```python
import torch

def _softmax(x, axis=-1):
    return torch.softmax(x, dim=axis)
def _gelu(x):
    return torch.nn.functional.gelu(x, approximate="tanh")
def _silu(x):
    return torch.nn.functional.silu(x)
def _sigmoid(x):
    return torch.sigmoid(x)
def _layernorm(x, axis=-1, eps=1e-5):
    m = x.mean(dim=axis, keepdim=True)
    v = x.var(dim=axis, keepdim=True, unbiased=False)
    return (x - m) / torch.sqrt(v + eps)
def _scatter_add(tgt, idx, src, axis=0):
    return tgt.clone().index_add_(axis, idx, src)
def _segment_sum(src, seg, n):
    out = torch.zeros((n,) + src.shape[1:], dtype=src.dtype)
    return out.index_add_(0, seg, src)
def _pad(x, pw):
    flat = tuple(v for pair in reversed(pw) for v in pair)
    return torch.nn.functional.pad(x, flat)

kernel_name = 'gated_mix__sliding_local_dilated__compressed_kv_cla__prompt'

def setup_inputs():

    _w = (lambda a: (lambda t: t.to(torch.bfloat16) if t.is_floating_point() else t)(torch.as_tensor(a)))
    def _A_setup():
        B, S, D = 1, 2048, 576
        return {
            "x": _w((lambda *s: torch.randn(*s, dtype=torch.bfloat16) * 0.05)(B, S, D)),
            "wqkv": _w((lambda *s: torch.randn(*s, dtype=torch.bfloat16) * 1.6)(D, 3 * D)),
            "wo": _w((lambda *s: torch.randn(*s, dtype=torch.bfloat16) * 0.05)(D, D)),
        }
    _A_in = _A_setup()

    def _B_setup():
        B, H, Sq, Sk, D, M = 1, 32, 2048, 2048, 128, 576
        Dc = 4 * D
        return {
            "x": _w((lambda *s: torch.randn(*s, dtype=torch.bfloat16) * 0.05)(B, Sq, M)),
            "c_kv": _w((lambda *s: torch.randn(*s, dtype=torch.bfloat16) * 1.6)(B, Sk, Dc)),
            "w_q": _w((lambda *s: torch.randn(*s, dtype=torch.bfloat16) * 6.4)(M, H, D) * (M ** -0.5)),
            "w_uk": _w((lambda *s: torch.randn(*s, dtype=torch.bfloat16) * 6.4)(Dc, H, D) * (Dc ** -0.5)),
            "w_uv": _w((lambda *s: torch.randn(*s, dtype=torch.bfloat16) * 1.6)(Dc, H, D) * (Dc ** -0.5)),
            "w_o": _w((lambda *s: torch.randn(*s, dtype=torch.bfloat16) * 1.6)(H, D, M) * ((H * D) ** -0.5)),
        }
    _B_in = _B_setup()

    return {
        "A_x": _A_in["x"],
        "A_wqkv": _A_in["wqkv"],
        "A_wo": _A_in["wo"],
        "B_x": _B_in["x"],
        "B_c_kv": _B_in["c_kv"],
        "B_w_q": _B_in["w_q"],
        "B_w_uk": _B_in["w_uk"],
        "B_w_uv": _B_in["w_uv"],
        "B_w_o": _B_in["w_o"],
        "gate_w": _w((lambda *s: torch.randn(*s, dtype=torch.bfloat16) * 0.05)(576) * 16.0),
    }

def reference(A_x, A_wqkv, A_wo, B_x, B_c_kv, B_w_q, B_w_uk, B_w_uv, B_w_o, gate_w):
    def _A_ref(x, wqkv, wo):
        B, S, D = x.shape
        H = 32; Dh = D // H
        W, dil = 8, 2
        qkv = (lambda x, *d: x.permute(*d))((x @ wqkv).reshape(B, S, 3, H, Dh), 2, 0, 3, 1, 4)
        q, k, v = qkv[0], qkv[1], qkv[2]
        scale = Dh ** -0.5
        pos = torch.arange(S)
        off = torch.arange(W) * dil
        idx = pos[:, None] - off[None, :]
        mask = idx >= 0
        idx_c = torch.where(mask, idx, 0).reshape(-1)
        kg = k[:, :, idx_c, :].reshape(B, H, S, W, Dh)
        vg = v[:, :, idx_c, :].reshape(B, H, S, W, Dh)
        logits = torch.einsum("bhsd,bhswd->bhsw", q, kg) * scale
        logits = torch.where(mask[None, None, :, :], logits, -1e9)
        attn = _softmax(logits, axis=-1)
        o = torch.einsum("bhsw,bhswd->bhsd", attn, vg)
        return (lambda x, *d: x.permute(*d))(o, 0, 2, 1, 3).reshape(B, S, D) @ wo

    def _B_ref(x, c_kv, w_q, w_uk, w_uv, w_o):
        B, Sq, M = x.shape[0], x.shape[1], x.shape[2]
        Sk = c_kv.shape[1]
        H, D = w_q.shape[1], w_q.shape[2]
        q = torch.einsum("bqm,mhd->bhqd", x, w_q)
        k = torch.einsum("bkc,chd->bhkd", c_kv, w_uk)
        v = torch.einsum("bkc,chd->bhkd", c_kv, w_uv)
        scores = torch.einsum("bhqd,bhkd->bhqk", q, k) * (D ** -0.5)
        off = Sk - Sq
        qi = torch.arange(Sq)[:, None]
        kj = torch.arange(Sk)[None, :]
        cmask = kj <= (qi + off)
        scores = torch.where(cmask[None, None], scores, -1e9)
        p = _softmax(scores, axis=-1)
        ctx = torch.einsum("bhqk,bhkd->bhqd", p, v)
        return torch.einsum("bhqd,hdm->bqm", ctx, w_o)

    x = A_x
    g = _sigmoid((x * gate_w).sum(-1, keepdims=True))
    a = _A_ref(x, A_wqkv, A_wo)
    b = _B_ref(x, B_c_kv, B_w_q, B_w_uk, B_w_uv, B_w_o)
    return g * a + (1 - g) * b
```

```asm
; @launch kernel=fused_kernel grid=(256,1,1) block=(256,1,1) lds=163840
; @launch kernel=outproj_kernel grid=(256,1,1) block=(256,1,1) lds=73728
.amdgcn_target "amdgcn-amd-amdhsa--gfx950"
.text
.globl fused_kernel
.p2align 8
.type fused_kernel,@function
fused_kernel:
    s_cmp_ge_u32 s2, 256
    s_cbranch_scc1 K1_END
    s_getpc_b64 s[94:95]
    s_load_dwordx2 s[8:9], s[0:1], 32
    s_load_dwordx2 s[12:13], s[0:1], 48
    s_load_dwordx2 s[16:17], s[0:1], 56
    s_load_dwordx2 s[20:21], s[0:1], 0
    s_load_dwordx2 s[24:25], s[0:1], 40
    s_load_dwordx2 s[88:89], s[0:1], 8
    s_load_dwordx2 s[90:91], s[0:1], 72
    s_load_dwordx2 s[48:49], s[0:1], 64
    s_load_dwordx2 s[92:93], s[0:1], 16
    s_load_dwordx2 s[44:45], s[0:1], 88
    s_load_dwordx2 s[56:57], s[0:1], 96
    v_lshrrev_b32 v64, 6, v0
    v_and_b32 v31, 63, v0
    v_readfirstlane_b32 s4, v64
    s_and_b32 s5, s2, 7
    s_lshl_b32 s5, s5, 2
    s_bfe_u32 s7, s2, 0x20003
    s_add_u32 s5, s5, s7
    s_lshr_b32 s6, s2, 5
    s_lshl_b32 s69, s4, 12
    s_mov_b32 s10, 2097152
    s_mov_b32 s11, 0x20000
    s_mov_b32 s14, 4194304
    s_mov_b32 s15, 0x20000
    s_mov_b32 s18, 4194304
    s_mov_b32 s19, 0x20000
    v_lshrrev_b32 v65, 3, v31
    v_and_b32 v66, 7, v31
    v_lshrrev_b32 v67, 1, v65
    v_xor_b32 v66, v66, v67
    v_lshlrev_b32 v66, 4, v66
    v_xor_b32 v67, 64, v66
    s_lshr_b32 s7, s4, 1
    s_lshl_b32 s73, s7, 7
    s_and_b32 s3, s4, 1
    s_lshl_b32 s98, s3, 5
    s_add_u32 s98, s98, s73
    v_add_lshl_u32 v68, v65, s98, 10
    v_add_u32 v6, v68, v66
    v_add_u32 v7, v68, v67
    v_add_u32 v7, 7168, v7
    v_add_u32 v8, v68, v66
    v_add_u32 v8, 14336, v8
    v_add_u32 v9, v68, v67
    v_add_u32 v9, 21504, v9
    v_lshrrev_b32 v69, 4, v31
    v_and_b32 v70, 15, v31
    v_lshlrev_b32 v71, 1, v69
    v_xor_b32 v71, v71, v70
    v_lshlrev_b32 v71, 4, v71
    v_xor_b32 v72, 128, v71
    s_lshl_b32 s98, s4, 4
    v_add_lshl_u32 v73, v69, s98, 13
    v_add_u32 v2, v73, v71
    v_add_u32 v3, v73, v71
    v_add_u32 v3, 31744, v3
    v_add_u32 v4, v73, v72
    v_add_u32 v4, 63488, v4
    v_add_u32 v5, v73, v72
    v_add_u32 v5, 95232, v5
    s_lshl_b32 s60, s5, 8
    s_lshl_b32 s61, s6, 18
    s_add_u32 s62, s61, 65536
    s_waitcnt lgkmcnt(0)
    s_add_u32 m0, s69, 0
    s_nop 0
    buffer_load_dwordx4 v6, s[8:11], s61 offen lds
    buffer_load_dwordx4 v7, s[8:11], s61 offen offset:1024 lds
    buffer_load_dwordx4 v8, s[8:11], s61 offen offset:2048 lds
    buffer_load_dwordx4 v9, s[8:11], s61 offen offset:3072 lds
    s_add_u32 s61, s61, 128
    s_add_u32 m0, s69, 16384
    s_nop 0
    buffer_load_dwordx4 v6, s[8:11], s62 offen lds
    buffer_load_dwordx4 v7, s[8:11], s62 offen offset:1024 lds
    buffer_load_dwordx4 v8, s[8:11], s62 offen offset:2048 lds
    buffer_load_dwordx4 v9, s[8:11], s62 offen offset:3072 lds
    s_add_u32 s62, s62, 128
    s_add_u32 m0, s69, 32768
    s_nop 0
    buffer_load_dwordx4 v2, s[12:15], s60 offen lds
    buffer_load_dwordx4 v3, s[12:15], s60 offen offset:1024 lds
    buffer_load_dwordx4 v4, s[12:15], s60 offen offset:2048 lds
    buffer_load_dwordx4 v5, s[12:15], s60 offen offset:3072 lds
    s_add_u32 m0, s69, 49152
    s_nop 0
    buffer_load_dwordx4 v6, s[8:11], s61 offen lds
    buffer_load_dwordx4 v7, s[8:11], s61 offen offset:1024 lds
    buffer_load_dwordx4 v8, s[8:11], s61 offen offset:2048 lds
    buffer_load_dwordx4 v9, s[8:11], s61 offen offset:3072 lds
    s_add_u32 s61, s61, 128
    s_add_u32 m0, s69, 65536
    s_nop 0
    buffer_load_dwordx4 v2, s[16:19], s60 offen lds
    buffer_load_dwordx4 v3, s[16:19], s60 offen offset:1024 lds
    buffer_load_dwordx4 v4, s[16:19], s60 offen offset:2048 lds
    buffer_load_dwordx4 v5, s[16:19], s60 offen offset:3072 lds
    s_add_u32 s60, s60, 524288
    s_add_u32 m0, s69, 81920
    s_nop 0
    buffer_load_dwordx4 v6, s[8:11], s62 offen lds
    buffer_load_dwordx4 v7, s[8:11], s62 offen offset:1024 lds
    buffer_load_dwordx4 v8, s[8:11], s62 offen offset:2048 lds
    buffer_load_dwordx4 v9, s[8:11], s62 offen offset:3072 lds
    s_add_u32 s62, s62, 128
    s_add_u32 m0, s69, 98304
    s_nop 0
    buffer_load_dwordx4 v2, s[12:15], s60 offen lds
    buffer_load_dwordx4 v3, s[12:15], s60 offen offset:1024 lds
    buffer_load_dwordx4 v4, s[12:15], s60 offen offset:2048 lds
    buffer_load_dwordx4 v5, s[12:15], s60 offen offset:3072 lds
    s_add_u32 m0, s69, 114688
    s_nop 0
    buffer_load_dwordx4 v6, s[8:11], s61 offen lds
    buffer_load_dwordx4 v7, s[8:11], s61 offen offset:1024 lds
    buffer_load_dwordx4 v8, s[8:11], s61 offen offset:2048 lds
    buffer_load_dwordx4 v9, s[8:11], s61 offen offset:3072 lds
    s_add_u32 s61, s61, 128
    v_lshlrev_b32 v74, 7, v0
    v_min_u32 v75, 65532, v74
    global_load_dword v76, v75, s[94:95]
    v_add_u32 v74, 0x8000, v74
    v_min_u32 v75, 65532, v74
    global_load_dword v76, v75, s[94:95]
    v_add_u32 v74, 0x8000, v74
    s_mov_b32 s22, 2359296
    s_mov_b32 s23, 0x20000
    s_mov_b32 s26, 4718592
    s_mov_b32 s27, 0x20000
    s_mov_b32 s50, 4718592
    s_mov_b32 s51, 0x20000
    s_mov_b32 s46, 256
    s_mov_b32 s47, 0x20000
    s_mul_i32 s7, s5, 1081344
    s_add_u32 s36, s56, s7
    s_addc_u32 s37, s57, 0
    s_mov_b32 s38, 1081344
    s_mov_b32 s39, 0x20000
    s_add_u32 s40, s56, 35651584
    s_addc_u32 s41, s57, 0
    s_mov_b32 s42, 19136512
    s_mov_b32 s43, 0x20000
    s_add_u32 s56, s56, 56623104
    s_addc_u32 s57, s57, 0
    s_mov_b32 s58, 5382144
    s_mov_b32 s59, 0x20000
    s_mul_i32 s7, s5, 36
    s_cmp_eq_u32 s4, 3
    s_cselect_b32 s28, s20, s88
    s_cselect_b32 s29, s21, s89
    s_cselect_b32 s30, s22, 1990656
    s_mov_b32 s31, 0x20000
    s_cselect_b32 s65, 0, s7
    s_mov_b32 s98, 128
    s_cselect_b32 s67, s98, 221184
    s_cmp_eq_u32 s4, 2
    s_cselect_b32 s32, s90, s28
    s_cselect_b32 s33, s91, s29
    s_cselect_b32 s34, 1152, s30
    s_mov_b32 s35, 0x20000
    s_cselect_b32 s66, 0, s65
    s_cselect_b32 s68, s98, s67
    s_cmp_eq_u32 s4, 0
    s_cselect_b32 s52, s48, s92
    s_cselect_b32 s53, s49, s93
    s_cselect_b32 s54, s50, 663552
    s_mov_b32 s55, 0x20000
    s_mul_i32 s63, s6, 147456
    s_sub_u32 s64, 2211840, s63
    s_lshl_b32 s70, s6, 2
    s_lshl1_add_u32 s70, s3, s70
    s_lshl_b32 s70, s70, 15
    s_lshl_b32 s98, s73, 6
    s_add_u32 s71, s70, s98
    s_add_u32 s71, s71, 49152
    s_lshl_b32 s98, s73, 4
    s_add_u32 s70, s70, s98
    v_lshlrev_b32 v1, 4, v31
    s_lshl_b32 s98, s4, 5
    v_add_u32 v68, s98, v65
    v_mul_u32_u24 v68, 1152, v68
    v_add_u32 v10, v68, v66
    v_add_u32 v11, v68, v67
    v_add_u32 v11, 8192, v11
    v_add_u32 v12, v68, v66
    v_add_u32 v12, 16384, v12
    v_add_u32 v13, v68, v67
    v_add_u32 v13, 24576, v13
    v_lshrrev_b32 v71, 1, v70
    v_xor_b32 v71, v71, v69
    v_lshlrev_b32 v71, 4, v71
    v_lshl_add_u32 v71, v70, 7, v71
    v_xor_b32 v72, 64, v71
    s_lshl_b32 s98, s3, 13
    v_add_u32 v22, s98, v71
    v_add_u32 v23, s98, v72
    s_lshl_b32 s98, s4, 11
    v_add_u32 v24, s98, v71
    v_add_u32 v25, s98, v72
    s_lshl_b32 s98, s3, 11
    s_add_u32 s98, s98, 12288
    v_add_u32 v100, s98, v71
    v_add_u32 v101, s98, v72
    v_bfe_u32 v73, v31, 2, 2
    v_and_b32 v74, 3, v31
    v_lshl_add_u32 v75, v69, 3, v73
    v_and_b32 v77, 1, v69
    v_lshl_add_u32 v77, v77, 2, v73
    v_lshlrev_b32 v77, 5, v77
    v_lshl_add_u32 v77, v74, 3, v77
    v_lshl_add_u32 v77, v75, 8, v77
    v_xor_b32 v14, 0, v77
    v_xor_b32 v14, s73, v14
    v_xor_b32 v15, 32, v77
    v_xor_b32 v15, s73, v15
    v_xor_b32 v16, 64, v77
    v_xor_b32 v16, s73, v16
    v_xor_b32 v17, 96, v77
    v_xor_b32 v17, s73, v17
    v_xor_b32 v18, 128, v77
    v_xor_b32 v19, 160, v77
    v_xor_b32 v20, 192, v77
    v_xor_b32 v21, 224, v77
    v_mul_u32_u24 v75, 144, v75
    s_lshr_b32 s98, s73, 4
    v_add_u32 v78, s98, v74
    v_mul_u32_u24 v79, 52, v78
    v_lshrrev_b32 v79, 8, v79
    v_add_u32 v78, v78, v79
    v_lshl_add_u32 v26, v78, 3, v75
    v_add_u32 v78, 4, v74
    v_mul_u32_u24 v79, 52, v78
    v_lshrrev_b32 v79, 8, v79
    v_add_u32 v78, v78, v79
    v_lshl_add_u32 v27, v78, 3, v75
    v_subrev_u32 v78, s98, v74
    v_add_u32 v78, 8, v78
    v_mul_u32_u24 v79, 52, v78
    v_lshrrev_b32 v79, 8, v79
    v_add_u32 v78, v78, v79
    v_lshl_add_u32 v28, v78, 3, v75
    v_add_u32 v78, 12, v74
    v_mul_u32_u24 v79, 52, v78
    v_lshrrev_b32 v79, 8, v79
    v_add_u32 v78, v78, v79
    v_lshl_add_u32 v29, v78, 3, v75
    v_lshlrev_b32 v30, 4, v69
    v_add_u32 v30, 9216, v30
    s_mov_b32 s86, 0x10001000
    s_mov_b32 s87, 0x10001000
    s_lshl_b32 s98, s6, 7
    s_sub_u32 s98, s98, 16
    s_max_i32 s98, s98, 0
    s_lshl_b32 s99, s6, 7
    s_sub_u32 s99, 1904, s99
    s_lshl_b32 s7, s4, 8
    s_add_u32 s7, s7, 0
    v_add_u32 v73, s7, v31
    v_mul_u32_u24 v74, 7282, v73
    v_lshrrev_b32 v74, 16, v74
    v_mul_u32_u24 v75, 9, v74
    v_sub_u32 v75, v73, v75
    v_mul_u32_u24 v77, 11, v75
    v_lshrrev_b32 v77, 5, v77
    v_mul_u32_u24 v73, 3, v77
    v_sub_u32 v75, v75, v73
    v_add_u32 v77, 1, v77
    v_cmp_eq_u32 vcc, 3, v77
    s_nop 1
    v_cndmask_b32_e64 v77, v77, 0, vcc
    v_mul_u32_u24 v77, 1152, v77
    v_mul_u32_u24 v74, 3456, v74
    v_lshl_add_u32 v75, v75, 4, v77
    v_add_u32 v96, v74, v75
    v_add_u32 v73, s98, v65
    v_mul_u32_u24 v73, 1152, v73
    v_add_u32 v73, v73, v66
    s_cmp_eq_u32 s4, 3
    s_cselect_b64 vcc, -1, 0
    v_cndmask_b32 v96, v96, v73, vcc
    s_lshl_b32 s7, s4, 8
    s_add_u32 s7, s7, 64
    v_add_u32 v73, s7, v31
    v_mul_u32_u24 v74, 7282, v73
    v_lshrrev_b32 v74, 16, v74
    v_mul_u32_u24 v75, 9, v74
    v_sub_u32 v75, v73, v75
    v_mul_u32_u24 v77, 11, v75
    v_lshrrev_b32 v77, 5, v77
    v_mul_u32_u24 v73, 3, v77
    v_sub_u32 v75, v75, v73
    v_add_u32 v77, 1, v77
    v_cmp_eq_u32 vcc, 3, v77
    s_nop 1
    v_cndmask_b32_e64 v77, v77, 0, vcc
    v_mul_u32_u24 v77, 1152, v77
    v_mul_u32_u24 v74, 3456, v74
    v_lshl_add_u32 v75, v75, 4, v77
    v_add_u32 v97, v74, v75
    v_add_u32 v73, s98, v65
    v_add_u32 v73, 8, v73
    v_mul_u32_u24 v73, 1152, v73
    v_add_u32 v73, v73, v67
    s_cmp_eq_u32 s4, 3
    s_cselect_b64 vcc, -1, 0
    v_cndmask_b32 v97, v97, v73, vcc
    v_mov_b32 v73, 67108864
    v_cmp_gt_u32 vcc, 8, v31
    s_nop 1
    v_cndmask_b32 v73, v73, v1, vcc
    s_cmp_eq_u32 s4, 2
    s_cselect_b64 vcc, -1, 0
    v_cndmask_b32 v97, v97, v73, vcc
    s_lshl_b32 s7, s4, 8
    s_add_u32 s7, s7, 128
    v_add_u32 v73, s7, v31
    v_mul_u32_u24 v74, 7282, v73
    v_lshrrev_b32 v74, 16, v74
    v_mul_u32_u24 v75, 9, v74
    v_sub_u32 v75, v73, v75
    v_mul_u32_u24 v77, 11, v75
    v_lshrrev_b32 v77, 5, v77
    v_mul_u32_u24 v73, 3, v77
    v_sub_u32 v75, v75, v73
    v_add_u32 v77, 1, v77
    v_cmp_eq_u32 vcc, 3, v77
    s_nop 1
    v_cndmask_b32_e64 v77, v77, 0, vcc
    v_mul_u32_u24 v77, 1152, v77
    v_mul_u32_u24 v74, 3456, v74
    v_lshl_add_u32 v75, v75, 4, v77
    v_add_u32 v98, v74, v75
    v_add_u32 v73, s99, v65
    v_mul_u32_u24 v73, 1152, v73
    v_add_u32 v73, v73, v66
    s_cmp_eq_u32 s4, 3
    s_cselect_b64 vcc, -1, 0
    v_cndmask_b32 v98, v98, v73, vcc
    v_mov_b32 v73, 67108864
    s_cmp_eq_u32 s4, 2
    s_cselect_b64 vcc, -1, 0
    v_cndmask_b32 v98, v98, v73, vcc
    s_lshl_b32 s7, s4, 8
    s_add_u32 s7, s7, 192
    v_add_u32 v73, s7, v31
    v_mul_u32_u24 v74, 7282, v73
    v_lshrrev_b32 v74, 16, v74
    v_mul_u32_u24 v75, 9, v74
    v_sub_u32 v75, v73, v75
    v_mul_u32_u24 v77, 11, v75
    v_lshrrev_b32 v77, 5, v77
    v_mul_u32_u24 v73, 3, v77
    v_sub_u32 v75, v75, v73
    v_add_u32 v77, 1, v77
    v_cmp_eq_u32 vcc, 3, v77
    s_nop 1
    v_cndmask_b32_e64 v77, v77, 0, vcc
    v_mul_u32_u24 v77, 1152, v77
    v_mul_u32_u24 v74, 3456, v74
    v_lshl_add_u32 v75, v75, 4, v77
    v_add_u32 v99, v74, v75
    v_add_u32 v73, s99, v65
    v_add_u32 v73, 8, v73
    v_mul_u32_u24 v73, 1152, v73
    v_add_u32 v73, v73, v67
    s_cmp_eq_u32 s4, 3
    s_cselect_b64 vcc, -1, 0
    v_cndmask_b32 v99, v99, v73, vcc
    v_mov_b32 v73, 67108864
    s_cmp_eq_u32 s4, 2
    s_cselect_b64 vcc, -1, 0
    v_cndmask_b32 v99, v99, v73, vcc
    s_mov_b32 s74, 0x3e0293ee
    s_mov_b64 s[84:85], 0
    s_mov_b32 s83, 0
    s_waitcnt vmcnt(18)
    s_barrier
    ds_read_b128 a[0:3], v22 offset:0
    ds_read_b64_tr_b16 v[40:41], v14 offset:32768
    ds_read_b64_tr_b16 v[42:43], v14 offset:33792
    s_waitcnt lgkmcnt(0)
    v_mfma_f32_16x16x32_bf16 v[128:131], v[40:43], a[0:3], 0
    s_add_u32 m0, s69, 131072
    ds_read_b128 a[4:7], v23 offset:0
    ds_read_b64_tr_b16 v[44:45], v14 offset:40960
    ds_read_b64_tr_b16 v[46:47], v14 offset:41984
    s_waitcnt lgkmcnt(0)
    v_mfma_f32_16x16x32_bf16 v[128:131], v[44:47], a[4:7], v[128:131]
    s_lshr_b32 s7, s6, 1
    ds_read_b128 a[8:11], v22 offset:2048
    ds_read_b128 a[12:15], v23 offset:2048
    s_waitcnt lgkmcnt(1)
    v_mfma_f32_16x16x32_bf16 v[132:135], v[40:43], a[8:11], 0
    s_lshl2_add_u32 s7, s5, s7
    ds_read_b128 a[16:19], v22 offset:4096
    ds_read_b128 a[20:23], v23 offset:4096
    s_waitcnt lgkmcnt(2)
    v_mfma_f32_16x16x32_bf16 v[132:135], v[44:47], a[12:15], v[132:135]
    s_and_b32 s3, s6, 1
    ds_read_b128 a[24:27], v22 offset:6144
    ds_read_b128 a[28:31], v23 offset:6144
    s_waitcnt lgkmcnt(3)
    v_mfma_f32_16x16x32_bf16 v[136:139], v[40:43], a[16:19], 0
    s_mul_i32 s98, s7, 36864
    ds_read_b128 a[32:35], v22 offset:16384
    ds_read_b128 a[36:39], v23 offset:16384
    s_waitcnt lgkmcnt(4)
    v_mfma_f32_16x16x32_bf16 v[136:139], v[44:47], a[20:23], v[136:139]
    s_mul_i32 s99, s3, 576
    ds_read_b128 a[40:43], v22 offset:18432
    ds_read_b128 a[44:47], v23 offset:18432
    s_waitcnt lgkmcnt(5)
    v_mfma_f32_16x16x32_bf16 v[140:143], v[40:43], a[24:27], 0
    s_add_u32 s98, s98, s99
    ds_read_b128 a[48:51], v22 offset:20480
    ds_read_b128 a[52:55], v23 offset:20480
    s_waitcnt lgkmcnt(6)
    v_mfma_f32_16x16x32_bf16 v[140:143], v[44:47], a[28:31], v[140:143]
    s_mul_i32 s99, s3, 18432
    ds_read_b128 a[56:59], v22 offset:22528
    ds_read_b128 a[60:63], v23 offset:22528
    s_waitcnt lgkmcnt(7)
    v_mfma_f32_16x16x32_bf16 v[144:147], v[40:43], a[32:35], 0
    s_waitcnt lgkmcnt(6)
    buffer_load_dwordx4 v2, s[16:19], s60 offen lds
    v_mfma_f32_16x16x32_bf16 v[144:147], v[44:47], a[36:39], v[144:147]
    s_waitcnt lgkmcnt(5)
    ds_read_b128 a[64:67], v22 offset:49152
    ds_read_b64_tr_b16 v[48:49], v15 offset:32768
    v_mfma_f32_16x16x32_bf16 v[148:151], v[40:43], a[40:43], 0
    s_waitcnt lgkmcnt(6)
    buffer_load_dwordx4 v3, s[16:19], s60 offen offset:1024 lds
    v_mfma_f32_16x16x32_bf16 v[148:151], v[44:47], a[44:47], v[148:151]
    s_waitcnt lgkmcnt(4)
    ds_read_b64_tr_b16 v[50:51], v15 offset:33792
    ds_read_b128 a[68:71], v23 offset:49152
    v_mfma_f32_16x16x32_bf16 v[152:155], v[40:43], a[48:51], 0
    ds_read_b64_tr_b16 v[52:53], v15 offset:40960
    ds_read_b64_tr_b16 v[54:55], v15 offset:41984
    v_mfma_f32_16x16x32_bf16 v[152:155], v[44:47], a[52:55], v[152:155]
    s_waitcnt lgkmcnt(6)
    buffer_load_dwordx4 v4, s[16:19], s60 offen offset:2048 lds
    v_mfma_f32_16x16x32_bf16 v[156:159], v[40:43], a[56:59], 0
    ds_read_b128 a[72:75], v22 offset:51200
    ds_read_b64_tr_b16 v[56:57], v16 offset:32768
    v_mfma_f32_16x16x32_bf16 v[156:159], v[44:47], a[60:63], v[156:159]
    s_waitcnt lgkmcnt(5)
    ds_read_b64_tr_b16 v[58:59], v16 offset:33792
    ds_read_b64_tr_b16 v[60:61], v16 offset:40960
    v_mfma_f32_16x16x32_bf16 v[160:163], v[48:51], a[0:3], 0
    s_waitcnt lgkmcnt(4)
    ds_read_b64_tr_b16 v[62:63], v16 offset:41984
    ds_read_b64_tr_b16 v[40:41], v17 offset:32768
    v_mfma_f32_16x16x32_bf16 v[160:163], v[52:55], a[4:7], v[160:163]
    ds_read_b64_tr_b16 v[42:43], v17 offset:33792
    ds_read_b64_tr_b16 v[44:45], v17 offset:40960
    v_mfma_f32_16x16x32_bf16 v[164:167], v[48:51], a[8:11], 0
    buffer_load_dwordx4 v5, s[16:19], s60 offen offset:3072 lds
    v_mfma_f32_16x16x32_bf16 v[164:167], v[52:55], a[12:15], v[164:167]
    ds_read_b128 a[76:79], v23 offset:51200
    ds_read_b64_tr_b16 v[46:47], v17 offset:41984
    v_mfma_f32_16x16x32_bf16 v[168:171], v[48:51], a[16:19], 0
    v_add_u32 v14, 0x10000, v14
    v_add_u32 v15, 0x10000, v15
    v_mfma_f32_16x16x32_bf16 v[168:171], v[52:55], a[20:23], v[168:171]
    v_add_u32 v16, 0x10000, v16
    v_add_u32 v17, 0x10000, v17
    v_mfma_f32_16x16x32_bf16 v[172:175], v[48:51], a[24:27], 0
    v_add_u32 v18, 0x10000, v18
    v_add_u32 v19, 0x10000, v19
    v_mfma_f32_16x16x32_bf16 v[172:175], v[52:55], a[28:31], v[172:175]
    v_add_u32 v20, 0x10000, v20
    v_add_u32 v21, 0x10000, v21
    v_mfma_f32_16x16x32_bf16 v[176:179], v[48:51], a[32:35], 0
    s_add_u32 m0, s69, 147456
    ds_read_b128 a[80:83], v22 offset:53248
    v_add_u32 v26, 0x10000, v26
    v_mfma_f32_16x16x32_bf16 v[176:179], v[52:55], a[36:39], v[176:179]
    s_add_u32 s60, s60, 524288
    buffer_load_dwordx4 v6, s[8:11], s62 offen lds
    v_mfma_f32_16x16x32_bf16 v[180:183], v[48:51], a[40:43], 0
    v_add_u32 v27, 0x10000, v27
    v_add_u32 v28, 0x10000, v28
    v_mfma_f32_16x16x32_bf16 v[180:183], v[52:55], a[44:47], v[180:183]
    v_add_u32 v29, 0x10000, v29
    v_add_u32 v30, 0x10000, v30
    v_mfma_f32_16x16x32_bf16 v[184:187], v[48:51], a[48:51], 0
    v_cmp_eq_u32 vcc, s69, v1
    v_mfma_f32_16x16x32_bf16 v[184:187], v[52:55], a[52:55], v[184:187]
    ds_read_b128 a[84:87], v23 offset:53248
    v_mfma_f32_16x16x32_bf16 v[188:191], v[48:51], a[56:59], 0
    v_mfma_f32_16x16x32_bf16 v[188:191], v[52:55], a[60:63], v[188:191]
    s_waitcnt lgkmcnt(1)
    buffer_load_dwordx4 v7, s[8:11], s62 offen offset:1024 lds
    v_mfma_f32_16x16x32_bf16 v[192:195], v[56:59], a[0:3], 0
    v_mfma_f32_16x16x32_bf16 v[192:195], v[60:63], a[4:7], v[192:195]
    v_mfma_f32_16x16x32_bf16 v[196:199], v[56:59], a[8:11], 0
    v_mfma_f32_16x16x32_bf16 v[196:199], v[60:63], a[12:15], v[196:199]
    ds_read_b128 a[88:91], v22 offset:55296
    v_mfma_f32_16x16x32_bf16 v[200:203], v[56:59], a[16:19], 0
    v_mfma_f32_16x16x32_bf16 v[200:203], v[60:63], a[20:23], v[200:203]
    buffer_load_dwordx4 v8, s[8:11], s62 offen offset:2048 lds
    v_mfma_f32_16x16x32_bf16 v[204:207], v[56:59], a[24:27], 0
    v_mfma_f32_16x16x32_bf16 v[204:207], v[60:63], a[28:31], v[204:207]
    v_mfma_f32_16x16x32_bf16 v[208:211], v[56:59], a[32:35], 0
    ds_read_b128 a[92:95], v23 offset:55296
    v_mfma_f32_16x16x32_bf16 v[208:211], v[60:63], a[36:39], v[208:211]
    v_mfma_f32_16x16x32_bf16 v[212:215], v[56:59], a[40:43], 0
    v_mfma_f32_16x16x32_bf16 v[212:215], v[60:63], a[44:47], v[212:215]
    buffer_load_dwordx4 v9, s[8:11], s62 offen offset:3072 lds
    v_mfma_f32_16x16x32_bf16 v[216:219], v[56:59], a[48:51], 0
    v_mfma_f32_16x16x32_bf16 v[216:219], v[60:63], a[52:55], v[216:219]
    v_mfma_f32_16x16x32_bf16 v[220:223], v[56:59], a[56:59], 0
    v_mfma_f32_16x16x32_bf16 v[220:223], v[60:63], a[60:63], v[220:223]
    v_mfma_f32_16x16x32_bf16 v[224:227], v[40:43], a[0:3], 0
    v_mfma_f32_16x16x32_bf16 v[224:227], v[44:47], a[4:7], v[224:227]
    s_add_u32 s62, s62, 128
    v_mfma_f32_16x16x32_bf16 v[228:231], v[40:43], a[8:11], 0
    v_mfma_f32_16x16x32_bf16 v[228:231], v[44:47], a[12:15], v[228:231]
    v_mfma_f32_16x16x32_bf16 v[232:235], v[40:43], a[16:19], 0
    v_mfma_f32_16x16x32_bf16 v[232:235], v[44:47], a[20:23], v[232:235]
    s_waitcnt vmcnt(18)
    s_barrier
    ds_read_b64_tr_b16 v[48:49], v14 offset:0
    v_mfma_f32_16x16x32_bf16 v[236:239], v[40:43], a[24:27], 0
    s_add_u32 m0, s69, 0
    ds_read_b64_tr_b16 v[50:51], v14 offset:1024
    ds_read_b64_tr_b16 v[52:53], v14 offset:8192
    v_mfma_f32_16x16x32_bf16 v[236:239], v[44:47], a[28:31], v[236:239]
    buffer_load_dwordx4 v2, s[12:15], s60 offen lds
    v_mfma_f32_16x16x32_bf16 v[240:243], v[40:43], a[32:35], 0
    ds_read_b64_tr_b16 v[54:55], v14 offset:9216
    ds_read_b64_tr_b16 v[56:57], v15 offset:0
    v_mfma_f32_16x16x32_bf16 v[240:243], v[44:47], a[36:39], v[240:243]
    ds_read_b64_tr_b16 v[58:59], v15 offset:1024
    ds_read_b64_tr_b16 v[60:61], v15 offset:8192
    v_mfma_f32_16x16x32_bf16 v[244:247], v[40:43], a[40:43], 0
    ds_read_b64_tr_b16 v[62:63], v15 offset:9216
    v_mfma_f32_16x16x32_bf16 v[244:247], v[44:47], a[44:47], v[244:247]
    v_mfma_f32_16x16x32_bf16 v[248:251], v[40:43], a[48:51], 0
    v_mfma_f32_16x16x32_bf16 v[248:251], v[44:47], a[52:55], v[248:251]
    buffer_load_dwordx4 v3, s[12:15], s60 offen offset:1024 lds
    v_mfma_f32_16x16x32_bf16 v[252:255], v[40:43], a[56:59], 0
    ds_read_b64_tr_b16 v[40:41], v16 offset:0
    ds_read_b64_tr_b16 v[42:43], v16 offset:1024
    v_mfma_f32_16x16x32_bf16 v[252:255], v[44:47], a[60:63], v[252:255]
    s_waitcnt lgkmcnt(2)
    ds_read_b64_tr_b16 v[44:45], v16 offset:8192
    ds_read_b64_tr_b16 v[46:47], v16 offset:9216
    v_mfma_f32_16x16x32_bf16 a[128:131], a[0:3], v[48:51], 0
    v_mfma_f32_16x16x32_bf16 a[128:131], a[4:7], v[52:55], a[128:131]
    v_add_u32 v22, 0x10000, v22
    v_mfma_f32_16x16x32_bf16 a[132:135], a[8:11], v[48:51], 0
    ds_read_b128 a[96:99], v22 offset:16384
    v_mfma_f32_16x16x32_bf16 a[132:135], a[12:15], v[52:55], a[132:135]
    v_mfma_f32_16x16x32_bf16 a[136:139], a[16:19], v[48:51], 0
    v_mfma_f32_16x16x32_bf16 a[136:139], a[20:23], v[52:55], a[136:139]
    buffer_load_dwordx4 v4, s[12:15], s60 offen offset:2048 lds
    v_mfma_f32_16x16x32_bf16 a[140:143], a[24:27], v[48:51], 0
    v_add_u32 v23, 0x10000, v23
    v_mfma_f32_16x16x32_bf16 a[140:143], a[28:31], v[52:55], a[140:143]
    ds_read_b128 a[100:103], v23 offset:16384
    v_mfma_f32_16x16x32_bf16 a[144:147], a[32:35], v[48:51], 0
    v_mfma_f32_16x16x32_bf16 a[144:147], a[36:39], v[52:55], a[144:147]
    v_mfma_f32_16x16x32_bf16 a[148:151], a[40:43], v[48:51], 0
    v_mfma_f32_16x16x32_bf16 a[148:151], a[44:47], v[52:55], a[148:151]
    v_mfma_f32_16x16x32_bf16 a[152:155], a[48:51], v[48:51], 0
    buffer_load_dwordx4 v5, s[12:15], s60 offen offset:3072 lds
    v_mfma_f32_16x16x32_bf16 a[152:155], a[52:55], v[52:55], a[152:155]
    ds_read_b128 a[104:107], v22 offset:18432
    v_mfma_f32_16x16x32_bf16 a[156:159], a[56:59], v[48:51], 0
    ds_read_b64_tr_b16 v[48:49], v17 offset:0
    ds_read_b64_tr_b16 v[50:51], v17 offset:1024
    v_mfma_f32_16x16x32_bf16 a[156:159], a[60:63], v[52:55], a[156:159]
    ds_read_b64_tr_b16 v[52:53], v17 offset:8192
    ds_read_b64_tr_b16 v[54:55], v17 offset:9216
    v_mfma_f32_16x16x32_bf16 a[160:163], a[0:3], v[56:59], 0
    v_mfma_f32_16x16x32_bf16 a[160:163], a[4:7], v[60:63], a[160:163]
    v_mfma_f32_16x16x32_bf16 a[164:167], a[8:11], v[56:59], 0
    ds_read_b128 a[108:111], v23 offset:18432
    v_mfma_f32_16x16x32_bf16 a[164:167], a[12:15], v[60:63], a[164:167]
    s_add_u32 m0, s69, 16384
    v_mfma_f32_16x16x32_bf16 a[168:171], a[16:19], v[56:59], 0
    buffer_load_dwordx4 v6, s[8:11], s61 offen lds
    v_mfma_f32_16x16x32_bf16 a[168:171], a[20:23], v[60:63], a[168:171]
    v_mfma_f32_16x16x32_bf16 a[172:175], a[24:27], v[56:59], 0
    v_mfma_f32_16x16x32_bf16 a[172:175], a[28:31], v[60:63], a[172:175]
    v_mfma_f32_16x16x32_bf16 a[176:179], a[32:35], v[56:59], 0
    ds_read_b128 a[112:115], v22 offset:20480
    v_mfma_f32_16x16x32_bf16 a[176:179], a[36:39], v[60:63], a[176:179]
    v_mfma_f32_16x16x32_bf16 a[180:183], a[40:43], v[56:59], 0
    v_mfma_f32_16x16x32_bf16 a[180:183], a[44:47], v[60:63], a[180:183]
    buffer_load_dwordx4 v7, s[8:11], s61 offen offset:1024 lds
    v_mfma_f32_16x16x32_bf16 a[184:187], a[48:51], v[56:59], 0
    v_mfma_f32_16x16x32_bf16 a[184:187], a[52:55], v[60:63], a[184:187]
    ds_read_b128 a[116:119], v23 offset:20480
    v_mfma_f32_16x16x32_bf16 a[188:191], a[56:59], v[56:59], 0
    v_mfma_f32_16x16x32_bf16 a[188:191], a[60:63], v[60:63], a[188:191]
    s_waitcnt lgkmcnt(1)
    v_mfma_f32_16x16x32_bf16 a[192:195], a[0:3], v[40:43], 0
    v_mfma_f32_16x16x32_bf16 a[192:195], a[4:7], v[44:47], a[192:195]
    v_mfma_f32_16x16x32_bf16 a[196:199], a[8:11], v[40:43], 0
    v_mfma_f32_16x16x32_bf16 a[196:199], a[12:15], v[44:47], a[196:199]
    buffer_load_dwordx4 v8, s[8:11], s61 offen offset:2048 lds
    v_mfma_f32_16x16x32_bf16 a[200:203], a[16:19], v[40:43], 0
    ds_read_b128 a[120:123], v22 offset:22528
    v_mfma_f32_16x16x32_bf16 a[200:203], a[20:23], v[44:47], a[200:203]
    v_mfma_f32_16x16x32_bf16 a[204:207], a[24:27], v[40:43], 0
    v_mfma_f32_16x16x32_bf16 a[204:207], a[28:31], v[44:47], a[204:207]
    v_mfma_f32_16x16x32_bf16 a[208:211], a[32:35], v[40:43], 0
    ds_read_b128 a[124:127], v23 offset:22528
    v_mfma_f32_16x16x32_bf16 a[208:211], a[36:39], v[44:47], a[208:211]
    v_mfma_f32_16x16x32_bf16 a[212:215], a[40:43], v[40:43], 0
    buffer_load_dwordx4 v9, s[8:11], s61 offen offset:3072 lds
    v_mfma_f32_16x16x32_bf16 a[212:215], a[44:47], v[44:47], a[212:215]
    v_mfma_f32_16x16x32_bf16 a[216:219], a[48:51], v[40:43], 0
    v_mfma_f32_16x16x32_bf16 a[216:219], a[52:55], v[44:47], a[216:219]
    v_mfma_f32_16x16x32_bf16 a[220:223], a[56:59], v[40:43], 0
    v_mfma_f32_16x16x32_bf16 a[220:223], a[60:63], v[44:47], a[220:223]
    v_mfma_f32_16x16x32_bf16 a[224:227], a[0:3], v[48:51], 0
    v_mfma_f32_16x16x32_bf16 a[224:227], a[4:7], v[52:55], a[224:227]
    s_add_u32 s61, s61, 128
    v_mfma_f32_16x16x32_bf16 a[228:231], a[8:11], v[48:51], 0
    v_mfma_f32_16x16x32_bf16 a[228:231], a[12:15], v[52:55], a[228:231]
    v_mfma_f32_16x16x32_bf16 a[232:235], a[16:19], v[48:51], 0
    v_mfma_f32_16x16x32_bf16 a[232:235], a[20:23], v[52:55], a[232:235]
    s_waitcnt vmcnt(18)
    s_barrier
    ds_read_b64_tr_b16 v[56:57], v14 offset:32768
    v_mfma_f32_16x16x32_bf16 a[236:239], a[24:27], v[48:51], 0
    s_add_u32 m0, s69, 32768
    ds_read_b64_tr_b16 v[58:59], v14 offset:33792
    ds_read_b64_tr_b16 v[60:61], v14 offset:40960
    v_mfma_f32_16x16x32_bf16 a[236:239], a[28:31], v[52:55], a[236:239]
    buffer_load_dwordx4 v2, s[16:19], s60 offen lds
    v_mfma_f32_16x16x32_bf16 a[240:243], a[32:35], v[48:51], 0
    ds_read_b64_tr_b16 v[62:63], v14 offset:41984
    ds_read_b64_tr_b16 v[40:41], v15 offset:32768
    v_mfma_f32_16x16x32_bf16 a[240:243], a[36:39], v[52:55], a[240:243]
    ds_read_b64_tr_b16 v[42:43], v15 offset:33792
    ds_read_b64_tr_b16 v[44:45], v15 offset:40960
    v_mfma_f32_16x16x32_bf16 a[244:247], a[40:43], v[48:51], 0
    ds_read_b64_tr_b16 v[46:47], v15 offset:41984
    v_add_u32 v14, 0x10000, v14
    v_mfma_f32_16x16x32_bf16 a[244:247], a[44:47], v[52:55], a[244:247]
    v_add_u32 v15, 0x10000, v15
    v_mfma_f32_16x16x32_bf16 a[248:251], a[48:51], v[48:51], 0
    v_mfma_f32_16x16x32_bf16 a[248:251], a[52:55], v[52:55], a[248:251]
    buffer_load_dwordx4 v3, s[16:19], s60 offen offset:1024 lds
    v_mfma_f32_16x16x32_bf16 a[252:255], a[56:59], v[48:51], 0
    ds_read_b64_tr_b16 v[48:49], v16 offset:32768
    ds_read_b64_tr_b16 v[50:51], v16 offset:33792
    v_mfma_f32_16x16x32_bf16 a[252:255], a[60:63], v[52:55], a[252:255]
    s_waitcnt lgkmcnt(2)
    ds_read_b64_tr_b16 v[52:53], v16 offset:40960
    ds_read_b64_tr_b16 v[54:55], v16 offset:41984
    v_mfma_f32_16x16x32_bf16 v[128:131], v[56:59], a[64:67], v[128:131]
    v_add_u32 v16, 0x10000, v16
    v_mfma_f32_16x16x32_bf16 v[128:131], v[60:63], a[68:71], v[128:131]
    v_mfma_f32_16x16x32_bf16 v[132:135], v[56:59], a[72:75], v[132:135]
    ds_read_b128 a[0:3], v22 offset:49152
    v_mfma_f32_16x16x32_bf16 v[132:135], v[60:63], a[76:79], v[132:135]
    v_mfma_f32_16x16x32_bf16 v[136:139], v[56:59], a[80:83], v[136:139]
    v_mfma_f32_16x16x32_bf16 v[136:139], v[60:63], a[84:87], v[136:139]
    buffer_load_dwordx4 v4, s[16:19], s60 offen offset:2048 lds
    v_mfma_f32_16x16x32_bf16 v[140:143], v[56:59], a[88:91], v[140:143]
    v_mfma_f32_16x16x32_bf16 v[140:143], v[60:63], a[92:95], v[140:143]
    ds_read_b128 a[4:7], v23 offset:49152
    v_mfma_f32_16x16x32_bf16 v[144:147], v[56:59], a[96:99], v[144:147]
    v_mfma_f32_16x16x32_bf16 v[144:147], v[60:63], a[100:103], v[144:147]
    v_mfma_f32_16x16x32_bf16 v[148:151], v[56:59], a[104:107], v[148:151]
    v_mfma_f32_16x16x32_bf16 v[148:151], v[60:63], a[108:111], v[148:151]
    v_mfma_f32_16x16x32_bf16 v[152:155], v[56:59], a[112:115], v[152:155]
    buffer_load_dwordx4 v5, s[16:19], s60 offen offset:3072 lds
    v_mfma_f32_16x16x32_bf16 v[152:155], v[60:63], a[116:119], v[152:155]
    ds_read_b128 a[8:11], v22 offset:51200
    v_mfma_f32_16x16x32_bf16 v[156:159], v[56:59], a[120:123], v[156:159]
    ds_read_b64_tr_b16 v[56:57], v17 offset:32768
    ds_read_b64_tr_b16 v[58:59], v17 offset:33792
    v_mfma_f32_16x16x32_bf16 v[156:159], v[60:63], a[124:127], v[156:159]
    ds_read_b64_tr_b16 v[60:61], v17 offset:40960
    ds_read_b64_tr_b16 v[62:63], v17 offset:41984
    v_mfma_f32_16x16x32_bf16 v[160:163], v[40:43], a[64:67], v[160:163]
    v_add_u32 v17, 0x10000, v17
    v_mfma_f32_16x16x32_bf16 v[160:163], v[44:47], a[68:71], v[160:163]
    v_mfma_f32_16x16x32_bf16 v[164:167], v[40:43], a[72:75], v[164:167]
    ds_read_b128 a[12:15], v23 offset:51200
    v_mfma_f32_16x16x32_bf16 v[164:167], v[44:47], a[76:79], v[164:167]
    s_add_u32 m0, s69, 49152
    v_mfma_f32_16x16x32_bf16 v[168:171], v[40:43], a[80:83], v[168:171]
    s_add_u32 s60, s60, 524288
    buffer_load_dwordx4 v6, s[8:11], s62 offen lds
    v_mfma_f32_16x16x32_bf16 v[168:171], v[44:47], a[84:87], v[168:171]
    v_mfma_f32_16x16x32_bf16 v[172:175], v[40:43], a[88:91], v[172:175]
    v_mfma_f32_16x16x32_bf16 v[172:175], v[44:47], a[92:95], v[172:175]
    v_mfma_f32_16x16x32_bf16 v[176:179], v[40:43], a[96:99], v[176:179]
    ds_read_b128 a[16:19], v22 offset:53248
    v_mfma_f32_16x16x32_bf16 v[176:179], v[44:47], a[100:103], v[176:179]
    v_mfma_f32_16x16x32_bf16 v[180:183], v[40:43], a[104:107], v[180:183]
    v_mfma_f32_16x16x32_bf16 v[180:183], v[44:47], a[108:111], v[180:183]
    buffer_load_dwordx4 v7, s[8:11], s62 offen offset:1024 lds
    v_mfma_f32_16x16x32_bf16 v[184:187], v[40:43], a[112:115], v[184:187]
    v_mfma_f32_16x16x32_bf16 v[184:187], v[44:47], a[116:119], v[184:187]
    ds_read_b128 a[20:23], v23 offset:53248
    v_mfma_f32_16x16x32_bf16 v[188:191], v[40:43], a[120:123], v[188:191]
    v_mfma_f32_16x16x32_bf16 v[188:191], v[44:47], a[124:127], v[188:191]
    s_waitcnt lgkmcnt(1)
    v_mfma_f32_16x16x32_bf16 v[192:195], v[48:51], a[64:67], v[192:195]
    v_mfma_f32_16x16x32_bf16 v[192:195], v[52:55], a[68:71], v[192:195]
    v_mfma_f32_16x16x32_bf16 v[196:199], v[48:51], a[72:75], v[196:199]
    v_mfma_f32_16x16x32_bf16 v[196:199], v[52:55], a[76:79], v[196:199]
    buffer_load_dwordx4 v8, s[8:11], s62 offen offset:2048 lds
    v_mfma_f32_16x16x32_bf16 v[200:203], v[48:51], a[80:83], v[200:203]
    ds_read_b128 a[24:27], v22 offset:55296
    v_mfma_f32_16x16x32_bf16 v[200:203], v[52:55], a[84:87], v[200:203]
    v_mfma_f32_16x16x32_bf16 v[204:207], v[48:51], a[88:91], v[204:207]
    v_mfma_f32_16x16x32_bf16 v[204:207], v[52:55], a[92:95], v[204:207]
    v_mfma_f32_16x16x32_bf16 v[208:211], v[48:51], a[96:99], v[208:211]
    ds_read_b128 a[28:31], v23 offset:55296
    v_mfma_f32_16x16x32_bf16 v[208:211], v[52:55], a[100:103], v[208:211]
    v_mfma_f32_16x16x32_bf16 v[212:215], v[48:51], a[104:107], v[212:215]
    buffer_load_dwordx4 v9, s[8:11], s62 offen offset:3072 lds
    v_mfma_f32_16x16x32_bf16 v[212:215], v[52:55], a[108:111], v[212:215]
    v_mfma_f32_16x16x32_bf16 v[216:219], v[48:51], a[112:115], v[216:219]
    v_mfma_f32_16x16x32_bf16 v[216:219], v[52:55], a[116:119], v[216:219]
    v_mfma_f32_16x16x32_bf16 v[220:223], v[48:51], a[120:123], v[220:223]
    v_mfma_f32_16x16x32_bf16 v[220:223], v[52:55], a[124:127], v[220:223]
    v_mfma_f32_16x16x32_bf16 v[224:227], v[56:59], a[64:67], v[224:227]
    v_mfma_f32_16x16x32_bf16 v[224:227], v[60:63], a[68:71], v[224:227]
    s_add_u32 s62, s62, 128
    v_mfma_f32_16x16x32_bf16 v[228:231], v[56:59], a[72:75], v[228:231]
    v_mfma_f32_16x16x32_bf16 v[228:231], v[60:63], a[76:79], v[228:231]
    v_mfma_f32_16x16x32_bf16 v[232:235], v[56:59], a[80:83], v[232:235]
    v_mfma_f32_16x16x32_bf16 v[232:235], v[60:63], a[84:87], v[232:235]
    s_waitcnt vmcnt(16)
    s_barrier
    ds_read_b64_tr_b16 v[40:41], v14 offset:0
    v_mfma_f32_16x16x32_bf16 v[236:239], v[56:59], a[88:91], v[236:239]
    s_add_u32 m0, s69, 65536
    ds_read_b64_tr_b16 v[42:43], v14 offset:1024
    ds_read_b64_tr_b16 v[44:45], v14 offset:8192
    v_mfma_f32_16x16x32_bf16 v[236:239], v[60:63], a[92:95], v[236:239]
    buffer_load_dwordx4 v2, s[12:15], s60 offen lds
    v_mfma_f32_16x16x32_bf16 v[240:243], v[56:59], a[96:99], v[240:243]
    ds_read_b64_tr_b16 v[46:47], v14 offset:9216
    ds_read_b64_tr_b16 v[48:49], v15 offset:0
    v_mfma_f32_16x16x32_bf16 v[240:243], v[60:63], a[100:103], v[240:243]
    ds_read_b64_tr_b16 v[50:51], v15 offset:1024
    ds_read_b64_tr_b16 v[52:53], v15 offset:8192
    v_mfma_f32_16x16x32_bf16 v[244:247], v[56:59], a[104:107], v[244:247]
    ds_read_b64_tr_b16 v[54:55], v15 offset:9216
    v_add_u32 v14, 0xfffe0000, v14
    v_mfma_f32_16x16x32_bf16 v[244:247], v[60:63], a[108:111], v[244:247]
    v_add_u32 v15, 0xfffe0000, v15
    v_mfma_f32_16x16x32_bf16 v[248:251], v[56:59], a[112:115], v[248:251]
    v_mfma_f32_16x16x32_bf16 v[248:251], v[60:63], a[116:119], v[248:251]
    buffer_load_dwordx4 v3, s[12:15], s60 offen offset:1024 lds
    v_mfma_f32_16x16x32_bf16 v[252:255], v[56:59], a[120:123], v[252:255]
    ds_read_b64_tr_b16 v[56:57], v16 offset:0
    ds_read_b64_tr_b16 v[58:59], v16 offset:1024
    v_mfma_f32_16x16x32_bf16 v[252:255], v[60:63], a[124:127], v[252:255]
    s_waitcnt lgkmcnt(2)
    ds_read_b64_tr_b16 v[60:61], v16 offset:8192
    ds_read_b64_tr_b16 v[62:63], v16 offset:9216
    v_mfma_f32_16x16x32_bf16 a[128:131], a[64:67], v[40:43], a[128:131]
    v_add_u32 v16, 0xfffe0000, v16
    v_mfma_f32_16x16x32_bf16 a[128:131], a[68:71], v[44:47], a[128:131]
    v_add_u32 v22, 0x10000, v22
    v_mfma_f32_16x16x32_bf16 a[132:135], a[72:75], v[40:43], a[132:135]
    ds_read_b128 a[32:35], v22 offset:16384
    v_mfma_f32_16x16x32_bf16 a[132:135], a[76:79], v[44:47], a[132:135]
    v_mfma_f32_16x16x32_bf16 a[136:139], a[80:83], v[40:43], a[136:139]
    v_mfma_f32_16x16x32_bf16 a[136:139], a[84:87], v[44:47], a[136:139]
    buffer_load_dwordx4 v4, s[12:15], s60 offen offset:2048 lds
    v_mfma_f32_16x16x32_bf16 a[140:143], a[88:91], v[40:43], a[140:143]
    v_add_u32 v23, 0x10000, v23
    v_mfma_f32_16x16x32_bf16 a[140:143], a[92:95], v[44:47], a[140:143]
    ds_read_b128 a[36:39], v23 offset:16384
    v_mfma_f32_16x16x32_bf16 a[144:147], a[96:99], v[40:43], a[144:147]
    v_mfma_f32_16x16x32_bf16 a[144:147], a[100:103], v[44:47], a[144:147]
    v_mfma_f32_16x16x32_bf16 a[148:151], a[104:107], v[40:43], a[148:151]
    v_mfma_f32_16x16x32_bf16 a[148:151], a[108:111], v[44:47], a[148:151]
    v_mfma_f32_16x16x32_bf16 a[152:155], a[112:115], v[40:43], a[152:155]
    buffer_load_dwordx4 v5, s[12:15], s60 offen offset:3072 lds
    v_mfma_f32_16x16x32_bf16 a[152:155], a[116:119], v[44:47], a[152:155]
    ds_read_b128 a[40:43], v22 offset:18432
    v_mfma_f32_16x16x32_bf16 a[156:159], a[120:123], v[40:43], a[156:159]
    ds_read_b64_tr_b16 v[40:41], v17 offset:0
    ds_read_b64_tr_b16 v[42:43], v17 offset:1024
    v_mfma_f32_16x16x32_bf16 a[156:159], a[124:127], v[44:47], a[156:159]
    ds_read_b64_tr_b16 v[44:45], v17 offset:8192
    ds_read_b64_tr_b16 v[46:47], v17 offset:9216
    v_mfma_f32_16x16x32_bf16 a[160:163], a[64:67], v[48:51], a[160:163]
    v_add_u32 v17, 0xfffe0000, v17
    v_mfma_f32_16x16x32_bf16 a[160:163], a[68:71], v[52:55], a[160:163]
    v_mfma_f32_16x16x32_bf16 a[164:167], a[72:75], v[48:51], a[164:167]
    ds_read_b128 a[44:47], v23 offset:18432
    v_mfma_f32_16x16x32_bf16 a[164:167], a[76:79], v[52:55], a[164:167]
    s_add_u32 m0, s69, 81920
    v_mfma_f32_16x16x32_bf16 a[168:171], a[80:83], v[48:51], a[168:171]
    buffer_load_dwordx4 v6, s[8:11], s61 offen lds
    v_mfma_f32_16x16x32_bf16 a[168:171], a[84:87], v[52:55], a[168:171]
    v_mfma_f32_16x16x32_bf16 a[172:175], a[88:91], v[48:51], a[172:175]
    v_mfma_f32_16x16x32_bf16 a[172:175], a[92:95], v[52:55], a[172:175]
    v_mfma_f32_16x16x32_bf16 a[176:179], a[96:99], v[48:51], a[176:179]
    ds_read_b128 a[48:51], v22 offset:20480
    v_mfma_f32_16x16x32_bf16 a[176:179], a[100:103], v[52:55], a[176:179]
    v_mfma_f32_16x16x32_bf16 a[180:183], a[104:107], v[48:51], a[180:183]
    v_mfma_f32_16x16x32_bf16 a[180:183], a[108:111], v[52:55], a[180:183]
    buffer_load_dwordx4 v7, s[8:11], s61 offen offset:1024 lds
    v_mfma_f32_16x16x32_bf16 a[184:187], a[112:115], v[48:51], a[184:187]
    v_mfma_f32_16x16x32_bf16 a[184:187], a[116:119], v[52:55], a[184:187]
    ds_read_b128 a[52:55], v23 offset:20480
    v_mfma_f32_16x16x32_bf16 a[188:191], a[120:123], v[48:51], a[188:191]
    v_mfma_f32_16x16x32_bf16 a[188:191], a[124:127], v[52:55], a[188:191]
    s_waitcnt lgkmcnt(1)
    v_mfma_f32_16x16x32_bf16 a[192:195], a[64:67], v[56:59], a[192:195]
    v_mfma_f32_16x16x32_bf16 a[192:195], a[68:71], v[60:63], a[192:195]
    v_mfma_f32_16x16x32_bf16 a[196:199], a[72:75], v[56:59], a[196:199]
    v_mfma_f32_16x16x32_bf16 a[196:199], a[76:79], v[60:63], a[196:199]
    buffer_load_dwordx4 v8, s[8:11], s61 offen offset:2048 lds
    v_mfma_f32_16x16x32_bf16 a[200:203], a[80:83], v[56:59], a[200:203]
    ds_read_b128 a[56:59], v22 offset:22528
    v_mfma_f32_16x16x32_bf16 a[200:203], a[84:87], v[60:63], a[200:203]
    v_mfma_f32_16x16x32_bf16 a[204:207], a[88:91], v[56:59], a[204:207]
    v_mfma_f32_16x16x32_bf16 a[204:207], a[92:95], v[60:63], a[204:207]
    v_mfma_f32_16x16x32_bf16 a[208:211], a[96:99], v[56:59], a[208:211]
    ds_read_b128 a[60:63], v23 offset:22528
    v_mfma_f32_16x16x32_bf16 a[208:211], a[100:103], v[60:63], a[208:211]
    v_mfma_f32_16x16x32_bf16 a[212:215], a[104:107], v[56:59], a[212:215]
    buffer_load_dwordx4 v9, s[8:11], s61 offen offset:3072 lds
    v_mfma_f32_16x16x32_bf16 a[212:215], a[108:111], v[60:63], a[212:215]
    v_mfma_f32_16x16x32_bf16 a[216:219], a[112:115], v[56:59], a[216:219]
    v_mfma_f32_16x16x32_bf16 a[216:219], a[116:119], v[60:63], a[216:219]
    v_mfma_f32_16x16x32_bf16 a[220:223], a[120:123], v[56:59], a[220:223]
    v_mfma_f32_16x16x32_bf16 a[220:223], a[124:127], v[60:63], a[220:223]
    v_mfma_f32_16x16x32_bf16 a[224:227], a[64:67], v[40:43], a[224:227]
    v_mfma_f32_16x16x32_bf16 a[224:227], a[68:71], v[44:47], a[224:227]
    s_add_u32 s61, s61, 128
    v_mfma_f32_16x16x32_bf16 a[228:231], a[72:75], v[40:43], a[228:231]
    v_mfma_f32_16x16x32_bf16 a[228:231], a[76:79], v[44:47], a[228:231]
    v_mfma_f32_16x16x32_bf16 a[232:235], a[80:83], v[40:43], a[232:235]
    v_mfma_f32_16x16x32_bf16 a[232:235], a[84:87], v[44:47], a[232:235]
    s_waitcnt vmcnt(16)
    s_barrier
    ds_read_b64_tr_b16 v[48:49], v14 offset:0
    v_mfma_f32_16x16x32_bf16 a[236:239], a[88:91], v[40:43], a[236:239]
    s_add_u32 m0, s69, 98304
    ds_read_b64_tr_b16 v[50:51], v14 offset:1024
    ds_read_b64_tr_b16 v[52:53], v14 offset:8192
    v_mfma_f32_16x16x32_bf16 a[236:239], a[92:95], v[44:47], a[236:239]
    buffer_load_dwordx4 v2, s[16:19], s60 offen lds
    v_mfma_f32_16x16x32_bf16 a[240:243], a[96:99], v[40:43], a[240:243]
    ds_read_b64_tr_b16 v[54:55], v14 offset:9216
    ds_read_b64_tr_b16 v[56:57], v15 offset:0
    v_mfma_f32_16x16x32_bf16 a[240:243], a[100:103], v[44:47], a[240:243]
    ds_read_b64_tr_b16 v[58:59], v15 offset:1024
    ds_read_b64_tr_b16 v[60:61], v15 offset:8192
    v_mfma_f32_16x16x32_bf16 a[244:247], a[104:107], v[40:43], a[244:247]
    ds_read_b64_tr_b16 v[62:63], v15 offset:9216
    v_mfma_f32_16x16x32_bf16 a[244:247], a[108:111], v[44:47], a[244:247]
    v_mfma_f32_16x16x32_bf16 a[248:251], a[112:115], v[40:43], a[248:251]
    v_mfma_f32_16x16x32_bf16 a[248:251], a[116:119], v[44:47], a[248:251]
    buffer_load_dwordx4 v3, s[16:19], s60 offen offset:1024 lds
    v_mfma_f32_16x16x32_bf16 a[252:255], a[120:123], v[40:43], a[252:255]
    ds_read_b64_tr_b16 v[40:41], v16 offset:0
    ds_read_b64_tr_b16 v[42:43], v16 offset:1024
    v_mfma_f32_16x16x32_bf16 a[252:255], a[124:127], v[44:47], a[252:255]
    s_waitcnt lgkmcnt(2)
    ds_read_b64_tr_b16 v[44:45], v16 offset:8192
    ds_read_b64_tr_b16 v[46:47], v16 offset:9216
    v_mfma_f32_16x16x32_bf16 v[128:131], v[48:51], a[0:3], v[128:131]
    v_mfma_f32_16x16x32_bf16 v[128:131], v[52:55], a[4:7], v[128:131]
    v_add_u32 v22, 0xfffe0000, v22
    v_mfma_f32_16x16x32_bf16 v[132:135], v[48:51], a[8:11], v[132:135]
    ds_read_b128 a[64:67], v22 offset:16384
    v_mfma_f32_16x16x32_bf16 v[132:135], v[52:55], a[12:15], v[132:135]
    v_mfma_f32_16x16x32_bf16 v[136:139], v[48:51], a[16:19], v[136:139]
    v_mfma_f32_16x16x32_bf16 v[136:139], v[52:55], a[20:23], v[136:139]
    buffer_load_dwordx4 v4, s[16:19], s60 offen offset:2048 lds
    v_mfma_f32_16x16x32_bf16 v[140:143], v[48:51], a[24:27], v[140:143]
    v_add_u32 v23, 0xfffe0000, v23
    v_mfma_f32_16x16x32_bf16 v[140:143], v[52:55], a[28:31], v[140:143]
    ds_read_b128 a[68:71], v23 offset:16384
    v_mfma_f32_16x16x32_bf16 v[144:147], v[48:51], a[32:35], v[144:147]
    v_mfma_f32_16x16x32_bf16 v[144:147], v[52:55], a[36:39], v[144:147]
    v_mfma_f32_16x16x32_bf16 v[148:151], v[48:51], a[40:43], v[148:151]
    v_mfma_f32_16x16x32_bf16 v[148:151], v[52:55], a[44:47], v[148:151]
    v_mfma_f32_16x16x32_bf16 v[152:155], v[48:51], a[48:51], v[152:155]
    buffer_load_dwordx4 v5, s[16:19], s60 offen offset:3072 lds
    v_mfma_f32_16x16x32_bf16 v[152:155], v[52:55], a[52:55], v[152:155]
    ds_read_b128 a[72:75], v22 offset:18432
    v_mfma_f32_16x16x32_bf16 v[156:159], v[48:51], a[56:59], v[156:159]
    ds_read_b64_tr_b16 v[48:49], v17 offset:0
    ds_read_b64_tr_b16 v[50:51], v17 offset:1024
    v_mfma_f32_16x16x32_bf16 v[156:159], v[52:55], a[60:63], v[156:159]
    ds_read_b64_tr_b16 v[52:53], v17 offset:8192
    ds_read_b64_tr_b16 v[54:55], v17 offset:9216
    v_mfma_f32_16x16x32_bf16 v[160:163], v[56:59], a[0:3], v[160:163]
    v_mfma_f32_16x16x32_bf16 v[160:163], v[60:63], a[4:7], v[160:163]
    v_mfma_f32_16x16x32_bf16 v[164:167], v[56:59], a[8:11], v[164:167]
    ds_read_b128 a[76:79], v23 offset:18432
    v_mfma_f32_16x16x32_bf16 v[164:167], v[60:63], a[12:15], v[164:167]
    s_add_u32 m0, s69, 114688
    v_mfma_f32_16x16x32_bf16 v[168:171], v[56:59], a[16:19], v[168:171]
    s_add_u32 s60, s60, 524288
    buffer_load_dwordx4 v6, s[8:11], s62 offen lds
    v_mfma_f32_16x16x32_bf16 v[168:171], v[60:63], a[20:23], v[168:171]
    v_mfma_f32_16x16x32_bf16 v[172:175], v[56:59], a[24:27], v[172:175]
    v_mfma_f32_16x16x32_bf16 v[172:175], v[60:63], a[28:31], v[172:175]
    v_mfma_f32_16x16x32_bf16 v[176:179], v[56:59], a[32:35], v[176:179]
    ds_read_b128 a[80:83], v22 offset:20480
    v_mfma_f32_16x16x32_bf16 v[176:179], v[60:63], a[36:39], v[176:179]
    v_mfma_f32_16x16x32_bf16 v[180:183], v[56:59], a[40:43], v[180:183]
    v_mfma_f32_16x16x32_bf16 v[180:183], v[60:63], a[44:47], v[180:183]
    buffer_load_dwordx4 v7, s[8:11], s62 offen offset:1024 lds
    v_mfma_f32_16x16x32_bf16 v[184:187], v[56:59], a[48:51], v[184:187]
    v_mfma_f32_16x16x32_bf16 v[184:187], v[60:63], a[52:55], v[184:187]
    ds_read_b128 a[84:87], v23 offset:20480
    v_mfma_f32_16x16x32_bf16 v[188:191], v[56:59], a[56:59], v[188:191]
    v_mfma_f32_16x16x32_bf16 v[188:191], v[60:63], a[60:63], v[188:191]
    s_waitcnt lgkmcnt(1)
    v_mfma_f32_16x16x32_bf16 v[192:195], v[40:43], a[0:3], v[192:195]
    v_mfma_f32_16x16x32_bf16 v[192:195], v[44:47], a[4:7], v[192:195]
    v_mfma_f32_16x16x32_bf16 v[196:199], v[40:43], a[8:11], v[196:199]
    v_mfma_f32_16x16x32_bf16 v[196:199], v[44:47], a[12:15], v[196:199]
    buffer_load_dwordx4 v8, s[8:11], s62 offen offset:2048 lds
    v_mfma_f32_16x16x32_bf16 v[200:203], v[40:43], a[16:19], v[200:203]
    ds_read_b128 a[88:91], v22 offset:22528
    v_mfma_f32_16x16x32_bf16 v[200:203], v[44:47], a[20:23], v[200:203]
    v_mfma_f32_16x16x32_bf16 v[204:207], v[40:43], a[24:27], v[204:207]
    v_mfma_f32_16x16x32_bf16 v[204:207], v[44:47], a[28:31], v[204:207]
    v_mfma_f32_16x16x32_bf16 v[208:211], v[40:43], a[32:35], v[208:211]
    ds_read_b128 a[92:95], v23 offset:22528
    v_mfma_f32_16x16x32_bf16 v[208:211], v[44:47], a[36:39], v[208:211]
    v_mfma_f32_16x16x32_bf16 v[212:215], v[40:43], a[40:43], v[212:215]
    buffer_load_dwordx4 v9, s[8:11], s62 offen offset:3072 lds
    v_mfma_f32_16x16x32_bf16 v[212:215], v[44:47], a[44:47], v[212:215]
    v_mfma_f32_16x16x32_bf16 v[216:219], v[40:43], a[48:51], v[216:219]
    v_mfma_f32_16x16x32_bf16 v[216:219], v[44:47], a[52:55], v[216:219]
    v_mfma_f32_16x16x32_bf16 v[220:223], v[40:43], a[56:59], v[220:223]
    v_mfma_f32_16x16x32_bf16 v[220:223], v[44:47], a[60:63], v[220:223]
    v_mfma_f32_16x16x32_bf16 v[224:227], v[48:51], a[0:3], v[224:227]
    v_mfma_f32_16x16x32_bf16 v[224:227], v[52:55], a[4:7], v[224:227]
    s_add_u32 s62, s62, 128
    v_mfma_f32_16x16x32_bf16 v[228:231], v[48:51], a[8:11], v[228:231]
    v_mfma_f32_16x16x32_bf16 v[228:231], v[52:55], a[12:15], v[228:231]
    v_mfma_f32_16x16x32_bf16 v[232:235], v[48:51], a[16:19], v[232:235]
    v_mfma_f32_16x16x32_bf16 v[232:235], v[52:55], a[20:23], v[232:235]
    s_waitcnt vmcnt(16)
    s_barrier
    ds_read_b64_tr_b16 v[56:57], v14 offset:32768
    v_mfma_f32_16x16x32_bf16 v[236:239], v[48:51], a[24:27], v[236:239]
    s_add_u32 m0, s69, 131072
    ds_read_b64_tr_b16 v[58:59], v14 offset:33792
    ds_read_b64_tr_b16 v[60:61], v14 offset:40960
    v_mfma_f32_16x16x32_bf16 v[236:239], v[52:55], a[28:31], v[236:239]
    buffer_load_dwordx4 v2, s[12:15], s60 offen lds
    v_mfma_f32_16x16x32_bf16 v[240:243], v[48:51], a[32:35], v[240:243]
    ds_read_b64_tr_b16 v[62:63], v14 offset:41984
    ds_read_b64_tr_b16 v[40:41], v15 offset:32768
    v_mfma_f32_16x16x32_bf16 v[240:243], v[52:55], a[36:39], v[240:243]
    ds_read_b64_tr_b16 v[42:43], v15 offset:33792
    ds_read_b64_tr_b16 v[44:45], v15 offset:40960
    v_mfma_f32_16x16x32_bf16 v[244:247], v[48:51], a[40:43], v[244:247]
    ds_read_b64_tr_b16 v[46:47], v15 offset:41984
    v_add_u32 v14, 0x10000, v14
    v_mfma_f32_16x16x32_bf16 v[244:247], v[52:55], a[44:47], v[244:247]
    v_add_u32 v15, 0x10000, v15
    v_mfma_f32_16x16x32_bf16 v[248:251], v[48:51], a[48:51], v[248:251]
    v_mfma_f32_16x16x32_bf16 v[248:251], v[52:55], a[52:55], v[248:251]
    buffer_load_dwordx4 v3, s[12:15], s60 offen offset:1024 lds
    v_mfma_f32_16x16x32_bf16 v[252:255], v[48:51], a[56:59], v[252:255]
    ds_read_b64_tr_b16 v[48:49], v16 offset:32768
    ds_read_b64_tr_b16 v[50:51], v16 offset:33792
    v_mfma_f32_16x16x32_bf16 v[252:255], v[52:55], a[60:63], v[252:255]
    s_waitcnt lgkmcnt(2)
    ds_read_b64_tr_b16 v[52:53], v16 offset:40960
    ds_read_b64_tr_b16 v[54:55], v16 offset:41984
    v_mfma_f32_16x16x32_bf16 a[128:131], a[0:3], v[56:59], a[128:131]
    v_add_u32 v16, 0x10000, v16
    v_mfma_f32_16x16x32_bf16 a[128:131], a[4:7], v[60:63], a[128:131]
    v_mfma_f32_16x16x32_bf16 a[132:135], a[8:11], v[56:59], a[132:135]
    ds_read_b128 a[96:99], v22 offset:49152
    v_mfma_f32_16x16x32_bf16 a[132:135], a[12:15], v[60:63], a[132:135]
    v_mfma_f32_16x16x32_bf16 a[136:139], a[16:19], v[56:59], a[136:139]
    v_mfma_f32_16x16x32_bf16 a[136:139], a[20:23], v[60:63], a[136:139]
    buffer_load_dwordx4 v4, s[12:15], s60 offen offset:2048 lds
    v_mfma_f32_16x16x32_bf16 a[140:143], a[24:27], v[56:59], a[140:143]
    v_mfma_f32_16x16x32_bf16 a[140:143], a[28:31], v[60:63], a[140:143]
    ds_read_b128 a[100:103], v23 offset:49152
    v_mfma_f32_16x16x32_bf16 a[144:147], a[32:35], v[56:59], a[144:147]
    v_mfma_f32_16x16x32_bf16 a[144:147], a[36:39], v[60:63], a[144:147]
    v_mfma_f32_16x16x32_bf16 a[148:151], a[40:43], v[56:59], a[148:151]
    v_mfma_f32_16x16x32_bf16 a[148:151], a[44:47], v[60:63], a[148:151]
    v_mfma_f32_16x16x32_bf16 a[152:155], a[48:51], v[56:59], a[152:155]
    buffer_load_dwordx4 v5, s[12:15], s60 offen offset:3072 lds
    v_mfma_f32_16x16x32_bf16 a[152:155], a[52:55], v[60:63], a[152:155]
    ds_read_b128 a[104:107], v22 offset:51200
    v_mfma_f32_16x16x32_bf16 a[156:159], a[56:59], v[56:59], a[156:159]
    ds_read_b64_tr_b16 v[56:57], v17 offset:32768
    ds_read_b64_tr_b16 v[58:59], v17 offset:33792
    v_mfma_f32_16x16x32_bf16 a[156:159], a[60:63], v[60:63], a[156:159]
    ds_read_b64_tr_b16 v[60:61], v17 offset:40960
    ds_read_b64_tr_b16 v[62:63], v17 offset:41984
    v_mfma_f32_16x16x32_bf16 a[160:163], a[0:3], v[40:43], a[160:163]
    v_add_u32 v17, 0x10000, v17
    v_mfma_f32_16x16x32_bf16 a[160:163], a[4:7], v[44:47], a[160:163]
    v_mfma_f32_16x16x32_bf16 a[164:167], a[8:11], v[40:43], a[164:167]
    ds_read_b128 a[108:111], v23 offset:51200
    v_mfma_f32_16x16x32_bf16 a[164:167], a[12:15], v[44:47], a[164:167]
    s_add_u32 m0, s69, 147456
    v_mfma_f32_16x16x32_bf16 a[168:171], a[16:19], v[40:43], a[168:171]
    buffer_load_dwordx4 v6, s[8:11], s61 offen lds
    v_mfma_f32_16x16x32_bf16 a[168:171], a[20:23], v[44:47], a[168:171]
    v_mfma_f32_16x16x32_bf16 a[172:175], a[24:27], v[40:43], a[172:175]
    v_mfma_f32_16x16x32_bf16 a[172:175], a[28:31], v[44:47], a[172:175]
    v_mfma_f32_16x16x32_bf16 a[176:179], a[32:35], v[40:43], a[176:179]
    ds_read_b128 a[112:115], v22 offset:53248
    v_mfma_f32_16x16x32_bf16 a[176:179], a[36:39], v[44:47], a[176:179]
    v_mfma_f32_16x16x32_bf16 a[180:183], a[40:43], v[40:43], a[180:183]
    v_mfma_f32_16x16x32_bf16 a[180:183], a[44:47], v[44:47], a[180:183]
    buffer_load_dwordx4 v7, s[8:11], s61 offen offset:1024 lds
    v_mfma_f32_16x16x32_bf16 a[184:187], a[48:51], v[40:43], a[184:187]
    v_mfma_f32_16x16x32_bf16 a[184:187], a[52:55], v[44:47], a[184:187]
    ds_read_b128 a[116:119], v23 offset:53248
    v_mfma_f32_16x16x32_bf16 a[188:191], a[56:59], v[40:43], a[188:191]
    v_mfma_f32_16x16x32_bf16 a[188:191], a[60:63], v[44:47], a[188:191]
    s_waitcnt lgkmcnt(1)
    v_mfma_f32_16x16x32_bf16 a[192:195], a[0:3], v[48:51], a[192:195]
    v_mfma_f32_16x16x32_bf16 a[192:195], a[4:7], v[52:55], a[192:195]
    v_mfma_f32_16x16x32_bf16 a[196:199], a[8:11], v[48:51], a[196:199]
    v_mfma_f32_16x16x32_bf16 a[196:199], a[12:15], v[52:55], a[196:199]
    buffer_load_dwordx4 v8, s[8:11], s61 offen offset:2048 lds
    v_mfma_f32_16x16x32_bf16 a[200:203], a[16:19], v[48:51], a[200:203]
    ds_read_b128 a[120:123], v22 offset:55296
    v_mfma_f32_16x16x32_bf16 a[200:203], a[20:23], v[52:55], a[200:203]
    v_mfma_f32_16x16x32_bf16 a[204:207], a[24:27], v[48:51], a[204:207]
    v_mfma_f32_16x16x32_bf16 a[204:207], a[28:31], v[52:55], a[204:207]
    v_mfma_f32_16x16x32_bf16 a[208:211], a[32:35], v[48:51], a[208:211]
    ds_read_b128 a[124:127], v23 offset:55296
    v_mfma_f32_16x16x32_bf16 a[208:211], a[36:39], v[52:55], a[208:211]
    v_mfma_f32_16x16x32_bf16 a[212:215], a[40:43], v[48:51], a[212:215]
    buffer_load_dwordx4 v9, s[8:11], s61 offen offset:3072 lds
    v_mfma_f32_16x16x32_bf16 a[212:215], a[44:47], v[52:55], a[212:215]
    v_mfma_f32_16x16x32_bf16 a[216:219], a[48:51], v[48:51], a[216:219]
    v_mfma_f32_16x16x32_bf16 a[216:219], a[52:55], v[52:55], a[216:219]
    v_mfma_f32_16x16x32_bf16 a[220:223], a[56:59], v[48:51], a[220:223]
    v_mfma_f32_16x16x32_bf16 a[220:223], a[60:63], v[52:55], a[220:223]
    v_mfma_f32_16x16x32_bf16 a[224:227], a[0:3], v[56:59], a[224:227]
    v_mfma_f32_16x16x32_bf16 a[224:227], a[4:7], v[60:63], a[224:227]
    s_add_u32 s61, s61, 128
    v_mfma_f32_16x16x32_bf16 a[228:231], a[8:11], v[56:59], a[228:231]
    v_mfma_f32_16x16x32_bf16 a[228:231], a[12:15], v[60:63], a[228:231]
    v_mfma_f32_16x16x32_bf16 a[232:235], a[16:19], v[56:59], a[232:235]
    v_mfma_f32_16x16x32_bf16 a[232:235], a[20:23], v[60:63], a[232:235]
    s_waitcnt vmcnt(16)
    s_barrier
    ds_read_b64_tr_b16 v[40:41], v14 offset:0
    v_mfma_f32_16x16x32_bf16 a[236:239], a[24:27], v[56:59], a[236:239]
    s_add_u32 m0, s69, 0
    ds_read_b64_tr_b16 v[42:43], v14 offset:1024
    ds_read_b64_tr_b16 v[44:45], v14 offset:8192
    v_mfma_f32_16x16x32_bf16 a[236:239], a[28:31], v[60:63], a[236:239]
    buffer_load_dwordx4 v2, s[16:19], s60 offen lds
    v_mfma_f32_16x16x32_bf16 a[240:243], a[32:35], v[56:59], a[240:243]
    ds_read_b64_tr_b16 v[46:47], v14 offset:9216
    ds_read_b64_tr_b16 v[48:49], v15 offset:0
    v_mfma_f32_16x16x32_bf16 a[240:243], a[36:39], v[60:63], a[240:243]
    ds_read_b64_tr_b16 v[50:51], v15 offset:1024
    ds_read_b64_tr_b16 v[52:53], v15 offset:8192
    v_mfma_f32_16x16x32_bf16 a[244:247], a[40:43], v[56:59], a[244:247]
    ds_read_b64_tr_b16 v[54:55], v15 offset:9216
    v_mfma_f32_16x16x32_bf16 a[244:247], a[44:47], v[60:63], a[244:247]
    v_mfma_f32_16x16x32_bf16 a[248:251], a[48:51], v[56:59], a[248:251]
    v_mfma_f32_16x16x32_bf16 a[248:251], a[52:55], v[60:63], a[248:251]
    buffer_load_dwordx4 v3, s[16:19], s60 offen offset:1024 lds
    v_mfma_f32_16x16x32_bf16 a[252:255], a[56:59], v[56:59], a[252:255]
    ds_read_b64_tr_b16 v[56:57], v16 offset:0
    ds_read_b64_tr_b16 v[58:59], v16 offset:1024
    v_mfma_f32_16x16x32_bf16 a[252:255], a[60:63], v[60:63], a[252:255]
    s_waitcnt lgkmcnt(2)
    ds_read_b64_tr_b16 v[60:61], v16 offset:8192
    ds_read_b64_tr_b16 v[62:63], v16 offset:9216
    v_mfma_f32_16x16x32_bf16 v[128:131], v[40:43], a[64:67], v[128:131]
    v_mfma_f32_16x16x32_bf16 v[128:131], v[44:47], a[68:71], v[128:131]
    v_add_u32 v22, 0x10000, v22
    v_mfma_f32_16x16x32_bf16 v[132:135], v[40:43], a[72:75], v[132:135]
    ds_read_b128 a[0:3], v22 offset:16384
    v_mfma_f32_16x16x32_bf16 v[132:135], v[44:47], a[76:79], v[132:135]
    v_mfma_f32_16x16x32_bf16 v[136:139], v[40:43], a[80:83], v[136:139]
    v_mfma_f32_16x16x32_bf16 v[136:139], v[44:47], a[84:87], v[136:139]
    buffer_load_dwordx4 v4, s[16:19], s60 offen offset:2048 lds
    v_mfma_f32_16x16x32_bf16 v[140:143], v[40:43], a[88:91], v[140:143]
    v_add_u32 v23, 0x10000, v23
    v_mfma_f32_16x16x32_bf16 v[140:143], v[44:47], a[92:95], v[140:143]
    ds_read_b128 a[4:7], v23 offset:16384
    v_mfma_f32_16x16x32_bf16 v[144:147], v[40:43], a[96:99], v[144:147]
    v_mfma_f32_16x16x32_bf16 v[144:147], v[44:47], a[100:103], v[144:147]
    v_mfma_f32_16x16x32_bf16 v[148:151], v[40:43], a[104:107], v[148:151]
    v_mfma_f32_16x16x32_bf16 v[148:151], v[44:47], a[108:111], v[148:151]
    v_mfma_f32_16x16x32_bf16 v[152:155], v[40:43], a[112:115], v[152:155]
    buffer_load_dwordx4 v5, s[16:19], s60 offen offset:3072 lds
    v_mfma_f32_16x16x32_bf16 v[152:155], v[44:47], a[116:119], v[152:155]
    ds_read_b128 a[8:11], v22 offset:18432
    v_mfma_f32_16x16x32_bf16 v[156:159], v[40:43], a[120:123], v[156:159]
    ds_read_b64_tr_b16 v[40:41], v17 offset:0
    ds_read_b64_tr_b16 v[42:43], v17 offset:1024
    v_mfma_f32_16x16x32_bf16 v[156:159], v[44:47], a[124:127], v[156:159]
    ds_read_b64_tr_b16 v[44:45], v17 offset:8192
    ds_read_b64_tr_b16 v[46:47], v17 offset:9216
    v_mfma_f32_16x16x32_bf16 v[160:163], v[48:51], a[64:67], v[160:163]
    v_mfma_f32_16x16x32_bf16 v[160:163], v[52:55], a[68:71], v[160:163]
    v_mfma_f32_16x16x32_bf16 v[164:167], v[48:51], a[72:75], v[164:167]
    ds_read_b128 a[12:15], v23 offset:18432
    v_mfma_f32_16x16x32_bf16 v[164:167], v[52:55], a[76:79], v[164:167]
    s_add_u32 m0, s69, 16384
    v_mfma_f32_16x16x32_bf16 v[168:171], v[48:51], a[80:83], v[168:171]
    s_add_u32 s60, s60, 524288
    buffer_load_dwordx4 v6, s[8:11], s62 offen lds
    v_mfma_f32_16x16x32_bf16 v[168:171], v[52:55], a[84:87], v[168:171]
    v_mfma_f32_16x16x32_bf16 v[172:175], v[48:51], a[88:91], v[172:175]
    v_mfma_f32_16x16x32_bf16 v[172:175], v[52:55], a[92:95], v[172:175]
    v_mfma_f32_16x16x32_bf16 v[176:179], v[48:51], a[96:99], v[176:179]
    ds_read_b128 a[16:19], v22 offset:20480
    v_mfma_f32_16x16x32_bf16 v[176:179], v[52:55], a[100:103], v[176:179]
    v_mfma_f32_16x16x32_bf16 v[180:183], v[48:51], a[104:107], v[180:183]
    v_mfma_f32_16x16x32_bf16 v[180:183], v[52:55], a[108:111], v[180:183]
    buffer_load_dwordx4 v7, s[8:11], s62 offen offset:1024 lds
    v_mfma_f32_16x16x32_bf16 v[184:187], v[48:51], a[112:115], v[184:187]
    v_mfma_f32_16x16x32_bf16 v[184:187], v[52:55], a[116:119], v[184:187]
    ds_read_b128 a[20:23], v23 offset:20480
    v_mfma_f32_16x16x32_bf16 v[188:191], v[48:51], a[120:123], v[188:191]
    v_mfma_f32_16x16x32_bf16 v[188:191], v[52:55], a[124:127], v[188:191]
    s_waitcnt lgkmcnt(1)
    v_mfma_f32_16x16x32_bf16 v[192:195], v[56:59], a[64:67], v[192:195]
    v_mfma_f32_16x16x32_bf16 v[192:195], v[60:63], a[68:71], v[192:195]
    v_mfma_f32_16x16x32_bf16 v[196:199], v[56:59], a[72:75], v[196:199]
    v_mfma_f32_16x16x32_bf16 v[196:199], v[60:63], a[76:79], v[196:199]
    buffer_load_dwordx4 v8, s[8:11], s62 offen offset:2048 lds
    v_mfma_f32_16x16x32_bf16 v[200:203], v[56:59], a[80:83], v[200:203]
    ds_read_b128 a[24:27], v22 offset:22528
    v_mfma_f32_16x16x32_bf16 v[200:203], v[60:63], a[84:87], v[200:203]
    v_mfma_f32_16x16x32_bf16 v[204:207], v[56:59], a[88:91], v[204:207]
    v_mfma_f32_16x16x32_bf16 v[204:207], v[60:63], a[92:95], v[204:207]
    v_mfma_f32_16x16x32_bf16 v[208:211], v[56:59], a[96:99], v[208:211]
    ds_read_b128 a[28:31], v23 offset:22528
    v_mfma_f32_16x16x32_bf16 v[208:211], v[60:63], a[100:103], v[208:211]
    v_mfma_f32_16x16x32_bf16 v[212:215], v[56:59], a[104:107], v[212:215]
    buffer_load_dwordx4 v9, s[8:11], s62 offen offset:3072 lds
    v_mfma_f32_16x16x32_bf16 v[212:215], v[60:63], a[108:111], v[212:215]
    v_mfma_f32_16x16x32_bf16 v[216:219], v[56:59], a[112:115], v[216:219]
    v_mfma_f32_16x16x32_bf16 v[216:219], v[60:63], a[116:119], v[216:219]
    v_mfma_f32_16x16x32_bf16 v[220:223], v[56:59], a[120:123], v[220:223]
    v_mfma_f32_16x16x32_bf16 v[220:223], v[60:63], a[124:127], v[220:223]
    v_mfma_f32_16x16x32_bf16 v[224:227], v[40:43], a[64:67], v[224:227]
    v_mfma_f32_16x16x32_bf16 v[224:227], v[44:47], a[68:71], v[224:227]
    s_add_u32 s62, s62, 128
    v_mfma_f32_16x16x32_bf16 v[228:231], v[40:43], a[72:75], v[228:231]
    v_mfma_f32_16x16x32_bf16 v[228:231], v[44:47], a[76:79], v[228:231]
    v_mfma_f32_16x16x32_bf16 v[232:235], v[40:43], a[80:83], v[232:235]
    v_mfma_f32_16x16x32_bf16 v[232:235], v[44:47], a[84:87], v[232:235]
    s_waitcnt vmcnt(16)
    s_barrier
    ds_read_b64_tr_b16 v[48:49], v14 offset:32768
    v_mfma_f32_16x16x32_bf16 v[236:239], v[40:43], a[88:91], v[236:239]
    s_add_u32 m0, s69, 32768
    ds_read_b64_tr_b16 v[50:51], v14 offset:33792
    ds_read_b64_tr_b16 v[52:53], v14 offset:40960
    v_mfma_f32_16x16x32_bf16 v[236:239], v[44:47], a[92:95], v[236:239]
    buffer_load_dwordx4 v2, s[12:15], s60 offen lds
    v_mfma_f32_16x16x32_bf16 v[240:243], v[40:43], a[96:99], v[240:243]
    ds_read_b64_tr_b16 v[54:55], v14 offset:41984
    ds_read_b64_tr_b16 v[56:57], v15 offset:32768
    v_mfma_f32_16x16x32_bf16 v[240:243], v[44:47], a[100:103], v[240:243]
    ds_read_b64_tr_b16 v[58:59], v15 offset:33792
    ds_read_b64_tr_b16 v[60:61], v15 offset:40960
    v_mfma_f32_16x16x32_bf16 v[244:247], v[40:43], a[104:107], v[244:247]
    ds_read_b64_tr_b16 v[62:63], v15 offset:41984
    v_add_u32 v14, 0x10000, v14
    v_mfma_f32_16x16x32_bf16 v[244:247], v[44:47], a[108:111], v[244:247]
    v_add_u32 v15, 0x10000, v15
    v_mfma_f32_16x16x32_bf16 v[248:251], v[40:43], a[112:115], v[248:251]
    v_mfma_f32_16x16x32_bf16 v[248:251], v[44:47], a[116:119], v[248:251]
    buffer_load_dwordx4 v3, s[12:15], s60 offen offset:1024 lds
    v_mfma_f32_16x16x32_bf16 v[252:255], v[40:43], a[120:123], v[252:255]
    ds_read_b64_tr_b16 v[40:41], v16 offset:32768
    ds_read_b64_tr_b16 v[42:43], v16 offset:33792
    v_mfma_f32_16x16x32_bf16 v[252:255], v[44:47], a[124:127], v[252:255]
    s_waitcnt lgkmcnt(2)
    ds_read_b64_tr_b16 v[44:45], v16 offset:40960
    ds_read_b64_tr_b16 v[46:47], v16 offset:41984
    v_mfma_f32_16x16x32_bf16 a[128:131], a[64:67], v[48:51], a[128:131]
    v_add_u32 v16, 0x10000, v16
    v_mfma_f32_16x16x32_bf16 a[128:131], a[68:71], v[52:55], a[128:131]
    v_mfma_f32_16x16x32_bf16 a[132:135], a[72:75], v[48:51], a[132:135]
    ds_read_b128 a[32:35], v22 offset:49152
    v_mfma_f32_16x16x32_bf16 a[132:135], a[76:79], v[52:55], a[132:135]
    v_mfma_f32_16x16x32_bf16 a[136:139], a[80:83], v[48:51], a[136:139]
    v_mfma_f32_16x16x32_bf16 a[136:139], a[84:87], v[52:55], a[136:139]
    buffer_load_dwordx4 v4, s[12:15], s60 offen offset:2048 lds
    v_mfma_f32_16x16x32_bf16 a[140:143], a[88:91], v[48:51], a[140:143]
    v_mfma_f32_16x16x32_bf16 a[140:143], a[92:95], v[52:55], a[140:143]
    ds_read_b128 a[36:39], v23 offset:49152
    v_mfma_f32_16x16x32_bf16 a[144:147], a[96:99], v[48:51], a[144:147]
    v_mfma_f32_16x16x32_bf16 a[144:147], a[100:103], v[52:55], a[144:147]
    v_mfma_f32_16x16x32_bf16 a[148:151], a[104:107], v[48:51], a[148:151]
    v_mfma_f32_16x16x32_bf16 a[148:151], a[108:111], v[52:55], a[148:151]
    v_mfma_f32_16x16x32_bf16 a[152:155], a[112:115], v[48:51], a[152:155]
    buffer_load_dwordx4 v5, s[12:15], s60 offen offset:3072 lds
    v_mfma_f32_16x16x32_bf16 a[152:155], a[116:119], v[52:55], a[152:155]
    ds_read_b128 a[40:43], v22 offset:51200
    v_mfma_f32_16x16x32_bf16 a[156:159], a[120:123], v[48:51], a[156:159]
    ds_read_b64_tr_b16 v[48:49], v17 offset:32768
    ds_read_b64_tr_b16 v[50:51], v17 offset:33792
    v_mfma_f32_16x16x32_bf16 a[156:159], a[124:127], v[52:55], a[156:159]
    ds_read_b64_tr_b16 v[52:53], v17 offset:40960
    ds_read_b64_tr_b16 v[54:55], v17 offset:41984
    v_mfma_f32_16x16x32_bf16 a[160:163], a[64:67], v[56:59], a[160:163]
    v_add_u32 v17, 0x10000, v17
    v_mfma_f32_16x16x32_bf16 a[160:163], a[68:71], v[60:63], a[160:163]
    v_mfma_f32_16x16x32_bf16 a[164:167], a[72:75], v[56:59], a[164:167]
    ds_read_b128 a[44:47], v23 offset:51200
    v_mfma_f32_16x16x32_bf16 a[164:167], a[76:79], v[60:63], a[164:167]
    s_add_u32 m0, s69, 49152
    v_mfma_f32_16x16x32_bf16 a[168:171], a[80:83], v[56:59], a[168:171]
    buffer_load_dwordx4 v6, s[8:11], s61 offen lds
    v_mfma_f32_16x16x32_bf16 a[168:171], a[84:87], v[60:63], a[168:171]
    v_mfma_f32_16x16x32_bf16 a[172:175], a[88:91], v[56:59], a[172:175]
    v_mfma_f32_16x16x32_bf16 a[172:175], a[92:95], v[60:63], a[172:175]
    v_mfma_f32_16x16x32_bf16 a[176:179], a[96:99], v[56:59], a[176:179]
    ds_read_b128 a[48:51], v22 offset:53248
    v_mfma_f32_16x16x32_bf16 a[176:179], a[100:103], v[60:63], a[176:179]
    v_mfma_f32_16x16x32_bf16 a[180:183], a[104:107], v[56:59], a[180:183]
    v_mfma_f32_16x16x32_bf16 a[180:183], a[108:111], v[60:63], a[180:183]
    buffer_load_dwordx4 v7, s[8:11], s61 offen offset:1024 lds
    v_mfma_f32_16x16x32_bf16 a[184:187], a[112:115], v[56:59], a[184:187]
    v_mfma_f32_16x16x32_bf16 a[184:187], a[116:119], v[60:63], a[184:187]
    ds_read_b128 a[52:55], v23 offset:53248
    v_mfma_f32_16x16x32_bf16 a[188:191], a[120:123], v[56:59], a[188:191]
    v_mfma_f32_16x16x32_bf16 a[188:191], a[124:127], v[60:63], a[188:191]
    s_waitcnt lgkmcnt(1)
    v_mfma_f32_16x16x32_bf16 a[192:195], a[64:67], v[40:43], a[192:195]
    v_mfma_f32_16x16x32_bf16 a[192:195], a[68:71], v[44:47], a[192:195]
    v_mfma_f32_16x16x32_bf16 a[196:199], a[72:75], v[40:43], a[196:199]
    v_mfma_f32_16x16x32_bf16 a[196:199], a[76:79], v[44:47], a[196:199]
    buffer_load_dwordx4 v8, s[8:11], s61 offen offset:2048 lds
    v_mfma_f32_16x16x32_bf16 a[200:203], a[80:83], v[40:43], a[200:203]
    ds_read_b128 a[56:59], v22 offset:55296
    v_mfma_f32_16x16x32_bf16 a[200:203], a[84:87], v[44:47], a[200:203]
    v_mfma_f32_16x16x32_bf16 a[204:207], a[88:91], v[40:43], a[204:207]
    v_mfma_f32_16x16x32_bf16 a[204:207], a[92:95], v[44:47], a[204:207]
    v_mfma_f32_16x16x32_bf16 a[208:211], a[96:99], v[40:43], a[208:211]
    ds_read_b128 a[60:63], v23 offset:55296
    v_mfma_f32_16x16x32_bf16 a[208:211], a[100:103], v[44:47], a[208:211]
    v_mfma_f32_16x16x32_bf16 a[212:215], a[104:107], v[40:43], a[212:215]
    buffer_load_dwordx4 v9, s[8:11], s61 offen offset:3072 lds
    v_mfma_f32_16x16x32_bf16 a[212:215], a[108:111], v[44:47], a[212:215]
    v_mfma_f32_16x16x32_bf16 a[216:219], a[112:115], v[40:43], a[216:219]
    v_mfma_f32_16x16x32_bf16 a[216:219], a[116:119], v[44:47], a[216:219]
    v_mfma_f32_16x16x32_bf16 a[220:223], a[120:123], v[40:43], a[220:223]
    v_mfma_f32_16x16x32_bf16 a[220:223], a[124:127], v[44:47], a[220:223]
    v_mfma_f32_16x16x32_bf16 a[224:227], a[64:67], v[48:51], a[224:227]
    v_mfma_f32_16x16x32_bf16 a[224:227], a[68:71], v[52:55], a[224:227]
    s_add_u32 s61, s61, 128
    v_mfma_f32_16x16x32_bf16 a[228:231], a[72:75], v[48:51], a[228:231]
    v_mfma_f32_16x16x32_bf16 a[228:231], a[76:79], v[52:55], a[228:231]
    v_mfma_f32_16x16x32_bf16 a[232:235], a[80:83], v[48:51], a[232:235]
    v_mfma_f32_16x16x32_bf16 a[232:235], a[84:87], v[52:55], a[232:235]
    s_waitcnt vmcnt(16)
    s_barrier
    ds_read_b64_tr_b16 v[56:57], v14 offset:0
    v_mfma_f32_16x16x32_bf16 a[236:239], a[88:91], v[48:51], a[236:239]
    s_add_u32 m0, s69, 65536
    ds_read_b64_tr_b16 v[58:59], v14 offset:1024
    ds_read_b64_tr_b16 v[60:61], v14 offset:8192
    v_mfma_f32_16x16x32_bf16 a[236:239], a[92:95], v[52:55], a[236:239]
    buffer_load_dwordx4 v2, s[16:19], s60 offen lds
    v_mfma_f32_16x16x32_bf16 a[240:243], a[96:99], v[48:51], a[240:243]
    ds_read_b64_tr_b16 v[62:63], v14 offset:9216
    ds_read_b64_tr_b16 v[40:41], v15 offset:0
    v_mfma_f32_16x16x32_bf16 a[240:243], a[100:103], v[52:55], a[240:243]
    ds_read_b64_tr_b16 v[42:43], v15 offset:1024
    ds_read_b64_tr_b16 v[44:45], v15 offset:8192
    v_mfma_f32_16x16x32_bf16 a[244:247], a[104:107], v[48:51], a[244:247]
    ds_read_b64_tr_b16 v[46:47], v15 offset:9216
    v_add_u32 v14, 0xfffe0000, v14
    v_mfma_f32_16x16x32_bf16 a[244:247], a[108:111], v[52:55], a[244:247]
    v_add_u32 v15, 0xfffe0000, v15
    v_mfma_f32_16x16x32_bf16 a[248:251], a[112:115], v[48:51], a[248:251]
    v_mfma_f32_16x16x32_bf16 a[248:251], a[116:119], v[52:55], a[248:251]
    buffer_load_dwordx4 v3, s[16:19], s60 offen offset:1024 lds
    v_mfma_f32_16x16x32_bf16 a[252:255], a[120:123], v[48:51], a[252:255]
    ds_read_b64_tr_b16 v[48:49], v16 offset:0
    ds_read_b64_tr_b16 v[50:51], v16 offset:1024
    v_mfma_f32_16x16x32_bf16 a[252:255], a[124:127], v[52:55], a[252:255]
    s_waitcnt lgkmcnt(2)
    ds_read_b64_tr_b16 v[52:53], v16 offset:8192
    ds_read_b64_tr_b16 v[54:55], v16 offset:9216
    v_mfma_f32_16x16x32_bf16 v[128:131], v[56:59], a[0:3], v[128:131]
    v_add_u32 v16, 0xfffe0000, v16
    v_mfma_f32_16x16x32_bf16 v[128:131], v[60:63], a[4:7], v[128:131]
    v_add_u32 v22, 0x10000, v22
    v_mfma_f32_16x16x32_bf16 v[132:135], v[56:59], a[8:11], v[132:135]
    ds_read_b128 a[64:67], v22 offset:16384
    v_mfma_f32_16x16x32_bf16 v[132:135], v[60:63], a[12:15], v[132:135]
    v_mfma_f32_16x16x32_bf16 v[136:139], v[56:59], a[16:19], v[136:139]
    v_mfma_f32_16x16x32_bf16 v[136:139], v[60:63], a[20:23], v[136:139]
    buffer_load_dwordx4 v4, s[16:19], s60 offen offset:2048 lds
    v_mfma_f32_16x16x32_bf16 v[140:143], v[56:59], a[24:27], v[140:143]
    v_add_u32 v23, 0x10000, v23
    v_mfma_f32_16x16x32_bf16 v[140:143], v[60:63], a[28:31], v[140:143]
    ds_read_b128 a[68:71], v23 offset:16384
    v_mfma_f32_16x16x32_bf16 v[144:147], v[56:59], a[32:35], v[144:147]
    v_mfma_f32_16x16x32_bf16 v[144:147], v[60:63], a[36:39], v[144:147]
    v_mfma_f32_16x16x32_bf16 v[148:151], v[56:59], a[40:43], v[148:151]
    v_mfma_f32_16x16x32_bf16 v[148:151], v[60:63], a[44:47], v[148:151]
    v_mfma_f32_16x16x32_bf16 v[152:155], v[56:59], a[48:51], v[152:155]
    buffer_load_dwordx4 v5, s[16:19], s60 offen offset:3072 lds
    v_mfma_f32_16x16x32_bf16 v[152:155], v[60:63], a[52:55], v[152:155]
    ds_read_b128 a[72:75], v22 offset:18432
    v_mfma_f32_16x16x32_bf16 v[156:159], v[56:59], a[56:59], v[156:159]
    ds_read_b64_tr_b16 v[56:57], v17 offset:0
    ds_read_b64_tr_b16 v[58:59], v17 offset:1024
    v_mfma_f32_16x16x32_bf16 v[156:159], v[60:63], a[60:63], v[156:159]
    ds_read_b64_tr_b16 v[60:61], v17 offset:8192
    ds_read_b64_tr_b16 v[62:63], v17 offset:9216
    v_mfma_f32_16x16x32_bf16 v[160:163], v[40:43], a[0:3], v[160:163]
    v_add_u32 v17, 0xfffe0000, v17
    v_mfma_f32_16x16x32_bf16 v[160:163], v[44:47], a[4:7], v[160:163]
    v_mfma_f32_16x16x32_bf16 v[164:167], v[40:43], a[8:11], v[164:167]
    ds_read_b128 a[76:79], v23 offset:18432
    v_mfma_f32_16x16x32_bf16 v[164:167], v[44:47], a[12:15], v[164:167]
    s_add_u32 m0, s69, 81920
    v_mfma_f32_16x16x32_bf16 v[168:171], v[40:43], a[16:19], v[168:171]
    s_add_u32 s60, s60, 524288
    buffer_load_dwordx4 v6, s[8:11], s62 offen lds
    v_mfma_f32_16x16x32_bf16 v[168:171], v[44:47], a[20:23], v[168:171]
    v_mfma_f32_16x16x32_bf16 v[172:175], v[40:43], a[24:27], v[172:175]
    v_mfma_f32_16x16x32_bf16 v[172:175], v[44:47], a[28:31], v[172:175]
    v_mfma_f32_16x16x32_bf16 v[176:179], v[40:43], a[32:35], v[176:179]
    ds_read_b128 a[80:83], v22 offset:20480
    v_mfma_f32_16x16x32_bf16 v[176:179], v[44:47], a[36:39], v[176:179]
    v_mfma_f32_16x16x32_bf16 v[180:183], v[40:43], a[40:43], v[180:183]
    v_mfma_f32_16x16x32_bf16 v[180:183], v[44:47], a[44:47], v[180:183]
    buffer_load_dwordx4 v7, s[8:11], s62 offen offset:1024 lds
    v_mfma_f32_16x16x32_bf16 v[184:187], v[40:43], a[48:51], v[184:187]
    v_mfma_f32_16x16x32_bf16 v[184:187], v[44:47], a[52:55], v[184:187]
    ds_read_b128 a[84:87], v23 offset:20480
    v_mfma_f32_16x16x32_bf16 v[188:191], v[40:43], a[56:59], v[188:191]
    v_mfma_f32_16x16x32_bf16 v[188:191], v[44:47], a[60:63], v[188:191]
    s_waitcnt lgkmcnt(1)
    v_mfma_f32_16x16x32_bf16 v[192:195], v[48:51], a[0:3], v[192:195]
    v_mfma_f32_16x16x32_bf16 v[192:195], v[52:55], a[4:7], v[192:195]
    v_mfma_f32_16x16x32_bf16 v[196:199], v[48:51], a[8:11], v[196:199]
    v_mfma_f32_16x16x32_bf16 v[196:199], v[52:55], a[12:15], v[196:199]
    buffer_load_dwordx4 v8, s[8:11], s62 offen offset:2048 lds
    v_mfma_f32_16x16x32_bf16 v[200:203], v[48:51], a[16:19], v[200:203]
    ds_read_b128 a[88:91], v22 offset:22528
    v_mfma_f32_16x16x32_bf16 v[200:203], v[52:55], a[20:23], v[200:203]
    v_mfma_f32_16x16x32_bf16 v[204:207], v[48:51], a[24:27], v[204:207]
    v_mfma_f32_16x16x32_bf16 v[204:207], v[52:55], a[28:31], v[204:207]
    v_mfma_f32_16x16x32_bf16 v[208:211], v[48:51], a[32:35], v[208:211]
    ds_read_b128 a[92:95], v23 offset:22528
    v_mfma_f32_16x16x32_bf16 v[208:211], v[52:55], a[36:39], v[208:211]
    v_mfma_f32_16x16x32_bf16 v[212:215], v[48:51], a[40:43], v[212:215]
    buffer_load_dwordx4 v9, s[8:11], s62 offen offset:3072 lds
    v_mfma_f32_16x16x32_bf16 v[212:215], v[52:55], a[44:47], v[212:215]
    v_mfma_f32_16x16x32_bf16 v[216:219], v[48:51], a[48:51], v[216:219]
    v_mfma_f32_16x16x32_bf16 v[216:219], v[52:55], a[52:55], v[216:219]
    v_mfma_f32_16x16x32_bf16 v[220:223], v[48:51], a[56:59], v[220:223]
    v_mfma_f32_16x16x32_bf16 v[220:223], v[52:55], a[60:63], v[220:223]
    v_mfma_f32_16x16x32_bf16 v[224:227], v[56:59], a[0:3], v[224:227]
    v_mfma_f32_16x16x32_bf16 v[224:227], v[60:63], a[4:7], v[224:227]
    s_add_u32 s62, s62, 128
    v_mfma_f32_16x16x32_bf16 v[228:231], v[56:59], a[8:11], v[228:231]
    v_mfma_f32_16x16x32_bf16 v[228:231], v[60:63], a[12:15], v[228:231]
    v_mfma_f32_16x16x32_bf16 v[232:235], v[56:59], a[16:19], v[232:235]
    v_mfma_f32_16x16x32_bf16 v[232:235], v[60:63], a[20:23], v[232:235]
    s_waitcnt vmcnt(16)
    s_barrier
    ds_read_b64_tr_b16 v[40:41], v14 offset:0
    v_mfma_f32_16x16x32_bf16 v[236:239], v[56:59], a[24:27], v[236:239]
    s_add_u32 m0, s69, 98304
    ds_read_b64_tr_b16 v[42:43], v14 offset:1024
    ds_read_b64_tr_b16 v[44:45], v14 offset:8192
    v_mfma_f32_16x16x32_bf16 v[236:239], v[60:63], a[28:31], v[236:239]
    buffer_load_dwordx4 v2, s[12:15], s60 offen lds
    v_mfma_f32_16x16x32_bf16 v[240:243], v[56:59], a[32:35], v[240:243]
    ds_read_b64_tr_b16 v[46:47], v14 offset:9216
    ds_read_b64_tr_b16 v[48:49], v15 offset:0
    v_mfma_f32_16x16x32_bf16 v[240:243], v[60:63], a[36:39], v[240:243]
    ds_read_b64_tr_b16 v[50:51], v15 offset:1024
    ds_read_b64_tr_b16 v[52:53], v15 offset:8192
    v_mfma_f32_16x16x32_bf16 v[244:247], v[56:59], a[40:43], v[244:247]
    ds_read_b64_tr_b16 v[54:55], v15 offset:9216
    v_mfma_f32_16x16x32_bf16 v[244:247], v[60:63], a[44:47], v[244:247]
    v_mfma_f32_16x16x32_bf16 v[248:251], v[56:59], a[48:51], v[248:251]
    v_mfma_f32_16x16x32_bf16 v[248:251], v[60:63], a[52:55], v[248:251]
    buffer_load_dwordx4 v3, s[12:15], s60 offen offset:1024 lds
    v_mfma_f32_16x16x32_bf16 v[252:255], v[56:59], a[56:59], v[252:255]
    ds_read_b64_tr_b16 v[56:57], v16 offset:0
    ds_read_b64_tr_b16 v[58:59], v16 offset:1024
    v_mfma_f32_16x16x32_bf16 v[252:255], v[60:63], a[60:63], v[252:255]
    s_waitcnt lgkmcnt(2)
    ds_read_b64_tr_b16 v[60:61], v16 offset:8192
    ds_read_b64_tr_b16 v[62:63], v16 offset:9216
    v_mfma_f32_16x16x32_bf16 a[128:131], a[0:3], v[40:43], a[128:131]
    v_mfma_f32_16x16x32_bf16 a[128:131], a[4:7], v[44:47], a[128:131]
    v_add_u32 v22, 0xfffe0000, v22
    v_mfma_f32_16x16x32_bf16 a[132:135], a[8:11], v[40:43], a[132:135]
    ds_read_b128 a[96:99], v22 offset:16384
    v_mfma_f32_16x16x32_bf16 a[132:135], a[12:15], v[44:47], a[132:135]
    v_mfma_f32_16x16x32_bf16 a[136:139], a[16:19], v[40:43], a[136:139]
    v_mfma_f32_16x16x32_bf16 a[136:139], a[20:23], v[44:47], a[136:139]
    buffer_load_dwordx4 v4, s[12:15], s60 offen offset:2048 lds
    v_mfma_f32_16x16x32_bf16 a[140:143], a[24:27], v[40:43], a[140:143]
    v_add_u32 v23, 0xfffe0000, v23
    v_mfma_f32_16x16x32_bf16 a[140:143], a[28:31], v[44:47], a[140:143]
    ds_read_b128 a[100:103], v23 offset:16384
    v_mfma_f32_16x16x32_bf16 a[144:147], a[32:35], v[40:43], a[144:147]
    v_mfma_f32_16x16x32_bf16 a[144:147], a[36:39], v[44:47], a[144:147]
    v_mfma_f32_16x16x32_bf16 a[148:151], a[40:43], v[40:43], a[148:151]
    v_mfma_f32_16x16x32_bf16 a[148:151], a[44:47], v[44:47], a[148:151]
    v_mfma_f32_16x16x32_bf16 a[152:155], a[48:51], v[40:43], a[152:155]
    buffer_load_dwordx4 v5, s[12:15], s60 offen offset:3072 lds
    v_mfma_f32_16x16x32_bf16 a[152:155], a[52:55], v[44:47], a[152:155]
    ds_read_b128 a[104:107], v22 offset:18432
    v_mfma_f32_16x16x32_bf16 a[156:159], a[56:59], v[40:43], a[156:159]
    ds_read_b64_tr_b16 v[40:41], v17 offset:0
    ds_read_b64_tr_b16 v[42:43], v17 offset:1024
    v_mfma_f32_16x16x32_bf16 a[156:159], a[60:63], v[44:47], a[156:159]
    ds_read_b64_tr_b16 v[44:45], v17 offset:8192
    ds_read_b64_tr_b16 v[46:47], v17 offset:9216
    v_mfma_f32_16x16x32_bf16 a[160:163], a[0:3], v[48:51], a[160:163]
    v_mfma_f32_16x16x32_bf16 a[160:163], a[4:7], v[52:55], a[160:163]
    v_mfma_f32_16x16x32_bf16 a[164:167], a[8:11], v[48:51], a[164:167]
    ds_read_b128 a[108:111], v23 offset:18432
    v_mfma_f32_16x16x32_bf16 a[164:167], a[12:15], v[52:55], a[164:167]
    s_add_u32 m0, s69, 114688
    v_mfma_f32_16x16x32_bf16 a[168:171], a[16:19], v[48:51], a[168:171]
    buffer_load_dwordx4 v6, s[8:11], s61 offen lds
    v_mfma_f32_16x16x32_bf16 a[168:171], a[20:23], v[52:55], a[168:171]
    v_mfma_f32_16x16x32_bf16 a[172:175], a[24:27], v[48:51], a[172:175]
    v_mfma_f32_16x16x32_bf16 a[172:175], a[28:31], v[52:55], a[172:175]
    v_mfma_f32_16x16x32_bf16 a[176:179], a[32:35], v[48:51], a[176:179]
    ds_read_b128 a[112:115], v22 offset:20480
    v_mfma_f32_16x16x32_bf16 a[176:179], a[36:39], v[52:55], a[176:179]
    v_mfma_f32_16x16x32_bf16 a[180:183], a[40:43], v[48:51], a[180:183]
    v_mfma_f32_16x16x32_bf16 a[180:183], a[44:47], v[52:55], a[180:183]
    buffer_load_dwordx4 v7, s[8:11], s61 offen offset:1024 lds
    v_mfma_f32_16x16x32_bf16 a[184:187], a[48:51], v[48:51], a[184:187]
    v_mfma_f32_16x16x32_bf16 a[184:187], a[52:55], v[52:55], a[184:187]
    ds_read_b128 a[116:119], v23 offset:20480
    v_mfma_f32_16x16x32_bf16 a[188:191], a[56:59], v[48:51], a[188:191]
    v_mfma_f32_16x16x32_bf16 a[188:191], a[60:63], v[52:55], a[188:191]
    s_waitcnt lgkmcnt(1)
    v_mfma_f32_16x16x32_bf16 a[192:195], a[0:3], v[56:59], a[192:195]
    v_mfma_f32_16x16x32_bf16 a[192:195], a[4:7], v[60:63], a[192:195]
    v_mfma_f32_16x16x32_bf16 a[196:199], a[8:11], v[56:59], a[196:199]
    v_mfma_f32_16x16x32_bf16 a[196:199], a[12:15], v[60:63], a[196:199]
    buffer_load_dwordx4 v8, s[8:11], s61 offen offset:2048 lds
    v_mfma_f32_16x16x32_bf16 a[200:203], a[16:19], v[56:59], a[200:203]
    ds_read_b128 a[120:123], v22 offset:22528
    v_mfma_f32_16x16x32_bf16 a[200:203], a[20:23], v[60:63], a[200:203]
    v_mfma_f32_16x16x32_bf16 a[204:207], a[24:27], v[56:59], a[204:207]
    v_mfma_f32_16x16x32_bf16 a[204:207], a[28:31], v[60:63], a[204:207]
    v_mfma_f32_16x16x32_bf16 a[208:211], a[32:35], v[56:59], a[208:211]
    ds_read_b128 a[124:127], v23 offset:22528
    v_mfma_f32_16x16x32_bf16 a[208:211], a[36:39], v[60:63], a[208:211]
    v_mfma_f32_16x16x32_bf16 a[212:215], a[40:43], v[56:59], a[212:215]
    buffer_load_dwordx4 v9, s[8:11], s61 offen offset:3072 lds
    v_mfma_f32_16x16x32_bf16 a[212:215], a[44:47], v[60:63], a[212:215]
    v_mfma_f32_16x16x32_bf16 a[216:219], a[48:51], v[56:59], a[216:219]
    v_mfma_f32_16x16x32_bf16 a[216:219], a[52:55], v[60:63], a[216:219]
    v_mfma_f32_16x16x32_bf16 a[220:223], a[56:59], v[56:59], a[220:223]
    v_mfma_f32_16x16x32_bf16 a[220:223], a[60:63], v[60:63], a[220:223]
    v_mfma_f32_16x16x32_bf16 a[224:227], a[0:3], v[40:43], a[224:227]
    v_mfma_f32_16x16x32_bf16 a[224:227], a[4:7], v[44:47], a[224:227]
    s_add_u32 s61, s61, 128
    v_mfma_f32_16x16x32_bf16 a[228:231], a[8:11], v[40:43], a[228:231]
    v_mfma_f32_16x16x32_bf16 a[228:231], a[12:15], v[44:47], a[228:231]
    v_mfma_f32_16x16x32_bf16 a[232:235], a[16:19], v[40:43], a[232:235]
    v_mfma_f32_16x16x32_bf16 a[232:235], a[20:23], v[44:47], a[232:235]
    s_waitcnt vmcnt(16)
    s_barrier
    ds_read_b64_tr_b16 v[48:49], v14 offset:32768
    v_mfma_f32_16x16x32_bf16 a[236:239], a[24:27], v[40:43], a[236:239]
    s_add_u32 m0, s69, 131072
    ds_read_b64_tr_b16 v[50:51], v14 offset:33792
    ds_read_b64_tr_b16 v[52:53], v14 offset:40960
    v_mfma_f32_16x16x32_bf16 a[236:239], a[28:31], v[44:47], a[236:239]
    buffer_load_dwordx4 v2, s[16:19], s60 offen lds
    v_mfma_f32_16x16x32_bf16 a[240:243], a[32:35], v[40:43], a[240:243]
    ds_read_b64_tr_b16 v[54:55], v14 offset:41984
    ds_read_b64_tr_b16 v[56:57], v15 offset:32768
    v_mfma_f32_16x16x32_bf16 a[240:243], a[36:39], v[44:47], a[240:243]
    ds_read_b64_tr_b16 v[58:59], v15 offset:33792
    ds_read_b64_tr_b16 v[60:61], v15 offset:40960
    v_mfma_f32_16x16x32_bf16 a[244:247], a[40:43], v[40:43], a[244:247]
    ds_read_b64_tr_b16 v[62:63], v15 offset:41984
    v_add_u32 v14, 0x10000, v14
    v_mfma_f32_16x16x32_bf16 a[244:247], a[44:47], v[44:47], a[244:247]
    v_add_u32 v15, 0x10000, v15
    v_mfma_f32_16x16x32_bf16 a[248:251], a[48:51], v[40:43], a[248:251]
    v_mfma_f32_16x16x32_bf16 a[248:251], a[52:55], v[44:47], a[248:251]
    buffer_load_dwordx4 v3, s[16:19], s60 offen offset:1024 lds
    v_mfma_f32_16x16x32_bf16 a[252:255], a[56:59], v[40:43], a[252:255]
    ds_read_b64_tr_b16 v[40:41], v16 offset:32768
    ds_read_b64_tr_b16 v[42:43], v16 offset:33792
    v_mfma_f32_16x16x32_bf16 a[252:255], a[60:63], v[44:47], a[252:255]
    s_waitcnt lgkmcnt(2)
    ds_read_b64_tr_b16 v[44:45], v16 offset:40960
    ds_read_b64_tr_b16 v[46:47], v16 offset:41984
    v_mfma_f32_16x16x32_bf16 v[128:131], v[48:51], a[64:67], v[128:131]
    v_add_u32 v16, 0x10000, v16
    v_mfma_f32_16x16x32_bf16 v[128:131], v[52:55], a[68:71], v[128:131]
    v_mfma_f32_16x16x32_bf16 v[132:135], v[48:51], a[72:75], v[132:135]
    ds_read_b128 a[0:3], v22 offset:49152
    v_mfma_f32_16x16x32_bf16 v[132:135], v[52:55], a[76:79], v[132:135]
    v_mfma_f32_16x16x32_bf16 v[136:139], v[48:51], a[80:83], v[136:139]
    v_mfma_f32_16x16x32_bf16 v[136:139], v[52:55], a[84:87], v[136:139]
    buffer_load_dwordx4 v4, s[16:19], s60 offen offset:2048 lds
    v_mfma_f32_16x16x32_bf16 v[140:143], v[48:51], a[88:91], v[140:143]
    v_mfma_f32_16x16x32_bf16 v[140:143], v[52:55], a[92:95], v[140:143]
    ds_read_b128 a[4:7], v23 offset:49152
    v_mfma_f32_16x16x32_bf16 v[144:147], v[48:51], a[96:99], v[144:147]
    v_mfma_f32_16x16x32_bf16 v[144:147], v[52:55], a[100:103], v[144:147]
    v_mfma_f32_16x16x32_bf16 v[148:151], v[48:51], a[104:107], v[148:151]
    v_mfma_f32_16x16x32_bf16 v[148:151], v[52:55], a[108:111], v[148:151]
    v_mfma_f32_16x16x32_bf16 v[152:155], v[48:51], a[112:115], v[152:155]
    buffer_load_dwordx4 v5, s[16:19], s60 offen offset:3072 lds
    v_mfma_f32_16x16x32_bf16 v[152:155], v[52:55], a[116:119], v[152:155]
    ds_read_b128 a[8:11], v22 offset:51200
    v_mfma_f32_16x16x32_bf16 v[156:159], v[48:51], a[120:123], v[156:159]
    ds_read_b64_tr_b16 v[48:49], v17 offset:32768
    ds_read_b64_tr_b16 v[50:51], v17 offset:33792
    v_mfma_f32_16x16x32_bf16 v[156:159], v[52:55], a[124:127], v[156:159]
    ds_read_b64_tr_b16 v[52:53], v17 offset:40960
    ds_read_b64_tr_b16 v[54:55], v17 offset:41984
    v_mfma_f32_16x16x32_bf16 v[160:163], v[56:59], a[64:67], v[160:163]
    v_add_u32 v17, 0x10000, v17
    v_mfma_f32_16x16x32_bf16 v[160:163], v[60:63], a[68:71], v[160:163]
    v_mfma_f32_16x16x32_bf16 v[164:167], v[56:59], a[72:75], v[164:167]
    ds_read_b128 a[12:15], v23 offset:51200
    v_mfma_f32_16x16x32_bf16 v[164:167], v[60:63], a[76:79], v[164:167]
    s_add_u32 m0, s69, 147456
    v_mfma_f32_16x16x32_bf16 v[168:171], v[56:59], a[80:83], v[168:171]
    s_add_u32 s60, s60, 524288
    buffer_load_dwordx4 v6, s[8:11], s62 offen lds
    v_mfma_f32_16x16x32_bf16 v[168:171], v[60:63], a[84:87], v[168:171]
    v_mov_b32 v6, v96
    v_mfma_f32_16x16x32_bf16 v[172:175], v[56:59], a[88:91], v[172:175]
    v_mfma_f32_16x16x32_bf16 v[172:175], v[60:63], a[92:95], v[172:175]
    v_mfma_f32_16x16x32_bf16 v[176:179], v[56:59], a[96:99], v[176:179]
    ds_read_b128 a[16:19], v22 offset:53248
    v_mfma_f32_16x16x32_bf16 v[176:179], v[60:63], a[100:103], v[176:179]
    v_mfma_f32_16x16x32_bf16 v[180:183], v[56:59], a[104:107], v[180:183]
    v_mfma_f32_16x16x32_bf16 v[180:183], v[60:63], a[108:111], v[180:183]
    buffer_load_dwordx4 v7, s[8:11], s62 offen offset:1024 lds
    v_mfma_f32_16x16x32_bf16 v[184:187], v[56:59], a[112:115], v[184:187]
    v_mov_b32 v7, v97
    v_mfma_f32_16x16x32_bf16 v[184:187], v[60:63], a[116:119], v[184:187]
    ds_read_b128 a[20:23], v23 offset:53248
    v_mfma_f32_16x16x32_bf16 v[188:191], v[56:59], a[120:123], v[188:191]
    v_mfma_f32_16x16x32_bf16 v[188:191], v[60:63], a[124:127], v[188:191]
    s_waitcnt lgkmcnt(1)
    v_mfma_f32_16x16x32_bf16 v[192:195], v[40:43], a[64:67], v[192:195]
    v_mfma_f32_16x16x32_bf16 v[192:195], v[44:47], a[68:71], v[192:195]
    v_mfma_f32_16x16x32_bf16 v[196:199], v[40:43], a[72:75], v[196:199]
    v_mfma_f32_16x16x32_bf16 v[196:199], v[44:47], a[76:79], v[196:199]
    buffer_load_dwordx4 v8, s[8:11], s62 offen offset:2048 lds
    v_mfma_f32_16x16x32_bf16 v[200:203], v[40:43], a[80:83], v[200:203]
    ds_read_b128 a[24:27], v22 offset:55296
    v_mov_b32 v8, v98
    v_mfma_f32_16x16x32_bf16 v[200:203], v[44:47], a[84:87], v[200:203]
    v_mfma_f32_16x16x32_bf16 v[204:207], v[40:43], a[88:91], v[204:207]
    v_mfma_f32_16x16x32_bf16 v[204:207], v[44:47], a[92:95], v[204:207]
    v_mfma_f32_16x16x32_bf16 v[208:211], v[40:43], a[96:99], v[208:211]
    ds_read_b128 a[28:31], v23 offset:55296
    v_mfma_f32_16x16x32_bf16 v[208:211], v[44:47], a[100:103], v[208:211]
    v_mfma_f32_16x16x32_bf16 v[212:215], v[40:43], a[104:107], v[212:215]
    buffer_load_dwordx4 v9, s[8:11], s62 offen offset:3072 lds
    v_mfma_f32_16x16x32_bf16 v[212:215], v[44:47], a[108:111], v[212:215]
    v_mov_b32 v9, v99
    v_mfma_f32_16x16x32_bf16 v[216:219], v[40:43], a[112:115], v[216:219]
    v_mfma_f32_16x16x32_bf16 v[216:219], v[44:47], a[116:119], v[216:219]
    v_mfma_f32_16x16x32_bf16 v[220:223], v[40:43], a[120:123], v[220:223]
    v_mfma_f32_16x16x32_bf16 v[220:223], v[44:47], a[124:127], v[220:223]
    v_mfma_f32_16x16x32_bf16 v[224:227], v[48:51], a[64:67], v[224:227]
    v_mfma_f32_16x16x32_bf16 v[224:227], v[52:55], a[68:71], v[224:227]
    s_add_u32 s62, s62, 128
    v_mfma_f32_16x16x32_bf16 v[228:231], v[48:51], a[72:75], v[228:231]
    v_mfma_f32_16x16x32_bf16 v[228:231], v[52:55], a[76:79], v[228:231]
    v_mfma_f32_16x16x32_bf16 v[232:235], v[48:51], a[80:83], v[232:235]
    v_mfma_f32_16x16x32_bf16 v[232:235], v[52:55], a[84:87], v[232:235]
    s_waitcnt vmcnt(16)
    s_barrier
    ds_read_b64_tr_b16 v[56:57], v14 offset:0
    v_mfma_f32_16x16x32_bf16 v[236:239], v[48:51], a[88:91], v[236:239]
    s_add_u32 m0, s69, 0
    ds_read_b64_tr_b16 v[58:59], v14 offset:1024
    ds_read_b64_tr_b16 v[60:61], v14 offset:8192
    v_mfma_f32_16x16x32_bf16 v[236:239], v[52:55], a[92:95], v[236:239]
    buffer_load_dwordx4 v2, s[12:15], s60 offen lds
    v_mfma_f32_16x16x32_bf16 v[240:243], v[48:51], a[96:99], v[240:243]
    ds_read_b64_tr_b16 v[62:63], v14 offset:9216
    ds_read_b64_tr_b16 v[40:41], v15 offset:0
    v_mfma_f32_16x16x32_bf16 v[240:243], v[52:55], a[100:103], v[240:243]
    ds_read_b64_tr_b16 v[42:43], v15 offset:1024
    ds_read_b64_tr_b16 v[44:45], v15 offset:8192
    v_mfma_f32_16x16x32_bf16 v[244:247], v[48:51], a[104:107], v[244:247]
    ds_read_b64_tr_b16 v[46:47], v15 offset:9216
    v_mfma_f32_16x16x32_bf16 v[244:247], v[52:55], a[108:111], v[244:247]
    v_mfma_f32_16x16x32_bf16 v[248:251], v[48:51], a[112:115], v[248:251]
    v_mfma_f32_16x16x32_bf16 v[248:251], v[52:55], a[116:119], v[248:251]
    buffer_load_dwordx4 v3, s[12:15], s60 offen offset:1024 lds
    v_mfma_f32_16x16x32_bf16 v[252:255], v[48:51], a[120:123], v[252:255]
    ds_read_b64_tr_b16 v[48:49], v16 offset:0
    ds_read_b64_tr_b16 v[50:51], v16 offset:1024
    v_mfma_f32_16x16x32_bf16 v[252:255], v[52:55], a[124:127], v[252:255]
    s_waitcnt lgkmcnt(2)
    ds_read_b64_tr_b16 v[52:53], v16 offset:8192
    ds_read_b64_tr_b16 v[54:55], v16 offset:9216
    v_mfma_f32_16x16x32_bf16 a[128:131], a[64:67], v[56:59], a[128:131]
    v_mfma_f32_16x16x32_bf16 a[128:131], a[68:71], v[60:63], a[128:131]
    v_add_u32 v22, 0x10000, v22
    v_mfma_f32_16x16x32_bf16 a[132:135], a[72:75], v[56:59], a[132:135]
    ds_read_b128 a[32:35], v22 offset:16384
    v_mfma_f32_16x16x32_bf16 a[132:135], a[76:79], v[60:63], a[132:135]
    v_mfma_f32_16x16x32_bf16 a[136:139], a[80:83], v[56:59], a[136:139]
    v_mfma_f32_16x16x32_bf16 a[136:139], a[84:87], v[60:63], a[136:139]
    buffer_load_dwordx4 v4, s[12:15], s60 offen offset:2048 lds
    v_mfma_f32_16x16x32_bf16 a[140:143], a[88:91], v[56:59], a[140:143]
    v_add_u32 v23, 0x10000, v23
    v_mfma_f32_16x16x32_bf16 a[140:143], a[92:95], v[60:63], a[140:143]
    ds_read_b128 a[36:39], v23 offset:16384
    v_mfma_f32_16x16x32_bf16 a[144:147], a[96:99], v[56:59], a[144:147]
    v_mfma_f32_16x16x32_bf16 a[144:147], a[100:103], v[60:63], a[144:147]
    v_mfma_f32_16x16x32_bf16 a[148:151], a[104:107], v[56:59], a[148:151]
    v_mfma_f32_16x16x32_bf16 a[148:151], a[108:111], v[60:63], a[148:151]
    v_mfma_f32_16x16x32_bf16 a[152:155], a[112:115], v[56:59], a[152:155]
    buffer_load_dwordx4 v5, s[12:15], s60 offen offset:3072 lds
    v_mfma_f32_16x16x32_bf16 a[152:155], a[116:119], v[60:63], a[152:155]
    ds_read_b128 a[40:43], v22 offset:18432
    v_mfma_f32_16x16x32_bf16 a[156:159], a[120:123], v[56:59], a[156:159]
    ds_read_b64_tr_b16 v[56:57], v17 offset:0
    ds_read_b64_tr_b16 v[58:59], v17 offset:1024
    v_mfma_f32_16x16x32_bf16 a[156:159], a[124:127], v[60:63], a[156:159]
    ds_read_b64_tr_b16 v[60:61], v17 offset:8192
    ds_read_b64_tr_b16 v[62:63], v17 offset:9216
    v_mfma_f32_16x16x32_bf16 a[160:163], a[64:67], v[40:43], a[160:163]
    v_mfma_f32_16x16x32_bf16 a[160:163], a[68:71], v[44:47], a[160:163]
    v_mfma_f32_16x16x32_bf16 a[164:167], a[72:75], v[40:43], a[164:167]
    ds_read_b128 a[44:47], v23 offset:18432
    v_mfma_f32_16x16x32_bf16 a[164:167], a[76:79], v[44:47], a[164:167]
    s_add_u32 m0, s69, 16384
    v_mfma_f32_16x16x32_bf16 a[168:171], a[80:83], v[40:43], a[168:171]
    buffer_load_dwordx4 v10, s[20:23], s63 offen lds
    v_mfma_f32_16x16x32_bf16 a[168:171], a[84:87], v[44:47], a[168:171]
    v_mfma_f32_16x16x32_bf16 a[172:175], a[88:91], v[40:43], a[172:175]
    v_mfma_f32_16x16x32_bf16 a[172:175], a[92:95], v[44:47], a[172:175]
    v_mfma_f32_16x16x32_bf16 a[176:179], a[96:99], v[40:43], a[176:179]
    ds_read_b128 a[48:51], v22 offset:20480
    v_mfma_f32_16x16x32_bf16 a[176:179], a[100:103], v[44:47], a[176:179]
    v_mfma_f32_16x16x32_bf16 a[180:183], a[104:107], v[40:43], a[180:183]
    v_mfma_f32_16x16x32_bf16 a[180:183], a[108:111], v[44:47], a[180:183]
    buffer_load_dwordx4 v11, s[20:23], s63 offen offset:1024 lds
    v_mfma_f32_16x16x32_bf16 a[184:187], a[112:115], v[40:43], a[184:187]
    v_mfma_f32_16x16x32_bf16 a[184:187], a[116:119], v[44:47], a[184:187]
    ds_read_b128 a[52:55], v23 offset:20480
    v_mfma_f32_16x16x32_bf16 a[188:191], a[120:123], v[40:43], a[188:191]
    v_mfma_f32_16x16x32_bf16 a[188:191], a[124:127], v[44:47], a[188:191]
    s_waitcnt lgkmcnt(1)
    v_mfma_f32_16x16x32_bf16 a[192:195], a[64:67], v[48:51], a[192:195]
    v_mfma_f32_16x16x32_bf16 a[192:195], a[68:71], v[52:55], a[192:195]
    v_mfma_f32_16x16x32_bf16 a[196:199], a[72:75], v[48:51], a[196:199]
    v_mfma_f32_16x16x32_bf16 a[196:199], a[76:79], v[52:55], a[196:199]
    buffer_load_dwordx4 v12, s[20:23], s63 offen offset:2048 lds
    v_mfma_f32_16x16x32_bf16 a[200:203], a[80:83], v[48:51], a[200:203]
    ds_read_b128 a[56:59], v22 offset:22528
    v_mfma_f32_16x16x32_bf16 a[200:203], a[84:87], v[52:55], a[200:203]
    v_mfma_f32_16x16x32_bf16 a[204:207], a[88:91], v[48:51], a[204:207]
    v_mfma_f32_16x16x32_bf16 a[204:207], a[92:95], v[52:55], a[204:207]
    v_mfma_f32_16x16x32_bf16 a[208:211], a[96:99], v[48:51], a[208:211]
    ds_read_b128 a[60:63], v23 offset:22528
    v_mfma_f32_16x16x32_bf16 a[208:211], a[100:103], v[52:55], a[208:211]
    v_mfma_f32_16x16x32_bf16 a[212:215], a[104:107], v[48:51], a[212:215]
    buffer_load_dwordx4 v13, s[20:23], s63 offen offset:3072 lds
    v_mfma_f32_16x16x32_bf16 a[212:215], a[108:111], v[52:55], a[212:215]
    v_mfma_f32_16x16x32_bf16 a[216:219], a[112:115], v[48:51], a[216:219]
    v_mfma_f32_16x16x32_bf16 a[216:219], a[116:119], v[52:55], a[216:219]
    v_mfma_f32_16x16x32_bf16 a[220:223], a[120:123], v[48:51], a[220:223]
    v_mfma_f32_16x16x32_bf16 a[220:223], a[124:127], v[52:55], a[220:223]
    v_mfma_f32_16x16x32_bf16 a[224:227], a[64:67], v[56:59], a[224:227]
    v_mfma_f32_16x16x32_bf16 a[224:227], a[68:71], v[60:63], a[224:227]
    s_add_u32 s63, s63, 128
    v_mfma_f32_16x16x32_bf16 a[228:231], a[72:75], v[56:59], a[228:231]
    v_mfma_f32_16x16x32_bf16 a[228:231], a[76:79], v[60:63], a[228:231]
    v_mfma_f32_16x16x32_bf16 a[232:235], a[80:83], v[56:59], a[232:235]
    v_mfma_f32_16x16x32_bf16 a[232:235], a[84:87], v[60:63], a[232:235]
    s_waitcnt vmcnt(16)
    s_barrier
    ds_read_b64_tr_b16 v[40:41], v14 offset:32768
    v_mfma_f32_16x16x32_bf16 a[236:239], a[88:91], v[56:59], a[236:239]
    s_add_u32 m0, s69, 32768
    ds_read_b64_tr_b16 v[42:43], v14 offset:33792
    ds_read_b64_tr_b16 v[44:45], v14 offset:40960
    v_mfma_f32_16x16x32_bf16 a[236:239], a[92:95], v[60:63], a[236:239]
    buffer_load_dwordx4 v2, s[16:19], s60 offen lds
    v_mfma_f32_16x16x32_bf16 a[240:243], a[96:99], v[56:59], a[240:243]
    ds_read_b64_tr_b16 v[46:47], v14 offset:41984
    ds_read_b64_tr_b16 v[48:49], v15 offset:32768
    v_mfma_f32_16x16x32_bf16 a[240:243], a[100:103], v[60:63], a[240:243]
    ds_read_b64_tr_b16 v[50:51], v15 offset:33792
    ds_read_b64_tr_b16 v[52:53], v15 offset:40960
    v_mfma_f32_16x16x32_bf16 a[244:247], a[104:107], v[56:59], a[244:247]
    ds_read_b64_tr_b16 v[54:55], v15 offset:41984
    v_add_u32 v14, 0x10000, v14
    v_mfma_f32_16x16x32_bf16 a[244:247], a[108:111], v[60:63], a[244:247]
    v_add_u32 v15, 0x10000, v15
    v_mfma_f32_16x16x32_bf16 a[248:251], a[112:115], v[56:59], a[248:251]
    v_mfma_f32_16x16x32_bf16 a[248:251], a[116:119], v[60:63], a[248:251]
    buffer_load_dwordx4 v3, s[16:19], s60 offen offset:1024 lds
    v_mfma_f32_16x16x32_bf16 a[252:255], a[120:123], v[56:59], a[252:255]
    ds_read_b64_tr_b16 v[56:57], v16 offset:32768
    ds_read_b64_tr_b16 v[58:59], v16 offset:33792
    v_mfma_f32_16x16x32_bf16 a[252:255], a[124:127], v[60:63], a[252:255]
    s_waitcnt lgkmcnt(2)
    ds_read_b64_tr_b16 v[60:61], v16 offset:40960
    ds_read_b64_tr_b16 v[62:63], v16 offset:41984
    v_mfma_f32_16x16x32_bf16 v[128:131], v[40:43], a[0:3], v[128:131]
    v_add_u32 v16, 0x10000, v16
    v_mfma_f32_16x16x32_bf16 v[128:131], v[44:47], a[4:7], v[128:131]
    v_mfma_f32_16x16x32_bf16 v[132:135], v[40:43], a[8:11], v[132:135]
    ds_read_b128 a[64:67], v22 offset:49152
    v_mfma_f32_16x16x32_bf16 v[132:135], v[44:47], a[12:15], v[132:135]
    v_mfma_f32_16x16x32_bf16 v[136:139], v[40:43], a[16:19], v[136:139]
    v_mfma_f32_16x16x32_bf16 v[136:139], v[44:47], a[20:23], v[136:139]
    buffer_load_dwordx4 v4, s[16:19], s60 offen offset:2048 lds
    v_mfma_f32_16x16x32_bf16 v[140:143], v[40:43], a[24:27], v[140:143]
    v_mfma_f32_16x16x32_bf16 v[140:143], v[44:47], a[28:31], v[140:143]
    ds_read_b128 a[68:71], v23 offset:49152
    v_mfma_f32_16x16x32_bf16 v[144:147], v[40:43], a[32:35], v[144:147]
    v_mfma_f32_16x16x32_bf16 v[144:147], v[44:47], a[36:39], v[144:147]
    v_mfma_f32_16x16x32_bf16 v[148:151], v[40:43], a[40:43], v[148:151]
    v_mfma_f32_16x16x32_bf16 v[148:151], v[44:47], a[44:47], v[148:151]
    v_mfma_f32_16x16x32_bf16 v[152:155], v[40:43], a[48:51], v[152:155]
    buffer_load_dwordx4 v5, s[16:19], s60 offen offset:3072 lds
    v_mfma_f32_16x16x32_bf16 v[152:155], v[44:47], a[52:55], v[152:155]
    ds_read_b128 a[72:75], v22 offset:51200
    v_mfma_f32_16x16x32_bf16 v[156:159], v[40:43], a[56:59], v[156:159]
    ds_read_b64_tr_b16 v[40:41], v17 offset:32768
    ds_read_b64_tr_b16 v[42:43], v17 offset:33792
    v_mfma_f32_16x16x32_bf16 v[156:159], v[44:47], a[60:63], v[156:159]
    ds_read_b64_tr_b16 v[44:45], v17 offset:40960
    ds_read_b64_tr_b16 v[46:47], v17 offset:41984
    v_mfma_f32_16x16x32_bf16 v[160:163], v[48:51], a[0:3], v[160:163]
    v_add_u32 v17, 0x10000, v17
    v_mfma_f32_16x16x32_bf16 v[160:163], v[52:55], a[4:7], v[160:163]
    v_mfma_f32_16x16x32_bf16 v[164:167], v[48:51], a[8:11], v[164:167]
    ds_read_b128 a[76:79], v23 offset:51200
    v_mfma_f32_16x16x32_bf16 v[164:167], v[52:55], a[12:15], v[164:167]
    s_add_u32 m0, s69, 49152
    v_mfma_f32_16x16x32_bf16 v[168:171], v[48:51], a[16:19], v[168:171]
    s_add_u32 s60, s60, 524288
    buffer_load_dwordx4 v10, s[20:23], s64 offen lds
    v_mfma_f32_16x16x32_bf16 v[168:171], v[52:55], a[20:23], v[168:171]
    v_mfma_f32_16x16x32_bf16 v[172:175], v[48:51], a[24:27], v[172:175]
    v_mfma_f32_16x16x32_bf16 v[172:175], v[52:55], a[28:31], v[172:175]
    v_mfma_f32_16x16x32_bf16 v[176:179], v[48:51], a[32:35], v[176:179]
    ds_read_b128 a[80:83], v22 offset:53248
    v_mfma_f32_16x16x32_bf16 v[176:179], v[52:55], a[36:39], v[176:179]
    v_mfma_f32_16x16x32_bf16 v[180:183], v[48:51], a[40:43], v[180:183]
    v_mfma_f32_16x16x32_bf16 v[180:183], v[52:55], a[44:47], v[180:183]
    buffer_load_dwordx4 v11, s[20:23], s64 offen offset:1024 lds
    v_mfma_f32_16x16x32_bf16 v[184:187], v[48:51], a[48:51], v[184:187]
    v_mfma_f32_16x16x32_bf16 v[184:187], v[52:55], a[52:55], v[184:187]
    ds_read_b128 a[84:87], v23 offset:53248
    v_mfma_f32_16x16x32_bf16 v[188:191], v[48:51], a[56:59], v[188:191]
    v_mfma_f32_16x16x32_bf16 v[188:191], v[52:55], a[60:63], v[188:191]
    s_waitcnt lgkmcnt(1)
    v_mfma_f32_16x16x32_bf16 v[192:195], v[56:59], a[0:3], v[192:195]
    v_mfma_f32_16x16x32_bf16 v[192:195], v[60:63], a[4:7], v[192:195]
    v_mfma_f32_16x16x32_bf16 v[196:199], v[56:59], a[8:11], v[196:199]
    v_mfma_f32_16x16x32_bf16 v[196:199], v[60:63], a[12:15], v[196:199]
    buffer_load_dwordx4 v12, s[20:23], s64 offen offset:2048 lds
    v_mfma_f32_16x16x32_bf16 v[200:203], v[56:59], a[16:19], v[200:203]
    ds_read_b128 a[88:91], v22 offset:55296
    v_mfma_f32_16x16x32_bf16 v[200:203], v[60:63], a[20:23], v[200:203]
    v_mfma_f32_16x16x32_bf16 v[204:207], v[56:59], a[24:27], v[204:207]
    v_mfma_f32_16x16x32_bf16 v[204:207], v[60:63], a[28:31], v[204:207]
    v_mfma_f32_16x16x32_bf16 v[208:211], v[56:59], a[32:35], v[208:211]
    ds_read_b128 a[92:95], v23 offset:55296
    v_mfma_f32_16x16x32_bf16 v[208:211], v[60:63], a[36:39], v[208:211]
    v_mfma_f32_16x16x32_bf16 v[212:215], v[56:59], a[40:43], v[212:215]
    buffer_load_dwordx4 v13, s[20:23], s64 offen offset:3072 lds
    v_mfma_f32_16x16x32_bf16 v[212:215], v[60:63], a[44:47], v[212:215]
    v_mfma_f32_16x16x32_bf16 v[216:219], v[56:59], a[48:51], v[216:219]
    v_mfma_f32_16x16x32_bf16 v[216:219], v[60:63], a[52:55], v[216:219]
    v_mfma_f32_16x16x32_bf16 v[220:223], v[56:59], a[56:59], v[220:223]
    v_mfma_f32_16x16x32_bf16 v[220:223], v[60:63], a[60:63], v[220:223]
    v_mfma_f32_16x16x32_bf16 v[224:227], v[40:43], a[0:3], v[224:227]
    v_mfma_f32_16x16x32_bf16 v[224:227], v[44:47], a[4:7], v[224:227]
    s_add_u32 s64, s64, 128
    v_mfma_f32_16x16x32_bf16 v[228:231], v[40:43], a[8:11], v[228:231]
    v_mfma_f32_16x16x32_bf16 v[228:231], v[44:47], a[12:15], v[228:231]
    v_mfma_f32_16x16x32_bf16 v[232:235], v[40:43], a[16:19], v[232:235]
    v_mfma_f32_16x16x32_bf16 v[232:235], v[44:47], a[20:23], v[232:235]
    s_waitcnt vmcnt(16)
    s_barrier
    ds_read_b64_tr_b16 v[48:49], v14 offset:0
    v_mfma_f32_16x16x32_bf16 v[236:239], v[40:43], a[24:27], v[236:239]
    s_add_u32 m0, s69, 65536
    ds_read_b64_tr_b16 v[50:51], v14 offset:1024
    ds_read_b64_tr_b16 v[52:53], v14 offset:8192
    v_mfma_f32_16x16x32_bf16 v[236:239], v[44:47], a[28:31], v[236:239]
    s_lshl_b32 s60, s5, 8
    buffer_load_dwordx4 v2, s[24:27], s60 offen lds
    v_mfma_f32_16x16x32_bf16 v[240:243], v[40:43], a[32:35], v[240:243]
    ds_read_b64_tr_b16 v[54:55], v14 offset:9216
    ds_read_b64_tr_b16 v[56:57], v15 offset:0
    v_mfma_f32_16x16x32_bf16 v[240:243], v[44:47], a[36:39], v[240:243]
    ds_read_b64_tr_b16 v[58:59], v15 offset:1024
    ds_read_b64_tr_b16 v[60:61], v15 offset:8192
    v_mfma_f32_16x16x32_bf16 v[244:247], v[40:43], a[40:43], v[244:247]
    ds_read_b64_tr_b16 v[62:63], v15 offset:9216
    v_add_u32 v14, 0xfffe0000, v14
    v_mfma_f32_16x16x32_bf16 v[244:247], v[44:47], a[44:47], v[244:247]
    v_add_u32 v15, 0xfffe0000, v15
    v_mfma_f32_16x16x32_bf16 v[248:251], v[40:43], a[48:51], v[248:251]
    v_mfma_f32_16x16x32_bf16 v[248:251], v[44:47], a[52:55], v[248:251]
    buffer_load_dwordx4 v3, s[24:27], s60 offen offset:1024 lds
    v_mfma_f32_16x16x32_bf16 v[252:255], v[40:43], a[56:59], v[252:255]
    ds_read_b64_tr_b16 v[40:41], v16 offset:0
    ds_read_b64_tr_b16 v[42:43], v16 offset:1024
    v_mfma_f32_16x16x32_bf16 v[252:255], v[44:47], a[60:63], v[252:255]
    s_waitcnt lgkmcnt(2)
    ds_read_b64_tr_b16 v[44:45], v16 offset:8192
    ds_read_b64_tr_b16 v[46:47], v16 offset:9216
    v_mfma_f32_16x16x32_bf16 a[128:131], a[0:3], v[48:51], a[128:131]
    v_add_u32 v16, 0xfffe0000, v16
    v_mfma_f32_16x16x32_bf16 a[128:131], a[4:7], v[52:55], a[128:131]
    v_add_u32 v22, 0x10000, v22
    v_mfma_f32_16x16x32_bf16 a[132:135], a[8:11], v[48:51], a[132:135]
    ds_read_b128 a[96:99], v22 offset:16384
    v_mfma_f32_16x16x32_bf16 a[132:135], a[12:15], v[52:55], a[132:135]
    v_mfma_f32_16x16x32_bf16 a[136:139], a[16:19], v[48:51], a[136:139]
    v_mfma_f32_16x16x32_bf16 a[136:139], a[20:23], v[52:55], a[136:139]
    buffer_load_dwordx4 v4, s[24:27], s60 offen offset:2048 lds
    v_mfma_f32_16x16x32_bf16 a[140:143], a[24:27], v[48:51], a[140:143]
    v_add_u32 v23, 0x10000, v23
    v_mfma_f32_16x16x32_bf16 a[140:143], a[28:31], v[52:55], a[140:143]
    ds_read_b128 a[100:103], v23 offset:16384
    v_mfma_f32_16x16x32_bf16 a[144:147], a[32:35], v[48:51], a[144:147]
    v_mfma_f32_16x16x32_bf16 a[144:147], a[36:39], v[52:55], a[144:147]
    v_mfma_f32_16x16x32_bf16 a[148:151], a[40:43], v[48:51], a[148:151]
    v_mfma_f32_16x16x32_bf16 a[148:151], a[44:47], v[52:55], a[148:151]
    v_mfma_f32_16x16x32_bf16 a[152:155], a[48:51], v[48:51], a[152:155]
    buffer_load_dwordx4 v5, s[24:27], s60 offen offset:3072 lds
    v_mfma_f32_16x16x32_bf16 a[152:155], a[52:55], v[52:55], a[152:155]
    ds_read_b128 a[104:107], v22 offset:18432
    v_mfma_f32_16x16x32_bf16 a[156:159], a[56:59], v[48:51], a[156:159]
    ds_read_b64_tr_b16 v[48:49], v17 offset:0
    ds_read_b64_tr_b16 v[50:51], v17 offset:1024
    v_mfma_f32_16x16x32_bf16 a[156:159], a[60:63], v[52:55], a[156:159]
    ds_read_b64_tr_b16 v[52:53], v17 offset:8192
    ds_read_b64_tr_b16 v[54:55], v17 offset:9216
    v_mfma_f32_16x16x32_bf16 a[160:163], a[0:3], v[56:59], a[160:163]
    v_add_u32 v17, 0xfffe0000, v17
    v_mfma_f32_16x16x32_bf16 a[160:163], a[4:7], v[60:63], a[160:163]
    v_mfma_f32_16x16x32_bf16 a[164:167], a[8:11], v[56:59], a[164:167]
    ds_read_b128 a[108:111], v23 offset:18432
    v_mfma_f32_16x16x32_bf16 a[164:167], a[12:15], v[60:63], a[164:167]
    s_add_u32 m0, s69, 81920
    v_mfma_f32_16x16x32_bf16 a[168:171], a[16:19], v[56:59], a[168:171]
    s_add_u32 s60, s60, 524288
    buffer_load_dwordx4 v10, s[20:23], s63 offen lds
    v_mfma_f32_16x16x32_bf16 a[168:171], a[20:23], v[60:63], a[168:171]
    v_mfma_f32_16x16x32_bf16 a[172:175], a[24:27], v[56:59], a[172:175]
    v_mfma_f32_16x16x32_bf16 a[172:175], a[28:31], v[60:63], a[172:175]
    v_mfma_f32_16x16x32_bf16 a[176:179], a[32:35], v[56:59], a[176:179]
    ds_read_b128 a[112:115], v22 offset:20480
    v_mfma_f32_16x16x32_bf16 a[176:179], a[36:39], v[60:63], a[176:179]
    v_mfma_f32_16x16x32_bf16 a[180:183], a[40:43], v[56:59], a[180:183]
    v_mfma_f32_16x16x32_bf16 a[180:183], a[44:47], v[60:63], a[180:183]
    buffer_load_dwordx4 v11, s[20:23], s63 offen offset:1024 lds
    v_mfma_f32_16x16x32_bf16 a[184:187], a[48:51], v[56:59], a[184:187]
    v_mfma_f32_16x16x32_bf16 a[184:187], a[52:55], v[60:63], a[184:187]
    ds_read_b128 a[116:119], v23 offset:20480
    v_mfma_f32_16x16x32_bf16 a[188:191], a[56:59], v[56:59], a[188:191]
    v_mfma_f32_16x16x32_bf16 a[188:191], a[60:63], v[60:63], a[188:191]
    s_waitcnt lgkmcnt(1)
    v_mfma_f32_16x16x32_bf16 a[192:195], a[0:3], v[40:43], a[192:195]
    v_mfma_f32_16x16x32_bf16 a[192:195], a[4:7], v[44:47], a[192:195]
    v_mfma_f32_16x16x32_bf16 a[196:199], a[8:11], v[40:43], a[196:199]
    v_mfma_f32_16x16x32_bf16 a[196:199], a[12:15], v[44:47], a[196:199]
    buffer_load_dwordx4 v12, s[20:23], s63 offen offset:2048 lds
    v_mfma_f32_16x16x32_bf16 a[200:203], a[16:19], v[40:43], a[200:203]
    ds_read_b128 a[120:123], v22 offset:22528
    v_mov_b32 v22, v100
    v_mfma_f32_16x16x32_bf16 a[200:203], a[20:23], v[44:47], a[200:203]
    v_add_u32 v22, 0x10000, v22
    v_mfma_f32_16x16x32_bf16 a[204:207], a[24:27], v[40:43], a[204:207]
    v_mfma_f32_16x16x32_bf16 a[204:207], a[28:31], v[44:47], a[204:207]
    v_mfma_f32_16x16x32_bf16 a[208:211], a[32:35], v[40:43], a[208:211]
    ds_read_b128 a[124:127], v23 offset:22528
    v_mov_b32 v23, v101
    v_mfma_f32_16x16x32_bf16 a[208:211], a[36:39], v[44:47], a[208:211]
    v_add_u32 v23, 0x10000, v23
    v_mfma_f32_16x16x32_bf16 a[212:215], a[40:43], v[40:43], a[212:215]
    buffer_load_dwordx4 v13, s[20:23], s63 offen offset:3072 lds
    v_mfma_f32_16x16x32_bf16 a[212:215], a[44:47], v[44:47], a[212:215]
    v_mfma_f32_16x16x32_bf16 a[216:219], a[48:51], v[40:43], a[216:219]
    v_mfma_f32_16x16x32_bf16 a[216:219], a[52:55], v[44:47], a[216:219]
    v_mfma_f32_16x16x32_bf16 a[220:223], a[56:59], v[40:43], a[220:223]
    v_mfma_f32_16x16x32_bf16 a[220:223], a[60:63], v[44:47], a[220:223]
    v_mfma_f32_16x16x32_bf16 a[224:227], a[0:3], v[48:51], a[224:227]
    v_mfma_f32_16x16x32_bf16 a[224:227], a[4:7], v[52:55], a[224:227]
    s_add_u32 s63, s63, 128
    v_mfma_f32_16x16x32_bf16 a[228:231], a[8:11], v[48:51], a[228:231]
    v_mfma_f32_16x16x32_bf16 a[228:231], a[12:15], v[52:55], a[228:231]
    v_mfma_f32_16x16x32_bf16 a[232:235], a[16:19], v[48:51], a[232:235]
    v_mfma_f32_16x16x32_bf16 a[232:235], a[20:23], v[52:55], a[232:235]
    s_waitcnt vmcnt(16)
    s_barrier
    ds_read_b64_tr_b16 v[56:57], v14 offset:0
    v_mfma_f32_16x16x32_bf16 a[236:239], a[24:27], v[48:51], a[236:239]
    s_add_u32 m0, s69, 98304
    ds_read_b64_tr_b16 v[58:59], v14 offset:1024
    ds_read_b64_tr_b16 v[60:61], v14 offset:8192
    v_mfma_f32_16x16x32_bf16 a[236:239], a[28:31], v[52:55], a[236:239]
    buffer_load_dwordx4 v6, s[28:31], s65 offen lds
    v_mfma_f32_16x16x32_bf16 a[240:243], a[32:35], v[48:51], a[240:243]
    ds_read_b64_tr_b16 v[62:63], v14 offset:9216
    ds_read_b64_tr_b16 v[40:41], v15 offset:0
    v_mfma_f32_16x16x32_bf16 a[240:243], a[36:39], v[52:55], a[240:243]
    ds_read_b64_tr_b16 v[42:43], v15 offset:1024
    ds_read_b64_tr_b16 v[44:45], v15 offset:8192
    v_mfma_f32_16x16x32_bf16 a[244:247], a[40:43], v[48:51], a[244:247]
    ds_read_b64_tr_b16 v[46:47], v15 offset:9216
    v_mfma_f32_16x16x32_bf16 a[244:247], a[44:47], v[52:55], a[244:247]
    v_mfma_f32_16x16x32_bf16 a[248:251], a[48:51], v[48:51], a[248:251]
    s_add_u32 m0, s69, 99328
    v_mfma_f32_16x16x32_bf16 a[248:251], a[52:55], v[52:55], a[248:251]
    buffer_load_dwordx4 v7, s[32:35], s66 offen lds
    v_mfma_f32_16x16x32_bf16 a[252:255], a[56:59], v[48:51], a[252:255]
    ds_read_b64_tr_b16 v[48:49], v16 offset:0
    ds_read_b64_tr_b16 v[50:51], v16 offset:1024
    v_mfma_f32_16x16x32_bf16 a[252:255], a[60:63], v[52:55], a[252:255]
    s_waitcnt lgkmcnt(2)
    ds_read_b64_tr_b16 v[52:53], v16 offset:8192
    ds_read_b64_tr_b16 v[54:55], v16 offset:9216
    v_mfma_f32_16x16x32_bf16 v[128:131], v[56:59], a[64:67], v[128:131]
    v_mfma_f32_16x16x32_bf16 v[128:131], v[60:63], a[68:71], v[128:131]
    v_mfma_f32_16x16x32_bf16 v[132:135], v[56:59], a[72:75], v[132:135]
    ds_read_b128 v[64:67], v24 offset:16384
    v_mfma_f32_16x16x32_bf16 v[132:135], v[60:63], a[76:79], v[132:135]
    v_mfma_f32_16x16x32_bf16 v[136:139], v[56:59], a[80:83], v[136:139]
    s_add_u32 m0, s69, 100352
    v_mfma_f32_16x16x32_bf16 v[136:139], v[60:63], a[84:87], v[136:139]
    buffer_load_dwordx4 v8, s[32:35], s66 offen lds
    v_mfma_f32_16x16x32_bf16 v[140:143], v[56:59], a[88:91], v[140:143]
    v_cvt_pk_bf16_f32 v128, v128, v129
    v_cvt_pk_bf16_f32 v130, v130, v131
    v_mfma_f32_16x16x32_bf16 v[140:143], v[60:63], a[92:95], v[140:143]
    v_accvgpr_write_b32 a0, v128
    v_accvgpr_write_b32 a1, v130
    v_mfma_f32_16x16x32_bf16 v[144:147], v[56:59], a[96:99], v[144:147]
    v_cvt_pk_bf16_f32 v132, v132, v133
    v_cvt_pk_bf16_f32 v134, v134, v135
    v_mfma_f32_16x16x32_bf16 v[144:147], v[60:63], a[100:103], v[144:147]
    v_accvgpr_write_b32 a8, v132
    v_accvgpr_write_b32 a9, v134
    v_mfma_f32_16x16x32_bf16 v[148:151], v[56:59], a[104:107], v[148:151]
    v_cvt_pk_bf16_f32 v136, v136, v137
    v_cvt_pk_bf16_f32 v138, v138, v139
    v_mfma_f32_16x16x32_bf16 v[148:151], v[60:63], a[108:111], v[148:151]
    s_add_u32 m0, s69, 101376
    v_accvgpr_write_b32 a16, v136
    v_accvgpr_write_b32 a17, v138
    v_mfma_f32_16x16x32_bf16 v[152:155], v[56:59], a[112:115], v[152:155]
    buffer_load_dwordx4 v9, s[32:35], s66 offen lds
    v_mfma_f32_16x16x32_bf16 v[152:155], v[60:63], a[116:119], v[152:155]
    ds_read_b128 v[68:71], v25 offset:16384
    v_cvt_pk_bf16_f32 v140, v140, v141
    v_mfma_f32_16x16x32_bf16 v[156:159], v[56:59], a[120:123], v[156:159]
    ds_read_b64_tr_b16 v[56:57], v17 offset:0
    ds_read_b64_tr_b16 v[58:59], v17 offset:1024
    v_mfma_f32_16x16x32_bf16 v[156:159], v[60:63], a[124:127], v[156:159]
    ds_read_b64_tr_b16 v[60:61], v17 offset:8192
    ds_read_b64_tr_b16 v[62:63], v17 offset:9216
    v_mfma_f32_16x16x32_bf16 v[160:163], v[40:43], a[64:67], v[160:163]
    v_cvt_pk_bf16_f32 v142, v142, v143
    v_accvgpr_write_b32 a24, v140
    v_mfma_f32_16x16x32_bf16 v[160:163], v[44:47], a[68:71], v[160:163]
    v_accvgpr_write_b32 a25, v142
    v_cvt_pk_bf16_f32 v144, v144, v145
    v_mfma_f32_16x16x32_bf16 v[164:167], v[40:43], a[72:75], v[164:167]
    v_cvt_pk_bf16_f32 v146, v146, v147
    v_accvgpr_write_b32 a32, v144
    v_mfma_f32_16x16x32_bf16 v[164:167], v[44:47], a[76:79], v[164:167]
    s_add_u32 m0, s69, 114688
    v_accvgpr_write_b32 a33, v146
    v_cvt_pk_bf16_f32 v148, v148, v149
    v_mfma_f32_16x16x32_bf16 v[168:171], v[40:43], a[80:83], v[168:171]
    s_add_u32 s65, s65, s67
    buffer_load_dwordx4 v10, s[20:23], s64 offen lds
    v_mfma_f32_16x16x32_bf16 v[168:171], v[44:47], a[84:87], v[168:171]
    s_add_u32 s66, s66, s68
    v_cvt_pk_bf16_f32 v150, v150, v151
    v_accvgpr_write_b32 a40, v148
    v_mfma_f32_16x16x32_bf16 v[172:175], v[40:43], a[88:91], v[172:175]
    v_accvgpr_write_b32 a41, v150
    v_cvt_pk_bf16_f32 v152, v152, v153
    v_mfma_f32_16x16x32_bf16 v[172:175], v[44:47], a[92:95], v[172:175]
    v_cvt_pk_bf16_f32 v154, v154, v155
    v_cvt_pk_bf16_f32 v160, v160, v161
    v_mfma_f32_16x16x32_bf16 v[176:179], v[40:43], a[96:99], v[176:179]
    ds_read_b128 v[72:75], v24 offset:24576
    v_cvt_pk_bf16_f32 v162, v162, v163
    v_mfma_f32_16x16x32_bf16 v[176:179], v[44:47], a[100:103], v[176:179]
    v_accvgpr_write_b32 a48, v152
    v_accvgpr_write_b32 a49, v154
    v_mfma_f32_16x16x32_bf16 v[180:183], v[40:43], a[104:107], v[180:183]
    v_accvgpr_write_b32 a2, v160
    v_accvgpr_write_b32 a3, v162
    v_mfma_f32_16x16x32_bf16 v[180:183], v[44:47], a[108:111], v[180:183]
    buffer_load_dwordx4 v11, s[20:23], s64 offen offset:1024 lds
    v_mfma_f32_16x16x32_bf16 v[184:187], v[40:43], a[112:115], v[184:187]
    v_cvt_pk_bf16_f32 v156, v156, v157
    v_cvt_pk_bf16_f32 v158, v158, v159
    v_mfma_f32_16x16x32_bf16 v[184:187], v[44:47], a[116:119], v[184:187]
    v_accvgpr_write_b32 a56, v156
    v_accvgpr_write_b32 a57, v158
    v_mfma_f32_16x16x32_bf16 v[188:191], v[40:43], a[120:123], v[188:191]
    v_cvt_pk_bf16_f32 v164, v164, v165
    v_cvt_pk_bf16_f32 v166, v166, v167
    v_mfma_f32_16x16x32_bf16 v[188:191], v[44:47], a[124:127], v[188:191]
    s_waitcnt lgkmcnt(0)
    v_accvgpr_write_b32 a10, v164
    v_accvgpr_write_b32 a11, v166
    v_mfma_f32_16x16x32_bf16 v[192:195], v[48:51], a[64:67], v[192:195]
    v_cvt_pk_bf16_f32 v168, v168, v169
    v_cvt_pk_bf16_f32 v170, v170, v171
    v_mfma_f32_16x16x32_bf16 v[192:195], v[52:55], a[68:71], v[192:195]
    v_accvgpr_write_b32 a18, v168
    v_accvgpr_write_b32 a19, v170
    v_mfma_f32_16x16x32_bf16 v[196:199], v[48:51], a[72:75], v[196:199]
    v_cvt_pk_bf16_f32 v172, v172, v173
    v_cvt_pk_bf16_f32 v174, v174, v175
    v_mfma_f32_16x16x32_bf16 v[196:199], v[52:55], a[76:79], v[196:199]
    buffer_load_dwordx4 v12, s[20:23], s64 offen offset:2048 lds
    v_mfma_f32_16x16x32_bf16 v[200:203], v[48:51], a[80:83], v[200:203]
    ds_read_b128 v[76:79], v25 offset:24576
    v_accvgpr_write_b32 a26, v172
    v_mfma_f32_16x16x32_bf16 v[200:203], v[52:55], a[84:87], v[200:203]
    v_accvgpr_write_b32 a27, v174
    v_cvt_pk_bf16_f32 v176, v176, v177
    v_mfma_f32_16x16x32_bf16 v[204:207], v[48:51], a[88:91], v[204:207]
    v_cvt_pk_bf16_f32 v178, v178, v179
    v_accvgpr_write_b32 a34, v176
    v_mfma_f32_16x16x32_bf16 v[204:207], v[52:55], a[92:95], v[204:207]
    v_accvgpr_write_b32 a35, v178
    v_cvt_pk_bf16_f32 v192, v192, v193
    v_mfma_f32_16x16x32_bf16 v[208:211], v[48:51], a[96:99], v[208:211]
    v_cvt_pk_bf16_f32 v194, v194, v195
    v_cvt_pk_bf16_f32 v180, v180, v181
    v_mfma_f32_16x16x32_bf16 v[208:211], v[52:55], a[100:103], v[208:211]
    v_cvt_pk_bf16_f32 v182, v182, v183
    v_accvgpr_write_b32 a4, v192
    v_mfma_f32_16x16x32_bf16 v[212:215], v[48:51], a[104:107], v[212:215]
    buffer_load_dwordx4 v13, s[20:23], s64 offen offset:3072 lds
    v_mfma_f32_16x16x32_bf16 v[212:215], v[52:55], a[108:111], v[212:215]
    v_accvgpr_write_b32 a5, v194
    v_accvgpr_write_b32 a42, v180
    v_mfma_f32_16x16x32_bf16 v[216:219], v[48:51], a[112:115], v[216:219]
    v_accvgpr_write_b32 a43, v182
    v_cvt_pk_bf16_f32 v184, v184, v185
    v_mfma_f32_16x16x32_bf16 v[216:219], v[52:55], a[116:119], v[216:219]
    v_cvt_pk_bf16_f32 v186, v186, v187
    v_accvgpr_write_b32 a50, v184
    v_mfma_f32_16x16x32_bf16 v[220:223], v[48:51], a[120:123], v[220:223]
    v_accvgpr_write_b32 a51, v186
    v_cvt_pk_bf16_f32 v188, v188, v189
    v_mfma_f32_16x16x32_bf16 v[220:223], v[52:55], a[124:127], v[220:223]
    v_cvt_pk_bf16_f32 v190, v190, v191
    v_accvgpr_write_b32 a58, v188
    v_mfma_f32_16x16x32_bf16 v[224:227], v[56:59], a[64:67], v[224:227]
    v_accvgpr_write_b32 a59, v190
    v_cvt_pk_bf16_f32 v196, v196, v197
    v_mfma_f32_16x16x32_bf16 v[224:227], v[60:63], a[68:71], v[224:227]
    s_add_u32 s64, s64, 128
    v_cvt_pk_bf16_f32 v198, v198, v199
    v_accvgpr_write_b32 a12, v196
    v_mfma_f32_16x16x32_bf16 v[228:231], v[56:59], a[72:75], v[228:231]
    v_accvgpr_write_b32 a13, v198
    v_cvt_pk_bf16_f32 v200, v200, v201
    v_mfma_f32_16x16x32_bf16 v[228:231], v[60:63], a[76:79], v[228:231]
    v_cvt_pk_bf16_f32 v202, v202, v203
    v_cvt_pk_bf16_f32 v224, v224, v225
    v_mfma_f32_16x16x32_bf16 v[232:235], v[56:59], a[80:83], v[232:235]
    v_cvt_pk_bf16_f32 v226, v226, v227
    v_accvgpr_write_b32 a6, v224
    v_mfma_f32_16x16x32_bf16 v[232:235], v[60:63], a[84:87], v[232:235]
    s_waitcnt vmcnt(16)
    s_barrier
    ds_read_b64_tr_b16 v[40:41], v14 offset:32768
    v_mfma_f32_16x16x32_bf16 v[236:239], v[56:59], a[88:91], v[236:239]
    s_add_u32 m0, s69, 131072
    ds_read_b64_tr_b16 v[42:43], v14 offset:33792
    ds_read_b64_tr_b16 v[44:45], v14 offset:40960
    v_mfma_f32_16x16x32_bf16 v[236:239], v[60:63], a[92:95], v[236:239]
    buffer_load_dwordx4 v2, s[24:27], s60 offen lds
    v_mfma_f32_16x16x32_bf16 v[240:243], v[56:59], a[96:99], v[240:243]
    ds_read_b64_tr_b16 v[46:47], v14 offset:41984
    ds_read_b64_tr_b16 v[48:49], v15 offset:32768
    v_mfma_f32_16x16x32_bf16 v[240:243], v[60:63], a[100:103], v[240:243]
    ds_read_b64_tr_b16 v[50:51], v15 offset:33792
    ds_read_b64_tr_b16 v[52:53], v15 offset:40960
    v_mfma_f32_16x16x32_bf16 v[244:247], v[56:59], a[104:107], v[244:247]
    ds_read_b64_tr_b16 v[54:55], v15 offset:41984
    v_xor_b32 v14, s73, v14
    v_mfma_f32_16x16x32_bf16 v[244:247], v[60:63], a[108:111], v[244:247]
    v_add_u32 v14, 0x10000, v14
    v_xor_b32 v15, s73, v15
    v_mfma_f32_16x16x32_bf16 v[248:251], v[56:59], a[112:115], v[248:251]
    v_add_u32 v15, 0x10000, v15
    v_accvgpr_write_b32 a7, v226
    v_mfma_f32_16x16x32_bf16 v[248:251], v[60:63], a[116:119], v[248:251]
    buffer_load_dwordx4 v3, s[24:27], s60 offen offset:1024 lds
    v_mfma_f32_16x16x32_bf16 v[252:255], v[56:59], a[120:123], v[252:255]
    ds_read_b64_tr_b16 v[56:57], v16 offset:32768
    ds_read_b64_tr_b16 v[58:59], v16 offset:33792
    v_mfma_f32_16x16x32_bf16 v[252:255], v[60:63], a[124:127], v[252:255]
    s_waitcnt lgkmcnt(2)
    ds_read_b64_tr_b16 v[60:61], v16 offset:40960
    ds_read_b64_tr_b16 v[62:63], v16 offset:41984
    v_mfma_f32_16x16x32_bf16 a[128:131], a[64:67], v[40:43], a[128:131]
    v_xor_b32 v16, s73, v16
    v_add_u32 v16, 0x10000, v16
    v_mfma_f32_16x16x32_bf16 a[128:131], a[68:71], v[44:47], a[128:131]
    v_accvgpr_write_b32 a20, v200
    v_accvgpr_write_b32 a21, v202
    v_mfma_f32_16x16x32_bf16 a[132:135], a[72:75], v[40:43], a[132:135]
    ds_read_b128 v[80:83], v24 offset:49152
    v_cvt_pk_bf16_f32 v204, v204, v205
    v_mfma_f32_16x16x32_bf16 a[132:135], a[76:79], v[44:47], a[132:135]
    v_cvt_pk_bf16_f32 v206, v206, v207
    v_accvgpr_write_b32 a28, v204
    v_mfma_f32_16x16x32_bf16 a[136:139], a[80:83], v[40:43], a[136:139]
    v_accvgpr_write_b32 a29, v206
    v_cvt_pk_bf16_f32 v208, v208, v209
    v_mfma_f32_16x16x32_bf16 a[136:139], a[84:87], v[44:47], a[136:139]
    buffer_load_dwordx4 v4, s[24:27], s60 offen offset:2048 lds
    v_mfma_f32_16x16x32_bf16 a[140:143], a[88:91], v[40:43], a[140:143]
    v_cvt_pk_bf16_f32 v210, v210, v211
    v_accvgpr_write_b32 a36, v208
    v_mfma_f32_16x16x32_bf16 a[140:143], a[92:95], v[44:47], a[140:143]
    v_accvgpr_write_b32 a37, v210
    v_cvt_pk_bf16_f32 v212, v212, v213
    v_mfma_f32_16x16x32_bf16 a[144:147], a[96:99], v[40:43], a[144:147]
    v_cvt_pk_bf16_f32 v214, v214, v215
    v_accvgpr_write_b32 a44, v212
    v_mfma_f32_16x16x32_bf16 a[144:147], a[100:103], v[44:47], a[144:147]
    v_accvgpr_write_b32 a45, v214
    v_cvt_pk_bf16_f32 v216, v216, v217
    v_mfma_f32_16x16x32_bf16 a[148:151], a[104:107], v[40:43], a[148:151]
    v_cvt_pk_bf16_f32 v218, v218, v219
    v_accvgpr_write_b32 a52, v216
    v_mfma_f32_16x16x32_bf16 a[148:151], a[108:111], v[44:47], a[148:151]
    v_accvgpr_write_b32 a53, v218
    v_cvt_pk_bf16_f32 v220, v220, v221
    v_mfma_f32_16x16x32_bf16 a[152:155], a[112:115], v[40:43], a[152:155]
    buffer_load_dwordx4 v5, s[24:27], s60 offen offset:3072 lds
    v_mfma_f32_16x16x32_bf16 a[152:155], a[116:119], v[44:47], a[152:155]
    ds_read_b128 v[84:87], v25 offset:49152
    v_cvt_pk_bf16_f32 v222, v222, v223
    v_mfma_f32_16x16x32_bf16 a[156:159], a[120:123], v[40:43], a[156:159]
    ds_read_b64_tr_b16 v[40:41], v17 offset:32768
    ds_read_b64_tr_b16 v[42:43], v17 offset:33792
    v_mfma_f32_16x16x32_bf16 a[156:159], a[124:127], v[44:47], a[156:159]
    ds_read_b64_tr_b16 v[44:45], v17 offset:40960
    ds_read_b64_tr_b16 v[46:47], v17 offset:41984
    v_mfma_f32_16x16x32_bf16 a[160:163], a[64:67], v[48:51], a[160:163]
    v_xor_b32 v17, s73, v17
    v_add_u32 v17, 0x10000, v17
    v_mfma_f32_16x16x32_bf16 a[160:163], a[68:71], v[52:55], a[160:163]
    v_accvgpr_write_b32 a60, v220
    v_accvgpr_write_b32 a61, v222
    v_mfma_f32_16x16x32_bf16 a[164:167], a[72:75], v[48:51], a[164:167]
    v_cvt_pk_bf16_f32 v228, v228, v229
    v_cvt_pk_bf16_f32 v230, v230, v231
    v_mfma_f32_16x16x32_bf16 a[164:167], a[76:79], v[52:55], a[164:167]
    s_add_u32 m0, s69, 147456
    v_accvgpr_write_b32 a14, v228
    v_accvgpr_write_b32 a15, v230
    v_mfma_f32_16x16x32_bf16 a[168:171], a[80:83], v[48:51], a[168:171]
    s_add_u32 s60, s60, 524288
    buffer_load_dwordx4 v10, s[20:23], s63 offen lds
    v_mfma_f32_16x16x32_bf16 a[168:171], a[84:87], v[52:55], a[168:171]
    v_cvt_pk_bf16_f32 v232, v232, v233
    v_cvt_pk_bf16_f32 v234, v234, v235
    v_mfma_f32_16x16x32_bf16 a[172:175], a[88:91], v[48:51], a[172:175]
    v_accvgpr_write_b32 a22, v232
    v_accvgpr_write_b32 a23, v234
    v_mfma_f32_16x16x32_bf16 a[172:175], a[92:95], v[52:55], a[172:175]
    v_cvt_pk_bf16_f32 v236, v236, v237
    v_cvt_pk_bf16_f32 v238, v238, v239
    v_mfma_f32_16x16x32_bf16 a[176:179], a[96:99], v[48:51], a[176:179]
    ds_read_b128 v[88:91], v24 offset:57344
    v_accvgpr_write_b32 a30, v236
    v_mfma_f32_16x16x32_bf16 a[176:179], a[100:103], v[52:55], a[176:179]
    v_accvgpr_write_b32 a31, v238
    v_cvt_pk_bf16_f32 v240, v240, v241
    v_mfma_f32_16x16x32_bf16 a[180:183], a[104:107], v[48:51], a[180:183]
    v_cvt_pk_bf16_f32 v242, v242, v243
    v_accvgpr_write_b32 a38, v240
    v_mfma_f32_16x16x32_bf16 a[180:183], a[108:111], v[52:55], a[180:183]
    buffer_load_dwordx4 v11, s[20:23], s63 offen offset:1024 lds
    v_mfma_f32_16x16x32_bf16 a[184:187], a[112:115], v[48:51], a[184:187]
    v_accvgpr_write_b32 a39, v242
    v_cvt_pk_bf16_f32 v244, v244, v245
    v_mfma_f32_16x16x32_bf16 a[184:187], a[116:119], v[52:55], a[184:187]
    v_cvt_pk_bf16_f32 v246, v246, v247
    v_accvgpr_write_b32 a46, v244
    v_mfma_f32_16x16x32_bf16 a[188:191], a[120:123], v[48:51], a[188:191]
    v_accvgpr_write_b32 a47, v246
    v_cvt_pk_bf16_f32 v248, v248, v249
    v_mfma_f32_16x16x32_bf16 a[188:191], a[124:127], v[52:55], a[188:191]
    s_waitcnt lgkmcnt(0)
    v_cvt_pk_bf16_f32 v250, v250, v251
    v_accvgpr_write_b32 a54, v248
    v_mfma_f32_16x16x32_bf16 a[192:195], a[64:67], v[56:59], a[192:195]
    v_accvgpr_write_b32 a55, v250
    v_cvt_pk_bf16_f32 v252, v252, v253
    v_mfma_f32_16x16x32_bf16 a[192:195], a[68:71], v[60:63], a[192:195]
    v_cvt_pk_bf16_f32 v254, v254, v255
    v_accvgpr_write_b32 a62, v252
    v_mfma_f32_16x16x32_bf16 a[196:199], a[72:75], v[56:59], a[196:199]
    v_accvgpr_write_b32 a63, v254
    v_mfma_f32_16x16x32_bf16 a[196:199], a[76:79], v[60:63], a[196:199]
    buffer_load_dwordx4 v12, s[20:23], s63 offen offset:2048 lds
    v_mfma_f32_16x16x32_bf16 a[200:203], a[80:83], v[56:59], a[200:203]
    ds_read_b128 v[92:95], v25 offset:57344
    v_accvgpr_read_b32 v32, a128
    v_mfma_f32_16x16x32_bf16 a[200:203], a[84:87], v[60:63], a[200:203]
    v_accvgpr_read_b32 v31, a129
    v_cvt_pk_bf16_f32 v32, v32, v31
    v_mfma_f32_16x16x32_bf16 a[204:207], a[88:91], v[56:59], a[204:207]
    v_accvgpr_read_b32 v33, a130
    v_accvgpr_read_b32 v31, a131
    v_mfma_f32_16x16x32_bf16 a[204:207], a[92:95], v[60:63], a[204:207]
    v_cvt_pk_bf16_f32 v33, v33, v31
    v_accvgpr_read_b32 v34, a132
    v_mfma_f32_16x16x32_bf16 a[208:211], a[96:99], v[56:59], a[208:211]
    v_accvgpr_read_b32 v31, a133
    v_cvt_pk_bf16_f32 v34, v34, v31
    v_mfma_f32_16x16x32_bf16 a[208:211], a[100:103], v[60:63], a[208:211]
    v_accvgpr_read_b32 v35, a134
    v_accvgpr_read_b32 v31, a135
    v_mfma_f32_16x16x32_bf16 a[212:215], a[104:107], v[56:59], a[212:215]
    buffer_load_dwordx4 v13, s[20:23], s63 offen offset:3072 lds
    v_mfma_f32_16x16x32_bf16 a[212:215], a[108:111], v[60:63], a[212:215]
    v_cvt_pk_bf16_f32 v35, v35, v31
    v_mfma_f32_16x16x32_bf16 a[216:219], a[112:115], v[56:59], a[216:219]
    v_mfma_f32_16x16x32_bf16 a[216:219], a[116:119], v[60:63], a[216:219]
    s_add_u32 s72, s71, 0
    v_mfma_f32_16x16x32_bf16 a[220:223], a[120:123], v[56:59], a[220:223]
    buffer_store_dwordx4 v[32:35], v1, s[36:39], s72 offen sc1
    v_mfma_f32_16x16x32_bf16 a[220:223], a[124:127], v[60:63], a[220:223]
    v_mfma_f32_16x16x32_bf16 a[224:227], a[64:67], v[40:43], a[224:227]
    v_mfma_f32_16x16x32_bf16 a[224:227], a[68:71], v[44:47], a[224:227]
    s_add_u32 s63, s63, 128
    v_mfma_f32_16x16x32_bf16 a[228:231], a[72:75], v[40:43], a[228:231]
    v_mfma_f32_16x16x32_bf16 a[228:231], a[76:79], v[44:47], a[228:231]
    v_mfma_f32_16x16x32_bf16 a[232:235], a[80:83], v[40:43], a[232:235]
    v_accvgpr_read_b32 v36, a136
    v_accvgpr_read_b32 v31, a137
    v_mfma_f32_16x16x32_bf16 a[232:235], a[84:87], v[44:47], a[232:235]
    s_waitcnt vmcnt(17)
    s_barrier
    ds_read_b64_tr_b16 v[48:49], v14 offset:0
    v_mfma_f32_16x16x32_bf16 a[236:239], a[88:91], v[40:43], a[236:239]
    s_add_u32 m0, s69, 0
    ds_read_b64_tr_b16 v[50:51], v14 offset:1024
    ds_read_b64_tr_b16 v[52:53], v14 offset:8192
    v_mfma_f32_16x16x32_bf16 a[236:239], a[92:95], v[44:47], a[236:239]
    buffer_load_dwordx4 v6, s[28:31], s65 offen lds
    v_mfma_f32_16x16x32_bf16 a[240:243], a[96:99], v[40:43], a[240:243]
    ds_read_b64_tr_b16 v[54:55], v14 offset:9216
    ds_read_b64_tr_b16 v[56:57], v15 offset:0
    v_mfma_f32_16x16x32_bf16 a[240:243], a[100:103], v[44:47], a[240:243]
    ds_read_b64_tr_b16 v[58:59], v15 offset:1024
    ds_read_b64_tr_b16 v[60:61], v15 offset:8192
    v_mfma_f32_16x16x32_bf16 a[244:247], a[104:107], v[40:43], a[244:247]
    ds_read_b64_tr_b16 v[62:63], v15 offset:9216
    v_add_u32 v14, 0x10000, v14
    v_mfma_f32_16x16x32_bf16 a[244:247], a[108:111], v[44:47], a[244:247]
    v_add_u32 v15, 0x10000, v15
    v_cvt_pk_bf16_f32 v36, v36, v31
    v_mfma_f32_16x16x32_bf16 a[248:251], a[112:115], v[40:43], a[248:251]
    s_add_u32 m0, s69, 1024
    v_accvgpr_read_b32 v37, a138
    v_accvgpr_read_b32 v31, a139
    v_mfma_f32_16x16x32_bf16 a[248:251], a[116:119], v[44:47], a[248:251]
    s_add_u32 s72, s71, 1024
    buffer_load_dwordx4 v7, s[32:35], s66 offen lds
    v_mfma_f32_16x16x32_bf16 a[252:255], a[120:123], v[40:43], a[252:255]
    ds_read_b64_tr_b16 v[40:41], v16 offset:0
    ds_read_b64_tr_b16 v[42:43], v16 offset:1024
    v_mfma_f32_16x16x32_bf16 a[252:255], a[124:127], v[44:47], a[252:255]
    s_waitcnt lgkmcnt(2)
    ds_read_b64_tr_b16 v[44:45], v16 offset:8192
    ds_read_b64_tr_b16 v[46:47], v16 offset:9216
    v_mfma_f32_16x16x32_bf16 v[128:131], v[48:51], v[64:67], 0
    v_add_u32 v16, 0x10000, v16
    v_cvt_pk_bf16_f32 v37, v37, v31
    v_mfma_f32_16x16x32_bf16 v[128:131], v[52:55], v[68:71], v[128:131]
    v_add_u32 v24, 0x10000, v24
    v_accvgpr_read_b32 v38, a140
    v_mfma_f32_16x16x32_bf16 v[132:135], v[48:51], v[72:75], 0
    ds_read_b128 v[96:99], v24 offset:16384
    v_accvgpr_read_b32 v31, a141
    v_mfma_f32_16x16x32_bf16 v[132:135], v[52:55], v[76:79], v[132:135]
    v_cvt_pk_bf16_f32 v38, v38, v31
    v_accvgpr_read_b32 v39, a142
    v_mfma_f32_16x16x32_bf16 v[136:139], v[48:51], v[80:83], 0
    s_add_u32 m0, s69, 2048
    v_accvgpr_read_b32 v31, a143
    v_cvt_pk_bf16_f32 v39, v39, v31
    v_mfma_f32_16x16x32_bf16 v[136:139], v[52:55], v[84:87], v[136:139]
    buffer_load_dwordx4 v8, s[32:35], s66 offen lds
    v_mfma_f32_16x16x32_bf16 v[140:143], v[48:51], v[88:91], 0
    ds_read_b64_tr_b16 v[48:49], v17 offset:0
    ds_read_b64_tr_b16 v[50:51], v17 offset:1024
    v_mfma_f32_16x16x32_bf16 v[140:143], v[52:55], v[92:95], v[140:143]
    ds_read_b64_tr_b16 v[52:53], v17 offset:8192
    ds_read_b64_tr_b16 v[54:55], v17 offset:9216
    v_mfma_f32_16x16x32_bf16 v[144:147], v[56:59], v[64:67], 0
    v_add_u32 v17, 0x10000, v17
    v_mfma_f32_16x16x32_bf16 v[144:147], v[60:63], v[68:71], v[144:147]
    buffer_store_dwordx4 v[36:39], v1, s[36:39], s72 offen sc1
    v_mfma_f32_16x16x32_bf16 v[148:151], v[56:59], v[72:75], 0
    s_add_u32 s72, s70, 0
    buffer_store_dwordx4 a[0:3], v1, s[36:39], s72 offen offset:0 sc1
    v_mfma_f32_16x16x32_bf16 v[148:151], v[60:63], v[76:79], v[148:151]
    s_add_u32 m0, s69, 3072
    v_mfma_f32_16x16x32_bf16 v[152:155], v[56:59], v[80:83], 0
    v_add_u32 v25, 0x10000, v25
    v_mfma_f32_16x16x32_bf16 v[152:155], v[60:63], v[84:87], v[152:155]
    buffer_load_dwordx4 v9, s[32:35], s66 offen lds
    v_mfma_f32_16x16x32_bf16 v[156:159], v[56:59], v[88:91], 0
    ds_read_b128 v[100:103], v25 offset:16384
    ds_read_b64_tr_b16 v[56:57], v18 offset:0
    v_mfma_f32_16x16x32_bf16 v[156:159], v[60:63], v[92:95], v[156:159]
    s_waitcnt lgkmcnt(2)
    ds_read_b64_tr_b16 v[58:59], v18 offset:1024
    ds_read_b64_tr_b16 v[60:61], v18 offset:8192
    v_mfma_f32_16x16x32_bf16 v[160:163], v[40:43], v[64:67], 0
    ds_read_b64_tr_b16 v[62:63], v18 offset:9216
    v_add_u32 v18, 0x10000, v18
    v_mfma_f32_16x16x32_bf16 v[160:163], v[44:47], v[68:71], v[160:163]
    v_mfma_f32_16x16x32_bf16 v[164:167], v[40:43], v[72:75], 0
    v_mfma_f32_16x16x32_bf16 v[164:167], v[44:47], v[76:79], v[164:167]
    s_add_u32 m0, s69, 16384
    v_mfma_f32_16x16x32_bf16 v[168:171], v[40:43], v[80:83], 0
    s_add_u32 s65, s65, s67
    buffer_load_dwordx4 v10, s[20:23], s64 offen lds
    v_mfma_f32_16x16x32_bf16 v[168:171], v[44:47], v[84:87], v[168:171]
    s_add_u32 s66, s66, s68
    v_mfma_f32_16x16x32_bf16 v[172:175], v[40:43], v[88:91], 0
    ds_read_b64_tr_b16 v[40:41], v19 offset:0
    ds_read_b64_tr_b16 v[42:43], v19 offset:1024
    v_mfma_f32_16x16x32_bf16 v[172:175], v[44:47], v[92:95], v[172:175]
    ds_read_b64_tr_b16 v[44:45], v19 offset:8192
    ds_read_b64_tr_b16 v[46:47], v19 offset:9216
    v_mfma_f32_16x16x32_bf16 v[176:179], v[48:51], v[64:67], 0
    ds_read_b128 v[104:107], v24 offset:24576
    v_add_u32 v19, 0x10000, v19
    v_mfma_f32_16x16x32_bf16 v[176:179], v[52:55], v[68:71], v[176:179]
    buffer_store_dwordx4 a[4:7], v1, s[36:39], s72 offen offset:1024 sc1
    v_mfma_f32_16x16x32_bf16 v[180:183], v[48:51], v[72:75], 0
    v_mfma_f32_16x16x32_bf16 v[180:183], v[52:55], v[76:79], v[180:183]
    buffer_load_dwordx4 v11, s[20:23], s64 offen offset:1024 lds
    v_mfma_f32_16x16x32_bf16 v[184:187], v[48:51], v[80:83], 0
    v_mfma_f32_16x16x32_bf16 v[184:187], v[52:55], v[84:87], v[184:187]
    v_mfma_f32_16x16x32_bf16 v[188:191], v[48:51], v[88:91], 0
    ds_read_b64_tr_b16 v[48:49], v20 offset:0
    ds_read_b64_tr_b16 v[50:51], v20 offset:1024
    v_mfma_f32_16x16x32_bf16 v[188:191], v[52:55], v[92:95], v[188:191]
    s_waitcnt lgkmcnt(2)
    ds_read_b64_tr_b16 v[52:53], v20 offset:8192
    ds_read_b64_tr_b16 v[54:55], v20 offset:9216
    v_mfma_f32_16x16x32_bf16 v[192:195], v[56:59], v[64:67], 0
    v_add_u32 v20, 0x10000, v20
    v_mfma_f32_16x16x32_bf16 v[192:195], v[60:63], v[68:71], v[192:195]
    s_add_u32 s72, s70, 4096
    v_mfma_f32_16x16x32_bf16 v[196:199], v[56:59], v[72:75], 0
    buffer_store_dwordx4 a[8:11], v1, s[36:39], s72 offen offset:0 sc1
    v_mfma_f32_16x16x32_bf16 v[196:199], v[60:63], v[76:79], v[196:199]
    buffer_load_dwordx4 v12, s[20:23], s64 offen offset:2048 lds
    v_mfma_f32_16x16x32_bf16 v[200:203], v[56:59], v[80:83], 0
    ds_read_b128 v[108:111], v25 offset:24576
    v_mfma_f32_16x16x32_bf16 v[200:203], v[60:63], v[84:87], v[200:203]
    v_mfma_f32_16x16x32_bf16 v[204:207], v[56:59], v[88:91], 0
    ds_read_b64_tr_b16 v[56:57], v21 offset:0
    ds_read_b64_tr_b16 v[58:59], v21 offset:1024
    v_mfma_f32_16x16x32_bf16 v[204:207], v[60:63], v[92:95], v[204:207]
    ds_read_b64_tr_b16 v[60:61], v21 offset:8192
    ds_read_b64_tr_b16 v[62:63], v21 offset:9216
    v_mfma_f32_16x16x32_bf16 v[208:211], v[40:43], v[64:67], 0
    v_add_u32 v21, 0x10000, v21
    v_mfma_f32_16x16x32_bf16 v[208:211], v[44:47], v[68:71], v[208:211]
    v_mfma_f32_16x16x32_bf16 v[212:215], v[40:43], v[72:75], 0
    buffer_load_dwordx4 v13, s[20:23], s64 offen offset:3072 lds
    v_mfma_f32_16x16x32_bf16 v[212:215], v[44:47], v[76:79], v[212:215]
    v_mfma_f32_16x16x32_bf16 v[216:219], v[40:43], v[80:83], 0
    v_mfma_f32_16x16x32_bf16 v[216:219], v[44:47], v[84:87], v[216:219]
    v_mfma_f32_16x16x32_bf16 v[220:223], v[40:43], v[88:91], 0
    buffer_store_dwordx4 a[12:15], v1, s[36:39], s72 offen offset:1024 sc1
    v_mfma_f32_16x16x32_bf16 v[220:223], v[44:47], v[92:95], v[220:223]
    s_waitcnt lgkmcnt(0)
    v_mfma_f32_16x16x32_bf16 v[224:227], v[48:51], v[64:67], 0
    v_mfma_f32_16x16x32_bf16 v[224:227], v[52:55], v[68:71], v[224:227]
    s_add_u32 s64, s64, 128
    v_mfma_f32_16x16x32_bf16 v[228:231], v[48:51], v[72:75], 0
    v_mfma_f32_16x16x32_bf16 v[228:231], v[52:55], v[76:79], v[228:231]
    v_mfma_f32_16x16x32_bf16 v[232:235], v[48:51], v[80:83], 0
    v_mfma_f32_16x16x32_bf16 v[232:235], v[52:55], v[84:87], v[232:235]
    s_waitcnt vmcnt(22)
    s_barrier
    ds_read_b64_tr_b16 v[40:41], v26 offset:32768
    v_mfma_f32_16x16x32_bf16 v[236:239], v[48:51], v[88:91], 0
    s_add_u32 m0, s69, 32768
    ds_read_b64_tr_b16 v[42:43], v26 offset:33344
    ds_read_b64_tr_b16 v[44:45], v26 offset:37376
    v_mfma_f32_16x16x32_bf16 v[236:239], v[52:55], v[92:95], v[236:239]
    buffer_load_dwordx4 v2, s[24:27], s60 offen lds
    v_mfma_f32_16x16x32_bf16 v[240:243], v[56:59], v[64:67], 0
    ds_read_b64_tr_b16 v[46:47], v26 offset:37952
    ds_read_b128 a[136:139], v22 offset:32768
    v_mfma_f32_16x16x32_bf16 v[240:243], v[60:63], v[68:71], v[240:243]
    s_add_u32 s72, s70, 8192
    ds_read_b128 a[140:143], v23 offset:32768
    ds_read_b64_tr_b16 v[48:49], v27 offset:32768
    v_mfma_f32_16x16x32_bf16 v[244:247], v[56:59], v[72:75], 0
    buffer_load_dwordx4 v3, s[24:27], s60 offen offset:1024 lds
    v_mfma_f32_16x16x32_bf16 v[244:247], v[60:63], v[76:79], v[244:247]
    ds_read_b64_tr_b16 v[50:51], v27 offset:33344
    ds_read_b64_tr_b16 v[52:53], v27 offset:37376
    v_mfma_f32_16x16x32_bf16 v[248:251], v[56:59], v[80:83], 0
    ds_read_b64_tr_b16 v[54:55], v27 offset:37952
    v_add_u32 v26, 0xffff0000, v26
    v_mfma_f32_16x16x32_bf16 v[248:251], v[60:63], v[84:87], v[248:251]
    v_add_u32 v22, 0xffff0000, v22
    v_add_u32 v23, 0xffff0000, v23
    v_mfma_f32_16x16x32_bf16 v[252:255], v[56:59], v[88:91], 0
    buffer_load_dwordx4 v4, s[24:27], s60 offen offset:2048 lds
    v_mfma_f32_16x16x32_bf16 v[252:255], v[60:63], v[92:95], v[252:255]
    s_waitcnt lgkmcnt(3)
    ds_read_b64_tr_b16 v[56:57], v28 offset:32768
    ds_read_b64_tr_b16 v[58:59], v28 offset:33344
    v_mfma_f32_16x16x32_bf16 a[64:67], v[40:43], v[64:67], 0
    ds_read_b64_tr_b16 v[60:61], v28 offset:37376
    ds_read_b64_tr_b16 v[62:63], v28 offset:37952
    v_mfma_f32_16x16x32_bf16 a[64:67], v[44:47], v[68:71], a[64:67]
    v_add_u32 v27, 0xffff0000, v27
    v_add_u32 v28, 0xffff0000, v28
    v_mfma_f32_16x16x32_bf16 a[68:71], v[40:43], v[72:75], 0
    buffer_load_dwordx4 v5, s[24:27], s60 offen offset:3072 lds
    v_mfma_f32_16x16x32_bf16 a[68:71], v[44:47], v[76:79], a[68:71]
    ds_read_b128 v[112:115], v24 offset:49152
    v_mfma_f32_16x16x32_bf16 a[72:75], v[40:43], v[80:83], 0
    buffer_store_dwordx4 a[16:19], v1, s[36:39], s72 offen offset:0 sc1
    v_mfma_f32_16x16x32_bf16 a[72:75], v[44:47], v[84:87], a[72:75]
    s_add_u32 m0, s69, 49152
    v_mfma_f32_16x16x32_bf16 a[76:79], v[40:43], v[88:91], 0
    s_add_u32 s60, s60, 524288
    buffer_load_dwordx4 v10, s[20:23], s63 offen lds
    v_mfma_f32_16x16x32_bf16 a[76:79], v[44:47], v[92:95], a[76:79]
    ds_read_b128 v[116:119], v25 offset:49152
    v_mfma_f32_16x16x32_bf16 a[128:131], v[40:43], a[136:139], 0
    ds_read_b64_tr_b16 v[40:41], v29 offset:32768
    ds_read_b64_tr_b16 v[42:43], v29 offset:33344
    v_mfma_f32_16x16x32_bf16 a[128:131], v[44:47], a[140:143], a[128:131]
    s_mov_b64 exec, s[86:87]
    ds_read_b128 v[40:43], v30 offset:32768
    s_mov_b64 exec, -1
    s_waitcnt lgkmcnt(4)
    v_mfma_f32_16x16x32_bf16 a[80:83], v[48:51], v[64:67], 0
    buffer_load_dwordx4 v11, s[20:23], s63 offen offset:1024 lds
    v_mfma_f32_16x16x32_bf16 a[80:83], v[52:55], v[68:71], a[80:83]
    ds_read_b128 v[120:123], v24 offset:57344
    ds_read_b64_tr_b16 v[44:45], v29 offset:37376
    v_mfma_f32_16x16x32_bf16 a[84:87], v[48:51], v[72:75], 0
    ds_read_b64_tr_b16 v[46:47], v29 offset:37952
    v_add_u32 v29, 0xffff0000, v29
    v_mfma_f32_16x16x32_bf16 a[84:87], v[52:55], v[76:79], a[84:87]
    s_mov_b64 exec, s[86:87]
    ds_read_b128 v[44:47], v30 offset:32832
    s_mov_b64 exec, -1
    v_mfma_f32_16x16x32_bf16 a[88:91], v[48:51], v[80:83], 0
    buffer_load_dwordx4 v12, s[20:23], s63 offen offset:2048 lds
    v_mfma_f32_16x16x32_bf16 a[88:91], v[52:55], v[84:87], a[88:91]
    ds_read_b128 v[124:127], v25 offset:57344
    v_add_u32 v30, 0xffff0000, v30
    v_mfma_f32_16x16x32_bf16 a[92:95], v[48:51], v[88:91], 0
    buffer_store_dwordx4 a[20:23], v1, s[36:39], s72 offen offset:1024 sc1
    v_mfma_f32_16x16x32_bf16 a[92:95], v[52:55], v[92:95], a[92:95]
    s_add_u32 s72, s70, 12288
    v_mfma_f32_16x16x32_bf16 a[132:135], v[48:51], a[136:139], 0
    buffer_load_dwordx4 v13, s[20:23], s63 offen offset:3072 lds
    v_mfma_f32_16x16x32_bf16 a[132:135], v[52:55], a[140:143], a[132:135]
    buffer_store_dwordx4 a[24:27], v1, s[36:39], s72 offen offset:0 sc1
    v_mfma_f32_16x16x32_bf16 a[96:99], v[56:59], v[64:67], 0
    v_mfma_f32_16x16x32_bf16 a[96:99], v[60:63], v[68:71], a[96:99]
    s_add_u32 s63, s63, 128
    v_mfma_f32_16x16x32_bf16 a[100:103], v[56:59], v[72:75], 0
    v_mfma_f32_16x16x32_bf16 a[100:103], v[60:63], v[76:79], a[100:103]
    v_mfma_f32_16x16x32_bf16 a[104:107], v[56:59], v[80:83], 0
    v_mfma_f32_16x16x32_bf16 a[104:107], v[60:63], v[84:87], a[104:107]
    s_waitcnt vmcnt(25)
    s_barrier
    ds_read_b64_tr_b16 v[48:49], v14 offset:0
    v_mfma_f32_16x16x32_bf16 a[108:111], v[56:59], v[88:91], 0
    s_add_u32 m0, s69, 65536
    ds_read_b64_tr_b16 v[50:51], v14 offset:1024
    ds_read_b64_tr_b16 v[52:53], v14 offset:8192
    v_mfma_f32_16x16x32_bf16 a[108:111], v[60:63], v[92:95], a[108:111]
    s_waitcnt lgkmcnt(3)
    buffer_load_dwordx4 v6, s[28:31], s65 offen lds
    v_mfma_f32_16x16x32_bf16 a[112:115], v[40:43], v[64:67], 0
    ds_read_b64_tr_b16 v[54:55], v14 offset:9216
    ds_read_b64_tr_b16 v[56:57], v15 offset:0
    v_mfma_f32_16x16x32_bf16 a[112:115], v[44:47], v[68:71], a[112:115]
    ds_read_b64_tr_b16 v[58:59], v15 offset:1024
    ds_read_b64_tr_b16 v[60:61], v15 offset:8192
    v_mfma_f32_16x16x32_bf16 a[116:119], v[40:43], v[72:75], 0
    ds_read_b64_tr_b16 v[62:63], v15 offset:9216
    v_add_u32 v14, 0xfffe0000, v14
    v_mfma_f32_16x16x32_bf16 a[116:119], v[44:47], v[76:79], a[116:119]
    v_add_u32 v15, 0xfffe0000, v15
    v_mfma_f32_16x16x32_bf16 a[120:123], v[40:43], v[80:83], 0
    s_add_u32 m0, s69, 66560
    buffer_store_dwordx4 a[28:31], v1, s[36:39], s72 offen offset:1024 sc1
    v_mfma_f32_16x16x32_bf16 a[120:123], v[44:47], v[84:87], a[120:123]
    buffer_load_dwordx4 v7, s[32:35], s66 offen lds
    v_mfma_f32_16x16x32_bf16 a[124:127], v[40:43], v[88:91], 0
    ds_read_b64_tr_b16 v[40:41], v16 offset:0
    ds_read_b64_tr_b16 v[42:43], v16 offset:1024
    v_mfma_f32_16x16x32_bf16 a[124:127], v[44:47], v[92:95], a[124:127]
    s_waitcnt lgkmcnt(2)
    ds_read_b64_tr_b16 v[44:45], v16 offset:8192
    ds_read_b64_tr_b16 v[46:47], v16 offset:9216
    v_mfma_f32_16x16x32_bf16 v[128:131], v[48:51], v[96:99], v[128:131]
    v_add_u32 v16, 0xfffe0000, v16
    v_mfma_f32_16x16x32_bf16 v[128:131], v[52:55], v[100:103], v[128:131]
    v_add_u32 v24, 0x10000, v24
    v_mfma_f32_16x16x32_bf16 v[132:135], v[48:51], v[104:107], v[132:135]
    ds_read_b128 v[64:67], v24 offset:16384
    v_mfma_f32_16x16x32_bf16 v[132:135], v[52:55], v[108:111], v[132:135]
    v_mfma_f32_16x16x32_bf16 v[136:139], v[48:51], v[112:115], v[136:139]
    s_add_u32 m0, s69, 67584
    v_mfma_f32_16x16x32_bf16 v[136:139], v[52:55], v[116:119], v[136:139]
    s_add_u32 s72, s70, 32768
    buffer_load_dwordx4 v8, s[32:35], s66 offen lds
    v_mfma_f32_16x16x32_bf16 v[140:143], v[48:51], v[120:123], v[140:143]
    ds_read_b64_tr_b16 v[48:49], v17 offset:0
    ds_read_b64_tr_b16 v[50:51], v17 offset:1024
    v_mfma_f32_16x16x32_bf16 v[140:143], v[52:55], v[124:127], v[140:143]
    ds_read_b64_tr_b16 v[52:53], v17 offset:8192
    ds_read_b64_tr_b16 v[54:55], v17 offset:9216
    v_mfma_f32_16x16x32_bf16 v[144:147], v[56:59], v[96:99], v[144:147]
    v_add_u32 v17, 0xfffe0000, v17
    v_mfma_f32_16x16x32_bf16 v[144:147], v[60:63], v[100:103], v[144:147]
    buffer_store_dwordx4 a[32:35], v1, s[36:39], s72 offen offset:0 sc1
    v_mfma_f32_16x16x32_bf16 v[148:151], v[56:59], v[104:107], v[148:151]
    v_mfma_f32_16x16x32_bf16 v[148:151], v[60:63], v[108:111], v[148:151]
    s_add_u32 m0, s69, 68608
    v_mfma_f32_16x16x32_bf16 v[152:155], v[56:59], v[112:115], v[152:155]
    v_add_u32 v25, 0x10000, v25
    v_mfma_f32_16x16x32_bf16 v[152:155], v[60:63], v[116:119], v[152:155]
    buffer_load_dwordx4 v9, s[32:35], s66 offen lds
    v_mfma_f32_16x16x32_bf16 v[156:159], v[56:59], v[120:123], v[156:159]
    ds_read_b128 v[68:71], v25 offset:16384
    ds_read_b64_tr_b16 v[56:57], v18 offset:0
    v_mfma_f32_16x16x32_bf16 v[156:159], v[60:63], v[124:127], v[156:159]
    s_waitcnt lgkmcnt(2)
    ds_read_b64_tr_b16 v[58:59], v18 offset:1024
    ds_read_b64_tr_b16 v[60:61], v18 offset:8192
    v_mfma_f32_16x16x32_bf16 v[160:163], v[40:43], v[96:99], v[160:163]
    ds_read_b64_tr_b16 v[62:63], v18 offset:9216
    v_add_u32 v18, 0xfffe0000, v18
    v_mfma_f32_16x16x32_bf16 v[160:163], v[44:47], v[100:103], v[160:163]
    v_mfma_f32_16x16x32_bf16 v[164:167], v[40:43], v[104:107], v[164:167]
    buffer_store_dwordx4 a[36:39], v1, s[36:39], s72 offen offset:1024 sc1
    v_mfma_f32_16x16x32_bf16 v[164:167], v[44:47], v[108:111], v[164:167]
    s_add_u32 m0, s69, 81920
    v_mfma_f32_16x16x32_bf16 v[168:171], v[40:43], v[112:115], v[168:171]
    s_add_u32 s65, s65, s67
    buffer_load_dwordx4 v10, s[20:23], s64 offen lds
    v_mfma_f32_16x16x32_bf16 v[168:171], v[44:47], v[116:119], v[168:171]
    s_add_u32 s66, s66, s68
    v_mfma_f32_16x16x32_bf16 v[172:175], v[40:43], v[120:123], v[172:175]
    ds_read_b64_tr_b16 v[40:41], v19 offset:0
    ds_read_b64_tr_b16 v[42:43], v19 offset:1024
    v_mfma_f32_16x16x32_bf16 v[172:175], v[44:47], v[124:127], v[172:175]
    ds_read_b64_tr_b16 v[44:45], v19 offset:8192
    ds_read_b64_tr_b16 v[46:47], v19 offset:9216
    v_mfma_f32_16x16x32_bf16 v[176:179], v[48:51], v[96:99], v[176:179]
    ds_read_b128 v[72:75], v24 offset:24576
    v_add_u32 v19, 0xfffe0000, v19
    v_mfma_f32_16x16x32_bf16 v[176:179], v[52:55], v[100:103], v[176:179]
    v_mfma_f32_16x16x32_bf16 v[180:183], v[48:51], v[104:107], v[180:183]
    v_mfma_f32_16x16x32_bf16 v[180:183], v[52:55], v[108:111], v[180:183]
    buffer_load_dwordx4 v11, s[20:23], s64 offen offset:1024 lds
    v_mfma_f32_16x16x32_bf16 v[184:187], v[48:51], v[112:115], v[184:187]
    v_mfma_f32_16x16x32_bf16 v[184:187], v[52:55], v[116:119], v[184:187]
    s_add_u32 s72, s70, 36864
    v_mfma_f32_16x16x32_bf16 v[188:191], v[48:51], v[120:123], v[188:191]
    ds_read_b64_tr_b16 v[48:49], v20 offset:0
    ds_read_b64_tr_b16 v[50:51], v20 offset:1024
    v_mfma_f32_16x16x32_bf16 v[188:191], v[52:55], v[124:127], v[188:191]
    s_waitcnt lgkmcnt(2)
    ds_read_b64_tr_b16 v[52:53], v20 offset:8192
    ds_read_b64_tr_b16 v[54:55], v20 offset:9216
    v_mfma_f32_16x16x32_bf16 v[192:195], v[56:59], v[96:99], v[192:195]
    v_add_u32 v20, 0xfffe0000, v20
    v_mfma_f32_16x16x32_bf16 v[192:195], v[60:63], v[100:103], v[192:195]
    buffer_store_dwordx4 a[40:43], v1, s[36:39], s72 offen offset:0 sc1
    v_mfma_f32_16x16x32_bf16 v[196:199], v[56:59], v[104:107], v[196:199]
    v_mfma_f32_16x16x32_bf16 v[196:199], v[60:63], v[108:111], v[196:199]
    buffer_load_dwordx4 v12, s[20:23], s64 offen offset:2048 lds
    v_mfma_f32_16x16x32_bf16 v[200:203], v[56:59], v[112:115], v[200:203]
    ds_read_b128 v[76:79], v25 offset:24576
    v_mfma_f32_16x16x32_bf16 v[200:203], v[60:63], v[116:119], v[200:203]
    v_mfma_f32_16x16x32_bf16 v[204:207], v[56:59], v[120:123], v[204:207]
    ds_read_b64_tr_b16 v[56:57], v21 offset:0
    ds_read_b64_tr_b16 v[58:59], v21 offset:1024
    v_mfma_f32_16x16x32_bf16 v[204:207], v[60:63], v[124:127], v[204:207]
    ds_read_b64_tr_b16 v[60:61], v21 offset:8192
    ds_read_b64_tr_b16 v[62:63], v21 offset:9216
    v_mfma_f32_16x16x32_bf16 v[208:211], v[40:43], v[96:99], v[208:211]
    v_add_u32 v21, 0xfffe0000, v21
    v_mfma_f32_16x16x32_bf16 v[208:211], v[44:47], v[100:103], v[208:211]
    v_mfma_f32_16x16x32_bf16 v[212:215], v[40:43], v[104:107], v[212:215]
    buffer_load_dwordx4 v13, s[20:23], s64 offen offset:3072 lds
    v_mfma_f32_16x16x32_bf16 v[212:215], v[44:47], v[108:111], v[212:215]
    buffer_store_dwordx4 a[44:47], v1, s[36:39], s72 offen offset:1024 sc1
    v_mfma_f32_16x16x32_bf16 v[216:219], v[40:43], v[112:115], v[216:219]
    v_mfma_f32_16x16x32_bf16 v[216:219], v[44:47], v[116:119], v[216:219]
    v_mfma_f32_16x16x32_bf16 v[220:223], v[40:43], v[120:123], v[220:223]
    v_mfma_f32_16x16x32_bf16 v[220:223], v[44:47], v[124:127], v[220:223]
    s_waitcnt lgkmcnt(0)
    v_mfma_f32_16x16x32_bf16 v[224:227], v[48:51], v[96:99], v[224:227]
    v_mfma_f32_16x16x32_bf16 v[224:227], v[52:55], v[100:103], v[224:227]
    s_add_u32 s64, s64, 128
    v_mfma_f32_16x16x32_bf16 v[228:231], v[48:51], v[104:107], v[228:231]
    v_mfma_f32_16x16x32_bf16 v[228:231], v[52:55], v[108:111], v[228:231]
    v_mfma_f32_16x16x32_bf16 v[232:235], v[48:51], v[112:115], v[232:235]
    v_mfma_f32_16x16x32_bf16 v[232:235], v[52:55], v[116:119], v[232:235]
    s_waitcnt vmcnt(25)
    s_barrier
    ds_read_b64_tr_b16 v[40:41], v26 offset:0
    v_mfma_f32_16x16x32_bf16 v[236:239], v[48:51], v[120:123], v[236:239]
    s_add_u32 m0, s69, 98304
    ds_read_b64_tr_b16 v[42:43], v26 offset:576
    ds_read_b64_tr_b16 v[44:45], v26 offset:4608
    v_mfma_f32_16x16x32_bf16 v[236:239], v[52:55], v[124:127], v[236:239]
    s_add_u32 s72, s70, 40960
    buffer_load_dwordx4 v2, s[24:27], s60 offen lds
    v_mfma_f32_16x16x32_bf16 v[240:243], v[56:59], v[96:99], v[240:243]
    ds_read_b64_tr_b16 v[46:47], v26 offset:5184
    ds_read_b128 a[136:139], v22 offset:0
    v_mfma_f32_16x16x32_bf16 v[240:243], v[60:63], v[100:103], v[240:243]
    ds_read_b128 a[140:143], v23 offset:0
    ds_read_b64_tr_b16 v[48:49], v27 offset:0
    v_mfma_f32_16x16x32_bf16 v[244:247], v[56:59], v[104:107], v[244:247]
    buffer_load_dwordx4 v3, s[24:27], s60 offen offset:1024 lds
    v_mfma_f32_16x16x32_bf16 v[244:247], v[60:63], v[108:111], v[244:247]
    ds_read_b64_tr_b16 v[50:51], v27 offset:576
    ds_read_b64_tr_b16 v[52:53], v27 offset:4608
    v_mfma_f32_16x16x32_bf16 v[248:251], v[56:59], v[112:115], v[248:251]
    ds_read_b64_tr_b16 v[54:55], v27 offset:5184
    v_add_u32 v26, 0x10000, v26
    v_mfma_f32_16x16x32_bf16 v[248:251], v[60:63], v[116:119], v[248:251]
    v_add_u32 v22, 0x10000, v22
    v_add_u32 v23, 0x10000, v23
    v_mfma_f32_16x16x32_bf16 v[252:255], v[56:59], v[120:123], v[252:255]
    buffer_load_dwordx4 v4, s[24:27], s60 offen offset:2048 lds
    v_mfma_f32_16x16x32_bf16 v[252:255], v[60:63], v[124:127], v[252:255]
    s_waitcnt lgkmcnt(3)
    ds_read_b64_tr_b16 v[56:57], v28 offset:0
    ds_read_b64_tr_b16 v[58:59], v28 offset:576
    v_mfma_f32_16x16x32_bf16 a[64:67], v[40:43], v[96:99], a[64:67]
    ds_read_b64_tr_b16 v[60:61], v28 offset:4608
    ds_read_b64_tr_b16 v[62:63], v28 offset:5184
    v_mfma_f32_16x16x32_bf16 a[64:67], v[44:47], v[100:103], a[64:67]
    v_add_u32 v24, 0xfffe0000, v24
    v_add_u32 v27, 0x10000, v27
    v_mfma_f32_16x16x32_bf16 a[68:71], v[40:43], v[104:107], a[68:71]
    buffer_load_dwordx4 v5, s[24:27], s60 offen offset:3072 lds
    v_mfma_f32_16x16x32_bf16 a[68:71], v[44:47], v[108:111], a[68:71]
    ds_read_b128 v[80:83], v24 offset:16384
    v_add_u32 v28, 0x10000, v28
    v_mfma_f32_16x16x32_bf16 a[72:75], v[40:43], v[112:115], a[72:75]
    buffer_store_dwordx4 a[48:51], v1, s[36:39], s72 offen offset:0 sc1
    v_mfma_f32_16x16x32_bf16 a[72:75], v[44:47], v[116:119], a[72:75]
    s_add_u32 m0, s69, 114688
    v_add_u32 v25, 0xfffe0000, v25
    v_mfma_f32_16x16x32_bf16 a[76:79], v[40:43], v[120:123], a[76:79]
    s_add_u32 s60, s60, 524288
    buffer_load_dwordx4 v10, s[20:23], s63 offen lds
    v_mfma_f32_16x16x32_bf16 a[76:79], v[44:47], v[124:127], a[76:79]
    ds_read_b128 v[84:87], v25 offset:16384
    v_mfma_f32_16x16x32_bf16 a[128:131], v[40:43], a[136:139], a[128:131]
    ds_read_b64_tr_b16 v[40:41], v29 offset:0
    ds_read_b64_tr_b16 v[42:43], v29 offset:576
    v_mfma_f32_16x16x32_bf16 a[128:131], v[44:47], a[140:143], a[128:131]
    s_mov_b64 exec, s[86:87]
    ds_read_b128 v[40:43], v30 offset:0
    s_mov_b64 exec, -1
    s_waitcnt lgkmcnt(4)
    v_mfma_f32_16x16x32_bf16 a[80:83], v[48:51], v[96:99], a[80:83]
    buffer_load_dwordx4 v11, s[20:23], s63 offen offset:1024 lds
    v_mfma_f32_16x16x32_bf16 a[80:83], v[52:55], v[100:103], a[80:83]
    ds_read_b128 v[88:91], v24 offset:24576
    ds_read_b64_tr_b16 v[44:45], v29 offset:4608
    v_mfma_f32_16x16x32_bf16 a[84:87], v[48:51], v[104:107], a[84:87]
    ds_read_b64_tr_b16 v[46:47], v29 offset:5184
    v_add_u32 v29, 0x10000, v29
    v_mfma_f32_16x16x32_bf16 a[84:87], v[52:55], v[108:111], a[84:87]
    s_mov_b64 exec, s[86:87]
    ds_read_b128 v[44:47], v30 offset:64
    s_mov_b64 exec, -1
    v_mfma_f32_16x16x32_bf16 a[88:91], v[48:51], v[112:115], a[88:91]
    buffer_load_dwordx4 v12, s[20:23], s63 offen offset:2048 lds
    v_mfma_f32_16x16x32_bf16 a[88:91], v[52:55], v[116:119], a[88:91]
    ds_read_b128 v[92:95], v25 offset:24576
    v_add_u32 v30, 0x10000, v30
    v_mfma_f32_16x16x32_bf16 a[92:95], v[48:51], v[120:123], a[92:95]
    buffer_store_dwordx4 a[52:55], v1, s[36:39], s72 offen offset:1024 sc1
    v_mfma_f32_16x16x32_bf16 a[92:95], v[52:55], v[124:127], a[92:95]
    s_add_u32 s72, s70, 45056
    buffer_store_dwordx4 a[56:59], v1, s[36:39], s72 offen offset:0 sc1
    v_mfma_f32_16x16x32_bf16 a[132:135], v[48:51], a[136:139], a[132:135]
    s_mul_i32 s70, s7, 36864
    buffer_load_dwordx4 v13, s[20:23], s63 offen offset:3072 lds
    v_mfma_f32_16x16x32_bf16 a[132:135], v[52:55], a[140:143], a[132:135]
    s_add_u32 s70, s70, s99
    v_mfma_f32_16x16x32_bf16 a[96:99], v[56:59], v[96:99], a[96:99]
    s_lshr_b32 s99, s69, 5
    v_mfma_f32_16x16x32_bf16 a[96:99], v[60:63], v[100:103], a[96:99]
    s_add_u32 s63, s63, 128
    v_mfma_f32_16x16x32_bf16 a[100:103], v[56:59], v[104:107], a[100:103]
    s_add_u32 s99, s99, s98
    v_mfma_f32_16x16x32_bf16 a[100:103], v[60:63], v[108:111], a[100:103]
    s_mul_hi_u32 s7, s2, 715827883
    v_mfma_f32_16x16x32_bf16 a[104:107], v[56:59], v[112:115], a[104:107]
    s_mul_i32 s3, s7, 6
    v_mfma_f32_16x16x32_bf16 a[104:107], v[60:63], v[116:119], a[104:107]
    s_waitcnt vmcnt(25)
    s_barrier
    ds_read_b64_tr_b16 v[48:49], v14 offset:32768
    v_mfma_f32_16x16x32_bf16 a[108:111], v[56:59], v[120:123], a[108:111]
    s_add_u32 m0, s69, 131072
    ds_read_b64_tr_b16 v[50:51], v14 offset:33792
    ds_read_b64_tr_b16 v[52:53], v14 offset:40960
    v_mfma_f32_16x16x32_bf16 a[108:111], v[60:63], v[124:127], a[108:111]
    s_sub_u32 s3, s2, s3
    buffer_load_dwordx4 v6, s[28:31], s65 offen lds
    s_waitcnt lgkmcnt(3)
    v_mfma_f32_16x16x32_bf16 a[112:115], v[40:43], v[96:99], a[112:115]
    s_mul_i32 s3, s3, 6
    ds_read_b64_tr_b16 v[54:55], v14 offset:41984
    ds_read_b64_tr_b16 v[56:57], v15 offset:32768
    v_mfma_f32_16x16x32_bf16 a[112:115], v[44:47], v[100:103], a[112:115]
    s_lshl1_add_u32 s3, s4, s3
    ds_read_b64_tr_b16 v[58:59], v15 offset:33792
    ds_read_b64_tr_b16 v[60:61], v15 offset:40960
    v_mfma_f32_16x16x32_bf16 a[116:119], v[40:43], v[104:107], a[116:119]
    s_sub_u32 s3, s3, 2
    ds_read_b64_tr_b16 v[62:63], v15 offset:41984
    v_add_u32 v14, 0x10000, v14
    v_mfma_f32_16x16x32_bf16 a[116:119], v[44:47], v[108:111], a[116:119]
    v_add_u32 v15, 0x10000, v15
    v_accvgpr_read_b32 v32, a144
    v_mfma_f32_16x16x32_bf16 a[120:123], v[40:43], v[112:115], a[120:123]
    s_add_u32 m0, s69, 132096
    buffer_store_dwordx4 a[60:63], v1, s[36:39], s72 offen offset:1024 sc1
    v_mfma_f32_16x16x32_bf16 a[120:123], v[44:47], v[116:119], a[120:123]
    buffer_load_dwordx4 v7, s[32:35], s66 offen lds
    v_mfma_f32_16x16x32_bf16 a[124:127], v[40:43], v[120:123], a[124:127]
    ds_read_b64_tr_b16 v[40:41], v16 offset:32768
    ds_read_b64_tr_b16 v[42:43], v16 offset:33792
    v_mfma_f32_16x16x32_bf16 a[124:127], v[44:47], v[124:127], a[124:127]
    s_waitcnt lgkmcnt(2)
    ds_read_b64_tr_b16 v[44:45], v16 offset:40960
    ds_read_b64_tr_b16 v[46:47], v16 offset:41984
    v_mfma_f32_16x16x32_bf16 v[128:131], v[48:51], v[64:67], v[128:131]
    v_add_u32 v16, 0x10000, v16
    v_accvgpr_read_b32 v31, a145
    v_mfma_f32_16x16x32_bf16 v[128:131], v[52:55], v[68:71], v[128:131]
    s_add_u32 s72, s71, 32768
    v_cvt_pk_bf16_f32 v32, v32, v31
    v_accvgpr_read_b32 v33, a146
    v_mfma_f32_16x16x32_bf16 v[132:135], v[48:51], v[72:75], v[132:135]
    ds_read_b128 v[96:99], v24 offset:49152
    v_accvgpr_read_b32 v31, a147
    v_mfma_f32_16x16x32_bf16 v[132:135], v[52:55], v[76:79], v[132:135]
    v_cvt_pk_bf16_f32 v33, v33, v31
    v_accvgpr_read_b32 v34, a148
    v_mfma_f32_16x16x32_bf16 v[136:139], v[48:51], v[80:83], v[136:139]
    s_add_u32 m0, s69, 133120
    v_accvgpr_read_b32 v31, a149
    v_cvt_pk_bf16_f32 v34, v34, v31
    v_mfma_f32_16x16x32_bf16 v[136:139], v[52:55], v[84:87], v[136:139]
    buffer_load_dwordx4 v8, s[32:35], s66 offen lds
    v_mfma_f32_16x16x32_bf16 v[140:143], v[48:51], v[88:91], v[140:143]
    ds_read_b64_tr_b16 v[48:49], v17 offset:32768
    ds_read_b64_tr_b16 v[50:51], v17 offset:33792
    v_mfma_f32_16x16x32_bf16 v[140:143], v[52:55], v[92:95], v[140:143]
    ds_read_b64_tr_b16 v[52:53], v17 offset:40960
    ds_read_b64_tr_b16 v[54:55], v17 offset:41984
    v_mfma_f32_16x16x32_bf16 v[144:147], v[56:59], v[64:67], v[144:147]
    v_add_u32 v17, 0x10000, v17
    v_accvgpr_read_b32 v35, a150
    v_mfma_f32_16x16x32_bf16 v[144:147], v[60:63], v[68:71], v[144:147]
    v_accvgpr_read_b32 v31, a151
    v_cvt_pk_bf16_f32 v35, v35, v31
    v_mfma_f32_16x16x32_bf16 v[148:151], v[56:59], v[72:75], v[148:151]
    buffer_store_dwordx4 v[32:35], v1, s[36:39], s72 offen sc1
    v_mfma_f32_16x16x32_bf16 v[148:151], v[60:63], v[76:79], v[148:151]
    s_add_u32 m0, s69, 134144
    v_accvgpr_read_b32 v36, a152
    v_accvgpr_read_b32 v31, a153
    v_mfma_f32_16x16x32_bf16 v[152:155], v[56:59], v[80:83], v[152:155]
    buffer_load_dwordx4 v9, s[32:35], s66 offen lds
    v_mfma_f32_16x16x32_bf16 v[152:155], v[60:63], v[84:87], v[152:155]
    ds_read_b128 v[100:103], v25 offset:49152
    v_cvt_pk_bf16_f32 v36, v36, v31
    v_mfma_f32_16x16x32_bf16 v[156:159], v[56:59], v[88:91], v[156:159]
    ds_read_b64_tr_b16 v[56:57], v18 offset:32768
    ds_read_b64_tr_b16 v[58:59], v18 offset:33792
    v_mfma_f32_16x16x32_bf16 v[156:159], v[60:63], v[92:95], v[156:159]
    s_add_u32 s72, s71, 33792
    ds_read_b64_tr_b16 v[60:61], v18 offset:40960
    ds_read_b64_tr_b16 v[62:63], v18 offset:41984
    s_waitcnt lgkmcnt(5)
    v_mfma_f32_16x16x32_bf16 v[160:163], v[40:43], v[64:67], v[160:163]
    v_add_u32 v18, 0x10000, v18
    v_accvgpr_read_b32 v37, a154
    v_mfma_f32_16x16x32_bf16 v[160:163], v[44:47], v[68:71], v[160:163]
    v_accvgpr_read_b32 v31, a155
    v_cvt_pk_bf16_f32 v37, v37, v31
    v_mfma_f32_16x16x32_bf16 v[164:167], v[40:43], v[72:75], v[164:167]
    v_accvgpr_read_b32 v38, a156
    v_accvgpr_read_b32 v31, a157
    v_mfma_f32_16x16x32_bf16 v[164:167], v[44:47], v[76:79], v[164:167]
    s_add_u32 m0, s69, 147456
    v_cvt_pk_bf16_f32 v38, v38, v31
    v_accvgpr_read_b32 v39, a158
    v_mfma_f32_16x16x32_bf16 v[168:171], v[40:43], v[80:83], v[168:171]
    s_add_u32 s65, s65, s67
    buffer_load_dwordx4 v10, s[20:23], s64 offen lds
    v_mfma_f32_16x16x32_bf16 v[168:171], v[44:47], v[84:87], v[168:171]
    s_add_u32 s66, s66, s68
    v_accvgpr_read_b32 v31, a159
    v_cvt_pk_bf16_f32 v39, v39, v31
    v_mfma_f32_16x16x32_bf16 v[172:175], v[40:43], v[88:91], v[172:175]
    ds_read_b64_tr_b16 v[40:41], v19 offset:32768
    ds_read_b64_tr_b16 v[42:43], v19 offset:33792
    v_mfma_f32_16x16x32_bf16 v[172:175], v[44:47], v[92:95], v[172:175]
    ds_read_b64_tr_b16 v[44:45], v19 offset:40960
    ds_read_b64_tr_b16 v[46:47], v19 offset:41984
    v_mfma_f32_16x16x32_bf16 v[176:179], v[48:51], v[64:67], v[176:179]
    ds_read_b128 v[104:107], v24 offset:57344
    v_add_u32 v19, 0x10000, v19
    v_mfma_f32_16x16x32_bf16 v[176:179], v[52:55], v[68:71], v[176:179]
    buffer_store_dwordx4 v[36:39], v1, s[36:39], s72 offen sc1
    v_mfma_f32_16x16x32_bf16 v[180:183], v[48:51], v[72:75], v[180:183]
    v_accvgpr_read_b32 v32, a160
    v_accvgpr_read_b32 v31, a161
    v_mfma_f32_16x16x32_bf16 v[180:183], v[52:55], v[76:79], v[180:183]
    buffer_load_dwordx4 v11, s[20:23], s64 offen offset:1024 lds
    v_mfma_f32_16x16x32_bf16 v[184:187], v[48:51], v[80:83], v[184:187]
    v_cvt_pk_bf16_f32 v32, v32, v31
    v_accvgpr_read_b32 v33, a162
    v_mfma_f32_16x16x32_bf16 v[184:187], v[52:55], v[84:87], v[184:187]
    s_add_u32 s72, s71, 2048
    v_accvgpr_read_b32 v31, a163
    v_cvt_pk_bf16_f32 v33, v33, v31
    v_mfma_f32_16x16x32_bf16 v[188:191], v[48:51], v[88:91], v[188:191]
    ds_read_b64_tr_b16 v[48:49], v20 offset:32768
    ds_read_b64_tr_b16 v[50:51], v20 offset:33792
    v_mfma_f32_16x16x32_bf16 v[188:191], v[52:55], v[92:95], v[188:191]
    s_waitcnt lgkmcnt(2)
    ds_read_b64_tr_b16 v[52:53], v20 offset:40960
    ds_read_b64_tr_b16 v[54:55], v20 offset:41984
    v_mfma_f32_16x16x32_bf16 v[192:195], v[56:59], v[64:67], v[192:195]
    v_add_u32 v20, 0x10000, v20
    v_accvgpr_read_b32 v34, a164
    v_mfma_f32_16x16x32_bf16 v[192:195], v[60:63], v[68:71], v[192:195]
    v_accvgpr_read_b32 v31, a165
    v_cvt_pk_bf16_f32 v34, v34, v31
    v_mfma_f32_16x16x32_bf16 v[196:199], v[56:59], v[72:75], v[196:199]
    v_accvgpr_read_b32 v35, a166
    v_accvgpr_read_b32 v31, a167
    v_mfma_f32_16x16x32_bf16 v[196:199], v[60:63], v[76:79], v[196:199]
    buffer_load_dwordx4 v12, s[20:23], s64 offen offset:2048 lds
    v_mfma_f32_16x16x32_bf16 v[200:203], v[56:59], v[80:83], v[200:203]
    ds_read_b128 v[108:111], v25 offset:57344
    v_cvt_pk_bf16_f32 v35, v35, v31
    v_mfma_f32_16x16x32_bf16 v[200:203], v[60:63], v[84:87], v[200:203]
    buffer_store_dwordx4 v[32:35], v1, s[36:39], s72 offen sc1
    v_mfma_f32_16x16x32_bf16 v[204:207], v[56:59], v[88:91], v[204:207]
    ds_read_b64_tr_b16 v[56:57], v21 offset:32768
    ds_read_b64_tr_b16 v[58:59], v21 offset:33792
    v_mfma_f32_16x16x32_bf16 v[204:207], v[60:63], v[92:95], v[204:207]
    ds_read_b64_tr_b16 v[60:61], v21 offset:40960
    ds_read_b64_tr_b16 v[62:63], v21 offset:41984
    v_mfma_f32_16x16x32_bf16 v[208:211], v[40:43], v[64:67], v[208:211]
    v_add_u32 v21, 0x10000, v21
    v_accvgpr_read_b32 v36, a168
    v_mfma_f32_16x16x32_bf16 v[208:211], v[44:47], v[68:71], v[208:211]
    v_accvgpr_read_b32 v31, a169
    v_cvt_pk_bf16_f32 v36, v36, v31
    v_mfma_f32_16x16x32_bf16 v[212:215], v[40:43], v[72:75], v[212:215]
    buffer_load_dwordx4 v13, s[20:23], s64 offen offset:3072 lds
    v_mfma_f32_16x16x32_bf16 v[212:215], v[44:47], v[76:79], v[212:215]
    s_add_u32 s72, s71, 3072
    v_accvgpr_read_b32 v37, a170
    v_accvgpr_read_b32 v31, a171
    v_mfma_f32_16x16x32_bf16 v[216:219], v[40:43], v[80:83], v[216:219]
    v_cvt_pk_bf16_f32 v37, v37, v31
    v_accvgpr_read_b32 v38, a172
    v_mfma_f32_16x16x32_bf16 v[216:219], v[44:47], v[84:87], v[216:219]
    v_accvgpr_read_b32 v31, a173
    v_cvt_pk_bf16_f32 v38, v38, v31
    v_mfma_f32_16x16x32_bf16 v[220:223], v[40:43], v[88:91], v[220:223]
    v_accvgpr_read_b32 v39, a174
    v_accvgpr_read_b32 v31, a175
    v_mfma_f32_16x16x32_bf16 v[220:223], v[44:47], v[92:95], v[220:223]
    s_waitcnt lgkmcnt(0)
    v_cvt_pk_bf16_f32 v39, v39, v31
    v_mfma_f32_16x16x32_bf16 v[224:227], v[48:51], v[64:67], v[224:227]
    buffer_store_dwordx4 v[36:39], v1, s[36:39], s72 offen sc1
    v_mfma_f32_16x16x32_bf16 v[224:227], v[52:55], v[68:71], v[224:227]
    s_add_u32 s64, s64, 128
    v_accvgpr_read_b32 v32, a176
    v_accvgpr_read_b32 v31, a177
    v_mfma_f32_16x16x32_bf16 v[228:231], v[48:51], v[72:75], v[228:231]
    v_cvt_pk_bf16_f32 v32, v32, v31
    v_accvgpr_read_b32 v33, a178
    v_mfma_f32_16x16x32_bf16 v[228:231], v[52:55], v[76:79], v[228:231]
    v_accvgpr_read_b32 v31, a179
    v_cvt_pk_bf16_f32 v33, v33, v31
    v_mfma_f32_16x16x32_bf16 v[232:235], v[48:51], v[80:83], v[232:235]
    v_accvgpr_read_b32 v34, a180
    v_accvgpr_read_b32 v31, a181
    v_mfma_f32_16x16x32_bf16 v[232:235], v[52:55], v[84:87], v[232:235]
    s_waitcnt vmcnt(25)
    s_barrier
    ds_read_b64_tr_b16 v[40:41], v26 offset:0
    v_mfma_f32_16x16x32_bf16 v[236:239], v[48:51], v[88:91], v[236:239]
    s_add_u32 m0, s69, 0
    ds_read_b64_tr_b16 v[42:43], v26 offset:576
    ds_read_b64_tr_b16 v[44:45], v26 offset:4608
    v_mfma_f32_16x16x32_bf16 v[236:239], v[52:55], v[92:95], v[236:239]
    buffer_load_dwordx4 v2, s[24:27], s60 offen lds
    v_mfma_f32_16x16x32_bf16 v[240:243], v[56:59], v[64:67], v[240:243]
    ds_read_b64_tr_b16 v[46:47], v26 offset:5184
    ds_read_b128 a[136:139], v22 offset:0
    v_mfma_f32_16x16x32_bf16 v[240:243], v[60:63], v[68:71], v[240:243]
    s_add_u32 s72, s71, 34816
    ds_read_b128 a[140:143], v23 offset:0
    ds_read_b64_tr_b16 v[48:49], v27 offset:0
    v_mfma_f32_16x16x32_bf16 v[244:247], v[56:59], v[72:75], v[244:247]
    buffer_load_dwordx4 v3, s[24:27], s60 offen offset:1024 lds
    v_mfma_f32_16x16x32_bf16 v[244:247], v[60:63], v[76:79], v[244:247]
    ds_read_b64_tr_b16 v[50:51], v27 offset:576
    ds_read_b64_tr_b16 v[52:53], v27 offset:4608
    v_mfma_f32_16x16x32_bf16 v[248:251], v[56:59], v[80:83], v[248:251]
    ds_read_b64_tr_b16 v[54:55], v27 offset:5184
    v_add_u32 v26, 0x10000, v26
    v_mfma_f32_16x16x32_bf16 v[248:251], v[60:63], v[84:87], v[248:251]
    v_add_u32 v22, 0x10000, v22
    v_add_u32 v23, 0x10000, v23
    v_mfma_f32_16x16x32_bf16 v[252:255], v[56:59], v[88:91], v[252:255]
    buffer_load_dwordx4 v4, s[24:27], s60 offen offset:2048 lds
    v_mfma_f32_16x16x32_bf16 v[252:255], v[60:63], v[92:95], v[252:255]
    s_waitcnt lgkmcnt(3)
    ds_read_b64_tr_b16 v[56:57], v28 offset:0
    ds_read_b64_tr_b16 v[58:59], v28 offset:576
    v_mfma_f32_16x16x32_bf16 a[64:67], v[40:43], v[64:67], a[64:67]
    ds_read_b64_tr_b16 v[60:61], v28 offset:4608
    ds_read_b64_tr_b16 v[62:63], v28 offset:5184
    v_mfma_f32_16x16x32_bf16 a[64:67], v[44:47], v[68:71], a[64:67]
    v_add_u32 v24, 0x10000, v24
    v_add_u32 v27, 0x10000, v27
    v_mfma_f32_16x16x32_bf16 a[68:71], v[40:43], v[72:75], a[68:71]
    buffer_load_dwordx4 v5, s[24:27], s60 offen offset:3072 lds
    v_mfma_f32_16x16x32_bf16 a[68:71], v[44:47], v[76:79], a[68:71]
    ds_read_b128 v[112:115], v24 offset:16384
    v_add_u32 v28, 0x10000, v28
    v_mfma_f32_16x16x32_bf16 a[72:75], v[40:43], v[80:83], a[72:75]
    v_cvt_pk_bf16_f32 v34, v34, v31
    v_accvgpr_read_b32 v35, a182
    v_mfma_f32_16x16x32_bf16 a[72:75], v[44:47], v[84:87], a[72:75]
    s_add_u32 m0, s69, 16384
    v_add_u32 v25, 0x10000, v25
    v_accvgpr_read_b32 v31, a183
    v_mfma_f32_16x16x32_bf16 a[76:79], v[40:43], v[88:91], a[76:79]
    s_add_u32 s60, s60, 524288
    buffer_load_dwordx4 v10, s[20:23], s63 offen lds
    v_mfma_f32_16x16x32_bf16 a[76:79], v[44:47], v[92:95], a[76:79]
    ds_read_b128 v[116:119], v25 offset:16384
    v_cvt_pk_bf16_f32 v35, v35, v31
    v_mfma_f32_16x16x32_bf16 a[128:131], v[40:43], a[136:139], a[128:131]
    ds_read_b64_tr_b16 v[40:41], v29 offset:0
    ds_read_b64_tr_b16 v[42:43], v29 offset:576
    v_mfma_f32_16x16x32_bf16 a[128:131], v[44:47], a[140:143], a[128:131]
    s_mov_b64 exec, s[86:87]
    ds_read_b128 v[40:43], v30 offset:0
    s_mov_b64 exec, -1
    s_waitcnt lgkmcnt(4)
    v_mfma_f32_16x16x32_bf16 a[80:83], v[48:51], v[64:67], a[80:83]
    buffer_load_dwordx4 v11, s[20:23], s63 offen offset:1024 lds
    v_mfma_f32_16x16x32_bf16 a[80:83], v[52:55], v[68:71], a[80:83]
    ds_read_b128 v[120:123], v24 offset:24576
    ds_read_b64_tr_b16 v[44:45], v29 offset:4608
    v_mfma_f32_16x16x32_bf16 a[84:87], v[48:51], v[72:75], a[84:87]
    ds_read_b64_tr_b16 v[46:47], v29 offset:5184
    v_add_u32 v29, 0x10000, v29
    v_mfma_f32_16x16x32_bf16 a[84:87], v[52:55], v[76:79], a[84:87]
    s_mov_b64 exec, s[86:87]
    ds_read_b128 v[44:47], v30 offset:64
    s_mov_b64 exec, -1
    v_mfma_f32_16x16x32_bf16 a[88:91], v[48:51], v[80:83], a[88:91]
    buffer_load_dwordx4 v12, s[20:23], s63 offen offset:2048 lds
    v_mfma_f32_16x16x32_bf16 a[88:91], v[52:55], v[84:87], a[88:91]
    ds_read_b128 v[124:127], v25 offset:24576
    v_add_u32 v30, 0x10000, v30
    v_mfma_f32_16x16x32_bf16 a[92:95], v[48:51], v[88:91], a[92:95]
    buffer_store_dwordx4 v[32:35], v1, s[36:39], s72 offen sc1
    v_mfma_f32_16x16x32_bf16 a[92:95], v[52:55], v[92:95], a[92:95]
    s_add_u32 s72, s71, 35840
    v_accvgpr_read_b32 v36, a184
    v_accvgpr_read_b32 v31, a185
    v_mfma_f32_16x16x32_bf16 a[132:135], v[48:51], a[136:139], a[132:135]
    buffer_load_dwordx4 v13, s[20:23], s63 offen offset:3072 lds
    v_mfma_f32_16x16x32_bf16 a[132:135], v[52:55], a[140:143], a[132:135]
    v_cvt_pk_bf16_f32 v36, v36, v31
    v_accvgpr_read_b32 v37, a186
    v_mfma_f32_16x16x32_bf16 a[96:99], v[56:59], v[64:67], a[96:99]
    v_accvgpr_read_b32 v31, a187
    v_cvt_pk_bf16_f32 v37, v37, v31
    v_mfma_f32_16x16x32_bf16 a[96:99], v[60:63], v[68:71], a[96:99]
    s_add_u32 s63, s63, 128
    v_accvgpr_read_b32 v38, a188
    v_accvgpr_read_b32 v31, a189
    v_mfma_f32_16x16x32_bf16 a[100:103], v[56:59], v[72:75], a[100:103]
    v_cvt_pk_bf16_f32 v38, v38, v31
    v_accvgpr_read_b32 v39, a190
    v_mfma_f32_16x16x32_bf16 a[100:103], v[60:63], v[76:79], a[100:103]
    v_accvgpr_read_b32 v31, a191
    v_cvt_pk_bf16_f32 v39, v39, v31
    v_mfma_f32_16x16x32_bf16 a[104:107], v[56:59], v[80:83], a[104:107]
    buffer_store_dwordx4 v[36:39], v1, s[36:39], s72 offen sc1
    v_mfma_f32_16x16x32_bf16 a[104:107], v[60:63], v[84:87], a[104:107]
    s_waitcnt vmcnt(23)
    s_barrier
    ds_read_b64_tr_b16 v[48:49], v14 offset:32768
    v_mfma_f32_16x16x32_bf16 a[108:111], v[56:59], v[88:91], a[108:111]
    s_add_u32 m0, s69, 32768
    ds_read_b64_tr_b16 v[50:51], v14 offset:33792
    ds_read_b64_tr_b16 v[52:53], v14 offset:40960
    v_mfma_f32_16x16x32_bf16 a[108:111], v[60:63], v[92:95], a[108:111]
    s_add_u32 s72, s71, 4096
    buffer_load_dwordx4 v6, s[28:31], s65 offen lds
    s_waitcnt lgkmcnt(3)
    v_mfma_f32_16x16x32_bf16 a[112:115], v[40:43], v[64:67], a[112:115]
    ds_read_b64_tr_b16 v[54:55], v14 offset:41984
    ds_read_b64_tr_b16 v[56:57], v15 offset:32768
    v_mfma_f32_16x16x32_bf16 a[112:115], v[44:47], v[68:71], a[112:115]
    ds_read_b64_tr_b16 v[58:59], v15 offset:33792
    ds_read_b64_tr_b16 v[60:61], v15 offset:40960
    v_mfma_f32_16x16x32_bf16 a[116:119], v[40:43], v[72:75], a[116:119]
    ds_read_b64_tr_b16 v[62:63], v15 offset:41984
    v_add_u32 v14, 0xffff0000, v14
    v_mfma_f32_16x16x32_bf16 a[116:119], v[44:47], v[76:79], a[116:119]
    v_add_u32 v15, 0xffff0000, v15
    v_accvgpr_read_b32 v32, a192
    v_mfma_f32_16x16x32_bf16 a[120:123], v[40:43], v[80:83], a[120:123]
    s_add_u32 m0, s69, 33792
    v_accvgpr_read_b32 v31, a193
    v_cvt_pk_bf16_f32 v32, v32, v31
    v_mfma_f32_16x16x32_bf16 a[120:123], v[44:47], v[84:87], a[120:123]
    buffer_load_dwordx4 v7, s[32:35], s66 offen lds
    v_mfma_f32_16x16x32_bf16 a[124:127], v[40:43], v[88:91], a[124:127]
    ds_read_b64_tr_b16 v[40:41], v16 offset:32768
    ds_read_b64_tr_b16 v[42:43], v16 offset:33792
    v_mfma_f32_16x16x32_bf16 a[124:127], v[44:47], v[92:95], a[124:127]
    s_waitcnt lgkmcnt(2)
    ds_read_b64_tr_b16 v[44:45], v16 offset:40960
    ds_read_b64_tr_b16 v[46:47], v16 offset:41984
    v_mfma_f32_16x16x32_bf16 v[128:131], v[48:51], v[96:99], v[128:131]
    v_add_u32 v16, 0xffff0000, v16
    v_accvgpr_read_b32 v33, a194
    v_mfma_f32_16x16x32_bf16 v[128:131], v[52:55], v[100:103], v[128:131]
    v_accvgpr_read_b32 v31, a195
    v_cvt_pk_bf16_f32 v33, v33, v31
    v_mfma_f32_16x16x32_bf16 v[132:135], v[48:51], v[104:107], v[132:135]
    ds_read_b128 v[64:67], v24 offset:49152
    v_accvgpr_read_b32 v34, a196
    v_mfma_f32_16x16x32_bf16 v[132:135], v[52:55], v[108:111], v[132:135]
    v_accvgpr_read_b32 v31, a197
    v_cvt_pk_bf16_f32 v34, v34, v31
    v_mfma_f32_16x16x32_bf16 v[136:139], v[48:51], v[112:115], v[136:139]
    s_add_u32 m0, s69, 34816
    v_accvgpr_read_b32 v35, a198
    v_accvgpr_read_b32 v31, a199
    v_mfma_f32_16x16x32_bf16 v[136:139], v[52:55], v[116:119], v[136:139]
    buffer_load_dwordx4 v8, s[32:35], s66 offen lds
    v_mfma_f32_16x16x32_bf16 v[140:143], v[48:51], v[120:123], v[140:143]
    ds_read_b64_tr_b16 v[48:49], v17 offset:32768
    ds_read_b64_tr_b16 v[50:51], v17 offset:33792
    v_mfma_f32_16x16x32_bf16 v[140:143], v[52:55], v[124:127], v[140:143]
    ds_read_b64_tr_b16 v[52:53], v17 offset:40960
    ds_read_b64_tr_b16 v[54:55], v17 offset:41984
    v_mfma_f32_16x16x32_bf16 v[144:147], v[56:59], v[96:99], v[144:147]
    v_add_u32 v17, 0xffff0000, v17
    v_cvt_pk_bf16_f32 v35, v35, v31
    v_mfma_f32_16x16x32_bf16 v[144:147], v[60:63], v[100:103], v[144:147]
    buffer_store_dwordx4 v[32:35], v1, s[36:39], s72 offen sc1
    v_mfma_f32_16x16x32_bf16 v[148:151], v[56:59], v[104:107], v[148:151]
    s_add_u32 s72, s71, 5120
    v_accvgpr_read_b32 v36, a200
    v_accvgpr_read_b32 v31, a201
    v_mfma_f32_16x16x32_bf16 v[148:151], v[60:63], v[108:111], v[148:151]
    s_add_u32 m0, s69, 35840
    v_cvt_pk_bf16_f32 v36, v36, v31
    v_accvgpr_read_b32 v37, a202
    v_mfma_f32_16x16x32_bf16 v[152:155], v[56:59], v[112:115], v[152:155]
    buffer_load_dwordx4 v9, s[32:35], s66 offen lds
    v_mfma_f32_16x16x32_bf16 v[152:155], v[60:63], v[116:119], v[152:155]
    ds_read_b128 v[68:71], v25 offset:49152
    v_accvgpr_read_b32 v31, a203
    v_mfma_f32_16x16x32_bf16 v[156:159], v[56:59], v[120:123], v[156:159]
    ds_read_b64_tr_b16 v[56:57], v18 offset:32768
    ds_read_b64_tr_b16 v[58:59], v18 offset:33792
    v_mfma_f32_16x16x32_bf16 v[156:159], v[60:63], v[124:127], v[156:159]
    s_waitcnt lgkmcnt(3)
    ds_read_b64_tr_b16 v[60:61], v18 offset:40960
    ds_read_b64_tr_b16 v[62:63], v18 offset:41984
    v_mfma_f32_16x16x32_bf16 v[160:163], v[40:43], v[96:99], v[160:163]
    v_add_u32 v18, 0xffff0000, v18
    v_cvt_pk_bf16_f32 v37, v37, v31
    v_mfma_f32_16x16x32_bf16 v[160:163], v[44:47], v[100:103], v[160:163]
    v_accvgpr_read_b32 v38, a204
    v_accvgpr_read_b32 v31, a205
    v_mfma_f32_16x16x32_bf16 v[164:167], v[40:43], v[104:107], v[164:167]
    v_cvt_pk_bf16_f32 v38, v38, v31
    v_accvgpr_read_b32 v39, a206
    v_mfma_f32_16x16x32_bf16 v[164:167], v[44:47], v[108:111], v[164:167]
    s_add_u32 m0, s69, 49152
    v_accvgpr_read_b32 v31, a207
    v_cvt_pk_bf16_f32 v39, v39, v31
    v_mfma_f32_16x16x32_bf16 v[168:171], v[40:43], v[112:115], v[168:171]
    s_add_u32 s65, s65, s67
    buffer_load_dwordx4 v10, s[20:23], s64 offen lds
    v_mfma_f32_16x16x32_bf16 v[168:171], v[44:47], v[116:119], v[168:171]
    s_add_u32 s66, s66, s68
    buffer_store_dwordx4 v[36:39], v1, s[36:39], s72 offen sc1
    v_mfma_f32_16x16x32_bf16 v[172:175], v[40:43], v[120:123], v[172:175]
    s_add_u32 s72, s71, 36864
    ds_read_b64_tr_b16 v[40:41], v19 offset:32768
    ds_read_b64_tr_b16 v[42:43], v19 offset:33792
    v_mfma_f32_16x16x32_bf16 v[172:175], v[44:47], v[124:127], v[172:175]
    ds_read_b64_tr_b16 v[44:45], v19 offset:40960
    ds_read_b64_tr_b16 v[46:47], v19 offset:41984
    v_mfma_f32_16x16x32_bf16 v[176:179], v[48:51], v[96:99], v[176:179]
    ds_read_b128 v[72:75], v24 offset:57344
    v_add_u32 v19, 0xffff0000, v19
    v_mfma_f32_16x16x32_bf16 v[176:179], v[52:55], v[100:103], v[176:179]
    v_accvgpr_read_b32 v32, a208
    v_accvgpr_read_b32 v31, a209
    v_mfma_f32_16x16x32_bf16 v[180:183], v[48:51], v[104:107], v[180:183]
    v_cvt_pk_bf16_f32 v32, v32, v31
    v_accvgpr_read_b32 v33, a210
    v_mfma_f32_16x16x32_bf16 v[180:183], v[52:55], v[108:111], v[180:183]
    buffer_load_dwordx4 v11, s[20:23], s64 offen offset:1024 lds
    v_mfma_f32_16x16x32_bf16 v[184:187], v[48:51], v[112:115], v[184:187]
    v_accvgpr_read_b32 v31, a211
    v_cvt_pk_bf16_f32 v33, v33, v31
    v_mfma_f32_16x16x32_bf16 v[184:187], v[52:55], v[116:119], v[184:187]
    v_accvgpr_read_b32 v34, a212
    v_accvgpr_read_b32 v31, a213
    v_mfma_f32_16x16x32_bf16 v[188:191], v[48:51], v[120:123], v[188:191]
    ds_read_b64_tr_b16 v[48:49], v20 offset:32768
    ds_read_b64_tr_b16 v[50:51], v20 offset:33792
    v_mfma_f32_16x16x32_bf16 v[188:191], v[52:55], v[124:127], v[188:191]
    s_waitcnt lgkmcnt(2)
    ds_read_b64_tr_b16 v[52:53], v20 offset:40960
    ds_read_b64_tr_b16 v[54:55], v20 offset:41984
    v_mfma_f32_16x16x32_bf16 v[192:195], v[56:59], v[96:99], v[192:195]
    v_add_u32 v20, 0xffff0000, v20
    v_cvt_pk_bf16_f32 v34, v34, v31
    v_mfma_f32_16x16x32_bf16 v[192:195], v[60:63], v[100:103], v[192:195]
    v_accvgpr_read_b32 v35, a214
    v_accvgpr_read_b32 v31, a215
    v_mfma_f32_16x16x32_bf16 v[196:199], v[56:59], v[104:107], v[196:199]
    v_cvt_pk_bf16_f32 v35, v35, v31
    v_accvgpr_read_b32 v36, a216
    v_mfma_f32_16x16x32_bf16 v[196:199], v[60:63], v[108:111], v[196:199]
    buffer_load_dwordx4 v12, s[20:23], s64 offen offset:2048 lds
    v_mfma_f32_16x16x32_bf16 v[200:203], v[56:59], v[112:115], v[200:203]
    ds_read_b128 v[76:79], v25 offset:57344
    v_accvgpr_read_b32 v31, a217
    v_mfma_f32_16x16x32_bf16 v[200:203], v[60:63], v[116:119], v[200:203]
    buffer_store_dwordx4 v[32:35], v1, s[36:39], s72 offen sc1
    v_mfma_f32_16x16x32_bf16 v[204:207], v[56:59], v[120:123], v[204:207]
    s_add_u32 s72, s71, 37888
    ds_read_b64_tr_b16 v[56:57], v21 offset:32768
    ds_read_b64_tr_b16 v[58:59], v21 offset:33792
    v_mfma_f32_16x16x32_bf16 v[204:207], v[60:63], v[124:127], v[204:207]
    ds_read_b64_tr_b16 v[60:61], v21 offset:40960
    ds_read_b64_tr_b16 v[62:63], v21 offset:41984
    v_mfma_f32_16x16x32_bf16 v[208:211], v[40:43], v[96:99], v[208:211]
    v_add_u32 v21, 0xffff0000, v21
    v_cvt_pk_bf16_f32 v36, v36, v31
    v_mfma_f32_16x16x32_bf16 v[208:211], v[44:47], v[100:103], v[208:211]
    v_accvgpr_read_b32 v37, a218
    v_accvgpr_read_b32 v31, a219
    v_mfma_f32_16x16x32_bf16 v[212:215], v[40:43], v[104:107], v[212:215]
    buffer_load_dwordx4 v13, s[20:23], s64 offen offset:3072 lds
    v_mfma_f32_16x16x32_bf16 v[212:215], v[44:47], v[108:111], v[212:215]
    v_cvt_pk_bf16_f32 v37, v37, v31
    v_accvgpr_read_b32 v38, a220
    v_mfma_f32_16x16x32_bf16 v[216:219], v[40:43], v[112:115], v[216:219]
    v_accvgpr_read_b32 v31, a221
    v_cvt_pk_bf16_f32 v38, v38, v31
    v_mfma_f32_16x16x32_bf16 v[216:219], v[44:47], v[116:119], v[216:219]
    v_accvgpr_read_b32 v39, a222
    v_accvgpr_read_b32 v31, a223
    v_mfma_f32_16x16x32_bf16 v[220:223], v[40:43], v[120:123], v[220:223]
    v_cvt_pk_bf16_f32 v39, v39, v31
    v_accvgpr_read_b32 v32, a224
    v_mfma_f32_16x16x32_bf16 v[220:223], v[44:47], v[124:127], v[220:223]
    s_waitcnt lgkmcnt(0)
    buffer_store_dwordx4 v[36:39], v1, s[36:39], s72 offen sc1
    v_mfma_f32_16x16x32_bf16 v[224:227], v[48:51], v[96:99], v[224:227]
    s_add_u32 s72, s71, 6144
    v_accvgpr_read_b32 v31, a225
    v_cvt_pk_bf16_f32 v32, v32, v31
    v_mfma_f32_16x16x32_bf16 v[224:227], v[52:55], v[100:103], v[224:227]
    s_add_u32 s64, s64, 128
    v_accvgpr_read_b32 v33, a226
    v_accvgpr_read_b32 v31, a227
    v_mfma_f32_16x16x32_bf16 v[228:231], v[48:51], v[104:107], v[228:231]
    v_cvt_pk_bf16_f32 v33, v33, v31
    v_accvgpr_read_b32 v34, a228
    v_mfma_f32_16x16x32_bf16 v[228:231], v[52:55], v[108:111], v[228:231]
    v_accvgpr_read_b32 v31, a229
    v_cvt_pk_bf16_f32 v34, v34, v31
    v_mfma_f32_16x16x32_bf16 v[232:235], v[48:51], v[112:115], v[232:235]
    v_accvgpr_read_b32 v35, a230
    v_accvgpr_read_b32 v31, a231
    v_mfma_f32_16x16x32_bf16 v[232:235], v[52:55], v[116:119], v[232:235]
    s_waitcnt vmcnt(23)
    s_barrier
    ds_read_b64_tr_b16 v[40:41], v26 offset:0
    v_mfma_f32_16x16x32_bf16 v[236:239], v[48:51], v[120:123], v[236:239]
    s_add_u32 m0, s69, 65536
    ds_read_b64_tr_b16 v[42:43], v26 offset:576
    ds_read_b64_tr_b16 v[44:45], v26 offset:4608
    v_mfma_f32_16x16x32_bf16 v[236:239], v[52:55], v[124:127], v[236:239]
    buffer_load_dwordx4 v2, s[24:27], s60 offen lds
    v_mfma_f32_16x16x32_bf16 v[240:243], v[56:59], v[96:99], v[240:243]
    ds_read_b64_tr_b16 v[46:47], v26 offset:5184
    ds_read_b128 a[136:139], v22 offset:0
    v_mfma_f32_16x16x32_bf16 v[240:243], v[60:63], v[100:103], v[240:243]
    ds_read_b128 a[140:143], v23 offset:0
    ds_read_b64_tr_b16 v[48:49], v27 offset:0
    v_mfma_f32_16x16x32_bf16 v[244:247], v[56:59], v[104:107], v[244:247]
    buffer_load_dwordx4 v3, s[24:27], s60 offen offset:1024 lds
    v_mfma_f32_16x16x32_bf16 v[244:247], v[60:63], v[108:111], v[244:247]
    ds_read_b64_tr_b16 v[50:51], v27 offset:576
    ds_read_b64_tr_b16 v[52:53], v27 offset:4608
    v_mfma_f32_16x16x32_bf16 v[248:251], v[56:59], v[112:115], v[248:251]
    ds_read_b64_tr_b16 v[54:55], v27 offset:5184
    v_add_u32 v26, 0xfffe0000, v26
    v_mfma_f32_16x16x32_bf16 v[248:251], v[60:63], v[116:119], v[248:251]
    v_add_u32 v22, 0xfffe0000, v22
    v_add_u32 v23, 0xfffe0000, v23
    v_mfma_f32_16x16x32_bf16 v[252:255], v[56:59], v[120:123], v[252:255]
    buffer_load_dwordx4 v4, s[24:27], s60 offen offset:2048 lds
    v_mfma_f32_16x16x32_bf16 v[252:255], v[60:63], v[124:127], v[252:255]
    s_waitcnt lgkmcnt(3)
    ds_read_b64_tr_b16 v[56:57], v28 offset:0
    ds_read_b64_tr_b16 v[58:59], v28 offset:576
    v_mfma_f32_16x16x32_bf16 a[64:67], v[40:43], v[96:99], a[64:67]
    ds_read_b64_tr_b16 v[60:61], v28 offset:4608
    ds_read_b64_tr_b16 v[62:63], v28 offset:5184
    v_mfma_f32_16x16x32_bf16 a[64:67], v[44:47], v[100:103], a[64:67]
    v_add_u32 v24, 0x10000, v24
    v_add_u32 v27, 0xfffe0000, v27
    v_mfma_f32_16x16x32_bf16 a[68:71], v[40:43], v[104:107], a[68:71]
    buffer_load_dwordx4 v5, s[24:27], s60 offen offset:3072 lds
    v_mfma_f32_16x16x32_bf16 a[68:71], v[44:47], v[108:111], a[68:71]
    ds_read_b128 v[80:83], v24 offset:16384
    v_add_u32 v28, 0xfffe0000, v28
    v_mfma_f32_16x16x32_bf16 a[72:75], v[40:43], v[112:115], a[72:75]
    v_cvt_pk_bf16_f32 v35, v35, v31
    v_accvgpr_read_b32 v36, a232
    v_mfma_f32_16x16x32_bf16 a[72:75], v[44:47], v[116:119], a[72:75]
    s_add_u32 m0, s69, 81920
    v_add_u32 v25, 0x10000, v25
    v_accvgpr_read_b32 v31, a233
    v_mfma_f32_16x16x32_bf16 a[76:79], v[40:43], v[120:123], a[76:79]
    s_add_u32 s60, s60, 524288
    buffer_load_dwordx4 v10, s[20:23], s63 offen lds
    v_mfma_f32_16x16x32_bf16 a[76:79], v[44:47], v[124:127], a[76:79]
    ds_read_b128 v[84:87], v25 offset:16384
    v_cvt_pk_bf16_f32 v36, v36, v31
    v_mfma_f32_16x16x32_bf16 a[128:131], v[40:43], a[136:139], a[128:131]
    ds_read_b64_tr_b16 v[40:41], v29 offset:0
    ds_read_b64_tr_b16 v[42:43], v29 offset:576
    v_mfma_f32_16x16x32_bf16 a[128:131], v[44:47], a[140:143], a[128:131]
    s_mov_b64 exec, s[86:87]
    ds_read_b128 v[40:43], v30 offset:0
    s_mov_b64 exec, -1
    s_waitcnt lgkmcnt(4)
    v_mfma_f32_16x16x32_bf16 a[80:83], v[48:51], v[96:99], a[80:83]
    buffer_load_dwordx4 v11, s[20:23], s63 offen offset:1024 lds
    v_mfma_f32_16x16x32_bf16 a[80:83], v[52:55], v[100:103], a[80:83]
    ds_read_b128 v[88:91], v24 offset:24576
    ds_read_b64_tr_b16 v[44:45], v29 offset:4608
    v_mfma_f32_16x16x32_bf16 a[84:87], v[48:51], v[104:107], a[84:87]
    ds_read_b64_tr_b16 v[46:47], v29 offset:5184
    v_add_u32 v29, 0xfffe0000, v29
    v_mfma_f32_16x16x32_bf16 a[84:87], v[52:55], v[108:111], a[84:87]
    s_mov_b64 exec, s[86:87]
    ds_read_b128 v[44:47], v30 offset:64
    s_mov_b64 exec, -1
    v_mfma_f32_16x16x32_bf16 a[88:91], v[48:51], v[112:115], a[88:91]
    buffer_load_dwordx4 v12, s[20:23], s63 offen offset:2048 lds
    v_mfma_f32_16x16x32_bf16 a[88:91], v[52:55], v[116:119], a[88:91]
    ds_read_b128 v[92:95], v25 offset:24576
    v_add_u32 v30, 0xfffe0000, v30
    v_mfma_f32_16x16x32_bf16 a[92:95], v[48:51], v[120:123], a[92:95]
    buffer_store_dwordx4 v[32:35], v1, s[36:39], s72 offen sc1
    v_mfma_f32_16x16x32_bf16 a[92:95], v[52:55], v[124:127], a[92:95]
    s_add_u32 s72, s71, 7168
    v_accvgpr_read_b32 v37, a234
    v_accvgpr_read_b32 v31, a235
    v_mfma_f32_16x16x32_bf16 a[132:135], v[48:51], a[136:139], a[132:135]
    buffer_load_dwordx4 v13, s[20:23], s63 offen offset:3072 lds
    v_mfma_f32_16x16x32_bf16 a[132:135], v[52:55], a[140:143], a[132:135]
    v_cvt_pk_bf16_f32 v37, v37, v31
    v_accvgpr_read_b32 v38, a236
    v_mfma_f32_16x16x32_bf16 a[96:99], v[56:59], v[96:99], a[96:99]
    v_accvgpr_read_b32 v31, a237
    v_cvt_pk_bf16_f32 v38, v38, v31
    v_mfma_f32_16x16x32_bf16 a[96:99], v[60:63], v[100:103], a[96:99]
    s_add_u32 s63, s63, 128
    v_accvgpr_read_b32 v39, a238
    v_accvgpr_read_b32 v31, a239
    v_mfma_f32_16x16x32_bf16 a[100:103], v[56:59], v[104:107], a[100:103]
    v_cvt_pk_bf16_f32 v39, v39, v31
    v_accvgpr_read_b32 v32, a240
    v_mfma_f32_16x16x32_bf16 a[100:103], v[60:63], v[108:111], a[100:103]
    buffer_store_dwordx4 v[36:39], v1, s[36:39], s72 offen sc1
    v_mfma_f32_16x16x32_bf16 a[104:107], v[56:59], v[112:115], a[104:107]
    s_add_u32 s72, s71, 38912
    v_accvgpr_read_b32 v31, a241
    v_cvt_pk_bf16_f32 v32, v32, v31
    v_mfma_f32_16x16x32_bf16 a[104:107], v[60:63], v[116:119], a[104:107]
    s_waitcnt vmcnt(23)
    s_barrier
    ds_read_b64_tr_b16 v[48:49], v14 offset:0
    v_mfma_f32_16x16x32_bf16 a[108:111], v[56:59], v[120:123], a[108:111]
    s_add_u32 m0, s69, 98304
    ds_read_b64_tr_b16 v[50:51], v14 offset:1024
    ds_read_b64_tr_b16 v[52:53], v14 offset:8192
    v_mfma_f32_16x16x32_bf16 a[108:111], v[60:63], v[124:127], a[108:111]
    s_waitcnt lgkmcnt(3)
    buffer_load_dwordx4 v6, s[28:31], s65 offen lds
    v_mfma_f32_16x16x32_bf16 a[112:115], v[40:43], v[96:99], a[112:115]
    ds_read_b64_tr_b16 v[54:55], v14 offset:9216
    ds_read_b64_tr_b16 v[56:57], v15 offset:0
    v_mfma_f32_16x16x32_bf16 a[112:115], v[44:47], v[100:103], a[112:115]
    ds_read_b64_tr_b16 v[58:59], v15 offset:1024
    ds_read_b64_tr_b16 v[60:61], v15 offset:8192
    v_mfma_f32_16x16x32_bf16 a[116:119], v[40:43], v[104:107], a[116:119]
    ds_read_b64_tr_b16 v[62:63], v15 offset:9216
    v_add_u32 v14, 0x10000, v14
    v_mfma_f32_16x16x32_bf16 a[116:119], v[44:47], v[108:111], a[116:119]
    v_add_u32 v15, 0x10000, v15
    v_accvgpr_read_b32 v33, a242
    v_mfma_f32_16x16x32_bf16 a[120:123], v[40:43], v[112:115], a[120:123]
    s_add_u32 m0, s69, 99328
    v_accvgpr_read_b32 v31, a243
    v_cvt_pk_bf16_f32 v33, v33, v31
    v_mfma_f32_16x16x32_bf16 a[120:123], v[44:47], v[116:119], a[120:123]
    buffer_load_dwordx4 v7, s[32:35], s66 offen lds
    v_mfma_f32_16x16x32_bf16 a[124:127], v[40:43], v[120:123], a[124:127]
    ds_read_b64_tr_b16 v[40:41], v16 offset:0
    ds_read_b64_tr_b16 v[42:43], v16 offset:1024
    v_mfma_f32_16x16x32_bf16 a[124:127], v[44:47], v[124:127], a[124:127]
    s_waitcnt lgkmcnt(2)
    ds_read_b64_tr_b16 v[44:45], v16 offset:8192
    ds_read_b64_tr_b16 v[46:47], v16 offset:9216
    v_mfma_f32_16x16x32_bf16 v[128:131], v[48:51], v[64:67], v[128:131]
    v_add_u32 v16, 0x10000, v16
    v_accvgpr_read_b32 v34, a244
    v_mfma_f32_16x16x32_bf16 v[128:131], v[52:55], v[68:71], v[128:131]
    v_add_u32 v24, 0xfffe0000, v24
    v_accvgpr_read_b32 v31, a245
    v_mfma_f32_16x16x32_bf16 v[132:135], v[48:51], v[72:75], v[132:135]
    ds_read_b128 v[96:99], v24 offset:16384
    v_cvt_pk_bf16_f32 v34, v34, v31
    v_mfma_f32_16x16x32_bf16 v[132:135], v[52:55], v[76:79], v[132:135]
    v_accvgpr_read_b32 v35, a246
    v_accvgpr_read_b32 v31, a247
    v_mfma_f32_16x16x32_bf16 v[136:139], v[48:51], v[80:83], v[136:139]
    s_add_u32 m0, s69, 100352
    v_cvt_pk_bf16_f32 v35, v35, v31
    v_accvgpr_read_b32 v36, a248
    v_mfma_f32_16x16x32_bf16 v[136:139], v[52:55], v[84:87], v[136:139]
    buffer_load_dwordx4 v8, s[32:35], s66 offen lds
    v_mfma_f32_16x16x32_bf16 v[140:143], v[48:51], v[88:91], v[140:143]
    ds_read_b64_tr_b16 v[48:49], v17 offset:0
    ds_read_b64_tr_b16 v[50:51], v17 offset:1024
    v_mfma_f32_16x16x32_bf16 v[140:143], v[52:55], v[92:95], v[140:143]
    ds_read_b64_tr_b16 v[52:53], v17 offset:8192
    ds_read_b64_tr_b16 v[54:55], v17 offset:9216
    v_mfma_f32_16x16x32_bf16 v[144:147], v[56:59], v[64:67], v[144:147]
    v_add_u32 v17, 0x10000, v17
    v_accvgpr_read_b32 v31, a249
    v_mfma_f32_16x16x32_bf16 v[144:147], v[60:63], v[68:71], v[144:147]
    buffer_store_dwordx4 v[32:35], v1, s[36:39], s72 offen sc1
    v_mfma_f32_16x16x32_bf16 v[148:151], v[56:59], v[72:75], v[148:151]
    s_add_u32 s72, s71, 39936
    v_mov_b32 v32, 67108864
    v_cndmask_b32_e64 v32, v32, 0, vcc
    v_mfma_f32_16x16x32_bf16 v[148:151], v[60:63], v[76:79], v[148:151]
    s_add_u32 m0, s69, 101376
    v_mov_b32 v33, 1
    v_cvt_pk_bf16_f32 v36, v36, v31
    v_mfma_f32_16x16x32_bf16 v[152:155], v[56:59], v[80:83], v[152:155]
    s_add_u32 s71, s70, 16384
    v_add_u32 v25, 0xfffe0000, v25
    v_accvgpr_read_b32 v37, a250
    v_mfma_f32_16x16x32_bf16 v[152:155], v[60:63], v[84:87], v[152:155]
    s_add_u32 s70, s70, s69
    buffer_load_dwordx4 v9, s[32:35], s66 offen lds
    v_mfma_f32_16x16x32_bf16 v[156:159], v[56:59], v[88:91], v[156:159]
    ds_read_b128 v[100:103], v25 offset:16384
    ds_read_b64_tr_b16 v[56:57], v18 offset:0
    v_mfma_f32_16x16x32_bf16 v[156:159], v[60:63], v[92:95], v[156:159]
    s_waitcnt lgkmcnt(2)
    ds_read_b64_tr_b16 v[58:59], v18 offset:1024
    ds_read_b64_tr_b16 v[60:61], v18 offset:8192
    v_mfma_f32_16x16x32_bf16 v[160:163], v[40:43], v[64:67], v[160:163]
    ds_read_b64_tr_b16 v[62:63], v18 offset:9216
    v_add_u32 v18, 0x10000, v18
    v_mfma_f32_16x16x32_bf16 v[160:163], v[44:47], v[68:71], v[160:163]
    v_accvgpr_read_b32 v31, a251
    v_cvt_pk_bf16_f32 v37, v37, v31
    v_mfma_f32_16x16x32_bf16 v[164:167], v[40:43], v[72:75], v[164:167]
    v_accvgpr_read_b32 v38, a252
    v_accvgpr_read_b32 v31, a253
    v_mfma_f32_16x16x32_bf16 v[164:167], v[44:47], v[76:79], v[164:167]
    s_add_u32 m0, s69, 114688
    v_cvt_pk_bf16_f32 v38, v38, v31
    v_accvgpr_read_b32 v39, a254
    v_mfma_f32_16x16x32_bf16 v[168:171], v[40:43], v[80:83], v[168:171]
    s_add_u32 s65, s65, s67
    buffer_load_dwordx4 v10, s[20:23], s64 offen lds
    v_mfma_f32_16x16x32_bf16 v[168:171], v[44:47], v[84:87], v[168:171]
    s_add_u32 s66, s66, s68
    v_accvgpr_read_b32 v31, a255
    v_cvt_pk_bf16_f32 v39, v39, v31
    v_mfma_f32_16x16x32_bf16 v[172:175], v[40:43], v[88:91], v[172:175]
    ds_read_b64_tr_b16 v[40:41], v19 offset:0
    ds_read_b64_tr_b16 v[42:43], v19 offset:1024
    v_mfma_f32_16x16x32_bf16 v[172:175], v[44:47], v[92:95], v[172:175]
    ds_read_b64_tr_b16 v[44:45], v19 offset:8192
    ds_read_b64_tr_b16 v[46:47], v19 offset:9216
    v_mfma_f32_16x16x32_bf16 v[176:179], v[48:51], v[64:67], v[176:179]
    ds_read_b128 v[104:107], v24 offset:24576
    v_add_u32 v19, 0x10000, v19
    v_mfma_f32_16x16x32_bf16 v[176:179], v[52:55], v[68:71], v[176:179]
    v_mov_b32 v31, 0x3f803f80
    v_accvgpr_write_b32 a224, v31
    v_mfma_f32_16x16x32_bf16 v[180:183], v[48:51], v[72:75], v[180:183]
    v_accvgpr_write_b32 a225, v31
    v_accvgpr_write_b32 a226, v31
    v_mfma_f32_16x16x32_bf16 v[180:183], v[52:55], v[76:79], v[180:183]
    buffer_load_dwordx4 v11, s[20:23], s64 offen offset:1024 lds
    v_mfma_f32_16x16x32_bf16 v[184:187], v[48:51], v[80:83], v[184:187]
    v_accvgpr_write_b32 a227, v31
    v_mfma_f32_16x16x32_bf16 v[184:187], v[52:55], v[84:87], v[184:187]
    buffer_store_dwordx4 v[36:39], v1, s[36:39], s72 offen sc1
    v_mfma_f32_16x16x32_bf16 v[188:191], v[48:51], v[88:91], v[188:191]
    s_lshl_b32 s72, s5, 3
    ds_read_b64_tr_b16 v[48:49], v20 offset:0
    ds_read_b64_tr_b16 v[50:51], v20 offset:1024
    v_mfma_f32_16x16x32_bf16 v[188:191], v[52:55], v[92:95], v[188:191]
    s_waitcnt lgkmcnt(2)
    ds_read_b64_tr_b16 v[52:53], v20 offset:8192
    ds_read_b64_tr_b16 v[54:55], v20 offset:9216
    v_mfma_f32_16x16x32_bf16 v[192:195], v[56:59], v[64:67], v[192:195]
    v_add_u32 v20, 0x10000, v20
    v_mfma_f32_16x16x32_bf16 v[192:195], v[60:63], v[68:71], v[192:195]
    v_mfma_f32_16x16x32_bf16 v[196:199], v[56:59], v[72:75], v[196:199]
    v_mfma_f32_16x16x32_bf16 v[196:199], v[60:63], v[76:79], v[196:199]
    buffer_load_dwordx4 v12, s[20:23], s64 offen offset:2048 lds
    v_mfma_f32_16x16x32_bf16 v[200:203], v[56:59], v[80:83], v[200:203]
    ds_read_b128 v[108:111], v25 offset:24576
    v_mfma_f32_16x16x32_bf16 v[200:203], v[60:63], v[84:87], v[200:203]
    v_mfma_f32_16x16x32_bf16 v[204:207], v[56:59], v[88:91], v[204:207]
    ds_read_b64_tr_b16 v[56:57], v21 offset:0
    ds_read_b64_tr_b16 v[58:59], v21 offset:1024
    v_mfma_f32_16x16x32_bf16 v[204:207], v[60:63], v[92:95], v[204:207]
    ds_read_b64_tr_b16 v[60:61], v21 offset:8192
    ds_read_b64_tr_b16 v[62:63], v21 offset:9216
    v_mfma_f32_16x16x32_bf16 v[208:211], v[40:43], v[64:67], v[208:211]
    v_add_u32 v21, 0x10000, v21
    v_mfma_f32_16x16x32_bf16 v[208:211], v[44:47], v[68:71], v[208:211]
    v_mfma_f32_16x16x32_bf16 v[212:215], v[40:43], v[72:75], v[212:215]
    buffer_load_dwordx4 v13, s[20:23], s64 offen offset:3072 lds
    v_mfma_f32_16x16x32_bf16 v[212:215], v[44:47], v[76:79], v[212:215]
    v_mfma_f32_16x16x32_bf16 v[216:219], v[40:43], v[80:83], v[216:219]
    v_mfma_f32_16x16x32_bf16 v[216:219], v[44:47], v[84:87], v[216:219]
    v_mfma_f32_16x16x32_bf16 v[220:223], v[40:43], v[88:91], v[220:223]
    v_mfma_f32_16x16x32_bf16 v[220:223], v[44:47], v[92:95], v[220:223]
    s_waitcnt lgkmcnt(0)
    v_mfma_f32_16x16x32_bf16 v[224:227], v[48:51], v[64:67], v[224:227]
    v_mfma_f32_16x16x32_bf16 v[224:227], v[52:55], v[68:71], v[224:227]
    s_add_u32 s64, s64, 128
    v_mfma_f32_16x16x32_bf16 v[228:231], v[48:51], v[72:75], v[228:231]
    v_mfma_f32_16x16x32_bf16 v[228:231], v[52:55], v[76:79], v[228:231]
    v_mfma_f32_16x16x32_bf16 v[232:235], v[48:51], v[80:83], v[232:235]
    v_mfma_f32_16x16x32_bf16 v[232:235], v[52:55], v[84:87], v[232:235]
    s_waitcnt vmcnt(21)
    s_barrier
    ds_read_b64_tr_b16 v[40:41], v26 offset:32768
    v_mfma_f32_16x16x32_bf16 v[236:239], v[48:51], v[88:91], v[236:239]
    s_add_u32 m0, s69, 131072
    ds_read_b64_tr_b16 v[42:43], v26 offset:33344
    ds_read_b64_tr_b16 v[44:45], v26 offset:37376
    v_mfma_f32_16x16x32_bf16 v[236:239], v[52:55], v[92:95], v[236:239]
    buffer_load_dwordx4 v2, s[24:27], s60 offen lds
    v_mfma_f32_16x16x32_bf16 v[240:243], v[56:59], v[64:67], v[240:243]
    ds_read_b64_tr_b16 v[46:47], v26 offset:37952
    ds_read_b128 a[136:139], v22 offset:32768
    v_mfma_f32_16x16x32_bf16 v[240:243], v[60:63], v[68:71], v[240:243]
    ds_read_b128 a[140:143], v23 offset:32768
    ds_read_b64_tr_b16 v[48:49], v27 offset:32768
    v_mfma_f32_16x16x32_bf16 v[244:247], v[56:59], v[72:75], v[244:247]
    buffer_load_dwordx4 v3, s[24:27], s60 offen offset:1024 lds
    v_mfma_f32_16x16x32_bf16 v[244:247], v[60:63], v[76:79], v[244:247]
    ds_read_b64_tr_b16 v[50:51], v27 offset:33344
    ds_read_b64_tr_b16 v[52:53], v27 offset:37376
    v_mfma_f32_16x16x32_bf16 v[248:251], v[56:59], v[80:83], v[248:251]
    ds_read_b64_tr_b16 v[54:55], v27 offset:37952
    v_add_u32 v26, 0x10000, v26
    v_mfma_f32_16x16x32_bf16 v[248:251], v[60:63], v[84:87], v[248:251]
    v_add_u32 v22, 0x10000, v22
    v_add_u32 v23, 0x10000, v23
    v_mfma_f32_16x16x32_bf16 v[252:255], v[56:59], v[88:91], v[252:255]
    buffer_load_dwordx4 v4, s[24:27], s60 offen offset:2048 lds
    v_mfma_f32_16x16x32_bf16 v[252:255], v[60:63], v[92:95], v[252:255]
    s_waitcnt lgkmcnt(3)
    ds_read_b64_tr_b16 v[56:57], v28 offset:32768
    ds_read_b64_tr_b16 v[58:59], v28 offset:33344
    v_mfma_f32_16x16x32_bf16 a[64:67], v[40:43], v[64:67], a[64:67]
    ds_read_b64_tr_b16 v[60:61], v28 offset:37376
    ds_read_b64_tr_b16 v[62:63], v28 offset:37952
    v_mfma_f32_16x16x32_bf16 a[64:67], v[44:47], v[68:71], a[64:67]
    v_add_u32 v27, 0x10000, v27
    v_add_u32 v28, 0x10000, v28
    v_mfma_f32_16x16x32_bf16 a[68:71], v[40:43], v[72:75], a[68:71]
    buffer_load_dwordx4 v5, s[24:27], s60 offen offset:3072 lds
    v_mfma_f32_16x16x32_bf16 a[68:71], v[44:47], v[76:79], a[68:71]
    ds_read_b128 v[112:115], v24 offset:49152
    v_mfma_f32_16x16x32_bf16 a[72:75], v[40:43], v[80:83], a[72:75]
    v_mfma_f32_16x16x32_bf16 a[72:75], v[44:47], v[84:87], a[72:75]
    s_add_u32 m0, s69, 147456
    v_mfma_f32_16x16x32_bf16 a[76:79], v[40:43], v[88:91], a[76:79]
    s_add_u32 s60, s60, 524288
    buffer_load_dwordx4 v10, s[20:23], s63 offen lds
    v_mfma_f32_16x16x32_bf16 a[76:79], v[44:47], v[92:95], a[76:79]
    ds_read_b128 v[116:119], v25 offset:49152
    v_mfma_f32_16x16x32_bf16 a[128:131], v[40:43], a[136:139], a[128:131]
    ds_read_b64_tr_b16 v[40:41], v29 offset:32768
    ds_read_b64_tr_b16 v[42:43], v29 offset:33344
    v_mfma_f32_16x16x32_bf16 a[128:131], v[44:47], a[140:143], a[128:131]
    s_mov_b64 exec, s[86:87]
    ds_read_b128 v[40:43], v30 offset:32768
    s_mov_b64 exec, -1
    s_waitcnt lgkmcnt(4)
    v_mfma_f32_16x16x32_bf16 a[80:83], v[48:51], v[64:67], a[80:83]
    buffer_load_dwordx4 v11, s[20:23], s63 offen offset:1024 lds
    v_mfma_f32_16x16x32_bf16 a[80:83], v[52:55], v[68:71], a[80:83]
    ds_read_b128 v[120:123], v24 offset:57344
    ds_read_b64_tr_b16 v[44:45], v29 offset:37376
    v_mfma_f32_16x16x32_bf16 a[84:87], v[48:51], v[72:75], a[84:87]
    ds_read_b64_tr_b16 v[46:47], v29 offset:37952
    v_add_u32 v29, 0x10000, v29
    v_mfma_f32_16x16x32_bf16 a[84:87], v[52:55], v[76:79], a[84:87]
    s_mov_b64 exec, s[86:87]
    ds_read_b128 v[44:47], v30 offset:32832
    s_mov_b64 exec, -1
    v_mfma_f32_16x16x32_bf16 a[88:91], v[48:51], v[80:83], a[88:91]
    buffer_load_dwordx4 v12, s[20:23], s63 offen offset:2048 lds
    v_mfma_f32_16x16x32_bf16 a[88:91], v[52:55], v[84:87], a[88:91]
    ds_read_b128 v[124:127], v25 offset:57344
    v_add_u32 v30, 0x10000, v30
    v_mfma_f32_16x16x32_bf16 a[92:95], v[48:51], v[88:91], a[92:95]
    v_mfma_f32_16x16x32_bf16 a[92:95], v[52:55], v[92:95], a[92:95]
    v_mfma_f32_16x16x32_bf16 a[132:135], v[48:51], a[136:139], a[132:135]
    buffer_load_dwordx4 v13, s[20:23], s63 offen offset:3072 lds
    v_mfma_f32_16x16x32_bf16 a[132:135], v[52:55], a[140:143], a[132:135]
    v_mfma_f32_16x16x32_bf16 a[96:99], v[56:59], v[64:67], a[96:99]
    v_mfma_f32_16x16x32_bf16 a[96:99], v[60:63], v[68:71], a[96:99]
    s_add_u32 s63, s63, 128
    v_mfma_f32_16x16x32_bf16 a[100:103], v[56:59], v[72:75], a[100:103]
    v_mfma_f32_16x16x32_bf16 a[100:103], v[60:63], v[76:79], a[100:103]
    v_mfma_f32_16x16x32_bf16 a[104:107], v[56:59], v[80:83], a[104:107]
    v_mfma_f32_16x16x32_bf16 a[104:107], v[60:63], v[84:87], a[104:107]
    s_waitcnt vmcnt(19)
    s_barrier
    ds_read_b64_tr_b16 v[48:49], v14 offset:0
    v_mfma_f32_16x16x32_bf16 a[108:111], v[56:59], v[88:91], a[108:111]
    s_add_u32 m0, s69, 0
    ds_read_b64_tr_b16 v[50:51], v14 offset:1024
    ds_read_b64_tr_b16 v[52:53], v14 offset:8192
    v_mfma_f32_16x16x32_bf16 a[108:111], v[60:63], v[92:95], a[108:111]
    s_waitcnt lgkmcnt(3)
    buffer_load_dwordx4 v6, s[28:31], s65 offen lds
    v_mfma_f32_16x16x32_bf16 a[112:115], v[40:43], v[64:67], a[112:115]
    ds_read_b64_tr_b16 v[54:55], v14 offset:9216
    ds_read_b64_tr_b16 v[56:57], v15 offset:0
    v_mfma_f32_16x16x32_bf16 a[112:115], v[44:47], v[68:71], a[112:115]
    ds_read_b64_tr_b16 v[58:59], v15 offset:1024
    ds_read_b64_tr_b16 v[60:61], v15 offset:8192
    v_mfma_f32_16x16x32_bf16 a[116:119], v[40:43], v[72:75], a[116:119]
    ds_read_b64_tr_b16 v[62:63], v15 offset:9216
    v_add_u32 v14, 0x10000, v14
    v_mfma_f32_16x16x32_bf16 a[116:119], v[44:47], v[76:79], a[116:119]
    v_add_u32 v15, 0x10000, v15
    v_mfma_f32_16x16x32_bf16 a[120:123], v[40:43], v[80:83], a[120:123]
    s_add_u32 m0, s69, 1024
    v_mfma_f32_16x16x32_bf16 a[120:123], v[44:47], v[84:87], a[120:123]
    buffer_load_dwordx4 v7, s[32:35], s66 offen lds
    v_mfma_f32_16x16x32_bf16 a[124:127], v[40:43], v[88:91], a[124:127]
    ds_read_b64_tr_b16 v[40:41], v16 offset:0
    ds_read_b64_tr_b16 v[42:43], v16 offset:1024
    v_mfma_f32_16x16x32_bf16 a[124:127], v[44:47], v[92:95], a[124:127]
    s_waitcnt lgkmcnt(2)
    ds_read_b64_tr_b16 v[44:45], v16 offset:8192
    ds_read_b64_tr_b16 v[46:47], v16 offset:9216
    v_mfma_f32_16x16x32_bf16 v[128:131], v[48:51], v[96:99], v[128:131]
    v_add_u32 v16, 0x10000, v16
    v_accvgpr_write_b32 a0, 0
    v_mfma_f32_16x16x32_bf16 v[128:131], v[52:55], v[100:103], v[128:131]
    v_add_u32 v24, 0x10000, v24
    v_mfma_f32_16x16x32_bf16 v[132:135], v[48:51], v[104:107], v[132:135]
    ds_read_b128 v[64:67], v24 offset:16384
    v_accvgpr_write_b32 a1, 0
    v_mfma_f32_16x16x32_bf16 v[132:135], v[52:55], v[108:111], v[132:135]
    v_mfma_f32_16x16x32_bf16 v[136:139], v[48:51], v[112:115], v[136:139]
    s_add_u32 m0, s69, 2048
    v_accvgpr_write_b32 a2, 0
    v_mfma_f32_16x16x32_bf16 v[136:139], v[52:55], v[116:119], v[136:139]
    buffer_load_dwordx4 v8, s[32:35], s66 offen lds
    v_mfma_f32_16x16x32_bf16 v[140:143], v[48:51], v[120:123], v[140:143]
    ds_read_b64_tr_b16 v[48:49], v17 offset:0
    ds_read_b64_tr_b16 v[50:51], v17 offset:1024
    v_mfma_f32_16x16x32_bf16 v[140:143], v[52:55], v[124:127], v[140:143]
    ds_read_b64_tr_b16 v[52:53], v17 offset:8192
    ds_read_b64_tr_b16 v[54:55], v17 offset:9216
    v_mfma_f32_16x16x32_bf16 v[144:147], v[56:59], v[96:99], v[144:147]
    v_add_u32 v17, 0x10000, v17
    v_accvgpr_write_b32 a3, 0
    v_mfma_f32_16x16x32_bf16 v[144:147], v[60:63], v[100:103], v[144:147]
    v_accvgpr_write_b32 a4, 0
    v_mfma_f32_16x16x32_bf16 v[148:151], v[56:59], v[104:107], v[148:151]
    v_accvgpr_write_b32 a5, 0
    v_mfma_f32_16x16x32_bf16 v[148:151], v[60:63], v[108:111], v[148:151]
    s_add_u32 m0, s69, 3072
    v_mfma_f32_16x16x32_bf16 v[152:155], v[56:59], v[112:115], v[152:155]
    v_add_u32 v25, 0x10000, v25
    v_accvgpr_write_b32 a6, 0
    v_mfma_f32_16x16x32_bf16 v[152:155], v[60:63], v[116:119], v[152:155]
    buffer_load_dwordx4 v9, s[32:35], s66 offen lds
    v_mfma_f32_16x16x32_bf16 v[156:159], v[56:59], v[120:123], v[156:159]
    ds_read_b128 v[68:71], v25 offset:16384
    ds_read_b64_tr_b16 v[56:57], v18 offset:0
    v_mfma_f32_16x16x32_bf16 v[156:159], v[60:63], v[124:127], v[156:159]
    s_waitcnt lgkmcnt(2)
    ds_read_b64_tr_b16 v[58:59], v18 offset:1024
    ds_read_b64_tr_b16 v[60:61], v18 offset:8192
    v_mfma_f32_16x16x32_bf16 v[160:163], v[40:43], v[96:99], v[160:163]
    ds_read_b64_tr_b16 v[62:63], v18 offset:9216
    v_add_u32 v18, 0x10000, v18
    v_mfma_f32_16x16x32_bf16 v[160:163], v[44:47], v[100:103], v[160:163]
    v_accvgpr_write_b32 a7, 0
    v_accvgpr_write_b32 a8, 0
    v_mfma_f32_16x16x32_bf16 v[164:167], v[40:43], v[104:107], v[164:167]
    v_accvgpr_write_b32 a9, 0
    v_mfma_f32_16x16x32_bf16 v[164:167], v[44:47], v[108:111], v[164:167]
    s_add_u32 m0, s69, 16384
    v_mfma_f32_16x16x32_bf16 v[168:171], v[40:43], v[112:115], v[168:171]
    s_add_u32 s65, s65, s67
    buffer_load_dwordx4 v10, s[20:23], s64 offen lds
    v_mfma_f32_16x16x32_bf16 v[168:171], v[44:47], v[116:119], v[168:171]
    s_add_u32 s66, s66, s68
    v_accvgpr_write_b32 a10, 0
    v_mfma_f32_16x16x32_bf16 v[172:175], v[40:43], v[120:123], v[172:175]
    ds_read_b64_tr_b16 v[40:41], v19 offset:0
    ds_read_b64_tr_b16 v[42:43], v19 offset:1024
    v_mfma_f32_16x16x32_bf16 v[172:175], v[44:47], v[124:127], v[172:175]
    ds_read_b64_tr_b16 v[44:45], v19 offset:8192
    ds_read_b64_tr_b16 v[46:47], v19 offset:9216
    v_mfma_f32_16x16x32_bf16 v[176:179], v[48:51], v[96:99], v[176:179]
    ds_read_b128 v[72:75], v24 offset:24576
    v_add_u32 v19, 0x10000, v19
    v_mfma_f32_16x16x32_bf16 v[176:179], v[52:55], v[100:103], v[176:179]
    v_accvgpr_write_b32 a11, 0
    v_accvgpr_write_b32 a12, 0
    v_mfma_f32_16x16x32_bf16 v[180:183], v[48:51], v[104:107], v[180:183]
    v_accvgpr_write_b32 a13, 0
    v_mfma_f32_16x16x32_bf16 v[180:183], v[52:55], v[108:111], v[180:183]
    buffer_load_dwordx4 v11, s[20:23], s64 offen offset:1024 lds
    v_mfma_f32_16x16x32_bf16 v[184:187], v[48:51], v[112:115], v[184:187]
    v_accvgpr_write_b32 a14, 0
    v_mfma_f32_16x16x32_bf16 v[184:187], v[52:55], v[116:119], v[184:187]
    v_mfma_f32_16x16x32_bf16 v[188:191], v[48:51], v[120:123], v[188:191]
    ds_read_b64_tr_b16 v[48:49], v20 offset:0
    ds_read_b64_tr_b16 v[50:51], v20 offset:1024
    v_mfma_f32_16x16x32_bf16 v[188:191], v[52:55], v[124:127], v[188:191]
    s_waitcnt lgkmcnt(2)
    ds_read_b64_tr_b16 v[52:53], v20 offset:8192
    ds_read_b64_tr_b16 v[54:55], v20 offset:9216
    v_mfma_f32_16x16x32_bf16 v[192:195], v[56:59], v[96:99], v[192:195]
    v_add_u32 v20, 0x10000, v20
    v_accvgpr_write_b32 a15, 0
    v_mfma_f32_16x16x32_bf16 v[192:195], v[60:63], v[100:103], v[192:195]
    v_accvgpr_write_b32 a16, 0
    v_mfma_f32_16x16x32_bf16 v[196:199], v[56:59], v[104:107], v[196:199]
    v_accvgpr_write_b32 a17, 0
    v_mfma_f32_16x16x32_bf16 v[196:199], v[60:63], v[108:111], v[196:199]
    buffer_load_dwordx4 v12, s[20:23], s64 offen offset:2048 lds
    v_mfma_f32_16x16x32_bf16 v[200:203], v[56:59], v[112:115], v[200:203]
    ds_read_b128 v[76:79], v25 offset:24576
    v_accvgpr_write_b32 a18, 0
    v_mfma_f32_16x16x32_bf16 v[200:203], v[60:63], v[116:119], v[200:203]
    v_mfma_f32_16x16x32_bf16 v[204:207], v[56:59], v[120:123], v[204:207]
    ds_read_b64_tr_b16 v[56:57], v21 offset:0
    ds_read_b64_tr_b16 v[58:59], v21 offset:1024
    v_mfma_f32_16x16x32_bf16 v[204:207], v[60:63], v[124:127], v[204:207]
    ds_read_b64_tr_b16 v[60:61], v21 offset:8192
    ds_read_b64_tr_b16 v[62:63], v21 offset:9216
    v_mfma_f32_16x16x32_bf16 v[208:211], v[40:43], v[96:99], v[208:211]
    v_add_u32 v21, 0x10000, v21
    v_accvgpr_write_b32 a19, 0
    v_mfma_f32_16x16x32_bf16 v[208:211], v[44:47], v[100:103], v[208:211]
    v_accvgpr_write_b32 a20, 0
    v_mfma_f32_16x16x32_bf16 v[212:215], v[40:43], v[104:107], v[212:215]
    buffer_load_dwordx4 v13, s[20:23], s64 offen offset:3072 lds
    v_mfma_f32_16x16x32_bf16 v[212:215], v[44:47], v[108:111], v[212:215]
    v_accvgpr_write_b32 a21, 0
    v_mfma_f32_16x16x32_bf16 v[216:219], v[40:43], v[112:115], v[216:219]
    v_accvgpr_write_b32 a22, 0
    v_mfma_f32_16x16x32_bf16 v[216:219], v[44:47], v[116:119], v[216:219]
    v_mfma_f32_16x16x32_bf16 v[220:223], v[40:43], v[120:123], v[220:223]
    v_accvgpr_write_b32 a23, 0
    v_mfma_f32_16x16x32_bf16 v[220:223], v[44:47], v[124:127], v[220:223]
    s_waitcnt lgkmcnt(0)
    v_mfma_f32_16x16x32_bf16 v[224:227], v[48:51], v[96:99], v[224:227]
    v_accvgpr_write_b32 a24, 0
    v_mfma_f32_16x16x32_bf16 v[224:227], v[52:55], v[100:103], v[224:227]
    s_add_u32 s64, s64, 128
    v_mfma_f32_16x16x32_bf16 v[228:231], v[48:51], v[104:107], v[228:231]
    v_accvgpr_write_b32 a25, 0
    v_mfma_f32_16x16x32_bf16 v[228:231], v[52:55], v[108:111], v[228:231]
    v_mfma_f32_16x16x32_bf16 v[232:235], v[48:51], v[112:115], v[232:235]
    v_accvgpr_write_b32 a26, 0
    v_mfma_f32_16x16x32_bf16 v[232:235], v[52:55], v[116:119], v[232:235]
    s_waitcnt vmcnt(16)
    s_barrier
    ds_read_b64_tr_b16 v[40:41], v26 offset:32768
    v_mfma_f32_16x16x32_bf16 v[236:239], v[48:51], v[120:123], v[236:239]
    s_add_u32 m0, s69, 32768
    ds_read_b64_tr_b16 v[42:43], v26 offset:33344
    ds_read_b64_tr_b16 v[44:45], v26 offset:37376
    v_mfma_f32_16x16x32_bf16 v[236:239], v[52:55], v[124:127], v[236:239]
    buffer_load_dwordx4 v2, s[24:27], s60 offen lds
    v_mfma_f32_16x16x32_bf16 v[240:243], v[56:59], v[96:99], v[240:243]
    ds_read_b64_tr_b16 v[46:47], v26 offset:37952
    ds_read_b128 a[136:139], v22 offset:32768
    v_mfma_f32_16x16x32_bf16 v[240:243], v[60:63], v[100:103], v[240:243]
    ds_read_b128 a[140:143], v23 offset:32768
    ds_read_b64_tr_b16 v[48:49], v27 offset:32768
    v_mfma_f32_16x16x32_bf16 v[244:247], v[56:59], v[104:107], v[244:247]
    buffer_load_dwordx4 v3, s[24:27], s60 offen offset:1024 lds
    v_mfma_f32_16x16x32_bf16 v[244:247], v[60:63], v[108:111], v[244:247]
    ds_read_b64_tr_b16 v[50:51], v27 offset:33344
    ds_read_b64_tr_b16 v[52:53], v27 offset:37376
    v_mfma_f32_16x16x32_bf16 v[248:251], v[56:59], v[112:115], v[248:251]
    ds_read_b64_tr_b16 v[54:55], v27 offset:37952
    v_add_u32 v26, 0xffff0000, v26
    v_mfma_f32_16x16x32_bf16 v[248:251], v[60:63], v[116:119], v[248:251]
    v_add_u32 v22, 0xffff0000, v22
    v_add_u32 v23, 0xffff0000, v23
    v_mfma_f32_16x16x32_bf16 v[252:255], v[56:59], v[120:123], v[252:255]
    buffer_load_dwordx4 v4, s[24:27], s60 offen offset:2048 lds
    v_mfma_f32_16x16x32_bf16 v[252:255], v[60:63], v[124:127], v[252:255]
    s_waitcnt lgkmcnt(3)
    ds_read_b64_tr_b16 v[56:57], v28 offset:32768
    ds_read_b64_tr_b16 v[58:59], v28 offset:33344
    v_mfma_f32_16x16x32_bf16 a[64:67], v[40:43], v[96:99], a[64:67]
    ds_read_b64_tr_b16 v[60:61], v28 offset:37376
    ds_read_b64_tr_b16 v[62:63], v28 offset:37952
    v_mfma_f32_16x16x32_bf16 a[64:67], v[44:47], v[100:103], a[64:67]
    v_add_u32 v27, 0xffff0000, v27
    v_add_u32 v28, 0xffff0000, v28
    v_mfma_f32_16x16x32_bf16 a[68:71], v[40:43], v[104:107], a[68:71]
    buffer_load_dwordx4 v5, s[24:27], s60 offen offset:3072 lds
    v_mfma_f32_16x16x32_bf16 a[68:71], v[44:47], v[108:111], a[68:71]
    ds_read_b128 v[80:83], v24 offset:49152
    v_accvgpr_write_b32 a27, 0
    v_mfma_f32_16x16x32_bf16 a[72:75], v[40:43], v[112:115], a[72:75]
    v_accvgpr_write_b32 a28, 0
    v_accvgpr_write_b32 a29, 0
    v_mfma_f32_16x16x32_bf16 a[72:75], v[44:47], v[116:119], a[72:75]
    s_add_u32 m0, s69, 49152
    v_accvgpr_write_b32 a30, 0
    v_accvgpr_write_b32 a31, 0
    v_mfma_f32_16x16x32_bf16 a[76:79], v[40:43], v[120:123], a[76:79]
    s_add_u32 s60, s60, 524288
    buffer_load_dwordx4 v10, s[20:23], s63 offen lds
    v_mfma_f32_16x16x32_bf16 a[76:79], v[44:47], v[124:127], a[76:79]
    ds_read_b128 v[84:87], v25 offset:49152
    v_accvgpr_write_b32 a32, 0
    v_mfma_f32_16x16x32_bf16 a[128:131], v[40:43], a[136:139], a[128:131]
    ds_read_b64_tr_b16 v[40:41], v29 offset:32768
    ds_read_b64_tr_b16 v[42:43], v29 offset:33344
    v_mfma_f32_16x16x32_bf16 a[128:131], v[44:47], a[140:143], a[128:131]
    s_mov_b64 exec, s[86:87]
    ds_read_b128 v[40:43], v30 offset:32768
    s_mov_b64 exec, -1
    s_waitcnt lgkmcnt(4)
    v_mfma_f32_16x16x32_bf16 a[80:83], v[48:51], v[96:99], a[80:83]
    buffer_load_dwordx4 v11, s[20:23], s63 offen offset:1024 lds
    v_mfma_f32_16x16x32_bf16 a[80:83], v[52:55], v[100:103], a[80:83]
    ds_read_b128 v[88:91], v24 offset:57344
    ds_read_b64_tr_b16 v[44:45], v29 offset:37376
    v_mfma_f32_16x16x32_bf16 a[84:87], v[48:51], v[104:107], a[84:87]
    ds_read_b64_tr_b16 v[46:47], v29 offset:37952
    v_add_u32 v29, 0xffff0000, v29
    v_mfma_f32_16x16x32_bf16 a[84:87], v[52:55], v[108:111], a[84:87]
    s_mov_b64 exec, s[86:87]
    ds_read_b128 v[44:47], v30 offset:32832
    s_mov_b64 exec, -1
    v_mfma_f32_16x16x32_bf16 a[88:91], v[48:51], v[112:115], a[88:91]
    buffer_load_dwordx4 v12, s[20:23], s63 offen offset:2048 lds
    v_mfma_f32_16x16x32_bf16 a[88:91], v[52:55], v[116:119], a[88:91]
    ds_read_b128 v[92:95], v25 offset:57344
    v_add_u32 v30, 0xffff0000, v30
    v_mfma_f32_16x16x32_bf16 a[92:95], v[48:51], v[120:123], a[92:95]
    v_accvgpr_write_b32 a33, 0
    v_accvgpr_write_b32 a34, 0
    v_mfma_f32_16x16x32_bf16 a[92:95], v[52:55], v[124:127], a[92:95]
    v_accvgpr_write_b32 a35, 0
    v_accvgpr_write_b32 a36, 0
    v_mfma_f32_16x16x32_bf16 a[132:135], v[48:51], a[136:139], a[132:135]
    buffer_load_dwordx4 v13, s[20:23], s63 offen offset:3072 lds
    v_mfma_f32_16x16x32_bf16 a[132:135], v[52:55], a[140:143], a[132:135]
    v_accvgpr_write_b32 a37, 0
    v_accvgpr_write_b32 a38, 0
    v_mfma_f32_16x16x32_bf16 a[96:99], v[56:59], v[96:99], a[96:99]
    v_accvgpr_write_b32 a39, 0
    v_accvgpr_write_b32 a40, 0
    v_mfma_f32_16x16x32_bf16 a[96:99], v[60:63], v[100:103], a[96:99]
    s_add_u32 s63, s63, 128
    v_accvgpr_write_b32 a41, 0
    v_accvgpr_write_b32 a42, 0
    v_mfma_f32_16x16x32_bf16 a[100:103], v[56:59], v[104:107], a[100:103]
    v_accvgpr_write_b32 a43, 0
    v_mfma_f32_16x16x32_bf16 a[100:103], v[60:63], v[108:111], a[100:103]
    v_mfma_f32_16x16x32_bf16 a[104:107], v[56:59], v[112:115], a[104:107]
    v_accvgpr_write_b32 a44, 0
    v_mfma_f32_16x16x32_bf16 a[104:107], v[60:63], v[116:119], a[104:107]
    s_waitcnt vmcnt(16)
    s_barrier
    ds_read_b64_tr_b16 v[48:49], v14 offset:0
    v_mfma_f32_16x16x32_bf16 a[108:111], v[56:59], v[120:123], a[108:111]
    s_add_u32 m0, s69, 65536
    ds_read_b64_tr_b16 v[50:51], v14 offset:1024
    ds_read_b64_tr_b16 v[52:53], v14 offset:8192
    v_mfma_f32_16x16x32_bf16 a[108:111], v[60:63], v[124:127], a[108:111]
    s_waitcnt lgkmcnt(3)
    buffer_load_dwordx4 v6, s[28:31], s65 offen lds
    v_mfma_f32_16x16x32_bf16 a[112:115], v[40:43], v[96:99], a[112:115]
    ds_read_b64_tr_b16 v[54:55], v14 offset:9216
    ds_read_b64_tr_b16 v[56:57], v15 offset:0
    v_mfma_f32_16x16x32_bf16 a[112:115], v[44:47], v[100:103], a[112:115]
    buffer_atomic_add v33, v32, s[44:47], s72 offen sc1
    v_mfma_f32_16x16x32_bf16 a[116:119], v[40:43], v[104:107], a[116:119]
    s_add_u32 s72, s7, 128
    ds_read_b64_tr_b16 v[58:59], v15 offset:1024
    ds_read_b64_tr_b16 v[60:61], v15 offset:8192
    v_mfma_f32_16x16x32_bf16 a[116:119], v[44:47], v[108:111], a[116:119]
    s_mul_i32 s72, s72, 36
    ds_read_b64_tr_b16 v[62:63], v15 offset:9216
    v_add_u32 v14, 0xfffe0000, v14
    v_mfma_f32_16x16x32_bf16 a[120:123], v[40:43], v[112:115], a[120:123]
    s_add_u32 m0, s69, 66560
    v_add_u32 v15, 0xfffe0000, v15
    v_accvgpr_write_b32 a45, 0
    v_mfma_f32_16x16x32_bf16 a[120:123], v[44:47], v[116:119], a[120:123]
    s_add_u32 s72, s72, s3
    buffer_load_dwordx4 v7, s[32:35], s66 offen lds
    v_mfma_f32_16x16x32_bf16 a[124:127], v[40:43], v[120:123], a[124:127]
    s_lshl_b32 s3, s3, 5
    ds_read_b64_tr_b16 v[40:41], v16 offset:0
    ds_read_b64_tr_b16 v[42:43], v16 offset:1024
    v_mfma_f32_16x16x32_bf16 a[124:127], v[44:47], v[124:127], a[124:127]
    s_lshl_b32 s72, s72, 10
    ds_read_b64_tr_b16 v[44:45], v16 offset:8192
    ds_read_b64_tr_b16 v[46:47], v16 offset:9216
    s_waitcnt lgkmcnt(5)
    v_mfma_f32_16x16x32_bf16 v[128:131], v[48:51], v[64:67], v[128:131]
    v_add_u32 v16, 0xfffe0000, v16
    v_accvgpr_write_b32 a46, 0
    v_mfma_f32_16x16x32_bf16 v[128:131], v[52:55], v[68:71], v[128:131]
    v_add_u32 v24, 0x10000, v24
    v_accvgpr_write_b32 a47, 0
    v_mfma_f32_16x16x32_bf16 v[132:135], v[48:51], v[72:75], v[132:135]
    ds_read_b128 v[96:99], v24 offset:16384
    v_accvgpr_write_b32 a48, 0
    v_mfma_f32_16x16x32_bf16 v[132:135], v[52:55], v[76:79], v[132:135]
    v_accvgpr_write_b32 a49, 0
    v_lshrrev_b32 v32, 7, v1
    v_mfma_f32_16x16x32_bf16 v[136:139], v[48:51], v[80:83], v[136:139]
    s_add_u32 m0, s69, 67584
    v_accvgpr_write_b32 a50, 0
    v_mul_u32_u24 v32, 1152, v32
    v_mfma_f32_16x16x32_bf16 v[136:139], v[52:55], v[84:87], v[136:139]
    buffer_load_dwordx4 v8, s[32:35], s66 offen lds
    v_mfma_f32_16x16x32_bf16 v[140:143], v[48:51], v[88:91], v[140:143]
    ds_read_b64_tr_b16 v[48:49], v17 offset:0
    ds_read_b64_tr_b16 v[50:51], v17 offset:1024
    v_mfma_f32_16x16x32_bf16 v[140:143], v[52:55], v[92:95], v[140:143]
    ds_read_b64_tr_b16 v[52:53], v17 offset:8192
    ds_read_b64_tr_b16 v[54:55], v17 offset:9216
    v_mfma_f32_16x16x32_bf16 v[144:147], v[56:59], v[64:67], v[144:147]
    s_waitcnt lgkmcnt(4)
    v_add_u32 v17, 0xfffe0000, v17
    v_accvgpr_write_b32 a51, 0
    v_mfma_f32_16x16x32_bf16 v[144:147], v[60:63], v[68:71], v[144:147]
    v_accvgpr_write_b32 a52, 0
    v_and_b32 v33, 0x70, v1
    v_mfma_f32_16x16x32_bf16 v[148:151], v[56:59], v[72:75], v[148:151]
    v_accvgpr_write_b32 a53, 0
    v_add3_u32 v32, v32, v33, s99
    v_mfma_f32_16x16x32_bf16 v[148:151], v[60:63], v[76:79], v[148:151]
    s_add_u32 m0, s69, 68608
    v_bfe_u32 v33, v1, 6, 2
    v_mfma_f32_16x16x32_bf16 v[152:155], v[56:59], v[80:83], v[152:155]
    v_add_u32 v25, 0x10000, v25
    v_accvgpr_write_b32 a54, 0
    v_mfma_f32_16x16x32_bf16 v[152:155], v[60:63], v[84:87], v[152:155]
    buffer_load_dwordx4 v9, s[32:35], s66 offen lds
    v_mfma_f32_16x16x32_bf16 v[156:159], v[56:59], v[88:91], v[156:159]
    ds_read_b128 v[100:103], v25 offset:16384
    ds_read_b64_tr_b16 v[56:57], v18 offset:0
    v_mfma_f32_16x16x32_bf16 v[156:159], v[60:63], v[92:95], v[156:159]
    ds_read_b64_tr_b16 v[58:59], v18 offset:1024
    ds_read_b64_tr_b16 v[60:61], v18 offset:8192
    v_mfma_f32_16x16x32_bf16 v[160:163], v[40:43], v[64:67], v[160:163]
    ds_read_b64_tr_b16 v[62:63], v18 offset:9216
    v_add_u32 v18, 0xfffe0000, v18
    v_mfma_f32_16x16x32_bf16 v[160:163], v[44:47], v[68:71], v[160:163]
    v_accvgpr_write_b32 a55, 0
    v_accvgpr_write_b32 a56, 0
    v_mfma_f32_16x16x32_bf16 v[164:167], v[40:43], v[72:75], v[164:167]
    v_accvgpr_write_b32 a57, 0
    v_mfma_f32_16x16x32_bf16 v[164:167], v[44:47], v[76:79], v[164:167]
    s_add_u32 m0, s69, 81920
    v_mfma_f32_16x16x32_bf16 v[168:171], v[40:43], v[80:83], v[168:171]
    s_add_u32 s65, s65, s67
    buffer_load_dwordx4 v10, s[20:23], s64 offen lds
    v_mfma_f32_16x16x32_bf16 v[168:171], v[44:47], v[84:87], v[168:171]
    s_add_u32 s66, s66, s68
    v_accvgpr_write_b32 a58, 0
    v_add_u32 v10, 0, v32
    v_mfma_f32_16x16x32_bf16 v[172:175], v[40:43], v[88:91], v[172:175]
    ds_read_b64_tr_b16 v[40:41], v19 offset:0
    ds_read_b64_tr_b16 v[42:43], v19 offset:1024
    v_mfma_f32_16x16x32_bf16 v[172:175], v[44:47], v[92:95], v[172:175]
    s_waitcnt lgkmcnt(2)
    ds_read_b64_tr_b16 v[44:45], v19 offset:8192
    ds_read_b64_tr_b16 v[46:47], v19 offset:9216
    v_mfma_f32_16x16x32_bf16 v[176:179], v[48:51], v[64:67], v[176:179]
    ds_read_b128 v[104:107], v24 offset:24576
    v_add_u32 v19, 0xfffe0000, v19
    v_mfma_f32_16x16x32_bf16 v[176:179], v[52:55], v[68:71], v[176:179]
    v_accvgpr_write_b32 a59, 0
    v_accvgpr_write_b32 a60, 0
    v_mfma_f32_16x16x32_bf16 v[180:183], v[48:51], v[72:75], v[180:183]
    v_accvgpr_write_b32 a61, 0
    v_mfma_f32_16x16x32_bf16 v[180:183], v[52:55], v[76:79], v[180:183]
    buffer_load_dwordx4 v11, s[20:23], s64 offen offset:1024 lds
    v_mfma_f32_16x16x32_bf16 v[184:187], v[48:51], v[80:83], v[184:187]
    v_accvgpr_write_b32 a62, 0
    v_add_u32 v11, 8192, v32
    v_mfma_f32_16x16x32_bf16 v[184:187], v[52:55], v[84:87], v[184:187]
    s_cmp_eq_u32 s4, 0
    s_cselect_b32 s71, s71, s72
    v_mfma_f32_16x16x32_bf16 v[188:191], v[48:51], v[88:91], v[188:191]
    ds_read_b64_tr_b16 v[48:49], v20 offset:0
    ds_read_b64_tr_b16 v[50:51], v20 offset:1024
    v_mfma_f32_16x16x32_bf16 v[188:191], v[52:55], v[92:95], v[188:191]
    ds_read_b64_tr_b16 v[52:53], v20 offset:8192
    ds_read_b64_tr_b16 v[54:55], v20 offset:9216
    v_mfma_f32_16x16x32_bf16 v[192:195], v[56:59], v[64:67], v[192:195]
    v_add_u32 v20, 0xfffe0000, v20
    v_accvgpr_write_b32 a63, 0
    v_mfma_f32_16x16x32_bf16 v[192:195], v[60:63], v[68:71], v[192:195]
    v_accvgpr_write_b32 a144, 0
    v_mfma_f32_16x16x32_bf16 v[196:199], v[56:59], v[72:75], v[196:199]
    v_accvgpr_write_b32 a145, 0
    v_mfma_f32_16x16x32_bf16 v[196:199], v[60:63], v[76:79], v[196:199]
    buffer_load_dwordx4 v12, s[20:23], s64 offen offset:2048 lds
    v_mfma_f32_16x16x32_bf16 v[200:203], v[56:59], v[80:83], v[200:203]
    ds_read_b128 v[108:111], v25 offset:24576
    v_accvgpr_write_b32 a146, 0
    v_mfma_f32_16x16x32_bf16 v[200:203], v[60:63], v[84:87], v[200:203]
    v_add_u32 v12, 16384, v32
    v_mfma_f32_16x16x32_bf16 v[204:207], v[56:59], v[88:91], v[204:207]
    ds_read_b64_tr_b16 v[56:57], v21 offset:0
    ds_read_b64_tr_b16 v[58:59], v21 offset:1024
    v_mfma_f32_16x16x32_bf16 v[204:207], v[60:63], v[92:95], v[204:207]
    s_waitcnt lgkmcnt(3)
    ds_read_b64_tr_b16 v[60:61], v21 offset:8192
    ds_read_b64_tr_b16 v[62:63], v21 offset:9216
    v_mfma_f32_16x16x32_bf16 v[208:211], v[40:43], v[64:67], v[208:211]
    v_add_u32 v21, 0xfffe0000, v21
    v_accvgpr_write_b32 a147, 0
    v_mfma_f32_16x16x32_bf16 v[208:211], v[44:47], v[68:71], v[208:211]
    v_accvgpr_write_b32 a148, 0
    v_mfma_f32_16x16x32_bf16 v[212:215], v[40:43], v[72:75], v[212:215]
    buffer_load_dwordx4 v13, s[20:23], s64 offen offset:3072 lds
    v_mfma_f32_16x16x32_bf16 v[212:215], v[44:47], v[76:79], v[212:215]
    v_accvgpr_write_b32 a149, 0
    v_add_u32 v13, 24576, v32
    v_mfma_f32_16x16x32_bf16 v[216:219], v[40:43], v[80:83], v[216:219]
    v_accvgpr_write_b32 a150, 0
    v_lshrrev_b32 v32, 8, v1
    v_mfma_f32_16x16x32_bf16 v[216:219], v[44:47], v[84:87], v[216:219]
    v_lshl_add_u32 v32, s7, 2, v32
    v_lshrrev_b32 v34, 1, v32
    v_mfma_f32_16x16x32_bf16 v[220:223], v[40:43], v[88:91], v[220:223]
    v_accvgpr_write_b32 a151, 0
    v_mul_u32_u24 v34, 18, v34
    v_mfma_f32_16x16x32_bf16 v[220:223], v[44:47], v[92:95], v[220:223]
    v_and_b32 v35, 1, v32
    v_lshl_add_u32 v34, v35, 3, v34
    v_mfma_f32_16x16x32_bf16 v[224:227], v[48:51], v[64:67], v[224:227]
    v_accvgpr_write_b32 a152, 0
    v_lshrrev_b32 v35, 1, v33
    v_mfma_f32_16x16x32_bf16 v[224:227], v[52:55], v[68:71], v[224:227]
    s_add_u32 s64, s64, 128
    v_lshl_add_u32 v35, v32, 2, v35
    v_add_u32 v35, 0xffffff00, v35
    v_mfma_f32_16x16x32_bf16 v[228:231], v[48:51], v[72:75], v[228:231]
    v_accvgpr_write_b32 a153, 0
    v_mul_u32_u24 v35, 18, v35
    v_mfma_f32_16x16x32_bf16 v[228:231], v[52:55], v[76:79], v[228:231]
    v_add3_u32 v34, v34, v33, 0
    v_cmp_gt_u32 vcc, 64, v32
    v_mfma_f32_16x16x32_bf16 v[232:235], v[48:51], v[80:83], v[232:235]
    v_accvgpr_write_b32 a154, 0
    v_mfma_f32_16x16x32_bf16 v[232:235], v[52:55], v[84:87], v[232:235]
    s_waitcnt vmcnt(17)
    s_barrier
    ds_read_b64_tr_b16 v[40:41], v26 offset:0
    v_mfma_f32_16x16x32_bf16 v[236:239], v[48:51], v[88:91], v[236:239]
    s_add_u32 m0, s69, 98304
    ds_read_b64_tr_b16 v[42:43], v26 offset:576
    ds_read_b64_tr_b16 v[44:45], v26 offset:4608
    v_mfma_f32_16x16x32_bf16 v[236:239], v[52:55], v[92:95], v[236:239]
    s_waitcnt lgkmcnt(3)
    buffer_load_dwordx4 v2, s[24:27], s60 offen lds
    v_mfma_f32_16x16x32_bf16 v[240:243], v[56:59], v[64:67], v[240:243]
    ds_read_b64_tr_b16 v[46:47], v26 offset:5184
    ds_read_b128 a[136:139], v22 offset:0
    v_mfma_f32_16x16x32_bf16 v[240:243], v[60:63], v[68:71], v[240:243]
    ds_read_b128 a[140:143], v23 offset:0
    ds_read_b64_tr_b16 v[48:49], v27 offset:0
    v_mfma_f32_16x16x32_bf16 v[244:247], v[56:59], v[72:75], v[244:247]
    buffer_load_dwordx4 v3, s[24:27], s60 offen offset:1024 lds
    v_mfma_f32_16x16x32_bf16 v[244:247], v[60:63], v[76:79], v[244:247]
    ds_read_b64_tr_b16 v[50:51], v27 offset:576
    ds_read_b64_tr_b16 v[52:53], v27 offset:4608
    v_mfma_f32_16x16x32_bf16 v[248:251], v[56:59], v[80:83], v[248:251]
    ds_read_b64_tr_b16 v[54:55], v27 offset:5184
    v_add_u32 v26, 0x10000, v26
    v_mfma_f32_16x16x32_bf16 v[248:251], v[60:63], v[84:87], v[248:251]
    v_add_u32 v22, 0x10000, v22
    v_add_u32 v23, 0x10000, v23
    v_mfma_f32_16x16x32_bf16 v[252:255], v[56:59], v[88:91], v[252:255]
    buffer_load_dwordx4 v4, s[24:27], s60 offen offset:2048 lds
    v_mfma_f32_16x16x32_bf16 v[252:255], v[60:63], v[92:95], v[252:255]
    s_waitcnt lgkmcnt(3)
    ds_read_b64_tr_b16 v[56:57], v28 offset:0
    ds_read_b64_tr_b16 v[58:59], v28 offset:576
    v_mfma_f32_16x16x32_bf16 a[64:67], v[40:43], v[64:67], a[64:67]
    ds_read_b64_tr_b16 v[60:61], v28 offset:4608
    ds_read_b64_tr_b16 v[62:63], v28 offset:5184
    v_mfma_f32_16x16x32_bf16 a[64:67], v[44:47], v[68:71], a[64:67]
    v_add_u32 v24, 0xfffe0000, v24
    v_add_u32 v27, 0x10000, v27
    v_mfma_f32_16x16x32_bf16 a[68:71], v[40:43], v[72:75], a[68:71]
    buffer_load_dwordx4 v5, s[24:27], s60 offen offset:3072 lds
    v_mfma_f32_16x16x32_bf16 a[68:71], v[44:47], v[76:79], a[68:71]
    ds_read_b128 v[112:115], v24 offset:16384
    v_add_u32 v28, 0x10000, v28
    v_mfma_f32_16x16x32_bf16 a[72:75], v[40:43], v[80:83], a[72:75]
    v_accvgpr_write_b32 a155, 0
    v_accvgpr_write_b32 a156, 0
    v_mfma_f32_16x16x32_bf16 a[72:75], v[44:47], v[84:87], a[72:75]
    s_add_u32 m0, s69, 114688
    v_add_u32 v25, 0xfffe0000, v25
    v_accvgpr_write_b32 a157, 0
    v_mfma_f32_16x16x32_bf16 a[76:79], v[40:43], v[88:91], a[76:79]
    s_add_u32 s60, s60, 524288
    buffer_load_dwordx4 v10, s[48:51], 0 offen lds
    v_mfma_f32_16x16x32_bf16 a[76:79], v[44:47], v[92:95], a[76:79]
    ds_read_b128 v[116:119], v25 offset:16384
    v_accvgpr_write_b32 a158, 0
    v_mfma_f32_16x16x32_bf16 a[128:131], v[40:43], a[136:139], a[128:131]
    ds_read_b64_tr_b16 v[40:41], v29 offset:0
    ds_read_b64_tr_b16 v[42:43], v29 offset:576
    v_mfma_f32_16x16x32_bf16 a[128:131], v[44:47], a[140:143], a[128:131]
    s_mov_b64 exec, s[86:87]
    ds_read_b128 v[40:43], v30 offset:0
    s_mov_b64 exec, -1
    s_waitcnt lgkmcnt(4)
    v_mfma_f32_16x16x32_bf16 a[80:83], v[48:51], v[64:67], a[80:83]
    buffer_load_dwordx4 v11, s[48:51], 0 offen offset:1024 lds
    v_mfma_f32_16x16x32_bf16 a[80:83], v[52:55], v[68:71], a[80:83]
    ds_read_b128 v[120:123], v24 offset:24576
    ds_read_b64_tr_b16 v[44:45], v29 offset:4608
    v_mfma_f32_16x16x32_bf16 a[84:87], v[48:51], v[72:75], a[84:87]
    ds_read_b64_tr_b16 v[46:47], v29 offset:5184
    v_add_u32 v29, 0x10000, v29
    v_mfma_f32_16x16x32_bf16 a[84:87], v[52:55], v[76:79], a[84:87]
    s_mov_b64 exec, s[86:87]
    ds_read_b128 v[44:47], v30 offset:64
    s_mov_b64 exec, -1
    v_mfma_f32_16x16x32_bf16 a[88:91], v[48:51], v[80:83], a[88:91]
    buffer_load_dwordx4 v12, s[48:51], 0 offen offset:2048 lds
    v_mfma_f32_16x16x32_bf16 a[88:91], v[52:55], v[84:87], a[88:91]
    ds_read_b128 v[124:127], v25 offset:24576
    v_add_u32 v30, 0x10000, v30
    v_mfma_f32_16x16x32_bf16 a[92:95], v[48:51], v[88:91], a[92:95]
    v_accvgpr_write_b32 a159, 0
    v_accvgpr_write_b32 a160, 0
    v_mfma_f32_16x16x32_bf16 a[92:95], v[52:55], v[92:95], a[92:95]
    v_accvgpr_write_b32 a161, 0
    v_accvgpr_write_b32 a162, 0
    v_mfma_f32_16x16x32_bf16 a[132:135], v[48:51], a[136:139], a[132:135]
    buffer_load_dwordx4 v13, s[48:51], 0 offen offset:3072 lds
    v_mfma_f32_16x16x32_bf16 a[132:135], v[52:55], a[140:143], a[132:135]
    v_accvgpr_write_b32 a163, 0
    v_accvgpr_write_b32 a164, 0
    v_mfma_f32_16x16x32_bf16 a[96:99], v[56:59], v[64:67], a[96:99]
    v_accvgpr_write_b32 a165, 0
    v_accvgpr_write_b32 a166, 0
    v_mfma_f32_16x16x32_bf16 a[96:99], v[60:63], v[68:71], a[96:99]
    v_accvgpr_write_b32 a167, 0
    v_accvgpr_write_b32 a168, 0
    v_mfma_f32_16x16x32_bf16 a[100:103], v[56:59], v[72:75], a[100:103]
    v_accvgpr_write_b32 a169, 0
    v_accvgpr_write_b32 a170, 0
    v_mfma_f32_16x16x32_bf16 a[100:103], v[60:63], v[76:79], a[100:103]
    v_accvgpr_write_b32 a171, 0
    v_and_b32 v2, 1, v33
    v_mfma_f32_16x16x32_bf16 a[104:107], v[56:59], v[80:83], a[104:107]
    v_accvgpr_write_b32 a172, 0
    v_add3_u32 v35, v35, v2, 16
    v_mfma_f32_16x16x32_bf16 a[104:107], v[60:63], v[84:87], a[104:107]
    s_waitcnt vmcnt(17)
    s_barrier
    ds_read_b64_tr_b16 v[48:49], v14 offset:32768
    v_mfma_f32_16x16x32_bf16 a[108:111], v[56:59], v[88:91], a[108:111]
    s_add_u32 m0, s69, 131072
    ds_read_b64_tr_b16 v[50:51], v14 offset:33792
    ds_read_b64_tr_b16 v[52:53], v14 offset:40960
    v_mfma_f32_16x16x32_bf16 a[108:111], v[60:63], v[92:95], a[108:111]
    s_waitcnt lgkmcnt(3)
    buffer_load_dwordx4 v6, s[28:31], s65 offen lds
    v_mfma_f32_16x16x32_bf16 a[112:115], v[40:43], v[64:67], a[112:115]
    ds_read_b64_tr_b16 v[54:55], v14 offset:41984
    ds_read_b64_tr_b16 v[56:57], v15 offset:32768
    v_mfma_f32_16x16x32_bf16 a[112:115], v[44:47], v[68:71], a[112:115]
    ds_read_b64_tr_b16 v[58:59], v15 offset:33792
    ds_read_b64_tr_b16 v[60:61], v15 offset:40960
    v_mfma_f32_16x16x32_bf16 a[116:119], v[40:43], v[72:75], a[116:119]
    ds_read_b64_tr_b16 v[62:63], v15 offset:41984
    v_add_u32 v14, 0x10000, v14
    v_mfma_f32_16x16x32_bf16 a[116:119], v[44:47], v[76:79], a[116:119]
    v_add_u32 v15, 0x10000, v15
    v_accvgpr_write_b32 a173, 0
    v_mfma_f32_16x16x32_bf16 a[120:123], v[40:43], v[80:83], a[120:123]
    v_accvgpr_write_b32 a174, 0
    v_accvgpr_write_b32 a175, 0
    v_mfma_f32_16x16x32_bf16 a[120:123], v[44:47], v[84:87], a[120:123]
    v_cndmask_b32 v34, v35, v34, vcc
    v_lshrrev_b32 v35, 6, v1
    v_mfma_f32_16x16x32_bf16 a[124:127], v[40:43], v[88:91], a[124:127]
    ds_read_b64_tr_b16 v[40:41], v16 offset:32768
    ds_read_b64_tr_b16 v[42:43], v16 offset:33792
    v_mfma_f32_16x16x32_bf16 a[124:127], v[44:47], v[92:95], a[124:127]
    s_add_u32 m0, s69, 132096
    ds_read_b64_tr_b16 v[44:45], v16 offset:40960
    ds_read_b64_tr_b16 v[46:47], v16 offset:41984
    s_waitcnt lgkmcnt(4)
    v_mfma_f32_16x16x32_bf16 v[128:131], v[48:51], v[96:99], v[128:131]
    buffer_load_dwordx4 v7, s[32:35], s66 offen lds
    v_mfma_f32_16x16x32_bf16 v[128:131], v[52:55], v[100:103], v[128:131]
    v_add_u32 v16, 0x10000, v16
    v_accvgpr_write_b32 a176, 0
    v_mfma_f32_16x16x32_bf16 v[132:135], v[48:51], v[104:107], v[132:135]
    ds_read_b128 v[64:67], v24 offset:49152
    v_accvgpr_write_b32 a177, 0
    v_mfma_f32_16x16x32_bf16 v[132:135], v[52:55], v[108:111], v[132:135]
    v_mul_u32_u24 v35, 1152, v35
    v_mul_u32_u24 v34, 1152, v34
    v_mfma_f32_16x16x32_bf16 v[136:139], v[48:51], v[112:115], v[136:139]
    v_accvgpr_write_b32 a178, 0
    v_add_u32 v35, s98, v35
    v_mfma_f32_16x16x32_bf16 v[136:139], v[52:55], v[116:119], v[136:139]
    v_add_u32 v34, s3, v34
    v_add_u32 v35, 512, v35
    v_mfma_f32_16x16x32_bf16 v[140:143], v[48:51], v[120:123], v[140:143]
    ds_read_b64_tr_b16 v[48:49], v17 offset:32768
    ds_read_b64_tr_b16 v[50:51], v17 offset:33792
    v_mfma_f32_16x16x32_bf16 v[140:143], v[52:55], v[124:127], v[140:143]
    ds_read_b64_tr_b16 v[52:53], v17 offset:40960
    ds_read_b64_tr_b16 v[54:55], v17 offset:41984
    v_mfma_f32_16x16x32_bf16 v[144:147], v[56:59], v[96:99], v[144:147]
    v_add_u32 v17, 0x10000, v17
    v_accvgpr_write_b32 a179, 0
    v_mfma_f32_16x16x32_bf16 v[144:147], v[60:63], v[100:103], v[144:147]
    s_add_u32 m0, s69, 133120
    v_accvgpr_write_b32 a180, 0
    v_and_b32 v3, 1, v33
    v_mfma_f32_16x16x32_bf16 v[148:151], v[56:59], v[104:107], v[148:151]
    buffer_load_dwordx4 v8, s[32:35], s66 offen lds
    v_mfma_f32_16x16x32_bf16 v[148:151], v[60:63], v[108:111], v[148:151]
    v_accvgpr_write_b32 a181, 0
    v_mfma_f32_16x16x32_bf16 v[152:155], v[56:59], v[112:115], v[152:155]
    v_accvgpr_write_b32 a182, 0
    v_mfma_f32_16x16x32_bf16 v[152:155], v[60:63], v[116:119], v[152:155]
    ds_read_b128 v[68:71], v25 offset:49152
    v_mfma_f32_16x16x32_bf16 v[156:159], v[56:59], v[120:123], v[156:159]
    ds_read_b64_tr_b16 v[56:57], v18 offset:32768
    ds_read_b64_tr_b16 v[58:59], v18 offset:33792
    v_mfma_f32_16x16x32_bf16 v[156:159], v[60:63], v[124:127], v[156:159]
    s_waitcnt lgkmcnt(3)
    ds_read_b64_tr_b16 v[60:61], v18 offset:40960
    ds_read_b64_tr_b16 v[62:63], v18 offset:41984
    v_mfma_f32_16x16x32_bf16 v[160:163], v[40:43], v[96:99], v[160:163]
    v_add_u32 v18, 0x10000, v18
    v_accvgpr_write_b32 a183, 0
    v_mfma_f32_16x16x32_bf16 v[160:163], v[44:47], v[100:103], v[160:163]
    v_accvgpr_write_b32 a184, 0
    v_mfma_f32_16x16x32_bf16 v[164:167], v[40:43], v[104:107], v[164:167]
    v_accvgpr_write_b32 a185, 0
    v_mfma_f32_16x16x32_bf16 v[164:167], v[44:47], v[108:111], v[164:167]
    s_add_u32 m0, s69, 134144
    v_mfma_f32_16x16x32_bf16 v[168:171], v[40:43], v[112:115], v[168:171]
    buffer_load_dwordx4 v9, s[32:35], s66 offen lds
    v_mfma_f32_16x16x32_bf16 v[168:171], v[44:47], v[116:119], v[168:171]
    s_cmp_eq_u32 s4, 0
    s_cselect_b64 vcc, -1, 0
    v_cndmask_b32 v34, v34, v35, vcc
    v_mfma_f32_16x16x32_bf16 v[172:175], v[40:43], v[120:123], v[172:175]
    ds_read_b64_tr_b16 v[40:41], v19 offset:32768
    ds_read_b64_tr_b16 v[42:43], v19 offset:33792
    v_mfma_f32_16x16x32_bf16 v[172:175], v[44:47], v[124:127], v[172:175]
    ds_read_b64_tr_b16 v[44:45], v19 offset:40960
    ds_read_b64_tr_b16 v[46:47], v19 offset:41984
    v_mfma_f32_16x16x32_bf16 v[176:179], v[48:51], v[96:99], v[176:179]
    ds_read_b128 v[72:75], v24 offset:57344
    v_add_u32 v19, 0x10000, v19
    v_mfma_f32_16x16x32_bf16 v[176:179], v[52:55], v[100:103], v[176:179]
    v_and_b32 v35, 0x30, v1
    v_accvgpr_write_b32 a186, 0
    v_mfma_f32_16x16x32_bf16 v[180:183], v[48:51], v[104:107], v[180:183]
    v_add_u32 v2, v34, v35
    v_lshrrev_b32 v34, 1, v32
    v_mfma_f32_16x16x32_bf16 v[180:183], v[52:55], v[108:111], v[180:183]
    v_mul_u32_u24 v34, 18, v34
    v_and_b32 v35, 1, v32
    v_mfma_f32_16x16x32_bf16 v[184:187], v[48:51], v[112:115], v[184:187]
    v_accvgpr_write_b32 a187, 0
    v_lshl_add_u32 v34, v35, 3, v34
    v_mfma_f32_16x16x32_bf16 v[184:187], v[52:55], v[116:119], v[184:187]
    s_add_u32 m0, s69, 147456
    v_lshrrev_b32 v35, 1, v33
    v_lshl_add_u32 v35, v32, 2, v35
    v_mfma_f32_16x16x32_bf16 v[188:191], v[48:51], v[120:123], v[188:191]
    s_add_u32 s65, s65, s67
    buffer_load_dwordx4 v2, s[52:55], 0 offen lds
    v_mfma_f32_16x16x32_bf16 v[188:191], v[52:55], v[124:127], v[188:191]
    s_add_u32 s66, s66, s68
    ds_read_b64_tr_b16 v[48:49], v20 offset:32768
    ds_read_b64_tr_b16 v[50:51], v20 offset:33792
    s_waitcnt lgkmcnt(2)
    v_mfma_f32_16x16x32_bf16 v[192:195], v[56:59], v[96:99], v[192:195]
    ds_read_b64_tr_b16 v[52:53], v20 offset:40960
    ds_read_b64_tr_b16 v[54:55], v20 offset:41984
    v_mfma_f32_16x16x32_bf16 v[192:195], v[60:63], v[100:103], v[192:195]
    v_add_u32 v20, 0x10000, v20
    v_accvgpr_write_b32 a188, 0
    v_mfma_f32_16x16x32_bf16 v[196:199], v[56:59], v[104:107], v[196:199]
    v_add_u32 v35, 0xffffff02, v35
    v_mul_u32_u24 v35, 18, v35
    v_mfma_f32_16x16x32_bf16 v[196:199], v[60:63], v[108:111], v[196:199]
    ds_read_b128 v[76:79], v25 offset:57344
    v_accvgpr_write_b32 a189, 0
    v_mfma_f32_16x16x32_bf16 v[200:203], v[56:59], v[112:115], v[200:203]
    v_add3_u32 v34, v34, v33, 4
    v_add3_u32 v35, v35, v3, 16
    v_mfma_f32_16x16x32_bf16 v[200:203], v[60:63], v[116:119], v[200:203]
    v_cmp_gt_u32 vcc, 64, v32
    v_accvgpr_write_b32 a190, 0
    v_mfma_f32_16x16x32_bf16 v[204:207], v[56:59], v[120:123], v[204:207]
    ds_read_b64_tr_b16 v[56:57], v21 offset:32768
    ds_read_b64_tr_b16 v[58:59], v21 offset:33792
    v_mfma_f32_16x16x32_bf16 v[204:207], v[60:63], v[124:127], v[204:207]
    s_add_u32 m0, s69, 148480
    ds_read_b64_tr_b16 v[60:61], v21 offset:40960
    ds_read_b64_tr_b16 v[62:63], v21 offset:41984
    v_mfma_f32_16x16x32_bf16 v[208:211], v[40:43], v[96:99], v[208:211]
    v_add_u32 v21, 0x10000, v21
    v_cndmask_b32 v34, v35, v34, vcc
    v_mfma_f32_16x16x32_bf16 v[208:211], v[44:47], v[100:103], v[208:211]
    s_cmp_eq_u32 s4, 0
    s_cselect_b64 vcc, -1, 0
    v_lshrrev_b32 v35, 6, v1
    v_mfma_f32_16x16x32_bf16 v[212:215], v[40:43], v[104:107], v[212:215]
    v_mul_u32_u24 v35, 1152, v35
    v_mul_u32_u24 v34, 1152, v34
    v_mfma_f32_16x16x32_bf16 v[212:215], v[44:47], v[108:111], v[212:215]
    v_add_u32 v35, s98, v35
    v_accvgpr_write_b32 a191, 0
    v_mfma_f32_16x16x32_bf16 v[216:219], v[40:43], v[112:115], v[216:219]
    v_add_u32 v34, s3, v34
    v_add_u32 v35, 18944, v35
    v_mfma_f32_16x16x32_bf16 v[216:219], v[44:47], v[116:119], v[216:219]
    v_cndmask_b32 v34, v34, v35, vcc
    v_and_b32 v35, 0x30, v1
    v_mfma_f32_16x16x32_bf16 v[220:223], v[40:43], v[120:123], v[220:223]
    v_accvgpr_write_b32 a192, 0
    v_add_u32 v3, v34, v35
    v_mfma_f32_16x16x32_bf16 v[220:223], v[44:47], v[124:127], v[220:223]
    s_waitcnt lgkmcnt(0)
    buffer_load_dwordx4 v3, s[52:55], 0 offen lds
    v_mfma_f32_16x16x32_bf16 v[224:227], v[48:51], v[96:99], v[224:227]
    v_accvgpr_write_b32 a193, 0
    v_accvgpr_write_b32 a194, 0
    v_mfma_f32_16x16x32_bf16 v[224:227], v[52:55], v[100:103], v[224:227]
    v_accvgpr_write_b32 a195, 0
    v_accvgpr_write_b32 a196, 0
    v_mfma_f32_16x16x32_bf16 v[228:231], v[48:51], v[104:107], v[228:231]
    v_accvgpr_write_b32 a197, 0
    v_accvgpr_write_b32 a198, 0
    v_mfma_f32_16x16x32_bf16 v[228:231], v[52:55], v[108:111], v[228:231]
    v_accvgpr_write_b32 a199, 0
    v_accvgpr_write_b32 a200, 0
    v_mfma_f32_16x16x32_bf16 v[232:235], v[48:51], v[112:115], v[232:235]
    v_accvgpr_write_b32 a201, 0
    v_accvgpr_write_b32 a202, 0
    v_mfma_f32_16x16x32_bf16 v[232:235], v[52:55], v[116:119], v[232:235]
    s_waitcnt vmcnt(14)
    s_barrier
    ds_read_b64_tr_b16 v[40:41], v26 offset:0
    v_mfma_f32_16x16x32_bf16 v[236:239], v[48:51], v[120:123], v[236:239]
    ds_read_b64_tr_b16 v[42:43], v26 offset:576
    ds_read_b64_tr_b16 v[44:45], v26 offset:4608
    v_mfma_f32_16x16x32_bf16 v[236:239], v[52:55], v[124:127], v[236:239]
    ds_read_b64_tr_b16 v[46:47], v26 offset:5184
    ds_read_b128 a[136:139], v22 offset:0
    v_mfma_f32_16x16x32_bf16 v[240:243], v[56:59], v[96:99], v[240:243]
    ds_read_b128 a[140:143], v23 offset:0
    ds_read_b64_tr_b16 v[48:49], v27 offset:0
    v_mfma_f32_16x16x32_bf16 v[240:243], v[60:63], v[100:103], v[240:243]
    ds_read_b64_tr_b16 v[50:51], v27 offset:576
    ds_read_b64_tr_b16 v[52:53], v27 offset:4608
    v_mfma_f32_16x16x32_bf16 v[244:247], v[56:59], v[104:107], v[244:247]
    ds_read_b64_tr_b16 v[54:55], v27 offset:5184
    v_add_u32 v26, 0x10000, v26
    v_mfma_f32_16x16x32_bf16 v[244:247], v[60:63], v[108:111], v[244:247]
    v_add_u32 v22, 0x10000, v22
    v_add_u32 v23, 0x10000, v23
    v_mfma_f32_16x16x32_bf16 v[248:251], v[56:59], v[112:115], v[248:251]
    v_add_u32 v27, 0x10000, v27
    v_accvgpr_write_b32 a203, 0
    v_mfma_f32_16x16x32_bf16 v[248:251], v[60:63], v[116:119], v[248:251]
    v_accvgpr_write_b32 a204, 0
    v_accvgpr_write_b32 a205, 0
    v_mfma_f32_16x16x32_bf16 v[252:255], v[56:59], v[120:123], v[252:255]
    ds_read_b64_tr_b16 v[56:57], v28 offset:0
    ds_read_b64_tr_b16 v[58:59], v28 offset:576
    v_mfma_f32_16x16x32_bf16 v[252:255], v[60:63], v[124:127], v[252:255]
    s_waitcnt lgkmcnt(2)
    ds_read_b64_tr_b16 v[60:61], v28 offset:4608
    ds_read_b64_tr_b16 v[62:63], v28 offset:5184
    v_mfma_f32_16x16x32_bf16 a[64:67], v[40:43], v[96:99], a[64:67]
    v_add_u32 v28, 0x10000, v28
    v_accvgpr_write_b32 a206, 0
    v_mfma_f32_16x16x32_bf16 a[64:67], v[44:47], v[100:103], a[64:67]
    v_add_u32 v24, 0x10000, v24
    v_accvgpr_write_b32 a207, 0
    v_mfma_f32_16x16x32_bf16 a[68:71], v[40:43], v[104:107], a[68:71]
    ds_read_b128 v[80:83], v24 offset:16384
    v_accvgpr_write_b32 a208, 0
    v_mfma_f32_16x16x32_bf16 a[68:71], v[44:47], v[108:111], a[68:71]
    v_accvgpr_write_b32 a209, 0
    v_bfe_u32 v33, v1, 4, 2
    v_mfma_f32_16x16x32_bf16 a[72:75], v[40:43], v[112:115], a[72:75]
    v_accvgpr_write_b32 a210, 0
    v_lshlrev_b32 v33, 3, v33
    v_mfma_f32_16x16x32_bf16 a[72:75], v[44:47], v[116:119], a[72:75]
    v_add_u32 v25, 0x10000, v25
    v_lshrrev_b32 v32, 6, v1
    v_mfma_f32_16x16x32_bf16 a[76:79], v[40:43], v[120:123], a[76:79]
    ds_read_b128 v[84:87], v25 offset:16384
    v_accvgpr_write_b32 a211, 0
    v_mfma_f32_16x16x32_bf16 a[76:79], v[44:47], v[124:127], a[76:79]
    v_add_u32 v33, s69, v33
    v_lshl_add_u32 v4, v32, 7, v33
    v_mfma_f32_16x16x32_bf16 a[128:131], v[40:43], a[136:139], a[128:131]
    ds_read_b64_tr_b16 v[40:41], v29 offset:0
    ds_read_b64_tr_b16 v[42:43], v29 offset:576
    v_mfma_f32_16x16x32_bf16 a[128:131], v[44:47], a[140:143], a[128:131]
    s_mov_b64 exec, s[86:87]
    ds_read_b128 v[40:43], v30 offset:0
    s_mov_b64 exec, -1
    v_mfma_f32_16x16x32_bf16 a[80:83], v[48:51], v[96:99], a[80:83]
    ds_read_b128 v[88:91], v24 offset:24576
    ds_read_b64_tr_b16 v[44:45], v29 offset:4608
    v_mfma_f32_16x16x32_bf16 a[80:83], v[52:55], v[100:103], a[80:83]
    ds_read_b64_tr_b16 v[46:47], v29 offset:5184
    v_add_u32 v29, 0x10000, v29
    v_mfma_f32_16x16x32_bf16 a[84:87], v[48:51], v[104:107], a[84:87]
    s_mov_b64 exec, s[86:87]
    ds_read_b128 v[44:47], v30 offset:64
    s_mov_b64 exec, -1
    v_mfma_f32_16x16x32_bf16 a[84:87], v[52:55], v[108:111], a[84:87]
    v_add_u32 v30, 0x10000, v30
    v_accvgpr_write_b32 a212, 0
    v_mfma_f32_16x16x32_bf16 a[88:91], v[48:51], v[112:115], a[88:91]
    ds_read_b128 v[92:95], v25 offset:24576
    v_accvgpr_write_b32 a213, 0
    v_mfma_f32_16x16x32_bf16 a[88:91], v[52:55], v[116:119], a[88:91]
    v_accvgpr_write_b32 a214, 0
    v_accvgpr_write_b32 a215, 0
    v_mfma_f32_16x16x32_bf16 a[92:95], v[48:51], v[120:123], a[92:95]
    v_accvgpr_write_b32 a216, 0
    v_add_u32 v4, 0x10000, v4
    v_mfma_f32_16x16x32_bf16 a[92:95], v[52:55], v[124:127], a[92:95]
    v_lshl_add_u32 v5, v32, 6, v33
    v_add_u32 v5, 0x20000, v5
    v_mfma_f32_16x16x32_bf16 a[132:135], v[48:51], a[136:139], a[132:135]
    v_accvgpr_write_b32 a217, 0
    v_mfma_f32_16x16x32_bf16 a[132:135], v[52:55], a[140:143], a[132:135]
    s_waitcnt lgkmcnt(0)
    v_mfma_f32_16x16x32_bf16 a[96:99], v[56:59], v[96:99], a[96:99]
    v_accvgpr_write_b32 a218, 0
    v_mfma_f32_16x16x32_bf16 a[96:99], v[60:63], v[100:103], a[96:99]
    v_mfma_f32_16x16x32_bf16 a[100:103], v[56:59], v[104:107], a[100:103]
    v_accvgpr_write_b32 a219, 0
    v_mfma_f32_16x16x32_bf16 a[100:103], v[60:63], v[108:111], a[100:103]
    v_mfma_f32_16x16x32_bf16 a[104:107], v[56:59], v[112:115], a[104:107]
    v_accvgpr_write_b32 a220, 0
    v_mfma_f32_16x16x32_bf16 a[104:107], v[60:63], v[116:119], a[104:107]
    s_waitcnt vmcnt(6)
    s_barrier
    ds_read_b64_tr_b16 v[48:49], v14 offset:32768
    v_mfma_f32_16x16x32_bf16 a[108:111], v[56:59], v[120:123], a[108:111]
    ds_read_b64_tr_b16 v[50:51], v14 offset:33792
    ds_read_b64_tr_b16 v[52:53], v14 offset:40960
    v_mfma_f32_16x16x32_bf16 a[108:111], v[60:63], v[124:127], a[108:111]
    ds_read_b64_tr_b16 v[54:55], v14 offset:41984
    ds_read_b64_tr_b16 v[56:57], v15 offset:32768
    v_mfma_f32_16x16x32_bf16 a[112:115], v[40:43], v[96:99], a[112:115]
    ds_read_b64_tr_b16 v[58:59], v15 offset:33792
    ds_read_b64_tr_b16 v[60:61], v15 offset:40960
    v_mfma_f32_16x16x32_bf16 a[112:115], v[44:47], v[100:103], a[112:115]
    ds_read_b64_tr_b16 v[62:63], v15 offset:41984
    v_accvgpr_write_b32 a221, 0
    v_mfma_f32_16x16x32_bf16 a[116:119], v[40:43], v[104:107], a[116:119]
    v_accvgpr_write_b32 a222, 0
    v_accvgpr_write_b32 a223, 0
    v_mfma_f32_16x16x32_bf16 a[116:119], v[44:47], v[108:111], a[116:119]
    v_mfma_f32_16x16x32_bf16 a[120:123], v[40:43], v[112:115], a[120:123]
    v_mfma_f32_16x16x32_bf16 a[120:123], v[44:47], v[116:119], a[120:123]
    v_mfma_f32_16x16x32_bf16 a[124:127], v[40:43], v[120:123], a[124:127]
    ds_read_b64_tr_b16 v[40:41], v16 offset:32768
    ds_read_b64_tr_b16 v[42:43], v16 offset:33792
    v_mfma_f32_16x16x32_bf16 a[124:127], v[44:47], v[124:127], a[124:127]
    s_waitcnt lgkmcnt(2)
    ds_read_b64_tr_b16 v[44:45], v16 offset:40960
    ds_read_b64_tr_b16 v[46:47], v16 offset:41984
    v_mfma_f32_16x16x32_bf16 v[128:131], v[48:51], v[64:67], v[128:131]
    v_mfma_f32_16x16x32_bf16 v[128:131], v[52:55], v[68:71], v[128:131]
    ds_read_b64_tr_b16 v[32:33], v4 offset:49152
    ds_read_b64_tr_b16 v[34:35], v4 offset:51200
    v_mfma_f32_16x16x32_bf16 v[132:135], v[48:51], v[72:75], v[132:135]
    v_mfma_f32_16x16x32_bf16 v[132:135], v[52:55], v[76:79], v[132:135]
    v_mfma_f32_16x16x32_bf16 v[136:139], v[48:51], v[80:83], v[136:139]
    v_mfma_f32_16x16x32_bf16 v[136:139], v[52:55], v[84:87], v[136:139]
    v_mfma_f32_16x16x32_bf16 v[140:143], v[48:51], v[88:91], v[140:143]
    ds_read_b64_tr_b16 v[48:49], v17 offset:32768
    ds_read_b64_tr_b16 v[50:51], v17 offset:33792
    v_mfma_f32_16x16x32_bf16 v[140:143], v[52:55], v[92:95], v[140:143]
    ds_read_b64_tr_b16 v[52:53], v17 offset:40960
    ds_read_b64_tr_b16 v[54:55], v17 offset:41984
    v_mfma_f32_16x16x32_bf16 v[144:147], v[56:59], v[64:67], v[144:147]
    s_waitcnt lgkmcnt(4)
    buffer_store_dwordx4 v[32:35], v1, s[56:59], s70 offen offset:0
    v_mfma_f32_16x16x32_bf16 v[144:147], v[60:63], v[68:71], v[144:147]
    v_mul_f32 v128, s74, v128
    v_mul_f32 v129, s74, v129
    v_mfma_f32_16x16x32_bf16 v[148:151], v[56:59], v[72:75], v[148:151]
    v_mul_f32 v130, s74, v130
    v_mul_f32 v131, s74, v131
    v_mfma_f32_16x16x32_bf16 v[148:151], v[60:63], v[76:79], v[148:151]
    ds_read_b64_tr_b16 v[36:37], v4 offset:49184
    ds_read_b64_tr_b16 v[38:39], v4 offset:51232
    v_mfma_f32_16x16x32_bf16 v[152:155], v[56:59], v[80:83], v[152:155]
    v_mul_f32 v132, s74, v132
    v_mul_f32 v133, s74, v133
    v_mfma_f32_16x16x32_bf16 v[152:155], v[60:63], v[84:87], v[152:155]
    v_mul_f32 v134, s74, v134
    v_mul_f32 v135, s74, v135
    v_mfma_f32_16x16x32_bf16 v[156:159], v[56:59], v[88:91], v[156:159]
    ds_read_b64_tr_b16 v[56:57], v18 offset:32768
    ds_read_b64_tr_b16 v[58:59], v18 offset:33792
    v_mfma_f32_16x16x32_bf16 v[156:159], v[60:63], v[92:95], v[156:159]
    ds_read_b64_tr_b16 v[60:61], v18 offset:40960
    ds_read_b64_tr_b16 v[62:63], v18 offset:41984
    v_mfma_f32_16x16x32_bf16 v[160:163], v[40:43], v[64:67], v[160:163]
    v_mul_f32 v136, s74, v136
    v_mul_f32 v137, s74, v137
    v_mfma_f32_16x16x32_bf16 v[160:163], v[44:47], v[68:71], v[160:163]
    v_mul_f32 v138, s74, v138
    v_mul_f32 v139, s74, v139
    v_mfma_f32_16x16x32_bf16 v[164:167], v[40:43], v[72:75], v[164:167]
    s_waitcnt lgkmcnt(4)
    buffer_store_dwordx4 v[36:39], v1, s[56:59], s70 offen offset:1024
    v_mfma_f32_16x16x32_bf16 v[164:167], v[44:47], v[76:79], v[164:167]
    v_mul_f32 v140, s74, v140
    v_mul_f32 v141, s74, v141
    v_mfma_f32_16x16x32_bf16 v[168:171], v[40:43], v[80:83], v[168:171]
    v_mul_f32 v142, s74, v142
    v_mul_f32 v143, s74, v143
    v_mfma_f32_16x16x32_bf16 v[168:171], v[44:47], v[84:87], v[168:171]
    ds_read_b64_tr_b16 v[32:33], v4 offset:49216
    ds_read_b64_tr_b16 v[34:35], v4 offset:51264
    v_mfma_f32_16x16x32_bf16 v[172:175], v[40:43], v[88:91], v[172:175]
    ds_read_b64_tr_b16 v[40:41], v19 offset:32768
    ds_read_b64_tr_b16 v[42:43], v19 offset:33792
    v_mfma_f32_16x16x32_bf16 v[172:175], v[44:47], v[92:95], v[172:175]
    ds_read_b64_tr_b16 v[44:45], v19 offset:40960
    ds_read_b64_tr_b16 v[46:47], v19 offset:41984
    v_mfma_f32_16x16x32_bf16 v[176:179], v[48:51], v[64:67], v[176:179]
    v_mul_f32 v144, s74, v144
    v_mul_f32 v145, s74, v145
    v_mfma_f32_16x16x32_bf16 v[176:179], v[52:55], v[68:71], v[176:179]
    v_mul_f32 v146, s74, v146
    v_mul_f32 v147, s74, v147
    v_mfma_f32_16x16x32_bf16 v[180:183], v[48:51], v[72:75], v[180:183]
    v_mul_f32 v148, s74, v148
    v_mul_f32 v149, s74, v149
    v_mfma_f32_16x16x32_bf16 v[180:183], v[52:55], v[76:79], v[180:183]
    v_mul_f32 v150, s74, v150
    v_mul_f32 v151, s74, v151
    v_mfma_f32_16x16x32_bf16 v[184:187], v[48:51], v[80:83], v[184:187]
    s_waitcnt lgkmcnt(0)
    buffer_store_dwordx4 v[32:35], v1, s[56:59], s70 offen offset:2048
    v_mfma_f32_16x16x32_bf16 v[184:187], v[52:55], v[84:87], v[184:187]
    v_mul_f32 v152, s74, v152
    v_mul_f32 v153, s74, v153
    v_mfma_f32_16x16x32_bf16 v[188:191], v[48:51], v[88:91], v[188:191]
    ds_read_b64_tr_b16 v[48:49], v20 offset:32768
    ds_read_b64_tr_b16 v[50:51], v20 offset:33792
    v_mfma_f32_16x16x32_bf16 v[188:191], v[52:55], v[92:95], v[188:191]
    ds_read_b64_tr_b16 v[52:53], v20 offset:40960
    ds_read_b64_tr_b16 v[54:55], v20 offset:41984
    v_mfma_f32_16x16x32_bf16 v[192:195], v[56:59], v[64:67], v[192:195]
    ds_read_b64_tr_b16 v[36:37], v4 offset:49248
    ds_read_b64_tr_b16 v[38:39], v4 offset:51296
    v_mfma_f32_16x16x32_bf16 v[192:195], v[60:63], v[68:71], v[192:195]
    v_mul_f32 v154, s74, v154
    v_mul_f32 v155, s74, v155
    v_mfma_f32_16x16x32_bf16 v[196:199], v[56:59], v[72:75], v[196:199]
    v_mul_f32 v156, s74, v156
    v_mul_f32 v157, s74, v157
    v_mfma_f32_16x16x32_bf16 v[196:199], v[60:63], v[76:79], v[196:199]
    v_mul_f32 v158, s74, v158
    v_mul_f32 v159, s74, v159
    v_mfma_f32_16x16x32_bf16 v[200:203], v[56:59], v[80:83], v[200:203]
    v_mul_f32 v160, s74, v160
    v_mul_f32 v161, s74, v161
    v_mfma_f32_16x16x32_bf16 v[200:203], v[60:63], v[84:87], v[200:203]
    v_mul_f32 v162, s74, v162
    v_mul_f32 v163, s74, v163
    v_mfma_f32_16x16x32_bf16 v[204:207], v[56:59], v[88:91], v[204:207]
    ds_read_b64_tr_b16 v[56:57], v21 offset:32768
    ds_read_b64_tr_b16 v[58:59], v21 offset:33792
    v_mfma_f32_16x16x32_bf16 v[204:207], v[60:63], v[92:95], v[204:207]
    ds_read_b64_tr_b16 v[60:61], v21 offset:40960
    ds_read_b64_tr_b16 v[62:63], v21 offset:41984
    v_mfma_f32_16x16x32_bf16 v[208:211], v[40:43], v[64:67], v[208:211]
    s_waitcnt lgkmcnt(4)
    buffer_store_dwordx4 v[36:39], v1, s[56:59], s70 offen offset:3072
    v_mfma_f32_16x16x32_bf16 v[208:211], v[44:47], v[68:71], v[208:211]
    v_mul_f32 v164, s74, v164
    v_mul_f32 v165, s74, v165
    v_mfma_f32_16x16x32_bf16 v[212:215], v[40:43], v[72:75], v[212:215]
    v_mul_f32 v166, s74, v166
    v_mul_f32 v167, s74, v167
    v_mfma_f32_16x16x32_bf16 v[212:215], v[44:47], v[76:79], v[212:215]
    v_mul_f32 v168, s74, v168
    v_mul_f32 v169, s74, v169
    v_mfma_f32_16x16x32_bf16 v[216:219], v[40:43], v[80:83], v[216:219]
    v_mul_f32 v170, s74, v170
    v_mul_f32 v171, s74, v171
    v_mfma_f32_16x16x32_bf16 v[216:219], v[44:47], v[84:87], v[216:219]
    v_mul_f32 v172, s74, v172
    v_mul_f32 v173, s74, v173
    v_mfma_f32_16x16x32_bf16 v[220:223], v[40:43], v[88:91], v[220:223]
    v_mul_f32 v174, s74, v174
    v_mul_f32 v175, s74, v175
    v_mfma_f32_16x16x32_bf16 v[220:223], v[44:47], v[92:95], v[220:223]
    v_mul_f32 v176, s74, v176
    v_mul_f32 v177, s74, v177
    v_mfma_f32_16x16x32_bf16 v[224:227], v[48:51], v[64:67], v[224:227]
    v_mul_f32 v178, s74, v178
    v_mul_f32 v179, s74, v179
    v_mfma_f32_16x16x32_bf16 v[224:227], v[52:55], v[68:71], v[224:227]
    v_mul_f32 v180, s74, v180
    v_mul_f32 v181, s74, v181
    v_mfma_f32_16x16x32_bf16 v[228:231], v[48:51], v[72:75], v[228:231]
    v_mul_f32 v182, s74, v182
    v_mul_f32 v183, s74, v183
    v_mfma_f32_16x16x32_bf16 v[228:231], v[52:55], v[76:79], v[228:231]
    v_mul_f32 v184, s74, v184
    v_mul_f32 v185, s74, v185
    v_mfma_f32_16x16x32_bf16 v[232:235], v[48:51], v[80:83], v[232:235]
    v_mul_f32 v186, s74, v186
    v_mul_f32 v187, s74, v187
    v_mfma_f32_16x16x32_bf16 v[232:235], v[52:55], v[84:87], v[232:235]
    s_waitcnt vmcnt(4)
    s_barrier
    ds_read_b64_tr_b16 v[40:41], v26 offset:0
    v_mfma_f32_16x16x32_bf16 v[236:239], v[48:51], v[88:91], v[236:239]
    ds_read_b64_tr_b16 v[42:43], v26 offset:576
    ds_read_b64_tr_b16 v[44:45], v26 offset:4608
    v_mfma_f32_16x16x32_bf16 v[236:239], v[52:55], v[92:95], v[236:239]
    s_waitcnt lgkmcnt(3)
    ds_read_b64_tr_b16 v[46:47], v26 offset:5184
    ds_read_b128 a[136:139], v22 offset:0
    v_mfma_f32_16x16x32_bf16 v[240:243], v[56:59], v[64:67], v[240:243]
    ds_read_b128 a[140:143], v23 offset:0
    ds_read_b64_tr_b16 v[48:49], v27 offset:0
    v_mfma_f32_16x16x32_bf16 v[240:243], v[60:63], v[68:71], v[240:243]
    ds_read_b64_tr_b16 v[50:51], v27 offset:576
    ds_read_b64_tr_b16 v[52:53], v27 offset:4608
    v_mfma_f32_16x16x32_bf16 v[244:247], v[56:59], v[72:75], v[244:247]
    ds_read_b64_tr_b16 v[54:55], v27 offset:5184
    v_mul_f32 v188, s74, v188
    v_mfma_f32_16x16x32_bf16 v[244:247], v[60:63], v[76:79], v[244:247]
    v_mul_f32 v189, s74, v189
    v_mul_f32 v190, s74, v190
    v_mfma_f32_16x16x32_bf16 v[248:251], v[56:59], v[80:83], v[248:251]
    v_mul_f32 v191, s74, v191
    v_mul_f32 v192, s74, v192
    v_mfma_f32_16x16x32_bf16 v[248:251], v[60:63], v[84:87], v[248:251]
    v_mul_f32 v193, s74, v193
    v_mul_f32 v194, s74, v194
    v_mfma_f32_16x16x32_bf16 v[252:255], v[56:59], v[88:91], v[252:255]
    ds_read_b64_tr_b16 v[56:57], v28 offset:0
    ds_read_b64_tr_b16 v[58:59], v28 offset:576
    v_mfma_f32_16x16x32_bf16 v[252:255], v[60:63], v[92:95], v[252:255]
    s_waitcnt lgkmcnt(2)
    ds_read_b64_tr_b16 v[60:61], v28 offset:4608
    ds_read_b64_tr_b16 v[62:63], v28 offset:5184
    v_mfma_f32_16x16x32_bf16 a[64:67], v[40:43], v[64:67], a[64:67]
    v_mul_f32 v195, s74, v195
    v_mul_f32 v196, s74, v196
    v_mfma_f32_16x16x32_bf16 a[64:67], v[44:47], v[68:71], a[64:67]
    ds_read_b64_tr_b16 v[32:33], v5 offset:16384
    ds_read_b64_tr_b16 v[34:35], v5 offset:17408
    v_mfma_f32_16x16x32_bf16 a[68:71], v[40:43], v[72:75], a[68:71]
    v_mul_f32 v197, s74, v197
    v_mul_f32 v198, s74, v198
    v_mfma_f32_16x16x32_bf16 a[68:71], v[44:47], v[76:79], a[68:71]
    v_mul_f32 v199, s74, v199
    v_mul_f32 v200, s74, v200
    v_mfma_f32_16x16x32_bf16 a[72:75], v[40:43], v[80:83], a[72:75]
    v_mul_f32 v201, s74, v201
    v_mul_f32 v202, s74, v202
    v_mfma_f32_16x16x32_bf16 a[72:75], v[44:47], v[84:87], a[72:75]
    v_mul_f32 v203, s74, v203
    v_mul_f32 v204, s74, v204
    v_mfma_f32_16x16x32_bf16 a[76:79], v[40:43], v[88:91], a[76:79]
    v_mul_f32 v205, s74, v205
    v_mul_f32 v206, s74, v206
    v_mfma_f32_16x16x32_bf16 a[76:79], v[44:47], v[92:95], a[76:79]
    v_mul_f32 v207, s74, v207
    v_mul_f32 v208, s74, v208
    v_mfma_f32_16x16x32_bf16 a[128:131], v[40:43], a[136:139], a[128:131]
    ds_read_b64_tr_b16 v[40:41], v29 offset:0
    ds_read_b64_tr_b16 v[42:43], v29 offset:576
    v_mfma_f32_16x16x32_bf16 a[128:131], v[44:47], a[140:143], a[128:131]
    s_mov_b64 exec, s[86:87]
    ds_read_b128 v[40:43], v30 offset:0
    s_mov_b64 exec, -1
    v_mfma_f32_16x16x32_bf16 a[80:83], v[48:51], v[64:67], a[80:83]
    ds_read_b64_tr_b16 v[44:45], v29 offset:4608
    ds_read_b64_tr_b16 v[46:47], v29 offset:5184
    v_mfma_f32_16x16x32_bf16 a[80:83], v[52:55], v[68:71], a[80:83]
    s_mov_b64 exec, s[86:87]
    ds_read_b128 v[44:47], v30 offset:64
    s_mov_b64 exec, -1
    v_mfma_f32_16x16x32_bf16 a[84:87], v[48:51], v[72:75], a[84:87]
    ds_read_b64_tr_b16 v[36:37], v5 offset:16416
    ds_read_b64_tr_b16 v[38:39], v5 offset:17440
    v_mfma_f32_16x16x32_bf16 a[84:87], v[52:55], v[76:79], a[84:87]
    v_mul_f32 v209, s74, v209
    v_mul_f32 v210, s74, v210
    v_mfma_f32_16x16x32_bf16 a[88:91], v[48:51], v[80:83], a[88:91]
    v_mul_f32 v211, s74, v211
    v_mul_f32 v212, s74, v212
    v_mfma_f32_16x16x32_bf16 a[88:91], v[52:55], v[84:87], a[88:91]
    v_mul_f32 v213, s74, v213
    v_mul_f32 v214, s74, v214
    v_mfma_f32_16x16x32_bf16 a[92:95], v[48:51], v[88:91], a[92:95]
    v_mul_f32 v215, s74, v215
    v_mul_f32 v216, s74, v216
    v_mfma_f32_16x16x32_bf16 a[92:95], v[52:55], v[92:95], a[92:95]
    v_mul_f32 v217, s74, v217
    v_mul_f32 v218, s74, v218
    v_mfma_f32_16x16x32_bf16 a[132:135], v[48:51], a[136:139], a[132:135]
    v_mul_f32 v219, s74, v219
    v_mul_f32 v220, s74, v220
    v_mfma_f32_16x16x32_bf16 a[132:135], v[52:55], a[140:143], a[132:135]
    s_waitcnt lgkmcnt(0)
    v_mul_f32 v221, s74, v221
    v_mul_f32 v222, s74, v222
    v_mfma_f32_16x16x32_bf16 a[96:99], v[56:59], v[64:67], a[96:99]
    v_mul_f32 v223, s74, v223
    v_mul_f32 v224, s74, v224
    v_mfma_f32_16x16x32_bf16 a[96:99], v[60:63], v[68:71], a[96:99]
    v_mul_f32 v225, s74, v225
    v_mul_f32 v226, s74, v226
    v_mfma_f32_16x16x32_bf16 a[100:103], v[56:59], v[72:75], a[100:103]
    v_mul_f32 v227, s74, v227
    v_mul_f32 v228, s74, v228
    v_mfma_f32_16x16x32_bf16 a[100:103], v[60:63], v[76:79], a[100:103]
    v_mul_f32 v229, s74, v229
    v_mul_f32 v230, s74, v230
    v_mfma_f32_16x16x32_bf16 a[104:107], v[56:59], v[80:83], a[104:107]
    v_mul_f32 v231, s74, v231
    v_mul_f32 v232, s74, v232
    v_mfma_f32_16x16x32_bf16 a[104:107], v[60:63], v[84:87], a[104:107]
    v_mul_f32 v233, s74, v233
    v_mul_f32 v234, s74, v234
    v_mfma_f32_16x16x32_bf16 a[108:111], v[56:59], v[88:91], a[108:111]
    v_mul_f32 v235, s74, v235
    v_mul_f32 v236, s74, v236
    v_mfma_f32_16x16x32_bf16 a[108:111], v[60:63], v[92:95], a[108:111]
    v_mul_f32 v237, s74, v237
    v_mul_f32 v238, s74, v238
    v_mfma_f32_16x16x32_bf16 a[112:115], v[40:43], v[64:67], a[112:115]
    v_mul_f32 v239, s74, v239
    v_mul_f32 v240, s74, v240
    v_mfma_f32_16x16x32_bf16 a[112:115], v[44:47], v[68:71], a[112:115]
    v_mul_f32 v241, s74, v241
    v_mul_f32 v242, s74, v242
    v_mfma_f32_16x16x32_bf16 a[116:119], v[40:43], v[72:75], a[116:119]
    v_mul_f32 v243, s74, v243
    v_mul_f32 v244, s74, v244
    v_mfma_f32_16x16x32_bf16 a[116:119], v[44:47], v[76:79], a[116:119]
    v_mul_f32 v245, s74, v245
    v_mul_f32 v246, s74, v246
    v_mfma_f32_16x16x32_bf16 a[120:123], v[40:43], v[80:83], a[120:123]
    v_mul_f32 v247, s74, v247
    v_mul_f32 v248, s74, v248
    v_mfma_f32_16x16x32_bf16 a[120:123], v[44:47], v[84:87], a[120:123]
    v_mul_f32 v249, s74, v249
    v_mul_f32 v250, s74, v250
    v_mfma_f32_16x16x32_bf16 a[124:127], v[40:43], v[88:91], a[124:127]
    v_mul_f32 v251, s74, v251
    v_mul_f32 v252, s74, v252
    v_mfma_f32_16x16x32_bf16 a[124:127], v[44:47], v[92:95], a[124:127]
    v_mul_f32 v253, s74, v253
    v_mul_f32 v254, s74, v254
    v_mul_f32 v255, s74, v255
    v_cvt_pk_bf16_f32 v128, v128, v129
    v_cvt_pk_bf16_f32 v129, v130, v131
    v_cvt_pk_bf16_f32 v130, v144, v145
    v_cvt_pk_bf16_f32 v131, v146, v147
    v_cvt_pk_bf16_f32 v132, v132, v133
    v_cvt_pk_bf16_f32 v133, v134, v135
    v_cvt_pk_bf16_f32 v134, v148, v149
    v_cvt_pk_bf16_f32 v135, v150, v151
    v_cvt_pk_bf16_f32 v136, v136, v137
    v_cvt_pk_bf16_f32 v137, v138, v139
    v_cvt_pk_bf16_f32 v138, v152, v153
    v_cvt_pk_bf16_f32 v139, v154, v155
    v_cvt_pk_bf16_f32 v140, v140, v141
    v_cvt_pk_bf16_f32 v141, v142, v143
    v_cvt_pk_bf16_f32 v142, v156, v157
    v_cvt_pk_bf16_f32 v143, v158, v159
    v_cvt_pk_bf16_f32 v160, v160, v161
    v_cvt_pk_bf16_f32 v161, v162, v163
    v_cvt_pk_bf16_f32 v162, v176, v177
    v_cvt_pk_bf16_f32 v163, v178, v179
    v_cvt_pk_bf16_f32 v164, v164, v165
    v_cvt_pk_bf16_f32 v165, v166, v167
    v_cvt_pk_bf16_f32 v166, v180, v181
    v_cvt_pk_bf16_f32 v167, v182, v183
    v_cvt_pk_bf16_f32 v168, v168, v169
    v_cvt_pk_bf16_f32 v169, v170, v171
    v_cvt_pk_bf16_f32 v170, v184, v185
    v_cvt_pk_bf16_f32 v171, v186, v187
    v_cvt_pk_bf16_f32 v172, v172, v173
    v_cvt_pk_bf16_f32 v173, v174, v175
    v_cvt_pk_bf16_f32 v174, v188, v189
    v_cvt_pk_bf16_f32 v175, v190, v191
    v_cvt_pk_bf16_f32 v192, v192, v193
    v_cvt_pk_bf16_f32 v193, v194, v195
    v_cvt_pk_bf16_f32 v194, v208, v209
    v_cvt_pk_bf16_f32 v195, v210, v211
    v_cvt_pk_bf16_f32 v196, v196, v197
    v_cvt_pk_bf16_f32 v197, v198, v199
    v_cvt_pk_bf16_f32 v198, v212, v213
    v_cvt_pk_bf16_f32 v199, v214, v215
    v_cvt_pk_bf16_f32 v200, v200, v201
    v_cvt_pk_bf16_f32 v201, v202, v203
    v_cvt_pk_bf16_f32 v202, v216, v217
    v_cvt_pk_bf16_f32 v203, v218, v219
    v_cvt_pk_bf16_f32 v204, v204, v205
    v_cvt_pk_bf16_f32 v205, v206, v207
    v_cvt_pk_bf16_f32 v206, v220, v221
    v_cvt_pk_bf16_f32 v207, v222, v223
    v_cvt_pk_bf16_f32 v224, v224, v225
    v_cvt_pk_bf16_f32 v225, v226, v227
    v_cvt_pk_bf16_f32 v226, v240, v241
    v_cvt_pk_bf16_f32 v227, v242, v243
    v_cvt_pk_bf16_f32 v228, v228, v229
    v_cvt_pk_bf16_f32 v229, v230, v231
    v_cvt_pk_bf16_f32 v230, v244, v245
    v_cvt_pk_bf16_f32 v231, v246, v247
    v_cvt_pk_bf16_f32 v232, v232, v233
    v_cvt_pk_bf16_f32 v233, v234, v235
    v_cvt_pk_bf16_f32 v234, v248, v249
    v_cvt_pk_bf16_f32 v235, v250, v251
    v_cvt_pk_bf16_f32 v236, v236, v237
    v_cvt_pk_bf16_f32 v237, v238, v239
    v_cvt_pk_bf16_f32 v238, v252, v253
    v_cvt_pk_bf16_f32 v239, v254, v255
    buffer_store_dwordx4 v[32:35], v1, s[56:59], s71 offen offset:0
    buffer_store_dwordx4 v[36:39], v1, s[56:59], s71 offen offset:1024
    v_bfe_u32 v2, v1, 4, 4
    v_lshrrev_b32 v3, 8, v1
    s_lshl_b32 s98, s4, 4
    s_add_u32 s98, s98, 16
    v_add_u32 v8, s98, v2
    v_mul_u32_u24 v8, 144, v8
    v_add_u32 v8, 98304, v8
    v_lshl_add_u32 v11, v3, 3, v8
    s_lshr_b32 s98, s73, 1
    v_add_u32 v10, s98, v11
    v_subrev_u32 v12, s98, v11
    s_and_b32 s99, s4, 1
    s_mul_i32 s99, s99, 20736
    s_add_u32 s99, s99, 98304
    v_mul_u32_u24 v9, 144, v2
    v_lshl_add_u32 v9, v3, 3, v9
    v_add_u32 v15, s99, v9
    v_add_u32 v14, s98, v15
    v_add_u32 v13, 120, v8
    s_lshl_b32 s72, s5, 3
    v_mov_b32 v2, 0
    s_mov_b32 s78, 0
K1_POLL:
    buffer_load_dword v3, v2, s[44:47], s72 offen sc1
    s_waitcnt vmcnt(0)
    v_readfirstlane_b32 s7, v3
    s_add_u32 s78, s78, 1
    s_cmp_ge_u32 s78, 0x40000
    s_cbranch_scc1 K1_POLLED
    s_cmp_ge_u32 s7, 8
    s_cbranch_scc1 K1_POLLED
    s_sleep 4
    s_branch K1_POLL
K1_POLLED:
    buffer_inv sc1
    s_lshl_b32 s80, s4, 13
    s_sub_u32 s7, 33, s6
    s_sub_u32 s7, s7, s6
    s_lshl_b32 s38, s7, 15
    s_mov_b32 s77, s80
    s_mov_b32 s76, 0
    s_waitcnt lgkmcnt(0)
    s_barrier
    s_add_u32 m0, s76, s80
    s_nop 0
    buffer_load_dwordx4 v1, s[36:39], s77 offen lds
    buffer_load_dwordx4 v1, s[36:39], s77 offen offset:1024 lds
    buffer_load_dwordx4 v1, s[36:39], s77 offen offset:2048 lds
    buffer_load_dwordx4 v1, s[36:39], s77 offen offset:3072 lds
    s_add_u32 s100, s77, 4096
    s_add_u32 m0, m0, 4096
    s_nop 0
    buffer_load_dwordx4 v1, s[36:39], s100 offen lds
    buffer_load_dwordx4 v1, s[36:39], s100 offen offset:1024 lds
    buffer_load_dwordx4 v1, s[36:39], s100 offen offset:2048 lds
    buffer_load_dwordx4 v1, s[36:39], s100 offen offset:3072 lds
    s_add_u32 s77, s77, 32768
    s_add_u32 s76, s76, 32768
    s_add_u32 m0, s76, s80
    s_nop 0
    buffer_load_dwordx4 v1, s[36:39], s77 offen lds
    buffer_load_dwordx4 v1, s[36:39], s77 offen offset:1024 lds
    buffer_load_dwordx4 v1, s[36:39], s77 offen offset:2048 lds
    buffer_load_dwordx4 v1, s[36:39], s77 offen offset:3072 lds
    s_add_u32 s100, s77, 4096
    s_add_u32 m0, m0, 4096
    s_nop 0
    buffer_load_dwordx4 v1, s[36:39], s100 offen lds
    buffer_load_dwordx4 v1, s[36:39], s100 offen offset:1024 lds
    buffer_load_dwordx4 v1, s[36:39], s100 offen offset:2048 lds
    buffer_load_dwordx4 v1, s[36:39], s100 offen offset:3072 lds
    s_add_u32 s77, s77, 32768
    s_add_u32 s76, s76, 32768
    s_add_u32 m0, s76, s80
    s_nop 0
    buffer_load_dwordx4 v1, s[36:39], s77 offen lds
    buffer_load_dwordx4 v1, s[36:39], s77 offen offset:1024 lds
    buffer_load_dwordx4 v1, s[36:39], s77 offen offset:2048 lds
    buffer_load_dwordx4 v1, s[36:39], s77 offen offset:3072 lds
    s_add_u32 s100, s77, 4096
    s_add_u32 m0, m0, 4096
    s_nop 0
    buffer_load_dwordx4 v1, s[36:39], s100 offen lds
    buffer_load_dwordx4 v1, s[36:39], s100 offen offset:1024 lds
    buffer_load_dwordx4 v1, s[36:39], s100 offen offset:2048 lds
    buffer_load_dwordx4 v1, s[36:39], s100 offen offset:3072 lds
    s_add_u32 s77, s77, 32768
    s_add_u32 s76, s76, 32768
    v_accvgpr_read_b32 v16, a64
    v_accvgpr_read_b32 v17, a65
    v_accvgpr_read_b32 v18, a66
    v_accvgpr_read_b32 v19, a67
    v_cvt_pk_bf16_f32 v16, v16, v17
    v_cvt_pk_bf16_f32 v17, v18, v19
    ds_write_b64 v10, v[16:17] offset:0
    v_accvgpr_read_b32 v20, a68
    v_accvgpr_read_b32 v21, a69
    v_accvgpr_read_b32 v22, a70
    v_accvgpr_read_b32 v23, a71
    v_cvt_pk_bf16_f32 v20, v20, v21
    v_cvt_pk_bf16_f32 v21, v22, v23
    ds_write_b64 v10, v[20:21] offset:9216
    v_accvgpr_read_b32 v24, a72
    v_accvgpr_read_b32 v25, a73
    v_accvgpr_read_b32 v26, a74
    v_accvgpr_read_b32 v27, a75
    v_cvt_pk_bf16_f32 v24, v24, v25
    v_cvt_pk_bf16_f32 v25, v26, v27
    ds_write_b64 v10, v[24:25] offset:20736
    v_accvgpr_read_b32 v28, a76
    v_accvgpr_read_b32 v29, a77
    v_accvgpr_read_b32 v30, a78
    v_accvgpr_read_b32 v31, a79
    v_cvt_pk_bf16_f32 v28, v28, v29
    v_cvt_pk_bf16_f32 v29, v30, v31
    ds_write_b64 v10, v[28:29] offset:29952
    v_accvgpr_read_b32 v16, a80
    v_accvgpr_read_b32 v17, a81
    v_accvgpr_read_b32 v18, a82
    v_accvgpr_read_b32 v19, a83
    v_cvt_pk_bf16_f32 v16, v16, v17
    v_cvt_pk_bf16_f32 v17, v18, v19
    ds_write_b64 v11, v[16:17] offset:32
    v_accvgpr_read_b32 v20, a84
    v_accvgpr_read_b32 v21, a85
    v_accvgpr_read_b32 v22, a86
    v_accvgpr_read_b32 v23, a87
    v_cvt_pk_bf16_f32 v20, v20, v21
    v_cvt_pk_bf16_f32 v21, v22, v23
    ds_write_b64 v11, v[20:21] offset:9248
    v_accvgpr_read_b32 v24, a88
    v_accvgpr_read_b32 v25, a89
    v_accvgpr_read_b32 v26, a90
    v_accvgpr_read_b32 v27, a91
    v_cvt_pk_bf16_f32 v24, v24, v25
    v_cvt_pk_bf16_f32 v25, v26, v27
    ds_write_b64 v11, v[24:25] offset:20768
    v_accvgpr_read_b32 v28, a92
    v_accvgpr_read_b32 v29, a93
    v_accvgpr_read_b32 v30, a94
    v_accvgpr_read_b32 v31, a95
    v_cvt_pk_bf16_f32 v28, v28, v29
    v_cvt_pk_bf16_f32 v29, v30, v31
    ds_write_b64 v11, v[28:29] offset:29984
    v_accvgpr_read_b32 v16, a96
    v_accvgpr_read_b32 v17, a97
    v_accvgpr_read_b32 v18, a98
    v_accvgpr_read_b32 v19, a99
    v_cvt_pk_bf16_f32 v16, v16, v17
    v_cvt_pk_bf16_f32 v17, v18, v19
    ds_write_b64 v12, v[16:17] offset:64
    v_accvgpr_read_b32 v20, a100
    v_accvgpr_read_b32 v21, a101
    v_accvgpr_read_b32 v22, a102
    v_accvgpr_read_b32 v23, a103
    v_cvt_pk_bf16_f32 v20, v20, v21
    v_cvt_pk_bf16_f32 v21, v22, v23
    ds_write_b64 v12, v[20:21] offset:9280
    v_accvgpr_read_b32 v24, a104
    v_accvgpr_read_b32 v25, a105
    v_accvgpr_read_b32 v26, a106
    v_accvgpr_read_b32 v27, a107
    v_cvt_pk_bf16_f32 v24, v24, v25
    v_cvt_pk_bf16_f32 v25, v26, v27
    ds_write_b64 v12, v[24:25] offset:20800
    v_accvgpr_read_b32 v28, a108
    v_accvgpr_read_b32 v29, a109
    v_accvgpr_read_b32 v30, a110
    v_accvgpr_read_b32 v31, a111
    v_cvt_pk_bf16_f32 v28, v28, v29
    v_cvt_pk_bf16_f32 v29, v30, v31
    ds_write_b64 v12, v[28:29] offset:30016
    v_accvgpr_read_b32 v16, a112
    v_accvgpr_read_b32 v17, a113
    v_accvgpr_read_b32 v18, a114
    v_accvgpr_read_b32 v19, a115
    v_cvt_pk_bf16_f32 v16, v16, v17
    v_cvt_pk_bf16_f32 v17, v18, v19
    ds_write_b64 v11, v[16:17] offset:96
    v_accvgpr_read_b32 v20, a116
    v_accvgpr_read_b32 v21, a117
    v_accvgpr_read_b32 v22, a118
    v_accvgpr_read_b32 v23, a119
    v_cvt_pk_bf16_f32 v20, v20, v21
    v_cvt_pk_bf16_f32 v21, v22, v23
    ds_write_b64 v11, v[20:21] offset:9312
    v_accvgpr_read_b32 v24, a120
    v_accvgpr_read_b32 v25, a121
    v_accvgpr_read_b32 v26, a122
    v_accvgpr_read_b32 v27, a123
    v_cvt_pk_bf16_f32 v24, v24, v25
    v_cvt_pk_bf16_f32 v25, v26, v27
    ds_write_b64 v11, v[24:25] offset:20832
    v_accvgpr_read_b32 v28, a124
    v_accvgpr_read_b32 v29, a125
    v_accvgpr_read_b32 v30, a126
    v_accvgpr_read_b32 v31, a127
    v_cvt_pk_bf16_f32 v28, v28, v29
    v_cvt_pk_bf16_f32 v29, v30, v31
    s_waitcnt lgkmcnt(14)
    ds_write_b64 v11, v[28:29] offset:30048
    v_accvgpr_read_b32 v16, a128
    v_accvgpr_read_b32 v17, a129
    v_accvgpr_read_b32 v18, a130
    v_accvgpr_read_b32 v19, a131
    v_cvt_pk_bf16_f32 v16, v16, v17
    v_cvt_pk_bf16_f32 v17, v18, v19
    s_waitcnt lgkmcnt(14)
    ds_write_b64 v14, v[16:17] offset:0
    v_accvgpr_read_b32 v20, a132
    v_accvgpr_read_b32 v21, a133
    v_accvgpr_read_b32 v22, a134
    v_accvgpr_read_b32 v23, a135
    v_cvt_pk_bf16_f32 v20, v20, v21
    v_cvt_pk_bf16_f32 v21, v22, v23
    s_cmp_eq_u32 s73, 0
    s_cselect_b64 exec, -1, 0
    s_waitcnt lgkmcnt(14)
    ds_write_b64 v15, v[20:21] offset:32
    s_mov_b64 exec, -1
    s_and_b32 s98, s4, 1
    s_lshl_b32 s98, s98, 6
    v_lshrrev_b32 v3, 4, v1
    v_add_u32 v3, s98, v3
    s_lshr_b32 s99, s4, 1
    s_mul_i32 s7, s99, 144
    s_add_u32 s7, s7, 2
    v_add_u32 v2, s7, v3
    v_mul_u32_u24 v2, 144, v2
    v_add_u32 v2, 98304, v2
    s_sub_u32 s7, 15, s6
    s_cmp_eq_u32 s99, 0
    s_cselect_b32 s7, s6, s7
    s_lshl_b32 s7, s7, 7
    v_add_u32 v3, s7, v3
    v_lshrrev_b32 v8, 4, v3
    s_mov_b32 s98, 149504
    v_mul_lo_u32 v8, v8, s98
    v_and_b32 v9, 0xf0, v1
    v_add_u32 v8, v8, v9
    s_waitcnt lgkmcnt(0)
    s_barrier
    ds_read_b128 v[112:115], v2 offset:2096
    ds_read_b128 v[116:119], v2 offset:2112
    ds_read_b128 v[120:123], v2 offset:2128
    ds_read_b32 v124, v13 offset:0
    ds_read_b32 v125, v13 offset:9216
    ds_read_b32 v126, v13 offset:20736
    ds_read_b32 v127, v13 offset:29952
    ds_read_b128 v[16:19], v2 offset:2016
    ds_read_b128 v[20:23], v2 offset:2032
    ds_read_b128 v[24:27], v2 offset:2048
    ds_read_b128 v[28:31], v2 offset:1728
    ds_read_b128 v[32:35], v2 offset:1744
    ds_read_b128 v[36:39], v2 offset:1760
    ds_read_b128 v[40:43], v2 offset:1440
    ds_read_b128 v[44:47], v2 offset:1456
    s_waitcnt lgkmcnt(14)
    ds_read_b128 v[48:51], v2 offset:1472
    s_waitcnt lgkmcnt(14)
    ds_read_b128 v[52:55], v2 offset:1152
    s_waitcnt lgkmcnt(14)
    ds_read_b128 v[56:59], v2 offset:1168
    s_waitcnt lgkmcnt(14)
    ds_read_b128 v[60:63], v2 offset:1184
    s_waitcnt lgkmcnt(14)
    ds_read_b128 v[64:67], v2 offset:864
    s_waitcnt lgkmcnt(14)
    ds_read_b128 v[68:71], v2 offset:880
    s_waitcnt lgkmcnt(14)
    ds_read_b128 v[72:75], v2 offset:896
    s_waitcnt lgkmcnt(14)
    ds_read_b128 v[76:79], v2 offset:576
    s_waitcnt lgkmcnt(14)
    ds_read_b128 v[80:83], v2 offset:592
    s_waitcnt lgkmcnt(14)
    ds_read_b128 v[84:87], v2 offset:608
    s_waitcnt lgkmcnt(14)
    ds_read_b128 v[88:91], v2 offset:288
    s_waitcnt lgkmcnt(14)
    ds_read_b128 v[92:95], v2 offset:304
    s_waitcnt lgkmcnt(14)
    ds_read_b128 v[96:99], v2 offset:320
    s_waitcnt lgkmcnt(14)
    ds_read_b128 v[100:103], v2 offset:0
    s_waitcnt lgkmcnt(14)
    ds_read_b128 v[104:107], v2 offset:16
    s_waitcnt lgkmcnt(14)
    ds_read_b128 v[108:111], v2 offset:32
    v_mov_b32 v144, 0
    v_mov_b32 v145, 0
    v_mov_b32 v146, 0
    v_mov_b32 v147, 0
    v_mov_b32 v148, 0
    v_mov_b32 v149, 0
    v_mov_b32 v150, 0
    v_mov_b32 v151, 0
    v_dot2c_f32_bf16 v144, v112, v16
    v_dot2c_f32_bf16 v145, v112, v28
    v_dot2c_f32_bf16 v146, v112, v40
    s_waitcnt lgkmcnt(14)
    v_dot2c_f32_bf16 v147, v112, v52
    v_dot2c_f32_bf16 v144, v113, v17
    v_dot2c_f32_bf16 v145, v113, v29
    v_dot2c_f32_bf16 v146, v113, v41
    v_dot2c_f32_bf16 v147, v113, v53
    v_dot2c_f32_bf16 v144, v114, v18
    v_dot2c_f32_bf16 v145, v114, v30
    v_dot2c_f32_bf16 v146, v114, v42
    v_dot2c_f32_bf16 v147, v114, v54
    v_dot2c_f32_bf16 v144, v115, v19
    v_dot2c_f32_bf16 v145, v115, v31
    v_dot2c_f32_bf16 v146, v115, v43
    v_dot2c_f32_bf16 v147, v115, v55
    v_dot2c_f32_bf16 v144, v116, v20
    v_dot2c_f32_bf16 v145, v116, v32
    v_dot2c_f32_bf16 v146, v116, v44
    s_waitcnt lgkmcnt(13)
    v_dot2c_f32_bf16 v147, v116, v56
    v_dot2c_f32_bf16 v144, v117, v21
    v_dot2c_f32_bf16 v145, v117, v33
    v_dot2c_f32_bf16 v146, v117, v45
    v_dot2c_f32_bf16 v147, v117, v57
    v_dot2c_f32_bf16 v144, v118, v22
    v_dot2c_f32_bf16 v145, v118, v34
    v_dot2c_f32_bf16 v146, v118, v46
    v_dot2c_f32_bf16 v147, v118, v58
    v_dot2c_f32_bf16 v144, v119, v23
    v_dot2c_f32_bf16 v145, v119, v35
    v_dot2c_f32_bf16 v146, v119, v47
    v_dot2c_f32_bf16 v147, v119, v59
    v_dot2c_f32_bf16 v144, v120, v24
    v_dot2c_f32_bf16 v145, v120, v36
    v_dot2c_f32_bf16 v146, v120, v48
    s_waitcnt lgkmcnt(12)
    v_dot2c_f32_bf16 v147, v120, v60
    ds_read_b128 v[16:19], v2 offset:2064
    ds_read_b128 v[20:23], v2 offset:2080
    ds_read_b128 v[28:31], v2 offset:1776
    s_waitcnt lgkmcnt(14)
    ds_read_b128 v[32:35], v2 offset:1792
    s_waitcnt lgkmcnt(14)
    ds_read_b128 v[40:43], v2 offset:1488
    s_waitcnt lgkmcnt(14)
    ds_read_b128 v[44:47], v2 offset:1504
    s_waitcnt lgkmcnt(14)
    ds_read_b128 v[52:55], v2 offset:1200
    s_waitcnt lgkmcnt(14)
    ds_read_b128 v[56:59], v2 offset:1216
    v_dot2c_f32_bf16 v148, v112, v64
    v_dot2c_f32_bf16 v149, v112, v76
    s_waitcnt lgkmcnt(13)
    v_dot2c_f32_bf16 v150, v112, v88
    s_waitcnt lgkmcnt(10)
    v_dot2c_f32_bf16 v151, v112, v100
    v_dot2c_f32_bf16 v148, v113, v65
    v_dot2c_f32_bf16 v149, v113, v77
    v_dot2c_f32_bf16 v150, v113, v89
    v_dot2c_f32_bf16 v151, v113, v101
    v_dot2c_f32_bf16 v148, v114, v66
    v_dot2c_f32_bf16 v149, v114, v78
    v_dot2c_f32_bf16 v150, v114, v90
    v_dot2c_f32_bf16 v151, v114, v102
    v_dot2c_f32_bf16 v148, v115, v67
    v_dot2c_f32_bf16 v149, v115, v79
    v_dot2c_f32_bf16 v150, v115, v91
    v_dot2c_f32_bf16 v151, v115, v103
    v_dot2c_f32_bf16 v148, v116, v68
    v_dot2c_f32_bf16 v149, v116, v80
    v_dot2c_f32_bf16 v150, v116, v92
    s_waitcnt lgkmcnt(9)
    v_dot2c_f32_bf16 v151, v116, v104
    v_dot2c_f32_bf16 v148, v117, v69
    v_dot2c_f32_bf16 v149, v117, v81
    v_dot2c_f32_bf16 v150, v117, v93
    v_dot2c_f32_bf16 v151, v117, v105
    v_dot2c_f32_bf16 v148, v118, v70
    v_dot2c_f32_bf16 v149, v118, v82
    v_dot2c_f32_bf16 v150, v118, v94
    v_dot2c_f32_bf16 v151, v118, v106
    v_dot2c_f32_bf16 v148, v119, v71
    v_dot2c_f32_bf16 v149, v119, v83
    v_dot2c_f32_bf16 v150, v119, v95
    v_dot2c_f32_bf16 v151, v119, v107
    v_dot2c_f32_bf16 v148, v120, v72
    v_dot2c_f32_bf16 v149, v120, v84
    v_dot2c_f32_bf16 v150, v120, v96
    s_waitcnt lgkmcnt(8)
    v_dot2c_f32_bf16 v151, v120, v108
    ds_read_b128 v[64:67], v2 offset:912
    ds_read_b128 v[68:71], v2 offset:928
    ds_read_b128 v[76:79], v2 offset:624
    ds_read_b128 v[80:83], v2 offset:640
    ds_read_b128 v[88:91], v2 offset:336
    ds_read_b128 v[92:95], v2 offset:352
    ds_read_b128 v[100:103], v2 offset:48
    s_waitcnt lgkmcnt(14)
    ds_read_b128 v[104:107], v2 offset:64
    s_mov_b32 s98, 0xbfb8aa3b
    s_mov_b32 s99, 0x3fb8aa3b
    s_mov_b32 s7, 0x3eae1a93
    v_lshlrev_b32 v9, 16, v122
    v_mul_f32 v9, s98, v9
    v_exp_f32 v9, v9
    v_lshlrev_b32 v4, 16, v124
    v_mul_f32 v4, s99, v4
    v_exp_f32 v4, v4
    v_lshlrev_b32 v5, 16, v125
    v_mul_f32 v5, s99, v5
    v_exp_f32 v5, v5
    v_lshlrev_b32 v6, 16, v126
    v_mul_f32 v6, s99, v6
    v_exp_f32 v6, v6
    v_lshlrev_b32 v7, 16, v127
    v_mul_f32 v7, s99, v7
    v_exp_f32 v7, v7
    v_add_f32 v9, 1.0, v9
    v_rcp_f32 v9, v9
    v_add_f32 v4, 1.0, v4
    v_rcp_f32 v4, v4
    v_add_f32 v5, 1.0, v5
    v_rcp_f32 v5, v5
    v_add_f32 v6, 1.0, v6
    v_rcp_f32 v6, v6
    v_add_f32 v7, 1.0, v7
    v_rcp_f32 v7, v7
    v_mov_b32 v10, 0xf149f2ca
    v_mul_f32 v144, s7, v144
    v_mul_f32 v145, s7, v145
    v_cmp_le_u32 vcc, 2, v3
    s_nop 1
    v_cndmask_b32 v145, v10, v145, vcc
    v_mul_f32 v146, s7, v146
    v_cmp_le_u32 vcc, 4, v3
    s_nop 1
    v_cndmask_b32 v146, v10, v146, vcc
    v_mul_f32 v147, s7, v147
    v_cmp_le_u32 vcc, 6, v3
    s_nop 1
    v_cndmask_b32 v147, v10, v147, vcc
    v_mul_f32 v148, s7, v148
    v_cmp_le_u32 vcc, 8, v3
    s_nop 1
    v_cndmask_b32 v148, v10, v148, vcc
    v_mul_f32 v149, s7, v149
    v_cmp_le_u32 vcc, 10, v3
    s_nop 1
    v_cndmask_b32 v149, v10, v149, vcc
    v_mul_f32 v150, s7, v150
    v_cmp_le_u32 vcc, 12, v3
    s_nop 1
    v_cndmask_b32 v150, v10, v150, vcc
    v_mul_f32 v151, s7, v151
    v_cmp_le_u32 vcc, 14, v3
    s_nop 1
    v_cndmask_b32 v151, v10, v151, vcc
    v_max3_f32 v10, v144, v145, v146
    v_max3_f32 v11, v147, v148, v149
    v_max3_f32 v10, v10, v150, v151
    v_max_f32 v10, v10, v11
    v_sub_f32 v144, v144, v10
    v_sub_f32 v145, v145, v10
    v_sub_f32 v146, v146, v10
    v_sub_f32 v147, v147, v10
    v_sub_f32 v148, v148, v10
    v_sub_f32 v149, v149, v10
    v_sub_f32 v150, v150, v10
    v_sub_f32 v151, v151, v10
    v_exp_f32 v144, v144
    v_exp_f32 v145, v145
    v_exp_f32 v146, v146
    v_exp_f32 v147, v147
    v_exp_f32 v148, v148
    v_exp_f32 v149, v149
    v_exp_f32 v150, v150
    v_exp_f32 v151, v151
    v_add_f32 v11, v144, v145
    v_add_f32 v11, v11, v146
    v_add_f32 v11, v11, v147
    v_add_f32 v11, v11, v148
    v_add_f32 v11, v11, v149
    v_add_f32 v11, v11, v150
    v_add_f32 v11, v11, v151
    v_rcp_f32 v11, v11
    v_mov_b32 v176, 0
    v_mov_b32 v177, 0
    v_mov_b32 v178, 0
    v_mov_b32 v179, 0
    v_mov_b32 v180, 0
    v_mov_b32 v181, 0
    v_mov_b32 v182, 0
    v_mov_b32 v183, 0
    v_mov_b32 v184, 0
    v_mov_b32 v185, 0
    v_mov_b32 v186, 0
    v_mov_b32 v187, 0
    v_mov_b32 v188, 0
    v_mov_b32 v189, 0
    v_mov_b32 v190, 0
    v_mov_b32 v191, 0
    v_mov_b32 v208, 0
    v_mov_b32 v209, 0
    v_mul_f32 v144, v144, v11
    v_mul_f32 v145, v145, v11
    v_mul_f32 v146, v146, v11
    v_mul_f32 v147, v147, v11
    v_mul_f32 v148, v148, v11
    v_mul_f32 v149, v149, v11
    v_mul_f32 v150, v150, v11
    v_mul_f32 v151, v151, v11
    v_cvt_pk_bf16_f32 v152, 0, v144
    v_cvt_pk_bf16_f32 v153, 0, v145
    v_cvt_pk_bf16_f32 v154, 0, v146
    v_cvt_pk_bf16_f32 v155, 0, v147
    v_cvt_pk_bf16_f32 v156, 0, v148
    v_cvt_pk_bf16_f32 v157, 0, v149
    v_cvt_pk_bf16_f32 v158, 0, v150
    v_cvt_pk_bf16_f32 v159, 0, v151
    v_lshrrev_b32 v144, 16, v152
    v_lshrrev_b32 v145, 16, v153
    v_lshrrev_b32 v146, 16, v154
    v_lshrrev_b32 v147, 16, v155
    v_lshrrev_b32 v148, 16, v156
    v_lshrrev_b32 v149, 16, v157
    v_lshrrev_b32 v150, 16, v158
    v_lshrrev_b32 v151, 16, v159
    v_dot2c_f32_bf16 v176, v26, v144
    v_dot2c_f32_bf16 v177, v26, v152
    v_dot2c_f32_bf16 v178, v27, v144
    v_dot2c_f32_bf16 v179, v27, v152
    v_dot2c_f32_bf16 v180, v16, v144
    v_dot2c_f32_bf16 v181, v16, v152
    v_dot2c_f32_bf16 v182, v17, v144
    v_dot2c_f32_bf16 v183, v17, v152
    v_dot2c_f32_bf16 v184, v18, v144
    v_dot2c_f32_bf16 v185, v18, v152
    v_dot2c_f32_bf16 v186, v19, v144
    v_dot2c_f32_bf16 v187, v19, v152
    s_waitcnt lgkmcnt(14)
    v_dot2c_f32_bf16 v188, v20, v144
    v_dot2c_f32_bf16 v189, v20, v152
    v_dot2c_f32_bf16 v190, v21, v144
    v_dot2c_f32_bf16 v191, v21, v152
    v_dot2c_f32_bf16 v208, v22, v144
    v_dot2c_f32_bf16 v209, v22, v152
    v_dot2c_f32_bf16 v176, v38, v145
    v_dot2c_f32_bf16 v177, v38, v153
    v_dot2c_f32_bf16 v178, v39, v145
    v_dot2c_f32_bf16 v179, v39, v153
    s_waitcnt lgkmcnt(13)
    v_dot2c_f32_bf16 v180, v28, v145
    v_dot2c_f32_bf16 v181, v28, v153
    v_dot2c_f32_bf16 v182, v29, v145
    v_dot2c_f32_bf16 v183, v29, v153
    v_dot2c_f32_bf16 v184, v30, v145
    v_dot2c_f32_bf16 v185, v30, v153
    v_dot2c_f32_bf16 v186, v31, v145
    v_dot2c_f32_bf16 v187, v31, v153
    s_waitcnt lgkmcnt(12)
    v_dot2c_f32_bf16 v188, v32, v145
    v_dot2c_f32_bf16 v189, v32, v153
    v_dot2c_f32_bf16 v190, v33, v145
    v_dot2c_f32_bf16 v191, v33, v153
    v_dot2c_f32_bf16 v208, v34, v145
    v_dot2c_f32_bf16 v209, v34, v153
    v_dot2c_f32_bf16 v176, v50, v146
    v_dot2c_f32_bf16 v177, v50, v154
    v_dot2c_f32_bf16 v178, v51, v146
    v_dot2c_f32_bf16 v179, v51, v154
    s_waitcnt lgkmcnt(11)
    v_dot2c_f32_bf16 v180, v40, v146
    v_dot2c_f32_bf16 v181, v40, v154
    v_dot2c_f32_bf16 v182, v41, v146
    v_dot2c_f32_bf16 v183, v41, v154
    v_dot2c_f32_bf16 v184, v42, v146
    v_dot2c_f32_bf16 v185, v42, v154
    v_dot2c_f32_bf16 v186, v43, v146
    v_dot2c_f32_bf16 v187, v43, v154
    s_waitcnt lgkmcnt(10)
    v_dot2c_f32_bf16 v188, v44, v146
    v_dot2c_f32_bf16 v189, v44, v154
    v_dot2c_f32_bf16 v190, v45, v146
    v_dot2c_f32_bf16 v191, v45, v154
    v_dot2c_f32_bf16 v208, v46, v146
    v_dot2c_f32_bf16 v209, v46, v154
    v_dot2c_f32_bf16 v176, v62, v147
    v_dot2c_f32_bf16 v177, v62, v155
    v_dot2c_f32_bf16 v178, v63, v147
    v_dot2c_f32_bf16 v179, v63, v155
    s_waitcnt lgkmcnt(9)
    v_dot2c_f32_bf16 v180, v52, v147
    v_dot2c_f32_bf16 v181, v52, v155
    v_dot2c_f32_bf16 v182, v53, v147
    v_dot2c_f32_bf16 v183, v53, v155
    v_dot2c_f32_bf16 v184, v54, v147
    v_dot2c_f32_bf16 v185, v54, v155
    v_dot2c_f32_bf16 v186, v55, v147
    v_dot2c_f32_bf16 v187, v55, v155
    s_waitcnt lgkmcnt(8)
    v_dot2c_f32_bf16 v188, v56, v147
    v_dot2c_f32_bf16 v189, v56, v155
    v_dot2c_f32_bf16 v190, v57, v147
    v_dot2c_f32_bf16 v191, v57, v155
    v_dot2c_f32_bf16 v208, v58, v147
    v_dot2c_f32_bf16 v209, v58, v155
    v_dot2c_f32_bf16 v176, v74, v148
    v_dot2c_f32_bf16 v177, v74, v156
    v_dot2c_f32_bf16 v178, v75, v148
    v_dot2c_f32_bf16 v179, v75, v156
    s_waitcnt lgkmcnt(7)
    v_dot2c_f32_bf16 v180, v64, v148
    v_dot2c_f32_bf16 v181, v64, v156
    v_dot2c_f32_bf16 v182, v65, v148
    v_dot2c_f32_bf16 v183, v65, v156
    v_dot2c_f32_bf16 v184, v66, v148
    v_dot2c_f32_bf16 v185, v66, v156
    v_dot2c_f32_bf16 v186, v67, v148
    v_dot2c_f32_bf16 v187, v67, v156
    s_waitcnt lgkmcnt(6)
    v_dot2c_f32_bf16 v188, v68, v148
    v_dot2c_f32_bf16 v189, v68, v156
    v_dot2c_f32_bf16 v190, v69, v148
    v_dot2c_f32_bf16 v191, v69, v156
    v_dot2c_f32_bf16 v208, v70, v148
    v_dot2c_f32_bf16 v209, v70, v156
    v_dot2c_f32_bf16 v176, v86, v149
    v_dot2c_f32_bf16 v177, v86, v157
    v_dot2c_f32_bf16 v178, v87, v149
    v_dot2c_f32_bf16 v179, v87, v157
    s_waitcnt lgkmcnt(5)
    v_dot2c_f32_bf16 v180, v76, v149
    v_dot2c_f32_bf16 v181, v76, v157
    v_dot2c_f32_bf16 v182, v77, v149
    v_dot2c_f32_bf16 v183, v77, v157
    v_dot2c_f32_bf16 v184, v78, v149
    v_dot2c_f32_bf16 v185, v78, v157
    v_dot2c_f32_bf16 v186, v79, v149
    v_dot2c_f32_bf16 v187, v79, v157
    s_waitcnt lgkmcnt(4)
    v_dot2c_f32_bf16 v188, v80, v149
    v_dot2c_f32_bf16 v189, v80, v157
    v_dot2c_f32_bf16 v190, v81, v149
    v_dot2c_f32_bf16 v191, v81, v157
    v_dot2c_f32_bf16 v208, v82, v149
    v_dot2c_f32_bf16 v209, v82, v157
    v_dot2c_f32_bf16 v176, v98, v150
    v_dot2c_f32_bf16 v177, v98, v158
    v_dot2c_f32_bf16 v178, v99, v150
    v_dot2c_f32_bf16 v179, v99, v158
    s_waitcnt lgkmcnt(3)
    v_dot2c_f32_bf16 v180, v88, v150
    v_dot2c_f32_bf16 v181, v88, v158
    v_dot2c_f32_bf16 v182, v89, v150
    v_dot2c_f32_bf16 v183, v89, v158
    v_dot2c_f32_bf16 v184, v90, v150
    v_dot2c_f32_bf16 v185, v90, v158
    v_dot2c_f32_bf16 v186, v91, v150
    v_dot2c_f32_bf16 v187, v91, v158
    s_waitcnt lgkmcnt(2)
    v_dot2c_f32_bf16 v188, v92, v150
    v_dot2c_f32_bf16 v189, v92, v158
    v_dot2c_f32_bf16 v190, v93, v150
    v_dot2c_f32_bf16 v191, v93, v158
    v_dot2c_f32_bf16 v208, v94, v150
    v_dot2c_f32_bf16 v209, v94, v158
    v_dot2c_f32_bf16 v176, v110, v151
    v_dot2c_f32_bf16 v177, v110, v159
    v_dot2c_f32_bf16 v178, v111, v151
    v_dot2c_f32_bf16 v179, v111, v159
    s_waitcnt lgkmcnt(1)
    v_dot2c_f32_bf16 v180, v100, v151
    v_dot2c_f32_bf16 v181, v100, v159
    v_dot2c_f32_bf16 v182, v101, v151
    v_dot2c_f32_bf16 v183, v101, v159
    v_dot2c_f32_bf16 v184, v102, v151
    v_dot2c_f32_bf16 v185, v102, v159
    v_dot2c_f32_bf16 v186, v103, v151
    v_dot2c_f32_bf16 v187, v103, v159
    s_waitcnt lgkmcnt(0)
    v_dot2c_f32_bf16 v188, v104, v151
    v_dot2c_f32_bf16 v189, v104, v159
    v_dot2c_f32_bf16 v190, v105, v151
    v_dot2c_f32_bf16 v191, v105, v159
    v_dot2c_f32_bf16 v208, v106, v151
    v_dot2c_f32_bf16 v209, v106, v159
    v_mul_f32 v176, v9, v176
    v_mul_f32 v177, v9, v177
    v_mul_f32 v178, v9, v178
    v_mul_f32 v179, v9, v179
    v_mul_f32 v180, v9, v180
    v_mul_f32 v181, v9, v181
    v_mul_f32 v182, v9, v182
    v_mul_f32 v183, v9, v183
    v_mul_f32 v184, v9, v184
    v_mul_f32 v185, v9, v185
    v_mul_f32 v186, v9, v186
    v_mul_f32 v187, v9, v187
    v_mul_f32 v188, v9, v188
    v_mul_f32 v189, v9, v189
    v_mul_f32 v190, v9, v190
    v_mul_f32 v191, v9, v191
    v_mul_f32 v208, v9, v208
    v_mul_f32 v209, v9, v209
    v_cvt_pk_bf16_f32 v16, v176, v177
    v_cvt_pk_bf16_f32 v17, v178, v179
    v_cvt_pk_bf16_f32 v18, v180, v181
    v_cvt_pk_bf16_f32 v19, v182, v183
    v_cvt_pk_bf16_f32 v20, v184, v185
    v_cvt_pk_bf16_f32 v21, v186, v187
    v_cvt_pk_bf16_f32 v22, v188, v189
    v_cvt_pk_bf16_f32 v23, v190, v191
    v_cvt_pk_bf16_f32 v24, v208, v209
    s_lshl_b32 s98, s5, 9
    s_add_u32 s98, s98, 131072
    s_lshr_b32 s99, s5, 2
    s_lshl_b32 s99, s99, 8
    s_and_b32 s7, s5, 3
    s_lshl2_add_u32 s99, s7, s99
    s_add_u32 s99, s99, 147456
    buffer_store_dwordx4 v[16:19], v8, s[40:43], s98 offen
    buffer_store_dwordx4 v[20:23], v8, s[40:43], s98 offen offset:256
    buffer_store_dword v24, v8, s[40:43], s99 offen
    v_bfe_u32 v9, v1, 4, 4
    v_lshrrev_b32 v10, 8, v1
    v_lshlrev_b32 v10, 2, v10
    s_lshl_b32 s98, s4, 4
    v_add_u32 v9, s98, v9
    v_sub_u32 v9, v9, v10
    v_mov_b32 v11, 0xf149f2ca
    v_cmp_le_i32 vcc, 0, v9
    s_nop 1
    v_cndmask_b32_e64 v208, v11, 0, vcc
    v_cmp_le_i32 vcc, 1, v9
    s_nop 1
    v_cndmask_b32_e64 v209, v11, 0, vcc
    v_cmp_le_i32 vcc, 2, v9
    s_nop 1
    v_cndmask_b32_e64 v210, v11, 0, vcc
    v_cmp_le_i32 vcc, 3, v9
    s_nop 1
    v_cndmask_b32_e64 v211, v11, 0, vcc
    v_cmp_le_i32 vcc, 16, v9
    s_nop 1
    v_cndmask_b32_e64 v212, v11, 0, vcc
    v_cmp_le_i32 vcc, 17, v9
    s_nop 1
    v_cndmask_b32_e64 v213, v11, 0, vcc
    v_cmp_le_i32 vcc, 18, v9
    s_nop 1
    v_cndmask_b32_e64 v214, v11, 0, vcc
    v_cmp_le_i32 vcc, 19, v9
    s_nop 1
    v_cndmask_b32_e64 v215, v11, 0, vcc
    v_cmp_le_i32 vcc, 32, v9
    s_nop 1
    v_cndmask_b32_e64 v216, v11, 0, vcc
    v_cmp_le_i32 vcc, 33, v9
    s_nop 1
    v_cndmask_b32_e64 v217, v11, 0, vcc
    v_cmp_le_i32 vcc, 34, v9
    s_nop 1
    v_cndmask_b32_e64 v218, v11, 0, vcc
    v_cmp_le_i32 vcc, 35, v9
    s_nop 1
    v_cndmask_b32_e64 v219, v11, 0, vcc
    v_cmp_le_i32 vcc, 48, v9
    s_nop 1
    v_cndmask_b32_e64 v220, v11, 0, vcc
    v_cmp_le_i32 vcc, 49, v9
    s_nop 1
    v_cndmask_b32_e64 v221, v11, 0, vcc
    v_cmp_le_i32 vcc, 50, v9
    s_nop 1
    v_cndmask_b32_e64 v222, v11, 0, vcc
    v_cmp_le_i32 vcc, 51, v9
    s_nop 1
    v_cndmask_b32_e64 v223, v11, 0, vcc
    s_lshl3_add_u32 s81, s6, s4
    s_mul_i32 s81, s81, 149504
    s_sub_u32 s7, 15, s6
    s_lshl3_add_u32 s82, s7, s4
    s_mul_i32 s82, s82, 149504
    s_lshl_b32 s7, s5, 12
    s_add_u32 s81, s81, s7
    s_add_u32 s82, s82, s7
    s_mov_b32 s101, 0x71800000
K1_ATT:
    s_mov_b32 s75, 0
    s_mov_b32 s76, 98304
    s_mov_b32 s60, 131072
    s_cmp_eq_u32 s6, 0
    s_cselect_b32 s79, 1.0, 0
    v_mov_b32 v2, v1
    v_mov_b32 v11, 0
    s_waitcnt vmcnt(16) lgkmcnt(0)
    s_barrier
    ds_read_b128 a[64:67], v2 offset:0
    ds_read_b128 a[68:71], v2 offset:1024
    ds_read_b128 a[72:75], v2 offset:2048
    ds_read_b128 a[76:79], v2 offset:3072
    ds_read_b128 a[96:99], v2 offset:16384
    ds_read_b128 a[100:103], v2 offset:17408
    s_cmp_lg_u32 s83, 0
    s_cbranch_scc1 K1_HAVEM
    v_mul_f32 v176, s79, v208
    v_mul_f32 v177, s79, v209
    v_mul_f32 v178, s79, v210
    v_mul_f32 v179, s79, v211
    s_waitcnt lgkmcnt(2)
    s_nop 0
    v_mfma_f32_16x16x32_bf16 v[240:243], a[64:67], v[128:131], v[176:179]
    v_mfma_f32_16x16x32_bf16 v[240:243], a[68:71], v[160:163], v[240:243]
    v_mfma_f32_16x16x32_bf16 v[240:243], a[72:75], v[192:195], v[240:243]
    v_mfma_f32_16x16x32_bf16 v[240:243], a[76:79], v[224:227], v[240:243]
    v_mfma_f32_16x16x32_bf16 v[244:247], a[64:67], v[132:135], 0
    v_mfma_f32_16x16x32_bf16 v[244:247], a[68:71], v[164:167], v[244:247]
    v_mfma_f32_16x16x32_bf16 v[244:247], a[72:75], v[196:199], v[244:247]
    v_mfma_f32_16x16x32_bf16 v[244:247], a[76:79], v[228:231], v[244:247]
    v_mfma_f32_16x16x32_bf16 v[248:251], a[64:67], v[136:139], 0
    v_mfma_f32_16x16x32_bf16 v[248:251], a[68:71], v[168:171], v[248:251]
    v_mfma_f32_16x16x32_bf16 v[248:251], a[72:75], v[200:203], v[248:251]
    v_mfma_f32_16x16x32_bf16 v[248:251], a[76:79], v[232:235], v[248:251]
    v_mfma_f32_16x16x32_bf16 v[252:255], a[64:67], v[140:143], 0
    v_mfma_f32_16x16x32_bf16 v[252:255], a[68:71], v[172:175], v[252:255]
    v_mfma_f32_16x16x32_bf16 v[252:255], a[72:75], v[204:207], v[252:255]
    v_mfma_f32_16x16x32_bf16 v[252:255], a[76:79], v[236:239], v[252:255]
    v_max3_f32 v240, v240, v241, v242
    v_max_f32 v240, v240, v243
    v_max3_f32 v244, v244, v245, v246
    v_max_f32 v244, v244, v247
    v_max3_f32 v248, v248, v249, v250
    v_max_f32 v248, v248, v251
    s_nop 1
    v_max3_f32 v252, v252, v253, v254
    v_max_f32 v252, v252, v255
    v_mov_b32 v241, v240
    v_mov_b32 v245, v244
    v_mov_b32 v249, v248
    v_mov_b32 v253, v252
    v_permlane32_swap_b32 v240, v241
    v_permlane32_swap_b32 v244, v245
    v_permlane32_swap_b32 v248, v249
    v_permlane32_swap_b32 v252, v253
    v_max_f32 v240, v240, v241
    v_max_f32 v244, v244, v245
    v_max_f32 v248, v248, v249
    v_max_f32 v252, v252, v253
    v_mov_b32 v241, v240
    v_mov_b32 v245, v244
    v_mov_b32 v249, v248
    v_mov_b32 v253, v252
    v_permlane16_swap_b32 v240, v241
    v_permlane16_swap_b32 v244, v245
    v_permlane16_swap_b32 v248, v249
    v_permlane16_swap_b32 v252, v253
    v_max_f32 v240, v240, v241
    v_max_f32 v244, v244, v245
    v_max_f32 v248, v248, v249
    v_max_f32 v252, v252, v253
    v_sub_f32 v144, 0, v240
    v_sub_f32 v145, 0, v240
    v_sub_f32 v146, 0, v240
    v_sub_f32 v147, 0, v240
    v_sub_f32 v148, 0, v244
    v_sub_f32 v149, 0, v244
    v_sub_f32 v150, 0, v244
    v_sub_f32 v151, 0, v244
    v_sub_f32 v152, 0, v248
    v_sub_f32 v153, 0, v248
    v_sub_f32 v154, 0, v248
    v_sub_f32 v155, 0, v248
    v_sub_f32 v156, 0, v252
    v_sub_f32 v157, 0, v252
    v_sub_f32 v158, 0, v252
    v_sub_f32 v159, 0, v252
K1_HAVEM:
    v_fma_f32 v176, v208, s79, v144
    v_fma_f32 v177, v209, s79, v144
    v_fma_f32 v178, v210, s79, v144
    v_fma_f32 v179, v211, s79, v144
    s_nop 1
    s_waitcnt lgkmcnt(0)
    v_mfma_f32_16x16x32_bf16 v[240:243], a[64:67], v[128:131], v[176:179]
    s_add_u32 m0, s76, s80
    ds_read_b128 a[80:83], v2 offset:4096
    ds_read_b128 a[84:87], v2 offset:5120
    v_mfma_f32_16x16x32_bf16 v[240:243], a[68:71], v[160:163], v[240:243]
    s_mov_b32 s76, s60
    buffer_load_dwordx4 v1, s[36:39], s77 offen lds
    v_mfma_f32_16x16x32_bf16 v[240:243], a[72:75], v[192:195], v[240:243]
    s_mov_b32 s60, s75
    ds_read_b128 a[88:91], v2 offset:6144
    ds_read_b128 a[92:95], v2 offset:7168
    v_mfma_f32_16x16x32_bf16 v[240:243], a[76:79], v[224:227], v[240:243]
    s_add_u32 s75, s75, 32768
    v_fma_f32 v180, v212, s79, v144
    v_fma_f32 v181, v213, s79, v144
    v_mfma_f32_16x16x32_bf16 v[244:247], a[64:67], v[132:135], v[148:151]
    v_fma_f32 v182, v214, s79, v144
    v_fma_f32 v183, v215, s79, v144
    v_mfma_f32_16x16x32_bf16 v[244:247], a[68:71], v[164:167], v[244:247]
    v_fma_f32 v184, v216, s79, v144
    v_fma_f32 v185, v217, s79, v144
    v_mfma_f32_16x16x32_bf16 v[244:247], a[72:75], v[196:199], v[244:247]
    buffer_load_dwordx4 v1, s[36:39], s77 offen offset:1024 lds
    v_mfma_f32_16x16x32_bf16 v[244:247], a[76:79], v[228:231], v[244:247]
    v_exp_f32 v240, v240
    v_mfma_f32_16x16x32_bf16 v[248:251], a[64:67], v[136:139], v[152:155]
    v_exp_f32 v241, v241
    v_mfma_f32_16x16x32_bf16 v[248:251], a[68:71], v[168:171], v[248:251]
    v_exp_f32 v242, v242
    v_mfma_f32_16x16x32_bf16 v[248:251], a[72:75], v[200:203], v[248:251]
    v_exp_f32 v243, v243
    v_mfma_f32_16x16x32_bf16 v[248:251], a[76:79], v[232:235], v[248:251]
    buffer_load_dwordx4 v1, s[36:39], s77 offen offset:2048 lds
    v_mfma_f32_16x16x32_bf16 v[252:255], a[64:67], v[140:143], v[156:159]
    v_cvt_pk_bf16_f32 v64, v240, v241
    v_cvt_pk_bf16_f32 v65, v242, v243
    v_mfma_f32_16x16x32_bf16 v[252:255], a[68:71], v[172:175], v[252:255]
    v_exp_f32 v244, v244
    v_mfma_f32_16x16x32_bf16 v[252:255], a[72:75], v[204:207], v[252:255]
    v_exp_f32 v245, v245
    v_mfma_f32_16x16x32_bf16 v[252:255], a[76:79], v[236:239], v[252:255]
    s_waitcnt lgkmcnt(0)
    v_exp_f32 v246, v246
    v_mfma_f32_16x16x32_bf16 v[240:243], a[80:83], v[128:131], v[180:183]
    v_exp_f32 v247, v247
    v_mfma_f32_16x16x32_bf16 v[240:243], a[84:87], v[160:163], v[240:243]
    buffer_load_dwordx4 v1, s[36:39], s77 offen offset:3072 lds
    v_mfma_f32_16x16x32_bf16 v[240:243], a[88:91], v[192:195], v[240:243]
    v_cvt_pk_bf16_f32 v72, v244, v245
    v_cvt_pk_bf16_f32 v73, v246, v247
    v_mfma_f32_16x16x32_bf16 v[240:243], a[92:95], v[224:227], v[240:243]
    v_exp_f32 v248, v248
    v_mfma_f32_16x16x32_bf16 v[244:247], a[80:83], v[132:135], v[148:151]
    v_exp_f32 v249, v249
    v_mfma_f32_16x16x32_bf16 v[244:247], a[84:87], v[164:167], v[244:247]
    s_add_u32 s100, s77, 4096
    v_exp_f32 v250, v250
    v_mfma_f32_16x16x32_bf16 v[244:247], a[88:91], v[196:199], v[244:247]
    s_add_u32 m0, m0, 4096
    v_exp_f32 v251, v251
    v_mfma_f32_16x16x32_bf16 v[244:247], a[92:95], v[228:231], v[244:247]
    v_cvt_pk_bf16_f32 v80, v248, v249
    v_cvt_pk_bf16_f32 v81, v250, v251
    v_mfma_f32_16x16x32_bf16 v[248:251], a[80:83], v[136:139], v[152:155]
    ds_read_b128 a[64:67], v2 offset:8192
    ds_read_b128 a[68:71], v2 offset:9216
    v_mfma_f32_16x16x32_bf16 v[248:251], a[84:87], v[168:171], v[248:251]
    buffer_load_dwordx4 v1, s[36:39], s100 offen lds
    v_mfma_f32_16x16x32_bf16 v[248:251], a[88:91], v[200:203], v[248:251]
    v_exp_f32 v252, v252
    v_mfma_f32_16x16x32_bf16 v[248:251], a[92:95], v[232:235], v[248:251]
    v_exp_f32 v253, v253
    v_exp_f32 v254, v254
    v_exp_f32 v255, v255
    v_cvt_pk_bf16_f32 v88, v252, v253
    v_cvt_pk_bf16_f32 v89, v254, v255
    v_mfma_f32_16x16x32_bf16 v[252:255], a[80:83], v[140:143], v[156:159]
    ds_read_b128 a[72:75], v2 offset:10240
    ds_read_b128 a[76:79], v2 offset:11264
    v_mfma_f32_16x16x32_bf16 v[252:255], a[84:87], v[172:175], v[252:255]
    buffer_load_dwordx4 v1, s[36:39], s100 offen offset:1024 lds
    v_mfma_f32_16x16x32_bf16 v[252:255], a[88:91], v[204:207], v[252:255]
    v_exp_f32 v240, v240
    v_mfma_f32_16x16x32_bf16 v[252:255], a[92:95], v[236:239], v[252:255]
    s_waitcnt lgkmcnt(2)
    v_exp_f32 v241, v241
    v_exp_f32 v242, v242
    v_exp_f32 v243, v243
    v_fma_f32 v186, v218, s79, v144
    v_fma_f32 v187, v219, s79, v144
    v_cvt_pk_bf16_f32 v66, v240, v241
    v_cvt_pk_bf16_f32 v67, v242, v243
    v_mfma_f32_16x16x32_bf16 v[240:243], a[64:67], v[128:131], v[184:187]
    v_exp_f32 v244, v244
    v_mfma_f32_16x16x32_bf16 v[240:243], a[68:71], v[160:163], v[240:243]
    s_waitcnt lgkmcnt(0)
    v_exp_f32 v245, v245
    v_mfma_f32_16x16x32_bf16 v[240:243], a[72:75], v[192:195], v[240:243]
    v_exp_f32 v246, v246
    v_mfma_f32_16x16x32_bf16 v[240:243], a[76:79], v[224:227], v[240:243]
    v_exp_f32 v247, v247
    v_cvt_pk_bf16_f32 v74, v244, v245
    v_cvt_pk_bf16_f32 v75, v246, v247
    v_mfma_f32_16x16x32_bf16 v[244:247], a[64:67], v[132:135], v[148:151]
    buffer_load_dwordx4 v1, s[36:39], s100 offen offset:2048 lds
    v_mfma_f32_16x16x32_bf16 v[244:247], a[68:71], v[164:167], v[244:247]
    v_exp_f32 v248, v248
    v_mfma_f32_16x16x32_bf16 v[244:247], a[72:75], v[196:199], v[244:247]
    v_exp_f32 v249, v249
    v_mfma_f32_16x16x32_bf16 v[244:247], a[76:79], v[228:231], v[244:247]
    v_exp_f32 v250, v250
    v_exp_f32 v251, v251
    v_cvt_pk_bf16_f32 v82, v248, v249
    v_cvt_pk_bf16_f32 v83, v250, v251
    v_mfma_f32_16x16x32_bf16 v[248:251], a[64:67], v[136:139], v[152:155]
    buffer_load_dwordx4 v1, s[36:39], s100 offen offset:3072 lds
    v_mfma_f32_16x16x32_bf16 v[248:251], a[68:71], v[168:171], v[248:251]
    ds_read_b128 a[80:83], v2 offset:12288
    ds_read_b128 a[84:87], v2 offset:13312
    v_mfma_f32_16x16x32_bf16 v[248:251], a[72:75], v[200:203], v[248:251]
    s_add_u32 s77, s77, 32768
    v_exp_f32 v252, v252
    v_mfma_f32_16x16x32_bf16 v[248:251], a[76:79], v[232:235], v[248:251]
    v_exp_f32 v253, v253
    v_exp_f32 v254, v254
    v_exp_f32 v255, v255
    v_cvt_pk_bf16_f32 v90, v252, v253
    v_cvt_pk_bf16_f32 v91, v254, v255
    v_mfma_f32_16x16x32_bf16 v[252:255], a[64:67], v[140:143], v[156:159]
    ds_read_b128 a[88:91], v2 offset:14336
    ds_read_b128 a[92:95], v2 offset:15360
    v_mfma_f32_16x16x32_bf16 v[252:255], a[68:71], v[172:175], v[252:255]
    v_exp_f32 v240, v240
    v_mfma_f32_16x16x32_bf16 v[252:255], a[72:75], v[204:207], v[252:255]
    v_exp_f32 v241, v241
    v_mfma_f32_16x16x32_bf16 v[252:255], a[76:79], v[236:239], v[252:255]
    s_waitcnt lgkmcnt(2)
    v_exp_f32 v242, v242
    v_exp_f32 v243, v243
    v_fma_f32 v188, v220, s79, v144
    v_fma_f32 v189, v221, s79, v144
    v_fma_f32 v190, v222, s79, v144
    v_fma_f32 v191, v223, s79, v144
    v_cvt_pk_bf16_f32 v68, v240, v241
    v_cvt_pk_bf16_f32 v69, v242, v243
    v_mfma_f32_16x16x32_bf16 v[240:243], a[80:83], v[128:131], v[188:191]
    v_exp_f32 v244, v244
    v_mfma_f32_16x16x32_bf16 v[240:243], a[84:87], v[160:163], v[240:243]
    s_cmp_eq_u32 s75, 163840
    s_cselect_b32 s75, 0, s75
    v_add_u32 v2, s75, v1
    s_waitcnt lgkmcnt(0)
    v_mfma_f32_16x16x32_bf16 v[240:243], a[88:91], v[192:195], v[240:243]
    v_exp_f32 v245, v245
    v_mfma_f32_16x16x32_bf16 v[240:243], a[92:95], v[224:227], v[240:243]
    s_waitcnt vmcnt(16)
    s_barrier
    v_cvt_pk_bf16_f32 v76, v244, v245
    v_exp_f32 v246, v246
    v_exp_f32 v247, v247
    s_nop 0
    v_cvt_pk_bf16_f32 v77, v246, v247
    v_mfma_f32_16x16x32_bf16 v[244:247], a[80:83], v[132:135], v[148:151]
    ds_read_b128 a[64:67], v2 offset:0
    ds_read_b128 a[68:71], v2 offset:1024
    v_mfma_f32_16x16x32_bf16 v[244:247], a[84:87], v[164:167], v[244:247]
    v_exp_f32 v248, v248
    v_mfma_f32_16x16x32_bf16 v[244:247], a[88:91], v[196:199], v[244:247]
    v_exp_f32 v249, v249
    v_mfma_f32_16x16x32_bf16 v[244:247], a[92:95], v[228:231], v[244:247]
    v_exp_f32 v250, v250
    v_exp_f32 v251, v251
    v_cvt_pk_bf16_f32 v84, v248, v249
    v_cvt_pk_bf16_f32 v85, v250, v251
    v_mfma_f32_16x16x32_bf16 v[248:251], a[80:83], v[136:139], v[152:155]
    ds_read_b128 a[72:75], v2 offset:2048
    ds_read_b128 a[76:79], v2 offset:3072
    v_mfma_f32_16x16x32_bf16 v[248:251], a[84:87], v[168:171], v[248:251]
    ds_read_b128 a[96:99], v2 offset:16384
    ds_read_b128 a[100:103], v2 offset:17408
    v_mfma_f32_16x16x32_bf16 v[248:251], a[88:91], v[200:203], v[248:251]
    v_exp_f32 v252, v252
    v_mfma_f32_16x16x32_bf16 v[248:251], a[92:95], v[232:235], v[248:251]
    v_exp_f32 v253, v253
    v_exp_f32 v254, v254
    v_exp_f32 v255, v255
    v_cvt_pk_bf16_f32 v92, v252, v253
    v_cvt_pk_bf16_f32 v93, v254, v255
    v_mfma_f32_16x16x32_bf16 v[252:255], a[80:83], v[140:143], v[156:159]
    v_exp_f32 v240, v240
    v_mfma_f32_16x16x32_bf16 v[252:255], a[84:87], v[172:175], v[252:255]
    v_exp_f32 v241, v241
    v_mfma_f32_16x16x32_bf16 v[252:255], a[88:91], v[204:207], v[252:255]
    v_exp_f32 v242, v242
    v_mfma_f32_16x16x32_bf16 v[252:255], a[92:95], v[236:239], v[252:255]
    v_exp_f32 v243, v243
    v_exp_f32 v244, v244
    v_exp_f32 v245, v245
    v_exp_f32 v246, v246
    v_exp_f32 v247, v247
    v_exp_f32 v248, v248
    v_exp_f32 v249, v249
    v_exp_f32 v250, v250
    v_exp_f32 v251, v251
    v_exp_f32 v252, v252
    v_exp_f32 v253, v253
    v_cvt_pk_bf16_f32 v70, v240, v241
    v_cvt_pk_bf16_f32 v71, v242, v243
    v_cvt_pk_bf16_f32 v78, v244, v245
    v_cvt_pk_bf16_f32 v79, v246, v247
    v_cvt_pk_bf16_f32 v86, v248, v249
    v_cvt_pk_bf16_f32 v87, v250, v251
    v_cvt_pk_bf16_f32 v94, v252, v253
    s_mov_b32 s78, s6
    s_cmp_eq_u32 s78, 0
    s_cbranch_scc1 K1_LB_END
.p2align 3
K1_LB:
    s_waitcnt lgkmcnt(0)
    v_mfma_f32_16x16x32_bf16 v[240:243], a[64:67], v[128:131], v[176:179]
    s_add_u32 m0, s76, s80
    v_exp_f32 v254, v254
    v_mfma_f32_16x16x32_bf16 v[240:243], a[68:71], v[160:163], v[240:243]
    s_mov_b32 s76, s60
    buffer_load_dwordx4 v1, s[36:39], s77 offen lds
    v_mfma_f32_16x16x32_bf16 v[240:243], a[72:75], v[192:195], v[240:243]
    s_mov_b32 s60, s75
    v_exp_f32 v255, v255
    v_mfma_f32_16x16x32_bf16 v[240:243], a[76:79], v[224:227], v[240:243]
    s_add_u32 s75, s75, 32768
    ds_read_b128 a[104:107], v2 offset:18432
    v_cvt_pk_bf16_f32 v95, v254, v255
    v_mfma_f32_16x16x32_bf16 a[0:3], a[96:99], v[64:67], a[0:3]
    ds_read_b128 a[108:111], v2 offset:19456
    ds_read_b128 a[80:83], v2 offset:4096
    v_mfma_f32_16x16x32_bf16 a[0:3], a[100:103], v[68:71], a[0:3]
    ds_read_b128 a[84:87], v2 offset:5120
    ds_read_b128 a[88:91], v2 offset:6144
    v_mfma_f32_16x16x32_bf16 a[4:7], a[96:99], v[72:75], a[4:7]
    ds_read_b128 a[92:95], v2 offset:7168
    ds_read_b128 a[112:115], v2 offset:20480
    v_mfma_f32_16x16x32_bf16 a[4:7], a[100:103], v[76:79], a[4:7]
    ds_read_b128 a[116:119], v2 offset:21504
    ds_read_b128 a[120:123], v2 offset:22528
    v_mfma_f32_16x16x32_bf16 v[244:247], a[64:67], v[132:135], v[148:151]
    v_exp_f32 v240, v240
    v_mfma_f32_16x16x32_bf16 v[244:247], a[68:71], v[164:167], v[244:247]
    v_exp_f32 v241, v241
    v_mfma_f32_16x16x32_bf16 v[244:247], a[72:75], v[196:199], v[244:247]
    v_exp_f32 v242, v242
    v_mfma_f32_16x16x32_bf16 v[244:247], a[76:79], v[228:231], v[244:247]
    v_exp_f32 v243, v243
    v_mfma_f32_16x16x32_bf16 a[8:11], a[96:99], v[80:83], a[8:11]
    v_cvt_pk_bf16_f32 v96, v240, v241
    v_cvt_pk_bf16_f32 v97, v242, v243
    v_mfma_f32_16x16x32_bf16 a[8:11], a[100:103], v[84:87], a[8:11]
    ds_read_b128 a[124:127], v2 offset:23552
    v_mfma_f32_16x16x32_bf16 a[12:15], a[96:99], v[88:91], a[12:15]
    v_mfma_f32_16x16x32_bf16 a[12:15], a[100:103], v[92:95], a[12:15]
    buffer_load_dwordx4 v1, s[36:39], s77 offen offset:1024 lds
    v_mfma_f32_16x16x32_bf16 v[248:251], a[64:67], v[136:139], v[152:155]
    v_exp_f32 v244, v244
    v_mfma_f32_16x16x32_bf16 v[248:251], a[68:71], v[168:171], v[248:251]
    v_exp_f32 v245, v245
    v_mfma_f32_16x16x32_bf16 v[248:251], a[72:75], v[200:203], v[248:251]
    v_exp_f32 v246, v246
    v_mfma_f32_16x16x32_bf16 v[248:251], a[76:79], v[232:235], v[248:251]
    s_waitcnt lgkmcnt(0)
    v_exp_f32 v247, v247
    v_mfma_f32_16x16x32_bf16 a[16:19], a[104:107], v[64:67], a[16:19]
    v_cvt_pk_bf16_f32 v104, v244, v245
    v_cvt_pk_bf16_f32 v105, v246, v247
    v_mfma_f32_16x16x32_bf16 a[16:19], a[108:111], v[68:71], a[16:19]
    v_mfma_f32_16x16x32_bf16 a[20:23], a[104:107], v[72:75], a[20:23]
    v_mfma_f32_16x16x32_bf16 a[20:23], a[108:111], v[76:79], a[20:23]
    v_mfma_f32_16x16x32_bf16 v[252:255], a[64:67], v[140:143], v[156:159]
    v_exp_f32 v248, v248
    v_mfma_f32_16x16x32_bf16 v[252:255], a[68:71], v[172:175], v[252:255]
    v_exp_f32 v249, v249
    v_mfma_f32_16x16x32_bf16 v[252:255], a[72:75], v[204:207], v[252:255]
    v_exp_f32 v250, v250
    v_mfma_f32_16x16x32_bf16 v[252:255], a[76:79], v[236:239], v[252:255]
    v_exp_f32 v251, v251
    v_mfma_f32_16x16x32_bf16 a[24:27], a[104:107], v[80:83], a[24:27]
    v_cvt_pk_bf16_f32 v112, v248, v249
    v_cvt_pk_bf16_f32 v113, v250, v251
    v_mfma_f32_16x16x32_bf16 a[24:27], a[108:111], v[84:87], a[24:27]
    buffer_load_dwordx4 v1, s[36:39], s77 offen offset:2048 lds
    v_mfma_f32_16x16x32_bf16 a[28:31], a[104:107], v[88:91], a[28:31]
    ds_read_b128 a[64:67], v2 offset:8192
    ds_read_b128 a[68:71], v2 offset:9216
    v_mfma_f32_16x16x32_bf16 a[28:31], a[108:111], v[92:95], a[28:31]
    v_exp_f32 v252, v252
    v_mfma_f32_16x16x32_bf16 v[240:243], a[80:83], v[128:131], v[180:183]
    v_exp_f32 v253, v253
    v_mfma_f32_16x16x32_bf16 v[240:243], a[84:87], v[160:163], v[240:243]
    v_exp_f32 v254, v254
    v_mfma_f32_16x16x32_bf16 v[240:243], a[88:91], v[192:195], v[240:243]
    v_exp_f32 v255, v255
    v_mfma_f32_16x16x32_bf16 v[240:243], a[92:95], v[224:227], v[240:243]
    v_cvt_pk_bf16_f32 v120, v252, v253
    v_cvt_pk_bf16_f32 v121, v254, v255
    v_mfma_f32_16x16x32_bf16 a[32:35], a[112:115], v[64:67], a[32:35]
    ds_read_b128 a[72:75], v2 offset:10240
    ds_read_b128 a[76:79], v2 offset:11264
    v_mfma_f32_16x16x32_bf16 a[32:35], a[116:119], v[68:71], a[32:35]
    ds_read_b128 a[96:99], v2 offset:24576
    ds_read_b128 a[100:103], v2 offset:25600
    v_mfma_f32_16x16x32_bf16 a[36:39], a[112:115], v[72:75], a[36:39]
    v_exp_f32 v240, v240
    v_mfma_f32_16x16x32_bf16 a[36:39], a[116:119], v[76:79], a[36:39]
    v_exp_f32 v241, v241
    v_mfma_f32_16x16x32_bf16 v[244:247], a[80:83], v[132:135], v[148:151]
    v_exp_f32 v242, v242
    v_mfma_f32_16x16x32_bf16 v[244:247], a[84:87], v[164:167], v[244:247]
    v_exp_f32 v243, v243
    v_mfma_f32_16x16x32_bf16 v[244:247], a[88:91], v[196:199], v[244:247]
    v_cvt_pk_bf16_f32 v98, v240, v241
    v_cvt_pk_bf16_f32 v99, v242, v243
    v_mfma_f32_16x16x32_bf16 v[244:247], a[92:95], v[228:231], v[244:247]
    buffer_load_dwordx4 v1, s[36:39], s77 offen offset:3072 lds
    v_mfma_f32_16x16x32_bf16 a[40:43], a[112:115], v[80:83], a[40:43]
    ds_read_b128 a[104:107], v2 offset:26624
    ds_read_b128 a[108:111], v2 offset:27648
    v_mfma_f32_16x16x32_bf16 a[40:43], a[116:119], v[84:87], a[40:43]
    v_mfma_f32_16x16x32_bf16 a[44:47], a[112:115], v[88:91], a[44:47]
    v_mfma_f32_16x16x32_bf16 a[44:47], a[116:119], v[92:95], a[44:47]
    v_mfma_f32_16x16x32_bf16 v[248:251], a[80:83], v[136:139], v[152:155]
    v_exp_f32 v244, v244
    v_mfma_f32_16x16x32_bf16 v[248:251], a[84:87], v[168:171], v[248:251]
    v_exp_f32 v245, v245
    v_mfma_f32_16x16x32_bf16 v[248:251], a[88:91], v[200:203], v[248:251]
    v_exp_f32 v246, v246
    v_mfma_f32_16x16x32_bf16 v[248:251], a[92:95], v[232:235], v[248:251]
    v_exp_f32 v247, v247
    v_mfma_f32_16x16x32_bf16 a[48:51], a[120:123], v[64:67], a[48:51]
    v_cvt_pk_bf16_f32 v106, v244, v245
    v_cvt_pk_bf16_f32 v107, v246, v247
    v_mfma_f32_16x16x32_bf16 a[48:51], a[124:127], v[68:71], a[48:51]
    v_mfma_f32_16x16x32_bf16 a[52:55], a[120:123], v[72:75], a[52:55]
    v_mfma_f32_16x16x32_bf16 a[52:55], a[124:127], v[76:79], a[52:55]
    v_mfma_f32_16x16x32_bf16 v[252:255], a[80:83], v[140:143], v[156:159]
    v_exp_f32 v248, v248
    v_mfma_f32_16x16x32_bf16 v[252:255], a[84:87], v[172:175], v[252:255]
    s_add_u32 s100, s77, 4096
    v_exp_f32 v249, v249
    v_mfma_f32_16x16x32_bf16 v[252:255], a[88:91], v[204:207], v[252:255]
    s_add_u32 m0, m0, 4096
    v_exp_f32 v250, v250
    v_mfma_f32_16x16x32_bf16 v[252:255], a[92:95], v[236:239], v[252:255]
    buffer_load_dwordx4 v1, s[36:39], s100 offen lds
    v_mfma_f32_16x16x32_bf16 a[56:59], a[120:123], v[80:83], a[56:59]
    v_exp_f32 v251, v251
    v_mfma_f32_16x16x32_bf16 a[56:59], a[124:127], v[84:87], a[56:59]
    v_cvt_pk_bf16_f32 v114, v248, v249
    v_cvt_pk_bf16_f32 v115, v250, v251
    v_mfma_f32_16x16x32_bf16 a[60:63], a[120:123], v[88:91], a[60:63]
    ds_read_b128 a[80:83], v2 offset:12288
    ds_read_b128 a[84:87], v2 offset:13312
    v_mfma_f32_16x16x32_bf16 a[60:63], a[124:127], v[92:95], a[60:63]
    s_waitcnt lgkmcnt(2)
    v_exp_f32 v252, v252
    v_mfma_f32_16x16x32_bf16 v[240:243], a[64:67], v[128:131], v[184:187]
    v_exp_f32 v253, v253
    v_mfma_f32_16x16x32_bf16 v[240:243], a[68:71], v[160:163], v[240:243]
    v_exp_f32 v254, v254
    v_mfma_f32_16x16x32_bf16 v[240:243], a[72:75], v[192:195], v[240:243]
    v_exp_f32 v255, v255
    v_mfma_f32_16x16x32_bf16 v[240:243], a[76:79], v[224:227], v[240:243]
    v_cvt_pk_bf16_f32 v122, v252, v253
    v_cvt_pk_bf16_f32 v123, v254, v255
    v_mfma_f32_16x16x32_bf16 a[144:147], a[96:99], v[64:67], a[144:147]
    ds_read_b128 a[88:91], v2 offset:14336
    ds_read_b128 a[92:95], v2 offset:15360
    v_mfma_f32_16x16x32_bf16 a[144:147], a[100:103], v[68:71], a[144:147]
    ds_read_b128 a[112:115], v2 offset:28672
    ds_read_b128 a[116:119], v2 offset:29696
    v_mfma_f32_16x16x32_bf16 a[148:151], a[96:99], v[72:75], a[148:151]
    v_exp_f32 v240, v240
    v_mfma_f32_16x16x32_bf16 a[148:151], a[100:103], v[76:79], a[148:151]
    v_exp_f32 v241, v241
    v_mfma_f32_16x16x32_bf16 v[244:247], a[64:67], v[132:135], v[148:151]
    buffer_load_dwordx4 v1, s[36:39], s100 offen offset:1024 lds
    v_mfma_f32_16x16x32_bf16 v[244:247], a[68:71], v[164:167], v[244:247]
    v_exp_f32 v242, v242
    v_mfma_f32_16x16x32_bf16 v[244:247], a[72:75], v[196:199], v[244:247]
    v_exp_f32 v243, v243
    v_mfma_f32_16x16x32_bf16 v[244:247], a[76:79], v[228:231], v[244:247]
    v_cvt_pk_bf16_f32 v100, v240, v241
    v_cvt_pk_bf16_f32 v101, v242, v243
    v_mfma_f32_16x16x32_bf16 a[152:155], a[96:99], v[80:83], a[152:155]
    ds_read_b128 a[120:123], v2 offset:30720
    ds_read_b128 a[124:127], v2 offset:31744
    v_mfma_f32_16x16x32_bf16 a[152:155], a[100:103], v[84:87], a[152:155]
    v_mfma_f32_16x16x32_bf16 a[156:159], a[96:99], v[88:91], a[156:159]
    v_mfma_f32_16x16x32_bf16 a[156:159], a[100:103], v[92:95], a[156:159]
    v_exp_f32 v244, v244
    v_mfma_f32_16x16x32_bf16 v[248:251], a[64:67], v[136:139], v[152:155]
    v_exp_f32 v245, v245
    v_mfma_f32_16x16x32_bf16 v[248:251], a[68:71], v[168:171], v[248:251]
    v_exp_f32 v246, v246
    v_mfma_f32_16x16x32_bf16 v[248:251], a[72:75], v[200:203], v[248:251]
    v_exp_f32 v247, v247
    v_mfma_f32_16x16x32_bf16 v[248:251], a[76:79], v[232:235], v[248:251]
    v_cvt_pk_bf16_f32 v108, v244, v245
    v_cvt_pk_bf16_f32 v109, v246, v247
    v_mfma_f32_16x16x32_bf16 a[160:163], a[104:107], v[64:67], a[160:163]
    v_mfma_f32_16x16x32_bf16 a[160:163], a[108:111], v[68:71], a[160:163]
    v_mfma_f32_16x16x32_bf16 a[164:167], a[104:107], v[72:75], a[164:167]
    buffer_load_dwordx4 v1, s[36:39], s100 offen offset:2048 lds
    v_mfma_f32_16x16x32_bf16 a[164:167], a[108:111], v[76:79], a[164:167]
    v_mfma_f32_16x16x32_bf16 v[252:255], a[64:67], v[140:143], v[156:159]
    v_exp_f32 v248, v248
    v_mfma_f32_16x16x32_bf16 v[252:255], a[68:71], v[172:175], v[252:255]
    v_exp_f32 v249, v249
    v_mfma_f32_16x16x32_bf16 v[252:255], a[72:75], v[204:207], v[252:255]
    v_exp_f32 v250, v250
    v_mfma_f32_16x16x32_bf16 v[252:255], a[76:79], v[236:239], v[252:255]
    v_exp_f32 v251, v251
    v_mfma_f32_16x16x32_bf16 a[168:171], a[104:107], v[80:83], a[168:171]
    v_cvt_pk_bf16_f32 v116, v248, v249
    v_cvt_pk_bf16_f32 v117, v250, v251
    v_mfma_f32_16x16x32_bf16 a[168:171], a[108:111], v[84:87], a[168:171]
    v_mfma_f32_16x16x32_bf16 a[172:175], a[104:107], v[88:91], a[172:175]
    v_mfma_f32_16x16x32_bf16 a[172:175], a[108:111], v[92:95], a[172:175]
    s_waitcnt lgkmcnt(0)
    v_mfma_f32_16x16x32_bf16 v[240:243], a[80:83], v[128:131], v[188:191]
    v_exp_f32 v252, v252
    v_mfma_f32_16x16x32_bf16 v[240:243], a[84:87], v[160:163], v[240:243]
    v_exp_f32 v253, v253
    v_mfma_f32_16x16x32_bf16 v[240:243], a[88:91], v[192:195], v[240:243]
    v_exp_f32 v254, v254
    v_mfma_f32_16x16x32_bf16 v[240:243], a[92:95], v[224:227], v[240:243]
    v_exp_f32 v255, v255
    v_mfma_f32_16x16x32_bf16 a[176:179], a[112:115], v[64:67], a[176:179]
    buffer_load_dwordx4 v1, s[36:39], s100 offen offset:3072 lds
    v_mfma_f32_16x16x32_bf16 a[176:179], a[116:119], v[68:71], a[176:179]
    v_cvt_pk_bf16_f32 v124, v252, v253
    v_cvt_pk_bf16_f32 v125, v254, v255
    v_mfma_f32_16x16x32_bf16 a[180:183], a[112:115], v[72:75], a[180:183]
    s_cmp_eq_u32 s75, 163840
    s_cselect_b32 s75, 0, s75
    v_add_u32 v2, s75, v1
    v_mfma_f32_16x16x32_bf16 a[180:183], a[116:119], v[76:79], a[180:183]
    v_exp_f32 v240, v240
    v_mfma_f32_16x16x32_bf16 v[244:247], a[80:83], v[132:135], v[148:151]
    v_exp_f32 v241, v241
    v_mfma_f32_16x16x32_bf16 v[244:247], a[84:87], v[164:167], v[244:247]
    v_exp_f32 v242, v242
    v_mfma_f32_16x16x32_bf16 v[244:247], a[88:91], v[196:199], v[244:247]
    v_exp_f32 v243, v243
    v_mfma_f32_16x16x32_bf16 v[244:247], a[92:95], v[228:231], v[244:247]
    v_cvt_pk_bf16_f32 v102, v240, v241
    v_cvt_pk_bf16_f32 v103, v242, v243
    v_mfma_f32_16x16x32_bf16 a[184:187], a[112:115], v[80:83], a[184:187]
    v_mfma_f32_16x16x32_bf16 a[184:187], a[116:119], v[84:87], a[184:187]
    v_mfma_f32_16x16x32_bf16 a[188:191], a[112:115], v[88:91], a[188:191]
    v_mfma_f32_16x16x32_bf16 a[188:191], a[116:119], v[92:95], a[188:191]
    v_mfma_f32_16x16x32_bf16 v[248:251], a[80:83], v[136:139], v[152:155]
    v_mfma_f32_16x16x32_bf16 v[248:251], a[84:87], v[168:171], v[248:251]
    v_exp_f32 v244, v244
    v_mfma_f32_16x16x32_bf16 v[248:251], a[88:91], v[200:203], v[248:251]
    s_add_u32 s77, s77, 32768
    v_exp_f32 v245, v245
    v_mfma_f32_16x16x32_bf16 v[248:251], a[92:95], v[232:235], v[248:251]
    v_exp_f32 v246, v246
    v_mfma_f32_16x16x32_bf16 a[192:195], a[120:123], v[64:67], a[192:195]
    v_exp_f32 v247, v247
    v_mfma_f32_16x16x32_bf16 a[192:195], a[124:127], v[68:71], a[192:195]
    v_cvt_pk_bf16_f32 v110, v244, v245
    v_cvt_pk_bf16_f32 v111, v246, v247
    v_mfma_f32_16x16x32_bf16 a[196:199], a[120:123], v[72:75], a[196:199]
    v_mfma_f32_16x16x32_bf16 a[196:199], a[124:127], v[76:79], a[196:199]
    v_exp_f32 v248, v248
    v_mfma_f32_16x16x32_bf16 v[252:255], a[80:83], v[140:143], v[156:159]
    v_exp_f32 v249, v249
    v_mfma_f32_16x16x32_bf16 v[252:255], a[84:87], v[172:175], v[252:255]
    v_exp_f32 v250, v250
    v_mfma_f32_16x16x32_bf16 v[252:255], a[88:91], v[204:207], v[252:255]
    v_exp_f32 v251, v251
    v_mfma_f32_16x16x32_bf16 v[252:255], a[92:95], v[236:239], v[252:255]
    s_waitcnt vmcnt(16)
    s_barrier
    ds_read_b128 a[64:67], v2 offset:0
    v_mfma_f32_16x16x32_bf16 a[200:203], a[120:123], v[80:83], a[200:203]
    ds_read_b128 a[68:71], v2 offset:1024
    ds_read_b128 a[72:75], v2 offset:2048
    v_mfma_f32_16x16x32_bf16 a[200:203], a[124:127], v[84:87], a[200:203]
    ds_read_b128 a[76:79], v2 offset:3072
    ds_read_b128 a[96:99], v2 offset:16384
    v_mfma_f32_16x16x32_bf16 a[204:207], a[120:123], v[88:91], a[204:207]
    ds_read_b128 a[100:103], v2 offset:17408
    v_cvt_pk_bf16_f32 v118, v248, v249
    v_mfma_f32_16x16x32_bf16 a[204:207], a[124:127], v[92:95], a[204:207]
    v_exp_f32 v252, v252
    v_mfma_f32_16x16x32_bf16 a[208:211], a[224:227], v[64:67], a[208:211]
    v_exp_f32 v253, v253
    v_mfma_f32_16x16x32_bf16 a[208:211], a[224:227], v[68:71], a[208:211]
    v_cvt_pk_bf16_f32 v119, v250, v251
    v_cvt_pk_bf16_f32 v126, v252, v253
    v_mfma_f32_16x16x32_bf16 a[212:215], a[224:227], v[72:75], a[212:215]
    v_mfma_f32_16x16x32_bf16 a[212:215], a[224:227], v[76:79], a[212:215]
    v_mfma_f32_16x16x32_bf16 a[216:219], a[224:227], v[80:83], a[216:219]
    v_mfma_f32_16x16x32_bf16 a[216:219], a[224:227], v[84:87], a[216:219]
    v_mfma_f32_16x16x32_bf16 a[220:223], a[224:227], v[88:91], a[220:223]
    v_mfma_f32_16x16x32_bf16 a[220:223], a[224:227], v[92:95], a[220:223]
    s_cmp_eq_u32 s78, 1
    s_cbranch_scc1 K1_LB_MASK
K1_LB_BACK:
    s_waitcnt lgkmcnt(0)
    v_mfma_f32_16x16x32_bf16 v[240:243], a[64:67], v[128:131], v[176:179]
    s_add_u32 m0, s76, s80
    v_exp_f32 v254, v254
    v_mfma_f32_16x16x32_bf16 v[240:243], a[68:71], v[160:163], v[240:243]
    s_mov_b32 s76, s60
    buffer_load_dwordx4 v1, s[36:39], s77 offen lds
    v_mfma_f32_16x16x32_bf16 v[240:243], a[72:75], v[192:195], v[240:243]
    s_mov_b32 s60, s75
    v_exp_f32 v255, v255
    v_mfma_f32_16x16x32_bf16 v[240:243], a[76:79], v[224:227], v[240:243]
    s_add_u32 s75, s75, 32768
    ds_read_b128 a[104:107], v2 offset:18432
    v_cvt_pk_bf16_f32 v127, v254, v255
    v_mfma_f32_16x16x32_bf16 a[0:3], a[96:99], v[96:99], a[0:3]
    ds_read_b128 a[108:111], v2 offset:19456
    ds_read_b128 a[80:83], v2 offset:4096
    v_mfma_f32_16x16x32_bf16 a[0:3], a[100:103], v[100:103], a[0:3]
    ds_read_b128 a[84:87], v2 offset:5120
    ds_read_b128 a[88:91], v2 offset:6144
    v_mfma_f32_16x16x32_bf16 a[4:7], a[96:99], v[104:107], a[4:7]
    ds_read_b128 a[92:95], v2 offset:7168
    ds_read_b128 a[112:115], v2 offset:20480
    v_mfma_f32_16x16x32_bf16 a[4:7], a[100:103], v[108:111], a[4:7]
    ds_read_b128 a[116:119], v2 offset:21504
    ds_read_b128 a[120:123], v2 offset:22528
    v_mfma_f32_16x16x32_bf16 v[244:247], a[64:67], v[132:135], v[148:151]
    v_exp_f32 v240, v240
    v_mfma_f32_16x16x32_bf16 v[244:247], a[68:71], v[164:167], v[244:247]
    v_exp_f32 v241, v241
    v_mfma_f32_16x16x32_bf16 v[244:247], a[72:75], v[196:199], v[244:247]
    v_exp_f32 v242, v242
    v_mfma_f32_16x16x32_bf16 v[244:247], a[76:79], v[228:231], v[244:247]
    v_exp_f32 v243, v243
    v_mfma_f32_16x16x32_bf16 a[8:11], a[96:99], v[112:115], a[8:11]
    v_cvt_pk_bf16_f32 v64, v240, v241
    v_cvt_pk_bf16_f32 v65, v242, v243
    v_mfma_f32_16x16x32_bf16 a[8:11], a[100:103], v[116:119], a[8:11]
    ds_read_b128 a[124:127], v2 offset:23552
    v_mfma_f32_16x16x32_bf16 a[12:15], a[96:99], v[120:123], a[12:15]
    v_mfma_f32_16x16x32_bf16 a[12:15], a[100:103], v[124:127], a[12:15]
    buffer_load_dwordx4 v1, s[36:39], s77 offen offset:1024 lds
    v_mfma_f32_16x16x32_bf16 v[248:251], a[64:67], v[136:139], v[152:155]
    v_exp_f32 v244, v244
    v_mfma_f32_16x16x32_bf16 v[248:251], a[68:71], v[168:171], v[248:251]
    v_exp_f32 v245, v245
    v_mfma_f32_16x16x32_bf16 v[248:251], a[72:75], v[200:203], v[248:251]
    v_exp_f32 v246, v246
    v_mfma_f32_16x16x32_bf16 v[248:251], a[76:79], v[232:235], v[248:251]
    s_waitcnt lgkmcnt(0)
    v_exp_f32 v247, v247
    v_mfma_f32_16x16x32_bf16 a[16:19], a[104:107], v[96:99], a[16:19]
    v_cvt_pk_bf16_f32 v72, v244, v245
    v_cvt_pk_bf16_f32 v73, v246, v247
    v_mfma_f32_16x16x32_bf16 a[16:19], a[108:111], v[100:103], a[16:19]
    v_mfma_f32_16x16x32_bf16 a[20:23], a[104:107], v[104:107], a[20:23]
    v_mfma_f32_16x16x32_bf16 a[20:23], a[108:111], v[108:111], a[20:23]
    v_mfma_f32_16x16x32_bf16 v[252:255], a[64:67], v[140:143], v[156:159]
    v_exp_f32 v248, v248
    v_mfma_f32_16x16x32_bf16 v[252:255], a[68:71], v[172:175], v[252:255]
    v_exp_f32 v249, v249
    v_mfma_f32_16x16x32_bf16 v[252:255], a[72:75], v[204:207], v[252:255]
    v_exp_f32 v250, v250
    v_mfma_f32_16x16x32_bf16 v[252:255], a[76:79], v[236:239], v[252:255]
    v_exp_f32 v251, v251
    v_mfma_f32_16x16x32_bf16 a[24:27], a[104:107], v[112:115], a[24:27]
    v_cvt_pk_bf16_f32 v80, v248, v249
    v_cvt_pk_bf16_f32 v81, v250, v251
    v_mfma_f32_16x16x32_bf16 a[24:27], a[108:111], v[116:119], a[24:27]
    buffer_load_dwordx4 v1, s[36:39], s77 offen offset:2048 lds
    v_mfma_f32_16x16x32_bf16 a[28:31], a[104:107], v[120:123], a[28:31]
    ds_read_b128 a[64:67], v2 offset:8192
    ds_read_b128 a[68:71], v2 offset:9216
    v_mfma_f32_16x16x32_bf16 a[28:31], a[108:111], v[124:127], a[28:31]
    v_exp_f32 v252, v252
    v_mfma_f32_16x16x32_bf16 v[240:243], a[80:83], v[128:131], v[180:183]
    v_exp_f32 v253, v253
    v_mfma_f32_16x16x32_bf16 v[240:243], a[84:87], v[160:163], v[240:243]
    v_exp_f32 v254, v254
    v_mfma_f32_16x16x32_bf16 v[240:243], a[88:91], v[192:195], v[240:243]
    v_exp_f32 v255, v255
    v_mfma_f32_16x16x32_bf16 v[240:243], a[92:95], v[224:227], v[240:243]
    v_cvt_pk_bf16_f32 v88, v252, v253
    v_cvt_pk_bf16_f32 v89, v254, v255
    v_mfma_f32_16x16x32_bf16 a[32:35], a[112:115], v[96:99], a[32:35]
    ds_read_b128 a[72:75], v2 offset:10240
    ds_read_b128 a[76:79], v2 offset:11264
    v_mfma_f32_16x16x32_bf16 a[32:35], a[116:119], v[100:103], a[32:35]
    ds_read_b128 a[96:99], v2 offset:24576
    ds_read_b128 a[100:103], v2 offset:25600
    v_mfma_f32_16x16x32_bf16 a[36:39], a[112:115], v[104:107], a[36:39]
    v_exp_f32 v240, v240
    v_mfma_f32_16x16x32_bf16 a[36:39], a[116:119], v[108:111], a[36:39]
    v_exp_f32 v241, v241
    v_mfma_f32_16x16x32_bf16 v[244:247], a[80:83], v[132:135], v[148:151]
    v_exp_f32 v242, v242
    v_mfma_f32_16x16x32_bf16 v[244:247], a[84:87], v[164:167], v[244:247]
    v_exp_f32 v243, v243
    v_mfma_f32_16x16x32_bf16 v[244:247], a[88:91], v[196:199], v[244:247]
    v_cvt_pk_bf16_f32 v66, v240, v241
    v_cvt_pk_bf16_f32 v67, v242, v243
    v_mfma_f32_16x16x32_bf16 v[244:247], a[92:95], v[228:231], v[244:247]
    buffer_load_dwordx4 v1, s[36:39], s77 offen offset:3072 lds
    v_mfma_f32_16x16x32_bf16 a[40:43], a[112:115], v[112:115], a[40:43]
    ds_read_b128 a[104:107], v2 offset:26624
    ds_read_b128 a[108:111], v2 offset:27648
    v_mfma_f32_16x16x32_bf16 a[40:43], a[116:119], v[116:119], a[40:43]
    v_mfma_f32_16x16x32_bf16 a[44:47], a[112:115], v[120:123], a[44:47]
    v_mfma_f32_16x16x32_bf16 a[44:47], a[116:119], v[124:127], a[44:47]
    v_mfma_f32_16x16x32_bf16 v[248:251], a[80:83], v[136:139], v[152:155]
    v_exp_f32 v244, v244
    v_mfma_f32_16x16x32_bf16 v[248:251], a[84:87], v[168:171], v[248:251]
    v_exp_f32 v245, v245
    v_mfma_f32_16x16x32_bf16 v[248:251], a[88:91], v[200:203], v[248:251]
    v_exp_f32 v246, v246
    v_mfma_f32_16x16x32_bf16 v[248:251], a[92:95], v[232:235], v[248:251]
    v_exp_f32 v247, v247
    v_mfma_f32_16x16x32_bf16 a[48:51], a[120:123], v[96:99], a[48:51]
    v_cvt_pk_bf16_f32 v74, v244, v245
    v_cvt_pk_bf16_f32 v75, v246, v247
    v_mfma_f32_16x16x32_bf16 a[48:51], a[124:127], v[100:103], a[48:51]
    v_mfma_f32_16x16x32_bf16 a[52:55], a[120:123], v[104:107], a[52:55]
    v_mfma_f32_16x16x32_bf16 a[52:55], a[124:127], v[108:111], a[52:55]
    v_mfma_f32_16x16x32_bf16 v[252:255], a[80:83], v[140:143], v[156:159]
    v_exp_f32 v248, v248
    v_mfma_f32_16x16x32_bf16 v[252:255], a[84:87], v[172:175], v[252:255]
    s_add_u32 s100, s77, 4096
    v_exp_f32 v249, v249
    v_mfma_f32_16x16x32_bf16 v[252:255], a[88:91], v[204:207], v[252:255]
    s_add_u32 m0, m0, 4096
    v_exp_f32 v250, v250
    v_mfma_f32_16x16x32_bf16 v[252:255], a[92:95], v[236:239], v[252:255]
    buffer_load_dwordx4 v1, s[36:39], s100 offen lds
    v_mfma_f32_16x16x32_bf16 a[56:59], a[120:123], v[112:115], a[56:59]
    v_exp_f32 v251, v251
    v_mfma_f32_16x16x32_bf16 a[56:59], a[124:127], v[116:119], a[56:59]
    v_cvt_pk_bf16_f32 v82, v248, v249
    v_cvt_pk_bf16_f32 v83, v250, v251
    v_mfma_f32_16x16x32_bf16 a[60:63], a[120:123], v[120:123], a[60:63]
    ds_read_b128 a[80:83], v2 offset:12288
    ds_read_b128 a[84:87], v2 offset:13312
    v_mfma_f32_16x16x32_bf16 a[60:63], a[124:127], v[124:127], a[60:63]
    s_waitcnt lgkmcnt(2)
    v_exp_f32 v252, v252
    v_mfma_f32_16x16x32_bf16 v[240:243], a[64:67], v[128:131], v[184:187]
    v_exp_f32 v253, v253
    v_mfma_f32_16x16x32_bf16 v[240:243], a[68:71], v[160:163], v[240:243]
    v_exp_f32 v254, v254
    v_mfma_f32_16x16x32_bf16 v[240:243], a[72:75], v[192:195], v[240:243]
    v_exp_f32 v255, v255
    v_mfma_f32_16x16x32_bf16 v[240:243], a[76:79], v[224:227], v[240:243]
    v_cvt_pk_bf16_f32 v90, v252, v253
    v_cvt_pk_bf16_f32 v91, v254, v255
    v_mfma_f32_16x16x32_bf16 a[144:147], a[96:99], v[96:99], a[144:147]
    ds_read_b128 a[88:91], v2 offset:14336
    ds_read_b128 a[92:95], v2 offset:15360
    v_mfma_f32_16x16x32_bf16 a[144:147], a[100:103], v[100:103], a[144:147]
    ds_read_b128 a[112:115], v2 offset:28672
    ds_read_b128 a[116:119], v2 offset:29696
    v_mfma_f32_16x16x32_bf16 a[148:151], a[96:99], v[104:107], a[148:151]
    v_exp_f32 v240, v240
    v_mfma_f32_16x16x32_bf16 a[148:151], a[100:103], v[108:111], a[148:151]
    v_exp_f32 v241, v241
    v_mfma_f32_16x16x32_bf16 v[244:247], a[64:67], v[132:135], v[148:151]
    buffer_load_dwordx4 v1, s[36:39], s100 offen offset:1024 lds
    v_mfma_f32_16x16x32_bf16 v[244:247], a[68:71], v[164:167], v[244:247]
    v_exp_f32 v242, v242
    v_mfma_f32_16x16x32_bf16 v[244:247], a[72:75], v[196:199], v[244:247]
    v_exp_f32 v243, v243
    v_mfma_f32_16x16x32_bf16 v[244:247], a[76:79], v[228:231], v[244:247]
    v_cvt_pk_bf16_f32 v68, v240, v241
    v_cvt_pk_bf16_f32 v69, v242, v243
    v_mfma_f32_16x16x32_bf16 a[152:155], a[96:99], v[112:115], a[152:155]
    ds_read_b128 a[120:123], v2 offset:30720
    ds_read_b128 a[124:127], v2 offset:31744
    v_mfma_f32_16x16x32_bf16 a[152:155], a[100:103], v[116:119], a[152:155]
    v_mfma_f32_16x16x32_bf16 a[156:159], a[96:99], v[120:123], a[156:159]
    v_mfma_f32_16x16x32_bf16 a[156:159], a[100:103], v[124:127], a[156:159]
    v_exp_f32 v244, v244
    v_mfma_f32_16x16x32_bf16 v[248:251], a[64:67], v[136:139], v[152:155]
    v_exp_f32 v245, v245
    v_mfma_f32_16x16x32_bf16 v[248:251], a[68:71], v[168:171], v[248:251]
    v_exp_f32 v246, v246
    v_mfma_f32_16x16x32_bf16 v[248:251], a[72:75], v[200:203], v[248:251]
    v_exp_f32 v247, v247
    v_mfma_f32_16x16x32_bf16 v[248:251], a[76:79], v[232:235], v[248:251]
    v_cvt_pk_bf16_f32 v76, v244, v245
    v_cvt_pk_bf16_f32 v77, v246, v247
    v_mfma_f32_16x16x32_bf16 a[160:163], a[104:107], v[96:99], a[160:163]
    v_mfma_f32_16x16x32_bf16 a[160:163], a[108:111], v[100:103], a[160:163]
    v_mfma_f32_16x16x32_bf16 a[164:167], a[104:107], v[104:107], a[164:167]
    buffer_load_dwordx4 v1, s[36:39], s100 offen offset:2048 lds
    v_mfma_f32_16x16x32_bf16 a[164:167], a[108:111], v[108:111], a[164:167]
    v_mfma_f32_16x16x32_bf16 v[252:255], a[64:67], v[140:143], v[156:159]
    v_exp_f32 v248, v248
    v_mfma_f32_16x16x32_bf16 v[252:255], a[68:71], v[172:175], v[252:255]
    v_exp_f32 v249, v249
    v_mfma_f32_16x16x32_bf16 v[252:255], a[72:75], v[204:207], v[252:255]
    v_exp_f32 v250, v250
    v_mfma_f32_16x16x32_bf16 v[252:255], a[76:79], v[236:239], v[252:255]
    v_exp_f32 v251, v251
    v_mfma_f32_16x16x32_bf16 a[168:171], a[104:107], v[112:115], a[168:171]
    v_cvt_pk_bf16_f32 v84, v248, v249
    v_cvt_pk_bf16_f32 v85, v250, v251
    v_mfma_f32_16x16x32_bf16 a[168:171], a[108:111], v[116:119], a[168:171]
    v_mfma_f32_16x16x32_bf16 a[172:175], a[104:107], v[120:123], a[172:175]
    v_mfma_f32_16x16x32_bf16 a[172:175], a[108:111], v[124:127], a[172:175]
    s_waitcnt lgkmcnt(0)
    v_mfma_f32_16x16x32_bf16 v[240:243], a[80:83], v[128:131], v[188:191]
    v_exp_f32 v252, v252
    v_mfma_f32_16x16x32_bf16 v[240:243], a[84:87], v[160:163], v[240:243]
    v_exp_f32 v253, v253
    v_mfma_f32_16x16x32_bf16 v[240:243], a[88:91], v[192:195], v[240:243]
    v_exp_f32 v254, v254
    v_mfma_f32_16x16x32_bf16 v[240:243], a[92:95], v[224:227], v[240:243]
    v_exp_f32 v255, v255
    v_mfma_f32_16x16x32_bf16 a[176:179], a[112:115], v[96:99], a[176:179]
    buffer_load_dwordx4 v1, s[36:39], s100 offen offset:3072 lds
    v_mfma_f32_16x16x32_bf16 a[176:179], a[116:119], v[100:103], a[176:179]
    v_cvt_pk_bf16_f32 v92, v252, v253
    v_cvt_pk_bf16_f32 v93, v254, v255
    v_mfma_f32_16x16x32_bf16 a[180:183], a[112:115], v[104:107], a[180:183]
    s_cmp_eq_u32 s75, 163840
    s_cselect_b32 s75, 0, s75
    v_add_u32 v2, s75, v1
    v_mfma_f32_16x16x32_bf16 a[180:183], a[116:119], v[108:111], a[180:183]
    v_exp_f32 v240, v240
    v_mfma_f32_16x16x32_bf16 v[244:247], a[80:83], v[132:135], v[148:151]
    v_exp_f32 v241, v241
    v_mfma_f32_16x16x32_bf16 v[244:247], a[84:87], v[164:167], v[244:247]
    v_exp_f32 v242, v242
    v_mfma_f32_16x16x32_bf16 v[244:247], a[88:91], v[196:199], v[244:247]
    v_exp_f32 v243, v243
    v_mfma_f32_16x16x32_bf16 v[244:247], a[92:95], v[228:231], v[244:247]
    v_cvt_pk_bf16_f32 v70, v240, v241
    v_cvt_pk_bf16_f32 v71, v242, v243
    v_mfma_f32_16x16x32_bf16 a[184:187], a[112:115], v[112:115], a[184:187]
    v_mfma_f32_16x16x32_bf16 a[184:187], a[116:119], v[116:119], a[184:187]
    v_mfma_f32_16x16x32_bf16 a[188:191], a[112:115], v[120:123], a[188:191]
    v_mfma_f32_16x16x32_bf16 a[188:191], a[116:119], v[124:127], a[188:191]
    v_mfma_f32_16x16x32_bf16 v[248:251], a[80:83], v[136:139], v[152:155]
    v_mfma_f32_16x16x32_bf16 v[248:251], a[84:87], v[168:171], v[248:251]
    v_exp_f32 v244, v244
    v_mfma_f32_16x16x32_bf16 v[248:251], a[88:91], v[200:203], v[248:251]
    s_add_u32 s77, s77, 32768
    v_exp_f32 v245, v245
    v_mfma_f32_16x16x32_bf16 v[248:251], a[92:95], v[232:235], v[248:251]
    v_exp_f32 v246, v246
    v_mfma_f32_16x16x32_bf16 a[192:195], a[120:123], v[96:99], a[192:195]
    v_exp_f32 v247, v247
    v_mfma_f32_16x16x32_bf16 a[192:195], a[124:127], v[100:103], a[192:195]
    v_cvt_pk_bf16_f32 v78, v244, v245
    v_cvt_pk_bf16_f32 v79, v246, v247
    v_mfma_f32_16x16x32_bf16 a[196:199], a[120:123], v[104:107], a[196:199]
    v_mfma_f32_16x16x32_bf16 a[196:199], a[124:127], v[108:111], a[196:199]
    v_exp_f32 v248, v248
    v_mfma_f32_16x16x32_bf16 v[252:255], a[80:83], v[140:143], v[156:159]
    v_exp_f32 v249, v249
    v_mfma_f32_16x16x32_bf16 v[252:255], a[84:87], v[172:175], v[252:255]
    v_exp_f32 v250, v250
    v_mfma_f32_16x16x32_bf16 v[252:255], a[88:91], v[204:207], v[252:255]
    v_exp_f32 v251, v251
    v_mfma_f32_16x16x32_bf16 v[252:255], a[92:95], v[236:239], v[252:255]
    s_waitcnt vmcnt(16)
    s_barrier
    ds_read_b128 a[64:67], v2 offset:0
    v_mfma_f32_16x16x32_bf16 a[200:203], a[120:123], v[112:115], a[200:203]
    ds_read_b128 a[68:71], v2 offset:1024
    ds_read_b128 a[72:75], v2 offset:2048
    v_mfma_f32_16x16x32_bf16 a[200:203], a[124:127], v[116:119], a[200:203]
    ds_read_b128 a[76:79], v2 offset:3072
    ds_read_b128 a[96:99], v2 offset:16384
    v_mfma_f32_16x16x32_bf16 a[204:207], a[120:123], v[120:123], a[204:207]
    ds_read_b128 a[100:103], v2 offset:17408
    v_cvt_pk_bf16_f32 v86, v248, v249
    v_mfma_f32_16x16x32_bf16 a[204:207], a[124:127], v[124:127], a[204:207]
    v_exp_f32 v252, v252
    v_mfma_f32_16x16x32_bf16 a[208:211], a[224:227], v[96:99], a[208:211]
    v_exp_f32 v253, v253
    v_mfma_f32_16x16x32_bf16 a[208:211], a[224:227], v[100:103], a[208:211]
    v_cvt_pk_bf16_f32 v87, v250, v251
    v_cvt_pk_bf16_f32 v94, v252, v253
    v_mfma_f32_16x16x32_bf16 a[212:215], a[224:227], v[104:107], a[212:215]
    v_mfma_f32_16x16x32_bf16 a[212:215], a[224:227], v[108:111], a[212:215]
    v_mfma_f32_16x16x32_bf16 a[216:219], a[224:227], v[112:115], a[216:219]
    v_mfma_f32_16x16x32_bf16 a[216:219], a[224:227], v[116:119], a[216:219]
    v_mfma_f32_16x16x32_bf16 a[220:223], a[224:227], v[120:123], a[220:223]
    v_mfma_f32_16x16x32_bf16 a[220:223], a[224:227], v[124:127], a[220:223]
    s_sub_u32 s78, s78, 1
    s_cmp_lg_u32 s78, 0
    s_cbranch_scc1 K1_LB
K1_LB_END:
    v_add_f32 v176, v208, v148
    v_add_f32 v177, v209, v148
    v_add_f32 v178, v210, v148
    v_add_f32 v179, v211, v148
    s_nop 1
    s_waitcnt lgkmcnt(0)
    v_mfma_f32_16x16x32_bf16 v[240:243], a[64:67], v[132:135], v[176:179]
    s_add_u32 m0, s76, s80
    ds_read_b128 a[104:107], v2 offset:18432
    ds_read_b128 a[108:111], v2 offset:19456
    v_mfma_f32_16x16x32_bf16 v[240:243], a[68:71], v[164:167], v[240:243]
    s_mov_b32 s76, s60
    buffer_load_dwordx4 v1, s[36:39], s77 offen lds
    v_mfma_f32_16x16x32_bf16 v[240:243], a[72:75], v[196:199], v[240:243]
    s_mov_b32 s60, s75
    v_exp_f32 v254, v254
    v_mfma_f32_16x16x32_bf16 v[240:243], a[76:79], v[228:231], v[240:243]
    s_add_u32 s75, s75, 32768
    v_exp_f32 v255, v255
    v_mfma_f32_16x16x32_bf16 a[0:3], a[96:99], v[64:67], a[0:3]
    v_cvt_pk_bf16_f32 v95, v254, v255
    ds_read_b128 a[80:83], v2 offset:4096
    v_mfma_f32_16x16x32_bf16 a[0:3], a[100:103], v[68:71], a[0:3]
    ds_read_b128 a[84:87], v2 offset:5120
    ds_read_b128 a[88:91], v2 offset:6144
    v_mfma_f32_16x16x32_bf16 a[4:7], a[96:99], v[72:75], a[4:7]
    ds_read_b128 a[92:95], v2 offset:7168
    ds_read_b128 a[112:115], v2 offset:20480
    v_mfma_f32_16x16x32_bf16 a[4:7], a[100:103], v[76:79], a[4:7]
    ds_read_b128 a[116:119], v2 offset:21504
    v_add_f32 v180, v212, v148
    v_mfma_f32_16x16x32_bf16 v[244:247], a[64:67], v[136:139], v[152:155]
    v_add_f32 v181, v213, v148
    v_add_f32 v182, v214, v148
    v_mfma_f32_16x16x32_bf16 v[244:247], a[68:71], v[168:171], v[244:247]
    v_add_f32 v183, v215, v148
    ds_read_b128 a[120:123], v2 offset:22528
    v_mfma_f32_16x16x32_bf16 v[244:247], a[72:75], v[200:203], v[244:247]
    v_exp_f32 v240, v240
    v_mfma_f32_16x16x32_bf16 v[244:247], a[76:79], v[232:235], v[244:247]
    v_exp_f32 v241, v241
    v_mfma_f32_16x16x32_bf16 a[8:11], a[96:99], v[80:83], a[8:11]
    v_exp_f32 v242, v242
    v_mfma_f32_16x16x32_bf16 a[8:11], a[100:103], v[84:87], a[8:11]
    buffer_load_dwordx4 v1, s[36:39], s77 offen offset:1024 lds
    v_mfma_f32_16x16x32_bf16 a[12:15], a[96:99], v[88:91], a[12:15]
    v_exp_f32 v243, v243
    v_mfma_f32_16x16x32_bf16 a[12:15], a[100:103], v[92:95], a[12:15]
    s_waitcnt lgkmcnt(0)
    v_cvt_pk_bf16_f32 v104, v240, v241
    v_cvt_pk_bf16_f32 v105, v242, v243
    v_mfma_f32_16x16x32_bf16 a[16:19], a[104:107], v[64:67], a[16:19]
    ds_read_b128 a[124:127], v2 offset:23552
    v_add_f32 v184, v216, v148
    v_mfma_f32_16x16x32_bf16 a[16:19], a[108:111], v[68:71], a[16:19]
    v_exp_f32 v244, v244
    v_mfma_f32_16x16x32_bf16 v[248:251], a[64:67], v[140:143], v[156:159]
    v_exp_f32 v245, v245
    v_mfma_f32_16x16x32_bf16 v[248:251], a[68:71], v[172:175], v[248:251]
    v_exp_f32 v246, v246
    v_mfma_f32_16x16x32_bf16 v[248:251], a[72:75], v[204:207], v[248:251]
    v_exp_f32 v247, v247
    v_mfma_f32_16x16x32_bf16 v[248:251], a[76:79], v[236:239], v[248:251]
    v_cvt_pk_bf16_f32 v112, v244, v245
    v_cvt_pk_bf16_f32 v113, v246, v247
    v_mfma_f32_16x16x32_bf16 a[20:23], a[104:107], v[72:75], a[20:23]
    ds_read_b128 a[64:67], v2 offset:8192
    ds_read_b128 a[68:71], v2 offset:9216
    v_mfma_f32_16x16x32_bf16 a[20:23], a[108:111], v[76:79], a[20:23]
    ds_read_b128 a[72:75], v2 offset:10240
    ds_read_b128 a[76:79], v2 offset:11264
    v_mfma_f32_16x16x32_bf16 a[24:27], a[104:107], v[80:83], a[24:27]
    ds_read_b128 a[96:99], v2 offset:24576
    ds_read_b128 a[100:103], v2 offset:25600
    v_mfma_f32_16x16x32_bf16 a[24:27], a[108:111], v[84:87], a[24:27]
    buffer_load_dwordx4 v1, s[36:39], s77 offen offset:2048 lds
    v_mfma_f32_16x16x32_bf16 a[28:31], a[104:107], v[88:91], a[28:31]
    v_exp_f32 v248, v248
    v_mfma_f32_16x16x32_bf16 a[28:31], a[108:111], v[92:95], a[28:31]
    v_exp_f32 v249, v249
    v_mfma_f32_16x16x32_bf16 v[252:255], a[80:83], v[132:135], v[180:183]
    v_exp_f32 v250, v250
    v_mfma_f32_16x16x32_bf16 v[252:255], a[84:87], v[164:167], v[252:255]
    v_exp_f32 v251, v251
    v_mfma_f32_16x16x32_bf16 v[252:255], a[88:91], v[196:199], v[252:255]
    v_add_f32 v185, v217, v148
    v_add_f32 v186, v218, v148
    v_mfma_f32_16x16x32_bf16 v[252:255], a[92:95], v[228:231], v[252:255]
    v_add_f32 v187, v219, v148
    v_cvt_pk_bf16_f32 v120, v248, v249
    v_mfma_f32_16x16x32_bf16 a[32:35], a[112:115], v[64:67], a[32:35]
    v_cvt_pk_bf16_f32 v121, v250, v251
    ds_read_b128 a[104:107], v2 offset:26624
    v_mfma_f32_16x16x32_bf16 a[32:35], a[116:119], v[68:71], a[32:35]
    ds_read_b128 a[108:111], v2 offset:27648
    v_add_f32 v188, v220, v148
    v_mfma_f32_16x16x32_bf16 a[36:39], a[112:115], v[72:75], a[36:39]
    v_exp_f32 v252, v252
    v_mfma_f32_16x16x32_bf16 a[36:39], a[116:119], v[76:79], a[36:39]
    v_exp_f32 v253, v253
    v_mfma_f32_16x16x32_bf16 v[240:243], a[80:83], v[136:139], v[152:155]
    v_exp_f32 v254, v254
    v_mfma_f32_16x16x32_bf16 v[240:243], a[84:87], v[168:171], v[240:243]
    buffer_load_dwordx4 v1, s[36:39], s77 offen offset:3072 lds
    v_mfma_f32_16x16x32_bf16 v[240:243], a[88:91], v[200:203], v[240:243]
    v_exp_f32 v255, v255
    v_mfma_f32_16x16x32_bf16 v[240:243], a[92:95], v[232:235], v[240:243]
    v_cvt_pk_bf16_f32 v106, v252, v253
    v_cvt_pk_bf16_f32 v107, v254, v255
    v_mfma_f32_16x16x32_bf16 a[40:43], a[112:115], v[80:83], a[40:43]
    v_add_f32 v189, v221, v148
    v_add_f32 v190, v222, v148
    v_mfma_f32_16x16x32_bf16 a[40:43], a[116:119], v[84:87], a[40:43]
    v_add_f32 v191, v223, v148
    v_mfma_f32_16x16x32_bf16 a[44:47], a[112:115], v[88:91], a[44:47]
    v_exp_f32 v240, v240
    v_mfma_f32_16x16x32_bf16 a[44:47], a[116:119], v[92:95], a[44:47]
    v_exp_f32 v241, v241
    v_mfma_f32_16x16x32_bf16 a[48:51], a[120:123], v[64:67], a[48:51]
    s_waitcnt lgkmcnt(0)
    v_exp_f32 v242, v242
    v_mfma_f32_16x16x32_bf16 a[48:51], a[124:127], v[68:71], a[48:51]
    v_exp_f32 v243, v243
    v_mfma_f32_16x16x32_bf16 v[244:247], a[80:83], v[140:143], v[156:159]
    v_cvt_pk_bf16_f32 v114, v240, v241
    v_cvt_pk_bf16_f32 v115, v242, v243
    v_mfma_f32_16x16x32_bf16 v[244:247], a[84:87], v[172:175], v[244:247]
    ds_read_b128 a[80:83], v2 offset:12288
    ds_read_b128 a[84:87], v2 offset:13312
    v_mfma_f32_16x16x32_bf16 v[244:247], a[88:91], v[204:207], v[244:247]
    ds_read_b128 a[88:91], v2 offset:14336
    v_mfma_f32_16x16x32_bf16 v[244:247], a[92:95], v[236:239], v[244:247]
    s_add_u32 s100, s77, 4096
    ds_read_b128 a[92:95], v2 offset:15360
    ds_read_b128 a[112:115], v2 offset:28672
    v_mfma_f32_16x16x32_bf16 a[52:55], a[120:123], v[72:75], a[52:55]
    s_add_u32 m0, m0, 4096
    ds_read_b128 a[116:119], v2 offset:29696
    v_mfma_f32_16x16x32_bf16 a[52:55], a[124:127], v[76:79], a[52:55]
    buffer_load_dwordx4 v1, s[36:39], s100 offen lds
    v_mfma_f32_16x16x32_bf16 a[56:59], a[120:123], v[80:83], a[56:59]
    v_exp_f32 v244, v244
    v_mfma_f32_16x16x32_bf16 a[56:59], a[124:127], v[84:87], a[56:59]
    v_exp_f32 v245, v245
    v_mfma_f32_16x16x32_bf16 a[60:63], a[120:123], v[88:91], a[60:63]
    v_exp_f32 v246, v246
    v_mfma_f32_16x16x32_bf16 a[60:63], a[124:127], v[92:95], a[60:63]
    v_exp_f32 v247, v247
    v_mfma_f32_16x16x32_bf16 v[248:251], a[64:67], v[132:135], v[184:187]
    v_cvt_pk_bf16_f32 v122, v244, v245
    v_cvt_pk_bf16_f32 v123, v246, v247
    v_mfma_f32_16x16x32_bf16 v[248:251], a[68:71], v[164:167], v[248:251]
    ds_read_b128 a[120:123], v2 offset:30720
    ds_read_b128 a[124:127], v2 offset:31744
    v_mfma_f32_16x16x32_bf16 v[248:251], a[72:75], v[196:199], v[248:251]
    s_cmp_eq_u32 s75, 163840
    s_cselect_b32 s75, 0, s75
    v_add_u32 v2, s75, v1
    v_mfma_f32_16x16x32_bf16 v[248:251], a[76:79], v[228:231], v[248:251]
    v_mfma_f32_16x16x32_bf16 a[144:147], a[96:99], v[64:67], a[144:147]
    v_mfma_f32_16x16x32_bf16 a[144:147], a[100:103], v[68:71], a[144:147]
    v_mfma_f32_16x16x32_bf16 a[148:151], a[96:99], v[72:75], a[148:151]
    buffer_load_dwordx4 v1, s[36:39], s100 offen offset:1024 lds
    v_mfma_f32_16x16x32_bf16 a[148:151], a[100:103], v[76:79], a[148:151]
    v_mfma_f32_16x16x32_bf16 v[252:255], a[64:67], v[136:139], v[152:155]
    v_mfma_f32_16x16x32_bf16 v[252:255], a[68:71], v[168:171], v[252:255]
    v_mfma_f32_16x16x32_bf16 v[252:255], a[72:75], v[200:203], v[252:255]
    v_exp_f32 v248, v248
    v_mfma_f32_16x16x32_bf16 v[252:255], a[76:79], v[232:235], v[252:255]
    v_exp_f32 v249, v249
    v_mfma_f32_16x16x32_bf16 a[152:155], a[96:99], v[80:83], a[152:155]
    v_exp_f32 v250, v250
    v_mfma_f32_16x16x32_bf16 a[152:155], a[100:103], v[84:87], a[152:155]
    v_exp_f32 v251, v251
    v_mfma_f32_16x16x32_bf16 a[156:159], a[96:99], v[88:91], a[156:159]
    v_cvt_pk_bf16_f32 v108, v248, v249
    v_cvt_pk_bf16_f32 v109, v250, v251
    v_mfma_f32_16x16x32_bf16 a[156:159], a[100:103], v[92:95], a[156:159]
    v_exp_f32 v252, v252
    v_mfma_f32_16x16x32_bf16 a[160:163], a[104:107], v[64:67], a[160:163]
    v_exp_f32 v253, v253
    v_mfma_f32_16x16x32_bf16 a[160:163], a[108:111], v[68:71], a[160:163]
    v_exp_f32 v254, v254
    v_mfma_f32_16x16x32_bf16 v[240:243], a[64:67], v[140:143], v[156:159]
    buffer_load_dwordx4 v1, s[36:39], s100 offen offset:2048 lds
    v_mfma_f32_16x16x32_bf16 v[240:243], a[68:71], v[172:175], v[240:243]
    v_exp_f32 v255, v255
    v_mfma_f32_16x16x32_bf16 v[240:243], a[72:75], v[204:207], v[240:243]
    v_cvt_pk_bf16_f32 v116, v252, v253
    v_cvt_pk_bf16_f32 v117, v254, v255
    v_mfma_f32_16x16x32_bf16 v[240:243], a[76:79], v[236:239], v[240:243]
    v_mfma_f32_16x16x32_bf16 a[164:167], a[104:107], v[72:75], a[164:167]
    v_mfma_f32_16x16x32_bf16 a[164:167], a[108:111], v[76:79], a[164:167]
    v_mfma_f32_16x16x32_bf16 a[168:171], a[104:107], v[80:83], a[168:171]
    v_mfma_f32_16x16x32_bf16 a[168:171], a[108:111], v[84:87], a[168:171]
    v_mfma_f32_16x16x32_bf16 a[172:175], a[104:107], v[88:91], a[172:175]
    v_mfma_f32_16x16x32_bf16 a[172:175], a[108:111], v[92:95], a[172:175]
    s_waitcnt lgkmcnt(0)
    v_mfma_f32_16x16x32_bf16 v[244:247], a[80:83], v[132:135], v[188:191]
    v_mfma_f32_16x16x32_bf16 v[244:247], a[84:87], v[164:167], v[244:247]
    v_exp_f32 v240, v240
    v_mfma_f32_16x16x32_bf16 v[244:247], a[88:91], v[196:199], v[244:247]
    buffer_load_dwordx4 v1, s[36:39], s100 offen offset:3072 lds
    v_mfma_f32_16x16x32_bf16 v[244:247], a[92:95], v[228:231], v[244:247]
    v_exp_f32 v241, v241
    v_mfma_f32_16x16x32_bf16 a[176:179], a[112:115], v[64:67], a[176:179]
    v_exp_f32 v242, v242
    v_mfma_f32_16x16x32_bf16 a[176:179], a[116:119], v[68:71], a[176:179]
    v_exp_f32 v243, v243
    v_mfma_f32_16x16x32_bf16 a[180:183], a[112:115], v[72:75], a[180:183]
    v_cvt_pk_bf16_f32 v124, v240, v241
    v_cvt_pk_bf16_f32 v125, v242, v243
    v_mfma_f32_16x16x32_bf16 a[180:183], a[116:119], v[76:79], a[180:183]
    v_exp_f32 v244, v244
    v_mfma_f32_16x16x32_bf16 v[248:251], a[80:83], v[136:139], v[152:155]
    v_exp_f32 v245, v245
    v_mfma_f32_16x16x32_bf16 v[248:251], a[84:87], v[168:171], v[248:251]
    v_exp_f32 v246, v246
    v_mfma_f32_16x16x32_bf16 v[248:251], a[88:91], v[200:203], v[248:251]
    v_exp_f32 v247, v247
    v_mfma_f32_16x16x32_bf16 v[248:251], a[92:95], v[232:235], v[248:251]
    v_cvt_pk_bf16_f32 v110, v244, v245
    v_cvt_pk_bf16_f32 v111, v246, v247
    v_mfma_f32_16x16x32_bf16 a[184:187], a[112:115], v[80:83], a[184:187]
    v_mfma_f32_16x16x32_bf16 a[184:187], a[116:119], v[84:87], a[184:187]
    v_mfma_f32_16x16x32_bf16 a[188:191], a[112:115], v[88:91], a[188:191]
    s_add_u32 s77, s77, 32768
    v_mfma_f32_16x16x32_bf16 a[188:191], a[116:119], v[92:95], a[188:191]
    v_mfma_f32_16x16x32_bf16 a[192:195], a[120:123], v[64:67], a[192:195]
    v_exp_f32 v248, v248
    v_mfma_f32_16x16x32_bf16 a[192:195], a[124:127], v[68:71], a[192:195]
    v_exp_f32 v249, v249
    v_mfma_f32_16x16x32_bf16 v[252:255], a[80:83], v[140:143], v[156:159]
    v_exp_f32 v250, v250
    v_mfma_f32_16x16x32_bf16 v[252:255], a[84:87], v[172:175], v[252:255]
    v_exp_f32 v251, v251
    v_mfma_f32_16x16x32_bf16 v[252:255], a[88:91], v[204:207], v[252:255]
    v_cvt_pk_bf16_f32 v118, v248, v249
    v_cvt_pk_bf16_f32 v119, v250, v251
    v_mfma_f32_16x16x32_bf16 v[252:255], a[92:95], v[236:239], v[252:255]
    v_mfma_f32_16x16x32_bf16 a[196:199], a[120:123], v[72:75], a[196:199]
    v_mfma_f32_16x16x32_bf16 a[196:199], a[124:127], v[76:79], a[196:199]
    s_waitcnt vmcnt(16)
    s_barrier
    ds_read_b128 a[64:67], v2 offset:0
    v_mfma_f32_16x16x32_bf16 a[200:203], a[120:123], v[80:83], a[200:203]
    ds_read_b128 a[68:71], v2 offset:1024
    ds_read_b128 a[72:75], v2 offset:2048
    v_mfma_f32_16x16x32_bf16 a[200:203], a[124:127], v[84:87], a[200:203]
    ds_read_b128 a[76:79], v2 offset:3072
    ds_read_b128 a[96:99], v2 offset:16384
    v_mfma_f32_16x16x32_bf16 a[204:207], a[120:123], v[88:91], a[204:207]
    ds_read_b128 a[100:103], v2 offset:17408
    v_mfma_f32_16x16x32_bf16 a[204:207], a[124:127], v[92:95], a[204:207]
    v_exp_f32 v252, v252
    v_mfma_f32_16x16x32_bf16 a[208:211], a[224:227], v[64:67], a[208:211]
    v_exp_f32 v253, v253
    v_mfma_f32_16x16x32_bf16 a[208:211], a[224:227], v[68:71], a[208:211]
    v_cvt_pk_bf16_f32 v126, v252, v253
    v_mfma_f32_16x16x32_bf16 a[212:215], a[224:227], v[72:75], a[212:215]
    v_mfma_f32_16x16x32_bf16 a[212:215], a[224:227], v[76:79], a[212:215]
    v_mfma_f32_16x16x32_bf16 a[216:219], a[224:227], v[80:83], a[216:219]
    v_mfma_f32_16x16x32_bf16 a[216:219], a[224:227], v[84:87], a[216:219]
    v_mfma_f32_16x16x32_bf16 a[220:223], a[224:227], v[88:91], a[220:223]
    v_mfma_f32_16x16x32_bf16 a[220:223], a[224:227], v[92:95], a[220:223]
    s_cmp_eq_u32 s6, 7
    s_cselect_b32 s79, 1.0, 0
    v_fma_f32 v176, v208, s79, v152
    v_fma_f32 v177, v209, s79, v152
    v_fma_f32 v178, v210, s79, v152
    v_fma_f32 v179, v211, s79, v152
    s_nop 1
    s_waitcnt lgkmcnt(0)
    v_mfma_f32_16x16x32_bf16 v[240:243], a[64:67], v[136:139], v[176:179]
    s_add_u32 m0, s76, s80
    v_exp_f32 v254, v254
    v_mfma_f32_16x16x32_bf16 v[240:243], a[68:71], v[168:171], v[240:243]
    s_mov_b32 s76, s60
    buffer_load_dwordx4 v1, s[36:39], s77 offen lds
    v_mfma_f32_16x16x32_bf16 v[240:243], a[72:75], v[200:203], v[240:243]
    s_mov_b32 s60, s75
    v_exp_f32 v255, v255
    v_mfma_f32_16x16x32_bf16 v[240:243], a[76:79], v[232:235], v[240:243]
    s_add_u32 s75, s75, 32768
    ds_read_b128 a[104:107], v2 offset:18432
    v_cvt_pk_bf16_f32 v127, v254, v255
    v_mfma_f32_16x16x32_bf16 a[4:7], a[96:99], v[104:107], a[4:7]
    ds_read_b128 a[108:111], v2 offset:19456
    ds_read_b128 a[80:83], v2 offset:4096
    v_mfma_f32_16x16x32_bf16 a[4:7], a[100:103], v[108:111], a[4:7]
    ds_read_b128 a[84:87], v2 offset:5120
    ds_read_b128 a[88:91], v2 offset:6144
    v_mfma_f32_16x16x32_bf16 a[8:11], a[96:99], v[112:115], a[8:11]
    ds_read_b128 a[92:95], v2 offset:7168
    ds_read_b128 a[112:115], v2 offset:20480
    v_mfma_f32_16x16x32_bf16 a[8:11], a[100:103], v[116:119], a[8:11]
    ds_read_b128 a[116:119], v2 offset:21504
    v_fma_f32 v180, v212, s79, v152
    v_mfma_f32_16x16x32_bf16 a[12:15], a[96:99], v[120:123], a[12:15]
    v_fma_f32 v181, v213, s79, v152
    v_fma_f32 v182, v214, s79, v152
    v_mfma_f32_16x16x32_bf16 a[12:15], a[100:103], v[124:127], a[12:15]
    buffer_load_dwordx4 v1, s[36:39], s77 offen offset:1024 lds
    v_mfma_f32_16x16x32_bf16 v[244:247], a[64:67], v[140:143], v[156:159]
    v_fma_f32 v183, v215, s79, v152
    ds_read_b128 a[120:123], v2 offset:22528
    v_mfma_f32_16x16x32_bf16 v[244:247], a[68:71], v[172:175], v[244:247]
    ds_read_b128 a[124:127], v2 offset:23552
    ds_read_b128 a[64:67], v2 offset:8192
    v_mfma_f32_16x16x32_bf16 v[244:247], a[72:75], v[204:207], v[244:247]
    ds_read_b128 a[68:71], v2 offset:9216
    ds_read_b128 a[72:75], v2 offset:10240
    v_mfma_f32_16x16x32_bf16 v[244:247], a[76:79], v[236:239], v[244:247]
    s_waitcnt lgkmcnt(5)
    ds_read_b128 a[76:79], v2 offset:11264
    ds_read_b128 a[96:99], v2 offset:24576
    v_mfma_f32_16x16x32_bf16 a[20:23], a[104:107], v[104:107], a[20:23]
    ds_read_b128 a[100:103], v2 offset:25600
    v_fma_f32 v184, v216, s79, v152
    v_mfma_f32_16x16x32_bf16 a[20:23], a[108:111], v[108:111], a[20:23]
    v_exp_f32 v240, v240
    v_mfma_f32_16x16x32_bf16 a[24:27], a[104:107], v[112:115], a[24:27]
    v_exp_f32 v241, v241
    v_mfma_f32_16x16x32_bf16 a[24:27], a[108:111], v[116:119], a[24:27]
    buffer_load_dwordx4 v1, s[36:39], s77 offen offset:2048 lds
    v_mfma_f32_16x16x32_bf16 a[28:31], a[104:107], v[120:123], a[28:31]
    v_exp_f32 v242, v242
    v_mfma_f32_16x16x32_bf16 a[28:31], a[108:111], v[124:127], a[28:31]
    v_exp_f32 v243, v243
    v_mfma_f32_16x16x32_bf16 v[248:251], a[80:83], v[136:139], v[180:183]
    v_fma_f32 v185, v217, s79, v152
    v_fma_f32 v186, v218, s79, v152
    v_mfma_f32_16x16x32_bf16 v[248:251], a[84:87], v[168:171], v[248:251]
    v_fma_f32 v187, v219, s79, v152
    v_cvt_pk_bf16_f32 v80, v240, v241
    v_mfma_f32_16x16x32_bf16 v[248:251], a[88:91], v[200:203], v[248:251]
    v_cvt_pk_bf16_f32 v81, v242, v243
    ds_read_b128 a[104:107], v2 offset:26624
    v_mfma_f32_16x16x32_bf16 v[248:251], a[92:95], v[232:235], v[248:251]
    ds_read_b128 a[108:111], v2 offset:27648
    v_fma_f32 v188, v220, s79, v152
    v_mfma_f32_16x16x32_bf16 a[36:39], a[112:115], v[104:107], a[36:39]
    v_exp_f32 v244, v244
    v_mfma_f32_16x16x32_bf16 a[36:39], a[116:119], v[108:111], a[36:39]
    buffer_load_dwordx4 v1, s[36:39], s77 offen offset:3072 lds
    v_mfma_f32_16x16x32_bf16 a[40:43], a[112:115], v[112:115], a[40:43]
    v_exp_f32 v245, v245
    v_mfma_f32_16x16x32_bf16 a[40:43], a[116:119], v[116:119], a[40:43]
    v_exp_f32 v246, v246
    v_mfma_f32_16x16x32_bf16 a[44:47], a[112:115], v[120:123], a[44:47]
    v_exp_f32 v247, v247
    v_mfma_f32_16x16x32_bf16 a[44:47], a[116:119], v[124:127], a[44:47]
    v_cvt_pk_bf16_f32 v88, v244, v245
    v_cvt_pk_bf16_f32 v89, v246, v247
    v_mfma_f32_16x16x32_bf16 v[252:255], a[80:83], v[140:143], v[156:159]
    ds_read_b128 a[80:83], v2 offset:12288
    v_fma_f32 v189, v221, s79, v152
    v_mfma_f32_16x16x32_bf16 v[252:255], a[84:87], v[172:175], v[252:255]
    ds_read_b128 a[84:87], v2 offset:13312
    v_fma_f32 v190, v222, s79, v152
    v_mfma_f32_16x16x32_bf16 v[252:255], a[88:91], v[204:207], v[252:255]
    s_add_u32 s100, s77, 4096
    ds_read_b128 a[88:91], v2 offset:14336
    v_fma_f32 v191, v223, s79, v152
    v_mfma_f32_16x16x32_bf16 v[252:255], a[92:95], v[236:239], v[252:255]
    s_add_u32 m0, m0, 4096
    ds_read_b128 a[92:95], v2 offset:15360
    ds_read_b128 a[112:115], v2 offset:28672
    s_waitcnt lgkmcnt(5)
    v_mfma_f32_16x16x32_bf16 a[52:55], a[120:123], v[104:107], a[52:55]
    buffer_load_dwordx4 v1, s[36:39], s100 offen lds
    v_mfma_f32_16x16x32_bf16 a[52:55], a[124:127], v[108:111], a[52:55]
    ds_read_b128 a[116:119], v2 offset:29696
    v_mfma_f32_16x16x32_bf16 a[56:59], a[120:123], v[112:115], a[56:59]
    v_exp_f32 v248, v248
    v_mfma_f32_16x16x32_bf16 a[56:59], a[124:127], v[116:119], a[56:59]
    v_exp_f32 v249, v249
    v_mfma_f32_16x16x32_bf16 a[60:63], a[120:123], v[120:123], a[60:63]
    v_exp_f32 v250, v250
    v_mfma_f32_16x16x32_bf16 a[60:63], a[124:127], v[124:127], a[60:63]
    v_exp_f32 v251, v251
    v_mfma_f32_16x16x32_bf16 v[240:243], a[64:67], v[136:139], v[184:187]
    v_cvt_pk_bf16_f32 v82, v248, v249
    v_cvt_pk_bf16_f32 v83, v250, v251
    v_mfma_f32_16x16x32_bf16 v[240:243], a[68:71], v[168:171], v[240:243]
    buffer_load_dwordx4 v1, s[36:39], s100 offen offset:1024 lds
    v_mfma_f32_16x16x32_bf16 v[240:243], a[72:75], v[200:203], v[240:243]
    ds_read_b128 a[120:123], v2 offset:30720
    ds_read_b128 a[124:127], v2 offset:31744
    v_mfma_f32_16x16x32_bf16 v[240:243], a[76:79], v[232:235], v[240:243]
    v_exp_f32 v252, v252
    v_mfma_f32_16x16x32_bf16 a[148:151], a[96:99], v[104:107], a[148:151]
    v_exp_f32 v253, v253
    v_mfma_f32_16x16x32_bf16 a[148:151], a[100:103], v[108:111], a[148:151]
    v_exp_f32 v254, v254
    v_mfma_f32_16x16x32_bf16 a[152:155], a[96:99], v[112:115], a[152:155]
    v_exp_f32 v255, v255
    v_mfma_f32_16x16x32_bf16 a[152:155], a[100:103], v[116:119], a[152:155]
    v_cvt_pk_bf16_f32 v90, v252, v253
    v_cvt_pk_bf16_f32 v91, v254, v255
    v_mfma_f32_16x16x32_bf16 a[156:159], a[96:99], v[120:123], a[156:159]
    s_cmp_eq_u32 s75, 163840
    s_cselect_b32 s75, 0, s75
    v_add_u32 v2, s75, v1
    v_mfma_f32_16x16x32_bf16 a[156:159], a[100:103], v[124:127], a[156:159]
    buffer_load_dwordx4 v1, s[36:39], s100 offen offset:2048 lds
    v_mfma_f32_16x16x32_bf16 v[244:247], a[64:67], v[140:143], v[156:159]
    v_exp_f32 v240, v240
    v_mfma_f32_16x16x32_bf16 v[244:247], a[68:71], v[172:175], v[244:247]
    v_exp_f32 v241, v241
    v_mfma_f32_16x16x32_bf16 v[244:247], a[72:75], v[204:207], v[244:247]
    v_exp_f32 v242, v242
    v_mfma_f32_16x16x32_bf16 v[244:247], a[76:79], v[236:239], v[244:247]
    v_exp_f32 v243, v243
    v_mfma_f32_16x16x32_bf16 a[164:167], a[104:107], v[104:107], a[164:167]
    v_cvt_pk_bf16_f32 v84, v240, v241
    v_cvt_pk_bf16_f32 v85, v242, v243
    v_mfma_f32_16x16x32_bf16 a[164:167], a[108:111], v[108:111], a[164:167]
    v_mfma_f32_16x16x32_bf16 a[168:171], a[104:107], v[112:115], a[168:171]
    v_mfma_f32_16x16x32_bf16 a[168:171], a[108:111], v[116:119], a[168:171]
    buffer_load_dwordx4 v1, s[36:39], s100 offen offset:3072 lds
    v_mfma_f32_16x16x32_bf16 a[172:175], a[104:107], v[120:123], a[172:175]
    v_exp_f32 v244, v244
    v_mfma_f32_16x16x32_bf16 a[172:175], a[108:111], v[124:127], a[172:175]
    s_waitcnt lgkmcnt(0)
    v_exp_f32 v245, v245
    v_mfma_f32_16x16x32_bf16 v[248:251], a[80:83], v[136:139], v[188:191]
    v_exp_f32 v246, v246
    v_mfma_f32_16x16x32_bf16 v[248:251], a[84:87], v[168:171], v[248:251]
    v_exp_f32 v247, v247
    v_mfma_f32_16x16x32_bf16 v[248:251], a[88:91], v[200:203], v[248:251]
    v_cvt_pk_bf16_f32 v92, v244, v245
    v_cvt_pk_bf16_f32 v93, v246, v247
    v_mfma_f32_16x16x32_bf16 v[248:251], a[92:95], v[232:235], v[248:251]
    v_mfma_f32_16x16x32_bf16 a[180:183], a[112:115], v[104:107], a[180:183]
    s_add_u32 s77, s77, 32768
    v_mfma_f32_16x16x32_bf16 a[180:183], a[116:119], v[108:111], a[180:183]
    v_mfma_f32_16x16x32_bf16 a[184:187], a[112:115], v[112:115], a[184:187]
    v_mfma_f32_16x16x32_bf16 a[184:187], a[116:119], v[116:119], a[184:187]
    v_mfma_f32_16x16x32_bf16 a[188:191], a[112:115], v[120:123], a[188:191]
    v_mfma_f32_16x16x32_bf16 a[188:191], a[116:119], v[124:127], a[188:191]
    v_mfma_f32_16x16x32_bf16 v[252:255], a[80:83], v[140:143], v[156:159]
    v_exp_f32 v248, v248
    v_mfma_f32_16x16x32_bf16 v[252:255], a[84:87], v[172:175], v[252:255]
    v_exp_f32 v249, v249
    v_mfma_f32_16x16x32_bf16 v[252:255], a[88:91], v[204:207], v[252:255]
    v_exp_f32 v250, v250
    v_mfma_f32_16x16x32_bf16 v[252:255], a[92:95], v[236:239], v[252:255]
    s_waitcnt vmcnt(16)
    s_barrier
    ds_read_b128 a[64:67], v2 offset:0
    v_mfma_f32_16x16x32_bf16 a[196:199], a[120:123], v[104:107], a[196:199]
    ds_read_b128 a[68:71], v2 offset:1024
    ds_read_b128 a[72:75], v2 offset:2048
    v_mfma_f32_16x16x32_bf16 a[196:199], a[124:127], v[108:111], a[196:199]
    ds_read_b128 a[76:79], v2 offset:3072
    ds_read_b128 a[96:99], v2 offset:16384
    v_mfma_f32_16x16x32_bf16 a[200:203], a[120:123], v[112:115], a[200:203]
    ds_read_b128 a[100:103], v2 offset:17408
    v_cvt_pk_bf16_f32 v86, v248, v249
    v_mfma_f32_16x16x32_bf16 a[200:203], a[124:127], v[116:119], a[200:203]
    v_exp_f32 v251, v251
    v_mfma_f32_16x16x32_bf16 a[204:207], a[120:123], v[120:123], a[204:207]
    v_exp_f32 v252, v252
    v_mfma_f32_16x16x32_bf16 a[204:207], a[124:127], v[124:127], a[204:207]
    v_exp_f32 v253, v253
    v_mfma_f32_16x16x32_bf16 a[212:215], a[224:227], v[104:107], a[212:215]
    v_cvt_pk_bf16_f32 v87, v250, v251
    v_cvt_pk_bf16_f32 v94, v252, v253
    v_mfma_f32_16x16x32_bf16 a[212:215], a[224:227], v[108:111], a[212:215]
    v_mfma_f32_16x16x32_bf16 a[216:219], a[224:227], v[112:115], a[216:219]
    v_mfma_f32_16x16x32_bf16 a[216:219], a[224:227], v[116:119], a[216:219]
    v_mfma_f32_16x16x32_bf16 a[220:223], a[224:227], v[120:123], a[220:223]
    v_mfma_f32_16x16x32_bf16 a[220:223], a[224:227], v[124:127], a[220:223]
    s_nop 7
    v_accvgpr_read_b32 v8, a208
    v_cmp_nge_f32 vcc, s101, v8
    v_rcp_f32 v10, v8
    s_nop 0
    s_or_b64 s[84:85], s[84:85], vcc
    v_mul_f32 v10, v10, v4
    v_accvgpr_read_b32 v12, a0
    v_accvgpr_read_b32 v13, a1
    v_accvgpr_read_b32 v14, a2
    v_accvgpr_read_b32 v15, a3
    v_accvgpr_read_b32 v16, a16
    v_accvgpr_read_b32 v17, a17
    v_accvgpr_read_b32 v18, a18
    v_accvgpr_read_b32 v19, a19
    v_pk_mul_f32 v[12:13], v[12:13], v[10:11] op_sel_hi:[1,0]
    v_pk_mul_f32 v[14:15], v[14:15], v[10:11] op_sel_hi:[1,0]
    v_pk_mul_f32 v[16:17], v[16:17], v[10:11] op_sel_hi:[1,0]
    v_pk_mul_f32 v[18:19], v[18:19], v[10:11] op_sel_hi:[1,0]
    v_cvt_pk_bf16_f32 v12, v12, v13
    v_cvt_pk_bf16_f32 v13, v14, v15
    v_cvt_pk_bf16_f32 v14, v16, v17
    v_cvt_pk_bf16_f32 v15, v18, v19
    buffer_store_dwordx4 v[12:15], v1, s[40:43], s81 offen offset:0
    v_accvgpr_read_b32 v20, a32
    v_accvgpr_read_b32 v21, a33
    v_accvgpr_read_b32 v22, a34
    v_accvgpr_read_b32 v23, a35
    v_accvgpr_read_b32 v24, a48
    v_accvgpr_read_b32 v25, a49
    v_accvgpr_read_b32 v26, a50
    v_accvgpr_read_b32 v27, a51
    v_pk_mul_f32 v[20:21], v[20:21], v[10:11] op_sel_hi:[1,0]
    v_pk_mul_f32 v[22:23], v[22:23], v[10:11] op_sel_hi:[1,0]
    v_pk_mul_f32 v[24:25], v[24:25], v[10:11] op_sel_hi:[1,0]
    v_pk_mul_f32 v[26:27], v[26:27], v[10:11] op_sel_hi:[1,0]
    v_cvt_pk_bf16_f32 v20, v20, v21
    v_cvt_pk_bf16_f32 v21, v22, v23
    v_cvt_pk_bf16_f32 v22, v24, v25
    v_cvt_pk_bf16_f32 v23, v26, v27
    buffer_store_dwordx4 v[20:23], v1, s[40:43], s81 offen offset:1024
    v_accvgpr_read_b32 v12, a144
    v_accvgpr_read_b32 v13, a145
    v_accvgpr_read_b32 v14, a146
    v_accvgpr_read_b32 v15, a147
    v_accvgpr_read_b32 v16, a160
    v_accvgpr_read_b32 v17, a161
    v_accvgpr_read_b32 v18, a162
    v_accvgpr_read_b32 v19, a163
    v_pk_mul_f32 v[12:13], v[12:13], v[10:11] op_sel_hi:[1,0]
    v_pk_mul_f32 v[14:15], v[14:15], v[10:11] op_sel_hi:[1,0]
    v_pk_mul_f32 v[16:17], v[16:17], v[10:11] op_sel_hi:[1,0]
    v_pk_mul_f32 v[18:19], v[18:19], v[10:11] op_sel_hi:[1,0]
    v_cvt_pk_bf16_f32 v12, v12, v13
    v_cvt_pk_bf16_f32 v13, v14, v15
    v_cvt_pk_bf16_f32 v14, v16, v17
    v_cvt_pk_bf16_f32 v15, v18, v19
    buffer_store_dwordx4 v[12:15], v1, s[40:43], s81 offen offset:2048
    v_accvgpr_read_b32 v20, a176
    v_accvgpr_read_b32 v21, a177
    v_accvgpr_read_b32 v22, a178
    v_accvgpr_read_b32 v23, a179
    v_accvgpr_read_b32 v24, a192
    v_accvgpr_read_b32 v25, a193
    v_accvgpr_read_b32 v26, a194
    v_accvgpr_read_b32 v27, a195
    v_pk_mul_f32 v[20:21], v[20:21], v[10:11] op_sel_hi:[1,0]
    v_pk_mul_f32 v[22:23], v[22:23], v[10:11] op_sel_hi:[1,0]
    v_pk_mul_f32 v[24:25], v[24:25], v[10:11] op_sel_hi:[1,0]
    v_pk_mul_f32 v[26:27], v[26:27], v[10:11] op_sel_hi:[1,0]
    v_cvt_pk_bf16_f32 v20, v20, v21
    v_cvt_pk_bf16_f32 v21, v22, v23
    v_cvt_pk_bf16_f32 v22, v24, v25
    v_cvt_pk_bf16_f32 v23, v26, v27
    buffer_store_dwordx4 v[20:23], v1, s[40:43], s81 offen offset:3072
    v_accvgpr_read_b32 v8, a212
    v_cmp_nge_f32 vcc, s101, v8
    v_rcp_f32 v10, v8
    s_nop 0
    s_or_b64 s[84:85], s[84:85], vcc
    v_mul_f32 v10, v10, v5
    s_add_u32 s72, s81, 598016
    v_accvgpr_read_b32 v12, a4
    v_accvgpr_read_b32 v13, a5
    v_accvgpr_read_b32 v14, a6
    v_accvgpr_read_b32 v15, a7
    v_accvgpr_read_b32 v16, a20
    v_accvgpr_read_b32 v17, a21
    v_accvgpr_read_b32 v18, a22
    v_accvgpr_read_b32 v19, a23
    v_pk_mul_f32 v[12:13], v[12:13], v[10:11] op_sel_hi:[1,0]
    v_pk_mul_f32 v[14:15], v[14:15], v[10:11] op_sel_hi:[1,0]
    v_pk_mul_f32 v[16:17], v[16:17], v[10:11] op_sel_hi:[1,0]
    v_pk_mul_f32 v[18:19], v[18:19], v[10:11] op_sel_hi:[1,0]
    v_cvt_pk_bf16_f32 v12, v12, v13
    v_cvt_pk_bf16_f32 v13, v14, v15
    v_cvt_pk_bf16_f32 v14, v16, v17
    v_cvt_pk_bf16_f32 v15, v18, v19
    buffer_store_dwordx4 v[12:15], v1, s[40:43], s72 offen offset:0
    v_accvgpr_read_b32 v20, a36
    v_accvgpr_read_b32 v21, a37
    v_accvgpr_read_b32 v22, a38
    v_accvgpr_read_b32 v23, a39
    v_accvgpr_read_b32 v24, a52
    v_accvgpr_read_b32 v25, a53
    v_accvgpr_read_b32 v26, a54
    v_accvgpr_read_b32 v27, a55
    v_pk_mul_f32 v[20:21], v[20:21], v[10:11] op_sel_hi:[1,0]
    v_pk_mul_f32 v[22:23], v[22:23], v[10:11] op_sel_hi:[1,0]
    v_pk_mul_f32 v[24:25], v[24:25], v[10:11] op_sel_hi:[1,0]
    v_pk_mul_f32 v[26:27], v[26:27], v[10:11] op_sel_hi:[1,0]
    v_cvt_pk_bf16_f32 v20, v20, v21
    v_cvt_pk_bf16_f32 v21, v22, v23
    v_cvt_pk_bf16_f32 v22, v24, v25
    v_cvt_pk_bf16_f32 v23, v26, v27
    buffer_store_dwordx4 v[20:23], v1, s[40:43], s72 offen offset:1024
    v_accvgpr_read_b32 v12, a148
    v_accvgpr_read_b32 v13, a149
    v_accvgpr_read_b32 v14, a150
    v_accvgpr_read_b32 v15, a151
    v_accvgpr_read_b32 v16, a164
    v_accvgpr_read_b32 v17, a165
    v_accvgpr_read_b32 v18, a166
    v_accvgpr_read_b32 v19, a167
    v_pk_mul_f32 v[12:13], v[12:13], v[10:11] op_sel_hi:[1,0]
    v_pk_mul_f32 v[14:15], v[14:15], v[10:11] op_sel_hi:[1,0]
    v_pk_mul_f32 v[16:17], v[16:17], v[10:11] op_sel_hi:[1,0]
    v_pk_mul_f32 v[18:19], v[18:19], v[10:11] op_sel_hi:[1,0]
    v_cvt_pk_bf16_f32 v12, v12, v13
    v_cvt_pk_bf16_f32 v13, v14, v15
    v_cvt_pk_bf16_f32 v14, v16, v17
    v_cvt_pk_bf16_f32 v15, v18, v19
    buffer_store_dwordx4 v[12:15], v1, s[40:43], s72 offen offset:2048
    v_accvgpr_read_b32 v20, a180
    v_accvgpr_read_b32 v21, a181
    v_accvgpr_read_b32 v22, a182
    v_accvgpr_read_b32 v23, a183
    v_accvgpr_read_b32 v24, a196
    v_accvgpr_read_b32 v25, a197
    v_accvgpr_read_b32 v26, a198
    v_accvgpr_read_b32 v27, a199
    v_pk_mul_f32 v[20:21], v[20:21], v[10:11] op_sel_hi:[1,0]
    v_pk_mul_f32 v[22:23], v[22:23], v[10:11] op_sel_hi:[1,0]
    v_pk_mul_f32 v[24:25], v[24:25], v[10:11] op_sel_hi:[1,0]
    v_pk_mul_f32 v[26:27], v[26:27], v[10:11] op_sel_hi:[1,0]
    v_cvt_pk_bf16_f32 v20, v20, v21
    v_cvt_pk_bf16_f32 v21, v22, v23
    v_cvt_pk_bf16_f32 v22, v24, v25
    v_cvt_pk_bf16_f32 v23, v26, v27
    buffer_store_dwordx4 v[20:23], v1, s[40:43], s72 offen offset:3072
    s_sub_u32 s78, 14, s6
    s_sub_u32 s78, s78, s6
    s_cmp_eq_u32 s78, 0
    s_cbranch_scc1 K1_LS_END
.p2align 3
K1_LS:
    s_waitcnt lgkmcnt(0)
    v_mfma_f32_16x16x32_bf16 v[240:243], a[64:67], v[136:139], v[176:179]
    s_add_u32 m0, s76, s80
    v_exp_f32 v254, v254
    v_mfma_f32_16x16x32_bf16 v[240:243], a[68:71], v[168:171], v[240:243]
    s_mov_b32 s76, s60
    v_exp_f32 v255, v255
    v_mfma_f32_16x16x32_bf16 v[240:243], a[72:75], v[200:203], v[240:243]
    s_mov_b32 s60, s75
    buffer_load_dwordx4 v1, s[36:39], s77 offen lds
    v_mfma_f32_16x16x32_bf16 v[240:243], a[76:79], v[232:235], v[240:243]
    s_add_u32 s75, s75, 32768
    ds_read_b128 a[104:107], v2 offset:18432
    v_cvt_pk_bf16_f32 v95, v254, v255
    v_mfma_f32_16x16x32_bf16 a[8:11], a[96:99], v[80:83], a[8:11]
    ds_read_b128 a[108:111], v2 offset:19456
    ds_read_b128 a[80:83], v2 offset:4096
    v_mfma_f32_16x16x32_bf16 a[8:11], a[100:103], v[84:87], a[8:11]
    ds_read_b128 a[84:87], v2 offset:5120
    ds_read_b128 a[88:91], v2 offset:6144
    v_mfma_f32_16x16x32_bf16 a[12:15], a[96:99], v[88:91], a[12:15]
    buffer_load_dwordx4 v1, s[36:39], s77 offen offset:1024 lds
    v_mfma_f32_16x16x32_bf16 a[12:15], a[100:103], v[92:95], a[12:15]
    ds_read_b128 a[92:95], v2 offset:7168
    ds_read_b128 a[112:115], v2 offset:20480
    v_mfma_f32_16x16x32_bf16 v[244:247], a[64:67], v[140:143], v[156:159]
    ds_read_b128 a[116:119], v2 offset:21504
    ds_read_b128 a[120:123], v2 offset:22528
    v_mfma_f32_16x16x32_bf16 v[244:247], a[68:71], v[172:175], v[244:247]
    ds_read_b128 a[124:127], v2 offset:23552
    ds_read_b128 a[64:67], v2 offset:8192
    v_mfma_f32_16x16x32_bf16 v[244:247], a[72:75], v[204:207], v[244:247]
    ds_read_b128 a[68:71], v2 offset:9216
    ds_read_b128 a[72:75], v2 offset:10240
    v_mfma_f32_16x16x32_bf16 v[244:247], a[76:79], v[236:239], v[244:247]
    s_waitcnt lgkmcnt(8)
    ds_read_b128 a[76:79], v2 offset:11264
    ds_read_b128 a[96:99], v2 offset:24576
    v_mfma_f32_16x16x32_bf16 a[24:27], a[104:107], v[80:83], a[24:27]
    buffer_load_dwordx4 v1, s[36:39], s77 offen offset:2048 lds
    v_mfma_f32_16x16x32_bf16 a[24:27], a[108:111], v[84:87], a[24:27]
    ds_read_b128 a[100:103], v2 offset:25600
    v_mfma_f32_16x16x32_bf16 a[28:31], a[104:107], v[88:91], a[28:31]
    v_exp_f32 v240, v240
    v_mfma_f32_16x16x32_bf16 a[28:31], a[108:111], v[92:95], a[28:31]
    v_exp_f32 v241, v241
    v_mfma_f32_16x16x32_bf16 v[248:251], a[80:83], v[136:139], v[180:183]
    v_exp_f32 v242, v242
    v_mfma_f32_16x16x32_bf16 v[248:251], a[84:87], v[168:171], v[248:251]
    v_exp_f32 v243, v243
    v_mfma_f32_16x16x32_bf16 v[248:251], a[88:91], v[200:203], v[248:251]
    s_waitcnt lgkmcnt(0)
    buffer_load_dwordx4 v1, s[36:39], s77 offen offset:3072 lds
    v_mfma_f32_16x16x32_bf16 v[248:251], a[92:95], v[232:235], v[248:251]
    v_cvt_pk_bf16_f32 v112, v240, v241
    v_cvt_pk_bf16_f32 v113, v242, v243
    v_mfma_f32_16x16x32_bf16 a[40:43], a[112:115], v[80:83], a[40:43]
    ds_read_b128 a[104:107], v2 offset:26624
    ds_read_b128 a[108:111], v2 offset:27648
    v_mfma_f32_16x16x32_bf16 a[40:43], a[116:119], v[84:87], a[40:43]
    v_exp_f32 v244, v244
    v_mfma_f32_16x16x32_bf16 a[44:47], a[112:115], v[88:91], a[44:47]
    v_exp_f32 v245, v245
    v_mfma_f32_16x16x32_bf16 a[44:47], a[116:119], v[92:95], a[44:47]
    s_add_u32 s100, s77, 4096
    v_exp_f32 v246, v246
    v_mfma_f32_16x16x32_bf16 v[252:255], a[80:83], v[140:143], v[156:159]
    s_add_u32 m0, m0, 4096
    v_exp_f32 v247, v247
    v_mfma_f32_16x16x32_bf16 v[252:255], a[84:87], v[172:175], v[252:255]
    buffer_load_dwordx4 v1, s[36:39], s100 offen lds
    v_mfma_f32_16x16x32_bf16 v[252:255], a[88:91], v[204:207], v[252:255]
    v_cvt_pk_bf16_f32 v120, v244, v245
    v_cvt_pk_bf16_f32 v121, v246, v247
    v_mfma_f32_16x16x32_bf16 v[252:255], a[92:95], v[236:239], v[252:255]
    ds_read_b128 a[80:83], v2 offset:12288
    ds_read_b128 a[84:87], v2 offset:13312
    v_mfma_f32_16x16x32_bf16 a[56:59], a[120:123], v[80:83], a[56:59]
    ds_read_b128 a[88:91], v2 offset:14336
    ds_read_b128 a[92:95], v2 offset:15360
    v_mfma_f32_16x16x32_bf16 a[56:59], a[124:127], v[84:87], a[56:59]
    buffer_load_dwordx4 v1, s[36:39], s100 offen offset:1024 lds
    v_mfma_f32_16x16x32_bf16 a[60:63], a[120:123], v[88:91], a[60:63]
    ds_read_b128 a[112:115], v2 offset:28672
    ds_read_b128 a[116:119], v2 offset:29696
    v_mfma_f32_16x16x32_bf16 a[60:63], a[124:127], v[92:95], a[60:63]
    v_exp_f32 v248, v248
    v_mfma_f32_16x16x32_bf16 v[240:243], a[64:67], v[136:139], v[184:187]
    v_exp_f32 v249, v249
    v_mfma_f32_16x16x32_bf16 v[240:243], a[68:71], v[168:171], v[240:243]
    v_exp_f32 v250, v250
    v_mfma_f32_16x16x32_bf16 v[240:243], a[72:75], v[200:203], v[240:243]
    v_exp_f32 v251, v251
    v_mfma_f32_16x16x32_bf16 v[240:243], a[76:79], v[232:235], v[240:243]
    buffer_load_dwordx4 v1, s[36:39], s100 offen offset:2048 lds
    v_mfma_f32_16x16x32_bf16 a[152:155], a[96:99], v[80:83], a[152:155]
    v_cvt_pk_bf16_f32 v114, v248, v249
    v_cvt_pk_bf16_f32 v115, v250, v251
    v_mfma_f32_16x16x32_bf16 a[152:155], a[100:103], v[84:87], a[152:155]
    ds_read_b128 a[120:123], v2 offset:30720
    ds_read_b128 a[124:127], v2 offset:31744
    v_mfma_f32_16x16x32_bf16 a[156:159], a[96:99], v[88:91], a[156:159]
    v_exp_f32 v252, v252
    v_mfma_f32_16x16x32_bf16 a[156:159], a[100:103], v[92:95], a[156:159]
    v_exp_f32 v253, v253
    v_mfma_f32_16x16x32_bf16 v[244:247], a[64:67], v[140:143], v[156:159]
    v_exp_f32 v254, v254
    v_mfma_f32_16x16x32_bf16 v[244:247], a[68:71], v[172:175], v[244:247]
    buffer_load_dwordx4 v1, s[36:39], s100 offen offset:3072 lds
    v_mfma_f32_16x16x32_bf16 v[244:247], a[72:75], v[204:207], v[244:247]
    v_exp_f32 v255, v255
    v_mfma_f32_16x16x32_bf16 v[244:247], a[76:79], v[236:239], v[244:247]
    s_cmp_eq_u32 s75, 163840
    s_cselect_b32 s75, 0, s75
    v_cvt_pk_bf16_f32 v122, v252, v253
    s_waitcnt lgkmcnt(0)
    v_mfma_f32_16x16x32_bf16 a[168:171], a[104:107], v[80:83], a[168:171]
    v_cvt_pk_bf16_f32 v123, v254, v255
    v_add_u32 v2, s75, v1
    v_mfma_f32_16x16x32_bf16 a[168:171], a[108:111], v[84:87], a[168:171]
    v_exp_f32 v240, v240
    v_mfma_f32_16x16x32_bf16 a[172:175], a[104:107], v[88:91], a[172:175]
    s_add_u32 s77, s77, 32768
    v_exp_f32 v241, v241
    v_mfma_f32_16x16x32_bf16 a[172:175], a[108:111], v[92:95], a[172:175]
    v_exp_f32 v242, v242
    v_mfma_f32_16x16x32_bf16 v[248:251], a[80:83], v[136:139], v[188:191]
    v_exp_f32 v243, v243
    v_mfma_f32_16x16x32_bf16 v[248:251], a[84:87], v[168:171], v[248:251]
    v_exp_f32 v244, v244
    v_mfma_f32_16x16x32_bf16 v[248:251], a[88:91], v[200:203], v[248:251]
    v_exp_f32 v245, v245
    v_mfma_f32_16x16x32_bf16 v[248:251], a[92:95], v[232:235], v[248:251]
    v_exp_f32 v246, v246
    v_mfma_f32_16x16x32_bf16 a[184:187], a[112:115], v[80:83], a[184:187]
    v_exp_f32 v247, v247
    v_mfma_f32_16x16x32_bf16 a[184:187], a[116:119], v[84:87], a[184:187]
    v_cvt_pk_bf16_f32 v116, v240, v241
    v_cvt_pk_bf16_f32 v117, v242, v243
    v_mfma_f32_16x16x32_bf16 a[188:191], a[112:115], v[88:91], a[188:191]
    v_cvt_pk_bf16_f32 v124, v244, v245
    v_cvt_pk_bf16_f32 v125, v246, v247
    v_mfma_f32_16x16x32_bf16 a[188:191], a[116:119], v[92:95], a[188:191]
    s_waitcnt vmcnt(16)
    s_barrier
    ds_read_b128 a[64:67], v2 offset:0
    v_mfma_f32_16x16x32_bf16 v[252:255], a[80:83], v[140:143], v[156:159]
    ds_read_b128 a[68:71], v2 offset:1024
    ds_read_b128 a[72:75], v2 offset:2048
    v_mfma_f32_16x16x32_bf16 v[252:255], a[84:87], v[172:175], v[252:255]
    ds_read_b128 a[76:79], v2 offset:3072
    ds_read_b128 a[96:99], v2 offset:16384
    v_mfma_f32_16x16x32_bf16 v[252:255], a[88:91], v[204:207], v[252:255]
    ds_read_b128 a[100:103], v2 offset:17408
    v_mfma_f32_16x16x32_bf16 v[252:255], a[92:95], v[236:239], v[252:255]
    v_exp_f32 v248, v248
    v_mfma_f32_16x16x32_bf16 a[200:203], a[120:123], v[80:83], a[200:203]
    v_exp_f32 v249, v249
    v_mfma_f32_16x16x32_bf16 a[200:203], a[124:127], v[84:87], a[200:203]
    v_exp_f32 v250, v250
    v_mfma_f32_16x16x32_bf16 a[204:207], a[120:123], v[88:91], a[204:207]
    v_exp_f32 v251, v251
    v_mfma_f32_16x16x32_bf16 a[204:207], a[124:127], v[92:95], a[204:207]
    v_exp_f32 v252, v252
    v_mfma_f32_16x16x32_bf16 a[216:219], a[224:227], v[80:83], a[216:219]
    v_exp_f32 v253, v253
    v_mfma_f32_16x16x32_bf16 a[216:219], a[224:227], v[84:87], a[216:219]
    v_cvt_pk_bf16_f32 v118, v248, v249
    v_cvt_pk_bf16_f32 v119, v250, v251
    v_mfma_f32_16x16x32_bf16 a[220:223], a[224:227], v[88:91], a[220:223]
    v_cvt_pk_bf16_f32 v126, v252, v253
    v_mfma_f32_16x16x32_bf16 a[220:223], a[224:227], v[92:95], a[220:223]
    s_cmp_eq_u32 s78, 1
    s_cbranch_scc1 K1_LS_MASK
K1_LS_BACK:
    s_waitcnt lgkmcnt(0)
    v_mfma_f32_16x16x32_bf16 v[240:243], a[64:67], v[136:139], v[176:179]
    s_add_u32 m0, s76, s80
    v_exp_f32 v254, v254
    v_mfma_f32_16x16x32_bf16 v[240:243], a[68:71], v[168:171], v[240:243]
    s_mov_b32 s76, s60
    v_exp_f32 v255, v255
    v_mfma_f32_16x16x32_bf16 v[240:243], a[72:75], v[200:203], v[240:243]
    s_mov_b32 s60, s75
    buffer_load_dwordx4 v1, s[36:39], s77 offen lds
    v_mfma_f32_16x16x32_bf16 v[240:243], a[76:79], v[232:235], v[240:243]
    s_add_u32 s75, s75, 32768
    ds_read_b128 a[104:107], v2 offset:18432
    v_cvt_pk_bf16_f32 v127, v254, v255
    v_mfma_f32_16x16x32_bf16 a[8:11], a[96:99], v[112:115], a[8:11]
    ds_read_b128 a[108:111], v2 offset:19456
    ds_read_b128 a[80:83], v2 offset:4096
    v_mfma_f32_16x16x32_bf16 a[8:11], a[100:103], v[116:119], a[8:11]
    ds_read_b128 a[84:87], v2 offset:5120
    ds_read_b128 a[88:91], v2 offset:6144
    v_mfma_f32_16x16x32_bf16 a[12:15], a[96:99], v[120:123], a[12:15]
    buffer_load_dwordx4 v1, s[36:39], s77 offen offset:1024 lds
    v_mfma_f32_16x16x32_bf16 a[12:15], a[100:103], v[124:127], a[12:15]
    ds_read_b128 a[92:95], v2 offset:7168
    ds_read_b128 a[112:115], v2 offset:20480
    v_mfma_f32_16x16x32_bf16 v[244:247], a[64:67], v[140:143], v[156:159]
    ds_read_b128 a[116:119], v2 offset:21504
    ds_read_b128 a[120:123], v2 offset:22528
    v_mfma_f32_16x16x32_bf16 v[244:247], a[68:71], v[172:175], v[244:247]
    ds_read_b128 a[124:127], v2 offset:23552
    ds_read_b128 a[64:67], v2 offset:8192
    v_mfma_f32_16x16x32_bf16 v[244:247], a[72:75], v[204:207], v[244:247]
    ds_read_b128 a[68:71], v2 offset:9216
    ds_read_b128 a[72:75], v2 offset:10240
    v_mfma_f32_16x16x32_bf16 v[244:247], a[76:79], v[236:239], v[244:247]
    s_waitcnt lgkmcnt(8)
    ds_read_b128 a[76:79], v2 offset:11264
    ds_read_b128 a[96:99], v2 offset:24576
    v_mfma_f32_16x16x32_bf16 a[24:27], a[104:107], v[112:115], a[24:27]
    buffer_load_dwordx4 v1, s[36:39], s77 offen offset:2048 lds
    v_mfma_f32_16x16x32_bf16 a[24:27], a[108:111], v[116:119], a[24:27]
    ds_read_b128 a[100:103], v2 offset:25600
    v_mfma_f32_16x16x32_bf16 a[28:31], a[104:107], v[120:123], a[28:31]
    v_exp_f32 v240, v240
    v_mfma_f32_16x16x32_bf16 a[28:31], a[108:111], v[124:127], a[28:31]
    v_exp_f32 v241, v241
    v_mfma_f32_16x16x32_bf16 v[248:251], a[80:83], v[136:139], v[180:183]
    v_exp_f32 v242, v242
    v_mfma_f32_16x16x32_bf16 v[248:251], a[84:87], v[168:171], v[248:251]
    v_exp_f32 v243, v243
    v_mfma_f32_16x16x32_bf16 v[248:251], a[88:91], v[200:203], v[248:251]
    s_waitcnt lgkmcnt(0)
    buffer_load_dwordx4 v1, s[36:39], s77 offen offset:3072 lds
    v_mfma_f32_16x16x32_bf16 v[248:251], a[92:95], v[232:235], v[248:251]
    v_cvt_pk_bf16_f32 v80, v240, v241
    v_cvt_pk_bf16_f32 v81, v242, v243
    v_mfma_f32_16x16x32_bf16 a[40:43], a[112:115], v[112:115], a[40:43]
    ds_read_b128 a[104:107], v2 offset:26624
    ds_read_b128 a[108:111], v2 offset:27648
    v_mfma_f32_16x16x32_bf16 a[40:43], a[116:119], v[116:119], a[40:43]
    v_exp_f32 v244, v244
    v_mfma_f32_16x16x32_bf16 a[44:47], a[112:115], v[120:123], a[44:47]
    v_exp_f32 v245, v245
    v_mfma_f32_16x16x32_bf16 a[44:47], a[116:119], v[124:127], a[44:47]
    s_add_u32 s100, s77, 4096
    v_exp_f32 v246, v246
    v_mfma_f32_16x16x32_bf16 v[252:255], a[80:83], v[140:143], v[156:159]
    s_add_u32 m0, m0, 4096
    v_exp_f32 v247, v247
    v_mfma_f32_16x16x32_bf16 v[252:255], a[84:87], v[172:175], v[252:255]
    buffer_load_dwordx4 v1, s[36:39], s100 offen lds
    v_mfma_f32_16x16x32_bf16 v[252:255], a[88:91], v[204:207], v[252:255]
    v_cvt_pk_bf16_f32 v88, v244, v245
    v_cvt_pk_bf16_f32 v89, v246, v247
    v_mfma_f32_16x16x32_bf16 v[252:255], a[92:95], v[236:239], v[252:255]
    ds_read_b128 a[80:83], v2 offset:12288
    ds_read_b128 a[84:87], v2 offset:13312
    v_mfma_f32_16x16x32_bf16 a[56:59], a[120:123], v[112:115], a[56:59]
    ds_read_b128 a[88:91], v2 offset:14336
    ds_read_b128 a[92:95], v2 offset:15360
    v_mfma_f32_16x16x32_bf16 a[56:59], a[124:127], v[116:119], a[56:59]
    buffer_load_dwordx4 v1, s[36:39], s100 offen offset:1024 lds
    v_mfma_f32_16x16x32_bf16 a[60:63], a[120:123], v[120:123], a[60:63]
    ds_read_b128 a[112:115], v2 offset:28672
    ds_read_b128 a[116:119], v2 offset:29696
    v_mfma_f32_16x16x32_bf16 a[60:63], a[124:127], v[124:127], a[60:63]
    v_exp_f32 v248, v248
    v_mfma_f32_16x16x32_bf16 v[240:243], a[64:67], v[136:139], v[184:187]
    v_exp_f32 v249, v249
    v_mfma_f32_16x16x32_bf16 v[240:243], a[68:71], v[168:171], v[240:243]
    v_exp_f32 v250, v250
    v_mfma_f32_16x16x32_bf16 v[240:243], a[72:75], v[200:203], v[240:243]
    v_exp_f32 v251, v251
    v_mfma_f32_16x16x32_bf16 v[240:243], a[76:79], v[232:235], v[240:243]
    buffer_load_dwordx4 v1, s[36:39], s100 offen offset:2048 lds
    v_mfma_f32_16x16x32_bf16 a[152:155], a[96:99], v[112:115], a[152:155]
    v_cvt_pk_bf16_f32 v82, v248, v249
    v_cvt_pk_bf16_f32 v83, v250, v251
    v_mfma_f32_16x16x32_bf16 a[152:155], a[100:103], v[116:119], a[152:155]
    ds_read_b128 a[120:123], v2 offset:30720
    ds_read_b128 a[124:127], v2 offset:31744
    v_mfma_f32_16x16x32_bf16 a[156:159], a[96:99], v[120:123], a[156:159]
    v_exp_f32 v252, v252
    v_mfma_f32_16x16x32_bf16 a[156:159], a[100:103], v[124:127], a[156:159]
    v_exp_f32 v253, v253
    v_mfma_f32_16x16x32_bf16 v[244:247], a[64:67], v[140:143], v[156:159]
    v_exp_f32 v254, v254
    v_mfma_f32_16x16x32_bf16 v[244:247], a[68:71], v[172:175], v[244:247]
    buffer_load_dwordx4 v1, s[36:39], s100 offen offset:3072 lds
    v_mfma_f32_16x16x32_bf16 v[244:247], a[72:75], v[204:207], v[244:247]
    v_exp_f32 v255, v255
    v_mfma_f32_16x16x32_bf16 v[244:247], a[76:79], v[236:239], v[244:247]
    s_cmp_eq_u32 s75, 163840
    s_cselect_b32 s75, 0, s75
    v_cvt_pk_bf16_f32 v90, v252, v253
    s_waitcnt lgkmcnt(0)
    v_mfma_f32_16x16x32_bf16 a[168:171], a[104:107], v[112:115], a[168:171]
    v_cvt_pk_bf16_f32 v91, v254, v255
    v_add_u32 v2, s75, v1
    v_mfma_f32_16x16x32_bf16 a[168:171], a[108:111], v[116:119], a[168:171]
    v_exp_f32 v240, v240
    v_mfma_f32_16x16x32_bf16 a[172:175], a[104:107], v[120:123], a[172:175]
    s_add_u32 s77, s77, 32768
    v_exp_f32 v241, v241
    v_mfma_f32_16x16x32_bf16 a[172:175], a[108:111], v[124:127], a[172:175]
    v_exp_f32 v242, v242
    v_mfma_f32_16x16x32_bf16 v[248:251], a[80:83], v[136:139], v[188:191]
    v_exp_f32 v243, v243
    v_mfma_f32_16x16x32_bf16 v[248:251], a[84:87], v[168:171], v[248:251]
    v_exp_f32 v244, v244
    v_mfma_f32_16x16x32_bf16 v[248:251], a[88:91], v[200:203], v[248:251]
    v_exp_f32 v245, v245
    v_mfma_f32_16x16x32_bf16 v[248:251], a[92:95], v[232:235], v[248:251]
    v_exp_f32 v246, v246
    v_mfma_f32_16x16x32_bf16 a[184:187], a[112:115], v[112:115], a[184:187]
    v_exp_f32 v247, v247
    v_mfma_f32_16x16x32_bf16 a[184:187], a[116:119], v[116:119], a[184:187]
    v_cvt_pk_bf16_f32 v84, v240, v241
    v_cvt_pk_bf16_f32 v85, v242, v243
    v_mfma_f32_16x16x32_bf16 a[188:191], a[112:115], v[120:123], a[188:191]
    v_cvt_pk_bf16_f32 v92, v244, v245
    v_cvt_pk_bf16_f32 v93, v246, v247
    v_mfma_f32_16x16x32_bf16 a[188:191], a[116:119], v[124:127], a[188:191]
    s_waitcnt vmcnt(16)
    s_barrier
    ds_read_b128 a[64:67], v2 offset:0
    v_mfma_f32_16x16x32_bf16 v[252:255], a[80:83], v[140:143], v[156:159]
    ds_read_b128 a[68:71], v2 offset:1024
    ds_read_b128 a[72:75], v2 offset:2048
    v_mfma_f32_16x16x32_bf16 v[252:255], a[84:87], v[172:175], v[252:255]
    ds_read_b128 a[76:79], v2 offset:3072
    ds_read_b128 a[96:99], v2 offset:16384
    v_mfma_f32_16x16x32_bf16 v[252:255], a[88:91], v[204:207], v[252:255]
    ds_read_b128 a[100:103], v2 offset:17408
    v_mfma_f32_16x16x32_bf16 v[252:255], a[92:95], v[236:239], v[252:255]
    v_exp_f32 v248, v248
    v_mfma_f32_16x16x32_bf16 a[200:203], a[120:123], v[112:115], a[200:203]
    v_exp_f32 v249, v249
    v_mfma_f32_16x16x32_bf16 a[200:203], a[124:127], v[116:119], a[200:203]
    v_exp_f32 v250, v250
    v_mfma_f32_16x16x32_bf16 a[204:207], a[120:123], v[120:123], a[204:207]
    v_exp_f32 v251, v251
    v_mfma_f32_16x16x32_bf16 a[204:207], a[124:127], v[124:127], a[204:207]
    v_exp_f32 v252, v252
    v_mfma_f32_16x16x32_bf16 a[216:219], a[224:227], v[112:115], a[216:219]
    v_exp_f32 v253, v253
    v_mfma_f32_16x16x32_bf16 a[216:219], a[224:227], v[116:119], a[216:219]
    v_cvt_pk_bf16_f32 v86, v248, v249
    v_cvt_pk_bf16_f32 v87, v250, v251
    v_mfma_f32_16x16x32_bf16 a[220:223], a[224:227], v[120:123], a[220:223]
    v_cvt_pk_bf16_f32 v94, v252, v253
    v_mfma_f32_16x16x32_bf16 a[220:223], a[224:227], v[124:127], a[220:223]
    s_sub_u32 s78, s78, 1
    s_cmp_lg_u32 s78, 0
    s_cbranch_scc1 K1_LS
K1_LS_END:
    v_add_f32 v176, v208, v156
    v_add_f32 v177, v209, v156
    v_add_f32 v178, v210, v156
    v_add_f32 v179, v211, v156
    s_nop 1
    s_waitcnt lgkmcnt(0)
    v_mfma_f32_16x16x32_bf16 v[240:243], a[64:67], v[140:143], v[176:179]
    s_add_u32 m0, s76, s80
    ds_read_b128 a[104:107], v2 offset:18432
    ds_read_b128 a[108:111], v2 offset:19456
    v_mfma_f32_16x16x32_bf16 v[240:243], a[68:71], v[172:175], v[240:243]
    s_mov_b32 s76, s60
    v_exp_f32 v254, v254
    v_mfma_f32_16x16x32_bf16 v[240:243], a[72:75], v[204:207], v[240:243]
    s_mov_b32 s60, s75
    v_exp_f32 v255, v255
    v_mfma_f32_16x16x32_bf16 v[240:243], a[76:79], v[236:239], v[240:243]
    s_add_u32 s75, s75, 32768
    buffer_load_dwordx4 v1, s[36:39], s77 offen lds
    v_mfma_f32_16x16x32_bf16 a[8:11], a[96:99], v[80:83], a[8:11]
    ds_read_b128 a[80:83], v2 offset:4096
    v_cvt_pk_bf16_f32 v95, v254, v255
    v_mfma_f32_16x16x32_bf16 a[8:11], a[100:103], v[84:87], a[8:11]
    ds_read_b128 a[84:87], v2 offset:5120
    ds_read_b128 a[88:91], v2 offset:6144
    v_mfma_f32_16x16x32_bf16 a[12:15], a[96:99], v[88:91], a[12:15]
    buffer_load_dwordx4 v1, s[36:39], s77 offen offset:1024 lds
    v_mfma_f32_16x16x32_bf16 a[12:15], a[100:103], v[92:95], a[12:15]
    s_waitcnt lgkmcnt(3)
    ds_read_b128 a[92:95], v2 offset:7168
    ds_read_b128 a[112:115], v2 offset:20480
    v_mfma_f32_16x16x32_bf16 a[24:27], a[104:107], v[80:83], a[24:27]
    ds_read_b128 a[116:119], v2 offset:21504
    v_add_f32 v180, v212, v156
    v_mfma_f32_16x16x32_bf16 a[24:27], a[108:111], v[84:87], a[24:27]
    v_add_f32 v181, v213, v156
    v_add_f32 v182, v214, v156
    v_mfma_f32_16x16x32_bf16 a[28:31], a[104:107], v[88:91], a[28:31]
    v_add_f32 v183, v215, v156
    ds_read_b128 a[120:123], v2 offset:22528
    v_mfma_f32_16x16x32_bf16 a[28:31], a[108:111], v[92:95], a[28:31]
    s_waitcnt lgkmcnt(4)
    buffer_load_dwordx4 v1, s[36:39], s77 offen offset:2048 lds
    v_mfma_f32_16x16x32_bf16 v[244:247], a[80:83], v[140:143], v[180:183]
    ds_read_b128 a[124:127], v2 offset:23552
    ds_read_b128 a[64:67], v2 offset:8192
    v_mfma_f32_16x16x32_bf16 v[244:247], a[84:87], v[172:175], v[244:247]
    buffer_load_dwordx4 v1, s[36:39], s77 offen offset:3072 lds
    v_mfma_f32_16x16x32_bf16 v[244:247], a[88:91], v[204:207], v[244:247]
    s_waitcnt lgkmcnt(3)
    ds_read_b128 a[68:71], v2 offset:9216
    ds_read_b128 a[72:75], v2 offset:10240
    v_mfma_f32_16x16x32_bf16 v[244:247], a[92:95], v[236:239], v[244:247]
    s_add_u32 s100, s77, 4096
    ds_read_b128 a[76:79], v2 offset:11264
    ds_read_b128 a[96:99], v2 offset:24576
    v_mfma_f32_16x16x32_bf16 a[40:43], a[112:115], v[80:83], a[40:43]
    s_add_u32 m0, m0, 4096
    ds_read_b128 a[100:103], v2 offset:25600
    v_add_f32 v184, v216, v156
    v_mfma_f32_16x16x32_bf16 a[40:43], a[116:119], v[84:87], a[40:43]
    buffer_load_dwordx4 v1, s[36:39], s100 offen lds
    v_mfma_f32_16x16x32_bf16 a[44:47], a[112:115], v[88:91], a[44:47]
    v_add_f32 v185, v217, v156
    v_add_f32 v186, v218, v156
    v_mfma_f32_16x16x32_bf16 a[44:47], a[116:119], v[92:95], a[44:47]
    s_waitcnt lgkmcnt(3)
    buffer_load_dwordx4 v1, s[36:39], s100 offen offset:1024 lds
    v_mfma_f32_16x16x32_bf16 a[56:59], a[120:123], v[80:83], a[56:59]
    v_add_f32 v187, v219, v156
    ds_read_b128 a[104:107], v2 offset:26624
    v_mfma_f32_16x16x32_bf16 a[56:59], a[124:127], v[84:87], a[56:59]
    ds_read_b128 a[108:111], v2 offset:27648
    ds_read_b128 a[80:83], v2 offset:12288
    v_mfma_f32_16x16x32_bf16 a[60:63], a[120:123], v[88:91], a[60:63]
    ds_read_b128 a[84:87], v2 offset:13312
    ds_read_b128 a[88:91], v2 offset:14336
    v_mfma_f32_16x16x32_bf16 a[60:63], a[124:127], v[92:95], a[60:63]
    buffer_load_dwordx4 v1, s[36:39], s100 offen offset:2048 lds
    v_mfma_f32_16x16x32_bf16 v[248:251], a[64:67], v[140:143], v[184:187]
    ds_read_b128 a[92:95], v2 offset:15360
    ds_read_b128 a[112:115], v2 offset:28672
    v_mfma_f32_16x16x32_bf16 v[248:251], a[68:71], v[172:175], v[248:251]
    ds_read_b128 a[116:119], v2 offset:29696
    v_add_f32 v188, v220, v156
    v_mfma_f32_16x16x32_bf16 v[248:251], a[72:75], v[204:207], v[248:251]
    s_waitcnt lgkmcnt(5)
    v_add_f32 v189, v221, v156
    v_add_f32 v190, v222, v156
    v_mfma_f32_16x16x32_bf16 v[248:251], a[76:79], v[236:239], v[248:251]
    buffer_load_dwordx4 v1, s[36:39], s100 offen offset:3072 lds
    v_mfma_f32_16x16x32_bf16 a[152:155], a[96:99], v[80:83], a[152:155]
    v_add_f32 v191, v223, v156
    ds_read_b128 a[120:123], v2 offset:30720
    v_mfma_f32_16x16x32_bf16 a[152:155], a[100:103], v[84:87], a[152:155]
    ds_read_b128 a[124:127], v2 offset:31744
    v_mfma_f32_16x16x32_bf16 a[156:159], a[96:99], v[88:91], a[156:159]
    s_add_u32 s77, s77, 32768
    v_exp_f32 v240, v240
    v_mfma_f32_16x16x32_bf16 a[156:159], a[100:103], v[92:95], a[156:159]
    s_cmp_eq_u32 s75, 163840
    s_cselect_b32 s75, 0, s75
    v_add_u32 v2, s75, v1
    v_mfma_f32_16x16x32_bf16 a[168:171], a[104:107], v[80:83], a[168:171]
    v_exp_f32 v241, v241
    v_mfma_f32_16x16x32_bf16 a[168:171], a[108:111], v[84:87], a[168:171]
    v_exp_f32 v242, v242
    v_mfma_f32_16x16x32_bf16 a[172:175], a[104:107], v[88:91], a[172:175]
    v_exp_f32 v243, v243
    v_mfma_f32_16x16x32_bf16 a[172:175], a[108:111], v[92:95], a[172:175]
    v_exp_f32 v244, v244
    v_mfma_f32_16x16x32_bf16 v[252:255], a[80:83], v[140:143], v[188:191]
    s_waitcnt lgkmcnt(0)
    v_exp_f32 v245, v245
    v_mfma_f32_16x16x32_bf16 v[252:255], a[84:87], v[172:175], v[252:255]
    v_exp_f32 v246, v246
    v_mfma_f32_16x16x32_bf16 v[252:255], a[88:91], v[204:207], v[252:255]
    v_exp_f32 v247, v247
    v_mfma_f32_16x16x32_bf16 v[252:255], a[92:95], v[236:239], v[252:255]
    s_waitcnt vmcnt(16)
    s_barrier
    ds_read_b128 a[64:67], v2 offset:0
    v_mfma_f32_16x16x32_bf16 a[184:187], a[112:115], v[80:83], a[184:187]
    ds_read_b128 a[68:71], v2 offset:1024
    ds_read_b128 a[72:75], v2 offset:2048
    v_mfma_f32_16x16x32_bf16 a[184:187], a[116:119], v[84:87], a[184:187]
    ds_read_b128 a[76:79], v2 offset:3072
    ds_read_b128 a[96:99], v2 offset:16384
    v_mfma_f32_16x16x32_bf16 a[188:191], a[112:115], v[88:91], a[188:191]
    ds_read_b128 a[100:103], v2 offset:17408
    v_cvt_pk_bf16_f32 v120, v240, v241
    v_mfma_f32_16x16x32_bf16 a[188:191], a[116:119], v[92:95], a[188:191]
    v_exp_f32 v248, v248
    v_mfma_f32_16x16x32_bf16 a[200:203], a[120:123], v[80:83], a[200:203]
    v_exp_f32 v249, v249
    v_mfma_f32_16x16x32_bf16 a[200:203], a[124:127], v[84:87], a[200:203]
    v_exp_f32 v250, v250
    v_mfma_f32_16x16x32_bf16 a[204:207], a[120:123], v[88:91], a[204:207]
    v_exp_f32 v251, v251
    v_mfma_f32_16x16x32_bf16 a[204:207], a[124:127], v[92:95], a[204:207]
    v_exp_f32 v252, v252
    v_mfma_f32_16x16x32_bf16 a[216:219], a[224:227], v[80:83], a[216:219]
    v_exp_f32 v253, v253
    v_mfma_f32_16x16x32_bf16 a[216:219], a[224:227], v[84:87], a[216:219]
    v_cvt_pk_bf16_f32 v121, v242, v243
    v_cvt_pk_bf16_f32 v122, v244, v245
    v_mfma_f32_16x16x32_bf16 a[220:223], a[224:227], v[88:91], a[220:223]
    v_cvt_pk_bf16_f32 v123, v246, v247
    v_cvt_pk_bf16_f32 v124, v248, v249
    v_mfma_f32_16x16x32_bf16 a[220:223], a[224:227], v[92:95], a[220:223]
    v_cvt_pk_bf16_f32 v125, v250, v251
    v_cvt_pk_bf16_f32 v126, v252, v253
    s_waitcnt lgkmcnt(0)
    v_mfma_f32_16x16x32_bf16 a[12:15], a[96:99], v[120:123], a[12:15]
    ds_read_b128 a[104:107], v2 offset:18432
    ds_read_b128 a[108:111], v2 offset:19456
    v_exp_f32 v254, v254
    v_exp_f32 v255, v255
    s_nop 0
    v_cvt_pk_bf16_f32 v127, v254, v255
    s_nop 1
    v_mfma_f32_16x16x32_bf16 a[12:15], a[100:103], v[124:127], a[12:15]
    s_waitcnt lgkmcnt(1)
    ds_read_b128 a[112:115], v2 offset:20480
    ds_read_b128 a[116:119], v2 offset:21504
    v_mfma_f32_16x16x32_bf16 a[28:31], a[104:107], v[120:123], a[28:31]
    s_waitcnt lgkmcnt(2)
    ds_read_b128 a[120:123], v2 offset:22528
    ds_read_b128 a[124:127], v2 offset:23552
    v_mfma_f32_16x16x32_bf16 a[28:31], a[108:111], v[124:127], a[28:31]
    s_waitcnt lgkmcnt(3)
    ds_read_b128 a[96:99], v2 offset:24576
    ds_read_b128 a[100:103], v2 offset:25600
    v_mfma_f32_16x16x32_bf16 a[44:47], a[112:115], v[120:123], a[44:47]
    s_waitcnt lgkmcnt(4)
    ds_read_b128 a[104:107], v2 offset:26624
    ds_read_b128 a[108:111], v2 offset:27648
    v_mfma_f32_16x16x32_bf16 a[44:47], a[116:119], v[124:127], a[44:47]
    s_waitcnt lgkmcnt(5)
    ds_read_b128 a[112:115], v2 offset:28672
    ds_read_b128 a[116:119], v2 offset:29696
    v_mfma_f32_16x16x32_bf16 a[60:63], a[120:123], v[120:123], a[60:63]
    s_waitcnt lgkmcnt(6)
    ds_read_b128 a[120:123], v2 offset:30720
    v_mfma_f32_16x16x32_bf16 a[60:63], a[124:127], v[124:127], a[60:63]
    s_waitcnt lgkmcnt(6)
    ds_read_b128 a[124:127], v2 offset:31744
    v_mfma_f32_16x16x32_bf16 a[156:159], a[96:99], v[120:123], a[156:159]
    s_waitcnt lgkmcnt(6)
    v_mfma_f32_16x16x32_bf16 a[156:159], a[100:103], v[124:127], a[156:159]
    s_waitcnt lgkmcnt(4)
    v_mfma_f32_16x16x32_bf16 a[172:175], a[104:107], v[120:123], a[172:175]
    v_mfma_f32_16x16x32_bf16 a[172:175], a[108:111], v[124:127], a[172:175]
    s_waitcnt lgkmcnt(1)
    v_mfma_f32_16x16x32_bf16 a[188:191], a[112:115], v[120:123], a[188:191]
    v_mfma_f32_16x16x32_bf16 a[188:191], a[116:119], v[124:127], a[188:191]
    v_mfma_f32_16x16x32_bf16 a[204:207], a[120:123], v[120:123], a[204:207]
    s_waitcnt lgkmcnt(0)
    v_mfma_f32_16x16x32_bf16 a[204:207], a[124:127], v[124:127], a[204:207]
    v_mfma_f32_16x16x32_bf16 a[220:223], a[224:227], v[120:123], a[220:223]
    v_mfma_f32_16x16x32_bf16 a[220:223], a[224:227], v[124:127], a[220:223]
    s_nop 7
    v_accvgpr_read_b32 v8, a216
    v_cmp_nge_f32 vcc, s101, v8
    v_rcp_f32 v10, v8
    s_nop 0
    s_or_b64 s[84:85], s[84:85], vcc
    v_mul_f32 v10, v10, v6
    v_accvgpr_read_b32 v12, a8
    v_accvgpr_read_b32 v13, a9
    v_accvgpr_read_b32 v14, a10
    v_accvgpr_read_b32 v15, a11
    v_accvgpr_read_b32 v16, a24
    v_accvgpr_read_b32 v17, a25
    v_accvgpr_read_b32 v18, a26
    v_accvgpr_read_b32 v19, a27
    v_pk_mul_f32 v[12:13], v[12:13], v[10:11] op_sel_hi:[1,0]
    v_pk_mul_f32 v[14:15], v[14:15], v[10:11] op_sel_hi:[1,0]
    v_pk_mul_f32 v[16:17], v[16:17], v[10:11] op_sel_hi:[1,0]
    v_pk_mul_f32 v[18:19], v[18:19], v[10:11] op_sel_hi:[1,0]
    v_cvt_pk_bf16_f32 v12, v12, v13
    v_cvt_pk_bf16_f32 v13, v14, v15
    v_cvt_pk_bf16_f32 v14, v16, v17
    v_cvt_pk_bf16_f32 v15, v18, v19
    buffer_store_dwordx4 v[12:15], v1, s[40:43], s82 offen offset:0
    v_accvgpr_read_b32 v20, a40
    v_accvgpr_read_b32 v21, a41
    v_accvgpr_read_b32 v22, a42
    v_accvgpr_read_b32 v23, a43
    v_accvgpr_read_b32 v24, a56
    v_accvgpr_read_b32 v25, a57
    v_accvgpr_read_b32 v26, a58
    v_accvgpr_read_b32 v27, a59
    v_pk_mul_f32 v[20:21], v[20:21], v[10:11] op_sel_hi:[1,0]
    v_pk_mul_f32 v[22:23], v[22:23], v[10:11] op_sel_hi:[1,0]
    v_pk_mul_f32 v[24:25], v[24:25], v[10:11] op_sel_hi:[1,0]
    v_pk_mul_f32 v[26:27], v[26:27], v[10:11] op_sel_hi:[1,0]
    v_cvt_pk_bf16_f32 v20, v20, v21
    v_cvt_pk_bf16_f32 v21, v22, v23
    v_cvt_pk_bf16_f32 v22, v24, v25
    v_cvt_pk_bf16_f32 v23, v26, v27
    buffer_store_dwordx4 v[20:23], v1, s[40:43], s82 offen offset:1024
    v_accvgpr_read_b32 v12, a152
    v_accvgpr_read_b32 v13, a153
    v_accvgpr_read_b32 v14, a154
    v_accvgpr_read_b32 v15, a155
    v_accvgpr_read_b32 v16, a168
    v_accvgpr_read_b32 v17, a169
    v_accvgpr_read_b32 v18, a170
    v_accvgpr_read_b32 v19, a171
    v_pk_mul_f32 v[12:13], v[12:13], v[10:11] op_sel_hi:[1,0]
    v_pk_mul_f32 v[14:15], v[14:15], v[10:11] op_sel_hi:[1,0]
    v_pk_mul_f32 v[16:17], v[16:17], v[10:11] op_sel_hi:[1,0]
    v_pk_mul_f32 v[18:19], v[18:19], v[10:11] op_sel_hi:[1,0]
    v_cvt_pk_bf16_f32 v12, v12, v13
    v_cvt_pk_bf16_f32 v13, v14, v15
    v_cvt_pk_bf16_f32 v14, v16, v17
    v_cvt_pk_bf16_f32 v15, v18, v19
    buffer_store_dwordx4 v[12:15], v1, s[40:43], s82 offen offset:2048
    v_accvgpr_read_b32 v20, a184
    v_accvgpr_read_b32 v21, a185
    v_accvgpr_read_b32 v22, a186
    v_accvgpr_read_b32 v23, a187
    v_accvgpr_read_b32 v24, a200
    v_accvgpr_read_b32 v25, a201
    v_accvgpr_read_b32 v26, a202
    v_accvgpr_read_b32 v27, a203
    v_pk_mul_f32 v[20:21], v[20:21], v[10:11] op_sel_hi:[1,0]
    v_pk_mul_f32 v[22:23], v[22:23], v[10:11] op_sel_hi:[1,0]
    v_pk_mul_f32 v[24:25], v[24:25], v[10:11] op_sel_hi:[1,0]
    v_pk_mul_f32 v[26:27], v[26:27], v[10:11] op_sel_hi:[1,0]
    v_cvt_pk_bf16_f32 v20, v20, v21
    v_cvt_pk_bf16_f32 v21, v22, v23
    v_cvt_pk_bf16_f32 v22, v24, v25
    v_cvt_pk_bf16_f32 v23, v26, v27
    buffer_store_dwordx4 v[20:23], v1, s[40:43], s82 offen offset:3072
    v_accvgpr_read_b32 v8, a220
    v_cmp_nge_f32 vcc, s101, v8
    v_rcp_f32 v10, v8
    s_nop 0
    s_or_b64 s[84:85], s[84:85], vcc
    v_mul_f32 v10, v10, v7
    s_add_u32 s72, s82, 598016
    v_accvgpr_read_b32 v12, a12
    v_accvgpr_read_b32 v13, a13
    v_accvgpr_read_b32 v14, a14
    v_accvgpr_read_b32 v15, a15
    v_accvgpr_read_b32 v16, a28
    v_accvgpr_read_b32 v17, a29
    v_accvgpr_read_b32 v18, a30
    v_accvgpr_read_b32 v19, a31
    v_pk_mul_f32 v[12:13], v[12:13], v[10:11] op_sel_hi:[1,0]
    v_pk_mul_f32 v[14:15], v[14:15], v[10:11] op_sel_hi:[1,0]
    v_pk_mul_f32 v[16:17], v[16:17], v[10:11] op_sel_hi:[1,0]
    v_pk_mul_f32 v[18:19], v[18:19], v[10:11] op_sel_hi:[1,0]
    v_cvt_pk_bf16_f32 v12, v12, v13
    v_cvt_pk_bf16_f32 v13, v14, v15
    v_cvt_pk_bf16_f32 v14, v16, v17
    v_cvt_pk_bf16_f32 v15, v18, v19
    buffer_store_dwordx4 v[12:15], v1, s[40:43], s72 offen offset:0
    v_accvgpr_read_b32 v20, a44
    v_accvgpr_read_b32 v21, a45
    v_accvgpr_read_b32 v22, a46
    v_accvgpr_read_b32 v23, a47
    v_accvgpr_read_b32 v24, a60
    v_accvgpr_read_b32 v25, a61
    v_accvgpr_read_b32 v26, a62
    v_accvgpr_read_b32 v27, a63
    v_pk_mul_f32 v[20:21], v[20:21], v[10:11] op_sel_hi:[1,0]
    v_pk_mul_f32 v[22:23], v[22:23], v[10:11] op_sel_hi:[1,0]
    v_pk_mul_f32 v[24:25], v[24:25], v[10:11] op_sel_hi:[1,0]
    v_pk_mul_f32 v[26:27], v[26:27], v[10:11] op_sel_hi:[1,0]
    v_cvt_pk_bf16_f32 v20, v20, v21
    v_cvt_pk_bf16_f32 v21, v22, v23
    v_cvt_pk_bf16_f32 v22, v24, v25
    v_cvt_pk_bf16_f32 v23, v26, v27
    buffer_store_dwordx4 v[20:23], v1, s[40:43], s72 offen offset:1024
    v_accvgpr_read_b32 v12, a156
    v_accvgpr_read_b32 v13, a157
    v_accvgpr_read_b32 v14, a158
    v_accvgpr_read_b32 v15, a159
    v_accvgpr_read_b32 v16, a172
    v_accvgpr_read_b32 v17, a173
    v_accvgpr_read_b32 v18, a174
    v_accvgpr_read_b32 v19, a175
    v_pk_mul_f32 v[12:13], v[12:13], v[10:11] op_sel_hi:[1,0]
    v_pk_mul_f32 v[14:15], v[14:15], v[10:11] op_sel_hi:[1,0]
    v_pk_mul_f32 v[16:17], v[16:17], v[10:11] op_sel_hi:[1,0]
    v_pk_mul_f32 v[18:19], v[18:19], v[10:11] op_sel_hi:[1,0]
    v_cvt_pk_bf16_f32 v12, v12, v13
    v_cvt_pk_bf16_f32 v13, v14, v15
    v_cvt_pk_bf16_f32 v14, v16, v17
    v_cvt_pk_bf16_f32 v15, v18, v19
    buffer_store_dwordx4 v[12:15], v1, s[40:43], s72 offen offset:2048
    v_accvgpr_read_b32 v20, a188
    v_accvgpr_read_b32 v21, a189
    v_accvgpr_read_b32 v22, a190
    v_accvgpr_read_b32 v23, a191
    v_accvgpr_read_b32 v24, a204
    v_accvgpr_read_b32 v25, a205
    v_accvgpr_read_b32 v26, a206
    v_accvgpr_read_b32 v27, a207
    v_pk_mul_f32 v[20:21], v[20:21], v[10:11] op_sel_hi:[1,0]
    v_pk_mul_f32 v[22:23], v[22:23], v[10:11] op_sel_hi:[1,0]
    v_pk_mul_f32 v[24:25], v[24:25], v[10:11] op_sel_hi:[1,0]
    v_pk_mul_f32 v[26:27], v[26:27], v[10:11] op_sel_hi:[1,0]
    v_cvt_pk_bf16_f32 v20, v20, v21
    v_cvt_pk_bf16_f32 v21, v22, v23
    v_cvt_pk_bf16_f32 v22, v24, v25
    v_cvt_pk_bf16_f32 v23, v26, v27
    buffer_store_dwordx4 v[20:23], v1, s[40:43], s72 offen offset:3072
    s_cmp_lg_u64 s[84:85], 0
    s_cselect_b32 s7, 1, 0
    v_mov_b32 v8, s7
    s_lshl_b32 s98, s4, 2
    v_mov_b32 v9, s98
    s_waitcnt vmcnt(8)
    s_barrier
    ds_write_b32 v9, v8
    v_mov_b32 v9, 0
    s_waitcnt lgkmcnt(0)
    s_barrier
    ds_read_b128 v[12:15], v9
    s_waitcnt lgkmcnt(0)
    v_or3_b32 v12, v12, v13, v14
    v_or_b32 v12, v12, v15
    s_nop 0
    v_readfirstlane_b32 s7, v12
    s_nop 1
    s_andn2_b32 s7, s7, s83
    s_cmp_lg_u32 s7, 0
    s_cbranch_scc1 K1_REDO
K1_END:
    s_endpgm
K1_LB_MASK:
    s_nop 1
    v_add_f32 v176, v176, v208
    v_add_f32 v177, v177, v209
    v_add_f32 v178, v178, v210
    v_add_f32 v179, v179, v211
    v_add_f32 v180, v180, v212
    v_add_f32 v181, v181, v213
    v_add_f32 v182, v182, v214
    v_add_f32 v183, v183, v215
    v_add_f32 v184, v184, v216
    v_add_f32 v185, v185, v217
    v_add_f32 v186, v186, v218
    v_add_f32 v187, v187, v219
    v_add_f32 v188, v188, v220
    v_add_f32 v189, v189, v221
    v_add_f32 v190, v190, v222
    v_add_f32 v191, v191, v223
    s_nop 1
    s_branch K1_LB_BACK
K1_LS_MASK:
    s_nop 1
    v_add_f32 v176, v176, v208
    v_add_f32 v177, v177, v209
    v_add_f32 v178, v178, v210
    v_add_f32 v179, v179, v211
    v_add_f32 v180, v180, v212
    v_add_f32 v181, v181, v213
    v_add_f32 v182, v182, v214
    v_add_f32 v183, v183, v215
    v_add_f32 v184, v184, v216
    v_add_f32 v185, v185, v217
    v_add_f32 v186, v186, v218
    v_add_f32 v187, v187, v219
    v_add_f32 v188, v188, v220
    v_add_f32 v189, v189, v221
    v_add_f32 v190, v190, v222
    v_add_f32 v191, v191, v223
    s_nop 1
    s_branch K1_LS_BACK
K1_REDO:
    s_mov_b32 s83, 1
    s_waitcnt vmcnt(0)
    s_barrier
    v_lshrrev_b32 v92, 4, v1
    v_and_b32 v64, 15, v92
    v_lshrrev_b32 v92, 4, v92
    v_lshlrev_b32 v92, 2, v92
    v_sub_u32 v92, v64, v92
    s_lshl_b32 s98, s4, 4
    v_add_u32 v92, s98, v92
    s_lshl_b32 s98, s6, 7
    s_sub_u32 s99, 1920, s98
    v_add_u32 v64, s98, v92
    v_add_u32 v65, 64, v64
    v_add_u32 v66, s99, v92
    v_add_u32 v67, 64, v66
    v_mov_b32 v93, 0xf149f2ca
    v_mov_b32 v68, v93
    v_mov_b32 v69, v93
    v_mov_b32 v70, v93
    v_mov_b32 v71, v93
    s_mov_b32 s78, 0
    s_add_u32 s99, s99, 128
K1_REDO_L:
    s_lshr_b32 s7, s78, 6
    s_lshl_b32 s7, s7, 15
    s_bfe_u32 s98, s78, 0x20004
    s_lshl_b32 s98, s98, 12
    s_add_u32 s7, s7, s98
    buffer_load_dwordx4 v[72:75], v1, s[36:39], s7 offen offset:0
    buffer_load_dwordx4 v[76:79], v1, s[36:39], s7 offen offset:1024
    buffer_load_dwordx4 v[80:83], v1, s[36:39], s7 offen offset:2048
    buffer_load_dwordx4 v[84:87], v1, s[36:39], s7 offen offset:3072
    s_waitcnt vmcnt(0)
    v_mfma_f32_16x16x32_bf16 v[88:91], v[72:75], v[128:131], 0
    v_mfma_f32_16x16x32_bf16 v[88:91], v[76:79], v[160:163], v[88:91]
    v_mfma_f32_16x16x32_bf16 v[88:91], v[80:83], v[192:195], v[88:91]
    v_mfma_f32_16x16x32_bf16 v[88:91], v[84:87], v[224:227], v[88:91]
    v_subrev_u32 v92, s78, v64
    v_cmp_le_i32 vcc, 0, v92
    s_nop 5
    v_cndmask_b32 v88, v93, v88, vcc
    v_max_f32 v68, v68, v88
    v_cmp_le_i32 vcc, 1, v92
    s_nop 1
    v_cndmask_b32 v89, v93, v89, vcc
    v_max_f32 v68, v68, v89
    v_cmp_le_i32 vcc, 2, v92
    s_nop 1
    v_cndmask_b32 v90, v93, v90, vcc
    v_max_f32 v68, v68, v90
    v_cmp_le_i32 vcc, 3, v92
    s_nop 1
    v_cndmask_b32 v91, v93, v91, vcc
    v_max_f32 v68, v68, v91
    v_mfma_f32_16x16x32_bf16 v[88:91], v[72:75], v[132:135], 0
    v_mfma_f32_16x16x32_bf16 v[88:91], v[76:79], v[164:167], v[88:91]
    v_mfma_f32_16x16x32_bf16 v[88:91], v[80:83], v[196:199], v[88:91]
    v_mfma_f32_16x16x32_bf16 v[88:91], v[84:87], v[228:231], v[88:91]
    v_subrev_u32 v92, s78, v65
    v_cmp_le_i32 vcc, 0, v92
    s_nop 5
    v_cndmask_b32 v88, v93, v88, vcc
    v_max_f32 v69, v69, v88
    v_cmp_le_i32 vcc, 1, v92
    s_nop 1
    v_cndmask_b32 v89, v93, v89, vcc
    v_max_f32 v69, v69, v89
    v_cmp_le_i32 vcc, 2, v92
    s_nop 1
    v_cndmask_b32 v90, v93, v90, vcc
    v_max_f32 v69, v69, v90
    v_cmp_le_i32 vcc, 3, v92
    s_nop 1
    v_cndmask_b32 v91, v93, v91, vcc
    v_max_f32 v69, v69, v91
    v_mfma_f32_16x16x32_bf16 v[88:91], v[72:75], v[136:139], 0
    v_mfma_f32_16x16x32_bf16 v[88:91], v[76:79], v[168:171], v[88:91]
    v_mfma_f32_16x16x32_bf16 v[88:91], v[80:83], v[200:203], v[88:91]
    v_mfma_f32_16x16x32_bf16 v[88:91], v[84:87], v[232:235], v[88:91]
    v_subrev_u32 v92, s78, v66
    v_cmp_le_i32 vcc, 0, v92
    s_nop 5
    v_cndmask_b32 v88, v93, v88, vcc
    v_max_f32 v70, v70, v88
    v_cmp_le_i32 vcc, 1, v92
    s_nop 1
    v_cndmask_b32 v89, v93, v89, vcc
    v_max_f32 v70, v70, v89
    v_cmp_le_i32 vcc, 2, v92
    s_nop 1
    v_cndmask_b32 v90, v93, v90, vcc
    v_max_f32 v70, v70, v90
    v_cmp_le_i32 vcc, 3, v92
    s_nop 1
    v_cndmask_b32 v91, v93, v91, vcc
    v_max_f32 v70, v70, v91
    v_mfma_f32_16x16x32_bf16 v[88:91], v[72:75], v[140:143], 0
    v_mfma_f32_16x16x32_bf16 v[88:91], v[76:79], v[172:175], v[88:91]
    v_mfma_f32_16x16x32_bf16 v[88:91], v[80:83], v[204:207], v[88:91]
    v_mfma_f32_16x16x32_bf16 v[88:91], v[84:87], v[236:239], v[88:91]
    v_subrev_u32 v92, s78, v67
    v_cmp_le_i32 vcc, 0, v92
    s_nop 5
    v_cndmask_b32 v88, v93, v88, vcc
    v_max_f32 v71, v71, v88
    v_cmp_le_i32 vcc, 1, v92
    s_nop 1
    v_cndmask_b32 v89, v93, v89, vcc
    v_max_f32 v71, v71, v89
    v_cmp_le_i32 vcc, 2, v92
    s_nop 1
    v_cndmask_b32 v90, v93, v90, vcc
    v_max_f32 v71, v71, v90
    v_cmp_le_i32 vcc, 3, v92
    s_nop 1
    v_cndmask_b32 v91, v93, v91, vcc
    v_max_f32 v71, v71, v91
    s_add_u32 s78, s78, 16
    s_cmp_lt_u32 s78, s99
    s_cbranch_scc1 K1_REDO_L
    v_mov_b32 v92, v68
    s_nop 1
    v_permlane32_swap_b32 v68, v92
    v_max_f32 v68, v68, v92
    v_mov_b32 v92, v68
    s_nop 1
    v_permlane16_swap_b32 v68, v92
    v_max_f32 v68, v68, v92
    v_sub_f32 v144, 0, v68
    v_sub_f32 v145, 0, v68
    v_sub_f32 v146, 0, v68
    v_sub_f32 v147, 0, v68
    v_mov_b32 v92, v69
    s_nop 1
    v_permlane32_swap_b32 v69, v92
    v_max_f32 v69, v69, v92
    v_mov_b32 v92, v69
    s_nop 1
    v_permlane16_swap_b32 v69, v92
    v_max_f32 v69, v69, v92
    v_sub_f32 v148, 0, v69
    v_sub_f32 v149, 0, v69
    v_sub_f32 v150, 0, v69
    v_sub_f32 v151, 0, v69
    v_mov_b32 v92, v70
    s_nop 1
    v_permlane32_swap_b32 v70, v92
    v_max_f32 v70, v70, v92
    v_mov_b32 v92, v70
    s_nop 1
    v_permlane16_swap_b32 v70, v92
    v_max_f32 v70, v70, v92
    v_sub_f32 v152, 0, v70
    v_sub_f32 v153, 0, v70
    v_sub_f32 v154, 0, v70
    v_sub_f32 v155, 0, v70
    v_mov_b32 v92, v71
    s_nop 1
    v_permlane32_swap_b32 v71, v92
    v_max_f32 v71, v71, v92
    v_mov_b32 v92, v71
    s_nop 1
    v_permlane16_swap_b32 v71, v92
    v_max_f32 v71, v71, v92
    v_sub_f32 v156, 0, v71
    v_sub_f32 v157, 0, v71
    v_sub_f32 v158, 0, v71
    v_sub_f32 v159, 0, v71
    v_accvgpr_write_b32 a0, 0
    v_accvgpr_write_b32 a1, 0
    v_accvgpr_write_b32 a2, 0
    v_accvgpr_write_b32 a3, 0
    v_accvgpr_write_b32 a4, 0
    v_accvgpr_write_b32 a5, 0
    v_accvgpr_write_b32 a6, 0
    v_accvgpr_write_b32 a7, 0
    v_accvgpr_write_b32 a8, 0
    v_accvgpr_write_b32 a9, 0
    v_accvgpr_write_b32 a10, 0
    v_accvgpr_write_b32 a11, 0
    v_accvgpr_write_b32 a12, 0
    v_accvgpr_write_b32 a13, 0
    v_accvgpr_write_b32 a14, 0
    v_accvgpr_write_b32 a15, 0
    v_accvgpr_write_b32 a16, 0
    v_accvgpr_write_b32 a17, 0
    v_accvgpr_write_b32 a18, 0
    v_accvgpr_write_b32 a19, 0
    v_accvgpr_write_b32 a20, 0
    v_accvgpr_write_b32 a21, 0
    v_accvgpr_write_b32 a22, 0
    v_accvgpr_write_b32 a23, 0
    v_accvgpr_write_b32 a24, 0
    v_accvgpr_write_b32 a25, 0
    v_accvgpr_write_b32 a26, 0
    v_accvgpr_write_b32 a27, 0
    v_accvgpr_write_b32 a28, 0
    v_accvgpr_write_b32 a29, 0
    v_accvgpr_write_b32 a30, 0
    v_accvgpr_write_b32 a31, 0
    v_accvgpr_write_b32 a32, 0
    v_accvgpr_write_b32 a33, 0
    v_accvgpr_write_b32 a34, 0
    v_accvgpr_write_b32 a35, 0
    v_accvgpr_write_b32 a36, 0
    v_accvgpr_write_b32 a37, 0
    v_accvgpr_write_b32 a38, 0
    v_accvgpr_write_b32 a39, 0
    v_accvgpr_write_b32 a40, 0
    v_accvgpr_write_b32 a41, 0
    v_accvgpr_write_b32 a42, 0
    v_accvgpr_write_b32 a43, 0
    v_accvgpr_write_b32 a44, 0
    v_accvgpr_write_b32 a45, 0
    v_accvgpr_write_b32 a46, 0
    v_accvgpr_write_b32 a47, 0
    v_accvgpr_write_b32 a48, 0
    v_accvgpr_write_b32 a49, 0
    v_accvgpr_write_b32 a50, 0
    v_accvgpr_write_b32 a51, 0
    v_accvgpr_write_b32 a52, 0
    v_accvgpr_write_b32 a53, 0
    v_accvgpr_write_b32 a54, 0
    v_accvgpr_write_b32 a55, 0
    v_accvgpr_write_b32 a56, 0
    v_accvgpr_write_b32 a57, 0
    v_accvgpr_write_b32 a58, 0
    v_accvgpr_write_b32 a59, 0
    v_accvgpr_write_b32 a60, 0
    v_accvgpr_write_b32 a61, 0
    v_accvgpr_write_b32 a62, 0
    v_accvgpr_write_b32 a63, 0
    v_accvgpr_write_b32 a144, 0
    v_accvgpr_write_b32 a145, 0
    v_accvgpr_write_b32 a146, 0
    v_accvgpr_write_b32 a147, 0
    v_accvgpr_write_b32 a148, 0
    v_accvgpr_write_b32 a149, 0
    v_accvgpr_write_b32 a150, 0
    v_accvgpr_write_b32 a151, 0
    v_accvgpr_write_b32 a152, 0
    v_accvgpr_write_b32 a153, 0
    v_accvgpr_write_b32 a154, 0
    v_accvgpr_write_b32 a155, 0
    v_accvgpr_write_b32 a156, 0
    v_accvgpr_write_b32 a157, 0
    v_accvgpr_write_b32 a158, 0
    v_accvgpr_write_b32 a159, 0
    v_accvgpr_write_b32 a160, 0
    v_accvgpr_write_b32 a161, 0
    v_accvgpr_write_b32 a162, 0
    v_accvgpr_write_b32 a163, 0
    v_accvgpr_write_b32 a164, 0
    v_accvgpr_write_b32 a165, 0
    v_accvgpr_write_b32 a166, 0
    v_accvgpr_write_b32 a167, 0
    v_accvgpr_write_b32 a168, 0
    v_accvgpr_write_b32 a169, 0
    v_accvgpr_write_b32 a170, 0
    v_accvgpr_write_b32 a171, 0
    v_accvgpr_write_b32 a172, 0
    v_accvgpr_write_b32 a173, 0
    v_accvgpr_write_b32 a174, 0
    v_accvgpr_write_b32 a175, 0
    v_accvgpr_write_b32 a176, 0
    v_accvgpr_write_b32 a177, 0
    v_accvgpr_write_b32 a178, 0
    v_accvgpr_write_b32 a179, 0
    v_accvgpr_write_b32 a180, 0
    v_accvgpr_write_b32 a181, 0
    v_accvgpr_write_b32 a182, 0
    v_accvgpr_write_b32 a183, 0
    v_accvgpr_write_b32 a184, 0
    v_accvgpr_write_b32 a185, 0
    v_accvgpr_write_b32 a186, 0
    v_accvgpr_write_b32 a187, 0
    v_accvgpr_write_b32 a188, 0
    v_accvgpr_write_b32 a189, 0
    v_accvgpr_write_b32 a190, 0
    v_accvgpr_write_b32 a191, 0
    v_accvgpr_write_b32 a192, 0
    v_accvgpr_write_b32 a193, 0
    v_accvgpr_write_b32 a194, 0
    v_accvgpr_write_b32 a195, 0
    v_accvgpr_write_b32 a196, 0
    v_accvgpr_write_b32 a197, 0
    v_accvgpr_write_b32 a198, 0
    v_accvgpr_write_b32 a199, 0
    v_accvgpr_write_b32 a200, 0
    v_accvgpr_write_b32 a201, 0
    v_accvgpr_write_b32 a202, 0
    v_accvgpr_write_b32 a203, 0
    v_accvgpr_write_b32 a204, 0
    v_accvgpr_write_b32 a205, 0
    v_accvgpr_write_b32 a206, 0
    v_accvgpr_write_b32 a207, 0
    v_accvgpr_write_b32 a208, 0
    v_accvgpr_write_b32 a209, 0
    v_accvgpr_write_b32 a210, 0
    v_accvgpr_write_b32 a211, 0
    v_accvgpr_write_b32 a212, 0
    v_accvgpr_write_b32 a213, 0
    v_accvgpr_write_b32 a214, 0
    v_accvgpr_write_b32 a215, 0
    v_accvgpr_write_b32 a216, 0
    v_accvgpr_write_b32 a217, 0
    v_accvgpr_write_b32 a218, 0
    v_accvgpr_write_b32 a219, 0
    v_accvgpr_write_b32 a220, 0
    v_accvgpr_write_b32 a221, 0
    v_accvgpr_write_b32 a222, 0
    v_accvgpr_write_b32 a223, 0
    s_mov_b32 s77, s80
    s_mov_b32 s76, 0
    s_add_u32 m0, s76, s80
    s_nop 0
    buffer_load_dwordx4 v1, s[36:39], s77 offen lds
    buffer_load_dwordx4 v1, s[36:39], s77 offen offset:1024 lds
    buffer_load_dwordx4 v1, s[36:39], s77 offen offset:2048 lds
    buffer_load_dwordx4 v1, s[36:39], s77 offen offset:3072 lds
    s_add_u32 s100, s77, 4096
    s_add_u32 m0, m0, 4096
    s_nop 0
    buffer_load_dwordx4 v1, s[36:39], s100 offen lds
    buffer_load_dwordx4 v1, s[36:39], s100 offen offset:1024 lds
    buffer_load_dwordx4 v1, s[36:39], s100 offen offset:2048 lds
    buffer_load_dwordx4 v1, s[36:39], s100 offen offset:3072 lds
    s_add_u32 s77, s77, 32768
    s_add_u32 s76, s76, 32768
    s_add_u32 m0, s76, s80
    s_nop 0
    buffer_load_dwordx4 v1, s[36:39], s77 offen lds
    buffer_load_dwordx4 v1, s[36:39], s77 offen offset:1024 lds
    buffer_load_dwordx4 v1, s[36:39], s77 offen offset:2048 lds
    buffer_load_dwordx4 v1, s[36:39], s77 offen offset:3072 lds
    s_add_u32 s100, s77, 4096
    s_add_u32 m0, m0, 4096
    s_nop 0
    buffer_load_dwordx4 v1, s[36:39], s100 offen lds
    buffer_load_dwordx4 v1, s[36:39], s100 offen offset:1024 lds
    buffer_load_dwordx4 v1, s[36:39], s100 offen offset:2048 lds
    buffer_load_dwordx4 v1, s[36:39], s100 offen offset:3072 lds
    s_add_u32 s77, s77, 32768
    s_add_u32 s76, s76, 32768
    s_add_u32 m0, s76, s80
    s_nop 0
    buffer_load_dwordx4 v1, s[36:39], s77 offen lds
    buffer_load_dwordx4 v1, s[36:39], s77 offen offset:1024 lds
    buffer_load_dwordx4 v1, s[36:39], s77 offen offset:2048 lds
    buffer_load_dwordx4 v1, s[36:39], s77 offen offset:3072 lds
    s_add_u32 s100, s77, 4096
    s_add_u32 m0, m0, 4096
    s_nop 0
    buffer_load_dwordx4 v1, s[36:39], s100 offen lds
    buffer_load_dwordx4 v1, s[36:39], s100 offen offset:1024 lds
    buffer_load_dwordx4 v1, s[36:39], s100 offen offset:2048 lds
    buffer_load_dwordx4 v1, s[36:39], s100 offen offset:3072 lds
    s_add_u32 s77, s77, 32768
    s_add_u32 s76, s76, 32768
    s_branch K1_ATT
.globl outproj_kernel
.p2align 8
.type outproj_kernel,@function
outproj_kernel:
    s_cmp_ge_u32 s2, 256
    s_cbranch_scc1 K2_END
    s_load_dwordx2 s[12:13], s[0:1], 96
    s_load_dwordx2 s[16:17], s[0:1], 80
    v_lshrrev_b32 v8, 6, v0
    v_and_b32 v7, 63, v0
    v_readfirstlane_b32 s20, v8
    s_bfe_u32 s21, s2, 0x20001
    s_lshr_b32 s27, s2, 5
    s_lshl3_add_u32 s21, s21, s27
    s_and_b32 s22, s2, 1
    s_bfe_u32 s27, s2, 0x10004
    s_lshl1_add_u32 s22, s22, s27
    s_bfe_u32 s23, s2, 0x10003
    s_mul_i32 s22, s22, 9
    s_mul_i32 s27, s23, 5
    s_add_u32 s25, s22, s27
    s_lshl_b32 s25, s25, 10
    s_add_u32 s26, s22, 4
    s_lshl_b32 s26, s26, 10
    s_mov_b32 s24, 0
    v_lshlrev_b32 v8, 4, v7
    s_mul_i32 s27, s20, 36864
    v_add_u32 v6, s27, v8
    s_lshl1_add_u32 s27, s23, 0
    s_and_b32 s27, s27, 3
    s_lshl2_add_u32 s27, s21, s27
    s_mul_i32 s27, s27, 146
    s_add_u32 s27, s27, s20
    s_lshl_b32 s27, s27, 10
    v_add_u32 v2, s27, v8
    s_lshl1_add_u32 s27, s23, 1
    s_and_b32 s27, s27, 3
    s_lshl2_add_u32 s27, s21, s27
    s_mul_i32 s27, s27, 146
    s_add_u32 s27, s27, s20
    s_lshl_b32 s27, s27, 10
    v_add_u32 v3, s27, v8
    s_lshl1_add_u32 s27, s23, 2
    s_and_b32 s27, s27, 3
    s_lshl2_add_u32 s27, s21, s27
    s_mul_i32 s27, s27, 146
    s_add_u32 s27, s27, s20
    s_lshl_b32 s27, s27, 10
    v_add_u32 v4, s27, v8
    s_lshl1_add_u32 s27, s23, 3
    s_and_b32 s27, s27, 3
    s_lshl2_add_u32 s27, s21, s27
    s_mul_i32 s27, s27, 146
    s_add_u32 s27, s27, s20
    s_lshl_b32 s27, s27, 10
    v_add_u32 v5, s27, v8
    s_waitcnt lgkmcnt(0)
    s_add_u32 s8, s12, 35651584
    s_addc_u32 s9, s13, 0
    s_mov_b32 s10, 19136512
    s_mov_b32 s11, 0x20000
    s_add_u32 s12, s12, 56623104
    s_addc_u32 s13, s13, 0
    s_mov_b32 s14, 5382144
    s_mov_b32 s15, 0x20000
    s_mov_b32 s18, 2359296
    s_mov_b32 s19, 0x20000
    buffer_load_dwordx4 a[0:3], v2, s[8:11], s24 offen
    buffer_load_dwordx4 a[4:7], v3, s[8:11], s24 offen
    buffer_load_dwordx4 a[8:11], v4, s[8:11], s24 offen
    buffer_load_dwordx4 a[12:15], v5, s[8:11], s24 offen
    buffer_load_dwordx4 a[16:19], v6, s[12:15], s25 offen offset:0
    buffer_load_dwordx4 a[20:23], v6, s[12:15], s25 offen offset:1024
    buffer_load_dwordx4 a[24:27], v6, s[12:15], s25 offen offset:2048
    buffer_load_dwordx4 a[28:31], v6, s[12:15], s25 offen offset:3072
    buffer_load_dwordx4 a[32:35], v6, s[12:15], s26 offen
    s_add_u32 s24, s24, 4096
    s_add_u32 s25, s25, 147456
    s_add_u32 s26, s26, 147456
    buffer_load_dwordx4 a[36:39], v2, s[8:11], s24 offen
    buffer_load_dwordx4 a[40:43], v3, s[8:11], s24 offen
    buffer_load_dwordx4 a[44:47], v4, s[8:11], s24 offen
    buffer_load_dwordx4 a[48:51], v5, s[8:11], s24 offen
    buffer_load_dwordx4 a[52:55], v6, s[12:15], s25 offen offset:0
    buffer_load_dwordx4 a[56:59], v6, s[12:15], s25 offen offset:1024
    buffer_load_dwordx4 a[60:63], v6, s[12:15], s25 offen offset:2048
    buffer_load_dwordx4 a[64:67], v6, s[12:15], s25 offen offset:3072
    buffer_load_dwordx4 a[68:71], v6, s[12:15], s26 offen
    s_add_u32 s24, s24, 4096
    s_add_u32 s25, s25, 147456
    s_add_u32 s26, s26, 147456
    buffer_load_dwordx4 a[72:75], v2, s[8:11], s24 offen
    buffer_load_dwordx4 a[76:79], v3, s[8:11], s24 offen
    buffer_load_dwordx4 a[80:83], v4, s[8:11], s24 offen
    buffer_load_dwordx4 a[84:87], v5, s[8:11], s24 offen
    buffer_load_dwordx4 a[88:91], v6, s[12:15], s25 offen offset:0
    buffer_load_dwordx4 a[92:95], v6, s[12:15], s25 offen offset:1024
    buffer_load_dwordx4 a[96:99], v6, s[12:15], s25 offen offset:2048
    buffer_load_dwordx4 a[100:103], v6, s[12:15], s25 offen offset:3072
    buffer_load_dwordx4 a[104:107], v6, s[12:15], s26 offen
    s_add_u32 s24, s24, 4096
    s_add_u32 s25, s25, 147456
    s_add_u32 s26, s26, 147456
    buffer_load_dwordx4 a[108:111], v2, s[8:11], s24 offen
    buffer_load_dwordx4 a[112:115], v3, s[8:11], s24 offen
    buffer_load_dwordx4 a[116:119], v4, s[8:11], s24 offen
    buffer_load_dwordx4 a[120:123], v5, s[8:11], s24 offen
    buffer_load_dwordx4 a[124:127], v6, s[12:15], s25 offen offset:0
    buffer_load_dwordx4 a[128:131], v6, s[12:15], s25 offen offset:1024
    buffer_load_dwordx4 a[132:135], v6, s[12:15], s25 offen offset:2048
    buffer_load_dwordx4 a[136:139], v6, s[12:15], s25 offen offset:3072
    buffer_load_dwordx4 a[140:143], v6, s[12:15], s26 offen
    s_add_u32 s24, s24, 4096
    s_add_u32 s25, s25, 147456
    s_add_u32 s26, s26, 147456
    buffer_load_dwordx4 a[144:147], v2, s[8:11], s24 offen
    buffer_load_dwordx4 a[148:151], v3, s[8:11], s24 offen
    buffer_load_dwordx4 a[152:155], v4, s[8:11], s24 offen
    buffer_load_dwordx4 a[156:159], v5, s[8:11], s24 offen
    buffer_load_dwordx4 a[160:163], v6, s[12:15], s25 offen offset:0
    buffer_load_dwordx4 a[164:167], v6, s[12:15], s25 offen offset:1024
    buffer_load_dwordx4 a[168:171], v6, s[12:15], s25 offen offset:2048
    buffer_load_dwordx4 a[172:175], v6, s[12:15], s25 offen offset:3072
    buffer_load_dwordx4 a[176:179], v6, s[12:15], s26 offen
    s_add_u32 s24, s24, 4096
    s_add_u32 s25, s25, 147456
    s_add_u32 s26, s26, 147456
    buffer_load_dwordx4 a[180:183], v2, s[8:11], s24 offen
    buffer_load_dwordx4 a[184:187], v3, s[8:11], s24 offen
    buffer_load_dwordx4 a[188:191], v4, s[8:11], s24 offen
    buffer_load_dwordx4 a[192:195], v5, s[8:11], s24 offen
    buffer_load_dwordx4 a[196:199], v6, s[12:15], s25 offen offset:0
    buffer_load_dwordx4 a[200:203], v6, s[12:15], s25 offen offset:1024
    buffer_load_dwordx4 a[204:207], v6, s[12:15], s25 offen offset:2048
    buffer_load_dwordx4 a[208:211], v6, s[12:15], s25 offen offset:3072
    buffer_load_dwordx4 a[212:215], v6, s[12:15], s26 offen
    s_add_u32 s24, s24, 4096
    s_add_u32 s25, s25, 147456
    s_add_u32 s26, s26, 147456
    buffer_load_dwordx4 a[216:219], v2, s[8:11], s24 offen
    buffer_load_dwordx4 a[220:223], v3, s[8:11], s24 offen
    buffer_load_dwordx4 a[224:227], v4, s[8:11], s24 offen
    buffer_load_dwordx4 a[228:231], v5, s[8:11], s24 offen
    buffer_load_dwordx4 a[232:235], v6, s[12:15], s25 offen offset:0
    buffer_load_dwordx4 a[236:239], v6, s[12:15], s25 offen offset:1024
    buffer_load_dwordx4 a[240:243], v6, s[12:15], s25 offen offset:2048
    buffer_load_dwordx4 a[244:247], v6, s[12:15], s25 offen offset:3072
    buffer_load_dwordx4 a[248:251], v6, s[12:15], s26 offen
    s_add_u32 s24, s24, 4096
    s_add_u32 s25, s25, 147456
    s_add_u32 s26, s26, 147456
    s_waitcnt vmcnt(54)
    v_mfma_f32_16x16x32_bf16 v[16:19], a[16:19], a[0:3], 0
    v_mfma_f32_16x16x32_bf16 v[20:23], a[16:19], a[4:7], 0
    v_mfma_f32_16x16x32_bf16 v[24:27], a[16:19], a[8:11], 0
    v_mfma_f32_16x16x32_bf16 v[28:31], a[16:19], a[12:15], 0
    v_mfma_f32_16x16x32_bf16 v[32:35], a[20:23], a[0:3], 0
    v_mfma_f32_16x16x32_bf16 v[36:39], a[20:23], a[4:7], 0
    v_mfma_f32_16x16x32_bf16 v[40:43], a[20:23], a[8:11], 0
    v_mfma_f32_16x16x32_bf16 v[44:47], a[20:23], a[12:15], 0
    v_mfma_f32_16x16x32_bf16 v[48:51], a[24:27], a[0:3], 0
    v_mfma_f32_16x16x32_bf16 v[52:55], a[24:27], a[4:7], 0
    v_mfma_f32_16x16x32_bf16 v[56:59], a[24:27], a[8:11], 0
    v_mfma_f32_16x16x32_bf16 v[60:63], a[24:27], a[12:15], 0
    v_mfma_f32_16x16x32_bf16 v[64:67], a[28:31], a[0:3], 0
    v_mfma_f32_16x16x32_bf16 v[68:71], a[28:31], a[4:7], 0
    v_mfma_f32_16x16x32_bf16 v[72:75], a[28:31], a[8:11], 0
    v_mfma_f32_16x16x32_bf16 v[76:79], a[28:31], a[12:15], 0
    v_mfma_f32_16x16x32_bf16 v[80:83], a[32:35], a[0:3], 0
    v_mfma_f32_16x16x32_bf16 v[84:87], a[32:35], a[4:7], 0
    buffer_load_dwordx4 a[0:3], v2, s[8:11], s24 offen
    buffer_load_dwordx4 a[4:7], v3, s[8:11], s24 offen
    buffer_load_dwordx4 a[8:11], v4, s[8:11], s24 offen
    buffer_load_dwordx4 a[12:15], v5, s[8:11], s24 offen
    buffer_load_dwordx4 a[16:19], v6, s[12:15], s25 offen offset:0
    buffer_load_dwordx4 a[20:23], v6, s[12:15], s25 offen offset:1024
    buffer_load_dwordx4 a[24:27], v6, s[12:15], s25 offen offset:2048
    buffer_load_dwordx4 a[28:31], v6, s[12:15], s25 offen offset:3072
    buffer_load_dwordx4 a[32:35], v6, s[12:15], s26 offen
    s_add_u32 s24, s24, 4096
    s_add_u32 s25, s25, 147456
    s_add_u32 s26, s26, 147456
    s_waitcnt vmcnt(54)
    v_mfma_f32_16x16x32_bf16 v[16:19], a[52:55], a[36:39], v[16:19]
    v_mfma_f32_16x16x32_bf16 v[20:23], a[52:55], a[40:43], v[20:23]
    v_mfma_f32_16x16x32_bf16 v[24:27], a[52:55], a[44:47], v[24:27]
    v_mfma_f32_16x16x32_bf16 v[28:31], a[52:55], a[48:51], v[28:31]
    v_mfma_f32_16x16x32_bf16 v[32:35], a[56:59], a[36:39], v[32:35]
    v_mfma_f32_16x16x32_bf16 v[36:39], a[56:59], a[40:43], v[36:39]
    v_mfma_f32_16x16x32_bf16 v[40:43], a[56:59], a[44:47], v[40:43]
    v_mfma_f32_16x16x32_bf16 v[44:47], a[56:59], a[48:51], v[44:47]
    v_mfma_f32_16x16x32_bf16 v[48:51], a[60:63], a[36:39], v[48:51]
    v_mfma_f32_16x16x32_bf16 v[52:55], a[60:63], a[40:43], v[52:55]
    v_mfma_f32_16x16x32_bf16 v[56:59], a[60:63], a[44:47], v[56:59]
    v_mfma_f32_16x16x32_bf16 v[60:63], a[60:63], a[48:51], v[60:63]
    v_mfma_f32_16x16x32_bf16 v[64:67], a[64:67], a[36:39], v[64:67]
    v_mfma_f32_16x16x32_bf16 v[68:71], a[64:67], a[40:43], v[68:71]
    v_mfma_f32_16x16x32_bf16 v[72:75], a[64:67], a[44:47], v[72:75]
    v_mfma_f32_16x16x32_bf16 v[76:79], a[64:67], a[48:51], v[76:79]
    v_mfma_f32_16x16x32_bf16 v[80:83], a[68:71], a[36:39], v[80:83]
    v_mfma_f32_16x16x32_bf16 v[84:87], a[68:71], a[40:43], v[84:87]
    buffer_load_dwordx4 a[36:39], v2, s[8:11], s24 offen
    buffer_load_dwordx4 a[40:43], v3, s[8:11], s24 offen
    buffer_load_dwordx4 a[44:47], v4, s[8:11], s24 offen
    buffer_load_dwordx4 a[48:51], v5, s[8:11], s24 offen
    buffer_load_dwordx4 a[52:55], v6, s[12:15], s25 offen offset:0
    buffer_load_dwordx4 a[56:59], v6, s[12:15], s25 offen offset:1024
    buffer_load_dwordx4 a[60:63], v6, s[12:15], s25 offen offset:2048
    buffer_load_dwordx4 a[64:67], v6, s[12:15], s25 offen offset:3072
    buffer_load_dwordx4 a[68:71], v6, s[12:15], s26 offen
    s_add_u32 s24, s24, 4096
    s_add_u32 s25, s25, 147456
    s_add_u32 s26, s26, 147456
    s_waitcnt vmcnt(54)
    v_mfma_f32_16x16x32_bf16 v[16:19], a[88:91], a[72:75], v[16:19]
    v_mfma_f32_16x16x32_bf16 v[20:23], a[88:91], a[76:79], v[20:23]
    v_mfma_f32_16x16x32_bf16 v[24:27], a[88:91], a[80:83], v[24:27]
    v_mfma_f32_16x16x32_bf16 v[28:31], a[88:91], a[84:87], v[28:31]
    v_mfma_f32_16x16x32_bf16 v[32:35], a[92:95], a[72:75], v[32:35]
    v_mfma_f32_16x16x32_bf16 v[36:39], a[92:95], a[76:79], v[36:39]
    v_mfma_f32_16x16x32_bf16 v[40:43], a[92:95], a[80:83], v[40:43]
    v_mfma_f32_16x16x32_bf16 v[44:47], a[92:95], a[84:87], v[44:47]
    v_mfma_f32_16x16x32_bf16 v[48:51], a[96:99], a[72:75], v[48:51]
    v_mfma_f32_16x16x32_bf16 v[52:55], a[96:99], a[76:79], v[52:55]
    v_mfma_f32_16x16x32_bf16 v[56:59], a[96:99], a[80:83], v[56:59]
    v_mfma_f32_16x16x32_bf16 v[60:63], a[96:99], a[84:87], v[60:63]
    v_mfma_f32_16x16x32_bf16 v[64:67], a[100:103], a[72:75], v[64:67]
    v_mfma_f32_16x16x32_bf16 v[68:71], a[100:103], a[76:79], v[68:71]
    v_mfma_f32_16x16x32_bf16 v[72:75], a[100:103], a[80:83], v[72:75]
    v_mfma_f32_16x16x32_bf16 v[76:79], a[100:103], a[84:87], v[76:79]
    v_mfma_f32_16x16x32_bf16 v[80:83], a[104:107], a[72:75], v[80:83]
    v_mfma_f32_16x16x32_bf16 v[84:87], a[104:107], a[76:79], v[84:87]
    buffer_load_dwordx4 a[72:75], v2, s[8:11], s24 offen
    buffer_load_dwordx4 a[76:79], v3, s[8:11], s24 offen
    buffer_load_dwordx4 a[80:83], v4, s[8:11], s24 offen
    buffer_load_dwordx4 a[84:87], v5, s[8:11], s24 offen
    buffer_load_dwordx4 a[88:91], v6, s[12:15], s25 offen offset:0
    buffer_load_dwordx4 a[92:95], v6, s[12:15], s25 offen offset:1024
    buffer_load_dwordx4 a[96:99], v6, s[12:15], s25 offen offset:2048
    buffer_load_dwordx4 a[100:103], v6, s[12:15], s25 offen offset:3072
    buffer_load_dwordx4 a[104:107], v6, s[12:15], s26 offen
    s_add_u32 s24, s24, 4096
    s_add_u32 s25, s25, 147456
    s_add_u32 s26, s26, 147456
    s_waitcnt vmcnt(54)
    v_mfma_f32_16x16x32_bf16 v[16:19], a[124:127], a[108:111], v[16:19]
    v_mfma_f32_16x16x32_bf16 v[20:23], a[124:127], a[112:115], v[20:23]
    v_mfma_f32_16x16x32_bf16 v[24:27], a[124:127], a[116:119], v[24:27]
    v_mfma_f32_16x16x32_bf16 v[28:31], a[124:127], a[120:123], v[28:31]
    v_mfma_f32_16x16x32_bf16 v[32:35], a[128:131], a[108:111], v[32:35]
    v_mfma_f32_16x16x32_bf16 v[36:39], a[128:131], a[112:115], v[36:39]
    v_mfma_f32_16x16x32_bf16 v[40:43], a[128:131], a[116:119], v[40:43]
    v_mfma_f32_16x16x32_bf16 v[44:47], a[128:131], a[120:123], v[44:47]
    v_mfma_f32_16x16x32_bf16 v[48:51], a[132:135], a[108:111], v[48:51]
    v_mfma_f32_16x16x32_bf16 v[52:55], a[132:135], a[112:115], v[52:55]
    v_mfma_f32_16x16x32_bf16 v[56:59], a[132:135], a[116:119], v[56:59]
    v_mfma_f32_16x16x32_bf16 v[60:63], a[132:135], a[120:123], v[60:63]
    v_mfma_f32_16x16x32_bf16 v[64:67], a[136:139], a[108:111], v[64:67]
    v_mfma_f32_16x16x32_bf16 v[68:71], a[136:139], a[112:115], v[68:71]
    v_mfma_f32_16x16x32_bf16 v[72:75], a[136:139], a[116:119], v[72:75]
    v_mfma_f32_16x16x32_bf16 v[76:79], a[136:139], a[120:123], v[76:79]
    v_mfma_f32_16x16x32_bf16 v[80:83], a[140:143], a[108:111], v[80:83]
    v_mfma_f32_16x16x32_bf16 v[84:87], a[140:143], a[112:115], v[84:87]
    buffer_load_dwordx4 a[108:111], v2, s[8:11], s24 offen
    buffer_load_dwordx4 a[112:115], v3, s[8:11], s24 offen
    buffer_load_dwordx4 a[116:119], v4, s[8:11], s24 offen
    buffer_load_dwordx4 a[120:123], v5, s[8:11], s24 offen
    buffer_load_dwordx4 a[124:127], v6, s[12:15], s25 offen offset:0
    buffer_load_dwordx4 a[128:131], v6, s[12:15], s25 offen offset:1024
    buffer_load_dwordx4 a[132:135], v6, s[12:15], s25 offen offset:2048
    buffer_load_dwordx4 a[136:139], v6, s[12:15], s25 offen offset:3072
    buffer_load_dwordx4 a[140:143], v6, s[12:15], s26 offen
    s_add_u32 s24, s24, 4096
    s_add_u32 s25, s25, 147456
    s_add_u32 s26, s26, 147456
    s_waitcnt vmcnt(54)
    v_mfma_f32_16x16x32_bf16 v[16:19], a[160:163], a[144:147], v[16:19]
    v_mfma_f32_16x16x32_bf16 v[20:23], a[160:163], a[148:151], v[20:23]
    v_mfma_f32_16x16x32_bf16 v[24:27], a[160:163], a[152:155], v[24:27]
    v_mfma_f32_16x16x32_bf16 v[28:31], a[160:163], a[156:159], v[28:31]
    v_mfma_f32_16x16x32_bf16 v[32:35], a[164:167], a[144:147], v[32:35]
    v_mfma_f32_16x16x32_bf16 v[36:39], a[164:167], a[148:151], v[36:39]
    v_mfma_f32_16x16x32_bf16 v[40:43], a[164:167], a[152:155], v[40:43]
    v_mfma_f32_16x16x32_bf16 v[44:47], a[164:167], a[156:159], v[44:47]
    v_mfma_f32_16x16x32_bf16 v[48:51], a[168:171], a[144:147], v[48:51]
    v_mfma_f32_16x16x32_bf16 v[52:55], a[168:171], a[148:151], v[52:55]
    v_mfma_f32_16x16x32_bf16 v[56:59], a[168:171], a[152:155], v[56:59]
    v_mfma_f32_16x16x32_bf16 v[60:63], a[168:171], a[156:159], v[60:63]
    v_mfma_f32_16x16x32_bf16 v[64:67], a[172:175], a[144:147], v[64:67]
    v_mfma_f32_16x16x32_bf16 v[68:71], a[172:175], a[148:151], v[68:71]
    v_mfma_f32_16x16x32_bf16 v[72:75], a[172:175], a[152:155], v[72:75]
    v_mfma_f32_16x16x32_bf16 v[76:79], a[172:175], a[156:159], v[76:79]
    v_mfma_f32_16x16x32_bf16 v[80:83], a[176:179], a[144:147], v[80:83]
    v_mfma_f32_16x16x32_bf16 v[84:87], a[176:179], a[148:151], v[84:87]
    buffer_load_dwordx4 a[144:147], v2, s[8:11], s24 offen
    buffer_load_dwordx4 a[148:151], v3, s[8:11], s24 offen
    buffer_load_dwordx4 a[152:155], v4, s[8:11], s24 offen
    buffer_load_dwordx4 a[156:159], v5, s[8:11], s24 offen
    buffer_load_dwordx4 a[160:163], v6, s[12:15], s25 offen offset:0
    buffer_load_dwordx4 a[164:167], v6, s[12:15], s25 offen offset:1024
    buffer_load_dwordx4 a[168:171], v6, s[12:15], s25 offen offset:2048
    buffer_load_dwordx4 a[172:175], v6, s[12:15], s25 offen offset:3072
    buffer_load_dwordx4 a[176:179], v6, s[12:15], s26 offen
    s_add_u32 s24, s24, 4096
    s_add_u32 s25, s25, 147456
    s_add_u32 s26, s26, 147456
    s_waitcnt vmcnt(54)
    v_mfma_f32_16x16x32_bf16 v[16:19], a[196:199], a[180:183], v[16:19]
    v_mfma_f32_16x16x32_bf16 v[20:23], a[196:199], a[184:187], v[20:23]
    v_mfma_f32_16x16x32_bf16 v[24:27], a[196:199], a[188:191], v[24:27]
    v_mfma_f32_16x16x32_bf16 v[28:31], a[196:199], a[192:195], v[28:31]
    v_mfma_f32_16x16x32_bf16 v[32:35], a[200:203], a[180:183], v[32:35]
    v_mfma_f32_16x16x32_bf16 v[36:39], a[200:203], a[184:187], v[36:39]
    v_mfma_f32_16x16x32_bf16 v[40:43], a[200:203], a[188:191], v[40:43]
    v_mfma_f32_16x16x32_bf16 v[44:47], a[200:203], a[192:195], v[44:47]
    v_mfma_f32_16x16x32_bf16 v[48:51], a[204:207], a[180:183], v[48:51]
    v_mfma_f32_16x16x32_bf16 v[52:55], a[204:207], a[184:187], v[52:55]
    v_mfma_f32_16x16x32_bf16 v[56:59], a[204:207], a[188:191], v[56:59]
    v_mfma_f32_16x16x32_bf16 v[60:63], a[204:207], a[192:195], v[60:63]
    v_mfma_f32_16x16x32_bf16 v[64:67], a[208:211], a[180:183], v[64:67]
    v_mfma_f32_16x16x32_bf16 v[68:71], a[208:211], a[184:187], v[68:71]
    v_mfma_f32_16x16x32_bf16 v[72:75], a[208:211], a[188:191], v[72:75]
    v_mfma_f32_16x16x32_bf16 v[76:79], a[208:211], a[192:195], v[76:79]
    v_mfma_f32_16x16x32_bf16 v[80:83], a[212:215], a[180:183], v[80:83]
    v_mfma_f32_16x16x32_bf16 v[84:87], a[212:215], a[184:187], v[84:87]
    buffer_load_dwordx4 a[180:183], v2, s[8:11], s24 offen
    buffer_load_dwordx4 a[184:187], v3, s[8:11], s24 offen
    buffer_load_dwordx4 a[188:191], v4, s[8:11], s24 offen
    buffer_load_dwordx4 a[192:195], v5, s[8:11], s24 offen
    buffer_load_dwordx4 a[196:199], v6, s[12:15], s25 offen offset:0
    buffer_load_dwordx4 a[200:203], v6, s[12:15], s25 offen offset:1024
    buffer_load_dwordx4 a[204:207], v6, s[12:15], s25 offen offset:2048
    buffer_load_dwordx4 a[208:211], v6, s[12:15], s25 offen offset:3072
    buffer_load_dwordx4 a[212:215], v6, s[12:15], s26 offen
    s_add_u32 s24, s24, 4096
    s_add_u32 s25, s25, 147456
    s_add_u32 s26, s26, 147456
    s_waitcnt vmcnt(54)
    v_mfma_f32_16x16x32_bf16 v[16:19], a[232:235], a[216:219], v[16:19]
    v_mfma_f32_16x16x32_bf16 v[20:23], a[232:235], a[220:223], v[20:23]
    v_mfma_f32_16x16x32_bf16 v[24:27], a[232:235], a[224:227], v[24:27]
    v_mfma_f32_16x16x32_bf16 v[28:31], a[232:235], a[228:231], v[28:31]
    v_mfma_f32_16x16x32_bf16 v[32:35], a[236:239], a[216:219], v[32:35]
    v_mfma_f32_16x16x32_bf16 v[36:39], a[236:239], a[220:223], v[36:39]
    v_mfma_f32_16x16x32_bf16 v[40:43], a[236:239], a[224:227], v[40:43]
    v_mfma_f32_16x16x32_bf16 v[44:47], a[236:239], a[228:231], v[44:47]
    v_mfma_f32_16x16x32_bf16 v[48:51], a[240:243], a[216:219], v[48:51]
    v_mfma_f32_16x16x32_bf16 v[52:55], a[240:243], a[220:223], v[52:55]
    v_mfma_f32_16x16x32_bf16 v[56:59], a[240:243], a[224:227], v[56:59]
    v_mfma_f32_16x16x32_bf16 v[60:63], a[240:243], a[228:231], v[60:63]
    v_mfma_f32_16x16x32_bf16 v[64:67], a[244:247], a[216:219], v[64:67]
    v_mfma_f32_16x16x32_bf16 v[68:71], a[244:247], a[220:223], v[68:71]
    v_mfma_f32_16x16x32_bf16 v[72:75], a[244:247], a[224:227], v[72:75]
    v_mfma_f32_16x16x32_bf16 v[76:79], a[244:247], a[228:231], v[76:79]
    v_mfma_f32_16x16x32_bf16 v[80:83], a[248:251], a[216:219], v[80:83]
    v_mfma_f32_16x16x32_bf16 v[84:87], a[248:251], a[220:223], v[84:87]
    buffer_load_dwordx4 a[216:219], v2, s[8:11], s24 offen
    buffer_load_dwordx4 a[220:223], v3, s[8:11], s24 offen
    buffer_load_dwordx4 a[224:227], v4, s[8:11], s24 offen
    buffer_load_dwordx4 a[228:231], v5, s[8:11], s24 offen
    buffer_load_dwordx4 a[232:235], v6, s[12:15], s25 offen offset:0
    buffer_load_dwordx4 a[236:239], v6, s[12:15], s25 offen offset:1024
    buffer_load_dwordx4 a[240:243], v6, s[12:15], s25 offen offset:2048
    buffer_load_dwordx4 a[244:247], v6, s[12:15], s25 offen offset:3072
    buffer_load_dwordx4 a[248:251], v6, s[12:15], s26 offen
    s_add_u32 s24, s24, 4096
    s_add_u32 s25, s25, 147456
    s_add_u32 s26, s26, 147456
    s_waitcnt vmcnt(54)
    v_mfma_f32_16x16x32_bf16 v[16:19], a[16:19], a[0:3], v[16:19]
    v_mfma_f32_16x16x32_bf16 v[20:23], a[16:19], a[4:7], v[20:23]
    v_mfma_f32_16x16x32_bf16 v[24:27], a[16:19], a[8:11], v[24:27]
    v_mfma_f32_16x16x32_bf16 v[28:31], a[16:19], a[12:15], v[28:31]
    v_mfma_f32_16x16x32_bf16 v[32:35], a[20:23], a[0:3], v[32:35]
    v_mfma_f32_16x16x32_bf16 v[36:39], a[20:23], a[4:7], v[36:39]
    v_mfma_f32_16x16x32_bf16 v[40:43], a[20:23], a[8:11], v[40:43]
    v_mfma_f32_16x16x32_bf16 v[44:47], a[20:23], a[12:15], v[44:47]
    v_mfma_f32_16x16x32_bf16 v[48:51], a[24:27], a[0:3], v[48:51]
    v_mfma_f32_16x16x32_bf16 v[52:55], a[24:27], a[4:7], v[52:55]
    v_mfma_f32_16x16x32_bf16 v[56:59], a[24:27], a[8:11], v[56:59]
    v_mfma_f32_16x16x32_bf16 v[60:63], a[24:27], a[12:15], v[60:63]
    v_mfma_f32_16x16x32_bf16 v[64:67], a[28:31], a[0:3], v[64:67]
    v_mfma_f32_16x16x32_bf16 v[68:71], a[28:31], a[4:7], v[68:71]
    v_mfma_f32_16x16x32_bf16 v[72:75], a[28:31], a[8:11], v[72:75]
    v_mfma_f32_16x16x32_bf16 v[76:79], a[28:31], a[12:15], v[76:79]
    v_mfma_f32_16x16x32_bf16 v[80:83], a[32:35], a[0:3], v[80:83]
    v_mfma_f32_16x16x32_bf16 v[84:87], a[32:35], a[4:7], v[84:87]
    buffer_load_dwordx4 a[0:3], v2, s[8:11], s24 offen
    buffer_load_dwordx4 a[4:7], v3, s[8:11], s24 offen
    buffer_load_dwordx4 a[8:11], v4, s[8:11], s24 offen
    buffer_load_dwordx4 a[12:15], v5, s[8:11], s24 offen
    buffer_load_dwordx4 a[16:19], v6, s[12:15], s25 offen offset:0
    buffer_load_dwordx4 a[20:23], v6, s[12:15], s25 offen offset:1024
    buffer_load_dwordx4 a[24:27], v6, s[12:15], s25 offen offset:2048
    buffer_load_dwordx4 a[28:31], v6, s[12:15], s25 offen offset:3072
    buffer_load_dwordx4 a[32:35], v6, s[12:15], s26 offen
    s_add_u32 s24, s24, 4096
    s_add_u32 s25, s25, 147456
    s_add_u32 s26, s26, 147456
    s_waitcnt vmcnt(54)
    v_mfma_f32_16x16x32_bf16 v[16:19], a[52:55], a[36:39], v[16:19]
    v_mfma_f32_16x16x32_bf16 v[20:23], a[52:55], a[40:43], v[20:23]
    v_mfma_f32_16x16x32_bf16 v[24:27], a[52:55], a[44:47], v[24:27]
    v_mfma_f32_16x16x32_bf16 v[28:31], a[52:55], a[48:51], v[28:31]
    v_mfma_f32_16x16x32_bf16 v[32:35], a[56:59], a[36:39], v[32:35]
    v_mfma_f32_16x16x32_bf16 v[36:39], a[56:59], a[40:43], v[36:39]
    v_mfma_f32_16x16x32_bf16 v[40:43], a[56:59], a[44:47], v[40:43]
    v_mfma_f32_16x16x32_bf16 v[44:47], a[56:59], a[48:51], v[44:47]
    v_mfma_f32_16x16x32_bf16 v[48:51], a[60:63], a[36:39], v[48:51]
    v_mfma_f32_16x16x32_bf16 v[52:55], a[60:63], a[40:43], v[52:55]
    v_mfma_f32_16x16x32_bf16 v[56:59], a[60:63], a[44:47], v[56:59]
    v_mfma_f32_16x16x32_bf16 v[60:63], a[60:63], a[48:51], v[60:63]
    v_mfma_f32_16x16x32_bf16 v[64:67], a[64:67], a[36:39], v[64:67]
    v_mfma_f32_16x16x32_bf16 v[68:71], a[64:67], a[40:43], v[68:71]
    v_mfma_f32_16x16x32_bf16 v[72:75], a[64:67], a[44:47], v[72:75]
    v_mfma_f32_16x16x32_bf16 v[76:79], a[64:67], a[48:51], v[76:79]
    v_mfma_f32_16x16x32_bf16 v[80:83], a[68:71], a[36:39], v[80:83]
    v_mfma_f32_16x16x32_bf16 v[84:87], a[68:71], a[40:43], v[84:87]
    buffer_load_dwordx4 a[36:39], v2, s[8:11], s24 offen
    buffer_load_dwordx4 a[40:43], v3, s[8:11], s24 offen
    buffer_load_dwordx4 a[44:47], v4, s[8:11], s24 offen
    buffer_load_dwordx4 a[48:51], v5, s[8:11], s24 offen
    buffer_load_dwordx4 a[52:55], v6, s[12:15], s25 offen offset:0
    buffer_load_dwordx4 a[56:59], v6, s[12:15], s25 offen offset:1024
    buffer_load_dwordx4 a[60:63], v6, s[12:15], s25 offen offset:2048
    buffer_load_dwordx4 a[64:67], v6, s[12:15], s25 offen offset:3072
    buffer_load_dwordx4 a[68:71], v6, s[12:15], s26 offen
    s_add_u32 s24, s24, 4096
    s_add_u32 s25, s25, 147456
    s_add_u32 s26, s26, 147456
    s_waitcnt vmcnt(54)
    v_mfma_f32_16x16x32_bf16 v[16:19], a[88:91], a[72:75], v[16:19]
    v_mfma_f32_16x16x32_bf16 v[20:23], a[88:91], a[76:79], v[20:23]
    v_mfma_f32_16x16x32_bf16 v[24:27], a[88:91], a[80:83], v[24:27]
    v_mfma_f32_16x16x32_bf16 v[28:31], a[88:91], a[84:87], v[28:31]
    v_mfma_f32_16x16x32_bf16 v[32:35], a[92:95], a[72:75], v[32:35]
    v_mfma_f32_16x16x32_bf16 v[36:39], a[92:95], a[76:79], v[36:39]
    v_mfma_f32_16x16x32_bf16 v[40:43], a[92:95], a[80:83], v[40:43]
    v_mfma_f32_16x16x32_bf16 v[44:47], a[92:95], a[84:87], v[44:47]
    v_mfma_f32_16x16x32_bf16 v[48:51], a[96:99], a[72:75], v[48:51]
    v_mfma_f32_16x16x32_bf16 v[52:55], a[96:99], a[76:79], v[52:55]
    v_mfma_f32_16x16x32_bf16 v[56:59], a[96:99], a[80:83], v[56:59]
    v_mfma_f32_16x16x32_bf16 v[60:63], a[96:99], a[84:87], v[60:63]
    v_mfma_f32_16x16x32_bf16 v[64:67], a[100:103], a[72:75], v[64:67]
    v_mfma_f32_16x16x32_bf16 v[68:71], a[100:103], a[76:79], v[68:71]
    v_mfma_f32_16x16x32_bf16 v[72:75], a[100:103], a[80:83], v[72:75]
    v_mfma_f32_16x16x32_bf16 v[76:79], a[100:103], a[84:87], v[76:79]
    v_mfma_f32_16x16x32_bf16 v[80:83], a[104:107], a[72:75], v[80:83]
    v_mfma_f32_16x16x32_bf16 v[84:87], a[104:107], a[76:79], v[84:87]
    buffer_load_dwordx4 a[72:75], v2, s[8:11], s24 offen
    buffer_load_dwordx4 a[76:79], v3, s[8:11], s24 offen
    buffer_load_dwordx4 a[80:83], v4, s[8:11], s24 offen
    buffer_load_dwordx4 a[84:87], v5, s[8:11], s24 offen
    buffer_load_dwordx4 a[88:91], v6, s[12:15], s25 offen offset:0
    buffer_load_dwordx4 a[92:95], v6, s[12:15], s25 offen offset:1024
    buffer_load_dwordx4 a[96:99], v6, s[12:15], s25 offen offset:2048
    buffer_load_dwordx4 a[100:103], v6, s[12:15], s25 offen offset:3072
    buffer_load_dwordx4 a[104:107], v6, s[12:15], s26 offen
    s_add_u32 s24, s24, 4096
    s_add_u32 s25, s25, 147456
    s_add_u32 s26, s26, 147456
    s_waitcnt vmcnt(54)
    v_mfma_f32_16x16x32_bf16 v[16:19], a[124:127], a[108:111], v[16:19]
    v_mfma_f32_16x16x32_bf16 v[20:23], a[124:127], a[112:115], v[20:23]
    v_mfma_f32_16x16x32_bf16 v[24:27], a[124:127], a[116:119], v[24:27]
    v_mfma_f32_16x16x32_bf16 v[28:31], a[124:127], a[120:123], v[28:31]
    v_mfma_f32_16x16x32_bf16 v[32:35], a[128:131], a[108:111], v[32:35]
    v_mfma_f32_16x16x32_bf16 v[36:39], a[128:131], a[112:115], v[36:39]
    v_mfma_f32_16x16x32_bf16 v[40:43], a[128:131], a[116:119], v[40:43]
    v_mfma_f32_16x16x32_bf16 v[44:47], a[128:131], a[120:123], v[44:47]
    v_mfma_f32_16x16x32_bf16 v[48:51], a[132:135], a[108:111], v[48:51]
    v_mfma_f32_16x16x32_bf16 v[52:55], a[132:135], a[112:115], v[52:55]
    v_mfma_f32_16x16x32_bf16 v[56:59], a[132:135], a[116:119], v[56:59]
    v_mfma_f32_16x16x32_bf16 v[60:63], a[132:135], a[120:123], v[60:63]
    v_mfma_f32_16x16x32_bf16 v[64:67], a[136:139], a[108:111], v[64:67]
    v_mfma_f32_16x16x32_bf16 v[68:71], a[136:139], a[112:115], v[68:71]
    v_mfma_f32_16x16x32_bf16 v[72:75], a[136:139], a[116:119], v[72:75]
    v_mfma_f32_16x16x32_bf16 v[76:79], a[136:139], a[120:123], v[76:79]
    v_mfma_f32_16x16x32_bf16 v[80:83], a[140:143], a[108:111], v[80:83]
    v_mfma_f32_16x16x32_bf16 v[84:87], a[140:143], a[112:115], v[84:87]
    buffer_load_dwordx4 a[108:111], v2, s[8:11], s24 offen
    buffer_load_dwordx4 a[112:115], v3, s[8:11], s24 offen
    buffer_load_dwordx4 a[116:119], v4, s[8:11], s24 offen
    buffer_load_dwordx4 a[120:123], v5, s[8:11], s24 offen
    buffer_load_dwordx4 a[124:127], v6, s[12:15], s25 offen offset:0
    buffer_load_dwordx4 a[128:131], v6, s[12:15], s25 offen offset:1024
    buffer_load_dwordx4 a[132:135], v6, s[12:15], s25 offen offset:2048
    buffer_load_dwordx4 a[136:139], v6, s[12:15], s25 offen offset:3072
    buffer_load_dwordx4 a[140:143], v6, s[12:15], s26 offen
    s_add_u32 s24, s24, 4096
    s_add_u32 s25, s25, 147456
    s_add_u32 s26, s26, 147456
    s_waitcnt vmcnt(54)
    v_mfma_f32_16x16x32_bf16 v[16:19], a[160:163], a[144:147], v[16:19]
    v_mfma_f32_16x16x32_bf16 v[20:23], a[160:163], a[148:151], v[20:23]
    v_mfma_f32_16x16x32_bf16 v[24:27], a[160:163], a[152:155], v[24:27]
    v_mfma_f32_16x16x32_bf16 v[28:31], a[160:163], a[156:159], v[28:31]
    v_mfma_f32_16x16x32_bf16 v[32:35], a[164:167], a[144:147], v[32:35]
    v_mfma_f32_16x16x32_bf16 v[36:39], a[164:167], a[148:151], v[36:39]
    v_mfma_f32_16x16x32_bf16 v[40:43], a[164:167], a[152:155], v[40:43]
    v_mfma_f32_16x16x32_bf16 v[44:47], a[164:167], a[156:159], v[44:47]
    v_mfma_f32_16x16x32_bf16 v[48:51], a[168:171], a[144:147], v[48:51]
    v_mfma_f32_16x16x32_bf16 v[52:55], a[168:171], a[148:151], v[52:55]
    v_mfma_f32_16x16x32_bf16 v[56:59], a[168:171], a[152:155], v[56:59]
    v_mfma_f32_16x16x32_bf16 v[60:63], a[168:171], a[156:159], v[60:63]
    v_mfma_f32_16x16x32_bf16 v[64:67], a[172:175], a[144:147], v[64:67]
    v_mfma_f32_16x16x32_bf16 v[68:71], a[172:175], a[148:151], v[68:71]
    v_mfma_f32_16x16x32_bf16 v[72:75], a[172:175], a[152:155], v[72:75]
    v_mfma_f32_16x16x32_bf16 v[76:79], a[172:175], a[156:159], v[76:79]
    v_mfma_f32_16x16x32_bf16 v[80:83], a[176:179], a[144:147], v[80:83]
    v_mfma_f32_16x16x32_bf16 v[84:87], a[176:179], a[148:151], v[84:87]
    buffer_load_dwordx4 a[144:147], v2, s[8:11], s24 offen
    buffer_load_dwordx4 a[148:151], v3, s[8:11], s24 offen
    buffer_load_dwordx4 a[152:155], v4, s[8:11], s24 offen
    buffer_load_dwordx4 a[156:159], v5, s[8:11], s24 offen
    buffer_load_dwordx4 a[160:163], v6, s[12:15], s25 offen offset:0
    buffer_load_dwordx4 a[164:167], v6, s[12:15], s25 offen offset:1024
    buffer_load_dwordx4 a[168:171], v6, s[12:15], s25 offen offset:2048
    buffer_load_dwordx4 a[172:175], v6, s[12:15], s25 offen offset:3072
    buffer_load_dwordx4 a[176:179], v6, s[12:15], s26 offen
    s_add_u32 s24, s24, 4096
    s_add_u32 s25, s25, 147456
    s_add_u32 s26, s26, 147456
    s_waitcnt vmcnt(54)
    v_mfma_f32_16x16x32_bf16 v[16:19], a[196:199], a[180:183], v[16:19]
    v_mfma_f32_16x16x32_bf16 v[20:23], a[196:199], a[184:187], v[20:23]
    v_mfma_f32_16x16x32_bf16 v[24:27], a[196:199], a[188:191], v[24:27]
    v_mfma_f32_16x16x32_bf16 v[28:31], a[196:199], a[192:195], v[28:31]
    v_mfma_f32_16x16x32_bf16 v[32:35], a[200:203], a[180:183], v[32:35]
    v_mfma_f32_16x16x32_bf16 v[36:39], a[200:203], a[184:187], v[36:39]
    v_mfma_f32_16x16x32_bf16 v[40:43], a[200:203], a[188:191], v[40:43]
    v_mfma_f32_16x16x32_bf16 v[44:47], a[200:203], a[192:195], v[44:47]
    v_mfma_f32_16x16x32_bf16 v[48:51], a[204:207], a[180:183], v[48:51]
    v_mfma_f32_16x16x32_bf16 v[52:55], a[204:207], a[184:187], v[52:55]
    v_mfma_f32_16x16x32_bf16 v[56:59], a[204:207], a[188:191], v[56:59]
    v_mfma_f32_16x16x32_bf16 v[60:63], a[204:207], a[192:195], v[60:63]
    v_mfma_f32_16x16x32_bf16 v[64:67], a[208:211], a[180:183], v[64:67]
    v_mfma_f32_16x16x32_bf16 v[68:71], a[208:211], a[184:187], v[68:71]
    v_mfma_f32_16x16x32_bf16 v[72:75], a[208:211], a[188:191], v[72:75]
    v_mfma_f32_16x16x32_bf16 v[76:79], a[208:211], a[192:195], v[76:79]
    v_mfma_f32_16x16x32_bf16 v[80:83], a[212:215], a[180:183], v[80:83]
    v_mfma_f32_16x16x32_bf16 v[84:87], a[212:215], a[184:187], v[84:87]
    buffer_load_dwordx4 a[180:183], v2, s[8:11], s24 offen
    buffer_load_dwordx4 a[184:187], v3, s[8:11], s24 offen
    buffer_load_dwordx4 a[188:191], v4, s[8:11], s24 offen
    buffer_load_dwordx4 a[192:195], v5, s[8:11], s24 offen
    buffer_load_dwordx4 a[196:199], v6, s[12:15], s25 offen offset:0
    buffer_load_dwordx4 a[200:203], v6, s[12:15], s25 offen offset:1024
    buffer_load_dwordx4 a[204:207], v6, s[12:15], s25 offen offset:2048
    buffer_load_dwordx4 a[208:211], v6, s[12:15], s25 offen offset:3072
    buffer_load_dwordx4 a[212:215], v6, s[12:15], s26 offen
    s_add_u32 s24, s24, 4096
    s_add_u32 s25, s25, 147456
    s_add_u32 s26, s26, 147456
    s_waitcnt vmcnt(54)
    v_mfma_f32_16x16x32_bf16 v[16:19], a[232:235], a[216:219], v[16:19]
    v_mfma_f32_16x16x32_bf16 v[20:23], a[232:235], a[220:223], v[20:23]
    v_mfma_f32_16x16x32_bf16 v[24:27], a[232:235], a[224:227], v[24:27]
    v_mfma_f32_16x16x32_bf16 v[28:31], a[232:235], a[228:231], v[28:31]
    v_mfma_f32_16x16x32_bf16 v[32:35], a[236:239], a[216:219], v[32:35]
    v_mfma_f32_16x16x32_bf16 v[36:39], a[236:239], a[220:223], v[36:39]
    v_mfma_f32_16x16x32_bf16 v[40:43], a[236:239], a[224:227], v[40:43]
    v_mfma_f32_16x16x32_bf16 v[44:47], a[236:239], a[228:231], v[44:47]
    v_mfma_f32_16x16x32_bf16 v[48:51], a[240:243], a[216:219], v[48:51]
    v_mfma_f32_16x16x32_bf16 v[52:55], a[240:243], a[220:223], v[52:55]
    v_mfma_f32_16x16x32_bf16 v[56:59], a[240:243], a[224:227], v[56:59]
    v_mfma_f32_16x16x32_bf16 v[60:63], a[240:243], a[228:231], v[60:63]
    v_mfma_f32_16x16x32_bf16 v[64:67], a[244:247], a[216:219], v[64:67]
    v_mfma_f32_16x16x32_bf16 v[68:71], a[244:247], a[220:223], v[68:71]
    v_mfma_f32_16x16x32_bf16 v[72:75], a[244:247], a[224:227], v[72:75]
    v_mfma_f32_16x16x32_bf16 v[76:79], a[244:247], a[228:231], v[76:79]
    v_mfma_f32_16x16x32_bf16 v[80:83], a[248:251], a[216:219], v[80:83]
    v_mfma_f32_16x16x32_bf16 v[84:87], a[248:251], a[220:223], v[84:87]
    buffer_load_dwordx4 a[216:219], v2, s[8:11], s24 offen
    buffer_load_dwordx4 a[220:223], v3, s[8:11], s24 offen
    buffer_load_dwordx4 a[224:227], v4, s[8:11], s24 offen
    buffer_load_dwordx4 a[228:231], v5, s[8:11], s24 offen
    buffer_load_dwordx4 a[232:235], v6, s[12:15], s25 offen offset:0
    buffer_load_dwordx4 a[236:239], v6, s[12:15], s25 offen offset:1024
    buffer_load_dwordx4 a[240:243], v6, s[12:15], s25 offen offset:2048
    buffer_load_dwordx4 a[244:247], v6, s[12:15], s25 offen offset:3072
    buffer_load_dwordx4 a[248:251], v6, s[12:15], s26 offen
    s_add_u32 s24, s24, 4096
    s_add_u32 s25, s25, 147456
    s_add_u32 s26, s26, 147456
    s_waitcnt vmcnt(54)
    v_mfma_f32_16x16x32_bf16 v[16:19], a[16:19], a[0:3], v[16:19]
    v_mfma_f32_16x16x32_bf16 v[20:23], a[16:19], a[4:7], v[20:23]
    v_mfma_f32_16x16x32_bf16 v[24:27], a[16:19], a[8:11], v[24:27]
    v_mfma_f32_16x16x32_bf16 v[28:31], a[16:19], a[12:15], v[28:31]
    v_mfma_f32_16x16x32_bf16 v[32:35], a[20:23], a[0:3], v[32:35]
    v_mfma_f32_16x16x32_bf16 v[36:39], a[20:23], a[4:7], v[36:39]
    v_mfma_f32_16x16x32_bf16 v[40:43], a[20:23], a[8:11], v[40:43]
    v_mfma_f32_16x16x32_bf16 v[44:47], a[20:23], a[12:15], v[44:47]
    v_mfma_f32_16x16x32_bf16 v[48:51], a[24:27], a[0:3], v[48:51]
    v_mfma_f32_16x16x32_bf16 v[52:55], a[24:27], a[4:7], v[52:55]
    v_mfma_f32_16x16x32_bf16 v[56:59], a[24:27], a[8:11], v[56:59]
    v_mfma_f32_16x16x32_bf16 v[60:63], a[24:27], a[12:15], v[60:63]
    v_mfma_f32_16x16x32_bf16 v[64:67], a[28:31], a[0:3], v[64:67]
    v_mfma_f32_16x16x32_bf16 v[68:71], a[28:31], a[4:7], v[68:71]
    v_mfma_f32_16x16x32_bf16 v[72:75], a[28:31], a[8:11], v[72:75]
    v_mfma_f32_16x16x32_bf16 v[76:79], a[28:31], a[12:15], v[76:79]
    v_mfma_f32_16x16x32_bf16 v[80:83], a[32:35], a[0:3], v[80:83]
    v_mfma_f32_16x16x32_bf16 v[84:87], a[32:35], a[4:7], v[84:87]
    buffer_load_dwordx4 a[0:3], v2, s[8:11], s24 offen
    buffer_load_dwordx4 a[4:7], v3, s[8:11], s24 offen
    buffer_load_dwordx4 a[8:11], v4, s[8:11], s24 offen
    buffer_load_dwordx4 a[12:15], v5, s[8:11], s24 offen
    buffer_load_dwordx4 a[16:19], v6, s[12:15], s25 offen offset:0
    buffer_load_dwordx4 a[20:23], v6, s[12:15], s25 offen offset:1024
    buffer_load_dwordx4 a[24:27], v6, s[12:15], s25 offen offset:2048
    buffer_load_dwordx4 a[28:31], v6, s[12:15], s25 offen offset:3072
    buffer_load_dwordx4 a[32:35], v6, s[12:15], s26 offen
    s_add_u32 s24, s24, 4096
    s_add_u32 s25, s25, 147456
    s_add_u32 s26, s26, 147456
    s_waitcnt vmcnt(54)
    v_mfma_f32_16x16x32_bf16 v[16:19], a[52:55], a[36:39], v[16:19]
    v_mfma_f32_16x16x32_bf16 v[20:23], a[52:55], a[40:43], v[20:23]
    v_mfma_f32_16x16x32_bf16 v[24:27], a[52:55], a[44:47], v[24:27]
    v_mfma_f32_16x16x32_bf16 v[28:31], a[52:55], a[48:51], v[28:31]
    v_mfma_f32_16x16x32_bf16 v[32:35], a[56:59], a[36:39], v[32:35]
    v_mfma_f32_16x16x32_bf16 v[36:39], a[56:59], a[40:43], v[36:39]
    v_mfma_f32_16x16x32_bf16 v[40:43], a[56:59], a[44:47], v[40:43]
    v_mfma_f32_16x16x32_bf16 v[44:47], a[56:59], a[48:51], v[44:47]
    v_mfma_f32_16x16x32_bf16 v[48:51], a[60:63], a[36:39], v[48:51]
    v_mfma_f32_16x16x32_bf16 v[52:55], a[60:63], a[40:43], v[52:55]
    v_mfma_f32_16x16x32_bf16 v[56:59], a[60:63], a[44:47], v[56:59]
    v_mfma_f32_16x16x32_bf16 v[60:63], a[60:63], a[48:51], v[60:63]
    v_mfma_f32_16x16x32_bf16 v[64:67], a[64:67], a[36:39], v[64:67]
    v_mfma_f32_16x16x32_bf16 v[68:71], a[64:67], a[40:43], v[68:71]
    v_mfma_f32_16x16x32_bf16 v[72:75], a[64:67], a[44:47], v[72:75]
    v_mfma_f32_16x16x32_bf16 v[76:79], a[64:67], a[48:51], v[76:79]
    v_mfma_f32_16x16x32_bf16 v[80:83], a[68:71], a[36:39], v[80:83]
    v_mfma_f32_16x16x32_bf16 v[84:87], a[68:71], a[40:43], v[84:87]
    buffer_load_dwordx4 a[36:39], v2, s[8:11], s24 offen
    buffer_load_dwordx4 a[40:43], v3, s[8:11], s24 offen
    buffer_load_dwordx4 a[44:47], v4, s[8:11], s24 offen
    buffer_load_dwordx4 a[48:51], v5, s[8:11], s24 offen
    buffer_load_dwordx4 a[52:55], v6, s[12:15], s25 offen offset:0
    buffer_load_dwordx4 a[56:59], v6, s[12:15], s25 offen offset:1024
    buffer_load_dwordx4 a[60:63], v6, s[12:15], s25 offen offset:2048
    buffer_load_dwordx4 a[64:67], v6, s[12:15], s25 offen offset:3072
    buffer_load_dwordx4 a[68:71], v6, s[12:15], s26 offen
    s_add_u32 s24, s24, 4096
    s_add_u32 s25, s25, 147456
    s_add_u32 s26, s26, 147456
    s_waitcnt vmcnt(54)
    v_mfma_f32_16x16x32_bf16 v[16:19], a[88:91], a[72:75], v[16:19]
    v_mfma_f32_16x16x32_bf16 v[20:23], a[88:91], a[76:79], v[20:23]
    v_mfma_f32_16x16x32_bf16 v[24:27], a[88:91], a[80:83], v[24:27]
    v_mfma_f32_16x16x32_bf16 v[28:31], a[88:91], a[84:87], v[28:31]
    v_mfma_f32_16x16x32_bf16 v[32:35], a[92:95], a[72:75], v[32:35]
    v_mfma_f32_16x16x32_bf16 v[36:39], a[92:95], a[76:79], v[36:39]
    v_mfma_f32_16x16x32_bf16 v[40:43], a[92:95], a[80:83], v[40:43]
    v_mfma_f32_16x16x32_bf16 v[44:47], a[92:95], a[84:87], v[44:47]
    v_mfma_f32_16x16x32_bf16 v[48:51], a[96:99], a[72:75], v[48:51]
    v_mfma_f32_16x16x32_bf16 v[52:55], a[96:99], a[76:79], v[52:55]
    v_mfma_f32_16x16x32_bf16 v[56:59], a[96:99], a[80:83], v[56:59]
    v_mfma_f32_16x16x32_bf16 v[60:63], a[96:99], a[84:87], v[60:63]
    v_mfma_f32_16x16x32_bf16 v[64:67], a[100:103], a[72:75], v[64:67]
    v_mfma_f32_16x16x32_bf16 v[68:71], a[100:103], a[76:79], v[68:71]
    v_mfma_f32_16x16x32_bf16 v[72:75], a[100:103], a[80:83], v[72:75]
    v_mfma_f32_16x16x32_bf16 v[76:79], a[100:103], a[84:87], v[76:79]
    v_mfma_f32_16x16x32_bf16 v[80:83], a[104:107], a[72:75], v[80:83]
    v_mfma_f32_16x16x32_bf16 v[84:87], a[104:107], a[76:79], v[84:87]
    buffer_load_dwordx4 a[72:75], v2, s[8:11], s24 offen
    buffer_load_dwordx4 a[76:79], v3, s[8:11], s24 offen
    buffer_load_dwordx4 a[80:83], v4, s[8:11], s24 offen
    buffer_load_dwordx4 a[84:87], v5, s[8:11], s24 offen
    buffer_load_dwordx4 a[88:91], v6, s[12:15], s25 offen offset:0
    buffer_load_dwordx4 a[92:95], v6, s[12:15], s25 offen offset:1024
    buffer_load_dwordx4 a[96:99], v6, s[12:15], s25 offen offset:2048
    buffer_load_dwordx4 a[100:103], v6, s[12:15], s25 offen offset:3072
    buffer_load_dwordx4 a[104:107], v6, s[12:15], s26 offen
    s_add_u32 s24, s24, 4096
    s_add_u32 s25, s25, 147456
    s_add_u32 s26, s26, 147456
    s_waitcnt vmcnt(54)
    v_mfma_f32_16x16x32_bf16 v[16:19], a[124:127], a[108:111], v[16:19]
    v_mfma_f32_16x16x32_bf16 v[20:23], a[124:127], a[112:115], v[20:23]
    v_mfma_f32_16x16x32_bf16 v[24:27], a[124:127], a[116:119], v[24:27]
    v_mfma_f32_16x16x32_bf16 v[28:31], a[124:127], a[120:123], v[28:31]
    v_mfma_f32_16x16x32_bf16 v[32:35], a[128:131], a[108:111], v[32:35]
    v_mfma_f32_16x16x32_bf16 v[36:39], a[128:131], a[112:115], v[36:39]
    v_mfma_f32_16x16x32_bf16 v[40:43], a[128:131], a[116:119], v[40:43]
    v_mfma_f32_16x16x32_bf16 v[44:47], a[128:131], a[120:123], v[44:47]
    v_mfma_f32_16x16x32_bf16 v[48:51], a[132:135], a[108:111], v[48:51]
    v_mfma_f32_16x16x32_bf16 v[52:55], a[132:135], a[112:115], v[52:55]
    v_mfma_f32_16x16x32_bf16 v[56:59], a[132:135], a[116:119], v[56:59]
    v_mfma_f32_16x16x32_bf16 v[60:63], a[132:135], a[120:123], v[60:63]
    v_mfma_f32_16x16x32_bf16 v[64:67], a[136:139], a[108:111], v[64:67]
    v_mfma_f32_16x16x32_bf16 v[68:71], a[136:139], a[112:115], v[68:71]
    v_mfma_f32_16x16x32_bf16 v[72:75], a[136:139], a[116:119], v[72:75]
    v_mfma_f32_16x16x32_bf16 v[76:79], a[136:139], a[120:123], v[76:79]
    v_mfma_f32_16x16x32_bf16 v[80:83], a[140:143], a[108:111], v[80:83]
    v_mfma_f32_16x16x32_bf16 v[84:87], a[140:143], a[112:115], v[84:87]
    buffer_load_dwordx4 a[108:111], v2, s[8:11], s24 offen
    buffer_load_dwordx4 a[112:115], v3, s[8:11], s24 offen
    buffer_load_dwordx4 a[116:119], v4, s[8:11], s24 offen
    buffer_load_dwordx4 a[120:123], v5, s[8:11], s24 offen
    buffer_load_dwordx4 a[124:127], v6, s[12:15], s25 offen offset:0
    buffer_load_dwordx4 a[128:131], v6, s[12:15], s25 offen offset:1024
    buffer_load_dwordx4 a[132:135], v6, s[12:15], s25 offen offset:2048
    buffer_load_dwordx4 a[136:139], v6, s[12:15], s25 offen offset:3072
    buffer_load_dwordx4 a[140:143], v6, s[12:15], s26 offen
    s_add_u32 s24, s24, 4096
    s_add_u32 s25, s25, 147456
    s_add_u32 s26, s26, 147456
    s_waitcnt vmcnt(54)
    v_mfma_f32_16x16x32_bf16 v[16:19], a[160:163], a[144:147], v[16:19]
    v_mfma_f32_16x16x32_bf16 v[20:23], a[160:163], a[148:151], v[20:23]
    v_mfma_f32_16x16x32_bf16 v[24:27], a[160:163], a[152:155], v[24:27]
    v_mfma_f32_16x16x32_bf16 v[28:31], a[160:163], a[156:159], v[28:31]
    v_mfma_f32_16x16x32_bf16 v[32:35], a[164:167], a[144:147], v[32:35]
    v_mfma_f32_16x16x32_bf16 v[36:39], a[164:167], a[148:151], v[36:39]
    v_mfma_f32_16x16x32_bf16 v[40:43], a[164:167], a[152:155], v[40:43]
    v_mfma_f32_16x16x32_bf16 v[44:47], a[164:167], a[156:159], v[44:47]
    v_mfma_f32_16x16x32_bf16 v[48:51], a[168:171], a[144:147], v[48:51]
    v_mfma_f32_16x16x32_bf16 v[52:55], a[168:171], a[148:151], v[52:55]
    v_mfma_f32_16x16x32_bf16 v[56:59], a[168:171], a[152:155], v[56:59]
    v_mfma_f32_16x16x32_bf16 v[60:63], a[168:171], a[156:159], v[60:63]
    v_mfma_f32_16x16x32_bf16 v[64:67], a[172:175], a[144:147], v[64:67]
    v_mfma_f32_16x16x32_bf16 v[68:71], a[172:175], a[148:151], v[68:71]
    v_mfma_f32_16x16x32_bf16 v[72:75], a[172:175], a[152:155], v[72:75]
    v_mfma_f32_16x16x32_bf16 v[76:79], a[172:175], a[156:159], v[76:79]
    v_mfma_f32_16x16x32_bf16 v[80:83], a[176:179], a[144:147], v[80:83]
    v_mfma_f32_16x16x32_bf16 v[84:87], a[176:179], a[148:151], v[84:87]
    buffer_load_dwordx4 a[144:147], v2, s[8:11], s24 offen
    buffer_load_dwordx4 a[148:151], v3, s[8:11], s24 offen
    buffer_load_dwordx4 a[152:155], v4, s[8:11], s24 offen
    buffer_load_dwordx4 a[156:159], v5, s[8:11], s24 offen
    buffer_load_dwordx4 a[160:163], v6, s[12:15], s25 offen offset:0
    buffer_load_dwordx4 a[164:167], v6, s[12:15], s25 offen offset:1024
    buffer_load_dwordx4 a[168:171], v6, s[12:15], s25 offen offset:2048
    buffer_load_dwordx4 a[172:175], v6, s[12:15], s25 offen offset:3072
    buffer_load_dwordx4 a[176:179], v6, s[12:15], s26 offen
    s_add_u32 s24, s24, 4096
    s_add_u32 s25, s25, 147456
    s_add_u32 s26, s26, 147456
    s_waitcnt vmcnt(54)
    v_mfma_f32_16x16x32_bf16 v[16:19], a[196:199], a[180:183], v[16:19]
    v_mfma_f32_16x16x32_bf16 v[20:23], a[196:199], a[184:187], v[20:23]
    v_mfma_f32_16x16x32_bf16 v[24:27], a[196:199], a[188:191], v[24:27]
    v_mfma_f32_16x16x32_bf16 v[28:31], a[196:199], a[192:195], v[28:31]
    v_mfma_f32_16x16x32_bf16 v[32:35], a[200:203], a[180:183], v[32:35]
    v_mfma_f32_16x16x32_bf16 v[36:39], a[200:203], a[184:187], v[36:39]
    v_mfma_f32_16x16x32_bf16 v[40:43], a[200:203], a[188:191], v[40:43]
    v_mfma_f32_16x16x32_bf16 v[44:47], a[200:203], a[192:195], v[44:47]
    v_mfma_f32_16x16x32_bf16 v[48:51], a[204:207], a[180:183], v[48:51]
    v_mfma_f32_16x16x32_bf16 v[52:55], a[204:207], a[184:187], v[52:55]
    v_mfma_f32_16x16x32_bf16 v[56:59], a[204:207], a[188:191], v[56:59]
    v_mfma_f32_16x16x32_bf16 v[60:63], a[204:207], a[192:195], v[60:63]
    v_mfma_f32_16x16x32_bf16 v[64:67], a[208:211], a[180:183], v[64:67]
    v_mfma_f32_16x16x32_bf16 v[68:71], a[208:211], a[184:187], v[68:71]
    v_mfma_f32_16x16x32_bf16 v[72:75], a[208:211], a[188:191], v[72:75]
    v_mfma_f32_16x16x32_bf16 v[76:79], a[208:211], a[192:195], v[76:79]
    v_mfma_f32_16x16x32_bf16 v[80:83], a[212:215], a[180:183], v[80:83]
    v_mfma_f32_16x16x32_bf16 v[84:87], a[212:215], a[184:187], v[84:87]
    buffer_load_dwordx4 a[180:183], v2, s[8:11], s24 offen
    buffer_load_dwordx4 a[184:187], v3, s[8:11], s24 offen
    buffer_load_dwordx4 a[188:191], v4, s[8:11], s24 offen
    buffer_load_dwordx4 a[192:195], v5, s[8:11], s24 offen
    buffer_load_dwordx4 a[196:199], v6, s[12:15], s25 offen offset:0
    buffer_load_dwordx4 a[200:203], v6, s[12:15], s25 offen offset:1024
    buffer_load_dwordx4 a[204:207], v6, s[12:15], s25 offen offset:2048
    buffer_load_dwordx4 a[208:211], v6, s[12:15], s25 offen offset:3072
    buffer_load_dwordx4 a[212:215], v6, s[12:15], s26 offen
    s_add_u32 s24, s24, 4096
    s_add_u32 s25, s25, 147456
    s_add_u32 s26, s26, 147456
    s_waitcnt vmcnt(54)
    v_mfma_f32_16x16x32_bf16 v[16:19], a[232:235], a[216:219], v[16:19]
    v_mfma_f32_16x16x32_bf16 v[20:23], a[232:235], a[220:223], v[20:23]
    v_mfma_f32_16x16x32_bf16 v[24:27], a[232:235], a[224:227], v[24:27]
    v_mfma_f32_16x16x32_bf16 v[28:31], a[232:235], a[228:231], v[28:31]
    v_mfma_f32_16x16x32_bf16 v[32:35], a[236:239], a[216:219], v[32:35]
    v_mfma_f32_16x16x32_bf16 v[36:39], a[236:239], a[220:223], v[36:39]
    v_mfma_f32_16x16x32_bf16 v[40:43], a[236:239], a[224:227], v[40:43]
    v_mfma_f32_16x16x32_bf16 v[44:47], a[236:239], a[228:231], v[44:47]
    v_mfma_f32_16x16x32_bf16 v[48:51], a[240:243], a[216:219], v[48:51]
    v_mfma_f32_16x16x32_bf16 v[52:55], a[240:243], a[220:223], v[52:55]
    v_mfma_f32_16x16x32_bf16 v[56:59], a[240:243], a[224:227], v[56:59]
    v_mfma_f32_16x16x32_bf16 v[60:63], a[240:243], a[228:231], v[60:63]
    v_mfma_f32_16x16x32_bf16 v[64:67], a[244:247], a[216:219], v[64:67]
    v_mfma_f32_16x16x32_bf16 v[68:71], a[244:247], a[220:223], v[68:71]
    v_mfma_f32_16x16x32_bf16 v[72:75], a[244:247], a[224:227], v[72:75]
    v_mfma_f32_16x16x32_bf16 v[76:79], a[244:247], a[228:231], v[76:79]
    v_mfma_f32_16x16x32_bf16 v[80:83], a[248:251], a[216:219], v[80:83]
    v_mfma_f32_16x16x32_bf16 v[84:87], a[248:251], a[220:223], v[84:87]
    buffer_load_dwordx4 a[216:219], v2, s[8:11], s24 offen
    buffer_load_dwordx4 a[220:223], v3, s[8:11], s24 offen
    buffer_load_dwordx4 a[224:227], v4, s[8:11], s24 offen
    buffer_load_dwordx4 a[228:231], v5, s[8:11], s24 offen
    buffer_load_dwordx4 a[232:235], v6, s[12:15], s25 offen offset:0
    buffer_load_dwordx4 a[236:239], v6, s[12:15], s25 offen offset:1024
    buffer_load_dwordx4 a[240:243], v6, s[12:15], s25 offen offset:2048
    buffer_load_dwordx4 a[244:247], v6, s[12:15], s25 offen offset:3072
    buffer_load_dwordx4 a[248:251], v6, s[12:15], s26 offen
    s_add_u32 s24, s24, 4096
    s_add_u32 s25, s25, 147456
    s_add_u32 s26, s26, 147456
    s_waitcnt vmcnt(54)
    v_mfma_f32_16x16x32_bf16 v[16:19], a[16:19], a[0:3], v[16:19]
    v_mfma_f32_16x16x32_bf16 v[20:23], a[16:19], a[4:7], v[20:23]
    v_mfma_f32_16x16x32_bf16 v[24:27], a[16:19], a[8:11], v[24:27]
    v_mfma_f32_16x16x32_bf16 v[28:31], a[16:19], a[12:15], v[28:31]
    v_mfma_f32_16x16x32_bf16 v[32:35], a[20:23], a[0:3], v[32:35]
    v_mfma_f32_16x16x32_bf16 v[36:39], a[20:23], a[4:7], v[36:39]
    v_mfma_f32_16x16x32_bf16 v[40:43], a[20:23], a[8:11], v[40:43]
    v_mfma_f32_16x16x32_bf16 v[44:47], a[20:23], a[12:15], v[44:47]
    v_mfma_f32_16x16x32_bf16 v[48:51], a[24:27], a[0:3], v[48:51]
    v_mfma_f32_16x16x32_bf16 v[52:55], a[24:27], a[4:7], v[52:55]
    v_mfma_f32_16x16x32_bf16 v[56:59], a[24:27], a[8:11], v[56:59]
    v_mfma_f32_16x16x32_bf16 v[60:63], a[24:27], a[12:15], v[60:63]
    v_mfma_f32_16x16x32_bf16 v[64:67], a[28:31], a[0:3], v[64:67]
    v_mfma_f32_16x16x32_bf16 v[68:71], a[28:31], a[4:7], v[68:71]
    v_mfma_f32_16x16x32_bf16 v[72:75], a[28:31], a[8:11], v[72:75]
    v_mfma_f32_16x16x32_bf16 v[76:79], a[28:31], a[12:15], v[76:79]
    v_mfma_f32_16x16x32_bf16 v[80:83], a[32:35], a[0:3], v[80:83]
    v_mfma_f32_16x16x32_bf16 v[84:87], a[32:35], a[4:7], v[84:87]
    buffer_load_dwordx4 a[0:3], v2, s[8:11], s24 offen
    buffer_load_dwordx4 a[4:7], v3, s[8:11], s24 offen
    buffer_load_dwordx4 a[8:11], v4, s[8:11], s24 offen
    buffer_load_dwordx4 a[12:15], v5, s[8:11], s24 offen
    buffer_load_dwordx4 a[16:19], v6, s[12:15], s25 offen offset:0
    buffer_load_dwordx4 a[20:23], v6, s[12:15], s25 offen offset:1024
    buffer_load_dwordx4 a[24:27], v6, s[12:15], s25 offen offset:2048
    buffer_load_dwordx4 a[28:31], v6, s[12:15], s25 offen offset:3072
    buffer_load_dwordx4 a[32:35], v6, s[12:15], s26 offen
    s_add_u32 s24, s24, 4096
    s_add_u32 s25, s25, 147456
    s_add_u32 s26, s26, 147456
    s_waitcnt vmcnt(54)
    v_mfma_f32_16x16x32_bf16 v[16:19], a[52:55], a[36:39], v[16:19]
    v_mfma_f32_16x16x32_bf16 v[20:23], a[52:55], a[40:43], v[20:23]
    v_mfma_f32_16x16x32_bf16 v[24:27], a[52:55], a[44:47], v[24:27]
    v_mfma_f32_16x16x32_bf16 v[28:31], a[52:55], a[48:51], v[28:31]
    v_mfma_f32_16x16x32_bf16 v[32:35], a[56:59], a[36:39], v[32:35]
    v_mfma_f32_16x16x32_bf16 v[36:39], a[56:59], a[40:43], v[36:39]
    v_mfma_f32_16x16x32_bf16 v[40:43], a[56:59], a[44:47], v[40:43]
    v_mfma_f32_16x16x32_bf16 v[44:47], a[56:59], a[48:51], v[44:47]
    v_mfma_f32_16x16x32_bf16 v[48:51], a[60:63], a[36:39], v[48:51]
    v_mfma_f32_16x16x32_bf16 v[52:55], a[60:63], a[40:43], v[52:55]
    v_mfma_f32_16x16x32_bf16 v[56:59], a[60:63], a[44:47], v[56:59]
    v_mfma_f32_16x16x32_bf16 v[60:63], a[60:63], a[48:51], v[60:63]
    v_mfma_f32_16x16x32_bf16 v[64:67], a[64:67], a[36:39], v[64:67]
    v_mfma_f32_16x16x32_bf16 v[68:71], a[64:67], a[40:43], v[68:71]
    v_mfma_f32_16x16x32_bf16 v[72:75], a[64:67], a[44:47], v[72:75]
    v_mfma_f32_16x16x32_bf16 v[76:79], a[64:67], a[48:51], v[76:79]
    v_mfma_f32_16x16x32_bf16 v[80:83], a[68:71], a[36:39], v[80:83]
    v_mfma_f32_16x16x32_bf16 v[84:87], a[68:71], a[40:43], v[84:87]
    buffer_load_dwordx4 a[36:39], v2, s[8:11], s24 offen
    buffer_load_dwordx4 a[40:43], v3, s[8:11], s24 offen
    buffer_load_dwordx4 a[44:47], v4, s[8:11], s24 offen
    buffer_load_dwordx4 a[48:51], v5, s[8:11], s24 offen
    buffer_load_dwordx4 a[52:55], v6, s[12:15], s25 offen offset:0
    buffer_load_dwordx4 a[56:59], v6, s[12:15], s25 offen offset:1024
    buffer_load_dwordx4 a[60:63], v6, s[12:15], s25 offen offset:2048
    buffer_load_dwordx4 a[64:67], v6, s[12:15], s25 offen offset:3072
    buffer_load_dwordx4 a[68:71], v6, s[12:15], s26 offen
    s_add_u32 s24, s24, 4096
    s_add_u32 s25, s25, 147456
    s_add_u32 s26, s26, 147456
    s_waitcnt vmcnt(54)
    v_mfma_f32_16x16x32_bf16 v[16:19], a[88:91], a[72:75], v[16:19]
    v_mfma_f32_16x16x32_bf16 v[20:23], a[88:91], a[76:79], v[20:23]
    v_mfma_f32_16x16x32_bf16 v[24:27], a[88:91], a[80:83], v[24:27]
    v_mfma_f32_16x16x32_bf16 v[28:31], a[88:91], a[84:87], v[28:31]
    v_mfma_f32_16x16x32_bf16 v[32:35], a[92:95], a[72:75], v[32:35]
    v_mfma_f32_16x16x32_bf16 v[36:39], a[92:95], a[76:79], v[36:39]
    v_mfma_f32_16x16x32_bf16 v[40:43], a[92:95], a[80:83], v[40:43]
    v_mfma_f32_16x16x32_bf16 v[44:47], a[92:95], a[84:87], v[44:47]
    v_mfma_f32_16x16x32_bf16 v[48:51], a[96:99], a[72:75], v[48:51]
    v_mfma_f32_16x16x32_bf16 v[52:55], a[96:99], a[76:79], v[52:55]
    v_mfma_f32_16x16x32_bf16 v[56:59], a[96:99], a[80:83], v[56:59]
    v_mfma_f32_16x16x32_bf16 v[60:63], a[96:99], a[84:87], v[60:63]
    v_mfma_f32_16x16x32_bf16 v[64:67], a[100:103], a[72:75], v[64:67]
    v_mfma_f32_16x16x32_bf16 v[68:71], a[100:103], a[76:79], v[68:71]
    v_mfma_f32_16x16x32_bf16 v[72:75], a[100:103], a[80:83], v[72:75]
    v_mfma_f32_16x16x32_bf16 v[76:79], a[100:103], a[84:87], v[76:79]
    v_mfma_f32_16x16x32_bf16 v[80:83], a[104:107], a[72:75], v[80:83]
    v_mfma_f32_16x16x32_bf16 v[84:87], a[104:107], a[76:79], v[84:87]
    buffer_load_dwordx4 a[72:75], v2, s[8:11], s24 offen
    buffer_load_dwordx4 a[76:79], v3, s[8:11], s24 offen
    buffer_load_dwordx4 a[80:83], v4, s[8:11], s24 offen
    buffer_load_dwordx4 a[84:87], v5, s[8:11], s24 offen
    buffer_load_dwordx4 a[88:91], v6, s[12:15], s25 offen offset:0
    buffer_load_dwordx4 a[92:95], v6, s[12:15], s25 offen offset:1024
    buffer_load_dwordx4 a[96:99], v6, s[12:15], s25 offen offset:2048
    buffer_load_dwordx4 a[100:103], v6, s[12:15], s25 offen offset:3072
    buffer_load_dwordx4 a[104:107], v6, s[12:15], s26 offen
    s_add_u32 s24, s24, 4096
    s_add_u32 s25, s25, 147456
    s_add_u32 s26, s26, 147456
    s_waitcnt vmcnt(54)
    v_mfma_f32_16x16x32_bf16 v[16:19], a[124:127], a[108:111], v[16:19]
    v_mfma_f32_16x16x32_bf16 v[20:23], a[124:127], a[112:115], v[20:23]
    v_mfma_f32_16x16x32_bf16 v[24:27], a[124:127], a[116:119], v[24:27]
    v_mfma_f32_16x16x32_bf16 v[28:31], a[124:127], a[120:123], v[28:31]
    v_mfma_f32_16x16x32_bf16 v[32:35], a[128:131], a[108:111], v[32:35]
    v_mfma_f32_16x16x32_bf16 v[36:39], a[128:131], a[112:115], v[36:39]
    v_mfma_f32_16x16x32_bf16 v[40:43], a[128:131], a[116:119], v[40:43]
    v_mfma_f32_16x16x32_bf16 v[44:47], a[128:131], a[120:123], v[44:47]
    v_mfma_f32_16x16x32_bf16 v[48:51], a[132:135], a[108:111], v[48:51]
    v_mfma_f32_16x16x32_bf16 v[52:55], a[132:135], a[112:115], v[52:55]
    v_mfma_f32_16x16x32_bf16 v[56:59], a[132:135], a[116:119], v[56:59]
    v_mfma_f32_16x16x32_bf16 v[60:63], a[132:135], a[120:123], v[60:63]
    v_mfma_f32_16x16x32_bf16 v[64:67], a[136:139], a[108:111], v[64:67]
    v_mfma_f32_16x16x32_bf16 v[68:71], a[136:139], a[112:115], v[68:71]
    v_mfma_f32_16x16x32_bf16 v[72:75], a[136:139], a[116:119], v[72:75]
    v_mfma_f32_16x16x32_bf16 v[76:79], a[136:139], a[120:123], v[76:79]
    v_mfma_f32_16x16x32_bf16 v[80:83], a[140:143], a[108:111], v[80:83]
    v_mfma_f32_16x16x32_bf16 v[84:87], a[140:143], a[112:115], v[84:87]
    buffer_load_dwordx4 a[108:111], v2, s[8:11], s24 offen
    buffer_load_dwordx4 a[112:115], v3, s[8:11], s24 offen
    buffer_load_dwordx4 a[116:119], v4, s[8:11], s24 offen
    buffer_load_dwordx4 a[120:123], v5, s[8:11], s24 offen
    buffer_load_dwordx4 a[124:127], v6, s[12:15], s25 offen offset:0
    buffer_load_dwordx4 a[128:131], v6, s[12:15], s25 offen offset:1024
    buffer_load_dwordx4 a[132:135], v6, s[12:15], s25 offen offset:2048
    buffer_load_dwordx4 a[136:139], v6, s[12:15], s25 offen offset:3072
    buffer_load_dwordx4 a[140:143], v6, s[12:15], s26 offen
    s_add_u32 s24, s24, 4096
    s_add_u32 s25, s25, 147456
    s_add_u32 s26, s26, 147456
    s_waitcnt vmcnt(54)
    v_mfma_f32_16x16x32_bf16 v[16:19], a[160:163], a[144:147], v[16:19]
    v_mfma_f32_16x16x32_bf16 v[20:23], a[160:163], a[148:151], v[20:23]
    v_mfma_f32_16x16x32_bf16 v[24:27], a[160:163], a[152:155], v[24:27]
    v_mfma_f32_16x16x32_bf16 v[28:31], a[160:163], a[156:159], v[28:31]
    v_mfma_f32_16x16x32_bf16 v[32:35], a[164:167], a[144:147], v[32:35]
    v_mfma_f32_16x16x32_bf16 v[36:39], a[164:167], a[148:151], v[36:39]
    v_mfma_f32_16x16x32_bf16 v[40:43], a[164:167], a[152:155], v[40:43]
    v_mfma_f32_16x16x32_bf16 v[44:47], a[164:167], a[156:159], v[44:47]
    v_mfma_f32_16x16x32_bf16 v[48:51], a[168:171], a[144:147], v[48:51]
    v_mfma_f32_16x16x32_bf16 v[52:55], a[168:171], a[148:151], v[52:55]
    v_mfma_f32_16x16x32_bf16 v[56:59], a[168:171], a[152:155], v[56:59]
    v_mfma_f32_16x16x32_bf16 v[60:63], a[168:171], a[156:159], v[60:63]
    v_mfma_f32_16x16x32_bf16 v[64:67], a[172:175], a[144:147], v[64:67]
    v_mfma_f32_16x16x32_bf16 v[68:71], a[172:175], a[148:151], v[68:71]
    v_mfma_f32_16x16x32_bf16 v[72:75], a[172:175], a[152:155], v[72:75]
    v_mfma_f32_16x16x32_bf16 v[76:79], a[172:175], a[156:159], v[76:79]
    v_mfma_f32_16x16x32_bf16 v[80:83], a[176:179], a[144:147], v[80:83]
    v_mfma_f32_16x16x32_bf16 v[84:87], a[176:179], a[148:151], v[84:87]
    buffer_load_dwordx4 a[144:147], v2, s[8:11], s24 offen
    buffer_load_dwordx4 a[148:151], v3, s[8:11], s24 offen
    buffer_load_dwordx4 a[152:155], v4, s[8:11], s24 offen
    buffer_load_dwordx4 a[156:159], v5, s[8:11], s24 offen
    buffer_load_dwordx4 a[160:163], v6, s[12:15], s25 offen offset:0
    buffer_load_dwordx4 a[164:167], v6, s[12:15], s25 offen offset:1024
    buffer_load_dwordx4 a[168:171], v6, s[12:15], s25 offen offset:2048
    buffer_load_dwordx4 a[172:175], v6, s[12:15], s25 offen offset:3072
    buffer_load_dwordx4 a[176:179], v6, s[12:15], s26 offen
    s_add_u32 s24, s24, 4096
    s_add_u32 s25, s25, 147456
    s_add_u32 s26, s26, 147456
    s_waitcnt vmcnt(54)
    v_mfma_f32_16x16x32_bf16 v[16:19], a[196:199], a[180:183], v[16:19]
    v_mfma_f32_16x16x32_bf16 v[20:23], a[196:199], a[184:187], v[20:23]
    v_mfma_f32_16x16x32_bf16 v[24:27], a[196:199], a[188:191], v[24:27]
    v_mfma_f32_16x16x32_bf16 v[28:31], a[196:199], a[192:195], v[28:31]
    v_mfma_f32_16x16x32_bf16 v[32:35], a[200:203], a[180:183], v[32:35]
    v_mfma_f32_16x16x32_bf16 v[36:39], a[200:203], a[184:187], v[36:39]
    v_mfma_f32_16x16x32_bf16 v[40:43], a[200:203], a[188:191], v[40:43]
    v_mfma_f32_16x16x32_bf16 v[44:47], a[200:203], a[192:195], v[44:47]
    v_mfma_f32_16x16x32_bf16 v[48:51], a[204:207], a[180:183], v[48:51]
    v_mfma_f32_16x16x32_bf16 v[52:55], a[204:207], a[184:187], v[52:55]
    v_mfma_f32_16x16x32_bf16 v[56:59], a[204:207], a[188:191], v[56:59]
    v_mfma_f32_16x16x32_bf16 v[60:63], a[204:207], a[192:195], v[60:63]
    v_mfma_f32_16x16x32_bf16 v[64:67], a[208:211], a[180:183], v[64:67]
    v_mfma_f32_16x16x32_bf16 v[68:71], a[208:211], a[184:187], v[68:71]
    v_mfma_f32_16x16x32_bf16 v[72:75], a[208:211], a[188:191], v[72:75]
    v_mfma_f32_16x16x32_bf16 v[76:79], a[208:211], a[192:195], v[76:79]
    v_mfma_f32_16x16x32_bf16 v[80:83], a[212:215], a[180:183], v[80:83]
    v_mfma_f32_16x16x32_bf16 v[84:87], a[212:215], a[184:187], v[84:87]
    buffer_load_dwordx4 a[180:183], v2, s[8:11], s24 offen
    buffer_load_dwordx4 a[184:187], v3, s[8:11], s24 offen
    buffer_load_dwordx4 a[188:191], v4, s[8:11], s24 offen
    buffer_load_dwordx4 a[192:195], v5, s[8:11], s24 offen
    buffer_load_dwordx4 a[196:199], v6, s[12:15], s25 offen offset:0
    buffer_load_dwordx4 a[200:203], v6, s[12:15], s25 offen offset:1024
    buffer_load_dwordx4 a[204:207], v6, s[12:15], s25 offen offset:2048
    buffer_load_dwordx4 a[208:211], v6, s[12:15], s25 offen offset:3072
    buffer_load_dwordx4 a[212:215], v6, s[12:15], s26 offen
    s_add_u32 s24, s24, 4096
    s_add_u32 s25, s25, 147456
    s_add_u32 s26, s26, 147456
    s_waitcnt vmcnt(54)
    v_mfma_f32_16x16x32_bf16 v[16:19], a[232:235], a[216:219], v[16:19]
    v_mfma_f32_16x16x32_bf16 v[20:23], a[232:235], a[220:223], v[20:23]
    v_mfma_f32_16x16x32_bf16 v[24:27], a[232:235], a[224:227], v[24:27]
    v_mfma_f32_16x16x32_bf16 v[28:31], a[232:235], a[228:231], v[28:31]
    v_mfma_f32_16x16x32_bf16 v[32:35], a[236:239], a[216:219], v[32:35]
    v_mfma_f32_16x16x32_bf16 v[36:39], a[236:239], a[220:223], v[36:39]
    v_mfma_f32_16x16x32_bf16 v[40:43], a[236:239], a[224:227], v[40:43]
    v_mfma_f32_16x16x32_bf16 v[44:47], a[236:239], a[228:231], v[44:47]
    v_mfma_f32_16x16x32_bf16 v[48:51], a[240:243], a[216:219], v[48:51]
    v_mfma_f32_16x16x32_bf16 v[52:55], a[240:243], a[220:223], v[52:55]
    v_mfma_f32_16x16x32_bf16 v[56:59], a[240:243], a[224:227], v[56:59]
    v_mfma_f32_16x16x32_bf16 v[60:63], a[240:243], a[228:231], v[60:63]
    v_mfma_f32_16x16x32_bf16 v[64:67], a[244:247], a[216:219], v[64:67]
    v_mfma_f32_16x16x32_bf16 v[68:71], a[244:247], a[220:223], v[68:71]
    v_mfma_f32_16x16x32_bf16 v[72:75], a[244:247], a[224:227], v[72:75]
    v_mfma_f32_16x16x32_bf16 v[76:79], a[244:247], a[228:231], v[76:79]
    v_mfma_f32_16x16x32_bf16 v[80:83], a[248:251], a[216:219], v[80:83]
    v_mfma_f32_16x16x32_bf16 v[84:87], a[248:251], a[220:223], v[84:87]
    buffer_load_dwordx4 a[216:219], v2, s[8:11], s24 offen
    buffer_load_dwordx4 a[220:223], v3, s[8:11], s24 offen
    buffer_load_dwordx4 a[224:227], v4, s[8:11], s24 offen
    buffer_load_dwordx4 a[228:231], v5, s[8:11], s24 offen
    buffer_load_dwordx4 a[232:235], v6, s[12:15], s25 offen offset:0
    buffer_load_dwordx4 a[236:239], v6, s[12:15], s25 offen offset:1024
    buffer_load_dwordx4 a[240:243], v6, s[12:15], s25 offen offset:2048
    buffer_load_dwordx4 a[244:247], v6, s[12:15], s25 offen offset:3072
    buffer_load_dwordx4 a[248:251], v6, s[12:15], s26 offen
    s_add_u32 s24, s24, 4096
    s_add_u32 s25, s25, 147456
    s_add_u32 s26, s26, 147456
    s_waitcnt vmcnt(54)
    v_mfma_f32_16x16x32_bf16 v[16:19], a[16:19], a[0:3], v[16:19]
    v_mfma_f32_16x16x32_bf16 v[20:23], a[16:19], a[4:7], v[20:23]
    v_mfma_f32_16x16x32_bf16 v[24:27], a[16:19], a[8:11], v[24:27]
    v_mfma_f32_16x16x32_bf16 v[28:31], a[16:19], a[12:15], v[28:31]
    v_mfma_f32_16x16x32_bf16 v[32:35], a[20:23], a[0:3], v[32:35]
    v_mfma_f32_16x16x32_bf16 v[36:39], a[20:23], a[4:7], v[36:39]
    v_mfma_f32_16x16x32_bf16 v[40:43], a[20:23], a[8:11], v[40:43]
    v_mfma_f32_16x16x32_bf16 v[44:47], a[20:23], a[12:15], v[44:47]
    v_mfma_f32_16x16x32_bf16 v[48:51], a[24:27], a[0:3], v[48:51]
    v_mfma_f32_16x16x32_bf16 v[52:55], a[24:27], a[4:7], v[52:55]
    v_mfma_f32_16x16x32_bf16 v[56:59], a[24:27], a[8:11], v[56:59]
    v_mfma_f32_16x16x32_bf16 v[60:63], a[24:27], a[12:15], v[60:63]
    v_mfma_f32_16x16x32_bf16 v[64:67], a[28:31], a[0:3], v[64:67]
    v_mfma_f32_16x16x32_bf16 v[68:71], a[28:31], a[4:7], v[68:71]
    v_mfma_f32_16x16x32_bf16 v[72:75], a[28:31], a[8:11], v[72:75]
    v_mfma_f32_16x16x32_bf16 v[76:79], a[28:31], a[12:15], v[76:79]
    v_mfma_f32_16x16x32_bf16 v[80:83], a[32:35], a[0:3], v[80:83]
    v_mfma_f32_16x16x32_bf16 v[84:87], a[32:35], a[4:7], v[84:87]
    buffer_load_dwordx4 a[0:3], v2, s[8:11], s24 offen
    buffer_load_dwordx4 a[4:7], v3, s[8:11], s24 offen
    buffer_load_dwordx4 a[8:11], v4, s[8:11], s24 offen
    buffer_load_dwordx4 a[12:15], v5, s[8:11], s24 offen
    buffer_load_dwordx4 a[16:19], v6, s[12:15], s25 offen offset:0
    buffer_load_dwordx4 a[20:23], v6, s[12:15], s25 offen offset:1024
    buffer_load_dwordx4 a[24:27], v6, s[12:15], s25 offen offset:2048
    buffer_load_dwordx4 a[28:31], v6, s[12:15], s25 offen offset:3072
    buffer_load_dwordx4 a[32:35], v6, s[12:15], s26 offen
    s_add_u32 s24, s24, 4096
    s_add_u32 s25, s25, 147456
    s_add_u32 s26, s26, 147456
    s_waitcnt vmcnt(54)
    v_mfma_f32_16x16x32_bf16 v[16:19], a[52:55], a[36:39], v[16:19]
    v_mfma_f32_16x16x32_bf16 v[20:23], a[52:55], a[40:43], v[20:23]
    v_mfma_f32_16x16x32_bf16 v[24:27], a[52:55], a[44:47], v[24:27]
    v_mfma_f32_16x16x32_bf16 v[28:31], a[52:55], a[48:51], v[28:31]
    v_mfma_f32_16x16x32_bf16 v[32:35], a[56:59], a[36:39], v[32:35]
    v_mfma_f32_16x16x32_bf16 v[36:39], a[56:59], a[40:43], v[36:39]
    v_mfma_f32_16x16x32_bf16 v[40:43], a[56:59], a[44:47], v[40:43]
    v_mfma_f32_16x16x32_bf16 v[44:47], a[56:59], a[48:51], v[44:47]
    v_mfma_f32_16x16x32_bf16 v[48:51], a[60:63], a[36:39], v[48:51]
    v_mfma_f32_16x16x32_bf16 v[52:55], a[60:63], a[40:43], v[52:55]
    v_mfma_f32_16x16x32_bf16 v[56:59], a[60:63], a[44:47], v[56:59]
    v_mfma_f32_16x16x32_bf16 v[60:63], a[60:63], a[48:51], v[60:63]
    v_mfma_f32_16x16x32_bf16 v[64:67], a[64:67], a[36:39], v[64:67]
    v_mfma_f32_16x16x32_bf16 v[68:71], a[64:67], a[40:43], v[68:71]
    v_mfma_f32_16x16x32_bf16 v[72:75], a[64:67], a[44:47], v[72:75]
    v_mfma_f32_16x16x32_bf16 v[76:79], a[64:67], a[48:51], v[76:79]
    v_mfma_f32_16x16x32_bf16 v[80:83], a[68:71], a[36:39], v[80:83]
    v_mfma_f32_16x16x32_bf16 v[84:87], a[68:71], a[40:43], v[84:87]
    buffer_load_dwordx4 a[36:39], v2, s[8:11], s24 offen
    buffer_load_dwordx4 a[40:43], v3, s[8:11], s24 offen
    buffer_load_dwordx4 a[44:47], v4, s[8:11], s24 offen
    buffer_load_dwordx4 a[48:51], v5, s[8:11], s24 offen
    buffer_load_dwordx4 a[52:55], v6, s[12:15], s25 offen offset:0
    buffer_load_dwordx4 a[56:59], v6, s[12:15], s25 offen offset:1024
    buffer_load_dwordx4 a[60:63], v6, s[12:15], s25 offen offset:2048
    buffer_load_dwordx4 a[64:67], v6, s[12:15], s25 offen offset:3072
    buffer_load_dwordx4 a[68:71], v6, s[12:15], s26 offen
    s_add_u32 s24, s24, 4096
    s_add_u32 s25, s25, 147456
    s_add_u32 s26, s26, 147456
    s_waitcnt vmcnt(54)
    v_mfma_f32_16x16x32_bf16 v[16:19], a[88:91], a[72:75], v[16:19]
    v_mfma_f32_16x16x32_bf16 v[20:23], a[88:91], a[76:79], v[20:23]
    v_mfma_f32_16x16x32_bf16 v[24:27], a[88:91], a[80:83], v[24:27]
    v_mfma_f32_16x16x32_bf16 v[28:31], a[88:91], a[84:87], v[28:31]
    v_mfma_f32_16x16x32_bf16 v[32:35], a[92:95], a[72:75], v[32:35]
    v_mfma_f32_16x16x32_bf16 v[36:39], a[92:95], a[76:79], v[36:39]
    v_mfma_f32_16x16x32_bf16 v[40:43], a[92:95], a[80:83], v[40:43]
    v_mfma_f32_16x16x32_bf16 v[44:47], a[92:95], a[84:87], v[44:47]
    v_mfma_f32_16x16x32_bf16 v[48:51], a[96:99], a[72:75], v[48:51]
    v_mfma_f32_16x16x32_bf16 v[52:55], a[96:99], a[76:79], v[52:55]
    v_mfma_f32_16x16x32_bf16 v[56:59], a[96:99], a[80:83], v[56:59]
    v_mfma_f32_16x16x32_bf16 v[60:63], a[96:99], a[84:87], v[60:63]
    v_mfma_f32_16x16x32_bf16 v[64:67], a[100:103], a[72:75], v[64:67]
    v_mfma_f32_16x16x32_bf16 v[68:71], a[100:103], a[76:79], v[68:71]
    v_mfma_f32_16x16x32_bf16 v[72:75], a[100:103], a[80:83], v[72:75]
    v_mfma_f32_16x16x32_bf16 v[76:79], a[100:103], a[84:87], v[76:79]
    v_mfma_f32_16x16x32_bf16 v[80:83], a[104:107], a[72:75], v[80:83]
    v_mfma_f32_16x16x32_bf16 v[84:87], a[104:107], a[76:79], v[84:87]
    s_waitcnt vmcnt(45)
    v_mfma_f32_16x16x32_bf16 v[16:19], a[124:127], a[108:111], v[16:19]
    v_mfma_f32_16x16x32_bf16 v[20:23], a[124:127], a[112:115], v[20:23]
    v_mfma_f32_16x16x32_bf16 v[24:27], a[124:127], a[116:119], v[24:27]
    v_mfma_f32_16x16x32_bf16 v[28:31], a[124:127], a[120:123], v[28:31]
    v_mfma_f32_16x16x32_bf16 v[32:35], a[128:131], a[108:111], v[32:35]
    v_mfma_f32_16x16x32_bf16 v[36:39], a[128:131], a[112:115], v[36:39]
    v_mfma_f32_16x16x32_bf16 v[40:43], a[128:131], a[116:119], v[40:43]
    v_mfma_f32_16x16x32_bf16 v[44:47], a[128:131], a[120:123], v[44:47]
    v_mfma_f32_16x16x32_bf16 v[48:51], a[132:135], a[108:111], v[48:51]
    v_mfma_f32_16x16x32_bf16 v[52:55], a[132:135], a[112:115], v[52:55]
    v_mfma_f32_16x16x32_bf16 v[56:59], a[132:135], a[116:119], v[56:59]
    v_mfma_f32_16x16x32_bf16 v[60:63], a[132:135], a[120:123], v[60:63]
    v_mfma_f32_16x16x32_bf16 v[64:67], a[136:139], a[108:111], v[64:67]
    v_mfma_f32_16x16x32_bf16 v[68:71], a[136:139], a[112:115], v[68:71]
    v_mfma_f32_16x16x32_bf16 v[72:75], a[136:139], a[116:119], v[72:75]
    v_mfma_f32_16x16x32_bf16 v[76:79], a[136:139], a[120:123], v[76:79]
    v_mfma_f32_16x16x32_bf16 v[80:83], a[140:143], a[108:111], v[80:83]
    v_mfma_f32_16x16x32_bf16 v[84:87], a[140:143], a[112:115], v[84:87]
    s_waitcnt vmcnt(36)
    v_mfma_f32_16x16x32_bf16 v[16:19], a[160:163], a[144:147], v[16:19]
    v_mfma_f32_16x16x32_bf16 v[20:23], a[160:163], a[148:151], v[20:23]
    v_mfma_f32_16x16x32_bf16 v[24:27], a[160:163], a[152:155], v[24:27]
    v_mfma_f32_16x16x32_bf16 v[28:31], a[160:163], a[156:159], v[28:31]
    v_mfma_f32_16x16x32_bf16 v[32:35], a[164:167], a[144:147], v[32:35]
    v_mfma_f32_16x16x32_bf16 v[36:39], a[164:167], a[148:151], v[36:39]
    v_mfma_f32_16x16x32_bf16 v[40:43], a[164:167], a[152:155], v[40:43]
    v_mfma_f32_16x16x32_bf16 v[44:47], a[164:167], a[156:159], v[44:47]
    v_mfma_f32_16x16x32_bf16 v[48:51], a[168:171], a[144:147], v[48:51]
    v_mfma_f32_16x16x32_bf16 v[52:55], a[168:171], a[148:151], v[52:55]
    v_mfma_f32_16x16x32_bf16 v[56:59], a[168:171], a[152:155], v[56:59]
    v_mfma_f32_16x16x32_bf16 v[60:63], a[168:171], a[156:159], v[60:63]
    v_mfma_f32_16x16x32_bf16 v[64:67], a[172:175], a[144:147], v[64:67]
    v_mfma_f32_16x16x32_bf16 v[68:71], a[172:175], a[148:151], v[68:71]
    v_mfma_f32_16x16x32_bf16 v[72:75], a[172:175], a[152:155], v[72:75]
    v_mfma_f32_16x16x32_bf16 v[76:79], a[172:175], a[156:159], v[76:79]
    v_mfma_f32_16x16x32_bf16 v[80:83], a[176:179], a[144:147], v[80:83]
    v_mfma_f32_16x16x32_bf16 v[84:87], a[176:179], a[148:151], v[84:87]
    s_waitcnt vmcnt(27)
    v_mfma_f32_16x16x32_bf16 v[16:19], a[196:199], a[180:183], v[16:19]
    v_mfma_f32_16x16x32_bf16 v[20:23], a[196:199], a[184:187], v[20:23]
    v_mfma_f32_16x16x32_bf16 v[24:27], a[196:199], a[188:191], v[24:27]
    v_mfma_f32_16x16x32_bf16 v[28:31], a[196:199], a[192:195], v[28:31]
    v_mfma_f32_16x16x32_bf16 v[32:35], a[200:203], a[180:183], v[32:35]
    v_mfma_f32_16x16x32_bf16 v[36:39], a[200:203], a[184:187], v[36:39]
    v_mfma_f32_16x16x32_bf16 v[40:43], a[200:203], a[188:191], v[40:43]
    v_mfma_f32_16x16x32_bf16 v[44:47], a[200:203], a[192:195], v[44:47]
    v_mfma_f32_16x16x32_bf16 v[48:51], a[204:207], a[180:183], v[48:51]
    v_mfma_f32_16x16x32_bf16 v[52:55], a[204:207], a[184:187], v[52:55]
    v_mfma_f32_16x16x32_bf16 v[56:59], a[204:207], a[188:191], v[56:59]
    v_mfma_f32_16x16x32_bf16 v[60:63], a[204:207], a[192:195], v[60:63]
    v_mfma_f32_16x16x32_bf16 v[64:67], a[208:211], a[180:183], v[64:67]
    v_mfma_f32_16x16x32_bf16 v[68:71], a[208:211], a[184:187], v[68:71]
    v_mfma_f32_16x16x32_bf16 v[72:75], a[208:211], a[188:191], v[72:75]
    v_mfma_f32_16x16x32_bf16 v[76:79], a[208:211], a[192:195], v[76:79]
    v_mfma_f32_16x16x32_bf16 v[80:83], a[212:215], a[180:183], v[80:83]
    v_mfma_f32_16x16x32_bf16 v[84:87], a[212:215], a[184:187], v[84:87]
    s_waitcnt vmcnt(18)
    v_mfma_f32_16x16x32_bf16 v[16:19], a[232:235], a[216:219], v[16:19]
    v_mfma_f32_16x16x32_bf16 v[20:23], a[232:235], a[220:223], v[20:23]
    v_mfma_f32_16x16x32_bf16 v[24:27], a[232:235], a[224:227], v[24:27]
    v_mfma_f32_16x16x32_bf16 v[28:31], a[232:235], a[228:231], v[28:31]
    v_mfma_f32_16x16x32_bf16 v[32:35], a[236:239], a[216:219], v[32:35]
    v_mfma_f32_16x16x32_bf16 v[36:39], a[236:239], a[220:223], v[36:39]
    v_mfma_f32_16x16x32_bf16 v[40:43], a[236:239], a[224:227], v[40:43]
    v_mfma_f32_16x16x32_bf16 v[44:47], a[236:239], a[228:231], v[44:47]
    v_mfma_f32_16x16x32_bf16 v[48:51], a[240:243], a[216:219], v[48:51]
    v_mfma_f32_16x16x32_bf16 v[52:55], a[240:243], a[220:223], v[52:55]
    v_mfma_f32_16x16x32_bf16 v[56:59], a[240:243], a[224:227], v[56:59]
    v_mfma_f32_16x16x32_bf16 v[60:63], a[240:243], a[228:231], v[60:63]
    v_mfma_f32_16x16x32_bf16 v[64:67], a[244:247], a[216:219], v[64:67]
    v_mfma_f32_16x16x32_bf16 v[68:71], a[244:247], a[220:223], v[68:71]
    v_mfma_f32_16x16x32_bf16 v[72:75], a[244:247], a[224:227], v[72:75]
    v_mfma_f32_16x16x32_bf16 v[76:79], a[244:247], a[228:231], v[76:79]
    v_mfma_f32_16x16x32_bf16 v[80:83], a[248:251], a[216:219], v[80:83]
    v_mfma_f32_16x16x32_bf16 v[84:87], a[248:251], a[220:223], v[84:87]
    s_waitcnt vmcnt(9)
    v_mfma_f32_16x16x32_bf16 v[16:19], a[16:19], a[0:3], v[16:19]
    v_mfma_f32_16x16x32_bf16 v[20:23], a[16:19], a[4:7], v[20:23]
    v_mfma_f32_16x16x32_bf16 v[24:27], a[16:19], a[8:11], v[24:27]
    v_mfma_f32_16x16x32_bf16 v[28:31], a[16:19], a[12:15], v[28:31]
    v_mfma_f32_16x16x32_bf16 v[32:35], a[20:23], a[0:3], v[32:35]
    v_mfma_f32_16x16x32_bf16 v[36:39], a[20:23], a[4:7], v[36:39]
    v_mfma_f32_16x16x32_bf16 v[40:43], a[20:23], a[8:11], v[40:43]
    v_mfma_f32_16x16x32_bf16 v[44:47], a[20:23], a[12:15], v[44:47]
    v_mfma_f32_16x16x32_bf16 v[48:51], a[24:27], a[0:3], v[48:51]
    v_mfma_f32_16x16x32_bf16 v[52:55], a[24:27], a[4:7], v[52:55]
    v_mfma_f32_16x16x32_bf16 v[56:59], a[24:27], a[8:11], v[56:59]
    v_mfma_f32_16x16x32_bf16 v[60:63], a[24:27], a[12:15], v[60:63]
    v_mfma_f32_16x16x32_bf16 v[64:67], a[28:31], a[0:3], v[64:67]
    v_mfma_f32_16x16x32_bf16 v[68:71], a[28:31], a[4:7], v[68:71]
    v_mfma_f32_16x16x32_bf16 v[72:75], a[28:31], a[8:11], v[72:75]
    v_mfma_f32_16x16x32_bf16 v[76:79], a[28:31], a[12:15], v[76:79]
    v_mfma_f32_16x16x32_bf16 v[80:83], a[32:35], a[0:3], v[80:83]
    v_mfma_f32_16x16x32_bf16 v[84:87], a[32:35], a[4:7], v[84:87]
    s_waitcnt vmcnt(0)
    v_mfma_f32_16x16x32_bf16 v[16:19], a[52:55], a[36:39], v[16:19]
    v_mfma_f32_16x16x32_bf16 v[20:23], a[52:55], a[40:43], v[20:23]
    v_mfma_f32_16x16x32_bf16 v[24:27], a[52:55], a[44:47], v[24:27]
    v_mfma_f32_16x16x32_bf16 v[28:31], a[52:55], a[48:51], v[28:31]
    v_mfma_f32_16x16x32_bf16 v[32:35], a[56:59], a[36:39], v[32:35]
    v_mfma_f32_16x16x32_bf16 v[36:39], a[56:59], a[40:43], v[36:39]
    v_mfma_f32_16x16x32_bf16 v[40:43], a[56:59], a[44:47], v[40:43]
    v_mfma_f32_16x16x32_bf16 v[44:47], a[56:59], a[48:51], v[44:47]
    v_mfma_f32_16x16x32_bf16 v[48:51], a[60:63], a[36:39], v[48:51]
    v_mfma_f32_16x16x32_bf16 v[52:55], a[60:63], a[40:43], v[52:55]
    v_mfma_f32_16x16x32_bf16 v[56:59], a[60:63], a[44:47], v[56:59]
    v_mfma_f32_16x16x32_bf16 v[60:63], a[60:63], a[48:51], v[60:63]
    v_mfma_f32_16x16x32_bf16 v[64:67], a[64:67], a[36:39], v[64:67]
    v_mfma_f32_16x16x32_bf16 v[68:71], a[64:67], a[40:43], v[68:71]
    v_mfma_f32_16x16x32_bf16 v[72:75], a[64:67], a[44:47], v[72:75]
    v_mfma_f32_16x16x32_bf16 v[76:79], a[64:67], a[48:51], v[76:79]
    v_mfma_f32_16x16x32_bf16 v[80:83], a[68:71], a[36:39], v[80:83]
    v_mfma_f32_16x16x32_bf16 v[84:87], a[68:71], a[40:43], v[84:87]
    s_lshl_b32 s27, s20, 10
    v_add_u32 v9, s27, v8
    v_add_u32 v6, 0x10000, v9
    ds_write_b128 v9, v[16:19] offset:0
    ds_write_b128 v9, v[20:23] offset:4096
    ds_write_b128 v9, v[24:27] offset:8192
    ds_write_b128 v9, v[28:31] offset:12288
    ds_write_b128 v9, v[32:35] offset:16384
    ds_write_b128 v9, v[36:39] offset:20480
    ds_write_b128 v9, v[40:43] offset:24576
    ds_write_b128 v9, v[44:47] offset:28672
    ds_write_b128 v9, v[48:51] offset:32768
    ds_write_b128 v9, v[52:55] offset:36864
    ds_write_b128 v9, v[56:59] offset:40960
    ds_write_b128 v9, v[60:63] offset:45056
    ds_write_b128 v9, v[64:67] offset:49152
    ds_write_b128 v9, v[68:71] offset:53248
    ds_write_b128 v9, v[72:75] offset:57344
    s_waitcnt lgkmcnt(14)
    ds_write_b128 v9, v[76:79] offset:61440
    s_waitcnt lgkmcnt(14)
    ds_write_b128 v6, v[80:83] offset:0
    s_waitcnt lgkmcnt(14)
    ds_write_b128 v6, v[84:87] offset:4096
    s_lshl_b32 s27, s20, 12
    v_add_u32 v9, s27, v8
    s_and_b32 s27, s27, 4096
    s_add_u32 s27, s27, 0x10000
    v_add_u32 v6, s27, v8
    s_lshl1_add_u32 s27, s23, s20
    s_and_b32 s27, s27, 3
    s_lshl2_add_u32 s27, s21, s27
    s_lshl_b32 s27, s27, 4
    v_and_b32 v2, 15, v7
    v_add_u32 v2, s27, v2
    v_mul_u32_u24 v2, 1152, v2
    v_lshrrev_b32 v3, 4, v7
    v_lshl_add_u32 v2, v3, 3, v2
    s_mul_i32 s27, s23, 5
    s_add_u32 s27, s27, s22
    s_lshl_b32 s27, s27, 5
    s_add_u32 s28, s22, 4
    s_lshl_b32 s28, s28, 5
    s_cmp_lt_u32 s20, 2
    s_cselect_b32 s28, s28, 67108864
    s_waitcnt lgkmcnt(0)
    s_barrier
    ds_read_b128 v[16:19], v9 offset:0
    ds_read_b128 v[20:23], v9 offset:1024
    ds_read_b128 v[24:27], v9 offset:2048
    ds_read_b128 v[28:31], v9 offset:3072
    ds_read_b128 v[32:35], v9 offset:16384
    ds_read_b128 v[36:39], v9 offset:17408
    ds_read_b128 v[40:43], v9 offset:18432
    ds_read_b128 v[44:47], v9 offset:19456
    ds_read_b128 v[48:51], v9 offset:32768
    ds_read_b128 v[52:55], v9 offset:33792
    ds_read_b128 v[56:59], v9 offset:34816
    ds_read_b128 v[60:63], v9 offset:35840
    ds_read_b128 v[64:67], v9 offset:49152
    ds_read_b128 v[68:71], v9 offset:50176
    ds_read_b128 v[72:75], v9 offset:51200
    s_waitcnt lgkmcnt(14)
    ds_read_b128 v[76:79], v9 offset:52224
    s_waitcnt lgkmcnt(14)
    ds_read_b128 v[80:83], v6 offset:0
    s_waitcnt lgkmcnt(14)
    ds_read_b128 v[84:87], v6 offset:1024
    s_waitcnt lgkmcnt(14)
    ds_read_b128 v[88:91], v6 offset:2048
    s_waitcnt lgkmcnt(14)
    ds_read_b128 v[92:95], v6 offset:3072
    v_pk_add_f32 v[16:17], v[16:17], v[20:21]
    v_pk_add_f32 v[24:25], v[24:25], v[28:29]
    v_pk_add_f32 v[16:17], v[16:17], v[24:25]
    v_pk_add_f32 v[18:19], v[18:19], v[22:23]
    v_pk_add_f32 v[26:27], v[26:27], v[30:31]
    v_pk_add_f32 v[18:19], v[18:19], v[26:27]
    v_cvt_pk_bf16_f32 v16, v16, v17
    v_cvt_pk_bf16_f32 v17, v18, v19
    buffer_store_dwordx2 v[16:17], v2, s[16:19], s27 offen
    s_waitcnt lgkmcnt(14)
    v_pk_add_f32 v[32:33], v[32:33], v[36:37]
    s_waitcnt lgkmcnt(12)
    v_pk_add_f32 v[40:41], v[40:41], v[44:45]
    v_pk_add_f32 v[32:33], v[32:33], v[40:41]
    v_pk_add_f32 v[34:35], v[34:35], v[38:39]
    v_pk_add_f32 v[42:43], v[42:43], v[46:47]
    v_pk_add_f32 v[34:35], v[34:35], v[42:43]
    v_cvt_pk_bf16_f32 v32, v32, v33
    v_cvt_pk_bf16_f32 v33, v34, v35
    buffer_store_dwordx2 v[32:33], v2, s[16:19], s27 offen offset:32
    s_waitcnt lgkmcnt(10)
    v_pk_add_f32 v[48:49], v[48:49], v[52:53]
    s_waitcnt lgkmcnt(8)
    v_pk_add_f32 v[56:57], v[56:57], v[60:61]
    v_pk_add_f32 v[48:49], v[48:49], v[56:57]
    v_pk_add_f32 v[50:51], v[50:51], v[54:55]
    v_pk_add_f32 v[58:59], v[58:59], v[62:63]
    v_pk_add_f32 v[50:51], v[50:51], v[58:59]
    v_cvt_pk_bf16_f32 v48, v48, v49
    v_cvt_pk_bf16_f32 v49, v50, v51
    buffer_store_dwordx2 v[48:49], v2, s[16:19], s27 offen offset:64
    s_waitcnt lgkmcnt(6)
    v_pk_add_f32 v[64:65], v[64:65], v[68:69]
    s_waitcnt lgkmcnt(4)
    v_pk_add_f32 v[72:73], v[72:73], v[76:77]
    v_pk_add_f32 v[64:65], v[64:65], v[72:73]
    v_pk_add_f32 v[66:67], v[66:67], v[70:71]
    v_pk_add_f32 v[74:75], v[74:75], v[78:79]
    v_pk_add_f32 v[66:67], v[66:67], v[74:75]
    v_cvt_pk_bf16_f32 v64, v64, v65
    v_cvt_pk_bf16_f32 v65, v66, v67
    buffer_store_dwordx2 v[64:65], v2, s[16:19], s27 offen offset:96
    s_waitcnt lgkmcnt(2)
    v_pk_add_f32 v[80:81], v[80:81], v[84:85]
    s_waitcnt lgkmcnt(0)
    v_pk_add_f32 v[88:89], v[88:89], v[92:93]
    v_pk_add_f32 v[80:81], v[80:81], v[88:89]
    v_pk_add_f32 v[82:83], v[82:83], v[86:87]
    v_pk_add_f32 v[90:91], v[90:91], v[94:95]
    v_pk_add_f32 v[82:83], v[82:83], v[90:91]
    v_cvt_pk_bf16_f32 v80, v80, v81
    v_cvt_pk_bf16_f32 v81, v82, v83
    buffer_store_dwordx2 v[80:81], v2, s[16:19], s28 offen
K2_END:
    s_endpgm
.section .rodata,"a"
.p2align 6
.amdhsa_kernel fused_kernel
.amdhsa_next_free_vgpr 512
.amdhsa_next_free_sgpr 102
.amdhsa_accum_offset 256
.amdhsa_group_segment_fixed_size 0
.amdhsa_kernarg_size 104
.amdhsa_user_sgpr_count 2
.amdhsa_user_sgpr_kernarg_segment_ptr 1
.amdhsa_system_sgpr_workgroup_id_x 1
.amdhsa_ieee_mode 0
.amdhsa_dx10_clamp 0
.end_amdhsa_kernel
.p2align 6
.amdhsa_kernel outproj_kernel
.amdhsa_next_free_vgpr 512
.amdhsa_next_free_sgpr 102
.amdhsa_accum_offset 256
.amdhsa_group_segment_fixed_size 0
.amdhsa_kernarg_size 104
.amdhsa_user_sgpr_count 2
.amdhsa_user_sgpr_kernarg_segment_ptr 1
.amdhsa_system_sgpr_workgroup_id_x 1
.amdhsa_ieee_mode 0
.amdhsa_dx10_clamp 0
.end_amdhsa_kernel
```

```asm
; @launch grid=(256,1,1) block=(256,1,1) lds=163840
.amdgcn_target "amdgcn-amd-amdhsa--gfx950"
.text
.globl gated_mix__sliding_local_dilated__compressed_kv_cla__prompt_kernel
.p2align 8
.type gated_mix__sliding_local_dilated__compressed_kv_cla__prompt_kernel,@function
gated_mix__sliding_local_dilated__compressed_kv_cla__prompt_kernel:
    s_cmp_ge_u32 s2, 256
    s_cbranch_scc1 K1_END
    s_getpc_b64 s[94:95]
    s_load_dwordx2 s[8:9], s[0:1], 32
    s_load_dwordx2 s[12:13], s[0:1], 48
    s_load_dwordx2 s[16:17], s[0:1], 56
    s_load_dwordx2 s[20:21], s[0:1], 0
    s_load_dwordx2 s[24:25], s[0:1], 40
    s_load_dwordx2 s[28:29], s[0:1], 8
    s_load_dwordx2 s[32:33], s[0:1], 72
    s_load_dwordx2 s[48:49], s[0:1], 64
    s_load_dwordx2 s[92:93], s[0:1], 16
    s_load_dwordx2 s[44:45], s[0:1], 88
    s_load_dwordx2 s[56:57], s[0:1], 96
    v_min_u32 v74, 15, v0
    s_lshr_b32 s7, s2, 3
    s_mul_i32 s7, s7, 16
    v_add_lshl_u32 v74, v74, s7, 7
    global_load_dword v76, v74, s[94:95]
    v_lshrrev_b32 v64, 6, v0
    v_and_b32 v31, 63, v0
    v_readfirstlane_b32 s4, v64
    s_and_b32 s5, s2, 7
    s_lshl_b32 s5, s5, 2
    s_bfe_u32 s7, s2, 0x20003
    s_add_u32 s5, s5, s7
    s_lshr_b32 s6, s2, 5
    s_lshl_b32 s69, s4, 12
    s_mov_b32 s10, 2097152
    s_mov_b32 s11, 0x20000
    s_mov_b32 s14, 4194304
    s_mov_b32 s15, 0x20000
    s_mov_b32 s18, 4194304
    s_mov_b32 s19, 0x20000
    v_lshrrev_b32 v65, 3, v31
    v_and_b32 v66, 7, v31
    v_lshrrev_b32 v67, 1, v65
    v_xor_b32 v66, v66, v67
    v_lshlrev_b32 v66, 4, v66
    v_xor_b32 v67, 64, v66
    s_lshr_b32 s7, s4, 1
    s_lshl_b32 s73, s7, 7
    s_and_b32 s3, s4, 1
    s_lshl_b32 s98, s3, 5
    s_add_u32 s98, s98, s73
    v_add_lshl_u32 v68, v65, s98, 10
    v_add_u32 v6, v68, v66
    v_add_u32 v7, v68, v67
    v_add_u32 v7, 7168, v7
    v_add_u32 v8, v68, v66
    v_add_u32 v8, 14336, v8
    v_add_u32 v9, v68, v67
    v_add_u32 v9, 21504, v9
    v_lshrrev_b32 v69, 4, v31
    v_and_b32 v70, 15, v31
    v_lshlrev_b32 v71, 1, v69
    v_xor_b32 v71, v71, v70
    v_lshlrev_b32 v71, 4, v71
    v_xor_b32 v72, 128, v71
    s_lshl_b32 s98, s4, 4
    v_add_lshl_u32 v73, v69, s98, 13
    v_add_u32 v2, v73, v71
    v_add_u32 v3, v73, v71
    v_add_u32 v3, 31744, v3
    v_add_u32 v4, v73, v72
    v_add_u32 v4, 63488, v4
    v_add_u32 v5, v73, v72
    v_add_u32 v5, 95232, v5
    s_lshl_b32 s60, s5, 8
    s_lshl_b32 s61, s6, 18
    s_add_u32 s62, s61, 65536
    s_waitcnt lgkmcnt(0)
    s_add_u32 m0, s69, 0
    s_nop 0
    buffer_load_dwordx4 v6, s[8:11], s61 offen lds
    buffer_load_dwordx4 v7, s[8:11], s61 offen offset:1024 lds
    buffer_load_dwordx4 v8, s[8:11], s61 offen offset:2048 lds
    buffer_load_dwordx4 v9, s[8:11], s61 offen offset:3072 lds
    s_add_u32 s61, s61, 128
    s_add_u32 m0, s69, 16384
    s_nop 0
    buffer_load_dwordx4 v6, s[8:11], s62 offen lds
    buffer_load_dwordx4 v7, s[8:11], s62 offen offset:1024 lds
    buffer_load_dwordx4 v8, s[8:11], s62 offen offset:2048 lds
    buffer_load_dwordx4 v9, s[8:11], s62 offen offset:3072 lds
    s_add_u32 s62, s62, 128
    s_add_u32 m0, s69, 32768
    s_nop 0
    buffer_load_dwordx4 v2, s[12:15], s60 offen nt lds
    buffer_load_dwordx4 v3, s[12:15], s60 offen offset:1024 nt lds
    buffer_load_dwordx4 v4, s[12:15], s60 offen offset:2048 nt lds
    buffer_load_dwordx4 v5, s[12:15], s60 offen offset:3072 nt lds
    s_add_u32 m0, s69, 49152
    s_nop 0
    buffer_load_dwordx4 v6, s[8:11], s61 offen lds
    buffer_load_dwordx4 v7, s[8:11], s61 offen offset:1024 lds
    buffer_load_dwordx4 v8, s[8:11], s61 offen offset:2048 lds
    buffer_load_dwordx4 v9, s[8:11], s61 offen offset:3072 lds
    s_add_u32 s61, s61, 128
    s_add_u32 m0, s69, 65536
    s_nop 0
    buffer_load_dwordx4 v2, s[16:19], s60 offen nt lds
    s_mov_b32 s22, 2359296
    s_mov_b32 s23, 0x20000
    s_mov_b32 s26, 4718592
    s_mov_b32 s27, 0x20000
    s_mov_b32 s50, 4718592
    s_mov_b32 s51, 0x20000
    s_mov_b32 s46, 256
    s_mov_b32 s47, 0x20000
    s_mov_b32 s30, 1990656
    buffer_load_dwordx4 v3, s[16:19], s60 offen offset:1024 nt lds
    s_mov_b32 s31, 0x20000
    s_mov_b32 s34, 1152
    s_mov_b32 s35, 0x20000
    s_mul_i32 s7, s5, 1081344
    s_add_u32 s36, s56, s7
    s_addc_u32 s37, s57, 0
    s_mov_b32 s38, 1081344
    s_mov_b32 s39, 0x20000
    s_add_u32 s40, s56, 35651584
    s_addc_u32 s41, s57, 0
    buffer_load_dwordx4 v4, s[16:19], s60 offen offset:2048 nt lds
    s_mov_b32 s42, 19136512
    s_mov_b32 s43, 0x20000
    s_cmp_eq_u32 s4, 0
    s_cselect_b64 s[86:87], 1, 0
    s_cselect_b32 s52, s48, s92
    s_cselect_b32 s53, s49, s93
    s_cselect_b32 s54, s50, 663552
    s_mov_b32 s55, 0x20000
    buffer_load_dwordx4 v5, s[16:19], s60 offen offset:3072 nt lds
    s_mul_i32 s63, s6, 147456
    s_sub_u32 s64, 2211840, s63
    s_lshl_b32 s67, s4, 11
    s_lshl_b32 s68, s4, 10
    s_lshl_b32 s75, s4, 13
    s_mov_b32 s65, s67
    s_mov_b32 s66, 0
    s_lshl_b32 s70, s6, 2
    s_lshl1_add_u32 s70, s3, s70
    s_lshl_b32 s70, s70, 15
    s_add_u32 s60, s60, 524288
    s_add_u32 m0, s69, 81920
    s_nop 0
    buffer_load_dwordx4 v6, s[8:11], s62 offen lds
    s_lshl_b32 s98, s73, 6
    s_add_u32 s71, s70, s98
    s_add_u32 s71, s71, 49152
    s_lshl_b32 s98, s73, 4
    s_add_u32 s70, s70, s98
    v_lshlrev_b32 v1, 4, v31
    v_mov_b32 v77, 1073741824
    v_cmp_eq_u32 vcc, 0, v0
    s_nop 1
    v_cndmask_b32_e64 v30, v77, 0, vcc
    buffer_load_dwordx4 v7, s[8:11], s62 offen offset:1024 lds
    v_lshlrev_b32 v103, 7, v31
    v_cmp_gt_u32 vcc, 9, v31
    s_nop 1
    v_cndmask_b32 v103, v77, v103, vcc
    s_lshl_b32 s98, s4, 5
    v_add_u32 v68, s98, v65
    v_mul_u32_u24 v68, 1152, v68
    v_add_u32 v10, v68, v66
    v_add_u32 v11, v68, v67
    v_add_u32 v11, 8192, v11
    buffer_load_dwordx4 v8, s[8:11], s62 offen offset:2048 lds
    v_add_u32 v12, v68, v66
    v_add_u32 v12, 16384, v12
    v_add_u32 v13, v68, v67
    v_add_u32 v13, 24576, v13
    s_sub_u32 s98, 15, s6
    s_cmp_eq_u32 s73, 0
    s_cselect_b32 s98, s6, s98
    s_lshl_b32 s98, s98, 7
    s_sub_u32 s98, s98, 16
    buffer_load_dwordx4 v9, s[8:11], s62 offen offset:3072 lds
    s_max_i32 s98, s98, 0
    s_lshl3_add_u32 s98, s3, s98
    v_add_u32 v68, s98, v65
    v_mul_u32_u24 v68, 1152, v68
    s_lshl_b32 s98, s3, 6
    v_xor_b32 v73, s98, v66
    v_add_u32 v96, v68, v73
    v_lshrrev_b32 v71, 1, v70
    v_xor_b32 v71, v71, v69
    v_lshlrev_b32 v71, 4, v71
    s_add_u32 s62, s62, 128
    s_add_u32 m0, s69, 98304
    s_nop 0
    buffer_load_dwordx4 v2, s[12:15], s60 offen nt lds
    v_lshl_add_u32 v71, v70, 7, v71
    v_xor_b32 v72, 64, v71
    s_lshl_b32 s98, s3, 13
    v_add_u32 v22, s98, v71
    v_add_u32 v23, s98, v72
    v_add_u32 v24, s67, v71
    v_add_u32 v25, s67, v72
    s_lshl_b32 s98, s3, 11
    s_add_u32 s98, s98, 8192
    buffer_load_dwordx4 v3, s[12:15], s60 offen offset:1024 nt lds
    v_add_u32 v100, s98, v71
    v_add_u32 v101, s98, v72
    v_bfe_u32 v73, v31, 2, 2
    v_and_b32 v74, 3, v31
    v_lshl_add_u32 v75, v69, 3, v73
    v_and_b32 v78, 1, v69
    v_lshl_add_u32 v77, v78, 2, v73
    v_lshlrev_b32 v77, 5, v77
    v_lshl_add_u32 v77, v74, 3, v77
    buffer_load_dwordx4 v4, s[12:15], s60 offen offset:2048 nt lds
    v_lshl_add_u32 v77, v75, 8, v77
    v_xor_b32 v14, 0, v77
    v_xor_b32 v14, s73, v14
    v_xor_b32 v15, 32, v77
    v_xor_b32 v15, s73, v15
    v_xor_b32 v16, 64, v77
    v_xor_b32 v16, s73, v16
    v_xor_b32 v17, 96, v77
    v_xor_b32 v17, s73, v17
    buffer_load_dwordx4 v5, s[12:15], s60 offen offset:3072 nt lds
    v_xor_b32 v18, 128, v77
    v_xor_b32 v19, 160, v77
    v_xor_b32 v20, 192, v77
    v_xor_b32 v21, 224, v77
    v_lshrrev_b32 v77, 1, v73
    v_lshl_add_u32 v77, v78, 1, v77
    v_lshlrev_b32 v77, 5, v77
    v_lshl_add_u32 v77, v74, 3, v77
    v_lshl_add_u32 v77, v75, 7, v77
    s_lshr_b32 s98, s73, 1
    s_add_u32 m0, s69, 114688
    s_nop 0
    buffer_load_dwordx4 v6, s[8:11], s61 offen lds
    v_xor_b32 v26, 0, v77
    v_xor_b32 v26, s98, v26
    v_xor_b32 v27, 32, v77
    v_xor_b32 v28, 64, v77
    v_xor_b32 v28, s98, v28
    v_xor_b32 v29, 96, v77
    v_and_b32 v73, 7, v0
    v_lshrrev_b32 v74, 3, v0
    s_mul_i32 s98, s6, 72
    buffer_load_dwordx4 v7, s[8:11], s61 offen offset:1024 lds
    v_add_u32 v74, s98, v74
    v_lshl_add_u32 v75, v73, 1, 0
    v_mul_u32_u24 v78, 52, v75
    v_lshrrev_b32 v78, 8, v78
    v_mul_u32_u24 v79, 5, v78
    v_sub_u32 v75, v75, v79
    v_add_u32 v78, 1, v78
    v_cmp_le_u32 vcc, 3, v78
    s_nop 1
    v_cndmask_b32_e64 v78, v78, 0, vcc
    buffer_load_dwordx4 v8, s[8:11], s61 offen offset:2048 lds
    v_mul_u32_u24 v78, 1152, v78
    v_lshl_add_u32 v75, v75, 3, v78
    v_mul_u32_u24 v78, 3456, v74
    v_add_u32 v75, v75, v78
    v_lshl_add_u32 v77, v73, 1, 1
    v_mul_u32_u24 v78, 52, v77
    v_lshrrev_b32 v78, 8, v78
    v_mul_u32_u24 v79, 5, v78
    v_sub_u32 v77, v77, v79
    buffer_load_dwordx4 v9, s[8:11], s61 offen offset:3072 lds
    s_add_u32 s61, s61, 128
    v_add_u32 v78, 1, v78
    v_cmp_le_u32 vcc, 3, v78
    s_nop 1
    v_cndmask_b32_e64 v78, v78, 0, vcc
    v_mul_u32_u24 v78, 1152, v78
    v_lshl_add_u32 v77, v77, 3, v78
    v_mul_u32_u24 v78, 3456, v74
    v_add_u32 v77, v77, v78
    v_lshlrev_b32 v78, 1, v74
    s_mul_i32 s98, s5, 36
    s_mov_b32 s99, 0
    buffer_load_dwordx2 v[80:81], v75, s[28:31], s98 offen
    buffer_load_dwordx2 v[82:83], v77, s[28:31], s98 offen
    buffer_load_ushort v92, v78, s[32:35], s99 offen
    s_add_u32 s98, s98, 110592
    s_add_u32 s99, s99, 64
    buffer_load_dwordx2 v[84:85], v75, s[28:31], s98 offen
    buffer_load_dwordx2 v[86:87], v77, s[28:31], s98 offen
    buffer_load_ushort v93, v78, s[32:35], s99 offen
    s_add_u32 s98, s98, 110592
    s_add_u32 s99, s99, 64
    s_cmp_eq_u32 s4, 0
    s_cselect_b32 s98, s98, 1073741824
    s_cselect_b32 s99, s99, 1073741824
    buffer_load_dwordx2 v[88:89], v75, s[28:31], s98 offen
    buffer_load_dwordx2 v[90:91], v77, s[28:31], s98 offen
    buffer_load_ushort v94, v78, s[32:35], s99 offen
    s_add_u32 s98, s98, 110592
    s_add_u32 s99, s99, 64
    v_bfe_u32 v78, v74, 1, 1
    v_bfe_u32 v79, v74, 3, 1
    v_lshl_add_u32 v78, v79, 1, v78
    v_lshlrev_b32 v78, 1, v78
    v_xor_b32 v78, v78, v73
    v_lshlrev_b32 v78, 4, v78
    v_lshl_add_u32 v95, v74, 7, v78
    v_cmp_eq_u32 s[92:93], 7, v73
    s_mul_i32 s7, s5, 73728
    s_add_u32 s7, s7, 62914560
    s_add_u32 s28, s56, s7
    s_addc_u32 s29, s57, 0
    s_mov_b32 s30, 73728
    s_add_u32 s32, s56, 66060288
    s_addc_u32 s33, s57, 0
    s_mov_b32 s34, 32768
    s_add_u32 s56, s56, 56623104
    s_addc_u32 s57, s57, 0
    s_mov_b32 s58, 5382144
    s_mov_b32 s59, 0x20000
    s_lshl_b32 s7, s6, 5
    s_add_u32 s7, s7, s5
    s_lshl_b32 s7, s7, 7
    v_mov_b32 v79, 0
    buffer_store_dword v79, v30, s[32:35], s7 offen sc1
    s_mov_b32 s74, 0x3e0293ee
    s_mov_b64 s[84:85], 0
    s_mov_b32 s83, 0
    s_lshl_b32 s95, s5, 2
    s_waitcnt vmcnt(26)
    s_barrier
    ds_read_b128 a[0:3], v22 offset:0
    ds_read_b64_tr_b16 v[40:41], v14 offset:32768
    ds_read_b64_tr_b16 v[42:43], v14 offset:33792
    s_waitcnt lgkmcnt(0)
    v_mfma_f32_16x16x32_bf16 v[128:131], v[40:43], a[0:3], 0
    s_add_u32 m0, s69, 131072
    ds_read_b128 a[4:7], v23 offset:0
    ds_read_b64_tr_b16 v[44:45], v14 offset:40960
    ds_read_b64_tr_b16 v[46:47], v14 offset:41984
    s_waitcnt lgkmcnt(0)
    v_mfma_f32_16x16x32_bf16 v[128:131], v[44:47], a[4:7], v[128:131]
    s_mul_i32 s77, s2, 9216
    ds_read_b128 a[8:11], v22 offset:2048
    ds_read_b128 a[12:15], v23 offset:2048
    s_waitcnt lgkmcnt(1)
    v_mfma_f32_16x16x32_bf16 v[132:135], v[40:43], a[8:11], 0
    s_mul_i32 s76, s4, 1152
    ds_read_b128 a[16:19], v22 offset:4096
    ds_read_b128 a[20:23], v23 offset:4096
    s_waitcnt lgkmcnt(2)
    v_mfma_f32_16x16x32_bf16 v[132:135], v[44:47], a[12:15], v[132:135]
    s_add_u32 s77, s77, s76
    ds_read_b128 a[24:27], v22 offset:6144
    ds_read_b128 a[28:31], v23 offset:6144
    s_waitcnt lgkmcnt(3)
    v_mfma_f32_16x16x32_bf16 v[136:139], v[40:43], a[16:19], 0
    s_mov_b32 s72, 0
    ds_read_b128 a[32:35], v22 offset:16384
    ds_read_b128 a[36:39], v23 offset:16384
    s_waitcnt lgkmcnt(4)
    v_mfma_f32_16x16x32_bf16 v[136:139], v[44:47], a[20:23], v[136:139]
    s_mul_i32 s76, s4, 1152
    ds_read_b128 a[40:43], v22 offset:18432
    ds_read_b128 a[44:47], v23 offset:18432
    s_waitcnt lgkmcnt(5)
    v_mfma_f32_16x16x32_bf16 v[140:143], v[40:43], a[24:27], 0
    s_lshr_b32 s7, s6, 1
    ds_read_b128 a[48:51], v22 offset:20480
    ds_read_b128 a[52:55], v23 offset:20480
    s_waitcnt lgkmcnt(6)
    v_mfma_f32_16x16x32_bf16 v[140:143], v[44:47], a[28:31], v[140:143]
    s_lshl2_add_u32 s7, s5, s7
    ds_read_b128 a[56:59], v22 offset:22528
    ds_read_b128 a[60:63], v23 offset:22528
    s_waitcnt lgkmcnt(7)
    v_mfma_f32_16x16x32_bf16 v[144:147], v[40:43], a[32:35], 0
    s_and_b32 s3, s6, 1
    buffer_load_dwordx4 v2, s[16:19], s60 offen nt lds
    s_waitcnt lgkmcnt(6)
    v_mfma_f32_16x16x32_bf16 v[144:147], v[44:47], a[36:39], v[144:147]
    s_mul_i32 s98, s7, 36864
    ds_read_b128 a[64:67], v22 offset:49152
    ds_read_b64_tr_b16 v[48:49], v15 offset:32768
    s_waitcnt lgkmcnt(7)
    v_mfma_f32_16x16x32_bf16 v[148:151], v[40:43], a[40:43], 0
    s_mul_i32 s99, s3, 576
    buffer_load_dwordx4 v3, s[16:19], s60 offen offset:1024 nt lds
    s_waitcnt lgkmcnt(6)
    v_mfma_f32_16x16x32_bf16 v[148:151], v[44:47], a[44:47], v[148:151]
    s_add_u32 s98, s98, s99
    ds_read_b64_tr_b16 v[50:51], v15 offset:33792
    ds_read_b128 a[68:71], v23 offset:49152
    s_waitcnt lgkmcnt(6)
    v_mfma_f32_16x16x32_bf16 v[152:155], v[40:43], a[48:51], 0
    s_mul_i32 s99, s3, 18432
    ds_read_b64_tr_b16 v[52:53], v15 offset:40960
    ds_read_b64_tr_b16 v[54:55], v15 offset:41984
    v_mfma_f32_16x16x32_bf16 v[152:155], v[44:47], a[52:55], v[152:155]
    s_waitcnt lgkmcnt(6)
    buffer_load_dwordx4 v4, s[16:19], s60 offen offset:2048 nt lds
    v_mfma_f32_16x16x32_bf16 v[156:159], v[40:43], a[56:59], 0
    ds_read_b128 a[72:75], v22 offset:51200
    ds_read_b64_tr_b16 v[56:57], v16 offset:32768
    v_mfma_f32_16x16x32_bf16 v[156:159], v[44:47], a[60:63], v[156:159]
    s_waitcnt lgkmcnt(5)
    ds_read_b64_tr_b16 v[58:59], v16 offset:33792
    ds_read_b64_tr_b16 v[60:61], v16 offset:40960
    v_mfma_f32_16x16x32_bf16 v[160:163], v[48:51], a[0:3], 0
    s_waitcnt lgkmcnt(4)
    ds_read_b64_tr_b16 v[62:63], v16 offset:41984
    ds_read_b64_tr_b16 v[40:41], v17 offset:32768
    v_mfma_f32_16x16x32_bf16 v[160:163], v[52:55], a[4:7], v[160:163]
    ds_read_b64_tr_b16 v[42:43], v17 offset:33792
    ds_read_b64_tr_b16 v[44:45], v17 offset:40960
    v_mfma_f32_16x16x32_bf16 v[164:167], v[48:51], a[8:11], 0
    buffer_load_dwordx4 v5, s[16:19], s60 offen offset:3072 nt lds
    v_mfma_f32_16x16x32_bf16 v[164:167], v[52:55], a[12:15], v[164:167]
    ds_read_b128 a[76:79], v23 offset:51200
    ds_read_b64_tr_b16 v[46:47], v17 offset:41984
    v_mfma_f32_16x16x32_bf16 v[168:171], v[48:51], a[16:19], 0
    v_add_u32 v14, 0x10000, v14
    v_add_u32 v15, 0x10000, v15
    v_mfma_f32_16x16x32_bf16 v[168:171], v[52:55], a[20:23], v[168:171]
    v_add_u32 v16, 0x10000, v16
    v_add_u32 v17, 0x10000, v17
    v_mfma_f32_16x16x32_bf16 v[172:175], v[48:51], a[24:27], 0
    v_mov_b32 v31, 1
    v_add_u32 v18, 0x10000, v18
    v_mfma_f32_16x16x32_bf16 v[172:175], v[52:55], a[28:31], v[172:175]
    v_add_u32 v19, 0x10000, v19
    v_add_u32 v20, 0x10000, v20
    v_mfma_f32_16x16x32_bf16 v[176:179], v[48:51], a[32:35], 0
    s_add_u32 m0, s69, 147456
    ds_read_b128 a[80:83], v22 offset:53248
    v_add_u32 v21, 0x10000, v21
    v_mfma_f32_16x16x32_bf16 v[176:179], v[52:55], a[36:39], v[176:179]
    s_add_u32 s60, s60, 524288
    buffer_load_dwordx4 v6, s[8:11], s62 offen lds
    v_mfma_f32_16x16x32_bf16 v[180:183], v[48:51], a[40:43], 0
    v_add_u32 v26, 0x10000, v26
    v_add_u32 v27, 0x10000, v27
    v_mfma_f32_16x16x32_bf16 v[180:183], v[52:55], a[44:47], v[180:183]
    v_add_u32 v28, 0x10000, v28
    v_add_u32 v29, 0x10000, v29
    v_mfma_f32_16x16x32_bf16 v[184:187], v[48:51], a[48:51], 0
    v_mfma_f32_16x16x32_bf16 v[184:187], v[52:55], a[52:55], v[184:187]
    ds_read_b128 a[84:87], v23 offset:53248
    v_mfma_f32_16x16x32_bf16 v[188:191], v[48:51], a[56:59], 0
    v_mfma_f32_16x16x32_bf16 v[188:191], v[52:55], a[60:63], v[188:191]
    s_waitcnt lgkmcnt(1)
    buffer_load_dwordx4 v7, s[8:11], s62 offen offset:1024 lds
    v_mfma_f32_16x16x32_bf16 v[192:195], v[56:59], a[0:3], 0
    v_mfma_f32_16x16x32_bf16 v[192:195], v[60:63], a[4:7], v[192:195]
    v_mfma_f32_16x16x32_bf16 v[196:199], v[56:59], a[8:11], 0
    v_mfma_f32_16x16x32_bf16 v[196:199], v[60:63], a[12:15], v[196:199]
    ds_read_b128 a[88:91], v22 offset:55296
    v_mfma_f32_16x16x32_bf16 v[200:203], v[56:59], a[16:19], 0
    v_mfma_f32_16x16x32_bf16 v[200:203], v[60:63], a[20:23], v[200:203]
    buffer_load_dwordx4 v8, s[8:11], s62 offen offset:2048 lds
    v_mfma_f32_16x16x32_bf16 v[204:207], v[56:59], a[24:27], 0
    v_mfma_f32_16x16x32_bf16 v[204:207], v[60:63], a[28:31], v[204:207]
    v_mfma_f32_16x16x32_bf16 v[208:211], v[56:59], a[32:35], 0
    ds_read_b128 a[92:95], v23 offset:55296
    v_mfma_f32_16x16x32_bf16 v[208:211], v[60:63], a[36:39], v[208:211]
    v_mfma_f32_16x16x32_bf16 v[212:215], v[56:59], a[40:43], 0
    v_mfma_f32_16x16x32_bf16 v[212:215], v[60:63], a[44:47], v[212:215]
    buffer_load_dwordx4 v9, s[8:11], s62 offen offset:3072 lds
    v_mfma_f32_16x16x32_bf16 v[216:219], v[56:59], a[48:51], 0
    v_mfma_f32_16x16x32_bf16 v[216:219], v[60:63], a[52:55], v[216:219]
    v_mfma_f32_16x16x32_bf16 v[220:223], v[56:59], a[56:59], 0
    v_mfma_f32_16x16x32_bf16 v[220:223], v[60:63], a[60:63], v[220:223]
    v_mfma_f32_16x16x32_bf16 v[224:227], v[40:43], a[0:3], 0
    v_mfma_f32_16x16x32_bf16 v[224:227], v[44:47], a[4:7], v[224:227]
    s_add_u32 s62, s62, 128
    v_mfma_f32_16x16x32_bf16 v[228:231], v[40:43], a[8:11], 0
    buffer_load_dword v104, v103, s[20:23], s77 offen
    v_mfma_f32_16x16x32_bf16 v[228:231], v[44:47], a[12:15], v[228:231]
    s_add_u32 s77, s77, 4608
    v_mfma_f32_16x16x32_bf16 v[232:235], v[40:43], a[16:19], 0
    v_mfma_f32_16x16x32_bf16 v[232:235], v[44:47], a[20:23], v[232:235]
    s_waitcnt vmcnt(27)
    s_barrier
    ds_read_b64_tr_b16 v[48:49], v14 offset:0
    v_mfma_f32_16x16x32_bf16 v[236:239], v[40:43], a[24:27], 0
    s_add_u32 m0, s69, 0
    ds_read_b64_tr_b16 v[50:51], v14 offset:1024
    ds_read_b64_tr_b16 v[52:53], v14 offset:8192
    v_mfma_f32_16x16x32_bf16 v[236:239], v[44:47], a[28:31], v[236:239]
    buffer_load_dwordx4 v2, s[12:15], s60 offen nt lds
    v_mfma_f32_16x16x32_bf16 v[240:243], v[40:43], a[32:35], 0
    ds_read_b64_tr_b16 v[54:55], v14 offset:9216
    ds_read_b64_tr_b16 v[56:57], v15 offset:0
    v_mfma_f32_16x16x32_bf16 v[240:243], v[44:47], a[36:39], v[240:243]
    ds_read_b64_tr_b16 v[58:59], v15 offset:1024
    ds_read_b64_tr_b16 v[60:61], v15 offset:8192
    v_mfma_f32_16x16x32_bf16 v[244:247], v[40:43], a[40:43], 0
    ds_read_b64_tr_b16 v[62:63], v15 offset:9216
    v_mfma_f32_16x16x32_bf16 v[244:247], v[44:47], a[44:47], v[244:247]
    v_mfma_f32_16x16x32_bf16 v[248:251], v[40:43], a[48:51], 0
    v_mfma_f32_16x16x32_bf16 v[248:251], v[44:47], a[52:55], v[248:251]
    buffer_load_dwordx4 v3, s[12:15], s60 offen offset:1024 nt lds
    v_mfma_f32_16x16x32_bf16 v[252:255], v[40:43], a[56:59], 0
    ds_read_b64_tr_b16 v[40:41], v16 offset:0
    ds_read_b64_tr_b16 v[42:43], v16 offset:1024
    v_mfma_f32_16x16x32_bf16 v[252:255], v[44:47], a[60:63], v[252:255]
    s_waitcnt lgkmcnt(2)
    ds_read_b64_tr_b16 v[44:45], v16 offset:8192
    ds_read_b64_tr_b16 v[46:47], v16 offset:9216
    v_mfma_f32_16x16x32_bf16 a[128:131], a[0:3], v[48:51], 0
    v_mfma_f32_16x16x32_bf16 a[128:131], a[4:7], v[52:55], a[128:131]
    v_add_u32 v22, 0x10000, v22
    v_mfma_f32_16x16x32_bf16 a[132:135], a[8:11], v[48:51], 0
    ds_read_b128 a[96:99], v22 offset:16384
    v_mfma_f32_16x16x32_bf16 a[132:135], a[12:15], v[52:55], a[132:135]
    v_mfma_f32_16x16x32_bf16 a[136:139], a[16:19], v[48:51], 0
    v_mfma_f32_16x16x32_bf16 a[136:139], a[20:23], v[52:55], a[136:139]
    buffer_load_dwordx4 v4, s[12:15], s60 offen offset:2048 nt lds
    v_mfma_f32_16x16x32_bf16 a[140:143], a[24:27], v[48:51], 0
    v_add_u32 v23, 0x10000, v23
    v_mfma_f32_16x16x32_bf16 a[140:143], a[28:31], v[52:55], a[140:143]
    ds_read_b128 a[100:103], v23 offset:16384
    v_mfma_f32_16x16x32_bf16 a[144:147], a[32:35], v[48:51], 0
    v_mfma_f32_16x16x32_bf16 a[144:147], a[36:39], v[52:55], a[144:147]
    v_mfma_f32_16x16x32_bf16 a[148:151], a[40:43], v[48:51], 0
    v_mfma_f32_16x16x32_bf16 a[148:151], a[44:47], v[52:55], a[148:151]
    v_mfma_f32_16x16x32_bf16 a[152:155], a[48:51], v[48:51], 0
    buffer_load_dwordx4 v5, s[12:15], s60 offen offset:3072 nt lds
    v_mfma_f32_16x16x32_bf16 a[152:155], a[52:55], v[52:55], a[152:155]
    ds_read_b128 a[104:107], v22 offset:18432
    v_mfma_f32_16x16x32_bf16 a[156:159], a[56:59], v[48:51], 0
    ds_read_b64_tr_b16 v[48:49], v17 offset:0
    ds_read_b64_tr_b16 v[50:51], v17 offset:1024
    v_mfma_f32_16x16x32_bf16 a[156:159], a[60:63], v[52:55], a[156:159]
    ds_read_b64_tr_b16 v[52:53], v17 offset:8192
    ds_read_b64_tr_b16 v[54:55], v17 offset:9216
    v_mfma_f32_16x16x32_bf16 a[160:163], a[0:3], v[56:59], 0
    v_mfma_f32_16x16x32_bf16 a[160:163], a[4:7], v[60:63], a[160:163]
    v_mfma_f32_16x16x32_bf16 a[164:167], a[8:11], v[56:59], 0
    ds_read_b128 a[108:111], v23 offset:18432
    v_mfma_f32_16x16x32_bf16 a[164:167], a[12:15], v[60:63], a[164:167]
    s_add_u32 m0, s69, 16384
    v_mfma_f32_16x16x32_bf16 a[168:171], a[16:19], v[56:59], 0
    buffer_load_dwordx4 v6, s[8:11], s61 offen lds
    v_mfma_f32_16x16x32_bf16 a[168:171], a[20:23], v[60:63], a[168:171]
    v_mfma_f32_16x16x32_bf16 a[172:175], a[24:27], v[56:59], 0
    v_mfma_f32_16x16x32_bf16 a[172:175], a[28:31], v[60:63], a[172:175]
    v_mfma_f32_16x16x32_bf16 a[176:179], a[32:35], v[56:59], 0
    ds_read_b128 a[112:115], v22 offset:20480
    v_mfma_f32_16x16x32_bf16 a[176:179], a[36:39], v[60:63], a[176:179]
    v_mfma_f32_16x16x32_bf16 a[180:183], a[40:43], v[56:59], 0
    v_mfma_f32_16x16x32_bf16 a[180:183], a[44:47], v[60:63], a[180:183]
    buffer_load_dwordx4 v7, s[8:11], s61 offen offset:1024 lds
    v_mfma_f32_16x16x32_bf16 a[184:187], a[48:51], v[56:59], 0
    v_mfma_f32_16x16x32_bf16 a[184:187], a[52:55], v[60:63], a[184:187]
    ds_read_b128 a[116:119], v23 offset:20480
    v_mfma_f32_16x16x32_bf16 a[188:191], a[56:59], v[56:59], 0
    v_mfma_f32_16x16x32_bf16 a[188:191], a[60:63], v[60:63], a[188:191]
    s_waitcnt lgkmcnt(1)
    v_mfma_f32_16x16x32_bf16 a[192:195], a[0:3], v[40:43], 0
    v_mfma_f32_16x16x32_bf16 a[192:195], a[4:7], v[44:47], a[192:195]
    v_mfma_f32_16x16x32_bf16 a[196:199], a[8:11], v[40:43], 0
    v_mfma_f32_16x16x32_bf16 a[196:199], a[12:15], v[44:47], a[196:199]
    buffer_load_dwordx4 v8, s[8:11], s61 offen offset:2048 lds
    v_mfma_f32_16x16x32_bf16 a[200:203], a[16:19], v[40:43], 0
    ds_read_b128 a[120:123], v22 offset:22528
    v_mfma_f32_16x16x32_bf16 a[200:203], a[20:23], v[44:47], a[200:203]
    v_mfma_f32_16x16x32_bf16 a[204:207], a[24:27], v[40:43], 0
    v_mfma_f32_16x16x32_bf16 a[204:207], a[28:31], v[44:47], a[204:207]
    v_mfma_f32_16x16x32_bf16 a[208:211], a[32:35], v[40:43], 0
    ds_read_b128 a[124:127], v23 offset:22528
    v_mfma_f32_16x16x32_bf16 a[208:211], a[36:39], v[44:47], a[208:211]
    v_mfma_f32_16x16x32_bf16 a[212:215], a[40:43], v[40:43], 0
    buffer_load_dwordx4 v9, s[8:11], s61 offen offset:3072 lds
    v_mfma_f32_16x16x32_bf16 a[212:215], a[44:47], v[44:47], a[212:215]
    v_mfma_f32_16x16x32_bf16 a[216:219], a[48:51], v[40:43], 0
    v_mfma_f32_16x16x32_bf16 a[216:219], a[52:55], v[44:47], a[216:219]
    v_mfma_f32_16x16x32_bf16 a[220:223], a[56:59], v[40:43], 0
    v_mfma_f32_16x16x32_bf16 a[220:223], a[60:63], v[44:47], a[220:223]
    v_mfma_f32_16x16x32_bf16 a[224:227], a[0:3], v[48:51], 0
    v_mfma_f32_16x16x32_bf16 a[224:227], a[4:7], v[52:55], a[224:227]
    s_add_u32 s61, s61, 128
    v_mfma_f32_16x16x32_bf16 a[228:231], a[8:11], v[48:51], 0
    v_mfma_f32_16x16x32_bf16 a[228:231], a[12:15], v[52:55], a[228:231]
    v_mfma_f32_16x16x32_bf16 a[232:235], a[16:19], v[48:51], 0
    v_mfma_f32_16x16x32_bf16 a[232:235], a[20:23], v[52:55], a[232:235]
    s_waitcnt vmcnt(27)
    s_barrier
    ds_read_b64_tr_b16 v[56:57], v14 offset:32768
    v_mfma_f32_16x16x32_bf16 a[236:239], a[24:27], v[48:51], 0
    s_add_u32 m0, s69, 32768
    ds_read_b64_tr_b16 v[58:59], v14 offset:33792
    ds_read_b64_tr_b16 v[60:61], v14 offset:40960
    v_mfma_f32_16x16x32_bf16 a[236:239], a[28:31], v[52:55], a[236:239]
    buffer_load_dwordx4 v2, s[16:19], s60 offen nt lds
    v_mfma_f32_16x16x32_bf16 a[240:243], a[32:35], v[48:51], 0
    buffer_load_dword v105, v103, s[20:23], s77 offen
    v_mfma_f32_16x16x32_bf16 a[240:243], a[36:39], v[52:55], a[240:243]
    s_mul_i32 s77, s2, 18432
    ds_read_b64_tr_b16 v[62:63], v14 offset:41984
    ds_read_b64_tr_b16 v[40:41], v15 offset:32768
    v_mfma_f32_16x16x32_bf16 a[244:247], a[40:43], v[48:51], 0
    s_add_u32 s77, s77, s76
    ds_read_b64_tr_b16 v[42:43], v15 offset:33792
    ds_read_b64_tr_b16 v[44:45], v15 offset:40960
    v_mfma_f32_16x16x32_bf16 a[244:247], a[44:47], v[52:55], a[244:247]
    s_mul_i32 s76, s4, 1152
    ds_read_b64_tr_b16 v[46:47], v15 offset:41984
    v_add_u32 v14, 0x10000, v14
    v_mfma_f32_16x16x32_bf16 a[248:251], a[48:51], v[48:51], 0
    v_add_u32 v15, 0x10000, v15
    v_mfma_f32_16x16x32_bf16 a[248:251], a[52:55], v[52:55], a[248:251]
    buffer_load_dwordx4 v3, s[16:19], s60 offen offset:1024 nt lds
    v_mfma_f32_16x16x32_bf16 a[252:255], a[56:59], v[48:51], 0
    ds_read_b64_tr_b16 v[48:49], v16 offset:32768
    ds_read_b64_tr_b16 v[50:51], v16 offset:33792
    v_mfma_f32_16x16x32_bf16 a[252:255], a[60:63], v[52:55], a[252:255]
    s_waitcnt lgkmcnt(3)
    ds_read_b64_tr_b16 v[52:53], v16 offset:40960
    ds_read_b64_tr_b16 v[54:55], v16 offset:41984
    v_mfma_f32_16x16x32_bf16 v[128:131], v[56:59], a[64:67], v[128:131]
    v_add_u32 v16, 0x10000, v16
    v_mfma_f32_16x16x32_bf16 v[128:131], v[60:63], a[68:71], v[128:131]
    v_mfma_f32_16x16x32_bf16 v[132:135], v[56:59], a[72:75], v[132:135]
    ds_read_b128 a[0:3], v22 offset:49152
    v_mfma_f32_16x16x32_bf16 v[132:135], v[60:63], a[76:79], v[132:135]
    v_mfma_f32_16x16x32_bf16 v[136:139], v[56:59], a[80:83], v[136:139]
    v_mfma_f32_16x16x32_bf16 v[136:139], v[60:63], a[84:87], v[136:139]
    buffer_load_dwordx4 v4, s[16:19], s60 offen offset:2048 nt lds
    v_mfma_f32_16x16x32_bf16 v[140:143], v[56:59], a[88:91], v[140:143]
    v_mfma_f32_16x16x32_bf16 v[140:143], v[60:63], a[92:95], v[140:143]
    ds_read_b128 a[4:7], v23 offset:49152
    v_mfma_f32_16x16x32_bf16 v[144:147], v[56:59], a[96:99], v[144:147]
    v_mfma_f32_16x16x32_bf16 v[144:147], v[60:63], a[100:103], v[144:147]
    v_mfma_f32_16x16x32_bf16 v[148:151], v[56:59], a[104:107], v[148:151]
    v_mfma_f32_16x16x32_bf16 v[148:151], v[60:63], a[108:111], v[148:151]
    v_mfma_f32_16x16x32_bf16 v[152:155], v[56:59], a[112:115], v[152:155]
    buffer_load_dwordx4 v5, s[16:19], s60 offen offset:3072 nt lds
    v_mfma_f32_16x16x32_bf16 v[152:155], v[60:63], a[116:119], v[152:155]
    ds_read_b128 a[8:11], v22 offset:51200
    v_mfma_f32_16x16x32_bf16 v[156:159], v[56:59], a[120:123], v[156:159]
    ds_read_b64_tr_b16 v[56:57], v17 offset:32768
    ds_read_b64_tr_b16 v[58:59], v17 offset:33792
    v_mfma_f32_16x16x32_bf16 v[156:159], v[60:63], a[124:127], v[156:159]
    ds_read_b64_tr_b16 v[60:61], v17 offset:40960
    ds_read_b64_tr_b16 v[62:63], v17 offset:41984
    v_mfma_f32_16x16x32_bf16 v[160:163], v[40:43], a[64:67], v[160:163]
    s_waitcnt lgkmcnt(5)
    v_add_u32 v17, 0x10000, v17
    v_mfma_f32_16x16x32_bf16 v[160:163], v[44:47], a[68:71], v[160:163]
    v_mfma_f32_16x16x32_bf16 v[164:167], v[40:43], a[72:75], v[164:167]
    ds_read_b128 a[12:15], v23 offset:51200
    v_mfma_f32_16x16x32_bf16 v[164:167], v[44:47], a[76:79], v[164:167]
    s_add_u32 m0, s69, 49152
    v_mfma_f32_16x16x32_bf16 v[168:171], v[40:43], a[80:83], v[168:171]
    s_add_u32 s60, s60, 524288
    buffer_load_dwordx4 v6, s[8:11], s62 offen lds
    v_mfma_f32_16x16x32_bf16 v[168:171], v[44:47], a[84:87], v[168:171]
    v_mfma_f32_16x16x32_bf16 v[172:175], v[40:43], a[88:91], v[172:175]
    v_mfma_f32_16x16x32_bf16 v[172:175], v[44:47], a[92:95], v[172:175]
    v_mfma_f32_16x16x32_bf16 v[176:179], v[40:43], a[96:99], v[176:179]
    ds_read_b128 a[16:19], v22 offset:53248
    v_mfma_f32_16x16x32_bf16 v[176:179], v[44:47], a[100:103], v[176:179]
    v_mfma_f32_16x16x32_bf16 v[180:183], v[40:43], a[104:107], v[180:183]
    v_mfma_f32_16x16x32_bf16 v[180:183], v[44:47], a[108:111], v[180:183]
    buffer_load_dwordx4 v7, s[8:11], s62 offen offset:1024 lds
    v_mfma_f32_16x16x32_bf16 v[184:187], v[40:43], a[112:115], v[184:187]
    v_mfma_f32_16x16x32_bf16 v[184:187], v[44:47], a[116:119], v[184:187]
    ds_read_b128 a[20:23], v23 offset:53248
    v_mfma_f32_16x16x32_bf16 v[188:191], v[40:43], a[120:123], v[188:191]
    v_mfma_f32_16x16x32_bf16 v[188:191], v[44:47], a[124:127], v[188:191]
    v_mfma_f32_16x16x32_bf16 v[192:195], v[48:51], a[64:67], v[192:195]
    v_mfma_f32_16x16x32_bf16 v[192:195], v[52:55], a[68:71], v[192:195]
    v_mfma_f32_16x16x32_bf16 v[196:199], v[48:51], a[72:75], v[196:199]
    v_mfma_f32_16x16x32_bf16 v[196:199], v[52:55], a[76:79], v[196:199]
    buffer_load_dwordx4 v8, s[8:11], s62 offen offset:2048 lds
    v_mfma_f32_16x16x32_bf16 v[200:203], v[48:51], a[80:83], v[200:203]
    ds_read_b128 a[24:27], v22 offset:55296
    v_mfma_f32_16x16x32_bf16 v[200:203], v[52:55], a[84:87], v[200:203]
    v_mfma_f32_16x16x32_bf16 v[204:207], v[48:51], a[88:91], v[204:207]
    v_mfma_f32_16x16x32_bf16 v[204:207], v[52:55], a[92:95], v[204:207]
    v_mfma_f32_16x16x32_bf16 v[208:211], v[48:51], a[96:99], v[208:211]
    ds_read_b128 a[28:31], v23 offset:55296
    v_mfma_f32_16x16x32_bf16 v[208:211], v[52:55], a[100:103], v[208:211]
    v_mfma_f32_16x16x32_bf16 v[212:215], v[48:51], a[104:107], v[212:215]
    buffer_load_dwordx4 v9, s[8:11], s62 offen offset:3072 lds
    v_mfma_f32_16x16x32_bf16 v[212:215], v[52:55], a[108:111], v[212:215]
    v_mfma_f32_16x16x32_bf16 v[216:219], v[48:51], a[112:115], v[216:219]
    v_mfma_f32_16x16x32_bf16 v[216:219], v[52:55], a[116:119], v[216:219]
    v_mfma_f32_16x16x32_bf16 v[220:223], v[48:51], a[120:123], v[220:223]
    v_mfma_f32_16x16x32_bf16 v[220:223], v[52:55], a[124:127], v[220:223]
    s_waitcnt lgkmcnt(0)
    v_mfma_f32_16x16x32_bf16 v[224:227], v[56:59], a[64:67], v[224:227]
    v_mfma_f32_16x16x32_bf16 v[224:227], v[60:63], a[68:71], v[224:227]
    s_add_u32 s62, s62, 128
    v_mfma_f32_16x16x32_bf16 v[228:231], v[56:59], a[72:75], v[228:231]
    v_mfma_f32_16x16x32_bf16 v[228:231], v[60:63], a[76:79], v[228:231]
    v_mfma_f32_16x16x32_bf16 v[232:235], v[56:59], a[80:83], v[232:235]
    v_mfma_f32_16x16x32_bf16 v[232:235], v[60:63], a[84:87], v[232:235]
    s_waitcnt vmcnt(18)
    s_barrier
    v_cndmask_b32 v82, v82, v92, s[92:93]
    v_mfma_f32_16x16x32_bf16 v[236:239], v[56:59], a[88:91], v[236:239]
    s_add_u32 m0, s69, 65536
    v_cndmask_b32_e64 v83, v83, 0, s[92:93]
    v_cndmask_b32 v86, v86, v93, s[92:93]
    v_mfma_f32_16x16x32_bf16 v[236:239], v[60:63], a[92:95], v[236:239]
    buffer_store_dwordx4 v[80:83], v95, s[28:31], s72 offen sc1
    v_mfma_f32_16x16x32_bf16 v[240:243], v[56:59], a[96:99], v[240:243]
    s_mov_b32 s72, 4096
    v_cndmask_b32_e64 v87, v87, 0, s[92:93]
    v_cndmask_b32 v90, v90, v94, s[92:93]
    v_mfma_f32_16x16x32_bf16 v[240:243], v[60:63], a[100:103], v[240:243]
    buffer_store_dwordx4 v[84:87], v95, s[28:31], s72 offen sc1
    v_mfma_f32_16x16x32_bf16 v[244:247], v[56:59], a[104:107], v[244:247]
    s_mov_b32 s72, 8192
    s_cmp_eq_u32 s4, 0
    s_cselect_b32 s72, s72, 1073741824
    v_mfma_f32_16x16x32_bf16 v[244:247], v[60:63], a[108:111], v[244:247]
    v_cndmask_b32_e64 v91, v91, 0, s[92:93]
    ds_read_b64_tr_b16 v[40:41], v14 offset:0
    v_mfma_f32_16x16x32_bf16 v[248:251], v[56:59], a[112:115], v[248:251]
    buffer_store_dwordx4 v[88:91], v95, s[28:31], s72 offen sc1
    v_mfma_f32_16x16x32_bf16 v[248:251], v[60:63], a[116:119], v[248:251]
    buffer_load_dwordx4 v2, s[12:15], s60 offen nt lds
    v_mfma_f32_16x16x32_bf16 v[252:255], v[56:59], a[120:123], v[252:255]
    ds_read_b64_tr_b16 v[42:43], v14 offset:1024
    ds_read_b64_tr_b16 v[44:45], v14 offset:8192
    v_mfma_f32_16x16x32_bf16 v[252:255], v[60:63], a[124:127], v[252:255]
    s_waitcnt lgkmcnt(1)
    ds_read_b64_tr_b16 v[46:47], v14 offset:9216
    ds_read_b64_tr_b16 v[48:49], v15 offset:0
    v_mfma_f32_16x16x32_bf16 a[128:131], a[64:67], v[40:43], a[128:131]
    s_waitcnt lgkmcnt(1)
    buffer_load_dword v106, v103, s[24:27], s77 offen
    v_mfma_f32_16x16x32_bf16 a[128:131], a[68:71], v[44:47], a[128:131]
    s_add_u32 s77, s77, 4608
    buffer_load_dwordx4 v3, s[12:15], s60 offen offset:1024 nt lds
    v_mfma_f32_16x16x32_bf16 a[132:135], a[72:75], v[40:43], a[132:135]
    v_add_u32 v22, 0x10000, v22
    ds_read_b128 a[32:35], v22 offset:16384
    v_mfma_f32_16x16x32_bf16 a[132:135], a[76:79], v[44:47], a[132:135]
    ds_read_b64_tr_b16 v[50:51], v15 offset:1024
    ds_read_b64_tr_b16 v[52:53], v15 offset:8192
    v_mfma_f32_16x16x32_bf16 a[136:139], a[80:83], v[40:43], a[136:139]
    ds_read_b64_tr_b16 v[54:55], v15 offset:9216
    ds_read_b64_tr_b16 v[56:57], v16 offset:0
    v_mfma_f32_16x16x32_bf16 a[136:139], a[84:87], v[44:47], a[136:139]
    buffer_load_dwordx4 v4, s[12:15], s60 offen offset:2048 nt lds
    v_mfma_f32_16x16x32_bf16 a[140:143], a[88:91], v[40:43], a[140:143]
    v_add_u32 v23, 0x10000, v23
    ds_read_b64_tr_b16 v[58:59], v16 offset:1024
    v_mfma_f32_16x16x32_bf16 a[140:143], a[92:95], v[44:47], a[140:143]
    ds_read_b128 a[36:39], v23 offset:16384
    ds_read_b64_tr_b16 v[60:61], v16 offset:8192
    v_mfma_f32_16x16x32_bf16 a[144:147], a[96:99], v[40:43], a[144:147]
    ds_read_b64_tr_b16 v[62:63], v16 offset:9216
    v_add_u32 v14, 0xfffe0000, v14
    v_mfma_f32_16x16x32_bf16 a[144:147], a[100:103], v[44:47], a[144:147]
    v_add_u32 v15, 0xfffe0000, v15
    v_add_u32 v16, 0xfffe0000, v16
    v_mfma_f32_16x16x32_bf16 a[148:151], a[104:107], v[40:43], a[148:151]
    v_mfma_f32_16x16x32_bf16 a[148:151], a[108:111], v[44:47], a[148:151]
    v_mfma_f32_16x16x32_bf16 a[152:155], a[112:115], v[40:43], a[152:155]
    buffer_load_dwordx4 v5, s[12:15], s60 offen offset:3072 nt lds
    v_mfma_f32_16x16x32_bf16 a[152:155], a[116:119], v[44:47], a[152:155]
    ds_read_b128 a[40:43], v22 offset:18432
    v_mfma_f32_16x16x32_bf16 a[156:159], a[120:123], v[40:43], a[156:159]
    ds_read_b64_tr_b16 v[40:41], v17 offset:0
    ds_read_b64_tr_b16 v[42:43], v17 offset:1024
    v_mfma_f32_16x16x32_bf16 a[156:159], a[124:127], v[44:47], a[156:159]
    s_waitcnt lgkmcnt(3)
    ds_read_b64_tr_b16 v[44:45], v17 offset:8192
    ds_read_b64_tr_b16 v[46:47], v17 offset:9216
    v_mfma_f32_16x16x32_bf16 a[160:163], a[64:67], v[48:51], a[160:163]
    v_add_u32 v17, 0xfffe0000, v17
    v_mfma_f32_16x16x32_bf16 a[160:163], a[68:71], v[52:55], a[160:163]
    v_mfma_f32_16x16x32_bf16 a[164:167], a[72:75], v[48:51], a[164:167]
    ds_read_b128 a[44:47], v23 offset:18432
    v_mfma_f32_16x16x32_bf16 a[164:167], a[76:79], v[52:55], a[164:167]
    s_add_u32 m0, s69, 81920
    v_mfma_f32_16x16x32_bf16 a[168:171], a[80:83], v[48:51], a[168:171]
    buffer_load_dwordx4 v6, s[8:11], s61 offen lds
    v_mfma_f32_16x16x32_bf16 a[168:171], a[84:87], v[52:55], a[168:171]
    v_mfma_f32_16x16x32_bf16 a[172:175], a[88:91], v[48:51], a[172:175]
    v_mfma_f32_16x16x32_bf16 a[172:175], a[92:95], v[52:55], a[172:175]
    v_mfma_f32_16x16x32_bf16 a[176:179], a[96:99], v[48:51], a[176:179]
    ds_read_b128 a[48:51], v22 offset:20480
    v_mfma_f32_16x16x32_bf16 a[176:179], a[100:103], v[52:55], a[176:179]
    v_mfma_f32_16x16x32_bf16 a[180:183], a[104:107], v[48:51], a[180:183]
    v_mfma_f32_16x16x32_bf16 a[180:183], a[108:111], v[52:55], a[180:183]
    buffer_load_dwordx4 v7, s[8:11], s61 offen offset:1024 lds
    v_mfma_f32_16x16x32_bf16 a[184:187], a[112:115], v[48:51], a[184:187]
    v_mfma_f32_16x16x32_bf16 a[184:187], a[116:119], v[52:55], a[184:187]
    ds_read_b128 a[52:55], v23 offset:20480
    v_mfma_f32_16x16x32_bf16 a[188:191], a[120:123], v[48:51], a[188:191]
    v_mfma_f32_16x16x32_bf16 a[188:191], a[124:127], v[52:55], a[188:191]
    v_mfma_f32_16x16x32_bf16 a[192:195], a[64:67], v[56:59], a[192:195]
    v_mfma_f32_16x16x32_bf16 a[192:195], a[68:71], v[60:63], a[192:195]
    v_mfma_f32_16x16x32_bf16 a[196:199], a[72:75], v[56:59], a[196:199]
    v_mfma_f32_16x16x32_bf16 a[196:199], a[76:79], v[60:63], a[196:199]
    buffer_load_dwordx4 v8, s[8:11], s61 offen offset:2048 lds
    v_mfma_f32_16x16x32_bf16 a[200:203], a[80:83], v[56:59], a[200:203]
    ds_read_b128 a[56:59], v22 offset:22528
    v_mfma_f32_16x16x32_bf16 a[200:203], a[84:87], v[60:63], a[200:203]
    v_mfma_f32_16x16x32_bf16 a[204:207], a[88:91], v[56:59], a[204:207]
    v_mfma_f32_16x16x32_bf16 a[204:207], a[92:95], v[60:63], a[204:207]
    v_mfma_f32_16x16x32_bf16 a[208:211], a[96:99], v[56:59], a[208:211]
    ds_read_b128 a[60:63], v23 offset:22528
    v_mfma_f32_16x16x32_bf16 a[208:211], a[100:103], v[60:63], a[208:211]
    v_mfma_f32_16x16x32_bf16 a[212:215], a[104:107], v[56:59], a[212:215]
    buffer_load_dwordx4 v9, s[8:11], s61 offen offset:3072 lds
    v_mfma_f32_16x16x32_bf16 a[212:215], a[108:111], v[60:63], a[212:215]
    v_mfma_f32_16x16x32_bf16 a[216:219], a[112:115], v[56:59], a[216:219]
    v_mfma_f32_16x16x32_bf16 a[216:219], a[116:119], v[60:63], a[216:219]
    v_mfma_f32_16x16x32_bf16 a[220:223], a[120:123], v[56:59], a[220:223]
    v_mfma_f32_16x16x32_bf16 a[220:223], a[124:127], v[60:63], a[220:223]
    s_waitcnt lgkmcnt(0)
    v_mfma_f32_16x16x32_bf16 a[224:227], a[64:67], v[40:43], a[224:227]
    v_mfma_f32_16x16x32_bf16 a[224:227], a[68:71], v[44:47], a[224:227]
    s_add_u32 s61, s61, 128
    v_mfma_f32_16x16x32_bf16 a[228:231], a[72:75], v[40:43], a[228:231]
    v_mfma_f32_16x16x32_bf16 a[228:231], a[76:79], v[44:47], a[228:231]
    v_mfma_f32_16x16x32_bf16 a[232:235], a[80:83], v[40:43], a[232:235]
    v_mfma_f32_16x16x32_bf16 a[232:235], a[84:87], v[44:47], a[232:235]
    s_waitcnt vmcnt(21)
    s_barrier
    ds_read_b64_tr_b16 v[48:49], v14 offset:0
    v_mfma_f32_16x16x32_bf16 a[236:239], a[88:91], v[40:43], a[236:239]
    s_add_u32 m0, s69, 98304
    ds_read_b64_tr_b16 v[50:51], v14 offset:1024
    ds_read_b64_tr_b16 v[52:53], v14 offset:8192
    v_mfma_f32_16x16x32_bf16 a[236:239], a[92:95], v[44:47], a[236:239]
    buffer_load_dwordx4 v2, s[16:19], s60 offen nt lds
    v_mfma_f32_16x16x32_bf16 a[240:243], a[96:99], v[40:43], a[240:243]
    ds_read_b64_tr_b16 v[54:55], v14 offset:9216
    ds_read_b64_tr_b16 v[56:57], v15 offset:0
    v_mfma_f32_16x16x32_bf16 a[240:243], a[100:103], v[44:47], a[240:243]
    ds_read_b64_tr_b16 v[58:59], v15 offset:1024
    ds_read_b64_tr_b16 v[60:61], v15 offset:8192
    v_mfma_f32_16x16x32_bf16 a[244:247], a[104:107], v[40:43], a[244:247]
    ds_read_b64_tr_b16 v[62:63], v15 offset:9216
    v_mfma_f32_16x16x32_bf16 a[244:247], a[108:111], v[44:47], a[244:247]
    v_mfma_f32_16x16x32_bf16 a[248:251], a[112:115], v[40:43], a[248:251]
    v_mfma_f32_16x16x32_bf16 a[248:251], a[116:119], v[44:47], a[248:251]
    buffer_load_dwordx4 v3, s[16:19], s60 offen offset:1024 nt lds
    v_mfma_f32_16x16x32_bf16 a[252:255], a[120:123], v[40:43], a[252:255]
    ds_read_b64_tr_b16 v[40:41], v16 offset:0
    ds_read_b64_tr_b16 v[42:43], v16 offset:1024
    v_mfma_f32_16x16x32_bf16 a[252:255], a[124:127], v[44:47], a[252:255]
    s_waitcnt lgkmcnt(2)
    ds_read_b64_tr_b16 v[44:45], v16 offset:8192
    ds_read_b64_tr_b16 v[46:47], v16 offset:9216
    v_mfma_f32_16x16x32_bf16 v[128:131], v[48:51], a[0:3], v[128:131]
    v_mfma_f32_16x16x32_bf16 v[128:131], v[52:55], a[4:7], v[128:131]
    v_add_u32 v22, 0xfffe0000, v22
    v_mfma_f32_16x16x32_bf16 v[132:135], v[48:51], a[8:11], v[132:135]
    ds_read_b128 a[64:67], v22 offset:16384
    v_mfma_f32_16x16x32_bf16 v[132:135], v[52:55], a[12:15], v[132:135]
    v_mfma_f32_16x16x32_bf16 v[136:139], v[48:51], a[16:19], v[136:139]
    v_mfma_f32_16x16x32_bf16 v[136:139], v[52:55], a[20:23], v[136:139]
    buffer_load_dword v107, v103, s[24:27], s77 offen
    v_mfma_f32_16x16x32_bf16 v[140:143], v[48:51], a[24:27], v[140:143]
    s_add_u32 s77, s77, 4608
    buffer_load_dwordx4 v4, s[16:19], s60 offen offset:2048 nt lds
    v_mfma_f32_16x16x32_bf16 v[140:143], v[52:55], a[28:31], v[140:143]
    v_add_u32 v23, 0xfffe0000, v23
    ds_read_b128 a[68:71], v23 offset:16384
    v_mfma_f32_16x16x32_bf16 v[144:147], v[48:51], a[32:35], v[144:147]
    v_mfma_f32_16x16x32_bf16 v[144:147], v[52:55], a[36:39], v[144:147]
    v_mfma_f32_16x16x32_bf16 v[148:151], v[48:51], a[40:43], v[148:151]
    v_mfma_f32_16x16x32_bf16 v[148:151], v[52:55], a[44:47], v[148:151]
    v_mfma_f32_16x16x32_bf16 v[152:155], v[48:51], a[48:51], v[152:155]
    buffer_load_dwordx4 v5, s[16:19], s60 offen offset:3072 nt lds
    v_mfma_f32_16x16x32_bf16 v[152:155], v[52:55], a[52:55], v[152:155]
    ds_read_b128 a[72:75], v22 offset:18432
    v_mfma_f32_16x16x32_bf16 v[156:159], v[48:51], a[56:59], v[156:159]
    ds_read_b64_tr_b16 v[48:49], v17 offset:0
    ds_read_b64_tr_b16 v[50:51], v17 offset:1024
    v_mfma_f32_16x16x32_bf16 v[156:159], v[52:55], a[60:63], v[156:159]
    ds_read_b64_tr_b16 v[52:53], v17 offset:8192
    ds_read_b64_tr_b16 v[54:55], v17 offset:9216
    v_mfma_f32_16x16x32_bf16 v[160:163], v[56:59], a[0:3], v[160:163]
    v_mfma_f32_16x16x32_bf16 v[160:163], v[60:63], a[4:7], v[160:163]
    v_mfma_f32_16x16x32_bf16 v[164:167], v[56:59], a[8:11], v[164:167]
    ds_read_b128 a[76:79], v23 offset:18432
    v_mfma_f32_16x16x32_bf16 v[164:167], v[60:63], a[12:15], v[164:167]
    s_add_u32 m0, s69, 114688
    v_mfma_f32_16x16x32_bf16 v[168:171], v[56:59], a[16:19], v[168:171]
    s_add_u32 s60, s60, 524288
    buffer_load_dwordx4 v6, s[8:11], s62 offen lds
    v_mfma_f32_16x16x32_bf16 v[168:171], v[60:63], a[20:23], v[168:171]
    v_mfma_f32_16x16x32_bf16 v[172:175], v[56:59], a[24:27], v[172:175]
    v_mfma_f32_16x16x32_bf16 v[172:175], v[60:63], a[28:31], v[172:175]
    v_mfma_f32_16x16x32_bf16 v[176:179], v[56:59], a[32:35], v[176:179]
    ds_read_b128 a[80:83], v22 offset:20480
    v_mfma_f32_16x16x32_bf16 v[176:179], v[60:63], a[36:39], v[176:179]
    v_mfma_f32_16x16x32_bf16 v[180:183], v[56:59], a[40:43], v[180:183]
    v_mfma_f32_16x16x32_bf16 v[180:183], v[60:63], a[44:47], v[180:183]
    buffer_load_dwordx4 v7, s[8:11], s62 offen offset:1024 lds
    v_mfma_f32_16x16x32_bf16 v[184:187], v[56:59], a[48:51], v[184:187]
    v_mfma_f32_16x16x32_bf16 v[184:187], v[60:63], a[52:55], v[184:187]
    ds_read_b128 a[84:87], v23 offset:20480
    v_mfma_f32_16x16x32_bf16 v[188:191], v[56:59], a[56:59], v[188:191]
    v_mfma_f32_16x16x32_bf16 v[188:191], v[60:63], a[60:63], v[188:191]
    s_waitcnt lgkmcnt(1)
    v_mfma_f32_16x16x32_bf16 v[192:195], v[40:43], a[0:3], v[192:195]
    v_mfma_f32_16x16x32_bf16 v[192:195], v[44:47], a[4:7], v[192:195]
    v_mfma_f32_16x16x32_bf16 v[196:199], v[40:43], a[8:11], v[196:199]
    v_mfma_f32_16x16x32_bf16 v[196:199], v[44:47], a[12:15], v[196:199]
    buffer_load_dwordx4 v8, s[8:11], s62 offen offset:2048 lds
    v_mfma_f32_16x16x32_bf16 v[200:203], v[40:43], a[16:19], v[200:203]
    ds_read_b128 a[88:91], v22 offset:22528
    v_mfma_f32_16x16x32_bf16 v[200:203], v[44:47], a[20:23], v[200:203]
    v_mfma_f32_16x16x32_bf16 v[204:207], v[40:43], a[24:27], v[204:207]
    v_mfma_f32_16x16x32_bf16 v[204:207], v[44:47], a[28:31], v[204:207]
    v_mfma_f32_16x16x32_bf16 v[208:211], v[40:43], a[32:35], v[208:211]
    ds_read_b128 a[92:95], v23 offset:22528
    v_mfma_f32_16x16x32_bf16 v[208:211], v[44:47], a[36:39], v[208:211]
    v_mfma_f32_16x16x32_bf16 v[212:215], v[40:43], a[40:43], v[212:215]
    buffer_load_dwordx4 v9, s[8:11], s62 offen offset:3072 lds
    v_mfma_f32_16x16x32_bf16 v[212:215], v[44:47], a[44:47], v[212:215]
    v_mfma_f32_16x16x32_bf16 v[216:219], v[40:43], a[48:51], v[216:219]
    v_mfma_f32_16x16x32_bf16 v[216:219], v[44:47], a[52:55], v[216:219]
    v_mfma_f32_16x16x32_bf16 v[220:223], v[40:43], a[56:59], v[220:223]
    v_mfma_f32_16x16x32_bf16 v[220:223], v[44:47], a[60:63], v[220:223]
    v_mfma_f32_16x16x32_bf16 v[224:227], v[48:51], a[0:3], v[224:227]
    v_mfma_f32_16x16x32_bf16 v[224:227], v[52:55], a[4:7], v[224:227]
    s_add_u32 s62, s62, 128
    v_mfma_f32_16x16x32_bf16 v[228:231], v[48:51], a[8:11], v[228:231]
    v_mfma_f32_16x16x32_bf16 v[228:231], v[52:55], a[12:15], v[228:231]
    v_mfma_f32_16x16x32_bf16 v[232:235], v[48:51], a[16:19], v[232:235]
    v_mfma_f32_16x16x32_bf16 v[232:235], v[52:55], a[20:23], v[232:235]
    s_waitcnt vmcnt(21)
    s_barrier
    ds_read_b64_tr_b16 v[56:57], v14 offset:32768
    v_mfma_f32_16x16x32_bf16 v[236:239], v[48:51], a[24:27], v[236:239]
    s_add_u32 m0, s69, 131072
    ds_read_b64_tr_b16 v[58:59], v14 offset:33792
    ds_read_b64_tr_b16 v[60:61], v14 offset:40960
    v_mfma_f32_16x16x32_bf16 v[236:239], v[52:55], a[28:31], v[236:239]
    buffer_load_dwordx4 v2, s[12:15], s60 offen nt lds
    v_mfma_f32_16x16x32_bf16 v[240:243], v[48:51], a[32:35], v[240:243]
    ds_read_b64_tr_b16 v[62:63], v14 offset:41984
    ds_read_b64_tr_b16 v[40:41], v15 offset:32768
    v_mfma_f32_16x16x32_bf16 v[240:243], v[52:55], a[36:39], v[240:243]
    ds_read_b64_tr_b16 v[42:43], v15 offset:33792
    ds_read_b64_tr_b16 v[44:45], v15 offset:40960
    v_mfma_f32_16x16x32_bf16 v[244:247], v[48:51], a[40:43], v[244:247]
    ds_read_b64_tr_b16 v[46:47], v15 offset:41984
    v_add_u32 v14, 0x10000, v14
    v_mfma_f32_16x16x32_bf16 v[244:247], v[52:55], a[44:47], v[244:247]
    v_add_u32 v15, 0x10000, v15
    v_mfma_f32_16x16x32_bf16 v[248:251], v[48:51], a[48:51], v[248:251]
    v_mfma_f32_16x16x32_bf16 v[248:251], v[52:55], a[52:55], v[248:251]
    buffer_load_dwordx4 v3, s[12:15], s60 offen offset:1024 nt lds
    v_mfma_f32_16x16x32_bf16 v[252:255], v[48:51], a[56:59], v[252:255]
    ds_read_b64_tr_b16 v[48:49], v16 offset:32768
    ds_read_b64_tr_b16 v[50:51], v16 offset:33792
    v_mfma_f32_16x16x32_bf16 v[252:255], v[52:55], a[60:63], v[252:255]
    s_waitcnt lgkmcnt(2)
    ds_read_b64_tr_b16 v[52:53], v16 offset:40960
    ds_read_b64_tr_b16 v[54:55], v16 offset:41984
    v_mfma_f32_16x16x32_bf16 a[128:131], a[0:3], v[56:59], a[128:131]
    v_add_u32 v16, 0x10000, v16
    v_mfma_f32_16x16x32_bf16 a[128:131], a[4:7], v[60:63], a[128:131]
    v_mfma_f32_16x16x32_bf16 a[132:135], a[8:11], v[56:59], a[132:135]
    ds_read_b128 a[96:99], v22 offset:49152
    v_mfma_f32_16x16x32_bf16 a[132:135], a[12:15], v[60:63], a[132:135]
    v_mfma_f32_16x16x32_bf16 a[136:139], a[16:19], v[56:59], a[136:139]
    v_mfma_f32_16x16x32_bf16 a[136:139], a[20:23], v[60:63], a[136:139]
    buffer_load_dwordx4 v4, s[12:15], s60 offen offset:2048 nt lds
    v_mfma_f32_16x16x32_bf16 a[140:143], a[24:27], v[56:59], a[140:143]
    v_mfma_f32_16x16x32_bf16 a[140:143], a[28:31], v[60:63], a[140:143]
    ds_read_b128 a[100:103], v23 offset:49152
    v_mfma_f32_16x16x32_bf16 a[144:147], a[32:35], v[56:59], a[144:147]
    v_mfma_f32_16x16x32_bf16 a[144:147], a[36:39], v[60:63], a[144:147]
    v_mfma_f32_16x16x32_bf16 a[148:151], a[40:43], v[56:59], a[148:151]
    v_mfma_f32_16x16x32_bf16 a[148:151], a[44:47], v[60:63], a[148:151]
    buffer_load_dword v108, v103, s[24:27], s77 offen
    v_mfma_f32_16x16x32_bf16 a[152:155], a[48:51], v[56:59], a[152:155]
    s_add_u32 s77, s77, 4608
    buffer_load_dwordx4 v5, s[12:15], s60 offen offset:3072 nt lds
    v_mfma_f32_16x16x32_bf16 a[152:155], a[52:55], v[60:63], a[152:155]
    ds_read_b128 a[104:107], v22 offset:51200
    v_mfma_f32_16x16x32_bf16 a[156:159], a[56:59], v[56:59], a[156:159]
    ds_read_b64_tr_b16 v[56:57], v17 offset:32768
    ds_read_b64_tr_b16 v[58:59], v17 offset:33792
    v_mfma_f32_16x16x32_bf16 a[156:159], a[60:63], v[60:63], a[156:159]
    ds_read_b64_tr_b16 v[60:61], v17 offset:40960
    ds_read_b64_tr_b16 v[62:63], v17 offset:41984
    v_mfma_f32_16x16x32_bf16 a[160:163], a[0:3], v[40:43], a[160:163]
    v_add_u32 v17, 0x10000, v17
    v_mfma_f32_16x16x32_bf16 a[160:163], a[4:7], v[44:47], a[160:163]
    v_mfma_f32_16x16x32_bf16 a[164:167], a[8:11], v[40:43], a[164:167]
    ds_read_b128 a[108:111], v23 offset:51200
    v_mfma_f32_16x16x32_bf16 a[164:167], a[12:15], v[44:47], a[164:167]
    s_add_u32 m0, s69, 147456
    v_mfma_f32_16x16x32_bf16 a[168:171], a[16:19], v[40:43], a[168:171]
    buffer_load_dwordx4 v6, s[8:11], s61 offen lds
    v_mfma_f32_16x16x32_bf16 a[168:171], a[20:23], v[44:47], a[168:171]
    v_mfma_f32_16x16x32_bf16 a[172:175], a[24:27], v[40:43], a[172:175]
    v_mfma_f32_16x16x32_bf16 a[172:175], a[28:31], v[44:47], a[172:175]
    v_mfma_f32_16x16x32_bf16 a[176:179], a[32:35], v[40:43], a[176:179]
    ds_read_b128 a[112:115], v22 offset:53248
    v_mfma_f32_16x16x32_bf16 a[176:179], a[36:39], v[44:47], a[176:179]
    v_mfma_f32_16x16x32_bf16 a[180:183], a[40:43], v[40:43], a[180:183]
    v_mfma_f32_16x16x32_bf16 a[180:183], a[44:47], v[44:47], a[180:183]
    buffer_load_dwordx4 v7, s[8:11], s61 offen offset:1024 lds
    v_mfma_f32_16x16x32_bf16 a[184:187], a[48:51], v[40:43], a[184:187]
    v_mfma_f32_16x16x32_bf16 a[184:187], a[52:55], v[44:47], a[184:187]
    ds_read_b128 a[116:119], v23 offset:53248
    v_mfma_f32_16x16x32_bf16 a[188:191], a[56:59], v[40:43], a[188:191]
    v_mfma_f32_16x16x32_bf16 a[188:191], a[60:63], v[44:47], a[188:191]
    s_waitcnt lgkmcnt(1)
    v_mfma_f32_16x16x32_bf16 a[192:195], a[0:3], v[48:51], a[192:195]
    v_mfma_f32_16x16x32_bf16 a[192:195], a[4:7], v[52:55], a[192:195]
    v_mfma_f32_16x16x32_bf16 a[196:199], a[8:11], v[48:51], a[196:199]
    v_mfma_f32_16x16x32_bf16 a[196:199], a[12:15], v[52:55], a[196:199]
    buffer_load_dwordx4 v8, s[8:11], s61 offen offset:2048 lds
    v_mfma_f32_16x16x32_bf16 a[200:203], a[16:19], v[48:51], a[200:203]
    ds_read_b128 a[120:123], v22 offset:55296
    v_mfma_f32_16x16x32_bf16 a[200:203], a[20:23], v[52:55], a[200:203]
    v_mfma_f32_16x16x32_bf16 a[204:207], a[24:27], v[48:51], a[204:207]
    v_mfma_f32_16x16x32_bf16 a[204:207], a[28:31], v[52:55], a[204:207]
    v_mfma_f32_16x16x32_bf16 a[208:211], a[32:35], v[48:51], a[208:211]
    ds_read_b128 a[124:127], v23 offset:55296
    v_mfma_f32_16x16x32_bf16 a[208:211], a[36:39], v[52:55], a[208:211]
    v_mfma_f32_16x16x32_bf16 a[212:215], a[40:43], v[48:51], a[212:215]
    buffer_load_dwordx4 v9, s[8:11], s61 offen offset:3072 lds
    v_mfma_f32_16x16x32_bf16 a[212:215], a[44:47], v[52:55], a[212:215]
    v_mfma_f32_16x16x32_bf16 a[216:219], a[48:51], v[48:51], a[216:219]
    v_mfma_f32_16x16x32_bf16 a[216:219], a[52:55], v[52:55], a[216:219]
    v_mfma_f32_16x16x32_bf16 a[220:223], a[56:59], v[48:51], a[220:223]
    v_mfma_f32_16x16x32_bf16 a[220:223], a[60:63], v[52:55], a[220:223]
    v_mfma_f32_16x16x32_bf16 a[224:227], a[0:3], v[56:59], a[224:227]
    v_mfma_f32_16x16x32_bf16 a[224:227], a[4:7], v[60:63], a[224:227]
    s_add_u32 s61, s61, 128
    v_mfma_f32_16x16x32_bf16 a[228:231], a[8:11], v[56:59], a[228:231]
    v_mfma_f32_16x16x32_bf16 a[228:231], a[12:15], v[60:63], a[228:231]
    v_mfma_f32_16x16x32_bf16 a[232:235], a[16:19], v[56:59], a[232:235]
    v_mfma_f32_16x16x32_bf16 a[232:235], a[20:23], v[60:63], a[232:235]
    s_waitcnt vmcnt(18)
    s_barrier
    ds_read_b64_tr_b16 v[40:41], v14 offset:0
    v_mfma_f32_16x16x32_bf16 a[236:239], a[24:27], v[56:59], a[236:239]
    s_add_u32 m0, s69, 0
    ds_read_b64_tr_b16 v[42:43], v14 offset:1024
    ds_read_b64_tr_b16 v[44:45], v14 offset:8192
    v_mfma_f32_16x16x32_bf16 a[236:239], a[28:31], v[60:63], a[236:239]
    buffer_load_dwordx4 v2, s[16:19], s60 offen nt lds
    v_mfma_f32_16x16x32_bf16 a[240:243], a[32:35], v[56:59], a[240:243]
    ds_read_b64_tr_b16 v[46:47], v14 offset:9216
    ds_read_b64_tr_b16 v[48:49], v15 offset:0
    v_mfma_f32_16x16x32_bf16 a[240:243], a[36:39], v[60:63], a[240:243]
    ds_read_b64_tr_b16 v[50:51], v15 offset:1024
    ds_read_b64_tr_b16 v[52:53], v15 offset:8192
    v_mfma_f32_16x16x32_bf16 a[244:247], a[40:43], v[56:59], a[244:247]
    ds_read_b64_tr_b16 v[54:55], v15 offset:9216
    v_mfma_f32_16x16x32_bf16 a[244:247], a[44:47], v[60:63], a[244:247]
    v_mfma_f32_16x16x32_bf16 a[248:251], a[48:51], v[56:59], a[248:251]
    v_mfma_f32_16x16x32_bf16 a[248:251], a[52:55], v[60:63], a[248:251]
    buffer_load_dwordx4 v3, s[16:19], s60 offen offset:1024 nt lds
    v_mfma_f32_16x16x32_bf16 a[252:255], a[56:59], v[56:59], a[252:255]
    ds_read_b64_tr_b16 v[56:57], v16 offset:0
    ds_read_b64_tr_b16 v[58:59], v16 offset:1024
    v_mfma_f32_16x16x32_bf16 a[252:255], a[60:63], v[60:63], a[252:255]
    s_waitcnt lgkmcnt(2)
    ds_read_b64_tr_b16 v[60:61], v16 offset:8192
    ds_read_b64_tr_b16 v[62:63], v16 offset:9216
    v_mfma_f32_16x16x32_bf16 v[128:131], v[40:43], a[64:67], v[128:131]
    v_mfma_f32_16x16x32_bf16 v[128:131], v[44:47], a[68:71], v[128:131]
    v_add_u32 v22, 0x10000, v22
    v_mfma_f32_16x16x32_bf16 v[132:135], v[40:43], a[72:75], v[132:135]
    ds_read_b128 a[0:3], v22 offset:16384
    v_mfma_f32_16x16x32_bf16 v[132:135], v[44:47], a[76:79], v[132:135]
    v_mfma_f32_16x16x32_bf16 v[136:139], v[40:43], a[80:83], v[136:139]
    v_mfma_f32_16x16x32_bf16 v[136:139], v[44:47], a[84:87], v[136:139]
    buffer_load_dwordx4 v4, s[16:19], s60 offen offset:2048 nt lds
    v_mfma_f32_16x16x32_bf16 v[140:143], v[40:43], a[88:91], v[140:143]
    v_add_u32 v23, 0x10000, v23
    v_mfma_f32_16x16x32_bf16 v[140:143], v[44:47], a[92:95], v[140:143]
    ds_read_b128 a[4:7], v23 offset:16384
    v_mfma_f32_16x16x32_bf16 v[144:147], v[40:43], a[96:99], v[144:147]
    v_mfma_f32_16x16x32_bf16 v[144:147], v[44:47], a[100:103], v[144:147]
    v_mfma_f32_16x16x32_bf16 v[148:151], v[40:43], a[104:107], v[148:151]
    v_mfma_f32_16x16x32_bf16 v[148:151], v[44:47], a[108:111], v[148:151]
    v_mfma_f32_16x16x32_bf16 v[152:155], v[40:43], a[112:115], v[152:155]
    buffer_load_dwordx4 v5, s[16:19], s60 offen offset:3072 nt lds
    v_mfma_f32_16x16x32_bf16 v[152:155], v[44:47], a[116:119], v[152:155]
    ds_read_b128 a[8:11], v22 offset:18432
    v_mfma_f32_16x16x32_bf16 v[156:159], v[40:43], a[120:123], v[156:159]
    ds_read_b64_tr_b16 v[40:41], v17 offset:0
    ds_read_b64_tr_b16 v[42:43], v17 offset:1024
    v_mfma_f32_16x16x32_bf16 v[156:159], v[44:47], a[124:127], v[156:159]
    ds_read_b64_tr_b16 v[44:45], v17 offset:8192
    ds_read_b64_tr_b16 v[46:47], v17 offset:9216
    v_mfma_f32_16x16x32_bf16 v[160:163], v[48:51], a[64:67], v[160:163]
    v_mfma_f32_16x16x32_bf16 v[160:163], v[52:55], a[68:71], v[160:163]
    v_mfma_f32_16x16x32_bf16 v[164:167], v[48:51], a[72:75], v[164:167]
    buffer_load_dword v109, v103, s[24:27], s77 offen
    v_mfma_f32_16x16x32_bf16 v[164:167], v[52:55], a[76:79], v[164:167]
    s_add_u32 m0, s69, 16384
    ds_read_b128 a[12:15], v23 offset:18432
    v_mfma_f32_16x16x32_bf16 v[168:171], v[48:51], a[80:83], v[168:171]
    s_add_u32 s60, s60, 524288
    buffer_load_dwordx4 v6, s[8:11], s62 offen lds
    v_mfma_f32_16x16x32_bf16 v[168:171], v[52:55], a[84:87], v[168:171]
    s_mul_i32 s77, s2, 18432
    v_mfma_f32_16x16x32_bf16 v[172:175], v[48:51], a[88:91], v[172:175]
    s_add_u32 s77, s77, s76
    v_mfma_f32_16x16x32_bf16 v[172:175], v[52:55], a[92:95], v[172:175]
    s_mul_i32 s76, s4, 1152
    v_mfma_f32_16x16x32_bf16 v[176:179], v[48:51], a[96:99], v[176:179]
    ds_read_b128 a[16:19], v22 offset:20480
    v_mfma_f32_16x16x32_bf16 v[176:179], v[52:55], a[100:103], v[176:179]
    v_mfma_f32_16x16x32_bf16 v[180:183], v[48:51], a[104:107], v[180:183]
    v_mfma_f32_16x16x32_bf16 v[180:183], v[52:55], a[108:111], v[180:183]
    buffer_load_dwordx4 v7, s[8:11], s62 offen offset:1024 lds
    v_mfma_f32_16x16x32_bf16 v[184:187], v[48:51], a[112:115], v[184:187]
    v_mfma_f32_16x16x32_bf16 v[184:187], v[52:55], a[116:119], v[184:187]
    ds_read_b128 a[20:23], v23 offset:20480
    v_mfma_f32_16x16x32_bf16 v[188:191], v[48:51], a[120:123], v[188:191]
    v_mfma_f32_16x16x32_bf16 v[188:191], v[52:55], a[124:127], v[188:191]
    s_waitcnt lgkmcnt(1)
    v_mfma_f32_16x16x32_bf16 v[192:195], v[56:59], a[64:67], v[192:195]
    v_mfma_f32_16x16x32_bf16 v[192:195], v[60:63], a[68:71], v[192:195]
    v_mfma_f32_16x16x32_bf16 v[196:199], v[56:59], a[72:75], v[196:199]
    v_mfma_f32_16x16x32_bf16 v[196:199], v[60:63], a[76:79], v[196:199]
    buffer_load_dwordx4 v8, s[8:11], s62 offen offset:2048 lds
    v_mfma_f32_16x16x32_bf16 v[200:203], v[56:59], a[80:83], v[200:203]
    ds_read_b128 a[24:27], v22 offset:22528
    v_mfma_f32_16x16x32_bf16 v[200:203], v[60:63], a[84:87], v[200:203]
    v_mfma_f32_16x16x32_bf16 v[204:207], v[56:59], a[88:91], v[204:207]
    v_mfma_f32_16x16x32_bf16 v[204:207], v[60:63], a[92:95], v[204:207]
    v_mfma_f32_16x16x32_bf16 v[208:211], v[56:59], a[96:99], v[208:211]
    ds_read_b128 a[28:31], v23 offset:22528
    v_mfma_f32_16x16x32_bf16 v[208:211], v[60:63], a[100:103], v[208:211]
    v_mfma_f32_16x16x32_bf16 v[212:215], v[56:59], a[104:107], v[212:215]
    buffer_load_dwordx4 v9, s[8:11], s62 offen offset:3072 lds
    v_mfma_f32_16x16x32_bf16 v[212:215], v[60:63], a[108:111], v[212:215]
    v_mfma_f32_16x16x32_bf16 v[216:219], v[56:59], a[112:115], v[216:219]
    v_mfma_f32_16x16x32_bf16 v[216:219], v[60:63], a[116:119], v[216:219]
    v_mfma_f32_16x16x32_bf16 v[220:223], v[56:59], a[120:123], v[220:223]
    v_mfma_f32_16x16x32_bf16 v[220:223], v[60:63], a[124:127], v[220:223]
    v_mfma_f32_16x16x32_bf16 v[224:227], v[40:43], a[64:67], v[224:227]
    v_mfma_f32_16x16x32_bf16 v[224:227], v[44:47], a[68:71], v[224:227]
    s_add_u32 s62, s62, 128
    v_mfma_f32_16x16x32_bf16 v[228:231], v[40:43], a[72:75], v[228:231]
    v_mfma_f32_16x16x32_bf16 v[228:231], v[44:47], a[76:79], v[228:231]
    v_mfma_f32_16x16x32_bf16 v[232:235], v[40:43], a[80:83], v[232:235]
    v_mfma_f32_16x16x32_bf16 v[232:235], v[44:47], a[84:87], v[232:235]
    s_waitcnt vmcnt(18)
    s_barrier
    ds_read_b64_tr_b16 v[48:49], v14 offset:32768
    v_mfma_f32_16x16x32_bf16 v[236:239], v[40:43], a[88:91], v[236:239]
    s_add_u32 m0, s69, 32768
    ds_read_b64_tr_b16 v[50:51], v14 offset:33792
    ds_read_b64_tr_b16 v[52:53], v14 offset:40960
    v_mfma_f32_16x16x32_bf16 v[236:239], v[44:47], a[92:95], v[236:239]
    buffer_load_dwordx4 v2, s[12:15], s60 offen nt lds
    v_mfma_f32_16x16x32_bf16 v[240:243], v[40:43], a[96:99], v[240:243]
    ds_read_b64_tr_b16 v[54:55], v14 offset:41984
    ds_read_b64_tr_b16 v[56:57], v15 offset:32768
    v_mfma_f32_16x16x32_bf16 v[240:243], v[44:47], a[100:103], v[240:243]
    buffer_atomic_add v31, v30, s[44:47], s95 offen sc1
    v_mfma_f32_16x16x32_bf16 v[244:247], v[40:43], a[104:107], v[244:247]
    ds_read_b64_tr_b16 v[58:59], v15 offset:33792
    ds_read_b64_tr_b16 v[60:61], v15 offset:40960
    v_mfma_f32_16x16x32_bf16 v[244:247], v[44:47], a[108:111], v[244:247]
    ds_read_b64_tr_b16 v[62:63], v15 offset:41984
    v_add_u32 v14, 0x10000, v14
    v_mfma_f32_16x16x32_bf16 v[248:251], v[40:43], a[112:115], v[248:251]
    v_add_u32 v15, 0x10000, v15
    v_mfma_f32_16x16x32_bf16 v[248:251], v[44:47], a[116:119], v[248:251]
    buffer_load_dwordx4 v3, s[12:15], s60 offen offset:1024 nt lds
    v_mfma_f32_16x16x32_bf16 v[252:255], v[40:43], a[120:123], v[252:255]
    ds_read_b64_tr_b16 v[40:41], v16 offset:32768
    ds_read_b64_tr_b16 v[42:43], v16 offset:33792
    v_mfma_f32_16x16x32_bf16 v[252:255], v[44:47], a[124:127], v[252:255]
    s_waitcnt lgkmcnt(3)
    ds_read_b64_tr_b16 v[44:45], v16 offset:40960
    ds_read_b64_tr_b16 v[46:47], v16 offset:41984
    v_mfma_f32_16x16x32_bf16 a[128:131], a[64:67], v[48:51], a[128:131]
    v_add_u32 v16, 0x10000, v16
    v_mfma_f32_16x16x32_bf16 a[128:131], a[68:71], v[52:55], a[128:131]
    v_mfma_f32_16x16x32_bf16 a[132:135], a[72:75], v[48:51], a[132:135]
    ds_read_b128 a[32:35], v22 offset:49152
    v_mfma_f32_16x16x32_bf16 a[132:135], a[76:79], v[52:55], a[132:135]
    v_mfma_f32_16x16x32_bf16 a[136:139], a[80:83], v[48:51], a[136:139]
    v_mfma_f32_16x16x32_bf16 a[136:139], a[84:87], v[52:55], a[136:139]
    buffer_load_dwordx4 v4, s[12:15], s60 offen offset:2048 nt lds
    v_mfma_f32_16x16x32_bf16 a[140:143], a[88:91], v[48:51], a[140:143]
    v_mfma_f32_16x16x32_bf16 a[140:143], a[92:95], v[52:55], a[140:143]
    ds_read_b128 a[36:39], v23 offset:49152
    v_mfma_f32_16x16x32_bf16 a[144:147], a[96:99], v[48:51], a[144:147]
    v_mfma_f32_16x16x32_bf16 a[144:147], a[100:103], v[52:55], a[144:147]
    v_mfma_f32_16x16x32_bf16 a[148:151], a[104:107], v[48:51], a[148:151]
    v_mfma_f32_16x16x32_bf16 a[148:151], a[108:111], v[52:55], a[148:151]
    v_mfma_f32_16x16x32_bf16 a[152:155], a[112:115], v[48:51], a[152:155]
    buffer_load_dwordx4 v5, s[12:15], s60 offen offset:3072 nt lds
    v_mfma_f32_16x16x32_bf16 a[152:155], a[116:119], v[52:55], a[152:155]
    ds_read_b128 a[40:43], v22 offset:51200
    v_mfma_f32_16x16x32_bf16 a[156:159], a[120:123], v[48:51], a[156:159]
    ds_read_b64_tr_b16 v[48:49], v17 offset:32768
    ds_read_b64_tr_b16 v[50:51], v17 offset:33792
    v_mfma_f32_16x16x32_bf16 a[156:159], a[124:127], v[52:55], a[156:159]
    ds_read_b64_tr_b16 v[52:53], v17 offset:40960
    ds_read_b64_tr_b16 v[54:55], v17 offset:41984
    v_mfma_f32_16x16x32_bf16 a[160:163], a[64:67], v[56:59], a[160:163]
    s_waitcnt lgkmcnt(5)
    v_add_u32 v17, 0x10000, v17
    v_mfma_f32_16x16x32_bf16 a[160:163], a[68:71], v[60:63], a[160:163]
    v_mfma_f32_16x16x32_bf16 a[164:167], a[72:75], v[56:59], a[164:167]
    ds_read_b128 a[44:47], v23 offset:51200
    v_mfma_f32_16x16x32_bf16 a[164:167], a[76:79], v[60:63], a[164:167]
    s_add_u32 m0, s69, 49152
    v_mfma_f32_16x16x32_bf16 a[168:171], a[80:83], v[56:59], a[168:171]
    buffer_load_dwordx4 v6, s[8:11], s61 offen lds
    v_mfma_f32_16x16x32_bf16 a[168:171], a[84:87], v[60:63], a[168:171]
    v_mfma_f32_16x16x32_bf16 a[172:175], a[88:91], v[56:59], a[172:175]
    v_mfma_f32_16x16x32_bf16 a[172:175], a[92:95], v[60:63], a[172:175]
    v_mfma_f32_16x16x32_bf16 a[176:179], a[96:99], v[56:59], a[176:179]
    buffer_load_dword v110, v103, s[48:51], s77 offen
    v_mfma_f32_16x16x32_bf16 a[176:179], a[100:103], v[60:63], a[176:179]
    s_add_u32 s77, s77, 4608
    ds_read_b128 a[48:51], v22 offset:53248
    v_mfma_f32_16x16x32_bf16 a[180:183], a[104:107], v[56:59], a[180:183]
    v_mfma_f32_16x16x32_bf16 a[180:183], a[108:111], v[60:63], a[180:183]
    buffer_load_dwordx4 v7, s[8:11], s61 offen offset:1024 lds
    v_mfma_f32_16x16x32_bf16 a[184:187], a[112:115], v[56:59], a[184:187]
    v_mfma_f32_16x16x32_bf16 a[184:187], a[116:119], v[60:63], a[184:187]
    ds_read_b128 a[52:55], v23 offset:53248
    v_mfma_f32_16x16x32_bf16 a[188:191], a[120:123], v[56:59], a[188:191]
    v_mfma_f32_16x16x32_bf16 a[188:191], a[124:127], v[60:63], a[188:191]
    v_mfma_f32_16x16x32_bf16 a[192:195], a[64:67], v[40:43], a[192:195]
    v_mfma_f32_16x16x32_bf16 a[192:195], a[68:71], v[44:47], a[192:195]
    v_mfma_f32_16x16x32_bf16 a[196:199], a[72:75], v[40:43], a[196:199]
    v_mfma_f32_16x16x32_bf16 a[196:199], a[76:79], v[44:47], a[196:199]
    buffer_load_dwordx4 v8, s[8:11], s61 offen offset:2048 lds
    v_mfma_f32_16x16x32_bf16 a[200:203], a[80:83], v[40:43], a[200:203]
    ds_read_b128 a[56:59], v22 offset:55296
    v_mfma_f32_16x16x32_bf16 a[200:203], a[84:87], v[44:47], a[200:203]
    v_mfma_f32_16x16x32_bf16 a[204:207], a[88:91], v[40:43], a[204:207]
    v_mfma_f32_16x16x32_bf16 a[204:207], a[92:95], v[44:47], a[204:207]
    v_mfma_f32_16x16x32_bf16 a[208:211], a[96:99], v[40:43], a[208:211]
    ds_read_b128 a[60:63], v23 offset:55296
    v_mfma_f32_16x16x32_bf16 a[208:211], a[100:103], v[44:47], a[208:211]
    v_mfma_f32_16x16x32_bf16 a[212:215], a[104:107], v[40:43], a[212:215]
    buffer_load_dwordx4 v9, s[8:11], s61 offen offset:3072 lds
    v_mfma_f32_16x16x32_bf16 a[212:215], a[108:111], v[44:47], a[212:215]
    v_mfma_f32_16x16x32_bf16 a[216:219], a[112:115], v[40:43], a[216:219]
    v_mfma_f32_16x16x32_bf16 a[216:219], a[116:119], v[44:47], a[216:219]
    v_mfma_f32_16x16x32_bf16 a[220:223], a[120:123], v[40:43], a[220:223]
    v_mfma_f32_16x16x32_bf16 a[220:223], a[124:127], v[44:47], a[220:223]
    s_waitcnt lgkmcnt(0)
    v_mfma_f32_16x16x32_bf16 a[224:227], a[64:67], v[48:51], a[224:227]
    v_mfma_f32_16x16x32_bf16 a[224:227], a[68:71], v[52:55], a[224:227]
    s_add_u32 s61, s61, 128
    v_mfma_f32_16x16x32_bf16 a[228:231], a[72:75], v[48:51], a[228:231]
    v_mfma_f32_16x16x32_bf16 a[228:231], a[76:79], v[52:55], a[228:231]
    v_mfma_f32_16x16x32_bf16 a[232:235], a[80:83], v[48:51], a[232:235]
    v_mfma_f32_16x16x32_bf16 a[232:235], a[84:87], v[52:55], a[232:235]
    s_waitcnt vmcnt(19)
    s_barrier
    ds_read_b64_tr_b16 v[56:57], v14 offset:0
    v_mfma_f32_16x16x32_bf16 a[236:239], a[88:91], v[48:51], a[236:239]
    s_add_u32 m0, s69, 65536
    ds_read_b64_tr_b16 v[58:59], v14 offset:1024
    ds_read_b64_tr_b16 v[60:61], v14 offset:8192
    v_mfma_f32_16x16x32_bf16 a[236:239], a[92:95], v[52:55], a[236:239]
    buffer_load_dwordx4 v2, s[16:19], s60 offen nt lds
    v_mfma_f32_16x16x32_bf16 a[240:243], a[96:99], v[48:51], a[240:243]
    ds_read_b64_tr_b16 v[62:63], v14 offset:9216
    ds_read_b64_tr_b16 v[40:41], v15 offset:0
    v_mfma_f32_16x16x32_bf16 a[240:243], a[100:103], v[52:55], a[240:243]
    ds_read_b64_tr_b16 v[42:43], v15 offset:1024
    ds_read_b64_tr_b16 v[44:45], v15 offset:8192
    v_mfma_f32_16x16x32_bf16 a[244:247], a[104:107], v[48:51], a[244:247]
    ds_read_b64_tr_b16 v[46:47], v15 offset:9216
    v_add_u32 v14, 0xfffe0000, v14
    v_mfma_f32_16x16x32_bf16 a[244:247], a[108:111], v[52:55], a[244:247]
    v_add_u32 v15, 0xfffe0000, v15
    v_mfma_f32_16x16x32_bf16 a[248:251], a[112:115], v[48:51], a[248:251]
    v_mfma_f32_16x16x32_bf16 a[248:251], a[116:119], v[52:55], a[248:251]
    buffer_load_dwordx4 v3, s[16:19], s60 offen offset:1024 nt lds
    v_mfma_f32_16x16x32_bf16 a[252:255], a[120:123], v[48:51], a[252:255]
    ds_read_b64_tr_b16 v[48:49], v16 offset:0
    ds_read_b64_tr_b16 v[50:51], v16 offset:1024
    v_mfma_f32_16x16x32_bf16 a[252:255], a[124:127], v[52:55], a[252:255]
    s_waitcnt lgkmcnt(2)
    ds_read_b64_tr_b16 v[52:53], v16 offset:8192
    ds_read_b64_tr_b16 v[54:55], v16 offset:9216
    v_mfma_f32_16x16x32_bf16 v[128:131], v[56:59], a[0:3], v[128:131]
    v_add_u32 v16, 0xfffe0000, v16
    v_mfma_f32_16x16x32_bf16 v[128:131], v[60:63], a[4:7], v[128:131]
    v_add_u32 v22, 0x10000, v22
    v_mfma_f32_16x16x32_bf16 v[132:135], v[56:59], a[8:11], v[132:135]
    ds_read_b128 a[64:67], v22 offset:16384
    v_mfma_f32_16x16x32_bf16 v[132:135], v[60:63], a[12:15], v[132:135]
    v_mfma_f32_16x16x32_bf16 v[136:139], v[56:59], a[16:19], v[136:139]
    v_mfma_f32_16x16x32_bf16 v[136:139], v[60:63], a[20:23], v[136:139]
    buffer_load_dwordx4 v4, s[16:19], s60 offen offset:2048 nt lds
    v_mfma_f32_16x16x32_bf16 v[140:143], v[56:59], a[24:27], v[140:143]
    v_add_u32 v23, 0x10000, v23
    v_mfma_f32_16x16x32_bf16 v[140:143], v[60:63], a[28:31], v[140:143]
    ds_read_b128 a[68:71], v23 offset:16384
    v_mfma_f32_16x16x32_bf16 v[144:147], v[56:59], a[32:35], v[144:147]
    v_mfma_f32_16x16x32_bf16 v[144:147], v[60:63], a[36:39], v[144:147]
    v_mfma_f32_16x16x32_bf16 v[148:151], v[56:59], a[40:43], v[148:151]
    v_mfma_f32_16x16x32_bf16 v[148:151], v[60:63], a[44:47], v[148:151]
    v_mfma_f32_16x16x32_bf16 v[152:155], v[56:59], a[48:51], v[152:155]
    buffer_load_dwordx4 v5, s[16:19], s60 offen offset:3072 nt lds
    v_mfma_f32_16x16x32_bf16 v[152:155], v[60:63], a[52:55], v[152:155]
    ds_read_b128 a[72:75], v22 offset:18432
    v_mfma_f32_16x16x32_bf16 v[156:159], v[56:59], a[56:59], v[156:159]
    ds_read_b64_tr_b16 v[56:57], v17 offset:0
    ds_read_b64_tr_b16 v[58:59], v17 offset:1024
    v_mfma_f32_16x16x32_bf16 v[156:159], v[60:63], a[60:63], v[156:159]
    ds_read_b64_tr_b16 v[60:61], v17 offset:8192
    ds_read_b64_tr_b16 v[62:63], v17 offset:9216
    v_mfma_f32_16x16x32_bf16 v[160:163], v[40:43], a[0:3], v[160:163]
    v_add_u32 v17, 0xfffe0000, v17
    v_mfma_f32_16x16x32_bf16 v[160:163], v[44:47], a[4:7], v[160:163]
    v_mfma_f32_16x16x32_bf16 v[164:167], v[40:43], a[8:11], v[164:167]
    ds_read_b128 a[76:79], v23 offset:18432
    v_mfma_f32_16x16x32_bf16 v[164:167], v[44:47], a[12:15], v[164:167]
    s_add_u32 m0, s69, 81920
    v_mfma_f32_16x16x32_bf16 v[168:171], v[40:43], a[16:19], v[168:171]
    s_add_u32 s60, s60, 524288
    buffer_load_dwordx4 v6, s[8:11], s62 offen lds
    v_mfma_f32_16x16x32_bf16 v[168:171], v[44:47], a[20:23], v[168:171]
    v_mfma_f32_16x16x32_bf16 v[172:175], v[40:43], a[24:27], v[172:175]
    v_mfma_f32_16x16x32_bf16 v[172:175], v[44:47], a[28:31], v[172:175]
    v_mfma_f32_16x16x32_bf16 v[176:179], v[40:43], a[32:35], v[176:179]
    ds_read_b128 a[80:83], v22 offset:20480
    v_mfma_f32_16x16x32_bf16 v[176:179], v[44:47], a[36:39], v[176:179]
    v_mfma_f32_16x16x32_bf16 v[180:183], v[40:43], a[40:43], v[180:183]
    v_mfma_f32_16x16x32_bf16 v[180:183], v[44:47], a[44:47], v[180:183]
    buffer_load_dwordx4 v7, s[8:11], s62 offen offset:1024 lds
    v_mfma_f32_16x16x32_bf16 v[184:187], v[40:43], a[48:51], v[184:187]
    v_mfma_f32_16x16x32_bf16 v[184:187], v[44:47], a[52:55], v[184:187]
    ds_read_b128 a[84:87], v23 offset:20480
    v_mfma_f32_16x16x32_bf16 v[188:191], v[40:43], a[56:59], v[188:191]
    buffer_load_dword v111, v103, s[48:51], s77 offen
    v_mfma_f32_16x16x32_bf16 v[188:191], v[44:47], a[60:63], v[188:191]
    s_add_u32 s77, s77, 4608
    s_waitcnt lgkmcnt(1)
    v_mfma_f32_16x16x32_bf16 v[192:195], v[48:51], a[0:3], v[192:195]
    v_mfma_f32_16x16x32_bf16 v[192:195], v[52:55], a[4:7], v[192:195]
    v_mfma_f32_16x16x32_bf16 v[196:199], v[48:51], a[8:11], v[196:199]
    v_mfma_f32_16x16x32_bf16 v[196:199], v[52:55], a[12:15], v[196:199]
    buffer_load_dwordx4 v8, s[8:11], s62 offen offset:2048 lds
    v_mfma_f32_16x16x32_bf16 v[200:203], v[48:51], a[16:19], v[200:203]
    ds_read_b128 a[88:91], v22 offset:22528
    v_mfma_f32_16x16x32_bf16 v[200:203], v[52:55], a[20:23], v[200:203]
    v_mfma_f32_16x16x32_bf16 v[204:207], v[48:51], a[24:27], v[204:207]
    v_mfma_f32_16x16x32_bf16 v[204:207], v[52:55], a[28:31], v[204:207]
    v_mfma_f32_16x16x32_bf16 v[208:211], v[48:51], a[32:35], v[208:211]
    ds_read_b128 a[92:95], v23 offset:22528
    v_mfma_f32_16x16x32_bf16 v[208:211], v[52:55], a[36:39], v[208:211]
    v_mfma_f32_16x16x32_bf16 v[212:215], v[48:51], a[40:43], v[212:215]
    buffer_load_dwordx4 v9, s[8:11], s62 offen offset:3072 lds
    v_mfma_f32_16x16x32_bf16 v[212:215], v[52:55], a[44:47], v[212:215]
    v_mfma_f32_16x16x32_bf16 v[216:219], v[48:51], a[48:51], v[216:219]
    v_mfma_f32_16x16x32_bf16 v[216:219], v[52:55], a[52:55], v[216:219]
    v_mfma_f32_16x16x32_bf16 v[220:223], v[48:51], a[56:59], v[220:223]
    v_mfma_f32_16x16x32_bf16 v[220:223], v[52:55], a[60:63], v[220:223]
    v_mfma_f32_16x16x32_bf16 v[224:227], v[56:59], a[0:3], v[224:227]
    v_mfma_f32_16x16x32_bf16 v[224:227], v[60:63], a[4:7], v[224:227]
    s_add_u32 s62, s62, 128
    v_mfma_f32_16x16x32_bf16 v[228:231], v[56:59], a[8:11], v[228:231]
    v_mfma_f32_16x16x32_bf16 v[228:231], v[60:63], a[12:15], v[228:231]
    v_mfma_f32_16x16x32_bf16 v[232:235], v[56:59], a[16:19], v[232:235]
    v_mfma_f32_16x16x32_bf16 v[232:235], v[60:63], a[20:23], v[232:235]
    s_waitcnt vmcnt(19)
    s_barrier
    ds_read_b64_tr_b16 v[40:41], v14 offset:0
    v_mfma_f32_16x16x32_bf16 v[236:239], v[56:59], a[24:27], v[236:239]
    s_add_u32 m0, s69, 98304
    ds_read_b64_tr_b16 v[42:43], v14 offset:1024
    ds_read_b64_tr_b16 v[44:45], v14 offset:8192
    v_mfma_f32_16x16x32_bf16 v[236:239], v[60:63], a[28:31], v[236:239]
    buffer_load_dwordx4 v2, s[12:15], s60 offen nt lds
    v_mfma_f32_16x16x32_bf16 v[240:243], v[56:59], a[32:35], v[240:243]
    ds_read_b64_tr_b16 v[46:47], v14 offset:9216
    ds_read_b64_tr_b16 v[48:49], v15 offset:0
    v_mfma_f32_16x16x32_bf16 v[240:243], v[60:63], a[36:39], v[240:243]
    ds_read_b64_tr_b16 v[50:51], v15 offset:1024
    ds_read_b64_tr_b16 v[52:53], v15 offset:8192
    v_mfma_f32_16x16x32_bf16 v[244:247], v[56:59], a[40:43], v[244:247]
    ds_read_b64_tr_b16 v[54:55], v15 offset:9216
    v_mfma_f32_16x16x32_bf16 v[244:247], v[60:63], a[44:47], v[244:247]
    v_mfma_f32_16x16x32_bf16 v[248:251], v[56:59], a[48:51], v[248:251]
    v_mfma_f32_16x16x32_bf16 v[248:251], v[60:63], a[52:55], v[248:251]
    buffer_load_dwordx4 v3, s[12:15], s60 offen offset:1024 nt lds
    v_mfma_f32_16x16x32_bf16 v[252:255], v[56:59], a[56:59], v[252:255]
    ds_read_b64_tr_b16 v[56:57], v16 offset:0
    ds_read_b64_tr_b16 v[58:59], v16 offset:1024
    v_mfma_f32_16x16x32_bf16 v[252:255], v[60:63], a[60:63], v[252:255]
    s_waitcnt lgkmcnt(2)
    ds_read_b64_tr_b16 v[60:61], v16 offset:8192
    ds_read_b64_tr_b16 v[62:63], v16 offset:9216
    v_mfma_f32_16x16x32_bf16 a[128:131], a[0:3], v[40:43], a[128:131]
    v_mfma_f32_16x16x32_bf16 a[128:131], a[4:7], v[44:47], a[128:131]
    v_add_u32 v22, 0xfffe0000, v22
    v_mfma_f32_16x16x32_bf16 a[132:135], a[8:11], v[40:43], a[132:135]
    ds_read_b128 a[96:99], v22 offset:16384
    v_mfma_f32_16x16x32_bf16 a[132:135], a[12:15], v[44:47], a[132:135]
    v_mfma_f32_16x16x32_bf16 a[136:139], a[16:19], v[40:43], a[136:139]
    v_mfma_f32_16x16x32_bf16 a[136:139], a[20:23], v[44:47], a[136:139]
    buffer_load_dwordx4 v4, s[12:15], s60 offen offset:2048 nt lds
    v_mfma_f32_16x16x32_bf16 a[140:143], a[24:27], v[40:43], a[140:143]
    v_add_u32 v23, 0xfffe0000, v23
    v_mfma_f32_16x16x32_bf16 a[140:143], a[28:31], v[44:47], a[140:143]
    ds_read_b128 a[100:103], v23 offset:16384
    v_mfma_f32_16x16x32_bf16 a[144:147], a[32:35], v[40:43], a[144:147]
    v_mfma_f32_16x16x32_bf16 a[144:147], a[36:39], v[44:47], a[144:147]
    v_mfma_f32_16x16x32_bf16 a[148:151], a[40:43], v[40:43], a[148:151]
    v_mfma_f32_16x16x32_bf16 a[148:151], a[44:47], v[44:47], a[148:151]
    v_mfma_f32_16x16x32_bf16 a[152:155], a[48:51], v[40:43], a[152:155]
    buffer_load_dwordx4 v5, s[12:15], s60 offen offset:3072 nt lds
    v_mfma_f32_16x16x32_bf16 a[152:155], a[52:55], v[44:47], a[152:155]
    ds_read_b128 a[104:107], v22 offset:18432
    v_mfma_f32_16x16x32_bf16 a[156:159], a[56:59], v[40:43], a[156:159]
    ds_read_b64_tr_b16 v[40:41], v17 offset:0
    ds_read_b64_tr_b16 v[42:43], v17 offset:1024
    v_mfma_f32_16x16x32_bf16 a[156:159], a[60:63], v[44:47], a[156:159]
    ds_read_b64_tr_b16 v[44:45], v17 offset:8192
    ds_read_b64_tr_b16 v[46:47], v17 offset:9216
    v_mfma_f32_16x16x32_bf16 a[160:163], a[0:3], v[48:51], a[160:163]
    v_mfma_f32_16x16x32_bf16 a[160:163], a[4:7], v[52:55], a[160:163]
    v_mfma_f32_16x16x32_bf16 a[164:167], a[8:11], v[48:51], a[164:167]
    ds_read_b128 a[108:111], v23 offset:18432
    v_mfma_f32_16x16x32_bf16 a[164:167], a[12:15], v[52:55], a[164:167]
    s_add_u32 m0, s69, 114688
    v_mfma_f32_16x16x32_bf16 a[168:171], a[16:19], v[48:51], a[168:171]
    buffer_load_dwordx4 v6, s[8:11], s61 offen lds
    v_mfma_f32_16x16x32_bf16 a[168:171], a[20:23], v[52:55], a[168:171]
    v_mfma_f32_16x16x32_bf16 a[172:175], a[24:27], v[48:51], a[172:175]
    v_mfma_f32_16x16x32_bf16 a[172:175], a[28:31], v[52:55], a[172:175]
    v_mfma_f32_16x16x32_bf16 a[176:179], a[32:35], v[48:51], a[176:179]
    ds_read_b128 a[112:115], v22 offset:20480
    v_mfma_f32_16x16x32_bf16 a[176:179], a[36:39], v[52:55], a[176:179]
    v_mfma_f32_16x16x32_bf16 a[180:183], a[40:43], v[48:51], a[180:183]
    v_mfma_f32_16x16x32_bf16 a[180:183], a[44:47], v[52:55], a[180:183]
    buffer_load_dwordx4 v7, s[8:11], s61 offen offset:1024 lds
    v_mfma_f32_16x16x32_bf16 a[184:187], a[48:51], v[48:51], a[184:187]
    v_mfma_f32_16x16x32_bf16 a[184:187], a[52:55], v[52:55], a[184:187]
    ds_read_b128 a[116:119], v23 offset:20480
    v_mfma_f32_16x16x32_bf16 a[188:191], a[56:59], v[48:51], a[188:191]
    v_mfma_f32_16x16x32_bf16 a[188:191], a[60:63], v[52:55], a[188:191]
    s_waitcnt lgkmcnt(1)
    v_mfma_f32_16x16x32_bf16 a[192:195], a[0:3], v[56:59], a[192:195]
    v_mfma_f32_16x16x32_bf16 a[192:195], a[4:7], v[60:63], a[192:195]
    v_mfma_f32_16x16x32_bf16 a[196:199], a[8:11], v[56:59], a[196:199]
    v_mfma_f32_16x16x32_bf16 a[196:199], a[12:15], v[60:63], a[196:199]
    buffer_load_dwordx4 v8, s[8:11], s61 offen offset:2048 lds
    v_mfma_f32_16x16x32_bf16 a[200:203], a[16:19], v[56:59], a[200:203]
    ds_read_b128 a[120:123], v22 offset:22528
    v_mfma_f32_16x16x32_bf16 a[200:203], a[20:23], v[60:63], a[200:203]
    buffer_load_dword v112, v103, s[48:51], s77 offen
    v_mfma_f32_16x16x32_bf16 a[204:207], a[24:27], v[56:59], a[204:207]
    s_add_u32 s77, s77, 4608
    v_mfma_f32_16x16x32_bf16 a[204:207], a[28:31], v[60:63], a[204:207]
    v_mfma_f32_16x16x32_bf16 a[208:211], a[32:35], v[56:59], a[208:211]
    ds_read_b128 a[124:127], v23 offset:22528
    v_mfma_f32_16x16x32_bf16 a[208:211], a[36:39], v[60:63], a[208:211]
    v_mfma_f32_16x16x32_bf16 a[212:215], a[40:43], v[56:59], a[212:215]
    buffer_load_dwordx4 v9, s[8:11], s61 offen offset:3072 lds
    v_mfma_f32_16x16x32_bf16 a[212:215], a[44:47], v[60:63], a[212:215]
    v_mfma_f32_16x16x32_bf16 a[216:219], a[48:51], v[56:59], a[216:219]
    v_mfma_f32_16x16x32_bf16 a[216:219], a[52:55], v[60:63], a[216:219]
    v_mfma_f32_16x16x32_bf16 a[220:223], a[56:59], v[56:59], a[220:223]
    v_mfma_f32_16x16x32_bf16 a[220:223], a[60:63], v[60:63], a[220:223]
    v_mfma_f32_16x16x32_bf16 a[224:227], a[0:3], v[40:43], a[224:227]
    v_mfma_f32_16x16x32_bf16 a[224:227], a[4:7], v[44:47], a[224:227]
    s_add_u32 s61, s61, 128
    v_mfma_f32_16x16x32_bf16 a[228:231], a[8:11], v[40:43], a[228:231]
    v_mfma_f32_16x16x32_bf16 a[228:231], a[12:15], v[44:47], a[228:231]
    v_mfma_f32_16x16x32_bf16 a[232:235], a[16:19], v[40:43], a[232:235]
    v_mfma_f32_16x16x32_bf16 a[232:235], a[20:23], v[44:47], a[232:235]
    s_waitcnt vmcnt(18)
    s_barrier
    ds_read_b64_tr_b16 v[48:49], v14 offset:32768
    v_mfma_f32_16x16x32_bf16 a[236:239], a[24:27], v[40:43], a[236:239]
    s_add_u32 m0, s69, 131072
    ds_read_b64_tr_b16 v[50:51], v14 offset:33792
    ds_read_b64_tr_b16 v[52:53], v14 offset:40960
    v_mfma_f32_16x16x32_bf16 a[236:239], a[28:31], v[44:47], a[236:239]
    buffer_load_dwordx4 v2, s[16:19], s60 offen nt lds
    v_mfma_f32_16x16x32_bf16 a[240:243], a[32:35], v[40:43], a[240:243]
    ds_read_b64_tr_b16 v[54:55], v14 offset:41984
    ds_read_b64_tr_b16 v[56:57], v15 offset:32768
    v_mfma_f32_16x16x32_bf16 a[240:243], a[36:39], v[44:47], a[240:243]
    ds_read_b64_tr_b16 v[58:59], v15 offset:33792
    ds_read_b64_tr_b16 v[60:61], v15 offset:40960
    v_mfma_f32_16x16x32_bf16 a[244:247], a[40:43], v[40:43], a[244:247]
    ds_read_b64_tr_b16 v[62:63], v15 offset:41984
    v_add_u32 v14, 0x10000, v14
    v_mfma_f32_16x16x32_bf16 a[244:247], a[44:47], v[44:47], a[244:247]
    v_add_u32 v15, 0x10000, v15
    v_mfma_f32_16x16x32_bf16 a[248:251], a[48:51], v[40:43], a[248:251]
    v_mfma_f32_16x16x32_bf16 a[248:251], a[52:55], v[44:47], a[248:251]
    buffer_load_dwordx4 v3, s[16:19], s60 offen offset:1024 nt lds
    v_mfma_f32_16x16x32_bf16 a[252:255], a[56:59], v[40:43], a[252:255]
    ds_read_b64_tr_b16 v[40:41], v16 offset:32768
    ds_read_b64_tr_b16 v[42:43], v16 offset:33792
    v_mfma_f32_16x16x32_bf16 a[252:255], a[60:63], v[44:47], a[252:255]
    s_waitcnt lgkmcnt(2)
    ds_read_b64_tr_b16 v[44:45], v16 offset:40960
    ds_read_b64_tr_b16 v[46:47], v16 offset:41984
    v_mfma_f32_16x16x32_bf16 v[128:131], v[48:51], a[64:67], v[128:131]
    v_add_u32 v16, 0x10000, v16
    v_mfma_f32_16x16x32_bf16 v[128:131], v[52:55], a[68:71], v[128:131]
    v_mfma_f32_16x16x32_bf16 v[132:135], v[48:51], a[72:75], v[132:135]
    ds_read_b128 a[0:3], v22 offset:49152
    v_mfma_f32_16x16x32_bf16 v[132:135], v[52:55], a[76:79], v[132:135]
    v_mfma_f32_16x16x32_bf16 v[136:139], v[48:51], a[80:83], v[136:139]
    v_mfma_f32_16x16x32_bf16 v[136:139], v[52:55], a[84:87], v[136:139]
    buffer_load_dwordx4 v4, s[16:19], s60 offen offset:2048 nt lds
    v_mfma_f32_16x16x32_bf16 v[140:143], v[48:51], a[88:91], v[140:143]
    v_mfma_f32_16x16x32_bf16 v[140:143], v[52:55], a[92:95], v[140:143]
    ds_read_b128 a[4:7], v23 offset:49152
    v_mfma_f32_16x16x32_bf16 v[144:147], v[48:51], a[96:99], v[144:147]
    v_mfma_f32_16x16x32_bf16 v[144:147], v[52:55], a[100:103], v[144:147]
    v_mfma_f32_16x16x32_bf16 v[148:151], v[48:51], a[104:107], v[148:151]
    v_mfma_f32_16x16x32_bf16 v[148:151], v[52:55], a[108:111], v[148:151]
    v_mfma_f32_16x16x32_bf16 v[152:155], v[48:51], a[112:115], v[152:155]
    buffer_load_dwordx4 v5, s[16:19], s60 offen offset:3072 nt lds
    v_mfma_f32_16x16x32_bf16 v[152:155], v[52:55], a[116:119], v[152:155]
    ds_read_b128 a[8:11], v22 offset:51200
    v_mfma_f32_16x16x32_bf16 v[156:159], v[48:51], a[120:123], v[156:159]
    ds_read_b64_tr_b16 v[48:49], v17 offset:32768
    ds_read_b64_tr_b16 v[50:51], v17 offset:33792
    v_mfma_f32_16x16x32_bf16 v[156:159], v[52:55], a[124:127], v[156:159]
    ds_read_b64_tr_b16 v[52:53], v17 offset:40960
    ds_read_b64_tr_b16 v[54:55], v17 offset:41984
    v_mfma_f32_16x16x32_bf16 v[160:163], v[56:59], a[64:67], v[160:163]
    v_add_u32 v17, 0x10000, v17
    v_mfma_f32_16x16x32_bf16 v[160:163], v[60:63], a[68:71], v[160:163]
    v_mfma_f32_16x16x32_bf16 v[164:167], v[56:59], a[72:75], v[164:167]
    ds_read_b128 a[12:15], v23 offset:51200
    v_mfma_f32_16x16x32_bf16 v[164:167], v[60:63], a[76:79], v[164:167]
    s_add_u32 m0, s69, 147456
    v_mfma_f32_16x16x32_bf16 v[168:171], v[56:59], a[80:83], v[168:171]
    s_add_u32 s60, s60, 524288
    buffer_load_dwordx4 v6, s[8:11], s62 offen lds
    v_mfma_f32_16x16x32_bf16 v[168:171], v[60:63], a[84:87], v[168:171]
    v_mov_b32 v6, v96
    v_mfma_f32_16x16x32_bf16 v[172:175], v[56:59], a[88:91], v[172:175]
    v_mfma_f32_16x16x32_bf16 v[172:175], v[60:63], a[92:95], v[172:175]
    v_mfma_f32_16x16x32_bf16 v[176:179], v[56:59], a[96:99], v[176:179]
    ds_read_b128 a[16:19], v22 offset:53248
    v_mfma_f32_16x16x32_bf16 v[176:179], v[60:63], a[100:103], v[176:179]
    v_mfma_f32_16x16x32_bf16 v[180:183], v[56:59], a[104:107], v[180:183]
    v_mfma_f32_16x16x32_bf16 v[180:183], v[60:63], a[108:111], v[180:183]
    buffer_load_dwordx4 v7, s[8:11], s62 offen offset:1024 lds
    v_mfma_f32_16x16x32_bf16 v[184:187], v[56:59], a[112:115], v[184:187]
    v_mfma_f32_16x16x32_bf16 v[184:187], v[60:63], a[116:119], v[184:187]
    ds_read_b128 a[20:23], v23 offset:53248
    v_mfma_f32_16x16x32_bf16 v[188:191], v[56:59], a[120:123], v[188:191]
    v_mfma_f32_16x16x32_bf16 v[188:191], v[60:63], a[124:127], v[188:191]
    s_waitcnt lgkmcnt(1)
    v_mfma_f32_16x16x32_bf16 v[192:195], v[40:43], a[64:67], v[192:195]
    v_mfma_f32_16x16x32_bf16 v[192:195], v[44:47], a[68:71], v[192:195]
    v_mfma_f32_16x16x32_bf16 v[196:199], v[40:43], a[72:75], v[196:199]
    v_mfma_f32_16x16x32_bf16 v[196:199], v[44:47], a[76:79], v[196:199]
    buffer_load_dwordx4 v8, s[8:11], s62 offen offset:2048 lds
    v_mfma_f32_16x16x32_bf16 v[200:203], v[40:43], a[80:83], v[200:203]
    ds_read_b128 a[24:27], v22 offset:55296
    v_mfma_f32_16x16x32_bf16 v[200:203], v[44:47], a[84:87], v[200:203]
    v_mfma_f32_16x16x32_bf16 v[204:207], v[40:43], a[88:91], v[204:207]
    v_mfma_f32_16x16x32_bf16 v[204:207], v[44:47], a[92:95], v[204:207]
    v_mfma_f32_16x16x32_bf16 v[208:211], v[40:43], a[96:99], v[208:211]
    ds_read_b128 a[28:31], v23 offset:55296
    v_mfma_f32_16x16x32_bf16 v[208:211], v[44:47], a[100:103], v[208:211]
    v_mfma_f32_16x16x32_bf16 v[212:215], v[40:43], a[104:107], v[212:215]
    buffer_load_dwordx4 v9, s[8:11], s62 offen offset:3072 lds
    v_mfma_f32_16x16x32_bf16 v[212:215], v[44:47], a[108:111], v[212:215]
    buffer_load_dword v113, v103, s[48:51], s77 offen
    v_mfma_f32_16x16x32_bf16 v[216:219], v[40:43], a[112:115], v[216:219]
    s_mul_i32 s77, s2, 2592
    v_mfma_f32_16x16x32_bf16 v[216:219], v[44:47], a[116:119], v[216:219]
    s_add_u32 s77, s77, s76
    v_mfma_f32_16x16x32_bf16 v[220:223], v[40:43], a[120:123], v[220:223]
    s_sub_u32 s77, s77, 1152
    v_mfma_f32_16x16x32_bf16 v[220:223], v[44:47], a[124:127], v[220:223]
    s_cmp_eq_u32 s4, 0
    s_cselect_b32 s77, 1073741824, s77
    v_mfma_f32_16x16x32_bf16 v[224:227], v[48:51], a[64:67], v[224:227]
    s_mov_b32 s76, 0
    v_mfma_f32_16x16x32_bf16 v[224:227], v[52:55], a[68:71], v[224:227]
    s_add_u32 s62, s62, 128
    v_mfma_f32_16x16x32_bf16 v[228:231], v[48:51], a[72:75], v[228:231]
    v_mfma_f32_16x16x32_bf16 v[228:231], v[52:55], a[76:79], v[228:231]
    v_mfma_f32_16x16x32_bf16 v[232:235], v[48:51], a[80:83], v[232:235]
    v_mfma_f32_16x16x32_bf16 v[232:235], v[52:55], a[84:87], v[232:235]
    s_waitcnt vmcnt(18)
    s_barrier
    ds_read_b64_tr_b16 v[56:57], v14 offset:0
    v_mfma_f32_16x16x32_bf16 v[236:239], v[48:51], a[88:91], v[236:239]
    s_add_u32 m0, s69, 0
    buffer_load_dword v7, v30, s[44:47], s95 offen sc1
    v_mfma_f32_16x16x32_bf16 v[236:239], v[52:55], a[92:95], v[236:239]
    buffer_load_dwordx4 v2, s[12:15], s60 offen nt lds
    v_mfma_f32_16x16x32_bf16 v[240:243], v[48:51], a[96:99], v[240:243]
    ds_read_b64_tr_b16 v[58:59], v14 offset:1024
    ds_read_b64_tr_b16 v[60:61], v14 offset:8192
    v_mfma_f32_16x16x32_bf16 v[240:243], v[52:55], a[100:103], v[240:243]
    ds_read_b64_tr_b16 v[62:63], v14 offset:9216
    ds_read_b64_tr_b16 v[40:41], v15 offset:0
    v_mfma_f32_16x16x32_bf16 v[244:247], v[48:51], a[104:107], v[244:247]
    ds_read_b64_tr_b16 v[42:43], v15 offset:1024
    ds_read_b64_tr_b16 v[44:45], v15 offset:8192
    v_mfma_f32_16x16x32_bf16 v[244:247], v[52:55], a[108:111], v[244:247]
    ds_read_b64_tr_b16 v[46:47], v15 offset:9216
    v_mfma_f32_16x16x32_bf16 v[248:251], v[48:51], a[112:115], v[248:251]
    v_mfma_f32_16x16x32_bf16 v[248:251], v[52:55], a[116:119], v[248:251]
    buffer_load_dwordx4 v3, s[12:15], s60 offen offset:1024 nt lds
    v_mfma_f32_16x16x32_bf16 v[252:255], v[48:51], a[120:123], v[252:255]
    ds_read_b64_tr_b16 v[48:49], v16 offset:0
    ds_read_b64_tr_b16 v[50:51], v16 offset:1024
    v_mfma_f32_16x16x32_bf16 v[252:255], v[52:55], a[124:127], v[252:255]
    s_waitcnt lgkmcnt(3)
    ds_read_b64_tr_b16 v[52:53], v16 offset:8192
    ds_read_b64_tr_b16 v[54:55], v16 offset:9216
    v_mfma_f32_16x16x32_bf16 a[128:131], a[64:67], v[56:59], a[128:131]
    v_mfma_f32_16x16x32_bf16 a[128:131], a[68:71], v[60:63], a[128:131]
    v_add_u32 v22, 0x10000, v22
    v_mfma_f32_16x16x32_bf16 a[132:135], a[72:75], v[56:59], a[132:135]
    ds_read_b128 a[32:35], v22 offset:16384
    v_mfma_f32_16x16x32_bf16 a[132:135], a[76:79], v[60:63], a[132:135]
    v_mfma_f32_16x16x32_bf16 a[136:139], a[80:83], v[56:59], a[136:139]
    v_mfma_f32_16x16x32_bf16 a[136:139], a[84:87], v[60:63], a[136:139]
    buffer_load_dwordx4 v4, s[12:15], s60 offen offset:2048 nt lds
    v_mfma_f32_16x16x32_bf16 a[140:143], a[88:91], v[56:59], a[140:143]
    v_add_u32 v23, 0x10000, v23
    v_mfma_f32_16x16x32_bf16 a[140:143], a[92:95], v[60:63], a[140:143]
    ds_read_b128 a[36:39], v23 offset:16384
    v_mfma_f32_16x16x32_bf16 a[144:147], a[96:99], v[56:59], a[144:147]
    v_mfma_f32_16x16x32_bf16 a[144:147], a[100:103], v[60:63], a[144:147]
    v_mfma_f32_16x16x32_bf16 a[148:151], a[104:107], v[56:59], a[148:151]
    v_mfma_f32_16x16x32_bf16 a[148:151], a[108:111], v[60:63], a[148:151]
    v_mfma_f32_16x16x32_bf16 a[152:155], a[112:115], v[56:59], a[152:155]
    buffer_load_dwordx4 v5, s[12:15], s60 offen offset:3072 nt lds
    v_mfma_f32_16x16x32_bf16 a[152:155], a[116:119], v[60:63], a[152:155]
    ds_read_b128 a[40:43], v22 offset:18432
    v_mfma_f32_16x16x32_bf16 a[156:159], a[120:123], v[56:59], a[156:159]
    ds_read_b64_tr_b16 v[56:57], v17 offset:0
    ds_read_b64_tr_b16 v[58:59], v17 offset:1024
    v_mfma_f32_16x16x32_bf16 a[156:159], a[124:127], v[60:63], a[156:159]
    ds_read_b64_tr_b16 v[60:61], v17 offset:8192
    ds_read_b64_tr_b16 v[62:63], v17 offset:9216
    v_mfma_f32_16x16x32_bf16 a[160:163], a[64:67], v[40:43], a[160:163]
    s_waitcnt lgkmcnt(5)
    v_mfma_f32_16x16x32_bf16 a[160:163], a[68:71], v[44:47], a[160:163]
    v_mfma_f32_16x16x32_bf16 a[164:167], a[72:75], v[40:43], a[164:167]
    ds_read_b128 a[44:47], v23 offset:18432
    v_mfma_f32_16x16x32_bf16 a[164:167], a[76:79], v[44:47], a[164:167]
    s_add_u32 m0, s69, 16384
    v_mfma_f32_16x16x32_bf16 a[168:171], a[80:83], v[40:43], a[168:171]
    buffer_load_dwordx4 v10, s[20:23], s63 offen lds
    v_mfma_f32_16x16x32_bf16 a[168:171], a[84:87], v[44:47], a[168:171]
    v_mfma_f32_16x16x32_bf16 a[172:175], a[88:91], v[40:43], a[172:175]
    v_mfma_f32_16x16x32_bf16 a[172:175], a[92:95], v[44:47], a[172:175]
    v_mfma_f32_16x16x32_bf16 a[176:179], a[96:99], v[40:43], a[176:179]
    ds_read_b128 a[48:51], v22 offset:20480
    v_mfma_f32_16x16x32_bf16 a[176:179], a[100:103], v[44:47], a[176:179]
    v_mfma_f32_16x16x32_bf16 a[180:183], a[104:107], v[40:43], a[180:183]
    v_mfma_f32_16x16x32_bf16 a[180:183], a[108:111], v[44:47], a[180:183]
    buffer_load_dwordx4 v11, s[20:23], s63 offen offset:1024 lds
    v_mfma_f32_16x16x32_bf16 a[184:187], a[112:115], v[40:43], a[184:187]
    v_mfma_f32_16x16x32_bf16 a[184:187], a[116:119], v[44:47], a[184:187]
    ds_read_b128 a[52:55], v23 offset:20480
    v_mfma_f32_16x16x32_bf16 a[188:191], a[120:123], v[40:43], a[188:191]
    v_mfma_f32_16x16x32_bf16 a[188:191], a[124:127], v[44:47], a[188:191]
    v_mfma_f32_16x16x32_bf16 a[192:195], a[64:67], v[48:51], a[192:195]
    v_mfma_f32_16x16x32_bf16 a[192:195], a[68:71], v[52:55], a[192:195]
    v_mfma_f32_16x16x32_bf16 a[196:199], a[72:75], v[48:51], a[196:199]
    v_mfma_f32_16x16x32_bf16 a[196:199], a[76:79], v[52:55], a[196:199]
    buffer_load_dwordx4 v12, s[20:23], s63 offen offset:2048 lds
    v_mfma_f32_16x16x32_bf16 a[200:203], a[80:83], v[48:51], a[200:203]
    ds_read_b128 a[56:59], v22 offset:22528
    v_mfma_f32_16x16x32_bf16 a[200:203], a[84:87], v[52:55], a[200:203]
    v_mfma_f32_16x16x32_bf16 a[204:207], a[88:91], v[48:51], a[204:207]
    v_mfma_f32_16x16x32_bf16 a[204:207], a[92:95], v[52:55], a[204:207]
    v_mfma_f32_16x16x32_bf16 a[208:211], a[96:99], v[48:51], a[208:211]
    ds_read_b128 a[60:63], v23 offset:22528
    v_mfma_f32_16x16x32_bf16 a[208:211], a[100:103], v[52:55], a[208:211]
    v_mfma_f32_16x16x32_bf16 a[212:215], a[104:107], v[48:51], a[212:215]
    buffer_load_dwordx4 v13, s[20:23], s63 offen offset:3072 lds
    v_mfma_f32_16x16x32_bf16 a[212:215], a[108:111], v[52:55], a[212:215]
    v_mfma_f32_16x16x32_bf16 a[216:219], a[112:115], v[48:51], a[216:219]
    v_mfma_f32_16x16x32_bf16 a[216:219], a[116:119], v[52:55], a[216:219]
    v_mfma_f32_16x16x32_bf16 a[220:223], a[120:123], v[48:51], a[220:223]
    v_mfma_f32_16x16x32_bf16 a[220:223], a[124:127], v[52:55], a[220:223]
    s_waitcnt lgkmcnt(0)
    v_mfma_f32_16x16x32_bf16 a[224:227], a[64:67], v[56:59], a[224:227]
    v_mfma_f32_16x16x32_bf16 a[224:227], a[68:71], v[60:63], a[224:227]
    s_add_u32 s63, s63, 128
    v_mfma_f32_16x16x32_bf16 a[228:231], a[72:75], v[56:59], a[228:231]
    buffer_load_dword v114, v103, s[52:55], s77 offen
    v_mfma_f32_16x16x32_bf16 a[228:231], a[76:79], v[60:63], a[228:231]
    s_mov_b32 s77, s75
    v_mfma_f32_16x16x32_bf16 a[232:235], a[80:83], v[56:59], a[232:235]
    v_mfma_f32_16x16x32_bf16 a[232:235], a[84:87], v[60:63], a[232:235]
    s_waitcnt vmcnt(19)
    s_barrier
    ds_read_b64_tr_b16 v[40:41], v14 offset:32768
    v_mfma_f32_16x16x32_bf16 a[236:239], a[88:91], v[56:59], a[236:239]
    s_add_u32 m0, s69, 32768
    ds_read_b64_tr_b16 v[42:43], v14 offset:33792
    ds_read_b64_tr_b16 v[44:45], v14 offset:40960
    v_mfma_f32_16x16x32_bf16 a[236:239], a[92:95], v[60:63], a[236:239]
    buffer_load_dwordx4 v2, s[16:19], s60 offen nt lds
    v_mfma_f32_16x16x32_bf16 a[240:243], a[96:99], v[56:59], a[240:243]
    ds_read_b64_tr_b16 v[46:47], v14 offset:41984
    ds_read_b64_tr_b16 v[48:49], v15 offset:32768
    v_mfma_f32_16x16x32_bf16 a[240:243], a[100:103], v[60:63], a[240:243]
    ds_read_b64_tr_b16 v[50:51], v15 offset:33792
    ds_read_b64_tr_b16 v[52:53], v15 offset:40960
    v_mfma_f32_16x16x32_bf16 a[244:247], a[104:107], v[56:59], a[244:247]
    ds_read_b64_tr_b16 v[54:55], v15 offset:41984
    v_add_u32 v14, 0x10000, v14
    v_mfma_f32_16x16x32_bf16 a[244:247], a[108:111], v[60:63], a[244:247]
    v_add_u32 v15, 0x10000, v15
    v_mfma_f32_16x16x32_bf16 a[248:251], a[112:115], v[56:59], a[248:251]
    v_mfma_f32_16x16x32_bf16 a[248:251], a[116:119], v[60:63], a[248:251]
    buffer_load_dwordx4 v3, s[16:19], s60 offen offset:1024 nt lds
    v_mfma_f32_16x16x32_bf16 a[252:255], a[120:123], v[56:59], a[252:255]
    ds_read_b64_tr_b16 v[56:57], v16 offset:32768
    ds_read_b64_tr_b16 v[58:59], v16 offset:33792
    v_mfma_f32_16x16x32_bf16 a[252:255], a[124:127], v[60:63], a[252:255]
    s_waitcnt lgkmcnt(2)
    ds_read_b64_tr_b16 v[60:61], v16 offset:40960
    ds_read_b64_tr_b16 v[62:63], v16 offset:41984
    v_mfma_f32_16x16x32_bf16 v[128:131], v[40:43], a[0:3], v[128:131]
    v_add_u32 v16, 0x10000, v16
    v_mfma_f32_16x16x32_bf16 v[128:131], v[44:47], a[4:7], v[128:131]
    v_mfma_f32_16x16x32_bf16 v[132:135], v[40:43], a[8:11], v[132:135]
    ds_read_b128 a[64:67], v22 offset:49152
    v_mfma_f32_16x16x32_bf16 v[132:135], v[44:47], a[12:15], v[132:135]
    v_mfma_f32_16x16x32_bf16 v[136:139], v[40:43], a[16:19], v[136:139]
    v_mfma_f32_16x16x32_bf16 v[136:139], v[44:47], a[20:23], v[136:139]
    buffer_load_dwordx4 v4, s[16:19], s60 offen offset:2048 nt lds
    v_mfma_f32_16x16x32_bf16 v[140:143], v[40:43], a[24:27], v[140:143]
    v_mfma_f32_16x16x32_bf16 v[140:143], v[44:47], a[28:31], v[140:143]
    ds_read_b128 a[68:71], v23 offset:49152
    v_mfma_f32_16x16x32_bf16 v[144:147], v[40:43], a[32:35], v[144:147]
    v_mfma_f32_16x16x32_bf16 v[144:147], v[44:47], a[36:39], v[144:147]
    v_mfma_f32_16x16x32_bf16 v[148:151], v[40:43], a[40:43], v[148:151]
    v_mfma_f32_16x16x32_bf16 v[148:151], v[44:47], a[44:47], v[148:151]
    v_mfma_f32_16x16x32_bf16 v[152:155], v[40:43], a[48:51], v[152:155]
    buffer_load_dwordx4 v5, s[16:19], s60 offen offset:3072 nt lds
    v_mfma_f32_16x16x32_bf16 v[152:155], v[44:47], a[52:55], v[152:155]
    ds_read_b128 a[72:75], v22 offset:51200
    v_mfma_f32_16x16x32_bf16 v[156:159], v[40:43], a[56:59], v[156:159]
    ds_read_b64_tr_b16 v[40:41], v17 offset:32768
    ds_read_b64_tr_b16 v[42:43], v17 offset:33792
    v_mfma_f32_16x16x32_bf16 v[156:159], v[44:47], a[60:63], v[156:159]
    ds_read_b64_tr_b16 v[44:45], v17 offset:40960
    ds_read_b64_tr_b16 v[46:47], v17 offset:41984
    v_mfma_f32_16x16x32_bf16 v[160:163], v[48:51], a[0:3], v[160:163]
    v_add_u32 v17, 0x10000, v17
    v_mfma_f32_16x16x32_bf16 v[160:163], v[52:55], a[4:7], v[160:163]
    v_mfma_f32_16x16x32_bf16 v[164:167], v[48:51], a[8:11], v[164:167]
    ds_read_b128 a[76:79], v23 offset:51200
    v_mfma_f32_16x16x32_bf16 v[164:167], v[52:55], a[12:15], v[164:167]
    s_add_u32 m0, s69, 49152
    v_mfma_f32_16x16x32_bf16 v[168:171], v[48:51], a[16:19], v[168:171]
    s_add_u32 s60, s60, 524288
    buffer_load_dwordx4 v10, s[20:23], s64 offen lds
    v_mfma_f32_16x16x32_bf16 v[168:171], v[52:55], a[20:23], v[168:171]
    v_mfma_f32_16x16x32_bf16 v[172:175], v[48:51], a[24:27], v[172:175]
    v_mfma_f32_16x16x32_bf16 v[172:175], v[52:55], a[28:31], v[172:175]
    v_mfma_f32_16x16x32_bf16 v[176:179], v[48:51], a[32:35], v[176:179]
    ds_read_b128 a[80:83], v22 offset:53248
    v_mfma_f32_16x16x32_bf16 v[176:179], v[52:55], a[36:39], v[176:179]
    v_mfma_f32_16x16x32_bf16 v[180:183], v[48:51], a[40:43], v[180:183]
    v_mfma_f32_16x16x32_bf16 v[180:183], v[52:55], a[44:47], v[180:183]
    buffer_load_dwordx4 v11, s[20:23], s64 offen offset:1024 lds
    v_mfma_f32_16x16x32_bf16 v[184:187], v[48:51], a[48:51], v[184:187]
    v_mfma_f32_16x16x32_bf16 v[184:187], v[52:55], a[52:55], v[184:187]
    ds_read_b128 a[84:87], v23 offset:53248
    v_mfma_f32_16x16x32_bf16 v[188:191], v[48:51], a[56:59], v[188:191]
    v_mfma_f32_16x16x32_bf16 v[188:191], v[52:55], a[60:63], v[188:191]
    s_waitcnt lgkmcnt(1)
    v_mfma_f32_16x16x32_bf16 v[192:195], v[56:59], a[0:3], v[192:195]
    v_mfma_f32_16x16x32_bf16 v[192:195], v[60:63], a[4:7], v[192:195]
    v_mfma_f32_16x16x32_bf16 v[196:199], v[56:59], a[8:11], v[196:199]
    v_mfma_f32_16x16x32_bf16 v[196:199], v[60:63], a[12:15], v[196:199]
    buffer_load_dwordx4 v12, s[20:23], s64 offen offset:2048 lds
    v_mfma_f32_16x16x32_bf16 v[200:203], v[56:59], a[16:19], v[200:203]
    ds_read_b128 a[88:91], v22 offset:55296
    v_mfma_f32_16x16x32_bf16 v[200:203], v[60:63], a[20:23], v[200:203]
    v_mfma_f32_16x16x32_bf16 v[204:207], v[56:59], a[24:27], v[204:207]
    v_mfma_f32_16x16x32_bf16 v[204:207], v[60:63], a[28:31], v[204:207]
    v_mfma_f32_16x16x32_bf16 v[208:211], v[56:59], a[32:35], v[208:211]
    ds_read_b128 a[92:95], v23 offset:55296
    v_mfma_f32_16x16x32_bf16 v[208:211], v[60:63], a[36:39], v[208:211]
    v_mfma_f32_16x16x32_bf16 v[212:215], v[56:59], a[40:43], v[212:215]
    buffer_load_dwordx4 v13, s[20:23], s64 offen offset:3072 lds
    v_mfma_f32_16x16x32_bf16 v[212:215], v[60:63], a[44:47], v[212:215]
    v_mfma_f32_16x16x32_bf16 v[216:219], v[56:59], a[48:51], v[216:219]
    v_mfma_f32_16x16x32_bf16 v[216:219], v[60:63], a[52:55], v[216:219]
    v_mfma_f32_16x16x32_bf16 v[220:223], v[56:59], a[56:59], v[220:223]
    v_mfma_f32_16x16x32_bf16 v[220:223], v[60:63], a[60:63], v[220:223]
    v_mfma_f32_16x16x32_bf16 v[224:227], v[40:43], a[0:3], v[224:227]
    v_mfma_f32_16x16x32_bf16 v[224:227], v[44:47], a[4:7], v[224:227]
    s_add_u32 s64, s64, 128
    v_mfma_f32_16x16x32_bf16 v[228:231], v[40:43], a[8:11], v[228:231]
    v_mfma_f32_16x16x32_bf16 v[228:231], v[44:47], a[12:15], v[228:231]
    v_mfma_f32_16x16x32_bf16 v[232:235], v[40:43], a[16:19], v[232:235]
    v_mfma_f32_16x16x32_bf16 v[232:235], v[44:47], a[20:23], v[232:235]
    s_waitcnt vmcnt(19)
    s_barrier
    ds_read_b64_tr_b16 v[48:49], v14 offset:0
    v_mfma_f32_16x16x32_bf16 v[236:239], v[40:43], a[24:27], v[236:239]
    s_add_u32 m0, s69, 65536
    ds_read_b64_tr_b16 v[50:51], v14 offset:1024
    ds_read_b64_tr_b16 v[52:53], v14 offset:8192
    v_mfma_f32_16x16x32_bf16 v[236:239], v[44:47], a[28:31], v[236:239]
    s_lshl_b32 s60, s5, 8
    buffer_load_dwordx4 v2, s[24:27], s60 offen lds
    v_mfma_f32_16x16x32_bf16 v[240:243], v[40:43], a[32:35], v[240:243]
    ds_read_b64_tr_b16 v[54:55], v14 offset:9216
    ds_read_b64_tr_b16 v[56:57], v15 offset:0
    v_mfma_f32_16x16x32_bf16 v[240:243], v[44:47], a[36:39], v[240:243]
    ds_read_b64_tr_b16 v[58:59], v15 offset:1024
    ds_read_b64_tr_b16 v[60:61], v15 offset:8192
    v_mfma_f32_16x16x32_bf16 v[244:247], v[40:43], a[40:43], v[244:247]
    ds_read_b64_tr_b16 v[62:63], v15 offset:9216
    v_add_u32 v14, 0xfffe0000, v14
    v_mfma_f32_16x16x32_bf16 v[244:247], v[44:47], a[44:47], v[244:247]
    v_add_u32 v15, 0xfffe0000, v15
    v_mfma_f32_16x16x32_bf16 v[248:251], v[40:43], a[48:51], v[248:251]
    v_mfma_f32_16x16x32_bf16 v[248:251], v[44:47], a[52:55], v[248:251]
    buffer_load_dwordx4 v3, s[24:27], s60 offen offset:1024 lds
    v_mfma_f32_16x16x32_bf16 v[252:255], v[40:43], a[56:59], v[252:255]
    ds_read_b64_tr_b16 v[40:41], v16 offset:0
    ds_read_b64_tr_b16 v[42:43], v16 offset:1024
    v_mfma_f32_16x16x32_bf16 v[252:255], v[44:47], a[60:63], v[252:255]
    s_waitcnt lgkmcnt(2)
    ds_read_b64_tr_b16 v[44:45], v16 offset:8192
    ds_read_b64_tr_b16 v[46:47], v16 offset:9216
    v_mfma_f32_16x16x32_bf16 a[128:131], a[0:3], v[48:51], a[128:131]
    v_add_u32 v16, 0xfffe0000, v16
    v_mfma_f32_16x16x32_bf16 a[128:131], a[4:7], v[52:55], a[128:131]
    v_add_u32 v22, 0x10000, v22
    v_mfma_f32_16x16x32_bf16 a[132:135], a[8:11], v[48:51], a[132:135]
    ds_read_b128 a[96:99], v22 offset:16384
    v_mfma_f32_16x16x32_bf16 a[132:135], a[12:15], v[52:55], a[132:135]
    v_mfma_f32_16x16x32_bf16 a[136:139], a[16:19], v[48:51], a[136:139]
    v_mfma_f32_16x16x32_bf16 a[136:139], a[20:23], v[52:55], a[136:139]
    buffer_load_dwordx4 v4, s[24:27], s60 offen offset:2048 lds
    v_mfma_f32_16x16x32_bf16 a[140:143], a[24:27], v[48:51], a[140:143]
    v_add_u32 v23, 0x10000, v23
    v_mfma_f32_16x16x32_bf16 a[140:143], a[28:31], v[52:55], a[140:143]
    ds_read_b128 a[100:103], v23 offset:16384
    v_mfma_f32_16x16x32_bf16 a[144:147], a[32:35], v[48:51], a[144:147]
    v_mfma_f32_16x16x32_bf16 a[144:147], a[36:39], v[52:55], a[144:147]
    v_mfma_f32_16x16x32_bf16 a[148:151], a[40:43], v[48:51], a[148:151]
    v_mfma_f32_16x16x32_bf16 a[148:151], a[44:47], v[52:55], a[148:151]
    v_mfma_f32_16x16x32_bf16 a[152:155], a[48:51], v[48:51], a[152:155]
    buffer_load_dwordx4 v5, s[24:27], s60 offen offset:3072 lds
    v_mfma_f32_16x16x32_bf16 a[152:155], a[52:55], v[52:55], a[152:155]
    ds_read_b128 a[104:107], v22 offset:18432
    v_mfma_f32_16x16x32_bf16 a[156:159], a[56:59], v[48:51], a[156:159]
    ds_read_b64_tr_b16 v[48:49], v17 offset:0
    ds_read_b64_tr_b16 v[50:51], v17 offset:1024
    v_mfma_f32_16x16x32_bf16 a[156:159], a[60:63], v[52:55], a[156:159]
    ds_read_b64_tr_b16 v[52:53], v17 offset:8192
    ds_read_b64_tr_b16 v[54:55], v17 offset:9216
    v_mfma_f32_16x16x32_bf16 a[160:163], a[0:3], v[56:59], a[160:163]
    v_add_u32 v17, 0xfffe0000, v17
    v_mfma_f32_16x16x32_bf16 a[160:163], a[4:7], v[60:63], a[160:163]
    v_mfma_f32_16x16x32_bf16 a[164:167], a[8:11], v[56:59], a[164:167]
    ds_read_b128 a[108:111], v23 offset:18432
    v_mfma_f32_16x16x32_bf16 a[164:167], a[12:15], v[60:63], a[164:167]
    s_add_u32 m0, s69, 81920
    v_mfma_f32_16x16x32_bf16 a[168:171], a[16:19], v[56:59], a[168:171]
    s_add_u32 s60, s60, 524288
    buffer_load_dwordx4 v10, s[20:23], s63 offen lds
    v_mfma_f32_16x16x32_bf16 a[168:171], a[20:23], v[60:63], a[168:171]
    v_mfma_f32_16x16x32_bf16 a[172:175], a[24:27], v[56:59], a[172:175]
    v_mfma_f32_16x16x32_bf16 a[172:175], a[28:31], v[60:63], a[172:175]
    v_mfma_f32_16x16x32_bf16 a[176:179], a[32:35], v[56:59], a[176:179]
    ds_read_b128 a[112:115], v22 offset:20480
    v_mfma_f32_16x16x32_bf16 a[176:179], a[36:39], v[60:63], a[176:179]
    v_mfma_f32_16x16x32_bf16 a[180:183], a[40:43], v[56:59], a[180:183]
    v_mfma_f32_16x16x32_bf16 a[180:183], a[44:47], v[60:63], a[180:183]
    buffer_load_dwordx4 v11, s[20:23], s63 offen offset:1024 lds
    v_mfma_f32_16x16x32_bf16 a[184:187], a[48:51], v[56:59], a[184:187]
    v_mfma_f32_16x16x32_bf16 a[184:187], a[52:55], v[60:63], a[184:187]
    ds_read_b128 a[116:119], v23 offset:20480
    v_mfma_f32_16x16x32_bf16 a[188:191], a[56:59], v[56:59], a[188:191]
    v_mfma_f32_16x16x32_bf16 a[188:191], a[60:63], v[60:63], a[188:191]
    s_waitcnt lgkmcnt(1)
    v_mfma_f32_16x16x32_bf16 a[192:195], a[0:3], v[40:43], a[192:195]
    v_mfma_f32_16x16x32_bf16 a[192:195], a[4:7], v[44:47], a[192:195]
    v_mfma_f32_16x16x32_bf16 a[196:199], a[8:11], v[40:43], a[196:199]
    v_mfma_f32_16x16x32_bf16 a[196:199], a[12:15], v[44:47], a[196:199]
    buffer_load_dwordx4 v12, s[20:23], s63 offen offset:2048 lds
    v_mfma_f32_16x16x32_bf16 a[200:203], a[16:19], v[40:43], a[200:203]
    ds_read_b128 a[120:123], v22 offset:22528
    v_mov_b32 v22, v100
    v_mfma_f32_16x16x32_bf16 a[200:203], a[20:23], v[44:47], a[200:203]
    v_add_u32 v22, 0x10000, v22
    v_mfma_f32_16x16x32_bf16 a[204:207], a[24:27], v[40:43], a[204:207]
    v_mfma_f32_16x16x32_bf16 a[204:207], a[28:31], v[44:47], a[204:207]
    v_mfma_f32_16x16x32_bf16 a[208:211], a[32:35], v[40:43], a[208:211]
    ds_read_b128 a[124:127], v23 offset:22528
    v_mov_b32 v23, v101
    v_mfma_f32_16x16x32_bf16 a[208:211], a[36:39], v[44:47], a[208:211]
    v_add_u32 v23, 0x10000, v23
    v_mfma_f32_16x16x32_bf16 a[212:215], a[40:43], v[40:43], a[212:215]
    buffer_load_dwordx4 v13, s[20:23], s63 offen offset:3072 lds
    v_mfma_f32_16x16x32_bf16 a[212:215], a[44:47], v[44:47], a[212:215]
    v_mfma_f32_16x16x32_bf16 a[216:219], a[48:51], v[40:43], a[216:219]
    v_mfma_f32_16x16x32_bf16 a[216:219], a[52:55], v[44:47], a[216:219]
    v_mfma_f32_16x16x32_bf16 a[220:223], a[56:59], v[40:43], a[220:223]
    v_mfma_f32_16x16x32_bf16 a[220:223], a[60:63], v[44:47], a[220:223]
    v_mfma_f32_16x16x32_bf16 a[224:227], a[0:3], v[48:51], a[224:227]
    v_mfma_f32_16x16x32_bf16 a[224:227], a[4:7], v[52:55], a[224:227]
    s_add_u32 s63, s63, 128
    v_mfma_f32_16x16x32_bf16 a[228:231], a[8:11], v[48:51], a[228:231]
    v_mfma_f32_16x16x32_bf16 a[228:231], a[12:15], v[52:55], a[228:231]
    v_mfma_f32_16x16x32_bf16 a[232:235], a[16:19], v[48:51], a[232:235]
    v_mfma_f32_16x16x32_bf16 a[232:235], a[20:23], v[52:55], a[232:235]
    s_add_u32 m0, s67, 98304
    s_waitcnt vmcnt(17)
    v_cmp_gt_u32 vcc, 8, v7
    s_nop 1
    s_and_b64 vcc, vcc, s[86:87]
    s_cbranch_scc1 SPIN_H14
BACK_H14:
    s_barrier
    v_mfma_f32_16x16x32_bf16 a[236:239], a[24:27], v[48:51], a[236:239]
    buffer_load_dwordx4 v1, s[28:31], s65 offen sc1 lds
    v_mfma_f32_16x16x32_bf16 a[236:239], a[28:31], v[52:55], a[236:239]
    ds_read_b64_tr_b16 v[56:57], v14 offset:0
    ds_read_b64_tr_b16 v[58:59], v14 offset:1024
    v_mfma_f32_16x16x32_bf16 a[240:243], a[32:35], v[48:51], a[240:243]
    ds_read_b64_tr_b16 v[60:61], v14 offset:8192
    ds_read_b64_tr_b16 v[62:63], v14 offset:9216
    v_mfma_f32_16x16x32_bf16 a[240:243], a[36:39], v[52:55], a[240:243]
    ds_read_b64_tr_b16 v[40:41], v15 offset:0
    ds_read_b64_tr_b16 v[42:43], v15 offset:1024
    v_mfma_f32_16x16x32_bf16 a[244:247], a[40:43], v[48:51], a[244:247]
    ds_read_b64_tr_b16 v[44:45], v15 offset:8192
    ds_read_b64_tr_b16 v[46:47], v15 offset:9216
    v_mfma_f32_16x16x32_bf16 a[244:247], a[44:47], v[52:55], a[244:247]
    v_mfma_f32_16x16x32_bf16 a[248:251], a[48:51], v[48:51], a[248:251]
    v_mfma_f32_16x16x32_bf16 a[248:251], a[52:55], v[52:55], a[248:251]
    v_mfma_f32_16x16x32_bf16 a[252:255], a[56:59], v[48:51], a[252:255]
    buffer_load_dwordx4 v1, s[28:31], s65 offen offset:1024 sc1 lds
    v_mfma_f32_16x16x32_bf16 a[252:255], a[60:63], v[52:55], a[252:255]
    s_waitcnt lgkmcnt(0)
    ds_read_b64_tr_b16 v[48:49], v16 offset:0
    ds_read_b64_tr_b16 v[50:51], v16 offset:1024
    v_mfma_f32_16x16x32_bf16 v[128:131], v[56:59], a[64:67], v[128:131]
    ds_read_b64_tr_b16 v[52:53], v16 offset:8192
    ds_read_b64_tr_b16 v[54:55], v16 offset:9216
    v_mfma_f32_16x16x32_bf16 v[128:131], v[60:63], a[68:71], v[128:131]
    v_mfma_f32_16x16x32_bf16 v[132:135], v[56:59], a[72:75], v[132:135]
    ds_read_b128 v[64:67], v24 offset:16384
    v_mfma_f32_16x16x32_bf16 v[132:135], v[60:63], a[76:79], v[132:135]
    v_mfma_f32_16x16x32_bf16 v[136:139], v[56:59], a[80:83], v[136:139]
    v_mfma_f32_16x16x32_bf16 v[136:139], v[60:63], a[84:87], v[136:139]
    v_mfma_f32_16x16x32_bf16 v[140:143], v[56:59], a[88:91], v[140:143]
    s_add_u32 m0, s68, 106496
    v_mfma_f32_16x16x32_bf16 v[140:143], v[60:63], a[92:95], v[140:143]
    buffer_load_dwordx4 v6, s[20:23], s66 offen lds
    v_mfma_f32_16x16x32_bf16 v[144:147], v[56:59], a[96:99], v[144:147]
    v_cvt_pk_bf16_f32 v128, v128, v129
    v_cvt_pk_bf16_f32 v130, v130, v131
    v_mfma_f32_16x16x32_bf16 v[144:147], v[60:63], a[100:103], v[144:147]
    v_accvgpr_write_b32 a0, v128
    v_accvgpr_write_b32 a1, v130
    v_mfma_f32_16x16x32_bf16 v[148:151], v[56:59], a[104:107], v[148:151]
    v_cvt_pk_bf16_f32 v132, v132, v133
    v_cvt_pk_bf16_f32 v134, v134, v135
    v_mfma_f32_16x16x32_bf16 v[148:151], v[60:63], a[108:111], v[148:151]
    v_accvgpr_write_b32 a8, v132
    v_accvgpr_write_b32 a9, v134
    v_mfma_f32_16x16x32_bf16 v[152:155], v[56:59], a[112:115], v[152:155]
    v_cvt_pk_bf16_f32 v136, v136, v137
    v_cvt_pk_bf16_f32 v138, v138, v139
    v_mfma_f32_16x16x32_bf16 v[152:155], v[60:63], a[116:119], v[152:155]
    ds_read_b128 v[68:71], v25 offset:16384
    v_accvgpr_write_b32 a16, v136
    v_mfma_f32_16x16x32_bf16 v[156:159], v[56:59], a[120:123], v[156:159]
    s_add_u32 m0, s69, 114688
    ds_read_b64_tr_b16 v[56:57], v17 offset:0
    ds_read_b64_tr_b16 v[58:59], v17 offset:1024
    v_mfma_f32_16x16x32_bf16 v[156:159], v[60:63], a[124:127], v[156:159]
    s_add_u32 s65, s65, 8192
    buffer_load_dwordx4 v10, s[20:23], s64 offen lds
    v_mfma_f32_16x16x32_bf16 v[160:163], v[40:43], a[64:67], v[160:163]
    s_add_u32 s66, s66, 128
    ds_read_b64_tr_b16 v[60:61], v17 offset:8192
    ds_read_b64_tr_b16 v[62:63], v17 offset:9216
    v_mfma_f32_16x16x32_bf16 v[160:163], v[44:47], a[68:71], v[160:163]
    v_accvgpr_write_b32 a17, v138
    v_cvt_pk_bf16_f32 v140, v140, v141
    v_mfma_f32_16x16x32_bf16 v[164:167], v[40:43], a[72:75], v[164:167]
    v_cvt_pk_bf16_f32 v142, v142, v143
    v_accvgpr_write_b32 a24, v140
    v_mfma_f32_16x16x32_bf16 v[164:167], v[44:47], a[76:79], v[164:167]
    v_accvgpr_write_b32 a25, v142
    v_cvt_pk_bf16_f32 v144, v144, v145
    v_mfma_f32_16x16x32_bf16 v[168:171], v[40:43], a[80:83], v[168:171]
    v_cvt_pk_bf16_f32 v146, v146, v147
    v_accvgpr_write_b32 a32, v144
    v_mfma_f32_16x16x32_bf16 v[168:171], v[44:47], a[84:87], v[168:171]
    v_accvgpr_write_b32 a33, v146
    v_cvt_pk_bf16_f32 v148, v148, v149
    v_mfma_f32_16x16x32_bf16 v[172:175], v[40:43], a[88:91], v[172:175]
    v_cvt_pk_bf16_f32 v150, v150, v151
    v_accvgpr_write_b32 a40, v148
    v_mfma_f32_16x16x32_bf16 v[172:175], v[44:47], a[92:95], v[172:175]
    v_accvgpr_write_b32 a41, v150
    v_cvt_pk_bf16_f32 v152, v152, v153
    v_mfma_f32_16x16x32_bf16 v[176:179], v[40:43], a[96:99], v[176:179]
    buffer_load_dwordx4 v11, s[20:23], s64 offen offset:1024 lds
    v_mfma_f32_16x16x32_bf16 v[176:179], v[44:47], a[100:103], v[176:179]
    ds_read_b128 v[72:75], v24 offset:24576
    v_cvt_pk_bf16_f32 v154, v154, v155
    v_mfma_f32_16x16x32_bf16 v[180:183], v[40:43], a[104:107], v[180:183]
    v_cvt_pk_bf16_f32 v160, v160, v161
    v_cvt_pk_bf16_f32 v162, v162, v163
    v_mfma_f32_16x16x32_bf16 v[180:183], v[44:47], a[108:111], v[180:183]
    v_accvgpr_write_b32 a48, v152
    v_accvgpr_write_b32 a49, v154
    v_mfma_f32_16x16x32_bf16 v[184:187], v[40:43], a[112:115], v[184:187]
    v_accvgpr_write_b32 a2, v160
    v_accvgpr_write_b32 a3, v162
    v_mfma_f32_16x16x32_bf16 v[184:187], v[44:47], a[116:119], v[184:187]
    v_cvt_pk_bf16_f32 v156, v156, v157
    v_cvt_pk_bf16_f32 v158, v158, v159
    v_mfma_f32_16x16x32_bf16 v[188:191], v[40:43], a[120:123], v[188:191]
    v_accvgpr_write_b32 a56, v156
    v_accvgpr_write_b32 a57, v158
    v_mfma_f32_16x16x32_bf16 v[188:191], v[44:47], a[124:127], v[188:191]
    s_waitcnt lgkmcnt(0)
    v_cvt_pk_bf16_f32 v164, v164, v165
    v_cvt_pk_bf16_f32 v166, v166, v167
    v_mfma_f32_16x16x32_bf16 v[192:195], v[48:51], a[64:67], v[192:195]
    buffer_load_dwordx4 v12, s[20:23], s64 offen offset:2048 lds
    v_mfma_f32_16x16x32_bf16 v[192:195], v[52:55], a[68:71], v[192:195]
    v_accvgpr_write_b32 a10, v164
    v_accvgpr_write_b32 a11, v166
    v_mfma_f32_16x16x32_bf16 v[196:199], v[48:51], a[72:75], v[196:199]
    v_cvt_pk_bf16_f32 v168, v168, v169
    v_cvt_pk_bf16_f32 v170, v170, v171
    v_mfma_f32_16x16x32_bf16 v[196:199], v[52:55], a[76:79], v[196:199]
    ds_read_b128 v[76:79], v25 offset:24576
    v_accvgpr_write_b32 a18, v168
    v_mfma_f32_16x16x32_bf16 v[200:203], v[48:51], a[80:83], v[200:203]
    v_accvgpr_write_b32 a19, v170
    v_cvt_pk_bf16_f32 v172, v172, v173
    v_mfma_f32_16x16x32_bf16 v[200:203], v[52:55], a[84:87], v[200:203]
    v_cvt_pk_bf16_f32 v174, v174, v175
    v_accvgpr_write_b32 a26, v172
    v_mfma_f32_16x16x32_bf16 v[204:207], v[48:51], a[88:91], v[204:207]
    v_accvgpr_write_b32 a27, v174
    v_cvt_pk_bf16_f32 v176, v176, v177
    v_mfma_f32_16x16x32_bf16 v[204:207], v[52:55], a[92:95], v[204:207]
    v_cvt_pk_bf16_f32 v178, v178, v179
    v_accvgpr_write_b32 a34, v176
    v_mfma_f32_16x16x32_bf16 v[208:211], v[48:51], a[96:99], v[208:211]
    v_accvgpr_write_b32 a35, v178
    v_cvt_pk_bf16_f32 v180, v180, v181
    v_mfma_f32_16x16x32_bf16 v[208:211], v[52:55], a[100:103], v[208:211]
    buffer_load_dwordx4 v13, s[20:23], s64 offen offset:3072 lds
    v_mfma_f32_16x16x32_bf16 v[212:215], v[48:51], a[104:107], v[212:215]
    v_cvt_pk_bf16_f32 v182, v182, v183
    v_accvgpr_write_b32 a42, v180
    v_mfma_f32_16x16x32_bf16 v[212:215], v[52:55], a[108:111], v[212:215]
    v_accvgpr_write_b32 a43, v182
    v_cvt_pk_bf16_f32 v184, v184, v185
    v_mfma_f32_16x16x32_bf16 v[216:219], v[48:51], a[112:115], v[216:219]
    v_cvt_pk_bf16_f32 v186, v186, v187
    v_accvgpr_write_b32 a50, v184
    v_mfma_f32_16x16x32_bf16 v[216:219], v[52:55], a[116:119], v[216:219]
    v_accvgpr_write_b32 a51, v186
    v_cvt_pk_bf16_f32 v188, v188, v189
    v_mfma_f32_16x16x32_bf16 v[220:223], v[48:51], a[120:123], v[220:223]
    v_cvt_pk_bf16_f32 v190, v190, v191
    v_accvgpr_write_b32 a58, v188
    v_mfma_f32_16x16x32_bf16 v[220:223], v[52:55], a[124:127], v[220:223]
    v_accvgpr_write_b32 a59, v190
    v_cvt_pk_bf16_f32 v192, v192, v193
    v_mfma_f32_16x16x32_bf16 v[224:227], v[56:59], a[64:67], v[224:227]
    v_cvt_pk_bf16_f32 v194, v194, v195
    v_accvgpr_write_b32 a4, v192
    v_mfma_f32_16x16x32_bf16 v[224:227], v[60:63], a[68:71], v[224:227]
    s_add_u32 s64, s64, 128
    v_accvgpr_write_b32 a5, v194
    v_cvt_pk_bf16_f32 v196, v196, v197
    v_mfma_f32_16x16x32_bf16 v[228:231], v[56:59], a[72:75], v[228:231]
    v_cvt_pk_bf16_f32 v198, v198, v199
    v_accvgpr_write_b32 a12, v196
    v_mfma_f32_16x16x32_bf16 v[228:231], v[60:63], a[76:79], v[228:231]
    v_accvgpr_write_b32 a13, v198
    v_cvt_pk_bf16_f32 v224, v224, v225
    v_mfma_f32_16x16x32_bf16 v[232:235], v[56:59], a[80:83], v[232:235]
    v_cvt_pk_bf16_f32 v226, v226, v227
    v_accvgpr_write_b32 a6, v224
    v_mfma_f32_16x16x32_bf16 v[232:235], v[60:63], a[84:87], v[232:235]
    s_waitcnt vmcnt(15)
    s_barrier
    ds_read_b64_tr_b16 v[40:41], v14 offset:32768
    v_mfma_f32_16x16x32_bf16 v[236:239], v[56:59], a[88:91], v[236:239]
    s_add_u32 m0, s69, 131072
    ds_read_b64_tr_b16 v[42:43], v14 offset:33792
    ds_read_b64_tr_b16 v[44:45], v14 offset:40960
    v_mfma_f32_16x16x32_bf16 v[236:239], v[60:63], a[92:95], v[236:239]
    buffer_load_dwordx4 v2, s[24:27], s60 offen lds
    v_mfma_f32_16x16x32_bf16 v[240:243], v[56:59], a[96:99], v[240:243]
    ds_read_b64_tr_b16 v[46:47], v14 offset:41984
    ds_read_b64_tr_b16 v[48:49], v15 offset:32768
    v_mfma_f32_16x16x32_bf16 v[240:243], v[60:63], a[100:103], v[240:243]
    ds_read_b64_tr_b16 v[50:51], v15 offset:33792
    ds_read_b64_tr_b16 v[52:53], v15 offset:40960
    v_mfma_f32_16x16x32_bf16 v[244:247], v[56:59], a[104:107], v[244:247]
    ds_read_b64_tr_b16 v[54:55], v15 offset:41984
    v_xor_b32 v14, s73, v14
    v_mfma_f32_16x16x32_bf16 v[244:247], v[60:63], a[108:111], v[244:247]
    v_add_u32 v14, 0x10000, v14
    v_xor_b32 v15, s73, v15
    v_mfma_f32_16x16x32_bf16 v[248:251], v[56:59], a[112:115], v[248:251]
    v_add_u32 v15, 0x10000, v15
    v_accvgpr_write_b32 a7, v226
    v_mfma_f32_16x16x32_bf16 v[248:251], v[60:63], a[116:119], v[248:251]
    buffer_load_dwordx4 v3, s[24:27], s60 offen offset:1024 lds
    v_mfma_f32_16x16x32_bf16 v[252:255], v[56:59], a[120:123], v[252:255]
    ds_read_b64_tr_b16 v[56:57], v16 offset:32768
    ds_read_b64_tr_b16 v[58:59], v16 offset:33792
    v_mfma_f32_16x16x32_bf16 v[252:255], v[60:63], a[124:127], v[252:255]
    s_waitcnt lgkmcnt(2)
    ds_read_b64_tr_b16 v[60:61], v16 offset:40960
    ds_read_b64_tr_b16 v[62:63], v16 offset:41984
    v_mfma_f32_16x16x32_bf16 a[128:131], a[64:67], v[40:43], a[128:131]
    v_xor_b32 v16, s73, v16
    v_add_u32 v16, 0x10000, v16
    v_mfma_f32_16x16x32_bf16 a[128:131], a[68:71], v[44:47], a[128:131]
    v_cvt_pk_bf16_f32 v200, v200, v201
    v_cvt_pk_bf16_f32 v202, v202, v203
    v_mfma_f32_16x16x32_bf16 a[132:135], a[72:75], v[40:43], a[132:135]
    ds_read_b128 v[80:83], v24 offset:49152
    v_accvgpr_write_b32 a20, v200
    v_mfma_f32_16x16x32_bf16 a[132:135], a[76:79], v[44:47], a[132:135]
    v_accvgpr_write_b32 a21, v202
    v_cvt_pk_bf16_f32 v204, v204, v205
    v_mfma_f32_16x16x32_bf16 a[136:139], a[80:83], v[40:43], a[136:139]
    v_cvt_pk_bf16_f32 v206, v206, v207
    v_accvgpr_write_b32 a28, v204
    v_mfma_f32_16x16x32_bf16 a[136:139], a[84:87], v[44:47], a[136:139]
    buffer_load_dwordx4 v4, s[24:27], s60 offen offset:2048 lds
    v_mfma_f32_16x16x32_bf16 a[140:143], a[88:91], v[40:43], a[140:143]
    v_accvgpr_write_b32 a29, v206
    v_cvt_pk_bf16_f32 v208, v208, v209
    v_mfma_f32_16x16x32_bf16 a[140:143], a[92:95], v[44:47], a[140:143]
    v_cvt_pk_bf16_f32 v210, v210, v211
    v_accvgpr_write_b32 a36, v208
    v_mfma_f32_16x16x32_bf16 a[144:147], a[96:99], v[40:43], a[144:147]
    v_accvgpr_write_b32 a37, v210
    v_cvt_pk_bf16_f32 v212, v212, v213
    v_mfma_f32_16x16x32_bf16 a[144:147], a[100:103], v[44:47], a[144:147]
    v_cvt_pk_bf16_f32 v214, v214, v215
    v_accvgpr_write_b32 a44, v212
    v_mfma_f32_16x16x32_bf16 a[148:151], a[104:107], v[40:43], a[148:151]
    v_accvgpr_write_b32 a45, v214
    v_cvt_pk_bf16_f32 v216, v216, v217
    v_mfma_f32_16x16x32_bf16 a[148:151], a[108:111], v[44:47], a[148:151]
    v_cvt_pk_bf16_f32 v218, v218, v219
    v_accvgpr_write_b32 a52, v216
    v_mfma_f32_16x16x32_bf16 a[152:155], a[112:115], v[40:43], a[152:155]
    buffer_load_dwordx4 v5, s[24:27], s60 offen offset:3072 lds
    v_mfma_f32_16x16x32_bf16 a[152:155], a[116:119], v[44:47], a[152:155]
    ds_read_b128 v[84:87], v25 offset:49152
    v_accvgpr_write_b32 a53, v218
    v_mfma_f32_16x16x32_bf16 a[156:159], a[120:123], v[40:43], a[156:159]
    ds_read_b64_tr_b16 v[40:41], v17 offset:32768
    ds_read_b64_tr_b16 v[42:43], v17 offset:33792
    v_mfma_f32_16x16x32_bf16 a[156:159], a[124:127], v[44:47], a[156:159]
    ds_read_b64_tr_b16 v[44:45], v17 offset:40960
    ds_read_b64_tr_b16 v[46:47], v17 offset:41984
    v_mfma_f32_16x16x32_bf16 a[160:163], a[64:67], v[48:51], a[160:163]
    v_xor_b32 v17, s73, v17
    v_add_u32 v17, 0x10000, v17
    v_mfma_f32_16x16x32_bf16 a[160:163], a[68:71], v[52:55], a[160:163]
    v_cvt_pk_bf16_f32 v220, v220, v221
    v_cvt_pk_bf16_f32 v222, v222, v223
    v_mfma_f32_16x16x32_bf16 a[164:167], a[72:75], v[48:51], a[164:167]
    v_accvgpr_write_b32 a60, v220
    v_accvgpr_write_b32 a61, v222
    v_mfma_f32_16x16x32_bf16 a[164:167], a[76:79], v[52:55], a[164:167]
    s_add_u32 m0, s69, 147456
    v_cvt_pk_bf16_f32 v228, v228, v229
    v_cvt_pk_bf16_f32 v230, v230, v231
    v_mfma_f32_16x16x32_bf16 a[168:171], a[80:83], v[48:51], a[168:171]
    s_add_u32 s60, s60, 524288
    buffer_load_dwordx4 v10, s[20:23], s63 offen lds
    v_mfma_f32_16x16x32_bf16 a[168:171], a[84:87], v[52:55], a[168:171]
    v_accvgpr_write_b32 a14, v228
    v_accvgpr_write_b32 a15, v230
    v_mfma_f32_16x16x32_bf16 a[172:175], a[88:91], v[48:51], a[172:175]
    v_cvt_pk_bf16_f32 v232, v232, v233
    v_cvt_pk_bf16_f32 v234, v234, v235
    v_mfma_f32_16x16x32_bf16 a[172:175], a[92:95], v[52:55], a[172:175]
    v_accvgpr_write_b32 a22, v232
    v_accvgpr_write_b32 a23, v234
    v_mfma_f32_16x16x32_bf16 a[176:179], a[96:99], v[48:51], a[176:179]
    ds_read_b128 v[88:91], v24 offset:57344
    v_cvt_pk_bf16_f32 v236, v236, v237
    v_mfma_f32_16x16x32_bf16 a[176:179], a[100:103], v[52:55], a[176:179]
    v_cvt_pk_bf16_f32 v238, v238, v239
    v_accvgpr_write_b32 a30, v236
    v_mfma_f32_16x16x32_bf16 a[180:183], a[104:107], v[48:51], a[180:183]
    v_accvgpr_write_b32 a31, v238
    v_cvt_pk_bf16_f32 v240, v240, v241
    v_mfma_f32_16x16x32_bf16 a[180:183], a[108:111], v[52:55], a[180:183]
    buffer_load_dwordx4 v11, s[20:23], s63 offen offset:1024 lds
    v_mfma_f32_16x16x32_bf16 a[184:187], a[112:115], v[48:51], a[184:187]
    v_cvt_pk_bf16_f32 v242, v242, v243
    v_accvgpr_write_b32 a38, v240
    v_mfma_f32_16x16x32_bf16 a[184:187], a[116:119], v[52:55], a[184:187]
    v_accvgpr_write_b32 a39, v242
    v_cvt_pk_bf16_f32 v244, v244, v245
    v_mfma_f32_16x16x32_bf16 a[188:191], a[120:123], v[48:51], a[188:191]
    v_cvt_pk_bf16_f32 v246, v246, v247
    v_accvgpr_write_b32 a46, v244
    v_mfma_f32_16x16x32_bf16 a[188:191], a[124:127], v[52:55], a[188:191]
    s_waitcnt lgkmcnt(0)
    v_accvgpr_write_b32 a47, v246
    v_cvt_pk_bf16_f32 v248, v248, v249
    v_mfma_f32_16x16x32_bf16 a[192:195], a[64:67], v[56:59], a[192:195]
    v_cvt_pk_bf16_f32 v250, v250, v251
    v_accvgpr_write_b32 a54, v248
    v_mfma_f32_16x16x32_bf16 a[192:195], a[68:71], v[60:63], a[192:195]
    v_accvgpr_write_b32 a55, v250
    v_cvt_pk_bf16_f32 v252, v252, v253
    v_mfma_f32_16x16x32_bf16 a[196:199], a[72:75], v[56:59], a[196:199]
    v_cvt_pk_bf16_f32 v254, v254, v255
    v_accvgpr_write_b32 a62, v252
    v_mfma_f32_16x16x32_bf16 a[196:199], a[76:79], v[60:63], a[196:199]
    buffer_load_dwordx4 v12, s[20:23], s63 offen offset:2048 lds
    v_mfma_f32_16x16x32_bf16 a[200:203], a[80:83], v[56:59], a[200:203]
    ds_read_b128 v[92:95], v25 offset:57344
    v_accvgpr_read_b32 v32, a128
    v_mfma_f32_16x16x32_bf16 a[200:203], a[84:87], v[60:63], a[200:203]
    v_accvgpr_read_b32 v31, a129
    v_cvt_pk_bf16_f32 v32, v32, v31
    v_mfma_f32_16x16x32_bf16 a[204:207], a[88:91], v[56:59], a[204:207]
    v_accvgpr_read_b32 v33, a130
    v_accvgpr_read_b32 v31, a131
    v_mfma_f32_16x16x32_bf16 a[204:207], a[92:95], v[60:63], a[204:207]
    v_cvt_pk_bf16_f32 v33, v33, v31
    v_accvgpr_read_b32 v34, a132
    v_mfma_f32_16x16x32_bf16 a[208:211], a[96:99], v[56:59], a[208:211]
    v_accvgpr_read_b32 v31, a133
    v_cvt_pk_bf16_f32 v34, v34, v31
    v_mfma_f32_16x16x32_bf16 a[208:211], a[100:103], v[60:63], a[208:211]
    v_accvgpr_read_b32 v35, a134
    v_accvgpr_read_b32 v31, a135
    v_mfma_f32_16x16x32_bf16 a[212:215], a[104:107], v[56:59], a[212:215]
    buffer_load_dwordx4 v13, s[20:23], s63 offen offset:3072 lds
    v_mfma_f32_16x16x32_bf16 a[212:215], a[108:111], v[60:63], a[212:215]
    v_cvt_pk_bf16_f32 v35, v35, v31
    v_accvgpr_write_b32 a63, v254
    v_mfma_f32_16x16x32_bf16 a[216:219], a[112:115], v[56:59], a[216:219]
    v_mfma_f32_16x16x32_bf16 a[216:219], a[116:119], v[60:63], a[216:219]
    s_add_u32 s72, s71, 0
    v_mfma_f32_16x16x32_bf16 a[220:223], a[120:123], v[56:59], a[220:223]
    buffer_store_dwordx4 v[32:35], v1, s[36:39], s72 offen sc1
    v_mfma_f32_16x16x32_bf16 a[220:223], a[124:127], v[60:63], a[220:223]
    v_mfma_f32_16x16x32_bf16 a[224:227], a[64:67], v[40:43], a[224:227]
    v_mfma_f32_16x16x32_bf16 a[224:227], a[68:71], v[44:47], a[224:227]
    s_add_u32 s63, s63, 128
    v_mfma_f32_16x16x32_bf16 a[228:231], a[72:75], v[40:43], a[228:231]
    v_mfma_f32_16x16x32_bf16 a[228:231], a[76:79], v[44:47], a[228:231]
    v_mfma_f32_16x16x32_bf16 a[232:235], a[80:83], v[40:43], a[232:235]
    v_accvgpr_read_b32 v36, a136
    v_accvgpr_read_b32 v31, a137
    v_mfma_f32_16x16x32_bf16 a[232:235], a[84:87], v[44:47], a[232:235]
    s_waitcnt vmcnt(16)
    s_barrier
    ds_read_b64_tr_b16 v[48:49], v14 offset:0
    v_mfma_f32_16x16x32_bf16 a[236:239], a[88:91], v[40:43], a[236:239]
    s_add_u32 m0, s67, 0
    ds_read_b64_tr_b16 v[50:51], v14 offset:1024
    ds_read_b64_tr_b16 v[52:53], v14 offset:8192
    v_mfma_f32_16x16x32_bf16 a[236:239], a[92:95], v[44:47], a[236:239]
    buffer_load_dwordx4 v1, s[28:31], s65 offen sc1 lds
    v_mfma_f32_16x16x32_bf16 a[240:243], a[96:99], v[40:43], a[240:243]
    ds_read_b64_tr_b16 v[54:55], v14 offset:9216
    ds_read_b64_tr_b16 v[56:57], v15 offset:0
    v_mfma_f32_16x16x32_bf16 a[240:243], a[100:103], v[44:47], a[240:243]
    ds_read_b64_tr_b16 v[58:59], v15 offset:1024
    ds_read_b64_tr_b16 v[60:61], v15 offset:8192
    v_mfma_f32_16x16x32_bf16 a[244:247], a[104:107], v[40:43], a[244:247]
    ds_read_b64_tr_b16 v[62:63], v15 offset:9216
    v_add_u32 v14, 0x10000, v14
    v_mfma_f32_16x16x32_bf16 a[244:247], a[108:111], v[44:47], a[244:247]
    v_add_u32 v15, 0x10000, v15
    v_cvt_pk_bf16_f32 v36, v36, v31
    v_mfma_f32_16x16x32_bf16 a[248:251], a[112:115], v[40:43], a[248:251]
    v_accvgpr_read_b32 v37, a138
    v_accvgpr_read_b32 v31, a139
    v_mfma_f32_16x16x32_bf16 a[248:251], a[116:119], v[44:47], a[248:251]
    s_add_u32 s72, s71, 1024
    v_cvt_pk_bf16_f32 v37, v37, v31
    v_accvgpr_read_b32 v38, a140
    v_mfma_f32_16x16x32_bf16 a[252:255], a[120:123], v[40:43], a[252:255]
    buffer_load_dwordx4 v1, s[28:31], s65 offen offset:1024 sc1 lds
    v_mfma_f32_16x16x32_bf16 a[252:255], a[124:127], v[44:47], a[252:255]
    s_waitcnt lgkmcnt(0)
    ds_read_b64_tr_b16 v[40:41], v16 offset:0
    ds_read_b64_tr_b16 v[42:43], v16 offset:1024
    v_mfma_f32_16x16x32_bf16 v[128:131], v[48:51], v[64:67], 0
    ds_read_b64_tr_b16 v[44:45], v16 offset:8192
    ds_read_b64_tr_b16 v[46:47], v16 offset:9216
    v_mfma_f32_16x16x32_bf16 v[128:131], v[52:55], v[68:71], v[128:131]
    v_add_u32 v24, 0x10000, v24
    v_add_u32 v16, 0x10000, v16
    v_mfma_f32_16x16x32_bf16 v[132:135], v[48:51], v[72:75], 0
    ds_read_b128 v[96:99], v24 offset:16384
    v_accvgpr_read_b32 v31, a141
    v_mfma_f32_16x16x32_bf16 v[132:135], v[52:55], v[76:79], v[132:135]
    v_cvt_pk_bf16_f32 v38, v38, v31
    v_accvgpr_read_b32 v39, a142
    v_mfma_f32_16x16x32_bf16 v[136:139], v[48:51], v[80:83], 0
    v_accvgpr_read_b32 v31, a143
    v_cvt_pk_bf16_f32 v39, v39, v31
    v_mfma_f32_16x16x32_bf16 v[136:139], v[52:55], v[84:87], v[136:139]
    buffer_store_dwordx4 v[36:39], v1, s[36:39], s72 offen sc1
    v_mfma_f32_16x16x32_bf16 v[140:143], v[48:51], v[88:91], 0
    s_add_u32 m0, s68, 8192
    ds_read_b64_tr_b16 v[48:49], v17 offset:0
    ds_read_b64_tr_b16 v[50:51], v17 offset:1024
    v_mfma_f32_16x16x32_bf16 v[140:143], v[52:55], v[92:95], v[140:143]
    buffer_load_dwordx4 v6, s[20:23], s66 offen lds
    v_mfma_f32_16x16x32_bf16 v[144:147], v[56:59], v[64:67], 0
    ds_read_b64_tr_b16 v[52:53], v17 offset:8192
    ds_read_b64_tr_b16 v[54:55], v17 offset:9216
    v_mfma_f32_16x16x32_bf16 v[144:147], v[60:63], v[68:71], v[144:147]
    s_add_u32 s72, s70, 0
    v_add_u32 v17, 0x10000, v17
    v_mfma_f32_16x16x32_bf16 v[148:151], v[56:59], v[72:75], 0
    buffer_store_dwordx4 a[0:3], v1, s[36:39], s72 offen offset:0 sc1
    v_mfma_f32_16x16x32_bf16 v[148:151], v[60:63], v[76:79], v[148:151]
    v_mfma_f32_16x16x32_bf16 v[152:155], v[56:59], v[80:83], 0
    v_add_u32 v25, 0x10000, v25
    v_accvgpr_write_b32 a0, 0
    v_mfma_f32_16x16x32_bf16 v[152:155], v[60:63], v[84:87], v[152:155]
    ds_read_b128 v[100:103], v25 offset:16384
    v_accvgpr_write_b32 a1, 0
    v_mfma_f32_16x16x32_bf16 v[156:159], v[56:59], v[88:91], 0
    s_add_u32 m0, s69, 16384
    ds_read_b64_tr_b16 v[56:57], v18 offset:0
    ds_read_b64_tr_b16 v[58:59], v18 offset:1024
    v_mfma_f32_16x16x32_bf16 v[156:159], v[60:63], v[92:95], v[156:159]
    s_add_u32 s65, s65, 8192
    buffer_load_dwordx4 v10, s[20:23], s64 offen lds
    s_waitcnt lgkmcnt(3)
    v_mfma_f32_16x16x32_bf16 v[160:163], v[40:43], v[64:67], 0
    s_add_u32 s66, s66, 128
    ds_read_b64_tr_b16 v[60:61], v18 offset:8192
    ds_read_b64_tr_b16 v[62:63], v18 offset:9216
    v_mfma_f32_16x16x32_bf16 v[160:163], v[44:47], v[68:71], v[160:163]
    v_add_u32 v18, 0x10000, v18
    v_accvgpr_write_b32 a2, 0
    v_mfma_f32_16x16x32_bf16 v[164:167], v[40:43], v[72:75], 0
    v_accvgpr_write_b32 a3, 0
    v_mfma_f32_16x16x32_bf16 v[164:167], v[44:47], v[76:79], v[164:167]
    v_mfma_f32_16x16x32_bf16 v[168:171], v[40:43], v[80:83], 0
    v_mfma_f32_16x16x32_bf16 v[168:171], v[44:47], v[84:87], v[168:171]
    v_mfma_f32_16x16x32_bf16 v[172:175], v[40:43], v[88:91], 0
    ds_read_b64_tr_b16 v[40:41], v19 offset:0
    ds_read_b64_tr_b16 v[42:43], v19 offset:1024
    v_mfma_f32_16x16x32_bf16 v[172:175], v[44:47], v[92:95], v[172:175]
    ds_read_b64_tr_b16 v[44:45], v19 offset:8192
    ds_read_b64_tr_b16 v[46:47], v19 offset:9216
    v_mfma_f32_16x16x32_bf16 v[176:179], v[48:51], v[64:67], 0
    buffer_load_dwordx4 v11, s[20:23], s64 offen offset:1024 lds
    v_mfma_f32_16x16x32_bf16 v[176:179], v[52:55], v[68:71], v[176:179]
    ds_read_b128 v[104:107], v24 offset:24576
    v_add_u32 v19, 0x10000, v19
    v_mfma_f32_16x16x32_bf16 v[180:183], v[48:51], v[72:75], 0
    v_mfma_f32_16x16x32_bf16 v[180:183], v[52:55], v[76:79], v[180:183]
    v_mfma_f32_16x16x32_bf16 v[184:187], v[48:51], v[80:83], 0
    v_mfma_f32_16x16x32_bf16 v[184:187], v[52:55], v[84:87], v[184:187]
    v_mfma_f32_16x16x32_bf16 v[188:191], v[48:51], v[88:91], 0
    ds_read_b64_tr_b16 v[48:49], v20 offset:0
    ds_read_b64_tr_b16 v[50:51], v20 offset:1024
    v_mfma_f32_16x16x32_bf16 v[188:191], v[52:55], v[92:95], v[188:191]
    s_waitcnt lgkmcnt(2)
    ds_read_b64_tr_b16 v[52:53], v20 offset:8192
    ds_read_b64_tr_b16 v[54:55], v20 offset:9216
    v_mfma_f32_16x16x32_bf16 v[192:195], v[56:59], v[64:67], 0
    buffer_load_dwordx4 v12, s[20:23], s64 offen offset:2048 lds
    v_mfma_f32_16x16x32_bf16 v[192:195], v[60:63], v[68:71], v[192:195]
    v_add_u32 v20, 0x10000, v20
    v_mfma_f32_16x16x32_bf16 v[196:199], v[56:59], v[72:75], 0
    buffer_store_dwordx4 a[4:7], v1, s[36:39], s72 offen offset:1024 sc1
    v_mfma_f32_16x16x32_bf16 v[196:199], v[60:63], v[76:79], v[196:199]
    ds_read_b128 v[108:111], v25 offset:24576
    v_accvgpr_write_b32 a4, 0
    v_mfma_f32_16x16x32_bf16 v[200:203], v[56:59], v[80:83], 0
    v_accvgpr_write_b32 a5, 0
    v_accvgpr_write_b32 a6, 0
    v_mfma_f32_16x16x32_bf16 v[200:203], v[60:63], v[84:87], v[200:203]
    v_accvgpr_write_b32 a7, 0
    v_mfma_f32_16x16x32_bf16 v[204:207], v[56:59], v[88:91], 0
    ds_read_b64_tr_b16 v[56:57], v21 offset:0
    ds_read_b64_tr_b16 v[58:59], v21 offset:1024
    v_mfma_f32_16x16x32_bf16 v[204:207], v[60:63], v[92:95], v[204:207]
    ds_read_b64_tr_b16 v[60:61], v21 offset:8192
    ds_read_b64_tr_b16 v[62:63], v21 offset:9216
    v_mfma_f32_16x16x32_bf16 v[208:211], v[40:43], v[64:67], 0
    v_add_u32 v21, 0x10000, v21
    v_mfma_f32_16x16x32_bf16 v[208:211], v[44:47], v[68:71], v[208:211]
    buffer_load_dwordx4 v13, s[20:23], s64 offen offset:3072 lds
    v_mfma_f32_16x16x32_bf16 v[212:215], v[40:43], v[72:75], 0
    v_mfma_f32_16x16x32_bf16 v[212:215], v[44:47], v[76:79], v[212:215]
    v_mfma_f32_16x16x32_bf16 v[216:219], v[40:43], v[80:83], 0
    v_mfma_f32_16x16x32_bf16 v[216:219], v[44:47], v[84:87], v[216:219]
    v_mfma_f32_16x16x32_bf16 v[220:223], v[40:43], v[88:91], 0
    v_mfma_f32_16x16x32_bf16 v[220:223], v[44:47], v[92:95], v[220:223]
    s_waitcnt lgkmcnt(0)
    v_mfma_f32_16x16x32_bf16 v[224:227], v[48:51], v[64:67], 0
    v_mfma_f32_16x16x32_bf16 v[224:227], v[52:55], v[68:71], v[224:227]
    s_add_u32 s64, s64, 128
    v_mfma_f32_16x16x32_bf16 v[228:231], v[48:51], v[72:75], 0
    s_add_u32 s72, s70, 4096
    buffer_store_dwordx4 a[8:11], v1, s[36:39], s72 offen offset:0 sc1
    v_mfma_f32_16x16x32_bf16 v[228:231], v[52:55], v[76:79], v[228:231]
    v_mfma_f32_16x16x32_bf16 v[232:235], v[48:51], v[80:83], 0
    v_accvgpr_write_b32 a8, 0
    v_accvgpr_write_b32 a9, 0
    v_mfma_f32_16x16x32_bf16 v[232:235], v[52:55], v[84:87], v[232:235]
    s_waitcnt vmcnt(20)
    s_barrier
    ds_read_b64_tr_b16 v[40:41], v26 offset:32768
    v_mfma_f32_16x16x32_bf16 v[236:239], v[48:51], v[88:91], 0
    s_add_u32 m0, s69, 32768
    ds_read_b64_tr_b16 v[42:43], v26 offset:33280
    ds_read_b64_tr_b16 v[44:45], v26 offset:36864
    v_mfma_f32_16x16x32_bf16 v[236:239], v[52:55], v[92:95], v[236:239]
    buffer_load_dwordx4 v2, s[24:27], s60 offen lds
    v_mfma_f32_16x16x32_bf16 v[240:243], v[56:59], v[64:67], 0
    ds_read_b64_tr_b16 v[46:47], v26 offset:37376
    ds_read_b128 a[136:139], v22 offset:32768
    v_mfma_f32_16x16x32_bf16 v[240:243], v[60:63], v[68:71], v[240:243]
    ds_read_b128 a[140:143], v23 offset:32768
    ds_read_b64_tr_b16 v[48:49], v27 offset:32768
    v_mfma_f32_16x16x32_bf16 v[244:247], v[56:59], v[72:75], 0
    buffer_load_dwordx4 v3, s[24:27], s60 offen offset:1024 lds
    v_mfma_f32_16x16x32_bf16 v[244:247], v[60:63], v[76:79], v[244:247]
    ds_read_b64_tr_b16 v[50:51], v27 offset:33280
    ds_read_b64_tr_b16 v[52:53], v27 offset:36864
    v_mfma_f32_16x16x32_bf16 v[248:251], v[56:59], v[80:83], 0
    ds_read_b64_tr_b16 v[54:55], v27 offset:37376
    v_add_u32 v26, 0xffff0000, v26
    v_mfma_f32_16x16x32_bf16 v[248:251], v[60:63], v[84:87], v[248:251]
    v_add_u32 v22, 0xffff0000, v22
    v_add_u32 v23, 0xffff0000, v23
    v_mfma_f32_16x16x32_bf16 v[252:255], v[56:59], v[88:91], 0
    buffer_load_dwordx4 v4, s[24:27], s60 offen offset:2048 lds
    v_mfma_f32_16x16x32_bf16 v[252:255], v[60:63], v[92:95], v[252:255]
    s_waitcnt lgkmcnt(3)
    ds_read_b64_tr_b16 v[56:57], v28 offset:32768
    ds_read_b64_tr_b16 v[58:59], v28 offset:33280
    v_mfma_f32_16x16x32_bf16 a[64:67], v[40:43], v[64:67], 0
    ds_read_b64_tr_b16 v[60:61], v28 offset:36864
    ds_read_b64_tr_b16 v[62:63], v28 offset:37376
    v_mfma_f32_16x16x32_bf16 a[64:67], v[44:47], v[68:71], a[64:67]
    v_add_u32 v27, 0xffff0000, v27
    v_add_u32 v28, 0xffff0000, v28
    v_mfma_f32_16x16x32_bf16 a[68:71], v[40:43], v[72:75], 0
    buffer_load_dwordx4 v5, s[24:27], s60 offen offset:3072 lds
    v_mfma_f32_16x16x32_bf16 a[68:71], v[44:47], v[76:79], a[68:71]
    ds_read_b128 v[112:115], v24 offset:49152
    v_accvgpr_write_b32 a10, 0
    v_mfma_f32_16x16x32_bf16 a[72:75], v[40:43], v[80:83], 0
    v_accvgpr_write_b32 a11, 0
    v_mfma_f32_16x16x32_bf16 a[72:75], v[44:47], v[84:87], a[72:75]
    s_add_u32 m0, s69, 49152
    v_mfma_f32_16x16x32_bf16 a[76:79], v[40:43], v[88:91], 0
    s_add_u32 s60, s60, 524288
    buffer_load_dwordx4 v10, s[20:23], s63 offen lds
    v_mfma_f32_16x16x32_bf16 a[76:79], v[44:47], v[92:95], a[76:79]
    ds_read_b128 v[116:119], v25 offset:49152
    v_mfma_f32_16x16x32_bf16 a[128:131], v[40:43], a[136:139], 0
    ds_read_b64_tr_b16 v[40:41], v29 offset:32768
    ds_read_b64_tr_b16 v[42:43], v29 offset:33280
    v_mfma_f32_16x16x32_bf16 a[128:131], v[44:47], a[140:143], a[128:131]
    s_waitcnt lgkmcnt(3)
    ds_read_b64_tr_b16 v[44:45], v29 offset:36864
    ds_read_b64_tr_b16 v[46:47], v29 offset:37376
    v_mfma_f32_16x16x32_bf16 a[80:83], v[48:51], v[64:67], 0
    buffer_load_dwordx4 v11, s[20:23], s63 offen offset:1024 lds
    v_mfma_f32_16x16x32_bf16 a[80:83], v[52:55], v[68:71], a[80:83]
    ds_read_b128 v[120:123], v24 offset:57344
    v_add_u32 v29, 0xffff0000, v29
    v_mfma_f32_16x16x32_bf16 a[84:87], v[48:51], v[72:75], 0
    buffer_store_dwordx4 a[12:15], v1, s[36:39], s72 offen offset:1024 sc1
    v_mfma_f32_16x16x32_bf16 a[84:87], v[52:55], v[76:79], a[84:87]
    v_mfma_f32_16x16x32_bf16 a[88:91], v[48:51], v[80:83], 0
    buffer_load_dwordx4 v12, s[20:23], s63 offen offset:2048 lds
    v_mfma_f32_16x16x32_bf16 a[88:91], v[52:55], v[84:87], a[88:91]
    ds_read_b128 v[124:127], v25 offset:57344
    v_accvgpr_write_b32 a12, 0
    v_mfma_f32_16x16x32_bf16 a[92:95], v[48:51], v[88:91], 0
    v_accvgpr_write_b32 a13, 0
    v_accvgpr_write_b32 a14, 0
    v_mfma_f32_16x16x32_bf16 a[92:95], v[52:55], v[92:95], a[92:95]
    v_accvgpr_write_b32 a15, 0
    v_mfma_f32_16x16x32_bf16 a[132:135], v[48:51], a[136:139], 0
    buffer_load_dwordx4 v13, s[20:23], s63 offen offset:3072 lds
    v_mfma_f32_16x16x32_bf16 a[132:135], v[52:55], a[140:143], a[132:135]
    v_mfma_f32_16x16x32_bf16 a[96:99], v[56:59], v[64:67], 0
    v_mfma_f32_16x16x32_bf16 a[96:99], v[60:63], v[68:71], a[96:99]
    s_add_u32 s63, s63, 128
    v_mfma_f32_16x16x32_bf16 a[100:103], v[56:59], v[72:75], 0
    v_mfma_f32_16x16x32_bf16 a[100:103], v[60:63], v[76:79], a[100:103]
    v_mfma_f32_16x16x32_bf16 a[104:107], v[56:59], v[80:83], 0
    v_mfma_f32_16x16x32_bf16 a[104:107], v[60:63], v[84:87], a[104:107]
    s_waitcnt vmcnt(21)
    s_barrier
    ds_read_b64_tr_b16 v[48:49], v14 offset:0
    v_mfma_f32_16x16x32_bf16 a[108:111], v[56:59], v[88:91], 0
    s_add_u32 m0, s67, 65536
    ds_read_b64_tr_b16 v[50:51], v14 offset:1024
    ds_read_b64_tr_b16 v[52:53], v14 offset:8192
    v_mfma_f32_16x16x32_bf16 a[108:111], v[60:63], v[92:95], a[108:111]
    s_add_u32 s72, s70, 8192
    buffer_load_dwordx4 v1, s[28:31], s65 offen sc1 lds
    s_waitcnt lgkmcnt(3)
    v_mfma_f32_16x16x32_bf16 a[112:115], v[40:43], v[64:67], 0
    ds_read_b64_tr_b16 v[54:55], v14 offset:9216
    ds_read_b64_tr_b16 v[56:57], v15 offset:0
    v_mfma_f32_16x16x32_bf16 a[112:115], v[44:47], v[68:71], a[112:115]
    ds_read_b64_tr_b16 v[58:59], v15 offset:1024
    ds_read_b64_tr_b16 v[60:61], v15 offset:8192
    v_mfma_f32_16x16x32_bf16 a[116:119], v[40:43], v[72:75], 0
    ds_read_b64_tr_b16 v[62:63], v15 offset:9216
    v_add_u32 v14, 0xfffe0000, v14
    v_mfma_f32_16x16x32_bf16 a[116:119], v[44:47], v[76:79], a[116:119]
    v_add_u32 v15, 0xfffe0000, v15
    v_mfma_f32_16x16x32_bf16 a[120:123], v[40:43], v[80:83], 0
    buffer_store_dwordx4 a[16:19], v1, s[36:39], s72 offen offset:0 sc1
    v_mfma_f32_16x16x32_bf16 a[120:123], v[44:47], v[84:87], a[120:123]
    v_mfma_f32_16x16x32_bf16 a[124:127], v[40:43], v[88:91], 0
    buffer_load_dwordx4 v1, s[28:31], s65 offen offset:1024 sc1 lds
    v_mfma_f32_16x16x32_bf16 a[124:127], v[44:47], v[92:95], a[124:127]
    s_waitcnt lgkmcnt(0)
    ds_read_b64_tr_b16 v[40:41], v16 offset:0
    ds_read_b64_tr_b16 v[42:43], v16 offset:1024
    v_mfma_f32_16x16x32_bf16 v[128:131], v[48:51], v[96:99], v[128:131]
    ds_read_b64_tr_b16 v[44:45], v16 offset:8192
    ds_read_b64_tr_b16 v[46:47], v16 offset:9216
    v_mfma_f32_16x16x32_bf16 v[128:131], v[52:55], v[100:103], v[128:131]
    v_add_u32 v24, 0x10000, v24
    v_add_u32 v16, 0xfffe0000, v16
    v_mfma_f32_16x16x32_bf16 v[132:135], v[48:51], v[104:107], v[132:135]
    ds_read_b128 v[64:67], v24 offset:16384
    v_accvgpr_write_b32 a16, 0
    v_mfma_f32_16x16x32_bf16 v[132:135], v[52:55], v[108:111], v[132:135]
    v_accvgpr_write_b32 a17, 0
    v_accvgpr_write_b32 a18, 0
    v_mfma_f32_16x16x32_bf16 v[136:139], v[48:51], v[112:115], v[136:139]
    v_accvgpr_write_b32 a19, 0
    v_mfma_f32_16x16x32_bf16 v[136:139], v[52:55], v[116:119], v[136:139]
    v_mfma_f32_16x16x32_bf16 v[140:143], v[48:51], v[120:123], v[140:143]
    s_add_u32 m0, s68, 73728
    ds_read_b64_tr_b16 v[48:49], v17 offset:0
    ds_read_b64_tr_b16 v[50:51], v17 offset:1024
    v_mfma_f32_16x16x32_bf16 v[140:143], v[52:55], v[124:127], v[140:143]
    buffer_load_dwordx4 v6, s[20:23], s66 offen lds
    v_mfma_f32_16x16x32_bf16 v[144:147], v[56:59], v[96:99], v[144:147]
    ds_read_b64_tr_b16 v[52:53], v17 offset:8192
    ds_read_b64_tr_b16 v[54:55], v17 offset:9216
    v_mfma_f32_16x16x32_bf16 v[144:147], v[60:63], v[100:103], v[144:147]
    v_add_u32 v17, 0xfffe0000, v17
    v_mfma_f32_16x16x32_bf16 v[148:151], v[56:59], v[104:107], v[148:151]
    buffer_store_dwordx4 a[20:23], v1, s[36:39], s72 offen offset:1024 sc1
    v_mfma_f32_16x16x32_bf16 v[148:151], v[60:63], v[108:111], v[148:151]
    v_mfma_f32_16x16x32_bf16 v[152:155], v[56:59], v[112:115], v[152:155]
    v_add_u32 v25, 0x10000, v25
    v_accvgpr_write_b32 a20, 0
    v_mfma_f32_16x16x32_bf16 v[152:155], v[60:63], v[116:119], v[152:155]
    ds_read_b128 v[68:71], v25 offset:16384
    v_accvgpr_write_b32 a21, 0
    v_mfma_f32_16x16x32_bf16 v[156:159], v[56:59], v[120:123], v[156:159]
    s_add_u32 m0, s69, 81920
    ds_read_b64_tr_b16 v[56:57], v18 offset:0
    ds_read_b64_tr_b16 v[58:59], v18 offset:1024
    v_mfma_f32_16x16x32_bf16 v[156:159], v[60:63], v[124:127], v[156:159]
    s_add_u32 s65, s65, 8192
    buffer_load_dwordx4 v10, s[20:23], s64 offen lds
    s_waitcnt lgkmcnt(3)
    v_mfma_f32_16x16x32_bf16 v[160:163], v[40:43], v[96:99], v[160:163]
    s_add_u32 s66, s66, 128
    ds_read_b64_tr_b16 v[60:61], v18 offset:8192
    ds_read_b64_tr_b16 v[62:63], v18 offset:9216
    v_mfma_f32_16x16x32_bf16 v[160:163], v[44:47], v[100:103], v[160:163]
    v_add_u32 v18, 0xfffe0000, v18
    v_accvgpr_write_b32 a22, 0
    v_mfma_f32_16x16x32_bf16 v[164:167], v[40:43], v[104:107], v[164:167]
    v_accvgpr_write_b32 a23, 0
    v_mfma_f32_16x16x32_bf16 v[164:167], v[44:47], v[108:111], v[164:167]
    v_mfma_f32_16x16x32_bf16 v[168:171], v[40:43], v[112:115], v[168:171]
    v_mfma_f32_16x16x32_bf16 v[168:171], v[44:47], v[116:119], v[168:171]
    v_mfma_f32_16x16x32_bf16 v[172:175], v[40:43], v[120:123], v[172:175]
    ds_read_b64_tr_b16 v[40:41], v19 offset:0
    ds_read_b64_tr_b16 v[42:43], v19 offset:1024
    v_mfma_f32_16x16x32_bf16 v[172:175], v[44:47], v[124:127], v[172:175]
    ds_read_b64_tr_b16 v[44:45], v19 offset:8192
    ds_read_b64_tr_b16 v[46:47], v19 offset:9216
    v_mfma_f32_16x16x32_bf16 v[176:179], v[48:51], v[96:99], v[176:179]
    buffer_load_dwordx4 v11, s[20:23], s64 offen offset:1024 lds
    v_mfma_f32_16x16x32_bf16 v[176:179], v[52:55], v[100:103], v[176:179]
    ds_read_b128 v[72:75], v24 offset:24576
    v_add_u32 v19, 0xfffe0000, v19
    v_mfma_f32_16x16x32_bf16 v[180:183], v[48:51], v[104:107], v[180:183]
    v_mfma_f32_16x16x32_bf16 v[180:183], v[52:55], v[108:111], v[180:183]
    v_mfma_f32_16x16x32_bf16 v[184:187], v[48:51], v[112:115], v[184:187]
    v_mfma_f32_16x16x32_bf16 v[184:187], v[52:55], v[116:119], v[184:187]
    s_add_u32 s72, s70, 12288
    v_mfma_f32_16x16x32_bf16 v[188:191], v[48:51], v[120:123], v[188:191]
    ds_read_b64_tr_b16 v[48:49], v20 offset:0
    ds_read_b64_tr_b16 v[50:51], v20 offset:1024
    v_mfma_f32_16x16x32_bf16 v[188:191], v[52:55], v[124:127], v[188:191]
    s_waitcnt lgkmcnt(2)
    ds_read_b64_tr_b16 v[52:53], v20 offset:8192
    ds_read_b64_tr_b16 v[54:55], v20 offset:9216
    v_mfma_f32_16x16x32_bf16 v[192:195], v[56:59], v[96:99], v[192:195]
    buffer_load_dwordx4 v12, s[20:23], s64 offen offset:2048 lds
    v_mfma_f32_16x16x32_bf16 v[192:195], v[60:63], v[100:103], v[192:195]
    v_add_u32 v20, 0xfffe0000, v20
    v_mfma_f32_16x16x32_bf16 v[196:199], v[56:59], v[104:107], v[196:199]
    buffer_store_dwordx4 a[24:27], v1, s[36:39], s72 offen offset:0 sc1
    v_mfma_f32_16x16x32_bf16 v[196:199], v[60:63], v[108:111], v[196:199]
    ds_read_b128 v[76:79], v25 offset:24576
    v_accvgpr_write_b32 a24, 0
    v_mfma_f32_16x16x32_bf16 v[200:203], v[56:59], v[112:115], v[200:203]
    v_accvgpr_write_b32 a25, 0
    v_accvgpr_write_b32 a26, 0
    v_mfma_f32_16x16x32_bf16 v[200:203], v[60:63], v[116:119], v[200:203]
    v_accvgpr_write_b32 a27, 0
    v_mfma_f32_16x16x32_bf16 v[204:207], v[56:59], v[120:123], v[204:207]
    ds_read_b64_tr_b16 v[56:57], v21 offset:0
    ds_read_b64_tr_b16 v[58:59], v21 offset:1024
    v_mfma_f32_16x16x32_bf16 v[204:207], v[60:63], v[124:127], v[204:207]
    ds_read_b64_tr_b16 v[60:61], v21 offset:8192
    ds_read_b64_tr_b16 v[62:63], v21 offset:9216
    v_mfma_f32_16x16x32_bf16 v[208:211], v[40:43], v[96:99], v[208:211]
    v_add_u32 v21, 0xfffe0000, v21
    v_mfma_f32_16x16x32_bf16 v[208:211], v[44:47], v[100:103], v[208:211]
    buffer_load_dwordx4 v13, s[20:23], s64 offen offset:3072 lds
    v_mfma_f32_16x16x32_bf16 v[212:215], v[40:43], v[104:107], v[212:215]
    v_mfma_f32_16x16x32_bf16 v[212:215], v[44:47], v[108:111], v[212:215]
    v_mfma_f32_16x16x32_bf16 v[216:219], v[40:43], v[112:115], v[216:219]
    v_mfma_f32_16x16x32_bf16 v[216:219], v[44:47], v[116:119], v[216:219]
    v_mfma_f32_16x16x32_bf16 v[220:223], v[40:43], v[120:123], v[220:223]
    v_mfma_f32_16x16x32_bf16 v[220:223], v[44:47], v[124:127], v[220:223]
    s_waitcnt lgkmcnt(0)
    v_mfma_f32_16x16x32_bf16 v[224:227], v[48:51], v[96:99], v[224:227]
    v_mfma_f32_16x16x32_bf16 v[224:227], v[52:55], v[100:103], v[224:227]
    s_add_u32 s64, s64, 128
    v_mfma_f32_16x16x32_bf16 v[228:231], v[48:51], v[104:107], v[228:231]
    buffer_store_dwordx4 a[28:31], v1, s[36:39], s72 offen offset:1024 sc1
    v_mfma_f32_16x16x32_bf16 v[228:231], v[52:55], v[108:111], v[228:231]
    v_mfma_f32_16x16x32_bf16 v[232:235], v[48:51], v[112:115], v[232:235]
    v_accvgpr_write_b32 a28, 0
    v_accvgpr_write_b32 a29, 0
    v_mfma_f32_16x16x32_bf16 v[232:235], v[52:55], v[116:119], v[232:235]
    s_waitcnt vmcnt(21)
    s_barrier
    ds_read_b64_tr_b16 v[40:41], v26 offset:0
    v_mfma_f32_16x16x32_bf16 v[236:239], v[48:51], v[120:123], v[236:239]
    s_add_u32 m0, s69, 98304
    ds_read_b64_tr_b16 v[42:43], v26 offset:512
    ds_read_b64_tr_b16 v[44:45], v26 offset:4096
    v_mfma_f32_16x16x32_bf16 v[236:239], v[52:55], v[124:127], v[236:239]
    buffer_load_dwordx4 v2, s[24:27], s60 offen lds
    v_mfma_f32_16x16x32_bf16 v[240:243], v[56:59], v[96:99], v[240:243]
    ds_read_b64_tr_b16 v[46:47], v26 offset:4608
    ds_read_b128 a[136:139], v22 offset:0
    v_mfma_f32_16x16x32_bf16 v[240:243], v[60:63], v[100:103], v[240:243]
    ds_read_b128 a[140:143], v23 offset:0
    ds_read_b64_tr_b16 v[48:49], v27 offset:0
    v_mfma_f32_16x16x32_bf16 v[244:247], v[56:59], v[104:107], v[244:247]
    buffer_load_dwordx4 v3, s[24:27], s60 offen offset:1024 lds
    v_mfma_f32_16x16x32_bf16 v[244:247], v[60:63], v[108:111], v[244:247]
    ds_read_b64_tr_b16 v[50:51], v27 offset:512
    ds_read_b64_tr_b16 v[52:53], v27 offset:4096
    v_mfma_f32_16x16x32_bf16 v[248:251], v[56:59], v[112:115], v[248:251]
    ds_read_b64_tr_b16 v[54:55], v27 offset:4608
    v_add_u32 v26, 0x10000, v26
    v_mfma_f32_16x16x32_bf16 v[248:251], v[60:63], v[116:119], v[248:251]
    v_add_u32 v22, 0x10000, v22
    v_add_u32 v23, 0x10000, v23
    v_mfma_f32_16x16x32_bf16 v[252:255], v[56:59], v[120:123], v[252:255]
    buffer_load_dwordx4 v4, s[24:27], s60 offen offset:2048 lds
    v_mfma_f32_16x16x32_bf16 v[252:255], v[60:63], v[124:127], v[252:255]
    s_waitcnt lgkmcnt(3)
    ds_read_b64_tr_b16 v[56:57], v28 offset:0
    ds_read_b64_tr_b16 v[58:59], v28 offset:512
    v_mfma_f32_16x16x32_bf16 a[64:67], v[40:43], v[96:99], a[64:67]
    ds_read_b64_tr_b16 v[60:61], v28 offset:4096
    ds_read_b64_tr_b16 v[62:63], v28 offset:4608
    v_mfma_f32_16x16x32_bf16 a[64:67], v[44:47], v[100:103], a[64:67]
    v_add_u32 v24, 0xfffe0000, v24
    v_add_u32 v27, 0x10000, v27
    v_mfma_f32_16x16x32_bf16 a[68:71], v[40:43], v[104:107], a[68:71]
    buffer_load_dwordx4 v5, s[24:27], s60 offen offset:3072 lds
    v_mfma_f32_16x16x32_bf16 a[68:71], v[44:47], v[108:111], a[68:71]
    ds_read_b128 v[80:83], v24 offset:16384
    v_add_u32 v28, 0x10000, v28
    v_mfma_f32_16x16x32_bf16 a[72:75], v[40:43], v[112:115], a[72:75]
    v_accvgpr_write_b32 a30, 0
    v_accvgpr_write_b32 a31, 0
    v_mfma_f32_16x16x32_bf16 a[72:75], v[44:47], v[116:119], a[72:75]
    s_add_u32 m0, s69, 114688
    v_add_u32 v25, 0xfffe0000, v25
    v_mfma_f32_16x16x32_bf16 a[76:79], v[40:43], v[120:123], a[76:79]
    s_add_u32 s60, s60, 524288
    buffer_load_dwordx4 v10, s[20:23], s63 offen lds
    v_mfma_f32_16x16x32_bf16 a[76:79], v[44:47], v[124:127], a[76:79]
    s_add_u32 s72, s70, 32768
    ds_read_b128 v[84:87], v25 offset:16384
    v_mfma_f32_16x16x32_bf16 a[128:131], v[40:43], a[136:139], a[128:131]
    ds_read_b64_tr_b16 v[40:41], v29 offset:0
    ds_read_b64_tr_b16 v[42:43], v29 offset:512
    v_mfma_f32_16x16x32_bf16 a[128:131], v[44:47], a[140:143], a[128:131]
    s_waitcnt lgkmcnt(3)
    ds_read_b64_tr_b16 v[44:45], v29 offset:4096
    ds_read_b64_tr_b16 v[46:47], v29 offset:4608
    v_mfma_f32_16x16x32_bf16 a[80:83], v[48:51], v[96:99], a[80:83]
    buffer_load_dwordx4 v11, s[20:23], s63 offen offset:1024 lds
    v_mfma_f32_16x16x32_bf16 a[80:83], v[52:55], v[100:103], a[80:83]
    ds_read_b128 v[88:91], v24 offset:24576
    v_add_u32 v29, 0x10000, v29
    v_mfma_f32_16x16x32_bf16 a[84:87], v[48:51], v[104:107], a[84:87]
    buffer_store_dwordx4 a[32:35], v1, s[36:39], s72 offen offset:0 sc1
    v_mfma_f32_16x16x32_bf16 a[84:87], v[52:55], v[108:111], a[84:87]
    v_mfma_f32_16x16x32_bf16 a[88:91], v[48:51], v[112:115], a[88:91]
    buffer_load_dwordx4 v12, s[20:23], s63 offen offset:2048 lds
    v_mfma_f32_16x16x32_bf16 a[88:91], v[52:55], v[116:119], a[88:91]
    ds_read_b128 v[92:95], v25 offset:24576
    v_accvgpr_write_b32 a32, 0
    v_mfma_f32_16x16x32_bf16 a[92:95], v[48:51], v[120:123], a[92:95]
    v_accvgpr_write_b32 a33, 0
    v_accvgpr_write_b32 a34, 0
    v_mfma_f32_16x16x32_bf16 a[92:95], v[52:55], v[124:127], a[92:95]
    v_accvgpr_write_b32 a35, 0
    v_mfma_f32_16x16x32_bf16 a[132:135], v[48:51], a[136:139], a[132:135]
    buffer_load_dwordx4 v13, s[20:23], s63 offen offset:3072 lds
    v_mfma_f32_16x16x32_bf16 a[132:135], v[52:55], a[140:143], a[132:135]
    v_mfma_f32_16x16x32_bf16 a[96:99], v[56:59], v[96:99], a[96:99]
    v_mfma_f32_16x16x32_bf16 a[96:99], v[60:63], v[100:103], a[96:99]
    s_add_u32 s63, s63, 128
    v_mfma_f32_16x16x32_bf16 a[100:103], v[56:59], v[104:107], a[100:103]
    v_mfma_f32_16x16x32_bf16 a[100:103], v[60:63], v[108:111], a[100:103]
    v_mfma_f32_16x16x32_bf16 a[104:107], v[56:59], v[112:115], a[104:107]
    v_mfma_f32_16x16x32_bf16 a[104:107], v[60:63], v[116:119], a[104:107]
    s_waitcnt vmcnt(20)
    s_barrier
    ds_read_b64_tr_b16 v[48:49], v14 offset:32768
    v_mfma_f32_16x16x32_bf16 a[108:111], v[56:59], v[120:123], a[108:111]
    s_add_u32 m0, s67, 131072
    ds_read_b64_tr_b16 v[50:51], v14 offset:33792
    ds_read_b64_tr_b16 v[52:53], v14 offset:40960
    v_mfma_f32_16x16x32_bf16 a[108:111], v[60:63], v[124:127], a[108:111]
    s_waitcnt lgkmcnt(3)
    buffer_load_dwordx4 v1, s[28:31], s65 offen sc1 lds
    v_mfma_f32_16x16x32_bf16 a[112:115], v[40:43], v[96:99], a[112:115]
    ds_read_b64_tr_b16 v[54:55], v14 offset:41984
    ds_read_b64_tr_b16 v[56:57], v15 offset:32768
    v_mfma_f32_16x16x32_bf16 a[112:115], v[44:47], v[100:103], a[112:115]
    ds_read_b64_tr_b16 v[58:59], v15 offset:33792
    ds_read_b64_tr_b16 v[60:61], v15 offset:40960
    v_mfma_f32_16x16x32_bf16 a[116:119], v[40:43], v[104:107], a[116:119]
    ds_read_b64_tr_b16 v[62:63], v15 offset:41984
    v_add_u32 v14, 0x10000, v14
    v_mfma_f32_16x16x32_bf16 a[116:119], v[44:47], v[108:111], a[116:119]
    v_add_u32 v15, 0x10000, v15
    v_mfma_f32_16x16x32_bf16 a[120:123], v[40:43], v[112:115], a[120:123]
    buffer_store_dwordx4 a[36:39], v1, s[36:39], s72 offen offset:1024 sc1
    v_mfma_f32_16x16x32_bf16 a[120:123], v[44:47], v[116:119], a[120:123]
    v_mfma_f32_16x16x32_bf16 a[124:127], v[40:43], v[120:123], a[124:127]
    buffer_load_dwordx4 v1, s[28:31], s65 offen offset:1024 sc1 lds
    v_mfma_f32_16x16x32_bf16 a[124:127], v[44:47], v[124:127], a[124:127]
    s_waitcnt lgkmcnt(0)
    ds_read_b64_tr_b16 v[40:41], v16 offset:32768
    ds_read_b64_tr_b16 v[42:43], v16 offset:33792
    v_mfma_f32_16x16x32_bf16 v[128:131], v[48:51], v[64:67], v[128:131]
    ds_read_b64_tr_b16 v[44:45], v16 offset:40960
    ds_read_b64_tr_b16 v[46:47], v16 offset:41984
    v_mfma_f32_16x16x32_bf16 v[128:131], v[52:55], v[68:71], v[128:131]
    v_add_u32 v16, 0x10000, v16
    v_accvgpr_write_b32 a36, 0
    v_mfma_f32_16x16x32_bf16 v[132:135], v[48:51], v[72:75], v[132:135]
    ds_read_b128 v[96:99], v24 offset:49152
    v_accvgpr_write_b32 a37, 0
    v_mfma_f32_16x16x32_bf16 v[132:135], v[52:55], v[76:79], v[132:135]
    v_accvgpr_write_b32 a38, 0
    v_accvgpr_write_b32 a39, 0
    v_mfma_f32_16x16x32_bf16 v[136:139], v[48:51], v[80:83], v[136:139]
    v_mfma_f32_16x16x32_bf16 v[136:139], v[52:55], v[84:87], v[136:139]
    v_mfma_f32_16x16x32_bf16 v[140:143], v[48:51], v[88:91], v[140:143]
    s_add_u32 m0, s68, 139264
    ds_read_b64_tr_b16 v[48:49], v17 offset:32768
    ds_read_b64_tr_b16 v[50:51], v17 offset:33792
    v_mfma_f32_16x16x32_bf16 v[140:143], v[52:55], v[92:95], v[140:143]
    buffer_load_dwordx4 v6, s[20:23], s66 offen lds
    v_mfma_f32_16x16x32_bf16 v[144:147], v[56:59], v[64:67], v[144:147]
    ds_read_b64_tr_b16 v[52:53], v17 offset:40960
    ds_read_b64_tr_b16 v[54:55], v17 offset:41984
    v_mfma_f32_16x16x32_bf16 v[144:147], v[60:63], v[68:71], v[144:147]
    s_add_u32 s72, s70, 36864
    v_add_u32 v17, 0x10000, v17
    v_mfma_f32_16x16x32_bf16 v[148:151], v[56:59], v[72:75], v[148:151]
    buffer_store_dwordx4 a[40:43], v1, s[36:39], s72 offen offset:0 sc1
    v_mfma_f32_16x16x32_bf16 v[148:151], v[60:63], v[76:79], v[148:151]
    v_mfma_f32_16x16x32_bf16 v[152:155], v[56:59], v[80:83], v[152:155]
    v_accvgpr_write_b32 a40, 0
    v_accvgpr_write_b32 a41, 0
    v_mfma_f32_16x16x32_bf16 v[152:155], v[60:63], v[84:87], v[152:155]
    ds_read_b128 v[100:103], v25 offset:49152
    v_accvgpr_write_b32 a42, 0
    v_mfma_f32_16x16x32_bf16 v[156:159], v[56:59], v[88:91], v[156:159]
    s_add_u32 m0, s69, 147456
    ds_read_b64_tr_b16 v[56:57], v18 offset:32768
    ds_read_b64_tr_b16 v[58:59], v18 offset:33792
    v_mfma_f32_16x16x32_bf16 v[156:159], v[60:63], v[92:95], v[156:159]
    s_add_u32 s65, s65, 8192
    buffer_load_dwordx4 v10, s[20:23], s64 offen lds
    s_waitcnt lgkmcnt(3)
    v_mfma_f32_16x16x32_bf16 v[160:163], v[40:43], v[64:67], v[160:163]
    s_add_u32 s66, s66, 128
    ds_read_b64_tr_b16 v[60:61], v18 offset:40960
    ds_read_b64_tr_b16 v[62:63], v18 offset:41984
    v_mfma_f32_16x16x32_bf16 v[160:163], v[44:47], v[68:71], v[160:163]
    v_add_u32 v18, 0x10000, v18
    v_accvgpr_write_b32 a43, 0
    v_mfma_f32_16x16x32_bf16 v[164:167], v[40:43], v[72:75], v[164:167]
    v_mfma_f32_16x16x32_bf16 v[164:167], v[44:47], v[76:79], v[164:167]
    v_mfma_f32_16x16x32_bf16 v[168:171], v[40:43], v[80:83], v[168:171]
    v_mfma_f32_16x16x32_bf16 v[168:171], v[44:47], v[84:87], v[168:171]
    v_mfma_f32_16x16x32_bf16 v[172:175], v[40:43], v[88:91], v[172:175]
    ds_read_b64_tr_b16 v[40:41], v19 offset:32768
    ds_read_b64_tr_b16 v[42:43], v19 offset:33792
    v_mfma_f32_16x16x32_bf16 v[172:175], v[44:47], v[92:95], v[172:175]
    ds_read_b64_tr_b16 v[44:45], v19 offset:40960
    ds_read_b64_tr_b16 v[46:47], v19 offset:41984
    v_mfma_f32_16x16x32_bf16 v[176:179], v[48:51], v[64:67], v[176:179]
    buffer_load_dwordx4 v11, s[20:23], s64 offen offset:1024 lds
    v_mfma_f32_16x16x32_bf16 v[176:179], v[52:55], v[68:71], v[176:179]
    ds_read_b128 v[104:107], v24 offset:57344
    v_add_u32 v19, 0x10000, v19
    v_mfma_f32_16x16x32_bf16 v[180:183], v[48:51], v[72:75], v[180:183]
    v_mfma_f32_16x16x32_bf16 v[180:183], v[52:55], v[76:79], v[180:183]
    v_mfma_f32_16x16x32_bf16 v[184:187], v[48:51], v[80:83], v[184:187]
    v_mfma_f32_16x16x32_bf16 v[184:187], v[52:55], v[84:87], v[184:187]
    v_mfma_f32_16x16x32_bf16 v[188:191], v[48:51], v[88:91], v[188:191]
    ds_read_b64_tr_b16 v[48:49], v20 offset:32768
    ds_read_b64_tr_b16 v[50:51], v20 offset:33792
    v_mfma_f32_16x16x32_bf16 v[188:191], v[52:55], v[92:95], v[188:191]
    s_waitcnt lgkmcnt(2)
    ds_read_b64_tr_b16 v[52:53], v20 offset:40960
    ds_read_b64_tr_b16 v[54:55], v20 offset:41984
    v_mfma_f32_16x16x32_bf16 v[192:195], v[56:59], v[64:67], v[192:195]
    buffer_load_dwordx4 v12, s[20:23], s64 offen offset:2048 lds
    v_mfma_f32_16x16x32_bf16 v[192:195], v[60:63], v[68:71], v[192:195]
    v_add_u32 v20, 0x10000, v20
    v_mfma_f32_16x16x32_bf16 v[196:199], v[56:59], v[72:75], v[196:199]
    buffer_store_dwordx4 a[44:47], v1, s[36:39], s72 offen offset:1024 sc1
    v_mfma_f32_16x16x32_bf16 v[196:199], v[60:63], v[76:79], v[196:199]
    ds_read_b128 v[108:111], v25 offset:57344
    v_accvgpr_write_b32 a44, 0
    v_mfma_f32_16x16x32_bf16 v[200:203], v[56:59], v[80:83], v[200:203]
    v_accvgpr_write_b32 a45, 0
    v_accvgpr_write_b32 a46, 0
    v_mfma_f32_16x16x32_bf16 v[200:203], v[60:63], v[84:87], v[200:203]
    v_accvgpr_write_b32 a47, 0
    v_mfma_f32_16x16x32_bf16 v[204:207], v[56:59], v[88:91], v[204:207]
    ds_read_b64_tr_b16 v[56:57], v21 offset:32768
    ds_read_b64_tr_b16 v[58:59], v21 offset:33792
    v_mfma_f32_16x16x32_bf16 v[204:207], v[60:63], v[92:95], v[204:207]
    ds_read_b64_tr_b16 v[60:61], v21 offset:40960
    ds_read_b64_tr_b16 v[62:63], v21 offset:41984
    v_mfma_f32_16x16x32_bf16 v[208:211], v[40:43], v[64:67], v[208:211]
    v_add_u32 v21, 0x10000, v21
    v_mfma_f32_16x16x32_bf16 v[208:211], v[44:47], v[68:71], v[208:211]
    buffer_load_dwordx4 v13, s[20:23], s64 offen offset:3072 lds
    v_mfma_f32_16x16x32_bf16 v[212:215], v[40:43], v[72:75], v[212:215]
    v_mfma_f32_16x16x32_bf16 v[212:215], v[44:47], v[76:79], v[212:215]
    v_mfma_f32_16x16x32_bf16 v[216:219], v[40:43], v[80:83], v[216:219]
    v_mfma_f32_16x16x32_bf16 v[216:219], v[44:47], v[84:87], v[216:219]
    v_mfma_f32_16x16x32_bf16 v[220:223], v[40:43], v[88:91], v[220:223]
    v_mfma_f32_16x16x32_bf16 v[220:223], v[44:47], v[92:95], v[220:223]
    s_waitcnt lgkmcnt(0)
    v_mfma_f32_16x16x32_bf16 v[224:227], v[48:51], v[64:67], v[224:227]
    v_mfma_f32_16x16x32_bf16 v[224:227], v[52:55], v[68:71], v[224:227]
    s_add_u32 s64, s64, 128
    v_mfma_f32_16x16x32_bf16 v[228:231], v[48:51], v[72:75], v[228:231]
    s_add_u32 s72, s70, 40960
    buffer_store_dwordx4 a[48:51], v1, s[36:39], s72 offen offset:0 sc1
    v_mfma_f32_16x16x32_bf16 v[228:231], v[52:55], v[76:79], v[228:231]
    v_mfma_f32_16x16x32_bf16 v[232:235], v[48:51], v[80:83], v[232:235]
    v_accvgpr_write_b32 a48, 0
    v_accvgpr_write_b32 a49, 0
    v_mfma_f32_16x16x32_bf16 v[232:235], v[52:55], v[84:87], v[232:235]
    s_waitcnt vmcnt(21)
    s_barrier
    ds_read_b64_tr_b16 v[40:41], v26 offset:0
    v_mfma_f32_16x16x32_bf16 v[236:239], v[48:51], v[88:91], v[236:239]
    s_add_u32 m0, s69, 0
    ds_read_b64_tr_b16 v[42:43], v26 offset:512
    ds_read_b64_tr_b16 v[44:45], v26 offset:4096
    v_mfma_f32_16x16x32_bf16 v[236:239], v[52:55], v[92:95], v[236:239]
    buffer_load_dwordx4 v2, s[24:27], s60 offen lds
    v_mfma_f32_16x16x32_bf16 v[240:243], v[56:59], v[64:67], v[240:243]
    ds_read_b64_tr_b16 v[46:47], v26 offset:4608
    ds_read_b128 a[136:139], v22 offset:0
    v_mfma_f32_16x16x32_bf16 v[240:243], v[60:63], v[68:71], v[240:243]
    ds_read_b128 a[140:143], v23 offset:0
    ds_read_b64_tr_b16 v[48:49], v27 offset:0
    v_mfma_f32_16x16x32_bf16 v[244:247], v[56:59], v[72:75], v[244:247]
    buffer_load_dwordx4 v3, s[24:27], s60 offen offset:1024 lds
    v_mfma_f32_16x16x32_bf16 v[244:247], v[60:63], v[76:79], v[244:247]
    ds_read_b64_tr_b16 v[50:51], v27 offset:512
    ds_read_b64_tr_b16 v[52:53], v27 offset:4096
    v_mfma_f32_16x16x32_bf16 v[248:251], v[56:59], v[80:83], v[248:251]
    ds_read_b64_tr_b16 v[54:55], v27 offset:4608
    v_add_u32 v26, 0x10000, v26
    v_mfma_f32_16x16x32_bf16 v[248:251], v[60:63], v[84:87], v[248:251]
    v_add_u32 v22, 0x10000, v22
    v_add_u32 v23, 0x10000, v23
    v_mfma_f32_16x16x32_bf16 v[252:255], v[56:59], v[88:91], v[252:255]
    buffer_load_dwordx4 v4, s[24:27], s60 offen offset:2048 lds
    v_mfma_f32_16x16x32_bf16 v[252:255], v[60:63], v[92:95], v[252:255]
    s_waitcnt lgkmcnt(3)
    ds_read_b64_tr_b16 v[56:57], v28 offset:0
    ds_read_b64_tr_b16 v[58:59], v28 offset:512
    v_mfma_f32_16x16x32_bf16 a[64:67], v[40:43], v[64:67], a[64:67]
    ds_read_b64_tr_b16 v[60:61], v28 offset:4096
    ds_read_b64_tr_b16 v[62:63], v28 offset:4608
    v_mfma_f32_16x16x32_bf16 a[64:67], v[44:47], v[68:71], a[64:67]
    v_add_u32 v24, 0x10000, v24
    v_add_u32 v27, 0x10000, v27
    v_mfma_f32_16x16x32_bf16 a[68:71], v[40:43], v[72:75], a[68:71]
    buffer_load_dwordx4 v5, s[24:27], s60 offen offset:3072 lds
    v_mfma_f32_16x16x32_bf16 a[68:71], v[44:47], v[76:79], a[68:71]
    ds_read_b128 v[112:115], v24 offset:16384
    v_add_u32 v28, 0x10000, v28
    v_mfma_f32_16x16x32_bf16 a[72:75], v[40:43], v[80:83], a[72:75]
    v_accvgpr_write_b32 a50, 0
    v_accvgpr_write_b32 a51, 0
    v_mfma_f32_16x16x32_bf16 a[72:75], v[44:47], v[84:87], a[72:75]
    s_add_u32 m0, s69, 16384
    v_add_u32 v25, 0x10000, v25
    v_mfma_f32_16x16x32_bf16 a[76:79], v[40:43], v[88:91], a[76:79]
    s_add_u32 s60, s60, 524288
    buffer_load_dwordx4 v10, s[20:23], s63 offen lds
    v_mfma_f32_16x16x32_bf16 a[76:79], v[44:47], v[92:95], a[76:79]
    ds_read_b128 v[116:119], v25 offset:16384
    v_mfma_f32_16x16x32_bf16 a[128:131], v[40:43], a[136:139], a[128:131]
    ds_read_b64_tr_b16 v[40:41], v29 offset:0
    ds_read_b64_tr_b16 v[42:43], v29 offset:512
    v_mfma_f32_16x16x32_bf16 a[128:131], v[44:47], a[140:143], a[128:131]
    s_waitcnt lgkmcnt(3)
    ds_read_b64_tr_b16 v[44:45], v29 offset:4096
    ds_read_b64_tr_b16 v[46:47], v29 offset:4608
    v_mfma_f32_16x16x32_bf16 a[80:83], v[48:51], v[64:67], a[80:83]
    buffer_load_dwordx4 v11, s[20:23], s63 offen offset:1024 lds
    v_mfma_f32_16x16x32_bf16 a[80:83], v[52:55], v[68:71], a[80:83]
    ds_read_b128 v[120:123], v24 offset:24576
    v_add_u32 v29, 0x10000, v29
    v_mfma_f32_16x16x32_bf16 a[84:87], v[48:51], v[72:75], a[84:87]
    buffer_store_dwordx4 a[52:55], v1, s[36:39], s72 offen offset:1024 sc1
    v_mfma_f32_16x16x32_bf16 a[84:87], v[52:55], v[76:79], a[84:87]
    v_mfma_f32_16x16x32_bf16 a[88:91], v[48:51], v[80:83], a[88:91]
    buffer_load_dwordx4 v12, s[20:23], s63 offen offset:2048 lds
    v_mfma_f32_16x16x32_bf16 a[88:91], v[52:55], v[84:87], a[88:91]
    ds_read_b128 v[124:127], v25 offset:24576
    v_accvgpr_write_b32 a52, 0
    v_mfma_f32_16x16x32_bf16 a[92:95], v[48:51], v[88:91], a[92:95]
    v_accvgpr_write_b32 a53, 0
    v_accvgpr_write_b32 a54, 0
    v_mfma_f32_16x16x32_bf16 a[92:95], v[52:55], v[92:95], a[92:95]
    v_accvgpr_write_b32 a55, 0
    v_mfma_f32_16x16x32_bf16 a[132:135], v[48:51], a[136:139], a[132:135]
    buffer_load_dwordx4 v13, s[20:23], s63 offen offset:3072 lds
    v_mfma_f32_16x16x32_bf16 a[132:135], v[52:55], a[140:143], a[132:135]
    v_mfma_f32_16x16x32_bf16 a[96:99], v[56:59], v[64:67], a[96:99]
    v_mfma_f32_16x16x32_bf16 a[96:99], v[60:63], v[68:71], a[96:99]
    s_add_u32 s63, s63, 128
    v_mfma_f32_16x16x32_bf16 a[100:103], v[56:59], v[72:75], a[100:103]
    v_mfma_f32_16x16x32_bf16 a[100:103], v[60:63], v[76:79], a[100:103]
    v_mfma_f32_16x16x32_bf16 a[104:107], v[56:59], v[80:83], a[104:107]
    v_mfma_f32_16x16x32_bf16 a[104:107], v[60:63], v[84:87], a[104:107]
    s_waitcnt vmcnt(20)
    s_barrier
    ds_read_b64_tr_b16 v[48:49], v14 offset:32768
    v_mfma_f32_16x16x32_bf16 a[108:111], v[56:59], v[88:91], a[108:111]
    s_add_u32 m0, s67, 32768
    ds_read_b64_tr_b16 v[50:51], v14 offset:33792
    ds_read_b64_tr_b16 v[52:53], v14 offset:40960
    v_mfma_f32_16x16x32_bf16 a[108:111], v[60:63], v[92:95], a[108:111]
    s_add_u32 s72, s70, 45056
    buffer_load_dwordx4 v1, s[28:31], s65 offen sc1 lds
    s_waitcnt lgkmcnt(3)
    v_mfma_f32_16x16x32_bf16 a[112:115], v[40:43], v[64:67], a[112:115]
    s_mul_i32 s70, s7, 36864
    ds_read_b64_tr_b16 v[54:55], v14 offset:41984
    ds_read_b64_tr_b16 v[56:57], v15 offset:32768
    v_mfma_f32_16x16x32_bf16 a[112:115], v[44:47], v[68:71], a[112:115]
    s_add_u32 s70, s70, s99
    ds_read_b64_tr_b16 v[58:59], v15 offset:33792
    ds_read_b64_tr_b16 v[60:61], v15 offset:40960
    v_mfma_f32_16x16x32_bf16 a[116:119], v[40:43], v[72:75], a[116:119]
    s_lshr_b32 s99, s69, 5
    ds_read_b64_tr_b16 v[62:63], v15 offset:41984
    v_add_u32 v14, 0xffff0000, v14
    v_mfma_f32_16x16x32_bf16 a[116:119], v[44:47], v[76:79], a[116:119]
    s_add_u32 s99, s99, s98
    v_add_u32 v15, 0xffff0000, v15
    v_mfma_f32_16x16x32_bf16 a[120:123], v[40:43], v[80:83], a[120:123]
    s_mul_hi_u32 s7, s2, 715827883
    buffer_store_dwordx4 a[56:59], v1, s[36:39], s72 offen offset:0 sc1
    v_mfma_f32_16x16x32_bf16 a[120:123], v[44:47], v[84:87], a[120:123]
    s_mul_i32 s3, s7, 6
    v_accvgpr_write_b32 a56, 0
    v_accvgpr_write_b32 a57, 0
    v_mfma_f32_16x16x32_bf16 a[124:127], v[40:43], v[88:91], a[124:127]
    s_sub_u32 s3, s2, s3
    buffer_load_dwordx4 v1, s[28:31], s65 offen offset:1024 sc1 lds
    v_mfma_f32_16x16x32_bf16 a[124:127], v[44:47], v[92:95], a[124:127]
    s_mul_i32 s3, s3, 6
    ds_read_b64_tr_b16 v[40:41], v16 offset:32768
    ds_read_b64_tr_b16 v[42:43], v16 offset:33792
    s_waitcnt lgkmcnt(2)
    v_mfma_f32_16x16x32_bf16 v[128:131], v[48:51], v[96:99], v[128:131]
    s_lshl1_add_u32 s3, s4, s3
    ds_read_b64_tr_b16 v[44:45], v16 offset:40960
    ds_read_b64_tr_b16 v[46:47], v16 offset:41984
    v_mfma_f32_16x16x32_bf16 v[128:131], v[52:55], v[100:103], v[128:131]
    s_sub_u32 s3, s3, 2
    v_add_u32 v16, 0xffff0000, v16
    v_accvgpr_write_b32 a58, 0
    v_mfma_f32_16x16x32_bf16 v[132:135], v[48:51], v[104:107], v[132:135]
    ds_read_b128 v[64:67], v24 offset:49152
    v_accvgpr_write_b32 a59, 0
    v_mfma_f32_16x16x32_bf16 v[132:135], v[52:55], v[108:111], v[132:135]
    v_mfma_f32_16x16x32_bf16 v[136:139], v[48:51], v[112:115], v[136:139]
    v_mfma_f32_16x16x32_bf16 v[136:139], v[52:55], v[116:119], v[136:139]
    v_mfma_f32_16x16x32_bf16 v[140:143], v[48:51], v[120:123], v[140:143]
    s_add_u32 m0, s68, 40960
    ds_read_b64_tr_b16 v[48:49], v17 offset:32768
    ds_read_b64_tr_b16 v[50:51], v17 offset:33792
    v_mfma_f32_16x16x32_bf16 v[140:143], v[52:55], v[124:127], v[140:143]
    buffer_load_dwordx4 v6, s[20:23], s66 offen lds
    v_mfma_f32_16x16x32_bf16 v[144:147], v[56:59], v[96:99], v[144:147]
    ds_read_b64_tr_b16 v[52:53], v17 offset:40960
    ds_read_b64_tr_b16 v[54:55], v17 offset:41984
    v_mfma_f32_16x16x32_bf16 v[144:147], v[60:63], v[100:103], v[144:147]
    v_add_u32 v17, 0xffff0000, v17
    v_mfma_f32_16x16x32_bf16 v[148:151], v[56:59], v[104:107], v[148:151]
    buffer_store_dwordx4 a[60:63], v1, s[36:39], s72 offen offset:1024 sc1
    v_mfma_f32_16x16x32_bf16 v[148:151], v[60:63], v[108:111], v[148:151]
    v_mfma_f32_16x16x32_bf16 v[152:155], v[56:59], v[112:115], v[152:155]
    v_accvgpr_write_b32 a60, 0
    v_accvgpr_write_b32 a61, 0
    v_mfma_f32_16x16x32_bf16 v[152:155], v[60:63], v[116:119], v[152:155]
    ds_read_b128 v[68:71], v25 offset:49152
    v_accvgpr_write_b32 a62, 0
    v_mfma_f32_16x16x32_bf16 v[156:159], v[56:59], v[120:123], v[156:159]
    s_add_u32 m0, s69, 49152
    ds_read_b64_tr_b16 v[56:57], v18 offset:32768
    ds_read_b64_tr_b16 v[58:59], v18 offset:33792
    v_mfma_f32_16x16x32_bf16 v[156:159], v[60:63], v[124:127], v[156:159]
    s_add_u32 s65, s65, 8192
    buffer_load_dwordx4 v10, s[20:23], s64 offen lds
    s_waitcnt lgkmcnt(3)
    v_mfma_f32_16x16x32_bf16 v[160:163], v[40:43], v[96:99], v[160:163]
    s_add_u32 s66, s66, 128
    ds_read_b64_tr_b16 v[60:61], v18 offset:40960
    ds_read_b64_tr_b16 v[62:63], v18 offset:41984
    v_mfma_f32_16x16x32_bf16 v[160:163], v[44:47], v[100:103], v[160:163]
    v_add_u32 v18, 0xffff0000, v18
    v_accvgpr_write_b32 a63, 0
    v_mfma_f32_16x16x32_bf16 v[164:167], v[40:43], v[104:107], v[164:167]
    v_mfma_f32_16x16x32_bf16 v[164:167], v[44:47], v[108:111], v[164:167]
    v_mfma_f32_16x16x32_bf16 v[168:171], v[40:43], v[112:115], v[168:171]
    v_accvgpr_read_b32 v32, a144
    v_accvgpr_read_b32 v31, a145
    v_mfma_f32_16x16x32_bf16 v[168:171], v[44:47], v[116:119], v[168:171]
    v_cvt_pk_bf16_f32 v32, v32, v31
    v_accvgpr_read_b32 v33, a146
    v_mfma_f32_16x16x32_bf16 v[172:175], v[40:43], v[120:123], v[172:175]
    ds_read_b64_tr_b16 v[40:41], v19 offset:32768
    ds_read_b64_tr_b16 v[42:43], v19 offset:33792
    v_mfma_f32_16x16x32_bf16 v[172:175], v[44:47], v[124:127], v[172:175]
    ds_read_b64_tr_b16 v[44:45], v19 offset:40960
    ds_read_b64_tr_b16 v[46:47], v19 offset:41984
    v_mfma_f32_16x16x32_bf16 v[176:179], v[48:51], v[96:99], v[176:179]
    buffer_load_dwordx4 v11, s[20:23], s64 offen offset:1024 lds
    v_mfma_f32_16x16x32_bf16 v[176:179], v[52:55], v[100:103], v[176:179]
    ds_read_b128 v[72:75], v24 offset:57344
    v_add_u32 v19, 0xffff0000, v19
    v_mfma_f32_16x16x32_bf16 v[180:183], v[48:51], v[104:107], v[180:183]
    v_accvgpr_read_b32 v31, a147
    v_cvt_pk_bf16_f32 v33, v33, v31
    v_mfma_f32_16x16x32_bf16 v[180:183], v[52:55], v[108:111], v[180:183]
    v_accvgpr_read_b32 v34, a148
    v_accvgpr_read_b32 v31, a149
    v_mfma_f32_16x16x32_bf16 v[184:187], v[48:51], v[112:115], v[184:187]
    v_cvt_pk_bf16_f32 v34, v34, v31
    v_accvgpr_read_b32 v35, a150
    v_mfma_f32_16x16x32_bf16 v[184:187], v[52:55], v[116:119], v[184:187]
    s_add_u32 s72, s71, 32768
    v_accvgpr_read_b32 v31, a151
    v_cvt_pk_bf16_f32 v35, v35, v31
    v_mfma_f32_16x16x32_bf16 v[188:191], v[48:51], v[120:123], v[188:191]
    ds_read_b64_tr_b16 v[48:49], v20 offset:32768
    ds_read_b64_tr_b16 v[50:51], v20 offset:33792
    v_mfma_f32_16x16x32_bf16 v[188:191], v[52:55], v[124:127], v[188:191]
    s_waitcnt lgkmcnt(2)
    ds_read_b64_tr_b16 v[52:53], v20 offset:40960
    ds_read_b64_tr_b16 v[54:55], v20 offset:41984
    v_mfma_f32_16x16x32_bf16 v[192:195], v[56:59], v[96:99], v[192:195]
    buffer_load_dwordx4 v12, s[20:23], s64 offen offset:2048 lds
    v_mfma_f32_16x16x32_bf16 v[192:195], v[60:63], v[100:103], v[192:195]
    v_add_u32 v20, 0xffff0000, v20
    v_accvgpr_write_b32 a144, 0
    v_mfma_f32_16x16x32_bf16 v[196:199], v[56:59], v[104:107], v[196:199]
    buffer_store_dwordx4 v[32:35], v1, s[36:39], s72 offen sc1
    v_mfma_f32_16x16x32_bf16 v[196:199], v[60:63], v[108:111], v[196:199]
    ds_read_b128 v[76:79], v25 offset:57344
    v_accvgpr_write_b32 a145, 0
    v_mfma_f32_16x16x32_bf16 v[200:203], v[56:59], v[112:115], v[200:203]
    v_accvgpr_write_b32 a146, 0
    v_accvgpr_write_b32 a147, 0
    v_mfma_f32_16x16x32_bf16 v[200:203], v[60:63], v[116:119], v[200:203]
    v_accvgpr_write_b32 a148, 0
    v_accvgpr_write_b32 a149, 0
    v_mfma_f32_16x16x32_bf16 v[204:207], v[56:59], v[120:123], v[204:207]
    ds_read_b64_tr_b16 v[56:57], v21 offset:32768
    ds_read_b64_tr_b16 v[58:59], v21 offset:33792
    v_mfma_f32_16x16x32_bf16 v[204:207], v[60:63], v[124:127], v[204:207]
    ds_read_b64_tr_b16 v[60:61], v21 offset:40960
    ds_read_b64_tr_b16 v[62:63], v21 offset:41984
    v_mfma_f32_16x16x32_bf16 v[208:211], v[40:43], v[96:99], v[208:211]
    v_add_u32 v21, 0xffff0000, v21
    v_accvgpr_read_b32 v36, a152
    v_mfma_f32_16x16x32_bf16 v[208:211], v[44:47], v[100:103], v[208:211]
    buffer_load_dwordx4 v13, s[20:23], s64 offen offset:3072 lds
    v_mfma_f32_16x16x32_bf16 v[212:215], v[40:43], v[104:107], v[212:215]
    v_accvgpr_read_b32 v31, a153
    v_cvt_pk_bf16_f32 v36, v36, v31
    v_mfma_f32_16x16x32_bf16 v[212:215], v[44:47], v[108:111], v[212:215]
    v_accvgpr_read_b32 v37, a154
    v_accvgpr_read_b32 v31, a155
    v_mfma_f32_16x16x32_bf16 v[216:219], v[40:43], v[112:115], v[216:219]
    v_cvt_pk_bf16_f32 v37, v37, v31
    v_accvgpr_read_b32 v38, a156
    v_mfma_f32_16x16x32_bf16 v[216:219], v[44:47], v[116:119], v[216:219]
    v_accvgpr_read_b32 v31, a157
    v_cvt_pk_bf16_f32 v38, v38, v31
    v_mfma_f32_16x16x32_bf16 v[220:223], v[40:43], v[120:123], v[220:223]
    v_accvgpr_read_b32 v39, a158
    v_accvgpr_read_b32 v31, a159
    v_mfma_f32_16x16x32_bf16 v[220:223], v[44:47], v[124:127], v[220:223]
    s_waitcnt lgkmcnt(0)
    v_cvt_pk_bf16_f32 v39, v39, v31
    v_accvgpr_write_b32 a150, 0
    v_mfma_f32_16x16x32_bf16 v[224:227], v[48:51], v[96:99], v[224:227]
    v_accvgpr_write_b32 a151, 0
    v_accvgpr_write_b32 a152, 0
    v_mfma_f32_16x16x32_bf16 v[224:227], v[52:55], v[100:103], v[224:227]
    s_add_u32 s64, s64, 128
    v_accvgpr_write_b32 a153, 0
    v_accvgpr_write_b32 a154, 0
    v_mfma_f32_16x16x32_bf16 v[228:231], v[48:51], v[104:107], v[228:231]
    s_add_u32 s72, s71, 33792
    buffer_store_dwordx4 v[36:39], v1, s[36:39], s72 offen sc1
    v_mfma_f32_16x16x32_bf16 v[228:231], v[52:55], v[108:111], v[228:231]
    v_accvgpr_write_b32 a155, 0
    v_accvgpr_write_b32 a156, 0
    v_mfma_f32_16x16x32_bf16 v[232:235], v[48:51], v[112:115], v[232:235]
    v_accvgpr_write_b32 a157, 0
    v_accvgpr_write_b32 a158, 0
    v_mfma_f32_16x16x32_bf16 v[232:235], v[52:55], v[116:119], v[232:235]
    s_waitcnt vmcnt(21)
    s_barrier
    ds_read_b64_tr_b16 v[40:41], v26 offset:0
    v_mfma_f32_16x16x32_bf16 v[236:239], v[48:51], v[120:123], v[236:239]
    s_add_u32 m0, s69, 65536
    ds_read_b64_tr_b16 v[42:43], v26 offset:512
    ds_read_b64_tr_b16 v[44:45], v26 offset:4096
    v_mfma_f32_16x16x32_bf16 v[236:239], v[52:55], v[124:127], v[236:239]
    buffer_load_dwordx4 v2, s[24:27], s60 offen lds
    v_mfma_f32_16x16x32_bf16 v[240:243], v[56:59], v[96:99], v[240:243]
    ds_read_b64_tr_b16 v[46:47], v26 offset:4608
    ds_read_b128 a[136:139], v22 offset:0
    v_mfma_f32_16x16x32_bf16 v[240:243], v[60:63], v[100:103], v[240:243]
    ds_read_b128 a[140:143], v23 offset:0
    ds_read_b64_tr_b16 v[48:49], v27 offset:0
    v_mfma_f32_16x16x32_bf16 v[244:247], v[56:59], v[104:107], v[244:247]
    buffer_load_dwordx4 v3, s[24:27], s60 offen offset:1024 lds
    v_mfma_f32_16x16x32_bf16 v[244:247], v[60:63], v[108:111], v[244:247]
    ds_read_b64_tr_b16 v[50:51], v27 offset:512
    ds_read_b64_tr_b16 v[52:53], v27 offset:4096
    v_mfma_f32_16x16x32_bf16 v[248:251], v[56:59], v[112:115], v[248:251]
    ds_read_b64_tr_b16 v[54:55], v27 offset:4608
    v_add_u32 v26, 0xfffe0000, v26
    v_mfma_f32_16x16x32_bf16 v[248:251], v[60:63], v[116:119], v[248:251]
    v_add_u32 v22, 0xfffe0000, v22
    v_add_u32 v23, 0xfffe0000, v23
    v_mfma_f32_16x16x32_bf16 v[252:255], v[56:59], v[120:123], v[252:255]
    buffer_load_dwordx4 v4, s[24:27], s60 offen offset:2048 lds
    v_mfma_f32_16x16x32_bf16 v[252:255], v[60:63], v[124:127], v[252:255]
    s_waitcnt lgkmcnt(3)
    ds_read_b64_tr_b16 v[56:57], v28 offset:0
    ds_read_b64_tr_b16 v[58:59], v28 offset:512
    v_mfma_f32_16x16x32_bf16 a[64:67], v[40:43], v[96:99], a[64:67]
    ds_read_b64_tr_b16 v[60:61], v28 offset:4096
    ds_read_b64_tr_b16 v[62:63], v28 offset:4608
    v_mfma_f32_16x16x32_bf16 a[64:67], v[44:47], v[100:103], a[64:67]
    v_add_u32 v24, 0x10000, v24
    v_add_u32 v27, 0xfffe0000, v27
    v_mfma_f32_16x16x32_bf16 a[68:71], v[40:43], v[104:107], a[68:71]
    buffer_load_dwordx4 v5, s[24:27], s60 offen offset:3072 lds
    v_mfma_f32_16x16x32_bf16 a[68:71], v[44:47], v[108:111], a[68:71]
    ds_read_b128 v[80:83], v24 offset:16384
    v_add_u32 v28, 0xfffe0000, v28
    v_mfma_f32_16x16x32_bf16 a[72:75], v[40:43], v[112:115], a[72:75]
    v_accvgpr_read_b32 v32, a160
    v_accvgpr_read_b32 v31, a161
    v_mfma_f32_16x16x32_bf16 a[72:75], v[44:47], v[116:119], a[72:75]
    s_add_u32 m0, s69, 81920
    v_add_u32 v25, 0x10000, v25
    v_cvt_pk_bf16_f32 v32, v32, v31
    v_mfma_f32_16x16x32_bf16 a[76:79], v[40:43], v[120:123], a[76:79]
    s_add_u32 s60, s60, 524288
    buffer_load_dwordx4 v10, s[20:23], s63 offen lds
    v_mfma_f32_16x16x32_bf16 a[76:79], v[44:47], v[124:127], a[76:79]
    s_add_u32 s72, s71, 2048
    ds_read_b128 v[84:87], v25 offset:16384
    v_accvgpr_read_b32 v33, a162
    v_mfma_f32_16x16x32_bf16 a[128:131], v[40:43], a[136:139], a[128:131]
    ds_read_b64_tr_b16 v[40:41], v29 offset:0
    ds_read_b64_tr_b16 v[42:43], v29 offset:512
    v_mfma_f32_16x16x32_bf16 a[128:131], v[44:47], a[140:143], a[128:131]
    s_waitcnt lgkmcnt(3)
    ds_read_b64_tr_b16 v[44:45], v29 offset:4096
    ds_read_b64_tr_b16 v[46:47], v29 offset:4608
    v_mfma_f32_16x16x32_bf16 a[80:83], v[48:51], v[96:99], a[80:83]
    buffer_load_dwordx4 v11, s[20:23], s63 offen offset:1024 lds
    v_mfma_f32_16x16x32_bf16 a[80:83], v[52:55], v[100:103], a[80:83]
    ds_read_b128 v[88:91], v24 offset:24576
    v_add_u32 v29, 0xfffe0000, v29
    v_mfma_f32_16x16x32_bf16 a[84:87], v[48:51], v[104:107], a[84:87]
    v_accvgpr_read_b32 v31, a163
    v_cvt_pk_bf16_f32 v33, v33, v31
    v_mfma_f32_16x16x32_bf16 a[84:87], v[52:55], v[108:111], a[84:87]
    v_accvgpr_read_b32 v34, a164
    v_accvgpr_read_b32 v31, a165
    v_mfma_f32_16x16x32_bf16 a[88:91], v[48:51], v[112:115], a[88:91]
    buffer_load_dwordx4 v12, s[20:23], s63 offen offset:2048 lds
    v_mfma_f32_16x16x32_bf16 a[88:91], v[52:55], v[116:119], a[88:91]
    ds_read_b128 v[92:95], v25 offset:24576
    v_cvt_pk_bf16_f32 v34, v34, v31
    v_mfma_f32_16x16x32_bf16 a[92:95], v[48:51], v[120:123], a[92:95]
    v_accvgpr_read_b32 v35, a166
    v_accvgpr_read_b32 v31, a167
    v_mfma_f32_16x16x32_bf16 a[92:95], v[52:55], v[124:127], a[92:95]
    v_cvt_pk_bf16_f32 v35, v35, v31
    v_accvgpr_read_b32 v36, a168
    v_mfma_f32_16x16x32_bf16 a[132:135], v[48:51], a[136:139], a[132:135]
    buffer_load_dwordx4 v13, s[20:23], s63 offen offset:3072 lds
    v_mfma_f32_16x16x32_bf16 a[132:135], v[52:55], a[140:143], a[132:135]
    buffer_store_dwordx4 v[32:35], v1, s[36:39], s72 offen sc1
    v_mfma_f32_16x16x32_bf16 a[96:99], v[56:59], v[96:99], a[96:99]
    v_accvgpr_read_b32 v31, a169
    v_cvt_pk_bf16_f32 v36, v36, v31
    v_mfma_f32_16x16x32_bf16 a[96:99], v[60:63], v[100:103], a[96:99]
    s_add_u32 s63, s63, 128
    v_accvgpr_read_b32 v37, a170
    v_accvgpr_read_b32 v31, a171
    v_mfma_f32_16x16x32_bf16 a[100:103], v[56:59], v[104:107], a[100:103]
    v_cvt_pk_bf16_f32 v37, v37, v31
    v_accvgpr_read_b32 v38, a172
    v_mfma_f32_16x16x32_bf16 a[100:103], v[60:63], v[108:111], a[100:103]
    v_accvgpr_read_b32 v31, a173
    v_cvt_pk_bf16_f32 v38, v38, v31
    v_mfma_f32_16x16x32_bf16 a[104:107], v[56:59], v[112:115], a[104:107]
    v_accvgpr_read_b32 v39, a174
    v_accvgpr_read_b32 v31, a175
    v_mfma_f32_16x16x32_bf16 a[104:107], v[60:63], v[116:119], a[104:107]
    s_waitcnt vmcnt(20)
    s_barrier
    ds_read_b64_tr_b16 v[48:49], v14 offset:0
    v_mfma_f32_16x16x32_bf16 a[108:111], v[56:59], v[120:123], a[108:111]
    s_add_u32 m0, s67, 98304
    ds_read_b64_tr_b16 v[50:51], v14 offset:1024
    ds_read_b64_tr_b16 v[52:53], v14 offset:8192
    v_mfma_f32_16x16x32_bf16 a[108:111], v[60:63], v[124:127], a[108:111]
    s_add_u32 s72, s71, 3072
    buffer_load_dwordx4 v1, s[28:31], s65 offen sc1 lds
    s_waitcnt lgkmcnt(3)
    v_mfma_f32_16x16x32_bf16 a[112:115], v[40:43], v[96:99], a[112:115]
    ds_read_b64_tr_b16 v[54:55], v14 offset:9216
    ds_read_b64_tr_b16 v[56:57], v15 offset:0
    v_mfma_f32_16x16x32_bf16 a[112:115], v[44:47], v[100:103], a[112:115]
    ds_read_b64_tr_b16 v[58:59], v15 offset:1024
    ds_read_b64_tr_b16 v[60:61], v15 offset:8192
    v_mfma_f32_16x16x32_bf16 a[116:119], v[40:43], v[104:107], a[116:119]
    ds_read_b64_tr_b16 v[62:63], v15 offset:9216
    v_add_u32 v14, 0x10000, v14
    v_mfma_f32_16x16x32_bf16 a[116:119], v[44:47], v[108:111], a[116:119]
    v_add_u32 v15, 0x10000, v15
    v_cvt_pk_bf16_f32 v39, v39, v31
    v_mfma_f32_16x16x32_bf16 a[120:123], v[40:43], v[112:115], a[120:123]
    buffer_store_dwordx4 v[36:39], v1, s[36:39], s72 offen sc1
    v_mfma_f32_16x16x32_bf16 a[120:123], v[44:47], v[116:119], a[120:123]
    v_accvgpr_write_b32 a159, 0
    v_accvgpr_write_b32 a160, 0
    v_mfma_f32_16x16x32_bf16 a[124:127], v[40:43], v[120:123], a[124:127]
    buffer_load_dwordx4 v1, s[28:31], s65 offen offset:1024 sc1 lds
    v_mfma_f32_16x16x32_bf16 a[124:127], v[44:47], v[124:127], a[124:127]
    s_waitcnt lgkmcnt(0)
    ds_read_b64_tr_b16 v[40:41], v16 offset:0
    ds_read_b64_tr_b16 v[42:43], v16 offset:1024
    v_mfma_f32_16x16x32_bf16 v[128:131], v[48:51], v[64:67], v[128:131]
    ds_read_b64_tr_b16 v[44:45], v16 offset:8192
    ds_read_b64_tr_b16 v[46:47], v16 offset:9216
    v_mfma_f32_16x16x32_bf16 v[128:131], v[52:55], v[68:71], v[128:131]
    v_add_u32 v24, 0xfffe0000, v24
    v_add_u32 v16, 0x10000, v16
    v_mfma_f32_16x16x32_bf16 v[132:135], v[48:51], v[72:75], v[132:135]
    ds_read_b128 v[96:99], v24 offset:16384
    v_accvgpr_read_b32 v32, a176
    v_mfma_f32_16x16x32_bf16 v[132:135], v[52:55], v[76:79], v[132:135]
    v_accvgpr_read_b32 v31, a177
    v_cvt_pk_bf16_f32 v32, v32, v31
    v_mfma_f32_16x16x32_bf16 v[136:139], v[48:51], v[80:83], v[136:139]
    v_accvgpr_read_b32 v33, a178
    v_accvgpr_read_b32 v31, a179
    v_mfma_f32_16x16x32_bf16 v[136:139], v[52:55], v[84:87], v[136:139]
    v_cvt_pk_bf16_f32 v33, v33, v31
    v_accvgpr_read_b32 v34, a180
    v_mfma_f32_16x16x32_bf16 v[140:143], v[48:51], v[88:91], v[140:143]
    s_add_u32 m0, s68, 106496
    ds_read_b64_tr_b16 v[48:49], v17 offset:0
    ds_read_b64_tr_b16 v[50:51], v17 offset:1024
    v_mfma_f32_16x16x32_bf16 v[140:143], v[52:55], v[92:95], v[140:143]
    buffer_load_dwordx4 v6, s[20:23], s66 offen lds
    v_mfma_f32_16x16x32_bf16 v[144:147], v[56:59], v[64:67], v[144:147]
    ds_read_b64_tr_b16 v[52:53], v17 offset:8192
    ds_read_b64_tr_b16 v[54:55], v17 offset:9216
    v_mfma_f32_16x16x32_bf16 v[144:147], v[60:63], v[68:71], v[144:147]
    s_add_u32 s72, s71, 34816
    v_add_u32 v17, 0x10000, v17
    v_accvgpr_read_b32 v31, a181
    v_mfma_f32_16x16x32_bf16 v[148:151], v[56:59], v[72:75], v[148:151]
    v_cvt_pk_bf16_f32 v34, v34, v31
    v_accvgpr_read_b32 v35, a182
    v_mfma_f32_16x16x32_bf16 v[148:151], v[60:63], v[76:79], v[148:151]
    v_accvgpr_read_b32 v31, a183
    v_cvt_pk_bf16_f32 v35, v35, v31
    v_mfma_f32_16x16x32_bf16 v[152:155], v[56:59], v[80:83], v[152:155]
    v_add_u32 v25, 0xfffe0000, v25
    v_accvgpr_write_b32 a161, 0
    v_mfma_f32_16x16x32_bf16 v[152:155], v[60:63], v[84:87], v[152:155]
    ds_read_b128 v[100:103], v25 offset:16384
    v_accvgpr_write_b32 a162, 0
    v_mfma_f32_16x16x32_bf16 v[156:159], v[56:59], v[88:91], v[156:159]
    s_add_u32 m0, s69, 114688
    ds_read_b64_tr_b16 v[56:57], v18 offset:0
    ds_read_b64_tr_b16 v[58:59], v18 offset:1024
    v_mfma_f32_16x16x32_bf16 v[156:159], v[60:63], v[92:95], v[156:159]
    s_add_u32 s65, s65, 8192
    buffer_load_dwordx4 v10, s[20:23], s64 offen lds
    s_waitcnt lgkmcnt(3)
    v_mfma_f32_16x16x32_bf16 v[160:163], v[40:43], v[64:67], v[160:163]
    s_add_u32 s66, s66, 128
    ds_read_b64_tr_b16 v[60:61], v18 offset:8192
    ds_read_b64_tr_b16 v[62:63], v18 offset:9216
    v_mfma_f32_16x16x32_bf16 v[160:163], v[44:47], v[68:71], v[160:163]
    v_add_u32 v18, 0x10000, v18
    v_accvgpr_write_b32 a163, 0
    v_mfma_f32_16x16x32_bf16 v[164:167], v[40:43], v[72:75], v[164:167]
    buffer_store_dwordx4 v[32:35], v1, s[36:39], s72 offen sc1
    v_mfma_f32_16x16x32_bf16 v[164:167], v[44:47], v[76:79], v[164:167]
    v_accvgpr_write_b32 a164, 0
    v_accvgpr_write_b32 a165, 0
    v_mfma_f32_16x16x32_bf16 v[168:171], v[40:43], v[80:83], v[168:171]
    v_accvgpr_read_b32 v36, a184
    v_accvgpr_read_b32 v31, a185
    v_mfma_f32_16x16x32_bf16 v[168:171], v[44:47], v[84:87], v[168:171]
    v_cvt_pk_bf16_f32 v36, v36, v31
    v_accvgpr_read_b32 v37, a186
    v_mfma_f32_16x16x32_bf16 v[172:175], v[40:43], v[88:91], v[172:175]
    ds_read_b64_tr_b16 v[40:41], v19 offset:0
    ds_read_b64_tr_b16 v[42:43], v19 offset:1024
    v_mfma_f32_16x16x32_bf16 v[172:175], v[44:47], v[92:95], v[172:175]
    ds_read_b64_tr_b16 v[44:45], v19 offset:8192
    ds_read_b64_tr_b16 v[46:47], v19 offset:9216
    v_mfma_f32_16x16x32_bf16 v[176:179], v[48:51], v[64:67], v[176:179]
    buffer_load_dwordx4 v11, s[20:23], s64 offen offset:1024 lds
    v_mfma_f32_16x16x32_bf16 v[176:179], v[52:55], v[68:71], v[176:179]
    ds_read_b128 v[104:107], v24 offset:24576
    v_add_u32 v19, 0x10000, v19
    v_mfma_f32_16x16x32_bf16 v[180:183], v[48:51], v[72:75], v[180:183]
    v_accvgpr_read_b32 v31, a187
    v_cvt_pk_bf16_f32 v37, v37, v31
    v_mfma_f32_16x16x32_bf16 v[180:183], v[52:55], v[76:79], v[180:183]
    v_accvgpr_read_b32 v38, a188
    v_accvgpr_read_b32 v31, a189
    v_mfma_f32_16x16x32_bf16 v[184:187], v[48:51], v[80:83], v[184:187]
    v_cvt_pk_bf16_f32 v38, v38, v31
    v_accvgpr_read_b32 v39, a190
    v_mfma_f32_16x16x32_bf16 v[184:187], v[52:55], v[84:87], v[184:187]
    s_add_u32 s72, s71, 35840
    v_accvgpr_read_b32 v31, a191
    v_cvt_pk_bf16_f32 v39, v39, v31
    v_mfma_f32_16x16x32_bf16 v[188:191], v[48:51], v[88:91], v[188:191]
    ds_read_b64_tr_b16 v[48:49], v20 offset:0
    ds_read_b64_tr_b16 v[50:51], v20 offset:1024
    v_mfma_f32_16x16x32_bf16 v[188:191], v[52:55], v[92:95], v[188:191]
    s_waitcnt lgkmcnt(2)
    ds_read_b64_tr_b16 v[52:53], v20 offset:8192
    ds_read_b64_tr_b16 v[54:55], v20 offset:9216
    v_mfma_f32_16x16x32_bf16 v[192:195], v[56:59], v[64:67], v[192:195]
    buffer_load_dwordx4 v12, s[20:23], s64 offen offset:2048 lds
    v_mfma_f32_16x16x32_bf16 v[192:195], v[60:63], v[68:71], v[192:195]
    v_add_u32 v20, 0x10000, v20
    v_accvgpr_write_b32 a166, 0
    v_mfma_f32_16x16x32_bf16 v[196:199], v[56:59], v[72:75], v[196:199]
    buffer_store_dwordx4 v[36:39], v1, s[36:39], s72 offen sc1
    v_mfma_f32_16x16x32_bf16 v[196:199], v[60:63], v[76:79], v[196:199]
    ds_read_b128 v[108:111], v25 offset:24576
    v_accvgpr_write_b32 a167, 0
    v_mfma_f32_16x16x32_bf16 v[200:203], v[56:59], v[80:83], v[200:203]
    v_accvgpr_write_b32 a168, 0
    v_accvgpr_write_b32 a169, 0
    v_mfma_f32_16x16x32_bf16 v[200:203], v[60:63], v[84:87], v[200:203]
    v_accvgpr_write_b32 a170, 0
    v_accvgpr_write_b32 a171, 0
    v_mfma_f32_16x16x32_bf16 v[204:207], v[56:59], v[88:91], v[204:207]
    ds_read_b64_tr_b16 v[56:57], v21 offset:0
    ds_read_b64_tr_b16 v[58:59], v21 offset:1024
    v_mfma_f32_16x16x32_bf16 v[204:207], v[60:63], v[92:95], v[204:207]
    ds_read_b64_tr_b16 v[60:61], v21 offset:8192
    ds_read_b64_tr_b16 v[62:63], v21 offset:9216
    v_mfma_f32_16x16x32_bf16 v[208:211], v[40:43], v[64:67], v[208:211]
    v_add_u32 v21, 0x10000, v21
    v_accvgpr_read_b32 v32, a192
    v_mfma_f32_16x16x32_bf16 v[208:211], v[44:47], v[68:71], v[208:211]
    buffer_load_dwordx4 v13, s[20:23], s64 offen offset:3072 lds
    v_mfma_f32_16x16x32_bf16 v[212:215], v[40:43], v[72:75], v[212:215]
    v_accvgpr_read_b32 v31, a193
    v_cvt_pk_bf16_f32 v32, v32, v31
    v_mfma_f32_16x16x32_bf16 v[212:215], v[44:47], v[76:79], v[212:215]
    v_accvgpr_read_b32 v33, a194
    v_accvgpr_read_b32 v31, a195
    v_mfma_f32_16x16x32_bf16 v[216:219], v[40:43], v[80:83], v[216:219]
    v_cvt_pk_bf16_f32 v33, v33, v31
    v_accvgpr_read_b32 v34, a196
    v_mfma_f32_16x16x32_bf16 v[216:219], v[44:47], v[84:87], v[216:219]
    v_accvgpr_read_b32 v31, a197
    v_cvt_pk_bf16_f32 v34, v34, v31
    v_mfma_f32_16x16x32_bf16 v[220:223], v[40:43], v[88:91], v[220:223]
    v_accvgpr_read_b32 v35, a198
    v_accvgpr_read_b32 v31, a199
    v_mfma_f32_16x16x32_bf16 v[220:223], v[44:47], v[92:95], v[220:223]
    s_waitcnt lgkmcnt(0)
    v_cvt_pk_bf16_f32 v35, v35, v31
    v_accvgpr_write_b32 a172, 0
    v_mfma_f32_16x16x32_bf16 v[224:227], v[48:51], v[64:67], v[224:227]
    v_accvgpr_write_b32 a173, 0
    v_accvgpr_write_b32 a174, 0
    v_mfma_f32_16x16x32_bf16 v[224:227], v[52:55], v[68:71], v[224:227]
    s_add_u32 s64, s64, 128
    v_accvgpr_write_b32 a175, 0
    v_accvgpr_write_b32 a176, 0
    v_mfma_f32_16x16x32_bf16 v[228:231], v[48:51], v[72:75], v[228:231]
    s_add_u32 s72, s71, 4096
    buffer_store_dwordx4 v[32:35], v1, s[36:39], s72 offen sc1
    v_mfma_f32_16x16x32_bf16 v[228:231], v[52:55], v[76:79], v[228:231]
    v_accvgpr_write_b32 a177, 0
    v_accvgpr_write_b32 a178, 0
    v_mfma_f32_16x16x32_bf16 v[232:235], v[48:51], v[80:83], v[232:235]
    v_accvgpr_write_b32 a179, 0
    v_accvgpr_write_b32 a180, 0
    v_mfma_f32_16x16x32_bf16 v[232:235], v[52:55], v[84:87], v[232:235]
    s_waitcnt vmcnt(21)
    s_barrier
    ds_read_b64_tr_b16 v[40:41], v26 offset:32768
    v_mfma_f32_16x16x32_bf16 v[236:239], v[48:51], v[88:91], v[236:239]
    s_add_u32 m0, s69, 131072
    ds_read_b64_tr_b16 v[42:43], v26 offset:33280
    ds_read_b64_tr_b16 v[44:45], v26 offset:36864
    v_mfma_f32_16x16x32_bf16 v[236:239], v[52:55], v[92:95], v[236:239]
    buffer_load_dwordx4 v2, s[24:27], s60 offen lds
    v_mfma_f32_16x16x32_bf16 v[240:243], v[56:59], v[64:67], v[240:243]
    ds_read_b64_tr_b16 v[46:47], v26 offset:37376
    ds_read_b128 a[136:139], v22 offset:32768
    v_mfma_f32_16x16x32_bf16 v[240:243], v[60:63], v[68:71], v[240:243]
    ds_read_b128 a[140:143], v23 offset:32768
    ds_read_b64_tr_b16 v[48:49], v27 offset:32768
    v_mfma_f32_16x16x32_bf16 v[244:247], v[56:59], v[72:75], v[244:247]
    buffer_load_dwordx4 v3, s[24:27], s60 offen offset:1024 lds
    v_mfma_f32_16x16x32_bf16 v[244:247], v[60:63], v[76:79], v[244:247]
    ds_read_b64_tr_b16 v[50:51], v27 offset:33280
    ds_read_b64_tr_b16 v[52:53], v27 offset:36864
    v_mfma_f32_16x16x32_bf16 v[248:251], v[56:59], v[80:83], v[248:251]
    ds_read_b64_tr_b16 v[54:55], v27 offset:37376
    v_add_u32 v26, 0x10000, v26
    v_mfma_f32_16x16x32_bf16 v[248:251], v[60:63], v[84:87], v[248:251]
    v_add_u32 v22, 0x10000, v22
    v_add_u32 v23, 0x10000, v23
    v_mfma_f32_16x16x32_bf16 v[252:255], v[56:59], v[88:91], v[252:255]
    buffer_load_dwordx4 v4, s[24:27], s60 offen offset:2048 lds
    v_mfma_f32_16x16x32_bf16 v[252:255], v[60:63], v[92:95], v[252:255]
    s_waitcnt lgkmcnt(3)
    ds_read_b64_tr_b16 v[56:57], v28 offset:32768
    ds_read_b64_tr_b16 v[58:59], v28 offset:33280
    v_mfma_f32_16x16x32_bf16 a[64:67], v[40:43], v[64:67], a[64:67]
    ds_read_b64_tr_b16 v[60:61], v28 offset:36864
    ds_read_b64_tr_b16 v[62:63], v28 offset:37376
    v_mfma_f32_16x16x32_bf16 a[64:67], v[44:47], v[68:71], a[64:67]
    v_add_u32 v27, 0x10000, v27
    v_add_u32 v28, 0x10000, v28
    v_mfma_f32_16x16x32_bf16 a[68:71], v[40:43], v[72:75], a[68:71]
    buffer_load_dwordx4 v5, s[24:27], s60 offen offset:3072 lds
    v_mfma_f32_16x16x32_bf16 a[68:71], v[44:47], v[76:79], a[68:71]
    ds_read_b128 v[112:115], v24 offset:49152
    v_accvgpr_read_b32 v36, a200
    v_mfma_f32_16x16x32_bf16 a[72:75], v[40:43], v[80:83], a[72:75]
    v_accvgpr_read_b32 v31, a201
    v_cvt_pk_bf16_f32 v36, v36, v31
    v_mfma_f32_16x16x32_bf16 a[72:75], v[44:47], v[84:87], a[72:75]
    s_add_u32 m0, s69, 147456
    v_accvgpr_read_b32 v37, a202
    v_accvgpr_read_b32 v31, a203
    v_mfma_f32_16x16x32_bf16 a[76:79], v[40:43], v[88:91], a[76:79]
    s_add_u32 s60, s60, 524288
    buffer_load_dwordx4 v10, s[20:23], s63 offen lds
    v_mfma_f32_16x16x32_bf16 a[76:79], v[44:47], v[92:95], a[76:79]
    s_add_u32 s72, s71, 5120
    ds_read_b128 v[116:119], v25 offset:49152
    v_cvt_pk_bf16_f32 v37, v37, v31
    v_mfma_f32_16x16x32_bf16 a[128:131], v[40:43], a[136:139], a[128:131]
    ds_read_b64_tr_b16 v[40:41], v29 offset:32768
    ds_read_b64_tr_b16 v[42:43], v29 offset:33280
    v_mfma_f32_16x16x32_bf16 a[128:131], v[44:47], a[140:143], a[128:131]
    s_waitcnt lgkmcnt(3)
    ds_read_b64_tr_b16 v[44:45], v29 offset:36864
    ds_read_b64_tr_b16 v[46:47], v29 offset:37376
    v_mfma_f32_16x16x32_bf16 a[80:83], v[48:51], v[64:67], a[80:83]
    buffer_load_dwordx4 v11, s[20:23], s63 offen offset:1024 lds
    v_mfma_f32_16x16x32_bf16 a[80:83], v[52:55], v[68:71], a[80:83]
    ds_read_b128 v[120:123], v24 offset:57344
    v_add_u32 v29, 0x10000, v29
    v_mfma_f32_16x16x32_bf16 a[84:87], v[48:51], v[72:75], a[84:87]
    v_accvgpr_read_b32 v38, a204
    v_accvgpr_read_b32 v31, a205
    v_mfma_f32_16x16x32_bf16 a[84:87], v[52:55], v[76:79], a[84:87]
    v_cvt_pk_bf16_f32 v38, v38, v31
    v_accvgpr_read_b32 v39, a206
    v_mfma_f32_16x16x32_bf16 a[88:91], v[48:51], v[80:83], a[88:91]
    buffer_load_dwordx4 v12, s[20:23], s63 offen offset:2048 lds
    v_mfma_f32_16x16x32_bf16 a[88:91], v[52:55], v[84:87], a[88:91]
    ds_read_b128 v[124:127], v25 offset:57344
    v_accvgpr_read_b32 v31, a207
    v_mfma_f32_16x16x32_bf16 a[92:95], v[48:51], v[88:91], a[92:95]
    v_cvt_pk_bf16_f32 v39, v39, v31
    v_accvgpr_read_b32 v32, a208
    v_mfma_f32_16x16x32_bf16 a[92:95], v[52:55], v[92:95], a[92:95]
    buffer_store_dwordx4 v[36:39], v1, s[36:39], s72 offen sc1
    v_mfma_f32_16x16x32_bf16 a[132:135], v[48:51], a[136:139], a[132:135]
    buffer_load_dwordx4 v13, s[20:23], s63 offen offset:3072 lds
    v_mfma_f32_16x16x32_bf16 a[132:135], v[52:55], a[140:143], a[132:135]
    v_accvgpr_read_b32 v31, a209
    v_cvt_pk_bf16_f32 v32, v32, v31
    v_mfma_f32_16x16x32_bf16 a[96:99], v[56:59], v[64:67], a[96:99]
    v_accvgpr_read_b32 v33, a210
    v_accvgpr_read_b32 v31, a211
    v_mfma_f32_16x16x32_bf16 a[96:99], v[60:63], v[68:71], a[96:99]
    s_add_u32 s63, s63, 128
    v_cvt_pk_bf16_f32 v33, v33, v31
    v_accvgpr_read_b32 v34, a212
    v_mfma_f32_16x16x32_bf16 a[100:103], v[56:59], v[72:75], a[100:103]
    v_accvgpr_read_b32 v31, a213
    v_cvt_pk_bf16_f32 v34, v34, v31
    v_mfma_f32_16x16x32_bf16 a[100:103], v[60:63], v[76:79], a[100:103]
    v_accvgpr_read_b32 v35, a214
    v_accvgpr_read_b32 v31, a215
    v_mfma_f32_16x16x32_bf16 a[104:107], v[56:59], v[80:83], a[104:107]
    v_cvt_pk_bf16_f32 v35, v35, v31
    v_accvgpr_write_b32 a181, 0
    v_mfma_f32_16x16x32_bf16 a[104:107], v[60:63], v[84:87], a[104:107]
    s_waitcnt vmcnt(21)
    s_barrier
    ds_read_b64_tr_b16 v[48:49], v14 offset:0
    v_mfma_f32_16x16x32_bf16 a[108:111], v[56:59], v[88:91], a[108:111]
    s_add_u32 m0, s67, 0
    ds_read_b64_tr_b16 v[50:51], v14 offset:1024
    ds_read_b64_tr_b16 v[52:53], v14 offset:8192
    v_mfma_f32_16x16x32_bf16 a[108:111], v[60:63], v[92:95], a[108:111]
    s_add_u32 s72, s71, 36864
    buffer_load_dwordx4 v1, s[28:31], s65 offen sc1 lds
    s_waitcnt lgkmcnt(3)
    v_mfma_f32_16x16x32_bf16 a[112:115], v[40:43], v[64:67], a[112:115]
    ds_read_b64_tr_b16 v[54:55], v14 offset:9216
    ds_read_b64_tr_b16 v[56:57], v15 offset:0
    v_mfma_f32_16x16x32_bf16 a[112:115], v[44:47], v[68:71], a[112:115]
    ds_read_b64_tr_b16 v[58:59], v15 offset:1024
    ds_read_b64_tr_b16 v[60:61], v15 offset:8192
    v_mfma_f32_16x16x32_bf16 a[116:119], v[40:43], v[72:75], a[116:119]
    ds_read_b64_tr_b16 v[62:63], v15 offset:9216
    v_add_u32 v14, 0x10000, v14
    v_mfma_f32_16x16x32_bf16 a[116:119], v[44:47], v[76:79], a[116:119]
    v_add_u32 v15, 0x10000, v15
    v_accvgpr_write_b32 a182, 0
    v_mfma_f32_16x16x32_bf16 a[120:123], v[40:43], v[80:83], a[120:123]
    buffer_store_dwordx4 v[32:35], v1, s[36:39], s72 offen sc1
    v_mfma_f32_16x16x32_bf16 a[120:123], v[44:47], v[84:87], a[120:123]
    v_accvgpr_write_b32 a183, 0
    v_accvgpr_write_b32 a184, 0
    v_mfma_f32_16x16x32_bf16 a[124:127], v[40:43], v[88:91], a[124:127]
    buffer_load_dwordx4 v1, s[28:31], s65 offen offset:1024 sc1 lds
    v_mfma_f32_16x16x32_bf16 a[124:127], v[44:47], v[92:95], a[124:127]
    s_waitcnt lgkmcnt(0)
    ds_read_b64_tr_b16 v[40:41], v16 offset:0
    ds_read_b64_tr_b16 v[42:43], v16 offset:1024
    v_mfma_f32_16x16x32_bf16 v[128:131], v[48:51], v[96:99], v[128:131]
    ds_read_b64_tr_b16 v[44:45], v16 offset:8192
    ds_read_b64_tr_b16 v[46:47], v16 offset:9216
    v_mfma_f32_16x16x32_bf16 v[128:131], v[52:55], v[100:103], v[128:131]
    v_add_u32 v24, 0x10000, v24
    v_add_u32 v16, 0x10000, v16
    v_mfma_f32_16x16x32_bf16 v[132:135], v[48:51], v[104:107], v[132:135]
    ds_read_b128 v[64:67], v24 offset:16384
    v_accvgpr_read_b32 v36, a216
    v_mfma_f32_16x16x32_bf16 v[132:135], v[52:55], v[108:111], v[132:135]
    v_accvgpr_read_b32 v31, a217
    v_cvt_pk_bf16_f32 v36, v36, v31
    v_mfma_f32_16x16x32_bf16 v[136:139], v[48:51], v[112:115], v[136:139]
    v_accvgpr_read_b32 v37, a218
    v_accvgpr_read_b32 v31, a219
    v_mfma_f32_16x16x32_bf16 v[136:139], v[52:55], v[116:119], v[136:139]
    v_cvt_pk_bf16_f32 v37, v37, v31
    v_accvgpr_read_b32 v38, a220
    v_mfma_f32_16x16x32_bf16 v[140:143], v[48:51], v[120:123], v[140:143]
    s_add_u32 m0, s68, 8192
    ds_read_b64_tr_b16 v[48:49], v17 offset:0
    ds_read_b64_tr_b16 v[50:51], v17 offset:1024
    v_mfma_f32_16x16x32_bf16 v[140:143], v[52:55], v[124:127], v[140:143]
    buffer_load_dwordx4 v6, s[20:23], s66 offen lds
    v_mfma_f32_16x16x32_bf16 v[144:147], v[56:59], v[96:99], v[144:147]
    ds_read_b64_tr_b16 v[52:53], v17 offset:8192
    ds_read_b64_tr_b16 v[54:55], v17 offset:9216
    v_mfma_f32_16x16x32_bf16 v[144:147], v[60:63], v[100:103], v[144:147]
    s_add_u32 s72, s71, 37888
    v_add_u32 v17, 0x10000, v17
    v_accvgpr_read_b32 v31, a221
    v_mfma_f32_16x16x32_bf16 v[148:151], v[56:59], v[104:107], v[148:151]
    v_cvt_pk_bf16_f32 v38, v38, v31
    v_accvgpr_read_b32 v39, a222
    v_mfma_f32_16x16x32_bf16 v[148:151], v[60:63], v[108:111], v[148:151]
    v_accvgpr_read_b32 v31, a223
    v_cvt_pk_bf16_f32 v39, v39, v31
    v_mfma_f32_16x16x32_bf16 v[152:155], v[56:59], v[112:115], v[152:155]
    v_add_u32 v25, 0x10000, v25
    v_accvgpr_write_b32 a185, 0
    v_mfma_f32_16x16x32_bf16 v[152:155], v[60:63], v[116:119], v[152:155]
    ds_read_b128 v[68:71], v25 offset:16384
    v_accvgpr_write_b32 a186, 0
    v_mfma_f32_16x16x32_bf16 v[156:159], v[56:59], v[120:123], v[156:159]
    s_add_u32 m0, s69, 16384
    ds_read_b64_tr_b16 v[56:57], v18 offset:0
    ds_read_b64_tr_b16 v[58:59], v18 offset:1024
    v_mfma_f32_16x16x32_bf16 v[156:159], v[60:63], v[124:127], v[156:159]
    s_add_u32 s65, s65, 8192
    buffer_load_dwordx4 v10, s[20:23], s64 offen lds
    s_waitcnt lgkmcnt(3)
    v_mfma_f32_16x16x32_bf16 v[160:163], v[40:43], v[96:99], v[160:163]
    s_add_u32 s66, s66, 128
    ds_read_b64_tr_b16 v[60:61], v18 offset:8192
    ds_read_b64_tr_b16 v[62:63], v18 offset:9216
    v_mfma_f32_16x16x32_bf16 v[160:163], v[44:47], v[100:103], v[160:163]
    v_add_u32 v18, 0x10000, v18
    v_accvgpr_write_b32 a187, 0
    v_mfma_f32_16x16x32_bf16 v[164:167], v[40:43], v[104:107], v[164:167]
    buffer_store_dwordx4 v[36:39], v1, s[36:39], s72 offen sc1
    v_mfma_f32_16x16x32_bf16 v[164:167], v[44:47], v[108:111], v[164:167]
    v_accvgpr_write_b32 a188, 0
    v_accvgpr_write_b32 a189, 0
    v_mfma_f32_16x16x32_bf16 v[168:171], v[40:43], v[112:115], v[168:171]
    v_accvgpr_read_b32 v32, a224
    v_accvgpr_read_b32 v31, a225
    v_mfma_f32_16x16x32_bf16 v[168:171], v[44:47], v[116:119], v[168:171]
    v_cvt_pk_bf16_f32 v32, v32, v31
    v_accvgpr_read_b32 v33, a226
    v_mfma_f32_16x16x32_bf16 v[172:175], v[40:43], v[120:123], v[172:175]
    ds_read_b64_tr_b16 v[40:41], v19 offset:0
    ds_read_b64_tr_b16 v[42:43], v19 offset:1024
    v_mfma_f32_16x16x32_bf16 v[172:175], v[44:47], v[124:127], v[172:175]
    ds_read_b64_tr_b16 v[44:45], v19 offset:8192
    ds_read_b64_tr_b16 v[46:47], v19 offset:9216
    v_mfma_f32_16x16x32_bf16 v[176:179], v[48:51], v[96:99], v[176:179]
    buffer_load_dwordx4 v11, s[20:23], s64 offen offset:1024 lds
    v_mfma_f32_16x16x32_bf16 v[176:179], v[52:55], v[100:103], v[176:179]
    ds_read_b128 v[72:75], v24 offset:24576
    v_add_u32 v19, 0x10000, v19
    v_mfma_f32_16x16x32_bf16 v[180:183], v[48:51], v[104:107], v[180:183]
    v_accvgpr_read_b32 v31, a227
    v_cvt_pk_bf16_f32 v33, v33, v31
    v_mfma_f32_16x16x32_bf16 v[180:183], v[52:55], v[108:111], v[180:183]
    v_accvgpr_read_b32 v34, a228
    v_accvgpr_read_b32 v31, a229
    v_mfma_f32_16x16x32_bf16 v[184:187], v[48:51], v[112:115], v[184:187]
    v_cvt_pk_bf16_f32 v34, v34, v31
    v_accvgpr_read_b32 v35, a230
    v_mfma_f32_16x16x32_bf16 v[184:187], v[52:55], v[116:119], v[184:187]
    s_add_u32 s72, s71, 6144
    v_accvgpr_read_b32 v31, a231
    v_cvt_pk_bf16_f32 v35, v35, v31
    v_mfma_f32_16x16x32_bf16 v[188:191], v[48:51], v[120:123], v[188:191]
    ds_read_b64_tr_b16 v[48:49], v20 offset:0
    ds_read_b64_tr_b16 v[50:51], v20 offset:1024
    v_mfma_f32_16x16x32_bf16 v[188:191], v[52:55], v[124:127], v[188:191]
    s_waitcnt lgkmcnt(2)
    ds_read_b64_tr_b16 v[52:53], v20 offset:8192
    ds_read_b64_tr_b16 v[54:55], v20 offset:9216
    v_mfma_f32_16x16x32_bf16 v[192:195], v[56:59], v[96:99], v[192:195]
    buffer_load_dwordx4 v12, s[20:23], s64 offen offset:2048 lds
    v_mfma_f32_16x16x32_bf16 v[192:195], v[60:63], v[100:103], v[192:195]
    v_add_u32 v20, 0x10000, v20
    v_accvgpr_write_b32 a190, 0
    v_mfma_f32_16x16x32_bf16 v[196:199], v[56:59], v[104:107], v[196:199]
    buffer_store_dwordx4 v[32:35], v1, s[36:39], s72 offen sc1
    v_mfma_f32_16x16x32_bf16 v[196:199], v[60:63], v[108:111], v[196:199]
    ds_read_b128 v[76:79], v25 offset:24576
    v_accvgpr_write_b32 a191, 0
    v_mfma_f32_16x16x32_bf16 v[200:203], v[56:59], v[112:115], v[200:203]
    v_accvgpr_write_b32 a192, 0
    v_accvgpr_write_b32 a193, 0
    v_mfma_f32_16x16x32_bf16 v[200:203], v[60:63], v[116:119], v[200:203]
    v_accvgpr_write_b32 a194, 0
    v_accvgpr_write_b32 a195, 0
    v_mfma_f32_16x16x32_bf16 v[204:207], v[56:59], v[120:123], v[204:207]
    ds_read_b64_tr_b16 v[56:57], v21 offset:0
    ds_read_b64_tr_b16 v[58:59], v21 offset:1024
    v_mfma_f32_16x16x32_bf16 v[204:207], v[60:63], v[124:127], v[204:207]
    ds_read_b64_tr_b16 v[60:61], v21 offset:8192
    ds_read_b64_tr_b16 v[62:63], v21 offset:9216
    v_mfma_f32_16x16x32_bf16 v[208:211], v[40:43], v[96:99], v[208:211]
    v_add_u32 v21, 0x10000, v21
    v_accvgpr_read_b32 v36, a232
    v_mfma_f32_16x16x32_bf16 v[208:211], v[44:47], v[100:103], v[208:211]
    buffer_load_dwordx4 v13, s[20:23], s64 offen offset:3072 lds
    v_mfma_f32_16x16x32_bf16 v[212:215], v[40:43], v[104:107], v[212:215]
    v_accvgpr_read_b32 v31, a233
    v_cvt_pk_bf16_f32 v36, v36, v31
    v_mfma_f32_16x16x32_bf16 v[212:215], v[44:47], v[108:111], v[212:215]
    v_accvgpr_read_b32 v37, a234
    v_accvgpr_read_b32 v31, a235
    v_mfma_f32_16x16x32_bf16 v[216:219], v[40:43], v[112:115], v[216:219]
    v_cvt_pk_bf16_f32 v37, v37, v31
    v_accvgpr_read_b32 v38, a236
    v_mfma_f32_16x16x32_bf16 v[216:219], v[44:47], v[116:119], v[216:219]
    v_accvgpr_read_b32 v31, a237
    v_cvt_pk_bf16_f32 v38, v38, v31
    v_mfma_f32_16x16x32_bf16 v[220:223], v[40:43], v[120:123], v[220:223]
    v_accvgpr_read_b32 v39, a238
    v_accvgpr_read_b32 v31, a239
    v_mfma_f32_16x16x32_bf16 v[220:223], v[44:47], v[124:127], v[220:223]
    s_waitcnt lgkmcnt(0)
    v_cvt_pk_bf16_f32 v39, v39, v31
    v_accvgpr_write_b32 a196, 0
    v_mfma_f32_16x16x32_bf16 v[224:227], v[48:51], v[96:99], v[224:227]
    v_accvgpr_write_b32 a197, 0
    v_accvgpr_write_b32 a198, 0
    v_mfma_f32_16x16x32_bf16 v[224:227], v[52:55], v[100:103], v[224:227]
    s_add_u32 s64, s64, 128
    v_accvgpr_write_b32 a199, 0
    v_accvgpr_write_b32 a200, 0
    v_mfma_f32_16x16x32_bf16 v[228:231], v[48:51], v[104:107], v[228:231]
    s_add_u32 s72, s71, 7168
    buffer_store_dwordx4 v[36:39], v1, s[36:39], s72 offen sc1
    v_mfma_f32_16x16x32_bf16 v[228:231], v[52:55], v[108:111], v[228:231]
    v_accvgpr_write_b32 a201, 0
    v_accvgpr_write_b32 a202, 0
    v_mfma_f32_16x16x32_bf16 v[232:235], v[48:51], v[112:115], v[232:235]
    v_accvgpr_write_b32 a203, 0
    v_accvgpr_write_b32 a204, 0
    v_mfma_f32_16x16x32_bf16 v[232:235], v[52:55], v[116:119], v[232:235]
    s_waitcnt vmcnt(21)
    s_barrier
    ds_read_b64_tr_b16 v[40:41], v26 offset:32768
    v_mfma_f32_16x16x32_bf16 v[236:239], v[48:51], v[120:123], v[236:239]
    s_add_u32 m0, s69, 32768
    ds_read_b64_tr_b16 v[42:43], v26 offset:33280
    ds_read_b64_tr_b16 v[44:45], v26 offset:36864
    v_mfma_f32_16x16x32_bf16 v[236:239], v[52:55], v[124:127], v[236:239]
    buffer_load_dwordx4 v2, s[24:27], s60 offen lds
    v_mfma_f32_16x16x32_bf16 v[240:243], v[56:59], v[96:99], v[240:243]
    ds_read_b64_tr_b16 v[46:47], v26 offset:37376
    ds_read_b128 a[136:139], v22 offset:32768
    v_mfma_f32_16x16x32_bf16 v[240:243], v[60:63], v[100:103], v[240:243]
    ds_read_b128 a[140:143], v23 offset:32768
    ds_read_b64_tr_b16 v[48:49], v27 offset:32768
    v_mfma_f32_16x16x32_bf16 v[244:247], v[56:59], v[104:107], v[244:247]
    buffer_load_dwordx4 v3, s[24:27], s60 offen offset:1024 lds
    v_mfma_f32_16x16x32_bf16 v[244:247], v[60:63], v[108:111], v[244:247]
    ds_read_b64_tr_b16 v[50:51], v27 offset:33280
    ds_read_b64_tr_b16 v[52:53], v27 offset:36864
    v_mfma_f32_16x16x32_bf16 v[248:251], v[56:59], v[112:115], v[248:251]
    ds_read_b64_tr_b16 v[54:55], v27 offset:37376
    v_add_u32 v26, 0xffff0000, v26
    v_mfma_f32_16x16x32_bf16 v[248:251], v[60:63], v[116:119], v[248:251]
    v_add_u32 v22, 0xffff0000, v22
    v_add_u32 v23, 0xffff0000, v23
    v_mfma_f32_16x16x32_bf16 v[252:255], v[56:59], v[120:123], v[252:255]
    buffer_load_dwordx4 v4, s[24:27], s60 offen offset:2048 lds
    v_mfma_f32_16x16x32_bf16 v[252:255], v[60:63], v[124:127], v[252:255]
    s_waitcnt lgkmcnt(3)
    ds_read_b64_tr_b16 v[56:57], v28 offset:32768
    ds_read_b64_tr_b16 v[58:59], v28 offset:33280
    v_mfma_f32_16x16x32_bf16 a[64:67], v[40:43], v[96:99], a[64:67]
    ds_read_b64_tr_b16 v[60:61], v28 offset:36864
    ds_read_b64_tr_b16 v[62:63], v28 offset:37376
    v_mfma_f32_16x16x32_bf16 a[64:67], v[44:47], v[100:103], a[64:67]
    v_add_u32 v27, 0xffff0000, v27
    v_add_u32 v28, 0xffff0000, v28
    v_mfma_f32_16x16x32_bf16 a[68:71], v[40:43], v[104:107], a[68:71]
    buffer_load_dwordx4 v5, s[24:27], s60 offen offset:3072 lds
    v_mfma_f32_16x16x32_bf16 a[68:71], v[44:47], v[108:111], a[68:71]
    ds_read_b128 v[80:83], v24 offset:49152
    v_accvgpr_read_b32 v32, a240
    v_mfma_f32_16x16x32_bf16 a[72:75], v[40:43], v[112:115], a[72:75]
    v_accvgpr_read_b32 v31, a241
    v_cvt_pk_bf16_f32 v32, v32, v31
    v_mfma_f32_16x16x32_bf16 a[72:75], v[44:47], v[116:119], a[72:75]
    s_add_u32 m0, s69, 49152
    v_accvgpr_read_b32 v33, a242
    v_accvgpr_read_b32 v31, a243
    v_mfma_f32_16x16x32_bf16 a[76:79], v[40:43], v[120:123], a[76:79]
    s_add_u32 s60, s60, 524288
    buffer_load_dwordx4 v10, s[20:23], s63 offen lds
    v_mfma_f32_16x16x32_bf16 a[76:79], v[44:47], v[124:127], a[76:79]
    s_add_u32 s72, s71, 38912
    ds_read_b128 v[84:87], v25 offset:49152
    v_cvt_pk_bf16_f32 v33, v33, v31
    v_mfma_f32_16x16x32_bf16 a[128:131], v[40:43], a[136:139], a[128:131]
    ds_read_b64_tr_b16 v[40:41], v29 offset:32768
    ds_read_b64_tr_b16 v[42:43], v29 offset:33280
    v_mfma_f32_16x16x32_bf16 a[128:131], v[44:47], a[140:143], a[128:131]
    s_waitcnt lgkmcnt(3)
    ds_read_b64_tr_b16 v[44:45], v29 offset:36864
    ds_read_b64_tr_b16 v[46:47], v29 offset:37376
    v_mfma_f32_16x16x32_bf16 a[80:83], v[48:51], v[96:99], a[80:83]
    buffer_load_dwordx4 v11, s[20:23], s63 offen offset:1024 lds
    v_mfma_f32_16x16x32_bf16 a[80:83], v[52:55], v[100:103], a[80:83]
    ds_read_b128 v[88:91], v24 offset:57344
    v_add_u32 v29, 0xffff0000, v29
    v_mfma_f32_16x16x32_bf16 a[84:87], v[48:51], v[104:107], a[84:87]
    v_accvgpr_read_b32 v34, a244
    v_accvgpr_read_b32 v31, a245
    v_mfma_f32_16x16x32_bf16 a[84:87], v[52:55], v[108:111], a[84:87]
    v_cvt_pk_bf16_f32 v34, v34, v31
    v_accvgpr_read_b32 v35, a246
    v_mfma_f32_16x16x32_bf16 a[88:91], v[48:51], v[112:115], a[88:91]
    buffer_load_dwordx4 v12, s[20:23], s63 offen offset:2048 lds
    v_mfma_f32_16x16x32_bf16 a[88:91], v[52:55], v[116:119], a[88:91]
    ds_read_b128 v[92:95], v25 offset:57344
    v_accvgpr_read_b32 v31, a247
    v_mfma_f32_16x16x32_bf16 a[92:95], v[48:51], v[120:123], a[92:95]
    v_cvt_pk_bf16_f32 v35, v35, v31
    v_accvgpr_read_b32 v36, a248
    v_mfma_f32_16x16x32_bf16 a[92:95], v[52:55], v[124:127], a[92:95]
    buffer_store_dwordx4 v[32:35], v1, s[36:39], s72 offen sc1
    v_mfma_f32_16x16x32_bf16 a[132:135], v[48:51], a[136:139], a[132:135]
    buffer_load_dwordx4 v13, s[20:23], s63 offen offset:3072 lds
    v_mfma_f32_16x16x32_bf16 a[132:135], v[52:55], a[140:143], a[132:135]
    v_accvgpr_read_b32 v31, a249
    v_cvt_pk_bf16_f32 v36, v36, v31
    v_mfma_f32_16x16x32_bf16 a[96:99], v[56:59], v[96:99], a[96:99]
    v_accvgpr_read_b32 v37, a250
    v_accvgpr_read_b32 v31, a251
    v_mfma_f32_16x16x32_bf16 a[96:99], v[60:63], v[100:103], a[96:99]
    s_add_u32 s63, s63, 128
    v_cvt_pk_bf16_f32 v37, v37, v31
    v_accvgpr_read_b32 v38, a252
    v_mfma_f32_16x16x32_bf16 a[100:103], v[56:59], v[104:107], a[100:103]
    v_accvgpr_read_b32 v31, a253
    v_cvt_pk_bf16_f32 v38, v38, v31
    v_mfma_f32_16x16x32_bf16 a[100:103], v[60:63], v[108:111], a[100:103]
    v_accvgpr_read_b32 v39, a254
    v_accvgpr_read_b32 v31, a255
    v_mfma_f32_16x16x32_bf16 a[104:107], v[56:59], v[112:115], a[104:107]
    v_cvt_pk_bf16_f32 v39, v39, v31
    v_mov_b32 v31, 1
    v_mfma_f32_16x16x32_bf16 a[104:107], v[60:63], v[116:119], a[104:107]
    s_waitcnt vmcnt(20)
    s_barrier
    ds_read_b64_tr_b16 v[48:49], v14 offset:0
    v_mfma_f32_16x16x32_bf16 a[108:111], v[56:59], v[120:123], a[108:111]
    s_add_u32 m0, s67, 65536
    ds_read_b64_tr_b16 v[50:51], v14 offset:1024
    ds_read_b64_tr_b16 v[52:53], v14 offset:8192
    v_mfma_f32_16x16x32_bf16 a[108:111], v[60:63], v[124:127], a[108:111]
    s_add_u32 s72, s71, 39936
    buffer_load_dwordx4 v1, s[28:31], s65 offen sc1 lds
    s_waitcnt lgkmcnt(3)
    v_mfma_f32_16x16x32_bf16 a[112:115], v[40:43], v[96:99], a[112:115]
    s_add_u32 s71, s70, 16384
    ds_read_b64_tr_b16 v[54:55], v14 offset:9216
    ds_read_b64_tr_b16 v[56:57], v15 offset:0
    v_mfma_f32_16x16x32_bf16 a[112:115], v[44:47], v[100:103], a[112:115]
    s_add_u32 s70, s70, s69
    ds_read_b64_tr_b16 v[58:59], v15 offset:1024
    ds_read_b64_tr_b16 v[60:61], v15 offset:8192
    v_mfma_f32_16x16x32_bf16 a[116:119], v[40:43], v[104:107], a[116:119]
    ds_read_b64_tr_b16 v[62:63], v15 offset:9216
    v_add_u32 v14, 0xfffe0000, v14
    v_mfma_f32_16x16x32_bf16 a[116:119], v[44:47], v[108:111], a[116:119]
    v_add_u32 v15, 0xfffe0000, v15
    v_lshrrev_b32 v32, 7, v1
    v_mfma_f32_16x16x32_bf16 a[120:123], v[40:43], v[112:115], a[120:123]
    buffer_store_dwordx4 v[36:39], v1, s[36:39], s72 offen sc1
    v_mfma_f32_16x16x32_bf16 a[120:123], v[44:47], v[116:119], a[120:123]
    s_add_u32 s72, s7, 128
    v_mul_u32_u24 v32, 1152, v32
    v_and_b32 v33, 0x70, v1
    v_mfma_f32_16x16x32_bf16 a[124:127], v[40:43], v[120:123], a[124:127]
    s_mul_i32 s72, s72, 36
    buffer_load_dwordx4 v1, s[28:31], s65 offen offset:1024 sc1 lds
    v_mfma_f32_16x16x32_bf16 a[124:127], v[44:47], v[124:127], a[124:127]
    s_add_u32 s72, s72, s3
    ds_read_b64_tr_b16 v[40:41], v16 offset:0
    ds_read_b64_tr_b16 v[42:43], v16 offset:1024
    s_waitcnt lgkmcnt(2)
    v_mfma_f32_16x16x32_bf16 v[128:131], v[48:51], v[64:67], v[128:131]
    s_lshl_b32 s3, s3, 5
    ds_read_b64_tr_b16 v[44:45], v16 offset:8192
    ds_read_b64_tr_b16 v[46:47], v16 offset:9216
    v_mfma_f32_16x16x32_bf16 v[128:131], v[52:55], v[68:71], v[128:131]
    s_lshl_b32 s72, s72, 10
    v_add_u32 v24, 0x10000, v24
    v_add_u32 v16, 0xfffe0000, v16
    v_mfma_f32_16x16x32_bf16 v[132:135], v[48:51], v[72:75], v[132:135]
    ds_read_b128 v[96:99], v24 offset:16384
    v_add3_u32 v32, v32, v33, s99
    v_mfma_f32_16x16x32_bf16 v[132:135], v[52:55], v[76:79], v[132:135]
    v_bfe_u32 v33, v1, 6, 2
    v_accvgpr_write_b32 a205, 0
    v_mfma_f32_16x16x32_bf16 v[136:139], v[48:51], v[80:83], v[136:139]
    s_cmp_eq_u32 s4, 0
    s_cselect_b32 s71, s71, s72
    v_accvgpr_write_b32 a206, 0
    v_mfma_f32_16x16x32_bf16 v[136:139], v[52:55], v[84:87], v[136:139]
    v_accvgpr_write_b32 a207, 0
    v_accvgpr_write_b32 a208, 0
    v_mfma_f32_16x16x32_bf16 v[140:143], v[48:51], v[88:91], v[140:143]
    s_add_u32 m0, s68, 73728
    ds_read_b64_tr_b16 v[48:49], v17 offset:0
    ds_read_b64_tr_b16 v[50:51], v17 offset:1024
    v_mfma_f32_16x16x32_bf16 v[140:143], v[52:55], v[92:95], v[140:143]
    buffer_load_dwordx4 v6, s[20:23], s66 offen lds
    v_mfma_f32_16x16x32_bf16 v[144:147], v[56:59], v[64:67], v[144:147]
    ds_read_b64_tr_b16 v[52:53], v17 offset:8192
    ds_read_b64_tr_b16 v[54:55], v17 offset:9216
    v_mfma_f32_16x16x32_bf16 v[144:147], v[60:63], v[68:71], v[144:147]
    v_add_u32 v17, 0xfffe0000, v17
    v_accvgpr_write_b32 a209, 0
    v_mfma_f32_16x16x32_bf16 v[148:151], v[56:59], v[72:75], v[148:151]
    v_accvgpr_write_b32 a210, 0
    v_accvgpr_write_b32 a211, 0
    v_mfma_f32_16x16x32_bf16 v[148:151], v[60:63], v[76:79], v[148:151]
    v_accvgpr_write_b32 a212, 0
    v_accvgpr_write_b32 a213, 0
    v_mfma_f32_16x16x32_bf16 v[152:155], v[56:59], v[80:83], v[152:155]
    v_add_u32 v25, 0x10000, v25
    v_accvgpr_write_b32 a214, 0
    v_mfma_f32_16x16x32_bf16 v[152:155], v[60:63], v[84:87], v[152:155]
    ds_read_b128 v[100:103], v25 offset:16384
    v_accvgpr_write_b32 a215, 0
    v_mfma_f32_16x16x32_bf16 v[156:159], v[56:59], v[88:91], v[156:159]
    s_add_u32 m0, s69, 81920
    ds_read_b64_tr_b16 v[56:57], v18 offset:0
    ds_read_b64_tr_b16 v[58:59], v18 offset:1024
    v_mfma_f32_16x16x32_bf16 v[156:159], v[60:63], v[92:95], v[156:159]
    s_add_u32 s65, s65, 8192
    buffer_load_dwordx4 v10, s[20:23], s64 offen lds
    s_waitcnt lgkmcnt(3)
    v_mfma_f32_16x16x32_bf16 v[160:163], v[40:43], v[64:67], v[160:163]
    s_add_u32 s66, s66, 128
    ds_read_b64_tr_b16 v[60:61], v18 offset:8192
    ds_read_b64_tr_b16 v[62:63], v18 offset:9216
    v_mfma_f32_16x16x32_bf16 v[160:163], v[44:47], v[68:71], v[160:163]
    v_add_u32 v18, 0xfffe0000, v18
    v_add_u32 v10, 0, v32
    v_mfma_f32_16x16x32_bf16 v[164:167], v[40:43], v[72:75], v[164:167]
    v_accvgpr_write_b32 a216, 0
    v_accvgpr_write_b32 a217, 0
    v_mfma_f32_16x16x32_bf16 v[164:167], v[44:47], v[76:79], v[164:167]
    v_accvgpr_write_b32 a218, 0
    v_accvgpr_write_b32 a219, 0
    v_mfma_f32_16x16x32_bf16 v[168:171], v[40:43], v[80:83], v[168:171]
    v_accvgpr_write_b32 a220, 0
    v_accvgpr_write_b32 a221, 0
    v_mfma_f32_16x16x32_bf16 v[168:171], v[44:47], v[84:87], v[168:171]
    v_accvgpr_write_b32 a222, 0
    v_accvgpr_write_b32 a223, 0
    v_mfma_f32_16x16x32_bf16 v[172:175], v[40:43], v[88:91], v[172:175]
    ds_read_b64_tr_b16 v[40:41], v19 offset:0
    ds_read_b64_tr_b16 v[42:43], v19 offset:1024
    v_mfma_f32_16x16x32_bf16 v[172:175], v[44:47], v[92:95], v[172:175]
    ds_read_b64_tr_b16 v[44:45], v19 offset:8192
    ds_read_b64_tr_b16 v[46:47], v19 offset:9216
    v_mfma_f32_16x16x32_bf16 v[176:179], v[48:51], v[64:67], v[176:179]
    buffer_load_dwordx4 v11, s[20:23], s64 offen offset:1024 lds
    v_mfma_f32_16x16x32_bf16 v[176:179], v[52:55], v[68:71], v[176:179]
    ds_read_b128 v[104:107], v24 offset:24576
    v_add_u32 v19, 0xfffe0000, v19
    v_mfma_f32_16x16x32_bf16 v[180:183], v[48:51], v[72:75], v[180:183]
    v_add_u32 v11, 8192, v32
    v_mfma_f32_16x16x32_bf16 v[180:183], v[52:55], v[76:79], v[180:183]
    v_mfma_f32_16x16x32_bf16 v[184:187], v[48:51], v[80:83], v[184:187]
    v_mfma_f32_16x16x32_bf16 v[184:187], v[52:55], v[84:87], v[184:187]
    v_mfma_f32_16x16x32_bf16 v[188:191], v[48:51], v[88:91], v[188:191]
    ds_read_b64_tr_b16 v[48:49], v20 offset:0
    ds_read_b64_tr_b16 v[50:51], v20 offset:1024
    v_mfma_f32_16x16x32_bf16 v[188:191], v[52:55], v[92:95], v[188:191]
    s_waitcnt lgkmcnt(2)
    ds_read_b64_tr_b16 v[52:53], v20 offset:8192
    ds_read_b64_tr_b16 v[54:55], v20 offset:9216
    v_mfma_f32_16x16x32_bf16 v[192:195], v[56:59], v[64:67], v[192:195]
    buffer_load_dwordx4 v12, s[20:23], s64 offen offset:2048 lds
    v_mfma_f32_16x16x32_bf16 v[192:195], v[60:63], v[68:71], v[192:195]
    v_add_u32 v20, 0xfffe0000, v20
    v_add_u32 v12, 16384, v32
    v_mfma_f32_16x16x32_bf16 v[196:199], v[56:59], v[72:75], v[196:199]
    v_mfma_f32_16x16x32_bf16 v[196:199], v[60:63], v[76:79], v[196:199]
    ds_read_b128 v[108:111], v25 offset:24576
    v_mfma_f32_16x16x32_bf16 v[200:203], v[56:59], v[80:83], v[200:203]
    v_mfma_f32_16x16x32_bf16 v[200:203], v[60:63], v[84:87], v[200:203]
    v_mfma_f32_16x16x32_bf16 v[204:207], v[56:59], v[88:91], v[204:207]
    ds_read_b64_tr_b16 v[56:57], v21 offset:0
    ds_read_b64_tr_b16 v[58:59], v21 offset:1024
    v_mfma_f32_16x16x32_bf16 v[204:207], v[60:63], v[92:95], v[204:207]
    ds_read_b64_tr_b16 v[60:61], v21 offset:8192
    ds_read_b64_tr_b16 v[62:63], v21 offset:9216
    v_mfma_f32_16x16x32_bf16 v[208:211], v[40:43], v[64:67], v[208:211]
    v_add_u32 v21, 0xfffe0000, v21
    v_mfma_f32_16x16x32_bf16 v[208:211], v[44:47], v[68:71], v[208:211]
    buffer_load_dwordx4 v13, s[20:23], s64 offen offset:3072 lds
    v_mfma_f32_16x16x32_bf16 v[212:215], v[40:43], v[72:75], v[212:215]
    v_add_u32 v13, 24576, v32
    v_lshrrev_b32 v32, 8, v1
    v_mfma_f32_16x16x32_bf16 v[212:215], v[44:47], v[76:79], v[212:215]
    v_lshl_add_u32 v32, s7, 2, v32
    v_lshrrev_b32 v34, 1, v32
    v_mfma_f32_16x16x32_bf16 v[216:219], v[40:43], v[80:83], v[216:219]
    s_sub_u32 s7, 33, s6
    v_mul_u32_u24 v34, 18, v34
    v_and_b32 v35, 1, v32
    v_mfma_f32_16x16x32_bf16 v[216:219], v[44:47], v[84:87], v[216:219]
    s_sub_u32 s7, s7, s6
    v_lshl_add_u32 v34, v35, 3, v34
    v_lshrrev_b32 v35, 1, v33
    v_mfma_f32_16x16x32_bf16 v[220:223], v[40:43], v[88:91], v[220:223]
    v_lshl_add_u32 v35, v32, 2, v35
    v_add_u32 v35, 0xffffff00, v35
    v_mfma_f32_16x16x32_bf16 v[220:223], v[44:47], v[92:95], v[220:223]
    s_waitcnt lgkmcnt(0)
    v_mul_u32_u24 v35, 18, v35
    v_add3_u32 v34, v34, v33, 0
    v_mfma_f32_16x16x32_bf16 v[224:227], v[48:51], v[64:67], v[224:227]
    v_cmp_gt_u32 vcc, 64, v32
    v_mfma_f32_16x16x32_bf16 v[224:227], v[52:55], v[68:71], v[224:227]
    s_add_u32 s64, s64, 128
    v_mfma_f32_16x16x32_bf16 v[228:231], v[48:51], v[72:75], v[228:231]
    v_mfma_f32_16x16x32_bf16 v[228:231], v[52:55], v[76:79], v[228:231]
    v_mfma_f32_16x16x32_bf16 v[232:235], v[48:51], v[80:83], v[232:235]
    v_mfma_f32_16x16x32_bf16 v[232:235], v[52:55], v[84:87], v[232:235]
    s_waitcnt vmcnt(18)
    s_barrier
    ds_read_b64_tr_b16 v[40:41], v26 offset:0
    v_mfma_f32_16x16x32_bf16 v[236:239], v[48:51], v[88:91], v[236:239]
    s_add_u32 m0, s69, 98304
    ds_read_b64_tr_b16 v[42:43], v26 offset:512
    ds_read_b64_tr_b16 v[44:45], v26 offset:4096
    v_mfma_f32_16x16x32_bf16 v[236:239], v[52:55], v[92:95], v[236:239]
    buffer_load_dwordx4 v2, s[24:27], s60 offen lds
    v_mfma_f32_16x16x32_bf16 v[240:243], v[56:59], v[64:67], v[240:243]
    ds_read_b64_tr_b16 v[46:47], v26 offset:4608
    ds_read_b128 a[136:139], v22 offset:0
    v_mfma_f32_16x16x32_bf16 v[240:243], v[60:63], v[68:71], v[240:243]
    ds_read_b128 a[140:143], v23 offset:0
    ds_read_b64_tr_b16 v[48:49], v27 offset:0
    v_mfma_f32_16x16x32_bf16 v[244:247], v[56:59], v[72:75], v[244:247]
    buffer_load_dwordx4 v3, s[24:27], s60 offen offset:1024 lds
    v_mfma_f32_16x16x32_bf16 v[244:247], v[60:63], v[76:79], v[244:247]
    ds_read_b64_tr_b16 v[50:51], v27 offset:512
    ds_read_b64_tr_b16 v[52:53], v27 offset:4096
    v_mfma_f32_16x16x32_bf16 v[248:251], v[56:59], v[80:83], v[248:251]
    ds_read_b64_tr_b16 v[54:55], v27 offset:4608
    v_add_u32 v26, 0x10000, v26
    v_mfma_f32_16x16x32_bf16 v[248:251], v[60:63], v[84:87], v[248:251]
    v_add_u32 v22, 0x10000, v22
    v_add_u32 v23, 0x10000, v23
    v_mfma_f32_16x16x32_bf16 v[252:255], v[56:59], v[88:91], v[252:255]
    buffer_load_dwordx4 v4, s[24:27], s60 offen offset:2048 lds
    v_mfma_f32_16x16x32_bf16 v[252:255], v[60:63], v[92:95], v[252:255]
    s_waitcnt lgkmcnt(3)
    ds_read_b64_tr_b16 v[56:57], v28 offset:0
    ds_read_b64_tr_b16 v[58:59], v28 offset:512
    v_mfma_f32_16x16x32_bf16 a[64:67], v[40:43], v[64:67], a[64:67]
    ds_read_b64_tr_b16 v[60:61], v28 offset:4096
    ds_read_b64_tr_b16 v[62:63], v28 offset:4608
    v_mfma_f32_16x16x32_bf16 a[64:67], v[44:47], v[68:71], a[64:67]
    v_add_u32 v24, 0xfffe0000, v24
    v_add_u32 v27, 0x10000, v27
    v_mfma_f32_16x16x32_bf16 a[68:71], v[40:43], v[72:75], a[68:71]
    buffer_load_dwordx4 v5, s[24:27], s60 offen offset:3072 lds
    v_mfma_f32_16x16x32_bf16 a[68:71], v[44:47], v[76:79], a[68:71]
    ds_read_b128 v[112:115], v24 offset:16384
    v_add_u32 v28, 0x10000, v28
    v_mfma_f32_16x16x32_bf16 a[72:75], v[40:43], v[80:83], a[72:75]
    v_and_b32 v2, 1, v33
    v_add3_u32 v35, v35, v2, 16
    v_mfma_f32_16x16x32_bf16 a[72:75], v[44:47], v[84:87], a[72:75]
    s_add_u32 m0, s69, 114688
    v_add_u32 v25, 0xfffe0000, v25
    v_cndmask_b32 v34, v35, v34, vcc
    v_mfma_f32_16x16x32_bf16 a[76:79], v[40:43], v[88:91], a[76:79]
    s_add_u32 s60, s60, 524288
    buffer_load_dwordx4 v10, s[48:51], 0 offen lds
    v_mfma_f32_16x16x32_bf16 a[76:79], v[44:47], v[92:95], a[76:79]
    ds_read_b128 v[116:119], v25 offset:16384
    v_lshrrev_b32 v35, 6, v1
    v_mfma_f32_16x16x32_bf16 a[128:131], v[40:43], a[136:139], a[128:131]
    ds_read_b64_tr_b16 v[40:41], v29 offset:0
    ds_read_b64_tr_b16 v[42:43], v29 offset:512
    v_mfma_f32_16x16x32_bf16 a[128:131], v[44:47], a[140:143], a[128:131]
    s_waitcnt lgkmcnt(3)
    ds_read_b64_tr_b16 v[44:45], v29 offset:4096
    ds_read_b64_tr_b16 v[46:47], v29 offset:4608
    v_mfma_f32_16x16x32_bf16 a[80:83], v[48:51], v[64:67], a[80:83]
    buffer_load_dwordx4 v11, s[48:51], 0 offen offset:1024 lds
    v_mfma_f32_16x16x32_bf16 a[80:83], v[52:55], v[68:71], a[80:83]
    ds_read_b128 v[120:123], v24 offset:24576
    v_add_u32 v29, 0x10000, v29
    v_mfma_f32_16x16x32_bf16 a[84:87], v[48:51], v[72:75], a[84:87]
    v_mul_u32_u24 v35, 1152, v35
    v_mul_u32_u24 v34, 1152, v34
    v_mfma_f32_16x16x32_bf16 a[84:87], v[52:55], v[76:79], a[84:87]
    v_add_u32 v35, s98, v35
    v_add_u32 v34, s3, v34
    v_mfma_f32_16x16x32_bf16 a[88:91], v[48:51], v[80:83], a[88:91]
    buffer_load_dwordx4 v12, s[48:51], 0 offen offset:2048 lds
    v_mfma_f32_16x16x32_bf16 a[88:91], v[52:55], v[84:87], a[88:91]
    ds_read_b128 v[124:127], v25 offset:24576
    v_add_u32 v35, 512, v35
    v_mfma_f32_16x16x32_bf16 a[92:95], v[48:51], v[88:91], a[92:95]
    s_cmp_eq_u32 s4, 0
    s_cselect_b64 vcc, -1, 0
    v_cndmask_b32 v34, v34, v35, vcc
    v_mfma_f32_16x16x32_bf16 a[92:95], v[52:55], v[92:95], a[92:95]
    v_and_b32 v35, 0x30, v1
    v_add_u32 v2, v34, v35
    v_mfma_f32_16x16x32_bf16 a[132:135], v[48:51], a[136:139], a[132:135]
    buffer_load_dwordx4 v13, s[48:51], 0 offen offset:3072 lds
    v_mfma_f32_16x16x32_bf16 a[132:135], v[52:55], a[140:143], a[132:135]
    v_lshrrev_b32 v34, 1, v32
    v_mul_u32_u24 v34, 18, v34
    v_mfma_f32_16x16x32_bf16 a[96:99], v[56:59], v[64:67], a[96:99]
    v_and_b32 v35, 1, v32
    v_lshl_add_u32 v34, v35, 3, v34
    v_mfma_f32_16x16x32_bf16 a[96:99], v[60:63], v[68:71], a[96:99]
    v_lshrrev_b32 v35, 1, v33
    v_lshl_add_u32 v35, v32, 2, v35
    v_mfma_f32_16x16x32_bf16 a[100:103], v[56:59], v[72:75], a[100:103]
    v_add_u32 v35, 0xffffff02, v35
    v_mul_u32_u24 v35, 18, v35
    v_mfma_f32_16x16x32_bf16 a[100:103], v[60:63], v[76:79], a[100:103]
    v_and_b32 v3, 1, v33
    v_add3_u32 v34, v34, v33, 4
    v_mfma_f32_16x16x32_bf16 a[104:107], v[56:59], v[80:83], a[104:107]
    v_add3_u32 v35, v35, v3, 16
    v_cmp_gt_u32 vcc, 64, v32
    v_mfma_f32_16x16x32_bf16 a[104:107], v[60:63], v[84:87], a[104:107]
    s_waitcnt vmcnt(16)
    s_barrier
    ds_read_b64_tr_b16 v[48:49], v14 offset:32768
    v_mfma_f32_16x16x32_bf16 a[108:111], v[56:59], v[88:91], a[108:111]
    s_add_u32 m0, s67, 131072
    ds_read_b64_tr_b16 v[50:51], v14 offset:33792
    ds_read_b64_tr_b16 v[52:53], v14 offset:40960
    v_mfma_f32_16x16x32_bf16 a[108:111], v[60:63], v[92:95], a[108:111]
    s_waitcnt lgkmcnt(3)
    buffer_load_dwordx4 v1, s[28:31], s65 offen sc1 lds
    v_mfma_f32_16x16x32_bf16 a[112:115], v[40:43], v[64:67], a[112:115]
    ds_read_b64_tr_b16 v[54:55], v14 offset:41984
    ds_read_b64_tr_b16 v[56:57], v15 offset:32768
    v_mfma_f32_16x16x32_bf16 a[112:115], v[44:47], v[68:71], a[112:115]
    ds_read_b64_tr_b16 v[58:59], v15 offset:33792
    ds_read_b64_tr_b16 v[60:61], v15 offset:40960
    v_mfma_f32_16x16x32_bf16 a[116:119], v[40:43], v[72:75], a[116:119]
    ds_read_b64_tr_b16 v[62:63], v15 offset:41984
    v_add_u32 v14, 0x10000, v14
    v_mfma_f32_16x16x32_bf16 a[116:119], v[44:47], v[76:79], a[116:119]
    v_add_u32 v15, 0x10000, v15
    v_cndmask_b32 v34, v35, v34, vcc
    v_mfma_f32_16x16x32_bf16 a[120:123], v[40:43], v[80:83], a[120:123]
    v_lshrrev_b32 v35, 6, v1
    v_mul_u32_u24 v35, 1152, v35
    v_mfma_f32_16x16x32_bf16 a[120:123], v[44:47], v[84:87], a[120:123]
    v_mul_u32_u24 v34, 1152, v34
    v_add_u32 v35, s98, v35
    v_mfma_f32_16x16x32_bf16 a[124:127], v[40:43], v[88:91], a[124:127]
    ds_read_b64_tr_b16 v[40:41], v16 offset:32768
    ds_read_b64_tr_b16 v[42:43], v16 offset:33792
    v_mfma_f32_16x16x32_bf16 a[124:127], v[44:47], v[92:95], a[124:127]
    s_waitcnt lgkmcnt(2)
    ds_read_b64_tr_b16 v[44:45], v16 offset:40960
    ds_read_b64_tr_b16 v[46:47], v16 offset:41984
    v_mfma_f32_16x16x32_bf16 v[128:131], v[48:51], v[96:99], v[128:131]
    v_add_u32 v16, 0x10000, v16
    v_add_u32 v34, s3, v34
    v_mfma_f32_16x16x32_bf16 v[128:131], v[52:55], v[100:103], v[128:131]
    v_add_u32 v35, 18944, v35
    v_bfe_u32 v33, v1, 4, 2
    v_mfma_f32_16x16x32_bf16 v[132:135], v[48:51], v[104:107], v[132:135]
    buffer_load_dwordx4 v1, s[28:31], s65 offen offset:1024 sc1 lds
    v_mfma_f32_16x16x32_bf16 v[132:135], v[52:55], v[108:111], v[132:135]
    ds_read_b128 v[64:67], v24 offset:49152
    v_lshlrev_b32 v33, 3, v33
    v_mfma_f32_16x16x32_bf16 v[136:139], v[48:51], v[112:115], v[136:139]
    s_cmp_eq_u32 s4, 0
    s_cselect_b64 vcc, -1, 0
    v_cndmask_b32 v34, v34, v35, vcc
    v_mfma_f32_16x16x32_bf16 v[136:139], v[52:55], v[116:119], v[136:139]
    v_and_b32 v35, 0x30, v1
    v_add_u32 v3, v34, v35
    v_mfma_f32_16x16x32_bf16 v[140:143], v[48:51], v[120:123], v[140:143]
    ds_read_b64_tr_b16 v[48:49], v17 offset:32768
    ds_read_b64_tr_b16 v[50:51], v17 offset:33792
    v_mfma_f32_16x16x32_bf16 v[140:143], v[52:55], v[124:127], v[140:143]
    ds_read_b64_tr_b16 v[52:53], v17 offset:40960
    ds_read_b64_tr_b16 v[54:55], v17 offset:41984
    v_mfma_f32_16x16x32_bf16 v[144:147], v[56:59], v[96:99], v[144:147]
    v_add_u32 v17, 0x10000, v17
    v_lshrrev_b32 v32, 6, v1
    v_mfma_f32_16x16x32_bf16 v[144:147], v[60:63], v[100:103], v[144:147]
    v_add_u32 v33, s69, v33
    v_lshl_add_u32 v4, v32, 7, v33
    v_mfma_f32_16x16x32_bf16 v[148:151], v[56:59], v[104:107], v[148:151]
    v_add_u32 v4, 0x10000, v4
    v_lshl_add_u32 v5, v32, 6, v33
    v_mfma_f32_16x16x32_bf16 v[148:151], v[60:63], v[108:111], v[148:151]
    v_add_u32 v5, 0x20000, v5
    v_mfma_f32_16x16x32_bf16 v[152:155], v[56:59], v[112:115], v[152:155]
    v_mfma_f32_16x16x32_bf16 v[152:155], v[60:63], v[116:119], v[152:155]
    s_add_u32 m0, s68, 139264
    ds_read_b128 v[68:71], v25 offset:49152
    v_mfma_f32_16x16x32_bf16 v[156:159], v[56:59], v[120:123], v[156:159]
    buffer_load_dwordx4 v6, s[20:23], s66 offen lds
    v_mfma_f32_16x16x32_bf16 v[156:159], v[60:63], v[124:127], v[156:159]
    s_waitcnt lgkmcnt(1)
    ds_read_b64_tr_b16 v[56:57], v18 offset:32768
    ds_read_b64_tr_b16 v[58:59], v18 offset:33792
    v_mfma_f32_16x16x32_bf16 v[160:163], v[40:43], v[96:99], v[160:163]
    ds_read_b64_tr_b16 v[60:61], v18 offset:40960
    ds_read_b64_tr_b16 v[62:63], v18 offset:41984
    v_mfma_f32_16x16x32_bf16 v[160:163], v[44:47], v[100:103], v[160:163]
    v_add_u32 v18, 0x10000, v18
    v_mfma_f32_16x16x32_bf16 v[164:167], v[40:43], v[104:107], v[164:167]
    v_mfma_f32_16x16x32_bf16 v[164:167], v[44:47], v[108:111], v[164:167]
    v_mfma_f32_16x16x32_bf16 v[168:171], v[40:43], v[112:115], v[168:171]
    v_mfma_f32_16x16x32_bf16 v[168:171], v[44:47], v[116:119], v[168:171]
    v_mfma_f32_16x16x32_bf16 v[172:175], v[40:43], v[120:123], v[172:175]
    ds_read_b64_tr_b16 v[40:41], v19 offset:32768
    ds_read_b64_tr_b16 v[42:43], v19 offset:33792
    v_mfma_f32_16x16x32_bf16 v[172:175], v[44:47], v[124:127], v[172:175]
    ds_read_b64_tr_b16 v[44:45], v19 offset:40960
    ds_read_b64_tr_b16 v[46:47], v19 offset:41984
    v_mfma_f32_16x16x32_bf16 v[176:179], v[48:51], v[96:99], v[176:179]
    ds_read_b128 v[72:75], v24 offset:57344
    v_add_u32 v19, 0x10000, v19
    v_mfma_f32_16x16x32_bf16 v[176:179], v[52:55], v[100:103], v[176:179]
    s_add_u32 m0, s69, 147456
    v_mfma_f32_16x16x32_bf16 v[180:183], v[48:51], v[104:107], v[180:183]
    s_add_u32 s65, s65, 8192
    buffer_load_dwordx4 v2, s[52:55], 0 offen lds
    v_mfma_f32_16x16x32_bf16 v[180:183], v[52:55], v[108:111], v[180:183]
    s_add_u32 s66, s66, 128
    v_mfma_f32_16x16x32_bf16 v[184:187], v[48:51], v[112:115], v[184:187]
    v_mfma_f32_16x16x32_bf16 v[184:187], v[52:55], v[116:119], v[184:187]
    v_mfma_f32_16x16x32_bf16 v[188:191], v[48:51], v[120:123], v[188:191]
    ds_read_b64_tr_b16 v[48:49], v20 offset:32768
    ds_read_b64_tr_b16 v[50:51], v20 offset:33792
    v_mfma_f32_16x16x32_bf16 v[188:191], v[52:55], v[124:127], v[188:191]
    s_waitcnt lgkmcnt(2)
    ds_read_b64_tr_b16 v[52:53], v20 offset:40960
    ds_read_b64_tr_b16 v[54:55], v20 offset:41984
    v_mfma_f32_16x16x32_bf16 v[192:195], v[56:59], v[96:99], v[192:195]
    v_add_u32 v20, 0x10000, v20
    v_mfma_f32_16x16x32_bf16 v[192:195], v[60:63], v[100:103], v[192:195]
    v_mfma_f32_16x16x32_bf16 v[196:199], v[56:59], v[104:107], v[196:199]
    v_mfma_f32_16x16x32_bf16 v[196:199], v[60:63], v[108:111], v[196:199]
    ds_read_b128 v[76:79], v25 offset:57344
    v_mfma_f32_16x16x32_bf16 v[200:203], v[56:59], v[112:115], v[200:203]
    v_mfma_f32_16x16x32_bf16 v[200:203], v[60:63], v[116:119], v[200:203]
    s_add_u32 m0, s69, 148480
    v_mfma_f32_16x16x32_bf16 v[204:207], v[56:59], v[120:123], v[204:207]
    buffer_load_dwordx4 v3, s[52:55], 0 offen lds
    v_mfma_f32_16x16x32_bf16 v[204:207], v[60:63], v[124:127], v[204:207]
    ds_read_b64_tr_b16 v[56:57], v21 offset:32768
    ds_read_b64_tr_b16 v[58:59], v21 offset:33792
    v_mfma_f32_16x16x32_bf16 v[208:211], v[40:43], v[96:99], v[208:211]
    ds_read_b64_tr_b16 v[60:61], v21 offset:40960
    ds_read_b64_tr_b16 v[62:63], v21 offset:41984
    v_mfma_f32_16x16x32_bf16 v[208:211], v[44:47], v[100:103], v[208:211]
    v_add_u32 v21, 0x10000, v21
    v_mfma_f32_16x16x32_bf16 v[212:215], v[40:43], v[104:107], v[212:215]
    v_mfma_f32_16x16x32_bf16 v[212:215], v[44:47], v[108:111], v[212:215]
    v_mfma_f32_16x16x32_bf16 v[216:219], v[40:43], v[112:115], v[216:219]
    v_mfma_f32_16x16x32_bf16 v[216:219], v[44:47], v[116:119], v[216:219]
    v_mfma_f32_16x16x32_bf16 v[220:223], v[40:43], v[120:123], v[220:223]
    v_mfma_f32_16x16x32_bf16 v[220:223], v[44:47], v[124:127], v[220:223]
    s_waitcnt lgkmcnt(0)
    v_mfma_f32_16x16x32_bf16 v[224:227], v[48:51], v[96:99], v[224:227]
    v_mfma_f32_16x16x32_bf16 v[224:227], v[52:55], v[100:103], v[224:227]
    v_mfma_f32_16x16x32_bf16 v[228:231], v[48:51], v[104:107], v[228:231]
    v_mfma_f32_16x16x32_bf16 v[228:231], v[52:55], v[108:111], v[228:231]
    v_mfma_f32_16x16x32_bf16 v[232:235], v[48:51], v[112:115], v[232:235]
    v_mfma_f32_16x16x32_bf16 v[232:235], v[52:55], v[116:119], v[232:235]
    s_waitcnt vmcnt(13)
    s_barrier
    ds_read_b64_tr_b16 v[40:41], v26 offset:0
    v_mfma_f32_16x16x32_bf16 v[236:239], v[48:51], v[120:123], v[236:239]
    ds_read_b64_tr_b16 v[42:43], v26 offset:512
    ds_read_b64_tr_b16 v[44:45], v26 offset:4096
    v_mfma_f32_16x16x32_bf16 v[236:239], v[52:55], v[124:127], v[236:239]
    ds_read_b64_tr_b16 v[46:47], v26 offset:4608
    ds_read_b128 a[136:139], v22 offset:0
    v_mfma_f32_16x16x32_bf16 v[240:243], v[56:59], v[96:99], v[240:243]
    ds_read_b128 a[140:143], v23 offset:0
    ds_read_b64_tr_b16 v[48:49], v27 offset:0
    v_mfma_f32_16x16x32_bf16 v[240:243], v[60:63], v[100:103], v[240:243]
    ds_read_b64_tr_b16 v[50:51], v27 offset:512
    ds_read_b64_tr_b16 v[52:53], v27 offset:4096
    v_mfma_f32_16x16x32_bf16 v[244:247], v[56:59], v[104:107], v[244:247]
    ds_read_b64_tr_b16 v[54:55], v27 offset:4608
    v_add_u32 v26, 0x10000, v26
    v_mfma_f32_16x16x32_bf16 v[244:247], v[60:63], v[108:111], v[244:247]
    v_add_u32 v22, 0x10000, v22
    v_add_u32 v23, 0x10000, v23
    v_mfma_f32_16x16x32_bf16 v[248:251], v[56:59], v[112:115], v[248:251]
    v_add_u32 v27, 0x10000, v27
    v_mfma_f32_16x16x32_bf16 v[248:251], v[60:63], v[116:119], v[248:251]
    v_mfma_f32_16x16x32_bf16 v[252:255], v[56:59], v[120:123], v[252:255]
    ds_read_b64_tr_b16 v[56:57], v28 offset:0
    ds_read_b64_tr_b16 v[58:59], v28 offset:512
    v_mfma_f32_16x16x32_bf16 v[252:255], v[60:63], v[124:127], v[252:255]
    s_waitcnt lgkmcnt(2)
    ds_read_b64_tr_b16 v[60:61], v28 offset:4096
    ds_read_b64_tr_b16 v[62:63], v28 offset:4608
    v_mfma_f32_16x16x32_bf16 a[64:67], v[40:43], v[96:99], a[64:67]
    v_add_u32 v28, 0x10000, v28
    v_mfma_f32_16x16x32_bf16 a[64:67], v[44:47], v[100:103], a[64:67]
    v_add_u32 v24, 0x10000, v24
    v_mfma_f32_16x16x32_bf16 a[68:71], v[40:43], v[104:107], a[68:71]
    ds_read_b128 v[80:83], v24 offset:16384
    v_mfma_f32_16x16x32_bf16 a[68:71], v[44:47], v[108:111], a[68:71]
    v_mfma_f32_16x16x32_bf16 a[72:75], v[40:43], v[112:115], a[72:75]
    v_mfma_f32_16x16x32_bf16 a[72:75], v[44:47], v[116:119], a[72:75]
    v_add_u32 v25, 0x10000, v25
    v_mfma_f32_16x16x32_bf16 a[76:79], v[40:43], v[120:123], a[76:79]
    ds_read_b128 v[84:87], v25 offset:16384
    v_mfma_f32_16x16x32_bf16 a[76:79], v[44:47], v[124:127], a[76:79]
    v_mfma_f32_16x16x32_bf16 a[128:131], v[40:43], a[136:139], a[128:131]
    ds_read_b64_tr_b16 v[40:41], v29 offset:0
    ds_read_b64_tr_b16 v[42:43], v29 offset:512
    v_mfma_f32_16x16x32_bf16 a[128:131], v[44:47], a[140:143], a[128:131]
    ds_read_b64_tr_b16 v[44:45], v29 offset:4096
    ds_read_b64_tr_b16 v[46:47], v29 offset:4608
    v_mfma_f32_16x16x32_bf16 a[80:83], v[48:51], v[96:99], a[80:83]
    ds_read_b128 v[88:91], v24 offset:24576
    v_add_u32 v29, 0x10000, v29
    v_mfma_f32_16x16x32_bf16 a[80:83], v[52:55], v[100:103], a[80:83]
    v_mfma_f32_16x16x32_bf16 a[84:87], v[48:51], v[104:107], a[84:87]
    v_mfma_f32_16x16x32_bf16 a[84:87], v[52:55], v[108:111], a[84:87]
    v_mfma_f32_16x16x32_bf16 a[88:91], v[48:51], v[112:115], a[88:91]
    ds_read_b128 v[92:95], v25 offset:24576
    v_mfma_f32_16x16x32_bf16 a[88:91], v[52:55], v[116:119], a[88:91]
    v_mfma_f32_16x16x32_bf16 a[92:95], v[48:51], v[120:123], a[92:95]
    v_mfma_f32_16x16x32_bf16 a[92:95], v[52:55], v[124:127], a[92:95]
    v_mfma_f32_16x16x32_bf16 a[132:135], v[48:51], a[136:139], a[132:135]
    v_mfma_f32_16x16x32_bf16 a[132:135], v[52:55], a[140:143], a[132:135]
    s_waitcnt lgkmcnt(0)
    v_mfma_f32_16x16x32_bf16 a[96:99], v[56:59], v[96:99], a[96:99]
    v_mfma_f32_16x16x32_bf16 a[96:99], v[60:63], v[100:103], a[96:99]
    v_mfma_f32_16x16x32_bf16 a[100:103], v[56:59], v[104:107], a[100:103]
    v_mfma_f32_16x16x32_bf16 a[100:103], v[60:63], v[108:111], a[100:103]
    v_mfma_f32_16x16x32_bf16 a[104:107], v[56:59], v[112:115], a[104:107]
    v_mfma_f32_16x16x32_bf16 a[104:107], v[60:63], v[116:119], a[104:107]
    s_waitcnt vmcnt(5)
    s_barrier
    ds_read_b64_tr_b16 v[48:49], v14 offset:32768
    v_mfma_f32_16x16x32_bf16 a[108:111], v[56:59], v[120:123], a[108:111]
    ds_read_b64_tr_b16 v[50:51], v14 offset:33792
    ds_read_b64_tr_b16 v[52:53], v14 offset:40960
    v_mfma_f32_16x16x32_bf16 a[108:111], v[60:63], v[124:127], a[108:111]
    ds_read_b64_tr_b16 v[54:55], v14 offset:41984
    ds_read_b64_tr_b16 v[56:57], v15 offset:32768
    v_mfma_f32_16x16x32_bf16 a[112:115], v[40:43], v[96:99], a[112:115]
    buffer_atomic_add v31, v30, s[44:47], s95 offen sc1
    v_mfma_f32_16x16x32_bf16 a[112:115], v[44:47], v[100:103], a[112:115]
    ds_read_b64_tr_b16 v[58:59], v15 offset:33792
    ds_read_b64_tr_b16 v[60:61], v15 offset:40960
    v_mfma_f32_16x16x32_bf16 a[116:119], v[40:43], v[104:107], a[116:119]
    ds_read_b64_tr_b16 v[62:63], v15 offset:41984
    v_mfma_f32_16x16x32_bf16 a[116:119], v[44:47], v[108:111], a[116:119]
    v_mfma_f32_16x16x32_bf16 a[120:123], v[40:43], v[112:115], a[120:123]
    v_mfma_f32_16x16x32_bf16 a[120:123], v[44:47], v[116:119], a[120:123]
    v_mfma_f32_16x16x32_bf16 a[124:127], v[40:43], v[120:123], a[124:127]
    ds_read_b64_tr_b16 v[40:41], v16 offset:32768
    ds_read_b64_tr_b16 v[42:43], v16 offset:33792
    v_mfma_f32_16x16x32_bf16 a[124:127], v[44:47], v[124:127], a[124:127]
    s_waitcnt lgkmcnt(2)
    ds_read_b64_tr_b16 v[44:45], v16 offset:40960
    ds_read_b64_tr_b16 v[46:47], v16 offset:41984
    v_mfma_f32_16x16x32_bf16 v[128:131], v[48:51], v[64:67], v[128:131]
    v_mfma_f32_16x16x32_bf16 v[128:131], v[52:55], v[68:71], v[128:131]
    ds_read_b64_tr_b16 v[32:33], v4 offset:49152
    ds_read_b64_tr_b16 v[34:35], v4 offset:51200
    v_mfma_f32_16x16x32_bf16 v[132:135], v[48:51], v[72:75], v[132:135]
    v_mfma_f32_16x16x32_bf16 v[132:135], v[52:55], v[76:79], v[132:135]
    v_mfma_f32_16x16x32_bf16 v[136:139], v[48:51], v[80:83], v[136:139]
    v_mfma_f32_16x16x32_bf16 v[136:139], v[52:55], v[84:87], v[136:139]
    v_mfma_f32_16x16x32_bf16 v[140:143], v[48:51], v[88:91], v[140:143]
    ds_read_b64_tr_b16 v[48:49], v17 offset:32768
    ds_read_b64_tr_b16 v[50:51], v17 offset:33792
    v_mfma_f32_16x16x32_bf16 v[140:143], v[52:55], v[92:95], v[140:143]
    ds_read_b64_tr_b16 v[52:53], v17 offset:40960
    ds_read_b64_tr_b16 v[54:55], v17 offset:41984
    v_mfma_f32_16x16x32_bf16 v[144:147], v[56:59], v[64:67], v[144:147]
    s_waitcnt lgkmcnt(4)
    buffer_store_dwordx4 v[32:35], v1, s[56:59], s70 offen offset:0 sc1
    v_mfma_f32_16x16x32_bf16 v[144:147], v[60:63], v[68:71], v[144:147]
    v_mul_f32 v128, s74, v128
    v_mul_f32 v129, s74, v129
    v_mfma_f32_16x16x32_bf16 v[148:151], v[56:59], v[72:75], v[148:151]
    v_mul_f32 v130, s74, v130
    v_mul_f32 v131, s74, v131
    v_mfma_f32_16x16x32_bf16 v[148:151], v[60:63], v[76:79], v[148:151]
    ds_read_b64_tr_b16 v[36:37], v4 offset:49184
    ds_read_b64_tr_b16 v[38:39], v4 offset:51232
    v_mfma_f32_16x16x32_bf16 v[152:155], v[56:59], v[80:83], v[152:155]
    v_mul_f32 v132, s74, v132
    v_mul_f32 v133, s74, v133
    v_mfma_f32_16x16x32_bf16 v[152:155], v[60:63], v[84:87], v[152:155]
    v_mul_f32 v134, s74, v134
    v_mul_f32 v135, s74, v135
    v_mfma_f32_16x16x32_bf16 v[156:159], v[56:59], v[88:91], v[156:159]
    buffer_load_dword v7, v30, s[44:47], s95 offen sc1
    v_mfma_f32_16x16x32_bf16 v[156:159], v[60:63], v[92:95], v[156:159]
    ds_read_b64_tr_b16 v[56:57], v18 offset:32768
    ds_read_b64_tr_b16 v[58:59], v18 offset:33792
    v_mfma_f32_16x16x32_bf16 v[160:163], v[40:43], v[64:67], v[160:163]
    ds_read_b64_tr_b16 v[60:61], v18 offset:40960
    ds_read_b64_tr_b16 v[62:63], v18 offset:41984
    v_mfma_f32_16x16x32_bf16 v[160:163], v[44:47], v[68:71], v[160:163]
    v_mul_f32 v136, s74, v136
    v_mul_f32 v137, s74, v137
    v_mfma_f32_16x16x32_bf16 v[164:167], v[40:43], v[72:75], v[164:167]
    s_waitcnt lgkmcnt(4)
    buffer_store_dwordx4 v[36:39], v1, s[56:59], s70 offen offset:1024 sc1
    v_mfma_f32_16x16x32_bf16 v[164:167], v[44:47], v[76:79], v[164:167]
    v_mul_f32 v138, s74, v138
    v_mul_f32 v139, s74, v139
    v_mfma_f32_16x16x32_bf16 v[168:171], v[40:43], v[80:83], v[168:171]
    v_mul_f32 v140, s74, v140
    v_mul_f32 v141, s74, v141
    v_mfma_f32_16x16x32_bf16 v[168:171], v[44:47], v[84:87], v[168:171]
    ds_read_b64_tr_b16 v[32:33], v4 offset:49216
    ds_read_b64_tr_b16 v[34:35], v4 offset:51264
    v_mfma_f32_16x16x32_bf16 v[172:175], v[40:43], v[88:91], v[172:175]
    ds_read_b64_tr_b16 v[40:41], v19 offset:32768
    ds_read_b64_tr_b16 v[42:43], v19 offset:33792
    v_mfma_f32_16x16x32_bf16 v[172:175], v[44:47], v[92:95], v[172:175]
    ds_read_b64_tr_b16 v[44:45], v19 offset:40960
    ds_read_b64_tr_b16 v[46:47], v19 offset:41984
    v_mfma_f32_16x16x32_bf16 v[176:179], v[48:51], v[64:67], v[176:179]
    v_mul_f32 v142, s74, v142
    v_mul_f32 v143, s74, v143
    v_mfma_f32_16x16x32_bf16 v[176:179], v[52:55], v[68:71], v[176:179]
    v_mul_f32 v144, s74, v144
    v_mul_f32 v145, s74, v145
    v_mfma_f32_16x16x32_bf16 v[180:183], v[48:51], v[72:75], v[180:183]
    v_mul_f32 v146, s74, v146
    v_mul_f32 v147, s74, v147
    v_mfma_f32_16x16x32_bf16 v[180:183], v[52:55], v[76:79], v[180:183]
    v_mul_f32 v148, s74, v148
    v_mul_f32 v149, s74, v149
    v_mfma_f32_16x16x32_bf16 v[184:187], v[48:51], v[80:83], v[184:187]
    s_waitcnt lgkmcnt(0)
    buffer_store_dwordx4 v[32:35], v1, s[56:59], s70 offen offset:2048 sc1
    v_mfma_f32_16x16x32_bf16 v[184:187], v[52:55], v[84:87], v[184:187]
    v_mul_f32 v150, s74, v150
    v_mul_f32 v151, s74, v151
    v_mfma_f32_16x16x32_bf16 v[188:191], v[48:51], v[88:91], v[188:191]
    ds_read_b64_tr_b16 v[48:49], v20 offset:32768
    ds_read_b64_tr_b16 v[50:51], v20 offset:33792
    v_mfma_f32_16x16x32_bf16 v[188:191], v[52:55], v[92:95], v[188:191]
    ds_read_b64_tr_b16 v[52:53], v20 offset:40960
    ds_read_b64_tr_b16 v[54:55], v20 offset:41984
    v_mfma_f32_16x16x32_bf16 v[192:195], v[56:59], v[64:67], v[192:195]
    ds_read_b64_tr_b16 v[36:37], v4 offset:49248
    ds_read_b64_tr_b16 v[38:39], v4 offset:51296
    v_mfma_f32_16x16x32_bf16 v[192:195], v[60:63], v[68:71], v[192:195]
    v_mul_f32 v152, s74, v152
    v_mul_f32 v153, s74, v153
    v_mfma_f32_16x16x32_bf16 v[196:199], v[56:59], v[72:75], v[196:199]
    v_mul_f32 v154, s74, v154
    v_mul_f32 v155, s74, v155
    v_mfma_f32_16x16x32_bf16 v[196:199], v[60:63], v[76:79], v[196:199]
    v_mul_f32 v156, s74, v156
    v_mul_f32 v157, s74, v157
    v_mfma_f32_16x16x32_bf16 v[200:203], v[56:59], v[80:83], v[200:203]
    v_mul_f32 v158, s74, v158
    v_mul_f32 v159, s74, v159
    v_mfma_f32_16x16x32_bf16 v[200:203], v[60:63], v[84:87], v[200:203]
    v_mul_f32 v160, s74, v160
    v_mul_f32 v161, s74, v161
    v_mfma_f32_16x16x32_bf16 v[204:207], v[56:59], v[88:91], v[204:207]
    ds_read_b64_tr_b16 v[56:57], v21 offset:32768
    ds_read_b64_tr_b16 v[58:59], v21 offset:33792
    v_mfma_f32_16x16x32_bf16 v[204:207], v[60:63], v[92:95], v[204:207]
    ds_read_b64_tr_b16 v[60:61], v21 offset:40960
    ds_read_b64_tr_b16 v[62:63], v21 offset:41984
    v_mfma_f32_16x16x32_bf16 v[208:211], v[40:43], v[64:67], v[208:211]
    s_waitcnt lgkmcnt(4)
    buffer_store_dwordx4 v[36:39], v1, s[56:59], s70 offen offset:3072 sc1
    v_mfma_f32_16x16x32_bf16 v[208:211], v[44:47], v[68:71], v[208:211]
    v_mul_f32 v162, s74, v162
    v_mul_f32 v163, s74, v163
    v_mfma_f32_16x16x32_bf16 v[212:215], v[40:43], v[72:75], v[212:215]
    v_mul_f32 v164, s74, v164
    v_mul_f32 v165, s74, v165
    v_mfma_f32_16x16x32_bf16 v[212:215], v[44:47], v[76:79], v[212:215]
    v_mul_f32 v166, s74, v166
    v_mul_f32 v167, s74, v167
    v_mfma_f32_16x16x32_bf16 v[216:219], v[40:43], v[80:83], v[216:219]
    v_mul_f32 v168, s74, v168
    v_mul_f32 v169, s74, v169
    v_mfma_f32_16x16x32_bf16 v[216:219], v[44:47], v[84:87], v[216:219]
    v_mul_f32 v170, s74, v170
    v_mul_f32 v171, s74, v171
    v_mfma_f32_16x16x32_bf16 v[220:223], v[40:43], v[88:91], v[220:223]
    v_mul_f32 v172, s74, v172
    v_mul_f32 v173, s74, v173
    v_mfma_f32_16x16x32_bf16 v[220:223], v[44:47], v[92:95], v[220:223]
    v_mul_f32 v174, s74, v174
    v_mul_f32 v175, s74, v175
    v_mfma_f32_16x16x32_bf16 v[224:227], v[48:51], v[64:67], v[224:227]
    v_mul_f32 v176, s74, v176
    v_mul_f32 v177, s74, v177
    v_mfma_f32_16x16x32_bf16 v[224:227], v[52:55], v[68:71], v[224:227]
    v_mul_f32 v178, s74, v178
    v_mul_f32 v179, s74, v179
    v_mfma_f32_16x16x32_bf16 v[228:231], v[48:51], v[72:75], v[228:231]
    v_mul_f32 v180, s74, v180
    v_mul_f32 v181, s74, v181
    v_mfma_f32_16x16x32_bf16 v[228:231], v[52:55], v[76:79], v[228:231]
    v_mul_f32 v182, s74, v182
    v_mul_f32 v183, s74, v183
    v_mfma_f32_16x16x32_bf16 v[232:235], v[48:51], v[80:83], v[232:235]
    v_mul_f32 v184, s74, v184
    v_mul_f32 v185, s74, v185
    v_mfma_f32_16x16x32_bf16 v[232:235], v[52:55], v[84:87], v[232:235]
    s_add_u32 m0, s76, s75
    v_mul_f32 v186, s74, v186
    v_mul_f32 v187, s74, v187
    s_waitcnt vmcnt(3)
    v_cmp_gt_u32 vcc, 16, v7
    s_nop 1
    s_and_b64 vcc, vcc, s[86:87]
    s_cbranch_scc1 SPIN_H33
BACK_H33:
    s_barrier
    v_mfma_f32_16x16x32_bf16 v[236:239], v[48:51], v[88:91], v[236:239]
    s_lshl_b32 s38, s7, 15
    buffer_load_dwordx4 v1, s[36:39], s77 offen sc1 lds
    v_mfma_f32_16x16x32_bf16 v[236:239], v[52:55], v[92:95], v[236:239]
    s_waitcnt lgkmcnt(0)
    ds_read_b64_tr_b16 v[40:41], v26 offset:0
    ds_read_b64_tr_b16 v[42:43], v26 offset:512
    v_mfma_f32_16x16x32_bf16 v[240:243], v[56:59], v[64:67], v[240:243]
    ds_read_b64_tr_b16 v[44:45], v26 offset:4096
    ds_read_b64_tr_b16 v[46:47], v26 offset:4608
    v_mfma_f32_16x16x32_bf16 v[240:243], v[60:63], v[68:71], v[240:243]
    ds_read_b128 a[136:139], v22 offset:0
    ds_read_b128 a[140:143], v23 offset:0
    v_mfma_f32_16x16x32_bf16 v[244:247], v[56:59], v[72:75], v[244:247]
    buffer_load_dwordx4 v1, s[36:39], s77 offen offset:1024 sc1 lds
    v_mfma_f32_16x16x32_bf16 v[244:247], v[60:63], v[76:79], v[244:247]
    ds_read_b64_tr_b16 v[48:49], v27 offset:0
    ds_read_b64_tr_b16 v[50:51], v27 offset:512
    v_mfma_f32_16x16x32_bf16 v[248:251], v[56:59], v[80:83], v[248:251]
    ds_read_b64_tr_b16 v[52:53], v27 offset:4096
    ds_read_b64_tr_b16 v[54:55], v27 offset:4608
    v_mfma_f32_16x16x32_bf16 v[248:251], v[60:63], v[84:87], v[248:251]
    v_mul_f32 v188, s74, v188
    v_mul_f32 v189, s74, v189
    v_mfma_f32_16x16x32_bf16 v[252:255], v[56:59], v[88:91], v[252:255]
    buffer_load_dwordx4 v1, s[36:39], s77 offen offset:2048 sc1 lds
    v_mfma_f32_16x16x32_bf16 v[252:255], v[60:63], v[92:95], v[252:255]
    s_waitcnt lgkmcnt(4)
    ds_read_b64_tr_b16 v[56:57], v28 offset:0
    ds_read_b64_tr_b16 v[58:59], v28 offset:512
    v_mfma_f32_16x16x32_bf16 a[64:67], v[40:43], v[64:67], a[64:67]
    ds_read_b64_tr_b16 v[60:61], v28 offset:4096
    ds_read_b64_tr_b16 v[62:63], v28 offset:4608
    v_mfma_f32_16x16x32_bf16 a[64:67], v[44:47], v[68:71], a[64:67]
    ds_read_b64_tr_b16 v[32:33], v5 offset:16384
    ds_read_b64_tr_b16 v[34:35], v5 offset:17408
    v_mfma_f32_16x16x32_bf16 a[68:71], v[40:43], v[72:75], a[68:71]
    buffer_load_dwordx4 v1, s[36:39], s77 offen offset:3072 sc1 lds
    v_mfma_f32_16x16x32_bf16 a[68:71], v[44:47], v[76:79], a[68:71]
    v_mul_f32 v190, s74, v190
    v_mul_f32 v191, s74, v191
    v_mfma_f32_16x16x32_bf16 a[72:75], v[40:43], v[80:83], a[72:75]
    v_mul_f32 v192, s74, v192
    v_mul_f32 v193, s74, v193
    v_mfma_f32_16x16x32_bf16 a[72:75], v[44:47], v[84:87], a[72:75]
    s_add_u32 s100, s77, 4096
    v_mul_f32 v194, s74, v194
    v_mul_f32 v195, s74, v195
    v_mfma_f32_16x16x32_bf16 a[76:79], v[40:43], v[88:91], a[76:79]
    s_add_u32 m0, m0, 4096
    v_mul_f32 v196, s74, v196
    v_mul_f32 v197, s74, v197
    v_mfma_f32_16x16x32_bf16 a[76:79], v[44:47], v[92:95], a[76:79]
    buffer_load_dwordx4 v1, s[36:39], s100 offen sc1 lds
    v_mfma_f32_16x16x32_bf16 a[128:131], v[40:43], a[136:139], a[128:131]
    ds_read_b64_tr_b16 v[40:41], v29 offset:0
    ds_read_b64_tr_b16 v[42:43], v29 offset:512
    v_mfma_f32_16x16x32_bf16 a[128:131], v[44:47], a[140:143], a[128:131]
    s_waitcnt lgkmcnt(2)
    ds_read_b64_tr_b16 v[44:45], v29 offset:4096
    ds_read_b64_tr_b16 v[46:47], v29 offset:4608
    v_mfma_f32_16x16x32_bf16 a[80:83], v[48:51], v[64:67], a[80:83]
    buffer_load_dwordx4 v1, s[36:39], s100 offen offset:1024 sc1 lds
    v_mfma_f32_16x16x32_bf16 a[80:83], v[52:55], v[68:71], a[80:83]
    ds_read_b64_tr_b16 v[36:37], v5 offset:16416
    ds_read_b64_tr_b16 v[38:39], v5 offset:17440
    v_mfma_f32_16x16x32_bf16 a[84:87], v[48:51], v[72:75], a[84:87]
    v_mul_f32 v198, s74, v198
    v_mul_f32 v199, s74, v199
    v_mfma_f32_16x16x32_bf16 a[84:87], v[52:55], v[76:79], a[84:87]
    v_mul_f32 v200, s74, v200
    v_mul_f32 v201, s74, v201
    v_mfma_f32_16x16x32_bf16 a[88:91], v[48:51], v[80:83], a[88:91]
    buffer_load_dwordx4 v1, s[36:39], s100 offen offset:2048 sc1 lds
    v_mfma_f32_16x16x32_bf16 a[88:91], v[52:55], v[84:87], a[88:91]
    v_mul_f32 v202, s74, v202
    v_mul_f32 v203, s74, v203
    v_mfma_f32_16x16x32_bf16 a[92:95], v[48:51], v[88:91], a[92:95]
    v_mul_f32 v204, s74, v204
    v_mul_f32 v205, s74, v205
    v_mfma_f32_16x16x32_bf16 a[92:95], v[52:55], v[92:95], a[92:95]
    v_mul_f32 v206, s74, v206
    v_mul_f32 v207, s74, v207
    v_mfma_f32_16x16x32_bf16 a[132:135], v[48:51], a[136:139], a[132:135]
    buffer_load_dwordx4 v1, s[36:39], s100 offen offset:3072 sc1 lds
    v_mfma_f32_16x16x32_bf16 a[132:135], v[52:55], a[140:143], a[132:135]
    v_mul_f32 v208, s74, v208
    v_mul_f32 v209, s74, v209
    v_mfma_f32_16x16x32_bf16 a[96:99], v[56:59], v[64:67], a[96:99]
    v_mul_f32 v210, s74, v210
    v_mul_f32 v211, s74, v211
    v_mfma_f32_16x16x32_bf16 a[96:99], v[60:63], v[68:71], a[96:99]
    s_add_u32 s77, s77, 32768
    v_mul_f32 v212, s74, v212
    v_mul_f32 v213, s74, v213
    v_mfma_f32_16x16x32_bf16 a[100:103], v[56:59], v[72:75], a[100:103]
    s_add_u32 s76, s76, 32768
    v_mul_f32 v214, s74, v214
    v_mul_f32 v215, s74, v215
    v_mfma_f32_16x16x32_bf16 a[100:103], v[60:63], v[76:79], a[100:103]
    v_mul_f32 v216, s74, v216
    v_mul_f32 v217, s74, v217
    v_mfma_f32_16x16x32_bf16 a[104:107], v[56:59], v[80:83], a[104:107]
    v_mul_f32 v218, s74, v218
    v_mul_f32 v219, s74, v219
    v_mfma_f32_16x16x32_bf16 a[104:107], v[60:63], v[84:87], a[104:107]
    v_mul_f32 v220, s74, v220
    v_mul_f32 v221, s74, v221
    v_mfma_f32_16x16x32_bf16 a[108:111], v[56:59], v[88:91], a[108:111]
    v_mul_f32 v222, s74, v222
    v_mul_f32 v223, s74, v223
    v_mfma_f32_16x16x32_bf16 a[108:111], v[60:63], v[92:95], a[108:111]
    s_waitcnt lgkmcnt(0)
    v_mul_f32 v224, s74, v224
    v_mul_f32 v225, s74, v225
    v_mfma_f32_16x16x32_bf16 a[112:115], v[40:43], v[64:67], a[112:115]
    v_mul_f32 v226, s74, v226
    v_mul_f32 v227, s74, v227
    v_mfma_f32_16x16x32_bf16 a[112:115], v[44:47], v[68:71], a[112:115]
    v_mul_f32 v228, s74, v228
    v_mul_f32 v229, s74, v229
    v_mfma_f32_16x16x32_bf16 a[116:119], v[40:43], v[72:75], a[116:119]
    v_mul_f32 v230, s74, v230
    v_mul_f32 v231, s74, v231
    v_mfma_f32_16x16x32_bf16 a[116:119], v[44:47], v[76:79], a[116:119]
    v_mul_f32 v232, s74, v232
    v_mul_f32 v233, s74, v233
    v_mfma_f32_16x16x32_bf16 a[120:123], v[40:43], v[80:83], a[120:123]
    v_mul_f32 v234, s74, v234
    v_mul_f32 v235, s74, v235
    v_mfma_f32_16x16x32_bf16 a[120:123], v[44:47], v[84:87], a[120:123]
    v_mul_f32 v236, s74, v236
    v_mul_f32 v237, s74, v237
    v_mfma_f32_16x16x32_bf16 a[124:127], v[40:43], v[88:91], a[124:127]
    v_mul_f32 v238, s74, v238
    v_mul_f32 v239, s74, v239
    v_mfma_f32_16x16x32_bf16 a[124:127], v[44:47], v[92:95], a[124:127]
    s_add_u32 m0, s76, s75
    s_nop 0
    buffer_load_dwordx4 v1, s[36:39], s77 offen sc1 lds
    v_mul_f32 v240, s74, v240
    v_mul_f32 v241, s74, v241
    v_mul_f32 v242, s74, v242
    v_mul_f32 v243, s74, v243
    v_mul_f32 v244, s74, v244
    v_mul_f32 v245, s74, v245
    v_mul_f32 v246, s74, v246
    v_mul_f32 v247, s74, v247
    v_mul_f32 v248, s74, v248
    v_mul_f32 v249, s74, v249
    v_mul_f32 v250, s74, v250
    v_mul_f32 v251, s74, v251
    v_mul_f32 v252, s74, v252
    v_mul_f32 v253, s74, v253
    v_mul_f32 v254, s74, v254
    v_mul_f32 v255, s74, v255
    buffer_load_dwordx4 v1, s[36:39], s77 offen offset:1024 sc1 lds
    v_cvt_pk_bf16_f32 v128, v128, v129
    v_cvt_pk_bf16_f32 v129, v130, v131
    v_cvt_pk_bf16_f32 v130, v144, v145
    v_cvt_pk_bf16_f32 v131, v146, v147
    v_cvt_pk_bf16_f32 v132, v132, v133
    v_cvt_pk_bf16_f32 v133, v134, v135
    v_cvt_pk_bf16_f32 v134, v148, v149
    v_cvt_pk_bf16_f32 v135, v150, v151
    v_cvt_pk_bf16_f32 v136, v136, v137
    v_cvt_pk_bf16_f32 v137, v138, v139
    v_cvt_pk_bf16_f32 v138, v152, v153
    v_cvt_pk_bf16_f32 v139, v154, v155
    v_cvt_pk_bf16_f32 v140, v140, v141
    v_cvt_pk_bf16_f32 v141, v142, v143
    v_cvt_pk_bf16_f32 v142, v156, v157
    v_cvt_pk_bf16_f32 v143, v158, v159
    buffer_load_dwordx4 v1, s[36:39], s77 offen offset:2048 sc1 lds
    v_cvt_pk_bf16_f32 v160, v160, v161
    v_cvt_pk_bf16_f32 v161, v162, v163
    v_cvt_pk_bf16_f32 v162, v176, v177
    v_cvt_pk_bf16_f32 v163, v178, v179
    v_cvt_pk_bf16_f32 v164, v164, v165
    v_cvt_pk_bf16_f32 v165, v166, v167
    v_cvt_pk_bf16_f32 v166, v180, v181
    v_cvt_pk_bf16_f32 v167, v182, v183
    v_cvt_pk_bf16_f32 v168, v168, v169
    v_cvt_pk_bf16_f32 v169, v170, v171
    v_cvt_pk_bf16_f32 v170, v184, v185
    v_cvt_pk_bf16_f32 v171, v186, v187
    v_cvt_pk_bf16_f32 v172, v172, v173
    v_cvt_pk_bf16_f32 v173, v174, v175
    v_cvt_pk_bf16_f32 v174, v188, v189
    v_cvt_pk_bf16_f32 v175, v190, v191
    v_cvt_pk_bf16_f32 v192, v192, v193
    buffer_load_dwordx4 v1, s[36:39], s77 offen offset:3072 sc1 lds
    v_cvt_pk_bf16_f32 v193, v194, v195
    v_cvt_pk_bf16_f32 v194, v208, v209
    v_cvt_pk_bf16_f32 v195, v210, v211
    v_cvt_pk_bf16_f32 v196, v196, v197
    v_cvt_pk_bf16_f32 v197, v198, v199
    v_cvt_pk_bf16_f32 v198, v212, v213
    v_cvt_pk_bf16_f32 v199, v214, v215
    v_cvt_pk_bf16_f32 v200, v200, v201
    v_cvt_pk_bf16_f32 v201, v202, v203
    v_cvt_pk_bf16_f32 v202, v216, v217
    v_cvt_pk_bf16_f32 v203, v218, v219
    v_cvt_pk_bf16_f32 v204, v204, v205
    v_cvt_pk_bf16_f32 v205, v206, v207
    v_cvt_pk_bf16_f32 v206, v220, v221
    v_cvt_pk_bf16_f32 v207, v222, v223
    v_cvt_pk_bf16_f32 v224, v224, v225
    s_add_u32 s100, s77, 4096
    s_add_u32 m0, m0, 4096
    s_nop 0
    buffer_load_dwordx4 v1, s[36:39], s100 offen sc1 lds
    v_cvt_pk_bf16_f32 v225, v226, v227
    v_cvt_pk_bf16_f32 v226, v240, v241
    v_cvt_pk_bf16_f32 v227, v242, v243
    v_cvt_pk_bf16_f32 v228, v228, v229
    v_cvt_pk_bf16_f32 v229, v230, v231
    v_cvt_pk_bf16_f32 v230, v244, v245
    v_cvt_pk_bf16_f32 v231, v246, v247
    v_cvt_pk_bf16_f32 v232, v232, v233
    v_cvt_pk_bf16_f32 v233, v234, v235
    v_cvt_pk_bf16_f32 v234, v248, v249
    v_cvt_pk_bf16_f32 v235, v250, v251
    v_cvt_pk_bf16_f32 v236, v236, v237
    v_cvt_pk_bf16_f32 v237, v238, v239
    v_cvt_pk_bf16_f32 v238, v252, v253
    v_cvt_pk_bf16_f32 v239, v254, v255
    buffer_store_dwordx4 v[32:35], v1, s[56:59], s71 offen offset:0 sc1
    buffer_load_dwordx4 v1, s[36:39], s100 offen offset:1024 sc1 lds
    buffer_store_dwordx4 v[36:39], v1, s[56:59], s71 offen offset:1024 sc1
    v_mov_b32 v8, 0x3f803f80
    v_accvgpr_write_b32 a136, v8
    v_accvgpr_write_b32 a137, v8
    v_accvgpr_write_b32 a138, v8
    v_accvgpr_write_b32 a139, v8
    v_bfe_u32 v8, v1, 4, 4
    v_lshrrev_b32 v9, 8, v1
    v_lshlrev_b32 v9, 2, v9
    v_sub_u32 v8, v8, v9
    v_mov_b32 v9, 0xf149f2ca
    v_cmp_le_i32 vcc, 0, v8
    s_cmp_eq_u32 s4, 0
    s_cselect_b32 s8, 1.0, 0
    v_cndmask_b32_e64 v208, v9, 0, vcc
    s_cmp_lt_u32 s4, 0
    s_cselect_b32 s12, 0xf149f2ca, 0
    buffer_load_dwordx4 v1, s[36:39], s100 offen offset:2048 sc1 lds
    v_cmp_le_i32 vcc, 1, v8
    s_cmp_eq_u32 s4, 1
    s_cselect_b32 s9, 1.0, 0
    v_cndmask_b32_e64 v209, v9, 0, vcc
    s_cmp_lt_u32 s4, 1
    s_cselect_b32 s13, 0xf149f2ca, 0
    v_cmp_le_i32 vcc, 2, v8
    s_cmp_eq_u32 s4, 2
    s_cselect_b32 s10, 1.0, 0
    v_cndmask_b32_e64 v210, v9, 0, vcc
    s_cmp_lt_u32 s4, 2
    s_cselect_b32 s14, 0xf149f2ca, 0
    v_cmp_le_i32 vcc, 3, v8
    s_cmp_eq_u32 s4, 3
    s_cselect_b32 s11, 1.0, 0
    buffer_load_dwordx4 v1, s[36:39], s100 offen offset:3072 sc1 lds
    s_add_u32 s77, s77, 32768
    s_add_u32 s76, s76, 32768
    v_cndmask_b32_e64 v211, v9, 0, vcc
    s_cmp_lt_u32 s4, 3
    s_cselect_b32 s15, 0xf149f2ca, 0
    s_lshl3_add_u32 s80, s6, s4
    s_mul_i32 s80, s80, 149504
    s_sub_u32 s7, 15, s6
    s_lshl3_add_u32 s81, s7, s4
    s_mul_i32 s81, s81, 149504
    s_lshl_b32 s7, s5, 12
    s_add_u32 s80, s80, s7
    s_add_u32 s81, s81, s7
    s_mov_b32 s101, 0x71800000
    s_mov_b32 s92, -1
    s_mov_b32 s93, 0
    s_load_dwordx2 s[24:25], s[0:1], 80
    s_mov_b32 s26, 2359296
    s_mov_b32 s27, 0x20000
K1_ATT:
    s_mov_b32 s82, 0
    s_mov_b32 s60, 131072
    v_mov_b32 v2, v1
    v_mov_b32 v11, 0
    s_cmp_eq_u32 s6, 0
    s_cselect_b32 s16, s8, 0
    s_cselect_b32 s17, s9, 0
    s_cselect_b32 s18, s10, 0
    s_cselect_b32 s19, s11, 0
    s_cselect_b32 s20, s12, 0
    s_cselect_b32 s21, s13, 0
    s_cselect_b32 s22, s14, 0
    s_cselect_b32 s23, s15, 0
    s_waitcnt vmcnt(8) lgkmcnt(0)
    s_barrier
    ds_read_b128 a[224:227], v2 offset:0
    ds_read_b128 a[228:231], v2 offset:1024
    ds_read_b128 a[232:235], v2 offset:2048
    ds_read_b128 a[236:239], v2 offset:3072
    ds_read_b128 v[96:99], v2 offset:16384
    ds_read_b128 v[100:103], v2 offset:17408
    s_cmp_lg_u32 s83, 0
    s_cbranch_scc1 K1_HAVEM_R
    s_add_u32 m0, s76, s75
    s_nop 0
    buffer_load_dwordx4 v1, s[36:39], s77 offen sc1 lds
    v_mul_f32 v176, s16, v208
    v_mul_f32 v177, s16, v209
    v_mul_f32 v178, s16, v210
    v_mul_f32 v179, s16, v211
    s_waitcnt lgkmcnt(2)
    buffer_load_dwordx4 v1, s[36:39], s77 offen offset:1024 sc1 lds
    v_mfma_f32_16x16x32_bf16 v[240:243], a[224:227], v[128:131], v[176:179]
    v_mfma_f32_16x16x32_bf16 v[240:243], a[228:231], v[160:163], v[240:243]
    v_mfma_f32_16x16x32_bf16 v[240:243], a[232:235], v[192:195], v[240:243]
    v_mfma_f32_16x16x32_bf16 v[240:243], a[236:239], v[224:227], v[240:243]
    v_mfma_f32_16x16x32_bf16 v[244:247], a[224:227], v[132:135], 0
    buffer_load_dwordx4 v1, s[36:39], s77 offen offset:2048 sc1 lds
    v_mfma_f32_16x16x32_bf16 v[244:247], a[228:231], v[164:167], v[244:247]
    v_mfma_f32_16x16x32_bf16 v[244:247], a[232:235], v[196:199], v[244:247]
    v_mfma_f32_16x16x32_bf16 v[244:247], a[236:239], v[228:231], v[244:247]
    v_mfma_f32_16x16x32_bf16 v[248:251], a[224:227], v[136:139], 0
    v_mfma_f32_16x16x32_bf16 v[248:251], a[228:231], v[168:171], v[248:251]
    buffer_load_dwordx4 v1, s[36:39], s77 offen offset:3072 sc1 lds
    s_add_u32 s100, s77, 4096
    v_mfma_f32_16x16x32_bf16 v[248:251], a[232:235], v[200:203], v[248:251]
    v_mfma_f32_16x16x32_bf16 v[248:251], a[236:239], v[232:235], v[248:251]
    v_mfma_f32_16x16x32_bf16 v[252:255], a[224:227], v[140:143], 0
    v_mfma_f32_16x16x32_bf16 v[252:255], a[228:231], v[172:175], v[252:255]
    v_mfma_f32_16x16x32_bf16 v[252:255], a[232:235], v[204:207], v[252:255]
    v_mfma_f32_16x16x32_bf16 v[252:255], a[236:239], v[236:239], v[252:255]
    s_add_u32 m0, m0, 4096
    s_nop 0
    buffer_load_dwordx4 v1, s[36:39], s100 offen sc1 lds
    v_max3_f32 v240, v240, v241, v242
    v_max_f32 v240, v240, v243
    v_max3_f32 v244, v244, v245, v246
    v_max_f32 v244, v244, v247
    v_max3_f32 v248, v248, v249, v250
    v_max_f32 v248, v248, v251
    v_max3_f32 v252, v252, v253, v254
    v_max_f32 v252, v252, v255
    v_mov_b32 v241, v240
    v_mov_b32 v245, v244
    v_mov_b32 v249, v248
    v_mov_b32 v253, v252
    buffer_load_dwordx4 v1, s[36:39], s100 offen offset:1024 sc1 lds
    v_permlane32_swap_b32 v240, v241
    v_permlane32_swap_b32 v244, v245
    v_permlane32_swap_b32 v248, v249
    v_permlane32_swap_b32 v252, v253
    v_max_f32 v240, v240, v241
    v_max_f32 v244, v244, v245
    v_max_f32 v248, v248, v249
    v_max_f32 v252, v252, v253
    v_mov_b32 v241, v240
    v_mov_b32 v245, v244
    v_mov_b32 v249, v248
    v_mov_b32 v253, v252
    buffer_load_dwordx4 v1, s[36:39], s100 offen offset:2048 sc1 lds
    v_permlane16_swap_b32 v240, v241
    v_permlane16_swap_b32 v244, v245
    v_permlane16_swap_b32 v248, v249
    v_permlane16_swap_b32 v252, v253
    v_max_f32 v240, v240, v241
    v_max_f32 v244, v244, v245
    v_max_f32 v248, v248, v249
    v_max_f32 v252, v252, v253
    v_sub_f32 v144, 0, v240
    v_sub_f32 v145, 0, v240
    v_sub_f32 v146, 0, v240
    v_sub_f32 v147, 0, v240
    buffer_load_dwordx4 v1, s[36:39], s100 offen offset:3072 sc1 lds
    s_add_u32 s77, s77, 32768
    s_add_u32 s76, s76, 32768
    v_sub_f32 v148, 0, v244
    v_sub_f32 v149, 0, v244
    v_sub_f32 v150, 0, v244
    v_sub_f32 v151, 0, v244
    v_sub_f32 v152, 0, v248
    v_sub_f32 v153, 0, v248
    v_sub_f32 v154, 0, v248
    v_sub_f32 v155, 0, v248
    v_sub_f32 v156, 0, v252
    v_sub_f32 v157, 0, v252
    v_sub_f32 v158, 0, v252
    v_sub_f32 v159, 0, v252
K1_HAVEM:
    v_add_f32 v212, s20, v144
    v_fma_f32 v176, v208, s16, v212
    v_fma_f32 v177, v209, s16, v212
    v_fma_f32 v178, v210, s16, v212
    v_fma_f32 v179, v211, s16, v212
    s_nop 1
    s_waitcnt lgkmcnt(0)
    v_mfma_f32_16x16x32_bf16 v[240:243], a[224:227], v[128:131], v[176:179]
    s_add_u32 m0, s76, s75
    ds_read_b128 a[240:243], v2 offset:4096
    ds_read_b128 a[244:247], v2 offset:5120
    v_mfma_f32_16x16x32_bf16 v[240:243], a[228:231], v[160:163], v[240:243]
    s_mov_b32 s76, s60
    buffer_load_dwordx4 v1, s[36:39], s77 offen sc1 lds
    v_mfma_f32_16x16x32_bf16 v[240:243], a[232:235], v[192:195], v[240:243]
    s_mov_b32 s60, s82
    ds_read_b128 a[248:251], v2 offset:6144
    ds_read_b128 a[252:255], v2 offset:7168
    v_mfma_f32_16x16x32_bf16 v[240:243], a[236:239], v[224:227], v[240:243]
    s_add_u32 s82, s82, 32768
    v_add_f32 v213, s21, v144
    v_fma_f32 v180, v208, s17, v213
    v_mfma_f32_16x16x32_bf16 v[244:247], a[224:227], v[132:135], v[148:151]
    v_fma_f32 v181, v209, s17, v213
    v_fma_f32 v182, v210, s17, v213
    v_mfma_f32_16x16x32_bf16 v[244:247], a[228:231], v[164:167], v[244:247]
    v_fma_f32 v183, v211, s17, v213
    v_add_f32 v214, s22, v144
    v_mfma_f32_16x16x32_bf16 v[244:247], a[232:235], v[196:199], v[244:247]
    buffer_load_dwordx4 v1, s[36:39], s77 offen offset:1024 sc1 lds
    v_mfma_f32_16x16x32_bf16 v[244:247], a[236:239], v[228:231], v[244:247]
    v_exp_f32 v240, v240
    v_mfma_f32_16x16x32_bf16 v[248:251], a[224:227], v[136:139], v[152:155]
    v_exp_f32 v241, v241
    v_mfma_f32_16x16x32_bf16 v[248:251], a[228:231], v[168:171], v[248:251]
    v_exp_f32 v242, v242
    v_mfma_f32_16x16x32_bf16 v[248:251], a[232:235], v[200:203], v[248:251]
    v_exp_f32 v243, v243
    v_mfma_f32_16x16x32_bf16 v[248:251], a[236:239], v[232:235], v[248:251]
    buffer_load_dwordx4 v1, s[36:39], s77 offen offset:2048 sc1 lds
    v_mfma_f32_16x16x32_bf16 v[252:255], a[224:227], v[140:143], v[156:159]
    v_cvt_pk_bf16_f32 v32, v240, v241
    v_cvt_pk_bf16_f32 v33, v242, v243
    v_mfma_f32_16x16x32_bf16 v[252:255], a[228:231], v[172:175], v[252:255]
    v_exp_f32 v244, v244
    v_mfma_f32_16x16x32_bf16 v[252:255], a[232:235], v[204:207], v[252:255]
    v_exp_f32 v245, v245
    v_mfma_f32_16x16x32_bf16 v[252:255], a[236:239], v[236:239], v[252:255]
    s_waitcnt lgkmcnt(0)
    v_exp_f32 v246, v246
    v_mfma_f32_16x16x32_bf16 v[240:243], a[240:243], v[128:131], v[180:183]
    v_exp_f32 v247, v247
    v_mfma_f32_16x16x32_bf16 v[240:243], a[244:247], v[160:163], v[240:243]
    buffer_load_dwordx4 v1, s[36:39], s77 offen offset:3072 sc1 lds
    v_mfma_f32_16x16x32_bf16 v[240:243], a[248:251], v[192:195], v[240:243]
    v_cvt_pk_bf16_f32 v40, v244, v245
    v_cvt_pk_bf16_f32 v41, v246, v247
    v_mfma_f32_16x16x32_bf16 v[240:243], a[252:255], v[224:227], v[240:243]
    v_exp_f32 v248, v248
    v_mfma_f32_16x16x32_bf16 v[244:247], a[240:243], v[132:135], v[148:151]
    v_exp_f32 v249, v249
    v_mfma_f32_16x16x32_bf16 v[244:247], a[244:247], v[164:167], v[244:247]
    s_add_u32 s100, s77, 4096
    v_exp_f32 v250, v250
    v_mfma_f32_16x16x32_bf16 v[244:247], a[248:251], v[196:199], v[244:247]
    s_add_u32 m0, m0, 4096
    v_exp_f32 v251, v251
    v_mfma_f32_16x16x32_bf16 v[244:247], a[252:255], v[228:231], v[244:247]
    v_cvt_pk_bf16_f32 v48, v248, v249
    v_cvt_pk_bf16_f32 v49, v250, v251
    v_mfma_f32_16x16x32_bf16 v[248:251], a[240:243], v[136:139], v[152:155]
    ds_read_b128 a[224:227], v2 offset:8192
    ds_read_b128 a[228:231], v2 offset:9216
    v_mfma_f32_16x16x32_bf16 v[248:251], a[244:247], v[168:171], v[248:251]
    buffer_load_dwordx4 v1, s[36:39], s100 offen sc1 lds
    v_mfma_f32_16x16x32_bf16 v[248:251], a[248:251], v[200:203], v[248:251]
    v_exp_f32 v252, v252
    v_mfma_f32_16x16x32_bf16 v[248:251], a[252:255], v[232:235], v[248:251]
    v_exp_f32 v253, v253
    v_exp_f32 v254, v254
    v_exp_f32 v255, v255
    v_cvt_pk_bf16_f32 v56, v252, v253
    v_cvt_pk_bf16_f32 v57, v254, v255
    v_mfma_f32_16x16x32_bf16 v[252:255], a[240:243], v[140:143], v[156:159]
    ds_read_b128 a[232:235], v2 offset:10240
    ds_read_b128 a[236:239], v2 offset:11264
    v_mfma_f32_16x16x32_bf16 v[252:255], a[244:247], v[172:175], v[252:255]
    buffer_load_dwordx4 v1, s[36:39], s100 offen offset:1024 sc1 lds
    v_mfma_f32_16x16x32_bf16 v[252:255], a[248:251], v[204:207], v[252:255]
    v_exp_f32 v240, v240
    v_mfma_f32_16x16x32_bf16 v[252:255], a[252:255], v[236:239], v[252:255]
    s_waitcnt lgkmcnt(2)
    v_exp_f32 v241, v241
    v_exp_f32 v242, v242
    v_exp_f32 v243, v243
    v_fma_f32 v184, v208, s18, v214
    v_fma_f32 v185, v209, s18, v214
    v_fma_f32 v186, v210, s18, v214
    v_fma_f32 v187, v211, s18, v214
    v_cvt_pk_bf16_f32 v34, v240, v241
    v_cvt_pk_bf16_f32 v35, v242, v243
    v_mfma_f32_16x16x32_bf16 v[240:243], a[224:227], v[128:131], v[184:187]
    v_exp_f32 v244, v244
    v_mfma_f32_16x16x32_bf16 v[240:243], a[228:231], v[160:163], v[240:243]
    s_waitcnt lgkmcnt(0)
    v_exp_f32 v245, v245
    v_mfma_f32_16x16x32_bf16 v[240:243], a[232:235], v[192:195], v[240:243]
    v_exp_f32 v246, v246
    v_mfma_f32_16x16x32_bf16 v[240:243], a[236:239], v[224:227], v[240:243]
    v_exp_f32 v247, v247
    v_cvt_pk_bf16_f32 v42, v244, v245
    v_cvt_pk_bf16_f32 v43, v246, v247
    v_mfma_f32_16x16x32_bf16 v[244:247], a[224:227], v[132:135], v[148:151]
    buffer_load_dwordx4 v1, s[36:39], s100 offen offset:2048 sc1 lds
    v_mfma_f32_16x16x32_bf16 v[244:247], a[228:231], v[164:167], v[244:247]
    v_exp_f32 v248, v248
    v_mfma_f32_16x16x32_bf16 v[244:247], a[232:235], v[196:199], v[244:247]
    v_exp_f32 v249, v249
    v_mfma_f32_16x16x32_bf16 v[244:247], a[236:239], v[228:231], v[244:247]
    v_exp_f32 v250, v250
    v_exp_f32 v251, v251
    v_cvt_pk_bf16_f32 v50, v248, v249
    v_cvt_pk_bf16_f32 v51, v250, v251
    v_mfma_f32_16x16x32_bf16 v[248:251], a[224:227], v[136:139], v[152:155]
    buffer_load_dwordx4 v1, s[36:39], s100 offen offset:3072 sc1 lds
    v_mfma_f32_16x16x32_bf16 v[248:251], a[228:231], v[168:171], v[248:251]
    ds_read_b128 a[240:243], v2 offset:12288
    ds_read_b128 a[244:247], v2 offset:13312
    v_mfma_f32_16x16x32_bf16 v[248:251], a[232:235], v[200:203], v[248:251]
    s_add_u32 s77, s77, 32768
    v_exp_f32 v252, v252
    v_mfma_f32_16x16x32_bf16 v[248:251], a[236:239], v[232:235], v[248:251]
    v_exp_f32 v253, v253
    v_exp_f32 v254, v254
    v_exp_f32 v255, v255
    v_cvt_pk_bf16_f32 v58, v252, v253
    v_cvt_pk_bf16_f32 v59, v254, v255
    v_mfma_f32_16x16x32_bf16 v[252:255], a[224:227], v[140:143], v[156:159]
    ds_read_b128 a[248:251], v2 offset:14336
    ds_read_b128 a[252:255], v2 offset:15360
    v_mfma_f32_16x16x32_bf16 v[252:255], a[228:231], v[172:175], v[252:255]
    v_add_f32 v215, s23, v144
    v_fma_f32 v188, v208, s19, v215
    v_mfma_f32_16x16x32_bf16 v[252:255], a[232:235], v[204:207], v[252:255]
    v_exp_f32 v240, v240
    v_mfma_f32_16x16x32_bf16 v[252:255], a[236:239], v[236:239], v[252:255]
    s_waitcnt lgkmcnt(2)
    v_exp_f32 v241, v241
    v_exp_f32 v242, v242
    v_exp_f32 v243, v243
    v_fma_f32 v189, v209, s19, v215
    v_fma_f32 v190, v210, s19, v215
    v_fma_f32 v191, v211, s19, v215
    v_cvt_pk_bf16_f32 v36, v240, v241
    v_cvt_pk_bf16_f32 v37, v242, v243
    v_mfma_f32_16x16x32_bf16 v[240:243], a[240:243], v[128:131], v[188:191]
    v_exp_f32 v244, v244
    v_mfma_f32_16x16x32_bf16 v[240:243], a[244:247], v[160:163], v[240:243]
    s_cmp_eq_u32 s82, 163840
    s_cselect_b32 s82, 0, s82
    v_add_u32 v2, s82, v1
    s_waitcnt lgkmcnt(0)
    v_mfma_f32_16x16x32_bf16 v[240:243], a[248:251], v[192:195], v[240:243]
    v_exp_f32 v245, v245
    v_mfma_f32_16x16x32_bf16 v[240:243], a[252:255], v[224:227], v[240:243]
    s_waitcnt vmcnt(16)
    s_barrier
    v_cvt_pk_bf16_f32 v44, v244, v245
    v_exp_f32 v246, v246
    v_exp_f32 v247, v247
    s_nop 0
    v_cvt_pk_bf16_f32 v45, v246, v247
    v_mfma_f32_16x16x32_bf16 v[244:247], a[240:243], v[132:135], v[148:151]
    ds_read_b128 a[224:227], v2 offset:0
    ds_read_b128 a[228:231], v2 offset:1024
    v_mfma_f32_16x16x32_bf16 v[244:247], a[244:247], v[164:167], v[244:247]
    v_exp_f32 v248, v248
    v_mfma_f32_16x16x32_bf16 v[244:247], a[248:251], v[196:199], v[244:247]
    v_exp_f32 v249, v249
    v_mfma_f32_16x16x32_bf16 v[244:247], a[252:255], v[228:231], v[244:247]
    v_exp_f32 v250, v250
    v_exp_f32 v251, v251
    v_cvt_pk_bf16_f32 v52, v248, v249
    v_cvt_pk_bf16_f32 v53, v250, v251
    v_mfma_f32_16x16x32_bf16 v[248:251], a[240:243], v[136:139], v[152:155]
    ds_read_b128 a[232:235], v2 offset:2048
    ds_read_b128 a[236:239], v2 offset:3072
    v_mfma_f32_16x16x32_bf16 v[248:251], a[244:247], v[168:171], v[248:251]
    ds_read_b128 v[96:99], v2 offset:16384
    ds_read_b128 v[100:103], v2 offset:17408
    v_mfma_f32_16x16x32_bf16 v[248:251], a[248:251], v[200:203], v[248:251]
    v_exp_f32 v252, v252
    v_mfma_f32_16x16x32_bf16 v[248:251], a[252:255], v[232:235], v[248:251]
    v_exp_f32 v253, v253
    v_exp_f32 v254, v254
    v_exp_f32 v255, v255
    v_cvt_pk_bf16_f32 v60, v252, v253
    v_cvt_pk_bf16_f32 v61, v254, v255
    v_mfma_f32_16x16x32_bf16 v[252:255], a[240:243], v[140:143], v[156:159]
    v_exp_f32 v240, v240
    v_mfma_f32_16x16x32_bf16 v[252:255], a[244:247], v[172:175], v[252:255]
    v_exp_f32 v241, v241
    v_mfma_f32_16x16x32_bf16 v[252:255], a[248:251], v[204:207], v[252:255]
    v_exp_f32 v242, v242
    v_mfma_f32_16x16x32_bf16 v[252:255], a[252:255], v[236:239], v[252:255]
    v_exp_f32 v243, v243
    v_exp_f32 v244, v244
    v_exp_f32 v245, v245
    v_exp_f32 v246, v246
    v_exp_f32 v247, v247
    v_exp_f32 v248, v248
    v_exp_f32 v249, v249
    v_exp_f32 v250, v250
    v_exp_f32 v251, v251
    v_exp_f32 v252, v252
    v_exp_f32 v253, v253
    v_cvt_pk_bf16_f32 v38, v240, v241
    v_cvt_pk_bf16_f32 v39, v242, v243
    v_cvt_pk_bf16_f32 v46, v244, v245
    v_cvt_pk_bf16_f32 v47, v246, v247
    v_cvt_pk_bf16_f32 v54, v248, v249
    v_cvt_pk_bf16_f32 v55, v250, v251
    v_cvt_pk_bf16_f32 v62, v252, v253
    s_mov_b32 s78, s6
    s_cmp_eq_u32 s78, 0
    s_cbranch_scc1 K1_LB_END
.p2align 3
K1_LB:
    s_waitcnt lgkmcnt(0)
    v_mfma_f32_16x16x32_bf16 v[240:243], a[224:227], v[128:131], v[176:179]
    s_add_u32 m0, s76, s75
    v_exp_f32 v254, v254
    v_mfma_f32_16x16x32_bf16 v[240:243], a[228:231], v[160:163], v[240:243]
    s_mov_b32 s76, s60
    buffer_load_dwordx4 v1, s[36:39], s77 offen sc1 lds
    v_mfma_f32_16x16x32_bf16 v[240:243], a[232:235], v[192:195], v[240:243]
    s_mov_b32 s60, s82
    v_exp_f32 v255, v255
    v_mfma_f32_16x16x32_bf16 v[240:243], a[236:239], v[224:227], v[240:243]
    s_add_u32 s82, s82, 32768
    ds_read_b128 v[104:107], v2 offset:18432
    v_cvt_pk_bf16_f32 v63, v254, v255
    v_mfma_f32_16x16x32_bf16 a[0:3], v[96:99], v[32:35], a[0:3]
    ds_read_b128 v[108:111], v2 offset:19456
    ds_read_b128 a[240:243], v2 offset:4096
    v_mfma_f32_16x16x32_bf16 a[0:3], v[100:103], v[36:39], a[0:3]
    ds_read_b128 a[244:247], v2 offset:5120
    ds_read_b128 a[248:251], v2 offset:6144
    v_mfma_f32_16x16x32_bf16 a[4:7], v[96:99], v[40:43], a[4:7]
    ds_read_b128 a[252:255], v2 offset:7168
    ds_read_b128 v[112:115], v2 offset:20480
    v_mfma_f32_16x16x32_bf16 a[4:7], v[100:103], v[44:47], a[4:7]
    ds_read_b128 v[116:119], v2 offset:21504
    ds_read_b128 v[120:123], v2 offset:22528
    v_mfma_f32_16x16x32_bf16 v[244:247], a[224:227], v[132:135], v[148:151]
    v_exp_f32 v240, v240
    v_mfma_f32_16x16x32_bf16 v[244:247], a[228:231], v[164:167], v[244:247]
    v_exp_f32 v241, v241
    v_mfma_f32_16x16x32_bf16 v[244:247], a[232:235], v[196:199], v[244:247]
    v_exp_f32 v242, v242
    v_mfma_f32_16x16x32_bf16 v[244:247], a[236:239], v[228:231], v[244:247]
    v_exp_f32 v243, v243
    v_mfma_f32_16x16x32_bf16 a[8:11], v[96:99], v[48:51], a[8:11]
    v_cvt_pk_bf16_f32 v64, v240, v241
    v_cvt_pk_bf16_f32 v65, v242, v243
    v_mfma_f32_16x16x32_bf16 a[8:11], v[100:103], v[52:55], a[8:11]
    ds_read_b128 v[124:127], v2 offset:23552
    v_mfma_f32_16x16x32_bf16 a[12:15], v[96:99], v[56:59], a[12:15]
    ds_read_b128 v[96:99], v2 offset:24576
    v_mfma_f32_16x16x32_bf16 a[12:15], v[100:103], v[60:63], a[12:15]
    buffer_load_dwordx4 v1, s[36:39], s77 offen offset:1024 sc1 lds
    v_mfma_f32_16x16x32_bf16 v[248:251], a[224:227], v[136:139], v[152:155]
    v_exp_f32 v244, v244
    v_mfma_f32_16x16x32_bf16 v[248:251], a[228:231], v[168:171], v[248:251]
    v_exp_f32 v245, v245
    v_mfma_f32_16x16x32_bf16 v[248:251], a[232:235], v[200:203], v[248:251]
    v_exp_f32 v246, v246
    v_mfma_f32_16x16x32_bf16 v[248:251], a[236:239], v[232:235], v[248:251]
    s_waitcnt lgkmcnt(0)
    v_exp_f32 v247, v247
    v_mfma_f32_16x16x32_bf16 a[16:19], v[104:107], v[32:35], a[16:19]
    v_cvt_pk_bf16_f32 v72, v244, v245
    v_cvt_pk_bf16_f32 v73, v246, v247
    v_mfma_f32_16x16x32_bf16 a[16:19], v[108:111], v[36:39], a[16:19]
    ds_read_b128 v[100:103], v2 offset:25600
    v_mfma_f32_16x16x32_bf16 a[20:23], v[104:107], v[40:43], a[20:23]
    v_mfma_f32_16x16x32_bf16 a[20:23], v[108:111], v[44:47], a[20:23]
    v_exp_f32 v248, v248
    v_mfma_f32_16x16x32_bf16 v[252:255], a[224:227], v[140:143], v[156:159]
    v_exp_f32 v249, v249
    v_mfma_f32_16x16x32_bf16 v[252:255], a[228:231], v[172:175], v[252:255]
    v_exp_f32 v250, v250
    v_mfma_f32_16x16x32_bf16 v[252:255], a[232:235], v[204:207], v[252:255]
    v_exp_f32 v251, v251
    v_mfma_f32_16x16x32_bf16 v[252:255], a[236:239], v[236:239], v[252:255]
    v_cvt_pk_bf16_f32 v80, v248, v249
    v_cvt_pk_bf16_f32 v81, v250, v251
    v_mfma_f32_16x16x32_bf16 a[24:27], v[104:107], v[48:51], a[24:27]
    ds_read_b128 a[224:227], v2 offset:8192
    ds_read_b128 a[228:231], v2 offset:9216
    v_mfma_f32_16x16x32_bf16 a[24:27], v[108:111], v[52:55], a[24:27]
    buffer_load_dwordx4 v1, s[36:39], s77 offen offset:2048 sc1 lds
    v_mfma_f32_16x16x32_bf16 a[28:31], v[104:107], v[56:59], a[28:31]
    v_exp_f32 v252, v252
    v_mfma_f32_16x16x32_bf16 a[28:31], v[108:111], v[60:63], a[28:31]
    v_exp_f32 v253, v253
    v_mfma_f32_16x16x32_bf16 v[240:243], a[240:243], v[128:131], v[180:183]
    v_exp_f32 v254, v254
    v_mfma_f32_16x16x32_bf16 v[240:243], a[244:247], v[160:163], v[240:243]
    v_exp_f32 v255, v255
    v_mfma_f32_16x16x32_bf16 v[240:243], a[248:251], v[192:195], v[240:243]
    v_cvt_pk_bf16_f32 v88, v252, v253
    v_cvt_pk_bf16_f32 v89, v254, v255
    v_mfma_f32_16x16x32_bf16 v[240:243], a[252:255], v[224:227], v[240:243]
    ds_read_b128 a[232:235], v2 offset:10240
    ds_read_b128 a[236:239], v2 offset:11264
    v_mfma_f32_16x16x32_bf16 a[32:35], v[112:115], v[32:35], a[32:35]
    ds_read_b128 v[104:107], v2 offset:26624
    ds_read_b128 v[108:111], v2 offset:27648
    v_mfma_f32_16x16x32_bf16 a[32:35], v[116:119], v[36:39], a[32:35]
    v_mfma_f32_16x16x32_bf16 a[36:39], v[112:115], v[40:43], a[36:39]
    v_mfma_f32_16x16x32_bf16 a[36:39], v[116:119], v[44:47], a[36:39]
    v_exp_f32 v240, v240
    v_mfma_f32_16x16x32_bf16 v[244:247], a[240:243], v[132:135], v[148:151]
    v_exp_f32 v241, v241
    v_mfma_f32_16x16x32_bf16 v[244:247], a[244:247], v[164:167], v[244:247]
    v_exp_f32 v242, v242
    v_mfma_f32_16x16x32_bf16 v[244:247], a[248:251], v[196:199], v[244:247]
    v_exp_f32 v243, v243
    v_mfma_f32_16x16x32_bf16 v[244:247], a[252:255], v[228:231], v[244:247]
    buffer_load_dwordx4 v1, s[36:39], s77 offen offset:3072 sc1 lds
    v_mfma_f32_16x16x32_bf16 a[40:43], v[112:115], v[48:51], a[40:43]
    v_cvt_pk_bf16_f32 v66, v240, v241
    v_cvt_pk_bf16_f32 v67, v242, v243
    v_mfma_f32_16x16x32_bf16 a[40:43], v[116:119], v[52:55], a[40:43]
    v_mfma_f32_16x16x32_bf16 a[44:47], v[112:115], v[56:59], a[44:47]
    ds_read_b128 v[112:115], v2 offset:28672
    v_mfma_f32_16x16x32_bf16 a[44:47], v[116:119], v[60:63], a[44:47]
    v_exp_f32 v244, v244
    v_mfma_f32_16x16x32_bf16 v[248:251], a[240:243], v[136:139], v[152:155]
    v_exp_f32 v245, v245
    v_mfma_f32_16x16x32_bf16 v[248:251], a[244:247], v[168:171], v[248:251]
    v_exp_f32 v246, v246
    v_mfma_f32_16x16x32_bf16 v[248:251], a[248:251], v[200:203], v[248:251]
    v_exp_f32 v247, v247
    v_mfma_f32_16x16x32_bf16 v[248:251], a[252:255], v[232:235], v[248:251]
    v_cvt_pk_bf16_f32 v74, v244, v245
    v_cvt_pk_bf16_f32 v75, v246, v247
    v_mfma_f32_16x16x32_bf16 a[48:51], v[120:123], v[32:35], a[48:51]
    ds_read_b128 v[116:119], v2 offset:29696
    v_mfma_f32_16x16x32_bf16 a[48:51], v[124:127], v[36:39], a[48:51]
    v_mfma_f32_16x16x32_bf16 a[52:55], v[120:123], v[40:43], a[52:55]
    v_mfma_f32_16x16x32_bf16 a[52:55], v[124:127], v[44:47], a[52:55]
    v_mfma_f32_16x16x32_bf16 v[252:255], a[240:243], v[140:143], v[156:159]
    v_exp_f32 v248, v248
    v_mfma_f32_16x16x32_bf16 v[252:255], a[244:247], v[172:175], v[252:255]
    s_add_u32 s100, s77, 4096
    v_exp_f32 v249, v249
    v_mfma_f32_16x16x32_bf16 v[252:255], a[248:251], v[204:207], v[252:255]
    s_add_u32 m0, m0, 4096
    v_exp_f32 v250, v250
    v_mfma_f32_16x16x32_bf16 v[252:255], a[252:255], v[236:239], v[252:255]
    buffer_load_dwordx4 v1, s[36:39], s100 offen sc1 lds
    v_mfma_f32_16x16x32_bf16 a[56:59], v[120:123], v[48:51], a[56:59]
    v_exp_f32 v251, v251
    v_mfma_f32_16x16x32_bf16 a[56:59], v[124:127], v[52:55], a[56:59]
    v_cvt_pk_bf16_f32 v82, v248, v249
    v_cvt_pk_bf16_f32 v83, v250, v251
    v_mfma_f32_16x16x32_bf16 a[60:63], v[120:123], v[56:59], a[60:63]
    ds_read_b128 a[240:243], v2 offset:12288
    ds_read_b128 a[244:247], v2 offset:13312
    v_mfma_f32_16x16x32_bf16 a[60:63], v[124:127], v[60:63], a[60:63]
    s_waitcnt lgkmcnt(2)
    v_exp_f32 v252, v252
    v_mfma_f32_16x16x32_bf16 v[240:243], a[224:227], v[128:131], v[184:187]
    v_exp_f32 v253, v253
    v_mfma_f32_16x16x32_bf16 v[240:243], a[228:231], v[160:163], v[240:243]
    v_exp_f32 v254, v254
    v_mfma_f32_16x16x32_bf16 v[240:243], a[232:235], v[192:195], v[240:243]
    v_exp_f32 v255, v255
    v_mfma_f32_16x16x32_bf16 v[240:243], a[236:239], v[224:227], v[240:243]
    v_cvt_pk_bf16_f32 v90, v252, v253
    v_cvt_pk_bf16_f32 v91, v254, v255
    v_mfma_f32_16x16x32_bf16 a[144:147], v[96:99], v[32:35], a[144:147]
    ds_read_b128 a[248:251], v2 offset:14336
    ds_read_b128 a[252:255], v2 offset:15360
    v_mfma_f32_16x16x32_bf16 a[144:147], v[100:103], v[36:39], a[144:147]
    ds_read_b128 v[120:123], v2 offset:30720
    ds_read_b128 v[124:127], v2 offset:31744
    v_mfma_f32_16x16x32_bf16 a[148:151], v[96:99], v[40:43], a[148:151]
    v_exp_f32 v240, v240
    v_mfma_f32_16x16x32_bf16 a[148:151], v[100:103], v[44:47], a[148:151]
    v_exp_f32 v241, v241
    v_mfma_f32_16x16x32_bf16 v[244:247], a[224:227], v[132:135], v[148:151]
    buffer_load_dwordx4 v1, s[36:39], s100 offen offset:1024 sc1 lds
    v_mfma_f32_16x16x32_bf16 v[244:247], a[228:231], v[164:167], v[244:247]
    v_exp_f32 v242, v242
    v_mfma_f32_16x16x32_bf16 v[244:247], a[232:235], v[196:199], v[244:247]
    v_exp_f32 v243, v243
    v_mfma_f32_16x16x32_bf16 v[244:247], a[236:239], v[228:231], v[244:247]
    v_cvt_pk_bf16_f32 v68, v240, v241
    v_cvt_pk_bf16_f32 v69, v242, v243
    v_mfma_f32_16x16x32_bf16 a[152:155], v[96:99], v[48:51], a[152:155]
    v_mfma_f32_16x16x32_bf16 a[152:155], v[100:103], v[52:55], a[152:155]
    v_mfma_f32_16x16x32_bf16 a[156:159], v[96:99], v[56:59], a[156:159]
    v_mfma_f32_16x16x32_bf16 a[156:159], v[100:103], v[60:63], a[156:159]
    v_mfma_f32_16x16x32_bf16 v[248:251], a[224:227], v[136:139], v[152:155]
    v_mfma_f32_16x16x32_bf16 v[248:251], a[228:231], v[168:171], v[248:251]
    v_exp_f32 v244, v244
    v_mfma_f32_16x16x32_bf16 v[248:251], a[232:235], v[200:203], v[248:251]
    v_exp_f32 v245, v245
    v_mfma_f32_16x16x32_bf16 v[248:251], a[236:239], v[232:235], v[248:251]
    v_exp_f32 v246, v246
    v_mfma_f32_16x16x32_bf16 a[160:163], v[104:107], v[32:35], a[160:163]
    v_exp_f32 v247, v247
    v_mfma_f32_16x16x32_bf16 a[160:163], v[108:111], v[36:39], a[160:163]
    v_cvt_pk_bf16_f32 v76, v244, v245
    v_cvt_pk_bf16_f32 v77, v246, v247
    v_mfma_f32_16x16x32_bf16 a[164:167], v[104:107], v[40:43], a[164:167]
    buffer_load_dwordx4 v1, s[36:39], s100 offen offset:2048 sc1 lds
    v_mfma_f32_16x16x32_bf16 a[164:167], v[108:111], v[44:47], a[164:167]
    v_exp_f32 v248, v248
    v_mfma_f32_16x16x32_bf16 v[252:255], a[224:227], v[140:143], v[156:159]
    v_exp_f32 v249, v249
    v_mfma_f32_16x16x32_bf16 v[252:255], a[228:231], v[172:175], v[252:255]
    v_exp_f32 v250, v250
    v_mfma_f32_16x16x32_bf16 v[252:255], a[232:235], v[204:207], v[252:255]
    v_exp_f32 v251, v251
    v_mfma_f32_16x16x32_bf16 v[252:255], a[236:239], v[236:239], v[252:255]
    v_cvt_pk_bf16_f32 v84, v248, v249
    v_cvt_pk_bf16_f32 v85, v250, v251
    v_mfma_f32_16x16x32_bf16 a[168:171], v[104:107], v[48:51], a[168:171]
    v_mfma_f32_16x16x32_bf16 a[168:171], v[108:111], v[52:55], a[168:171]
    v_mfma_f32_16x16x32_bf16 a[172:175], v[104:107], v[56:59], a[172:175]
    v_mfma_f32_16x16x32_bf16 a[172:175], v[108:111], v[60:63], a[172:175]
    s_waitcnt lgkmcnt(0)
    v_mfma_f32_16x16x32_bf16 v[240:243], a[240:243], v[128:131], v[188:191]
    v_mfma_f32_16x16x32_bf16 v[240:243], a[244:247], v[160:163], v[240:243]
    v_exp_f32 v252, v252
    v_mfma_f32_16x16x32_bf16 v[240:243], a[248:251], v[192:195], v[240:243]
    v_exp_f32 v253, v253
    v_mfma_f32_16x16x32_bf16 v[240:243], a[252:255], v[224:227], v[240:243]
    v_exp_f32 v254, v254
    v_mfma_f32_16x16x32_bf16 a[176:179], v[112:115], v[32:35], a[176:179]
    buffer_load_dwordx4 v1, s[36:39], s100 offen offset:3072 sc1 lds
    v_mfma_f32_16x16x32_bf16 a[176:179], v[116:119], v[36:39], a[176:179]
    v_exp_f32 v255, v255
    v_mfma_f32_16x16x32_bf16 a[180:183], v[112:115], v[40:43], a[180:183]
    v_cvt_pk_bf16_f32 v92, v252, v253
    v_cvt_pk_bf16_f32 v93, v254, v255
    v_mfma_f32_16x16x32_bf16 a[180:183], v[116:119], v[44:47], a[180:183]
    s_cmp_eq_u32 s82, 163840
    s_cselect_b32 s82, 0, s82
    v_add_u32 v2, s82, v1
    v_mfma_f32_16x16x32_bf16 v[244:247], a[240:243], v[132:135], v[148:151]
    v_exp_f32 v240, v240
    v_mfma_f32_16x16x32_bf16 v[244:247], a[244:247], v[164:167], v[244:247]
    v_exp_f32 v241, v241
    v_mfma_f32_16x16x32_bf16 v[244:247], a[248:251], v[196:199], v[244:247]
    v_exp_f32 v242, v242
    v_mfma_f32_16x16x32_bf16 v[244:247], a[252:255], v[228:231], v[244:247]
    v_exp_f32 v243, v243
    v_mfma_f32_16x16x32_bf16 a[184:187], v[112:115], v[48:51], a[184:187]
    v_cvt_pk_bf16_f32 v70, v240, v241
    v_cvt_pk_bf16_f32 v71, v242, v243
    v_mfma_f32_16x16x32_bf16 a[184:187], v[116:119], v[52:55], a[184:187]
    v_mfma_f32_16x16x32_bf16 a[188:191], v[112:115], v[56:59], a[188:191]
    v_mfma_f32_16x16x32_bf16 a[188:191], v[116:119], v[60:63], a[188:191]
    v_mfma_f32_16x16x32_bf16 v[248:251], a[240:243], v[136:139], v[152:155]
    v_exp_f32 v244, v244
    v_mfma_f32_16x16x32_bf16 v[248:251], a[244:247], v[168:171], v[248:251]
    v_exp_f32 v245, v245
    v_mfma_f32_16x16x32_bf16 v[248:251], a[248:251], v[200:203], v[248:251]
    s_add_u32 s77, s77, 32768
    v_exp_f32 v246, v246
    v_mfma_f32_16x16x32_bf16 v[248:251], a[252:255], v[232:235], v[248:251]
    v_exp_f32 v247, v247
    v_mfma_f32_16x16x32_bf16 a[192:195], v[120:123], v[32:35], a[192:195]
    v_cvt_pk_bf16_f32 v78, v244, v245
    v_cvt_pk_bf16_f32 v79, v246, v247
    v_mfma_f32_16x16x32_bf16 a[192:195], v[124:127], v[36:39], a[192:195]
    v_mfma_f32_16x16x32_bf16 a[196:199], v[120:123], v[40:43], a[196:199]
    v_mfma_f32_16x16x32_bf16 a[196:199], v[124:127], v[44:47], a[196:199]
    v_mfma_f32_16x16x32_bf16 v[252:255], a[240:243], v[140:143], v[156:159]
    v_exp_f32 v248, v248
    v_mfma_f32_16x16x32_bf16 v[252:255], a[244:247], v[172:175], v[252:255]
    v_exp_f32 v249, v249
    v_mfma_f32_16x16x32_bf16 v[252:255], a[248:251], v[204:207], v[252:255]
    v_exp_f32 v250, v250
    v_mfma_f32_16x16x32_bf16 v[252:255], a[252:255], v[236:239], v[252:255]
    s_waitcnt vmcnt(16)
    s_barrier
    ds_read_b128 a[224:227], v2 offset:0
    v_mfma_f32_16x16x32_bf16 a[200:203], v[120:123], v[48:51], a[200:203]
    ds_read_b128 a[228:231], v2 offset:1024
    ds_read_b128 a[232:235], v2 offset:2048
    v_mfma_f32_16x16x32_bf16 a[200:203], v[124:127], v[52:55], a[200:203]
    ds_read_b128 a[236:239], v2 offset:3072
    ds_read_b128 v[96:99], v2 offset:16384
    v_mfma_f32_16x16x32_bf16 a[204:207], v[120:123], v[56:59], a[204:207]
    ds_read_b128 v[100:103], v2 offset:17408
    v_cvt_pk_bf16_f32 v86, v248, v249
    v_mfma_f32_16x16x32_bf16 a[204:207], v[124:127], v[60:63], a[204:207]
    v_exp_f32 v251, v251
    v_mfma_f32_16x16x32_bf16 a[208:211], a[136:139], v[32:35], a[208:211]
    v_exp_f32 v252, v252
    v_mfma_f32_16x16x32_bf16 a[208:211], a[136:139], v[36:39], a[208:211]
    v_exp_f32 v253, v253
    v_mfma_f32_16x16x32_bf16 a[212:215], a[136:139], v[40:43], a[212:215]
    v_cvt_pk_bf16_f32 v87, v250, v251
    v_cvt_pk_bf16_f32 v94, v252, v253
    v_mfma_f32_16x16x32_bf16 a[212:215], a[136:139], v[44:47], a[212:215]
    v_mfma_f32_16x16x32_bf16 a[216:219], a[136:139], v[48:51], a[216:219]
    v_mfma_f32_16x16x32_bf16 a[216:219], a[136:139], v[52:55], a[216:219]
    v_mfma_f32_16x16x32_bf16 a[220:223], a[136:139], v[56:59], a[220:223]
    v_mfma_f32_16x16x32_bf16 a[220:223], a[136:139], v[60:63], a[220:223]
    s_cmp_eq_u32 s78, 1
    s_cbranch_scc1 K1_LB_MASK
K1_LB_BACK:
    s_waitcnt lgkmcnt(0)
    v_mfma_f32_16x16x32_bf16 v[240:243], a[224:227], v[128:131], v[176:179]
    s_add_u32 m0, s76, s75
    v_exp_f32 v254, v254
    v_mfma_f32_16x16x32_bf16 v[240:243], a[228:231], v[160:163], v[240:243]
    s_mov_b32 s76, s60
    buffer_load_dwordx4 v1, s[36:39], s77 offen sc1 lds
    v_mfma_f32_16x16x32_bf16 v[240:243], a[232:235], v[192:195], v[240:243]
    s_mov_b32 s60, s82
    v_exp_f32 v255, v255
    v_mfma_f32_16x16x32_bf16 v[240:243], a[236:239], v[224:227], v[240:243]
    s_add_u32 s82, s82, 32768
    ds_read_b128 v[104:107], v2 offset:18432
    v_cvt_pk_bf16_f32 v95, v254, v255
    v_mfma_f32_16x16x32_bf16 a[0:3], v[96:99], v[64:67], a[0:3]
    ds_read_b128 v[108:111], v2 offset:19456
    ds_read_b128 a[240:243], v2 offset:4096
    v_mfma_f32_16x16x32_bf16 a[0:3], v[100:103], v[68:71], a[0:3]
    ds_read_b128 a[244:247], v2 offset:5120
    ds_read_b128 a[248:251], v2 offset:6144
    v_mfma_f32_16x16x32_bf16 a[4:7], v[96:99], v[72:75], a[4:7]
    ds_read_b128 a[252:255], v2 offset:7168
    ds_read_b128 v[112:115], v2 offset:20480
    v_mfma_f32_16x16x32_bf16 a[4:7], v[100:103], v[76:79], a[4:7]
    ds_read_b128 v[116:119], v2 offset:21504
    ds_read_b128 v[120:123], v2 offset:22528
    v_mfma_f32_16x16x32_bf16 v[244:247], a[224:227], v[132:135], v[148:151]
    v_exp_f32 v240, v240
    v_mfma_f32_16x16x32_bf16 v[244:247], a[228:231], v[164:167], v[244:247]
    v_exp_f32 v241, v241
    v_mfma_f32_16x16x32_bf16 v[244:247], a[232:235], v[196:199], v[244:247]
    v_exp_f32 v242, v242
    v_mfma_f32_16x16x32_bf16 v[244:247], a[236:239], v[228:231], v[244:247]
    v_exp_f32 v243, v243
    v_mfma_f32_16x16x32_bf16 a[8:11], v[96:99], v[80:83], a[8:11]
    v_cvt_pk_bf16_f32 v32, v240, v241
    v_cvt_pk_bf16_f32 v33, v242, v243
    v_mfma_f32_16x16x32_bf16 a[8:11], v[100:103], v[84:87], a[8:11]
    ds_read_b128 v[124:127], v2 offset:23552
    v_mfma_f32_16x16x32_bf16 a[12:15], v[96:99], v[88:91], a[12:15]
    ds_read_b128 v[96:99], v2 offset:24576
    v_mfma_f32_16x16x32_bf16 a[12:15], v[100:103], v[92:95], a[12:15]
    buffer_load_dwordx4 v1, s[36:39], s77 offen offset:1024 sc1 lds
    v_mfma_f32_16x16x32_bf16 v[248:251], a[224:227], v[136:139], v[152:155]
    v_exp_f32 v244, v244
    v_mfma_f32_16x16x32_bf16 v[248:251], a[228:231], v[168:171], v[248:251]
    v_exp_f32 v245, v245
    v_mfma_f32_16x16x32_bf16 v[248:251], a[232:235], v[200:203], v[248:251]
    v_exp_f32 v246, v246
    v_mfma_f32_16x16x32_bf16 v[248:251], a[236:239], v[232:235], v[248:251]
    s_waitcnt lgkmcnt(0)
    v_exp_f32 v247, v247
    v_mfma_f32_16x16x32_bf16 a[16:19], v[104:107], v[64:67], a[16:19]
    v_cvt_pk_bf16_f32 v40, v244, v245
    v_cvt_pk_bf16_f32 v41, v246, v247
    v_mfma_f32_16x16x32_bf16 a[16:19], v[108:111], v[68:71], a[16:19]
    ds_read_b128 v[100:103], v2 offset:25600
    v_mfma_f32_16x16x32_bf16 a[20:23], v[104:107], v[72:75], a[20:23]
    v_mfma_f32_16x16x32_bf16 a[20:23], v[108:111], v[76:79], a[20:23]
    v_exp_f32 v248, v248
    v_mfma_f32_16x16x32_bf16 v[252:255], a[224:227], v[140:143], v[156:159]
    v_exp_f32 v249, v249
    v_mfma_f32_16x16x32_bf16 v[252:255], a[228:231], v[172:175], v[252:255]
    v_exp_f32 v250, v250
    v_mfma_f32_16x16x32_bf16 v[252:255], a[232:235], v[204:207], v[252:255]
    v_exp_f32 v251, v251
    v_mfma_f32_16x16x32_bf16 v[252:255], a[236:239], v[236:239], v[252:255]
    v_cvt_pk_bf16_f32 v48, v248, v249
    v_cvt_pk_bf16_f32 v49, v250, v251
    v_mfma_f32_16x16x32_bf16 a[24:27], v[104:107], v[80:83], a[24:27]
    ds_read_b128 a[224:227], v2 offset:8192
    ds_read_b128 a[228:231], v2 offset:9216
    v_mfma_f32_16x16x32_bf16 a[24:27], v[108:111], v[84:87], a[24:27]
    buffer_load_dwordx4 v1, s[36:39], s77 offen offset:2048 sc1 lds
    v_mfma_f32_16x16x32_bf16 a[28:31], v[104:107], v[88:91], a[28:31]
    v_exp_f32 v252, v252
    v_mfma_f32_16x16x32_bf16 a[28:31], v[108:111], v[92:95], a[28:31]
    v_exp_f32 v253, v253
    v_mfma_f32_16x16x32_bf16 v[240:243], a[240:243], v[128:131], v[180:183]
    v_exp_f32 v254, v254
    v_mfma_f32_16x16x32_bf16 v[240:243], a[244:247], v[160:163], v[240:243]
    v_exp_f32 v255, v255
    v_mfma_f32_16x16x32_bf16 v[240:243], a[248:251], v[192:195], v[240:243]
    v_cvt_pk_bf16_f32 v56, v252, v253
    v_cvt_pk_bf16_f32 v57, v254, v255
    v_mfma_f32_16x16x32_bf16 v[240:243], a[252:255], v[224:227], v[240:243]
    ds_read_b128 a[232:235], v2 offset:10240
    ds_read_b128 a[236:239], v2 offset:11264
    v_mfma_f32_16x16x32_bf16 a[32:35], v[112:115], v[64:67], a[32:35]
    ds_read_b128 v[104:107], v2 offset:26624
    ds_read_b128 v[108:111], v2 offset:27648
    v_mfma_f32_16x16x32_bf16 a[32:35], v[116:119], v[68:71], a[32:35]
    v_mfma_f32_16x16x32_bf16 a[36:39], v[112:115], v[72:75], a[36:39]
    v_mfma_f32_16x16x32_bf16 a[36:39], v[116:119], v[76:79], a[36:39]
    v_exp_f32 v240, v240
    v_mfma_f32_16x16x32_bf16 v[244:247], a[240:243], v[132:135], v[148:151]
    v_exp_f32 v241, v241
    v_mfma_f32_16x16x32_bf16 v[244:247], a[244:247], v[164:167], v[244:247]
    v_exp_f32 v242, v242
    v_mfma_f32_16x16x32_bf16 v[244:247], a[248:251], v[196:199], v[244:247]
    v_exp_f32 v243, v243
    v_mfma_f32_16x16x32_bf16 v[244:247], a[252:255], v[228:231], v[244:247]
    buffer_load_dwordx4 v1, s[36:39], s77 offen offset:3072 sc1 lds
    v_mfma_f32_16x16x32_bf16 a[40:43], v[112:115], v[80:83], a[40:43]
    v_cvt_pk_bf16_f32 v34, v240, v241
    v_cvt_pk_bf16_f32 v35, v242, v243
    v_mfma_f32_16x16x32_bf16 a[40:43], v[116:119], v[84:87], a[40:43]
    v_mfma_f32_16x16x32_bf16 a[44:47], v[112:115], v[88:91], a[44:47]
    ds_read_b128 v[112:115], v2 offset:28672
    v_mfma_f32_16x16x32_bf16 a[44:47], v[116:119], v[92:95], a[44:47]
    v_exp_f32 v244, v244
    v_mfma_f32_16x16x32_bf16 v[248:251], a[240:243], v[136:139], v[152:155]
    v_exp_f32 v245, v245
    v_mfma_f32_16x16x32_bf16 v[248:251], a[244:247], v[168:171], v[248:251]
    v_exp_f32 v246, v246
    v_mfma_f32_16x16x32_bf16 v[248:251], a[248:251], v[200:203], v[248:251]
    v_exp_f32 v247, v247
    v_mfma_f32_16x16x32_bf16 v[248:251], a[252:255], v[232:235], v[248:251]
    v_cvt_pk_bf16_f32 v42, v244, v245
    v_cvt_pk_bf16_f32 v43, v246, v247
    v_mfma_f32_16x16x32_bf16 a[48:51], v[120:123], v[64:67], a[48:51]
    ds_read_b128 v[116:119], v2 offset:29696
    v_mfma_f32_16x16x32_bf16 a[48:51], v[124:127], v[68:71], a[48:51]
    v_mfma_f32_16x16x32_bf16 a[52:55], v[120:123], v[72:75], a[52:55]
    v_mfma_f32_16x16x32_bf16 a[52:55], v[124:127], v[76:79], a[52:55]
    v_mfma_f32_16x16x32_bf16 v[252:255], a[240:243], v[140:143], v[156:159]
    v_exp_f32 v248, v248
    v_mfma_f32_16x16x32_bf16 v[252:255], a[244:247], v[172:175], v[252:255]
    s_add_u32 s100, s77, 4096
    v_exp_f32 v249, v249
    v_mfma_f32_16x16x32_bf16 v[252:255], a[248:251], v[204:207], v[252:255]
    s_add_u32 m0, m0, 4096
    v_exp_f32 v250, v250
    v_mfma_f32_16x16x32_bf16 v[252:255], a[252:255], v[236:239], v[252:255]
    buffer_load_dwordx4 v1, s[36:39], s100 offen sc1 lds
    v_mfma_f32_16x16x32_bf16 a[56:59], v[120:123], v[80:83], a[56:59]
    v_exp_f32 v251, v251
    v_mfma_f32_16x16x32_bf16 a[56:59], v[124:127], v[84:87], a[56:59]
    v_cvt_pk_bf16_f32 v50, v248, v249
    v_cvt_pk_bf16_f32 v51, v250, v251
    v_mfma_f32_16x16x32_bf16 a[60:63], v[120:123], v[88:91], a[60:63]
    ds_read_b128 a[240:243], v2 offset:12288
    ds_read_b128 a[244:247], v2 offset:13312
    v_mfma_f32_16x16x32_bf16 a[60:63], v[124:127], v[92:95], a[60:63]
    s_waitcnt lgkmcnt(2)
    v_exp_f32 v252, v252
    v_mfma_f32_16x16x32_bf16 v[240:243], a[224:227], v[128:131], v[184:187]
    v_exp_f32 v253, v253
    v_mfma_f32_16x16x32_bf16 v[240:243], a[228:231], v[160:163], v[240:243]
    v_exp_f32 v254, v254
    v_mfma_f32_16x16x32_bf16 v[240:243], a[232:235], v[192:195], v[240:243]
    v_exp_f32 v255, v255
    v_mfma_f32_16x16x32_bf16 v[240:243], a[236:239], v[224:227], v[240:243]
    v_cvt_pk_bf16_f32 v58, v252, v253
    v_cvt_pk_bf16_f32 v59, v254, v255
    v_mfma_f32_16x16x32_bf16 a[144:147], v[96:99], v[64:67], a[144:147]
    ds_read_b128 a[248:251], v2 offset:14336
    ds_read_b128 a[252:255], v2 offset:15360
    v_mfma_f32_16x16x32_bf16 a[144:147], v[100:103], v[68:71], a[144:147]
    ds_read_b128 v[120:123], v2 offset:30720
    ds_read_b128 v[124:127], v2 offset:31744
    v_mfma_f32_16x16x32_bf16 a[148:151], v[96:99], v[72:75], a[148:151]
    v_exp_f32 v240, v240
    v_mfma_f32_16x16x32_bf16 a[148:151], v[100:103], v[76:79], a[148:151]
    v_exp_f32 v241, v241
    v_mfma_f32_16x16x32_bf16 v[244:247], a[224:227], v[132:135], v[148:151]
    buffer_load_dwordx4 v1, s[36:39], s100 offen offset:1024 sc1 lds
    v_mfma_f32_16x16x32_bf16 v[244:247], a[228:231], v[164:167], v[244:247]
    v_exp_f32 v242, v242
    v_mfma_f32_16x16x32_bf16 v[244:247], a[232:235], v[196:199], v[244:247]
    v_exp_f32 v243, v243
    v_mfma_f32_16x16x32_bf16 v[244:247], a[236:239], v[228:231], v[244:247]
    v_cvt_pk_bf16_f32 v36, v240, v241
    v_cvt_pk_bf16_f32 v37, v242, v243
    v_mfma_f32_16x16x32_bf16 a[152:155], v[96:99], v[80:83], a[152:155]
    v_mfma_f32_16x16x32_bf16 a[152:155], v[100:103], v[84:87], a[152:155]
    v_mfma_f32_16x16x32_bf16 a[156:159], v[96:99], v[88:91], a[156:159]
    v_mfma_f32_16x16x32_bf16 a[156:159], v[100:103], v[92:95], a[156:159]
    v_mfma_f32_16x16x32_bf16 v[248:251], a[224:227], v[136:139], v[152:155]
    v_mfma_f32_16x16x32_bf16 v[248:251], a[228:231], v[168:171], v[248:251]
    v_exp_f32 v244, v244
    v_mfma_f32_16x16x32_bf16 v[248:251], a[232:235], v[200:203], v[248:251]
    v_exp_f32 v245, v245
    v_mfma_f32_16x16x32_bf16 v[248:251], a[236:239], v[232:235], v[248:251]
    v_exp_f32 v246, v246
    v_mfma_f32_16x16x32_bf16 a[160:163], v[104:107], v[64:67], a[160:163]
    v_exp_f32 v247, v247
    v_mfma_f32_16x16x32_bf16 a[160:163], v[108:111], v[68:71], a[160:163]
    v_cvt_pk_bf16_f32 v44, v244, v245
    v_cvt_pk_bf16_f32 v45, v246, v247
    v_mfma_f32_16x16x32_bf16 a[164:167], v[104:107], v[72:75], a[164:167]
    buffer_load_dwordx4 v1, s[36:39], s100 offen offset:2048 sc1 lds
    v_mfma_f32_16x16x32_bf16 a[164:167], v[108:111], v[76:79], a[164:167]
    v_exp_f32 v248, v248
    v_mfma_f32_16x16x32_bf16 v[252:255], a[224:227], v[140:143], v[156:159]
    v_exp_f32 v249, v249
    v_mfma_f32_16x16x32_bf16 v[252:255], a[228:231], v[172:175], v[252:255]
    v_exp_f32 v250, v250
    v_mfma_f32_16x16x32_bf16 v[252:255], a[232:235], v[204:207], v[252:255]
    v_exp_f32 v251, v251
    v_mfma_f32_16x16x32_bf16 v[252:255], a[236:239], v[236:239], v[252:255]
    v_cvt_pk_bf16_f32 v52, v248, v249
    v_cvt_pk_bf16_f32 v53, v250, v251
    v_mfma_f32_16x16x32_bf16 a[168:171], v[104:107], v[80:83], a[168:171]
    v_mfma_f32_16x16x32_bf16 a[168:171], v[108:111], v[84:87], a[168:171]
    v_mfma_f32_16x16x32_bf16 a[172:175], v[104:107], v[88:91], a[172:175]
    v_mfma_f32_16x16x32_bf16 a[172:175], v[108:111], v[92:95], a[172:175]
    s_waitcnt lgkmcnt(0)
    v_mfma_f32_16x16x32_bf16 v[240:243], a[240:243], v[128:131], v[188:191]
    v_mfma_f32_16x16x32_bf16 v[240:243], a[244:247], v[160:163], v[240:243]
    v_exp_f32 v252, v252
    v_mfma_f32_16x16x32_bf16 v[240:243], a[248:251], v[192:195], v[240:243]
    v_exp_f32 v253, v253
    v_mfma_f32_16x16x32_bf16 v[240:243], a[252:255], v[224:227], v[240:243]
    v_exp_f32 v254, v254
    v_mfma_f32_16x16x32_bf16 a[176:179], v[112:115], v[64:67], a[176:179]
    buffer_load_dwordx4 v1, s[36:39], s100 offen offset:3072 sc1 lds
    v_mfma_f32_16x16x32_bf16 a[176:179], v[116:119], v[68:71], a[176:179]
    v_exp_f32 v255, v255
    v_mfma_f32_16x16x32_bf16 a[180:183], v[112:115], v[72:75], a[180:183]
    v_cvt_pk_bf16_f32 v60, v252, v253
    v_cvt_pk_bf16_f32 v61, v254, v255
    v_mfma_f32_16x16x32_bf16 a[180:183], v[116:119], v[76:79], a[180:183]
    s_cmp_eq_u32 s82, 163840
    s_cselect_b32 s82, 0, s82
    v_add_u32 v2, s82, v1
    v_mfma_f32_16x16x32_bf16 v[244:247], a[240:243], v[132:135], v[148:151]
    v_exp_f32 v240, v240
    v_mfma_f32_16x16x32_bf16 v[244:247], a[244:247], v[164:167], v[244:247]
    v_exp_f32 v241, v241
    v_mfma_f32_16x16x32_bf16 v[244:247], a[248:251], v[196:199], v[244:247]
    v_exp_f32 v242, v242
    v_mfma_f32_16x16x32_bf16 v[244:247], a[252:255], v[228:231], v[244:247]
    v_exp_f32 v243, v243
    v_mfma_f32_16x16x32_bf16 a[184:187], v[112:115], v[80:83], a[184:187]
    v_cvt_pk_bf16_f32 v38, v240, v241
    v_cvt_pk_bf16_f32 v39, v242, v243
    v_mfma_f32_16x16x32_bf16 a[184:187], v[116:119], v[84:87], a[184:187]
    v_mfma_f32_16x16x32_bf16 a[188:191], v[112:115], v[88:91], a[188:191]
    v_mfma_f32_16x16x32_bf16 a[188:191], v[116:119], v[92:95], a[188:191]
    v_mfma_f32_16x16x32_bf16 v[248:251], a[240:243], v[136:139], v[152:155]
    v_exp_f32 v244, v244
    v_mfma_f32_16x16x32_bf16 v[248:251], a[244:247], v[168:171], v[248:251]
    v_exp_f32 v245, v245
    v_mfma_f32_16x16x32_bf16 v[248:251], a[248:251], v[200:203], v[248:251]
    s_add_u32 s77, s77, 32768
    v_exp_f32 v246, v246
    v_mfma_f32_16x16x32_bf16 v[248:251], a[252:255], v[232:235], v[248:251]
    v_exp_f32 v247, v247
    v_mfma_f32_16x16x32_bf16 a[192:195], v[120:123], v[64:67], a[192:195]
    v_cvt_pk_bf16_f32 v46, v244, v245
    v_cvt_pk_bf16_f32 v47, v246, v247
    v_mfma_f32_16x16x32_bf16 a[192:195], v[124:127], v[68:71], a[192:195]
    v_mfma_f32_16x16x32_bf16 a[196:199], v[120:123], v[72:75], a[196:199]
    v_mfma_f32_16x16x32_bf16 a[196:199], v[124:127], v[76:79], a[196:199]
    v_mfma_f32_16x16x32_bf16 v[252:255], a[240:243], v[140:143], v[156:159]
    v_exp_f32 v248, v248
    v_mfma_f32_16x16x32_bf16 v[252:255], a[244:247], v[172:175], v[252:255]
    v_exp_f32 v249, v249
    v_mfma_f32_16x16x32_bf16 v[252:255], a[248:251], v[204:207], v[252:255]
    v_exp_f32 v250, v250
    v_mfma_f32_16x16x32_bf16 v[252:255], a[252:255], v[236:239], v[252:255]
    s_waitcnt vmcnt(16)
    s_barrier
    ds_read_b128 a[224:227], v2 offset:0
    v_mfma_f32_16x16x32_bf16 a[200:203], v[120:123], v[80:83], a[200:203]
    ds_read_b128 a[228:231], v2 offset:1024
    ds_read_b128 a[232:235], v2 offset:2048
    v_mfma_f32_16x16x32_bf16 a[200:203], v[124:127], v[84:87], a[200:203]
    ds_read_b128 a[236:239], v2 offset:3072
    ds_read_b128 v[96:99], v2 offset:16384
    v_mfma_f32_16x16x32_bf16 a[204:207], v[120:123], v[88:91], a[204:207]
    ds_read_b128 v[100:103], v2 offset:17408
    v_cvt_pk_bf16_f32 v54, v248, v249
    v_mfma_f32_16x16x32_bf16 a[204:207], v[124:127], v[92:95], a[204:207]
    v_exp_f32 v251, v251
    v_mfma_f32_16x16x32_bf16 a[208:211], a[136:139], v[64:67], a[208:211]
    v_exp_f32 v252, v252
    v_mfma_f32_16x16x32_bf16 a[208:211], a[136:139], v[68:71], a[208:211]
    v_exp_f32 v253, v253
    v_mfma_f32_16x16x32_bf16 a[212:215], a[136:139], v[72:75], a[212:215]
    v_cvt_pk_bf16_f32 v55, v250, v251
    v_cvt_pk_bf16_f32 v62, v252, v253
    v_mfma_f32_16x16x32_bf16 a[212:215], a[136:139], v[76:79], a[212:215]
    v_mfma_f32_16x16x32_bf16 a[216:219], a[136:139], v[80:83], a[216:219]
    v_mfma_f32_16x16x32_bf16 a[216:219], a[136:139], v[84:87], a[216:219]
    v_mfma_f32_16x16x32_bf16 a[220:223], a[136:139], v[88:91], a[220:223]
    v_mfma_f32_16x16x32_bf16 a[220:223], a[136:139], v[92:95], a[220:223]
    s_sub_u32 s78, s78, 1
    s_cmp_lg_u32 s78, 0
    s_cbranch_scc1 K1_LB
K1_LB_END:
    v_add_f32 v212, s12, v148
    v_fma_f32 v176, v208, s8, v212
    v_fma_f32 v177, v209, s8, v212
    v_fma_f32 v178, v210, s8, v212
    v_fma_f32 v179, v211, s8, v212
    s_nop 1
    s_waitcnt lgkmcnt(0)
    v_mfma_f32_16x16x32_bf16 v[240:243], a[224:227], v[132:135], v[176:179]
    s_add_u32 m0, s76, s75
    ds_read_b128 v[104:107], v2 offset:18432
    ds_read_b128 v[108:111], v2 offset:19456
    v_mfma_f32_16x16x32_bf16 v[240:243], a[228:231], v[164:167], v[240:243]
    s_mov_b32 s76, s60
    buffer_load_dwordx4 v1, s[36:39], s77 offen sc1 lds
    v_mfma_f32_16x16x32_bf16 v[240:243], a[232:235], v[196:199], v[240:243]
    s_mov_b32 s60, s82
    v_exp_f32 v254, v254
    v_mfma_f32_16x16x32_bf16 v[240:243], a[236:239], v[228:231], v[240:243]
    s_add_u32 s82, s82, 32768
    v_exp_f32 v255, v255
    v_mfma_f32_16x16x32_bf16 a[0:3], v[96:99], v[32:35], a[0:3]
    s_mov_b32 s98, 0x3fb8aa3b
    v_cvt_pk_bf16_f32 v63, v254, v255
    ds_read_b128 a[240:243], v2 offset:4096
    v_mfma_f32_16x16x32_bf16 a[0:3], v[100:103], v[36:39], a[0:3]
    ds_read_b128 a[244:247], v2 offset:5120
    ds_read_b128 a[248:251], v2 offset:6144
    v_mfma_f32_16x16x32_bf16 a[4:7], v[96:99], v[40:43], a[4:7]
    ds_read_b128 a[252:255], v2 offset:7168
    ds_read_b128 v[112:115], v2 offset:20480
    v_mfma_f32_16x16x32_bf16 a[4:7], v[100:103], v[44:47], a[4:7]
    v_add_f32 v213, s13, v148
    ds_read_b128 v[116:119], v2 offset:21504
    v_mfma_f32_16x16x32_bf16 v[244:247], a[224:227], v[136:139], v[152:155]
    v_fma_f32 v180, v208, s9, v213
    v_fma_f32 v181, v209, s9, v213
    v_mfma_f32_16x16x32_bf16 v[244:247], a[228:231], v[168:171], v[244:247]
    v_fma_f32 v182, v210, s9, v213
    v_fma_f32 v183, v211, s9, v213
    v_mfma_f32_16x16x32_bf16 v[244:247], a[232:235], v[200:203], v[244:247]
    v_exp_f32 v240, v240
    v_mfma_f32_16x16x32_bf16 v[244:247], a[236:239], v[232:235], v[244:247]
    v_exp_f32 v241, v241
    v_mfma_f32_16x16x32_bf16 a[8:11], v[96:99], v[48:51], a[8:11]
    v_exp_f32 v242, v242
    v_mfma_f32_16x16x32_bf16 a[8:11], v[100:103], v[52:55], a[8:11]
    buffer_load_dwordx4 v1, s[36:39], s77 offen offset:1024 sc1 lds
    v_mfma_f32_16x16x32_bf16 a[12:15], v[96:99], v[56:59], a[12:15]
    v_exp_f32 v243, v243
    v_mfma_f32_16x16x32_bf16 a[12:15], v[100:103], v[60:63], a[12:15]
    s_waitcnt lgkmcnt(0)
    v_cvt_pk_bf16_f32 v72, v240, v241
    v_cvt_pk_bf16_f32 v73, v242, v243
    v_mfma_f32_16x16x32_bf16 a[16:19], v[104:107], v[32:35], a[16:19]
    ds_read_b128 v[120:123], v2 offset:22528
    ds_read_b128 v[124:127], v2 offset:23552
    v_mfma_f32_16x16x32_bf16 a[16:19], v[108:111], v[36:39], a[16:19]
    v_exp_f32 v244, v244
    v_mfma_f32_16x16x32_bf16 v[248:251], a[224:227], v[140:143], v[156:159]
    v_exp_f32 v245, v245
    v_mfma_f32_16x16x32_bf16 v[248:251], a[228:231], v[172:175], v[248:251]
    v_exp_f32 v246, v246
    v_mfma_f32_16x16x32_bf16 v[248:251], a[232:235], v[204:207], v[248:251]
    v_exp_f32 v247, v247
    v_mfma_f32_16x16x32_bf16 v[248:251], a[236:239], v[236:239], v[248:251]
    v_cvt_pk_bf16_f32 v80, v244, v245
    v_cvt_pk_bf16_f32 v81, v246, v247
    v_mfma_f32_16x16x32_bf16 a[20:23], v[104:107], v[40:43], a[20:23]
    ds_read_b128 a[224:227], v2 offset:8192
    ds_read_b128 a[228:231], v2 offset:9216
    v_mfma_f32_16x16x32_bf16 a[20:23], v[108:111], v[44:47], a[20:23]
    ds_read_b128 a[232:235], v2 offset:10240
    ds_read_b128 a[236:239], v2 offset:11264
    v_mfma_f32_16x16x32_bf16 a[24:27], v[104:107], v[48:51], a[24:27]
    ds_read_b128 v[96:99], v2 offset:24576
    v_add_f32 v214, s14, v148
    v_mfma_f32_16x16x32_bf16 a[24:27], v[108:111], v[52:55], a[24:27]
    buffer_load_dwordx4 v1, s[36:39], s77 offen offset:2048 sc1 lds
    v_mfma_f32_16x16x32_bf16 a[28:31], v[104:107], v[56:59], a[28:31]
    ds_read_b128 v[100:103], v2 offset:25600
    v_fma_f32 v184, v208, s10, v214
    v_mfma_f32_16x16x32_bf16 a[28:31], v[108:111], v[60:63], a[28:31]
    v_exp_f32 v248, v248
    v_mfma_f32_16x16x32_bf16 v[252:255], a[240:243], v[132:135], v[180:183]
    v_exp_f32 v249, v249
    v_mfma_f32_16x16x32_bf16 v[252:255], a[244:247], v[164:167], v[252:255]
    v_exp_f32 v250, v250
    v_mfma_f32_16x16x32_bf16 v[252:255], a[248:251], v[196:199], v[252:255]
    v_exp_f32 v251, v251
    v_mfma_f32_16x16x32_bf16 v[252:255], a[252:255], v[228:231], v[252:255]
    v_fma_f32 v185, v209, s10, v214
    v_fma_f32 v186, v210, s10, v214
    v_mfma_f32_16x16x32_bf16 a[32:35], v[112:115], v[32:35], a[32:35]
    v_fma_f32 v187, v211, s10, v214
    v_cvt_pk_bf16_f32 v88, v248, v249
    v_mfma_f32_16x16x32_bf16 a[32:35], v[116:119], v[36:39], a[32:35]
    v_cvt_pk_bf16_f32 v89, v250, v251
    ds_read_b128 v[104:107], v2 offset:26624
    v_mfma_f32_16x16x32_bf16 a[36:39], v[112:115], v[40:43], a[36:39]
    v_exp_f32 v252, v252
    v_mfma_f32_16x16x32_bf16 a[36:39], v[116:119], v[44:47], a[36:39]
    v_exp_f32 v253, v253
    v_mfma_f32_16x16x32_bf16 v[240:243], a[240:243], v[136:139], v[152:155]
    v_exp_f32 v254, v254
    v_mfma_f32_16x16x32_bf16 v[240:243], a[244:247], v[168:171], v[240:243]
    buffer_load_dwordx4 v1, s[36:39], s77 offen offset:3072 sc1 lds
    v_mfma_f32_16x16x32_bf16 v[240:243], a[248:251], v[200:203], v[240:243]
    v_exp_f32 v255, v255
    v_mfma_f32_16x16x32_bf16 v[240:243], a[252:255], v[232:235], v[240:243]
    v_cvt_pk_bf16_f32 v74, v252, v253
    v_cvt_pk_bf16_f32 v75, v254, v255
    v_mfma_f32_16x16x32_bf16 a[40:43], v[112:115], v[48:51], a[40:43]
    ds_read_b128 v[108:111], v2 offset:27648
    v_add_f32 v215, s15, v148
    v_mfma_f32_16x16x32_bf16 a[40:43], v[116:119], v[52:55], a[40:43]
    v_fma_f32 v188, v208, s11, v215
    v_fma_f32 v189, v209, s11, v215
    v_mfma_f32_16x16x32_bf16 a[44:47], v[112:115], v[56:59], a[44:47]
    v_exp_f32 v240, v240
    v_mfma_f32_16x16x32_bf16 a[44:47], v[116:119], v[60:63], a[44:47]
    s_waitcnt lgkmcnt(1)
    v_exp_f32 v241, v241
    v_mfma_f32_16x16x32_bf16 a[48:51], v[120:123], v[32:35], a[48:51]
    v_exp_f32 v242, v242
    v_mfma_f32_16x16x32_bf16 a[48:51], v[124:127], v[36:39], a[48:51]
    v_exp_f32 v243, v243
    v_mfma_f32_16x16x32_bf16 v[244:247], a[240:243], v[140:143], v[156:159]
    v_cvt_pk_bf16_f32 v82, v240, v241
    v_cvt_pk_bf16_f32 v83, v242, v243
    v_mfma_f32_16x16x32_bf16 v[244:247], a[244:247], v[172:175], v[244:247]
    ds_read_b128 a[240:243], v2 offset:12288
    ds_read_b128 a[244:247], v2 offset:13312
    v_mfma_f32_16x16x32_bf16 v[244:247], a[248:251], v[204:207], v[244:247]
    ds_read_b128 a[248:251], v2 offset:14336
    ds_read_b128 v[112:115], v2 offset:28672
    v_mfma_f32_16x16x32_bf16 v[244:247], a[252:255], v[236:239], v[244:247]
    s_add_u32 s100, s77, 4096
    ds_read_b128 a[252:255], v2 offset:15360
    ds_read_b128 v[116:119], v2 offset:29696
    v_mfma_f32_16x16x32_bf16 a[52:55], v[120:123], v[40:43], a[52:55]
    s_add_u32 m0, m0, 4096
    v_fma_f32 v190, v210, s11, v215
    v_fma_f32 v191, v211, s11, v215
    v_mfma_f32_16x16x32_bf16 a[52:55], v[124:127], v[44:47], a[52:55]
    buffer_load_dwordx4 v1, s[36:39], s100 offen sc1 lds
    v_mfma_f32_16x16x32_bf16 a[56:59], v[120:123], v[48:51], a[56:59]
    v_exp_f32 v244, v244
    v_mfma_f32_16x16x32_bf16 a[56:59], v[124:127], v[52:55], a[56:59]
    v_exp_f32 v245, v245
    v_mfma_f32_16x16x32_bf16 a[60:63], v[120:123], v[56:59], a[60:63]
    v_exp_f32 v246, v246
    v_mfma_f32_16x16x32_bf16 a[60:63], v[124:127], v[60:63], a[60:63]
    v_exp_f32 v247, v247
    v_mfma_f32_16x16x32_bf16 v[248:251], a[224:227], v[132:135], v[184:187]
    v_cvt_pk_bf16_f32 v90, v244, v245
    v_cvt_pk_bf16_f32 v91, v246, v247
    v_mfma_f32_16x16x32_bf16 v[248:251], a[228:231], v[164:167], v[248:251]
    ds_read_b128 v[120:123], v2 offset:30720
    ds_read_b128 v[124:127], v2 offset:31744
    v_mfma_f32_16x16x32_bf16 v[248:251], a[232:235], v[196:199], v[248:251]
    s_cmp_eq_u32 s82, 163840
    s_cselect_b32 s82, 0, s82
    v_add_u32 v2, s82, v1
    v_mfma_f32_16x16x32_bf16 v[248:251], a[236:239], v[228:231], v[248:251]
    v_mov_b32 v9, 1
    v_bfe_u32 v8, v1, 2, 6
    v_mfma_f32_16x16x32_bf16 a[144:147], v[96:99], v[32:35], a[144:147]
    v_accvgpr_read_b32 v4, a112
    v_accvgpr_read_b32 v5, a116
    v_mfma_f32_16x16x32_bf16 a[144:147], v[100:103], v[36:39], a[144:147]
    v_accvgpr_read_b32 v6, a120
    v_add_u32 v8, 192, v8
    v_mfma_f32_16x16x32_bf16 a[148:151], v[96:99], v[40:43], a[148:151]
    buffer_load_dwordx4 v1, s[36:39], s100 offen offset:1024 sc1 lds
    v_mfma_f32_16x16x32_bf16 a[148:151], v[100:103], v[44:47], a[148:151]
    v_exp_f32 v248, v248
    v_mfma_f32_16x16x32_bf16 v[252:255], a[224:227], v[136:139], v[152:155]
    v_exp_f32 v249, v249
    v_mfma_f32_16x16x32_bf16 v[252:255], a[228:231], v[168:171], v[252:255]
    v_exp_f32 v250, v250
    v_mfma_f32_16x16x32_bf16 v[252:255], a[232:235], v[200:203], v[252:255]
    v_exp_f32 v251, v251
    v_mfma_f32_16x16x32_bf16 v[252:255], a[236:239], v[232:235], v[252:255]
    v_cvt_pk_bf16_f32 v76, v248, v249
    v_cvt_pk_bf16_f32 v77, v250, v251
    v_mfma_f32_16x16x32_bf16 a[152:155], v[96:99], v[48:51], a[152:155]
    v_cvt_pk_bf16_f32 v4, 0, v4
    v_cvt_pk_bf16_f32 v5, 0, v5
    v_mfma_f32_16x16x32_bf16 a[152:155], v[100:103], v[52:55], a[152:155]
    v_cvt_pk_bf16_f32 v6, 0, v6
    ds_bpermute_b32 v4, v8, v4
    v_mfma_f32_16x16x32_bf16 a[156:159], v[96:99], v[56:59], a[156:159]
    v_exp_f32 v252, v252
    v_mfma_f32_16x16x32_bf16 a[156:159], v[100:103], v[60:63], a[156:159]
    v_exp_f32 v253, v253
    v_mfma_f32_16x16x32_bf16 a[160:163], v[104:107], v[32:35], a[160:163]
    s_waitcnt lgkmcnt(1)
    v_exp_f32 v254, v254
    v_mfma_f32_16x16x32_bf16 a[160:163], v[108:111], v[36:39], a[160:163]
    v_exp_f32 v255, v255
    v_mfma_f32_16x16x32_bf16 v[240:243], a[224:227], v[140:143], v[156:159]
    buffer_load_dwordx4 v1, s[36:39], s100 offen offset:2048 sc1 lds
    v_mfma_f32_16x16x32_bf16 v[240:243], a[228:231], v[172:175], v[240:243]
    v_cvt_pk_bf16_f32 v84, v252, v253
    v_cvt_pk_bf16_f32 v85, v254, v255
    v_mfma_f32_16x16x32_bf16 v[240:243], a[232:235], v[204:207], v[240:243]
    ds_bpermute_b32 v5, v8, v5
    ds_bpermute_b32 v6, v8, v6
    v_mfma_f32_16x16x32_bf16 v[240:243], a[236:239], v[236:239], v[240:243]
    s_waitcnt lgkmcnt(1)
    v_mul_f32 v4, s98, v4
    v_mul_f32 v5, s98, v5
    v_mfma_f32_16x16x32_bf16 a[164:167], v[104:107], v[40:43], a[164:167]
    s_waitcnt lgkmcnt(0)
    v_mul_f32 v6, s98, v6
    v_mfma_f32_16x16x32_bf16 a[164:167], v[108:111], v[44:47], a[164:167]
    v_exp_f32 v4, v4
    v_mfma_f32_16x16x32_bf16 a[168:171], v[104:107], v[48:51], a[168:171]
    v_exp_f32 v5, v5
    v_mfma_f32_16x16x32_bf16 a[168:171], v[108:111], v[52:55], a[168:171]
    v_exp_f32 v240, v240
    v_mfma_f32_16x16x32_bf16 a[172:175], v[104:107], v[56:59], a[172:175]
    v_exp_f32 v241, v241
    v_mfma_f32_16x16x32_bf16 a[172:175], v[108:111], v[60:63], a[172:175]
    v_exp_f32 v242, v242
    v_mfma_f32_16x16x32_bf16 v[244:247], a[240:243], v[132:135], v[188:191]
    v_exp_f32 v243, v243
    v_mfma_f32_16x16x32_bf16 v[244:247], a[244:247], v[164:167], v[244:247]
    v_cvt_pk_bf16_f32 v92, v240, v241
    v_cvt_pk_bf16_f32 v93, v242, v243
    v_mfma_f32_16x16x32_bf16 v[244:247], a[248:251], v[196:199], v[244:247]
    buffer_load_dwordx4 v1, s[36:39], s100 offen offset:3072 sc1 lds
    v_mfma_f32_16x16x32_bf16 v[244:247], a[252:255], v[228:231], v[244:247]
    buffer_atomic_add v9, v30, s[44:47], s95 offen sc1
    v_mfma_f32_16x16x32_bf16 a[176:179], v[112:115], v[32:35], a[176:179]
    v_exp_f32 v6, v6
    v_mfma_f32_16x16x32_bf16 a[176:179], v[116:119], v[36:39], a[176:179]
    v_add_f32 v4, 1.0, v4
    v_add_f32 v5, 1.0, v5
    v_mfma_f32_16x16x32_bf16 a[180:183], v[112:115], v[40:43], a[180:183]
    v_add_f32 v6, 1.0, v6
    v_mfma_f32_16x16x32_bf16 a[180:183], v[116:119], v[44:47], a[180:183]
    v_exp_f32 v244, v244
    v_mfma_f32_16x16x32_bf16 v[248:251], a[240:243], v[136:139], v[152:155]
    v_exp_f32 v245, v245
    v_mfma_f32_16x16x32_bf16 v[248:251], a[244:247], v[168:171], v[248:251]
    v_exp_f32 v246, v246
    v_mfma_f32_16x16x32_bf16 v[248:251], a[248:251], v[200:203], v[248:251]
    v_exp_f32 v247, v247
    v_mfma_f32_16x16x32_bf16 v[248:251], a[252:255], v[232:235], v[248:251]
    v_cvt_pk_bf16_f32 v78, v244, v245
    v_cvt_pk_bf16_f32 v79, v246, v247
    v_mfma_f32_16x16x32_bf16 a[184:187], v[112:115], v[48:51], a[184:187]
    v_rcp_f32 v4, v4
    v_mfma_f32_16x16x32_bf16 a[184:187], v[116:119], v[52:55], a[184:187]
    v_rcp_f32 v5, v5
    v_mfma_f32_16x16x32_bf16 a[188:191], v[112:115], v[56:59], a[188:191]
    s_add_u32 s77, s77, 32768
    v_exp_f32 v248, v248
    v_mfma_f32_16x16x32_bf16 a[188:191], v[116:119], v[60:63], a[188:191]
    v_exp_f32 v249, v249
    v_mfma_f32_16x16x32_bf16 a[192:195], v[120:123], v[32:35], a[192:195]
    v_exp_f32 v250, v250
    v_mfma_f32_16x16x32_bf16 a[192:195], v[124:127], v[36:39], a[192:195]
    v_exp_f32 v251, v251
    v_mfma_f32_16x16x32_bf16 v[252:255], a[240:243], v[140:143], v[156:159]
    v_cvt_pk_bf16_f32 v86, v248, v249
    v_cvt_pk_bf16_f32 v87, v250, v251
    v_mfma_f32_16x16x32_bf16 v[252:255], a[244:247], v[172:175], v[252:255]
    v_rcp_f32 v6, v6
    v_mfma_f32_16x16x32_bf16 v[252:255], a[248:251], v[204:207], v[252:255]
    v_mfma_f32_16x16x32_bf16 v[252:255], a[252:255], v[236:239], v[252:255]
    v_mfma_f32_16x16x32_bf16 a[196:199], v[120:123], v[40:43], a[196:199]
    v_mfma_f32_16x16x32_bf16 a[196:199], v[124:127], v[44:47], a[196:199]
    s_waitcnt vmcnt(16)
    s_barrier
    ds_read_b128 a[224:227], v2 offset:0
    v_mfma_f32_16x16x32_bf16 a[200:203], v[120:123], v[48:51], a[200:203]
    ds_read_b128 a[228:231], v2 offset:1024
    ds_read_b128 a[232:235], v2 offset:2048
    v_mfma_f32_16x16x32_bf16 a[200:203], v[124:127], v[52:55], a[200:203]
    ds_read_b128 a[236:239], v2 offset:3072
    ds_read_b128 v[96:99], v2 offset:16384
    v_mfma_f32_16x16x32_bf16 a[204:207], v[120:123], v[56:59], a[204:207]
    ds_read_b128 v[100:103], v2 offset:17408
    v_mfma_f32_16x16x32_bf16 a[204:207], v[124:127], v[60:63], a[204:207]
    v_exp_f32 v252, v252
    v_mfma_f32_16x16x32_bf16 a[208:211], a[136:139], v[32:35], a[208:211]
    v_exp_f32 v253, v253
    v_mfma_f32_16x16x32_bf16 a[208:211], a[136:139], v[36:39], a[208:211]
    v_cvt_pk_bf16_f32 v94, v252, v253
    v_mfma_f32_16x16x32_bf16 a[212:215], a[136:139], v[40:43], a[212:215]
    v_mfma_f32_16x16x32_bf16 a[212:215], a[136:139], v[44:47], a[212:215]
    v_mfma_f32_16x16x32_bf16 a[216:219], a[136:139], v[48:51], a[216:219]
    v_mfma_f32_16x16x32_bf16 a[216:219], a[136:139], v[52:55], a[216:219]
    v_mfma_f32_16x16x32_bf16 a[220:223], a[136:139], v[56:59], a[220:223]
    v_mfma_f32_16x16x32_bf16 a[220:223], a[136:139], v[60:63], a[220:223]
    s_cmp_eq_u32 s6, 7
    s_cselect_b32 s16, s8, 0
    s_cselect_b32 s17, s9, 0
    s_cselect_b32 s18, s10, 0
    s_cselect_b32 s19, s11, 0
    s_cselect_b32 s20, s12, 0
    s_cselect_b32 s21, s13, 0
    s_cselect_b32 s22, s14, 0
    s_cselect_b32 s23, s15, 0
    v_add_f32 v212, s20, v152
    v_fma_f32 v176, v208, s16, v212
    v_fma_f32 v177, v209, s16, v212
    v_fma_f32 v178, v210, s16, v212
    v_fma_f32 v179, v211, s16, v212
    s_nop 1
    s_waitcnt lgkmcnt(0)
    v_mfma_f32_16x16x32_bf16 v[240:243], a[224:227], v[136:139], v[176:179]
    s_add_u32 m0, s76, s75
    v_exp_f32 v254, v254
    v_mfma_f32_16x16x32_bf16 v[240:243], a[228:231], v[168:171], v[240:243]
    s_mov_b32 s76, s60
    buffer_load_dwordx4 v1, s[36:39], s77 offen sc1 lds
    v_mfma_f32_16x16x32_bf16 v[240:243], a[232:235], v[200:203], v[240:243]
    s_mov_b32 s60, s82
    v_exp_f32 v255, v255
    v_mfma_f32_16x16x32_bf16 v[240:243], a[236:239], v[232:235], v[240:243]
    s_add_u32 s82, s82, 32768
    ds_read_b128 v[104:107], v2 offset:18432
    v_cvt_pk_bf16_f32 v95, v254, v255
    v_mfma_f32_16x16x32_bf16 a[4:7], v[96:99], v[72:75], a[4:7]
    ds_read_b128 v[108:111], v2 offset:19456
    ds_read_b128 a[240:243], v2 offset:4096
    v_mfma_f32_16x16x32_bf16 a[4:7], v[100:103], v[76:79], a[4:7]
    ds_read_b128 a[244:247], v2 offset:5120
    ds_read_b128 a[248:251], v2 offset:6144
    v_mfma_f32_16x16x32_bf16 a[8:11], v[96:99], v[80:83], a[8:11]
    ds_read_b128 a[252:255], v2 offset:7168
    ds_read_b128 v[112:115], v2 offset:20480
    v_mfma_f32_16x16x32_bf16 a[8:11], v[100:103], v[84:87], a[8:11]
    v_add_f32 v213, s21, v152
    ds_read_b128 v[116:119], v2 offset:21504
    v_mfma_f32_16x16x32_bf16 a[12:15], v[96:99], v[88:91], a[12:15]
    v_fma_f32 v180, v208, s17, v213
    v_fma_f32 v181, v209, s17, v213
    v_mfma_f32_16x16x32_bf16 a[12:15], v[100:103], v[92:95], a[12:15]
    buffer_load_dwordx4 v1, s[36:39], s77 offen offset:1024 sc1 lds
    v_mfma_f32_16x16x32_bf16 v[244:247], a[224:227], v[140:143], v[156:159]
    v_fma_f32 v182, v210, s17, v213
    v_fma_f32 v183, v211, s17, v213
    v_mfma_f32_16x16x32_bf16 v[244:247], a[228:231], v[172:175], v[244:247]
    ds_read_b128 v[120:123], v2 offset:22528
    ds_read_b128 v[124:127], v2 offset:23552
    v_mfma_f32_16x16x32_bf16 v[244:247], a[232:235], v[204:207], v[244:247]
    ds_read_b128 a[224:227], v2 offset:8192
    ds_read_b128 a[228:231], v2 offset:9216
    v_mfma_f32_16x16x32_bf16 v[244:247], a[236:239], v[236:239], v[244:247]
    s_waitcnt lgkmcnt(4)
    ds_read_b128 a[232:235], v2 offset:10240
    ds_read_b128 a[236:239], v2 offset:11264
    v_mfma_f32_16x16x32_bf16 a[20:23], v[104:107], v[72:75], a[20:23]
    ds_read_b128 v[96:99], v2 offset:24576
    v_add_f32 v214, s22, v152
    v_mfma_f32_16x16x32_bf16 a[20:23], v[108:111], v[76:79], a[20:23]
    ds_read_b128 v[100:103], v2 offset:25600
    v_fma_f32 v184, v208, s18, v214
    v_mfma_f32_16x16x32_bf16 a[24:27], v[104:107], v[80:83], a[24:27]
    v_exp_f32 v240, v240
    v_mfma_f32_16x16x32_bf16 a[24:27], v[108:111], v[84:87], a[24:27]
    buffer_load_dwordx4 v1, s[36:39], s77 offen offset:2048 sc1 lds
    v_mfma_f32_16x16x32_bf16 a[28:31], v[104:107], v[88:91], a[28:31]
    v_exp_f32 v241, v241
    v_mfma_f32_16x16x32_bf16 a[28:31], v[108:111], v[92:95], a[28:31]
    v_exp_f32 v242, v242
    v_mfma_f32_16x16x32_bf16 v[248:251], a[240:243], v[136:139], v[180:183]
    v_exp_f32 v243, v243
    v_mfma_f32_16x16x32_bf16 v[248:251], a[244:247], v[168:171], v[248:251]
    v_fma_f32 v185, v209, s18, v214
    v_fma_f32 v186, v210, s18, v214
    v_mfma_f32_16x16x32_bf16 v[248:251], a[248:251], v[200:203], v[248:251]
    v_fma_f32 v187, v211, s18, v214
    v_cvt_pk_bf16_f32 v48, v240, v241
    v_mfma_f32_16x16x32_bf16 v[248:251], a[252:255], v[232:235], v[248:251]
    v_cvt_pk_bf16_f32 v49, v242, v243
    ds_read_b128 v[104:107], v2 offset:26624
    v_mfma_f32_16x16x32_bf16 a[36:39], v[112:115], v[72:75], a[36:39]
    ds_read_b128 v[108:111], v2 offset:27648
    v_add_f32 v215, s23, v152
    v_mfma_f32_16x16x32_bf16 a[36:39], v[116:119], v[76:79], a[36:39]
    buffer_load_dwordx4 v1, s[36:39], s77 offen offset:3072 sc1 lds
    v_mfma_f32_16x16x32_bf16 a[40:43], v[112:115], v[80:83], a[40:43]
    v_exp_f32 v244, v244
    v_mfma_f32_16x16x32_bf16 a[40:43], v[116:119], v[84:87], a[40:43]
    v_exp_f32 v245, v245
    v_mfma_f32_16x16x32_bf16 a[44:47], v[112:115], v[88:91], a[44:47]
    v_exp_f32 v246, v246
    v_mfma_f32_16x16x32_bf16 a[44:47], v[116:119], v[92:95], a[44:47]
    v_exp_f32 v247, v247
    v_mfma_f32_16x16x32_bf16 v[252:255], a[240:243], v[140:143], v[156:159]
    v_cvt_pk_bf16_f32 v56, v244, v245
    v_cvt_pk_bf16_f32 v57, v246, v247
    v_mfma_f32_16x16x32_bf16 v[252:255], a[244:247], v[172:175], v[252:255]
    ds_read_b128 a[240:243], v2 offset:12288
    ds_read_b128 a[244:247], v2 offset:13312
    v_mfma_f32_16x16x32_bf16 v[252:255], a[248:251], v[204:207], v[252:255]
    s_add_u32 s100, s77, 4096
    ds_read_b128 a[248:251], v2 offset:14336
    ds_read_b128 v[112:115], v2 offset:28672
    v_mfma_f32_16x16x32_bf16 v[252:255], a[252:255], v[236:239], v[252:255]
    s_add_u32 m0, m0, 4096
    ds_read_b128 a[252:255], v2 offset:15360
    s_waitcnt lgkmcnt(5)
    ds_read_b128 v[116:119], v2 offset:29696
    v_mfma_f32_16x16x32_bf16 a[52:55], v[120:123], v[72:75], a[52:55]
    buffer_load_dwordx4 v1, s[36:39], s100 offen sc1 lds
    v_mfma_f32_16x16x32_bf16 a[52:55], v[124:127], v[76:79], a[52:55]
    v_exp_f32 v248, v248
    v_mfma_f32_16x16x32_bf16 a[56:59], v[120:123], v[80:83], a[56:59]
    v_exp_f32 v249, v249
    v_mfma_f32_16x16x32_bf16 a[56:59], v[124:127], v[84:87], a[56:59]
    v_exp_f32 v250, v250
    v_mfma_f32_16x16x32_bf16 a[60:63], v[120:123], v[88:91], a[60:63]
    v_exp_f32 v251, v251
    v_mfma_f32_16x16x32_bf16 a[60:63], v[124:127], v[92:95], a[60:63]
    v_fma_f32 v188, v208, s19, v215
    v_fma_f32 v189, v209, s19, v215
    v_mfma_f32_16x16x32_bf16 v[240:243], a[224:227], v[136:139], v[184:187]
    v_fma_f32 v190, v210, s19, v215
    v_fma_f32 v191, v211, s19, v215
    v_mfma_f32_16x16x32_bf16 v[240:243], a[228:231], v[168:171], v[240:243]
    buffer_load_dwordx4 v1, s[36:39], s100 offen offset:1024 sc1 lds
    v_mfma_f32_16x16x32_bf16 v[240:243], a[232:235], v[200:203], v[240:243]
    v_cvt_pk_bf16_f32 v50, v248, v249
    v_cvt_pk_bf16_f32 v51, v250, v251
    v_mfma_f32_16x16x32_bf16 v[240:243], a[236:239], v[232:235], v[240:243]
    ds_read_b128 v[120:123], v2 offset:30720
    ds_read_b128 v[124:127], v2 offset:31744
    v_mfma_f32_16x16x32_bf16 a[148:151], v[96:99], v[72:75], a[148:151]
    v_exp_f32 v252, v252
    v_mfma_f32_16x16x32_bf16 a[148:151], v[100:103], v[76:79], a[148:151]
    v_exp_f32 v253, v253
    v_mfma_f32_16x16x32_bf16 a[152:155], v[96:99], v[80:83], a[152:155]
    v_exp_f32 v254, v254
    v_mfma_f32_16x16x32_bf16 a[152:155], v[100:103], v[84:87], a[152:155]
    v_exp_f32 v255, v255
    v_mfma_f32_16x16x32_bf16 a[156:159], v[96:99], v[88:91], a[156:159]
    v_cvt_pk_bf16_f32 v58, v252, v253
    v_cvt_pk_bf16_f32 v59, v254, v255
    v_mfma_f32_16x16x32_bf16 a[156:159], v[100:103], v[92:95], a[156:159]
    buffer_load_dwordx4 v1, s[36:39], s100 offen offset:2048 sc1 lds
    v_mfma_f32_16x16x32_bf16 v[244:247], a[224:227], v[140:143], v[156:159]
    s_cmp_eq_u32 s82, 163840
    s_cselect_b32 s82, 0, s82
    v_add_u32 v2, s82, v1
    v_mfma_f32_16x16x32_bf16 v[244:247], a[228:231], v[172:175], v[244:247]
    v_exp_f32 v240, v240
    v_mfma_f32_16x16x32_bf16 v[244:247], a[232:235], v[204:207], v[244:247]
    v_exp_f32 v241, v241
    v_mfma_f32_16x16x32_bf16 v[244:247], a[236:239], v[236:239], v[244:247]
    v_exp_f32 v242, v242
    v_mfma_f32_16x16x32_bf16 a[164:167], v[104:107], v[72:75], a[164:167]
    v_exp_f32 v243, v243
    v_mfma_f32_16x16x32_bf16 a[164:167], v[108:111], v[76:79], a[164:167]
    v_cvt_pk_bf16_f32 v52, v240, v241
    v_cvt_pk_bf16_f32 v53, v242, v243
    v_mfma_f32_16x16x32_bf16 a[168:171], v[104:107], v[80:83], a[168:171]
    v_accvgpr_read_b32 v7, a124
    v_cvt_pk_bf16_f32 v7, 0, v7
    v_mfma_f32_16x16x32_bf16 a[168:171], v[108:111], v[84:87], a[168:171]
    buffer_load_dwordx4 v1, s[36:39], s100 offen offset:3072 sc1 lds
    v_mfma_f32_16x16x32_bf16 a[172:175], v[104:107], v[88:91], a[172:175]
    v_exp_f32 v244, v244
    v_mfma_f32_16x16x32_bf16 a[172:175], v[108:111], v[92:95], a[172:175]
    s_waitcnt lgkmcnt(0)
    v_exp_f32 v245, v245
    v_mfma_f32_16x16x32_bf16 v[248:251], a[240:243], v[136:139], v[188:191]
    v_exp_f32 v246, v246
    v_mfma_f32_16x16x32_bf16 v[248:251], a[244:247], v[168:171], v[248:251]
    v_exp_f32 v247, v247
    v_mfma_f32_16x16x32_bf16 v[248:251], a[248:251], v[200:203], v[248:251]
    v_cvt_pk_bf16_f32 v60, v244, v245
    v_cvt_pk_bf16_f32 v61, v246, v247
    v_mfma_f32_16x16x32_bf16 v[248:251], a[252:255], v[232:235], v[248:251]
    ds_bpermute_b32 v7, v8, v7
    s_waitcnt lgkmcnt(0)
    v_mul_f32 v7, s98, v7
    v_mfma_f32_16x16x32_bf16 a[180:183], v[112:115], v[72:75], a[180:183]
    s_add_u32 s77, s77, 32768
    v_exp_f32 v7, v7
    v_mfma_f32_16x16x32_bf16 a[180:183], v[116:119], v[76:79], a[180:183]
    v_add_f32 v7, 1.0, v7
    v_mfma_f32_16x16x32_bf16 a[184:187], v[112:115], v[80:83], a[184:187]
    v_exp_f32 v248, v248
    v_mfma_f32_16x16x32_bf16 a[184:187], v[116:119], v[84:87], a[184:187]
    v_exp_f32 v249, v249
    v_mfma_f32_16x16x32_bf16 a[188:191], v[112:115], v[88:91], a[188:191]
    v_exp_f32 v250, v250
    v_mfma_f32_16x16x32_bf16 a[188:191], v[116:119], v[92:95], a[188:191]
    v_exp_f32 v251, v251
    v_mfma_f32_16x16x32_bf16 v[252:255], a[240:243], v[140:143], v[156:159]
    v_cvt_pk_bf16_f32 v54, v248, v249
    v_cvt_pk_bf16_f32 v55, v250, v251
    v_mfma_f32_16x16x32_bf16 v[252:255], a[244:247], v[172:175], v[252:255]
    v_rcp_f32 v7, v7
    v_mfma_f32_16x16x32_bf16 v[252:255], a[248:251], v[204:207], v[252:255]
    v_mfma_f32_16x16x32_bf16 v[252:255], a[252:255], v[236:239], v[252:255]
    s_waitcnt vmcnt(16)
    s_barrier
    ds_read_b128 a[224:227], v2 offset:0
    v_mfma_f32_16x16x32_bf16 a[196:199], v[120:123], v[72:75], a[196:199]
    ds_read_b128 a[228:231], v2 offset:1024
    ds_read_b128 a[232:235], v2 offset:2048
    v_mfma_f32_16x16x32_bf16 a[196:199], v[124:127], v[76:79], a[196:199]
    ds_read_b128 a[236:239], v2 offset:3072
    ds_read_b128 v[96:99], v2 offset:16384
    v_mfma_f32_16x16x32_bf16 a[200:203], v[120:123], v[80:83], a[200:203]
    ds_read_b128 v[100:103], v2 offset:17408
    v_mfma_f32_16x16x32_bf16 a[200:203], v[124:127], v[84:87], a[200:203]
    v_exp_f32 v252, v252
    v_mfma_f32_16x16x32_bf16 a[204:207], v[120:123], v[88:91], a[204:207]
    v_exp_f32 v253, v253
    v_mfma_f32_16x16x32_bf16 a[204:207], v[124:127], v[92:95], a[204:207]
    v_cvt_pk_bf16_f32 v62, v252, v253
    v_mfma_f32_16x16x32_bf16 a[212:215], a[136:139], v[72:75], a[212:215]
    v_mfma_f32_16x16x32_bf16 a[212:215], a[136:139], v[76:79], a[212:215]
    v_mfma_f32_16x16x32_bf16 a[216:219], a[136:139], v[80:83], a[216:219]
    v_mfma_f32_16x16x32_bf16 a[216:219], a[136:139], v[84:87], a[216:219]
    v_mfma_f32_16x16x32_bf16 a[220:223], a[136:139], v[88:91], a[220:223]
    v_mfma_f32_16x16x32_bf16 a[220:223], a[136:139], v[92:95], a[220:223]
    s_nop 7
    v_accvgpr_read_b32 v8, a208
    v_cmp_nge_f32 vcc, s101, v8
    v_rcp_f32 v10, v8
    s_nop 0
    s_or_b64 s[84:85], s[84:85], vcc
    v_mul_f32 v10, v10, v4
    v_accvgpr_read_b32 v12, a0
    v_accvgpr_read_b32 v13, a1
    v_accvgpr_read_b32 v14, a2
    v_accvgpr_read_b32 v15, a3
    v_accvgpr_read_b32 v16, a16
    v_accvgpr_read_b32 v17, a17
    v_accvgpr_read_b32 v18, a18
    v_accvgpr_read_b32 v19, a19
    v_pk_mul_f32 v[12:13], v[12:13], v[10:11] op_sel_hi:[1,0]
    v_pk_mul_f32 v[14:15], v[14:15], v[10:11] op_sel_hi:[1,0]
    v_pk_mul_f32 v[16:17], v[16:17], v[10:11] op_sel_hi:[1,0]
    v_pk_mul_f32 v[18:19], v[18:19], v[10:11] op_sel_hi:[1,0]
    v_cvt_pk_bf16_f32 v12, v12, v13
    v_cvt_pk_bf16_f32 v13, v14, v15
    v_cvt_pk_bf16_f32 v14, v16, v17
    v_cvt_pk_bf16_f32 v15, v18, v19
    buffer_store_dwordx4 v[12:15], v1, s[40:43], s80 offen offset:0 sc1
    v_accvgpr_read_b32 v20, a32
    v_accvgpr_read_b32 v21, a33
    v_accvgpr_read_b32 v22, a34
    v_accvgpr_read_b32 v23, a35
    v_accvgpr_read_b32 v24, a48
    v_accvgpr_read_b32 v25, a49
    v_accvgpr_read_b32 v26, a50
    v_accvgpr_read_b32 v27, a51
    v_pk_mul_f32 v[20:21], v[20:21], v[10:11] op_sel_hi:[1,0]
    v_pk_mul_f32 v[22:23], v[22:23], v[10:11] op_sel_hi:[1,0]
    v_pk_mul_f32 v[24:25], v[24:25], v[10:11] op_sel_hi:[1,0]
    v_pk_mul_f32 v[26:27], v[26:27], v[10:11] op_sel_hi:[1,0]
    v_cvt_pk_bf16_f32 v20, v20, v21
    v_cvt_pk_bf16_f32 v21, v22, v23
    v_cvt_pk_bf16_f32 v22, v24, v25
    v_cvt_pk_bf16_f32 v23, v26, v27
    buffer_store_dwordx4 v[20:23], v1, s[40:43], s80 offen offset:1024 sc1
    v_accvgpr_read_b32 v12, a144
    v_accvgpr_read_b32 v13, a145
    v_accvgpr_read_b32 v14, a146
    v_accvgpr_read_b32 v15, a147
    v_accvgpr_read_b32 v16, a160
    v_accvgpr_read_b32 v17, a161
    v_accvgpr_read_b32 v18, a162
    v_accvgpr_read_b32 v19, a163
    v_pk_mul_f32 v[12:13], v[12:13], v[10:11] op_sel_hi:[1,0]
    v_pk_mul_f32 v[14:15], v[14:15], v[10:11] op_sel_hi:[1,0]
    v_pk_mul_f32 v[16:17], v[16:17], v[10:11] op_sel_hi:[1,0]
    v_pk_mul_f32 v[18:19], v[18:19], v[10:11] op_sel_hi:[1,0]
    v_cvt_pk_bf16_f32 v12, v12, v13
    v_cvt_pk_bf16_f32 v13, v14, v15
    v_cvt_pk_bf16_f32 v14, v16, v17
    v_cvt_pk_bf16_f32 v15, v18, v19
    buffer_store_dwordx4 v[12:15], v1, s[40:43], s80 offen offset:2048 sc1
    v_accvgpr_read_b32 v20, a176
    v_accvgpr_read_b32 v21, a177
    v_accvgpr_read_b32 v22, a178
    v_accvgpr_read_b32 v23, a179
    v_accvgpr_read_b32 v24, a192
    v_accvgpr_read_b32 v25, a193
    v_accvgpr_read_b32 v26, a194
    v_accvgpr_read_b32 v27, a195
    v_pk_mul_f32 v[20:21], v[20:21], v[10:11] op_sel_hi:[1,0]
    v_pk_mul_f32 v[22:23], v[22:23], v[10:11] op_sel_hi:[1,0]
    v_pk_mul_f32 v[24:25], v[24:25], v[10:11] op_sel_hi:[1,0]
    v_pk_mul_f32 v[26:27], v[26:27], v[10:11] op_sel_hi:[1,0]
    v_cvt_pk_bf16_f32 v20, v20, v21
    v_cvt_pk_bf16_f32 v21, v22, v23
    v_cvt_pk_bf16_f32 v22, v24, v25
    v_cvt_pk_bf16_f32 v23, v26, v27
    buffer_store_dwordx4 v[20:23], v1, s[40:43], s80 offen offset:3072 sc1
    v_accvgpr_read_b32 v8, a212
    v_cmp_nge_f32 vcc, s101, v8
    v_rcp_f32 v10, v8
    s_nop 0
    s_or_b64 s[84:85], s[84:85], vcc
    v_mul_f32 v10, v10, v5
    s_add_u32 s72, s80, 598016
    v_accvgpr_read_b32 v12, a4
    v_accvgpr_read_b32 v13, a5
    v_accvgpr_read_b32 v14, a6
    v_accvgpr_read_b32 v15, a7
    v_accvgpr_read_b32 v16, a20
    v_accvgpr_read_b32 v17, a21
    v_accvgpr_read_b32 v18, a22
    v_accvgpr_read_b32 v19, a23
    v_pk_mul_f32 v[12:13], v[12:13], v[10:11] op_sel_hi:[1,0]
    v_pk_mul_f32 v[14:15], v[14:15], v[10:11] op_sel_hi:[1,0]
    v_pk_mul_f32 v[16:17], v[16:17], v[10:11] op_sel_hi:[1,0]
    v_pk_mul_f32 v[18:19], v[18:19], v[10:11] op_sel_hi:[1,0]
    v_cvt_pk_bf16_f32 v12, v12, v13
    v_cvt_pk_bf16_f32 v13, v14, v15
    v_cvt_pk_bf16_f32 v14, v16, v17
    v_cvt_pk_bf16_f32 v15, v18, v19
    buffer_store_dwordx4 v[12:15], v1, s[40:43], s72 offen offset:0 sc1
    v_accvgpr_read_b32 v20, a36
    v_accvgpr_read_b32 v21, a37
    v_accvgpr_read_b32 v22, a38
    v_accvgpr_read_b32 v23, a39
    v_accvgpr_read_b32 v24, a52
    v_accvgpr_read_b32 v25, a53
    v_accvgpr_read_b32 v26, a54
    v_accvgpr_read_b32 v27, a55
    v_pk_mul_f32 v[20:21], v[20:21], v[10:11] op_sel_hi:[1,0]
    v_pk_mul_f32 v[22:23], v[22:23], v[10:11] op_sel_hi:[1,0]
    v_pk_mul_f32 v[24:25], v[24:25], v[10:11] op_sel_hi:[1,0]
    v_pk_mul_f32 v[26:27], v[26:27], v[10:11] op_sel_hi:[1,0]
    v_cvt_pk_bf16_f32 v20, v20, v21
    v_cvt_pk_bf16_f32 v21, v22, v23
    v_cvt_pk_bf16_f32 v22, v24, v25
    v_cvt_pk_bf16_f32 v23, v26, v27
    buffer_store_dwordx4 v[20:23], v1, s[40:43], s72 offen offset:1024 sc1
    v_accvgpr_read_b32 v12, a148
    v_accvgpr_read_b32 v13, a149
    v_accvgpr_read_b32 v14, a150
    v_accvgpr_read_b32 v15, a151
    v_accvgpr_read_b32 v16, a164
    v_accvgpr_read_b32 v17, a165
    v_accvgpr_read_b32 v18, a166
    v_accvgpr_read_b32 v19, a167
    v_pk_mul_f32 v[12:13], v[12:13], v[10:11] op_sel_hi:[1,0]
    v_pk_mul_f32 v[14:15], v[14:15], v[10:11] op_sel_hi:[1,0]
    v_pk_mul_f32 v[16:17], v[16:17], v[10:11] op_sel_hi:[1,0]
    v_pk_mul_f32 v[18:19], v[18:19], v[10:11] op_sel_hi:[1,0]
    v_cvt_pk_bf16_f32 v12, v12, v13
    v_cvt_pk_bf16_f32 v13, v14, v15
    v_cvt_pk_bf16_f32 v14, v16, v17
    v_cvt_pk_bf16_f32 v15, v18, v19
    buffer_store_dwordx4 v[12:15], v1, s[40:43], s72 offen offset:2048 sc1
    v_accvgpr_read_b32 v20, a180
    v_accvgpr_read_b32 v21, a181
    v_accvgpr_read_b32 v22, a182
    v_accvgpr_read_b32 v23, a183
    v_accvgpr_read_b32 v24, a196
    v_accvgpr_read_b32 v25, a197
    v_accvgpr_read_b32 v26, a198
    v_accvgpr_read_b32 v27, a199
    v_pk_mul_f32 v[20:21], v[20:21], v[10:11] op_sel_hi:[1,0]
    v_pk_mul_f32 v[22:23], v[22:23], v[10:11] op_sel_hi:[1,0]
    v_pk_mul_f32 v[24:25], v[24:25], v[10:11] op_sel_hi:[1,0]
    v_pk_mul_f32 v[26:27], v[26:27], v[10:11] op_sel_hi:[1,0]
    v_cvt_pk_bf16_f32 v20, v20, v21
    v_cvt_pk_bf16_f32 v21, v22, v23
    v_cvt_pk_bf16_f32 v22, v24, v25
    v_cvt_pk_bf16_f32 v23, v26, v27
    buffer_store_dwordx4 v[20:23], v1, s[40:43], s72 offen offset:3072 sc1
    s_sub_u32 s78, 14, s6
    s_sub_u32 s78, s78, s6
    s_cmp_eq_u32 s78, 0
    s_cbranch_scc1 K1_LS_END
.p2align 3
K1_LS:
    s_waitcnt lgkmcnt(0)
    v_mfma_f32_16x16x32_bf16 v[240:243], a[224:227], v[136:139], v[176:179]
    s_add_u32 m0, s76, s75
    v_exp_f32 v254, v254
    v_mfma_f32_16x16x32_bf16 v[240:243], a[228:231], v[168:171], v[240:243]
    s_mov_b32 s76, s60
    v_exp_f32 v255, v255
    v_mfma_f32_16x16x32_bf16 v[240:243], a[232:235], v[200:203], v[240:243]
    s_mov_b32 s60, s82
    buffer_load_dwordx4 v1, s[36:39], s77 offen sc1 lds
    v_mfma_f32_16x16x32_bf16 v[240:243], a[236:239], v[232:235], v[240:243]
    s_add_u32 s82, s82, 32768
    ds_read_b128 v[104:107], v2 offset:18432
    v_cvt_pk_bf16_f32 v63, v254, v255
    v_mfma_f32_16x16x32_bf16 a[8:11], v[96:99], v[48:51], a[8:11]
    ds_read_b128 v[108:111], v2 offset:19456
    ds_read_b128 a[240:243], v2 offset:4096
    v_mfma_f32_16x16x32_bf16 a[8:11], v[100:103], v[52:55], a[8:11]
    ds_read_b128 a[244:247], v2 offset:5120
    ds_read_b128 a[248:251], v2 offset:6144
    v_mfma_f32_16x16x32_bf16 a[12:15], v[96:99], v[56:59], a[12:15]
    buffer_load_dwordx4 v1, s[36:39], s77 offen offset:1024 sc1 lds
    v_mfma_f32_16x16x32_bf16 a[12:15], v[100:103], v[60:63], a[12:15]
    ds_read_b128 a[252:255], v2 offset:7168
    ds_read_b128 v[112:115], v2 offset:20480
    v_mfma_f32_16x16x32_bf16 v[244:247], a[224:227], v[140:143], v[156:159]
    ds_read_b128 v[116:119], v2 offset:21504
    ds_read_b128 v[120:123], v2 offset:22528
    v_mfma_f32_16x16x32_bf16 v[244:247], a[228:231], v[172:175], v[244:247]
    ds_read_b128 v[124:127], v2 offset:23552
    ds_read_b128 a[224:227], v2 offset:8192
    v_mfma_f32_16x16x32_bf16 v[244:247], a[232:235], v[204:207], v[244:247]
    ds_read_b128 a[228:231], v2 offset:9216
    ds_read_b128 a[232:235], v2 offset:10240
    v_mfma_f32_16x16x32_bf16 v[244:247], a[236:239], v[236:239], v[244:247]
    s_waitcnt lgkmcnt(8)
    ds_read_b128 a[236:239], v2 offset:11264
    ds_read_b128 v[96:99], v2 offset:24576
    v_mfma_f32_16x16x32_bf16 a[24:27], v[104:107], v[48:51], a[24:27]
    buffer_load_dwordx4 v1, s[36:39], s77 offen offset:2048 sc1 lds
    v_mfma_f32_16x16x32_bf16 a[24:27], v[108:111], v[52:55], a[24:27]
    ds_read_b128 v[100:103], v2 offset:25600
    v_mfma_f32_16x16x32_bf16 a[28:31], v[104:107], v[56:59], a[28:31]
    v_exp_f32 v240, v240
    v_mfma_f32_16x16x32_bf16 a[28:31], v[108:111], v[60:63], a[28:31]
    v_exp_f32 v241, v241
    v_mfma_f32_16x16x32_bf16 v[248:251], a[240:243], v[136:139], v[180:183]
    v_exp_f32 v242, v242
    v_mfma_f32_16x16x32_bf16 v[248:251], a[244:247], v[168:171], v[248:251]
    v_exp_f32 v243, v243
    v_mfma_f32_16x16x32_bf16 v[248:251], a[248:251], v[200:203], v[248:251]
    s_waitcnt lgkmcnt(0)
    buffer_load_dwordx4 v1, s[36:39], s77 offen offset:3072 sc1 lds
    v_mfma_f32_16x16x32_bf16 v[248:251], a[252:255], v[232:235], v[248:251]
    v_cvt_pk_bf16_f32 v80, v240, v241
    v_cvt_pk_bf16_f32 v81, v242, v243
    v_mfma_f32_16x16x32_bf16 a[40:43], v[112:115], v[48:51], a[40:43]
    ds_read_b128 v[104:107], v2 offset:26624
    ds_read_b128 v[108:111], v2 offset:27648
    v_mfma_f32_16x16x32_bf16 a[40:43], v[116:119], v[52:55], a[40:43]
    v_exp_f32 v244, v244
    v_mfma_f32_16x16x32_bf16 a[44:47], v[112:115], v[56:59], a[44:47]
    v_exp_f32 v245, v245
    v_mfma_f32_16x16x32_bf16 a[44:47], v[116:119], v[60:63], a[44:47]
    s_add_u32 s100, s77, 4096
    v_exp_f32 v246, v246
    v_mfma_f32_16x16x32_bf16 v[252:255], a[240:243], v[140:143], v[156:159]
    s_add_u32 m0, m0, 4096
    v_exp_f32 v247, v247
    v_mfma_f32_16x16x32_bf16 v[252:255], a[244:247], v[172:175], v[252:255]
    buffer_load_dwordx4 v1, s[36:39], s100 offen sc1 lds
    v_mfma_f32_16x16x32_bf16 v[252:255], a[248:251], v[204:207], v[252:255]
    v_cvt_pk_bf16_f32 v88, v244, v245
    v_cvt_pk_bf16_f32 v89, v246, v247
    v_mfma_f32_16x16x32_bf16 v[252:255], a[252:255], v[236:239], v[252:255]
    ds_read_b128 a[240:243], v2 offset:12288
    ds_read_b128 a[244:247], v2 offset:13312
    v_mfma_f32_16x16x32_bf16 a[56:59], v[120:123], v[48:51], a[56:59]
    ds_read_b128 a[248:251], v2 offset:14336
    ds_read_b128 a[252:255], v2 offset:15360
    v_mfma_f32_16x16x32_bf16 a[56:59], v[124:127], v[52:55], a[56:59]
    buffer_load_dwordx4 v1, s[36:39], s100 offen offset:1024 sc1 lds
    v_mfma_f32_16x16x32_bf16 a[60:63], v[120:123], v[56:59], a[60:63]
    ds_read_b128 v[112:115], v2 offset:28672
    ds_read_b128 v[116:119], v2 offset:29696
    v_mfma_f32_16x16x32_bf16 a[60:63], v[124:127], v[60:63], a[60:63]
    v_exp_f32 v248, v248
    v_mfma_f32_16x16x32_bf16 v[240:243], a[224:227], v[136:139], v[184:187]
    v_exp_f32 v249, v249
    v_mfma_f32_16x16x32_bf16 v[240:243], a[228:231], v[168:171], v[240:243]
    v_exp_f32 v250, v250
    v_mfma_f32_16x16x32_bf16 v[240:243], a[232:235], v[200:203], v[240:243]
    v_exp_f32 v251, v251
    v_mfma_f32_16x16x32_bf16 v[240:243], a[236:239], v[232:235], v[240:243]
    buffer_load_dwordx4 v1, s[36:39], s100 offen offset:2048 sc1 lds
    v_mfma_f32_16x16x32_bf16 a[152:155], v[96:99], v[48:51], a[152:155]
    v_cvt_pk_bf16_f32 v82, v248, v249
    v_cvt_pk_bf16_f32 v83, v250, v251
    v_mfma_f32_16x16x32_bf16 a[152:155], v[100:103], v[52:55], a[152:155]
    ds_read_b128 v[120:123], v2 offset:30720
    ds_read_b128 v[124:127], v2 offset:31744
    v_mfma_f32_16x16x32_bf16 a[156:159], v[96:99], v[56:59], a[156:159]
    v_exp_f32 v252, v252
    v_mfma_f32_16x16x32_bf16 a[156:159], v[100:103], v[60:63], a[156:159]
    v_exp_f32 v253, v253
    v_mfma_f32_16x16x32_bf16 v[244:247], a[224:227], v[140:143], v[156:159]
    v_exp_f32 v254, v254
    v_mfma_f32_16x16x32_bf16 v[244:247], a[228:231], v[172:175], v[244:247]
    buffer_load_dwordx4 v1, s[36:39], s100 offen offset:3072 sc1 lds
    v_mfma_f32_16x16x32_bf16 v[244:247], a[232:235], v[204:207], v[244:247]
    v_exp_f32 v255, v255
    v_mfma_f32_16x16x32_bf16 v[244:247], a[236:239], v[236:239], v[244:247]
    s_cmp_eq_u32 s82, 163840
    s_cselect_b32 s82, 0, s82
    v_cvt_pk_bf16_f32 v90, v252, v253
    s_waitcnt lgkmcnt(0)
    v_mfma_f32_16x16x32_bf16 a[168:171], v[104:107], v[48:51], a[168:171]
    v_cvt_pk_bf16_f32 v91, v254, v255
    v_add_u32 v2, s82, v1
    v_mfma_f32_16x16x32_bf16 a[168:171], v[108:111], v[52:55], a[168:171]
    v_exp_f32 v240, v240
    v_mfma_f32_16x16x32_bf16 a[172:175], v[104:107], v[56:59], a[172:175]
    s_add_u32 s77, s77, 32768
    v_exp_f32 v241, v241
    v_mfma_f32_16x16x32_bf16 a[172:175], v[108:111], v[60:63], a[172:175]
    v_exp_f32 v242, v242
    v_mfma_f32_16x16x32_bf16 v[248:251], a[240:243], v[136:139], v[188:191]
    v_exp_f32 v243, v243
    v_mfma_f32_16x16x32_bf16 v[248:251], a[244:247], v[168:171], v[248:251]
    v_exp_f32 v244, v244
    v_mfma_f32_16x16x32_bf16 v[248:251], a[248:251], v[200:203], v[248:251]
    v_exp_f32 v245, v245
    v_mfma_f32_16x16x32_bf16 v[248:251], a[252:255], v[232:235], v[248:251]
    v_exp_f32 v246, v246
    v_mfma_f32_16x16x32_bf16 a[184:187], v[112:115], v[48:51], a[184:187]
    v_exp_f32 v247, v247
    v_mfma_f32_16x16x32_bf16 a[184:187], v[116:119], v[52:55], a[184:187]
    v_cvt_pk_bf16_f32 v84, v240, v241
    v_cvt_pk_bf16_f32 v85, v242, v243
    v_mfma_f32_16x16x32_bf16 a[188:191], v[112:115], v[56:59], a[188:191]
    v_cvt_pk_bf16_f32 v92, v244, v245
    v_cvt_pk_bf16_f32 v93, v246, v247
    v_mfma_f32_16x16x32_bf16 a[188:191], v[116:119], v[60:63], a[188:191]
    s_waitcnt vmcnt(16)
    s_barrier
    ds_read_b128 a[224:227], v2 offset:0
    v_mfma_f32_16x16x32_bf16 v[252:255], a[240:243], v[140:143], v[156:159]
    ds_read_b128 a[228:231], v2 offset:1024
    ds_read_b128 a[232:235], v2 offset:2048
    v_mfma_f32_16x16x32_bf16 v[252:255], a[244:247], v[172:175], v[252:255]
    ds_read_b128 a[236:239], v2 offset:3072
    ds_read_b128 v[96:99], v2 offset:16384
    v_mfma_f32_16x16x32_bf16 v[252:255], a[248:251], v[204:207], v[252:255]
    ds_read_b128 v[100:103], v2 offset:17408
    v_mfma_f32_16x16x32_bf16 v[252:255], a[252:255], v[236:239], v[252:255]
    v_exp_f32 v248, v248
    v_mfma_f32_16x16x32_bf16 a[200:203], v[120:123], v[48:51], a[200:203]
    v_exp_f32 v249, v249
    v_mfma_f32_16x16x32_bf16 a[200:203], v[124:127], v[52:55], a[200:203]
    v_exp_f32 v250, v250
    v_mfma_f32_16x16x32_bf16 a[204:207], v[120:123], v[56:59], a[204:207]
    v_exp_f32 v251, v251
    v_mfma_f32_16x16x32_bf16 a[204:207], v[124:127], v[60:63], a[204:207]
    v_exp_f32 v252, v252
    v_mfma_f32_16x16x32_bf16 a[216:219], a[136:139], v[48:51], a[216:219]
    v_exp_f32 v253, v253
    v_mfma_f32_16x16x32_bf16 a[216:219], a[136:139], v[52:55], a[216:219]
    v_cvt_pk_bf16_f32 v86, v248, v249
    v_cvt_pk_bf16_f32 v87, v250, v251
    v_mfma_f32_16x16x32_bf16 a[220:223], a[136:139], v[56:59], a[220:223]
    v_cvt_pk_bf16_f32 v94, v252, v253
    v_mfma_f32_16x16x32_bf16 a[220:223], a[136:139], v[60:63], a[220:223]
    s_cmp_eq_u32 s78, 1
    s_cbranch_scc1 K1_LS_MASK
K1_LS_BACK:
    s_waitcnt lgkmcnt(0)
    v_mfma_f32_16x16x32_bf16 v[240:243], a[224:227], v[136:139], v[176:179]
    s_add_u32 m0, s76, s75
    v_exp_f32 v254, v254
    v_mfma_f32_16x16x32_bf16 v[240:243], a[228:231], v[168:171], v[240:243]
    s_mov_b32 s76, s60
    v_exp_f32 v255, v255
    v_mfma_f32_16x16x32_bf16 v[240:243], a[232:235], v[200:203], v[240:243]
    s_mov_b32 s60, s82
    buffer_load_dwordx4 v1, s[36:39], s77 offen sc1 lds
    v_mfma_f32_16x16x32_bf16 v[240:243], a[236:239], v[232:235], v[240:243]
    s_add_u32 s82, s82, 32768
    ds_read_b128 v[104:107], v2 offset:18432
    v_cvt_pk_bf16_f32 v95, v254, v255
    v_mfma_f32_16x16x32_bf16 a[8:11], v[96:99], v[80:83], a[8:11]
    ds_read_b128 v[108:111], v2 offset:19456
    ds_read_b128 a[240:243], v2 offset:4096
    v_mfma_f32_16x16x32_bf16 a[8:11], v[100:103], v[84:87], a[8:11]
    ds_read_b128 a[244:247], v2 offset:5120
    ds_read_b128 a[248:251], v2 offset:6144
    v_mfma_f32_16x16x32_bf16 a[12:15], v[96:99], v[88:91], a[12:15]
    buffer_load_dwordx4 v1, s[36:39], s77 offen offset:1024 sc1 lds
    v_mfma_f32_16x16x32_bf16 a[12:15], v[100:103], v[92:95], a[12:15]
    ds_read_b128 a[252:255], v2 offset:7168
    ds_read_b128 v[112:115], v2 offset:20480
    v_mfma_f32_16x16x32_bf16 v[244:247], a[224:227], v[140:143], v[156:159]
    ds_read_b128 v[116:119], v2 offset:21504
    ds_read_b128 v[120:123], v2 offset:22528
    v_mfma_f32_16x16x32_bf16 v[244:247], a[228:231], v[172:175], v[244:247]
    ds_read_b128 v[124:127], v2 offset:23552
    ds_read_b128 a[224:227], v2 offset:8192
    v_mfma_f32_16x16x32_bf16 v[244:247], a[232:235], v[204:207], v[244:247]
    ds_read_b128 a[228:231], v2 offset:9216
    ds_read_b128 a[232:235], v2 offset:10240
    v_mfma_f32_16x16x32_bf16 v[244:247], a[236:239], v[236:239], v[244:247]
    s_waitcnt lgkmcnt(8)
    ds_read_b128 a[236:239], v2 offset:11264
    ds_read_b128 v[96:99], v2 offset:24576
    v_mfma_f32_16x16x32_bf16 a[24:27], v[104:107], v[80:83], a[24:27]
    buffer_load_dwordx4 v1, s[36:39], s77 offen offset:2048 sc1 lds
    v_mfma_f32_16x16x32_bf16 a[24:27], v[108:111], v[84:87], a[24:27]
    ds_read_b128 v[100:103], v2 offset:25600
    v_mfma_f32_16x16x32_bf16 a[28:31], v[104:107], v[88:91], a[28:31]
    v_exp_f32 v240, v240
    v_mfma_f32_16x16x32_bf16 a[28:31], v[108:111], v[92:95], a[28:31]
    v_exp_f32 v241, v241
    v_mfma_f32_16x16x32_bf16 v[248:251], a[240:243], v[136:139], v[180:183]
    v_exp_f32 v242, v242
    v_mfma_f32_16x16x32_bf16 v[248:251], a[244:247], v[168:171], v[248:251]
    v_exp_f32 v243, v243
    v_mfma_f32_16x16x32_bf16 v[248:251], a[248:251], v[200:203], v[248:251]
    s_waitcnt lgkmcnt(0)
    buffer_load_dwordx4 v1, s[36:39], s77 offen offset:3072 sc1 lds
    v_mfma_f32_16x16x32_bf16 v[248:251], a[252:255], v[232:235], v[248:251]
    v_cvt_pk_bf16_f32 v48, v240, v241
    v_cvt_pk_bf16_f32 v49, v242, v243
    v_mfma_f32_16x16x32_bf16 a[40:43], v[112:115], v[80:83], a[40:43]
    ds_read_b128 v[104:107], v2 offset:26624
    ds_read_b128 v[108:111], v2 offset:27648
    v_mfma_f32_16x16x32_bf16 a[40:43], v[116:119], v[84:87], a[40:43]
    v_exp_f32 v244, v244
    v_mfma_f32_16x16x32_bf16 a[44:47], v[112:115], v[88:91], a[44:47]
    v_exp_f32 v245, v245
    v_mfma_f32_16x16x32_bf16 a[44:47], v[116:119], v[92:95], a[44:47]
    s_add_u32 s100, s77, 4096
    v_exp_f32 v246, v246
    v_mfma_f32_16x16x32_bf16 v[252:255], a[240:243], v[140:143], v[156:159]
    s_add_u32 m0, m0, 4096
    v_exp_f32 v247, v247
    v_mfma_f32_16x16x32_bf16 v[252:255], a[244:247], v[172:175], v[252:255]
    buffer_load_dwordx4 v1, s[36:39], s100 offen sc1 lds
    v_mfma_f32_16x16x32_bf16 v[252:255], a[248:251], v[204:207], v[252:255]
    v_cvt_pk_bf16_f32 v56, v244, v245
    v_cvt_pk_bf16_f32 v57, v246, v247
    v_mfma_f32_16x16x32_bf16 v[252:255], a[252:255], v[236:239], v[252:255]
    ds_read_b128 a[240:243], v2 offset:12288
    ds_read_b128 a[244:247], v2 offset:13312
    v_mfma_f32_16x16x32_bf16 a[56:59], v[120:123], v[80:83], a[56:59]
    ds_read_b128 a[248:251], v2 offset:14336
    ds_read_b128 a[252:255], v2 offset:15360
    v_mfma_f32_16x16x32_bf16 a[56:59], v[124:127], v[84:87], a[56:59]
    buffer_load_dwordx4 v1, s[36:39], s100 offen offset:1024 sc1 lds
    v_mfma_f32_16x16x32_bf16 a[60:63], v[120:123], v[88:91], a[60:63]
    ds_read_b128 v[112:115], v2 offset:28672
    ds_read_b128 v[116:119], v2 offset:29696
    v_mfma_f32_16x16x32_bf16 a[60:63], v[124:127], v[92:95], a[60:63]
    v_exp_f32 v248, v248
    v_mfma_f32_16x16x32_bf16 v[240:243], a[224:227], v[136:139], v[184:187]
    v_exp_f32 v249, v249
    v_mfma_f32_16x16x32_bf16 v[240:243], a[228:231], v[168:171], v[240:243]
    v_exp_f32 v250, v250
    v_mfma_f32_16x16x32_bf16 v[240:243], a[232:235], v[200:203], v[240:243]
    v_exp_f32 v251, v251
    v_mfma_f32_16x16x32_bf16 v[240:243], a[236:239], v[232:235], v[240:243]
    buffer_load_dwordx4 v1, s[36:39], s100 offen offset:2048 sc1 lds
    v_mfma_f32_16x16x32_bf16 a[152:155], v[96:99], v[80:83], a[152:155]
    v_cvt_pk_bf16_f32 v50, v248, v249
    v_cvt_pk_bf16_f32 v51, v250, v251
    v_mfma_f32_16x16x32_bf16 a[152:155], v[100:103], v[84:87], a[152:155]
    ds_read_b128 v[120:123], v2 offset:30720
    ds_read_b128 v[124:127], v2 offset:31744
    v_mfma_f32_16x16x32_bf16 a[156:159], v[96:99], v[88:91], a[156:159]
    v_exp_f32 v252, v252
    v_mfma_f32_16x16x32_bf16 a[156:159], v[100:103], v[92:95], a[156:159]
    v_exp_f32 v253, v253
    v_mfma_f32_16x16x32_bf16 v[244:247], a[224:227], v[140:143], v[156:159]
    v_exp_f32 v254, v254
    v_mfma_f32_16x16x32_bf16 v[244:247], a[228:231], v[172:175], v[244:247]
    buffer_load_dwordx4 v1, s[36:39], s100 offen offset:3072 sc1 lds
    v_mfma_f32_16x16x32_bf16 v[244:247], a[232:235], v[204:207], v[244:247]
    v_exp_f32 v255, v255
    v_mfma_f32_16x16x32_bf16 v[244:247], a[236:239], v[236:239], v[244:247]
    s_cmp_eq_u32 s82, 163840
    s_cselect_b32 s82, 0, s82
    v_cvt_pk_bf16_f32 v58, v252, v253
    s_waitcnt lgkmcnt(0)
    v_mfma_f32_16x16x32_bf16 a[168:171], v[104:107], v[80:83], a[168:171]
    v_cvt_pk_bf16_f32 v59, v254, v255
    v_add_u32 v2, s82, v1
    v_mfma_f32_16x16x32_bf16 a[168:171], v[108:111], v[84:87], a[168:171]
    v_exp_f32 v240, v240
    v_mfma_f32_16x16x32_bf16 a[172:175], v[104:107], v[88:91], a[172:175]
    s_add_u32 s77, s77, 32768
    v_exp_f32 v241, v241
    v_mfma_f32_16x16x32_bf16 a[172:175], v[108:111], v[92:95], a[172:175]
    v_exp_f32 v242, v242
    v_mfma_f32_16x16x32_bf16 v[248:251], a[240:243], v[136:139], v[188:191]
    v_exp_f32 v243, v243
    v_mfma_f32_16x16x32_bf16 v[248:251], a[244:247], v[168:171], v[248:251]
    v_exp_f32 v244, v244
    v_mfma_f32_16x16x32_bf16 v[248:251], a[248:251], v[200:203], v[248:251]
    v_exp_f32 v245, v245
    v_mfma_f32_16x16x32_bf16 v[248:251], a[252:255], v[232:235], v[248:251]
    v_exp_f32 v246, v246
    v_mfma_f32_16x16x32_bf16 a[184:187], v[112:115], v[80:83], a[184:187]
    v_exp_f32 v247, v247
    v_mfma_f32_16x16x32_bf16 a[184:187], v[116:119], v[84:87], a[184:187]
    v_cvt_pk_bf16_f32 v52, v240, v241
    v_cvt_pk_bf16_f32 v53, v242, v243
    v_mfma_f32_16x16x32_bf16 a[188:191], v[112:115], v[88:91], a[188:191]
    v_cvt_pk_bf16_f32 v60, v244, v245
    v_cvt_pk_bf16_f32 v61, v246, v247
    v_mfma_f32_16x16x32_bf16 a[188:191], v[116:119], v[92:95], a[188:191]
    s_waitcnt vmcnt(16)
    s_barrier
    ds_read_b128 a[224:227], v2 offset:0
    v_mfma_f32_16x16x32_bf16 v[252:255], a[240:243], v[140:143], v[156:159]
    ds_read_b128 a[228:231], v2 offset:1024
    ds_read_b128 a[232:235], v2 offset:2048
    v_mfma_f32_16x16x32_bf16 v[252:255], a[244:247], v[172:175], v[252:255]
    ds_read_b128 a[236:239], v2 offset:3072
    ds_read_b128 v[96:99], v2 offset:16384
    v_mfma_f32_16x16x32_bf16 v[252:255], a[248:251], v[204:207], v[252:255]
    ds_read_b128 v[100:103], v2 offset:17408
    v_mfma_f32_16x16x32_bf16 v[252:255], a[252:255], v[236:239], v[252:255]
    v_exp_f32 v248, v248
    v_mfma_f32_16x16x32_bf16 a[200:203], v[120:123], v[80:83], a[200:203]
    v_exp_f32 v249, v249
    v_mfma_f32_16x16x32_bf16 a[200:203], v[124:127], v[84:87], a[200:203]
    v_exp_f32 v250, v250
    v_mfma_f32_16x16x32_bf16 a[204:207], v[120:123], v[88:91], a[204:207]
    v_exp_f32 v251, v251
    v_mfma_f32_16x16x32_bf16 a[204:207], v[124:127], v[92:95], a[204:207]
    v_exp_f32 v252, v252
    v_mfma_f32_16x16x32_bf16 a[216:219], a[136:139], v[80:83], a[216:219]
    v_exp_f32 v253, v253
    v_mfma_f32_16x16x32_bf16 a[216:219], a[136:139], v[84:87], a[216:219]
    v_cvt_pk_bf16_f32 v54, v248, v249
    v_cvt_pk_bf16_f32 v55, v250, v251
    v_mfma_f32_16x16x32_bf16 a[220:223], a[136:139], v[88:91], a[220:223]
    v_cvt_pk_bf16_f32 v62, v252, v253
    v_mfma_f32_16x16x32_bf16 a[220:223], a[136:139], v[92:95], a[220:223]
    s_sub_u32 s78, s78, 1
    s_cmp_lg_u32 s78, 0
    s_cbranch_scc1 K1_LS
K1_LS_END:
    v_add_f32 v212, s12, v156
    v_fma_f32 v176, v208, s8, v212
    v_fma_f32 v177, v209, s8, v212
    v_fma_f32 v178, v210, s8, v212
    v_fma_f32 v179, v211, s8, v212
    s_nop 1
    s_waitcnt lgkmcnt(0)
    v_mfma_f32_16x16x32_bf16 v[240:243], a[224:227], v[140:143], v[176:179]
    s_mov_b32 s76, s60
    ds_read_b128 v[104:107], v2 offset:18432
    ds_read_b128 v[108:111], v2 offset:19456
    v_mfma_f32_16x16x32_bf16 v[240:243], a[228:231], v[172:175], v[240:243]
    s_mov_b32 s60, s82
    v_lshrrev_b32 v29, 2, v1
    ds_read_b128 a[240:243], v2 offset:4096
    v_mfma_f32_16x16x32_bf16 v[240:243], a[232:235], v[204:207], v[240:243]
    s_add_u32 s82, s82, 32768
    v_exp_f32 v254, v254
    v_mfma_f32_16x16x32_bf16 v[240:243], a[236:239], v[236:239], v[240:243]
    v_exp_f32 v255, v255
    v_mfma_f32_16x16x32_bf16 a[8:11], v[96:99], v[48:51], a[8:11]
    buffer_load_dword v3, v29, s[44:47], 0 offen sc1
    v_mfma_f32_16x16x32_bf16 a[8:11], v[100:103], v[52:55], a[8:11]
    v_cvt_pk_bf16_f32 v63, v254, v255
    ds_read_b128 a[244:247], v2 offset:5120
    v_mfma_f32_16x16x32_bf16 a[12:15], v[96:99], v[56:59], a[12:15]
    ds_read_b128 a[248:251], v2 offset:6144
    ds_read_b128 a[252:255], v2 offset:7168
    v_mfma_f32_16x16x32_bf16 a[12:15], v[100:103], v[60:63], a[12:15]
    s_waitcnt lgkmcnt(3)
    ds_read_b128 v[112:115], v2 offset:20480
    v_add_f32 v213, s13, v156
    v_mfma_f32_16x16x32_bf16 a[24:27], v[104:107], v[48:51], a[24:27]
    ds_read_b128 v[116:119], v2 offset:21504
    v_fma_f32 v180, v208, s9, v213
    v_mfma_f32_16x16x32_bf16 a[24:27], v[108:111], v[52:55], a[24:27]
    v_fma_f32 v181, v209, s9, v213
    v_fma_f32 v182, v210, s9, v213
    v_mfma_f32_16x16x32_bf16 a[28:31], v[104:107], v[56:59], a[28:31]
    v_fma_f32 v183, v211, s9, v213
    ds_read_b128 v[120:123], v2 offset:22528
    v_mfma_f32_16x16x32_bf16 a[28:31], v[108:111], v[60:63], a[28:31]
    ds_read_b128 v[124:127], v2 offset:23552
    ds_read_b128 a[224:227], v2 offset:8192
    v_mfma_f32_16x16x32_bf16 v[244:247], a[240:243], v[140:143], v[180:183]
    s_waitcnt lgkmcnt(4)
    ds_read_b128 a[228:231], v2 offset:9216
    ds_read_b128 a[232:235], v2 offset:10240
    v_mfma_f32_16x16x32_bf16 v[244:247], a[244:247], v[172:175], v[244:247]
    ds_read_b128 a[236:239], v2 offset:11264
    ds_read_b128 v[96:99], v2 offset:24576
    v_mfma_f32_16x16x32_bf16 v[244:247], a[248:251], v[204:207], v[244:247]
    v_add_f32 v214, s14, v156
    ds_read_b128 v[100:103], v2 offset:25600
    v_mfma_f32_16x16x32_bf16 v[244:247], a[252:255], v[236:239], v[244:247]
    v_fma_f32 v184, v208, s10, v214
    v_fma_f32 v185, v209, s10, v214
    v_mfma_f32_16x16x32_bf16 a[40:43], v[112:115], v[48:51], a[40:43]
    s_waitcnt lgkmcnt(5)
    v_fma_f32 v186, v210, s10, v214
    v_fma_f32 v187, v211, s10, v214
    v_mfma_f32_16x16x32_bf16 a[40:43], v[116:119], v[52:55], a[40:43]
    ds_read_b128 v[104:107], v2 offset:26624
    ds_read_b128 v[108:111], v2 offset:27648
    v_mfma_f32_16x16x32_bf16 a[44:47], v[112:115], v[56:59], a[44:47]
    ds_read_b128 a[240:243], v2 offset:12288
    ds_read_b128 a[244:247], v2 offset:13312
    v_mfma_f32_16x16x32_bf16 a[44:47], v[116:119], v[60:63], a[44:47]
    ds_read_b128 a[248:251], v2 offset:14336
    ds_read_b128 a[252:255], v2 offset:15360
    v_mfma_f32_16x16x32_bf16 a[56:59], v[120:123], v[48:51], a[56:59]
    ds_read_b128 v[112:115], v2 offset:28672
    v_add_f32 v215, s15, v156
    v_mfma_f32_16x16x32_bf16 a[56:59], v[124:127], v[52:55], a[56:59]
    ds_read_b128 v[116:119], v2 offset:29696
    v_fma_f32 v188, v208, s11, v215
    v_mfma_f32_16x16x32_bf16 a[60:63], v[120:123], v[56:59], a[60:63]
    v_fma_f32 v189, v209, s11, v215
    v_fma_f32 v190, v210, s11, v215
    v_mfma_f32_16x16x32_bf16 a[60:63], v[124:127], v[60:63], a[60:63]
    v_fma_f32 v191, v211, s11, v215
    ds_read_b128 v[120:123], v2 offset:30720
    v_mfma_f32_16x16x32_bf16 v[248:251], a[224:227], v[140:143], v[184:187]
    s_waitcnt lgkmcnt(3)
    ds_read_b128 v[124:127], v2 offset:31744
    v_mfma_f32_16x16x32_bf16 v[248:251], a[228:231], v[172:175], v[248:251]
    s_cmp_eq_u32 s82, 163840
    s_cselect_b32 s82, 0, s82
    v_add_u32 v2, s82, v1
    v_mfma_f32_16x16x32_bf16 v[248:251], a[232:235], v[204:207], v[248:251]
    v_exp_f32 v240, v240
    v_mfma_f32_16x16x32_bf16 v[248:251], a[236:239], v[236:239], v[248:251]
    v_exp_f32 v241, v241
    v_mfma_f32_16x16x32_bf16 a[152:155], v[96:99], v[48:51], a[152:155]
    v_exp_f32 v242, v242
    v_mfma_f32_16x16x32_bf16 a[152:155], v[100:103], v[52:55], a[152:155]
    v_exp_f32 v243, v243
    v_mfma_f32_16x16x32_bf16 a[156:159], v[96:99], v[56:59], a[156:159]
    v_exp_f32 v244, v244
    v_mfma_f32_16x16x32_bf16 a[156:159], v[100:103], v[60:63], a[156:159]
    v_exp_f32 v245, v245
    v_mfma_f32_16x16x32_bf16 a[168:171], v[104:107], v[48:51], a[168:171]
    v_exp_f32 v246, v246
    v_mfma_f32_16x16x32_bf16 a[168:171], v[108:111], v[52:55], a[168:171]
    v_exp_f32 v247, v247
    v_mfma_f32_16x16x32_bf16 a[172:175], v[104:107], v[56:59], a[172:175]
    v_exp_f32 v248, v248
    v_mfma_f32_16x16x32_bf16 a[172:175], v[108:111], v[60:63], a[172:175]
    v_exp_f32 v249, v249
    v_mfma_f32_16x16x32_bf16 v[252:255], a[240:243], v[140:143], v[188:191]
    v_exp_f32 v250, v250
    v_mfma_f32_16x16x32_bf16 v[252:255], a[244:247], v[172:175], v[252:255]
    v_exp_f32 v251, v251
    v_mfma_f32_16x16x32_bf16 v[252:255], a[248:251], v[204:207], v[252:255]
    v_cvt_pk_bf16_f32 v88, v240, v241
    v_cvt_pk_bf16_f32 v89, v242, v243
    v_mfma_f32_16x16x32_bf16 v[252:255], a[252:255], v[236:239], v[252:255]
    s_waitcnt vmcnt(0) lgkmcnt(0)
    s_barrier
    ds_read_b128 a[224:227], v2 offset:0
    v_mfma_f32_16x16x32_bf16 a[184:187], v[112:115], v[48:51], a[184:187]
    ds_read_b128 a[228:231], v2 offset:1024
    ds_read_b128 a[232:235], v2 offset:2048
    v_mfma_f32_16x16x32_bf16 a[184:187], v[116:119], v[52:55], a[184:187]
    ds_read_b128 a[236:239], v2 offset:3072
    ds_read_b128 v[96:99], v2 offset:16384
    v_mfma_f32_16x16x32_bf16 a[188:191], v[112:115], v[56:59], a[188:191]
    ds_read_b128 v[100:103], v2 offset:17408
    v_cvt_pk_bf16_f32 v90, v244, v245
    v_mfma_f32_16x16x32_bf16 a[188:191], v[116:119], v[60:63], a[188:191]
    v_exp_f32 v252, v252
    v_mfma_f32_16x16x32_bf16 a[200:203], v[120:123], v[48:51], a[200:203]
    v_exp_f32 v253, v253
    v_mfma_f32_16x16x32_bf16 a[200:203], v[124:127], v[52:55], a[200:203]
    v_cvt_pk_bf16_f32 v91, v246, v247
    v_cvt_pk_bf16_f32 v92, v248, v249
    v_mfma_f32_16x16x32_bf16 a[204:207], v[120:123], v[56:59], a[204:207]
    v_cvt_pk_bf16_f32 v93, v250, v251
    v_cvt_pk_bf16_f32 v94, v252, v253
    v_mfma_f32_16x16x32_bf16 a[204:207], v[124:127], v[60:63], a[204:207]
    v_mfma_f32_16x16x32_bf16 a[216:219], a[136:139], v[48:51], a[216:219]
    v_mfma_f32_16x16x32_bf16 a[216:219], a[136:139], v[52:55], a[216:219]
    v_mfma_f32_16x16x32_bf16 a[220:223], a[136:139], v[56:59], a[220:223]
    v_mfma_f32_16x16x32_bf16 a[220:223], a[136:139], v[60:63], a[220:223]
    s_waitcnt lgkmcnt(0)
    v_mfma_f32_16x16x32_bf16 a[12:15], v[96:99], v[88:91], a[12:15]
    ds_read_b128 v[104:107], v2 offset:18432
    ds_read_b128 v[108:111], v2 offset:19456
    v_exp_f32 v254, v254
    v_exp_f32 v255, v255
    s_nop 0
    v_cvt_pk_bf16_f32 v95, v254, v255
    s_nop 1
    v_mfma_f32_16x16x32_bf16 a[12:15], v[100:103], v[92:95], a[12:15]
    s_waitcnt lgkmcnt(1)
    ds_read_b128 v[112:115], v2 offset:20480
    ds_read_b128 v[116:119], v2 offset:21504
    v_mfma_f32_16x16x32_bf16 a[28:31], v[104:107], v[88:91], a[28:31]
    s_waitcnt lgkmcnt(2)
    ds_read_b128 v[120:123], v2 offset:22528
    ds_read_b128 v[124:127], v2 offset:23552
    v_mfma_f32_16x16x32_bf16 a[28:31], v[108:111], v[92:95], a[28:31]
    s_waitcnt lgkmcnt(3)
    ds_read_b128 v[96:99], v2 offset:24576
    ds_read_b128 v[100:103], v2 offset:25600
    v_mfma_f32_16x16x32_bf16 a[44:47], v[112:115], v[88:91], a[44:47]
    s_waitcnt lgkmcnt(4)
    ds_read_b128 v[104:107], v2 offset:26624
    ds_read_b128 v[108:111], v2 offset:27648
    v_mfma_f32_16x16x32_bf16 a[44:47], v[116:119], v[92:95], a[44:47]
    s_waitcnt lgkmcnt(5)
    ds_read_b128 v[112:115], v2 offset:28672
    ds_read_b128 v[116:119], v2 offset:29696
    v_mfma_f32_16x16x32_bf16 a[60:63], v[120:123], v[88:91], a[60:63]
    s_waitcnt lgkmcnt(6)
    ds_read_b128 v[120:123], v2 offset:30720
    v_mfma_f32_16x16x32_bf16 a[60:63], v[124:127], v[92:95], a[60:63]
    s_waitcnt lgkmcnt(6)
    ds_read_b128 v[124:127], v2 offset:31744
    v_mfma_f32_16x16x32_bf16 a[156:159], v[96:99], v[88:91], a[156:159]
    s_waitcnt lgkmcnt(6)
    v_mfma_f32_16x16x32_bf16 a[156:159], v[100:103], v[92:95], a[156:159]
    s_waitcnt lgkmcnt(4)
    v_mfma_f32_16x16x32_bf16 a[172:175], v[104:107], v[88:91], a[172:175]
    v_mfma_f32_16x16x32_bf16 a[172:175], v[108:111], v[92:95], a[172:175]
    s_waitcnt lgkmcnt(1)
    v_mfma_f32_16x16x32_bf16 a[188:191], v[112:115], v[88:91], a[188:191]
    v_mfma_f32_16x16x32_bf16 a[188:191], v[116:119], v[92:95], a[188:191]
    v_mfma_f32_16x16x32_bf16 a[204:207], v[120:123], v[88:91], a[204:207]
    s_waitcnt lgkmcnt(0)
    v_mfma_f32_16x16x32_bf16 a[204:207], v[124:127], v[92:95], a[204:207]
    v_mfma_f32_16x16x32_bf16 a[220:223], a[136:139], v[88:91], a[220:223]
    v_mfma_f32_16x16x32_bf16 a[220:223], a[136:139], v[92:95], a[220:223]
    s_nop 7
    v_accvgpr_read_b32 v8, a216
    v_cmp_nge_f32 vcc, s101, v8
    v_rcp_f32 v10, v8
    s_nop 0
    s_or_b64 s[84:85], s[84:85], vcc
    v_mul_f32 v10, v10, v6
    v_accvgpr_read_b32 v12, a8
    v_accvgpr_read_b32 v13, a9
    v_accvgpr_read_b32 v14, a10
    v_accvgpr_read_b32 v15, a11
    v_accvgpr_read_b32 v16, a24
    v_accvgpr_read_b32 v17, a25
    v_accvgpr_read_b32 v18, a26
    v_accvgpr_read_b32 v19, a27
    v_pk_mul_f32 v[12:13], v[12:13], v[10:11] op_sel_hi:[1,0]
    v_pk_mul_f32 v[14:15], v[14:15], v[10:11] op_sel_hi:[1,0]
    v_pk_mul_f32 v[16:17], v[16:17], v[10:11] op_sel_hi:[1,0]
    v_pk_mul_f32 v[18:19], v[18:19], v[10:11] op_sel_hi:[1,0]
    v_cvt_pk_bf16_f32 v12, v12, v13
    v_cvt_pk_bf16_f32 v13, v14, v15
    v_cvt_pk_bf16_f32 v14, v16, v17
    v_cvt_pk_bf16_f32 v15, v18, v19
    buffer_store_dwordx4 v[12:15], v1, s[40:43], s81 offen offset:0 sc1
    v_accvgpr_read_b32 v20, a40
    v_accvgpr_read_b32 v21, a41
    v_accvgpr_read_b32 v22, a42
    v_accvgpr_read_b32 v23, a43
    v_accvgpr_read_b32 v24, a56
    v_accvgpr_read_b32 v25, a57
    v_accvgpr_read_b32 v26, a58
    v_accvgpr_read_b32 v27, a59
    v_pk_mul_f32 v[20:21], v[20:21], v[10:11] op_sel_hi:[1,0]
    v_pk_mul_f32 v[22:23], v[22:23], v[10:11] op_sel_hi:[1,0]
    v_pk_mul_f32 v[24:25], v[24:25], v[10:11] op_sel_hi:[1,0]
    v_pk_mul_f32 v[26:27], v[26:27], v[10:11] op_sel_hi:[1,0]
    v_cvt_pk_bf16_f32 v20, v20, v21
    v_cvt_pk_bf16_f32 v21, v22, v23
    v_cvt_pk_bf16_f32 v22, v24, v25
    v_cvt_pk_bf16_f32 v23, v26, v27
    buffer_store_dwordx4 v[20:23], v1, s[40:43], s81 offen offset:1024 sc1
    v_accvgpr_read_b32 v12, a152
    v_accvgpr_read_b32 v13, a153
    v_accvgpr_read_b32 v14, a154
    v_accvgpr_read_b32 v15, a155
    v_accvgpr_read_b32 v16, a168
    v_accvgpr_read_b32 v17, a169
    v_accvgpr_read_b32 v18, a170
    v_accvgpr_read_b32 v19, a171
    v_pk_mul_f32 v[12:13], v[12:13], v[10:11] op_sel_hi:[1,0]
    v_pk_mul_f32 v[14:15], v[14:15], v[10:11] op_sel_hi:[1,0]
    v_pk_mul_f32 v[16:17], v[16:17], v[10:11] op_sel_hi:[1,0]
    v_pk_mul_f32 v[18:19], v[18:19], v[10:11] op_sel_hi:[1,0]
    v_cvt_pk_bf16_f32 v12, v12, v13
    v_cvt_pk_bf16_f32 v13, v14, v15
    v_cvt_pk_bf16_f32 v14, v16, v17
    v_cvt_pk_bf16_f32 v15, v18, v19
    buffer_store_dwordx4 v[12:15], v1, s[40:43], s81 offen offset:2048 sc1
    v_accvgpr_read_b32 v20, a184
    v_accvgpr_read_b32 v21, a185
    v_accvgpr_read_b32 v22, a186
    v_accvgpr_read_b32 v23, a187
    v_accvgpr_read_b32 v24, a200
    v_accvgpr_read_b32 v25, a201
    v_accvgpr_read_b32 v26, a202
    v_accvgpr_read_b32 v27, a203
    v_pk_mul_f32 v[20:21], v[20:21], v[10:11] op_sel_hi:[1,0]
    v_pk_mul_f32 v[22:23], v[22:23], v[10:11] op_sel_hi:[1,0]
    v_pk_mul_f32 v[24:25], v[24:25], v[10:11] op_sel_hi:[1,0]
    v_pk_mul_f32 v[26:27], v[26:27], v[10:11] op_sel_hi:[1,0]
    v_cvt_pk_bf16_f32 v20, v20, v21
    v_cvt_pk_bf16_f32 v21, v22, v23
    v_cvt_pk_bf16_f32 v22, v24, v25
    v_cvt_pk_bf16_f32 v23, v26, v27
    buffer_store_dwordx4 v[20:23], v1, s[40:43], s81 offen offset:3072 sc1
    v_accvgpr_read_b32 v8, a220
    v_cmp_nge_f32 vcc, s101, v8
    v_rcp_f32 v10, v8
    s_nop 0
    s_or_b64 s[84:85], s[84:85], vcc
    v_mul_f32 v10, v10, v7
    s_add_u32 s72, s81, 598016
    v_accvgpr_read_b32 v12, a12
    v_accvgpr_read_b32 v13, a13
    v_accvgpr_read_b32 v14, a14
    v_accvgpr_read_b32 v15, a15
    v_accvgpr_read_b32 v16, a28
    v_accvgpr_read_b32 v17, a29
    v_accvgpr_read_b32 v18, a30
    v_accvgpr_read_b32 v19, a31
    v_pk_mul_f32 v[12:13], v[12:13], v[10:11] op_sel_hi:[1,0]
    v_pk_mul_f32 v[14:15], v[14:15], v[10:11] op_sel_hi:[1,0]
    v_pk_mul_f32 v[16:17], v[16:17], v[10:11] op_sel_hi:[1,0]
    v_pk_mul_f32 v[18:19], v[18:19], v[10:11] op_sel_hi:[1,0]
    v_cvt_pk_bf16_f32 v12, v12, v13
    v_cvt_pk_bf16_f32 v13, v14, v15
    v_cvt_pk_bf16_f32 v14, v16, v17
    v_cvt_pk_bf16_f32 v15, v18, v19
    buffer_store_dwordx4 v[12:15], v1, s[40:43], s72 offen offset:0 sc1
    v_accvgpr_read_b32 v20, a44
    v_accvgpr_read_b32 v21, a45
    v_accvgpr_read_b32 v22, a46
    v_accvgpr_read_b32 v23, a47
    v_accvgpr_read_b32 v24, a60
    v_accvgpr_read_b32 v25, a61
    v_accvgpr_read_b32 v26, a62
    v_accvgpr_read_b32 v27, a63
    v_pk_mul_f32 v[20:21], v[20:21], v[10:11] op_sel_hi:[1,0]
    v_pk_mul_f32 v[22:23], v[22:23], v[10:11] op_sel_hi:[1,0]
    v_pk_mul_f32 v[24:25], v[24:25], v[10:11] op_sel_hi:[1,0]
    v_pk_mul_f32 v[26:27], v[26:27], v[10:11] op_sel_hi:[1,0]
    v_cvt_pk_bf16_f32 v20, v20, v21
    v_cvt_pk_bf16_f32 v21, v22, v23
    v_cvt_pk_bf16_f32 v22, v24, v25
    v_cvt_pk_bf16_f32 v23, v26, v27
    buffer_store_dwordx4 v[20:23], v1, s[40:43], s72 offen offset:1024 sc1
    v_accvgpr_read_b32 v12, a156
    v_accvgpr_read_b32 v13, a157
    v_accvgpr_read_b32 v14, a158
    v_accvgpr_read_b32 v15, a159
    v_accvgpr_read_b32 v16, a172
    v_accvgpr_read_b32 v17, a173
    v_accvgpr_read_b32 v18, a174
    v_accvgpr_read_b32 v19, a175
    v_pk_mul_f32 v[12:13], v[12:13], v[10:11] op_sel_hi:[1,0]
    v_pk_mul_f32 v[14:15], v[14:15], v[10:11] op_sel_hi:[1,0]
    v_pk_mul_f32 v[16:17], v[16:17], v[10:11] op_sel_hi:[1,0]
    v_pk_mul_f32 v[18:19], v[18:19], v[10:11] op_sel_hi:[1,0]
    v_cvt_pk_bf16_f32 v12, v12, v13
    v_cvt_pk_bf16_f32 v13, v14, v15
    v_cvt_pk_bf16_f32 v14, v16, v17
    v_cvt_pk_bf16_f32 v15, v18, v19
    buffer_store_dwordx4 v[12:15], v1, s[40:43], s72 offen offset:2048 sc1
    v_accvgpr_read_b32 v20, a188
    v_accvgpr_read_b32 v21, a189
    v_accvgpr_read_b32 v22, a190
    v_accvgpr_read_b32 v23, a191
    v_accvgpr_read_b32 v24, a204
    v_accvgpr_read_b32 v25, a205
    v_accvgpr_read_b32 v26, a206
    v_accvgpr_read_b32 v27, a207
    v_pk_mul_f32 v[20:21], v[20:21], v[10:11] op_sel_hi:[1,0]
    v_pk_mul_f32 v[22:23], v[22:23], v[10:11] op_sel_hi:[1,0]
    v_pk_mul_f32 v[24:25], v[24:25], v[10:11] op_sel_hi:[1,0]
    v_pk_mul_f32 v[26:27], v[26:27], v[10:11] op_sel_hi:[1,0]
    v_cvt_pk_bf16_f32 v20, v20, v21
    v_cvt_pk_bf16_f32 v21, v22, v23
    v_cvt_pk_bf16_f32 v22, v24, v25
    v_cvt_pk_bf16_f32 v23, v26, v27
    buffer_store_dwordx4 v[20:23], v1, s[40:43], s72 offen offset:3072 sc1
    s_bfe_u32 s61, s2, 0x20001
    s_lshr_b32 s98, s2, 5
    s_lshl3_add_u32 s61, s61, s98
    s_and_b32 s62, s2, 1
    s_bfe_u32 s98, s2, 0x10004
    s_lshl1_add_u32 s62, s62, s98
    s_bfe_u32 s63, s2, 0x10003
    s_mul_i32 s62, s62, 9
    s_mul_i32 s98, s63, 5
    s_add_u32 s65, s62, s98
    s_lshl_b32 s65, s65, 10
    s_add_u32 s66, s62, 4
    s_lshl_b32 s66, s66, 10
    s_mul_i32 s98, s4, 36864
    v_add_u32 v16, s98, v1
    v_cmp_gt_u32 vcc, 24, v3
    s_nop 1
    s_and_b64 vcc, vcc, s[92:93]
    s_cbranch_scc1 SPIN_ALL
BACK_ALL:
    buffer_load_dwordx4 a[0:3], v16, s[56:59], s65 offen offset:0 sc1
    s_add_u32 s79, s82, 32768
    s_cmp_ge_u32 s79, 131072
    s_cselect_b32 s79, 0, s79
    v_bfe_u32 v20, v1, 4, 4
    v_lshrrev_b32 v21, 8, v1
    s_lshl_b32 s98, s4, 4
    s_add_u32 s98, s98, 16
    v_add_u32 v22, s98, v20
    v_mul_u32_u24 v22, 144, v22
    v_add_u32 v22, s79, v22
    v_lshl_add_u32 v9, v21, 3, v22
    s_lshr_b32 s98, s73, 1
    v_add_u32 v8, s98, v9
    v_subrev_u32 v10, s98, v9
    s_and_b32 s99, s4, 1
    s_mul_i32 s99, s99, 20736
    buffer_load_dwordx4 a[4:7], v16, s[56:59], s65 offen offset:1024 sc1
    s_add_u32 s99, s99, s79
    v_mul_u32_u24 v23, 144, v20
    v_lshl_add_u32 v23, v21, 3, v23
    v_add_u32 v13, s99, v23
    v_add_u32 v12, s98, v13
    v_accvgpr_read_b32 v32, a64
    v_accvgpr_read_b32 v33, a65
    v_accvgpr_read_b32 v34, a66
    v_accvgpr_read_b32 v35, a67
    v_cvt_pk_bf16_f32 v32, v32, v33
    v_cvt_pk_bf16_f32 v33, v34, v35
    ds_write_b64 v8, v[32:33] offset:0
    v_accvgpr_read_b32 v36, a68
    v_accvgpr_read_b32 v37, a69
    v_accvgpr_read_b32 v38, a70
    v_accvgpr_read_b32 v39, a71
    buffer_load_dwordx4 a[8:11], v16, s[56:59], s65 offen offset:2048 sc1
    v_cvt_pk_bf16_f32 v36, v36, v37
    v_cvt_pk_bf16_f32 v37, v38, v39
    ds_write_b64 v8, v[36:37] offset:9216
    v_accvgpr_read_b32 v40, a72
    v_accvgpr_read_b32 v41, a73
    v_accvgpr_read_b32 v42, a74
    v_accvgpr_read_b32 v43, a75
    v_cvt_pk_bf16_f32 v40, v40, v41
    v_cvt_pk_bf16_f32 v41, v42, v43
    ds_write_b64 v8, v[40:41] offset:20736
    v_accvgpr_read_b32 v44, a76
    v_accvgpr_read_b32 v45, a77
    v_accvgpr_read_b32 v46, a78
    v_accvgpr_read_b32 v47, a79
    v_cvt_pk_bf16_f32 v44, v44, v45
    v_cvt_pk_bf16_f32 v45, v46, v47
    buffer_load_dwordx4 a[12:15], v16, s[56:59], s65 offen offset:3072 sc1
    ds_write_b64 v8, v[44:45] offset:29952
    v_accvgpr_read_b32 v32, a80
    v_accvgpr_read_b32 v33, a81
    v_accvgpr_read_b32 v34, a82
    v_accvgpr_read_b32 v35, a83
    v_cvt_pk_bf16_f32 v32, v32, v33
    v_cvt_pk_bf16_f32 v33, v34, v35
    ds_write_b64 v9, v[32:33] offset:32
    v_accvgpr_read_b32 v36, a84
    v_accvgpr_read_b32 v37, a85
    v_accvgpr_read_b32 v38, a86
    v_accvgpr_read_b32 v39, a87
    v_cvt_pk_bf16_f32 v36, v36, v37
    v_cvt_pk_bf16_f32 v37, v38, v39
    ds_write_b64 v9, v[36:37] offset:9248
    v_accvgpr_read_b32 v40, a88
    s_add_u32 s65, s65, 147456
    buffer_load_dwordx4 a[16:19], v16, s[56:59], s66 offen sc1
    v_accvgpr_read_b32 v41, a89
    v_accvgpr_read_b32 v42, a90
    v_accvgpr_read_b32 v43, a91
    v_cvt_pk_bf16_f32 v40, v40, v41
    v_cvt_pk_bf16_f32 v41, v42, v43
    ds_write_b64 v9, v[40:41] offset:20768
    v_accvgpr_read_b32 v44, a92
    v_accvgpr_read_b32 v45, a93
    v_accvgpr_read_b32 v46, a94
    v_accvgpr_read_b32 v47, a95
    v_cvt_pk_bf16_f32 v44, v44, v45
    v_cvt_pk_bf16_f32 v45, v46, v47
    ds_write_b64 v9, v[44:45] offset:29984
    v_accvgpr_read_b32 v32, a96
    v_accvgpr_read_b32 v33, a97
    v_accvgpr_read_b32 v34, a98
    s_add_u32 s66, s66, 147456
    buffer_load_dwordx4 a[20:23], v16, s[56:59], s65 offen offset:0 sc1
    v_accvgpr_read_b32 v35, a99
    v_cvt_pk_bf16_f32 v32, v32, v33
    v_cvt_pk_bf16_f32 v33, v34, v35
    ds_write_b64 v10, v[32:33] offset:64
    v_accvgpr_read_b32 v36, a100
    v_accvgpr_read_b32 v37, a101
    v_accvgpr_read_b32 v38, a102
    v_accvgpr_read_b32 v39, a103
    v_cvt_pk_bf16_f32 v36, v36, v37
    v_cvt_pk_bf16_f32 v37, v38, v39
    ds_write_b64 v10, v[36:37] offset:9280
    v_accvgpr_read_b32 v40, a104
    v_accvgpr_read_b32 v41, a105
    v_accvgpr_read_b32 v42, a106
    v_accvgpr_read_b32 v43, a107
    v_cvt_pk_bf16_f32 v40, v40, v41
    buffer_load_dwordx4 a[24:27], v16, s[56:59], s65 offen offset:1024 sc1
    v_cvt_pk_bf16_f32 v41, v42, v43
    ds_write_b64 v10, v[40:41] offset:20800
    v_accvgpr_read_b32 v44, a108
    v_accvgpr_read_b32 v45, a109
    v_accvgpr_read_b32 v46, a110
    v_accvgpr_read_b32 v47, a111
    v_cvt_pk_bf16_f32 v44, v44, v45
    v_cvt_pk_bf16_f32 v45, v46, v47
    ds_write_b64 v10, v[44:45] offset:30016
    v_accvgpr_read_b32 v32, a112
    v_accvgpr_read_b32 v33, a113
    v_accvgpr_read_b32 v34, a114
    v_accvgpr_read_b32 v35, a115
    v_cvt_pk_bf16_f32 v32, v32, v33
    v_cvt_pk_bf16_f32 v33, v34, v35
    ds_write_b64 v9, v[32:33] offset:96
    buffer_load_dwordx4 a[28:31], v16, s[56:59], s65 offen offset:2048 sc1
    v_accvgpr_read_b32 v36, a116
    v_accvgpr_read_b32 v37, a117
    v_accvgpr_read_b32 v38, a118
    v_accvgpr_read_b32 v39, a119
    v_cvt_pk_bf16_f32 v36, v36, v37
    v_cvt_pk_bf16_f32 v37, v38, v39
    ds_write_b64 v9, v[36:37] offset:9312
    v_accvgpr_read_b32 v40, a120
    v_accvgpr_read_b32 v41, a121
    v_accvgpr_read_b32 v42, a122
    v_accvgpr_read_b32 v43, a123
    v_cvt_pk_bf16_f32 v40, v40, v41
    v_cvt_pk_bf16_f32 v41, v42, v43
    ds_write_b64 v9, v[40:41] offset:20832
    v_accvgpr_read_b32 v44, a124
    v_accvgpr_read_b32 v45, a125
    buffer_load_dwordx4 a[32:35], v16, s[56:59], s65 offen offset:3072 sc1
    v_accvgpr_read_b32 v46, a126
    v_accvgpr_read_b32 v47, a127
    v_cvt_pk_bf16_f32 v44, v44, v45
    v_cvt_pk_bf16_f32 v45, v46, v47
    s_waitcnt lgkmcnt(14)
    ds_write_b64 v9, v[44:45] offset:30048
    v_accvgpr_read_b32 v32, a128
    v_accvgpr_read_b32 v33, a129
    v_accvgpr_read_b32 v34, a130
    v_accvgpr_read_b32 v35, a131
    v_cvt_pk_bf16_f32 v32, v32, v33
    v_cvt_pk_bf16_f32 v33, v34, v35
    s_waitcnt lgkmcnt(14)
    ds_write_b64 v12, v[32:33] offset:0
    v_accvgpr_read_b32 v36, a132
    v_accvgpr_read_b32 v37, a133
    v_accvgpr_read_b32 v38, a134
    v_accvgpr_read_b32 v39, a135
    s_add_u32 s65, s65, 147456
    buffer_load_dwordx4 a[36:39], v16, s[56:59], s66 offen sc1
    s_add_u32 s66, s66, 147456
    v_cvt_pk_bf16_f32 v36, v36, v37
    v_cvt_pk_bf16_f32 v37, v38, v39
    s_cmp_eq_u32 s73, 0
    s_cselect_b64 exec, -1, 0
    s_waitcnt lgkmcnt(14)
    ds_write_b64 v13, v[36:37] offset:32
    s_mov_b64 exec, -1
    s_cmp_lg_u64 s[84:85], 0
    s_cselect_b32 s7, 1, 0
    v_mov_b32 v20, s7
    s_lshl2_add_u32 s98, s4, s79
    v_mov_b32 v21, s98
    s_waitcnt lgkmcnt(14)
    ds_write_b32 v21, v20 offset:41472
    v_mov_b32 v21, s79
    s_lshl_b32 s70, s6, 5
    s_add_u32 s70, s70, s5
    s_lshl_b32 s70, s70, 7
    s_waitcnt vmcnt(10)
    s_waitcnt lgkmcnt(0)
    s_barrier
    ds_read_b128 v[24:27], v21 offset:41472
    s_and_b32 s98, s4, 1
    s_lshl_b32 s98, s98, 6
    v_lshrrev_b32 v14, 4, v1
    v_add_u32 v14, s98, v14
    s_lshr_b32 s99, s4, 1
    s_mul_i32 s7, s99, 144
    s_add_u32 s7, s7, 2
    v_add_u32 v2, s7, v14
    v_mul_u32_u24 v2, 144, v2
    v_add_u32 v2, s79, v2
    s_waitcnt lgkmcnt(0)
    v_or3_b32 v24, v24, v25, v26
    v_or_b32 v24, v24, v27
    s_nop 0
    v_readfirstlane_b32 s7, v24
    s_nop 1
    s_andn2_b32 s7, s7, s83
    s_cbranch_scc1 K1_REDO
    v_mov_b32 v31, 1
    buffer_store_dword v31, v30, s[32:35], s70 offen sc1
    buffer_load_dwordx4 a[40:43], v16, s[56:59], s65 offen offset:0 sc1
    ds_read_b128 v[128:131], v2 offset:2096
    ds_read_b128 v[132:135], v2 offset:2112
    ds_read_b128 v[136:139], v2 offset:2128
    ds_read_b128 v[32:35], v2 offset:2016
    ds_read_b128 v[36:39], v2 offset:2032
    ds_read_b128 v[40:43], v2 offset:2048
    ds_read_b128 v[44:47], v2 offset:1728
    ds_read_b128 v[48:51], v2 offset:1744
    ds_read_b128 v[52:55], v2 offset:1760
    ds_read_b128 v[56:59], v2 offset:1440
    ds_read_b128 v[60:63], v2 offset:1456
    ds_read_b128 v[64:67], v2 offset:1472
    buffer_load_dwordx4 a[44:47], v16, s[56:59], s65 offen offset:1024 sc1
    ds_read_b128 v[68:71], v2 offset:1152
    ds_read_b128 v[72:75], v2 offset:1168
    ds_read_b128 v[76:79], v2 offset:1184
    s_waitcnt lgkmcnt(14)
    ds_read_b128 v[80:83], v2 offset:864
    s_waitcnt lgkmcnt(14)
    ds_read_b128 v[84:87], v2 offset:880
    s_waitcnt lgkmcnt(14)
    ds_read_b128 v[88:91], v2 offset:896
    s_waitcnt lgkmcnt(14)
    ds_read_b128 v[92:95], v2 offset:576
    s_waitcnt lgkmcnt(14)
    ds_read_b128 v[96:99], v2 offset:592
    s_waitcnt lgkmcnt(14)
    ds_read_b128 v[100:103], v2 offset:608
    s_waitcnt lgkmcnt(14)
    ds_read_b128 v[104:107], v2 offset:288
    s_waitcnt lgkmcnt(14)
    ds_read_b128 v[108:111], v2 offset:304
    s_waitcnt lgkmcnt(14)
    ds_read_b128 v[112:115], v2 offset:320
    s_waitcnt lgkmcnt(14)
    ds_read_b128 v[116:119], v2 offset:0
    buffer_load_dwordx4 a[48:51], v16, s[56:59], s65 offen offset:2048 sc1
    s_waitcnt lgkmcnt(14)
    ds_read_b128 v[120:123], v2 offset:16
    s_waitcnt lgkmcnt(14)
    ds_read_b128 v[124:127], v2 offset:32
    s_sub_u32 s7, 15, s6
    s_cmp_eq_u32 s99, 0
    s_cselect_b32 s7, s6, s7
    s_lshl_b32 s7, s7, 7
    v_add_u32 v14, s7, v14
    v_lshrrev_b32 v15, 4, v14
    s_mov_b32 s98, 149504
    v_mul_lo_u32 v15, v15, s98
    v_and_b32 v23, 0xf0, v1
    v_add_u32 v15, v15, v23
    s_lshl1_add_u32 s98, s63, 0
    buffer_load_dwordx4 a[52:55], v16, s[56:59], s65 offen offset:3072 sc1
    s_and_b32 s98, s98, 3
    s_lshl2_add_u32 s98, s61, s98
    s_mul_i32 s98, s98, 146
    s_add_u32 s98, s98, s4
    s_lshl_b32 s98, s98, 10
    v_add_u32 v4, s98, v1
    s_lshl1_add_u32 s98, s63, 1
    s_and_b32 s98, s98, 3
    s_lshl2_add_u32 s98, s61, s98
    s_mul_i32 s98, s98, 146
    s_add_u32 s98, s98, s4
    s_lshl_b32 s98, s98, 10
    s_add_u32 s65, s65, 147456
    buffer_load_dwordx4 a[56:59], v16, s[56:59], s66 offen sc1
    v_add_u32 v5, s98, v1
    s_lshl1_add_u32 s98, s63, 2
    s_and_b32 s98, s98, 3
    s_lshl2_add_u32 s98, s61, s98
    s_mul_i32 s98, s98, 146
    s_add_u32 s98, s98, s4
    s_lshl_b32 s98, s98, 10
    v_add_u32 v6, s98, v1
    s_lshl1_add_u32 s98, s63, 3
    s_and_b32 s98, s98, 3
    s_lshl2_add_u32 s98, s61, s98
    s_mul_i32 s98, s98, 146
    s_add_u32 s98, s98, s4
    s_add_u32 s66, s66, 147456
    buffer_load_dwordx4 a[136:139], v16, s[56:59], s65 offen offset:0 sc1
    s_lshl_b32 s98, s98, 10
    v_add_u32 v7, s98, v1
    s_mov_b32 s64, 0
    s_lshr_b32 s98, s61, 1
    s_sub_u32 s99, 15, s98
    s_min_u32 s98, s98, s99
    s_lshl_b32 s71, s98, 12
    v_lshlrev_b32 v19, 3, v1
    v_min_u32 v19, 3968, v19
    v_mov_b32 v140, 0
    v_mov_b32 v141, 0
    v_mov_b32 v142, 0
    v_mov_b32 v143, 0
    buffer_load_dwordx4 a[140:143], v16, s[56:59], s65 offen offset:1024 sc1
    v_mov_b32 v144, 0
    v_mov_b32 v145, 0
    v_mov_b32 v146, 0
    v_mov_b32 v147, 0
    v_dot2c_f32_bf16 v140, v128, v32
    v_dot2c_f32_bf16 v141, v128, v44
    v_dot2c_f32_bf16 v142, v128, v56
    s_waitcnt lgkmcnt(14)
    v_dot2c_f32_bf16 v143, v128, v68
    v_dot2c_f32_bf16 v140, v129, v33
    v_dot2c_f32_bf16 v141, v129, v45
    v_dot2c_f32_bf16 v142, v129, v57
    v_dot2c_f32_bf16 v143, v129, v69
    v_dot2c_f32_bf16 v140, v130, v34
    buffer_load_dwordx4 a[144:147], v16, s[56:59], s65 offen offset:2048 sc1
    v_dot2c_f32_bf16 v141, v130, v46
    v_dot2c_f32_bf16 v142, v130, v58
    v_dot2c_f32_bf16 v143, v130, v70
    v_dot2c_f32_bf16 v140, v131, v35
    v_dot2c_f32_bf16 v141, v131, v47
    v_dot2c_f32_bf16 v142, v131, v59
    v_dot2c_f32_bf16 v143, v131, v71
    v_dot2c_f32_bf16 v140, v132, v36
    v_dot2c_f32_bf16 v141, v132, v48
    v_dot2c_f32_bf16 v142, v132, v60
    s_waitcnt lgkmcnt(13)
    v_dot2c_f32_bf16 v143, v132, v72
    v_dot2c_f32_bf16 v140, v133, v37
    buffer_load_dwordx4 a[148:151], v16, s[56:59], s65 offen offset:3072 sc1
    v_dot2c_f32_bf16 v141, v133, v49
    v_dot2c_f32_bf16 v142, v133, v61
    v_dot2c_f32_bf16 v143, v133, v73
    v_dot2c_f32_bf16 v140, v134, v38
    v_dot2c_f32_bf16 v141, v134, v50
    v_dot2c_f32_bf16 v142, v134, v62
    v_dot2c_f32_bf16 v143, v134, v74
    v_dot2c_f32_bf16 v140, v135, v39
    v_dot2c_f32_bf16 v141, v135, v51
    v_dot2c_f32_bf16 v142, v135, v63
    v_dot2c_f32_bf16 v143, v135, v75
    v_dot2c_f32_bf16 v140, v136, v40
    v_dot2c_f32_bf16 v141, v136, v52
    s_add_u32 s65, s65, 147456
    buffer_load_dwordx4 a[152:155], v16, s[56:59], s66 offen sc1
    v_dot2c_f32_bf16 v142, v136, v64
    s_waitcnt lgkmcnt(12)
    v_dot2c_f32_bf16 v143, v136, v76
    ds_read_b128 v[32:35], v2 offset:2064
    ds_read_b128 v[36:39], v2 offset:2080
    ds_read_b128 v[44:47], v2 offset:1776
    s_waitcnt lgkmcnt(14)
    ds_read_b128 v[48:51], v2 offset:1792
    s_waitcnt lgkmcnt(14)
    ds_read_b128 v[56:59], v2 offset:1488
    s_waitcnt lgkmcnt(14)
    ds_read_b128 v[60:63], v2 offset:1504
    s_waitcnt lgkmcnt(14)
    ds_read_b128 v[68:71], v2 offset:1200
    s_waitcnt lgkmcnt(14)
    ds_read_b128 v[72:75], v2 offset:1216
    v_dot2c_f32_bf16 v144, v128, v80
    v_dot2c_f32_bf16 v145, v128, v92
    s_waitcnt lgkmcnt(13)
    v_dot2c_f32_bf16 v146, v128, v104
    s_add_u32 s66, s66, 147456
    buffer_load_dwordx4 a[156:159], v16, s[56:59], s65 offen offset:0 sc1
    s_waitcnt lgkmcnt(10)
    v_dot2c_f32_bf16 v147, v128, v116
    v_dot2c_f32_bf16 v144, v129, v81
    v_dot2c_f32_bf16 v145, v129, v93
    v_dot2c_f32_bf16 v146, v129, v105
    v_dot2c_f32_bf16 v147, v129, v117
    v_dot2c_f32_bf16 v144, v130, v82
    v_dot2c_f32_bf16 v145, v130, v94
    v_dot2c_f32_bf16 v146, v130, v106
    v_dot2c_f32_bf16 v147, v130, v118
    v_dot2c_f32_bf16 v144, v131, v83
    v_dot2c_f32_bf16 v145, v131, v95
    v_dot2c_f32_bf16 v146, v131, v107
    v_dot2c_f32_bf16 v147, v131, v119
    buffer_load_dwordx4 a[160:163], v16, s[56:59], s65 offen offset:1024 sc1
    v_dot2c_f32_bf16 v144, v132, v84
    v_dot2c_f32_bf16 v145, v132, v96
    v_dot2c_f32_bf16 v146, v132, v108
    s_waitcnt lgkmcnt(9)
    v_dot2c_f32_bf16 v147, v132, v120
    v_dot2c_f32_bf16 v144, v133, v85
    v_dot2c_f32_bf16 v145, v133, v97
    v_dot2c_f32_bf16 v146, v133, v109
    v_dot2c_f32_bf16 v147, v133, v121
    v_dot2c_f32_bf16 v144, v134, v86
    v_dot2c_f32_bf16 v145, v134, v98
    v_dot2c_f32_bf16 v146, v134, v110
    v_dot2c_f32_bf16 v147, v134, v122
    buffer_load_dwordx4 a[164:167], v16, s[56:59], s65 offen offset:2048 sc1
    v_dot2c_f32_bf16 v144, v135, v87
    v_dot2c_f32_bf16 v145, v135, v99
    v_dot2c_f32_bf16 v146, v135, v111
    v_dot2c_f32_bf16 v147, v135, v123
    v_dot2c_f32_bf16 v144, v136, v88
    v_dot2c_f32_bf16 v145, v136, v100
    v_dot2c_f32_bf16 v146, v136, v112
    s_waitcnt lgkmcnt(8)
    v_dot2c_f32_bf16 v147, v136, v124
    ds_read_b128 v[80:83], v2 offset:912
    ds_read_b128 v[84:87], v2 offset:928
    ds_read_b128 v[92:95], v2 offset:624
    ds_read_b128 v[96:99], v2 offset:640
    ds_read_b128 v[104:107], v2 offset:336
    buffer_load_dwordx4 a[168:171], v16, s[56:59], s65 offen offset:3072 sc1
    ds_read_b128 v[108:111], v2 offset:352
    ds_read_b128 v[116:119], v2 offset:48
    s_waitcnt lgkmcnt(14)
    ds_read_b128 v[120:123], v2 offset:64
    s_mov_b32 s98, 0xbfb8aa3b
    s_mov_b32 s7, 0x3eae1a93
    v_lshlrev_b32 v8, 16, v138
    v_mul_f32 v8, s98, v8
    v_exp_f32 v8, v8
    v_mov_b32 v9, 0xf149f2ca
    v_add_f32 v8, 1.0, v8
    v_rcp_f32 v8, v8
    v_mul_f32 v140, s7, v140
    v_mov_b32 v128, 0
    s_add_u32 s65, s65, 147456
    buffer_load_dwordx4 a[172:175], v16, s[56:59], s66 offen sc1
    v_mov_b32 v129, 0
    v_cmp_le_u32 vcc, 2, v14
    v_mul_f32 v141, s7, v141
    v_mov_b32 v130, 0
    v_mov_b32 v131, 0
    v_cndmask_b32 v141, v9, v141, vcc
    v_cmp_le_u32 vcc, 4, v14
    v_mul_f32 v142, s7, v142
    v_mov_b32 v132, 0
    v_mov_b32 v133, 0
    v_cndmask_b32 v142, v9, v142, vcc
    v_cmp_le_u32 vcc, 6, v14
    v_mul_f32 v143, s7, v143
    s_add_u32 s66, s66, 147456
    buffer_load_dwordx4 a[176:179], v16, s[56:59], s65 offen offset:0 sc1
    v_mov_b32 v134, 0
    v_mov_b32 v135, 0
    v_cndmask_b32 v143, v9, v143, vcc
    v_cmp_le_u32 vcc, 8, v14
    v_mul_f32 v144, s7, v144
    v_mov_b32 v136, 0
    v_mov_b32 v137, 0
    v_cndmask_b32 v144, v9, v144, vcc
    v_cmp_le_u32 vcc, 10, v14
    v_mul_f32 v145, s7, v145
    v_mov_b32 v138, 0
    v_mov_b32 v139, 0
    buffer_load_dwordx4 a[180:183], v16, s[56:59], s65 offen offset:1024 sc1
    v_cndmask_b32 v145, v9, v145, vcc
    v_cmp_le_u32 vcc, 12, v14
    v_mul_f32 v146, s7, v146
    v_mov_b32 v156, 0
    v_mov_b32 v157, 0
    v_cndmask_b32 v146, v9, v146, vcc
    v_cmp_le_u32 vcc, 14, v14
    v_mul_f32 v147, s7, v147
    v_mov_b32 v158, 0
    v_mov_b32 v159, 0
    v_cndmask_b32 v147, v9, v147, vcc
    v_max3_f32 v9, v140, v141, v142
    v_max3_f32 v10, v143, v144, v145
    buffer_load_dwordx4 a[184:187], v16, s[56:59], s65 offen offset:2048 sc1
    v_max3_f32 v9, v9, v146, v147
    v_max_f32 v9, v9, v10
    v_sub_f32 v140, v140, v9
    v_sub_f32 v141, v141, v9
    v_sub_f32 v142, v142, v9
    v_sub_f32 v143, v143, v9
    v_sub_f32 v144, v144, v9
    v_sub_f32 v145, v145, v9
    v_sub_f32 v146, v146, v9
    v_sub_f32 v147, v147, v9
    v_exp_f32 v140, v140
    v_exp_f32 v141, v141
    v_exp_f32 v142, v142
    buffer_load_dwordx4 a[188:191], v16, s[56:59], s65 offen offset:3072 sc1
    v_exp_f32 v143, v143
    v_exp_f32 v144, v144
    v_exp_f32 v145, v145
    v_exp_f32 v146, v146
    v_exp_f32 v147, v147
    v_add_f32 v10, v140, v141
    v_add_f32 v10, v10, v142
    v_add_f32 v10, v10, v143
    v_add_f32 v10, v10, v144
    v_add_f32 v10, v10, v145
    v_add_f32 v10, v10, v146
    v_add_f32 v10, v10, v147
    v_rcp_f32 v10, v10
    s_add_u32 s65, s65, 147456
    buffer_load_dwordx4 a[192:195], v16, s[56:59], s66 offen sc1
    v_mov_b32 v17, 0
    v_mov_b32 v18, 0
    v_mul_f32 v140, v140, v10
    v_mul_f32 v141, v141, v10
    v_mul_f32 v142, v142, v10
    v_mul_f32 v143, v143, v10
    v_mul_f32 v144, v144, v10
    v_mul_f32 v145, v145, v10
    v_mul_f32 v146, v146, v10
    v_mul_f32 v147, v147, v10
    v_cvt_pk_bf16_f32 v148, 0, v140
    v_cvt_pk_bf16_f32 v149, 0, v141
    s_add_u32 s66, s66, 147456
    buffer_load_dwordx4 a[196:199], v16, s[56:59], s65 offen offset:0 sc1
    v_cvt_pk_bf16_f32 v150, 0, v142
    v_cvt_pk_bf16_f32 v151, 0, v143
    v_cvt_pk_bf16_f32 v152, 0, v144
    v_cvt_pk_bf16_f32 v153, 0, v145
    v_cvt_pk_bf16_f32 v154, 0, v146
    v_cvt_pk_bf16_f32 v155, 0, v147
    v_lshrrev_b32 v140, 16, v148
    v_lshrrev_b32 v141, 16, v149
    v_lshrrev_b32 v142, 16, v150
    v_lshrrev_b32 v143, 16, v151
    v_lshrrev_b32 v144, 16, v152
    v_lshrrev_b32 v145, 16, v153
    v_lshrrev_b32 v146, 16, v154
    buffer_load_dwordx4 a[200:203], v16, s[56:59], s65 offen offset:1024 sc1
    v_lshrrev_b32 v147, 16, v155
    v_dot2c_f32_bf16 v128, v42, v140
    v_dot2c_f32_bf16 v129, v42, v148
    v_dot2c_f32_bf16 v130, v43, v140
    v_dot2c_f32_bf16 v131, v43, v148
    v_dot2c_f32_bf16 v132, v32, v140
    v_dot2c_f32_bf16 v133, v32, v148
    v_dot2c_f32_bf16 v134, v33, v140
    v_dot2c_f32_bf16 v135, v33, v148
    v_dot2c_f32_bf16 v136, v34, v140
    v_dot2c_f32_bf16 v137, v34, v148
    v_dot2c_f32_bf16 v138, v35, v140
    v_dot2c_f32_bf16 v139, v35, v148
    buffer_load_dwordx4 a[204:207], v16, s[56:59], s65 offen offset:2048 sc1
    s_waitcnt lgkmcnt(14)
    v_dot2c_f32_bf16 v156, v36, v140
    v_dot2c_f32_bf16 v157, v36, v148
    v_dot2c_f32_bf16 v158, v37, v140
    v_dot2c_f32_bf16 v159, v37, v148
    v_dot2c_f32_bf16 v17, v38, v140
    v_dot2c_f32_bf16 v18, v38, v148
    v_dot2c_f32_bf16 v128, v54, v141
    v_dot2c_f32_bf16 v129, v54, v149
    v_dot2c_f32_bf16 v130, v55, v141
    v_dot2c_f32_bf16 v131, v55, v149
    s_waitcnt lgkmcnt(13)
    v_dot2c_f32_bf16 v132, v44, v141
    v_dot2c_f32_bf16 v133, v44, v149
    v_dot2c_f32_bf16 v134, v45, v141
    buffer_load_dwordx4 a[208:211], v16, s[56:59], s65 offen offset:3072 sc1
    v_dot2c_f32_bf16 v135, v45, v149
    v_dot2c_f32_bf16 v136, v46, v141
    v_dot2c_f32_bf16 v137, v46, v149
    v_dot2c_f32_bf16 v138, v47, v141
    v_dot2c_f32_bf16 v139, v47, v149
    s_waitcnt lgkmcnt(12)
    v_dot2c_f32_bf16 v156, v48, v141
    v_dot2c_f32_bf16 v157, v48, v149
    v_dot2c_f32_bf16 v158, v49, v141
    v_dot2c_f32_bf16 v159, v49, v149
    v_dot2c_f32_bf16 v17, v50, v141
    v_dot2c_f32_bf16 v18, v50, v149
    v_dot2c_f32_bf16 v128, v66, v142
    s_add_u32 s65, s65, 147456
    buffer_load_dwordx4 a[212:215], v16, s[56:59], s66 offen sc1
    v_dot2c_f32_bf16 v129, v66, v150
    v_dot2c_f32_bf16 v130, v67, v142
    v_dot2c_f32_bf16 v131, v67, v150
    s_waitcnt lgkmcnt(11)
    v_dot2c_f32_bf16 v132, v56, v142
    v_dot2c_f32_bf16 v133, v56, v150
    v_dot2c_f32_bf16 v134, v57, v142
    v_dot2c_f32_bf16 v135, v57, v150
    v_dot2c_f32_bf16 v136, v58, v142
    v_dot2c_f32_bf16 v137, v58, v150
    v_dot2c_f32_bf16 v138, v59, v142
    v_dot2c_f32_bf16 v139, v59, v150
    s_waitcnt lgkmcnt(10)
    v_dot2c_f32_bf16 v156, v60, v142
    v_dot2c_f32_bf16 v157, v60, v150
    s_add_u32 s66, s66, 147456
    buffer_load_dwordx4 a[216:219], v16, s[56:59], s65 offen offset:0 sc1
    v_dot2c_f32_bf16 v158, v61, v142
    v_dot2c_f32_bf16 v159, v61, v150
    v_dot2c_f32_bf16 v17, v62, v142
    v_dot2c_f32_bf16 v18, v62, v150
    v_dot2c_f32_bf16 v128, v78, v143
    v_dot2c_f32_bf16 v129, v78, v151
    v_dot2c_f32_bf16 v130, v79, v143
    v_dot2c_f32_bf16 v131, v79, v151
    s_waitcnt lgkmcnt(9)
    v_dot2c_f32_bf16 v132, v68, v143
    v_dot2c_f32_bf16 v133, v68, v151
    v_dot2c_f32_bf16 v134, v69, v143
    v_dot2c_f32_bf16 v135, v69, v151
    v_dot2c_f32_bf16 v136, v70, v143
    buffer_load_dwordx4 a[220:223], v16, s[56:59], s65 offen offset:1024 sc1
    v_dot2c_f32_bf16 v137, v70, v151
    v_dot2c_f32_bf16 v138, v71, v143
    v_dot2c_f32_bf16 v139, v71, v151
    s_waitcnt lgkmcnt(8)
    v_dot2c_f32_bf16 v156, v72, v143
    v_dot2c_f32_bf16 v157, v72, v151
    v_dot2c_f32_bf16 v158, v73, v143
    v_dot2c_f32_bf16 v159, v73, v151
    v_dot2c_f32_bf16 v17, v74, v143
    v_dot2c_f32_bf16 v18, v74, v151
    v_dot2c_f32_bf16 v128, v90, v144
    v_dot2c_f32_bf16 v129, v90, v152
    v_dot2c_f32_bf16 v130, v91, v144
    v_dot2c_f32_bf16 v131, v91, v152
    buffer_load_dwordx4 a[224:227], v16, s[56:59], s65 offen offset:2048 sc1
    s_waitcnt lgkmcnt(7)
    v_dot2c_f32_bf16 v132, v80, v144
    v_dot2c_f32_bf16 v133, v80, v152
    v_dot2c_f32_bf16 v134, v81, v144
    v_dot2c_f32_bf16 v135, v81, v152
    v_dot2c_f32_bf16 v136, v82, v144
    v_dot2c_f32_bf16 v137, v82, v152
    v_dot2c_f32_bf16 v138, v83, v144
    v_dot2c_f32_bf16 v139, v83, v152
    s_waitcnt lgkmcnt(6)
    v_dot2c_f32_bf16 v156, v84, v144
    v_dot2c_f32_bf16 v157, v84, v152
    v_dot2c_f32_bf16 v158, v85, v144
    v_dot2c_f32_bf16 v159, v85, v152
    buffer_load_dwordx4 a[228:231], v16, s[56:59], s65 offen offset:3072 sc1
    v_dot2c_f32_bf16 v17, v86, v144
    v_dot2c_f32_bf16 v18, v86, v152
    v_dot2c_f32_bf16 v128, v102, v145
    v_dot2c_f32_bf16 v129, v102, v153
    v_dot2c_f32_bf16 v130, v103, v145
    v_dot2c_f32_bf16 v131, v103, v153
    s_waitcnt lgkmcnt(5)
    v_dot2c_f32_bf16 v132, v92, v145
    v_dot2c_f32_bf16 v133, v92, v153
    v_dot2c_f32_bf16 v134, v93, v145
    v_dot2c_f32_bf16 v135, v93, v153
    v_dot2c_f32_bf16 v136, v94, v145
    v_dot2c_f32_bf16 v137, v94, v153
    v_dot2c_f32_bf16 v138, v95, v145
    s_add_u32 s65, s65, 147456
    buffer_load_dwordx4 a[232:235], v16, s[56:59], s66 offen sc1
    v_dot2c_f32_bf16 v139, v95, v153
    s_waitcnt lgkmcnt(4)
    v_dot2c_f32_bf16 v156, v96, v145
    v_dot2c_f32_bf16 v157, v96, v153
    v_dot2c_f32_bf16 v158, v97, v145
    v_dot2c_f32_bf16 v159, v97, v153
    v_dot2c_f32_bf16 v17, v98, v145
    v_dot2c_f32_bf16 v18, v98, v153
    v_dot2c_f32_bf16 v128, v114, v146
    v_dot2c_f32_bf16 v129, v114, v154
    v_dot2c_f32_bf16 v130, v115, v146
    v_dot2c_f32_bf16 v131, v115, v154
    s_waitcnt lgkmcnt(3)
    v_dot2c_f32_bf16 v132, v104, v146
    v_dot2c_f32_bf16 v133, v104, v154
    s_add_u32 s66, s66, 147456
    buffer_load_dwordx4 a[236:239], v16, s[56:59], s65 offen offset:0 sc1
    v_dot2c_f32_bf16 v134, v105, v146
    v_dot2c_f32_bf16 v135, v105, v154
    v_dot2c_f32_bf16 v136, v106, v146
    v_dot2c_f32_bf16 v137, v106, v154
    v_dot2c_f32_bf16 v138, v107, v146
    v_dot2c_f32_bf16 v139, v107, v154
    s_waitcnt lgkmcnt(2)
    v_dot2c_f32_bf16 v156, v108, v146
    v_dot2c_f32_bf16 v157, v108, v154
    v_dot2c_f32_bf16 v158, v109, v146
    v_dot2c_f32_bf16 v159, v109, v154
    v_dot2c_f32_bf16 v17, v110, v146
    v_dot2c_f32_bf16 v18, v110, v154
    v_dot2c_f32_bf16 v128, v126, v147
    buffer_load_dwordx4 a[240:243], v16, s[56:59], s65 offen offset:1024 sc1
    v_dot2c_f32_bf16 v129, v126, v155
    v_dot2c_f32_bf16 v130, v127, v147
    v_dot2c_f32_bf16 v131, v127, v155
    s_waitcnt lgkmcnt(1)
    v_dot2c_f32_bf16 v132, v116, v147
    v_dot2c_f32_bf16 v133, v116, v155
    v_dot2c_f32_bf16 v134, v117, v147
    v_dot2c_f32_bf16 v135, v117, v155
    v_dot2c_f32_bf16 v136, v118, v147
    v_dot2c_f32_bf16 v137, v118, v155
    v_dot2c_f32_bf16 v138, v119, v147
    v_dot2c_f32_bf16 v139, v119, v155
    s_waitcnt lgkmcnt(0)
    v_dot2c_f32_bf16 v156, v120, v147
    buffer_load_dwordx4 a[244:247], v16, s[56:59], s65 offen offset:2048 sc1
    v_dot2c_f32_bf16 v157, v120, v155
    v_dot2c_f32_bf16 v158, v121, v147
    v_dot2c_f32_bf16 v159, v121, v155
    v_dot2c_f32_bf16 v17, v122, v147
    v_dot2c_f32_bf16 v18, v122, v155
    v_mul_f32 v128, v8, v128
    v_mul_f32 v129, v8, v129
    v_mul_f32 v130, v8, v130
    v_mul_f32 v131, v8, v131
    v_mul_f32 v132, v8, v132
    v_mul_f32 v133, v8, v133
    v_mul_f32 v134, v8, v134
    v_mul_f32 v135, v8, v135
    buffer_load_dwordx4 a[248:251], v16, s[56:59], s65 offen offset:3072 sc1
    v_mul_f32 v136, v8, v136
    v_mul_f32 v137, v8, v137
    v_mul_f32 v138, v8, v138
    v_mul_f32 v139, v8, v139
    v_mul_f32 v156, v8, v156
    v_mul_f32 v157, v8, v157
    v_mul_f32 v158, v8, v158
    v_mul_f32 v159, v8, v159
    v_mul_f32 v17, v8, v17
    v_mul_f32 v18, v8, v18
    v_cvt_pk_bf16_f32 v104, v128, v129
    v_cvt_pk_bf16_f32 v105, v130, v131
    v_cvt_pk_bf16_f32 v106, v132, v133
    s_add_u32 s65, s65, 147456
    buffer_load_dwordx4 a[252:255], v16, s[56:59], s66 offen sc1
    s_add_u32 s66, s66, 147456
    v_cvt_pk_bf16_f32 v107, v134, v135
    v_cvt_pk_bf16_f32 v108, v136, v137
    v_cvt_pk_bf16_f32 v109, v138, v139
    v_cvt_pk_bf16_f32 v110, v156, v157
    v_cvt_pk_bf16_f32 v111, v158, v159
    v_cvt_pk_bf16_f32 v112, v17, v18
    s_lshl_b32 s98, s5, 9
    s_add_u32 s98, s98, 131072
    s_lshr_b32 s99, s5, 2
    s_lshl_b32 s99, s99, 8
    s_and_b32 s7, s5, 3
    s_lshl2_add_u32 s99, s7, s99
    s_add_u32 s99, s99, 147456
    buffer_store_dwordx4 v[104:107], v15, s[40:43], s98 offen sc1
    buffer_store_dwordx4 v[108:111], v15, s[40:43], s98 offen offset:256 sc1
    buffer_store_dword v112, v15, s[40:43], s99 offen sc1
    s_waitcnt vmcnt(28)
    buffer_load_dword v3, v19, s[32:35], s71 offen sc1
    buffer_load_dwordx4 a[64:67], v16, s[56:59], s65 offen offset:0 sc1
    buffer_load_dwordx4 a[68:71], v16, s[56:59], s65 offen offset:1024 sc1
    buffer_load_dwordx4 a[72:75], v16, s[56:59], s65 offen offset:2048 sc1
    buffer_load_dwordx4 a[76:79], v16, s[56:59], s65 offen offset:3072 sc1
    s_add_u32 s65, s65, 147456
    buffer_load_dwordx4 a[80:83], v16, s[56:59], s66 offen sc1
    s_add_u32 s66, s66, 147456
    buffer_load_dwordx4 a[84:87], v16, s[56:59], s65 offen offset:0 sc1
    buffer_load_dwordx4 a[88:91], v16, s[56:59], s65 offen offset:1024 sc1
    buffer_load_dwordx4 a[92:95], v16, s[56:59], s65 offen offset:2048 sc1
    buffer_load_dwordx4 a[96:99], v16, s[56:59], s65 offen offset:3072 sc1
    s_add_u32 s65, s65, 147456
    buffer_load_dwordx4 a[100:103], v16, s[56:59], s66 offen sc1
    s_add_u32 s66, s66, 147456
    buffer_load_dwordx4 a[104:107], v16, s[56:59], s65 offen offset:0 sc1
    buffer_load_dwordx4 a[108:111], v16, s[56:59], s65 offen offset:1024 sc1
    buffer_load_dwordx4 a[112:115], v16, s[56:59], s65 offen offset:2048 sc1
    buffer_load_dwordx4 a[116:119], v16, s[56:59], s65 offen offset:3072 sc1
    s_add_u32 s65, s65, 147456
    buffer_load_dwordx4 a[120:123], v16, s[56:59], s66 offen sc1
    s_add_u32 s66, s66, 147456
    s_waitcnt vmcnt(15)
    v_cmp_gt_u32 vcc, 1, v3
    s_nop 1
    s_and_b64 vcc, vcc, exec
    s_cbranch_scc1 SPIN_CTX
BACK_CTX:
    s_barrier
    v_mov_b32 v31, 2
    buffer_store_dword v31, v30, s[32:35], s70 offen sc1
    buffer_load_dwordx4 v[160:163], v4, s[40:43], s64 offen sc1
    buffer_load_dwordx4 v[164:167], v5, s[40:43], s64 offen sc1
    buffer_load_dwordx4 v[168:171], v6, s[40:43], s64 offen sc1
    buffer_load_dwordx4 v[172:175], v7, s[40:43], s64 offen sc1
    s_add_u32 s64, s64, 4096
    buffer_load_dwordx4 v[176:179], v4, s[40:43], s64 offen sc1
    buffer_load_dwordx4 v[180:183], v5, s[40:43], s64 offen sc1
    buffer_load_dwordx4 v[184:187], v6, s[40:43], s64 offen sc1
    buffer_load_dwordx4 v[188:191], v7, s[40:43], s64 offen sc1
    s_add_u32 s64, s64, 4096
    buffer_load_dwordx4 v[192:195], v4, s[40:43], s64 offen sc1
    buffer_load_dwordx4 v[196:199], v5, s[40:43], s64 offen sc1
    buffer_load_dwordx4 v[200:203], v6, s[40:43], s64 offen sc1
    buffer_load_dwordx4 v[204:207], v7, s[40:43], s64 offen sc1
    s_add_u32 s64, s64, 4096
    buffer_load_dwordx4 v[208:211], v4, s[40:43], s64 offen sc1
    buffer_load_dwordx4 v[212:215], v5, s[40:43], s64 offen sc1
    buffer_load_dwordx4 v[216:219], v6, s[40:43], s64 offen sc1
    buffer_load_dwordx4 v[220:223], v7, s[40:43], s64 offen sc1
    s_add_u32 s64, s64, 4096
    buffer_load_dwordx4 v[224:227], v4, s[40:43], s64 offen sc1
    buffer_load_dwordx4 v[228:231], v5, s[40:43], s64 offen sc1
    buffer_load_dwordx4 v[232:235], v6, s[40:43], s64 offen sc1
    buffer_load_dwordx4 v[236:239], v7, s[40:43], s64 offen sc1
    s_add_u32 s64, s64, 4096
    buffer_load_dwordx4 v[240:243], v4, s[40:43], s64 offen sc1
    buffer_load_dwordx4 v[244:247], v5, s[40:43], s64 offen sc1
    buffer_load_dwordx4 v[248:251], v6, s[40:43], s64 offen sc1
    buffer_load_dwordx4 v[252:255], v7, s[40:43], s64 offen sc1
    s_add_u32 s64, s64, 4096
    s_waitcnt vmcnt(20)
    v_mfma_f32_16x16x32_bf16 v[32:35], a[0:3], v[160:163], 0
    v_mfma_f32_16x16x32_bf16 v[36:39], a[0:3], v[164:167], 0
    v_mfma_f32_16x16x32_bf16 v[40:43], a[0:3], v[168:171], 0
    v_mfma_f32_16x16x32_bf16 v[44:47], a[0:3], v[172:175], 0
    v_mfma_f32_16x16x32_bf16 v[48:51], a[4:7], v[160:163], 0
    v_mfma_f32_16x16x32_bf16 v[52:55], a[4:7], v[164:167], 0
    v_mfma_f32_16x16x32_bf16 v[56:59], a[4:7], v[168:171], 0
    v_mfma_f32_16x16x32_bf16 v[60:63], a[4:7], v[172:175], 0
    v_mfma_f32_16x16x32_bf16 v[64:67], a[8:11], v[160:163], 0
    v_mfma_f32_16x16x32_bf16 v[68:71], a[8:11], v[164:167], 0
    v_mfma_f32_16x16x32_bf16 v[72:75], a[8:11], v[168:171], 0
    v_mfma_f32_16x16x32_bf16 v[76:79], a[8:11], v[172:175], 0
    v_mfma_f32_16x16x32_bf16 v[80:83], a[12:15], v[160:163], 0
    v_mfma_f32_16x16x32_bf16 v[84:87], a[12:15], v[164:167], 0
    v_mfma_f32_16x16x32_bf16 v[88:91], a[12:15], v[168:171], 0
    v_mfma_f32_16x16x32_bf16 v[92:95], a[12:15], v[172:175], 0
    v_mfma_f32_16x16x32_bf16 v[96:99], a[16:19], v[160:163], 0
    v_mfma_f32_16x16x32_bf16 v[100:103], a[16:19], v[164:167], 0
    s_waitcnt vmcnt(16)
    v_mfma_f32_16x16x32_bf16 v[32:35], a[20:23], v[176:179], v[32:35]
    buffer_load_dwordx4 v[160:163], v4, s[40:43], s64 offen sc1
    v_mfma_f32_16x16x32_bf16 v[36:39], a[20:23], v[180:183], v[36:39]
    buffer_load_dwordx4 v[164:167], v5, s[40:43], s64 offen sc1
    v_mfma_f32_16x16x32_bf16 v[40:43], a[20:23], v[184:187], v[40:43]
    v_mfma_f32_16x16x32_bf16 v[44:47], a[20:23], v[188:191], v[44:47]
    buffer_load_dwordx4 v[168:171], v6, s[40:43], s64 offen sc1
    v_mfma_f32_16x16x32_bf16 v[48:51], a[24:27], v[176:179], v[48:51]
    v_mfma_f32_16x16x32_bf16 v[52:55], a[24:27], v[180:183], v[52:55]
    buffer_load_dwordx4 v[172:175], v7, s[40:43], s64 offen sc1
    v_mfma_f32_16x16x32_bf16 v[56:59], a[24:27], v[184:187], v[56:59]
    v_mfma_f32_16x16x32_bf16 v[60:63], a[24:27], v[188:191], v[60:63]
    s_add_u32 s64, s64, 4096
    buffer_load_dwordx4 a[0:3], v16, s[56:59], s65 offen offset:0 sc1
    v_mfma_f32_16x16x32_bf16 v[64:67], a[28:31], v[176:179], v[64:67]
    v_mfma_f32_16x16x32_bf16 v[68:71], a[28:31], v[180:183], v[68:71]
    buffer_load_dwordx4 a[4:7], v16, s[56:59], s65 offen offset:1024 sc1
    v_mfma_f32_16x16x32_bf16 v[72:75], a[28:31], v[184:187], v[72:75]
    v_mfma_f32_16x16x32_bf16 v[76:79], a[28:31], v[188:191], v[76:79]
    buffer_load_dwordx4 a[8:11], v16, s[56:59], s65 offen offset:2048 sc1
    v_mfma_f32_16x16x32_bf16 v[80:83], a[32:35], v[176:179], v[80:83]
    v_mfma_f32_16x16x32_bf16 v[84:87], a[32:35], v[180:183], v[84:87]
    buffer_load_dwordx4 a[12:15], v16, s[56:59], s65 offen offset:3072 sc1
    v_mfma_f32_16x16x32_bf16 v[88:91], a[32:35], v[184:187], v[88:91]
    v_mfma_f32_16x16x32_bf16 v[92:95], a[32:35], v[188:191], v[92:95]
    s_add_u32 s65, s65, 147456
    buffer_load_dwordx4 a[16:19], v16, s[56:59], s66 offen sc1
    s_add_u32 s66, s66, 147456
    v_mfma_f32_16x16x32_bf16 v[96:99], a[36:39], v[176:179], v[96:99]
    v_mfma_f32_16x16x32_bf16 v[100:103], a[36:39], v[180:183], v[100:103]
    s_waitcnt vmcnt(21)
    v_mfma_f32_16x16x32_bf16 v[32:35], a[40:43], v[192:195], v[32:35]
    buffer_load_dwordx4 v[176:179], v4, s[40:43], s64 offen sc1
    v_mfma_f32_16x16x32_bf16 v[36:39], a[40:43], v[196:199], v[36:39]
    buffer_load_dwordx4 v[180:183], v5, s[40:43], s64 offen sc1
    v_mfma_f32_16x16x32_bf16 v[40:43], a[40:43], v[200:203], v[40:43]
    v_mfma_f32_16x16x32_bf16 v[44:47], a[40:43], v[204:207], v[44:47]
    buffer_load_dwordx4 v[184:187], v6, s[40:43], s64 offen sc1
    v_mfma_f32_16x16x32_bf16 v[48:51], a[44:47], v[192:195], v[48:51]
    v_mfma_f32_16x16x32_bf16 v[52:55], a[44:47], v[196:199], v[52:55]
    buffer_load_dwordx4 v[188:191], v7, s[40:43], s64 offen sc1
    v_mfma_f32_16x16x32_bf16 v[56:59], a[44:47], v[200:203], v[56:59]
    v_mfma_f32_16x16x32_bf16 v[60:63], a[44:47], v[204:207], v[60:63]
    s_add_u32 s64, s64, 4096
    buffer_load_dwordx4 a[20:23], v16, s[56:59], s65 offen offset:0 sc1
    v_mfma_f32_16x16x32_bf16 v[64:67], a[48:51], v[192:195], v[64:67]
    v_mfma_f32_16x16x32_bf16 v[68:71], a[48:51], v[196:199], v[68:71]
    buffer_load_dwordx4 a[24:27], v16, s[56:59], s65 offen offset:1024 sc1
    v_mfma_f32_16x16x32_bf16 v[72:75], a[48:51], v[200:203], v[72:75]
    v_mfma_f32_16x16x32_bf16 v[76:79], a[48:51], v[204:207], v[76:79]
    buffer_load_dwordx4 a[28:31], v16, s[56:59], s65 offen offset:2048 sc1
    v_mfma_f32_16x16x32_bf16 v[80:83], a[52:55], v[192:195], v[80:83]
    v_mfma_f32_16x16x32_bf16 v[84:87], a[52:55], v[196:199], v[84:87]
    buffer_load_dwordx4 a[32:35], v16, s[56:59], s65 offen offset:3072 sc1
    v_mfma_f32_16x16x32_bf16 v[88:91], a[52:55], v[200:203], v[88:91]
    v_mfma_f32_16x16x32_bf16 v[92:95], a[52:55], v[204:207], v[92:95]
    s_add_u32 s65, s65, 147456
    buffer_load_dwordx4 a[36:39], v16, s[56:59], s66 offen sc1
    s_add_u32 s66, s66, 147456
    v_mfma_f32_16x16x32_bf16 v[96:99], a[56:59], v[192:195], v[96:99]
    v_mfma_f32_16x16x32_bf16 v[100:103], a[56:59], v[196:199], v[100:103]
    s_waitcnt vmcnt(26)
    v_mfma_f32_16x16x32_bf16 v[32:35], a[136:139], v[208:211], v[32:35]
    buffer_load_dwordx4 v[192:195], v4, s[40:43], s64 offen sc1
    v_mfma_f32_16x16x32_bf16 v[36:39], a[136:139], v[212:215], v[36:39]
    buffer_load_dwordx4 v[196:199], v5, s[40:43], s64 offen sc1
    v_mfma_f32_16x16x32_bf16 v[40:43], a[136:139], v[216:219], v[40:43]
    v_mfma_f32_16x16x32_bf16 v[44:47], a[136:139], v[220:223], v[44:47]
    buffer_load_dwordx4 v[200:203], v6, s[40:43], s64 offen sc1
    v_mfma_f32_16x16x32_bf16 v[48:51], a[140:143], v[208:211], v[48:51]
    v_mfma_f32_16x16x32_bf16 v[52:55], a[140:143], v[212:215], v[52:55]
    buffer_load_dwordx4 v[204:207], v7, s[40:43], s64 offen sc1
    v_mfma_f32_16x16x32_bf16 v[56:59], a[140:143], v[216:219], v[56:59]
    v_mfma_f32_16x16x32_bf16 v[60:63], a[140:143], v[220:223], v[60:63]
    s_add_u32 s64, s64, 4096
    buffer_load_dwordx4 a[40:43], v16, s[56:59], s65 offen offset:0 sc1
    v_mfma_f32_16x16x32_bf16 v[64:67], a[144:147], v[208:211], v[64:67]
    v_mfma_f32_16x16x32_bf16 v[68:71], a[144:147], v[212:215], v[68:71]
    buffer_load_dwordx4 a[44:47], v16, s[56:59], s65 offen offset:1024 sc1
    v_mfma_f32_16x16x32_bf16 v[72:75], a[144:147], v[216:219], v[72:75]
    v_mfma_f32_16x16x32_bf16 v[76:79], a[144:147], v[220:223], v[76:79]
    buffer_load_dwordx4 a[48:51], v16, s[56:59], s65 offen offset:2048 sc1
    v_mfma_f32_16x16x32_bf16 v[80:83], a[148:151], v[208:211], v[80:83]
    v_mfma_f32_16x16x32_bf16 v[84:87], a[148:151], v[212:215], v[84:87]
    buffer_load_dwordx4 a[52:55], v16, s[56:59], s65 offen offset:3072 sc1
    v_mfma_f32_16x16x32_bf16 v[88:91], a[148:151], v[216:219], v[88:91]
    v_mfma_f32_16x16x32_bf16 v[92:95], a[148:151], v[220:223], v[92:95]
    s_add_u32 s65, s65, 147456
    buffer_load_dwordx4 a[56:59], v16, s[56:59], s66 offen sc1
    s_add_u32 s66, s66, 147456
    v_mfma_f32_16x16x32_bf16 v[96:99], a[152:155], v[208:211], v[96:99]
    v_mfma_f32_16x16x32_bf16 v[100:103], a[152:155], v[212:215], v[100:103]
    s_waitcnt vmcnt(31)
    v_mfma_f32_16x16x32_bf16 v[32:35], a[156:159], v[224:227], v[32:35]
    buffer_load_dwordx4 v[208:211], v4, s[40:43], s64 offen sc1
    v_mfma_f32_16x16x32_bf16 v[36:39], a[156:159], v[228:231], v[36:39]
    buffer_load_dwordx4 v[212:215], v5, s[40:43], s64 offen sc1
    v_mfma_f32_16x16x32_bf16 v[40:43], a[156:159], v[232:235], v[40:43]
    v_mfma_f32_16x16x32_bf16 v[44:47], a[156:159], v[236:239], v[44:47]
    buffer_load_dwordx4 v[216:219], v6, s[40:43], s64 offen sc1
    v_mfma_f32_16x16x32_bf16 v[48:51], a[160:163], v[224:227], v[48:51]
    v_mfma_f32_16x16x32_bf16 v[52:55], a[160:163], v[228:231], v[52:55]
    buffer_load_dwordx4 v[220:223], v7, s[40:43], s64 offen sc1
    v_mfma_f32_16x16x32_bf16 v[56:59], a[160:163], v[232:235], v[56:59]
    v_mfma_f32_16x16x32_bf16 v[60:63], a[160:163], v[236:239], v[60:63]
    s_add_u32 s64, s64, 4096
    buffer_load_dwordx4 a[136:139], v16, s[56:59], s65 offen offset:0 sc1
    v_mfma_f32_16x16x32_bf16 v[64:67], a[164:167], v[224:227], v[64:67]
    v_mfma_f32_16x16x32_bf16 v[68:71], a[164:167], v[228:231], v[68:71]
    buffer_load_dwordx4 a[140:143], v16, s[56:59], s65 offen offset:1024 sc1
    v_mfma_f32_16x16x32_bf16 v[72:75], a[164:167], v[232:235], v[72:75]
    v_mfma_f32_16x16x32_bf16 v[76:79], a[164:167], v[236:239], v[76:79]
    buffer_load_dwordx4 a[144:147], v16, s[56:59], s65 offen offset:2048 sc1
    v_mfma_f32_16x16x32_bf16 v[80:83], a[168:171], v[224:227], v[80:83]
    v_mfma_f32_16x16x32_bf16 v[84:87], a[168:171], v[228:231], v[84:87]
    buffer_load_dwordx4 a[148:151], v16, s[56:59], s65 offen offset:3072 sc1
    v_mfma_f32_16x16x32_bf16 v[88:91], a[168:171], v[232:235], v[88:91]
    v_mfma_f32_16x16x32_bf16 v[92:95], a[168:171], v[236:239], v[92:95]
    s_add_u32 s65, s65, 147456
    buffer_load_dwordx4 a[152:155], v16, s[56:59], s66 offen sc1
    s_add_u32 s66, s66, 147456
    v_mfma_f32_16x16x32_bf16 v[96:99], a[172:175], v[224:227], v[96:99]
    v_mfma_f32_16x16x32_bf16 v[100:103], a[172:175], v[228:231], v[100:103]
    s_waitcnt vmcnt(36)
    v_mfma_f32_16x16x32_bf16 v[32:35], a[176:179], v[240:243], v[32:35]
    buffer_load_dwordx4 v[224:227], v4, s[40:43], s64 offen sc1
    v_mfma_f32_16x16x32_bf16 v[36:39], a[176:179], v[244:247], v[36:39]
    buffer_load_dwordx4 v[228:231], v5, s[40:43], s64 offen sc1
    v_mfma_f32_16x16x32_bf16 v[40:43], a[176:179], v[248:251], v[40:43]
    v_mfma_f32_16x16x32_bf16 v[44:47], a[176:179], v[252:255], v[44:47]
    buffer_load_dwordx4 v[232:235], v6, s[40:43], s64 offen sc1
    v_mfma_f32_16x16x32_bf16 v[48:51], a[180:183], v[240:243], v[48:51]
    v_mfma_f32_16x16x32_bf16 v[52:55], a[180:183], v[244:247], v[52:55]
    buffer_load_dwordx4 v[236:239], v7, s[40:43], s64 offen sc1
    v_mfma_f32_16x16x32_bf16 v[56:59], a[180:183], v[248:251], v[56:59]
    v_mfma_f32_16x16x32_bf16 v[60:63], a[180:183], v[252:255], v[60:63]
    s_add_u32 s64, s64, 4096
    buffer_load_dwordx4 a[156:159], v16, s[56:59], s65 offen offset:0 sc1
    v_mfma_f32_16x16x32_bf16 v[64:67], a[184:187], v[240:243], v[64:67]
    v_mfma_f32_16x16x32_bf16 v[68:71], a[184:187], v[244:247], v[68:71]
    buffer_load_dwordx4 a[160:163], v16, s[56:59], s65 offen offset:1024 sc1
    v_mfma_f32_16x16x32_bf16 v[72:75], a[184:187], v[248:251], v[72:75]
    v_mfma_f32_16x16x32_bf16 v[76:79], a[184:187], v[252:255], v[76:79]
    buffer_load_dwordx4 a[164:167], v16, s[56:59], s65 offen offset:2048 sc1
    v_mfma_f32_16x16x32_bf16 v[80:83], a[188:191], v[240:243], v[80:83]
    v_mfma_f32_16x16x32_bf16 v[84:87], a[188:191], v[244:247], v[84:87]
    buffer_load_dwordx4 a[168:171], v16, s[56:59], s65 offen offset:3072 sc1
    v_mfma_f32_16x16x32_bf16 v[88:91], a[188:191], v[248:251], v[88:91]
    v_mfma_f32_16x16x32_bf16 v[92:95], a[188:191], v[252:255], v[92:95]
    s_add_u32 s65, s65, 147456
    buffer_load_dwordx4 a[172:175], v16, s[56:59], s66 offen sc1
    s_add_u32 s66, s66, 147456
    v_mfma_f32_16x16x32_bf16 v[96:99], a[192:195], v[240:243], v[96:99]
    v_mfma_f32_16x16x32_bf16 v[100:103], a[192:195], v[244:247], v[100:103]
    s_waitcnt vmcnt(41)
    v_mfma_f32_16x16x32_bf16 v[32:35], a[196:199], v[160:163], v[32:35]
    buffer_load_dwordx4 v[240:243], v4, s[40:43], s64 offen sc1
    v_mfma_f32_16x16x32_bf16 v[36:39], a[196:199], v[164:167], v[36:39]
    buffer_load_dwordx4 v[244:247], v5, s[40:43], s64 offen sc1
    v_mfma_f32_16x16x32_bf16 v[40:43], a[196:199], v[168:171], v[40:43]
    v_mfma_f32_16x16x32_bf16 v[44:47], a[196:199], v[172:175], v[44:47]
    buffer_load_dwordx4 v[248:251], v6, s[40:43], s64 offen sc1
    v_mfma_f32_16x16x32_bf16 v[48:51], a[200:203], v[160:163], v[48:51]
    v_mfma_f32_16x16x32_bf16 v[52:55], a[200:203], v[164:167], v[52:55]
    buffer_load_dwordx4 v[252:255], v7, s[40:43], s64 offen sc1
    v_mfma_f32_16x16x32_bf16 v[56:59], a[200:203], v[168:171], v[56:59]
    v_mfma_f32_16x16x32_bf16 v[60:63], a[200:203], v[172:175], v[60:63]
    s_add_u32 s64, s64, 4096
    buffer_load_dwordx4 a[176:179], v16, s[56:59], s65 offen offset:0 sc1
    v_mfma_f32_16x16x32_bf16 v[64:67], a[204:207], v[160:163], v[64:67]
    v_mfma_f32_16x16x32_bf16 v[68:71], a[204:207], v[164:167], v[68:71]
    buffer_load_dwordx4 a[180:183], v16, s[56:59], s65 offen offset:1024 sc1
    v_mfma_f32_16x16x32_bf16 v[72:75], a[204:207], v[168:171], v[72:75]
    v_mfma_f32_16x16x32_bf16 v[76:79], a[204:207], v[172:175], v[76:79]
    buffer_load_dwordx4 a[184:187], v16, s[56:59], s65 offen offset:2048 sc1
    v_mfma_f32_16x16x32_bf16 v[80:83], a[208:211], v[160:163], v[80:83]
    v_mfma_f32_16x16x32_bf16 v[84:87], a[208:211], v[164:167], v[84:87]
    buffer_load_dwordx4 a[188:191], v16, s[56:59], s65 offen offset:3072 sc1
    v_mfma_f32_16x16x32_bf16 v[88:91], a[208:211], v[168:171], v[88:91]
    v_mfma_f32_16x16x32_bf16 v[92:95], a[208:211], v[172:175], v[92:95]
    s_add_u32 s65, s65, 147456
    buffer_load_dwordx4 a[192:195], v16, s[56:59], s66 offen sc1
    s_add_u32 s66, s66, 147456
    v_mfma_f32_16x16x32_bf16 v[96:99], a[212:215], v[160:163], v[96:99]
    v_mfma_f32_16x16x32_bf16 v[100:103], a[212:215], v[164:167], v[100:103]
    s_waitcnt vmcnt(41)
    v_mfma_f32_16x16x32_bf16 v[32:35], a[216:219], v[176:179], v[32:35]
    buffer_load_dwordx4 v[160:163], v4, s[40:43], s64 offen sc1
    v_mfma_f32_16x16x32_bf16 v[36:39], a[216:219], v[180:183], v[36:39]
    buffer_load_dwordx4 v[164:167], v5, s[40:43], s64 offen sc1
    v_mfma_f32_16x16x32_bf16 v[40:43], a[216:219], v[184:187], v[40:43]
    v_mfma_f32_16x16x32_bf16 v[44:47], a[216:219], v[188:191], v[44:47]
    buffer_load_dwordx4 v[168:171], v6, s[40:43], s64 offen sc1
    v_mfma_f32_16x16x32_bf16 v[48:51], a[220:223], v[176:179], v[48:51]
    v_mfma_f32_16x16x32_bf16 v[52:55], a[220:223], v[180:183], v[52:55]
    buffer_load_dwordx4 v[172:175], v7, s[40:43], s64 offen sc1
    v_mfma_f32_16x16x32_bf16 v[56:59], a[220:223], v[184:187], v[56:59]
    v_mfma_f32_16x16x32_bf16 v[60:63], a[220:223], v[188:191], v[60:63]
    s_add_u32 s64, s64, 4096
    buffer_load_dwordx4 a[196:199], v16, s[56:59], s65 offen offset:0 sc1
    v_mfma_f32_16x16x32_bf16 v[64:67], a[224:227], v[176:179], v[64:67]
    v_mfma_f32_16x16x32_bf16 v[68:71], a[224:227], v[180:183], v[68:71]
    buffer_load_dwordx4 a[200:203], v16, s[56:59], s65 offen offset:1024 sc1
    v_mfma_f32_16x16x32_bf16 v[72:75], a[224:227], v[184:187], v[72:75]
    v_mfma_f32_16x16x32_bf16 v[76:79], a[224:227], v[188:191], v[76:79]
    buffer_load_dwordx4 a[204:207], v16, s[56:59], s65 offen offset:2048 sc1
    v_mfma_f32_16x16x32_bf16 v[80:83], a[228:231], v[176:179], v[80:83]
    v_mfma_f32_16x16x32_bf16 v[84:87], a[228:231], v[180:183], v[84:87]
    buffer_load_dwordx4 a[208:211], v16, s[56:59], s65 offen offset:3072 sc1
    v_mfma_f32_16x16x32_bf16 v[88:91], a[228:231], v[184:187], v[88:91]
    v_mfma_f32_16x16x32_bf16 v[92:95], a[228:231], v[188:191], v[92:95]
    s_add_u32 s65, s65, 147456
    buffer_load_dwordx4 a[212:215], v16, s[56:59], s66 offen sc1
    s_add_u32 s66, s66, 147456
    v_mfma_f32_16x16x32_bf16 v[96:99], a[232:235], v[176:179], v[96:99]
    v_mfma_f32_16x16x32_bf16 v[100:103], a[232:235], v[180:183], v[100:103]
    s_waitcnt vmcnt(41)
    v_mfma_f32_16x16x32_bf16 v[32:35], a[236:239], v[192:195], v[32:35]
    buffer_load_dwordx4 v[176:179], v4, s[40:43], s64 offen sc1
    v_mfma_f32_16x16x32_bf16 v[36:39], a[236:239], v[196:199], v[36:39]
    buffer_load_dwordx4 v[180:183], v5, s[40:43], s64 offen sc1
    v_mfma_f32_16x16x32_bf16 v[40:43], a[236:239], v[200:203], v[40:43]
    v_mfma_f32_16x16x32_bf16 v[44:47], a[236:239], v[204:207], v[44:47]
    buffer_load_dwordx4 v[184:187], v6, s[40:43], s64 offen sc1
    v_mfma_f32_16x16x32_bf16 v[48:51], a[240:243], v[192:195], v[48:51]
    v_mfma_f32_16x16x32_bf16 v[52:55], a[240:243], v[196:199], v[52:55]
    buffer_load_dwordx4 v[188:191], v7, s[40:43], s64 offen sc1
    v_mfma_f32_16x16x32_bf16 v[56:59], a[240:243], v[200:203], v[56:59]
    v_mfma_f32_16x16x32_bf16 v[60:63], a[240:243], v[204:207], v[60:63]
    s_add_u32 s64, s64, 4096
    buffer_load_dwordx4 a[216:219], v16, s[56:59], s65 offen offset:0 sc1
    v_mfma_f32_16x16x32_bf16 v[64:67], a[244:247], v[192:195], v[64:67]
    v_mfma_f32_16x16x32_bf16 v[68:71], a[244:247], v[196:199], v[68:71]
    buffer_load_dwordx4 a[220:223], v16, s[56:59], s65 offen offset:1024 sc1
    v_mfma_f32_16x16x32_bf16 v[72:75], a[244:247], v[200:203], v[72:75]
    v_mfma_f32_16x16x32_bf16 v[76:79], a[244:247], v[204:207], v[76:79]
    buffer_load_dwordx4 a[224:227], v16, s[56:59], s65 offen offset:2048 sc1
    v_mfma_f32_16x16x32_bf16 v[80:83], a[248:251], v[192:195], v[80:83]
    v_mfma_f32_16x16x32_bf16 v[84:87], a[248:251], v[196:199], v[84:87]
    buffer_load_dwordx4 a[228:231], v16, s[56:59], s65 offen offset:3072 sc1
    v_mfma_f32_16x16x32_bf16 v[88:91], a[248:251], v[200:203], v[88:91]
    v_mfma_f32_16x16x32_bf16 v[92:95], a[248:251], v[204:207], v[92:95]
    s_add_u32 s65, s65, 147456
    buffer_load_dwordx4 a[232:235], v16, s[56:59], s66 offen sc1
    s_add_u32 s66, s66, 147456
    v_mfma_f32_16x16x32_bf16 v[96:99], a[252:255], v[192:195], v[96:99]
    v_mfma_f32_16x16x32_bf16 v[100:103], a[252:255], v[196:199], v[100:103]
    s_waitcnt vmcnt(41)
    v_mfma_f32_16x16x32_bf16 v[32:35], a[64:67], v[208:211], v[32:35]
    buffer_load_dwordx4 v[192:195], v4, s[40:43], s64 offen sc1
    v_mfma_f32_16x16x32_bf16 v[36:39], a[64:67], v[212:215], v[36:39]
    buffer_load_dwordx4 v[196:199], v5, s[40:43], s64 offen sc1
    v_mfma_f32_16x16x32_bf16 v[40:43], a[64:67], v[216:219], v[40:43]
    v_mfma_f32_16x16x32_bf16 v[44:47], a[64:67], v[220:223], v[44:47]
    buffer_load_dwordx4 v[200:203], v6, s[40:43], s64 offen sc1
    v_mfma_f32_16x16x32_bf16 v[48:51], a[68:71], v[208:211], v[48:51]
    v_mfma_f32_16x16x32_bf16 v[52:55], a[68:71], v[212:215], v[52:55]
    buffer_load_dwordx4 v[204:207], v7, s[40:43], s64 offen sc1
    v_mfma_f32_16x16x32_bf16 v[56:59], a[68:71], v[216:219], v[56:59]
    v_mfma_f32_16x16x32_bf16 v[60:63], a[68:71], v[220:223], v[60:63]
    s_add_u32 s64, s64, 4096
    buffer_load_dwordx4 a[236:239], v16, s[56:59], s65 offen offset:0 sc1
    v_mfma_f32_16x16x32_bf16 v[64:67], a[72:75], v[208:211], v[64:67]
    v_mfma_f32_16x16x32_bf16 v[68:71], a[72:75], v[212:215], v[68:71]
    buffer_load_dwordx4 a[240:243], v16, s[56:59], s65 offen offset:1024 sc1
    v_mfma_f32_16x16x32_bf16 v[72:75], a[72:75], v[216:219], v[72:75]
    v_mfma_f32_16x16x32_bf16 v[76:79], a[72:75], v[220:223], v[76:79]
    buffer_load_dwordx4 a[244:247], v16, s[56:59], s65 offen offset:2048 sc1
    v_mfma_f32_16x16x32_bf16 v[80:83], a[76:79], v[208:211], v[80:83]
    v_mfma_f32_16x16x32_bf16 v[84:87], a[76:79], v[212:215], v[84:87]
    buffer_load_dwordx4 a[248:251], v16, s[56:59], s65 offen offset:3072 sc1
    v_mfma_f32_16x16x32_bf16 v[88:91], a[76:79], v[216:219], v[88:91]
    v_mfma_f32_16x16x32_bf16 v[92:95], a[76:79], v[220:223], v[92:95]
    s_add_u32 s65, s65, 147456
    buffer_load_dwordx4 a[252:255], v16, s[56:59], s66 offen sc1
    s_add_u32 s66, s66, 147456
    v_mfma_f32_16x16x32_bf16 v[96:99], a[80:83], v[208:211], v[96:99]
    v_mfma_f32_16x16x32_bf16 v[100:103], a[80:83], v[212:215], v[100:103]
    s_waitcnt vmcnt(41)
    v_mfma_f32_16x16x32_bf16 v[32:35], a[84:87], v[224:227], v[32:35]
    buffer_load_dwordx4 v[208:211], v4, s[40:43], s64 offen sc1
    v_mfma_f32_16x16x32_bf16 v[36:39], a[84:87], v[228:231], v[36:39]
    buffer_load_dwordx4 v[212:215], v5, s[40:43], s64 offen sc1
    v_mfma_f32_16x16x32_bf16 v[40:43], a[84:87], v[232:235], v[40:43]
    v_mfma_f32_16x16x32_bf16 v[44:47], a[84:87], v[236:239], v[44:47]
    buffer_load_dwordx4 v[216:219], v6, s[40:43], s64 offen sc1
    v_mfma_f32_16x16x32_bf16 v[48:51], a[88:91], v[224:227], v[48:51]
    v_mfma_f32_16x16x32_bf16 v[52:55], a[88:91], v[228:231], v[52:55]
    buffer_load_dwordx4 v[220:223], v7, s[40:43], s64 offen sc1
    v_mfma_f32_16x16x32_bf16 v[56:59], a[88:91], v[232:235], v[56:59]
    v_mfma_f32_16x16x32_bf16 v[60:63], a[88:91], v[236:239], v[60:63]
    s_add_u32 s64, s64, 4096
    buffer_load_dwordx4 a[64:67], v16, s[56:59], s65 offen offset:0 sc1
    v_mfma_f32_16x16x32_bf16 v[64:67], a[92:95], v[224:227], v[64:67]
    v_mfma_f32_16x16x32_bf16 v[68:71], a[92:95], v[228:231], v[68:71]
    buffer_load_dwordx4 a[68:71], v16, s[56:59], s65 offen offset:1024 sc1
    v_mfma_f32_16x16x32_bf16 v[72:75], a[92:95], v[232:235], v[72:75]
    v_mfma_f32_16x16x32_bf16 v[76:79], a[92:95], v[236:239], v[76:79]
    buffer_load_dwordx4 a[72:75], v16, s[56:59], s65 offen offset:2048 sc1
    v_mfma_f32_16x16x32_bf16 v[80:83], a[96:99], v[224:227], v[80:83]
    v_mfma_f32_16x16x32_bf16 v[84:87], a[96:99], v[228:231], v[84:87]
    buffer_load_dwordx4 a[76:79], v16, s[56:59], s65 offen offset:3072 sc1
    v_mfma_f32_16x16x32_bf16 v[88:91], a[96:99], v[232:235], v[88:91]
    v_mfma_f32_16x16x32_bf16 v[92:95], a[96:99], v[236:239], v[92:95]
    s_add_u32 s65, s65, 147456
    buffer_load_dwordx4 a[80:83], v16, s[56:59], s66 offen sc1
    s_add_u32 s66, s66, 147456
    v_mfma_f32_16x16x32_bf16 v[96:99], a[100:103], v[224:227], v[96:99]
    v_mfma_f32_16x16x32_bf16 v[100:103], a[100:103], v[228:231], v[100:103]
    s_waitcnt vmcnt(41)
    v_mfma_f32_16x16x32_bf16 v[32:35], a[104:107], v[240:243], v[32:35]
    buffer_load_dwordx4 v[224:227], v4, s[40:43], s64 offen sc1
    v_mfma_f32_16x16x32_bf16 v[36:39], a[104:107], v[244:247], v[36:39]
    buffer_load_dwordx4 v[228:231], v5, s[40:43], s64 offen sc1
    v_mfma_f32_16x16x32_bf16 v[40:43], a[104:107], v[248:251], v[40:43]
    v_mfma_f32_16x16x32_bf16 v[44:47], a[104:107], v[252:255], v[44:47]
    buffer_load_dwordx4 v[232:235], v6, s[40:43], s64 offen sc1
    v_mfma_f32_16x16x32_bf16 v[48:51], a[108:111], v[240:243], v[48:51]
    v_mfma_f32_16x16x32_bf16 v[52:55], a[108:111], v[244:247], v[52:55]
    buffer_load_dwordx4 v[236:239], v7, s[40:43], s64 offen sc1
    v_mfma_f32_16x16x32_bf16 v[56:59], a[108:111], v[248:251], v[56:59]
    v_mfma_f32_16x16x32_bf16 v[60:63], a[108:111], v[252:255], v[60:63]
    s_add_u32 s64, s64, 4096
    buffer_load_dwordx4 a[84:87], v16, s[56:59], s65 offen offset:0 sc1
    v_mfma_f32_16x16x32_bf16 v[64:67], a[112:115], v[240:243], v[64:67]
    v_mfma_f32_16x16x32_bf16 v[68:71], a[112:115], v[244:247], v[68:71]
    buffer_load_dwordx4 a[88:91], v16, s[56:59], s65 offen offset:1024 sc1
    v_mfma_f32_16x16x32_bf16 v[72:75], a[112:115], v[248:251], v[72:75]
    v_mfma_f32_16x16x32_bf16 v[76:79], a[112:115], v[252:255], v[76:79]
    buffer_load_dwordx4 a[92:95], v16, s[56:59], s65 offen offset:2048 sc1
    v_mfma_f32_16x16x32_bf16 v[80:83], a[116:119], v[240:243], v[80:83]
    v_mfma_f32_16x16x32_bf16 v[84:87], a[116:119], v[244:247], v[84:87]
    buffer_load_dwordx4 a[96:99], v16, s[56:59], s65 offen offset:3072 sc1
    v_mfma_f32_16x16x32_bf16 v[88:91], a[116:119], v[248:251], v[88:91]
    v_mfma_f32_16x16x32_bf16 v[92:95], a[116:119], v[252:255], v[92:95]
    s_add_u32 s65, s65, 147456
    buffer_load_dwordx4 a[100:103], v16, s[56:59], s66 offen sc1
    s_add_u32 s66, s66, 147456
    v_mfma_f32_16x16x32_bf16 v[96:99], a[120:123], v[240:243], v[96:99]
    v_mfma_f32_16x16x32_bf16 v[100:103], a[120:123], v[244:247], v[100:103]
    s_waitcnt vmcnt(41)
    v_mfma_f32_16x16x32_bf16 v[32:35], a[0:3], v[160:163], v[32:35]
    buffer_load_dwordx4 v[240:243], v4, s[40:43], s64 offen sc1
    v_mfma_f32_16x16x32_bf16 v[36:39], a[0:3], v[164:167], v[36:39]
    buffer_load_dwordx4 v[244:247], v5, s[40:43], s64 offen sc1
    v_mfma_f32_16x16x32_bf16 v[40:43], a[0:3], v[168:171], v[40:43]
    v_mfma_f32_16x16x32_bf16 v[44:47], a[0:3], v[172:175], v[44:47]
    buffer_load_dwordx4 v[248:251], v6, s[40:43], s64 offen sc1
    v_mfma_f32_16x16x32_bf16 v[48:51], a[4:7], v[160:163], v[48:51]
    v_mfma_f32_16x16x32_bf16 v[52:55], a[4:7], v[164:167], v[52:55]
    buffer_load_dwordx4 v[252:255], v7, s[40:43], s64 offen sc1
    v_mfma_f32_16x16x32_bf16 v[56:59], a[4:7], v[168:171], v[56:59]
    v_mfma_f32_16x16x32_bf16 v[60:63], a[4:7], v[172:175], v[60:63]
    s_add_u32 s64, s64, 4096
    buffer_load_dwordx4 a[104:107], v16, s[56:59], s65 offen offset:0 sc1
    v_mfma_f32_16x16x32_bf16 v[64:67], a[8:11], v[160:163], v[64:67]
    v_mfma_f32_16x16x32_bf16 v[68:71], a[8:11], v[164:167], v[68:71]
    buffer_load_dwordx4 a[108:111], v16, s[56:59], s65 offen offset:1024 sc1
    v_mfma_f32_16x16x32_bf16 v[72:75], a[8:11], v[168:171], v[72:75]
    v_mfma_f32_16x16x32_bf16 v[76:79], a[8:11], v[172:175], v[76:79]
    buffer_load_dwordx4 a[112:115], v16, s[56:59], s65 offen offset:2048 sc1
    v_mfma_f32_16x16x32_bf16 v[80:83], a[12:15], v[160:163], v[80:83]
    v_mfma_f32_16x16x32_bf16 v[84:87], a[12:15], v[164:167], v[84:87]
    buffer_load_dwordx4 a[116:119], v16, s[56:59], s65 offen offset:3072 sc1
    v_mfma_f32_16x16x32_bf16 v[88:91], a[12:15], v[168:171], v[88:91]
    v_mfma_f32_16x16x32_bf16 v[92:95], a[12:15], v[172:175], v[92:95]
    s_add_u32 s65, s65, 147456
    buffer_load_dwordx4 a[120:123], v16, s[56:59], s66 offen sc1
    s_add_u32 s66, s66, 147456
    v_mfma_f32_16x16x32_bf16 v[96:99], a[16:19], v[160:163], v[96:99]
    v_mfma_f32_16x16x32_bf16 v[100:103], a[16:19], v[164:167], v[100:103]
    s_waitcnt vmcnt(41)
    v_mfma_f32_16x16x32_bf16 v[32:35], a[20:23], v[176:179], v[32:35]
    buffer_load_dwordx4 v[160:163], v4, s[40:43], s64 offen sc1
    v_mfma_f32_16x16x32_bf16 v[36:39], a[20:23], v[180:183], v[36:39]
    buffer_load_dwordx4 v[164:167], v5, s[40:43], s64 offen sc1
    v_mfma_f32_16x16x32_bf16 v[40:43], a[20:23], v[184:187], v[40:43]
    v_mfma_f32_16x16x32_bf16 v[44:47], a[20:23], v[188:191], v[44:47]
    buffer_load_dwordx4 v[168:171], v6, s[40:43], s64 offen sc1
    v_mfma_f32_16x16x32_bf16 v[48:51], a[24:27], v[176:179], v[48:51]
    v_mfma_f32_16x16x32_bf16 v[52:55], a[24:27], v[180:183], v[52:55]
    buffer_load_dwordx4 v[172:175], v7, s[40:43], s64 offen sc1
    v_mfma_f32_16x16x32_bf16 v[56:59], a[24:27], v[184:187], v[56:59]
    v_mfma_f32_16x16x32_bf16 v[60:63], a[24:27], v[188:191], v[60:63]
    s_add_u32 s64, s64, 4096
    buffer_load_dwordx4 a[0:3], v16, s[56:59], s65 offen offset:0 sc1
    v_mfma_f32_16x16x32_bf16 v[64:67], a[28:31], v[176:179], v[64:67]
    v_mfma_f32_16x16x32_bf16 v[68:71], a[28:31], v[180:183], v[68:71]
    buffer_load_dwordx4 a[4:7], v16, s[56:59], s65 offen offset:1024 sc1
    v_mfma_f32_16x16x32_bf16 v[72:75], a[28:31], v[184:187], v[72:75]
    v_mfma_f32_16x16x32_bf16 v[76:79], a[28:31], v[188:191], v[76:79]
    buffer_load_dwordx4 a[8:11], v16, s[56:59], s65 offen offset:2048 sc1
    v_mfma_f32_16x16x32_bf16 v[80:83], a[32:35], v[176:179], v[80:83]
    v_mfma_f32_16x16x32_bf16 v[84:87], a[32:35], v[180:183], v[84:87]
    buffer_load_dwordx4 a[12:15], v16, s[56:59], s65 offen offset:3072 sc1
    v_mfma_f32_16x16x32_bf16 v[88:91], a[32:35], v[184:187], v[88:91]
    v_mfma_f32_16x16x32_bf16 v[92:95], a[32:35], v[188:191], v[92:95]
    s_add_u32 s65, s65, 147456
    buffer_load_dwordx4 a[16:19], v16, s[56:59], s66 offen sc1
    s_add_u32 s66, s66, 147456
    v_mfma_f32_16x16x32_bf16 v[96:99], a[36:39], v[176:179], v[96:99]
    v_mfma_f32_16x16x32_bf16 v[100:103], a[36:39], v[180:183], v[100:103]
    s_waitcnt vmcnt(41)
    v_mfma_f32_16x16x32_bf16 v[32:35], a[40:43], v[192:195], v[32:35]
    buffer_load_dwordx4 v[176:179], v4, s[40:43], s64 offen sc1
    v_mfma_f32_16x16x32_bf16 v[36:39], a[40:43], v[196:199], v[36:39]
    buffer_load_dwordx4 v[180:183], v5, s[40:43], s64 offen sc1
    v_mfma_f32_16x16x32_bf16 v[40:43], a[40:43], v[200:203], v[40:43]
    v_mfma_f32_16x16x32_bf16 v[44:47], a[40:43], v[204:207], v[44:47]
    buffer_load_dwordx4 v[184:187], v6, s[40:43], s64 offen sc1
    v_mfma_f32_16x16x32_bf16 v[48:51], a[44:47], v[192:195], v[48:51]
    v_mfma_f32_16x16x32_bf16 v[52:55], a[44:47], v[196:199], v[52:55]
    buffer_load_dwordx4 v[188:191], v7, s[40:43], s64 offen sc1
    v_mfma_f32_16x16x32_bf16 v[56:59], a[44:47], v[200:203], v[56:59]
    v_mfma_f32_16x16x32_bf16 v[60:63], a[44:47], v[204:207], v[60:63]
    s_add_u32 s64, s64, 4096
    buffer_load_dwordx4 a[20:23], v16, s[56:59], s65 offen offset:0 sc1
    v_mfma_f32_16x16x32_bf16 v[64:67], a[48:51], v[192:195], v[64:67]
    v_mfma_f32_16x16x32_bf16 v[68:71], a[48:51], v[196:199], v[68:71]
    buffer_load_dwordx4 a[24:27], v16, s[56:59], s65 offen offset:1024 sc1
    v_mfma_f32_16x16x32_bf16 v[72:75], a[48:51], v[200:203], v[72:75]
    v_mfma_f32_16x16x32_bf16 v[76:79], a[48:51], v[204:207], v[76:79]
    buffer_load_dwordx4 a[28:31], v16, s[56:59], s65 offen offset:2048 sc1
    v_mfma_f32_16x16x32_bf16 v[80:83], a[52:55], v[192:195], v[80:83]
    v_mfma_f32_16x16x32_bf16 v[84:87], a[52:55], v[196:199], v[84:87]
    buffer_load_dwordx4 a[32:35], v16, s[56:59], s65 offen offset:3072 sc1
    v_mfma_f32_16x16x32_bf16 v[88:91], a[52:55], v[200:203], v[88:91]
    v_mfma_f32_16x16x32_bf16 v[92:95], a[52:55], v[204:207], v[92:95]
    s_add_u32 s65, s65, 147456
    buffer_load_dwordx4 a[36:39], v16, s[56:59], s66 offen sc1
    s_add_u32 s66, s66, 147456
    v_mfma_f32_16x16x32_bf16 v[96:99], a[56:59], v[192:195], v[96:99]
    v_mfma_f32_16x16x32_bf16 v[100:103], a[56:59], v[196:199], v[100:103]
    s_waitcnt vmcnt(41)
    v_mfma_f32_16x16x32_bf16 v[32:35], a[136:139], v[208:211], v[32:35]
    buffer_load_dwordx4 v[192:195], v4, s[40:43], s64 offen sc1
    v_mfma_f32_16x16x32_bf16 v[36:39], a[136:139], v[212:215], v[36:39]
    buffer_load_dwordx4 v[196:199], v5, s[40:43], s64 offen sc1
    v_mfma_f32_16x16x32_bf16 v[40:43], a[136:139], v[216:219], v[40:43]
    v_mfma_f32_16x16x32_bf16 v[44:47], a[136:139], v[220:223], v[44:47]
    buffer_load_dwordx4 v[200:203], v6, s[40:43], s64 offen sc1
    v_mfma_f32_16x16x32_bf16 v[48:51], a[140:143], v[208:211], v[48:51]
    v_mfma_f32_16x16x32_bf16 v[52:55], a[140:143], v[212:215], v[52:55]
    buffer_load_dwordx4 v[204:207], v7, s[40:43], s64 offen sc1
    v_mfma_f32_16x16x32_bf16 v[56:59], a[140:143], v[216:219], v[56:59]
    v_mfma_f32_16x16x32_bf16 v[60:63], a[140:143], v[220:223], v[60:63]
    s_add_u32 s64, s64, 4096
    buffer_load_dwordx4 a[40:43], v16, s[56:59], s65 offen offset:0 sc1
    v_mfma_f32_16x16x32_bf16 v[64:67], a[144:147], v[208:211], v[64:67]
    v_mfma_f32_16x16x32_bf16 v[68:71], a[144:147], v[212:215], v[68:71]
    buffer_load_dwordx4 a[44:47], v16, s[56:59], s65 offen offset:1024 sc1
    v_mfma_f32_16x16x32_bf16 v[72:75], a[144:147], v[216:219], v[72:75]
    v_mfma_f32_16x16x32_bf16 v[76:79], a[144:147], v[220:223], v[76:79]
    buffer_load_dwordx4 a[48:51], v16, s[56:59], s65 offen offset:2048 sc1
    v_mfma_f32_16x16x32_bf16 v[80:83], a[148:151], v[208:211], v[80:83]
    v_mfma_f32_16x16x32_bf16 v[84:87], a[148:151], v[212:215], v[84:87]
    buffer_load_dwordx4 a[52:55], v16, s[56:59], s65 offen offset:3072 sc1
    v_mfma_f32_16x16x32_bf16 v[88:91], a[148:151], v[216:219], v[88:91]
    v_mfma_f32_16x16x32_bf16 v[92:95], a[148:151], v[220:223], v[92:95]
    s_add_u32 s65, s65, 147456
    buffer_load_dwordx4 a[56:59], v16, s[56:59], s66 offen sc1
    s_add_u32 s66, s66, 147456
    v_mfma_f32_16x16x32_bf16 v[96:99], a[152:155], v[208:211], v[96:99]
    v_mfma_f32_16x16x32_bf16 v[100:103], a[152:155], v[212:215], v[100:103]
    s_waitcnt vmcnt(41)
    v_mfma_f32_16x16x32_bf16 v[32:35], a[156:159], v[224:227], v[32:35]
    buffer_load_dwordx4 v[208:211], v4, s[40:43], s64 offen sc1
    v_mfma_f32_16x16x32_bf16 v[36:39], a[156:159], v[228:231], v[36:39]
    buffer_load_dwordx4 v[212:215], v5, s[40:43], s64 offen sc1
    v_mfma_f32_16x16x32_bf16 v[40:43], a[156:159], v[232:235], v[40:43]
    v_mfma_f32_16x16x32_bf16 v[44:47], a[156:159], v[236:239], v[44:47]
    buffer_load_dwordx4 v[216:219], v6, s[40:43], s64 offen sc1
    v_mfma_f32_16x16x32_bf16 v[48:51], a[160:163], v[224:227], v[48:51]
    v_mfma_f32_16x16x32_bf16 v[52:55], a[160:163], v[228:231], v[52:55]
    buffer_load_dwordx4 v[220:223], v7, s[40:43], s64 offen sc1
    v_mfma_f32_16x16x32_bf16 v[56:59], a[160:163], v[232:235], v[56:59]
    v_mfma_f32_16x16x32_bf16 v[60:63], a[160:163], v[236:239], v[60:63]
    s_add_u32 s64, s64, 4096
    buffer_load_dwordx4 a[136:139], v16, s[56:59], s65 offen offset:0 sc1
    v_mfma_f32_16x16x32_bf16 v[64:67], a[164:167], v[224:227], v[64:67]
    v_mfma_f32_16x16x32_bf16 v[68:71], a[164:167], v[228:231], v[68:71]
    buffer_load_dwordx4 a[140:143], v16, s[56:59], s65 offen offset:1024 sc1
    v_mfma_f32_16x16x32_bf16 v[72:75], a[164:167], v[232:235], v[72:75]
    v_mfma_f32_16x16x32_bf16 v[76:79], a[164:167], v[236:239], v[76:79]
    buffer_load_dwordx4 a[144:147], v16, s[56:59], s65 offen offset:2048 sc1
    v_mfma_f32_16x16x32_bf16 v[80:83], a[168:171], v[224:227], v[80:83]
    v_mfma_f32_16x16x32_bf16 v[84:87], a[168:171], v[228:231], v[84:87]
    buffer_load_dwordx4 a[148:151], v16, s[56:59], s65 offen offset:3072 sc1
    v_mfma_f32_16x16x32_bf16 v[88:91], a[168:171], v[232:235], v[88:91]
    v_mfma_f32_16x16x32_bf16 v[92:95], a[168:171], v[236:239], v[92:95]
    s_add_u32 s65, s65, 147456
    buffer_load_dwordx4 a[152:155], v16, s[56:59], s66 offen sc1
    s_add_u32 s66, s66, 147456
    v_mfma_f32_16x16x32_bf16 v[96:99], a[172:175], v[224:227], v[96:99]
    v_mfma_f32_16x16x32_bf16 v[100:103], a[172:175], v[228:231], v[100:103]
    s_waitcnt vmcnt(41)
    v_mfma_f32_16x16x32_bf16 v[32:35], a[176:179], v[240:243], v[32:35]
    buffer_load_dwordx4 v[224:227], v4, s[40:43], s64 offen sc1
    v_mfma_f32_16x16x32_bf16 v[36:39], a[176:179], v[244:247], v[36:39]
    buffer_load_dwordx4 v[228:231], v5, s[40:43], s64 offen sc1
    v_mfma_f32_16x16x32_bf16 v[40:43], a[176:179], v[248:251], v[40:43]
    v_mfma_f32_16x16x32_bf16 v[44:47], a[176:179], v[252:255], v[44:47]
    buffer_load_dwordx4 v[232:235], v6, s[40:43], s64 offen sc1
    v_mfma_f32_16x16x32_bf16 v[48:51], a[180:183], v[240:243], v[48:51]
    v_mfma_f32_16x16x32_bf16 v[52:55], a[180:183], v[244:247], v[52:55]
    buffer_load_dwordx4 v[236:239], v7, s[40:43], s64 offen sc1
    v_mfma_f32_16x16x32_bf16 v[56:59], a[180:183], v[248:251], v[56:59]
    v_mfma_f32_16x16x32_bf16 v[60:63], a[180:183], v[252:255], v[60:63]
    s_add_u32 s64, s64, 4096
    buffer_load_dwordx4 a[156:159], v16, s[56:59], s65 offen offset:0 sc1
    v_mfma_f32_16x16x32_bf16 v[64:67], a[184:187], v[240:243], v[64:67]
    v_mfma_f32_16x16x32_bf16 v[68:71], a[184:187], v[244:247], v[68:71]
    buffer_load_dwordx4 a[160:163], v16, s[56:59], s65 offen offset:1024 sc1
    v_mfma_f32_16x16x32_bf16 v[72:75], a[184:187], v[248:251], v[72:75]
    v_mfma_f32_16x16x32_bf16 v[76:79], a[184:187], v[252:255], v[76:79]
    buffer_load_dwordx4 a[164:167], v16, s[56:59], s65 offen offset:2048 sc1
    v_mfma_f32_16x16x32_bf16 v[80:83], a[188:191], v[240:243], v[80:83]
    v_mfma_f32_16x16x32_bf16 v[84:87], a[188:191], v[244:247], v[84:87]
    buffer_load_dwordx4 a[168:171], v16, s[56:59], s65 offen offset:3072 sc1
    v_mfma_f32_16x16x32_bf16 v[88:91], a[188:191], v[248:251], v[88:91]
    v_mfma_f32_16x16x32_bf16 v[92:95], a[188:191], v[252:255], v[92:95]
    s_add_u32 s65, s65, 147456
    buffer_load_dwordx4 a[172:175], v16, s[56:59], s66 offen sc1
    s_add_u32 s66, s66, 147456
    v_mfma_f32_16x16x32_bf16 v[96:99], a[192:195], v[240:243], v[96:99]
    v_mfma_f32_16x16x32_bf16 v[100:103], a[192:195], v[244:247], v[100:103]
    s_waitcnt vmcnt(41)
    v_mfma_f32_16x16x32_bf16 v[32:35], a[196:199], v[160:163], v[32:35]
    buffer_load_dwordx4 v[240:243], v4, s[40:43], s64 offen sc1
    v_mfma_f32_16x16x32_bf16 v[36:39], a[196:199], v[164:167], v[36:39]
    buffer_load_dwordx4 v[244:247], v5, s[40:43], s64 offen sc1
    v_mfma_f32_16x16x32_bf16 v[40:43], a[196:199], v[168:171], v[40:43]
    v_mfma_f32_16x16x32_bf16 v[44:47], a[196:199], v[172:175], v[44:47]
    buffer_load_dwordx4 v[248:251], v6, s[40:43], s64 offen sc1
    v_mfma_f32_16x16x32_bf16 v[48:51], a[200:203], v[160:163], v[48:51]
    v_mfma_f32_16x16x32_bf16 v[52:55], a[200:203], v[164:167], v[52:55]
    buffer_load_dwordx4 v[252:255], v7, s[40:43], s64 offen sc1
    v_mfma_f32_16x16x32_bf16 v[56:59], a[200:203], v[168:171], v[56:59]
    v_mfma_f32_16x16x32_bf16 v[60:63], a[200:203], v[172:175], v[60:63]
    s_add_u32 s64, s64, 4096
    buffer_load_dwordx4 a[176:179], v16, s[56:59], s65 offen offset:0 sc1
    v_mfma_f32_16x16x32_bf16 v[64:67], a[204:207], v[160:163], v[64:67]
    v_mfma_f32_16x16x32_bf16 v[68:71], a[204:207], v[164:167], v[68:71]
    buffer_load_dwordx4 a[180:183], v16, s[56:59], s65 offen offset:1024 sc1
    v_mfma_f32_16x16x32_bf16 v[72:75], a[204:207], v[168:171], v[72:75]
    v_mfma_f32_16x16x32_bf16 v[76:79], a[204:207], v[172:175], v[76:79]
    buffer_load_dwordx4 a[184:187], v16, s[56:59], s65 offen offset:2048 sc1
    v_mfma_f32_16x16x32_bf16 v[80:83], a[208:211], v[160:163], v[80:83]
    v_mfma_f32_16x16x32_bf16 v[84:87], a[208:211], v[164:167], v[84:87]
    buffer_load_dwordx4 a[188:191], v16, s[56:59], s65 offen offset:3072 sc1
    v_mfma_f32_16x16x32_bf16 v[88:91], a[208:211], v[168:171], v[88:91]
    v_mfma_f32_16x16x32_bf16 v[92:95], a[208:211], v[172:175], v[92:95]
    s_add_u32 s65, s65, 147456
    buffer_load_dwordx4 a[192:195], v16, s[56:59], s66 offen sc1
    s_add_u32 s66, s66, 147456
    v_mfma_f32_16x16x32_bf16 v[96:99], a[212:215], v[160:163], v[96:99]
    v_mfma_f32_16x16x32_bf16 v[100:103], a[212:215], v[164:167], v[100:103]
    s_waitcnt vmcnt(41)
    v_mfma_f32_16x16x32_bf16 v[32:35], a[216:219], v[176:179], v[32:35]
    buffer_load_dwordx4 v[160:163], v4, s[40:43], s64 offen sc1
    v_mfma_f32_16x16x32_bf16 v[36:39], a[216:219], v[180:183], v[36:39]
    buffer_load_dwordx4 v[164:167], v5, s[40:43], s64 offen sc1
    v_mfma_f32_16x16x32_bf16 v[40:43], a[216:219], v[184:187], v[40:43]
    v_mfma_f32_16x16x32_bf16 v[44:47], a[216:219], v[188:191], v[44:47]
    buffer_load_dwordx4 v[168:171], v6, s[40:43], s64 offen sc1
    v_mfma_f32_16x16x32_bf16 v[48:51], a[220:223], v[176:179], v[48:51]
    v_mfma_f32_16x16x32_bf16 v[52:55], a[220:223], v[180:183], v[52:55]
    buffer_load_dwordx4 v[172:175], v7, s[40:43], s64 offen sc1
    v_mfma_f32_16x16x32_bf16 v[56:59], a[220:223], v[184:187], v[56:59]
    v_mfma_f32_16x16x32_bf16 v[60:63], a[220:223], v[188:191], v[60:63]
    s_add_u32 s64, s64, 4096
    buffer_load_dwordx4 a[196:199], v16, s[56:59], s65 offen offset:0 sc1
    v_mfma_f32_16x16x32_bf16 v[64:67], a[224:227], v[176:179], v[64:67]
    v_mfma_f32_16x16x32_bf16 v[68:71], a[224:227], v[180:183], v[68:71]
    buffer_load_dwordx4 a[200:203], v16, s[56:59], s65 offen offset:1024 sc1
    v_mfma_f32_16x16x32_bf16 v[72:75], a[224:227], v[184:187], v[72:75]
    v_mfma_f32_16x16x32_bf16 v[76:79], a[224:227], v[188:191], v[76:79]
    buffer_load_dwordx4 a[204:207], v16, s[56:59], s65 offen offset:2048 sc1
    v_mfma_f32_16x16x32_bf16 v[80:83], a[228:231], v[176:179], v[80:83]
    v_mfma_f32_16x16x32_bf16 v[84:87], a[228:231], v[180:183], v[84:87]
    buffer_load_dwordx4 a[208:211], v16, s[56:59], s65 offen offset:3072 sc1
    v_mfma_f32_16x16x32_bf16 v[88:91], a[228:231], v[184:187], v[88:91]
    v_mfma_f32_16x16x32_bf16 v[92:95], a[228:231], v[188:191], v[92:95]
    s_add_u32 s65, s65, 147456
    buffer_load_dwordx4 a[212:215], v16, s[56:59], s66 offen sc1
    s_add_u32 s66, s66, 147456
    v_mfma_f32_16x16x32_bf16 v[96:99], a[232:235], v[176:179], v[96:99]
    v_mfma_f32_16x16x32_bf16 v[100:103], a[232:235], v[180:183], v[100:103]
    s_waitcnt vmcnt(41)
    v_mfma_f32_16x16x32_bf16 v[32:35], a[236:239], v[192:195], v[32:35]
    buffer_load_dwordx4 v[176:179], v4, s[40:43], s64 offen sc1
    v_mfma_f32_16x16x32_bf16 v[36:39], a[236:239], v[196:199], v[36:39]
    buffer_load_dwordx4 v[180:183], v5, s[40:43], s64 offen sc1
    v_mfma_f32_16x16x32_bf16 v[40:43], a[236:239], v[200:203], v[40:43]
    v_mfma_f32_16x16x32_bf16 v[44:47], a[236:239], v[204:207], v[44:47]
    buffer_load_dwordx4 v[184:187], v6, s[40:43], s64 offen sc1
    v_mfma_f32_16x16x32_bf16 v[48:51], a[240:243], v[192:195], v[48:51]
    v_mfma_f32_16x16x32_bf16 v[52:55], a[240:243], v[196:199], v[52:55]
    buffer_load_dwordx4 v[188:191], v7, s[40:43], s64 offen sc1
    v_mfma_f32_16x16x32_bf16 v[56:59], a[240:243], v[200:203], v[56:59]
    v_mfma_f32_16x16x32_bf16 v[60:63], a[240:243], v[204:207], v[60:63]
    s_add_u32 s64, s64, 4096
    buffer_load_dwordx4 a[216:219], v16, s[56:59], s65 offen offset:0 sc1
    v_mfma_f32_16x16x32_bf16 v[64:67], a[244:247], v[192:195], v[64:67]
    v_mfma_f32_16x16x32_bf16 v[68:71], a[244:247], v[196:199], v[68:71]
    buffer_load_dwordx4 a[220:223], v16, s[56:59], s65 offen offset:1024 sc1
    v_mfma_f32_16x16x32_bf16 v[72:75], a[244:247], v[200:203], v[72:75]
    v_mfma_f32_16x16x32_bf16 v[76:79], a[244:247], v[204:207], v[76:79]
    buffer_load_dwordx4 a[224:227], v16, s[56:59], s65 offen offset:2048 sc1
    v_mfma_f32_16x16x32_bf16 v[80:83], a[248:251], v[192:195], v[80:83]
    v_mfma_f32_16x16x32_bf16 v[84:87], a[248:251], v[196:199], v[84:87]
    buffer_load_dwordx4 a[228:231], v16, s[56:59], s65 offen offset:3072 sc1
    v_mfma_f32_16x16x32_bf16 v[88:91], a[248:251], v[200:203], v[88:91]
    v_mfma_f32_16x16x32_bf16 v[92:95], a[248:251], v[204:207], v[92:95]
    s_add_u32 s65, s65, 147456
    buffer_load_dwordx4 a[232:235], v16, s[56:59], s66 offen sc1
    s_add_u32 s66, s66, 147456
    v_mfma_f32_16x16x32_bf16 v[96:99], a[252:255], v[192:195], v[96:99]
    v_mfma_f32_16x16x32_bf16 v[100:103], a[252:255], v[196:199], v[100:103]
    s_waitcnt vmcnt(41)
    v_mfma_f32_16x16x32_bf16 v[32:35], a[64:67], v[208:211], v[32:35]
    buffer_load_dword v3, v19, s[32:35], s71 offen sc1
    v_mfma_f32_16x16x32_bf16 v[36:39], a[64:67], v[212:215], v[36:39]
    buffer_load_dwordx4 v[192:195], v4, s[40:43], s64 offen sc1
    v_mfma_f32_16x16x32_bf16 v[40:43], a[64:67], v[216:219], v[40:43]
    v_mfma_f32_16x16x32_bf16 v[44:47], a[64:67], v[220:223], v[44:47]
    buffer_load_dwordx4 v[196:199], v5, s[40:43], s64 offen sc1
    v_mfma_f32_16x16x32_bf16 v[48:51], a[68:71], v[208:211], v[48:51]
    v_mfma_f32_16x16x32_bf16 v[52:55], a[68:71], v[212:215], v[52:55]
    buffer_load_dwordx4 v[200:203], v6, s[40:43], s64 offen sc1
    v_mfma_f32_16x16x32_bf16 v[56:59], a[68:71], v[216:219], v[56:59]
    buffer_load_dwordx4 v[204:207], v7, s[40:43], s64 offen sc1
    v_mfma_f32_16x16x32_bf16 v[60:63], a[68:71], v[220:223], v[60:63]
    v_mfma_f32_16x16x32_bf16 v[64:67], a[72:75], v[208:211], v[64:67]
    s_add_u32 s64, s64, 4096
    buffer_load_dwordx4 a[236:239], v16, s[56:59], s65 offen offset:0 sc1
    v_mfma_f32_16x16x32_bf16 v[68:71], a[72:75], v[212:215], v[68:71]
    v_mfma_f32_16x16x32_bf16 v[72:75], a[72:75], v[216:219], v[72:75]
    buffer_load_dwordx4 a[240:243], v16, s[56:59], s65 offen offset:1024 sc1
    v_mfma_f32_16x16x32_bf16 v[76:79], a[72:75], v[220:223], v[76:79]
    buffer_load_dwordx4 a[244:247], v16, s[56:59], s65 offen offset:2048 sc1
    v_mfma_f32_16x16x32_bf16 v[80:83], a[76:79], v[208:211], v[80:83]
    v_mfma_f32_16x16x32_bf16 v[84:87], a[76:79], v[212:215], v[84:87]
    buffer_load_dwordx4 a[248:251], v16, s[56:59], s65 offen offset:3072 sc1
    v_mfma_f32_16x16x32_bf16 v[88:91], a[76:79], v[216:219], v[88:91]
    v_mfma_f32_16x16x32_bf16 v[92:95], a[76:79], v[220:223], v[92:95]
    s_add_u32 s65, s65, 147456
    buffer_load_dwordx4 a[252:255], v16, s[56:59], s66 offen sc1
    s_add_u32 s66, s66, 147456
    v_mfma_f32_16x16x32_bf16 v[96:99], a[80:83], v[208:211], v[96:99]
    v_mfma_f32_16x16x32_bf16 v[100:103], a[80:83], v[212:215], v[100:103]
    s_waitcnt vmcnt(42)
    v_mfma_f32_16x16x32_bf16 v[32:35], a[84:87], v[224:227], v[32:35]
    buffer_load_dwordx4 v[208:211], v4, s[40:43], s64 offen sc1
    v_mfma_f32_16x16x32_bf16 v[36:39], a[84:87], v[228:231], v[36:39]
    buffer_load_dwordx4 v[212:215], v5, s[40:43], s64 offen sc1
    v_mfma_f32_16x16x32_bf16 v[40:43], a[84:87], v[232:235], v[40:43]
    v_mfma_f32_16x16x32_bf16 v[44:47], a[84:87], v[236:239], v[44:47]
    buffer_load_dwordx4 v[216:219], v6, s[40:43], s64 offen sc1
    v_mfma_f32_16x16x32_bf16 v[48:51], a[88:91], v[224:227], v[48:51]
    v_mfma_f32_16x16x32_bf16 v[52:55], a[88:91], v[228:231], v[52:55]
    buffer_load_dwordx4 v[220:223], v7, s[40:43], s64 offen sc1
    v_mfma_f32_16x16x32_bf16 v[56:59], a[88:91], v[232:235], v[56:59]
    v_mfma_f32_16x16x32_bf16 v[60:63], a[88:91], v[236:239], v[60:63]
    s_add_u32 s64, s64, 4096
    buffer_load_dwordx4 a[64:67], v16, s[56:59], s65 offen offset:0 sc1
    v_mfma_f32_16x16x32_bf16 v[64:67], a[92:95], v[224:227], v[64:67]
    v_mfma_f32_16x16x32_bf16 v[68:71], a[92:95], v[228:231], v[68:71]
    buffer_load_dwordx4 a[68:71], v16, s[56:59], s65 offen offset:1024 sc1
    v_mfma_f32_16x16x32_bf16 v[72:75], a[92:95], v[232:235], v[72:75]
    v_mfma_f32_16x16x32_bf16 v[76:79], a[92:95], v[236:239], v[76:79]
    buffer_load_dwordx4 a[72:75], v16, s[56:59], s65 offen offset:2048 sc1
    v_mfma_f32_16x16x32_bf16 v[80:83], a[96:99], v[224:227], v[80:83]
    v_mfma_f32_16x16x32_bf16 v[84:87], a[96:99], v[228:231], v[84:87]
    buffer_load_dwordx4 a[76:79], v16, s[56:59], s65 offen offset:3072 sc1
    v_mfma_f32_16x16x32_bf16 v[88:91], a[96:99], v[232:235], v[88:91]
    v_mfma_f32_16x16x32_bf16 v[92:95], a[96:99], v[236:239], v[92:95]
    s_add_u32 s65, s65, 147456
    buffer_load_dwordx4 a[80:83], v16, s[56:59], s66 offen sc1
    s_add_u32 s66, s66, 147456
    v_mfma_f32_16x16x32_bf16 v[96:99], a[100:103], v[224:227], v[96:99]
    v_mfma_f32_16x16x32_bf16 v[100:103], a[100:103], v[228:231], v[100:103]
    s_waitcnt vmcnt(42)
    v_mfma_f32_16x16x32_bf16 v[32:35], a[104:107], v[240:243], v[32:35]
    buffer_load_dwordx4 v[224:227], v4, s[40:43], s64 offen sc1
    v_mfma_f32_16x16x32_bf16 v[36:39], a[104:107], v[244:247], v[36:39]
    buffer_load_dwordx4 v[228:231], v5, s[40:43], s64 offen sc1
    v_mfma_f32_16x16x32_bf16 v[40:43], a[104:107], v[248:251], v[40:43]
    v_mfma_f32_16x16x32_bf16 v[44:47], a[104:107], v[252:255], v[44:47]
    buffer_load_dwordx4 v[232:235], v6, s[40:43], s64 offen sc1
    v_mfma_f32_16x16x32_bf16 v[48:51], a[108:111], v[240:243], v[48:51]
    v_mfma_f32_16x16x32_bf16 v[52:55], a[108:111], v[244:247], v[52:55]
    buffer_load_dwordx4 v[236:239], v7, s[40:43], s64 offen sc1
    v_mfma_f32_16x16x32_bf16 v[56:59], a[108:111], v[248:251], v[56:59]
    v_mfma_f32_16x16x32_bf16 v[60:63], a[108:111], v[252:255], v[60:63]
    s_add_u32 s64, s64, 4096
    buffer_load_dwordx4 a[84:87], v16, s[56:59], s65 offen offset:0 sc1
    v_mfma_f32_16x16x32_bf16 v[64:67], a[112:115], v[240:243], v[64:67]
    v_mfma_f32_16x16x32_bf16 v[68:71], a[112:115], v[244:247], v[68:71]
    buffer_load_dwordx4 a[88:91], v16, s[56:59], s65 offen offset:1024 sc1
    v_mfma_f32_16x16x32_bf16 v[72:75], a[112:115], v[248:251], v[72:75]
    v_mfma_f32_16x16x32_bf16 v[76:79], a[112:115], v[252:255], v[76:79]
    buffer_load_dwordx4 a[92:95], v16, s[56:59], s65 offen offset:2048 sc1
    v_mfma_f32_16x16x32_bf16 v[80:83], a[116:119], v[240:243], v[80:83]
    v_mfma_f32_16x16x32_bf16 v[84:87], a[116:119], v[244:247], v[84:87]
    buffer_load_dwordx4 a[96:99], v16, s[56:59], s65 offen offset:3072 sc1
    v_mfma_f32_16x16x32_bf16 v[88:91], a[116:119], v[248:251], v[88:91]
    v_mfma_f32_16x16x32_bf16 v[92:95], a[116:119], v[252:255], v[92:95]
    s_add_u32 s65, s65, 147456
    buffer_load_dwordx4 a[100:103], v16, s[56:59], s66 offen sc1
    s_add_u32 s66, s66, 147456
    v_mfma_f32_16x16x32_bf16 v[96:99], a[120:123], v[240:243], v[96:99]
    v_mfma_f32_16x16x32_bf16 v[100:103], a[120:123], v[244:247], v[100:103]
    s_waitcnt vmcnt(42)
    v_mfma_f32_16x16x32_bf16 v[32:35], a[0:3], v[160:163], v[32:35]
    buffer_load_dwordx4 v[240:243], v4, s[40:43], s64 offen sc1
    v_mfma_f32_16x16x32_bf16 v[36:39], a[0:3], v[164:167], v[36:39]
    buffer_load_dwordx4 v[244:247], v5, s[40:43], s64 offen sc1
    v_mfma_f32_16x16x32_bf16 v[40:43], a[0:3], v[168:171], v[40:43]
    v_mfma_f32_16x16x32_bf16 v[44:47], a[0:3], v[172:175], v[44:47]
    buffer_load_dwordx4 v[248:251], v6, s[40:43], s64 offen sc1
    v_mfma_f32_16x16x32_bf16 v[48:51], a[4:7], v[160:163], v[48:51]
    v_mfma_f32_16x16x32_bf16 v[52:55], a[4:7], v[164:167], v[52:55]
    buffer_load_dwordx4 v[252:255], v7, s[40:43], s64 offen sc1
    v_mfma_f32_16x16x32_bf16 v[56:59], a[4:7], v[168:171], v[56:59]
    v_mfma_f32_16x16x32_bf16 v[60:63], a[4:7], v[172:175], v[60:63]
    s_add_u32 s64, s64, 4096
    buffer_load_dwordx4 a[104:107], v16, s[56:59], s65 offen offset:0 sc1
    v_mfma_f32_16x16x32_bf16 v[64:67], a[8:11], v[160:163], v[64:67]
    v_mfma_f32_16x16x32_bf16 v[68:71], a[8:11], v[164:167], v[68:71]
    buffer_load_dwordx4 a[108:111], v16, s[56:59], s65 offen offset:1024 sc1
    v_mfma_f32_16x16x32_bf16 v[72:75], a[8:11], v[168:171], v[72:75]
    v_mfma_f32_16x16x32_bf16 v[76:79], a[8:11], v[172:175], v[76:79]
    buffer_load_dwordx4 a[112:115], v16, s[56:59], s65 offen offset:2048 sc1
    v_mfma_f32_16x16x32_bf16 v[80:83], a[12:15], v[160:163], v[80:83]
    v_mfma_f32_16x16x32_bf16 v[84:87], a[12:15], v[164:167], v[84:87]
    buffer_load_dwordx4 a[116:119], v16, s[56:59], s65 offen offset:3072 sc1
    v_mfma_f32_16x16x32_bf16 v[88:91], a[12:15], v[168:171], v[88:91]
    v_mfma_f32_16x16x32_bf16 v[92:95], a[12:15], v[172:175], v[92:95]
    s_add_u32 s65, s65, 147456
    buffer_load_dwordx4 a[120:123], v16, s[56:59], s66 offen sc1
    s_add_u32 s66, s66, 147456
    v_mfma_f32_16x16x32_bf16 v[96:99], a[16:19], v[160:163], v[96:99]
    v_mfma_f32_16x16x32_bf16 v[100:103], a[16:19], v[164:167], v[100:103]
    s_waitcnt vmcnt(42)
    v_mfma_f32_16x16x32_bf16 v[32:35], a[20:23], v[176:179], v[32:35]
    buffer_load_dwordx4 v[160:163], v4, s[40:43], s64 offen sc1
    v_mfma_f32_16x16x32_bf16 v[36:39], a[20:23], v[180:183], v[36:39]
    buffer_load_dwordx4 v[164:167], v5, s[40:43], s64 offen sc1
    v_mfma_f32_16x16x32_bf16 v[40:43], a[20:23], v[184:187], v[40:43]
    v_mfma_f32_16x16x32_bf16 v[44:47], a[20:23], v[188:191], v[44:47]
    buffer_load_dwordx4 v[168:171], v6, s[40:43], s64 offen sc1
    v_mfma_f32_16x16x32_bf16 v[48:51], a[24:27], v[176:179], v[48:51]
    v_mfma_f32_16x16x32_bf16 v[52:55], a[24:27], v[180:183], v[52:55]
    buffer_load_dwordx4 v[172:175], v7, s[40:43], s64 offen sc1
    v_mfma_f32_16x16x32_bf16 v[56:59], a[24:27], v[184:187], v[56:59]
    v_mfma_f32_16x16x32_bf16 v[60:63], a[24:27], v[188:191], v[60:63]
    s_add_u32 s64, s64, 4096
    buffer_load_dwordx4 a[0:3], v16, s[56:59], s65 offen offset:0 sc1
    v_mfma_f32_16x16x32_bf16 v[64:67], a[28:31], v[176:179], v[64:67]
    v_mfma_f32_16x16x32_bf16 v[68:71], a[28:31], v[180:183], v[68:71]
    buffer_load_dwordx4 a[4:7], v16, s[56:59], s65 offen offset:1024 sc1
    v_mfma_f32_16x16x32_bf16 v[72:75], a[28:31], v[184:187], v[72:75]
    v_mfma_f32_16x16x32_bf16 v[76:79], a[28:31], v[188:191], v[76:79]
    buffer_load_dwordx4 a[8:11], v16, s[56:59], s65 offen offset:2048 sc1
    v_mfma_f32_16x16x32_bf16 v[80:83], a[32:35], v[176:179], v[80:83]
    v_mfma_f32_16x16x32_bf16 v[84:87], a[32:35], v[180:183], v[84:87]
    buffer_load_dwordx4 a[12:15], v16, s[56:59], s65 offen offset:3072 sc1
    v_mfma_f32_16x16x32_bf16 v[88:91], a[32:35], v[184:187], v[88:91]
    v_mfma_f32_16x16x32_bf16 v[92:95], a[32:35], v[188:191], v[92:95]
    s_add_u32 s65, s65, 147456
    buffer_load_dwordx4 a[16:19], v16, s[56:59], s66 offen sc1
    s_add_u32 s66, s66, 147456
    v_mfma_f32_16x16x32_bf16 v[96:99], a[36:39], v[176:179], v[96:99]
    v_mfma_f32_16x16x32_bf16 v[100:103], a[36:39], v[180:183], v[100:103]
    s_waitcnt vmcnt(41)
    v_mfma_f32_16x16x32_bf16 v[32:35], a[40:43], v[192:195], v[32:35]
    buffer_load_dwordx4 v[176:179], v4, s[40:43], s64 offen sc1
    v_mfma_f32_16x16x32_bf16 v[36:39], a[40:43], v[196:199], v[36:39]
    v_mfma_f32_16x16x32_bf16 v[40:43], a[40:43], v[200:203], v[40:43]
    v_mfma_f32_16x16x32_bf16 v[44:47], a[40:43], v[204:207], v[44:47]
    v_mfma_f32_16x16x32_bf16 v[48:51], a[44:47], v[192:195], v[48:51]
    buffer_load_dwordx4 v[180:183], v5, s[40:43], s64 offen sc1
    v_mfma_f32_16x16x32_bf16 v[52:55], a[44:47], v[196:199], v[52:55]
    v_mfma_f32_16x16x32_bf16 v[56:59], a[44:47], v[200:203], v[56:59]
    v_mfma_f32_16x16x32_bf16 v[60:63], a[44:47], v[204:207], v[60:63]
    v_mfma_f32_16x16x32_bf16 v[64:67], a[48:51], v[192:195], v[64:67]
    buffer_load_dwordx4 v[184:187], v6, s[40:43], s64 offen sc1
    v_mfma_f32_16x16x32_bf16 v[68:71], a[48:51], v[196:199], v[68:71]
    v_mfma_f32_16x16x32_bf16 v[72:75], a[48:51], v[200:203], v[72:75]
    v_mfma_f32_16x16x32_bf16 v[76:79], a[48:51], v[204:207], v[76:79]
    v_mfma_f32_16x16x32_bf16 v[80:83], a[52:55], v[192:195], v[80:83]
    buffer_load_dwordx4 v[188:191], v7, s[40:43], s64 offen sc1
    s_add_u32 s64, s64, 4096
    v_mfma_f32_16x16x32_bf16 v[84:87], a[52:55], v[196:199], v[84:87]
    v_mfma_f32_16x16x32_bf16 v[88:91], a[52:55], v[200:203], v[88:91]
    v_mfma_f32_16x16x32_bf16 v[92:95], a[52:55], v[204:207], v[92:95]
    v_mfma_f32_16x16x32_bf16 v[96:99], a[56:59], v[192:195], v[96:99]
    v_mfma_f32_16x16x32_bf16 v[100:103], a[56:59], v[196:199], v[100:103]
    s_waitcnt vmcnt(36)
    s_waitcnt vmcnt(49)
    v_cmp_gt_u32 vcc, 2, v3
    s_nop 1
    s_and_b64 vcc, vcc, exec
    s_cbranch_scc1 SPIN_OA
BACK_OA:
    v_mfma_f32_16x16x32_bf16 v[32:35], a[136:139], v[208:211], v[32:35]
    buffer_load_dwordx4 v[192:195], v4, s[40:43], s64 offen sc1
    v_mfma_f32_16x16x32_bf16 v[36:39], a[136:139], v[212:215], v[36:39]
    v_mfma_f32_16x16x32_bf16 v[40:43], a[136:139], v[216:219], v[40:43]
    v_mfma_f32_16x16x32_bf16 v[44:47], a[136:139], v[220:223], v[44:47]
    v_mfma_f32_16x16x32_bf16 v[48:51], a[140:143], v[208:211], v[48:51]
    buffer_load_dwordx4 v[196:199], v5, s[40:43], s64 offen sc1
    v_mfma_f32_16x16x32_bf16 v[52:55], a[140:143], v[212:215], v[52:55]
    v_mfma_f32_16x16x32_bf16 v[56:59], a[140:143], v[216:219], v[56:59]
    v_mfma_f32_16x16x32_bf16 v[60:63], a[140:143], v[220:223], v[60:63]
    v_mfma_f32_16x16x32_bf16 v[64:67], a[144:147], v[208:211], v[64:67]
    buffer_load_dwordx4 v[200:203], v6, s[40:43], s64 offen sc1
    v_mfma_f32_16x16x32_bf16 v[68:71], a[144:147], v[212:215], v[68:71]
    v_mfma_f32_16x16x32_bf16 v[72:75], a[144:147], v[216:219], v[72:75]
    v_mfma_f32_16x16x32_bf16 v[76:79], a[144:147], v[220:223], v[76:79]
    v_mfma_f32_16x16x32_bf16 v[80:83], a[148:151], v[208:211], v[80:83]
    buffer_load_dwordx4 v[204:207], v7, s[40:43], s64 offen sc1
    s_add_u32 s64, s64, 4096
    v_mfma_f32_16x16x32_bf16 v[84:87], a[148:151], v[212:215], v[84:87]
    v_mfma_f32_16x16x32_bf16 v[88:91], a[148:151], v[216:219], v[88:91]
    v_mfma_f32_16x16x32_bf16 v[92:95], a[148:151], v[220:223], v[92:95]
    v_mfma_f32_16x16x32_bf16 v[96:99], a[152:155], v[208:211], v[96:99]
    v_mfma_f32_16x16x32_bf16 v[100:103], a[152:155], v[212:215], v[100:103]
    s_waitcnt vmcnt(31)
    v_mfma_f32_16x16x32_bf16 v[32:35], a[156:159], v[224:227], v[32:35]
    buffer_load_dwordx4 v[208:211], v4, s[40:43], s64 offen sc1
    v_mfma_f32_16x16x32_bf16 v[36:39], a[156:159], v[228:231], v[36:39]
    v_mfma_f32_16x16x32_bf16 v[40:43], a[156:159], v[232:235], v[40:43]
    v_mfma_f32_16x16x32_bf16 v[44:47], a[156:159], v[236:239], v[44:47]
    v_mfma_f32_16x16x32_bf16 v[48:51], a[160:163], v[224:227], v[48:51]
    buffer_load_dwordx4 v[212:215], v5, s[40:43], s64 offen sc1
    v_mfma_f32_16x16x32_bf16 v[52:55], a[160:163], v[228:231], v[52:55]
    v_mfma_f32_16x16x32_bf16 v[56:59], a[160:163], v[232:235], v[56:59]
    v_mfma_f32_16x16x32_bf16 v[60:63], a[160:163], v[236:239], v[60:63]
    v_mfma_f32_16x16x32_bf16 v[64:67], a[164:167], v[224:227], v[64:67]
    buffer_load_dwordx4 v[216:219], v6, s[40:43], s64 offen sc1
    v_mfma_f32_16x16x32_bf16 v[68:71], a[164:167], v[228:231], v[68:71]
    v_mfma_f32_16x16x32_bf16 v[72:75], a[164:167], v[232:235], v[72:75]
    v_mfma_f32_16x16x32_bf16 v[76:79], a[164:167], v[236:239], v[76:79]
    v_mfma_f32_16x16x32_bf16 v[80:83], a[168:171], v[224:227], v[80:83]
    buffer_load_dwordx4 v[220:223], v7, s[40:43], s64 offen sc1
    s_add_u32 s64, s64, 4096
    v_mfma_f32_16x16x32_bf16 v[84:87], a[168:171], v[228:231], v[84:87]
    v_mfma_f32_16x16x32_bf16 v[88:91], a[168:171], v[232:235], v[88:91]
    v_mfma_f32_16x16x32_bf16 v[92:95], a[168:171], v[236:239], v[92:95]
    v_mfma_f32_16x16x32_bf16 v[96:99], a[172:175], v[224:227], v[96:99]
    v_mfma_f32_16x16x32_bf16 v[100:103], a[172:175], v[228:231], v[100:103]
    s_waitcnt vmcnt(26)
    v_mfma_f32_16x16x32_bf16 v[32:35], a[176:179], v[240:243], v[32:35]
    buffer_load_dwordx4 v[224:227], v4, s[40:43], s64 offen sc1
    v_mfma_f32_16x16x32_bf16 v[36:39], a[176:179], v[244:247], v[36:39]
    v_mfma_f32_16x16x32_bf16 v[40:43], a[176:179], v[248:251], v[40:43]
    v_mfma_f32_16x16x32_bf16 v[44:47], a[176:179], v[252:255], v[44:47]
    v_mfma_f32_16x16x32_bf16 v[48:51], a[180:183], v[240:243], v[48:51]
    buffer_load_dwordx4 v[228:231], v5, s[40:43], s64 offen sc1
    v_mfma_f32_16x16x32_bf16 v[52:55], a[180:183], v[244:247], v[52:55]
    v_mfma_f32_16x16x32_bf16 v[56:59], a[180:183], v[248:251], v[56:59]
    v_mfma_f32_16x16x32_bf16 v[60:63], a[180:183], v[252:255], v[60:63]
    v_mfma_f32_16x16x32_bf16 v[64:67], a[184:187], v[240:243], v[64:67]
    buffer_load_dwordx4 v[232:235], v6, s[40:43], s64 offen sc1
    v_mfma_f32_16x16x32_bf16 v[68:71], a[184:187], v[244:247], v[68:71]
    v_mfma_f32_16x16x32_bf16 v[72:75], a[184:187], v[248:251], v[72:75]
    v_mfma_f32_16x16x32_bf16 v[76:79], a[184:187], v[252:255], v[76:79]
    v_mfma_f32_16x16x32_bf16 v[80:83], a[188:191], v[240:243], v[80:83]
    buffer_load_dwordx4 v[236:239], v7, s[40:43], s64 offen sc1
    s_add_u32 s64, s64, 4096
    v_mfma_f32_16x16x32_bf16 v[84:87], a[188:191], v[244:247], v[84:87]
    v_mfma_f32_16x16x32_bf16 v[88:91], a[188:191], v[248:251], v[88:91]
    v_mfma_f32_16x16x32_bf16 v[92:95], a[188:191], v[252:255], v[92:95]
    v_mfma_f32_16x16x32_bf16 v[96:99], a[192:195], v[240:243], v[96:99]
    v_mfma_f32_16x16x32_bf16 v[100:103], a[192:195], v[244:247], v[100:103]
    s_waitcnt vmcnt(21)
    v_mfma_f32_16x16x32_bf16 v[32:35], a[196:199], v[160:163], v[32:35]
    buffer_load_dwordx4 v[240:243], v4, s[40:43], s64 offen sc1
    v_mfma_f32_16x16x32_bf16 v[36:39], a[196:199], v[164:167], v[36:39]
    v_mfma_f32_16x16x32_bf16 v[40:43], a[196:199], v[168:171], v[40:43]
    v_mfma_f32_16x16x32_bf16 v[44:47], a[196:199], v[172:175], v[44:47]
    v_mfma_f32_16x16x32_bf16 v[48:51], a[200:203], v[160:163], v[48:51]
    buffer_load_dwordx4 v[244:247], v5, s[40:43], s64 offen sc1
    v_mfma_f32_16x16x32_bf16 v[52:55], a[200:203], v[164:167], v[52:55]
    v_mfma_f32_16x16x32_bf16 v[56:59], a[200:203], v[168:171], v[56:59]
    v_mfma_f32_16x16x32_bf16 v[60:63], a[200:203], v[172:175], v[60:63]
    v_mfma_f32_16x16x32_bf16 v[64:67], a[204:207], v[160:163], v[64:67]
    buffer_load_dwordx4 v[248:251], v6, s[40:43], s64 offen sc1
    v_mfma_f32_16x16x32_bf16 v[68:71], a[204:207], v[164:167], v[68:71]
    v_mfma_f32_16x16x32_bf16 v[72:75], a[204:207], v[168:171], v[72:75]
    v_mfma_f32_16x16x32_bf16 v[76:79], a[204:207], v[172:175], v[76:79]
    v_mfma_f32_16x16x32_bf16 v[80:83], a[208:211], v[160:163], v[80:83]
    buffer_load_dwordx4 v[252:255], v7, s[40:43], s64 offen sc1
    s_add_u32 s64, s64, 4096
    v_mfma_f32_16x16x32_bf16 v[84:87], a[208:211], v[164:167], v[84:87]
    v_mfma_f32_16x16x32_bf16 v[88:91], a[208:211], v[168:171], v[88:91]
    v_mfma_f32_16x16x32_bf16 v[92:95], a[208:211], v[172:175], v[92:95]
    v_mfma_f32_16x16x32_bf16 v[96:99], a[212:215], v[160:163], v[96:99]
    v_mfma_f32_16x16x32_bf16 v[100:103], a[212:215], v[164:167], v[100:103]
    s_waitcnt vmcnt(16)
    v_mfma_f32_16x16x32_bf16 v[32:35], a[216:219], v[176:179], v[32:35]
    s_cmp_lt_u32 s4, 2
    s_cselect_b32 s64, s64, 1073741824
    buffer_load_dwordx4 v[160:163], v4, s[40:43], s64 offen sc1
    v_mfma_f32_16x16x32_bf16 v[36:39], a[216:219], v[180:183], v[36:39]
    v_mfma_f32_16x16x32_bf16 v[40:43], a[216:219], v[184:187], v[40:43]
    v_mfma_f32_16x16x32_bf16 v[44:47], a[216:219], v[188:191], v[44:47]
    v_mfma_f32_16x16x32_bf16 v[48:51], a[220:223], v[176:179], v[48:51]
    buffer_load_dwordx4 v[164:167], v5, s[40:43], s64 offen sc1
    v_mfma_f32_16x16x32_bf16 v[52:55], a[220:223], v[180:183], v[52:55]
    v_mfma_f32_16x16x32_bf16 v[56:59], a[220:223], v[184:187], v[56:59]
    v_mfma_f32_16x16x32_bf16 v[60:63], a[220:223], v[188:191], v[60:63]
    v_mfma_f32_16x16x32_bf16 v[64:67], a[224:227], v[176:179], v[64:67]
    buffer_load_dwordx4 v[168:171], v6, s[40:43], s64 offen sc1
    v_mfma_f32_16x16x32_bf16 v[68:71], a[224:227], v[180:183], v[68:71]
    v_mfma_f32_16x16x32_bf16 v[72:75], a[224:227], v[184:187], v[72:75]
    v_mfma_f32_16x16x32_bf16 v[76:79], a[224:227], v[188:191], v[76:79]
    v_mfma_f32_16x16x32_bf16 v[80:83], a[228:231], v[176:179], v[80:83]
    buffer_load_dwordx4 v[172:175], v7, s[40:43], s64 offen sc1
    s_add_u32 s64, s64, 4096
    v_mfma_f32_16x16x32_bf16 v[84:87], a[228:231], v[180:183], v[84:87]
    v_mfma_f32_16x16x32_bf16 v[88:91], a[228:231], v[184:187], v[88:91]
    v_mfma_f32_16x16x32_bf16 v[92:95], a[228:231], v[188:191], v[92:95]
    v_mfma_f32_16x16x32_bf16 v[96:99], a[232:235], v[176:179], v[96:99]
    v_mfma_f32_16x16x32_bf16 v[100:103], a[232:235], v[180:183], v[100:103]
    s_waitcnt vmcnt(16)
    v_mfma_f32_16x16x32_bf16 v[32:35], a[236:239], v[192:195], v[32:35]
    v_mfma_f32_16x16x32_bf16 v[36:39], a[236:239], v[196:199], v[36:39]
    v_mfma_f32_16x16x32_bf16 v[40:43], a[236:239], v[200:203], v[40:43]
    v_mfma_f32_16x16x32_bf16 v[44:47], a[236:239], v[204:207], v[44:47]
    v_mfma_f32_16x16x32_bf16 v[48:51], a[240:243], v[192:195], v[48:51]
    v_mfma_f32_16x16x32_bf16 v[52:55], a[240:243], v[196:199], v[52:55]
    v_mfma_f32_16x16x32_bf16 v[56:59], a[240:243], v[200:203], v[56:59]
    v_mfma_f32_16x16x32_bf16 v[60:63], a[240:243], v[204:207], v[60:63]
    v_mfma_f32_16x16x32_bf16 v[64:67], a[244:247], v[192:195], v[64:67]
    v_mfma_f32_16x16x32_bf16 v[68:71], a[244:247], v[196:199], v[68:71]
    v_mfma_f32_16x16x32_bf16 v[72:75], a[244:247], v[200:203], v[72:75]
    v_mfma_f32_16x16x32_bf16 v[76:79], a[244:247], v[204:207], v[76:79]
    v_mfma_f32_16x16x32_bf16 v[80:83], a[248:251], v[192:195], v[80:83]
    v_mfma_f32_16x16x32_bf16 v[84:87], a[248:251], v[196:199], v[84:87]
    v_mfma_f32_16x16x32_bf16 v[88:91], a[248:251], v[200:203], v[88:91]
    v_mfma_f32_16x16x32_bf16 v[92:95], a[248:251], v[204:207], v[92:95]
    v_mfma_f32_16x16x32_bf16 v[96:99], a[252:255], v[192:195], v[96:99]
    v_mfma_f32_16x16x32_bf16 v[100:103], a[252:255], v[196:199], v[100:103]
    s_waitcnt vmcnt(12)
    v_mfma_f32_16x16x32_bf16 v[32:35], a[64:67], v[208:211], v[32:35]
    v_mfma_f32_16x16x32_bf16 v[36:39], a[64:67], v[212:215], v[36:39]
    v_mfma_f32_16x16x32_bf16 v[40:43], a[64:67], v[216:219], v[40:43]
    v_mfma_f32_16x16x32_bf16 v[44:47], a[64:67], v[220:223], v[44:47]
    v_mfma_f32_16x16x32_bf16 v[48:51], a[68:71], v[208:211], v[48:51]
    v_mfma_f32_16x16x32_bf16 v[52:55], a[68:71], v[212:215], v[52:55]
    v_mfma_f32_16x16x32_bf16 v[56:59], a[68:71], v[216:219], v[56:59]
    v_mfma_f32_16x16x32_bf16 v[60:63], a[68:71], v[220:223], v[60:63]
    v_mfma_f32_16x16x32_bf16 v[64:67], a[72:75], v[208:211], v[64:67]
    v_mfma_f32_16x16x32_bf16 v[68:71], a[72:75], v[212:215], v[68:71]
    v_mfma_f32_16x16x32_bf16 v[72:75], a[72:75], v[216:219], v[72:75]
    v_mfma_f32_16x16x32_bf16 v[76:79], a[72:75], v[220:223], v[76:79]
    v_mfma_f32_16x16x32_bf16 v[80:83], a[76:79], v[208:211], v[80:83]
    v_mfma_f32_16x16x32_bf16 v[84:87], a[76:79], v[212:215], v[84:87]
    v_mfma_f32_16x16x32_bf16 v[88:91], a[76:79], v[216:219], v[88:91]
    v_mfma_f32_16x16x32_bf16 v[92:95], a[76:79], v[220:223], v[92:95]
    v_mfma_f32_16x16x32_bf16 v[96:99], a[80:83], v[208:211], v[96:99]
    v_mfma_f32_16x16x32_bf16 v[100:103], a[80:83], v[212:215], v[100:103]
    s_waitcnt vmcnt(8)
    v_mfma_f32_16x16x32_bf16 v[32:35], a[84:87], v[224:227], v[32:35]
    v_mfma_f32_16x16x32_bf16 v[36:39], a[84:87], v[228:231], v[36:39]
    v_mfma_f32_16x16x32_bf16 v[40:43], a[84:87], v[232:235], v[40:43]
    v_mfma_f32_16x16x32_bf16 v[44:47], a[84:87], v[236:239], v[44:47]
    v_mfma_f32_16x16x32_bf16 v[48:51], a[88:91], v[224:227], v[48:51]
    v_mfma_f32_16x16x32_bf16 v[52:55], a[88:91], v[228:231], v[52:55]
    v_mfma_f32_16x16x32_bf16 v[56:59], a[88:91], v[232:235], v[56:59]
    v_mfma_f32_16x16x32_bf16 v[60:63], a[88:91], v[236:239], v[60:63]
    v_mfma_f32_16x16x32_bf16 v[64:67], a[92:95], v[224:227], v[64:67]
    v_mfma_f32_16x16x32_bf16 v[68:71], a[92:95], v[228:231], v[68:71]
    v_mfma_f32_16x16x32_bf16 v[72:75], a[92:95], v[232:235], v[72:75]
    v_mfma_f32_16x16x32_bf16 v[76:79], a[92:95], v[236:239], v[76:79]
    v_mfma_f32_16x16x32_bf16 v[80:83], a[96:99], v[224:227], v[80:83]
    v_mfma_f32_16x16x32_bf16 v[84:87], a[96:99], v[228:231], v[84:87]
    v_mfma_f32_16x16x32_bf16 v[88:91], a[96:99], v[232:235], v[88:91]
    v_mfma_f32_16x16x32_bf16 v[92:95], a[96:99], v[236:239], v[92:95]
    v_mfma_f32_16x16x32_bf16 v[96:99], a[100:103], v[224:227], v[96:99]
    v_mfma_f32_16x16x32_bf16 v[100:103], a[100:103], v[228:231], v[100:103]
    s_waitcnt vmcnt(4)
    v_mfma_f32_16x16x32_bf16 v[32:35], a[104:107], v[240:243], v[32:35]
    v_mfma_f32_16x16x32_bf16 v[36:39], a[104:107], v[244:247], v[36:39]
    v_mfma_f32_16x16x32_bf16 v[40:43], a[104:107], v[248:251], v[40:43]
    v_mfma_f32_16x16x32_bf16 v[44:47], a[104:107], v[252:255], v[44:47]
    v_mfma_f32_16x16x32_bf16 v[48:51], a[108:111], v[240:243], v[48:51]
    v_mfma_f32_16x16x32_bf16 v[52:55], a[108:111], v[244:247], v[52:55]
    v_mfma_f32_16x16x32_bf16 v[56:59], a[108:111], v[248:251], v[56:59]
    v_mfma_f32_16x16x32_bf16 v[60:63], a[108:111], v[252:255], v[60:63]
    v_mfma_f32_16x16x32_bf16 v[64:67], a[112:115], v[240:243], v[64:67]
    v_mfma_f32_16x16x32_bf16 v[68:71], a[112:115], v[244:247], v[68:71]
    v_mfma_f32_16x16x32_bf16 v[72:75], a[112:115], v[248:251], v[72:75]
    v_mfma_f32_16x16x32_bf16 v[76:79], a[112:115], v[252:255], v[76:79]
    v_mfma_f32_16x16x32_bf16 v[80:83], a[116:119], v[240:243], v[80:83]
    v_mfma_f32_16x16x32_bf16 v[84:87], a[116:119], v[244:247], v[84:87]
    v_mfma_f32_16x16x32_bf16 v[88:91], a[116:119], v[248:251], v[88:91]
    v_mfma_f32_16x16x32_bf16 v[92:95], a[116:119], v[252:255], v[92:95]
    v_mfma_f32_16x16x32_bf16 v[96:99], a[120:123], v[240:243], v[96:99]
    v_mfma_f32_16x16x32_bf16 v[100:103], a[120:123], v[244:247], v[100:103]
    s_waitcnt vmcnt(0)
    v_mfma_f32_16x16x32_bf16 v[32:35], a[0:3], v[160:163], v[32:35]
    v_mfma_f32_16x16x32_bf16 v[36:39], a[0:3], v[164:167], v[36:39]
    v_mfma_f32_16x16x32_bf16 v[40:43], a[0:3], v[168:171], v[40:43]
    v_mfma_f32_16x16x32_bf16 v[44:47], a[0:3], v[172:175], v[44:47]
    v_mfma_f32_16x16x32_bf16 v[48:51], a[4:7], v[160:163], v[48:51]
    v_mfma_f32_16x16x32_bf16 v[52:55], a[4:7], v[164:167], v[52:55]
    v_mfma_f32_16x16x32_bf16 v[56:59], a[4:7], v[168:171], v[56:59]
    v_mfma_f32_16x16x32_bf16 v[60:63], a[4:7], v[172:175], v[60:63]
    v_mfma_f32_16x16x32_bf16 v[64:67], a[8:11], v[160:163], v[64:67]
    v_mfma_f32_16x16x32_bf16 v[68:71], a[8:11], v[164:167], v[68:71]
    v_mfma_f32_16x16x32_bf16 v[72:75], a[8:11], v[168:171], v[72:75]
    v_mfma_f32_16x16x32_bf16 v[76:79], a[8:11], v[172:175], v[76:79]
    v_mfma_f32_16x16x32_bf16 v[80:83], a[12:15], v[160:163], v[80:83]
    v_mfma_f32_16x16x32_bf16 v[84:87], a[12:15], v[164:167], v[84:87]
    v_mfma_f32_16x16x32_bf16 v[88:91], a[12:15], v[168:171], v[88:91]
    v_mfma_f32_16x16x32_bf16 v[92:95], a[12:15], v[172:175], v[92:95]
    v_mfma_f32_16x16x32_bf16 v[96:99], a[16:19], v[160:163], v[96:99]
    v_mfma_f32_16x16x32_bf16 v[100:103], a[16:19], v[164:167], v[100:103]
    v_add_u32 v8, s68, v1
    v_add_u32 v16, 0x10000, v8
    ds_write_b128 v8, v[32:35] offset:0
    ds_write_b128 v8, v[36:39] offset:4096
    ds_write_b128 v8, v[40:43] offset:8192
    ds_write_b128 v8, v[44:47] offset:12288
    ds_write_b128 v8, v[48:51] offset:16384
    ds_write_b128 v8, v[52:55] offset:20480
    ds_write_b128 v8, v[56:59] offset:24576
    ds_write_b128 v8, v[60:63] offset:28672
    ds_write_b128 v8, v[64:67] offset:32768
    ds_write_b128 v8, v[68:71] offset:36864
    ds_write_b128 v8, v[72:75] offset:40960
    ds_write_b128 v8, v[76:79] offset:45056
    ds_write_b128 v8, v[80:83] offset:49152
    ds_write_b128 v8, v[84:87] offset:53248
    ds_write_b128 v8, v[88:91] offset:57344
    s_waitcnt lgkmcnt(14)
    ds_write_b128 v8, v[92:95] offset:61440
    s_waitcnt lgkmcnt(14)
    ds_write_b128 v16, v[96:99] offset:0
    s_waitcnt lgkmcnt(14)
    ds_write_b128 v16, v[100:103] offset:4096
    v_add_u32 v8, s69, v1
    s_and_b32 s98, s69, 4096
    s_add_u32 s98, s98, 0x10000
    v_add_u32 v16, s98, v1
    s_lshl1_add_u32 s98, s63, s4
    s_and_b32 s98, s98, 3
    s_lshl2_add_u32 s98, s61, s98
    s_lshl_b32 s98, s98, 4
    v_bfe_u32 v4, v1, 4, 4
    v_add_u32 v4, s98, v4
    v_mul_u32_u24 v4, 1152, v4
    v_lshrrev_b32 v5, 8, v1
    v_lshl_add_u32 v4, v5, 3, v4
    s_mul_i32 s98, s63, 5
    s_add_u32 s98, s98, s62
    s_lshl_b32 s98, s98, 5
    s_add_u32 s99, s62, 4
    s_lshl_b32 s99, s99, 5
    s_cmp_lt_u32 s4, 2
    s_cselect_b32 s99, s99, 1073741824
    s_waitcnt lgkmcnt(0)
    s_barrier
    ds_read_b128 v[32:35], v8 offset:0
    ds_read_b128 v[36:39], v8 offset:1024
    ds_read_b128 v[40:43], v8 offset:2048
    ds_read_b128 v[44:47], v8 offset:3072
    ds_read_b128 v[48:51], v8 offset:16384
    ds_read_b128 v[52:55], v8 offset:17408
    ds_read_b128 v[56:59], v8 offset:18432
    ds_read_b128 v[60:63], v8 offset:19456
    ds_read_b128 v[64:67], v8 offset:32768
    ds_read_b128 v[68:71], v8 offset:33792
    ds_read_b128 v[72:75], v8 offset:34816
    ds_read_b128 v[76:79], v8 offset:35840
    ds_read_b128 v[80:83], v8 offset:49152
    ds_read_b128 v[84:87], v8 offset:50176
    ds_read_b128 v[88:91], v8 offset:51200
    s_waitcnt lgkmcnt(14)
    ds_read_b128 v[92:95], v8 offset:52224
    s_waitcnt lgkmcnt(14)
    ds_read_b128 v[96:99], v16 offset:0
    s_waitcnt lgkmcnt(14)
    ds_read_b128 v[100:103], v16 offset:1024
    s_waitcnt lgkmcnt(14)
    ds_read_b128 v[104:107], v16 offset:2048
    s_waitcnt lgkmcnt(14)
    ds_read_b128 v[108:111], v16 offset:3072
    v_pk_add_f32 v[32:33], v[32:33], v[36:37]
    v_pk_add_f32 v[40:41], v[40:41], v[44:45]
    v_pk_add_f32 v[32:33], v[32:33], v[40:41]
    v_pk_add_f32 v[34:35], v[34:35], v[38:39]
    v_pk_add_f32 v[42:43], v[42:43], v[46:47]
    v_pk_add_f32 v[34:35], v[34:35], v[42:43]
    v_cvt_pk_bf16_f32 v32, v32, v33
    v_cvt_pk_bf16_f32 v33, v34, v35
    buffer_store_dwordx2 v[32:33], v4, s[24:27], s98 offen
    s_waitcnt lgkmcnt(14)
    v_pk_add_f32 v[48:49], v[48:49], v[52:53]
    s_waitcnt lgkmcnt(12)
    v_pk_add_f32 v[56:57], v[56:57], v[60:61]
    v_pk_add_f32 v[48:49], v[48:49], v[56:57]
    v_pk_add_f32 v[50:51], v[50:51], v[54:55]
    v_pk_add_f32 v[58:59], v[58:59], v[62:63]
    v_pk_add_f32 v[50:51], v[50:51], v[58:59]
    v_cvt_pk_bf16_f32 v48, v48, v49
    v_cvt_pk_bf16_f32 v49, v50, v51
    buffer_store_dwordx2 v[48:49], v4, s[24:27], s98 offen offset:32
    s_waitcnt lgkmcnt(10)
    v_pk_add_f32 v[64:65], v[64:65], v[68:69]
    s_waitcnt lgkmcnt(8)
    v_pk_add_f32 v[72:73], v[72:73], v[76:77]
    v_pk_add_f32 v[64:65], v[64:65], v[72:73]
    v_pk_add_f32 v[66:67], v[66:67], v[70:71]
    v_pk_add_f32 v[74:75], v[74:75], v[78:79]
    v_pk_add_f32 v[66:67], v[66:67], v[74:75]
    v_cvt_pk_bf16_f32 v64, v64, v65
    v_cvt_pk_bf16_f32 v65, v66, v67
    buffer_store_dwordx2 v[64:65], v4, s[24:27], s98 offen offset:64
    s_waitcnt lgkmcnt(6)
    v_pk_add_f32 v[80:81], v[80:81], v[84:85]
    s_waitcnt lgkmcnt(4)
    v_pk_add_f32 v[88:89], v[88:89], v[92:93]
    v_pk_add_f32 v[80:81], v[80:81], v[88:89]
    v_pk_add_f32 v[82:83], v[82:83], v[86:87]
    v_pk_add_f32 v[90:91], v[90:91], v[94:95]
    v_pk_add_f32 v[82:83], v[82:83], v[90:91]
    v_cvt_pk_bf16_f32 v80, v80, v81
    v_cvt_pk_bf16_f32 v81, v82, v83
    buffer_store_dwordx2 v[80:81], v4, s[24:27], s98 offen offset:96
    s_waitcnt lgkmcnt(2)
    v_pk_add_f32 v[96:97], v[96:97], v[100:101]
    s_waitcnt lgkmcnt(0)
    v_pk_add_f32 v[104:105], v[104:105], v[108:109]
    v_pk_add_f32 v[96:97], v[96:97], v[104:105]
    v_pk_add_f32 v[98:99], v[98:99], v[102:103]
    v_pk_add_f32 v[106:107], v[106:107], v[110:111]
    v_pk_add_f32 v[98:99], v[98:99], v[106:107]
    v_cvt_pk_bf16_f32 v96, v96, v97
    v_cvt_pk_bf16_f32 v97, v98, v99
    buffer_store_dwordx2 v[96:97], v4, s[24:27], s99 offen
K1_END:
    s_endpgm
K1_LB_MASK:
    s_nop 1
    v_add_f32 v212, s12, v144
    v_fma_f32 v176, v208, s8, v212
    v_fma_f32 v177, v209, s8, v212
    v_fma_f32 v178, v210, s8, v212
    v_fma_f32 v179, v211, s8, v212
    v_add_f32 v213, s13, v144
    v_fma_f32 v180, v208, s9, v213
    v_fma_f32 v181, v209, s9, v213
    v_fma_f32 v182, v210, s9, v213
    v_fma_f32 v183, v211, s9, v213
    v_add_f32 v214, s14, v144
    v_fma_f32 v184, v208, s10, v214
    v_fma_f32 v185, v209, s10, v214
    v_fma_f32 v186, v210, s10, v214
    v_fma_f32 v187, v211, s10, v214
    v_add_f32 v215, s15, v144
    v_fma_f32 v188, v208, s11, v215
    v_fma_f32 v189, v209, s11, v215
    v_fma_f32 v190, v210, s11, v215
    v_fma_f32 v191, v211, s11, v215
    s_nop 1
    s_branch K1_LB_BACK
K1_LS_MASK:
    s_nop 1
    v_add_f32 v212, s12, v152
    v_fma_f32 v176, v208, s8, v212
    v_fma_f32 v177, v209, s8, v212
    v_fma_f32 v178, v210, s8, v212
    v_fma_f32 v179, v211, s8, v212
    v_add_f32 v213, s13, v152
    v_fma_f32 v180, v208, s9, v213
    v_fma_f32 v181, v209, s9, v213
    v_fma_f32 v182, v210, s9, v213
    v_fma_f32 v183, v211, s9, v213
    v_add_f32 v214, s14, v152
    v_fma_f32 v184, v208, s10, v214
    v_fma_f32 v185, v209, s10, v214
    v_fma_f32 v186, v210, s10, v214
    v_fma_f32 v187, v211, s10, v214
    v_add_f32 v215, s15, v152
    v_fma_f32 v188, v208, s11, v215
    v_fma_f32 v189, v209, s11, v215
    v_fma_f32 v190, v210, s11, v215
    v_fma_f32 v191, v211, s11, v215
    s_nop 1
    s_branch K1_LS_BACK
K1_HAVEM_R:
    s_add_u32 m0, s76, s75
    s_nop 0
    buffer_load_dwordx4 v1, s[36:39], s77 offen sc1 lds
    buffer_load_dwordx4 v1, s[36:39], s77 offen offset:1024 sc1 lds
    buffer_load_dwordx4 v1, s[36:39], s77 offen offset:2048 sc1 lds
    buffer_load_dwordx4 v1, s[36:39], s77 offen offset:3072 sc1 lds
    s_add_u32 s100, s77, 4096
    s_add_u32 m0, m0, 4096
    s_nop 0
    buffer_load_dwordx4 v1, s[36:39], s100 offen sc1 lds
    buffer_load_dwordx4 v1, s[36:39], s100 offen offset:1024 sc1 lds
    buffer_load_dwordx4 v1, s[36:39], s100 offen offset:2048 sc1 lds
    buffer_load_dwordx4 v1, s[36:39], s100 offen offset:3072 sc1 lds
    s_add_u32 s77, s77, 32768
    s_add_u32 s76, s76, 32768
    s_branch K1_HAVEM
K1_REDO:
    s_mov_b32 s83, 1
    s_waitcnt vmcnt(0) lgkmcnt(0)
    s_barrier
    v_lshrrev_b32 v92, 4, v1
    v_and_b32 v64, 15, v92
    v_lshrrev_b32 v92, 4, v92
    v_lshlrev_b32 v92, 2, v92
    v_sub_u32 v92, v64, v92
    s_lshl_b32 s98, s4, 4
    v_add_u32 v92, s98, v92
    s_lshl_b32 s98, s6, 7
    s_sub_u32 s99, 1920, s98
    v_add_u32 v64, s98, v92
    v_add_u32 v65, 64, v64
    v_add_u32 v66, s99, v92
    v_add_u32 v67, 64, v66
    v_mov_b32 v93, 0xf149f2ca
    v_mov_b32 v68, v93
    v_mov_b32 v69, v93
    v_mov_b32 v70, v93
    v_mov_b32 v71, v93
    s_mov_b32 s78, 0
    s_add_u32 s99, s99, 128
K1_REDO_L:
    s_lshr_b32 s7, s78, 6
    s_lshl_b32 s7, s7, 15
    s_bfe_u32 s98, s78, 0x20004
    s_lshl_b32 s98, s98, 12
    s_add_u32 s7, s7, s98
    buffer_load_dwordx4 v[72:75], v1, s[36:39], s7 offen offset:0 sc1
    buffer_load_dwordx4 v[76:79], v1, s[36:39], s7 offen offset:1024 sc1
    buffer_load_dwordx4 v[80:83], v1, s[36:39], s7 offen offset:2048 sc1
    buffer_load_dwordx4 v[84:87], v1, s[36:39], s7 offen offset:3072 sc1
    s_waitcnt vmcnt(0)
    v_mfma_f32_16x16x32_bf16 v[88:91], v[72:75], v[128:131], 0
    v_mfma_f32_16x16x32_bf16 v[88:91], v[76:79], v[160:163], v[88:91]
    v_mfma_f32_16x16x32_bf16 v[88:91], v[80:83], v[192:195], v[88:91]
    v_mfma_f32_16x16x32_bf16 v[88:91], v[84:87], v[224:227], v[88:91]
    v_subrev_u32 v92, s78, v64
    v_cmp_le_i32 vcc, 0, v92
    s_nop 5
    v_cndmask_b32 v88, v93, v88, vcc
    v_max_f32 v68, v68, v88
    v_cmp_le_i32 vcc, 1, v92
    s_nop 1
    v_cndmask_b32 v89, v93, v89, vcc
    v_max_f32 v68, v68, v89
    v_cmp_le_i32 vcc, 2, v92
    s_nop 1
    v_cndmask_b32 v90, v93, v90, vcc
    v_max_f32 v68, v68, v90
    v_cmp_le_i32 vcc, 3, v92
    s_nop 1
    v_cndmask_b32 v91, v93, v91, vcc
    v_max_f32 v68, v68, v91
    v_mfma_f32_16x16x32_bf16 v[88:91], v[72:75], v[132:135], 0
    v_mfma_f32_16x16x32_bf16 v[88:91], v[76:79], v[164:167], v[88:91]
    v_mfma_f32_16x16x32_bf16 v[88:91], v[80:83], v[196:199], v[88:91]
    v_mfma_f32_16x16x32_bf16 v[88:91], v[84:87], v[228:231], v[88:91]
    v_subrev_u32 v92, s78, v65
    v_cmp_le_i32 vcc, 0, v92
    s_nop 5
    v_cndmask_b32 v88, v93, v88, vcc
    v_max_f32 v69, v69, v88
    v_cmp_le_i32 vcc, 1, v92
    s_nop 1
    v_cndmask_b32 v89, v93, v89, vcc
    v_max_f32 v69, v69, v89
    v_cmp_le_i32 vcc, 2, v92
    s_nop 1
    v_cndmask_b32 v90, v93, v90, vcc
    v_max_f32 v69, v69, v90
    v_cmp_le_i32 vcc, 3, v92
    s_nop 1
    v_cndmask_b32 v91, v93, v91, vcc
    v_max_f32 v69, v69, v91
    v_mfma_f32_16x16x32_bf16 v[88:91], v[72:75], v[136:139], 0
    v_mfma_f32_16x16x32_bf16 v[88:91], v[76:79], v[168:171], v[88:91]
    v_mfma_f32_16x16x32_bf16 v[88:91], v[80:83], v[200:203], v[88:91]
    v_mfma_f32_16x16x32_bf16 v[88:91], v[84:87], v[232:235], v[88:91]
    v_subrev_u32 v92, s78, v66
    v_cmp_le_i32 vcc, 0, v92
    s_nop 5
    v_cndmask_b32 v88, v93, v88, vcc
    v_max_f32 v70, v70, v88
    v_cmp_le_i32 vcc, 1, v92
    s_nop 1
    v_cndmask_b32 v89, v93, v89, vcc
    v_max_f32 v70, v70, v89
    v_cmp_le_i32 vcc, 2, v92
    s_nop 1
    v_cndmask_b32 v90, v93, v90, vcc
    v_max_f32 v70, v70, v90
    v_cmp_le_i32 vcc, 3, v92
    s_nop 1
    v_cndmask_b32 v91, v93, v91, vcc
    v_max_f32 v70, v70, v91
    v_mfma_f32_16x16x32_bf16 v[88:91], v[72:75], v[140:143], 0
    v_mfma_f32_16x16x32_bf16 v[88:91], v[76:79], v[172:175], v[88:91]
    v_mfma_f32_16x16x32_bf16 v[88:91], v[80:83], v[204:207], v[88:91]
    v_mfma_f32_16x16x32_bf16 v[88:91], v[84:87], v[236:239], v[88:91]
    v_subrev_u32 v92, s78, v67
    v_cmp_le_i32 vcc, 0, v92
    s_nop 5
    v_cndmask_b32 v88, v93, v88, vcc
    v_max_f32 v71, v71, v88
    v_cmp_le_i32 vcc, 1, v92
    s_nop 1
    v_cndmask_b32 v89, v93, v89, vcc
    v_max_f32 v71, v71, v89
    v_cmp_le_i32 vcc, 2, v92
    s_nop 1
    v_cndmask_b32 v90, v93, v90, vcc
    v_max_f32 v71, v71, v90
    v_cmp_le_i32 vcc, 3, v92
    s_nop 1
    v_cndmask_b32 v91, v93, v91, vcc
    v_max_f32 v71, v71, v91
    s_add_u32 s78, s78, 16
    s_cmp_lt_u32 s78, s99
    s_cbranch_scc1 K1_REDO_L
    v_mov_b32 v92, v68
    s_nop 1
    v_permlane32_swap_b32 v68, v92
    v_max_f32 v68, v68, v92
    v_mov_b32 v92, v68
    s_nop 1
    v_permlane16_swap_b32 v68, v92
    v_max_f32 v68, v68, v92
    v_sub_f32 v144, 0, v68
    v_sub_f32 v145, 0, v68
    v_sub_f32 v146, 0, v68
    v_sub_f32 v147, 0, v68
    v_mov_b32 v92, v69
    s_nop 1
    v_permlane32_swap_b32 v69, v92
    v_max_f32 v69, v69, v92
    v_mov_b32 v92, v69
    s_nop 1
    v_permlane16_swap_b32 v69, v92
    v_max_f32 v69, v69, v92
    v_sub_f32 v148, 0, v69
    v_sub_f32 v149, 0, v69
    v_sub_f32 v150, 0, v69
    v_sub_f32 v151, 0, v69
    v_mov_b32 v92, v70
    s_nop 1
    v_permlane32_swap_b32 v70, v92
    v_max_f32 v70, v70, v92
    v_mov_b32 v92, v70
    s_nop 1
    v_permlane16_swap_b32 v70, v92
    v_max_f32 v70, v70, v92
    v_sub_f32 v152, 0, v70
    v_sub_f32 v153, 0, v70
    v_sub_f32 v154, 0, v70
    v_sub_f32 v155, 0, v70
    v_mov_b32 v92, v71
    s_nop 1
    v_permlane32_swap_b32 v71, v92
    v_max_f32 v71, v71, v92
    v_mov_b32 v92, v71
    s_nop 1
    v_permlane16_swap_b32 v71, v92
    v_max_f32 v71, v71, v92
    v_sub_f32 v156, 0, v71
    v_sub_f32 v157, 0, v71
    v_sub_f32 v158, 0, v71
    v_sub_f32 v159, 0, v71
    v_accvgpr_write_b32 a0, 0
    v_accvgpr_write_b32 a1, 0
    v_accvgpr_write_b32 a2, 0
    v_accvgpr_write_b32 a3, 0
    v_accvgpr_write_b32 a4, 0
    v_accvgpr_write_b32 a5, 0
    v_accvgpr_write_b32 a6, 0
    v_accvgpr_write_b32 a7, 0
    v_accvgpr_write_b32 a8, 0
    v_accvgpr_write_b32 a9, 0
    v_accvgpr_write_b32 a10, 0
    v_accvgpr_write_b32 a11, 0
    v_accvgpr_write_b32 a12, 0
    v_accvgpr_write_b32 a13, 0
    v_accvgpr_write_b32 a14, 0
    v_accvgpr_write_b32 a15, 0
    v_accvgpr_write_b32 a16, 0
    v_accvgpr_write_b32 a17, 0
    v_accvgpr_write_b32 a18, 0
    v_accvgpr_write_b32 a19, 0
    v_accvgpr_write_b32 a20, 0
    v_accvgpr_write_b32 a21, 0
    v_accvgpr_write_b32 a22, 0
    v_accvgpr_write_b32 a23, 0
    v_accvgpr_write_b32 a24, 0
    v_accvgpr_write_b32 a25, 0
    v_accvgpr_write_b32 a26, 0
    v_accvgpr_write_b32 a27, 0
    v_accvgpr_write_b32 a28, 0
    v_accvgpr_write_b32 a29, 0
    v_accvgpr_write_b32 a30, 0
    v_accvgpr_write_b32 a31, 0
    v_accvgpr_write_b32 a32, 0
    v_accvgpr_write_b32 a33, 0
    v_accvgpr_write_b32 a34, 0
    v_accvgpr_write_b32 a35, 0
    v_accvgpr_write_b32 a36, 0
    v_accvgpr_write_b32 a37, 0
    v_accvgpr_write_b32 a38, 0
    v_accvgpr_write_b32 a39, 0
    v_accvgpr_write_b32 a40, 0
    v_accvgpr_write_b32 a41, 0
    v_accvgpr_write_b32 a42, 0
    v_accvgpr_write_b32 a43, 0
    v_accvgpr_write_b32 a44, 0
    v_accvgpr_write_b32 a45, 0
    v_accvgpr_write_b32 a46, 0
    v_accvgpr_write_b32 a47, 0
    v_accvgpr_write_b32 a48, 0
    v_accvgpr_write_b32 a49, 0
    v_accvgpr_write_b32 a50, 0
    v_accvgpr_write_b32 a51, 0
    v_accvgpr_write_b32 a52, 0
    v_accvgpr_write_b32 a53, 0
    v_accvgpr_write_b32 a54, 0
    v_accvgpr_write_b32 a55, 0
    v_accvgpr_write_b32 a56, 0
    v_accvgpr_write_b32 a57, 0
    v_accvgpr_write_b32 a58, 0
    v_accvgpr_write_b32 a59, 0
    v_accvgpr_write_b32 a60, 0
    v_accvgpr_write_b32 a61, 0
    v_accvgpr_write_b32 a62, 0
    v_accvgpr_write_b32 a63, 0
    v_accvgpr_write_b32 a144, 0
    v_accvgpr_write_b32 a145, 0
    v_accvgpr_write_b32 a146, 0
    v_accvgpr_write_b32 a147, 0
    v_accvgpr_write_b32 a148, 0
    v_accvgpr_write_b32 a149, 0
    v_accvgpr_write_b32 a150, 0
    v_accvgpr_write_b32 a151, 0
    v_accvgpr_write_b32 a152, 0
    v_accvgpr_write_b32 a153, 0
    v_accvgpr_write_b32 a154, 0
    v_accvgpr_write_b32 a155, 0
    v_accvgpr_write_b32 a156, 0
    v_accvgpr_write_b32 a157, 0
    v_accvgpr_write_b32 a158, 0
    v_accvgpr_write_b32 a159, 0
    v_accvgpr_write_b32 a160, 0
    v_accvgpr_write_b32 a161, 0
    v_accvgpr_write_b32 a162, 0
    v_accvgpr_write_b32 a163, 0
    v_accvgpr_write_b32 a164, 0
    v_accvgpr_write_b32 a165, 0
    v_accvgpr_write_b32 a166, 0
    v_accvgpr_write_b32 a167, 0
    v_accvgpr_write_b32 a168, 0
    v_accvgpr_write_b32 a169, 0
    v_accvgpr_write_b32 a170, 0
    v_accvgpr_write_b32 a171, 0
    v_accvgpr_write_b32 a172, 0
    v_accvgpr_write_b32 a173, 0
    v_accvgpr_write_b32 a174, 0
    v_accvgpr_write_b32 a175, 0
    v_accvgpr_write_b32 a176, 0
    v_accvgpr_write_b32 a177, 0
    v_accvgpr_write_b32 a178, 0
    v_accvgpr_write_b32 a179, 0
    v_accvgpr_write_b32 a180, 0
    v_accvgpr_write_b32 a181, 0
    v_accvgpr_write_b32 a182, 0
    v_accvgpr_write_b32 a183, 0
    v_accvgpr_write_b32 a184, 0
    v_accvgpr_write_b32 a185, 0
    v_accvgpr_write_b32 a186, 0
    v_accvgpr_write_b32 a187, 0
    v_accvgpr_write_b32 a188, 0
    v_accvgpr_write_b32 a189, 0
    v_accvgpr_write_b32 a190, 0
    v_accvgpr_write_b32 a191, 0
    v_accvgpr_write_b32 a192, 0
    v_accvgpr_write_b32 a193, 0
    v_accvgpr_write_b32 a194, 0
    v_accvgpr_write_b32 a195, 0
    v_accvgpr_write_b32 a196, 0
    v_accvgpr_write_b32 a197, 0
    v_accvgpr_write_b32 a198, 0
    v_accvgpr_write_b32 a199, 0
    v_accvgpr_write_b32 a200, 0
    v_accvgpr_write_b32 a201, 0
    v_accvgpr_write_b32 a202, 0
    v_accvgpr_write_b32 a203, 0
    v_accvgpr_write_b32 a204, 0
    v_accvgpr_write_b32 a205, 0
    v_accvgpr_write_b32 a206, 0
    v_accvgpr_write_b32 a207, 0
    v_accvgpr_write_b32 a208, 0
    v_accvgpr_write_b32 a209, 0
    v_accvgpr_write_b32 a210, 0
    v_accvgpr_write_b32 a211, 0
    v_accvgpr_write_b32 a212, 0
    v_accvgpr_write_b32 a213, 0
    v_accvgpr_write_b32 a214, 0
    v_accvgpr_write_b32 a215, 0
    v_accvgpr_write_b32 a216, 0
    v_accvgpr_write_b32 a217, 0
    v_accvgpr_write_b32 a218, 0
    v_accvgpr_write_b32 a219, 0
    v_accvgpr_write_b32 a220, 0
    v_accvgpr_write_b32 a221, 0
    v_accvgpr_write_b32 a222, 0
    v_accvgpr_write_b32 a223, 0
    v_mov_b32 v92, 0x3f803f80
    v_accvgpr_write_b32 a136, v92
    v_accvgpr_write_b32 a137, v92
    v_accvgpr_write_b32 a138, v92
    v_accvgpr_write_b32 a139, v92
    s_mov_b32 s77, s75
    s_mov_b32 s76, 0
    s_add_u32 m0, s76, s75
    s_nop 0
    buffer_load_dwordx4 v1, s[36:39], s77 offen sc1 lds
    buffer_load_dwordx4 v1, s[36:39], s77 offen offset:1024 sc1 lds
    buffer_load_dwordx4 v1, s[36:39], s77 offen offset:2048 sc1 lds
    buffer_load_dwordx4 v1, s[36:39], s77 offen offset:3072 sc1 lds
    s_add_u32 s100, s77, 4096
    s_add_u32 m0, m0, 4096
    s_nop 0
    buffer_load_dwordx4 v1, s[36:39], s100 offen sc1 lds
    buffer_load_dwordx4 v1, s[36:39], s100 offen offset:1024 sc1 lds
    buffer_load_dwordx4 v1, s[36:39], s100 offen offset:2048 sc1 lds
    buffer_load_dwordx4 v1, s[36:39], s100 offen offset:3072 sc1 lds
    s_add_u32 s77, s77, 32768
    s_add_u32 s76, s76, 32768
    s_add_u32 m0, s76, s75
    s_nop 0
    buffer_load_dwordx4 v1, s[36:39], s77 offen sc1 lds
    buffer_load_dwordx4 v1, s[36:39], s77 offen offset:1024 sc1 lds
    buffer_load_dwordx4 v1, s[36:39], s77 offen offset:2048 sc1 lds
    buffer_load_dwordx4 v1, s[36:39], s77 offen offset:3072 sc1 lds
    s_add_u32 s100, s77, 4096
    s_add_u32 m0, m0, 4096
    s_nop 0
    buffer_load_dwordx4 v1, s[36:39], s100 offen sc1 lds
    buffer_load_dwordx4 v1, s[36:39], s100 offen offset:1024 sc1 lds
    buffer_load_dwordx4 v1, s[36:39], s100 offen offset:2048 sc1 lds
    buffer_load_dwordx4 v1, s[36:39], s100 offen offset:3072 sc1 lds
    s_add_u32 s77, s77, 32768
    s_add_u32 s76, s76, 32768
    s_branch K1_ATT
SPIN_H14:
    s_mov_b32 s94, 0
SPIN_H14_L:
    s_sleep 2
    buffer_load_dword v7, v30, s[44:47], s95 offen sc1
    s_add_u32 s94, s94, 1
    s_cmp_ge_u32 s94, 0x40000
    s_waitcnt vmcnt(0)
    s_cbranch_scc1 BACK_H14
    v_cmp_gt_u32 vcc, 8, v7
    s_nop 1
    s_and_b64 vcc, vcc, s[86:87]
    s_cbranch_scc1 SPIN_H14_L
    s_branch BACK_H14
SPIN_H33:
    s_mov_b32 s94, 0
SPIN_H33_L:
    s_sleep 2
    buffer_load_dword v7, v30, s[44:47], s95 offen sc1
    s_add_u32 s94, s94, 1
    s_cmp_ge_u32 s94, 0x40000
    s_waitcnt vmcnt(0)
    s_cbranch_scc1 BACK_H33
    v_cmp_gt_u32 vcc, 16, v7
    s_nop 1
    s_and_b64 vcc, vcc, s[86:87]
    s_cbranch_scc1 SPIN_H33_L
    s_branch BACK_H33
SPIN_ALL:
    s_mov_b32 s94, 0
SPIN_ALL_L:
    s_sleep 2
    buffer_load_dword v3, v29, s[44:47], 0 offen sc1
    s_add_u32 s94, s94, 1
    s_cmp_ge_u32 s94, 0x40000
    s_waitcnt vmcnt(0)
    s_cbranch_scc1 BACK_ALL
    v_cmp_gt_u32 vcc, 24, v3
    s_nop 1
    s_and_b64 vcc, vcc, s[92:93]
    s_cbranch_scc1 SPIN_ALL_L
    s_branch BACK_ALL
SPIN_CTX:
    s_mov_b32 s94, 0
SPIN_CTX_L:
    s_sleep 2
    buffer_load_dword v3, v19, s[32:35], s71 offen sc1
    s_add_u32 s94, s94, 1
    s_cmp_ge_u32 s94, 0x40000
    s_waitcnt vmcnt(0)
    s_cbranch_scc1 BACK_CTX
    v_cmp_gt_u32 vcc, 1, v3
    s_nop 1
    s_and_b64 vcc, vcc, exec
    s_cbranch_scc1 SPIN_CTX_L
    s_branch BACK_CTX
SPIN_OA:
    s_mov_b32 s94, 0
SPIN_OA_L:
    s_sleep 2
    buffer_load_dword v3, v19, s[32:35], s71 offen sc1
    s_add_u32 s94, s94, 1
    s_cmp_ge_u32 s94, 0x40000
    s_waitcnt vmcnt(0)
    s_cbranch_scc1 BACK_OA
    v_cmp_gt_u32 vcc, 2, v3
    s_nop 1
    s_and_b64 vcc, vcc, exec
    s_cbranch_scc1 SPIN_OA_L
    s_branch BACK_OA
.section .rodata,"a"
.p2align 6
.amdhsa_kernel gated_mix__sliding_local_dilated__compressed_kv_cla__prompt_kernel
.amdhsa_next_free_vgpr 512
.amdhsa_next_free_sgpr 102
.amdhsa_accum_offset 256
.amdhsa_group_segment_fixed_size 0
.amdhsa_kernarg_size 104
.amdhsa_user_sgpr_count 2
.amdhsa_user_sgpr_kernarg_segment_ptr 1
.amdhsa_system_sgpr_workgroup_id_x 1
.amdhsa_ieee_mode 0
.amdhsa_dx10_clamp 0
.end_amdhsa_kernel
```

```asm
; @launch grid=(256,1,1) block=(256,1,1) lds=163840
.amdgcn_target "amdgcn-amd-amdhsa--gfx950"
.text
.globl gated_mix__sliding_local_dilated__compressed_kv_cla__prompt_kernel
.p2align 8
.type gated_mix__sliding_local_dilated__compressed_kv_cla__prompt_kernel,@function
gated_mix__sliding_local_dilated__compressed_kv_cla__prompt_kernel:
    s_cmp_ge_u32 s2, 256
    s_cbranch_scc1 K1_END
    s_getpc_b64 s[94:95]
    s_load_dwordx2 s[8:9], s[0:1], 32
    s_load_dwordx2 s[12:13], s[0:1], 48
    s_load_dwordx2 s[16:17], s[0:1], 56
    s_load_dwordx2 s[20:21], s[0:1], 0
    s_load_dwordx2 s[24:25], s[0:1], 40
    s_load_dwordx2 s[28:29], s[0:1], 8
    s_load_dwordx2 s[32:33], s[0:1], 72
    s_load_dwordx2 s[48:49], s[0:1], 64
    s_load_dwordx2 s[92:93], s[0:1], 16
    s_load_dwordx2 s[44:45], s[0:1], 88
    s_load_dwordx2 s[56:57], s[0:1], 96
    v_min_u32 v74, 16, v0
    s_lshr_b32 s7, s2, 3
    s_mul_i32 s7, s7, 17
    v_add_lshl_u32 v74, v74, s7, 7
    global_load_dword v76, v74, s[94:95]
    v_lshrrev_b32 v64, 6, v0
    v_and_b32 v31, 63, v0
    v_readfirstlane_b32 s4, v64
    s_and_b32 s5, s2, 7
    s_lshl_b32 s5, s5, 2
    s_bfe_u32 s7, s2, 0x20003
    s_add_u32 s5, s5, s7
    s_lshr_b32 s6, s2, 5
    s_lshl_b32 s69, s4, 12
    s_mov_b32 s10, 2097152
    s_mov_b32 s11, 0x20000
    s_mov_b32 s14, 4194304
    s_mov_b32 s15, 0x20000
    s_mov_b32 s18, 4194304
    s_mov_b32 s19, 0x20000
    v_lshrrev_b32 v65, 3, v31
    v_and_b32 v66, 7, v31
    v_lshrrev_b32 v67, 1, v65
    v_xor_b32 v66, v66, v67
    v_lshlrev_b32 v66, 4, v66
    v_xor_b32 v67, 64, v66
    s_lshr_b32 s7, s4, 1
    s_lshl_b32 s73, s7, 7
    s_and_b32 s3, s4, 1
    s_lshl_b32 s98, s3, 5
    s_add_u32 s98, s98, s73
    v_add_lshl_u32 v68, v65, s98, 10
    v_add_u32 v6, v68, v66
    v_add_u32 v7, v68, v67
    v_add_u32 v7, 7168, v7
    v_add_u32 v8, v68, v66
    v_add_u32 v8, 14336, v8
    v_add_u32 v9, v68, v67
    v_add_u32 v9, 21504, v9
    v_lshrrev_b32 v69, 4, v31
    v_and_b32 v70, 15, v31
    v_lshlrev_b32 v71, 1, v69
    v_xor_b32 v71, v71, v70
    v_lshlrev_b32 v71, 4, v71
    v_xor_b32 v72, 128, v71
    s_lshl_b32 s98, s4, 4
    v_add_lshl_u32 v73, v69, s98, 13
    v_add_u32 v2, v73, v71
    v_add_u32 v3, v73, v71
    v_add_u32 v3, 31744, v3
    v_add_u32 v4, v73, v72
    v_add_u32 v4, 63488, v4
    v_add_u32 v5, v73, v72
    v_add_u32 v5, 95232, v5
    s_lshl_b32 s60, s5, 8
    s_lshl_b32 s61, s6, 18
    s_add_u32 s62, s61, 65536
    s_waitcnt lgkmcnt(0)
    s_add_u32 m0, s69, 0
    s_nop 0
    buffer_load_dwordx4 v6, s[8:11], s61 offen lds
    buffer_load_dwordx4 v7, s[8:11], s61 offen offset:1024 lds
    buffer_load_dwordx4 v8, s[8:11], s61 offen offset:2048 lds
    buffer_load_dwordx4 v9, s[8:11], s61 offen offset:3072 lds
    s_add_u32 s61, s61, 128
    s_add_u32 m0, s69, 16384
    s_nop 0
    buffer_load_dwordx4 v6, s[8:11], s62 offen lds
    buffer_load_dwordx4 v7, s[8:11], s62 offen offset:1024 lds
    buffer_load_dwordx4 v8, s[8:11], s62 offen offset:2048 lds
    buffer_load_dwordx4 v9, s[8:11], s62 offen offset:3072 lds
    s_add_u32 s62, s62, 128
    s_add_u32 m0, s69, 32768
    s_nop 0
    buffer_load_dwordx4 v2, s[12:15], s60 offen nt lds
    buffer_load_dwordx4 v3, s[12:15], s60 offen offset:1024 nt lds
    buffer_load_dwordx4 v4, s[12:15], s60 offen offset:2048 nt lds
    buffer_load_dwordx4 v5, s[12:15], s60 offen offset:3072 nt lds
    s_add_u32 m0, s69, 49152
    s_nop 0
    buffer_load_dwordx4 v6, s[8:11], s61 offen lds
    buffer_load_dwordx4 v7, s[8:11], s61 offen offset:1024 lds
    buffer_load_dwordx4 v8, s[8:11], s61 offen offset:2048 lds
    buffer_load_dwordx4 v9, s[8:11], s61 offen offset:3072 lds
    s_add_u32 s61, s61, 128
    s_add_u32 m0, s69, 65536
    s_nop 0
    buffer_load_dwordx4 v2, s[16:19], s60 offen nt lds
    s_mov_b32 s22, 2359296
    s_mov_b32 s23, 0x20000
    s_mov_b32 s26, 4718592
    s_mov_b32 s27, 0x20000
    s_mov_b32 s50, 4718592
    s_mov_b32 s51, 0x20000
    s_mov_b32 s46, 256
    s_mov_b32 s47, 0x20000
    s_mov_b32 s30, 1990656
    buffer_load_dwordx4 v3, s[16:19], s60 offen offset:1024 nt lds
    s_mov_b32 s31, 0x20000
    s_mov_b32 s34, 1152
    s_mov_b32 s35, 0x20000
    s_mul_i32 s7, s5, 1081344
    s_add_u32 s36, s56, s7
    s_addc_u32 s37, s57, 0
    s_mov_b32 s38, 1081344
    s_mov_b32 s39, 0x20000
    s_add_u32 s40, s56, 35651584
    s_addc_u32 s41, s57, 0
    buffer_load_dwordx4 v4, s[16:19], s60 offen offset:2048 nt lds
    s_mov_b32 s42, 19136512
    s_mov_b32 s43, 0x20000
    s_cmp_eq_u32 s4, 0
    s_cselect_b64 s[86:87], 1, 0
    s_cselect_b32 s52, s48, s92
    s_cselect_b32 s53, s49, s93
    s_cselect_b32 s54, s50, 663552
    s_mov_b32 s55, 0x20000
    buffer_load_dwordx4 v5, s[16:19], s60 offen offset:3072 nt lds
    s_mul_i32 s63, s6, 147456
    s_sub_u32 s64, 2211840, s63
    s_lshl_b32 s67, s4, 11
    s_lshl_b32 s68, s4, 10
    s_lshl_b32 s75, s4, 13
    s_mov_b32 s65, s67
    s_mov_b32 s66, 0
    s_lshl_b32 s70, s6, 2
    s_lshl1_add_u32 s70, s3, s70
    s_lshl_b32 s70, s70, 15
    s_add_u32 s60, s60, 524288
    s_add_u32 m0, s69, 81920
    s_nop 0
    buffer_load_dwordx4 v6, s[8:11], s62 offen lds
    s_lshl_b32 s98, s73, 6
    s_add_u32 s71, s70, s98
    s_add_u32 s71, s71, 49152
    s_lshl_b32 s98, s73, 4
    s_add_u32 s70, s70, s98
    v_lshlrev_b32 v1, 4, v31
    v_mov_b32 v77, 1073741824
    v_cmp_eq_u32 vcc, 0, v0
    s_nop 1
    v_cndmask_b32_e64 v30, v77, 0, vcc
    buffer_load_dwordx4 v7, s[8:11], s62 offen offset:1024 lds
    v_lshlrev_b32 v103, 7, v31
    v_cmp_gt_u32 vcc, 9, v31
    s_nop 1
    v_cndmask_b32 v103, v77, v103, vcc
    s_lshl_b32 s98, s4, 5
    v_add_u32 v68, s98, v65
    v_mul_u32_u24 v68, 1152, v68
    v_add_u32 v10, v68, v66
    v_add_u32 v11, v68, v67
    v_add_u32 v11, 8192, v11
    buffer_load_dwordx4 v8, s[8:11], s62 offen offset:2048 lds
    v_add_u32 v12, v68, v66
    v_add_u32 v12, 16384, v12
    v_add_u32 v13, v68, v67
    v_add_u32 v13, 24576, v13
    s_sub_u32 s98, 15, s6
    s_cmp_eq_u32 s73, 0
    s_cselect_b32 s98, s6, s98
    s_lshl_b32 s98, s98, 7
    s_sub_u32 s98, s98, 16
    buffer_load_dwordx4 v9, s[8:11], s62 offen offset:3072 lds
    s_max_i32 s98, s98, 0
    s_lshl3_add_u32 s98, s3, s98
    v_add_u32 v68, s98, v65
    v_mul_u32_u24 v68, 1152, v68
    s_lshl_b32 s98, s3, 6
    v_xor_b32 v73, s98, v66
    v_add_u32 v96, v68, v73
    v_lshrrev_b32 v71, 1, v70
    v_xor_b32 v71, v71, v69
    v_lshlrev_b32 v71, 4, v71
    s_add_u32 s62, s62, 128
    s_add_u32 m0, s69, 98304
    s_nop 0
    buffer_load_dwordx4 v2, s[12:15], s60 offen nt lds
    v_lshl_add_u32 v71, v70, 7, v71
    v_xor_b32 v72, 64, v71
    s_lshl_b32 s98, s3, 13
    v_add_u32 v22, s98, v71
    v_add_u32 v23, s98, v72
    v_add_u32 v24, s67, v71
    v_add_u32 v25, s67, v72
    s_lshl_b32 s98, s3, 11
    s_add_u32 s98, s98, 8192
    buffer_load_dwordx4 v3, s[12:15], s60 offen offset:1024 nt lds
    v_add_u32 v100, s98, v71
    v_add_u32 v101, s98, v72
    v_bfe_u32 v73, v31, 2, 2
    v_and_b32 v74, 3, v31
    v_lshl_add_u32 v75, v69, 3, v73
    v_and_b32 v78, 1, v69
    v_lshl_add_u32 v77, v78, 2, v73
    v_lshlrev_b32 v77, 5, v77
    v_lshl_add_u32 v77, v74, 3, v77
    buffer_load_dwordx4 v4, s[12:15], s60 offen offset:2048 nt lds
    v_lshl_add_u32 v77, v75, 8, v77
    v_xor_b32 v14, 0, v77
    v_xor_b32 v14, s73, v14
    v_xor_b32 v15, 32, v77
    v_xor_b32 v15, s73, v15
    v_xor_b32 v16, 64, v77
    v_xor_b32 v16, s73, v16
    v_xor_b32 v17, 96, v77
    v_xor_b32 v17, s73, v17
    buffer_load_dwordx4 v5, s[12:15], s60 offen offset:3072 nt lds
    v_xor_b32 v18, 128, v77
    v_xor_b32 v19, 160, v77
    v_xor_b32 v20, 192, v77
    v_xor_b32 v21, 224, v77
    v_lshrrev_b32 v77, 1, v73
    v_lshl_add_u32 v77, v78, 1, v77
    v_lshlrev_b32 v77, 5, v77
    v_lshl_add_u32 v77, v74, 3, v77
    v_lshl_add_u32 v77, v75, 7, v77
    s_lshr_b32 s98, s73, 1
    s_add_u32 m0, s69, 114688
    s_nop 0
    buffer_load_dwordx4 v6, s[8:11], s61 offen lds
    v_xor_b32 v26, 0, v77
    v_xor_b32 v26, s98, v26
    v_xor_b32 v27, 32, v77
    v_xor_b32 v28, 64, v77
    v_xor_b32 v28, s98, v28
    v_xor_b32 v29, 96, v77
    v_and_b32 v73, 7, v0
    v_lshrrev_b32 v74, 3, v0
    s_mul_i32 s98, s6, 72
    buffer_load_dwordx4 v7, s[8:11], s61 offen offset:1024 lds
    v_add_u32 v74, s98, v74
    v_lshl_add_u32 v75, v73, 1, 0
    v_mul_u32_u24 v78, 52, v75
    v_lshrrev_b32 v78, 8, v78
    v_mul_u32_u24 v79, 5, v78
    v_sub_u32 v75, v75, v79
    v_add_u32 v78, 1, v78
    v_cmp_le_u32 vcc, 3, v78
    s_nop 1
    v_cndmask_b32_e64 v78, v78, 0, vcc
    buffer_load_dwordx4 v8, s[8:11], s61 offen offset:2048 lds
    v_mul_u32_u24 v78, 1152, v78
    v_lshl_add_u32 v75, v75, 3, v78
    v_mul_u32_u24 v78, 3456, v74
    v_add_u32 v75, v75, v78
    v_lshl_add_u32 v77, v73, 1, 1
    v_mul_u32_u24 v78, 52, v77
    v_lshrrev_b32 v78, 8, v78
    v_mul_u32_u24 v79, 5, v78
    v_sub_u32 v77, v77, v79
    buffer_load_dwordx4 v9, s[8:11], s61 offen offset:3072 lds
    s_add_u32 s61, s61, 128
    v_add_u32 v78, 1, v78
    v_cmp_le_u32 vcc, 3, v78
    s_nop 1
    v_cndmask_b32_e64 v78, v78, 0, vcc
    v_mul_u32_u24 v78, 1152, v78
    v_lshl_add_u32 v77, v77, 3, v78
    v_mul_u32_u24 v78, 3456, v74
    v_add_u32 v77, v77, v78
    v_lshlrev_b32 v78, 1, v74
    s_mul_i32 s98, s5, 36
    s_mov_b32 s99, 0
    buffer_load_dwordx2 v[80:81], v75, s[28:31], s98 offen
    buffer_load_dwordx2 v[82:83], v77, s[28:31], s98 offen
    buffer_load_ushort v92, v78, s[32:35], s99 offen
    s_add_u32 s98, s98, 110592
    s_add_u32 s99, s99, 64
    buffer_load_dwordx2 v[84:85], v75, s[28:31], s98 offen
    buffer_load_dwordx2 v[86:87], v77, s[28:31], s98 offen
    buffer_load_ushort v93, v78, s[32:35], s99 offen
    s_add_u32 s98, s98, 110592
    s_add_u32 s99, s99, 64
    s_cmp_eq_u32 s4, 0
    s_cselect_b32 s98, s98, 1073741824
    s_cselect_b32 s99, s99, 1073741824
    buffer_load_dwordx2 v[88:89], v75, s[28:31], s98 offen
    buffer_load_dwordx2 v[90:91], v77, s[28:31], s98 offen
    buffer_load_ushort v94, v78, s[32:35], s99 offen
    s_add_u32 s98, s98, 110592
    s_add_u32 s99, s99, 64
    v_bfe_u32 v78, v74, 1, 1
    v_bfe_u32 v79, v74, 3, 1
    v_lshl_add_u32 v78, v79, 1, v78
    v_lshlrev_b32 v78, 1, v78
    v_xor_b32 v78, v78, v73
    v_lshlrev_b32 v78, 4, v78
    v_lshl_add_u32 v95, v74, 7, v78
    v_cmp_eq_u32 s[92:93], 7, v73
    s_mul_i32 s7, s5, 73728
    s_add_u32 s7, s7, 62914560
    s_add_u32 s28, s56, s7
    s_addc_u32 s29, s57, 0
    s_mov_b32 s30, 73728
    s_add_u32 s32, s56, 66060288
    s_addc_u32 s33, s57, 0
    s_mov_b32 s34, 32768
    s_add_u32 s56, s56, 56623104
    s_addc_u32 s57, s57, 0
    s_mov_b32 s58, 5382144
    s_mov_b32 s59, 0x20000
    s_lshl_b32 s101, s6, 5
    s_add_u32 s101, s101, s5
    s_lshl_b32 s101, s101, 7
    v_mov_b32 v79, 0
    v_lshlrev_b32 v78, 2, v0
    v_cmp_gt_u32 vcc, 5, v0
    s_nop 1
    v_cndmask_b32 v78, v30, v78, vcc
    buffer_store_dword v79, v78, s[32:35], s101 offen sc1
    s_mov_b32 s74, 0x3e0293ee
    s_mov_b64 s[84:85], 0
    s_mov_b32 s83, 0
    s_lshl_b32 s95, s5, 3
    s_waitcnt vmcnt(26)
    s_barrier
    ds_read_b128 a[0:3], v22 offset:0
    ds_read_b64_tr_b16 v[40:41], v14 offset:32768
    ds_read_b64_tr_b16 v[42:43], v14 offset:33792
    s_waitcnt lgkmcnt(0)
    v_mfma_f32_16x16x32_bf16 v[128:131], v[40:43], a[0:3], 0
    s_add_u32 m0, s69, 131072
    ds_read_b128 a[4:7], v23 offset:0
    ds_read_b64_tr_b16 v[44:45], v14 offset:40960
    ds_read_b64_tr_b16 v[46:47], v14 offset:41984
    s_waitcnt lgkmcnt(0)
    v_mfma_f32_16x16x32_bf16 v[128:131], v[44:47], a[4:7], v[128:131]
    s_mul_i32 s77, s2, 9216
    ds_read_b128 a[8:11], v22 offset:2048
    ds_read_b128 a[12:15], v23 offset:2048
    s_waitcnt lgkmcnt(1)
    v_mfma_f32_16x16x32_bf16 v[132:135], v[40:43], a[8:11], 0
    s_mul_i32 s76, s4, 1152
    ds_read_b128 a[16:19], v22 offset:4096
    ds_read_b128 a[20:23], v23 offset:4096
    s_waitcnt lgkmcnt(2)
    v_mfma_f32_16x16x32_bf16 v[132:135], v[44:47], a[12:15], v[132:135]
    s_add_u32 s77, s77, s76
    ds_read_b128 a[24:27], v22 offset:6144
    ds_read_b128 a[28:31], v23 offset:6144
    s_waitcnt lgkmcnt(3)
    v_mfma_f32_16x16x32_bf16 v[136:139], v[40:43], a[16:19], 0
    s_mov_b32 s72, 0
    ds_read_b128 a[32:35], v22 offset:16384
    ds_read_b128 a[36:39], v23 offset:16384
    s_waitcnt lgkmcnt(4)
    v_mfma_f32_16x16x32_bf16 v[136:139], v[44:47], a[20:23], v[136:139]
    s_mul_i32 s76, s4, 1152
    ds_read_b128 a[40:43], v22 offset:18432
    ds_read_b128 a[44:47], v23 offset:18432
    s_waitcnt lgkmcnt(5)
    v_mfma_f32_16x16x32_bf16 v[140:143], v[40:43], a[24:27], 0
    s_lshr_b32 s7, s6, 1
    ds_read_b128 a[48:51], v22 offset:20480
    ds_read_b128 a[52:55], v23 offset:20480
    s_waitcnt lgkmcnt(6)
    v_mfma_f32_16x16x32_bf16 v[140:143], v[44:47], a[28:31], v[140:143]
    s_lshl2_add_u32 s7, s5, s7
    ds_read_b128 a[56:59], v22 offset:22528
    ds_read_b128 a[60:63], v23 offset:22528
    s_waitcnt lgkmcnt(7)
    v_mfma_f32_16x16x32_bf16 v[144:147], v[40:43], a[32:35], 0
    s_and_b32 s3, s6, 1
    buffer_load_dwordx4 v2, s[16:19], s60 offen nt lds
    s_waitcnt lgkmcnt(6)
    v_mfma_f32_16x16x32_bf16 v[144:147], v[44:47], a[36:39], v[144:147]
    s_mul_i32 s98, s7, 36864
    ds_read_b128 a[64:67], v22 offset:49152
    ds_read_b64_tr_b16 v[48:49], v15 offset:32768
    s_waitcnt lgkmcnt(7)
    v_mfma_f32_16x16x32_bf16 v[148:151], v[40:43], a[40:43], 0
    s_mul_i32 s99, s3, 576
    buffer_load_dwordx4 v3, s[16:19], s60 offen offset:1024 nt lds
    s_waitcnt lgkmcnt(6)
    v_mfma_f32_16x16x32_bf16 v[148:151], v[44:47], a[44:47], v[148:151]
    s_add_u32 s98, s98, s99
    ds_read_b64_tr_b16 v[50:51], v15 offset:33792
    ds_read_b128 a[68:71], v23 offset:49152
    s_waitcnt lgkmcnt(6)
    v_mfma_f32_16x16x32_bf16 v[152:155], v[40:43], a[48:51], 0
    s_mul_i32 s99, s3, 18432
    ds_read_b64_tr_b16 v[52:53], v15 offset:40960
    ds_read_b64_tr_b16 v[54:55], v15 offset:41984
    v_mfma_f32_16x16x32_bf16 v[152:155], v[44:47], a[52:55], v[152:155]
    s_waitcnt lgkmcnt(6)
    buffer_load_dwordx4 v4, s[16:19], s60 offen offset:2048 nt lds
    v_mfma_f32_16x16x32_bf16 v[156:159], v[40:43], a[56:59], 0
    ds_read_b128 a[72:75], v22 offset:51200
    ds_read_b64_tr_b16 v[56:57], v16 offset:32768
    v_mfma_f32_16x16x32_bf16 v[156:159], v[44:47], a[60:63], v[156:159]
    s_waitcnt lgkmcnt(5)
    ds_read_b64_tr_b16 v[58:59], v16 offset:33792
    ds_read_b64_tr_b16 v[60:61], v16 offset:40960
    v_mfma_f32_16x16x32_bf16 v[160:163], v[48:51], a[0:3], 0
    s_waitcnt lgkmcnt(4)
    ds_read_b64_tr_b16 v[62:63], v16 offset:41984
    ds_read_b64_tr_b16 v[40:41], v17 offset:32768
    v_mfma_f32_16x16x32_bf16 v[160:163], v[52:55], a[4:7], v[160:163]
    ds_read_b64_tr_b16 v[42:43], v17 offset:33792
    ds_read_b64_tr_b16 v[44:45], v17 offset:40960
    v_mfma_f32_16x16x32_bf16 v[164:167], v[48:51], a[8:11], 0
    buffer_load_dwordx4 v5, s[16:19], s60 offen offset:3072 nt lds
    v_mfma_f32_16x16x32_bf16 v[164:167], v[52:55], a[12:15], v[164:167]
    ds_read_b128 a[76:79], v23 offset:51200
    ds_read_b64_tr_b16 v[46:47], v17 offset:41984
    v_mfma_f32_16x16x32_bf16 v[168:171], v[48:51], a[16:19], 0
    v_add_u32 v14, 0x10000, v14
    v_add_u32 v15, 0x10000, v15
    v_mfma_f32_16x16x32_bf16 v[168:171], v[52:55], a[20:23], v[168:171]
    v_add_u32 v16, 0x10000, v16
    v_add_u32 v17, 0x10000, v17
    v_mfma_f32_16x16x32_bf16 v[172:175], v[48:51], a[24:27], 0
    v_mov_b32 v31, 1
    v_add_u32 v18, 0x10000, v18
    v_mfma_f32_16x16x32_bf16 v[172:175], v[52:55], a[28:31], v[172:175]
    v_add_u32 v19, 0x10000, v19
    v_add_u32 v20, 0x10000, v20
    v_mfma_f32_16x16x32_bf16 v[176:179], v[48:51], a[32:35], 0
    s_add_u32 m0, s69, 147456
    ds_read_b128 a[80:83], v22 offset:53248
    v_add_u32 v21, 0x10000, v21
    v_mfma_f32_16x16x32_bf16 v[176:179], v[52:55], a[36:39], v[176:179]
    s_add_u32 s60, s60, 524288
    buffer_load_dwordx4 v6, s[8:11], s62 offen lds
    v_mfma_f32_16x16x32_bf16 v[180:183], v[48:51], a[40:43], 0
    v_add_u32 v26, 0x10000, v26
    v_add_u32 v27, 0x10000, v27
    v_mfma_f32_16x16x32_bf16 v[180:183], v[52:55], a[44:47], v[180:183]
    v_add_u32 v28, 0x10000, v28
    v_add_u32 v29, 0x10000, v29
    v_mfma_f32_16x16x32_bf16 v[184:187], v[48:51], a[48:51], 0
    v_mfma_f32_16x16x32_bf16 v[184:187], v[52:55], a[52:55], v[184:187]
    ds_read_b128 a[84:87], v23 offset:53248
    v_mfma_f32_16x16x32_bf16 v[188:191], v[48:51], a[56:59], 0
    v_mfma_f32_16x16x32_bf16 v[188:191], v[52:55], a[60:63], v[188:191]
    s_waitcnt lgkmcnt(1)
    buffer_load_dwordx4 v7, s[8:11], s62 offen offset:1024 lds
    v_mfma_f32_16x16x32_bf16 v[192:195], v[56:59], a[0:3], 0
    v_mfma_f32_16x16x32_bf16 v[192:195], v[60:63], a[4:7], v[192:195]
    v_mfma_f32_16x16x32_bf16 v[196:199], v[56:59], a[8:11], 0
    v_mfma_f32_16x16x32_bf16 v[196:199], v[60:63], a[12:15], v[196:199]
    ds_read_b128 a[88:91], v22 offset:55296
    v_mfma_f32_16x16x32_bf16 v[200:203], v[56:59], a[16:19], 0
    v_mfma_f32_16x16x32_bf16 v[200:203], v[60:63], a[20:23], v[200:203]
    buffer_load_dwordx4 v8, s[8:11], s62 offen offset:2048 lds
    v_mfma_f32_16x16x32_bf16 v[204:207], v[56:59], a[24:27], 0
    v_mfma_f32_16x16x32_bf16 v[204:207], v[60:63], a[28:31], v[204:207]
    v_mfma_f32_16x16x32_bf16 v[208:211], v[56:59], a[32:35], 0
    ds_read_b128 a[92:95], v23 offset:55296
    v_mfma_f32_16x16x32_bf16 v[208:211], v[60:63], a[36:39], v[208:211]
    v_mfma_f32_16x16x32_bf16 v[212:215], v[56:59], a[40:43], 0
    v_mfma_f32_16x16x32_bf16 v[212:215], v[60:63], a[44:47], v[212:215]
    buffer_load_dwordx4 v9, s[8:11], s62 offen offset:3072 lds
    v_mfma_f32_16x16x32_bf16 v[216:219], v[56:59], a[48:51], 0
    v_mfma_f32_16x16x32_bf16 v[216:219], v[60:63], a[52:55], v[216:219]
    v_mfma_f32_16x16x32_bf16 v[220:223], v[56:59], a[56:59], 0
    v_mfma_f32_16x16x32_bf16 v[220:223], v[60:63], a[60:63], v[220:223]
    v_mfma_f32_16x16x32_bf16 v[224:227], v[40:43], a[0:3], 0
    v_mfma_f32_16x16x32_bf16 v[224:227], v[44:47], a[4:7], v[224:227]
    s_add_u32 s62, s62, 128
    v_mfma_f32_16x16x32_bf16 v[228:231], v[40:43], a[8:11], 0
    buffer_load_dword v104, v103, s[20:23], s77 offen
    v_mfma_f32_16x16x32_bf16 v[228:231], v[44:47], a[12:15], v[228:231]
    s_add_u32 s77, s77, 4608
    v_mfma_f32_16x16x32_bf16 v[232:235], v[40:43], a[16:19], 0
    v_mfma_f32_16x16x32_bf16 v[232:235], v[44:47], a[20:23], v[232:235]
    s_waitcnt vmcnt(27)
    s_barrier
    ds_read_b64_tr_b16 v[48:49], v14 offset:0
    v_mfma_f32_16x16x32_bf16 v[236:239], v[40:43], a[24:27], 0
    s_add_u32 m0, s69, 0
    ds_read_b64_tr_b16 v[50:51], v14 offset:1024
    ds_read_b64_tr_b16 v[52:53], v14 offset:8192
    v_mfma_f32_16x16x32_bf16 v[236:239], v[44:47], a[28:31], v[236:239]
    buffer_load_dwordx4 v2, s[12:15], s60 offen nt lds
    v_mfma_f32_16x16x32_bf16 v[240:243], v[40:43], a[32:35], 0
    ds_read_b64_tr_b16 v[54:55], v14 offset:9216
    ds_read_b64_tr_b16 v[56:57], v15 offset:0
    v_mfma_f32_16x16x32_bf16 v[240:243], v[44:47], a[36:39], v[240:243]
    ds_read_b64_tr_b16 v[58:59], v15 offset:1024
    ds_read_b64_tr_b16 v[60:61], v15 offset:8192
    v_mfma_f32_16x16x32_bf16 v[244:247], v[40:43], a[40:43], 0
    ds_read_b64_tr_b16 v[62:63], v15 offset:9216
    v_mfma_f32_16x16x32_bf16 v[244:247], v[44:47], a[44:47], v[244:247]
    v_mfma_f32_16x16x32_bf16 v[248:251], v[40:43], a[48:51], 0
    v_mfma_f32_16x16x32_bf16 v[248:251], v[44:47], a[52:55], v[248:251]
    buffer_load_dwordx4 v3, s[12:15], s60 offen offset:1024 nt lds
    v_mfma_f32_16x16x32_bf16 v[252:255], v[40:43], a[56:59], 0
    ds_read_b64_tr_b16 v[40:41], v16 offset:0
    ds_read_b64_tr_b16 v[42:43], v16 offset:1024
    v_mfma_f32_16x16x32_bf16 v[252:255], v[44:47], a[60:63], v[252:255]
    s_waitcnt lgkmcnt(2)
    ds_read_b64_tr_b16 v[44:45], v16 offset:8192
    ds_read_b64_tr_b16 v[46:47], v16 offset:9216
    v_mfma_f32_16x16x32_bf16 a[128:131], a[0:3], v[48:51], 0
    v_mfma_f32_16x16x32_bf16 a[128:131], a[4:7], v[52:55], a[128:131]
    v_add_u32 v22, 0x10000, v22
    v_mfma_f32_16x16x32_bf16 a[132:135], a[8:11], v[48:51], 0
    ds_read_b128 a[96:99], v22 offset:16384
    v_mfma_f32_16x16x32_bf16 a[132:135], a[12:15], v[52:55], a[132:135]
    v_mfma_f32_16x16x32_bf16 a[136:139], a[16:19], v[48:51], 0
    v_mfma_f32_16x16x32_bf16 a[136:139], a[20:23], v[52:55], a[136:139]
    buffer_load_dwordx4 v4, s[12:15], s60 offen offset:2048 nt lds
    v_mfma_f32_16x16x32_bf16 a[140:143], a[24:27], v[48:51], 0
    v_add_u32 v23, 0x10000, v23
    v_mfma_f32_16x16x32_bf16 a[140:143], a[28:31], v[52:55], a[140:143]
    ds_read_b128 a[100:103], v23 offset:16384
    v_mfma_f32_16x16x32_bf16 a[144:147], a[32:35], v[48:51], 0
    v_mfma_f32_16x16x32_bf16 a[144:147], a[36:39], v[52:55], a[144:147]
    v_mfma_f32_16x16x32_bf16 a[148:151], a[40:43], v[48:51], 0
    v_mfma_f32_16x16x32_bf16 a[148:151], a[44:47], v[52:55], a[148:151]
    v_mfma_f32_16x16x32_bf16 a[152:155], a[48:51], v[48:51], 0
    buffer_load_dwordx4 v5, s[12:15], s60 offen offset:3072 nt lds
    v_mfma_f32_16x16x32_bf16 a[152:155], a[52:55], v[52:55], a[152:155]
    ds_read_b128 a[104:107], v22 offset:18432
    v_mfma_f32_16x16x32_bf16 a[156:159], a[56:59], v[48:51], 0
    ds_read_b64_tr_b16 v[48:49], v17 offset:0
    ds_read_b64_tr_b16 v[50:51], v17 offset:1024
    v_mfma_f32_16x16x32_bf16 a[156:159], a[60:63], v[52:55], a[156:159]
    ds_read_b64_tr_b16 v[52:53], v17 offset:8192
    ds_read_b64_tr_b16 v[54:55], v17 offset:9216
    v_mfma_f32_16x16x32_bf16 a[160:163], a[0:3], v[56:59], 0
    v_mfma_f32_16x16x32_bf16 a[160:163], a[4:7], v[60:63], a[160:163]
    v_mfma_f32_16x16x32_bf16 a[164:167], a[8:11], v[56:59], 0
    ds_read_b128 a[108:111], v23 offset:18432
    v_mfma_f32_16x16x32_bf16 a[164:167], a[12:15], v[60:63], a[164:167]
    s_add_u32 m0, s69, 16384
    v_mfma_f32_16x16x32_bf16 a[168:171], a[16:19], v[56:59], 0
    buffer_load_dwordx4 v6, s[8:11], s61 offen lds
    v_mfma_f32_16x16x32_bf16 a[168:171], a[20:23], v[60:63], a[168:171]
    v_mfma_f32_16x16x32_bf16 a[172:175], a[24:27], v[56:59], 0
    v_mfma_f32_16x16x32_bf16 a[172:175], a[28:31], v[60:63], a[172:175]
    v_mfma_f32_16x16x32_bf16 a[176:179], a[32:35], v[56:59], 0
    ds_read_b128 a[112:115], v22 offset:20480
    v_mfma_f32_16x16x32_bf16 a[176:179], a[36:39], v[60:63], a[176:179]
    v_mfma_f32_16x16x32_bf16 a[180:183], a[40:43], v[56:59], 0
    v_mfma_f32_16x16x32_bf16 a[180:183], a[44:47], v[60:63], a[180:183]
    buffer_load_dwordx4 v7, s[8:11], s61 offen offset:1024 lds
    v_mfma_f32_16x16x32_bf16 a[184:187], a[48:51], v[56:59], 0
    v_mfma_f32_16x16x32_bf16 a[184:187], a[52:55], v[60:63], a[184:187]
    ds_read_b128 a[116:119], v23 offset:20480
    v_mfma_f32_16x16x32_bf16 a[188:191], a[56:59], v[56:59], 0
    v_mfma_f32_16x16x32_bf16 a[188:191], a[60:63], v[60:63], a[188:191]
    s_waitcnt lgkmcnt(1)
    v_mfma_f32_16x16x32_bf16 a[192:195], a[0:3], v[40:43], 0
    v_mfma_f32_16x16x32_bf16 a[192:195], a[4:7], v[44:47], a[192:195]
    v_mfma_f32_16x16x32_bf16 a[196:199], a[8:11], v[40:43], 0
    v_mfma_f32_16x16x32_bf16 a[196:199], a[12:15], v[44:47], a[196:199]
    buffer_load_dwordx4 v8, s[8:11], s61 offen offset:2048 lds
    v_mfma_f32_16x16x32_bf16 a[200:203], a[16:19], v[40:43], 0
    ds_read_b128 a[120:123], v22 offset:22528
    v_mfma_f32_16x16x32_bf16 a[200:203], a[20:23], v[44:47], a[200:203]
    v_mfma_f32_16x16x32_bf16 a[204:207], a[24:27], v[40:43], 0
    v_mfma_f32_16x16x32_bf16 a[204:207], a[28:31], v[44:47], a[204:207]
    v_mfma_f32_16x16x32_bf16 a[208:211], a[32:35], v[40:43], 0
    ds_read_b128 a[124:127], v23 offset:22528
    v_mfma_f32_16x16x32_bf16 a[208:211], a[36:39], v[44:47], a[208:211]
    v_mfma_f32_16x16x32_bf16 a[212:215], a[40:43], v[40:43], 0
    buffer_load_dwordx4 v9, s[8:11], s61 offen offset:3072 lds
    v_mfma_f32_16x16x32_bf16 a[212:215], a[44:47], v[44:47], a[212:215]
    v_mfma_f32_16x16x32_bf16 a[216:219], a[48:51], v[40:43], 0
    v_mfma_f32_16x16x32_bf16 a[216:219], a[52:55], v[44:47], a[216:219]
    v_mfma_f32_16x16x32_bf16 a[220:223], a[56:59], v[40:43], 0
    v_mfma_f32_16x16x32_bf16 a[220:223], a[60:63], v[44:47], a[220:223]
    v_mfma_f32_16x16x32_bf16 a[224:227], a[0:3], v[48:51], 0
    v_mfma_f32_16x16x32_bf16 a[224:227], a[4:7], v[52:55], a[224:227]
    s_add_u32 s61, s61, 128
    v_mfma_f32_16x16x32_bf16 a[228:231], a[8:11], v[48:51], 0
    v_mfma_f32_16x16x32_bf16 a[228:231], a[12:15], v[52:55], a[228:231]
    v_mfma_f32_16x16x32_bf16 a[232:235], a[16:19], v[48:51], 0
    v_mfma_f32_16x16x32_bf16 a[232:235], a[20:23], v[52:55], a[232:235]
    s_waitcnt vmcnt(27)
    s_barrier
    ds_read_b64_tr_b16 v[56:57], v14 offset:32768
    v_mfma_f32_16x16x32_bf16 a[236:239], a[24:27], v[48:51], 0
    s_add_u32 m0, s69, 32768
    ds_read_b64_tr_b16 v[58:59], v14 offset:33792
    ds_read_b64_tr_b16 v[60:61], v14 offset:40960
    v_mfma_f32_16x16x32_bf16 a[236:239], a[28:31], v[52:55], a[236:239]
    buffer_load_dwordx4 v2, s[16:19], s60 offen nt lds
    v_mfma_f32_16x16x32_bf16 a[240:243], a[32:35], v[48:51], 0
    ds_read_b64_tr_b16 v[62:63], v14 offset:41984
    ds_read_b64_tr_b16 v[40:41], v15 offset:32768
    v_mfma_f32_16x16x32_bf16 a[240:243], a[36:39], v[52:55], a[240:243]
    ds_read_b64_tr_b16 v[42:43], v15 offset:33792
    ds_read_b64_tr_b16 v[44:45], v15 offset:40960
    v_mfma_f32_16x16x32_bf16 a[244:247], a[40:43], v[48:51], 0
    ds_read_b64_tr_b16 v[46:47], v15 offset:41984
    v_add_u32 v14, 0x10000, v14
    v_mfma_f32_16x16x32_bf16 a[244:247], a[44:47], v[52:55], a[244:247]
    v_add_u32 v15, 0x10000, v15
    v_mfma_f32_16x16x32_bf16 a[248:251], a[48:51], v[48:51], 0
    v_mfma_f32_16x16x32_bf16 a[248:251], a[52:55], v[52:55], a[248:251]
    buffer_load_dwordx4 v3, s[16:19], s60 offen offset:1024 nt lds
    v_mfma_f32_16x16x32_bf16 a[252:255], a[56:59], v[48:51], 0
    ds_read_b64_tr_b16 v[48:49], v16 offset:32768
    ds_read_b64_tr_b16 v[50:51], v16 offset:33792
    v_mfma_f32_16x16x32_bf16 a[252:255], a[60:63], v[52:55], a[252:255]
    s_waitcnt lgkmcnt(2)
    ds_read_b64_tr_b16 v[52:53], v16 offset:40960
    ds_read_b64_tr_b16 v[54:55], v16 offset:41984
    v_mfma_f32_16x16x32_bf16 v[128:131], v[56:59], a[64:67], v[128:131]
    v_add_u32 v16, 0x10000, v16
    v_mfma_f32_16x16x32_bf16 v[128:131], v[60:63], a[68:71], v[128:131]
    v_mfma_f32_16x16x32_bf16 v[132:135], v[56:59], a[72:75], v[132:135]
    ds_read_b128 a[0:3], v22 offset:49152
    v_mfma_f32_16x16x32_bf16 v[132:135], v[60:63], a[76:79], v[132:135]
    v_mfma_f32_16x16x32_bf16 v[136:139], v[56:59], a[80:83], v[136:139]
    v_mfma_f32_16x16x32_bf16 v[136:139], v[60:63], a[84:87], v[136:139]
    buffer_load_dwordx4 v4, s[16:19], s60 offen offset:2048 nt lds
    v_mfma_f32_16x16x32_bf16 v[140:143], v[56:59], a[88:91], v[140:143]
    v_mfma_f32_16x16x32_bf16 v[140:143], v[60:63], a[92:95], v[140:143]
    ds_read_b128 a[4:7], v23 offset:49152
    v_mfma_f32_16x16x32_bf16 v[144:147], v[56:59], a[96:99], v[144:147]
    v_mfma_f32_16x16x32_bf16 v[144:147], v[60:63], a[100:103], v[144:147]
    v_mfma_f32_16x16x32_bf16 v[148:151], v[56:59], a[104:107], v[148:151]
    v_mfma_f32_16x16x32_bf16 v[148:151], v[60:63], a[108:111], v[148:151]
    v_mfma_f32_16x16x32_bf16 v[152:155], v[56:59], a[112:115], v[152:155]
    buffer_load_dwordx4 v5, s[16:19], s60 offen offset:3072 nt lds
    v_mfma_f32_16x16x32_bf16 v[152:155], v[60:63], a[116:119], v[152:155]
    ds_read_b128 a[8:11], v22 offset:51200
    v_mfma_f32_16x16x32_bf16 v[156:159], v[56:59], a[120:123], v[156:159]
    ds_read_b64_tr_b16 v[56:57], v17 offset:32768
    ds_read_b64_tr_b16 v[58:59], v17 offset:33792
    v_mfma_f32_16x16x32_bf16 v[156:159], v[60:63], a[124:127], v[156:159]
    ds_read_b64_tr_b16 v[60:61], v17 offset:40960
    ds_read_b64_tr_b16 v[62:63], v17 offset:41984
    v_mfma_f32_16x16x32_bf16 v[160:163], v[40:43], a[64:67], v[160:163]
    v_add_u32 v17, 0x10000, v17
    v_mfma_f32_16x16x32_bf16 v[160:163], v[44:47], a[68:71], v[160:163]
    v_mfma_f32_16x16x32_bf16 v[164:167], v[40:43], a[72:75], v[164:167]
    ds_read_b128 a[12:15], v23 offset:51200
    v_mfma_f32_16x16x32_bf16 v[164:167], v[44:47], a[76:79], v[164:167]
    s_add_u32 m0, s69, 49152
    v_mfma_f32_16x16x32_bf16 v[168:171], v[40:43], a[80:83], v[168:171]
    s_add_u32 s60, s60, 524288
    buffer_load_dwordx4 v6, s[8:11], s62 offen lds
    v_mfma_f32_16x16x32_bf16 v[168:171], v[44:47], a[84:87], v[168:171]
    v_mfma_f32_16x16x32_bf16 v[172:175], v[40:43], a[88:91], v[172:175]
    v_mfma_f32_16x16x32_bf16 v[172:175], v[44:47], a[92:95], v[172:175]
    v_mfma_f32_16x16x32_bf16 v[176:179], v[40:43], a[96:99], v[176:179]
    ds_read_b128 a[16:19], v22 offset:53248
    v_mfma_f32_16x16x32_bf16 v[176:179], v[44:47], a[100:103], v[176:179]
    v_mfma_f32_16x16x32_bf16 v[180:183], v[40:43], a[104:107], v[180:183]
    v_mfma_f32_16x16x32_bf16 v[180:183], v[44:47], a[108:111], v[180:183]
    buffer_load_dwordx4 v7, s[8:11], s62 offen offset:1024 lds
    v_mfma_f32_16x16x32_bf16 v[184:187], v[40:43], a[112:115], v[184:187]
    v_mfma_f32_16x16x32_bf16 v[184:187], v[44:47], a[116:119], v[184:187]
    ds_read_b128 a[20:23], v23 offset:53248
    v_mfma_f32_16x16x32_bf16 v[188:191], v[40:43], a[120:123], v[188:191]
    v_mfma_f32_16x16x32_bf16 v[188:191], v[44:47], a[124:127], v[188:191]
    s_waitcnt lgkmcnt(1)
    v_mfma_f32_16x16x32_bf16 v[192:195], v[48:51], a[64:67], v[192:195]
    v_mfma_f32_16x16x32_bf16 v[192:195], v[52:55], a[68:71], v[192:195]
    v_mfma_f32_16x16x32_bf16 v[196:199], v[48:51], a[72:75], v[196:199]
    v_mfma_f32_16x16x32_bf16 v[196:199], v[52:55], a[76:79], v[196:199]
    buffer_load_dwordx4 v8, s[8:11], s62 offen offset:2048 lds
    v_mfma_f32_16x16x32_bf16 v[200:203], v[48:51], a[80:83], v[200:203]
    ds_read_b128 a[24:27], v22 offset:55296
    v_mfma_f32_16x16x32_bf16 v[200:203], v[52:55], a[84:87], v[200:203]
    v_mfma_f32_16x16x32_bf16 v[204:207], v[48:51], a[88:91], v[204:207]
    v_mfma_f32_16x16x32_bf16 v[204:207], v[52:55], a[92:95], v[204:207]
    v_mfma_f32_16x16x32_bf16 v[208:211], v[48:51], a[96:99], v[208:211]
    ds_read_b128 a[28:31], v23 offset:55296
    v_mfma_f32_16x16x32_bf16 v[208:211], v[52:55], a[100:103], v[208:211]
    v_mfma_f32_16x16x32_bf16 v[212:215], v[48:51], a[104:107], v[212:215]
    buffer_load_dwordx4 v9, s[8:11], s62 offen offset:3072 lds
    v_mfma_f32_16x16x32_bf16 v[212:215], v[52:55], a[108:111], v[212:215]
    v_mfma_f32_16x16x32_bf16 v[216:219], v[48:51], a[112:115], v[216:219]
    v_mfma_f32_16x16x32_bf16 v[216:219], v[52:55], a[116:119], v[216:219]
    v_mfma_f32_16x16x32_bf16 v[220:223], v[48:51], a[120:123], v[220:223]
    v_mfma_f32_16x16x32_bf16 v[220:223], v[52:55], a[124:127], v[220:223]
    v_mfma_f32_16x16x32_bf16 v[224:227], v[56:59], a[64:67], v[224:227]
    v_mfma_f32_16x16x32_bf16 v[224:227], v[60:63], a[68:71], v[224:227]
    s_add_u32 s62, s62, 128
    v_mfma_f32_16x16x32_bf16 v[228:231], v[56:59], a[72:75], v[228:231]
    v_mfma_f32_16x16x32_bf16 v[228:231], v[60:63], a[76:79], v[228:231]
    v_mfma_f32_16x16x32_bf16 v[232:235], v[56:59], a[80:83], v[232:235]
    v_mfma_f32_16x16x32_bf16 v[232:235], v[60:63], a[84:87], v[232:235]
    s_waitcnt vmcnt(17)
    s_barrier
    v_cndmask_b32 v82, v82, v92, s[92:93]
    v_mfma_f32_16x16x32_bf16 v[236:239], v[56:59], a[88:91], v[236:239]
    s_add_u32 m0, s69, 65536
    v_cndmask_b32_e64 v83, v83, 0, s[92:93]
    v_cndmask_b32 v86, v86, v93, s[92:93]
    v_mfma_f32_16x16x32_bf16 v[236:239], v[60:63], a[92:95], v[236:239]
    buffer_store_dwordx4 v[80:83], v95, s[28:31], s72 offen sc1
    v_mfma_f32_16x16x32_bf16 v[240:243], v[56:59], a[96:99], v[240:243]
    s_mov_b32 s72, 4096
    v_cndmask_b32_e64 v87, v87, 0, s[92:93]
    v_cndmask_b32 v90, v90, v94, s[92:93]
    v_mfma_f32_16x16x32_bf16 v[240:243], v[60:63], a[100:103], v[240:243]
    buffer_store_dwordx4 v[84:87], v95, s[28:31], s72 offen sc1
    v_mfma_f32_16x16x32_bf16 v[244:247], v[56:59], a[104:107], v[244:247]
    s_mov_b32 s72, 8192
    s_cmp_eq_u32 s4, 0
    s_cselect_b32 s72, s72, 1073741824
    v_mfma_f32_16x16x32_bf16 v[244:247], v[60:63], a[108:111], v[244:247]
    v_cndmask_b32_e64 v91, v91, 0, s[92:93]
    ds_read_b64_tr_b16 v[40:41], v14 offset:0
    v_mfma_f32_16x16x32_bf16 v[248:251], v[56:59], a[112:115], v[248:251]
    buffer_store_dwordx4 v[88:91], v95, s[28:31], s72 offen sc1
    v_mfma_f32_16x16x32_bf16 v[248:251], v[60:63], a[116:119], v[248:251]
    buffer_load_dwordx4 v2, s[12:15], s60 offen nt lds
    v_mfma_f32_16x16x32_bf16 v[252:255], v[56:59], a[120:123], v[252:255]
    ds_read_b64_tr_b16 v[42:43], v14 offset:1024
    ds_read_b64_tr_b16 v[44:45], v14 offset:8192
    v_mfma_f32_16x16x32_bf16 v[252:255], v[60:63], a[124:127], v[252:255]
    s_waitcnt lgkmcnt(1)
    ds_read_b64_tr_b16 v[46:47], v14 offset:9216
    ds_read_b64_tr_b16 v[48:49], v15 offset:0
    v_mfma_f32_16x16x32_bf16 a[128:131], a[64:67], v[40:43], a[128:131]
    s_waitcnt lgkmcnt(1)
    buffer_load_dword v105, v103, s[20:23], s77 offen
    v_mfma_f32_16x16x32_bf16 a[128:131], a[68:71], v[44:47], a[128:131]
    s_mul_i32 s77, s2, 18432
    buffer_load_dwordx4 v3, s[12:15], s60 offen offset:1024 nt lds
    v_mfma_f32_16x16x32_bf16 a[132:135], a[72:75], v[40:43], a[132:135]
    s_add_u32 s77, s77, s76
    v_add_u32 v22, 0x10000, v22
    ds_read_b128 a[32:35], v22 offset:16384
    v_mfma_f32_16x16x32_bf16 a[132:135], a[76:79], v[44:47], a[132:135]
    s_mov_b32 s76, 0
    ds_read_b64_tr_b16 v[50:51], v15 offset:1024
    ds_read_b64_tr_b16 v[52:53], v15 offset:8192
    v_mfma_f32_16x16x32_bf16 a[136:139], a[80:83], v[40:43], a[136:139]
    ds_read_b64_tr_b16 v[54:55], v15 offset:9216
    ds_read_b64_tr_b16 v[56:57], v16 offset:0
    v_mfma_f32_16x16x32_bf16 a[136:139], a[84:87], v[44:47], a[136:139]
    buffer_load_dwordx4 v4, s[12:15], s60 offen offset:2048 nt lds
    v_mfma_f32_16x16x32_bf16 a[140:143], a[88:91], v[40:43], a[140:143]
    v_add_u32 v23, 0x10000, v23
    ds_read_b64_tr_b16 v[58:59], v16 offset:1024
    v_mfma_f32_16x16x32_bf16 a[140:143], a[92:95], v[44:47], a[140:143]
    ds_read_b128 a[36:39], v23 offset:16384
    ds_read_b64_tr_b16 v[60:61], v16 offset:8192
    v_mfma_f32_16x16x32_bf16 a[144:147], a[96:99], v[40:43], a[144:147]
    ds_read_b64_tr_b16 v[62:63], v16 offset:9216
    v_add_u32 v14, 0xfffe0000, v14
    v_mfma_f32_16x16x32_bf16 a[144:147], a[100:103], v[44:47], a[144:147]
    v_add_u32 v15, 0xfffe0000, v15
    v_add_u32 v16, 0xfffe0000, v16
    v_mfma_f32_16x16x32_bf16 a[148:151], a[104:107], v[40:43], a[148:151]
    v_mfma_f32_16x16x32_bf16 a[148:151], a[108:111], v[44:47], a[148:151]
    v_mfma_f32_16x16x32_bf16 a[152:155], a[112:115], v[40:43], a[152:155]
    buffer_load_dwordx4 v5, s[12:15], s60 offen offset:3072 nt lds
    v_mfma_f32_16x16x32_bf16 a[152:155], a[116:119], v[44:47], a[152:155]
    ds_read_b128 a[40:43], v22 offset:18432
    v_mfma_f32_16x16x32_bf16 a[156:159], a[120:123], v[40:43], a[156:159]
    ds_read_b64_tr_b16 v[40:41], v17 offset:0
    ds_read_b64_tr_b16 v[42:43], v17 offset:1024
    v_mfma_f32_16x16x32_bf16 a[156:159], a[124:127], v[44:47], a[156:159]
    s_waitcnt lgkmcnt(3)
    ds_read_b64_tr_b16 v[44:45], v17 offset:8192
    ds_read_b64_tr_b16 v[46:47], v17 offset:9216
    v_mfma_f32_16x16x32_bf16 a[160:163], a[64:67], v[48:51], a[160:163]
    v_add_u32 v17, 0xfffe0000, v17
    v_mfma_f32_16x16x32_bf16 a[160:163], a[68:71], v[52:55], a[160:163]
    v_mfma_f32_16x16x32_bf16 a[164:167], a[72:75], v[48:51], a[164:167]
    ds_read_b128 a[44:47], v23 offset:18432
    v_mfma_f32_16x16x32_bf16 a[164:167], a[76:79], v[52:55], a[164:167]
    s_add_u32 m0, s69, 81920
    v_mfma_f32_16x16x32_bf16 a[168:171], a[80:83], v[48:51], a[168:171]
    buffer_load_dwordx4 v6, s[8:11], s61 offen lds
    v_mfma_f32_16x16x32_bf16 a[168:171], a[84:87], v[52:55], a[168:171]
    v_mfma_f32_16x16x32_bf16 a[172:175], a[88:91], v[48:51], a[172:175]
    v_mfma_f32_16x16x32_bf16 a[172:175], a[92:95], v[52:55], a[172:175]
    v_mfma_f32_16x16x32_bf16 a[176:179], a[96:99], v[48:51], a[176:179]
    ds_read_b128 a[48:51], v22 offset:20480
    v_mfma_f32_16x16x32_bf16 a[176:179], a[100:103], v[52:55], a[176:179]
    v_mfma_f32_16x16x32_bf16 a[180:183], a[104:107], v[48:51], a[180:183]
    v_mfma_f32_16x16x32_bf16 a[180:183], a[108:111], v[52:55], a[180:183]
    buffer_load_dwordx4 v7, s[8:11], s61 offen offset:1024 lds
    v_mfma_f32_16x16x32_bf16 a[184:187], a[112:115], v[48:51], a[184:187]
    v_mfma_f32_16x16x32_bf16 a[184:187], a[116:119], v[52:55], a[184:187]
    ds_read_b128 a[52:55], v23 offset:20480
    v_mfma_f32_16x16x32_bf16 a[188:191], a[120:123], v[48:51], a[188:191]
    v_mfma_f32_16x16x32_bf16 a[188:191], a[124:127], v[52:55], a[188:191]
    v_mfma_f32_16x16x32_bf16 a[192:195], a[64:67], v[56:59], a[192:195]
    v_mfma_f32_16x16x32_bf16 a[192:195], a[68:71], v[60:63], a[192:195]
    v_mfma_f32_16x16x32_bf16 a[196:199], a[72:75], v[56:59], a[196:199]
    v_mfma_f32_16x16x32_bf16 a[196:199], a[76:79], v[60:63], a[196:199]
    buffer_load_dwordx4 v8, s[8:11], s61 offen offset:2048 lds
    v_mfma_f32_16x16x32_bf16 a[200:203], a[80:83], v[56:59], a[200:203]
    ds_read_b128 a[56:59], v22 offset:22528
    v_mfma_f32_16x16x32_bf16 a[200:203], a[84:87], v[60:63], a[200:203]
    v_mfma_f32_16x16x32_bf16 a[204:207], a[88:91], v[56:59], a[204:207]
    v_mfma_f32_16x16x32_bf16 a[204:207], a[92:95], v[60:63], a[204:207]
    v_mfma_f32_16x16x32_bf16 a[208:211], a[96:99], v[56:59], a[208:211]
    ds_read_b128 a[60:63], v23 offset:22528
    v_mfma_f32_16x16x32_bf16 a[208:211], a[100:103], v[60:63], a[208:211]
    v_mfma_f32_16x16x32_bf16 a[212:215], a[104:107], v[56:59], a[212:215]
    buffer_load_dwordx4 v9, s[8:11], s61 offen offset:3072 lds
    v_mfma_f32_16x16x32_bf16 a[212:215], a[108:111], v[60:63], a[212:215]
    v_mfma_f32_16x16x32_bf16 a[216:219], a[112:115], v[56:59], a[216:219]
    v_mfma_f32_16x16x32_bf16 a[216:219], a[116:119], v[60:63], a[216:219]
    v_mfma_f32_16x16x32_bf16 a[220:223], a[120:123], v[56:59], a[220:223]
    v_mfma_f32_16x16x32_bf16 a[220:223], a[124:127], v[60:63], a[220:223]
    s_waitcnt lgkmcnt(0)
    v_mfma_f32_16x16x32_bf16 a[224:227], a[64:67], v[40:43], a[224:227]
    v_mfma_f32_16x16x32_bf16 a[224:227], a[68:71], v[44:47], a[224:227]
    s_add_u32 s61, s61, 128
    v_mfma_f32_16x16x32_bf16 a[228:231], a[72:75], v[40:43], a[228:231]
    v_mfma_f32_16x16x32_bf16 a[228:231], a[76:79], v[44:47], a[228:231]
    v_mfma_f32_16x16x32_bf16 a[232:235], a[80:83], v[40:43], a[232:235]
    v_mfma_f32_16x16x32_bf16 a[232:235], a[84:87], v[44:47], a[232:235]
    s_waitcnt vmcnt(20)
    s_barrier
    ds_read_b64_tr_b16 v[48:49], v14 offset:0
    v_mfma_f32_16x16x32_bf16 a[236:239], a[88:91], v[40:43], a[236:239]
    s_add_u32 m0, s69, 98304
    ds_read_b64_tr_b16 v[50:51], v14 offset:1024
    ds_read_b64_tr_b16 v[52:53], v14 offset:8192
    v_mfma_f32_16x16x32_bf16 a[236:239], a[92:95], v[44:47], a[236:239]
    buffer_load_dwordx4 v2, s[16:19], s60 offen nt lds
    v_mfma_f32_16x16x32_bf16 a[240:243], a[96:99], v[40:43], a[240:243]
    ds_read_b64_tr_b16 v[54:55], v14 offset:9216
    ds_read_b64_tr_b16 v[56:57], v15 offset:0
    v_mfma_f32_16x16x32_bf16 a[240:243], a[100:103], v[44:47], a[240:243]
    ds_read_b64_tr_b16 v[58:59], v15 offset:1024
    ds_read_b64_tr_b16 v[60:61], v15 offset:8192
    v_mfma_f32_16x16x32_bf16 a[244:247], a[104:107], v[40:43], a[244:247]
    ds_read_b64_tr_b16 v[62:63], v15 offset:9216
    v_mfma_f32_16x16x32_bf16 a[244:247], a[108:111], v[44:47], a[244:247]
    v_mfma_f32_16x16x32_bf16 a[248:251], a[112:115], v[40:43], a[248:251]
    v_mfma_f32_16x16x32_bf16 a[248:251], a[116:119], v[44:47], a[248:251]
    buffer_load_dwordx4 v3, s[16:19], s60 offen offset:1024 nt lds
    v_mfma_f32_16x16x32_bf16 a[252:255], a[120:123], v[40:43], a[252:255]
    ds_read_b64_tr_b16 v[40:41], v16 offset:0
    ds_read_b64_tr_b16 v[42:43], v16 offset:1024
    v_mfma_f32_16x16x32_bf16 a[252:255], a[124:127], v[44:47], a[252:255]
    s_waitcnt lgkmcnt(2)
    ds_read_b64_tr_b16 v[44:45], v16 offset:8192
    ds_read_b64_tr_b16 v[46:47], v16 offset:9216
    v_mfma_f32_16x16x32_bf16 v[128:131], v[48:51], a[0:3], v[128:131]
    v_mfma_f32_16x16x32_bf16 v[128:131], v[52:55], a[4:7], v[128:131]
    v_add_u32 v22, 0xfffe0000, v22
    v_mfma_f32_16x16x32_bf16 v[132:135], v[48:51], a[8:11], v[132:135]
    ds_read_b128 a[64:67], v22 offset:16384
    v_mfma_f32_16x16x32_bf16 v[132:135], v[52:55], a[12:15], v[132:135]
    v_mfma_f32_16x16x32_bf16 v[136:139], v[48:51], a[16:19], v[136:139]
    v_mfma_f32_16x16x32_bf16 v[136:139], v[52:55], a[20:23], v[136:139]
    buffer_load_dwordx4 v4, s[16:19], s60 offen offset:2048 nt lds
    v_mfma_f32_16x16x32_bf16 v[140:143], v[48:51], a[24:27], v[140:143]
    v_add_u32 v23, 0xfffe0000, v23
    v_mfma_f32_16x16x32_bf16 v[140:143], v[52:55], a[28:31], v[140:143]
    ds_read_b128 a[68:71], v23 offset:16384
    v_mfma_f32_16x16x32_bf16 v[144:147], v[48:51], a[32:35], v[144:147]
    v_mfma_f32_16x16x32_bf16 v[144:147], v[52:55], a[36:39], v[144:147]
    v_mfma_f32_16x16x32_bf16 v[148:151], v[48:51], a[40:43], v[148:151]
    v_mfma_f32_16x16x32_bf16 v[148:151], v[52:55], a[44:47], v[148:151]
    v_mfma_f32_16x16x32_bf16 v[152:155], v[48:51], a[48:51], v[152:155]
    buffer_load_dwordx4 v5, s[16:19], s60 offen offset:3072 nt lds
    v_mfma_f32_16x16x32_bf16 v[152:155], v[52:55], a[52:55], v[152:155]
    ds_read_b128 a[72:75], v22 offset:18432
    v_mfma_f32_16x16x32_bf16 v[156:159], v[48:51], a[56:59], v[156:159]
    ds_read_b64_tr_b16 v[48:49], v17 offset:0
    ds_read_b64_tr_b16 v[50:51], v17 offset:1024
    v_mfma_f32_16x16x32_bf16 v[156:159], v[52:55], a[60:63], v[156:159]
    ds_read_b64_tr_b16 v[52:53], v17 offset:8192
    ds_read_b64_tr_b16 v[54:55], v17 offset:9216
    v_mfma_f32_16x16x32_bf16 v[160:163], v[56:59], a[0:3], v[160:163]
    v_mfma_f32_16x16x32_bf16 v[160:163], v[60:63], a[4:7], v[160:163]
    v_mfma_f32_16x16x32_bf16 v[164:167], v[56:59], a[8:11], v[164:167]
    ds_read_b128 a[76:79], v23 offset:18432
    v_mfma_f32_16x16x32_bf16 v[164:167], v[60:63], a[12:15], v[164:167]
    s_add_u32 m0, s69, 114688
    v_mfma_f32_16x16x32_bf16 v[168:171], v[56:59], a[16:19], v[168:171]
    s_add_u32 s60, s60, 524288
    buffer_load_dwordx4 v6, s[8:11], s62 offen lds
    v_mfma_f32_16x16x32_bf16 v[168:171], v[60:63], a[20:23], v[168:171]
    v_mfma_f32_16x16x32_bf16 v[172:175], v[56:59], a[24:27], v[172:175]
    v_mfma_f32_16x16x32_bf16 v[172:175], v[60:63], a[28:31], v[172:175]
    v_mfma_f32_16x16x32_bf16 v[176:179], v[56:59], a[32:35], v[176:179]
    ds_read_b128 a[80:83], v22 offset:20480
    v_mfma_f32_16x16x32_bf16 v[176:179], v[60:63], a[36:39], v[176:179]
    v_mfma_f32_16x16x32_bf16 v[180:183], v[56:59], a[40:43], v[180:183]
    v_mfma_f32_16x16x32_bf16 v[180:183], v[60:63], a[44:47], v[180:183]
    buffer_load_dwordx4 v7, s[8:11], s62 offen offset:1024 lds
    v_mfma_f32_16x16x32_bf16 v[184:187], v[56:59], a[48:51], v[184:187]
    v_mfma_f32_16x16x32_bf16 v[184:187], v[60:63], a[52:55], v[184:187]
    ds_read_b128 a[84:87], v23 offset:20480
    v_mfma_f32_16x16x32_bf16 v[188:191], v[56:59], a[56:59], v[188:191]
    v_mfma_f32_16x16x32_bf16 v[188:191], v[60:63], a[60:63], v[188:191]
    s_waitcnt lgkmcnt(1)
    v_mfma_f32_16x16x32_bf16 v[192:195], v[40:43], a[0:3], v[192:195]
    v_mfma_f32_16x16x32_bf16 v[192:195], v[44:47], a[4:7], v[192:195]
    v_mfma_f32_16x16x32_bf16 v[196:199], v[40:43], a[8:11], v[196:199]
    v_mfma_f32_16x16x32_bf16 v[196:199], v[44:47], a[12:15], v[196:199]
    buffer_load_dwordx4 v8, s[8:11], s62 offen offset:2048 lds
    v_mfma_f32_16x16x32_bf16 v[200:203], v[40:43], a[16:19], v[200:203]
    ds_read_b128 a[88:91], v22 offset:22528
    v_mfma_f32_16x16x32_bf16 v[200:203], v[44:47], a[20:23], v[200:203]
    v_mfma_f32_16x16x32_bf16 v[204:207], v[40:43], a[24:27], v[204:207]
    v_mfma_f32_16x16x32_bf16 v[204:207], v[44:47], a[28:31], v[204:207]
    v_mfma_f32_16x16x32_bf16 v[208:211], v[40:43], a[32:35], v[208:211]
    ds_read_b128 a[92:95], v23 offset:22528
    v_mfma_f32_16x16x32_bf16 v[208:211], v[44:47], a[36:39], v[208:211]
    v_mfma_f32_16x16x32_bf16 v[212:215], v[40:43], a[40:43], v[212:215]
    buffer_load_dwordx4 v9, s[8:11], s62 offen offset:3072 lds
    v_mfma_f32_16x16x32_bf16 v[212:215], v[44:47], a[44:47], v[212:215]
    v_mfma_f32_16x16x32_bf16 v[216:219], v[40:43], a[48:51], v[216:219]
    v_mfma_f32_16x16x32_bf16 v[216:219], v[44:47], a[52:55], v[216:219]
    v_mfma_f32_16x16x32_bf16 v[220:223], v[40:43], a[56:59], v[220:223]
    v_mfma_f32_16x16x32_bf16 v[220:223], v[44:47], a[60:63], v[220:223]
    v_mfma_f32_16x16x32_bf16 v[224:227], v[48:51], a[0:3], v[224:227]
    v_mfma_f32_16x16x32_bf16 v[224:227], v[52:55], a[4:7], v[224:227]
    s_add_u32 s62, s62, 128
    v_mfma_f32_16x16x32_bf16 v[228:231], v[48:51], a[8:11], v[228:231]
    v_mfma_f32_16x16x32_bf16 v[228:231], v[52:55], a[12:15], v[228:231]
    v_mfma_f32_16x16x32_bf16 v[232:235], v[48:51], a[16:19], v[232:235]
    v_mfma_f32_16x16x32_bf16 v[232:235], v[52:55], a[20:23], v[232:235]
    s_waitcnt vmcnt(20)
    s_barrier
    ds_read_b64_tr_b16 v[56:57], v14 offset:32768
    v_mfma_f32_16x16x32_bf16 v[236:239], v[48:51], a[24:27], v[236:239]
    s_add_u32 m0, s69, 131072
    ds_read_b64_tr_b16 v[58:59], v14 offset:33792
    ds_read_b64_tr_b16 v[60:61], v14 offset:40960
    v_mfma_f32_16x16x32_bf16 v[236:239], v[52:55], a[28:31], v[236:239]
    buffer_load_dwordx4 v2, s[12:15], s60 offen nt lds
    v_mfma_f32_16x16x32_bf16 v[240:243], v[48:51], a[32:35], v[240:243]
    ds_read_b64_tr_b16 v[62:63], v14 offset:41984
    ds_read_b64_tr_b16 v[40:41], v15 offset:32768
    v_mfma_f32_16x16x32_bf16 v[240:243], v[52:55], a[36:39], v[240:243]
    ds_read_b64_tr_b16 v[42:43], v15 offset:33792
    ds_read_b64_tr_b16 v[44:45], v15 offset:40960
    v_mfma_f32_16x16x32_bf16 v[244:247], v[48:51], a[40:43], v[244:247]
    ds_read_b64_tr_b16 v[46:47], v15 offset:41984
    v_add_u32 v14, 0x10000, v14
    v_mfma_f32_16x16x32_bf16 v[244:247], v[52:55], a[44:47], v[244:247]
    v_add_u32 v15, 0x10000, v15
    v_mfma_f32_16x16x32_bf16 v[248:251], v[48:51], a[48:51], v[248:251]
    v_mfma_f32_16x16x32_bf16 v[248:251], v[52:55], a[52:55], v[248:251]
    buffer_load_dwordx4 v3, s[12:15], s60 offen offset:1024 nt lds
    v_mfma_f32_16x16x32_bf16 v[252:255], v[48:51], a[56:59], v[252:255]
    ds_read_b64_tr_b16 v[48:49], v16 offset:32768
    ds_read_b64_tr_b16 v[50:51], v16 offset:33792
    v_mfma_f32_16x16x32_bf16 v[252:255], v[52:55], a[60:63], v[252:255]
    s_waitcnt lgkmcnt(2)
    ds_read_b64_tr_b16 v[52:53], v16 offset:40960
    ds_read_b64_tr_b16 v[54:55], v16 offset:41984
    v_mfma_f32_16x16x32_bf16 a[128:131], a[0:3], v[56:59], a[128:131]
    v_add_u32 v16, 0x10000, v16
    v_mfma_f32_16x16x32_bf16 a[128:131], a[4:7], v[60:63], a[128:131]
    v_mfma_f32_16x16x32_bf16 a[132:135], a[8:11], v[56:59], a[132:135]
    ds_read_b128 a[96:99], v22 offset:49152
    v_mfma_f32_16x16x32_bf16 a[132:135], a[12:15], v[60:63], a[132:135]
    v_mfma_f32_16x16x32_bf16 a[136:139], a[16:19], v[56:59], a[136:139]
    v_mfma_f32_16x16x32_bf16 a[136:139], a[20:23], v[60:63], a[136:139]
    buffer_load_dwordx4 v4, s[12:15], s60 offen offset:2048 nt lds
    v_mfma_f32_16x16x32_bf16 a[140:143], a[24:27], v[56:59], a[140:143]
    v_mfma_f32_16x16x32_bf16 a[140:143], a[28:31], v[60:63], a[140:143]
    ds_read_b128 a[100:103], v23 offset:49152
    v_mfma_f32_16x16x32_bf16 a[144:147], a[32:35], v[56:59], a[144:147]
    v_mfma_f32_16x16x32_bf16 a[144:147], a[36:39], v[60:63], a[144:147]
    v_mfma_f32_16x16x32_bf16 a[148:151], a[40:43], v[56:59], a[148:151]
    v_mfma_f32_16x16x32_bf16 a[148:151], a[44:47], v[60:63], a[148:151]
    buffer_load_dword v106, v103, s[24:27], s77 offen
    v_mfma_f32_16x16x32_bf16 a[152:155], a[48:51], v[56:59], a[152:155]
    s_add_u32 s77, s77, 4608
    buffer_load_dwordx4 v5, s[12:15], s60 offen offset:3072 nt lds
    v_mfma_f32_16x16x32_bf16 a[152:155], a[52:55], v[60:63], a[152:155]
    ds_read_b128 a[104:107], v22 offset:51200
    v_mfma_f32_16x16x32_bf16 a[156:159], a[56:59], v[56:59], a[156:159]
    ds_read_b64_tr_b16 v[56:57], v17 offset:32768
    ds_read_b64_tr_b16 v[58:59], v17 offset:33792
    v_mfma_f32_16x16x32_bf16 a[156:159], a[60:63], v[60:63], a[156:159]
    ds_read_b64_tr_b16 v[60:61], v17 offset:40960
    ds_read_b64_tr_b16 v[62:63], v17 offset:41984
    v_mfma_f32_16x16x32_bf16 a[160:163], a[0:3], v[40:43], a[160:163]
    v_add_u32 v17, 0x10000, v17
    v_mfma_f32_16x16x32_bf16 a[160:163], a[4:7], v[44:47], a[160:163]
    v_mfma_f32_16x16x32_bf16 a[164:167], a[8:11], v[40:43], a[164:167]
    ds_read_b128 a[108:111], v23 offset:51200
    v_mfma_f32_16x16x32_bf16 a[164:167], a[12:15], v[44:47], a[164:167]
    s_add_u32 m0, s69, 147456
    v_mfma_f32_16x16x32_bf16 a[168:171], a[16:19], v[40:43], a[168:171]
    buffer_load_dwordx4 v6, s[8:11], s61 offen lds
    v_mfma_f32_16x16x32_bf16 a[168:171], a[20:23], v[44:47], a[168:171]
    v_mfma_f32_16x16x32_bf16 a[172:175], a[24:27], v[40:43], a[172:175]
    v_mfma_f32_16x16x32_bf16 a[172:175], a[28:31], v[44:47], a[172:175]
    v_mfma_f32_16x16x32_bf16 a[176:179], a[32:35], v[40:43], a[176:179]
    ds_read_b128 a[112:115], v22 offset:53248
    v_mfma_f32_16x16x32_bf16 a[176:179], a[36:39], v[44:47], a[176:179]
    v_mfma_f32_16x16x32_bf16 a[180:183], a[40:43], v[40:43], a[180:183]
    v_mfma_f32_16x16x32_bf16 a[180:183], a[44:47], v[44:47], a[180:183]
    buffer_load_dwordx4 v7, s[8:11], s61 offen offset:1024 lds
    v_mfma_f32_16x16x32_bf16 a[184:187], a[48:51], v[40:43], a[184:187]
    v_mfma_f32_16x16x32_bf16 a[184:187], a[52:55], v[44:47], a[184:187]
    ds_read_b128 a[116:119], v23 offset:53248
    v_mfma_f32_16x16x32_bf16 a[188:191], a[56:59], v[40:43], a[188:191]
    v_mfma_f32_16x16x32_bf16 a[188:191], a[60:63], v[44:47], a[188:191]
    s_waitcnt lgkmcnt(1)
    v_mfma_f32_16x16x32_bf16 a[192:195], a[0:3], v[48:51], a[192:195]
    v_mfma_f32_16x16x32_bf16 a[192:195], a[4:7], v[52:55], a[192:195]
    v_mfma_f32_16x16x32_bf16 a[196:199], a[8:11], v[48:51], a[196:199]
    v_mfma_f32_16x16x32_bf16 a[196:199], a[12:15], v[52:55], a[196:199]
    buffer_load_dwordx4 v8, s[8:11], s61 offen offset:2048 lds
    v_mfma_f32_16x16x32_bf16 a[200:203], a[16:19], v[48:51], a[200:203]
    ds_read_b128 a[120:123], v22 offset:55296
    v_mfma_f32_16x16x32_bf16 a[200:203], a[20:23], v[52:55], a[200:203]
    v_mfma_f32_16x16x32_bf16 a[204:207], a[24:27], v[48:51], a[204:207]
    v_mfma_f32_16x16x32_bf16 a[204:207], a[28:31], v[52:55], a[204:207]
    v_mfma_f32_16x16x32_bf16 a[208:211], a[32:35], v[48:51], a[208:211]
    ds_read_b128 a[124:127], v23 offset:55296
    v_mfma_f32_16x16x32_bf16 a[208:211], a[36:39], v[52:55], a[208:211]
    v_mfma_f32_16x16x32_bf16 a[212:215], a[40:43], v[48:51], a[212:215]
    buffer_load_dwordx4 v9, s[8:11], s61 offen offset:3072 lds
    v_mfma_f32_16x16x32_bf16 a[212:215], a[44:47], v[52:55], a[212:215]
    v_mfma_f32_16x16x32_bf16 a[216:219], a[48:51], v[48:51], a[216:219]
    v_mfma_f32_16x16x32_bf16 a[216:219], a[52:55], v[52:55], a[216:219]
    v_mfma_f32_16x16x32_bf16 a[220:223], a[56:59], v[48:51], a[220:223]
    v_mfma_f32_16x16x32_bf16 a[220:223], a[60:63], v[52:55], a[220:223]
    v_mfma_f32_16x16x32_bf16 a[224:227], a[0:3], v[56:59], a[224:227]
    v_mfma_f32_16x16x32_bf16 a[224:227], a[4:7], v[60:63], a[224:227]
    s_add_u32 s61, s61, 128
    v_mfma_f32_16x16x32_bf16 a[228:231], a[8:11], v[56:59], a[228:231]
    v_mfma_f32_16x16x32_bf16 a[228:231], a[12:15], v[60:63], a[228:231]
    v_mfma_f32_16x16x32_bf16 a[232:235], a[16:19], v[56:59], a[232:235]
    v_mfma_f32_16x16x32_bf16 a[232:235], a[20:23], v[60:63], a[232:235]
    s_waitcnt vmcnt(17)
    s_barrier
    ds_read_b64_tr_b16 v[40:41], v14 offset:0
    v_mfma_f32_16x16x32_bf16 a[236:239], a[24:27], v[56:59], a[236:239]
    s_add_u32 m0, s69, 0
    ds_read_b64_tr_b16 v[42:43], v14 offset:1024
    ds_read_b64_tr_b16 v[44:45], v14 offset:8192
    v_mfma_f32_16x16x32_bf16 a[236:239], a[28:31], v[60:63], a[236:239]
    buffer_load_dwordx4 v2, s[16:19], s60 offen nt lds
    v_mfma_f32_16x16x32_bf16 a[240:243], a[32:35], v[56:59], a[240:243]
    ds_read_b64_tr_b16 v[46:47], v14 offset:9216
    ds_read_b64_tr_b16 v[48:49], v15 offset:0
    v_mfma_f32_16x16x32_bf16 a[240:243], a[36:39], v[60:63], a[240:243]
    ds_read_b64_tr_b16 v[50:51], v15 offset:1024
    ds_read_b64_tr_b16 v[52:53], v15 offset:8192
    v_mfma_f32_16x16x32_bf16 a[244:247], a[40:43], v[56:59], a[244:247]
    ds_read_b64_tr_b16 v[54:55], v15 offset:9216
    v_mfma_f32_16x16x32_bf16 a[244:247], a[44:47], v[60:63], a[244:247]
    v_mfma_f32_16x16x32_bf16 a[248:251], a[48:51], v[56:59], a[248:251]
    v_mfma_f32_16x16x32_bf16 a[248:251], a[52:55], v[60:63], a[248:251]
    buffer_load_dwordx4 v3, s[16:19], s60 offen offset:1024 nt lds
    v_mfma_f32_16x16x32_bf16 a[252:255], a[56:59], v[56:59], a[252:255]
    ds_read_b64_tr_b16 v[56:57], v16 offset:0
    ds_read_b64_tr_b16 v[58:59], v16 offset:1024
    v_mfma_f32_16x16x32_bf16 a[252:255], a[60:63], v[60:63], a[252:255]
    s_waitcnt lgkmcnt(2)
    ds_read_b64_tr_b16 v[60:61], v16 offset:8192
    ds_read_b64_tr_b16 v[62:63], v16 offset:9216
    v_mfma_f32_16x16x32_bf16 v[128:131], v[40:43], a[64:67], v[128:131]
    v_mfma_f32_16x16x32_bf16 v[128:131], v[44:47], a[68:71], v[128:131]
    v_add_u32 v22, 0x10000, v22
    v_mfma_f32_16x16x32_bf16 v[132:135], v[40:43], a[72:75], v[132:135]
    ds_read_b128 a[0:3], v22 offset:16384
    v_mfma_f32_16x16x32_bf16 v[132:135], v[44:47], a[76:79], v[132:135]
    v_mfma_f32_16x16x32_bf16 v[136:139], v[40:43], a[80:83], v[136:139]
    v_mfma_f32_16x16x32_bf16 v[136:139], v[44:47], a[84:87], v[136:139]
    buffer_load_dwordx4 v4, s[16:19], s60 offen offset:2048 nt lds
    v_mfma_f32_16x16x32_bf16 v[140:143], v[40:43], a[88:91], v[140:143]
    v_add_u32 v23, 0x10000, v23
    v_mfma_f32_16x16x32_bf16 v[140:143], v[44:47], a[92:95], v[140:143]
    ds_read_b128 a[4:7], v23 offset:16384
    v_mfma_f32_16x16x32_bf16 v[144:147], v[40:43], a[96:99], v[144:147]
    v_mfma_f32_16x16x32_bf16 v[144:147], v[44:47], a[100:103], v[144:147]
    v_mfma_f32_16x16x32_bf16 v[148:151], v[40:43], a[104:107], v[148:151]
    v_mfma_f32_16x16x32_bf16 v[148:151], v[44:47], a[108:111], v[148:151]
    v_mfma_f32_16x16x32_bf16 v[152:155], v[40:43], a[112:115], v[152:155]
    buffer_load_dwordx4 v5, s[16:19], s60 offen offset:3072 nt lds
    v_mfma_f32_16x16x32_bf16 v[152:155], v[44:47], a[116:119], v[152:155]
    ds_read_b128 a[8:11], v22 offset:18432
    v_mfma_f32_16x16x32_bf16 v[156:159], v[40:43], a[120:123], v[156:159]
    ds_read_b64_tr_b16 v[40:41], v17 offset:0
    ds_read_b64_tr_b16 v[42:43], v17 offset:1024
    v_mfma_f32_16x16x32_bf16 v[156:159], v[44:47], a[124:127], v[156:159]
    ds_read_b64_tr_b16 v[44:45], v17 offset:8192
    ds_read_b64_tr_b16 v[46:47], v17 offset:9216
    v_mfma_f32_16x16x32_bf16 v[160:163], v[48:51], a[64:67], v[160:163]
    v_mfma_f32_16x16x32_bf16 v[160:163], v[52:55], a[68:71], v[160:163]
    v_mfma_f32_16x16x32_bf16 v[164:167], v[48:51], a[72:75], v[164:167]
    ds_read_b128 a[12:15], v23 offset:18432
    v_mfma_f32_16x16x32_bf16 v[164:167], v[52:55], a[76:79], v[164:167]
    s_add_u32 m0, s69, 16384
    v_mfma_f32_16x16x32_bf16 v[168:171], v[48:51], a[80:83], v[168:171]
    s_add_u32 s60, s60, 524288
    buffer_load_dwordx4 v6, s[8:11], s62 offen lds
    v_mfma_f32_16x16x32_bf16 v[168:171], v[52:55], a[84:87], v[168:171]
    v_mfma_f32_16x16x32_bf16 v[172:175], v[48:51], a[88:91], v[172:175]
    v_mfma_f32_16x16x32_bf16 v[172:175], v[52:55], a[92:95], v[172:175]
    v_mfma_f32_16x16x32_bf16 v[176:179], v[48:51], a[96:99], v[176:179]
    ds_read_b128 a[16:19], v22 offset:20480
    v_mfma_f32_16x16x32_bf16 v[176:179], v[52:55], a[100:103], v[176:179]
    v_mfma_f32_16x16x32_bf16 v[180:183], v[48:51], a[104:107], v[180:183]
    v_mfma_f32_16x16x32_bf16 v[180:183], v[52:55], a[108:111], v[180:183]
    buffer_load_dwordx4 v7, s[8:11], s62 offen offset:1024 lds
    v_mfma_f32_16x16x32_bf16 v[184:187], v[48:51], a[112:115], v[184:187]
    v_mfma_f32_16x16x32_bf16 v[184:187], v[52:55], a[116:119], v[184:187]
    ds_read_b128 a[20:23], v23 offset:20480
    v_mfma_f32_16x16x32_bf16 v[188:191], v[48:51], a[120:123], v[188:191]
    v_mfma_f32_16x16x32_bf16 v[188:191], v[52:55], a[124:127], v[188:191]
    s_waitcnt lgkmcnt(1)
    v_mfma_f32_16x16x32_bf16 v[192:195], v[56:59], a[64:67], v[192:195]
    v_mfma_f32_16x16x32_bf16 v[192:195], v[60:63], a[68:71], v[192:195]
    v_mfma_f32_16x16x32_bf16 v[196:199], v[56:59], a[72:75], v[196:199]
    v_mfma_f32_16x16x32_bf16 v[196:199], v[60:63], a[76:79], v[196:199]
    buffer_load_dwordx4 v8, s[8:11], s62 offen offset:2048 lds
    v_mfma_f32_16x16x32_bf16 v[200:203], v[56:59], a[80:83], v[200:203]
    ds_read_b128 a[24:27], v22 offset:22528
    v_mfma_f32_16x16x32_bf16 v[200:203], v[60:63], a[84:87], v[200:203]
    v_mfma_f32_16x16x32_bf16 v[204:207], v[56:59], a[88:91], v[204:207]
    v_mfma_f32_16x16x32_bf16 v[204:207], v[60:63], a[92:95], v[204:207]
    v_mfma_f32_16x16x32_bf16 v[208:211], v[56:59], a[96:99], v[208:211]
    ds_read_b128 a[28:31], v23 offset:22528
    v_mfma_f32_16x16x32_bf16 v[208:211], v[60:63], a[100:103], v[208:211]
    v_mfma_f32_16x16x32_bf16 v[212:215], v[56:59], a[104:107], v[212:215]
    buffer_load_dwordx4 v9, s[8:11], s62 offen offset:3072 lds
    v_mfma_f32_16x16x32_bf16 v[212:215], v[60:63], a[108:111], v[212:215]
    v_mfma_f32_16x16x32_bf16 v[216:219], v[56:59], a[112:115], v[216:219]
    v_mfma_f32_16x16x32_bf16 v[216:219], v[60:63], a[116:119], v[216:219]
    v_mfma_f32_16x16x32_bf16 v[220:223], v[56:59], a[120:123], v[220:223]
    v_mfma_f32_16x16x32_bf16 v[220:223], v[60:63], a[124:127], v[220:223]
    v_mfma_f32_16x16x32_bf16 v[224:227], v[40:43], a[64:67], v[224:227]
    v_mfma_f32_16x16x32_bf16 v[224:227], v[44:47], a[68:71], v[224:227]
    s_add_u32 s62, s62, 128
    v_mfma_f32_16x16x32_bf16 v[228:231], v[40:43], a[72:75], v[228:231]
    v_mfma_f32_16x16x32_bf16 v[228:231], v[44:47], a[76:79], v[228:231]
    v_mfma_f32_16x16x32_bf16 v[232:235], v[40:43], a[80:83], v[232:235]
    v_mfma_f32_16x16x32_bf16 v[232:235], v[44:47], a[84:87], v[232:235]
    s_waitcnt vmcnt(17)
    s_barrier
    ds_read_b64_tr_b16 v[48:49], v14 offset:32768
    v_mfma_f32_16x16x32_bf16 v[236:239], v[40:43], a[88:91], v[236:239]
    s_add_u32 m0, s69, 32768
    ds_read_b64_tr_b16 v[50:51], v14 offset:33792
    ds_read_b64_tr_b16 v[52:53], v14 offset:40960
    v_mfma_f32_16x16x32_bf16 v[236:239], v[44:47], a[92:95], v[236:239]
    buffer_load_dwordx4 v2, s[12:15], s60 offen nt lds
    v_mfma_f32_16x16x32_bf16 v[240:243], v[40:43], a[96:99], v[240:243]
    ds_read_b64_tr_b16 v[54:55], v14 offset:41984
    ds_read_b64_tr_b16 v[56:57], v15 offset:32768
    v_mfma_f32_16x16x32_bf16 v[240:243], v[44:47], a[100:103], v[240:243]
    buffer_atomic_add v31, v30, s[44:47], s95 offen sc1
    v_mfma_f32_16x16x32_bf16 v[244:247], v[40:43], a[104:107], v[244:247]
    ds_read_b64_tr_b16 v[58:59], v15 offset:33792
    ds_read_b64_tr_b16 v[60:61], v15 offset:40960
    v_mfma_f32_16x16x32_bf16 v[244:247], v[44:47], a[108:111], v[244:247]
    ds_read_b64_tr_b16 v[62:63], v15 offset:41984
    v_add_u32 v14, 0x10000, v14
    v_mfma_f32_16x16x32_bf16 v[248:251], v[40:43], a[112:115], v[248:251]
    v_add_u32 v15, 0x10000, v15
    v_mfma_f32_16x16x32_bf16 v[248:251], v[44:47], a[116:119], v[248:251]
    buffer_load_dwordx4 v3, s[12:15], s60 offen offset:1024 nt lds
    v_mfma_f32_16x16x32_bf16 v[252:255], v[40:43], a[120:123], v[252:255]
    ds_read_b64_tr_b16 v[40:41], v16 offset:32768
    ds_read_b64_tr_b16 v[42:43], v16 offset:33792
    v_mfma_f32_16x16x32_bf16 v[252:255], v[44:47], a[124:127], v[252:255]
    s_waitcnt lgkmcnt(3)
    ds_read_b64_tr_b16 v[44:45], v16 offset:40960
    ds_read_b64_tr_b16 v[46:47], v16 offset:41984
    v_mfma_f32_16x16x32_bf16 a[128:131], a[64:67], v[48:51], a[128:131]
    v_add_u32 v16, 0x10000, v16
    v_mfma_f32_16x16x32_bf16 a[128:131], a[68:71], v[52:55], a[128:131]
    v_mfma_f32_16x16x32_bf16 a[132:135], a[72:75], v[48:51], a[132:135]
    ds_read_b128 a[32:35], v22 offset:49152
    v_mfma_f32_16x16x32_bf16 a[132:135], a[76:79], v[52:55], a[132:135]
    v_mfma_f32_16x16x32_bf16 a[136:139], a[80:83], v[48:51], a[136:139]
    v_mfma_f32_16x16x32_bf16 a[136:139], a[84:87], v[52:55], a[136:139]
    buffer_load_dwordx4 v4, s[12:15], s60 offen offset:2048 nt lds
    v_mfma_f32_16x16x32_bf16 a[140:143], a[88:91], v[48:51], a[140:143]
    v_mfma_f32_16x16x32_bf16 a[140:143], a[92:95], v[52:55], a[140:143]
    ds_read_b128 a[36:39], v23 offset:49152
    v_mfma_f32_16x16x32_bf16 a[144:147], a[96:99], v[48:51], a[144:147]
    v_mfma_f32_16x16x32_bf16 a[144:147], a[100:103], v[52:55], a[144:147]
    v_mfma_f32_16x16x32_bf16 a[148:151], a[104:107], v[48:51], a[148:151]
    v_mfma_f32_16x16x32_bf16 a[148:151], a[108:111], v[52:55], a[148:151]
    v_mfma_f32_16x16x32_bf16 a[152:155], a[112:115], v[48:51], a[152:155]
    buffer_load_dwordx4 v5, s[12:15], s60 offen offset:3072 nt lds
    v_mfma_f32_16x16x32_bf16 a[152:155], a[116:119], v[52:55], a[152:155]
    ds_read_b128 a[40:43], v22 offset:51200
    v_mfma_f32_16x16x32_bf16 a[156:159], a[120:123], v[48:51], a[156:159]
    ds_read_b64_tr_b16 v[48:49], v17 offset:32768
    ds_read_b64_tr_b16 v[50:51], v17 offset:33792
    v_mfma_f32_16x16x32_bf16 a[156:159], a[124:127], v[52:55], a[156:159]
    ds_read_b64_tr_b16 v[52:53], v17 offset:40960
    ds_read_b64_tr_b16 v[54:55], v17 offset:41984
    v_mfma_f32_16x16x32_bf16 a[160:163], a[64:67], v[56:59], a[160:163]
    s_waitcnt lgkmcnt(5)
    v_add_u32 v17, 0x10000, v17
    v_mfma_f32_16x16x32_bf16 a[160:163], a[68:71], v[60:63], a[160:163]
    v_mfma_f32_16x16x32_bf16 a[164:167], a[72:75], v[56:59], a[164:167]
    ds_read_b128 a[44:47], v23 offset:51200
    v_mfma_f32_16x16x32_bf16 a[164:167], a[76:79], v[60:63], a[164:167]
    s_add_u32 m0, s69, 49152
    v_mfma_f32_16x16x32_bf16 a[168:171], a[80:83], v[56:59], a[168:171]
    buffer_load_dwordx4 v6, s[8:11], s61 offen lds
    v_mfma_f32_16x16x32_bf16 a[168:171], a[84:87], v[60:63], a[168:171]
    v_mfma_f32_16x16x32_bf16 a[172:175], a[88:91], v[56:59], a[172:175]
    v_mfma_f32_16x16x32_bf16 a[172:175], a[92:95], v[60:63], a[172:175]
    v_mfma_f32_16x16x32_bf16 a[176:179], a[96:99], v[56:59], a[176:179]
    buffer_load_dword v107, v103, s[24:27], s77 offen
    v_mfma_f32_16x16x32_bf16 a[176:179], a[100:103], v[60:63], a[176:179]
    s_add_u32 s77, s77, 4608
    ds_read_b128 a[48:51], v22 offset:53248
    v_mfma_f32_16x16x32_bf16 a[180:183], a[104:107], v[56:59], a[180:183]
    v_mfma_f32_16x16x32_bf16 a[180:183], a[108:111], v[60:63], a[180:183]
    buffer_load_dwordx4 v7, s[8:11], s61 offen offset:1024 lds
    v_mfma_f32_16x16x32_bf16 a[184:187], a[112:115], v[56:59], a[184:187]
    v_mfma_f32_16x16x32_bf16 a[184:187], a[116:119], v[60:63], a[184:187]
    ds_read_b128 a[52:55], v23 offset:53248
    v_mfma_f32_16x16x32_bf16 a[188:191], a[120:123], v[56:59], a[188:191]
    v_mfma_f32_16x16x32_bf16 a[188:191], a[124:127], v[60:63], a[188:191]
    v_mfma_f32_16x16x32_bf16 a[192:195], a[64:67], v[40:43], a[192:195]
    v_mfma_f32_16x16x32_bf16 a[192:195], a[68:71], v[44:47], a[192:195]
    v_mfma_f32_16x16x32_bf16 a[196:199], a[72:75], v[40:43], a[196:199]
    v_mfma_f32_16x16x32_bf16 a[196:199], a[76:79], v[44:47], a[196:199]
    buffer_load_dwordx4 v8, s[8:11], s61 offen offset:2048 lds
    v_mfma_f32_16x16x32_bf16 a[200:203], a[80:83], v[40:43], a[200:203]
    ds_read_b128 a[56:59], v22 offset:55296
    v_mfma_f32_16x16x32_bf16 a[200:203], a[84:87], v[44:47], a[200:203]
    v_mfma_f32_16x16x32_bf16 a[204:207], a[88:91], v[40:43], a[204:207]
    v_mfma_f32_16x16x32_bf16 a[204:207], a[92:95], v[44:47], a[204:207]
    v_mfma_f32_16x16x32_bf16 a[208:211], a[96:99], v[40:43], a[208:211]
    ds_read_b128 a[60:63], v23 offset:55296
    v_mfma_f32_16x16x32_bf16 a[208:211], a[100:103], v[44:47], a[208:211]
    v_mfma_f32_16x16x32_bf16 a[212:215], a[104:107], v[40:43], a[212:215]
    buffer_load_dwordx4 v9, s[8:11], s61 offen offset:3072 lds
    v_mfma_f32_16x16x32_bf16 a[212:215], a[108:111], v[44:47], a[212:215]
    v_mfma_f32_16x16x32_bf16 a[216:219], a[112:115], v[40:43], a[216:219]
    v_mfma_f32_16x16x32_bf16 a[216:219], a[116:119], v[44:47], a[216:219]
    v_mfma_f32_16x16x32_bf16 a[220:223], a[120:123], v[40:43], a[220:223]
    v_mfma_f32_16x16x32_bf16 a[220:223], a[124:127], v[44:47], a[220:223]
    s_waitcnt lgkmcnt(0)
    v_mfma_f32_16x16x32_bf16 a[224:227], a[64:67], v[48:51], a[224:227]
    v_mfma_f32_16x16x32_bf16 a[224:227], a[68:71], v[52:55], a[224:227]
    s_add_u32 s61, s61, 128
    v_mfma_f32_16x16x32_bf16 a[228:231], a[72:75], v[48:51], a[228:231]
    v_mfma_f32_16x16x32_bf16 a[228:231], a[76:79], v[52:55], a[228:231]
    v_mfma_f32_16x16x32_bf16 a[232:235], a[80:83], v[48:51], a[232:235]
    v_mfma_f32_16x16x32_bf16 a[232:235], a[84:87], v[52:55], a[232:235]
    s_waitcnt vmcnt(18)
    s_barrier
    ds_read_b64_tr_b16 v[56:57], v14 offset:0
    v_mfma_f32_16x16x32_bf16 a[236:239], a[88:91], v[48:51], a[236:239]
    s_add_u32 m0, s69, 65536
    ds_read_b64_tr_b16 v[58:59], v14 offset:1024
    ds_read_b64_tr_b16 v[60:61], v14 offset:8192
    v_mfma_f32_16x16x32_bf16 a[236:239], a[92:95], v[52:55], a[236:239]
    buffer_load_dwordx4 v2, s[16:19], s60 offen nt lds
    v_mfma_f32_16x16x32_bf16 a[240:243], a[96:99], v[48:51], a[240:243]
    ds_read_b64_tr_b16 v[62:63], v14 offset:9216
    ds_read_b64_tr_b16 v[40:41], v15 offset:0
    v_mfma_f32_16x16x32_bf16 a[240:243], a[100:103], v[52:55], a[240:243]
    ds_read_b64_tr_b16 v[42:43], v15 offset:1024
    ds_read_b64_tr_b16 v[44:45], v15 offset:8192
    v_mfma_f32_16x16x32_bf16 a[244:247], a[104:107], v[48:51], a[244:247]
    ds_read_b64_tr_b16 v[46:47], v15 offset:9216
    v_add_u32 v14, 0xfffe0000, v14
    v_mfma_f32_16x16x32_bf16 a[244:247], a[108:111], v[52:55], a[244:247]
    v_add_u32 v15, 0xfffe0000, v15
    v_mfma_f32_16x16x32_bf16 a[248:251], a[112:115], v[48:51], a[248:251]
    v_mfma_f32_16x16x32_bf16 a[248:251], a[116:119], v[52:55], a[248:251]
    buffer_load_dwordx4 v3, s[16:19], s60 offen offset:1024 nt lds
    v_mfma_f32_16x16x32_bf16 a[252:255], a[120:123], v[48:51], a[252:255]
    ds_read_b64_tr_b16 v[48:49], v16 offset:0
    ds_read_b64_tr_b16 v[50:51], v16 offset:1024
    v_mfma_f32_16x16x32_bf16 a[252:255], a[124:127], v[52:55], a[252:255]
    s_waitcnt lgkmcnt(2)
    ds_read_b64_tr_b16 v[52:53], v16 offset:8192
    ds_read_b64_tr_b16 v[54:55], v16 offset:9216
    v_mfma_f32_16x16x32_bf16 v[128:131], v[56:59], a[0:3], v[128:131]
    v_add_u32 v16, 0xfffe0000, v16
    v_mfma_f32_16x16x32_bf16 v[128:131], v[60:63], a[4:7], v[128:131]
    v_add_u32 v22, 0x10000, v22
    v_mfma_f32_16x16x32_bf16 v[132:135], v[56:59], a[8:11], v[132:135]
    ds_read_b128 a[64:67], v22 offset:16384
    v_mfma_f32_16x16x32_bf16 v[132:135], v[60:63], a[12:15], v[132:135]
    v_mfma_f32_16x16x32_bf16 v[136:139], v[56:59], a[16:19], v[136:139]
    v_mfma_f32_16x16x32_bf16 v[136:139], v[60:63], a[20:23], v[136:139]
    buffer_load_dwordx4 v4, s[16:19], s60 offen offset:2048 nt lds
    v_mfma_f32_16x16x32_bf16 v[140:143], v[56:59], a[24:27], v[140:143]
    v_add_u32 v23, 0x10000, v23
    v_mfma_f32_16x16x32_bf16 v[140:143], v[60:63], a[28:31], v[140:143]
    ds_read_b128 a[68:71], v23 offset:16384
    v_mfma_f32_16x16x32_bf16 v[144:147], v[56:59], a[32:35], v[144:147]
    v_mfma_f32_16x16x32_bf16 v[144:147], v[60:63], a[36:39], v[144:147]
    v_mfma_f32_16x16x32_bf16 v[148:151], v[56:59], a[40:43], v[148:151]
    v_mfma_f32_16x16x32_bf16 v[148:151], v[60:63], a[44:47], v[148:151]
    v_mfma_f32_16x16x32_bf16 v[152:155], v[56:59], a[48:51], v[152:155]
    buffer_load_dwordx4 v5, s[16:19], s60 offen offset:3072 nt lds
    v_mfma_f32_16x16x32_bf16 v[152:155], v[60:63], a[52:55], v[152:155]
    ds_read_b128 a[72:75], v22 offset:18432
    v_mfma_f32_16x16x32_bf16 v[156:159], v[56:59], a[56:59], v[156:159]
    ds_read_b64_tr_b16 v[56:57], v17 offset:0
    ds_read_b64_tr_b16 v[58:59], v17 offset:1024
    v_mfma_f32_16x16x32_bf16 v[156:159], v[60:63], a[60:63], v[156:159]
    ds_read_b64_tr_b16 v[60:61], v17 offset:8192
    ds_read_b64_tr_b16 v[62:63], v17 offset:9216
    v_mfma_f32_16x16x32_bf16 v[160:163], v[40:43], a[0:3], v[160:163]
    v_add_u32 v17, 0xfffe0000, v17
    v_mfma_f32_16x16x32_bf16 v[160:163], v[44:47], a[4:7], v[160:163]
    v_mfma_f32_16x16x32_bf16 v[164:167], v[40:43], a[8:11], v[164:167]
    ds_read_b128 a[76:79], v23 offset:18432
    v_mfma_f32_16x16x32_bf16 v[164:167], v[44:47], a[12:15], v[164:167]
    s_add_u32 m0, s69, 81920
    v_mfma_f32_16x16x32_bf16 v[168:171], v[40:43], a[16:19], v[168:171]
    s_add_u32 s60, s60, 524288
    buffer_load_dwordx4 v6, s[8:11], s62 offen lds
    v_mfma_f32_16x16x32_bf16 v[168:171], v[44:47], a[20:23], v[168:171]
    v_mfma_f32_16x16x32_bf16 v[172:175], v[40:43], a[24:27], v[172:175]
    v_mfma_f32_16x16x32_bf16 v[172:175], v[44:47], a[28:31], v[172:175]
    v_mfma_f32_16x16x32_bf16 v[176:179], v[40:43], a[32:35], v[176:179]
    ds_read_b128 a[80:83], v22 offset:20480
    v_mfma_f32_16x16x32_bf16 v[176:179], v[44:47], a[36:39], v[176:179]
    v_mfma_f32_16x16x32_bf16 v[180:183], v[40:43], a[40:43], v[180:183]
    v_mfma_f32_16x16x32_bf16 v[180:183], v[44:47], a[44:47], v[180:183]
    buffer_load_dwordx4 v7, s[8:11], s62 offen offset:1024 lds
    v_mfma_f32_16x16x32_bf16 v[184:187], v[40:43], a[48:51], v[184:187]
    v_mfma_f32_16x16x32_bf16 v[184:187], v[44:47], a[52:55], v[184:187]
    ds_read_b128 a[84:87], v23 offset:20480
    v_mfma_f32_16x16x32_bf16 v[188:191], v[40:43], a[56:59], v[188:191]
    v_mfma_f32_16x16x32_bf16 v[188:191], v[44:47], a[60:63], v[188:191]
    s_waitcnt lgkmcnt(1)
    v_mfma_f32_16x16x32_bf16 v[192:195], v[48:51], a[0:3], v[192:195]
    v_mfma_f32_16x16x32_bf16 v[192:195], v[52:55], a[4:7], v[192:195]
    v_mfma_f32_16x16x32_bf16 v[196:199], v[48:51], a[8:11], v[196:199]
    v_mfma_f32_16x16x32_bf16 v[196:199], v[52:55], a[12:15], v[196:199]
    buffer_load_dwordx4 v8, s[8:11], s62 offen offset:2048 lds
    v_mfma_f32_16x16x32_bf16 v[200:203], v[48:51], a[16:19], v[200:203]
    ds_read_b128 a[88:91], v22 offset:22528
    v_mfma_f32_16x16x32_bf16 v[200:203], v[52:55], a[20:23], v[200:203]
    v_mfma_f32_16x16x32_bf16 v[204:207], v[48:51], a[24:27], v[204:207]
    v_mfma_f32_16x16x32_bf16 v[204:207], v[52:55], a[28:31], v[204:207]
    v_mfma_f32_16x16x32_bf16 v[208:211], v[48:51], a[32:35], v[208:211]
    ds_read_b128 a[92:95], v23 offset:22528
    v_mfma_f32_16x16x32_bf16 v[208:211], v[52:55], a[36:39], v[208:211]
    v_mfma_f32_16x16x32_bf16 v[212:215], v[48:51], a[40:43], v[212:215]
    buffer_load_dwordx4 v9, s[8:11], s62 offen offset:3072 lds
    v_mfma_f32_16x16x32_bf16 v[212:215], v[52:55], a[44:47], v[212:215]
    v_mfma_f32_16x16x32_bf16 v[216:219], v[48:51], a[48:51], v[216:219]
    v_mfma_f32_16x16x32_bf16 v[216:219], v[52:55], a[52:55], v[216:219]
    v_mfma_f32_16x16x32_bf16 v[220:223], v[48:51], a[56:59], v[220:223]
    v_mfma_f32_16x16x32_bf16 v[220:223], v[52:55], a[60:63], v[220:223]
    v_mfma_f32_16x16x32_bf16 v[224:227], v[56:59], a[0:3], v[224:227]
    v_mfma_f32_16x16x32_bf16 v[224:227], v[60:63], a[4:7], v[224:227]
    s_add_u32 s62, s62, 128
    v_mfma_f32_16x16x32_bf16 v[228:231], v[56:59], a[8:11], v[228:231]
    v_mfma_f32_16x16x32_bf16 v[228:231], v[60:63], a[12:15], v[228:231]
    v_mfma_f32_16x16x32_bf16 v[232:235], v[56:59], a[16:19], v[232:235]
    v_mfma_f32_16x16x32_bf16 v[232:235], v[60:63], a[20:23], v[232:235]
    s_waitcnt vmcnt(18)
    s_barrier
    ds_read_b64_tr_b16 v[40:41], v14 offset:0
    v_mfma_f32_16x16x32_bf16 v[236:239], v[56:59], a[24:27], v[236:239]
    s_add_u32 m0, s69, 98304
    ds_read_b64_tr_b16 v[42:43], v14 offset:1024
    ds_read_b64_tr_b16 v[44:45], v14 offset:8192
    v_mfma_f32_16x16x32_bf16 v[236:239], v[60:63], a[28:31], v[236:239]
    buffer_load_dwordx4 v2, s[12:15], s60 offen nt lds
    v_mfma_f32_16x16x32_bf16 v[240:243], v[56:59], a[32:35], v[240:243]
    ds_read_b64_tr_b16 v[46:47], v14 offset:9216
    ds_read_b64_tr_b16 v[48:49], v15 offset:0
    v_mfma_f32_16x16x32_bf16 v[240:243], v[60:63], a[36:39], v[240:243]
    ds_read_b64_tr_b16 v[50:51], v15 offset:1024
    ds_read_b64_tr_b16 v[52:53], v15 offset:8192
    v_mfma_f32_16x16x32_bf16 v[244:247], v[56:59], a[40:43], v[244:247]
    ds_read_b64_tr_b16 v[54:55], v15 offset:9216
    v_mfma_f32_16x16x32_bf16 v[244:247], v[60:63], a[44:47], v[244:247]
    v_mfma_f32_16x16x32_bf16 v[248:251], v[56:59], a[48:51], v[248:251]
    v_mfma_f32_16x16x32_bf16 v[248:251], v[60:63], a[52:55], v[248:251]
    buffer_load_dwordx4 v3, s[12:15], s60 offen offset:1024 nt lds
    v_mfma_f32_16x16x32_bf16 v[252:255], v[56:59], a[56:59], v[252:255]
    ds_read_b64_tr_b16 v[56:57], v16 offset:0
    ds_read_b64_tr_b16 v[58:59], v16 offset:1024
    v_mfma_f32_16x16x32_bf16 v[252:255], v[60:63], a[60:63], v[252:255]
    s_waitcnt lgkmcnt(2)
    ds_read_b64_tr_b16 v[60:61], v16 offset:8192
    ds_read_b64_tr_b16 v[62:63], v16 offset:9216
    v_mfma_f32_16x16x32_bf16 a[128:131], a[0:3], v[40:43], a[128:131]
    v_mfma_f32_16x16x32_bf16 a[128:131], a[4:7], v[44:47], a[128:131]
    v_add_u32 v22, 0xfffe0000, v22
    v_mfma_f32_16x16x32_bf16 a[132:135], a[8:11], v[40:43], a[132:135]
    ds_read_b128 a[96:99], v22 offset:16384
    v_mfma_f32_16x16x32_bf16 a[132:135], a[12:15], v[44:47], a[132:135]
    v_mfma_f32_16x16x32_bf16 a[136:139], a[16:19], v[40:43], a[136:139]
    v_mfma_f32_16x16x32_bf16 a[136:139], a[20:23], v[44:47], a[136:139]
    buffer_load_dwordx4 v4, s[12:15], s60 offen offset:2048 nt lds
    v_mfma_f32_16x16x32_bf16 a[140:143], a[24:27], v[40:43], a[140:143]
    v_add_u32 v23, 0xfffe0000, v23
    v_mfma_f32_16x16x32_bf16 a[140:143], a[28:31], v[44:47], a[140:143]
    ds_read_b128 a[100:103], v23 offset:16384
    v_mfma_f32_16x16x32_bf16 a[144:147], a[32:35], v[40:43], a[144:147]
    v_mfma_f32_16x16x32_bf16 a[144:147], a[36:39], v[44:47], a[144:147]
    v_mfma_f32_16x16x32_bf16 a[148:151], a[40:43], v[40:43], a[148:151]
    v_mfma_f32_16x16x32_bf16 a[148:151], a[44:47], v[44:47], a[148:151]
    v_mfma_f32_16x16x32_bf16 a[152:155], a[48:51], v[40:43], a[152:155]
    buffer_load_dwordx4 v5, s[12:15], s60 offen offset:3072 nt lds
    v_mfma_f32_16x16x32_bf16 a[152:155], a[52:55], v[44:47], a[152:155]
    ds_read_b128 a[104:107], v22 offset:18432
    v_mfma_f32_16x16x32_bf16 a[156:159], a[56:59], v[40:43], a[156:159]
    ds_read_b64_tr_b16 v[40:41], v17 offset:0
    ds_read_b64_tr_b16 v[42:43], v17 offset:1024
    v_mfma_f32_16x16x32_bf16 a[156:159], a[60:63], v[44:47], a[156:159]
    ds_read_b64_tr_b16 v[44:45], v17 offset:8192
    ds_read_b64_tr_b16 v[46:47], v17 offset:9216
    v_mfma_f32_16x16x32_bf16 a[160:163], a[0:3], v[48:51], a[160:163]
    v_mfma_f32_16x16x32_bf16 a[160:163], a[4:7], v[52:55], a[160:163]
    v_mfma_f32_16x16x32_bf16 a[164:167], a[8:11], v[48:51], a[164:167]
    ds_read_b128 a[108:111], v23 offset:18432
    v_mfma_f32_16x16x32_bf16 a[164:167], a[12:15], v[52:55], a[164:167]
    s_add_u32 m0, s69, 114688
    v_mfma_f32_16x16x32_bf16 a[168:171], a[16:19], v[48:51], a[168:171]
    buffer_load_dwordx4 v6, s[8:11], s61 offen lds
    v_mfma_f32_16x16x32_bf16 a[168:171], a[20:23], v[52:55], a[168:171]
    v_mfma_f32_16x16x32_bf16 a[172:175], a[24:27], v[48:51], a[172:175]
    v_mfma_f32_16x16x32_bf16 a[172:175], a[28:31], v[52:55], a[172:175]
    v_mfma_f32_16x16x32_bf16 a[176:179], a[32:35], v[48:51], a[176:179]
    ds_read_b128 a[112:115], v22 offset:20480
    v_mfma_f32_16x16x32_bf16 a[176:179], a[36:39], v[52:55], a[176:179]
    v_mfma_f32_16x16x32_bf16 a[180:183], a[40:43], v[48:51], a[180:183]
    v_mfma_f32_16x16x32_bf16 a[180:183], a[44:47], v[52:55], a[180:183]
    buffer_load_dwordx4 v7, s[8:11], s61 offen offset:1024 lds
    v_mfma_f32_16x16x32_bf16 a[184:187], a[48:51], v[48:51], a[184:187]
    v_mfma_f32_16x16x32_bf16 a[184:187], a[52:55], v[52:55], a[184:187]
    ds_read_b128 a[116:119], v23 offset:20480
    v_mfma_f32_16x16x32_bf16 a[188:191], a[56:59], v[48:51], a[188:191]
    v_mfma_f32_16x16x32_bf16 a[188:191], a[60:63], v[52:55], a[188:191]
    s_waitcnt lgkmcnt(1)
    v_mfma_f32_16x16x32_bf16 a[192:195], a[0:3], v[56:59], a[192:195]
    v_mfma_f32_16x16x32_bf16 a[192:195], a[4:7], v[60:63], a[192:195]
    v_mfma_f32_16x16x32_bf16 a[196:199], a[8:11], v[56:59], a[196:199]
    v_mfma_f32_16x16x32_bf16 a[196:199], a[12:15], v[60:63], a[196:199]
    buffer_load_dwordx4 v8, s[8:11], s61 offen offset:2048 lds
    v_mfma_f32_16x16x32_bf16 a[200:203], a[16:19], v[56:59], a[200:203]
    ds_read_b128 a[120:123], v22 offset:22528
    v_mfma_f32_16x16x32_bf16 a[200:203], a[20:23], v[60:63], a[200:203]
    buffer_load_dword v108, v103, s[24:27], s77 offen
    v_mfma_f32_16x16x32_bf16 a[204:207], a[24:27], v[56:59], a[204:207]
    s_add_u32 s77, s77, 4608
    v_mfma_f32_16x16x32_bf16 a[204:207], a[28:31], v[60:63], a[204:207]
    v_mfma_f32_16x16x32_bf16 a[208:211], a[32:35], v[56:59], a[208:211]
    ds_read_b128 a[124:127], v23 offset:22528
    v_mfma_f32_16x16x32_bf16 a[208:211], a[36:39], v[60:63], a[208:211]
    v_mfma_f32_16x16x32_bf16 a[212:215], a[40:43], v[56:59], a[212:215]
    buffer_load_dwordx4 v9, s[8:11], s61 offen offset:3072 lds
    v_mfma_f32_16x16x32_bf16 a[212:215], a[44:47], v[60:63], a[212:215]
    v_mfma_f32_16x16x32_bf16 a[216:219], a[48:51], v[56:59], a[216:219]
    v_mfma_f32_16x16x32_bf16 a[216:219], a[52:55], v[60:63], a[216:219]
    v_mfma_f32_16x16x32_bf16 a[220:223], a[56:59], v[56:59], a[220:223]
    v_mfma_f32_16x16x32_bf16 a[220:223], a[60:63], v[60:63], a[220:223]
    v_mfma_f32_16x16x32_bf16 a[224:227], a[0:3], v[40:43], a[224:227]
    v_mfma_f32_16x16x32_bf16 a[224:227], a[4:7], v[44:47], a[224:227]
    s_add_u32 s61, s61, 128
    v_mfma_f32_16x16x32_bf16 a[228:231], a[8:11], v[40:43], a[228:231]
    s_lshl_b32 s61, s5, 7
    v_mfma_f32_16x16x32_bf16 a[228:231], a[12:15], v[44:47], a[228:231]
    v_mfma_f32_16x16x32_bf16 a[232:235], a[16:19], v[40:43], a[232:235]
    v_mfma_f32_16x16x32_bf16 a[232:235], a[20:23], v[44:47], a[232:235]
    s_waitcnt vmcnt(17)
    s_barrier
    ds_read_b64_tr_b16 v[48:49], v14 offset:32768
    v_mfma_f32_16x16x32_bf16 a[236:239], a[24:27], v[40:43], a[236:239]
    s_add_u32 m0, s69, 131072
    ds_read_b64_tr_b16 v[50:51], v14 offset:33792
    ds_read_b64_tr_b16 v[52:53], v14 offset:40960
    v_mfma_f32_16x16x32_bf16 a[236:239], a[28:31], v[44:47], a[236:239]
    buffer_load_dwordx4 v2, s[16:19], s60 offen nt lds
    v_mfma_f32_16x16x32_bf16 a[240:243], a[32:35], v[40:43], a[240:243]
    ds_read_b64_tr_b16 v[54:55], v14 offset:41984
    ds_read_b64_tr_b16 v[56:57], v15 offset:32768
    v_mfma_f32_16x16x32_bf16 a[240:243], a[36:39], v[44:47], a[240:243]
    ds_read_b64_tr_b16 v[58:59], v15 offset:33792
    ds_read_b64_tr_b16 v[60:61], v15 offset:40960
    v_mfma_f32_16x16x32_bf16 a[244:247], a[40:43], v[40:43], a[244:247]
    ds_read_b64_tr_b16 v[62:63], v15 offset:41984
    v_add_u32 v14, 0x10000, v14
    v_mfma_f32_16x16x32_bf16 a[244:247], a[44:47], v[44:47], a[244:247]
    v_add_u32 v15, 0x10000, v15
    v_mfma_f32_16x16x32_bf16 a[248:251], a[48:51], v[40:43], a[248:251]
    v_mfma_f32_16x16x32_bf16 a[248:251], a[52:55], v[44:47], a[248:251]
    buffer_load_dwordx4 v3, s[16:19], s60 offen offset:1024 nt lds
    v_mfma_f32_16x16x32_bf16 a[252:255], a[56:59], v[40:43], a[252:255]
    ds_read_b64_tr_b16 v[40:41], v16 offset:32768
    ds_read_b64_tr_b16 v[42:43], v16 offset:33792
    v_mfma_f32_16x16x32_bf16 a[252:255], a[60:63], v[44:47], a[252:255]
    s_waitcnt lgkmcnt(2)
    ds_read_b64_tr_b16 v[44:45], v16 offset:40960
    ds_read_b64_tr_b16 v[46:47], v16 offset:41984
    v_mfma_f32_16x16x32_bf16 v[128:131], v[48:51], a[64:67], v[128:131]
    v_add_u32 v16, 0x10000, v16
    v_mfma_f32_16x16x32_bf16 v[128:131], v[52:55], a[68:71], v[128:131]
    v_mfma_f32_16x16x32_bf16 v[132:135], v[48:51], a[72:75], v[132:135]
    ds_read_b128 a[0:3], v22 offset:49152
    v_mfma_f32_16x16x32_bf16 v[132:135], v[52:55], a[76:79], v[132:135]
    v_mfma_f32_16x16x32_bf16 v[136:139], v[48:51], a[80:83], v[136:139]
    v_mfma_f32_16x16x32_bf16 v[136:139], v[52:55], a[84:87], v[136:139]
    buffer_load_dwordx4 v4, s[16:19], s60 offen offset:2048 nt lds
    v_mfma_f32_16x16x32_bf16 v[140:143], v[48:51], a[88:91], v[140:143]
    v_mfma_f32_16x16x32_bf16 v[140:143], v[52:55], a[92:95], v[140:143]
    ds_read_b128 a[4:7], v23 offset:49152
    v_mfma_f32_16x16x32_bf16 v[144:147], v[48:51], a[96:99], v[144:147]
    v_mfma_f32_16x16x32_bf16 v[144:147], v[52:55], a[100:103], v[144:147]
    v_mfma_f32_16x16x32_bf16 v[148:151], v[48:51], a[104:107], v[148:151]
    v_mfma_f32_16x16x32_bf16 v[148:151], v[52:55], a[108:111], v[148:151]
    v_mfma_f32_16x16x32_bf16 v[152:155], v[48:51], a[112:115], v[152:155]
    buffer_load_dwordx4 v5, s[16:19], s60 offen offset:3072 nt lds
    v_mfma_f32_16x16x32_bf16 v[152:155], v[52:55], a[116:119], v[152:155]
    ds_read_b128 a[8:11], v22 offset:51200
    v_mfma_f32_16x16x32_bf16 v[156:159], v[48:51], a[120:123], v[156:159]
    ds_read_b64_tr_b16 v[48:49], v17 offset:32768
    ds_read_b64_tr_b16 v[50:51], v17 offset:33792
    v_mfma_f32_16x16x32_bf16 v[156:159], v[52:55], a[124:127], v[156:159]
    ds_read_b64_tr_b16 v[52:53], v17 offset:40960
    ds_read_b64_tr_b16 v[54:55], v17 offset:41984
    v_mfma_f32_16x16x32_bf16 v[160:163], v[56:59], a[64:67], v[160:163]
    v_add_u32 v17, 0x10000, v17
    v_mfma_f32_16x16x32_bf16 v[160:163], v[60:63], a[68:71], v[160:163]
    v_mfma_f32_16x16x32_bf16 v[164:167], v[56:59], a[72:75], v[164:167]
    ds_read_b128 a[12:15], v23 offset:51200
    v_mfma_f32_16x16x32_bf16 v[164:167], v[60:63], a[76:79], v[164:167]
    s_add_u32 m0, s69, 147456
    v_mfma_f32_16x16x32_bf16 v[168:171], v[56:59], a[80:83], v[168:171]
    s_add_u32 s60, s60, 524288
    buffer_load_dwordx4 v6, s[8:11], s62 offen lds
    v_mfma_f32_16x16x32_bf16 v[168:171], v[60:63], a[84:87], v[168:171]
    v_mov_b32 v6, v96
    v_mfma_f32_16x16x32_bf16 v[172:175], v[56:59], a[88:91], v[172:175]
    v_mfma_f32_16x16x32_bf16 v[172:175], v[60:63], a[92:95], v[172:175]
    v_mfma_f32_16x16x32_bf16 v[176:179], v[56:59], a[96:99], v[176:179]
    ds_read_b128 a[16:19], v22 offset:53248
    v_mfma_f32_16x16x32_bf16 v[176:179], v[60:63], a[100:103], v[176:179]
    v_mfma_f32_16x16x32_bf16 v[180:183], v[56:59], a[104:107], v[180:183]
    v_mfma_f32_16x16x32_bf16 v[180:183], v[60:63], a[108:111], v[180:183]
    buffer_load_dwordx4 v7, s[8:11], s62 offen offset:1024 lds
    v_mfma_f32_16x16x32_bf16 v[184:187], v[56:59], a[112:115], v[184:187]
    v_mfma_f32_16x16x32_bf16 v[184:187], v[60:63], a[116:119], v[184:187]
    ds_read_b128 a[20:23], v23 offset:53248
    v_mfma_f32_16x16x32_bf16 v[188:191], v[56:59], a[120:123], v[188:191]
    v_mfma_f32_16x16x32_bf16 v[188:191], v[60:63], a[124:127], v[188:191]
    s_waitcnt lgkmcnt(1)
    v_mfma_f32_16x16x32_bf16 v[192:195], v[40:43], a[64:67], v[192:195]
    v_mfma_f32_16x16x32_bf16 v[192:195], v[44:47], a[68:71], v[192:195]
    v_mfma_f32_16x16x32_bf16 v[196:199], v[40:43], a[72:75], v[196:199]
    v_mfma_f32_16x16x32_bf16 v[196:199], v[44:47], a[76:79], v[196:199]
    buffer_load_dwordx4 v8, s[8:11], s62 offen offset:2048 lds
    v_mfma_f32_16x16x32_bf16 v[200:203], v[40:43], a[80:83], v[200:203]
    ds_read_b128 a[24:27], v22 offset:55296
    v_bfe_u32 v8, v1, 4, 3
    v_mfma_f32_16x16x32_bf16 v[200:203], v[44:47], a[84:87], v[200:203]
    v_lshlrev_b32 v8, 12, v8
    v_mfma_f32_16x16x32_bf16 v[204:207], v[40:43], a[88:91], v[204:207]
    v_mfma_f32_16x16x32_bf16 v[204:207], v[44:47], a[92:95], v[204:207]
    v_mfma_f32_16x16x32_bf16 v[208:211], v[40:43], a[96:99], v[208:211]
    ds_read_b128 a[28:31], v23 offset:55296
    v_mfma_f32_16x16x32_bf16 v[208:211], v[44:47], a[100:103], v[208:211]
    v_mfma_f32_16x16x32_bf16 v[212:215], v[40:43], a[104:107], v[212:215]
    buffer_load_dwordx4 v9, s[8:11], s62 offen offset:3072 lds
    v_mfma_f32_16x16x32_bf16 v[212:215], v[44:47], a[108:111], v[212:215]
    v_mfma_f32_16x16x32_bf16 v[216:219], v[40:43], a[112:115], v[216:219]
    v_mfma_f32_16x16x32_bf16 v[216:219], v[44:47], a[116:119], v[216:219]
    v_mfma_f32_16x16x32_bf16 v[220:223], v[40:43], a[120:123], v[220:223]
    v_mfma_f32_16x16x32_bf16 v[220:223], v[44:47], a[124:127], v[220:223]
    v_mfma_f32_16x16x32_bf16 v[224:227], v[48:51], a[64:67], v[224:227]
    v_mfma_f32_16x16x32_bf16 v[224:227], v[52:55], a[68:71], v[224:227]
    s_add_u32 s62, s62, 128
    v_mfma_f32_16x16x32_bf16 v[228:231], v[48:51], a[72:75], v[228:231]
    v_mfma_f32_16x16x32_bf16 v[228:231], v[52:55], a[76:79], v[228:231]
    v_mfma_f32_16x16x32_bf16 v[232:235], v[48:51], a[80:83], v[232:235]
    v_mfma_f32_16x16x32_bf16 v[232:235], v[52:55], a[84:87], v[232:235]
    s_waitcnt vmcnt(17)
    s_barrier
    ds_read_b64_tr_b16 v[56:57], v14 offset:0
    v_mfma_f32_16x16x32_bf16 v[236:239], v[48:51], a[88:91], v[236:239]
    s_add_u32 m0, s69, 0
    ds_read_b64_tr_b16 v[58:59], v14 offset:1024
    ds_read_b64_tr_b16 v[60:61], v14 offset:8192
    v_mfma_f32_16x16x32_bf16 v[236:239], v[52:55], a[92:95], v[236:239]
    buffer_load_dwordx4 v2, s[12:15], s60 offen nt lds
    v_mfma_f32_16x16x32_bf16 v[240:243], v[48:51], a[96:99], v[240:243]
    ds_read_b64_tr_b16 v[62:63], v14 offset:9216
    ds_read_b64_tr_b16 v[40:41], v15 offset:0
    v_mfma_f32_16x16x32_bf16 v[240:243], v[52:55], a[100:103], v[240:243]
    ds_read_b64_tr_b16 v[42:43], v15 offset:1024
    ds_read_b64_tr_b16 v[44:45], v15 offset:8192
    v_mfma_f32_16x16x32_bf16 v[244:247], v[48:51], a[104:107], v[244:247]
    ds_read_b64_tr_b16 v[46:47], v15 offset:9216
    v_mfma_f32_16x16x32_bf16 v[244:247], v[52:55], a[108:111], v[244:247]
    v_mfma_f32_16x16x32_bf16 v[248:251], v[48:51], a[112:115], v[248:251]
    v_mfma_f32_16x16x32_bf16 v[248:251], v[52:55], a[116:119], v[248:251]
    buffer_load_dwordx4 v3, s[12:15], s60 offen offset:1024 nt lds
    v_mfma_f32_16x16x32_bf16 v[252:255], v[48:51], a[120:123], v[252:255]
    ds_read_b64_tr_b16 v[48:49], v16 offset:0
    ds_read_b64_tr_b16 v[50:51], v16 offset:1024
    v_mfma_f32_16x16x32_bf16 v[252:255], v[52:55], a[124:127], v[252:255]
    s_waitcnt lgkmcnt(2)
    ds_read_b64_tr_b16 v[52:53], v16 offset:8192
    ds_read_b64_tr_b16 v[54:55], v16 offset:9216
    v_mfma_f32_16x16x32_bf16 a[128:131], a[64:67], v[56:59], a[128:131]
    v_mfma_f32_16x16x32_bf16 a[128:131], a[68:71], v[60:63], a[128:131]
    v_add_u32 v22, 0x10000, v22
    v_mfma_f32_16x16x32_bf16 a[132:135], a[72:75], v[56:59], a[132:135]
    ds_read_b128 a[32:35], v22 offset:16384
    v_mfma_f32_16x16x32_bf16 a[132:135], a[76:79], v[60:63], a[132:135]
    v_mfma_f32_16x16x32_bf16 a[136:139], a[80:83], v[56:59], a[136:139]
    v_mfma_f32_16x16x32_bf16 a[136:139], a[84:87], v[60:63], a[136:139]
    buffer_load_dwordx4 v4, s[12:15], s60 offen offset:2048 nt lds
    v_mfma_f32_16x16x32_bf16 a[140:143], a[88:91], v[56:59], a[140:143]
    v_add_u32 v23, 0x10000, v23
    v_mfma_f32_16x16x32_bf16 a[140:143], a[92:95], v[60:63], a[140:143]
    ds_read_b128 a[36:39], v23 offset:16384
    v_mfma_f32_16x16x32_bf16 a[144:147], a[96:99], v[56:59], a[144:147]
    v_mfma_f32_16x16x32_bf16 a[144:147], a[100:103], v[60:63], a[144:147]
    v_mfma_f32_16x16x32_bf16 a[148:151], a[104:107], v[56:59], a[148:151]
    v_mfma_f32_16x16x32_bf16 a[148:151], a[108:111], v[60:63], a[148:151]
    v_mfma_f32_16x16x32_bf16 a[152:155], a[112:115], v[56:59], a[152:155]
    buffer_load_dwordx4 v5, s[12:15], s60 offen offset:3072 nt lds
    v_mfma_f32_16x16x32_bf16 a[152:155], a[116:119], v[60:63], a[152:155]
    ds_read_b128 a[40:43], v22 offset:18432
    v_mfma_f32_16x16x32_bf16 a[156:159], a[120:123], v[56:59], a[156:159]
    ds_read_b64_tr_b16 v[56:57], v17 offset:0
    ds_read_b64_tr_b16 v[58:59], v17 offset:1024
    v_mfma_f32_16x16x32_bf16 a[156:159], a[124:127], v[60:63], a[156:159]
    ds_read_b64_tr_b16 v[60:61], v17 offset:8192
    ds_read_b64_tr_b16 v[62:63], v17 offset:9216
    v_mfma_f32_16x16x32_bf16 a[160:163], a[64:67], v[40:43], a[160:163]
    v_mfma_f32_16x16x32_bf16 a[160:163], a[68:71], v[44:47], a[160:163]
    v_mfma_f32_16x16x32_bf16 a[164:167], a[72:75], v[40:43], a[164:167]
    ds_read_b128 a[44:47], v23 offset:18432
    v_mfma_f32_16x16x32_bf16 a[164:167], a[76:79], v[44:47], a[164:167]
    s_add_u32 m0, s69, 16384
    v_mfma_f32_16x16x32_bf16 a[168:171], a[80:83], v[40:43], a[168:171]
    buffer_load_dwordx4 v10, s[20:23], s63 offen lds
    v_mfma_f32_16x16x32_bf16 a[168:171], a[84:87], v[44:47], a[168:171]
    v_mfma_f32_16x16x32_bf16 a[172:175], a[88:91], v[40:43], a[172:175]
    v_mfma_f32_16x16x32_bf16 a[172:175], a[92:95], v[44:47], a[172:175]
    v_mfma_f32_16x16x32_bf16 a[176:179], a[96:99], v[40:43], a[176:179]
    ds_read_b128 a[48:51], v22 offset:20480
    v_mfma_f32_16x16x32_bf16 a[176:179], a[100:103], v[44:47], a[176:179]
    v_mfma_f32_16x16x32_bf16 a[180:183], a[104:107], v[40:43], a[180:183]
    v_mfma_f32_16x16x32_bf16 a[180:183], a[108:111], v[44:47], a[180:183]
    buffer_load_dwordx4 v11, s[20:23], s63 offen offset:1024 lds
    v_mfma_f32_16x16x32_bf16 a[184:187], a[112:115], v[40:43], a[184:187]
    v_mfma_f32_16x16x32_bf16 a[184:187], a[116:119], v[44:47], a[184:187]
    ds_read_b128 a[52:55], v23 offset:20480
    v_mfma_f32_16x16x32_bf16 a[188:191], a[120:123], v[40:43], a[188:191]
    v_mfma_f32_16x16x32_bf16 a[188:191], a[124:127], v[44:47], a[188:191]
    s_waitcnt lgkmcnt(1)
    v_mfma_f32_16x16x32_bf16 a[192:195], a[64:67], v[48:51], a[192:195]
    v_mfma_f32_16x16x32_bf16 a[192:195], a[68:71], v[52:55], a[192:195]
    v_mfma_f32_16x16x32_bf16 a[196:199], a[72:75], v[48:51], a[196:199]
    v_mfma_f32_16x16x32_bf16 a[196:199], a[76:79], v[52:55], a[196:199]
    buffer_load_dwordx4 v12, s[20:23], s63 offen offset:2048 lds
    v_mfma_f32_16x16x32_bf16 a[200:203], a[80:83], v[48:51], a[200:203]
    ds_read_b128 a[56:59], v22 offset:22528
    v_mfma_f32_16x16x32_bf16 a[200:203], a[84:87], v[52:55], a[200:203]
    v_mfma_f32_16x16x32_bf16 a[204:207], a[88:91], v[48:51], a[204:207]
    v_mfma_f32_16x16x32_bf16 a[204:207], a[92:95], v[52:55], a[204:207]
    v_mfma_f32_16x16x32_bf16 a[208:211], a[96:99], v[48:51], a[208:211]
    ds_read_b128 a[60:63], v23 offset:22528
    v_mfma_f32_16x16x32_bf16 a[208:211], a[100:103], v[52:55], a[208:211]
    v_mfma_f32_16x16x32_bf16 a[212:215], a[104:107], v[48:51], a[212:215]
    buffer_load_dwordx4 v13, s[20:23], s63 offen offset:3072 lds
    v_mfma_f32_16x16x32_bf16 a[212:215], a[108:111], v[52:55], a[212:215]
    v_mfma_f32_16x16x32_bf16 a[216:219], a[112:115], v[48:51], a[216:219]
    v_mfma_f32_16x16x32_bf16 a[216:219], a[116:119], v[52:55], a[216:219]
    v_mfma_f32_16x16x32_bf16 a[220:223], a[120:123], v[48:51], a[220:223]
    v_mfma_f32_16x16x32_bf16 a[220:223], a[124:127], v[52:55], a[220:223]
    v_mfma_f32_16x16x32_bf16 a[224:227], a[64:67], v[56:59], a[224:227]
    v_mfma_f32_16x16x32_bf16 a[224:227], a[68:71], v[60:63], a[224:227]
    s_add_u32 s63, s63, 128
    v_mfma_f32_16x16x32_bf16 a[228:231], a[72:75], v[56:59], a[228:231]
    buffer_load_dword v109, v103, s[24:27], s77 offen
    v_mfma_f32_16x16x32_bf16 a[228:231], a[76:79], v[60:63], a[228:231]
    s_mov_b32 s77, s75
    v_mfma_f32_16x16x32_bf16 a[232:235], a[80:83], v[56:59], a[232:235]
    v_mfma_f32_16x16x32_bf16 a[232:235], a[84:87], v[60:63], a[232:235]
    s_waitcnt vmcnt(17)
    s_barrier
    ds_read_b64_tr_b16 v[40:41], v14 offset:32768
    v_mfma_f32_16x16x32_bf16 a[236:239], a[88:91], v[56:59], a[236:239]
    s_add_u32 m0, s69, 32768
    buffer_load_dword v7, v30, s[44:47], s95 offen sc1
    v_mfma_f32_16x16x32_bf16 a[236:239], a[92:95], v[60:63], a[236:239]
    buffer_load_dwordx4 v2, s[16:19], s60 offen nt lds
    v_mfma_f32_16x16x32_bf16 a[240:243], a[96:99], v[56:59], a[240:243]
    ds_read_b64_tr_b16 v[42:43], v14 offset:33792
    ds_read_b64_tr_b16 v[44:45], v14 offset:40960
    v_mfma_f32_16x16x32_bf16 a[240:243], a[100:103], v[60:63], a[240:243]
    ds_read_b64_tr_b16 v[46:47], v14 offset:41984
    ds_read_b64_tr_b16 v[48:49], v15 offset:32768
    v_mfma_f32_16x16x32_bf16 a[244:247], a[104:107], v[56:59], a[244:247]
    ds_read_b64_tr_b16 v[50:51], v15 offset:33792
    ds_read_b64_tr_b16 v[52:53], v15 offset:40960
    v_mfma_f32_16x16x32_bf16 a[244:247], a[108:111], v[60:63], a[244:247]
    ds_read_b64_tr_b16 v[54:55], v15 offset:41984
    v_add_u32 v14, 0x10000, v14
    v_mfma_f32_16x16x32_bf16 a[248:251], a[112:115], v[56:59], a[248:251]
    v_add_u32 v15, 0x10000, v15
    v_mfma_f32_16x16x32_bf16 a[248:251], a[116:119], v[60:63], a[248:251]
    buffer_load_dwordx4 v3, s[16:19], s60 offen offset:1024 nt lds
    v_mfma_f32_16x16x32_bf16 a[252:255], a[120:123], v[56:59], a[252:255]
    ds_read_b64_tr_b16 v[56:57], v16 offset:32768
    ds_read_b64_tr_b16 v[58:59], v16 offset:33792
    v_mfma_f32_16x16x32_bf16 a[252:255], a[124:127], v[60:63], a[252:255]
    s_waitcnt lgkmcnt(3)
    ds_read_b64_tr_b16 v[60:61], v16 offset:40960
    ds_read_b64_tr_b16 v[62:63], v16 offset:41984
    v_mfma_f32_16x16x32_bf16 v[128:131], v[40:43], a[0:3], v[128:131]
    v_add_u32 v16, 0x10000, v16
    v_mfma_f32_16x16x32_bf16 v[128:131], v[44:47], a[4:7], v[128:131]
    v_mfma_f32_16x16x32_bf16 v[132:135], v[40:43], a[8:11], v[132:135]
    ds_read_b128 a[64:67], v22 offset:49152
    v_mfma_f32_16x16x32_bf16 v[132:135], v[44:47], a[12:15], v[132:135]
    v_mfma_f32_16x16x32_bf16 v[136:139], v[40:43], a[16:19], v[136:139]
    v_mfma_f32_16x16x32_bf16 v[136:139], v[44:47], a[20:23], v[136:139]
    buffer_load_dwordx4 v4, s[16:19], s60 offen offset:2048 nt lds
    v_mfma_f32_16x16x32_bf16 v[140:143], v[40:43], a[24:27], v[140:143]
    v_mfma_f32_16x16x32_bf16 v[140:143], v[44:47], a[28:31], v[140:143]
    ds_read_b128 a[68:71], v23 offset:49152
    v_mfma_f32_16x16x32_bf16 v[144:147], v[40:43], a[32:35], v[144:147]
    v_mfma_f32_16x16x32_bf16 v[144:147], v[44:47], a[36:39], v[144:147]
    v_mfma_f32_16x16x32_bf16 v[148:151], v[40:43], a[40:43], v[148:151]
    v_mfma_f32_16x16x32_bf16 v[148:151], v[44:47], a[44:47], v[148:151]
    v_mfma_f32_16x16x32_bf16 v[152:155], v[40:43], a[48:51], v[152:155]
    buffer_load_dwordx4 v5, s[16:19], s60 offen offset:3072 nt lds
    v_mfma_f32_16x16x32_bf16 v[152:155], v[44:47], a[52:55], v[152:155]
    ds_read_b128 a[72:75], v22 offset:51200
    v_mfma_f32_16x16x32_bf16 v[156:159], v[40:43], a[56:59], v[156:159]
    ds_read_b64_tr_b16 v[40:41], v17 offset:32768
    ds_read_b64_tr_b16 v[42:43], v17 offset:33792
    v_mfma_f32_16x16x32_bf16 v[156:159], v[44:47], a[60:63], v[156:159]
    ds_read_b64_tr_b16 v[44:45], v17 offset:40960
    ds_read_b64_tr_b16 v[46:47], v17 offset:41984
    v_mfma_f32_16x16x32_bf16 v[160:163], v[48:51], a[0:3], v[160:163]
    s_waitcnt lgkmcnt(5)
    v_add_u32 v17, 0x10000, v17
    v_mfma_f32_16x16x32_bf16 v[160:163], v[52:55], a[4:7], v[160:163]
    v_mfma_f32_16x16x32_bf16 v[164:167], v[48:51], a[8:11], v[164:167]
    ds_read_b128 a[76:79], v23 offset:51200
    v_mfma_f32_16x16x32_bf16 v[164:167], v[52:55], a[12:15], v[164:167]
    s_add_u32 m0, s69, 49152
    v_mfma_f32_16x16x32_bf16 v[168:171], v[48:51], a[16:19], v[168:171]
    s_add_u32 s60, s60, 524288
    buffer_load_dwordx4 v10, s[20:23], s64 offen lds
    v_mfma_f32_16x16x32_bf16 v[168:171], v[52:55], a[20:23], v[168:171]
    v_mfma_f32_16x16x32_bf16 v[172:175], v[48:51], a[24:27], v[172:175]
    v_mfma_f32_16x16x32_bf16 v[172:175], v[52:55], a[28:31], v[172:175]
    v_mfma_f32_16x16x32_bf16 v[176:179], v[48:51], a[32:35], v[176:179]
    ds_read_b128 a[80:83], v22 offset:53248
    v_mfma_f32_16x16x32_bf16 v[176:179], v[52:55], a[36:39], v[176:179]
    v_mfma_f32_16x16x32_bf16 v[180:183], v[48:51], a[40:43], v[180:183]
    v_mfma_f32_16x16x32_bf16 v[180:183], v[52:55], a[44:47], v[180:183]
    buffer_load_dwordx4 v11, s[20:23], s64 offen offset:1024 lds
    v_mfma_f32_16x16x32_bf16 v[184:187], v[48:51], a[48:51], v[184:187]
    v_mfma_f32_16x16x32_bf16 v[184:187], v[52:55], a[52:55], v[184:187]
    ds_read_b128 a[84:87], v23 offset:53248
    v_mfma_f32_16x16x32_bf16 v[188:191], v[48:51], a[56:59], v[188:191]
    v_mfma_f32_16x16x32_bf16 v[188:191], v[52:55], a[60:63], v[188:191]
    v_mfma_f32_16x16x32_bf16 v[192:195], v[56:59], a[0:3], v[192:195]
    v_mfma_f32_16x16x32_bf16 v[192:195], v[60:63], a[4:7], v[192:195]
    v_mfma_f32_16x16x32_bf16 v[196:199], v[56:59], a[8:11], v[196:199]
    v_mfma_f32_16x16x32_bf16 v[196:199], v[60:63], a[12:15], v[196:199]
    buffer_load_dwordx4 v12, s[20:23], s64 offen offset:2048 lds
    v_mfma_f32_16x16x32_bf16 v[200:203], v[56:59], a[16:19], v[200:203]
    ds_read_b128 a[88:91], v22 offset:55296
    v_mfma_f32_16x16x32_bf16 v[200:203], v[60:63], a[20:23], v[200:203]
    v_mfma_f32_16x16x32_bf16 v[204:207], v[56:59], a[24:27], v[204:207]
    v_mfma_f32_16x16x32_bf16 v[204:207], v[60:63], a[28:31], v[204:207]
    v_mfma_f32_16x16x32_bf16 v[208:211], v[56:59], a[32:35], v[208:211]
    ds_read_b128 a[92:95], v23 offset:55296
    v_mfma_f32_16x16x32_bf16 v[208:211], v[60:63], a[36:39], v[208:211]
    v_mfma_f32_16x16x32_bf16 v[212:215], v[56:59], a[40:43], v[212:215]
    buffer_load_dwordx4 v13, s[20:23], s64 offen offset:3072 lds
    v_mfma_f32_16x16x32_bf16 v[212:215], v[60:63], a[44:47], v[212:215]
    v_mfma_f32_16x16x32_bf16 v[216:219], v[56:59], a[48:51], v[216:219]
    v_mfma_f32_16x16x32_bf16 v[216:219], v[60:63], a[52:55], v[216:219]
    v_mfma_f32_16x16x32_bf16 v[220:223], v[56:59], a[56:59], v[220:223]
    v_mfma_f32_16x16x32_bf16 v[220:223], v[60:63], a[60:63], v[220:223]
    s_waitcnt lgkmcnt(0)
    v_mfma_f32_16x16x32_bf16 v[224:227], v[40:43], a[0:3], v[224:227]
    v_mfma_f32_16x16x32_bf16 v[224:227], v[44:47], a[4:7], v[224:227]
    s_add_u32 s64, s64, 128
    v_mfma_f32_16x16x32_bf16 v[228:231], v[40:43], a[8:11], v[228:231]
    v_mfma_f32_16x16x32_bf16 v[228:231], v[44:47], a[12:15], v[228:231]
    v_mfma_f32_16x16x32_bf16 v[232:235], v[40:43], a[16:19], v[232:235]
    v_mfma_f32_16x16x32_bf16 v[232:235], v[44:47], a[20:23], v[232:235]
    s_waitcnt vmcnt(18)
    s_barrier
    ds_read_b64_tr_b16 v[48:49], v14 offset:0
    v_mfma_f32_16x16x32_bf16 v[236:239], v[40:43], a[24:27], v[236:239]
    s_add_u32 m0, s69, 65536
    ds_read_b64_tr_b16 v[50:51], v14 offset:1024
    ds_read_b64_tr_b16 v[52:53], v14 offset:8192
    v_mfma_f32_16x16x32_bf16 v[236:239], v[44:47], a[28:31], v[236:239]
    s_lshl_b32 s60, s5, 8
    buffer_load_dwordx4 v2, s[24:27], s60 offen lds
    v_mfma_f32_16x16x32_bf16 v[240:243], v[40:43], a[32:35], v[240:243]
    ds_read_b64_tr_b16 v[54:55], v14 offset:9216
    ds_read_b64_tr_b16 v[56:57], v15 offset:0
    v_mfma_f32_16x16x32_bf16 v[240:243], v[44:47], a[36:39], v[240:243]
    ds_read_b64_tr_b16 v[58:59], v15 offset:1024
    ds_read_b64_tr_b16 v[60:61], v15 offset:8192
    v_mfma_f32_16x16x32_bf16 v[244:247], v[40:43], a[40:43], v[244:247]
    ds_read_b64_tr_b16 v[62:63], v15 offset:9216
    v_add_u32 v14, 0xfffe0000, v14
    v_mfma_f32_16x16x32_bf16 v[244:247], v[44:47], a[44:47], v[244:247]
    v_add_u32 v15, 0xfffe0000, v15
    v_mfma_f32_16x16x32_bf16 v[248:251], v[40:43], a[48:51], v[248:251]
    v_mfma_f32_16x16x32_bf16 v[248:251], v[44:47], a[52:55], v[248:251]
    buffer_load_dwordx4 v3, s[24:27], s60 offen offset:1024 lds
    v_mfma_f32_16x16x32_bf16 v[252:255], v[40:43], a[56:59], v[252:255]
    ds_read_b64_tr_b16 v[40:41], v16 offset:0
    ds_read_b64_tr_b16 v[42:43], v16 offset:1024
    v_mfma_f32_16x16x32_bf16 v[252:255], v[44:47], a[60:63], v[252:255]
    s_waitcnt lgkmcnt(2)
    ds_read_b64_tr_b16 v[44:45], v16 offset:8192
    ds_read_b64_tr_b16 v[46:47], v16 offset:9216
    v_mfma_f32_16x16x32_bf16 a[128:131], a[0:3], v[48:51], a[128:131]
    v_add_u32 v16, 0xfffe0000, v16
    v_mfma_f32_16x16x32_bf16 a[128:131], a[4:7], v[52:55], a[128:131]
    v_add_u32 v22, 0x10000, v22
    v_mfma_f32_16x16x32_bf16 a[132:135], a[8:11], v[48:51], a[132:135]
    ds_read_b128 a[96:99], v22 offset:16384
    v_mfma_f32_16x16x32_bf16 a[132:135], a[12:15], v[52:55], a[132:135]
    v_mfma_f32_16x16x32_bf16 a[136:139], a[16:19], v[48:51], a[136:139]
    v_mfma_f32_16x16x32_bf16 a[136:139], a[20:23], v[52:55], a[136:139]
    buffer_load_dwordx4 v4, s[24:27], s60 offen offset:2048 lds
    v_mfma_f32_16x16x32_bf16 a[140:143], a[24:27], v[48:51], a[140:143]
    v_add_u32 v23, 0x10000, v23
    v_mfma_f32_16x16x32_bf16 a[140:143], a[28:31], v[52:55], a[140:143]
    ds_read_b128 a[100:103], v23 offset:16384
    v_mfma_f32_16x16x32_bf16 a[144:147], a[32:35], v[48:51], a[144:147]
    v_mfma_f32_16x16x32_bf16 a[144:147], a[36:39], v[52:55], a[144:147]
    v_mfma_f32_16x16x32_bf16 a[148:151], a[40:43], v[48:51], a[148:151]
    v_mfma_f32_16x16x32_bf16 a[148:151], a[44:47], v[52:55], a[148:151]
    v_mfma_f32_16x16x32_bf16 a[152:155], a[48:51], v[48:51], a[152:155]
    buffer_load_dwordx4 v5, s[24:27], s60 offen offset:3072 lds
    v_mfma_f32_16x16x32_bf16 a[152:155], a[52:55], v[52:55], a[152:155]
    ds_read_b128 a[104:107], v22 offset:18432
    v_mfma_f32_16x16x32_bf16 a[156:159], a[56:59], v[48:51], a[156:159]
    ds_read_b64_tr_b16 v[48:49], v17 offset:0
    ds_read_b64_tr_b16 v[50:51], v17 offset:1024
    v_mfma_f32_16x16x32_bf16 a[156:159], a[60:63], v[52:55], a[156:159]
    ds_read_b64_tr_b16 v[52:53], v17 offset:8192
    ds_read_b64_tr_b16 v[54:55], v17 offset:9216
    v_mfma_f32_16x16x32_bf16 a[160:163], a[0:3], v[56:59], a[160:163]
    v_add_u32 v17, 0xfffe0000, v17
    v_mfma_f32_16x16x32_bf16 a[160:163], a[4:7], v[60:63], a[160:163]
    v_mfma_f32_16x16x32_bf16 a[164:167], a[8:11], v[56:59], a[164:167]
    ds_read_b128 a[108:111], v23 offset:18432
    v_mfma_f32_16x16x32_bf16 a[164:167], a[12:15], v[60:63], a[164:167]
    s_add_u32 m0, s69, 81920
    v_mfma_f32_16x16x32_bf16 a[168:171], a[16:19], v[56:59], a[168:171]
    s_add_u32 s60, s60, 524288
    buffer_load_dwordx4 v10, s[20:23], s63 offen lds
    v_mfma_f32_16x16x32_bf16 a[168:171], a[20:23], v[60:63], a[168:171]
    v_mfma_f32_16x16x32_bf16 a[172:175], a[24:27], v[56:59], a[172:175]
    v_mfma_f32_16x16x32_bf16 a[172:175], a[28:31], v[60:63], a[172:175]
    v_mfma_f32_16x16x32_bf16 a[176:179], a[32:35], v[56:59], a[176:179]
    ds_read_b128 a[112:115], v22 offset:20480
    v_mfma_f32_16x16x32_bf16 a[176:179], a[36:39], v[60:63], a[176:179]
    v_mfma_f32_16x16x32_bf16 a[180:183], a[40:43], v[56:59], a[180:183]
    v_mfma_f32_16x16x32_bf16 a[180:183], a[44:47], v[60:63], a[180:183]
    buffer_load_dwordx4 v11, s[20:23], s63 offen offset:1024 lds
    v_mfma_f32_16x16x32_bf16 a[184:187], a[48:51], v[56:59], a[184:187]
    v_mfma_f32_16x16x32_bf16 a[184:187], a[52:55], v[60:63], a[184:187]
    ds_read_b128 a[116:119], v23 offset:20480
    v_mfma_f32_16x16x32_bf16 a[188:191], a[56:59], v[56:59], a[188:191]
    v_mfma_f32_16x16x32_bf16 a[188:191], a[60:63], v[60:63], a[188:191]
    s_waitcnt lgkmcnt(1)
    v_mfma_f32_16x16x32_bf16 a[192:195], a[0:3], v[40:43], a[192:195]
    v_mfma_f32_16x16x32_bf16 a[192:195], a[4:7], v[44:47], a[192:195]
    v_mfma_f32_16x16x32_bf16 a[196:199], a[8:11], v[40:43], a[196:199]
    v_mfma_f32_16x16x32_bf16 a[196:199], a[12:15], v[44:47], a[196:199]
    buffer_load_dwordx4 v12, s[20:23], s63 offen offset:2048 lds
    v_mfma_f32_16x16x32_bf16 a[200:203], a[16:19], v[40:43], a[200:203]
    ds_read_b128 a[120:123], v22 offset:22528
    v_mov_b32 v22, v100
    v_mfma_f32_16x16x32_bf16 a[200:203], a[20:23], v[44:47], a[200:203]
    v_add_u32 v22, 0x10000, v22
    v_mfma_f32_16x16x32_bf16 a[204:207], a[24:27], v[40:43], a[204:207]
    v_mfma_f32_16x16x32_bf16 a[204:207], a[28:31], v[44:47], a[204:207]
    v_mfma_f32_16x16x32_bf16 a[208:211], a[32:35], v[40:43], a[208:211]
    ds_read_b128 a[124:127], v23 offset:22528
    v_mov_b32 v23, v101
    v_mfma_f32_16x16x32_bf16 a[208:211], a[36:39], v[44:47], a[208:211]
    v_add_u32 v23, 0x10000, v23
    v_mfma_f32_16x16x32_bf16 a[212:215], a[40:43], v[40:43], a[212:215]
    buffer_load_dwordx4 v13, s[20:23], s63 offen offset:3072 lds
    v_mfma_f32_16x16x32_bf16 a[212:215], a[44:47], v[44:47], a[212:215]
    v_mfma_f32_16x16x32_bf16 a[216:219], a[48:51], v[40:43], a[216:219]
    v_mfma_f32_16x16x32_bf16 a[216:219], a[52:55], v[44:47], a[216:219]
    v_mfma_f32_16x16x32_bf16 a[220:223], a[56:59], v[40:43], a[220:223]
    v_mfma_f32_16x16x32_bf16 a[220:223], a[60:63], v[44:47], a[220:223]
    v_mfma_f32_16x16x32_bf16 a[224:227], a[0:3], v[48:51], a[224:227]
    v_mfma_f32_16x16x32_bf16 a[224:227], a[4:7], v[52:55], a[224:227]
    s_add_u32 s63, s63, 128
    v_mfma_f32_16x16x32_bf16 a[228:231], a[8:11], v[48:51], a[228:231]
    v_mfma_f32_16x16x32_bf16 a[228:231], a[12:15], v[52:55], a[228:231]
    v_mfma_f32_16x16x32_bf16 a[232:235], a[16:19], v[48:51], a[232:235]
    v_mfma_f32_16x16x32_bf16 a[232:235], a[20:23], v[52:55], a[232:235]
    s_add_u32 m0, s67, 98304
    s_waitcnt vmcnt(16)
    v_cmp_gt_u32 vcc, 8, v7
    s_nop 1
    s_and_b64 vcc, vcc, s[86:87]
    s_cbranch_scc1 SPIN_WA
BACK_WA:
    s_barrier
    v_mfma_f32_16x16x32_bf16 a[236:239], a[24:27], v[48:51], a[236:239]
    buffer_load_dwordx4 v1, s[28:31], s65 offen sc1 lds
    v_mfma_f32_16x16x32_bf16 a[236:239], a[28:31], v[52:55], a[236:239]
    ds_read_b64_tr_b16 v[56:57], v14 offset:0
    ds_read_b64_tr_b16 v[58:59], v14 offset:1024
    v_mfma_f32_16x16x32_bf16 a[240:243], a[32:35], v[48:51], a[240:243]
    ds_read_b64_tr_b16 v[60:61], v14 offset:8192
    ds_read_b64_tr_b16 v[62:63], v14 offset:9216
    v_mfma_f32_16x16x32_bf16 a[240:243], a[36:39], v[52:55], a[240:243]
    ds_read_b64_tr_b16 v[40:41], v15 offset:0
    ds_read_b64_tr_b16 v[42:43], v15 offset:1024
    v_mfma_f32_16x16x32_bf16 a[244:247], a[40:43], v[48:51], a[244:247]
    ds_read_b64_tr_b16 v[44:45], v15 offset:8192
    ds_read_b64_tr_b16 v[46:47], v15 offset:9216
    v_mfma_f32_16x16x32_bf16 a[244:247], a[44:47], v[52:55], a[244:247]
    v_mfma_f32_16x16x32_bf16 a[248:251], a[48:51], v[48:51], a[248:251]
    v_mfma_f32_16x16x32_bf16 a[248:251], a[52:55], v[52:55], a[248:251]
    v_mfma_f32_16x16x32_bf16 a[252:255], a[56:59], v[48:51], a[252:255]
    buffer_load_dwordx4 v1, s[28:31], s65 offen offset:1024 sc1 lds
    v_mfma_f32_16x16x32_bf16 a[252:255], a[60:63], v[52:55], a[252:255]
    s_waitcnt lgkmcnt(0)
    ds_read_b64_tr_b16 v[48:49], v16 offset:0
    ds_read_b64_tr_b16 v[50:51], v16 offset:1024
    v_mfma_f32_16x16x32_bf16 v[128:131], v[56:59], a[64:67], v[128:131]
    ds_read_b64_tr_b16 v[52:53], v16 offset:8192
    ds_read_b64_tr_b16 v[54:55], v16 offset:9216
    v_mfma_f32_16x16x32_bf16 v[128:131], v[60:63], a[68:71], v[128:131]
    v_mfma_f32_16x16x32_bf16 v[132:135], v[56:59], a[72:75], v[132:135]
    ds_read_b128 v[64:67], v24 offset:16384
    v_mfma_f32_16x16x32_bf16 v[132:135], v[60:63], a[76:79], v[132:135]
    v_mfma_f32_16x16x32_bf16 v[136:139], v[56:59], a[80:83], v[136:139]
    v_mfma_f32_16x16x32_bf16 v[136:139], v[60:63], a[84:87], v[136:139]
    v_mfma_f32_16x16x32_bf16 v[140:143], v[56:59], a[88:91], v[140:143]
    s_add_u32 m0, s68, 106496
    v_mfma_f32_16x16x32_bf16 v[140:143], v[60:63], a[92:95], v[140:143]
    buffer_load_dwordx4 v6, s[20:23], s66 offen lds
    v_mfma_f32_16x16x32_bf16 v[144:147], v[56:59], a[96:99], v[144:147]
    v_cvt_pk_bf16_f32 v128, v128, v129
    v_cvt_pk_bf16_f32 v130, v130, v131
    v_mfma_f32_16x16x32_bf16 v[144:147], v[60:63], a[100:103], v[144:147]
    v_accvgpr_write_b32 a0, v128
    v_accvgpr_write_b32 a1, v130
    v_mfma_f32_16x16x32_bf16 v[148:151], v[56:59], a[104:107], v[148:151]
    v_cvt_pk_bf16_f32 v132, v132, v133
    v_cvt_pk_bf16_f32 v134, v134, v135
    v_mfma_f32_16x16x32_bf16 v[148:151], v[60:63], a[108:111], v[148:151]
    v_accvgpr_write_b32 a8, v132
    v_accvgpr_write_b32 a9, v134
    v_mfma_f32_16x16x32_bf16 v[152:155], v[56:59], a[112:115], v[152:155]
    v_cvt_pk_bf16_f32 v136, v136, v137
    v_cvt_pk_bf16_f32 v138, v138, v139
    v_mfma_f32_16x16x32_bf16 v[152:155], v[60:63], a[116:119], v[152:155]
    ds_read_b128 v[68:71], v25 offset:16384
    v_accvgpr_write_b32 a16, v136
    v_mfma_f32_16x16x32_bf16 v[156:159], v[56:59], a[120:123], v[156:159]
    s_add_u32 m0, s69, 114688
    ds_read_b64_tr_b16 v[56:57], v17 offset:0
    ds_read_b64_tr_b16 v[58:59], v17 offset:1024
    v_mfma_f32_16x16x32_bf16 v[156:159], v[60:63], a[124:127], v[156:159]
    s_add_u32 s65, s65, 8192
    buffer_load_dwordx4 v10, s[20:23], s64 offen lds
    v_mfma_f32_16x16x32_bf16 v[160:163], v[40:43], a[64:67], v[160:163]
    s_add_u32 s66, s66, 128
    ds_read_b64_tr_b16 v[60:61], v17 offset:8192
    ds_read_b64_tr_b16 v[62:63], v17 offset:9216
    v_mfma_f32_16x16x32_bf16 v[160:163], v[44:47], a[68:71], v[160:163]
    v_accvgpr_write_b32 a17, v138
    v_cvt_pk_bf16_f32 v140, v140, v141
    v_mfma_f32_16x16x32_bf16 v[164:167], v[40:43], a[72:75], v[164:167]
    v_cvt_pk_bf16_f32 v142, v142, v143
    v_accvgpr_write_b32 a24, v140
    v_mfma_f32_16x16x32_bf16 v[164:167], v[44:47], a[76:79], v[164:167]
    v_accvgpr_write_b32 a25, v142
    v_cvt_pk_bf16_f32 v144, v144, v145
    v_mfma_f32_16x16x32_bf16 v[168:171], v[40:43], a[80:83], v[168:171]
    v_cvt_pk_bf16_f32 v160, v160, v161
    v_cvt_pk_bf16_f32 v162, v162, v163
    v_mfma_f32_16x16x32_bf16 v[168:171], v[44:47], a[84:87], v[168:171]
    v_accvgpr_write_b32 a2, v160
    v_accvgpr_write_b32 a3, v162
    v_mfma_f32_16x16x32_bf16 v[172:175], v[40:43], a[88:91], v[172:175]
    v_cvt_pk_bf16_f32 v164, v164, v165
    v_cvt_pk_bf16_f32 v166, v166, v167
    v_mfma_f32_16x16x32_bf16 v[172:175], v[44:47], a[92:95], v[172:175]
    v_accvgpr_write_b32 a10, v164
    v_accvgpr_write_b32 a11, v166
    v_mfma_f32_16x16x32_bf16 v[176:179], v[40:43], a[96:99], v[176:179]
    buffer_load_dwordx4 v11, s[20:23], s64 offen offset:1024 lds
    v_mfma_f32_16x16x32_bf16 v[176:179], v[44:47], a[100:103], v[176:179]
    ds_read_b128 v[72:75], v24 offset:24576
    v_cvt_pk_bf16_f32 v168, v168, v169
    v_mfma_f32_16x16x32_bf16 v[180:183], v[40:43], a[104:107], v[180:183]
    v_cvt_pk_bf16_f32 v170, v170, v171
    v_accvgpr_write_b32 a18, v168
    v_mfma_f32_16x16x32_bf16 v[180:183], v[44:47], a[108:111], v[180:183]
    v_accvgpr_write_b32 a19, v170
    v_cvt_pk_bf16_f32 v146, v146, v147
    v_mfma_f32_16x16x32_bf16 v[184:187], v[40:43], a[112:115], v[184:187]
    v_accvgpr_write_b32 a32, v144
    v_accvgpr_write_b32 a33, v146
    v_mfma_f32_16x16x32_bf16 v[184:187], v[44:47], a[116:119], v[184:187]
    v_cvt_pk_bf16_f32 v148, v148, v149
    v_cvt_pk_bf16_f32 v150, v150, v151
    v_mfma_f32_16x16x32_bf16 v[188:191], v[40:43], a[120:123], v[188:191]
    v_accvgpr_write_b32 a40, v148
    v_accvgpr_write_b32 a41, v150
    v_mfma_f32_16x16x32_bf16 v[188:191], v[44:47], a[124:127], v[188:191]
    s_waitcnt lgkmcnt(0)
    v_cvt_pk_bf16_f32 v152, v152, v153
    v_cvt_pk_bf16_f32 v154, v154, v155
    v_mfma_f32_16x16x32_bf16 v[192:195], v[48:51], a[64:67], v[192:195]
    buffer_load_dwordx4 v12, s[20:23], s64 offen offset:2048 lds
    v_mfma_f32_16x16x32_bf16 v[192:195], v[52:55], a[68:71], v[192:195]
    v_accvgpr_write_b32 a48, v152
    v_accvgpr_write_b32 a49, v154
    v_mfma_f32_16x16x32_bf16 v[196:199], v[48:51], a[72:75], v[196:199]
    v_cvt_pk_bf16_f32 v156, v156, v157
    v_cvt_pk_bf16_f32 v158, v158, v159
    v_mfma_f32_16x16x32_bf16 v[196:199], v[52:55], a[76:79], v[196:199]
    ds_read_b128 v[76:79], v25 offset:24576
    v_accvgpr_write_b32 a56, v156
    v_mfma_f32_16x16x32_bf16 v[200:203], v[48:51], a[80:83], v[200:203]
    v_accvgpr_write_b32 a57, v158
    v_cvt_pk_bf16_f32 v172, v172, v173
    v_mfma_f32_16x16x32_bf16 v[200:203], v[52:55], a[84:87], v[200:203]
    v_cvt_pk_bf16_f32 v174, v174, v175
    v_accvgpr_write_b32 a26, v172
    v_mfma_f32_16x16x32_bf16 v[204:207], v[48:51], a[88:91], v[204:207]
    v_accvgpr_write_b32 a27, v174
    v_cvt_pk_bf16_f32 v176, v176, v177
    v_mfma_f32_16x16x32_bf16 v[204:207], v[52:55], a[92:95], v[204:207]
    v_cvt_pk_bf16_f32 v178, v178, v179
    v_accvgpr_write_b32 a34, v176
    v_mfma_f32_16x16x32_bf16 v[208:211], v[48:51], a[96:99], v[208:211]
    v_accvgpr_write_b32 a35, v178
    v_cvt_pk_bf16_f32 v180, v180, v181
    v_mfma_f32_16x16x32_bf16 v[208:211], v[52:55], a[100:103], v[208:211]
    buffer_load_dwordx4 v13, s[20:23], s64 offen offset:3072 lds
    v_mfma_f32_16x16x32_bf16 v[212:215], v[48:51], a[104:107], v[212:215]
    v_cvt_pk_bf16_f32 v182, v182, v183
    v_accvgpr_write_b32 a42, v180
    v_mfma_f32_16x16x32_bf16 v[212:215], v[52:55], a[108:111], v[212:215]
    v_accvgpr_write_b32 a43, v182
    v_cvt_pk_bf16_f32 v184, v184, v185
    v_mfma_f32_16x16x32_bf16 v[216:219], v[48:51], a[112:115], v[216:219]
    v_cvt_pk_bf16_f32 v186, v186, v187
    v_accvgpr_write_b32 a50, v184
    v_mfma_f32_16x16x32_bf16 v[216:219], v[52:55], a[116:119], v[216:219]
    v_accvgpr_write_b32 a51, v186
    v_cvt_pk_bf16_f32 v188, v188, v189
    v_mfma_f32_16x16x32_bf16 v[220:223], v[48:51], a[120:123], v[220:223]
    v_cvt_pk_bf16_f32 v190, v190, v191
    v_accvgpr_write_b32 a58, v188
    v_mfma_f32_16x16x32_bf16 v[220:223], v[52:55], a[124:127], v[220:223]
    v_accvgpr_write_b32 a59, v190
    v_cvt_pk_bf16_f32 v192, v192, v193
    v_mfma_f32_16x16x32_bf16 v[224:227], v[56:59], a[64:67], v[224:227]
    v_cvt_pk_bf16_f32 v194, v194, v195
    v_accvgpr_write_b32 a4, v192
    v_mfma_f32_16x16x32_bf16 v[224:227], v[60:63], a[68:71], v[224:227]
    s_add_u32 s64, s64, 128
    v_accvgpr_write_b32 a5, v194
    v_cvt_pk_bf16_f32 v196, v196, v197
    v_mfma_f32_16x16x32_bf16 v[228:231], v[56:59], a[72:75], v[228:231]
    v_cvt_pk_bf16_f32 v198, v198, v199
    v_accvgpr_write_b32 a12, v196
    v_mfma_f32_16x16x32_bf16 v[228:231], v[60:63], a[76:79], v[228:231]
    v_accvgpr_write_b32 a13, v198
    v_cvt_pk_bf16_f32 v200, v200, v201
    v_mfma_f32_16x16x32_bf16 v[232:235], v[56:59], a[80:83], v[232:235]
    v_cvt_pk_bf16_f32 v202, v202, v203
    v_accvgpr_write_b32 a20, v200
    v_mfma_f32_16x16x32_bf16 v[232:235], v[60:63], a[84:87], v[232:235]
    s_waitcnt vmcnt(15)
    s_barrier
    ds_read_b64_tr_b16 v[40:41], v14 offset:32768
    v_mfma_f32_16x16x32_bf16 v[236:239], v[56:59], a[88:91], v[236:239]
    s_add_u32 m0, s69, 131072
    ds_read_b64_tr_b16 v[42:43], v14 offset:33792
    ds_read_b64_tr_b16 v[44:45], v14 offset:40960
    v_mfma_f32_16x16x32_bf16 v[236:239], v[60:63], a[92:95], v[236:239]
    buffer_load_dwordx4 v2, s[24:27], s60 offen lds
    v_mfma_f32_16x16x32_bf16 v[240:243], v[56:59], a[96:99], v[240:243]
    ds_read_b64_tr_b16 v[46:47], v14 offset:41984
    ds_read_b64_tr_b16 v[48:49], v15 offset:32768
    v_mfma_f32_16x16x32_bf16 v[240:243], v[60:63], a[100:103], v[240:243]
    ds_read_b64_tr_b16 v[50:51], v15 offset:33792
    ds_read_b64_tr_b16 v[52:53], v15 offset:40960
    v_mfma_f32_16x16x32_bf16 v[244:247], v[56:59], a[104:107], v[244:247]
    ds_read_b64_tr_b16 v[54:55], v15 offset:41984
    v_xor_b32 v14, s73, v14
    v_mfma_f32_16x16x32_bf16 v[244:247], v[60:63], a[108:111], v[244:247]
    v_add_u32 v14, 0x10000, v14
    v_xor_b32 v15, s73, v15
    v_mfma_f32_16x16x32_bf16 v[248:251], v[56:59], a[112:115], v[248:251]
    v_add_u32 v15, 0x10000, v15
    v_accvgpr_write_b32 a21, v202
    v_mfma_f32_16x16x32_bf16 v[248:251], v[60:63], a[116:119], v[248:251]
    buffer_load_dwordx4 v3, s[24:27], s60 offen offset:1024 lds
    v_mfma_f32_16x16x32_bf16 v[252:255], v[56:59], a[120:123], v[252:255]
    ds_read_b64_tr_b16 v[56:57], v16 offset:32768
    ds_read_b64_tr_b16 v[58:59], v16 offset:33792
    v_mfma_f32_16x16x32_bf16 v[252:255], v[60:63], a[124:127], v[252:255]
    s_waitcnt lgkmcnt(2)
    ds_read_b64_tr_b16 v[60:61], v16 offset:40960
    ds_read_b64_tr_b16 v[62:63], v16 offset:41984
    v_mfma_f32_16x16x32_bf16 a[128:131], a[64:67], v[40:43], a[128:131]
    v_xor_b32 v16, s73, v16
    v_add_u32 v16, 0x10000, v16
    v_mfma_f32_16x16x32_bf16 a[128:131], a[68:71], v[44:47], a[128:131]
    v_cvt_pk_bf16_f32 v204, v204, v205
    v_cvt_pk_bf16_f32 v206, v206, v207
    v_mfma_f32_16x16x32_bf16 a[132:135], a[72:75], v[40:43], a[132:135]
    ds_read_b128 v[80:83], v24 offset:49152
    v_accvgpr_write_b32 a28, v204
    v_mfma_f32_16x16x32_bf16 a[132:135], a[76:79], v[44:47], a[132:135]
    v_accvgpr_write_b32 a29, v206
    v_cvt_pk_bf16_f32 v208, v208, v209
    v_mfma_f32_16x16x32_bf16 a[136:139], a[80:83], v[40:43], a[136:139]
    v_cvt_pk_bf16_f32 v210, v210, v211
    v_accvgpr_write_b32 a36, v208
    v_mfma_f32_16x16x32_bf16 a[136:139], a[84:87], v[44:47], a[136:139]
    buffer_load_dwordx4 v4, s[24:27], s60 offen offset:2048 lds
    v_mfma_f32_16x16x32_bf16 a[140:143], a[88:91], v[40:43], a[140:143]
    v_accvgpr_write_b32 a37, v210
    v_cvt_pk_bf16_f32 v212, v212, v213
    v_mfma_f32_16x16x32_bf16 a[140:143], a[92:95], v[44:47], a[140:143]
    v_cvt_pk_bf16_f32 v214, v214, v215
    v_accvgpr_write_b32 a44, v212
    v_mfma_f32_16x16x32_bf16 a[144:147], a[96:99], v[40:43], a[144:147]
    v_accvgpr_write_b32 a45, v214
    v_cvt_pk_bf16_f32 v216, v216, v217
    v_mfma_f32_16x16x32_bf16 a[144:147], a[100:103], v[44:47], a[144:147]
    v_cvt_pk_bf16_f32 v218, v218, v219
    v_accvgpr_write_b32 a52, v216
    v_mfma_f32_16x16x32_bf16 a[148:151], a[104:107], v[40:43], a[148:151]
    v_accvgpr_write_b32 a53, v218
    v_cvt_pk_bf16_f32 v220, v220, v221
    v_mfma_f32_16x16x32_bf16 a[148:151], a[108:111], v[44:47], a[148:151]
    v_cvt_pk_bf16_f32 v222, v222, v223
    v_accvgpr_write_b32 a60, v220
    v_mfma_f32_16x16x32_bf16 a[152:155], a[112:115], v[40:43], a[152:155]
    buffer_load_dwordx4 v5, s[24:27], s60 offen offset:3072 lds
    v_mfma_f32_16x16x32_bf16 a[152:155], a[116:119], v[44:47], a[152:155]
    ds_read_b128 v[84:87], v25 offset:49152
    v_accvgpr_write_b32 a61, v222
    v_mfma_f32_16x16x32_bf16 a[156:159], a[120:123], v[40:43], a[156:159]
    ds_read_b64_tr_b16 v[40:41], v17 offset:32768
    ds_read_b64_tr_b16 v[42:43], v17 offset:33792
    v_mfma_f32_16x16x32_bf16 a[156:159], a[124:127], v[44:47], a[156:159]
    s_add_u32 s72, s70, 0
    ds_read_b64_tr_b16 v[44:45], v17 offset:40960
    ds_read_b64_tr_b16 v[46:47], v17 offset:41984
    v_mfma_f32_16x16x32_bf16 a[160:163], a[64:67], v[48:51], a[160:163]
    v_xor_b32 v17, s73, v17
    v_add_u32 v17, 0x10000, v17
    v_mfma_f32_16x16x32_bf16 a[160:163], a[68:71], v[52:55], a[160:163]
    buffer_store_dwordx4 a[0:3], v1, s[36:39], s72 offen sc1
    v_mfma_f32_16x16x32_bf16 a[164:167], a[72:75], v[48:51], a[164:167]
    v_cvt_pk_bf16_f32 v224, v224, v225
    v_cvt_pk_bf16_f32 v226, v226, v227
    v_mfma_f32_16x16x32_bf16 a[164:167], a[76:79], v[52:55], a[164:167]
    s_add_u32 m0, s69, 147456
    v_accvgpr_write_b32 a6, v224
    v_accvgpr_write_b32 a7, v226
    v_mfma_f32_16x16x32_bf16 a[168:171], a[80:83], v[48:51], a[168:171]
    s_add_u32 s60, s60, 524288
    buffer_load_dwordx4 v10, s[20:23], s63 offen lds
    v_mfma_f32_16x16x32_bf16 a[168:171], a[84:87], v[52:55], a[168:171]
    v_cvt_pk_bf16_f32 v228, v228, v229
    v_cvt_pk_bf16_f32 v230, v230, v231
    v_mfma_f32_16x16x32_bf16 a[172:175], a[88:91], v[48:51], a[172:175]
    v_accvgpr_write_b32 a14, v228
    v_accvgpr_write_b32 a15, v230
    v_mfma_f32_16x16x32_bf16 a[172:175], a[92:95], v[52:55], a[172:175]
    v_cvt_pk_bf16_f32 v232, v232, v233
    v_cvt_pk_bf16_f32 v234, v234, v235
    v_mfma_f32_16x16x32_bf16 a[176:179], a[96:99], v[48:51], a[176:179]
    ds_read_b128 v[88:91], v24 offset:57344
    v_accvgpr_write_b32 a22, v232
    v_mfma_f32_16x16x32_bf16 a[176:179], a[100:103], v[52:55], a[176:179]
    v_accvgpr_write_b32 a23, v234
    v_cvt_pk_bf16_f32 v236, v236, v237
    v_mfma_f32_16x16x32_bf16 a[180:183], a[104:107], v[48:51], a[180:183]
    v_cvt_pk_bf16_f32 v238, v238, v239
    v_accvgpr_write_b32 a30, v236
    v_mfma_f32_16x16x32_bf16 a[180:183], a[108:111], v[52:55], a[180:183]
    buffer_load_dwordx4 v11, s[20:23], s63 offen offset:1024 lds
    v_mfma_f32_16x16x32_bf16 a[184:187], a[112:115], v[48:51], a[184:187]
    v_accvgpr_write_b32 a31, v238
    v_cvt_pk_bf16_f32 v240, v240, v241
    v_mfma_f32_16x16x32_bf16 a[184:187], a[116:119], v[52:55], a[184:187]
    v_cvt_pk_bf16_f32 v242, v242, v243
    v_accvgpr_write_b32 a38, v240
    v_mfma_f32_16x16x32_bf16 a[188:191], a[120:123], v[48:51], a[188:191]
    v_accvgpr_write_b32 a39, v242
    v_cvt_pk_bf16_f32 v244, v244, v245
    v_mfma_f32_16x16x32_bf16 a[188:191], a[124:127], v[52:55], a[188:191]
    s_waitcnt lgkmcnt(0)
    v_cvt_pk_bf16_f32 v246, v246, v247
    v_accvgpr_write_b32 a46, v244
    v_mfma_f32_16x16x32_bf16 a[192:195], a[64:67], v[56:59], a[192:195]
    s_add_u32 s72, s70, 4096
    v_accvgpr_write_b32 a47, v246
    v_cvt_pk_bf16_f32 v248, v248, v249
    v_mfma_f32_16x16x32_bf16 a[192:195], a[68:71], v[60:63], a[192:195]
    buffer_store_dwordx4 a[8:11], v1, s[36:39], s72 offen sc1
    v_mfma_f32_16x16x32_bf16 a[196:199], a[72:75], v[56:59], a[196:199]
    v_cvt_pk_bf16_f32 v250, v250, v251
    v_accvgpr_write_b32 a54, v248
    v_mfma_f32_16x16x32_bf16 a[196:199], a[76:79], v[60:63], a[196:199]
    buffer_load_dwordx4 v12, s[20:23], s63 offen offset:2048 lds
    v_mfma_f32_16x16x32_bf16 a[200:203], a[80:83], v[56:59], a[200:203]
    ds_read_b128 v[92:95], v25 offset:57344
    v_accvgpr_write_b32 a55, v250
    v_mfma_f32_16x16x32_bf16 a[200:203], a[84:87], v[60:63], a[200:203]
    v_cvt_pk_bf16_f32 v252, v252, v253
    v_cvt_pk_bf16_f32 v254, v254, v255
    v_mfma_f32_16x16x32_bf16 a[204:207], a[88:91], v[56:59], a[204:207]
    v_accvgpr_write_b32 a62, v252
    v_accvgpr_write_b32 a63, v254
    v_mfma_f32_16x16x32_bf16 a[204:207], a[92:95], v[60:63], a[204:207]
    v_accvgpr_write_b32 a0, 0
    v_accvgpr_write_b32 a1, 0
    v_mfma_f32_16x16x32_bf16 a[208:211], a[96:99], v[56:59], a[208:211]
    v_accvgpr_read_b32 v32, a128
    v_accvgpr_read_b32 v31, a129
    v_mfma_f32_16x16x32_bf16 a[208:211], a[100:103], v[60:63], a[208:211]
    v_cvt_pk_bf16_f32 v32, v32, v31
    v_accvgpr_read_b32 v33, a130
    v_mfma_f32_16x16x32_bf16 a[212:215], a[104:107], v[56:59], a[212:215]
    buffer_load_dwordx4 v13, s[20:23], s63 offen offset:3072 lds
    v_mfma_f32_16x16x32_bf16 a[212:215], a[108:111], v[60:63], a[212:215]
    v_accvgpr_read_b32 v31, a131
    v_cvt_pk_bf16_f32 v33, v33, v31
    v_mfma_f32_16x16x32_bf16 a[216:219], a[112:115], v[56:59], a[216:219]
    v_accvgpr_read_b32 v34, a132
    v_accvgpr_read_b32 v31, a133
    v_mfma_f32_16x16x32_bf16 a[216:219], a[116:119], v[60:63], a[216:219]
    v_cvt_pk_bf16_f32 v34, v34, v31
    v_accvgpr_read_b32 v35, a134
    v_mfma_f32_16x16x32_bf16 a[220:223], a[120:123], v[56:59], a[220:223]
    v_accvgpr_read_b32 v31, a135
    v_cvt_pk_bf16_f32 v35, v35, v31
    v_mfma_f32_16x16x32_bf16 a[220:223], a[124:127], v[60:63], a[220:223]
    v_accvgpr_write_b32 a2, 0
    v_accvgpr_write_b32 a3, 0
    v_mfma_f32_16x16x32_bf16 a[224:227], a[64:67], v[40:43], a[224:227]
    v_accvgpr_write_b32 a8, 0
    v_accvgpr_write_b32 a9, 0
    v_mfma_f32_16x16x32_bf16 a[224:227], a[68:71], v[44:47], a[224:227]
    s_add_u32 s63, s63, 128
    v_accvgpr_write_b32 a10, 0
    v_accvgpr_write_b32 a11, 0
    v_mfma_f32_16x16x32_bf16 a[228:231], a[72:75], v[40:43], a[228:231]
    s_add_u32 s72, s71, 0
    buffer_store_dwordx4 v[32:35], v1, s[36:39], s72 offen sc1
    v_mfma_f32_16x16x32_bf16 a[228:231], a[76:79], v[44:47], a[228:231]
    v_mfma_f32_16x16x32_bf16 a[232:235], a[80:83], v[40:43], a[232:235]
    v_mfma_f32_16x16x32_bf16 a[232:235], a[84:87], v[44:47], a[232:235]
    s_waitcnt vmcnt(18)
    s_barrier
    ds_read_b64_tr_b16 v[48:49], v14 offset:0
    v_mfma_f32_16x16x32_bf16 a[236:239], a[88:91], v[40:43], a[236:239]
    s_add_u32 m0, s67, 0
    ds_read_b64_tr_b16 v[50:51], v14 offset:1024
    ds_read_b64_tr_b16 v[52:53], v14 offset:8192
    v_mfma_f32_16x16x32_bf16 a[236:239], a[92:95], v[44:47], a[236:239]
    buffer_load_dwordx4 v1, s[28:31], s65 offen sc1 lds
    v_mfma_f32_16x16x32_bf16 a[240:243], a[96:99], v[40:43], a[240:243]
    ds_read_b64_tr_b16 v[54:55], v14 offset:9216
    ds_read_b64_tr_b16 v[56:57], v15 offset:0
    v_mfma_f32_16x16x32_bf16 a[240:243], a[100:103], v[44:47], a[240:243]
    ds_read_b64_tr_b16 v[58:59], v15 offset:1024
    ds_read_b64_tr_b16 v[60:61], v15 offset:8192
    v_mfma_f32_16x16x32_bf16 a[244:247], a[104:107], v[40:43], a[244:247]
    ds_read_b64_tr_b16 v[62:63], v15 offset:9216
    v_add_u32 v14, 0x10000, v14
    v_mfma_f32_16x16x32_bf16 a[244:247], a[108:111], v[44:47], a[244:247]
    v_add_u32 v15, 0x10000, v15
    v_mfma_f32_16x16x32_bf16 a[248:251], a[112:115], v[40:43], a[248:251]
    v_mfma_f32_16x16x32_bf16 a[248:251], a[116:119], v[44:47], a[248:251]
    v_mfma_f32_16x16x32_bf16 a[252:255], a[120:123], v[40:43], a[252:255]
    buffer_load_dwordx4 v1, s[28:31], s65 offen offset:1024 sc1 lds
    v_mfma_f32_16x16x32_bf16 a[252:255], a[124:127], v[44:47], a[252:255]
    s_waitcnt lgkmcnt(0)
    ds_read_b64_tr_b16 v[40:41], v16 offset:0
    ds_read_b64_tr_b16 v[42:43], v16 offset:1024
    v_mfma_f32_16x16x32_bf16 v[128:131], v[48:51], v[64:67], 0
    ds_read_b64_tr_b16 v[44:45], v16 offset:8192
    ds_read_b64_tr_b16 v[46:47], v16 offset:9216
    v_mfma_f32_16x16x32_bf16 v[128:131], v[52:55], v[68:71], v[128:131]
    v_add_u32 v24, 0x10000, v24
    v_add_u32 v16, 0x10000, v16
    v_mfma_f32_16x16x32_bf16 v[132:135], v[48:51], v[72:75], 0
    s_add_u32 s72, s70, 8192
    ds_read_b128 v[96:99], v24 offset:16384
    v_mfma_f32_16x16x32_bf16 v[132:135], v[52:55], v[76:79], v[132:135]
    buffer_store_dwordx4 a[16:19], v1, s[36:39], s72 offen sc1
    v_mfma_f32_16x16x32_bf16 v[136:139], v[48:51], v[80:83], 0
    v_mfma_f32_16x16x32_bf16 v[136:139], v[52:55], v[84:87], v[136:139]
    v_accvgpr_write_b32 a16, 0
    v_accvgpr_write_b32 a17, 0
    v_mfma_f32_16x16x32_bf16 v[140:143], v[48:51], v[88:91], 0
    s_add_u32 m0, s68, 8192
    ds_read_b64_tr_b16 v[48:49], v17 offset:0
    ds_read_b64_tr_b16 v[50:51], v17 offset:1024
    v_mfma_f32_16x16x32_bf16 v[140:143], v[52:55], v[92:95], v[140:143]
    buffer_load_dwordx4 v6, s[20:23], s66 offen lds
    v_mfma_f32_16x16x32_bf16 v[144:147], v[56:59], v[64:67], 0
    ds_read_b64_tr_b16 v[52:53], v17 offset:8192
    ds_read_b64_tr_b16 v[54:55], v17 offset:9216
    v_mfma_f32_16x16x32_bf16 v[144:147], v[60:63], v[68:71], v[144:147]
    v_add_u32 v17, 0x10000, v17
    v_accvgpr_write_b32 a18, 0
    v_mfma_f32_16x16x32_bf16 v[148:151], v[56:59], v[72:75], 0
    v_accvgpr_read_b32 v36, a136
    v_accvgpr_read_b32 v31, a137
    v_mfma_f32_16x16x32_bf16 v[148:151], v[60:63], v[76:79], v[148:151]
    v_cvt_pk_bf16_f32 v36, v36, v31
    v_accvgpr_read_b32 v37, a138
    v_mfma_f32_16x16x32_bf16 v[152:155], v[56:59], v[80:83], 0
    v_add_u32 v25, 0x10000, v25
    v_accvgpr_read_b32 v31, a139
    v_mfma_f32_16x16x32_bf16 v[152:155], v[60:63], v[84:87], v[152:155]
    ds_read_b128 v[100:103], v25 offset:16384
    v_cvt_pk_bf16_f32 v37, v37, v31
    v_mfma_f32_16x16x32_bf16 v[156:159], v[56:59], v[88:91], 0
    s_add_u32 m0, s69, 16384
    ds_read_b64_tr_b16 v[56:57], v18 offset:0
    ds_read_b64_tr_b16 v[58:59], v18 offset:1024
    v_mfma_f32_16x16x32_bf16 v[156:159], v[60:63], v[92:95], v[156:159]
    s_add_u32 s65, s65, 8192
    buffer_load_dwordx4 v10, s[20:23], s64 offen lds
    s_waitcnt lgkmcnt(3)
    v_mfma_f32_16x16x32_bf16 v[160:163], v[40:43], v[64:67], 0
    s_add_u32 s66, s66, 128
    ds_read_b64_tr_b16 v[60:61], v18 offset:8192
    ds_read_b64_tr_b16 v[62:63], v18 offset:9216
    v_mfma_f32_16x16x32_bf16 v[160:163], v[44:47], v[68:71], v[160:163]
    v_add_u32 v18, 0x10000, v18
    v_accvgpr_read_b32 v38, a140
    v_mfma_f32_16x16x32_bf16 v[164:167], v[40:43], v[72:75], 0
    v_accvgpr_read_b32 v31, a141
    v_cvt_pk_bf16_f32 v38, v38, v31
    v_mfma_f32_16x16x32_bf16 v[164:167], v[44:47], v[76:79], v[164:167]
    s_add_u32 s72, s71, 1024
    v_accvgpr_read_b32 v39, a142
    v_accvgpr_read_b32 v31, a143
    v_mfma_f32_16x16x32_bf16 v[168:171], v[40:43], v[80:83], 0
    v_cvt_pk_bf16_f32 v39, v39, v31
    v_accvgpr_write_b32 a19, 0
    v_mfma_f32_16x16x32_bf16 v[168:171], v[44:47], v[84:87], v[168:171]
    buffer_store_dwordx4 v[36:39], v1, s[36:39], s72 offen sc1
    v_mfma_f32_16x16x32_bf16 v[172:175], v[40:43], v[88:91], 0
    ds_read_b64_tr_b16 v[40:41], v19 offset:0
    ds_read_b64_tr_b16 v[42:43], v19 offset:1024
    v_mfma_f32_16x16x32_bf16 v[172:175], v[44:47], v[92:95], v[172:175]
    ds_read_b64_tr_b16 v[44:45], v19 offset:8192
    ds_read_b64_tr_b16 v[46:47], v19 offset:9216
    v_mfma_f32_16x16x32_bf16 v[176:179], v[48:51], v[64:67], 0
    buffer_load_dwordx4 v11, s[20:23], s64 offen offset:1024 lds
    v_mfma_f32_16x16x32_bf16 v[176:179], v[52:55], v[68:71], v[176:179]
    ds_read_b128 v[104:107], v24 offset:24576
    v_add_u32 v19, 0x10000, v19
    v_mfma_f32_16x16x32_bf16 v[180:183], v[48:51], v[72:75], 0
    v_mfma_f32_16x16x32_bf16 v[180:183], v[52:55], v[76:79], v[180:183]
    v_mfma_f32_16x16x32_bf16 v[184:187], v[48:51], v[80:83], 0
    v_mfma_f32_16x16x32_bf16 v[184:187], v[52:55], v[84:87], v[184:187]
    v_mfma_f32_16x16x32_bf16 v[188:191], v[48:51], v[88:91], 0
    ds_read_b64_tr_b16 v[48:49], v20 offset:0
    ds_read_b64_tr_b16 v[50:51], v20 offset:1024
    v_mfma_f32_16x16x32_bf16 v[188:191], v[52:55], v[92:95], v[188:191]
    s_waitcnt lgkmcnt(2)
    ds_read_b64_tr_b16 v[52:53], v20 offset:8192
    ds_read_b64_tr_b16 v[54:55], v20 offset:9216
    v_mfma_f32_16x16x32_bf16 v[192:195], v[56:59], v[64:67], 0
    buffer_load_dwordx4 v12, s[20:23], s64 offen offset:2048 lds
    v_mfma_f32_16x16x32_bf16 v[192:195], v[60:63], v[68:71], v[192:195]
    v_add_u32 v20, 0x10000, v20
    v_mfma_f32_16x16x32_bf16 v[196:199], v[56:59], v[72:75], 0
    v_mfma_f32_16x16x32_bf16 v[196:199], v[60:63], v[76:79], v[196:199]
    ds_read_b128 v[108:111], v25 offset:24576
    v_mfma_f32_16x16x32_bf16 v[200:203], v[56:59], v[80:83], 0
    s_add_u32 s72, s70, 12288
    v_mfma_f32_16x16x32_bf16 v[200:203], v[60:63], v[84:87], v[200:203]
    buffer_store_dwordx4 a[24:27], v1, s[36:39], s72 offen sc1
    v_mfma_f32_16x16x32_bf16 v[204:207], v[56:59], v[88:91], 0
    ds_read_b64_tr_b16 v[56:57], v21 offset:0
    ds_read_b64_tr_b16 v[58:59], v21 offset:1024
    v_mfma_f32_16x16x32_bf16 v[204:207], v[60:63], v[92:95], v[204:207]
    ds_read_b64_tr_b16 v[60:61], v21 offset:8192
    ds_read_b64_tr_b16 v[62:63], v21 offset:9216
    v_mfma_f32_16x16x32_bf16 v[208:211], v[40:43], v[64:67], 0
    v_add_u32 v21, 0x10000, v21
    v_accvgpr_write_b32 a24, 0
    v_mfma_f32_16x16x32_bf16 v[208:211], v[44:47], v[68:71], v[208:211]
    buffer_load_dwordx4 v13, s[20:23], s64 offen offset:3072 lds
    v_mfma_f32_16x16x32_bf16 v[212:215], v[40:43], v[72:75], 0
    v_accvgpr_write_b32 a25, 0
    v_accvgpr_write_b32 a26, 0
    v_mfma_f32_16x16x32_bf16 v[212:215], v[44:47], v[76:79], v[212:215]
    v_accvgpr_write_b32 a27, 0
    v_mfma_f32_16x16x32_bf16 v[216:219], v[40:43], v[80:83], 0
    v_mfma_f32_16x16x32_bf16 v[216:219], v[44:47], v[84:87], v[216:219]
    v_mfma_f32_16x16x32_bf16 v[220:223], v[40:43], v[88:91], 0
    v_mfma_f32_16x16x32_bf16 v[220:223], v[44:47], v[92:95], v[220:223]
    s_waitcnt lgkmcnt(0)
    v_mfma_f32_16x16x32_bf16 v[224:227], v[48:51], v[64:67], 0
    v_mfma_f32_16x16x32_bf16 v[224:227], v[52:55], v[68:71], v[224:227]
    s_add_u32 s64, s64, 128
    v_mfma_f32_16x16x32_bf16 v[228:231], v[48:51], v[72:75], 0
    v_mfma_f32_16x16x32_bf16 v[228:231], v[52:55], v[76:79], v[228:231]
    v_mfma_f32_16x16x32_bf16 v[232:235], v[48:51], v[80:83], 0
    v_mfma_f32_16x16x32_bf16 v[232:235], v[52:55], v[84:87], v[232:235]
    s_waitcnt vmcnt(21)
    s_barrier
    ds_read_b64_tr_b16 v[40:41], v26 offset:32768
    v_mfma_f32_16x16x32_bf16 v[236:239], v[48:51], v[88:91], 0
    s_add_u32 m0, s69, 32768
    ds_read_b64_tr_b16 v[42:43], v26 offset:33280
    ds_read_b64_tr_b16 v[44:45], v26 offset:36864
    v_mfma_f32_16x16x32_bf16 v[236:239], v[52:55], v[92:95], v[236:239]
    s_add_u32 s72, s70, 32768
    buffer_load_dwordx4 v2, s[24:27], s60 offen lds
    v_mfma_f32_16x16x32_bf16 v[240:243], v[56:59], v[64:67], 0
    ds_read_b64_tr_b16 v[46:47], v26 offset:37376
    ds_read_b128 a[136:139], v22 offset:32768
    v_mfma_f32_16x16x32_bf16 v[240:243], v[60:63], v[68:71], v[240:243]
    ds_read_b128 a[140:143], v23 offset:32768
    ds_read_b64_tr_b16 v[48:49], v27 offset:32768
    v_mfma_f32_16x16x32_bf16 v[244:247], v[56:59], v[72:75], 0
    buffer_load_dwordx4 v3, s[24:27], s60 offen offset:1024 lds
    v_mfma_f32_16x16x32_bf16 v[244:247], v[60:63], v[76:79], v[244:247]
    ds_read_b64_tr_b16 v[50:51], v27 offset:33280
    ds_read_b64_tr_b16 v[52:53], v27 offset:36864
    v_mfma_f32_16x16x32_bf16 v[248:251], v[56:59], v[80:83], 0
    ds_read_b64_tr_b16 v[54:55], v27 offset:37376
    v_add_u32 v26, 0xffff0000, v26
    v_mfma_f32_16x16x32_bf16 v[248:251], v[60:63], v[84:87], v[248:251]
    v_add_u32 v22, 0xffff0000, v22
    v_add_u32 v23, 0xffff0000, v23
    v_mfma_f32_16x16x32_bf16 v[252:255], v[56:59], v[88:91], 0
    buffer_load_dwordx4 v4, s[24:27], s60 offen offset:2048 lds
    v_mfma_f32_16x16x32_bf16 v[252:255], v[60:63], v[92:95], v[252:255]
    s_waitcnt lgkmcnt(3)
    ds_read_b64_tr_b16 v[56:57], v28 offset:32768
    ds_read_b64_tr_b16 v[58:59], v28 offset:33280
    v_mfma_f32_16x16x32_bf16 a[64:67], v[40:43], v[64:67], 0
    ds_read_b64_tr_b16 v[60:61], v28 offset:36864
    ds_read_b64_tr_b16 v[62:63], v28 offset:37376
    v_mfma_f32_16x16x32_bf16 a[64:67], v[44:47], v[68:71], a[64:67]
    v_add_u32 v27, 0xffff0000, v27
    v_add_u32 v28, 0xffff0000, v28
    v_mfma_f32_16x16x32_bf16 a[68:71], v[40:43], v[72:75], 0
    buffer_load_dwordx4 v5, s[24:27], s60 offen offset:3072 lds
    v_mfma_f32_16x16x32_bf16 a[68:71], v[44:47], v[76:79], a[68:71]
    ds_read_b128 v[112:115], v24 offset:49152
    v_mfma_f32_16x16x32_bf16 a[72:75], v[40:43], v[80:83], 0
    buffer_store_dwordx4 a[32:35], v1, s[36:39], s72 offen sc1
    v_mfma_f32_16x16x32_bf16 a[72:75], v[44:47], v[84:87], a[72:75]
    s_add_u32 m0, s69, 49152
    v_accvgpr_write_b32 a32, 0
    v_accvgpr_write_b32 a33, 0
    v_mfma_f32_16x16x32_bf16 a[76:79], v[40:43], v[88:91], 0
    s_add_u32 s60, s60, 524288
    buffer_load_dwordx4 v10, s[20:23], s63 offen lds
    v_mfma_f32_16x16x32_bf16 a[76:79], v[44:47], v[92:95], a[76:79]
    s_add_u32 s72, s70, 36864
    ds_read_b128 v[116:119], v25 offset:49152
    v_accvgpr_write_b32 a34, 0
    v_mfma_f32_16x16x32_bf16 a[128:131], v[40:43], a[136:139], 0
    ds_read_b64_tr_b16 v[40:41], v29 offset:32768
    ds_read_b64_tr_b16 v[42:43], v29 offset:33280
    v_mfma_f32_16x16x32_bf16 a[128:131], v[44:47], a[140:143], a[128:131]
    s_waitcnt lgkmcnt(3)
    ds_read_b64_tr_b16 v[44:45], v29 offset:36864
    ds_read_b64_tr_b16 v[46:47], v29 offset:37376
    v_mfma_f32_16x16x32_bf16 a[80:83], v[48:51], v[64:67], 0
    buffer_load_dwordx4 v11, s[20:23], s63 offen offset:1024 lds
    v_mfma_f32_16x16x32_bf16 a[80:83], v[52:55], v[68:71], a[80:83]
    ds_read_b128 v[120:123], v24 offset:57344
    v_add_u32 v29, 0xffff0000, v29
    v_mfma_f32_16x16x32_bf16 a[84:87], v[48:51], v[72:75], 0
    buffer_store_dwordx4 a[40:43], v1, s[36:39], s72 offen sc1
    v_mfma_f32_16x16x32_bf16 a[84:87], v[52:55], v[76:79], a[84:87]
    v_accvgpr_write_b32 a35, 0
    v_accvgpr_write_b32 a40, 0
    v_mfma_f32_16x16x32_bf16 a[88:91], v[48:51], v[80:83], 0
    buffer_load_dwordx4 v12, s[20:23], s63 offen offset:2048 lds
    v_mfma_f32_16x16x32_bf16 a[88:91], v[52:55], v[84:87], a[88:91]
    ds_read_b128 v[124:127], v25 offset:57344
    v_accvgpr_write_b32 a41, 0
    v_mfma_f32_16x16x32_bf16 a[92:95], v[48:51], v[88:91], 0
    v_accvgpr_write_b32 a42, 0
    v_accvgpr_write_b32 a43, 0
    v_mfma_f32_16x16x32_bf16 a[92:95], v[52:55], v[92:95], a[92:95]
    v_mfma_f32_16x16x32_bf16 a[132:135], v[48:51], a[136:139], 0
    buffer_load_dwordx4 v13, s[20:23], s63 offen offset:3072 lds
    v_mfma_f32_16x16x32_bf16 a[132:135], v[52:55], a[140:143], a[132:135]
    v_mfma_f32_16x16x32_bf16 a[96:99], v[56:59], v[64:67], 0
    v_mfma_f32_16x16x32_bf16 a[96:99], v[60:63], v[68:71], a[96:99]
    s_add_u32 s63, s63, 128
    v_mfma_f32_16x16x32_bf16 a[100:103], v[56:59], v[72:75], 0
    v_mfma_f32_16x16x32_bf16 a[100:103], v[60:63], v[76:79], a[100:103]
    s_add_u32 s72, s70, 40960
    v_mfma_f32_16x16x32_bf16 a[104:107], v[56:59], v[80:83], 0
    buffer_store_dwordx4 a[48:51], v1, s[36:39], s72 offen sc1
    v_mfma_f32_16x16x32_bf16 a[104:107], v[60:63], v[84:87], a[104:107]
    s_waitcnt vmcnt(22)
    s_barrier
    ds_read_b64_tr_b16 v[48:49], v14 offset:0
    v_mfma_f32_16x16x32_bf16 a[108:111], v[56:59], v[88:91], 0
    s_add_u32 m0, s67, 65536
    ds_read_b64_tr_b16 v[50:51], v14 offset:1024
    ds_read_b64_tr_b16 v[52:53], v14 offset:8192
    v_mfma_f32_16x16x32_bf16 a[108:111], v[60:63], v[92:95], a[108:111]
    s_waitcnt lgkmcnt(3)
    buffer_load_dwordx4 v1, s[28:31], s65 offen sc1 lds
    v_mfma_f32_16x16x32_bf16 a[112:115], v[40:43], v[64:67], 0
    ds_read_b64_tr_b16 v[54:55], v14 offset:9216
    ds_read_b64_tr_b16 v[56:57], v15 offset:0
    v_mfma_f32_16x16x32_bf16 a[112:115], v[44:47], v[68:71], a[112:115]
    ds_read_b64_tr_b16 v[58:59], v15 offset:1024
    ds_read_b64_tr_b16 v[60:61], v15 offset:8192
    v_mfma_f32_16x16x32_bf16 a[116:119], v[40:43], v[72:75], 0
    ds_read_b64_tr_b16 v[62:63], v15 offset:9216
    v_add_u32 v14, 0xfffe0000, v14
    v_mfma_f32_16x16x32_bf16 a[116:119], v[44:47], v[76:79], a[116:119]
    v_add_u32 v15, 0xfffe0000, v15
    v_accvgpr_write_b32 a48, 0
    v_mfma_f32_16x16x32_bf16 a[120:123], v[40:43], v[80:83], 0
    v_accvgpr_write_b32 a49, 0
    v_accvgpr_write_b32 a50, 0
    v_mfma_f32_16x16x32_bf16 a[120:123], v[44:47], v[84:87], a[120:123]
    v_accvgpr_write_b32 a51, 0
    v_mfma_f32_16x16x32_bf16 a[124:127], v[40:43], v[88:91], 0
    buffer_load_dwordx4 v1, s[28:31], s65 offen offset:1024 sc1 lds
    v_mfma_f32_16x16x32_bf16 a[124:127], v[44:47], v[92:95], a[124:127]
    s_waitcnt lgkmcnt(0)
    ds_read_b64_tr_b16 v[40:41], v16 offset:0
    ds_read_b64_tr_b16 v[42:43], v16 offset:1024
    v_mfma_f32_16x16x32_bf16 v[128:131], v[48:51], v[96:99], v[128:131]
    ds_read_b64_tr_b16 v[44:45], v16 offset:8192
    ds_read_b64_tr_b16 v[46:47], v16 offset:9216
    v_mfma_f32_16x16x32_bf16 v[128:131], v[52:55], v[100:103], v[128:131]
    v_add_u32 v24, 0x10000, v24
    v_add_u32 v16, 0xfffe0000, v16
    v_mfma_f32_16x16x32_bf16 v[132:135], v[48:51], v[104:107], v[132:135]
    ds_read_b128 v[64:67], v24 offset:16384
    v_mfma_f32_16x16x32_bf16 v[132:135], v[52:55], v[108:111], v[132:135]
    v_mfma_f32_16x16x32_bf16 v[136:139], v[48:51], v[112:115], v[136:139]
    s_add_u32 s72, s70, 45056
    v_mfma_f32_16x16x32_bf16 v[136:139], v[52:55], v[116:119], v[136:139]
    buffer_store_dwordx4 a[56:59], v1, s[36:39], s72 offen sc1
    v_mfma_f32_16x16x32_bf16 v[140:143], v[48:51], v[120:123], v[140:143]
    s_add_u32 m0, s68, 73728
    ds_read_b64_tr_b16 v[48:49], v17 offset:0
    ds_read_b64_tr_b16 v[50:51], v17 offset:1024
    v_mfma_f32_16x16x32_bf16 v[140:143], v[52:55], v[124:127], v[140:143]
    buffer_load_dwordx4 v6, s[20:23], s66 offen lds
    v_mfma_f32_16x16x32_bf16 v[144:147], v[56:59], v[96:99], v[144:147]
    ds_read_b64_tr_b16 v[52:53], v17 offset:8192
    ds_read_b64_tr_b16 v[54:55], v17 offset:9216
    v_mfma_f32_16x16x32_bf16 v[144:147], v[60:63], v[100:103], v[144:147]
    v_add_u32 v17, 0xfffe0000, v17
    v_accvgpr_write_b32 a56, 0
    v_mfma_f32_16x16x32_bf16 v[148:151], v[56:59], v[104:107], v[148:151]
    v_accvgpr_write_b32 a57, 0
    v_accvgpr_write_b32 a58, 0
    v_mfma_f32_16x16x32_bf16 v[148:151], v[60:63], v[108:111], v[148:151]
    v_accvgpr_write_b32 a59, 0
    v_mfma_f32_16x16x32_bf16 v[152:155], v[56:59], v[112:115], v[152:155]
    v_add_u32 v25, 0x10000, v25
    v_mfma_f32_16x16x32_bf16 v[152:155], v[60:63], v[116:119], v[152:155]
    ds_read_b128 v[68:71], v25 offset:16384
    v_mfma_f32_16x16x32_bf16 v[156:159], v[56:59], v[120:123], v[156:159]
    s_add_u32 m0, s69, 81920
    ds_read_b64_tr_b16 v[56:57], v18 offset:0
    ds_read_b64_tr_b16 v[58:59], v18 offset:1024
    v_mfma_f32_16x16x32_bf16 v[156:159], v[60:63], v[124:127], v[156:159]
    s_add_u32 s65, s65, 8192
    buffer_load_dwordx4 v10, s[20:23], s64 offen lds
    s_waitcnt lgkmcnt(3)
    v_mfma_f32_16x16x32_bf16 v[160:163], v[40:43], v[96:99], v[160:163]
    s_add_u32 s66, s66, 128
    ds_read_b64_tr_b16 v[60:61], v18 offset:8192
    ds_read_b64_tr_b16 v[62:63], v18 offset:9216
    v_mfma_f32_16x16x32_bf16 v[160:163], v[44:47], v[100:103], v[160:163]
    v_add_u32 v18, 0xfffe0000, v18
    v_mfma_f32_16x16x32_bf16 v[164:167], v[40:43], v[104:107], v[164:167]
    v_mfma_f32_16x16x32_bf16 v[164:167], v[44:47], v[108:111], v[164:167]
    v_mfma_f32_16x16x32_bf16 v[168:171], v[40:43], v[112:115], v[168:171]
    v_mfma_f32_16x16x32_bf16 v[168:171], v[44:47], v[116:119], v[168:171]
    s_add_u32 s72, s70, 1024
    v_mfma_f32_16x16x32_bf16 v[172:175], v[40:43], v[120:123], v[172:175]
    ds_read_b64_tr_b16 v[40:41], v19 offset:0
    ds_read_b64_tr_b16 v[42:43], v19 offset:1024
    v_mfma_f32_16x16x32_bf16 v[172:175], v[44:47], v[124:127], v[172:175]
    ds_read_b64_tr_b16 v[44:45], v19 offset:8192
    ds_read_b64_tr_b16 v[46:47], v19 offset:9216
    v_mfma_f32_16x16x32_bf16 v[176:179], v[48:51], v[96:99], v[176:179]
    buffer_load_dwordx4 v11, s[20:23], s64 offen offset:1024 lds
    v_mfma_f32_16x16x32_bf16 v[176:179], v[52:55], v[100:103], v[176:179]
    ds_read_b128 v[72:75], v24 offset:24576
    v_add_u32 v19, 0xfffe0000, v19
    v_mfma_f32_16x16x32_bf16 v[180:183], v[48:51], v[104:107], v[180:183]
    buffer_store_dwordx4 a[4:7], v1, s[36:39], s72 offen sc1
    v_mfma_f32_16x16x32_bf16 v[180:183], v[52:55], v[108:111], v[180:183]
    v_mfma_f32_16x16x32_bf16 v[184:187], v[48:51], v[112:115], v[184:187]
    v_accvgpr_write_b32 a4, 0
    v_accvgpr_write_b32 a5, 0
    v_mfma_f32_16x16x32_bf16 v[184:187], v[52:55], v[116:119], v[184:187]
    v_accvgpr_write_b32 a6, 0
    v_accvgpr_write_b32 a7, 0
    v_mfma_f32_16x16x32_bf16 v[188:191], v[48:51], v[120:123], v[188:191]
    ds_read_b64_tr_b16 v[48:49], v20 offset:0
    ds_read_b64_tr_b16 v[50:51], v20 offset:1024
    v_mfma_f32_16x16x32_bf16 v[188:191], v[52:55], v[124:127], v[188:191]
    s_waitcnt lgkmcnt(2)
    ds_read_b64_tr_b16 v[52:53], v20 offset:8192
    ds_read_b64_tr_b16 v[54:55], v20 offset:9216
    v_mfma_f32_16x16x32_bf16 v[192:195], v[56:59], v[96:99], v[192:195]
    buffer_load_dwordx4 v12, s[20:23], s64 offen offset:2048 lds
    v_mfma_f32_16x16x32_bf16 v[192:195], v[60:63], v[100:103], v[192:195]
    v_add_u32 v20, 0xfffe0000, v20
    v_mfma_f32_16x16x32_bf16 v[196:199], v[56:59], v[104:107], v[196:199]
    v_mfma_f32_16x16x32_bf16 v[196:199], v[60:63], v[108:111], v[196:199]
    ds_read_b128 v[76:79], v25 offset:24576
    v_mfma_f32_16x16x32_bf16 v[200:203], v[56:59], v[112:115], v[200:203]
    v_mfma_f32_16x16x32_bf16 v[200:203], v[60:63], v[116:119], v[200:203]
    v_mfma_f32_16x16x32_bf16 v[204:207], v[56:59], v[120:123], v[204:207]
    s_add_u32 s72, s70, 5120
    ds_read_b64_tr_b16 v[56:57], v21 offset:0
    ds_read_b64_tr_b16 v[58:59], v21 offset:1024
    v_mfma_f32_16x16x32_bf16 v[204:207], v[60:63], v[124:127], v[204:207]
    ds_read_b64_tr_b16 v[60:61], v21 offset:8192
    ds_read_b64_tr_b16 v[62:63], v21 offset:9216
    v_mfma_f32_16x16x32_bf16 v[208:211], v[40:43], v[96:99], v[208:211]
    v_add_u32 v21, 0xfffe0000, v21
    v_mfma_f32_16x16x32_bf16 v[208:211], v[44:47], v[100:103], v[208:211]
    buffer_load_dwordx4 v13, s[20:23], s64 offen offset:3072 lds
    v_mfma_f32_16x16x32_bf16 v[212:215], v[40:43], v[104:107], v[212:215]
    buffer_store_dwordx4 a[12:15], v1, s[36:39], s72 offen sc1
    v_mfma_f32_16x16x32_bf16 v[212:215], v[44:47], v[108:111], v[212:215]
    v_mfma_f32_16x16x32_bf16 v[216:219], v[40:43], v[112:115], v[216:219]
    v_accvgpr_write_b32 a12, 0
    v_accvgpr_write_b32 a13, 0
    v_mfma_f32_16x16x32_bf16 v[216:219], v[44:47], v[116:119], v[216:219]
    v_accvgpr_write_b32 a14, 0
    v_accvgpr_write_b32 a15, 0
    v_mfma_f32_16x16x32_bf16 v[220:223], v[40:43], v[120:123], v[220:223]
    v_mfma_f32_16x16x32_bf16 v[220:223], v[44:47], v[124:127], v[220:223]
    s_waitcnt lgkmcnt(0)
    v_mfma_f32_16x16x32_bf16 v[224:227], v[48:51], v[96:99], v[224:227]
    v_mfma_f32_16x16x32_bf16 v[224:227], v[52:55], v[100:103], v[224:227]
    s_add_u32 s64, s64, 128
    v_mfma_f32_16x16x32_bf16 v[228:231], v[48:51], v[104:107], v[228:231]
    v_mfma_f32_16x16x32_bf16 v[228:231], v[52:55], v[108:111], v[228:231]
    v_mfma_f32_16x16x32_bf16 v[232:235], v[48:51], v[112:115], v[232:235]
    v_mfma_f32_16x16x32_bf16 v[232:235], v[52:55], v[116:119], v[232:235]
    s_waitcnt vmcnt(21)
    s_barrier
    ds_read_b64_tr_b16 v[40:41], v26 offset:0
    v_mfma_f32_16x16x32_bf16 v[236:239], v[48:51], v[120:123], v[236:239]
    s_add_u32 m0, s69, 98304
    ds_read_b64_tr_b16 v[42:43], v26 offset:512
    ds_read_b64_tr_b16 v[44:45], v26 offset:4096
    v_mfma_f32_16x16x32_bf16 v[236:239], v[52:55], v[124:127], v[236:239]
    s_add_u32 s72, s70, 9216
    buffer_load_dwordx4 v2, s[24:27], s60 offen lds
    v_mfma_f32_16x16x32_bf16 v[240:243], v[56:59], v[96:99], v[240:243]
    ds_read_b64_tr_b16 v[46:47], v26 offset:4608
    ds_read_b128 a[136:139], v22 offset:0
    v_mfma_f32_16x16x32_bf16 v[240:243], v[60:63], v[100:103], v[240:243]
    ds_read_b128 a[140:143], v23 offset:0
    ds_read_b64_tr_b16 v[48:49], v27 offset:0
    v_mfma_f32_16x16x32_bf16 v[244:247], v[56:59], v[104:107], v[244:247]
    buffer_load_dwordx4 v3, s[24:27], s60 offen offset:1024 lds
    v_mfma_f32_16x16x32_bf16 v[244:247], v[60:63], v[108:111], v[244:247]
    ds_read_b64_tr_b16 v[50:51], v27 offset:512
    ds_read_b64_tr_b16 v[52:53], v27 offset:4096
    v_mfma_f32_16x16x32_bf16 v[248:251], v[56:59], v[112:115], v[248:251]
    ds_read_b64_tr_b16 v[54:55], v27 offset:4608
    v_add_u32 v26, 0x10000, v26
    v_mfma_f32_16x16x32_bf16 v[248:251], v[60:63], v[116:119], v[248:251]
    v_add_u32 v22, 0x10000, v22
    v_add_u32 v23, 0x10000, v23
    v_mfma_f32_16x16x32_bf16 v[252:255], v[56:59], v[120:123], v[252:255]
    buffer_load_dwordx4 v4, s[24:27], s60 offen offset:2048 lds
    v_mfma_f32_16x16x32_bf16 v[252:255], v[60:63], v[124:127], v[252:255]
    s_waitcnt lgkmcnt(3)
    ds_read_b64_tr_b16 v[56:57], v28 offset:0
    ds_read_b64_tr_b16 v[58:59], v28 offset:512
    v_mfma_f32_16x16x32_bf16 a[64:67], v[40:43], v[96:99], a[64:67]
    ds_read_b64_tr_b16 v[60:61], v28 offset:4096
    ds_read_b64_tr_b16 v[62:63], v28 offset:4608
    v_mfma_f32_16x16x32_bf16 a[64:67], v[44:47], v[100:103], a[64:67]
    v_add_u32 v24, 0xfffe0000, v24
    v_add_u32 v27, 0x10000, v27
    v_mfma_f32_16x16x32_bf16 a[68:71], v[40:43], v[104:107], a[68:71]
    buffer_load_dwordx4 v5, s[24:27], s60 offen offset:3072 lds
    v_mfma_f32_16x16x32_bf16 a[68:71], v[44:47], v[108:111], a[68:71]
    ds_read_b128 v[80:83], v24 offset:16384
    v_add_u32 v28, 0x10000, v28
    v_mfma_f32_16x16x32_bf16 a[72:75], v[40:43], v[112:115], a[72:75]
    buffer_store_dwordx4 a[20:23], v1, s[36:39], s72 offen sc1
    v_mfma_f32_16x16x32_bf16 a[72:75], v[44:47], v[116:119], a[72:75]
    s_add_u32 m0, s69, 114688
    v_add_u32 v25, 0xfffe0000, v25
    v_accvgpr_write_b32 a20, 0
    v_mfma_f32_16x16x32_bf16 a[76:79], v[40:43], v[120:123], a[76:79]
    s_add_u32 s60, s60, 524288
    buffer_load_dwordx4 v10, s[20:23], s63 offen lds
    v_mfma_f32_16x16x32_bf16 a[76:79], v[44:47], v[124:127], a[76:79]
    ds_read_b128 v[84:87], v25 offset:16384
    v_accvgpr_write_b32 a21, 0
    v_mfma_f32_16x16x32_bf16 a[128:131], v[40:43], a[136:139], a[128:131]
    s_add_u32 s72, s70, 13312
    ds_read_b64_tr_b16 v[40:41], v29 offset:0
    ds_read_b64_tr_b16 v[42:43], v29 offset:512
    v_mfma_f32_16x16x32_bf16 a[128:131], v[44:47], a[140:143], a[128:131]
    s_waitcnt lgkmcnt(3)
    ds_read_b64_tr_b16 v[44:45], v29 offset:4096
    ds_read_b64_tr_b16 v[46:47], v29 offset:4608
    v_mfma_f32_16x16x32_bf16 a[80:83], v[48:51], v[96:99], a[80:83]
    buffer_load_dwordx4 v11, s[20:23], s63 offen offset:1024 lds
    v_mfma_f32_16x16x32_bf16 a[80:83], v[52:55], v[100:103], a[80:83]
    ds_read_b128 v[88:91], v24 offset:24576
    v_add_u32 v29, 0x10000, v29
    v_mfma_f32_16x16x32_bf16 a[84:87], v[48:51], v[104:107], a[84:87]
    buffer_store_dwordx4 a[28:31], v1, s[36:39], s72 offen sc1
    v_mfma_f32_16x16x32_bf16 a[84:87], v[52:55], v[108:111], a[84:87]
    v_accvgpr_write_b32 a22, 0
    v_accvgpr_write_b32 a23, 0
    v_mfma_f32_16x16x32_bf16 a[88:91], v[48:51], v[112:115], a[88:91]
    buffer_load_dwordx4 v12, s[20:23], s63 offen offset:2048 lds
    v_mfma_f32_16x16x32_bf16 a[88:91], v[52:55], v[116:119], a[88:91]
    ds_read_b128 v[92:95], v25 offset:24576
    v_accvgpr_write_b32 a28, 0
    v_mfma_f32_16x16x32_bf16 a[92:95], v[48:51], v[120:123], a[92:95]
    v_accvgpr_write_b32 a29, 0
    v_accvgpr_write_b32 a30, 0
    v_mfma_f32_16x16x32_bf16 a[92:95], v[52:55], v[124:127], a[92:95]
    v_accvgpr_write_b32 a31, 0
    v_mfma_f32_16x16x32_bf16 a[132:135], v[48:51], a[136:139], a[132:135]
    buffer_load_dwordx4 v13, s[20:23], s63 offen offset:3072 lds
    v_mfma_f32_16x16x32_bf16 a[132:135], v[52:55], a[140:143], a[132:135]
    v_mfma_f32_16x16x32_bf16 a[96:99], v[56:59], v[96:99], a[96:99]
    v_mfma_f32_16x16x32_bf16 a[96:99], v[60:63], v[100:103], a[96:99]
    s_add_u32 s63, s63, 128
    v_mfma_f32_16x16x32_bf16 a[100:103], v[56:59], v[104:107], a[100:103]
    v_mfma_f32_16x16x32_bf16 a[100:103], v[60:63], v[108:111], a[100:103]
    v_mfma_f32_16x16x32_bf16 a[104:107], v[56:59], v[112:115], a[104:107]
    v_mfma_f32_16x16x32_bf16 a[104:107], v[60:63], v[116:119], a[104:107]
    s_waitcnt vmcnt(21)
    s_barrier
    ds_read_b64_tr_b16 v[48:49], v14 offset:32768
    v_mfma_f32_16x16x32_bf16 a[108:111], v[56:59], v[120:123], a[108:111]
    s_add_u32 m0, s67, 131072
    ds_read_b64_tr_b16 v[50:51], v14 offset:33792
    ds_read_b64_tr_b16 v[52:53], v14 offset:40960
    v_mfma_f32_16x16x32_bf16 a[108:111], v[60:63], v[124:127], a[108:111]
    s_add_u32 s72, s70, 33792
    buffer_load_dwordx4 v1, s[28:31], s65 offen sc1 lds
    s_waitcnt lgkmcnt(3)
    v_mfma_f32_16x16x32_bf16 a[112:115], v[40:43], v[96:99], a[112:115]
    ds_read_b64_tr_b16 v[54:55], v14 offset:41984
    ds_read_b64_tr_b16 v[56:57], v15 offset:32768
    v_mfma_f32_16x16x32_bf16 a[112:115], v[44:47], v[100:103], a[112:115]
    ds_read_b64_tr_b16 v[58:59], v15 offset:33792
    ds_read_b64_tr_b16 v[60:61], v15 offset:40960
    v_mfma_f32_16x16x32_bf16 a[116:119], v[40:43], v[104:107], a[116:119]
    ds_read_b64_tr_b16 v[62:63], v15 offset:41984
    v_add_u32 v14, 0x10000, v14
    v_mfma_f32_16x16x32_bf16 a[116:119], v[44:47], v[108:111], a[116:119]
    v_add_u32 v15, 0x10000, v15
    v_mfma_f32_16x16x32_bf16 a[120:123], v[40:43], v[112:115], a[120:123]
    buffer_store_dwordx4 a[36:39], v1, s[36:39], s72 offen sc1
    v_mfma_f32_16x16x32_bf16 a[120:123], v[44:47], v[116:119], a[120:123]
    v_mfma_f32_16x16x32_bf16 a[124:127], v[40:43], v[120:123], a[124:127]
    buffer_load_dwordx4 v1, s[28:31], s65 offen offset:1024 sc1 lds
    v_mfma_f32_16x16x32_bf16 a[124:127], v[44:47], v[124:127], a[124:127]
    s_waitcnt lgkmcnt(0)
    ds_read_b64_tr_b16 v[40:41], v16 offset:32768
    ds_read_b64_tr_b16 v[42:43], v16 offset:33792
    v_mfma_f32_16x16x32_bf16 v[128:131], v[48:51], v[64:67], v[128:131]
    ds_read_b64_tr_b16 v[44:45], v16 offset:40960
    ds_read_b64_tr_b16 v[46:47], v16 offset:41984
    v_mfma_f32_16x16x32_bf16 v[128:131], v[52:55], v[68:71], v[128:131]
    v_add_u32 v16, 0x10000, v16
    v_accvgpr_write_b32 a36, 0
    v_mfma_f32_16x16x32_bf16 v[132:135], v[48:51], v[72:75], v[132:135]
    ds_read_b128 v[96:99], v24 offset:49152
    v_accvgpr_write_b32 a37, 0
    v_mfma_f32_16x16x32_bf16 v[132:135], v[52:55], v[76:79], v[132:135]
    v_accvgpr_write_b32 a38, 0
    v_accvgpr_write_b32 a39, 0
    v_mfma_f32_16x16x32_bf16 v[136:139], v[48:51], v[80:83], v[136:139]
    v_mfma_f32_16x16x32_bf16 v[136:139], v[52:55], v[84:87], v[136:139]
    v_mfma_f32_16x16x32_bf16 v[140:143], v[48:51], v[88:91], v[140:143]
    s_add_u32 m0, s68, 139264
    ds_read_b64_tr_b16 v[48:49], v17 offset:32768
    ds_read_b64_tr_b16 v[50:51], v17 offset:33792
    v_mfma_f32_16x16x32_bf16 v[140:143], v[52:55], v[92:95], v[140:143]
    s_add_u32 s72, s70, 37888
    buffer_load_dwordx4 v6, s[20:23], s66 offen lds
    v_mfma_f32_16x16x32_bf16 v[144:147], v[56:59], v[64:67], v[144:147]
    ds_read_b64_tr_b16 v[52:53], v17 offset:40960
    ds_read_b64_tr_b16 v[54:55], v17 offset:41984
    v_mfma_f32_16x16x32_bf16 v[144:147], v[60:63], v[68:71], v[144:147]
    v_add_u32 v17, 0x10000, v17
    v_mfma_f32_16x16x32_bf16 v[148:151], v[56:59], v[72:75], v[148:151]
    buffer_store_dwordx4 a[44:47], v1, s[36:39], s72 offen sc1
    v_mfma_f32_16x16x32_bf16 v[148:151], v[60:63], v[76:79], v[148:151]
    v_mfma_f32_16x16x32_bf16 v[152:155], v[56:59], v[80:83], v[152:155]
    v_accvgpr_write_b32 a44, 0
    v_accvgpr_write_b32 a45, 0
    v_mfma_f32_16x16x32_bf16 v[152:155], v[60:63], v[84:87], v[152:155]
    ds_read_b128 v[100:103], v25 offset:49152
    v_accvgpr_write_b32 a46, 0
    v_mfma_f32_16x16x32_bf16 v[156:159], v[56:59], v[88:91], v[156:159]
    s_add_u32 m0, s69, 147456
    ds_read_b64_tr_b16 v[56:57], v18 offset:32768
    ds_read_b64_tr_b16 v[58:59], v18 offset:33792
    v_mfma_f32_16x16x32_bf16 v[156:159], v[60:63], v[92:95], v[156:159]
    s_add_u32 s65, s65, 8192
    buffer_load_dwordx4 v10, s[20:23], s64 offen lds
    s_waitcnt lgkmcnt(3)
    v_mfma_f32_16x16x32_bf16 v[160:163], v[40:43], v[64:67], v[160:163]
    s_add_u32 s66, s66, 128
    ds_read_b64_tr_b16 v[60:61], v18 offset:40960
    ds_read_b64_tr_b16 v[62:63], v18 offset:41984
    v_mfma_f32_16x16x32_bf16 v[160:163], v[44:47], v[68:71], v[160:163]
    v_add_u32 v18, 0x10000, v18
    v_accvgpr_write_b32 a47, 0
    v_mfma_f32_16x16x32_bf16 v[164:167], v[40:43], v[72:75], v[164:167]
    v_mfma_f32_16x16x32_bf16 v[164:167], v[44:47], v[76:79], v[164:167]
    v_mfma_f32_16x16x32_bf16 v[168:171], v[40:43], v[80:83], v[168:171]
    v_mfma_f32_16x16x32_bf16 v[168:171], v[44:47], v[84:87], v[168:171]
    v_mfma_f32_16x16x32_bf16 v[172:175], v[40:43], v[88:91], v[172:175]
    ds_read_b64_tr_b16 v[40:41], v19 offset:32768
    ds_read_b64_tr_b16 v[42:43], v19 offset:33792
    v_mfma_f32_16x16x32_bf16 v[172:175], v[44:47], v[92:95], v[172:175]
    s_add_u32 s72, s70, 41984
    ds_read_b64_tr_b16 v[44:45], v19 offset:40960
    ds_read_b64_tr_b16 v[46:47], v19 offset:41984
    v_mfma_f32_16x16x32_bf16 v[176:179], v[48:51], v[64:67], v[176:179]
    buffer_load_dwordx4 v11, s[20:23], s64 offen offset:1024 lds
    v_mfma_f32_16x16x32_bf16 v[176:179], v[52:55], v[68:71], v[176:179]
    ds_read_b128 v[104:107], v24 offset:57344
    v_add_u32 v19, 0x10000, v19
    v_mfma_f32_16x16x32_bf16 v[180:183], v[48:51], v[72:75], v[180:183]
    buffer_store_dwordx4 a[52:55], v1, s[36:39], s72 offen sc1
    v_mfma_f32_16x16x32_bf16 v[180:183], v[52:55], v[76:79], v[180:183]
    v_mfma_f32_16x16x32_bf16 v[184:187], v[48:51], v[80:83], v[184:187]
    v_accvgpr_write_b32 a52, 0
    v_accvgpr_write_b32 a53, 0
    v_mfma_f32_16x16x32_bf16 v[184:187], v[52:55], v[84:87], v[184:187]
    v_accvgpr_write_b32 a54, 0
    v_accvgpr_write_b32 a55, 0
    v_mfma_f32_16x16x32_bf16 v[188:191], v[48:51], v[88:91], v[188:191]
    ds_read_b64_tr_b16 v[48:49], v20 offset:32768
    ds_read_b64_tr_b16 v[50:51], v20 offset:33792
    v_mfma_f32_16x16x32_bf16 v[188:191], v[52:55], v[92:95], v[188:191]
    s_waitcnt lgkmcnt(2)
    ds_read_b64_tr_b16 v[52:53], v20 offset:40960
    ds_read_b64_tr_b16 v[54:55], v20 offset:41984
    v_mfma_f32_16x16x32_bf16 v[192:195], v[56:59], v[64:67], v[192:195]
    buffer_load_dwordx4 v12, s[20:23], s64 offen offset:2048 lds
    v_mfma_f32_16x16x32_bf16 v[192:195], v[60:63], v[68:71], v[192:195]
    v_add_u32 v20, 0x10000, v20
    v_mfma_f32_16x16x32_bf16 v[196:199], v[56:59], v[72:75], v[196:199]
    v_mfma_f32_16x16x32_bf16 v[196:199], v[60:63], v[76:79], v[196:199]
    ds_read_b128 v[108:111], v25 offset:57344
    v_mfma_f32_16x16x32_bf16 v[200:203], v[56:59], v[80:83], v[200:203]
    v_mfma_f32_16x16x32_bf16 v[200:203], v[60:63], v[84:87], v[200:203]
    v_mfma_f32_16x16x32_bf16 v[204:207], v[56:59], v[88:91], v[204:207]
    ds_read_b64_tr_b16 v[56:57], v21 offset:32768
    ds_read_b64_tr_b16 v[58:59], v21 offset:33792
    v_mfma_f32_16x16x32_bf16 v[204:207], v[60:63], v[92:95], v[204:207]
    ds_read_b64_tr_b16 v[60:61], v21 offset:40960
    ds_read_b64_tr_b16 v[62:63], v21 offset:41984
    v_mfma_f32_16x16x32_bf16 v[208:211], v[40:43], v[64:67], v[208:211]
    s_add_u32 s72, s70, 46080
    v_add_u32 v21, 0x10000, v21
    v_mfma_f32_16x16x32_bf16 v[208:211], v[44:47], v[68:71], v[208:211]
    s_mul_i32 s70, s7, 36864
    buffer_load_dwordx4 v13, s[20:23], s64 offen offset:3072 lds
    v_mfma_f32_16x16x32_bf16 v[212:215], v[40:43], v[72:75], v[212:215]
    s_add_u32 s70, s70, s99
    buffer_store_dwordx4 a[60:63], v1, s[36:39], s72 offen sc1
    v_mfma_f32_16x16x32_bf16 v[212:215], v[44:47], v[76:79], v[212:215]
    s_lshr_b32 s99, s69, 5
    v_accvgpr_write_b32 a60, 0
    v_accvgpr_write_b32 a61, 0
    v_mfma_f32_16x16x32_bf16 v[216:219], v[40:43], v[80:83], v[216:219]
    s_add_u32 s99, s99, s98
    v_accvgpr_write_b32 a62, 0
    v_accvgpr_write_b32 a63, 0
    v_mfma_f32_16x16x32_bf16 v[216:219], v[44:47], v[84:87], v[216:219]
    s_mul_hi_u32 s7, s2, 715827883
    v_mfma_f32_16x16x32_bf16 v[220:223], v[40:43], v[88:91], v[220:223]
    s_mul_i32 s3, s7, 6
    v_mfma_f32_16x16x32_bf16 v[220:223], v[44:47], v[92:95], v[220:223]
    s_sub_u32 s3, s2, s3
    s_waitcnt lgkmcnt(0)
    v_mfma_f32_16x16x32_bf16 v[224:227], v[48:51], v[64:67], v[224:227]
    s_mul_i32 s3, s3, 6
    v_accvgpr_read_b32 v32, a144
    v_accvgpr_read_b32 v31, a145
    v_mfma_f32_16x16x32_bf16 v[224:227], v[52:55], v[68:71], v[224:227]
    s_add_u32 s64, s64, 128
    v_cvt_pk_bf16_f32 v32, v32, v31
    v_accvgpr_read_b32 v33, a146
    v_mfma_f32_16x16x32_bf16 v[228:231], v[48:51], v[72:75], v[228:231]
    s_lshl1_add_u32 s3, s4, s3
    v_accvgpr_read_b32 v31, a147
    v_cvt_pk_bf16_f32 v33, v33, v31
    v_mfma_f32_16x16x32_bf16 v[228:231], v[52:55], v[76:79], v[228:231]
    s_sub_u32 s3, s3, 2
    v_accvgpr_read_b32 v34, a148
    v_accvgpr_read_b32 v31, a149
    v_mfma_f32_16x16x32_bf16 v[232:235], v[48:51], v[80:83], v[232:235]
    v_cvt_pk_bf16_f32 v34, v34, v31
    v_accvgpr_read_b32 v35, a150
    v_mfma_f32_16x16x32_bf16 v[232:235], v[52:55], v[84:87], v[232:235]
    s_waitcnt vmcnt(22)
    s_barrier
    ds_read_b64_tr_b16 v[40:41], v26 offset:0
    v_mfma_f32_16x16x32_bf16 v[236:239], v[48:51], v[88:91], v[236:239]
    s_add_u32 m0, s69, 0
    ds_read_b64_tr_b16 v[42:43], v26 offset:512
    ds_read_b64_tr_b16 v[44:45], v26 offset:4096
    v_mfma_f32_16x16x32_bf16 v[236:239], v[52:55], v[92:95], v[236:239]
    buffer_load_dwordx4 v2, s[24:27], s60 offen lds
    v_mfma_f32_16x16x32_bf16 v[240:243], v[56:59], v[64:67], v[240:243]
    ds_read_b64_tr_b16 v[46:47], v26 offset:4608
    ds_read_b128 a[136:139], v22 offset:0
    v_mfma_f32_16x16x32_bf16 v[240:243], v[60:63], v[68:71], v[240:243]
    s_add_u32 s72, s71, 32768
    ds_read_b128 a[140:143], v23 offset:0
    ds_read_b64_tr_b16 v[48:49], v27 offset:0
    v_mfma_f32_16x16x32_bf16 v[244:247], v[56:59], v[72:75], v[244:247]
    buffer_load_dwordx4 v3, s[24:27], s60 offen offset:1024 lds
    v_mfma_f32_16x16x32_bf16 v[244:247], v[60:63], v[76:79], v[244:247]
    ds_read_b64_tr_b16 v[50:51], v27 offset:512
    ds_read_b64_tr_b16 v[52:53], v27 offset:4096
    v_mfma_f32_16x16x32_bf16 v[248:251], v[56:59], v[80:83], v[248:251]
    ds_read_b64_tr_b16 v[54:55], v27 offset:4608
    v_add_u32 v26, 0x10000, v26
    v_mfma_f32_16x16x32_bf16 v[248:251], v[60:63], v[84:87], v[248:251]
    v_add_u32 v22, 0x10000, v22
    v_add_u32 v23, 0x10000, v23
    v_mfma_f32_16x16x32_bf16 v[252:255], v[56:59], v[88:91], v[252:255]
    buffer_load_dwordx4 v4, s[24:27], s60 offen offset:2048 lds
    v_mfma_f32_16x16x32_bf16 v[252:255], v[60:63], v[92:95], v[252:255]
    s_waitcnt lgkmcnt(3)
    ds_read_b64_tr_b16 v[56:57], v28 offset:0
    ds_read_b64_tr_b16 v[58:59], v28 offset:512
    v_mfma_f32_16x16x32_bf16 a[64:67], v[40:43], v[64:67], a[64:67]
    ds_read_b64_tr_b16 v[60:61], v28 offset:4096
    ds_read_b64_tr_b16 v[62:63], v28 offset:4608
    v_mfma_f32_16x16x32_bf16 a[64:67], v[44:47], v[68:71], a[64:67]
    v_add_u32 v24, 0x10000, v24
    v_add_u32 v27, 0x10000, v27
    v_mfma_f32_16x16x32_bf16 a[68:71], v[40:43], v[72:75], a[68:71]
    buffer_load_dwordx4 v5, s[24:27], s60 offen offset:3072 lds
    v_mfma_f32_16x16x32_bf16 a[68:71], v[44:47], v[76:79], a[68:71]
    ds_read_b128 v[112:115], v24 offset:16384
    v_add_u32 v28, 0x10000, v28
    v_mfma_f32_16x16x32_bf16 a[72:75], v[40:43], v[80:83], a[72:75]
    v_accvgpr_read_b32 v31, a151
    v_cvt_pk_bf16_f32 v35, v35, v31
    v_mfma_f32_16x16x32_bf16 a[72:75], v[44:47], v[84:87], a[72:75]
    s_add_u32 m0, s69, 16384
    v_add_u32 v25, 0x10000, v25
    v_accvgpr_read_b32 v36, a152
    v_mfma_f32_16x16x32_bf16 a[76:79], v[40:43], v[88:91], a[76:79]
    s_add_u32 s60, s60, 524288
    buffer_load_dwordx4 v10, s[20:23], s63 offen lds
    v_mfma_f32_16x16x32_bf16 a[76:79], v[44:47], v[92:95], a[76:79]
    ds_read_b128 v[116:119], v25 offset:16384
    v_accvgpr_read_b32 v31, a153
    v_mfma_f32_16x16x32_bf16 a[128:131], v[40:43], a[136:139], a[128:131]
    ds_read_b64_tr_b16 v[40:41], v29 offset:0
    ds_read_b64_tr_b16 v[42:43], v29 offset:512
    v_mfma_f32_16x16x32_bf16 a[128:131], v[44:47], a[140:143], a[128:131]
    s_waitcnt lgkmcnt(3)
    ds_read_b64_tr_b16 v[44:45], v29 offset:4096
    ds_read_b64_tr_b16 v[46:47], v29 offset:4608
    v_mfma_f32_16x16x32_bf16 a[80:83], v[48:51], v[64:67], a[80:83]
    buffer_load_dwordx4 v11, s[20:23], s63 offen offset:1024 lds
    v_mfma_f32_16x16x32_bf16 a[80:83], v[52:55], v[68:71], a[80:83]
    ds_read_b128 v[120:123], v24 offset:24576
    v_add_u32 v29, 0x10000, v29
    v_mfma_f32_16x16x32_bf16 a[84:87], v[48:51], v[72:75], a[84:87]
    buffer_store_dwordx4 v[32:35], v1, s[36:39], s72 offen sc1
    v_mfma_f32_16x16x32_bf16 a[84:87], v[52:55], v[76:79], a[84:87]
    s_add_u32 s72, s71, 33792
    v_cvt_pk_bf16_f32 v36, v36, v31
    v_accvgpr_read_b32 v37, a154
    v_mfma_f32_16x16x32_bf16 a[88:91], v[48:51], v[80:83], a[88:91]
    buffer_load_dwordx4 v12, s[20:23], s63 offen offset:2048 lds
    v_mfma_f32_16x16x32_bf16 a[88:91], v[52:55], v[84:87], a[88:91]
    ds_read_b128 v[124:127], v25 offset:24576
    v_accvgpr_read_b32 v31, a155
    v_mfma_f32_16x16x32_bf16 a[92:95], v[48:51], v[88:91], a[92:95]
    v_cvt_pk_bf16_f32 v37, v37, v31
    v_accvgpr_read_b32 v38, a156
    v_mfma_f32_16x16x32_bf16 a[92:95], v[52:55], v[92:95], a[92:95]
    v_accvgpr_read_b32 v31, a157
    v_cvt_pk_bf16_f32 v38, v38, v31
    v_mfma_f32_16x16x32_bf16 a[132:135], v[48:51], a[136:139], a[132:135]
    buffer_load_dwordx4 v13, s[20:23], s63 offen offset:3072 lds
    v_mfma_f32_16x16x32_bf16 a[132:135], v[52:55], a[140:143], a[132:135]
    v_accvgpr_read_b32 v39, a158
    v_accvgpr_read_b32 v31, a159
    v_mfma_f32_16x16x32_bf16 a[96:99], v[56:59], v[64:67], a[96:99]
    v_cvt_pk_bf16_f32 v39, v39, v31
    v_accvgpr_read_b32 v32, a160
    v_mfma_f32_16x16x32_bf16 a[96:99], v[60:63], v[68:71], a[96:99]
    s_add_u32 s63, s63, 128
    buffer_store_dwordx4 v[36:39], v1, s[36:39], s72 offen sc1
    v_mfma_f32_16x16x32_bf16 a[100:103], v[56:59], v[72:75], a[100:103]
    v_accvgpr_read_b32 v31, a161
    v_cvt_pk_bf16_f32 v32, v32, v31
    v_mfma_f32_16x16x32_bf16 a[100:103], v[60:63], v[76:79], a[100:103]
    v_accvgpr_read_b32 v33, a162
    v_accvgpr_read_b32 v31, a163
    v_mfma_f32_16x16x32_bf16 a[104:107], v[56:59], v[80:83], a[104:107]
    v_cvt_pk_bf16_f32 v33, v33, v31
    v_accvgpr_read_b32 v34, a164
    v_mfma_f32_16x16x32_bf16 a[104:107], v[60:63], v[84:87], a[104:107]
    s_waitcnt vmcnt(21)
    s_barrier
    ds_read_b64_tr_b16 v[48:49], v14 offset:32768
    v_mfma_f32_16x16x32_bf16 a[108:111], v[56:59], v[88:91], a[108:111]
    s_add_u32 m0, s67, 32768
    ds_read_b64_tr_b16 v[50:51], v14 offset:33792
    ds_read_b64_tr_b16 v[52:53], v14 offset:40960
    v_mfma_f32_16x16x32_bf16 a[108:111], v[60:63], v[92:95], a[108:111]
    s_add_u32 s72, s71, 2048
    buffer_load_dwordx4 v1, s[28:31], s65 offen sc1 lds
    s_waitcnt lgkmcnt(3)
    v_mfma_f32_16x16x32_bf16 a[112:115], v[40:43], v[64:67], a[112:115]
    ds_read_b64_tr_b16 v[54:55], v14 offset:41984
    ds_read_b64_tr_b16 v[56:57], v15 offset:32768
    v_mfma_f32_16x16x32_bf16 a[112:115], v[44:47], v[68:71], a[112:115]
    ds_read_b64_tr_b16 v[58:59], v15 offset:33792
    ds_read_b64_tr_b16 v[60:61], v15 offset:40960
    v_mfma_f32_16x16x32_bf16 a[116:119], v[40:43], v[72:75], a[116:119]
    ds_read_b64_tr_b16 v[62:63], v15 offset:41984
    v_add_u32 v14, 0xffff0000, v14
    v_mfma_f32_16x16x32_bf16 a[116:119], v[44:47], v[76:79], a[116:119]
    v_add_u32 v15, 0xffff0000, v15
    v_accvgpr_read_b32 v31, a165
    v_mfma_f32_16x16x32_bf16 a[120:123], v[40:43], v[80:83], a[120:123]
    v_cvt_pk_bf16_f32 v34, v34, v31
    v_accvgpr_read_b32 v35, a166
    v_mfma_f32_16x16x32_bf16 a[120:123], v[44:47], v[84:87], a[120:123]
    v_accvgpr_read_b32 v31, a167
    v_cvt_pk_bf16_f32 v35, v35, v31
    v_mfma_f32_16x16x32_bf16 a[124:127], v[40:43], v[88:91], a[124:127]
    buffer_load_dwordx4 v1, s[28:31], s65 offen offset:1024 sc1 lds
    v_mfma_f32_16x16x32_bf16 a[124:127], v[44:47], v[92:95], a[124:127]
    s_waitcnt lgkmcnt(0)
    ds_read_b64_tr_b16 v[40:41], v16 offset:32768
    ds_read_b64_tr_b16 v[42:43], v16 offset:33792
    v_mfma_f32_16x16x32_bf16 v[128:131], v[48:51], v[96:99], v[128:131]
    ds_read_b64_tr_b16 v[44:45], v16 offset:40960
    ds_read_b64_tr_b16 v[46:47], v16 offset:41984
    v_mfma_f32_16x16x32_bf16 v[128:131], v[52:55], v[100:103], v[128:131]
    v_add_u32 v16, 0xffff0000, v16
    v_accvgpr_read_b32 v36, a168
    v_mfma_f32_16x16x32_bf16 v[132:135], v[48:51], v[104:107], v[132:135]
    ds_read_b128 v[64:67], v24 offset:49152
    v_accvgpr_read_b32 v31, a169
    v_mfma_f32_16x16x32_bf16 v[132:135], v[52:55], v[108:111], v[132:135]
    buffer_store_dwordx4 v[32:35], v1, s[36:39], s72 offen sc1
    v_mfma_f32_16x16x32_bf16 v[136:139], v[48:51], v[112:115], v[136:139]
    v_cvt_pk_bf16_f32 v36, v36, v31
    v_accvgpr_read_b32 v37, a170
    v_mfma_f32_16x16x32_bf16 v[136:139], v[52:55], v[116:119], v[136:139]
    v_accvgpr_read_b32 v31, a171
    v_cvt_pk_bf16_f32 v37, v37, v31
    v_mfma_f32_16x16x32_bf16 v[140:143], v[48:51], v[120:123], v[140:143]
    s_add_u32 m0, s68, 40960
    ds_read_b64_tr_b16 v[48:49], v17 offset:32768
    ds_read_b64_tr_b16 v[50:51], v17 offset:33792
    v_mfma_f32_16x16x32_bf16 v[140:143], v[52:55], v[124:127], v[140:143]
    buffer_load_dwordx4 v6, s[20:23], s66 offen lds
    v_mfma_f32_16x16x32_bf16 v[144:147], v[56:59], v[96:99], v[144:147]
    s_add_u32 s72, s71, 3072
    ds_read_b64_tr_b16 v[52:53], v17 offset:40960
    ds_read_b64_tr_b16 v[54:55], v17 offset:41984
    v_mfma_f32_16x16x32_bf16 v[144:147], v[60:63], v[100:103], v[144:147]
    v_add_u32 v17, 0xffff0000, v17
    v_accvgpr_read_b32 v38, a172
    v_mfma_f32_16x16x32_bf16 v[148:151], v[56:59], v[104:107], v[148:151]
    v_accvgpr_read_b32 v31, a173
    v_cvt_pk_bf16_f32 v38, v38, v31
    v_mfma_f32_16x16x32_bf16 v[148:151], v[60:63], v[108:111], v[148:151]
    v_accvgpr_read_b32 v39, a174
    v_accvgpr_read_b32 v31, a175
    v_mfma_f32_16x16x32_bf16 v[152:155], v[56:59], v[112:115], v[152:155]
    v_cvt_pk_bf16_f32 v39, v39, v31
    v_accvgpr_write_b32 a144, 0
    v_mfma_f32_16x16x32_bf16 v[152:155], v[60:63], v[116:119], v[152:155]
    ds_read_b128 v[68:71], v25 offset:49152
    v_accvgpr_write_b32 a145, 0
    v_mfma_f32_16x16x32_bf16 v[156:159], v[56:59], v[120:123], v[156:159]
    s_add_u32 m0, s69, 49152
    ds_read_b64_tr_b16 v[56:57], v18 offset:32768
    ds_read_b64_tr_b16 v[58:59], v18 offset:33792
    v_mfma_f32_16x16x32_bf16 v[156:159], v[60:63], v[124:127], v[156:159]
    s_add_u32 s65, s65, 8192
    buffer_load_dwordx4 v10, s[20:23], s64 offen lds
    s_waitcnt lgkmcnt(3)
    v_mfma_f32_16x16x32_bf16 v[160:163], v[40:43], v[96:99], v[160:163]
    s_add_u32 s66, s66, 128
    ds_read_b64_tr_b16 v[60:61], v18 offset:40960
    ds_read_b64_tr_b16 v[62:63], v18 offset:41984
    v_mfma_f32_16x16x32_bf16 v[160:163], v[44:47], v[100:103], v[160:163]
    v_add_u32 v18, 0xffff0000, v18
    v_accvgpr_read_b32 v32, a176
    v_mfma_f32_16x16x32_bf16 v[164:167], v[40:43], v[104:107], v[164:167]
    buffer_store_dwordx4 v[36:39], v1, s[36:39], s72 offen sc1
    v_mfma_f32_16x16x32_bf16 v[164:167], v[44:47], v[108:111], v[164:167]
    v_accvgpr_read_b32 v31, a177
    v_cvt_pk_bf16_f32 v32, v32, v31
    v_mfma_f32_16x16x32_bf16 v[168:171], v[40:43], v[112:115], v[168:171]
    v_accvgpr_read_b32 v33, a178
    v_accvgpr_read_b32 v31, a179
    v_mfma_f32_16x16x32_bf16 v[168:171], v[44:47], v[116:119], v[168:171]
    v_cvt_pk_bf16_f32 v33, v33, v31
    v_accvgpr_read_b32 v34, a180
    v_mfma_f32_16x16x32_bf16 v[172:175], v[40:43], v[120:123], v[172:175]
    ds_read_b64_tr_b16 v[40:41], v19 offset:32768
    ds_read_b64_tr_b16 v[42:43], v19 offset:33792
    v_mfma_f32_16x16x32_bf16 v[172:175], v[44:47], v[124:127], v[172:175]
    ds_read_b64_tr_b16 v[44:45], v19 offset:40960
    ds_read_b64_tr_b16 v[46:47], v19 offset:41984
    v_mfma_f32_16x16x32_bf16 v[176:179], v[48:51], v[96:99], v[176:179]
    buffer_load_dwordx4 v11, s[20:23], s64 offen offset:1024 lds
    v_mfma_f32_16x16x32_bf16 v[176:179], v[52:55], v[100:103], v[176:179]
    s_add_u32 s72, s71, 34816
    ds_read_b128 v[72:75], v24 offset:57344
    v_add_u32 v19, 0xffff0000, v19
    v_mfma_f32_16x16x32_bf16 v[180:183], v[48:51], v[104:107], v[180:183]
    v_accvgpr_read_b32 v31, a181
    v_cvt_pk_bf16_f32 v34, v34, v31
    v_mfma_f32_16x16x32_bf16 v[180:183], v[52:55], v[108:111], v[180:183]
    v_accvgpr_read_b32 v35, a182
    v_accvgpr_read_b32 v31, a183
    v_mfma_f32_16x16x32_bf16 v[184:187], v[48:51], v[112:115], v[184:187]
    v_cvt_pk_bf16_f32 v35, v35, v31
    v_accvgpr_write_b32 a146, 0
    v_mfma_f32_16x16x32_bf16 v[184:187], v[52:55], v[116:119], v[184:187]
    buffer_store_dwordx4 v[32:35], v1, s[36:39], s72 offen sc1
    v_mfma_f32_16x16x32_bf16 v[188:191], v[48:51], v[120:123], v[188:191]
    ds_read_b64_tr_b16 v[48:49], v20 offset:32768
    ds_read_b64_tr_b16 v[50:51], v20 offset:33792
    v_mfma_f32_16x16x32_bf16 v[188:191], v[52:55], v[124:127], v[188:191]
    s_waitcnt lgkmcnt(2)
    ds_read_b64_tr_b16 v[52:53], v20 offset:40960
    ds_read_b64_tr_b16 v[54:55], v20 offset:41984
    v_mfma_f32_16x16x32_bf16 v[192:195], v[56:59], v[96:99], v[192:195]
    buffer_load_dwordx4 v12, s[20:23], s64 offen offset:2048 lds
    v_mfma_f32_16x16x32_bf16 v[192:195], v[60:63], v[100:103], v[192:195]
    v_add_u32 v20, 0xffff0000, v20
    v_accvgpr_read_b32 v36, a184
    v_mfma_f32_16x16x32_bf16 v[196:199], v[56:59], v[104:107], v[196:199]
    v_accvgpr_read_b32 v31, a185
    v_cvt_pk_bf16_f32 v36, v36, v31
    v_mfma_f32_16x16x32_bf16 v[196:199], v[60:63], v[108:111], v[196:199]
    ds_read_b128 v[76:79], v25 offset:57344
    v_accvgpr_read_b32 v37, a186
    v_mfma_f32_16x16x32_bf16 v[200:203], v[56:59], v[112:115], v[200:203]
    v_accvgpr_read_b32 v31, a187
    v_cvt_pk_bf16_f32 v37, v37, v31
    v_mfma_f32_16x16x32_bf16 v[200:203], v[60:63], v[116:119], v[200:203]
    v_accvgpr_read_b32 v38, a188
    v_accvgpr_read_b32 v31, a189
    v_mfma_f32_16x16x32_bf16 v[204:207], v[56:59], v[120:123], v[204:207]
    ds_read_b64_tr_b16 v[56:57], v21 offset:32768
    ds_read_b64_tr_b16 v[58:59], v21 offset:33792
    v_mfma_f32_16x16x32_bf16 v[204:207], v[60:63], v[124:127], v[204:207]
    ds_read_b64_tr_b16 v[60:61], v21 offset:40960
    ds_read_b64_tr_b16 v[62:63], v21 offset:41984
    v_mfma_f32_16x16x32_bf16 v[208:211], v[40:43], v[96:99], v[208:211]
    v_add_u32 v21, 0xffff0000, v21
    v_cvt_pk_bf16_f32 v38, v38, v31
    v_mfma_f32_16x16x32_bf16 v[208:211], v[44:47], v[100:103], v[208:211]
    buffer_load_dwordx4 v13, s[20:23], s64 offen offset:3072 lds
    v_mfma_f32_16x16x32_bf16 v[212:215], v[40:43], v[104:107], v[212:215]
    s_add_u32 s72, s71, 35840
    v_accvgpr_read_b32 v39, a190
    v_accvgpr_read_b32 v31, a191
    v_mfma_f32_16x16x32_bf16 v[212:215], v[44:47], v[108:111], v[212:215]
    v_cvt_pk_bf16_f32 v39, v39, v31
    v_accvgpr_write_b32 a147, 0
    v_mfma_f32_16x16x32_bf16 v[216:219], v[40:43], v[112:115], v[216:219]
    buffer_store_dwordx4 v[36:39], v1, s[36:39], s72 offen sc1
    v_mfma_f32_16x16x32_bf16 v[216:219], v[44:47], v[116:119], v[216:219]
    v_accvgpr_write_b32 a148, 0
    v_accvgpr_write_b32 a149, 0
    v_mfma_f32_16x16x32_bf16 v[220:223], v[40:43], v[120:123], v[220:223]
    v_accvgpr_write_b32 a150, 0
    v_accvgpr_write_b32 a151, 0
    v_mfma_f32_16x16x32_bf16 v[220:223], v[44:47], v[124:127], v[220:223]
    s_waitcnt lgkmcnt(0)
    v_accvgpr_write_b32 a152, 0
    v_accvgpr_write_b32 a153, 0
    v_mfma_f32_16x16x32_bf16 v[224:227], v[48:51], v[96:99], v[224:227]
    v_accvgpr_write_b32 a154, 0
    v_accvgpr_write_b32 a155, 0
    v_mfma_f32_16x16x32_bf16 v[224:227], v[52:55], v[100:103], v[224:227]
    s_add_u32 s64, s64, 128
    v_accvgpr_write_b32 a156, 0
    v_accvgpr_write_b32 a157, 0
    v_mfma_f32_16x16x32_bf16 v[228:231], v[48:51], v[104:107], v[228:231]
    v_accvgpr_read_b32 v32, a192
    v_accvgpr_read_b32 v31, a193
    v_mfma_f32_16x16x32_bf16 v[228:231], v[52:55], v[108:111], v[228:231]
    v_cvt_pk_bf16_f32 v32, v32, v31
    v_accvgpr_read_b32 v33, a194
    v_mfma_f32_16x16x32_bf16 v[232:235], v[48:51], v[112:115], v[232:235]
    v_accvgpr_read_b32 v31, a195
    v_cvt_pk_bf16_f32 v33, v33, v31
    v_mfma_f32_16x16x32_bf16 v[232:235], v[52:55], v[116:119], v[232:235]
    s_waitcnt vmcnt(22)
    s_barrier
    ds_read_b64_tr_b16 v[40:41], v26 offset:0
    v_mfma_f32_16x16x32_bf16 v[236:239], v[48:51], v[120:123], v[236:239]
    s_add_u32 m0, s69, 65536
    ds_read_b64_tr_b16 v[42:43], v26 offset:512
    ds_read_b64_tr_b16 v[44:45], v26 offset:4096
    v_mfma_f32_16x16x32_bf16 v[236:239], v[52:55], v[124:127], v[236:239]
    buffer_load_dwordx4 v2, s[24:27], s60 offen lds
    v_mfma_f32_16x16x32_bf16 v[240:243], v[56:59], v[96:99], v[240:243]
    ds_read_b64_tr_b16 v[46:47], v26 offset:4608
    ds_read_b128 a[136:139], v22 offset:0
    v_mfma_f32_16x16x32_bf16 v[240:243], v[60:63], v[100:103], v[240:243]
    ds_read_b128 a[140:143], v23 offset:0
    ds_read_b64_tr_b16 v[48:49], v27 offset:0
    v_mfma_f32_16x16x32_bf16 v[244:247], v[56:59], v[104:107], v[244:247]
    buffer_load_dwordx4 v3, s[24:27], s60 offen offset:1024 lds
    v_mfma_f32_16x16x32_bf16 v[244:247], v[60:63], v[108:111], v[244:247]
    s_add_u32 s72, s71, 4096
    ds_read_b64_tr_b16 v[50:51], v27 offset:512
    ds_read_b64_tr_b16 v[52:53], v27 offset:4096
    v_mfma_f32_16x16x32_bf16 v[248:251], v[56:59], v[112:115], v[248:251]
    ds_read_b64_tr_b16 v[54:55], v27 offset:4608
    v_add_u32 v26, 0xfffe0000, v26
    v_mfma_f32_16x16x32_bf16 v[248:251], v[60:63], v[116:119], v[248:251]
    v_add_u32 v22, 0xfffe0000, v22
    v_add_u32 v23, 0xfffe0000, v23
    v_mfma_f32_16x16x32_bf16 v[252:255], v[56:59], v[120:123], v[252:255]
    buffer_load_dwordx4 v4, s[24:27], s60 offen offset:2048 lds
    v_mfma_f32_16x16x32_bf16 v[252:255], v[60:63], v[124:127], v[252:255]
    s_waitcnt lgkmcnt(3)
    ds_read_b64_tr_b16 v[56:57], v28 offset:0
    ds_read_b64_tr_b16 v[58:59], v28 offset:512
    v_mfma_f32_16x16x32_bf16 a[64:67], v[40:43], v[96:99], a[64:67]
    ds_read_b64_tr_b16 v[60:61], v28 offset:4096
    ds_read_b64_tr_b16 v[62:63], v28 offset:4608
    v_mfma_f32_16x16x32_bf16 a[64:67], v[44:47], v[100:103], a[64:67]
    v_add_u32 v24, 0x10000, v24
    v_add_u32 v27, 0xfffe0000, v27
    v_mfma_f32_16x16x32_bf16 a[68:71], v[40:43], v[104:107], a[68:71]
    buffer_load_dwordx4 v5, s[24:27], s60 offen offset:3072 lds
    v_mfma_f32_16x16x32_bf16 a[68:71], v[44:47], v[108:111], a[68:71]
    ds_read_b128 v[80:83], v24 offset:16384
    v_add_u32 v28, 0xfffe0000, v28
    v_mfma_f32_16x16x32_bf16 a[72:75], v[40:43], v[112:115], a[72:75]
    v_accvgpr_read_b32 v34, a196
    v_accvgpr_read_b32 v31, a197
    v_mfma_f32_16x16x32_bf16 a[72:75], v[44:47], v[116:119], a[72:75]
    s_add_u32 m0, s69, 81920
    v_add_u32 v25, 0x10000, v25
    v_cvt_pk_bf16_f32 v34, v34, v31
    v_mfma_f32_16x16x32_bf16 a[76:79], v[40:43], v[120:123], a[76:79]
    s_add_u32 s60, s60, 524288
    buffer_load_dwordx4 v10, s[20:23], s63 offen lds
    v_mfma_f32_16x16x32_bf16 a[76:79], v[44:47], v[124:127], a[76:79]
    ds_read_b128 v[84:87], v25 offset:16384
    v_accvgpr_read_b32 v35, a198
    v_mfma_f32_16x16x32_bf16 a[128:131], v[40:43], a[136:139], a[128:131]
    ds_read_b64_tr_b16 v[40:41], v29 offset:0
    ds_read_b64_tr_b16 v[42:43], v29 offset:512
    v_mfma_f32_16x16x32_bf16 a[128:131], v[44:47], a[140:143], a[128:131]
    s_waitcnt lgkmcnt(3)
    ds_read_b64_tr_b16 v[44:45], v29 offset:4096
    ds_read_b64_tr_b16 v[46:47], v29 offset:4608
    v_mfma_f32_16x16x32_bf16 a[80:83], v[48:51], v[96:99], a[80:83]
    buffer_load_dwordx4 v11, s[20:23], s63 offen offset:1024 lds
    v_mfma_f32_16x16x32_bf16 a[80:83], v[52:55], v[100:103], a[80:83]
    ds_read_b128 v[88:91], v24 offset:24576
    v_add_u32 v29, 0xfffe0000, v29
    v_mfma_f32_16x16x32_bf16 a[84:87], v[48:51], v[104:107], a[84:87]
    v_accvgpr_read_b32 v31, a199
    v_cvt_pk_bf16_f32 v35, v35, v31
    v_mfma_f32_16x16x32_bf16 a[84:87], v[52:55], v[108:111], a[84:87]
    buffer_store_dwordx4 v[32:35], v1, s[36:39], s72 offen sc1
    v_mfma_f32_16x16x32_bf16 a[88:91], v[48:51], v[112:115], a[88:91]
    s_add_u32 s72, s71, 5120
    buffer_load_dwordx4 v12, s[20:23], s63 offen offset:2048 lds
    v_mfma_f32_16x16x32_bf16 a[88:91], v[52:55], v[116:119], a[88:91]
    ds_read_b128 v[92:95], v25 offset:24576
    v_accvgpr_read_b32 v36, a200
    v_mfma_f32_16x16x32_bf16 a[92:95], v[48:51], v[120:123], a[92:95]
    v_accvgpr_read_b32 v31, a201
    v_cvt_pk_bf16_f32 v36, v36, v31
    v_mfma_f32_16x16x32_bf16 a[92:95], v[52:55], v[124:127], a[92:95]
    v_accvgpr_read_b32 v37, a202
    v_accvgpr_read_b32 v31, a203
    v_mfma_f32_16x16x32_bf16 a[132:135], v[48:51], a[136:139], a[132:135]
    buffer_load_dwordx4 v13, s[20:23], s63 offen offset:3072 lds
    v_mfma_f32_16x16x32_bf16 a[132:135], v[52:55], a[140:143], a[132:135]
    v_cvt_pk_bf16_f32 v37, v37, v31
    v_accvgpr_read_b32 v38, a204
    v_mfma_f32_16x16x32_bf16 a[96:99], v[56:59], v[96:99], a[96:99]
    v_accvgpr_read_b32 v31, a205
    v_cvt_pk_bf16_f32 v38, v38, v31
    v_mfma_f32_16x16x32_bf16 a[96:99], v[60:63], v[100:103], a[96:99]
    s_add_u32 s63, s63, 128
    v_accvgpr_read_b32 v39, a206
    v_accvgpr_read_b32 v31, a207
    v_mfma_f32_16x16x32_bf16 a[100:103], v[56:59], v[104:107], a[100:103]
    v_cvt_pk_bf16_f32 v39, v39, v31
    v_accvgpr_read_b32 v32, a208
    v_mfma_f32_16x16x32_bf16 a[100:103], v[60:63], v[108:111], a[100:103]
    buffer_store_dwordx4 v[36:39], v1, s[36:39], s72 offen sc1
    v_mfma_f32_16x16x32_bf16 a[104:107], v[56:59], v[112:115], a[104:107]
    v_accvgpr_read_b32 v31, a209
    v_cvt_pk_bf16_f32 v32, v32, v31
    v_mfma_f32_16x16x32_bf16 a[104:107], v[60:63], v[116:119], a[104:107]
    s_waitcnt vmcnt(22)
    s_barrier
    ds_read_b64_tr_b16 v[48:49], v14 offset:0
    v_mfma_f32_16x16x32_bf16 a[108:111], v[56:59], v[120:123], a[108:111]
    s_add_u32 m0, s67, 98304
    ds_read_b64_tr_b16 v[50:51], v14 offset:1024
    ds_read_b64_tr_b16 v[52:53], v14 offset:8192
    v_mfma_f32_16x16x32_bf16 a[108:111], v[60:63], v[124:127], a[108:111]
    s_waitcnt lgkmcnt(3)
    buffer_load_dwordx4 v1, s[28:31], s65 offen sc1 lds
    v_mfma_f32_16x16x32_bf16 a[112:115], v[40:43], v[96:99], a[112:115]
    ds_read_b64_tr_b16 v[54:55], v14 offset:9216
    ds_read_b64_tr_b16 v[56:57], v15 offset:0
    v_mfma_f32_16x16x32_bf16 a[112:115], v[44:47], v[100:103], a[112:115]
    s_add_u32 s72, s71, 36864
    ds_read_b64_tr_b16 v[58:59], v15 offset:1024
    ds_read_b64_tr_b16 v[60:61], v15 offset:8192
    v_mfma_f32_16x16x32_bf16 a[116:119], v[40:43], v[104:107], a[116:119]
    ds_read_b64_tr_b16 v[62:63], v15 offset:9216
    v_add_u32 v14, 0x10000, v14
    v_mfma_f32_16x16x32_bf16 a[116:119], v[44:47], v[108:111], a[116:119]
    v_add_u32 v15, 0x10000, v15
    v_accvgpr_read_b32 v33, a210
    v_mfma_f32_16x16x32_bf16 a[120:123], v[40:43], v[112:115], a[120:123]
    v_accvgpr_read_b32 v31, a211
    v_cvt_pk_bf16_f32 v33, v33, v31
    v_mfma_f32_16x16x32_bf16 a[120:123], v[44:47], v[116:119], a[120:123]
    v_accvgpr_read_b32 v34, a212
    v_accvgpr_read_b32 v31, a213
    v_mfma_f32_16x16x32_bf16 a[124:127], v[40:43], v[120:123], a[124:127]
    buffer_load_dwordx4 v1, s[28:31], s65 offen offset:1024 sc1 lds
    v_mfma_f32_16x16x32_bf16 a[124:127], v[44:47], v[124:127], a[124:127]
    s_waitcnt lgkmcnt(0)
    ds_read_b64_tr_b16 v[40:41], v16 offset:0
    ds_read_b64_tr_b16 v[42:43], v16 offset:1024
    v_mfma_f32_16x16x32_bf16 v[128:131], v[48:51], v[64:67], v[128:131]
    ds_read_b64_tr_b16 v[44:45], v16 offset:8192
    ds_read_b64_tr_b16 v[46:47], v16 offset:9216
    v_mfma_f32_16x16x32_bf16 v[128:131], v[52:55], v[68:71], v[128:131]
    v_add_u32 v24, 0xfffe0000, v24
    v_add_u32 v16, 0x10000, v16
    v_mfma_f32_16x16x32_bf16 v[132:135], v[48:51], v[72:75], v[132:135]
    ds_read_b128 v[96:99], v24 offset:16384
    v_cvt_pk_bf16_f32 v34, v34, v31
    v_mfma_f32_16x16x32_bf16 v[132:135], v[52:55], v[76:79], v[132:135]
    v_accvgpr_read_b32 v35, a214
    v_accvgpr_read_b32 v31, a215
    v_mfma_f32_16x16x32_bf16 v[136:139], v[48:51], v[80:83], v[136:139]
    v_cvt_pk_bf16_f32 v35, v35, v31
    v_accvgpr_read_b32 v36, a216
    v_mfma_f32_16x16x32_bf16 v[136:139], v[52:55], v[84:87], v[136:139]
    buffer_store_dwordx4 v[32:35], v1, s[36:39], s72 offen sc1
    v_mfma_f32_16x16x32_bf16 v[140:143], v[48:51], v[88:91], v[140:143]
    s_add_u32 m0, s68, 106496
    ds_read_b64_tr_b16 v[48:49], v17 offset:0
    ds_read_b64_tr_b16 v[50:51], v17 offset:1024
    v_mfma_f32_16x16x32_bf16 v[140:143], v[52:55], v[92:95], v[140:143]
    buffer_load_dwordx4 v6, s[20:23], s66 offen lds
    v_mfma_f32_16x16x32_bf16 v[144:147], v[56:59], v[64:67], v[144:147]
    ds_read_b64_tr_b16 v[52:53], v17 offset:8192
    ds_read_b64_tr_b16 v[54:55], v17 offset:9216
    v_mfma_f32_16x16x32_bf16 v[144:147], v[60:63], v[68:71], v[144:147]
    v_add_u32 v17, 0x10000, v17
    v_accvgpr_read_b32 v31, a217
    v_mfma_f32_16x16x32_bf16 v[148:151], v[56:59], v[72:75], v[148:151]
    s_add_u32 s72, s71, 37888
    v_cvt_pk_bf16_f32 v36, v36, v31
    v_accvgpr_read_b32 v37, a218
    v_mfma_f32_16x16x32_bf16 v[148:151], v[60:63], v[76:79], v[148:151]
    v_accvgpr_read_b32 v31, a219
    v_cvt_pk_bf16_f32 v37, v37, v31
    v_mfma_f32_16x16x32_bf16 v[152:155], v[56:59], v[80:83], v[152:155]
    v_add_u32 v25, 0xfffe0000, v25
    v_accvgpr_read_b32 v38, a220
    v_mfma_f32_16x16x32_bf16 v[152:155], v[60:63], v[84:87], v[152:155]
    ds_read_b128 v[100:103], v25 offset:16384
    v_accvgpr_read_b32 v31, a221
    v_mfma_f32_16x16x32_bf16 v[156:159], v[56:59], v[88:91], v[156:159]
    s_add_u32 m0, s69, 114688
    ds_read_b64_tr_b16 v[56:57], v18 offset:0
    ds_read_b64_tr_b16 v[58:59], v18 offset:1024
    v_mfma_f32_16x16x32_bf16 v[156:159], v[60:63], v[92:95], v[156:159]
    s_add_u32 s65, s65, 8192
    buffer_load_dwordx4 v10, s[20:23], s64 offen lds
    s_waitcnt lgkmcnt(3)
    v_mfma_f32_16x16x32_bf16 v[160:163], v[40:43], v[64:67], v[160:163]
    s_add_u32 s66, s66, 128
    ds_read_b64_tr_b16 v[60:61], v18 offset:8192
    ds_read_b64_tr_b16 v[62:63], v18 offset:9216
    v_mfma_f32_16x16x32_bf16 v[160:163], v[44:47], v[68:71], v[160:163]
    v_add_u32 v18, 0x10000, v18
    v_cvt_pk_bf16_f32 v38, v38, v31
    v_mfma_f32_16x16x32_bf16 v[164:167], v[40:43], v[72:75], v[164:167]
    v_accvgpr_read_b32 v39, a222
    v_accvgpr_read_b32 v31, a223
    v_mfma_f32_16x16x32_bf16 v[164:167], v[44:47], v[76:79], v[164:167]
    v_cvt_pk_bf16_f32 v39, v39, v31
    v_accvgpr_read_b32 v32, a224
    v_mfma_f32_16x16x32_bf16 v[168:171], v[40:43], v[80:83], v[168:171]
    buffer_store_dwordx4 v[36:39], v1, s[36:39], s72 offen sc1
    v_mfma_f32_16x16x32_bf16 v[168:171], v[44:47], v[84:87], v[168:171]
    v_accvgpr_read_b32 v31, a225
    v_cvt_pk_bf16_f32 v32, v32, v31
    v_mfma_f32_16x16x32_bf16 v[172:175], v[40:43], v[88:91], v[172:175]
    ds_read_b64_tr_b16 v[40:41], v19 offset:0
    ds_read_b64_tr_b16 v[42:43], v19 offset:1024
    v_mfma_f32_16x16x32_bf16 v[172:175], v[44:47], v[92:95], v[172:175]
    ds_read_b64_tr_b16 v[44:45], v19 offset:8192
    ds_read_b64_tr_b16 v[46:47], v19 offset:9216
    v_mfma_f32_16x16x32_bf16 v[176:179], v[48:51], v[64:67], v[176:179]
    buffer_load_dwordx4 v11, s[20:23], s64 offen offset:1024 lds
    v_mfma_f32_16x16x32_bf16 v[176:179], v[52:55], v[68:71], v[176:179]
    ds_read_b128 v[104:107], v24 offset:24576
    v_add_u32 v19, 0x10000, v19
    v_mfma_f32_16x16x32_bf16 v[180:183], v[48:51], v[72:75], v[180:183]
    v_accvgpr_read_b32 v33, a226
    v_accvgpr_read_b32 v31, a227
    v_mfma_f32_16x16x32_bf16 v[180:183], v[52:55], v[76:79], v[180:183]
    s_add_u32 s72, s71, 6144
    v_cvt_pk_bf16_f32 v33, v33, v31
    v_accvgpr_read_b32 v34, a228
    v_mfma_f32_16x16x32_bf16 v[184:187], v[48:51], v[80:83], v[184:187]
    v_accvgpr_read_b32 v31, a229
    v_cvt_pk_bf16_f32 v34, v34, v31
    v_mfma_f32_16x16x32_bf16 v[184:187], v[52:55], v[84:87], v[184:187]
    v_accvgpr_read_b32 v35, a230
    v_accvgpr_read_b32 v31, a231
    v_mfma_f32_16x16x32_bf16 v[188:191], v[48:51], v[88:91], v[188:191]
    ds_read_b64_tr_b16 v[48:49], v20 offset:0
    ds_read_b64_tr_b16 v[50:51], v20 offset:1024
    v_mfma_f32_16x16x32_bf16 v[188:191], v[52:55], v[92:95], v[188:191]
    s_waitcnt lgkmcnt(2)
    ds_read_b64_tr_b16 v[52:53], v20 offset:8192
    ds_read_b64_tr_b16 v[54:55], v20 offset:9216
    v_mfma_f32_16x16x32_bf16 v[192:195], v[56:59], v[64:67], v[192:195]
    buffer_load_dwordx4 v12, s[20:23], s64 offen offset:2048 lds
    v_mfma_f32_16x16x32_bf16 v[192:195], v[60:63], v[68:71], v[192:195]
    v_add_u32 v20, 0x10000, v20
    v_cvt_pk_bf16_f32 v35, v35, v31
    v_mfma_f32_16x16x32_bf16 v[196:199], v[56:59], v[72:75], v[196:199]
    buffer_store_dwordx4 v[32:35], v1, s[36:39], s72 offen sc1
    v_mfma_f32_16x16x32_bf16 v[196:199], v[60:63], v[76:79], v[196:199]
    ds_read_b128 v[108:111], v25 offset:24576
    v_accvgpr_read_b32 v36, a232
    v_mfma_f32_16x16x32_bf16 v[200:203], v[56:59], v[80:83], v[200:203]
    v_accvgpr_read_b32 v31, a233
    v_cvt_pk_bf16_f32 v36, v36, v31
    v_mfma_f32_16x16x32_bf16 v[200:203], v[60:63], v[84:87], v[200:203]
    v_accvgpr_read_b32 v37, a234
    v_accvgpr_read_b32 v31, a235
    v_mfma_f32_16x16x32_bf16 v[204:207], v[56:59], v[88:91], v[204:207]
    ds_read_b64_tr_b16 v[56:57], v21 offset:0
    ds_read_b64_tr_b16 v[58:59], v21 offset:1024
    v_mfma_f32_16x16x32_bf16 v[204:207], v[60:63], v[92:95], v[204:207]
    ds_read_b64_tr_b16 v[60:61], v21 offset:8192
    ds_read_b64_tr_b16 v[62:63], v21 offset:9216
    v_mfma_f32_16x16x32_bf16 v[208:211], v[40:43], v[64:67], v[208:211]
    v_add_u32 v21, 0x10000, v21
    v_cvt_pk_bf16_f32 v37, v37, v31
    v_mfma_f32_16x16x32_bf16 v[208:211], v[44:47], v[68:71], v[208:211]
    buffer_load_dwordx4 v13, s[20:23], s64 offen offset:3072 lds
    v_mfma_f32_16x16x32_bf16 v[212:215], v[40:43], v[72:75], v[212:215]
    v_accvgpr_read_b32 v38, a236
    v_accvgpr_read_b32 v31, a237
    v_mfma_f32_16x16x32_bf16 v[212:215], v[44:47], v[76:79], v[212:215]
    v_cvt_pk_bf16_f32 v38, v38, v31
    v_accvgpr_read_b32 v39, a238
    v_mfma_f32_16x16x32_bf16 v[216:219], v[40:43], v[80:83], v[216:219]
    s_add_u32 s72, s71, 7168
    v_accvgpr_read_b32 v31, a239
    v_cvt_pk_bf16_f32 v39, v39, v31
    v_mfma_f32_16x16x32_bf16 v[216:219], v[44:47], v[84:87], v[216:219]
    buffer_store_dwordx4 v[36:39], v1, s[36:39], s72 offen sc1
    v_mfma_f32_16x16x32_bf16 v[220:223], v[40:43], v[88:91], v[220:223]
    v_accvgpr_write_b32 a158, 0
    v_accvgpr_write_b32 a159, 0
    v_mfma_f32_16x16x32_bf16 v[220:223], v[44:47], v[92:95], v[220:223]
    s_waitcnt lgkmcnt(0)
    v_accvgpr_write_b32 a160, 0
    v_accvgpr_write_b32 a161, 0
    v_mfma_f32_16x16x32_bf16 v[224:227], v[48:51], v[64:67], v[224:227]
    v_accvgpr_write_b32 a162, 0
    v_accvgpr_write_b32 a163, 0
    v_mfma_f32_16x16x32_bf16 v[224:227], v[52:55], v[68:71], v[224:227]
    s_add_u32 s64, s64, 128
    v_accvgpr_write_b32 a164, 0
    v_accvgpr_write_b32 a165, 0
    v_mfma_f32_16x16x32_bf16 v[228:231], v[48:51], v[72:75], v[228:231]
    v_accvgpr_write_b32 a166, 0
    v_accvgpr_write_b32 a167, 0
    v_mfma_f32_16x16x32_bf16 v[228:231], v[52:55], v[76:79], v[228:231]
    v_accvgpr_write_b32 a168, 0
    v_accvgpr_write_b32 a169, 0
    v_mfma_f32_16x16x32_bf16 v[232:235], v[48:51], v[80:83], v[232:235]
    v_accvgpr_read_b32 v32, a240
    v_accvgpr_read_b32 v31, a241
    v_mfma_f32_16x16x32_bf16 v[232:235], v[52:55], v[84:87], v[232:235]
    s_waitcnt vmcnt(22)
    s_barrier
    ds_read_b64_tr_b16 v[40:41], v26 offset:32768
    v_mfma_f32_16x16x32_bf16 v[236:239], v[48:51], v[88:91], v[236:239]
    s_add_u32 m0, s69, 131072
    ds_read_b64_tr_b16 v[42:43], v26 offset:33280
    ds_read_b64_tr_b16 v[44:45], v26 offset:36864
    v_mfma_f32_16x16x32_bf16 v[236:239], v[52:55], v[92:95], v[236:239]
    buffer_load_dwordx4 v2, s[24:27], s60 offen lds
    v_mfma_f32_16x16x32_bf16 v[240:243], v[56:59], v[64:67], v[240:243]
    ds_read_b64_tr_b16 v[46:47], v26 offset:37376
    ds_read_b128 a[136:139], v22 offset:32768
    v_mfma_f32_16x16x32_bf16 v[240:243], v[60:63], v[68:71], v[240:243]
    ds_read_b128 a[140:143], v23 offset:32768
    ds_read_b64_tr_b16 v[48:49], v27 offset:32768
    v_mfma_f32_16x16x32_bf16 v[244:247], v[56:59], v[72:75], v[244:247]
    buffer_load_dwordx4 v3, s[24:27], s60 offen offset:1024 lds
    v_mfma_f32_16x16x32_bf16 v[244:247], v[60:63], v[76:79], v[244:247]
    ds_read_b64_tr_b16 v[50:51], v27 offset:33280
    ds_read_b64_tr_b16 v[52:53], v27 offset:36864
    v_mfma_f32_16x16x32_bf16 v[248:251], v[56:59], v[80:83], v[248:251]
    ds_read_b64_tr_b16 v[54:55], v27 offset:37376
    v_add_u32 v26, 0x10000, v26
    v_mfma_f32_16x16x32_bf16 v[248:251], v[60:63], v[84:87], v[248:251]
    s_add_u32 s72, s71, 38912
    v_add_u32 v22, 0x10000, v22
    v_add_u32 v23, 0x10000, v23
    v_mfma_f32_16x16x32_bf16 v[252:255], v[56:59], v[88:91], v[252:255]
    buffer_load_dwordx4 v4, s[24:27], s60 offen offset:2048 lds
    v_mfma_f32_16x16x32_bf16 v[252:255], v[60:63], v[92:95], v[252:255]
    s_waitcnt lgkmcnt(3)
    ds_read_b64_tr_b16 v[56:57], v28 offset:32768
    ds_read_b64_tr_b16 v[58:59], v28 offset:33280
    v_mfma_f32_16x16x32_bf16 a[64:67], v[40:43], v[64:67], a[64:67]
    ds_read_b64_tr_b16 v[60:61], v28 offset:36864
    ds_read_b64_tr_b16 v[62:63], v28 offset:37376
    v_mfma_f32_16x16x32_bf16 a[64:67], v[44:47], v[68:71], a[64:67]
    v_add_u32 v27, 0x10000, v27
    v_add_u32 v28, 0x10000, v28
    v_mfma_f32_16x16x32_bf16 a[68:71], v[40:43], v[72:75], a[68:71]
    buffer_load_dwordx4 v5, s[24:27], s60 offen offset:3072 lds
    v_mfma_f32_16x16x32_bf16 a[68:71], v[44:47], v[76:79], a[68:71]
    ds_read_b128 v[112:115], v24 offset:49152
    v_cvt_pk_bf16_f32 v32, v32, v31
    v_mfma_f32_16x16x32_bf16 a[72:75], v[40:43], v[80:83], a[72:75]
    v_accvgpr_read_b32 v33, a242
    v_accvgpr_read_b32 v31, a243
    v_mfma_f32_16x16x32_bf16 a[72:75], v[44:47], v[84:87], a[72:75]
    s_add_u32 m0, s69, 147456
    v_cvt_pk_bf16_f32 v33, v33, v31
    v_accvgpr_read_b32 v34, a244
    v_mfma_f32_16x16x32_bf16 a[76:79], v[40:43], v[88:91], a[76:79]
    s_add_u32 s60, s60, 524288
    buffer_load_dwordx4 v10, s[20:23], s63 offen lds
    v_mfma_f32_16x16x32_bf16 a[76:79], v[44:47], v[92:95], a[76:79]
    ds_read_b128 v[116:119], v25 offset:49152
    v_accvgpr_read_b32 v31, a245
    v_mfma_f32_16x16x32_bf16 a[128:131], v[40:43], a[136:139], a[128:131]
    ds_read_b64_tr_b16 v[40:41], v29 offset:32768
    ds_read_b64_tr_b16 v[42:43], v29 offset:33280
    v_mfma_f32_16x16x32_bf16 a[128:131], v[44:47], a[140:143], a[128:131]
    s_waitcnt lgkmcnt(3)
    ds_read_b64_tr_b16 v[44:45], v29 offset:36864
    ds_read_b64_tr_b16 v[46:47], v29 offset:37376
    v_mfma_f32_16x16x32_bf16 a[80:83], v[48:51], v[64:67], a[80:83]
    buffer_load_dwordx4 v11, s[20:23], s63 offen offset:1024 lds
    v_mfma_f32_16x16x32_bf16 a[80:83], v[52:55], v[68:71], a[80:83]
    ds_read_b128 v[120:123], v24 offset:57344
    v_add_u32 v29, 0x10000, v29
    v_mfma_f32_16x16x32_bf16 a[84:87], v[48:51], v[72:75], a[84:87]
    v_cvt_pk_bf16_f32 v34, v34, v31
    v_accvgpr_read_b32 v35, a246
    v_mfma_f32_16x16x32_bf16 a[84:87], v[52:55], v[76:79], a[84:87]
    v_accvgpr_read_b32 v31, a247
    v_cvt_pk_bf16_f32 v35, v35, v31
    v_mfma_f32_16x16x32_bf16 a[88:91], v[48:51], v[80:83], a[88:91]
    buffer_load_dwordx4 v12, s[20:23], s63 offen offset:2048 lds
    v_mfma_f32_16x16x32_bf16 a[88:91], v[52:55], v[84:87], a[88:91]
    ds_read_b128 v[124:127], v25 offset:57344
    v_accvgpr_read_b32 v36, a248
    v_mfma_f32_16x16x32_bf16 a[92:95], v[48:51], v[88:91], a[92:95]
    buffer_store_dwordx4 v[32:35], v1, s[36:39], s72 offen sc1
    v_mfma_f32_16x16x32_bf16 a[92:95], v[52:55], v[92:95], a[92:95]
    s_add_u32 s72, s71, 39936
    v_accvgpr_read_b32 v31, a249
    v_cvt_pk_bf16_f32 v36, v36, v31
    v_mfma_f32_16x16x32_bf16 a[132:135], v[48:51], a[136:139], a[132:135]
    s_add_u32 s71, s70, 16384
    buffer_load_dwordx4 v13, s[20:23], s63 offen offset:3072 lds
    v_mfma_f32_16x16x32_bf16 a[132:135], v[52:55], a[140:143], a[132:135]
    s_add_u32 s70, s70, s69
    v_accvgpr_read_b32 v37, a250
    v_accvgpr_read_b32 v31, a251
    v_mfma_f32_16x16x32_bf16 a[96:99], v[56:59], v[64:67], a[96:99]
    v_cvt_pk_bf16_f32 v37, v37, v31
    v_accvgpr_read_b32 v38, a252
    v_mfma_f32_16x16x32_bf16 a[96:99], v[60:63], v[68:71], a[96:99]
    s_add_u32 s63, s63, 128
    v_accvgpr_read_b32 v31, a253
    v_cvt_pk_bf16_f32 v38, v38, v31
    v_mfma_f32_16x16x32_bf16 a[100:103], v[56:59], v[72:75], a[100:103]
    v_accvgpr_read_b32 v39, a254
    v_accvgpr_read_b32 v31, a255
    v_mfma_f32_16x16x32_bf16 a[100:103], v[60:63], v[76:79], a[100:103]
    v_cvt_pk_bf16_f32 v39, v39, v31
    v_mov_b32 v31, 1
    v_mfma_f32_16x16x32_bf16 a[104:107], v[56:59], v[80:83], a[104:107]
    buffer_store_dwordx4 v[36:39], v1, s[36:39], s72 offen sc1
    v_mfma_f32_16x16x32_bf16 a[104:107], v[60:63], v[84:87], a[104:107]
    s_waitcnt vmcnt(22)
    s_barrier
    ds_read_b64_tr_b16 v[48:49], v14 offset:0
    v_mfma_f32_16x16x32_bf16 a[108:111], v[56:59], v[88:91], a[108:111]
    s_add_u32 m0, s67, 0
    ds_read_b64_tr_b16 v[50:51], v14 offset:1024
    ds_read_b64_tr_b16 v[52:53], v14 offset:8192
    v_mfma_f32_16x16x32_bf16 a[108:111], v[60:63], v[92:95], a[108:111]
    s_add_u32 s72, s7, 128
    buffer_load_dwordx4 v1, s[28:31], s65 offen sc1 lds
    s_waitcnt lgkmcnt(3)
    v_mfma_f32_16x16x32_bf16 a[112:115], v[40:43], v[64:67], a[112:115]
    s_mul_i32 s72, s72, 36
    ds_read_b64_tr_b16 v[54:55], v14 offset:9216
    ds_read_b64_tr_b16 v[56:57], v15 offset:0
    v_mfma_f32_16x16x32_bf16 a[112:115], v[44:47], v[68:71], a[112:115]
    s_add_u32 s72, s72, s3
    ds_read_b64_tr_b16 v[58:59], v15 offset:1024
    ds_read_b64_tr_b16 v[60:61], v15 offset:8192
    v_mfma_f32_16x16x32_bf16 a[116:119], v[40:43], v[72:75], a[116:119]
    s_lshl_b32 s3, s3, 5
    ds_read_b64_tr_b16 v[62:63], v15 offset:9216
    v_add_u32 v14, 0x10000, v14
    v_mfma_f32_16x16x32_bf16 a[116:119], v[44:47], v[76:79], a[116:119]
    s_lshl_b32 s72, s72, 10
    v_add_u32 v15, 0x10000, v15
    v_lshrrev_b32 v32, 7, v1
    v_mfma_f32_16x16x32_bf16 a[120:123], v[40:43], v[80:83], a[120:123]
    v_mul_u32_u24 v32, 1152, v32
    v_and_b32 v33, 0x70, v1
    v_mfma_f32_16x16x32_bf16 a[120:123], v[44:47], v[84:87], a[120:123]
    v_add3_u32 v32, v32, v33, s99
    v_bfe_u32 v33, v1, 6, 2
    v_mfma_f32_16x16x32_bf16 a[124:127], v[40:43], v[88:91], a[124:127]
    buffer_load_dwordx4 v1, s[28:31], s65 offen offset:1024 sc1 lds
    v_mfma_f32_16x16x32_bf16 a[124:127], v[44:47], v[92:95], a[124:127]
    s_waitcnt lgkmcnt(0)
    ds_read_b64_tr_b16 v[40:41], v16 offset:0
    ds_read_b64_tr_b16 v[42:43], v16 offset:1024
    v_mfma_f32_16x16x32_bf16 v[128:131], v[48:51], v[96:99], v[128:131]
    ds_read_b64_tr_b16 v[44:45], v16 offset:8192
    ds_read_b64_tr_b16 v[46:47], v16 offset:9216
    v_mfma_f32_16x16x32_bf16 v[128:131], v[52:55], v[100:103], v[128:131]
    v_add_u32 v24, 0x10000, v24
    v_add_u32 v16, 0x10000, v16
    v_mfma_f32_16x16x32_bf16 v[132:135], v[48:51], v[104:107], v[132:135]
    ds_read_b128 v[64:67], v24 offset:16384
    v_accvgpr_write_b32 a170, 0
    v_mfma_f32_16x16x32_bf16 v[132:135], v[52:55], v[108:111], v[132:135]
    s_cmp_eq_u32 s4, 0
    s_cselect_b32 s71, s71, s72
    v_accvgpr_write_b32 a171, 0
    v_mfma_f32_16x16x32_bf16 v[136:139], v[48:51], v[112:115], v[136:139]
    v_accvgpr_write_b32 a172, 0
    v_accvgpr_write_b32 a173, 0
    v_mfma_f32_16x16x32_bf16 v[136:139], v[52:55], v[116:119], v[136:139]
    v_accvgpr_write_b32 a174, 0
    v_accvgpr_write_b32 a175, 0
    v_mfma_f32_16x16x32_bf16 v[140:143], v[48:51], v[120:123], v[140:143]
    s_add_u32 m0, s68, 8192
    ds_read_b64_tr_b16 v[48:49], v17 offset:0
    ds_read_b64_tr_b16 v[50:51], v17 offset:1024
    v_mfma_f32_16x16x32_bf16 v[140:143], v[52:55], v[124:127], v[140:143]
    buffer_load_dwordx4 v6, s[20:23], s66 offen lds
    v_mfma_f32_16x16x32_bf16 v[144:147], v[56:59], v[96:99], v[144:147]
    ds_read_b64_tr_b16 v[52:53], v17 offset:8192
    ds_read_b64_tr_b16 v[54:55], v17 offset:9216
    v_mfma_f32_16x16x32_bf16 v[144:147], v[60:63], v[100:103], v[144:147]
    v_add_u32 v17, 0x10000, v17
    v_accvgpr_write_b32 a176, 0
    v_mfma_f32_16x16x32_bf16 v[148:151], v[56:59], v[104:107], v[148:151]
    v_accvgpr_write_b32 a177, 0
    v_accvgpr_write_b32 a178, 0
    v_mfma_f32_16x16x32_bf16 v[148:151], v[60:63], v[108:111], v[148:151]
    v_accvgpr_write_b32 a179, 0
    v_accvgpr_write_b32 a180, 0
    v_mfma_f32_16x16x32_bf16 v[152:155], v[56:59], v[112:115], v[152:155]
    v_add_u32 v25, 0x10000, v25
    v_accvgpr_write_b32 a181, 0
    v_mfma_f32_16x16x32_bf16 v[152:155], v[60:63], v[116:119], v[152:155]
    ds_read_b128 v[68:71], v25 offset:16384
    v_accvgpr_write_b32 a182, 0
    v_mfma_f32_16x16x32_bf16 v[156:159], v[56:59], v[120:123], v[156:159]
    s_add_u32 m0, s69, 16384
    ds_read_b64_tr_b16 v[56:57], v18 offset:0
    ds_read_b64_tr_b16 v[58:59], v18 offset:1024
    v_mfma_f32_16x16x32_bf16 v[156:159], v[60:63], v[124:127], v[156:159]
    s_add_u32 s65, s65, 8192
    buffer_load_dwordx4 v10, s[20:23], s64 offen lds
    s_waitcnt lgkmcnt(3)
    v_mfma_f32_16x16x32_bf16 v[160:163], v[40:43], v[96:99], v[160:163]
    s_add_u32 s66, s66, 128
    ds_read_b64_tr_b16 v[60:61], v18 offset:8192
    ds_read_b64_tr_b16 v[62:63], v18 offset:9216
    v_mfma_f32_16x16x32_bf16 v[160:163], v[44:47], v[100:103], v[160:163]
    v_add_u32 v18, 0x10000, v18
    v_accvgpr_write_b32 a183, 0
    v_mfma_f32_16x16x32_bf16 v[164:167], v[40:43], v[104:107], v[164:167]
    v_accvgpr_write_b32 a184, 0
    v_accvgpr_write_b32 a185, 0
    v_mfma_f32_16x16x32_bf16 v[164:167], v[44:47], v[108:111], v[164:167]
    v_accvgpr_write_b32 a186, 0
    v_accvgpr_write_b32 a187, 0
    v_mfma_f32_16x16x32_bf16 v[168:171], v[40:43], v[112:115], v[168:171]
    v_accvgpr_write_b32 a188, 0
    v_accvgpr_write_b32 a189, 0
    v_mfma_f32_16x16x32_bf16 v[168:171], v[44:47], v[116:119], v[168:171]
    v_accvgpr_write_b32 a190, 0
    v_accvgpr_write_b32 a191, 0
    v_mfma_f32_16x16x32_bf16 v[172:175], v[40:43], v[120:123], v[172:175]
    ds_read_b64_tr_b16 v[40:41], v19 offset:0
    ds_read_b64_tr_b16 v[42:43], v19 offset:1024
    v_mfma_f32_16x16x32_bf16 v[172:175], v[44:47], v[124:127], v[172:175]
    ds_read_b64_tr_b16 v[44:45], v19 offset:8192
    ds_read_b64_tr_b16 v[46:47], v19 offset:9216
    v_mfma_f32_16x16x32_bf16 v[176:179], v[48:51], v[96:99], v[176:179]
    buffer_load_dwordx4 v11, s[20:23], s64 offen offset:1024 lds
    v_mfma_f32_16x16x32_bf16 v[176:179], v[52:55], v[100:103], v[176:179]
    ds_read_b128 v[72:75], v24 offset:24576
    v_add_u32 v19, 0x10000, v19
    v_mfma_f32_16x16x32_bf16 v[180:183], v[48:51], v[104:107], v[180:183]
    v_accvgpr_write_b32 a192, 0
    v_accvgpr_write_b32 a193, 0
    v_mfma_f32_16x16x32_bf16 v[180:183], v[52:55], v[108:111], v[180:183]
    v_accvgpr_write_b32 a194, 0
    v_accvgpr_write_b32 a195, 0
    v_mfma_f32_16x16x32_bf16 v[184:187], v[48:51], v[112:115], v[184:187]
    v_accvgpr_write_b32 a196, 0
    v_accvgpr_write_b32 a197, 0
    v_mfma_f32_16x16x32_bf16 v[184:187], v[52:55], v[116:119], v[184:187]
    v_accvgpr_write_b32 a198, 0
    v_accvgpr_write_b32 a199, 0
    v_mfma_f32_16x16x32_bf16 v[188:191], v[48:51], v[120:123], v[188:191]
    ds_read_b64_tr_b16 v[48:49], v20 offset:0
    ds_read_b64_tr_b16 v[50:51], v20 offset:1024
    v_mfma_f32_16x16x32_bf16 v[188:191], v[52:55], v[124:127], v[188:191]
    s_waitcnt lgkmcnt(2)
    ds_read_b64_tr_b16 v[52:53], v20 offset:8192
    ds_read_b64_tr_b16 v[54:55], v20 offset:9216
    v_mfma_f32_16x16x32_bf16 v[192:195], v[56:59], v[96:99], v[192:195]
    buffer_load_dwordx4 v12, s[20:23], s64 offen offset:2048 lds
    v_mfma_f32_16x16x32_bf16 v[192:195], v[60:63], v[100:103], v[192:195]
    v_add_u32 v20, 0x10000, v20
    v_accvgpr_write_b32 a200, 0
    v_mfma_f32_16x16x32_bf16 v[196:199], v[56:59], v[104:107], v[196:199]
    v_accvgpr_write_b32 a201, 0
    v_accvgpr_write_b32 a202, 0
    v_mfma_f32_16x16x32_bf16 v[196:199], v[60:63], v[108:111], v[196:199]
    ds_read_b128 v[76:79], v25 offset:24576
    v_accvgpr_write_b32 a203, 0
    v_mfma_f32_16x16x32_bf16 v[200:203], v[56:59], v[112:115], v[200:203]
    v_accvgpr_write_b32 a204, 0
    v_accvgpr_write_b32 a205, 0
    v_mfma_f32_16x16x32_bf16 v[200:203], v[60:63], v[116:119], v[200:203]
    v_accvgpr_write_b32 a206, 0
    v_accvgpr_write_b32 a207, 0
    v_mfma_f32_16x16x32_bf16 v[204:207], v[56:59], v[120:123], v[204:207]
    ds_read_b64_tr_b16 v[56:57], v21 offset:0
    ds_read_b64_tr_b16 v[58:59], v21 offset:1024
    v_mfma_f32_16x16x32_bf16 v[204:207], v[60:63], v[124:127], v[204:207]
    ds_read_b64_tr_b16 v[60:61], v21 offset:8192
    ds_read_b64_tr_b16 v[62:63], v21 offset:9216
    v_mfma_f32_16x16x32_bf16 v[208:211], v[40:43], v[96:99], v[208:211]
    v_add_u32 v21, 0x10000, v21
    v_accvgpr_write_b32 a208, 0
    v_mfma_f32_16x16x32_bf16 v[208:211], v[44:47], v[100:103], v[208:211]
    buffer_load_dwordx4 v13, s[20:23], s64 offen offset:3072 lds
    v_mfma_f32_16x16x32_bf16 v[212:215], v[40:43], v[104:107], v[212:215]
    v_accvgpr_write_b32 a209, 0
    v_accvgpr_write_b32 a210, 0
    v_mfma_f32_16x16x32_bf16 v[212:215], v[44:47], v[108:111], v[212:215]
    v_accvgpr_write_b32 a211, 0
    v_accvgpr_write_b32 a212, 0
    v_mfma_f32_16x16x32_bf16 v[216:219], v[40:43], v[112:115], v[216:219]
    v_accvgpr_write_b32 a213, 0
    v_accvgpr_write_b32 a214, 0
    v_mfma_f32_16x16x32_bf16 v[216:219], v[44:47], v[116:119], v[216:219]
    v_accvgpr_write_b32 a215, 0
    v_accvgpr_write_b32 a216, 0
    v_mfma_f32_16x16x32_bf16 v[220:223], v[40:43], v[120:123], v[220:223]
    v_accvgpr_write_b32 a217, 0
    v_accvgpr_write_b32 a218, 0
    v_mfma_f32_16x16x32_bf16 v[220:223], v[44:47], v[124:127], v[220:223]
    s_waitcnt lgkmcnt(0)
    v_accvgpr_write_b32 a219, 0
    v_accvgpr_write_b32 a220, 0
    v_mfma_f32_16x16x32_bf16 v[224:227], v[48:51], v[96:99], v[224:227]
    v_accvgpr_write_b32 a221, 0
    v_accvgpr_write_b32 a222, 0
    v_mfma_f32_16x16x32_bf16 v[224:227], v[52:55], v[100:103], v[224:227]
    s_add_u32 s64, s64, 128
    v_accvgpr_write_b32 a223, 0
    v_mfma_f32_16x16x32_bf16 v[228:231], v[48:51], v[104:107], v[228:231]
    v_mfma_f32_16x16x32_bf16 v[228:231], v[52:55], v[108:111], v[228:231]
    v_mfma_f32_16x16x32_bf16 v[232:235], v[48:51], v[112:115], v[232:235]
    v_mfma_f32_16x16x32_bf16 v[232:235], v[52:55], v[116:119], v[232:235]
    s_waitcnt vmcnt(18)
    s_barrier
    ds_read_b64_tr_b16 v[40:41], v26 offset:32768
    v_mfma_f32_16x16x32_bf16 v[236:239], v[48:51], v[120:123], v[236:239]
    s_add_u32 m0, s69, 32768
    ds_read_b64_tr_b16 v[42:43], v26 offset:33280
    ds_read_b64_tr_b16 v[44:45], v26 offset:36864
    v_mfma_f32_16x16x32_bf16 v[236:239], v[52:55], v[124:127], v[236:239]
    buffer_load_dwordx4 v2, s[24:27], s60 offen lds
    v_mfma_f32_16x16x32_bf16 v[240:243], v[56:59], v[96:99], v[240:243]
    ds_read_b64_tr_b16 v[46:47], v26 offset:37376
    ds_read_b128 a[136:139], v22 offset:32768
    v_mfma_f32_16x16x32_bf16 v[240:243], v[60:63], v[100:103], v[240:243]
    ds_read_b128 a[140:143], v23 offset:32768
    ds_read_b64_tr_b16 v[48:49], v27 offset:32768
    v_mfma_f32_16x16x32_bf16 v[244:247], v[56:59], v[104:107], v[244:247]
    buffer_load_dwordx4 v3, s[24:27], s60 offen offset:1024 lds
    v_mfma_f32_16x16x32_bf16 v[244:247], v[60:63], v[108:111], v[244:247]
    ds_read_b64_tr_b16 v[50:51], v27 offset:33280
    ds_read_b64_tr_b16 v[52:53], v27 offset:36864
    v_mfma_f32_16x16x32_bf16 v[248:251], v[56:59], v[112:115], v[248:251]
    ds_read_b64_tr_b16 v[54:55], v27 offset:37376
    v_add_u32 v26, 0xffff0000, v26
    v_mfma_f32_16x16x32_bf16 v[248:251], v[60:63], v[116:119], v[248:251]
    v_add_u32 v22, 0xffff0000, v22
    v_add_u32 v23, 0xffff0000, v23
    v_mfma_f32_16x16x32_bf16 v[252:255], v[56:59], v[120:123], v[252:255]
    buffer_load_dwordx4 v4, s[24:27], s60 offen offset:2048 lds
    v_mfma_f32_16x16x32_bf16 v[252:255], v[60:63], v[124:127], v[252:255]
    s_waitcnt lgkmcnt(3)
    ds_read_b64_tr_b16 v[56:57], v28 offset:32768
    ds_read_b64_tr_b16 v[58:59], v28 offset:33280
    v_mfma_f32_16x16x32_bf16 a[64:67], v[40:43], v[96:99], a[64:67]
    ds_read_b64_tr_b16 v[60:61], v28 offset:36864
    ds_read_b64_tr_b16 v[62:63], v28 offset:37376
    v_mfma_f32_16x16x32_bf16 a[64:67], v[44:47], v[100:103], a[64:67]
    v_add_u32 v27, 0xffff0000, v27
    v_add_u32 v28, 0xffff0000, v28
    v_mfma_f32_16x16x32_bf16 a[68:71], v[40:43], v[104:107], a[68:71]
    buffer_load_dwordx4 v5, s[24:27], s60 offen offset:3072 lds
    v_mfma_f32_16x16x32_bf16 a[68:71], v[44:47], v[108:111], a[68:71]
    ds_read_b128 v[80:83], v24 offset:49152
    v_mfma_f32_16x16x32_bf16 a[72:75], v[40:43], v[112:115], a[72:75]
    v_mfma_f32_16x16x32_bf16 a[72:75], v[44:47], v[116:119], a[72:75]
    s_add_u32 m0, s69, 49152
    v_mfma_f32_16x16x32_bf16 a[76:79], v[40:43], v[120:123], a[76:79]
    s_add_u32 s60, s60, 524288
    buffer_load_dwordx4 v10, s[20:23], s63 offen lds
    v_mfma_f32_16x16x32_bf16 a[76:79], v[44:47], v[124:127], a[76:79]
    ds_read_b128 v[84:87], v25 offset:49152
    v_mfma_f32_16x16x32_bf16 a[128:131], v[40:43], a[136:139], a[128:131]
    ds_read_b64_tr_b16 v[40:41], v29 offset:32768
    ds_read_b64_tr_b16 v[42:43], v29 offset:33280
    v_mfma_f32_16x16x32_bf16 a[128:131], v[44:47], a[140:143], a[128:131]
    s_waitcnt lgkmcnt(3)
    ds_read_b64_tr_b16 v[44:45], v29 offset:36864
    ds_read_b64_tr_b16 v[46:47], v29 offset:37376
    v_mfma_f32_16x16x32_bf16 a[80:83], v[48:51], v[96:99], a[80:83]
    buffer_load_dwordx4 v11, s[20:23], s63 offen offset:1024 lds
    v_mfma_f32_16x16x32_bf16 a[80:83], v[52:55], v[100:103], a[80:83]
    ds_read_b128 v[88:91], v24 offset:57344
    v_add_u32 v29, 0xffff0000, v29
    v_mfma_f32_16x16x32_bf16 a[84:87], v[48:51], v[104:107], a[84:87]
    v_mfma_f32_16x16x32_bf16 a[84:87], v[52:55], v[108:111], a[84:87]
    v_mfma_f32_16x16x32_bf16 a[88:91], v[48:51], v[112:115], a[88:91]
    buffer_load_dwordx4 v12, s[20:23], s63 offen offset:2048 lds
    v_mfma_f32_16x16x32_bf16 a[88:91], v[52:55], v[116:119], a[88:91]
    ds_read_b128 v[92:95], v25 offset:57344
    v_mfma_f32_16x16x32_bf16 a[92:95], v[48:51], v[120:123], a[92:95]
    v_mfma_f32_16x16x32_bf16 a[92:95], v[52:55], v[124:127], a[92:95]
    v_mfma_f32_16x16x32_bf16 a[132:135], v[48:51], a[136:139], a[132:135]
    buffer_load_dwordx4 v13, s[20:23], s63 offen offset:3072 lds
    v_mfma_f32_16x16x32_bf16 a[132:135], v[52:55], a[140:143], a[132:135]
    v_mfma_f32_16x16x32_bf16 a[96:99], v[56:59], v[96:99], a[96:99]
    v_mfma_f32_16x16x32_bf16 a[96:99], v[60:63], v[100:103], a[96:99]
    s_add_u32 s63, s63, 128
    v_mfma_f32_16x16x32_bf16 a[100:103], v[56:59], v[104:107], a[100:103]
    v_mfma_f32_16x16x32_bf16 a[100:103], v[60:63], v[108:111], a[100:103]
    v_mfma_f32_16x16x32_bf16 a[104:107], v[56:59], v[112:115], a[104:107]
    v_mfma_f32_16x16x32_bf16 a[104:107], v[60:63], v[116:119], a[104:107]
    s_waitcnt vmcnt(16)
    s_barrier
    ds_read_b64_tr_b16 v[48:49], v14 offset:0
    v_mfma_f32_16x16x32_bf16 a[108:111], v[56:59], v[120:123], a[108:111]
    s_add_u32 m0, s67, 65536
    ds_read_b64_tr_b16 v[50:51], v14 offset:1024
    ds_read_b64_tr_b16 v[52:53], v14 offset:8192
    v_mfma_f32_16x16x32_bf16 a[108:111], v[60:63], v[124:127], a[108:111]
    s_waitcnt lgkmcnt(3)
    buffer_load_dwordx4 v1, s[28:31], s65 offen sc1 lds
    v_mfma_f32_16x16x32_bf16 a[112:115], v[40:43], v[96:99], a[112:115]
    ds_read_b64_tr_b16 v[54:55], v14 offset:9216
    ds_read_b64_tr_b16 v[56:57], v15 offset:0
    v_mfma_f32_16x16x32_bf16 a[112:115], v[44:47], v[100:103], a[112:115]
    ds_read_b64_tr_b16 v[58:59], v15 offset:1024
    ds_read_b64_tr_b16 v[60:61], v15 offset:8192
    v_mfma_f32_16x16x32_bf16 a[116:119], v[40:43], v[104:107], a[116:119]
    ds_read_b64_tr_b16 v[62:63], v15 offset:9216
    v_add_u32 v14, 0xfffe0000, v14
    v_mfma_f32_16x16x32_bf16 a[116:119], v[44:47], v[108:111], a[116:119]
    v_add_u32 v15, 0xfffe0000, v15
    v_mfma_f32_16x16x32_bf16 a[120:123], v[40:43], v[112:115], a[120:123]
    v_mfma_f32_16x16x32_bf16 a[120:123], v[44:47], v[116:119], a[120:123]
    v_mfma_f32_16x16x32_bf16 a[124:127], v[40:43], v[120:123], a[124:127]
    buffer_load_dwordx4 v1, s[28:31], s65 offen offset:1024 sc1 lds
    v_mfma_f32_16x16x32_bf16 a[124:127], v[44:47], v[124:127], a[124:127]
    s_waitcnt lgkmcnt(0)
    ds_read_b64_tr_b16 v[40:41], v16 offset:0
    ds_read_b64_tr_b16 v[42:43], v16 offset:1024
    v_mfma_f32_16x16x32_bf16 v[128:131], v[48:51], v[64:67], v[128:131]
    ds_read_b64_tr_b16 v[44:45], v16 offset:8192
    ds_read_b64_tr_b16 v[46:47], v16 offset:9216
    v_mfma_f32_16x16x32_bf16 v[128:131], v[52:55], v[68:71], v[128:131]
    v_add_u32 v24, 0x10000, v24
    v_add_u32 v16, 0xfffe0000, v16
    v_mfma_f32_16x16x32_bf16 v[132:135], v[48:51], v[72:75], v[132:135]
    ds_read_b128 v[96:99], v24 offset:16384
    v_mfma_f32_16x16x32_bf16 v[132:135], v[52:55], v[76:79], v[132:135]
    v_mfma_f32_16x16x32_bf16 v[136:139], v[48:51], v[80:83], v[136:139]
    v_mfma_f32_16x16x32_bf16 v[136:139], v[52:55], v[84:87], v[136:139]
    v_mfma_f32_16x16x32_bf16 v[140:143], v[48:51], v[88:91], v[140:143]
    s_add_u32 m0, s68, 73728
    ds_read_b64_tr_b16 v[48:49], v17 offset:0
    ds_read_b64_tr_b16 v[50:51], v17 offset:1024
    v_mfma_f32_16x16x32_bf16 v[140:143], v[52:55], v[92:95], v[140:143]
    buffer_load_dwordx4 v6, s[20:23], s66 offen lds
    v_mfma_f32_16x16x32_bf16 v[144:147], v[56:59], v[64:67], v[144:147]
    ds_read_b64_tr_b16 v[52:53], v17 offset:8192
    ds_read_b64_tr_b16 v[54:55], v17 offset:9216
    v_mfma_f32_16x16x32_bf16 v[144:147], v[60:63], v[68:71], v[144:147]
    v_add_u32 v17, 0xfffe0000, v17
    v_mfma_f32_16x16x32_bf16 v[148:151], v[56:59], v[72:75], v[148:151]
    v_mfma_f32_16x16x32_bf16 v[148:151], v[60:63], v[76:79], v[148:151]
    v_mfma_f32_16x16x32_bf16 v[152:155], v[56:59], v[80:83], v[152:155]
    v_add_u32 v25, 0x10000, v25
    v_mfma_f32_16x16x32_bf16 v[152:155], v[60:63], v[84:87], v[152:155]
    ds_read_b128 v[100:103], v25 offset:16384
    v_mfma_f32_16x16x32_bf16 v[156:159], v[56:59], v[88:91], v[156:159]
    s_add_u32 m0, s69, 81920
    ds_read_b64_tr_b16 v[56:57], v18 offset:0
    ds_read_b64_tr_b16 v[58:59], v18 offset:1024
    v_mfma_f32_16x16x32_bf16 v[156:159], v[60:63], v[92:95], v[156:159]
    s_add_u32 s65, s65, 8192
    buffer_load_dwordx4 v10, s[20:23], s64 offen lds
    s_waitcnt lgkmcnt(3)
    v_mfma_f32_16x16x32_bf16 v[160:163], v[40:43], v[64:67], v[160:163]
    s_add_u32 s66, s66, 128
    ds_read_b64_tr_b16 v[60:61], v18 offset:8192
    ds_read_b64_tr_b16 v[62:63], v18 offset:9216
    v_mfma_f32_16x16x32_bf16 v[160:163], v[44:47], v[68:71], v[160:163]
    v_add_u32 v18, 0xfffe0000, v18
    v_add_u32 v10, 0, v32
    v_mfma_f32_16x16x32_bf16 v[164:167], v[40:43], v[72:75], v[164:167]
    v_mfma_f32_16x16x32_bf16 v[164:167], v[44:47], v[76:79], v[164:167]
    v_mfma_f32_16x16x32_bf16 v[168:171], v[40:43], v[80:83], v[168:171]
    v_mfma_f32_16x16x32_bf16 v[168:171], v[44:47], v[84:87], v[168:171]
    v_mfma_f32_16x16x32_bf16 v[172:175], v[40:43], v[88:91], v[172:175]
    ds_read_b64_tr_b16 v[40:41], v19 offset:0
    ds_read_b64_tr_b16 v[42:43], v19 offset:1024
    v_mfma_f32_16x16x32_bf16 v[172:175], v[44:47], v[92:95], v[172:175]
    ds_read_b64_tr_b16 v[44:45], v19 offset:8192
    ds_read_b64_tr_b16 v[46:47], v19 offset:9216
    v_mfma_f32_16x16x32_bf16 v[176:179], v[48:51], v[64:67], v[176:179]
    buffer_load_dwordx4 v11, s[20:23], s64 offen offset:1024 lds
    v_mfma_f32_16x16x32_bf16 v[176:179], v[52:55], v[68:71], v[176:179]
    ds_read_b128 v[104:107], v24 offset:24576
    v_add_u32 v19, 0xfffe0000, v19
    v_mfma_f32_16x16x32_bf16 v[180:183], v[48:51], v[72:75], v[180:183]
    v_add_u32 v11, 8192, v32
    v_mfma_f32_16x16x32_bf16 v[180:183], v[52:55], v[76:79], v[180:183]
    v_mfma_f32_16x16x32_bf16 v[184:187], v[48:51], v[80:83], v[184:187]
    v_mfma_f32_16x16x32_bf16 v[184:187], v[52:55], v[84:87], v[184:187]
    v_mfma_f32_16x16x32_bf16 v[188:191], v[48:51], v[88:91], v[188:191]
    ds_read_b64_tr_b16 v[48:49], v20 offset:0
    ds_read_b64_tr_b16 v[50:51], v20 offset:1024
    v_mfma_f32_16x16x32_bf16 v[188:191], v[52:55], v[92:95], v[188:191]
    s_waitcnt lgkmcnt(2)
    ds_read_b64_tr_b16 v[52:53], v20 offset:8192
    ds_read_b64_tr_b16 v[54:55], v20 offset:9216
    v_mfma_f32_16x16x32_bf16 v[192:195], v[56:59], v[64:67], v[192:195]
    buffer_load_dwordx4 v12, s[20:23], s64 offen offset:2048 lds
    v_mfma_f32_16x16x32_bf16 v[192:195], v[60:63], v[68:71], v[192:195]
    v_add_u32 v20, 0xfffe0000, v20
    v_add_u32 v12, 16384, v32
    v_mfma_f32_16x16x32_bf16 v[196:199], v[56:59], v[72:75], v[196:199]
    v_mfma_f32_16x16x32_bf16 v[196:199], v[60:63], v[76:79], v[196:199]
    ds_read_b128 v[108:111], v25 offset:24576
    v_mfma_f32_16x16x32_bf16 v[200:203], v[56:59], v[80:83], v[200:203]
    v_mfma_f32_16x16x32_bf16 v[200:203], v[60:63], v[84:87], v[200:203]
    v_mfma_f32_16x16x32_bf16 v[204:207], v[56:59], v[88:91], v[204:207]
    ds_read_b64_tr_b16 v[56:57], v21 offset:0
    ds_read_b64_tr_b16 v[58:59], v21 offset:1024
    v_mfma_f32_16x16x32_bf16 v[204:207], v[60:63], v[92:95], v[204:207]
    ds_read_b64_tr_b16 v[60:61], v21 offset:8192
    ds_read_b64_tr_b16 v[62:63], v21 offset:9216
    v_mfma_f32_16x16x32_bf16 v[208:211], v[40:43], v[64:67], v[208:211]
    v_add_u32 v21, 0xfffe0000, v21
    v_mfma_f32_16x16x32_bf16 v[208:211], v[44:47], v[68:71], v[208:211]
    buffer_load_dwordx4 v13, s[20:23], s64 offen offset:3072 lds
    v_mfma_f32_16x16x32_bf16 v[212:215], v[40:43], v[72:75], v[212:215]
    v_add_u32 v13, 24576, v32
    v_lshrrev_b32 v32, 8, v1
    v_mfma_f32_16x16x32_bf16 v[212:215], v[44:47], v[76:79], v[212:215]
    v_lshl_add_u32 v32, s7, 2, v32
    v_lshrrev_b32 v34, 1, v32
    v_mfma_f32_16x16x32_bf16 v[216:219], v[40:43], v[80:83], v[216:219]
    s_sub_u32 s7, 33, s6
    v_mul_u32_u24 v34, 18, v34
    v_and_b32 v35, 1, v32
    v_mfma_f32_16x16x32_bf16 v[216:219], v[44:47], v[84:87], v[216:219]
    s_sub_u32 s7, s7, s6
    v_lshl_add_u32 v34, v35, 3, v34
    v_lshrrev_b32 v35, 1, v33
    v_mfma_f32_16x16x32_bf16 v[220:223], v[40:43], v[88:91], v[220:223]
    v_lshl_add_u32 v35, v32, 2, v35
    v_add_u32 v35, 0xffffff00, v35
    v_mfma_f32_16x16x32_bf16 v[220:223], v[44:47], v[92:95], v[220:223]
    s_waitcnt lgkmcnt(0)
    v_mul_u32_u24 v35, 18, v35
    v_add3_u32 v34, v34, v33, 0
    v_mfma_f32_16x16x32_bf16 v[224:227], v[48:51], v[64:67], v[224:227]
    v_cmp_gt_u32 vcc, 64, v32
    v_mfma_f32_16x16x32_bf16 v[224:227], v[52:55], v[68:71], v[224:227]
    s_add_u32 s64, s64, 128
    v_mfma_f32_16x16x32_bf16 v[228:231], v[48:51], v[72:75], v[228:231]
    v_mfma_f32_16x16x32_bf16 v[228:231], v[52:55], v[76:79], v[228:231]
    v_mfma_f32_16x16x32_bf16 v[232:235], v[48:51], v[80:83], v[232:235]
    v_mfma_f32_16x16x32_bf16 v[232:235], v[52:55], v[84:87], v[232:235]
    s_waitcnt vmcnt(15)
    s_barrier
    ds_read_b64_tr_b16 v[40:41], v26 offset:0
    v_mfma_f32_16x16x32_bf16 v[236:239], v[48:51], v[88:91], v[236:239]
    s_add_u32 m0, s69, 98304
    ds_read_b64_tr_b16 v[42:43], v26 offset:512
    ds_read_b64_tr_b16 v[44:45], v26 offset:4096
    v_mfma_f32_16x16x32_bf16 v[236:239], v[52:55], v[92:95], v[236:239]
    buffer_load_dwordx4 v2, s[24:27], s60 offen lds
    v_mfma_f32_16x16x32_bf16 v[240:243], v[56:59], v[64:67], v[240:243]
    ds_read_b64_tr_b16 v[46:47], v26 offset:4608
    ds_read_b128 a[136:139], v22 offset:0
    v_mfma_f32_16x16x32_bf16 v[240:243], v[60:63], v[68:71], v[240:243]
    buffer_store_dword v31, v30, s[32:35], s101 offen sc1
    v_mfma_f32_16x16x32_bf16 v[244:247], v[56:59], v[72:75], v[244:247]
    buffer_load_dwordx4 v3, s[24:27], s60 offen offset:1024 lds
    v_mfma_f32_16x16x32_bf16 v[244:247], v[60:63], v[76:79], v[244:247]
    ds_read_b128 a[140:143], v23 offset:0
    ds_read_b64_tr_b16 v[48:49], v27 offset:0
    v_mfma_f32_16x16x32_bf16 v[248:251], v[56:59], v[80:83], v[248:251]
    ds_read_b64_tr_b16 v[50:51], v27 offset:512
    ds_read_b64_tr_b16 v[52:53], v27 offset:4096
    v_mfma_f32_16x16x32_bf16 v[248:251], v[60:63], v[84:87], v[248:251]
    ds_read_b64_tr_b16 v[54:55], v27 offset:4608
    v_add_u32 v26, 0x10000, v26
    v_mfma_f32_16x16x32_bf16 v[252:255], v[56:59], v[88:91], v[252:255]
    buffer_load_dwordx4 v4, s[24:27], s60 offen offset:2048 lds
    v_mfma_f32_16x16x32_bf16 v[252:255], v[60:63], v[92:95], v[252:255]
    s_waitcnt lgkmcnt(5)
    ds_read_b64_tr_b16 v[56:57], v28 offset:0
    ds_read_b64_tr_b16 v[58:59], v28 offset:512
    v_mfma_f32_16x16x32_bf16 a[64:67], v[40:43], v[64:67], a[64:67]
    ds_read_b64_tr_b16 v[60:61], v28 offset:4096
    ds_read_b64_tr_b16 v[62:63], v28 offset:4608
    v_mfma_f32_16x16x32_bf16 a[64:67], v[44:47], v[68:71], a[64:67]
    v_add_u32 v24, 0xfffe0000, v24
    v_add_u32 v22, 0x10000, v22
    v_mfma_f32_16x16x32_bf16 a[68:71], v[40:43], v[72:75], a[68:71]
    buffer_load_dwordx4 v5, s[24:27], s60 offen offset:3072 lds
    v_mfma_f32_16x16x32_bf16 a[68:71], v[44:47], v[76:79], a[68:71]
    ds_read_b128 v[112:115], v24 offset:16384
    v_add_u32 v23, 0x10000, v23
    v_mfma_f32_16x16x32_bf16 a[72:75], v[40:43], v[80:83], a[72:75]
    v_add_u32 v27, 0x10000, v27
    v_add_u32 v28, 0x10000, v28
    v_mfma_f32_16x16x32_bf16 a[72:75], v[44:47], v[84:87], a[72:75]
    s_add_u32 m0, s69, 114688
    v_add_u32 v25, 0xfffe0000, v25
    v_and_b32 v2, 1, v33
    v_mfma_f32_16x16x32_bf16 a[76:79], v[40:43], v[88:91], a[76:79]
    s_add_u32 s60, s60, 524288
    buffer_load_dwordx4 v10, s[48:51], 0 offen nt lds
    v_mfma_f32_16x16x32_bf16 a[76:79], v[44:47], v[92:95], a[76:79]
    ds_read_b128 v[116:119], v25 offset:16384
    v_add3_u32 v35, v35, v2, 16
    v_mfma_f32_16x16x32_bf16 a[128:131], v[40:43], a[136:139], a[128:131]
    s_waitcnt lgkmcnt(1)
    ds_read_b64_tr_b16 v[40:41], v29 offset:0
    ds_read_b64_tr_b16 v[42:43], v29 offset:512
    v_mfma_f32_16x16x32_bf16 a[128:131], v[44:47], a[140:143], a[128:131]
    ds_read_b64_tr_b16 v[44:45], v29 offset:4096
    ds_read_b64_tr_b16 v[46:47], v29 offset:4608
    v_mfma_f32_16x16x32_bf16 a[80:83], v[48:51], v[64:67], a[80:83]
    buffer_load_dwordx4 v11, s[48:51], 0 offen offset:1024 nt lds
    v_mfma_f32_16x16x32_bf16 a[80:83], v[52:55], v[68:71], a[80:83]
    ds_read_b128 v[120:123], v24 offset:24576
    v_add_u32 v29, 0x10000, v29
    v_mfma_f32_16x16x32_bf16 a[84:87], v[48:51], v[72:75], a[84:87]
    v_cndmask_b32 v34, v35, v34, vcc
    v_lshrrev_b32 v35, 6, v1
    v_mfma_f32_16x16x32_bf16 a[84:87], v[52:55], v[76:79], a[84:87]
    v_mul_u32_u24 v35, 1152, v35
    v_mul_u32_u24 v34, 1152, v34
    v_mfma_f32_16x16x32_bf16 a[88:91], v[48:51], v[80:83], a[88:91]
    buffer_load_dwordx4 v12, s[48:51], 0 offen offset:2048 nt lds
    v_mfma_f32_16x16x32_bf16 a[88:91], v[52:55], v[84:87], a[88:91]
    ds_read_b128 v[124:127], v25 offset:24576
    v_add_u32 v35, s98, v35
    v_mfma_f32_16x16x32_bf16 a[92:95], v[48:51], v[88:91], a[92:95]
    v_add_u32 v34, s3, v34
    v_add_u32 v35, 512, v35
    v_mfma_f32_16x16x32_bf16 a[92:95], v[52:55], v[92:95], a[92:95]
    s_cmp_eq_u32 s4, 0
    s_cselect_b64 vcc, -1, 0
    v_cndmask_b32 v34, v34, v35, vcc
    v_mfma_f32_16x16x32_bf16 a[132:135], v[48:51], a[136:139], a[132:135]
    buffer_load_dwordx4 v13, s[48:51], 0 offen offset:3072 nt lds
    v_mfma_f32_16x16x32_bf16 a[132:135], v[52:55], a[140:143], a[132:135]
    v_and_b32 v35, 0x30, v1
    v_add_u32 v2, v34, v35
    v_mfma_f32_16x16x32_bf16 a[96:99], v[56:59], v[64:67], a[96:99]
    v_lshrrev_b32 v34, 1, v32
    v_mul_u32_u24 v34, 18, v34
    v_mfma_f32_16x16x32_bf16 a[96:99], v[60:63], v[68:71], a[96:99]
    v_and_b32 v35, 1, v32
    v_lshl_add_u32 v34, v35, 3, v34
    v_mfma_f32_16x16x32_bf16 a[100:103], v[56:59], v[72:75], a[100:103]
    v_lshrrev_b32 v35, 1, v33
    v_lshl_add_u32 v35, v32, 2, v35
    v_mfma_f32_16x16x32_bf16 a[100:103], v[60:63], v[76:79], a[100:103]
    v_add_u32 v35, 0xffffff02, v35
    v_mul_u32_u24 v35, 18, v35
    v_mfma_f32_16x16x32_bf16 a[104:107], v[56:59], v[80:83], a[104:107]
    v_and_b32 v3, 1, v33
    v_add3_u32 v34, v34, v33, 4
    v_mfma_f32_16x16x32_bf16 a[104:107], v[60:63], v[84:87], a[104:107]
    s_waitcnt vmcnt(16)
    s_barrier
    ds_read_b64_tr_b16 v[48:49], v14 offset:32768
    v_mfma_f32_16x16x32_bf16 a[108:111], v[56:59], v[88:91], a[108:111]
    s_add_u32 m0, s67, 131072
    ds_read_b64_tr_b16 v[50:51], v14 offset:33792
    ds_read_b64_tr_b16 v[52:53], v14 offset:40960
    v_mfma_f32_16x16x32_bf16 a[108:111], v[60:63], v[92:95], a[108:111]
    s_waitcnt lgkmcnt(3)
    buffer_load_dwordx4 v1, s[28:31], s65 offen sc1 lds
    v_mfma_f32_16x16x32_bf16 a[112:115], v[40:43], v[64:67], a[112:115]
    ds_read_b64_tr_b16 v[54:55], v14 offset:41984
    ds_read_b64_tr_b16 v[56:57], v15 offset:32768
    v_mfma_f32_16x16x32_bf16 a[112:115], v[44:47], v[68:71], a[112:115]
    ds_read_b64_tr_b16 v[58:59], v15 offset:33792
    ds_read_b64_tr_b16 v[60:61], v15 offset:40960
    v_mfma_f32_16x16x32_bf16 a[116:119], v[40:43], v[72:75], a[116:119]
    ds_read_b64_tr_b16 v[62:63], v15 offset:41984
    v_add_u32 v14, 0x10000, v14
    v_mfma_f32_16x16x32_bf16 a[116:119], v[44:47], v[76:79], a[116:119]
    v_add_u32 v15, 0x10000, v15
    v_add3_u32 v35, v35, v3, 16
    v_mfma_f32_16x16x32_bf16 a[120:123], v[40:43], v[80:83], a[120:123]
    v_cmp_gt_u32 vcc, 64, v32
    v_bfe_u32 v33, v1, 4, 2
    v_mfma_f32_16x16x32_bf16 a[120:123], v[44:47], v[84:87], a[120:123]
    v_cndmask_b32 v34, v35, v34, vcc
    v_lshrrev_b32 v35, 6, v1
    v_mfma_f32_16x16x32_bf16 a[124:127], v[40:43], v[88:91], a[124:127]
    ds_read_b64_tr_b16 v[40:41], v16 offset:32768
    ds_read_b64_tr_b16 v[42:43], v16 offset:33792
    v_mfma_f32_16x16x32_bf16 a[124:127], v[44:47], v[92:95], a[124:127]
    s_waitcnt lgkmcnt(2)
    ds_read_b64_tr_b16 v[44:45], v16 offset:40960
    ds_read_b64_tr_b16 v[46:47], v16 offset:41984
    v_mfma_f32_16x16x32_bf16 v[128:131], v[48:51], v[96:99], v[128:131]
    v_add_u32 v16, 0x10000, v16
    v_mul_u32_u24 v35, 1152, v35
    v_mfma_f32_16x16x32_bf16 v[128:131], v[52:55], v[100:103], v[128:131]
    v_mul_u32_u24 v34, 1152, v34
    v_add_u32 v35, s98, v35
    v_mfma_f32_16x16x32_bf16 v[132:135], v[48:51], v[104:107], v[132:135]
    buffer_load_dwordx4 v1, s[28:31], s65 offen offset:1024 sc1 lds
    v_mfma_f32_16x16x32_bf16 v[132:135], v[52:55], v[108:111], v[132:135]
    ds_read_b128 v[64:67], v24 offset:49152
    v_add_u32 v34, s3, v34
    v_mfma_f32_16x16x32_bf16 v[136:139], v[48:51], v[112:115], v[136:139]
    v_add_u32 v35, 18944, v35
    v_lshlrev_b32 v33, 3, v33
    v_mfma_f32_16x16x32_bf16 v[136:139], v[52:55], v[116:119], v[136:139]
    s_cmp_eq_u32 s4, 0
    s_cselect_b64 vcc, -1, 0
    v_cndmask_b32 v34, v34, v35, vcc
    v_mfma_f32_16x16x32_bf16 v[140:143], v[48:51], v[120:123], v[140:143]
    ds_read_b64_tr_b16 v[48:49], v17 offset:32768
    ds_read_b64_tr_b16 v[50:51], v17 offset:33792
    v_mfma_f32_16x16x32_bf16 v[140:143], v[52:55], v[124:127], v[140:143]
    ds_read_b64_tr_b16 v[52:53], v17 offset:40960
    ds_read_b64_tr_b16 v[54:55], v17 offset:41984
    v_mfma_f32_16x16x32_bf16 v[144:147], v[56:59], v[96:99], v[144:147]
    v_add_u32 v17, 0x10000, v17
    v_and_b32 v35, 0x30, v1
    v_mfma_f32_16x16x32_bf16 v[144:147], v[60:63], v[100:103], v[144:147]
    v_add_u32 v3, v34, v35
    v_lshrrev_b32 v32, 6, v1
    v_mfma_f32_16x16x32_bf16 v[148:151], v[56:59], v[104:107], v[148:151]
    v_add_u32 v33, s69, v33
    v_lshl_add_u32 v4, v32, 7, v33
    v_mfma_f32_16x16x32_bf16 v[148:151], v[60:63], v[108:111], v[148:151]
    v_add_u32 v4, 0x10000, v4
    v_lshl_add_u32 v5, v32, 6, v33
    v_mfma_f32_16x16x32_bf16 v[152:155], v[56:59], v[112:115], v[152:155]
    v_add_u32 v5, 0x20000, v5
    v_mfma_f32_16x16x32_bf16 v[152:155], v[60:63], v[116:119], v[152:155]
    s_add_u32 m0, s68, 139264
    ds_read_b128 v[68:71], v25 offset:49152
    v_mfma_f32_16x16x32_bf16 v[156:159], v[56:59], v[120:123], v[156:159]
    buffer_load_dwordx4 v6, s[20:23], s66 offen lds
    v_mfma_f32_16x16x32_bf16 v[156:159], v[60:63], v[124:127], v[156:159]
    s_waitcnt lgkmcnt(1)
    ds_read_b64_tr_b16 v[56:57], v18 offset:32768
    ds_read_b64_tr_b16 v[58:59], v18 offset:33792
    v_mfma_f32_16x16x32_bf16 v[160:163], v[40:43], v[96:99], v[160:163]
    ds_read_b64_tr_b16 v[60:61], v18 offset:40960
    ds_read_b64_tr_b16 v[62:63], v18 offset:41984
    v_mfma_f32_16x16x32_bf16 v[160:163], v[44:47], v[100:103], v[160:163]
    v_add_u32 v18, 0x10000, v18
    v_mfma_f32_16x16x32_bf16 v[164:167], v[40:43], v[104:107], v[164:167]
    v_mfma_f32_16x16x32_bf16 v[164:167], v[44:47], v[108:111], v[164:167]
    v_mfma_f32_16x16x32_bf16 v[168:171], v[40:43], v[112:115], v[168:171]
    v_mfma_f32_16x16x32_bf16 v[168:171], v[44:47], v[116:119], v[168:171]
    v_mfma_f32_16x16x32_bf16 v[172:175], v[40:43], v[120:123], v[172:175]
    ds_read_b64_tr_b16 v[40:41], v19 offset:32768
    ds_read_b64_tr_b16 v[42:43], v19 offset:33792
    v_mfma_f32_16x16x32_bf16 v[172:175], v[44:47], v[124:127], v[172:175]
    ds_read_b64_tr_b16 v[44:45], v19 offset:40960
    ds_read_b64_tr_b16 v[46:47], v19 offset:41984
    v_mfma_f32_16x16x32_bf16 v[176:179], v[48:51], v[96:99], v[176:179]
    ds_read_b128 v[72:75], v24 offset:57344
    v_add_u32 v19, 0x10000, v19
    v_mfma_f32_16x16x32_bf16 v[176:179], v[52:55], v[100:103], v[176:179]
    s_add_u32 m0, s69, 147456
    v_mfma_f32_16x16x32_bf16 v[180:183], v[48:51], v[104:107], v[180:183]
    s_add_u32 s65, s65, 8192
    buffer_load_dwordx4 v2, s[52:55], 0 offen lds
    v_mfma_f32_16x16x32_bf16 v[180:183], v[52:55], v[108:111], v[180:183]
    s_add_u32 s66, s66, 128
    v_mfma_f32_16x16x32_bf16 v[184:187], v[48:51], v[112:115], v[184:187]
    v_mfma_f32_16x16x32_bf16 v[184:187], v[52:55], v[116:119], v[184:187]
    v_mfma_f32_16x16x32_bf16 v[188:191], v[48:51], v[120:123], v[188:191]
    ds_read_b64_tr_b16 v[48:49], v20 offset:32768
    ds_read_b64_tr_b16 v[50:51], v20 offset:33792
    v_mfma_f32_16x16x32_bf16 v[188:191], v[52:55], v[124:127], v[188:191]
    s_waitcnt lgkmcnt(2)
    ds_read_b64_tr_b16 v[52:53], v20 offset:40960
    ds_read_b64_tr_b16 v[54:55], v20 offset:41984
    v_mfma_f32_16x16x32_bf16 v[192:195], v[56:59], v[96:99], v[192:195]
    v_add_u32 v20, 0x10000, v20
    v_mfma_f32_16x16x32_bf16 v[192:195], v[60:63], v[100:103], v[192:195]
    v_mfma_f32_16x16x32_bf16 v[196:199], v[56:59], v[104:107], v[196:199]
    v_mfma_f32_16x16x32_bf16 v[196:199], v[60:63], v[108:111], v[196:199]
    ds_read_b128 v[76:79], v25 offset:57344
    v_mfma_f32_16x16x32_bf16 v[200:203], v[56:59], v[112:115], v[200:203]
    v_mfma_f32_16x16x32_bf16 v[200:203], v[60:63], v[116:119], v[200:203]
    s_add_u32 m0, s69, 148480
    v_mfma_f32_16x16x32_bf16 v[204:207], v[56:59], v[120:123], v[204:207]
    buffer_load_dwordx4 v3, s[52:55], 0 offen lds
    v_mfma_f32_16x16x32_bf16 v[204:207], v[60:63], v[124:127], v[204:207]
    ds_read_b64_tr_b16 v[56:57], v21 offset:32768
    ds_read_b64_tr_b16 v[58:59], v21 offset:33792
    v_mfma_f32_16x16x32_bf16 v[208:211], v[40:43], v[96:99], v[208:211]
    ds_read_b64_tr_b16 v[60:61], v21 offset:40960
    ds_read_b64_tr_b16 v[62:63], v21 offset:41984
    v_mfma_f32_16x16x32_bf16 v[208:211], v[44:47], v[100:103], v[208:211]
    v_add_u32 v21, 0x10000, v21
    v_mfma_f32_16x16x32_bf16 v[212:215], v[40:43], v[104:107], v[212:215]
    v_mfma_f32_16x16x32_bf16 v[212:215], v[44:47], v[108:111], v[212:215]
    v_mfma_f32_16x16x32_bf16 v[216:219], v[40:43], v[112:115], v[216:219]
    v_mfma_f32_16x16x32_bf16 v[216:219], v[44:47], v[116:119], v[216:219]
    v_mfma_f32_16x16x32_bf16 v[220:223], v[40:43], v[120:123], v[220:223]
    v_mfma_f32_16x16x32_bf16 v[220:223], v[44:47], v[124:127], v[220:223]
    s_waitcnt lgkmcnt(0)
    v_mfma_f32_16x16x32_bf16 v[224:227], v[48:51], v[96:99], v[224:227]
    v_mfma_f32_16x16x32_bf16 v[224:227], v[52:55], v[100:103], v[224:227]
    v_mfma_f32_16x16x32_bf16 v[228:231], v[48:51], v[104:107], v[228:231]
    v_mfma_f32_16x16x32_bf16 v[228:231], v[52:55], v[108:111], v[228:231]
    v_mfma_f32_16x16x32_bf16 v[232:235], v[48:51], v[112:115], v[232:235]
    v_mfma_f32_16x16x32_bf16 v[232:235], v[52:55], v[116:119], v[232:235]
    s_waitcnt vmcnt(14)
    s_barrier
    ds_read_b64_tr_b16 v[40:41], v26 offset:0
    v_mfma_f32_16x16x32_bf16 v[236:239], v[48:51], v[120:123], v[236:239]
    ds_read_b64_tr_b16 v[42:43], v26 offset:512
    ds_read_b64_tr_b16 v[44:45], v26 offset:4096
    v_mfma_f32_16x16x32_bf16 v[236:239], v[52:55], v[124:127], v[236:239]
    ds_read_b64_tr_b16 v[46:47], v26 offset:4608
    ds_read_b128 a[136:139], v22 offset:0
    v_mfma_f32_16x16x32_bf16 v[240:243], v[56:59], v[96:99], v[240:243]
    ds_read_b128 a[140:143], v23 offset:0
    ds_read_b64_tr_b16 v[48:49], v27 offset:0
    v_mfma_f32_16x16x32_bf16 v[240:243], v[60:63], v[100:103], v[240:243]
    ds_read_b64_tr_b16 v[50:51], v27 offset:512
    ds_read_b64_tr_b16 v[52:53], v27 offset:4096
    v_mfma_f32_16x16x32_bf16 v[244:247], v[56:59], v[104:107], v[244:247]
    ds_read_b64_tr_b16 v[54:55], v27 offset:4608
    v_add_u32 v26, 0x10000, v26
    v_mfma_f32_16x16x32_bf16 v[244:247], v[60:63], v[108:111], v[244:247]
    v_add_u32 v22, 0x10000, v22
    v_add_u32 v23, 0x10000, v23
    v_mfma_f32_16x16x32_bf16 v[248:251], v[56:59], v[112:115], v[248:251]
    v_add_u32 v27, 0x10000, v27
    v_mfma_f32_16x16x32_bf16 v[248:251], v[60:63], v[116:119], v[248:251]
    v_mfma_f32_16x16x32_bf16 v[252:255], v[56:59], v[120:123], v[252:255]
    ds_read_b64_tr_b16 v[56:57], v28 offset:0
    ds_read_b64_tr_b16 v[58:59], v28 offset:512
    v_mfma_f32_16x16x32_bf16 v[252:255], v[60:63], v[124:127], v[252:255]
    s_waitcnt lgkmcnt(2)
    ds_read_b64_tr_b16 v[60:61], v28 offset:4096
    ds_read_b64_tr_b16 v[62:63], v28 offset:4608
    v_mfma_f32_16x16x32_bf16 a[64:67], v[40:43], v[96:99], a[64:67]
    v_add_u32 v28, 0x10000, v28
    v_mfma_f32_16x16x32_bf16 a[64:67], v[44:47], v[100:103], a[64:67]
    v_add_u32 v24, 0x10000, v24
    v_mfma_f32_16x16x32_bf16 a[68:71], v[40:43], v[104:107], a[68:71]
    ds_read_b128 v[80:83], v24 offset:16384
    v_mfma_f32_16x16x32_bf16 a[68:71], v[44:47], v[108:111], a[68:71]
    v_mfma_f32_16x16x32_bf16 a[72:75], v[40:43], v[112:115], a[72:75]
    v_mfma_f32_16x16x32_bf16 a[72:75], v[44:47], v[116:119], a[72:75]
    v_add_u32 v25, 0x10000, v25
    v_mfma_f32_16x16x32_bf16 a[76:79], v[40:43], v[120:123], a[76:79]
    ds_read_b128 v[84:87], v25 offset:16384
    v_mfma_f32_16x16x32_bf16 a[76:79], v[44:47], v[124:127], a[76:79]
    v_mfma_f32_16x16x32_bf16 a[128:131], v[40:43], a[136:139], a[128:131]
    ds_read_b64_tr_b16 v[40:41], v29 offset:0
    ds_read_b64_tr_b16 v[42:43], v29 offset:512
    v_mfma_f32_16x16x32_bf16 a[128:131], v[44:47], a[140:143], a[128:131]
    ds_read_b64_tr_b16 v[44:45], v29 offset:4096
    ds_read_b64_tr_b16 v[46:47], v29 offset:4608
    v_mfma_f32_16x16x32_bf16 a[80:83], v[48:51], v[96:99], a[80:83]
    ds_read_b128 v[88:91], v24 offset:24576
    v_add_u32 v29, 0x10000, v29
    v_mfma_f32_16x16x32_bf16 a[80:83], v[52:55], v[100:103], a[80:83]
    v_mfma_f32_16x16x32_bf16 a[84:87], v[48:51], v[104:107], a[84:87]
    v_mfma_f32_16x16x32_bf16 a[84:87], v[52:55], v[108:111], a[84:87]
    v_mfma_f32_16x16x32_bf16 a[88:91], v[48:51], v[112:115], a[88:91]
    ds_read_b128 v[92:95], v25 offset:24576
    v_mfma_f32_16x16x32_bf16 a[88:91], v[52:55], v[116:119], a[88:91]
    v_mfma_f32_16x16x32_bf16 a[92:95], v[48:51], v[120:123], a[92:95]
    v_mfma_f32_16x16x32_bf16 a[92:95], v[52:55], v[124:127], a[92:95]
    v_mfma_f32_16x16x32_bf16 a[132:135], v[48:51], a[136:139], a[132:135]
    v_mfma_f32_16x16x32_bf16 a[132:135], v[52:55], a[140:143], a[132:135]
    s_waitcnt lgkmcnt(0)
    v_mfma_f32_16x16x32_bf16 a[96:99], v[56:59], v[96:99], a[96:99]
    v_mfma_f32_16x16x32_bf16 a[96:99], v[60:63], v[100:103], a[96:99]
    v_mfma_f32_16x16x32_bf16 a[100:103], v[56:59], v[104:107], a[100:103]
    v_mfma_f32_16x16x32_bf16 a[100:103], v[60:63], v[108:111], a[100:103]
    v_mfma_f32_16x16x32_bf16 a[104:107], v[56:59], v[112:115], a[104:107]
    v_mfma_f32_16x16x32_bf16 a[104:107], v[60:63], v[116:119], a[104:107]
    s_waitcnt vmcnt(5)
    s_barrier
    ds_read_b64_tr_b16 v[48:49], v14 offset:32768
    v_mfma_f32_16x16x32_bf16 a[108:111], v[56:59], v[120:123], a[108:111]
    ds_read_b64_tr_b16 v[50:51], v14 offset:33792
    ds_read_b64_tr_b16 v[52:53], v14 offset:40960
    v_mfma_f32_16x16x32_bf16 a[108:111], v[60:63], v[124:127], a[108:111]
    ds_read_b64_tr_b16 v[54:55], v14 offset:41984
    ds_read_b64_tr_b16 v[56:57], v15 offset:32768
    v_mfma_f32_16x16x32_bf16 a[112:115], v[40:43], v[96:99], a[112:115]
    ds_read_b64_tr_b16 v[58:59], v15 offset:33792
    ds_read_b64_tr_b16 v[60:61], v15 offset:40960
    v_mfma_f32_16x16x32_bf16 a[112:115], v[44:47], v[100:103], a[112:115]
    ds_read_b64_tr_b16 v[62:63], v15 offset:41984
    v_mfma_f32_16x16x32_bf16 a[116:119], v[40:43], v[104:107], a[116:119]
    v_mfma_f32_16x16x32_bf16 a[116:119], v[44:47], v[108:111], a[116:119]
    v_mfma_f32_16x16x32_bf16 a[120:123], v[40:43], v[112:115], a[120:123]
    v_mfma_f32_16x16x32_bf16 a[120:123], v[44:47], v[116:119], a[120:123]
    v_mfma_f32_16x16x32_bf16 a[124:127], v[40:43], v[120:123], a[124:127]
    ds_read_b64_tr_b16 v[40:41], v16 offset:32768
    ds_read_b64_tr_b16 v[42:43], v16 offset:33792
    v_mfma_f32_16x16x32_bf16 a[124:127], v[44:47], v[124:127], a[124:127]
    s_waitcnt lgkmcnt(2)
    ds_read_b64_tr_b16 v[44:45], v16 offset:40960
    ds_read_b64_tr_b16 v[46:47], v16 offset:41984
    v_mfma_f32_16x16x32_bf16 v[128:131], v[48:51], v[64:67], v[128:131]
    v_mfma_f32_16x16x32_bf16 v[128:131], v[52:55], v[68:71], v[128:131]
    ds_read_b64_tr_b16 v[32:33], v4 offset:49152
    ds_read_b64_tr_b16 v[34:35], v4 offset:51200
    v_mfma_f32_16x16x32_bf16 v[132:135], v[48:51], v[72:75], v[132:135]
    v_mfma_f32_16x16x32_bf16 v[132:135], v[52:55], v[76:79], v[132:135]
    v_mfma_f32_16x16x32_bf16 v[136:139], v[48:51], v[80:83], v[136:139]
    v_mfma_f32_16x16x32_bf16 v[136:139], v[52:55], v[84:87], v[136:139]
    v_mfma_f32_16x16x32_bf16 v[140:143], v[48:51], v[88:91], v[140:143]
    ds_read_b64_tr_b16 v[48:49], v17 offset:32768
    ds_read_b64_tr_b16 v[50:51], v17 offset:33792
    v_mfma_f32_16x16x32_bf16 v[140:143], v[52:55], v[92:95], v[140:143]
    ds_read_b64_tr_b16 v[52:53], v17 offset:40960
    ds_read_b64_tr_b16 v[54:55], v17 offset:41984
    v_mfma_f32_16x16x32_bf16 v[144:147], v[56:59], v[64:67], v[144:147]
    s_waitcnt lgkmcnt(4)
    buffer_store_dwordx4 v[32:35], v1, s[56:59], s70 offen offset:0 sc1
    v_mfma_f32_16x16x32_bf16 v[144:147], v[60:63], v[68:71], v[144:147]
    v_mul_f32 v128, s74, v128
    v_mul_f32 v129, s74, v129
    v_mfma_f32_16x16x32_bf16 v[148:151], v[56:59], v[72:75], v[148:151]
    v_mul_f32 v130, s74, v130
    v_mul_f32 v131, s74, v131
    v_mfma_f32_16x16x32_bf16 v[148:151], v[60:63], v[76:79], v[148:151]
    ds_read_b64_tr_b16 v[36:37], v4 offset:49184
    ds_read_b64_tr_b16 v[38:39], v4 offset:51232
    v_mfma_f32_16x16x32_bf16 v[152:155], v[56:59], v[80:83], v[152:155]
    v_mul_f32 v132, s74, v132
    v_mul_f32 v133, s74, v133
    v_mfma_f32_16x16x32_bf16 v[152:155], v[60:63], v[84:87], v[152:155]
    v_mul_f32 v134, s74, v134
    v_mul_f32 v135, s74, v135
    v_mfma_f32_16x16x32_bf16 v[156:159], v[56:59], v[88:91], v[156:159]
    ds_read_b64_tr_b16 v[56:57], v18 offset:32768
    ds_read_b64_tr_b16 v[58:59], v18 offset:33792
    v_mfma_f32_16x16x32_bf16 v[156:159], v[60:63], v[92:95], v[156:159]
    ds_read_b64_tr_b16 v[60:61], v18 offset:40960
    ds_read_b64_tr_b16 v[62:63], v18 offset:41984
    v_mfma_f32_16x16x32_bf16 v[160:163], v[40:43], v[64:67], v[160:163]
    v_mul_f32 v136, s74, v136
    v_mul_f32 v137, s74, v137
    v_mfma_f32_16x16x32_bf16 v[160:163], v[44:47], v[68:71], v[160:163]
    v_mul_f32 v138, s74, v138
    v_mul_f32 v139, s74, v139
    v_mfma_f32_16x16x32_bf16 v[164:167], v[40:43], v[72:75], v[164:167]
    s_waitcnt lgkmcnt(4)
    buffer_store_dwordx4 v[36:39], v1, s[56:59], s70 offen offset:1024 sc1
    v_mfma_f32_16x16x32_bf16 v[164:167], v[44:47], v[76:79], v[164:167]
    buffer_load_dword v7, v8, s[32:35], s61 offen sc1
    v_mfma_f32_16x16x32_bf16 v[168:171], v[40:43], v[80:83], v[168:171]
    v_mul_f32 v140, s74, v140
    v_mul_f32 v141, s74, v141
    v_mfma_f32_16x16x32_bf16 v[168:171], v[44:47], v[84:87], v[168:171]
    ds_read_b64_tr_b16 v[32:33], v4 offset:49216
    ds_read_b64_tr_b16 v[34:35], v4 offset:51264
    v_mfma_f32_16x16x32_bf16 v[172:175], v[40:43], v[88:91], v[172:175]
    ds_read_b64_tr_b16 v[40:41], v19 offset:32768
    ds_read_b64_tr_b16 v[42:43], v19 offset:33792
    v_mfma_f32_16x16x32_bf16 v[172:175], v[44:47], v[92:95], v[172:175]
    ds_read_b64_tr_b16 v[44:45], v19 offset:40960
    ds_read_b64_tr_b16 v[46:47], v19 offset:41984
    v_mfma_f32_16x16x32_bf16 v[176:179], v[48:51], v[64:67], v[176:179]
    v_mul_f32 v142, s74, v142
    v_mul_f32 v143, s74, v143
    v_mfma_f32_16x16x32_bf16 v[176:179], v[52:55], v[68:71], v[176:179]
    v_mul_f32 v144, s74, v144
    v_mul_f32 v145, s74, v145
    v_mfma_f32_16x16x32_bf16 v[180:183], v[48:51], v[72:75], v[180:183]
    v_mul_f32 v146, s74, v146
    v_mul_f32 v147, s74, v147
    v_mfma_f32_16x16x32_bf16 v[180:183], v[52:55], v[76:79], v[180:183]
    v_mul_f32 v148, s74, v148
    v_mul_f32 v149, s74, v149
    v_mfma_f32_16x16x32_bf16 v[184:187], v[48:51], v[80:83], v[184:187]
    s_waitcnt lgkmcnt(0)
    buffer_store_dwordx4 v[32:35], v1, s[56:59], s70 offen offset:2048 sc1
    v_mfma_f32_16x16x32_bf16 v[184:187], v[52:55], v[84:87], v[184:187]
    v_mul_f32 v150, s74, v150
    v_mul_f32 v151, s74, v151
    v_mfma_f32_16x16x32_bf16 v[188:191], v[48:51], v[88:91], v[188:191]
    ds_read_b64_tr_b16 v[48:49], v20 offset:32768
    ds_read_b64_tr_b16 v[50:51], v20 offset:33792
    v_mfma_f32_16x16x32_bf16 v[188:191], v[52:55], v[92:95], v[188:191]
    ds_read_b64_tr_b16 v[52:53], v20 offset:40960
    ds_read_b64_tr_b16 v[54:55], v20 offset:41984
    v_mfma_f32_16x16x32_bf16 v[192:195], v[56:59], v[64:67], v[192:195]
    ds_read_b64_tr_b16 v[36:37], v4 offset:49248
    ds_read_b64_tr_b16 v[38:39], v4 offset:51296
    v_mfma_f32_16x16x32_bf16 v[192:195], v[60:63], v[68:71], v[192:195]
    v_mul_f32 v152, s74, v152
    v_mul_f32 v153, s74, v153
    v_mfma_f32_16x16x32_bf16 v[196:199], v[56:59], v[72:75], v[196:199]
    v_mul_f32 v154, s74, v154
    v_mul_f32 v155, s74, v155
    v_mfma_f32_16x16x32_bf16 v[196:199], v[60:63], v[76:79], v[196:199]
    v_mul_f32 v156, s74, v156
    v_mul_f32 v157, s74, v157
    v_mfma_f32_16x16x32_bf16 v[200:203], v[56:59], v[80:83], v[200:203]
    v_mul_f32 v158, s74, v158
    v_mul_f32 v159, s74, v159
    v_mfma_f32_16x16x32_bf16 v[200:203], v[60:63], v[84:87], v[200:203]
    v_mul_f32 v160, s74, v160
    v_mul_f32 v161, s74, v161
    v_mfma_f32_16x16x32_bf16 v[204:207], v[56:59], v[88:91], v[204:207]
    ds_read_b64_tr_b16 v[56:57], v21 offset:32768
    ds_read_b64_tr_b16 v[58:59], v21 offset:33792
    v_mfma_f32_16x16x32_bf16 v[204:207], v[60:63], v[92:95], v[204:207]
    ds_read_b64_tr_b16 v[60:61], v21 offset:40960
    ds_read_b64_tr_b16 v[62:63], v21 offset:41984
    v_mfma_f32_16x16x32_bf16 v[208:211], v[40:43], v[64:67], v[208:211]
    s_waitcnt lgkmcnt(4)
    buffer_store_dwordx4 v[36:39], v1, s[56:59], s70 offen offset:3072 sc1
    v_mfma_f32_16x16x32_bf16 v[208:211], v[44:47], v[68:71], v[208:211]
    v_mul_f32 v162, s74, v162
    v_mul_f32 v163, s74, v163
    v_mfma_f32_16x16x32_bf16 v[212:215], v[40:43], v[72:75], v[212:215]
    v_mul_f32 v164, s74, v164
    v_mul_f32 v165, s74, v165
    v_mfma_f32_16x16x32_bf16 v[212:215], v[44:47], v[76:79], v[212:215]
    v_mul_f32 v166, s74, v166
    v_mul_f32 v167, s74, v167
    v_mfma_f32_16x16x32_bf16 v[216:219], v[40:43], v[80:83], v[216:219]
    v_mul_f32 v168, s74, v168
    v_mul_f32 v169, s74, v169
    v_mfma_f32_16x16x32_bf16 v[216:219], v[44:47], v[84:87], v[216:219]
    v_mul_f32 v170, s74, v170
    v_mul_f32 v171, s74, v171
    v_mfma_f32_16x16x32_bf16 v[220:223], v[40:43], v[88:91], v[220:223]
    v_mul_f32 v172, s74, v172
    v_mul_f32 v173, s74, v173
    v_mfma_f32_16x16x32_bf16 v[220:223], v[44:47], v[92:95], v[220:223]
    v_mul_f32 v174, s74, v174
    v_mul_f32 v175, s74, v175
    v_mfma_f32_16x16x32_bf16 v[224:227], v[48:51], v[64:67], v[224:227]
    v_mul_f32 v176, s74, v176
    v_mul_f32 v177, s74, v177
    v_mfma_f32_16x16x32_bf16 v[224:227], v[52:55], v[68:71], v[224:227]
    v_mul_f32 v178, s74, v178
    v_mul_f32 v179, s74, v179
    v_mfma_f32_16x16x32_bf16 v[228:231], v[48:51], v[72:75], v[228:231]
    v_mul_f32 v180, s74, v180
    v_mul_f32 v181, s74, v181
    v_mfma_f32_16x16x32_bf16 v[228:231], v[52:55], v[76:79], v[228:231]
    v_mul_f32 v182, s74, v182
    v_mul_f32 v183, s74, v183
    v_mfma_f32_16x16x32_bf16 v[232:235], v[48:51], v[80:83], v[232:235]
    v_mul_f32 v184, s74, v184
    v_mul_f32 v185, s74, v185
    v_mfma_f32_16x16x32_bf16 v[232:235], v[52:55], v[84:87], v[232:235]
    s_add_u32 m0, s76, s75
    v_mul_f32 v186, s74, v186
    v_mul_f32 v187, s74, v187
    s_waitcnt vmcnt(2)
    v_cmp_gt_u32 vcc, 1, v7
    s_nop 1
    s_and_b64 vcc, vcc, exec
    s_cbranch_scc1 SPIN_KV
BACK_KV:
    s_barrier
    v_mfma_f32_16x16x32_bf16 v[236:239], v[48:51], v[88:91], v[236:239]
    s_lshl_b32 s38, s7, 15
    buffer_load_dwordx4 v1, s[36:39], s77 offen sc1 lds
    v_mfma_f32_16x16x32_bf16 v[236:239], v[52:55], v[92:95], v[236:239]
    s_waitcnt lgkmcnt(0)
    ds_read_b64_tr_b16 v[40:41], v26 offset:0
    ds_read_b64_tr_b16 v[42:43], v26 offset:512
    v_mfma_f32_16x16x32_bf16 v[240:243], v[56:59], v[64:67], v[240:243]
    ds_read_b64_tr_b16 v[44:45], v26 offset:4096
    ds_read_b64_tr_b16 v[46:47], v26 offset:4608
    v_mfma_f32_16x16x32_bf16 v[240:243], v[60:63], v[68:71], v[240:243]
    ds_read_b128 a[136:139], v22 offset:0
    ds_read_b128 a[140:143], v23 offset:0
    v_mfma_f32_16x16x32_bf16 v[244:247], v[56:59], v[72:75], v[244:247]
    buffer_load_dwordx4 v1, s[36:39], s77 offen offset:1024 sc1 lds
    v_mfma_f32_16x16x32_bf16 v[244:247], v[60:63], v[76:79], v[244:247]
    ds_read_b64_tr_b16 v[48:49], v27 offset:0
    ds_read_b64_tr_b16 v[50:51], v27 offset:512
    v_mfma_f32_16x16x32_bf16 v[248:251], v[56:59], v[80:83], v[248:251]
    ds_read_b64_tr_b16 v[52:53], v27 offset:4096
    ds_read_b64_tr_b16 v[54:55], v27 offset:4608
    v_mfma_f32_16x16x32_bf16 v[248:251], v[60:63], v[84:87], v[248:251]
    v_mul_f32 v188, s74, v188
    v_mul_f32 v189, s74, v189
    v_mfma_f32_16x16x32_bf16 v[252:255], v[56:59], v[88:91], v[252:255]
    buffer_load_dwordx4 v1, s[36:39], s77 offen offset:2048 sc1 lds
    v_mfma_f32_16x16x32_bf16 v[252:255], v[60:63], v[92:95], v[252:255]
    s_waitcnt lgkmcnt(4)
    ds_read_b64_tr_b16 v[56:57], v28 offset:0
    ds_read_b64_tr_b16 v[58:59], v28 offset:512
    v_mfma_f32_16x16x32_bf16 a[64:67], v[40:43], v[64:67], a[64:67]
    ds_read_b64_tr_b16 v[60:61], v28 offset:4096
    ds_read_b64_tr_b16 v[62:63], v28 offset:4608
    v_mfma_f32_16x16x32_bf16 a[64:67], v[44:47], v[68:71], a[64:67]
    ds_read_b64_tr_b16 v[32:33], v5 offset:16384
    ds_read_b64_tr_b16 v[34:35], v5 offset:17408
    v_mfma_f32_16x16x32_bf16 a[68:71], v[40:43], v[72:75], a[68:71]
    buffer_load_dwordx4 v1, s[36:39], s77 offen offset:3072 sc1 lds
    v_mfma_f32_16x16x32_bf16 a[68:71], v[44:47], v[76:79], a[68:71]
    v_mul_f32 v190, s74, v190
    v_mul_f32 v191, s74, v191
    v_mfma_f32_16x16x32_bf16 a[72:75], v[40:43], v[80:83], a[72:75]
    v_mul_f32 v192, s74, v192
    v_mul_f32 v193, s74, v193
    v_mfma_f32_16x16x32_bf16 a[72:75], v[44:47], v[84:87], a[72:75]
    s_add_u32 s100, s77, 4096
    v_mul_f32 v194, s74, v194
    v_mul_f32 v195, s74, v195
    v_mfma_f32_16x16x32_bf16 a[76:79], v[40:43], v[88:91], a[76:79]
    s_add_u32 m0, m0, 4096
    v_mul_f32 v196, s74, v196
    v_mul_f32 v197, s74, v197
    v_mfma_f32_16x16x32_bf16 a[76:79], v[44:47], v[92:95], a[76:79]
    buffer_load_dwordx4 v1, s[36:39], s100 offen sc1 lds
    v_mfma_f32_16x16x32_bf16 a[128:131], v[40:43], a[136:139], a[128:131]
    ds_read_b64_tr_b16 v[40:41], v29 offset:0
    ds_read_b64_tr_b16 v[42:43], v29 offset:512
    v_mfma_f32_16x16x32_bf16 a[128:131], v[44:47], a[140:143], a[128:131]
    s_waitcnt lgkmcnt(2)
    ds_read_b64_tr_b16 v[44:45], v29 offset:4096
    ds_read_b64_tr_b16 v[46:47], v29 offset:4608
    v_mfma_f32_16x16x32_bf16 a[80:83], v[48:51], v[64:67], a[80:83]
    buffer_load_dwordx4 v1, s[36:39], s100 offen offset:1024 sc1 lds
    v_mfma_f32_16x16x32_bf16 a[80:83], v[52:55], v[68:71], a[80:83]
    ds_read_b64_tr_b16 v[36:37], v5 offset:16416
    ds_read_b64_tr_b16 v[38:39], v5 offset:17440
    v_mfma_f32_16x16x32_bf16 a[84:87], v[48:51], v[72:75], a[84:87]
    v_mul_f32 v198, s74, v198
    v_mul_f32 v199, s74, v199
    v_mfma_f32_16x16x32_bf16 a[84:87], v[52:55], v[76:79], a[84:87]
    v_mul_f32 v200, s74, v200
    v_mul_f32 v201, s74, v201
    v_mfma_f32_16x16x32_bf16 a[88:91], v[48:51], v[80:83], a[88:91]
    buffer_load_dwordx4 v1, s[36:39], s100 offen offset:2048 sc1 lds
    v_mfma_f32_16x16x32_bf16 a[88:91], v[52:55], v[84:87], a[88:91]
    v_mul_f32 v202, s74, v202
    v_mul_f32 v203, s74, v203
    v_mfma_f32_16x16x32_bf16 a[92:95], v[48:51], v[88:91], a[92:95]
    v_mul_f32 v204, s74, v204
    v_mul_f32 v205, s74, v205
    v_mfma_f32_16x16x32_bf16 a[92:95], v[52:55], v[92:95], a[92:95]
    v_mul_f32 v206, s74, v206
    v_mul_f32 v207, s74, v207
    v_mfma_f32_16x16x32_bf16 a[132:135], v[48:51], a[136:139], a[132:135]
    buffer_load_dwordx4 v1, s[36:39], s100 offen offset:3072 sc1 lds
    v_mfma_f32_16x16x32_bf16 a[132:135], v[52:55], a[140:143], a[132:135]
    v_mul_f32 v208, s74, v208
    v_mul_f32 v209, s74, v209
    v_mfma_f32_16x16x32_bf16 a[96:99], v[56:59], v[64:67], a[96:99]
    v_mul_f32 v210, s74, v210
    v_mul_f32 v211, s74, v211
    v_mfma_f32_16x16x32_bf16 a[96:99], v[60:63], v[68:71], a[96:99]
    s_add_u32 s77, s77, 32768
    v_mul_f32 v212, s74, v212
    v_mul_f32 v213, s74, v213
    v_mfma_f32_16x16x32_bf16 a[100:103], v[56:59], v[72:75], a[100:103]
    s_add_u32 s76, s76, 32768
    v_mul_f32 v214, s74, v214
    v_mul_f32 v215, s74, v215
    v_mfma_f32_16x16x32_bf16 a[100:103], v[60:63], v[76:79], a[100:103]
    v_mul_f32 v216, s74, v216
    v_mul_f32 v217, s74, v217
    v_mfma_f32_16x16x32_bf16 a[104:107], v[56:59], v[80:83], a[104:107]
    v_mul_f32 v218, s74, v218
    v_mul_f32 v219, s74, v219
    v_mfma_f32_16x16x32_bf16 a[104:107], v[60:63], v[84:87], a[104:107]
    v_mul_f32 v220, s74, v220
    v_mul_f32 v221, s74, v221
    v_mfma_f32_16x16x32_bf16 a[108:111], v[56:59], v[88:91], a[108:111]
    v_mul_f32 v222, s74, v222
    v_mul_f32 v223, s74, v223
    v_mfma_f32_16x16x32_bf16 a[108:111], v[60:63], v[92:95], a[108:111]
    s_waitcnt lgkmcnt(0)
    v_mul_f32 v224, s74, v224
    v_mul_f32 v225, s74, v225
    v_mfma_f32_16x16x32_bf16 a[112:115], v[40:43], v[64:67], a[112:115]
    v_mul_f32 v226, s74, v226
    v_mul_f32 v227, s74, v227
    v_mfma_f32_16x16x32_bf16 a[112:115], v[44:47], v[68:71], a[112:115]
    v_mul_f32 v228, s74, v228
    v_mul_f32 v229, s74, v229
    v_mfma_f32_16x16x32_bf16 a[116:119], v[40:43], v[72:75], a[116:119]
    v_mul_f32 v230, s74, v230
    v_mul_f32 v231, s74, v231
    v_mfma_f32_16x16x32_bf16 a[116:119], v[44:47], v[76:79], a[116:119]
    v_mul_f32 v232, s74, v232
    v_mul_f32 v233, s74, v233
    v_mfma_f32_16x16x32_bf16 a[120:123], v[40:43], v[80:83], a[120:123]
    v_mul_f32 v234, s74, v234
    v_mul_f32 v235, s74, v235
    v_mfma_f32_16x16x32_bf16 a[120:123], v[44:47], v[84:87], a[120:123]
    v_mul_f32 v236, s74, v236
    v_mul_f32 v237, s74, v237
    v_mfma_f32_16x16x32_bf16 a[124:127], v[40:43], v[88:91], a[124:127]
    v_mul_f32 v238, s74, v238
    v_mul_f32 v239, s74, v239
    v_mfma_f32_16x16x32_bf16 a[124:127], v[44:47], v[92:95], a[124:127]
    s_add_u32 m0, s76, s75
    s_nop 0
    buffer_load_dwordx4 v1, s[36:39], s77 offen sc1 lds
    v_mul_f32 v240, s74, v240
    v_mul_f32 v241, s74, v241
    v_mul_f32 v242, s74, v242
    v_mul_f32 v243, s74, v243
    v_mul_f32 v244, s74, v244
    v_mul_f32 v245, s74, v245
    v_mul_f32 v246, s74, v246
    v_mul_f32 v247, s74, v247
    v_mul_f32 v248, s74, v248
    v_mul_f32 v249, s74, v249
    v_mul_f32 v250, s74, v250
    v_mul_f32 v251, s74, v251
    v_mul_f32 v252, s74, v252
    v_mul_f32 v253, s74, v253
    v_mul_f32 v254, s74, v254
    v_mul_f32 v255, s74, v255
    buffer_load_dwordx4 v1, s[36:39], s77 offen offset:1024 sc1 lds
    v_cvt_pk_bf16_f32 v128, v128, v129
    v_cvt_pk_bf16_f32 v129, v130, v131
    v_cvt_pk_bf16_f32 v130, v144, v145
    v_cvt_pk_bf16_f32 v131, v146, v147
    v_cvt_pk_bf16_f32 v132, v132, v133
    v_cvt_pk_bf16_f32 v133, v134, v135
    v_cvt_pk_bf16_f32 v134, v148, v149
    v_cvt_pk_bf16_f32 v135, v150, v151
    v_cvt_pk_bf16_f32 v136, v136, v137
    v_cvt_pk_bf16_f32 v137, v138, v139
    v_cvt_pk_bf16_f32 v138, v152, v153
    v_cvt_pk_bf16_f32 v139, v154, v155
    v_cvt_pk_bf16_f32 v140, v140, v141
    v_cvt_pk_bf16_f32 v141, v142, v143
    v_cvt_pk_bf16_f32 v142, v156, v157
    v_cvt_pk_bf16_f32 v143, v158, v159
    buffer_load_dwordx4 v1, s[36:39], s77 offen offset:2048 sc1 lds
    v_cvt_pk_bf16_f32 v160, v160, v161
    v_cvt_pk_bf16_f32 v161, v162, v163
    v_cvt_pk_bf16_f32 v162, v176, v177
    v_cvt_pk_bf16_f32 v163, v178, v179
    v_cvt_pk_bf16_f32 v164, v164, v165
    v_cvt_pk_bf16_f32 v165, v166, v167
    v_cvt_pk_bf16_f32 v166, v180, v181
    v_cvt_pk_bf16_f32 v167, v182, v183
    v_cvt_pk_bf16_f32 v168, v168, v169
    v_cvt_pk_bf16_f32 v169, v170, v171
    v_cvt_pk_bf16_f32 v170, v184, v185
    v_cvt_pk_bf16_f32 v171, v186, v187
    v_cvt_pk_bf16_f32 v172, v172, v173
    v_cvt_pk_bf16_f32 v173, v174, v175
    v_cvt_pk_bf16_f32 v174, v188, v189
    v_cvt_pk_bf16_f32 v175, v190, v191
    buffer_load_dwordx4 v1, s[36:39], s77 offen offset:3072 sc1 lds
    v_cvt_pk_bf16_f32 v192, v192, v193
    v_cvt_pk_bf16_f32 v193, v194, v195
    v_cvt_pk_bf16_f32 v194, v208, v209
    v_cvt_pk_bf16_f32 v195, v210, v211
    v_cvt_pk_bf16_f32 v196, v196, v197
    v_cvt_pk_bf16_f32 v197, v198, v199
    v_cvt_pk_bf16_f32 v198, v212, v213
    v_cvt_pk_bf16_f32 v199, v214, v215
    v_cvt_pk_bf16_f32 v200, v200, v201
    v_cvt_pk_bf16_f32 v201, v202, v203
    v_cvt_pk_bf16_f32 v202, v216, v217
    v_cvt_pk_bf16_f32 v203, v218, v219
    v_cvt_pk_bf16_f32 v204, v204, v205
    v_cvt_pk_bf16_f32 v205, v206, v207
    v_cvt_pk_bf16_f32 v206, v220, v221
    v_cvt_pk_bf16_f32 v207, v222, v223
    v_cvt_pk_bf16_f32 v224, v224, v225
    s_add_u32 s100, s77, 4096
    s_add_u32 m0, m0, 4096
    s_nop 0
    buffer_load_dwordx4 v1, s[36:39], s100 offen sc1 lds
    v_cvt_pk_bf16_f32 v225, v226, v227
    v_cvt_pk_bf16_f32 v226, v240, v241
    v_cvt_pk_bf16_f32 v227, v242, v243
    v_cvt_pk_bf16_f32 v228, v228, v229
    v_cvt_pk_bf16_f32 v229, v230, v231
    v_cvt_pk_bf16_f32 v230, v244, v245
    v_cvt_pk_bf16_f32 v231, v246, v247
    v_cvt_pk_bf16_f32 v232, v232, v233
    v_cvt_pk_bf16_f32 v233, v234, v235
    v_cvt_pk_bf16_f32 v234, v248, v249
    v_cvt_pk_bf16_f32 v235, v250, v251
    v_cvt_pk_bf16_f32 v236, v236, v237
    v_cvt_pk_bf16_f32 v237, v238, v239
    v_cvt_pk_bf16_f32 v238, v252, v253
    v_cvt_pk_bf16_f32 v239, v254, v255
    buffer_store_dwordx4 v[32:35], v1, s[56:59], s71 offen offset:0 sc1
    buffer_load_dwordx4 v1, s[36:39], s100 offen offset:1024 sc1 lds
    buffer_store_dwordx4 v[36:39], v1, s[56:59], s71 offen offset:1024 sc1
    v_mov_b32 v8, 0x3f803f80
    v_accvgpr_write_b32 a136, v8
    v_accvgpr_write_b32 a137, v8
    v_accvgpr_write_b32 a138, v8
    v_accvgpr_write_b32 a139, v8
    v_bfe_u32 v8, v1, 4, 4
    v_lshrrev_b32 v9, 8, v1
    v_lshlrev_b32 v9, 2, v9
    v_sub_u32 v8, v8, v9
    v_mov_b32 v9, 0xf149f2ca
    v_cmp_le_i32 vcc, 0, v8
    s_cmp_eq_u32 s4, 0
    s_cselect_b32 s8, 1.0, 0
    v_cndmask_b32_e64 v208, v9, 0, vcc
    buffer_load_dwordx4 v1, s[36:39], s100 offen offset:2048 sc1 lds
    s_cmp_lt_u32 s4, 0
    s_cselect_b32 s12, 0xf149f2ca, 0
    v_cmp_le_i32 vcc, 1, v8
    s_cmp_eq_u32 s4, 1
    s_cselect_b32 s9, 1.0, 0
    v_cndmask_b32_e64 v209, v9, 0, vcc
    s_cmp_lt_u32 s4, 1
    s_cselect_b32 s13, 0xf149f2ca, 0
    v_cmp_le_i32 vcc, 2, v8
    s_cmp_eq_u32 s4, 2
    s_cselect_b32 s10, 1.0, 0
    v_cndmask_b32_e64 v210, v9, 0, vcc
    s_cmp_lt_u32 s4, 2
    s_cselect_b32 s14, 0xf149f2ca, 0
    v_cmp_le_i32 vcc, 3, v8
    s_cmp_eq_u32 s4, 3
    s_cselect_b32 s11, 1.0, 0
    buffer_load_dwordx4 v1, s[36:39], s100 offen offset:3072 sc1 lds
    s_add_u32 s77, s77, 32768
    s_add_u32 s76, s76, 32768
    v_cndmask_b32_e64 v211, v9, 0, vcc
    s_cmp_lt_u32 s4, 3
    s_cselect_b32 s15, 0xf149f2ca, 0
    s_lshl3_add_u32 s80, s6, s4
    s_mul_i32 s80, s80, 149504
    s_sub_u32 s7, 15, s6
    s_lshl3_add_u32 s81, s7, s4
    s_mul_i32 s81, s81, 149504
    s_lshl_b32 s7, s5, 12
    s_add_u32 s80, s80, s7
    s_add_u32 s81, s81, s7
    s_mov_b32 s92, 0x55555555
    s_mov_b32 s93, 0x55555555
    s_load_dwordx2 s[24:25], s[0:1], 80
    s_mov_b32 s26, 2359296
    s_mov_b32 s27, 0x20000
K1_ATT:
    s_mov_b32 s82, 0
    s_mov_b32 s60, 131072
    v_mov_b32 v2, v1
    v_mov_b32 v11, 0
    s_cmp_eq_u32 s6, 0
    s_cselect_b32 s16, s8, 0
    s_cselect_b32 s17, s9, 0
    s_cselect_b32 s18, s10, 0
    s_cselect_b32 s19, s11, 0
    s_cselect_b32 s20, s12, 0
    s_cselect_b32 s21, s13, 0
    s_cselect_b32 s22, s14, 0
    s_cselect_b32 s23, s15, 0
    s_waitcnt vmcnt(8) lgkmcnt(0)
    s_barrier
    ds_read_b128 a[224:227], v2 offset:0
    ds_read_b128 a[228:231], v2 offset:1024
    ds_read_b128 a[232:235], v2 offset:2048
    ds_read_b128 a[236:239], v2 offset:3072
    ds_read_b128 v[96:99], v2 offset:16384
    ds_read_b128 v[100:103], v2 offset:17408
    s_cmp_lg_u32 s83, 0
    s_cbranch_scc1 K1_HAVEM_R
    s_add_u32 m0, s76, s75
    s_nop 0
    buffer_load_dwordx4 v1, s[36:39], s77 offen sc1 lds
    v_mul_f32 v176, s16, v208
    v_mul_f32 v177, s16, v209
    v_mul_f32 v178, s16, v210
    v_mul_f32 v179, s16, v211
    s_waitcnt lgkmcnt(2)
    buffer_load_dwordx4 v1, s[36:39], s77 offen offset:1024 sc1 lds
    v_mfma_f32_16x16x32_bf16 v[240:243], a[224:227], v[128:131], v[176:179]
    v_mfma_f32_16x16x32_bf16 v[240:243], a[228:231], v[160:163], v[240:243]
    v_mfma_f32_16x16x32_bf16 v[240:243], a[232:235], v[192:195], v[240:243]
    v_mfma_f32_16x16x32_bf16 v[240:243], a[236:239], v[224:227], v[240:243]
    v_mfma_f32_16x16x32_bf16 v[244:247], a[224:227], v[132:135], 0
    buffer_load_dwordx4 v1, s[36:39], s77 offen offset:2048 sc1 lds
    v_mfma_f32_16x16x32_bf16 v[244:247], a[228:231], v[164:167], v[244:247]
    v_mfma_f32_16x16x32_bf16 v[244:247], a[232:235], v[196:199], v[244:247]
    v_mfma_f32_16x16x32_bf16 v[244:247], a[236:239], v[228:231], v[244:247]
    v_mfma_f32_16x16x32_bf16 v[248:251], a[224:227], v[136:139], 0
    v_mfma_f32_16x16x32_bf16 v[248:251], a[228:231], v[168:171], v[248:251]
    buffer_load_dwordx4 v1, s[36:39], s77 offen offset:3072 sc1 lds
    s_add_u32 s100, s77, 4096
    v_mfma_f32_16x16x32_bf16 v[248:251], a[232:235], v[200:203], v[248:251]
    v_mfma_f32_16x16x32_bf16 v[248:251], a[236:239], v[232:235], v[248:251]
    v_mfma_f32_16x16x32_bf16 v[252:255], a[224:227], v[140:143], 0
    v_mfma_f32_16x16x32_bf16 v[252:255], a[228:231], v[172:175], v[252:255]
    v_mfma_f32_16x16x32_bf16 v[252:255], a[232:235], v[204:207], v[252:255]
    v_mfma_f32_16x16x32_bf16 v[252:255], a[236:239], v[236:239], v[252:255]
    s_add_u32 m0, m0, 4096
    s_nop 0
    buffer_load_dwordx4 v1, s[36:39], s100 offen sc1 lds
    v_max3_f32 v240, v240, v241, v242
    v_max_f32 v240, v240, v243
    v_max3_f32 v244, v244, v245, v246
    v_max_f32 v244, v244, v247
    v_max3_f32 v248, v248, v249, v250
    v_max_f32 v248, v248, v251
    v_max3_f32 v252, v252, v253, v254
    v_max_f32 v252, v252, v255
    v_mov_b32 v241, v240
    v_mov_b32 v245, v244
    v_mov_b32 v249, v248
    v_mov_b32 v253, v252
    buffer_load_dwordx4 v1, s[36:39], s100 offen offset:1024 sc1 lds
    v_permlane32_swap_b32 v240, v241
    v_permlane32_swap_b32 v244, v245
    v_permlane32_swap_b32 v248, v249
    v_permlane32_swap_b32 v252, v253
    v_max_f32 v240, v240, v241
    v_max_f32 v244, v244, v245
    v_max_f32 v248, v248, v249
    v_max_f32 v252, v252, v253
    v_mov_b32 v241, v240
    v_mov_b32 v245, v244
    v_mov_b32 v249, v248
    v_mov_b32 v253, v252
    buffer_load_dwordx4 v1, s[36:39], s100 offen offset:2048 sc1 lds
    v_permlane16_swap_b32 v240, v241
    v_permlane16_swap_b32 v244, v245
    v_permlane16_swap_b32 v248, v249
    v_permlane16_swap_b32 v252, v253
    v_max_f32 v240, v240, v241
    v_max_f32 v244, v244, v245
    v_max_f32 v248, v248, v249
    v_max_f32 v252, v252, v253
    v_sub_f32 v144, 0, v240
    v_sub_f32 v145, 0, v240
    v_sub_f32 v146, 0, v240
    v_sub_f32 v147, 0, v240
    buffer_load_dwordx4 v1, s[36:39], s100 offen offset:3072 sc1 lds
    s_add_u32 s77, s77, 32768
    s_add_u32 s76, s76, 32768
    v_sub_f32 v148, 0, v244
    v_sub_f32 v149, 0, v244
    v_sub_f32 v150, 0, v244
    v_sub_f32 v151, 0, v244
    v_sub_f32 v152, 0, v248
    v_sub_f32 v153, 0, v248
    v_sub_f32 v154, 0, v248
    v_sub_f32 v155, 0, v248
    v_sub_f32 v156, 0, v252
    v_sub_f32 v157, 0, v252
    v_sub_f32 v158, 0, v252
    v_sub_f32 v159, 0, v252
K1_HAVEM:
    v_add_f32 v212, s20, v144
    v_fma_f32 v176, v208, s16, v212
    v_fma_f32 v177, v209, s16, v212
    v_fma_f32 v178, v210, s16, v212
    v_fma_f32 v179, v211, s16, v212
    s_nop 1
    s_waitcnt lgkmcnt(0)
    v_mfma_f32_16x16x32_bf16 v[240:243], a[224:227], v[128:131], v[176:179]
    s_add_u32 m0, s76, s75
    ds_read_b128 a[240:243], v2 offset:4096
    ds_read_b128 a[244:247], v2 offset:5120
    v_mfma_f32_16x16x32_bf16 v[240:243], a[228:231], v[160:163], v[240:243]
    s_mov_b32 s76, s60
    buffer_load_dwordx4 v1, s[36:39], s77 offen sc1 lds
    v_mfma_f32_16x16x32_bf16 v[240:243], a[232:235], v[192:195], v[240:243]
    s_mov_b32 s60, s82
    ds_read_b128 a[248:251], v2 offset:6144
    ds_read_b128 a[252:255], v2 offset:7168
    v_mfma_f32_16x16x32_bf16 v[240:243], a[236:239], v[224:227], v[240:243]
    s_add_u32 s82, s82, 32768
    v_add_f32 v213, s21, v144
    v_fma_f32 v180, v208, s17, v213
    v_mfma_f32_16x16x32_bf16 v[244:247], a[224:227], v[132:135], v[148:151]
    v_fma_f32 v181, v209, s17, v213
    v_fma_f32 v182, v210, s17, v213
    v_mfma_f32_16x16x32_bf16 v[244:247], a[228:231], v[164:167], v[244:247]
    v_fma_f32 v183, v211, s17, v213
    v_add_f32 v214, s22, v144
    v_mfma_f32_16x16x32_bf16 v[244:247], a[232:235], v[196:199], v[244:247]
    buffer_load_dwordx4 v1, s[36:39], s77 offen offset:1024 sc1 lds
    v_mfma_f32_16x16x32_bf16 v[244:247], a[236:239], v[228:231], v[244:247]
    v_exp_f32 v240, v240
    v_mfma_f32_16x16x32_bf16 v[248:251], a[224:227], v[136:139], v[152:155]
    v_exp_f32 v241, v241
    v_mfma_f32_16x16x32_bf16 v[248:251], a[228:231], v[168:171], v[248:251]
    v_exp_f32 v242, v242
    v_mfma_f32_16x16x32_bf16 v[248:251], a[232:235], v[200:203], v[248:251]
    v_exp_f32 v243, v243
    v_mfma_f32_16x16x32_bf16 v[248:251], a[236:239], v[232:235], v[248:251]
    buffer_load_dwordx4 v1, s[36:39], s77 offen offset:2048 sc1 lds
    v_mfma_f32_16x16x32_bf16 v[252:255], a[224:227], v[140:143], v[156:159]
    v_cvt_pk_bf16_f32 v32, v240, v241
    v_cvt_pk_bf16_f32 v33, v242, v243
    v_mfma_f32_16x16x32_bf16 v[252:255], a[228:231], v[172:175], v[252:255]
    v_exp_f32 v244, v244
    v_mfma_f32_16x16x32_bf16 v[252:255], a[232:235], v[204:207], v[252:255]
    v_exp_f32 v245, v245
    v_mfma_f32_16x16x32_bf16 v[252:255], a[236:239], v[236:239], v[252:255]
    s_waitcnt lgkmcnt(0)
    v_exp_f32 v246, v246
    v_mfma_f32_16x16x32_bf16 v[240:243], a[240:243], v[128:131], v[180:183]
    v_exp_f32 v247, v247
    v_mfma_f32_16x16x32_bf16 v[240:243], a[244:247], v[160:163], v[240:243]
    buffer_load_dwordx4 v1, s[36:39], s77 offen offset:3072 sc1 lds
    v_mfma_f32_16x16x32_bf16 v[240:243], a[248:251], v[192:195], v[240:243]
    v_cvt_pk_bf16_f32 v40, v244, v245
    v_cvt_pk_bf16_f32 v41, v246, v247
    v_mfma_f32_16x16x32_bf16 v[240:243], a[252:255], v[224:227], v[240:243]
    v_exp_f32 v248, v248
    v_mfma_f32_16x16x32_bf16 v[244:247], a[240:243], v[132:135], v[148:151]
    v_exp_f32 v249, v249
    v_mfma_f32_16x16x32_bf16 v[244:247], a[244:247], v[164:167], v[244:247]
    s_add_u32 s100, s77, 4096
    v_exp_f32 v250, v250
    v_mfma_f32_16x16x32_bf16 v[244:247], a[248:251], v[196:199], v[244:247]
    s_add_u32 m0, m0, 4096
    v_exp_f32 v251, v251
    v_mfma_f32_16x16x32_bf16 v[244:247], a[252:255], v[228:231], v[244:247]
    v_cvt_pk_bf16_f32 v48, v248, v249
    v_cvt_pk_bf16_f32 v49, v250, v251
    v_mfma_f32_16x16x32_bf16 v[248:251], a[240:243], v[136:139], v[152:155]
    ds_read_b128 a[224:227], v2 offset:8192
    ds_read_b128 a[228:231], v2 offset:9216
    v_mfma_f32_16x16x32_bf16 v[248:251], a[244:247], v[168:171], v[248:251]
    buffer_load_dwordx4 v1, s[36:39], s100 offen sc1 lds
    v_mfma_f32_16x16x32_bf16 v[248:251], a[248:251], v[200:203], v[248:251]
    v_exp_f32 v252, v252
    v_mfma_f32_16x16x32_bf16 v[248:251], a[252:255], v[232:235], v[248:251]
    v_exp_f32 v253, v253
    v_exp_f32 v254, v254
    v_exp_f32 v255, v255
    v_cvt_pk_bf16_f32 v56, v252, v253
    v_cvt_pk_bf16_f32 v57, v254, v255
    v_mfma_f32_16x16x32_bf16 v[252:255], a[240:243], v[140:143], v[156:159]
    ds_read_b128 a[232:235], v2 offset:10240
    ds_read_b128 a[236:239], v2 offset:11264
    v_mfma_f32_16x16x32_bf16 v[252:255], a[244:247], v[172:175], v[252:255]
    buffer_load_dwordx4 v1, s[36:39], s100 offen offset:1024 sc1 lds
    v_mfma_f32_16x16x32_bf16 v[252:255], a[248:251], v[204:207], v[252:255]
    v_exp_f32 v240, v240
    v_mfma_f32_16x16x32_bf16 v[252:255], a[252:255], v[236:239], v[252:255]
    s_waitcnt lgkmcnt(2)
    v_exp_f32 v241, v241
    v_exp_f32 v242, v242
    v_exp_f32 v243, v243
    v_fma_f32 v184, v208, s18, v214
    v_fma_f32 v185, v209, s18, v214
    v_fma_f32 v186, v210, s18, v214
    v_fma_f32 v187, v211, s18, v214
    v_cvt_pk_bf16_f32 v34, v240, v241
    v_cvt_pk_bf16_f32 v35, v242, v243
    v_mfma_f32_16x16x32_bf16 v[240:243], a[224:227], v[128:131], v[184:187]
    v_exp_f32 v244, v244
    v_mfma_f32_16x16x32_bf16 v[240:243], a[228:231], v[160:163], v[240:243]
    s_waitcnt lgkmcnt(0)
    v_exp_f32 v245, v245
    v_mfma_f32_16x16x32_bf16 v[240:243], a[232:235], v[192:195], v[240:243]
    v_exp_f32 v246, v246
    v_mfma_f32_16x16x32_bf16 v[240:243], a[236:239], v[224:227], v[240:243]
    v_exp_f32 v247, v247
    v_cvt_pk_bf16_f32 v42, v244, v245
    v_cvt_pk_bf16_f32 v43, v246, v247
    v_mfma_f32_16x16x32_bf16 v[244:247], a[224:227], v[132:135], v[148:151]
    buffer_load_dwordx4 v1, s[36:39], s100 offen offset:2048 sc1 lds
    v_mfma_f32_16x16x32_bf16 v[244:247], a[228:231], v[164:167], v[244:247]
    v_exp_f32 v248, v248
    v_mfma_f32_16x16x32_bf16 v[244:247], a[232:235], v[196:199], v[244:247]
    v_exp_f32 v249, v249
    v_mfma_f32_16x16x32_bf16 v[244:247], a[236:239], v[228:231], v[244:247]
    v_exp_f32 v250, v250
    v_exp_f32 v251, v251
    v_cvt_pk_bf16_f32 v50, v248, v249
    v_cvt_pk_bf16_f32 v51, v250, v251
    v_mfma_f32_16x16x32_bf16 v[248:251], a[224:227], v[136:139], v[152:155]
    buffer_load_dwordx4 v1, s[36:39], s100 offen offset:3072 sc1 lds
    v_mfma_f32_16x16x32_bf16 v[248:251], a[228:231], v[168:171], v[248:251]
    ds_read_b128 a[240:243], v2 offset:12288
    ds_read_b128 a[244:247], v2 offset:13312
    v_mfma_f32_16x16x32_bf16 v[248:251], a[232:235], v[200:203], v[248:251]
    s_add_u32 s77, s77, 32768
    v_exp_f32 v252, v252
    v_mfma_f32_16x16x32_bf16 v[248:251], a[236:239], v[232:235], v[248:251]
    v_exp_f32 v253, v253
    v_exp_f32 v254, v254
    v_exp_f32 v255, v255
    v_cvt_pk_bf16_f32 v58, v252, v253
    v_cvt_pk_bf16_f32 v59, v254, v255
    v_mfma_f32_16x16x32_bf16 v[252:255], a[224:227], v[140:143], v[156:159]
    ds_read_b128 a[248:251], v2 offset:14336
    ds_read_b128 a[252:255], v2 offset:15360
    v_mfma_f32_16x16x32_bf16 v[252:255], a[228:231], v[172:175], v[252:255]
    v_add_f32 v215, s23, v144
    v_fma_f32 v188, v208, s19, v215
    v_mfma_f32_16x16x32_bf16 v[252:255], a[232:235], v[204:207], v[252:255]
    v_exp_f32 v240, v240
    v_mfma_f32_16x16x32_bf16 v[252:255], a[236:239], v[236:239], v[252:255]
    s_waitcnt lgkmcnt(2)
    v_exp_f32 v241, v241
    v_exp_f32 v242, v242
    v_exp_f32 v243, v243
    v_fma_f32 v189, v209, s19, v215
    v_fma_f32 v190, v210, s19, v215
    v_fma_f32 v191, v211, s19, v215
    v_cvt_pk_bf16_f32 v36, v240, v241
    v_cvt_pk_bf16_f32 v37, v242, v243
    v_mfma_f32_16x16x32_bf16 v[240:243], a[240:243], v[128:131], v[188:191]
    v_exp_f32 v244, v244
    v_mfma_f32_16x16x32_bf16 v[240:243], a[244:247], v[160:163], v[240:243]
    s_cmp_eq_u32 s82, 163840
    s_cselect_b32 s82, 0, s82
    v_add_u32 v2, s82, v1
    s_waitcnt lgkmcnt(0)
    v_mfma_f32_16x16x32_bf16 v[240:243], a[248:251], v[192:195], v[240:243]
    v_exp_f32 v245, v245
    v_mfma_f32_16x16x32_bf16 v[240:243], a[252:255], v[224:227], v[240:243]
    s_waitcnt vmcnt(16)
    s_barrier
    v_cvt_pk_bf16_f32 v44, v244, v245
    v_exp_f32 v246, v246
    v_exp_f32 v247, v247
    s_nop 0
    v_cvt_pk_bf16_f32 v45, v246, v247
    v_mfma_f32_16x16x32_bf16 v[244:247], a[240:243], v[132:135], v[148:151]
    ds_read_b128 a[224:227], v2 offset:0
    ds_read_b128 a[228:231], v2 offset:1024
    v_mfma_f32_16x16x32_bf16 v[244:247], a[244:247], v[164:167], v[244:247]
    v_exp_f32 v248, v248
    v_mfma_f32_16x16x32_bf16 v[244:247], a[248:251], v[196:199], v[244:247]
    v_exp_f32 v249, v249
    v_mfma_f32_16x16x32_bf16 v[244:247], a[252:255], v[228:231], v[244:247]
    v_exp_f32 v250, v250
    v_exp_f32 v251, v251
    v_cvt_pk_bf16_f32 v52, v248, v249
    v_cvt_pk_bf16_f32 v53, v250, v251
    v_mfma_f32_16x16x32_bf16 v[248:251], a[240:243], v[136:139], v[152:155]
    ds_read_b128 a[232:235], v2 offset:2048
    ds_read_b128 a[236:239], v2 offset:3072
    v_mfma_f32_16x16x32_bf16 v[248:251], a[244:247], v[168:171], v[248:251]
    ds_read_b128 v[96:99], v2 offset:16384
    ds_read_b128 v[100:103], v2 offset:17408
    v_mfma_f32_16x16x32_bf16 v[248:251], a[248:251], v[200:203], v[248:251]
    v_exp_f32 v252, v252
    v_mfma_f32_16x16x32_bf16 v[248:251], a[252:255], v[232:235], v[248:251]
    v_exp_f32 v253, v253
    v_exp_f32 v254, v254
    v_exp_f32 v255, v255
    v_cvt_pk_bf16_f32 v60, v252, v253
    v_cvt_pk_bf16_f32 v61, v254, v255
    v_mfma_f32_16x16x32_bf16 v[252:255], a[240:243], v[140:143], v[156:159]
    v_exp_f32 v240, v240
    v_mfma_f32_16x16x32_bf16 v[252:255], a[244:247], v[172:175], v[252:255]
    v_exp_f32 v241, v241
    v_mfma_f32_16x16x32_bf16 v[252:255], a[248:251], v[204:207], v[252:255]
    v_exp_f32 v242, v242
    v_mfma_f32_16x16x32_bf16 v[252:255], a[252:255], v[236:239], v[252:255]
    v_exp_f32 v243, v243
    v_exp_f32 v244, v244
    v_exp_f32 v245, v245
    v_exp_f32 v246, v246
    v_exp_f32 v247, v247
    v_exp_f32 v248, v248
    v_exp_f32 v249, v249
    v_exp_f32 v250, v250
    v_exp_f32 v251, v251
    v_exp_f32 v252, v252
    v_exp_f32 v253, v253
    v_cvt_pk_bf16_f32 v38, v240, v241
    v_cvt_pk_bf16_f32 v39, v242, v243
    v_cvt_pk_bf16_f32 v46, v244, v245
    v_cvt_pk_bf16_f32 v47, v246, v247
    v_cvt_pk_bf16_f32 v54, v248, v249
    v_cvt_pk_bf16_f32 v55, v250, v251
    v_cvt_pk_bf16_f32 v62, v252, v253
    v_mov_b32 v9, 1
    s_mov_b32 s78, s6
    buffer_atomic_add v9, v30, s[44:47], s95 offen sc1
    s_cmp_eq_u32 s78, 0
    s_cbranch_scc1 K1_LB_END
.p2align 3
K1_LB:
    s_waitcnt lgkmcnt(0)
    v_mfma_f32_16x16x32_bf16 v[240:243], a[224:227], v[128:131], v[176:179]
    s_add_u32 m0, s76, s75
    v_exp_f32 v254, v254
    v_mfma_f32_16x16x32_bf16 v[240:243], a[228:231], v[160:163], v[240:243]
    s_mov_b32 s76, s60
    buffer_load_dwordx4 v1, s[36:39], s77 offen sc1 lds
    v_mfma_f32_16x16x32_bf16 v[240:243], a[232:235], v[192:195], v[240:243]
    s_mov_b32 s60, s82
    v_exp_f32 v255, v255
    v_mfma_f32_16x16x32_bf16 v[240:243], a[236:239], v[224:227], v[240:243]
    s_add_u32 s82, s82, 32768
    ds_read_b128 v[104:107], v2 offset:18432
    v_cvt_pk_bf16_f32 v63, v254, v255
    v_mfma_f32_16x16x32_bf16 a[0:3], v[96:99], v[32:35], a[0:3]
    ds_read_b128 v[108:111], v2 offset:19456
    ds_read_b128 a[240:243], v2 offset:4096
    v_mfma_f32_16x16x32_bf16 a[0:3], v[100:103], v[36:39], a[0:3]
    ds_read_b128 a[244:247], v2 offset:5120
    ds_read_b128 a[248:251], v2 offset:6144
    v_mfma_f32_16x16x32_bf16 a[4:7], v[96:99], v[40:43], a[4:7]
    ds_read_b128 a[252:255], v2 offset:7168
    ds_read_b128 v[112:115], v2 offset:20480
    v_mfma_f32_16x16x32_bf16 a[4:7], v[100:103], v[44:47], a[4:7]
    ds_read_b128 v[116:119], v2 offset:21504
    ds_read_b128 v[120:123], v2 offset:22528
    v_mfma_f32_16x16x32_bf16 v[244:247], a[224:227], v[132:135], v[148:151]
    v_exp_f32 v240, v240
    v_mfma_f32_16x16x32_bf16 v[244:247], a[228:231], v[164:167], v[244:247]
    v_exp_f32 v241, v241
    v_mfma_f32_16x16x32_bf16 v[244:247], a[232:235], v[196:199], v[244:247]
    v_exp_f32 v242, v242
    v_mfma_f32_16x16x32_bf16 v[244:247], a[236:239], v[228:231], v[244:247]
    v_exp_f32 v243, v243
    v_mfma_f32_16x16x32_bf16 a[8:11], v[96:99], v[48:51], a[8:11]
    v_cvt_pk_bf16_f32 v64, v240, v241
    v_cvt_pk_bf16_f32 v65, v242, v243
    v_mfma_f32_16x16x32_bf16 a[8:11], v[100:103], v[52:55], a[8:11]
    ds_read_b128 v[124:127], v2 offset:23552
    v_mfma_f32_16x16x32_bf16 a[12:15], v[96:99], v[56:59], a[12:15]
    ds_read_b128 v[96:99], v2 offset:24576
    v_mfma_f32_16x16x32_bf16 a[12:15], v[100:103], v[60:63], a[12:15]
    buffer_load_dwordx4 v1, s[36:39], s77 offen offset:1024 sc1 lds
    v_mfma_f32_16x16x32_bf16 v[248:251], a[224:227], v[136:139], v[152:155]
    v_exp_f32 v244, v244
    v_mfma_f32_16x16x32_bf16 v[248:251], a[228:231], v[168:171], v[248:251]
    v_exp_f32 v245, v245
    v_mfma_f32_16x16x32_bf16 v[248:251], a[232:235], v[200:203], v[248:251]
    v_exp_f32 v246, v246
    v_mfma_f32_16x16x32_bf16 v[248:251], a[236:239], v[232:235], v[248:251]
    s_waitcnt lgkmcnt(0)
    v_exp_f32 v247, v247
    v_mfma_f32_16x16x32_bf16 a[16:19], v[104:107], v[32:35], a[16:19]
    v_cvt_pk_bf16_f32 v72, v244, v245
    v_cvt_pk_bf16_f32 v73, v246, v247
    v_mfma_f32_16x16x32_bf16 a[16:19], v[108:111], v[36:39], a[16:19]
    ds_read_b128 v[100:103], v2 offset:25600
    v_mfma_f32_16x16x32_bf16 a[20:23], v[104:107], v[40:43], a[20:23]
    v_mfma_f32_16x16x32_bf16 a[20:23], v[108:111], v[44:47], a[20:23]
    v_exp_f32 v248, v248
    v_mfma_f32_16x16x32_bf16 v[252:255], a[224:227], v[140:143], v[156:159]
    v_exp_f32 v249, v249
    v_mfma_f32_16x16x32_bf16 v[252:255], a[228:231], v[172:175], v[252:255]
    v_exp_f32 v250, v250
    v_mfma_f32_16x16x32_bf16 v[252:255], a[232:235], v[204:207], v[252:255]
    v_exp_f32 v251, v251
    v_mfma_f32_16x16x32_bf16 v[252:255], a[236:239], v[236:239], v[252:255]
    v_cvt_pk_bf16_f32 v80, v248, v249
    v_cvt_pk_bf16_f32 v81, v250, v251
    v_mfma_f32_16x16x32_bf16 a[24:27], v[104:107], v[48:51], a[24:27]
    ds_read_b128 a[224:227], v2 offset:8192
    ds_read_b128 a[228:231], v2 offset:9216
    v_mfma_f32_16x16x32_bf16 a[24:27], v[108:111], v[52:55], a[24:27]
    buffer_load_dwordx4 v1, s[36:39], s77 offen offset:2048 sc1 lds
    v_mfma_f32_16x16x32_bf16 a[28:31], v[104:107], v[56:59], a[28:31]
    v_exp_f32 v252, v252
    v_mfma_f32_16x16x32_bf16 a[28:31], v[108:111], v[60:63], a[28:31]
    v_exp_f32 v253, v253
    v_mfma_f32_16x16x32_bf16 v[240:243], a[240:243], v[128:131], v[180:183]
    v_exp_f32 v254, v254
    v_mfma_f32_16x16x32_bf16 v[240:243], a[244:247], v[160:163], v[240:243]
    v_exp_f32 v255, v255
    v_mfma_f32_16x16x32_bf16 v[240:243], a[248:251], v[192:195], v[240:243]
    v_cvt_pk_bf16_f32 v88, v252, v253
    v_cvt_pk_bf16_f32 v89, v254, v255
    v_mfma_f32_16x16x32_bf16 v[240:243], a[252:255], v[224:227], v[240:243]
    ds_read_b128 a[232:235], v2 offset:10240
    ds_read_b128 a[236:239], v2 offset:11264
    v_mfma_f32_16x16x32_bf16 a[32:35], v[112:115], v[32:35], a[32:35]
    ds_read_b128 v[104:107], v2 offset:26624
    ds_read_b128 v[108:111], v2 offset:27648
    v_mfma_f32_16x16x32_bf16 a[32:35], v[116:119], v[36:39], a[32:35]
    v_mfma_f32_16x16x32_bf16 a[36:39], v[112:115], v[40:43], a[36:39]
    v_mfma_f32_16x16x32_bf16 a[36:39], v[116:119], v[44:47], a[36:39]
    v_exp_f32 v240, v240
    v_mfma_f32_16x16x32_bf16 v[244:247], a[240:243], v[132:135], v[148:151]
    v_exp_f32 v241, v241
    v_mfma_f32_16x16x32_bf16 v[244:247], a[244:247], v[164:167], v[244:247]
    v_exp_f32 v242, v242
    v_mfma_f32_16x16x32_bf16 v[244:247], a[248:251], v[196:199], v[244:247]
    v_exp_f32 v243, v243
    v_mfma_f32_16x16x32_bf16 v[244:247], a[252:255], v[228:231], v[244:247]
    buffer_load_dwordx4 v1, s[36:39], s77 offen offset:3072 sc1 lds
    v_mfma_f32_16x16x32_bf16 a[40:43], v[112:115], v[48:51], a[40:43]
    v_cvt_pk_bf16_f32 v66, v240, v241
    v_cvt_pk_bf16_f32 v67, v242, v243
    v_mfma_f32_16x16x32_bf16 a[40:43], v[116:119], v[52:55], a[40:43]
    v_mfma_f32_16x16x32_bf16 a[44:47], v[112:115], v[56:59], a[44:47]
    ds_read_b128 v[112:115], v2 offset:28672
    v_mfma_f32_16x16x32_bf16 a[44:47], v[116:119], v[60:63], a[44:47]
    v_exp_f32 v244, v244
    v_mfma_f32_16x16x32_bf16 v[248:251], a[240:243], v[136:139], v[152:155]
    v_exp_f32 v245, v245
    v_mfma_f32_16x16x32_bf16 v[248:251], a[244:247], v[168:171], v[248:251]
    v_exp_f32 v246, v246
    v_mfma_f32_16x16x32_bf16 v[248:251], a[248:251], v[200:203], v[248:251]
    v_exp_f32 v247, v247
    v_mfma_f32_16x16x32_bf16 v[248:251], a[252:255], v[232:235], v[248:251]
    v_cvt_pk_bf16_f32 v74, v244, v245
    v_cvt_pk_bf16_f32 v75, v246, v247
    v_mfma_f32_16x16x32_bf16 a[48:51], v[120:123], v[32:35], a[48:51]
    ds_read_b128 v[116:119], v2 offset:29696
    v_mfma_f32_16x16x32_bf16 a[48:51], v[124:127], v[36:39], a[48:51]
    v_mfma_f32_16x16x32_bf16 a[52:55], v[120:123], v[40:43], a[52:55]
    v_mfma_f32_16x16x32_bf16 a[52:55], v[124:127], v[44:47], a[52:55]
    v_mfma_f32_16x16x32_bf16 v[252:255], a[240:243], v[140:143], v[156:159]
    v_exp_f32 v248, v248
    v_mfma_f32_16x16x32_bf16 v[252:255], a[244:247], v[172:175], v[252:255]
    s_add_u32 s100, s77, 4096
    v_exp_f32 v249, v249
    v_mfma_f32_16x16x32_bf16 v[252:255], a[248:251], v[204:207], v[252:255]
    s_add_u32 m0, m0, 4096
    v_exp_f32 v250, v250
    v_mfma_f32_16x16x32_bf16 v[252:255], a[252:255], v[236:239], v[252:255]
    buffer_load_dwordx4 v1, s[36:39], s100 offen sc1 lds
    v_mfma_f32_16x16x32_bf16 a[56:59], v[120:123], v[48:51], a[56:59]
    v_exp_f32 v251, v251
    v_mfma_f32_16x16x32_bf16 a[56:59], v[124:127], v[52:55], a[56:59]
    v_cvt_pk_bf16_f32 v82, v248, v249
    v_cvt_pk_bf16_f32 v83, v250, v251
    v_mfma_f32_16x16x32_bf16 a[60:63], v[120:123], v[56:59], a[60:63]
    ds_read_b128 a[240:243], v2 offset:12288
    ds_read_b128 a[244:247], v2 offset:13312
    v_mfma_f32_16x16x32_bf16 a[60:63], v[124:127], v[60:63], a[60:63]
    s_waitcnt lgkmcnt(2)
    v_exp_f32 v252, v252
    v_mfma_f32_16x16x32_bf16 v[240:243], a[224:227], v[128:131], v[184:187]
    v_exp_f32 v253, v253
    v_mfma_f32_16x16x32_bf16 v[240:243], a[228:231], v[160:163], v[240:243]
    v_exp_f32 v254, v254
    v_mfma_f32_16x16x32_bf16 v[240:243], a[232:235], v[192:195], v[240:243]
    v_exp_f32 v255, v255
    v_mfma_f32_16x16x32_bf16 v[240:243], a[236:239], v[224:227], v[240:243]
    v_cvt_pk_bf16_f32 v90, v252, v253
    v_cvt_pk_bf16_f32 v91, v254, v255
    v_mfma_f32_16x16x32_bf16 a[144:147], v[96:99], v[32:35], a[144:147]
    ds_read_b128 a[248:251], v2 offset:14336
    ds_read_b128 a[252:255], v2 offset:15360
    v_mfma_f32_16x16x32_bf16 a[144:147], v[100:103], v[36:39], a[144:147]
    ds_read_b128 v[120:123], v2 offset:30720
    ds_read_b128 v[124:127], v2 offset:31744
    v_mfma_f32_16x16x32_bf16 a[148:151], v[96:99], v[40:43], a[148:151]
    v_exp_f32 v240, v240
    v_mfma_f32_16x16x32_bf16 a[148:151], v[100:103], v[44:47], a[148:151]
    v_exp_f32 v241, v241
    v_mfma_f32_16x16x32_bf16 v[244:247], a[224:227], v[132:135], v[148:151]
    buffer_load_dwordx4 v1, s[36:39], s100 offen offset:1024 sc1 lds
    v_mfma_f32_16x16x32_bf16 v[244:247], a[228:231], v[164:167], v[244:247]
    v_exp_f32 v242, v242
    v_mfma_f32_16x16x32_bf16 v[244:247], a[232:235], v[196:199], v[244:247]
    v_exp_f32 v243, v243
    v_mfma_f32_16x16x32_bf16 v[244:247], a[236:239], v[228:231], v[244:247]
    v_cvt_pk_bf16_f32 v68, v240, v241
    v_cvt_pk_bf16_f32 v69, v242, v243
    v_mfma_f32_16x16x32_bf16 a[152:155], v[96:99], v[48:51], a[152:155]
    v_mfma_f32_16x16x32_bf16 a[152:155], v[100:103], v[52:55], a[152:155]
    v_mfma_f32_16x16x32_bf16 a[156:159], v[96:99], v[56:59], a[156:159]
    v_mfma_f32_16x16x32_bf16 a[156:159], v[100:103], v[60:63], a[156:159]
    v_mfma_f32_16x16x32_bf16 v[248:251], a[224:227], v[136:139], v[152:155]
    v_mfma_f32_16x16x32_bf16 v[248:251], a[228:231], v[168:171], v[248:251]
    v_exp_f32 v244, v244
    v_mfma_f32_16x16x32_bf16 v[248:251], a[232:235], v[200:203], v[248:251]
    v_exp_f32 v245, v245
    v_mfma_f32_16x16x32_bf16 v[248:251], a[236:239], v[232:235], v[248:251]
    v_exp_f32 v246, v246
    v_mfma_f32_16x16x32_bf16 a[160:163], v[104:107], v[32:35], a[160:163]
    v_exp_f32 v247, v247
    v_mfma_f32_16x16x32_bf16 a[160:163], v[108:111], v[36:39], a[160:163]
    v_cvt_pk_bf16_f32 v76, v244, v245
    v_cvt_pk_bf16_f32 v77, v246, v247
    v_mfma_f32_16x16x32_bf16 a[164:167], v[104:107], v[40:43], a[164:167]
    buffer_load_dwordx4 v1, s[36:39], s100 offen offset:2048 sc1 lds
    v_mfma_f32_16x16x32_bf16 a[164:167], v[108:111], v[44:47], a[164:167]
    v_exp_f32 v248, v248
    v_mfma_f32_16x16x32_bf16 v[252:255], a[224:227], v[140:143], v[156:159]
    v_exp_f32 v249, v249
    v_mfma_f32_16x16x32_bf16 v[252:255], a[228:231], v[172:175], v[252:255]
    v_exp_f32 v250, v250
    v_mfma_f32_16x16x32_bf16 v[252:255], a[232:235], v[204:207], v[252:255]
    v_exp_f32 v251, v251
    v_mfma_f32_16x16x32_bf16 v[252:255], a[236:239], v[236:239], v[252:255]
    v_cvt_pk_bf16_f32 v84, v248, v249
    v_cvt_pk_bf16_f32 v85, v250, v251
    v_mfma_f32_16x16x32_bf16 a[168:171], v[104:107], v[48:51], a[168:171]
    v_mfma_f32_16x16x32_bf16 a[168:171], v[108:111], v[52:55], a[168:171]
    v_mfma_f32_16x16x32_bf16 a[172:175], v[104:107], v[56:59], a[172:175]
    v_mfma_f32_16x16x32_bf16 a[172:175], v[108:111], v[60:63], a[172:175]
    s_waitcnt lgkmcnt(0)
    v_mfma_f32_16x16x32_bf16 v[240:243], a[240:243], v[128:131], v[188:191]
    v_mfma_f32_16x16x32_bf16 v[240:243], a[244:247], v[160:163], v[240:243]
    v_exp_f32 v252, v252
    v_mfma_f32_16x16x32_bf16 v[240:243], a[248:251], v[192:195], v[240:243]
    v_exp_f32 v253, v253
    v_mfma_f32_16x16x32_bf16 v[240:243], a[252:255], v[224:227], v[240:243]
    v_exp_f32 v254, v254
    v_mfma_f32_16x16x32_bf16 a[176:179], v[112:115], v[32:35], a[176:179]
    buffer_load_dwordx4 v1, s[36:39], s100 offen offset:3072 sc1 lds
    v_mfma_f32_16x16x32_bf16 a[176:179], v[116:119], v[36:39], a[176:179]
    v_exp_f32 v255, v255
    v_mfma_f32_16x16x32_bf16 a[180:183], v[112:115], v[40:43], a[180:183]
    v_cvt_pk_bf16_f32 v92, v252, v253
    v_cvt_pk_bf16_f32 v93, v254, v255
    v_mfma_f32_16x16x32_bf16 a[180:183], v[116:119], v[44:47], a[180:183]
    s_cmp_eq_u32 s82, 163840
    s_cselect_b32 s82, 0, s82
    v_add_u32 v2, s82, v1
    v_mfma_f32_16x16x32_bf16 v[244:247], a[240:243], v[132:135], v[148:151]
    v_exp_f32 v240, v240
    v_mfma_f32_16x16x32_bf16 v[244:247], a[244:247], v[164:167], v[244:247]
    v_exp_f32 v241, v241
    v_mfma_f32_16x16x32_bf16 v[244:247], a[248:251], v[196:199], v[244:247]
    v_exp_f32 v242, v242
    v_mfma_f32_16x16x32_bf16 v[244:247], a[252:255], v[228:231], v[244:247]
    v_exp_f32 v243, v243
    v_mfma_f32_16x16x32_bf16 a[184:187], v[112:115], v[48:51], a[184:187]
    v_cvt_pk_bf16_f32 v70, v240, v241
    v_cvt_pk_bf16_f32 v71, v242, v243
    v_mfma_f32_16x16x32_bf16 a[184:187], v[116:119], v[52:55], a[184:187]
    v_mfma_f32_16x16x32_bf16 a[188:191], v[112:115], v[56:59], a[188:191]
    v_mfma_f32_16x16x32_bf16 a[188:191], v[116:119], v[60:63], a[188:191]
    v_mfma_f32_16x16x32_bf16 v[248:251], a[240:243], v[136:139], v[152:155]
    v_exp_f32 v244, v244
    v_mfma_f32_16x16x32_bf16 v[248:251], a[244:247], v[168:171], v[248:251]
    v_exp_f32 v245, v245
    v_mfma_f32_16x16x32_bf16 v[248:251], a[248:251], v[200:203], v[248:251]
    s_add_u32 s77, s77, 32768
    v_exp_f32 v246, v246
    v_mfma_f32_16x16x32_bf16 v[248:251], a[252:255], v[232:235], v[248:251]
    v_exp_f32 v247, v247
    v_mfma_f32_16x16x32_bf16 a[192:195], v[120:123], v[32:35], a[192:195]
    v_cvt_pk_bf16_f32 v78, v244, v245
    v_cvt_pk_bf16_f32 v79, v246, v247
    v_mfma_f32_16x16x32_bf16 a[192:195], v[124:127], v[36:39], a[192:195]
    v_mfma_f32_16x16x32_bf16 a[196:199], v[120:123], v[40:43], a[196:199]
    v_mfma_f32_16x16x32_bf16 a[196:199], v[124:127], v[44:47], a[196:199]
    v_mfma_f32_16x16x32_bf16 v[252:255], a[240:243], v[140:143], v[156:159]
    v_exp_f32 v248, v248
    v_mfma_f32_16x16x32_bf16 v[252:255], a[244:247], v[172:175], v[252:255]
    v_exp_f32 v249, v249
    v_mfma_f32_16x16x32_bf16 v[252:255], a[248:251], v[204:207], v[252:255]
    v_exp_f32 v250, v250
    v_mfma_f32_16x16x32_bf16 v[252:255], a[252:255], v[236:239], v[252:255]
    s_waitcnt vmcnt(16)
    s_barrier
    ds_read_b128 a[224:227], v2 offset:0
    v_mfma_f32_16x16x32_bf16 a[200:203], v[120:123], v[48:51], a[200:203]
    ds_read_b128 a[228:231], v2 offset:1024
    ds_read_b128 a[232:235], v2 offset:2048
    v_mfma_f32_16x16x32_bf16 a[200:203], v[124:127], v[52:55], a[200:203]
    ds_read_b128 a[236:239], v2 offset:3072
    ds_read_b128 v[96:99], v2 offset:16384
    v_mfma_f32_16x16x32_bf16 a[204:207], v[120:123], v[56:59], a[204:207]
    ds_read_b128 v[100:103], v2 offset:17408
    v_cvt_pk_bf16_f32 v86, v248, v249
    v_mfma_f32_16x16x32_bf16 a[204:207], v[124:127], v[60:63], a[204:207]
    v_exp_f32 v251, v251
    v_mfma_f32_16x16x32_bf16 a[208:211], a[136:139], v[32:35], a[208:211]
    v_exp_f32 v252, v252
    v_mfma_f32_16x16x32_bf16 a[208:211], a[136:139], v[36:39], a[208:211]
    v_exp_f32 v253, v253
    v_mfma_f32_16x16x32_bf16 a[212:215], a[136:139], v[40:43], a[212:215]
    v_cvt_pk_bf16_f32 v87, v250, v251
    v_cvt_pk_bf16_f32 v94, v252, v253
    v_mfma_f32_16x16x32_bf16 a[212:215], a[136:139], v[44:47], a[212:215]
    v_mfma_f32_16x16x32_bf16 a[216:219], a[136:139], v[48:51], a[216:219]
    v_mfma_f32_16x16x32_bf16 a[216:219], a[136:139], v[52:55], a[216:219]
    v_mfma_f32_16x16x32_bf16 a[220:223], a[136:139], v[56:59], a[220:223]
    v_mfma_f32_16x16x32_bf16 a[220:223], a[136:139], v[60:63], a[220:223]
    s_cmp_eq_u32 s78, 1
    s_cbranch_scc1 K1_LB_MASK
K1_LB_BACK:
    s_waitcnt lgkmcnt(0)
    v_mfma_f32_16x16x32_bf16 v[240:243], a[224:227], v[128:131], v[176:179]
    s_add_u32 m0, s76, s75
    v_exp_f32 v254, v254
    v_mfma_f32_16x16x32_bf16 v[240:243], a[228:231], v[160:163], v[240:243]
    s_mov_b32 s76, s60
    buffer_load_dwordx4 v1, s[36:39], s77 offen sc1 lds
    v_mfma_f32_16x16x32_bf16 v[240:243], a[232:235], v[192:195], v[240:243]
    s_mov_b32 s60, s82
    v_exp_f32 v255, v255
    v_mfma_f32_16x16x32_bf16 v[240:243], a[236:239], v[224:227], v[240:243]
    s_add_u32 s82, s82, 32768
    ds_read_b128 v[104:107], v2 offset:18432
    v_cvt_pk_bf16_f32 v95, v254, v255
    v_mfma_f32_16x16x32_bf16 a[0:3], v[96:99], v[64:67], a[0:3]
    ds_read_b128 v[108:111], v2 offset:19456
    ds_read_b128 a[240:243], v2 offset:4096
    v_mfma_f32_16x16x32_bf16 a[0:3], v[100:103], v[68:71], a[0:3]
    ds_read_b128 a[244:247], v2 offset:5120
    ds_read_b128 a[248:251], v2 offset:6144
    v_mfma_f32_16x16x32_bf16 a[4:7], v[96:99], v[72:75], a[4:7]
    ds_read_b128 a[252:255], v2 offset:7168
    ds_read_b128 v[112:115], v2 offset:20480
    v_mfma_f32_16x16x32_bf16 a[4:7], v[100:103], v[76:79], a[4:7]
    ds_read_b128 v[116:119], v2 offset:21504
    ds_read_b128 v[120:123], v2 offset:22528
    v_mfma_f32_16x16x32_bf16 v[244:247], a[224:227], v[132:135], v[148:151]
    v_exp_f32 v240, v240
    v_mfma_f32_16x16x32_bf16 v[244:247], a[228:231], v[164:167], v[244:247]
    v_exp_f32 v241, v241
    v_mfma_f32_16x16x32_bf16 v[244:247], a[232:235], v[196:199], v[244:247]
    v_exp_f32 v242, v242
    v_mfma_f32_16x16x32_bf16 v[244:247], a[236:239], v[228:231], v[244:247]
    v_exp_f32 v243, v243
    v_mfma_f32_16x16x32_bf16 a[8:11], v[96:99], v[80:83], a[8:11]
    v_cvt_pk_bf16_f32 v32, v240, v241
    v_cvt_pk_bf16_f32 v33, v242, v243
    v_mfma_f32_16x16x32_bf16 a[8:11], v[100:103], v[84:87], a[8:11]
    ds_read_b128 v[124:127], v2 offset:23552
    v_mfma_f32_16x16x32_bf16 a[12:15], v[96:99], v[88:91], a[12:15]
    ds_read_b128 v[96:99], v2 offset:24576
    v_mfma_f32_16x16x32_bf16 a[12:15], v[100:103], v[92:95], a[12:15]
    buffer_load_dwordx4 v1, s[36:39], s77 offen offset:1024 sc1 lds
    v_mfma_f32_16x16x32_bf16 v[248:251], a[224:227], v[136:139], v[152:155]
    v_exp_f32 v244, v244
    v_mfma_f32_16x16x32_bf16 v[248:251], a[228:231], v[168:171], v[248:251]
    v_exp_f32 v245, v245
    v_mfma_f32_16x16x32_bf16 v[248:251], a[232:235], v[200:203], v[248:251]
    v_exp_f32 v246, v246
    v_mfma_f32_16x16x32_bf16 v[248:251], a[236:239], v[232:235], v[248:251]
    s_waitcnt lgkmcnt(0)
    v_exp_f32 v247, v247
    v_mfma_f32_16x16x32_bf16 a[16:19], v[104:107], v[64:67], a[16:19]
    v_cvt_pk_bf16_f32 v40, v244, v245
    v_cvt_pk_bf16_f32 v41, v246, v247
    v_mfma_f32_16x16x32_bf16 a[16:19], v[108:111], v[68:71], a[16:19]
    ds_read_b128 v[100:103], v2 offset:25600
    v_mfma_f32_16x16x32_bf16 a[20:23], v[104:107], v[72:75], a[20:23]
    v_mfma_f32_16x16x32_bf16 a[20:23], v[108:111], v[76:79], a[20:23]
    v_exp_f32 v248, v248
    v_mfma_f32_16x16x32_bf16 v[252:255], a[224:227], v[140:143], v[156:159]
    v_exp_f32 v249, v249
    v_mfma_f32_16x16x32_bf16 v[252:255], a[228:231], v[172:175], v[252:255]
    v_exp_f32 v250, v250
    v_mfma_f32_16x16x32_bf16 v[252:255], a[232:235], v[204:207], v[252:255]
    v_exp_f32 v251, v251
    v_mfma_f32_16x16x32_bf16 v[252:255], a[236:239], v[236:239], v[252:255]
    v_cvt_pk_bf16_f32 v48, v248, v249
    v_cvt_pk_bf16_f32 v49, v250, v251
    v_mfma_f32_16x16x32_bf16 a[24:27], v[104:107], v[80:83], a[24:27]
    ds_read_b128 a[224:227], v2 offset:8192
    ds_read_b128 a[228:231], v2 offset:9216
    v_mfma_f32_16x16x32_bf16 a[24:27], v[108:111], v[84:87], a[24:27]
    buffer_load_dwordx4 v1, s[36:39], s77 offen offset:2048 sc1 lds
    v_mfma_f32_16x16x32_bf16 a[28:31], v[104:107], v[88:91], a[28:31]
    v_exp_f32 v252, v252
    v_mfma_f32_16x16x32_bf16 a[28:31], v[108:111], v[92:95], a[28:31]
    v_exp_f32 v253, v253
    v_mfma_f32_16x16x32_bf16 v[240:243], a[240:243], v[128:131], v[180:183]
    v_exp_f32 v254, v254
    v_mfma_f32_16x16x32_bf16 v[240:243], a[244:247], v[160:163], v[240:243]
    v_exp_f32 v255, v255
    v_mfma_f32_16x16x32_bf16 v[240:243], a[248:251], v[192:195], v[240:243]
    v_cvt_pk_bf16_f32 v56, v252, v253
    v_cvt_pk_bf16_f32 v57, v254, v255
    v_mfma_f32_16x16x32_bf16 v[240:243], a[252:255], v[224:227], v[240:243]
    ds_read_b128 a[232:235], v2 offset:10240
    ds_read_b128 a[236:239], v2 offset:11264
    v_mfma_f32_16x16x32_bf16 a[32:35], v[112:115], v[64:67], a[32:35]
    ds_read_b128 v[104:107], v2 offset:26624
    ds_read_b128 v[108:111], v2 offset:27648
    v_mfma_f32_16x16x32_bf16 a[32:35], v[116:119], v[68:71], a[32:35]
    v_mfma_f32_16x16x32_bf16 a[36:39], v[112:115], v[72:75], a[36:39]
    v_mfma_f32_16x16x32_bf16 a[36:39], v[116:119], v[76:79], a[36:39]
    v_exp_f32 v240, v240
    v_mfma_f32_16x16x32_bf16 v[244:247], a[240:243], v[132:135], v[148:151]
    v_exp_f32 v241, v241
    v_mfma_f32_16x16x32_bf16 v[244:247], a[244:247], v[164:167], v[244:247]
    v_exp_f32 v242, v242
    v_mfma_f32_16x16x32_bf16 v[244:247], a[248:251], v[196:199], v[244:247]
    v_exp_f32 v243, v243
    v_mfma_f32_16x16x32_bf16 v[244:247], a[252:255], v[228:231], v[244:247]
    buffer_load_dwordx4 v1, s[36:39], s77 offen offset:3072 sc1 lds
    v_mfma_f32_16x16x32_bf16 a[40:43], v[112:115], v[80:83], a[40:43]
    v_cvt_pk_bf16_f32 v34, v240, v241
    v_cvt_pk_bf16_f32 v35, v242, v243
    v_mfma_f32_16x16x32_bf16 a[40:43], v[116:119], v[84:87], a[40:43]
    v_mfma_f32_16x16x32_bf16 a[44:47], v[112:115], v[88:91], a[44:47]
    ds_read_b128 v[112:115], v2 offset:28672
    v_mfma_f32_16x16x32_bf16 a[44:47], v[116:119], v[92:95], a[44:47]
    v_exp_f32 v244, v244
    v_mfma_f32_16x16x32_bf16 v[248:251], a[240:243], v[136:139], v[152:155]
    v_exp_f32 v245, v245
    v_mfma_f32_16x16x32_bf16 v[248:251], a[244:247], v[168:171], v[248:251]
    v_exp_f32 v246, v246
    v_mfma_f32_16x16x32_bf16 v[248:251], a[248:251], v[200:203], v[248:251]
    v_exp_f32 v247, v247
    v_mfma_f32_16x16x32_bf16 v[248:251], a[252:255], v[232:235], v[248:251]
    v_cvt_pk_bf16_f32 v42, v244, v245
    v_cvt_pk_bf16_f32 v43, v246, v247
    v_mfma_f32_16x16x32_bf16 a[48:51], v[120:123], v[64:67], a[48:51]
    ds_read_b128 v[116:119], v2 offset:29696
    v_mfma_f32_16x16x32_bf16 a[48:51], v[124:127], v[68:71], a[48:51]
    v_mfma_f32_16x16x32_bf16 a[52:55], v[120:123], v[72:75], a[52:55]
    v_mfma_f32_16x16x32_bf16 a[52:55], v[124:127], v[76:79], a[52:55]
    v_mfma_f32_16x16x32_bf16 v[252:255], a[240:243], v[140:143], v[156:159]
    v_exp_f32 v248, v248
    v_mfma_f32_16x16x32_bf16 v[252:255], a[244:247], v[172:175], v[252:255]
    s_add_u32 s100, s77, 4096
    v_exp_f32 v249, v249
    v_mfma_f32_16x16x32_bf16 v[252:255], a[248:251], v[204:207], v[252:255]
    s_add_u32 m0, m0, 4096
    v_exp_f32 v250, v250
    v_mfma_f32_16x16x32_bf16 v[252:255], a[252:255], v[236:239], v[252:255]
    buffer_load_dwordx4 v1, s[36:39], s100 offen sc1 lds
    v_mfma_f32_16x16x32_bf16 a[56:59], v[120:123], v[80:83], a[56:59]
    v_exp_f32 v251, v251
    v_mfma_f32_16x16x32_bf16 a[56:59], v[124:127], v[84:87], a[56:59]
    v_cvt_pk_bf16_f32 v50, v248, v249
    v_cvt_pk_bf16_f32 v51, v250, v251
    v_mfma_f32_16x16x32_bf16 a[60:63], v[120:123], v[88:91], a[60:63]
    ds_read_b128 a[240:243], v2 offset:12288
    ds_read_b128 a[244:247], v2 offset:13312
    v_mfma_f32_16x16x32_bf16 a[60:63], v[124:127], v[92:95], a[60:63]
    s_waitcnt lgkmcnt(2)
    v_exp_f32 v252, v252
    v_mfma_f32_16x16x32_bf16 v[240:243], a[224:227], v[128:131], v[184:187]
    v_exp_f32 v253, v253
    v_mfma_f32_16x16x32_bf16 v[240:243], a[228:231], v[160:163], v[240:243]
    v_exp_f32 v254, v254
    v_mfma_f32_16x16x32_bf16 v[240:243], a[232:235], v[192:195], v[240:243]
    v_exp_f32 v255, v255
    v_mfma_f32_16x16x32_bf16 v[240:243], a[236:239], v[224:227], v[240:243]
    v_cvt_pk_bf16_f32 v58, v252, v253
    v_cvt_pk_bf16_f32 v59, v254, v255
    v_mfma_f32_16x16x32_bf16 a[144:147], v[96:99], v[64:67], a[144:147]
    ds_read_b128 a[248:251], v2 offset:14336
    ds_read_b128 a[252:255], v2 offset:15360
    v_mfma_f32_16x16x32_bf16 a[144:147], v[100:103], v[68:71], a[144:147]
    ds_read_b128 v[120:123], v2 offset:30720
    ds_read_b128 v[124:127], v2 offset:31744
    v_mfma_f32_16x16x32_bf16 a[148:151], v[96:99], v[72:75], a[148:151]
    v_exp_f32 v240, v240
    v_mfma_f32_16x16x32_bf16 a[148:151], v[100:103], v[76:79], a[148:151]
    v_exp_f32 v241, v241
    v_mfma_f32_16x16x32_bf16 v[244:247], a[224:227], v[132:135], v[148:151]
    buffer_load_dwordx4 v1, s[36:39], s100 offen offset:1024 sc1 lds
    v_mfma_f32_16x16x32_bf16 v[244:247], a[228:231], v[164:167], v[244:247]
    v_exp_f32 v242, v242
    v_mfma_f32_16x16x32_bf16 v[244:247], a[232:235], v[196:199], v[244:247]
    v_exp_f32 v243, v243
    v_mfma_f32_16x16x32_bf16 v[244:247], a[236:239], v[228:231], v[244:247]
    v_cvt_pk_bf16_f32 v36, v240, v241
    v_cvt_pk_bf16_f32 v37, v242, v243
    v_mfma_f32_16x16x32_bf16 a[152:155], v[96:99], v[80:83], a[152:155]
    v_mfma_f32_16x16x32_bf16 a[152:155], v[100:103], v[84:87], a[152:155]
    v_mfma_f32_16x16x32_bf16 a[156:159], v[96:99], v[88:91], a[156:159]
    v_mfma_f32_16x16x32_bf16 a[156:159], v[100:103], v[92:95], a[156:159]
    v_mfma_f32_16x16x32_bf16 v[248:251], a[224:227], v[136:139], v[152:155]
    v_mfma_f32_16x16x32_bf16 v[248:251], a[228:231], v[168:171], v[248:251]
    v_exp_f32 v244, v244
    v_mfma_f32_16x16x32_bf16 v[248:251], a[232:235], v[200:203], v[248:251]
    v_exp_f32 v245, v245
    v_mfma_f32_16x16x32_bf16 v[248:251], a[236:239], v[232:235], v[248:251]
    v_exp_f32 v246, v246
    v_mfma_f32_16x16x32_bf16 a[160:163], v[104:107], v[64:67], a[160:163]
    v_exp_f32 v247, v247
    v_mfma_f32_16x16x32_bf16 a[160:163], v[108:111], v[68:71], a[160:163]
    v_cvt_pk_bf16_f32 v44, v244, v245
    v_cvt_pk_bf16_f32 v45, v246, v247
    v_mfma_f32_16x16x32_bf16 a[164:167], v[104:107], v[72:75], a[164:167]
    buffer_load_dwordx4 v1, s[36:39], s100 offen offset:2048 sc1 lds
    v_mfma_f32_16x16x32_bf16 a[164:167], v[108:111], v[76:79], a[164:167]
    v_exp_f32 v248, v248
    v_mfma_f32_16x16x32_bf16 v[252:255], a[224:227], v[140:143], v[156:159]
    v_exp_f32 v249, v249
    v_mfma_f32_16x16x32_bf16 v[252:255], a[228:231], v[172:175], v[252:255]
    v_exp_f32 v250, v250
    v_mfma_f32_16x16x32_bf16 v[252:255], a[232:235], v[204:207], v[252:255]
    v_exp_f32 v251, v251
    v_mfma_f32_16x16x32_bf16 v[252:255], a[236:239], v[236:239], v[252:255]
    v_cvt_pk_bf16_f32 v52, v248, v249
    v_cvt_pk_bf16_f32 v53, v250, v251
    v_mfma_f32_16x16x32_bf16 a[168:171], v[104:107], v[80:83], a[168:171]
    v_mfma_f32_16x16x32_bf16 a[168:171], v[108:111], v[84:87], a[168:171]
    v_mfma_f32_16x16x32_bf16 a[172:175], v[104:107], v[88:91], a[172:175]
    v_mfma_f32_16x16x32_bf16 a[172:175], v[108:111], v[92:95], a[172:175]
    s_waitcnt lgkmcnt(0)
    v_mfma_f32_16x16x32_bf16 v[240:243], a[240:243], v[128:131], v[188:191]
    v_mfma_f32_16x16x32_bf16 v[240:243], a[244:247], v[160:163], v[240:243]
    v_exp_f32 v252, v252
    v_mfma_f32_16x16x32_bf16 v[240:243], a[248:251], v[192:195], v[240:243]
    v_exp_f32 v253, v253
    v_mfma_f32_16x16x32_bf16 v[240:243], a[252:255], v[224:227], v[240:243]
    v_exp_f32 v254, v254
    v_mfma_f32_16x16x32_bf16 a[176:179], v[112:115], v[64:67], a[176:179]
    buffer_load_dwordx4 v1, s[36:39], s100 offen offset:3072 sc1 lds
    v_mfma_f32_16x16x32_bf16 a[176:179], v[116:119], v[68:71], a[176:179]
    v_exp_f32 v255, v255
    v_mfma_f32_16x16x32_bf16 a[180:183], v[112:115], v[72:75], a[180:183]
    v_cvt_pk_bf16_f32 v60, v252, v253
    v_cvt_pk_bf16_f32 v61, v254, v255
    v_mfma_f32_16x16x32_bf16 a[180:183], v[116:119], v[76:79], a[180:183]
    s_cmp_eq_u32 s82, 163840
    s_cselect_b32 s82, 0, s82
    v_add_u32 v2, s82, v1
    v_mfma_f32_16x16x32_bf16 v[244:247], a[240:243], v[132:135], v[148:151]
    v_exp_f32 v240, v240
    v_mfma_f32_16x16x32_bf16 v[244:247], a[244:247], v[164:167], v[244:247]
    v_exp_f32 v241, v241
    v_mfma_f32_16x16x32_bf16 v[244:247], a[248:251], v[196:199], v[244:247]
    v_exp_f32 v242, v242
    v_mfma_f32_16x16x32_bf16 v[244:247], a[252:255], v[228:231], v[244:247]
    v_exp_f32 v243, v243
    v_mfma_f32_16x16x32_bf16 a[184:187], v[112:115], v[80:83], a[184:187]
    v_cvt_pk_bf16_f32 v38, v240, v241
    v_cvt_pk_bf16_f32 v39, v242, v243
    v_mfma_f32_16x16x32_bf16 a[184:187], v[116:119], v[84:87], a[184:187]
    v_mfma_f32_16x16x32_bf16 a[188:191], v[112:115], v[88:91], a[188:191]
    v_mfma_f32_16x16x32_bf16 a[188:191], v[116:119], v[92:95], a[188:191]
    v_mfma_f32_16x16x32_bf16 v[248:251], a[240:243], v[136:139], v[152:155]
    v_exp_f32 v244, v244
    v_mfma_f32_16x16x32_bf16 v[248:251], a[244:247], v[168:171], v[248:251]
    v_exp_f32 v245, v245
    v_mfma_f32_16x16x32_bf16 v[248:251], a[248:251], v[200:203], v[248:251]
    s_add_u32 s77, s77, 32768
    v_exp_f32 v246, v246
    v_mfma_f32_16x16x32_bf16 v[248:251], a[252:255], v[232:235], v[248:251]
    v_exp_f32 v247, v247
    v_mfma_f32_16x16x32_bf16 a[192:195], v[120:123], v[64:67], a[192:195]
    v_cvt_pk_bf16_f32 v46, v244, v245
    v_cvt_pk_bf16_f32 v47, v246, v247
    v_mfma_f32_16x16x32_bf16 a[192:195], v[124:127], v[68:71], a[192:195]
    v_mfma_f32_16x16x32_bf16 a[196:199], v[120:123], v[72:75], a[196:199]
    v_mfma_f32_16x16x32_bf16 a[196:199], v[124:127], v[76:79], a[196:199]
    v_mfma_f32_16x16x32_bf16 v[252:255], a[240:243], v[140:143], v[156:159]
    v_exp_f32 v248, v248
    v_mfma_f32_16x16x32_bf16 v[252:255], a[244:247], v[172:175], v[252:255]
    v_exp_f32 v249, v249
    v_mfma_f32_16x16x32_bf16 v[252:255], a[248:251], v[204:207], v[252:255]
    v_exp_f32 v250, v250
    v_mfma_f32_16x16x32_bf16 v[252:255], a[252:255], v[236:239], v[252:255]
    s_waitcnt vmcnt(16)
    s_barrier
    ds_read_b128 a[224:227], v2 offset:0
    v_mfma_f32_16x16x32_bf16 a[200:203], v[120:123], v[80:83], a[200:203]
    ds_read_b128 a[228:231], v2 offset:1024
    ds_read_b128 a[232:235], v2 offset:2048
    v_mfma_f32_16x16x32_bf16 a[200:203], v[124:127], v[84:87], a[200:203]
    ds_read_b128 a[236:239], v2 offset:3072
    ds_read_b128 v[96:99], v2 offset:16384
    v_mfma_f32_16x16x32_bf16 a[204:207], v[120:123], v[88:91], a[204:207]
    ds_read_b128 v[100:103], v2 offset:17408
    v_cvt_pk_bf16_f32 v54, v248, v249
    v_mfma_f32_16x16x32_bf16 a[204:207], v[124:127], v[92:95], a[204:207]
    v_exp_f32 v251, v251
    v_mfma_f32_16x16x32_bf16 a[208:211], a[136:139], v[64:67], a[208:211]
    v_exp_f32 v252, v252
    v_mfma_f32_16x16x32_bf16 a[208:211], a[136:139], v[68:71], a[208:211]
    v_exp_f32 v253, v253
    v_mfma_f32_16x16x32_bf16 a[212:215], a[136:139], v[72:75], a[212:215]
    v_cvt_pk_bf16_f32 v55, v250, v251
    v_cvt_pk_bf16_f32 v62, v252, v253
    v_mfma_f32_16x16x32_bf16 a[212:215], a[136:139], v[76:79], a[212:215]
    v_mfma_f32_16x16x32_bf16 a[216:219], a[136:139], v[80:83], a[216:219]
    v_mfma_f32_16x16x32_bf16 a[216:219], a[136:139], v[84:87], a[216:219]
    v_mfma_f32_16x16x32_bf16 a[220:223], a[136:139], v[88:91], a[220:223]
    v_mfma_f32_16x16x32_bf16 a[220:223], a[136:139], v[92:95], a[220:223]
    s_sub_u32 s78, s78, 1
    s_cmp_lg_u32 s78, 0
    s_cbranch_scc1 K1_LB
K1_LB_END:
    v_add_f32 v212, s12, v148
    v_fma_f32 v176, v208, s8, v212
    v_fma_f32 v177, v209, s8, v212
    v_fma_f32 v178, v210, s8, v212
    v_fma_f32 v179, v211, s8, v212
    s_nop 1
    s_waitcnt lgkmcnt(0)
    v_mfma_f32_16x16x32_bf16 v[240:243], a[224:227], v[132:135], v[176:179]
    s_add_u32 m0, s76, s75
    ds_read_b128 v[104:107], v2 offset:18432
    ds_read_b128 v[108:111], v2 offset:19456
    v_mfma_f32_16x16x32_bf16 v[240:243], a[228:231], v[164:167], v[240:243]
    s_mov_b32 s76, s60
    buffer_load_dwordx4 v1, s[36:39], s77 offen sc1 lds
    v_mfma_f32_16x16x32_bf16 v[240:243], a[232:235], v[196:199], v[240:243]
    s_mov_b32 s60, s82
    v_exp_f32 v254, v254
    v_mfma_f32_16x16x32_bf16 v[240:243], a[236:239], v[228:231], v[240:243]
    s_add_u32 s82, s82, 32768
    v_exp_f32 v255, v255
    v_mfma_f32_16x16x32_bf16 a[0:3], v[96:99], v[32:35], a[0:3]
    s_mov_b32 s98, 0x3fb8aa3b
    v_cvt_pk_bf16_f32 v63, v254, v255
    ds_read_b128 a[240:243], v2 offset:4096
    v_mfma_f32_16x16x32_bf16 a[0:3], v[100:103], v[36:39], a[0:3]
    ds_read_b128 a[244:247], v2 offset:5120
    ds_read_b128 a[248:251], v2 offset:6144
    v_mfma_f32_16x16x32_bf16 a[4:7], v[96:99], v[40:43], a[4:7]
    ds_read_b128 a[252:255], v2 offset:7168
    ds_read_b128 v[112:115], v2 offset:20480
    v_mfma_f32_16x16x32_bf16 a[4:7], v[100:103], v[44:47], a[4:7]
    v_add_f32 v213, s13, v148
    ds_read_b128 v[116:119], v2 offset:21504
    v_mfma_f32_16x16x32_bf16 v[244:247], a[224:227], v[136:139], v[152:155]
    v_fma_f32 v180, v208, s9, v213
    v_fma_f32 v181, v209, s9, v213
    v_mfma_f32_16x16x32_bf16 v[244:247], a[228:231], v[168:171], v[244:247]
    v_fma_f32 v182, v210, s9, v213
    v_fma_f32 v183, v211, s9, v213
    v_mfma_f32_16x16x32_bf16 v[244:247], a[232:235], v[200:203], v[244:247]
    v_exp_f32 v240, v240
    v_mfma_f32_16x16x32_bf16 v[244:247], a[236:239], v[232:235], v[244:247]
    v_exp_f32 v241, v241
    v_mfma_f32_16x16x32_bf16 a[8:11], v[96:99], v[48:51], a[8:11]
    v_exp_f32 v242, v242
    v_mfma_f32_16x16x32_bf16 a[8:11], v[100:103], v[52:55], a[8:11]
    buffer_load_dwordx4 v1, s[36:39], s77 offen offset:1024 sc1 lds
    v_mfma_f32_16x16x32_bf16 a[12:15], v[96:99], v[56:59], a[12:15]
    v_exp_f32 v243, v243
    v_mfma_f32_16x16x32_bf16 a[12:15], v[100:103], v[60:63], a[12:15]
    s_waitcnt lgkmcnt(0)
    v_cvt_pk_bf16_f32 v72, v240, v241
    v_cvt_pk_bf16_f32 v73, v242, v243
    v_mfma_f32_16x16x32_bf16 a[16:19], v[104:107], v[32:35], a[16:19]
    ds_read_b128 v[120:123], v2 offset:22528
    ds_read_b128 v[124:127], v2 offset:23552
    v_mfma_f32_16x16x32_bf16 a[16:19], v[108:111], v[36:39], a[16:19]
    v_exp_f32 v244, v244
    v_mfma_f32_16x16x32_bf16 v[248:251], a[224:227], v[140:143], v[156:159]
    v_exp_f32 v245, v245
    v_mfma_f32_16x16x32_bf16 v[248:251], a[228:231], v[172:175], v[248:251]
    v_exp_f32 v246, v246
    v_mfma_f32_16x16x32_bf16 v[248:251], a[232:235], v[204:207], v[248:251]
    v_exp_f32 v247, v247
    v_mfma_f32_16x16x32_bf16 v[248:251], a[236:239], v[236:239], v[248:251]
    v_cvt_pk_bf16_f32 v80, v244, v245
    v_cvt_pk_bf16_f32 v81, v246, v247
    v_mfma_f32_16x16x32_bf16 a[20:23], v[104:107], v[40:43], a[20:23]
    ds_read_b128 a[224:227], v2 offset:8192
    ds_read_b128 a[228:231], v2 offset:9216
    v_mfma_f32_16x16x32_bf16 a[20:23], v[108:111], v[44:47], a[20:23]
    ds_read_b128 a[232:235], v2 offset:10240
    ds_read_b128 a[236:239], v2 offset:11264
    v_mfma_f32_16x16x32_bf16 a[24:27], v[104:107], v[48:51], a[24:27]
    ds_read_b128 v[96:99], v2 offset:24576
    v_add_f32 v214, s14, v148
    v_mfma_f32_16x16x32_bf16 a[24:27], v[108:111], v[52:55], a[24:27]
    buffer_load_dwordx4 v1, s[36:39], s77 offen offset:2048 sc1 lds
    v_mfma_f32_16x16x32_bf16 a[28:31], v[104:107], v[56:59], a[28:31]
    ds_read_b128 v[100:103], v2 offset:25600
    v_fma_f32 v184, v208, s10, v214
    v_mfma_f32_16x16x32_bf16 a[28:31], v[108:111], v[60:63], a[28:31]
    v_exp_f32 v248, v248
    v_mfma_f32_16x16x32_bf16 v[252:255], a[240:243], v[132:135], v[180:183]
    v_exp_f32 v249, v249
    v_mfma_f32_16x16x32_bf16 v[252:255], a[244:247], v[164:167], v[252:255]
    v_exp_f32 v250, v250
    v_mfma_f32_16x16x32_bf16 v[252:255], a[248:251], v[196:199], v[252:255]
    v_exp_f32 v251, v251
    v_mfma_f32_16x16x32_bf16 v[252:255], a[252:255], v[228:231], v[252:255]
    v_fma_f32 v185, v209, s10, v214
    v_fma_f32 v186, v210, s10, v214
    v_mfma_f32_16x16x32_bf16 a[32:35], v[112:115], v[32:35], a[32:35]
    v_fma_f32 v187, v211, s10, v214
    v_cvt_pk_bf16_f32 v88, v248, v249
    v_mfma_f32_16x16x32_bf16 a[32:35], v[116:119], v[36:39], a[32:35]
    v_cvt_pk_bf16_f32 v89, v250, v251
    ds_read_b128 v[104:107], v2 offset:26624
    v_mfma_f32_16x16x32_bf16 a[36:39], v[112:115], v[40:43], a[36:39]
    v_exp_f32 v252, v252
    v_mfma_f32_16x16x32_bf16 a[36:39], v[116:119], v[44:47], a[36:39]
    v_exp_f32 v253, v253
    v_mfma_f32_16x16x32_bf16 v[240:243], a[240:243], v[136:139], v[152:155]
    v_exp_f32 v254, v254
    v_mfma_f32_16x16x32_bf16 v[240:243], a[244:247], v[168:171], v[240:243]
    buffer_load_dwordx4 v1, s[36:39], s77 offen offset:3072 sc1 lds
    v_mfma_f32_16x16x32_bf16 v[240:243], a[248:251], v[200:203], v[240:243]
    v_exp_f32 v255, v255
    v_mfma_f32_16x16x32_bf16 v[240:243], a[252:255], v[232:235], v[240:243]
    v_cvt_pk_bf16_f32 v74, v252, v253
    v_cvt_pk_bf16_f32 v75, v254, v255
    v_mfma_f32_16x16x32_bf16 a[40:43], v[112:115], v[48:51], a[40:43]
    ds_read_b128 v[108:111], v2 offset:27648
    v_add_f32 v215, s15, v148
    v_mfma_f32_16x16x32_bf16 a[40:43], v[116:119], v[52:55], a[40:43]
    v_fma_f32 v188, v208, s11, v215
    v_fma_f32 v189, v209, s11, v215
    v_mfma_f32_16x16x32_bf16 a[44:47], v[112:115], v[56:59], a[44:47]
    v_exp_f32 v240, v240
    v_mfma_f32_16x16x32_bf16 a[44:47], v[116:119], v[60:63], a[44:47]
    s_waitcnt lgkmcnt(1)
    v_exp_f32 v241, v241
    v_mfma_f32_16x16x32_bf16 a[48:51], v[120:123], v[32:35], a[48:51]
    v_exp_f32 v242, v242
    v_mfma_f32_16x16x32_bf16 a[48:51], v[124:127], v[36:39], a[48:51]
    v_exp_f32 v243, v243
    v_mfma_f32_16x16x32_bf16 v[244:247], a[240:243], v[140:143], v[156:159]
    v_cvt_pk_bf16_f32 v82, v240, v241
    v_cvt_pk_bf16_f32 v83, v242, v243
    v_mfma_f32_16x16x32_bf16 v[244:247], a[244:247], v[172:175], v[244:247]
    ds_read_b128 a[240:243], v2 offset:12288
    ds_read_b128 a[244:247], v2 offset:13312
    v_mfma_f32_16x16x32_bf16 v[244:247], a[248:251], v[204:207], v[244:247]
    ds_read_b128 a[248:251], v2 offset:14336
    ds_read_b128 v[112:115], v2 offset:28672
    v_mfma_f32_16x16x32_bf16 v[244:247], a[252:255], v[236:239], v[244:247]
    s_add_u32 s100, s77, 4096
    ds_read_b128 a[252:255], v2 offset:15360
    ds_read_b128 v[116:119], v2 offset:29696
    v_mfma_f32_16x16x32_bf16 a[52:55], v[120:123], v[40:43], a[52:55]
    s_add_u32 m0, m0, 4096
    v_fma_f32 v190, v210, s11, v215
    v_fma_f32 v191, v211, s11, v215
    v_mfma_f32_16x16x32_bf16 a[52:55], v[124:127], v[44:47], a[52:55]
    buffer_load_dwordx4 v1, s[36:39], s100 offen sc1 lds
    v_mfma_f32_16x16x32_bf16 a[56:59], v[120:123], v[48:51], a[56:59]
    v_exp_f32 v244, v244
    v_mfma_f32_16x16x32_bf16 a[56:59], v[124:127], v[52:55], a[56:59]
    v_exp_f32 v245, v245
    v_mfma_f32_16x16x32_bf16 a[60:63], v[120:123], v[56:59], a[60:63]
    v_exp_f32 v246, v246
    v_mfma_f32_16x16x32_bf16 a[60:63], v[124:127], v[60:63], a[60:63]
    v_exp_f32 v247, v247
    v_mfma_f32_16x16x32_bf16 v[248:251], a[224:227], v[132:135], v[184:187]
    v_cvt_pk_bf16_f32 v90, v244, v245
    v_cvt_pk_bf16_f32 v91, v246, v247
    v_mfma_f32_16x16x32_bf16 v[248:251], a[228:231], v[164:167], v[248:251]
    ds_read_b128 v[120:123], v2 offset:30720
    ds_read_b128 v[124:127], v2 offset:31744
    v_mfma_f32_16x16x32_bf16 v[248:251], a[232:235], v[196:199], v[248:251]
    s_cmp_eq_u32 s82, 163840
    s_cselect_b32 s82, 0, s82
    v_add_u32 v2, s82, v1
    v_mfma_f32_16x16x32_bf16 v[248:251], a[236:239], v[228:231], v[248:251]
    v_bfe_u32 v8, v1, 2, 6
    v_accvgpr_read_b32 v4, a112
    v_mfma_f32_16x16x32_bf16 a[144:147], v[96:99], v[32:35], a[144:147]
    v_accvgpr_read_b32 v5, a116
    v_accvgpr_read_b32 v6, a120
    v_mfma_f32_16x16x32_bf16 a[144:147], v[100:103], v[36:39], a[144:147]
    v_add_u32 v8, 192, v8
    v_cvt_pk_bf16_f32 v4, 0, v4
    v_mfma_f32_16x16x32_bf16 a[148:151], v[96:99], v[40:43], a[148:151]
    buffer_load_dwordx4 v1, s[36:39], s100 offen offset:1024 sc1 lds
    v_mfma_f32_16x16x32_bf16 a[148:151], v[100:103], v[44:47], a[148:151]
    v_exp_f32 v248, v248
    v_mfma_f32_16x16x32_bf16 v[252:255], a[224:227], v[136:139], v[152:155]
    v_exp_f32 v249, v249
    v_mfma_f32_16x16x32_bf16 v[252:255], a[228:231], v[168:171], v[252:255]
    v_exp_f32 v250, v250
    v_mfma_f32_16x16x32_bf16 v[252:255], a[232:235], v[200:203], v[252:255]
    v_exp_f32 v251, v251
    v_mfma_f32_16x16x32_bf16 v[252:255], a[236:239], v[232:235], v[252:255]
    v_cvt_pk_bf16_f32 v76, v248, v249
    v_cvt_pk_bf16_f32 v77, v250, v251
    v_mfma_f32_16x16x32_bf16 a[152:155], v[96:99], v[48:51], a[152:155]
    v_cvt_pk_bf16_f32 v5, 0, v5
    v_cvt_pk_bf16_f32 v6, 0, v6
    v_mfma_f32_16x16x32_bf16 a[152:155], v[100:103], v[52:55], a[152:155]
    ds_bpermute_b32 v4, v8, v4
    ds_bpermute_b32 v5, v8, v5
    v_mfma_f32_16x16x32_bf16 a[156:159], v[96:99], v[56:59], a[156:159]
    v_exp_f32 v252, v252
    v_mfma_f32_16x16x32_bf16 a[156:159], v[100:103], v[60:63], a[156:159]
    v_exp_f32 v253, v253
    v_mfma_f32_16x16x32_bf16 a[160:163], v[104:107], v[32:35], a[160:163]
    s_waitcnt lgkmcnt(2)
    v_exp_f32 v254, v254
    v_mfma_f32_16x16x32_bf16 a[160:163], v[108:111], v[36:39], a[160:163]
    v_exp_f32 v255, v255
    v_mfma_f32_16x16x32_bf16 v[240:243], a[224:227], v[140:143], v[156:159]
    buffer_load_dwordx4 v1, s[36:39], s100 offen offset:2048 sc1 lds
    v_mfma_f32_16x16x32_bf16 v[240:243], a[228:231], v[172:175], v[240:243]
    v_cvt_pk_bf16_f32 v84, v252, v253
    v_cvt_pk_bf16_f32 v85, v254, v255
    v_mfma_f32_16x16x32_bf16 v[240:243], a[232:235], v[204:207], v[240:243]
    s_waitcnt lgkmcnt(0)
    ds_bpermute_b32 v6, v8, v6
    v_mul_f32 v4, s98, v4
    v_mfma_f32_16x16x32_bf16 v[240:243], a[236:239], v[236:239], v[240:243]
    s_waitcnt lgkmcnt(0)
    v_mul_f32 v5, s98, v5
    v_mul_f32 v6, s98, v6
    v_mfma_f32_16x16x32_bf16 a[164:167], v[104:107], v[40:43], a[164:167]
    v_exp_f32 v4, v4
    v_mfma_f32_16x16x32_bf16 a[164:167], v[108:111], v[44:47], a[164:167]
    v_exp_f32 v5, v5
    v_mfma_f32_16x16x32_bf16 a[168:171], v[104:107], v[48:51], a[168:171]
    v_exp_f32 v6, v6
    v_mfma_f32_16x16x32_bf16 a[168:171], v[108:111], v[52:55], a[168:171]
    v_exp_f32 v240, v240
    v_mfma_f32_16x16x32_bf16 a[172:175], v[104:107], v[56:59], a[172:175]
    v_exp_f32 v241, v241
    v_mfma_f32_16x16x32_bf16 a[172:175], v[108:111], v[60:63], a[172:175]
    v_exp_f32 v242, v242
    v_mfma_f32_16x16x32_bf16 v[244:247], a[240:243], v[132:135], v[188:191]
    v_exp_f32 v243, v243
    v_mfma_f32_16x16x32_bf16 v[244:247], a[244:247], v[164:167], v[244:247]
    v_cvt_pk_bf16_f32 v92, v240, v241
    v_cvt_pk_bf16_f32 v93, v242, v243
    v_mfma_f32_16x16x32_bf16 v[244:247], a[248:251], v[196:199], v[244:247]
    buffer_load_dwordx4 v1, s[36:39], s100 offen offset:3072 sc1 lds
    v_mfma_f32_16x16x32_bf16 v[244:247], a[252:255], v[228:231], v[244:247]
    v_add_f32 v4, 1.0, v4
    v_add_f32 v5, 1.0, v5
    v_mfma_f32_16x16x32_bf16 a[176:179], v[112:115], v[32:35], a[176:179]
    v_add_f32 v6, 1.0, v6
    v_mfma_f32_16x16x32_bf16 a[176:179], v[116:119], v[36:39], a[176:179]
    v_rcp_f32 v4, v4
    v_mfma_f32_16x16x32_bf16 a[180:183], v[112:115], v[40:43], a[180:183]
    v_rcp_f32 v5, v5
    v_mfma_f32_16x16x32_bf16 a[180:183], v[116:119], v[44:47], a[180:183]
    v_exp_f32 v244, v244
    v_mfma_f32_16x16x32_bf16 v[248:251], a[240:243], v[136:139], v[152:155]
    v_exp_f32 v245, v245
    v_mfma_f32_16x16x32_bf16 v[248:251], a[244:247], v[168:171], v[248:251]
    v_exp_f32 v246, v246
    v_mfma_f32_16x16x32_bf16 v[248:251], a[248:251], v[200:203], v[248:251]
    v_exp_f32 v247, v247
    v_mfma_f32_16x16x32_bf16 v[248:251], a[252:255], v[232:235], v[248:251]
    v_cvt_pk_bf16_f32 v78, v244, v245
    v_cvt_pk_bf16_f32 v79, v246, v247
    v_mfma_f32_16x16x32_bf16 a[184:187], v[112:115], v[48:51], a[184:187]
    v_rcp_f32 v6, v6
    v_mfma_f32_16x16x32_bf16 a[184:187], v[116:119], v[52:55], a[184:187]
    v_mfma_f32_16x16x32_bf16 a[188:191], v[112:115], v[56:59], a[188:191]
    s_add_u32 s77, s77, 32768
    v_mfma_f32_16x16x32_bf16 a[188:191], v[116:119], v[60:63], a[188:191]
    v_exp_f32 v248, v248
    v_mfma_f32_16x16x32_bf16 a[192:195], v[120:123], v[32:35], a[192:195]
    v_exp_f32 v249, v249
    v_mfma_f32_16x16x32_bf16 a[192:195], v[124:127], v[36:39], a[192:195]
    v_exp_f32 v250, v250
    v_mfma_f32_16x16x32_bf16 v[252:255], a[240:243], v[140:143], v[156:159]
    v_exp_f32 v251, v251
    v_mfma_f32_16x16x32_bf16 v[252:255], a[244:247], v[172:175], v[252:255]
    v_cvt_pk_bf16_f32 v86, v248, v249
    v_cvt_pk_bf16_f32 v87, v250, v251
    v_mfma_f32_16x16x32_bf16 v[252:255], a[248:251], v[204:207], v[252:255]
    v_mfma_f32_16x16x32_bf16 v[252:255], a[252:255], v[236:239], v[252:255]
    v_mfma_f32_16x16x32_bf16 a[196:199], v[120:123], v[40:43], a[196:199]
    v_mfma_f32_16x16x32_bf16 a[196:199], v[124:127], v[44:47], a[196:199]
    s_waitcnt vmcnt(16)
    s_barrier
    ds_read_b128 a[224:227], v2 offset:0
    v_mfma_f32_16x16x32_bf16 a[200:203], v[120:123], v[48:51], a[200:203]
    ds_read_b128 a[228:231], v2 offset:1024
    ds_read_b128 a[232:235], v2 offset:2048
    v_mfma_f32_16x16x32_bf16 a[200:203], v[124:127], v[52:55], a[200:203]
    ds_read_b128 a[236:239], v2 offset:3072
    ds_read_b128 v[96:99], v2 offset:16384
    v_mfma_f32_16x16x32_bf16 a[204:207], v[120:123], v[56:59], a[204:207]
    ds_read_b128 v[100:103], v2 offset:17408
    v_mfma_f32_16x16x32_bf16 a[204:207], v[124:127], v[60:63], a[204:207]
    v_exp_f32 v252, v252
    v_mfma_f32_16x16x32_bf16 a[208:211], a[136:139], v[32:35], a[208:211]
    v_exp_f32 v253, v253
    v_mfma_f32_16x16x32_bf16 a[208:211], a[136:139], v[36:39], a[208:211]
    v_cvt_pk_bf16_f32 v94, v252, v253
    v_mfma_f32_16x16x32_bf16 a[212:215], a[136:139], v[40:43], a[212:215]
    v_mfma_f32_16x16x32_bf16 a[212:215], a[136:139], v[44:47], a[212:215]
    v_mfma_f32_16x16x32_bf16 a[216:219], a[136:139], v[48:51], a[216:219]
    v_mfma_f32_16x16x32_bf16 a[216:219], a[136:139], v[52:55], a[216:219]
    v_mfma_f32_16x16x32_bf16 a[220:223], a[136:139], v[56:59], a[220:223]
    v_mfma_f32_16x16x32_bf16 a[220:223], a[136:139], v[60:63], a[220:223]
    s_cmp_eq_u32 s6, 7
    s_cselect_b32 s16, s8, 0
    s_cselect_b32 s17, s9, 0
    s_cselect_b32 s18, s10, 0
    s_cselect_b32 s19, s11, 0
    s_cselect_b32 s20, s12, 0
    s_cselect_b32 s21, s13, 0
    s_cselect_b32 s22, s14, 0
    s_cselect_b32 s23, s15, 0
    v_add_f32 v212, s20, v152
    v_fma_f32 v176, v208, s16, v212
    v_fma_f32 v177, v209, s16, v212
    v_fma_f32 v178, v210, s16, v212
    v_fma_f32 v179, v211, s16, v212
    s_nop 1
    s_waitcnt lgkmcnt(0)
    v_mfma_f32_16x16x32_bf16 v[240:243], a[224:227], v[136:139], v[176:179]
    s_add_u32 m0, s76, s75
    v_exp_f32 v254, v254
    v_mfma_f32_16x16x32_bf16 v[240:243], a[228:231], v[168:171], v[240:243]
    s_mov_b32 s76, s60
    buffer_load_dwordx4 v1, s[36:39], s77 offen sc1 lds
    v_mfma_f32_16x16x32_bf16 v[240:243], a[232:235], v[200:203], v[240:243]
    s_mov_b32 s60, s82
    v_exp_f32 v255, v255
    v_mfma_f32_16x16x32_bf16 v[240:243], a[236:239], v[232:235], v[240:243]
    s_add_u32 s82, s82, 32768
    ds_read_b128 v[104:107], v2 offset:18432
    v_cvt_pk_bf16_f32 v95, v254, v255
    v_mfma_f32_16x16x32_bf16 a[4:7], v[96:99], v[72:75], a[4:7]
    ds_read_b128 v[108:111], v2 offset:19456
    ds_read_b128 a[240:243], v2 offset:4096
    v_mfma_f32_16x16x32_bf16 a[4:7], v[100:103], v[76:79], a[4:7]
    ds_read_b128 a[244:247], v2 offset:5120
    ds_read_b128 a[248:251], v2 offset:6144
    v_mfma_f32_16x16x32_bf16 a[8:11], v[96:99], v[80:83], a[8:11]
    ds_read_b128 a[252:255], v2 offset:7168
    ds_read_b128 v[112:115], v2 offset:20480
    v_mfma_f32_16x16x32_bf16 a[8:11], v[100:103], v[84:87], a[8:11]
    v_add_f32 v213, s21, v152
    ds_read_b128 v[116:119], v2 offset:21504
    v_mfma_f32_16x16x32_bf16 a[12:15], v[96:99], v[88:91], a[12:15]
    v_fma_f32 v180, v208, s17, v213
    v_fma_f32 v181, v209, s17, v213
    v_mfma_f32_16x16x32_bf16 a[12:15], v[100:103], v[92:95], a[12:15]
    buffer_load_dwordx4 v1, s[36:39], s77 offen offset:1024 sc1 lds
    v_mfma_f32_16x16x32_bf16 v[244:247], a[224:227], v[140:143], v[156:159]
    v_fma_f32 v182, v210, s17, v213
    v_fma_f32 v183, v211, s17, v213
    v_mfma_f32_16x16x32_bf16 v[244:247], a[228:231], v[172:175], v[244:247]
    ds_read_b128 v[120:123], v2 offset:22528
    ds_read_b128 v[124:127], v2 offset:23552
    v_mfma_f32_16x16x32_bf16 v[244:247], a[232:235], v[204:207], v[244:247]
    ds_read_b128 a[224:227], v2 offset:8192
    ds_read_b128 a[228:231], v2 offset:9216
    v_mfma_f32_16x16x32_bf16 v[244:247], a[236:239], v[236:239], v[244:247]
    s_waitcnt lgkmcnt(4)
    ds_read_b128 a[232:235], v2 offset:10240
    ds_read_b128 a[236:239], v2 offset:11264
    v_mfma_f32_16x16x32_bf16 a[20:23], v[104:107], v[72:75], a[20:23]
    ds_read_b128 v[96:99], v2 offset:24576
    v_add_f32 v214, s22, v152
    v_mfma_f32_16x16x32_bf16 a[20:23], v[108:111], v[76:79], a[20:23]
    ds_read_b128 v[100:103], v2 offset:25600
    v_fma_f32 v184, v208, s18, v214
    v_mfma_f32_16x16x32_bf16 a[24:27], v[104:107], v[80:83], a[24:27]
    v_exp_f32 v240, v240
    v_mfma_f32_16x16x32_bf16 a[24:27], v[108:111], v[84:87], a[24:27]
    buffer_load_dwordx4 v1, s[36:39], s77 offen offset:2048 sc1 lds
    v_mfma_f32_16x16x32_bf16 a[28:31], v[104:107], v[88:91], a[28:31]
    v_exp_f32 v241, v241
    v_mfma_f32_16x16x32_bf16 a[28:31], v[108:111], v[92:95], a[28:31]
    v_exp_f32 v242, v242
    v_mfma_f32_16x16x32_bf16 v[248:251], a[240:243], v[136:139], v[180:183]
    v_exp_f32 v243, v243
    v_mfma_f32_16x16x32_bf16 v[248:251], a[244:247], v[168:171], v[248:251]
    v_fma_f32 v185, v209, s18, v214
    v_fma_f32 v186, v210, s18, v214
    v_mfma_f32_16x16x32_bf16 v[248:251], a[248:251], v[200:203], v[248:251]
    v_fma_f32 v187, v211, s18, v214
    v_cvt_pk_bf16_f32 v48, v240, v241
    v_mfma_f32_16x16x32_bf16 v[248:251], a[252:255], v[232:235], v[248:251]
    v_cvt_pk_bf16_f32 v49, v242, v243
    ds_read_b128 v[104:107], v2 offset:26624
    v_mfma_f32_16x16x32_bf16 a[36:39], v[112:115], v[72:75], a[36:39]
    ds_read_b128 v[108:111], v2 offset:27648
    v_add_f32 v215, s23, v152
    v_mfma_f32_16x16x32_bf16 a[36:39], v[116:119], v[76:79], a[36:39]
    buffer_load_dwordx4 v1, s[36:39], s77 offen offset:3072 sc1 lds
    v_mfma_f32_16x16x32_bf16 a[40:43], v[112:115], v[80:83], a[40:43]
    v_exp_f32 v244, v244
    v_mfma_f32_16x16x32_bf16 a[40:43], v[116:119], v[84:87], a[40:43]
    v_exp_f32 v245, v245
    v_mfma_f32_16x16x32_bf16 a[44:47], v[112:115], v[88:91], a[44:47]
    v_exp_f32 v246, v246
    v_mfma_f32_16x16x32_bf16 a[44:47], v[116:119], v[92:95], a[44:47]
    v_exp_f32 v247, v247
    v_mfma_f32_16x16x32_bf16 v[252:255], a[240:243], v[140:143], v[156:159]
    v_cvt_pk_bf16_f32 v56, v244, v245
    v_cvt_pk_bf16_f32 v57, v246, v247
    v_mfma_f32_16x16x32_bf16 v[252:255], a[244:247], v[172:175], v[252:255]
    ds_read_b128 a[240:243], v2 offset:12288
    ds_read_b128 a[244:247], v2 offset:13312
    v_mfma_f32_16x16x32_bf16 v[252:255], a[248:251], v[204:207], v[252:255]
    s_add_u32 s100, s77, 4096
    ds_read_b128 a[248:251], v2 offset:14336
    ds_read_b128 v[112:115], v2 offset:28672
    v_mfma_f32_16x16x32_bf16 v[252:255], a[252:255], v[236:239], v[252:255]
    s_add_u32 m0, m0, 4096
    ds_read_b128 a[252:255], v2 offset:15360
    s_waitcnt lgkmcnt(5)
    ds_read_b128 v[116:119], v2 offset:29696
    v_mfma_f32_16x16x32_bf16 a[52:55], v[120:123], v[72:75], a[52:55]
    buffer_load_dwordx4 v1, s[36:39], s100 offen sc1 lds
    v_mfma_f32_16x16x32_bf16 a[52:55], v[124:127], v[76:79], a[52:55]
    v_exp_f32 v248, v248
    v_mfma_f32_16x16x32_bf16 a[56:59], v[120:123], v[80:83], a[56:59]
    v_exp_f32 v249, v249
    v_mfma_f32_16x16x32_bf16 a[56:59], v[124:127], v[84:87], a[56:59]
    v_exp_f32 v250, v250
    v_mfma_f32_16x16x32_bf16 a[60:63], v[120:123], v[88:91], a[60:63]
    v_exp_f32 v251, v251
    v_mfma_f32_16x16x32_bf16 a[60:63], v[124:127], v[92:95], a[60:63]
    v_fma_f32 v188, v208, s19, v215
    v_fma_f32 v189, v209, s19, v215
    v_mfma_f32_16x16x32_bf16 v[240:243], a[224:227], v[136:139], v[184:187]
    v_fma_f32 v190, v210, s19, v215
    v_fma_f32 v191, v211, s19, v215
    v_mfma_f32_16x16x32_bf16 v[240:243], a[228:231], v[168:171], v[240:243]
    buffer_load_dwordx4 v1, s[36:39], s100 offen offset:1024 sc1 lds
    v_mfma_f32_16x16x32_bf16 v[240:243], a[232:235], v[200:203], v[240:243]
    v_cvt_pk_bf16_f32 v50, v248, v249
    v_cvt_pk_bf16_f32 v51, v250, v251
    v_mfma_f32_16x16x32_bf16 v[240:243], a[236:239], v[232:235], v[240:243]
    ds_read_b128 v[120:123], v2 offset:30720
    ds_read_b128 v[124:127], v2 offset:31744
    v_mfma_f32_16x16x32_bf16 a[148:151], v[96:99], v[72:75], a[148:151]
    v_exp_f32 v252, v252
    v_mfma_f32_16x16x32_bf16 a[148:151], v[100:103], v[76:79], a[148:151]
    v_exp_f32 v253, v253
    v_mfma_f32_16x16x32_bf16 a[152:155], v[96:99], v[80:83], a[152:155]
    v_exp_f32 v254, v254
    v_mfma_f32_16x16x32_bf16 a[152:155], v[100:103], v[84:87], a[152:155]
    v_exp_f32 v255, v255
    v_mfma_f32_16x16x32_bf16 a[156:159], v[96:99], v[88:91], a[156:159]
    v_cvt_pk_bf16_f32 v58, v252, v253
    v_cvt_pk_bf16_f32 v59, v254, v255
    v_mfma_f32_16x16x32_bf16 a[156:159], v[100:103], v[92:95], a[156:159]
    buffer_load_dwordx4 v1, s[36:39], s100 offen offset:2048 sc1 lds
    v_mfma_f32_16x16x32_bf16 v[244:247], a[224:227], v[140:143], v[156:159]
    s_cmp_eq_u32 s82, 163840
    s_cselect_b32 s82, 0, s82
    v_add_u32 v2, s82, v1
    v_mfma_f32_16x16x32_bf16 v[244:247], a[228:231], v[172:175], v[244:247]
    v_exp_f32 v240, v240
    v_mfma_f32_16x16x32_bf16 v[244:247], a[232:235], v[204:207], v[244:247]
    v_exp_f32 v241, v241
    v_mfma_f32_16x16x32_bf16 v[244:247], a[236:239], v[236:239], v[244:247]
    v_exp_f32 v242, v242
    v_mfma_f32_16x16x32_bf16 a[164:167], v[104:107], v[72:75], a[164:167]
    v_exp_f32 v243, v243
    v_mfma_f32_16x16x32_bf16 a[164:167], v[108:111], v[76:79], a[164:167]
    v_cvt_pk_bf16_f32 v52, v240, v241
    v_cvt_pk_bf16_f32 v53, v242, v243
    v_mfma_f32_16x16x32_bf16 a[168:171], v[104:107], v[80:83], a[168:171]
    v_accvgpr_read_b32 v7, a124
    v_cvt_pk_bf16_f32 v7, 0, v7
    v_mfma_f32_16x16x32_bf16 a[168:171], v[108:111], v[84:87], a[168:171]
    buffer_load_dwordx4 v1, s[36:39], s100 offen offset:3072 sc1 lds
    v_mfma_f32_16x16x32_bf16 a[172:175], v[104:107], v[88:91], a[172:175]
    v_exp_f32 v244, v244
    v_mfma_f32_16x16x32_bf16 a[172:175], v[108:111], v[92:95], a[172:175]
    s_waitcnt lgkmcnt(0)
    v_exp_f32 v245, v245
    v_mfma_f32_16x16x32_bf16 v[248:251], a[240:243], v[136:139], v[188:191]
    v_exp_f32 v246, v246
    v_mfma_f32_16x16x32_bf16 v[248:251], a[244:247], v[168:171], v[248:251]
    v_exp_f32 v247, v247
    v_mfma_f32_16x16x32_bf16 v[248:251], a[248:251], v[200:203], v[248:251]
    v_cvt_pk_bf16_f32 v60, v244, v245
    v_cvt_pk_bf16_f32 v61, v246, v247
    v_mfma_f32_16x16x32_bf16 v[248:251], a[252:255], v[232:235], v[248:251]
    ds_bpermute_b32 v7, v8, v7
    s_waitcnt lgkmcnt(0)
    v_mul_f32 v7, s98, v7
    v_mfma_f32_16x16x32_bf16 a[180:183], v[112:115], v[72:75], a[180:183]
    s_add_u32 s77, s77, 32768
    v_exp_f32 v7, v7
    v_mfma_f32_16x16x32_bf16 a[180:183], v[116:119], v[76:79], a[180:183]
    v_add_f32 v7, 1.0, v7
    v_mfma_f32_16x16x32_bf16 a[184:187], v[112:115], v[80:83], a[184:187]
    v_exp_f32 v248, v248
    v_mfma_f32_16x16x32_bf16 a[184:187], v[116:119], v[84:87], a[184:187]
    v_exp_f32 v249, v249
    v_mfma_f32_16x16x32_bf16 a[188:191], v[112:115], v[88:91], a[188:191]
    v_exp_f32 v250, v250
    v_mfma_f32_16x16x32_bf16 a[188:191], v[116:119], v[92:95], a[188:191]
    v_exp_f32 v251, v251
    v_mfma_f32_16x16x32_bf16 v[252:255], a[240:243], v[140:143], v[156:159]
    v_cvt_pk_bf16_f32 v54, v248, v249
    v_cvt_pk_bf16_f32 v55, v250, v251
    v_mfma_f32_16x16x32_bf16 v[252:255], a[244:247], v[172:175], v[252:255]
    v_rcp_f32 v7, v7
    v_mfma_f32_16x16x32_bf16 v[252:255], a[248:251], v[204:207], v[252:255]
    v_mfma_f32_16x16x32_bf16 v[252:255], a[252:255], v[236:239], v[252:255]
    s_waitcnt vmcnt(16)
    s_barrier
    ds_read_b128 a[224:227], v2 offset:0
    v_mfma_f32_16x16x32_bf16 a[196:199], v[120:123], v[72:75], a[196:199]
    ds_read_b128 a[228:231], v2 offset:1024
    ds_read_b128 a[232:235], v2 offset:2048
    v_mfma_f32_16x16x32_bf16 a[196:199], v[124:127], v[76:79], a[196:199]
    ds_read_b128 a[236:239], v2 offset:3072
    ds_read_b128 v[96:99], v2 offset:16384
    v_mfma_f32_16x16x32_bf16 a[200:203], v[120:123], v[80:83], a[200:203]
    ds_read_b128 v[100:103], v2 offset:17408
    v_mfma_f32_16x16x32_bf16 a[200:203], v[124:127], v[84:87], a[200:203]
    v_exp_f32 v252, v252
    v_mfma_f32_16x16x32_bf16 a[204:207], v[120:123], v[88:91], a[204:207]
    v_exp_f32 v253, v253
    v_mfma_f32_16x16x32_bf16 a[204:207], v[124:127], v[92:95], a[204:207]
    v_cvt_pk_bf16_f32 v62, v252, v253
    v_mfma_f32_16x16x32_bf16 a[212:215], a[136:139], v[72:75], a[212:215]
    v_mfma_f32_16x16x32_bf16 a[212:215], a[136:139], v[76:79], a[212:215]
    v_mfma_f32_16x16x32_bf16 a[216:219], a[136:139], v[80:83], a[216:219]
    v_mfma_f32_16x16x32_bf16 a[216:219], a[136:139], v[84:87], a[216:219]
    v_mfma_f32_16x16x32_bf16 a[220:223], a[136:139], v[88:91], a[220:223]
    v_mfma_f32_16x16x32_bf16 a[220:223], a[136:139], v[92:95], a[220:223]
    s_nop 7
    v_accvgpr_read_b32 v8, a208
    v_cmp_nge_f32 vcc, 0x71800000, v8
    v_rcp_f32 v10, v8
    s_nop 0
    s_or_b64 s[84:85], s[84:85], vcc
    v_mul_f32 v10, v10, v4
    v_accvgpr_read_b32 v12, a0
    v_accvgpr_read_b32 v13, a1
    v_accvgpr_read_b32 v14, a2
    v_accvgpr_read_b32 v15, a3
    v_accvgpr_read_b32 v16, a16
    v_accvgpr_read_b32 v17, a17
    v_accvgpr_read_b32 v18, a18
    v_accvgpr_read_b32 v19, a19
    v_pk_mul_f32 v[12:13], v[12:13], v[10:11] op_sel_hi:[1,0]
    v_pk_mul_f32 v[14:15], v[14:15], v[10:11] op_sel_hi:[1,0]
    v_pk_mul_f32 v[16:17], v[16:17], v[10:11] op_sel_hi:[1,0]
    v_pk_mul_f32 v[18:19], v[18:19], v[10:11] op_sel_hi:[1,0]
    v_cvt_pk_bf16_f32 v12, v12, v13
    v_cvt_pk_bf16_f32 v13, v14, v15
    v_cvt_pk_bf16_f32 v14, v16, v17
    v_cvt_pk_bf16_f32 v15, v18, v19
    buffer_store_dwordx4 v[12:15], v1, s[40:43], s80 offen offset:0 sc1
    v_accvgpr_read_b32 v20, a32
    v_accvgpr_read_b32 v21, a33
    v_accvgpr_read_b32 v22, a34
    v_accvgpr_read_b32 v23, a35
    v_accvgpr_read_b32 v24, a48
    v_accvgpr_read_b32 v25, a49
    v_accvgpr_read_b32 v26, a50
    v_accvgpr_read_b32 v27, a51
    v_pk_mul_f32 v[20:21], v[20:21], v[10:11] op_sel_hi:[1,0]
    v_pk_mul_f32 v[22:23], v[22:23], v[10:11] op_sel_hi:[1,0]
    v_pk_mul_f32 v[24:25], v[24:25], v[10:11] op_sel_hi:[1,0]
    v_pk_mul_f32 v[26:27], v[26:27], v[10:11] op_sel_hi:[1,0]
    v_cvt_pk_bf16_f32 v20, v20, v21
    v_cvt_pk_bf16_f32 v21, v22, v23
    v_cvt_pk_bf16_f32 v22, v24, v25
    v_cvt_pk_bf16_f32 v23, v26, v27
    buffer_store_dwordx4 v[20:23], v1, s[40:43], s80 offen offset:1024 sc1
    v_accvgpr_read_b32 v12, a144
    v_accvgpr_read_b32 v13, a145
    v_accvgpr_read_b32 v14, a146
    v_accvgpr_read_b32 v15, a147
    v_accvgpr_read_b32 v16, a160
    v_accvgpr_read_b32 v17, a161
    v_accvgpr_read_b32 v18, a162
    v_accvgpr_read_b32 v19, a163
    v_pk_mul_f32 v[12:13], v[12:13], v[10:11] op_sel_hi:[1,0]
    v_pk_mul_f32 v[14:15], v[14:15], v[10:11] op_sel_hi:[1,0]
    v_pk_mul_f32 v[16:17], v[16:17], v[10:11] op_sel_hi:[1,0]
    v_pk_mul_f32 v[18:19], v[18:19], v[10:11] op_sel_hi:[1,0]
    v_cvt_pk_bf16_f32 v12, v12, v13
    v_cvt_pk_bf16_f32 v13, v14, v15
    v_cvt_pk_bf16_f32 v14, v16, v17
    v_cvt_pk_bf16_f32 v15, v18, v19
    buffer_store_dwordx4 v[12:15], v1, s[40:43], s80 offen offset:2048 sc1
    v_accvgpr_read_b32 v20, a176
    v_accvgpr_read_b32 v21, a177
    v_accvgpr_read_b32 v22, a178
    v_accvgpr_read_b32 v23, a179
    v_accvgpr_read_b32 v24, a192
    v_accvgpr_read_b32 v25, a193
    v_accvgpr_read_b32 v26, a194
    v_accvgpr_read_b32 v27, a195
    v_pk_mul_f32 v[20:21], v[20:21], v[10:11] op_sel_hi:[1,0]
    v_pk_mul_f32 v[22:23], v[22:23], v[10:11] op_sel_hi:[1,0]
    v_pk_mul_f32 v[24:25], v[24:25], v[10:11] op_sel_hi:[1,0]
    v_pk_mul_f32 v[26:27], v[26:27], v[10:11] op_sel_hi:[1,0]
    v_cvt_pk_bf16_f32 v20, v20, v21
    v_cvt_pk_bf16_f32 v21, v22, v23
    v_cvt_pk_bf16_f32 v22, v24, v25
    v_cvt_pk_bf16_f32 v23, v26, v27
    buffer_store_dwordx4 v[20:23], v1, s[40:43], s80 offen offset:3072 sc1
    v_accvgpr_read_b32 v8, a212
    v_cmp_nge_f32 vcc, 0x71800000, v8
    v_rcp_f32 v10, v8
    s_nop 0
    s_or_b64 s[84:85], s[84:85], vcc
    v_mul_f32 v10, v10, v5
    s_add_u32 s72, s80, 598016
    v_accvgpr_read_b32 v12, a4
    v_accvgpr_read_b32 v13, a5
    v_accvgpr_read_b32 v14, a6
    v_accvgpr_read_b32 v15, a7
    v_accvgpr_read_b32 v16, a20
    v_accvgpr_read_b32 v17, a21
    v_accvgpr_read_b32 v18, a22
    v_accvgpr_read_b32 v19, a23
    v_pk_mul_f32 v[12:13], v[12:13], v[10:11] op_sel_hi:[1,0]
    v_pk_mul_f32 v[14:15], v[14:15], v[10:11] op_sel_hi:[1,0]
    v_pk_mul_f32 v[16:17], v[16:17], v[10:11] op_sel_hi:[1,0]
    v_pk_mul_f32 v[18:19], v[18:19], v[10:11] op_sel_hi:[1,0]
    v_cvt_pk_bf16_f32 v12, v12, v13
    v_cvt_pk_bf16_f32 v13, v14, v15
    v_cvt_pk_bf16_f32 v14, v16, v17
    v_cvt_pk_bf16_f32 v15, v18, v19
    buffer_store_dwordx4 v[12:15], v1, s[40:43], s72 offen offset:0 sc1
    v_accvgpr_read_b32 v20, a36
    v_accvgpr_read_b32 v21, a37
    v_accvgpr_read_b32 v22, a38
    v_accvgpr_read_b32 v23, a39
    v_accvgpr_read_b32 v24, a52
    v_accvgpr_read_b32 v25, a53
    v_accvgpr_read_b32 v26, a54
    v_accvgpr_read_b32 v27, a55
    v_pk_mul_f32 v[20:21], v[20:21], v[10:11] op_sel_hi:[1,0]
    v_pk_mul_f32 v[22:23], v[22:23], v[10:11] op_sel_hi:[1,0]
    v_pk_mul_f32 v[24:25], v[24:25], v[10:11] op_sel_hi:[1,0]
    v_pk_mul_f32 v[26:27], v[26:27], v[10:11] op_sel_hi:[1,0]
    v_cvt_pk_bf16_f32 v20, v20, v21
    v_cvt_pk_bf16_f32 v21, v22, v23
    v_cvt_pk_bf16_f32 v22, v24, v25
    v_cvt_pk_bf16_f32 v23, v26, v27
    buffer_store_dwordx4 v[20:23], v1, s[40:43], s72 offen offset:1024 sc1
    v_accvgpr_read_b32 v12, a148
    v_accvgpr_read_b32 v13, a149
    v_accvgpr_read_b32 v14, a150
    v_accvgpr_read_b32 v15, a151
    v_accvgpr_read_b32 v16, a164
    v_accvgpr_read_b32 v17, a165
    v_accvgpr_read_b32 v18, a166
    v_accvgpr_read_b32 v19, a167
    v_pk_mul_f32 v[12:13], v[12:13], v[10:11] op_sel_hi:[1,0]
    v_pk_mul_f32 v[14:15], v[14:15], v[10:11] op_sel_hi:[1,0]
    v_pk_mul_f32 v[16:17], v[16:17], v[10:11] op_sel_hi:[1,0]
    v_pk_mul_f32 v[18:19], v[18:19], v[10:11] op_sel_hi:[1,0]
    v_cvt_pk_bf16_f32 v12, v12, v13
    v_cvt_pk_bf16_f32 v13, v14, v15
    v_cvt_pk_bf16_f32 v14, v16, v17
    v_cvt_pk_bf16_f32 v15, v18, v19
    buffer_store_dwordx4 v[12:15], v1, s[40:43], s72 offen offset:2048 sc1
    v_accvgpr_read_b32 v20, a180
    v_accvgpr_read_b32 v21, a181
    v_accvgpr_read_b32 v22, a182
    v_accvgpr_read_b32 v23, a183
    v_accvgpr_read_b32 v24, a196
    v_accvgpr_read_b32 v25, a197
    v_accvgpr_read_b32 v26, a198
    v_accvgpr_read_b32 v27, a199
    v_pk_mul_f32 v[20:21], v[20:21], v[10:11] op_sel_hi:[1,0]
    v_pk_mul_f32 v[22:23], v[22:23], v[10:11] op_sel_hi:[1,0]
    v_pk_mul_f32 v[24:25], v[24:25], v[10:11] op_sel_hi:[1,0]
    v_pk_mul_f32 v[26:27], v[26:27], v[10:11] op_sel_hi:[1,0]
    v_cvt_pk_bf16_f32 v20, v20, v21
    v_cvt_pk_bf16_f32 v21, v22, v23
    v_cvt_pk_bf16_f32 v22, v24, v25
    v_cvt_pk_bf16_f32 v23, v26, v27
    buffer_store_dwordx4 v[20:23], v1, s[40:43], s72 offen offset:3072 sc1
    s_sub_u32 s78, 14, s6
    s_sub_u32 s78, s78, s6
    s_cmp_eq_u32 s78, 0
    s_cbranch_scc1 K1_LS_END
.p2align 3
K1_LS:
    s_waitcnt lgkmcnt(0)
    v_mfma_f32_16x16x32_bf16 v[240:243], a[224:227], v[136:139], v[176:179]
    s_add_u32 m0, s76, s75
    v_exp_f32 v254, v254
    v_mfma_f32_16x16x32_bf16 v[240:243], a[228:231], v[168:171], v[240:243]
    s_mov_b32 s76, s60
    v_exp_f32 v255, v255
    v_mfma_f32_16x16x32_bf16 v[240:243], a[232:235], v[200:203], v[240:243]
    s_mov_b32 s60, s82
    buffer_load_dwordx4 v1, s[36:39], s77 offen sc1 lds
    v_mfma_f32_16x16x32_bf16 v[240:243], a[236:239], v[232:235], v[240:243]
    s_add_u32 s82, s82, 32768
    ds_read_b128 v[104:107], v2 offset:18432
    v_cvt_pk_bf16_f32 v63, v254, v255
    v_mfma_f32_16x16x32_bf16 a[8:11], v[96:99], v[48:51], a[8:11]
    ds_read_b128 v[108:111], v2 offset:19456
    ds_read_b128 a[240:243], v2 offset:4096
    v_mfma_f32_16x16x32_bf16 a[8:11], v[100:103], v[52:55], a[8:11]
    ds_read_b128 a[244:247], v2 offset:5120
    ds_read_b128 a[248:251], v2 offset:6144
    v_mfma_f32_16x16x32_bf16 a[12:15], v[96:99], v[56:59], a[12:15]
    buffer_load_dwordx4 v1, s[36:39], s77 offen offset:1024 sc1 lds
    v_mfma_f32_16x16x32_bf16 a[12:15], v[100:103], v[60:63], a[12:15]
    ds_read_b128 a[252:255], v2 offset:7168
    ds_read_b128 v[112:115], v2 offset:20480
    v_mfma_f32_16x16x32_bf16 v[244:247], a[224:227], v[140:143], v[156:159]
    ds_read_b128 v[116:119], v2 offset:21504
    ds_read_b128 v[120:123], v2 offset:22528
    v_mfma_f32_16x16x32_bf16 v[244:247], a[228:231], v[172:175], v[244:247]
    ds_read_b128 v[124:127], v2 offset:23552
    ds_read_b128 a[224:227], v2 offset:8192
    v_mfma_f32_16x16x32_bf16 v[244:247], a[232:235], v[204:207], v[244:247]
    ds_read_b128 a[228:231], v2 offset:9216
    ds_read_b128 a[232:235], v2 offset:10240
    v_mfma_f32_16x16x32_bf16 v[244:247], a[236:239], v[236:239], v[244:247]
    s_waitcnt lgkmcnt(8)
    ds_read_b128 a[236:239], v2 offset:11264
    ds_read_b128 v[96:99], v2 offset:24576
    v_mfma_f32_16x16x32_bf16 a[24:27], v[104:107], v[48:51], a[24:27]
    buffer_load_dwordx4 v1, s[36:39], s77 offen offset:2048 sc1 lds
    v_mfma_f32_16x16x32_bf16 a[24:27], v[108:111], v[52:55], a[24:27]
    ds_read_b128 v[100:103], v2 offset:25600
    v_mfma_f32_16x16x32_bf16 a[28:31], v[104:107], v[56:59], a[28:31]
    v_exp_f32 v240, v240
    v_mfma_f32_16x16x32_bf16 a[28:31], v[108:111], v[60:63], a[28:31]
    v_exp_f32 v241, v241
    v_mfma_f32_16x16x32_bf16 v[248:251], a[240:243], v[136:139], v[180:183]
    v_exp_f32 v242, v242
    v_mfma_f32_16x16x32_bf16 v[248:251], a[244:247], v[168:171], v[248:251]
    v_exp_f32 v243, v243
    v_mfma_f32_16x16x32_bf16 v[248:251], a[248:251], v[200:203], v[248:251]
    s_waitcnt lgkmcnt(0)
    buffer_load_dwordx4 v1, s[36:39], s77 offen offset:3072 sc1 lds
    v_mfma_f32_16x16x32_bf16 v[248:251], a[252:255], v[232:235], v[248:251]
    v_cvt_pk_bf16_f32 v80, v240, v241
    v_cvt_pk_bf16_f32 v81, v242, v243
    v_mfma_f32_16x16x32_bf16 a[40:43], v[112:115], v[48:51], a[40:43]
    ds_read_b128 v[104:107], v2 offset:26624
    ds_read_b128 v[108:111], v2 offset:27648
    v_mfma_f32_16x16x32_bf16 a[40:43], v[116:119], v[52:55], a[40:43]
    v_exp_f32 v244, v244
    v_mfma_f32_16x16x32_bf16 a[44:47], v[112:115], v[56:59], a[44:47]
    v_exp_f32 v245, v245
    v_mfma_f32_16x16x32_bf16 a[44:47], v[116:119], v[60:63], a[44:47]
    s_add_u32 s100, s77, 4096
    v_exp_f32 v246, v246
    v_mfma_f32_16x16x32_bf16 v[252:255], a[240:243], v[140:143], v[156:159]
    s_add_u32 m0, m0, 4096
    v_exp_f32 v247, v247
    v_mfma_f32_16x16x32_bf16 v[252:255], a[244:247], v[172:175], v[252:255]
    buffer_load_dwordx4 v1, s[36:39], s100 offen sc1 lds
    v_mfma_f32_16x16x32_bf16 v[252:255], a[248:251], v[204:207], v[252:255]
    v_cvt_pk_bf16_f32 v88, v244, v245
    v_cvt_pk_bf16_f32 v89, v246, v247
    v_mfma_f32_16x16x32_bf16 v[252:255], a[252:255], v[236:239], v[252:255]
    ds_read_b128 a[240:243], v2 offset:12288
    ds_read_b128 a[244:247], v2 offset:13312
    v_mfma_f32_16x16x32_bf16 a[56:59], v[120:123], v[48:51], a[56:59]
    ds_read_b128 a[248:251], v2 offset:14336
    ds_read_b128 a[252:255], v2 offset:15360
    v_mfma_f32_16x16x32_bf16 a[56:59], v[124:127], v[52:55], a[56:59]
    buffer_load_dwordx4 v1, s[36:39], s100 offen offset:1024 sc1 lds
    v_mfma_f32_16x16x32_bf16 a[60:63], v[120:123], v[56:59], a[60:63]
    ds_read_b128 v[112:115], v2 offset:28672
    ds_read_b128 v[116:119], v2 offset:29696
    v_mfma_f32_16x16x32_bf16 a[60:63], v[124:127], v[60:63], a[60:63]
    v_exp_f32 v248, v248
    v_mfma_f32_16x16x32_bf16 v[240:243], a[224:227], v[136:139], v[184:187]
    v_exp_f32 v249, v249
    v_mfma_f32_16x16x32_bf16 v[240:243], a[228:231], v[168:171], v[240:243]
    v_exp_f32 v250, v250
    v_mfma_f32_16x16x32_bf16 v[240:243], a[232:235], v[200:203], v[240:243]
    v_exp_f32 v251, v251
    v_mfma_f32_16x16x32_bf16 v[240:243], a[236:239], v[232:235], v[240:243]
    buffer_load_dwordx4 v1, s[36:39], s100 offen offset:2048 sc1 lds
    v_mfma_f32_16x16x32_bf16 a[152:155], v[96:99], v[48:51], a[152:155]
    v_cvt_pk_bf16_f32 v82, v248, v249
    v_cvt_pk_bf16_f32 v83, v250, v251
    v_mfma_f32_16x16x32_bf16 a[152:155], v[100:103], v[52:55], a[152:155]
    ds_read_b128 v[120:123], v2 offset:30720
    ds_read_b128 v[124:127], v2 offset:31744
    v_mfma_f32_16x16x32_bf16 a[156:159], v[96:99], v[56:59], a[156:159]
    v_exp_f32 v252, v252
    v_mfma_f32_16x16x32_bf16 a[156:159], v[100:103], v[60:63], a[156:159]
    v_exp_f32 v253, v253
    v_mfma_f32_16x16x32_bf16 v[244:247], a[224:227], v[140:143], v[156:159]
    v_exp_f32 v254, v254
    v_mfma_f32_16x16x32_bf16 v[244:247], a[228:231], v[172:175], v[244:247]
    buffer_load_dwordx4 v1, s[36:39], s100 offen offset:3072 sc1 lds
    v_mfma_f32_16x16x32_bf16 v[244:247], a[232:235], v[204:207], v[244:247]
    v_exp_f32 v255, v255
    v_mfma_f32_16x16x32_bf16 v[244:247], a[236:239], v[236:239], v[244:247]
    s_cmp_eq_u32 s82, 163840
    s_cselect_b32 s82, 0, s82
    v_cvt_pk_bf16_f32 v90, v252, v253
    s_waitcnt lgkmcnt(0)
    v_mfma_f32_16x16x32_bf16 a[168:171], v[104:107], v[48:51], a[168:171]
    v_cvt_pk_bf16_f32 v91, v254, v255
    v_add_u32 v2, s82, v1
    v_mfma_f32_16x16x32_bf16 a[168:171], v[108:111], v[52:55], a[168:171]
    v_exp_f32 v240, v240
    v_mfma_f32_16x16x32_bf16 a[172:175], v[104:107], v[56:59], a[172:175]
    s_add_u32 s77, s77, 32768
    v_exp_f32 v241, v241
    v_mfma_f32_16x16x32_bf16 a[172:175], v[108:111], v[60:63], a[172:175]
    v_exp_f32 v242, v242
    v_mfma_f32_16x16x32_bf16 v[248:251], a[240:243], v[136:139], v[188:191]
    v_exp_f32 v243, v243
    v_mfma_f32_16x16x32_bf16 v[248:251], a[244:247], v[168:171], v[248:251]
    v_exp_f32 v244, v244
    v_mfma_f32_16x16x32_bf16 v[248:251], a[248:251], v[200:203], v[248:251]
    v_exp_f32 v245, v245
    v_mfma_f32_16x16x32_bf16 v[248:251], a[252:255], v[232:235], v[248:251]
    v_exp_f32 v246, v246
    v_mfma_f32_16x16x32_bf16 a[184:187], v[112:115], v[48:51], a[184:187]
    v_exp_f32 v247, v247
    v_mfma_f32_16x16x32_bf16 a[184:187], v[116:119], v[52:55], a[184:187]
    v_cvt_pk_bf16_f32 v84, v240, v241
    v_cvt_pk_bf16_f32 v85, v242, v243
    v_mfma_f32_16x16x32_bf16 a[188:191], v[112:115], v[56:59], a[188:191]
    v_cvt_pk_bf16_f32 v92, v244, v245
    v_cvt_pk_bf16_f32 v93, v246, v247
    v_mfma_f32_16x16x32_bf16 a[188:191], v[116:119], v[60:63], a[188:191]
    s_waitcnt vmcnt(16)
    s_barrier
    ds_read_b128 a[224:227], v2 offset:0
    v_mfma_f32_16x16x32_bf16 v[252:255], a[240:243], v[140:143], v[156:159]
    ds_read_b128 a[228:231], v2 offset:1024
    ds_read_b128 a[232:235], v2 offset:2048
    v_mfma_f32_16x16x32_bf16 v[252:255], a[244:247], v[172:175], v[252:255]
    ds_read_b128 a[236:239], v2 offset:3072
    ds_read_b128 v[96:99], v2 offset:16384
    v_mfma_f32_16x16x32_bf16 v[252:255], a[248:251], v[204:207], v[252:255]
    ds_read_b128 v[100:103], v2 offset:17408
    v_mfma_f32_16x16x32_bf16 v[252:255], a[252:255], v[236:239], v[252:255]
    v_exp_f32 v248, v248
    v_mfma_f32_16x16x32_bf16 a[200:203], v[120:123], v[48:51], a[200:203]
    v_exp_f32 v249, v249
    v_mfma_f32_16x16x32_bf16 a[200:203], v[124:127], v[52:55], a[200:203]
    v_exp_f32 v250, v250
    v_mfma_f32_16x16x32_bf16 a[204:207], v[120:123], v[56:59], a[204:207]
    v_exp_f32 v251, v251
    v_mfma_f32_16x16x32_bf16 a[204:207], v[124:127], v[60:63], a[204:207]
    v_exp_f32 v252, v252
    v_mfma_f32_16x16x32_bf16 a[216:219], a[136:139], v[48:51], a[216:219]
    v_exp_f32 v253, v253
    v_mfma_f32_16x16x32_bf16 a[216:219], a[136:139], v[52:55], a[216:219]
    v_cvt_pk_bf16_f32 v86, v248, v249
    v_cvt_pk_bf16_f32 v87, v250, v251
    v_mfma_f32_16x16x32_bf16 a[220:223], a[136:139], v[56:59], a[220:223]
    v_cvt_pk_bf16_f32 v94, v252, v253
    v_mfma_f32_16x16x32_bf16 a[220:223], a[136:139], v[60:63], a[220:223]
    s_cmp_eq_u32 s78, 1
    s_cbranch_scc1 K1_LS_MASK
K1_LS_BACK:
    s_waitcnt lgkmcnt(0)
    v_mfma_f32_16x16x32_bf16 v[240:243], a[224:227], v[136:139], v[176:179]
    s_add_u32 m0, s76, s75
    v_exp_f32 v254, v254
    v_mfma_f32_16x16x32_bf16 v[240:243], a[228:231], v[168:171], v[240:243]
    s_mov_b32 s76, s60
    v_exp_f32 v255, v255
    v_mfma_f32_16x16x32_bf16 v[240:243], a[232:235], v[200:203], v[240:243]
    s_mov_b32 s60, s82
    buffer_load_dwordx4 v1, s[36:39], s77 offen sc1 lds
    v_mfma_f32_16x16x32_bf16 v[240:243], a[236:239], v[232:235], v[240:243]
    s_add_u32 s82, s82, 32768
    ds_read_b128 v[104:107], v2 offset:18432
    v_cvt_pk_bf16_f32 v95, v254, v255
    v_mfma_f32_16x16x32_bf16 a[8:11], v[96:99], v[80:83], a[8:11]
    ds_read_b128 v[108:111], v2 offset:19456
    ds_read_b128 a[240:243], v2 offset:4096
    v_mfma_f32_16x16x32_bf16 a[8:11], v[100:103], v[84:87], a[8:11]
    ds_read_b128 a[244:247], v2 offset:5120
    ds_read_b128 a[248:251], v2 offset:6144
    v_mfma_f32_16x16x32_bf16 a[12:15], v[96:99], v[88:91], a[12:15]
    buffer_load_dwordx4 v1, s[36:39], s77 offen offset:1024 sc1 lds
    v_mfma_f32_16x16x32_bf16 a[12:15], v[100:103], v[92:95], a[12:15]
    ds_read_b128 a[252:255], v2 offset:7168
    ds_read_b128 v[112:115], v2 offset:20480
    v_mfma_f32_16x16x32_bf16 v[244:247], a[224:227], v[140:143], v[156:159]
    ds_read_b128 v[116:119], v2 offset:21504
    ds_read_b128 v[120:123], v2 offset:22528
    v_mfma_f32_16x16x32_bf16 v[244:247], a[228:231], v[172:175], v[244:247]
    ds_read_b128 v[124:127], v2 offset:23552
    ds_read_b128 a[224:227], v2 offset:8192
    v_mfma_f32_16x16x32_bf16 v[244:247], a[232:235], v[204:207], v[244:247]
    ds_read_b128 a[228:231], v2 offset:9216
    ds_read_b128 a[232:235], v2 offset:10240
    v_mfma_f32_16x16x32_bf16 v[244:247], a[236:239], v[236:239], v[244:247]
    s_waitcnt lgkmcnt(8)
    ds_read_b128 a[236:239], v2 offset:11264
    ds_read_b128 v[96:99], v2 offset:24576
    v_mfma_f32_16x16x32_bf16 a[24:27], v[104:107], v[80:83], a[24:27]
    buffer_load_dwordx4 v1, s[36:39], s77 offen offset:2048 sc1 lds
    v_mfma_f32_16x16x32_bf16 a[24:27], v[108:111], v[84:87], a[24:27]
    ds_read_b128 v[100:103], v2 offset:25600
    v_mfma_f32_16x16x32_bf16 a[28:31], v[104:107], v[88:91], a[28:31]
    v_exp_f32 v240, v240
    v_mfma_f32_16x16x32_bf16 a[28:31], v[108:111], v[92:95], a[28:31]
    v_exp_f32 v241, v241
    v_mfma_f32_16x16x32_bf16 v[248:251], a[240:243], v[136:139], v[180:183]
    v_exp_f32 v242, v242
    v_mfma_f32_16x16x32_bf16 v[248:251], a[244:247], v[168:171], v[248:251]
    v_exp_f32 v243, v243
    v_mfma_f32_16x16x32_bf16 v[248:251], a[248:251], v[200:203], v[248:251]
    s_waitcnt lgkmcnt(0)
    buffer_load_dwordx4 v1, s[36:39], s77 offen offset:3072 sc1 lds
    v_mfma_f32_16x16x32_bf16 v[248:251], a[252:255], v[232:235], v[248:251]
    v_cvt_pk_bf16_f32 v48, v240, v241
    v_cvt_pk_bf16_f32 v49, v242, v243
    v_mfma_f32_16x16x32_bf16 a[40:43], v[112:115], v[80:83], a[40:43]
    ds_read_b128 v[104:107], v2 offset:26624
    ds_read_b128 v[108:111], v2 offset:27648
    v_mfma_f32_16x16x32_bf16 a[40:43], v[116:119], v[84:87], a[40:43]
    v_exp_f32 v244, v244
    v_mfma_f32_16x16x32_bf16 a[44:47], v[112:115], v[88:91], a[44:47]
    v_exp_f32 v245, v245
    v_mfma_f32_16x16x32_bf16 a[44:47], v[116:119], v[92:95], a[44:47]
    s_add_u32 s100, s77, 4096
    v_exp_f32 v246, v246
    v_mfma_f32_16x16x32_bf16 v[252:255], a[240:243], v[140:143], v[156:159]
    s_add_u32 m0, m0, 4096
    v_exp_f32 v247, v247
    v_mfma_f32_16x16x32_bf16 v[252:255], a[244:247], v[172:175], v[252:255]
    buffer_load_dwordx4 v1, s[36:39], s100 offen sc1 lds
    v_mfma_f32_16x16x32_bf16 v[252:255], a[248:251], v[204:207], v[252:255]
    v_cvt_pk_bf16_f32 v56, v244, v245
    v_cvt_pk_bf16_f32 v57, v246, v247
    v_mfma_f32_16x16x32_bf16 v[252:255], a[252:255], v[236:239], v[252:255]
    ds_read_b128 a[240:243], v2 offset:12288
    ds_read_b128 a[244:247], v2 offset:13312
    v_mfma_f32_16x16x32_bf16 a[56:59], v[120:123], v[80:83], a[56:59]
    ds_read_b128 a[248:251], v2 offset:14336
    ds_read_b128 a[252:255], v2 offset:15360
    v_mfma_f32_16x16x32_bf16 a[56:59], v[124:127], v[84:87], a[56:59]
    buffer_load_dwordx4 v1, s[36:39], s100 offen offset:1024 sc1 lds
    v_mfma_f32_16x16x32_bf16 a[60:63], v[120:123], v[88:91], a[60:63]
    ds_read_b128 v[112:115], v2 offset:28672
    ds_read_b128 v[116:119], v2 offset:29696
    v_mfma_f32_16x16x32_bf16 a[60:63], v[124:127], v[92:95], a[60:63]
    v_exp_f32 v248, v248
    v_mfma_f32_16x16x32_bf16 v[240:243], a[224:227], v[136:139], v[184:187]
    v_exp_f32 v249, v249
    v_mfma_f32_16x16x32_bf16 v[240:243], a[228:231], v[168:171], v[240:243]
    v_exp_f32 v250, v250
    v_mfma_f32_16x16x32_bf16 v[240:243], a[232:235], v[200:203], v[240:243]
    v_exp_f32 v251, v251
    v_mfma_f32_16x16x32_bf16 v[240:243], a[236:239], v[232:235], v[240:243]
    buffer_load_dwordx4 v1, s[36:39], s100 offen offset:2048 sc1 lds
    v_mfma_f32_16x16x32_bf16 a[152:155], v[96:99], v[80:83], a[152:155]
    v_cvt_pk_bf16_f32 v50, v248, v249
    v_cvt_pk_bf16_f32 v51, v250, v251
    v_mfma_f32_16x16x32_bf16 a[152:155], v[100:103], v[84:87], a[152:155]
    ds_read_b128 v[120:123], v2 offset:30720
    ds_read_b128 v[124:127], v2 offset:31744
    v_mfma_f32_16x16x32_bf16 a[156:159], v[96:99], v[88:91], a[156:159]
    v_exp_f32 v252, v252
    v_mfma_f32_16x16x32_bf16 a[156:159], v[100:103], v[92:95], a[156:159]
    v_exp_f32 v253, v253
    v_mfma_f32_16x16x32_bf16 v[244:247], a[224:227], v[140:143], v[156:159]
    v_exp_f32 v254, v254
    v_mfma_f32_16x16x32_bf16 v[244:247], a[228:231], v[172:175], v[244:247]
    buffer_load_dwordx4 v1, s[36:39], s100 offen offset:3072 sc1 lds
    v_mfma_f32_16x16x32_bf16 v[244:247], a[232:235], v[204:207], v[244:247]
    v_exp_f32 v255, v255
    v_mfma_f32_16x16x32_bf16 v[244:247], a[236:239], v[236:239], v[244:247]
    s_cmp_eq_u32 s82, 163840
    s_cselect_b32 s82, 0, s82
    v_cvt_pk_bf16_f32 v58, v252, v253
    s_waitcnt lgkmcnt(0)
    v_mfma_f32_16x16x32_bf16 a[168:171], v[104:107], v[80:83], a[168:171]
    v_cvt_pk_bf16_f32 v59, v254, v255
    v_add_u32 v2, s82, v1
    v_mfma_f32_16x16x32_bf16 a[168:171], v[108:111], v[84:87], a[168:171]
    v_exp_f32 v240, v240
    v_mfma_f32_16x16x32_bf16 a[172:175], v[104:107], v[88:91], a[172:175]
    s_add_u32 s77, s77, 32768
    v_exp_f32 v241, v241
    v_mfma_f32_16x16x32_bf16 a[172:175], v[108:111], v[92:95], a[172:175]
    v_exp_f32 v242, v242
    v_mfma_f32_16x16x32_bf16 v[248:251], a[240:243], v[136:139], v[188:191]
    v_exp_f32 v243, v243
    v_mfma_f32_16x16x32_bf16 v[248:251], a[244:247], v[168:171], v[248:251]
    v_exp_f32 v244, v244
    v_mfma_f32_16x16x32_bf16 v[248:251], a[248:251], v[200:203], v[248:251]
    v_exp_f32 v245, v245
    v_mfma_f32_16x16x32_bf16 v[248:251], a[252:255], v[232:235], v[248:251]
    v_exp_f32 v246, v246
    v_mfma_f32_16x16x32_bf16 a[184:187], v[112:115], v[80:83], a[184:187]
    v_exp_f32 v247, v247
    v_mfma_f32_16x16x32_bf16 a[184:187], v[116:119], v[84:87], a[184:187]
    v_cvt_pk_bf16_f32 v52, v240, v241
    v_cvt_pk_bf16_f32 v53, v242, v243
    v_mfma_f32_16x16x32_bf16 a[188:191], v[112:115], v[88:91], a[188:191]
    v_cvt_pk_bf16_f32 v60, v244, v245
    v_cvt_pk_bf16_f32 v61, v246, v247
    v_mfma_f32_16x16x32_bf16 a[188:191], v[116:119], v[92:95], a[188:191]
    s_waitcnt vmcnt(16)
    s_barrier
    ds_read_b128 a[224:227], v2 offset:0
    v_mfma_f32_16x16x32_bf16 v[252:255], a[240:243], v[140:143], v[156:159]
    ds_read_b128 a[228:231], v2 offset:1024
    ds_read_b128 a[232:235], v2 offset:2048
    v_mfma_f32_16x16x32_bf16 v[252:255], a[244:247], v[172:175], v[252:255]
    ds_read_b128 a[236:239], v2 offset:3072
    ds_read_b128 v[96:99], v2 offset:16384
    v_mfma_f32_16x16x32_bf16 v[252:255], a[248:251], v[204:207], v[252:255]
    ds_read_b128 v[100:103], v2 offset:17408
    v_mfma_f32_16x16x32_bf16 v[252:255], a[252:255], v[236:239], v[252:255]
    v_exp_f32 v248, v248
    v_mfma_f32_16x16x32_bf16 a[200:203], v[120:123], v[80:83], a[200:203]
    v_exp_f32 v249, v249
    v_mfma_f32_16x16x32_bf16 a[200:203], v[124:127], v[84:87], a[200:203]
    v_exp_f32 v250, v250
    v_mfma_f32_16x16x32_bf16 a[204:207], v[120:123], v[88:91], a[204:207]
    v_exp_f32 v251, v251
    v_mfma_f32_16x16x32_bf16 a[204:207], v[124:127], v[92:95], a[204:207]
    v_exp_f32 v252, v252
    v_mfma_f32_16x16x32_bf16 a[216:219], a[136:139], v[80:83], a[216:219]
    v_exp_f32 v253, v253
    v_mfma_f32_16x16x32_bf16 a[216:219], a[136:139], v[84:87], a[216:219]
    v_cvt_pk_bf16_f32 v54, v248, v249
    v_cvt_pk_bf16_f32 v55, v250, v251
    v_mfma_f32_16x16x32_bf16 a[220:223], a[136:139], v[88:91], a[220:223]
    v_cvt_pk_bf16_f32 v62, v252, v253
    v_mfma_f32_16x16x32_bf16 a[220:223], a[136:139], v[92:95], a[220:223]
    s_sub_u32 s78, s78, 1
    s_cmp_lg_u32 s78, 0
    s_cbranch_scc1 K1_LS
K1_LS_END:
    v_add_f32 v212, s12, v156
    v_fma_f32 v176, v208, s8, v212
    v_fma_f32 v177, v209, s8, v212
    v_fma_f32 v178, v210, s8, v212
    v_fma_f32 v179, v211, s8, v212
    s_nop 1
    s_waitcnt lgkmcnt(0)
    v_mfma_f32_16x16x32_bf16 v[240:243], a[224:227], v[140:143], v[176:179]
    s_mov_b32 s76, s60
    ds_read_b128 v[104:107], v2 offset:18432
    ds_read_b128 v[108:111], v2 offset:19456
    v_mfma_f32_16x16x32_bf16 v[240:243], a[228:231], v[172:175], v[240:243]
    s_mov_b32 s60, s82
    v_lshrrev_b32 v29, 2, v1
    ds_read_b128 a[240:243], v2 offset:4096
    v_mfma_f32_16x16x32_bf16 v[240:243], a[232:235], v[204:207], v[240:243]
    s_add_u32 s82, s82, 32768
    v_exp_f32 v254, v254
    v_mfma_f32_16x16x32_bf16 v[240:243], a[236:239], v[236:239], v[240:243]
    v_exp_f32 v255, v255
    v_mfma_f32_16x16x32_bf16 a[8:11], v[96:99], v[48:51], a[8:11]
    buffer_load_dword v3, v29, s[44:47], 0 offen sc1
    v_mfma_f32_16x16x32_bf16 a[8:11], v[100:103], v[52:55], a[8:11]
    v_cvt_pk_bf16_f32 v63, v254, v255
    ds_read_b128 a[244:247], v2 offset:5120
    v_mfma_f32_16x16x32_bf16 a[12:15], v[96:99], v[56:59], a[12:15]
    ds_read_b128 a[248:251], v2 offset:6144
    ds_read_b128 a[252:255], v2 offset:7168
    v_mfma_f32_16x16x32_bf16 a[12:15], v[100:103], v[60:63], a[12:15]
    s_waitcnt lgkmcnt(3)
    ds_read_b128 v[112:115], v2 offset:20480
    v_add_f32 v213, s13, v156
    v_mfma_f32_16x16x32_bf16 a[24:27], v[104:107], v[48:51], a[24:27]
    ds_read_b128 v[116:119], v2 offset:21504
    v_fma_f32 v180, v208, s9, v213
    v_mfma_f32_16x16x32_bf16 a[24:27], v[108:111], v[52:55], a[24:27]
    v_fma_f32 v181, v209, s9, v213
    v_fma_f32 v182, v210, s9, v213
    v_mfma_f32_16x16x32_bf16 a[28:31], v[104:107], v[56:59], a[28:31]
    v_fma_f32 v183, v211, s9, v213
    ds_read_b128 v[120:123], v2 offset:22528
    v_mfma_f32_16x16x32_bf16 a[28:31], v[108:111], v[60:63], a[28:31]
    ds_read_b128 v[124:127], v2 offset:23552
    ds_read_b128 a[224:227], v2 offset:8192
    v_mfma_f32_16x16x32_bf16 v[244:247], a[240:243], v[140:143], v[180:183]
    s_waitcnt lgkmcnt(4)
    ds_read_b128 a[228:231], v2 offset:9216
    ds_read_b128 a[232:235], v2 offset:10240
    v_mfma_f32_16x16x32_bf16 v[244:247], a[244:247], v[172:175], v[244:247]
    ds_read_b128 a[236:239], v2 offset:11264
    ds_read_b128 v[96:99], v2 offset:24576
    v_mfma_f32_16x16x32_bf16 v[244:247], a[248:251], v[204:207], v[244:247]
    v_add_f32 v214, s14, v156
    ds_read_b128 v[100:103], v2 offset:25600
    v_mfma_f32_16x16x32_bf16 v[244:247], a[252:255], v[236:239], v[244:247]
    v_fma_f32 v184, v208, s10, v214
    v_fma_f32 v185, v209, s10, v214
    v_mfma_f32_16x16x32_bf16 a[40:43], v[112:115], v[48:51], a[40:43]
    s_waitcnt lgkmcnt(5)
    v_fma_f32 v186, v210, s10, v214
    v_fma_f32 v187, v211, s10, v214
    v_mfma_f32_16x16x32_bf16 a[40:43], v[116:119], v[52:55], a[40:43]
    ds_read_b128 v[104:107], v2 offset:26624
    ds_read_b128 v[108:111], v2 offset:27648
    v_mfma_f32_16x16x32_bf16 a[44:47], v[112:115], v[56:59], a[44:47]
    ds_read_b128 a[240:243], v2 offset:12288
    ds_read_b128 a[244:247], v2 offset:13312
    v_mfma_f32_16x16x32_bf16 a[44:47], v[116:119], v[60:63], a[44:47]
    ds_read_b128 a[248:251], v2 offset:14336
    ds_read_b128 a[252:255], v2 offset:15360
    v_mfma_f32_16x16x32_bf16 a[56:59], v[120:123], v[48:51], a[56:59]
    ds_read_b128 v[112:115], v2 offset:28672
    v_add_f32 v215, s15, v156
    v_mfma_f32_16x16x32_bf16 a[56:59], v[124:127], v[52:55], a[56:59]
    ds_read_b128 v[116:119], v2 offset:29696
    v_fma_f32 v188, v208, s11, v215
    v_mfma_f32_16x16x32_bf16 a[60:63], v[120:123], v[56:59], a[60:63]
    v_fma_f32 v189, v209, s11, v215
    v_fma_f32 v190, v210, s11, v215
    v_mfma_f32_16x16x32_bf16 a[60:63], v[124:127], v[60:63], a[60:63]
    v_fma_f32 v191, v211, s11, v215
    ds_read_b128 v[120:123], v2 offset:30720
    v_mfma_f32_16x16x32_bf16 v[248:251], a[224:227], v[140:143], v[184:187]
    s_waitcnt lgkmcnt(3)
    ds_read_b128 v[124:127], v2 offset:31744
    v_mfma_f32_16x16x32_bf16 v[248:251], a[228:231], v[172:175], v[248:251]
    s_cmp_eq_u32 s82, 163840
    s_cselect_b32 s82, 0, s82
    v_add_u32 v2, s82, v1
    v_mfma_f32_16x16x32_bf16 v[248:251], a[232:235], v[204:207], v[248:251]
    v_exp_f32 v240, v240
    v_mfma_f32_16x16x32_bf16 v[248:251], a[236:239], v[236:239], v[248:251]
    v_exp_f32 v241, v241
    v_mfma_f32_16x16x32_bf16 a[152:155], v[96:99], v[48:51], a[152:155]
    v_exp_f32 v242, v242
    v_mfma_f32_16x16x32_bf16 a[152:155], v[100:103], v[52:55], a[152:155]
    v_exp_f32 v243, v243
    v_mfma_f32_16x16x32_bf16 a[156:159], v[96:99], v[56:59], a[156:159]
    v_exp_f32 v244, v244
    v_mfma_f32_16x16x32_bf16 a[156:159], v[100:103], v[60:63], a[156:159]
    v_exp_f32 v245, v245
    v_mfma_f32_16x16x32_bf16 a[168:171], v[104:107], v[48:51], a[168:171]
    v_exp_f32 v246, v246
    v_mfma_f32_16x16x32_bf16 a[168:171], v[108:111], v[52:55], a[168:171]
    v_exp_f32 v247, v247
    v_mfma_f32_16x16x32_bf16 a[172:175], v[104:107], v[56:59], a[172:175]
    v_exp_f32 v248, v248
    v_mfma_f32_16x16x32_bf16 a[172:175], v[108:111], v[60:63], a[172:175]
    v_exp_f32 v249, v249
    v_mfma_f32_16x16x32_bf16 v[252:255], a[240:243], v[140:143], v[188:191]
    v_exp_f32 v250, v250
    v_mfma_f32_16x16x32_bf16 v[252:255], a[244:247], v[172:175], v[252:255]
    v_exp_f32 v251, v251
    v_mfma_f32_16x16x32_bf16 v[252:255], a[248:251], v[204:207], v[252:255]
    v_cvt_pk_bf16_f32 v88, v240, v241
    v_cvt_pk_bf16_f32 v89, v242, v243
    v_mfma_f32_16x16x32_bf16 v[252:255], a[252:255], v[236:239], v[252:255]
    s_waitcnt vmcnt(0) lgkmcnt(0)
    s_barrier
    ds_read_b128 a[224:227], v2 offset:0
    v_mfma_f32_16x16x32_bf16 a[184:187], v[112:115], v[48:51], a[184:187]
    ds_read_b128 a[228:231], v2 offset:1024
    ds_read_b128 a[232:235], v2 offset:2048
    v_mfma_f32_16x16x32_bf16 a[184:187], v[116:119], v[52:55], a[184:187]
    ds_read_b128 a[236:239], v2 offset:3072
    ds_read_b128 v[96:99], v2 offset:16384
    v_mfma_f32_16x16x32_bf16 a[188:191], v[112:115], v[56:59], a[188:191]
    ds_read_b128 v[100:103], v2 offset:17408
    v_cvt_pk_bf16_f32 v90, v244, v245
    v_mfma_f32_16x16x32_bf16 a[188:191], v[116:119], v[60:63], a[188:191]
    v_exp_f32 v252, v252
    v_mfma_f32_16x16x32_bf16 a[200:203], v[120:123], v[48:51], a[200:203]
    v_exp_f32 v253, v253
    v_mfma_f32_16x16x32_bf16 a[200:203], v[124:127], v[52:55], a[200:203]
    v_cvt_pk_bf16_f32 v91, v246, v247
    v_cvt_pk_bf16_f32 v92, v248, v249
    v_mfma_f32_16x16x32_bf16 a[204:207], v[120:123], v[56:59], a[204:207]
    v_cvt_pk_bf16_f32 v93, v250, v251
    v_cvt_pk_bf16_f32 v94, v252, v253
    v_mfma_f32_16x16x32_bf16 a[204:207], v[124:127], v[60:63], a[204:207]
    v_mfma_f32_16x16x32_bf16 a[216:219], a[136:139], v[48:51], a[216:219]
    v_mfma_f32_16x16x32_bf16 a[216:219], a[136:139], v[52:55], a[216:219]
    v_mfma_f32_16x16x32_bf16 a[220:223], a[136:139], v[56:59], a[220:223]
    v_mfma_f32_16x16x32_bf16 a[220:223], a[136:139], v[60:63], a[220:223]
    s_waitcnt lgkmcnt(0)
    v_mfma_f32_16x16x32_bf16 a[12:15], v[96:99], v[88:91], a[12:15]
    ds_read_b128 v[104:107], v2 offset:18432
    ds_read_b128 v[108:111], v2 offset:19456
    v_exp_f32 v254, v254
    v_exp_f32 v255, v255
    s_nop 0
    v_cvt_pk_bf16_f32 v95, v254, v255
    s_nop 1
    v_mfma_f32_16x16x32_bf16 a[12:15], v[100:103], v[92:95], a[12:15]
    s_waitcnt lgkmcnt(1)
    ds_read_b128 v[112:115], v2 offset:20480
    ds_read_b128 v[116:119], v2 offset:21504
    v_mfma_f32_16x16x32_bf16 a[28:31], v[104:107], v[88:91], a[28:31]
    s_waitcnt lgkmcnt(2)
    ds_read_b128 v[120:123], v2 offset:22528
    ds_read_b128 v[124:127], v2 offset:23552
    v_mfma_f32_16x16x32_bf16 a[28:31], v[108:111], v[92:95], a[28:31]
    s_waitcnt lgkmcnt(3)
    ds_read_b128 v[96:99], v2 offset:24576
    ds_read_b128 v[100:103], v2 offset:25600
    v_mfma_f32_16x16x32_bf16 a[44:47], v[112:115], v[88:91], a[44:47]
    s_waitcnt lgkmcnt(4)
    ds_read_b128 v[104:107], v2 offset:26624
    ds_read_b128 v[108:111], v2 offset:27648
    v_mfma_f32_16x16x32_bf16 a[44:47], v[116:119], v[92:95], a[44:47]
    s_waitcnt lgkmcnt(5)
    ds_read_b128 v[112:115], v2 offset:28672
    ds_read_b128 v[116:119], v2 offset:29696
    v_mfma_f32_16x16x32_bf16 a[60:63], v[120:123], v[88:91], a[60:63]
    s_waitcnt lgkmcnt(6)
    ds_read_b128 v[120:123], v2 offset:30720
    v_mfma_f32_16x16x32_bf16 a[60:63], v[124:127], v[92:95], a[60:63]
    s_waitcnt lgkmcnt(6)
    ds_read_b128 v[124:127], v2 offset:31744
    v_mfma_f32_16x16x32_bf16 a[156:159], v[96:99], v[88:91], a[156:159]
    s_waitcnt lgkmcnt(6)
    v_mfma_f32_16x16x32_bf16 a[156:159], v[100:103], v[92:95], a[156:159]
    s_waitcnt lgkmcnt(4)
    v_mfma_f32_16x16x32_bf16 a[172:175], v[104:107], v[88:91], a[172:175]
    v_mfma_f32_16x16x32_bf16 a[172:175], v[108:111], v[92:95], a[172:175]
    s_waitcnt lgkmcnt(1)
    v_mfma_f32_16x16x32_bf16 a[188:191], v[112:115], v[88:91], a[188:191]
    v_mfma_f32_16x16x32_bf16 a[188:191], v[116:119], v[92:95], a[188:191]
    v_mfma_f32_16x16x32_bf16 a[204:207], v[120:123], v[88:91], a[204:207]
    s_waitcnt lgkmcnt(0)
    v_mfma_f32_16x16x32_bf16 a[204:207], v[124:127], v[92:95], a[204:207]
    v_mfma_f32_16x16x32_bf16 a[220:223], a[136:139], v[88:91], a[220:223]
    v_mfma_f32_16x16x32_bf16 a[220:223], a[136:139], v[92:95], a[220:223]
    s_waitcnt lgkmcnt(0)
    s_barrier
    s_lshr_b32 s61, s5, 3
    s_and_b32 s98, s5, 3
    s_mul_i32 s98, s98, 9
    s_mul_i32 s65, s61, 1152
    s_add_u32 s65, s65, s98
    s_add_u32 s99, s4, s61
    s_and_b32 s99, s99, 3
    s_lshl1_add_u32 s64, s99, s65
    s_lshl_b32 s64, s64, 10
    s_mul_i32 s99, s4, 36
    s_add_u32 s65, s65, s99
    s_add_u32 s65, s65, 8
    s_lshl_b32 s65, s65, 10
    v_cmp_gt_u32 vcc, 16, v3
    s_nop 1
    s_and_b64 vcc, vcc, s[92:93]
    s_cbranch_scc1 SPIN_ALL
BACK_ALL:
    v_accvgpr_read_b32 v8, a216
    v_cmp_nge_f32 vcc, 0x71800000, v8
    v_rcp_f32 v10, v8
    s_nop 0
    s_or_b64 s[84:85], s[84:85], vcc
    v_mul_f32 v10, v10, v6
    v_accvgpr_read_b32 v12, a8
    v_accvgpr_read_b32 v13, a9
    v_accvgpr_read_b32 v14, a10
    v_accvgpr_read_b32 v15, a11
    v_accvgpr_read_b32 v16, a24
    v_accvgpr_read_b32 v17, a25
    v_accvgpr_read_b32 v18, a26
    v_accvgpr_read_b32 v19, a27
    v_pk_mul_f32 v[12:13], v[12:13], v[10:11] op_sel_hi:[1,0]
    v_pk_mul_f32 v[14:15], v[14:15], v[10:11] op_sel_hi:[1,0]
    v_pk_mul_f32 v[16:17], v[16:17], v[10:11] op_sel_hi:[1,0]
    v_pk_mul_f32 v[18:19], v[18:19], v[10:11] op_sel_hi:[1,0]
    v_cvt_pk_bf16_f32 v12, v12, v13
    v_cvt_pk_bf16_f32 v13, v14, v15
    v_cvt_pk_bf16_f32 v14, v16, v17
    v_cvt_pk_bf16_f32 v15, v18, v19
    buffer_store_dwordx4 v[12:15], v1, s[40:43], s81 offen offset:0 sc1
    v_accvgpr_read_b32 v20, a40
    v_accvgpr_read_b32 v21, a41
    v_accvgpr_read_b32 v22, a42
    v_accvgpr_read_b32 v23, a43
    v_accvgpr_read_b32 v24, a56
    v_accvgpr_read_b32 v25, a57
    v_accvgpr_read_b32 v26, a58
    v_accvgpr_read_b32 v27, a59
    v_pk_mul_f32 v[20:21], v[20:21], v[10:11] op_sel_hi:[1,0]
    v_pk_mul_f32 v[22:23], v[22:23], v[10:11] op_sel_hi:[1,0]
    v_pk_mul_f32 v[24:25], v[24:25], v[10:11] op_sel_hi:[1,0]
    v_pk_mul_f32 v[26:27], v[26:27], v[10:11] op_sel_hi:[1,0]
    v_cvt_pk_bf16_f32 v20, v20, v21
    v_cvt_pk_bf16_f32 v21, v22, v23
    v_cvt_pk_bf16_f32 v22, v24, v25
    v_cvt_pk_bf16_f32 v23, v26, v27
    buffer_store_dwordx4 v[20:23], v1, s[40:43], s81 offen offset:1024 sc1
    v_accvgpr_read_b32 v12, a152
    v_accvgpr_read_b32 v13, a153
    v_accvgpr_read_b32 v14, a154
    v_accvgpr_read_b32 v15, a155
    v_accvgpr_read_b32 v16, a168
    v_accvgpr_read_b32 v17, a169
    v_accvgpr_read_b32 v18, a170
    v_accvgpr_read_b32 v19, a171
    v_pk_mul_f32 v[12:13], v[12:13], v[10:11] op_sel_hi:[1,0]
    v_pk_mul_f32 v[14:15], v[14:15], v[10:11] op_sel_hi:[1,0]
    v_pk_mul_f32 v[16:17], v[16:17], v[10:11] op_sel_hi:[1,0]
    v_pk_mul_f32 v[18:19], v[18:19], v[10:11] op_sel_hi:[1,0]
    v_cvt_pk_bf16_f32 v12, v12, v13
    v_cvt_pk_bf16_f32 v13, v14, v15
    v_cvt_pk_bf16_f32 v14, v16, v17
    v_cvt_pk_bf16_f32 v15, v18, v19
    buffer_store_dwordx4 v[12:15], v1, s[40:43], s81 offen offset:2048 sc1
    v_accvgpr_read_b32 v20, a184
    v_accvgpr_read_b32 v21, a185
    v_accvgpr_read_b32 v22, a186
    v_accvgpr_read_b32 v23, a187
    v_accvgpr_read_b32 v24, a200
    v_accvgpr_read_b32 v25, a201
    v_accvgpr_read_b32 v26, a202
    v_accvgpr_read_b32 v27, a203
    v_pk_mul_f32 v[20:21], v[20:21], v[10:11] op_sel_hi:[1,0]
    v_pk_mul_f32 v[22:23], v[22:23], v[10:11] op_sel_hi:[1,0]
    v_pk_mul_f32 v[24:25], v[24:25], v[10:11] op_sel_hi:[1,0]
    v_pk_mul_f32 v[26:27], v[26:27], v[10:11] op_sel_hi:[1,0]
    v_cvt_pk_bf16_f32 v20, v20, v21
    v_cvt_pk_bf16_f32 v21, v22, v23
    v_cvt_pk_bf16_f32 v22, v24, v25
    v_cvt_pk_bf16_f32 v23, v26, v27
    buffer_store_dwordx4 v[20:23], v1, s[40:43], s81 offen offset:3072 sc1
    v_accvgpr_read_b32 v8, a220
    v_cmp_nge_f32 vcc, 0x71800000, v8
    v_rcp_f32 v10, v8
    s_nop 0
    s_or_b64 s[84:85], s[84:85], vcc
    v_mul_f32 v10, v10, v7
    s_add_u32 s72, s81, 598016
    v_accvgpr_read_b32 v12, a12
    v_accvgpr_read_b32 v13, a13
    v_accvgpr_read_b32 v14, a14
    v_accvgpr_read_b32 v15, a15
    v_accvgpr_read_b32 v16, a28
    v_accvgpr_read_b32 v17, a29
    v_accvgpr_read_b32 v18, a30
    v_accvgpr_read_b32 v19, a31
    v_pk_mul_f32 v[12:13], v[12:13], v[10:11] op_sel_hi:[1,0]
    v_pk_mul_f32 v[14:15], v[14:15], v[10:11] op_sel_hi:[1,0]
    v_pk_mul_f32 v[16:17], v[16:17], v[10:11] op_sel_hi:[1,0]
    v_pk_mul_f32 v[18:19], v[18:19], v[10:11] op_sel_hi:[1,0]
    v_cvt_pk_bf16_f32 v12, v12, v13
    v_cvt_pk_bf16_f32 v13, v14, v15
    v_cvt_pk_bf16_f32 v14, v16, v17
    v_cvt_pk_bf16_f32 v15, v18, v19
    buffer_store_dwordx4 v[12:15], v1, s[40:43], s72 offen offset:0 sc1
    v_accvgpr_read_b32 v20, a44
    v_accvgpr_read_b32 v21, a45
    v_accvgpr_read_b32 v22, a46
    v_accvgpr_read_b32 v23, a47
    v_accvgpr_read_b32 v24, a60
    v_accvgpr_read_b32 v25, a61
    v_accvgpr_read_b32 v26, a62
    v_accvgpr_read_b32 v27, a63
    v_pk_mul_f32 v[20:21], v[20:21], v[10:11] op_sel_hi:[1,0]
    v_pk_mul_f32 v[22:23], v[22:23], v[10:11] op_sel_hi:[1,0]
    v_pk_mul_f32 v[24:25], v[24:25], v[10:11] op_sel_hi:[1,0]
    v_pk_mul_f32 v[26:27], v[26:27], v[10:11] op_sel_hi:[1,0]
    v_cvt_pk_bf16_f32 v20, v20, v21
    v_cvt_pk_bf16_f32 v21, v22, v23
    v_cvt_pk_bf16_f32 v22, v24, v25
    v_cvt_pk_bf16_f32 v23, v26, v27
    buffer_store_dwordx4 v[20:23], v1, s[40:43], s72 offen offset:1024 sc1
    v_accvgpr_read_b32 v12, a156
    v_accvgpr_read_b32 v13, a157
    v_accvgpr_read_b32 v14, a158
    v_accvgpr_read_b32 v15, a159
    v_accvgpr_read_b32 v16, a172
    v_accvgpr_read_b32 v17, a173
    v_accvgpr_read_b32 v18, a174
    v_accvgpr_read_b32 v19, a175
    v_pk_mul_f32 v[12:13], v[12:13], v[10:11] op_sel_hi:[1,0]
    v_pk_mul_f32 v[14:15], v[14:15], v[10:11] op_sel_hi:[1,0]
    v_pk_mul_f32 v[16:17], v[16:17], v[10:11] op_sel_hi:[1,0]
    v_pk_mul_f32 v[18:19], v[18:19], v[10:11] op_sel_hi:[1,0]
    v_cvt_pk_bf16_f32 v12, v12, v13
    v_cvt_pk_bf16_f32 v13, v14, v15
    v_cvt_pk_bf16_f32 v14, v16, v17
    v_cvt_pk_bf16_f32 v15, v18, v19
    buffer_store_dwordx4 v[12:15], v1, s[40:43], s72 offen offset:2048 sc1
    v_accvgpr_read_b32 v20, a188
    v_accvgpr_read_b32 v21, a189
    v_accvgpr_read_b32 v22, a190
    v_accvgpr_read_b32 v23, a191
    v_accvgpr_read_b32 v24, a204
    v_accvgpr_read_b32 v25, a205
    v_accvgpr_read_b32 v26, a206
    v_accvgpr_read_b32 v27, a207
    v_pk_mul_f32 v[20:21], v[20:21], v[10:11] op_sel_hi:[1,0]
    v_pk_mul_f32 v[22:23], v[22:23], v[10:11] op_sel_hi:[1,0]
    v_pk_mul_f32 v[24:25], v[24:25], v[10:11] op_sel_hi:[1,0]
    v_pk_mul_f32 v[26:27], v[26:27], v[10:11] op_sel_hi:[1,0]
    v_cvt_pk_bf16_f32 v20, v20, v21
    v_cvt_pk_bf16_f32 v21, v22, v23
    v_cvt_pk_bf16_f32 v22, v24, v25
    v_cvt_pk_bf16_f32 v23, v26, v27
    buffer_store_dwordx4 v[20:23], v1, s[40:43], s72 offen offset:3072 sc1
    s_add_u32 m0, s67, 0
    s_nop 0
    buffer_load_dwordx4 v1, s[56:59], s64 offen sc1 lds
    s_mov_b32 s79, 110592
    v_bfe_u32 v20, v1, 4, 4
    v_lshrrev_b32 v21, 8, v1
    s_lshl_b32 s98, s4, 4
    s_add_u32 s98, s98, 16
    v_add_u32 v22, s98, v20
    v_mul_u32_u24 v22, 144, v22
    v_add_u32 v22, s79, v22
    v_lshl_add_u32 v9, v21, 3, v22
    s_lshr_b32 s98, s73, 1
    v_add_u32 v8, s98, v9
    v_subrev_u32 v10, s98, v9
    s_and_b32 s99, s4, 1
    s_mul_i32 s99, s99, 20736
    s_add_u32 s99, s99, s79
    v_mul_u32_u24 v23, 144, v20
    v_lshl_add_u32 v23, v21, 3, v23
    buffer_load_dwordx4 v1, s[56:59], s64 offen offset:1024 sc1 lds
    v_add_u32 v13, s99, v23
    v_add_u32 v12, s98, v13
    v_accvgpr_read_b32 v32, a64
    v_accvgpr_read_b32 v33, a65
    v_accvgpr_read_b32 v34, a66
    v_accvgpr_read_b32 v35, a67
    v_cvt_pk_bf16_f32 v32, v32, v33
    v_cvt_pk_bf16_f32 v33, v34, v35
    ds_write_b64 v8, v[32:33] offset:0
    v_accvgpr_read_b32 v36, a68
    v_accvgpr_read_b32 v37, a69
    v_accvgpr_read_b32 v38, a70
    v_accvgpr_read_b32 v39, a71
    v_cvt_pk_bf16_f32 v36, v36, v37
    v_cvt_pk_bf16_f32 v37, v38, v39
    ds_write_b64 v8, v[36:37] offset:9216
    v_accvgpr_read_b32 v40, a72
    s_add_u32 s64, s64, 36864
    s_add_u32 m0, s67, 8192
    s_nop 0
    buffer_load_dwordx4 v1, s[56:59], s64 offen sc1 lds
    v_accvgpr_read_b32 v41, a73
    v_accvgpr_read_b32 v42, a74
    v_accvgpr_read_b32 v43, a75
    v_cvt_pk_bf16_f32 v40, v40, v41
    v_cvt_pk_bf16_f32 v41, v42, v43
    ds_write_b64 v8, v[40:41] offset:20736
    v_accvgpr_read_b32 v44, a76
    v_accvgpr_read_b32 v45, a77
    v_accvgpr_read_b32 v46, a78
    v_accvgpr_read_b32 v47, a79
    v_cvt_pk_bf16_f32 v44, v44, v45
    v_cvt_pk_bf16_f32 v45, v46, v47
    ds_write_b64 v8, v[44:45] offset:29952
    v_accvgpr_read_b32 v32, a80
    v_accvgpr_read_b32 v33, a81
    v_accvgpr_read_b32 v34, a82
    v_accvgpr_read_b32 v35, a83
    buffer_load_dwordx4 v1, s[56:59], s64 offen offset:1024 sc1 lds
    v_cvt_pk_bf16_f32 v32, v32, v33
    v_cvt_pk_bf16_f32 v33, v34, v35
    ds_write_b64 v9, v[32:33] offset:32
    v_accvgpr_read_b32 v36, a84
    v_accvgpr_read_b32 v37, a85
    v_accvgpr_read_b32 v38, a86
    v_accvgpr_read_b32 v39, a87
    v_cvt_pk_bf16_f32 v36, v36, v37
    v_cvt_pk_bf16_f32 v37, v38, v39
    ds_write_b64 v9, v[36:37] offset:9248
    v_accvgpr_read_b32 v40, a88
    v_accvgpr_read_b32 v41, a89
    v_accvgpr_read_b32 v42, a90
    v_accvgpr_read_b32 v43, a91
    v_cvt_pk_bf16_f32 v40, v40, v41
    v_cvt_pk_bf16_f32 v41, v42, v43
    ds_write_b64 v9, v[40:41] offset:20768
    s_add_u32 s64, s64, 36864
    s_add_u32 m0, s67, 16384
    s_nop 0
    buffer_load_dwordx4 v1, s[56:59], s64 offen sc1 lds
    v_accvgpr_read_b32 v44, a92
    v_accvgpr_read_b32 v45, a93
    v_accvgpr_read_b32 v46, a94
    v_accvgpr_read_b32 v47, a95
    v_cvt_pk_bf16_f32 v44, v44, v45
    v_cvt_pk_bf16_f32 v45, v46, v47
    ds_write_b64 v9, v[44:45] offset:29984
    v_accvgpr_read_b32 v32, a96
    v_accvgpr_read_b32 v33, a97
    v_accvgpr_read_b32 v34, a98
    v_accvgpr_read_b32 v35, a99
    v_cvt_pk_bf16_f32 v32, v32, v33
    v_cvt_pk_bf16_f32 v33, v34, v35
    ds_write_b64 v10, v[32:33] offset:64
    v_accvgpr_read_b32 v36, a100
    v_accvgpr_read_b32 v37, a101
    v_accvgpr_read_b32 v38, a102
    v_accvgpr_read_b32 v39, a103
    buffer_load_dwordx4 v1, s[56:59], s64 offen offset:1024 sc1 lds
    v_cvt_pk_bf16_f32 v36, v36, v37
    v_cvt_pk_bf16_f32 v37, v38, v39
    ds_write_b64 v10, v[36:37] offset:9280
    v_accvgpr_read_b32 v40, a104
    v_accvgpr_read_b32 v41, a105
    v_accvgpr_read_b32 v42, a106
    v_accvgpr_read_b32 v43, a107
    v_cvt_pk_bf16_f32 v40, v40, v41
    v_cvt_pk_bf16_f32 v41, v42, v43
    ds_write_b64 v10, v[40:41] offset:20800
    v_accvgpr_read_b32 v44, a108
    v_accvgpr_read_b32 v45, a109
    v_accvgpr_read_b32 v46, a110
    v_accvgpr_read_b32 v47, a111
    v_cvt_pk_bf16_f32 v44, v44, v45
    v_cvt_pk_bf16_f32 v45, v46, v47
    ds_write_b64 v10, v[44:45] offset:30016
    s_add_u32 s64, s64, 36864
    s_add_u32 m0, s67, 24576
    s_nop 0
    buffer_load_dwordx4 v1, s[56:59], s64 offen sc1 lds
    v_accvgpr_read_b32 v32, a112
    v_accvgpr_read_b32 v33, a113
    v_accvgpr_read_b32 v34, a114
    v_accvgpr_read_b32 v35, a115
    v_cvt_pk_bf16_f32 v32, v32, v33
    v_cvt_pk_bf16_f32 v33, v34, v35
    ds_write_b64 v9, v[32:33] offset:96
    v_accvgpr_read_b32 v36, a116
    v_accvgpr_read_b32 v37, a117
    v_accvgpr_read_b32 v38, a118
    v_accvgpr_read_b32 v39, a119
    v_cvt_pk_bf16_f32 v36, v36, v37
    v_cvt_pk_bf16_f32 v37, v38, v39
    ds_write_b64 v9, v[36:37] offset:9312
    v_accvgpr_read_b32 v40, a120
    v_accvgpr_read_b32 v41, a121
    v_accvgpr_read_b32 v42, a122
    buffer_load_dwordx4 v1, s[56:59], s64 offen offset:1024 sc1 lds
    v_accvgpr_read_b32 v43, a123
    v_cvt_pk_bf16_f32 v40, v40, v41
    v_cvt_pk_bf16_f32 v41, v42, v43
    ds_write_b64 v9, v[40:41] offset:20832
    v_accvgpr_read_b32 v44, a124
    v_accvgpr_read_b32 v45, a125
    v_accvgpr_read_b32 v46, a126
    v_accvgpr_read_b32 v47, a127
    v_cvt_pk_bf16_f32 v44, v44, v45
    v_cvt_pk_bf16_f32 v45, v46, v47
    s_waitcnt lgkmcnt(14)
    ds_write_b64 v9, v[44:45] offset:30048
    v_accvgpr_read_b32 v32, a128
    v_accvgpr_read_b32 v33, a129
    v_accvgpr_read_b32 v34, a130
    v_accvgpr_read_b32 v35, a131
    v_cvt_pk_bf16_f32 v32, v32, v33
    v_cvt_pk_bf16_f32 v33, v34, v35
    s_add_u32 s64, s64, 36864
    s_add_u32 m0, s68, 32768
    s_nop 0
    buffer_load_dwordx4 v1, s[56:59], s65 offen sc1 lds
    s_add_u32 s65, s65, 147456
    s_waitcnt lgkmcnt(14)
    ds_write_b64 v12, v[32:33] offset:0
    v_accvgpr_read_b32 v36, a132
    v_accvgpr_read_b32 v37, a133
    v_accvgpr_read_b32 v38, a134
    v_accvgpr_read_b32 v39, a135
    v_cvt_pk_bf16_f32 v36, v36, v37
    v_cvt_pk_bf16_f32 v37, v38, v39
    s_cmp_eq_u32 s73, 0
    s_cselect_b64 exec, -1, 0
    s_waitcnt lgkmcnt(14)
    ds_write_b64 v13, v[36:37] offset:32
    s_mov_b64 exec, -1
    s_cmp_lg_u64 s[84:85], 0
    s_cselect_b32 s7, 1, 0
    v_mov_b32 v20, s7
    s_lshl2_add_u32 s98, s4, s79
    v_mov_b32 v21, s98
    s_waitcnt lgkmcnt(14)
    ds_write_b32 v21, v20 offset:41472
    v_mov_b32 v21, s79
    s_waitcnt vmcnt(9)
    s_waitcnt lgkmcnt(0)
    s_barrier
    ds_read_b128 v[24:27], v21 offset:41472
    s_and_b32 s98, s4, 1
    s_lshl_b32 s98, s98, 6
    v_lshrrev_b32 v14, 4, v1
    v_add_u32 v14, s98, v14
    s_lshr_b32 s99, s4, 1
    s_mul_i32 s7, s99, 144
    s_add_u32 s7, s7, 2
    v_add_u32 v2, s7, v14
    v_mul_u32_u24 v2, 144, v2
    v_add_u32 v2, s79, v2
    s_waitcnt lgkmcnt(0)
    v_or3_b32 v24, v24, v25, v26
    v_or_b32 v24, v24, v27
    s_nop 0
    v_readfirstlane_b32 s7, v24
    s_nop 1
    s_andn2_b32 s7, s7, s83
    s_cbranch_scc1 K1_REDO
    v_mov_b32 v31, 2
    buffer_store_dword v31, v30, s[32:35], s101 offen sc1
    s_add_u32 m0, s67, 36864
    s_nop 0
    buffer_load_dwordx4 v1, s[56:59], s64 offen sc1 lds
    ds_read_b128 v[128:131], v2 offset:2096
    ds_read_b128 v[132:135], v2 offset:2112
    ds_read_b128 v[136:139], v2 offset:2128
    ds_read_b128 v[32:35], v2 offset:2016
    ds_read_b128 v[36:39], v2 offset:2032
    ds_read_b128 v[40:43], v2 offset:2048
    ds_read_b128 v[44:47], v2 offset:1728
    ds_read_b128 v[48:51], v2 offset:1744
    ds_read_b128 v[52:55], v2 offset:1760
    ds_read_b128 v[56:59], v2 offset:1440
    ds_read_b128 v[60:63], v2 offset:1456
    ds_read_b128 v[64:67], v2 offset:1472
    ds_read_b128 v[68:71], v2 offset:1152
    ds_read_b128 v[72:75], v2 offset:1168
    ds_read_b128 v[76:79], v2 offset:1184
    s_waitcnt lgkmcnt(14)
    ds_read_b128 v[80:83], v2 offset:864
    s_waitcnt lgkmcnt(14)
    ds_read_b128 v[84:87], v2 offset:880
    s_waitcnt lgkmcnt(14)
    ds_read_b128 v[88:91], v2 offset:896
    buffer_load_dwordx4 v1, s[56:59], s64 offen offset:1024 sc1 lds
    s_waitcnt lgkmcnt(14)
    ds_read_b128 v[92:95], v2 offset:576
    s_waitcnt lgkmcnt(14)
    ds_read_b128 v[96:99], v2 offset:592
    s_waitcnt lgkmcnt(14)
    ds_read_b128 v[100:103], v2 offset:608
    s_waitcnt lgkmcnt(14)
    ds_read_b128 v[104:107], v2 offset:288
    s_waitcnt lgkmcnt(14)
    ds_read_b128 v[108:111], v2 offset:304
    s_waitcnt lgkmcnt(14)
    ds_read_b128 v[112:115], v2 offset:320
    s_waitcnt lgkmcnt(14)
    ds_read_b128 v[116:119], v2 offset:0
    s_waitcnt lgkmcnt(14)
    ds_read_b128 v[120:123], v2 offset:16
    s_waitcnt lgkmcnt(14)
    ds_read_b128 v[124:127], v2 offset:32
    s_sub_u32 s7, 15, s6
    s_cmp_eq_u32 s99, 0
    s_cselect_b32 s7, s6, s7
    s_lshl_b32 s7, s7, 7
    v_add_u32 v14, s7, v14
    v_lshrrev_b32 v15, 4, v14
    s_mov_b32 s98, 149504
    v_mul_lo_u32 v15, v15, s98
    v_and_b32 v23, 0xf0, v1
    s_add_u32 s64, s64, 36864
    s_add_u32 m0, s67, 45056
    s_nop 0
    buffer_load_dwordx4 v1, s[56:59], s64 offen sc1 lds
    v_add_u32 v15, v15, v23
    s_sub_u32 s62, 15, s6
    s_bitcmp1_b32 s5, 2
    s_cselect_b32 s62, s62, s6
    s_lshl2_add_u32 s98, s62, s4
    s_mul_i32 s98, s98, 299008
    v_add_u32 v4, s98, v1
    v_add_u32 v5, 149504, v4
    v_lshrrev_b32 v23, 9, v1
    s_and_b32 s98, s61, 1
    v_cmp_eq_u32 vcc, s98, v23
    v_mov_b32 v23, 1073741824
    s_lshl_b32 s63, s61, 15
    v_cndmask_b32 v6, v23, v4, vcc
    v_cndmask_b32 v7, v23, v5, vcc
    s_lshl2_add_u32 s66, s6, s61
    s_lshl_b32 s66, s66, 10
    v_bfe_u32 v19, v1, 4, 3
    buffer_load_dwordx4 v1, s[56:59], s64 offen offset:1024 sc1 lds
    v_lshlrev_b32 v19, 7, v19
    s_add_u32 s48, s32, 1048576
    s_addc_u32 s49, s33, 0
    s_mov_b32 s50, 9437184
    v_mov_b32 v140, 0
    v_mov_b32 v141, 0
    v_mov_b32 v142, 0
    v_mov_b32 v143, 0
    v_mov_b32 v144, 0
    v_mov_b32 v145, 0
    v_mov_b32 v146, 0
    v_mov_b32 v147, 0
    v_dot2c_f32_bf16 v140, v128, v32
    v_dot2c_f32_bf16 v141, v128, v44
    v_dot2c_f32_bf16 v142, v128, v56
    s_waitcnt lgkmcnt(14)
    v_dot2c_f32_bf16 v143, v128, v68
    v_dot2c_f32_bf16 v140, v129, v33
    v_dot2c_f32_bf16 v141, v129, v45
    s_add_u32 s64, s64, 36864
    s_add_u32 m0, s67, 53248
    s_nop 0
    buffer_load_dwordx4 v1, s[56:59], s64 offen sc1 lds
    v_dot2c_f32_bf16 v142, v129, v57
    v_dot2c_f32_bf16 v143, v129, v69
    v_dot2c_f32_bf16 v140, v130, v34
    v_dot2c_f32_bf16 v141, v130, v46
    v_dot2c_f32_bf16 v142, v130, v58
    v_dot2c_f32_bf16 v143, v130, v70
    v_dot2c_f32_bf16 v140, v131, v35
    v_dot2c_f32_bf16 v141, v131, v47
    v_dot2c_f32_bf16 v142, v131, v59
    v_dot2c_f32_bf16 v143, v131, v71
    v_dot2c_f32_bf16 v140, v132, v36
    v_dot2c_f32_bf16 v141, v132, v48
    v_dot2c_f32_bf16 v142, v132, v60
    s_waitcnt lgkmcnt(13)
    v_dot2c_f32_bf16 v143, v132, v72
    v_dot2c_f32_bf16 v140, v133, v37
    v_dot2c_f32_bf16 v141, v133, v49
    v_dot2c_f32_bf16 v142, v133, v61
    v_dot2c_f32_bf16 v143, v133, v73
    buffer_load_dwordx4 v1, s[56:59], s64 offen offset:1024 sc1 lds
    v_dot2c_f32_bf16 v140, v134, v38
    v_dot2c_f32_bf16 v141, v134, v50
    v_dot2c_f32_bf16 v142, v134, v62
    v_dot2c_f32_bf16 v143, v134, v74
    v_dot2c_f32_bf16 v140, v135, v39
    v_dot2c_f32_bf16 v141, v135, v51
    v_dot2c_f32_bf16 v142, v135, v63
    v_dot2c_f32_bf16 v143, v135, v75
    v_dot2c_f32_bf16 v140, v136, v40
    v_dot2c_f32_bf16 v141, v136, v52
    v_dot2c_f32_bf16 v142, v136, v64
    s_waitcnt lgkmcnt(12)
    v_dot2c_f32_bf16 v143, v136, v76
    ds_read_b128 v[32:35], v2 offset:2064
    ds_read_b128 v[36:39], v2 offset:2080
    ds_read_b128 v[44:47], v2 offset:1776
    s_waitcnt lgkmcnt(14)
    ds_read_b128 v[48:51], v2 offset:1792
    s_waitcnt lgkmcnt(14)
    ds_read_b128 v[56:59], v2 offset:1488
    s_waitcnt lgkmcnt(14)
    ds_read_b128 v[60:63], v2 offset:1504
    s_add_u32 s64, s64, 36864
    s_add_u32 m0, s67, 61440
    s_nop 0
    buffer_load_dwordx4 v1, s[56:59], s64 offen sc1 lds
    s_waitcnt lgkmcnt(14)
    ds_read_b128 v[68:71], v2 offset:1200
    s_waitcnt lgkmcnt(14)
    ds_read_b128 v[72:75], v2 offset:1216
    v_dot2c_f32_bf16 v144, v128, v80
    v_dot2c_f32_bf16 v145, v128, v92
    s_waitcnt lgkmcnt(13)
    v_dot2c_f32_bf16 v146, v128, v104
    s_waitcnt lgkmcnt(10)
    v_dot2c_f32_bf16 v147, v128, v116
    v_dot2c_f32_bf16 v144, v129, v81
    v_dot2c_f32_bf16 v145, v129, v93
    v_dot2c_f32_bf16 v146, v129, v105
    v_dot2c_f32_bf16 v147, v129, v117
    v_dot2c_f32_bf16 v144, v130, v82
    v_dot2c_f32_bf16 v145, v130, v94
    v_dot2c_f32_bf16 v146, v130, v106
    v_dot2c_f32_bf16 v147, v130, v118
    v_dot2c_f32_bf16 v144, v131, v83
    v_dot2c_f32_bf16 v145, v131, v95
    v_dot2c_f32_bf16 v146, v131, v107
    v_dot2c_f32_bf16 v147, v131, v119
    buffer_load_dwordx4 v1, s[56:59], s64 offen offset:1024 sc1 lds
    v_dot2c_f32_bf16 v144, v132, v84
    v_dot2c_f32_bf16 v145, v132, v96
    v_dot2c_f32_bf16 v146, v132, v108
    s_waitcnt lgkmcnt(9)
    v_dot2c_f32_bf16 v147, v132, v120
    v_dot2c_f32_bf16 v144, v133, v85
    v_dot2c_f32_bf16 v145, v133, v97
    v_dot2c_f32_bf16 v146, v133, v109
    v_dot2c_f32_bf16 v147, v133, v121
    v_dot2c_f32_bf16 v144, v134, v86
    v_dot2c_f32_bf16 v145, v134, v98
    v_dot2c_f32_bf16 v146, v134, v110
    v_dot2c_f32_bf16 v147, v134, v122
    v_dot2c_f32_bf16 v144, v135, v87
    v_dot2c_f32_bf16 v145, v135, v99
    v_dot2c_f32_bf16 v146, v135, v111
    v_dot2c_f32_bf16 v147, v135, v123
    v_dot2c_f32_bf16 v144, v136, v88
    v_dot2c_f32_bf16 v145, v136, v100
    s_add_u32 s64, s64, 36864
    s_add_u32 m0, s68, 69632
    s_nop 0
    buffer_load_dwordx4 v1, s[56:59], s65 offen sc1 lds
    v_dot2c_f32_bf16 v146, v136, v112
    s_waitcnt lgkmcnt(8)
    v_dot2c_f32_bf16 v147, v136, v124
    ds_read_b128 v[80:83], v2 offset:912
    ds_read_b128 v[84:87], v2 offset:928
    ds_read_b128 v[92:95], v2 offset:624
    ds_read_b128 v[96:99], v2 offset:640
    ds_read_b128 v[104:107], v2 offset:336
    ds_read_b128 v[108:111], v2 offset:352
    ds_read_b128 v[116:119], v2 offset:48
    s_waitcnt lgkmcnt(14)
    ds_read_b128 v[120:123], v2 offset:64
    s_mov_b32 s98, 0xbfb8aa3b
    s_mov_b32 s7, 0x3eae1a93
    v_lshlrev_b32 v8, 16, v138
    v_mul_f32 v8, s98, v8
    v_exp_f32 v8, v8
    v_mov_b32 v9, 0xf149f2ca
    v_add_f32 v8, 1.0, v8
    v_rcp_f32 v8, v8
    s_add_u32 s65, s65, 147456
    s_add_u32 m0, s67, 73728
    s_nop 0
    buffer_load_dwordx4 v1, s[56:59], s64 offen sc1 lds
    v_mul_f32 v140, s7, v140
    v_mov_b32 v128, 0
    v_mov_b32 v129, 0
    v_cmp_le_u32 vcc, 2, v14
    v_mul_f32 v141, s7, v141
    v_mov_b32 v130, 0
    v_mov_b32 v131, 0
    v_cndmask_b32 v141, v9, v141, vcc
    v_cmp_le_u32 vcc, 4, v14
    v_mul_f32 v142, s7, v142
    v_mov_b32 v132, 0
    v_mov_b32 v133, 0
    v_cndmask_b32 v142, v9, v142, vcc
    v_cmp_le_u32 vcc, 6, v14
    v_mul_f32 v143, s7, v143
    v_mov_b32 v134, 0
    v_mov_b32 v135, 0
    v_cndmask_b32 v143, v9, v143, vcc
    buffer_load_dwordx4 v1, s[56:59], s64 offen offset:1024 sc1 lds
    v_cmp_le_u32 vcc, 8, v14
    v_mul_f32 v144, s7, v144
    v_mov_b32 v136, 0
    v_mov_b32 v137, 0
    v_cndmask_b32 v144, v9, v144, vcc
    v_cmp_le_u32 vcc, 10, v14
    v_mul_f32 v145, s7, v145
    v_mov_b32 v138, 0
    v_mov_b32 v139, 0
    v_cndmask_b32 v145, v9, v145, vcc
    v_cmp_le_u32 vcc, 12, v14
    v_mul_f32 v146, s7, v146
    v_mov_b32 v156, 0
    v_mov_b32 v157, 0
    v_cndmask_b32 v146, v9, v146, vcc
    v_cmp_le_u32 vcc, 14, v14
    v_mul_f32 v147, s7, v147
    v_mov_b32 v158, 0
    s_add_u32 s64, s64, 36864
    s_add_u32 m0, s67, 81920
    s_nop 0
    buffer_load_dwordx4 v1, s[56:59], s64 offen sc1 lds
    v_mov_b32 v159, 0
    v_cndmask_b32 v147, v9, v147, vcc
    v_max3_f32 v9, v140, v141, v142
    v_max3_f32 v10, v143, v144, v145
    v_max3_f32 v9, v9, v146, v147
    v_max_f32 v9, v9, v10
    v_sub_f32 v140, v140, v9
    v_sub_f32 v141, v141, v9
    v_sub_f32 v142, v142, v9
    v_sub_f32 v143, v143, v9
    v_sub_f32 v144, v144, v9
    v_sub_f32 v145, v145, v9
    v_sub_f32 v146, v146, v9
    v_sub_f32 v147, v147, v9
    v_exp_f32 v140, v140
    v_exp_f32 v141, v141
    v_exp_f32 v142, v142
    v_exp_f32 v143, v143
    buffer_load_dwordx4 v1, s[56:59], s64 offen offset:1024 sc1 lds
    v_exp_f32 v144, v144
    v_exp_f32 v145, v145
    v_exp_f32 v146, v146
    v_exp_f32 v147, v147
    v_add_f32 v10, v140, v141
    v_add_f32 v10, v10, v142
    v_add_f32 v10, v10, v143
    v_add_f32 v10, v10, v144
    v_add_f32 v10, v10, v145
    v_add_f32 v10, v10, v146
    v_add_f32 v10, v10, v147
    v_rcp_f32 v10, v10
    v_mov_b32 v17, 0
    v_mov_b32 v18, 0
    v_mul_f32 v140, v140, v10
    v_mul_f32 v141, v141, v10
    v_mul_f32 v142, v142, v10
    v_mul_f32 v143, v143, v10
    s_add_u32 s64, s64, 36864
    s_add_u32 m0, s67, 90112
    s_nop 0
    buffer_load_dwordx4 v1, s[56:59], s64 offen sc1 lds
    v_mul_f32 v144, v144, v10
    v_mul_f32 v145, v145, v10
    v_mul_f32 v146, v146, v10
    v_mul_f32 v147, v147, v10
    v_cvt_pk_bf16_f32 v148, 0, v140
    v_cvt_pk_bf16_f32 v149, 0, v141
    v_cvt_pk_bf16_f32 v150, 0, v142
    v_cvt_pk_bf16_f32 v151, 0, v143
    v_cvt_pk_bf16_f32 v152, 0, v144
    v_cvt_pk_bf16_f32 v153, 0, v145
    v_cvt_pk_bf16_f32 v154, 0, v146
    v_cvt_pk_bf16_f32 v155, 0, v147
    v_lshrrev_b32 v140, 16, v148
    v_lshrrev_b32 v141, 16, v149
    v_lshrrev_b32 v142, 16, v150
    v_lshrrev_b32 v143, 16, v151
    v_lshrrev_b32 v144, 16, v152
    v_lshrrev_b32 v145, 16, v153
    buffer_load_dwordx4 v1, s[56:59], s64 offen offset:1024 sc1 lds
    v_lshrrev_b32 v146, 16, v154
    v_lshrrev_b32 v147, 16, v155
    v_dot2c_f32_bf16 v128, v42, v140
    v_dot2c_f32_bf16 v129, v42, v148
    v_dot2c_f32_bf16 v130, v43, v140
    v_dot2c_f32_bf16 v131, v43, v148
    v_dot2c_f32_bf16 v132, v32, v140
    v_dot2c_f32_bf16 v133, v32, v148
    v_dot2c_f32_bf16 v134, v33, v140
    v_dot2c_f32_bf16 v135, v33, v148
    v_dot2c_f32_bf16 v136, v34, v140
    v_dot2c_f32_bf16 v137, v34, v148
    v_dot2c_f32_bf16 v138, v35, v140
    v_dot2c_f32_bf16 v139, v35, v148
    s_waitcnt lgkmcnt(14)
    v_dot2c_f32_bf16 v156, v36, v140
    v_dot2c_f32_bf16 v157, v36, v148
    v_dot2c_f32_bf16 v158, v37, v140
    v_dot2c_f32_bf16 v159, v37, v148
    s_add_u32 s64, s64, 36864
    s_add_u32 m0, s67, 98304
    s_nop 0
    buffer_load_dwordx4 v1, s[56:59], s64 offen sc1 lds
    v_dot2c_f32_bf16 v17, v38, v140
    v_dot2c_f32_bf16 v18, v38, v148
    v_dot2c_f32_bf16 v128, v54, v141
    v_dot2c_f32_bf16 v129, v54, v149
    v_dot2c_f32_bf16 v130, v55, v141
    v_dot2c_f32_bf16 v131, v55, v149
    s_waitcnt lgkmcnt(13)
    v_dot2c_f32_bf16 v132, v44, v141
    v_dot2c_f32_bf16 v133, v44, v149
    v_dot2c_f32_bf16 v134, v45, v141
    v_dot2c_f32_bf16 v135, v45, v149
    v_dot2c_f32_bf16 v136, v46, v141
    v_dot2c_f32_bf16 v137, v46, v149
    v_dot2c_f32_bf16 v138, v47, v141
    v_dot2c_f32_bf16 v139, v47, v149
    s_waitcnt lgkmcnt(12)
    v_dot2c_f32_bf16 v156, v48, v141
    v_dot2c_f32_bf16 v157, v48, v149
    v_dot2c_f32_bf16 v158, v49, v141
    v_dot2c_f32_bf16 v159, v49, v149
    buffer_load_dwordx4 v1, s[56:59], s64 offen offset:1024 sc1 lds
    v_dot2c_f32_bf16 v17, v50, v141
    v_dot2c_f32_bf16 v18, v50, v149
    v_dot2c_f32_bf16 v128, v66, v142
    v_dot2c_f32_bf16 v129, v66, v150
    v_dot2c_f32_bf16 v130, v67, v142
    v_dot2c_f32_bf16 v131, v67, v150
    s_waitcnt lgkmcnt(11)
    v_dot2c_f32_bf16 v132, v56, v142
    v_dot2c_f32_bf16 v133, v56, v150
    v_dot2c_f32_bf16 v134, v57, v142
    v_dot2c_f32_bf16 v135, v57, v150
    v_dot2c_f32_bf16 v136, v58, v142
    v_dot2c_f32_bf16 v137, v58, v150
    v_dot2c_f32_bf16 v138, v59, v142
    v_dot2c_f32_bf16 v139, v59, v150
    s_waitcnt lgkmcnt(10)
    v_dot2c_f32_bf16 v156, v60, v142
    v_dot2c_f32_bf16 v157, v60, v150
    v_dot2c_f32_bf16 v158, v61, v142
    v_dot2c_f32_bf16 v159, v61, v150
    s_add_u32 s64, s64, 36864
    s_add_u32 m0, s68, 106496
    s_nop 0
    buffer_load_dwordx4 v1, s[56:59], s65 offen sc1 lds
    s_add_u32 s65, s65, 147456
    v_dot2c_f32_bf16 v17, v62, v142
    v_dot2c_f32_bf16 v18, v62, v150
    v_dot2c_f32_bf16 v128, v78, v143
    v_dot2c_f32_bf16 v129, v78, v151
    v_dot2c_f32_bf16 v130, v79, v143
    v_dot2c_f32_bf16 v131, v79, v151
    s_waitcnt lgkmcnt(9)
    v_dot2c_f32_bf16 v132, v68, v143
    v_dot2c_f32_bf16 v133, v68, v151
    v_dot2c_f32_bf16 v134, v69, v143
    v_dot2c_f32_bf16 v135, v69, v151
    v_dot2c_f32_bf16 v136, v70, v143
    v_dot2c_f32_bf16 v137, v70, v151
    v_dot2c_f32_bf16 v138, v71, v143
    v_dot2c_f32_bf16 v139, v71, v151
    s_waitcnt lgkmcnt(8)
    v_dot2c_f32_bf16 v156, v72, v143
    v_dot2c_f32_bf16 v157, v72, v151
    v_dot2c_f32_bf16 v158, v73, v143
    v_dot2c_f32_bf16 v159, v73, v151
    buffer_load_dword v3, v19, s[32:35], s66 offen sc1
    v_dot2c_f32_bf16 v17, v74, v143
    v_dot2c_f32_bf16 v18, v74, v151
    v_dot2c_f32_bf16 v128, v90, v144
    v_dot2c_f32_bf16 v129, v90, v152
    v_dot2c_f32_bf16 v130, v91, v144
    v_dot2c_f32_bf16 v131, v91, v152
    s_waitcnt lgkmcnt(7)
    v_dot2c_f32_bf16 v132, v80, v144
    v_dot2c_f32_bf16 v133, v80, v152
    v_dot2c_f32_bf16 v134, v81, v144
    v_dot2c_f32_bf16 v135, v81, v152
    v_dot2c_f32_bf16 v136, v82, v144
    v_dot2c_f32_bf16 v137, v82, v152
    v_dot2c_f32_bf16 v138, v83, v144
    v_dot2c_f32_bf16 v139, v83, v152
    s_waitcnt lgkmcnt(6)
    v_dot2c_f32_bf16 v156, v84, v144
    v_dot2c_f32_bf16 v157, v84, v152
    v_dot2c_f32_bf16 v158, v85, v144
    v_dot2c_f32_bf16 v159, v85, v152
    v_dot2c_f32_bf16 v17, v86, v144
    v_dot2c_f32_bf16 v18, v86, v152
    v_dot2c_f32_bf16 v128, v102, v145
    v_dot2c_f32_bf16 v129, v102, v153
    v_dot2c_f32_bf16 v130, v103, v145
    v_dot2c_f32_bf16 v131, v103, v153
    s_waitcnt lgkmcnt(5)
    v_dot2c_f32_bf16 v132, v92, v145
    v_dot2c_f32_bf16 v133, v92, v153
    v_dot2c_f32_bf16 v134, v93, v145
    v_dot2c_f32_bf16 v135, v93, v153
    v_dot2c_f32_bf16 v136, v94, v145
    v_dot2c_f32_bf16 v137, v94, v153
    v_dot2c_f32_bf16 v138, v95, v145
    v_dot2c_f32_bf16 v139, v95, v153
    s_waitcnt lgkmcnt(4)
    v_dot2c_f32_bf16 v156, v96, v145
    v_dot2c_f32_bf16 v157, v96, v153
    v_dot2c_f32_bf16 v158, v97, v145
    v_dot2c_f32_bf16 v159, v97, v153
    v_dot2c_f32_bf16 v17, v98, v145
    v_dot2c_f32_bf16 v18, v98, v153
    v_dot2c_f32_bf16 v128, v114, v146
    v_dot2c_f32_bf16 v129, v114, v154
    v_dot2c_f32_bf16 v130, v115, v146
    v_dot2c_f32_bf16 v131, v115, v154
    s_waitcnt lgkmcnt(3)
    v_dot2c_f32_bf16 v132, v104, v146
    v_dot2c_f32_bf16 v133, v104, v154
    v_dot2c_f32_bf16 v134, v105, v146
    v_dot2c_f32_bf16 v135, v105, v154
    v_dot2c_f32_bf16 v136, v106, v146
    v_dot2c_f32_bf16 v137, v106, v154
    v_dot2c_f32_bf16 v138, v107, v146
    v_dot2c_f32_bf16 v139, v107, v154
    s_waitcnt lgkmcnt(2)
    v_dot2c_f32_bf16 v156, v108, v146
    v_dot2c_f32_bf16 v157, v108, v154
    v_dot2c_f32_bf16 v158, v109, v146
    v_dot2c_f32_bf16 v159, v109, v154
    v_dot2c_f32_bf16 v17, v110, v146
    v_dot2c_f32_bf16 v18, v110, v154
    v_dot2c_f32_bf16 v128, v126, v147
    v_dot2c_f32_bf16 v129, v126, v155
    v_dot2c_f32_bf16 v130, v127, v147
    v_dot2c_f32_bf16 v131, v127, v155
    s_waitcnt lgkmcnt(1)
    v_dot2c_f32_bf16 v132, v116, v147
    v_dot2c_f32_bf16 v133, v116, v155
    v_dot2c_f32_bf16 v134, v117, v147
    v_dot2c_f32_bf16 v135, v117, v155
    v_dot2c_f32_bf16 v136, v118, v147
    v_dot2c_f32_bf16 v137, v118, v155
    v_dot2c_f32_bf16 v138, v119, v147
    v_dot2c_f32_bf16 v139, v119, v155
    s_waitcnt lgkmcnt(0)
    v_dot2c_f32_bf16 v156, v120, v147
    v_dot2c_f32_bf16 v157, v120, v155
    v_dot2c_f32_bf16 v158, v121, v147
    v_dot2c_f32_bf16 v159, v121, v155
    v_dot2c_f32_bf16 v17, v122, v147
    v_dot2c_f32_bf16 v18, v122, v155
    v_mul_f32 v128, v8, v128
    v_mul_f32 v129, v8, v129
    v_mul_f32 v130, v8, v130
    v_mul_f32 v131, v8, v131
    v_mul_f32 v132, v8, v132
    v_mul_f32 v133, v8, v133
    v_mul_f32 v134, v8, v134
    v_mul_f32 v135, v8, v135
    v_mul_f32 v136, v8, v136
    v_mul_f32 v137, v8, v137
    v_mul_f32 v138, v8, v138
    v_mul_f32 v139, v8, v139
    v_mul_f32 v156, v8, v156
    v_mul_f32 v157, v8, v157
    v_mul_f32 v158, v8, v158
    v_mul_f32 v159, v8, v159
    v_mul_f32 v17, v8, v17
    v_mul_f32 v18, v8, v18
    v_cvt_pk_bf16_f32 v104, v128, v129
    v_cvt_pk_bf16_f32 v105, v130, v131
    v_cvt_pk_bf16_f32 v106, v132, v133
    v_cvt_pk_bf16_f32 v107, v134, v135
    v_cvt_pk_bf16_f32 v108, v136, v137
    v_cvt_pk_bf16_f32 v109, v138, v139
    v_cvt_pk_bf16_f32 v110, v156, v157
    v_cvt_pk_bf16_f32 v111, v158, v159
    v_cvt_pk_bf16_f32 v112, v17, v18
    s_lshl_b32 s98, s5, 9
    s_add_u32 s98, s98, 131072
    s_lshr_b32 s99, s5, 2
    s_lshl_b32 s99, s99, 8
    s_and_b32 s7, s5, 3
    s_lshl2_add_u32 s99, s7, s99
    s_add_u32 s99, s99, 147456
    buffer_store_dwordx4 v[104:107], v15, s[40:43], s98 offen sc1
    buffer_store_dwordx4 v[108:111], v15, s[40:43], s98 offen offset:256 sc1
    buffer_store_dword v112, v15, s[40:43], s99 offen sc1
    s_waitcnt vmcnt(3)
    v_cmp_gt_u32 vcc, 2, v3
    s_nop 1
    s_and_b64 vcc, vcc, exec
    s_cbranch_scc1 SPIN_CTX
BACK_CTX:
    buffer_load_dwordx4 a[0:3], v4, s[40:43], s63 offen offset:0 sc1
    buffer_load_dwordx4 a[4:7], v5, s[40:43], s63 offen offset:0 sc1
    buffer_load_dwordx4 a[8:11], v4, s[40:43], s63 offen offset:1024 sc1
    buffer_load_dwordx4 a[12:15], v5, s[40:43], s63 offen offset:1024 sc1
    buffer_load_dwordx4 a[16:19], v4, s[40:43], s63 offen offset:2048 sc1
    buffer_load_dwordx4 a[20:23], v5, s[40:43], s63 offen offset:2048 sc1
    buffer_load_dwordx4 a[24:27], v4, s[40:43], s63 offen offset:3072 sc1
    buffer_load_dwordx4 a[28:31], v5, s[40:43], s63 offen offset:3072 sc1
    s_add_u32 s63, s63, 4096
    buffer_load_dwordx4 a[32:35], v4, s[40:43], s63 offen offset:0 sc1
    buffer_load_dwordx4 a[36:39], v5, s[40:43], s63 offen offset:0 sc1
    buffer_load_dwordx4 a[40:43], v4, s[40:43], s63 offen offset:1024 sc1
    buffer_load_dwordx4 a[44:47], v5, s[40:43], s63 offen offset:1024 sc1
    buffer_load_dwordx4 a[48:51], v4, s[40:43], s63 offen offset:2048 sc1
    buffer_load_dwordx4 a[52:55], v5, s[40:43], s63 offen offset:2048 sc1
    buffer_load_dwordx4 a[56:59], v4, s[40:43], s63 offen offset:3072 sc1
    buffer_load_dwordx4 a[60:63], v5, s[40:43], s63 offen offset:3072 sc1
    s_add_u32 s63, s63, 4096
    v_mov_b32 v8, v1
    v_add_u32 v9, 0x10000, v1
    v_add_u32 v10, 0x20000, v1
    s_waitcnt vmcnt(8)
    s_barrier
    v_mov_b32 v31, 3
    buffer_store_dword v31, v30, s[32:35], s101 offen sc1
    ds_read_b128 v[104:107], v8 offset:0
    s_waitcnt lgkmcnt(0)
    v_mfma_f32_16x16x32_bf16 v[160:163], v[104:107], a[0:3], 0
    s_lshl_b32 s71, s6, 5
    ds_read_b128 v[108:111], v8 offset:8192
    ds_read_b128 v[112:115], v8 offset:1024
    s_waitcnt lgkmcnt(1)
    v_mfma_f32_16x16x32_bf16 v[160:163], v[108:111], a[8:11], v[160:163]
    ds_read_b128 v[116:119], v8 offset:9216
    ds_read_b128 v[120:123], v8 offset:2048
    v_mfma_f32_16x16x32_bf16 v[164:167], v[104:107], a[4:7], 0
    ds_read_b128 v[124:127], v8 offset:10240
    ds_read_b128 v[128:131], v8 offset:3072
    v_mfma_f32_16x16x32_bf16 v[164:167], v[108:111], a[12:15], v[164:167]
    s_waitcnt lgkmcnt(4)
    buffer_load_dwordx4 a[64:67], v4, s[40:43], s63 offen offset:0 sc1
    v_mfma_f32_16x16x32_bf16 v[168:171], v[112:115], a[0:3], 0
    s_waitcnt lgkmcnt(3)
    ds_read_b128 v[132:135], v8 offset:11264
    ds_read_b128 v[136:139], v8 offset:4096
    v_mfma_f32_16x16x32_bf16 v[168:171], v[116:119], a[8:11], v[168:171]
    ds_read_b128 v[140:143], v8 offset:12288
    ds_read_b128 v[104:107], v8 offset:5120
    v_mfma_f32_16x16x32_bf16 v[172:175], v[112:115], a[4:7], 0
    ds_read_b128 v[108:111], v8 offset:13312
    ds_read_b128 v[112:115], v8 offset:6144
    v_mfma_f32_16x16x32_bf16 v[172:175], v[116:119], a[12:15], v[172:175]
    s_waitcnt lgkmcnt(6)
    ds_read_b128 v[116:119], v8 offset:14336
    v_mfma_f32_16x16x32_bf16 v[176:179], v[120:123], a[0:3], 0
    buffer_load_dwordx4 a[68:71], v5, s[40:43], s63 offen offset:0 sc1
    v_mfma_f32_16x16x32_bf16 v[176:179], v[124:127], a[8:11], v[176:179]
    v_mfma_f32_16x16x32_bf16 v[180:183], v[120:123], a[4:7], 0
    ds_read_b128 v[120:123], v8 offset:7168
    v_mfma_f32_16x16x32_bf16 v[180:183], v[124:127], a[12:15], v[180:183]
    ds_read_b128 v[124:127], v8 offset:15360
    v_mfma_f32_16x16x32_bf16 v[184:187], v[128:131], a[0:3], 0
    s_waitcnt lgkmcnt(2)
    v_mfma_f32_16x16x32_bf16 v[184:187], v[132:135], a[8:11], v[184:187]
    v_mfma_f32_16x16x32_bf16 v[188:191], v[128:131], a[4:7], 0
    ds_read_b128 v[128:131], v8 offset:32768
    v_mfma_f32_16x16x32_bf16 v[188:191], v[132:135], a[12:15], v[188:191]
    buffer_load_dwordx4 a[72:75], v4, s[40:43], s63 offen offset:1024 sc1
    v_mfma_f32_16x16x32_bf16 v[192:195], v[136:139], a[0:3], 0
    ds_read_b128 v[132:135], v8 offset:33792
    v_mfma_f32_16x16x32_bf16 v[192:195], v[140:143], a[8:11], v[192:195]
    v_mfma_f32_16x16x32_bf16 v[196:199], v[136:139], a[4:7], 0
    ds_read_b128 v[136:139], v8 offset:16384
    v_mfma_f32_16x16x32_bf16 v[196:199], v[140:143], a[12:15], v[196:199]
    ds_read_b128 v[140:143], v8 offset:24576
    v_mfma_f32_16x16x32_bf16 v[200:203], v[104:107], a[0:3], 0
    v_mfma_f32_16x16x32_bf16 v[200:203], v[108:111], a[8:11], v[200:203]
    v_mfma_f32_16x16x32_bf16 v[204:207], v[104:107], a[4:7], 0
    buffer_load_dwordx4 a[76:79], v5, s[40:43], s63 offen offset:1024 sc1
    v_mfma_f32_16x16x32_bf16 v[204:207], v[108:111], a[12:15], v[204:207]
    ds_read_b128 v[104:107], v8 offset:17408
    ds_read_b128 v[108:111], v8 offset:25600
    v_mfma_f32_16x16x32_bf16 v[208:211], v[112:115], a[0:3], 0
    v_mfma_f32_16x16x32_bf16 v[208:211], v[116:119], a[8:11], v[208:211]
    v_mfma_f32_16x16x32_bf16 v[212:215], v[112:115], a[4:7], 0
    ds_read_b128 v[112:115], v8 offset:18432
    v_mfma_f32_16x16x32_bf16 v[212:215], v[116:119], a[12:15], v[212:215]
    s_waitcnt lgkmcnt(3)
    ds_read_b128 v[116:119], v8 offset:26624
    v_mfma_f32_16x16x32_bf16 v[216:219], v[120:123], a[0:3], 0
    v_mfma_f32_16x16x32_bf16 v[216:219], v[124:127], a[8:11], v[216:219]
    buffer_load_dwordx4 a[80:83], v4, s[40:43], s63 offen offset:2048 sc1
    v_mfma_f32_16x16x32_bf16 v[220:223], v[120:123], a[4:7], 0
    ds_read_b128 v[120:123], v8 offset:19456
    v_mfma_f32_16x16x32_bf16 v[220:223], v[124:127], a[12:15], v[220:223]
    ds_read_b128 v[124:127], v8 offset:27648
    v_mfma_f32_16x16x32_bf16 v[224:227], v[128:131], a[0:3], 0
    v_mfma_f32_16x16x32_bf16 v[224:227], v[132:135], a[8:11], v[224:227]
    v_mfma_f32_16x16x32_bf16 v[228:231], v[128:131], a[4:7], 0
    ds_read_b128 v[128:131], v8 offset:20480
    v_mfma_f32_16x16x32_bf16 v[228:231], v[132:135], a[12:15], v[228:231]
    ds_read_b128 v[132:135], v8 offset:28672
    v_mfma_f32_16x16x32_bf16 v[160:163], v[136:139], a[16:19], v[160:163]
    buffer_load_dwordx4 a[84:87], v5, s[40:43], s63 offen offset:2048 sc1
    v_mfma_f32_16x16x32_bf16 v[160:163], v[140:143], a[24:27], v[160:163]
    v_mfma_f32_16x16x32_bf16 v[164:167], v[136:139], a[20:23], v[164:167]
    ds_read_b128 v[136:139], v8 offset:21504
    v_mfma_f32_16x16x32_bf16 v[164:167], v[140:143], a[28:31], v[164:167]
    s_waitcnt lgkmcnt(2)
    ds_read_b128 v[140:143], v8 offset:29696
    v_mfma_f32_16x16x32_bf16 v[168:171], v[104:107], a[16:19], v[168:171]
    v_mfma_f32_16x16x32_bf16 v[168:171], v[108:111], a[24:27], v[168:171]
    v_mfma_f32_16x16x32_bf16 v[172:175], v[104:107], a[20:23], v[172:175]
    ds_read_b128 v[104:107], v8 offset:22528
    v_mfma_f32_16x16x32_bf16 v[172:175], v[108:111], a[28:31], v[172:175]
    buffer_load_dwordx4 a[88:91], v4, s[40:43], s63 offen offset:3072 sc1
    v_mfma_f32_16x16x32_bf16 v[176:179], v[112:115], a[16:19], v[176:179]
    ds_read_b128 v[108:111], v8 offset:30720
    v_mfma_f32_16x16x32_bf16 v[176:179], v[116:119], a[24:27], v[176:179]
    v_mfma_f32_16x16x32_bf16 v[180:183], v[112:115], a[20:23], v[180:183]
    ds_read_b128 v[112:115], v8 offset:23552
    v_mfma_f32_16x16x32_bf16 v[180:183], v[116:119], a[28:31], v[180:183]
    ds_read_b128 v[116:119], v8 offset:31744
    v_mfma_f32_16x16x32_bf16 v[184:187], v[120:123], a[16:19], v[184:187]
    v_mfma_f32_16x16x32_bf16 v[184:187], v[124:127], a[24:27], v[184:187]
    v_mfma_f32_16x16x32_bf16 v[188:191], v[120:123], a[20:23], v[188:191]
    buffer_load_dwordx4 a[92:95], v5, s[40:43], s63 offen offset:3072 sc1
    v_mfma_f32_16x16x32_bf16 v[188:191], v[124:127], a[28:31], v[188:191]
    ds_read_b128 v[120:123], v8 offset:34816
    ds_read_b128 v[124:127], v8 offset:35840
    v_mfma_f32_16x16x32_bf16 v[192:195], v[128:131], a[16:19], v[192:195]
    s_waitcnt lgkmcnt(2)
    v_mfma_f32_16x16x32_bf16 v[192:195], v[132:135], a[24:27], v[192:195]
    v_mfma_f32_16x16x32_bf16 v[196:199], v[128:131], a[20:23], v[196:199]
    v_mfma_f32_16x16x32_bf16 v[196:199], v[132:135], a[28:31], v[196:199]
    v_mfma_f32_16x16x32_bf16 v[200:203], v[136:139], a[16:19], v[200:203]
    s_add_u32 s63, s63, 4096
    v_mfma_f32_16x16x32_bf16 v[200:203], v[140:143], a[24:27], v[200:203]
    v_mfma_f32_16x16x32_bf16 v[204:207], v[136:139], a[20:23], v[204:207]
    v_mfma_f32_16x16x32_bf16 v[204:207], v[140:143], a[28:31], v[204:207]
    v_mfma_f32_16x16x32_bf16 v[208:211], v[104:107], a[16:19], v[208:211]
    v_mfma_f32_16x16x32_bf16 v[208:211], v[108:111], a[24:27], v[208:211]
    s_waitcnt vmcnt(9)
    s_barrier
    ds_read_b128 v[128:131], v8 offset:36864
    v_mfma_f32_16x16x32_bf16 v[212:215], v[104:107], a[20:23], v[212:215]
    s_add_u32 m0, s67, 110592
    ds_read_b128 v[132:135], v8 offset:45056
    ds_read_b128 v[136:139], v8 offset:37888
    v_mfma_f32_16x16x32_bf16 v[212:215], v[108:111], a[28:31], v[212:215]
    buffer_load_dwordx4 v1, s[56:59], s64 offen sc1 lds
    v_mfma_f32_16x16x32_bf16 v[216:219], v[112:115], a[16:19], v[216:219]
    ds_read_b128 v[140:143], v8 offset:46080
    ds_read_b128 v[104:107], v8 offset:38912
    v_mfma_f32_16x16x32_bf16 v[216:219], v[116:119], a[24:27], v[216:219]
    ds_read_b128 v[108:111], v8 offset:47104
    v_mfma_f32_16x16x32_bf16 v[220:223], v[112:115], a[20:23], v[220:223]
    ds_read_b128 v[112:115], v8 offset:39936
    v_mfma_f32_16x16x32_bf16 v[220:223], v[116:119], a[28:31], v[220:223]
    s_waitcnt lgkmcnt(4)
    ds_read_b128 v[116:119], v8 offset:48128
    v_mfma_f32_16x16x32_bf16 v[224:227], v[120:123], a[16:19], v[224:227]
    v_mfma_f32_16x16x32_bf16 v[224:227], v[124:127], a[24:27], v[224:227]
    v_mfma_f32_16x16x32_bf16 v[228:231], v[120:123], a[20:23], v[228:231]
    buffer_load_dwordx4 v1, s[56:59], s64 offen offset:1024 sc1 lds
    v_mfma_f32_16x16x32_bf16 v[228:231], v[124:127], a[28:31], v[228:231]
    ds_read_b128 v[120:123], v8 offset:40960
    ds_read_b128 v[124:127], v8 offset:49152
    v_mfma_f32_16x16x32_bf16 v[160:163], v[128:131], a[32:35], v[160:163]
    v_mfma_f32_16x16x32_bf16 v[160:163], v[132:135], a[40:43], v[160:163]
    v_mfma_f32_16x16x32_bf16 v[164:167], v[128:131], a[36:39], v[164:167]
    ds_read_b128 v[128:131], v8 offset:41984
    v_mfma_f32_16x16x32_bf16 v[164:167], v[132:135], a[44:47], v[164:167]
    s_add_u32 s64, s64, 36864
    s_add_u32 m0, s67, 118784
    ds_read_b128 v[132:135], v8 offset:50176
    v_mfma_f32_16x16x32_bf16 v[168:171], v[136:139], a[32:35], v[168:171]
    s_waitcnt lgkmcnt(2)
    v_mfma_f32_16x16x32_bf16 v[168:171], v[140:143], a[40:43], v[168:171]
    buffer_load_dwordx4 v1, s[56:59], s64 offen sc1 lds
    v_mfma_f32_16x16x32_bf16 v[172:175], v[136:139], a[36:39], v[172:175]
    ds_read_b128 v[136:139], v8 offset:43008
    v_mfma_f32_16x16x32_bf16 v[172:175], v[140:143], a[44:47], v[172:175]
    ds_read_b128 v[140:143], v8 offset:51200
    v_mfma_f32_16x16x32_bf16 v[176:179], v[104:107], a[32:35], v[176:179]
    v_mfma_f32_16x16x32_bf16 v[176:179], v[108:111], a[40:43], v[176:179]
    v_mfma_f32_16x16x32_bf16 v[180:183], v[104:107], a[36:39], v[180:183]
    ds_read_b128 v[104:107], v8 offset:44032
    v_mfma_f32_16x16x32_bf16 v[180:183], v[108:111], a[44:47], v[180:183]
    ds_read_b128 v[108:111], v8 offset:52224
    v_mfma_f32_16x16x32_bf16 v[184:187], v[112:115], a[32:35], v[184:187]
    buffer_load_dwordx4 v1, s[56:59], s64 offen offset:1024 sc1 lds
    v_mfma_f32_16x16x32_bf16 v[184:187], v[116:119], a[40:43], v[184:187]
    v_mfma_f32_16x16x32_bf16 v[188:191], v[112:115], a[36:39], v[188:191]
    ds_read_b128 v[112:115], v9 offset:4096
    v_mfma_f32_16x16x32_bf16 v[188:191], v[116:119], a[44:47], v[188:191]
    ds_read_b128 v[116:119], v9 offset:5120
    v_mfma_f32_16x16x32_bf16 v[192:195], v[120:123], a[32:35], v[192:195]
    v_mfma_f32_16x16x32_bf16 v[192:195], v[124:127], a[40:43], v[192:195]
    s_add_u32 s64, s64, 36864
    s_add_u32 m0, s67, 126976
    v_mfma_f32_16x16x32_bf16 v[196:199], v[120:123], a[36:39], v[196:199]
    ds_read_b128 v[120:123], v8 offset:53248
    v_mfma_f32_16x16x32_bf16 v[196:199], v[124:127], a[44:47], v[196:199]
    s_waitcnt lgkmcnt(2)
    buffer_load_dwordx4 v1, s[56:59], s64 offen sc1 lds
    v_mfma_f32_16x16x32_bf16 v[200:203], v[128:131], a[32:35], v[200:203]
    ds_read_b128 v[124:127], v8 offset:61440
    v_mfma_f32_16x16x32_bf16 v[200:203], v[132:135], a[40:43], v[200:203]
    v_mfma_f32_16x16x32_bf16 v[204:207], v[128:131], a[36:39], v[204:207]
    ds_read_b128 v[128:131], v8 offset:54272
    v_mfma_f32_16x16x32_bf16 v[204:207], v[132:135], a[44:47], v[204:207]
    ds_read_b128 v[132:135], v8 offset:62464
    v_mfma_f32_16x16x32_bf16 v[208:211], v[136:139], a[32:35], v[208:211]
    v_mfma_f32_16x16x32_bf16 v[208:211], v[140:143], a[40:43], v[208:211]
    v_mfma_f32_16x16x32_bf16 v[212:215], v[136:139], a[36:39], v[212:215]
    ds_read_b128 v[136:139], v8 offset:55296
    v_mfma_f32_16x16x32_bf16 v[212:215], v[140:143], a[44:47], v[212:215]
    buffer_load_dwordx4 v1, s[56:59], s64 offen offset:1024 sc1 lds
    v_mfma_f32_16x16x32_bf16 v[216:219], v[104:107], a[32:35], v[216:219]
    ds_read_b128 v[140:143], v8 offset:63488
    v_mfma_f32_16x16x32_bf16 v[216:219], v[108:111], a[40:43], v[216:219]
    v_mfma_f32_16x16x32_bf16 v[220:223], v[104:107], a[36:39], v[220:223]
    ds_read_b128 v[104:107], v8 offset:56320
    v_mfma_f32_16x16x32_bf16 v[220:223], v[108:111], a[44:47], v[220:223]
    ds_read_b128 v[108:111], v8 offset:64512
    v_mfma_f32_16x16x32_bf16 v[224:227], v[112:115], a[32:35], v[224:227]
    s_add_u32 s64, s64, 36864
    s_add_u32 m0, s67, 135168
    s_waitcnt lgkmcnt(3)
    v_mfma_f32_16x16x32_bf16 v[224:227], v[116:119], a[40:43], v[224:227]
    v_mfma_f32_16x16x32_bf16 v[228:231], v[112:115], a[36:39], v[228:231]
    buffer_load_dwordx4 v1, s[56:59], s64 offen sc1 lds
    v_mfma_f32_16x16x32_bf16 v[228:231], v[116:119], a[44:47], v[228:231]
    ds_read_b128 v[112:115], v8 offset:57344
    ds_read_b128 v[116:119], v9 offset:0
    v_mfma_f32_16x16x32_bf16 v[160:163], v[120:123], a[48:51], v[160:163]
    v_mfma_f32_16x16x32_bf16 v[160:163], v[124:127], a[56:59], v[160:163]
    v_mfma_f32_16x16x32_bf16 v[164:167], v[120:123], a[52:55], v[164:167]
    ds_read_b128 v[120:123], v8 offset:58368
    v_mfma_f32_16x16x32_bf16 v[164:167], v[124:127], a[60:63], v[164:167]
    ds_read_b128 v[124:127], v9 offset:1024
    v_mfma_f32_16x16x32_bf16 v[168:171], v[128:131], a[48:51], v[168:171]
    v_mfma_f32_16x16x32_bf16 v[168:171], v[132:135], a[56:59], v[168:171]
    buffer_load_dwordx4 v1, s[56:59], s64 offen offset:1024 sc1 lds
    v_mfma_f32_16x16x32_bf16 v[172:175], v[128:131], a[52:55], v[172:175]
    ds_read_b128 v[128:131], v8 offset:59392
    v_mfma_f32_16x16x32_bf16 v[172:175], v[132:135], a[60:63], v[172:175]
    ds_read_b128 v[132:135], v9 offset:2048
    v_mfma_f32_16x16x32_bf16 v[176:179], v[136:139], a[48:51], v[176:179]
    s_waitcnt lgkmcnt(2)
    v_mfma_f32_16x16x32_bf16 v[176:179], v[140:143], a[56:59], v[176:179]
    v_mfma_f32_16x16x32_bf16 v[180:183], v[136:139], a[52:55], v[180:183]
    s_add_u32 m0, s68, 143360
    ds_read_b128 v[136:139], v8 offset:60416
    v_mfma_f32_16x16x32_bf16 v[180:183], v[140:143], a[60:63], v[180:183]
    s_add_u32 s64, s64, 36864
    ds_read_b128 v[140:143], v9 offset:3072
    v_mfma_f32_16x16x32_bf16 v[184:187], v[104:107], a[48:51], v[184:187]
    buffer_load_dwordx4 v1, s[56:59], s65 offen sc1 lds
    v_mfma_f32_16x16x32_bf16 v[184:187], v[108:111], a[56:59], v[184:187]
    buffer_load_dwordx4 a[0:3], v4, s[40:43], s63 offen offset:0 sc1
    v_mfma_f32_16x16x32_bf16 v[188:191], v[104:107], a[52:55], v[188:191]
    buffer_load_dwordx4 a[4:7], v5, s[40:43], s63 offen offset:0 sc1
    v_mfma_f32_16x16x32_bf16 v[188:191], v[108:111], a[60:63], v[188:191]
    buffer_load_dwordx4 a[8:11], v4, s[40:43], s63 offen offset:1024 sc1
    v_mfma_f32_16x16x32_bf16 v[192:195], v[112:115], a[48:51], v[192:195]
    buffer_load_dwordx4 a[12:15], v5, s[40:43], s63 offen offset:1024 sc1
    v_mfma_f32_16x16x32_bf16 v[192:195], v[116:119], a[56:59], v[192:195]
    buffer_load_dwordx4 a[16:19], v4, s[40:43], s63 offen offset:2048 sc1
    v_mfma_f32_16x16x32_bf16 v[196:199], v[112:115], a[52:55], v[196:199]
    s_add_u32 s65, s65, 147456
    buffer_load_dwordx4 a[20:23], v5, s[40:43], s63 offen offset:2048 sc1
    v_mfma_f32_16x16x32_bf16 v[196:199], v[116:119], a[60:63], v[196:199]
    buffer_load_dwordx4 a[24:27], v4, s[40:43], s63 offen offset:3072 sc1
    v_mfma_f32_16x16x32_bf16 v[200:203], v[120:123], a[48:51], v[200:203]
    buffer_load_dwordx4 a[28:31], v5, s[40:43], s63 offen offset:3072 sc1
    v_mfma_f32_16x16x32_bf16 v[200:203], v[124:127], a[56:59], v[200:203]
    s_add_u32 s63, s63, 4096
    ds_read_b128 v[104:107], v9 offset:6144
    ds_read_b128 v[108:111], v9 offset:7168
    v_mfma_f32_16x16x32_bf16 v[204:207], v[120:123], a[52:55], v[204:207]
    v_mfma_f32_16x16x32_bf16 v[204:207], v[124:127], a[60:63], v[204:207]
    s_waitcnt lgkmcnt(2)
    v_mfma_f32_16x16x32_bf16 v[208:211], v[128:131], a[48:51], v[208:211]
    v_mfma_f32_16x16x32_bf16 v[208:211], v[132:135], a[56:59], v[208:211]
    s_waitcnt vmcnt(17)
    s_barrier
    ds_read_b128 v[112:115], v9 offset:8192
    v_mfma_f32_16x16x32_bf16 v[212:215], v[128:131], a[52:55], v[212:215]
    s_add_u32 m0, s67, 0
    ds_read_b128 v[116:119], v9 offset:16384
    ds_read_b128 v[120:123], v9 offset:9216
    v_mfma_f32_16x16x32_bf16 v[212:215], v[132:135], a[60:63], v[212:215]
    buffer_load_dwordx4 v1, s[56:59], s64 offen sc1 lds
    v_mfma_f32_16x16x32_bf16 v[216:219], v[136:139], a[48:51], v[216:219]
    ds_read_b128 v[124:127], v9 offset:17408
    ds_read_b128 v[128:131], v9 offset:10240
    v_mfma_f32_16x16x32_bf16 v[216:219], v[140:143], a[56:59], v[216:219]
    ds_read_b128 v[132:135], v9 offset:18432
    v_mfma_f32_16x16x32_bf16 v[220:223], v[136:139], a[52:55], v[220:223]
    ds_read_b128 v[136:139], v9 offset:11264
    v_mfma_f32_16x16x32_bf16 v[220:223], v[140:143], a[60:63], v[220:223]
    s_waitcnt lgkmcnt(4)
    ds_read_b128 v[140:143], v9 offset:19456
    v_mfma_f32_16x16x32_bf16 v[224:227], v[104:107], a[48:51], v[224:227]
    v_mfma_f32_16x16x32_bf16 v[224:227], v[108:111], a[56:59], v[224:227]
    v_mfma_f32_16x16x32_bf16 v[228:231], v[104:107], a[52:55], v[228:231]
    buffer_load_dwordx4 v1, s[56:59], s64 offen offset:1024 sc1 lds
    v_mfma_f32_16x16x32_bf16 v[228:231], v[108:111], a[60:63], v[228:231]
    ds_read_b128 v[104:107], v9 offset:12288
    ds_read_b128 v[108:111], v9 offset:20480
    v_mfma_f32_16x16x32_bf16 v[160:163], v[112:115], a[64:67], v[160:163]
    v_mfma_f32_16x16x32_bf16 v[160:163], v[116:119], a[72:75], v[160:163]
    v_mfma_f32_16x16x32_bf16 v[164:167], v[112:115], a[68:71], v[164:167]
    ds_read_b128 v[112:115], v9 offset:13312
    v_mfma_f32_16x16x32_bf16 v[164:167], v[116:119], a[76:79], v[164:167]
    s_add_u32 s64, s64, 36864
    s_add_u32 m0, s67, 8192
    ds_read_b128 v[116:119], v9 offset:21504
    v_mfma_f32_16x16x32_bf16 v[168:171], v[120:123], a[64:67], v[168:171]
    s_waitcnt lgkmcnt(2)
    v_mfma_f32_16x16x32_bf16 v[168:171], v[124:127], a[72:75], v[168:171]
    buffer_load_dwordx4 v1, s[56:59], s64 offen sc1 lds
    v_mfma_f32_16x16x32_bf16 v[172:175], v[120:123], a[68:71], v[172:175]
    ds_read_b128 v[120:123], v9 offset:14336
    v_mfma_f32_16x16x32_bf16 v[172:175], v[124:127], a[76:79], v[172:175]
    ds_read_b128 v[124:127], v9 offset:22528
    v_mfma_f32_16x16x32_bf16 v[176:179], v[128:131], a[64:67], v[176:179]
    v_mfma_f32_16x16x32_bf16 v[176:179], v[132:135], a[72:75], v[176:179]
    v_mfma_f32_16x16x32_bf16 v[180:183], v[128:131], a[68:71], v[180:183]
    ds_read_b128 v[128:131], v9 offset:15360
    v_mfma_f32_16x16x32_bf16 v[180:183], v[132:135], a[76:79], v[180:183]
    ds_read_b128 v[132:135], v9 offset:23552
    v_mfma_f32_16x16x32_bf16 v[184:187], v[136:139], a[64:67], v[184:187]
    buffer_load_dwordx4 v1, s[56:59], s64 offen offset:1024 sc1 lds
    v_mfma_f32_16x16x32_bf16 v[184:187], v[140:143], a[72:75], v[184:187]
    v_mfma_f32_16x16x32_bf16 v[188:191], v[136:139], a[68:71], v[188:191]
    ds_read_b128 v[136:139], v9 offset:40960
    v_mfma_f32_16x16x32_bf16 v[188:191], v[140:143], a[76:79], v[188:191]
    ds_read_b128 v[140:143], v9 offset:41984
    v_mfma_f32_16x16x32_bf16 v[192:195], v[104:107], a[64:67], v[192:195]
    v_mfma_f32_16x16x32_bf16 v[192:195], v[108:111], a[72:75], v[192:195]
    s_add_u32 s64, s64, 36864
    s_add_u32 m0, s67, 16384
    v_mfma_f32_16x16x32_bf16 v[196:199], v[104:107], a[68:71], v[196:199]
    ds_read_b128 v[104:107], v9 offset:24576
    v_mfma_f32_16x16x32_bf16 v[196:199], v[108:111], a[76:79], v[196:199]
    s_waitcnt lgkmcnt(2)
    buffer_load_dwordx4 v1, s[56:59], s64 offen sc1 lds
    v_mfma_f32_16x16x32_bf16 v[200:203], v[112:115], a[64:67], v[200:203]
    ds_read_b128 v[108:111], v9 offset:32768
    v_mfma_f32_16x16x32_bf16 v[200:203], v[116:119], a[72:75], v[200:203]
    v_mfma_f32_16x16x32_bf16 v[204:207], v[112:115], a[68:71], v[204:207]
    ds_read_b128 v[112:115], v9 offset:25600
    v_mfma_f32_16x16x32_bf16 v[204:207], v[116:119], a[76:79], v[204:207]
    ds_read_b128 v[116:119], v9 offset:33792
    v_mfma_f32_16x16x32_bf16 v[208:211], v[120:123], a[64:67], v[208:211]
    v_mfma_f32_16x16x32_bf16 v[208:211], v[124:127], a[72:75], v[208:211]
    v_mfma_f32_16x16x32_bf16 v[212:215], v[120:123], a[68:71], v[212:215]
    ds_read_b128 v[120:123], v9 offset:26624
    v_mfma_f32_16x16x32_bf16 v[212:215], v[124:127], a[76:79], v[212:215]
    buffer_load_dwordx4 v1, s[56:59], s64 offen offset:1024 sc1 lds
    v_mfma_f32_16x16x32_bf16 v[216:219], v[128:131], a[64:67], v[216:219]
    ds_read_b128 v[124:127], v9 offset:34816
    v_mfma_f32_16x16x32_bf16 v[216:219], v[132:135], a[72:75], v[216:219]
    v_mfma_f32_16x16x32_bf16 v[220:223], v[128:131], a[68:71], v[220:223]
    ds_read_b128 v[128:131], v9 offset:27648
    v_mfma_f32_16x16x32_bf16 v[220:223], v[132:135], a[76:79], v[220:223]
    ds_read_b128 v[132:135], v9 offset:35840
    v_mfma_f32_16x16x32_bf16 v[224:227], v[136:139], a[64:67], v[224:227]
    s_add_u32 s64, s64, 36864
    s_add_u32 m0, s67, 24576
    s_waitcnt lgkmcnt(3)
    v_mfma_f32_16x16x32_bf16 v[224:227], v[140:143], a[72:75], v[224:227]
    v_mfma_f32_16x16x32_bf16 v[228:231], v[136:139], a[68:71], v[228:231]
    buffer_load_dwordx4 v1, s[56:59], s64 offen sc1 lds
    v_mfma_f32_16x16x32_bf16 v[228:231], v[140:143], a[76:79], v[228:231]
    ds_read_b128 v[136:139], v9 offset:28672
    ds_read_b128 v[140:143], v9 offset:36864
    v_mfma_f32_16x16x32_bf16 v[160:163], v[104:107], a[80:83], v[160:163]
    v_mfma_f32_16x16x32_bf16 v[160:163], v[108:111], a[88:91], v[160:163]
    v_mfma_f32_16x16x32_bf16 v[164:167], v[104:107], a[84:87], v[164:167]
    ds_read_b128 v[104:107], v9 offset:29696
    v_mfma_f32_16x16x32_bf16 v[164:167], v[108:111], a[92:95], v[164:167]
    ds_read_b128 v[108:111], v9 offset:37888
    v_mfma_f32_16x16x32_bf16 v[168:171], v[112:115], a[80:83], v[168:171]
    v_mfma_f32_16x16x32_bf16 v[168:171], v[116:119], a[88:91], v[168:171]
    buffer_load_dwordx4 v1, s[56:59], s64 offen offset:1024 sc1 lds
    v_mfma_f32_16x16x32_bf16 v[172:175], v[112:115], a[84:87], v[172:175]
    ds_read_b128 v[112:115], v9 offset:30720
    v_mfma_f32_16x16x32_bf16 v[172:175], v[116:119], a[92:95], v[172:175]
    ds_read_b128 v[116:119], v9 offset:38912
    v_mfma_f32_16x16x32_bf16 v[176:179], v[120:123], a[80:83], v[176:179]
    s_waitcnt lgkmcnt(2)
    v_mfma_f32_16x16x32_bf16 v[176:179], v[124:127], a[88:91], v[176:179]
    v_mfma_f32_16x16x32_bf16 v[180:183], v[120:123], a[84:87], v[180:183]
    s_add_u32 m0, s68, 32768
    ds_read_b128 v[120:123], v9 offset:31744
    v_mfma_f32_16x16x32_bf16 v[180:183], v[124:127], a[92:95], v[180:183]
    s_add_u32 s64, s64, 36864
    ds_read_b128 v[124:127], v9 offset:39936
    v_mfma_f32_16x16x32_bf16 v[184:187], v[128:131], a[80:83], v[184:187]
    buffer_load_dwordx4 v1, s[56:59], s65 offen sc1 lds
    v_mfma_f32_16x16x32_bf16 v[184:187], v[132:135], a[88:91], v[184:187]
    buffer_load_dwordx4 a[32:35], v4, s[40:43], s63 offen offset:0 sc1
    v_mfma_f32_16x16x32_bf16 v[188:191], v[128:131], a[84:87], v[188:191]
    buffer_load_dwordx4 a[36:39], v5, s[40:43], s63 offen offset:0 sc1
    v_mfma_f32_16x16x32_bf16 v[188:191], v[132:135], a[92:95], v[188:191]
    buffer_load_dwordx4 a[40:43], v4, s[40:43], s63 offen offset:1024 sc1
    v_mfma_f32_16x16x32_bf16 v[192:195], v[136:139], a[80:83], v[192:195]
    buffer_load_dwordx4 a[44:47], v5, s[40:43], s63 offen offset:1024 sc1
    v_mfma_f32_16x16x32_bf16 v[192:195], v[140:143], a[88:91], v[192:195]
    buffer_load_dwordx4 a[48:51], v4, s[40:43], s63 offen offset:2048 sc1
    v_mfma_f32_16x16x32_bf16 v[196:199], v[136:139], a[84:87], v[196:199]
    s_add_u32 s65, s65, 147456
    buffer_load_dwordx4 a[52:55], v5, s[40:43], s63 offen offset:2048 sc1
    v_mfma_f32_16x16x32_bf16 v[196:199], v[140:143], a[92:95], v[196:199]
    buffer_load_dwordx4 a[56:59], v4, s[40:43], s63 offen offset:3072 sc1
    v_mfma_f32_16x16x32_bf16 v[200:203], v[104:107], a[80:83], v[200:203]
    buffer_load_dwordx4 a[60:63], v5, s[40:43], s63 offen offset:3072 sc1
    v_mfma_f32_16x16x32_bf16 v[200:203], v[108:111], a[88:91], v[200:203]
    s_add_u32 s63, s63, 4096
    ds_read_b128 v[128:131], v9 offset:43008
    ds_read_b128 v[132:135], v9 offset:44032
    v_mfma_f32_16x16x32_bf16 v[204:207], v[104:107], a[84:87], v[204:207]
    v_mfma_f32_16x16x32_bf16 v[204:207], v[108:111], a[92:95], v[204:207]
    s_waitcnt lgkmcnt(2)
    v_mfma_f32_16x16x32_bf16 v[208:211], v[112:115], a[80:83], v[208:211]
    v_mfma_f32_16x16x32_bf16 v[208:211], v[116:119], a[88:91], v[208:211]
    s_waitcnt vmcnt(17)
    s_barrier
    ds_read_b128 v[136:139], v9 offset:45056
    v_mfma_f32_16x16x32_bf16 v[212:215], v[112:115], a[84:87], v[212:215]
    s_add_u32 m0, s67, 36864
    ds_read_b128 v[140:143], v9 offset:53248
    ds_read_b128 v[104:107], v9 offset:46080
    v_mfma_f32_16x16x32_bf16 v[212:215], v[116:119], a[92:95], v[212:215]
    buffer_load_dwordx4 v1, s[56:59], s64 offen sc1 lds
    v_mfma_f32_16x16x32_bf16 v[216:219], v[120:123], a[80:83], v[216:219]
    ds_read_b128 v[108:111], v9 offset:54272
    ds_read_b128 v[112:115], v9 offset:47104
    v_mfma_f32_16x16x32_bf16 v[216:219], v[124:127], a[88:91], v[216:219]
    ds_read_b128 v[116:119], v9 offset:55296
    v_mfma_f32_16x16x32_bf16 v[220:223], v[120:123], a[84:87], v[220:223]
    ds_read_b128 v[120:123], v9 offset:48128
    v_mfma_f32_16x16x32_bf16 v[220:223], v[124:127], a[92:95], v[220:223]
    s_waitcnt lgkmcnt(4)
    ds_read_b128 v[124:127], v9 offset:56320
    v_mfma_f32_16x16x32_bf16 v[224:227], v[128:131], a[80:83], v[224:227]
    v_mfma_f32_16x16x32_bf16 v[224:227], v[132:135], a[88:91], v[224:227]
    v_mfma_f32_16x16x32_bf16 v[228:231], v[128:131], a[84:87], v[228:231]
    buffer_load_dwordx4 v1, s[56:59], s64 offen offset:1024 sc1 lds
    v_mfma_f32_16x16x32_bf16 v[228:231], v[132:135], a[92:95], v[228:231]
    ds_read_b128 v[128:131], v9 offset:49152
    ds_read_b128 v[132:135], v9 offset:57344
    v_mfma_f32_16x16x32_bf16 v[160:163], v[136:139], a[0:3], v[160:163]
    v_mfma_f32_16x16x32_bf16 v[160:163], v[140:143], a[8:11], v[160:163]
    v_mfma_f32_16x16x32_bf16 v[164:167], v[136:139], a[4:7], v[164:167]
    ds_read_b128 v[136:139], v9 offset:50176
    v_mfma_f32_16x16x32_bf16 v[164:167], v[140:143], a[12:15], v[164:167]
    s_add_u32 s64, s64, 36864
    s_add_u32 m0, s67, 45056
    ds_read_b128 v[140:143], v9 offset:58368
    v_mfma_f32_16x16x32_bf16 v[168:171], v[104:107], a[0:3], v[168:171]
    s_waitcnt lgkmcnt(2)
    v_mfma_f32_16x16x32_bf16 v[168:171], v[108:111], a[8:11], v[168:171]
    buffer_load_dwordx4 v1, s[56:59], s64 offen sc1 lds
    v_mfma_f32_16x16x32_bf16 v[172:175], v[104:107], a[4:7], v[172:175]
    ds_read_b128 v[104:107], v9 offset:51200
    v_mfma_f32_16x16x32_bf16 v[172:175], v[108:111], a[12:15], v[172:175]
    ds_read_b128 v[108:111], v9 offset:59392
    v_mfma_f32_16x16x32_bf16 v[176:179], v[112:115], a[0:3], v[176:179]
    v_mfma_f32_16x16x32_bf16 v[176:179], v[116:119], a[8:11], v[176:179]
    v_mfma_f32_16x16x32_bf16 v[180:183], v[112:115], a[4:7], v[180:183]
    ds_read_b128 v[112:115], v9 offset:52224
    v_mfma_f32_16x16x32_bf16 v[180:183], v[116:119], a[12:15], v[180:183]
    ds_read_b128 v[116:119], v9 offset:60416
    v_mfma_f32_16x16x32_bf16 v[184:187], v[120:123], a[0:3], v[184:187]
    buffer_load_dwordx4 v1, s[56:59], s64 offen offset:1024 sc1 lds
    v_mfma_f32_16x16x32_bf16 v[184:187], v[124:127], a[8:11], v[184:187]
    v_mfma_f32_16x16x32_bf16 v[188:191], v[120:123], a[4:7], v[188:191]
    ds_read_b128 v[120:123], v10 offset:12288
    v_mfma_f32_16x16x32_bf16 v[188:191], v[124:127], a[12:15], v[188:191]
    ds_read_b128 v[124:127], v10 offset:13312
    v_mfma_f32_16x16x32_bf16 v[192:195], v[128:131], a[0:3], v[192:195]
    v_mfma_f32_16x16x32_bf16 v[192:195], v[132:135], a[8:11], v[192:195]
    s_add_u32 s64, s64, 36864
    s_add_u32 m0, s67, 53248
    v_mfma_f32_16x16x32_bf16 v[196:199], v[128:131], a[4:7], v[196:199]
    ds_read_b128 v[128:131], v9 offset:61440
    v_mfma_f32_16x16x32_bf16 v[196:199], v[132:135], a[12:15], v[196:199]
    s_waitcnt lgkmcnt(2)
    buffer_load_dwordx4 v1, s[56:59], s64 offen sc1 lds
    v_mfma_f32_16x16x32_bf16 v[200:203], v[136:139], a[0:3], v[200:203]
    ds_read_b128 v[132:135], v10 offset:4096
    v_mfma_f32_16x16x32_bf16 v[200:203], v[140:143], a[8:11], v[200:203]
    v_mfma_f32_16x16x32_bf16 v[204:207], v[136:139], a[4:7], v[204:207]
    ds_read_b128 v[136:139], v9 offset:62464
    v_mfma_f32_16x16x32_bf16 v[204:207], v[140:143], a[12:15], v[204:207]
    ds_read_b128 v[140:143], v10 offset:5120
    v_mfma_f32_16x16x32_bf16 v[208:211], v[104:107], a[0:3], v[208:211]
    v_mfma_f32_16x16x32_bf16 v[208:211], v[108:111], a[8:11], v[208:211]
    v_mfma_f32_16x16x32_bf16 v[212:215], v[104:107], a[4:7], v[212:215]
    ds_read_b128 v[104:107], v9 offset:63488
    v_mfma_f32_16x16x32_bf16 v[212:215], v[108:111], a[12:15], v[212:215]
    buffer_load_dwordx4 v1, s[56:59], s64 offen offset:1024 sc1 lds
    v_mfma_f32_16x16x32_bf16 v[216:219], v[112:115], a[0:3], v[216:219]
    ds_read_b128 v[108:111], v10 offset:6144
    v_mfma_f32_16x16x32_bf16 v[216:219], v[116:119], a[8:11], v[216:219]
    v_mfma_f32_16x16x32_bf16 v[220:223], v[112:115], a[4:7], v[220:223]
    ds_read_b128 v[112:115], v9 offset:64512
    v_mfma_f32_16x16x32_bf16 v[220:223], v[116:119], a[12:15], v[220:223]
    ds_read_b128 v[116:119], v10 offset:7168
    v_mfma_f32_16x16x32_bf16 v[224:227], v[120:123], a[0:3], v[224:227]
    s_add_u32 s64, s64, 36864
    s_add_u32 m0, s67, 61440
    s_waitcnt lgkmcnt(3)
    v_mfma_f32_16x16x32_bf16 v[224:227], v[124:127], a[8:11], v[224:227]
    v_mfma_f32_16x16x32_bf16 v[228:231], v[120:123], a[4:7], v[228:231]
    buffer_load_dwordx4 v1, s[56:59], s64 offen sc1 lds
    v_mfma_f32_16x16x32_bf16 v[228:231], v[124:127], a[12:15], v[228:231]
    ds_read_b128 v[120:123], v10 offset:0
    ds_read_b128 v[124:127], v10 offset:8192
    v_mfma_f32_16x16x32_bf16 v[160:163], v[128:131], a[16:19], v[160:163]
    v_mfma_f32_16x16x32_bf16 v[160:163], v[132:135], a[24:27], v[160:163]
    v_mfma_f32_16x16x32_bf16 v[164:167], v[128:131], a[20:23], v[164:167]
    ds_read_b128 v[128:131], v10 offset:1024
    v_mfma_f32_16x16x32_bf16 v[164:167], v[132:135], a[28:31], v[164:167]
    ds_read_b128 v[132:135], v10 offset:9216
    v_mfma_f32_16x16x32_bf16 v[168:171], v[136:139], a[16:19], v[168:171]
    v_mfma_f32_16x16x32_bf16 v[168:171], v[140:143], a[24:27], v[168:171]
    buffer_load_dwordx4 v1, s[56:59], s64 offen offset:1024 sc1 lds
    v_mfma_f32_16x16x32_bf16 v[172:175], v[136:139], a[20:23], v[172:175]
    ds_read_b128 v[136:139], v10 offset:2048
    v_mfma_f32_16x16x32_bf16 v[172:175], v[140:143], a[28:31], v[172:175]
    ds_read_b128 v[140:143], v10 offset:10240
    v_mfma_f32_16x16x32_bf16 v[176:179], v[104:107], a[16:19], v[176:179]
    s_waitcnt lgkmcnt(2)
    v_mfma_f32_16x16x32_bf16 v[176:179], v[108:111], a[24:27], v[176:179]
    v_mfma_f32_16x16x32_bf16 v[180:183], v[104:107], a[20:23], v[180:183]
    s_add_u32 m0, s68, 69632
    ds_read_b128 v[104:107], v10 offset:3072
    v_mfma_f32_16x16x32_bf16 v[180:183], v[108:111], a[28:31], v[180:183]
    s_add_u32 s64, s64, 36864
    ds_read_b128 v[108:111], v10 offset:11264
    v_mfma_f32_16x16x32_bf16 v[184:187], v[112:115], a[16:19], v[184:187]
    buffer_load_dwordx4 v1, s[56:59], s65 offen sc1 lds
    v_mfma_f32_16x16x32_bf16 v[184:187], v[116:119], a[24:27], v[184:187]
    buffer_load_dwordx4 a[64:67], v4, s[40:43], s63 offen offset:0 sc1
    v_mfma_f32_16x16x32_bf16 v[188:191], v[112:115], a[20:23], v[188:191]
    buffer_load_dwordx4 a[68:71], v5, s[40:43], s63 offen offset:0 sc1
    v_mfma_f32_16x16x32_bf16 v[188:191], v[116:119], a[28:31], v[188:191]
    buffer_load_dwordx4 a[72:75], v4, s[40:43], s63 offen offset:1024 sc1
    v_mfma_f32_16x16x32_bf16 v[192:195], v[120:123], a[16:19], v[192:195]
    buffer_load_dwordx4 a[76:79], v5, s[40:43], s63 offen offset:1024 sc1
    v_mfma_f32_16x16x32_bf16 v[192:195], v[124:127], a[24:27], v[192:195]
    buffer_load_dwordx4 a[80:83], v4, s[40:43], s63 offen offset:2048 sc1
    v_mfma_f32_16x16x32_bf16 v[196:199], v[120:123], a[20:23], v[196:199]
    s_add_u32 s65, s65, 147456
    buffer_load_dwordx4 a[84:87], v5, s[40:43], s63 offen offset:2048 sc1
    v_mfma_f32_16x16x32_bf16 v[196:199], v[124:127], a[28:31], v[196:199]
    buffer_load_dwordx4 a[88:91], v4, s[40:43], s63 offen offset:3072 sc1
    v_mfma_f32_16x16x32_bf16 v[200:203], v[128:131], a[16:19], v[200:203]
    buffer_load_dwordx4 a[92:95], v5, s[40:43], s63 offen offset:3072 sc1
    v_mfma_f32_16x16x32_bf16 v[200:203], v[132:135], a[24:27], v[200:203]
    s_add_u32 s63, s63, 4096
    ds_read_b128 v[112:115], v10 offset:14336
    ds_read_b128 v[116:119], v10 offset:15360
    v_mfma_f32_16x16x32_bf16 v[204:207], v[128:131], a[20:23], v[204:207]
    v_mfma_f32_16x16x32_bf16 v[204:207], v[132:135], a[28:31], v[204:207]
    s_waitcnt lgkmcnt(2)
    v_mfma_f32_16x16x32_bf16 v[208:211], v[136:139], a[16:19], v[208:211]
    v_mfma_f32_16x16x32_bf16 v[208:211], v[140:143], a[24:27], v[208:211]
    s_waitcnt vmcnt(17)
    s_barrier
    ds_read_b128 v[120:123], v8 offset:0
    v_mfma_f32_16x16x32_bf16 v[212:215], v[136:139], a[20:23], v[212:215]
    s_add_u32 m0, s67, 73728
    ds_read_b128 v[124:127], v8 offset:8192
    ds_read_b128 v[128:131], v8 offset:1024
    v_mfma_f32_16x16x32_bf16 v[212:215], v[140:143], a[28:31], v[212:215]
    buffer_load_dword v3, v19, s[32:35], s66 offen sc1
    v_mfma_f32_16x16x32_bf16 v[216:219], v[104:107], a[16:19], v[216:219]
    buffer_load_dwordx4 v1, s[56:59], s64 offen sc1 lds
    v_mfma_f32_16x16x32_bf16 v[216:219], v[108:111], a[24:27], v[216:219]
    ds_read_b128 v[132:135], v8 offset:9216
    ds_read_b128 v[136:139], v8 offset:2048
    v_mfma_f32_16x16x32_bf16 v[220:223], v[104:107], a[20:23], v[220:223]
    ds_read_b128 v[140:143], v8 offset:10240
    ds_read_b128 v[104:107], v8 offset:3072
    v_mfma_f32_16x16x32_bf16 v[220:223], v[108:111], a[28:31], v[220:223]
    s_waitcnt lgkmcnt(4)
    ds_read_b128 v[108:111], v8 offset:11264
    v_mfma_f32_16x16x32_bf16 v[224:227], v[112:115], a[16:19], v[224:227]
    v_mfma_f32_16x16x32_bf16 v[224:227], v[116:119], a[24:27], v[224:227]
    v_mfma_f32_16x16x32_bf16 v[228:231], v[112:115], a[20:23], v[228:231]
    buffer_load_dwordx4 v1, s[56:59], s64 offen offset:1024 sc1 lds
    v_mfma_f32_16x16x32_bf16 v[228:231], v[116:119], a[28:31], v[228:231]
    ds_read_b128 v[112:115], v8 offset:4096
    ds_read_b128 v[116:119], v8 offset:12288
    v_mfma_f32_16x16x32_bf16 v[160:163], v[120:123], a[32:35], v[160:163]
    v_mfma_f32_16x16x32_bf16 v[160:163], v[124:127], a[40:43], v[160:163]
    v_mfma_f32_16x16x32_bf16 v[164:167], v[120:123], a[36:39], v[164:167]
    ds_read_b128 v[120:123], v8 offset:5120
    v_mfma_f32_16x16x32_bf16 v[164:167], v[124:127], a[44:47], v[164:167]
    s_add_u32 s64, s64, 36864
    s_add_u32 m0, s67, 81920
    ds_read_b128 v[124:127], v8 offset:13312
    v_mfma_f32_16x16x32_bf16 v[168:171], v[128:131], a[32:35], v[168:171]
    s_waitcnt lgkmcnt(2)
    v_mfma_f32_16x16x32_bf16 v[168:171], v[132:135], a[40:43], v[168:171]
    buffer_load_dwordx4 v1, s[56:59], s64 offen sc1 lds
    v_mfma_f32_16x16x32_bf16 v[172:175], v[128:131], a[36:39], v[172:175]
    ds_read_b128 v[128:131], v8 offset:6144
    v_mfma_f32_16x16x32_bf16 v[172:175], v[132:135], a[44:47], v[172:175]
    ds_read_b128 v[132:135], v8 offset:14336
    v_mfma_f32_16x16x32_bf16 v[176:179], v[136:139], a[32:35], v[176:179]
    v_mfma_f32_16x16x32_bf16 v[176:179], v[140:143], a[40:43], v[176:179]
    v_mfma_f32_16x16x32_bf16 v[180:183], v[136:139], a[36:39], v[180:183]
    ds_read_b128 v[136:139], v8 offset:7168
    v_mfma_f32_16x16x32_bf16 v[180:183], v[140:143], a[44:47], v[180:183]
    ds_read_b128 v[140:143], v8 offset:15360
    v_mfma_f32_16x16x32_bf16 v[184:187], v[104:107], a[32:35], v[184:187]
    buffer_load_dwordx4 v1, s[56:59], s64 offen offset:1024 sc1 lds
    v_mfma_f32_16x16x32_bf16 v[184:187], v[108:111], a[40:43], v[184:187]
    v_mfma_f32_16x16x32_bf16 v[188:191], v[104:107], a[36:39], v[188:191]
    ds_read_b128 v[104:107], v8 offset:32768
    v_mfma_f32_16x16x32_bf16 v[188:191], v[108:111], a[44:47], v[188:191]
    ds_read_b128 v[108:111], v8 offset:33792
    v_mfma_f32_16x16x32_bf16 v[192:195], v[112:115], a[32:35], v[192:195]
    v_mfma_f32_16x16x32_bf16 v[192:195], v[116:119], a[40:43], v[192:195]
    s_add_u32 s64, s64, 36864
    s_add_u32 m0, s67, 90112
    v_mfma_f32_16x16x32_bf16 v[196:199], v[112:115], a[36:39], v[196:199]
    ds_read_b128 v[112:115], v8 offset:16384
    v_mfma_f32_16x16x32_bf16 v[196:199], v[116:119], a[44:47], v[196:199]
    s_waitcnt lgkmcnt(2)
    buffer_load_dwordx4 v1, s[56:59], s64 offen sc1 lds
    v_mfma_f32_16x16x32_bf16 v[200:203], v[120:123], a[32:35], v[200:203]
    ds_read_b128 v[116:119], v8 offset:24576
    v_mfma_f32_16x16x32_bf16 v[200:203], v[124:127], a[40:43], v[200:203]
    v_mfma_f32_16x16x32_bf16 v[204:207], v[120:123], a[36:39], v[204:207]
    ds_read_b128 v[120:123], v8 offset:17408
    v_mfma_f32_16x16x32_bf16 v[204:207], v[124:127], a[44:47], v[204:207]
    ds_read_b128 v[124:127], v8 offset:25600
    v_mfma_f32_16x16x32_bf16 v[208:211], v[128:131], a[32:35], v[208:211]
    v_mfma_f32_16x16x32_bf16 v[208:211], v[132:135], a[40:43], v[208:211]
    v_mfma_f32_16x16x32_bf16 v[212:215], v[128:131], a[36:39], v[212:215]
    ds_read_b128 v[128:131], v8 offset:18432
    v_mfma_f32_16x16x32_bf16 v[212:215], v[132:135], a[44:47], v[212:215]
    buffer_load_dwordx4 v1, s[56:59], s64 offen offset:1024 sc1 lds
    v_mfma_f32_16x16x32_bf16 v[216:219], v[136:139], a[32:35], v[216:219]
    ds_read_b128 v[132:135], v8 offset:26624
    v_mfma_f32_16x16x32_bf16 v[216:219], v[140:143], a[40:43], v[216:219]
    v_mfma_f32_16x16x32_bf16 v[220:223], v[136:139], a[36:39], v[220:223]
    ds_read_b128 v[136:139], v8 offset:19456
    v_mfma_f32_16x16x32_bf16 v[220:223], v[140:143], a[44:47], v[220:223]
    ds_read_b128 v[140:143], v8 offset:27648
    v_mfma_f32_16x16x32_bf16 v[224:227], v[104:107], a[32:35], v[224:227]
    s_add_u32 s64, s64, 36864
    s_add_u32 m0, s67, 98304
    s_waitcnt lgkmcnt(3)
    v_mfma_f32_16x16x32_bf16 v[224:227], v[108:111], a[40:43], v[224:227]
    v_mfma_f32_16x16x32_bf16 v[228:231], v[104:107], a[36:39], v[228:231]
    buffer_load_dwordx4 v1, s[56:59], s64 offen sc1 lds
    v_mfma_f32_16x16x32_bf16 v[228:231], v[108:111], a[44:47], v[228:231]
    ds_read_b128 v[104:107], v8 offset:20480
    ds_read_b128 v[108:111], v8 offset:28672
    v_mfma_f32_16x16x32_bf16 v[160:163], v[112:115], a[48:51], v[160:163]
    v_mfma_f32_16x16x32_bf16 v[160:163], v[116:119], a[56:59], v[160:163]
    v_mfma_f32_16x16x32_bf16 v[164:167], v[112:115], a[52:55], v[164:167]
    ds_read_b128 v[112:115], v8 offset:21504
    v_mfma_f32_16x16x32_bf16 v[164:167], v[116:119], a[60:63], v[164:167]
    ds_read_b128 v[116:119], v8 offset:29696
    v_mfma_f32_16x16x32_bf16 v[168:171], v[120:123], a[48:51], v[168:171]
    v_mfma_f32_16x16x32_bf16 v[168:171], v[124:127], a[56:59], v[168:171]
    buffer_load_dwordx4 v1, s[56:59], s64 offen offset:1024 sc1 lds
    v_mfma_f32_16x16x32_bf16 v[172:175], v[120:123], a[52:55], v[172:175]
    ds_read_b128 v[120:123], v8 offset:22528
    v_mfma_f32_16x16x32_bf16 v[172:175], v[124:127], a[60:63], v[172:175]
    ds_read_b128 v[124:127], v8 offset:30720
    v_mfma_f32_16x16x32_bf16 v[176:179], v[128:131], a[48:51], v[176:179]
    s_waitcnt lgkmcnt(2)
    v_mfma_f32_16x16x32_bf16 v[176:179], v[132:135], a[56:59], v[176:179]
    v_mfma_f32_16x16x32_bf16 v[180:183], v[128:131], a[52:55], v[180:183]
    s_add_u32 m0, s68, 106496
    ds_read_b128 v[128:131], v8 offset:23552
    v_mfma_f32_16x16x32_bf16 v[180:183], v[132:135], a[60:63], v[180:183]
    s_add_u32 s64, s64, 36864
    ds_read_b128 v[132:135], v8 offset:31744
    v_mfma_f32_16x16x32_bf16 v[184:187], v[136:139], a[48:51], v[184:187]
    buffer_load_dwordx4 v1, s[56:59], s65 offen sc1 lds
    v_mfma_f32_16x16x32_bf16 v[184:187], v[140:143], a[56:59], v[184:187]
    buffer_load_dwordx4 a[0:3], v4, s[40:43], s63 offen offset:0 sc1
    v_mfma_f32_16x16x32_bf16 v[188:191], v[136:139], a[52:55], v[188:191]
    buffer_load_dwordx4 a[4:7], v5, s[40:43], s63 offen offset:0 sc1
    v_mfma_f32_16x16x32_bf16 v[188:191], v[140:143], a[60:63], v[188:191]
    buffer_load_dwordx4 a[8:11], v4, s[40:43], s63 offen offset:1024 sc1
    v_mfma_f32_16x16x32_bf16 v[192:195], v[104:107], a[48:51], v[192:195]
    buffer_load_dwordx4 a[12:15], v5, s[40:43], s63 offen offset:1024 sc1
    v_mfma_f32_16x16x32_bf16 v[192:195], v[108:111], a[56:59], v[192:195]
    buffer_load_dwordx4 a[16:19], v4, s[40:43], s63 offen offset:2048 sc1
    v_mfma_f32_16x16x32_bf16 v[196:199], v[104:107], a[52:55], v[196:199]
    s_add_u32 s65, s65, 147456
    buffer_load_dwordx4 a[20:23], v5, s[40:43], s63 offen offset:2048 sc1
    v_mfma_f32_16x16x32_bf16 v[196:199], v[108:111], a[60:63], v[196:199]
    buffer_load_dwordx4 a[24:27], v4, s[40:43], s63 offen offset:3072 sc1
    v_mfma_f32_16x16x32_bf16 v[200:203], v[112:115], a[48:51], v[200:203]
    buffer_load_dwordx4 a[28:31], v5, s[40:43], s63 offen offset:3072 sc1
    v_mfma_f32_16x16x32_bf16 v[200:203], v[116:119], a[56:59], v[200:203]
    s_add_u32 s63, s63, 4096
    ds_read_b128 v[136:139], v8 offset:34816
    ds_read_b128 v[140:143], v8 offset:35840
    v_mfma_f32_16x16x32_bf16 v[204:207], v[112:115], a[52:55], v[204:207]
    v_mfma_f32_16x16x32_bf16 v[204:207], v[116:119], a[60:63], v[204:207]
    s_waitcnt lgkmcnt(2)
    v_mfma_f32_16x16x32_bf16 v[208:211], v[120:123], a[48:51], v[208:211]
    v_mfma_f32_16x16x32_bf16 v[208:211], v[124:127], a[56:59], v[208:211]
    s_waitcnt vmcnt(18)
    s_barrier
    ds_read_b128 v[104:107], v8 offset:36864
    v_mfma_f32_16x16x32_bf16 v[212:215], v[120:123], a[52:55], v[212:215]
    s_add_u32 m0, s67, 110592
    ds_read_b128 v[108:111], v8 offset:45056
    ds_read_b128 v[112:115], v8 offset:37888
    v_mfma_f32_16x16x32_bf16 v[212:215], v[124:127], a[60:63], v[212:215]
    buffer_load_dwordx4 v1, s[56:59], s64 offen sc1 lds
    v_mfma_f32_16x16x32_bf16 v[216:219], v[128:131], a[48:51], v[216:219]
    ds_read_b128 v[116:119], v8 offset:46080
    ds_read_b128 v[120:123], v8 offset:38912
    v_mfma_f32_16x16x32_bf16 v[216:219], v[132:135], a[56:59], v[216:219]
    ds_read_b128 v[124:127], v8 offset:47104
    v_mfma_f32_16x16x32_bf16 v[220:223], v[128:131], a[52:55], v[220:223]
    ds_read_b128 v[128:131], v8 offset:39936
    v_mfma_f32_16x16x32_bf16 v[220:223], v[132:135], a[60:63], v[220:223]
    s_waitcnt lgkmcnt(4)
    ds_read_b128 v[132:135], v8 offset:48128
    v_mfma_f32_16x16x32_bf16 v[224:227], v[136:139], a[48:51], v[224:227]
    v_mfma_f32_16x16x32_bf16 v[224:227], v[140:143], a[56:59], v[224:227]
    v_mfma_f32_16x16x32_bf16 v[228:231], v[136:139], a[52:55], v[228:231]
    buffer_load_dwordx4 v1, s[56:59], s64 offen offset:1024 sc1 lds
    v_mfma_f32_16x16x32_bf16 v[228:231], v[140:143], a[60:63], v[228:231]
    ds_read_b128 v[136:139], v8 offset:40960
    ds_read_b128 v[140:143], v8 offset:49152
    v_mfma_f32_16x16x32_bf16 v[160:163], v[104:107], a[64:67], v[160:163]
    v_mfma_f32_16x16x32_bf16 v[160:163], v[108:111], a[72:75], v[160:163]
    v_mfma_f32_16x16x32_bf16 v[164:167], v[104:107], a[68:71], v[164:167]
    ds_read_b128 v[104:107], v8 offset:41984
    v_mfma_f32_16x16x32_bf16 v[164:167], v[108:111], a[76:79], v[164:167]
    s_add_u32 s64, s64, 36864
    s_add_u32 m0, s67, 118784
    ds_read_b128 v[108:111], v8 offset:50176
    v_mfma_f32_16x16x32_bf16 v[168:171], v[112:115], a[64:67], v[168:171]
    s_waitcnt lgkmcnt(2)
    v_mfma_f32_16x16x32_bf16 v[168:171], v[116:119], a[72:75], v[168:171]
    buffer_load_dwordx4 v1, s[56:59], s64 offen sc1 lds
    v_mfma_f32_16x16x32_bf16 v[172:175], v[112:115], a[68:71], v[172:175]
    ds_read_b128 v[112:115], v8 offset:43008
    v_mfma_f32_16x16x32_bf16 v[172:175], v[116:119], a[76:79], v[172:175]
    ds_read_b128 v[116:119], v8 offset:51200
    v_mfma_f32_16x16x32_bf16 v[176:179], v[120:123], a[64:67], v[176:179]
    v_mfma_f32_16x16x32_bf16 v[176:179], v[124:127], a[72:75], v[176:179]
    v_mfma_f32_16x16x32_bf16 v[180:183], v[120:123], a[68:71], v[180:183]
    ds_read_b128 v[120:123], v8 offset:44032
    v_mfma_f32_16x16x32_bf16 v[180:183], v[124:127], a[76:79], v[180:183]
    ds_read_b128 v[124:127], v8 offset:52224
    v_mfma_f32_16x16x32_bf16 v[184:187], v[128:131], a[64:67], v[184:187]
    buffer_load_dwordx4 v1, s[56:59], s64 offen offset:1024 sc1 lds
    v_mfma_f32_16x16x32_bf16 v[184:187], v[132:135], a[72:75], v[184:187]
    v_mfma_f32_16x16x32_bf16 v[188:191], v[128:131], a[68:71], v[188:191]
    ds_read_b128 v[128:131], v9 offset:4096
    v_mfma_f32_16x16x32_bf16 v[188:191], v[132:135], a[76:79], v[188:191]
    ds_read_b128 v[132:135], v9 offset:5120
    v_mfma_f32_16x16x32_bf16 v[192:195], v[136:139], a[64:67], v[192:195]
    v_mfma_f32_16x16x32_bf16 v[192:195], v[140:143], a[72:75], v[192:195]
    s_add_u32 s64, s64, 36864
    s_add_u32 m0, s67, 126976
    v_mfma_f32_16x16x32_bf16 v[196:199], v[136:139], a[68:71], v[196:199]
    ds_read_b128 v[136:139], v8 offset:53248
    v_mfma_f32_16x16x32_bf16 v[196:199], v[140:143], a[76:79], v[196:199]
    s_waitcnt lgkmcnt(2)
    buffer_load_dwordx4 v1, s[56:59], s64 offen sc1 lds
    v_mfma_f32_16x16x32_bf16 v[200:203], v[104:107], a[64:67], v[200:203]
    ds_read_b128 v[140:143], v8 offset:61440
    v_mfma_f32_16x16x32_bf16 v[200:203], v[108:111], a[72:75], v[200:203]
    v_mfma_f32_16x16x32_bf16 v[204:207], v[104:107], a[68:71], v[204:207]
    ds_read_b128 v[104:107], v8 offset:54272
    v_mfma_f32_16x16x32_bf16 v[204:207], v[108:111], a[76:79], v[204:207]
    ds_read_b128 v[108:111], v8 offset:62464
    v_mfma_f32_16x16x32_bf16 v[208:211], v[112:115], a[64:67], v[208:211]
    v_mfma_f32_16x16x32_bf16 v[208:211], v[116:119], a[72:75], v[208:211]
    v_mfma_f32_16x16x32_bf16 v[212:215], v[112:115], a[68:71], v[212:215]
    ds_read_b128 v[112:115], v8 offset:55296
    v_mfma_f32_16x16x32_bf16 v[212:215], v[116:119], a[76:79], v[212:215]
    buffer_load_dwordx4 v1, s[56:59], s64 offen offset:1024 sc1 lds
    v_mfma_f32_16x16x32_bf16 v[216:219], v[120:123], a[64:67], v[216:219]
    ds_read_b128 v[116:119], v8 offset:63488
    v_mfma_f32_16x16x32_bf16 v[216:219], v[124:127], a[72:75], v[216:219]
    v_mfma_f32_16x16x32_bf16 v[220:223], v[120:123], a[68:71], v[220:223]
    ds_read_b128 v[120:123], v8 offset:56320
    v_mfma_f32_16x16x32_bf16 v[220:223], v[124:127], a[76:79], v[220:223]
    ds_read_b128 v[124:127], v8 offset:64512
    v_mfma_f32_16x16x32_bf16 v[224:227], v[128:131], a[64:67], v[224:227]
    s_add_u32 s64, s64, 36864
    s_add_u32 m0, s67, 135168
    s_waitcnt lgkmcnt(3)
    v_mfma_f32_16x16x32_bf16 v[224:227], v[132:135], a[72:75], v[224:227]
    v_mfma_f32_16x16x32_bf16 v[228:231], v[128:131], a[68:71], v[228:231]
    buffer_load_dwordx4 v1, s[56:59], s64 offen sc1 lds
    v_mfma_f32_16x16x32_bf16 v[228:231], v[132:135], a[76:79], v[228:231]
    ds_read_b128 v[128:131], v8 offset:57344
    ds_read_b128 v[132:135], v9 offset:0
    v_mfma_f32_16x16x32_bf16 v[160:163], v[136:139], a[80:83], v[160:163]
    v_mfma_f32_16x16x32_bf16 v[160:163], v[140:143], a[88:91], v[160:163]
    v_mfma_f32_16x16x32_bf16 v[164:167], v[136:139], a[84:87], v[164:167]
    ds_read_b128 v[136:139], v8 offset:58368
    v_mfma_f32_16x16x32_bf16 v[164:167], v[140:143], a[92:95], v[164:167]
    ds_read_b128 v[140:143], v9 offset:1024
    v_mfma_f32_16x16x32_bf16 v[168:171], v[104:107], a[80:83], v[168:171]
    v_mfma_f32_16x16x32_bf16 v[168:171], v[108:111], a[88:91], v[168:171]
    buffer_load_dwordx4 v1, s[56:59], s64 offen offset:1024 sc1 lds
    v_mfma_f32_16x16x32_bf16 v[172:175], v[104:107], a[84:87], v[172:175]
    ds_read_b128 v[104:107], v8 offset:59392
    v_mfma_f32_16x16x32_bf16 v[172:175], v[108:111], a[92:95], v[172:175]
    ds_read_b128 v[108:111], v9 offset:2048
    v_mfma_f32_16x16x32_bf16 v[176:179], v[112:115], a[80:83], v[176:179]
    s_waitcnt lgkmcnt(2)
    v_mfma_f32_16x16x32_bf16 v[176:179], v[116:119], a[88:91], v[176:179]
    v_mfma_f32_16x16x32_bf16 v[180:183], v[112:115], a[84:87], v[180:183]
    s_add_u32 m0, s68, 143360
    ds_read_b128 v[112:115], v8 offset:60416
    v_mfma_f32_16x16x32_bf16 v[180:183], v[116:119], a[92:95], v[180:183]
    s_add_u32 s64, s64, 36864
    ds_read_b128 v[116:119], v9 offset:3072
    v_mfma_f32_16x16x32_bf16 v[184:187], v[120:123], a[80:83], v[184:187]
    buffer_load_dwordx4 v1, s[56:59], s65 offen sc1 lds
    v_mfma_f32_16x16x32_bf16 v[184:187], v[124:127], a[88:91], v[184:187]
    buffer_load_dwordx4 a[32:35], v4, s[40:43], s63 offen offset:0 sc1
    v_mfma_f32_16x16x32_bf16 v[188:191], v[120:123], a[84:87], v[188:191]
    buffer_load_dwordx4 a[36:39], v5, s[40:43], s63 offen offset:0 sc1
    v_mfma_f32_16x16x32_bf16 v[188:191], v[124:127], a[92:95], v[188:191]
    buffer_load_dwordx4 a[40:43], v4, s[40:43], s63 offen offset:1024 sc1
    v_mfma_f32_16x16x32_bf16 v[192:195], v[128:131], a[80:83], v[192:195]
    buffer_load_dwordx4 a[44:47], v5, s[40:43], s63 offen offset:1024 sc1
    v_mfma_f32_16x16x32_bf16 v[192:195], v[132:135], a[88:91], v[192:195]
    buffer_load_dwordx4 a[48:51], v4, s[40:43], s63 offen offset:2048 sc1
    v_mfma_f32_16x16x32_bf16 v[196:199], v[128:131], a[84:87], v[196:199]
    s_add_u32 s65, s65, 147456
    buffer_load_dwordx4 a[52:55], v5, s[40:43], s63 offen offset:2048 sc1
    v_mfma_f32_16x16x32_bf16 v[196:199], v[132:135], a[92:95], v[196:199]
    buffer_load_dwordx4 a[56:59], v4, s[40:43], s63 offen offset:3072 sc1
    v_mfma_f32_16x16x32_bf16 v[200:203], v[136:139], a[80:83], v[200:203]
    buffer_load_dwordx4 a[60:63], v5, s[40:43], s63 offen offset:3072 sc1
    v_mfma_f32_16x16x32_bf16 v[200:203], v[140:143], a[88:91], v[200:203]
    s_add_u32 s63, s63, 4096
    ds_read_b128 v[120:123], v9 offset:6144
    ds_read_b128 v[124:127], v9 offset:7168
    v_mfma_f32_16x16x32_bf16 v[204:207], v[136:139], a[84:87], v[204:207]
    v_mfma_f32_16x16x32_bf16 v[204:207], v[140:143], a[92:95], v[204:207]
    s_waitcnt lgkmcnt(2)
    v_mfma_f32_16x16x32_bf16 v[208:211], v[104:107], a[80:83], v[208:211]
    v_mfma_f32_16x16x32_bf16 v[208:211], v[108:111], a[88:91], v[208:211]
    s_mul_i32 s98, s61, 1032192
    s_waitcnt vmcnt(17)
    v_cmp_gt_u32 vcc, 3, v3
    s_nop 1
    s_and_b64 vcc, vcc, exec
    s_cbranch_scc1 SPIN_OA
BACK_OA:
    s_barrier
    v_mfma_f32_16x16x32_bf16 v[212:215], v[104:107], a[84:87], v[212:215]
    s_sub_u32 s98, 3538944, s98
    ds_read_b128 v[128:131], v9 offset:8192
    ds_read_b128 v[132:135], v9 offset:16384
    v_mfma_f32_16x16x32_bf16 v[212:215], v[108:111], a[92:95], v[212:215]
    s_add_u32 s64, s64, s98
    ds_read_b128 v[136:139], v9 offset:9216
    ds_read_b128 v[140:143], v9 offset:17408
    v_mfma_f32_16x16x32_bf16 v[216:219], v[112:115], a[80:83], v[216:219]
    s_add_u32 m0, s67, 0
    ds_read_b128 v[104:107], v9 offset:10240
    ds_read_b128 v[108:111], v9 offset:18432
    v_mfma_f32_16x16x32_bf16 v[216:219], v[116:119], a[88:91], v[216:219]
    s_add_u32 s65, s65, s98
    buffer_load_dwordx4 v1, s[56:59], s64 offen sc1 lds
    v_mfma_f32_16x16x32_bf16 v[220:223], v[112:115], a[84:87], v[220:223]
    ds_read_b128 v[112:115], v9 offset:11264
    v_mfma_f32_16x16x32_bf16 v[220:223], v[116:119], a[92:95], v[220:223]
    s_waitcnt lgkmcnt(5)
    ds_read_b128 v[116:119], v9 offset:19456
    v_mfma_f32_16x16x32_bf16 v[224:227], v[120:123], a[80:83], v[224:227]
    v_mfma_f32_16x16x32_bf16 v[224:227], v[124:127], a[88:91], v[224:227]
    v_mfma_f32_16x16x32_bf16 v[228:231], v[120:123], a[84:87], v[228:231]
    buffer_load_dwordx4 v1, s[56:59], s64 offen offset:1024 sc1 lds
    v_mfma_f32_16x16x32_bf16 v[228:231], v[124:127], a[92:95], v[228:231]
    s_lshl_b32 s63, s61, 12
    ds_read_b128 v[120:123], v9 offset:12288
    ds_read_b128 v[124:127], v9 offset:20480
    v_mfma_f32_16x16x32_bf16 v[160:163], v[128:131], a[0:3], v[160:163]
    s_add_u32 s63, s63, 131072
    v_mfma_f32_16x16x32_bf16 v[160:163], v[132:135], a[8:11], v[160:163]
    v_mfma_f32_16x16x32_bf16 v[164:167], v[128:131], a[4:7], v[164:167]
    ds_read_b128 v[128:131], v9 offset:13312
    v_mfma_f32_16x16x32_bf16 v[164:167], v[132:135], a[12:15], v[164:167]
    s_add_u32 s64, s64, 36864
    s_add_u32 m0, s67, 8192
    ds_read_b128 v[132:135], v9 offset:21504
    s_waitcnt lgkmcnt(4)
    v_mfma_f32_16x16x32_bf16 v[168:171], v[136:139], a[0:3], v[168:171]
    v_mfma_f32_16x16x32_bf16 v[168:171], v[140:143], a[8:11], v[168:171]
    buffer_load_dwordx4 v1, s[56:59], s64 offen sc1 lds
    v_mfma_f32_16x16x32_bf16 v[172:175], v[136:139], a[4:7], v[172:175]
    ds_read_b128 v[136:139], v9 offset:14336
    v_mfma_f32_16x16x32_bf16 v[172:175], v[140:143], a[12:15], v[172:175]
    ds_read_b128 v[140:143], v9 offset:22528
    v_mfma_f32_16x16x32_bf16 v[176:179], v[104:107], a[0:3], v[176:179]
    v_mfma_f32_16x16x32_bf16 v[176:179], v[108:111], a[8:11], v[176:179]
    v_mfma_f32_16x16x32_bf16 v[180:183], v[104:107], a[4:7], v[180:183]
    ds_read_b128 v[104:107], v9 offset:15360
    v_mfma_f32_16x16x32_bf16 v[180:183], v[108:111], a[12:15], v[180:183]
    ds_read_b128 v[108:111], v9 offset:23552
    v_mfma_f32_16x16x32_bf16 v[184:187], v[112:115], a[0:3], v[184:187]
    buffer_load_dwordx4 v1, s[56:59], s64 offen offset:1024 sc1 lds
    v_mfma_f32_16x16x32_bf16 v[184:187], v[116:119], a[8:11], v[184:187]
    v_mfma_f32_16x16x32_bf16 v[188:191], v[112:115], a[4:7], v[188:191]
    ds_read_b128 v[112:115], v9 offset:40960
    v_mfma_f32_16x16x32_bf16 v[188:191], v[116:119], a[12:15], v[188:191]
    s_waitcnt lgkmcnt(2)
    ds_read_b128 v[116:119], v9 offset:41984
    v_mfma_f32_16x16x32_bf16 v[192:195], v[120:123], a[0:3], v[192:195]
    v_mfma_f32_16x16x32_bf16 v[192:195], v[124:127], a[8:11], v[192:195]
    s_add_u32 s64, s64, 36864
    s_add_u32 m0, s67, 16384
    v_mfma_f32_16x16x32_bf16 v[196:199], v[120:123], a[4:7], v[196:199]
    ds_read_b128 v[120:123], v9 offset:24576
    v_mfma_f32_16x16x32_bf16 v[196:199], v[124:127], a[12:15], v[196:199]
    buffer_load_dwordx4 v1, s[56:59], s64 offen sc1 lds
    v_mfma_f32_16x16x32_bf16 v[200:203], v[128:131], a[0:3], v[200:203]
    ds_read_b128 v[124:127], v9 offset:32768
    v_mfma_f32_16x16x32_bf16 v[200:203], v[132:135], a[8:11], v[200:203]
    v_mfma_f32_16x16x32_bf16 v[204:207], v[128:131], a[4:7], v[204:207]
    ds_read_b128 v[128:131], v9 offset:25600
    v_mfma_f32_16x16x32_bf16 v[204:207], v[132:135], a[12:15], v[204:207]
    ds_read_b128 v[132:135], v9 offset:33792
    v_mfma_f32_16x16x32_bf16 v[208:211], v[136:139], a[0:3], v[208:211]
    v_mfma_f32_16x16x32_bf16 v[208:211], v[140:143], a[8:11], v[208:211]
    v_mfma_f32_16x16x32_bf16 v[212:215], v[136:139], a[4:7], v[212:215]
    ds_read_b128 v[136:139], v9 offset:26624
    v_mfma_f32_16x16x32_bf16 v[212:215], v[140:143], a[12:15], v[212:215]
    buffer_load_dwordx4 v1, s[56:59], s64 offen offset:1024 sc1 lds
    v_mfma_f32_16x16x32_bf16 v[216:219], v[104:107], a[0:3], v[216:219]
    s_waitcnt lgkmcnt(1)
    ds_read_b128 v[140:143], v9 offset:34816
    v_mfma_f32_16x16x32_bf16 v[216:219], v[108:111], a[8:11], v[216:219]
    v_mfma_f32_16x16x32_bf16 v[220:223], v[104:107], a[4:7], v[220:223]
    ds_read_b128 v[104:107], v9 offset:27648
    v_mfma_f32_16x16x32_bf16 v[220:223], v[108:111], a[12:15], v[220:223]
    ds_read_b128 v[108:111], v9 offset:35840
    v_mfma_f32_16x16x32_bf16 v[224:227], v[112:115], a[0:3], v[224:227]
    s_add_u32 s64, s64, 36864
    s_add_u32 m0, s67, 24576
    v_mfma_f32_16x16x32_bf16 v[224:227], v[116:119], a[8:11], v[224:227]
    v_mfma_f32_16x16x32_bf16 v[228:231], v[112:115], a[4:7], v[228:231]
    buffer_load_dwordx4 v1, s[56:59], s64 offen sc1 lds
    v_mfma_f32_16x16x32_bf16 v[228:231], v[116:119], a[12:15], v[228:231]
    ds_read_b128 v[112:115], v9 offset:28672
    ds_read_b128 v[116:119], v9 offset:36864
    v_mfma_f32_16x16x32_bf16 v[160:163], v[120:123], a[16:19], v[160:163]
    v_mfma_f32_16x16x32_bf16 v[160:163], v[124:127], a[24:27], v[160:163]
    v_mfma_f32_16x16x32_bf16 v[164:167], v[120:123], a[20:23], v[164:167]
    ds_read_b128 v[120:123], v9 offset:29696
    v_mfma_f32_16x16x32_bf16 v[164:167], v[124:127], a[28:31], v[164:167]
    ds_read_b128 v[124:127], v9 offset:37888
    v_mfma_f32_16x16x32_bf16 v[168:171], v[128:131], a[16:19], v[168:171]
    v_mfma_f32_16x16x32_bf16 v[168:171], v[132:135], a[24:27], v[168:171]
    buffer_load_dwordx4 v1, s[56:59], s64 offen offset:1024 sc1 lds
    v_mfma_f32_16x16x32_bf16 v[172:175], v[128:131], a[20:23], v[172:175]
    ds_read_b128 v[128:131], v9 offset:30720
    v_mfma_f32_16x16x32_bf16 v[172:175], v[132:135], a[28:31], v[172:175]
    s_waitcnt lgkmcnt(2)
    ds_read_b128 v[132:135], v9 offset:38912
    v_mfma_f32_16x16x32_bf16 v[176:179], v[136:139], a[16:19], v[176:179]
    v_mfma_f32_16x16x32_bf16 v[176:179], v[140:143], a[24:27], v[176:179]
    v_mfma_f32_16x16x32_bf16 v[180:183], v[136:139], a[20:23], v[180:183]
    s_add_u32 m0, s68, 32768
    ds_read_b128 v[136:139], v9 offset:31744
    v_mfma_f32_16x16x32_bf16 v[180:183], v[140:143], a[28:31], v[180:183]
    s_add_u32 s64, s64, 36864
    ds_read_b128 v[140:143], v9 offset:39936
    v_mfma_f32_16x16x32_bf16 v[184:187], v[104:107], a[16:19], v[184:187]
    buffer_load_dwordx4 v1, s[56:59], s65 offen sc1 lds
    v_mfma_f32_16x16x32_bf16 v[184:187], v[108:111], a[24:27], v[184:187]
    buffer_load_dwordx4 a[64:67], v4, s[40:43], s63 offen offset:0 sc1
    v_mfma_f32_16x16x32_bf16 v[188:191], v[104:107], a[20:23], v[188:191]
    buffer_load_dwordx4 a[68:71], v5, s[40:43], s63 offen offset:0 sc1
    v_mfma_f32_16x16x32_bf16 v[188:191], v[108:111], a[28:31], v[188:191]
    buffer_load_dwordx4 a[72:75], v4, s[40:43], s63 offen offset:1024 sc1
    v_mfma_f32_16x16x32_bf16 v[192:195], v[112:115], a[16:19], v[192:195]
    buffer_load_dwordx4 a[76:79], v5, s[40:43], s63 offen offset:1024 sc1
    v_mfma_f32_16x16x32_bf16 v[192:195], v[116:119], a[24:27], v[192:195]
    buffer_load_dwordx4 a[80:83], v4, s[40:43], s63 offen offset:2048 sc1
    v_mfma_f32_16x16x32_bf16 v[196:199], v[112:115], a[20:23], v[196:199]
    s_add_u32 s65, s65, 147456
    buffer_load_dwordx4 a[84:87], v5, s[40:43], s63 offen offset:2048 sc1
    v_mfma_f32_16x16x32_bf16 v[196:199], v[116:119], a[28:31], v[196:199]
    buffer_load_dwordx4 a[88:91], v4, s[40:43], s63 offen offset:3072 sc1
    v_mfma_f32_16x16x32_bf16 v[200:203], v[120:123], a[16:19], v[200:203]
    s_waitcnt lgkmcnt(0)
    buffer_load_dwordx4 a[92:95], v5, s[40:43], s63 offen offset:3072 sc1
    v_mfma_f32_16x16x32_bf16 v[200:203], v[124:127], a[24:27], v[200:203]
    s_add_u32 s63, s63, 4096
    ds_read_b128 v[104:107], v9 offset:43008
    ds_read_b128 v[108:111], v9 offset:44032
    v_mfma_f32_16x16x32_bf16 v[204:207], v[120:123], a[20:23], v[204:207]
    v_mfma_f32_16x16x32_bf16 v[204:207], v[124:127], a[28:31], v[204:207]
    v_mfma_f32_16x16x32_bf16 v[208:211], v[128:131], a[16:19], v[208:211]
    v_mfma_f32_16x16x32_bf16 v[208:211], v[132:135], a[24:27], v[208:211]
    s_lshr_b32 s98, s61, 1
    s_lshl_b32 s99, s61, 2
    s_sub_u32 s98, s98, s99
    s_waitcnt vmcnt(17)
    s_barrier
    v_mfma_f32_16x16x32_bf16 v[212:215], v[128:131], a[20:23], v[212:215]
    s_add_u32 s98, s98, 12
    ds_read_b128 v[112:115], v9 offset:45056
    ds_read_b128 v[116:119], v9 offset:53248
    v_mfma_f32_16x16x32_bf16 v[212:215], v[132:135], a[28:31], v[212:215]
    s_mul_i32 s98, s98, 36864
    ds_read_b128 v[120:123], v9 offset:46080
    ds_read_b128 v[124:127], v9 offset:54272
    v_mfma_f32_16x16x32_bf16 v[216:219], v[136:139], a[16:19], v[216:219]
    s_add_u32 s64, s64, s98
    s_add_u32 s65, s65, s98
    s_add_u32 m0, s67, 36864
    v_mfma_f32_16x16x32_bf16 v[216:219], v[140:143], a[24:27], v[216:219]
    s_cmp_eq_u32 s4, 0
    s_cselect_b32 s65, s65, 1073741824
    ds_read_b128 v[128:131], v9 offset:47104
    v_mfma_f32_16x16x32_bf16 v[220:223], v[136:139], a[20:23], v[220:223]
    s_mov_b32 s99, 1
    buffer_load_dwordx4 v1, s[56:59], s64 offen sc1 lds
    v_mfma_f32_16x16x32_bf16 v[220:223], v[140:143], a[28:31], v[220:223]
    s_lshl3_add_u32 s98, s99, s5
    ds_read_b128 v[132:135], v9 offset:55296
    ds_read_b128 v[136:139], v9 offset:48128
    s_waitcnt lgkmcnt(5)
    v_mfma_f32_16x16x32_bf16 v[224:227], v[104:107], a[16:19], v[224:227]
    s_and_b32 s98, s98, 31
    ds_read_b128 v[140:143], v9 offset:56320
    v_mfma_f32_16x16x32_bf16 v[224:227], v[108:111], a[24:27], v[224:227]
    s_add_u32 s98, s98, s71
    v_mfma_f32_16x16x32_bf16 v[228:231], v[104:107], a[20:23], v[228:231]
    s_mul_i32 s98, s98, 3
    ds_read_b128 v[104:107], v9 offset:49152
    v_mfma_f32_16x16x32_bf16 v[228:231], v[108:111], a[28:31], v[228:231]
    s_lshr_b32 s63, s61, 1
    ds_read_b128 v[108:111], v9 offset:57344
    v_mfma_f32_16x16x32_bf16 v[160:163], v[112:115], a[32:35], v[160:163]
    s_lshl_b32 s63, s63, 10
    v_mfma_f32_16x16x32_bf16 v[160:163], v[116:119], a[40:43], v[160:163]
    s_add_u32 s63, s63, 147456
    v_mfma_f32_16x16x32_bf16 v[164:167], v[112:115], a[36:39], v[164:167]
    s_sub_u32 s98, s98, s99
    ds_read_b128 v[112:115], v9 offset:50176
    v_mfma_f32_16x16x32_bf16 v[164:167], v[116:119], a[44:47], v[164:167]
    s_add_u32 s98, s98, 3
    ds_read_b128 v[116:119], v9 offset:58368
    s_waitcnt lgkmcnt(3)
    v_mfma_f32_16x16x32_bf16 v[168:171], v[120:123], a[32:35], v[168:171]
    s_lshl2_add_u32 s98, s98, s4
    v_mfma_f32_16x16x32_bf16 v[168:171], v[124:127], a[40:43], v[168:171]
    s_mov_b32 s99, 2
    v_mfma_f32_16x16x32_bf16 v[172:175], v[120:123], a[36:39], v[172:175]
    s_mul_i32 s71, s98, 3072
    ds_read_b128 v[120:123], v9 offset:51200
    v_mfma_f32_16x16x32_bf16 v[172:175], v[124:127], a[44:47], v[172:175]
    s_lshl3_add_u32 s98, s99, s5
    ds_read_b128 v[124:127], v9 offset:59392
    v_mfma_f32_16x16x32_bf16 v[176:179], v[128:131], a[32:35], v[176:179]
    s_and_b32 s98, s98, 31
    v_mfma_f32_16x16x32_bf16 v[176:179], v[132:135], a[40:43], v[176:179]
    v_mfma_f32_16x16x32_bf16 v[180:183], v[128:131], a[36:39], v[180:183]
    ds_read_b128 v[128:131], v9 offset:52224
    v_mfma_f32_16x16x32_bf16 v[180:183], v[132:135], a[44:47], v[180:183]
    ds_read_b128 v[132:135], v9 offset:60416
    v_mfma_f32_16x16x32_bf16 v[184:187], v[136:139], a[32:35], v[184:187]
    buffer_load_dwordx4 v1, s[56:59], s64 offen offset:1024 sc1 lds
    v_mfma_f32_16x16x32_bf16 v[184:187], v[140:143], a[40:43], v[184:187]
    v_mfma_f32_16x16x32_bf16 v[188:191], v[136:139], a[36:39], v[188:191]
    ds_read_b128 v[136:139], v10 offset:12288
    v_mfma_f32_16x16x32_bf16 v[188:191], v[140:143], a[44:47], v[188:191]
    ds_read_b128 v[140:143], v10 offset:13312
    v_mfma_f32_16x16x32_bf16 v[192:195], v[104:107], a[32:35], v[192:195]
    s_waitcnt lgkmcnt(2)
    v_mfma_f32_16x16x32_bf16 v[192:195], v[108:111], a[40:43], v[192:195]
    v_mfma_f32_16x16x32_bf16 v[196:199], v[104:107], a[36:39], v[196:199]
    ds_read_b128 v[104:107], v9 offset:61440
    v_mfma_f32_16x16x32_bf16 v[196:199], v[108:111], a[44:47], v[196:199]
    ds_read_b128 v[108:111], v10 offset:4096
    v_mfma_f32_16x16x32_bf16 v[200:203], v[112:115], a[32:35], v[200:203]
    v_mfma_f32_16x16x32_bf16 v[200:203], v[116:119], a[40:43], v[200:203]
    v_mfma_f32_16x16x32_bf16 v[204:207], v[112:115], a[36:39], v[204:207]
    ds_read_b128 v[112:115], v9 offset:62464
    v_mfma_f32_16x16x32_bf16 v[204:207], v[116:119], a[44:47], v[204:207]
    ds_read_b128 v[116:119], v10 offset:5120
    v_mfma_f32_16x16x32_bf16 v[208:211], v[120:123], a[32:35], v[208:211]
    v_mfma_f32_16x16x32_bf16 v[208:211], v[124:127], a[40:43], v[208:211]
    v_mfma_f32_16x16x32_bf16 v[212:215], v[120:123], a[36:39], v[212:215]
    ds_read_b128 v[120:123], v9 offset:63488
    v_mfma_f32_16x16x32_bf16 v[212:215], v[124:127], a[44:47], v[212:215]
    ds_read_b128 v[124:127], v10 offset:6144
    v_mfma_f32_16x16x32_bf16 v[216:219], v[128:131], a[32:35], v[216:219]
    v_mfma_f32_16x16x32_bf16 v[216:219], v[132:135], a[40:43], v[216:219]
    v_mfma_f32_16x16x32_bf16 v[220:223], v[128:131], a[36:39], v[220:223]
    ds_read_b128 v[128:131], v9 offset:64512
    v_mfma_f32_16x16x32_bf16 v[220:223], v[132:135], a[44:47], v[220:223]
    s_waitcnt lgkmcnt(2)
    ds_read_b128 v[132:135], v10 offset:7168
    v_mfma_f32_16x16x32_bf16 v[224:227], v[136:139], a[32:35], v[224:227]
    s_add_u32 m0, s68, 69632
    v_mfma_f32_16x16x32_bf16 v[224:227], v[140:143], a[40:43], v[224:227]
    s_add_u32 s64, s64, 36864
    v_mfma_f32_16x16x32_bf16 v[228:231], v[136:139], a[36:39], v[228:231]
    buffer_load_dwordx4 v1, s[56:59], s65 offen sc1 lds
    v_mfma_f32_16x16x32_bf16 v[228:231], v[140:143], a[44:47], v[228:231]
    buffer_load_dwordx4 a[0:3], v6, s[40:43], s63 offen offset:0 sc1
    v_mfma_f32_16x16x32_bf16 v[160:163], v[104:107], a[48:51], v[160:163]
    buffer_load_dwordx4 a[4:7], v7, s[40:43], s63 offen offset:0 sc1
    v_mfma_f32_16x16x32_bf16 v[160:163], v[108:111], a[56:59], v[160:163]
    ds_read_b128 v[136:139], v10 offset:0
    ds_read_b128 v[140:143], v10 offset:8192
    v_mfma_f32_16x16x32_bf16 v[164:167], v[104:107], a[52:55], v[164:167]
    ds_read_b128 v[104:107], v10 offset:1024
    v_mfma_f32_16x16x32_bf16 v[164:167], v[108:111], a[60:63], v[164:167]
    ds_read_b128 v[108:111], v10 offset:9216
    v_mfma_f32_16x16x32_bf16 v[168:171], v[112:115], a[48:51], v[168:171]
    v_mfma_f32_16x16x32_bf16 v[168:171], v[116:119], a[56:59], v[168:171]
    v_mfma_f32_16x16x32_bf16 v[172:175], v[112:115], a[52:55], v[172:175]
    ds_read_b128 v[112:115], v10 offset:2048
    v_mfma_f32_16x16x32_bf16 v[172:175], v[116:119], a[60:63], v[172:175]
    ds_read_b128 v[116:119], v10 offset:10240
    v_mfma_f32_16x16x32_bf16 v[176:179], v[120:123], a[48:51], v[176:179]
    s_waitcnt lgkmcnt(2)
    v_mfma_f32_16x16x32_bf16 v[176:179], v[124:127], a[56:59], v[176:179]
    v_mfma_f32_16x16x32_bf16 v[180:183], v[120:123], a[52:55], v[180:183]
    ds_read_b128 v[120:123], v10 offset:3072
    v_mfma_f32_16x16x32_bf16 v[180:183], v[124:127], a[60:63], v[180:183]
    ds_read_b128 v[124:127], v10 offset:11264
    v_mfma_f32_16x16x32_bf16 v[184:187], v[128:131], a[48:51], v[184:187]
    v_mfma_f32_16x16x32_bf16 v[184:187], v[132:135], a[56:59], v[184:187]
    v_mfma_f32_16x16x32_bf16 v[188:191], v[128:131], a[52:55], v[188:191]
    ds_read_b128 v[128:131], v10 offset:14336
    v_mfma_f32_16x16x32_bf16 v[188:191], v[132:135], a[60:63], v[188:191]
    ds_read_b128 v[132:135], v10 offset:15360
    v_mfma_f32_16x16x32_bf16 v[192:195], v[136:139], a[48:51], v[192:195]
    v_mfma_f32_16x16x32_bf16 v[192:195], v[140:143], a[56:59], v[192:195]
    v_mfma_f32_16x16x32_bf16 v[196:199], v[136:139], a[52:55], v[196:199]
    s_add_u32 s65, s65, 147456
    v_mfma_f32_16x16x32_bf16 v[196:199], v[140:143], a[60:63], v[196:199]
    v_mfma_f32_16x16x32_bf16 v[200:203], v[104:107], a[48:51], v[200:203]
    s_add_u32 s63, s63, 4096
    v_mfma_f32_16x16x32_bf16 v[200:203], v[108:111], a[56:59], v[200:203]
    v_mfma_f32_16x16x32_bf16 v[204:207], v[104:107], a[52:55], v[204:207]
    v_mfma_f32_16x16x32_bf16 v[204:207], v[108:111], a[60:63], v[204:207]
    s_waitcnt lgkmcnt(0)
    v_mfma_f32_16x16x32_bf16 v[208:211], v[112:115], a[48:51], v[208:211]
    v_mfma_f32_16x16x32_bf16 v[208:211], v[116:119], a[56:59], v[208:211]
    s_waitcnt vmcnt(5)
    s_barrier
    ds_read_b128 v[136:139], v8 offset:0
    v_mfma_f32_16x16x32_bf16 v[212:215], v[112:115], a[52:55], v[212:215]
    ds_read_b128 v[140:143], v8 offset:8192
    ds_read_b128 v[104:107], v8 offset:1024
    v_mfma_f32_16x16x32_bf16 v[212:215], v[116:119], a[60:63], v[212:215]
    ds_read_b128 v[108:111], v8 offset:9216
    ds_read_b128 v[112:115], v8 offset:2048
    v_mfma_f32_16x16x32_bf16 v[216:219], v[120:123], a[48:51], v[216:219]
    ds_read_b128 v[116:119], v8 offset:10240
    v_mfma_f32_16x16x32_bf16 v[216:219], v[124:127], a[56:59], v[216:219]
    v_mfma_f32_16x16x32_bf16 v[220:223], v[120:123], a[52:55], v[220:223]
    ds_read_b128 v[120:123], v8 offset:3072
    v_mfma_f32_16x16x32_bf16 v[220:223], v[124:127], a[60:63], v[220:223]
    ds_read_b128 v[124:127], v8 offset:11264
    v_mfma_f32_16x16x32_bf16 v[224:227], v[128:131], a[48:51], v[224:227]
    v_mfma_f32_16x16x32_bf16 v[224:227], v[132:135], a[56:59], v[224:227]
    v_mfma_f32_16x16x32_bf16 v[228:231], v[128:131], a[52:55], v[228:231]
    ds_read_b128 v[128:131], v8 offset:4096
    v_mfma_f32_16x16x32_bf16 v[228:231], v[132:135], a[60:63], v[228:231]
    s_waitcnt lgkmcnt(2)
    ds_read_b128 v[132:135], v8 offset:12288
    v_mfma_f32_16x16x32_bf16 v[160:163], v[136:139], a[64:67], v[160:163]
    v_mfma_f32_16x16x32_bf16 v[160:163], v[140:143], a[72:75], v[160:163]
    v_mfma_f32_16x16x32_bf16 v[164:167], v[136:139], a[68:71], v[164:167]
    ds_read_b128 v[136:139], v8 offset:5120
    v_mfma_f32_16x16x32_bf16 v[164:167], v[140:143], a[76:79], v[164:167]
    ds_read_b128 v[140:143], v8 offset:13312
    v_mfma_f32_16x16x32_bf16 v[168:171], v[104:107], a[64:67], v[168:171]
    v_mfma_f32_16x16x32_bf16 v[168:171], v[108:111], a[72:75], v[168:171]
    v_mfma_f32_16x16x32_bf16 v[172:175], v[104:107], a[68:71], v[172:175]
    ds_read_b128 v[104:107], v8 offset:6144
    v_mfma_f32_16x16x32_bf16 v[172:175], v[108:111], a[76:79], v[172:175]
    ds_read_b128 v[108:111], v8 offset:14336
    v_mfma_f32_16x16x32_bf16 v[176:179], v[112:115], a[64:67], v[176:179]
    v_mfma_f32_16x16x32_bf16 v[176:179], v[116:119], a[72:75], v[176:179]
    v_mfma_f32_16x16x32_bf16 v[180:183], v[112:115], a[68:71], v[180:183]
    ds_read_b128 v[112:115], v8 offset:7168
    v_mfma_f32_16x16x32_bf16 v[180:183], v[116:119], a[76:79], v[180:183]
    ds_read_b128 v[116:119], v8 offset:15360
    v_mfma_f32_16x16x32_bf16 v[184:187], v[120:123], a[64:67], v[184:187]
    s_waitcnt lgkmcnt(2)
    v_mfma_f32_16x16x32_bf16 v[184:187], v[124:127], a[72:75], v[184:187]
    v_mfma_f32_16x16x32_bf16 v[188:191], v[120:123], a[68:71], v[188:191]
    ds_read_b128 v[120:123], v8 offset:32768
    v_mfma_f32_16x16x32_bf16 v[188:191], v[124:127], a[76:79], v[188:191]
    ds_read_b128 v[124:127], v8 offset:33792
    v_mfma_f32_16x16x32_bf16 v[192:195], v[128:131], a[64:67], v[192:195]
    v_mfma_f32_16x16x32_bf16 v[192:195], v[132:135], a[72:75], v[192:195]
    v_mfma_f32_16x16x32_bf16 v[196:199], v[128:131], a[68:71], v[196:199]
    ds_read_b128 v[128:131], v8 offset:18432
    v_mfma_f32_16x16x32_bf16 v[196:199], v[132:135], a[76:79], v[196:199]
    ds_read_b128 v[132:135], v8 offset:26624
    v_mfma_f32_16x16x32_bf16 v[200:203], v[136:139], a[64:67], v[200:203]
    v_mfma_f32_16x16x32_bf16 v[200:203], v[140:143], a[72:75], v[200:203]
    v_mfma_f32_16x16x32_bf16 v[204:207], v[136:139], a[68:71], v[204:207]
    v_mfma_f32_16x16x32_bf16 v[204:207], v[140:143], a[76:79], v[204:207]
    ds_read_b128 v[140:143], v8 offset:19456
    v_mfma_f32_16x16x32_bf16 v[208:211], v[104:107], a[64:67], v[208:211]
    v_mfma_f32_16x16x32_bf16 v[208:211], v[108:111], a[72:75], v[208:211]
    s_waitcnt vmcnt(0)
    s_barrier
    ds_read_b128 v[136:139], v8 offset:38912
    v_mfma_f32_16x16x32_bf16 v[212:215], v[104:107], a[68:71], v[212:215]
    ds_read_b128 v[104:107], v8 offset:27648
    v_mfma_f32_16x16x32_bf16 v[212:215], v[108:111], a[76:79], v[212:215]
    s_waitcnt lgkmcnt(3)
    ds_read_b128 v[108:111], v8 offset:39936
    v_mfma_f32_16x16x32_bf16 v[216:219], v[112:115], a[64:67], v[216:219]
    v_mfma_f32_16x16x32_bf16 v[216:219], v[116:119], a[72:75], v[216:219]
    v_mfma_f32_16x16x32_bf16 v[220:223], v[112:115], a[68:71], v[220:223]
    ds_read_b128 v[112:115], v8 offset:20480
    v_mfma_f32_16x16x32_bf16 v[220:223], v[116:119], a[76:79], v[220:223]
    ds_read_b128 v[116:119], v8 offset:28672
    v_mfma_f32_16x16x32_bf16 v[224:227], v[120:123], a[64:67], v[224:227]
    v_mfma_f32_16x16x32_bf16 v[224:227], v[124:127], a[72:75], v[224:227]
    v_mfma_f32_16x16x32_bf16 v[228:231], v[120:123], a[68:71], v[228:231]
    ds_read_b128 v[120:123], v8 offset:40960
    v_mfma_f32_16x16x32_bf16 v[228:231], v[124:127], a[76:79], v[228:231]
    ds_read_b128 v[124:127], v8 offset:21504
    v_mfma_f32_16x16x32_bf16 v[176:179], v[128:131], a[80:83], v[176:179]
    v_mfma_f32_16x16x32_bf16 v[176:179], v[132:135], a[88:91], v[176:179]
    s_waitcnt lgkmcnt(2)
    v_mfma_f32_16x16x32_bf16 v[176:179], v[136:139], a[0:3], v[176:179]
    v_mfma_f32_16x16x32_bf16 v[180:183], v[128:131], a[84:87], v[180:183]
    ds_read_b128 v[128:131], v8 offset:29696
    v_mfma_f32_16x16x32_bf16 v[180:183], v[132:135], a[92:95], v[180:183]
    ds_read_b128 v[132:135], v8 offset:41984
    v_mfma_f32_16x16x32_bf16 v[180:183], v[136:139], a[4:7], v[180:183]
    ds_read_b128 v[136:139], v8 offset:22528
    v_mfma_f32_16x16x32_bf16 v[184:187], v[140:143], a[80:83], v[184:187]
    v_mfma_f32_16x16x32_bf16 v[184:187], v[104:107], a[88:91], v[184:187]
    v_cvt_pk_bf16_f32 v64, v176, v177
    v_cvt_pk_bf16_f32 v65, v178, v179
    v_mfma_f32_16x16x32_bf16 v[184:187], v[108:111], a[0:3], v[184:187]
    v_mfma_f32_16x16x32_bf16 v[188:191], v[140:143], a[84:87], v[188:191]
    ds_read_b128 v[140:143], v8 offset:30720
    v_cvt_pk_bf16_f32 v66, v180, v181
    v_mfma_f32_16x16x32_bf16 v[188:191], v[104:107], a[92:95], v[188:191]
    ds_read_b128 v[104:107], v8 offset:43008
    v_cvt_pk_bf16_f32 v67, v182, v183
    v_mfma_f32_16x16x32_bf16 v[188:191], v[108:111], a[4:7], v[188:191]
    ds_read_b128 v[108:111], v8 offset:23552
    v_cvt_pk_bf16_f32 v68, v184, v185
    v_mfma_f32_16x16x32_bf16 v[192:195], v[112:115], a[80:83], v[192:195]
    v_cvt_pk_bf16_f32 v69, v186, v187
    v_mfma_f32_16x16x32_bf16 v[192:195], v[116:119], a[88:91], v[192:195]
    s_waitcnt lgkmcnt(3)
    buffer_store_dwordx4 v[64:67], v1, s[48:51], s71 offen offset:0 sc1
    v_mfma_f32_16x16x32_bf16 v[192:195], v[120:123], a[0:3], v[192:195]
    v_mfma_f32_16x16x32_bf16 v[196:199], v[112:115], a[84:87], v[196:199]
    ds_read_b128 v[112:115], v8 offset:31744
    v_cvt_pk_bf16_f32 v70, v188, v189
    v_mfma_f32_16x16x32_bf16 v[196:199], v[116:119], a[92:95], v[196:199]
    ds_read_b128 v[116:119], v8 offset:44032
    v_cvt_pk_bf16_f32 v71, v190, v191
    v_mfma_f32_16x16x32_bf16 v[196:199], v[120:123], a[4:7], v[196:199]
    ds_read_b128 v[120:123], v8 offset:34816
    v_cvt_pk_bf16_f32 v72, v192, v193
    v_mfma_f32_16x16x32_bf16 v[200:203], v[124:127], a[80:83], v[200:203]
    buffer_store_dwordx4 v[68:71], v1, s[48:51], s71 offen offset:1024 sc1
    v_mfma_f32_16x16x32_bf16 v[200:203], v[128:131], a[88:91], v[200:203]
    s_lshl_b32 s71, s6, 5
    v_cvt_pk_bf16_f32 v73, v194, v195
    v_mfma_f32_16x16x32_bf16 v[200:203], v[132:135], a[0:3], v[200:203]
    s_add_u32 s98, s98, s71
    v_cvt_pk_bf16_f32 v74, v196, v197
    v_cvt_pk_bf16_f32 v75, v198, v199
    v_mfma_f32_16x16x32_bf16 v[204:207], v[124:127], a[84:87], v[204:207]
    s_mul_i32 s98, s98, 3
    ds_read_b128 v[124:127], v8 offset:35840
    v_mfma_f32_16x16x32_bf16 v[204:207], v[128:131], a[92:95], v[204:207]
    s_sub_u32 s98, s98, s99
    ds_read_b128 v[128:131], v9 offset:4096
    v_cvt_pk_bf16_f32 v76, v200, v201
    v_mfma_f32_16x16x32_bf16 v[204:207], v[132:135], a[4:7], v[204:207]
    s_add_u32 s98, s98, 3
    ds_read_b128 v[132:135], v8 offset:16384
    v_cvt_pk_bf16_f32 v77, v202, v203
    v_mfma_f32_16x16x32_bf16 v[208:211], v[136:139], a[80:83], v[208:211]
    s_lshl2_add_u32 s98, s98, s4
    s_waitcnt lgkmcnt(3)
    v_mfma_f32_16x16x32_bf16 v[208:211], v[140:143], a[88:91], v[208:211]
    s_mov_b32 s99, 3
    v_mfma_f32_16x16x32_bf16 v[208:211], v[104:107], a[0:3], v[208:211]
    s_mul_i32 s71, s98, 3072
    v_cvt_pk_bf16_f32 v78, v204, v205
    v_cvt_pk_bf16_f32 v79, v206, v207
    v_mfma_f32_16x16x32_bf16 v[212:215], v[136:139], a[84:87], v[212:215]
    s_lshl3_add_u32 s98, s99, s5
    ds_read_b128 v[136:139], v8 offset:24576
    v_mfma_f32_16x16x32_bf16 v[212:215], v[140:143], a[92:95], v[212:215]
    s_and_b32 s98, s98, 31
    ds_read_b128 v[140:143], v8 offset:36864
    v_cvt_pk_bf16_f32 v64, v208, v209
    v_mfma_f32_16x16x32_bf16 v[212:215], v[104:107], a[4:7], v[212:215]
    buffer_store_dwordx4 v[72:75], v1, s[48:51], s71 offen offset:0 sc1
    v_mfma_f32_16x16x32_bf16 v[216:219], v[108:111], a[80:83], v[216:219]
    buffer_store_dwordx4 v[76:79], v1, s[48:51], s71 offen offset:1024 sc1
    v_mfma_f32_16x16x32_bf16 v[216:219], v[112:115], a[88:91], v[216:219]
    s_lshl_b32 s71, s6, 5
    ds_read_b128 v[104:107], v8 offset:17408
    v_cvt_pk_bf16_f32 v65, v210, v211
    v_mfma_f32_16x16x32_bf16 v[216:219], v[116:119], a[0:3], v[216:219]
    s_add_u32 s98, s98, s71
    v_cvt_pk_bf16_f32 v66, v212, v213
    v_cvt_pk_bf16_f32 v67, v214, v215
    v_mfma_f32_16x16x32_bf16 v[220:223], v[108:111], a[84:87], v[220:223]
    s_mul_i32 s98, s98, 3
    ds_read_b128 v[108:111], v8 offset:25600
    v_mfma_f32_16x16x32_bf16 v[220:223], v[112:115], a[92:95], v[220:223]
    s_sub_u32 s98, s98, s99
    ds_read_b128 v[112:115], v8 offset:37888
    v_cvt_pk_bf16_f32 v68, v216, v217
    v_mfma_f32_16x16x32_bf16 v[220:223], v[116:119], a[4:7], v[220:223]
    s_add_u32 s98, s98, 3
    v_cvt_pk_bf16_f32 v69, v218, v219
    v_mfma_f32_16x16x32_bf16 v[224:227], v[120:123], a[80:83], v[224:227]
    s_sub_u32 s99, s4, s61
    s_waitcnt lgkmcnt(2)
    v_mfma_f32_16x16x32_bf16 v[224:227], v[124:127], a[88:91], v[224:227]
    s_lshl2_add_u32 s98, s98, s4
    v_mfma_f32_16x16x32_bf16 v[224:227], v[128:131], a[0:3], v[224:227]
    s_and_b32 s99, s99, 3
    v_cvt_pk_bf16_f32 v70, v220, v221
    v_cvt_pk_bf16_f32 v71, v222, v223
    v_mfma_f32_16x16x32_bf16 v[228:231], v[120:123], a[84:87], v[228:231]
    s_mul_i32 s71, s98, 3072
    buffer_store_dwordx4 v[64:67], v1, s[48:51], s71 offen offset:0 sc1
    v_mfma_f32_16x16x32_bf16 v[228:231], v[124:127], a[92:95], v[228:231]
    s_lshl3_add_u32 s98, s99, s5
    buffer_store_dwordx4 v[68:71], v1, s[48:51], s71 offen offset:1024 sc1
    v_mfma_f32_16x16x32_bf16 v[228:231], v[128:131], a[4:7], v[228:231]
    s_and_b32 s98, s98, 31
    v_cvt_pk_bf16_f32 v72, v224, v225
    v_cvt_pk_bf16_f32 v73, v226, v227
    v_mfma_f32_16x16x32_bf16 v[160:163], v[132:135], a[80:83], v[160:163]
    s_lshl_b32 s71, s6, 5
    v_mfma_f32_16x16x32_bf16 v[160:163], v[136:139], a[88:91], v[160:163]
    s_add_u32 s98, s98, s71
    v_mfma_f32_16x16x32_bf16 v[160:163], v[140:143], a[0:3], v[160:163]
    s_mul_i32 s98, s98, 3
    v_cvt_pk_bf16_f32 v74, v228, v229
    v_cvt_pk_bf16_f32 v75, v230, v231
    v_mfma_f32_16x16x32_bf16 v[164:167], v[132:135], a[84:87], v[164:167]
    s_sub_u32 s98, s98, s99
    v_mfma_f32_16x16x32_bf16 v[164:167], v[136:139], a[92:95], v[164:167]
    s_add_u32 s98, s98, 3
    v_mfma_f32_16x16x32_bf16 v[164:167], v[140:143], a[4:7], v[164:167]
    s_lshl2_add_u32 s98, s98, s4
    v_mfma_f32_16x16x32_bf16 v[168:171], v[104:107], a[80:83], v[168:171]
    s_mul_i32 s71, s98, 3072
    s_waitcnt lgkmcnt(0)
    v_mfma_f32_16x16x32_bf16 v[168:171], v[108:111], a[88:91], v[168:171]
    s_cmp_eq_u32 s99, 0
    s_cselect_b32 s71, 1073741824, s71
    v_mfma_f32_16x16x32_bf16 v[168:171], v[112:115], a[0:3], v[168:171]
    buffer_store_dwordx4 v[72:75], v1, s[48:51], s71 offen offset:2048 sc1
    v_mfma_f32_16x16x32_bf16 v[172:175], v[104:107], a[84:87], v[172:175]
    v_mfma_f32_16x16x32_bf16 v[172:175], v[108:111], a[92:95], v[172:175]
    v_mfma_f32_16x16x32_bf16 v[172:175], v[112:115], a[4:7], v[172:175]
    v_mov_b32 v31, 1
    v_mov_b32 v23, 1073741824
    v_cmp_eq_u32 vcc, 0, v1
    s_lshl2_add_u32 s98, s4, s101
    s_nop 0
    v_cndmask_b32_e64 v23, v23, 4, vcc
    v_lshrrev_b32 v19, 4, v1
    v_min_u32 v19, 2, v19
    s_add_u32 s99, s5, 8
    v_lshl_add_u32 v19, v19, 3, s99
    v_and_b32 v19, 31, v19
    v_lshlrev_b32 v19, 7, v19
    s_lshl_b32 s66, s6, 10
    s_add_u32 s66, s66, s4
    s_lshl2_add_u32 s66, s66, 4
    s_waitcnt vmcnt(0)
    buffer_store_dword v31, v23, s[32:35], s98 offen sc1
    s_lshl2_add_u32 s98, s62, s4
    s_lshl_b32 s98, s98, 5
    v_bfe_u32 v4, v1, 4, 4
    v_add_u32 v4, s98, v4
    v_mul_u32_u24 v4, 1152, v4
    v_lshrrev_b32 v5, 8, v1
    v_lshl_add_u32 v4, v5, 3, v4
    v_add_u32 v5, 18432, v4
    s_and_b32 s98, s5, 3
    s_mul_i32 s98, s98, 288
    s_add_u32 s65, s98, 256
    s_lshl_b32 s99, s61, 6
    s_add_u32 s64, s98, s99
    s_lshr_b32 s98, s101, 7
    s_mul_i32 s98, s98, 12
    s_add_u32 s98, s98, s4
    s_mul_i32 s71, s98, 3072
    s_cmp_eq_u32 s4, s61
    s_cselect_b32 s65, s65, 1073741824
    s_cselect_b32 s63, s71, 1073741824
    buffer_load_dword v3, v19, s[32:35], s66 offen sc1
    s_waitcnt vmcnt(0)
    v_cmp_gt_u32 vcc, 1, v3
    s_nop 1
    s_and_b64 vcc, vcc, exec
    s_cbranch_scc1 SPIN_X
BACK_X:
    s_add_u32 s98, s71, 0
    buffer_load_dwordx4 v[32:35], v1, s[48:51], s98 offen offset:0 sc1
    s_add_u32 s98, s71, 12288
    buffer_load_dwordx4 v[44:47], v1, s[48:51], s98 offen offset:0 sc1
    s_add_u32 s98, s71, 24576
    buffer_load_dwordx4 v[56:59], v1, s[48:51], s98 offen offset:0 sc1
    s_add_u32 s98, s71, 0
    buffer_load_dwordx4 v[36:39], v1, s[48:51], s98 offen offset:1024 sc1
    s_add_u32 s98, s71, 12288
    buffer_load_dwordx4 v[48:51], v1, s[48:51], s98 offen offset:1024 sc1
    s_add_u32 s98, s71, 24576
    buffer_load_dwordx4 v[60:63], v1, s[48:51], s98 offen offset:1024 sc1
    s_add_u32 s98, s63, 0
    buffer_load_dwordx4 v[40:43], v1, s[48:51], s98 offen offset:2048 sc1
    s_add_u32 s98, s63, 12288
    buffer_load_dwordx4 v[52:55], v1, s[48:51], s98 offen offset:2048 sc1
    s_add_u32 s98, s63, 24576
    buffer_load_dwordx4 v[64:67], v1, s[48:51], s98 offen offset:2048 sc1
    s_waitcnt vmcnt(6)
    v_lshlrev_b32 v68, 16, v32
    v_and_b32 v69, 0xffff0000, v32
    v_pk_add_f32 v[160:161], v[160:161], v[68:69]
    v_lshlrev_b32 v68, 16, v33
    v_and_b32 v69, 0xffff0000, v33
    v_pk_add_f32 v[162:163], v[162:163], v[68:69]
    v_lshlrev_b32 v68, 16, v34
    v_and_b32 v69, 0xffff0000, v34
    v_pk_add_f32 v[164:165], v[164:165], v[68:69]
    v_lshlrev_b32 v68, 16, v35
    v_and_b32 v69, 0xffff0000, v35
    v_pk_add_f32 v[166:167], v[166:167], v[68:69]
    v_lshlrev_b32 v68, 16, v44
    v_and_b32 v69, 0xffff0000, v44
    v_pk_add_f32 v[160:161], v[160:161], v[68:69]
    v_lshlrev_b32 v68, 16, v45
    v_and_b32 v69, 0xffff0000, v45
    v_pk_add_f32 v[162:163], v[162:163], v[68:69]
    v_lshlrev_b32 v68, 16, v46
    v_and_b32 v69, 0xffff0000, v46
    v_pk_add_f32 v[164:165], v[164:165], v[68:69]
    v_lshlrev_b32 v68, 16, v47
    v_and_b32 v69, 0xffff0000, v47
    v_pk_add_f32 v[166:167], v[166:167], v[68:69]
    v_lshlrev_b32 v68, 16, v56
    v_and_b32 v69, 0xffff0000, v56
    v_pk_add_f32 v[160:161], v[160:161], v[68:69]
    v_lshlrev_b32 v68, 16, v57
    v_and_b32 v69, 0xffff0000, v57
    v_pk_add_f32 v[162:163], v[162:163], v[68:69]
    v_lshlrev_b32 v68, 16, v58
    v_and_b32 v69, 0xffff0000, v58
    v_pk_add_f32 v[164:165], v[164:165], v[68:69]
    v_lshlrev_b32 v68, 16, v59
    v_and_b32 v69, 0xffff0000, v59
    v_pk_add_f32 v[166:167], v[166:167], v[68:69]
    v_cvt_pk_bf16_f32 v160, v160, v161
    v_cvt_pk_bf16_f32 v161, v162, v163
    buffer_store_dwordx2 v[160:161], v4, s[24:27], s64 offen
    v_cvt_pk_bf16_f32 v164, v164, v165
    v_cvt_pk_bf16_f32 v165, v166, v167
    buffer_store_dwordx2 v[164:165], v5, s[24:27], s64 offen
    s_waitcnt vmcnt(5)
    v_lshlrev_b32 v68, 16, v36
    v_and_b32 v69, 0xffff0000, v36
    v_pk_add_f32 v[168:169], v[168:169], v[68:69]
    v_lshlrev_b32 v68, 16, v37
    v_and_b32 v69, 0xffff0000, v37
    v_pk_add_f32 v[170:171], v[170:171], v[68:69]
    v_lshlrev_b32 v68, 16, v38
    v_and_b32 v69, 0xffff0000, v38
    v_pk_add_f32 v[172:173], v[172:173], v[68:69]
    v_lshlrev_b32 v68, 16, v39
    v_and_b32 v69, 0xffff0000, v39
    v_pk_add_f32 v[174:175], v[174:175], v[68:69]
    v_lshlrev_b32 v68, 16, v48
    v_and_b32 v69, 0xffff0000, v48
    v_pk_add_f32 v[168:169], v[168:169], v[68:69]
    v_lshlrev_b32 v68, 16, v49
    v_and_b32 v69, 0xffff0000, v49
    v_pk_add_f32 v[170:171], v[170:171], v[68:69]
    v_lshlrev_b32 v68, 16, v50
    v_and_b32 v69, 0xffff0000, v50
    v_pk_add_f32 v[172:173], v[172:173], v[68:69]
    v_lshlrev_b32 v68, 16, v51
    v_and_b32 v69, 0xffff0000, v51
    v_pk_add_f32 v[174:175], v[174:175], v[68:69]
    v_lshlrev_b32 v68, 16, v60
    v_and_b32 v69, 0xffff0000, v60
    v_pk_add_f32 v[168:169], v[168:169], v[68:69]
    v_lshlrev_b32 v68, 16, v61
    v_and_b32 v69, 0xffff0000, v61
    v_pk_add_f32 v[170:171], v[170:171], v[68:69]
    v_lshlrev_b32 v68, 16, v62
    v_and_b32 v69, 0xffff0000, v62
    v_pk_add_f32 v[172:173], v[172:173], v[68:69]
    v_lshlrev_b32 v68, 16, v63
    v_and_b32 v69, 0xffff0000, v63
    v_pk_add_f32 v[174:175], v[174:175], v[68:69]
    v_cvt_pk_bf16_f32 v168, v168, v169
    v_cvt_pk_bf16_f32 v169, v170, v171
    buffer_store_dwordx2 v[168:169], v4, s[24:27], s64 offen offset:32
    v_cvt_pk_bf16_f32 v172, v172, v173
    v_cvt_pk_bf16_f32 v173, v174, v175
    buffer_store_dwordx2 v[172:173], v5, s[24:27], s64 offen offset:32
    s_waitcnt vmcnt(4)
    v_lshlrev_b32 v68, 16, v40
    v_and_b32 v69, 0xffff0000, v40
    v_pk_add_f32 v[224:225], v[224:225], v[68:69]
    v_lshlrev_b32 v68, 16, v41
    v_and_b32 v69, 0xffff0000, v41
    v_pk_add_f32 v[226:227], v[226:227], v[68:69]
    v_lshlrev_b32 v68, 16, v42
    v_and_b32 v69, 0xffff0000, v42
    v_pk_add_f32 v[228:229], v[228:229], v[68:69]
    v_lshlrev_b32 v68, 16, v43
    v_and_b32 v69, 0xffff0000, v43
    v_pk_add_f32 v[230:231], v[230:231], v[68:69]
    v_lshlrev_b32 v68, 16, v52
    v_and_b32 v69, 0xffff0000, v52
    v_pk_add_f32 v[224:225], v[224:225], v[68:69]
    v_lshlrev_b32 v68, 16, v53
    v_and_b32 v69, 0xffff0000, v53
    v_pk_add_f32 v[226:227], v[226:227], v[68:69]
    v_lshlrev_b32 v68, 16, v54
    v_and_b32 v69, 0xffff0000, v54
    v_pk_add_f32 v[228:229], v[228:229], v[68:69]
    v_lshlrev_b32 v68, 16, v55
    v_and_b32 v69, 0xffff0000, v55
    v_pk_add_f32 v[230:231], v[230:231], v[68:69]
    v_lshlrev_b32 v68, 16, v64
    v_and_b32 v69, 0xffff0000, v64
    v_pk_add_f32 v[224:225], v[224:225], v[68:69]
    v_lshlrev_b32 v68, 16, v65
    v_and_b32 v69, 0xffff0000, v65
    v_pk_add_f32 v[226:227], v[226:227], v[68:69]
    v_lshlrev_b32 v68, 16, v66
    v_and_b32 v69, 0xffff0000, v66
    v_pk_add_f32 v[228:229], v[228:229], v[68:69]
    v_lshlrev_b32 v68, 16, v67
    v_and_b32 v69, 0xffff0000, v67
    v_pk_add_f32 v[230:231], v[230:231], v[68:69]
    v_cvt_pk_bf16_f32 v224, v224, v225
    v_cvt_pk_bf16_f32 v225, v226, v227
    buffer_store_dwordx2 v[224:225], v4, s[24:27], s65 offen
    v_cvt_pk_bf16_f32 v228, v228, v229
    v_cvt_pk_bf16_f32 v229, v230, v231
    buffer_store_dwordx2 v[228:229], v5, s[24:27], s65 offen
K1_END:
    s_endpgm
K1_LB_MASK:
    s_nop 1
    v_add_f32 v212, s12, v144
    v_fma_f32 v176, v208, s8, v212
    v_fma_f32 v177, v209, s8, v212
    v_fma_f32 v178, v210, s8, v212
    v_fma_f32 v179, v211, s8, v212
    v_add_f32 v213, s13, v144
    v_fma_f32 v180, v208, s9, v213
    v_fma_f32 v181, v209, s9, v213
    v_fma_f32 v182, v210, s9, v213
    v_fma_f32 v183, v211, s9, v213
    v_add_f32 v214, s14, v144
    v_fma_f32 v184, v208, s10, v214
    v_fma_f32 v185, v209, s10, v214
    v_fma_f32 v186, v210, s10, v214
    v_fma_f32 v187, v211, s10, v214
    v_add_f32 v215, s15, v144
    v_fma_f32 v188, v208, s11, v215
    v_fma_f32 v189, v209, s11, v215
    v_fma_f32 v190, v210, s11, v215
    v_fma_f32 v191, v211, s11, v215
    s_nop 1
    s_branch K1_LB_BACK
K1_LS_MASK:
    s_nop 1
    v_add_f32 v212, s12, v152
    v_fma_f32 v176, v208, s8, v212
    v_fma_f32 v177, v209, s8, v212
    v_fma_f32 v178, v210, s8, v212
    v_fma_f32 v179, v211, s8, v212
    v_add_f32 v213, s13, v152
    v_fma_f32 v180, v208, s9, v213
    v_fma_f32 v181, v209, s9, v213
    v_fma_f32 v182, v210, s9, v213
    v_fma_f32 v183, v211, s9, v213
    v_add_f32 v214, s14, v152
    v_fma_f32 v184, v208, s10, v214
    v_fma_f32 v185, v209, s10, v214
    v_fma_f32 v186, v210, s10, v214
    v_fma_f32 v187, v211, s10, v214
    v_add_f32 v215, s15, v152
    v_fma_f32 v188, v208, s11, v215
    v_fma_f32 v189, v209, s11, v215
    v_fma_f32 v190, v210, s11, v215
    v_fma_f32 v191, v211, s11, v215
    s_nop 1
    s_branch K1_LS_BACK
K1_HAVEM_R:
    s_add_u32 m0, s76, s75
    s_nop 0
    buffer_load_dwordx4 v1, s[36:39], s77 offen sc1 lds
    buffer_load_dwordx4 v1, s[36:39], s77 offen offset:1024 sc1 lds
    buffer_load_dwordx4 v1, s[36:39], s77 offen offset:2048 sc1 lds
    buffer_load_dwordx4 v1, s[36:39], s77 offen offset:3072 sc1 lds
    s_add_u32 s100, s77, 4096
    s_add_u32 m0, m0, 4096
    s_nop 0
    buffer_load_dwordx4 v1, s[36:39], s100 offen sc1 lds
    buffer_load_dwordx4 v1, s[36:39], s100 offen offset:1024 sc1 lds
    buffer_load_dwordx4 v1, s[36:39], s100 offen offset:2048 sc1 lds
    buffer_load_dwordx4 v1, s[36:39], s100 offen offset:3072 sc1 lds
    s_add_u32 s77, s77, 32768
    s_add_u32 s76, s76, 32768
    s_branch K1_HAVEM
K1_REDO:
    s_mov_b32 s83, 1
    s_waitcnt vmcnt(0) lgkmcnt(0)
    s_barrier
    v_lshrrev_b32 v92, 4, v1
    v_and_b32 v64, 15, v92
    v_lshrrev_b32 v92, 4, v92
    v_lshlrev_b32 v92, 2, v92
    v_sub_u32 v92, v64, v92
    s_lshl_b32 s98, s4, 4
    v_add_u32 v92, s98, v92
    s_lshl_b32 s98, s6, 7
    s_sub_u32 s99, 1920, s98
    v_add_u32 v64, s98, v92
    v_add_u32 v65, 64, v64
    v_add_u32 v66, s99, v92
    v_add_u32 v67, 64, v66
    v_mov_b32 v93, 0xf149f2ca
    v_mov_b32 v68, v93
    v_mov_b32 v69, v93
    v_mov_b32 v70, v93
    v_mov_b32 v71, v93
    s_mov_b32 s78, 0
    s_add_u32 s99, s99, 128
K1_REDO_L:
    s_lshr_b32 s7, s78, 6
    s_lshl_b32 s7, s7, 15
    s_bfe_u32 s98, s78, 0x20004
    s_lshl_b32 s98, s98, 12
    s_add_u32 s7, s7, s98
    buffer_load_dwordx4 v[72:75], v1, s[36:39], s7 offen offset:0 sc1
    buffer_load_dwordx4 v[76:79], v1, s[36:39], s7 offen offset:1024 sc1
    buffer_load_dwordx4 v[80:83], v1, s[36:39], s7 offen offset:2048 sc1
    buffer_load_dwordx4 v[84:87], v1, s[36:39], s7 offen offset:3072 sc1
    s_waitcnt vmcnt(0)
    v_mfma_f32_16x16x32_bf16 v[88:91], v[72:75], v[128:131], 0
    v_mfma_f32_16x16x32_bf16 v[88:91], v[76:79], v[160:163], v[88:91]
    v_mfma_f32_16x16x32_bf16 v[88:91], v[80:83], v[192:195], v[88:91]
    v_mfma_f32_16x16x32_bf16 v[88:91], v[84:87], v[224:227], v[88:91]
    v_subrev_u32 v92, s78, v64
    v_cmp_le_i32 vcc, 0, v92
    s_nop 5
    v_cndmask_b32 v88, v93, v88, vcc
    v_max_f32 v68, v68, v88
    v_cmp_le_i32 vcc, 1, v92
    s_nop 1
    v_cndmask_b32 v89, v93, v89, vcc
    v_max_f32 v68, v68, v89
    v_cmp_le_i32 vcc, 2, v92
    s_nop 1
    v_cndmask_b32 v90, v93, v90, vcc
    v_max_f32 v68, v68, v90
    v_cmp_le_i32 vcc, 3, v92
    s_nop 1
    v_cndmask_b32 v91, v93, v91, vcc
    v_max_f32 v68, v68, v91
    v_mfma_f32_16x16x32_bf16 v[88:91], v[72:75], v[132:135], 0
    v_mfma_f32_16x16x32_bf16 v[88:91], v[76:79], v[164:167], v[88:91]
    v_mfma_f32_16x16x32_bf16 v[88:91], v[80:83], v[196:199], v[88:91]
    v_mfma_f32_16x16x32_bf16 v[88:91], v[84:87], v[228:231], v[88:91]
    v_subrev_u32 v92, s78, v65
    v_cmp_le_i32 vcc, 0, v92
    s_nop 5
    v_cndmask_b32 v88, v93, v88, vcc
    v_max_f32 v69, v69, v88
    v_cmp_le_i32 vcc, 1, v92
    s_nop 1
    v_cndmask_b32 v89, v93, v89, vcc
    v_max_f32 v69, v69, v89
    v_cmp_le_i32 vcc, 2, v92
    s_nop 1
    v_cndmask_b32 v90, v93, v90, vcc
    v_max_f32 v69, v69, v90
    v_cmp_le_i32 vcc, 3, v92
    s_nop 1
    v_cndmask_b32 v91, v93, v91, vcc
    v_max_f32 v69, v69, v91
    v_mfma_f32_16x16x32_bf16 v[88:91], v[72:75], v[136:139], 0
    v_mfma_f32_16x16x32_bf16 v[88:91], v[76:79], v[168:171], v[88:91]
    v_mfma_f32_16x16x32_bf16 v[88:91], v[80:83], v[200:203], v[88:91]
    v_mfma_f32_16x16x32_bf16 v[88:91], v[84:87], v[232:235], v[88:91]
    v_subrev_u32 v92, s78, v66
    v_cmp_le_i32 vcc, 0, v92
    s_nop 5
    v_cndmask_b32 v88, v93, v88, vcc
    v_max_f32 v70, v70, v88
    v_cmp_le_i32 vcc, 1, v92
    s_nop 1
    v_cndmask_b32 v89, v93, v89, vcc
    v_max_f32 v70, v70, v89
    v_cmp_le_i32 vcc, 2, v92
    s_nop 1
    v_cndmask_b32 v90, v93, v90, vcc
    v_max_f32 v70, v70, v90
    v_cmp_le_i32 vcc, 3, v92
    s_nop 1
    v_cndmask_b32 v91, v93, v91, vcc
    v_max_f32 v70, v70, v91
    v_mfma_f32_16x16x32_bf16 v[88:91], v[72:75], v[140:143], 0
    v_mfma_f32_16x16x32_bf16 v[88:91], v[76:79], v[172:175], v[88:91]
    v_mfma_f32_16x16x32_bf16 v[88:91], v[80:83], v[204:207], v[88:91]
    v_mfma_f32_16x16x32_bf16 v[88:91], v[84:87], v[236:239], v[88:91]
    v_subrev_u32 v92, s78, v67
    v_cmp_le_i32 vcc, 0, v92
    s_nop 5
    v_cndmask_b32 v88, v93, v88, vcc
    v_max_f32 v71, v71, v88
    v_cmp_le_i32 vcc, 1, v92
    s_nop 1
    v_cndmask_b32 v89, v93, v89, vcc
    v_max_f32 v71, v71, v89
    v_cmp_le_i32 vcc, 2, v92
    s_nop 1
    v_cndmask_b32 v90, v93, v90, vcc
    v_max_f32 v71, v71, v90
    v_cmp_le_i32 vcc, 3, v92
    s_nop 1
    v_cndmask_b32 v91, v93, v91, vcc
    v_max_f32 v71, v71, v91
    s_add_u32 s78, s78, 16
    s_cmp_lt_u32 s78, s99
    s_cbranch_scc1 K1_REDO_L
    v_mov_b32 v92, v68
    s_nop 1
    v_permlane32_swap_b32 v68, v92
    v_max_f32 v68, v68, v92
    v_mov_b32 v92, v68
    s_nop 1
    v_permlane16_swap_b32 v68, v92
    v_max_f32 v68, v68, v92
    v_sub_f32 v144, 0, v68
    v_sub_f32 v145, 0, v68
    v_sub_f32 v146, 0, v68
    v_sub_f32 v147, 0, v68
    v_mov_b32 v92, v69
    s_nop 1
    v_permlane32_swap_b32 v69, v92
    v_max_f32 v69, v69, v92
    v_mov_b32 v92, v69
    s_nop 1
    v_permlane16_swap_b32 v69, v92
    v_max_f32 v69, v69, v92
    v_sub_f32 v148, 0, v69
    v_sub_f32 v149, 0, v69
    v_sub_f32 v150, 0, v69
    v_sub_f32 v151, 0, v69
    v_mov_b32 v92, v70
    s_nop 1
    v_permlane32_swap_b32 v70, v92
    v_max_f32 v70, v70, v92
    v_mov_b32 v92, v70
    s_nop 1
    v_permlane16_swap_b32 v70, v92
    v_max_f32 v70, v70, v92
    v_sub_f32 v152, 0, v70
    v_sub_f32 v153, 0, v70
    v_sub_f32 v154, 0, v70
    v_sub_f32 v155, 0, v70
    v_mov_b32 v92, v71
    s_nop 1
    v_permlane32_swap_b32 v71, v92
    v_max_f32 v71, v71, v92
    v_mov_b32 v92, v71
    s_nop 1
    v_permlane16_swap_b32 v71, v92
    v_max_f32 v71, v71, v92
    v_sub_f32 v156, 0, v71
    v_sub_f32 v157, 0, v71
    v_sub_f32 v158, 0, v71
    v_sub_f32 v159, 0, v71
    v_accvgpr_write_b32 a0, 0
    v_accvgpr_write_b32 a1, 0
    v_accvgpr_write_b32 a2, 0
    v_accvgpr_write_b32 a3, 0
    v_accvgpr_write_b32 a4, 0
    v_accvgpr_write_b32 a5, 0
    v_accvgpr_write_b32 a6, 0
    v_accvgpr_write_b32 a7, 0
    v_accvgpr_write_b32 a8, 0
    v_accvgpr_write_b32 a9, 0
    v_accvgpr_write_b32 a10, 0
    v_accvgpr_write_b32 a11, 0
    v_accvgpr_write_b32 a12, 0
    v_accvgpr_write_b32 a13, 0
    v_accvgpr_write_b32 a14, 0
    v_accvgpr_write_b32 a15, 0
    v_accvgpr_write_b32 a16, 0
    v_accvgpr_write_b32 a17, 0
    v_accvgpr_write_b32 a18, 0
    v_accvgpr_write_b32 a19, 0
    v_accvgpr_write_b32 a20, 0
    v_accvgpr_write_b32 a21, 0
    v_accvgpr_write_b32 a22, 0
    v_accvgpr_write_b32 a23, 0
    v_accvgpr_write_b32 a24, 0
    v_accvgpr_write_b32 a25, 0
    v_accvgpr_write_b32 a26, 0
    v_accvgpr_write_b32 a27, 0
    v_accvgpr_write_b32 a28, 0
    v_accvgpr_write_b32 a29, 0
    v_accvgpr_write_b32 a30, 0
    v_accvgpr_write_b32 a31, 0
    v_accvgpr_write_b32 a32, 0
    v_accvgpr_write_b32 a33, 0
    v_accvgpr_write_b32 a34, 0
    v_accvgpr_write_b32 a35, 0
    v_accvgpr_write_b32 a36, 0
    v_accvgpr_write_b32 a37, 0
    v_accvgpr_write_b32 a38, 0
    v_accvgpr_write_b32 a39, 0
    v_accvgpr_write_b32 a40, 0
    v_accvgpr_write_b32 a41, 0
    v_accvgpr_write_b32 a42, 0
    v_accvgpr_write_b32 a43, 0
    v_accvgpr_write_b32 a44, 0
    v_accvgpr_write_b32 a45, 0
    v_accvgpr_write_b32 a46, 0
    v_accvgpr_write_b32 a47, 0
    v_accvgpr_write_b32 a48, 0
    v_accvgpr_write_b32 a49, 0
    v_accvgpr_write_b32 a50, 0
    v_accvgpr_write_b32 a51, 0
    v_accvgpr_write_b32 a52, 0
    v_accvgpr_write_b32 a53, 0
    v_accvgpr_write_b32 a54, 0
    v_accvgpr_write_b32 a55, 0
    v_accvgpr_write_b32 a56, 0
    v_accvgpr_write_b32 a57, 0
    v_accvgpr_write_b32 a58, 0
    v_accvgpr_write_b32 a59, 0
    v_accvgpr_write_b32 a60, 0
    v_accvgpr_write_b32 a61, 0
    v_accvgpr_write_b32 a62, 0
    v_accvgpr_write_b32 a63, 0
    v_accvgpr_write_b32 a144, 0
    v_accvgpr_write_b32 a145, 0
    v_accvgpr_write_b32 a146, 0
    v_accvgpr_write_b32 a147, 0
    v_accvgpr_write_b32 a148, 0
    v_accvgpr_write_b32 a149, 0
    v_accvgpr_write_b32 a150, 0
    v_accvgpr_write_b32 a151, 0
    v_accvgpr_write_b32 a152, 0
    v_accvgpr_write_b32 a153, 0
    v_accvgpr_write_b32 a154, 0
    v_accvgpr_write_b32 a155, 0
    v_accvgpr_write_b32 a156, 0
    v_accvgpr_write_b32 a157, 0
    v_accvgpr_write_b32 a158, 0
    v_accvgpr_write_b32 a159, 0
    v_accvgpr_write_b32 a160, 0
    v_accvgpr_write_b32 a161, 0
    v_accvgpr_write_b32 a162, 0
    v_accvgpr_write_b32 a163, 0
    v_accvgpr_write_b32 a164, 0
    v_accvgpr_write_b32 a165, 0
    v_accvgpr_write_b32 a166, 0
    v_accvgpr_write_b32 a167, 0
    v_accvgpr_write_b32 a168, 0
    v_accvgpr_write_b32 a169, 0
    v_accvgpr_write_b32 a170, 0
    v_accvgpr_write_b32 a171, 0
    v_accvgpr_write_b32 a172, 0
    v_accvgpr_write_b32 a173, 0
    v_accvgpr_write_b32 a174, 0
    v_accvgpr_write_b32 a175, 0
    v_accvgpr_write_b32 a176, 0
    v_accvgpr_write_b32 a177, 0
    v_accvgpr_write_b32 a178, 0
    v_accvgpr_write_b32 a179, 0
    v_accvgpr_write_b32 a180, 0
    v_accvgpr_write_b32 a181, 0
    v_accvgpr_write_b32 a182, 0
    v_accvgpr_write_b32 a183, 0
    v_accvgpr_write_b32 a184, 0
    v_accvgpr_write_b32 a185, 0
    v_accvgpr_write_b32 a186, 0
    v_accvgpr_write_b32 a187, 0
    v_accvgpr_write_b32 a188, 0
    v_accvgpr_write_b32 a189, 0
    v_accvgpr_write_b32 a190, 0
    v_accvgpr_write_b32 a191, 0
    v_accvgpr_write_b32 a192, 0
    v_accvgpr_write_b32 a193, 0
    v_accvgpr_write_b32 a194, 0
    v_accvgpr_write_b32 a195, 0
    v_accvgpr_write_b32 a196, 0
    v_accvgpr_write_b32 a197, 0
    v_accvgpr_write_b32 a198, 0
    v_accvgpr_write_b32 a199, 0
    v_accvgpr_write_b32 a200, 0
    v_accvgpr_write_b32 a201, 0
    v_accvgpr_write_b32 a202, 0
    v_accvgpr_write_b32 a203, 0
    v_accvgpr_write_b32 a204, 0
    v_accvgpr_write_b32 a205, 0
    v_accvgpr_write_b32 a206, 0
    v_accvgpr_write_b32 a207, 0
    v_accvgpr_write_b32 a208, 0
    v_accvgpr_write_b32 a209, 0
    v_accvgpr_write_b32 a210, 0
    v_accvgpr_write_b32 a211, 0
    v_accvgpr_write_b32 a212, 0
    v_accvgpr_write_b32 a213, 0
    v_accvgpr_write_b32 a214, 0
    v_accvgpr_write_b32 a215, 0
    v_accvgpr_write_b32 a216, 0
    v_accvgpr_write_b32 a217, 0
    v_accvgpr_write_b32 a218, 0
    v_accvgpr_write_b32 a219, 0
    v_accvgpr_write_b32 a220, 0
    v_accvgpr_write_b32 a221, 0
    v_accvgpr_write_b32 a222, 0
    v_accvgpr_write_b32 a223, 0
    v_mov_b32 v92, 0x3f803f80
    v_accvgpr_write_b32 a136, v92
    v_accvgpr_write_b32 a137, v92
    v_accvgpr_write_b32 a138, v92
    v_accvgpr_write_b32 a139, v92
    s_mov_b32 s77, s75
    s_mov_b32 s76, 0
    s_add_u32 m0, s76, s75
    s_nop 0
    buffer_load_dwordx4 v1, s[36:39], s77 offen sc1 lds
    buffer_load_dwordx4 v1, s[36:39], s77 offen offset:1024 sc1 lds
    buffer_load_dwordx4 v1, s[36:39], s77 offen offset:2048 sc1 lds
    buffer_load_dwordx4 v1, s[36:39], s77 offen offset:3072 sc1 lds
    s_add_u32 s100, s77, 4096
    s_add_u32 m0, m0, 4096
    s_nop 0
    buffer_load_dwordx4 v1, s[36:39], s100 offen sc1 lds
    buffer_load_dwordx4 v1, s[36:39], s100 offen offset:1024 sc1 lds
    buffer_load_dwordx4 v1, s[36:39], s100 offen offset:2048 sc1 lds
    buffer_load_dwordx4 v1, s[36:39], s100 offen offset:3072 sc1 lds
    s_add_u32 s77, s77, 32768
    s_add_u32 s76, s76, 32768
    s_add_u32 m0, s76, s75
    s_nop 0
    buffer_load_dwordx4 v1, s[36:39], s77 offen sc1 lds
    buffer_load_dwordx4 v1, s[36:39], s77 offen offset:1024 sc1 lds
    buffer_load_dwordx4 v1, s[36:39], s77 offen offset:2048 sc1 lds
    buffer_load_dwordx4 v1, s[36:39], s77 offen offset:3072 sc1 lds
    s_add_u32 s100, s77, 4096
    s_add_u32 m0, m0, 4096
    s_nop 0
    buffer_load_dwordx4 v1, s[36:39], s100 offen sc1 lds
    buffer_load_dwordx4 v1, s[36:39], s100 offen offset:1024 sc1 lds
    buffer_load_dwordx4 v1, s[36:39], s100 offen offset:2048 sc1 lds
    buffer_load_dwordx4 v1, s[36:39], s100 offen offset:3072 sc1 lds
    s_add_u32 s77, s77, 32768
    s_add_u32 s76, s76, 32768
    s_branch K1_ATT
SPIN_WA:
    s_mov_b32 s94, 0
SPIN_WA_L:
    s_sleep 2
    buffer_load_dword v7, v30, s[44:47], s95 offen sc1
    s_add_u32 s94, s94, 1
    s_cmp_ge_u32 s94, 0x40000
    s_waitcnt vmcnt(0)
    s_cbranch_scc1 BACK_WA
    v_cmp_gt_u32 vcc, 8, v7
    s_nop 1
    s_and_b64 vcc, vcc, s[86:87]
    s_cbranch_scc1 SPIN_WA_L
    s_branch BACK_WA
SPIN_KV:
    s_mov_b32 s94, 0
SPIN_KV_L:
    s_sleep 2
    buffer_load_dword v7, v8, s[32:35], s61 offen sc1
    s_add_u32 s94, s94, 1
    s_cmp_ge_u32 s94, 0x40000
    s_waitcnt vmcnt(0)
    s_cbranch_scc1 BACK_KV
    v_cmp_gt_u32 vcc, 1, v7
    s_nop 1
    s_and_b64 vcc, vcc, exec
    s_cbranch_scc1 SPIN_KV_L
    s_branch BACK_KV
SPIN_ALL:
    s_mov_b32 s94, 0
SPIN_ALL_L:
    s_sleep 2
    buffer_load_dword v3, v29, s[44:47], 0 offen sc1
    s_add_u32 s94, s94, 1
    s_cmp_ge_u32 s94, 0x40000
    s_waitcnt vmcnt(0)
    s_cbranch_scc1 BACK_ALL
    v_cmp_gt_u32 vcc, 16, v3
    s_nop 1
    s_and_b64 vcc, vcc, s[92:93]
    s_cbranch_scc1 SPIN_ALL_L
    s_branch BACK_ALL
SPIN_CTX:
    s_mov_b32 s94, 0
SPIN_CTX_L:
    s_sleep 2
    buffer_load_dword v3, v19, s[32:35], s66 offen sc1
    s_add_u32 s94, s94, 1
    s_cmp_ge_u32 s94, 0x40000
    s_waitcnt vmcnt(0)
    s_cbranch_scc1 BACK_CTX
    v_cmp_gt_u32 vcc, 2, v3
    s_nop 1
    s_and_b64 vcc, vcc, exec
    s_cbranch_scc1 SPIN_CTX_L
    s_branch BACK_CTX
SPIN_OA:
    s_mov_b32 s94, 0
SPIN_OA_L:
    s_sleep 2
    buffer_load_dword v3, v19, s[32:35], s66 offen sc1
    s_add_u32 s94, s94, 1
    s_cmp_ge_u32 s94, 0x40000
    s_waitcnt vmcnt(0)
    s_cbranch_scc1 BACK_OA
    v_cmp_gt_u32 vcc, 3, v3
    s_nop 1
    s_and_b64 vcc, vcc, exec
    s_cbranch_scc1 SPIN_OA_L
    s_branch BACK_OA
SPIN_X:
    s_mov_b32 s94, 0
SPIN_X_L:
    s_sleep 2
    buffer_load_dword v3, v19, s[32:35], s66 offen sc1
    s_add_u32 s94, s94, 1
    s_cmp_ge_u32 s94, 0x40000
    s_waitcnt vmcnt(0)
    s_cbranch_scc1 BACK_X
    v_cmp_gt_u32 vcc, 1, v3
    s_nop 1
    s_and_b64 vcc, vcc, exec
    s_cbranch_scc1 SPIN_X_L
    s_branch BACK_X
.section .rodata,"a"
.p2align 6
.amdhsa_kernel gated_mix__sliding_local_dilated__compressed_kv_cla__prompt_kernel
.amdhsa_next_free_vgpr 512
.amdhsa_next_free_sgpr 102
.amdhsa_accum_offset 256
.amdhsa_group_segment_fixed_size 0
.amdhsa_kernarg_size 104
.amdhsa_user_sgpr_count 2
.amdhsa_user_sgpr_kernarg_segment_ptr 1
.amdhsa_system_sgpr_workgroup_id_x 1
.amdhsa_ieee_mode 0
.amdhsa_dx10_clamp 0
.end_amdhsa_kernel
```

```asm
; @launch grid=(256,1,1) block=(256,1,1) lds=163840
.amdgcn_target "amdgcn-amd-amdhsa--gfx950"
.text
.globl gated_mix__sliding_local_dilated__compressed_kv_cla__prompt_kernel
.p2align 8
.type gated_mix__sliding_local_dilated__compressed_kv_cla__prompt_kernel,@function
gated_mix__sliding_local_dilated__compressed_kv_cla__prompt_kernel:
    s_cmp_ge_u32 s2, 256
    s_cbranch_scc1 K1_END
    s_getpc_b64 s[94:95]
    s_load_dwordx8 s[36:43], s[0:1], 32
    v_min_u32 v74, 16, v0
    s_lshr_b32 s7, s2, 3
    s_mul_i32 s7, s7, 17
    v_add_lshl_u32 v74, v74, s7, 7
    global_load_dword v76, v74, s[94:95]
    v_lshrrev_b32 v64, 6, v0
    v_and_b32 v31, 63, v0
    v_readfirstlane_b32 s4, v64
    s_and_b32 s5, s2, 7
    s_lshl_b32 s5, s5, 2
    s_bfe_u32 s7, s2, 0x20003
    s_add_u32 s5, s5, s7
    s_lshr_b32 s6, s2, 5
    s_lshl_b32 s69, s4, 12
    s_mov_b32 s10, 2097152
    s_mov_b32 s11, 0x20000
    s_mov_b32 s14, 4194304
    s_mov_b32 s15, 0x20000
    s_mov_b32 s18, 4194304
    s_mov_b32 s19, 0x20000
    v_lshrrev_b32 v65, 3, v31
    v_and_b32 v66, 7, v31
    v_lshrrev_b32 v67, 1, v65
    v_xor_b32 v66, v66, v67
    v_lshlrev_b32 v66, 4, v66
    v_xor_b32 v67, 64, v66
    s_lshr_b32 s7, s4, 1
    s_lshl_b32 s73, s7, 7
    s_and_b32 s100, s4, 1
    s_lshl_b32 s98, s100, 5
    s_add_u32 s98, s98, s73
    v_add_lshl_u32 v68, v65, s98, 10
    v_add_u32 v6, v68, v66
    v_add_u32 v7, v68, v67
    v_add_u32 v7, 7168, v7
    v_add_u32 v8, v68, v66
    v_add_u32 v8, 14336, v8
    v_add_u32 v9, v68, v67
    v_add_u32 v9, 21504, v9
    v_lshrrev_b32 v69, 4, v31
    v_and_b32 v70, 15, v31
    v_lshlrev_b32 v71, 1, v69
    v_xor_b32 v71, v71, v70
    v_lshlrev_b32 v71, 4, v71
    v_xor_b32 v72, 128, v71
    s_lshl_b32 s98, s4, 4
    v_add_lshl_u32 v73, v69, s98, 13
    v_add_u32 v2, v73, v71
    v_add_u32 v3, v73, v71
    v_add_u32 v3, 31744, v3
    v_add_u32 v4, v73, v72
    v_add_u32 v4, 63488, v4
    v_add_u32 v5, v73, v72
    v_add_u32 v5, 95232, v5
    s_add_u32 s3, s5, s6
    s_and_b32 s3, s3, 0
    s_lshl_b32 s66, s3, 7
    s_lshl_b32 s60, s3, 11
    s_add_u32 s60, s60, s5
    s_lshl_b32 s60, s60, 8
    s_lshl_b32 s61, s6, 18
    s_add_u32 s61, s61, s66
    s_add_u32 s62, s61, 65536
    s_waitcnt lgkmcnt(0)
    s_mov_b64 s[8:9], s[36:37]
    s_mov_b64 s[24:25], s[38:39]
    s_mov_b64 s[12:13], s[40:41]
    s_mov_b64 s[16:17], s[42:43]
    s_load_dwordx2 s[20:21], s[0:1], 0
    s_load_dwordx2 s[28:29], s[0:1], 8
    s_load_dwordx2 s[32:33], s[0:1], 72
    s_load_dwordx2 s[48:49], s[0:1], 64
    s_load_dwordx2 s[92:93], s[0:1], 16
    s_load_dwordx2 s[44:45], s[0:1], 88
    s_load_dwordx2 s[56:57], s[0:1], 96
    s_add_u32 m0, s69, 0
    s_nop 0
    buffer_load_dwordx4 v6, s[8:11], s61 offen lds
    buffer_load_dwordx4 v7, s[8:11], s61 offen offset:1024 lds
    buffer_load_dwordx4 v8, s[8:11], s61 offen offset:2048 lds
    buffer_load_dwordx4 v9, s[8:11], s61 offen offset:3072 lds
    s_xor_b32 s61, s61, 128
    s_add_u32 m0, s69, 16384
    s_nop 0
    buffer_load_dwordx4 v6, s[8:11], s62 offen lds
    buffer_load_dwordx4 v7, s[8:11], s62 offen offset:1024 lds
    buffer_load_dwordx4 v8, s[8:11], s62 offen offset:2048 lds
    buffer_load_dwordx4 v9, s[8:11], s62 offen offset:3072 lds
    s_xor_b32 s62, s62, 128
    s_add_u32 m0, s69, 32768
    s_nop 0
    buffer_load_dwordx4 v2, s[12:15], s60 offen nt lds
    buffer_load_dwordx4 v3, s[12:15], s60 offen offset:1024 nt lds
    buffer_load_dwordx4 v4, s[12:15], s60 offen offset:2048 nt lds
    buffer_load_dwordx4 v5, s[12:15], s60 offen offset:3072 nt lds
    s_add_u32 m0, s69, 49152
    s_nop 0
    buffer_load_dwordx4 v6, s[8:11], s61 offen lds
    buffer_load_dwordx4 v7, s[8:11], s61 offen offset:1024 lds
    buffer_load_dwordx4 v8, s[8:11], s61 offen offset:2048 lds
    buffer_load_dwordx4 v9, s[8:11], s61 offen offset:3072 lds
    s_xor_b32 s61, s61, 384
    s_waitcnt lgkmcnt(0)
    s_mov_b32 s22, 2359296
    s_mov_b32 s23, 0x20000
    s_mov_b32 s26, 4718592
    s_mov_b32 s27, 0x20000
    s_mov_b32 s50, 4718592
    s_mov_b32 s51, 0x20000
    s_mov_b32 s46, 256
    s_mov_b32 s47, 0x20000
    s_mov_b32 s30, 1990656
    s_mov_b32 s31, 0x20000
    s_mov_b32 s34, 1152
    s_mov_b32 s35, 0x20000
    s_mul_i32 s7, s5, 1081344
    s_add_u32 s36, s56, s7
    s_addc_u32 s37, s57, 0
    s_mov_b32 s38, 1081344
    s_mov_b32 s39, 0x20000
    s_add_u32 s40, s56, 35651584
    s_addc_u32 s41, s57, 0
    s_mov_b32 s42, 19922944
    s_mov_b32 s43, 0x20000
    s_cmp_eq_u32 s4, 0
    s_cselect_b32 s86, 0x55555555, 0
    s_cselect_b32 s87, 0x55555555, 0
    s_cselect_b32 s52, s48, s92
    s_cselect_b32 s53, s49, s93
    s_cselect_b32 s54, s50, 663552
    s_mov_b32 s55, 0x20000
    s_mul_i32 s63, s6, 147456
    s_sub_u32 s64, 2211840, s63
    s_add_u32 s63, s63, s66
    s_add_u32 s64, s64, s66
    s_lshl_b32 s67, s4, 11
    s_lshl_b32 s68, s4, 10
    s_lshl_b32 s75, s4, 13
    s_lshl_b32 s65, s3, 13
    s_add_u32 s65, s65, s67
    s_lshl_b32 s70, s6, 2
    s_lshl1_add_u32 s70, s100, s70
    s_lshl_b32 s70, s70, 15
    s_lshl_b32 s98, s73, 6
    s_add_u32 s71, s70, s98
    s_add_u32 s71, s71, 49152
    s_lshl_b32 s98, s73, 4
    s_add_u32 s70, s70, s98
    v_lshlrev_b32 v1, 4, v31
    v_mov_b32 v77, 1073741824
    v_cmp_eq_u32 vcc, 0, v0
    s_nop 1
    v_cndmask_b32_e64 v30, v77, 0, vcc
    v_lshlrev_b32 v103, 7, v31
    v_cmp_gt_u32 vcc, 9, v31
    s_nop 1
    v_cndmask_b32 v103, v77, v103, vcc
    s_lshl_b32 s98, s4, 5
    v_add_u32 v68, s98, v65
    v_mul_u32_u24 v68, 1152, v68
    v_add_u32 v10, v68, v66
    v_add_u32 v11, v68, v67
    v_add_u32 v11, 8192, v11
    v_add_u32 v12, v68, v66
    v_add_u32 v12, 16384, v12
    v_add_u32 v13, v68, v67
    v_add_u32 v13, 24576, v13
    s_sub_u32 s98, 15, s6
    s_cmp_eq_u32 s73, 0
    s_cselect_b32 s98, s6, s98
    s_lshl_b32 s98, s98, 7
    s_sub_u32 s98, s98, 16
    s_max_i32 s98, s98, 0
    s_lshl3_add_u32 s98, s100, s98
    v_add_u32 v68, s98, v65
    v_mul_u32_u24 v68, 1152, v68
    s_lshl_b32 s98, s100, 6
    s_add_u32 m0, s69, 65536
    s_nop 0
    buffer_load_dwordx4 v2, s[16:19], s60 offen nt lds
    v_xor_b32 v73, s98, v66
    v_add_u32 v96, v68, v73
    v_lshrrev_b32 v71, 1, v70
    v_xor_b32 v71, v71, v69
    v_lshlrev_b32 v71, 4, v71
    v_lshl_add_u32 v71, v70, 7, v71
    v_xor_b32 v72, 64, v71
    s_lshl_b32 s98, s100, 13
    v_add_u32 v22, s98, v71
    v_add_u32 v23, s98, v72
    v_add_u32 v24, s67, v71
    v_add_u32 v25, s67, v72
    s_lshl_b32 s98, s100, 11
    s_add_u32 s98, s98, 8192
    v_add_u32 v100, s98, v71
    v_add_u32 v101, s98, v72
    v_bfe_u32 v73, v31, 2, 2
    v_and_b32 v74, 3, v31
    buffer_load_dwordx4 v3, s[16:19], s60 offen offset:1024 nt lds
    v_lshl_add_u32 v75, v69, 3, v73
    v_and_b32 v78, 1, v69
    v_lshl_add_u32 v77, v78, 2, v73
    v_lshlrev_b32 v77, 5, v77
    v_lshl_add_u32 v77, v74, 3, v77
    v_lshl_add_u32 v77, v75, 8, v77
    v_xor_b32 v14, 0, v77
    v_xor_b32 v14, s73, v14
    v_xor_b32 v15, 32, v77
    v_xor_b32 v15, s73, v15
    v_xor_b32 v16, 64, v77
    v_xor_b32 v16, s73, v16
    v_xor_b32 v17, 96, v77
    v_xor_b32 v17, s73, v17
    v_xor_b32 v18, 128, v77
    v_xor_b32 v19, 160, v77
    v_xor_b32 v20, 192, v77
    v_xor_b32 v21, 224, v77
    v_lshrrev_b32 v77, 1, v73
    buffer_load_dwordx4 v4, s[16:19], s60 offen offset:2048 nt lds
    v_lshl_add_u32 v77, v78, 1, v77
    v_lshlrev_b32 v77, 5, v77
    v_lshl_add_u32 v77, v74, 3, v77
    v_lshl_add_u32 v77, v75, 7, v77
    s_lshr_b32 s98, s73, 1
    v_xor_b32 v26, 0, v77
    v_xor_b32 v26, s98, v26
    v_xor_b32 v27, 32, v77
    v_xor_b32 v28, 64, v77
    v_xor_b32 v28, s98, v28
    v_xor_b32 v29, 96, v77
    v_and_b32 v73, 7, v0
    v_lshrrev_b32 v74, 3, v0
    v_lshl_add_u32 v75, v73, 1, 0
    v_mul_u32_u24 v78, 52, v75
    v_lshrrev_b32 v78, 8, v78
    v_mul_u32_u24 v79, 5, v78
    v_sub_u32 v75, v75, v79
    buffer_load_dwordx4 v5, s[16:19], s60 offen offset:3072 nt lds
    s_xor_b32 s60, s60, 524288
    v_add_u32 v78, 1, v78
    v_cmp_le_u32 vcc, 3, v78
    s_nop 1
    v_cndmask_b32_e64 v78, v78, 0, vcc
    v_mul_u32_u24 v78, 1152, v78
    v_lshl_add_u32 v75, v75, 3, v78
    v_mad_u32_u24 v75, v74, 36, v75
    v_lshl_add_u32 v77, v73, 1, 1
    v_mul_u32_u24 v78, 52, v77
    v_lshrrev_b32 v78, 8, v78
    v_mul_u32_u24 v79, 5, v78
    v_sub_u32 v77, v77, v79
    v_add_u32 v78, 1, v78
    v_cmp_le_u32 vcc, 3, v78
    s_nop 1
    v_cndmask_b32_e64 v78, v78, 0, vcc
    v_mul_u32_u24 v78, 1152, v78
    v_lshl_add_u32 v77, v77, 3, v78
    v_mad_u32_u24 v77, v74, 36, v77
    s_mul_i32 s98, s2, 10368
    s_mul_i32 s99, s2, 6
    s_mov_b32 s7, 73728
    v_mul_lo_u32 v95, v74, s7
    v_lshl_add_u32 v95, v73, 4, v95
    v_cmp_eq_u32 s[92:93], 7, v73
    s_add_u32 s56, s56, 56623104
    s_addc_u32 s57, s57, 0
    s_mov_b32 s58, 5603328
    s_mov_b32 s59, 0x20000
    s_lshl_b32 s101, s6, 5
    s_add_u32 s101, s101, s5
    s_lshl_b32 s101, s101, 7
    v_mov_b32 v65, 0
    v_lshlrev_b32 v64, 15, v0
    s_mov_b32 s74, 0x3e0293ee
    s_mov_b64 s[84:85], 0
    s_mov_b32 s83, 0
    s_lshl_b32 s95, s5, 3
    s_waitcnt vmcnt(4)
    s_barrier
    ds_read_b128 a[0:3], v22 offset:0
    ds_read_b64_tr_b16 v[40:41], v14 offset:32768
    ds_read_b64_tr_b16 v[42:43], v14 offset:33792
    ds_read_b128 a[4:7], v23 offset:0
    ds_read_b64_tr_b16 v[44:45], v14 offset:40960
    ds_read_b64_tr_b16 v[46:47], v14 offset:41984
    ds_read_b128 a[8:11], v22 offset:2048
    ds_read_b128 a[12:15], v23 offset:2048
    ds_read_b128 a[16:19], v22 offset:4096
    ds_read_b128 a[20:23], v23 offset:4096
    ds_read_b128 a[24:27], v22 offset:6144
    ds_read_b128 a[28:31], v23 offset:6144
    ds_read_b128 a[32:35], v22 offset:16384
    ds_read_b128 a[36:39], v23 offset:16384
    ds_read_b128 a[40:43], v22 offset:18432
    s_waitcnt lgkmcnt(14)
    ds_read_b128 a[44:47], v23 offset:18432
    s_waitcnt lgkmcnt(14)
    ds_read_b128 a[48:51], v22 offset:20480
    s_waitcnt lgkmcnt(14)
    ds_read_b128 a[52:55], v23 offset:20480
    s_waitcnt lgkmcnt(14)
    ds_read_b128 a[56:59], v22 offset:22528
    s_waitcnt lgkmcnt(14)
    ds_read_b128 a[60:63], v23 offset:22528
    v_mfma_f32_16x16x32_bf16 v[128:131], v[40:43], a[0:3], 0
    s_add_u32 m0, s69, 81920
    s_waitcnt lgkmcnt(14)
    ds_read_b64_tr_b16 v[48:49], v15 offset:32768
    s_waitcnt lgkmcnt(14)
    ds_read_b64_tr_b16 v[50:51], v15 offset:33792
    v_mfma_f32_16x16x32_bf16 v[128:131], v[44:47], a[4:7], v[128:131]
    s_mul_i32 s77, s2, 9216
    buffer_load_dwordx4 v6, s[8:11], s62 offen lds
    v_mfma_f32_16x16x32_bf16 v[132:135], v[40:43], a[8:11], 0
    s_mul_i32 s76, s4, 1152
    s_waitcnt lgkmcnt(14)
    ds_read_b128 a[64:67], v22 offset:49152
    s_waitcnt lgkmcnt(14)
    ds_read_b64_tr_b16 v[52:53], v15 offset:40960
    v_mfma_f32_16x16x32_bf16 v[132:135], v[44:47], a[12:15], v[132:135]
    s_add_u32 s77, s77, s76
    s_waitcnt lgkmcnt(14)
    ds_read_b64_tr_b16 v[54:55], v15 offset:41984
    s_waitcnt lgkmcnt(14)
    ds_read_b64_tr_b16 v[56:57], v16 offset:32768
    v_mfma_f32_16x16x32_bf16 v[136:139], v[40:43], a[16:19], 0
    s_mul_i32 s76, s4, 1152
    buffer_load_dwordx4 v7, s[8:11], s62 offen offset:1024 lds
    v_mfma_f32_16x16x32_bf16 v[136:139], v[44:47], a[20:23], v[136:139]
    s_mul_i32 s72, s2, 3
    s_waitcnt lgkmcnt(4)
    ds_read_b64_tr_b16 v[58:59], v16 offset:33792
    ds_read_b64_tr_b16 v[60:61], v16 offset:40960
    v_mfma_f32_16x16x32_bf16 v[140:143], v[40:43], a[24:27], 0
    s_add_u32 s72, s72, 0
    ds_read_b64_tr_b16 v[62:63], v16 offset:41984
    v_add_u32 v14, 0x10000, v14
    v_mfma_f32_16x16x32_bf16 v[140:143], v[44:47], a[28:31], v[140:143]
    s_mul_i32 s7, s5, 73728
    ds_read_b128 a[68:71], v23 offset:49152
    v_add_u32 v15, 0x10000, v15
    v_mfma_f32_16x16x32_bf16 v[144:147], v[40:43], a[32:35], 0
    s_and_b32 s100, s6, 1
    buffer_load_dwordx4 v8, s[8:11], s62 offen offset:2048 lds
    v_mfma_f32_16x16x32_bf16 v[144:147], v[44:47], a[36:39], v[144:147]
    v_add_u32 v16, 0x10000, v16
    v_mov_b32 v31, 1
    v_mfma_f32_16x16x32_bf16 v[148:151], v[40:43], a[40:43], 0
    v_add_u32 v18, 0x10000, v18
    v_add_u32 v19, 0x10000, v19
    v_mfma_f32_16x16x32_bf16 v[148:151], v[44:47], a[44:47], v[148:151]
    v_add_u32 v20, 0x10000, v20
    v_add_u32 v21, 0x10000, v21
    v_mfma_f32_16x16x32_bf16 v[152:155], v[40:43], a[48:51], 0
    buffer_load_dwordx4 v9, s[8:11], s62 offen offset:3072 lds
    v_mfma_f32_16x16x32_bf16 v[152:155], v[44:47], a[52:55], v[152:155]
    ds_read_b128 a[72:75], v22 offset:51200
    v_add_u32 v26, 0x10000, v26
    v_mfma_f32_16x16x32_bf16 v[156:159], v[40:43], a[56:59], 0
    s_add_u32 m0, s69, 98304
    ds_read_b64_tr_b16 v[40:41], v17 offset:32768
    ds_read_b64_tr_b16 v[42:43], v17 offset:33792
    v_mfma_f32_16x16x32_bf16 v[156:159], v[44:47], a[60:63], v[156:159]
    s_xor_b32 s62, s62, 384
    ds_read_b64_tr_b16 v[44:45], v17 offset:40960
    ds_read_b64_tr_b16 v[46:47], v17 offset:41984
    v_mfma_f32_16x16x32_bf16 v[160:163], v[48:51], a[0:3], 0
    s_waitcnt lgkmcnt(5)
    buffer_load_dwordx4 v2, s[12:15], s60 offen nt lds
    v_mfma_f32_16x16x32_bf16 v[160:163], v[52:55], a[4:7], v[160:163]
    v_add_u32 v17, 0x10000, v17
    v_add_u32 v27, 0x10000, v27
    v_mfma_f32_16x16x32_bf16 v[164:167], v[48:51], a[8:11], 0
    ds_read_b128 a[76:79], v23 offset:51200
    v_add_u32 v28, 0x10000, v28
    v_mfma_f32_16x16x32_bf16 v[164:167], v[52:55], a[12:15], v[164:167]
    v_add_u32 v29, 0x10000, v29
    v_mfma_f32_16x16x32_bf16 v[168:171], v[48:51], a[16:19], 0
    buffer_load_dwordx4 v3, s[12:15], s60 offen offset:1024 nt lds
    v_mfma_f32_16x16x32_bf16 v[168:171], v[52:55], a[20:23], v[168:171]
    v_mfma_f32_16x16x32_bf16 v[172:175], v[48:51], a[24:27], 0
    v_mfma_f32_16x16x32_bf16 v[172:175], v[52:55], a[28:31], v[172:175]
    v_mfma_f32_16x16x32_bf16 v[176:179], v[48:51], a[32:35], 0
    buffer_load_dwordx4 v4, s[12:15], s60 offen offset:2048 nt lds
    v_mfma_f32_16x16x32_bf16 v[176:179], v[52:55], a[36:39], v[176:179]
    ds_read_b128 a[80:83], v22 offset:53248
    v_mfma_f32_16x16x32_bf16 v[180:183], v[48:51], a[40:43], 0
    v_mfma_f32_16x16x32_bf16 v[180:183], v[52:55], a[44:47], v[180:183]
    v_mfma_f32_16x16x32_bf16 v[184:187], v[48:51], a[48:51], 0
    buffer_load_dwordx4 v5, s[12:15], s60 offen offset:3072 nt lds
    v_mfma_f32_16x16x32_bf16 v[184:187], v[52:55], a[52:55], v[184:187]
    ds_read_b128 a[84:87], v23 offset:53248
    v_mfma_f32_16x16x32_bf16 v[188:191], v[48:51], a[56:59], 0
    s_add_u32 m0, s69, 114688
    v_mfma_f32_16x16x32_bf16 v[188:191], v[52:55], a[60:63], v[188:191]
    v_mfma_f32_16x16x32_bf16 v[192:195], v[56:59], a[0:3], 0
    buffer_load_dwordx4 v6, s[8:11], s61 offen lds
    v_mfma_f32_16x16x32_bf16 v[192:195], v[60:63], a[4:7], v[192:195]
    v_mfma_f32_16x16x32_bf16 v[196:199], v[56:59], a[8:11], 0
    v_mfma_f32_16x16x32_bf16 v[196:199], v[60:63], a[12:15], v[196:199]
    ds_read_b128 a[88:91], v22 offset:55296
    v_mfma_f32_16x16x32_bf16 v[200:203], v[56:59], a[16:19], 0
    buffer_load_dwordx4 v7, s[8:11], s61 offen offset:1024 lds
    v_mfma_f32_16x16x32_bf16 v[200:203], v[60:63], a[20:23], v[200:203]
    v_mfma_f32_16x16x32_bf16 v[204:207], v[56:59], a[24:27], 0
    v_mfma_f32_16x16x32_bf16 v[204:207], v[60:63], a[28:31], v[204:207]
    v_mfma_f32_16x16x32_bf16 v[208:211], v[56:59], a[32:35], 0
    buffer_load_dwordx4 v8, s[8:11], s61 offen offset:2048 lds
    v_mfma_f32_16x16x32_bf16 v[208:211], v[60:63], a[36:39], v[208:211]
    ds_read_b128 a[92:95], v23 offset:55296
    v_mfma_f32_16x16x32_bf16 v[212:215], v[56:59], a[40:43], 0
    v_mfma_f32_16x16x32_bf16 v[212:215], v[60:63], a[44:47], v[212:215]
    v_mfma_f32_16x16x32_bf16 v[216:219], v[56:59], a[48:51], 0
    buffer_load_dwordx4 v9, s[8:11], s61 offen offset:3072 lds
    v_mfma_f32_16x16x32_bf16 v[216:219], v[60:63], a[52:55], v[216:219]
    v_mfma_f32_16x16x32_bf16 v[220:223], v[56:59], a[56:59], 0
    s_xor_b32 s61, s61, 128
    v_mfma_f32_16x16x32_bf16 v[220:223], v[60:63], a[60:63], v[220:223]
    s_add_u32 m0, s69, 131072
    s_waitcnt lgkmcnt(0)
    v_mfma_f32_16x16x32_bf16 v[224:227], v[40:43], a[0:3], 0
    buffer_load_dwordx4 v2, s[16:19], s60 offen nt lds
    v_mfma_f32_16x16x32_bf16 v[224:227], v[44:47], a[4:7], v[224:227]
    v_mfma_f32_16x16x32_bf16 v[228:231], v[40:43], a[8:11], 0
    buffer_load_dword v104, v103, s[20:23], s77 offen
    v_mfma_f32_16x16x32_bf16 v[228:231], v[44:47], a[12:15], v[228:231]
    s_add_u32 s77, s77, 4608
    v_mfma_f32_16x16x32_bf16 v[232:235], v[40:43], a[16:19], 0
    v_mfma_f32_16x16x32_bf16 v[232:235], v[44:47], a[20:23], v[232:235]
    s_waitcnt vmcnt(10)
    s_barrier
    ds_read_b64_tr_b16 v[48:49], v14 offset:0
    v_mfma_f32_16x16x32_bf16 v[236:239], v[40:43], a[24:27], 0
    buffer_load_dwordx4 v3, s[16:19], s60 offen offset:1024 nt lds
    v_mfma_f32_16x16x32_bf16 v[236:239], v[44:47], a[28:31], v[236:239]
    ds_read_b64_tr_b16 v[50:51], v14 offset:1024
    ds_read_b64_tr_b16 v[52:53], v14 offset:8192
    v_mfma_f32_16x16x32_bf16 v[240:243], v[40:43], a[32:35], 0
    ds_read_b64_tr_b16 v[54:55], v14 offset:9216
    ds_read_b64_tr_b16 v[56:57], v15 offset:0
    v_mfma_f32_16x16x32_bf16 v[240:243], v[44:47], a[36:39], v[240:243]
    buffer_load_dwordx4 v4, s[16:19], s60 offen offset:2048 nt lds
    v_mfma_f32_16x16x32_bf16 v[244:247], v[40:43], a[40:43], 0
    ds_read_b64_tr_b16 v[58:59], v15 offset:1024
    ds_read_b64_tr_b16 v[60:61], v15 offset:8192
    v_mfma_f32_16x16x32_bf16 v[244:247], v[44:47], a[44:47], v[244:247]
    ds_read_b64_tr_b16 v[62:63], v15 offset:9216
    v_mfma_f32_16x16x32_bf16 v[248:251], v[40:43], a[48:51], 0
    v_mfma_f32_16x16x32_bf16 v[248:251], v[44:47], a[52:55], v[248:251]
    buffer_load_dwordx4 v5, s[16:19], s60 offen offset:3072 nt lds
    v_mfma_f32_16x16x32_bf16 v[252:255], v[40:43], a[56:59], 0
    ds_read_b64_tr_b16 v[40:41], v16 offset:0
    ds_read_b64_tr_b16 v[42:43], v16 offset:1024
    v_mfma_f32_16x16x32_bf16 v[252:255], v[44:47], a[60:63], v[252:255]
    s_waitcnt lgkmcnt(3)
    ds_read_b64_tr_b16 v[44:45], v16 offset:8192
    ds_read_b64_tr_b16 v[46:47], v16 offset:9216
    v_mfma_f32_16x16x32_bf16 a[128:131], a[0:3], v[48:51], 0
    v_mfma_f32_16x16x32_bf16 a[128:131], a[4:7], v[52:55], a[128:131]
    s_add_u32 m0, s69, 147456
    v_add_u32 v22, 0x10000, v22
    v_mfma_f32_16x16x32_bf16 a[132:135], a[8:11], v[48:51], 0
    s_xor_b32 s60, s60, 1572864
    buffer_load_dwordx4 v6, s[8:11], s62 offen lds
    v_mfma_f32_16x16x32_bf16 a[132:135], a[12:15], v[52:55], a[132:135]
    ds_read_b128 a[96:99], v22 offset:16384
    v_mfma_f32_16x16x32_bf16 a[136:139], a[16:19], v[48:51], 0
    v_mfma_f32_16x16x32_bf16 a[136:139], a[20:23], v[52:55], a[136:139]
    v_mfma_f32_16x16x32_bf16 a[140:143], a[24:27], v[48:51], 0
    buffer_load_dwordx4 v7, s[8:11], s62 offen offset:1024 lds
    v_mfma_f32_16x16x32_bf16 a[140:143], a[28:31], v[52:55], a[140:143]
    v_add_u32 v23, 0x10000, v23
    ds_read_b128 a[100:103], v23 offset:16384
    v_mfma_f32_16x16x32_bf16 a[144:147], a[32:35], v[48:51], 0
    v_mfma_f32_16x16x32_bf16 a[144:147], a[36:39], v[52:55], a[144:147]
    v_mfma_f32_16x16x32_bf16 a[148:151], a[40:43], v[48:51], 0
    v_mfma_f32_16x16x32_bf16 a[148:151], a[44:47], v[52:55], a[148:151]
    buffer_load_dwordx4 v8, s[8:11], s62 offen offset:2048 lds
    v_mfma_f32_16x16x32_bf16 a[152:155], a[48:51], v[48:51], 0
    v_mfma_f32_16x16x32_bf16 a[152:155], a[52:55], v[52:55], a[152:155]
    ds_read_b128 a[104:107], v22 offset:18432
    v_mfma_f32_16x16x32_bf16 a[156:159], a[56:59], v[48:51], 0
    ds_read_b64_tr_b16 v[48:49], v17 offset:0
    ds_read_b64_tr_b16 v[50:51], v17 offset:1024
    v_mfma_f32_16x16x32_bf16 a[156:159], a[60:63], v[52:55], a[156:159]
    buffer_load_dwordx4 v9, s[8:11], s62 offen offset:3072 lds
    v_mfma_f32_16x16x32_bf16 a[160:163], a[0:3], v[56:59], 0
    s_waitcnt lgkmcnt(3)
    ds_read_b64_tr_b16 v[52:53], v17 offset:8192
    ds_read_b64_tr_b16 v[54:55], v17 offset:9216
    v_mfma_f32_16x16x32_bf16 a[160:163], a[4:7], v[60:63], a[160:163]
    v_mfma_f32_16x16x32_bf16 a[164:167], a[8:11], v[56:59], 0
    ds_read_b128 a[108:111], v23 offset:18432
    v_mfma_f32_16x16x32_bf16 a[164:167], a[12:15], v[60:63], a[164:167]
    s_add_u32 m0, s69, 0
    v_mfma_f32_16x16x32_bf16 a[168:171], a[16:19], v[56:59], 0
    s_xor_b32 s62, s62, 128
    buffer_load_dwordx4 v2, s[12:15], s60 offen nt lds
    v_mfma_f32_16x16x32_bf16 a[168:171], a[20:23], v[60:63], a[168:171]
    v_mfma_f32_16x16x32_bf16 a[172:175], a[24:27], v[56:59], 0
    v_mfma_f32_16x16x32_bf16 a[172:175], a[28:31], v[60:63], a[172:175]
    v_mfma_f32_16x16x32_bf16 a[176:179], a[32:35], v[56:59], 0
    buffer_load_dwordx4 v3, s[12:15], s60 offen offset:1024 nt lds
    v_mfma_f32_16x16x32_bf16 a[176:179], a[36:39], v[60:63], a[176:179]
    ds_read_b128 a[112:115], v22 offset:20480
    v_mfma_f32_16x16x32_bf16 a[180:183], a[40:43], v[56:59], 0
    v_mfma_f32_16x16x32_bf16 a[180:183], a[44:47], v[60:63], a[180:183]
    v_mfma_f32_16x16x32_bf16 a[184:187], a[48:51], v[56:59], 0
    v_mfma_f32_16x16x32_bf16 a[184:187], a[52:55], v[60:63], a[184:187]
    buffer_load_dwordx4 v4, s[12:15], s60 offen offset:2048 nt lds
    v_mfma_f32_16x16x32_bf16 a[188:191], a[56:59], v[56:59], 0
    ds_read_b128 a[116:119], v23 offset:20480
    v_mfma_f32_16x16x32_bf16 a[188:191], a[60:63], v[60:63], a[188:191]
    v_mfma_f32_16x16x32_bf16 a[192:195], a[0:3], v[40:43], 0
    v_mfma_f32_16x16x32_bf16 a[192:195], a[4:7], v[44:47], a[192:195]
    buffer_load_dwordx4 v5, s[12:15], s60 offen offset:3072 nt lds
    v_mfma_f32_16x16x32_bf16 a[196:199], a[8:11], v[40:43], 0
    v_mfma_f32_16x16x32_bf16 a[196:199], a[12:15], v[44:47], a[196:199]
    ds_read_b128 a[120:123], v22 offset:22528
    v_mfma_f32_16x16x32_bf16 a[200:203], a[16:19], v[40:43], 0
    v_mfma_f32_16x16x32_bf16 a[200:203], a[20:23], v[44:47], a[200:203]
    s_add_u32 m0, s69, 16384
    v_mfma_f32_16x16x32_bf16 a[204:207], a[24:27], v[40:43], 0
    buffer_load_dwordx4 v6, s[8:11], s61 offen lds
    v_mfma_f32_16x16x32_bf16 a[204:207], a[28:31], v[44:47], a[204:207]
    v_mfma_f32_16x16x32_bf16 a[208:211], a[32:35], v[40:43], 0
    ds_read_b128 a[124:127], v23 offset:22528
    v_mfma_f32_16x16x32_bf16 a[208:211], a[36:39], v[44:47], a[208:211]
    v_mfma_f32_16x16x32_bf16 a[212:215], a[40:43], v[40:43], 0
    buffer_load_dwordx4 v7, s[8:11], s61 offen offset:1024 lds
    v_mfma_f32_16x16x32_bf16 a[212:215], a[44:47], v[44:47], a[212:215]
    v_mfma_f32_16x16x32_bf16 a[216:219], a[48:51], v[40:43], 0
    v_mfma_f32_16x16x32_bf16 a[216:219], a[52:55], v[44:47], a[216:219]
    v_mfma_f32_16x16x32_bf16 a[220:223], a[56:59], v[40:43], 0
    v_mfma_f32_16x16x32_bf16 a[220:223], a[60:63], v[44:47], a[220:223]
    s_waitcnt lgkmcnt(0)
    buffer_load_dwordx4 v8, s[8:11], s61 offen offset:2048 lds
    v_mfma_f32_16x16x32_bf16 a[224:227], a[0:3], v[48:51], 0
    v_mfma_f32_16x16x32_bf16 a[224:227], a[4:7], v[52:55], a[224:227]
    v_mfma_f32_16x16x32_bf16 a[228:231], a[8:11], v[48:51], 0
    v_mfma_f32_16x16x32_bf16 a[228:231], a[12:15], v[52:55], a[228:231]
    buffer_load_dwordx4 v9, s[8:11], s61 offen offset:3072 lds
    v_mfma_f32_16x16x32_bf16 a[232:235], a[16:19], v[48:51], 0
    v_mfma_f32_16x16x32_bf16 a[232:235], a[20:23], v[52:55], a[232:235]
    s_waitcnt vmcnt(8) lgkmcnt(0)
    s_barrier
    ds_read_b64_tr_b16 v[56:57], v14 offset:32768
    v_mfma_f32_16x16x32_bf16 a[236:239], a[24:27], v[48:51], 0
    s_add_u32 m0, s69, 32768
    ds_read_b64_tr_b16 v[58:59], v14 offset:33792
    ds_read_b64_tr_b16 v[60:61], v14 offset:40960
    v_mfma_f32_16x16x32_bf16 a[236:239], a[28:31], v[52:55], a[236:239]
    s_xor_b32 s61, s61, 896
    buffer_load_dwordx4 v2, s[16:19], s60 offen nt lds
    v_mfma_f32_16x16x32_bf16 a[240:243], a[32:35], v[48:51], 0
    ds_read_b64_tr_b16 v[62:63], v14 offset:41984
    ds_read_b64_tr_b16 v[40:41], v15 offset:32768
    v_mfma_f32_16x16x32_bf16 a[240:243], a[36:39], v[52:55], a[240:243]
    ds_read_b64_tr_b16 v[42:43], v15 offset:33792
    ds_read_b64_tr_b16 v[44:45], v15 offset:40960
    v_mfma_f32_16x16x32_bf16 a[244:247], a[40:43], v[48:51], 0
    ds_read_b64_tr_b16 v[46:47], v15 offset:41984
    v_add_u32 v14, 0x10000, v14
    v_mfma_f32_16x16x32_bf16 a[244:247], a[44:47], v[52:55], a[244:247]
    v_add_u32 v15, 0x10000, v15
    v_mfma_f32_16x16x32_bf16 a[248:251], a[48:51], v[48:51], 0
    v_mfma_f32_16x16x32_bf16 a[248:251], a[52:55], v[52:55], a[248:251]
    buffer_load_dwordx4 v3, s[16:19], s60 offen offset:1024 nt lds
    v_mfma_f32_16x16x32_bf16 a[252:255], a[56:59], v[48:51], 0
    ds_read_b64_tr_b16 v[48:49], v16 offset:32768
    ds_read_b64_tr_b16 v[50:51], v16 offset:33792
    v_mfma_f32_16x16x32_bf16 a[252:255], a[60:63], v[52:55], a[252:255]
    s_waitcnt lgkmcnt(2)
    ds_read_b64_tr_b16 v[52:53], v16 offset:40960
    ds_read_b64_tr_b16 v[54:55], v16 offset:41984
    v_mfma_f32_16x16x32_bf16 v[128:131], v[56:59], a[64:67], v[128:131]
    v_add_u32 v16, 0x10000, v16
    v_mfma_f32_16x16x32_bf16 v[128:131], v[60:63], a[68:71], v[128:131]
    v_mfma_f32_16x16x32_bf16 v[132:135], v[56:59], a[72:75], v[132:135]
    ds_read_b128 a[0:3], v22 offset:49152
    v_mfma_f32_16x16x32_bf16 v[132:135], v[60:63], a[76:79], v[132:135]
    v_mfma_f32_16x16x32_bf16 v[136:139], v[56:59], a[80:83], v[136:139]
    v_mfma_f32_16x16x32_bf16 v[136:139], v[60:63], a[84:87], v[136:139]
    buffer_load_dwordx4 v4, s[16:19], s60 offen offset:2048 nt lds
    v_mfma_f32_16x16x32_bf16 v[140:143], v[56:59], a[88:91], v[140:143]
    v_mfma_f32_16x16x32_bf16 v[140:143], v[60:63], a[92:95], v[140:143]
    ds_read_b128 a[4:7], v23 offset:49152
    v_mfma_f32_16x16x32_bf16 v[144:147], v[56:59], a[96:99], v[144:147]
    v_mfma_f32_16x16x32_bf16 v[144:147], v[60:63], a[100:103], v[144:147]
    v_mfma_f32_16x16x32_bf16 v[148:151], v[56:59], a[104:107], v[148:151]
    v_mfma_f32_16x16x32_bf16 v[148:151], v[60:63], a[108:111], v[148:151]
    v_mfma_f32_16x16x32_bf16 v[152:155], v[56:59], a[112:115], v[152:155]
    buffer_load_dwordx4 v5, s[16:19], s60 offen offset:3072 nt lds
    v_mfma_f32_16x16x32_bf16 v[152:155], v[60:63], a[116:119], v[152:155]
    ds_read_b128 a[8:11], v22 offset:51200
    v_mfma_f32_16x16x32_bf16 v[156:159], v[56:59], a[120:123], v[156:159]
    ds_read_b64_tr_b16 v[56:57], v17 offset:32768
    ds_read_b64_tr_b16 v[58:59], v17 offset:33792
    v_mfma_f32_16x16x32_bf16 v[156:159], v[60:63], a[124:127], v[156:159]
    ds_read_b64_tr_b16 v[60:61], v17 offset:40960
    ds_read_b64_tr_b16 v[62:63], v17 offset:41984
    v_mfma_f32_16x16x32_bf16 v[160:163], v[40:43], a[64:67], v[160:163]
    v_add_u32 v17, 0x10000, v17
    v_mfma_f32_16x16x32_bf16 v[160:163], v[44:47], a[68:71], v[160:163]
    v_mfma_f32_16x16x32_bf16 v[164:167], v[40:43], a[72:75], v[164:167]
    ds_read_b128 a[12:15], v23 offset:51200
    v_mfma_f32_16x16x32_bf16 v[164:167], v[44:47], a[76:79], v[164:167]
    s_add_u32 m0, s69, 49152
    v_mfma_f32_16x16x32_bf16 v[168:171], v[40:43], a[80:83], v[168:171]
    s_xor_b32 s60, s60, 524288
    buffer_load_dwordx4 v6, s[8:11], s62 offen lds
    v_mfma_f32_16x16x32_bf16 v[168:171], v[44:47], a[84:87], v[168:171]
    v_mfma_f32_16x16x32_bf16 v[172:175], v[40:43], a[88:91], v[172:175]
    buffer_load_dwordx2 v[80:81], v75, s[28:31], s98 offen nt
    v_mfma_f32_16x16x32_bf16 v[172:175], v[44:47], a[92:95], v[172:175]
    v_mfma_f32_16x16x32_bf16 v[176:179], v[40:43], a[96:99], v[176:179]
    ds_read_b128 a[16:19], v22 offset:53248
    v_mfma_f32_16x16x32_bf16 v[176:179], v[44:47], a[100:103], v[176:179]
    v_mfma_f32_16x16x32_bf16 v[180:183], v[40:43], a[104:107], v[180:183]
    v_mfma_f32_16x16x32_bf16 v[180:183], v[44:47], a[108:111], v[180:183]
    buffer_load_dwordx4 v7, s[8:11], s62 offen offset:1024 lds
    v_mfma_f32_16x16x32_bf16 v[184:187], v[40:43], a[112:115], v[184:187]
    buffer_load_dwordx2 v[82:83], v77, s[28:31], s98 offen nt
    v_mfma_f32_16x16x32_bf16 v[184:187], v[44:47], a[116:119], v[184:187]
    ds_read_b128 a[20:23], v23 offset:53248
    v_mfma_f32_16x16x32_bf16 v[188:191], v[40:43], a[120:123], v[188:191]
    s_waitcnt lgkmcnt(1)
    ds_read_b64_tr_b16 v[40:41], v14 offset:0
    ds_read_b64_tr_b16 v[42:43], v14 offset:1024
    v_mfma_f32_16x16x32_bf16 v[188:191], v[44:47], a[124:127], v[188:191]
    ds_read_b64_tr_b16 v[44:45], v14 offset:8192
    ds_read_b64_tr_b16 v[46:47], v14 offset:9216
    v_mfma_f32_16x16x32_bf16 v[192:195], v[48:51], a[64:67], v[192:195]
    v_add_u32 v14, 0xfffe0000, v14
    v_mfma_f32_16x16x32_bf16 v[192:195], v[52:55], a[68:71], v[192:195]
    v_mfma_f32_16x16x32_bf16 v[196:199], v[48:51], a[72:75], v[196:199]
    buffer_load_ushort v92, v65, s[32:35], s99 offen offset:0
    v_mfma_f32_16x16x32_bf16 v[196:199], v[52:55], a[76:79], v[196:199]
    ds_read_b128 a[24:27], v22 offset:55296
    v_mfma_f32_16x16x32_bf16 v[200:203], v[48:51], a[80:83], v[200:203]
    buffer_load_dwordx4 v8, s[8:11], s62 offen offset:2048 lds
    v_mfma_f32_16x16x32_bf16 v[200:203], v[52:55], a[84:87], v[200:203]
    v_mfma_f32_16x16x32_bf16 v[204:207], v[48:51], a[88:91], v[204:207]
    s_add_u32 s98, s98, 3456
    v_mfma_f32_16x16x32_bf16 v[204:207], v[52:55], a[92:95], v[204:207]
    v_mfma_f32_16x16x32_bf16 v[208:211], v[48:51], a[96:99], v[208:211]
    buffer_load_dwordx2 v[84:85], v75, s[28:31], s98 offen nt
    v_mfma_f32_16x16x32_bf16 v[208:211], v[52:55], a[100:103], v[208:211]
    ds_read_b128 a[28:31], v23 offset:55296
    v_mfma_f32_16x16x32_bf16 v[212:215], v[48:51], a[104:107], v[212:215]
    v_mfma_f32_16x16x32_bf16 v[212:215], v[52:55], a[108:111], v[212:215]
    v_mfma_f32_16x16x32_bf16 v[216:219], v[48:51], a[112:115], v[216:219]
    buffer_load_dwordx4 v9, s[8:11], s62 offen offset:3072 lds
    v_mfma_f32_16x16x32_bf16 v[216:219], v[52:55], a[116:119], v[216:219]
    v_mfma_f32_16x16x32_bf16 v[220:223], v[48:51], a[120:123], v[220:223]
    ds_read_b64_tr_b16 v[48:49], v15 offset:0
    ds_read_b64_tr_b16 v[50:51], v15 offset:1024
    v_mfma_f32_16x16x32_bf16 v[220:223], v[52:55], a[124:127], v[220:223]
    ds_read_b64_tr_b16 v[52:53], v15 offset:8192
    ds_read_b64_tr_b16 v[54:55], v15 offset:9216
    v_mfma_f32_16x16x32_bf16 v[224:227], v[56:59], a[64:67], v[224:227]
    buffer_load_dwordx2 v[86:87], v77, s[28:31], s98 offen nt
    v_mfma_f32_16x16x32_bf16 v[224:227], v[60:63], a[68:71], v[224:227]
    s_xor_b32 s62, s62, 896
    v_add_u32 v15, 0xfffe0000, v15
    v_mfma_f32_16x16x32_bf16 v[228:231], v[56:59], a[72:75], v[228:231]
    v_mfma_f32_16x16x32_bf16 v[228:231], v[60:63], a[76:79], v[228:231]
    v_mfma_f32_16x16x32_bf16 v[232:235], v[56:59], a[80:83], v[232:235]
    buffer_load_ushort v93, v65, s[32:35], s99 offen offset:2
    v_mfma_f32_16x16x32_bf16 v[232:235], v[60:63], a[84:87], v[232:235]
    s_add_u32 m0, s69, 65536
    v_mfma_f32_16x16x32_bf16 v[236:239], v[56:59], a[88:91], v[236:239]
    v_mfma_f32_16x16x32_bf16 v[236:239], v[60:63], a[92:95], v[236:239]
    v_mfma_f32_16x16x32_bf16 v[240:243], v[56:59], a[96:99], v[240:243]
    s_add_u32 s98, s98, 3456
    buffer_load_dwordx4 v2, s[12:15], s60 offen nt lds
    v_mfma_f32_16x16x32_bf16 v[240:243], v[60:63], a[100:103], v[240:243]
    v_mfma_f32_16x16x32_bf16 v[244:247], v[56:59], a[104:107], v[244:247]
    v_mfma_f32_16x16x32_bf16 v[244:247], v[60:63], a[108:111], v[244:247]
    v_mfma_f32_16x16x32_bf16 v[248:251], v[56:59], a[112:115], v[248:251]
    buffer_load_dwordx2 v[88:89], v75, s[28:31], s98 offen nt
    v_mfma_f32_16x16x32_bf16 v[248:251], v[60:63], a[116:119], v[248:251]
    v_mfma_f32_16x16x32_bf16 v[252:255], v[56:59], a[120:123], v[252:255]
    ds_read_b64_tr_b16 v[56:57], v16 offset:0
    ds_read_b64_tr_b16 v[58:59], v16 offset:1024
    v_mfma_f32_16x16x32_bf16 v[252:255], v[60:63], a[124:127], v[252:255]
    s_waitcnt lgkmcnt(2)
    ds_read_b64_tr_b16 v[60:61], v16 offset:8192
    ds_read_b64_tr_b16 v[62:63], v16 offset:9216
    v_mfma_f32_16x16x32_bf16 a[128:131], a[64:67], v[40:43], a[128:131]
    buffer_load_dword v105, v103, s[20:23], s77 offen
    v_mfma_f32_16x16x32_bf16 a[128:131], a[68:71], v[44:47], a[128:131]
    s_mul_i32 s77, s2, 18432
    v_add_u32 v22, 0x10000, v22
    v_add_u32 v16, 0xfffe0000, v16
    v_mfma_f32_16x16x32_bf16 a[132:135], a[72:75], v[40:43], a[132:135]
    s_add_u32 s77, s77, s76
    ds_read_b128 a[32:35], v22 offset:16384
    v_mfma_f32_16x16x32_bf16 a[132:135], a[76:79], v[44:47], a[132:135]
    s_mov_b32 s76, 0
    v_mfma_f32_16x16x32_bf16 a[136:139], a[80:83], v[40:43], a[136:139]
    buffer_load_dwordx4 v3, s[12:15], s60 offen offset:1024 nt lds
    v_mfma_f32_16x16x32_bf16 a[136:139], a[84:87], v[44:47], a[136:139]
    v_mfma_f32_16x16x32_bf16 a[140:143], a[88:91], v[40:43], a[140:143]
    v_add_u32 v23, 0x10000, v23
    v_mfma_f32_16x16x32_bf16 a[140:143], a[92:95], v[44:47], a[140:143]
    ds_read_b128 a[36:39], v23 offset:16384
    v_mfma_f32_16x16x32_bf16 a[144:147], a[96:99], v[40:43], a[144:147]
    buffer_load_dwordx2 v[90:91], v77, s[28:31], s98 offen nt
    v_mfma_f32_16x16x32_bf16 a[144:147], a[100:103], v[44:47], a[144:147]
    v_mfma_f32_16x16x32_bf16 a[148:151], a[104:107], v[40:43], a[148:151]
    s_add_u32 s98, s98, 3456
    v_mfma_f32_16x16x32_bf16 a[148:151], a[108:111], v[44:47], a[148:151]
    s_mov_b32 s30, 2359296
    v_mfma_f32_16x16x32_bf16 a[152:155], a[112:115], v[40:43], a[152:155]
    s_bfe_u32 s98, s72, 0x10001
    buffer_load_dwordx4 v4, s[12:15], s60 offen offset:2048 nt lds
    v_mfma_f32_16x16x32_bf16 a[152:155], a[116:119], v[44:47], a[152:155]
    s_add_u32 s28, s56, 6291456
    s_addc_u32 s29, s57, 0
    ds_read_b128 a[40:43], v22 offset:18432
    v_mfma_f32_16x16x32_bf16 a[156:159], a[120:123], v[40:43], a[156:159]
    ds_read_b64_tr_b16 v[40:41], v17 offset:0
    ds_read_b64_tr_b16 v[42:43], v17 offset:1024
    v_mfma_f32_16x16x32_bf16 a[156:159], a[124:127], v[44:47], a[156:159]
    ds_read_b64_tr_b16 v[44:45], v17 offset:8192
    ds_read_b64_tr_b16 v[46:47], v17 offset:9216
    v_mfma_f32_16x16x32_bf16 a[160:163], a[64:67], v[48:51], a[160:163]
    buffer_load_ushort v94, v65, s[32:35], s99 offen offset:4
    v_mfma_f32_16x16x32_bf16 a[160:163], a[68:71], v[52:55], a[160:163]
    s_add_u32 s32, s56, 9437184
    s_addc_u32 s33, s57, 0
    s_mov_b32 s34, 163840
    v_mfma_f32_16x16x32_bf16 a[164:167], a[72:75], v[48:51], a[164:167]
    s_bfe_u32 s99, s72, 0x10003
    ds_read_b128 a[44:47], v23 offset:18432
    v_add_u32 v17, 0xfffe0000, v17
    v_mfma_f32_16x16x32_bf16 a[164:167], a[76:79], v[52:55], a[164:167]
    s_lshl1_add_u32 s98, s99, s98
    v_mfma_f32_16x16x32_bf16 a[168:171], a[80:83], v[48:51], a[168:171]
    s_lshl_b32 s98, s98, 5
    buffer_store_dword v65, v64, s[32:35], s101 offen sc1
    v_mfma_f32_16x16x32_bf16 a[168:171], a[84:87], v[52:55], a[168:171]
    s_lshl_b32 s72, s72, 7
    v_mfma_f32_16x16x32_bf16 a[172:175], a[88:91], v[48:51], a[172:175]
    v_mfma_f32_16x16x32_bf16 a[172:175], a[92:95], v[52:55], a[172:175]
    v_mfma_f32_16x16x32_bf16 a[176:179], a[96:99], v[48:51], a[176:179]
    buffer_load_dwordx4 v5, s[12:15], s60 offen offset:3072 nt lds
    v_mfma_f32_16x16x32_bf16 a[176:179], a[100:103], v[52:55], a[176:179]
    s_add_u32 m0, s69, 81920
    ds_read_b128 a[48:51], v22 offset:20480
    v_mfma_f32_16x16x32_bf16 a[180:183], a[104:107], v[48:51], a[180:183]
    v_mfma_f32_16x16x32_bf16 a[180:183], a[108:111], v[52:55], a[180:183]
    v_mfma_f32_16x16x32_bf16 a[184:187], a[112:115], v[48:51], a[184:187]
    buffer_load_dwordx4 v6, s[8:11], s61 offen lds
    v_mfma_f32_16x16x32_bf16 a[184:187], a[116:119], v[52:55], a[184:187]
    ds_read_b128 a[52:55], v23 offset:20480
    v_mfma_f32_16x16x32_bf16 a[188:191], a[120:123], v[48:51], a[188:191]
    v_mfma_f32_16x16x32_bf16 a[188:191], a[124:127], v[52:55], a[188:191]
    s_waitcnt lgkmcnt(1)
    v_mfma_f32_16x16x32_bf16 a[192:195], a[64:67], v[56:59], a[192:195]
    buffer_load_dwordx4 v7, s[8:11], s61 offen offset:1024 lds
    v_mfma_f32_16x16x32_bf16 a[192:195], a[68:71], v[60:63], a[192:195]
    s_cmp_lt_u32 s2, 192
    s_cselect_b32 s72, s72, 1073741824
    v_mfma_f32_16x16x32_bf16 a[196:199], a[72:75], v[56:59], a[196:199]
    v_mfma_f32_16x16x32_bf16 a[196:199], a[76:79], v[60:63], a[196:199]
    ds_read_b128 a[56:59], v22 offset:22528
    v_mfma_f32_16x16x32_bf16 a[200:203], a[80:83], v[56:59], a[200:203]
    buffer_load_dwordx4 v8, s[8:11], s61 offen offset:2048 lds
    v_mfma_f32_16x16x32_bf16 a[200:203], a[84:87], v[60:63], a[200:203]
    v_mfma_f32_16x16x32_bf16 a[204:207], a[88:91], v[56:59], a[204:207]
    v_mfma_f32_16x16x32_bf16 a[204:207], a[92:95], v[60:63], a[204:207]
    v_mfma_f32_16x16x32_bf16 a[208:211], a[96:99], v[56:59], a[208:211]
    ds_read_b128 a[60:63], v23 offset:22528
    v_mfma_f32_16x16x32_bf16 a[208:211], a[100:103], v[60:63], a[208:211]
    v_mfma_f32_16x16x32_bf16 a[212:215], a[104:107], v[56:59], a[212:215]
    buffer_load_dwordx4 v9, s[8:11], s61 offen offset:3072 lds
    v_mfma_f32_16x16x32_bf16 a[212:215], a[108:111], v[60:63], a[212:215]
    v_mfma_f32_16x16x32_bf16 a[216:219], a[112:115], v[56:59], a[216:219]
    v_mfma_f32_16x16x32_bf16 a[216:219], a[116:119], v[60:63], a[216:219]
    v_mfma_f32_16x16x32_bf16 a[220:223], a[120:123], v[56:59], a[220:223]
    v_mfma_f32_16x16x32_bf16 a[220:223], a[124:127], v[60:63], a[220:223]
    v_mfma_f32_16x16x32_bf16 a[224:227], a[64:67], v[40:43], a[224:227]
    v_mfma_f32_16x16x32_bf16 a[224:227], a[68:71], v[44:47], a[224:227]
    s_xor_b32 s61, s61, 128
    v_mfma_f32_16x16x32_bf16 a[228:231], a[72:75], v[40:43], a[228:231]
    v_mfma_f32_16x16x32_bf16 a[228:231], a[76:79], v[44:47], a[228:231]
    v_mfma_f32_16x16x32_bf16 a[232:235], a[80:83], v[40:43], a[232:235]
    v_mfma_f32_16x16x32_bf16 a[232:235], a[84:87], v[44:47], a[232:235]
    s_waitcnt vmcnt(15) lgkmcnt(0)
    s_barrier
    ds_read_b64_tr_b16 v[48:49], v14 offset:0
    v_mfma_f32_16x16x32_bf16 a[236:239], a[88:91], v[40:43], a[236:239]
    s_add_u32 m0, s69, 98304
    ds_read_b64_tr_b16 v[50:51], v14 offset:1024
    ds_read_b64_tr_b16 v[52:53], v14 offset:8192
    v_mfma_f32_16x16x32_bf16 a[236:239], a[92:95], v[44:47], a[236:239]
    buffer_load_dwordx4 v2, s[16:19], s60 offen nt lds
    v_mfma_f32_16x16x32_bf16 a[240:243], a[96:99], v[40:43], a[240:243]
    ds_read_b64_tr_b16 v[54:55], v14 offset:9216
    ds_read_b64_tr_b16 v[56:57], v15 offset:0
    v_mfma_f32_16x16x32_bf16 a[240:243], a[100:103], v[44:47], a[240:243]
    ds_read_b64_tr_b16 v[58:59], v15 offset:1024
    ds_read_b64_tr_b16 v[60:61], v15 offset:8192
    v_mfma_f32_16x16x32_bf16 a[244:247], a[104:107], v[40:43], a[244:247]
    ds_read_b64_tr_b16 v[62:63], v15 offset:9216
    v_mfma_f32_16x16x32_bf16 a[244:247], a[108:111], v[44:47], a[244:247]
    v_mfma_f32_16x16x32_bf16 a[248:251], a[112:115], v[40:43], a[248:251]
    v_mfma_f32_16x16x32_bf16 a[248:251], a[116:119], v[44:47], a[248:251]
    buffer_load_dwordx4 v3, s[16:19], s60 offen offset:1024 nt lds
    v_mfma_f32_16x16x32_bf16 a[252:255], a[120:123], v[40:43], a[252:255]
    ds_read_b64_tr_b16 v[40:41], v16 offset:0
    ds_read_b64_tr_b16 v[42:43], v16 offset:1024
    v_mfma_f32_16x16x32_bf16 a[252:255], a[124:127], v[44:47], a[252:255]
    s_waitcnt lgkmcnt(2)
    ds_read_b64_tr_b16 v[44:45], v16 offset:8192
    ds_read_b64_tr_b16 v[46:47], v16 offset:9216
    v_mfma_f32_16x16x32_bf16 v[128:131], v[48:51], a[0:3], v[128:131]
    v_mfma_f32_16x16x32_bf16 v[128:131], v[52:55], a[4:7], v[128:131]
    v_add_u32 v22, 0xfffe0000, v22
    v_mfma_f32_16x16x32_bf16 v[132:135], v[48:51], a[8:11], v[132:135]
    ds_read_b128 a[64:67], v22 offset:16384
    v_mfma_f32_16x16x32_bf16 v[132:135], v[52:55], a[12:15], v[132:135]
    v_mfma_f32_16x16x32_bf16 v[136:139], v[48:51], a[16:19], v[136:139]
    v_mfma_f32_16x16x32_bf16 v[136:139], v[52:55], a[20:23], v[136:139]
    buffer_load_dwordx4 v4, s[16:19], s60 offen offset:2048 nt lds
    v_mfma_f32_16x16x32_bf16 v[140:143], v[48:51], a[24:27], v[140:143]
    v_add_u32 v23, 0xfffe0000, v23
    v_mfma_f32_16x16x32_bf16 v[140:143], v[52:55], a[28:31], v[140:143]
    ds_read_b128 a[68:71], v23 offset:16384
    v_mfma_f32_16x16x32_bf16 v[144:147], v[48:51], a[32:35], v[144:147]
    v_mfma_f32_16x16x32_bf16 v[144:147], v[52:55], a[36:39], v[144:147]
    v_mfma_f32_16x16x32_bf16 v[148:151], v[48:51], a[40:43], v[148:151]
    v_mfma_f32_16x16x32_bf16 v[148:151], v[52:55], a[44:47], v[148:151]
    v_mfma_f32_16x16x32_bf16 v[152:155], v[48:51], a[48:51], v[152:155]
    buffer_load_dwordx4 v5, s[16:19], s60 offen offset:3072 nt lds
    v_mfma_f32_16x16x32_bf16 v[152:155], v[52:55], a[52:55], v[152:155]
    ds_read_b128 a[72:75], v22 offset:18432
    v_mfma_f32_16x16x32_bf16 v[156:159], v[48:51], a[56:59], v[156:159]
    ds_read_b64_tr_b16 v[48:49], v17 offset:0
    ds_read_b64_tr_b16 v[50:51], v17 offset:1024
    v_mfma_f32_16x16x32_bf16 v[156:159], v[52:55], a[60:63], v[156:159]
    ds_read_b64_tr_b16 v[52:53], v17 offset:8192
    ds_read_b64_tr_b16 v[54:55], v17 offset:9216
    v_mfma_f32_16x16x32_bf16 v[160:163], v[56:59], a[0:3], v[160:163]
    v_mfma_f32_16x16x32_bf16 v[160:163], v[60:63], a[4:7], v[160:163]
    v_mfma_f32_16x16x32_bf16 v[164:167], v[56:59], a[8:11], v[164:167]
    ds_read_b128 a[76:79], v23 offset:18432
    v_mfma_f32_16x16x32_bf16 v[164:167], v[60:63], a[12:15], v[164:167]
    s_add_u32 m0, s69, 114688
    v_mfma_f32_16x16x32_bf16 v[168:171], v[56:59], a[16:19], v[168:171]
    s_xor_b32 s60, s60, 3670016
    buffer_load_dwordx4 v6, s[8:11], s62 offen lds
    v_mfma_f32_16x16x32_bf16 v[168:171], v[60:63], a[20:23], v[168:171]
    v_mfma_f32_16x16x32_bf16 v[172:175], v[56:59], a[24:27], v[172:175]
    v_mfma_f32_16x16x32_bf16 v[172:175], v[60:63], a[28:31], v[172:175]
    v_mfma_f32_16x16x32_bf16 v[176:179], v[56:59], a[32:35], v[176:179]
    ds_read_b128 a[80:83], v22 offset:20480
    v_mfma_f32_16x16x32_bf16 v[176:179], v[60:63], a[36:39], v[176:179]
    v_mfma_f32_16x16x32_bf16 v[180:183], v[56:59], a[40:43], v[180:183]
    v_mfma_f32_16x16x32_bf16 v[180:183], v[60:63], a[44:47], v[180:183]
    buffer_load_dwordx4 v7, s[8:11], s62 offen offset:1024 lds
    v_mfma_f32_16x16x32_bf16 v[184:187], v[56:59], a[48:51], v[184:187]
    v_mfma_f32_16x16x32_bf16 v[184:187], v[60:63], a[52:55], v[184:187]
    ds_read_b128 a[84:87], v23 offset:20480
    v_mfma_f32_16x16x32_bf16 v[188:191], v[56:59], a[56:59], v[188:191]
    s_waitcnt lgkmcnt(1)
    ds_read_b64_tr_b16 v[56:57], v14 offset:32768
    ds_read_b64_tr_b16 v[58:59], v14 offset:33792
    v_mfma_f32_16x16x32_bf16 v[188:191], v[60:63], a[60:63], v[188:191]
    ds_read_b64_tr_b16 v[60:61], v14 offset:40960
    ds_read_b64_tr_b16 v[62:63], v14 offset:41984
    v_mfma_f32_16x16x32_bf16 v[192:195], v[40:43], a[0:3], v[192:195]
    v_add_u32 v14, 0x10000, v14
    v_mfma_f32_16x16x32_bf16 v[192:195], v[44:47], a[4:7], v[192:195]
    v_mfma_f32_16x16x32_bf16 v[196:199], v[40:43], a[8:11], v[196:199]
    v_mfma_f32_16x16x32_bf16 v[196:199], v[44:47], a[12:15], v[196:199]
    buffer_load_dwordx4 v8, s[8:11], s62 offen offset:2048 lds
    v_mfma_f32_16x16x32_bf16 v[200:203], v[40:43], a[16:19], v[200:203]
    ds_read_b128 a[88:91], v22 offset:22528
    v_mfma_f32_16x16x32_bf16 v[200:203], v[44:47], a[20:23], v[200:203]
    v_mfma_f32_16x16x32_bf16 v[204:207], v[40:43], a[24:27], v[204:207]
    v_mfma_f32_16x16x32_bf16 v[204:207], v[44:47], a[28:31], v[204:207]
    v_mfma_f32_16x16x32_bf16 v[208:211], v[40:43], a[32:35], v[208:211]
    ds_read_b128 a[92:95], v23 offset:22528
    v_mfma_f32_16x16x32_bf16 v[208:211], v[44:47], a[36:39], v[208:211]
    v_mfma_f32_16x16x32_bf16 v[212:215], v[40:43], a[40:43], v[212:215]
    buffer_load_dwordx4 v9, s[8:11], s62 offen offset:3072 lds
    v_mfma_f32_16x16x32_bf16 v[212:215], v[44:47], a[44:47], v[212:215]
    v_mfma_f32_16x16x32_bf16 v[216:219], v[40:43], a[48:51], v[216:219]
    v_mfma_f32_16x16x32_bf16 v[216:219], v[44:47], a[52:55], v[216:219]
    v_mfma_f32_16x16x32_bf16 v[220:223], v[40:43], a[56:59], v[220:223]
    ds_read_b64_tr_b16 v[40:41], v15 offset:32768
    ds_read_b64_tr_b16 v[42:43], v15 offset:33792
    v_mfma_f32_16x16x32_bf16 v[220:223], v[44:47], a[60:63], v[220:223]
    ds_read_b64_tr_b16 v[44:45], v15 offset:40960
    ds_read_b64_tr_b16 v[46:47], v15 offset:41984
    v_mfma_f32_16x16x32_bf16 v[224:227], v[48:51], a[0:3], v[224:227]
    v_add_u32 v15, 0x10000, v15
    v_mfma_f32_16x16x32_bf16 v[224:227], v[52:55], a[4:7], v[224:227]
    s_xor_b32 s62, s62, 128
    v_mfma_f32_16x16x32_bf16 v[228:231], v[48:51], a[8:11], v[228:231]
    v_mfma_f32_16x16x32_bf16 v[228:231], v[52:55], a[12:15], v[228:231]
    v_mfma_f32_16x16x32_bf16 v[232:235], v[48:51], a[16:19], v[232:235]
    v_mfma_f32_16x16x32_bf16 v[232:235], v[52:55], a[20:23], v[232:235]
    s_add_u32 m0, s69, 131072
    v_mfma_f32_16x16x32_bf16 v[236:239], v[48:51], a[24:27], v[236:239]
    buffer_load_dwordx4 v2, s[12:15], s60 offen nt lds
    v_mfma_f32_16x16x32_bf16 v[236:239], v[52:55], a[28:31], v[236:239]
    v_mfma_f32_16x16x32_bf16 v[240:243], v[48:51], a[32:35], v[240:243]
    v_mfma_f32_16x16x32_bf16 v[240:243], v[52:55], a[36:39], v[240:243]
    v_mfma_f32_16x16x32_bf16 v[244:247], v[48:51], a[40:43], v[244:247]
    v_mfma_f32_16x16x32_bf16 v[244:247], v[52:55], a[44:47], v[244:247]
    v_mfma_f32_16x16x32_bf16 v[248:251], v[48:51], a[48:51], v[248:251]
    v_mfma_f32_16x16x32_bf16 v[248:251], v[52:55], a[52:55], v[248:251]
    buffer_load_dwordx4 v3, s[12:15], s60 offen offset:1024 nt lds
    v_mfma_f32_16x16x32_bf16 v[252:255], v[48:51], a[56:59], v[252:255]
    ds_read_b64_tr_b16 v[48:49], v16 offset:32768
    ds_read_b64_tr_b16 v[50:51], v16 offset:33792
    v_mfma_f32_16x16x32_bf16 v[252:255], v[52:55], a[60:63], v[252:255]
    s_waitcnt lgkmcnt(2)
    ds_read_b64_tr_b16 v[52:53], v16 offset:40960
    ds_read_b64_tr_b16 v[54:55], v16 offset:41984
    v_mfma_f32_16x16x32_bf16 a[128:131], a[0:3], v[56:59], a[128:131]
    v_add_u32 v16, 0x10000, v16
    v_mfma_f32_16x16x32_bf16 a[128:131], a[4:7], v[60:63], a[128:131]
    v_mfma_f32_16x16x32_bf16 a[132:135], a[8:11], v[56:59], a[132:135]
    ds_read_b128 a[96:99], v22 offset:49152
    v_mfma_f32_16x16x32_bf16 a[132:135], a[12:15], v[60:63], a[132:135]
    v_mfma_f32_16x16x32_bf16 a[136:139], a[16:19], v[56:59], a[136:139]
    v_mfma_f32_16x16x32_bf16 a[136:139], a[20:23], v[60:63], a[136:139]
    buffer_load_dwordx4 v4, s[12:15], s60 offen offset:2048 nt lds
    v_mfma_f32_16x16x32_bf16 a[140:143], a[24:27], v[56:59], a[140:143]
    v_mfma_f32_16x16x32_bf16 a[140:143], a[28:31], v[60:63], a[140:143]
    ds_read_b128 a[100:103], v23 offset:49152
    v_mfma_f32_16x16x32_bf16 a[144:147], a[32:35], v[56:59], a[144:147]
    v_mfma_f32_16x16x32_bf16 a[144:147], a[36:39], v[60:63], a[144:147]
    v_mfma_f32_16x16x32_bf16 a[148:151], a[40:43], v[56:59], a[148:151]
    v_mfma_f32_16x16x32_bf16 a[148:151], a[44:47], v[60:63], a[148:151]
    buffer_load_dword v106, v103, s[24:27], s77 offen
    v_mfma_f32_16x16x32_bf16 a[152:155], a[48:51], v[56:59], a[152:155]
    s_add_u32 s77, s77, 4608
    buffer_load_dwordx4 v5, s[12:15], s60 offen offset:3072 nt lds
    v_mfma_f32_16x16x32_bf16 a[152:155], a[52:55], v[60:63], a[152:155]
    ds_read_b128 a[104:107], v22 offset:51200
    v_mfma_f32_16x16x32_bf16 a[156:159], a[56:59], v[56:59], a[156:159]
    ds_read_b64_tr_b16 v[56:57], v17 offset:32768
    ds_read_b64_tr_b16 v[58:59], v17 offset:33792
    v_mfma_f32_16x16x32_bf16 a[156:159], a[60:63], v[60:63], a[156:159]
    ds_read_b64_tr_b16 v[60:61], v17 offset:40960
    ds_read_b64_tr_b16 v[62:63], v17 offset:41984
    v_mfma_f32_16x16x32_bf16 a[160:163], a[0:3], v[40:43], a[160:163]
    v_add_u32 v17, 0x10000, v17
    v_mfma_f32_16x16x32_bf16 a[160:163], a[4:7], v[44:47], a[160:163]
    v_mfma_f32_16x16x32_bf16 a[164:167], a[8:11], v[40:43], a[164:167]
    ds_read_b128 a[108:111], v23 offset:51200
    v_mfma_f32_16x16x32_bf16 a[164:167], a[12:15], v[44:47], a[164:167]
    s_add_u32 m0, s69, 147456
    v_mfma_f32_16x16x32_bf16 a[168:171], a[16:19], v[40:43], a[168:171]
    buffer_load_dwordx4 v6, s[8:11], s61 offen lds
    v_mfma_f32_16x16x32_bf16 a[168:171], a[20:23], v[44:47], a[168:171]
    v_mfma_f32_16x16x32_bf16 a[172:175], a[24:27], v[40:43], a[172:175]
    v_mfma_f32_16x16x32_bf16 a[172:175], a[28:31], v[44:47], a[172:175]
    v_mfma_f32_16x16x32_bf16 a[176:179], a[32:35], v[40:43], a[176:179]
    ds_read_b128 a[112:115], v22 offset:53248
    v_mfma_f32_16x16x32_bf16 a[176:179], a[36:39], v[44:47], a[176:179]
    v_mfma_f32_16x16x32_bf16 a[180:183], a[40:43], v[40:43], a[180:183]
    v_mfma_f32_16x16x32_bf16 a[180:183], a[44:47], v[44:47], a[180:183]
    buffer_load_dwordx4 v7, s[8:11], s61 offen offset:1024 lds
    v_mfma_f32_16x16x32_bf16 a[184:187], a[48:51], v[40:43], a[184:187]
    v_mfma_f32_16x16x32_bf16 a[184:187], a[52:55], v[44:47], a[184:187]
    ds_read_b128 a[116:119], v23 offset:53248
    v_mfma_f32_16x16x32_bf16 a[188:191], a[56:59], v[40:43], a[188:191]
    v_mfma_f32_16x16x32_bf16 a[188:191], a[60:63], v[44:47], a[188:191]
    s_waitcnt lgkmcnt(1)
    v_mfma_f32_16x16x32_bf16 a[192:195], a[0:3], v[48:51], a[192:195]
    v_mfma_f32_16x16x32_bf16 a[192:195], a[4:7], v[52:55], a[192:195]
    v_mfma_f32_16x16x32_bf16 a[196:199], a[8:11], v[48:51], a[196:199]
    v_mfma_f32_16x16x32_bf16 a[196:199], a[12:15], v[52:55], a[196:199]
    buffer_load_dwordx4 v8, s[8:11], s61 offen offset:2048 lds
    v_mfma_f32_16x16x32_bf16 a[200:203], a[16:19], v[48:51], a[200:203]
    ds_read_b128 a[120:123], v22 offset:55296
    v_mfma_f32_16x16x32_bf16 a[200:203], a[20:23], v[52:55], a[200:203]
    v_mfma_f32_16x16x32_bf16 a[204:207], a[24:27], v[48:51], a[204:207]
    v_mfma_f32_16x16x32_bf16 a[204:207], a[28:31], v[52:55], a[204:207]
    v_mfma_f32_16x16x32_bf16 a[208:211], a[32:35], v[48:51], a[208:211]
    ds_read_b128 a[124:127], v23 offset:55296
    v_mfma_f32_16x16x32_bf16 a[208:211], a[36:39], v[52:55], a[208:211]
    v_mfma_f32_16x16x32_bf16 a[212:215], a[40:43], v[48:51], a[212:215]
    buffer_load_dwordx4 v9, s[8:11], s61 offen offset:3072 lds
    v_mfma_f32_16x16x32_bf16 a[212:215], a[44:47], v[52:55], a[212:215]
    v_mfma_f32_16x16x32_bf16 a[216:219], a[48:51], v[48:51], a[216:219]
    v_mfma_f32_16x16x32_bf16 a[216:219], a[52:55], v[52:55], a[216:219]
    v_mfma_f32_16x16x32_bf16 a[220:223], a[56:59], v[48:51], a[220:223]
    v_mfma_f32_16x16x32_bf16 a[220:223], a[60:63], v[52:55], a[220:223]
    v_mfma_f32_16x16x32_bf16 a[224:227], a[0:3], v[56:59], a[224:227]
    v_mfma_f32_16x16x32_bf16 a[224:227], a[4:7], v[60:63], a[224:227]
    s_xor_b32 s61, s61, 384
    v_mfma_f32_16x16x32_bf16 a[228:231], a[8:11], v[56:59], a[228:231]
    v_mfma_f32_16x16x32_bf16 a[228:231], a[12:15], v[60:63], a[228:231]
    v_mfma_f32_16x16x32_bf16 a[232:235], a[16:19], v[56:59], a[232:235]
    v_mfma_f32_16x16x32_bf16 a[232:235], a[20:23], v[60:63], a[232:235]
    s_waitcnt vmcnt(9) lgkmcnt(0)
    s_barrier
    ds_read_b64_tr_b16 v[40:41], v14 offset:0
    v_mfma_f32_16x16x32_bf16 a[236:239], a[24:27], v[56:59], a[236:239]
    s_add_u32 m0, s69, 0
    ds_read_b64_tr_b16 v[42:43], v14 offset:1024
    ds_read_b64_tr_b16 v[44:45], v14 offset:8192
    v_mfma_f32_16x16x32_bf16 a[236:239], a[28:31], v[60:63], a[236:239]
    buffer_load_dwordx4 v2, s[16:19], s60 offen nt lds
    v_mfma_f32_16x16x32_bf16 a[240:243], a[32:35], v[56:59], a[240:243]
    ds_read_b64_tr_b16 v[46:47], v14 offset:9216
    v_cndmask_b32 v82, v82, v92, s[92:93]
    v_mfma_f32_16x16x32_bf16 a[240:243], a[36:39], v[60:63], a[240:243]
    v_cndmask_b32_e64 v83, v83, 0, s[92:93]
    v_xor_b32 v92, s98, v95
    v_mfma_f32_16x16x32_bf16 a[244:247], a[40:43], v[56:59], a[244:247]
    buffer_store_dwordx4 v[80:83], v92, s[28:31], s72 offen sc1
    v_mfma_f32_16x16x32_bf16 a[244:247], a[44:47], v[60:63], a[244:247]
    s_mul_i32 s72, s2, 3
    ds_read_b64_tr_b16 v[48:49], v15 offset:0
    ds_read_b64_tr_b16 v[50:51], v15 offset:1024
    v_mfma_f32_16x16x32_bf16 a[248:251], a[48:51], v[56:59], a[248:251]
    s_add_u32 s72, s72, 1
    ds_read_b64_tr_b16 v[52:53], v15 offset:8192
    ds_read_b64_tr_b16 v[54:55], v15 offset:9216
    v_mfma_f32_16x16x32_bf16 a[248:251], a[52:55], v[60:63], a[248:251]
    s_bfe_u32 s98, s72, 0x10001
    buffer_load_dwordx4 v3, s[16:19], s60 offen offset:1024 nt lds
    v_mfma_f32_16x16x32_bf16 a[252:255], a[56:59], v[56:59], a[252:255]
    s_bfe_u32 s99, s72, 0x10003
    v_cndmask_b32 v86, v86, v93, s[92:93]
    v_cndmask_b32_e64 v87, v87, 0, s[92:93]
    v_mfma_f32_16x16x32_bf16 a[252:255], a[60:63], v[60:63], a[252:255]
    s_lshl1_add_u32 s98, s99, s98
    v_cndmask_b32 v90, v90, v94, s[92:93]
    v_cndmask_b32_e64 v91, v91, 0, s[92:93]
    s_waitcnt lgkmcnt(4)
    v_mfma_f32_16x16x32_bf16 v[128:131], v[40:43], a[64:67], v[128:131]
    s_lshl_b32 s98, s98, 5
    v_xor_b32 v93, s98, v95
    ds_read_b64_tr_b16 v[56:57], v16 offset:0
    v_mfma_f32_16x16x32_bf16 v[128:131], v[44:47], a[68:71], v[128:131]
    s_lshl_b32 s72, s72, 7
    v_add_u32 v22, 0x10000, v22
    ds_read_b64_tr_b16 v[58:59], v16 offset:1024
    v_mfma_f32_16x16x32_bf16 v[132:135], v[40:43], a[72:75], v[132:135]
    ds_read_b128 a[0:3], v22 offset:16384
    ds_read_b64_tr_b16 v[60:61], v16 offset:8192
    v_mfma_f32_16x16x32_bf16 v[132:135], v[44:47], a[76:79], v[132:135]
    s_cmp_lt_u32 s2, 192
    s_cselect_b32 s72, s72, 1073741824
    ds_read_b64_tr_b16 v[62:63], v16 offset:9216
    v_mfma_f32_16x16x32_bf16 v[136:139], v[40:43], a[80:83], v[136:139]
    buffer_store_dwordx4 v[84:87], v93, s[28:31], s72 offen sc1
    v_mfma_f32_16x16x32_bf16 v[136:139], v[44:47], a[84:87], v[136:139]
    s_mul_i32 s72, s2, 3
    buffer_load_dwordx4 v4, s[16:19], s60 offen offset:2048 nt lds
    v_mfma_f32_16x16x32_bf16 v[140:143], v[40:43], a[88:91], v[140:143]
    s_add_u32 s72, s72, 2
    v_add_u32 v23, 0x10000, v23
    v_mfma_f32_16x16x32_bf16 v[140:143], v[44:47], a[92:95], v[140:143]
    s_bfe_u32 s98, s72, 0x10001
    ds_read_b128 a[4:7], v23 offset:16384
    v_mfma_f32_16x16x32_bf16 v[144:147], v[40:43], a[96:99], v[144:147]
    s_bfe_u32 s99, s72, 0x10003
    v_mfma_f32_16x16x32_bf16 v[144:147], v[44:47], a[100:103], v[144:147]
    s_lshl1_add_u32 s98, s99, s98
    v_mfma_f32_16x16x32_bf16 v[148:151], v[40:43], a[104:107], v[148:151]
    s_lshl_b32 s98, s98, 5
    v_xor_b32 v94, s98, v95
    v_mfma_f32_16x16x32_bf16 v[148:151], v[44:47], a[108:111], v[148:151]
    s_lshl_b32 s72, s72, 7
    v_mfma_f32_16x16x32_bf16 v[152:155], v[40:43], a[112:115], v[152:155]
    s_mul_i32 s99, s100, 576
    buffer_load_dwordx4 v5, s[16:19], s60 offen offset:3072 nt lds
    v_mfma_f32_16x16x32_bf16 v[152:155], v[44:47], a[116:119], v[152:155]
    ds_read_b128 a[8:11], v22 offset:18432
    v_mfma_f32_16x16x32_bf16 v[156:159], v[40:43], a[120:123], v[156:159]
    s_cmp_lt_u32 s2, 192
    s_cselect_b32 s72, s72, 1073741824
    ds_read_b64_tr_b16 v[40:41], v17 offset:0
    v_mfma_f32_16x16x32_bf16 v[156:159], v[44:47], a[124:127], v[156:159]
    s_waitcnt lgkmcnt(2)
    buffer_store_dwordx4 v[88:91], v94, s[28:31], s72 offen sc1
    v_mfma_f32_16x16x32_bf16 v[160:163], v[48:51], a[64:67], v[160:163]
    s_mov_b32 s30, 73728
    ds_read_b64_tr_b16 v[42:43], v17 offset:1024
    ds_read_b64_tr_b16 v[44:45], v17 offset:8192
    v_mfma_f32_16x16x32_bf16 v[160:163], v[52:55], a[68:71], v[160:163]
    ds_read_b64_tr_b16 v[46:47], v17 offset:9216
    v_mfma_f32_16x16x32_bf16 v[164:167], v[48:51], a[72:75], v[164:167]
    ds_read_b128 a[12:15], v23 offset:18432
    v_mfma_f32_16x16x32_bf16 v[164:167], v[52:55], a[76:79], v[164:167]
    s_add_u32 m0, s69, 16384
    v_mfma_f32_16x16x32_bf16 v[168:171], v[48:51], a[80:83], v[168:171]
    s_xor_b32 s60, s60, 524288
    buffer_load_dwordx4 v6, s[8:11], s62 offen lds
    v_mfma_f32_16x16x32_bf16 v[168:171], v[52:55], a[84:87], v[168:171]
    s_add_u32 s28, s28, s7
    s_addc_u32 s29, s29, 0
    v_mfma_f32_16x16x32_bf16 v[172:175], v[48:51], a[88:91], v[172:175]
    s_lshr_b32 s7, s6, 1
    v_mfma_f32_16x16x32_bf16 v[172:175], v[52:55], a[92:95], v[172:175]
    s_lshl2_add_u32 s7, s5, s7
    v_mfma_f32_16x16x32_bf16 v[176:179], v[48:51], a[96:99], v[176:179]
    s_mul_i32 s98, s7, 36864
    ds_read_b128 a[16:19], v22 offset:20480
    v_mfma_f32_16x16x32_bf16 v[176:179], v[52:55], a[100:103], v[176:179]
    s_add_u32 s98, s98, s99
    v_mfma_f32_16x16x32_bf16 v[180:183], v[48:51], a[104:107], v[180:183]
    s_mul_i32 s99, s100, 18432
    v_mfma_f32_16x16x32_bf16 v[180:183], v[52:55], a[108:111], v[180:183]
    buffer_load_dwordx4 v7, s[8:11], s62 offen offset:1024 lds
    v_mfma_f32_16x16x32_bf16 v[184:187], v[48:51], a[112:115], v[184:187]
    v_mfma_f32_16x16x32_bf16 v[184:187], v[52:55], a[116:119], v[184:187]
    ds_read_b128 a[20:23], v23 offset:20480
    v_mfma_f32_16x16x32_bf16 v[188:191], v[48:51], a[120:123], v[188:191]
    ds_read_b64_tr_b16 v[48:49], v14 offset:32768
    ds_read_b64_tr_b16 v[50:51], v14 offset:33792
    v_mfma_f32_16x16x32_bf16 v[188:191], v[52:55], a[124:127], v[188:191]
    ds_read_b64_tr_b16 v[52:53], v14 offset:40960
    ds_read_b64_tr_b16 v[54:55], v14 offset:41984
    v_mfma_f32_16x16x32_bf16 v[192:195], v[56:59], a[64:67], v[192:195]
    v_add_u32 v14, 0x10000, v14
    v_mfma_f32_16x16x32_bf16 v[192:195], v[60:63], a[68:71], v[192:195]
    v_mfma_f32_16x16x32_bf16 v[196:199], v[56:59], a[72:75], v[196:199]
    v_mfma_f32_16x16x32_bf16 v[196:199], v[60:63], a[76:79], v[196:199]
    buffer_load_dwordx4 v8, s[8:11], s62 offen offset:2048 lds
    v_mfma_f32_16x16x32_bf16 v[200:203], v[56:59], a[80:83], v[200:203]
    ds_read_b128 a[24:27], v22 offset:22528
    v_mfma_f32_16x16x32_bf16 v[200:203], v[60:63], a[84:87], v[200:203]
    v_mfma_f32_16x16x32_bf16 v[204:207], v[56:59], a[88:91], v[204:207]
    v_mfma_f32_16x16x32_bf16 v[204:207], v[60:63], a[92:95], v[204:207]
    v_mfma_f32_16x16x32_bf16 v[208:211], v[56:59], a[96:99], v[208:211]
    ds_read_b128 a[28:31], v23 offset:22528
    v_mfma_f32_16x16x32_bf16 v[208:211], v[60:63], a[100:103], v[208:211]
    v_mfma_f32_16x16x32_bf16 v[212:215], v[56:59], a[104:107], v[212:215]
    buffer_load_dwordx4 v9, s[8:11], s62 offen offset:3072 lds
    v_mfma_f32_16x16x32_bf16 v[212:215], v[60:63], a[108:111], v[212:215]
    v_mfma_f32_16x16x32_bf16 v[216:219], v[56:59], a[112:115], v[216:219]
    v_mfma_f32_16x16x32_bf16 v[216:219], v[60:63], a[116:119], v[216:219]
    v_mfma_f32_16x16x32_bf16 v[220:223], v[56:59], a[120:123], v[220:223]
    s_waitcnt lgkmcnt(0)
    ds_read_b64_tr_b16 v[56:57], v15 offset:32768
    ds_read_b64_tr_b16 v[58:59], v15 offset:33792
    v_mfma_f32_16x16x32_bf16 v[220:223], v[60:63], a[124:127], v[220:223]
    ds_read_b64_tr_b16 v[60:61], v15 offset:40960
    ds_read_b64_tr_b16 v[62:63], v15 offset:41984
    v_mfma_f32_16x16x32_bf16 v[224:227], v[40:43], a[64:67], v[224:227]
    v_add_u32 v15, 0x10000, v15
    v_mfma_f32_16x16x32_bf16 v[224:227], v[44:47], a[68:71], v[224:227]
    s_xor_b32 s62, s62, 384
    v_mfma_f32_16x16x32_bf16 v[228:231], v[40:43], a[72:75], v[228:231]
    v_mfma_f32_16x16x32_bf16 v[228:231], v[44:47], a[76:79], v[228:231]
    v_mfma_f32_16x16x32_bf16 v[232:235], v[40:43], a[80:83], v[232:235]
    v_mfma_f32_16x16x32_bf16 v[232:235], v[44:47], a[84:87], v[232:235]
    s_add_u32 m0, s69, 32768
    v_mfma_f32_16x16x32_bf16 v[236:239], v[40:43], a[88:91], v[236:239]
    buffer_load_dwordx4 v2, s[12:15], s60 offen nt lds
    v_mfma_f32_16x16x32_bf16 v[236:239], v[44:47], a[92:95], v[236:239]
    v_mfma_f32_16x16x32_bf16 v[240:243], v[40:43], a[96:99], v[240:243]
    v_mfma_f32_16x16x32_bf16 v[240:243], v[44:47], a[100:103], v[240:243]
    v_mfma_f32_16x16x32_bf16 v[244:247], v[40:43], a[104:107], v[244:247]
    v_mfma_f32_16x16x32_bf16 v[244:247], v[44:47], a[108:111], v[244:247]
    v_mfma_f32_16x16x32_bf16 v[248:251], v[40:43], a[112:115], v[248:251]
    v_mfma_f32_16x16x32_bf16 v[248:251], v[44:47], a[116:119], v[248:251]
    buffer_load_dwordx4 v3, s[12:15], s60 offen offset:1024 nt lds
    v_mfma_f32_16x16x32_bf16 v[252:255], v[40:43], a[120:123], v[252:255]
    ds_read_b64_tr_b16 v[40:41], v16 offset:32768
    ds_read_b64_tr_b16 v[42:43], v16 offset:33792
    v_mfma_f32_16x16x32_bf16 v[252:255], v[44:47], a[124:127], v[252:255]
    ds_read_b64_tr_b16 v[44:45], v16 offset:40960
    ds_read_b64_tr_b16 v[46:47], v16 offset:41984
    v_mfma_f32_16x16x32_bf16 a[128:131], a[64:67], v[48:51], a[128:131]
    v_add_u32 v16, 0x10000, v16
    v_mfma_f32_16x16x32_bf16 a[128:131], a[68:71], v[52:55], a[128:131]
    v_mfma_f32_16x16x32_bf16 a[132:135], a[72:75], v[48:51], a[132:135]
    ds_read_b128 a[32:35], v22 offset:49152
    v_mfma_f32_16x16x32_bf16 a[132:135], a[76:79], v[52:55], a[132:135]
    v_mfma_f32_16x16x32_bf16 a[136:139], a[80:83], v[48:51], a[136:139]
    v_mfma_f32_16x16x32_bf16 a[136:139], a[84:87], v[52:55], a[136:139]
    buffer_load_dwordx4 v4, s[12:15], s60 offen offset:2048 nt lds
    v_mfma_f32_16x16x32_bf16 a[140:143], a[88:91], v[48:51], a[140:143]
    v_mfma_f32_16x16x32_bf16 a[140:143], a[92:95], v[52:55], a[140:143]
    ds_read_b128 a[36:39], v23 offset:49152
    v_mfma_f32_16x16x32_bf16 a[144:147], a[96:99], v[48:51], a[144:147]
    v_mfma_f32_16x16x32_bf16 a[144:147], a[100:103], v[52:55], a[144:147]
    v_mfma_f32_16x16x32_bf16 a[148:151], a[104:107], v[48:51], a[148:151]
    v_mfma_f32_16x16x32_bf16 a[148:151], a[108:111], v[52:55], a[148:151]
    v_mfma_f32_16x16x32_bf16 a[152:155], a[112:115], v[48:51], a[152:155]
    buffer_load_dwordx4 v5, s[12:15], s60 offen offset:3072 nt lds
    v_mfma_f32_16x16x32_bf16 a[152:155], a[116:119], v[52:55], a[152:155]
    ds_read_b128 a[40:43], v22 offset:51200
    v_mfma_f32_16x16x32_bf16 a[156:159], a[120:123], v[48:51], a[156:159]
    ds_read_b64_tr_b16 v[48:49], v17 offset:32768
    ds_read_b64_tr_b16 v[50:51], v17 offset:33792
    v_mfma_f32_16x16x32_bf16 a[156:159], a[124:127], v[52:55], a[156:159]
    s_waitcnt lgkmcnt(3)
    ds_read_b64_tr_b16 v[52:53], v17 offset:40960
    ds_read_b64_tr_b16 v[54:55], v17 offset:41984
    v_mfma_f32_16x16x32_bf16 a[160:163], a[64:67], v[56:59], a[160:163]
    v_add_u32 v17, 0x10000, v17
    v_mfma_f32_16x16x32_bf16 a[160:163], a[68:71], v[60:63], a[160:163]
    v_mfma_f32_16x16x32_bf16 a[164:167], a[72:75], v[56:59], a[164:167]
    ds_read_b128 a[44:47], v23 offset:51200
    v_mfma_f32_16x16x32_bf16 a[164:167], a[76:79], v[60:63], a[164:167]
    s_add_u32 m0, s69, 49152
    v_mfma_f32_16x16x32_bf16 a[168:171], a[80:83], v[56:59], a[168:171]
    buffer_load_dwordx4 v6, s[8:11], s61 offen lds
    v_mfma_f32_16x16x32_bf16 a[168:171], a[84:87], v[60:63], a[168:171]
    v_mfma_f32_16x16x32_bf16 a[172:175], a[88:91], v[56:59], a[172:175]
    v_mfma_f32_16x16x32_bf16 a[172:175], a[92:95], v[60:63], a[172:175]
    v_mfma_f32_16x16x32_bf16 a[176:179], a[96:99], v[56:59], a[176:179]
    buffer_load_dword v107, v103, s[24:27], s77 offen
    v_mfma_f32_16x16x32_bf16 a[176:179], a[100:103], v[60:63], a[176:179]
    s_add_u32 s77, s77, 4608
    ds_read_b128 a[48:51], v22 offset:53248
    v_mfma_f32_16x16x32_bf16 a[180:183], a[104:107], v[56:59], a[180:183]
    v_mfma_f32_16x16x32_bf16 a[180:183], a[108:111], v[60:63], a[180:183]
    buffer_load_dwordx4 v7, s[8:11], s61 offen offset:1024 lds
    v_mfma_f32_16x16x32_bf16 a[184:187], a[112:115], v[56:59], a[184:187]
    v_mfma_f32_16x16x32_bf16 a[184:187], a[116:119], v[60:63], a[184:187]
    ds_read_b128 a[52:55], v23 offset:53248
    v_mfma_f32_16x16x32_bf16 a[188:191], a[120:123], v[56:59], a[188:191]
    v_mfma_f32_16x16x32_bf16 a[188:191], a[124:127], v[60:63], a[188:191]
    v_mfma_f32_16x16x32_bf16 a[192:195], a[64:67], v[40:43], a[192:195]
    v_mfma_f32_16x16x32_bf16 a[192:195], a[68:71], v[44:47], a[192:195]
    v_mfma_f32_16x16x32_bf16 a[196:199], a[72:75], v[40:43], a[196:199]
    v_mfma_f32_16x16x32_bf16 a[196:199], a[76:79], v[44:47], a[196:199]
    buffer_load_dwordx4 v8, s[8:11], s61 offen offset:2048 lds
    v_mfma_f32_16x16x32_bf16 a[200:203], a[80:83], v[40:43], a[200:203]
    ds_read_b128 a[56:59], v22 offset:55296
    v_mfma_f32_16x16x32_bf16 a[200:203], a[84:87], v[44:47], a[200:203]
    v_mfma_f32_16x16x32_bf16 a[204:207], a[88:91], v[40:43], a[204:207]
    v_mfma_f32_16x16x32_bf16 a[204:207], a[92:95], v[44:47], a[204:207]
    v_mfma_f32_16x16x32_bf16 a[208:211], a[96:99], v[40:43], a[208:211]
    ds_read_b128 a[60:63], v23 offset:55296
    v_mfma_f32_16x16x32_bf16 a[208:211], a[100:103], v[44:47], a[208:211]
    v_mfma_f32_16x16x32_bf16 a[212:215], a[104:107], v[40:43], a[212:215]
    buffer_load_dwordx4 v9, s[8:11], s61 offen offset:3072 lds
    v_mfma_f32_16x16x32_bf16 a[212:215], a[108:111], v[44:47], a[212:215]
    v_mfma_f32_16x16x32_bf16 a[216:219], a[112:115], v[40:43], a[216:219]
    v_mfma_f32_16x16x32_bf16 a[216:219], a[116:119], v[44:47], a[216:219]
    v_mfma_f32_16x16x32_bf16 a[220:223], a[120:123], v[40:43], a[220:223]
    v_mfma_f32_16x16x32_bf16 a[220:223], a[124:127], v[44:47], a[220:223]
    s_waitcnt lgkmcnt(0)
    v_mfma_f32_16x16x32_bf16 a[224:227], a[64:67], v[48:51], a[224:227]
    v_mfma_f32_16x16x32_bf16 a[224:227], a[68:71], v[52:55], a[224:227]
    s_xor_b32 s61, s61, 128
    v_mfma_f32_16x16x32_bf16 a[228:231], a[72:75], v[48:51], a[228:231]
    v_mfma_f32_16x16x32_bf16 a[228:231], a[76:79], v[52:55], a[228:231]
    v_mfma_f32_16x16x32_bf16 a[232:235], a[80:83], v[48:51], a[232:235]
    v_mfma_f32_16x16x32_bf16 a[232:235], a[84:87], v[52:55], a[232:235]
    s_waitcnt vmcnt(9) lgkmcnt(0)
    s_barrier
    ds_read_b64_tr_b16 v[56:57], v14 offset:0
    v_mfma_f32_16x16x32_bf16 a[236:239], a[88:91], v[48:51], a[236:239]
    s_add_u32 m0, s69, 65536
    ds_read_b64_tr_b16 v[58:59], v14 offset:1024
    ds_read_b64_tr_b16 v[60:61], v14 offset:8192
    v_mfma_f32_16x16x32_bf16 a[236:239], a[92:95], v[52:55], a[236:239]
    buffer_load_dwordx4 v2, s[16:19], s60 offen nt lds
    v_mfma_f32_16x16x32_bf16 a[240:243], a[96:99], v[48:51], a[240:243]
    ds_read_b64_tr_b16 v[62:63], v14 offset:9216
    ds_read_b64_tr_b16 v[40:41], v15 offset:0
    v_mfma_f32_16x16x32_bf16 a[240:243], a[100:103], v[52:55], a[240:243]
    buffer_atomic_add v31, v30, s[44:47], s95 offen sc1
    v_mfma_f32_16x16x32_bf16 a[244:247], a[104:107], v[48:51], a[244:247]
    ds_read_b64_tr_b16 v[42:43], v15 offset:1024
    ds_read_b64_tr_b16 v[44:45], v15 offset:8192
    v_mfma_f32_16x16x32_bf16 a[244:247], a[108:111], v[52:55], a[244:247]
    ds_read_b64_tr_b16 v[46:47], v15 offset:9216
    v_add_u32 v14, 0xfffe0000, v14
    v_mfma_f32_16x16x32_bf16 a[248:251], a[112:115], v[48:51], a[248:251]
    v_add_u32 v15, 0xfffe0000, v15
    v_mfma_f32_16x16x32_bf16 a[248:251], a[116:119], v[52:55], a[248:251]
    buffer_load_dwordx4 v3, s[16:19], s60 offen offset:1024 nt lds
    v_mfma_f32_16x16x32_bf16 a[252:255], a[120:123], v[48:51], a[252:255]
    ds_read_b64_tr_b16 v[48:49], v16 offset:0
    ds_read_b64_tr_b16 v[50:51], v16 offset:1024
    v_mfma_f32_16x16x32_bf16 a[252:255], a[124:127], v[52:55], a[252:255]
    s_waitcnt lgkmcnt(3)
    ds_read_b64_tr_b16 v[52:53], v16 offset:8192
    ds_read_b64_tr_b16 v[54:55], v16 offset:9216
    v_mfma_f32_16x16x32_bf16 v[128:131], v[56:59], a[0:3], v[128:131]
    v_add_u32 v16, 0xfffe0000, v16
    v_mfma_f32_16x16x32_bf16 v[128:131], v[60:63], a[4:7], v[128:131]
    v_add_u32 v22, 0x10000, v22
    v_mfma_f32_16x16x32_bf16 v[132:135], v[56:59], a[8:11], v[132:135]
    ds_read_b128 a[64:67], v22 offset:16384
    v_mfma_f32_16x16x32_bf16 v[132:135], v[60:63], a[12:15], v[132:135]
    v_mfma_f32_16x16x32_bf16 v[136:139], v[56:59], a[16:19], v[136:139]
    v_mfma_f32_16x16x32_bf16 v[136:139], v[60:63], a[20:23], v[136:139]
    buffer_load_dwordx4 v4, s[16:19], s60 offen offset:2048 nt lds
    v_mfma_f32_16x16x32_bf16 v[140:143], v[56:59], a[24:27], v[140:143]
    v_add_u32 v23, 0x10000, v23
    v_mfma_f32_16x16x32_bf16 v[140:143], v[60:63], a[28:31], v[140:143]
    ds_read_b128 a[68:71], v23 offset:16384
    v_mfma_f32_16x16x32_bf16 v[144:147], v[56:59], a[32:35], v[144:147]
    v_mfma_f32_16x16x32_bf16 v[144:147], v[60:63], a[36:39], v[144:147]
    v_mfma_f32_16x16x32_bf16 v[148:151], v[56:59], a[40:43], v[148:151]
    v_mfma_f32_16x16x32_bf16 v[148:151], v[60:63], a[44:47], v[148:151]
    v_mfma_f32_16x16x32_bf16 v[152:155], v[56:59], a[48:51], v[152:155]
    buffer_load_dwordx4 v5, s[16:19], s60 offen offset:3072 nt lds
    v_mfma_f32_16x16x32_bf16 v[152:155], v[60:63], a[52:55], v[152:155]
    ds_read_b128 a[72:75], v22 offset:18432
    v_mfma_f32_16x16x32_bf16 v[156:159], v[56:59], a[56:59], v[156:159]
    ds_read_b64_tr_b16 v[56:57], v17 offset:0
    ds_read_b64_tr_b16 v[58:59], v17 offset:1024
    v_mfma_f32_16x16x32_bf16 v[156:159], v[60:63], a[60:63], v[156:159]
    ds_read_b64_tr_b16 v[60:61], v17 offset:8192
    ds_read_b64_tr_b16 v[62:63], v17 offset:9216
    v_mfma_f32_16x16x32_bf16 v[160:163], v[40:43], a[0:3], v[160:163]
    s_waitcnt lgkmcnt(5)
    v_add_u32 v17, 0xfffe0000, v17
    v_mfma_f32_16x16x32_bf16 v[160:163], v[44:47], a[4:7], v[160:163]
    v_mfma_f32_16x16x32_bf16 v[164:167], v[40:43], a[8:11], v[164:167]
    ds_read_b128 a[76:79], v23 offset:18432
    v_mfma_f32_16x16x32_bf16 v[164:167], v[44:47], a[12:15], v[164:167]
    s_add_u32 m0, s69, 81920
    v_mfma_f32_16x16x32_bf16 v[168:171], v[40:43], a[16:19], v[168:171]
    s_xor_b32 s60, s60, 1572864
    buffer_load_dwordx4 v6, s[8:11], s62 offen lds
    v_mfma_f32_16x16x32_bf16 v[168:171], v[44:47], a[20:23], v[168:171]
    v_mfma_f32_16x16x32_bf16 v[172:175], v[40:43], a[24:27], v[172:175]
    v_mfma_f32_16x16x32_bf16 v[172:175], v[44:47], a[28:31], v[172:175]
    v_mfma_f32_16x16x32_bf16 v[176:179], v[40:43], a[32:35], v[176:179]
    ds_read_b128 a[80:83], v22 offset:20480
    v_mfma_f32_16x16x32_bf16 v[176:179], v[44:47], a[36:39], v[176:179]
    v_mfma_f32_16x16x32_bf16 v[180:183], v[40:43], a[40:43], v[180:183]
    v_mfma_f32_16x16x32_bf16 v[180:183], v[44:47], a[44:47], v[180:183]
    buffer_load_dwordx4 v7, s[8:11], s62 offen offset:1024 lds
    v_mfma_f32_16x16x32_bf16 v[184:187], v[40:43], a[48:51], v[184:187]
    v_mfma_f32_16x16x32_bf16 v[184:187], v[44:47], a[52:55], v[184:187]
    ds_read_b128 a[84:87], v23 offset:20480
    v_mfma_f32_16x16x32_bf16 v[188:191], v[40:43], a[56:59], v[188:191]
    ds_read_b64_tr_b16 v[40:41], v14 offset:0
    ds_read_b64_tr_b16 v[42:43], v14 offset:1024
    v_mfma_f32_16x16x32_bf16 v[188:191], v[44:47], a[60:63], v[188:191]
    ds_read_b64_tr_b16 v[44:45], v14 offset:8192
    ds_read_b64_tr_b16 v[46:47], v14 offset:9216
    v_mfma_f32_16x16x32_bf16 v[192:195], v[48:51], a[0:3], v[192:195]
    v_mfma_f32_16x16x32_bf16 v[192:195], v[52:55], a[4:7], v[192:195]
    v_mfma_f32_16x16x32_bf16 v[196:199], v[48:51], a[8:11], v[196:199]
    v_mfma_f32_16x16x32_bf16 v[196:199], v[52:55], a[12:15], v[196:199]
    buffer_load_dwordx4 v8, s[8:11], s62 offen offset:2048 lds
    v_mfma_f32_16x16x32_bf16 v[200:203], v[48:51], a[16:19], v[200:203]
    ds_read_b128 a[88:91], v22 offset:22528
    v_mfma_f32_16x16x32_bf16 v[200:203], v[52:55], a[20:23], v[200:203]
    v_mfma_f32_16x16x32_bf16 v[204:207], v[48:51], a[24:27], v[204:207]
    v_mfma_f32_16x16x32_bf16 v[204:207], v[52:55], a[28:31], v[204:207]
    v_mfma_f32_16x16x32_bf16 v[208:211], v[48:51], a[32:35], v[208:211]
    ds_read_b128 a[92:95], v23 offset:22528
    v_mfma_f32_16x16x32_bf16 v[208:211], v[52:55], a[36:39], v[208:211]
    v_mfma_f32_16x16x32_bf16 v[212:215], v[48:51], a[40:43], v[212:215]
    buffer_load_dwordx4 v9, s[8:11], s62 offen offset:3072 lds
    v_mfma_f32_16x16x32_bf16 v[212:215], v[52:55], a[44:47], v[212:215]
    v_mfma_f32_16x16x32_bf16 v[216:219], v[48:51], a[48:51], v[216:219]
    v_mfma_f32_16x16x32_bf16 v[216:219], v[52:55], a[52:55], v[216:219]
    v_mfma_f32_16x16x32_bf16 v[220:223], v[48:51], a[56:59], v[220:223]
    s_waitcnt lgkmcnt(0)
    ds_read_b64_tr_b16 v[48:49], v15 offset:0
    ds_read_b64_tr_b16 v[50:51], v15 offset:1024
    v_mfma_f32_16x16x32_bf16 v[220:223], v[52:55], a[60:63], v[220:223]
    ds_read_b64_tr_b16 v[52:53], v15 offset:8192
    ds_read_b64_tr_b16 v[54:55], v15 offset:9216
    v_mfma_f32_16x16x32_bf16 v[224:227], v[56:59], a[0:3], v[224:227]
    v_mfma_f32_16x16x32_bf16 v[224:227], v[60:63], a[4:7], v[224:227]
    s_xor_b32 s62, s62, 128
    v_mfma_f32_16x16x32_bf16 v[228:231], v[56:59], a[8:11], v[228:231]
    v_mfma_f32_16x16x32_bf16 v[228:231], v[60:63], a[12:15], v[228:231]
    v_mfma_f32_16x16x32_bf16 v[232:235], v[56:59], a[16:19], v[232:235]
    v_mfma_f32_16x16x32_bf16 v[232:235], v[60:63], a[20:23], v[232:235]
    s_add_u32 m0, s69, 98304
    v_mfma_f32_16x16x32_bf16 v[236:239], v[56:59], a[24:27], v[236:239]
    buffer_load_dwordx4 v2, s[12:15], s60 offen nt lds
    v_mfma_f32_16x16x32_bf16 v[236:239], v[60:63], a[28:31], v[236:239]
    v_mfma_f32_16x16x32_bf16 v[240:243], v[56:59], a[32:35], v[240:243]
    v_mfma_f32_16x16x32_bf16 v[240:243], v[60:63], a[36:39], v[240:243]
    v_mfma_f32_16x16x32_bf16 v[244:247], v[56:59], a[40:43], v[244:247]
    v_mfma_f32_16x16x32_bf16 v[244:247], v[60:63], a[44:47], v[244:247]
    v_mfma_f32_16x16x32_bf16 v[248:251], v[56:59], a[48:51], v[248:251]
    v_mfma_f32_16x16x32_bf16 v[248:251], v[60:63], a[52:55], v[248:251]
    buffer_load_dwordx4 v3, s[12:15], s60 offen offset:1024 nt lds
    v_mfma_f32_16x16x32_bf16 v[252:255], v[56:59], a[56:59], v[252:255]
    ds_read_b64_tr_b16 v[56:57], v16 offset:0
    ds_read_b64_tr_b16 v[58:59], v16 offset:1024
    v_mfma_f32_16x16x32_bf16 v[252:255], v[60:63], a[60:63], v[252:255]
    ds_read_b64_tr_b16 v[60:61], v16 offset:8192
    ds_read_b64_tr_b16 v[62:63], v16 offset:9216
    v_mfma_f32_16x16x32_bf16 a[128:131], a[0:3], v[40:43], a[128:131]
    v_mfma_f32_16x16x32_bf16 a[128:131], a[4:7], v[44:47], a[128:131]
    v_add_u32 v22, 0xfffe0000, v22
    v_mfma_f32_16x16x32_bf16 a[132:135], a[8:11], v[40:43], a[132:135]
    ds_read_b128 a[96:99], v22 offset:16384
    v_mfma_f32_16x16x32_bf16 a[132:135], a[12:15], v[44:47], a[132:135]
    v_mfma_f32_16x16x32_bf16 a[136:139], a[16:19], v[40:43], a[136:139]
    v_mfma_f32_16x16x32_bf16 a[136:139], a[20:23], v[44:47], a[136:139]
    buffer_load_dwordx4 v4, s[12:15], s60 offen offset:2048 nt lds
    v_mfma_f32_16x16x32_bf16 a[140:143], a[24:27], v[40:43], a[140:143]
    v_add_u32 v23, 0xfffe0000, v23
    v_mfma_f32_16x16x32_bf16 a[140:143], a[28:31], v[44:47], a[140:143]
    ds_read_b128 a[100:103], v23 offset:16384
    v_mfma_f32_16x16x32_bf16 a[144:147], a[32:35], v[40:43], a[144:147]
    v_mfma_f32_16x16x32_bf16 a[144:147], a[36:39], v[44:47], a[144:147]
    v_mfma_f32_16x16x32_bf16 a[148:151], a[40:43], v[40:43], a[148:151]
    v_mfma_f32_16x16x32_bf16 a[148:151], a[44:47], v[44:47], a[148:151]
    v_mfma_f32_16x16x32_bf16 a[152:155], a[48:51], v[40:43], a[152:155]
    buffer_load_dwordx4 v5, s[12:15], s60 offen offset:3072 nt lds
    v_mfma_f32_16x16x32_bf16 a[152:155], a[52:55], v[44:47], a[152:155]
    ds_read_b128 a[104:107], v22 offset:18432
    v_mfma_f32_16x16x32_bf16 a[156:159], a[56:59], v[40:43], a[156:159]
    ds_read_b64_tr_b16 v[40:41], v17 offset:0
    ds_read_b64_tr_b16 v[42:43], v17 offset:1024
    v_mfma_f32_16x16x32_bf16 a[156:159], a[60:63], v[44:47], a[156:159]
    s_waitcnt lgkmcnt(3)
    ds_read_b64_tr_b16 v[44:45], v17 offset:8192
    ds_read_b64_tr_b16 v[46:47], v17 offset:9216
    v_mfma_f32_16x16x32_bf16 a[160:163], a[0:3], v[48:51], a[160:163]
    v_mfma_f32_16x16x32_bf16 a[160:163], a[4:7], v[52:55], a[160:163]
    v_mfma_f32_16x16x32_bf16 a[164:167], a[8:11], v[48:51], a[164:167]
    ds_read_b128 a[108:111], v23 offset:18432
    v_mfma_f32_16x16x32_bf16 a[164:167], a[12:15], v[52:55], a[164:167]
    s_add_u32 m0, s69, 114688
    v_mfma_f32_16x16x32_bf16 a[168:171], a[16:19], v[48:51], a[168:171]
    buffer_load_dwordx4 v6, s[8:11], s61 offen lds
    v_mfma_f32_16x16x32_bf16 a[168:171], a[20:23], v[52:55], a[168:171]
    v_mfma_f32_16x16x32_bf16 a[172:175], a[24:27], v[48:51], a[172:175]
    v_mfma_f32_16x16x32_bf16 a[172:175], a[28:31], v[52:55], a[172:175]
    v_mfma_f32_16x16x32_bf16 a[176:179], a[32:35], v[48:51], a[176:179]
    ds_read_b128 a[112:115], v22 offset:20480
    v_mfma_f32_16x16x32_bf16 a[176:179], a[36:39], v[52:55], a[176:179]
    v_mfma_f32_16x16x32_bf16 a[180:183], a[40:43], v[48:51], a[180:183]
    v_mfma_f32_16x16x32_bf16 a[180:183], a[44:47], v[52:55], a[180:183]
    buffer_load_dwordx4 v7, s[8:11], s61 offen offset:1024 lds
    v_mfma_f32_16x16x32_bf16 a[184:187], a[48:51], v[48:51], a[184:187]
    v_mfma_f32_16x16x32_bf16 a[184:187], a[52:55], v[52:55], a[184:187]
    ds_read_b128 a[116:119], v23 offset:20480
    v_mfma_f32_16x16x32_bf16 a[188:191], a[56:59], v[48:51], a[188:191]
    v_mfma_f32_16x16x32_bf16 a[188:191], a[60:63], v[52:55], a[188:191]
    v_mfma_f32_16x16x32_bf16 a[192:195], a[0:3], v[56:59], a[192:195]
    v_mfma_f32_16x16x32_bf16 a[192:195], a[4:7], v[60:63], a[192:195]
    v_mfma_f32_16x16x32_bf16 a[196:199], a[8:11], v[56:59], a[196:199]
    v_mfma_f32_16x16x32_bf16 a[196:199], a[12:15], v[60:63], a[196:199]
    buffer_load_dwordx4 v8, s[8:11], s61 offen offset:2048 lds
    v_mfma_f32_16x16x32_bf16 a[200:203], a[16:19], v[56:59], a[200:203]
    ds_read_b128 a[120:123], v22 offset:22528
    v_mfma_f32_16x16x32_bf16 a[200:203], a[20:23], v[60:63], a[200:203]
    buffer_load_dword v108, v103, s[24:27], s77 offen
    v_mfma_f32_16x16x32_bf16 a[204:207], a[24:27], v[56:59], a[204:207]
    s_add_u32 s77, s77, 4608
    v_mfma_f32_16x16x32_bf16 a[204:207], a[28:31], v[60:63], a[204:207]
    v_mfma_f32_16x16x32_bf16 a[208:211], a[32:35], v[56:59], a[208:211]
    ds_read_b128 a[124:127], v23 offset:22528
    v_mfma_f32_16x16x32_bf16 a[208:211], a[36:39], v[60:63], a[208:211]
    v_mfma_f32_16x16x32_bf16 a[212:215], a[40:43], v[56:59], a[212:215]
    buffer_load_dwordx4 v9, s[8:11], s61 offen offset:3072 lds
    v_mfma_f32_16x16x32_bf16 a[212:215], a[44:47], v[60:63], a[212:215]
    v_mfma_f32_16x16x32_bf16 a[216:219], a[48:51], v[56:59], a[216:219]
    v_mfma_f32_16x16x32_bf16 a[216:219], a[52:55], v[60:63], a[216:219]
    v_mfma_f32_16x16x32_bf16 a[220:223], a[56:59], v[56:59], a[220:223]
    v_mfma_f32_16x16x32_bf16 a[220:223], a[60:63], v[60:63], a[220:223]
    s_waitcnt lgkmcnt(0)
    v_mfma_f32_16x16x32_bf16 a[224:227], a[0:3], v[40:43], a[224:227]
    v_mfma_f32_16x16x32_bf16 a[224:227], a[4:7], v[44:47], a[224:227]
    s_xor_b32 s61, s61, 1920
    v_mfma_f32_16x16x32_bf16 a[228:231], a[8:11], v[40:43], a[228:231]
    s_andn2_b32 s61, s61, 896
    v_mfma_f32_16x16x32_bf16 a[228:231], a[12:15], v[44:47], a[228:231]
    s_lshl_b32 s61, s5, 7
    v_mfma_f32_16x16x32_bf16 a[232:235], a[16:19], v[40:43], a[232:235]
    v_mfma_f32_16x16x32_bf16 a[232:235], a[20:23], v[44:47], a[232:235]
    s_waitcnt vmcnt(9) lgkmcnt(0)
    s_barrier
    ds_read_b64_tr_b16 v[48:49], v14 offset:32768
    v_mfma_f32_16x16x32_bf16 a[236:239], a[24:27], v[40:43], a[236:239]
    s_add_u32 m0, s69, 131072
    ds_read_b64_tr_b16 v[50:51], v14 offset:33792
    ds_read_b64_tr_b16 v[52:53], v14 offset:40960
    v_mfma_f32_16x16x32_bf16 a[236:239], a[28:31], v[44:47], a[236:239]
    buffer_load_dwordx4 v2, s[16:19], s60 offen nt lds
    v_mfma_f32_16x16x32_bf16 a[240:243], a[32:35], v[40:43], a[240:243]
    ds_read_b64_tr_b16 v[54:55], v14 offset:41984
    ds_read_b64_tr_b16 v[56:57], v15 offset:32768
    v_mfma_f32_16x16x32_bf16 a[240:243], a[36:39], v[44:47], a[240:243]
    ds_read_b64_tr_b16 v[58:59], v15 offset:33792
    ds_read_b64_tr_b16 v[60:61], v15 offset:40960
    v_mfma_f32_16x16x32_bf16 a[244:247], a[40:43], v[40:43], a[244:247]
    ds_read_b64_tr_b16 v[62:63], v15 offset:41984
    v_add_u32 v14, 0x10000, v14
    v_mfma_f32_16x16x32_bf16 a[244:247], a[44:47], v[44:47], a[244:247]
    v_add_u32 v15, 0x10000, v15
    v_mfma_f32_16x16x32_bf16 a[248:251], a[48:51], v[40:43], a[248:251]
    v_mfma_f32_16x16x32_bf16 a[248:251], a[52:55], v[44:47], a[248:251]
    buffer_load_dwordx4 v3, s[16:19], s60 offen offset:1024 nt lds
    v_mfma_f32_16x16x32_bf16 a[252:255], a[56:59], v[40:43], a[252:255]
    ds_read_b64_tr_b16 v[40:41], v16 offset:32768
    ds_read_b64_tr_b16 v[42:43], v16 offset:33792
    v_mfma_f32_16x16x32_bf16 a[252:255], a[60:63], v[44:47], a[252:255]
    s_waitcnt lgkmcnt(2)
    ds_read_b64_tr_b16 v[44:45], v16 offset:40960
    ds_read_b64_tr_b16 v[46:47], v16 offset:41984
    v_mfma_f32_16x16x32_bf16 v[128:131], v[48:51], a[64:67], v[128:131]
    v_add_u32 v16, 0x10000, v16
    v_mfma_f32_16x16x32_bf16 v[128:131], v[52:55], a[68:71], v[128:131]
    v_mfma_f32_16x16x32_bf16 v[132:135], v[48:51], a[72:75], v[132:135]
    ds_read_b128 a[0:3], v22 offset:49152
    v_mfma_f32_16x16x32_bf16 v[132:135], v[52:55], a[76:79], v[132:135]
    v_mfma_f32_16x16x32_bf16 v[136:139], v[48:51], a[80:83], v[136:139]
    v_mfma_f32_16x16x32_bf16 v[136:139], v[52:55], a[84:87], v[136:139]
    buffer_load_dwordx4 v4, s[16:19], s60 offen offset:2048 nt lds
    v_mfma_f32_16x16x32_bf16 v[140:143], v[48:51], a[88:91], v[140:143]
    v_mfma_f32_16x16x32_bf16 v[140:143], v[52:55], a[92:95], v[140:143]
    ds_read_b128 a[4:7], v23 offset:49152
    v_mfma_f32_16x16x32_bf16 v[144:147], v[48:51], a[96:99], v[144:147]
    v_mfma_f32_16x16x32_bf16 v[144:147], v[52:55], a[100:103], v[144:147]
    v_mfma_f32_16x16x32_bf16 v[148:151], v[48:51], a[104:107], v[148:151]
    v_mfma_f32_16x16x32_bf16 v[148:151], v[52:55], a[108:111], v[148:151]
    v_mfma_f32_16x16x32_bf16 v[152:155], v[48:51], a[112:115], v[152:155]
    buffer_load_dwordx4 v5, s[16:19], s60 offen offset:3072 nt lds
    v_mfma_f32_16x16x32_bf16 v[152:155], v[52:55], a[116:119], v[152:155]
    ds_read_b128 a[8:11], v22 offset:51200
    v_mfma_f32_16x16x32_bf16 v[156:159], v[48:51], a[120:123], v[156:159]
    ds_read_b64_tr_b16 v[48:49], v17 offset:32768
    ds_read_b64_tr_b16 v[50:51], v17 offset:33792
    v_mfma_f32_16x16x32_bf16 v[156:159], v[52:55], a[124:127], v[156:159]
    ds_read_b64_tr_b16 v[52:53], v17 offset:40960
    ds_read_b64_tr_b16 v[54:55], v17 offset:41984
    v_mfma_f32_16x16x32_bf16 v[160:163], v[56:59], a[64:67], v[160:163]
    v_add_u32 v17, 0x10000, v17
    v_mfma_f32_16x16x32_bf16 v[160:163], v[60:63], a[68:71], v[160:163]
    v_mfma_f32_16x16x32_bf16 v[164:167], v[56:59], a[72:75], v[164:167]
    ds_read_b128 a[12:15], v23 offset:51200
    v_mfma_f32_16x16x32_bf16 v[164:167], v[60:63], a[76:79], v[164:167]
    s_add_u32 m0, s69, 147456
    v_mfma_f32_16x16x32_bf16 v[168:171], v[56:59], a[80:83], v[168:171]
    s_xor_b32 s60, s60, 524288
    buffer_load_dwordx4 v6, s[8:11], s62 offen lds
    v_mfma_f32_16x16x32_bf16 v[168:171], v[60:63], a[84:87], v[168:171]
    v_mov_b32 v6, v96
    v_mfma_f32_16x16x32_bf16 v[172:175], v[56:59], a[88:91], v[172:175]
    v_mfma_f32_16x16x32_bf16 v[172:175], v[60:63], a[92:95], v[172:175]
    v_mfma_f32_16x16x32_bf16 v[176:179], v[56:59], a[96:99], v[176:179]
    ds_read_b128 a[16:19], v22 offset:53248
    v_mfma_f32_16x16x32_bf16 v[176:179], v[60:63], a[100:103], v[176:179]
    v_mfma_f32_16x16x32_bf16 v[180:183], v[56:59], a[104:107], v[180:183]
    v_mfma_f32_16x16x32_bf16 v[180:183], v[60:63], a[108:111], v[180:183]
    buffer_load_dwordx4 v7, s[8:11], s62 offen offset:1024 lds
    v_mfma_f32_16x16x32_bf16 v[184:187], v[56:59], a[112:115], v[184:187]
    v_mfma_f32_16x16x32_bf16 v[184:187], v[60:63], a[116:119], v[184:187]
    ds_read_b128 a[20:23], v23 offset:53248
    v_mfma_f32_16x16x32_bf16 v[188:191], v[56:59], a[120:123], v[188:191]
    s_waitcnt lgkmcnt(1)
    ds_read_b64_tr_b16 v[56:57], v14 offset:0
    ds_read_b64_tr_b16 v[58:59], v14 offset:1024
    v_mfma_f32_16x16x32_bf16 v[188:191], v[60:63], a[124:127], v[188:191]
    ds_read_b64_tr_b16 v[60:61], v14 offset:8192
    ds_read_b64_tr_b16 v[62:63], v14 offset:9216
    v_mfma_f32_16x16x32_bf16 v[192:195], v[40:43], a[64:67], v[192:195]
    v_mfma_f32_16x16x32_bf16 v[192:195], v[44:47], a[68:71], v[192:195]
    v_mfma_f32_16x16x32_bf16 v[196:199], v[40:43], a[72:75], v[196:199]
    v_mfma_f32_16x16x32_bf16 v[196:199], v[44:47], a[76:79], v[196:199]
    buffer_load_dwordx4 v8, s[8:11], s62 offen offset:2048 lds
    v_mfma_f32_16x16x32_bf16 v[200:203], v[40:43], a[80:83], v[200:203]
    ds_read_b128 a[24:27], v22 offset:55296
    v_bfe_u32 v8, v1, 4, 3
    v_mfma_f32_16x16x32_bf16 v[200:203], v[44:47], a[84:87], v[200:203]
    v_lshlrev_b32 v8, 12, v8
    v_mfma_f32_16x16x32_bf16 v[204:207], v[40:43], a[88:91], v[204:207]
    v_mfma_f32_16x16x32_bf16 v[204:207], v[44:47], a[92:95], v[204:207]
    v_mfma_f32_16x16x32_bf16 v[208:211], v[40:43], a[96:99], v[208:211]
    ds_read_b128 a[28:31], v23 offset:55296
    v_mfma_f32_16x16x32_bf16 v[208:211], v[44:47], a[100:103], v[208:211]
    v_mfma_f32_16x16x32_bf16 v[212:215], v[40:43], a[104:107], v[212:215]
    buffer_load_dwordx4 v9, s[8:11], s62 offen offset:3072 lds
    v_mfma_f32_16x16x32_bf16 v[212:215], v[44:47], a[108:111], v[212:215]
    v_lshrrev_b32 v9, 2, v1
    v_mfma_f32_16x16x32_bf16 v[216:219], v[40:43], a[112:115], v[216:219]
    v_mfma_f32_16x16x32_bf16 v[216:219], v[44:47], a[116:119], v[216:219]
    v_mfma_f32_16x16x32_bf16 v[220:223], v[40:43], a[120:123], v[220:223]
    ds_read_b64_tr_b16 v[40:41], v15 offset:0
    ds_read_b64_tr_b16 v[42:43], v15 offset:1024
    v_mfma_f32_16x16x32_bf16 v[220:223], v[44:47], a[124:127], v[220:223]
    ds_read_b64_tr_b16 v[44:45], v15 offset:8192
    ds_read_b64_tr_b16 v[46:47], v15 offset:9216
    v_mfma_f32_16x16x32_bf16 v[224:227], v[48:51], a[64:67], v[224:227]
    v_mfma_f32_16x16x32_bf16 v[224:227], v[52:55], a[68:71], v[224:227]
    s_xor_b32 s62, s62, 1920
    v_mfma_f32_16x16x32_bf16 v[228:231], v[48:51], a[72:75], v[228:231]
    s_andn2_b32 s62, s62, 896
    v_mfma_f32_16x16x32_bf16 v[228:231], v[52:55], a[76:79], v[228:231]
    v_mfma_f32_16x16x32_bf16 v[232:235], v[48:51], a[80:83], v[232:235]
    v_mfma_f32_16x16x32_bf16 v[232:235], v[52:55], a[84:87], v[232:235]
    s_add_u32 m0, s69, 0
    v_mfma_f32_16x16x32_bf16 v[236:239], v[48:51], a[88:91], v[236:239]
    buffer_load_dwordx4 v2, s[12:15], s60 offen nt lds
    v_mfma_f32_16x16x32_bf16 v[236:239], v[52:55], a[92:95], v[236:239]
    v_mfma_f32_16x16x32_bf16 v[240:243], v[48:51], a[96:99], v[240:243]
    v_mfma_f32_16x16x32_bf16 v[240:243], v[52:55], a[100:103], v[240:243]
    v_mfma_f32_16x16x32_bf16 v[244:247], v[48:51], a[104:107], v[244:247]
    v_mfma_f32_16x16x32_bf16 v[244:247], v[52:55], a[108:111], v[244:247]
    v_mfma_f32_16x16x32_bf16 v[248:251], v[48:51], a[112:115], v[248:251]
    v_mfma_f32_16x16x32_bf16 v[248:251], v[52:55], a[116:119], v[248:251]
    buffer_load_dwordx4 v3, s[12:15], s60 offen offset:1024 nt lds
    v_mfma_f32_16x16x32_bf16 v[252:255], v[48:51], a[120:123], v[252:255]
    ds_read_b64_tr_b16 v[48:49], v16 offset:0
    ds_read_b64_tr_b16 v[50:51], v16 offset:1024
    v_mfma_f32_16x16x32_bf16 v[252:255], v[52:55], a[124:127], v[252:255]
    s_waitcnt lgkmcnt(2)
    ds_read_b64_tr_b16 v[52:53], v16 offset:8192
    ds_read_b64_tr_b16 v[54:55], v16 offset:9216
    v_mfma_f32_16x16x32_bf16 a[128:131], a[64:67], v[56:59], a[128:131]
    v_mfma_f32_16x16x32_bf16 a[128:131], a[68:71], v[60:63], a[128:131]
    v_add_u32 v22, 0x10000, v22
    v_mfma_f32_16x16x32_bf16 a[132:135], a[72:75], v[56:59], a[132:135]
    ds_read_b128 a[32:35], v22 offset:16384
    v_mfma_f32_16x16x32_bf16 a[132:135], a[76:79], v[60:63], a[132:135]
    v_mfma_f32_16x16x32_bf16 a[136:139], a[80:83], v[56:59], a[136:139]
    v_mfma_f32_16x16x32_bf16 a[136:139], a[84:87], v[60:63], a[136:139]
    buffer_load_dwordx4 v4, s[12:15], s60 offen offset:2048 nt lds
    v_mfma_f32_16x16x32_bf16 a[140:143], a[88:91], v[56:59], a[140:143]
    v_add_u32 v23, 0x10000, v23
    v_mfma_f32_16x16x32_bf16 a[140:143], a[92:95], v[60:63], a[140:143]
    ds_read_b128 a[36:39], v23 offset:16384
    v_mfma_f32_16x16x32_bf16 a[144:147], a[96:99], v[56:59], a[144:147]
    v_mfma_f32_16x16x32_bf16 a[144:147], a[100:103], v[60:63], a[144:147]
    v_mfma_f32_16x16x32_bf16 a[148:151], a[104:107], v[56:59], a[148:151]
    v_mfma_f32_16x16x32_bf16 a[148:151], a[108:111], v[60:63], a[148:151]
    v_mfma_f32_16x16x32_bf16 a[152:155], a[112:115], v[56:59], a[152:155]
    buffer_load_dwordx4 v5, s[12:15], s60 offen offset:3072 nt lds
    v_mfma_f32_16x16x32_bf16 a[152:155], a[116:119], v[60:63], a[152:155]
    ds_read_b128 a[40:43], v22 offset:18432
    v_mfma_f32_16x16x32_bf16 a[156:159], a[120:123], v[56:59], a[156:159]
    ds_read_b64_tr_b16 v[56:57], v17 offset:0
    ds_read_b64_tr_b16 v[58:59], v17 offset:1024
    v_mfma_f32_16x16x32_bf16 a[156:159], a[124:127], v[60:63], a[156:159]
    ds_read_b64_tr_b16 v[60:61], v17 offset:8192
    ds_read_b64_tr_b16 v[62:63], v17 offset:9216
    v_mfma_f32_16x16x32_bf16 a[160:163], a[64:67], v[40:43], a[160:163]
    v_mfma_f32_16x16x32_bf16 a[160:163], a[68:71], v[44:47], a[160:163]
    v_mfma_f32_16x16x32_bf16 a[164:167], a[72:75], v[40:43], a[164:167]
    ds_read_b128 a[44:47], v23 offset:18432
    v_mfma_f32_16x16x32_bf16 a[164:167], a[76:79], v[44:47], a[164:167]
    s_add_u32 m0, s69, 16384
    v_mfma_f32_16x16x32_bf16 a[168:171], a[80:83], v[40:43], a[168:171]
    buffer_load_dwordx4 v10, s[20:23], s63 offen lds
    v_mfma_f32_16x16x32_bf16 a[168:171], a[84:87], v[44:47], a[168:171]
    v_mfma_f32_16x16x32_bf16 a[172:175], a[88:91], v[40:43], a[172:175]
    v_mfma_f32_16x16x32_bf16 a[172:175], a[92:95], v[44:47], a[172:175]
    v_mfma_f32_16x16x32_bf16 a[176:179], a[96:99], v[40:43], a[176:179]
    ds_read_b128 a[48:51], v22 offset:20480
    v_mfma_f32_16x16x32_bf16 a[176:179], a[100:103], v[44:47], a[176:179]
    v_mfma_f32_16x16x32_bf16 a[180:183], a[104:107], v[40:43], a[180:183]
    v_mfma_f32_16x16x32_bf16 a[180:183], a[108:111], v[44:47], a[180:183]
    buffer_load_dwordx4 v11, s[20:23], s63 offen offset:1024 lds
    v_mfma_f32_16x16x32_bf16 a[184:187], a[112:115], v[40:43], a[184:187]
    v_mfma_f32_16x16x32_bf16 a[184:187], a[116:119], v[44:47], a[184:187]
    ds_read_b128 a[52:55], v23 offset:20480
    v_mfma_f32_16x16x32_bf16 a[188:191], a[120:123], v[40:43], a[188:191]
    v_mfma_f32_16x16x32_bf16 a[188:191], a[124:127], v[44:47], a[188:191]
    s_waitcnt lgkmcnt(1)
    v_mfma_f32_16x16x32_bf16 a[192:195], a[64:67], v[48:51], a[192:195]
    v_mfma_f32_16x16x32_bf16 a[192:195], a[68:71], v[52:55], a[192:195]
    v_mfma_f32_16x16x32_bf16 a[196:199], a[72:75], v[48:51], a[196:199]
    v_mfma_f32_16x16x32_bf16 a[196:199], a[76:79], v[52:55], a[196:199]
    buffer_load_dwordx4 v12, s[20:23], s63 offen offset:2048 lds
    v_mfma_f32_16x16x32_bf16 a[200:203], a[80:83], v[48:51], a[200:203]
    ds_read_b128 a[56:59], v22 offset:22528
    v_mfma_f32_16x16x32_bf16 a[200:203], a[84:87], v[52:55], a[200:203]
    v_mfma_f32_16x16x32_bf16 a[204:207], a[88:91], v[48:51], a[204:207]
    v_mfma_f32_16x16x32_bf16 a[204:207], a[92:95], v[52:55], a[204:207]
    v_mfma_f32_16x16x32_bf16 a[208:211], a[96:99], v[48:51], a[208:211]
    ds_read_b128 a[60:63], v23 offset:22528
    v_mfma_f32_16x16x32_bf16 a[208:211], a[100:103], v[52:55], a[208:211]
    v_mfma_f32_16x16x32_bf16 a[212:215], a[104:107], v[48:51], a[212:215]
    buffer_load_dwordx4 v13, s[20:23], s63 offen offset:3072 lds
    v_mfma_f32_16x16x32_bf16 a[212:215], a[108:111], v[52:55], a[212:215]
    v_mfma_f32_16x16x32_bf16 a[216:219], a[112:115], v[48:51], a[216:219]
    v_mfma_f32_16x16x32_bf16 a[216:219], a[116:119], v[52:55], a[216:219]
    v_mfma_f32_16x16x32_bf16 a[220:223], a[120:123], v[48:51], a[220:223]
    v_mfma_f32_16x16x32_bf16 a[220:223], a[124:127], v[52:55], a[220:223]
    v_mfma_f32_16x16x32_bf16 a[224:227], a[64:67], v[56:59], a[224:227]
    v_mfma_f32_16x16x32_bf16 a[224:227], a[68:71], v[60:63], a[224:227]
    s_xor_b32 s63, s63, 128
    v_mfma_f32_16x16x32_bf16 a[228:231], a[72:75], v[56:59], a[228:231]
    buffer_load_dword v109, v103, s[24:27], s77 offen
    v_mfma_f32_16x16x32_bf16 a[228:231], a[76:79], v[60:63], a[228:231]
    v_mfma_f32_16x16x32_bf16 a[232:235], a[80:83], v[56:59], a[232:235]
    v_mfma_f32_16x16x32_bf16 a[232:235], a[84:87], v[60:63], a[232:235]
    s_waitcnt vmcnt(9) lgkmcnt(0)
    s_barrier
    ds_read_b64_tr_b16 v[40:41], v14 offset:32768
    v_mfma_f32_16x16x32_bf16 a[236:239], a[88:91], v[56:59], a[236:239]
    s_add_u32 m0, s69, 32768
    ds_read_b64_tr_b16 v[42:43], v14 offset:33792
    ds_read_b64_tr_b16 v[44:45], v14 offset:40960
    v_mfma_f32_16x16x32_bf16 a[236:239], a[92:95], v[60:63], a[236:239]
    buffer_load_dwordx4 v2, s[16:19], s60 offen nt lds
    v_mfma_f32_16x16x32_bf16 a[240:243], a[96:99], v[56:59], a[240:243]
    ds_read_b64_tr_b16 v[46:47], v14 offset:41984
    ds_read_b64_tr_b16 v[48:49], v15 offset:32768
    v_mfma_f32_16x16x32_bf16 a[240:243], a[100:103], v[60:63], a[240:243]
    ds_read_b64_tr_b16 v[50:51], v15 offset:33792
    ds_read_b64_tr_b16 v[52:53], v15 offset:40960
    v_mfma_f32_16x16x32_bf16 a[244:247], a[104:107], v[56:59], a[244:247]
    ds_read_b64_tr_b16 v[54:55], v15 offset:41984
    v_add_u32 v14, 0x10000, v14
    v_mfma_f32_16x16x32_bf16 a[244:247], a[108:111], v[60:63], a[244:247]
    v_add_u32 v15, 0x10000, v15
    v_mfma_f32_16x16x32_bf16 a[248:251], a[112:115], v[56:59], a[248:251]
    v_mfma_f32_16x16x32_bf16 a[248:251], a[116:119], v[60:63], a[248:251]
    buffer_load_dwordx4 v3, s[16:19], s60 offen offset:1024 nt lds
    v_mfma_f32_16x16x32_bf16 a[252:255], a[120:123], v[56:59], a[252:255]
    ds_read_b64_tr_b16 v[56:57], v16 offset:32768
    ds_read_b64_tr_b16 v[58:59], v16 offset:33792
    v_mfma_f32_16x16x32_bf16 a[252:255], a[124:127], v[60:63], a[252:255]
    s_waitcnt lgkmcnt(2)
    ds_read_b64_tr_b16 v[60:61], v16 offset:40960
    ds_read_b64_tr_b16 v[62:63], v16 offset:41984
    v_mfma_f32_16x16x32_bf16 v[128:131], v[40:43], a[0:3], v[128:131]
    v_add_u32 v16, 0x10000, v16
    v_mfma_f32_16x16x32_bf16 v[128:131], v[44:47], a[4:7], v[128:131]
    v_mfma_f32_16x16x32_bf16 v[132:135], v[40:43], a[8:11], v[132:135]
    ds_read_b128 a[64:67], v22 offset:49152
    v_mfma_f32_16x16x32_bf16 v[132:135], v[44:47], a[12:15], v[132:135]
    v_mfma_f32_16x16x32_bf16 v[136:139], v[40:43], a[16:19], v[136:139]
    v_mfma_f32_16x16x32_bf16 v[136:139], v[44:47], a[20:23], v[136:139]
    buffer_load_dwordx4 v4, s[16:19], s60 offen offset:2048 nt lds
    v_mfma_f32_16x16x32_bf16 v[140:143], v[40:43], a[24:27], v[140:143]
    v_mfma_f32_16x16x32_bf16 v[140:143], v[44:47], a[28:31], v[140:143]
    ds_read_b128 a[68:71], v23 offset:49152
    v_mfma_f32_16x16x32_bf16 v[144:147], v[40:43], a[32:35], v[144:147]
    v_mfma_f32_16x16x32_bf16 v[144:147], v[44:47], a[36:39], v[144:147]
    v_mfma_f32_16x16x32_bf16 v[148:151], v[40:43], a[40:43], v[148:151]
    v_mfma_f32_16x16x32_bf16 v[148:151], v[44:47], a[44:47], v[148:151]
    v_mfma_f32_16x16x32_bf16 v[152:155], v[40:43], a[48:51], v[152:155]
    buffer_load_dwordx4 v5, s[16:19], s60 offen offset:3072 nt lds
    v_mfma_f32_16x16x32_bf16 v[152:155], v[44:47], a[52:55], v[152:155]
    ds_read_b128 a[72:75], v22 offset:51200
    v_mfma_f32_16x16x32_bf16 v[156:159], v[40:43], a[56:59], v[156:159]
    ds_read_b64_tr_b16 v[40:41], v17 offset:32768
    ds_read_b64_tr_b16 v[42:43], v17 offset:33792
    v_mfma_f32_16x16x32_bf16 v[156:159], v[44:47], a[60:63], v[156:159]
    ds_read_b64_tr_b16 v[44:45], v17 offset:40960
    ds_read_b64_tr_b16 v[46:47], v17 offset:41984
    v_mfma_f32_16x16x32_bf16 v[160:163], v[48:51], a[0:3], v[160:163]
    v_add_u32 v17, 0x10000, v17
    v_mfma_f32_16x16x32_bf16 v[160:163], v[52:55], a[4:7], v[160:163]
    v_mfma_f32_16x16x32_bf16 v[164:167], v[48:51], a[8:11], v[164:167]
    ds_read_b128 a[76:79], v23 offset:51200
    v_mfma_f32_16x16x32_bf16 v[164:167], v[52:55], a[12:15], v[164:167]
    s_add_u32 m0, s69, 49152
    buffer_load_dword v7, v9, s[44:47], s69 offen sc1
    v_mfma_f32_16x16x32_bf16 v[168:171], v[48:51], a[16:19], v[168:171]
    s_xor_b32 s60, s60, 3670016
    buffer_load_dwordx4 v10, s[20:23], s64 offen lds
    v_mfma_f32_16x16x32_bf16 v[168:171], v[52:55], a[20:23], v[168:171]
    v_mfma_f32_16x16x32_bf16 v[172:175], v[48:51], a[24:27], v[172:175]
    v_mfma_f32_16x16x32_bf16 v[172:175], v[52:55], a[28:31], v[172:175]
    v_mfma_f32_16x16x32_bf16 v[176:179], v[48:51], a[32:35], v[176:179]
    ds_read_b128 a[80:83], v22 offset:53248
    v_mfma_f32_16x16x32_bf16 v[176:179], v[52:55], a[36:39], v[176:179]
    v_mfma_f32_16x16x32_bf16 v[180:183], v[48:51], a[40:43], v[180:183]
    v_mfma_f32_16x16x32_bf16 v[180:183], v[52:55], a[44:47], v[180:183]
    buffer_load_dwordx4 v11, s[20:23], s64 offen offset:1024 lds
    v_mfma_f32_16x16x32_bf16 v[184:187], v[48:51], a[48:51], v[184:187]
    v_mfma_f32_16x16x32_bf16 v[184:187], v[52:55], a[52:55], v[184:187]
    ds_read_b128 a[84:87], v23 offset:53248
    v_mfma_f32_16x16x32_bf16 v[188:191], v[48:51], a[56:59], v[188:191]
    s_waitcnt lgkmcnt(1)
    ds_read_b64_tr_b16 v[48:49], v14 offset:0
    ds_read_b64_tr_b16 v[50:51], v14 offset:1024
    v_mfma_f32_16x16x32_bf16 v[188:191], v[52:55], a[60:63], v[188:191]
    ds_read_b64_tr_b16 v[52:53], v14 offset:8192
    ds_read_b64_tr_b16 v[54:55], v14 offset:9216
    v_mfma_f32_16x16x32_bf16 v[192:195], v[56:59], a[0:3], v[192:195]
    v_add_u32 v14, 0xfffe0000, v14
    v_mfma_f32_16x16x32_bf16 v[192:195], v[60:63], a[4:7], v[192:195]
    v_mfma_f32_16x16x32_bf16 v[196:199], v[56:59], a[8:11], v[196:199]
    v_mfma_f32_16x16x32_bf16 v[196:199], v[60:63], a[12:15], v[196:199]
    buffer_load_dwordx4 v12, s[20:23], s64 offen offset:2048 lds
    v_mfma_f32_16x16x32_bf16 v[200:203], v[56:59], a[16:19], v[200:203]
    ds_read_b128 a[88:91], v22 offset:55296
    v_mfma_f32_16x16x32_bf16 v[200:203], v[60:63], a[20:23], v[200:203]
    v_mfma_f32_16x16x32_bf16 v[204:207], v[56:59], a[24:27], v[204:207]
    v_mfma_f32_16x16x32_bf16 v[204:207], v[60:63], a[28:31], v[204:207]
    v_mfma_f32_16x16x32_bf16 v[208:211], v[56:59], a[32:35], v[208:211]
    ds_read_b128 a[92:95], v23 offset:55296
    v_mfma_f32_16x16x32_bf16 v[208:211], v[60:63], a[36:39], v[208:211]
    v_mfma_f32_16x16x32_bf16 v[212:215], v[56:59], a[40:43], v[212:215]
    buffer_load_dwordx4 v13, s[20:23], s64 offen offset:3072 lds
    v_mfma_f32_16x16x32_bf16 v[212:215], v[60:63], a[44:47], v[212:215]
    v_mfma_f32_16x16x32_bf16 v[216:219], v[56:59], a[48:51], v[216:219]
    v_mfma_f32_16x16x32_bf16 v[216:219], v[60:63], a[52:55], v[216:219]
    v_mfma_f32_16x16x32_bf16 v[220:223], v[56:59], a[56:59], v[220:223]
    ds_read_b64_tr_b16 v[56:57], v15 offset:0
    ds_read_b64_tr_b16 v[58:59], v15 offset:1024
    v_mfma_f32_16x16x32_bf16 v[220:223], v[60:63], a[60:63], v[220:223]
    ds_read_b64_tr_b16 v[60:61], v15 offset:8192
    ds_read_b64_tr_b16 v[62:63], v15 offset:9216
    v_mfma_f32_16x16x32_bf16 v[224:227], v[40:43], a[0:3], v[224:227]
    v_add_u32 v15, 0xfffe0000, v15
    v_mfma_f32_16x16x32_bf16 v[224:227], v[44:47], a[4:7], v[224:227]
    s_xor_b32 s64, s64, 128
    v_mfma_f32_16x16x32_bf16 v[228:231], v[40:43], a[8:11], v[228:231]
    v_mfma_f32_16x16x32_bf16 v[228:231], v[44:47], a[12:15], v[228:231]
    v_mfma_f32_16x16x32_bf16 v[232:235], v[40:43], a[16:19], v[232:235]
    v_mfma_f32_16x16x32_bf16 v[232:235], v[44:47], a[20:23], v[232:235]
    s_add_u32 m0, s69, 65536
    v_mfma_f32_16x16x32_bf16 v[236:239], v[40:43], a[24:27], v[236:239]
    buffer_load_dwordx4 v2, s[24:27], s60 offen lds
    v_mfma_f32_16x16x32_bf16 v[236:239], v[44:47], a[28:31], v[236:239]
    v_mfma_f32_16x16x32_bf16 v[240:243], v[40:43], a[32:35], v[240:243]
    v_mfma_f32_16x16x32_bf16 v[240:243], v[44:47], a[36:39], v[240:243]
    v_mfma_f32_16x16x32_bf16 v[244:247], v[40:43], a[40:43], v[244:247]
    v_mfma_f32_16x16x32_bf16 v[244:247], v[44:47], a[44:47], v[244:247]
    v_mfma_f32_16x16x32_bf16 v[248:251], v[40:43], a[48:51], v[248:251]
    v_mfma_f32_16x16x32_bf16 v[248:251], v[44:47], a[52:55], v[248:251]
    buffer_load_dwordx4 v3, s[24:27], s60 offen offset:1024 lds
    v_mfma_f32_16x16x32_bf16 v[252:255], v[40:43], a[56:59], v[252:255]
    ds_read_b64_tr_b16 v[40:41], v16 offset:0
    ds_read_b64_tr_b16 v[42:43], v16 offset:1024
    v_mfma_f32_16x16x32_bf16 v[252:255], v[44:47], a[60:63], v[252:255]
    s_waitcnt lgkmcnt(2)
    ds_read_b64_tr_b16 v[44:45], v16 offset:8192
    ds_read_b64_tr_b16 v[46:47], v16 offset:9216
    v_mfma_f32_16x16x32_bf16 a[128:131], a[0:3], v[48:51], a[128:131]
    v_add_u32 v16, 0xfffe0000, v16
    v_mfma_f32_16x16x32_bf16 a[128:131], a[4:7], v[52:55], a[128:131]
    v_add_u32 v22, 0x10000, v22
    v_mfma_f32_16x16x32_bf16 a[132:135], a[8:11], v[48:51], a[132:135]
    ds_read_b128 a[96:99], v22 offset:16384
    v_mfma_f32_16x16x32_bf16 a[132:135], a[12:15], v[52:55], a[132:135]
    v_mfma_f32_16x16x32_bf16 a[136:139], a[16:19], v[48:51], a[136:139]
    v_mfma_f32_16x16x32_bf16 a[136:139], a[20:23], v[52:55], a[136:139]
    buffer_load_dwordx4 v4, s[24:27], s60 offen offset:2048 lds
    v_mfma_f32_16x16x32_bf16 a[140:143], a[24:27], v[48:51], a[140:143]
    v_add_u32 v23, 0x10000, v23
    v_mfma_f32_16x16x32_bf16 a[140:143], a[28:31], v[52:55], a[140:143]
    ds_read_b128 a[100:103], v23 offset:16384
    v_mfma_f32_16x16x32_bf16 a[144:147], a[32:35], v[48:51], a[144:147]
    v_mfma_f32_16x16x32_bf16 a[144:147], a[36:39], v[52:55], a[144:147]
    v_mfma_f32_16x16x32_bf16 a[148:151], a[40:43], v[48:51], a[148:151]
    v_mfma_f32_16x16x32_bf16 a[148:151], a[44:47], v[52:55], a[148:151]
    v_mfma_f32_16x16x32_bf16 a[152:155], a[48:51], v[48:51], a[152:155]
    buffer_load_dwordx4 v5, s[24:27], s60 offen offset:3072 lds
    v_mfma_f32_16x16x32_bf16 a[152:155], a[52:55], v[52:55], a[152:155]
    ds_read_b128 a[104:107], v22 offset:18432
    v_mfma_f32_16x16x32_bf16 a[156:159], a[56:59], v[48:51], a[156:159]
    ds_read_b64_tr_b16 v[48:49], v17 offset:0
    ds_read_b64_tr_b16 v[50:51], v17 offset:1024
    v_mfma_f32_16x16x32_bf16 a[156:159], a[60:63], v[52:55], a[156:159]
    ds_read_b64_tr_b16 v[52:53], v17 offset:8192
    ds_read_b64_tr_b16 v[54:55], v17 offset:9216
    v_mfma_f32_16x16x32_bf16 a[160:163], a[0:3], v[56:59], a[160:163]
    v_add_u32 v17, 0xfffe0000, v17
    v_mfma_f32_16x16x32_bf16 a[160:163], a[4:7], v[60:63], a[160:163]
    v_mfma_f32_16x16x32_bf16 a[164:167], a[8:11], v[56:59], a[164:167]
    ds_read_b128 a[108:111], v23 offset:18432
    v_mfma_f32_16x16x32_bf16 a[164:167], a[12:15], v[60:63], a[164:167]
    s_add_u32 m0, s69, 81920
    v_mfma_f32_16x16x32_bf16 a[168:171], a[16:19], v[56:59], a[168:171]
    s_xor_b32 s60, s60, 524288
    buffer_load_dwordx4 v10, s[20:23], s63 offen lds
    v_mfma_f32_16x16x32_bf16 a[168:171], a[20:23], v[60:63], a[168:171]
    v_mfma_f32_16x16x32_bf16 a[172:175], a[24:27], v[56:59], a[172:175]
    v_mfma_f32_16x16x32_bf16 a[172:175], a[28:31], v[60:63], a[172:175]
    v_mfma_f32_16x16x32_bf16 a[176:179], a[32:35], v[56:59], a[176:179]
    ds_read_b128 a[112:115], v22 offset:20480
    v_mfma_f32_16x16x32_bf16 a[176:179], a[36:39], v[60:63], a[176:179]
    v_mfma_f32_16x16x32_bf16 a[180:183], a[40:43], v[56:59], a[180:183]
    v_mfma_f32_16x16x32_bf16 a[180:183], a[44:47], v[60:63], a[180:183]
    buffer_load_dwordx4 v11, s[20:23], s63 offen offset:1024 lds
    v_mfma_f32_16x16x32_bf16 a[184:187], a[48:51], v[56:59], a[184:187]
    v_mfma_f32_16x16x32_bf16 a[184:187], a[52:55], v[60:63], a[184:187]
    ds_read_b128 a[116:119], v23 offset:20480
    v_mfma_f32_16x16x32_bf16 a[188:191], a[56:59], v[56:59], a[188:191]
    v_mfma_f32_16x16x32_bf16 a[188:191], a[60:63], v[60:63], a[188:191]
    s_waitcnt lgkmcnt(1)
    v_mfma_f32_16x16x32_bf16 a[192:195], a[0:3], v[40:43], a[192:195]
    v_mfma_f32_16x16x32_bf16 a[192:195], a[4:7], v[44:47], a[192:195]
    v_mfma_f32_16x16x32_bf16 a[196:199], a[8:11], v[40:43], a[196:199]
    v_mfma_f32_16x16x32_bf16 a[196:199], a[12:15], v[44:47], a[196:199]
    buffer_load_dwordx4 v12, s[20:23], s63 offen offset:2048 lds
    v_mfma_f32_16x16x32_bf16 a[200:203], a[16:19], v[40:43], a[200:203]
    ds_read_b128 a[120:123], v22 offset:22528
    v_mov_b32 v22, v100
    v_mfma_f32_16x16x32_bf16 a[200:203], a[20:23], v[44:47], a[200:203]
    v_add_u32 v22, 0x10000, v22
    v_mfma_f32_16x16x32_bf16 a[204:207], a[24:27], v[40:43], a[204:207]
    v_mfma_f32_16x16x32_bf16 a[204:207], a[28:31], v[44:47], a[204:207]
    v_mfma_f32_16x16x32_bf16 a[208:211], a[32:35], v[40:43], a[208:211]
    ds_read_b128 a[124:127], v23 offset:22528
    v_mov_b32 v23, v101
    v_mfma_f32_16x16x32_bf16 a[208:211], a[36:39], v[44:47], a[208:211]
    v_add_u32 v23, 0x10000, v23
    v_mfma_f32_16x16x32_bf16 a[212:215], a[40:43], v[40:43], a[212:215]
    buffer_load_dwordx4 v13, s[20:23], s63 offen offset:3072 lds
    v_mfma_f32_16x16x32_bf16 a[212:215], a[44:47], v[44:47], a[212:215]
    v_mfma_f32_16x16x32_bf16 a[216:219], a[48:51], v[40:43], a[216:219]
    v_mfma_f32_16x16x32_bf16 a[216:219], a[52:55], v[44:47], a[216:219]
    v_mfma_f32_16x16x32_bf16 a[220:223], a[56:59], v[40:43], a[220:223]
    v_mfma_f32_16x16x32_bf16 a[220:223], a[60:63], v[44:47], a[220:223]
    v_mfma_f32_16x16x32_bf16 a[224:227], a[0:3], v[48:51], a[224:227]
    v_mfma_f32_16x16x32_bf16 a[224:227], a[4:7], v[52:55], a[224:227]
    s_xor_b32 s63, s63, 384
    v_mfma_f32_16x16x32_bf16 a[228:231], a[8:11], v[48:51], a[228:231]
    v_mfma_f32_16x16x32_bf16 a[228:231], a[12:15], v[52:55], a[228:231]
    v_mfma_f32_16x16x32_bf16 a[232:235], a[16:19], v[48:51], a[232:235]
    v_mfma_f32_16x16x32_bf16 a[232:235], a[20:23], v[52:55], a[232:235]
    s_add_u32 m0, s67, 98304
    s_waitcnt vmcnt(8) lgkmcnt(0)
    v_cmp_gt_u32 vcc, 8, v7
    s_nop 1
    s_and_b64 vcc, vcc, s[86:87]
    s_cbranch_scc1 SPIN_WA
BACK_WA:
    s_barrier
    v_mfma_f32_16x16x32_bf16 a[236:239], a[24:27], v[48:51], a[236:239]
    buffer_load_dwordx4 v1, s[28:31], s65 offen sc1 lds
    v_mfma_f32_16x16x32_bf16 a[236:239], a[28:31], v[52:55], a[236:239]
    ds_read_b64_tr_b16 v[56:57], v14 offset:0
    ds_read_b64_tr_b16 v[58:59], v14 offset:1024
    v_mfma_f32_16x16x32_bf16 a[240:243], a[32:35], v[48:51], a[240:243]
    ds_read_b64_tr_b16 v[60:61], v14 offset:8192
    ds_read_b64_tr_b16 v[62:63], v14 offset:9216
    v_mfma_f32_16x16x32_bf16 a[240:243], a[36:39], v[52:55], a[240:243]
    ds_read_b64_tr_b16 v[40:41], v15 offset:0
    ds_read_b64_tr_b16 v[42:43], v15 offset:1024
    v_mfma_f32_16x16x32_bf16 a[244:247], a[40:43], v[48:51], a[244:247]
    ds_read_b64_tr_b16 v[44:45], v15 offset:8192
    ds_read_b64_tr_b16 v[46:47], v15 offset:9216
    v_mfma_f32_16x16x32_bf16 a[244:247], a[44:47], v[52:55], a[244:247]
    v_mfma_f32_16x16x32_bf16 a[248:251], a[48:51], v[48:51], a[248:251]
    v_mfma_f32_16x16x32_bf16 a[248:251], a[52:55], v[52:55], a[248:251]
    v_mfma_f32_16x16x32_bf16 a[252:255], a[56:59], v[48:51], a[252:255]
    buffer_load_dwordx4 v1, s[28:31], s65 offen offset:1024 sc1 lds
    v_mfma_f32_16x16x32_bf16 a[252:255], a[60:63], v[52:55], a[252:255]
    s_waitcnt lgkmcnt(0)
    ds_read_b64_tr_b16 v[48:49], v16 offset:0
    ds_read_b64_tr_b16 v[50:51], v16 offset:1024
    v_mfma_f32_16x16x32_bf16 v[128:131], v[56:59], a[64:67], v[128:131]
    ds_read_b64_tr_b16 v[52:53], v16 offset:8192
    ds_read_b64_tr_b16 v[54:55], v16 offset:9216
    v_mfma_f32_16x16x32_bf16 v[128:131], v[60:63], a[68:71], v[128:131]
    v_mfma_f32_16x16x32_bf16 v[132:135], v[56:59], a[72:75], v[132:135]
    ds_read_b128 v[64:67], v24 offset:16384
    v_mfma_f32_16x16x32_bf16 v[132:135], v[60:63], a[76:79], v[132:135]
    v_mfma_f32_16x16x32_bf16 v[136:139], v[56:59], a[80:83], v[136:139]
    v_mfma_f32_16x16x32_bf16 v[136:139], v[60:63], a[84:87], v[136:139]
    v_mfma_f32_16x16x32_bf16 v[140:143], v[56:59], a[88:91], v[140:143]
    s_add_u32 m0, s68, 106496
    v_mfma_f32_16x16x32_bf16 v[140:143], v[60:63], a[92:95], v[140:143]
    buffer_load_dwordx4 v6, s[20:23], s66 offen lds
    v_mfma_f32_16x16x32_bf16 v[144:147], v[56:59], a[96:99], v[144:147]
    v_cvt_pk_bf16_f32 v128, v128, v129
    v_cvt_pk_bf16_f32 v130, v130, v131
    v_mfma_f32_16x16x32_bf16 v[144:147], v[60:63], a[100:103], v[144:147]
    v_accvgpr_write_b32 a0, v128
    v_accvgpr_write_b32 a1, v130
    v_mfma_f32_16x16x32_bf16 v[148:151], v[56:59], a[104:107], v[148:151]
    v_cvt_pk_bf16_f32 v132, v132, v133
    v_cvt_pk_bf16_f32 v134, v134, v135
    v_mfma_f32_16x16x32_bf16 v[148:151], v[60:63], a[108:111], v[148:151]
    v_accvgpr_write_b32 a8, v132
    v_accvgpr_write_b32 a9, v134
    v_mfma_f32_16x16x32_bf16 v[152:155], v[56:59], a[112:115], v[152:155]
    v_cvt_pk_bf16_f32 v136, v136, v137
    v_cvt_pk_bf16_f32 v138, v138, v139
    v_mfma_f32_16x16x32_bf16 v[152:155], v[60:63], a[116:119], v[152:155]
    ds_read_b128 v[68:71], v25 offset:16384
    v_accvgpr_write_b32 a16, v136
    v_mfma_f32_16x16x32_bf16 v[156:159], v[56:59], a[120:123], v[156:159]
    s_add_u32 m0, s69, 114688
    ds_read_b64_tr_b16 v[56:57], v17 offset:0
    ds_read_b64_tr_b16 v[58:59], v17 offset:1024
    v_mfma_f32_16x16x32_bf16 v[156:159], v[60:63], a[124:127], v[156:159]
    s_xor_b32 s65, s65, 8192
    buffer_load_dwordx4 v10, s[20:23], s64 offen lds
    v_mfma_f32_16x16x32_bf16 v[160:163], v[40:43], a[64:67], v[160:163]
    s_xor_b32 s66, s66, 128
    ds_read_b64_tr_b16 v[60:61], v17 offset:8192
    ds_read_b64_tr_b16 v[62:63], v17 offset:9216
    v_mfma_f32_16x16x32_bf16 v[160:163], v[44:47], a[68:71], v[160:163]
    v_accvgpr_write_b32 a17, v138
    v_cvt_pk_bf16_f32 v140, v140, v141
    v_mfma_f32_16x16x32_bf16 v[164:167], v[40:43], a[72:75], v[164:167]
    v_cvt_pk_bf16_f32 v142, v142, v143
    v_accvgpr_write_b32 a24, v140
    v_mfma_f32_16x16x32_bf16 v[164:167], v[44:47], a[76:79], v[164:167]
    v_accvgpr_write_b32 a25, v142
    v_cvt_pk_bf16_f32 v144, v144, v145
    v_mfma_f32_16x16x32_bf16 v[168:171], v[40:43], a[80:83], v[168:171]
    v_cvt_pk_bf16_f32 v160, v160, v161
    v_cvt_pk_bf16_f32 v162, v162, v163
    v_mfma_f32_16x16x32_bf16 v[168:171], v[44:47], a[84:87], v[168:171]
    v_accvgpr_write_b32 a2, v160
    v_accvgpr_write_b32 a3, v162
    v_mfma_f32_16x16x32_bf16 v[172:175], v[40:43], a[88:91], v[172:175]
    v_cvt_pk_bf16_f32 v164, v164, v165
    v_cvt_pk_bf16_f32 v166, v166, v167
    v_mfma_f32_16x16x32_bf16 v[172:175], v[44:47], a[92:95], v[172:175]
    v_accvgpr_write_b32 a10, v164
    v_accvgpr_write_b32 a11, v166
    v_mfma_f32_16x16x32_bf16 v[176:179], v[40:43], a[96:99], v[176:179]
    buffer_load_dwordx4 v11, s[20:23], s64 offen offset:1024 lds
    v_mfma_f32_16x16x32_bf16 v[176:179], v[44:47], a[100:103], v[176:179]
    ds_read_b128 v[72:75], v24 offset:24576
    v_cvt_pk_bf16_f32 v146, v146, v147
    v_mfma_f32_16x16x32_bf16 v[180:183], v[40:43], a[104:107], v[180:183]
    v_accvgpr_write_b32 a32, v144
    v_accvgpr_write_b32 a33, v146
    v_mfma_f32_16x16x32_bf16 v[180:183], v[44:47], a[108:111], v[180:183]
    v_cvt_pk_bf16_f32 v148, v148, v149
    v_cvt_pk_bf16_f32 v150, v150, v151
    v_mfma_f32_16x16x32_bf16 v[184:187], v[40:43], a[112:115], v[184:187]
    v_accvgpr_write_b32 a40, v148
    v_accvgpr_write_b32 a41, v150
    v_mfma_f32_16x16x32_bf16 v[184:187], v[44:47], a[116:119], v[184:187]
    v_cvt_pk_bf16_f32 v152, v152, v153
    v_cvt_pk_bf16_f32 v154, v154, v155
    v_mfma_f32_16x16x32_bf16 v[188:191], v[40:43], a[120:123], v[188:191]
    ds_read_b64_tr_b16 v[40:41], v14 offset:32768
    ds_read_b64_tr_b16 v[42:43], v14 offset:33792
    v_mfma_f32_16x16x32_bf16 v[188:191], v[44:47], a[124:127], v[188:191]
    s_waitcnt lgkmcnt(2)
    ds_read_b64_tr_b16 v[44:45], v14 offset:40960
    ds_read_b64_tr_b16 v[46:47], v14 offset:41984
    v_mfma_f32_16x16x32_bf16 v[192:195], v[48:51], a[64:67], v[192:195]
    buffer_load_dwordx4 v12, s[20:23], s64 offen offset:2048 lds
    v_mfma_f32_16x16x32_bf16 v[192:195], v[52:55], a[68:71], v[192:195]
    v_xor_b32 v14, s73, v14
    v_add_u32 v14, 0x10000, v14
    v_mfma_f32_16x16x32_bf16 v[196:199], v[48:51], a[72:75], v[196:199]
    v_accvgpr_write_b32 a48, v152
    v_accvgpr_write_b32 a49, v154
    v_mfma_f32_16x16x32_bf16 v[196:199], v[52:55], a[76:79], v[196:199]
    ds_read_b128 v[76:79], v25 offset:24576
    v_cvt_pk_bf16_f32 v156, v156, v157
    v_mfma_f32_16x16x32_bf16 v[200:203], v[48:51], a[80:83], v[200:203]
    v_cvt_pk_bf16_f32 v158, v158, v159
    v_accvgpr_write_b32 a56, v156
    v_mfma_f32_16x16x32_bf16 v[200:203], v[52:55], a[84:87], v[200:203]
    v_accvgpr_write_b32 a57, v158
    v_cvt_pk_bf16_f32 v168, v168, v169
    v_mfma_f32_16x16x32_bf16 v[204:207], v[48:51], a[88:91], v[204:207]
    v_cvt_pk_bf16_f32 v170, v170, v171
    v_accvgpr_write_b32 a18, v168
    v_mfma_f32_16x16x32_bf16 v[204:207], v[52:55], a[92:95], v[204:207]
    v_accvgpr_write_b32 a19, v170
    v_cvt_pk_bf16_f32 v172, v172, v173
    v_mfma_f32_16x16x32_bf16 v[208:211], v[48:51], a[96:99], v[208:211]
    v_cvt_pk_bf16_f32 v174, v174, v175
    v_accvgpr_write_b32 a26, v172
    v_mfma_f32_16x16x32_bf16 v[208:211], v[52:55], a[100:103], v[208:211]
    buffer_load_dwordx4 v13, s[20:23], s64 offen offset:3072 lds
    v_mfma_f32_16x16x32_bf16 v[212:215], v[48:51], a[104:107], v[212:215]
    v_accvgpr_write_b32 a27, v174
    v_cvt_pk_bf16_f32 v176, v176, v177
    v_mfma_f32_16x16x32_bf16 v[212:215], v[52:55], a[108:111], v[212:215]
    v_cvt_pk_bf16_f32 v178, v178, v179
    v_accvgpr_write_b32 a34, v176
    v_mfma_f32_16x16x32_bf16 v[216:219], v[48:51], a[112:115], v[216:219]
    v_accvgpr_write_b32 a35, v178
    v_cvt_pk_bf16_f32 v180, v180, v181
    v_mfma_f32_16x16x32_bf16 v[216:219], v[52:55], a[116:119], v[216:219]
    v_cvt_pk_bf16_f32 v182, v182, v183
    v_accvgpr_write_b32 a42, v180
    v_mfma_f32_16x16x32_bf16 v[220:223], v[48:51], a[120:123], v[220:223]
    ds_read_b64_tr_b16 v[48:49], v15 offset:32768
    ds_read_b64_tr_b16 v[50:51], v15 offset:33792
    v_mfma_f32_16x16x32_bf16 v[220:223], v[52:55], a[124:127], v[220:223]
    ds_read_b64_tr_b16 v[52:53], v15 offset:40960
    ds_read_b64_tr_b16 v[54:55], v15 offset:41984
    v_mfma_f32_16x16x32_bf16 v[224:227], v[56:59], a[64:67], v[224:227]
    v_xor_b32 v15, s73, v15
    v_add_u32 v15, 0x10000, v15
    v_mfma_f32_16x16x32_bf16 v[224:227], v[60:63], a[68:71], v[224:227]
    s_xor_b32 s64, s64, 384
    v_accvgpr_write_b32 a43, v182
    v_cvt_pk_bf16_f32 v184, v184, v185
    v_mfma_f32_16x16x32_bf16 v[228:231], v[56:59], a[72:75], v[228:231]
    v_cvt_pk_bf16_f32 v186, v186, v187
    v_accvgpr_write_b32 a50, v184
    v_mfma_f32_16x16x32_bf16 v[228:231], v[60:63], a[76:79], v[228:231]
    v_accvgpr_write_b32 a51, v186
    v_cvt_pk_bf16_f32 v188, v188, v189
    v_mfma_f32_16x16x32_bf16 v[232:235], v[56:59], a[80:83], v[232:235]
    v_cvt_pk_bf16_f32 v190, v190, v191
    v_accvgpr_write_b32 a58, v188
    v_mfma_f32_16x16x32_bf16 v[232:235], v[60:63], a[84:87], v[232:235]
    s_add_u32 m0, s69, 131072
    v_accvgpr_write_b32 a59, v190
    v_cvt_pk_bf16_f32 v192, v192, v193
    v_mfma_f32_16x16x32_bf16 v[236:239], v[56:59], a[88:91], v[236:239]
    buffer_load_dwordx4 v2, s[24:27], s60 offen lds
    v_mfma_f32_16x16x32_bf16 v[236:239], v[60:63], a[92:95], v[236:239]
    v_cvt_pk_bf16_f32 v194, v194, v195
    v_accvgpr_write_b32 a4, v192
    v_mfma_f32_16x16x32_bf16 v[240:243], v[56:59], a[96:99], v[240:243]
    v_accvgpr_write_b32 a5, v194
    v_cvt_pk_bf16_f32 v196, v196, v197
    v_mfma_f32_16x16x32_bf16 v[240:243], v[60:63], a[100:103], v[240:243]
    v_cvt_pk_bf16_f32 v198, v198, v199
    v_accvgpr_write_b32 a12, v196
    v_mfma_f32_16x16x32_bf16 v[244:247], v[56:59], a[104:107], v[244:247]
    v_accvgpr_write_b32 a13, v198
    v_cvt_pk_bf16_f32 v200, v200, v201
    v_mfma_f32_16x16x32_bf16 v[244:247], v[60:63], a[108:111], v[244:247]
    v_cvt_pk_bf16_f32 v202, v202, v203
    v_accvgpr_write_b32 a20, v200
    v_mfma_f32_16x16x32_bf16 v[248:251], v[56:59], a[112:115], v[248:251]
    v_accvgpr_write_b32 a21, v202
    v_cvt_pk_bf16_f32 v204, v204, v205
    v_mfma_f32_16x16x32_bf16 v[248:251], v[60:63], a[116:119], v[248:251]
    buffer_load_dwordx4 v3, s[24:27], s60 offen offset:1024 lds
    v_mfma_f32_16x16x32_bf16 v[252:255], v[56:59], a[120:123], v[252:255]
    ds_read_b64_tr_b16 v[56:57], v16 offset:32768
    ds_read_b64_tr_b16 v[58:59], v16 offset:33792
    v_mfma_f32_16x16x32_bf16 v[252:255], v[60:63], a[124:127], v[252:255]
    s_waitcnt lgkmcnt(2)
    ds_read_b64_tr_b16 v[60:61], v16 offset:40960
    ds_read_b64_tr_b16 v[62:63], v16 offset:41984
    v_mfma_f32_16x16x32_bf16 a[128:131], a[64:67], v[40:43], a[128:131]
    v_xor_b32 v16, s73, v16
    v_add_u32 v16, 0x10000, v16
    v_mfma_f32_16x16x32_bf16 a[128:131], a[68:71], v[44:47], a[128:131]
    v_cvt_pk_bf16_f32 v206, v206, v207
    v_accvgpr_write_b32 a28, v204
    v_mfma_f32_16x16x32_bf16 a[132:135], a[72:75], v[40:43], a[132:135]
    ds_read_b128 v[80:83], v24 offset:49152
    v_accvgpr_write_b32 a29, v206
    v_mfma_f32_16x16x32_bf16 a[132:135], a[76:79], v[44:47], a[132:135]
    v_cvt_pk_bf16_f32 v208, v208, v209
    v_cvt_pk_bf16_f32 v210, v210, v211
    v_mfma_f32_16x16x32_bf16 a[136:139], a[80:83], v[40:43], a[136:139]
    v_accvgpr_write_b32 a36, v208
    v_accvgpr_write_b32 a37, v210
    v_mfma_f32_16x16x32_bf16 a[136:139], a[84:87], v[44:47], a[136:139]
    buffer_load_dwordx4 v4, s[24:27], s60 offen offset:2048 lds
    v_mfma_f32_16x16x32_bf16 a[140:143], a[88:91], v[40:43], a[140:143]
    v_cvt_pk_bf16_f32 v212, v212, v213
    v_cvt_pk_bf16_f32 v214, v214, v215
    v_mfma_f32_16x16x32_bf16 a[140:143], a[92:95], v[44:47], a[140:143]
    v_accvgpr_write_b32 a44, v212
    v_accvgpr_write_b32 a45, v214
    v_mfma_f32_16x16x32_bf16 a[144:147], a[96:99], v[40:43], a[144:147]
    v_cvt_pk_bf16_f32 v216, v216, v217
    v_cvt_pk_bf16_f32 v218, v218, v219
    v_mfma_f32_16x16x32_bf16 a[144:147], a[100:103], v[44:47], a[144:147]
    v_accvgpr_write_b32 a52, v216
    v_accvgpr_write_b32 a53, v218
    v_mfma_f32_16x16x32_bf16 a[148:151], a[104:107], v[40:43], a[148:151]
    v_cvt_pk_bf16_f32 v220, v220, v221
    v_cvt_pk_bf16_f32 v222, v222, v223
    v_mfma_f32_16x16x32_bf16 a[148:151], a[108:111], v[44:47], a[148:151]
    v_accvgpr_write_b32 a60, v220
    v_accvgpr_write_b32 a61, v222
    v_mfma_f32_16x16x32_bf16 a[152:155], a[112:115], v[40:43], a[152:155]
    buffer_load_dwordx4 v5, s[24:27], s60 offen offset:3072 lds
    v_mfma_f32_16x16x32_bf16 a[152:155], a[116:119], v[44:47], a[152:155]
    ds_read_b128 v[84:87], v25 offset:49152
    v_cvt_pk_bf16_f32 v224, v224, v225
    v_mfma_f32_16x16x32_bf16 a[156:159], a[120:123], v[40:43], a[156:159]
    ds_read_b64_tr_b16 v[40:41], v17 offset:32768
    ds_read_b64_tr_b16 v[42:43], v17 offset:33792
    v_mfma_f32_16x16x32_bf16 a[156:159], a[124:127], v[44:47], a[156:159]
    s_add_u32 s72, s70, 0
    ds_read_b64_tr_b16 v[44:45], v17 offset:40960
    ds_read_b64_tr_b16 v[46:47], v17 offset:41984
    v_mfma_f32_16x16x32_bf16 a[160:163], a[64:67], v[48:51], a[160:163]
    v_xor_b32 v17, s73, v17
    v_add_u32 v17, 0x10000, v17
    v_mfma_f32_16x16x32_bf16 a[160:163], a[68:71], v[52:55], a[160:163]
    buffer_store_dwordx4 a[0:3], v1, s[36:39], s72 offen sc1
    v_mfma_f32_16x16x32_bf16 a[164:167], a[72:75], v[48:51], a[164:167]
    v_cvt_pk_bf16_f32 v226, v226, v227
    v_accvgpr_write_b32 a6, v224
    v_mfma_f32_16x16x32_bf16 a[164:167], a[76:79], v[52:55], a[164:167]
    s_add_u32 m0, s69, 147456
    v_accvgpr_write_b32 a7, v226
    v_cvt_pk_bf16_f32 v228, v228, v229
    v_mfma_f32_16x16x32_bf16 a[168:171], a[80:83], v[48:51], a[168:171]
    s_xor_b32 s60, s60, 1572864
    buffer_load_dwordx4 v10, s[20:23], s63 offen lds
    v_mfma_f32_16x16x32_bf16 a[168:171], a[84:87], v[52:55], a[168:171]
    v_cvt_pk_bf16_f32 v230, v230, v231
    v_accvgpr_write_b32 a14, v228
    v_mfma_f32_16x16x32_bf16 a[172:175], a[88:91], v[48:51], a[172:175]
    v_accvgpr_write_b32 a15, v230
    v_cvt_pk_bf16_f32 v232, v232, v233
    v_mfma_f32_16x16x32_bf16 a[172:175], a[92:95], v[52:55], a[172:175]
    v_cvt_pk_bf16_f32 v234, v234, v235
    v_accvgpr_write_b32 a22, v232
    v_mfma_f32_16x16x32_bf16 a[176:179], a[96:99], v[48:51], a[176:179]
    ds_read_b128 v[88:91], v24 offset:57344
    v_accvgpr_write_b32 a23, v234
    v_mfma_f32_16x16x32_bf16 a[176:179], a[100:103], v[52:55], a[176:179]
    v_cvt_pk_bf16_f32 v236, v236, v237
    v_cvt_pk_bf16_f32 v238, v238, v239
    v_mfma_f32_16x16x32_bf16 a[180:183], a[104:107], v[48:51], a[180:183]
    v_accvgpr_write_b32 a30, v236
    v_accvgpr_write_b32 a31, v238
    v_mfma_f32_16x16x32_bf16 a[180:183], a[108:111], v[52:55], a[180:183]
    buffer_load_dwordx4 v11, s[20:23], s63 offen offset:1024 lds
    v_mfma_f32_16x16x32_bf16 a[184:187], a[112:115], v[48:51], a[184:187]
    v_cvt_pk_bf16_f32 v240, v240, v241
    v_cvt_pk_bf16_f32 v242, v242, v243
    v_mfma_f32_16x16x32_bf16 a[184:187], a[116:119], v[52:55], a[184:187]
    v_accvgpr_write_b32 a38, v240
    v_accvgpr_write_b32 a39, v242
    v_mfma_f32_16x16x32_bf16 a[188:191], a[120:123], v[48:51], a[188:191]
    v_cvt_pk_bf16_f32 v244, v244, v245
    v_cvt_pk_bf16_f32 v246, v246, v247
    v_mfma_f32_16x16x32_bf16 a[188:191], a[124:127], v[52:55], a[188:191]
    s_waitcnt lgkmcnt(0)
    v_accvgpr_write_b32 a46, v244
    v_accvgpr_write_b32 a47, v246
    v_mfma_f32_16x16x32_bf16 a[192:195], a[64:67], v[56:59], a[192:195]
    v_cvt_pk_bf16_f32 v248, v248, v249
    v_cvt_pk_bf16_f32 v250, v250, v251
    v_mfma_f32_16x16x32_bf16 a[192:195], a[68:71], v[60:63], a[192:195]
    v_accvgpr_write_b32 a54, v248
    v_accvgpr_write_b32 a55, v250
    v_mfma_f32_16x16x32_bf16 a[196:199], a[72:75], v[56:59], a[196:199]
    v_cvt_pk_bf16_f32 v252, v252, v253
    v_cvt_pk_bf16_f32 v254, v254, v255
    v_mfma_f32_16x16x32_bf16 a[196:199], a[76:79], v[60:63], a[196:199]
    buffer_load_dwordx4 v12, s[20:23], s63 offen offset:2048 lds
    v_mfma_f32_16x16x32_bf16 a[200:203], a[80:83], v[56:59], a[200:203]
    ds_read_b128 v[92:95], v25 offset:57344
    v_accvgpr_write_b32 a62, v252
    v_mfma_f32_16x16x32_bf16 a[200:203], a[84:87], v[60:63], a[200:203]
    s_add_u32 s72, s70, 4096
    v_accvgpr_write_b32 a63, v254
    v_accvgpr_write_b32 a0, 0
    v_mfma_f32_16x16x32_bf16 a[204:207], a[88:91], v[56:59], a[204:207]
    buffer_store_dwordx4 a[8:11], v1, s[36:39], s72 offen sc1
    v_mfma_f32_16x16x32_bf16 a[204:207], a[92:95], v[60:63], a[204:207]
    v_accvgpr_write_b32 a1, 0
    v_accvgpr_write_b32 a2, 0
    v_mfma_f32_16x16x32_bf16 a[208:211], a[96:99], v[56:59], a[208:211]
    v_accvgpr_write_b32 a3, 0
    v_accvgpr_write_b32 a8, 0
    v_mfma_f32_16x16x32_bf16 a[208:211], a[100:103], v[60:63], a[208:211]
    v_accvgpr_write_b32 a9, 0
    v_accvgpr_write_b32 a10, 0
    v_mfma_f32_16x16x32_bf16 a[212:215], a[104:107], v[56:59], a[212:215]
    buffer_load_dwordx4 v13, s[20:23], s63 offen offset:3072 lds
    v_mfma_f32_16x16x32_bf16 a[212:215], a[108:111], v[60:63], a[212:215]
    v_accvgpr_write_b32 a11, 0
    v_mfma_f32_16x16x32_bf16 a[216:219], a[112:115], v[56:59], a[216:219]
    v_mfma_f32_16x16x32_bf16 a[216:219], a[116:119], v[60:63], a[216:219]
    v_mfma_f32_16x16x32_bf16 a[220:223], a[120:123], v[56:59], a[220:223]
    v_mfma_f32_16x16x32_bf16 a[220:223], a[124:127], v[60:63], a[220:223]
    v_mfma_f32_16x16x32_bf16 a[224:227], a[64:67], v[40:43], a[224:227]
    v_mfma_f32_16x16x32_bf16 a[224:227], a[68:71], v[44:47], a[224:227]
    s_xor_b32 s63, s63, 128
    v_mfma_f32_16x16x32_bf16 a[228:231], a[72:75], v[40:43], a[228:231]
    v_accvgpr_read_b32 v32, a128
    v_accvgpr_read_b32 v31, a129
    v_mfma_f32_16x16x32_bf16 a[228:231], a[76:79], v[44:47], a[228:231]
    v_cvt_pk_bf16_f32 v32, v32, v31
    v_accvgpr_read_b32 v33, a130
    v_mfma_f32_16x16x32_bf16 a[232:235], a[80:83], v[40:43], a[232:235]
    v_accvgpr_read_b32 v31, a131
    v_cvt_pk_bf16_f32 v33, v33, v31
    v_mfma_f32_16x16x32_bf16 a[232:235], a[84:87], v[44:47], a[232:235]
    s_waitcnt vmcnt(10) lgkmcnt(0)
    s_barrier
    ds_read_b64_tr_b16 v[48:49], v14 offset:0
    v_mfma_f32_16x16x32_bf16 a[236:239], a[88:91], v[40:43], a[236:239]
    s_add_u32 m0, s67, 0
    ds_read_b64_tr_b16 v[50:51], v14 offset:1024
    ds_read_b64_tr_b16 v[52:53], v14 offset:8192
    v_mfma_f32_16x16x32_bf16 a[236:239], a[92:95], v[44:47], a[236:239]
    buffer_load_dwordx4 v1, s[28:31], s65 offen sc1 lds
    v_mfma_f32_16x16x32_bf16 a[240:243], a[96:99], v[40:43], a[240:243]
    ds_read_b64_tr_b16 v[54:55], v14 offset:9216
    ds_read_b64_tr_b16 v[56:57], v15 offset:0
    v_mfma_f32_16x16x32_bf16 a[240:243], a[100:103], v[44:47], a[240:243]
    ds_read_b64_tr_b16 v[58:59], v15 offset:1024
    ds_read_b64_tr_b16 v[60:61], v15 offset:8192
    v_mfma_f32_16x16x32_bf16 a[244:247], a[104:107], v[40:43], a[244:247]
    ds_read_b64_tr_b16 v[62:63], v15 offset:9216
    v_add_u32 v14, 0x10000, v14
    v_mfma_f32_16x16x32_bf16 a[244:247], a[108:111], v[44:47], a[244:247]
    s_add_u32 s72, s71, 0
    v_add_u32 v15, 0x10000, v15
    v_accvgpr_read_b32 v34, a132
    v_mfma_f32_16x16x32_bf16 a[248:251], a[112:115], v[40:43], a[248:251]
    v_accvgpr_read_b32 v31, a133
    v_cvt_pk_bf16_f32 v34, v34, v31
    v_mfma_f32_16x16x32_bf16 a[248:251], a[116:119], v[44:47], a[248:251]
    v_accvgpr_read_b32 v35, a134
    v_accvgpr_read_b32 v31, a135
    v_mfma_f32_16x16x32_bf16 a[252:255], a[120:123], v[40:43], a[252:255]
    buffer_load_dwordx4 v1, s[28:31], s65 offen offset:1024 sc1 lds
    v_mfma_f32_16x16x32_bf16 a[252:255], a[124:127], v[44:47], a[252:255]
    s_waitcnt lgkmcnt(0)
    ds_read_b64_tr_b16 v[40:41], v16 offset:0
    ds_read_b64_tr_b16 v[42:43], v16 offset:1024
    v_mfma_f32_16x16x32_bf16 v[128:131], v[48:51], v[64:67], 0
    ds_read_b64_tr_b16 v[44:45], v16 offset:8192
    ds_read_b64_tr_b16 v[46:47], v16 offset:9216
    v_mfma_f32_16x16x32_bf16 v[128:131], v[52:55], v[68:71], v[128:131]
    v_add_u32 v24, 0x10000, v24
    v_add_u32 v16, 0x10000, v16
    v_mfma_f32_16x16x32_bf16 v[132:135], v[48:51], v[72:75], 0
    ds_read_b128 v[96:99], v24 offset:16384
    v_cvt_pk_bf16_f32 v35, v35, v31
    v_mfma_f32_16x16x32_bf16 v[132:135], v[52:55], v[76:79], v[132:135]
    buffer_store_dwordx4 v[32:35], v1, s[36:39], s72 offen sc1
    v_mfma_f32_16x16x32_bf16 v[136:139], v[48:51], v[80:83], 0
    v_mfma_f32_16x16x32_bf16 v[136:139], v[52:55], v[84:87], v[136:139]
    v_mfma_f32_16x16x32_bf16 v[140:143], v[48:51], v[88:91], 0
    s_add_u32 m0, s68, 8192
    ds_read_b64_tr_b16 v[48:49], v17 offset:0
    ds_read_b64_tr_b16 v[50:51], v17 offset:1024
    v_mfma_f32_16x16x32_bf16 v[140:143], v[52:55], v[92:95], v[140:143]
    buffer_load_dwordx4 v6, s[20:23], s66 offen lds
    v_mfma_f32_16x16x32_bf16 v[144:147], v[56:59], v[64:67], 0
    ds_read_b64_tr_b16 v[52:53], v17 offset:8192
    ds_read_b64_tr_b16 v[54:55], v17 offset:9216
    v_mfma_f32_16x16x32_bf16 v[144:147], v[60:63], v[68:71], v[144:147]
    v_add_u32 v17, 0x10000, v17
    v_mfma_f32_16x16x32_bf16 v[148:151], v[56:59], v[72:75], 0
    v_mfma_f32_16x16x32_bf16 v[148:151], v[60:63], v[76:79], v[148:151]
    v_mfma_f32_16x16x32_bf16 v[152:155], v[56:59], v[80:83], 0
    v_add_u32 v25, 0x10000, v25
    v_mfma_f32_16x16x32_bf16 v[152:155], v[60:63], v[84:87], v[152:155]
    ds_read_b128 v[100:103], v25 offset:16384
    v_mfma_f32_16x16x32_bf16 v[156:159], v[56:59], v[88:91], 0
    s_add_u32 m0, s69, 16384
    ds_read_b64_tr_b16 v[56:57], v18 offset:0
    ds_read_b64_tr_b16 v[58:59], v18 offset:1024
    v_mfma_f32_16x16x32_bf16 v[156:159], v[60:63], v[92:95], v[156:159]
    s_xor_b32 s65, s65, 24576
    buffer_load_dwordx4 v10, s[20:23], s64 offen lds
    s_waitcnt lgkmcnt(3)
    v_mfma_f32_16x16x32_bf16 v[160:163], v[40:43], v[64:67], 0
    s_xor_b32 s66, s66, 384
    ds_read_b64_tr_b16 v[60:61], v18 offset:8192
    ds_read_b64_tr_b16 v[62:63], v18 offset:9216
    v_mfma_f32_16x16x32_bf16 v[160:163], v[44:47], v[68:71], v[160:163]
    s_add_u32 s72, s70, 8192
    v_add_u32 v18, 0x10000, v18
    v_mfma_f32_16x16x32_bf16 v[164:167], v[40:43], v[72:75], 0
    buffer_store_dwordx4 a[16:19], v1, s[36:39], s72 offen sc1
    v_mfma_f32_16x16x32_bf16 v[164:167], v[44:47], v[76:79], v[164:167]
    v_mfma_f32_16x16x32_bf16 v[168:171], v[40:43], v[80:83], 0
    v_accvgpr_write_b32 a16, 0
    v_accvgpr_write_b32 a17, 0
    v_mfma_f32_16x16x32_bf16 v[168:171], v[44:47], v[84:87], v[168:171]
    v_accvgpr_write_b32 a18, 0
    v_accvgpr_write_b32 a19, 0
    v_mfma_f32_16x16x32_bf16 v[172:175], v[40:43], v[88:91], 0
    ds_read_b64_tr_b16 v[40:41], v19 offset:0
    ds_read_b64_tr_b16 v[42:43], v19 offset:1024
    v_mfma_f32_16x16x32_bf16 v[172:175], v[44:47], v[92:95], v[172:175]
    ds_read_b64_tr_b16 v[44:45], v19 offset:8192
    ds_read_b64_tr_b16 v[46:47], v19 offset:9216
    v_mfma_f32_16x16x32_bf16 v[176:179], v[48:51], v[64:67], 0
    buffer_load_dwordx4 v11, s[20:23], s64 offen offset:1024 lds
    v_mfma_f32_16x16x32_bf16 v[176:179], v[52:55], v[68:71], v[176:179]
    ds_read_b128 v[104:107], v24 offset:24576
    v_add_u32 v19, 0x10000, v19
    v_mfma_f32_16x16x32_bf16 v[180:183], v[48:51], v[72:75], 0
    v_mfma_f32_16x16x32_bf16 v[180:183], v[52:55], v[76:79], v[180:183]
    v_mfma_f32_16x16x32_bf16 v[184:187], v[48:51], v[80:83], 0
    v_mfma_f32_16x16x32_bf16 v[184:187], v[52:55], v[84:87], v[184:187]
    v_mfma_f32_16x16x32_bf16 v[188:191], v[48:51], v[88:91], 0
    ds_read_b64_tr_b16 v[48:49], v20 offset:0
    ds_read_b64_tr_b16 v[50:51], v20 offset:1024
    v_mfma_f32_16x16x32_bf16 v[188:191], v[52:55], v[92:95], v[188:191]
    s_waitcnt lgkmcnt(2)
    ds_read_b64_tr_b16 v[52:53], v20 offset:8192
    ds_read_b64_tr_b16 v[54:55], v20 offset:9216
    v_mfma_f32_16x16x32_bf16 v[192:195], v[56:59], v[64:67], 0
    buffer_load_dwordx4 v12, s[20:23], s64 offen offset:2048 lds
    v_mfma_f32_16x16x32_bf16 v[192:195], v[60:63], v[68:71], v[192:195]
    v_add_u32 v20, 0x10000, v20
    v_accvgpr_read_b32 v36, a136
    v_mfma_f32_16x16x32_bf16 v[196:199], v[56:59], v[72:75], 0
    v_accvgpr_read_b32 v31, a137
    v_cvt_pk_bf16_f32 v36, v36, v31
    v_mfma_f32_16x16x32_bf16 v[196:199], v[60:63], v[76:79], v[196:199]
    ds_read_b128 v[108:111], v25 offset:24576
    v_accvgpr_read_b32 v37, a138
    v_mfma_f32_16x16x32_bf16 v[200:203], v[56:59], v[80:83], 0
    v_accvgpr_read_b32 v31, a139
    ds_read_b128 a[136:139], v22 offset:32768
    v_mfma_f32_16x16x32_bf16 v[200:203], v[60:63], v[84:87], v[200:203]
    v_add_u32 v22, 0xffff0000, v22
    v_cvt_pk_bf16_f32 v37, v37, v31
    v_mfma_f32_16x16x32_bf16 v[204:207], v[56:59], v[88:91], 0
    ds_read_b64_tr_b16 v[56:57], v21 offset:0
    ds_read_b64_tr_b16 v[58:59], v21 offset:1024
    v_mfma_f32_16x16x32_bf16 v[204:207], v[60:63], v[92:95], v[204:207]
    s_add_u32 s72, s71, 1024
    ds_read_b64_tr_b16 v[60:61], v21 offset:8192
    ds_read_b64_tr_b16 v[62:63], v21 offset:9216
    v_mfma_f32_16x16x32_bf16 v[208:211], v[40:43], v[64:67], 0
    v_add_u32 v21, 0x10000, v21
    v_accvgpr_read_b32 v38, a140
    v_mfma_f32_16x16x32_bf16 v[208:211], v[44:47], v[68:71], v[208:211]
    buffer_load_dwordx4 v13, s[20:23], s64 offen offset:3072 lds
    v_mfma_f32_16x16x32_bf16 v[212:215], v[40:43], v[72:75], 0
    v_accvgpr_read_b32 v31, a141
    v_cvt_pk_bf16_f32 v38, v38, v31
    v_mfma_f32_16x16x32_bf16 v[212:215], v[44:47], v[76:79], v[212:215]
    v_accvgpr_read_b32 v39, a142
    v_accvgpr_read_b32 v31, a143
    v_mfma_f32_16x16x32_bf16 v[216:219], v[40:43], v[80:83], 0
    ds_read_b128 a[140:143], v23 offset:32768
    v_add_u32 v23, 0xffff0000, v23
    v_mfma_f32_16x16x32_bf16 v[216:219], v[44:47], v[84:87], v[216:219]
    v_cvt_pk_bf16_f32 v39, v39, v31
    v_mfma_f32_16x16x32_bf16 v[220:223], v[40:43], v[88:91], 0
    ds_read_b64_tr_b16 v[40:41], v26 offset:32768
    ds_read_b64_tr_b16 v[42:43], v26 offset:33280
    v_mfma_f32_16x16x32_bf16 v[220:223], v[44:47], v[92:95], v[220:223]
    s_waitcnt lgkmcnt(3)
    ds_read_b64_tr_b16 v[44:45], v26 offset:36864
    ds_read_b64_tr_b16 v[46:47], v26 offset:37376
    v_mfma_f32_16x16x32_bf16 v[224:227], v[48:51], v[64:67], 0
    buffer_store_dwordx4 v[36:39], v1, s[36:39], s72 offen sc1
    v_mfma_f32_16x16x32_bf16 v[224:227], v[52:55], v[68:71], v[224:227]
    s_xor_b32 s64, s64, 128
    v_add_u32 v26, 0xffff0000, v26
    v_mfma_f32_16x16x32_bf16 v[228:231], v[48:51], v[72:75], 0
    v_mfma_f32_16x16x32_bf16 v[228:231], v[52:55], v[76:79], v[228:231]
    v_mfma_f32_16x16x32_bf16 v[232:235], v[48:51], v[80:83], 0
    v_mfma_f32_16x16x32_bf16 v[232:235], v[52:55], v[84:87], v[232:235]
    s_add_u32 m0, s69, 32768
    v_mfma_f32_16x16x32_bf16 v[236:239], v[48:51], v[88:91], 0
    buffer_load_dwordx4 v2, s[24:27], s60 offen lds
    v_mfma_f32_16x16x32_bf16 v[236:239], v[52:55], v[92:95], v[236:239]
    ds_read_b64_tr_b16 v[48:49], v27 offset:32768
    ds_read_b64_tr_b16 v[50:51], v27 offset:33280
    v_mfma_f32_16x16x32_bf16 v[240:243], v[56:59], v[64:67], 0
    ds_read_b64_tr_b16 v[52:53], v27 offset:36864
    ds_read_b64_tr_b16 v[54:55], v27 offset:37376
    v_mfma_f32_16x16x32_bf16 v[240:243], v[60:63], v[68:71], v[240:243]
    v_add_u32 v27, 0xffff0000, v27
    v_mfma_f32_16x16x32_bf16 v[244:247], v[56:59], v[72:75], 0
    buffer_load_dwordx4 v3, s[24:27], s60 offen offset:1024 lds
    v_mfma_f32_16x16x32_bf16 v[244:247], v[60:63], v[76:79], v[244:247]
    v_mfma_f32_16x16x32_bf16 v[248:251], v[56:59], v[80:83], 0
    v_mfma_f32_16x16x32_bf16 v[248:251], v[60:63], v[84:87], v[248:251]
    s_add_u32 s72, s70, 12288
    v_mfma_f32_16x16x32_bf16 v[252:255], v[56:59], v[88:91], 0
    buffer_load_dwordx4 v4, s[24:27], s60 offen offset:2048 lds
    v_mfma_f32_16x16x32_bf16 v[252:255], v[60:63], v[92:95], v[252:255]
    s_waitcnt lgkmcnt(0)
    ds_read_b64_tr_b16 v[56:57], v28 offset:32768
    ds_read_b64_tr_b16 v[58:59], v28 offset:33280
    v_mfma_f32_16x16x32_bf16 a[64:67], v[40:43], v[64:67], 0
    ds_read_b64_tr_b16 v[60:61], v28 offset:36864
    ds_read_b64_tr_b16 v[62:63], v28 offset:37376
    v_mfma_f32_16x16x32_bf16 a[64:67], v[44:47], v[68:71], a[64:67]
    buffer_store_dwordx4 a[24:27], v1, s[36:39], s72 offen sc1
    v_mfma_f32_16x16x32_bf16 a[68:71], v[40:43], v[72:75], 0
    buffer_load_dwordx4 v5, s[24:27], s60 offen offset:3072 lds
    v_mfma_f32_16x16x32_bf16 a[68:71], v[44:47], v[76:79], a[68:71]
    ds_read_b128 v[112:115], v24 offset:49152
    v_add_u32 v28, 0xffff0000, v28
    v_mfma_f32_16x16x32_bf16 a[72:75], v[40:43], v[80:83], 0
    v_accvgpr_write_b32 a24, 0
    v_accvgpr_write_b32 a25, 0
    v_mfma_f32_16x16x32_bf16 a[72:75], v[44:47], v[84:87], a[72:75]
    s_add_u32 m0, s69, 49152
    v_accvgpr_write_b32 a26, 0
    v_accvgpr_write_b32 a27, 0
    v_mfma_f32_16x16x32_bf16 a[76:79], v[40:43], v[88:91], 0
    s_xor_b32 s60, s60, 524288
    buffer_load_dwordx4 v10, s[20:23], s63 offen lds
    v_mfma_f32_16x16x32_bf16 a[76:79], v[44:47], v[92:95], a[76:79]
    ds_read_b128 v[116:119], v25 offset:49152
    v_mfma_f32_16x16x32_bf16 a[128:131], v[40:43], a[136:139], 0
    ds_read_b64_tr_b16 v[40:41], v29 offset:32768
    ds_read_b64_tr_b16 v[42:43], v29 offset:33280
    v_mfma_f32_16x16x32_bf16 a[128:131], v[44:47], a[140:143], a[128:131]
    ds_read_b64_tr_b16 v[44:45], v29 offset:36864
    ds_read_b64_tr_b16 v[46:47], v29 offset:37376
    v_mfma_f32_16x16x32_bf16 a[80:83], v[48:51], v[64:67], 0
    buffer_load_dwordx4 v11, s[20:23], s63 offen offset:1024 lds
    v_mfma_f32_16x16x32_bf16 a[80:83], v[52:55], v[68:71], a[80:83]
    ds_read_b128 v[120:123], v24 offset:57344
    v_add_u32 v29, 0xffff0000, v29
    v_mfma_f32_16x16x32_bf16 a[84:87], v[48:51], v[72:75], 0
    v_mfma_f32_16x16x32_bf16 a[84:87], v[52:55], v[76:79], a[84:87]
    v_mfma_f32_16x16x32_bf16 a[88:91], v[48:51], v[80:83], 0
    buffer_load_dwordx4 v12, s[20:23], s63 offen offset:2048 lds
    v_mfma_f32_16x16x32_bf16 a[88:91], v[52:55], v[84:87], a[88:91]
    ds_read_b128 v[124:127], v25 offset:57344
    v_mfma_f32_16x16x32_bf16 a[92:95], v[48:51], v[88:91], 0
    v_mfma_f32_16x16x32_bf16 a[92:95], v[52:55], v[92:95], a[92:95]
    v_mfma_f32_16x16x32_bf16 a[132:135], v[48:51], a[136:139], 0
    buffer_load_dwordx4 v13, s[20:23], s63 offen offset:3072 lds
    v_mfma_f32_16x16x32_bf16 a[132:135], v[52:55], a[140:143], a[132:135]
    s_add_u32 s72, s70, 32768
    s_waitcnt lgkmcnt(1)
    v_mfma_f32_16x16x32_bf16 a[96:99], v[56:59], v[64:67], 0
    v_mfma_f32_16x16x32_bf16 a[96:99], v[60:63], v[68:71], a[96:99]
    s_xor_b32 s63, s63, 896
    v_mfma_f32_16x16x32_bf16 a[100:103], v[56:59], v[72:75], 0
    buffer_store_dwordx4 a[32:35], v1, s[36:39], s72 offen sc1
    v_mfma_f32_16x16x32_bf16 a[100:103], v[60:63], v[76:79], a[100:103]
    v_mfma_f32_16x16x32_bf16 a[104:107], v[56:59], v[80:83], 0
    v_accvgpr_write_b32 a32, 0
    v_accvgpr_write_b32 a33, 0
    v_mfma_f32_16x16x32_bf16 a[104:107], v[60:63], v[84:87], a[104:107]
    s_waitcnt vmcnt(11) lgkmcnt(0)
    s_barrier
    ds_read_b64_tr_b16 v[48:49], v14 offset:0
    v_mfma_f32_16x16x32_bf16 a[108:111], v[56:59], v[88:91], 0
    s_add_u32 m0, s67, 65536
    ds_read_b64_tr_b16 v[50:51], v14 offset:1024
    ds_read_b64_tr_b16 v[52:53], v14 offset:8192
    v_mfma_f32_16x16x32_bf16 a[108:111], v[60:63], v[92:95], a[108:111]
    buffer_load_dwordx4 v1, s[28:31], s65 offen sc1 lds
    v_mfma_f32_16x16x32_bf16 a[112:115], v[40:43], v[64:67], 0
    ds_read_b64_tr_b16 v[54:55], v14 offset:9216
    ds_read_b64_tr_b16 v[56:57], v15 offset:0
    v_mfma_f32_16x16x32_bf16 a[112:115], v[44:47], v[68:71], a[112:115]
    ds_read_b64_tr_b16 v[58:59], v15 offset:1024
    ds_read_b64_tr_b16 v[60:61], v15 offset:8192
    v_mfma_f32_16x16x32_bf16 a[116:119], v[40:43], v[72:75], 0
    ds_read_b64_tr_b16 v[62:63], v15 offset:9216
    ds_read_b128 a[136:139], v22 offset:0
    v_mfma_f32_16x16x32_bf16 a[116:119], v[44:47], v[76:79], a[116:119]
    ds_read_b128 a[140:143], v23 offset:0
    v_add_u32 v14, 0xfffe0000, v14
    v_mfma_f32_16x16x32_bf16 a[120:123], v[40:43], v[80:83], 0
    v_add_u32 v15, 0xfffe0000, v15
    v_add_u32 v22, 0x10000, v22
    v_mfma_f32_16x16x32_bf16 a[120:123], v[44:47], v[84:87], a[120:123]
    v_add_u32 v23, 0x10000, v23
    v_accvgpr_write_b32 a34, 0
    v_mfma_f32_16x16x32_bf16 a[124:127], v[40:43], v[88:91], 0
    buffer_load_dwordx4 v1, s[28:31], s65 offen offset:1024 sc1 lds
    v_mfma_f32_16x16x32_bf16 a[124:127], v[44:47], v[92:95], a[124:127]
    s_waitcnt lgkmcnt(1)
    ds_read_b64_tr_b16 v[40:41], v16 offset:0
    ds_read_b64_tr_b16 v[42:43], v16 offset:1024
    v_mfma_f32_16x16x32_bf16 v[128:131], v[48:51], v[96:99], v[128:131]
    ds_read_b64_tr_b16 v[44:45], v16 offset:8192
    ds_read_b64_tr_b16 v[46:47], v16 offset:9216
    v_mfma_f32_16x16x32_bf16 v[128:131], v[52:55], v[100:103], v[128:131]
    v_add_u32 v24, 0x10000, v24
    v_add_u32 v16, 0xfffe0000, v16
    v_mfma_f32_16x16x32_bf16 v[132:135], v[48:51], v[104:107], v[132:135]
    ds_read_b128 v[64:67], v24 offset:16384
    v_accvgpr_write_b32 a35, 0
    v_mfma_f32_16x16x32_bf16 v[132:135], v[52:55], v[108:111], v[132:135]
    v_mfma_f32_16x16x32_bf16 v[136:139], v[48:51], v[112:115], v[136:139]
    v_mfma_f32_16x16x32_bf16 v[136:139], v[52:55], v[116:119], v[136:139]
    s_add_u32 s72, s70, 36864
    v_mfma_f32_16x16x32_bf16 v[140:143], v[48:51], v[120:123], v[140:143]
    s_add_u32 m0, s68, 73728
    ds_read_b64_tr_b16 v[48:49], v17 offset:0
    ds_read_b64_tr_b16 v[50:51], v17 offset:1024
    v_mfma_f32_16x16x32_bf16 v[140:143], v[52:55], v[124:127], v[140:143]
    buffer_load_dwordx4 v6, s[20:23], s66 offen lds
    v_mfma_f32_16x16x32_bf16 v[144:147], v[56:59], v[96:99], v[144:147]
    ds_read_b64_tr_b16 v[52:53], v17 offset:8192
    ds_read_b64_tr_b16 v[54:55], v17 offset:9216
    v_mfma_f32_16x16x32_bf16 v[144:147], v[60:63], v[100:103], v[144:147]
    buffer_store_dwordx4 a[40:43], v1, s[36:39], s72 offen sc1
    v_mfma_f32_16x16x32_bf16 v[148:151], v[56:59], v[104:107], v[148:151]
    v_add_u32 v17, 0xfffe0000, v17
    v_accvgpr_write_b32 a40, 0
    v_mfma_f32_16x16x32_bf16 v[148:151], v[60:63], v[108:111], v[148:151]
    v_accvgpr_write_b32 a41, 0
    v_accvgpr_write_b32 a42, 0
    v_mfma_f32_16x16x32_bf16 v[152:155], v[56:59], v[112:115], v[152:155]
    v_add_u32 v25, 0x10000, v25
    v_accvgpr_write_b32 a43, 0
    v_mfma_f32_16x16x32_bf16 v[152:155], v[60:63], v[116:119], v[152:155]
    ds_read_b128 v[68:71], v25 offset:16384
    v_mfma_f32_16x16x32_bf16 v[156:159], v[56:59], v[120:123], v[156:159]
    s_add_u32 m0, s69, 81920
    ds_read_b64_tr_b16 v[56:57], v18 offset:0
    ds_read_b64_tr_b16 v[58:59], v18 offset:1024
    v_mfma_f32_16x16x32_bf16 v[156:159], v[60:63], v[124:127], v[156:159]
    s_xor_b32 s65, s65, 8192
    buffer_load_dwordx4 v10, s[20:23], s64 offen lds
    s_waitcnt lgkmcnt(3)
    v_mfma_f32_16x16x32_bf16 v[160:163], v[40:43], v[96:99], v[160:163]
    s_xor_b32 s66, s66, 128
    ds_read_b64_tr_b16 v[60:61], v18 offset:8192
    ds_read_b64_tr_b16 v[62:63], v18 offset:9216
    v_mfma_f32_16x16x32_bf16 v[160:163], v[44:47], v[100:103], v[160:163]
    v_add_u32 v18, 0xfffe0000, v18
    v_mfma_f32_16x16x32_bf16 v[164:167], v[40:43], v[104:107], v[164:167]
    v_mfma_f32_16x16x32_bf16 v[164:167], v[44:47], v[108:111], v[164:167]
    v_mfma_f32_16x16x32_bf16 v[168:171], v[40:43], v[112:115], v[168:171]
    v_mfma_f32_16x16x32_bf16 v[168:171], v[44:47], v[116:119], v[168:171]
    v_mfma_f32_16x16x32_bf16 v[172:175], v[40:43], v[120:123], v[172:175]
    ds_read_b64_tr_b16 v[40:41], v19 offset:0
    ds_read_b64_tr_b16 v[42:43], v19 offset:1024
    v_mfma_f32_16x16x32_bf16 v[172:175], v[44:47], v[124:127], v[172:175]
    ds_read_b64_tr_b16 v[44:45], v19 offset:8192
    ds_read_b64_tr_b16 v[46:47], v19 offset:9216
    v_mfma_f32_16x16x32_bf16 v[176:179], v[48:51], v[96:99], v[176:179]
    buffer_load_dwordx4 v11, s[20:23], s64 offen offset:1024 lds
    v_mfma_f32_16x16x32_bf16 v[176:179], v[52:55], v[100:103], v[176:179]
    ds_read_b128 v[72:75], v24 offset:24576
    v_add_u32 v19, 0xfffe0000, v19
    v_mfma_f32_16x16x32_bf16 v[180:183], v[48:51], v[104:107], v[180:183]
    v_mfma_f32_16x16x32_bf16 v[180:183], v[52:55], v[108:111], v[180:183]
    s_add_u32 s72, s70, 40960
    v_mfma_f32_16x16x32_bf16 v[184:187], v[48:51], v[112:115], v[184:187]
    buffer_store_dwordx4 a[48:51], v1, s[36:39], s72 offen sc1
    v_mfma_f32_16x16x32_bf16 v[184:187], v[52:55], v[116:119], v[184:187]
    v_mfma_f32_16x16x32_bf16 v[188:191], v[48:51], v[120:123], v[188:191]
    ds_read_b64_tr_b16 v[48:49], v20 offset:0
    ds_read_b64_tr_b16 v[50:51], v20 offset:1024
    v_mfma_f32_16x16x32_bf16 v[188:191], v[52:55], v[124:127], v[188:191]
    s_waitcnt lgkmcnt(2)
    ds_read_b64_tr_b16 v[52:53], v20 offset:8192
    ds_read_b64_tr_b16 v[54:55], v20 offset:9216
    v_mfma_f32_16x16x32_bf16 v[192:195], v[56:59], v[96:99], v[192:195]
    buffer_load_dwordx4 v12, s[20:23], s64 offen offset:2048 lds
    v_mfma_f32_16x16x32_bf16 v[192:195], v[60:63], v[100:103], v[192:195]
    v_add_u32 v20, 0xfffe0000, v20
    v_accvgpr_write_b32 a48, 0
    v_mfma_f32_16x16x32_bf16 v[196:199], v[56:59], v[104:107], v[196:199]
    v_accvgpr_write_b32 a49, 0
    v_accvgpr_write_b32 a50, 0
    v_mfma_f32_16x16x32_bf16 v[196:199], v[60:63], v[108:111], v[196:199]
    ds_read_b128 v[76:79], v25 offset:24576
    v_accvgpr_write_b32 a51, 0
    v_mfma_f32_16x16x32_bf16 v[200:203], v[56:59], v[112:115], v[200:203]
    v_mfma_f32_16x16x32_bf16 v[200:203], v[60:63], v[116:119], v[200:203]
    v_mfma_f32_16x16x32_bf16 v[204:207], v[56:59], v[120:123], v[204:207]
    ds_read_b64_tr_b16 v[56:57], v21 offset:0
    ds_read_b64_tr_b16 v[58:59], v21 offset:1024
    v_mfma_f32_16x16x32_bf16 v[204:207], v[60:63], v[124:127], v[204:207]
    ds_read_b64_tr_b16 v[60:61], v21 offset:8192
    ds_read_b64_tr_b16 v[62:63], v21 offset:9216
    v_mfma_f32_16x16x32_bf16 v[208:211], v[40:43], v[96:99], v[208:211]
    v_add_u32 v21, 0xfffe0000, v21
    v_mfma_f32_16x16x32_bf16 v[208:211], v[44:47], v[100:103], v[208:211]
    buffer_load_dwordx4 v13, s[20:23], s64 offen offset:3072 lds
    v_mfma_f32_16x16x32_bf16 v[212:215], v[40:43], v[104:107], v[212:215]
    v_mfma_f32_16x16x32_bf16 v[212:215], v[44:47], v[108:111], v[212:215]
    v_mfma_f32_16x16x32_bf16 v[216:219], v[40:43], v[112:115], v[216:219]
    v_mfma_f32_16x16x32_bf16 v[216:219], v[44:47], v[116:119], v[216:219]
    v_mfma_f32_16x16x32_bf16 v[220:223], v[40:43], v[120:123], v[220:223]
    ds_read_b64_tr_b16 v[40:41], v26 offset:0
    ds_read_b64_tr_b16 v[42:43], v26 offset:512
    v_mfma_f32_16x16x32_bf16 v[220:223], v[44:47], v[124:127], v[220:223]
    s_waitcnt lgkmcnt(2)
    ds_read_b64_tr_b16 v[44:45], v26 offset:4096
    ds_read_b64_tr_b16 v[46:47], v26 offset:4608
    v_mfma_f32_16x16x32_bf16 v[224:227], v[48:51], v[96:99], v[224:227]
    v_add_u32 v26, 0x10000, v26
    v_mfma_f32_16x16x32_bf16 v[224:227], v[52:55], v[100:103], v[224:227]
    s_xor_b32 s64, s64, 896
    v_mfma_f32_16x16x32_bf16 v[228:231], v[48:51], v[104:107], v[228:231]
    s_add_u32 s72, s70, 45056
    buffer_store_dwordx4 a[56:59], v1, s[36:39], s72 offen sc1
    v_mfma_f32_16x16x32_bf16 v[228:231], v[52:55], v[108:111], v[228:231]
    v_mfma_f32_16x16x32_bf16 v[232:235], v[48:51], v[112:115], v[232:235]
    v_accvgpr_write_b32 a56, 0
    v_accvgpr_write_b32 a57, 0
    v_mfma_f32_16x16x32_bf16 v[232:235], v[52:55], v[116:119], v[232:235]
    s_add_u32 m0, s69, 98304
    v_accvgpr_write_b32 a58, 0
    v_accvgpr_write_b32 a59, 0
    v_mfma_f32_16x16x32_bf16 v[236:239], v[48:51], v[120:123], v[236:239]
    buffer_load_dwordx4 v2, s[24:27], s60 offen lds
    v_mfma_f32_16x16x32_bf16 v[236:239], v[52:55], v[124:127], v[236:239]
    ds_read_b64_tr_b16 v[48:49], v27 offset:0
    ds_read_b64_tr_b16 v[50:51], v27 offset:512
    v_mfma_f32_16x16x32_bf16 v[240:243], v[56:59], v[96:99], v[240:243]
    ds_read_b64_tr_b16 v[52:53], v27 offset:4096
    ds_read_b64_tr_b16 v[54:55], v27 offset:4608
    v_mfma_f32_16x16x32_bf16 v[240:243], v[60:63], v[100:103], v[240:243]
    v_add_u32 v27, 0x10000, v27
    v_mfma_f32_16x16x32_bf16 v[244:247], v[56:59], v[104:107], v[244:247]
    buffer_load_dwordx4 v3, s[24:27], s60 offen offset:1024 lds
    v_mfma_f32_16x16x32_bf16 v[244:247], v[60:63], v[108:111], v[244:247]
    v_mfma_f32_16x16x32_bf16 v[248:251], v[56:59], v[112:115], v[248:251]
    v_mfma_f32_16x16x32_bf16 v[248:251], v[60:63], v[116:119], v[248:251]
    v_mfma_f32_16x16x32_bf16 v[252:255], v[56:59], v[120:123], v[252:255]
    buffer_load_dwordx4 v4, s[24:27], s60 offen offset:2048 lds
    v_mfma_f32_16x16x32_bf16 v[252:255], v[60:63], v[124:127], v[252:255]
    s_waitcnt lgkmcnt(0)
    ds_read_b64_tr_b16 v[56:57], v28 offset:0
    ds_read_b64_tr_b16 v[58:59], v28 offset:512
    v_mfma_f32_16x16x32_bf16 a[64:67], v[40:43], v[96:99], a[64:67]
    ds_read_b64_tr_b16 v[60:61], v28 offset:4096
    ds_read_b64_tr_b16 v[62:63], v28 offset:4608
    v_mfma_f32_16x16x32_bf16 a[64:67], v[44:47], v[100:103], a[64:67]
    v_add_u32 v24, 0xfffe0000, v24
    v_add_u32 v28, 0x10000, v28
    v_mfma_f32_16x16x32_bf16 a[68:71], v[40:43], v[104:107], a[68:71]
    buffer_load_dwordx4 v5, s[24:27], s60 offen offset:3072 lds
    v_mfma_f32_16x16x32_bf16 a[68:71], v[44:47], v[108:111], a[68:71]
    ds_read_b128 v[80:83], v24 offset:16384
    v_mfma_f32_16x16x32_bf16 a[72:75], v[40:43], v[112:115], a[72:75]
    v_mfma_f32_16x16x32_bf16 a[72:75], v[44:47], v[116:119], a[72:75]
    s_add_u32 m0, s69, 114688
    v_add_u32 v25, 0xfffe0000, v25
    v_mfma_f32_16x16x32_bf16 a[76:79], v[40:43], v[120:123], a[76:79]
    s_xor_b32 s60, s60, 3670016
    buffer_load_dwordx4 v10, s[20:23], s63 offen lds
    v_mfma_f32_16x16x32_bf16 a[76:79], v[44:47], v[124:127], a[76:79]
    s_add_u32 s72, s70, 1024
    ds_read_b128 v[84:87], v25 offset:16384
    v_mfma_f32_16x16x32_bf16 a[128:131], v[40:43], a[136:139], a[128:131]
    ds_read_b64_tr_b16 v[40:41], v29 offset:0
    ds_read_b64_tr_b16 v[42:43], v29 offset:512
    v_mfma_f32_16x16x32_bf16 a[128:131], v[44:47], a[140:143], a[128:131]
    ds_read_b64_tr_b16 v[44:45], v29 offset:4096
    ds_read_b64_tr_b16 v[46:47], v29 offset:4608
    v_mfma_f32_16x16x32_bf16 a[80:83], v[48:51], v[96:99], a[80:83]
    buffer_load_dwordx4 v11, s[20:23], s63 offen offset:1024 lds
    v_mfma_f32_16x16x32_bf16 a[80:83], v[52:55], v[100:103], a[80:83]
    ds_read_b128 v[88:91], v24 offset:24576
    v_add_u32 v29, 0x10000, v29
    v_mfma_f32_16x16x32_bf16 a[84:87], v[48:51], v[104:107], a[84:87]
    buffer_store_dwordx4 a[4:7], v1, s[36:39], s72 offen sc1
    v_mfma_f32_16x16x32_bf16 a[84:87], v[52:55], v[108:111], a[84:87]
    v_mfma_f32_16x16x32_bf16 a[88:91], v[48:51], v[112:115], a[88:91]
    buffer_load_dwordx4 v12, s[20:23], s63 offen offset:2048 lds
    v_mfma_f32_16x16x32_bf16 a[88:91], v[52:55], v[116:119], a[88:91]
    ds_read_b128 v[92:95], v25 offset:24576
    v_accvgpr_write_b32 a4, 0
    v_mfma_f32_16x16x32_bf16 a[92:95], v[48:51], v[120:123], a[92:95]
    v_accvgpr_write_b32 a5, 0
    v_accvgpr_write_b32 a6, 0
    v_mfma_f32_16x16x32_bf16 a[92:95], v[52:55], v[124:127], a[92:95]
    v_accvgpr_write_b32 a7, 0
    v_mfma_f32_16x16x32_bf16 a[132:135], v[48:51], a[136:139], a[132:135]
    buffer_load_dwordx4 v13, s[20:23], s63 offen offset:3072 lds
    v_mfma_f32_16x16x32_bf16 a[132:135], v[52:55], a[140:143], a[132:135]
    s_waitcnt lgkmcnt(1)
    v_mfma_f32_16x16x32_bf16 a[96:99], v[56:59], v[96:99], a[96:99]
    v_mfma_f32_16x16x32_bf16 a[96:99], v[60:63], v[100:103], a[96:99]
    s_xor_b32 s63, s63, 128
    v_mfma_f32_16x16x32_bf16 a[100:103], v[56:59], v[104:107], a[100:103]
    v_mfma_f32_16x16x32_bf16 a[100:103], v[60:63], v[108:111], a[100:103]
    v_mfma_f32_16x16x32_bf16 a[104:107], v[56:59], v[112:115], a[104:107]
    v_mfma_f32_16x16x32_bf16 a[104:107], v[60:63], v[116:119], a[104:107]
    s_waitcnt vmcnt(10) lgkmcnt(0)
    s_barrier
    ds_read_b64_tr_b16 v[48:49], v14 offset:32768
    v_mfma_f32_16x16x32_bf16 a[108:111], v[56:59], v[120:123], a[108:111]
    s_add_u32 m0, s67, 131072
    ds_read_b64_tr_b16 v[50:51], v14 offset:33792
    ds_read_b64_tr_b16 v[52:53], v14 offset:40960
    v_mfma_f32_16x16x32_bf16 a[108:111], v[60:63], v[124:127], a[108:111]
    buffer_load_dwordx4 v1, s[28:31], s65 offen sc1 lds
    v_mfma_f32_16x16x32_bf16 a[112:115], v[40:43], v[96:99], a[112:115]
    ds_read_b64_tr_b16 v[54:55], v14 offset:41984
    ds_read_b64_tr_b16 v[56:57], v15 offset:32768
    v_mfma_f32_16x16x32_bf16 a[112:115], v[44:47], v[100:103], a[112:115]
    s_add_u32 s72, s70, 5120
    ds_read_b64_tr_b16 v[58:59], v15 offset:33792
    ds_read_b64_tr_b16 v[60:61], v15 offset:40960
    v_mfma_f32_16x16x32_bf16 a[116:119], v[40:43], v[104:107], a[116:119]
    ds_read_b64_tr_b16 v[62:63], v15 offset:41984
    ds_read_b128 a[136:139], v22 offset:0
    v_mfma_f32_16x16x32_bf16 a[116:119], v[44:47], v[108:111], a[116:119]
    ds_read_b128 a[140:143], v23 offset:0
    v_add_u32 v14, 0x10000, v14
    v_mfma_f32_16x16x32_bf16 a[120:123], v[40:43], v[112:115], a[120:123]
    v_add_u32 v15, 0x10000, v15
    v_add_u32 v22, 0x10000, v22
    v_mfma_f32_16x16x32_bf16 a[120:123], v[44:47], v[116:119], a[120:123]
    buffer_store_dwordx4 a[12:15], v1, s[36:39], s72 offen sc1
    v_mfma_f32_16x16x32_bf16 a[124:127], v[40:43], v[120:123], a[124:127]
    buffer_load_dwordx4 v1, s[28:31], s65 offen offset:1024 sc1 lds
    v_mfma_f32_16x16x32_bf16 a[124:127], v[44:47], v[124:127], a[124:127]
    s_waitcnt lgkmcnt(1)
    ds_read_b64_tr_b16 v[40:41], v16 offset:32768
    ds_read_b64_tr_b16 v[42:43], v16 offset:33792
    v_mfma_f32_16x16x32_bf16 v[128:131], v[48:51], v[64:67], v[128:131]
    ds_read_b64_tr_b16 v[44:45], v16 offset:40960
    ds_read_b64_tr_b16 v[46:47], v16 offset:41984
    v_mfma_f32_16x16x32_bf16 v[128:131], v[52:55], v[68:71], v[128:131]
    v_add_u32 v16, 0x10000, v16
    v_add_u32 v23, 0x10000, v23
    v_mfma_f32_16x16x32_bf16 v[132:135], v[48:51], v[72:75], v[132:135]
    ds_read_b128 v[96:99], v24 offset:49152
    v_accvgpr_write_b32 a12, 0
    v_mfma_f32_16x16x32_bf16 v[132:135], v[52:55], v[76:79], v[132:135]
    v_accvgpr_write_b32 a13, 0
    v_accvgpr_write_b32 a14, 0
    v_mfma_f32_16x16x32_bf16 v[136:139], v[48:51], v[80:83], v[136:139]
    v_accvgpr_write_b32 a15, 0
    v_mfma_f32_16x16x32_bf16 v[136:139], v[52:55], v[84:87], v[136:139]
    v_mfma_f32_16x16x32_bf16 v[140:143], v[48:51], v[88:91], v[140:143]
    s_add_u32 m0, s68, 139264
    ds_read_b64_tr_b16 v[48:49], v17 offset:32768
    ds_read_b64_tr_b16 v[50:51], v17 offset:33792
    v_mfma_f32_16x16x32_bf16 v[140:143], v[52:55], v[92:95], v[140:143]
    buffer_load_dwordx4 v6, s[20:23], s66 offen lds
    v_mfma_f32_16x16x32_bf16 v[144:147], v[56:59], v[64:67], v[144:147]
    ds_read_b64_tr_b16 v[52:53], v17 offset:40960
    ds_read_b64_tr_b16 v[54:55], v17 offset:41984
    v_mfma_f32_16x16x32_bf16 v[144:147], v[60:63], v[68:71], v[144:147]
    v_add_u32 v17, 0x10000, v17
    v_mfma_f32_16x16x32_bf16 v[148:151], v[56:59], v[72:75], v[148:151]
    v_mfma_f32_16x16x32_bf16 v[148:151], v[60:63], v[76:79], v[148:151]
    v_mfma_f32_16x16x32_bf16 v[152:155], v[56:59], v[80:83], v[152:155]
    v_mfma_f32_16x16x32_bf16 v[152:155], v[60:63], v[84:87], v[152:155]
    ds_read_b128 v[100:103], v25 offset:49152
    v_mfma_f32_16x16x32_bf16 v[156:159], v[56:59], v[88:91], v[156:159]
    s_add_u32 m0, s69, 147456
    ds_read_b64_tr_b16 v[56:57], v18 offset:32768
    ds_read_b64_tr_b16 v[58:59], v18 offset:33792
    v_mfma_f32_16x16x32_bf16 v[156:159], v[60:63], v[92:95], v[156:159]
    s_xor_b32 s65, s65, 57344
    buffer_load_dwordx4 v10, s[20:23], s64 offen lds
    s_waitcnt lgkmcnt(3)
    v_mfma_f32_16x16x32_bf16 v[160:163], v[40:43], v[64:67], v[160:163]
    s_xor_b32 s66, s66, 896
    ds_read_b64_tr_b16 v[60:61], v18 offset:40960
    ds_read_b64_tr_b16 v[62:63], v18 offset:41984
    v_mfma_f32_16x16x32_bf16 v[160:163], v[44:47], v[68:71], v[160:163]
    s_add_u32 s72, s70, 9216
    buffer_store_dwordx4 a[20:23], v1, s[36:39], s72 offen sc1
    v_mfma_f32_16x16x32_bf16 v[164:167], v[40:43], v[72:75], v[164:167]
    v_add_u32 v18, 0x10000, v18
    v_accvgpr_write_b32 a20, 0
    v_mfma_f32_16x16x32_bf16 v[164:167], v[44:47], v[76:79], v[164:167]
    v_accvgpr_write_b32 a21, 0
    v_accvgpr_write_b32 a22, 0
    v_mfma_f32_16x16x32_bf16 v[168:171], v[40:43], v[80:83], v[168:171]
    v_accvgpr_write_b32 a23, 0
    v_mfma_f32_16x16x32_bf16 v[168:171], v[44:47], v[84:87], v[168:171]
    v_mfma_f32_16x16x32_bf16 v[172:175], v[40:43], v[88:91], v[172:175]
    ds_read_b64_tr_b16 v[40:41], v19 offset:32768
    ds_read_b64_tr_b16 v[42:43], v19 offset:33792
    v_mfma_f32_16x16x32_bf16 v[172:175], v[44:47], v[92:95], v[172:175]
    ds_read_b64_tr_b16 v[44:45], v19 offset:40960
    ds_read_b64_tr_b16 v[46:47], v19 offset:41984
    v_mfma_f32_16x16x32_bf16 v[176:179], v[48:51], v[64:67], v[176:179]
    buffer_load_dwordx4 v11, s[20:23], s64 offen offset:1024 lds
    v_mfma_f32_16x16x32_bf16 v[176:179], v[52:55], v[68:71], v[176:179]
    ds_read_b128 v[104:107], v24 offset:57344
    v_add_u32 v19, 0x10000, v19
    v_mfma_f32_16x16x32_bf16 v[180:183], v[48:51], v[72:75], v[180:183]
    v_mfma_f32_16x16x32_bf16 v[180:183], v[52:55], v[76:79], v[180:183]
    v_mfma_f32_16x16x32_bf16 v[184:187], v[48:51], v[80:83], v[184:187]
    v_mfma_f32_16x16x32_bf16 v[184:187], v[52:55], v[84:87], v[184:187]
    v_mfma_f32_16x16x32_bf16 v[188:191], v[48:51], v[88:91], v[188:191]
    ds_read_b64_tr_b16 v[48:49], v20 offset:32768
    ds_read_b64_tr_b16 v[50:51], v20 offset:33792
    v_mfma_f32_16x16x32_bf16 v[188:191], v[52:55], v[92:95], v[188:191]
    s_waitcnt lgkmcnt(2)
    ds_read_b64_tr_b16 v[52:53], v20 offset:40960
    ds_read_b64_tr_b16 v[54:55], v20 offset:41984
    v_mfma_f32_16x16x32_bf16 v[192:195], v[56:59], v[64:67], v[192:195]
    buffer_load_dwordx4 v12, s[20:23], s64 offen offset:2048 lds
    v_mfma_f32_16x16x32_bf16 v[192:195], v[60:63], v[68:71], v[192:195]
    v_add_u32 v20, 0x10000, v20
    v_mfma_f32_16x16x32_bf16 v[196:199], v[56:59], v[72:75], v[196:199]
    v_mfma_f32_16x16x32_bf16 v[196:199], v[60:63], v[76:79], v[196:199]
    ds_read_b128 v[108:111], v25 offset:57344
    v_mfma_f32_16x16x32_bf16 v[200:203], v[56:59], v[80:83], v[200:203]
    v_mfma_f32_16x16x32_bf16 v[200:203], v[60:63], v[84:87], v[200:203]
    s_add_u32 s72, s70, 13312
    v_mfma_f32_16x16x32_bf16 v[204:207], v[56:59], v[88:91], v[204:207]
    ds_read_b64_tr_b16 v[56:57], v21 offset:32768
    ds_read_b64_tr_b16 v[58:59], v21 offset:33792
    v_mfma_f32_16x16x32_bf16 v[204:207], v[60:63], v[92:95], v[204:207]
    ds_read_b64_tr_b16 v[60:61], v21 offset:40960
    ds_read_b64_tr_b16 v[62:63], v21 offset:41984
    v_mfma_f32_16x16x32_bf16 v[208:211], v[40:43], v[64:67], v[208:211]
    buffer_store_dwordx4 a[28:31], v1, s[36:39], s72 offen sc1
    v_mfma_f32_16x16x32_bf16 v[208:211], v[44:47], v[68:71], v[208:211]
    buffer_load_dwordx4 v13, s[20:23], s64 offen offset:3072 lds
    v_mfma_f32_16x16x32_bf16 v[212:215], v[40:43], v[72:75], v[212:215]
    v_add_u32 v21, 0x10000, v21
    v_accvgpr_write_b32 a28, 0
    v_mfma_f32_16x16x32_bf16 v[212:215], v[44:47], v[76:79], v[212:215]
    v_accvgpr_write_b32 a29, 0
    v_accvgpr_write_b32 a30, 0
    v_mfma_f32_16x16x32_bf16 v[216:219], v[40:43], v[80:83], v[216:219]
    v_accvgpr_write_b32 a31, 0
    v_mfma_f32_16x16x32_bf16 v[216:219], v[44:47], v[84:87], v[216:219]
    v_mfma_f32_16x16x32_bf16 v[220:223], v[40:43], v[88:91], v[220:223]
    ds_read_b64_tr_b16 v[40:41], v26 offset:0
    ds_read_b64_tr_b16 v[42:43], v26 offset:512
    v_mfma_f32_16x16x32_bf16 v[220:223], v[44:47], v[92:95], v[220:223]
    s_waitcnt lgkmcnt(2)
    ds_read_b64_tr_b16 v[44:45], v26 offset:4096
    ds_read_b64_tr_b16 v[46:47], v26 offset:4608
    v_mfma_f32_16x16x32_bf16 v[224:227], v[48:51], v[64:67], v[224:227]
    v_add_u32 v26, 0x10000, v26
    v_mfma_f32_16x16x32_bf16 v[224:227], v[52:55], v[68:71], v[224:227]
    s_xor_b32 s64, s64, 128
    v_mfma_f32_16x16x32_bf16 v[228:231], v[48:51], v[72:75], v[228:231]
    v_mfma_f32_16x16x32_bf16 v[228:231], v[52:55], v[76:79], v[228:231]
    v_mfma_f32_16x16x32_bf16 v[232:235], v[48:51], v[80:83], v[232:235]
    v_mfma_f32_16x16x32_bf16 v[232:235], v[52:55], v[84:87], v[232:235]
    s_add_u32 m0, s69, 0
    v_mfma_f32_16x16x32_bf16 v[236:239], v[48:51], v[88:91], v[236:239]
    buffer_load_dwordx4 v2, s[24:27], s60 offen lds
    v_mfma_f32_16x16x32_bf16 v[236:239], v[52:55], v[92:95], v[236:239]
    ds_read_b64_tr_b16 v[48:49], v27 offset:0
    ds_read_b64_tr_b16 v[50:51], v27 offset:512
    v_mfma_f32_16x16x32_bf16 v[240:243], v[56:59], v[64:67], v[240:243]
    ds_read_b64_tr_b16 v[52:53], v27 offset:4096
    ds_read_b64_tr_b16 v[54:55], v27 offset:4608
    v_mfma_f32_16x16x32_bf16 v[240:243], v[60:63], v[68:71], v[240:243]
    v_add_u32 v27, 0x10000, v27
    v_mfma_f32_16x16x32_bf16 v[244:247], v[56:59], v[72:75], v[244:247]
    buffer_load_dwordx4 v3, s[24:27], s60 offen offset:1024 lds
    v_mfma_f32_16x16x32_bf16 v[244:247], v[60:63], v[76:79], v[244:247]
    s_add_u32 s72, s70, 33792
    v_mfma_f32_16x16x32_bf16 v[248:251], v[56:59], v[80:83], v[248:251]
    buffer_store_dwordx4 a[36:39], v1, s[36:39], s72 offen sc1
    v_mfma_f32_16x16x32_bf16 v[248:251], v[60:63], v[84:87], v[248:251]
    v_mfma_f32_16x16x32_bf16 v[252:255], v[56:59], v[88:91], v[252:255]
    buffer_load_dwordx4 v4, s[24:27], s60 offen offset:2048 lds
    v_mfma_f32_16x16x32_bf16 v[252:255], v[60:63], v[92:95], v[252:255]
    s_waitcnt lgkmcnt(0)
    ds_read_b64_tr_b16 v[56:57], v28 offset:0
    ds_read_b64_tr_b16 v[58:59], v28 offset:512
    v_mfma_f32_16x16x32_bf16 a[64:67], v[40:43], v[64:67], a[64:67]
    ds_read_b64_tr_b16 v[60:61], v28 offset:4096
    ds_read_b64_tr_b16 v[62:63], v28 offset:4608
    v_mfma_f32_16x16x32_bf16 a[64:67], v[44:47], v[68:71], a[64:67]
    v_add_u32 v24, 0x10000, v24
    v_add_u32 v28, 0x10000, v28
    v_mfma_f32_16x16x32_bf16 a[68:71], v[40:43], v[72:75], a[68:71]
    buffer_load_dwordx4 v5, s[24:27], s60 offen offset:3072 lds
    v_mfma_f32_16x16x32_bf16 a[68:71], v[44:47], v[76:79], a[68:71]
    ds_read_b128 v[112:115], v24 offset:16384
    v_accvgpr_write_b32 a36, 0
    v_mfma_f32_16x16x32_bf16 a[72:75], v[40:43], v[80:83], a[72:75]
    v_accvgpr_write_b32 a37, 0
    v_accvgpr_write_b32 a38, 0
    v_mfma_f32_16x16x32_bf16 a[72:75], v[44:47], v[84:87], a[72:75]
    s_add_u32 m0, s69, 16384
    v_add_u32 v25, 0x10000, v25
    v_accvgpr_write_b32 a39, 0
    v_mfma_f32_16x16x32_bf16 a[76:79], v[40:43], v[88:91], a[76:79]
    s_xor_b32 s60, s60, 524288
    buffer_load_dwordx4 v10, s[20:23], s63 offen lds
    v_mfma_f32_16x16x32_bf16 a[76:79], v[44:47], v[92:95], a[76:79]
    ds_read_b128 v[116:119], v25 offset:16384
    v_mfma_f32_16x16x32_bf16 a[128:131], v[40:43], a[136:139], a[128:131]
    ds_read_b64_tr_b16 v[40:41], v29 offset:0
    ds_read_b64_tr_b16 v[42:43], v29 offset:512
    v_mfma_f32_16x16x32_bf16 a[128:131], v[44:47], a[140:143], a[128:131]
    ds_read_b64_tr_b16 v[44:45], v29 offset:4096
    ds_read_b64_tr_b16 v[46:47], v29 offset:4608
    v_mfma_f32_16x16x32_bf16 a[80:83], v[48:51], v[64:67], a[80:83]
    buffer_load_dwordx4 v11, s[20:23], s63 offen offset:1024 lds
    v_mfma_f32_16x16x32_bf16 a[80:83], v[52:55], v[68:71], a[80:83]
    ds_read_b128 v[120:123], v24 offset:24576
    v_add_u32 v29, 0x10000, v29
    v_mfma_f32_16x16x32_bf16 a[84:87], v[48:51], v[72:75], a[84:87]
    v_mfma_f32_16x16x32_bf16 a[84:87], v[52:55], v[76:79], a[84:87]
    v_mfma_f32_16x16x32_bf16 a[88:91], v[48:51], v[80:83], a[88:91]
    buffer_load_dwordx4 v12, s[20:23], s63 offen offset:2048 lds
    v_mfma_f32_16x16x32_bf16 a[88:91], v[52:55], v[84:87], a[88:91]
    ds_read_b128 v[124:127], v25 offset:24576
    v_mfma_f32_16x16x32_bf16 a[92:95], v[48:51], v[88:91], a[92:95]
    v_mfma_f32_16x16x32_bf16 a[92:95], v[52:55], v[92:95], a[92:95]
    s_add_u32 s72, s70, 37888
    v_mfma_f32_16x16x32_bf16 a[132:135], v[48:51], a[136:139], a[132:135]
    buffer_load_dwordx4 v13, s[20:23], s63 offen offset:3072 lds
    v_mfma_f32_16x16x32_bf16 a[132:135], v[52:55], a[140:143], a[132:135]
    s_waitcnt lgkmcnt(1)
    v_mfma_f32_16x16x32_bf16 a[96:99], v[56:59], v[64:67], a[96:99]
    v_mfma_f32_16x16x32_bf16 a[96:99], v[60:63], v[68:71], a[96:99]
    s_xor_b32 s63, s63, 384
    v_mfma_f32_16x16x32_bf16 a[100:103], v[56:59], v[72:75], a[100:103]
    buffer_store_dwordx4 a[44:47], v1, s[36:39], s72 offen sc1
    v_mfma_f32_16x16x32_bf16 a[100:103], v[60:63], v[76:79], a[100:103]
    v_mfma_f32_16x16x32_bf16 a[104:107], v[56:59], v[80:83], a[104:107]
    v_accvgpr_write_b32 a44, 0
    v_accvgpr_write_b32 a45, 0
    v_mfma_f32_16x16x32_bf16 a[104:107], v[60:63], v[84:87], a[104:107]
    s_waitcnt vmcnt(10) lgkmcnt(0)
    s_barrier
    ds_read_b64_tr_b16 v[48:49], v14 offset:32768
    v_mfma_f32_16x16x32_bf16 a[108:111], v[56:59], v[88:91], a[108:111]
    s_add_u32 m0, s67, 32768
    ds_read_b64_tr_b16 v[50:51], v14 offset:33792
    ds_read_b64_tr_b16 v[52:53], v14 offset:40960
    v_mfma_f32_16x16x32_bf16 a[108:111], v[60:63], v[92:95], a[108:111]
    buffer_load_dwordx4 v1, s[28:31], s65 offen sc1 lds
    v_mfma_f32_16x16x32_bf16 a[112:115], v[40:43], v[64:67], a[112:115]
    ds_read_b64_tr_b16 v[54:55], v14 offset:41984
    ds_read_b64_tr_b16 v[56:57], v15 offset:32768
    v_mfma_f32_16x16x32_bf16 a[112:115], v[44:47], v[68:71], a[112:115]
    ds_read_b64_tr_b16 v[58:59], v15 offset:33792
    ds_read_b64_tr_b16 v[60:61], v15 offset:40960
    v_mfma_f32_16x16x32_bf16 a[116:119], v[40:43], v[72:75], a[116:119]
    ds_read_b64_tr_b16 v[62:63], v15 offset:41984
    ds_read_b128 a[136:139], v22 offset:0
    v_mfma_f32_16x16x32_bf16 a[116:119], v[44:47], v[76:79], a[116:119]
    ds_read_b128 a[140:143], v23 offset:0
    v_add_u32 v14, 0xffff0000, v14
    v_mfma_f32_16x16x32_bf16 a[120:123], v[40:43], v[80:83], a[120:123]
    v_add_u32 v15, 0xffff0000, v15
    v_add_u32 v22, 0xfffe0000, v22
    v_mfma_f32_16x16x32_bf16 a[120:123], v[44:47], v[84:87], a[120:123]
    v_add_u32 v23, 0xfffe0000, v23
    v_accvgpr_write_b32 a46, 0
    v_mfma_f32_16x16x32_bf16 a[124:127], v[40:43], v[88:91], a[124:127]
    buffer_load_dwordx4 v1, s[28:31], s65 offen offset:1024 sc1 lds
    v_mfma_f32_16x16x32_bf16 a[124:127], v[44:47], v[92:95], a[124:127]
    s_waitcnt lgkmcnt(1)
    ds_read_b64_tr_b16 v[40:41], v16 offset:32768
    ds_read_b64_tr_b16 v[42:43], v16 offset:33792
    v_mfma_f32_16x16x32_bf16 v[128:131], v[48:51], v[96:99], v[128:131]
    ds_read_b64_tr_b16 v[44:45], v16 offset:40960
    ds_read_b64_tr_b16 v[46:47], v16 offset:41984
    v_mfma_f32_16x16x32_bf16 v[128:131], v[52:55], v[100:103], v[128:131]
    v_add_u32 v16, 0xffff0000, v16
    v_accvgpr_write_b32 a47, 0
    v_mfma_f32_16x16x32_bf16 v[132:135], v[48:51], v[104:107], v[132:135]
    ds_read_b128 v[64:67], v24 offset:49152
    v_mfma_f32_16x16x32_bf16 v[132:135], v[52:55], v[108:111], v[132:135]
    s_add_u32 s72, s70, 41984
    v_mfma_f32_16x16x32_bf16 v[136:139], v[48:51], v[112:115], v[136:139]
    buffer_store_dwordx4 a[52:55], v1, s[36:39], s72 offen sc1
    v_mfma_f32_16x16x32_bf16 v[136:139], v[52:55], v[116:119], v[136:139]
    v_mfma_f32_16x16x32_bf16 v[140:143], v[48:51], v[120:123], v[140:143]
    s_add_u32 m0, s68, 40960
    ds_read_b64_tr_b16 v[48:49], v17 offset:32768
    ds_read_b64_tr_b16 v[50:51], v17 offset:33792
    v_mfma_f32_16x16x32_bf16 v[140:143], v[52:55], v[124:127], v[140:143]
    buffer_load_dwordx4 v6, s[20:23], s66 offen lds
    v_mfma_f32_16x16x32_bf16 v[144:147], v[56:59], v[96:99], v[144:147]
    ds_read_b64_tr_b16 v[52:53], v17 offset:40960
    ds_read_b64_tr_b16 v[54:55], v17 offset:41984
    v_mfma_f32_16x16x32_bf16 v[144:147], v[60:63], v[100:103], v[144:147]
    v_add_u32 v17, 0xffff0000, v17
    v_accvgpr_write_b32 a52, 0
    v_mfma_f32_16x16x32_bf16 v[148:151], v[56:59], v[104:107], v[148:151]
    v_accvgpr_write_b32 a53, 0
    v_accvgpr_write_b32 a54, 0
    v_mfma_f32_16x16x32_bf16 v[148:151], v[60:63], v[108:111], v[148:151]
    v_accvgpr_write_b32 a55, 0
    v_mfma_f32_16x16x32_bf16 v[152:155], v[56:59], v[112:115], v[152:155]
    v_mfma_f32_16x16x32_bf16 v[152:155], v[60:63], v[116:119], v[152:155]
    ds_read_b128 v[68:71], v25 offset:49152
    v_mfma_f32_16x16x32_bf16 v[156:159], v[56:59], v[120:123], v[156:159]
    s_add_u32 m0, s69, 49152
    ds_read_b64_tr_b16 v[56:57], v18 offset:32768
    ds_read_b64_tr_b16 v[58:59], v18 offset:33792
    v_mfma_f32_16x16x32_bf16 v[156:159], v[60:63], v[124:127], v[156:159]
    s_xor_b32 s65, s65, 8192
    buffer_load_dwordx4 v10, s[20:23], s64 offen lds
    s_waitcnt lgkmcnt(3)
    v_mfma_f32_16x16x32_bf16 v[160:163], v[40:43], v[96:99], v[160:163]
    s_xor_b32 s66, s66, 128
    ds_read_b64_tr_b16 v[60:61], v18 offset:40960
    ds_read_b64_tr_b16 v[62:63], v18 offset:41984
    v_mfma_f32_16x16x32_bf16 v[160:163], v[44:47], v[100:103], v[160:163]
    v_add_u32 v18, 0xffff0000, v18
    v_mfma_f32_16x16x32_bf16 v[164:167], v[40:43], v[104:107], v[164:167]
    v_mfma_f32_16x16x32_bf16 v[164:167], v[44:47], v[108:111], v[164:167]
    v_mfma_f32_16x16x32_bf16 v[168:171], v[40:43], v[112:115], v[168:171]
    v_mfma_f32_16x16x32_bf16 v[168:171], v[44:47], v[116:119], v[168:171]
    v_mfma_f32_16x16x32_bf16 v[172:175], v[40:43], v[120:123], v[172:175]
    ds_read_b64_tr_b16 v[40:41], v19 offset:32768
    ds_read_b64_tr_b16 v[42:43], v19 offset:33792
    v_mfma_f32_16x16x32_bf16 v[172:175], v[44:47], v[124:127], v[172:175]
    ds_read_b64_tr_b16 v[44:45], v19 offset:40960
    ds_read_b64_tr_b16 v[46:47], v19 offset:41984
    v_mfma_f32_16x16x32_bf16 v[176:179], v[48:51], v[96:99], v[176:179]
    buffer_load_dwordx4 v11, s[20:23], s64 offen offset:1024 lds
    v_mfma_f32_16x16x32_bf16 v[176:179], v[52:55], v[100:103], v[176:179]
    s_add_u32 s72, s70, 46080
    ds_read_b128 v[72:75], v24 offset:57344
    v_add_u32 v19, 0xffff0000, v19
    v_mfma_f32_16x16x32_bf16 v[180:183], v[48:51], v[104:107], v[180:183]
    s_mul_i32 s70, s7, 36864
    buffer_store_dwordx4 a[60:63], v1, s[36:39], s72 offen sc1
    v_mfma_f32_16x16x32_bf16 v[180:183], v[52:55], v[108:111], v[180:183]
    s_add_u32 s70, s70, s99
    v_accvgpr_write_b32 a60, 0
    v_accvgpr_write_b32 a61, 0
    v_mfma_f32_16x16x32_bf16 v[184:187], v[48:51], v[112:115], v[184:187]
    s_lshr_b32 s99, s69, 5
    v_accvgpr_write_b32 a62, 0
    v_accvgpr_write_b32 a63, 0
    v_mfma_f32_16x16x32_bf16 v[184:187], v[52:55], v[116:119], v[184:187]
    s_add_u32 s99, s99, s98
    v_mfma_f32_16x16x32_bf16 v[188:191], v[48:51], v[120:123], v[188:191]
    s_mul_hi_u32 s7, s2, 715827883
    ds_read_b64_tr_b16 v[48:49], v20 offset:32768
    ds_read_b64_tr_b16 v[50:51], v20 offset:33792
    v_mfma_f32_16x16x32_bf16 v[188:191], v[52:55], v[124:127], v[188:191]
    s_mul_i32 s100, s7, 6
    ds_read_b64_tr_b16 v[52:53], v20 offset:40960
    ds_read_b64_tr_b16 v[54:55], v20 offset:41984
    s_waitcnt lgkmcnt(4)
    v_mfma_f32_16x16x32_bf16 v[192:195], v[56:59], v[96:99], v[192:195]
    s_sub_u32 s100, s2, s100
    buffer_load_dwordx4 v12, s[20:23], s64 offen offset:2048 lds
    v_mfma_f32_16x16x32_bf16 v[192:195], v[60:63], v[100:103], v[192:195]
    s_mul_i32 s100, s100, 6
    v_add_u32 v20, 0xffff0000, v20
    v_mfma_f32_16x16x32_bf16 v[196:199], v[56:59], v[104:107], v[196:199]
    s_lshl1_add_u32 s100, s4, s100
    v_mfma_f32_16x16x32_bf16 v[196:199], v[60:63], v[108:111], v[196:199]
    s_sub_u32 s100, s100, 2
    ds_read_b128 v[76:79], v25 offset:57344
    v_mfma_f32_16x16x32_bf16 v[200:203], v[56:59], v[112:115], v[200:203]
    v_mfma_f32_16x16x32_bf16 v[200:203], v[60:63], v[116:119], v[200:203]
    v_mfma_f32_16x16x32_bf16 v[204:207], v[56:59], v[120:123], v[204:207]
    ds_read_b64_tr_b16 v[56:57], v21 offset:32768
    ds_read_b64_tr_b16 v[58:59], v21 offset:33792
    v_mfma_f32_16x16x32_bf16 v[204:207], v[60:63], v[124:127], v[204:207]
    ds_read_b64_tr_b16 v[60:61], v21 offset:40960
    ds_read_b64_tr_b16 v[62:63], v21 offset:41984
    v_mfma_f32_16x16x32_bf16 v[208:211], v[40:43], v[96:99], v[208:211]
    v_add_u32 v21, 0xffff0000, v21
    v_accvgpr_read_b32 v32, a144
    v_mfma_f32_16x16x32_bf16 v[208:211], v[44:47], v[100:103], v[208:211]
    buffer_load_dwordx4 v13, s[20:23], s64 offen offset:3072 lds
    v_mfma_f32_16x16x32_bf16 v[212:215], v[40:43], v[104:107], v[212:215]
    v_accvgpr_read_b32 v31, a145
    v_cvt_pk_bf16_f32 v32, v32, v31
    v_mfma_f32_16x16x32_bf16 v[212:215], v[44:47], v[108:111], v[212:215]
    v_accvgpr_read_b32 v33, a146
    v_accvgpr_read_b32 v31, a147
    v_mfma_f32_16x16x32_bf16 v[216:219], v[40:43], v[112:115], v[216:219]
    v_cvt_pk_bf16_f32 v33, v33, v31
    v_accvgpr_read_b32 v34, a148
    v_mfma_f32_16x16x32_bf16 v[216:219], v[44:47], v[116:119], v[216:219]
    v_accvgpr_read_b32 v31, a149
    v_cvt_pk_bf16_f32 v34, v34, v31
    v_mfma_f32_16x16x32_bf16 v[220:223], v[40:43], v[120:123], v[220:223]
    ds_read_b64_tr_b16 v[40:41], v26 offset:0
    ds_read_b64_tr_b16 v[42:43], v26 offset:512
    v_mfma_f32_16x16x32_bf16 v[220:223], v[44:47], v[124:127], v[220:223]
    s_add_u32 s72, s71, 32768
    ds_read_b64_tr_b16 v[44:45], v26 offset:4096
    ds_read_b64_tr_b16 v[46:47], v26 offset:4608
    s_waitcnt lgkmcnt(4)
    v_mfma_f32_16x16x32_bf16 v[224:227], v[48:51], v[96:99], v[224:227]
    v_add_u32 v26, 0xfffe0000, v26
    v_accvgpr_read_b32 v35, a150
    v_mfma_f32_16x16x32_bf16 v[224:227], v[52:55], v[100:103], v[224:227]
    s_xor_b32 s64, s64, 384
    v_accvgpr_read_b32 v31, a151
    v_cvt_pk_bf16_f32 v35, v35, v31
    v_mfma_f32_16x16x32_bf16 v[228:231], v[48:51], v[104:107], v[228:231]
    buffer_store_dwordx4 v[32:35], v1, s[36:39], s72 offen sc1
    v_mfma_f32_16x16x32_bf16 v[228:231], v[52:55], v[108:111], v[228:231]
    v_accvgpr_write_b32 a144, 0
    v_accvgpr_write_b32 a145, 0
    v_mfma_f32_16x16x32_bf16 v[232:235], v[48:51], v[112:115], v[232:235]
    v_accvgpr_write_b32 a146, 0
    v_accvgpr_write_b32 a147, 0
    v_mfma_f32_16x16x32_bf16 v[232:235], v[52:55], v[116:119], v[232:235]
    s_add_u32 m0, s69, 65536
    v_accvgpr_write_b32 a148, 0
    v_accvgpr_write_b32 a149, 0
    v_mfma_f32_16x16x32_bf16 v[236:239], v[48:51], v[120:123], v[236:239]
    buffer_load_dwordx4 v2, s[24:27], s60 offen lds
    v_mfma_f32_16x16x32_bf16 v[236:239], v[52:55], v[124:127], v[236:239]
    ds_read_b64_tr_b16 v[48:49], v27 offset:0
    ds_read_b64_tr_b16 v[50:51], v27 offset:512
    v_mfma_f32_16x16x32_bf16 v[240:243], v[56:59], v[96:99], v[240:243]
    ds_read_b64_tr_b16 v[52:53], v27 offset:4096
    ds_read_b64_tr_b16 v[54:55], v27 offset:4608
    v_mfma_f32_16x16x32_bf16 v[240:243], v[60:63], v[100:103], v[240:243]
    v_add_u32 v27, 0xfffe0000, v27
    v_accvgpr_write_b32 a150, 0
    v_mfma_f32_16x16x32_bf16 v[244:247], v[56:59], v[104:107], v[244:247]
    buffer_load_dwordx4 v3, s[24:27], s60 offen offset:1024 lds
    v_mfma_f32_16x16x32_bf16 v[244:247], v[60:63], v[108:111], v[244:247]
    v_accvgpr_write_b32 a151, 0
    v_mfma_f32_16x16x32_bf16 v[248:251], v[56:59], v[112:115], v[248:251]
    v_accvgpr_read_b32 v36, a152
    v_accvgpr_read_b32 v31, a153
    v_mfma_f32_16x16x32_bf16 v[248:251], v[60:63], v[116:119], v[248:251]
    v_cvt_pk_bf16_f32 v36, v36, v31
    v_accvgpr_read_b32 v37, a154
    v_mfma_f32_16x16x32_bf16 v[252:255], v[56:59], v[120:123], v[252:255]
    buffer_load_dwordx4 v4, s[24:27], s60 offen offset:2048 lds
    v_mfma_f32_16x16x32_bf16 v[252:255], v[60:63], v[124:127], v[252:255]
    s_waitcnt lgkmcnt(0)
    ds_read_b64_tr_b16 v[56:57], v28 offset:0
    ds_read_b64_tr_b16 v[58:59], v28 offset:512
    v_mfma_f32_16x16x32_bf16 a[64:67], v[40:43], v[96:99], a[64:67]
    ds_read_b64_tr_b16 v[60:61], v28 offset:4096
    ds_read_b64_tr_b16 v[62:63], v28 offset:4608
    v_mfma_f32_16x16x32_bf16 a[64:67], v[44:47], v[100:103], a[64:67]
    v_add_u32 v24, 0x10000, v24
    v_add_u32 v28, 0xfffe0000, v28
    v_mfma_f32_16x16x32_bf16 a[68:71], v[40:43], v[104:107], a[68:71]
    buffer_load_dwordx4 v5, s[24:27], s60 offen offset:3072 lds
    v_mfma_f32_16x16x32_bf16 a[68:71], v[44:47], v[108:111], a[68:71]
    ds_read_b128 v[80:83], v24 offset:16384
    v_accvgpr_read_b32 v31, a155
    v_mfma_f32_16x16x32_bf16 a[72:75], v[40:43], v[112:115], a[72:75]
    v_cvt_pk_bf16_f32 v37, v37, v31
    v_accvgpr_read_b32 v38, a156
    v_mfma_f32_16x16x32_bf16 a[72:75], v[44:47], v[116:119], a[72:75]
    s_add_u32 m0, s69, 81920
    v_add_u32 v25, 0x10000, v25
    v_accvgpr_read_b32 v31, a157
    v_mfma_f32_16x16x32_bf16 a[76:79], v[40:43], v[120:123], a[76:79]
    s_xor_b32 s60, s60, 1572864
    buffer_load_dwordx4 v10, s[20:23], s63 offen lds
    v_mfma_f32_16x16x32_bf16 a[76:79], v[44:47], v[124:127], a[76:79]
    s_add_u32 s72, s71, 33792
    ds_read_b128 v[84:87], v25 offset:16384
    v_cvt_pk_bf16_f32 v38, v38, v31
    v_mfma_f32_16x16x32_bf16 a[128:131], v[40:43], a[136:139], a[128:131]
    ds_read_b64_tr_b16 v[40:41], v29 offset:0
    ds_read_b64_tr_b16 v[42:43], v29 offset:512
    v_mfma_f32_16x16x32_bf16 a[128:131], v[44:47], a[140:143], a[128:131]
    ds_read_b64_tr_b16 v[44:45], v29 offset:4096
    ds_read_b64_tr_b16 v[46:47], v29 offset:4608
    v_mfma_f32_16x16x32_bf16 a[80:83], v[48:51], v[96:99], a[80:83]
    buffer_load_dwordx4 v11, s[20:23], s63 offen offset:1024 lds
    v_mfma_f32_16x16x32_bf16 a[80:83], v[52:55], v[100:103], a[80:83]
    ds_read_b128 v[88:91], v24 offset:24576
    v_add_u32 v29, 0xfffe0000, v29
    v_mfma_f32_16x16x32_bf16 a[84:87], v[48:51], v[104:107], a[84:87]
    v_accvgpr_read_b32 v39, a158
    v_accvgpr_read_b32 v31, a159
    v_mfma_f32_16x16x32_bf16 a[84:87], v[52:55], v[108:111], a[84:87]
    v_cvt_pk_bf16_f32 v39, v39, v31
    v_accvgpr_write_b32 a152, 0
    v_mfma_f32_16x16x32_bf16 a[88:91], v[48:51], v[112:115], a[88:91]
    buffer_load_dwordx4 v12, s[20:23], s63 offen offset:2048 lds
    v_mfma_f32_16x16x32_bf16 a[88:91], v[52:55], v[116:119], a[88:91]
    ds_read_b128 v[92:95], v25 offset:24576
    v_accvgpr_write_b32 a153, 0
    v_mfma_f32_16x16x32_bf16 a[92:95], v[48:51], v[120:123], a[92:95]
    buffer_store_dwordx4 v[36:39], v1, s[36:39], s72 offen sc1
    v_mfma_f32_16x16x32_bf16 a[92:95], v[52:55], v[124:127], a[92:95]
    v_accvgpr_write_b32 a154, 0
    v_accvgpr_write_b32 a155, 0
    v_mfma_f32_16x16x32_bf16 a[132:135], v[48:51], a[136:139], a[132:135]
    buffer_load_dwordx4 v13, s[20:23], s63 offen offset:3072 lds
    v_mfma_f32_16x16x32_bf16 a[132:135], v[52:55], a[140:143], a[132:135]
    s_waitcnt lgkmcnt(1)
    v_accvgpr_read_b32 v32, a160
    v_accvgpr_read_b32 v31, a161
    v_mfma_f32_16x16x32_bf16 a[96:99], v[56:59], v[96:99], a[96:99]
    v_cvt_pk_bf16_f32 v32, v32, v31
    v_accvgpr_read_b32 v33, a162
    v_mfma_f32_16x16x32_bf16 a[96:99], v[60:63], v[100:103], a[96:99]
    s_xor_b32 s63, s63, 128
    v_accvgpr_read_b32 v31, a163
    v_cvt_pk_bf16_f32 v33, v33, v31
    v_mfma_f32_16x16x32_bf16 a[100:103], v[56:59], v[104:107], a[100:103]
    v_accvgpr_read_b32 v34, a164
    v_accvgpr_read_b32 v31, a165
    v_mfma_f32_16x16x32_bf16 a[100:103], v[60:63], v[108:111], a[100:103]
    v_cvt_pk_bf16_f32 v34, v34, v31
    v_accvgpr_read_b32 v35, a166
    v_mfma_f32_16x16x32_bf16 a[104:107], v[56:59], v[112:115], a[104:107]
    v_accvgpr_read_b32 v31, a167
    v_cvt_pk_bf16_f32 v35, v35, v31
    v_mfma_f32_16x16x32_bf16 a[104:107], v[60:63], v[116:119], a[104:107]
    s_waitcnt vmcnt(10) lgkmcnt(0)
    s_barrier
    ds_read_b64_tr_b16 v[48:49], v14 offset:0
    v_mfma_f32_16x16x32_bf16 a[108:111], v[56:59], v[120:123], a[108:111]
    s_add_u32 m0, s67, 98304
    ds_read_b64_tr_b16 v[50:51], v14 offset:1024
    ds_read_b64_tr_b16 v[52:53], v14 offset:8192
    v_mfma_f32_16x16x32_bf16 a[108:111], v[60:63], v[124:127], a[108:111]
    s_add_u32 s72, s71, 2048
    buffer_load_dwordx4 v1, s[28:31], s65 offen sc1 lds
    v_mfma_f32_16x16x32_bf16 a[112:115], v[40:43], v[96:99], a[112:115]
    ds_read_b64_tr_b16 v[54:55], v14 offset:9216
    ds_read_b64_tr_b16 v[56:57], v15 offset:0
    v_mfma_f32_16x16x32_bf16 a[112:115], v[44:47], v[100:103], a[112:115]
    ds_read_b64_tr_b16 v[58:59], v15 offset:1024
    ds_read_b64_tr_b16 v[60:61], v15 offset:8192
    v_mfma_f32_16x16x32_bf16 a[116:119], v[40:43], v[104:107], a[116:119]
    ds_read_b64_tr_b16 v[62:63], v15 offset:9216
    ds_read_b128 a[136:139], v22 offset:32768
    v_mfma_f32_16x16x32_bf16 a[116:119], v[44:47], v[108:111], a[116:119]
    ds_read_b128 a[140:143], v23 offset:32768
    v_add_u32 v14, 0x10000, v14
    v_mfma_f32_16x16x32_bf16 a[120:123], v[40:43], v[112:115], a[120:123]
    v_add_u32 v15, 0x10000, v15
    v_add_u32 v22, 0x10000, v22
    v_mfma_f32_16x16x32_bf16 a[120:123], v[44:47], v[116:119], a[120:123]
    v_add_u32 v23, 0x10000, v23
    v_accvgpr_write_b32 a156, 0
    v_mfma_f32_16x16x32_bf16 a[124:127], v[40:43], v[120:123], a[124:127]
    buffer_load_dwordx4 v1, s[28:31], s65 offen offset:1024 sc1 lds
    v_mfma_f32_16x16x32_bf16 a[124:127], v[44:47], v[124:127], a[124:127]
    s_waitcnt lgkmcnt(1)
    ds_read_b64_tr_b16 v[40:41], v16 offset:0
    ds_read_b64_tr_b16 v[42:43], v16 offset:1024
    v_mfma_f32_16x16x32_bf16 v[128:131], v[48:51], v[64:67], v[128:131]
    ds_read_b64_tr_b16 v[44:45], v16 offset:8192
    ds_read_b64_tr_b16 v[46:47], v16 offset:9216
    v_mfma_f32_16x16x32_bf16 v[128:131], v[52:55], v[68:71], v[128:131]
    v_add_u32 v24, 0xfffe0000, v24
    v_add_u32 v16, 0x10000, v16
    v_mfma_f32_16x16x32_bf16 v[132:135], v[48:51], v[72:75], v[132:135]
    ds_read_b128 v[96:99], v24 offset:16384
    v_accvgpr_write_b32 a157, 0
    v_mfma_f32_16x16x32_bf16 v[132:135], v[52:55], v[76:79], v[132:135]
    buffer_store_dwordx4 v[32:35], v1, s[36:39], s72 offen sc1
    v_mfma_f32_16x16x32_bf16 v[136:139], v[48:51], v[80:83], v[136:139]
    v_accvgpr_read_b32 v36, a168
    v_accvgpr_read_b32 v31, a169
    v_mfma_f32_16x16x32_bf16 v[136:139], v[52:55], v[84:87], v[136:139]
    v_cvt_pk_bf16_f32 v36, v36, v31
    v_accvgpr_read_b32 v37, a170
    v_mfma_f32_16x16x32_bf16 v[140:143], v[48:51], v[88:91], v[140:143]
    s_add_u32 m0, s68, 106496
    ds_read_b64_tr_b16 v[48:49], v17 offset:0
    ds_read_b64_tr_b16 v[50:51], v17 offset:1024
    v_mfma_f32_16x16x32_bf16 v[140:143], v[52:55], v[92:95], v[140:143]
    buffer_load_dwordx4 v6, s[20:23], s66 offen lds
    v_mfma_f32_16x16x32_bf16 v[144:147], v[56:59], v[64:67], v[144:147]
    ds_read_b64_tr_b16 v[52:53], v17 offset:8192
    ds_read_b64_tr_b16 v[54:55], v17 offset:9216
    v_mfma_f32_16x16x32_bf16 v[144:147], v[60:63], v[68:71], v[144:147]
    v_add_u32 v17, 0x10000, v17
    v_accvgpr_read_b32 v31, a171
    v_mfma_f32_16x16x32_bf16 v[148:151], v[56:59], v[72:75], v[148:151]
    v_cvt_pk_bf16_f32 v37, v37, v31
    v_accvgpr_read_b32 v38, a172
    v_mfma_f32_16x16x32_bf16 v[148:151], v[60:63], v[76:79], v[148:151]
    v_accvgpr_read_b32 v31, a173
    v_cvt_pk_bf16_f32 v38, v38, v31
    v_mfma_f32_16x16x32_bf16 v[152:155], v[56:59], v[80:83], v[152:155]
    v_add_u32 v25, 0xfffe0000, v25
    v_accvgpr_read_b32 v39, a174
    v_mfma_f32_16x16x32_bf16 v[152:155], v[60:63], v[84:87], v[152:155]
    s_add_u32 s72, s71, 3072
    ds_read_b128 v[100:103], v25 offset:16384
    v_accvgpr_read_b32 v31, a175
    v_mfma_f32_16x16x32_bf16 v[156:159], v[56:59], v[88:91], v[156:159]
    s_add_u32 m0, s69, 114688
    ds_read_b64_tr_b16 v[56:57], v18 offset:0
    ds_read_b64_tr_b16 v[58:59], v18 offset:1024
    v_mfma_f32_16x16x32_bf16 v[156:159], v[60:63], v[92:95], v[156:159]
    s_xor_b32 s65, s65, 24576
    buffer_load_dwordx4 v10, s[20:23], s64 offen lds
    s_waitcnt lgkmcnt(3)
    v_mfma_f32_16x16x32_bf16 v[160:163], v[40:43], v[64:67], v[160:163]
    s_xor_b32 s66, s66, 384
    ds_read_b64_tr_b16 v[60:61], v18 offset:8192
    ds_read_b64_tr_b16 v[62:63], v18 offset:9216
    v_mfma_f32_16x16x32_bf16 v[160:163], v[44:47], v[68:71], v[160:163]
    v_add_u32 v18, 0x10000, v18
    v_cvt_pk_bf16_f32 v39, v39, v31
    v_mfma_f32_16x16x32_bf16 v[164:167], v[40:43], v[72:75], v[164:167]
    buffer_store_dwordx4 v[36:39], v1, s[36:39], s72 offen sc1
    v_mfma_f32_16x16x32_bf16 v[164:167], v[44:47], v[76:79], v[164:167]
    v_accvgpr_write_b32 a158, 0
    v_accvgpr_write_b32 a159, 0
    v_mfma_f32_16x16x32_bf16 v[168:171], v[40:43], v[80:83], v[168:171]
    v_accvgpr_write_b32 a160, 0
    v_accvgpr_write_b32 a161, 0
    v_mfma_f32_16x16x32_bf16 v[168:171], v[44:47], v[84:87], v[168:171]
    v_accvgpr_write_b32 a162, 0
    v_accvgpr_write_b32 a163, 0
    v_mfma_f32_16x16x32_bf16 v[172:175], v[40:43], v[88:91], v[172:175]
    ds_read_b64_tr_b16 v[40:41], v19 offset:0
    ds_read_b64_tr_b16 v[42:43], v19 offset:1024
    v_mfma_f32_16x16x32_bf16 v[172:175], v[44:47], v[92:95], v[172:175]
    ds_read_b64_tr_b16 v[44:45], v19 offset:8192
    ds_read_b64_tr_b16 v[46:47], v19 offset:9216
    v_mfma_f32_16x16x32_bf16 v[176:179], v[48:51], v[64:67], v[176:179]
    buffer_load_dwordx4 v11, s[20:23], s64 offen offset:1024 lds
    v_mfma_f32_16x16x32_bf16 v[176:179], v[52:55], v[68:71], v[176:179]
    ds_read_b128 v[104:107], v24 offset:24576
    v_add_u32 v19, 0x10000, v19
    v_mfma_f32_16x16x32_bf16 v[180:183], v[48:51], v[72:75], v[180:183]
    v_accvgpr_read_b32 v32, a176
    v_accvgpr_read_b32 v31, a177
    v_mfma_f32_16x16x32_bf16 v[180:183], v[52:55], v[76:79], v[180:183]
    v_cvt_pk_bf16_f32 v32, v32, v31
    v_accvgpr_read_b32 v33, a178
    v_mfma_f32_16x16x32_bf16 v[184:187], v[48:51], v[80:83], v[184:187]
    v_accvgpr_read_b32 v31, a179
    v_cvt_pk_bf16_f32 v33, v33, v31
    v_mfma_f32_16x16x32_bf16 v[184:187], v[52:55], v[84:87], v[184:187]
    v_accvgpr_read_b32 v34, a180
    v_accvgpr_read_b32 v31, a181
    v_mfma_f32_16x16x32_bf16 v[188:191], v[48:51], v[88:91], v[188:191]
    ds_read_b64_tr_b16 v[48:49], v20 offset:0
    ds_read_b64_tr_b16 v[50:51], v20 offset:1024
    v_mfma_f32_16x16x32_bf16 v[188:191], v[52:55], v[92:95], v[188:191]
    s_waitcnt lgkmcnt(2)
    ds_read_b64_tr_b16 v[52:53], v20 offset:8192
    ds_read_b64_tr_b16 v[54:55], v20 offset:9216
    v_mfma_f32_16x16x32_bf16 v[192:195], v[56:59], v[64:67], v[192:195]
    buffer_load_dwordx4 v12, s[20:23], s64 offen offset:2048 lds
    v_mfma_f32_16x16x32_bf16 v[192:195], v[60:63], v[68:71], v[192:195]
    v_add_u32 v20, 0x10000, v20
    v_cvt_pk_bf16_f32 v34, v34, v31
    v_mfma_f32_16x16x32_bf16 v[196:199], v[56:59], v[72:75], v[196:199]
    v_accvgpr_read_b32 v35, a182
    v_accvgpr_read_b32 v31, a183
    v_mfma_f32_16x16x32_bf16 v[196:199], v[60:63], v[76:79], v[196:199]
    s_add_u32 s72, s71, 34816
    ds_read_b128 v[108:111], v25 offset:24576
    v_cvt_pk_bf16_f32 v35, v35, v31
    v_mfma_f32_16x16x32_bf16 v[200:203], v[56:59], v[80:83], v[200:203]
    buffer_store_dwordx4 v[32:35], v1, s[36:39], s72 offen sc1
    v_mfma_f32_16x16x32_bf16 v[200:203], v[60:63], v[84:87], v[200:203]
    v_accvgpr_write_b32 a164, 0
    v_accvgpr_write_b32 a165, 0
    v_mfma_f32_16x16x32_bf16 v[204:207], v[56:59], v[88:91], v[204:207]
    ds_read_b64_tr_b16 v[56:57], v21 offset:0
    ds_read_b64_tr_b16 v[58:59], v21 offset:1024
    v_mfma_f32_16x16x32_bf16 v[204:207], v[60:63], v[92:95], v[204:207]
    ds_read_b64_tr_b16 v[60:61], v21 offset:8192
    ds_read_b64_tr_b16 v[62:63], v21 offset:9216
    v_mfma_f32_16x16x32_bf16 v[208:211], v[40:43], v[64:67], v[208:211]
    v_add_u32 v21, 0x10000, v21
    v_accvgpr_write_b32 a166, 0
    v_mfma_f32_16x16x32_bf16 v[208:211], v[44:47], v[68:71], v[208:211]
    buffer_load_dwordx4 v13, s[20:23], s64 offen offset:3072 lds
    v_mfma_f32_16x16x32_bf16 v[212:215], v[40:43], v[72:75], v[212:215]
    v_accvgpr_write_b32 a167, 0
    v_accvgpr_write_b32 a168, 0
    v_mfma_f32_16x16x32_bf16 v[212:215], v[44:47], v[76:79], v[212:215]
    v_accvgpr_write_b32 a169, 0
    v_accvgpr_write_b32 a170, 0
    v_mfma_f32_16x16x32_bf16 v[216:219], v[40:43], v[80:83], v[216:219]
    v_accvgpr_write_b32 a171, 0
    v_accvgpr_write_b32 a172, 0
    v_mfma_f32_16x16x32_bf16 v[216:219], v[44:47], v[84:87], v[216:219]
    v_accvgpr_write_b32 a173, 0
    v_accvgpr_write_b32 a174, 0
    v_mfma_f32_16x16x32_bf16 v[220:223], v[40:43], v[88:91], v[220:223]
    ds_read_b64_tr_b16 v[40:41], v26 offset:32768
    ds_read_b64_tr_b16 v[42:43], v26 offset:33280
    v_mfma_f32_16x16x32_bf16 v[220:223], v[44:47], v[92:95], v[220:223]
    s_waitcnt lgkmcnt(2)
    ds_read_b64_tr_b16 v[44:45], v26 offset:36864
    ds_read_b64_tr_b16 v[46:47], v26 offset:37376
    v_mfma_f32_16x16x32_bf16 v[224:227], v[48:51], v[64:67], v[224:227]
    v_add_u32 v26, 0x10000, v26
    v_accvgpr_read_b32 v36, a184
    v_mfma_f32_16x16x32_bf16 v[224:227], v[52:55], v[68:71], v[224:227]
    s_xor_b32 s64, s64, 128
    v_accvgpr_read_b32 v31, a185
    v_cvt_pk_bf16_f32 v36, v36, v31
    v_mfma_f32_16x16x32_bf16 v[228:231], v[48:51], v[72:75], v[228:231]
    v_accvgpr_read_b32 v37, a186
    v_accvgpr_read_b32 v31, a187
    v_mfma_f32_16x16x32_bf16 v[228:231], v[52:55], v[76:79], v[228:231]
    v_cvt_pk_bf16_f32 v37, v37, v31
    v_accvgpr_read_b32 v38, a188
    v_mfma_f32_16x16x32_bf16 v[232:235], v[48:51], v[80:83], v[232:235]
    v_accvgpr_read_b32 v31, a189
    v_cvt_pk_bf16_f32 v38, v38, v31
    v_mfma_f32_16x16x32_bf16 v[232:235], v[52:55], v[84:87], v[232:235]
    s_add_u32 m0, s69, 131072
    v_accvgpr_read_b32 v39, a190
    v_accvgpr_read_b32 v31, a191
    v_mfma_f32_16x16x32_bf16 v[236:239], v[48:51], v[88:91], v[236:239]
    buffer_load_dwordx4 v2, s[24:27], s60 offen lds
    v_mfma_f32_16x16x32_bf16 v[236:239], v[52:55], v[92:95], v[236:239]
    ds_read_b64_tr_b16 v[48:49], v27 offset:32768
    ds_read_b64_tr_b16 v[50:51], v27 offset:33280
    v_mfma_f32_16x16x32_bf16 v[240:243], v[56:59], v[64:67], v[240:243]
    ds_read_b64_tr_b16 v[52:53], v27 offset:36864
    ds_read_b64_tr_b16 v[54:55], v27 offset:37376
    v_mfma_f32_16x16x32_bf16 v[240:243], v[60:63], v[68:71], v[240:243]
    s_add_u32 s72, s71, 35840
    v_add_u32 v27, 0x10000, v27
    v_cvt_pk_bf16_f32 v39, v39, v31
    v_mfma_f32_16x16x32_bf16 v[244:247], v[56:59], v[72:75], v[244:247]
    buffer_load_dwordx4 v3, s[24:27], s60 offen offset:1024 lds
    v_mfma_f32_16x16x32_bf16 v[244:247], v[60:63], v[76:79], v[244:247]
    buffer_store_dwordx4 v[36:39], v1, s[36:39], s72 offen sc1
    v_mfma_f32_16x16x32_bf16 v[248:251], v[56:59], v[80:83], v[248:251]
    v_accvgpr_write_b32 a175, 0
    v_accvgpr_write_b32 a176, 0
    v_mfma_f32_16x16x32_bf16 v[248:251], v[60:63], v[84:87], v[248:251]
    v_accvgpr_write_b32 a177, 0
    v_accvgpr_write_b32 a178, 0
    v_mfma_f32_16x16x32_bf16 v[252:255], v[56:59], v[88:91], v[252:255]
    buffer_load_dwordx4 v4, s[24:27], s60 offen offset:2048 lds
    v_mfma_f32_16x16x32_bf16 v[252:255], v[60:63], v[92:95], v[252:255]
    s_waitcnt lgkmcnt(0)
    ds_read_b64_tr_b16 v[56:57], v28 offset:32768
    ds_read_b64_tr_b16 v[58:59], v28 offset:33280
    v_mfma_f32_16x16x32_bf16 a[64:67], v[40:43], v[64:67], a[64:67]
    ds_read_b64_tr_b16 v[60:61], v28 offset:36864
    ds_read_b64_tr_b16 v[62:63], v28 offset:37376
    v_mfma_f32_16x16x32_bf16 a[64:67], v[44:47], v[68:71], a[64:67]
    v_add_u32 v28, 0x10000, v28
    v_accvgpr_write_b32 a179, 0
    v_mfma_f32_16x16x32_bf16 a[68:71], v[40:43], v[72:75], a[68:71]
    buffer_load_dwordx4 v5, s[24:27], s60 offen offset:3072 lds
    v_mfma_f32_16x16x32_bf16 a[68:71], v[44:47], v[76:79], a[68:71]
    ds_read_b128 v[112:115], v24 offset:49152
    v_accvgpr_write_b32 a180, 0
    v_mfma_f32_16x16x32_bf16 a[72:75], v[40:43], v[80:83], a[72:75]
    v_accvgpr_write_b32 a181, 0
    v_accvgpr_write_b32 a182, 0
    v_mfma_f32_16x16x32_bf16 a[72:75], v[44:47], v[84:87], a[72:75]
    s_add_u32 m0, s69, 147456
    v_accvgpr_write_b32 a183, 0
    v_accvgpr_write_b32 a184, 0
    v_mfma_f32_16x16x32_bf16 a[76:79], v[40:43], v[88:91], a[76:79]
    s_xor_b32 s60, s60, 524288
    buffer_load_dwordx4 v10, s[20:23], s63 offen lds
    v_mfma_f32_16x16x32_bf16 a[76:79], v[44:47], v[92:95], a[76:79]
    ds_read_b128 v[116:119], v25 offset:49152
    v_accvgpr_read_b32 v32, a192
    v_mfma_f32_16x16x32_bf16 a[128:131], v[40:43], a[136:139], a[128:131]
    ds_read_b64_tr_b16 v[40:41], v29 offset:32768
    ds_read_b64_tr_b16 v[42:43], v29 offset:33280
    v_mfma_f32_16x16x32_bf16 a[128:131], v[44:47], a[140:143], a[128:131]
    ds_read_b64_tr_b16 v[44:45], v29 offset:36864
    ds_read_b64_tr_b16 v[46:47], v29 offset:37376
    v_mfma_f32_16x16x32_bf16 a[80:83], v[48:51], v[64:67], a[80:83]
    buffer_load_dwordx4 v11, s[20:23], s63 offen offset:1024 lds
    v_mfma_f32_16x16x32_bf16 a[80:83], v[52:55], v[68:71], a[80:83]
    ds_read_b128 v[120:123], v24 offset:57344
    v_add_u32 v29, 0x10000, v29
    v_mfma_f32_16x16x32_bf16 a[84:87], v[48:51], v[72:75], a[84:87]
    v_accvgpr_read_b32 v31, a193
    v_cvt_pk_bf16_f32 v32, v32, v31
    v_mfma_f32_16x16x32_bf16 a[84:87], v[52:55], v[76:79], a[84:87]
    v_accvgpr_read_b32 v33, a194
    v_accvgpr_read_b32 v31, a195
    v_mfma_f32_16x16x32_bf16 a[88:91], v[48:51], v[80:83], a[88:91]
    buffer_load_dwordx4 v12, s[20:23], s63 offen offset:2048 lds
    v_mfma_f32_16x16x32_bf16 a[88:91], v[52:55], v[84:87], a[88:91]
    s_add_u32 s72, s71, 4096
    ds_read_b128 v[124:127], v25 offset:57344
    v_cvt_pk_bf16_f32 v33, v33, v31
    v_mfma_f32_16x16x32_bf16 a[92:95], v[48:51], v[88:91], a[92:95]
    v_accvgpr_read_b32 v34, a196
    v_accvgpr_read_b32 v31, a197
    v_mfma_f32_16x16x32_bf16 a[92:95], v[52:55], v[92:95], a[92:95]
    v_cvt_pk_bf16_f32 v34, v34, v31
    v_accvgpr_read_b32 v35, a198
    v_mfma_f32_16x16x32_bf16 a[132:135], v[48:51], a[136:139], a[132:135]
    buffer_load_dwordx4 v13, s[20:23], s63 offen offset:3072 lds
    v_mfma_f32_16x16x32_bf16 a[132:135], v[52:55], a[140:143], a[132:135]
    s_waitcnt lgkmcnt(1)
    v_accvgpr_read_b32 v31, a199
    v_cvt_pk_bf16_f32 v35, v35, v31
    v_mfma_f32_16x16x32_bf16 a[96:99], v[56:59], v[64:67], a[96:99]
    v_accvgpr_write_b32 a185, 0
    v_accvgpr_write_b32 a186, 0
    v_mfma_f32_16x16x32_bf16 a[96:99], v[60:63], v[68:71], a[96:99]
    s_xor_b32 s63, s63, 1920
    v_accvgpr_write_b32 a187, 0
    v_accvgpr_write_b32 a188, 0
    v_mfma_f32_16x16x32_bf16 a[100:103], v[56:59], v[72:75], a[100:103]
    s_andn2_b32 s63, s63, 896
    buffer_store_dwordx4 v[32:35], v1, s[36:39], s72 offen sc1
    v_mfma_f32_16x16x32_bf16 a[100:103], v[60:63], v[76:79], a[100:103]
    v_accvgpr_write_b32 a189, 0
    v_accvgpr_write_b32 a190, 0
    v_mfma_f32_16x16x32_bf16 a[104:107], v[56:59], v[80:83], a[104:107]
    v_accvgpr_write_b32 a191, 0
    v_accvgpr_write_b32 a192, 0
    v_mfma_f32_16x16x32_bf16 a[104:107], v[60:63], v[84:87], a[104:107]
    s_waitcnt vmcnt(10) lgkmcnt(0)
    s_barrier
    ds_read_b64_tr_b16 v[48:49], v14 offset:0
    v_mfma_f32_16x16x32_bf16 a[108:111], v[56:59], v[88:91], a[108:111]
    s_add_u32 m0, s67, 0
    ds_read_b64_tr_b16 v[50:51], v14 offset:1024
    ds_read_b64_tr_b16 v[52:53], v14 offset:8192
    v_mfma_f32_16x16x32_bf16 a[108:111], v[60:63], v[92:95], a[108:111]
    buffer_load_dwordx4 v1, s[28:31], s65 offen sc1 lds
    v_mfma_f32_16x16x32_bf16 a[112:115], v[40:43], v[64:67], a[112:115]
    ds_read_b64_tr_b16 v[54:55], v14 offset:9216
    ds_read_b64_tr_b16 v[56:57], v15 offset:0
    v_mfma_f32_16x16x32_bf16 a[112:115], v[44:47], v[68:71], a[112:115]
    ds_read_b64_tr_b16 v[58:59], v15 offset:1024
    ds_read_b64_tr_b16 v[60:61], v15 offset:8192
    v_mfma_f32_16x16x32_bf16 a[116:119], v[40:43], v[72:75], a[116:119]
    ds_read_b64_tr_b16 v[62:63], v15 offset:9216
    ds_read_b128 a[136:139], v22 offset:32768
    v_mfma_f32_16x16x32_bf16 a[116:119], v[44:47], v[76:79], a[116:119]
    ds_read_b128 a[140:143], v23 offset:32768
    v_add_u32 v14, 0x10000, v14
    v_mfma_f32_16x16x32_bf16 a[120:123], v[40:43], v[80:83], a[120:123]
    v_add_u32 v15, 0x10000, v15
    v_add_u32 v22, 0xffff0000, v22
    v_mfma_f32_16x16x32_bf16 a[120:123], v[44:47], v[84:87], a[120:123]
    v_add_u32 v23, 0xffff0000, v23
    v_accvgpr_read_b32 v36, a200
    v_mfma_f32_16x16x32_bf16 a[124:127], v[40:43], v[88:91], a[124:127]
    buffer_load_dwordx4 v1, s[28:31], s65 offen offset:1024 sc1 lds
    v_mfma_f32_16x16x32_bf16 a[124:127], v[44:47], v[92:95], a[124:127]
    s_waitcnt lgkmcnt(1)
    ds_read_b64_tr_b16 v[40:41], v16 offset:0
    ds_read_b64_tr_b16 v[42:43], v16 offset:1024
    v_mfma_f32_16x16x32_bf16 v[128:131], v[48:51], v[96:99], v[128:131]
    ds_read_b64_tr_b16 v[44:45], v16 offset:8192
    ds_read_b64_tr_b16 v[46:47], v16 offset:9216
    v_mfma_f32_16x16x32_bf16 v[128:131], v[52:55], v[100:103], v[128:131]
    s_add_u32 s72, s71, 5120
    v_add_u32 v24, 0x10000, v24
    v_add_u32 v16, 0x10000, v16
    v_mfma_f32_16x16x32_bf16 v[132:135], v[48:51], v[104:107], v[132:135]
    ds_read_b128 v[64:67], v24 offset:16384
    v_accvgpr_read_b32 v31, a201
    v_mfma_f32_16x16x32_bf16 v[132:135], v[52:55], v[108:111], v[132:135]
    v_cvt_pk_bf16_f32 v36, v36, v31
    v_accvgpr_read_b32 v37, a202
    v_mfma_f32_16x16x32_bf16 v[136:139], v[48:51], v[112:115], v[136:139]
    v_accvgpr_read_b32 v31, a203
    v_cvt_pk_bf16_f32 v37, v37, v31
    v_mfma_f32_16x16x32_bf16 v[136:139], v[52:55], v[116:119], v[136:139]
    v_accvgpr_read_b32 v38, a204
    v_accvgpr_read_b32 v31, a205
    v_mfma_f32_16x16x32_bf16 v[140:143], v[48:51], v[120:123], v[140:143]
    s_add_u32 m0, s68, 8192
    ds_read_b64_tr_b16 v[48:49], v17 offset:0
    ds_read_b64_tr_b16 v[50:51], v17 offset:1024
    v_mfma_f32_16x16x32_bf16 v[140:143], v[52:55], v[124:127], v[140:143]
    buffer_load_dwordx4 v6, s[20:23], s66 offen lds
    v_mfma_f32_16x16x32_bf16 v[144:147], v[56:59], v[96:99], v[144:147]
    ds_read_b64_tr_b16 v[52:53], v17 offset:8192
    ds_read_b64_tr_b16 v[54:55], v17 offset:9216
    v_mfma_f32_16x16x32_bf16 v[144:147], v[60:63], v[100:103], v[144:147]
    v_add_u32 v17, 0x10000, v17
    v_cvt_pk_bf16_f32 v38, v38, v31
    v_mfma_f32_16x16x32_bf16 v[148:151], v[56:59], v[104:107], v[148:151]
    v_accvgpr_read_b32 v39, a206
    v_accvgpr_read_b32 v31, a207
    v_mfma_f32_16x16x32_bf16 v[148:151], v[60:63], v[108:111], v[148:151]
    v_cvt_pk_bf16_f32 v39, v39, v31
    v_accvgpr_write_b32 a193, 0
    v_mfma_f32_16x16x32_bf16 v[152:155], v[56:59], v[112:115], v[152:155]
    v_add_u32 v25, 0x10000, v25
    v_accvgpr_write_b32 a194, 0
    v_mfma_f32_16x16x32_bf16 v[152:155], v[60:63], v[116:119], v[152:155]
    ds_read_b128 v[68:71], v25 offset:16384
    v_accvgpr_write_b32 a195, 0
    v_mfma_f32_16x16x32_bf16 v[156:159], v[56:59], v[120:123], v[156:159]
    s_add_u32 m0, s69, 16384
    ds_read_b64_tr_b16 v[56:57], v18 offset:0
    ds_read_b64_tr_b16 v[58:59], v18 offset:1024
    v_mfma_f32_16x16x32_bf16 v[156:159], v[60:63], v[124:127], v[156:159]
    s_xor_b32 s65, s65, 8192
    buffer_load_dwordx4 v10, s[20:23], s64 offen lds
    s_waitcnt lgkmcnt(3)
    v_mfma_f32_16x16x32_bf16 v[160:163], v[40:43], v[96:99], v[160:163]
    s_xor_b32 s66, s66, 128
    ds_read_b64_tr_b16 v[60:61], v18 offset:8192
    ds_read_b64_tr_b16 v[62:63], v18 offset:9216
    v_mfma_f32_16x16x32_bf16 v[160:163], v[44:47], v[100:103], v[160:163]
    v_add_u32 v18, 0x10000, v18
    v_accvgpr_read_b32 v32, a208
    v_mfma_f32_16x16x32_bf16 v[164:167], v[40:43], v[104:107], v[164:167]
    buffer_store_dwordx4 v[36:39], v1, s[36:39], s72 offen sc1
    v_mfma_f32_16x16x32_bf16 v[164:167], v[44:47], v[108:111], v[164:167]
    v_accvgpr_read_b32 v31, a209
    v_cvt_pk_bf16_f32 v32, v32, v31
    v_mfma_f32_16x16x32_bf16 v[168:171], v[40:43], v[112:115], v[168:171]
    v_accvgpr_read_b32 v33, a210
    v_accvgpr_read_b32 v31, a211
    v_mfma_f32_16x16x32_bf16 v[168:171], v[44:47], v[116:119], v[168:171]
    v_cvt_pk_bf16_f32 v33, v33, v31
    v_accvgpr_read_b32 v34, a212
    v_mfma_f32_16x16x32_bf16 v[172:175], v[40:43], v[120:123], v[172:175]
    ds_read_b64_tr_b16 v[40:41], v19 offset:0
    ds_read_b64_tr_b16 v[42:43], v19 offset:1024
    v_mfma_f32_16x16x32_bf16 v[172:175], v[44:47], v[124:127], v[172:175]
    s_add_u32 s72, s71, 36864
    ds_read_b64_tr_b16 v[44:45], v19 offset:8192
    ds_read_b64_tr_b16 v[46:47], v19 offset:9216
    v_mfma_f32_16x16x32_bf16 v[176:179], v[48:51], v[96:99], v[176:179]
    buffer_load_dwordx4 v11, s[20:23], s64 offen offset:1024 lds
    v_mfma_f32_16x16x32_bf16 v[176:179], v[52:55], v[100:103], v[176:179]
    ds_read_b128 v[72:75], v24 offset:24576
    v_add_u32 v19, 0x10000, v19
    v_mfma_f32_16x16x32_bf16 v[180:183], v[48:51], v[104:107], v[180:183]
    v_accvgpr_read_b32 v31, a213
    v_cvt_pk_bf16_f32 v34, v34, v31
    v_mfma_f32_16x16x32_bf16 v[180:183], v[52:55], v[108:111], v[180:183]
    v_accvgpr_read_b32 v35, a214
    v_accvgpr_read_b32 v31, a215
    v_mfma_f32_16x16x32_bf16 v[184:187], v[48:51], v[112:115], v[184:187]
    v_cvt_pk_bf16_f32 v35, v35, v31
    v_accvgpr_write_b32 a196, 0
    v_mfma_f32_16x16x32_bf16 v[184:187], v[52:55], v[116:119], v[184:187]
    buffer_store_dwordx4 v[32:35], v1, s[36:39], s72 offen sc1
    v_mfma_f32_16x16x32_bf16 v[188:191], v[48:51], v[120:123], v[188:191]
    ds_read_b64_tr_b16 v[48:49], v20 offset:0
    ds_read_b64_tr_b16 v[50:51], v20 offset:1024
    v_mfma_f32_16x16x32_bf16 v[188:191], v[52:55], v[124:127], v[188:191]
    s_waitcnt lgkmcnt(2)
    ds_read_b64_tr_b16 v[52:53], v20 offset:8192
    ds_read_b64_tr_b16 v[54:55], v20 offset:9216
    v_mfma_f32_16x16x32_bf16 v[192:195], v[56:59], v[96:99], v[192:195]
    buffer_load_dwordx4 v12, s[20:23], s64 offen offset:2048 lds
    v_mfma_f32_16x16x32_bf16 v[192:195], v[60:63], v[100:103], v[192:195]
    v_add_u32 v20, 0x10000, v20
    v_accvgpr_write_b32 a197, 0
    v_mfma_f32_16x16x32_bf16 v[196:199], v[56:59], v[104:107], v[196:199]
    v_accvgpr_write_b32 a198, 0
    v_accvgpr_write_b32 a199, 0
    v_mfma_f32_16x16x32_bf16 v[196:199], v[60:63], v[108:111], v[196:199]
    ds_read_b128 v[76:79], v25 offset:24576
    v_accvgpr_write_b32 a200, 0
    v_mfma_f32_16x16x32_bf16 v[200:203], v[56:59], v[112:115], v[200:203]
    v_accvgpr_read_b32 v36, a216
    v_accvgpr_read_b32 v31, a217
    v_mfma_f32_16x16x32_bf16 v[200:203], v[60:63], v[116:119], v[200:203]
    v_cvt_pk_bf16_f32 v36, v36, v31
    v_accvgpr_read_b32 v37, a218
    v_mfma_f32_16x16x32_bf16 v[204:207], v[56:59], v[120:123], v[204:207]
    ds_read_b64_tr_b16 v[56:57], v21 offset:0
    ds_read_b64_tr_b16 v[58:59], v21 offset:1024
    v_mfma_f32_16x16x32_bf16 v[204:207], v[60:63], v[124:127], v[204:207]
    ds_read_b64_tr_b16 v[60:61], v21 offset:8192
    ds_read_b64_tr_b16 v[62:63], v21 offset:9216
    v_mfma_f32_16x16x32_bf16 v[208:211], v[40:43], v[96:99], v[208:211]
    v_add_u32 v21, 0x10000, v21
    v_accvgpr_read_b32 v31, a219
    v_mfma_f32_16x16x32_bf16 v[208:211], v[44:47], v[100:103], v[208:211]
    buffer_load_dwordx4 v13, s[20:23], s64 offen offset:3072 lds
    v_mfma_f32_16x16x32_bf16 v[212:215], v[40:43], v[104:107], v[212:215]
    v_cvt_pk_bf16_f32 v37, v37, v31
    v_accvgpr_read_b32 v38, a220
    v_mfma_f32_16x16x32_bf16 v[212:215], v[44:47], v[108:111], v[212:215]
    v_accvgpr_read_b32 v31, a221
    v_cvt_pk_bf16_f32 v38, v38, v31
    v_mfma_f32_16x16x32_bf16 v[216:219], v[40:43], v[112:115], v[216:219]
    v_accvgpr_read_b32 v39, a222
    v_accvgpr_read_b32 v31, a223
    v_mfma_f32_16x16x32_bf16 v[216:219], v[44:47], v[116:119], v[216:219]
    s_add_u32 s72, s71, 37888
    v_cvt_pk_bf16_f32 v39, v39, v31
    v_accvgpr_write_b32 a201, 0
    v_mfma_f32_16x16x32_bf16 v[220:223], v[40:43], v[120:123], v[220:223]
    ds_read_b64_tr_b16 v[40:41], v26 offset:32768
    ds_read_b64_tr_b16 v[42:43], v26 offset:33280
    v_mfma_f32_16x16x32_bf16 v[220:223], v[44:47], v[124:127], v[220:223]
    s_waitcnt lgkmcnt(2)
    ds_read_b64_tr_b16 v[44:45], v26 offset:36864
    ds_read_b64_tr_b16 v[46:47], v26 offset:37376
    v_mfma_f32_16x16x32_bf16 v[224:227], v[48:51], v[96:99], v[224:227]
    v_add_u32 v26, 0xffff0000, v26
    v_accvgpr_write_b32 a202, 0
    v_mfma_f32_16x16x32_bf16 v[224:227], v[52:55], v[100:103], v[224:227]
    s_xor_b32 s64, s64, 1920
    buffer_store_dwordx4 v[36:39], v1, s[36:39], s72 offen sc1
    v_mfma_f32_16x16x32_bf16 v[228:231], v[48:51], v[104:107], v[228:231]
    s_andn2_b32 s64, s64, 896
    v_accvgpr_write_b32 a203, 0
    v_accvgpr_write_b32 a204, 0
    v_mfma_f32_16x16x32_bf16 v[228:231], v[52:55], v[108:111], v[228:231]
    v_accvgpr_write_b32 a205, 0
    v_accvgpr_write_b32 a206, 0
    v_mfma_f32_16x16x32_bf16 v[232:235], v[48:51], v[112:115], v[232:235]
    v_accvgpr_write_b32 a207, 0
    v_accvgpr_write_b32 a208, 0
    v_mfma_f32_16x16x32_bf16 v[232:235], v[52:55], v[116:119], v[232:235]
    s_add_u32 m0, s69, 32768
    v_accvgpr_write_b32 a209, 0
    v_accvgpr_write_b32 a210, 0
    v_mfma_f32_16x16x32_bf16 v[236:239], v[48:51], v[120:123], v[236:239]
    buffer_load_dwordx4 v2, s[24:27], s60 offen lds
    v_mfma_f32_16x16x32_bf16 v[236:239], v[52:55], v[124:127], v[236:239]
    ds_read_b64_tr_b16 v[48:49], v27 offset:32768
    ds_read_b64_tr_b16 v[50:51], v27 offset:33280
    v_mfma_f32_16x16x32_bf16 v[240:243], v[56:59], v[96:99], v[240:243]
    ds_read_b64_tr_b16 v[52:53], v27 offset:36864
    ds_read_b64_tr_b16 v[54:55], v27 offset:37376
    v_mfma_f32_16x16x32_bf16 v[240:243], v[60:63], v[100:103], v[240:243]
    v_add_u32 v27, 0xffff0000, v27
    v_accvgpr_write_b32 a211, 0
    v_mfma_f32_16x16x32_bf16 v[244:247], v[56:59], v[104:107], v[244:247]
    buffer_load_dwordx4 v3, s[24:27], s60 offen offset:1024 lds
    v_mfma_f32_16x16x32_bf16 v[244:247], v[60:63], v[108:111], v[244:247]
    v_accvgpr_read_b32 v32, a224
    v_accvgpr_read_b32 v31, a225
    v_mfma_f32_16x16x32_bf16 v[248:251], v[56:59], v[112:115], v[248:251]
    v_cvt_pk_bf16_f32 v32, v32, v31
    v_accvgpr_read_b32 v33, a226
    v_mfma_f32_16x16x32_bf16 v[248:251], v[60:63], v[116:119], v[248:251]
    v_accvgpr_read_b32 v31, a227
    v_cvt_pk_bf16_f32 v33, v33, v31
    v_mfma_f32_16x16x32_bf16 v[252:255], v[56:59], v[120:123], v[252:255]
    buffer_load_dwordx4 v4, s[24:27], s60 offen offset:2048 lds
    v_mfma_f32_16x16x32_bf16 v[252:255], v[60:63], v[124:127], v[252:255]
    s_waitcnt lgkmcnt(0)
    ds_read_b64_tr_b16 v[56:57], v28 offset:32768
    ds_read_b64_tr_b16 v[58:59], v28 offset:33280
    v_mfma_f32_16x16x32_bf16 a[64:67], v[40:43], v[96:99], a[64:67]
    ds_read_b64_tr_b16 v[60:61], v28 offset:36864
    ds_read_b64_tr_b16 v[62:63], v28 offset:37376
    v_mfma_f32_16x16x32_bf16 a[64:67], v[44:47], v[100:103], a[64:67]
    v_add_u32 v28, 0xffff0000, v28
    v_accvgpr_read_b32 v34, a228
    v_mfma_f32_16x16x32_bf16 a[68:71], v[40:43], v[104:107], a[68:71]
    buffer_load_dwordx4 v5, s[24:27], s60 offen offset:3072 lds
    v_mfma_f32_16x16x32_bf16 a[68:71], v[44:47], v[108:111], a[68:71]
    s_add_u32 s72, s71, 6144
    ds_read_b128 v[80:83], v24 offset:49152
    v_accvgpr_read_b32 v31, a229
    v_mfma_f32_16x16x32_bf16 a[72:75], v[40:43], v[112:115], a[72:75]
    v_cvt_pk_bf16_f32 v34, v34, v31
    v_accvgpr_read_b32 v35, a230
    v_mfma_f32_16x16x32_bf16 a[72:75], v[44:47], v[116:119], a[72:75]
    s_xor_b32 s60, s60, 7864320
    v_accvgpr_read_b32 v31, a231
    v_cvt_pk_bf16_f32 v35, v35, v31
    v_mfma_f32_16x16x32_bf16 a[76:79], v[40:43], v[120:123], a[76:79]
    s_add_u32 m0, s69, 49152
    ds_read_b128 v[84:87], v25 offset:49152
    v_accvgpr_write_b32 a212, 0
    v_mfma_f32_16x16x32_bf16 a[76:79], v[44:47], v[124:127], a[76:79]
    s_andn2_b32 s60, s60, 3670016
    buffer_load_dwordx4 v10, s[20:23], s63 offen lds
    v_mfma_f32_16x16x32_bf16 a[128:131], v[40:43], a[136:139], a[128:131]
    ds_read_b64_tr_b16 v[40:41], v29 offset:32768
    ds_read_b64_tr_b16 v[42:43], v29 offset:33280
    v_mfma_f32_16x16x32_bf16 a[128:131], v[44:47], a[140:143], a[128:131]
    ds_read_b64_tr_b16 v[44:45], v29 offset:36864
    ds_read_b64_tr_b16 v[46:47], v29 offset:37376
    v_mfma_f32_16x16x32_bf16 a[80:83], v[48:51], v[96:99], a[80:83]
    buffer_load_dwordx4 v11, s[20:23], s63 offen offset:1024 lds
    v_mfma_f32_16x16x32_bf16 a[80:83], v[52:55], v[100:103], a[80:83]
    ds_read_b128 v[88:91], v24 offset:57344
    v_add_u32 v29, 0xffff0000, v29
    v_mfma_f32_16x16x32_bf16 a[84:87], v[48:51], v[104:107], a[84:87]
    buffer_store_dwordx4 v[32:35], v1, s[36:39], s72 offen sc1
    v_mfma_f32_16x16x32_bf16 a[84:87], v[52:55], v[108:111], a[84:87]
    v_accvgpr_write_b32 a213, 0
    v_accvgpr_write_b32 a214, 0
    v_mfma_f32_16x16x32_bf16 a[88:91], v[48:51], v[112:115], a[88:91]
    ds_read_b128 v[92:95], v25 offset:57344
    v_accvgpr_write_b32 a215, 0
    v_mfma_f32_16x16x32_bf16 a[88:91], v[52:55], v[116:119], a[88:91]
    buffer_load_dwordx4 v12, s[20:23], s63 offen offset:2048 lds
    v_mfma_f32_16x16x32_bf16 a[92:95], v[48:51], v[120:123], a[92:95]
    v_accvgpr_read_b32 v36, a232
    v_accvgpr_read_b32 v31, a233
    v_mfma_f32_16x16x32_bf16 a[92:95], v[52:55], v[124:127], a[92:95]
    v_cvt_pk_bf16_f32 v36, v36, v31
    v_accvgpr_read_b32 v37, a234
    v_mfma_f32_16x16x32_bf16 a[132:135], v[48:51], a[136:139], a[132:135]
    v_accvgpr_read_b32 v31, a235
    v_cvt_pk_bf16_f32 v37, v37, v31
    v_mfma_f32_16x16x32_bf16 a[132:135], v[52:55], a[140:143], a[132:135]
    s_waitcnt lgkmcnt(0)
    buffer_load_dwordx4 v13, s[20:23], s63 offen offset:3072 lds
    v_mfma_f32_16x16x32_bf16 a[96:99], v[56:59], v[96:99], a[96:99]
    v_accvgpr_read_b32 v38, a236
    v_accvgpr_read_b32 v31, a237
    v_mfma_f32_16x16x32_bf16 a[96:99], v[60:63], v[100:103], a[96:99]
    s_xor_b32 s63, s63, 128
    v_cvt_pk_bf16_f32 v38, v38, v31
    v_accvgpr_read_b32 v39, a238
    v_mfma_f32_16x16x32_bf16 a[100:103], v[56:59], v[104:107], a[100:103]
    v_accvgpr_read_b32 v31, a239
    v_cvt_pk_bf16_f32 v39, v39, v31
    v_mfma_f32_16x16x32_bf16 a[100:103], v[60:63], v[108:111], a[100:103]
    v_accvgpr_write_b32 a216, 0
    v_accvgpr_write_b32 a217, 0
    v_mfma_f32_16x16x32_bf16 a[104:107], v[56:59], v[112:115], a[104:107]
    v_accvgpr_write_b32 a218, 0
    v_accvgpr_write_b32 a219, 0
    v_mfma_f32_16x16x32_bf16 a[104:107], v[60:63], v[116:119], a[104:107]
    s_waitcnt vmcnt(10) lgkmcnt(0)
    s_barrier
    ds_read_b64_tr_b16 v[48:49], v14 offset:0
    v_mfma_f32_16x16x32_bf16 a[108:111], v[56:59], v[120:123], a[108:111]
    s_add_u32 m0, s67, 65536
    ds_read_b64_tr_b16 v[50:51], v14 offset:1024
    ds_read_b64_tr_b16 v[52:53], v14 offset:8192
    v_mfma_f32_16x16x32_bf16 a[108:111], v[60:63], v[124:127], a[108:111]
    s_add_u32 s72, s71, 7168
    buffer_load_dwordx4 v1, s[28:31], s65 offen sc1 lds
    v_mfma_f32_16x16x32_bf16 a[112:115], v[40:43], v[96:99], a[112:115]
    ds_read_b64_tr_b16 v[54:55], v14 offset:9216
    ds_read_b64_tr_b16 v[56:57], v15 offset:0
    v_mfma_f32_16x16x32_bf16 a[112:115], v[44:47], v[100:103], a[112:115]
    ds_read_b64_tr_b16 v[58:59], v15 offset:1024
    ds_read_b64_tr_b16 v[60:61], v15 offset:8192
    v_mfma_f32_16x16x32_bf16 a[116:119], v[40:43], v[104:107], a[116:119]
    ds_read_b64_tr_b16 v[62:63], v15 offset:9216
    ds_read_b128 a[136:139], v22 offset:0
    v_mfma_f32_16x16x32_bf16 a[116:119], v[44:47], v[108:111], a[116:119]
    ds_read_b128 a[140:143], v23 offset:0
    v_add_u32 v14, 0xfffe0000, v14
    v_mfma_f32_16x16x32_bf16 a[120:123], v[40:43], v[112:115], a[120:123]
    v_add_u32 v15, 0xfffe0000, v15
    v_add_u32 v22, 0x10000, v22
    v_mfma_f32_16x16x32_bf16 a[120:123], v[44:47], v[116:119], a[120:123]
    v_add_u32 v23, 0x10000, v23
    v_accvgpr_write_b32 a220, 0
    v_mfma_f32_16x16x32_bf16 a[124:127], v[40:43], v[120:123], a[124:127]
    buffer_load_dwordx4 v1, s[28:31], s65 offen offset:1024 sc1 lds
    v_mfma_f32_16x16x32_bf16 a[124:127], v[44:47], v[124:127], a[124:127]
    s_waitcnt lgkmcnt(1)
    ds_read_b64_tr_b16 v[40:41], v16 offset:0
    ds_read_b64_tr_b16 v[42:43], v16 offset:1024
    v_mfma_f32_16x16x32_bf16 v[128:131], v[48:51], v[64:67], v[128:131]
    ds_read_b64_tr_b16 v[44:45], v16 offset:8192
    ds_read_b64_tr_b16 v[46:47], v16 offset:9216
    v_mfma_f32_16x16x32_bf16 v[128:131], v[52:55], v[68:71], v[128:131]
    v_add_u32 v24, 0x10000, v24
    v_add_u32 v16, 0xfffe0000, v16
    v_mfma_f32_16x16x32_bf16 v[132:135], v[48:51], v[72:75], v[132:135]
    ds_read_b128 v[96:99], v24 offset:16384
    v_accvgpr_read_b32 v32, a240
    v_mfma_f32_16x16x32_bf16 v[132:135], v[52:55], v[76:79], v[132:135]
    buffer_store_dwordx4 v[36:39], v1, s[36:39], s72 offen sc1
    v_mfma_f32_16x16x32_bf16 v[136:139], v[48:51], v[80:83], v[136:139]
    v_accvgpr_read_b32 v31, a241
    v_cvt_pk_bf16_f32 v32, v32, v31
    v_mfma_f32_16x16x32_bf16 v[136:139], v[52:55], v[84:87], v[136:139]
    v_accvgpr_read_b32 v33, a242
    v_accvgpr_read_b32 v31, a243
    v_mfma_f32_16x16x32_bf16 v[140:143], v[48:51], v[88:91], v[140:143]
    s_add_u32 m0, s68, 73728
    ds_read_b64_tr_b16 v[48:49], v17 offset:0
    ds_read_b64_tr_b16 v[50:51], v17 offset:1024
    v_mfma_f32_16x16x32_bf16 v[140:143], v[52:55], v[92:95], v[140:143]
    buffer_load_dwordx4 v6, s[20:23], s66 offen lds
    v_mfma_f32_16x16x32_bf16 v[144:147], v[56:59], v[64:67], v[144:147]
    ds_read_b64_tr_b16 v[52:53], v17 offset:8192
    ds_read_b64_tr_b16 v[54:55], v17 offset:9216
    v_mfma_f32_16x16x32_bf16 v[144:147], v[60:63], v[68:71], v[144:147]
    v_add_u32 v17, 0xfffe0000, v17
    v_cvt_pk_bf16_f32 v33, v33, v31
    v_mfma_f32_16x16x32_bf16 v[148:151], v[56:59], v[72:75], v[148:151]
    v_accvgpr_read_b32 v34, a244
    v_accvgpr_read_b32 v31, a245
    v_mfma_f32_16x16x32_bf16 v[148:151], v[60:63], v[76:79], v[148:151]
    s_add_u32 s72, s71, 38912
    v_cvt_pk_bf16_f32 v34, v34, v31
    v_accvgpr_read_b32 v35, a246
    v_mfma_f32_16x16x32_bf16 v[152:155], v[56:59], v[80:83], v[152:155]
    v_add_u32 v25, 0x10000, v25
    v_accvgpr_read_b32 v31, a247
    v_mfma_f32_16x16x32_bf16 v[152:155], v[60:63], v[84:87], v[152:155]
    ds_read_b128 v[100:103], v25 offset:16384
    v_cvt_pk_bf16_f32 v35, v35, v31
    v_mfma_f32_16x16x32_bf16 v[156:159], v[56:59], v[88:91], v[156:159]
    s_xor_b32 s65, s65, 122880
    ds_read_b64_tr_b16 v[56:57], v18 offset:0
    ds_read_b64_tr_b16 v[58:59], v18 offset:1024
    v_mfma_f32_16x16x32_bf16 v[156:159], v[60:63], v[92:95], v[156:159]
    s_xor_b32 s66, s66, 1920
    ds_read_b64_tr_b16 v[60:61], v18 offset:8192
    ds_read_b64_tr_b16 v[62:63], v18 offset:9216
    s_waitcnt lgkmcnt(5)
    v_mfma_f32_16x16x32_bf16 v[160:163], v[40:43], v[64:67], v[160:163]
    s_add_u32 m0, s69, 81920
    v_add_u32 v18, 0xfffe0000, v18
    v_accvgpr_write_b32 a221, 0
    v_mfma_f32_16x16x32_bf16 v[160:163], v[44:47], v[68:71], v[160:163]
    s_andn2_b32 s65, s65, 57344
    s_andn2_b32 s66, s66, 896
    v_accvgpr_write_b32 a222, 0
    v_mfma_f32_16x16x32_bf16 v[164:167], v[40:43], v[72:75], v[164:167]
    buffer_load_dwordx4 v10, s[20:23], s64 offen lds
    v_mfma_f32_16x16x32_bf16 v[164:167], v[44:47], v[76:79], v[164:167]
    buffer_store_dwordx4 v[32:35], v1, s[36:39], s72 offen sc1
    v_mfma_f32_16x16x32_bf16 v[168:171], v[40:43], v[80:83], v[168:171]
    v_accvgpr_write_b32 a223, 0
    v_lshrrev_b32 v32, 7, v1
    v_mfma_f32_16x16x32_bf16 v[168:171], v[44:47], v[84:87], v[168:171]
    v_mul_u32_u24 v32, 1152, v32
    v_and_b32 v33, 0x70, v1
    v_mfma_f32_16x16x32_bf16 v[172:175], v[40:43], v[88:91], v[172:175]
    ds_read_b64_tr_b16 v[40:41], v19 offset:0
    ds_read_b64_tr_b16 v[42:43], v19 offset:1024
    v_mfma_f32_16x16x32_bf16 v[172:175], v[44:47], v[92:95], v[172:175]
    ds_read_b64_tr_b16 v[44:45], v19 offset:8192
    ds_read_b64_tr_b16 v[46:47], v19 offset:9216
    v_mfma_f32_16x16x32_bf16 v[176:179], v[48:51], v[64:67], v[176:179]
    buffer_load_dwordx4 v11, s[20:23], s64 offen offset:1024 lds
    v_mfma_f32_16x16x32_bf16 v[176:179], v[52:55], v[68:71], v[176:179]
    ds_read_b128 v[104:107], v24 offset:24576
    v_add_u32 v19, 0xfffe0000, v19
    v_mfma_f32_16x16x32_bf16 v[180:183], v[48:51], v[72:75], v[180:183]
    v_accvgpr_read_b32 v36, a248
    v_accvgpr_read_b32 v31, a249
    v_mfma_f32_16x16x32_bf16 v[180:183], v[52:55], v[76:79], v[180:183]
    v_cvt_pk_bf16_f32 v36, v36, v31
    v_accvgpr_read_b32 v37, a250
    v_mfma_f32_16x16x32_bf16 v[184:187], v[48:51], v[80:83], v[184:187]
    v_accvgpr_read_b32 v31, a251
    v_cvt_pk_bf16_f32 v37, v37, v31
    v_mfma_f32_16x16x32_bf16 v[184:187], v[52:55], v[84:87], v[184:187]
    v_accvgpr_read_b32 v38, a252
    v_accvgpr_read_b32 v31, a253
    v_mfma_f32_16x16x32_bf16 v[188:191], v[48:51], v[88:91], v[188:191]
    ds_read_b64_tr_b16 v[48:49], v20 offset:0
    ds_read_b64_tr_b16 v[50:51], v20 offset:1024
    v_mfma_f32_16x16x32_bf16 v[188:191], v[52:55], v[92:95], v[188:191]
    s_waitcnt lgkmcnt(2)
    ds_read_b64_tr_b16 v[52:53], v20 offset:8192
    ds_read_b64_tr_b16 v[54:55], v20 offset:9216
    v_mfma_f32_16x16x32_bf16 v[192:195], v[56:59], v[64:67], v[192:195]
    buffer_load_dwordx4 v12, s[20:23], s64 offen offset:2048 lds
    v_mfma_f32_16x16x32_bf16 v[192:195], v[60:63], v[68:71], v[192:195]
    s_add_u32 s72, s71, 39936
    v_add_u32 v20, 0xfffe0000, v20
    v_cvt_pk_bf16_f32 v38, v38, v31
    v_mfma_f32_16x16x32_bf16 v[196:199], v[56:59], v[72:75], v[196:199]
    s_add_u32 s71, s70, 16384
    v_accvgpr_read_b32 v39, a254
    v_accvgpr_read_b32 v31, a255
    v_mfma_f32_16x16x32_bf16 v[196:199], v[60:63], v[76:79], v[196:199]
    s_add_u32 s70, s70, s69
    ds_read_b128 v[108:111], v25 offset:24576
    v_cvt_pk_bf16_f32 v39, v39, v31
    v_mfma_f32_16x16x32_bf16 v[200:203], v[56:59], v[80:83], v[200:203]
    v_mov_b32 v31, 1
    v_add3_u32 v32, v32, v33, s99
    v_mfma_f32_16x16x32_bf16 v[200:203], v[60:63], v[84:87], v[200:203]
    buffer_store_dwordx4 v[36:39], v1, s[36:39], s72 offen sc1
    v_mfma_f32_16x16x32_bf16 v[204:207], v[56:59], v[88:91], v[204:207]
    s_add_u32 s72, s7, 128
    ds_read_b64_tr_b16 v[56:57], v21 offset:0
    ds_read_b64_tr_b16 v[58:59], v21 offset:1024
    v_mfma_f32_16x16x32_bf16 v[204:207], v[60:63], v[92:95], v[204:207]
    s_mul_i32 s72, s72, 36
    ds_read_b64_tr_b16 v[60:61], v21 offset:8192
    ds_read_b64_tr_b16 v[62:63], v21 offset:9216
    v_mfma_f32_16x16x32_bf16 v[208:211], v[40:43], v[64:67], v[208:211]
    s_add_u32 s72, s72, s100
    v_add_u32 v21, 0xfffe0000, v21
    v_add_u32 v10, 0, v32
    v_mfma_f32_16x16x32_bf16 v[208:211], v[44:47], v[68:71], v[208:211]
    s_lshl_b32 s100, s100, 5
    buffer_load_dwordx4 v13, s[20:23], s64 offen offset:3072 lds
    v_mfma_f32_16x16x32_bf16 v[212:215], v[40:43], v[72:75], v[212:215]
    s_lshl_b32 s72, s72, 10
    v_add_u32 v11, 8192, v32
    v_add_u32 v12, 16384, v32
    v_mfma_f32_16x16x32_bf16 v[212:215], v[44:47], v[76:79], v[212:215]
    v_add_u32 v13, 24576, v32
    v_lshrrev_b32 v32, 8, v1
    v_mfma_f32_16x16x32_bf16 v[216:219], v[40:43], v[80:83], v[216:219]
    v_lshl_add_u32 v32, s7, 2, v32
    v_mul_u32_u24 v34, 171, v32
    v_mfma_f32_16x16x32_bf16 v[216:219], v[44:47], v[84:87], v[216:219]
    v_lshrrev_b32 v34, 9, v34
    v_mul_u32_u24 v35, 3, v34
    v_mfma_f32_16x16x32_bf16 v[220:223], v[40:43], v[88:91], v[220:223]
    ds_read_b64_tr_b16 v[40:41], v26 offset:0
    ds_read_b64_tr_b16 v[42:43], v26 offset:512
    v_mfma_f32_16x16x32_bf16 v[220:223], v[44:47], v[92:95], v[220:223]
    s_waitcnt lgkmcnt(2)
    ds_read_b64_tr_b16 v[44:45], v26 offset:4096
    ds_read_b64_tr_b16 v[46:47], v26 offset:4608
    v_mfma_f32_16x16x32_bf16 v[224:227], v[48:51], v[64:67], v[224:227]
    v_add_u32 v26, 0x10000, v26
    v_bfe_u32 v33, v1, 6, 2
    v_mfma_f32_16x16x32_bf16 v[224:227], v[52:55], v[68:71], v[224:227]
    s_xor_b32 s64, s64, 128
    v_sub_u32 v35, v32, v35
    v_lshl_add_u32 v35, v35, 3, v33
    v_mfma_f32_16x16x32_bf16 v[228:231], v[48:51], v[72:75], v[228:231]
    v_mad_u32_u24 v34, v34, 18, v35
    v_add_u32 v34, 0, v34
    v_mfma_f32_16x16x32_bf16 v[228:231], v[52:55], v[76:79], v[228:231]
    v_mul_u32_u24 v34, 1152, v34
    v_cmp_gt_u32 vcc, 18, v35
    v_mfma_f32_16x16x32_bf16 v[232:235], v[48:51], v[80:83], v[232:235]
    v_add_u32 v34, s100, v34
    v_mov_b32 v35, 1073741824
    v_mfma_f32_16x16x32_bf16 v[232:235], v[52:55], v[84:87], v[232:235]
    s_add_u32 m0, s69, 98304
    v_cndmask_b32 v34, v35, v34, vcc
    v_lshrrev_b32 v35, 6, v1
    v_mfma_f32_16x16x32_bf16 v[236:239], v[48:51], v[88:91], v[236:239]
    buffer_load_dwordx4 v2, s[24:27], s60 offen lds
    v_mfma_f32_16x16x32_bf16 v[236:239], v[52:55], v[92:95], v[236:239]
    ds_read_b64_tr_b16 v[48:49], v27 offset:0
    ds_read_b64_tr_b16 v[50:51], v27 offset:512
    v_mfma_f32_16x16x32_bf16 v[240:243], v[56:59], v[64:67], v[240:243]
    ds_read_b64_tr_b16 v[52:53], v27 offset:4096
    ds_read_b64_tr_b16 v[54:55], v27 offset:4608
    v_mfma_f32_16x16x32_bf16 v[240:243], v[60:63], v[68:71], v[240:243]
    v_add_u32 v27, 0x10000, v27
    v_mul_u32_u24 v35, 1152, v35
    v_mfma_f32_16x16x32_bf16 v[244:247], v[56:59], v[72:75], v[244:247]
    buffer_load_dwordx4 v3, s[24:27], s60 offen offset:1024 lds
    v_mfma_f32_16x16x32_bf16 v[244:247], v[60:63], v[76:79], v[244:247]
    v_add_u32 v35, s98, v35
    v_add_u32 v35, 512, v35
    v_mfma_f32_16x16x32_bf16 v[248:251], v[56:59], v[80:83], v[248:251]
    s_cmp_eq_u32 s4, 0
    s_cselect_b64 vcc, -1, 0
    v_cndmask_b32 v34, v34, v35, vcc
    v_mfma_f32_16x16x32_bf16 v[248:251], v[60:63], v[84:87], v[248:251]
    v_and_b32 v35, 0x30, v1
    v_add_u32 v2, v34, v35
    v_mfma_f32_16x16x32_bf16 v[252:255], v[56:59], v[88:91], v[252:255]
    buffer_load_dwordx4 v4, s[24:27], s60 offen offset:2048 lds
    v_mfma_f32_16x16x32_bf16 v[252:255], v[60:63], v[92:95], v[252:255]
    s_waitcnt lgkmcnt(0)
    ds_read_b64_tr_b16 v[56:57], v28 offset:0
    ds_read_b64_tr_b16 v[58:59], v28 offset:512
    v_mfma_f32_16x16x32_bf16 a[64:67], v[40:43], v[64:67], a[64:67]
    ds_read_b64_tr_b16 v[60:61], v28 offset:4096
    ds_read_b64_tr_b16 v[62:63], v28 offset:4608
    v_mfma_f32_16x16x32_bf16 a[64:67], v[44:47], v[68:71], a[64:67]
    v_add_u32 v24, 0xfffe0000, v24
    v_add_u32 v28, 0x10000, v28
    v_mfma_f32_16x16x32_bf16 a[68:71], v[40:43], v[72:75], a[68:71]
    buffer_load_dwordx4 v5, s[24:27], s60 offen offset:3072 lds
    v_mfma_f32_16x16x32_bf16 a[68:71], v[44:47], v[76:79], a[68:71]
    ds_read_b128 v[112:115], v24 offset:16384
    v_mul_u32_u24 v34, 171, v32
    v_mfma_f32_16x16x32_bf16 a[72:75], v[40:43], v[80:83], a[72:75]
    v_lshrrev_b32 v34, 9, v34
    v_mul_u32_u24 v35, 3, v34
    v_mfma_f32_16x16x32_bf16 a[72:75], v[44:47], v[84:87], a[72:75]
    s_add_u32 m0, s69, 114688
    v_add_u32 v25, 0xfffe0000, v25
    v_sub_u32 v35, v32, v35
    v_mfma_f32_16x16x32_bf16 a[76:79], v[40:43], v[88:91], a[76:79]
    s_xor_b32 s60, s60, 524288
    buffer_load_dwordx4 v10, s[48:51], 0 offen nt lds
    v_mfma_f32_16x16x32_bf16 a[76:79], v[44:47], v[92:95], a[76:79]
    ds_read_b128 v[116:119], v25 offset:16384
    v_lshl_add_u32 v35, v35, 3, v33
    v_mfma_f32_16x16x32_bf16 a[128:131], v[40:43], a[136:139], a[128:131]
    ds_read_b64_tr_b16 v[40:41], v29 offset:0
    ds_read_b64_tr_b16 v[42:43], v29 offset:512
    v_mfma_f32_16x16x32_bf16 a[128:131], v[44:47], a[140:143], a[128:131]
    ds_read_b64_tr_b16 v[44:45], v29 offset:4096
    ds_read_b64_tr_b16 v[46:47], v29 offset:4608
    v_mfma_f32_16x16x32_bf16 a[80:83], v[48:51], v[64:67], a[80:83]
    buffer_load_dwordx4 v11, s[48:51], 0 offen offset:1024 nt lds
    v_mfma_f32_16x16x32_bf16 a[80:83], v[52:55], v[68:71], a[80:83]
    ds_read_b128 v[120:123], v24 offset:24576
    v_add_u32 v29, 0x10000, v29
    v_mfma_f32_16x16x32_bf16 a[84:87], v[48:51], v[72:75], a[84:87]
    v_mad_u32_u24 v34, v34, 18, v35
    v_add_u32 v34, 4, v34
    v_mfma_f32_16x16x32_bf16 a[84:87], v[52:55], v[76:79], a[84:87]
    v_mul_u32_u24 v34, 1152, v34
    v_cmp_gt_u32 vcc, 14, v35
    v_mfma_f32_16x16x32_bf16 a[88:91], v[48:51], v[80:83], a[88:91]
    buffer_load_dwordx4 v12, s[48:51], 0 offen offset:2048 nt lds
    v_mfma_f32_16x16x32_bf16 a[88:91], v[52:55], v[84:87], a[88:91]
    ds_read_b128 v[124:127], v25 offset:24576
    v_add_u32 v34, s100, v34
    v_mfma_f32_16x16x32_bf16 a[92:95], v[48:51], v[88:91], a[92:95]
    v_mov_b32 v35, 1073741824
    v_cndmask_b32 v34, v35, v34, vcc
    v_mfma_f32_16x16x32_bf16 a[92:95], v[52:55], v[92:95], a[92:95]
    v_lshrrev_b32 v35, 6, v1
    v_mul_u32_u24 v35, 1152, v35
    v_mfma_f32_16x16x32_bf16 a[132:135], v[48:51], a[136:139], a[132:135]
    buffer_load_dwordx4 v13, s[48:51], 0 offen offset:3072 nt lds
    v_mfma_f32_16x16x32_bf16 a[132:135], v[52:55], a[140:143], a[132:135]
    s_waitcnt lgkmcnt(1)
    v_add_u32 v35, s98, v35
    v_add_u32 v35, 18944, v35
    v_mfma_f32_16x16x32_bf16 a[96:99], v[56:59], v[64:67], a[96:99]
    s_cmp_eq_u32 s4, 0
    s_cselect_b64 vcc, -1, 0
    v_cndmask_b32 v34, v34, v35, vcc
    v_mfma_f32_16x16x32_bf16 a[96:99], v[60:63], v[68:71], a[96:99]
    v_and_b32 v35, 0x30, v1
    v_add_u32 v3, v34, v35
    v_mfma_f32_16x16x32_bf16 a[100:103], v[56:59], v[72:75], a[100:103]
    v_bfe_u32 v33, v1, 4, 2
    v_lshlrev_b32 v33, 3, v33
    v_mfma_f32_16x16x32_bf16 a[100:103], v[60:63], v[76:79], a[100:103]
    v_lshrrev_b32 v32, 6, v1
    v_add_u32 v33, s69, v33
    v_mfma_f32_16x16x32_bf16 a[104:107], v[56:59], v[80:83], a[104:107]
    v_lshl_add_u32 v4, v32, 7, v33
    v_add_u32 v4, 0x10000, v4
    v_mfma_f32_16x16x32_bf16 a[104:107], v[60:63], v[84:87], a[104:107]
    s_waitcnt vmcnt(8) lgkmcnt(0)
    s_barrier
    ds_read_b64_tr_b16 v[48:49], v14 offset:32768
    v_mfma_f32_16x16x32_bf16 a[108:111], v[56:59], v[88:91], a[108:111]
    s_add_u32 m0, s67, 131072
    buffer_store_dword v31, v30, s[32:35], s101 offen sc1
    v_mfma_f32_16x16x32_bf16 a[108:111], v[60:63], v[92:95], a[108:111]
    buffer_load_dwordx4 v1, s[28:31], s65 offen sc1 lds
    v_mfma_f32_16x16x32_bf16 a[112:115], v[40:43], v[64:67], a[112:115]
    ds_read_b64_tr_b16 v[50:51], v14 offset:33792
    ds_read_b64_tr_b16 v[52:53], v14 offset:40960
    v_mfma_f32_16x16x32_bf16 a[112:115], v[44:47], v[68:71], a[112:115]
    ds_read_b64_tr_b16 v[54:55], v14 offset:41984
    ds_read_b64_tr_b16 v[56:57], v15 offset:32768
    v_mfma_f32_16x16x32_bf16 a[116:119], v[40:43], v[72:75], a[116:119]
    ds_read_b64_tr_b16 v[58:59], v15 offset:33792
    ds_read_b64_tr_b16 v[60:61], v15 offset:40960
    v_mfma_f32_16x16x32_bf16 a[116:119], v[44:47], v[76:79], a[116:119]
    ds_read_b64_tr_b16 v[62:63], v15 offset:41984
    ds_read_b128 a[136:139], v22 offset:0
    v_mfma_f32_16x16x32_bf16 a[120:123], v[40:43], v[80:83], a[120:123]
    ds_read_b128 a[140:143], v23 offset:0
    v_add_u32 v14, 0x10000, v14
    v_mfma_f32_16x16x32_bf16 a[120:123], v[44:47], v[84:87], a[120:123]
    v_add_u32 v15, 0x10000, v15
    v_add_u32 v22, 0x10000, v22
    v_mfma_f32_16x16x32_bf16 a[124:127], v[40:43], v[88:91], a[124:127]
    ds_read_b64_tr_b16 v[40:41], v16 offset:32768
    ds_read_b64_tr_b16 v[42:43], v16 offset:33792
    v_mfma_f32_16x16x32_bf16 a[124:127], v[44:47], v[92:95], a[124:127]
    s_waitcnt lgkmcnt(5)
    ds_read_b64_tr_b16 v[44:45], v16 offset:40960
    ds_read_b64_tr_b16 v[46:47], v16 offset:41984
    v_mfma_f32_16x16x32_bf16 v[128:131], v[48:51], v[96:99], v[128:131]
    v_add_u32 v16, 0x10000, v16
    v_add_u32 v23, 0x10000, v23
    v_mfma_f32_16x16x32_bf16 v[128:131], v[52:55], v[100:103], v[128:131]
    v_lshl_add_u32 v5, v32, 6, v33
    v_add_u32 v5, 0x20000, v5
    v_mfma_f32_16x16x32_bf16 v[132:135], v[48:51], v[104:107], v[132:135]
    buffer_load_dwordx4 v1, s[28:31], s65 offen offset:1024 sc1 lds
    v_mfma_f32_16x16x32_bf16 v[132:135], v[52:55], v[108:111], v[132:135]
    ds_read_b128 v[64:67], v24 offset:49152
    v_mfma_f32_16x16x32_bf16 v[136:139], v[48:51], v[112:115], v[136:139]
    s_cmp_eq_u32 s4, 0
    s_cselect_b32 s71, s71, s72
    v_mfma_f32_16x16x32_bf16 v[136:139], v[52:55], v[116:119], v[136:139]
    v_mfma_f32_16x16x32_bf16 v[140:143], v[48:51], v[120:123], v[140:143]
    ds_read_b64_tr_b16 v[48:49], v17 offset:32768
    ds_read_b64_tr_b16 v[50:51], v17 offset:33792
    v_mfma_f32_16x16x32_bf16 v[140:143], v[52:55], v[124:127], v[140:143]
    ds_read_b64_tr_b16 v[52:53], v17 offset:40960
    ds_read_b64_tr_b16 v[54:55], v17 offset:41984
    v_mfma_f32_16x16x32_bf16 v[144:147], v[56:59], v[96:99], v[144:147]
    s_waitcnt lgkmcnt(4)
    v_add_u32 v17, 0x10000, v17
    v_mfma_f32_16x16x32_bf16 v[144:147], v[60:63], v[100:103], v[144:147]
    v_mfma_f32_16x16x32_bf16 v[148:151], v[56:59], v[104:107], v[148:151]
    v_mfma_f32_16x16x32_bf16 v[148:151], v[60:63], v[108:111], v[148:151]
    v_mfma_f32_16x16x32_bf16 v[152:155], v[56:59], v[112:115], v[152:155]
    v_mfma_f32_16x16x32_bf16 v[152:155], v[60:63], v[116:119], v[152:155]
    s_add_u32 m0, s68, 139264
    ds_read_b128 v[68:71], v25 offset:49152
    v_mfma_f32_16x16x32_bf16 v[156:159], v[56:59], v[120:123], v[156:159]
    buffer_load_dwordx4 v6, s[20:23], s66 offen lds
    v_mfma_f32_16x16x32_bf16 v[156:159], v[60:63], v[124:127], v[156:159]
    ds_read_b64_tr_b16 v[56:57], v18 offset:32768
    ds_read_b64_tr_b16 v[58:59], v18 offset:33792
    v_mfma_f32_16x16x32_bf16 v[160:163], v[40:43], v[96:99], v[160:163]
    ds_read_b64_tr_b16 v[60:61], v18 offset:40960
    ds_read_b64_tr_b16 v[62:63], v18 offset:41984
    v_mfma_f32_16x16x32_bf16 v[160:163], v[44:47], v[100:103], v[160:163]
    v_add_u32 v18, 0x10000, v18
    v_mfma_f32_16x16x32_bf16 v[164:167], v[40:43], v[104:107], v[164:167]
    v_mfma_f32_16x16x32_bf16 v[164:167], v[44:47], v[108:111], v[164:167]
    v_mfma_f32_16x16x32_bf16 v[168:171], v[40:43], v[112:115], v[168:171]
    v_mfma_f32_16x16x32_bf16 v[168:171], v[44:47], v[116:119], v[168:171]
    v_mfma_f32_16x16x32_bf16 v[172:175], v[40:43], v[120:123], v[172:175]
    ds_read_b64_tr_b16 v[40:41], v19 offset:32768
    ds_read_b64_tr_b16 v[42:43], v19 offset:33792
    v_mfma_f32_16x16x32_bf16 v[172:175], v[44:47], v[124:127], v[172:175]
    s_waitcnt lgkmcnt(2)
    ds_read_b64_tr_b16 v[44:45], v19 offset:40960
    ds_read_b64_tr_b16 v[46:47], v19 offset:41984
    v_mfma_f32_16x16x32_bf16 v[176:179], v[48:51], v[96:99], v[176:179]
    ds_read_b128 v[72:75], v24 offset:57344
    v_add_u32 v19, 0x10000, v19
    v_mfma_f32_16x16x32_bf16 v[176:179], v[52:55], v[100:103], v[176:179]
    s_add_u32 m0, s69, 147456
    v_mfma_f32_16x16x32_bf16 v[180:183], v[48:51], v[104:107], v[180:183]
    s_xor_b32 s65, s65, 8192
    buffer_load_dwordx4 v2, s[52:55], 0 offen lds
    v_mfma_f32_16x16x32_bf16 v[180:183], v[52:55], v[108:111], v[180:183]
    s_xor_b32 s66, s66, 128
    v_mfma_f32_16x16x32_bf16 v[184:187], v[48:51], v[112:115], v[184:187]
    v_mfma_f32_16x16x32_bf16 v[184:187], v[52:55], v[116:119], v[184:187]
    v_mfma_f32_16x16x32_bf16 v[188:191], v[48:51], v[120:123], v[188:191]
    ds_read_b64_tr_b16 v[48:49], v20 offset:32768
    ds_read_b64_tr_b16 v[50:51], v20 offset:33792
    v_mfma_f32_16x16x32_bf16 v[188:191], v[52:55], v[124:127], v[188:191]
    ds_read_b64_tr_b16 v[52:53], v20 offset:40960
    ds_read_b64_tr_b16 v[54:55], v20 offset:41984
    v_mfma_f32_16x16x32_bf16 v[192:195], v[56:59], v[96:99], v[192:195]
    v_add_u32 v20, 0x10000, v20
    v_mfma_f32_16x16x32_bf16 v[192:195], v[60:63], v[100:103], v[192:195]
    v_mfma_f32_16x16x32_bf16 v[196:199], v[56:59], v[104:107], v[196:199]
    v_mfma_f32_16x16x32_bf16 v[196:199], v[60:63], v[108:111], v[196:199]
    ds_read_b128 v[76:79], v25 offset:57344
    v_mfma_f32_16x16x32_bf16 v[200:203], v[56:59], v[112:115], v[200:203]
    v_mfma_f32_16x16x32_bf16 v[200:203], v[60:63], v[116:119], v[200:203]
    s_add_u32 m0, s69, 148480
    v_mfma_f32_16x16x32_bf16 v[204:207], v[56:59], v[120:123], v[204:207]
    buffer_load_dwordx4 v3, s[52:55], 0 offen lds
    v_mfma_f32_16x16x32_bf16 v[204:207], v[60:63], v[124:127], v[204:207]
    s_waitcnt lgkmcnt(1)
    ds_read_b64_tr_b16 v[56:57], v21 offset:32768
    ds_read_b64_tr_b16 v[58:59], v21 offset:33792
    v_mfma_f32_16x16x32_bf16 v[208:211], v[40:43], v[96:99], v[208:211]
    ds_read_b64_tr_b16 v[60:61], v21 offset:40960
    ds_read_b64_tr_b16 v[62:63], v21 offset:41984
    v_mfma_f32_16x16x32_bf16 v[208:211], v[44:47], v[100:103], v[208:211]
    v_add_u32 v21, 0x10000, v21
    v_mfma_f32_16x16x32_bf16 v[212:215], v[40:43], v[104:107], v[212:215]
    v_mfma_f32_16x16x32_bf16 v[212:215], v[44:47], v[108:111], v[212:215]
    v_mfma_f32_16x16x32_bf16 v[216:219], v[40:43], v[112:115], v[216:219]
    v_mfma_f32_16x16x32_bf16 v[216:219], v[44:47], v[116:119], v[216:219]
    v_mfma_f32_16x16x32_bf16 v[220:223], v[40:43], v[120:123], v[220:223]
    ds_read_b64_tr_b16 v[40:41], v26 offset:0
    ds_read_b64_tr_b16 v[42:43], v26 offset:512
    v_mfma_f32_16x16x32_bf16 v[220:223], v[44:47], v[124:127], v[220:223]
    ds_read_b64_tr_b16 v[44:45], v26 offset:4096
    ds_read_b64_tr_b16 v[46:47], v26 offset:4608
    v_mfma_f32_16x16x32_bf16 v[224:227], v[48:51], v[96:99], v[224:227]
    v_add_u32 v26, 0x10000, v26
    v_mfma_f32_16x16x32_bf16 v[224:227], v[52:55], v[100:103], v[224:227]
    v_mfma_f32_16x16x32_bf16 v[228:231], v[48:51], v[104:107], v[228:231]
    v_mfma_f32_16x16x32_bf16 v[228:231], v[52:55], v[108:111], v[228:231]
    v_mfma_f32_16x16x32_bf16 v[232:235], v[48:51], v[112:115], v[232:235]
    v_mfma_f32_16x16x32_bf16 v[232:235], v[52:55], v[116:119], v[232:235]
    v_mfma_f32_16x16x32_bf16 v[236:239], v[48:51], v[120:123], v[236:239]
    ds_read_b64_tr_b16 v[48:49], v27 offset:0
    ds_read_b64_tr_b16 v[50:51], v27 offset:512
    v_mfma_f32_16x16x32_bf16 v[236:239], v[52:55], v[124:127], v[236:239]
    s_waitcnt lgkmcnt(2)
    ds_read_b64_tr_b16 v[52:53], v27 offset:4096
    ds_read_b64_tr_b16 v[54:55], v27 offset:4608
    v_mfma_f32_16x16x32_bf16 v[240:243], v[56:59], v[96:99], v[240:243]
    v_add_u32 v27, 0x10000, v27
    v_mfma_f32_16x16x32_bf16 v[240:243], v[60:63], v[100:103], v[240:243]
    v_mfma_f32_16x16x32_bf16 v[244:247], v[56:59], v[104:107], v[244:247]
    v_mfma_f32_16x16x32_bf16 v[244:247], v[60:63], v[108:111], v[244:247]
    v_mfma_f32_16x16x32_bf16 v[248:251], v[56:59], v[112:115], v[248:251]
    v_mfma_f32_16x16x32_bf16 v[248:251], v[60:63], v[116:119], v[248:251]
    v_mfma_f32_16x16x32_bf16 v[252:255], v[56:59], v[120:123], v[252:255]
    ds_read_b64_tr_b16 v[56:57], v28 offset:0
    ds_read_b64_tr_b16 v[58:59], v28 offset:512
    v_mfma_f32_16x16x32_bf16 v[252:255], v[60:63], v[124:127], v[252:255]
    ds_read_b64_tr_b16 v[60:61], v28 offset:4096
    ds_read_b64_tr_b16 v[62:63], v28 offset:4608
    v_mfma_f32_16x16x32_bf16 a[64:67], v[40:43], v[96:99], a[64:67]
    v_add_u32 v28, 0x10000, v28
    v_mfma_f32_16x16x32_bf16 a[64:67], v[44:47], v[100:103], a[64:67]
    v_add_u32 v24, 0x10000, v24
    v_mfma_f32_16x16x32_bf16 a[68:71], v[40:43], v[104:107], a[68:71]
    ds_read_b128 v[80:83], v24 offset:16384
    v_mfma_f32_16x16x32_bf16 a[68:71], v[44:47], v[108:111], a[68:71]
    v_mfma_f32_16x16x32_bf16 a[72:75], v[40:43], v[112:115], a[72:75]
    v_mfma_f32_16x16x32_bf16 a[72:75], v[44:47], v[116:119], a[72:75]
    v_add_u32 v25, 0x10000, v25
    v_mfma_f32_16x16x32_bf16 a[76:79], v[40:43], v[120:123], a[76:79]
    ds_read_b128 v[84:87], v25 offset:16384
    v_mfma_f32_16x16x32_bf16 a[76:79], v[44:47], v[124:127], a[76:79]
    v_mfma_f32_16x16x32_bf16 a[128:131], v[40:43], a[136:139], a[128:131]
    ds_read_b64_tr_b16 v[40:41], v29 offset:0
    ds_read_b64_tr_b16 v[42:43], v29 offset:512
    v_mfma_f32_16x16x32_bf16 a[128:131], v[44:47], a[140:143], a[128:131]
    s_waitcnt lgkmcnt(3)
    ds_read_b64_tr_b16 v[44:45], v29 offset:4096
    ds_read_b64_tr_b16 v[46:47], v29 offset:4608
    v_mfma_f32_16x16x32_bf16 a[80:83], v[48:51], v[96:99], a[80:83]
    ds_read_b128 v[88:91], v24 offset:24576
    v_add_u32 v29, 0x10000, v29
    v_mfma_f32_16x16x32_bf16 a[80:83], v[52:55], v[100:103], a[80:83]
    v_mfma_f32_16x16x32_bf16 a[84:87], v[48:51], v[104:107], a[84:87]
    v_mfma_f32_16x16x32_bf16 a[84:87], v[52:55], v[108:111], a[84:87]
    v_mfma_f32_16x16x32_bf16 a[88:91], v[48:51], v[112:115], a[88:91]
    ds_read_b128 v[92:95], v25 offset:24576
    v_mfma_f32_16x16x32_bf16 a[88:91], v[52:55], v[116:119], a[88:91]
    v_mfma_f32_16x16x32_bf16 a[92:95], v[48:51], v[120:123], a[92:95]
    v_mfma_f32_16x16x32_bf16 a[92:95], v[52:55], v[124:127], a[92:95]
    v_mfma_f32_16x16x32_bf16 a[132:135], v[48:51], a[136:139], a[132:135]
    v_mfma_f32_16x16x32_bf16 a[132:135], v[52:55], a[140:143], a[132:135]
    v_mfma_f32_16x16x32_bf16 a[96:99], v[56:59], v[96:99], a[96:99]
    v_mfma_f32_16x16x32_bf16 a[96:99], v[60:63], v[100:103], a[96:99]
    v_mfma_f32_16x16x32_bf16 a[100:103], v[56:59], v[104:107], a[100:103]
    v_mfma_f32_16x16x32_bf16 a[100:103], v[60:63], v[108:111], a[100:103]
    v_mfma_f32_16x16x32_bf16 a[104:107], v[56:59], v[112:115], a[104:107]
    v_mfma_f32_16x16x32_bf16 a[104:107], v[60:63], v[116:119], a[104:107]
    s_waitcnt vmcnt(0) lgkmcnt(0)
    s_barrier
    ds_read_b64_tr_b16 v[48:49], v14 offset:32768
    v_mfma_f32_16x16x32_bf16 a[108:111], v[56:59], v[120:123], a[108:111]
    ds_read_b64_tr_b16 v[50:51], v14 offset:33792
    ds_read_b64_tr_b16 v[52:53], v14 offset:40960
    v_mfma_f32_16x16x32_bf16 a[108:111], v[60:63], v[124:127], a[108:111]
    ds_read_b64_tr_b16 v[54:55], v14 offset:41984
    ds_read_b64_tr_b16 v[56:57], v15 offset:32768
    v_mfma_f32_16x16x32_bf16 a[112:115], v[40:43], v[96:99], a[112:115]
    ds_read_b64_tr_b16 v[58:59], v15 offset:33792
    ds_read_b64_tr_b16 v[60:61], v15 offset:40960
    v_mfma_f32_16x16x32_bf16 a[112:115], v[44:47], v[100:103], a[112:115]
    ds_read_b64_tr_b16 v[62:63], v15 offset:41984
    ds_read_b128 a[136:139], v22 offset:0
    v_mfma_f32_16x16x32_bf16 a[116:119], v[40:43], v[104:107], a[116:119]
    ds_read_b128 a[140:143], v23 offset:0
    v_mfma_f32_16x16x32_bf16 a[116:119], v[44:47], v[108:111], a[116:119]
    v_mfma_f32_16x16x32_bf16 a[120:123], v[40:43], v[112:115], a[120:123]
    v_mfma_f32_16x16x32_bf16 a[120:123], v[44:47], v[116:119], a[120:123]
    v_mfma_f32_16x16x32_bf16 a[124:127], v[40:43], v[120:123], a[124:127]
    ds_read_b64_tr_b16 v[40:41], v16 offset:32768
    ds_read_b64_tr_b16 v[42:43], v16 offset:33792
    v_mfma_f32_16x16x32_bf16 a[124:127], v[44:47], v[124:127], a[124:127]
    s_waitcnt lgkmcnt(2)
    ds_read_b64_tr_b16 v[44:45], v16 offset:40960
    ds_read_b64_tr_b16 v[46:47], v16 offset:41984
    v_mfma_f32_16x16x32_bf16 v[128:131], v[48:51], v[64:67], v[128:131]
    v_mfma_f32_16x16x32_bf16 v[128:131], v[52:55], v[68:71], v[128:131]
    ds_read_b64_tr_b16 v[32:33], v4 offset:49152
    ds_read_b64_tr_b16 v[34:35], v4 offset:51200
    v_mfma_f32_16x16x32_bf16 v[132:135], v[48:51], v[72:75], v[132:135]
    v_mfma_f32_16x16x32_bf16 v[132:135], v[52:55], v[76:79], v[132:135]
    v_mfma_f32_16x16x32_bf16 v[136:139], v[48:51], v[80:83], v[136:139]
    v_mfma_f32_16x16x32_bf16 v[136:139], v[52:55], v[84:87], v[136:139]
    v_mfma_f32_16x16x32_bf16 v[140:143], v[48:51], v[88:91], v[140:143]
    ds_read_b64_tr_b16 v[48:49], v17 offset:32768
    ds_read_b64_tr_b16 v[50:51], v17 offset:33792
    v_mfma_f32_16x16x32_bf16 v[140:143], v[52:55], v[92:95], v[140:143]
    ds_read_b64_tr_b16 v[52:53], v17 offset:40960
    ds_read_b64_tr_b16 v[54:55], v17 offset:41984
    v_mfma_f32_16x16x32_bf16 v[144:147], v[56:59], v[64:67], v[144:147]
    s_waitcnt lgkmcnt(4)
    buffer_store_dwordx4 v[32:35], v1, s[56:59], s70 offen offset:0 sc1
    v_mfma_f32_16x16x32_bf16 v[144:147], v[60:63], v[68:71], v[144:147]
    v_mul_f32 v128, s74, v128
    v_mul_f32 v129, s74, v129
    v_mfma_f32_16x16x32_bf16 v[148:151], v[56:59], v[72:75], v[148:151]
    v_mul_f32 v130, s74, v130
    v_mul_f32 v131, s74, v131
    v_mfma_f32_16x16x32_bf16 v[148:151], v[60:63], v[76:79], v[148:151]
    ds_read_b64_tr_b16 v[36:37], v4 offset:49184
    ds_read_b64_tr_b16 v[38:39], v4 offset:51232
    v_mfma_f32_16x16x32_bf16 v[152:155], v[56:59], v[80:83], v[152:155]
    v_mul_f32 v132, s74, v132
    v_mul_f32 v133, s74, v133
    v_mfma_f32_16x16x32_bf16 v[152:155], v[60:63], v[84:87], v[152:155]
    v_mul_f32 v134, s74, v134
    v_mul_f32 v135, s74, v135
    v_mfma_f32_16x16x32_bf16 v[156:159], v[56:59], v[88:91], v[156:159]
    ds_read_b64_tr_b16 v[56:57], v18 offset:32768
    ds_read_b64_tr_b16 v[58:59], v18 offset:33792
    v_mfma_f32_16x16x32_bf16 v[156:159], v[60:63], v[92:95], v[156:159]
    ds_read_b64_tr_b16 v[60:61], v18 offset:40960
    ds_read_b64_tr_b16 v[62:63], v18 offset:41984
    v_mfma_f32_16x16x32_bf16 v[160:163], v[40:43], v[64:67], v[160:163]
    v_mul_f32 v136, s74, v136
    v_mul_f32 v137, s74, v137
    v_mfma_f32_16x16x32_bf16 v[160:163], v[44:47], v[68:71], v[160:163]
    v_mul_f32 v138, s74, v138
    v_mul_f32 v139, s74, v139
    v_mfma_f32_16x16x32_bf16 v[164:167], v[40:43], v[72:75], v[164:167]
    s_waitcnt lgkmcnt(4)
    buffer_store_dwordx4 v[36:39], v1, s[56:59], s70 offen offset:1024 sc1
    v_mfma_f32_16x16x32_bf16 v[164:167], v[44:47], v[76:79], v[164:167]
    buffer_load_dword v7, v8, s[32:35], s61 offen sc1
    v_mfma_f32_16x16x32_bf16 v[168:171], v[40:43], v[80:83], v[168:171]
    v_mul_f32 v140, s74, v140
    v_mul_f32 v141, s74, v141
    v_mfma_f32_16x16x32_bf16 v[168:171], v[44:47], v[84:87], v[168:171]
    ds_read_b64_tr_b16 v[32:33], v4 offset:49216
    ds_read_b64_tr_b16 v[34:35], v4 offset:51264
    v_mfma_f32_16x16x32_bf16 v[172:175], v[40:43], v[88:91], v[172:175]
    ds_read_b64_tr_b16 v[40:41], v19 offset:32768
    ds_read_b64_tr_b16 v[42:43], v19 offset:33792
    v_mfma_f32_16x16x32_bf16 v[172:175], v[44:47], v[92:95], v[172:175]
    ds_read_b64_tr_b16 v[44:45], v19 offset:40960
    ds_read_b64_tr_b16 v[46:47], v19 offset:41984
    v_mfma_f32_16x16x32_bf16 v[176:179], v[48:51], v[64:67], v[176:179]
    v_mul_f32 v142, s74, v142
    v_mul_f32 v143, s74, v143
    v_mfma_f32_16x16x32_bf16 v[176:179], v[52:55], v[68:71], v[176:179]
    v_mul_f32 v144, s74, v144
    v_mul_f32 v145, s74, v145
    v_mfma_f32_16x16x32_bf16 v[180:183], v[48:51], v[72:75], v[180:183]
    v_mul_f32 v146, s74, v146
    v_mul_f32 v147, s74, v147
    v_mfma_f32_16x16x32_bf16 v[180:183], v[52:55], v[76:79], v[180:183]
    v_mul_f32 v148, s74, v148
    v_mul_f32 v149, s74, v149
    v_mfma_f32_16x16x32_bf16 v[184:187], v[48:51], v[80:83], v[184:187]
    s_waitcnt lgkmcnt(0)
    buffer_store_dwordx4 v[32:35], v1, s[56:59], s70 offen offset:2048 sc1
    v_mfma_f32_16x16x32_bf16 v[184:187], v[52:55], v[84:87], v[184:187]
    v_mul_f32 v150, s74, v150
    v_mul_f32 v151, s74, v151
    v_mfma_f32_16x16x32_bf16 v[188:191], v[48:51], v[88:91], v[188:191]
    ds_read_b64_tr_b16 v[48:49], v20 offset:32768
    ds_read_b64_tr_b16 v[50:51], v20 offset:33792
    v_mfma_f32_16x16x32_bf16 v[188:191], v[52:55], v[92:95], v[188:191]
    ds_read_b64_tr_b16 v[52:53], v20 offset:40960
    ds_read_b64_tr_b16 v[54:55], v20 offset:41984
    v_mfma_f32_16x16x32_bf16 v[192:195], v[56:59], v[64:67], v[192:195]
    ds_read_b64_tr_b16 v[36:37], v4 offset:49248
    ds_read_b64_tr_b16 v[38:39], v4 offset:51296
    v_mfma_f32_16x16x32_bf16 v[192:195], v[60:63], v[68:71], v[192:195]
    v_mul_f32 v152, s74, v152
    v_mul_f32 v153, s74, v153
    v_mfma_f32_16x16x32_bf16 v[196:199], v[56:59], v[72:75], v[196:199]
    v_mul_f32 v154, s74, v154
    v_mul_f32 v155, s74, v155
    v_mfma_f32_16x16x32_bf16 v[196:199], v[60:63], v[76:79], v[196:199]
    v_mul_f32 v156, s74, v156
    v_mul_f32 v157, s74, v157
    v_mfma_f32_16x16x32_bf16 v[200:203], v[56:59], v[80:83], v[200:203]
    v_mul_f32 v158, s74, v158
    v_mul_f32 v159, s74, v159
    v_mfma_f32_16x16x32_bf16 v[200:203], v[60:63], v[84:87], v[200:203]
    v_mul_f32 v160, s74, v160
    v_mul_f32 v161, s74, v161
    v_mfma_f32_16x16x32_bf16 v[204:207], v[56:59], v[88:91], v[204:207]
    ds_read_b64_tr_b16 v[56:57], v21 offset:32768
    ds_read_b64_tr_b16 v[58:59], v21 offset:33792
    v_mfma_f32_16x16x32_bf16 v[204:207], v[60:63], v[92:95], v[204:207]
    ds_read_b64_tr_b16 v[60:61], v21 offset:40960
    ds_read_b64_tr_b16 v[62:63], v21 offset:41984
    v_mfma_f32_16x16x32_bf16 v[208:211], v[40:43], v[64:67], v[208:211]
    s_waitcnt lgkmcnt(4)
    buffer_store_dwordx4 v[36:39], v1, s[56:59], s70 offen offset:3072 sc1
    v_mfma_f32_16x16x32_bf16 v[208:211], v[44:47], v[68:71], v[208:211]
    v_mul_f32 v162, s74, v162
    v_mul_f32 v163, s74, v163
    v_mfma_f32_16x16x32_bf16 v[212:215], v[40:43], v[72:75], v[212:215]
    v_mul_f32 v164, s74, v164
    v_mul_f32 v165, s74, v165
    v_mfma_f32_16x16x32_bf16 v[212:215], v[44:47], v[76:79], v[212:215]
    v_mul_f32 v166, s74, v166
    v_mul_f32 v167, s74, v167
    v_mfma_f32_16x16x32_bf16 v[216:219], v[40:43], v[80:83], v[216:219]
    v_mul_f32 v168, s74, v168
    v_mul_f32 v169, s74, v169
    v_mfma_f32_16x16x32_bf16 v[216:219], v[44:47], v[84:87], v[216:219]
    v_mul_f32 v170, s74, v170
    v_mul_f32 v171, s74, v171
    v_mfma_f32_16x16x32_bf16 v[220:223], v[40:43], v[88:91], v[220:223]
    ds_read_b64_tr_b16 v[40:41], v26 offset:0
    ds_read_b64_tr_b16 v[42:43], v26 offset:512
    v_mfma_f32_16x16x32_bf16 v[220:223], v[44:47], v[92:95], v[220:223]
    ds_read_b64_tr_b16 v[44:45], v26 offset:4096
    ds_read_b64_tr_b16 v[46:47], v26 offset:4608
    v_mfma_f32_16x16x32_bf16 v[224:227], v[48:51], v[64:67], v[224:227]
    v_mul_f32 v172, s74, v172
    v_mul_f32 v173, s74, v173
    v_mfma_f32_16x16x32_bf16 v[224:227], v[52:55], v[68:71], v[224:227]
    v_mul_f32 v174, s74, v174
    v_mul_f32 v175, s74, v175
    v_mfma_f32_16x16x32_bf16 v[228:231], v[48:51], v[72:75], v[228:231]
    v_mul_f32 v176, s74, v176
    v_mul_f32 v177, s74, v177
    v_mfma_f32_16x16x32_bf16 v[228:231], v[52:55], v[76:79], v[228:231]
    v_mul_f32 v178, s74, v178
    v_mul_f32 v179, s74, v179
    v_mfma_f32_16x16x32_bf16 v[232:235], v[48:51], v[80:83], v[232:235]
    v_mul_f32 v180, s74, v180
    v_mul_f32 v181, s74, v181
    v_mfma_f32_16x16x32_bf16 v[232:235], v[52:55], v[84:87], v[232:235]
    s_mov_b32 s38, 16384
    v_mul_f32 v182, s74, v182
    v_mul_f32 v183, s74, v183
    s_waitcnt vmcnt(2)
    v_cmp_gt_u32 vcc, 1, v7
    s_nop 1
    s_and_b64 vcc, vcc, exec
    s_cbranch_scc1 SPIN_KV
BACK_KV:
    v_mfma_f32_16x16x32_bf16 v[236:239], v[48:51], v[88:91], v[236:239]
    s_mov_b32 s77, s75
    ds_read_b64_tr_b16 v[48:49], v27 offset:0
    ds_read_b64_tr_b16 v[50:51], v27 offset:512
    v_mfma_f32_16x16x32_bf16 v[236:239], v[52:55], v[92:95], v[236:239]
    s_add_u32 m0, s76, s75
    ds_read_b64_tr_b16 v[52:53], v27 offset:4096
    ds_read_b64_tr_b16 v[54:55], v27 offset:4608
    s_waitcnt lgkmcnt(4)
    v_mfma_f32_16x16x32_bf16 v[240:243], v[56:59], v[64:67], v[240:243]
    buffer_load_dwordx4 v1, s[36:39], s77 offen sc1 lds
    v_mfma_f32_16x16x32_bf16 v[240:243], v[60:63], v[68:71], v[240:243]
    v_mul_f32 v184, s74, v184
    v_mul_f32 v185, s74, v185
    v_mfma_f32_16x16x32_bf16 v[244:247], v[56:59], v[72:75], v[244:247]
    buffer_load_dwordx4 v1, s[36:39], s77 offen offset:1024 sc1 lds
    v_mfma_f32_16x16x32_bf16 v[244:247], v[60:63], v[76:79], v[244:247]
    v_mul_f32 v186, s74, v186
    v_mul_f32 v187, s74, v187
    v_mfma_f32_16x16x32_bf16 v[248:251], v[56:59], v[80:83], v[248:251]
    v_mul_f32 v188, s74, v188
    v_mul_f32 v189, s74, v189
    v_mfma_f32_16x16x32_bf16 v[248:251], v[60:63], v[84:87], v[248:251]
    v_mul_f32 v190, s74, v190
    v_mul_f32 v191, s74, v191
    v_mfma_f32_16x16x32_bf16 v[252:255], v[56:59], v[88:91], v[252:255]
    buffer_load_dwordx4 v1, s[36:39], s77 offen offset:2048 sc1 lds
    v_mfma_f32_16x16x32_bf16 v[252:255], v[60:63], v[92:95], v[252:255]
    ds_read_b64_tr_b16 v[56:57], v28 offset:0
    ds_read_b64_tr_b16 v[58:59], v28 offset:512
    v_mfma_f32_16x16x32_bf16 a[64:67], v[40:43], v[64:67], a[64:67]
    ds_read_b64_tr_b16 v[60:61], v28 offset:4096
    ds_read_b64_tr_b16 v[62:63], v28 offset:4608
    v_mfma_f32_16x16x32_bf16 a[64:67], v[44:47], v[68:71], a[64:67]
    ds_read_b64_tr_b16 v[32:33], v5 offset:16384
    ds_read_b64_tr_b16 v[34:35], v5 offset:17408
    v_mfma_f32_16x16x32_bf16 a[68:71], v[40:43], v[72:75], a[68:71]
    buffer_load_dwordx4 v1, s[36:39], s77 offen offset:3072 sc1 lds
    v_mfma_f32_16x16x32_bf16 a[68:71], v[44:47], v[76:79], a[68:71]
    v_mul_f32 v192, s74, v192
    v_mul_f32 v193, s74, v193
    v_mfma_f32_16x16x32_bf16 a[72:75], v[40:43], v[80:83], a[72:75]
    v_mul_f32 v194, s74, v194
    v_mul_f32 v195, s74, v195
    v_mfma_f32_16x16x32_bf16 a[72:75], v[44:47], v[84:87], a[72:75]
    s_add_u32 s100, s77, 4096
    v_mul_f32 v196, s74, v196
    v_mul_f32 v197, s74, v197
    v_mfma_f32_16x16x32_bf16 a[76:79], v[40:43], v[88:91], a[76:79]
    s_add_u32 m0, m0, 4096
    v_mul_f32 v198, s74, v198
    v_mul_f32 v199, s74, v199
    v_mfma_f32_16x16x32_bf16 a[76:79], v[44:47], v[92:95], a[76:79]
    buffer_load_dwordx4 v1, s[36:39], s100 offen sc1 lds
    v_mfma_f32_16x16x32_bf16 a[128:131], v[40:43], a[136:139], a[128:131]
    ds_read_b64_tr_b16 v[40:41], v29 offset:0
    ds_read_b64_tr_b16 v[42:43], v29 offset:512
    v_mfma_f32_16x16x32_bf16 a[128:131], v[44:47], a[140:143], a[128:131]
    s_waitcnt lgkmcnt(2)
    ds_read_b64_tr_b16 v[44:45], v29 offset:4096
    ds_read_b64_tr_b16 v[46:47], v29 offset:4608
    v_mfma_f32_16x16x32_bf16 a[80:83], v[48:51], v[64:67], a[80:83]
    buffer_load_dwordx4 v1, s[36:39], s100 offen offset:1024 sc1 lds
    v_mfma_f32_16x16x32_bf16 a[80:83], v[52:55], v[68:71], a[80:83]
    ds_read_b64_tr_b16 v[36:37], v5 offset:16416
    ds_read_b64_tr_b16 v[38:39], v5 offset:17440
    v_mfma_f32_16x16x32_bf16 a[84:87], v[48:51], v[72:75], a[84:87]
    v_mul_f32 v200, s74, v200
    v_mul_f32 v201, s74, v201
    v_mfma_f32_16x16x32_bf16 a[84:87], v[52:55], v[76:79], a[84:87]
    v_mul_f32 v202, s74, v202
    v_mul_f32 v203, s74, v203
    v_mfma_f32_16x16x32_bf16 a[88:91], v[48:51], v[80:83], a[88:91]
    buffer_load_dwordx4 v1, s[36:39], s100 offen offset:2048 sc1 lds
    v_mfma_f32_16x16x32_bf16 a[88:91], v[52:55], v[84:87], a[88:91]
    v_mul_f32 v204, s74, v204
    v_mul_f32 v205, s74, v205
    v_mfma_f32_16x16x32_bf16 a[92:95], v[48:51], v[88:91], a[92:95]
    v_mul_f32 v206, s74, v206
    v_mul_f32 v207, s74, v207
    v_mfma_f32_16x16x32_bf16 a[92:95], v[52:55], v[92:95], a[92:95]
    v_mul_f32 v208, s74, v208
    v_mul_f32 v209, s74, v209
    v_mfma_f32_16x16x32_bf16 a[132:135], v[48:51], a[136:139], a[132:135]
    buffer_load_dwordx4 v1, s[36:39], s100 offen offset:3072 sc1 lds
    v_mfma_f32_16x16x32_bf16 a[132:135], v[52:55], a[140:143], a[132:135]
    v_mul_f32 v210, s74, v210
    v_mul_f32 v211, s74, v211
    v_mfma_f32_16x16x32_bf16 a[96:99], v[56:59], v[64:67], a[96:99]
    v_mul_f32 v212, s74, v212
    v_mul_f32 v213, s74, v213
    v_mfma_f32_16x16x32_bf16 a[96:99], v[60:63], v[68:71], a[96:99]
    s_lshr_b32 s7, s4, 1
    s_add_u32 s7, s7, 32
    v_mul_f32 v214, s74, v214
    v_mfma_f32_16x16x32_bf16 a[100:103], v[56:59], v[72:75], a[100:103]
    s_sub_u32 s7, s7, s6
    v_mul_f32 v215, s74, v215
    v_mul_f32 v216, s74, v216
    v_mfma_f32_16x16x32_bf16 a[100:103], v[60:63], v[76:79], a[100:103]
    s_sub_u32 s7, s7, s6
    v_mul_f32 v217, s74, v217
    v_mul_f32 v218, s74, v218
    v_mfma_f32_16x16x32_bf16 a[104:107], v[56:59], v[80:83], a[104:107]
    s_add_u32 s77, s77, 32768
    s_add_u32 s76, s76, 32768
    s_lshl_b32 s38, s7, 15
    v_mfma_f32_16x16x32_bf16 a[104:107], v[60:63], v[84:87], a[104:107]
    v_mul_f32 v219, s74, v219
    v_mul_f32 v220, s74, v220
    v_mfma_f32_16x16x32_bf16 a[108:111], v[56:59], v[88:91], a[108:111]
    v_mul_f32 v221, s74, v221
    v_mul_f32 v222, s74, v222
    v_mfma_f32_16x16x32_bf16 a[108:111], v[60:63], v[92:95], a[108:111]
    s_waitcnt lgkmcnt(0)
    v_mul_f32 v223, s74, v223
    v_mul_f32 v224, s74, v224
    v_mfma_f32_16x16x32_bf16 a[112:115], v[40:43], v[64:67], a[112:115]
    v_mul_f32 v225, s74, v225
    v_mul_f32 v226, s74, v226
    v_mfma_f32_16x16x32_bf16 a[112:115], v[44:47], v[68:71], a[112:115]
    v_mul_f32 v227, s74, v227
    v_mul_f32 v228, s74, v228
    v_mfma_f32_16x16x32_bf16 a[116:119], v[40:43], v[72:75], a[116:119]
    v_mul_f32 v229, s74, v229
    v_mul_f32 v230, s74, v230
    v_mfma_f32_16x16x32_bf16 a[116:119], v[44:47], v[76:79], a[116:119]
    v_mul_f32 v231, s74, v231
    v_mul_f32 v232, s74, v232
    v_mfma_f32_16x16x32_bf16 a[120:123], v[40:43], v[80:83], a[120:123]
    v_mul_f32 v233, s74, v233
    v_mul_f32 v234, s74, v234
    v_mfma_f32_16x16x32_bf16 a[120:123], v[44:47], v[84:87], a[120:123]
    v_mul_f32 v235, s74, v235
    v_mul_f32 v236, s74, v236
    v_mfma_f32_16x16x32_bf16 a[124:127], v[40:43], v[88:91], a[124:127]
    v_mul_f32 v237, s74, v237
    v_mul_f32 v238, s74, v238
    v_mfma_f32_16x16x32_bf16 a[124:127], v[44:47], v[92:95], a[124:127]
    s_add_u32 m0, s76, s75
    s_nop 0
    buffer_load_dwordx4 v1, s[36:39], s77 offen sc1 lds
    v_mul_f32 v239, s74, v239
    v_mul_f32 v240, s74, v240
    v_mul_f32 v241, s74, v241
    v_mul_f32 v242, s74, v242
    v_mul_f32 v243, s74, v243
    v_mul_f32 v244, s74, v244
    v_mul_f32 v245, s74, v245
    v_mul_f32 v246, s74, v246
    v_mul_f32 v247, s74, v247
    v_mul_f32 v248, s74, v248
    v_mul_f32 v249, s74, v249
    v_mul_f32 v250, s74, v250
    v_mul_f32 v251, s74, v251
    v_mul_f32 v252, s74, v252
    v_mul_f32 v253, s74, v253
    v_mul_f32 v254, s74, v254
    buffer_load_dwordx4 v1, s[36:39], s77 offen offset:1024 sc1 lds
    v_mul_f32 v255, s74, v255
    v_cvt_pk_bf16_f32 v128, v128, v129
    v_cvt_pk_bf16_f32 v129, v130, v131
    v_cvt_pk_bf16_f32 v130, v144, v145
    v_cvt_pk_bf16_f32 v131, v146, v147
    v_cvt_pk_bf16_f32 v132, v132, v133
    v_cvt_pk_bf16_f32 v133, v134, v135
    v_cvt_pk_bf16_f32 v134, v148, v149
    v_cvt_pk_bf16_f32 v135, v150, v151
    v_cvt_pk_bf16_f32 v136, v136, v137
    v_cvt_pk_bf16_f32 v137, v138, v139
    v_cvt_pk_bf16_f32 v138, v152, v153
    v_cvt_pk_bf16_f32 v139, v154, v155
    v_cvt_pk_bf16_f32 v140, v140, v141
    v_cvt_pk_bf16_f32 v141, v142, v143
    v_cvt_pk_bf16_f32 v142, v156, v157
    buffer_load_dwordx4 v1, s[36:39], s77 offen offset:2048 sc1 lds
    v_cvt_pk_bf16_f32 v143, v158, v159
    v_cvt_pk_bf16_f32 v160, v160, v161
    v_cvt_pk_bf16_f32 v161, v162, v163
    v_cvt_pk_bf16_f32 v162, v176, v177
    v_cvt_pk_bf16_f32 v163, v178, v179
    v_cvt_pk_bf16_f32 v164, v164, v165
    v_cvt_pk_bf16_f32 v165, v166, v167
    v_cvt_pk_bf16_f32 v166, v180, v181
    v_cvt_pk_bf16_f32 v167, v182, v183
    v_cvt_pk_bf16_f32 v168, v168, v169
    v_cvt_pk_bf16_f32 v169, v170, v171
    v_cvt_pk_bf16_f32 v170, v184, v185
    v_cvt_pk_bf16_f32 v171, v186, v187
    v_cvt_pk_bf16_f32 v172, v172, v173
    v_cvt_pk_bf16_f32 v173, v174, v175
    v_cvt_pk_bf16_f32 v174, v188, v189
    v_cvt_pk_bf16_f32 v175, v190, v191
    buffer_load_dwordx4 v1, s[36:39], s77 offen offset:3072 sc1 lds
    v_cvt_pk_bf16_f32 v192, v192, v193
    v_cvt_pk_bf16_f32 v193, v194, v195
    v_cvt_pk_bf16_f32 v194, v208, v209
    v_cvt_pk_bf16_f32 v195, v210, v211
    v_cvt_pk_bf16_f32 v196, v196, v197
    v_cvt_pk_bf16_f32 v197, v198, v199
    v_cvt_pk_bf16_f32 v198, v212, v213
    v_cvt_pk_bf16_f32 v199, v214, v215
    v_cvt_pk_bf16_f32 v200, v200, v201
    v_cvt_pk_bf16_f32 v201, v202, v203
    v_cvt_pk_bf16_f32 v202, v216, v217
    v_cvt_pk_bf16_f32 v203, v218, v219
    v_cvt_pk_bf16_f32 v204, v204, v205
    v_cvt_pk_bf16_f32 v205, v206, v207
    v_cvt_pk_bf16_f32 v206, v220, v221
    v_cvt_pk_bf16_f32 v207, v222, v223
    s_add_u32 s100, s77, 4096
    s_add_u32 m0, m0, 4096
    s_nop 0
    buffer_load_dwordx4 v1, s[36:39], s100 offen sc1 lds
    v_cvt_pk_bf16_f32 v224, v224, v225
    v_cvt_pk_bf16_f32 v225, v226, v227
    v_cvt_pk_bf16_f32 v226, v240, v241
    v_cvt_pk_bf16_f32 v227, v242, v243
    v_cvt_pk_bf16_f32 v228, v228, v229
    v_cvt_pk_bf16_f32 v229, v230, v231
    v_cvt_pk_bf16_f32 v230, v244, v245
    v_cvt_pk_bf16_f32 v231, v246, v247
    v_cvt_pk_bf16_f32 v232, v232, v233
    v_cvt_pk_bf16_f32 v233, v234, v235
    v_cvt_pk_bf16_f32 v234, v248, v249
    v_cvt_pk_bf16_f32 v235, v250, v251
    v_cvt_pk_bf16_f32 v236, v236, v237
    v_cvt_pk_bf16_f32 v237, v238, v239
    v_cvt_pk_bf16_f32 v238, v252, v253
    v_cvt_pk_bf16_f32 v239, v254, v255
    buffer_load_dwordx4 v1, s[36:39], s100 offen offset:1024 sc1 lds
    buffer_store_dwordx4 v[32:35], v1, s[56:59], s71 offen offset:0 sc1
    buffer_store_dwordx4 v[36:39], v1, s[56:59], s71 offen offset:1024 sc1
    v_mov_b32 v8, 0x3f803f80
    v_accvgpr_write_b32 a136, v8
    v_accvgpr_write_b32 a137, v8
    v_accvgpr_write_b32 a138, v8
    v_accvgpr_write_b32 a139, v8
    v_bfe_u32 v8, v1, 4, 4
    v_lshrrev_b32 v9, 8, v1
    v_lshlrev_b32 v9, 2, v9
    v_sub_u32 v8, v8, v9
    v_mov_b32 v9, 0xf149f2ca
    v_cmp_le_i32 vcc, 0, v8
    s_cmp_eq_u32 s4, 0
    s_cselect_b32 s8, 1.0, 0
    v_cndmask_b32_e64 v208, v9, 0, vcc
    buffer_load_dwordx4 v1, s[36:39], s100 offen offset:2048 sc1 lds
    s_cmp_lt_u32 s4, 0
    s_cselect_b32 s12, 0xf149f2ca, 0
    v_cmp_le_i32 vcc, 1, v8
    s_cmp_eq_u32 s4, 1
    s_cselect_b32 s9, 1.0, 0
    v_cndmask_b32_e64 v209, v9, 0, vcc
    s_cmp_lt_u32 s4, 1
    s_cselect_b32 s13, 0xf149f2ca, 0
    v_cmp_le_i32 vcc, 2, v8
    s_cmp_eq_u32 s4, 2
    s_cselect_b32 s10, 1.0, 0
    v_cndmask_b32_e64 v210, v9, 0, vcc
    s_cmp_lt_u32 s4, 2
    s_cselect_b32 s14, 0xf149f2ca, 0
    v_cmp_le_i32 vcc, 3, v8
    s_cmp_eq_u32 s4, 3
    s_cselect_b32 s11, 1.0, 0
    buffer_load_dwordx4 v1, s[36:39], s100 offen offset:3072 sc1 lds
    s_add_u32 s77, s77, 32768
    s_add_u32 s76, s76, 32768
    v_cndmask_b32_e64 v211, v9, 0, vcc
    s_cmp_lt_u32 s4, 3
    s_cselect_b32 s15, 0xf149f2ca, 0
    s_lshl3_add_u32 s80, s6, s4
    s_mul_i32 s80, s80, 155648
    s_sub_u32 s7, 15, s6
    s_lshl3_add_u32 s81, s7, s4
    s_mul_i32 s81, s81, 155648
    s_lshl_b32 s7, s5, 12
    s_add_u32 s80, s80, s7
    s_add_u32 s81, s81, s7
    s_mov_b32 s92, 0x55555555
    s_mov_b32 s93, 0x55555555
    s_load_dwordx2 s[24:25], s[0:1], 80
    s_mov_b32 s26, 2359296
    s_mov_b32 s27, 0x20000
K1_ATT:
    s_mov_b32 s82, 0
    s_mov_b32 s60, 131072
    v_mov_b32 v2, v1
    v_mov_b32 v11, 0
    s_cmp_eq_u32 s6, 0
    s_cselect_b32 s16, s8, 0
    s_cselect_b32 s17, s9, 0
    s_cselect_b32 s18, s10, 0
    s_cselect_b32 s19, s11, 0
    s_cselect_b32 s20, s12, 0
    s_cselect_b32 s21, s13, 0
    s_cselect_b32 s22, s14, 0
    s_cselect_b32 s23, s15, 0
    s_waitcnt vmcnt(8) lgkmcnt(0)
    s_barrier
    ds_read_b128 a[224:227], v2 offset:0
    ds_read_b128 a[228:231], v2 offset:1024
    ds_read_b128 a[232:235], v2 offset:2048
    ds_read_b128 a[236:239], v2 offset:3072
    ds_read_b128 v[96:99], v2 offset:16384
    ds_read_b128 v[100:103], v2 offset:17408
    s_cmp_lg_u32 s83, 0
    s_cbranch_scc1 K1_HAVEM_R
    s_add_u32 m0, s76, s75
    s_nop 0
    buffer_load_dwordx4 v1, s[36:39], s77 offen sc1 lds
    v_mul_f32 v176, s16, v208
    v_mul_f32 v177, s16, v209
    v_mul_f32 v178, s16, v210
    v_mul_f32 v179, s16, v211
    s_waitcnt lgkmcnt(2)
    buffer_load_dwordx4 v1, s[36:39], s77 offen offset:1024 sc1 lds
    v_mfma_f32_16x16x32_bf16 v[240:243], a[224:227], v[128:131], v[176:179]
    v_mfma_f32_16x16x32_bf16 v[240:243], a[228:231], v[160:163], v[240:243]
    v_mfma_f32_16x16x32_bf16 v[240:243], a[232:235], v[192:195], v[240:243]
    v_mfma_f32_16x16x32_bf16 v[240:243], a[236:239], v[224:227], v[240:243]
    v_mfma_f32_16x16x32_bf16 v[244:247], a[224:227], v[132:135], 0
    buffer_load_dwordx4 v1, s[36:39], s77 offen offset:2048 sc1 lds
    v_mfma_f32_16x16x32_bf16 v[244:247], a[228:231], v[164:167], v[244:247]
    v_mfma_f32_16x16x32_bf16 v[244:247], a[232:235], v[196:199], v[244:247]
    v_mfma_f32_16x16x32_bf16 v[244:247], a[236:239], v[228:231], v[244:247]
    v_mfma_f32_16x16x32_bf16 v[248:251], a[224:227], v[136:139], 0
    v_mfma_f32_16x16x32_bf16 v[248:251], a[228:231], v[168:171], v[248:251]
    buffer_load_dwordx4 v1, s[36:39], s77 offen offset:3072 sc1 lds
    s_add_u32 s100, s77, 4096
    v_mfma_f32_16x16x32_bf16 v[248:251], a[232:235], v[200:203], v[248:251]
    v_mfma_f32_16x16x32_bf16 v[248:251], a[236:239], v[232:235], v[248:251]
    v_mfma_f32_16x16x32_bf16 v[252:255], a[224:227], v[140:143], 0
    v_mfma_f32_16x16x32_bf16 v[252:255], a[228:231], v[172:175], v[252:255]
    v_mfma_f32_16x16x32_bf16 v[252:255], a[232:235], v[204:207], v[252:255]
    v_mfma_f32_16x16x32_bf16 v[252:255], a[236:239], v[236:239], v[252:255]
    s_add_u32 m0, m0, 4096
    s_nop 0
    buffer_load_dwordx4 v1, s[36:39], s100 offen sc1 lds
    v_max3_f32 v240, v240, v241, v242
    v_max_f32 v240, v240, v243
    v_max3_f32 v244, v244, v245, v246
    v_max_f32 v244, v244, v247
    v_max3_f32 v248, v248, v249, v250
    v_max_f32 v248, v248, v251
    v_max3_f32 v252, v252, v253, v254
    v_max_f32 v252, v252, v255
    v_mov_b32 v241, v240
    v_mov_b32 v245, v244
    v_mov_b32 v249, v248
    v_mov_b32 v253, v252
    buffer_load_dwordx4 v1, s[36:39], s100 offen offset:1024 sc1 lds
    v_permlane32_swap_b32 v240, v241
    v_permlane32_swap_b32 v244, v245
    v_permlane32_swap_b32 v248, v249
    v_permlane32_swap_b32 v252, v253
    v_max_f32 v240, v240, v241
    v_max_f32 v244, v244, v245
    v_max_f32 v248, v248, v249
    v_max_f32 v252, v252, v253
    v_mov_b32 v241, v240
    v_mov_b32 v245, v244
    v_mov_b32 v249, v248
    v_mov_b32 v253, v252
    buffer_load_dwordx4 v1, s[36:39], s100 offen offset:2048 sc1 lds
    v_permlane16_swap_b32 v240, v241
    v_permlane16_swap_b32 v244, v245
    v_permlane16_swap_b32 v248, v249
    v_permlane16_swap_b32 v252, v253
    v_max_f32 v240, v240, v241
    v_max_f32 v244, v244, v245
    v_max_f32 v248, v248, v249
    v_max_f32 v252, v252, v253
    v_sub_f32 v144, 0, v240
    v_sub_f32 v145, 0, v240
    v_sub_f32 v146, 0, v240
    v_sub_f32 v147, 0, v240
    buffer_load_dwordx4 v1, s[36:39], s100 offen offset:3072 sc1 lds
    s_add_u32 s77, s77, 32768
    s_add_u32 s76, s76, 32768
    v_sub_f32 v148, 0, v244
    v_sub_f32 v149, 0, v244
    v_sub_f32 v150, 0, v244
    v_sub_f32 v151, 0, v244
    v_sub_f32 v152, 0, v248
    v_sub_f32 v153, 0, v248
    v_sub_f32 v154, 0, v248
    v_sub_f32 v155, 0, v248
    v_sub_f32 v156, 0, v252
    v_sub_f32 v157, 0, v252
    v_sub_f32 v158, 0, v252
    v_sub_f32 v159, 0, v252
K1_HAVEM:
    v_add_f32 v212, s20, v144
    v_fma_f32 v176, v208, s16, v212
    v_fma_f32 v177, v209, s16, v212
    v_fma_f32 v178, v210, s16, v212
    v_fma_f32 v179, v211, s16, v212
    s_nop 1
    s_waitcnt lgkmcnt(0)
    v_mfma_f32_16x16x32_bf16 v[240:243], a[224:227], v[128:131], v[176:179]
    s_add_u32 m0, s76, s75
    ds_read_b128 a[240:243], v2 offset:4096
    ds_read_b128 a[244:247], v2 offset:5120
    v_mfma_f32_16x16x32_bf16 v[240:243], a[228:231], v[160:163], v[240:243]
    s_mov_b32 s76, s60
    buffer_load_dwordx4 v1, s[36:39], s77 offen sc1 lds
    v_mfma_f32_16x16x32_bf16 v[240:243], a[232:235], v[192:195], v[240:243]
    s_mov_b32 s60, s82
    ds_read_b128 a[248:251], v2 offset:6144
    ds_read_b128 a[252:255], v2 offset:7168
    v_mfma_f32_16x16x32_bf16 v[240:243], a[236:239], v[224:227], v[240:243]
    s_add_u32 s82, s82, 32768
    v_add_f32 v213, s21, v144
    v_fma_f32 v180, v208, s17, v213
    v_mfma_f32_16x16x32_bf16 v[244:247], a[224:227], v[132:135], v[148:151]
    v_fma_f32 v181, v209, s17, v213
    v_fma_f32 v182, v210, s17, v213
    v_mfma_f32_16x16x32_bf16 v[244:247], a[228:231], v[164:167], v[244:247]
    v_fma_f32 v183, v211, s17, v213
    v_add_f32 v214, s22, v144
    v_mfma_f32_16x16x32_bf16 v[244:247], a[232:235], v[196:199], v[244:247]
    buffer_load_dwordx4 v1, s[36:39], s77 offen offset:1024 sc1 lds
    v_mfma_f32_16x16x32_bf16 v[244:247], a[236:239], v[228:231], v[244:247]
    v_exp_f32 v240, v240
    v_mfma_f32_16x16x32_bf16 v[248:251], a[224:227], v[136:139], v[152:155]
    v_exp_f32 v241, v241
    v_mfma_f32_16x16x32_bf16 v[248:251], a[228:231], v[168:171], v[248:251]
    v_exp_f32 v242, v242
    v_mfma_f32_16x16x32_bf16 v[248:251], a[232:235], v[200:203], v[248:251]
    v_exp_f32 v243, v243
    v_mfma_f32_16x16x32_bf16 v[248:251], a[236:239], v[232:235], v[248:251]
    buffer_load_dwordx4 v1, s[36:39], s77 offen offset:2048 sc1 lds
    v_mfma_f32_16x16x32_bf16 v[252:255], a[224:227], v[140:143], v[156:159]
    v_cvt_pk_bf16_f32 v32, v240, v241
    v_cvt_pk_bf16_f32 v33, v242, v243
    v_mfma_f32_16x16x32_bf16 v[252:255], a[228:231], v[172:175], v[252:255]
    v_exp_f32 v244, v244
    v_mfma_f32_16x16x32_bf16 v[252:255], a[232:235], v[204:207], v[252:255]
    v_exp_f32 v245, v245
    v_mfma_f32_16x16x32_bf16 v[252:255], a[236:239], v[236:239], v[252:255]
    s_waitcnt lgkmcnt(0)
    v_exp_f32 v246, v246
    v_mfma_f32_16x16x32_bf16 v[240:243], a[240:243], v[128:131], v[180:183]
    v_exp_f32 v247, v247
    v_mfma_f32_16x16x32_bf16 v[240:243], a[244:247], v[160:163], v[240:243]
    buffer_load_dwordx4 v1, s[36:39], s77 offen offset:3072 sc1 lds
    v_mfma_f32_16x16x32_bf16 v[240:243], a[248:251], v[192:195], v[240:243]
    v_cvt_pk_bf16_f32 v40, v244, v245
    v_cvt_pk_bf16_f32 v41, v246, v247
    v_mfma_f32_16x16x32_bf16 v[240:243], a[252:255], v[224:227], v[240:243]
    v_exp_f32 v248, v248
    v_mfma_f32_16x16x32_bf16 v[244:247], a[240:243], v[132:135], v[148:151]
    v_exp_f32 v249, v249
    v_mfma_f32_16x16x32_bf16 v[244:247], a[244:247], v[164:167], v[244:247]
    s_add_u32 s100, s77, 4096
    v_exp_f32 v250, v250
    v_mfma_f32_16x16x32_bf16 v[244:247], a[248:251], v[196:199], v[244:247]
    s_add_u32 m0, m0, 4096
    v_exp_f32 v251, v251
    v_mfma_f32_16x16x32_bf16 v[244:247], a[252:255], v[228:231], v[244:247]
    v_cvt_pk_bf16_f32 v48, v248, v249
    v_cvt_pk_bf16_f32 v49, v250, v251
    v_mfma_f32_16x16x32_bf16 v[248:251], a[240:243], v[136:139], v[152:155]
    ds_read_b128 a[224:227], v2 offset:8192
    ds_read_b128 a[228:231], v2 offset:9216
    v_mfma_f32_16x16x32_bf16 v[248:251], a[244:247], v[168:171], v[248:251]
    buffer_load_dwordx4 v1, s[36:39], s100 offen sc1 lds
    v_mfma_f32_16x16x32_bf16 v[248:251], a[248:251], v[200:203], v[248:251]
    v_exp_f32 v252, v252
    v_mfma_f32_16x16x32_bf16 v[248:251], a[252:255], v[232:235], v[248:251]
    v_exp_f32 v253, v253
    v_exp_f32 v254, v254
    v_exp_f32 v255, v255
    v_cvt_pk_bf16_f32 v56, v252, v253
    v_cvt_pk_bf16_f32 v57, v254, v255
    v_mfma_f32_16x16x32_bf16 v[252:255], a[240:243], v[140:143], v[156:159]
    ds_read_b128 a[232:235], v2 offset:10240
    ds_read_b128 a[236:239], v2 offset:11264
    v_mfma_f32_16x16x32_bf16 v[252:255], a[244:247], v[172:175], v[252:255]
    buffer_load_dwordx4 v1, s[36:39], s100 offen offset:1024 sc1 lds
    v_mfma_f32_16x16x32_bf16 v[252:255], a[248:251], v[204:207], v[252:255]
    v_exp_f32 v240, v240
    v_mfma_f32_16x16x32_bf16 v[252:255], a[252:255], v[236:239], v[252:255]
    s_waitcnt lgkmcnt(2)
    v_exp_f32 v241, v241
    v_exp_f32 v242, v242
    v_exp_f32 v243, v243
    v_fma_f32 v184, v208, s18, v214
    v_fma_f32 v185, v209, s18, v214
    v_fma_f32 v186, v210, s18, v214
    v_fma_f32 v187, v211, s18, v214
    v_cvt_pk_bf16_f32 v34, v240, v241
    v_cvt_pk_bf16_f32 v35, v242, v243
    v_mfma_f32_16x16x32_bf16 v[240:243], a[224:227], v[128:131], v[184:187]
    v_exp_f32 v244, v244
    v_mfma_f32_16x16x32_bf16 v[240:243], a[228:231], v[160:163], v[240:243]
    s_waitcnt lgkmcnt(0)
    v_exp_f32 v245, v245
    v_mfma_f32_16x16x32_bf16 v[240:243], a[232:235], v[192:195], v[240:243]
    v_exp_f32 v246, v246
    v_mfma_f32_16x16x32_bf16 v[240:243], a[236:239], v[224:227], v[240:243]
    v_exp_f32 v247, v247
    v_cvt_pk_bf16_f32 v42, v244, v245
    v_cvt_pk_bf16_f32 v43, v246, v247
    v_mfma_f32_16x16x32_bf16 v[244:247], a[224:227], v[132:135], v[148:151]
    buffer_load_dwordx4 v1, s[36:39], s100 offen offset:2048 sc1 lds
    v_mfma_f32_16x16x32_bf16 v[244:247], a[228:231], v[164:167], v[244:247]
    v_exp_f32 v248, v248
    v_mfma_f32_16x16x32_bf16 v[244:247], a[232:235], v[196:199], v[244:247]
    v_exp_f32 v249, v249
    v_mfma_f32_16x16x32_bf16 v[244:247], a[236:239], v[228:231], v[244:247]
    v_exp_f32 v250, v250
    v_exp_f32 v251, v251
    v_cvt_pk_bf16_f32 v50, v248, v249
    v_cvt_pk_bf16_f32 v51, v250, v251
    v_mfma_f32_16x16x32_bf16 v[248:251], a[224:227], v[136:139], v[152:155]
    buffer_load_dwordx4 v1, s[36:39], s100 offen offset:3072 sc1 lds
    v_mfma_f32_16x16x32_bf16 v[248:251], a[228:231], v[168:171], v[248:251]
    ds_read_b128 a[240:243], v2 offset:12288
    ds_read_b128 a[244:247], v2 offset:13312
    v_mfma_f32_16x16x32_bf16 v[248:251], a[232:235], v[200:203], v[248:251]
    s_add_u32 s77, s77, 32768
    v_exp_f32 v252, v252
    v_mfma_f32_16x16x32_bf16 v[248:251], a[236:239], v[232:235], v[248:251]
    v_exp_f32 v253, v253
    v_exp_f32 v254, v254
    v_exp_f32 v255, v255
    v_cvt_pk_bf16_f32 v58, v252, v253
    v_cvt_pk_bf16_f32 v59, v254, v255
    v_mfma_f32_16x16x32_bf16 v[252:255], a[224:227], v[140:143], v[156:159]
    ds_read_b128 a[248:251], v2 offset:14336
    ds_read_b128 a[252:255], v2 offset:15360
    v_mfma_f32_16x16x32_bf16 v[252:255], a[228:231], v[172:175], v[252:255]
    v_add_f32 v215, s23, v144
    v_fma_f32 v188, v208, s19, v215
    v_mfma_f32_16x16x32_bf16 v[252:255], a[232:235], v[204:207], v[252:255]
    v_exp_f32 v240, v240
    v_mfma_f32_16x16x32_bf16 v[252:255], a[236:239], v[236:239], v[252:255]
    s_waitcnt lgkmcnt(2)
    v_exp_f32 v241, v241
    v_exp_f32 v242, v242
    v_exp_f32 v243, v243
    v_fma_f32 v189, v209, s19, v215
    v_fma_f32 v190, v210, s19, v215
    v_fma_f32 v191, v211, s19, v215
    v_cvt_pk_bf16_f32 v36, v240, v241
    v_cvt_pk_bf16_f32 v37, v242, v243
    v_mfma_f32_16x16x32_bf16 v[240:243], a[240:243], v[128:131], v[188:191]
    v_exp_f32 v244, v244
    v_mfma_f32_16x16x32_bf16 v[240:243], a[244:247], v[160:163], v[240:243]
    s_cmp_eq_u32 s82, 163840
    s_cselect_b32 s82, 0, s82
    v_add_u32 v2, s82, v1
    s_waitcnt lgkmcnt(0)
    v_mfma_f32_16x16x32_bf16 v[240:243], a[248:251], v[192:195], v[240:243]
    v_exp_f32 v245, v245
    v_mfma_f32_16x16x32_bf16 v[240:243], a[252:255], v[224:227], v[240:243]
    s_waitcnt vmcnt(8) lgkmcnt(0)
    s_barrier
    v_cvt_pk_bf16_f32 v44, v244, v245
    v_exp_f32 v246, v246
    v_exp_f32 v247, v247
    s_nop 0
    v_cvt_pk_bf16_f32 v45, v246, v247
    v_mfma_f32_16x16x32_bf16 v[244:247], a[240:243], v[132:135], v[148:151]
    ds_read_b128 a[224:227], v2 offset:0
    ds_read_b128 a[228:231], v2 offset:1024
    v_mfma_f32_16x16x32_bf16 v[244:247], a[244:247], v[164:167], v[244:247]
    v_exp_f32 v248, v248
    v_mfma_f32_16x16x32_bf16 v[244:247], a[248:251], v[196:199], v[244:247]
    v_exp_f32 v249, v249
    v_mfma_f32_16x16x32_bf16 v[244:247], a[252:255], v[228:231], v[244:247]
    v_exp_f32 v250, v250
    v_exp_f32 v251, v251
    v_cvt_pk_bf16_f32 v52, v248, v249
    v_cvt_pk_bf16_f32 v53, v250, v251
    v_mfma_f32_16x16x32_bf16 v[248:251], a[240:243], v[136:139], v[152:155]
    ds_read_b128 a[232:235], v2 offset:2048
    ds_read_b128 a[236:239], v2 offset:3072
    v_mfma_f32_16x16x32_bf16 v[248:251], a[244:247], v[168:171], v[248:251]
    ds_read_b128 v[96:99], v2 offset:16384
    v_mfma_f32_16x16x32_bf16 v[248:251], a[248:251], v[200:203], v[248:251]
    v_exp_f32 v252, v252
    v_mfma_f32_16x16x32_bf16 v[248:251], a[252:255], v[232:235], v[248:251]
    v_exp_f32 v253, v253
    v_exp_f32 v254, v254
    v_exp_f32 v255, v255
    v_cvt_pk_bf16_f32 v60, v252, v253
    v_cvt_pk_bf16_f32 v61, v254, v255
    v_mfma_f32_16x16x32_bf16 v[252:255], a[240:243], v[140:143], v[156:159]
    ds_read_b128 v[100:103], v2 offset:17408
    v_mfma_f32_16x16x32_bf16 v[252:255], a[244:247], v[172:175], v[252:255]
    v_exp_f32 v240, v240
    v_mfma_f32_16x16x32_bf16 v[252:255], a[248:251], v[204:207], v[252:255]
    v_exp_f32 v241, v241
    v_mfma_f32_16x16x32_bf16 v[252:255], a[252:255], v[236:239], v[252:255]
    v_exp_f32 v242, v242
    v_exp_f32 v243, v243
    v_exp_f32 v244, v244
    v_exp_f32 v245, v245
    v_exp_f32 v246, v246
    v_exp_f32 v247, v247
    v_exp_f32 v248, v248
    v_exp_f32 v249, v249
    v_exp_f32 v250, v250
    v_exp_f32 v251, v251
    v_exp_f32 v252, v252
    v_exp_f32 v253, v253
    v_cvt_pk_bf16_f32 v38, v240, v241
    v_cvt_pk_bf16_f32 v39, v242, v243
    v_cvt_pk_bf16_f32 v46, v244, v245
    v_cvt_pk_bf16_f32 v47, v246, v247
    v_cvt_pk_bf16_f32 v54, v248, v249
    v_cvt_pk_bf16_f32 v55, v250, v251
    v_cvt_pk_bf16_f32 v62, v252, v253
    v_mov_b32 v9, 1
    s_mov_b32 s78, s6
    buffer_atomic_add v9, v30, s[44:47], s95 offen sc1
    s_cmp_eq_u32 s78, 0
    s_cbranch_scc1 K1_LB_END
.p2align 3
K1_LB:
    s_waitcnt lgkmcnt(0)
    v_mfma_f32_16x16x32_bf16 v[240:243], a[224:227], v[128:131], v[176:179]
    s_add_u32 m0, s76, s75
    v_exp_f32 v254, v254
    v_mfma_f32_16x16x32_bf16 v[240:243], a[228:231], v[160:163], v[240:243]
    s_mov_b32 s76, s60
    buffer_load_dwordx4 v1, s[36:39], s77 offen sc1 lds
    v_mfma_f32_16x16x32_bf16 v[240:243], a[232:235], v[192:195], v[240:243]
    s_mov_b32 s60, s82
    v_exp_f32 v255, v255
    v_mfma_f32_16x16x32_bf16 v[240:243], a[236:239], v[224:227], v[240:243]
    s_add_u32 s82, s82, 32768
    ds_read_b128 v[104:107], v2 offset:18432
    v_cvt_pk_bf16_f32 v63, v254, v255
    v_mfma_f32_16x16x32_bf16 a[0:3], v[96:99], v[32:35], a[0:3]
    ds_read_b128 v[108:111], v2 offset:19456
    ds_read_b128 a[240:243], v2 offset:4096
    v_mfma_f32_16x16x32_bf16 a[0:3], v[100:103], v[36:39], a[0:3]
    ds_read_b128 a[244:247], v2 offset:5120
    v_mfma_f32_16x16x32_bf16 a[4:7], v[96:99], v[40:43], a[4:7]
    v_exp_f32 v240, v240
    v_mfma_f32_16x16x32_bf16 a[4:7], v[100:103], v[44:47], a[4:7]
    ds_read_b128 a[248:251], v2 offset:6144
    ds_read_b128 a[252:255], v2 offset:7168
    v_mfma_f32_16x16x32_bf16 v[244:247], a[224:227], v[132:135], v[148:151]
    v_exp_f32 v241, v241
    v_mfma_f32_16x16x32_bf16 v[244:247], a[228:231], v[164:167], v[244:247]
    ds_read_b128 v[112:115], v2 offset:20480
    ds_read_b128 v[116:119], v2 offset:21504
    v_mfma_f32_16x16x32_bf16 v[244:247], a[232:235], v[196:199], v[244:247]
    v_exp_f32 v242, v242
    v_mfma_f32_16x16x32_bf16 v[244:247], a[236:239], v[228:231], v[244:247]
    v_exp_f32 v243, v243
    v_mfma_f32_16x16x32_bf16 a[8:11], v[96:99], v[48:51], a[8:11]
    v_cvt_pk_bf16_f32 v64, v240, v241
    v_cvt_pk_bf16_f32 v65, v242, v243
    v_mfma_f32_16x16x32_bf16 a[8:11], v[100:103], v[52:55], a[8:11]
    ds_read_b128 v[120:123], v2 offset:22528
    ds_read_b128 v[124:127], v2 offset:23552
    v_mfma_f32_16x16x32_bf16 a[12:15], v[96:99], v[56:59], a[12:15]
    v_exp_f32 v244, v244
    v_mfma_f32_16x16x32_bf16 a[12:15], v[100:103], v[60:63], a[12:15]
    buffer_load_dwordx4 v1, s[36:39], s77 offen offset:1024 sc1 lds
    v_mfma_f32_16x16x32_bf16 v[248:251], a[224:227], v[136:139], v[152:155]
    v_exp_f32 v245, v245
    v_mfma_f32_16x16x32_bf16 v[248:251], a[228:231], v[168:171], v[248:251]
    v_exp_f32 v246, v246
    v_mfma_f32_16x16x32_bf16 v[248:251], a[232:235], v[200:203], v[248:251]
    v_exp_f32 v247, v247
    v_mfma_f32_16x16x32_bf16 v[248:251], a[236:239], v[232:235], v[248:251]
    s_waitcnt lgkmcnt(0)
    v_cvt_pk_bf16_f32 v72, v244, v245
    v_cvt_pk_bf16_f32 v73, v246, v247
    v_mfma_f32_16x16x32_bf16 a[16:19], v[104:107], v[32:35], a[16:19]
    ds_read_b128 v[96:99], v2 offset:24576
    ds_read_b128 v[100:103], v2 offset:25600
    v_mfma_f32_16x16x32_bf16 a[16:19], v[108:111], v[36:39], a[16:19]
    v_mfma_f32_16x16x32_bf16 a[20:23], v[104:107], v[40:43], a[20:23]
    v_mfma_f32_16x16x32_bf16 a[20:23], v[108:111], v[44:47], a[20:23]
    v_exp_f32 v248, v248
    v_mfma_f32_16x16x32_bf16 v[252:255], a[224:227], v[140:143], v[156:159]
    v_exp_f32 v249, v249
    v_mfma_f32_16x16x32_bf16 v[252:255], a[228:231], v[172:175], v[252:255]
    v_exp_f32 v250, v250
    v_mfma_f32_16x16x32_bf16 v[252:255], a[232:235], v[204:207], v[252:255]
    v_exp_f32 v251, v251
    v_mfma_f32_16x16x32_bf16 v[252:255], a[236:239], v[236:239], v[252:255]
    v_cvt_pk_bf16_f32 v80, v248, v249
    v_cvt_pk_bf16_f32 v81, v250, v251
    v_mfma_f32_16x16x32_bf16 a[24:27], v[104:107], v[48:51], a[24:27]
    ds_read_b128 a[224:227], v2 offset:8192
    ds_read_b128 a[228:231], v2 offset:9216
    v_mfma_f32_16x16x32_bf16 a[24:27], v[108:111], v[52:55], a[24:27]
    buffer_load_dwordx4 v1, s[36:39], s77 offen offset:2048 sc1 lds
    v_mfma_f32_16x16x32_bf16 a[28:31], v[104:107], v[56:59], a[28:31]
    v_exp_f32 v252, v252
    v_mfma_f32_16x16x32_bf16 a[28:31], v[108:111], v[60:63], a[28:31]
    v_exp_f32 v253, v253
    v_mfma_f32_16x16x32_bf16 v[240:243], a[240:243], v[128:131], v[180:183]
    v_exp_f32 v254, v254
    v_mfma_f32_16x16x32_bf16 v[240:243], a[244:247], v[160:163], v[240:243]
    v_exp_f32 v255, v255
    v_mfma_f32_16x16x32_bf16 v[240:243], a[248:251], v[192:195], v[240:243]
    v_cvt_pk_bf16_f32 v88, v252, v253
    v_cvt_pk_bf16_f32 v89, v254, v255
    v_mfma_f32_16x16x32_bf16 v[240:243], a[252:255], v[224:227], v[240:243]
    ds_read_b128 a[232:235], v2 offset:10240
    ds_read_b128 a[236:239], v2 offset:11264
    v_mfma_f32_16x16x32_bf16 a[32:35], v[112:115], v[32:35], a[32:35]
    ds_read_b128 v[104:107], v2 offset:26624
    v_mfma_f32_16x16x32_bf16 a[32:35], v[116:119], v[36:39], a[32:35]
    ds_read_b128 v[108:111], v2 offset:27648
    v_mfma_f32_16x16x32_bf16 a[36:39], v[112:115], v[40:43], a[36:39]
    v_mfma_f32_16x16x32_bf16 a[36:39], v[116:119], v[44:47], a[36:39]
    v_exp_f32 v240, v240
    v_mfma_f32_16x16x32_bf16 v[244:247], a[240:243], v[132:135], v[148:151]
    v_exp_f32 v241, v241
    v_mfma_f32_16x16x32_bf16 v[244:247], a[244:247], v[164:167], v[244:247]
    v_exp_f32 v242, v242
    v_mfma_f32_16x16x32_bf16 v[244:247], a[248:251], v[196:199], v[244:247]
    v_exp_f32 v243, v243
    v_mfma_f32_16x16x32_bf16 v[244:247], a[252:255], v[228:231], v[244:247]
    buffer_load_dwordx4 v1, s[36:39], s77 offen offset:3072 sc1 lds
    v_mfma_f32_16x16x32_bf16 a[40:43], v[112:115], v[48:51], a[40:43]
    v_cvt_pk_bf16_f32 v66, v240, v241
    v_cvt_pk_bf16_f32 v67, v242, v243
    v_mfma_f32_16x16x32_bf16 a[40:43], v[116:119], v[52:55], a[40:43]
    v_mfma_f32_16x16x32_bf16 a[44:47], v[112:115], v[56:59], a[44:47]
    ds_read_b128 v[112:115], v2 offset:28672
    v_mfma_f32_16x16x32_bf16 a[44:47], v[116:119], v[60:63], a[44:47]
    v_exp_f32 v244, v244
    v_mfma_f32_16x16x32_bf16 v[248:251], a[240:243], v[136:139], v[152:155]
    v_exp_f32 v245, v245
    v_mfma_f32_16x16x32_bf16 v[248:251], a[244:247], v[168:171], v[248:251]
    v_exp_f32 v246, v246
    v_mfma_f32_16x16x32_bf16 v[248:251], a[248:251], v[200:203], v[248:251]
    v_exp_f32 v247, v247
    v_mfma_f32_16x16x32_bf16 v[248:251], a[252:255], v[232:235], v[248:251]
    v_cvt_pk_bf16_f32 v74, v244, v245
    v_cvt_pk_bf16_f32 v75, v246, v247
    v_mfma_f32_16x16x32_bf16 a[48:51], v[120:123], v[32:35], a[48:51]
    ds_read_b128 v[116:119], v2 offset:29696
    v_mfma_f32_16x16x32_bf16 a[48:51], v[124:127], v[36:39], a[48:51]
    v_mfma_f32_16x16x32_bf16 a[52:55], v[120:123], v[40:43], a[52:55]
    v_mfma_f32_16x16x32_bf16 a[52:55], v[124:127], v[44:47], a[52:55]
    v_mfma_f32_16x16x32_bf16 v[252:255], a[240:243], v[140:143], v[156:159]
    v_exp_f32 v248, v248
    v_mfma_f32_16x16x32_bf16 v[252:255], a[244:247], v[172:175], v[252:255]
    s_add_u32 s100, s77, 4096
    v_exp_f32 v249, v249
    v_mfma_f32_16x16x32_bf16 v[252:255], a[248:251], v[204:207], v[252:255]
    s_add_u32 m0, m0, 4096
    v_exp_f32 v250, v250
    v_mfma_f32_16x16x32_bf16 v[252:255], a[252:255], v[236:239], v[252:255]
    buffer_load_dwordx4 v1, s[36:39], s100 offen sc1 lds
    v_mfma_f32_16x16x32_bf16 a[56:59], v[120:123], v[48:51], a[56:59]
    v_exp_f32 v251, v251
    v_mfma_f32_16x16x32_bf16 a[56:59], v[124:127], v[52:55], a[56:59]
    v_cvt_pk_bf16_f32 v82, v248, v249
    v_cvt_pk_bf16_f32 v83, v250, v251
    v_mfma_f32_16x16x32_bf16 a[60:63], v[120:123], v[56:59], a[60:63]
    ds_read_b128 a[240:243], v2 offset:12288
    ds_read_b128 a[244:247], v2 offset:13312
    v_mfma_f32_16x16x32_bf16 a[60:63], v[124:127], v[60:63], a[60:63]
    s_waitcnt lgkmcnt(2)
    v_exp_f32 v252, v252
    v_mfma_f32_16x16x32_bf16 v[240:243], a[224:227], v[128:131], v[184:187]
    v_exp_f32 v253, v253
    v_mfma_f32_16x16x32_bf16 v[240:243], a[228:231], v[160:163], v[240:243]
    v_exp_f32 v254, v254
    v_mfma_f32_16x16x32_bf16 v[240:243], a[232:235], v[192:195], v[240:243]
    v_exp_f32 v255, v255
    v_mfma_f32_16x16x32_bf16 v[240:243], a[236:239], v[224:227], v[240:243]
    v_cvt_pk_bf16_f32 v90, v252, v253
    v_cvt_pk_bf16_f32 v91, v254, v255
    v_mfma_f32_16x16x32_bf16 a[144:147], v[96:99], v[32:35], a[144:147]
    ds_read_b128 a[248:251], v2 offset:14336
    ds_read_b128 a[252:255], v2 offset:15360
    v_mfma_f32_16x16x32_bf16 a[144:147], v[100:103], v[36:39], a[144:147]
    ds_read_b128 v[120:123], v2 offset:30720
    v_mfma_f32_16x16x32_bf16 a[148:151], v[96:99], v[40:43], a[148:151]
    v_exp_f32 v240, v240
    v_mfma_f32_16x16x32_bf16 a[148:151], v[100:103], v[44:47], a[148:151]
    v_exp_f32 v241, v241
    v_mfma_f32_16x16x32_bf16 v[244:247], a[224:227], v[132:135], v[148:151]
    buffer_load_dwordx4 v1, s[36:39], s100 offen offset:1024 sc1 lds
    v_mfma_f32_16x16x32_bf16 v[244:247], a[228:231], v[164:167], v[244:247]
    v_exp_f32 v242, v242
    v_mfma_f32_16x16x32_bf16 v[244:247], a[232:235], v[196:199], v[244:247]
    v_exp_f32 v243, v243
    v_mfma_f32_16x16x32_bf16 v[244:247], a[236:239], v[228:231], v[244:247]
    v_cvt_pk_bf16_f32 v68, v240, v241
    v_cvt_pk_bf16_f32 v69, v242, v243
    v_mfma_f32_16x16x32_bf16 a[152:155], v[96:99], v[48:51], a[152:155]
    ds_read_b128 v[124:127], v2 offset:31744
    v_mfma_f32_16x16x32_bf16 a[152:155], v[100:103], v[52:55], a[152:155]
    v_mfma_f32_16x16x32_bf16 a[156:159], v[96:99], v[56:59], a[156:159]
    v_mfma_f32_16x16x32_bf16 a[156:159], v[100:103], v[60:63], a[156:159]
    v_mfma_f32_16x16x32_bf16 v[248:251], a[224:227], v[136:139], v[152:155]
    v_exp_f32 v244, v244
    v_mfma_f32_16x16x32_bf16 v[248:251], a[228:231], v[168:171], v[248:251]
    v_exp_f32 v245, v245
    v_mfma_f32_16x16x32_bf16 v[248:251], a[232:235], v[200:203], v[248:251]
    v_exp_f32 v246, v246
    v_mfma_f32_16x16x32_bf16 v[248:251], a[236:239], v[232:235], v[248:251]
    v_exp_f32 v247, v247
    v_mfma_f32_16x16x32_bf16 a[160:163], v[104:107], v[32:35], a[160:163]
    v_cvt_pk_bf16_f32 v76, v244, v245
    v_cvt_pk_bf16_f32 v77, v246, v247
    v_mfma_f32_16x16x32_bf16 a[160:163], v[108:111], v[36:39], a[160:163]
    v_mfma_f32_16x16x32_bf16 a[164:167], v[104:107], v[40:43], a[164:167]
    buffer_load_dwordx4 v1, s[36:39], s100 offen offset:2048 sc1 lds
    v_mfma_f32_16x16x32_bf16 a[164:167], v[108:111], v[44:47], a[164:167]
    v_exp_f32 v248, v248
    v_mfma_f32_16x16x32_bf16 v[252:255], a[224:227], v[140:143], v[156:159]
    v_exp_f32 v249, v249
    v_mfma_f32_16x16x32_bf16 v[252:255], a[228:231], v[172:175], v[252:255]
    v_exp_f32 v250, v250
    v_mfma_f32_16x16x32_bf16 v[252:255], a[232:235], v[204:207], v[252:255]
    v_exp_f32 v251, v251
    v_mfma_f32_16x16x32_bf16 v[252:255], a[236:239], v[236:239], v[252:255]
    v_cvt_pk_bf16_f32 v84, v248, v249
    v_cvt_pk_bf16_f32 v85, v250, v251
    v_mfma_f32_16x16x32_bf16 a[168:171], v[104:107], v[48:51], a[168:171]
    v_mfma_f32_16x16x32_bf16 a[168:171], v[108:111], v[52:55], a[168:171]
    v_mfma_f32_16x16x32_bf16 a[172:175], v[104:107], v[56:59], a[172:175]
    v_mfma_f32_16x16x32_bf16 a[172:175], v[108:111], v[60:63], a[172:175]
    s_waitcnt lgkmcnt(0)
    v_mfma_f32_16x16x32_bf16 v[240:243], a[240:243], v[128:131], v[188:191]
    v_mfma_f32_16x16x32_bf16 v[240:243], a[244:247], v[160:163], v[240:243]
    v_exp_f32 v252, v252
    v_mfma_f32_16x16x32_bf16 v[240:243], a[248:251], v[192:195], v[240:243]
    v_exp_f32 v253, v253
    v_mfma_f32_16x16x32_bf16 v[240:243], a[252:255], v[224:227], v[240:243]
    v_exp_f32 v254, v254
    v_mfma_f32_16x16x32_bf16 a[176:179], v[112:115], v[32:35], a[176:179]
    buffer_load_dwordx4 v1, s[36:39], s100 offen offset:3072 sc1 lds
    v_mfma_f32_16x16x32_bf16 a[176:179], v[116:119], v[36:39], a[176:179]
    v_exp_f32 v255, v255
    v_mfma_f32_16x16x32_bf16 a[180:183], v[112:115], v[40:43], a[180:183]
    v_cvt_pk_bf16_f32 v92, v252, v253
    v_cvt_pk_bf16_f32 v93, v254, v255
    v_mfma_f32_16x16x32_bf16 a[180:183], v[116:119], v[44:47], a[180:183]
    s_cmp_eq_u32 s82, 163840
    s_cselect_b32 s82, 0, s82
    v_add_u32 v2, s82, v1
    v_mfma_f32_16x16x32_bf16 v[244:247], a[240:243], v[132:135], v[148:151]
    ds_read_b128 a[224:227], v2 offset:0
    ds_read_b128 a[228:231], v2 offset:1024
    v_mfma_f32_16x16x32_bf16 v[244:247], a[244:247], v[164:167], v[244:247]
    v_exp_f32 v240, v240
    v_mfma_f32_16x16x32_bf16 v[244:247], a[248:251], v[196:199], v[244:247]
    ds_read_b128 a[232:235], v2 offset:2048
    ds_read_b128 a[236:239], v2 offset:3072
    v_mfma_f32_16x16x32_bf16 v[244:247], a[252:255], v[228:231], v[244:247]
    v_exp_f32 v241, v241
    v_mfma_f32_16x16x32_bf16 a[184:187], v[112:115], v[48:51], a[184:187]
    ds_read_b128 v[96:99], v2 offset:16384
    ds_read_b128 v[100:103], v2 offset:17408
    v_mfma_f32_16x16x32_bf16 a[184:187], v[116:119], v[52:55], a[184:187]
    v_exp_f32 v242, v242
    v_mfma_f32_16x16x32_bf16 a[188:191], v[112:115], v[56:59], a[188:191]
    v_exp_f32 v243, v243
    v_mfma_f32_16x16x32_bf16 a[188:191], v[116:119], v[60:63], a[188:191]
    v_exp_f32 v244, v244
    v_mfma_f32_16x16x32_bf16 v[248:251], a[240:243], v[136:139], v[152:155]
    v_exp_f32 v245, v245
    v_mfma_f32_16x16x32_bf16 v[248:251], a[244:247], v[168:171], v[248:251]
    v_exp_f32 v246, v246
    v_mfma_f32_16x16x32_bf16 v[248:251], a[248:251], v[200:203], v[248:251]
    s_add_u32 s77, s77, 32768
    v_exp_f32 v247, v247
    v_mfma_f32_16x16x32_bf16 v[248:251], a[252:255], v[232:235], v[248:251]
    v_cvt_pk_bf16_f32 v70, v240, v241
    v_cvt_pk_bf16_f32 v71, v242, v243
    v_mfma_f32_16x16x32_bf16 a[192:195], v[120:123], v[32:35], a[192:195]
    v_cvt_pk_bf16_f32 v78, v244, v245
    v_cvt_pk_bf16_f32 v79, v246, v247
    v_mfma_f32_16x16x32_bf16 a[192:195], v[124:127], v[36:39], a[192:195]
    v_mfma_f32_16x16x32_bf16 a[196:199], v[120:123], v[40:43], a[196:199]
    v_mfma_f32_16x16x32_bf16 a[196:199], v[124:127], v[44:47], a[196:199]
    v_exp_f32 v248, v248
    v_mfma_f32_16x16x32_bf16 v[252:255], a[240:243], v[140:143], v[156:159]
    v_exp_f32 v249, v249
    v_mfma_f32_16x16x32_bf16 v[252:255], a[244:247], v[172:175], v[252:255]
    v_exp_f32 v250, v250
    v_mfma_f32_16x16x32_bf16 v[252:255], a[248:251], v[204:207], v[252:255]
    v_exp_f32 v251, v251
    v_mfma_f32_16x16x32_bf16 v[252:255], a[252:255], v[236:239], v[252:255]
    v_cvt_pk_bf16_f32 v86, v248, v249
    v_cvt_pk_bf16_f32 v87, v250, v251
    v_mfma_f32_16x16x32_bf16 a[200:203], v[120:123], v[48:51], a[200:203]
    v_mfma_f32_16x16x32_bf16 a[200:203], v[124:127], v[52:55], a[200:203]
    v_mfma_f32_16x16x32_bf16 a[204:207], v[120:123], v[56:59], a[204:207]
    v_mfma_f32_16x16x32_bf16 a[204:207], v[124:127], v[60:63], a[204:207]
    v_mfma_f32_16x16x32_bf16 a[208:211], a[136:139], v[32:35], a[208:211]
    v_mfma_f32_16x16x32_bf16 a[208:211], a[136:139], v[36:39], a[208:211]
    v_exp_f32 v252, v252
    v_mfma_f32_16x16x32_bf16 a[212:215], a[136:139], v[40:43], a[212:215]
    v_exp_f32 v253, v253
    v_mfma_f32_16x16x32_bf16 a[212:215], a[136:139], v[44:47], a[212:215]
    v_cvt_pk_bf16_f32 v94, v252, v253
    v_mfma_f32_16x16x32_bf16 a[216:219], a[136:139], v[48:51], a[216:219]
    v_mfma_f32_16x16x32_bf16 a[216:219], a[136:139], v[52:55], a[216:219]
    v_mfma_f32_16x16x32_bf16 a[220:223], a[136:139], v[56:59], a[220:223]
    v_mfma_f32_16x16x32_bf16 a[220:223], a[136:139], v[60:63], a[220:223]
    s_cmp_eq_u32 s78, 1
    s_cbranch_scc1 K1_LB_MASK
K1_LB_BACK:
    s_waitcnt lgkmcnt(0)
    v_mfma_f32_16x16x32_bf16 v[240:243], a[224:227], v[128:131], v[176:179]
    s_add_u32 m0, s76, s75
    v_exp_f32 v254, v254
    v_mfma_f32_16x16x32_bf16 v[240:243], a[228:231], v[160:163], v[240:243]
    s_mov_b32 s76, s60
    buffer_load_dwordx4 v1, s[36:39], s77 offen sc1 lds
    v_mfma_f32_16x16x32_bf16 v[240:243], a[232:235], v[192:195], v[240:243]
    s_mov_b32 s60, s82
    v_exp_f32 v255, v255
    v_mfma_f32_16x16x32_bf16 v[240:243], a[236:239], v[224:227], v[240:243]
    s_add_u32 s82, s82, 32768
    ds_read_b128 v[104:107], v2 offset:18432
    v_cvt_pk_bf16_f32 v95, v254, v255
    v_mfma_f32_16x16x32_bf16 a[0:3], v[96:99], v[64:67], a[0:3]
    ds_read_b128 v[108:111], v2 offset:19456
    ds_read_b128 a[240:243], v2 offset:4096
    v_mfma_f32_16x16x32_bf16 a[0:3], v[100:103], v[68:71], a[0:3]
    ds_read_b128 a[244:247], v2 offset:5120
    v_mfma_f32_16x16x32_bf16 a[4:7], v[96:99], v[72:75], a[4:7]
    v_exp_f32 v240, v240
    v_mfma_f32_16x16x32_bf16 a[4:7], v[100:103], v[76:79], a[4:7]
    ds_read_b128 a[248:251], v2 offset:6144
    ds_read_b128 a[252:255], v2 offset:7168
    v_mfma_f32_16x16x32_bf16 v[244:247], a[224:227], v[132:135], v[148:151]
    v_exp_f32 v241, v241
    v_mfma_f32_16x16x32_bf16 v[244:247], a[228:231], v[164:167], v[244:247]
    ds_read_b128 v[112:115], v2 offset:20480
    ds_read_b128 v[116:119], v2 offset:21504
    v_mfma_f32_16x16x32_bf16 v[244:247], a[232:235], v[196:199], v[244:247]
    v_exp_f32 v242, v242
    v_mfma_f32_16x16x32_bf16 v[244:247], a[236:239], v[228:231], v[244:247]
    v_exp_f32 v243, v243
    v_mfma_f32_16x16x32_bf16 a[8:11], v[96:99], v[80:83], a[8:11]
    v_cvt_pk_bf16_f32 v32, v240, v241
    v_cvt_pk_bf16_f32 v33, v242, v243
    v_mfma_f32_16x16x32_bf16 a[8:11], v[100:103], v[84:87], a[8:11]
    ds_read_b128 v[120:123], v2 offset:22528
    ds_read_b128 v[124:127], v2 offset:23552
    v_mfma_f32_16x16x32_bf16 a[12:15], v[96:99], v[88:91], a[12:15]
    v_exp_f32 v244, v244
    v_mfma_f32_16x16x32_bf16 a[12:15], v[100:103], v[92:95], a[12:15]
    buffer_load_dwordx4 v1, s[36:39], s77 offen offset:1024 sc1 lds
    v_mfma_f32_16x16x32_bf16 v[248:251], a[224:227], v[136:139], v[152:155]
    v_exp_f32 v245, v245
    v_mfma_f32_16x16x32_bf16 v[248:251], a[228:231], v[168:171], v[248:251]
    v_exp_f32 v246, v246
    v_mfma_f32_16x16x32_bf16 v[248:251], a[232:235], v[200:203], v[248:251]
    v_exp_f32 v247, v247
    v_mfma_f32_16x16x32_bf16 v[248:251], a[236:239], v[232:235], v[248:251]
    s_waitcnt lgkmcnt(0)
    v_cvt_pk_bf16_f32 v40, v244, v245
    v_cvt_pk_bf16_f32 v41, v246, v247
    v_mfma_f32_16x16x32_bf16 a[16:19], v[104:107], v[64:67], a[16:19]
    ds_read_b128 v[96:99], v2 offset:24576
    ds_read_b128 v[100:103], v2 offset:25600
    v_mfma_f32_16x16x32_bf16 a[16:19], v[108:111], v[68:71], a[16:19]
    v_mfma_f32_16x16x32_bf16 a[20:23], v[104:107], v[72:75], a[20:23]
    v_mfma_f32_16x16x32_bf16 a[20:23], v[108:111], v[76:79], a[20:23]
    v_exp_f32 v248, v248
    v_mfma_f32_16x16x32_bf16 v[252:255], a[224:227], v[140:143], v[156:159]
    v_exp_f32 v249, v249
    v_mfma_f32_16x16x32_bf16 v[252:255], a[228:231], v[172:175], v[252:255]
    v_exp_f32 v250, v250
    v_mfma_f32_16x16x32_bf16 v[252:255], a[232:235], v[204:207], v[252:255]
    v_exp_f32 v251, v251
    v_mfma_f32_16x16x32_bf16 v[252:255], a[236:239], v[236:239], v[252:255]
    v_cvt_pk_bf16_f32 v48, v248, v249
    v_cvt_pk_bf16_f32 v49, v250, v251
    v_mfma_f32_16x16x32_bf16 a[24:27], v[104:107], v[80:83], a[24:27]
    ds_read_b128 a[224:227], v2 offset:8192
    ds_read_b128 a[228:231], v2 offset:9216
    v_mfma_f32_16x16x32_bf16 a[24:27], v[108:111], v[84:87], a[24:27]
    buffer_load_dwordx4 v1, s[36:39], s77 offen offset:2048 sc1 lds
    v_mfma_f32_16x16x32_bf16 a[28:31], v[104:107], v[88:91], a[28:31]
    v_exp_f32 v252, v252
    v_mfma_f32_16x16x32_bf16 a[28:31], v[108:111], v[92:95], a[28:31]
    v_exp_f32 v253, v253
    v_mfma_f32_16x16x32_bf16 v[240:243], a[240:243], v[128:131], v[180:183]
    v_exp_f32 v254, v254
    v_mfma_f32_16x16x32_bf16 v[240:243], a[244:247], v[160:163], v[240:243]
    v_exp_f32 v255, v255
    v_mfma_f32_16x16x32_bf16 v[240:243], a[248:251], v[192:195], v[240:243]
    v_cvt_pk_bf16_f32 v56, v252, v253
    v_cvt_pk_bf16_f32 v57, v254, v255
    v_mfma_f32_16x16x32_bf16 v[240:243], a[252:255], v[224:227], v[240:243]
    ds_read_b128 a[232:235], v2 offset:10240
    ds_read_b128 a[236:239], v2 offset:11264
    v_mfma_f32_16x16x32_bf16 a[32:35], v[112:115], v[64:67], a[32:35]
    ds_read_b128 v[104:107], v2 offset:26624
    v_mfma_f32_16x16x32_bf16 a[32:35], v[116:119], v[68:71], a[32:35]
    ds_read_b128 v[108:111], v2 offset:27648
    v_mfma_f32_16x16x32_bf16 a[36:39], v[112:115], v[72:75], a[36:39]
    v_mfma_f32_16x16x32_bf16 a[36:39], v[116:119], v[76:79], a[36:39]
    v_exp_f32 v240, v240
    v_mfma_f32_16x16x32_bf16 v[244:247], a[240:243], v[132:135], v[148:151]
    v_exp_f32 v241, v241
    v_mfma_f32_16x16x32_bf16 v[244:247], a[244:247], v[164:167], v[244:247]
    v_exp_f32 v242, v242
    v_mfma_f32_16x16x32_bf16 v[244:247], a[248:251], v[196:199], v[244:247]
    v_exp_f32 v243, v243
    v_mfma_f32_16x16x32_bf16 v[244:247], a[252:255], v[228:231], v[244:247]
    buffer_load_dwordx4 v1, s[36:39], s77 offen offset:3072 sc1 lds
    v_mfma_f32_16x16x32_bf16 a[40:43], v[112:115], v[80:83], a[40:43]
    v_cvt_pk_bf16_f32 v34, v240, v241
    v_cvt_pk_bf16_f32 v35, v242, v243
    v_mfma_f32_16x16x32_bf16 a[40:43], v[116:119], v[84:87], a[40:43]
    v_mfma_f32_16x16x32_bf16 a[44:47], v[112:115], v[88:91], a[44:47]
    ds_read_b128 v[112:115], v2 offset:28672
    v_mfma_f32_16x16x32_bf16 a[44:47], v[116:119], v[92:95], a[44:47]
    v_exp_f32 v244, v244
    v_mfma_f32_16x16x32_bf16 v[248:251], a[240:243], v[136:139], v[152:155]
    v_exp_f32 v245, v245
    v_mfma_f32_16x16x32_bf16 v[248:251], a[244:247], v[168:171], v[248:251]
    v_exp_f32 v246, v246
    v_mfma_f32_16x16x32_bf16 v[248:251], a[248:251], v[200:203], v[248:251]
    v_exp_f32 v247, v247
    v_mfma_f32_16x16x32_bf16 v[248:251], a[252:255], v[232:235], v[248:251]
    v_cvt_pk_bf16_f32 v42, v244, v245
    v_cvt_pk_bf16_f32 v43, v246, v247
    v_mfma_f32_16x16x32_bf16 a[48:51], v[120:123], v[64:67], a[48:51]
    ds_read_b128 v[116:119], v2 offset:29696
    v_mfma_f32_16x16x32_bf16 a[48:51], v[124:127], v[68:71], a[48:51]
    v_mfma_f32_16x16x32_bf16 a[52:55], v[120:123], v[72:75], a[52:55]
    v_mfma_f32_16x16x32_bf16 a[52:55], v[124:127], v[76:79], a[52:55]
    v_mfma_f32_16x16x32_bf16 v[252:255], a[240:243], v[140:143], v[156:159]
    v_exp_f32 v248, v248
    v_mfma_f32_16x16x32_bf16 v[252:255], a[244:247], v[172:175], v[252:255]
    s_add_u32 s100, s77, 4096
    v_exp_f32 v249, v249
    v_mfma_f32_16x16x32_bf16 v[252:255], a[248:251], v[204:207], v[252:255]
    s_add_u32 m0, m0, 4096
    v_exp_f32 v250, v250
    v_mfma_f32_16x16x32_bf16 v[252:255], a[252:255], v[236:239], v[252:255]
    buffer_load_dwordx4 v1, s[36:39], s100 offen sc1 lds
    v_mfma_f32_16x16x32_bf16 a[56:59], v[120:123], v[80:83], a[56:59]
    v_exp_f32 v251, v251
    v_mfma_f32_16x16x32_bf16 a[56:59], v[124:127], v[84:87], a[56:59]
    v_cvt_pk_bf16_f32 v50, v248, v249
    v_cvt_pk_bf16_f32 v51, v250, v251
    v_mfma_f32_16x16x32_bf16 a[60:63], v[120:123], v[88:91], a[60:63]
    ds_read_b128 a[240:243], v2 offset:12288
    ds_read_b128 a[244:247], v2 offset:13312
    v_mfma_f32_16x16x32_bf16 a[60:63], v[124:127], v[92:95], a[60:63]
    s_waitcnt lgkmcnt(2)
    v_exp_f32 v252, v252
    v_mfma_f32_16x16x32_bf16 v[240:243], a[224:227], v[128:131], v[184:187]
    v_exp_f32 v253, v253
    v_mfma_f32_16x16x32_bf16 v[240:243], a[228:231], v[160:163], v[240:243]
    v_exp_f32 v254, v254
    v_mfma_f32_16x16x32_bf16 v[240:243], a[232:235], v[192:195], v[240:243]
    v_exp_f32 v255, v255
    v_mfma_f32_16x16x32_bf16 v[240:243], a[236:239], v[224:227], v[240:243]
    v_cvt_pk_bf16_f32 v58, v252, v253
    v_cvt_pk_bf16_f32 v59, v254, v255
    v_mfma_f32_16x16x32_bf16 a[144:147], v[96:99], v[64:67], a[144:147]
    ds_read_b128 a[248:251], v2 offset:14336
    ds_read_b128 a[252:255], v2 offset:15360
    v_mfma_f32_16x16x32_bf16 a[144:147], v[100:103], v[68:71], a[144:147]
    ds_read_b128 v[120:123], v2 offset:30720
    v_mfma_f32_16x16x32_bf16 a[148:151], v[96:99], v[72:75], a[148:151]
    v_exp_f32 v240, v240
    v_mfma_f32_16x16x32_bf16 a[148:151], v[100:103], v[76:79], a[148:151]
    v_exp_f32 v241, v241
    v_mfma_f32_16x16x32_bf16 v[244:247], a[224:227], v[132:135], v[148:151]
    buffer_load_dwordx4 v1, s[36:39], s100 offen offset:1024 sc1 lds
    v_mfma_f32_16x16x32_bf16 v[244:247], a[228:231], v[164:167], v[244:247]
    v_exp_f32 v242, v242
    v_mfma_f32_16x16x32_bf16 v[244:247], a[232:235], v[196:199], v[244:247]
    v_exp_f32 v243, v243
    v_mfma_f32_16x16x32_bf16 v[244:247], a[236:239], v[228:231], v[244:247]
    v_cvt_pk_bf16_f32 v36, v240, v241
    v_cvt_pk_bf16_f32 v37, v242, v243
    v_mfma_f32_16x16x32_bf16 a[152:155], v[96:99], v[80:83], a[152:155]
    ds_read_b128 v[124:127], v2 offset:31744
    v_mfma_f32_16x16x32_bf16 a[152:155], v[100:103], v[84:87], a[152:155]
    v_mfma_f32_16x16x32_bf16 a[156:159], v[96:99], v[88:91], a[156:159]
    v_mfma_f32_16x16x32_bf16 a[156:159], v[100:103], v[92:95], a[156:159]
    v_mfma_f32_16x16x32_bf16 v[248:251], a[224:227], v[136:139], v[152:155]
    v_exp_f32 v244, v244
    v_mfma_f32_16x16x32_bf16 v[248:251], a[228:231], v[168:171], v[248:251]
    v_exp_f32 v245, v245
    v_mfma_f32_16x16x32_bf16 v[248:251], a[232:235], v[200:203], v[248:251]
    v_exp_f32 v246, v246
    v_mfma_f32_16x16x32_bf16 v[248:251], a[236:239], v[232:235], v[248:251]
    v_exp_f32 v247, v247
    v_mfma_f32_16x16x32_bf16 a[160:163], v[104:107], v[64:67], a[160:163]
    v_cvt_pk_bf16_f32 v44, v244, v245
    v_cvt_pk_bf16_f32 v45, v246, v247
    v_mfma_f32_16x16x32_bf16 a[160:163], v[108:111], v[68:71], a[160:163]
    v_mfma_f32_16x16x32_bf16 a[164:167], v[104:107], v[72:75], a[164:167]
    buffer_load_dwordx4 v1, s[36:39], s100 offen offset:2048 sc1 lds
    v_mfma_f32_16x16x32_bf16 a[164:167], v[108:111], v[76:79], a[164:167]
    v_exp_f32 v248, v248
    v_mfma_f32_16x16x32_bf16 v[252:255], a[224:227], v[140:143], v[156:159]
    v_exp_f32 v249, v249
    v_mfma_f32_16x16x32_bf16 v[252:255], a[228:231], v[172:175], v[252:255]
    v_exp_f32 v250, v250
    v_mfma_f32_16x16x32_bf16 v[252:255], a[232:235], v[204:207], v[252:255]
    v_exp_f32 v251, v251
    v_mfma_f32_16x16x32_bf16 v[252:255], a[236:239], v[236:239], v[252:255]
    v_cvt_pk_bf16_f32 v52, v248, v249
    v_cvt_pk_bf16_f32 v53, v250, v251
    v_mfma_f32_16x16x32_bf16 a[168:171], v[104:107], v[80:83], a[168:171]
    v_mfma_f32_16x16x32_bf16 a[168:171], v[108:111], v[84:87], a[168:171]
    v_mfma_f32_16x16x32_bf16 a[172:175], v[104:107], v[88:91], a[172:175]
    v_mfma_f32_16x16x32_bf16 a[172:175], v[108:111], v[92:95], a[172:175]
    s_waitcnt lgkmcnt(0)
    v_mfma_f32_16x16x32_bf16 v[240:243], a[240:243], v[128:131], v[188:191]
    v_mfma_f32_16x16x32_bf16 v[240:243], a[244:247], v[160:163], v[240:243]
    v_exp_f32 v252, v252
    v_mfma_f32_16x16x32_bf16 v[240:243], a[248:251], v[192:195], v[240:243]
    v_exp_f32 v253, v253
    v_mfma_f32_16x16x32_bf16 v[240:243], a[252:255], v[224:227], v[240:243]
    v_exp_f32 v254, v254
    v_mfma_f32_16x16x32_bf16 a[176:179], v[112:115], v[64:67], a[176:179]
    buffer_load_dwordx4 v1, s[36:39], s100 offen offset:3072 sc1 lds
    v_mfma_f32_16x16x32_bf16 a[176:179], v[116:119], v[68:71], a[176:179]
    v_exp_f32 v255, v255
    v_mfma_f32_16x16x32_bf16 a[180:183], v[112:115], v[72:75], a[180:183]
    v_cvt_pk_bf16_f32 v60, v252, v253
    v_cvt_pk_bf16_f32 v61, v254, v255
    v_mfma_f32_16x16x32_bf16 a[180:183], v[116:119], v[76:79], a[180:183]
    s_cmp_eq_u32 s82, 163840
    s_cselect_b32 s82, 0, s82
    v_add_u32 v2, s82, v1
    v_mfma_f32_16x16x32_bf16 v[244:247], a[240:243], v[132:135], v[148:151]
    v_exp_f32 v240, v240
    v_mfma_f32_16x16x32_bf16 v[244:247], a[244:247], v[164:167], v[244:247]
    v_exp_f32 v241, v241
    v_mfma_f32_16x16x32_bf16 v[244:247], a[248:251], v[196:199], v[244:247]
    v_exp_f32 v242, v242
    v_mfma_f32_16x16x32_bf16 v[244:247], a[252:255], v[228:231], v[244:247]
    v_exp_f32 v243, v243
    v_mfma_f32_16x16x32_bf16 a[184:187], v[112:115], v[80:83], a[184:187]
    v_cvt_pk_bf16_f32 v38, v240, v241
    v_cvt_pk_bf16_f32 v39, v242, v243
    v_mfma_f32_16x16x32_bf16 a[184:187], v[116:119], v[84:87], a[184:187]
    v_mfma_f32_16x16x32_bf16 a[188:191], v[112:115], v[88:91], a[188:191]
    v_mfma_f32_16x16x32_bf16 a[188:191], v[116:119], v[92:95], a[188:191]
    v_mfma_f32_16x16x32_bf16 v[248:251], a[240:243], v[136:139], v[152:155]
    v_exp_f32 v244, v244
    v_mfma_f32_16x16x32_bf16 v[248:251], a[244:247], v[168:171], v[248:251]
    v_exp_f32 v245, v245
    v_mfma_f32_16x16x32_bf16 v[248:251], a[248:251], v[200:203], v[248:251]
    s_add_u32 s77, s77, 32768
    v_exp_f32 v246, v246
    v_mfma_f32_16x16x32_bf16 v[248:251], a[252:255], v[232:235], v[248:251]
    v_exp_f32 v247, v247
    v_mfma_f32_16x16x32_bf16 a[192:195], v[120:123], v[64:67], a[192:195]
    v_cvt_pk_bf16_f32 v46, v244, v245
    v_cvt_pk_bf16_f32 v47, v246, v247
    v_mfma_f32_16x16x32_bf16 a[192:195], v[124:127], v[68:71], a[192:195]
    v_mfma_f32_16x16x32_bf16 a[196:199], v[120:123], v[72:75], a[196:199]
    v_mfma_f32_16x16x32_bf16 a[196:199], v[124:127], v[76:79], a[196:199]
    v_mfma_f32_16x16x32_bf16 v[252:255], a[240:243], v[140:143], v[156:159]
    v_exp_f32 v248, v248
    v_mfma_f32_16x16x32_bf16 v[252:255], a[244:247], v[172:175], v[252:255]
    v_exp_f32 v249, v249
    v_mfma_f32_16x16x32_bf16 v[252:255], a[248:251], v[204:207], v[252:255]
    v_exp_f32 v250, v250
    v_mfma_f32_16x16x32_bf16 v[252:255], a[252:255], v[236:239], v[252:255]
    s_waitcnt vmcnt(8) lgkmcnt(0)
    s_barrier
    ds_read_b128 a[224:227], v2 offset:0
    v_mfma_f32_16x16x32_bf16 a[200:203], v[120:123], v[80:83], a[200:203]
    ds_read_b128 a[228:231], v2 offset:1024
    ds_read_b128 a[232:235], v2 offset:2048
    v_mfma_f32_16x16x32_bf16 a[200:203], v[124:127], v[84:87], a[200:203]
    ds_read_b128 a[236:239], v2 offset:3072
    v_cvt_pk_bf16_f32 v54, v248, v249
    v_mfma_f32_16x16x32_bf16 a[204:207], v[120:123], v[88:91], a[204:207]
    v_exp_f32 v251, v251
    v_mfma_f32_16x16x32_bf16 a[204:207], v[124:127], v[92:95], a[204:207]
    ds_read_b128 v[96:99], v2 offset:16384
    ds_read_b128 v[100:103], v2 offset:17408
    v_mfma_f32_16x16x32_bf16 a[208:211], a[136:139], v[64:67], a[208:211]
    v_exp_f32 v252, v252
    v_mfma_f32_16x16x32_bf16 a[208:211], a[136:139], v[68:71], a[208:211]
    v_exp_f32 v253, v253
    v_mfma_f32_16x16x32_bf16 a[212:215], a[136:139], v[72:75], a[212:215]
    v_cvt_pk_bf16_f32 v55, v250, v251
    v_cvt_pk_bf16_f32 v62, v252, v253
    v_mfma_f32_16x16x32_bf16 a[212:215], a[136:139], v[76:79], a[212:215]
    v_mfma_f32_16x16x32_bf16 a[216:219], a[136:139], v[80:83], a[216:219]
    v_mfma_f32_16x16x32_bf16 a[216:219], a[136:139], v[84:87], a[216:219]
    v_mfma_f32_16x16x32_bf16 a[220:223], a[136:139], v[88:91], a[220:223]
    v_mfma_f32_16x16x32_bf16 a[220:223], a[136:139], v[92:95], a[220:223]
    s_sub_u32 s78, s78, 1
    s_cmp_lg_u32 s78, 0
    s_cbranch_scc1 K1_LB
K1_LB_END:
    v_add_f32 v212, s12, v148
    v_fma_f32 v176, v208, s8, v212
    v_fma_f32 v177, v209, s8, v212
    v_fma_f32 v178, v210, s8, v212
    v_fma_f32 v179, v211, s8, v212
    s_nop 1
    s_waitcnt lgkmcnt(0)
    v_mfma_f32_16x16x32_bf16 v[240:243], a[224:227], v[132:135], v[176:179]
    s_add_u32 m0, s76, s75
    ds_read_b128 v[104:107], v2 offset:18432
    ds_read_b128 v[108:111], v2 offset:19456
    v_mfma_f32_16x16x32_bf16 v[240:243], a[228:231], v[164:167], v[240:243]
    s_mov_b32 s76, s60
    buffer_load_dwordx4 v1, s[36:39], s77 offen sc1 lds
    v_mfma_f32_16x16x32_bf16 v[240:243], a[232:235], v[196:199], v[240:243]
    s_mov_b32 s60, s82
    v_exp_f32 v254, v254
    v_mfma_f32_16x16x32_bf16 v[240:243], a[236:239], v[228:231], v[240:243]
    s_add_u32 s82, s82, 32768
    v_exp_f32 v255, v255
    v_mfma_f32_16x16x32_bf16 a[0:3], v[96:99], v[32:35], a[0:3]
    s_mov_b32 s98, 0x3fb8aa3b
    v_cvt_pk_bf16_f32 v63, v254, v255
    ds_read_b128 a[240:243], v2 offset:4096
    v_mfma_f32_16x16x32_bf16 a[0:3], v[100:103], v[36:39], a[0:3]
    ds_read_b128 a[244:247], v2 offset:5120
    ds_read_b128 a[248:251], v2 offset:6144
    v_mfma_f32_16x16x32_bf16 a[4:7], v[96:99], v[40:43], a[4:7]
    ds_read_b128 a[252:255], v2 offset:7168
    v_add_f32 v213, s13, v148
    v_mfma_f32_16x16x32_bf16 a[4:7], v[100:103], v[44:47], a[4:7]
    ds_read_b128 v[112:115], v2 offset:20480
    v_fma_f32 v180, v208, s9, v213
    v_mfma_f32_16x16x32_bf16 v[244:247], a[224:227], v[136:139], v[152:155]
    ds_read_b128 v[116:119], v2 offset:21504
    v_fma_f32 v181, v209, s9, v213
    v_mfma_f32_16x16x32_bf16 v[244:247], a[228:231], v[168:171], v[244:247]
    v_fma_f32 v182, v210, s9, v213
    v_fma_f32 v183, v211, s9, v213
    v_mfma_f32_16x16x32_bf16 v[244:247], a[232:235], v[200:203], v[244:247]
    v_exp_f32 v240, v240
    v_mfma_f32_16x16x32_bf16 v[244:247], a[236:239], v[232:235], v[244:247]
    v_exp_f32 v241, v241
    v_mfma_f32_16x16x32_bf16 a[8:11], v[96:99], v[48:51], a[8:11]
    v_exp_f32 v242, v242
    v_mfma_f32_16x16x32_bf16 a[8:11], v[100:103], v[52:55], a[8:11]
    buffer_load_dwordx4 v1, s[36:39], s77 offen offset:1024 sc1 lds
    v_mfma_f32_16x16x32_bf16 a[12:15], v[96:99], v[56:59], a[12:15]
    v_exp_f32 v243, v243
    v_mfma_f32_16x16x32_bf16 a[12:15], v[100:103], v[60:63], a[12:15]
    s_waitcnt lgkmcnt(0)
    v_cvt_pk_bf16_f32 v72, v240, v241
    v_cvt_pk_bf16_f32 v73, v242, v243
    v_mfma_f32_16x16x32_bf16 a[16:19], v[104:107], v[32:35], a[16:19]
    ds_read_b128 v[120:123], v2 offset:22528
    ds_read_b128 v[124:127], v2 offset:23552
    v_mfma_f32_16x16x32_bf16 a[16:19], v[108:111], v[36:39], a[16:19]
    v_exp_f32 v244, v244
    v_mfma_f32_16x16x32_bf16 v[248:251], a[224:227], v[140:143], v[156:159]
    v_exp_f32 v245, v245
    v_mfma_f32_16x16x32_bf16 v[248:251], a[228:231], v[172:175], v[248:251]
    v_exp_f32 v246, v246
    v_mfma_f32_16x16x32_bf16 v[248:251], a[232:235], v[204:207], v[248:251]
    v_exp_f32 v247, v247
    v_mfma_f32_16x16x32_bf16 v[248:251], a[236:239], v[236:239], v[248:251]
    v_cvt_pk_bf16_f32 v80, v244, v245
    v_cvt_pk_bf16_f32 v81, v246, v247
    v_mfma_f32_16x16x32_bf16 a[20:23], v[104:107], v[40:43], a[20:23]
    ds_read_b128 a[224:227], v2 offset:8192
    ds_read_b128 a[228:231], v2 offset:9216
    v_mfma_f32_16x16x32_bf16 a[20:23], v[108:111], v[44:47], a[20:23]
    ds_read_b128 a[232:235], v2 offset:10240
    v_add_f32 v214, s14, v148
    v_mfma_f32_16x16x32_bf16 a[24:27], v[104:107], v[48:51], a[24:27]
    ds_read_b128 a[236:239], v2 offset:11264
    v_fma_f32 v184, v208, s10, v214
    v_mfma_f32_16x16x32_bf16 a[24:27], v[108:111], v[52:55], a[24:27]
    buffer_load_dwordx4 v1, s[36:39], s77 offen offset:2048 sc1 lds
    v_mfma_f32_16x16x32_bf16 a[28:31], v[104:107], v[56:59], a[28:31]
    ds_read_b128 v[96:99], v2 offset:24576
    ds_read_b128 v[100:103], v2 offset:25600
    v_mfma_f32_16x16x32_bf16 a[28:31], v[108:111], v[60:63], a[28:31]
    v_exp_f32 v248, v248
    v_mfma_f32_16x16x32_bf16 v[252:255], a[240:243], v[132:135], v[180:183]
    v_exp_f32 v249, v249
    v_mfma_f32_16x16x32_bf16 v[252:255], a[244:247], v[164:167], v[252:255]
    v_exp_f32 v250, v250
    v_mfma_f32_16x16x32_bf16 v[252:255], a[248:251], v[196:199], v[252:255]
    v_exp_f32 v251, v251
    v_mfma_f32_16x16x32_bf16 v[252:255], a[252:255], v[228:231], v[252:255]
    v_fma_f32 v185, v209, s10, v214
    v_fma_f32 v186, v210, s10, v214
    v_mfma_f32_16x16x32_bf16 a[32:35], v[112:115], v[32:35], a[32:35]
    v_fma_f32 v187, v211, s10, v214
    v_cvt_pk_bf16_f32 v88, v248, v249
    v_mfma_f32_16x16x32_bf16 a[32:35], v[116:119], v[36:39], a[32:35]
    v_cvt_pk_bf16_f32 v89, v250, v251
    ds_read_b128 v[104:107], v2 offset:26624
    v_mfma_f32_16x16x32_bf16 a[36:39], v[112:115], v[40:43], a[36:39]
    v_exp_f32 v252, v252
    v_mfma_f32_16x16x32_bf16 a[36:39], v[116:119], v[44:47], a[36:39]
    v_exp_f32 v253, v253
    v_mfma_f32_16x16x32_bf16 v[240:243], a[240:243], v[136:139], v[152:155]
    v_exp_f32 v254, v254
    v_mfma_f32_16x16x32_bf16 v[240:243], a[244:247], v[168:171], v[240:243]
    buffer_load_dwordx4 v1, s[36:39], s77 offen offset:3072 sc1 lds
    v_mfma_f32_16x16x32_bf16 v[240:243], a[248:251], v[200:203], v[240:243]
    v_exp_f32 v255, v255
    v_mfma_f32_16x16x32_bf16 v[240:243], a[252:255], v[232:235], v[240:243]
    v_cvt_pk_bf16_f32 v74, v252, v253
    v_cvt_pk_bf16_f32 v75, v254, v255
    v_mfma_f32_16x16x32_bf16 a[40:43], v[112:115], v[48:51], a[40:43]
    ds_read_b128 v[108:111], v2 offset:27648
    v_add_f32 v215, s15, v148
    v_mfma_f32_16x16x32_bf16 a[40:43], v[116:119], v[52:55], a[40:43]
    v_fma_f32 v188, v208, s11, v215
    v_fma_f32 v189, v209, s11, v215
    v_mfma_f32_16x16x32_bf16 a[44:47], v[112:115], v[56:59], a[44:47]
    v_exp_f32 v240, v240
    v_mfma_f32_16x16x32_bf16 a[44:47], v[116:119], v[60:63], a[44:47]
    s_waitcnt lgkmcnt(1)
    v_exp_f32 v241, v241
    v_mfma_f32_16x16x32_bf16 a[48:51], v[120:123], v[32:35], a[48:51]
    v_exp_f32 v242, v242
    v_mfma_f32_16x16x32_bf16 a[48:51], v[124:127], v[36:39], a[48:51]
    v_exp_f32 v243, v243
    v_mfma_f32_16x16x32_bf16 v[244:247], a[240:243], v[140:143], v[156:159]
    v_cvt_pk_bf16_f32 v82, v240, v241
    v_cvt_pk_bf16_f32 v83, v242, v243
    v_mfma_f32_16x16x32_bf16 v[244:247], a[244:247], v[172:175], v[244:247]
    ds_read_b128 a[240:243], v2 offset:12288
    ds_read_b128 a[244:247], v2 offset:13312
    v_mfma_f32_16x16x32_bf16 v[244:247], a[248:251], v[204:207], v[244:247]
    ds_read_b128 a[248:251], v2 offset:14336
    v_fma_f32 v190, v210, s11, v215
    v_mfma_f32_16x16x32_bf16 v[244:247], a[252:255], v[236:239], v[244:247]
    s_add_u32 s100, s77, 4096
    ds_read_b128 a[252:255], v2 offset:15360
    v_fma_f32 v191, v211, s11, v215
    v_mfma_f32_16x16x32_bf16 a[52:55], v[120:123], v[40:43], a[52:55]
    s_add_u32 m0, m0, 4096
    ds_read_b128 v[112:115], v2 offset:28672
    v_bfe_u32 v8, v1, 2, 6
    v_mfma_f32_16x16x32_bf16 a[52:55], v[124:127], v[44:47], a[52:55]
    buffer_load_dwordx4 v1, s[36:39], s100 offen sc1 lds
    v_mfma_f32_16x16x32_bf16 a[56:59], v[120:123], v[48:51], a[56:59]
    ds_read_b128 v[116:119], v2 offset:29696
    v_accvgpr_read_b32 v4, a112
    v_mfma_f32_16x16x32_bf16 a[56:59], v[124:127], v[52:55], a[56:59]
    v_exp_f32 v244, v244
    v_mfma_f32_16x16x32_bf16 a[60:63], v[120:123], v[56:59], a[60:63]
    v_exp_f32 v245, v245
    v_mfma_f32_16x16x32_bf16 a[60:63], v[124:127], v[60:63], a[60:63]
    v_exp_f32 v246, v246
    v_mfma_f32_16x16x32_bf16 v[248:251], a[224:227], v[132:135], v[184:187]
    v_exp_f32 v247, v247
    v_mfma_f32_16x16x32_bf16 v[248:251], a[228:231], v[164:167], v[248:251]
    v_cvt_pk_bf16_f32 v90, v244, v245
    v_cvt_pk_bf16_f32 v91, v246, v247
    v_mfma_f32_16x16x32_bf16 v[248:251], a[232:235], v[196:199], v[248:251]
    ds_read_b128 v[120:123], v2 offset:30720
    ds_read_b128 v[124:127], v2 offset:31744
    v_mfma_f32_16x16x32_bf16 v[248:251], a[236:239], v[228:231], v[248:251]
    v_accvgpr_read_b32 v5, a116
    v_accvgpr_read_b32 v6, a120
    v_mfma_f32_16x16x32_bf16 a[144:147], v[96:99], v[32:35], a[144:147]
    v_add_u32 v8, 192, v8
    v_cvt_pk_bf16_f32 v4, 0, v4
    v_mfma_f32_16x16x32_bf16 a[144:147], v[100:103], v[36:39], a[144:147]
    v_cvt_pk_bf16_f32 v5, 0, v5
    v_cvt_pk_bf16_f32 v6, 0, v6
    v_mfma_f32_16x16x32_bf16 a[148:151], v[96:99], v[40:43], a[148:151]
    buffer_load_dwordx4 v1, s[36:39], s100 offen offset:1024 sc1 lds
    v_mfma_f32_16x16x32_bf16 a[148:151], v[100:103], v[44:47], a[148:151]
    v_exp_f32 v248, v248
    v_mfma_f32_16x16x32_bf16 v[252:255], a[224:227], v[136:139], v[152:155]
    v_exp_f32 v249, v249
    v_mfma_f32_16x16x32_bf16 v[252:255], a[228:231], v[168:171], v[252:255]
    v_exp_f32 v250, v250
    v_mfma_f32_16x16x32_bf16 v[252:255], a[232:235], v[200:203], v[252:255]
    v_exp_f32 v251, v251
    v_mfma_f32_16x16x32_bf16 v[252:255], a[236:239], v[232:235], v[252:255]
    v_cvt_pk_bf16_f32 v76, v248, v249
    v_cvt_pk_bf16_f32 v77, v250, v251
    v_mfma_f32_16x16x32_bf16 a[152:155], v[96:99], v[48:51], a[152:155]
    ds_bpermute_b32 v4, v8, v4
    ds_bpermute_b32 v5, v8, v5
    v_mfma_f32_16x16x32_bf16 a[152:155], v[100:103], v[52:55], a[152:155]
    s_waitcnt lgkmcnt(1)
    ds_bpermute_b32 v6, v8, v6
    v_mul_f32 v4, s98, v4
    v_mfma_f32_16x16x32_bf16 a[156:159], v[96:99], v[56:59], a[156:159]
    v_exp_f32 v252, v252
    v_mfma_f32_16x16x32_bf16 a[156:159], v[100:103], v[60:63], a[156:159]
    v_exp_f32 v253, v253
    v_mfma_f32_16x16x32_bf16 a[160:163], v[104:107], v[32:35], a[160:163]
    v_exp_f32 v254, v254
    v_mfma_f32_16x16x32_bf16 a[160:163], v[108:111], v[36:39], a[160:163]
    v_exp_f32 v255, v255
    v_mfma_f32_16x16x32_bf16 v[240:243], a[224:227], v[140:143], v[156:159]
    buffer_load_dwordx4 v1, s[36:39], s100 offen offset:2048 sc1 lds
    v_mfma_f32_16x16x32_bf16 v[240:243], a[228:231], v[172:175], v[240:243]
    v_cvt_pk_bf16_f32 v84, v252, v253
    v_cvt_pk_bf16_f32 v85, v254, v255
    v_mfma_f32_16x16x32_bf16 v[240:243], a[232:235], v[204:207], v[240:243]
    s_cmp_eq_u32 s82, 163840
    s_cselect_b32 s82, 0, s82
    v_add_u32 v2, s82, v1
    v_mfma_f32_16x16x32_bf16 v[240:243], a[236:239], v[236:239], v[240:243]
    ds_read_b128 a[224:227], v2 offset:0
    ds_read_b128 a[228:231], v2 offset:1024
    v_mfma_f32_16x16x32_bf16 a[164:167], v[104:107], v[40:43], a[164:167]
    s_waitcnt lgkmcnt(2)
    ds_read_b128 a[232:235], v2 offset:2048
    v_mul_f32 v5, s98, v5
    v_mfma_f32_16x16x32_bf16 a[164:167], v[108:111], v[44:47], a[164:167]
    ds_read_b128 a[236:239], v2 offset:3072
    v_mul_f32 v6, s98, v6
    v_mfma_f32_16x16x32_bf16 a[168:171], v[104:107], v[48:51], a[168:171]
    v_exp_f32 v240, v240
    v_mfma_f32_16x16x32_bf16 a[168:171], v[108:111], v[52:55], a[168:171]
    ds_read_b128 v[96:99], v2 offset:16384
    ds_read_b128 v[100:103], v2 offset:17408
    v_mfma_f32_16x16x32_bf16 a[172:175], v[104:107], v[56:59], a[172:175]
    v_exp_f32 v241, v241
    v_mfma_f32_16x16x32_bf16 a[172:175], v[108:111], v[60:63], a[172:175]
    v_exp_f32 v242, v242
    v_mfma_f32_16x16x32_bf16 v[244:247], a[240:243], v[132:135], v[188:191]
    v_exp_f32 v243, v243
    v_mfma_f32_16x16x32_bf16 v[244:247], a[244:247], v[164:167], v[244:247]
    v_cvt_pk_bf16_f32 v92, v240, v241
    v_cvt_pk_bf16_f32 v93, v242, v243
    v_mfma_f32_16x16x32_bf16 v[244:247], a[248:251], v[196:199], v[244:247]
    buffer_load_dwordx4 v1, s[36:39], s100 offen offset:3072 sc1 lds
    v_mfma_f32_16x16x32_bf16 v[244:247], a[252:255], v[228:231], v[244:247]
    v_exp_f32 v4, v4
    v_mfma_f32_16x16x32_bf16 a[176:179], v[112:115], v[32:35], a[176:179]
    v_exp_f32 v5, v5
    v_mfma_f32_16x16x32_bf16 a[176:179], v[116:119], v[36:39], a[176:179]
    v_exp_f32 v6, v6
    v_mfma_f32_16x16x32_bf16 a[180:183], v[112:115], v[40:43], a[180:183]
    v_add_f32 v4, 1.0, v4
    v_add_f32 v5, 1.0, v5
    v_mfma_f32_16x16x32_bf16 a[180:183], v[116:119], v[44:47], a[180:183]
    v_exp_f32 v244, v244
    v_mfma_f32_16x16x32_bf16 v[248:251], a[240:243], v[136:139], v[152:155]
    v_exp_f32 v245, v245
    v_mfma_f32_16x16x32_bf16 v[248:251], a[244:247], v[168:171], v[248:251]
    v_exp_f32 v246, v246
    v_mfma_f32_16x16x32_bf16 v[248:251], a[248:251], v[200:203], v[248:251]
    v_exp_f32 v247, v247
    v_mfma_f32_16x16x32_bf16 v[248:251], a[252:255], v[232:235], v[248:251]
    v_cvt_pk_bf16_f32 v78, v244, v245
    v_cvt_pk_bf16_f32 v79, v246, v247
    v_mfma_f32_16x16x32_bf16 a[184:187], v[112:115], v[48:51], a[184:187]
    v_rcp_f32 v4, v4
    v_mfma_f32_16x16x32_bf16 a[184:187], v[116:119], v[52:55], a[184:187]
    v_rcp_f32 v5, v5
    v_mfma_f32_16x16x32_bf16 a[188:191], v[112:115], v[56:59], a[188:191]
    s_add_u32 s77, s77, 32768
    v_exp_f32 v248, v248
    v_mfma_f32_16x16x32_bf16 a[188:191], v[116:119], v[60:63], a[188:191]
    v_exp_f32 v249, v249
    v_mfma_f32_16x16x32_bf16 a[192:195], v[120:123], v[32:35], a[192:195]
    v_exp_f32 v250, v250
    v_mfma_f32_16x16x32_bf16 a[192:195], v[124:127], v[36:39], a[192:195]
    v_exp_f32 v251, v251
    v_mfma_f32_16x16x32_bf16 v[252:255], a[240:243], v[140:143], v[156:159]
    v_cvt_pk_bf16_f32 v86, v248, v249
    v_cvt_pk_bf16_f32 v87, v250, v251
    v_mfma_f32_16x16x32_bf16 v[252:255], a[244:247], v[172:175], v[252:255]
    v_add_f32 v6, 1.0, v6
    v_mfma_f32_16x16x32_bf16 v[252:255], a[248:251], v[204:207], v[252:255]
    v_rcp_f32 v6, v6
    v_mfma_f32_16x16x32_bf16 v[252:255], a[252:255], v[236:239], v[252:255]
    v_mfma_f32_16x16x32_bf16 a[196:199], v[120:123], v[40:43], a[196:199]
    v_mfma_f32_16x16x32_bf16 a[196:199], v[124:127], v[44:47], a[196:199]
    v_mfma_f32_16x16x32_bf16 a[200:203], v[120:123], v[48:51], a[200:203]
    v_mfma_f32_16x16x32_bf16 a[200:203], v[124:127], v[52:55], a[200:203]
    v_mfma_f32_16x16x32_bf16 a[204:207], v[120:123], v[56:59], a[204:207]
    v_mfma_f32_16x16x32_bf16 a[204:207], v[124:127], v[60:63], a[204:207]
    v_mfma_f32_16x16x32_bf16 a[208:211], a[136:139], v[32:35], a[208:211]
    v_mfma_f32_16x16x32_bf16 a[208:211], a[136:139], v[36:39], a[208:211]
    v_exp_f32 v252, v252
    v_mfma_f32_16x16x32_bf16 a[212:215], a[136:139], v[40:43], a[212:215]
    v_exp_f32 v253, v253
    v_mfma_f32_16x16x32_bf16 a[212:215], a[136:139], v[44:47], a[212:215]
    v_cvt_pk_bf16_f32 v94, v252, v253
    v_mfma_f32_16x16x32_bf16 a[216:219], a[136:139], v[48:51], a[216:219]
    v_mfma_f32_16x16x32_bf16 a[216:219], a[136:139], v[52:55], a[216:219]
    v_mfma_f32_16x16x32_bf16 a[220:223], a[136:139], v[56:59], a[220:223]
    v_mfma_f32_16x16x32_bf16 a[220:223], a[136:139], v[60:63], a[220:223]
    s_cmp_eq_u32 s6, 7
    s_cselect_b32 s16, s8, 0
    s_cselect_b32 s17, s9, 0
    s_cselect_b32 s18, s10, 0
    s_cselect_b32 s19, s11, 0
    s_cselect_b32 s20, s12, 0
    s_cselect_b32 s21, s13, 0
    s_cselect_b32 s22, s14, 0
    s_cselect_b32 s23, s15, 0
    v_add_f32 v212, s20, v152
    v_fma_f32 v176, v208, s16, v212
    v_fma_f32 v177, v209, s16, v212
    v_fma_f32 v178, v210, s16, v212
    v_fma_f32 v179, v211, s16, v212
    s_nop 1
    s_waitcnt lgkmcnt(0)
    v_mfma_f32_16x16x32_bf16 v[240:243], a[224:227], v[136:139], v[176:179]
    s_add_u32 m0, s76, s75
    v_exp_f32 v254, v254
    v_mfma_f32_16x16x32_bf16 v[240:243], a[228:231], v[168:171], v[240:243]
    s_mov_b32 s76, s60
    buffer_load_dwordx4 v1, s[36:39], s77 offen sc1 lds
    v_mfma_f32_16x16x32_bf16 v[240:243], a[232:235], v[200:203], v[240:243]
    s_mov_b32 s60, s82
    v_exp_f32 v255, v255
    v_mfma_f32_16x16x32_bf16 v[240:243], a[236:239], v[232:235], v[240:243]
    s_add_u32 s82, s82, 32768
    ds_read_b128 v[104:107], v2 offset:18432
    v_cvt_pk_bf16_f32 v95, v254, v255
    v_mfma_f32_16x16x32_bf16 a[4:7], v[96:99], v[72:75], a[4:7]
    ds_read_b128 v[108:111], v2 offset:19456
    ds_read_b128 a[240:243], v2 offset:4096
    v_mfma_f32_16x16x32_bf16 a[4:7], v[100:103], v[76:79], a[4:7]
    ds_read_b128 a[244:247], v2 offset:5120
    v_add_f32 v213, s21, v152
    v_mfma_f32_16x16x32_bf16 a[8:11], v[96:99], v[80:83], a[8:11]
    ds_read_b128 a[248:251], v2 offset:6144
    v_fma_f32 v180, v208, s17, v213
    v_mfma_f32_16x16x32_bf16 a[8:11], v[100:103], v[84:87], a[8:11]
    ds_read_b128 a[252:255], v2 offset:7168
    v_fma_f32 v181, v209, s17, v213
    v_mfma_f32_16x16x32_bf16 a[12:15], v[96:99], v[88:91], a[12:15]
    ds_read_b128 v[112:115], v2 offset:20480
    v_fma_f32 v182, v210, s17, v213
    v_mfma_f32_16x16x32_bf16 a[12:15], v[100:103], v[92:95], a[12:15]
    buffer_load_dwordx4 v1, s[36:39], s77 offen offset:1024 sc1 lds
    v_mfma_f32_16x16x32_bf16 v[244:247], a[224:227], v[140:143], v[156:159]
    ds_read_b128 v[116:119], v2 offset:21504
    v_fma_f32 v183, v211, s17, v213
    v_mfma_f32_16x16x32_bf16 v[244:247], a[228:231], v[172:175], v[244:247]
    ds_read_b128 v[120:123], v2 offset:22528
    ds_read_b128 v[124:127], v2 offset:23552
    v_mfma_f32_16x16x32_bf16 v[244:247], a[232:235], v[204:207], v[244:247]
    ds_read_b128 a[224:227], v2 offset:8192
    v_add_f32 v214, s22, v152
    v_mfma_f32_16x16x32_bf16 v[244:247], a[236:239], v[236:239], v[244:247]
    s_waitcnt lgkmcnt(4)
    ds_read_b128 a[228:231], v2 offset:9216
    v_fma_f32 v184, v208, s18, v214
    v_mfma_f32_16x16x32_bf16 a[20:23], v[104:107], v[72:75], a[20:23]
    ds_read_b128 a[232:235], v2 offset:10240
    v_fma_f32 v185, v209, s18, v214
    v_mfma_f32_16x16x32_bf16 a[20:23], v[108:111], v[76:79], a[20:23]
    ds_read_b128 a[236:239], v2 offset:11264
    v_fma_f32 v186, v210, s18, v214
    v_mfma_f32_16x16x32_bf16 a[24:27], v[104:107], v[80:83], a[24:27]
    ds_read_b128 v[96:99], v2 offset:24576
    v_fma_f32 v187, v211, s18, v214
    v_mfma_f32_16x16x32_bf16 a[24:27], v[108:111], v[84:87], a[24:27]
    buffer_load_dwordx4 v1, s[36:39], s77 offen offset:2048 sc1 lds
    v_mfma_f32_16x16x32_bf16 a[28:31], v[104:107], v[88:91], a[28:31]
    ds_read_b128 v[100:103], v2 offset:25600
    ds_read_b128 v[104:107], v2 offset:26624
    v_mfma_f32_16x16x32_bf16 a[28:31], v[108:111], v[92:95], a[28:31]
    v_exp_f32 v240, v240
    v_mfma_f32_16x16x32_bf16 v[248:251], a[240:243], v[136:139], v[180:183]
    v_exp_f32 v241, v241
    v_mfma_f32_16x16x32_bf16 v[248:251], a[244:247], v[168:171], v[248:251]
    v_exp_f32 v242, v242
    v_mfma_f32_16x16x32_bf16 v[248:251], a[248:251], v[200:203], v[248:251]
    v_exp_f32 v243, v243
    v_mfma_f32_16x16x32_bf16 v[248:251], a[252:255], v[232:235], v[248:251]
    v_cvt_pk_bf16_f32 v48, v240, v241
    v_cvt_pk_bf16_f32 v49, v242, v243
    v_mfma_f32_16x16x32_bf16 a[36:39], v[112:115], v[72:75], a[36:39]
    s_waitcnt lgkmcnt(0)
    ds_read_b128 v[108:111], v2 offset:27648
    v_add_f32 v215, s23, v152
    v_mfma_f32_16x16x32_bf16 a[36:39], v[116:119], v[76:79], a[36:39]
    buffer_load_dwordx4 v1, s[36:39], s77 offen offset:3072 sc1 lds
    v_mfma_f32_16x16x32_bf16 a[40:43], v[112:115], v[80:83], a[40:43]
    v_exp_f32 v244, v244
    v_mfma_f32_16x16x32_bf16 a[40:43], v[116:119], v[84:87], a[40:43]
    v_exp_f32 v245, v245
    v_mfma_f32_16x16x32_bf16 a[44:47], v[112:115], v[88:91], a[44:47]
    v_exp_f32 v246, v246
    v_mfma_f32_16x16x32_bf16 a[44:47], v[116:119], v[92:95], a[44:47]
    v_exp_f32 v247, v247
    v_mfma_f32_16x16x32_bf16 v[252:255], a[240:243], v[140:143], v[156:159]
    v_cvt_pk_bf16_f32 v56, v244, v245
    v_cvt_pk_bf16_f32 v57, v246, v247
    v_mfma_f32_16x16x32_bf16 v[252:255], a[244:247], v[172:175], v[252:255]
    ds_read_b128 a[240:243], v2 offset:12288
    ds_read_b128 a[244:247], v2 offset:13312
    v_mfma_f32_16x16x32_bf16 v[252:255], a[248:251], v[204:207], v[252:255]
    s_add_u32 s100, s77, 4096
    ds_read_b128 a[248:251], v2 offset:14336
    v_fma_f32 v188, v208, s19, v215
    v_mfma_f32_16x16x32_bf16 v[252:255], a[252:255], v[236:239], v[252:255]
    s_add_u32 m0, m0, 4096
    ds_read_b128 a[252:255], v2 offset:15360
    v_fma_f32 v189, v209, s19, v215
    v_mfma_f32_16x16x32_bf16 a[52:55], v[120:123], v[72:75], a[52:55]
    buffer_load_dwordx4 v1, s[36:39], s100 offen sc1 lds
    v_mfma_f32_16x16x32_bf16 a[52:55], v[124:127], v[76:79], a[52:55]
    ds_read_b128 v[112:115], v2 offset:28672
    ds_read_b128 v[116:119], v2 offset:29696
    v_mfma_f32_16x16x32_bf16 a[56:59], v[120:123], v[80:83], a[56:59]
    v_exp_f32 v248, v248
    v_mfma_f32_16x16x32_bf16 a[56:59], v[124:127], v[84:87], a[56:59]
    v_exp_f32 v249, v249
    v_mfma_f32_16x16x32_bf16 a[60:63], v[120:123], v[88:91], a[60:63]
    v_exp_f32 v250, v250
    v_mfma_f32_16x16x32_bf16 a[60:63], v[124:127], v[92:95], a[60:63]
    v_exp_f32 v251, v251
    v_mfma_f32_16x16x32_bf16 v[240:243], a[224:227], v[136:139], v[184:187]
    v_fma_f32 v190, v210, s19, v215
    v_fma_f32 v191, v211, s19, v215
    v_mfma_f32_16x16x32_bf16 v[240:243], a[228:231], v[168:171], v[240:243]
    buffer_load_dwordx4 v1, s[36:39], s100 offen offset:1024 sc1 lds
    v_mfma_f32_16x16x32_bf16 v[240:243], a[232:235], v[200:203], v[240:243]
    v_cvt_pk_bf16_f32 v50, v248, v249
    v_cvt_pk_bf16_f32 v51, v250, v251
    v_mfma_f32_16x16x32_bf16 v[240:243], a[236:239], v[232:235], v[240:243]
    ds_read_b128 v[120:123], v2 offset:30720
    ds_read_b128 v[124:127], v2 offset:31744
    v_mfma_f32_16x16x32_bf16 a[148:151], v[96:99], v[72:75], a[148:151]
    v_exp_f32 v252, v252
    v_mfma_f32_16x16x32_bf16 a[148:151], v[100:103], v[76:79], a[148:151]
    v_exp_f32 v253, v253
    v_mfma_f32_16x16x32_bf16 a[152:155], v[96:99], v[80:83], a[152:155]
    v_exp_f32 v254, v254
    v_mfma_f32_16x16x32_bf16 a[152:155], v[100:103], v[84:87], a[152:155]
    v_exp_f32 v255, v255
    v_mfma_f32_16x16x32_bf16 a[156:159], v[96:99], v[88:91], a[156:159]
    v_cvt_pk_bf16_f32 v58, v252, v253
    v_cvt_pk_bf16_f32 v59, v254, v255
    v_mfma_f32_16x16x32_bf16 a[156:159], v[100:103], v[92:95], a[156:159]
    buffer_load_dwordx4 v1, s[36:39], s100 offen offset:2048 sc1 lds
    v_mfma_f32_16x16x32_bf16 v[244:247], a[224:227], v[140:143], v[156:159]
    s_cmp_eq_u32 s82, 163840
    s_cselect_b32 s82, 0, s82
    v_add_u32 v2, s82, v1
    v_mfma_f32_16x16x32_bf16 v[244:247], a[228:231], v[172:175], v[244:247]
    v_exp_f32 v240, v240
    v_mfma_f32_16x16x32_bf16 v[244:247], a[232:235], v[204:207], v[244:247]
    v_exp_f32 v241, v241
    v_mfma_f32_16x16x32_bf16 v[244:247], a[236:239], v[236:239], v[244:247]
    v_exp_f32 v242, v242
    v_mfma_f32_16x16x32_bf16 a[164:167], v[104:107], v[72:75], a[164:167]
    s_waitcnt lgkmcnt(0)
    v_exp_f32 v243, v243
    v_mfma_f32_16x16x32_bf16 a[164:167], v[108:111], v[76:79], a[164:167]
    v_cvt_pk_bf16_f32 v52, v240, v241
    v_cvt_pk_bf16_f32 v53, v242, v243
    v_mfma_f32_16x16x32_bf16 a[168:171], v[104:107], v[80:83], a[168:171]
    v_accvgpr_read_b32 v7, a124
    v_cvt_pk_bf16_f32 v7, 0, v7
    v_mfma_f32_16x16x32_bf16 a[168:171], v[108:111], v[84:87], a[168:171]
    buffer_load_dwordx4 v1, s[36:39], s100 offen offset:3072 sc1 lds
    v_mfma_f32_16x16x32_bf16 a[172:175], v[104:107], v[88:91], a[172:175]
    v_exp_f32 v244, v244
    v_mfma_f32_16x16x32_bf16 a[172:175], v[108:111], v[92:95], a[172:175]
    v_exp_f32 v245, v245
    v_mfma_f32_16x16x32_bf16 v[248:251], a[240:243], v[136:139], v[188:191]
    v_exp_f32 v246, v246
    v_mfma_f32_16x16x32_bf16 v[248:251], a[244:247], v[168:171], v[248:251]
    v_exp_f32 v247, v247
    v_mfma_f32_16x16x32_bf16 v[248:251], a[248:251], v[200:203], v[248:251]
    v_cvt_pk_bf16_f32 v60, v244, v245
    v_cvt_pk_bf16_f32 v61, v246, v247
    v_mfma_f32_16x16x32_bf16 v[248:251], a[252:255], v[232:235], v[248:251]
    ds_bpermute_b32 v7, v8, v7
    s_waitcnt lgkmcnt(0)
    v_mul_f32 v7, s98, v7
    v_mfma_f32_16x16x32_bf16 a[180:183], v[112:115], v[72:75], a[180:183]
    s_add_u32 s77, s77, 32768
    v_exp_f32 v7, v7
    v_mfma_f32_16x16x32_bf16 a[180:183], v[116:119], v[76:79], a[180:183]
    v_add_f32 v7, 1.0, v7
    v_mfma_f32_16x16x32_bf16 a[184:187], v[112:115], v[80:83], a[184:187]
    v_exp_f32 v248, v248
    v_mfma_f32_16x16x32_bf16 a[184:187], v[116:119], v[84:87], a[184:187]
    v_exp_f32 v249, v249
    v_mfma_f32_16x16x32_bf16 a[188:191], v[112:115], v[88:91], a[188:191]
    v_exp_f32 v250, v250
    v_mfma_f32_16x16x32_bf16 a[188:191], v[116:119], v[92:95], a[188:191]
    v_exp_f32 v251, v251
    v_mfma_f32_16x16x32_bf16 v[252:255], a[240:243], v[140:143], v[156:159]
    v_cvt_pk_bf16_f32 v54, v248, v249
    v_cvt_pk_bf16_f32 v55, v250, v251
    v_mfma_f32_16x16x32_bf16 v[252:255], a[244:247], v[172:175], v[252:255]
    v_rcp_f32 v7, v7
    v_mfma_f32_16x16x32_bf16 v[252:255], a[248:251], v[204:207], v[252:255]
    v_mfma_f32_16x16x32_bf16 v[252:255], a[252:255], v[236:239], v[252:255]
    s_waitcnt vmcnt(16)
    s_barrier
    ds_read_b128 a[224:227], v2 offset:0
    v_mfma_f32_16x16x32_bf16 a[196:199], v[120:123], v[72:75], a[196:199]
    ds_read_b128 a[228:231], v2 offset:1024
    ds_read_b128 a[232:235], v2 offset:2048
    v_mfma_f32_16x16x32_bf16 a[196:199], v[124:127], v[76:79], a[196:199]
    ds_read_b128 a[236:239], v2 offset:3072
    v_mfma_f32_16x16x32_bf16 a[200:203], v[120:123], v[80:83], a[200:203]
    v_exp_f32 v252, v252
    v_mfma_f32_16x16x32_bf16 a[200:203], v[124:127], v[84:87], a[200:203]
    ds_read_b128 v[96:99], v2 offset:16384
    ds_read_b128 v[100:103], v2 offset:17408
    v_mfma_f32_16x16x32_bf16 a[204:207], v[120:123], v[88:91], a[204:207]
    v_exp_f32 v253, v253
    v_mfma_f32_16x16x32_bf16 a[204:207], v[124:127], v[92:95], a[204:207]
    v_cvt_pk_bf16_f32 v62, v252, v253
    v_mfma_f32_16x16x32_bf16 a[212:215], a[136:139], v[72:75], a[212:215]
    v_mfma_f32_16x16x32_bf16 a[212:215], a[136:139], v[76:79], a[212:215]
    v_mfma_f32_16x16x32_bf16 a[216:219], a[136:139], v[80:83], a[216:219]
    v_mfma_f32_16x16x32_bf16 a[216:219], a[136:139], v[84:87], a[216:219]
    v_mfma_f32_16x16x32_bf16 a[220:223], a[136:139], v[88:91], a[220:223]
    v_mfma_f32_16x16x32_bf16 a[220:223], a[136:139], v[92:95], a[220:223]
    s_nop 7
    v_accvgpr_read_b32 v8, a208
    v_cmp_nge_f32 vcc, 0x71800000, v8
    v_rcp_f32 v10, v8
    s_nop 0
    s_or_b64 s[84:85], s[84:85], vcc
    v_mul_f32 v10, v10, v4
    v_accvgpr_read_b32 v12, a0
    v_accvgpr_read_b32 v13, a1
    v_accvgpr_read_b32 v14, a2
    v_accvgpr_read_b32 v15, a3
    v_accvgpr_read_b32 v16, a16
    v_accvgpr_read_b32 v17, a17
    v_accvgpr_read_b32 v18, a18
    v_accvgpr_read_b32 v19, a19
    v_pk_mul_f32 v[12:13], v[12:13], v[10:11] op_sel_hi:[1,0]
    v_pk_mul_f32 v[14:15], v[14:15], v[10:11] op_sel_hi:[1,0]
    v_pk_mul_f32 v[16:17], v[16:17], v[10:11] op_sel_hi:[1,0]
    v_pk_mul_f32 v[18:19], v[18:19], v[10:11] op_sel_hi:[1,0]
    v_cvt_pk_bf16_f32 v12, v12, v13
    v_cvt_pk_bf16_f32 v13, v14, v15
    v_cvt_pk_bf16_f32 v14, v16, v17
    v_cvt_pk_bf16_f32 v15, v18, v19
    buffer_store_dwordx4 v[12:15], v1, s[40:43], s80 offen offset:0 sc1
    v_accvgpr_read_b32 v20, a32
    v_accvgpr_read_b32 v21, a33
    v_accvgpr_read_b32 v22, a34
    v_accvgpr_read_b32 v23, a35
    v_accvgpr_read_b32 v24, a48
    v_accvgpr_read_b32 v25, a49
    v_accvgpr_read_b32 v26, a50
    v_accvgpr_read_b32 v27, a51
    v_pk_mul_f32 v[20:21], v[20:21], v[10:11] op_sel_hi:[1,0]
    v_pk_mul_f32 v[22:23], v[22:23], v[10:11] op_sel_hi:[1,0]
    v_pk_mul_f32 v[24:25], v[24:25], v[10:11] op_sel_hi:[1,0]
    v_pk_mul_f32 v[26:27], v[26:27], v[10:11] op_sel_hi:[1,0]
    v_cvt_pk_bf16_f32 v20, v20, v21
    v_cvt_pk_bf16_f32 v21, v22, v23
    v_cvt_pk_bf16_f32 v22, v24, v25
    v_cvt_pk_bf16_f32 v23, v26, v27
    buffer_store_dwordx4 v[20:23], v1, s[40:43], s80 offen offset:1024 sc1
    v_accvgpr_read_b32 v12, a144
    v_accvgpr_read_b32 v13, a145
    v_accvgpr_read_b32 v14, a146
    v_accvgpr_read_b32 v15, a147
    v_accvgpr_read_b32 v16, a160
    v_accvgpr_read_b32 v17, a161
    v_accvgpr_read_b32 v18, a162
    v_accvgpr_read_b32 v19, a163
    v_pk_mul_f32 v[12:13], v[12:13], v[10:11] op_sel_hi:[1,0]
    v_pk_mul_f32 v[14:15], v[14:15], v[10:11] op_sel_hi:[1,0]
    v_pk_mul_f32 v[16:17], v[16:17], v[10:11] op_sel_hi:[1,0]
    v_pk_mul_f32 v[18:19], v[18:19], v[10:11] op_sel_hi:[1,0]
    v_cvt_pk_bf16_f32 v12, v12, v13
    v_cvt_pk_bf16_f32 v13, v14, v15
    v_cvt_pk_bf16_f32 v14, v16, v17
    v_cvt_pk_bf16_f32 v15, v18, v19
    buffer_store_dwordx4 v[12:15], v1, s[40:43], s80 offen offset:2048 sc1
    v_accvgpr_read_b32 v20, a176
    v_accvgpr_read_b32 v21, a177
    v_accvgpr_read_b32 v22, a178
    v_accvgpr_read_b32 v23, a179
    v_accvgpr_read_b32 v24, a192
    v_accvgpr_read_b32 v25, a193
    v_accvgpr_read_b32 v26, a194
    v_accvgpr_read_b32 v27, a195
    v_pk_mul_f32 v[20:21], v[20:21], v[10:11] op_sel_hi:[1,0]
    v_pk_mul_f32 v[22:23], v[22:23], v[10:11] op_sel_hi:[1,0]
    v_pk_mul_f32 v[24:25], v[24:25], v[10:11] op_sel_hi:[1,0]
    v_pk_mul_f32 v[26:27], v[26:27], v[10:11] op_sel_hi:[1,0]
    v_cvt_pk_bf16_f32 v20, v20, v21
    v_cvt_pk_bf16_f32 v21, v22, v23
    v_cvt_pk_bf16_f32 v22, v24, v25
    v_cvt_pk_bf16_f32 v23, v26, v27
    buffer_store_dwordx4 v[20:23], v1, s[40:43], s80 offen offset:3072 sc1
    v_accvgpr_read_b32 v8, a212
    v_cmp_nge_f32 vcc, 0x71800000, v8
    v_rcp_f32 v10, v8
    s_nop 0
    s_or_b64 s[84:85], s[84:85], vcc
    v_mul_f32 v10, v10, v5
    s_add_u32 s72, s80, 622592
    v_accvgpr_read_b32 v12, a4
    v_accvgpr_read_b32 v13, a5
    v_accvgpr_read_b32 v14, a6
    v_accvgpr_read_b32 v15, a7
    v_accvgpr_read_b32 v16, a20
    v_accvgpr_read_b32 v17, a21
    v_accvgpr_read_b32 v18, a22
    v_accvgpr_read_b32 v19, a23
    v_pk_mul_f32 v[12:13], v[12:13], v[10:11] op_sel_hi:[1,0]
    v_pk_mul_f32 v[14:15], v[14:15], v[10:11] op_sel_hi:[1,0]
    v_pk_mul_f32 v[16:17], v[16:17], v[10:11] op_sel_hi:[1,0]
    v_pk_mul_f32 v[18:19], v[18:19], v[10:11] op_sel_hi:[1,0]
    v_cvt_pk_bf16_f32 v12, v12, v13
    v_cvt_pk_bf16_f32 v13, v14, v15
    v_cvt_pk_bf16_f32 v14, v16, v17
    v_cvt_pk_bf16_f32 v15, v18, v19
    buffer_store_dwordx4 v[12:15], v1, s[40:43], s72 offen offset:0 sc1
    v_accvgpr_read_b32 v20, a36
    v_accvgpr_read_b32 v21, a37
    v_accvgpr_read_b32 v22, a38
    v_accvgpr_read_b32 v23, a39
    v_accvgpr_read_b32 v24, a52
    v_accvgpr_read_b32 v25, a53
    v_accvgpr_read_b32 v26, a54
    v_accvgpr_read_b32 v27, a55
    v_pk_mul_f32 v[20:21], v[20:21], v[10:11] op_sel_hi:[1,0]
    v_pk_mul_f32 v[22:23], v[22:23], v[10:11] op_sel_hi:[1,0]
    v_pk_mul_f32 v[24:25], v[24:25], v[10:11] op_sel_hi:[1,0]
    v_pk_mul_f32 v[26:27], v[26:27], v[10:11] op_sel_hi:[1,0]
    v_cvt_pk_bf16_f32 v20, v20, v21
    v_cvt_pk_bf16_f32 v21, v22, v23
    v_cvt_pk_bf16_f32 v22, v24, v25
    v_cvt_pk_bf16_f32 v23, v26, v27
    buffer_store_dwordx4 v[20:23], v1, s[40:43], s72 offen offset:1024 sc1
    v_accvgpr_read_b32 v12, a148
    v_accvgpr_read_b32 v13, a149
    v_accvgpr_read_b32 v14, a150
    v_accvgpr_read_b32 v15, a151
    v_accvgpr_read_b32 v16, a164
    v_accvgpr_read_b32 v17, a165
    v_accvgpr_read_b32 v18, a166
    v_accvgpr_read_b32 v19, a167
    v_pk_mul_f32 v[12:13], v[12:13], v[10:11] op_sel_hi:[1,0]
    v_pk_mul_f32 v[14:15], v[14:15], v[10:11] op_sel_hi:[1,0]
    v_pk_mul_f32 v[16:17], v[16:17], v[10:11] op_sel_hi:[1,0]
    v_pk_mul_f32 v[18:19], v[18:19], v[10:11] op_sel_hi:[1,0]
    v_cvt_pk_bf16_f32 v12, v12, v13
    v_cvt_pk_bf16_f32 v13, v14, v15
    v_cvt_pk_bf16_f32 v14, v16, v17
    v_cvt_pk_bf16_f32 v15, v18, v19
    buffer_store_dwordx4 v[12:15], v1, s[40:43], s72 offen offset:2048 sc1
    v_accvgpr_read_b32 v20, a180
    v_accvgpr_read_b32 v21, a181
    v_accvgpr_read_b32 v22, a182
    v_accvgpr_read_b32 v23, a183
    v_accvgpr_read_b32 v24, a196
    v_accvgpr_read_b32 v25, a197
    v_accvgpr_read_b32 v26, a198
    v_accvgpr_read_b32 v27, a199
    v_pk_mul_f32 v[20:21], v[20:21], v[10:11] op_sel_hi:[1,0]
    v_pk_mul_f32 v[22:23], v[22:23], v[10:11] op_sel_hi:[1,0]
    v_pk_mul_f32 v[24:25], v[24:25], v[10:11] op_sel_hi:[1,0]
    v_pk_mul_f32 v[26:27], v[26:27], v[10:11] op_sel_hi:[1,0]
    v_cvt_pk_bf16_f32 v20, v20, v21
    v_cvt_pk_bf16_f32 v21, v22, v23
    v_cvt_pk_bf16_f32 v22, v24, v25
    v_cvt_pk_bf16_f32 v23, v26, v27
    buffer_store_dwordx4 v[20:23], v1, s[40:43], s72 offen offset:3072 sc1
    s_sub_u32 s78, 14, s6
    s_sub_u32 s78, s78, s6
    s_cmp_eq_u32 s78, 0
    s_cbranch_scc1 K1_LS_END
.p2align 3
K1_LS:
    s_waitcnt lgkmcnt(0)
    v_mfma_f32_16x16x32_bf16 v[240:243], a[224:227], v[136:139], v[176:179]
    s_add_u32 m0, s76, s75
    v_exp_f32 v254, v254
    v_mfma_f32_16x16x32_bf16 v[240:243], a[228:231], v[168:171], v[240:243]
    s_mov_b32 s76, s60
    v_exp_f32 v255, v255
    v_mfma_f32_16x16x32_bf16 v[240:243], a[232:235], v[200:203], v[240:243]
    s_mov_b32 s60, s82
    buffer_load_dwordx4 v1, s[36:39], s77 offen sc1 lds
    v_mfma_f32_16x16x32_bf16 v[240:243], a[236:239], v[232:235], v[240:243]
    s_add_u32 s82, s82, 32768
    ds_read_b128 v[104:107], v2 offset:18432
    v_cvt_pk_bf16_f32 v63, v254, v255
    v_mfma_f32_16x16x32_bf16 a[8:11], v[96:99], v[48:51], a[8:11]
    ds_read_b128 v[108:111], v2 offset:19456
    ds_read_b128 a[240:243], v2 offset:4096
    v_mfma_f32_16x16x32_bf16 a[8:11], v[100:103], v[52:55], a[8:11]
    ds_read_b128 a[244:247], v2 offset:5120
    v_mfma_f32_16x16x32_bf16 a[12:15], v[96:99], v[56:59], a[12:15]
    buffer_load_dwordx4 v1, s[36:39], s77 offen offset:1024 sc1 lds
    v_mfma_f32_16x16x32_bf16 a[12:15], v[100:103], v[60:63], a[12:15]
    ds_read_b128 a[248:251], v2 offset:6144
    ds_read_b128 a[252:255], v2 offset:7168
    v_mfma_f32_16x16x32_bf16 v[244:247], a[224:227], v[140:143], v[156:159]
    v_exp_f32 v240, v240
    v_mfma_f32_16x16x32_bf16 v[244:247], a[228:231], v[172:175], v[244:247]
    ds_read_b128 v[112:115], v2 offset:20480
    ds_read_b128 v[116:119], v2 offset:21504
    v_mfma_f32_16x16x32_bf16 v[244:247], a[232:235], v[204:207], v[244:247]
    v_exp_f32 v241, v241
    v_mfma_f32_16x16x32_bf16 v[244:247], a[236:239], v[236:239], v[244:247]
    s_waitcnt lgkmcnt(4)
    ds_read_b128 v[120:123], v2 offset:22528
    ds_read_b128 v[124:127], v2 offset:23552
    v_mfma_f32_16x16x32_bf16 a[24:27], v[104:107], v[48:51], a[24:27]
    buffer_load_dwordx4 v1, s[36:39], s77 offen offset:2048 sc1 lds
    v_mfma_f32_16x16x32_bf16 a[24:27], v[108:111], v[52:55], a[24:27]
    ds_read_b128 a[224:227], v2 offset:8192
    ds_read_b128 a[228:231], v2 offset:9216
    v_mfma_f32_16x16x32_bf16 a[28:31], v[104:107], v[56:59], a[28:31]
    ds_read_b128 a[232:235], v2 offset:10240
    v_cvt_pk_bf16_f32 v80, v240, v241
    v_mfma_f32_16x16x32_bf16 a[28:31], v[108:111], v[60:63], a[28:31]
    v_exp_f32 v242, v242
    v_mfma_f32_16x16x32_bf16 v[248:251], a[240:243], v[136:139], v[180:183]
    ds_read_b128 a[236:239], v2 offset:11264
    ds_read_b128 v[96:99], v2 offset:24576
    v_mfma_f32_16x16x32_bf16 v[248:251], a[244:247], v[168:171], v[248:251]
    s_waitcnt lgkmcnt(5)
    v_exp_f32 v243, v243
    v_mfma_f32_16x16x32_bf16 v[248:251], a[248:251], v[200:203], v[248:251]
    buffer_load_dwordx4 v1, s[36:39], s77 offen offset:3072 sc1 lds
    v_mfma_f32_16x16x32_bf16 v[248:251], a[252:255], v[232:235], v[248:251]
    ds_read_b128 v[100:103], v2 offset:25600
    v_cvt_pk_bf16_f32 v81, v242, v243
    v_mfma_f32_16x16x32_bf16 a[40:43], v[112:115], v[48:51], a[40:43]
    ds_read_b128 v[104:107], v2 offset:26624
    ds_read_b128 v[108:111], v2 offset:27648
    v_mfma_f32_16x16x32_bf16 a[40:43], v[116:119], v[52:55], a[40:43]
    v_exp_f32 v244, v244
    v_mfma_f32_16x16x32_bf16 a[44:47], v[112:115], v[56:59], a[44:47]
    v_exp_f32 v245, v245
    v_mfma_f32_16x16x32_bf16 a[44:47], v[116:119], v[60:63], a[44:47]
    s_add_u32 s100, s77, 4096
    v_exp_f32 v246, v246
    v_mfma_f32_16x16x32_bf16 v[252:255], a[240:243], v[140:143], v[156:159]
    s_add_u32 m0, m0, 4096
    v_exp_f32 v247, v247
    v_mfma_f32_16x16x32_bf16 v[252:255], a[244:247], v[172:175], v[252:255]
    buffer_load_dwordx4 v1, s[36:39], s100 offen sc1 lds
    v_mfma_f32_16x16x32_bf16 v[252:255], a[248:251], v[204:207], v[252:255]
    v_cvt_pk_bf16_f32 v88, v244, v245
    v_cvt_pk_bf16_f32 v89, v246, v247
    v_mfma_f32_16x16x32_bf16 v[252:255], a[252:255], v[236:239], v[252:255]
    ds_read_b128 a[240:243], v2 offset:12288
    ds_read_b128 a[244:247], v2 offset:13312
    v_mfma_f32_16x16x32_bf16 a[56:59], v[120:123], v[48:51], a[56:59]
    v_exp_f32 v248, v248
    v_mfma_f32_16x16x32_bf16 a[56:59], v[124:127], v[52:55], a[56:59]
    buffer_load_dwordx4 v1, s[36:39], s100 offen offset:1024 sc1 lds
    v_mfma_f32_16x16x32_bf16 a[60:63], v[120:123], v[56:59], a[60:63]
    ds_read_b128 a[248:251], v2 offset:14336
    ds_read_b128 a[252:255], v2 offset:15360
    v_mfma_f32_16x16x32_bf16 a[60:63], v[124:127], v[60:63], a[60:63]
    s_waitcnt lgkmcnt(4)
    v_exp_f32 v249, v249
    v_mfma_f32_16x16x32_bf16 v[240:243], a[224:227], v[136:139], v[184:187]
    ds_read_b128 v[112:115], v2 offset:28672
    ds_read_b128 v[116:119], v2 offset:29696
    v_mfma_f32_16x16x32_bf16 v[240:243], a[228:231], v[168:171], v[240:243]
    v_exp_f32 v250, v250
    v_mfma_f32_16x16x32_bf16 v[240:243], a[232:235], v[200:203], v[240:243]
    v_exp_f32 v251, v251
    v_mfma_f32_16x16x32_bf16 v[240:243], a[236:239], v[232:235], v[240:243]
    buffer_load_dwordx4 v1, s[36:39], s100 offen offset:2048 sc1 lds
    v_mfma_f32_16x16x32_bf16 a[152:155], v[96:99], v[48:51], a[152:155]
    v_cvt_pk_bf16_f32 v82, v248, v249
    v_cvt_pk_bf16_f32 v83, v250, v251
    v_mfma_f32_16x16x32_bf16 a[152:155], v[100:103], v[52:55], a[152:155]
    ds_read_b128 v[120:123], v2 offset:30720
    ds_read_b128 v[124:127], v2 offset:31744
    v_mfma_f32_16x16x32_bf16 a[156:159], v[96:99], v[56:59], a[156:159]
    v_exp_f32 v252, v252
    v_mfma_f32_16x16x32_bf16 a[156:159], v[100:103], v[60:63], a[156:159]
    v_exp_f32 v253, v253
    v_mfma_f32_16x16x32_bf16 v[244:247], a[224:227], v[140:143], v[156:159]
    v_exp_f32 v254, v254
    v_mfma_f32_16x16x32_bf16 v[244:247], a[228:231], v[172:175], v[244:247]
    buffer_load_dwordx4 v1, s[36:39], s100 offen offset:3072 sc1 lds
    v_mfma_f32_16x16x32_bf16 v[244:247], a[232:235], v[204:207], v[244:247]
    v_exp_f32 v255, v255
    v_mfma_f32_16x16x32_bf16 v[244:247], a[236:239], v[236:239], v[244:247]
    s_cmp_eq_u32 s82, 163840
    s_cselect_b32 s82, 0, s82
    v_cvt_pk_bf16_f32 v90, v252, v253
    v_mfma_f32_16x16x32_bf16 a[168:171], v[104:107], v[48:51], a[168:171]
    v_cvt_pk_bf16_f32 v91, v254, v255
    v_add_u32 v2, s82, v1
    v_mfma_f32_16x16x32_bf16 a[168:171], v[108:111], v[52:55], a[168:171]
    v_exp_f32 v240, v240
    v_mfma_f32_16x16x32_bf16 a[172:175], v[104:107], v[56:59], a[172:175]
    s_add_u32 s77, s77, 32768
    v_exp_f32 v241, v241
    v_mfma_f32_16x16x32_bf16 a[172:175], v[108:111], v[60:63], a[172:175]
    s_waitcnt lgkmcnt(0)
    v_exp_f32 v242, v242
    v_mfma_f32_16x16x32_bf16 v[248:251], a[240:243], v[136:139], v[188:191]
    v_exp_f32 v243, v243
    v_mfma_f32_16x16x32_bf16 v[248:251], a[244:247], v[168:171], v[248:251]
    v_exp_f32 v244, v244
    v_mfma_f32_16x16x32_bf16 v[248:251], a[248:251], v[200:203], v[248:251]
    v_exp_f32 v245, v245
    v_mfma_f32_16x16x32_bf16 v[248:251], a[252:255], v[232:235], v[248:251]
    v_exp_f32 v246, v246
    v_mfma_f32_16x16x32_bf16 a[184:187], v[112:115], v[48:51], a[184:187]
    v_exp_f32 v247, v247
    v_mfma_f32_16x16x32_bf16 a[184:187], v[116:119], v[52:55], a[184:187]
    v_cvt_pk_bf16_f32 v84, v240, v241
    v_cvt_pk_bf16_f32 v85, v242, v243
    v_mfma_f32_16x16x32_bf16 a[188:191], v[112:115], v[56:59], a[188:191]
    v_cvt_pk_bf16_f32 v92, v244, v245
    v_cvt_pk_bf16_f32 v93, v246, v247
    v_mfma_f32_16x16x32_bf16 a[188:191], v[116:119], v[60:63], a[188:191]
    s_waitcnt vmcnt(16)
    s_barrier
    ds_read_b128 a[224:227], v2 offset:0
    v_mfma_f32_16x16x32_bf16 v[252:255], a[240:243], v[140:143], v[156:159]
    ds_read_b128 a[228:231], v2 offset:1024
    ds_read_b128 a[232:235], v2 offset:2048
    v_mfma_f32_16x16x32_bf16 v[252:255], a[244:247], v[172:175], v[252:255]
    v_exp_f32 v248, v248
    v_mfma_f32_16x16x32_bf16 v[252:255], a[248:251], v[204:207], v[252:255]
    ds_read_b128 a[236:239], v2 offset:3072
    ds_read_b128 v[96:99], v2 offset:16384
    v_mfma_f32_16x16x32_bf16 v[252:255], a[252:255], v[236:239], v[252:255]
    v_exp_f32 v249, v249
    v_mfma_f32_16x16x32_bf16 a[200:203], v[120:123], v[48:51], a[200:203]
    ds_read_b128 v[100:103], v2 offset:17408
    v_cvt_pk_bf16_f32 v86, v248, v249
    v_mfma_f32_16x16x32_bf16 a[200:203], v[124:127], v[52:55], a[200:203]
    v_exp_f32 v250, v250
    v_mfma_f32_16x16x32_bf16 a[204:207], v[120:123], v[56:59], a[204:207]
    v_exp_f32 v251, v251
    v_mfma_f32_16x16x32_bf16 a[204:207], v[124:127], v[60:63], a[204:207]
    v_exp_f32 v252, v252
    v_mfma_f32_16x16x32_bf16 a[216:219], a[136:139], v[48:51], a[216:219]
    v_exp_f32 v253, v253
    v_mfma_f32_16x16x32_bf16 a[216:219], a[136:139], v[52:55], a[216:219]
    v_cvt_pk_bf16_f32 v87, v250, v251
    v_cvt_pk_bf16_f32 v94, v252, v253
    v_mfma_f32_16x16x32_bf16 a[220:223], a[136:139], v[56:59], a[220:223]
    v_mfma_f32_16x16x32_bf16 a[220:223], a[136:139], v[60:63], a[220:223]
    s_cmp_eq_u32 s78, 1
    s_cbranch_scc1 K1_LS_MASK
K1_LS_BACK:
    s_waitcnt lgkmcnt(0)
    v_mfma_f32_16x16x32_bf16 v[240:243], a[224:227], v[136:139], v[176:179]
    s_add_u32 m0, s76, s75
    v_exp_f32 v254, v254
    v_mfma_f32_16x16x32_bf16 v[240:243], a[228:231], v[168:171], v[240:243]
    s_mov_b32 s76, s60
    v_exp_f32 v255, v255
    v_mfma_f32_16x16x32_bf16 v[240:243], a[232:235], v[200:203], v[240:243]
    s_mov_b32 s60, s82
    buffer_load_dwordx4 v1, s[36:39], s77 offen sc1 lds
    v_mfma_f32_16x16x32_bf16 v[240:243], a[236:239], v[232:235], v[240:243]
    s_add_u32 s82, s82, 32768
    ds_read_b128 v[104:107], v2 offset:18432
    v_cvt_pk_bf16_f32 v95, v254, v255
    v_mfma_f32_16x16x32_bf16 a[8:11], v[96:99], v[80:83], a[8:11]
    ds_read_b128 v[108:111], v2 offset:19456
    ds_read_b128 a[240:243], v2 offset:4096
    v_mfma_f32_16x16x32_bf16 a[8:11], v[100:103], v[84:87], a[8:11]
    ds_read_b128 a[244:247], v2 offset:5120
    v_mfma_f32_16x16x32_bf16 a[12:15], v[96:99], v[88:91], a[12:15]
    buffer_load_dwordx4 v1, s[36:39], s77 offen offset:1024 sc1 lds
    v_mfma_f32_16x16x32_bf16 a[12:15], v[100:103], v[92:95], a[12:15]
    ds_read_b128 a[248:251], v2 offset:6144
    ds_read_b128 a[252:255], v2 offset:7168
    v_mfma_f32_16x16x32_bf16 v[244:247], a[224:227], v[140:143], v[156:159]
    v_exp_f32 v240, v240
    v_mfma_f32_16x16x32_bf16 v[244:247], a[228:231], v[172:175], v[244:247]
    ds_read_b128 v[112:115], v2 offset:20480
    ds_read_b128 v[116:119], v2 offset:21504
    v_mfma_f32_16x16x32_bf16 v[244:247], a[232:235], v[204:207], v[244:247]
    v_exp_f32 v241, v241
    v_mfma_f32_16x16x32_bf16 v[244:247], a[236:239], v[236:239], v[244:247]
    s_waitcnt lgkmcnt(4)
    ds_read_b128 v[120:123], v2 offset:22528
    ds_read_b128 v[124:127], v2 offset:23552
    v_mfma_f32_16x16x32_bf16 a[24:27], v[104:107], v[80:83], a[24:27]
    buffer_load_dwordx4 v1, s[36:39], s77 offen offset:2048 sc1 lds
    v_mfma_f32_16x16x32_bf16 a[24:27], v[108:111], v[84:87], a[24:27]
    ds_read_b128 a[224:227], v2 offset:8192
    ds_read_b128 a[228:231], v2 offset:9216
    v_mfma_f32_16x16x32_bf16 a[28:31], v[104:107], v[88:91], a[28:31]
    ds_read_b128 a[232:235], v2 offset:10240
    v_cvt_pk_bf16_f32 v48, v240, v241
    v_mfma_f32_16x16x32_bf16 a[28:31], v[108:111], v[92:95], a[28:31]
    v_exp_f32 v242, v242
    v_mfma_f32_16x16x32_bf16 v[248:251], a[240:243], v[136:139], v[180:183]
    ds_read_b128 a[236:239], v2 offset:11264
    ds_read_b128 v[96:99], v2 offset:24576
    v_mfma_f32_16x16x32_bf16 v[248:251], a[244:247], v[168:171], v[248:251]
    s_waitcnt lgkmcnt(5)
    v_exp_f32 v243, v243
    v_mfma_f32_16x16x32_bf16 v[248:251], a[248:251], v[200:203], v[248:251]
    buffer_load_dwordx4 v1, s[36:39], s77 offen offset:3072 sc1 lds
    v_mfma_f32_16x16x32_bf16 v[248:251], a[252:255], v[232:235], v[248:251]
    ds_read_b128 v[100:103], v2 offset:25600
    v_cvt_pk_bf16_f32 v49, v242, v243
    v_mfma_f32_16x16x32_bf16 a[40:43], v[112:115], v[80:83], a[40:43]
    ds_read_b128 v[104:107], v2 offset:26624
    ds_read_b128 v[108:111], v2 offset:27648
    v_mfma_f32_16x16x32_bf16 a[40:43], v[116:119], v[84:87], a[40:43]
    v_exp_f32 v244, v244
    v_mfma_f32_16x16x32_bf16 a[44:47], v[112:115], v[88:91], a[44:47]
    v_exp_f32 v245, v245
    v_mfma_f32_16x16x32_bf16 a[44:47], v[116:119], v[92:95], a[44:47]
    s_add_u32 s100, s77, 4096
    v_exp_f32 v246, v246
    v_mfma_f32_16x16x32_bf16 v[252:255], a[240:243], v[140:143], v[156:159]
    s_add_u32 m0, m0, 4096
    v_exp_f32 v247, v247
    v_mfma_f32_16x16x32_bf16 v[252:255], a[244:247], v[172:175], v[252:255]
    buffer_load_dwordx4 v1, s[36:39], s100 offen sc1 lds
    v_mfma_f32_16x16x32_bf16 v[252:255], a[248:251], v[204:207], v[252:255]
    v_cvt_pk_bf16_f32 v56, v244, v245
    v_cvt_pk_bf16_f32 v57, v246, v247
    v_mfma_f32_16x16x32_bf16 v[252:255], a[252:255], v[236:239], v[252:255]
    ds_read_b128 a[240:243], v2 offset:12288
    ds_read_b128 a[244:247], v2 offset:13312
    v_mfma_f32_16x16x32_bf16 a[56:59], v[120:123], v[80:83], a[56:59]
    v_exp_f32 v248, v248
    v_mfma_f32_16x16x32_bf16 a[56:59], v[124:127], v[84:87], a[56:59]
    buffer_load_dwordx4 v1, s[36:39], s100 offen offset:1024 sc1 lds
    v_mfma_f32_16x16x32_bf16 a[60:63], v[120:123], v[88:91], a[60:63]
    ds_read_b128 a[248:251], v2 offset:14336
    ds_read_b128 a[252:255], v2 offset:15360
    v_mfma_f32_16x16x32_bf16 a[60:63], v[124:127], v[92:95], a[60:63]
    s_waitcnt lgkmcnt(4)
    v_exp_f32 v249, v249
    v_mfma_f32_16x16x32_bf16 v[240:243], a[224:227], v[136:139], v[184:187]
    ds_read_b128 v[112:115], v2 offset:28672
    ds_read_b128 v[116:119], v2 offset:29696
    v_mfma_f32_16x16x32_bf16 v[240:243], a[228:231], v[168:171], v[240:243]
    v_exp_f32 v250, v250
    v_mfma_f32_16x16x32_bf16 v[240:243], a[232:235], v[200:203], v[240:243]
    v_exp_f32 v251, v251
    v_mfma_f32_16x16x32_bf16 v[240:243], a[236:239], v[232:235], v[240:243]
    buffer_load_dwordx4 v1, s[36:39], s100 offen offset:2048 sc1 lds
    v_mfma_f32_16x16x32_bf16 a[152:155], v[96:99], v[80:83], a[152:155]
    v_cvt_pk_bf16_f32 v50, v248, v249
    v_cvt_pk_bf16_f32 v51, v250, v251
    v_mfma_f32_16x16x32_bf16 a[152:155], v[100:103], v[84:87], a[152:155]
    ds_read_b128 v[120:123], v2 offset:30720
    ds_read_b128 v[124:127], v2 offset:31744
    v_mfma_f32_16x16x32_bf16 a[156:159], v[96:99], v[88:91], a[156:159]
    v_exp_f32 v252, v252
    v_mfma_f32_16x16x32_bf16 a[156:159], v[100:103], v[92:95], a[156:159]
    v_exp_f32 v253, v253
    v_mfma_f32_16x16x32_bf16 v[244:247], a[224:227], v[140:143], v[156:159]
    v_exp_f32 v254, v254
    v_mfma_f32_16x16x32_bf16 v[244:247], a[228:231], v[172:175], v[244:247]
    buffer_load_dwordx4 v1, s[36:39], s100 offen offset:3072 sc1 lds
    v_mfma_f32_16x16x32_bf16 v[244:247], a[232:235], v[204:207], v[244:247]
    v_exp_f32 v255, v255
    v_mfma_f32_16x16x32_bf16 v[244:247], a[236:239], v[236:239], v[244:247]
    s_cmp_eq_u32 s82, 163840
    s_cselect_b32 s82, 0, s82
    v_cvt_pk_bf16_f32 v58, v252, v253
    v_mfma_f32_16x16x32_bf16 a[168:171], v[104:107], v[80:83], a[168:171]
    v_cvt_pk_bf16_f32 v59, v254, v255
    v_add_u32 v2, s82, v1
    v_mfma_f32_16x16x32_bf16 a[168:171], v[108:111], v[84:87], a[168:171]
    v_exp_f32 v240, v240
    v_mfma_f32_16x16x32_bf16 a[172:175], v[104:107], v[88:91], a[172:175]
    s_add_u32 s77, s77, 32768
    v_exp_f32 v241, v241
    v_mfma_f32_16x16x32_bf16 a[172:175], v[108:111], v[92:95], a[172:175]
    s_waitcnt lgkmcnt(0)
    v_exp_f32 v242, v242
    v_mfma_f32_16x16x32_bf16 v[248:251], a[240:243], v[136:139], v[188:191]
    v_exp_f32 v243, v243
    v_mfma_f32_16x16x32_bf16 v[248:251], a[244:247], v[168:171], v[248:251]
    v_exp_f32 v244, v244
    v_mfma_f32_16x16x32_bf16 v[248:251], a[248:251], v[200:203], v[248:251]
    v_exp_f32 v245, v245
    v_mfma_f32_16x16x32_bf16 v[248:251], a[252:255], v[232:235], v[248:251]
    v_exp_f32 v246, v246
    v_mfma_f32_16x16x32_bf16 a[184:187], v[112:115], v[80:83], a[184:187]
    v_exp_f32 v247, v247
    v_mfma_f32_16x16x32_bf16 a[184:187], v[116:119], v[84:87], a[184:187]
    v_cvt_pk_bf16_f32 v52, v240, v241
    v_cvt_pk_bf16_f32 v53, v242, v243
    v_mfma_f32_16x16x32_bf16 a[188:191], v[112:115], v[88:91], a[188:191]
    v_cvt_pk_bf16_f32 v60, v244, v245
    v_cvt_pk_bf16_f32 v61, v246, v247
    v_mfma_f32_16x16x32_bf16 a[188:191], v[116:119], v[92:95], a[188:191]
    s_waitcnt vmcnt(16)
    s_barrier
    ds_read_b128 a[224:227], v2 offset:0
    v_mfma_f32_16x16x32_bf16 v[252:255], a[240:243], v[140:143], v[156:159]
    ds_read_b128 a[228:231], v2 offset:1024
    ds_read_b128 a[232:235], v2 offset:2048
    v_mfma_f32_16x16x32_bf16 v[252:255], a[244:247], v[172:175], v[252:255]
    v_exp_f32 v248, v248
    v_mfma_f32_16x16x32_bf16 v[252:255], a[248:251], v[204:207], v[252:255]
    ds_read_b128 a[236:239], v2 offset:3072
    ds_read_b128 v[96:99], v2 offset:16384
    v_mfma_f32_16x16x32_bf16 v[252:255], a[252:255], v[236:239], v[252:255]
    v_exp_f32 v249, v249
    v_mfma_f32_16x16x32_bf16 a[200:203], v[120:123], v[80:83], a[200:203]
    ds_read_b128 v[100:103], v2 offset:17408
    v_cvt_pk_bf16_f32 v54, v248, v249
    v_mfma_f32_16x16x32_bf16 a[200:203], v[124:127], v[84:87], a[200:203]
    v_exp_f32 v250, v250
    v_mfma_f32_16x16x32_bf16 a[204:207], v[120:123], v[88:91], a[204:207]
    v_exp_f32 v251, v251
    v_mfma_f32_16x16x32_bf16 a[204:207], v[124:127], v[92:95], a[204:207]
    v_exp_f32 v252, v252
    v_mfma_f32_16x16x32_bf16 a[216:219], a[136:139], v[80:83], a[216:219]
    v_exp_f32 v253, v253
    v_mfma_f32_16x16x32_bf16 a[216:219], a[136:139], v[84:87], a[216:219]
    v_cvt_pk_bf16_f32 v55, v250, v251
    v_cvt_pk_bf16_f32 v62, v252, v253
    v_mfma_f32_16x16x32_bf16 a[220:223], a[136:139], v[88:91], a[220:223]
    v_mfma_f32_16x16x32_bf16 a[220:223], a[136:139], v[92:95], a[220:223]
    s_sub_u32 s78, s78, 1
    s_cmp_lg_u32 s78, 0
    s_cbranch_scc1 K1_LS
K1_LS_END:
    v_add_f32 v212, s12, v156
    v_fma_f32 v176, v208, s8, v212
    v_fma_f32 v177, v209, s8, v212
    v_fma_f32 v178, v210, s8, v212
    v_fma_f32 v179, v211, s8, v212
    s_nop 1
    s_waitcnt lgkmcnt(0)
    v_mfma_f32_16x16x32_bf16 v[240:243], a[224:227], v[140:143], v[176:179]
    s_mov_b32 s76, s60
    ds_read_b128 v[104:107], v2 offset:18432
    ds_read_b128 v[108:111], v2 offset:19456
    v_mfma_f32_16x16x32_bf16 v[240:243], a[228:231], v[172:175], v[240:243]
    s_mov_b32 s60, s82
    v_lshrrev_b32 v29, 2, v1
    ds_read_b128 a[240:243], v2 offset:4096
    v_mfma_f32_16x16x32_bf16 v[240:243], a[232:235], v[204:207], v[240:243]
    s_add_u32 s82, s82, 32768
    v_exp_f32 v254, v254
    v_mfma_f32_16x16x32_bf16 v[240:243], a[236:239], v[236:239], v[240:243]
    v_exp_f32 v255, v255
    v_mfma_f32_16x16x32_bf16 a[8:11], v[96:99], v[48:51], a[8:11]
    buffer_load_dword v3, v29, s[44:47], 0 offen sc1
    v_mfma_f32_16x16x32_bf16 a[8:11], v[100:103], v[52:55], a[8:11]
    v_cvt_pk_bf16_f32 v63, v254, v255
    ds_read_b128 a[244:247], v2 offset:5120
    v_mfma_f32_16x16x32_bf16 a[12:15], v[96:99], v[56:59], a[12:15]
    ds_read_b128 a[248:251], v2 offset:6144
    ds_read_b128 a[252:255], v2 offset:7168
    v_mfma_f32_16x16x32_bf16 a[12:15], v[100:103], v[60:63], a[12:15]
    s_waitcnt lgkmcnt(3)
    ds_read_b128 v[112:115], v2 offset:20480
    v_add_f32 v213, s13, v156
    v_mfma_f32_16x16x32_bf16 a[24:27], v[104:107], v[48:51], a[24:27]
    ds_read_b128 v[116:119], v2 offset:21504
    v_fma_f32 v180, v208, s9, v213
    v_mfma_f32_16x16x32_bf16 a[24:27], v[108:111], v[52:55], a[24:27]
    v_fma_f32 v181, v209, s9, v213
    v_fma_f32 v182, v210, s9, v213
    v_mfma_f32_16x16x32_bf16 a[28:31], v[104:107], v[56:59], a[28:31]
    v_fma_f32 v183, v211, s9, v213
    ds_read_b128 v[120:123], v2 offset:22528
    v_mfma_f32_16x16x32_bf16 a[28:31], v[108:111], v[60:63], a[28:31]
    ds_read_b128 v[124:127], v2 offset:23552
    ds_read_b128 a[224:227], v2 offset:8192
    v_mfma_f32_16x16x32_bf16 v[244:247], a[240:243], v[140:143], v[180:183]
    s_waitcnt lgkmcnt(4)
    ds_read_b128 a[228:231], v2 offset:9216
    v_add_f32 v214, s14, v156
    v_mfma_f32_16x16x32_bf16 v[244:247], a[244:247], v[172:175], v[244:247]
    ds_read_b128 a[232:235], v2 offset:10240
    v_fma_f32 v184, v208, s10, v214
    v_mfma_f32_16x16x32_bf16 v[244:247], a[248:251], v[204:207], v[244:247]
    ds_read_b128 a[236:239], v2 offset:11264
    v_fma_f32 v185, v209, s10, v214
    v_mfma_f32_16x16x32_bf16 v[244:247], a[252:255], v[236:239], v[244:247]
    ds_read_b128 v[96:99], v2 offset:24576
    v_fma_f32 v186, v210, s10, v214
    v_mfma_f32_16x16x32_bf16 a[40:43], v[112:115], v[48:51], a[40:43]
    s_waitcnt lgkmcnt(4)
    ds_read_b128 v[100:103], v2 offset:25600
    v_fma_f32 v187, v211, s10, v214
    v_mfma_f32_16x16x32_bf16 a[40:43], v[116:119], v[52:55], a[40:43]
    ds_read_b128 v[104:107], v2 offset:26624
    v_add_f32 v215, s15, v156
    v_mfma_f32_16x16x32_bf16 a[44:47], v[112:115], v[56:59], a[44:47]
    ds_read_b128 v[108:111], v2 offset:27648
    v_fma_f32 v188, v208, s11, v215
    v_mfma_f32_16x16x32_bf16 a[44:47], v[116:119], v[60:63], a[44:47]
    ds_read_b128 a[240:243], v2 offset:12288
    v_fma_f32 v189, v209, s11, v215
    v_mfma_f32_16x16x32_bf16 a[56:59], v[120:123], v[48:51], a[56:59]
    ds_read_b128 a[244:247], v2 offset:13312
    v_fma_f32 v190, v210, s11, v215
    v_mfma_f32_16x16x32_bf16 a[56:59], v[124:127], v[52:55], a[56:59]
    ds_read_b128 a[248:251], v2 offset:14336
    v_fma_f32 v191, v211, s11, v215
    v_mfma_f32_16x16x32_bf16 a[60:63], v[120:123], v[56:59], a[60:63]
    v_exp_f32 v240, v240
    v_mfma_f32_16x16x32_bf16 a[60:63], v[124:127], v[60:63], a[60:63]
    ds_read_b128 a[252:255], v2 offset:15360
    ds_read_b128 v[112:115], v2 offset:28672
    v_mfma_f32_16x16x32_bf16 v[248:251], a[224:227], v[140:143], v[184:187]
    s_waitcnt lgkmcnt(4)
    v_exp_f32 v241, v241
    v_mfma_f32_16x16x32_bf16 v[248:251], a[228:231], v[172:175], v[248:251]
    ds_read_b128 v[116:119], v2 offset:29696
    ds_read_b128 v[120:123], v2 offset:30720
    v_mfma_f32_16x16x32_bf16 v[248:251], a[232:235], v[204:207], v[248:251]
    ds_read_b128 v[124:127], v2 offset:31744
    v_cvt_pk_bf16_f32 v88, v240, v241
    v_mfma_f32_16x16x32_bf16 v[248:251], a[236:239], v[236:239], v[248:251]
    s_cmp_eq_u32 s82, 163840
    s_cselect_b32 s82, 0, s82
    v_add_u32 v2, s82, v1
    v_mfma_f32_16x16x32_bf16 a[152:155], v[96:99], v[48:51], a[152:155]
    v_exp_f32 v242, v242
    v_mfma_f32_16x16x32_bf16 a[152:155], v[100:103], v[52:55], a[152:155]
    v_exp_f32 v243, v243
    v_mfma_f32_16x16x32_bf16 a[156:159], v[96:99], v[56:59], a[156:159]
    v_exp_f32 v244, v244
    v_mfma_f32_16x16x32_bf16 a[156:159], v[100:103], v[60:63], a[156:159]
    v_exp_f32 v245, v245
    v_mfma_f32_16x16x32_bf16 a[168:171], v[104:107], v[48:51], a[168:171]
    v_exp_f32 v246, v246
    v_mfma_f32_16x16x32_bf16 a[168:171], v[108:111], v[52:55], a[168:171]
    v_exp_f32 v247, v247
    v_mfma_f32_16x16x32_bf16 a[172:175], v[104:107], v[56:59], a[172:175]
    v_exp_f32 v248, v248
    v_mfma_f32_16x16x32_bf16 a[172:175], v[108:111], v[60:63], a[172:175]
    v_exp_f32 v249, v249
    v_mfma_f32_16x16x32_bf16 v[252:255], a[240:243], v[140:143], v[188:191]
    s_waitcnt lgkmcnt(0)
    v_exp_f32 v250, v250
    v_mfma_f32_16x16x32_bf16 v[252:255], a[244:247], v[172:175], v[252:255]
    v_exp_f32 v251, v251
    v_mfma_f32_16x16x32_bf16 v[252:255], a[248:251], v[204:207], v[252:255]
    v_cvt_pk_bf16_f32 v89, v242, v243
    v_cvt_pk_bf16_f32 v90, v244, v245
    v_mfma_f32_16x16x32_bf16 v[252:255], a[252:255], v[236:239], v[252:255]
    s_waitcnt vmcnt(8)
    s_barrier
    ds_read_b128 a[224:227], v2 offset:0
    v_mfma_f32_16x16x32_bf16 a[184:187], v[112:115], v[48:51], a[184:187]
    ds_read_b128 a[228:231], v2 offset:1024
    ds_read_b128 a[232:235], v2 offset:2048
    v_mfma_f32_16x16x32_bf16 a[184:187], v[116:119], v[52:55], a[184:187]
    ds_read_b128 a[236:239], v2 offset:3072
    v_cvt_pk_bf16_f32 v91, v246, v247
    v_mfma_f32_16x16x32_bf16 a[188:191], v[112:115], v[56:59], a[188:191]
    ds_read_b128 v[96:99], v2 offset:16384
    v_cvt_pk_bf16_f32 v92, v248, v249
    v_mfma_f32_16x16x32_bf16 a[188:191], v[116:119], v[60:63], a[188:191]
    ds_read_b128 v[100:103], v2 offset:17408
    v_cvt_pk_bf16_f32 v93, v250, v251
    v_mfma_f32_16x16x32_bf16 a[200:203], v[120:123], v[48:51], a[200:203]
    v_exp_f32 v252, v252
    v_mfma_f32_16x16x32_bf16 a[200:203], v[124:127], v[52:55], a[200:203]
    v_exp_f32 v253, v253
    v_mfma_f32_16x16x32_bf16 a[204:207], v[120:123], v[56:59], a[204:207]
    v_cvt_pk_bf16_f32 v94, v252, v253
    v_mfma_f32_16x16x32_bf16 a[204:207], v[124:127], v[60:63], a[204:207]
    v_mfma_f32_16x16x32_bf16 a[216:219], a[136:139], v[48:51], a[216:219]
    v_mfma_f32_16x16x32_bf16 a[216:219], a[136:139], v[52:55], a[216:219]
    v_mfma_f32_16x16x32_bf16 a[220:223], a[136:139], v[56:59], a[220:223]
    v_mfma_f32_16x16x32_bf16 a[220:223], a[136:139], v[60:63], a[220:223]
    ds_read_b128 v[104:107], v2 offset:18432
    ds_read_b128 v[108:111], v2 offset:19456
    ds_read_b128 v[112:115], v2 offset:20480
    ds_read_b128 v[116:119], v2 offset:21504
    ds_read_b128 v[120:123], v2 offset:22528
    ds_read_b128 v[124:127], v2 offset:23552
    s_waitcnt lgkmcnt(6)
    v_mfma_f32_16x16x32_bf16 a[12:15], v[96:99], v[88:91], a[12:15]
    v_exp_f32 v254, v254
    v_exp_f32 v255, v255
    s_nop 0
    v_cvt_pk_bf16_f32 v95, v254, v255
    s_nop 1
    v_mfma_f32_16x16x32_bf16 a[12:15], v[100:103], v[92:95], a[12:15]
    s_waitcnt lgkmcnt(5)
    ds_read_b128 v[96:99], v2 offset:24576
    ds_read_b128 v[100:103], v2 offset:25600
    v_mfma_f32_16x16x32_bf16 a[28:31], v[104:107], v[88:91], a[28:31]
    s_waitcnt lgkmcnt(6)
    ds_read_b128 v[104:107], v2 offset:26624
    v_mfma_f32_16x16x32_bf16 a[28:31], v[108:111], v[92:95], a[28:31]
    s_waitcnt lgkmcnt(6)
    ds_read_b128 v[108:111], v2 offset:27648
    v_mfma_f32_16x16x32_bf16 a[44:47], v[112:115], v[88:91], a[44:47]
    s_waitcnt lgkmcnt(4)
    ds_read_b128 v[112:115], v2 offset:28672
    v_mfma_f32_16x16x32_bf16 a[44:47], v[116:119], v[92:95], a[44:47]
    ds_read_b128 v[116:119], v2 offset:29696
    v_mfma_f32_16x16x32_bf16 a[60:63], v[120:123], v[88:91], a[60:63]
    ds_read_b128 v[120:123], v2 offset:30720
    v_mfma_f32_16x16x32_bf16 a[60:63], v[124:127], v[92:95], a[60:63]
    s_waitcnt lgkmcnt(4)
    ds_read_b128 v[124:127], v2 offset:31744
    v_mfma_f32_16x16x32_bf16 a[156:159], v[96:99], v[88:91], a[156:159]
    v_mfma_f32_16x16x32_bf16 a[156:159], v[100:103], v[92:95], a[156:159]
    v_mfma_f32_16x16x32_bf16 a[172:175], v[104:107], v[88:91], a[172:175]
    s_waitcnt lgkmcnt(2)
    v_mfma_f32_16x16x32_bf16 a[172:175], v[108:111], v[92:95], a[172:175]
    v_mfma_f32_16x16x32_bf16 a[188:191], v[112:115], v[88:91], a[188:191]
    v_mfma_f32_16x16x32_bf16 a[188:191], v[116:119], v[92:95], a[188:191]
    s_waitcnt lgkmcnt(0)
    v_mfma_f32_16x16x32_bf16 a[204:207], v[120:123], v[88:91], a[204:207]
    v_mfma_f32_16x16x32_bf16 a[204:207], v[124:127], v[92:95], a[204:207]
    v_mfma_f32_16x16x32_bf16 a[220:223], a[136:139], v[88:91], a[220:223]
    v_mfma_f32_16x16x32_bf16 a[220:223], a[136:139], v[92:95], a[220:223]
    s_waitcnt vmcnt(0) lgkmcnt(0)
    s_barrier
    s_lshr_b32 s61, s5, 3
    s_and_b32 s98, s5, 3
    s_add_u32 s20, s98, 32
    s_lshl_b32 s20, s20, 10
    s_mul_i32 s78, s4, 7168
    s_add_u32 s3, s5, s6
    s_and_b32 s3, s3, 3
    s_lshl3_add_u32 s3, s61, s3
    s_add_u32 s99, s61, 0
    s_and_b32 s99, s99, 3
    s_lshl2_add_u32 s99, s99, s98
    s_lshl_b32 s16, s99, 11
    s_add_u32 s99, s61, 1
    s_and_b32 s99, s99, 3
    s_lshl2_add_u32 s99, s99, s98
    s_lshl_b32 s17, s99, 11
    s_add_u32 s99, s61, 2
    s_and_b32 s99, s99, 3
    s_lshl2_add_u32 s99, s99, s98
    s_lshl_b32 s18, s99, 11
    s_add_u32 s99, s61, 3
    s_and_b32 s99, s99, 3
    s_lshl2_add_u32 s99, s99, s98
    s_lshl_b32 s19, s99, 11
    v_cmp_gt_u32 vcc, 16, v3
    s_nop 1
    s_and_b64 vcc, vcc, s[92:93]
    s_cbranch_scc1 SPIN_ALL
BACK_ALL:
    v_accvgpr_read_b32 v8, a216
    v_cmp_nge_f32 vcc, 0x71800000, v8
    v_rcp_f32 v10, v8
    s_nop 0
    s_or_b64 s[84:85], s[84:85], vcc
    v_mul_f32 v10, v10, v6
    v_accvgpr_read_b32 v12, a8
    v_accvgpr_read_b32 v13, a9
    v_accvgpr_read_b32 v14, a10
    v_accvgpr_read_b32 v15, a11
    v_accvgpr_read_b32 v16, a24
    v_accvgpr_read_b32 v17, a25
    v_accvgpr_read_b32 v18, a26
    v_accvgpr_read_b32 v19, a27
    v_pk_mul_f32 v[12:13], v[12:13], v[10:11] op_sel_hi:[1,0]
    v_pk_mul_f32 v[14:15], v[14:15], v[10:11] op_sel_hi:[1,0]
    v_pk_mul_f32 v[16:17], v[16:17], v[10:11] op_sel_hi:[1,0]
    v_pk_mul_f32 v[18:19], v[18:19], v[10:11] op_sel_hi:[1,0]
    v_cvt_pk_bf16_f32 v12, v12, v13
    v_cvt_pk_bf16_f32 v13, v14, v15
    v_cvt_pk_bf16_f32 v14, v16, v17
    v_cvt_pk_bf16_f32 v15, v18, v19
    buffer_store_dwordx4 v[12:15], v1, s[40:43], s81 offen offset:0 sc1
    v_accvgpr_read_b32 v20, a40
    v_accvgpr_read_b32 v21, a41
    v_accvgpr_read_b32 v22, a42
    v_accvgpr_read_b32 v23, a43
    v_accvgpr_read_b32 v24, a56
    v_accvgpr_read_b32 v25, a57
    v_accvgpr_read_b32 v26, a58
    v_accvgpr_read_b32 v27, a59
    v_pk_mul_f32 v[20:21], v[20:21], v[10:11] op_sel_hi:[1,0]
    v_pk_mul_f32 v[22:23], v[22:23], v[10:11] op_sel_hi:[1,0]
    v_pk_mul_f32 v[24:25], v[24:25], v[10:11] op_sel_hi:[1,0]
    v_pk_mul_f32 v[26:27], v[26:27], v[10:11] op_sel_hi:[1,0]
    v_cvt_pk_bf16_f32 v20, v20, v21
    v_cvt_pk_bf16_f32 v21, v22, v23
    v_cvt_pk_bf16_f32 v22, v24, v25
    v_cvt_pk_bf16_f32 v23, v26, v27
    buffer_store_dwordx4 v[20:23], v1, s[40:43], s81 offen offset:1024 sc1
    v_accvgpr_read_b32 v12, a152
    v_accvgpr_read_b32 v13, a153
    v_accvgpr_read_b32 v14, a154
    v_accvgpr_read_b32 v15, a155
    v_accvgpr_read_b32 v16, a168
    v_accvgpr_read_b32 v17, a169
    v_accvgpr_read_b32 v18, a170
    v_accvgpr_read_b32 v19, a171
    v_pk_mul_f32 v[12:13], v[12:13], v[10:11] op_sel_hi:[1,0]
    v_pk_mul_f32 v[14:15], v[14:15], v[10:11] op_sel_hi:[1,0]
    v_pk_mul_f32 v[16:17], v[16:17], v[10:11] op_sel_hi:[1,0]
    v_pk_mul_f32 v[18:19], v[18:19], v[10:11] op_sel_hi:[1,0]
    v_cvt_pk_bf16_f32 v12, v12, v13
    v_cvt_pk_bf16_f32 v13, v14, v15
    v_cvt_pk_bf16_f32 v14, v16, v17
    v_cvt_pk_bf16_f32 v15, v18, v19
    buffer_store_dwordx4 v[12:15], v1, s[40:43], s81 offen offset:2048 sc1
    v_accvgpr_read_b32 v20, a184
    v_accvgpr_read_b32 v21, a185
    v_accvgpr_read_b32 v22, a186
    v_accvgpr_read_b32 v23, a187
    v_accvgpr_read_b32 v24, a200
    v_accvgpr_read_b32 v25, a201
    v_accvgpr_read_b32 v26, a202
    v_accvgpr_read_b32 v27, a203
    v_pk_mul_f32 v[20:21], v[20:21], v[10:11] op_sel_hi:[1,0]
    v_pk_mul_f32 v[22:23], v[22:23], v[10:11] op_sel_hi:[1,0]
    v_pk_mul_f32 v[24:25], v[24:25], v[10:11] op_sel_hi:[1,0]
    v_pk_mul_f32 v[26:27], v[26:27], v[10:11] op_sel_hi:[1,0]
    v_cvt_pk_bf16_f32 v20, v20, v21
    v_cvt_pk_bf16_f32 v21, v22, v23
    v_cvt_pk_bf16_f32 v22, v24, v25
    v_cvt_pk_bf16_f32 v23, v26, v27
    buffer_store_dwordx4 v[20:23], v1, s[40:43], s81 offen offset:3072 sc1
    v_accvgpr_read_b32 v8, a220
    v_cmp_nge_f32 vcc, 0x71800000, v8
    v_rcp_f32 v10, v8
    s_nop 0
    s_or_b64 s[84:85], s[84:85], vcc
    v_mul_f32 v10, v10, v7
    s_add_u32 s72, s81, 622592
    v_accvgpr_read_b32 v12, a12
    v_accvgpr_read_b32 v13, a13
    v_accvgpr_read_b32 v14, a14
    v_accvgpr_read_b32 v15, a15
    v_accvgpr_read_b32 v16, a28
    v_accvgpr_read_b32 v17, a29
    v_accvgpr_read_b32 v18, a30
    v_accvgpr_read_b32 v19, a31
    v_pk_mul_f32 v[12:13], v[12:13], v[10:11] op_sel_hi:[1,0]
    v_pk_mul_f32 v[14:15], v[14:15], v[10:11] op_sel_hi:[1,0]
    v_pk_mul_f32 v[16:17], v[16:17], v[10:11] op_sel_hi:[1,0]
    v_pk_mul_f32 v[18:19], v[18:19], v[10:11] op_sel_hi:[1,0]
    v_cvt_pk_bf16_f32 v12, v12, v13
    v_cvt_pk_bf16_f32 v13, v14, v15
    v_cvt_pk_bf16_f32 v14, v16, v17
    v_cvt_pk_bf16_f32 v15, v18, v19
    buffer_store_dwordx4 v[12:15], v1, s[40:43], s72 offen offset:0 sc1
    v_accvgpr_read_b32 v20, a44
    v_accvgpr_read_b32 v21, a45
    v_accvgpr_read_b32 v22, a46
    v_accvgpr_read_b32 v23, a47
    v_accvgpr_read_b32 v24, a60
    v_accvgpr_read_b32 v25, a61
    v_accvgpr_read_b32 v26, a62
    v_accvgpr_read_b32 v27, a63
    v_pk_mul_f32 v[20:21], v[20:21], v[10:11] op_sel_hi:[1,0]
    v_pk_mul_f32 v[22:23], v[22:23], v[10:11] op_sel_hi:[1,0]
    v_pk_mul_f32 v[24:25], v[24:25], v[10:11] op_sel_hi:[1,0]
    v_pk_mul_f32 v[26:27], v[26:27], v[10:11] op_sel_hi:[1,0]
    v_cvt_pk_bf16_f32 v20, v20, v21
    v_cvt_pk_bf16_f32 v21, v22, v23
    v_cvt_pk_bf16_f32 v22, v24, v25
    v_cvt_pk_bf16_f32 v23, v26, v27
    buffer_store_dwordx4 v[20:23], v1, s[40:43], s72 offen offset:1024 sc1
    v_accvgpr_read_b32 v12, a156
    v_accvgpr_read_b32 v13, a157
    v_accvgpr_read_b32 v14, a158
    v_accvgpr_read_b32 v15, a159
    v_accvgpr_read_b32 v16, a172
    v_accvgpr_read_b32 v17, a173
    v_accvgpr_read_b32 v18, a174
    v_accvgpr_read_b32 v19, a175
    v_pk_mul_f32 v[12:13], v[12:13], v[10:11] op_sel_hi:[1,0]
    v_pk_mul_f32 v[14:15], v[14:15], v[10:11] op_sel_hi:[1,0]
    v_pk_mul_f32 v[16:17], v[16:17], v[10:11] op_sel_hi:[1,0]
    v_pk_mul_f32 v[18:19], v[18:19], v[10:11] op_sel_hi:[1,0]
    v_cvt_pk_bf16_f32 v12, v12, v13
    v_cvt_pk_bf16_f32 v13, v14, v15
    v_cvt_pk_bf16_f32 v14, v16, v17
    v_cvt_pk_bf16_f32 v15, v18, v19
    buffer_store_dwordx4 v[12:15], v1, s[40:43], s72 offen offset:2048 sc1
    v_accvgpr_read_b32 v20, a188
    v_accvgpr_read_b32 v21, a189
    v_accvgpr_read_b32 v22, a190
    v_accvgpr_read_b32 v23, a191
    v_accvgpr_read_b32 v24, a204
    v_accvgpr_read_b32 v25, a205
    v_accvgpr_read_b32 v26, a206
    v_accvgpr_read_b32 v27, a207
    v_pk_mul_f32 v[20:21], v[20:21], v[10:11] op_sel_hi:[1,0]
    v_pk_mul_f32 v[22:23], v[22:23], v[10:11] op_sel_hi:[1,0]
    v_pk_mul_f32 v[24:25], v[24:25], v[10:11] op_sel_hi:[1,0]
    v_pk_mul_f32 v[26:27], v[26:27], v[10:11] op_sel_hi:[1,0]
    v_cvt_pk_bf16_f32 v20, v20, v21
    v_cvt_pk_bf16_f32 v21, v22, v23
    v_cvt_pk_bf16_f32 v22, v24, v25
    v_cvt_pk_bf16_f32 v23, v26, v27
    buffer_store_dwordx4 v[20:23], v1, s[40:43], s72 offen offset:3072 sc1
    s_xor_b32 s21, s3, 0
    s_lshl2_add_u32 s21, s21, s4
    s_mul_i32 s21, s21, 36864
    s_add_u32 s64, s21, s17
    s_add_u32 m0, s78, 0
    s_nop 0
    buffer_load_dwordx4 v1, s[56:59], s64 offen sc1 lds
    s_mov_b32 s79, 114688
    v_bfe_u32 v20, v1, 4, 4
    v_lshrrev_b32 v21, 8, v1
    s_lshl_b32 s98, s4, 4
    s_add_u32 s98, s98, 16
    v_add_u32 v22, s98, v20
    v_mul_u32_u24 v22, 144, v22
    v_add_u32 v22, s79, v22
    v_lshl_add_u32 v9, v21, 3, v22
    s_lshr_b32 s98, s73, 1
    v_add_u32 v8, s98, v9
    v_subrev_u32 v10, s98, v9
    s_and_b32 s99, s4, 1
    s_mul_i32 s99, s99, 20736
    s_add_u32 s99, s99, s79
    v_mul_u32_u24 v23, 144, v20
    v_lshl_add_u32 v23, v21, 3, v23
    v_add_u32 v13, s99, v23
    v_add_u32 v12, s98, v13
    v_accvgpr_read_b32 v32, a64
    v_accvgpr_read_b32 v33, a65
    v_accvgpr_read_b32 v34, a66
    buffer_load_dwordx4 v1, s[56:59], s64 offen offset:1024 sc1 lds
    v_accvgpr_read_b32 v35, a67
    v_cvt_pk_bf16_f32 v32, v32, v33
    v_cvt_pk_bf16_f32 v33, v34, v35
    ds_write_b64 v8, v[32:33] offset:0
    v_accvgpr_read_b32 v36, a68
    v_accvgpr_read_b32 v37, a69
    v_accvgpr_read_b32 v38, a70
    v_accvgpr_read_b32 v39, a71
    v_cvt_pk_bf16_f32 v36, v36, v37
    v_cvt_pk_bf16_f32 v37, v38, v39
    ds_write_b64 v8, v[36:37] offset:9216
    v_accvgpr_read_b32 v40, a72
    v_accvgpr_read_b32 v41, a73
    v_accvgpr_read_b32 v42, a74
    v_accvgpr_read_b32 v43, a75
    v_cvt_pk_bf16_f32 v40, v40, v41
    v_cvt_pk_bf16_f32 v41, v42, v43
    ds_write_b64 v8, v[40:41] offset:20736
    v_accvgpr_read_b32 v44, a76
    v_accvgpr_read_b32 v45, a77
    v_accvgpr_read_b32 v46, a78
    v_accvgpr_read_b32 v47, a79
    s_add_u32 s64, s21, s18
    s_add_u32 m0, s78, 2048
    s_nop 0
    buffer_load_dwordx4 v1, s[56:59], s64 offen sc1 lds
    v_cvt_pk_bf16_f32 v44, v44, v45
    v_cvt_pk_bf16_f32 v45, v46, v47
    ds_write_b64 v8, v[44:45] offset:29952
    v_accvgpr_read_b32 v32, a80
    v_accvgpr_read_b32 v33, a81
    v_accvgpr_read_b32 v34, a82
    v_accvgpr_read_b32 v35, a83
    v_cvt_pk_bf16_f32 v32, v32, v33
    v_cvt_pk_bf16_f32 v33, v34, v35
    ds_write_b64 v9, v[32:33] offset:32
    v_accvgpr_read_b32 v36, a84
    v_accvgpr_read_b32 v37, a85
    v_accvgpr_read_b32 v38, a86
    v_accvgpr_read_b32 v39, a87
    v_cvt_pk_bf16_f32 v36, v36, v37
    v_cvt_pk_bf16_f32 v37, v38, v39
    ds_write_b64 v9, v[36:37] offset:9248
    v_accvgpr_read_b32 v40, a88
    v_accvgpr_read_b32 v41, a89
    v_accvgpr_read_b32 v42, a90
    v_accvgpr_read_b32 v43, a91
    v_cvt_pk_bf16_f32 v40, v40, v41
    buffer_load_dwordx4 v1, s[56:59], s64 offen offset:1024 sc1 lds
    v_cvt_pk_bf16_f32 v41, v42, v43
    ds_write_b64 v9, v[40:41] offset:20768
    v_accvgpr_read_b32 v44, a92
    v_accvgpr_read_b32 v45, a93
    v_accvgpr_read_b32 v46, a94
    v_accvgpr_read_b32 v47, a95
    v_cvt_pk_bf16_f32 v44, v44, v45
    v_cvt_pk_bf16_f32 v45, v46, v47
    ds_write_b64 v9, v[44:45] offset:29984
    v_accvgpr_read_b32 v32, a96
    v_accvgpr_read_b32 v33, a97
    v_accvgpr_read_b32 v34, a98
    v_accvgpr_read_b32 v35, a99
    v_cvt_pk_bf16_f32 v32, v32, v33
    v_cvt_pk_bf16_f32 v33, v34, v35
    ds_write_b64 v10, v[32:33] offset:64
    v_accvgpr_read_b32 v36, a100
    v_accvgpr_read_b32 v37, a101
    v_accvgpr_read_b32 v38, a102
    v_accvgpr_read_b32 v39, a103
    v_cvt_pk_bf16_f32 v36, v36, v37
    v_cvt_pk_bf16_f32 v37, v38, v39
    s_add_u32 s64, s21, s19
    s_add_u32 m0, s78, 4096
    s_nop 0
    buffer_load_dwordx4 v1, s[56:59], s64 offen sc1 lds
    ds_write_b64 v10, v[36:37] offset:9280
    v_accvgpr_read_b32 v40, a104
    v_accvgpr_read_b32 v41, a105
    v_accvgpr_read_b32 v42, a106
    v_accvgpr_read_b32 v43, a107
    v_cvt_pk_bf16_f32 v40, v40, v41
    v_cvt_pk_bf16_f32 v41, v42, v43
    ds_write_b64 v10, v[40:41] offset:20800
    v_accvgpr_read_b32 v44, a108
    v_accvgpr_read_b32 v45, a109
    v_accvgpr_read_b32 v46, a110
    v_accvgpr_read_b32 v47, a111
    v_cvt_pk_bf16_f32 v44, v44, v45
    v_cvt_pk_bf16_f32 v45, v46, v47
    ds_write_b64 v10, v[44:45] offset:30016
    v_accvgpr_read_b32 v32, a112
    v_accvgpr_read_b32 v33, a113
    v_accvgpr_read_b32 v34, a114
    v_accvgpr_read_b32 v35, a115
    v_cvt_pk_bf16_f32 v32, v32, v33
    v_cvt_pk_bf16_f32 v33, v34, v35
    ds_write_b64 v9, v[32:33] offset:96
    buffer_load_dwordx4 v1, s[56:59], s64 offen offset:1024 sc1 lds
    v_accvgpr_read_b32 v36, a116
    v_accvgpr_read_b32 v37, a117
    v_accvgpr_read_b32 v38, a118
    v_accvgpr_read_b32 v39, a119
    v_cvt_pk_bf16_f32 v36, v36, v37
    v_cvt_pk_bf16_f32 v37, v38, v39
    ds_write_b64 v9, v[36:37] offset:9312
    v_accvgpr_read_b32 v40, a120
    v_accvgpr_read_b32 v41, a121
    v_accvgpr_read_b32 v42, a122
    v_accvgpr_read_b32 v43, a123
    v_cvt_pk_bf16_f32 v40, v40, v41
    v_cvt_pk_bf16_f32 v41, v42, v43
    ds_write_b64 v9, v[40:41] offset:20832
    v_accvgpr_read_b32 v44, a124
    v_accvgpr_read_b32 v45, a125
    v_accvgpr_read_b32 v46, a126
    v_accvgpr_read_b32 v47, a127
    v_cvt_pk_bf16_f32 v44, v44, v45
    v_cvt_pk_bf16_f32 v45, v46, v47
    s_waitcnt lgkmcnt(14)
    ds_write_b64 v9, v[44:45] offset:30048
    v_accvgpr_read_b32 v32, a128
    s_add_u32 s64, s21, s20
    s_add_u32 m0, s78, 6144
    s_nop 0
    buffer_load_dwordx4 v1, s[56:59], s64 offen sc1 lds
    v_accvgpr_read_b32 v33, a129
    v_accvgpr_read_b32 v34, a130
    v_accvgpr_read_b32 v35, a131
    v_cvt_pk_bf16_f32 v32, v32, v33
    v_cvt_pk_bf16_f32 v33, v34, v35
    s_waitcnt lgkmcnt(14)
    ds_write_b64 v12, v[32:33] offset:0
    v_accvgpr_read_b32 v36, a132
    v_accvgpr_read_b32 v37, a133
    v_accvgpr_read_b32 v38, a134
    v_accvgpr_read_b32 v39, a135
    v_cvt_pk_bf16_f32 v36, v36, v37
    v_cvt_pk_bf16_f32 v37, v38, v39
    s_cmp_eq_u32 s73, 0
    s_cselect_b64 exec, -1, 0
    s_waitcnt lgkmcnt(14)
    ds_write_b64 v13, v[36:37] offset:32
    s_mov_b64 exec, -1
    s_cmp_lg_u64 s[84:85], 0
    s_cselect_b32 s7, 1, 0
    v_mov_b32 v20, s7
    s_lshl2_add_u32 s98, s4, s79
    v_mov_b32 v21, s98
    s_waitcnt lgkmcnt(14)
    ds_write_b32 v21, v20 offset:41472
    v_mov_b32 v21, s79
    s_waitcnt vmcnt(7)
    s_waitcnt lgkmcnt(0)
    s_barrier
    ds_read_b128 v[24:27], v21 offset:41472
    s_and_b32 s98, s4, 1
    s_lshl_b32 s98, s98, 6
    v_lshrrev_b32 v14, 4, v1
    v_add_u32 v14, s98, v14
    s_lshr_b32 s99, s4, 1
    s_mul_i32 s7, s99, 144
    s_add_u32 s7, s7, 2
    v_add_u32 v2, s7, v14
    v_mul_u32_u24 v2, 144, v2
    v_add_u32 v2, s79, v2
    s_waitcnt lgkmcnt(0)
    v_or3_b32 v24, v24, v25, v26
    v_or_b32 v24, v24, v27
    s_nop 0
    v_readfirstlane_b32 s7, v24
    s_nop 1
    s_andn2_b32 s7, s7, s83
    s_cbranch_scc1 K1_REDO
    v_mov_b32 v31, 2
    buffer_store_dword v31, v30, s[32:35], s101 offen sc1
    s_xor_b32 s21, s3, 1
    s_lshl2_add_u32 s21, s21, s4
    s_mul_i32 s21, s21, 36864
    s_add_u32 s64, s21, s17
    s_add_u32 m0, s78, 28672
    s_nop 0
    buffer_load_dwordx4 v1, s[56:59], s64 offen sc1 lds
    ds_read_b128 v[128:131], v2 offset:2096
    ds_read_b128 v[132:135], v2 offset:2112
    ds_read_b128 v[136:139], v2 offset:2128
    ds_read_b128 v[32:35], v2 offset:2016
    ds_read_b128 v[36:39], v2 offset:2032
    ds_read_b128 v[40:43], v2 offset:2048
    ds_read_b128 v[44:47], v2 offset:1728
    ds_read_b128 v[48:51], v2 offset:1744
    ds_read_b128 v[52:55], v2 offset:1760
    ds_read_b128 v[56:59], v2 offset:1440
    ds_read_b128 v[60:63], v2 offset:1456
    ds_read_b128 v[64:67], v2 offset:1472
    ds_read_b128 v[68:71], v2 offset:1152
    ds_read_b128 v[72:75], v2 offset:1168
    buffer_load_dwordx4 v1, s[56:59], s64 offen offset:1024 sc1 lds
    ds_read_b128 v[76:79], v2 offset:1184
    s_waitcnt lgkmcnt(14)
    ds_read_b128 v[80:83], v2 offset:864
    s_waitcnt lgkmcnt(14)
    ds_read_b128 v[84:87], v2 offset:880
    s_waitcnt lgkmcnt(14)
    ds_read_b128 v[88:91], v2 offset:896
    s_waitcnt lgkmcnt(14)
    ds_read_b128 v[92:95], v2 offset:576
    s_waitcnt lgkmcnt(14)
    ds_read_b128 v[96:99], v2 offset:592
    s_waitcnt lgkmcnt(14)
    ds_read_b128 v[100:103], v2 offset:608
    s_waitcnt lgkmcnt(14)
    ds_read_b128 v[104:107], v2 offset:288
    s_waitcnt lgkmcnt(14)
    ds_read_b128 v[108:111], v2 offset:304
    s_waitcnt lgkmcnt(14)
    ds_read_b128 v[112:115], v2 offset:320
    s_waitcnt lgkmcnt(14)
    ds_read_b128 v[116:119], v2 offset:0
    s_waitcnt lgkmcnt(14)
    ds_read_b128 v[120:123], v2 offset:16
    s_waitcnt lgkmcnt(14)
    ds_read_b128 v[124:127], v2 offset:32
    s_sub_u32 s7, 15, s6
    s_cmp_eq_u32 s99, 0
    s_cselect_b32 s7, s6, s7
    s_add_u32 s64, s21, s18
    s_add_u32 m0, s78, 30720
    s_nop 0
    buffer_load_dwordx4 v1, s[56:59], s64 offen sc1 lds
    s_lshl_b32 s7, s7, 7
    v_add_u32 v14, s7, v14
    v_lshrrev_b32 v15, 4, v14
    s_mov_b32 s98, 155648
    v_mul_lo_u32 v15, v15, s98
    v_and_b32 v23, 0xf0, v1
    v_add_u32 v15, v15, v23
    s_sub_u32 s62, 15, s6
    s_bitcmp1_b32 s5, 2
    s_cselect_b32 s62, s62, s6
    s_lshl2_add_u32 s98, s62, s4
    s_mul_i32 s98, s98, 311296
    v_add_u32 v4, s98, v1
    v_add_u32 v5, 155648, v4
    buffer_load_dwordx4 v1, s[56:59], s64 offen offset:1024 sc1 lds
    s_lshl_b32 s63, s3, 12
    s_lshl2_add_u32 s66, s6, s61
    s_lshl_b32 s66, s66, 10
    v_bfe_u32 v19, v1, 4, 3
    v_lshlrev_b32 v19, 7, v19
    s_add_u32 s48, s32, 1048576
    s_addc_u32 s49, s33, 0
    s_mov_b32 s50, 9437184
    v_mov_b32 v140, 0
    v_mov_b32 v141, 0
    v_mov_b32 v142, 0
    v_mov_b32 v143, 0
    v_mov_b32 v144, 0
    v_mov_b32 v145, 0
    s_add_u32 s64, s21, s19
    s_add_u32 m0, s78, 32768
    s_nop 0
    buffer_load_dwordx4 v1, s[56:59], s64 offen sc1 lds
    v_mov_b32 v146, 0
    v_mov_b32 v147, 0
    v_dot2c_f32_bf16 v140, v128, v32
    v_dot2c_f32_bf16 v141, v128, v44
    v_dot2c_f32_bf16 v142, v128, v56
    s_waitcnt lgkmcnt(14)
    v_dot2c_f32_bf16 v143, v128, v68
    v_dot2c_f32_bf16 v140, v129, v33
    v_dot2c_f32_bf16 v141, v129, v45
    v_dot2c_f32_bf16 v142, v129, v57
    v_dot2c_f32_bf16 v143, v129, v69
    v_dot2c_f32_bf16 v140, v130, v34
    v_dot2c_f32_bf16 v141, v130, v46
    v_dot2c_f32_bf16 v142, v130, v58
    v_dot2c_f32_bf16 v143, v130, v70
    v_dot2c_f32_bf16 v140, v131, v35
    buffer_load_dwordx4 v1, s[56:59], s64 offen offset:1024 sc1 lds
    v_dot2c_f32_bf16 v141, v131, v47
    v_dot2c_f32_bf16 v142, v131, v59
    v_dot2c_f32_bf16 v143, v131, v71
    v_dot2c_f32_bf16 v140, v132, v36
    v_dot2c_f32_bf16 v141, v132, v48
    v_dot2c_f32_bf16 v142, v132, v60
    s_waitcnt lgkmcnt(13)
    v_dot2c_f32_bf16 v143, v132, v72
    v_dot2c_f32_bf16 v140, v133, v37
    v_dot2c_f32_bf16 v141, v133, v49
    v_dot2c_f32_bf16 v142, v133, v61
    v_dot2c_f32_bf16 v143, v133, v73
    v_dot2c_f32_bf16 v140, v134, v38
    v_dot2c_f32_bf16 v141, v134, v50
    v_dot2c_f32_bf16 v142, v134, v62
    v_dot2c_f32_bf16 v143, v134, v74
    s_add_u32 s64, s21, s20
    s_add_u32 m0, s78, 34816
    s_nop 0
    buffer_load_dwordx4 v1, s[56:59], s64 offen sc1 lds
    v_dot2c_f32_bf16 v140, v135, v39
    v_dot2c_f32_bf16 v141, v135, v51
    v_dot2c_f32_bf16 v142, v135, v63
    v_dot2c_f32_bf16 v143, v135, v75
    v_dot2c_f32_bf16 v140, v136, v40
    v_dot2c_f32_bf16 v141, v136, v52
    v_dot2c_f32_bf16 v142, v136, v64
    s_waitcnt lgkmcnt(12)
    v_dot2c_f32_bf16 v143, v136, v76
    ds_read_b128 v[32:35], v2 offset:2064
    ds_read_b128 v[36:39], v2 offset:2080
    ds_read_b128 v[44:47], v2 offset:1776
    s_waitcnt lgkmcnt(14)
    ds_read_b128 v[48:51], v2 offset:1792
    s_waitcnt lgkmcnt(14)
    ds_read_b128 v[56:59], v2 offset:1488
    s_waitcnt lgkmcnt(14)
    ds_read_b128 v[60:63], v2 offset:1504
    s_waitcnt lgkmcnt(14)
    ds_read_b128 v[68:71], v2 offset:1200
    s_xor_b32 s21, s3, 2
    s_lshl2_add_u32 s21, s21, s4
    s_mul_i32 s21, s21, 36864
    s_add_u32 s64, s21, s17
    s_add_u32 m0, s78, 57344
    s_nop 0
    buffer_load_dwordx4 v1, s[56:59], s64 offen sc1 lds
    s_waitcnt lgkmcnt(14)
    ds_read_b128 v[72:75], v2 offset:1216
    v_dot2c_f32_bf16 v144, v128, v80
    v_dot2c_f32_bf16 v145, v128, v92
    s_waitcnt lgkmcnt(13)
    v_dot2c_f32_bf16 v146, v128, v104
    s_waitcnt lgkmcnt(10)
    v_dot2c_f32_bf16 v147, v128, v116
    v_dot2c_f32_bf16 v144, v129, v81
    v_dot2c_f32_bf16 v145, v129, v93
    v_dot2c_f32_bf16 v146, v129, v105
    v_dot2c_f32_bf16 v147, v129, v117
    v_dot2c_f32_bf16 v144, v130, v82
    v_dot2c_f32_bf16 v145, v130, v94
    v_dot2c_f32_bf16 v146, v130, v106
    v_dot2c_f32_bf16 v147, v130, v118
    v_dot2c_f32_bf16 v144, v131, v83
    buffer_load_dwordx4 v1, s[56:59], s64 offen offset:1024 sc1 lds
    v_dot2c_f32_bf16 v145, v131, v95
    v_dot2c_f32_bf16 v146, v131, v107
    v_dot2c_f32_bf16 v147, v131, v119
    v_dot2c_f32_bf16 v144, v132, v84
    v_dot2c_f32_bf16 v145, v132, v96
    v_dot2c_f32_bf16 v146, v132, v108
    s_waitcnt lgkmcnt(9)
    v_dot2c_f32_bf16 v147, v132, v120
    v_dot2c_f32_bf16 v144, v133, v85
    v_dot2c_f32_bf16 v145, v133, v97
    v_dot2c_f32_bf16 v146, v133, v109
    v_dot2c_f32_bf16 v147, v133, v121
    v_dot2c_f32_bf16 v144, v134, v86
    v_dot2c_f32_bf16 v145, v134, v98
    v_dot2c_f32_bf16 v146, v134, v110
    v_dot2c_f32_bf16 v147, v134, v122
    s_add_u32 s64, s21, s18
    s_add_u32 m0, s78, 59392
    s_nop 0
    buffer_load_dwordx4 v1, s[56:59], s64 offen sc1 lds
    v_dot2c_f32_bf16 v144, v135, v87
    v_dot2c_f32_bf16 v145, v135, v99
    v_dot2c_f32_bf16 v146, v135, v111
    v_dot2c_f32_bf16 v147, v135, v123
    v_dot2c_f32_bf16 v144, v136, v88
    v_dot2c_f32_bf16 v145, v136, v100
    v_dot2c_f32_bf16 v146, v136, v112
    s_waitcnt lgkmcnt(8)
    v_dot2c_f32_bf16 v147, v136, v124
    ds_read_b128 v[80:83], v2 offset:912
    ds_read_b128 v[84:87], v2 offset:928
    ds_read_b128 v[92:95], v2 offset:624
    ds_read_b128 v[96:99], v2 offset:640
    ds_read_b128 v[104:107], v2 offset:336
    ds_read_b128 v[108:111], v2 offset:352
    ds_read_b128 v[116:119], v2 offset:48
    buffer_load_dwordx4 v1, s[56:59], s64 offen offset:1024 sc1 lds
    s_waitcnt lgkmcnt(14)
    ds_read_b128 v[120:123], v2 offset:64
    s_mov_b32 s98, 0xbfb8aa3b
    s_mov_b32 s7, 0x3eae1a93
    v_lshlrev_b32 v8, 16, v138
    v_mul_f32 v8, s98, v8
    v_exp_f32 v8, v8
    v_mov_b32 v9, 0xf149f2ca
    v_add_f32 v8, 1.0, v8
    v_rcp_f32 v8, v8
    v_mul_f32 v140, s7, v140
    v_mov_b32 v128, 0
    v_mov_b32 v129, 0
    v_cmp_le_u32 vcc, 2, v14
    v_mul_f32 v141, s7, v141
    s_add_u32 s64, s21, s19
    s_add_u32 m0, s78, 61440
    s_nop 0
    buffer_load_dwordx4 v1, s[56:59], s64 offen sc1 lds
    v_mov_b32 v130, 0
    v_mov_b32 v131, 0
    v_cndmask_b32 v141, v9, v141, vcc
    v_cmp_le_u32 vcc, 4, v14
    v_mul_f32 v142, s7, v142
    v_mov_b32 v132, 0
    v_mov_b32 v133, 0
    v_cndmask_b32 v142, v9, v142, vcc
    v_cmp_le_u32 vcc, 6, v14
    v_mul_f32 v143, s7, v143
    v_mov_b32 v134, 0
    v_mov_b32 v135, 0
    v_cndmask_b32 v143, v9, v143, vcc
    v_cmp_le_u32 vcc, 8, v14
    v_mul_f32 v144, s7, v144
    buffer_load_dwordx4 v1, s[56:59], s64 offen offset:1024 sc1 lds
    v_mov_b32 v136, 0
    v_mov_b32 v137, 0
    v_cndmask_b32 v144, v9, v144, vcc
    v_cmp_le_u32 vcc, 10, v14
    v_mul_f32 v145, s7, v145
    v_mov_b32 v138, 0
    v_mov_b32 v139, 0
    v_cndmask_b32 v145, v9, v145, vcc
    v_cmp_le_u32 vcc, 12, v14
    v_mul_f32 v146, s7, v146
    v_mov_b32 v156, 0
    v_mov_b32 v157, 0
    v_cndmask_b32 v146, v9, v146, vcc
    v_cmp_le_u32 vcc, 14, v14
    v_mul_f32 v147, s7, v147
    s_add_u32 s64, s21, s20
    s_add_u32 m0, s78, 63488
    s_nop 0
    buffer_load_dwordx4 v1, s[56:59], s64 offen sc1 lds
    v_mov_b32 v158, 0
    v_mov_b32 v159, 0
    v_cndmask_b32 v147, v9, v147, vcc
    v_max3_f32 v9, v140, v141, v142
    v_max3_f32 v10, v143, v144, v145
    v_max3_f32 v9, v9, v146, v147
    v_max_f32 v9, v9, v10
    v_sub_f32 v140, v140, v9
    v_sub_f32 v141, v141, v9
    v_sub_f32 v142, v142, v9
    v_sub_f32 v143, v143, v9
    v_sub_f32 v144, v144, v9
    v_sub_f32 v145, v145, v9
    v_sub_f32 v146, v146, v9
    v_sub_f32 v147, v147, v9
    buffer_load_dword v3, v19, s[32:35], s66 offen sc1
    s_xor_b32 s21, s3, 3
    s_lshl2_add_u32 s21, s21, s4
    s_mul_i32 s21, s21, 36864
    s_add_u32 s64, s21, s17
    s_add_u32 m0, s78, 86016
    s_nop 0
    buffer_load_dwordx4 v1, s[56:59], s64 offen sc1 lds
    v_exp_f32 v140, v140
    v_exp_f32 v141, v141
    v_exp_f32 v142, v142
    v_exp_f32 v143, v143
    v_exp_f32 v144, v144
    v_exp_f32 v145, v145
    buffer_load_dwordx4 v1, s[56:59], s64 offen offset:1024 sc1 lds
    v_exp_f32 v146, v146
    v_exp_f32 v147, v147
    v_add_f32 v10, v140, v141
    v_add_f32 v10, v10, v142
    v_add_f32 v10, v10, v143
    v_add_f32 v10, v10, v144
    s_add_u32 s64, s21, s18
    s_add_u32 m0, s78, 88064
    s_nop 0
    buffer_load_dwordx4 v1, s[56:59], s64 offen sc1 lds
    v_add_f32 v10, v10, v145
    v_add_f32 v10, v10, v146
    v_add_f32 v10, v10, v147
    v_rcp_f32 v10, v10
    v_mov_b32 v17, 0
    v_mov_b32 v18, 0
    buffer_load_dwordx4 v1, s[56:59], s64 offen offset:1024 sc1 lds
    v_mul_f32 v140, v140, v10
    v_mul_f32 v141, v141, v10
    v_mul_f32 v142, v142, v10
    v_mul_f32 v143, v143, v10
    v_mul_f32 v144, v144, v10
    v_mul_f32 v145, v145, v10
    s_add_u32 s64, s21, s19
    s_add_u32 m0, s78, 90112
    s_nop 0
    buffer_load_dwordx4 v1, s[56:59], s64 offen sc1 lds
    v_mul_f32 v146, v146, v10
    v_mul_f32 v147, v147, v10
    v_cvt_pk_bf16_f32 v148, 0, v140
    v_cvt_pk_bf16_f32 v149, 0, v141
    v_cvt_pk_bf16_f32 v150, 0, v142
    v_cvt_pk_bf16_f32 v151, 0, v143
    buffer_load_dwordx4 v1, s[56:59], s64 offen offset:1024 sc1 lds
    v_cvt_pk_bf16_f32 v152, 0, v144
    v_cvt_pk_bf16_f32 v153, 0, v145
    v_cvt_pk_bf16_f32 v154, 0, v146
    v_cvt_pk_bf16_f32 v155, 0, v147
    v_lshrrev_b32 v140, 16, v148
    v_lshrrev_b32 v141, 16, v149
    s_add_u32 s64, s21, s20
    s_add_u32 m0, s78, 92160
    s_nop 0
    buffer_load_dwordx4 v1, s[56:59], s64 offen sc1 lds
    v_lshrrev_b32 v142, 16, v150
    v_lshrrev_b32 v143, 16, v151
    v_lshrrev_b32 v144, 16, v152
    v_lshrrev_b32 v145, 16, v153
    v_lshrrev_b32 v146, 16, v154
    v_lshrrev_b32 v147, 16, v155
    s_waitcnt vmcnt(7)
    v_cmp_gt_u32 vcc, 2, v3
    s_nop 1
    s_and_b64 vcc, vcc, exec
    s_cbranch_scc1 SPIN_CTX
BACK_CTX:
    buffer_load_dwordx4 a[0:3], v4, s[40:43], s63 offen offset:0 sc1
    v_dot2c_f32_bf16 v128, v42, v140
    v_dot2c_f32_bf16 v129, v42, v148
    v_dot2c_f32_bf16 v130, v43, v140
    v_dot2c_f32_bf16 v131, v43, v148
    v_dot2c_f32_bf16 v132, v32, v140
    v_dot2c_f32_bf16 v133, v32, v148
    v_dot2c_f32_bf16 v134, v33, v140
    v_dot2c_f32_bf16 v135, v33, v148
    buffer_load_dwordx4 a[4:7], v5, s[40:43], s63 offen offset:0 sc1
    v_dot2c_f32_bf16 v136, v34, v140
    v_dot2c_f32_bf16 v137, v34, v148
    v_dot2c_f32_bf16 v138, v35, v140
    v_dot2c_f32_bf16 v139, v35, v148
    s_waitcnt lgkmcnt(14)
    v_dot2c_f32_bf16 v156, v36, v140
    v_dot2c_f32_bf16 v157, v36, v148
    v_dot2c_f32_bf16 v158, v37, v140
    v_dot2c_f32_bf16 v159, v37, v148
    buffer_load_dwordx4 a[8:11], v4, s[40:43], s63 offen offset:1024 sc1
    v_dot2c_f32_bf16 v17, v38, v140
    v_dot2c_f32_bf16 v18, v38, v148
    v_dot2c_f32_bf16 v128, v54, v141
    v_dot2c_f32_bf16 v129, v54, v149
    v_dot2c_f32_bf16 v130, v55, v141
    v_dot2c_f32_bf16 v131, v55, v149
    s_waitcnt lgkmcnt(13)
    v_dot2c_f32_bf16 v132, v44, v141
    v_dot2c_f32_bf16 v133, v44, v149
    buffer_load_dwordx4 a[12:15], v5, s[40:43], s63 offen offset:1024 sc1
    v_dot2c_f32_bf16 v134, v45, v141
    v_dot2c_f32_bf16 v135, v45, v149
    v_dot2c_f32_bf16 v136, v46, v141
    v_dot2c_f32_bf16 v137, v46, v149
    v_dot2c_f32_bf16 v138, v47, v141
    v_dot2c_f32_bf16 v139, v47, v149
    s_waitcnt lgkmcnt(12)
    v_dot2c_f32_bf16 v156, v48, v141
    v_dot2c_f32_bf16 v157, v48, v149
    v_dot2c_f32_bf16 v158, v49, v141
    buffer_load_dwordx4 a[16:19], v4, s[40:43], s63 offen offset:2048 sc1
    v_dot2c_f32_bf16 v159, v49, v149
    v_dot2c_f32_bf16 v17, v50, v141
    v_dot2c_f32_bf16 v18, v50, v149
    v_dot2c_f32_bf16 v128, v66, v142
    v_dot2c_f32_bf16 v129, v66, v150
    v_dot2c_f32_bf16 v130, v67, v142
    v_dot2c_f32_bf16 v131, v67, v150
    s_waitcnt lgkmcnt(11)
    v_dot2c_f32_bf16 v132, v56, v142
    buffer_load_dwordx4 a[20:23], v5, s[40:43], s63 offen offset:2048 sc1
    v_dot2c_f32_bf16 v133, v56, v150
    v_dot2c_f32_bf16 v134, v57, v142
    v_dot2c_f32_bf16 v135, v57, v150
    v_dot2c_f32_bf16 v136, v58, v142
    v_dot2c_f32_bf16 v137, v58, v150
    v_dot2c_f32_bf16 v138, v59, v142
    v_dot2c_f32_bf16 v139, v59, v150
    s_waitcnt lgkmcnt(10)
    v_dot2c_f32_bf16 v156, v60, v142
    buffer_load_dwordx4 a[24:27], v4, s[40:43], s63 offen offset:3072 sc1
    v_dot2c_f32_bf16 v157, v60, v150
    v_dot2c_f32_bf16 v158, v61, v142
    v_dot2c_f32_bf16 v159, v61, v150
    v_dot2c_f32_bf16 v17, v62, v142
    v_dot2c_f32_bf16 v18, v62, v150
    v_dot2c_f32_bf16 v128, v78, v143
    v_dot2c_f32_bf16 v129, v78, v151
    v_dot2c_f32_bf16 v130, v79, v143
    buffer_load_dwordx4 a[28:31], v5, s[40:43], s63 offen offset:3072 sc1
    v_dot2c_f32_bf16 v131, v79, v151
    s_waitcnt lgkmcnt(9)
    v_dot2c_f32_bf16 v132, v68, v143
    v_dot2c_f32_bf16 v133, v68, v151
    v_dot2c_f32_bf16 v134, v69, v143
    v_dot2c_f32_bf16 v135, v69, v151
    v_dot2c_f32_bf16 v136, v70, v143
    v_dot2c_f32_bf16 v137, v70, v151
    v_dot2c_f32_bf16 v138, v71, v143
    v_dot2c_f32_bf16 v139, v71, v151
    s_xor_b32 s63, s63, 4096
    buffer_load_dwordx4 a[32:35], v4, s[40:43], s63 offen offset:0 sc1
    s_waitcnt lgkmcnt(8)
    v_dot2c_f32_bf16 v156, v72, v143
    v_dot2c_f32_bf16 v157, v72, v151
    v_dot2c_f32_bf16 v158, v73, v143
    v_dot2c_f32_bf16 v159, v73, v151
    v_dot2c_f32_bf16 v17, v74, v143
    v_dot2c_f32_bf16 v18, v74, v151
    v_dot2c_f32_bf16 v128, v90, v144
    v_dot2c_f32_bf16 v129, v90, v152
    buffer_load_dwordx4 a[36:39], v5, s[40:43], s63 offen offset:0 sc1
    v_dot2c_f32_bf16 v130, v91, v144
    v_dot2c_f32_bf16 v131, v91, v152
    s_waitcnt lgkmcnt(7)
    v_dot2c_f32_bf16 v132, v80, v144
    v_dot2c_f32_bf16 v133, v80, v152
    v_dot2c_f32_bf16 v134, v81, v144
    v_dot2c_f32_bf16 v135, v81, v152
    v_dot2c_f32_bf16 v136, v82, v144
    v_dot2c_f32_bf16 v137, v82, v152
    buffer_load_dwordx4 a[40:43], v4, s[40:43], s63 offen offset:1024 sc1
    v_dot2c_f32_bf16 v138, v83, v144
    v_dot2c_f32_bf16 v139, v83, v152
    s_waitcnt lgkmcnt(6)
    v_dot2c_f32_bf16 v156, v84, v144
    v_dot2c_f32_bf16 v157, v84, v152
    v_dot2c_f32_bf16 v158, v85, v144
    v_dot2c_f32_bf16 v159, v85, v152
    v_dot2c_f32_bf16 v17, v86, v144
    v_dot2c_f32_bf16 v18, v86, v152
    buffer_load_dwordx4 a[44:47], v5, s[40:43], s63 offen offset:1024 sc1
    v_dot2c_f32_bf16 v128, v102, v145
    v_dot2c_f32_bf16 v129, v102, v153
    v_dot2c_f32_bf16 v130, v103, v145
    v_dot2c_f32_bf16 v131, v103, v153
    s_waitcnt lgkmcnt(5)
    v_dot2c_f32_bf16 v132, v92, v145
    v_dot2c_f32_bf16 v133, v92, v153
    v_dot2c_f32_bf16 v134, v93, v145
    v_dot2c_f32_bf16 v135, v93, v153
    v_dot2c_f32_bf16 v136, v94, v145
    buffer_load_dwordx4 a[48:51], v4, s[40:43], s63 offen offset:2048 sc1
    v_dot2c_f32_bf16 v137, v94, v153
    v_dot2c_f32_bf16 v138, v95, v145
    v_dot2c_f32_bf16 v139, v95, v153
    s_waitcnt lgkmcnt(4)
    v_dot2c_f32_bf16 v156, v96, v145
    v_dot2c_f32_bf16 v157, v96, v153
    v_dot2c_f32_bf16 v158, v97, v145
    v_dot2c_f32_bf16 v159, v97, v153
    v_dot2c_f32_bf16 v17, v98, v145
    buffer_load_dwordx4 a[52:55], v5, s[40:43], s63 offen offset:2048 sc1
    v_dot2c_f32_bf16 v18, v98, v153
    v_dot2c_f32_bf16 v128, v114, v146
    v_dot2c_f32_bf16 v129, v114, v154
    v_dot2c_f32_bf16 v130, v115, v146
    v_dot2c_f32_bf16 v131, v115, v154
    s_waitcnt lgkmcnt(3)
    v_dot2c_f32_bf16 v132, v104, v146
    v_dot2c_f32_bf16 v133, v104, v154
    v_dot2c_f32_bf16 v134, v105, v146
    buffer_load_dwordx4 a[56:59], v4, s[40:43], s63 offen offset:3072 sc1
    v_dot2c_f32_bf16 v135, v105, v154
    v_dot2c_f32_bf16 v136, v106, v146
    v_dot2c_f32_bf16 v137, v106, v154
    v_dot2c_f32_bf16 v138, v107, v146
    v_dot2c_f32_bf16 v139, v107, v154
    s_waitcnt lgkmcnt(2)
    v_dot2c_f32_bf16 v156, v108, v146
    v_dot2c_f32_bf16 v157, v108, v154
    v_dot2c_f32_bf16 v158, v109, v146
    buffer_load_dwordx4 a[60:63], v5, s[40:43], s63 offen offset:3072 sc1
    s_xor_b32 s63, s63, 12288
    v_dot2c_f32_bf16 v159, v109, v154
    v_dot2c_f32_bf16 v17, v110, v146
    v_dot2c_f32_bf16 v18, v110, v154
    v_dot2c_f32_bf16 v128, v126, v147
    v_dot2c_f32_bf16 v129, v126, v155
    v_dot2c_f32_bf16 v130, v127, v147
    v_dot2c_f32_bf16 v131, v127, v155
    s_waitcnt lgkmcnt(1)
    v_dot2c_f32_bf16 v132, v116, v147
    v_dot2c_f32_bf16 v133, v116, v155
    v_dot2c_f32_bf16 v134, v117, v147
    v_dot2c_f32_bf16 v135, v117, v155
    v_dot2c_f32_bf16 v136, v118, v147
    v_dot2c_f32_bf16 v137, v118, v155
    v_dot2c_f32_bf16 v138, v119, v147
    v_dot2c_f32_bf16 v139, v119, v155
    s_waitcnt lgkmcnt(0)
    v_dot2c_f32_bf16 v156, v120, v147
    v_dot2c_f32_bf16 v157, v120, v155
    v_dot2c_f32_bf16 v158, v121, v147
    v_dot2c_f32_bf16 v159, v121, v155
    v_dot2c_f32_bf16 v17, v122, v147
    v_dot2c_f32_bf16 v18, v122, v155
    v_mul_f32 v128, v8, v128
    v_mul_f32 v129, v8, v129
    v_mul_f32 v130, v8, v130
    v_mul_f32 v131, v8, v131
    v_mul_f32 v132, v8, v132
    v_mul_f32 v133, v8, v133
    v_mul_f32 v134, v8, v134
    v_mul_f32 v135, v8, v135
    v_mul_f32 v136, v8, v136
    v_mul_f32 v137, v8, v137
    v_mul_f32 v138, v8, v138
    v_mul_f32 v139, v8, v139
    v_mul_f32 v156, v8, v156
    v_mul_f32 v157, v8, v157
    v_mul_f32 v158, v8, v158
    v_mul_f32 v159, v8, v159
    v_mul_f32 v17, v8, v17
    v_mul_f32 v18, v8, v18
    v_cvt_pk_bf16_f32 v80, v128, v129
    v_cvt_pk_bf16_f32 v81, v130, v131
    v_cvt_pk_bf16_f32 v82, v132, v133
    v_cvt_pk_bf16_f32 v83, v134, v135
    v_cvt_pk_bf16_f32 v84, v136, v137
    v_cvt_pk_bf16_f32 v85, v138, v139
    v_cvt_pk_bf16_f32 v86, v156, v157
    v_cvt_pk_bf16_f32 v87, v158, v159
    v_cvt_pk_bf16_f32 v88, v17, v18
    v_mov_b32 v89, 0
    v_mov_b32 v90, 0
    v_mov_b32 v91, 0
    s_mul_i32 s98, s5, 768
    s_add_u32 s98, s98, 131072
    buffer_store_dwordx4 v[80:83], v15, s[40:43], s98 offen offset:0 sc1
    buffer_store_dwordx4 v[84:87], v15, s[40:43], s98 offen offset:256 sc1
    buffer_store_dwordx4 v[88:91], v15, s[40:43], s98 offen offset:512 sc1
    v_mov_b32 v8, v1
    v_add_u32 v9, 0x10000, v1
    v_add_u32 v10, 0x20000, v1
    s_waitcnt vmcnt(11)
    s_barrier
    ds_read_b128 v[104:107], v8 offset:0
    ds_read_b128 v[108:111], v8 offset:7168
    ds_read_b128 v[112:115], v8 offset:1024
    ds_read_b128 v[116:119], v8 offset:8192
    s_waitcnt lgkmcnt(3)
    v_mfma_f32_16x16x32_bf16 v[176:179], v[104:107], a[0:3], 0
    s_lshl3_add_u32 s98, 1, s5
    ds_read_b128 v[120:123], v8 offset:2048
    ds_read_b128 v[124:127], v8 offset:9216
    s_waitcnt lgkmcnt(4)
    v_mfma_f32_16x16x32_bf16 v[176:179], v[108:111], a[8:11], v[176:179]
    s_and_b32 s98, s98, 31
    buffer_load_dwordx4 a[64:67], v4, s[40:43], s63 offen offset:0 sc1
    v_mfma_f32_16x16x32_bf16 v[180:183], v[104:107], a[4:7], 0
    s_lshl_b32 s8, s6, 5
    ds_read_b128 v[128:131], v8 offset:3072
    ds_read_b128 v[132:135], v8 offset:10240
    v_mfma_f32_16x16x32_bf16 v[180:183], v[108:111], a[12:15], v[180:183]
    s_add_u32 s98, s98, s8
    ds_read_b128 v[136:139], v8 offset:4096
    s_waitcnt lgkmcnt(6)
    v_mfma_f32_16x16x32_bf16 v[184:187], v[112:115], a[0:3], 0
    s_mul_i32 s98, s98, 3
    buffer_load_dwordx4 a[68:71], v5, s[40:43], s63 offen offset:0 sc1
    s_waitcnt lgkmcnt(5)
    v_mfma_f32_16x16x32_bf16 v[184:187], v[116:119], a[8:11], v[184:187]
    s_sub_u32 s98, s98, 1
    ds_read_b128 v[140:143], v8 offset:11264
    ds_read_b128 v[144:147], v8 offset:5120
    v_mfma_f32_16x16x32_bf16 v[188:191], v[112:115], a[4:7], 0
    s_add_u32 s98, s98, 3
    ds_read_b128 v[148:151], v8 offset:12288
    v_mfma_f32_16x16x32_bf16 v[188:191], v[116:119], a[12:15], v[188:191]
    s_lshl2_add_u32 s98, s98, s4
    ds_read_b128 v[104:107], v8 offset:6144
    s_waitcnt lgkmcnt(5)
    v_mfma_f32_16x16x32_bf16 v[192:195], v[120:123], a[0:3], 0
    s_mul_i32 s8, s98, 3072
    buffer_load_dwordx4 a[72:75], v4, s[40:43], s63 offen offset:1024 sc1
    v_mfma_f32_16x16x32_bf16 v[192:195], v[124:127], a[8:11], v[192:195]
    s_lshl3_add_u32 s98, 2, s5
    ds_read_b128 v[108:111], v8 offset:13312
    ds_read_b128 v[112:115], v8 offset:14336
    v_mfma_f32_16x16x32_bf16 v[196:199], v[120:123], a[4:7], 0
    s_and_b32 s98, s98, 31
    ds_read_b128 v[116:119], v8 offset:21504
    v_mfma_f32_16x16x32_bf16 v[196:199], v[124:127], a[12:15], v[196:199]
    s_lshl_b32 s9, s6, 5
    ds_read_b128 v[120:123], v8 offset:15360
    v_mfma_f32_16x16x32_bf16 v[200:203], v[128:131], a[0:3], 0
    s_add_u32 s98, s98, s9
    buffer_load_dwordx4 a[76:79], v5, s[40:43], s63 offen offset:1024 sc1
    v_mfma_f32_16x16x32_bf16 v[200:203], v[132:135], a[8:11], v[200:203]
    s_mul_i32 s98, s98, 3
    ds_read_b128 v[124:127], v8 offset:22528
    v_mfma_f32_16x16x32_bf16 v[204:207], v[128:131], a[4:7], 0
    s_sub_u32 s98, s98, 2
    ds_read_b128 v[128:131], v8 offset:16384
    v_mfma_f32_16x16x32_bf16 v[204:207], v[132:135], a[12:15], v[204:207]
    s_add_u32 s98, s98, 3
    ds_read_b128 v[132:135], v8 offset:23552
    s_waitcnt lgkmcnt(4)
    v_mfma_f32_16x16x32_bf16 v[208:211], v[136:139], a[0:3], 0
    s_lshl2_add_u32 s98, s98, s4
    buffer_load_dwordx4 a[80:83], v4, s[40:43], s63 offen offset:2048 sc1
    v_mfma_f32_16x16x32_bf16 v[208:211], v[140:143], a[8:11], v[208:211]
    s_mul_i32 s9, s98, 3072
    v_mfma_f32_16x16x32_bf16 v[212:215], v[136:139], a[4:7], 0
    s_lshl3_add_u32 s98, 3, s5
    ds_read_b128 v[136:139], v8 offset:17408
    v_mfma_f32_16x16x32_bf16 v[212:215], v[140:143], a[12:15], v[212:215]
    s_and_b32 s98, s98, 31
    ds_read_b128 v[140:143], v8 offset:24576
    v_mfma_f32_16x16x32_bf16 v[216:219], v[144:147], a[0:3], 0
    s_lshl_b32 s10, s6, 5
    v_mfma_f32_16x16x32_bf16 v[216:219], v[148:151], a[8:11], v[216:219]
    s_add_u32 s98, s98, s10
    buffer_load_dwordx4 a[84:87], v5, s[40:43], s63 offen offset:2048 sc1
    v_mfma_f32_16x16x32_bf16 v[220:223], v[144:147], a[4:7], 0
    s_mul_i32 s98, s98, 3
    ds_read_b128 v[144:147], v8 offset:18432
    v_mfma_f32_16x16x32_bf16 v[220:223], v[148:151], a[12:15], v[220:223]
    s_sub_u32 s98, s98, 3
    ds_read_b128 v[148:151], v8 offset:25600
    v_mfma_f32_16x16x32_bf16 v[224:227], v[104:107], a[0:3], 0
    s_add_u32 s98, s98, 3
    v_mfma_f32_16x16x32_bf16 v[224:227], v[108:111], a[8:11], v[224:227]
    s_lshl2_add_u32 s98, s98, s4
    buffer_load_dwordx4 a[88:91], v4, s[40:43], s63 offen offset:3072 sc1
    v_mfma_f32_16x16x32_bf16 v[228:231], v[104:107], a[4:7], 0
    s_mul_i32 s10, s98, 3072
    ds_read_b128 v[104:107], v8 offset:19456
    v_mfma_f32_16x16x32_bf16 v[228:231], v[108:111], a[12:15], v[228:231]
    s_sub_u32 s99, s4, s61
    ds_read_b128 v[108:111], v8 offset:26624
    v_mfma_f32_16x16x32_bf16 v[176:179], v[112:115], a[16:19], v[176:179]
    s_and_b32 s99, s99, 3
    v_mfma_f32_16x16x32_bf16 v[176:179], v[116:119], a[24:27], v[176:179]
    s_lshl3_add_u32 s98, s99, s5
    buffer_load_dwordx4 a[92:95], v5, s[40:43], s63 offen offset:3072 sc1
    v_mfma_f32_16x16x32_bf16 v[180:183], v[112:115], a[20:23], v[180:183]
    s_xor_b32 s63, s63, 4096
    ds_read_b128 v[112:115], v8 offset:20480
    v_mfma_f32_16x16x32_bf16 v[180:183], v[116:119], a[28:31], v[180:183]
    s_and_b32 s98, s98, 31
    ds_read_b128 v[116:119], v8 offset:27648
    s_waitcnt lgkmcnt(3)
    v_mfma_f32_16x16x32_bf16 v[184:187], v[120:123], a[16:19], v[184:187]
    s_lshl_b32 s11, s6, 5
    v_mfma_f32_16x16x32_bf16 v[184:187], v[124:127], a[24:27], v[184:187]
    s_add_u32 s98, s98, s11
    buffer_load_dwordx4 a[96:99], v4, s[40:43], s63 offen offset:0 sc1
    v_mfma_f32_16x16x32_bf16 v[188:191], v[120:123], a[20:23], v[188:191]
    s_mul_i32 s98, s98, 3
    ds_read_b128 v[120:123], v8 offset:28672
    v_mfma_f32_16x16x32_bf16 v[188:191], v[124:127], a[28:31], v[188:191]
    s_sub_u32 s98, s98, s99
    ds_read_b128 v[124:127], v8 offset:35840
    v_mfma_f32_16x16x32_bf16 v[192:195], v[128:131], a[16:19], v[192:195]
    s_add_u32 s98, s98, 3
    v_mfma_f32_16x16x32_bf16 v[192:195], v[132:135], a[24:27], v[192:195]
    s_lshl2_add_u32 s98, s98, s4
    buffer_load_dwordx4 a[100:103], v5, s[40:43], s63 offen offset:0 sc1
    v_mfma_f32_16x16x32_bf16 v[196:199], v[128:131], a[20:23], v[196:199]
    s_mul_i32 s11, s98, 3072
    ds_read_b128 v[128:131], v8 offset:29696
    v_mfma_f32_16x16x32_bf16 v[196:199], v[132:135], a[28:31], v[196:199]
    ds_read_b128 v[132:135], v8 offset:36864
    v_mfma_f32_16x16x32_bf16 v[200:203], v[136:139], a[16:19], v[200:203]
    s_cmp_eq_u32 s99, 0
    s_cselect_b32 s11, 1073741824, s11
    v_mfma_f32_16x16x32_bf16 v[200:203], v[140:143], a[24:27], v[200:203]
    v_mfma_f32_16x16x32_bf16 v[204:207], v[136:139], a[20:23], v[204:207]
    buffer_load_dwordx4 a[104:107], v4, s[40:43], s63 offen offset:1024 sc1
    v_mfma_f32_16x16x32_bf16 v[204:207], v[140:143], a[28:31], v[204:207]
    s_waitcnt vmcnt(14)
    ds_read_b128 v[136:139], v8 offset:30720
    ds_read_b128 v[140:143], v8 offset:37888
    v_mfma_f32_16x16x32_bf16 v[208:211], v[144:147], a[16:19], v[208:211]
    v_mfma_f32_16x16x32_bf16 v[208:211], v[148:151], a[24:27], v[208:211]
    v_mfma_f32_16x16x32_bf16 v[212:215], v[144:147], a[20:23], v[212:215]
    buffer_load_dwordx4 a[108:111], v5, s[40:43], s63 offen offset:1024 sc1
    v_mfma_f32_16x16x32_bf16 v[212:215], v[148:151], a[28:31], v[212:215]
    ds_read_b128 v[144:147], v8 offset:31744
    ds_read_b128 v[148:151], v8 offset:38912
    v_mfma_f32_16x16x32_bf16 v[216:219], v[104:107], a[16:19], v[216:219]
    s_waitcnt lgkmcnt(2)
    v_mfma_f32_16x16x32_bf16 v[216:219], v[108:111], a[24:27], v[216:219]
    v_mfma_f32_16x16x32_bf16 v[220:223], v[104:107], a[20:23], v[220:223]
    buffer_load_dwordx4 a[112:115], v4, s[40:43], s63 offen offset:2048 sc1
    v_mfma_f32_16x16x32_bf16 v[220:223], v[108:111], a[28:31], v[220:223]
    ds_read_b128 v[104:107], v8 offset:32768
    ds_read_b128 v[108:111], v8 offset:39936
    v_mfma_f32_16x16x32_bf16 v[224:227], v[112:115], a[16:19], v[224:227]
    v_mfma_f32_16x16x32_bf16 v[224:227], v[116:119], a[24:27], v[224:227]
    v_mfma_f32_16x16x32_bf16 v[228:231], v[112:115], a[20:23], v[228:231]
    buffer_load_dwordx4 a[116:119], v5, s[40:43], s63 offen offset:2048 sc1
    v_mfma_f32_16x16x32_bf16 v[228:231], v[116:119], a[28:31], v[228:231]
    ds_read_b128 v[112:115], v8 offset:33792
    ds_read_b128 v[116:119], v8 offset:40960
    v_mfma_f32_16x16x32_bf16 v[176:179], v[120:123], a[32:35], v[176:179]
    v_mfma_f32_16x16x32_bf16 v[176:179], v[124:127], a[40:43], v[176:179]
    v_mfma_f32_16x16x32_bf16 v[180:183], v[120:123], a[36:39], v[180:183]
    buffer_load_dwordx4 a[120:123], v4, s[40:43], s63 offen offset:3072 sc1
    v_mfma_f32_16x16x32_bf16 v[180:183], v[124:127], a[44:47], v[180:183]
    ds_read_b128 v[120:123], v8 offset:34816
    ds_read_b128 v[124:127], v8 offset:41984
    v_mfma_f32_16x16x32_bf16 v[184:187], v[128:131], a[32:35], v[184:187]
    v_mfma_f32_16x16x32_bf16 v[184:187], v[132:135], a[40:43], v[184:187]
    v_mfma_f32_16x16x32_bf16 v[188:191], v[128:131], a[36:39], v[188:191]
    ds_read_b128 v[128:131], v8 offset:43008
    v_mfma_f32_16x16x32_bf16 v[188:191], v[132:135], a[44:47], v[188:191]
    buffer_load_dwordx4 a[124:127], v5, s[40:43], s63 offen offset:3072 sc1
    v_mfma_f32_16x16x32_bf16 v[192:195], v[136:139], a[32:35], v[192:195]
    s_xor_b32 s21, s3, 4
    ds_read_b128 v[132:135], v8 offset:50176
    v_mfma_f32_16x16x32_bf16 v[192:195], v[140:143], a[40:43], v[192:195]
    s_lshl2_add_u32 s21, s21, s4
    v_mfma_f32_16x16x32_bf16 v[196:199], v[136:139], a[36:39], v[196:199]
    s_mul_i32 s21, s21, 36864
    ds_read_b128 v[136:139], v8 offset:44032
    v_mfma_f32_16x16x32_bf16 v[196:199], v[140:143], a[44:47], v[196:199]
    s_add_u32 s64, s21, s17
    s_add_u32 m0, s78, 114688
    ds_read_b128 v[140:143], v8 offset:51200
    s_waitcnt lgkmcnt(3)
    v_mfma_f32_16x16x32_bf16 v[200:203], v[144:147], a[32:35], v[200:203]
    s_xor_b32 s63, s63, 28672
    buffer_load_dwordx4 v1, s[56:59], s64 offen sc1 lds
    v_mfma_f32_16x16x32_bf16 v[200:203], v[148:151], a[40:43], v[200:203]
    v_mfma_f32_16x16x32_bf16 v[204:207], v[144:147], a[36:39], v[204:207]
    ds_read_b128 v[144:147], v8 offset:45056
    v_mfma_f32_16x16x32_bf16 v[204:207], v[148:151], a[44:47], v[204:207]
    buffer_load_dwordx4 v1, s[56:59], s64 offen offset:1024 sc1 lds
    v_mfma_f32_16x16x32_bf16 v[208:211], v[104:107], a[32:35], v[208:211]
    s_add_u32 s64, s21, s18
    ds_read_b128 v[148:151], v8 offset:52224
    v_mfma_f32_16x16x32_bf16 v[208:211], v[108:111], a[40:43], v[208:211]
    s_add_u32 m0, s78, 116736
    v_mfma_f32_16x16x32_bf16 v[212:215], v[104:107], a[36:39], v[212:215]
    ds_read_b128 v[104:107], v8 offset:46080
    v_mfma_f32_16x16x32_bf16 v[212:215], v[108:111], a[44:47], v[212:215]
    buffer_load_dwordx4 v1, s[56:59], s64 offen sc1 lds
    v_mfma_f32_16x16x32_bf16 v[216:219], v[112:115], a[32:35], v[216:219]
    ds_read_b128 v[108:111], v8 offset:53248
    v_mfma_f32_16x16x32_bf16 v[216:219], v[116:119], a[40:43], v[216:219]
    v_mfma_f32_16x16x32_bf16 v[220:223], v[112:115], a[36:39], v[220:223]
    ds_read_b128 v[112:115], v8 offset:47104
    v_mfma_f32_16x16x32_bf16 v[220:223], v[116:119], a[44:47], v[220:223]
    buffer_load_dwordx4 v1, s[56:59], s64 offen offset:1024 sc1 lds
    v_mfma_f32_16x16x32_bf16 v[224:227], v[120:123], a[32:35], v[224:227]
    ds_read_b128 v[116:119], v8 offset:54272
    v_mfma_f32_16x16x32_bf16 v[224:227], v[124:127], a[40:43], v[224:227]
    s_add_u32 s64, s21, s19
    v_mfma_f32_16x16x32_bf16 v[228:231], v[120:123], a[36:39], v[228:231]
    s_add_u32 m0, s78, 118784
    ds_read_b128 v[120:123], v8 offset:48128
    v_mfma_f32_16x16x32_bf16 v[228:231], v[124:127], a[44:47], v[228:231]
    ds_read_b128 v[124:127], v8 offset:55296
    v_mfma_f32_16x16x32_bf16 v[176:179], v[128:131], a[48:51], v[176:179]
    s_waitcnt lgkmcnt(3)
    buffer_load_dwordx4 v1, s[56:59], s64 offen sc1 lds
    v_mfma_f32_16x16x32_bf16 v[176:179], v[132:135], a[56:59], v[176:179]
    v_mfma_f32_16x16x32_bf16 v[180:183], v[128:131], a[52:55], v[180:183]
    ds_read_b128 v[128:131], v8 offset:49152
    v_mfma_f32_16x16x32_bf16 v[180:183], v[132:135], a[60:63], v[180:183]
    ds_read_b128 v[132:135], v8 offset:56320
    v_mfma_f32_16x16x32_bf16 v[184:187], v[136:139], a[48:51], v[184:187]
    buffer_load_dwordx4 v1, s[56:59], s64 offen offset:1024 sc1 lds
    v_mfma_f32_16x16x32_bf16 v[184:187], v[140:143], a[56:59], v[184:187]
    s_add_u32 s64, s21, s20
    v_mfma_f32_16x16x32_bf16 v[188:191], v[136:139], a[52:55], v[188:191]
    s_add_u32 m0, s78, 120832
    ds_read_b128 v[136:139], v8 offset:57344
    v_mfma_f32_16x16x32_bf16 v[188:191], v[140:143], a[60:63], v[188:191]
    ds_read_b128 v[140:143], v8 offset:64512
    v_mfma_f32_16x16x32_bf16 v[192:195], v[144:147], a[48:51], v[192:195]
    buffer_load_dwordx4 v1, s[56:59], s64 offen sc1 lds
    v_mfma_f32_16x16x32_bf16 v[192:195], v[148:151], a[56:59], v[192:195]
    v_mfma_f32_16x16x32_bf16 v[196:199], v[144:147], a[52:55], v[196:199]
    ds_read_b128 v[144:147], v8 offset:58368
    v_mfma_f32_16x16x32_bf16 v[196:199], v[148:151], a[60:63], v[196:199]
    ds_read_b128 v[148:151], v9 offset:0
    v_mfma_f32_16x16x32_bf16 v[200:203], v[104:107], a[48:51], v[200:203]
    buffer_load_dwordx4 a[128:131], v4, s[40:43], s63 offen offset:0 sc1
    v_mfma_f32_16x16x32_bf16 v[200:203], v[108:111], a[56:59], v[200:203]
    v_mfma_f32_16x16x32_bf16 v[204:207], v[104:107], a[52:55], v[204:207]
    ds_read_b128 v[104:107], v8 offset:59392
    v_mfma_f32_16x16x32_bf16 v[204:207], v[108:111], a[60:63], v[204:207]
    s_waitcnt vmcnt(16)
    s_barrier
    v_mov_b32 v31, 3
    v_mfma_f32_16x16x32_bf16 v[208:211], v[112:115], a[48:51], v[208:211]
    s_waitcnt lgkmcnt(1)
    buffer_load_dwordx4 a[132:135], v5, s[40:43], s63 offen offset:0 sc1
    v_mfma_f32_16x16x32_bf16 v[208:211], v[116:119], a[56:59], v[208:211]
    buffer_store_dword v31, v30, s[32:35], s101 offen sc1
    v_mfma_f32_16x16x32_bf16 v[212:215], v[112:115], a[52:55], v[212:215]
    ds_read_b128 v[108:111], v9 offset:1024
    ds_read_b128 v[112:115], v8 offset:60416
    v_mfma_f32_16x16x32_bf16 v[212:215], v[116:119], a[60:63], v[212:215]
    ds_read_b128 v[116:119], v9 offset:2048
    v_mfma_f32_16x16x32_bf16 v[216:219], v[120:123], a[48:51], v[216:219]
    v_mfma_f32_16x16x32_bf16 v[216:219], v[124:127], a[56:59], v[216:219]
    buffer_load_dwordx4 a[136:139], v4, s[40:43], s63 offen offset:1024 sc1
    v_mfma_f32_16x16x32_bf16 v[220:223], v[120:123], a[52:55], v[220:223]
    ds_read_b128 v[120:123], v8 offset:61440
    v_mfma_f32_16x16x32_bf16 v[220:223], v[124:127], a[60:63], v[220:223]
    ds_read_b128 v[124:127], v9 offset:3072
    v_mfma_f32_16x16x32_bf16 v[224:227], v[128:131], a[48:51], v[224:227]
    v_mfma_f32_16x16x32_bf16 v[224:227], v[132:135], a[56:59], v[224:227]
    buffer_load_dwordx4 a[140:143], v5, s[40:43], s63 offen offset:1024 sc1
    v_mfma_f32_16x16x32_bf16 v[228:231], v[128:131], a[52:55], v[228:231]
    ds_read_b128 v[128:131], v8 offset:62464
    v_mfma_f32_16x16x32_bf16 v[228:231], v[132:135], a[60:63], v[228:231]
    ds_read_b128 v[132:135], v9 offset:4096
    v_mfma_f32_16x16x32_bf16 v[176:179], v[136:139], a[64:67], v[176:179]
    v_mfma_f32_16x16x32_bf16 v[176:179], v[140:143], a[72:75], v[176:179]
    buffer_load_dwordx4 a[144:147], v4, s[40:43], s63 offen offset:2048 sc1
    v_mfma_f32_16x16x32_bf16 v[180:183], v[136:139], a[68:71], v[180:183]
    ds_read_b128 v[136:139], v8 offset:63488
    v_mfma_f32_16x16x32_bf16 v[180:183], v[140:143], a[76:79], v[180:183]
    ds_read_b128 v[140:143], v9 offset:5120
    v_mfma_f32_16x16x32_bf16 v[184:187], v[144:147], a[64:67], v[184:187]
    v_mfma_f32_16x16x32_bf16 v[184:187], v[148:151], a[72:75], v[184:187]
    buffer_load_dwordx4 a[148:151], v5, s[40:43], s63 offen offset:2048 sc1
    v_mfma_f32_16x16x32_bf16 v[188:191], v[144:147], a[68:71], v[188:191]
    ds_read_b128 v[144:147], v9 offset:6144
    v_mfma_f32_16x16x32_bf16 v[188:191], v[148:151], a[76:79], v[188:191]
    s_waitcnt lgkmcnt(2)
    ds_read_b128 v[148:151], v9 offset:13312
    v_mfma_f32_16x16x32_bf16 v[192:195], v[104:107], a[64:67], v[192:195]
    v_mfma_f32_16x16x32_bf16 v[192:195], v[108:111], a[72:75], v[192:195]
    buffer_load_dwordx4 a[152:155], v4, s[40:43], s63 offen offset:3072 sc1
    v_mfma_f32_16x16x32_bf16 v[196:199], v[104:107], a[68:71], v[196:199]
    ds_read_b128 v[104:107], v9 offset:7168
    v_mfma_f32_16x16x32_bf16 v[196:199], v[108:111], a[76:79], v[196:199]
    ds_read_b128 v[108:111], v9 offset:14336
    v_mfma_f32_16x16x32_bf16 v[200:203], v[112:115], a[64:67], v[200:203]
    v_mfma_f32_16x16x32_bf16 v[200:203], v[116:119], a[72:75], v[200:203]
    v_mfma_f32_16x16x32_bf16 v[204:207], v[112:115], a[68:71], v[204:207]
    buffer_load_dwordx4 a[156:159], v5, s[40:43], s63 offen offset:3072 sc1
    v_mfma_f32_16x16x32_bf16 v[204:207], v[116:119], a[76:79], v[204:207]
    s_xor_b32 s21, s3, 5
    ds_read_b128 v[112:115], v9 offset:8192
    ds_read_b128 v[116:119], v9 offset:15360
    v_mfma_f32_16x16x32_bf16 v[208:211], v[120:123], a[64:67], v[208:211]
    s_lshl2_add_u32 s21, s21, s4
    v_mfma_f32_16x16x32_bf16 v[208:211], v[124:127], a[72:75], v[208:211]
    s_mul_i32 s21, s21, 36864
    v_mfma_f32_16x16x32_bf16 v[212:215], v[120:123], a[68:71], v[212:215]
    s_add_u32 s64, s21, s17
    s_add_u32 m0, s78, 0
    ds_read_b128 v[120:123], v9 offset:9216
    v_mfma_f32_16x16x32_bf16 v[212:215], v[124:127], a[76:79], v[212:215]
    s_xor_b32 s63, s63, 4096
    buffer_load_dwordx4 v1, s[56:59], s64 offen sc1 lds
    v_mfma_f32_16x16x32_bf16 v[216:219], v[128:131], a[64:67], v[216:219]
    ds_read_b128 v[124:127], v9 offset:16384
    v_mfma_f32_16x16x32_bf16 v[216:219], v[132:135], a[72:75], v[216:219]
    v_mfma_f32_16x16x32_bf16 v[220:223], v[128:131], a[68:71], v[220:223]
    buffer_load_dwordx4 v1, s[56:59], s64 offen offset:1024 sc1 lds
    v_mfma_f32_16x16x32_bf16 v[220:223], v[132:135], a[76:79], v[220:223]
    s_add_u32 s64, s21, s18
    ds_read_b128 v[128:131], v9 offset:10240
    ds_read_b128 v[132:135], v9 offset:17408
    v_mfma_f32_16x16x32_bf16 v[224:227], v[136:139], a[64:67], v[224:227]
    s_add_u32 m0, s78, 2048
    s_waitcnt lgkmcnt(3)
    v_mfma_f32_16x16x32_bf16 v[224:227], v[140:143], a[72:75], v[224:227]
    v_mfma_f32_16x16x32_bf16 v[228:231], v[136:139], a[68:71], v[228:231]
    buffer_load_dwordx4 v1, s[56:59], s64 offen sc1 lds
    v_mfma_f32_16x16x32_bf16 v[228:231], v[140:143], a[76:79], v[228:231]
    ds_read_b128 v[136:139], v9 offset:11264
    ds_read_b128 v[140:143], v9 offset:18432
    v_mfma_f32_16x16x32_bf16 v[176:179], v[144:147], a[80:83], v[176:179]
    v_mfma_f32_16x16x32_bf16 v[176:179], v[148:151], a[88:91], v[176:179]
    v_mfma_f32_16x16x32_bf16 v[180:183], v[144:147], a[84:87], v[180:183]
    buffer_load_dwordx4 v1, s[56:59], s64 offen offset:1024 sc1 lds
    v_mfma_f32_16x16x32_bf16 v[180:183], v[148:151], a[92:95], v[180:183]
    ds_read_b128 v[144:147], v9 offset:12288
    ds_read_b128 v[148:151], v9 offset:19456
    v_mfma_f32_16x16x32_bf16 v[184:187], v[104:107], a[80:83], v[184:187]
    s_add_u32 s64, s21, s19
    v_mfma_f32_16x16x32_bf16 v[184:187], v[108:111], a[88:91], v[184:187]
    s_add_u32 m0, s78, 4096
    v_mfma_f32_16x16x32_bf16 v[188:191], v[104:107], a[84:87], v[188:191]
    ds_read_b128 v[104:107], v9 offset:20480
    v_mfma_f32_16x16x32_bf16 v[188:191], v[108:111], a[92:95], v[188:191]
    buffer_load_dwordx4 v1, s[56:59], s64 offen sc1 lds
    v_mfma_f32_16x16x32_bf16 v[192:195], v[112:115], a[80:83], v[192:195]
    ds_read_b128 v[108:111], v9 offset:27648
    v_mfma_f32_16x16x32_bf16 v[192:195], v[116:119], a[88:91], v[192:195]
    v_mfma_f32_16x16x32_bf16 v[196:199], v[112:115], a[84:87], v[196:199]
    ds_read_b128 v[112:115], v9 offset:21504
    v_mfma_f32_16x16x32_bf16 v[196:199], v[116:119], a[92:95], v[196:199]
    buffer_load_dwordx4 v1, s[56:59], s64 offen offset:1024 sc1 lds
    v_mfma_f32_16x16x32_bf16 v[200:203], v[120:123], a[80:83], v[200:203]
    s_add_u32 s64, s21, s20
    ds_read_b128 v[116:119], v9 offset:28672
    s_waitcnt lgkmcnt(3)
    v_mfma_f32_16x16x32_bf16 v[200:203], v[124:127], a[88:91], v[200:203]
    s_add_u32 m0, s78, 6144
    v_mfma_f32_16x16x32_bf16 v[204:207], v[120:123], a[84:87], v[204:207]
    ds_read_b128 v[120:123], v9 offset:22528
    v_mfma_f32_16x16x32_bf16 v[204:207], v[124:127], a[92:95], v[204:207]
    s_waitcnt vmcnt(22)
    s_barrier
    ds_read_b128 v[124:127], v9 offset:29696
    v_mfma_f32_16x16x32_bf16 v[208:211], v[128:131], a[80:83], v[208:211]
    buffer_load_dwordx4 v1, s[56:59], s64 offen sc1 lds
    v_mfma_f32_16x16x32_bf16 v[208:211], v[132:135], a[88:91], v[208:211]
    v_mfma_f32_16x16x32_bf16 v[212:215], v[128:131], a[84:87], v[212:215]
    ds_read_b128 v[128:131], v9 offset:23552
    v_mfma_f32_16x16x32_bf16 v[212:215], v[132:135], a[92:95], v[212:215]
    buffer_load_dwordx4 a[160:163], v4, s[40:43], s63 offen offset:0 sc1
    v_mfma_f32_16x16x32_bf16 v[216:219], v[136:139], a[80:83], v[216:219]
    ds_read_b128 v[132:135], v9 offset:30720
    v_mfma_f32_16x16x32_bf16 v[216:219], v[140:143], a[88:91], v[216:219]
    v_mfma_f32_16x16x32_bf16 v[220:223], v[136:139], a[84:87], v[220:223]
    ds_read_b128 v[136:139], v9 offset:24576
    v_mfma_f32_16x16x32_bf16 v[220:223], v[140:143], a[92:95], v[220:223]
    buffer_load_dwordx4 a[164:167], v5, s[40:43], s63 offen offset:0 sc1
    v_mfma_f32_16x16x32_bf16 v[224:227], v[144:147], a[80:83], v[224:227]
    ds_read_b128 v[140:143], v9 offset:31744
    v_mfma_f32_16x16x32_bf16 v[224:227], v[148:151], a[88:91], v[224:227]
    v_mfma_f32_16x16x32_bf16 v[228:231], v[144:147], a[84:87], v[228:231]
    ds_read_b128 v[144:147], v9 offset:25600
    v_mfma_f32_16x16x32_bf16 v[228:231], v[148:151], a[92:95], v[228:231]
    buffer_load_dwordx4 a[168:171], v4, s[40:43], s63 offen offset:1024 sc1
    v_mfma_f32_16x16x32_bf16 v[176:179], v[104:107], a[96:99], v[176:179]
    s_waitcnt lgkmcnt(2)
    ds_read_b128 v[148:151], v9 offset:32768
    v_mfma_f32_16x16x32_bf16 v[176:179], v[108:111], a[104:107], v[176:179]
    v_mfma_f32_16x16x32_bf16 v[180:183], v[104:107], a[100:103], v[180:183]
    ds_read_b128 v[104:107], v9 offset:26624
    v_mfma_f32_16x16x32_bf16 v[180:183], v[108:111], a[108:111], v[180:183]
    ds_read_b128 v[108:111], v9 offset:33792
    v_mfma_f32_16x16x32_bf16 v[184:187], v[112:115], a[96:99], v[184:187]
    buffer_load_dwordx4 a[172:175], v5, s[40:43], s63 offen offset:1024 sc1
    v_mfma_f32_16x16x32_bf16 v[184:187], v[116:119], a[104:107], v[184:187]
    v_mfma_f32_16x16x32_bf16 v[188:191], v[112:115], a[100:103], v[188:191]
    ds_read_b128 v[112:115], v9 offset:34816
    v_mfma_f32_16x16x32_bf16 v[188:191], v[116:119], a[108:111], v[188:191]
    ds_read_b128 v[116:119], v9 offset:41984
    v_mfma_f32_16x16x32_bf16 v[192:195], v[120:123], a[96:99], v[192:195]
    buffer_load_dwordx4 a[176:179], v4, s[40:43], s63 offen offset:2048 sc1
    v_mfma_f32_16x16x32_bf16 v[192:195], v[124:127], a[104:107], v[192:195]
    v_mfma_f32_16x16x32_bf16 v[196:199], v[120:123], a[100:103], v[196:199]
    ds_read_b128 v[120:123], v9 offset:35840
    v_mfma_f32_16x16x32_bf16 v[196:199], v[124:127], a[108:111], v[196:199]
    ds_read_b128 v[124:127], v9 offset:43008
    v_mfma_f32_16x16x32_bf16 v[200:203], v[128:131], a[96:99], v[200:203]
    buffer_load_dwordx4 a[180:183], v5, s[40:43], s63 offen offset:2048 sc1
    v_mfma_f32_16x16x32_bf16 v[200:203], v[132:135], a[104:107], v[200:203]
    v_mfma_f32_16x16x32_bf16 v[204:207], v[128:131], a[100:103], v[204:207]
    ds_read_b128 v[128:131], v9 offset:36864
    v_mfma_f32_16x16x32_bf16 v[204:207], v[132:135], a[108:111], v[204:207]
    ds_read_b128 v[132:135], v9 offset:44032
    v_mfma_f32_16x16x32_bf16 v[208:211], v[136:139], a[96:99], v[208:211]
    s_waitcnt lgkmcnt(2)
    buffer_load_dwordx4 a[184:187], v4, s[40:43], s63 offen offset:3072 sc1
    v_mfma_f32_16x16x32_bf16 v[208:211], v[140:143], a[104:107], v[208:211]
    v_mfma_f32_16x16x32_bf16 v[212:215], v[136:139], a[100:103], v[212:215]
    ds_read_b128 v[136:139], v9 offset:37888
    v_mfma_f32_16x16x32_bf16 v[212:215], v[140:143], a[108:111], v[212:215]
    ds_read_b128 v[140:143], v9 offset:45056
    v_mfma_f32_16x16x32_bf16 v[216:219], v[144:147], a[96:99], v[216:219]
    buffer_load_dwordx4 a[188:191], v5, s[40:43], s63 offen offset:3072 sc1
    v_mfma_f32_16x16x32_bf16 v[216:219], v[148:151], a[104:107], v[216:219]
    v_mfma_f32_16x16x32_bf16 v[220:223], v[144:147], a[100:103], v[220:223]
    s_xor_b32 s21, s3, 6
    ds_read_b128 v[144:147], v9 offset:38912
    v_mfma_f32_16x16x32_bf16 v[220:223], v[148:151], a[108:111], v[220:223]
    s_lshl2_add_u32 s21, s21, s4
    ds_read_b128 v[148:151], v9 offset:46080
    v_mfma_f32_16x16x32_bf16 v[224:227], v[104:107], a[96:99], v[224:227]
    s_mul_i32 s21, s21, 36864
    v_mfma_f32_16x16x32_bf16 v[224:227], v[108:111], a[104:107], v[224:227]
    s_add_u32 s64, s21, s17
    s_add_u32 m0, s78, 28672
    v_mfma_f32_16x16x32_bf16 v[228:231], v[104:107], a[100:103], v[228:231]
    s_xor_b32 s63, s63, 12288
    buffer_load_dwordx4 v1, s[56:59], s64 offen sc1 lds
    v_mfma_f32_16x16x32_bf16 v[228:231], v[108:111], a[108:111], v[228:231]
    ds_read_b128 v[104:107], v9 offset:39936
    ds_read_b128 v[108:111], v9 offset:47104
    v_mfma_f32_16x16x32_bf16 v[176:179], v[112:115], a[112:115], v[176:179]
    v_mfma_f32_16x16x32_bf16 v[176:179], v[116:119], a[120:123], v[176:179]
    buffer_load_dwordx4 v1, s[56:59], s64 offen offset:1024 sc1 lds
    v_mfma_f32_16x16x32_bf16 v[180:183], v[112:115], a[116:119], v[180:183]
    s_add_u32 s64, s21, s18
    ds_read_b128 v[112:115], v9 offset:40960
    v_mfma_f32_16x16x32_bf16 v[180:183], v[116:119], a[124:127], v[180:183]
    s_add_u32 m0, s78, 30720
    ds_read_b128 v[116:119], v9 offset:48128
    v_mfma_f32_16x16x32_bf16 v[184:187], v[120:123], a[112:115], v[184:187]
    v_mfma_f32_16x16x32_bf16 v[184:187], v[124:127], a[120:123], v[184:187]
    buffer_load_dwordx4 v1, s[56:59], s64 offen sc1 lds
    v_mfma_f32_16x16x32_bf16 v[188:191], v[120:123], a[116:119], v[188:191]
    v_mfma_f32_16x16x32_bf16 v[188:191], v[124:127], a[124:127], v[188:191]
    s_waitcnt lgkmcnt(1)
    v_mfma_f32_16x16x32_bf16 v[192:195], v[128:131], a[112:115], v[192:195]
    v_mfma_f32_16x16x32_bf16 v[192:195], v[132:135], a[120:123], v[192:195]
    buffer_load_dwordx4 v1, s[56:59], s64 offen offset:1024 sc1 lds
    v_mfma_f32_16x16x32_bf16 v[196:199], v[128:131], a[116:119], v[196:199]
    s_add_u32 s64, s21, s19
    v_mfma_f32_16x16x32_bf16 v[196:199], v[132:135], a[124:127], v[196:199]
    s_add_u32 m0, s78, 32768
    v_mfma_f32_16x16x32_bf16 v[200:203], v[136:139], a[112:115], v[200:203]
    v_mfma_f32_16x16x32_bf16 v[200:203], v[140:143], a[120:123], v[200:203]
    buffer_load_dwordx4 v1, s[56:59], s64 offen sc1 lds
    v_mfma_f32_16x16x32_bf16 v[204:207], v[136:139], a[116:119], v[204:207]
    v_mfma_f32_16x16x32_bf16 v[204:207], v[140:143], a[124:127], v[204:207]
    s_waitcnt vmcnt(20)
    s_barrier
    ds_read_b128 v[120:123], v9 offset:49152
    v_mfma_f32_16x16x32_bf16 v[208:211], v[144:147], a[112:115], v[208:211]
    ds_read_b128 v[124:127], v9 offset:56320
    ds_read_b128 v[128:131], v9 offset:50176
    v_mfma_f32_16x16x32_bf16 v[208:211], v[148:151], a[120:123], v[208:211]
    ds_read_b128 v[132:135], v9 offset:57344
    v_mfma_f32_16x16x32_bf16 v[212:215], v[144:147], a[116:119], v[212:215]
    buffer_load_dwordx4 v1, s[56:59], s64 offen offset:1024 sc1 lds
    v_mfma_f32_16x16x32_bf16 v[212:215], v[148:151], a[124:127], v[212:215]
    s_add_u32 s64, s21, s20
    ds_read_b128 v[136:139], v9 offset:51200
    ds_read_b128 v[140:143], v9 offset:58368
    v_mfma_f32_16x16x32_bf16 v[216:219], v[104:107], a[112:115], v[216:219]
    s_add_u32 m0, s78, 34816
    ds_read_b128 v[144:147], v9 offset:52224
    v_mfma_f32_16x16x32_bf16 v[216:219], v[108:111], a[120:123], v[216:219]
    ds_read_b128 v[148:151], v9 offset:59392
    v_mfma_f32_16x16x32_bf16 v[220:223], v[104:107], a[116:119], v[220:223]
    buffer_load_dwordx4 v1, s[56:59], s64 offen sc1 lds
    v_mfma_f32_16x16x32_bf16 v[220:223], v[108:111], a[124:127], v[220:223]
    ds_read_b128 v[104:107], v9 offset:53248
    ds_read_b128 v[108:111], v9 offset:60416
    v_mfma_f32_16x16x32_bf16 v[224:227], v[112:115], a[112:115], v[224:227]
    s_waitcnt lgkmcnt(4)
    v_mfma_f32_16x16x32_bf16 v[224:227], v[116:119], a[120:123], v[224:227]
    v_mfma_f32_16x16x32_bf16 v[228:231], v[112:115], a[116:119], v[228:231]
    buffer_load_dwordx4 a[192:195], v4, s[40:43], s63 offen offset:0 sc1
    v_mfma_f32_16x16x32_bf16 v[228:231], v[116:119], a[124:127], v[228:231]
    ds_read_b128 v[112:115], v9 offset:54272
    ds_read_b128 v[116:119], v9 offset:61440
    v_mfma_f32_16x16x32_bf16 v[176:179], v[120:123], a[128:131], v[176:179]
    v_mfma_f32_16x16x32_bf16 v[176:179], v[124:127], a[136:139], v[176:179]
    v_mfma_f32_16x16x32_bf16 v[180:183], v[120:123], a[132:135], v[180:183]
    buffer_load_dwordx4 a[196:199], v5, s[40:43], s63 offen offset:0 sc1
    v_mfma_f32_16x16x32_bf16 v[180:183], v[124:127], a[140:143], v[180:183]
    ds_read_b128 v[120:123], v9 offset:55296
    ds_read_b128 v[124:127], v9 offset:62464
    v_mfma_f32_16x16x32_bf16 v[184:187], v[128:131], a[128:131], v[184:187]
    v_mfma_f32_16x16x32_bf16 v[184:187], v[132:135], a[136:139], v[184:187]
    v_mfma_f32_16x16x32_bf16 v[188:191], v[128:131], a[132:135], v[188:191]
    buffer_load_dwordx4 a[200:203], v4, s[40:43], s63 offen offset:1024 sc1
    v_mfma_f32_16x16x32_bf16 v[188:191], v[132:135], a[140:143], v[188:191]
    ds_read_b128 v[128:131], v9 offset:63488
    ds_read_b128 v[132:135], v10 offset:5120
    v_mfma_f32_16x16x32_bf16 v[192:195], v[136:139], a[128:131], v[192:195]
    v_mfma_f32_16x16x32_bf16 v[192:195], v[140:143], a[136:139], v[192:195]
    v_mfma_f32_16x16x32_bf16 v[196:199], v[136:139], a[132:135], v[196:199]
    ds_read_b128 v[136:139], v9 offset:64512
    v_mfma_f32_16x16x32_bf16 v[196:199], v[140:143], a[140:143], v[196:199]
    s_waitcnt lgkmcnt(3)
    buffer_load_dwordx4 a[204:207], v5, s[40:43], s63 offen offset:1024 sc1
    v_mfma_f32_16x16x32_bf16 v[200:203], v[144:147], a[128:131], v[200:203]
    ds_read_b128 v[140:143], v10 offset:6144
    v_mfma_f32_16x16x32_bf16 v[200:203], v[148:151], a[136:139], v[200:203]
    v_mfma_f32_16x16x32_bf16 v[204:207], v[144:147], a[132:135], v[204:207]
    ds_read_b128 v[144:147], v10 offset:0
    v_mfma_f32_16x16x32_bf16 v[204:207], v[148:151], a[140:143], v[204:207]
    buffer_load_dwordx4 a[208:211], v4, s[40:43], s63 offen offset:2048 sc1
    v_mfma_f32_16x16x32_bf16 v[208:211], v[104:107], a[128:131], v[208:211]
    ds_read_b128 v[148:151], v10 offset:7168
    v_mfma_f32_16x16x32_bf16 v[208:211], v[108:111], a[136:139], v[208:211]
    v_mfma_f32_16x16x32_bf16 v[212:215], v[104:107], a[132:135], v[212:215]
    ds_read_b128 v[104:107], v10 offset:1024
    v_mfma_f32_16x16x32_bf16 v[212:215], v[108:111], a[140:143], v[212:215]
    buffer_load_dwordx4 a[212:215], v5, s[40:43], s63 offen offset:2048 sc1
    v_mfma_f32_16x16x32_bf16 v[216:219], v[112:115], a[128:131], v[216:219]
    ds_read_b128 v[108:111], v10 offset:8192
    v_mfma_f32_16x16x32_bf16 v[216:219], v[116:119], a[136:139], v[216:219]
    v_mfma_f32_16x16x32_bf16 v[220:223], v[112:115], a[132:135], v[220:223]
    ds_read_b128 v[112:115], v10 offset:2048
    v_mfma_f32_16x16x32_bf16 v[220:223], v[116:119], a[140:143], v[220:223]
    buffer_load_dwordx4 a[216:219], v4, s[40:43], s63 offen offset:3072 sc1
    v_mfma_f32_16x16x32_bf16 v[224:227], v[120:123], a[128:131], v[224:227]
    ds_read_b128 v[116:119], v10 offset:9216
    v_mfma_f32_16x16x32_bf16 v[224:227], v[124:127], a[136:139], v[224:227]
    v_mfma_f32_16x16x32_bf16 v[228:231], v[120:123], a[132:135], v[228:231]
    ds_read_b128 v[120:123], v10 offset:3072
    v_mfma_f32_16x16x32_bf16 v[228:231], v[124:127], a[140:143], v[228:231]
    s_waitcnt lgkmcnt(2)
    buffer_load_dwordx4 a[220:223], v5, s[40:43], s63 offen offset:3072 sc1
    v_mfma_f32_16x16x32_bf16 v[176:179], v[128:131], a[144:147], v[176:179]
    ds_read_b128 v[124:127], v10 offset:10240
    v_mfma_f32_16x16x32_bf16 v[176:179], v[132:135], a[152:155], v[176:179]
    s_xor_b32 s63, s63, 4096
    v_mfma_f32_16x16x32_bf16 v[180:183], v[128:131], a[148:151], v[180:183]
    ds_read_b128 v[128:131], v10 offset:4096
    v_mfma_f32_16x16x32_bf16 v[180:183], v[132:135], a[156:159], v[180:183]
    ds_read_b128 v[132:135], v10 offset:11264
    v_mfma_f32_16x16x32_bf16 v[184:187], v[136:139], a[144:147], v[184:187]
    buffer_load_dword v3, v19, s[32:35], s66 offen sc1
    v_mfma_f32_16x16x32_bf16 v[184:187], v[140:143], a[152:155], v[184:187]
    s_xor_b32 s21, s3, 7
    v_mfma_f32_16x16x32_bf16 v[188:191], v[136:139], a[148:151], v[188:191]
    s_lshl2_add_u32 s21, s21, s4
    v_mfma_f32_16x16x32_bf16 v[188:191], v[140:143], a[156:159], v[188:191]
    s_mul_i32 s21, s21, 36864
    v_mfma_f32_16x16x32_bf16 v[192:195], v[144:147], a[144:147], v[192:195]
    s_add_u32 s64, s21, s17
    s_add_u32 m0, s78, 57344
    v_mfma_f32_16x16x32_bf16 v[192:195], v[148:151], a[152:155], v[192:195]
    buffer_load_dwordx4 v1, s[56:59], s64 offen sc1 lds
    v_mfma_f32_16x16x32_bf16 v[196:199], v[144:147], a[148:151], v[196:199]
    v_mfma_f32_16x16x32_bf16 v[196:199], v[148:151], a[156:159], v[196:199]
    v_mfma_f32_16x16x32_bf16 v[200:203], v[104:107], a[144:147], v[200:203]
    buffer_load_dwordx4 v1, s[56:59], s64 offen offset:1024 sc1 lds
    v_mfma_f32_16x16x32_bf16 v[200:203], v[108:111], a[152:155], v[200:203]
    s_add_u32 s64, s21, s18
    v_mfma_f32_16x16x32_bf16 v[204:207], v[104:107], a[148:151], v[204:207]
    s_add_u32 m0, s78, 59392
    v_mfma_f32_16x16x32_bf16 v[204:207], v[108:111], a[156:159], v[204:207]
    s_waitcnt vmcnt(18)
    s_barrier
    ds_read_b128 v[136:139], v8 offset:0
    v_mfma_f32_16x16x32_bf16 v[208:211], v[112:115], a[144:147], v[208:211]
    s_waitcnt lgkmcnt(1)
    buffer_load_dwordx4 v1, s[56:59], s64 offen sc1 lds
    v_mfma_f32_16x16x32_bf16 v[208:211], v[116:119], a[152:155], v[208:211]
    ds_read_b128 v[140:143], v8 offset:7168
    ds_read_b128 v[144:147], v8 offset:1024
    v_mfma_f32_16x16x32_bf16 v[212:215], v[112:115], a[148:151], v[212:215]
    ds_read_b128 v[148:151], v8 offset:8192
    v_mfma_f32_16x16x32_bf16 v[212:215], v[116:119], a[156:159], v[212:215]
    ds_read_b128 v[104:107], v8 offset:2048
    v_mfma_f32_16x16x32_bf16 v[216:219], v[120:123], a[144:147], v[216:219]
    buffer_load_dwordx4 v1, s[56:59], s64 offen offset:1024 sc1 lds
    v_mfma_f32_16x16x32_bf16 v[216:219], v[124:127], a[152:155], v[216:219]
    ds_read_b128 v[108:111], v8 offset:9216
    ds_read_b128 v[112:115], v8 offset:3072
    v_mfma_f32_16x16x32_bf16 v[220:223], v[120:123], a[148:151], v[220:223]
    s_add_u32 s64, s21, s19
    ds_read_b128 v[116:119], v8 offset:10240
    v_mfma_f32_16x16x32_bf16 v[220:223], v[124:127], a[156:159], v[220:223]
    s_add_u32 m0, s78, 61440
    ds_read_b128 v[120:123], v8 offset:4096
    v_mfma_f32_16x16x32_bf16 v[224:227], v[128:131], a[144:147], v[224:227]
    ds_read_b128 v[124:127], v8 offset:11264
    v_mfma_f32_16x16x32_bf16 v[224:227], v[132:135], a[152:155], v[224:227]
    buffer_load_dwordx4 v1, s[56:59], s64 offen sc1 lds
    v_mfma_f32_16x16x32_bf16 v[228:231], v[128:131], a[148:151], v[228:231]
    ds_read_b128 v[128:131], v8 offset:5120
    v_mfma_f32_16x16x32_bf16 v[228:231], v[132:135], a[156:159], v[228:231]
    s_waitcnt lgkmcnt(3)
    ds_read_b128 v[132:135], v8 offset:12288
    v_mfma_f32_16x16x32_bf16 v[176:179], v[136:139], a[160:163], v[176:179]
    v_mfma_f32_16x16x32_bf16 v[176:179], v[140:143], a[168:171], v[176:179]
    buffer_load_dwordx4 v1, s[56:59], s64 offen offset:1024 sc1 lds
    v_mfma_f32_16x16x32_bf16 v[180:183], v[136:139], a[164:167], v[180:183]
    s_add_u32 s64, s21, s20
    ds_read_b128 v[136:139], v8 offset:6144
    v_mfma_f32_16x16x32_bf16 v[180:183], v[140:143], a[172:175], v[180:183]
    s_add_u32 m0, s78, 63488
    ds_read_b128 v[140:143], v8 offset:13312
    v_mfma_f32_16x16x32_bf16 v[184:187], v[144:147], a[160:163], v[184:187]
    v_mfma_f32_16x16x32_bf16 v[184:187], v[148:151], a[168:171], v[184:187]
    buffer_load_dwordx4 v1, s[56:59], s64 offen sc1 lds
    v_mfma_f32_16x16x32_bf16 v[188:191], v[144:147], a[164:167], v[188:191]
    ds_read_b128 v[144:147], v8 offset:14336
    v_mfma_f32_16x16x32_bf16 v[188:191], v[148:151], a[172:175], v[188:191]
    ds_read_b128 v[148:151], v8 offset:21504
    v_mfma_f32_16x16x32_bf16 v[192:195], v[104:107], a[160:163], v[192:195]
    v_mfma_f32_16x16x32_bf16 v[192:195], v[108:111], a[168:171], v[192:195]
    buffer_load_dwordx4 a[224:227], v4, s[40:43], s63 offen offset:0 sc1
    v_mfma_f32_16x16x32_bf16 v[196:199], v[104:107], a[164:167], v[196:199]
    ds_read_b128 v[104:107], v8 offset:15360
    v_mfma_f32_16x16x32_bf16 v[196:199], v[108:111], a[172:175], v[196:199]
    ds_read_b128 v[108:111], v8 offset:22528
    v_mfma_f32_16x16x32_bf16 v[200:203], v[112:115], a[160:163], v[200:203]
    v_mfma_f32_16x16x32_bf16 v[200:203], v[116:119], a[168:171], v[200:203]
    buffer_load_dwordx4 a[228:231], v5, s[40:43], s63 offen offset:0 sc1
    v_mfma_f32_16x16x32_bf16 v[204:207], v[112:115], a[164:167], v[204:207]
    ds_read_b128 v[112:115], v8 offset:16384
    v_mfma_f32_16x16x32_bf16 v[204:207], v[116:119], a[172:175], v[204:207]
    s_waitcnt lgkmcnt(2)
    ds_read_b128 v[116:119], v8 offset:23552
    v_mfma_f32_16x16x32_bf16 v[208:211], v[120:123], a[160:163], v[208:211]
    v_mfma_f32_16x16x32_bf16 v[208:211], v[124:127], a[168:171], v[208:211]
    v_mfma_f32_16x16x32_bf16 v[212:215], v[120:123], a[164:167], v[212:215]
    buffer_load_dwordx4 a[232:235], v4, s[40:43], s63 offen offset:1024 sc1
    v_mfma_f32_16x16x32_bf16 v[212:215], v[124:127], a[172:175], v[212:215]
    ds_read_b128 v[120:123], v8 offset:17408
    ds_read_b128 v[124:127], v8 offset:24576
    v_mfma_f32_16x16x32_bf16 v[216:219], v[128:131], a[160:163], v[216:219]
    v_mfma_f32_16x16x32_bf16 v[216:219], v[132:135], a[168:171], v[216:219]
    v_mfma_f32_16x16x32_bf16 v[220:223], v[128:131], a[164:167], v[220:223]
    buffer_load_dwordx4 a[236:239], v5, s[40:43], s63 offen offset:1024 sc1
    v_mfma_f32_16x16x32_bf16 v[220:223], v[132:135], a[172:175], v[220:223]
    ds_read_b128 v[128:131], v8 offset:18432
    ds_read_b128 v[132:135], v8 offset:25600
    v_mfma_f32_16x16x32_bf16 v[224:227], v[136:139], a[160:163], v[224:227]
    v_mfma_f32_16x16x32_bf16 v[224:227], v[140:143], a[168:171], v[224:227]
    v_mfma_f32_16x16x32_bf16 v[228:231], v[136:139], a[164:167], v[228:231]
    buffer_load_dwordx4 a[240:243], v4, s[40:43], s63 offen offset:2048 sc1
    v_mfma_f32_16x16x32_bf16 v[228:231], v[140:143], a[172:175], v[228:231]
    ds_read_b128 v[136:139], v8 offset:19456
    ds_read_b128 v[140:143], v8 offset:26624
    v_mfma_f32_16x16x32_bf16 v[176:179], v[144:147], a[176:179], v[176:179]
    v_mfma_f32_16x16x32_bf16 v[176:179], v[148:151], a[184:187], v[176:179]
    v_mfma_f32_16x16x32_bf16 v[180:183], v[144:147], a[180:183], v[180:183]
    buffer_load_dwordx4 a[244:247], v5, s[40:43], s63 offen offset:2048 sc1
    v_mfma_f32_16x16x32_bf16 v[180:183], v[148:151], a[188:191], v[180:183]
    ds_read_b128 v[144:147], v8 offset:20480
    ds_read_b128 v[148:151], v8 offset:27648
    v_mfma_f32_16x16x32_bf16 v[184:187], v[104:107], a[176:179], v[184:187]
    s_waitcnt lgkmcnt(2)
    v_mfma_f32_16x16x32_bf16 v[184:187], v[108:111], a[184:187], v[184:187]
    v_mfma_f32_16x16x32_bf16 v[188:191], v[104:107], a[180:183], v[188:191]
    buffer_load_dwordx4 a[248:251], v4, s[40:43], s63 offen offset:3072 sc1
    v_mfma_f32_16x16x32_bf16 v[188:191], v[108:111], a[188:191], v[188:191]
    v_mfma_f32_16x16x32_bf16 v[192:195], v[112:115], a[176:179], v[192:195]
    v_mfma_f32_16x16x32_bf16 v[192:195], v[116:119], a[184:187], v[192:195]
    v_mfma_f32_16x16x32_bf16 v[196:199], v[112:115], a[180:183], v[196:199]
    v_mfma_f32_16x16x32_bf16 v[196:199], v[116:119], a[188:191], v[196:199]
    buffer_load_dwordx4 a[252:255], v5, s[40:43], s63 offen offset:3072 sc1
    v_mfma_f32_16x16x32_bf16 v[200:203], v[120:123], a[176:179], v[200:203]
    s_mul_i32 s21, s61, 6
    s_add_u32 s21, s4, s21
    v_mfma_f32_16x16x32_bf16 v[200:203], v[124:127], a[184:187], v[200:203]
    s_add_u32 s21, s21, 128
    v_mfma_f32_16x16x32_bf16 v[204:207], v[120:123], a[180:183], v[204:207]
    s_mul_i32 s21, s21, 36864
    v_mfma_f32_16x16x32_bf16 v[204:207], v[124:127], a[188:191], v[204:207]
    s_add_u32 s64, s21, s17
    s_add_u32 m0, s78, 86016
    s_waitcnt vmcnt(15)
    v_cmp_gt_u32 vcc, 3, v3
    s_nop 1
    s_and_b64 vcc, vcc, exec
    s_cbranch_scc1 SPIN_OA
BACK_OA:
    s_barrier
    v_mfma_f32_16x16x32_bf16 v[208:211], v[128:131], a[176:179], v[208:211]
    s_add_u32 s63, s63, 4096
    buffer_load_dwordx4 v1, s[56:59], s64 offen sc1 lds
    v_mfma_f32_16x16x32_bf16 v[208:211], v[132:135], a[184:187], v[208:211]
    ds_read_b128 v[104:107], v8 offset:28672
    ds_read_b128 v[108:111], v8 offset:35840
    v_mfma_f32_16x16x32_bf16 v[212:215], v[128:131], a[180:183], v[212:215]
    ds_read_b128 v[112:115], v8 offset:29696
    v_mfma_f32_16x16x32_bf16 v[212:215], v[132:135], a[188:191], v[212:215]
    buffer_load_dwordx4 v1, s[56:59], s64 offen offset:1024 sc1 lds
    v_mfma_f32_16x16x32_bf16 v[216:219], v[136:139], a[176:179], v[216:219]
    s_add_u32 s64, s21, s18
    ds_read_b128 v[116:119], v8 offset:36864
    ds_read_b128 v[120:123], v8 offset:30720
    v_mfma_f32_16x16x32_bf16 v[216:219], v[140:143], a[184:187], v[216:219]
    s_add_u32 m0, s78, 88064
    ds_read_b128 v[124:127], v8 offset:37888
    v_mfma_f32_16x16x32_bf16 v[220:223], v[136:139], a[180:183], v[220:223]
    ds_read_b128 v[128:131], v8 offset:31744
    v_mfma_f32_16x16x32_bf16 v[220:223], v[140:143], a[188:191], v[220:223]
    s_waitcnt lgkmcnt(4)
    buffer_load_dwordx4 v1, s[56:59], s64 offen sc1 lds
    v_mfma_f32_16x16x32_bf16 v[224:227], v[144:147], a[176:179], v[224:227]
    ds_read_b128 v[132:135], v8 offset:38912
    ds_read_b128 v[136:139], v8 offset:32768
    v_mfma_f32_16x16x32_bf16 v[224:227], v[148:151], a[184:187], v[224:227]
    ds_read_b128 v[140:143], v8 offset:39936
    v_mfma_f32_16x16x32_bf16 v[228:231], v[144:147], a[180:183], v[228:231]
    ds_read_b128 v[144:147], v8 offset:33792
    v_mfma_f32_16x16x32_bf16 v[228:231], v[148:151], a[188:191], v[228:231]
    buffer_load_dwordx4 v1, s[56:59], s64 offen offset:1024 sc1 lds
    v_mfma_f32_16x16x32_bf16 v[176:179], v[104:107], a[192:195], v[176:179]
    ds_read_b128 v[148:151], v8 offset:40960
    v_mfma_f32_16x16x32_bf16 v[176:179], v[108:111], a[200:203], v[176:179]
    s_add_u32 s64, s21, s19
    v_mfma_f32_16x16x32_bf16 v[180:183], v[104:107], a[196:199], v[180:183]
    s_add_u32 m0, s78, 90112
    ds_read_b128 v[104:107], v8 offset:34816
    v_mfma_f32_16x16x32_bf16 v[180:183], v[108:111], a[204:207], v[180:183]
    ds_read_b128 v[108:111], v8 offset:41984
    v_mfma_f32_16x16x32_bf16 v[184:187], v[112:115], a[192:195], v[184:187]
    s_waitcnt lgkmcnt(3)
    buffer_load_dwordx4 v1, s[56:59], s64 offen sc1 lds
    v_mfma_f32_16x16x32_bf16 v[184:187], v[116:119], a[200:203], v[184:187]
    v_mfma_f32_16x16x32_bf16 v[188:191], v[112:115], a[196:199], v[188:191]
    ds_read_b128 v[112:115], v8 offset:43008
    v_mfma_f32_16x16x32_bf16 v[188:191], v[116:119], a[204:207], v[188:191]
    ds_read_b128 v[116:119], v8 offset:50176
    v_mfma_f32_16x16x32_bf16 v[192:195], v[120:123], a[192:195], v[192:195]
    buffer_load_dwordx4 v1, s[56:59], s64 offen offset:1024 sc1 lds
    v_mfma_f32_16x16x32_bf16 v[192:195], v[124:127], a[200:203], v[192:195]
    s_add_u32 s64, s21, s20
    v_mfma_f32_16x16x32_bf16 v[196:199], v[120:123], a[196:199], v[196:199]
    s_add_u32 m0, s78, 92160
    ds_read_b128 v[120:123], v8 offset:44032
    v_mfma_f32_16x16x32_bf16 v[196:199], v[124:127], a[204:207], v[196:199]
    ds_read_b128 v[124:127], v8 offset:51200
    v_mfma_f32_16x16x32_bf16 v[200:203], v[128:131], a[192:195], v[200:203]
    buffer_load_dwordx4 v1, s[56:59], s64 offen sc1 lds
    v_mfma_f32_16x16x32_bf16 v[200:203], v[132:135], a[200:203], v[200:203]
    s_mul_i32 s63, s61, 6144
    v_mfma_f32_16x16x32_bf16 v[204:207], v[128:131], a[196:199], v[204:207]
    s_add_u32 s63, s63, 131072
    ds_read_b128 v[128:131], v8 offset:45056
    v_mfma_f32_16x16x32_bf16 v[204:207], v[132:135], a[204:207], v[204:207]
    ds_read_b128 v[132:135], v8 offset:52224
    v_mfma_f32_16x16x32_bf16 v[208:211], v[136:139], a[192:195], v[208:211]
    buffer_load_dwordx4 v[32:35], v4, s[40:43], s63 offen offset:0 sc1
    v_mfma_f32_16x16x32_bf16 v[208:211], v[140:143], a[200:203], v[208:211]
    v_mfma_f32_16x16x32_bf16 v[212:215], v[136:139], a[196:199], v[212:215]
    ds_read_b128 v[136:139], v8 offset:46080
    v_mfma_f32_16x16x32_bf16 v[212:215], v[140:143], a[204:207], v[212:215]
    ds_read_b128 v[140:143], v8 offset:53248
    v_mfma_f32_16x16x32_bf16 v[216:219], v[144:147], a[192:195], v[216:219]
    s_waitcnt lgkmcnt(2)
    buffer_load_dwordx4 v[36:39], v5, s[40:43], s63 offen offset:0 sc1
    v_mfma_f32_16x16x32_bf16 v[216:219], v[148:151], a[200:203], v[216:219]
    v_mfma_f32_16x16x32_bf16 v[220:223], v[144:147], a[196:199], v[220:223]
    ds_read_b128 v[144:147], v8 offset:47104
    v_mfma_f32_16x16x32_bf16 v[220:223], v[148:151], a[204:207], v[220:223]
    ds_read_b128 v[148:151], v8 offset:54272
    v_mfma_f32_16x16x32_bf16 v[224:227], v[104:107], a[192:195], v[224:227]
    v_mfma_f32_16x16x32_bf16 v[224:227], v[108:111], a[200:203], v[224:227]
    buffer_load_dwordx4 v[40:43], v4, s[40:43], s63 offen offset:1024 sc1
    v_mfma_f32_16x16x32_bf16 v[228:231], v[104:107], a[196:199], v[228:231]
    ds_read_b128 v[104:107], v8 offset:48128
    v_mfma_f32_16x16x32_bf16 v[228:231], v[108:111], a[204:207], v[228:231]
    ds_read_b128 v[108:111], v8 offset:55296
    v_mfma_f32_16x16x32_bf16 v[176:179], v[112:115], a[208:211], v[176:179]
    v_mfma_f32_16x16x32_bf16 v[176:179], v[116:119], a[216:219], v[176:179]
    buffer_load_dwordx4 v[44:47], v5, s[40:43], s63 offen offset:1024 sc1
    v_mfma_f32_16x16x32_bf16 v[180:183], v[112:115], a[212:215], v[180:183]
    ds_read_b128 v[112:115], v8 offset:49152
    v_mfma_f32_16x16x32_bf16 v[180:183], v[116:119], a[220:223], v[180:183]
    ds_read_b128 v[116:119], v8 offset:56320
    v_mfma_f32_16x16x32_bf16 v[184:187], v[120:123], a[208:211], v[184:187]
    v_mfma_f32_16x16x32_bf16 v[184:187], v[124:127], a[216:219], v[184:187]
    buffer_load_dwordx4 v[48:51], v4, s[40:43], s63 offen offset:2048 sc1
    v_mfma_f32_16x16x32_bf16 v[188:191], v[120:123], a[212:215], v[188:191]
    v_mfma_f32_16x16x32_bf16 v[188:191], v[124:127], a[220:223], v[188:191]
    v_mfma_f32_16x16x32_bf16 v[192:195], v[128:131], a[208:211], v[192:195]
    v_mfma_f32_16x16x32_bf16 v[192:195], v[132:135], a[216:219], v[192:195]
    buffer_load_dwordx4 v[52:55], v5, s[40:43], s63 offen offset:2048 sc1
    v_mfma_f32_16x16x32_bf16 v[196:199], v[128:131], a[212:215], v[196:199]
    v_mfma_f32_16x16x32_bf16 v[196:199], v[132:135], a[220:223], v[196:199]
    s_waitcnt lgkmcnt(0)
    v_mfma_f32_16x16x32_bf16 v[200:203], v[136:139], a[208:211], v[200:203]
    v_mfma_f32_16x16x32_bf16 v[200:203], v[140:143], a[216:219], v[200:203]
    buffer_load_dwordx4 v[56:59], v4, s[40:43], s63 offen offset:3072 sc1
    v_mfma_f32_16x16x32_bf16 v[204:207], v[136:139], a[212:215], v[204:207]
    v_mfma_f32_16x16x32_bf16 v[204:207], v[140:143], a[220:223], v[204:207]
    s_waitcnt vmcnt(14)
    s_barrier
    ds_read_b128 v[120:123], v8 offset:57344
    v_mfma_f32_16x16x32_bf16 v[208:211], v[144:147], a[208:211], v[208:211]
    ds_read_b128 v[124:127], v8 offset:64512
    ds_read_b128 v[128:131], v8 offset:58368
    v_mfma_f32_16x16x32_bf16 v[208:211], v[148:151], a[216:219], v[208:211]
    ds_read_b128 v[132:135], v9 offset:0
    v_mfma_f32_16x16x32_bf16 v[212:215], v[144:147], a[212:215], v[212:215]
    buffer_load_dwordx4 v[60:63], v5, s[40:43], s63 offen offset:3072 sc1
    v_mfma_f32_16x16x32_bf16 v[212:215], v[148:151], a[220:223], v[212:215]
    s_mul_i32 s21, s61, 6
    s_cmp_eq_u32 s4, 0
    s_cselect_b32 s64, s17, s18
    v_mfma_f32_16x16x32_bf16 v[216:219], v[104:107], a[208:211], v[216:219]
    s_add_u32 s21, s21, 132
    s_cmp_eq_u32 s4, 2
    s_cselect_b32 s64, s19, s64
    v_mfma_f32_16x16x32_bf16 v[216:219], v[108:111], a[216:219], v[216:219]
    s_mul_i32 s21, s21, 36864
    s_cmp_eq_u32 s4, 3
    s_cselect_b32 s64, s20, s64
    v_mfma_f32_16x16x32_bf16 v[220:223], v[104:107], a[212:215], v[220:223]
    s_add_u32 s64, s64, s21
    s_add_u32 m0, s67, 114688
    ds_read_b128 v[136:139], v8 offset:59392
    v_mfma_f32_16x16x32_bf16 v[220:223], v[108:111], a[220:223], v[220:223]
    s_add_u32 s63, s63, 4096
    buffer_load_dwordx4 v1, s[56:59], s64 offen sc1 lds
    v_mfma_f32_16x16x32_bf16 v[224:227], v[112:115], a[208:211], v[224:227]
    ds_read_b128 v[140:143], v9 offset:1024
    ds_read_b128 v[144:147], v8 offset:60416
    v_mfma_f32_16x16x32_bf16 v[224:227], v[116:119], a[216:219], v[224:227]
    ds_read_b128 v[148:151], v9 offset:2048
    v_mfma_f32_16x16x32_bf16 v[228:231], v[112:115], a[212:215], v[228:231]
    buffer_load_dwordx4 v1, s[56:59], s64 offen offset:1024 sc1 lds
    v_mfma_f32_16x16x32_bf16 v[228:231], v[116:119], a[220:223], v[228:231]
    s_add_u32 s64, s64, 36864
    ds_read_b128 v[104:107], v8 offset:61440
    ds_read_b128 v[108:111], v9 offset:3072
    s_waitcnt lgkmcnt(5)
    v_mfma_f32_16x16x32_bf16 v[176:179], v[120:123], a[224:227], v[176:179]
    s_add_u32 m0, s67, 122880
    ds_read_b128 v[112:115], v8 offset:62464
    v_lshrrev_b32 v19, 4, v1
    v_mfma_f32_16x16x32_bf16 v[176:179], v[124:127], a[232:235], v[176:179]
    s_add_u32 s23, s5, 8
    ds_read_b128 v[116:119], v9 offset:4096
    v_min_u32 v19, 2, v19
    v_mfma_f32_16x16x32_bf16 v[180:183], v[120:123], a[228:231], v[180:183]
    s_add_u32 s22, s4, 1
    buffer_load_dwordx4 v1, s[56:59], s64 offen sc1 lds
    v_mfma_f32_16x16x32_bf16 v[180:183], v[124:127], a[236:239], v[180:183]
    s_mul_i32 s70, s4, 3072
    ds_read_b128 v[120:123], v8 offset:63488
    ds_read_b128 v[124:127], v9 offset:5120
    v_mfma_f32_16x16x32_bf16 v[184:187], v[128:131], a[224:227], v[184:187]
    s_lshl_b32 s22, s22, 15
    v_lshl_add_u32 v19, v19, 3, s23
    v_bfe_u32 v20, v1, 4, 4
    v_mfma_f32_16x16x32_bf16 v[184:187], v[132:135], a[232:235], v[184:187]
    s_lshl2_add_u32 s23, s62, s4
    v_lshrrev_b32 v21, 8, v1
    v_and_b32 v19, 31, v19
    v_mfma_f32_16x16x32_bf16 v[188:191], v[128:131], a[228:231], v[188:191]
    s_lshl_b32 s23, s23, 5
    buffer_load_dwordx4 v1, s[56:59], s64 offen offset:1024 sc1 lds
    v_mfma_f32_16x16x32_bf16 v[188:191], v[132:135], a[236:239], v[188:191]
    s_lshl_b32 s66, s6, 12
    ds_read_b128 v[128:131], v9 offset:6144
    ds_read_b128 v[132:135], v9 offset:13312
    v_mfma_f32_16x16x32_bf16 v[192:195], v[136:139], a[224:227], v[192:195]
    s_add_u32 s64, s64, 36864
    v_add_u32 v20, s23, v20
    v_mul_u32_u24 v20, 1152, v20
    s_waitcnt lgkmcnt(2)
    v_mfma_f32_16x16x32_bf16 v[192:195], v[140:143], a[232:235], v[192:195]
    s_mul_i32 s23, s101, 288
    v_lshl_add_u32 v20, v21, 3, v20
    v_mov_b32 v31, 1
    v_mfma_f32_16x16x32_bf16 v[196:199], v[136:139], a[228:231], v[196:199]
    s_add_u32 s23, s23, s70
    ds_read_b128 v[136:139], v9 offset:7168
    v_lshlrev_b32 v23, 20, v1
    v_mfma_f32_16x16x32_bf16 v[196:199], v[140:143], a[236:239], v[196:199]
    s_lshr_b32 s65, s20, 5
    buffer_load_dwordx4 v[64:67], v4, s[40:43], s63 offen offset:0 sc1
    v_mfma_f32_16x16x32_bf16 v[200:203], v[144:147], a[224:227], v[200:203]
    s_add_u32 s66, s66, s22
    ds_read_b128 v[140:143], v9 offset:14336
    v_lshlrev_b32 v19, 7, v19
    v_mfma_f32_16x16x32_bf16 v[200:203], v[148:151], a[232:235], v[200:203]
    s_add_u32 s22, s22, s101
    v_add_u32 v21, 18432, v20
    v_mfma_f32_16x16x32_bf16 v[204:207], v[144:147], a[228:231], v[204:207]
    ds_read_b128 v[144:147], v9 offset:8192
    v_mfma_f32_16x16x32_bf16 v[204:207], v[148:151], a[236:239], v[204:207]
    buffer_load_dwordx4 v[68:71], v5, s[40:43], s63 offen offset:0 sc1
    v_mfma_f32_16x16x32_bf16 v[208:211], v[104:107], a[224:227], v[208:211]
    ds_read_b128 v[148:151], v9 offset:15360
    v_mfma_f32_16x16x32_bf16 v[208:211], v[108:111], a[232:235], v[208:211]
    s_cmp_eq_u32 s4, s61
    s_cselect_b32 s65, s65, 1073741824
    s_cselect_b32 s70, s23, 1073741824
    v_mfma_f32_16x16x32_bf16 v[212:215], v[104:107], a[228:231], v[212:215]
    s_add_u32 s98, s70, 0
    ds_read_b128 v[104:107], v9 offset:9216
    v_mfma_f32_16x16x32_bf16 v[212:215], v[108:111], a[236:239], v[212:215]
    buffer_load_dwordx4 v[72:75], v4, s[40:43], s63 offen offset:1024 sc1
    v_mfma_f32_16x16x32_bf16 v[216:219], v[112:115], a[224:227], v[216:219]
    ds_read_b128 v[108:111], v9 offset:16384
    v_mfma_f32_16x16x32_bf16 v[216:219], v[116:119], a[232:235], v[216:219]
    v_mfma_f32_16x16x32_bf16 v[220:223], v[112:115], a[228:231], v[220:223]
    ds_read_b128 v[112:115], v9 offset:10240
    v_mfma_f32_16x16x32_bf16 v[220:223], v[116:119], a[236:239], v[220:223]
    buffer_load_dwordx4 v[76:79], v5, s[40:43], s63 offen offset:1024 sc1
    v_mfma_f32_16x16x32_bf16 v[224:227], v[120:123], a[224:227], v[224:227]
    s_lshr_b32 s64, s4, 1
    s_lshl1_add_u32 s21, s61, s64
    s_mul_i32 s21, s21, 3
    v_mfma_f32_16x16x32_bf16 v[224:227], v[124:127], a[232:235], v[224:227]
    s_add_u32 s21, s21, 128
    s_mul_i32 s21, s21, 36864
    ds_read_b128 v[116:119], v9 offset:17408
    v_mfma_f32_16x16x32_bf16 v[228:231], v[120:123], a[228:231], v[228:231]
    s_add_u32 s21, s21, s16
    s_and_b32 s64, s68, 1024
    ds_read_b128 v[120:123], v9 offset:11264
    v_mfma_f32_16x16x32_bf16 v[228:231], v[124:127], a[236:239], v[228:231]
    s_add_u32 s21, s21, s64
    s_add_u32 m0, s69, 143360
    ds_read_b128 v[124:127], v9 offset:18432
    s_waitcnt lgkmcnt(3)
    v_mfma_f32_16x16x32_bf16 v[176:179], v[128:131], a[240:243], v[176:179]
    s_add_u32 s63, s63, 4096
    buffer_load_dwordx4 v1, s[56:59], s21 offen sc1 lds
    v_mfma_f32_16x16x32_bf16 v[176:179], v[132:135], a[248:251], v[176:179]
    s_add_u32 s21, s21, 36864
    v_mfma_f32_16x16x32_bf16 v[180:183], v[128:131], a[244:247], v[180:183]
    s_add_u32 m0, s69, 144384
    ds_read_b128 v[128:131], v9 offset:12288
    v_mfma_f32_16x16x32_bf16 v[180:183], v[132:135], a[252:255], v[180:183]
    s_lshr_b32 s64, s16, 5
    ds_read_b128 v[132:135], v9 offset:19456
    v_mfma_f32_16x16x32_bf16 v[184:187], v[136:139], a[240:243], v[184:187]
    buffer_load_dwordx4 v1, s[56:59], s21 offen sc1 lds
    v_mfma_f32_16x16x32_bf16 v[184:187], v[140:143], a[248:251], v[184:187]
    s_add_u32 s21, s21, 36864
    v_mfma_f32_16x16x32_bf16 v[188:191], v[136:139], a[244:247], v[188:191]
    s_add_u32 m0, s69, 145408
    v_mfma_f32_16x16x32_bf16 v[188:191], v[140:143], a[252:255], v[188:191]
    v_mfma_f32_16x16x32_bf16 v[192:195], v[144:147], a[240:243], v[192:195]
    buffer_load_dwordx4 v1, s[56:59], s21 offen sc1 lds
    v_mfma_f32_16x16x32_bf16 v[192:195], v[148:151], a[248:251], v[192:195]
    s_add_u32 s21, s21, 36864
    v_mfma_f32_16x16x32_bf16 v[196:199], v[144:147], a[244:247], v[196:199]
    v_mfma_f32_16x16x32_bf16 v[196:199], v[148:151], a[252:255], v[196:199]
    v_mfma_f32_16x16x32_bf16 v[200:203], v[104:107], a[240:243], v[200:203]
    v_mfma_f32_16x16x32_bf16 v[200:203], v[108:111], a[248:251], v[200:203]
    s_add_u32 s21, s4, 0
    v_mfma_f32_16x16x32_bf16 v[204:207], v[104:107], a[244:247], v[204:207]
    s_xor_b32 s21, s21, s3
    v_mfma_f32_16x16x32_bf16 v[204:207], v[108:111], a[252:255], v[204:207]
    s_waitcnt vmcnt(11)
    s_barrier
    s_mul_i32 s21, s21, 147456
    v_mfma_f32_16x16x32_bf16 v[208:211], v[112:115], a[240:243], v[208:211]
    s_add_u32 s21, s21, s16
    s_add_u32 m0, s75, 0
    ds_read_b128 v[136:139], v9 offset:20480
    s_waitcnt lgkmcnt(1)
    v_mfma_f32_16x16x32_bf16 v[208:211], v[116:119], a[248:251], v[208:211]
    buffer_load_dwordx4 v1, s[56:59], s21 offen sc1 lds
    v_mfma_f32_16x16x32_bf16 v[212:215], v[112:115], a[244:247], v[212:215]
    ds_read_b128 v[140:143], v9 offset:27648
    ds_read_b128 v[144:147], v9 offset:21504
    v_mfma_f32_16x16x32_bf16 v[212:215], v[116:119], a[252:255], v[212:215]
    ds_read_b128 v[148:151], v9 offset:28672
    v_mfma_f32_16x16x32_bf16 v[216:219], v[120:123], a[240:243], v[216:219]
    buffer_load_dwordx4 v1, s[56:59], s21 offen offset:1024 sc1 lds
    v_mfma_f32_16x16x32_bf16 v[216:219], v[124:127], a[248:251], v[216:219]
    s_add_u32 s21, s21, 36864
    ds_read_b128 v[104:107], v9 offset:22528
    ds_read_b128 v[108:111], v9 offset:29696
    v_mfma_f32_16x16x32_bf16 v[220:223], v[120:123], a[244:247], v[220:223]
    s_add_u32 m0, s75, 2048
    ds_read_b128 v[112:115], v9 offset:23552
    v_mfma_f32_16x16x32_bf16 v[220:223], v[124:127], a[252:255], v[220:223]
    ds_read_b128 v[116:119], v9 offset:30720
    v_mfma_f32_16x16x32_bf16 v[224:227], v[128:131], a[240:243], v[224:227]
    buffer_load_dwordx4 v1, s[56:59], s21 offen sc1 lds
    v_mfma_f32_16x16x32_bf16 v[224:227], v[132:135], a[248:251], v[224:227]
    ds_read_b128 v[120:123], v9 offset:24576
    ds_read_b128 v[124:127], v9 offset:31744
    v_mfma_f32_16x16x32_bf16 v[228:231], v[128:131], a[244:247], v[228:231]
    ds_read_b128 v[128:131], v9 offset:25600
    v_mfma_f32_16x16x32_bf16 v[228:231], v[132:135], a[252:255], v[228:231]
    s_waitcnt lgkmcnt(4)
    ds_read_b128 v[132:135], v9 offset:32768
    v_mfma_f32_16x16x32_bf16 v[176:179], v[136:139], v[32:35], v[176:179]
    buffer_load_dwordx4 v1, s[56:59], s21 offen offset:1024 sc1 lds
    v_mfma_f32_16x16x32_bf16 v[176:179], v[140:143], v[40:43], v[176:179]
    s_add_u32 s21, s21, 36864
    v_mfma_f32_16x16x32_bf16 v[180:183], v[136:139], v[36:39], v[180:183]
    s_add_u32 m0, s75, 4096
    ds_read_b128 v[136:139], v9 offset:26624
    v_mfma_f32_16x16x32_bf16 v[180:183], v[140:143], v[44:47], v[180:183]
    ds_read_b128 v[140:143], v9 offset:33792
    v_mfma_f32_16x16x32_bf16 v[184:187], v[144:147], v[32:35], v[184:187]
    buffer_load_dwordx4 v1, s[56:59], s21 offen sc1 lds
    v_mfma_f32_16x16x32_bf16 v[184:187], v[148:151], v[40:43], v[184:187]
    v_mfma_f32_16x16x32_bf16 v[188:191], v[144:147], v[36:39], v[188:191]
    ds_read_b128 v[144:147], v9 offset:34816
    v_mfma_f32_16x16x32_bf16 v[188:191], v[148:151], v[44:47], v[188:191]
    ds_read_b128 v[148:151], v9 offset:41984
    v_mfma_f32_16x16x32_bf16 v[192:195], v[104:107], v[32:35], v[192:195]
    buffer_load_dwordx4 v1, s[56:59], s21 offen offset:1024 sc1 lds
    v_mfma_f32_16x16x32_bf16 v[192:195], v[108:111], v[40:43], v[192:195]
    v_mfma_f32_16x16x32_bf16 v[196:199], v[104:107], v[36:39], v[196:199]
    s_add_u32 s21, s21, 36864
    v_mfma_f32_16x16x32_bf16 v[196:199], v[108:111], v[44:47], v[196:199]
    s_add_u32 m0, s75, 6144
    v_mfma_f32_16x16x32_bf16 v[200:203], v[112:115], v[32:35], v[200:203]
    s_waitcnt lgkmcnt(0)
    v_mfma_f32_16x16x32_bf16 v[200:203], v[116:119], v[40:43], v[200:203]
    buffer_load_dwordx4 v1, s[56:59], s21 offen sc1 lds
    v_mfma_f32_16x16x32_bf16 v[204:207], v[112:115], v[36:39], v[204:207]
    ds_read_b128 v[112:115], v9 offset:35840
    v_mfma_f32_16x16x32_bf16 v[204:207], v[116:119], v[44:47], v[204:207]
    s_waitcnt vmcnt(10)
    s_barrier
    ds_read_b128 v[104:107], v9 offset:49152
    v_mfma_f32_16x16x32_bf16 v[208:211], v[120:123], v[32:35], v[208:211]
    ds_read_b128 v[108:111], v9 offset:57344
    ds_read_b128 v[116:119], v9 offset:43008
    v_mfma_f32_16x16x32_bf16 v[208:211], v[124:127], v[40:43], v[208:211]
    buffer_load_dwordx4 v1, s[56:59], s21 offen offset:1024 sc1 lds
    v_mfma_f32_16x16x32_bf16 v[212:215], v[120:123], v[36:39], v[212:215]
    s_add_u32 s21, s21, 36864
    s_add_u32 s21, s4, 4
    ds_read_b128 v[120:123], v9 offset:50176
    v_mfma_f32_16x16x32_bf16 v[212:215], v[124:127], v[44:47], v[212:215]
    s_xor_b32 s21, s21, s3
    ds_read_b128 v[124:127], v9 offset:58368
    v_mfma_f32_16x16x32_bf16 v[216:219], v[128:131], v[32:35], v[216:219]
    s_mul_i32 s21, s21, 147456
    v_mfma_f32_16x16x32_bf16 v[216:219], v[132:135], v[40:43], v[216:219]
    s_add_u32 s21, s21, s16
    s_add_u32 m0, s75, 32768
    v_mfma_f32_16x16x32_bf16 v[220:223], v[128:131], v[36:39], v[220:223]
    buffer_load_dwordx4 v1, s[56:59], s21 offen sc1 lds
    v_mfma_f32_16x16x32_bf16 v[220:223], v[132:135], v[44:47], v[220:223]
    ds_read_b128 v[128:131], v9 offset:36864
    ds_read_b128 v[132:135], v9 offset:44032
    v_mfma_f32_16x16x32_bf16 v[224:227], v[136:139], v[32:35], v[224:227]
    v_mfma_f32_16x16x32_bf16 v[224:227], v[140:143], v[40:43], v[224:227]
    buffer_load_dwordx4 v1, s[56:59], s21 offen offset:1024 sc1 lds
    v_mfma_f32_16x16x32_bf16 v[228:231], v[136:139], v[36:39], v[228:231]
    s_add_u32 s21, s21, 36864
    ds_read_b128 v[136:139], v9 offset:51200
    v_mfma_f32_16x16x32_bf16 v[228:231], v[140:143], v[44:47], v[228:231]
    s_add_u32 m0, s75, 34816
    ds_read_b128 v[140:143], v9 offset:59392
    v_mfma_f32_16x16x32_bf16 v[176:179], v[144:147], v[48:51], v[176:179]
    v_mfma_f32_16x16x32_bf16 v[176:179], v[148:151], v[56:59], v[176:179]
    s_waitcnt lgkmcnt(2)
    buffer_load_dwordx4 v1, s[56:59], s21 offen sc1 lds
    v_mfma_f32_16x16x32_bf16 v[176:179], v[104:107], v[64:67], v[176:179]
    v_mfma_f32_16x16x32_bf16 v[176:179], v[108:111], v[72:75], v[176:179]
    v_mfma_f32_16x16x32_bf16 v[180:183], v[144:147], v[52:55], v[180:183]
    ds_read_b128 v[144:147], v9 offset:37888
    v_mfma_f32_16x16x32_bf16 v[180:183], v[148:151], v[60:63], v[180:183]
    ds_read_b128 v[148:151], v9 offset:45056
    v_mfma_f32_16x16x32_bf16 v[180:183], v[104:107], v[68:71], v[180:183]
    buffer_load_dwordx4 v1, s[56:59], s21 offen offset:1024 sc1 lds
    v_mfma_f32_16x16x32_bf16 v[180:183], v[108:111], v[76:79], v[180:183]
    s_add_u32 s21, s21, 36864
    v_cvt_pk_bf16_f32 v232, v176, v177
    v_cvt_pk_bf16_f32 v233, v178, v179
    v_mfma_f32_16x16x32_bf16 v[184:187], v[112:115], v[48:51], v[184:187]
    s_add_u32 m0, s75, 36864
    ds_read_b128 v[104:107], v9 offset:52224
    ds_read_b128 v[108:111], v9 offset:60416
    v_mfma_f32_16x16x32_bf16 v[184:187], v[116:119], v[56:59], v[184:187]
    v_cvt_pk_bf16_f32 v234, v180, v181
    v_cvt_pk_bf16_f32 v235, v182, v183
    v_mfma_f32_16x16x32_bf16 v[184:187], v[120:123], v[64:67], v[184:187]
    buffer_load_dwordx4 v1, s[56:59], s21 offen sc1 lds
    v_mfma_f32_16x16x32_bf16 v[184:187], v[124:127], v[72:75], v[184:187]
    buffer_store_dwordx4 v[232:235], v1, s[48:51], s8 offen offset:0 sc1
    v_mfma_f32_16x16x32_bf16 v[188:191], v[112:115], v[52:55], v[188:191]
    ds_read_b128 v[112:115], v9 offset:38912
    v_mfma_f32_16x16x32_bf16 v[188:191], v[116:119], v[60:63], v[188:191]
    ds_read_b128 v[116:119], v9 offset:46080
    v_mfma_f32_16x16x32_bf16 v[188:191], v[120:123], v[68:71], v[188:191]
    buffer_load_dwordx4 v1, s[56:59], s21 offen offset:1024 sc1 lds
    v_mfma_f32_16x16x32_bf16 v[188:191], v[124:127], v[76:79], v[188:191]
    s_add_u32 s21, s21, 36864
    v_cvt_pk_bf16_f32 v236, v184, v185
    v_cvt_pk_bf16_f32 v237, v186, v187
    v_mfma_f32_16x16x32_bf16 v[192:195], v[128:131], v[48:51], v[192:195]
    s_add_u32 m0, s75, 38912
    ds_read_b128 v[120:123], v9 offset:53248
    ds_read_b128 v[124:127], v9 offset:61440
    v_mfma_f32_16x16x32_bf16 v[192:195], v[132:135], v[56:59], v[192:195]
    s_waitcnt lgkmcnt(3)
    v_cvt_pk_bf16_f32 v238, v188, v189
    v_cvt_pk_bf16_f32 v239, v190, v191
    v_mfma_f32_16x16x32_bf16 v[192:195], v[136:139], v[64:67], v[192:195]
    buffer_load_dwordx4 v1, s[56:59], s21 offen sc1 lds
    v_mfma_f32_16x16x32_bf16 v[192:195], v[140:143], v[72:75], v[192:195]
    v_mfma_f32_16x16x32_bf16 v[196:199], v[128:131], v[52:55], v[196:199]
    ds_read_b128 v[128:131], v9 offset:39936
    v_mfma_f32_16x16x32_bf16 v[196:199], v[132:135], v[60:63], v[196:199]
    ds_read_b128 v[132:135], v9 offset:47104
    v_mfma_f32_16x16x32_bf16 v[196:199], v[136:139], v[68:71], v[196:199]
    buffer_store_dwordx4 v[236:239], v1, s[48:51], s8 offen offset:1024 sc1
    v_mfma_f32_16x16x32_bf16 v[196:199], v[140:143], v[76:79], v[196:199]
    ds_read_b128 v[136:139], v9 offset:54272
    v_cvt_pk_bf16_f32 v240, v192, v193
    v_mfma_f32_16x16x32_bf16 v[200:203], v[144:147], v[48:51], v[200:203]
    v_cvt_pk_bf16_f32 v241, v194, v195
    ds_read_b128 v[140:143], v9 offset:62464
    v_mfma_f32_16x16x32_bf16 v[200:203], v[148:151], v[56:59], v[200:203]
    v_mfma_f32_16x16x32_bf16 v[200:203], v[104:107], v[64:67], v[200:203]
    buffer_load_dwordx4 v1, s[56:59], s21 offen offset:1024 sc1 lds
    v_mfma_f32_16x16x32_bf16 v[200:203], v[108:111], v[72:75], v[200:203]
    s_add_u32 s21, s21, 36864
    v_cvt_pk_bf16_f32 v242, v196, v197
    v_cvt_pk_bf16_f32 v243, v198, v199
    v_mfma_f32_16x16x32_bf16 v[204:207], v[144:147], v[52:55], v[204:207]
    ds_read_b128 v[144:147], v9 offset:40960
    v_mfma_f32_16x16x32_bf16 v[204:207], v[148:151], v[60:63], v[204:207]
    ds_read_b128 v[148:151], v9 offset:48128
    v_mfma_f32_16x16x32_bf16 v[204:207], v[104:107], v[68:71], v[204:207]
    buffer_store_dwordx4 v[240:243], v1, s[48:51], s9 offen offset:0 sc1
    v_mfma_f32_16x16x32_bf16 v[204:207], v[108:111], v[76:79], v[204:207]
    v_cvt_pk_bf16_f32 v244, v200, v201
    v_cvt_pk_bf16_f32 v245, v202, v203
    v_mfma_f32_16x16x32_bf16 v[208:211], v[112:115], v[48:51], v[208:211]
    s_waitcnt lgkmcnt(2)
    ds_read_b128 v[104:107], v9 offset:55296
    ds_read_b128 v[108:111], v9 offset:63488
    v_mfma_f32_16x16x32_bf16 v[208:211], v[116:119], v[56:59], v[208:211]
    v_mfma_f32_16x16x32_bf16 v[208:211], v[120:123], v[64:67], v[208:211]
    v_mfma_f32_16x16x32_bf16 v[208:211], v[124:127], v[72:75], v[208:211]
    v_cvt_pk_bf16_f32 v246, v204, v205
    v_cvt_pk_bf16_f32 v247, v206, v207
    v_mfma_f32_16x16x32_bf16 v[212:215], v[112:115], v[52:55], v[212:215]
    buffer_store_dwordx4 v[244:247], v1, s[48:51], s9 offen offset:1024 sc1
    v_mfma_f32_16x16x32_bf16 v[212:215], v[116:119], v[60:63], v[212:215]
    v_mfma_f32_16x16x32_bf16 v[212:215], v[120:123], v[68:71], v[212:215]
    v_mfma_f32_16x16x32_bf16 v[212:215], v[124:127], v[76:79], v[212:215]
    v_mfma_f32_16x16x32_bf16 v[216:219], v[128:131], v[48:51], v[216:219]
    v_cvt_pk_bf16_f32 v232, v208, v209
    v_cvt_pk_bf16_f32 v233, v210, v211
    v_mfma_f32_16x16x32_bf16 v[216:219], v[132:135], v[56:59], v[216:219]
    v_mfma_f32_16x16x32_bf16 v[216:219], v[136:139], v[64:67], v[216:219]
    v_mfma_f32_16x16x32_bf16 v[216:219], v[140:143], v[72:75], v[216:219]
    s_waitcnt vmcnt(12)
    s_barrier
    v_cvt_pk_bf16_f32 v234, v212, v213
    v_mfma_f32_16x16x32_bf16 v[220:223], v[128:131], v[52:55], v[220:223]
    v_cvt_pk_bf16_f32 v235, v214, v215
    ds_read_b128 v[112:115], v8 offset:0
    v_mfma_f32_16x16x32_bf16 v[220:223], v[132:135], v[60:63], v[220:223]
    buffer_store_dwordx4 v[232:235], v1, s[48:51], s10 offen offset:0 sc1
    v_mfma_f32_16x16x32_bf16 v[220:223], v[136:139], v[68:71], v[220:223]
    ds_read_b128 v[116:119], v8 offset:2048
    ds_read_b128 v[120:123], v8 offset:4096
    v_mfma_f32_16x16x32_bf16 v[220:223], v[140:143], v[76:79], v[220:223]
    s_waitcnt lgkmcnt(3)
    ds_read_b128 v[124:127], v8 offset:6144
    v_cvt_pk_bf16_f32 v236, v216, v217
    v_mfma_f32_16x16x32_bf16 v[224:227], v[144:147], v[48:51], v[224:227]
    v_cvt_pk_bf16_f32 v237, v218, v219
    ds_read_b128 v[128:131], v8 offset:1024
    v_mfma_f32_16x16x32_bf16 v[224:227], v[148:151], v[56:59], v[224:227]
    ds_read_b128 v[132:135], v8 offset:3072
    v_mfma_f32_16x16x32_bf16 v[224:227], v[104:107], v[64:67], v[224:227]
    v_cvt_pk_bf16_f32 v238, v220, v221
    v_cvt_pk_bf16_f32 v239, v222, v223
    v_mfma_f32_16x16x32_bf16 v[224:227], v[108:111], v[72:75], v[224:227]
    buffer_store_dwordx4 v[236:239], v1, s[48:51], s10 offen offset:1024 sc1
    v_mfma_f32_16x16x32_bf16 v[228:231], v[144:147], v[52:55], v[228:231]
    ds_read_b128 v[136:139], v8 offset:5120
    ds_read_b128 v[140:143], v8 offset:7168
    v_mfma_f32_16x16x32_bf16 v[228:231], v[148:151], v[60:63], v[228:231]
    ds_read_b128 v[144:147], v8 offset:8192
    v_mfma_f32_16x16x32_bf16 v[228:231], v[104:107], v[68:71], v[228:231]
    ds_read_b128 v[148:151], v8 offset:10240
    v_cvt_pk_bf16_f32 v240, v224, v225
    v_mfma_f32_16x16x32_bf16 v[228:231], v[108:111], v[76:79], v[228:231]
    s_waitcnt lgkmcnt(4)
    v_cvt_pk_bf16_f32 v241, v226, v227
    ds_read_b128 v[104:107], v8 offset:12288
    v_mfma_f32_16x16x32_bf16 v[160:163], v[112:115], a[0:3], 0
    ds_read_b128 v[108:111], v8 offset:14336
    v_mfma_f32_16x16x32_bf16 v[160:163], v[116:119], a[8:11], v[160:163]
    v_mfma_f32_16x16x32_bf16 v[160:163], v[120:123], a[16:19], v[160:163]
    v_mfma_f32_16x16x32_bf16 v[160:163], v[124:127], a[24:27], v[160:163]
    v_mfma_f32_16x16x32_bf16 v[164:167], v[112:115], a[4:7], 0
    v_cvt_pk_bf16_f32 v242, v228, v229
    v_cvt_pk_bf16_f32 v243, v230, v231
    v_mfma_f32_16x16x32_bf16 v[164:167], v[116:119], a[12:15], v[164:167]
    buffer_store_dwordx4 v[240:243], v1, s[48:51], s11 offen offset:2048 sc1
    v_mfma_f32_16x16x32_bf16 v[164:167], v[120:123], a[20:23], v[164:167]
    ds_read_b128 v[112:115], v8 offset:9216
    ds_read_b128 v[116:119], v8 offset:11264
    v_mfma_f32_16x16x32_bf16 v[164:167], v[124:127], a[28:31], v[164:167]
    ds_read_b128 v[120:123], v8 offset:13312
    v_mfma_f32_16x16x32_bf16 v[168:171], v[128:131], a[0:3], 0
    ds_read_b128 v[124:127], v8 offset:15360
    v_mfma_f32_16x16x32_bf16 v[168:171], v[132:135], a[8:11], v[168:171]
    s_waitcnt lgkmcnt(4)
    v_mfma_f32_16x16x32_bf16 v[168:171], v[136:139], a[16:19], v[168:171]
    v_mfma_f32_16x16x32_bf16 v[168:171], v[140:143], a[24:27], v[168:171]
    v_mfma_f32_16x16x32_bf16 v[172:175], v[128:131], a[4:7], 0
    ds_read_b128 v[128:131], v8 offset:16384
    v_mfma_f32_16x16x32_bf16 v[172:175], v[132:135], a[12:15], v[172:175]
    ds_read_b128 v[132:135], v8 offset:18432
    v_mfma_f32_16x16x32_bf16 v[172:175], v[136:139], a[20:23], v[172:175]
    ds_read_b128 v[136:139], v8 offset:20480
    v_mfma_f32_16x16x32_bf16 v[172:175], v[140:143], a[28:31], v[172:175]
    ds_read_b128 v[140:143], v8 offset:22528
    v_mfma_f32_16x16x32_bf16 v[160:163], v[144:147], a[32:35], v[160:163]
    v_mfma_f32_16x16x32_bf16 v[160:163], v[148:151], a[40:43], v[160:163]
    v_mfma_f32_16x16x32_bf16 v[160:163], v[104:107], a[48:51], v[160:163]
    v_mfma_f32_16x16x32_bf16 v[160:163], v[108:111], a[56:59], v[160:163]
    v_mfma_f32_16x16x32_bf16 v[164:167], v[144:147], a[36:39], v[164:167]
    ds_read_b128 v[144:147], v8 offset:17408
    v_mfma_f32_16x16x32_bf16 v[164:167], v[148:151], a[44:47], v[164:167]
    ds_read_b128 v[148:151], v8 offset:19456
    v_mfma_f32_16x16x32_bf16 v[164:167], v[104:107], a[52:55], v[164:167]
    ds_read_b128 v[104:107], v8 offset:21504
    v_mfma_f32_16x16x32_bf16 v[164:167], v[108:111], a[60:63], v[164:167]
    s_waitcnt lgkmcnt(3)
    ds_read_b128 v[108:111], v8 offset:23552
    v_mfma_f32_16x16x32_bf16 v[168:171], v[112:115], a[32:35], v[168:171]
    v_mfma_f32_16x16x32_bf16 v[168:171], v[116:119], a[40:43], v[168:171]
    v_mfma_f32_16x16x32_bf16 v[168:171], v[120:123], a[48:51], v[168:171]
    v_mfma_f32_16x16x32_bf16 v[168:171], v[124:127], a[56:59], v[168:171]
    v_mfma_f32_16x16x32_bf16 v[172:175], v[112:115], a[36:39], v[172:175]
    ds_read_b128 v[112:115], v8 offset:24576
    v_mfma_f32_16x16x32_bf16 v[172:175], v[116:119], a[44:47], v[172:175]
    ds_read_b128 v[116:119], v8 offset:26624
    v_mfma_f32_16x16x32_bf16 v[172:175], v[120:123], a[52:55], v[172:175]
    ds_read_b128 v[120:123], v8 offset:28672
    v_mfma_f32_16x16x32_bf16 v[172:175], v[124:127], a[60:63], v[172:175]
    ds_read_b128 v[124:127], v8 offset:30720
    v_mfma_f32_16x16x32_bf16 v[160:163], v[128:131], a[64:67], v[160:163]
    v_mfma_f32_16x16x32_bf16 v[160:163], v[132:135], a[72:75], v[160:163]
    v_mfma_f32_16x16x32_bf16 v[160:163], v[136:139], a[80:83], v[160:163]
    v_mfma_f32_16x16x32_bf16 v[160:163], v[140:143], a[88:91], v[160:163]
    v_mfma_f32_16x16x32_bf16 v[164:167], v[128:131], a[68:71], v[164:167]
    ds_read_b128 v[128:131], v8 offset:25600
    v_mfma_f32_16x16x32_bf16 v[164:167], v[132:135], a[76:79], v[164:167]
    ds_read_b128 v[132:135], v8 offset:27648
    v_mfma_f32_16x16x32_bf16 v[164:167], v[136:139], a[84:87], v[164:167]
    ds_read_b128 v[136:139], v8 offset:29696
    v_mfma_f32_16x16x32_bf16 v[164:167], v[140:143], a[92:95], v[164:167]
    s_waitcnt lgkmcnt(3)
    ds_read_b128 v[140:143], v8 offset:31744
    v_mfma_f32_16x16x32_bf16 v[168:171], v[144:147], a[64:67], v[168:171]
    v_mfma_f32_16x16x32_bf16 v[168:171], v[148:151], a[72:75], v[168:171]
    v_mfma_f32_16x16x32_bf16 v[168:171], v[104:107], a[80:83], v[168:171]
    v_mfma_f32_16x16x32_bf16 v[168:171], v[108:111], a[88:91], v[168:171]
    v_mfma_f32_16x16x32_bf16 v[172:175], v[144:147], a[68:71], v[172:175]
    v_mfma_f32_16x16x32_bf16 v[172:175], v[148:151], a[76:79], v[172:175]
    v_mfma_f32_16x16x32_bf16 v[172:175], v[104:107], a[84:87], v[172:175]
    v_mfma_f32_16x16x32_bf16 v[172:175], v[108:111], a[92:95], v[172:175]
    v_mfma_f32_16x16x32_bf16 v[160:163], v[112:115], a[96:99], v[160:163]
    v_mfma_f32_16x16x32_bf16 v[160:163], v[116:119], a[104:107], v[160:163]
    v_mfma_f32_16x16x32_bf16 v[160:163], v[120:123], a[112:115], v[160:163]
    s_waitcnt vmcnt(0)
    buffer_store_dword v31, v23, s[32:35], s22 offen sc1
    v_mfma_f32_16x16x32_bf16 v[160:163], v[124:127], a[120:123], v[160:163]
    s_waitcnt vmcnt(6)
    s_barrier
    ds_read_b128 v[144:147], v8 offset:32768
    v_mfma_f32_16x16x32_bf16 v[164:167], v[112:115], a[100:103], v[164:167]
    ds_read_b128 v[148:151], v8 offset:34816
    ds_read_b128 v[104:107], v8 offset:36864
    v_mfma_f32_16x16x32_bf16 v[164:167], v[116:119], a[108:111], v[164:167]
    ds_read_b128 v[108:111], v8 offset:38912
    v_mfma_f32_16x16x32_bf16 v[164:167], v[120:123], a[116:119], v[164:167]
    ds_read_b128 v[112:115], v8 offset:33792
    v_mfma_f32_16x16x32_bf16 v[164:167], v[124:127], a[124:127], v[164:167]
    s_waitcnt lgkmcnt(5)
    ds_read_b128 v[116:119], v8 offset:35840
    v_mfma_f32_16x16x32_bf16 v[168:171], v[128:131], a[96:99], v[168:171]
    ds_read_b128 v[120:123], v8 offset:37888
    v_mfma_f32_16x16x32_bf16 v[168:171], v[132:135], a[104:107], v[168:171]
    ds_read_b128 v[124:127], v8 offset:39936
    v_mfma_f32_16x16x32_bf16 v[168:171], v[136:139], a[112:115], v[168:171]
    v_mfma_f32_16x16x32_bf16 v[168:171], v[140:143], a[120:123], v[168:171]
    v_mfma_f32_16x16x32_bf16 v[172:175], v[128:131], a[100:103], v[172:175]
    ds_read_b128 v[128:131], v8 offset:40960
    v_mfma_f32_16x16x32_bf16 v[172:175], v[132:135], a[108:111], v[172:175]
    ds_read_b128 v[132:135], v8 offset:43008
    v_mfma_f32_16x16x32_bf16 v[172:175], v[136:139], a[116:119], v[172:175]
    ds_read_b128 v[136:139], v8 offset:45056
    v_mfma_f32_16x16x32_bf16 v[172:175], v[140:143], a[124:127], v[172:175]
    s_waitcnt lgkmcnt(3)
    ds_read_b128 v[140:143], v8 offset:47104
    v_mfma_f32_16x16x32_bf16 v[160:163], v[144:147], a[128:131], v[160:163]
    v_mfma_f32_16x16x32_bf16 v[160:163], v[148:151], a[136:139], v[160:163]
    v_mfma_f32_16x16x32_bf16 v[160:163], v[104:107], a[144:147], v[160:163]
    v_mfma_f32_16x16x32_bf16 v[160:163], v[108:111], a[152:155], v[160:163]
    v_mfma_f32_16x16x32_bf16 v[164:167], v[144:147], a[132:135], v[164:167]
    ds_read_b128 v[144:147], v8 offset:41984
    v_mfma_f32_16x16x32_bf16 v[164:167], v[148:151], a[140:143], v[164:167]
    ds_read_b128 v[148:151], v8 offset:44032
    v_mfma_f32_16x16x32_bf16 v[164:167], v[104:107], a[148:151], v[164:167]
    ds_read_b128 v[104:107], v8 offset:46080
    v_mfma_f32_16x16x32_bf16 v[164:167], v[108:111], a[156:159], v[164:167]
    ds_read_b128 v[108:111], v8 offset:48128
    v_mfma_f32_16x16x32_bf16 v[168:171], v[112:115], a[128:131], v[168:171]
    v_mfma_f32_16x16x32_bf16 v[168:171], v[116:119], a[136:139], v[168:171]
    v_mfma_f32_16x16x32_bf16 v[168:171], v[120:123], a[144:147], v[168:171]
    v_mfma_f32_16x16x32_bf16 v[168:171], v[124:127], a[152:155], v[168:171]
    v_mfma_f32_16x16x32_bf16 v[172:175], v[112:115], a[132:135], v[172:175]
    ds_read_b128 v[112:115], v8 offset:49152
    v_mfma_f32_16x16x32_bf16 v[172:175], v[116:119], a[140:143], v[172:175]
    ds_read_b128 v[116:119], v8 offset:51200
    v_mfma_f32_16x16x32_bf16 v[172:175], v[120:123], a[148:151], v[172:175]
    ds_read_b128 v[120:123], v8 offset:53248
    v_mfma_f32_16x16x32_bf16 v[172:175], v[124:127], a[156:159], v[172:175]
    s_waitcnt lgkmcnt(3)
    ds_read_b128 v[124:127], v8 offset:55296
    v_mfma_f32_16x16x32_bf16 v[160:163], v[128:131], a[160:163], v[160:163]
    v_mfma_f32_16x16x32_bf16 v[160:163], v[132:135], a[168:171], v[160:163]
    v_mfma_f32_16x16x32_bf16 v[160:163], v[136:139], a[176:179], v[160:163]
    v_mfma_f32_16x16x32_bf16 v[160:163], v[140:143], a[184:187], v[160:163]
    v_mfma_f32_16x16x32_bf16 v[164:167], v[128:131], a[164:167], v[164:167]
    ds_read_b128 v[128:131], v8 offset:50176
    v_mfma_f32_16x16x32_bf16 v[164:167], v[132:135], a[172:175], v[164:167]
    buffer_load_dword v3, v19, s[32:35], s66 offen sc1
    v_mfma_f32_16x16x32_bf16 v[164:167], v[136:139], a[180:183], v[164:167]
    ds_read_b128 v[132:135], v8 offset:52224
    ds_read_b128 v[136:139], v8 offset:54272
    v_mfma_f32_16x16x32_bf16 v[164:167], v[140:143], a[188:191], v[164:167]
    ds_read_b128 v[140:143], v8 offset:56320
    v_mfma_f32_16x16x32_bf16 v[168:171], v[144:147], a[160:163], v[168:171]
    v_mfma_f32_16x16x32_bf16 v[168:171], v[148:151], a[168:171], v[168:171]
    v_mfma_f32_16x16x32_bf16 v[168:171], v[104:107], a[176:179], v[168:171]
    v_mfma_f32_16x16x32_bf16 v[168:171], v[108:111], a[184:187], v[168:171]
    v_mfma_f32_16x16x32_bf16 v[172:175], v[144:147], a[164:167], v[172:175]
    ds_read_b128 v[144:147], v8 offset:57344
    v_mfma_f32_16x16x32_bf16 v[172:175], v[148:151], a[172:175], v[172:175]
    ds_read_b128 v[148:151], v8 offset:59392
    v_mfma_f32_16x16x32_bf16 v[172:175], v[104:107], a[180:183], v[172:175]
    ds_read_b128 v[104:107], v8 offset:61440
    v_mfma_f32_16x16x32_bf16 v[172:175], v[108:111], a[188:191], v[172:175]
    s_waitcnt lgkmcnt(3)
    ds_read_b128 v[108:111], v8 offset:63488
    v_mfma_f32_16x16x32_bf16 v[160:163], v[112:115], a[192:195], v[160:163]
    v_mfma_f32_16x16x32_bf16 v[160:163], v[116:119], a[200:203], v[160:163]
    v_mfma_f32_16x16x32_bf16 v[160:163], v[120:123], a[208:211], v[160:163]
    v_mfma_f32_16x16x32_bf16 v[160:163], v[124:127], a[216:219], v[160:163]
    v_mfma_f32_16x16x32_bf16 v[164:167], v[112:115], a[196:199], v[164:167]
    ds_read_b128 v[112:115], v8 offset:58368
    v_mfma_f32_16x16x32_bf16 v[164:167], v[116:119], a[204:207], v[164:167]
    ds_read_b128 v[116:119], v8 offset:60416
    v_mfma_f32_16x16x32_bf16 v[164:167], v[120:123], a[212:215], v[164:167]
    ds_read_b128 v[120:123], v8 offset:62464
    v_mfma_f32_16x16x32_bf16 v[164:167], v[124:127], a[220:223], v[164:167]
    ds_read_b128 v[124:127], v8 offset:64512
    v_mfma_f32_16x16x32_bf16 v[168:171], v[128:131], a[192:195], v[168:171]
    v_mfma_f32_16x16x32_bf16 v[168:171], v[132:135], a[200:203], v[168:171]
    v_mfma_f32_16x16x32_bf16 v[168:171], v[136:139], a[208:211], v[168:171]
    v_mfma_f32_16x16x32_bf16 v[168:171], v[140:143], a[216:219], v[168:171]
    v_mfma_f32_16x16x32_bf16 v[172:175], v[128:131], a[196:199], v[172:175]
    ds_read_b128 v[128:131], v10 offset:12288
    v_mfma_f32_16x16x32_bf16 v[172:175], v[132:135], a[204:207], v[172:175]
    ds_read_b128 v[132:135], v10 offset:13312
    v_mfma_f32_16x16x32_bf16 v[172:175], v[136:139], a[212:215], v[172:175]
    ds_read_b128 v[136:139], v10 offset:14336
    v_mfma_f32_16x16x32_bf16 v[172:175], v[140:143], a[220:223], v[172:175]
    s_waitcnt lgkmcnt(3)
    ds_read_b128 v[140:143], v10 offset:16384
    v_mfma_f32_16x16x32_bf16 v[160:163], v[144:147], a[224:227], v[160:163]
    s_waitcnt vmcnt(0)
    v_cmp_gt_u32 vcc, 1, v3
    s_nop 1
    s_and_b64 vcc, vcc, exec
    s_cbranch_scc1 SPIN_X
BACK_X:
    v_mfma_f32_16x16x32_bf16 v[160:163], v[148:151], a[232:235], v[160:163]
    buffer_load_dwordx4 v[200:203], v1, s[48:51], s98 offen offset:2048 sc1
    v_mfma_f32_16x16x32_bf16 v[160:163], v[104:107], a[240:243], v[160:163]
    s_add_u32 s98, s70, 12288
    buffer_load_dwordx4 v[204:207], v1, s[48:51], s98 offen offset:2048 sc1
    v_mfma_f32_16x16x32_bf16 v[160:163], v[108:111], a[248:251], v[160:163]
    s_add_u32 s98, s70, 24576
    v_mfma_f32_16x16x32_bf16 v[164:167], v[144:147], a[228:231], v[164:167]
    ds_read_b128 v[144:147], v10 offset:17408
    v_mfma_f32_16x16x32_bf16 v[164:167], v[148:151], a[236:239], v[164:167]
    buffer_load_dwordx4 v[208:211], v1, s[48:51], s98 offen offset:2048 sc1
    v_mfma_f32_16x16x32_bf16 v[164:167], v[104:107], a[244:247], v[164:167]
    s_add_u32 s98, s23, 0
    ds_read_b128 v[148:151], v10 offset:18432
    ds_read_b128 v[104:107], v10 offset:20480
    v_mfma_f32_16x16x32_bf16 v[164:167], v[108:111], a[252:255], v[164:167]
    ds_read_b128 v[108:111], v10 offset:21504
    v_mfma_f32_16x16x32_bf16 v[168:171], v[112:115], a[224:227], v[168:171]
    v_mfma_f32_16x16x32_bf16 v[168:171], v[116:119], a[232:235], v[168:171]
    buffer_load_dwordx4 v[176:179], v1, s[48:51], s98 offen offset:0 sc1
    v_mfma_f32_16x16x32_bf16 v[168:171], v[120:123], a[240:243], v[168:171]
    s_add_u32 s98, s23, 12288
    v_mfma_f32_16x16x32_bf16 v[168:171], v[124:127], a[248:251], v[168:171]
    v_mfma_f32_16x16x32_bf16 v[172:175], v[112:115], a[228:231], v[172:175]
    ds_read_b128 v[112:115], v10 offset:22528
    v_mfma_f32_16x16x32_bf16 v[172:175], v[116:119], a[236:239], v[172:175]
    buffer_load_dwordx4 v[180:183], v1, s[48:51], s98 offen offset:0 sc1
    v_mfma_f32_16x16x32_bf16 v[172:175], v[120:123], a[244:247], v[172:175]
    s_add_u32 s98, s23, 24576
    ds_read_b128 v[116:119], v10 offset:24576
    ds_read_b128 v[120:123], v10 offset:25600
    v_mfma_f32_16x16x32_bf16 v[172:175], v[124:127], a[252:255], v[172:175]
    s_waitcnt lgkmcnt(3)
    ds_read_b128 v[124:127], v10 offset:26624
    v_mfma_f32_16x16x32_bf16 v[160:163], v[128:131], v[32:35], v[160:163]
    v_mfma_f32_16x16x32_bf16 v[160:163], v[132:135], v[40:43], v[160:163]
    buffer_load_dwordx4 v[184:187], v1, s[48:51], s98 offen offset:0 sc1
    v_mfma_f32_16x16x32_bf16 v[160:163], v[136:139], v[48:51], v[160:163]
    s_add_u32 s98, s23, 0
    v_mfma_f32_16x16x32_bf16 v[164:167], v[128:131], v[36:39], v[164:167]
    v_mfma_f32_16x16x32_bf16 v[164:167], v[132:135], v[44:47], v[164:167]
    v_mfma_f32_16x16x32_bf16 v[164:167], v[136:139], v[52:55], v[164:167]
    buffer_load_dwordx4 v[188:191], v1, s[48:51], s98 offen offset:1024 sc1
    v_mfma_f32_16x16x32_bf16 v[168:171], v[140:143], v[32:35], v[168:171]
    s_add_u32 s98, s23, 12288
    v_mfma_f32_16x16x32_bf16 v[168:171], v[144:147], v[40:43], v[168:171]
    v_mfma_f32_16x16x32_bf16 v[168:171], v[148:151], v[48:51], v[168:171]
    v_mfma_f32_16x16x32_bf16 v[172:175], v[140:143], v[36:39], v[172:175]
    buffer_load_dwordx4 v[192:195], v1, s[48:51], s98 offen offset:1024 sc1
    v_mfma_f32_16x16x32_bf16 v[172:175], v[144:147], v[44:47], v[172:175]
    s_add_u32 s98, s23, 24576
    v_mfma_f32_16x16x32_bf16 v[172:175], v[148:151], v[52:55], v[172:175]
    v_mfma_f32_16x16x32_bf16 v[160:163], v[104:107], v[56:59], v[160:163]
    v_mfma_f32_16x16x32_bf16 v[160:163], v[108:111], v[64:67], v[160:163]
    s_waitcnt lgkmcnt(0)
    buffer_load_dwordx4 v[196:199], v1, s[48:51], s98 offen offset:1024 sc1
    v_mfma_f32_16x16x32_bf16 v[160:163], v[112:115], v[72:75], v[160:163]
    v_mfma_f32_16x16x32_bf16 v[164:167], v[104:107], v[60:63], v[164:167]
    v_mfma_f32_16x16x32_bf16 v[164:167], v[108:111], v[68:71], v[164:167]
    v_mfma_f32_16x16x32_bf16 v[164:167], v[112:115], v[76:79], v[164:167]
    v_mfma_f32_16x16x32_bf16 v[168:171], v[116:119], v[56:59], v[168:171]
    v_mfma_f32_16x16x32_bf16 v[168:171], v[120:123], v[64:67], v[168:171]
    v_mfma_f32_16x16x32_bf16 v[168:171], v[124:127], v[72:75], v[168:171]
    v_mfma_f32_16x16x32_bf16 v[172:175], v[116:119], v[60:63], v[172:175]
    v_mfma_f32_16x16x32_bf16 v[172:175], v[120:123], v[68:71], v[172:175]
    v_mfma_f32_16x16x32_bf16 v[172:175], v[124:127], v[76:79], v[172:175]
    s_cmp_lg_u32 s4, s61
    s_cbranch_scc1 K1_X2
    s_waitcnt vmcnt(6)
    v_lshlrev_b32 v80, 16, v200
    v_and_b32 v81, 0xffff0000, v200
    v_lshlrev_b32 v82, 16, v204
    v_and_b32 v83, 0xffff0000, v204
    v_lshlrev_b32 v84, 16, v208
    v_and_b32 v85, 0xffff0000, v208
    v_pk_add_f32 v[80:81], v[80:81], v[82:83]
    v_pk_add_f32 v[224:225], v[224:225], v[84:85]
    v_pk_add_f32 v[224:225], v[224:225], v[80:81]
    v_cvt_pk_bf16_f32 v200, v224, v225
    v_lshlrev_b32 v86, 16, v201
    v_and_b32 v87, 0xffff0000, v201
    v_lshlrev_b32 v88, 16, v205
    v_and_b32 v89, 0xffff0000, v205
    v_lshlrev_b32 v90, 16, v209
    v_and_b32 v91, 0xffff0000, v209
    v_pk_add_f32 v[86:87], v[86:87], v[88:89]
    v_pk_add_f32 v[226:227], v[226:227], v[90:91]
    v_pk_add_f32 v[226:227], v[226:227], v[86:87]
    v_cvt_pk_bf16_f32 v201, v226, v227
    buffer_store_dwordx2 v[200:201], v20, s[24:27], s65 offen
    v_lshlrev_b32 v92, 16, v202
    v_and_b32 v93, 0xffff0000, v202
    v_lshlrev_b32 v94, 16, v206
    v_and_b32 v95, 0xffff0000, v206
    v_lshlrev_b32 v96, 16, v210
    v_and_b32 v97, 0xffff0000, v210
    v_pk_add_f32 v[92:93], v[92:93], v[94:95]
    v_pk_add_f32 v[228:229], v[228:229], v[96:97]
    v_pk_add_f32 v[228:229], v[228:229], v[92:93]
    v_cvt_pk_bf16_f32 v202, v228, v229
    v_lshlrev_b32 v98, 16, v203
    v_and_b32 v99, 0xffff0000, v203
    v_lshlrev_b32 v100, 16, v207
    v_and_b32 v101, 0xffff0000, v207
    v_lshlrev_b32 v102, 16, v211
    v_and_b32 v103, 0xffff0000, v211
    v_pk_add_f32 v[98:99], v[98:99], v[100:101]
    v_pk_add_f32 v[230:231], v[230:231], v[102:103]
    v_pk_add_f32 v[230:231], v[230:231], v[98:99]
    v_cvt_pk_bf16_f32 v203, v230, v231
    buffer_store_dwordx2 v[202:203], v21, s[24:27], s65 offen
    s_waitcnt vmcnt(2)
K1_X2:
    s_waitcnt vmcnt(3)
    v_lshlrev_b32 v80, 16, v176
    v_and_b32 v81, 0xffff0000, v176
    v_lshlrev_b32 v82, 16, v180
    v_and_b32 v83, 0xffff0000, v180
    v_lshlrev_b32 v84, 16, v184
    v_and_b32 v85, 0xffff0000, v184
    v_pk_add_f32 v[80:81], v[80:81], v[82:83]
    v_pk_add_f32 v[160:161], v[160:161], v[84:85]
    v_pk_add_f32 v[160:161], v[160:161], v[80:81]
    v_cvt_pk_bf16_f32 v176, v160, v161
    v_lshlrev_b32 v86, 16, v177
    v_and_b32 v87, 0xffff0000, v177
    v_lshlrev_b32 v88, 16, v181
    v_and_b32 v89, 0xffff0000, v181
    v_lshlrev_b32 v90, 16, v185
    v_and_b32 v91, 0xffff0000, v185
    v_pk_add_f32 v[86:87], v[86:87], v[88:89]
    v_pk_add_f32 v[162:163], v[162:163], v[90:91]
    v_pk_add_f32 v[162:163], v[162:163], v[86:87]
    v_cvt_pk_bf16_f32 v177, v162, v163
    buffer_store_dwordx2 v[176:177], v20, s[24:27], s64 offen
    v_lshlrev_b32 v92, 16, v178
    v_and_b32 v93, 0xffff0000, v178
    v_lshlrev_b32 v94, 16, v182
    v_and_b32 v95, 0xffff0000, v182
    v_lshlrev_b32 v96, 16, v186
    v_and_b32 v97, 0xffff0000, v186
    v_pk_add_f32 v[92:93], v[92:93], v[94:95]
    v_pk_add_f32 v[164:165], v[164:165], v[96:97]
    v_pk_add_f32 v[164:165], v[164:165], v[92:93]
    v_cvt_pk_bf16_f32 v178, v164, v165
    v_lshlrev_b32 v98, 16, v179
    v_and_b32 v99, 0xffff0000, v179
    v_lshlrev_b32 v100, 16, v183
    v_and_b32 v101, 0xffff0000, v183
    v_lshlrev_b32 v102, 16, v187
    v_and_b32 v103, 0xffff0000, v187
    v_pk_add_f32 v[98:99], v[98:99], v[100:101]
    v_pk_add_f32 v[166:167], v[166:167], v[102:103]
    v_pk_add_f32 v[166:167], v[166:167], v[98:99]
    v_cvt_pk_bf16_f32 v179, v166, v167
    buffer_store_dwordx2 v[178:179], v21, s[24:27], s64 offen
    s_waitcnt vmcnt(2)
    v_lshlrev_b32 v80, 16, v188
    v_and_b32 v81, 0xffff0000, v188
    v_lshlrev_b32 v82, 16, v192
    v_and_b32 v83, 0xffff0000, v192
    v_lshlrev_b32 v84, 16, v196
    v_and_b32 v85, 0xffff0000, v196
    v_pk_add_f32 v[80:81], v[80:81], v[82:83]
    v_pk_add_f32 v[168:169], v[168:169], v[84:85]
    v_pk_add_f32 v[168:169], v[168:169], v[80:81]
    v_cvt_pk_bf16_f32 v188, v168, v169
    v_lshlrev_b32 v86, 16, v189
    v_and_b32 v87, 0xffff0000, v189
    v_lshlrev_b32 v88, 16, v193
    v_and_b32 v89, 0xffff0000, v193
    v_lshlrev_b32 v90, 16, v197
    v_and_b32 v91, 0xffff0000, v197
    v_pk_add_f32 v[86:87], v[86:87], v[88:89]
    v_pk_add_f32 v[170:171], v[170:171], v[90:91]
    v_pk_add_f32 v[170:171], v[170:171], v[86:87]
    v_cvt_pk_bf16_f32 v189, v170, v171
    buffer_store_dwordx2 v[188:189], v20, s[24:27], s64 offen offset:32
    v_lshlrev_b32 v92, 16, v190
    v_and_b32 v93, 0xffff0000, v190
    v_lshlrev_b32 v94, 16, v194
    v_and_b32 v95, 0xffff0000, v194
    v_lshlrev_b32 v96, 16, v198
    v_and_b32 v97, 0xffff0000, v198
    v_pk_add_f32 v[92:93], v[92:93], v[94:95]
    v_pk_add_f32 v[172:173], v[172:173], v[96:97]
    v_pk_add_f32 v[172:173], v[172:173], v[92:93]
    v_cvt_pk_bf16_f32 v190, v172, v173
    v_lshlrev_b32 v98, 16, v191
    v_and_b32 v99, 0xffff0000, v191
    v_lshlrev_b32 v100, 16, v195
    v_and_b32 v101, 0xffff0000, v195
    v_lshlrev_b32 v102, 16, v199
    v_and_b32 v103, 0xffff0000, v199
    v_pk_add_f32 v[98:99], v[98:99], v[100:101]
    v_pk_add_f32 v[174:175], v[174:175], v[102:103]
    v_pk_add_f32 v[174:175], v[174:175], v[98:99]
    v_cvt_pk_bf16_f32 v191, v174, v175
    buffer_store_dwordx2 v[190:191], v21, s[24:27], s64 offen offset:32
K1_END:
    s_endpgm
K1_LB_MASK:
    s_nop 1
    v_add_f32 v212, s12, v144
    v_fma_f32 v176, v208, s8, v212
    v_fma_f32 v177, v209, s8, v212
    v_fma_f32 v178, v210, s8, v212
    v_fma_f32 v179, v211, s8, v212
    v_add_f32 v213, s13, v144
    v_fma_f32 v180, v208, s9, v213
    v_fma_f32 v181, v209, s9, v213
    v_fma_f32 v182, v210, s9, v213
    v_fma_f32 v183, v211, s9, v213
    v_add_f32 v214, s14, v144
    v_fma_f32 v184, v208, s10, v214
    v_fma_f32 v185, v209, s10, v214
    v_fma_f32 v186, v210, s10, v214
    v_fma_f32 v187, v211, s10, v214
    v_add_f32 v215, s15, v144
    v_fma_f32 v188, v208, s11, v215
    v_fma_f32 v189, v209, s11, v215
    v_fma_f32 v190, v210, s11, v215
    v_fma_f32 v191, v211, s11, v215
    s_nop 1
    s_branch K1_LB_BACK
K1_LS_MASK:
    s_nop 1
    v_add_f32 v212, s12, v152
    v_fma_f32 v176, v208, s8, v212
    v_fma_f32 v177, v209, s8, v212
    v_fma_f32 v178, v210, s8, v212
    v_fma_f32 v179, v211, s8, v212
    v_add_f32 v213, s13, v152
    v_fma_f32 v180, v208, s9, v213
    v_fma_f32 v181, v209, s9, v213
    v_fma_f32 v182, v210, s9, v213
    v_fma_f32 v183, v211, s9, v213
    v_add_f32 v214, s14, v152
    v_fma_f32 v184, v208, s10, v214
    v_fma_f32 v185, v209, s10, v214
    v_fma_f32 v186, v210, s10, v214
    v_fma_f32 v187, v211, s10, v214
    v_add_f32 v215, s15, v152
    v_fma_f32 v188, v208, s11, v215
    v_fma_f32 v189, v209, s11, v215
    v_fma_f32 v190, v210, s11, v215
    v_fma_f32 v191, v211, s11, v215
    s_nop 1
    s_branch K1_LS_BACK
K1_HAVEM_R:
    s_add_u32 m0, s76, s75
    s_nop 0
    buffer_load_dwordx4 v1, s[36:39], s77 offen sc1 lds
    buffer_load_dwordx4 v1, s[36:39], s77 offen offset:1024 sc1 lds
    buffer_load_dwordx4 v1, s[36:39], s77 offen offset:2048 sc1 lds
    buffer_load_dwordx4 v1, s[36:39], s77 offen offset:3072 sc1 lds
    s_add_u32 s100, s77, 4096
    s_add_u32 m0, m0, 4096
    s_nop 0
    buffer_load_dwordx4 v1, s[36:39], s100 offen sc1 lds
    buffer_load_dwordx4 v1, s[36:39], s100 offen offset:1024 sc1 lds
    buffer_load_dwordx4 v1, s[36:39], s100 offen offset:2048 sc1 lds
    buffer_load_dwordx4 v1, s[36:39], s100 offen offset:3072 sc1 lds
    s_add_u32 s77, s77, 32768
    s_add_u32 s76, s76, 32768
    s_branch K1_HAVEM
K1_REDO:
    s_mov_b32 s83, 1
    s_waitcnt vmcnt(0) lgkmcnt(0)
    s_barrier
    v_lshrrev_b32 v92, 4, v1
    v_and_b32 v64, 15, v92
    v_lshrrev_b32 v92, 4, v92
    v_lshlrev_b32 v92, 2, v92
    v_sub_u32 v92, v64, v92
    s_lshl_b32 s98, s4, 4
    v_add_u32 v92, s98, v92
    s_lshl_b32 s98, s6, 7
    s_sub_u32 s99, 1920, s98
    v_add_u32 v64, s98, v92
    v_add_u32 v65, 64, v64
    v_add_u32 v66, s99, v92
    v_add_u32 v67, 64, v66
    v_mov_b32 v93, 0xf149f2ca
    v_mov_b32 v68, v93
    v_mov_b32 v69, v93
    v_mov_b32 v70, v93
    v_mov_b32 v71, v93
    s_mov_b32 s78, 0
    s_add_u32 s99, s99, 128
K1_REDO_L:
    s_lshr_b32 s7, s78, 6
    s_lshl_b32 s7, s7, 15
    s_bfe_u32 s98, s78, 0x20004
    s_lshl_b32 s98, s98, 12
    s_add_u32 s7, s7, s98
    buffer_load_dwordx4 v[72:75], v1, s[36:39], s7 offen offset:0 sc1
    buffer_load_dwordx4 v[76:79], v1, s[36:39], s7 offen offset:1024 sc1
    buffer_load_dwordx4 v[80:83], v1, s[36:39], s7 offen offset:2048 sc1
    buffer_load_dwordx4 v[84:87], v1, s[36:39], s7 offen offset:3072 sc1
    s_waitcnt vmcnt(0)
    v_mfma_f32_16x16x32_bf16 v[88:91], v[72:75], v[128:131], 0
    v_mfma_f32_16x16x32_bf16 v[88:91], v[76:79], v[160:163], v[88:91]
    v_mfma_f32_16x16x32_bf16 v[88:91], v[80:83], v[192:195], v[88:91]
    v_mfma_f32_16x16x32_bf16 v[88:91], v[84:87], v[224:227], v[88:91]
    v_subrev_u32 v92, s78, v64
    v_cmp_le_i32 vcc, 0, v92
    s_nop 5
    v_cndmask_b32 v88, v93, v88, vcc
    v_max_f32 v68, v68, v88
    v_cmp_le_i32 vcc, 1, v92
    s_nop 1
    v_cndmask_b32 v89, v93, v89, vcc
    v_max_f32 v68, v68, v89
    v_cmp_le_i32 vcc, 2, v92
    s_nop 1
    v_cndmask_b32 v90, v93, v90, vcc
    v_max_f32 v68, v68, v90
    v_cmp_le_i32 vcc, 3, v92
    s_nop 1
    v_cndmask_b32 v91, v93, v91, vcc
    v_max_f32 v68, v68, v91
    v_mfma_f32_16x16x32_bf16 v[88:91], v[72:75], v[132:135], 0
    v_mfma_f32_16x16x32_bf16 v[88:91], v[76:79], v[164:167], v[88:91]
    v_mfma_f32_16x16x32_bf16 v[88:91], v[80:83], v[196:199], v[88:91]
    v_mfma_f32_16x16x32_bf16 v[88:91], v[84:87], v[228:231], v[88:91]
    v_subrev_u32 v92, s78, v65
    v_cmp_le_i32 vcc, 0, v92
    s_nop 5
    v_cndmask_b32 v88, v93, v88, vcc
    v_max_f32 v69, v69, v88
    v_cmp_le_i32 vcc, 1, v92
    s_nop 1
    v_cndmask_b32 v89, v93, v89, vcc
    v_max_f32 v69, v69, v89
    v_cmp_le_i32 vcc, 2, v92
    s_nop 1
    v_cndmask_b32 v90, v93, v90, vcc
    v_max_f32 v69, v69, v90
    v_cmp_le_i32 vcc, 3, v92
    s_nop 1
    v_cndmask_b32 v91, v93, v91, vcc
    v_max_f32 v69, v69, v91
    v_mfma_f32_16x16x32_bf16 v[88:91], v[72:75], v[136:139], 0
    v_mfma_f32_16x16x32_bf16 v[88:91], v[76:79], v[168:171], v[88:91]
    v_mfma_f32_16x16x32_bf16 v[88:91], v[80:83], v[200:203], v[88:91]
    v_mfma_f32_16x16x32_bf16 v[88:91], v[84:87], v[232:235], v[88:91]
    v_subrev_u32 v92, s78, v66
    v_cmp_le_i32 vcc, 0, v92
    s_nop 5
    v_cndmask_b32 v88, v93, v88, vcc
    v_max_f32 v70, v70, v88
    v_cmp_le_i32 vcc, 1, v92
    s_nop 1
    v_cndmask_b32 v89, v93, v89, vcc
    v_max_f32 v70, v70, v89
    v_cmp_le_i32 vcc, 2, v92
    s_nop 1
    v_cndmask_b32 v90, v93, v90, vcc
    v_max_f32 v70, v70, v90
    v_cmp_le_i32 vcc, 3, v92
    s_nop 1
    v_cndmask_b32 v91, v93, v91, vcc
    v_max_f32 v70, v70, v91
    v_mfma_f32_16x16x32_bf16 v[88:91], v[72:75], v[140:143], 0
    v_mfma_f32_16x16x32_bf16 v[88:91], v[76:79], v[172:175], v[88:91]
    v_mfma_f32_16x16x32_bf16 v[88:91], v[80:83], v[204:207], v[88:91]
    v_mfma_f32_16x16x32_bf16 v[88:91], v[84:87], v[236:239], v[88:91]
    v_subrev_u32 v92, s78, v67
    v_cmp_le_i32 vcc, 0, v92
    s_nop 5
    v_cndmask_b32 v88, v93, v88, vcc
    v_max_f32 v71, v71, v88
    v_cmp_le_i32 vcc, 1, v92
    s_nop 1
    v_cndmask_b32 v89, v93, v89, vcc
    v_max_f32 v71, v71, v89
    v_cmp_le_i32 vcc, 2, v92
    s_nop 1
    v_cndmask_b32 v90, v93, v90, vcc
    v_max_f32 v71, v71, v90
    v_cmp_le_i32 vcc, 3, v92
    s_nop 1
    v_cndmask_b32 v91, v93, v91, vcc
    v_max_f32 v71, v71, v91
    s_add_u32 s78, s78, 16
    s_cmp_lt_u32 s78, s99
    s_cbranch_scc1 K1_REDO_L
    v_mov_b32 v92, v68
    s_nop 1
    v_permlane32_swap_b32 v68, v92
    v_max_f32 v68, v68, v92
    v_mov_b32 v92, v68
    s_nop 1
    v_permlane16_swap_b32 v68, v92
    v_max_f32 v68, v68, v92
    v_sub_f32 v144, 0, v68
    v_sub_f32 v145, 0, v68
    v_sub_f32 v146, 0, v68
    v_sub_f32 v147, 0, v68
    v_mov_b32 v92, v69
    s_nop 1
    v_permlane32_swap_b32 v69, v92
    v_max_f32 v69, v69, v92
    v_mov_b32 v92, v69
    s_nop 1
    v_permlane16_swap_b32 v69, v92
    v_max_f32 v69, v69, v92
    v_sub_f32 v148, 0, v69
    v_sub_f32 v149, 0, v69
    v_sub_f32 v150, 0, v69
    v_sub_f32 v151, 0, v69
    v_mov_b32 v92, v70
    s_nop 1
    v_permlane32_swap_b32 v70, v92
    v_max_f32 v70, v70, v92
    v_mov_b32 v92, v70
    s_nop 1
    v_permlane16_swap_b32 v70, v92
    v_max_f32 v70, v70, v92
    v_sub_f32 v152, 0, v70
    v_sub_f32 v153, 0, v70
    v_sub_f32 v154, 0, v70
    v_sub_f32 v155, 0, v70
    v_mov_b32 v92, v71
    s_nop 1
    v_permlane32_swap_b32 v71, v92
    v_max_f32 v71, v71, v92
    v_mov_b32 v92, v71
    s_nop 1
    v_permlane16_swap_b32 v71, v92
    v_max_f32 v71, v71, v92
    v_sub_f32 v156, 0, v71
    v_sub_f32 v157, 0, v71
    v_sub_f32 v158, 0, v71
    v_sub_f32 v159, 0, v71
    v_accvgpr_write_b32 a0, 0
    v_accvgpr_write_b32 a1, 0
    v_accvgpr_write_b32 a2, 0
    v_accvgpr_write_b32 a3, 0
    v_accvgpr_write_b32 a4, 0
    v_accvgpr_write_b32 a5, 0
    v_accvgpr_write_b32 a6, 0
    v_accvgpr_write_b32 a7, 0
    v_accvgpr_write_b32 a8, 0
    v_accvgpr_write_b32 a9, 0
    v_accvgpr_write_b32 a10, 0
    v_accvgpr_write_b32 a11, 0
    v_accvgpr_write_b32 a12, 0
    v_accvgpr_write_b32 a13, 0
    v_accvgpr_write_b32 a14, 0
    v_accvgpr_write_b32 a15, 0
    v_accvgpr_write_b32 a16, 0
    v_accvgpr_write_b32 a17, 0
    v_accvgpr_write_b32 a18, 0
    v_accvgpr_write_b32 a19, 0
    v_accvgpr_write_b32 a20, 0
    v_accvgpr_write_b32 a21, 0
    v_accvgpr_write_b32 a22, 0
    v_accvgpr_write_b32 a23, 0
    v_accvgpr_write_b32 a24, 0
    v_accvgpr_write_b32 a25, 0
    v_accvgpr_write_b32 a26, 0
    v_accvgpr_write_b32 a27, 0
    v_accvgpr_write_b32 a28, 0
    v_accvgpr_write_b32 a29, 0
    v_accvgpr_write_b32 a30, 0
    v_accvgpr_write_b32 a31, 0
    v_accvgpr_write_b32 a32, 0
    v_accvgpr_write_b32 a33, 0
    v_accvgpr_write_b32 a34, 0
    v_accvgpr_write_b32 a35, 0
    v_accvgpr_write_b32 a36, 0
    v_accvgpr_write_b32 a37, 0
    v_accvgpr_write_b32 a38, 0
    v_accvgpr_write_b32 a39, 0
    v_accvgpr_write_b32 a40, 0
    v_accvgpr_write_b32 a41, 0
    v_accvgpr_write_b32 a42, 0
    v_accvgpr_write_b32 a43, 0
    v_accvgpr_write_b32 a44, 0
    v_accvgpr_write_b32 a45, 0
    v_accvgpr_write_b32 a46, 0
    v_accvgpr_write_b32 a47, 0
    v_accvgpr_write_b32 a48, 0
    v_accvgpr_write_b32 a49, 0
    v_accvgpr_write_b32 a50, 0
    v_accvgpr_write_b32 a51, 0
    v_accvgpr_write_b32 a52, 0
    v_accvgpr_write_b32 a53, 0
    v_accvgpr_write_b32 a54, 0
    v_accvgpr_write_b32 a55, 0
    v_accvgpr_write_b32 a56, 0
    v_accvgpr_write_b32 a57, 0
    v_accvgpr_write_b32 a58, 0
    v_accvgpr_write_b32 a59, 0
    v_accvgpr_write_b32 a60, 0
    v_accvgpr_write_b32 a61, 0
    v_accvgpr_write_b32 a62, 0
    v_accvgpr_write_b32 a63, 0
    v_accvgpr_write_b32 a144, 0
    v_accvgpr_write_b32 a145, 0
    v_accvgpr_write_b32 a146, 0
    v_accvgpr_write_b32 a147, 0
    v_accvgpr_write_b32 a148, 0
    v_accvgpr_write_b32 a149, 0
    v_accvgpr_write_b32 a150, 0
    v_accvgpr_write_b32 a151, 0
    v_accvgpr_write_b32 a152, 0
    v_accvgpr_write_b32 a153, 0
    v_accvgpr_write_b32 a154, 0
    v_accvgpr_write_b32 a155, 0
    v_accvgpr_write_b32 a156, 0
    v_accvgpr_write_b32 a157, 0
    v_accvgpr_write_b32 a158, 0
    v_accvgpr_write_b32 a159, 0
    v_accvgpr_write_b32 a160, 0
    v_accvgpr_write_b32 a161, 0
    v_accvgpr_write_b32 a162, 0
    v_accvgpr_write_b32 a163, 0
    v_accvgpr_write_b32 a164, 0
    v_accvgpr_write_b32 a165, 0
    v_accvgpr_write_b32 a166, 0
    v_accvgpr_write_b32 a167, 0
    v_accvgpr_write_b32 a168, 0
    v_accvgpr_write_b32 a169, 0
    v_accvgpr_write_b32 a170, 0
    v_accvgpr_write_b32 a171, 0
    v_accvgpr_write_b32 a172, 0
    v_accvgpr_write_b32 a173, 0
    v_accvgpr_write_b32 a174, 0
    v_accvgpr_write_b32 a175, 0
    v_accvgpr_write_b32 a176, 0
    v_accvgpr_write_b32 a177, 0
    v_accvgpr_write_b32 a178, 0
    v_accvgpr_write_b32 a179, 0
    v_accvgpr_write_b32 a180, 0
    v_accvgpr_write_b32 a181, 0
    v_accvgpr_write_b32 a182, 0
    v_accvgpr_write_b32 a183, 0
    v_accvgpr_write_b32 a184, 0
    v_accvgpr_write_b32 a185, 0
    v_accvgpr_write_b32 a186, 0
    v_accvgpr_write_b32 a187, 0
    v_accvgpr_write_b32 a188, 0
    v_accvgpr_write_b32 a189, 0
    v_accvgpr_write_b32 a190, 0
    v_accvgpr_write_b32 a191, 0
    v_accvgpr_write_b32 a192, 0
    v_accvgpr_write_b32 a193, 0
    v_accvgpr_write_b32 a194, 0
    v_accvgpr_write_b32 a195, 0
    v_accvgpr_write_b32 a196, 0
    v_accvgpr_write_b32 a197, 0
    v_accvgpr_write_b32 a198, 0
    v_accvgpr_write_b32 a199, 0
    v_accvgpr_write_b32 a200, 0
    v_accvgpr_write_b32 a201, 0
    v_accvgpr_write_b32 a202, 0
    v_accvgpr_write_b32 a203, 0
    v_accvgpr_write_b32 a204, 0
    v_accvgpr_write_b32 a205, 0
    v_accvgpr_write_b32 a206, 0
    v_accvgpr_write_b32 a207, 0
    v_accvgpr_write_b32 a208, 0
    v_accvgpr_write_b32 a209, 0
    v_accvgpr_write_b32 a210, 0
    v_accvgpr_write_b32 a211, 0
    v_accvgpr_write_b32 a212, 0
    v_accvgpr_write_b32 a213, 0
    v_accvgpr_write_b32 a214, 0
    v_accvgpr_write_b32 a215, 0
    v_accvgpr_write_b32 a216, 0
    v_accvgpr_write_b32 a217, 0
    v_accvgpr_write_b32 a218, 0
    v_accvgpr_write_b32 a219, 0
    v_accvgpr_write_b32 a220, 0
    v_accvgpr_write_b32 a221, 0
    v_accvgpr_write_b32 a222, 0
    v_accvgpr_write_b32 a223, 0
    v_mov_b32 v92, 0x3f803f80
    v_accvgpr_write_b32 a136, v92
    v_accvgpr_write_b32 a137, v92
    v_accvgpr_write_b32 a138, v92
    v_accvgpr_write_b32 a139, v92
    s_mov_b32 s77, s75
    s_mov_b32 s76, 0
    s_mov_b32 s38, 16384
    s_add_u32 m0, s76, s75
    s_nop 0
    buffer_load_dwordx4 v1, s[36:39], s77 offen sc1 lds
    buffer_load_dwordx4 v1, s[36:39], s77 offen offset:1024 sc1 lds
    buffer_load_dwordx4 v1, s[36:39], s77 offen offset:2048 sc1 lds
    buffer_load_dwordx4 v1, s[36:39], s77 offen offset:3072 sc1 lds
    s_add_u32 s100, s77, 4096
    s_add_u32 m0, m0, 4096
    s_nop 0
    buffer_load_dwordx4 v1, s[36:39], s100 offen sc1 lds
    buffer_load_dwordx4 v1, s[36:39], s100 offen offset:1024 sc1 lds
    buffer_load_dwordx4 v1, s[36:39], s100 offen offset:2048 sc1 lds
    buffer_load_dwordx4 v1, s[36:39], s100 offen offset:3072 sc1 lds
    s_add_u32 s77, s77, 32768
    s_add_u32 s76, s76, 32768
    s_lshr_b32 s7, s4, 1
    s_add_u32 s7, s7, 32
    s_sub_u32 s7, s7, s6
    s_sub_u32 s7, s7, s6
    s_lshl_b32 s38, s7, 15
    s_add_u32 m0, s76, s75
    s_nop 0
    buffer_load_dwordx4 v1, s[36:39], s77 offen sc1 lds
    buffer_load_dwordx4 v1, s[36:39], s77 offen offset:1024 sc1 lds
    buffer_load_dwordx4 v1, s[36:39], s77 offen offset:2048 sc1 lds
    buffer_load_dwordx4 v1, s[36:39], s77 offen offset:3072 sc1 lds
    s_add_u32 s100, s77, 4096
    s_add_u32 m0, m0, 4096
    s_nop 0
    buffer_load_dwordx4 v1, s[36:39], s100 offen sc1 lds
    buffer_load_dwordx4 v1, s[36:39], s100 offen offset:1024 sc1 lds
    buffer_load_dwordx4 v1, s[36:39], s100 offen offset:2048 sc1 lds
    buffer_load_dwordx4 v1, s[36:39], s100 offen offset:3072 sc1 lds
    s_add_u32 s77, s77, 32768
    s_add_u32 s76, s76, 32768
    s_branch K1_ATT
SPIN_WA:
    s_mov_b32 s94, 0
SPIN_WA_L:
    s_sleep 2
    buffer_load_dword v7, v9, s[44:47], s69 offen sc1
    s_add_u32 s94, s94, 1
    s_cmp_ge_u32 s94, 0x40000
    s_waitcnt vmcnt(0)
    s_cbranch_scc1 BACK_WA
    v_cmp_gt_u32 vcc, 8, v7
    s_nop 1
    s_and_b64 vcc, vcc, s[86:87]
    s_cbranch_scc1 SPIN_WA_L
    s_branch BACK_WA
SPIN_KV:
    s_mov_b32 s94, 0
SPIN_KV_L:
    s_sleep 2
    buffer_load_dword v7, v8, s[32:35], s61 offen sc1
    s_add_u32 s94, s94, 1
    s_cmp_ge_u32 s94, 0x40000
    s_waitcnt vmcnt(0)
    s_cbranch_scc1 BACK_KV
    v_cmp_gt_u32 vcc, 1, v7
    s_nop 1
    s_and_b64 vcc, vcc, exec
    s_cbranch_scc1 SPIN_KV_L
    s_branch BACK_KV
SPIN_ALL:
    s_mov_b32 s94, 0
SPIN_ALL_L:
    s_sleep 2
    buffer_load_dword v3, v29, s[44:47], 0 offen sc1
    s_add_u32 s94, s94, 1
    s_cmp_ge_u32 s94, 0x40000
    s_waitcnt vmcnt(0)
    s_cbranch_scc1 BACK_ALL
    v_cmp_gt_u32 vcc, 16, v3
    s_nop 1
    s_and_b64 vcc, vcc, s[92:93]
    s_cbranch_scc1 SPIN_ALL_L
    s_branch BACK_ALL
SPIN_CTX:
    s_mov_b32 s94, 0
SPIN_CTX_L:
    s_sleep 2
    buffer_load_dword v3, v19, s[32:35], s66 offen sc1
    s_add_u32 s94, s94, 1
    s_cmp_ge_u32 s94, 0x40000
    s_waitcnt vmcnt(0)
    s_cbranch_scc1 BACK_CTX
    v_cmp_gt_u32 vcc, 2, v3
    s_nop 1
    s_and_b64 vcc, vcc, exec
    s_cbranch_scc1 SPIN_CTX_L
    s_branch BACK_CTX
SPIN_OA:
    s_mov_b32 s94, 0
SPIN_OA_L:
    s_sleep 2
    buffer_load_dword v3, v19, s[32:35], s66 offen sc1
    s_add_u32 s94, s94, 1
    s_cmp_ge_u32 s94, 0x40000
    s_waitcnt vmcnt(0)
    s_cbranch_scc1 BACK_OA
    v_cmp_gt_u32 vcc, 3, v3
    s_nop 1
    s_and_b64 vcc, vcc, exec
    s_cbranch_scc1 SPIN_OA_L
    s_branch BACK_OA
SPIN_X:
    s_mov_b32 s94, 0
SPIN_X_L:
    s_sleep 2
    buffer_load_dword v3, v19, s[32:35], s66 offen sc1
    s_add_u32 s94, s94, 1
    s_cmp_ge_u32 s94, 0x40000
    s_waitcnt vmcnt(0)
    s_cbranch_scc1 BACK_X
    v_cmp_gt_u32 vcc, 1, v3
    s_nop 1
    s_and_b64 vcc, vcc, exec
    s_cbranch_scc1 SPIN_X_L
    s_branch BACK_X
.section .rodata,"a"
.p2align 6
.amdhsa_kernel gated_mix__sliding_local_dilated__compressed_kv_cla__prompt_kernel
.amdhsa_next_free_vgpr 512
.amdhsa_next_free_sgpr 102
.amdhsa_accum_offset 256
.amdhsa_group_segment_fixed_size 0
.amdhsa_kernarg_size 104
.amdhsa_user_sgpr_count 2
.amdhsa_user_sgpr_kernarg_segment_ptr 1
.amdhsa_system_sgpr_workgroup_id_x 1
.amdhsa_ieee_mode 0
.amdhsa_dx10_clamp 0
.end_amdhsa_kernel
```

```asm
; @launch grid=(256,1,1) block=(256,1,1) lds=163840
.amdgcn_target "amdgcn-amd-amdhsa--gfx950"
.text
.globl gated_mix__sliding_local_dilated__compressed_kv_cla__prompt_kernel
.p2align 8
.type gated_mix__sliding_local_dilated__compressed_kv_cla__prompt_kernel,@function
gated_mix__sliding_local_dilated__compressed_kv_cla__prompt_kernel:
    s_cmp_ge_u32 s2, 256
    s_cbranch_scc1 K1_END
    s_getpc_b64 s[94:95]
    s_load_dwordx8 s[36:43], s[0:1], 32
    v_min_u32 v74, 16, v0
    s_lshr_b32 s7, s2, 3
    s_mul_i32 s7, s7, 17
    v_add_lshl_u32 v74, v74, s7, 7
    global_load_dword v76, v74, s[94:95]
    v_lshrrev_b32 v64, 6, v0
    v_and_b32 v31, 63, v0
    v_readfirstlane_b32 s4, v64
    s_and_b32 s5, s2, 7
    s_lshl_b32 s5, s5, 2
    s_bfe_u32 s7, s2, 0x20003
    s_add_u32 s5, s5, s7
    s_lshr_b32 s6, s2, 5
    s_lshl_b32 s69, s4, 12
    s_mov_b32 s10, 2097152
    s_mov_b32 s11, 0x20000
    s_mov_b32 s14, 4194304
    s_mov_b32 s15, 0x20000
    s_mov_b32 s18, 4194304
    s_mov_b32 s19, 0x20000
    v_lshrrev_b32 v65, 3, v31
    v_and_b32 v66, 7, v31
    v_lshrrev_b32 v67, 1, v65
    v_xor_b32 v66, v66, v67
    v_lshlrev_b32 v66, 4, v66
    v_xor_b32 v67, 64, v66
    s_lshr_b32 s7, s4, 1
    s_lshl_b32 s73, s7, 7
    s_and_b32 s100, s4, 1
    s_lshl_b32 s98, s100, 5
    s_add_u32 s98, s98, s73
    v_add_lshl_u32 v68, v65, s98, 10
    v_add_u32 v6, v68, v66
    v_add_u32 v7, v68, v67
    v_add_u32 v7, 7168, v7
    v_add_u32 v8, v68, v66
    v_add_u32 v8, 14336, v8
    v_add_u32 v9, v68, v67
    v_add_u32 v9, 21504, v9
    v_lshrrev_b32 v69, 4, v31
    v_and_b32 v70, 15, v31
    v_lshlrev_b32 v71, 1, v69
    v_xor_b32 v71, v71, v70
    v_lshlrev_b32 v71, 4, v71
    v_xor_b32 v72, 128, v71
    s_lshl_b32 s98, s4, 4
    v_add_lshl_u32 v73, v69, s98, 13
    v_add_u32 v2, v73, v71
    v_add_u32 v3, v73, v71
    v_add_u32 v3, 31744, v3
    v_add_u32 v4, v73, v72
    v_add_u32 v4, 63488, v4
    v_add_u32 v5, v73, v72
    v_add_u32 v5, 95232, v5
    s_and_b32 s3, s6, 0
    s_lshl_b32 s66, s3, 7
    s_lshl_b32 s60, s3, 11
    s_add_u32 s60, s60, s5
    s_lshl_b32 s60, s60, 8
    s_lshl_b32 s61, s6, 18
    s_add_u32 s61, s61, s66
    s_add_u32 s62, s61, 65536
    s_waitcnt lgkmcnt(0)
    s_mov_b64 s[8:9], s[36:37]
    s_mov_b64 s[24:25], s[38:39]
    s_mov_b64 s[12:13], s[40:41]
    s_mov_b64 s[16:17], s[42:43]
    s_load_dwordx2 s[20:21], s[0:1], 0
    s_load_dwordx2 s[28:29], s[0:1], 8
    s_load_dwordx2 s[32:33], s[0:1], 72
    s_load_dwordx2 s[48:49], s[0:1], 64
    s_load_dwordx2 s[92:93], s[0:1], 16
    s_load_dwordx2 s[44:45], s[0:1], 88
    s_load_dwordx2 s[56:57], s[0:1], 96
    s_add_u32 m0, s69, 0
    s_nop 0
    buffer_load_dwordx4 v6, s[8:11], s61 offen lds
    buffer_load_dwordx4 v7, s[8:11], s61 offen offset:1024 lds
    buffer_load_dwordx4 v8, s[8:11], s61 offen offset:2048 lds
    buffer_load_dwordx4 v9, s[8:11], s61 offen offset:3072 lds
    s_xor_b32 s61, s61, 128
    s_add_u32 m0, s69, 16384
    s_nop 0
    buffer_load_dwordx4 v6, s[8:11], s62 offen lds
    buffer_load_dwordx4 v7, s[8:11], s62 offen offset:1024 lds
    buffer_load_dwordx4 v8, s[8:11], s62 offen offset:2048 lds
    buffer_load_dwordx4 v9, s[8:11], s62 offen offset:3072 lds
    s_xor_b32 s62, s62, 128
    s_add_u32 m0, s69, 32768
    s_nop 0
    buffer_load_dwordx4 v2, s[12:15], s60 offen nt lds
    buffer_load_dwordx4 v3, s[12:15], s60 offen offset:1024 nt lds
    buffer_load_dwordx4 v4, s[12:15], s60 offen offset:2048 nt lds
    buffer_load_dwordx4 v5, s[12:15], s60 offen offset:3072 nt lds
    s_add_u32 m0, s69, 49152
    s_nop 0
    buffer_load_dwordx4 v6, s[8:11], s61 offen lds
    buffer_load_dwordx4 v7, s[8:11], s61 offen offset:1024 lds
    buffer_load_dwordx4 v8, s[8:11], s61 offen offset:2048 lds
    buffer_load_dwordx4 v9, s[8:11], s61 offen offset:3072 lds
    s_xor_b32 s61, s61, 384
    v_min_u32 v74, 15, v31
    s_lshl2_add_u32 s98, s2, s4
    s_lshl_b32 s98, s98, 11
    v_lshlrev_b32 v74, 7, v74
    buffer_load_dword v102, v74, s[8:11], s98 offen
    s_cmp_lt_u32 s4, 2
    s_cselect_b32 s40, s12, s16
    s_cselect_b32 s41, s13, s17
    s_mov_b32 s42, 4194304
    s_mov_b32 s43, 0x20000
    v_min_u32 v120, 7, v31
    v_and_b32 v75, 1, v120
    v_lshrrev_b32 v120, 1, v120
    s_lshl1_add_u32 s98, s6, s100
    s_lshl_b32 s98, s98, 2
    v_add_lshl_u32 v120, v120, s98, 6
    s_lshl_b32 s98, s5, 1
    v_add3_u32 v120, v120, v75, s98
    v_lshlrev_b32 v120, 7, v120
    s_mov_b32 s98, 524288
    buffer_load_dword v121, v120, s[40:43], s98 offen nt
    s_mov_b32 s98, 1048576
    buffer_load_dword v122, v120, s[40:43], s98 offen nt
    s_waitcnt lgkmcnt(0)
    s_mov_b32 s22, 2359296
    s_mov_b32 s23, 0x20000
    s_mov_b32 s26, 4718592
    s_mov_b32 s27, 0x20000
    s_mov_b32 s50, 4718592
    s_mov_b32 s51, 0x20000
    s_mov_b32 s46, 256
    s_mov_b32 s47, 0x20000
    s_mov_b32 s30, 1990656
    s_mov_b32 s31, 0x20000
    s_mov_b32 s34, 1152
    s_mov_b32 s35, 0x20000
    s_mul_i32 s7, s5, 1081344
    s_add_u32 s36, s56, s7
    s_addc_u32 s37, s57, 0
    s_mov_b32 s38, 1081344
    s_mov_b32 s39, 0x20000
    s_cmp_eq_u32 s4, 0
    s_cselect_b32 s86, 0x55555555, 0
    s_cselect_b32 s87, 0x55555555, 0
    s_cselect_b32 s52, s48, s92
    s_cselect_b32 s53, s49, s93
    s_cselect_b32 s54, s50, 663552
    s_mov_b32 s55, 0x20000
    s_mul_i32 s63, s6, 147456
    s_sub_u32 s64, 2211840, s63
    s_add_u32 s63, s63, s66
    s_add_u32 s64, s64, s66
    s_lshl_b32 s67, s4, 11
    s_lshl_b32 s68, s4, 10
    s_lshl_b32 s75, s4, 13
    s_lshl_b32 s65, s3, 13
    s_add_u32 s65, s65, s67
    s_lshl_b32 s70, s6, 2
    s_lshl1_add_u32 s70, s100, s70
    s_lshl_b32 s70, s70, 15
    s_lshl_b32 s98, s73, 6
    s_add_u32 s71, s70, s98
    s_add_u32 s71, s71, 49152
    s_lshl_b32 s98, s73, 4
    s_add_u32 s70, s70, s98
    v_lshlrev_b32 v1, 4, v31
    v_mov_b32 v77, 1073741824
    v_cmp_eq_u32 vcc, 0, v0
    s_nop 1
    v_cndmask_b32_e64 v30, v77, 0, vcc
    v_lshlrev_b32 v103, 7, v31
    v_cmp_gt_u32 vcc, 9, v31
    s_nop 1
    v_cndmask_b32 v103, v77, v103, vcc
    s_lshl_b32 s98, s4, 5
    v_add_u32 v68, s98, v65
    v_mul_u32_u24 v68, 1152, v68
    v_add_u32 v10, v68, v66
    v_add_u32 v11, v68, v67
    v_add_u32 v11, 8192, v11
    v_add_u32 v12, v68, v66
    v_add_u32 v12, 16384, v12
    v_add_u32 v13, v68, v67
    v_add_u32 v13, 24576, v13
    s_sub_u32 s98, 15, s6
    s_cmp_eq_u32 s73, 0
    s_cselect_b32 s98, s6, s98
    s_lshl_b32 s98, s98, 7
    s_sub_u32 s98, s98, 16
    s_max_i32 s98, s98, 0
    s_lshl3_add_u32 s98, s100, s98
    v_add_u32 v68, s98, v65
    v_mul_u32_u24 v68, 1152, v68
    s_lshl_b32 s98, s100, 6
    v_xor_b32 v73, s98, v66
    v_add_u32 v96, v68, v73
    s_add_u32 m0, s69, 65536
    s_nop 0
    buffer_load_dwordx4 v2, s[16:19], s60 offen nt lds
    v_lshrrev_b32 v71, 1, v70
    v_xor_b32 v71, v71, v69
    v_lshlrev_b32 v71, 4, v71
    v_lshl_add_u32 v71, v70, 7, v71
    v_xor_b32 v72, 64, v71
    s_lshl_b32 s98, s100, 13
    v_add_u32 v22, s98, v71
    v_add_u32 v23, s98, v72
    v_add_u32 v24, s67, v71
    v_add_u32 v25, s67, v72
    s_lshl_b32 s98, s100, 11
    s_add_u32 s98, s98, 8192
    v_add_u32 v100, s98, v71
    v_add_u32 v101, s98, v72
    v_bfe_u32 v73, v31, 2, 2
    v_and_b32 v74, 3, v31
    v_lshl_add_u32 v75, v69, 3, v73
    v_and_b32 v78, 1, v69
    buffer_load_dwordx4 v3, s[16:19], s60 offen offset:1024 nt lds
    v_lshl_add_u32 v77, v78, 2, v73
    v_lshlrev_b32 v77, 5, v77
    v_lshl_add_u32 v77, v74, 3, v77
    v_lshl_add_u32 v77, v75, 8, v77
    v_xor_b32 v14, 0, v77
    v_xor_b32 v14, s73, v14
    v_xor_b32 v15, 32, v77
    v_xor_b32 v15, s73, v15
    v_xor_b32 v16, 64, v77
    v_xor_b32 v16, s73, v16
    v_xor_b32 v17, 96, v77
    v_xor_b32 v17, s73, v17
    v_xor_b32 v18, 128, v77
    v_xor_b32 v19, 160, v77
    v_xor_b32 v20, 192, v77
    v_xor_b32 v21, 224, v77
    v_lshrrev_b32 v77, 1, v73
    v_lshl_add_u32 v77, v78, 1, v77
    buffer_load_dwordx4 v4, s[16:19], s60 offen offset:2048 nt lds
    v_lshlrev_b32 v77, 5, v77
    v_lshl_add_u32 v77, v74, 3, v77
    v_lshl_add_u32 v77, v75, 7, v77
    s_lshr_b32 s98, s73, 1
    v_xor_b32 v26, 0, v77
    v_xor_b32 v26, s98, v26
    v_xor_b32 v27, 32, v77
    v_xor_b32 v28, 64, v77
    v_xor_b32 v28, s98, v28
    v_xor_b32 v29, 96, v77
    v_and_b32 v73, 7, v0
    v_lshrrev_b32 v74, 3, v0
    v_lshl_add_u32 v75, v73, 1, 0
    v_mul_u32_u24 v78, 52, v75
    v_lshrrev_b32 v78, 8, v78
    v_mul_u32_u24 v79, 5, v78
    v_sub_u32 v75, v75, v79
    v_add_u32 v78, 1, v78
    buffer_load_dwordx4 v5, s[16:19], s60 offen offset:3072 nt lds
    s_xor_b32 s60, s60, 524288
    v_cmp_le_u32 vcc, 3, v78
    s_nop 1
    v_cndmask_b32_e64 v78, v78, 0, vcc
    v_mul_u32_u24 v78, 1152, v78
    v_lshl_add_u32 v75, v75, 3, v78
    v_mad_u32_u24 v75, v74, 36, v75
    v_lshl_add_u32 v77, v73, 1, 1
    v_mul_u32_u24 v78, 52, v77
    v_lshrrev_b32 v78, 8, v78
    v_mul_u32_u24 v79, 5, v78
    v_sub_u32 v77, v77, v79
    v_add_u32 v78, 1, v78
    v_cmp_le_u32 vcc, 3, v78
    s_nop 1
    v_cndmask_b32_e64 v78, v78, 0, vcc
    v_mul_u32_u24 v78, 1152, v78
    v_lshl_add_u32 v77, v77, 3, v78
    v_mad_u32_u24 v77, v74, 36, v77
    s_mul_i32 s98, s2, 10368
    s_mul_i32 s99, s2, 6
    s_mov_b32 s7, 73728
    v_mul_lo_u32 v95, v74, s7
    v_lshl_add_u32 v95, v73, 4, v95
    v_cmp_eq_u32 s[92:93], 7, v73
    s_add_u32 s56, s56, 56623104
    s_addc_u32 s57, s57, 0
    s_mov_b32 s58, 5603328
    s_mov_b32 s59, 0x20000
    s_lshl_b32 s101, s6, 5
    s_add_u32 s101, s101, s5
    s_lshl_b32 s101, s101, 7
    v_mov_b32 v65, 0
    v_lshlrev_b32 v64, 15, v0
    s_mov_b32 s74, 0x3e0293ee
    s_mov_b64 s[84:85], 0
    s_mov_b32 s83, 0
    s_lshl_b32 s95, s5, 3
    s_waitcnt vmcnt(7)
    s_barrier
    ds_read_b128 a[0:3], v22 offset:0
    ds_read_b64_tr_b16 v[40:41], v14 offset:32768
    ds_read_b64_tr_b16 v[42:43], v14 offset:33792
    ds_read_b128 a[4:7], v23 offset:0
    ds_read_b64_tr_b16 v[44:45], v14 offset:40960
    ds_read_b64_tr_b16 v[46:47], v14 offset:41984
    ds_read_b128 a[8:11], v22 offset:2048
    ds_read_b128 a[12:15], v23 offset:2048
    ds_read_b128 a[16:19], v22 offset:4096
    ds_read_b128 a[20:23], v23 offset:4096
    ds_read_b128 a[24:27], v22 offset:6144
    ds_read_b128 a[28:31], v23 offset:6144
    ds_read_b128 a[32:35], v22 offset:16384
    ds_read_b128 a[36:39], v23 offset:16384
    ds_read_b128 a[40:43], v22 offset:18432
    s_waitcnt lgkmcnt(14)
    ds_read_b128 a[44:47], v23 offset:18432
    s_waitcnt lgkmcnt(14)
    ds_read_b128 a[48:51], v22 offset:20480
    s_waitcnt lgkmcnt(14)
    ds_read_b128 a[52:55], v23 offset:20480
    s_waitcnt lgkmcnt(14)
    ds_read_b128 a[56:59], v22 offset:22528
    s_waitcnt lgkmcnt(14)
    ds_read_b128 a[60:63], v23 offset:22528
    v_mfma_f32_16x16x32_bf16 v[128:131], v[40:43], a[0:3], 0
    s_add_u32 m0, s69, 81920
    s_waitcnt lgkmcnt(14)
    ds_read_b64_tr_b16 v[48:49], v15 offset:32768
    s_waitcnt lgkmcnt(14)
    ds_read_b64_tr_b16 v[50:51], v15 offset:33792
    v_mfma_f32_16x16x32_bf16 v[128:131], v[44:47], a[4:7], v[128:131]
    s_mul_i32 s77, s2, 9216
    buffer_load_dwordx4 v6, s[8:11], s62 offen lds
    v_mfma_f32_16x16x32_bf16 v[132:135], v[40:43], a[8:11], 0
    s_mul_i32 s76, s4, 1152
    s_waitcnt lgkmcnt(14)
    ds_read_b128 a[64:67], v22 offset:49152
    s_waitcnt lgkmcnt(14)
    ds_read_b64_tr_b16 v[52:53], v15 offset:40960
    v_mfma_f32_16x16x32_bf16 v[132:135], v[44:47], a[12:15], v[132:135]
    s_add_u32 s77, s77, s76
    s_waitcnt lgkmcnt(14)
    ds_read_b64_tr_b16 v[54:55], v15 offset:41984
    s_waitcnt lgkmcnt(14)
    ds_read_b64_tr_b16 v[56:57], v16 offset:32768
    v_mfma_f32_16x16x32_bf16 v[136:139], v[40:43], a[16:19], 0
    s_mul_i32 s76, s4, 1152
    buffer_load_dwordx4 v7, s[8:11], s62 offen offset:1024 lds
    v_mfma_f32_16x16x32_bf16 v[136:139], v[44:47], a[20:23], v[136:139]
    s_mul_i32 s72, s2, 3
    s_waitcnt lgkmcnt(4)
    ds_read_b64_tr_b16 v[58:59], v16 offset:33792
    ds_read_b64_tr_b16 v[60:61], v16 offset:40960
    v_mfma_f32_16x16x32_bf16 v[140:143], v[40:43], a[24:27], 0
    s_add_u32 s72, s72, 0
    ds_read_b64_tr_b16 v[62:63], v16 offset:41984
    v_add_u32 v14, 0x10000, v14
    v_mfma_f32_16x16x32_bf16 v[140:143], v[44:47], a[28:31], v[140:143]
    s_mul_i32 s7, s5, 73728
    ds_read_b128 a[68:71], v23 offset:49152
    v_add_u32 v15, 0x10000, v15
    v_mfma_f32_16x16x32_bf16 v[144:147], v[40:43], a[32:35], 0
    s_and_b32 s100, s6, 1
    buffer_load_dwordx4 v8, s[8:11], s62 offen offset:2048 lds
    v_mfma_f32_16x16x32_bf16 v[144:147], v[44:47], a[36:39], v[144:147]
    v_add_u32 v16, 0x10000, v16
    v_mov_b32 v31, 1
    v_mfma_f32_16x16x32_bf16 v[148:151], v[40:43], a[40:43], 0
    v_add_u32 v18, 0x10000, v18
    v_add_u32 v19, 0x10000, v19
    v_mfma_f32_16x16x32_bf16 v[148:151], v[44:47], a[44:47], v[148:151]
    v_add_u32 v20, 0x10000, v20
    v_add_u32 v21, 0x10000, v21
    v_mfma_f32_16x16x32_bf16 v[152:155], v[40:43], a[48:51], 0
    buffer_load_dwordx4 v9, s[8:11], s62 offen offset:3072 lds
    v_mfma_f32_16x16x32_bf16 v[152:155], v[44:47], a[52:55], v[152:155]
    ds_read_b128 a[72:75], v22 offset:51200
    v_add_u32 v26, 0x10000, v26
    v_mfma_f32_16x16x32_bf16 v[156:159], v[40:43], a[56:59], 0
    s_add_u32 m0, s69, 98304
    ds_read_b64_tr_b16 v[40:41], v17 offset:32768
    ds_read_b64_tr_b16 v[42:43], v17 offset:33792
    v_mfma_f32_16x16x32_bf16 v[156:159], v[44:47], a[60:63], v[156:159]
    s_xor_b32 s62, s62, 384
    ds_read_b64_tr_b16 v[44:45], v17 offset:40960
    ds_read_b64_tr_b16 v[46:47], v17 offset:41984
    v_mfma_f32_16x16x32_bf16 v[160:163], v[48:51], a[0:3], 0
    s_waitcnt lgkmcnt(5)
    buffer_load_dwordx4 v2, s[12:15], s60 offen nt lds
    v_mfma_f32_16x16x32_bf16 v[160:163], v[52:55], a[4:7], v[160:163]
    v_add_u32 v17, 0x10000, v17
    v_add_u32 v27, 0x10000, v27
    v_mfma_f32_16x16x32_bf16 v[164:167], v[48:51], a[8:11], 0
    ds_read_b128 a[76:79], v23 offset:51200
    v_add_u32 v28, 0x10000, v28
    v_mfma_f32_16x16x32_bf16 v[164:167], v[52:55], a[12:15], v[164:167]
    v_add_u32 v29, 0x10000, v29
    v_lshrrev_b32 v36, 7, v1
    v_mfma_f32_16x16x32_bf16 v[168:171], v[48:51], a[16:19], 0
    buffer_load_dwordx4 v3, s[12:15], s60 offen offset:1024 nt lds
    v_mfma_f32_16x16x32_bf16 v[168:171], v[52:55], a[20:23], v[168:171]
    v_mul_u32_u24 v36, 1152, v36
    v_and_b32 v37, 0x70, v1
    v_mfma_f32_16x16x32_bf16 v[172:175], v[48:51], a[24:27], 0
    v_mfma_f32_16x16x32_bf16 v[172:175], v[52:55], a[28:31], v[172:175]
    v_mfma_f32_16x16x32_bf16 v[176:179], v[48:51], a[32:35], 0
    buffer_load_dwordx4 v4, s[12:15], s60 offen offset:2048 nt lds
    v_mfma_f32_16x16x32_bf16 v[176:179], v[52:55], a[36:39], v[176:179]
    ds_read_b128 a[80:83], v22 offset:53248
    v_mfma_f32_16x16x32_bf16 v[180:183], v[48:51], a[40:43], 0
    v_mfma_f32_16x16x32_bf16 v[180:183], v[52:55], a[44:47], v[180:183]
    v_mfma_f32_16x16x32_bf16 v[184:187], v[48:51], a[48:51], 0
    buffer_load_dwordx4 v5, s[12:15], s60 offen offset:3072 nt lds
    v_mfma_f32_16x16x32_bf16 v[184:187], v[52:55], a[52:55], v[184:187]
    ds_read_b128 a[84:87], v23 offset:53248
    v_mfma_f32_16x16x32_bf16 v[188:191], v[48:51], a[56:59], 0
    s_add_u32 m0, s69, 114688
    v_mfma_f32_16x16x32_bf16 v[188:191], v[52:55], a[60:63], v[188:191]
    v_mfma_f32_16x16x32_bf16 v[192:195], v[56:59], a[0:3], 0
    buffer_load_dwordx4 v6, s[8:11], s61 offen lds
    v_mfma_f32_16x16x32_bf16 v[192:195], v[60:63], a[4:7], v[192:195]
    v_mfma_f32_16x16x32_bf16 v[196:199], v[56:59], a[8:11], 0
    v_mfma_f32_16x16x32_bf16 v[196:199], v[60:63], a[12:15], v[196:199]
    ds_read_b128 a[88:91], v22 offset:55296
    v_mfma_f32_16x16x32_bf16 v[200:203], v[56:59], a[16:19], 0
    buffer_load_dwordx4 v7, s[8:11], s61 offen offset:1024 lds
    v_mfma_f32_16x16x32_bf16 v[200:203], v[60:63], a[20:23], v[200:203]
    v_mfma_f32_16x16x32_bf16 v[204:207], v[56:59], a[24:27], 0
    v_mfma_f32_16x16x32_bf16 v[204:207], v[60:63], a[28:31], v[204:207]
    v_mfma_f32_16x16x32_bf16 v[208:211], v[56:59], a[32:35], 0
    buffer_load_dwordx4 v8, s[8:11], s61 offen offset:2048 lds
    v_mfma_f32_16x16x32_bf16 v[208:211], v[60:63], a[36:39], v[208:211]
    ds_read_b128 a[92:95], v23 offset:55296
    v_mfma_f32_16x16x32_bf16 v[212:215], v[56:59], a[40:43], 0
    v_mfma_f32_16x16x32_bf16 v[212:215], v[60:63], a[44:47], v[212:215]
    v_mfma_f32_16x16x32_bf16 v[216:219], v[56:59], a[48:51], 0
    buffer_load_dwordx4 v9, s[8:11], s61 offen offset:3072 lds
    v_mfma_f32_16x16x32_bf16 v[216:219], v[60:63], a[52:55], v[216:219]
    v_mfma_f32_16x16x32_bf16 v[220:223], v[56:59], a[56:59], 0
    s_xor_b32 s61, s61, 128
    v_mfma_f32_16x16x32_bf16 v[220:223], v[60:63], a[60:63], v[220:223]
    s_add_u32 m0, s69, 131072
    s_waitcnt lgkmcnt(0)
    v_mfma_f32_16x16x32_bf16 v[224:227], v[40:43], a[0:3], 0
    s_mov_b32 s82, 1572864
    buffer_load_dwordx4 v2, s[16:19], s60 offen nt lds
    v_mfma_f32_16x16x32_bf16 v[224:227], v[44:47], a[4:7], v[224:227]
    v_mfma_f32_16x16x32_bf16 v[228:231], v[40:43], a[8:11], 0
    buffer_load_dword v123, v120, s[40:43], s82 offen nt
    v_mfma_f32_16x16x32_bf16 v[228:231], v[44:47], a[12:15], v[228:231]
    v_mfma_f32_16x16x32_bf16 v[232:235], v[40:43], a[16:19], 0
    v_mfma_f32_16x16x32_bf16 v[232:235], v[44:47], a[20:23], v[232:235]
    s_waitcnt vmcnt(10)
    s_barrier
    ds_read_b64_tr_b16 v[48:49], v14 offset:0
    v_mfma_f32_16x16x32_bf16 v[236:239], v[40:43], a[24:27], 0
    buffer_load_dword v104, v103, s[20:23], s77 offen
    v_mfma_f32_16x16x32_bf16 v[236:239], v[44:47], a[28:31], v[236:239]
    s_add_u32 s77, s77, 4608
    ds_read_b64_tr_b16 v[50:51], v14 offset:1024
    ds_read_b64_tr_b16 v[52:53], v14 offset:8192
    v_mfma_f32_16x16x32_bf16 v[240:243], v[40:43], a[32:35], 0
    ds_read_b64_tr_b16 v[54:55], v14 offset:9216
    ds_read_b64_tr_b16 v[56:57], v15 offset:0
    v_mfma_f32_16x16x32_bf16 v[240:243], v[44:47], a[36:39], v[240:243]
    buffer_load_dwordx4 v3, s[16:19], s60 offen offset:1024 nt lds
    v_mfma_f32_16x16x32_bf16 v[244:247], v[40:43], a[40:43], 0
    ds_read_b64_tr_b16 v[58:59], v15 offset:1024
    ds_read_b64_tr_b16 v[60:61], v15 offset:8192
    v_mfma_f32_16x16x32_bf16 v[244:247], v[44:47], a[44:47], v[244:247]
    ds_read_b64_tr_b16 v[62:63], v15 offset:9216
    v_mfma_f32_16x16x32_bf16 v[248:251], v[40:43], a[48:51], 0
    v_mfma_f32_16x16x32_bf16 v[248:251], v[44:47], a[52:55], v[248:251]
    buffer_load_dwordx4 v4, s[16:19], s60 offen offset:2048 nt lds
    v_mfma_f32_16x16x32_bf16 v[252:255], v[40:43], a[56:59], 0
    ds_read_b64_tr_b16 v[40:41], v16 offset:0
    ds_read_b64_tr_b16 v[42:43], v16 offset:1024
    v_mfma_f32_16x16x32_bf16 v[252:255], v[44:47], a[60:63], v[252:255]
    s_waitcnt lgkmcnt(3)
    ds_read_b64_tr_b16 v[44:45], v16 offset:8192
    ds_read_b64_tr_b16 v[46:47], v16 offset:9216
    v_mfma_f32_16x16x32_bf16 a[128:131], a[0:3], v[48:51], 0
    v_mfma_f32_16x16x32_bf16 a[128:131], a[4:7], v[52:55], a[128:131]
    buffer_load_dwordx4 v5, s[16:19], s60 offen offset:3072 nt lds
    v_mfma_f32_16x16x32_bf16 a[132:135], a[8:11], v[48:51], 0
    s_add_u32 m0, s69, 147456
    v_add_u32 v22, 0x10000, v22
    ds_read_b128 a[96:99], v22 offset:16384
    v_mfma_f32_16x16x32_bf16 a[132:135], a[12:15], v[52:55], a[132:135]
    s_xor_b32 s60, s60, 1572864
    v_mfma_f32_16x16x32_bf16 a[136:139], a[16:19], v[48:51], 0
    v_mfma_f32_16x16x32_bf16 a[136:139], a[20:23], v[52:55], a[136:139]
    buffer_load_dwordx4 v6, s[8:11], s62 offen lds
    v_mfma_f32_16x16x32_bf16 a[140:143], a[24:27], v[48:51], 0
    v_add_u32 v23, 0x10000, v23
    v_mfma_f32_16x16x32_bf16 a[140:143], a[28:31], v[52:55], a[140:143]
    ds_read_b128 a[100:103], v23 offset:16384
    v_mfma_f32_16x16x32_bf16 a[144:147], a[32:35], v[48:51], 0
    v_mfma_f32_16x16x32_bf16 a[144:147], a[36:39], v[52:55], a[144:147]
    buffer_load_dwordx4 v7, s[8:11], s62 offen offset:1024 lds
    v_mfma_f32_16x16x32_bf16 a[148:151], a[40:43], v[48:51], 0
    v_mfma_f32_16x16x32_bf16 a[148:151], a[44:47], v[52:55], a[148:151]
    v_mfma_f32_16x16x32_bf16 a[152:155], a[48:51], v[48:51], 0
    v_mfma_f32_16x16x32_bf16 a[152:155], a[52:55], v[52:55], a[152:155]
    buffer_load_dwordx4 v8, s[8:11], s62 offen offset:2048 lds
    v_mfma_f32_16x16x32_bf16 a[156:159], a[56:59], v[48:51], 0
    ds_read_b128 a[104:107], v22 offset:18432
    ds_read_b64_tr_b16 v[48:49], v17 offset:0
    v_mfma_f32_16x16x32_bf16 a[156:159], a[60:63], v[52:55], a[156:159]
    ds_read_b64_tr_b16 v[50:51], v17 offset:1024
    ds_read_b64_tr_b16 v[52:53], v17 offset:8192
    v_mfma_f32_16x16x32_bf16 a[160:163], a[0:3], v[56:59], 0
    s_waitcnt lgkmcnt(4)
    ds_read_b64_tr_b16 v[54:55], v17 offset:9216
    v_mfma_f32_16x16x32_bf16 a[160:163], a[4:7], v[60:63], a[160:163]
    buffer_load_dwordx4 v9, s[8:11], s62 offen offset:3072 lds
    v_mfma_f32_16x16x32_bf16 a[164:167], a[8:11], v[56:59], 0
    ds_read_b128 a[108:111], v23 offset:18432
    v_mfma_f32_16x16x32_bf16 a[164:167], a[12:15], v[60:63], a[164:167]
    s_add_u32 m0, s69, 0
    v_mfma_f32_16x16x32_bf16 a[168:171], a[16:19], v[56:59], 0
    s_xor_b32 s62, s62, 128
    v_mfma_f32_16x16x32_bf16 a[168:171], a[20:23], v[60:63], a[168:171]
    buffer_load_dwordx4 v2, s[12:15], s60 offen nt lds
    v_mfma_f32_16x16x32_bf16 a[172:175], a[24:27], v[56:59], 0
    v_mfma_f32_16x16x32_bf16 a[172:175], a[28:31], v[60:63], a[172:175]
    v_mfma_f32_16x16x32_bf16 a[176:179], a[32:35], v[56:59], 0
    ds_read_b128 a[112:115], v22 offset:20480
    v_mfma_f32_16x16x32_bf16 a[176:179], a[36:39], v[60:63], a[176:179]
    buffer_load_dwordx4 v3, s[12:15], s60 offen offset:1024 nt lds
    v_mfma_f32_16x16x32_bf16 a[180:183], a[40:43], v[56:59], 0
    v_mfma_f32_16x16x32_bf16 a[180:183], a[44:47], v[60:63], a[180:183]
    v_mfma_f32_16x16x32_bf16 a[184:187], a[48:51], v[56:59], 0
    v_mfma_f32_16x16x32_bf16 a[184:187], a[52:55], v[60:63], a[184:187]
    buffer_load_dwordx4 v4, s[12:15], s60 offen offset:2048 nt lds
    v_mfma_f32_16x16x32_bf16 a[188:191], a[56:59], v[56:59], 0
    ds_read_b128 a[116:119], v23 offset:20480
    v_mfma_f32_16x16x32_bf16 a[188:191], a[60:63], v[60:63], a[188:191]
    v_mfma_f32_16x16x32_bf16 a[192:195], a[0:3], v[40:43], 0
    v_mfma_f32_16x16x32_bf16 a[192:195], a[4:7], v[44:47], a[192:195]
    buffer_load_dwordx4 v5, s[12:15], s60 offen offset:3072 nt lds
    v_mfma_f32_16x16x32_bf16 a[196:199], a[8:11], v[40:43], 0
    v_mfma_f32_16x16x32_bf16 a[196:199], a[12:15], v[44:47], a[196:199]
    ds_read_b128 a[120:123], v22 offset:22528
    v_mfma_f32_16x16x32_bf16 a[200:203], a[16:19], v[40:43], 0
    v_mfma_f32_16x16x32_bf16 a[200:203], a[20:23], v[44:47], a[200:203]
    s_add_u32 m0, s69, 16384
    v_mfma_f32_16x16x32_bf16 a[204:207], a[24:27], v[40:43], 0
    buffer_load_dwordx4 v6, s[8:11], s61 offen lds
    v_mfma_f32_16x16x32_bf16 a[204:207], a[28:31], v[44:47], a[204:207]
    v_mfma_f32_16x16x32_bf16 a[208:211], a[32:35], v[40:43], 0
    ds_read_b128 a[124:127], v23 offset:22528
    v_mfma_f32_16x16x32_bf16 a[208:211], a[36:39], v[44:47], a[208:211]
    v_mfma_f32_16x16x32_bf16 a[212:215], a[40:43], v[40:43], 0
    buffer_load_dwordx4 v7, s[8:11], s61 offen offset:1024 lds
    v_mfma_f32_16x16x32_bf16 a[212:215], a[44:47], v[44:47], a[212:215]
    v_mfma_f32_16x16x32_bf16 a[216:219], a[48:51], v[40:43], 0
    v_mfma_f32_16x16x32_bf16 a[216:219], a[52:55], v[44:47], a[216:219]
    v_mfma_f32_16x16x32_bf16 a[220:223], a[56:59], v[40:43], 0
    v_mfma_f32_16x16x32_bf16 a[220:223], a[60:63], v[44:47], a[220:223]
    s_waitcnt lgkmcnt(0)
    buffer_load_dwordx4 v8, s[8:11], s61 offen offset:2048 lds
    v_mfma_f32_16x16x32_bf16 a[224:227], a[0:3], v[48:51], 0
    v_mfma_f32_16x16x32_bf16 a[224:227], a[4:7], v[52:55], a[224:227]
    v_mfma_f32_16x16x32_bf16 a[228:231], a[8:11], v[48:51], 0
    v_mfma_f32_16x16x32_bf16 a[228:231], a[12:15], v[52:55], a[228:231]
    buffer_load_dwordx4 v9, s[8:11], s61 offen offset:3072 lds
    v_mfma_f32_16x16x32_bf16 a[232:235], a[16:19], v[48:51], 0
    v_mfma_f32_16x16x32_bf16 a[232:235], a[20:23], v[52:55], a[232:235]
    s_waitcnt vmcnt(8) lgkmcnt(0)
    s_barrier
    ds_read_b64_tr_b16 v[56:57], v14 offset:32768
    v_mfma_f32_16x16x32_bf16 a[236:239], a[24:27], v[48:51], 0
    s_add_u32 m0, s69, 32768
    ds_read_b64_tr_b16 v[58:59], v14 offset:33792
    ds_read_b64_tr_b16 v[60:61], v14 offset:40960
    v_mfma_f32_16x16x32_bf16 a[236:239], a[28:31], v[52:55], a[236:239]
    s_xor_b32 s61, s61, 896
    buffer_load_dwordx4 v2, s[16:19], s60 offen nt lds
    v_mfma_f32_16x16x32_bf16 a[240:243], a[32:35], v[48:51], 0
    ds_read_b64_tr_b16 v[62:63], v14 offset:41984
    ds_read_b64_tr_b16 v[40:41], v15 offset:32768
    v_mfma_f32_16x16x32_bf16 a[240:243], a[36:39], v[52:55], a[240:243]
    ds_read_b64_tr_b16 v[42:43], v15 offset:33792
    ds_read_b64_tr_b16 v[44:45], v15 offset:40960
    v_mfma_f32_16x16x32_bf16 a[244:247], a[40:43], v[48:51], 0
    ds_read_b64_tr_b16 v[46:47], v15 offset:41984
    v_add_u32 v14, 0x10000, v14
    v_mfma_f32_16x16x32_bf16 a[244:247], a[44:47], v[52:55], a[244:247]
    v_add_u32 v15, 0x10000, v15
    v_mfma_f32_16x16x32_bf16 a[248:251], a[48:51], v[48:51], 0
    v_mfma_f32_16x16x32_bf16 a[248:251], a[52:55], v[52:55], a[248:251]
    buffer_load_dwordx4 v3, s[16:19], s60 offen offset:1024 nt lds
    v_mfma_f32_16x16x32_bf16 a[252:255], a[56:59], v[48:51], 0
    ds_read_b64_tr_b16 v[48:49], v16 offset:32768
    ds_read_b64_tr_b16 v[50:51], v16 offset:33792
    v_mfma_f32_16x16x32_bf16 a[252:255], a[60:63], v[52:55], a[252:255]
    s_waitcnt lgkmcnt(2)
    ds_read_b64_tr_b16 v[52:53], v16 offset:40960
    ds_read_b64_tr_b16 v[54:55], v16 offset:41984
    v_mfma_f32_16x16x32_bf16 v[128:131], v[56:59], a[64:67], v[128:131]
    v_add_u32 v16, 0x10000, v16
    v_mfma_f32_16x16x32_bf16 v[128:131], v[60:63], a[68:71], v[128:131]
    v_mfma_f32_16x16x32_bf16 v[132:135], v[56:59], a[72:75], v[132:135]
    ds_read_b128 a[0:3], v22 offset:49152
    v_mfma_f32_16x16x32_bf16 v[132:135], v[60:63], a[76:79], v[132:135]
    v_mfma_f32_16x16x32_bf16 v[136:139], v[56:59], a[80:83], v[136:139]
    v_mfma_f32_16x16x32_bf16 v[136:139], v[60:63], a[84:87], v[136:139]
    buffer_load_dwordx4 v4, s[16:19], s60 offen offset:2048 nt lds
    v_mfma_f32_16x16x32_bf16 v[140:143], v[56:59], a[88:91], v[140:143]
    v_mfma_f32_16x16x32_bf16 v[140:143], v[60:63], a[92:95], v[140:143]
    ds_read_b128 a[4:7], v23 offset:49152
    v_mfma_f32_16x16x32_bf16 v[144:147], v[56:59], a[96:99], v[144:147]
    v_mfma_f32_16x16x32_bf16 v[144:147], v[60:63], a[100:103], v[144:147]
    v_mfma_f32_16x16x32_bf16 v[148:151], v[56:59], a[104:107], v[148:151]
    v_mfma_f32_16x16x32_bf16 v[148:151], v[60:63], a[108:111], v[148:151]
    v_mfma_f32_16x16x32_bf16 v[152:155], v[56:59], a[112:115], v[152:155]
    buffer_load_dwordx4 v5, s[16:19], s60 offen offset:3072 nt lds
    v_mfma_f32_16x16x32_bf16 v[152:155], v[60:63], a[116:119], v[152:155]
    ds_read_b128 a[8:11], v22 offset:51200
    v_mfma_f32_16x16x32_bf16 v[156:159], v[56:59], a[120:123], v[156:159]
    ds_read_b64_tr_b16 v[56:57], v17 offset:32768
    ds_read_b64_tr_b16 v[58:59], v17 offset:33792
    v_mfma_f32_16x16x32_bf16 v[156:159], v[60:63], a[124:127], v[156:159]
    ds_read_b64_tr_b16 v[60:61], v17 offset:40960
    ds_read_b64_tr_b16 v[62:63], v17 offset:41984
    v_mfma_f32_16x16x32_bf16 v[160:163], v[40:43], a[64:67], v[160:163]
    v_add_u32 v17, 0x10000, v17
    v_mfma_f32_16x16x32_bf16 v[160:163], v[44:47], a[68:71], v[160:163]
    v_mfma_f32_16x16x32_bf16 v[164:167], v[40:43], a[72:75], v[164:167]
    ds_read_b128 a[12:15], v23 offset:51200
    v_mfma_f32_16x16x32_bf16 v[164:167], v[44:47], a[76:79], v[164:167]
    s_add_u32 m0, s69, 49152
    v_mfma_f32_16x16x32_bf16 v[168:171], v[40:43], a[80:83], v[168:171]
    s_xor_b32 s60, s60, 524288
    buffer_load_dwordx4 v6, s[8:11], s62 offen lds
    v_mfma_f32_16x16x32_bf16 v[168:171], v[44:47], a[84:87], v[168:171]
    v_mfma_f32_16x16x32_bf16 v[172:175], v[40:43], a[88:91], v[172:175]
    buffer_load_dwordx2 v[80:81], v75, s[28:31], s98 offen nt
    v_mfma_f32_16x16x32_bf16 v[172:175], v[44:47], a[92:95], v[172:175]
    v_mfma_f32_16x16x32_bf16 v[176:179], v[40:43], a[96:99], v[176:179]
    ds_read_b128 a[16:19], v22 offset:53248
    v_mfma_f32_16x16x32_bf16 v[176:179], v[44:47], a[100:103], v[176:179]
    v_mfma_f32_16x16x32_bf16 v[180:183], v[40:43], a[104:107], v[180:183]
    v_mfma_f32_16x16x32_bf16 v[180:183], v[44:47], a[108:111], v[180:183]
    buffer_load_dwordx4 v7, s[8:11], s62 offen offset:1024 lds
    v_mfma_f32_16x16x32_bf16 v[184:187], v[40:43], a[112:115], v[184:187]
    buffer_load_dwordx2 v[82:83], v77, s[28:31], s98 offen nt
    v_mfma_f32_16x16x32_bf16 v[184:187], v[44:47], a[116:119], v[184:187]
    ds_read_b128 a[20:23], v23 offset:53248
    v_mfma_f32_16x16x32_bf16 v[188:191], v[40:43], a[120:123], v[188:191]
    s_waitcnt lgkmcnt(1)
    ds_read_b64_tr_b16 v[40:41], v14 offset:0
    ds_read_b64_tr_b16 v[42:43], v14 offset:1024
    v_mfma_f32_16x16x32_bf16 v[188:191], v[44:47], a[124:127], v[188:191]
    ds_read_b64_tr_b16 v[44:45], v14 offset:8192
    ds_read_b64_tr_b16 v[46:47], v14 offset:9216
    v_mfma_f32_16x16x32_bf16 v[192:195], v[48:51], a[64:67], v[192:195]
    v_add_u32 v14, 0xfffe0000, v14
    v_mfma_f32_16x16x32_bf16 v[192:195], v[52:55], a[68:71], v[192:195]
    v_mfma_f32_16x16x32_bf16 v[196:199], v[48:51], a[72:75], v[196:199]
    buffer_load_ushort v92, v65, s[32:35], s99 offen offset:0
    v_mfma_f32_16x16x32_bf16 v[196:199], v[52:55], a[76:79], v[196:199]
    ds_read_b128 a[24:27], v22 offset:55296
    v_mfma_f32_16x16x32_bf16 v[200:203], v[48:51], a[80:83], v[200:203]
    buffer_load_dwordx4 v8, s[8:11], s62 offen offset:2048 lds
    v_mfma_f32_16x16x32_bf16 v[200:203], v[52:55], a[84:87], v[200:203]
    v_mfma_f32_16x16x32_bf16 v[204:207], v[48:51], a[88:91], v[204:207]
    s_add_u32 s98, s98, 3456
    v_mfma_f32_16x16x32_bf16 v[204:207], v[52:55], a[92:95], v[204:207]
    v_mfma_f32_16x16x32_bf16 v[208:211], v[48:51], a[96:99], v[208:211]
    buffer_load_dwordx2 v[84:85], v75, s[28:31], s98 offen nt
    v_mfma_f32_16x16x32_bf16 v[208:211], v[52:55], a[100:103], v[208:211]
    ds_read_b128 a[28:31], v23 offset:55296
    v_mfma_f32_16x16x32_bf16 v[212:215], v[48:51], a[104:107], v[212:215]
    v_mfma_f32_16x16x32_bf16 v[212:215], v[52:55], a[108:111], v[212:215]
    v_mfma_f32_16x16x32_bf16 v[216:219], v[48:51], a[112:115], v[216:219]
    buffer_load_dwordx4 v9, s[8:11], s62 offen offset:3072 lds
    v_mfma_f32_16x16x32_bf16 v[216:219], v[52:55], a[116:119], v[216:219]
    v_mfma_f32_16x16x32_bf16 v[220:223], v[48:51], a[120:123], v[220:223]
    ds_read_b64_tr_b16 v[48:49], v15 offset:0
    ds_read_b64_tr_b16 v[50:51], v15 offset:1024
    v_mfma_f32_16x16x32_bf16 v[220:223], v[52:55], a[124:127], v[220:223]
    ds_read_b64_tr_b16 v[52:53], v15 offset:8192
    ds_read_b64_tr_b16 v[54:55], v15 offset:9216
    v_mfma_f32_16x16x32_bf16 v[224:227], v[56:59], a[64:67], v[224:227]
    s_mov_b32 s82, 2097152
    buffer_load_dwordx2 v[86:87], v77, s[28:31], s98 offen nt
    v_mfma_f32_16x16x32_bf16 v[224:227], v[60:63], a[68:71], v[224:227]
    s_xor_b32 s62, s62, 896
    v_add_u32 v15, 0xfffe0000, v15
    v_mfma_f32_16x16x32_bf16 v[228:231], v[56:59], a[72:75], v[228:231]
    v_mfma_f32_16x16x32_bf16 v[228:231], v[60:63], a[76:79], v[228:231]
    v_mfma_f32_16x16x32_bf16 v[232:235], v[56:59], a[80:83], v[232:235]
    buffer_load_dword v124, v120, s[40:43], s82 offen nt
    v_mfma_f32_16x16x32_bf16 v[232:235], v[60:63], a[84:87], v[232:235]
    s_add_u32 m0, s69, 65536
    v_mfma_f32_16x16x32_bf16 v[236:239], v[56:59], a[88:91], v[236:239]
    v_mfma_f32_16x16x32_bf16 v[236:239], v[60:63], a[92:95], v[236:239]
    v_mfma_f32_16x16x32_bf16 v[240:243], v[56:59], a[96:99], v[240:243]
    s_add_u32 s98, s98, 3456
    buffer_load_dword v105, v103, s[20:23], s77 offen
    v_mfma_f32_16x16x32_bf16 v[240:243], v[60:63], a[100:103], v[240:243]
    s_mul_i32 s77, s2, 18432
    v_mfma_f32_16x16x32_bf16 v[244:247], v[56:59], a[104:107], v[244:247]
    s_add_u32 s77, s77, s76
    v_mfma_f32_16x16x32_bf16 v[244:247], v[60:63], a[108:111], v[244:247]
    s_mov_b32 s76, 0
    v_mfma_f32_16x16x32_bf16 v[248:251], v[56:59], a[112:115], v[248:251]
    buffer_load_ushort v93, v65, s[32:35], s99 offen offset:2
    v_mfma_f32_16x16x32_bf16 v[248:251], v[60:63], a[116:119], v[248:251]
    v_mfma_f32_16x16x32_bf16 v[252:255], v[56:59], a[120:123], v[252:255]
    ds_read_b64_tr_b16 v[56:57], v16 offset:0
    ds_read_b64_tr_b16 v[58:59], v16 offset:1024
    v_mfma_f32_16x16x32_bf16 v[252:255], v[60:63], a[124:127], v[252:255]
    s_waitcnt lgkmcnt(2)
    ds_read_b64_tr_b16 v[60:61], v16 offset:8192
    ds_read_b64_tr_b16 v[62:63], v16 offset:9216
    v_mfma_f32_16x16x32_bf16 a[128:131], a[64:67], v[40:43], a[128:131]
    buffer_load_dwordx4 v2, s[12:15], s60 offen nt lds
    v_mfma_f32_16x16x32_bf16 a[128:131], a[68:71], v[44:47], a[128:131]
    v_add_u32 v22, 0x10000, v22
    v_add_u32 v16, 0xfffe0000, v16
    v_mfma_f32_16x16x32_bf16 a[132:135], a[72:75], v[40:43], a[132:135]
    ds_read_b128 a[32:35], v22 offset:16384
    v_mfma_f32_16x16x32_bf16 a[132:135], a[76:79], v[44:47], a[132:135]
    v_mfma_f32_16x16x32_bf16 a[136:139], a[80:83], v[40:43], a[136:139]
    buffer_load_dwordx2 v[88:89], v75, s[28:31], s98 offen nt
    v_mfma_f32_16x16x32_bf16 a[136:139], a[84:87], v[44:47], a[136:139]
    v_mfma_f32_16x16x32_bf16 a[140:143], a[88:91], v[40:43], a[140:143]
    v_add_u32 v23, 0x10000, v23
    v_mfma_f32_16x16x32_bf16 a[140:143], a[92:95], v[44:47], a[140:143]
    ds_read_b128 a[36:39], v23 offset:16384
    v_mfma_f32_16x16x32_bf16 a[144:147], a[96:99], v[40:43], a[144:147]
    buffer_load_dwordx4 v3, s[12:15], s60 offen offset:1024 nt lds
    v_mfma_f32_16x16x32_bf16 a[144:147], a[100:103], v[44:47], a[144:147]
    v_mfma_f32_16x16x32_bf16 a[148:151], a[104:107], v[40:43], a[148:151]
    v_mfma_f32_16x16x32_bf16 a[148:151], a[108:111], v[44:47], a[148:151]
    v_mfma_f32_16x16x32_bf16 a[152:155], a[112:115], v[40:43], a[152:155]
    buffer_load_dwordx2 v[90:91], v77, s[28:31], s98 offen nt
    v_mfma_f32_16x16x32_bf16 a[152:155], a[116:119], v[44:47], a[152:155]
    s_add_u32 s98, s98, 3456
    ds_read_b128 a[40:43], v22 offset:18432
    v_mfma_f32_16x16x32_bf16 a[156:159], a[120:123], v[40:43], a[156:159]
    s_add_u32 s28, s56, 6291456
    s_addc_u32 s29, s57, 0
    s_mov_b32 s30, 2359296
    v_mfma_f32_16x16x32_bf16 a[156:159], a[124:127], v[44:47], a[156:159]
    s_bfe_u32 s98, s72, 0x10001
    ds_read_b64_tr_b16 v[40:41], v17 offset:0
    ds_read_b64_tr_b16 v[42:43], v17 offset:1024
    v_mfma_f32_16x16x32_bf16 a[160:163], a[64:67], v[48:51], a[160:163]
    buffer_load_dwordx4 v4, s[12:15], s60 offen offset:2048 nt lds
    v_mfma_f32_16x16x32_bf16 a[160:163], a[68:71], v[52:55], a[160:163]
    ds_read_b64_tr_b16 v[44:45], v17 offset:8192
    ds_read_b64_tr_b16 v[46:47], v17 offset:9216
    v_mfma_f32_16x16x32_bf16 a[164:167], a[72:75], v[48:51], a[164:167]
    ds_read_b128 a[44:47], v23 offset:18432
    v_add_u32 v17, 0xfffe0000, v17
    v_mfma_f32_16x16x32_bf16 a[164:167], a[76:79], v[52:55], a[164:167]
    v_mfma_f32_16x16x32_bf16 a[168:171], a[80:83], v[48:51], a[168:171]
    buffer_load_ushort v94, v65, s[32:35], s99 offen offset:4
    v_mfma_f32_16x16x32_bf16 a[168:171], a[84:87], v[52:55], a[168:171]
    s_add_u32 s32, s56, 9437184
    s_addc_u32 s33, s57, 0
    s_mov_b32 s34, 163840
    v_mfma_f32_16x16x32_bf16 a[172:175], a[88:91], v[48:51], a[172:175]
    s_bfe_u32 s99, s72, 0x10003
    v_mfma_f32_16x16x32_bf16 a[172:175], a[92:95], v[52:55], a[172:175]
    s_lshl1_add_u32 s98, s99, s98
    v_mfma_f32_16x16x32_bf16 a[176:179], a[96:99], v[48:51], a[176:179]
    s_lshl_b32 s98, s98, 5
    buffer_store_dword v65, v64, s[32:35], s101 offen sc1
    v_mfma_f32_16x16x32_bf16 a[176:179], a[100:103], v[52:55], a[176:179]
    s_lshl_b32 s72, s72, 7
    ds_read_b128 a[48:51], v22 offset:20480
    v_mfma_f32_16x16x32_bf16 a[180:183], a[104:107], v[48:51], a[180:183]
    v_mfma_f32_16x16x32_bf16 a[180:183], a[108:111], v[52:55], a[180:183]
    v_mfma_f32_16x16x32_bf16 a[184:187], a[112:115], v[48:51], a[184:187]
    buffer_load_dwordx4 v5, s[12:15], s60 offen offset:3072 nt lds
    v_mfma_f32_16x16x32_bf16 a[184:187], a[116:119], v[52:55], a[184:187]
    s_add_u32 m0, s69, 81920
    ds_read_b128 a[52:55], v23 offset:20480
    v_mfma_f32_16x16x32_bf16 a[188:191], a[120:123], v[48:51], a[188:191]
    v_mfma_f32_16x16x32_bf16 a[188:191], a[124:127], v[52:55], a[188:191]
    s_waitcnt lgkmcnt(1)
    v_mfma_f32_16x16x32_bf16 a[192:195], a[64:67], v[56:59], a[192:195]
    buffer_load_dwordx4 v6, s[8:11], s61 offen lds
    v_mfma_f32_16x16x32_bf16 a[192:195], a[68:71], v[60:63], a[192:195]
    v_mfma_f32_16x16x32_bf16 a[196:199], a[72:75], v[56:59], a[196:199]
    v_mfma_f32_16x16x32_bf16 a[196:199], a[76:79], v[60:63], a[196:199]
    ds_read_b128 a[56:59], v22 offset:22528
    v_mfma_f32_16x16x32_bf16 a[200:203], a[80:83], v[56:59], a[200:203]
    buffer_load_dwordx4 v7, s[8:11], s61 offen offset:1024 lds
    v_mfma_f32_16x16x32_bf16 a[200:203], a[84:87], v[60:63], a[200:203]
    v_mfma_f32_16x16x32_bf16 a[204:207], a[88:91], v[56:59], a[204:207]
    v_mfma_f32_16x16x32_bf16 a[204:207], a[92:95], v[60:63], a[204:207]
    v_mfma_f32_16x16x32_bf16 a[208:211], a[96:99], v[56:59], a[208:211]
    buffer_load_dwordx4 v8, s[8:11], s61 offen offset:2048 lds
    v_mfma_f32_16x16x32_bf16 a[208:211], a[100:103], v[60:63], a[208:211]
    ds_read_b128 a[60:63], v23 offset:22528
    v_mfma_f32_16x16x32_bf16 a[212:215], a[104:107], v[56:59], a[212:215]
    v_mfma_f32_16x16x32_bf16 a[212:215], a[108:111], v[60:63], a[212:215]
    v_mfma_f32_16x16x32_bf16 a[216:219], a[112:115], v[56:59], a[216:219]
    buffer_load_dwordx4 v9, s[8:11], s61 offen offset:3072 lds
    v_mfma_f32_16x16x32_bf16 a[216:219], a[116:119], v[60:63], a[216:219]
    s_cmp_lt_u32 s2, 192
    s_cselect_b32 s72, s72, 1073741824
    v_mfma_f32_16x16x32_bf16 a[220:223], a[120:123], v[56:59], a[220:223]
    v_mfma_f32_16x16x32_bf16 a[220:223], a[124:127], v[60:63], a[220:223]
    v_mfma_f32_16x16x32_bf16 a[224:227], a[64:67], v[40:43], a[224:227]
    v_mfma_f32_16x16x32_bf16 a[224:227], a[68:71], v[44:47], a[224:227]
    s_xor_b32 s61, s61, 128
    v_mfma_f32_16x16x32_bf16 a[228:231], a[72:75], v[40:43], a[228:231]
    v_mfma_f32_16x16x32_bf16 a[228:231], a[76:79], v[44:47], a[228:231]
    v_mfma_f32_16x16x32_bf16 a[232:235], a[80:83], v[40:43], a[232:235]
    v_mfma_f32_16x16x32_bf16 a[232:235], a[84:87], v[44:47], a[232:235]
    s_waitcnt vmcnt(16) lgkmcnt(0)
    s_barrier
    ds_read_b64_tr_b16 v[48:49], v14 offset:0
    v_mfma_f32_16x16x32_bf16 a[236:239], a[88:91], v[40:43], a[236:239]
    s_add_u32 m0, s69, 98304
    ds_read_b64_tr_b16 v[50:51], v14 offset:1024
    ds_read_b64_tr_b16 v[52:53], v14 offset:8192
    v_mfma_f32_16x16x32_bf16 a[236:239], a[92:95], v[44:47], a[236:239]
    buffer_load_dwordx4 v2, s[16:19], s60 offen nt lds
    v_mfma_f32_16x16x32_bf16 a[240:243], a[96:99], v[40:43], a[240:243]
    ds_read_b64_tr_b16 v[54:55], v14 offset:9216
    ds_read_b64_tr_b16 v[56:57], v15 offset:0
    v_mfma_f32_16x16x32_bf16 a[240:243], a[100:103], v[44:47], a[240:243]
    ds_read_b64_tr_b16 v[58:59], v15 offset:1024
    ds_read_b64_tr_b16 v[60:61], v15 offset:8192
    v_mfma_f32_16x16x32_bf16 a[244:247], a[104:107], v[40:43], a[244:247]
    ds_read_b64_tr_b16 v[62:63], v15 offset:9216
    v_mfma_f32_16x16x32_bf16 a[244:247], a[108:111], v[44:47], a[244:247]
    v_mfma_f32_16x16x32_bf16 a[248:251], a[112:115], v[40:43], a[248:251]
    v_mfma_f32_16x16x32_bf16 a[248:251], a[116:119], v[44:47], a[248:251]
    buffer_load_dwordx4 v3, s[16:19], s60 offen offset:1024 nt lds
    v_mfma_f32_16x16x32_bf16 a[252:255], a[120:123], v[40:43], a[252:255]
    ds_read_b64_tr_b16 v[40:41], v16 offset:0
    ds_read_b64_tr_b16 v[42:43], v16 offset:1024
    v_mfma_f32_16x16x32_bf16 a[252:255], a[124:127], v[44:47], a[252:255]
    s_waitcnt lgkmcnt(2)
    ds_read_b64_tr_b16 v[44:45], v16 offset:8192
    ds_read_b64_tr_b16 v[46:47], v16 offset:9216
    v_mfma_f32_16x16x32_bf16 v[128:131], v[48:51], a[0:3], v[128:131]
    v_mfma_f32_16x16x32_bf16 v[128:131], v[52:55], a[4:7], v[128:131]
    v_add_u32 v22, 0xfffe0000, v22
    v_mfma_f32_16x16x32_bf16 v[132:135], v[48:51], a[8:11], v[132:135]
    ds_read_b128 a[64:67], v22 offset:16384
    v_mfma_f32_16x16x32_bf16 v[132:135], v[52:55], a[12:15], v[132:135]
    v_mfma_f32_16x16x32_bf16 v[136:139], v[48:51], a[16:19], v[136:139]
    v_mfma_f32_16x16x32_bf16 v[136:139], v[52:55], a[20:23], v[136:139]
    buffer_load_dwordx4 v4, s[16:19], s60 offen offset:2048 nt lds
    v_mfma_f32_16x16x32_bf16 v[140:143], v[48:51], a[24:27], v[140:143]
    v_add_u32 v23, 0xfffe0000, v23
    v_mfma_f32_16x16x32_bf16 v[140:143], v[52:55], a[28:31], v[140:143]
    ds_read_b128 a[68:71], v23 offset:16384
    v_mfma_f32_16x16x32_bf16 v[144:147], v[48:51], a[32:35], v[144:147]
    v_mfma_f32_16x16x32_bf16 v[144:147], v[52:55], a[36:39], v[144:147]
    v_mfma_f32_16x16x32_bf16 v[148:151], v[48:51], a[40:43], v[148:151]
    v_mfma_f32_16x16x32_bf16 v[148:151], v[52:55], a[44:47], v[148:151]
    v_mfma_f32_16x16x32_bf16 v[152:155], v[48:51], a[48:51], v[152:155]
    buffer_load_dwordx4 v5, s[16:19], s60 offen offset:3072 nt lds
    v_mfma_f32_16x16x32_bf16 v[152:155], v[52:55], a[52:55], v[152:155]
    ds_read_b128 a[72:75], v22 offset:18432
    v_mfma_f32_16x16x32_bf16 v[156:159], v[48:51], a[56:59], v[156:159]
    ds_read_b64_tr_b16 v[48:49], v17 offset:0
    ds_read_b64_tr_b16 v[50:51], v17 offset:1024
    v_mfma_f32_16x16x32_bf16 v[156:159], v[52:55], a[60:63], v[156:159]
    ds_read_b64_tr_b16 v[52:53], v17 offset:8192
    ds_read_b64_tr_b16 v[54:55], v17 offset:9216
    v_mfma_f32_16x16x32_bf16 v[160:163], v[56:59], a[0:3], v[160:163]
    v_mfma_f32_16x16x32_bf16 v[160:163], v[60:63], a[4:7], v[160:163]
    v_mfma_f32_16x16x32_bf16 v[164:167], v[56:59], a[8:11], v[164:167]
    ds_read_b128 a[76:79], v23 offset:18432
    v_mfma_f32_16x16x32_bf16 v[164:167], v[60:63], a[12:15], v[164:167]
    s_add_u32 m0, s69, 114688
    v_mfma_f32_16x16x32_bf16 v[168:171], v[56:59], a[16:19], v[168:171]
    s_xor_b32 s60, s60, 3670016
    buffer_load_dwordx4 v6, s[8:11], s62 offen lds
    v_mfma_f32_16x16x32_bf16 v[168:171], v[60:63], a[20:23], v[168:171]
    v_mfma_f32_16x16x32_bf16 v[172:175], v[56:59], a[24:27], v[172:175]
    v_mfma_f32_16x16x32_bf16 v[172:175], v[60:63], a[28:31], v[172:175]
    v_mfma_f32_16x16x32_bf16 v[176:179], v[56:59], a[32:35], v[176:179]
    ds_read_b128 a[80:83], v22 offset:20480
    v_mfma_f32_16x16x32_bf16 v[176:179], v[60:63], a[36:39], v[176:179]
    v_mfma_f32_16x16x32_bf16 v[180:183], v[56:59], a[40:43], v[180:183]
    v_mfma_f32_16x16x32_bf16 v[180:183], v[60:63], a[44:47], v[180:183]
    buffer_load_dwordx4 v7, s[8:11], s62 offen offset:1024 lds
    v_mfma_f32_16x16x32_bf16 v[184:187], v[56:59], a[48:51], v[184:187]
    v_mfma_f32_16x16x32_bf16 v[184:187], v[60:63], a[52:55], v[184:187]
    ds_read_b128 a[84:87], v23 offset:20480
    v_mfma_f32_16x16x32_bf16 v[188:191], v[56:59], a[56:59], v[188:191]
    s_waitcnt lgkmcnt(1)
    ds_read_b64_tr_b16 v[56:57], v14 offset:32768
    ds_read_b64_tr_b16 v[58:59], v14 offset:33792
    v_mfma_f32_16x16x32_bf16 v[188:191], v[60:63], a[60:63], v[188:191]
    ds_read_b64_tr_b16 v[60:61], v14 offset:40960
    ds_read_b64_tr_b16 v[62:63], v14 offset:41984
    v_mfma_f32_16x16x32_bf16 v[192:195], v[40:43], a[0:3], v[192:195]
    v_add_u32 v14, 0x10000, v14
    v_mfma_f32_16x16x32_bf16 v[192:195], v[44:47], a[4:7], v[192:195]
    v_mfma_f32_16x16x32_bf16 v[196:199], v[40:43], a[8:11], v[196:199]
    v_mfma_f32_16x16x32_bf16 v[196:199], v[44:47], a[12:15], v[196:199]
    buffer_load_dwordx4 v8, s[8:11], s62 offen offset:2048 lds
    v_mfma_f32_16x16x32_bf16 v[200:203], v[40:43], a[16:19], v[200:203]
    ds_read_b128 a[88:91], v22 offset:22528
    v_mfma_f32_16x16x32_bf16 v[200:203], v[44:47], a[20:23], v[200:203]
    v_mfma_f32_16x16x32_bf16 v[204:207], v[40:43], a[24:27], v[204:207]
    v_mfma_f32_16x16x32_bf16 v[204:207], v[44:47], a[28:31], v[204:207]
    v_mfma_f32_16x16x32_bf16 v[208:211], v[40:43], a[32:35], v[208:211]
    ds_read_b128 a[92:95], v23 offset:22528
    v_mfma_f32_16x16x32_bf16 v[208:211], v[44:47], a[36:39], v[208:211]
    v_mfma_f32_16x16x32_bf16 v[212:215], v[40:43], a[40:43], v[212:215]
    buffer_load_dwordx4 v9, s[8:11], s62 offen offset:3072 lds
    v_mfma_f32_16x16x32_bf16 v[212:215], v[44:47], a[44:47], v[212:215]
    v_mfma_f32_16x16x32_bf16 v[216:219], v[40:43], a[48:51], v[216:219]
    v_mfma_f32_16x16x32_bf16 v[216:219], v[44:47], a[52:55], v[216:219]
    v_mfma_f32_16x16x32_bf16 v[220:223], v[40:43], a[56:59], v[220:223]
    ds_read_b64_tr_b16 v[40:41], v15 offset:32768
    ds_read_b64_tr_b16 v[42:43], v15 offset:33792
    v_mfma_f32_16x16x32_bf16 v[220:223], v[44:47], a[60:63], v[220:223]
    ds_read_b64_tr_b16 v[44:45], v15 offset:40960
    ds_read_b64_tr_b16 v[46:47], v15 offset:41984
    v_mfma_f32_16x16x32_bf16 v[224:227], v[48:51], a[0:3], v[224:227]
    s_mov_b32 s82, 2621440
    v_add_u32 v15, 0x10000, v15
    v_mfma_f32_16x16x32_bf16 v[224:227], v[52:55], a[4:7], v[224:227]
    s_xor_b32 s62, s62, 128
    v_mfma_f32_16x16x32_bf16 v[228:231], v[48:51], a[8:11], v[228:231]
    buffer_load_dword v125, v120, s[40:43], s82 offen nt
    v_mfma_f32_16x16x32_bf16 v[228:231], v[52:55], a[12:15], v[228:231]
    buffer_load_dword v106, v103, s[24:27], s77 offen
    v_mfma_f32_16x16x32_bf16 v[232:235], v[48:51], a[16:19], v[232:235]
    s_add_u32 s77, s77, 4608
    v_mfma_f32_16x16x32_bf16 v[232:235], v[52:55], a[20:23], v[232:235]
    s_add_u32 m0, s69, 131072
    v_mfma_f32_16x16x32_bf16 v[236:239], v[48:51], a[24:27], v[236:239]
    buffer_load_dwordx4 v2, s[12:15], s60 offen nt lds
    v_mfma_f32_16x16x32_bf16 v[236:239], v[52:55], a[28:31], v[236:239]
    v_mfma_f32_16x16x32_bf16 v[240:243], v[48:51], a[32:35], v[240:243]
    v_mfma_f32_16x16x32_bf16 v[240:243], v[52:55], a[36:39], v[240:243]
    v_mfma_f32_16x16x32_bf16 v[244:247], v[48:51], a[40:43], v[244:247]
    v_mfma_f32_16x16x32_bf16 v[244:247], v[52:55], a[44:47], v[244:247]
    v_mfma_f32_16x16x32_bf16 v[248:251], v[48:51], a[48:51], v[248:251]
    v_mfma_f32_16x16x32_bf16 v[248:251], v[52:55], a[52:55], v[248:251]
    buffer_load_dwordx4 v3, s[12:15], s60 offen offset:1024 nt lds
    v_mfma_f32_16x16x32_bf16 v[252:255], v[48:51], a[56:59], v[252:255]
    ds_read_b64_tr_b16 v[48:49], v16 offset:32768
    ds_read_b64_tr_b16 v[50:51], v16 offset:33792
    v_mfma_f32_16x16x32_bf16 v[252:255], v[52:55], a[60:63], v[252:255]
    s_waitcnt lgkmcnt(2)
    ds_read_b64_tr_b16 v[52:53], v16 offset:40960
    ds_read_b64_tr_b16 v[54:55], v16 offset:41984
    v_mfma_f32_16x16x32_bf16 a[128:131], a[0:3], v[56:59], a[128:131]
    v_add_u32 v16, 0x10000, v16
    v_mfma_f32_16x16x32_bf16 a[128:131], a[4:7], v[60:63], a[128:131]
    v_mfma_f32_16x16x32_bf16 a[132:135], a[8:11], v[56:59], a[132:135]
    ds_read_b128 a[96:99], v22 offset:49152
    v_mfma_f32_16x16x32_bf16 a[132:135], a[12:15], v[60:63], a[132:135]
    v_mfma_f32_16x16x32_bf16 a[136:139], a[16:19], v[56:59], a[136:139]
    v_mfma_f32_16x16x32_bf16 a[136:139], a[20:23], v[60:63], a[136:139]
    buffer_load_dwordx4 v4, s[12:15], s60 offen offset:2048 nt lds
    v_mfma_f32_16x16x32_bf16 a[140:143], a[24:27], v[56:59], a[140:143]
    v_mfma_f32_16x16x32_bf16 a[140:143], a[28:31], v[60:63], a[140:143]
    ds_read_b128 a[100:103], v23 offset:49152
    v_mfma_f32_16x16x32_bf16 a[144:147], a[32:35], v[56:59], a[144:147]
    v_mfma_f32_16x16x32_bf16 a[144:147], a[36:39], v[60:63], a[144:147]
    v_mfma_f32_16x16x32_bf16 a[148:151], a[40:43], v[56:59], a[148:151]
    v_mfma_f32_16x16x32_bf16 a[148:151], a[44:47], v[60:63], a[148:151]
    v_mfma_f32_16x16x32_bf16 a[152:155], a[48:51], v[56:59], a[152:155]
    buffer_load_dwordx4 v5, s[12:15], s60 offen offset:3072 nt lds
    v_mfma_f32_16x16x32_bf16 a[152:155], a[52:55], v[60:63], a[152:155]
    ds_read_b128 a[104:107], v22 offset:51200
    v_mfma_f32_16x16x32_bf16 a[156:159], a[56:59], v[56:59], a[156:159]
    ds_read_b64_tr_b16 v[56:57], v17 offset:32768
    ds_read_b64_tr_b16 v[58:59], v17 offset:33792
    v_mfma_f32_16x16x32_bf16 a[156:159], a[60:63], v[60:63], a[156:159]
    ds_read_b64_tr_b16 v[60:61], v17 offset:40960
    ds_read_b64_tr_b16 v[62:63], v17 offset:41984
    v_mfma_f32_16x16x32_bf16 a[160:163], a[0:3], v[40:43], a[160:163]
    v_add_u32 v17, 0x10000, v17
    v_mfma_f32_16x16x32_bf16 a[160:163], a[4:7], v[44:47], a[160:163]
    v_mfma_f32_16x16x32_bf16 a[164:167], a[8:11], v[40:43], a[164:167]
    ds_read_b128 a[108:111], v23 offset:51200
    v_mfma_f32_16x16x32_bf16 a[164:167], a[12:15], v[44:47], a[164:167]
    s_add_u32 m0, s69, 147456
    v_mfma_f32_16x16x32_bf16 a[168:171], a[16:19], v[40:43], a[168:171]
    buffer_load_dwordx4 v6, s[8:11], s61 offen lds
    v_mfma_f32_16x16x32_bf16 a[168:171], a[20:23], v[44:47], a[168:171]
    v_mfma_f32_16x16x32_bf16 a[172:175], a[24:27], v[40:43], a[172:175]
    v_mfma_f32_16x16x32_bf16 a[172:175], a[28:31], v[44:47], a[172:175]
    v_mfma_f32_16x16x32_bf16 a[176:179], a[32:35], v[40:43], a[176:179]
    ds_read_b128 a[112:115], v22 offset:53248
    v_mfma_f32_16x16x32_bf16 a[176:179], a[36:39], v[44:47], a[176:179]
    v_mfma_f32_16x16x32_bf16 a[180:183], a[40:43], v[40:43], a[180:183]
    v_mfma_f32_16x16x32_bf16 a[180:183], a[44:47], v[44:47], a[180:183]
    buffer_load_dwordx4 v7, s[8:11], s61 offen offset:1024 lds
    v_mfma_f32_16x16x32_bf16 a[184:187], a[48:51], v[40:43], a[184:187]
    v_mfma_f32_16x16x32_bf16 a[184:187], a[52:55], v[44:47], a[184:187]
    ds_read_b128 a[116:119], v23 offset:53248
    v_mfma_f32_16x16x32_bf16 a[188:191], a[56:59], v[40:43], a[188:191]
    v_mfma_f32_16x16x32_bf16 a[188:191], a[60:63], v[44:47], a[188:191]
    s_waitcnt lgkmcnt(1)
    v_mfma_f32_16x16x32_bf16 a[192:195], a[0:3], v[48:51], a[192:195]
    v_mfma_f32_16x16x32_bf16 a[192:195], a[4:7], v[52:55], a[192:195]
    v_mfma_f32_16x16x32_bf16 a[196:199], a[8:11], v[48:51], a[196:199]
    v_mfma_f32_16x16x32_bf16 a[196:199], a[12:15], v[52:55], a[196:199]
    buffer_load_dwordx4 v8, s[8:11], s61 offen offset:2048 lds
    v_mfma_f32_16x16x32_bf16 a[200:203], a[16:19], v[48:51], a[200:203]
    ds_read_b128 a[120:123], v22 offset:55296
    v_mfma_f32_16x16x32_bf16 a[200:203], a[20:23], v[52:55], a[200:203]
    v_mfma_f32_16x16x32_bf16 a[204:207], a[24:27], v[48:51], a[204:207]
    v_mfma_f32_16x16x32_bf16 a[204:207], a[28:31], v[52:55], a[204:207]
    v_mfma_f32_16x16x32_bf16 a[208:211], a[32:35], v[48:51], a[208:211]
    ds_read_b128 a[124:127], v23 offset:55296
    v_mfma_f32_16x16x32_bf16 a[208:211], a[36:39], v[52:55], a[208:211]
    v_mfma_f32_16x16x32_bf16 a[212:215], a[40:43], v[48:51], a[212:215]
    buffer_load_dwordx4 v9, s[8:11], s61 offen offset:3072 lds
    v_mfma_f32_16x16x32_bf16 a[212:215], a[44:47], v[52:55], a[212:215]
    v_mfma_f32_16x16x32_bf16 a[216:219], a[48:51], v[48:51], a[216:219]
    v_mfma_f32_16x16x32_bf16 a[216:219], a[52:55], v[52:55], a[216:219]
    v_mfma_f32_16x16x32_bf16 a[220:223], a[56:59], v[48:51], a[220:223]
    v_mfma_f32_16x16x32_bf16 a[220:223], a[60:63], v[52:55], a[220:223]
    v_mfma_f32_16x16x32_bf16 a[224:227], a[0:3], v[56:59], a[224:227]
    v_mfma_f32_16x16x32_bf16 a[224:227], a[4:7], v[60:63], a[224:227]
    s_xor_b32 s61, s61, 384
    v_mfma_f32_16x16x32_bf16 a[228:231], a[8:11], v[56:59], a[228:231]
    v_mfma_f32_16x16x32_bf16 a[228:231], a[12:15], v[60:63], a[228:231]
    v_mfma_f32_16x16x32_bf16 a[232:235], a[16:19], v[56:59], a[232:235]
    v_mfma_f32_16x16x32_bf16 a[232:235], a[20:23], v[60:63], a[232:235]
    s_waitcnt vmcnt(10) lgkmcnt(0)
    s_barrier
    ds_read_b64_tr_b16 v[40:41], v14 offset:0
    v_mfma_f32_16x16x32_bf16 a[236:239], a[24:27], v[56:59], a[236:239]
    s_add_u32 m0, s69, 0
    ds_read_b64_tr_b16 v[42:43], v14 offset:1024
    ds_read_b64_tr_b16 v[44:45], v14 offset:8192
    v_mfma_f32_16x16x32_bf16 a[236:239], a[28:31], v[60:63], a[236:239]
    buffer_load_dwordx4 v2, s[16:19], s60 offen nt lds
    v_mfma_f32_16x16x32_bf16 a[240:243], a[32:35], v[56:59], a[240:243]
    ds_read_b64_tr_b16 v[46:47], v14 offset:9216
    v_cndmask_b32 v82, v82, v92, s[92:93]
    v_mfma_f32_16x16x32_bf16 a[240:243], a[36:39], v[60:63], a[240:243]
    v_cndmask_b32_e64 v83, v83, 0, s[92:93]
    v_xor_b32 v92, s98, v95
    v_mfma_f32_16x16x32_bf16 a[244:247], a[40:43], v[56:59], a[244:247]
    buffer_store_dwordx4 v[80:83], v92, s[28:31], s72 offen sc1
    v_mfma_f32_16x16x32_bf16 a[244:247], a[44:47], v[60:63], a[244:247]
    s_mul_i32 s72, s2, 3
    ds_read_b64_tr_b16 v[48:49], v15 offset:0
    ds_read_b64_tr_b16 v[50:51], v15 offset:1024
    v_mfma_f32_16x16x32_bf16 a[248:251], a[48:51], v[56:59], a[248:251]
    s_add_u32 s72, s72, 1
    ds_read_b64_tr_b16 v[52:53], v15 offset:8192
    ds_read_b64_tr_b16 v[54:55], v15 offset:9216
    v_mfma_f32_16x16x32_bf16 a[248:251], a[52:55], v[60:63], a[248:251]
    s_bfe_u32 s98, s72, 0x10001
    buffer_load_dwordx4 v3, s[16:19], s60 offen offset:1024 nt lds
    v_mfma_f32_16x16x32_bf16 a[252:255], a[56:59], v[56:59], a[252:255]
    s_bfe_u32 s99, s72, 0x10003
    v_cndmask_b32 v86, v86, v93, s[92:93]
    v_cndmask_b32_e64 v87, v87, 0, s[92:93]
    v_mfma_f32_16x16x32_bf16 a[252:255], a[60:63], v[60:63], a[252:255]
    s_lshl1_add_u32 s98, s99, s98
    v_cndmask_b32 v90, v90, v94, s[92:93]
    v_cndmask_b32_e64 v91, v91, 0, s[92:93]
    s_waitcnt lgkmcnt(4)
    v_mfma_f32_16x16x32_bf16 v[128:131], v[40:43], a[64:67], v[128:131]
    s_lshl_b32 s98, s98, 5
    v_xor_b32 v93, s98, v95
    ds_read_b64_tr_b16 v[56:57], v16 offset:0
    v_mfma_f32_16x16x32_bf16 v[128:131], v[44:47], a[68:71], v[128:131]
    s_lshl_b32 s72, s72, 7
    v_add_u32 v22, 0x10000, v22
    ds_read_b64_tr_b16 v[58:59], v16 offset:1024
    v_mfma_f32_16x16x32_bf16 v[132:135], v[40:43], a[72:75], v[132:135]
    ds_read_b128 a[0:3], v22 offset:16384
    ds_read_b64_tr_b16 v[60:61], v16 offset:8192
    v_mfma_f32_16x16x32_bf16 v[132:135], v[44:47], a[76:79], v[132:135]
    s_cmp_lt_u32 s2, 192
    s_cselect_b32 s72, s72, 1073741824
    ds_read_b64_tr_b16 v[62:63], v16 offset:9216
    v_mfma_f32_16x16x32_bf16 v[136:139], v[40:43], a[80:83], v[136:139]
    buffer_store_dwordx4 v[84:87], v93, s[28:31], s72 offen sc1
    v_mfma_f32_16x16x32_bf16 v[136:139], v[44:47], a[84:87], v[136:139]
    s_mul_i32 s72, s2, 3
    buffer_load_dwordx4 v4, s[16:19], s60 offen offset:2048 nt lds
    v_mfma_f32_16x16x32_bf16 v[140:143], v[40:43], a[88:91], v[140:143]
    s_add_u32 s72, s72, 2
    v_add_u32 v23, 0x10000, v23
    v_mfma_f32_16x16x32_bf16 v[140:143], v[44:47], a[92:95], v[140:143]
    s_bfe_u32 s98, s72, 0x10001
    ds_read_b128 a[4:7], v23 offset:16384
    v_mfma_f32_16x16x32_bf16 v[144:147], v[40:43], a[96:99], v[144:147]
    s_bfe_u32 s99, s72, 0x10003
    v_mfma_f32_16x16x32_bf16 v[144:147], v[44:47], a[100:103], v[144:147]
    s_lshl1_add_u32 s98, s99, s98
    v_mfma_f32_16x16x32_bf16 v[148:151], v[40:43], a[104:107], v[148:151]
    s_lshl_b32 s98, s98, 5
    v_xor_b32 v94, s98, v95
    v_mfma_f32_16x16x32_bf16 v[148:151], v[44:47], a[108:111], v[148:151]
    s_lshl_b32 s72, s72, 7
    v_mfma_f32_16x16x32_bf16 v[152:155], v[40:43], a[112:115], v[152:155]
    s_mul_i32 s99, s100, 576
    buffer_load_dwordx4 v5, s[16:19], s60 offen offset:3072 nt lds
    v_mfma_f32_16x16x32_bf16 v[152:155], v[44:47], a[116:119], v[152:155]
    ds_read_b128 a[8:11], v22 offset:18432
    v_mfma_f32_16x16x32_bf16 v[156:159], v[40:43], a[120:123], v[156:159]
    s_cmp_lt_u32 s2, 192
    s_cselect_b32 s72, s72, 1073741824
    ds_read_b64_tr_b16 v[40:41], v17 offset:0
    v_mfma_f32_16x16x32_bf16 v[156:159], v[44:47], a[124:127], v[156:159]
    s_waitcnt lgkmcnt(2)
    buffer_store_dwordx4 v[88:91], v94, s[28:31], s72 offen sc1
    v_mfma_f32_16x16x32_bf16 v[160:163], v[48:51], a[64:67], v[160:163]
    s_mov_b32 s30, 73728
    ds_read_b64_tr_b16 v[42:43], v17 offset:1024
    ds_read_b64_tr_b16 v[44:45], v17 offset:8192
    v_mfma_f32_16x16x32_bf16 v[160:163], v[52:55], a[68:71], v[160:163]
    ds_read_b64_tr_b16 v[46:47], v17 offset:9216
    v_mfma_f32_16x16x32_bf16 v[164:167], v[48:51], a[72:75], v[164:167]
    ds_read_b128 a[12:15], v23 offset:18432
    v_mfma_f32_16x16x32_bf16 v[164:167], v[52:55], a[76:79], v[164:167]
    s_add_u32 m0, s69, 16384
    v_mfma_f32_16x16x32_bf16 v[168:171], v[48:51], a[80:83], v[168:171]
    s_xor_b32 s60, s60, 524288
    buffer_load_dwordx4 v6, s[8:11], s62 offen lds
    v_mfma_f32_16x16x32_bf16 v[168:171], v[52:55], a[84:87], v[168:171]
    s_add_u32 s28, s28, s7
    s_addc_u32 s29, s29, 0
    v_mfma_f32_16x16x32_bf16 v[172:175], v[48:51], a[88:91], v[172:175]
    s_lshr_b32 s7, s6, 1
    v_mfma_f32_16x16x32_bf16 v[172:175], v[52:55], a[92:95], v[172:175]
    s_lshl2_add_u32 s7, s5, s7
    v_mfma_f32_16x16x32_bf16 v[176:179], v[48:51], a[96:99], v[176:179]
    s_mul_i32 s98, s7, 36864
    ds_read_b128 a[16:19], v22 offset:20480
    v_mfma_f32_16x16x32_bf16 v[176:179], v[52:55], a[100:103], v[176:179]
    s_add_u32 s98, s98, s99
    v_mfma_f32_16x16x32_bf16 v[180:183], v[48:51], a[104:107], v[180:183]
    s_mul_i32 s99, s100, 18432
    v_mfma_f32_16x16x32_bf16 v[180:183], v[52:55], a[108:111], v[180:183]
    buffer_load_dwordx4 v7, s[8:11], s62 offen offset:1024 lds
    v_mfma_f32_16x16x32_bf16 v[184:187], v[48:51], a[112:115], v[184:187]
    v_mfma_f32_16x16x32_bf16 v[184:187], v[52:55], a[116:119], v[184:187]
    ds_read_b128 a[20:23], v23 offset:20480
    v_mfma_f32_16x16x32_bf16 v[188:191], v[48:51], a[120:123], v[188:191]
    ds_read_b64_tr_b16 v[48:49], v14 offset:32768
    ds_read_b64_tr_b16 v[50:51], v14 offset:33792
    v_mfma_f32_16x16x32_bf16 v[188:191], v[52:55], a[124:127], v[188:191]
    ds_read_b64_tr_b16 v[52:53], v14 offset:40960
    ds_read_b64_tr_b16 v[54:55], v14 offset:41984
    v_mfma_f32_16x16x32_bf16 v[192:195], v[56:59], a[64:67], v[192:195]
    v_add_u32 v14, 0x10000, v14
    v_mfma_f32_16x16x32_bf16 v[192:195], v[60:63], a[68:71], v[192:195]
    v_mfma_f32_16x16x32_bf16 v[196:199], v[56:59], a[72:75], v[196:199]
    v_mfma_f32_16x16x32_bf16 v[196:199], v[60:63], a[76:79], v[196:199]
    buffer_load_dwordx4 v8, s[8:11], s62 offen offset:2048 lds
    v_mfma_f32_16x16x32_bf16 v[200:203], v[56:59], a[80:83], v[200:203]
    ds_read_b128 a[24:27], v22 offset:22528
    v_mfma_f32_16x16x32_bf16 v[200:203], v[60:63], a[84:87], v[200:203]
    v_mfma_f32_16x16x32_bf16 v[204:207], v[56:59], a[88:91], v[204:207]
    v_mfma_f32_16x16x32_bf16 v[204:207], v[60:63], a[92:95], v[204:207]
    v_mfma_f32_16x16x32_bf16 v[208:211], v[56:59], a[96:99], v[208:211]
    ds_read_b128 a[28:31], v23 offset:22528
    v_mfma_f32_16x16x32_bf16 v[208:211], v[60:63], a[100:103], v[208:211]
    v_mfma_f32_16x16x32_bf16 v[212:215], v[56:59], a[104:107], v[212:215]
    buffer_load_dwordx4 v9, s[8:11], s62 offen offset:3072 lds
    v_mfma_f32_16x16x32_bf16 v[212:215], v[60:63], a[108:111], v[212:215]
    v_mfma_f32_16x16x32_bf16 v[216:219], v[56:59], a[112:115], v[216:219]
    v_mfma_f32_16x16x32_bf16 v[216:219], v[60:63], a[116:119], v[216:219]
    v_mfma_f32_16x16x32_bf16 v[220:223], v[56:59], a[120:123], v[220:223]
    s_waitcnt lgkmcnt(0)
    ds_read_b64_tr_b16 v[56:57], v15 offset:32768
    ds_read_b64_tr_b16 v[58:59], v15 offset:33792
    v_mfma_f32_16x16x32_bf16 v[220:223], v[60:63], a[124:127], v[220:223]
    ds_read_b64_tr_b16 v[60:61], v15 offset:40960
    ds_read_b64_tr_b16 v[62:63], v15 offset:41984
    v_mfma_f32_16x16x32_bf16 v[224:227], v[40:43], a[64:67], v[224:227]
    s_mov_b32 s82, 3145728
    v_add_u32 v15, 0x10000, v15
    v_mfma_f32_16x16x32_bf16 v[224:227], v[44:47], a[68:71], v[224:227]
    s_xor_b32 s62, s62, 384
    v_mfma_f32_16x16x32_bf16 v[228:231], v[40:43], a[72:75], v[228:231]
    buffer_load_dword v126, v120, s[40:43], s82 offen nt
    v_mfma_f32_16x16x32_bf16 v[228:231], v[44:47], a[76:79], v[228:231]
    buffer_load_dword v107, v103, s[24:27], s77 offen
    v_mfma_f32_16x16x32_bf16 v[232:235], v[40:43], a[80:83], v[232:235]
    s_add_u32 s77, s77, 4608
    v_mfma_f32_16x16x32_bf16 v[232:235], v[44:47], a[84:87], v[232:235]
    s_add_u32 m0, s69, 32768
    v_mfma_f32_16x16x32_bf16 v[236:239], v[40:43], a[88:91], v[236:239]
    buffer_load_dwordx4 v2, s[12:15], s60 offen nt lds
    v_mfma_f32_16x16x32_bf16 v[236:239], v[44:47], a[92:95], v[236:239]
    v_mfma_f32_16x16x32_bf16 v[240:243], v[40:43], a[96:99], v[240:243]
    v_mfma_f32_16x16x32_bf16 v[240:243], v[44:47], a[100:103], v[240:243]
    v_mfma_f32_16x16x32_bf16 v[244:247], v[40:43], a[104:107], v[244:247]
    v_mfma_f32_16x16x32_bf16 v[244:247], v[44:47], a[108:111], v[244:247]
    v_mfma_f32_16x16x32_bf16 v[248:251], v[40:43], a[112:115], v[248:251]
    v_mfma_f32_16x16x32_bf16 v[248:251], v[44:47], a[116:119], v[248:251]
    buffer_load_dwordx4 v3, s[12:15], s60 offen offset:1024 nt lds
    v_mfma_f32_16x16x32_bf16 v[252:255], v[40:43], a[120:123], v[252:255]
    ds_read_b64_tr_b16 v[40:41], v16 offset:32768
    ds_read_b64_tr_b16 v[42:43], v16 offset:33792
    v_mfma_f32_16x16x32_bf16 v[252:255], v[44:47], a[124:127], v[252:255]
    ds_read_b64_tr_b16 v[44:45], v16 offset:40960
    ds_read_b64_tr_b16 v[46:47], v16 offset:41984
    v_mfma_f32_16x16x32_bf16 a[128:131], a[64:67], v[48:51], a[128:131]
    v_add_u32 v16, 0x10000, v16
    v_mfma_f32_16x16x32_bf16 a[128:131], a[68:71], v[52:55], a[128:131]
    v_mfma_f32_16x16x32_bf16 a[132:135], a[72:75], v[48:51], a[132:135]
    ds_read_b128 a[32:35], v22 offset:49152
    v_mfma_f32_16x16x32_bf16 a[132:135], a[76:79], v[52:55], a[132:135]
    v_mfma_f32_16x16x32_bf16 a[136:139], a[80:83], v[48:51], a[136:139]
    v_mfma_f32_16x16x32_bf16 a[136:139], a[84:87], v[52:55], a[136:139]
    buffer_load_dwordx4 v4, s[12:15], s60 offen offset:2048 nt lds
    v_mfma_f32_16x16x32_bf16 a[140:143], a[88:91], v[48:51], a[140:143]
    v_mfma_f32_16x16x32_bf16 a[140:143], a[92:95], v[52:55], a[140:143]
    ds_read_b128 a[36:39], v23 offset:49152
    v_mfma_f32_16x16x32_bf16 a[144:147], a[96:99], v[48:51], a[144:147]
    v_mfma_f32_16x16x32_bf16 a[144:147], a[100:103], v[52:55], a[144:147]
    v_mfma_f32_16x16x32_bf16 a[148:151], a[104:107], v[48:51], a[148:151]
    v_mfma_f32_16x16x32_bf16 a[148:151], a[108:111], v[52:55], a[148:151]
    v_mfma_f32_16x16x32_bf16 a[152:155], a[112:115], v[48:51], a[152:155]
    buffer_load_dwordx4 v5, s[12:15], s60 offen offset:3072 nt lds
    v_mfma_f32_16x16x32_bf16 a[152:155], a[116:119], v[52:55], a[152:155]
    ds_read_b128 a[40:43], v22 offset:51200
    v_mfma_f32_16x16x32_bf16 a[156:159], a[120:123], v[48:51], a[156:159]
    ds_read_b64_tr_b16 v[48:49], v17 offset:32768
    ds_read_b64_tr_b16 v[50:51], v17 offset:33792
    v_mfma_f32_16x16x32_bf16 a[156:159], a[124:127], v[52:55], a[156:159]
    s_waitcnt lgkmcnt(3)
    ds_read_b64_tr_b16 v[52:53], v17 offset:40960
    ds_read_b64_tr_b16 v[54:55], v17 offset:41984
    v_mfma_f32_16x16x32_bf16 a[160:163], a[64:67], v[56:59], a[160:163]
    v_add_u32 v17, 0x10000, v17
    v_mfma_f32_16x16x32_bf16 a[160:163], a[68:71], v[60:63], a[160:163]
    v_mfma_f32_16x16x32_bf16 a[164:167], a[72:75], v[56:59], a[164:167]
    ds_read_b128 a[44:47], v23 offset:51200
    v_mfma_f32_16x16x32_bf16 a[164:167], a[76:79], v[60:63], a[164:167]
    s_add_u32 m0, s69, 49152
    v_mfma_f32_16x16x32_bf16 a[168:171], a[80:83], v[56:59], a[168:171]
    buffer_load_dwordx4 v6, s[8:11], s61 offen lds
    v_mfma_f32_16x16x32_bf16 a[168:171], a[84:87], v[60:63], a[168:171]
    v_mfma_f32_16x16x32_bf16 a[172:175], a[88:91], v[56:59], a[172:175]
    v_mfma_f32_16x16x32_bf16 a[172:175], a[92:95], v[60:63], a[172:175]
    v_mfma_f32_16x16x32_bf16 a[176:179], a[96:99], v[56:59], a[176:179]
    ds_read_b128 a[48:51], v22 offset:53248
    v_mfma_f32_16x16x32_bf16 a[176:179], a[100:103], v[60:63], a[176:179]
    v_mfma_f32_16x16x32_bf16 a[180:183], a[104:107], v[56:59], a[180:183]
    v_mfma_f32_16x16x32_bf16 a[180:183], a[108:111], v[60:63], a[180:183]
    buffer_load_dwordx4 v7, s[8:11], s61 offen offset:1024 lds
    v_mfma_f32_16x16x32_bf16 a[184:187], a[112:115], v[56:59], a[184:187]
    v_mfma_f32_16x16x32_bf16 a[184:187], a[116:119], v[60:63], a[184:187]
    ds_read_b128 a[52:55], v23 offset:53248
    v_mfma_f32_16x16x32_bf16 a[188:191], a[120:123], v[56:59], a[188:191]
    v_mfma_f32_16x16x32_bf16 a[188:191], a[124:127], v[60:63], a[188:191]
    v_mfma_f32_16x16x32_bf16 a[192:195], a[64:67], v[40:43], a[192:195]
    v_mfma_f32_16x16x32_bf16 a[192:195], a[68:71], v[44:47], a[192:195]
    v_mfma_f32_16x16x32_bf16 a[196:199], a[72:75], v[40:43], a[196:199]
    v_mfma_f32_16x16x32_bf16 a[196:199], a[76:79], v[44:47], a[196:199]
    buffer_load_dwordx4 v8, s[8:11], s61 offen offset:2048 lds
    v_mfma_f32_16x16x32_bf16 a[200:203], a[80:83], v[40:43], a[200:203]
    ds_read_b128 a[56:59], v22 offset:55296
    v_mfma_f32_16x16x32_bf16 a[200:203], a[84:87], v[44:47], a[200:203]
    v_mfma_f32_16x16x32_bf16 a[204:207], a[88:91], v[40:43], a[204:207]
    v_mfma_f32_16x16x32_bf16 a[204:207], a[92:95], v[44:47], a[204:207]
    v_mfma_f32_16x16x32_bf16 a[208:211], a[96:99], v[40:43], a[208:211]
    ds_read_b128 a[60:63], v23 offset:55296
    v_mfma_f32_16x16x32_bf16 a[208:211], a[100:103], v[44:47], a[208:211]
    v_mfma_f32_16x16x32_bf16 a[212:215], a[104:107], v[40:43], a[212:215]
    buffer_load_dwordx4 v9, s[8:11], s61 offen offset:3072 lds
    v_mfma_f32_16x16x32_bf16 a[212:215], a[108:111], v[44:47], a[212:215]
    v_mfma_f32_16x16x32_bf16 a[216:219], a[112:115], v[40:43], a[216:219]
    v_mfma_f32_16x16x32_bf16 a[216:219], a[116:119], v[44:47], a[216:219]
    v_mfma_f32_16x16x32_bf16 a[220:223], a[120:123], v[40:43], a[220:223]
    v_mfma_f32_16x16x32_bf16 a[220:223], a[124:127], v[44:47], a[220:223]
    s_waitcnt lgkmcnt(0)
    v_mfma_f32_16x16x32_bf16 a[224:227], a[64:67], v[48:51], a[224:227]
    v_mfma_f32_16x16x32_bf16 a[224:227], a[68:71], v[52:55], a[224:227]
    s_xor_b32 s61, s61, 128
    v_mfma_f32_16x16x32_bf16 a[228:231], a[72:75], v[48:51], a[228:231]
    v_mfma_f32_16x16x32_bf16 a[228:231], a[76:79], v[52:55], a[228:231]
    v_mfma_f32_16x16x32_bf16 a[232:235], a[80:83], v[48:51], a[232:235]
    v_mfma_f32_16x16x32_bf16 a[232:235], a[84:87], v[52:55], a[232:235]
    s_waitcnt vmcnt(10) lgkmcnt(0)
    s_barrier
    ds_read_b64_tr_b16 v[56:57], v14 offset:0
    v_mfma_f32_16x16x32_bf16 a[236:239], a[88:91], v[48:51], a[236:239]
    s_add_u32 m0, s69, 65536
    ds_read_b64_tr_b16 v[58:59], v14 offset:1024
    ds_read_b64_tr_b16 v[60:61], v14 offset:8192
    v_mfma_f32_16x16x32_bf16 a[236:239], a[92:95], v[52:55], a[236:239]
    buffer_load_dwordx4 v2, s[16:19], s60 offen nt lds
    v_mfma_f32_16x16x32_bf16 a[240:243], a[96:99], v[48:51], a[240:243]
    ds_read_b64_tr_b16 v[62:63], v14 offset:9216
    ds_read_b64_tr_b16 v[40:41], v15 offset:0
    v_mfma_f32_16x16x32_bf16 a[240:243], a[100:103], v[52:55], a[240:243]
    buffer_atomic_add v31, v30, s[44:47], s95 offen sc1
    v_mfma_f32_16x16x32_bf16 a[244:247], a[104:107], v[48:51], a[244:247]
    ds_read_b64_tr_b16 v[42:43], v15 offset:1024
    ds_read_b64_tr_b16 v[44:45], v15 offset:8192
    v_mfma_f32_16x16x32_bf16 a[244:247], a[108:111], v[52:55], a[244:247]
    ds_read_b64_tr_b16 v[46:47], v15 offset:9216
    v_add_u32 v14, 0xfffe0000, v14
    v_mfma_f32_16x16x32_bf16 a[248:251], a[112:115], v[48:51], a[248:251]
    v_add_u32 v15, 0xfffe0000, v15
    v_mfma_f32_16x16x32_bf16 a[248:251], a[116:119], v[52:55], a[248:251]
    buffer_load_dwordx4 v3, s[16:19], s60 offen offset:1024 nt lds
    v_mfma_f32_16x16x32_bf16 a[252:255], a[120:123], v[48:51], a[252:255]
    ds_read_b64_tr_b16 v[48:49], v16 offset:0
    ds_read_b64_tr_b16 v[50:51], v16 offset:1024
    v_mfma_f32_16x16x32_bf16 a[252:255], a[124:127], v[52:55], a[252:255]
    s_waitcnt lgkmcnt(3)
    ds_read_b64_tr_b16 v[52:53], v16 offset:8192
    ds_read_b64_tr_b16 v[54:55], v16 offset:9216
    v_mfma_f32_16x16x32_bf16 v[128:131], v[56:59], a[0:3], v[128:131]
    v_add_u32 v16, 0xfffe0000, v16
    v_mfma_f32_16x16x32_bf16 v[128:131], v[60:63], a[4:7], v[128:131]
    v_add_u32 v22, 0x10000, v22
    v_mfma_f32_16x16x32_bf16 v[132:135], v[56:59], a[8:11], v[132:135]
    ds_read_b128 a[64:67], v22 offset:16384
    v_mfma_f32_16x16x32_bf16 v[132:135], v[60:63], a[12:15], v[132:135]
    v_mfma_f32_16x16x32_bf16 v[136:139], v[56:59], a[16:19], v[136:139]
    v_mfma_f32_16x16x32_bf16 v[136:139], v[60:63], a[20:23], v[136:139]
    buffer_load_dwordx4 v4, s[16:19], s60 offen offset:2048 nt lds
    v_mfma_f32_16x16x32_bf16 v[140:143], v[56:59], a[24:27], v[140:143]
    v_add_u32 v23, 0x10000, v23
    v_mfma_f32_16x16x32_bf16 v[140:143], v[60:63], a[28:31], v[140:143]
    ds_read_b128 a[68:71], v23 offset:16384
    v_mfma_f32_16x16x32_bf16 v[144:147], v[56:59], a[32:35], v[144:147]
    v_mfma_f32_16x16x32_bf16 v[144:147], v[60:63], a[36:39], v[144:147]
    v_mfma_f32_16x16x32_bf16 v[148:151], v[56:59], a[40:43], v[148:151]
    v_mfma_f32_16x16x32_bf16 v[148:151], v[60:63], a[44:47], v[148:151]
    v_mfma_f32_16x16x32_bf16 v[152:155], v[56:59], a[48:51], v[152:155]
    buffer_load_dwordx4 v5, s[16:19], s60 offen offset:3072 nt lds
    v_mfma_f32_16x16x32_bf16 v[152:155], v[60:63], a[52:55], v[152:155]
    ds_read_b128 a[72:75], v22 offset:18432
    v_mfma_f32_16x16x32_bf16 v[156:159], v[56:59], a[56:59], v[156:159]
    ds_read_b64_tr_b16 v[56:57], v17 offset:0
    ds_read_b64_tr_b16 v[58:59], v17 offset:1024
    v_mfma_f32_16x16x32_bf16 v[156:159], v[60:63], a[60:63], v[156:159]
    ds_read_b64_tr_b16 v[60:61], v17 offset:8192
    ds_read_b64_tr_b16 v[62:63], v17 offset:9216
    v_mfma_f32_16x16x32_bf16 v[160:163], v[40:43], a[0:3], v[160:163]
    s_waitcnt lgkmcnt(5)
    v_add_u32 v17, 0xfffe0000, v17
    v_mfma_f32_16x16x32_bf16 v[160:163], v[44:47], a[4:7], v[160:163]
    v_mfma_f32_16x16x32_bf16 v[164:167], v[40:43], a[8:11], v[164:167]
    ds_read_b128 a[76:79], v23 offset:18432
    v_mfma_f32_16x16x32_bf16 v[164:167], v[44:47], a[12:15], v[164:167]
    s_add_u32 m0, s69, 81920
    v_mfma_f32_16x16x32_bf16 v[168:171], v[40:43], a[16:19], v[168:171]
    s_xor_b32 s60, s60, 1572864
    buffer_load_dwordx4 v6, s[8:11], s62 offen lds
    v_mfma_f32_16x16x32_bf16 v[168:171], v[44:47], a[20:23], v[168:171]
    v_mfma_f32_16x16x32_bf16 v[172:175], v[40:43], a[24:27], v[172:175]
    v_mfma_f32_16x16x32_bf16 v[172:175], v[44:47], a[28:31], v[172:175]
    v_mfma_f32_16x16x32_bf16 v[176:179], v[40:43], a[32:35], v[176:179]
    ds_read_b128 a[80:83], v22 offset:20480
    v_mfma_f32_16x16x32_bf16 v[176:179], v[44:47], a[36:39], v[176:179]
    v_mfma_f32_16x16x32_bf16 v[180:183], v[40:43], a[40:43], v[180:183]
    v_mfma_f32_16x16x32_bf16 v[180:183], v[44:47], a[44:47], v[180:183]
    buffer_load_dwordx4 v7, s[8:11], s62 offen offset:1024 lds
    v_mfma_f32_16x16x32_bf16 v[184:187], v[40:43], a[48:51], v[184:187]
    v_mfma_f32_16x16x32_bf16 v[184:187], v[44:47], a[52:55], v[184:187]
    ds_read_b128 a[84:87], v23 offset:20480
    v_mfma_f32_16x16x32_bf16 v[188:191], v[40:43], a[56:59], v[188:191]
    ds_read_b64_tr_b16 v[40:41], v14 offset:0
    ds_read_b64_tr_b16 v[42:43], v14 offset:1024
    v_mfma_f32_16x16x32_bf16 v[188:191], v[44:47], a[60:63], v[188:191]
    ds_read_b64_tr_b16 v[44:45], v14 offset:8192
    ds_read_b64_tr_b16 v[46:47], v14 offset:9216
    v_mfma_f32_16x16x32_bf16 v[192:195], v[48:51], a[0:3], v[192:195]
    v_mfma_f32_16x16x32_bf16 v[192:195], v[52:55], a[4:7], v[192:195]
    v_mfma_f32_16x16x32_bf16 v[196:199], v[48:51], a[8:11], v[196:199]
    v_mfma_f32_16x16x32_bf16 v[196:199], v[52:55], a[12:15], v[196:199]
    buffer_load_dwordx4 v8, s[8:11], s62 offen offset:2048 lds
    v_mfma_f32_16x16x32_bf16 v[200:203], v[48:51], a[16:19], v[200:203]
    ds_read_b128 a[88:91], v22 offset:22528
    v_mfma_f32_16x16x32_bf16 v[200:203], v[52:55], a[20:23], v[200:203]
    v_mfma_f32_16x16x32_bf16 v[204:207], v[48:51], a[24:27], v[204:207]
    v_mfma_f32_16x16x32_bf16 v[204:207], v[52:55], a[28:31], v[204:207]
    v_mfma_f32_16x16x32_bf16 v[208:211], v[48:51], a[32:35], v[208:211]
    ds_read_b128 a[92:95], v23 offset:22528
    v_mfma_f32_16x16x32_bf16 v[208:211], v[52:55], a[36:39], v[208:211]
    v_mfma_f32_16x16x32_bf16 v[212:215], v[48:51], a[40:43], v[212:215]
    buffer_load_dwordx4 v9, s[8:11], s62 offen offset:3072 lds
    v_mfma_f32_16x16x32_bf16 v[212:215], v[52:55], a[44:47], v[212:215]
    v_mfma_f32_16x16x32_bf16 v[216:219], v[48:51], a[48:51], v[216:219]
    v_mfma_f32_16x16x32_bf16 v[216:219], v[52:55], a[52:55], v[216:219]
    v_mfma_f32_16x16x32_bf16 v[220:223], v[48:51], a[56:59], v[220:223]
    s_waitcnt lgkmcnt(0)
    ds_read_b64_tr_b16 v[48:49], v15 offset:0
    ds_read_b64_tr_b16 v[50:51], v15 offset:1024
    v_mfma_f32_16x16x32_bf16 v[220:223], v[52:55], a[60:63], v[220:223]
    ds_read_b64_tr_b16 v[52:53], v15 offset:8192
    ds_read_b64_tr_b16 v[54:55], v15 offset:9216
    v_mfma_f32_16x16x32_bf16 v[224:227], v[56:59], a[0:3], v[224:227]
    s_mov_b32 s82, 3670016
    v_mfma_f32_16x16x32_bf16 v[224:227], v[60:63], a[4:7], v[224:227]
    s_xor_b32 s62, s62, 128
    v_mfma_f32_16x16x32_bf16 v[228:231], v[56:59], a[8:11], v[228:231]
    buffer_load_dword v127, v120, s[40:43], s82 offen nt
    v_mfma_f32_16x16x32_bf16 v[228:231], v[60:63], a[12:15], v[228:231]
    buffer_load_dword v108, v103, s[24:27], s77 offen
    v_mfma_f32_16x16x32_bf16 v[232:235], v[56:59], a[16:19], v[232:235]
    s_add_u32 s77, s77, 4608
    v_mfma_f32_16x16x32_bf16 v[232:235], v[60:63], a[20:23], v[232:235]
    s_add_u32 m0, s69, 98304
    v_mfma_f32_16x16x32_bf16 v[236:239], v[56:59], a[24:27], v[236:239]
    buffer_load_dwordx4 v2, s[12:15], s60 offen nt lds
    v_mfma_f32_16x16x32_bf16 v[236:239], v[60:63], a[28:31], v[236:239]
    v_mfma_f32_16x16x32_bf16 v[240:243], v[56:59], a[32:35], v[240:243]
    v_mfma_f32_16x16x32_bf16 v[240:243], v[60:63], a[36:39], v[240:243]
    v_mfma_f32_16x16x32_bf16 v[244:247], v[56:59], a[40:43], v[244:247]
    v_mfma_f32_16x16x32_bf16 v[244:247], v[60:63], a[44:47], v[244:247]
    v_mfma_f32_16x16x32_bf16 v[248:251], v[56:59], a[48:51], v[248:251]
    v_mfma_f32_16x16x32_bf16 v[248:251], v[60:63], a[52:55], v[248:251]
    buffer_load_dwordx4 v3, s[12:15], s60 offen offset:1024 nt lds
    v_mfma_f32_16x16x32_bf16 v[252:255], v[56:59], a[56:59], v[252:255]
    ds_read_b64_tr_b16 v[56:57], v16 offset:0
    ds_read_b64_tr_b16 v[58:59], v16 offset:1024
    v_mfma_f32_16x16x32_bf16 v[252:255], v[60:63], a[60:63], v[252:255]
    ds_read_b64_tr_b16 v[60:61], v16 offset:8192
    ds_read_b64_tr_b16 v[62:63], v16 offset:9216
    v_mfma_f32_16x16x32_bf16 a[128:131], a[0:3], v[40:43], a[128:131]
    v_mfma_f32_16x16x32_bf16 a[128:131], a[4:7], v[44:47], a[128:131]
    v_add_u32 v22, 0xfffe0000, v22
    v_mfma_f32_16x16x32_bf16 a[132:135], a[8:11], v[40:43], a[132:135]
    ds_read_b128 a[96:99], v22 offset:16384
    v_mfma_f32_16x16x32_bf16 a[132:135], a[12:15], v[44:47], a[132:135]
    v_mfma_f32_16x16x32_bf16 a[136:139], a[16:19], v[40:43], a[136:139]
    v_mfma_f32_16x16x32_bf16 a[136:139], a[20:23], v[44:47], a[136:139]
    buffer_load_dwordx4 v4, s[12:15], s60 offen offset:2048 nt lds
    v_mfma_f32_16x16x32_bf16 a[140:143], a[24:27], v[40:43], a[140:143]
    v_add_u32 v23, 0xfffe0000, v23
    v_mfma_f32_16x16x32_bf16 a[140:143], a[28:31], v[44:47], a[140:143]
    ds_read_b128 a[100:103], v23 offset:16384
    v_mfma_f32_16x16x32_bf16 a[144:147], a[32:35], v[40:43], a[144:147]
    v_mfma_f32_16x16x32_bf16 a[144:147], a[36:39], v[44:47], a[144:147]
    v_mfma_f32_16x16x32_bf16 a[148:151], a[40:43], v[40:43], a[148:151]
    v_mfma_f32_16x16x32_bf16 a[148:151], a[44:47], v[44:47], a[148:151]
    v_mfma_f32_16x16x32_bf16 a[152:155], a[48:51], v[40:43], a[152:155]
    buffer_load_dwordx4 v5, s[12:15], s60 offen offset:3072 nt lds
    v_mfma_f32_16x16x32_bf16 a[152:155], a[52:55], v[44:47], a[152:155]
    ds_read_b128 a[104:107], v22 offset:18432
    v_mfma_f32_16x16x32_bf16 a[156:159], a[56:59], v[40:43], a[156:159]
    ds_read_b64_tr_b16 v[40:41], v17 offset:0
    ds_read_b64_tr_b16 v[42:43], v17 offset:1024
    v_mfma_f32_16x16x32_bf16 a[156:159], a[60:63], v[44:47], a[156:159]
    s_waitcnt lgkmcnt(3)
    ds_read_b64_tr_b16 v[44:45], v17 offset:8192
    ds_read_b64_tr_b16 v[46:47], v17 offset:9216
    v_mfma_f32_16x16x32_bf16 a[160:163], a[0:3], v[48:51], a[160:163]
    v_mfma_f32_16x16x32_bf16 a[160:163], a[4:7], v[52:55], a[160:163]
    v_mfma_f32_16x16x32_bf16 a[164:167], a[8:11], v[48:51], a[164:167]
    ds_read_b128 a[108:111], v23 offset:18432
    v_mfma_f32_16x16x32_bf16 a[164:167], a[12:15], v[52:55], a[164:167]
    s_add_u32 m0, s69, 114688
    v_mfma_f32_16x16x32_bf16 a[168:171], a[16:19], v[48:51], a[168:171]
    buffer_load_dwordx4 v6, s[8:11], s61 offen lds
    v_mfma_f32_16x16x32_bf16 a[168:171], a[20:23], v[52:55], a[168:171]
    v_mfma_f32_16x16x32_bf16 a[172:175], a[24:27], v[48:51], a[172:175]
    v_mfma_f32_16x16x32_bf16 a[172:175], a[28:31], v[52:55], a[172:175]
    v_mfma_f32_16x16x32_bf16 a[176:179], a[32:35], v[48:51], a[176:179]
    ds_read_b128 a[112:115], v22 offset:20480
    v_mfma_f32_16x16x32_bf16 a[176:179], a[36:39], v[52:55], a[176:179]
    v_mfma_f32_16x16x32_bf16 a[180:183], a[40:43], v[48:51], a[180:183]
    v_mfma_f32_16x16x32_bf16 a[180:183], a[44:47], v[52:55], a[180:183]
    buffer_load_dwordx4 v7, s[8:11], s61 offen offset:1024 lds
    v_mfma_f32_16x16x32_bf16 a[184:187], a[48:51], v[48:51], a[184:187]
    v_mfma_f32_16x16x32_bf16 a[184:187], a[52:55], v[52:55], a[184:187]
    ds_read_b128 a[116:119], v23 offset:20480
    v_mfma_f32_16x16x32_bf16 a[188:191], a[56:59], v[48:51], a[188:191]
    v_mfma_f32_16x16x32_bf16 a[188:191], a[60:63], v[52:55], a[188:191]
    v_mfma_f32_16x16x32_bf16 a[192:195], a[0:3], v[56:59], a[192:195]
    v_mfma_f32_16x16x32_bf16 a[192:195], a[4:7], v[60:63], a[192:195]
    v_mfma_f32_16x16x32_bf16 a[196:199], a[8:11], v[56:59], a[196:199]
    v_mfma_f32_16x16x32_bf16 a[196:199], a[12:15], v[60:63], a[196:199]
    buffer_load_dwordx4 v8, s[8:11], s61 offen offset:2048 lds
    v_mfma_f32_16x16x32_bf16 a[200:203], a[16:19], v[56:59], a[200:203]
    ds_read_b128 a[120:123], v22 offset:22528
    v_mfma_f32_16x16x32_bf16 a[200:203], a[20:23], v[60:63], a[200:203]
    v_mfma_f32_16x16x32_bf16 a[204:207], a[24:27], v[56:59], a[204:207]
    v_mfma_f32_16x16x32_bf16 a[204:207], a[28:31], v[60:63], a[204:207]
    v_mfma_f32_16x16x32_bf16 a[208:211], a[32:35], v[56:59], a[208:211]
    ds_read_b128 a[124:127], v23 offset:22528
    v_mfma_f32_16x16x32_bf16 a[208:211], a[36:39], v[60:63], a[208:211]
    v_mfma_f32_16x16x32_bf16 a[212:215], a[40:43], v[56:59], a[212:215]
    buffer_load_dwordx4 v9, s[8:11], s61 offen offset:3072 lds
    v_mfma_f32_16x16x32_bf16 a[212:215], a[44:47], v[60:63], a[212:215]
    v_mfma_f32_16x16x32_bf16 a[216:219], a[48:51], v[56:59], a[216:219]
    v_mfma_f32_16x16x32_bf16 a[216:219], a[52:55], v[60:63], a[216:219]
    v_mfma_f32_16x16x32_bf16 a[220:223], a[56:59], v[56:59], a[220:223]
    v_mfma_f32_16x16x32_bf16 a[220:223], a[60:63], v[60:63], a[220:223]
    s_waitcnt lgkmcnt(0)
    v_mfma_f32_16x16x32_bf16 a[224:227], a[0:3], v[40:43], a[224:227]
    v_mfma_f32_16x16x32_bf16 a[224:227], a[4:7], v[44:47], a[224:227]
    s_xor_b32 s61, s61, 1920
    v_mfma_f32_16x16x32_bf16 a[228:231], a[8:11], v[40:43], a[228:231]
    s_andn2_b32 s61, s61, 896
    v_mfma_f32_16x16x32_bf16 a[228:231], a[12:15], v[44:47], a[228:231]
    s_lshl_b32 s61, s5, 7
    v_mfma_f32_16x16x32_bf16 a[232:235], a[16:19], v[40:43], a[232:235]
    v_mfma_f32_16x16x32_bf16 a[232:235], a[20:23], v[44:47], a[232:235]
    s_waitcnt vmcnt(10) lgkmcnt(0)
    s_barrier
    ds_read_b64_tr_b16 v[48:49], v14 offset:32768
    v_mfma_f32_16x16x32_bf16 a[236:239], a[24:27], v[40:43], a[236:239]
    s_add_u32 m0, s69, 131072
    ds_read_b64_tr_b16 v[50:51], v14 offset:33792
    ds_read_b64_tr_b16 v[52:53], v14 offset:40960
    v_mfma_f32_16x16x32_bf16 a[236:239], a[28:31], v[44:47], a[236:239]
    buffer_load_dwordx4 v2, s[16:19], s60 offen nt lds
    v_mfma_f32_16x16x32_bf16 a[240:243], a[32:35], v[40:43], a[240:243]
    ds_read_b64_tr_b16 v[54:55], v14 offset:41984
    ds_read_b64_tr_b16 v[56:57], v15 offset:32768
    v_mfma_f32_16x16x32_bf16 a[240:243], a[36:39], v[44:47], a[240:243]
    ds_read_b64_tr_b16 v[58:59], v15 offset:33792
    ds_read_b64_tr_b16 v[60:61], v15 offset:40960
    v_mfma_f32_16x16x32_bf16 a[244:247], a[40:43], v[40:43], a[244:247]
    ds_read_b64_tr_b16 v[62:63], v15 offset:41984
    v_add_u32 v14, 0x10000, v14
    v_mfma_f32_16x16x32_bf16 a[244:247], a[44:47], v[44:47], a[244:247]
    v_add_u32 v15, 0x10000, v15
    v_mfma_f32_16x16x32_bf16 a[248:251], a[48:51], v[40:43], a[248:251]
    v_mfma_f32_16x16x32_bf16 a[248:251], a[52:55], v[44:47], a[248:251]
    buffer_load_dwordx4 v3, s[16:19], s60 offen offset:1024 nt lds
    v_mfma_f32_16x16x32_bf16 a[252:255], a[56:59], v[40:43], a[252:255]
    ds_read_b64_tr_b16 v[40:41], v16 offset:32768
    ds_read_b64_tr_b16 v[42:43], v16 offset:33792
    v_mfma_f32_16x16x32_bf16 a[252:255], a[60:63], v[44:47], a[252:255]
    s_waitcnt lgkmcnt(2)
    ds_read_b64_tr_b16 v[44:45], v16 offset:40960
    ds_read_b64_tr_b16 v[46:47], v16 offset:41984
    v_mfma_f32_16x16x32_bf16 v[128:131], v[48:51], a[64:67], v[128:131]
    v_add_u32 v16, 0x10000, v16
    v_mfma_f32_16x16x32_bf16 v[128:131], v[52:55], a[68:71], v[128:131]
    v_mfma_f32_16x16x32_bf16 v[132:135], v[48:51], a[72:75], v[132:135]
    ds_read_b128 a[0:3], v22 offset:49152
    v_mfma_f32_16x16x32_bf16 v[132:135], v[52:55], a[76:79], v[132:135]
    v_mfma_f32_16x16x32_bf16 v[136:139], v[48:51], a[80:83], v[136:139]
    v_mfma_f32_16x16x32_bf16 v[136:139], v[52:55], a[84:87], v[136:139]
    buffer_load_dwordx4 v4, s[16:19], s60 offen offset:2048 nt lds
    v_mfma_f32_16x16x32_bf16 v[140:143], v[48:51], a[88:91], v[140:143]
    v_mfma_f32_16x16x32_bf16 v[140:143], v[52:55], a[92:95], v[140:143]
    ds_read_b128 a[4:7], v23 offset:49152
    v_mfma_f32_16x16x32_bf16 v[144:147], v[48:51], a[96:99], v[144:147]
    v_mfma_f32_16x16x32_bf16 v[144:147], v[52:55], a[100:103], v[144:147]
    v_mfma_f32_16x16x32_bf16 v[148:151], v[48:51], a[104:107], v[148:151]
    v_mfma_f32_16x16x32_bf16 v[148:151], v[52:55], a[108:111], v[148:151]
    v_mfma_f32_16x16x32_bf16 v[152:155], v[48:51], a[112:115], v[152:155]
    buffer_load_dwordx4 v5, s[16:19], s60 offen offset:3072 nt lds
    v_mfma_f32_16x16x32_bf16 v[152:155], v[52:55], a[116:119], v[152:155]
    ds_read_b128 a[8:11], v22 offset:51200
    v_mfma_f32_16x16x32_bf16 v[156:159], v[48:51], a[120:123], v[156:159]
    ds_read_b64_tr_b16 v[48:49], v17 offset:32768
    ds_read_b64_tr_b16 v[50:51], v17 offset:33792
    v_mfma_f32_16x16x32_bf16 v[156:159], v[52:55], a[124:127], v[156:159]
    ds_read_b64_tr_b16 v[52:53], v17 offset:40960
    ds_read_b64_tr_b16 v[54:55], v17 offset:41984
    v_mfma_f32_16x16x32_bf16 v[160:163], v[56:59], a[64:67], v[160:163]
    v_add_u32 v17, 0x10000, v17
    v_mfma_f32_16x16x32_bf16 v[160:163], v[60:63], a[68:71], v[160:163]
    v_mfma_f32_16x16x32_bf16 v[164:167], v[56:59], a[72:75], v[164:167]
    ds_read_b128 a[12:15], v23 offset:51200
    v_mfma_f32_16x16x32_bf16 v[164:167], v[60:63], a[76:79], v[164:167]
    s_add_u32 m0, s69, 147456
    v_mfma_f32_16x16x32_bf16 v[168:171], v[56:59], a[80:83], v[168:171]
    s_xor_b32 s60, s60, 524288
    buffer_load_dwordx4 v6, s[8:11], s62 offen lds
    v_mfma_f32_16x16x32_bf16 v[168:171], v[60:63], a[84:87], v[168:171]
    v_mov_b32 v6, v96
    v_mfma_f32_16x16x32_bf16 v[172:175], v[56:59], a[88:91], v[172:175]
    v_mfma_f32_16x16x32_bf16 v[172:175], v[60:63], a[92:95], v[172:175]
    v_mfma_f32_16x16x32_bf16 v[176:179], v[56:59], a[96:99], v[176:179]
    ds_read_b128 a[16:19], v22 offset:53248
    v_mfma_f32_16x16x32_bf16 v[176:179], v[60:63], a[100:103], v[176:179]
    v_mfma_f32_16x16x32_bf16 v[180:183], v[56:59], a[104:107], v[180:183]
    v_mfma_f32_16x16x32_bf16 v[180:183], v[60:63], a[108:111], v[180:183]
    buffer_load_dwordx4 v7, s[8:11], s62 offen offset:1024 lds
    v_mfma_f32_16x16x32_bf16 v[184:187], v[56:59], a[112:115], v[184:187]
    v_mfma_f32_16x16x32_bf16 v[184:187], v[60:63], a[116:119], v[184:187]
    ds_read_b128 a[20:23], v23 offset:53248
    v_mfma_f32_16x16x32_bf16 v[188:191], v[56:59], a[120:123], v[188:191]
    s_waitcnt lgkmcnt(1)
    ds_read_b64_tr_b16 v[56:57], v14 offset:0
    ds_read_b64_tr_b16 v[58:59], v14 offset:1024
    v_mfma_f32_16x16x32_bf16 v[188:191], v[60:63], a[124:127], v[188:191]
    ds_read_b64_tr_b16 v[60:61], v14 offset:8192
    ds_read_b64_tr_b16 v[62:63], v14 offset:9216
    v_mfma_f32_16x16x32_bf16 v[192:195], v[40:43], a[64:67], v[192:195]
    v_mfma_f32_16x16x32_bf16 v[192:195], v[44:47], a[68:71], v[192:195]
    v_mfma_f32_16x16x32_bf16 v[196:199], v[40:43], a[72:75], v[196:199]
    v_mfma_f32_16x16x32_bf16 v[196:199], v[44:47], a[76:79], v[196:199]
    buffer_load_dwordx4 v8, s[8:11], s62 offen offset:2048 lds
    v_mfma_f32_16x16x32_bf16 v[200:203], v[40:43], a[80:83], v[200:203]
    ds_read_b128 a[24:27], v22 offset:55296
    v_bfe_u32 v8, v1, 4, 3
    v_mfma_f32_16x16x32_bf16 v[200:203], v[44:47], a[84:87], v[200:203]
    v_lshlrev_b32 v8, 12, v8
    v_mfma_f32_16x16x32_bf16 v[204:207], v[40:43], a[88:91], v[204:207]
    v_mfma_f32_16x16x32_bf16 v[204:207], v[44:47], a[92:95], v[204:207]
    v_mfma_f32_16x16x32_bf16 v[208:211], v[40:43], a[96:99], v[208:211]
    ds_read_b128 a[28:31], v23 offset:55296
    v_mfma_f32_16x16x32_bf16 v[208:211], v[44:47], a[100:103], v[208:211]
    v_mfma_f32_16x16x32_bf16 v[212:215], v[40:43], a[104:107], v[212:215]
    buffer_load_dwordx4 v9, s[8:11], s62 offen offset:3072 lds
    v_mfma_f32_16x16x32_bf16 v[212:215], v[44:47], a[108:111], v[212:215]
    s_mul_i32 s8, s7, 36864
    v_lshrrev_b32 v9, 2, v1
    v_mfma_f32_16x16x32_bf16 v[216:219], v[40:43], a[112:115], v[216:219]
    s_add_u32 s8, s8, s99
    v_mfma_f32_16x16x32_bf16 v[216:219], v[44:47], a[116:119], v[216:219]
    s_lshr_b32 s99, s69, 5
    v_mfma_f32_16x16x32_bf16 v[220:223], v[40:43], a[120:123], v[220:223]
    s_add_u32 s99, s99, s98
    ds_read_b64_tr_b16 v[40:41], v15 offset:0
    ds_read_b64_tr_b16 v[42:43], v15 offset:1024
    v_mfma_f32_16x16x32_bf16 v[220:223], v[44:47], a[124:127], v[220:223]
    s_mul_hi_u32 s7, s2, 715827883
    ds_read_b64_tr_b16 v[44:45], v15 offset:8192
    ds_read_b64_tr_b16 v[46:47], v15 offset:9216
    v_mfma_f32_16x16x32_bf16 v[224:227], v[48:51], a[64:67], v[224:227]
    s_mul_i32 s100, s7, 6
    v_add3_u32 v36, v36, v37, s99
    v_bfe_u32 v37, v1, 6, 2
    v_mfma_f32_16x16x32_bf16 v[224:227], v[52:55], a[68:71], v[224:227]
    s_xor_b32 s62, s62, 1920
    v_mfma_f32_16x16x32_bf16 v[228:231], v[48:51], a[72:75], v[228:231]
    s_andn2_b32 s62, s62, 896
    buffer_load_dword v109, v103, s[24:27], s77 offen
    v_mfma_f32_16x16x32_bf16 v[228:231], v[52:55], a[76:79], v[228:231]
    s_sub_u32 s100, s2, s100
    v_mfma_f32_16x16x32_bf16 v[232:235], v[48:51], a[80:83], v[232:235]
    s_mul_i32 s100, s100, 6
    v_mfma_f32_16x16x32_bf16 v[232:235], v[52:55], a[84:87], v[232:235]
    s_add_u32 m0, s69, 0
    v_mfma_f32_16x16x32_bf16 v[236:239], v[48:51], a[88:91], v[236:239]
    s_lshl1_add_u32 s100, s4, s100
    buffer_load_dwordx4 v2, s[12:15], s60 offen nt lds
    v_mfma_f32_16x16x32_bf16 v[236:239], v[52:55], a[92:95], v[236:239]
    s_add_u32 s10, s7, 128
    v_mfma_f32_16x16x32_bf16 v[240:243], v[48:51], a[96:99], v[240:243]
    s_sub_u32 s100, s100, 2
    v_mfma_f32_16x16x32_bf16 v[240:243], v[52:55], a[100:103], v[240:243]
    s_mul_i32 s10, s10, 36
    v_mfma_f32_16x16x32_bf16 v[244:247], v[48:51], a[104:107], v[244:247]
    s_add_u32 s10, s10, s100
    v_mfma_f32_16x16x32_bf16 v[244:247], v[52:55], a[108:111], v[244:247]
    s_lshl_b32 s100, s100, 5
    v_mfma_f32_16x16x32_bf16 v[248:251], v[48:51], a[112:115], v[248:251]
    s_add_u32 s9, s8, 16384
    v_mfma_f32_16x16x32_bf16 v[248:251], v[52:55], a[116:119], v[248:251]
    s_add_u32 s8, s8, s69
    buffer_load_dwordx4 v3, s[12:15], s60 offen offset:1024 nt lds
    v_mfma_f32_16x16x32_bf16 v[252:255], v[48:51], a[120:123], v[252:255]
    s_lshl_b32 s10, s10, 10
    ds_read_b64_tr_b16 v[48:49], v16 offset:0
    ds_read_b64_tr_b16 v[50:51], v16 offset:1024
    v_mfma_f32_16x16x32_bf16 v[252:255], v[52:55], a[124:127], v[252:255]
    s_waitcnt lgkmcnt(2)
    ds_read_b64_tr_b16 v[52:53], v16 offset:8192
    ds_read_b64_tr_b16 v[54:55], v16 offset:9216
    v_mfma_f32_16x16x32_bf16 a[128:131], a[64:67], v[56:59], a[128:131]
    s_cmp_eq_u32 s4, 0
    s_cselect_b32 s9, s9, s10
    v_mfma_f32_16x16x32_bf16 a[128:131], a[68:71], v[60:63], a[128:131]
    v_add_u32 v22, 0x10000, v22
    v_mfma_f32_16x16x32_bf16 a[132:135], a[72:75], v[56:59], a[132:135]
    ds_read_b128 a[32:35], v22 offset:16384
    v_mfma_f32_16x16x32_bf16 a[132:135], a[76:79], v[60:63], a[132:135]
    v_mfma_f32_16x16x32_bf16 a[136:139], a[80:83], v[56:59], a[136:139]
    v_mfma_f32_16x16x32_bf16 a[136:139], a[84:87], v[60:63], a[136:139]
    buffer_load_dwordx4 v4, s[12:15], s60 offen offset:2048 nt lds
    v_mfma_f32_16x16x32_bf16 a[140:143], a[88:91], v[56:59], a[140:143]
    v_add_u32 v23, 0x10000, v23
    v_mfma_f32_16x16x32_bf16 a[140:143], a[92:95], v[60:63], a[140:143]
    ds_read_b128 a[36:39], v23 offset:16384
    v_mfma_f32_16x16x32_bf16 a[144:147], a[96:99], v[56:59], a[144:147]
    v_mfma_f32_16x16x32_bf16 a[144:147], a[100:103], v[60:63], a[144:147]
    v_mfma_f32_16x16x32_bf16 a[148:151], a[104:107], v[56:59], a[148:151]
    v_mfma_f32_16x16x32_bf16 a[148:151], a[108:111], v[60:63], a[148:151]
    v_mfma_f32_16x16x32_bf16 a[152:155], a[112:115], v[56:59], a[152:155]
    buffer_load_dwordx4 v5, s[12:15], s60 offen offset:3072 nt lds
    v_mfma_f32_16x16x32_bf16 a[152:155], a[116:119], v[60:63], a[152:155]
    ds_read_b128 a[40:43], v22 offset:18432
    v_mfma_f32_16x16x32_bf16 a[156:159], a[120:123], v[56:59], a[156:159]
    ds_read_b64_tr_b16 v[56:57], v17 offset:0
    ds_read_b64_tr_b16 v[58:59], v17 offset:1024
    v_mfma_f32_16x16x32_bf16 a[156:159], a[124:127], v[60:63], a[156:159]
    ds_read_b64_tr_b16 v[60:61], v17 offset:8192
    ds_read_b64_tr_b16 v[62:63], v17 offset:9216
    v_mfma_f32_16x16x32_bf16 a[160:163], a[64:67], v[40:43], a[160:163]
    v_mfma_f32_16x16x32_bf16 a[160:163], a[68:71], v[44:47], a[160:163]
    v_mfma_f32_16x16x32_bf16 a[164:167], a[72:75], v[40:43], a[164:167]
    ds_read_b128 a[44:47], v23 offset:18432
    v_mfma_f32_16x16x32_bf16 a[164:167], a[76:79], v[44:47], a[164:167]
    s_add_u32 m0, s69, 16384
    v_mfma_f32_16x16x32_bf16 a[168:171], a[80:83], v[40:43], a[168:171]
    buffer_load_dwordx4 v10, s[20:23], s63 offen lds
    v_mfma_f32_16x16x32_bf16 a[168:171], a[84:87], v[44:47], a[168:171]
    v_mfma_f32_16x16x32_bf16 a[172:175], a[88:91], v[40:43], a[172:175]
    v_mfma_f32_16x16x32_bf16 a[172:175], a[92:95], v[44:47], a[172:175]
    v_mfma_f32_16x16x32_bf16 a[176:179], a[96:99], v[40:43], a[176:179]
    ds_read_b128 a[48:51], v22 offset:20480
    v_mfma_f32_16x16x32_bf16 a[176:179], a[100:103], v[44:47], a[176:179]
    v_mfma_f32_16x16x32_bf16 a[180:183], a[104:107], v[40:43], a[180:183]
    v_mfma_f32_16x16x32_bf16 a[180:183], a[108:111], v[44:47], a[180:183]
    buffer_load_dwordx4 v11, s[20:23], s63 offen offset:1024 lds
    v_mfma_f32_16x16x32_bf16 a[184:187], a[112:115], v[40:43], a[184:187]
    v_mfma_f32_16x16x32_bf16 a[184:187], a[116:119], v[44:47], a[184:187]
    ds_read_b128 a[52:55], v23 offset:20480
    v_mfma_f32_16x16x32_bf16 a[188:191], a[120:123], v[40:43], a[188:191]
    v_mfma_f32_16x16x32_bf16 a[188:191], a[124:127], v[44:47], a[188:191]
    s_waitcnt lgkmcnt(1)
    v_mfma_f32_16x16x32_bf16 a[192:195], a[64:67], v[48:51], a[192:195]
    v_mfma_f32_16x16x32_bf16 a[192:195], a[68:71], v[52:55], a[192:195]
    v_mfma_f32_16x16x32_bf16 a[196:199], a[72:75], v[48:51], a[196:199]
    v_mfma_f32_16x16x32_bf16 a[196:199], a[76:79], v[52:55], a[196:199]
    buffer_load_dwordx4 v12, s[20:23], s63 offen offset:2048 lds
    v_mfma_f32_16x16x32_bf16 a[200:203], a[80:83], v[48:51], a[200:203]
    ds_read_b128 a[56:59], v22 offset:22528
    v_mfma_f32_16x16x32_bf16 a[200:203], a[84:87], v[52:55], a[200:203]
    v_mfma_f32_16x16x32_bf16 a[204:207], a[88:91], v[48:51], a[204:207]
    v_mfma_f32_16x16x32_bf16 a[204:207], a[92:95], v[52:55], a[204:207]
    v_mfma_f32_16x16x32_bf16 a[208:211], a[96:99], v[48:51], a[208:211]
    ds_read_b128 a[60:63], v23 offset:22528
    v_mfma_f32_16x16x32_bf16 a[208:211], a[100:103], v[52:55], a[208:211]
    v_mfma_f32_16x16x32_bf16 a[212:215], a[104:107], v[48:51], a[212:215]
    buffer_load_dwordx4 v13, s[20:23], s63 offen offset:3072 lds
    v_mfma_f32_16x16x32_bf16 a[212:215], a[108:111], v[52:55], a[212:215]
    v_mfma_f32_16x16x32_bf16 a[216:219], a[112:115], v[48:51], a[216:219]
    v_mfma_f32_16x16x32_bf16 a[216:219], a[116:119], v[52:55], a[216:219]
    v_mfma_f32_16x16x32_bf16 a[220:223], a[120:123], v[48:51], a[220:223]
    v_mfma_f32_16x16x32_bf16 a[220:223], a[124:127], v[52:55], a[220:223]
    v_mfma_f32_16x16x32_bf16 a[224:227], a[64:67], v[56:59], a[224:227]
    v_mfma_f32_16x16x32_bf16 a[224:227], a[68:71], v[60:63], a[224:227]
    s_xor_b32 s63, s63, 128
    v_mfma_f32_16x16x32_bf16 a[228:231], a[72:75], v[56:59], a[228:231]
    v_mfma_f32_16x16x32_bf16 a[228:231], a[76:79], v[60:63], a[228:231]
    v_mfma_f32_16x16x32_bf16 a[232:235], a[80:83], v[56:59], a[232:235]
    v_mfma_f32_16x16x32_bf16 a[232:235], a[84:87], v[60:63], a[232:235]
    s_waitcnt vmcnt(9) lgkmcnt(0)
    s_barrier
    ds_read_b64_tr_b16 v[40:41], v14 offset:32768
    v_mfma_f32_16x16x32_bf16 a[236:239], a[88:91], v[56:59], a[236:239]
    s_add_u32 m0, s69, 32768
    ds_read_b64_tr_b16 v[42:43], v14 offset:33792
    ds_read_b64_tr_b16 v[44:45], v14 offset:40960
    v_mfma_f32_16x16x32_bf16 a[236:239], a[92:95], v[60:63], a[236:239]
    buffer_load_dwordx4 v2, s[16:19], s60 offen nt lds
    v_mfma_f32_16x16x32_bf16 a[240:243], a[96:99], v[56:59], a[240:243]
    ds_read_b64_tr_b16 v[46:47], v14 offset:41984
    ds_read_b64_tr_b16 v[48:49], v15 offset:32768
    v_mfma_f32_16x16x32_bf16 a[240:243], a[100:103], v[60:63], a[240:243]
    ds_read_b64_tr_b16 v[50:51], v15 offset:33792
    ds_read_b64_tr_b16 v[52:53], v15 offset:40960
    v_mfma_f32_16x16x32_bf16 a[244:247], a[104:107], v[56:59], a[244:247]
    ds_read_b64_tr_b16 v[54:55], v15 offset:41984
    v_add_u32 v14, 0x10000, v14
    v_mfma_f32_16x16x32_bf16 a[244:247], a[108:111], v[60:63], a[244:247]
    v_add_u32 v15, 0x10000, v15
    v_mfma_f32_16x16x32_bf16 a[248:251], a[112:115], v[56:59], a[248:251]
    v_mfma_f32_16x16x32_bf16 a[248:251], a[116:119], v[60:63], a[248:251]
    buffer_load_dwordx4 v3, s[16:19], s60 offen offset:1024 nt lds
    v_mfma_f32_16x16x32_bf16 a[252:255], a[120:123], v[56:59], a[252:255]
    ds_read_b64_tr_b16 v[56:57], v16 offset:32768
    ds_read_b64_tr_b16 v[58:59], v16 offset:33792
    v_mfma_f32_16x16x32_bf16 a[252:255], a[124:127], v[60:63], a[252:255]
    s_waitcnt lgkmcnt(2)
    ds_read_b64_tr_b16 v[60:61], v16 offset:40960
    ds_read_b64_tr_b16 v[62:63], v16 offset:41984
    v_mfma_f32_16x16x32_bf16 v[128:131], v[40:43], a[0:3], v[128:131]
    v_add_u32 v16, 0x10000, v16
    v_mfma_f32_16x16x32_bf16 v[128:131], v[44:47], a[4:7], v[128:131]
    v_mfma_f32_16x16x32_bf16 v[132:135], v[40:43], a[8:11], v[132:135]
    ds_read_b128 a[64:67], v22 offset:49152
    v_mfma_f32_16x16x32_bf16 v[132:135], v[44:47], a[12:15], v[132:135]
    v_mfma_f32_16x16x32_bf16 v[136:139], v[40:43], a[16:19], v[136:139]
    v_mfma_f32_16x16x32_bf16 v[136:139], v[44:47], a[20:23], v[136:139]
    buffer_load_dwordx4 v4, s[16:19], s60 offen offset:2048 nt lds
    v_mfma_f32_16x16x32_bf16 v[140:143], v[40:43], a[24:27], v[140:143]
    v_mfma_f32_16x16x32_bf16 v[140:143], v[44:47], a[28:31], v[140:143]
    ds_read_b128 a[68:71], v23 offset:49152
    v_mfma_f32_16x16x32_bf16 v[144:147], v[40:43], a[32:35], v[144:147]
    v_mfma_f32_16x16x32_bf16 v[144:147], v[44:47], a[36:39], v[144:147]
    v_mfma_f32_16x16x32_bf16 v[148:151], v[40:43], a[40:43], v[148:151]
    v_mfma_f32_16x16x32_bf16 v[148:151], v[44:47], a[44:47], v[148:151]
    v_mfma_f32_16x16x32_bf16 v[152:155], v[40:43], a[48:51], v[152:155]
    buffer_load_dwordx4 v5, s[16:19], s60 offen offset:3072 nt lds
    v_mfma_f32_16x16x32_bf16 v[152:155], v[44:47], a[52:55], v[152:155]
    ds_read_b128 a[72:75], v22 offset:51200
    v_mfma_f32_16x16x32_bf16 v[156:159], v[40:43], a[56:59], v[156:159]
    ds_read_b64_tr_b16 v[40:41], v17 offset:32768
    ds_read_b64_tr_b16 v[42:43], v17 offset:33792
    v_mfma_f32_16x16x32_bf16 v[156:159], v[44:47], a[60:63], v[156:159]
    ds_read_b64_tr_b16 v[44:45], v17 offset:40960
    ds_read_b64_tr_b16 v[46:47], v17 offset:41984
    v_mfma_f32_16x16x32_bf16 v[160:163], v[48:51], a[0:3], v[160:163]
    v_add_u32 v17, 0x10000, v17
    v_mfma_f32_16x16x32_bf16 v[160:163], v[52:55], a[4:7], v[160:163]
    v_mfma_f32_16x16x32_bf16 v[164:167], v[48:51], a[8:11], v[164:167]
    ds_read_b128 a[76:79], v23 offset:51200
    v_mfma_f32_16x16x32_bf16 v[164:167], v[52:55], a[12:15], v[164:167]
    s_add_u32 m0, s69, 49152
    buffer_load_dword v7, v9, s[44:47], s69 offen sc1
    v_mfma_f32_16x16x32_bf16 v[168:171], v[48:51], a[16:19], v[168:171]
    s_xor_b32 s60, s60, 3670016
    buffer_load_dwordx4 v10, s[20:23], s64 offen lds
    v_mfma_f32_16x16x32_bf16 v[168:171], v[52:55], a[20:23], v[168:171]
    v_mfma_f32_16x16x32_bf16 v[172:175], v[48:51], a[24:27], v[172:175]
    v_mfma_f32_16x16x32_bf16 v[172:175], v[52:55], a[28:31], v[172:175]
    v_mfma_f32_16x16x32_bf16 v[176:179], v[48:51], a[32:35], v[176:179]
    ds_read_b128 a[80:83], v22 offset:53248
    v_mfma_f32_16x16x32_bf16 v[176:179], v[52:55], a[36:39], v[176:179]
    v_mfma_f32_16x16x32_bf16 v[180:183], v[48:51], a[40:43], v[180:183]
    v_mfma_f32_16x16x32_bf16 v[180:183], v[52:55], a[44:47], v[180:183]
    buffer_load_dwordx4 v11, s[20:23], s64 offen offset:1024 lds
    v_mfma_f32_16x16x32_bf16 v[184:187], v[48:51], a[48:51], v[184:187]
    v_mfma_f32_16x16x32_bf16 v[184:187], v[52:55], a[52:55], v[184:187]
    ds_read_b128 a[84:87], v23 offset:53248
    v_mfma_f32_16x16x32_bf16 v[188:191], v[48:51], a[56:59], v[188:191]
    s_waitcnt lgkmcnt(1)
    ds_read_b64_tr_b16 v[48:49], v14 offset:0
    ds_read_b64_tr_b16 v[50:51], v14 offset:1024
    v_mfma_f32_16x16x32_bf16 v[188:191], v[52:55], a[60:63], v[188:191]
    ds_read_b64_tr_b16 v[52:53], v14 offset:8192
    ds_read_b64_tr_b16 v[54:55], v14 offset:9216
    v_mfma_f32_16x16x32_bf16 v[192:195], v[56:59], a[0:3], v[192:195]
    v_add_u32 v14, 0xfffe0000, v14
    v_mfma_f32_16x16x32_bf16 v[192:195], v[60:63], a[4:7], v[192:195]
    v_mfma_f32_16x16x32_bf16 v[196:199], v[56:59], a[8:11], v[196:199]
    v_mfma_f32_16x16x32_bf16 v[196:199], v[60:63], a[12:15], v[196:199]
    buffer_load_dwordx4 v12, s[20:23], s64 offen offset:2048 lds
    v_mfma_f32_16x16x32_bf16 v[200:203], v[56:59], a[16:19], v[200:203]
    ds_read_b128 a[88:91], v22 offset:55296
    v_mfma_f32_16x16x32_bf16 v[200:203], v[60:63], a[20:23], v[200:203]
    v_mfma_f32_16x16x32_bf16 v[204:207], v[56:59], a[24:27], v[204:207]
    v_mfma_f32_16x16x32_bf16 v[204:207], v[60:63], a[28:31], v[204:207]
    v_mfma_f32_16x16x32_bf16 v[208:211], v[56:59], a[32:35], v[208:211]
    ds_read_b128 a[92:95], v23 offset:55296
    v_mfma_f32_16x16x32_bf16 v[208:211], v[60:63], a[36:39], v[208:211]
    v_mfma_f32_16x16x32_bf16 v[212:215], v[56:59], a[40:43], v[212:215]
    buffer_load_dwordx4 v13, s[20:23], s64 offen offset:3072 lds
    v_mfma_f32_16x16x32_bf16 v[212:215], v[60:63], a[44:47], v[212:215]
    v_mfma_f32_16x16x32_bf16 v[216:219], v[56:59], a[48:51], v[216:219]
    v_mfma_f32_16x16x32_bf16 v[216:219], v[60:63], a[52:55], v[216:219]
    v_mfma_f32_16x16x32_bf16 v[220:223], v[56:59], a[56:59], v[220:223]
    ds_read_b64_tr_b16 v[56:57], v15 offset:0
    ds_read_b64_tr_b16 v[58:59], v15 offset:1024
    v_mfma_f32_16x16x32_bf16 v[220:223], v[60:63], a[60:63], v[220:223]
    ds_read_b64_tr_b16 v[60:61], v15 offset:8192
    ds_read_b64_tr_b16 v[62:63], v15 offset:9216
    v_mfma_f32_16x16x32_bf16 v[224:227], v[40:43], a[0:3], v[224:227]
    v_add_u32 v15, 0xfffe0000, v15
    v_mfma_f32_16x16x32_bf16 v[224:227], v[44:47], a[4:7], v[224:227]
    s_xor_b32 s64, s64, 128
    v_mfma_f32_16x16x32_bf16 v[228:231], v[40:43], a[8:11], v[228:231]
    v_mfma_f32_16x16x32_bf16 v[228:231], v[44:47], a[12:15], v[228:231]
    v_mfma_f32_16x16x32_bf16 v[232:235], v[40:43], a[16:19], v[232:235]
    v_mfma_f32_16x16x32_bf16 v[232:235], v[44:47], a[20:23], v[232:235]
    s_add_u32 m0, s69, 65536
    v_mfma_f32_16x16x32_bf16 v[236:239], v[40:43], a[24:27], v[236:239]
    buffer_load_dwordx4 v2, s[24:27], s60 offen lds
    v_mfma_f32_16x16x32_bf16 v[236:239], v[44:47], a[28:31], v[236:239]
    v_mfma_f32_16x16x32_bf16 v[240:243], v[40:43], a[32:35], v[240:243]
    v_mfma_f32_16x16x32_bf16 v[240:243], v[44:47], a[36:39], v[240:243]
    v_mfma_f32_16x16x32_bf16 v[244:247], v[40:43], a[40:43], v[244:247]
    v_mfma_f32_16x16x32_bf16 v[244:247], v[44:47], a[44:47], v[244:247]
    v_mfma_f32_16x16x32_bf16 v[248:251], v[40:43], a[48:51], v[248:251]
    v_mfma_f32_16x16x32_bf16 v[248:251], v[44:47], a[52:55], v[248:251]
    buffer_load_dwordx4 v3, s[24:27], s60 offen offset:1024 lds
    v_mfma_f32_16x16x32_bf16 v[252:255], v[40:43], a[56:59], v[252:255]
    ds_read_b64_tr_b16 v[40:41], v16 offset:0
    ds_read_b64_tr_b16 v[42:43], v16 offset:1024
    v_mfma_f32_16x16x32_bf16 v[252:255], v[44:47], a[60:63], v[252:255]
    s_waitcnt lgkmcnt(2)
    ds_read_b64_tr_b16 v[44:45], v16 offset:8192
    ds_read_b64_tr_b16 v[46:47], v16 offset:9216
    v_mfma_f32_16x16x32_bf16 a[128:131], a[0:3], v[48:51], a[128:131]
    v_add_u32 v16, 0xfffe0000, v16
    v_mfma_f32_16x16x32_bf16 a[128:131], a[4:7], v[52:55], a[128:131]
    v_add_u32 v22, 0x10000, v22
    v_mfma_f32_16x16x32_bf16 a[132:135], a[8:11], v[48:51], a[132:135]
    ds_read_b128 a[96:99], v22 offset:16384
    v_mfma_f32_16x16x32_bf16 a[132:135], a[12:15], v[52:55], a[132:135]
    v_mfma_f32_16x16x32_bf16 a[136:139], a[16:19], v[48:51], a[136:139]
    v_mfma_f32_16x16x32_bf16 a[136:139], a[20:23], v[52:55], a[136:139]
    buffer_load_dwordx4 v4, s[24:27], s60 offen offset:2048 lds
    v_mfma_f32_16x16x32_bf16 a[140:143], a[24:27], v[48:51], a[140:143]
    v_add_u32 v23, 0x10000, v23
    v_mfma_f32_16x16x32_bf16 a[140:143], a[28:31], v[52:55], a[140:143]
    ds_read_b128 a[100:103], v23 offset:16384
    v_mfma_f32_16x16x32_bf16 a[144:147], a[32:35], v[48:51], a[144:147]
    v_mfma_f32_16x16x32_bf16 a[144:147], a[36:39], v[52:55], a[144:147]
    v_mfma_f32_16x16x32_bf16 a[148:151], a[40:43], v[48:51], a[148:151]
    v_mfma_f32_16x16x32_bf16 a[148:151], a[44:47], v[52:55], a[148:151]
    v_mfma_f32_16x16x32_bf16 a[152:155], a[48:51], v[48:51], a[152:155]
    buffer_load_dwordx4 v5, s[24:27], s60 offen offset:3072 lds
    v_mfma_f32_16x16x32_bf16 a[152:155], a[52:55], v[52:55], a[152:155]
    ds_read_b128 a[104:107], v22 offset:18432
    v_mfma_f32_16x16x32_bf16 a[156:159], a[56:59], v[48:51], a[156:159]
    ds_read_b64_tr_b16 v[48:49], v17 offset:0
    ds_read_b64_tr_b16 v[50:51], v17 offset:1024
    v_mfma_f32_16x16x32_bf16 a[156:159], a[60:63], v[52:55], a[156:159]
    ds_read_b64_tr_b16 v[52:53], v17 offset:8192
    ds_read_b64_tr_b16 v[54:55], v17 offset:9216
    v_mfma_f32_16x16x32_bf16 a[160:163], a[0:3], v[56:59], a[160:163]
    v_add_u32 v17, 0xfffe0000, v17
    v_mfma_f32_16x16x32_bf16 a[160:163], a[4:7], v[60:63], a[160:163]
    v_mfma_f32_16x16x32_bf16 a[164:167], a[8:11], v[56:59], a[164:167]
    ds_read_b128 a[108:111], v23 offset:18432
    v_mfma_f32_16x16x32_bf16 a[164:167], a[12:15], v[60:63], a[164:167]
    s_add_u32 m0, s69, 81920
    v_mfma_f32_16x16x32_bf16 a[168:171], a[16:19], v[56:59], a[168:171]
    s_xor_b32 s60, s60, 524288
    buffer_load_dwordx4 v10, s[20:23], s63 offen lds
    v_mfma_f32_16x16x32_bf16 a[168:171], a[20:23], v[60:63], a[168:171]
    v_mfma_f32_16x16x32_bf16 a[172:175], a[24:27], v[56:59], a[172:175]
    v_mfma_f32_16x16x32_bf16 a[172:175], a[28:31], v[60:63], a[172:175]
    v_mfma_f32_16x16x32_bf16 a[176:179], a[32:35], v[56:59], a[176:179]
    ds_read_b128 a[112:115], v22 offset:20480
    v_mfma_f32_16x16x32_bf16 a[176:179], a[36:39], v[60:63], a[176:179]
    v_mfma_f32_16x16x32_bf16 a[180:183], a[40:43], v[56:59], a[180:183]
    v_mfma_f32_16x16x32_bf16 a[180:183], a[44:47], v[60:63], a[180:183]
    buffer_load_dwordx4 v11, s[20:23], s63 offen offset:1024 lds
    v_mfma_f32_16x16x32_bf16 a[184:187], a[48:51], v[56:59], a[184:187]
    v_mfma_f32_16x16x32_bf16 a[184:187], a[52:55], v[60:63], a[184:187]
    ds_read_b128 a[116:119], v23 offset:20480
    v_mfma_f32_16x16x32_bf16 a[188:191], a[56:59], v[56:59], a[188:191]
    v_mfma_f32_16x16x32_bf16 a[188:191], a[60:63], v[60:63], a[188:191]
    s_waitcnt lgkmcnt(1)
    v_mfma_f32_16x16x32_bf16 a[192:195], a[0:3], v[40:43], a[192:195]
    v_mfma_f32_16x16x32_bf16 a[192:195], a[4:7], v[44:47], a[192:195]
    v_mfma_f32_16x16x32_bf16 a[196:199], a[8:11], v[40:43], a[196:199]
    v_mfma_f32_16x16x32_bf16 a[196:199], a[12:15], v[44:47], a[196:199]
    buffer_load_dwordx4 v12, s[20:23], s63 offen offset:2048 lds
    v_mfma_f32_16x16x32_bf16 a[200:203], a[16:19], v[40:43], a[200:203]
    ds_read_b128 a[120:123], v22 offset:22528
    v_mov_b32 v22, v100
    v_mfma_f32_16x16x32_bf16 a[200:203], a[20:23], v[44:47], a[200:203]
    v_add_u32 v22, 0x10000, v22
    v_mfma_f32_16x16x32_bf16 a[204:207], a[24:27], v[40:43], a[204:207]
    v_mfma_f32_16x16x32_bf16 a[204:207], a[28:31], v[44:47], a[204:207]
    v_mfma_f32_16x16x32_bf16 a[208:211], a[32:35], v[40:43], a[208:211]
    ds_read_b128 a[124:127], v23 offset:22528
    v_mov_b32 v23, v101
    v_mfma_f32_16x16x32_bf16 a[208:211], a[36:39], v[44:47], a[208:211]
    v_add_u32 v23, 0x10000, v23
    v_mfma_f32_16x16x32_bf16 a[212:215], a[40:43], v[40:43], a[212:215]
    buffer_load_dwordx4 v13, s[20:23], s63 offen offset:3072 lds
    v_mfma_f32_16x16x32_bf16 a[212:215], a[44:47], v[44:47], a[212:215]
    v_mfma_f32_16x16x32_bf16 a[216:219], a[48:51], v[40:43], a[216:219]
    v_mfma_f32_16x16x32_bf16 a[216:219], a[52:55], v[44:47], a[216:219]
    v_mfma_f32_16x16x32_bf16 a[220:223], a[56:59], v[40:43], a[220:223]
    v_mfma_f32_16x16x32_bf16 a[220:223], a[60:63], v[44:47], a[220:223]
    v_mfma_f32_16x16x32_bf16 a[224:227], a[0:3], v[48:51], a[224:227]
    v_mfma_f32_16x16x32_bf16 a[224:227], a[4:7], v[52:55], a[224:227]
    s_xor_b32 s63, s63, 384
    v_mfma_f32_16x16x32_bf16 a[228:231], a[8:11], v[48:51], a[228:231]
    v_mfma_f32_16x16x32_bf16 a[228:231], a[12:15], v[52:55], a[228:231]
    v_mfma_f32_16x16x32_bf16 a[232:235], a[16:19], v[48:51], a[232:235]
    v_mfma_f32_16x16x32_bf16 a[232:235], a[20:23], v[52:55], a[232:235]
    s_add_u32 m0, s67, 98304
    s_waitcnt vmcnt(8) lgkmcnt(0)
    v_cmp_gt_u32 vcc, 8, v7
    s_nop 1
    s_and_b64 vcc, vcc, s[86:87]
    s_cbranch_scc1 SPIN_WA
BACK_WA:
    s_barrier
    v_mfma_f32_16x16x32_bf16 a[236:239], a[24:27], v[48:51], a[236:239]
    buffer_load_dwordx4 v1, s[28:31], s65 offen sc1 lds
    v_mfma_f32_16x16x32_bf16 a[236:239], a[28:31], v[52:55], a[236:239]
    ds_read_b64_tr_b16 v[56:57], v14 offset:0
    ds_read_b64_tr_b16 v[58:59], v14 offset:1024
    v_mfma_f32_16x16x32_bf16 a[240:243], a[32:35], v[48:51], a[240:243]
    ds_read_b64_tr_b16 v[60:61], v14 offset:8192
    ds_read_b64_tr_b16 v[62:63], v14 offset:9216
    v_mfma_f32_16x16x32_bf16 a[240:243], a[36:39], v[52:55], a[240:243]
    ds_read_b64_tr_b16 v[40:41], v15 offset:0
    ds_read_b64_tr_b16 v[42:43], v15 offset:1024
    v_mfma_f32_16x16x32_bf16 a[244:247], a[40:43], v[48:51], a[244:247]
    ds_read_b64_tr_b16 v[44:45], v15 offset:8192
    ds_read_b64_tr_b16 v[46:47], v15 offset:9216
    v_mfma_f32_16x16x32_bf16 a[244:247], a[44:47], v[52:55], a[244:247]
    v_mfma_f32_16x16x32_bf16 a[248:251], a[48:51], v[48:51], a[248:251]
    v_mfma_f32_16x16x32_bf16 a[248:251], a[52:55], v[52:55], a[248:251]
    v_mfma_f32_16x16x32_bf16 a[252:255], a[56:59], v[48:51], a[252:255]
    s_lshr_b32 s92, s2, 3
    buffer_load_dwordx4 v1, s[28:31], s65 offen offset:1024 sc1 lds
    v_mfma_f32_16x16x32_bf16 a[252:255], a[60:63], v[52:55], a[252:255]
    s_lshl2_add_u32 s92, s92, s4
    v_lshrrev_b32 v9, 4, v1
    v_min_u32 v9, 0, v9
    s_waitcnt lgkmcnt(0)
    v_mfma_f32_16x16x32_bf16 v[128:131], v[56:59], a[64:67], v[128:131]
    s_mul_i32 s92, s92, 1
    ds_read_b64_tr_b16 v[48:49], v16 offset:0
    ds_read_b64_tr_b16 v[50:51], v16 offset:1024
    v_mfma_f32_16x16x32_bf16 v[128:131], v[60:63], a[68:71], v[128:131]
    s_add_u32 s92, s92, 32
    v_add_lshl_u32 v9, v9, s92, 7
    ds_read_b64_tr_b16 v[52:53], v16 offset:8192
    v_mfma_f32_16x16x32_bf16 v[132:135], v[56:59], a[72:75], v[132:135]
    s_getpc_b64 s[92:93]
    global_load_dword v9, v9, s[92:93]
    v_mfma_f32_16x16x32_bf16 v[132:135], v[60:63], a[76:79], v[132:135]
    ds_read_b128 v[64:67], v24 offset:16384
    ds_read_b64_tr_b16 v[54:55], v16 offset:9216
    v_mfma_f32_16x16x32_bf16 v[136:139], v[56:59], a[80:83], v[136:139]
    v_cvt_pk_bf16_f32 v128, v128, v129
    v_cvt_pk_bf16_f32 v130, v130, v131
    v_mfma_f32_16x16x32_bf16 v[136:139], v[60:63], a[84:87], v[136:139]
    v_accvgpr_write_b32 a0, v128
    v_accvgpr_write_b32 a1, v130
    v_mfma_f32_16x16x32_bf16 v[140:143], v[56:59], a[88:91], v[140:143]
    s_add_u32 m0, s68, 106496
    v_cvt_pk_bf16_f32 v132, v132, v133
    v_cvt_pk_bf16_f32 v134, v134, v135
    v_mfma_f32_16x16x32_bf16 v[140:143], v[60:63], a[92:95], v[140:143]
    buffer_load_dwordx4 v6, s[20:23], s66 offen lds
    v_mfma_f32_16x16x32_bf16 v[144:147], v[56:59], a[96:99], v[144:147]
    v_accvgpr_write_b32 a8, v132
    v_accvgpr_write_b32 a9, v134
    v_mfma_f32_16x16x32_bf16 v[144:147], v[60:63], a[100:103], v[144:147]
    v_cvt_pk_bf16_f32 v136, v136, v137
    v_cvt_pk_bf16_f32 v138, v138, v139
    v_mfma_f32_16x16x32_bf16 v[148:151], v[56:59], a[104:107], v[148:151]
    v_accvgpr_write_b32 a16, v136
    v_accvgpr_write_b32 a17, v138
    v_mfma_f32_16x16x32_bf16 v[148:151], v[60:63], a[108:111], v[148:151]
    v_cvt_pk_bf16_f32 v140, v140, v141
    v_cvt_pk_bf16_f32 v142, v142, v143
    v_mfma_f32_16x16x32_bf16 v[152:155], v[56:59], a[112:115], v[152:155]
    v_accvgpr_write_b32 a24, v140
    v_accvgpr_write_b32 a25, v142
    v_mfma_f32_16x16x32_bf16 v[152:155], v[60:63], a[116:119], v[152:155]
    ds_read_b128 v[68:71], v25 offset:16384
    v_cvt_pk_bf16_f32 v144, v144, v145
    v_mfma_f32_16x16x32_bf16 v[156:159], v[56:59], a[120:123], v[156:159]
    s_add_u32 m0, s69, 114688
    ds_read_b64_tr_b16 v[56:57], v17 offset:0
    ds_read_b64_tr_b16 v[58:59], v17 offset:1024
    v_mfma_f32_16x16x32_bf16 v[156:159], v[60:63], a[124:127], v[156:159]
    s_xor_b32 s65, s65, 8192
    buffer_load_dwordx4 v10, s[20:23], s64 offen lds
    v_mfma_f32_16x16x32_bf16 v[160:163], v[40:43], a[64:67], v[160:163]
    s_xor_b32 s66, s66, 128
    ds_read_b64_tr_b16 v[60:61], v17 offset:8192
    ds_read_b64_tr_b16 v[62:63], v17 offset:9216
    v_mfma_f32_16x16x32_bf16 v[160:163], v[44:47], a[68:71], v[160:163]
    v_cvt_pk_bf16_f32 v146, v146, v147
    v_accvgpr_write_b32 a32, v144
    v_mfma_f32_16x16x32_bf16 v[164:167], v[40:43], a[72:75], v[164:167]
    v_accvgpr_write_b32 a33, v146
    v_cvt_pk_bf16_f32 v148, v148, v149
    v_mfma_f32_16x16x32_bf16 v[164:167], v[44:47], a[76:79], v[164:167]
    v_cvt_pk_bf16_f32 v150, v150, v151
    v_accvgpr_write_b32 a40, v148
    v_mfma_f32_16x16x32_bf16 v[168:171], v[40:43], a[80:83], v[168:171]
    v_cvt_pk_bf16_f32 v160, v160, v161
    v_cvt_pk_bf16_f32 v162, v162, v163
    v_mfma_f32_16x16x32_bf16 v[168:171], v[44:47], a[84:87], v[168:171]
    v_accvgpr_write_b32 a2, v160
    v_accvgpr_write_b32 a3, v162
    v_mfma_f32_16x16x32_bf16 v[172:175], v[40:43], a[88:91], v[172:175]
    v_cvt_pk_bf16_f32 v164, v164, v165
    v_cvt_pk_bf16_f32 v166, v166, v167
    v_mfma_f32_16x16x32_bf16 v[172:175], v[44:47], a[92:95], v[172:175]
    v_accvgpr_write_b32 a10, v164
    v_accvgpr_write_b32 a11, v166
    v_mfma_f32_16x16x32_bf16 v[176:179], v[40:43], a[96:99], v[176:179]
    buffer_load_dwordx4 v11, s[20:23], s64 offen offset:1024 lds
    v_mfma_f32_16x16x32_bf16 v[176:179], v[44:47], a[100:103], v[176:179]
    ds_read_b128 v[72:75], v24 offset:24576
    v_accvgpr_write_b32 a41, v150
    v_mfma_f32_16x16x32_bf16 v[180:183], v[40:43], a[104:107], v[180:183]
    v_cvt_pk_bf16_f32 v152, v152, v153
    v_cvt_pk_bf16_f32 v154, v154, v155
    v_mfma_f32_16x16x32_bf16 v[180:183], v[44:47], a[108:111], v[180:183]
    v_accvgpr_write_b32 a48, v152
    v_accvgpr_write_b32 a49, v154
    v_mfma_f32_16x16x32_bf16 v[184:187], v[40:43], a[112:115], v[184:187]
    v_cvt_pk_bf16_f32 v156, v156, v157
    v_cvt_pk_bf16_f32 v158, v158, v159
    v_mfma_f32_16x16x32_bf16 v[184:187], v[44:47], a[116:119], v[184:187]
    v_accvgpr_write_b32 a56, v156
    v_accvgpr_write_b32 a57, v158
    v_mfma_f32_16x16x32_bf16 v[188:191], v[40:43], a[120:123], v[188:191]
    ds_read_b64_tr_b16 v[40:41], v14 offset:32768
    ds_read_b64_tr_b16 v[42:43], v14 offset:33792
    v_mfma_f32_16x16x32_bf16 v[188:191], v[44:47], a[124:127], v[188:191]
    s_waitcnt lgkmcnt(2)
    ds_read_b64_tr_b16 v[44:45], v14 offset:40960
    ds_read_b64_tr_b16 v[46:47], v14 offset:41984
    v_mfma_f32_16x16x32_bf16 v[192:195], v[48:51], a[64:67], v[192:195]
    buffer_load_dwordx4 v12, s[20:23], s64 offen offset:2048 lds
    v_mfma_f32_16x16x32_bf16 v[192:195], v[52:55], a[68:71], v[192:195]
    v_xor_b32 v14, s73, v14
    v_add_u32 v14, 0x10000, v14
    v_mfma_f32_16x16x32_bf16 v[196:199], v[48:51], a[72:75], v[196:199]
    v_cvt_pk_bf16_f32 v168, v168, v169
    v_cvt_pk_bf16_f32 v170, v170, v171
    v_mfma_f32_16x16x32_bf16 v[196:199], v[52:55], a[76:79], v[196:199]
    ds_read_b128 v[76:79], v25 offset:24576
    v_accvgpr_write_b32 a18, v168
    v_mfma_f32_16x16x32_bf16 v[200:203], v[48:51], a[80:83], v[200:203]
    v_accvgpr_write_b32 a19, v170
    v_cvt_pk_bf16_f32 v172, v172, v173
    v_mfma_f32_16x16x32_bf16 v[200:203], v[52:55], a[84:87], v[200:203]
    v_cvt_pk_bf16_f32 v174, v174, v175
    v_accvgpr_write_b32 a26, v172
    v_mfma_f32_16x16x32_bf16 v[204:207], v[48:51], a[88:91], v[204:207]
    v_accvgpr_write_b32 a27, v174
    v_cvt_pk_bf16_f32 v176, v176, v177
    v_mfma_f32_16x16x32_bf16 v[204:207], v[52:55], a[92:95], v[204:207]
    v_cvt_pk_bf16_f32 v178, v178, v179
    v_accvgpr_write_b32 a34, v176
    v_mfma_f32_16x16x32_bf16 v[208:211], v[48:51], a[96:99], v[208:211]
    v_accvgpr_write_b32 a35, v178
    v_cvt_pk_bf16_f32 v180, v180, v181
    v_mfma_f32_16x16x32_bf16 v[208:211], v[52:55], a[100:103], v[208:211]
    buffer_load_dwordx4 v13, s[20:23], s64 offen offset:3072 lds
    v_mfma_f32_16x16x32_bf16 v[212:215], v[48:51], a[104:107], v[212:215]
    v_cvt_pk_bf16_f32 v182, v182, v183
    v_accvgpr_write_b32 a42, v180
    v_mfma_f32_16x16x32_bf16 v[212:215], v[52:55], a[108:111], v[212:215]
    v_accvgpr_write_b32 a43, v182
    v_cvt_pk_bf16_f32 v184, v184, v185
    v_mfma_f32_16x16x32_bf16 v[216:219], v[48:51], a[112:115], v[216:219]
    v_cvt_pk_bf16_f32 v186, v186, v187
    v_accvgpr_write_b32 a50, v184
    v_mfma_f32_16x16x32_bf16 v[216:219], v[52:55], a[116:119], v[216:219]
    v_accvgpr_write_b32 a51, v186
    v_cvt_pk_bf16_f32 v188, v188, v189
    v_mfma_f32_16x16x32_bf16 v[220:223], v[48:51], a[120:123], v[220:223]
    ds_read_b64_tr_b16 v[48:49], v15 offset:32768
    ds_read_b64_tr_b16 v[50:51], v15 offset:33792
    v_mfma_f32_16x16x32_bf16 v[220:223], v[52:55], a[124:127], v[220:223]
    ds_read_b64_tr_b16 v[52:53], v15 offset:40960
    ds_read_b64_tr_b16 v[54:55], v15 offset:41984
    v_mfma_f32_16x16x32_bf16 v[224:227], v[56:59], a[64:67], v[224:227]
    v_xor_b32 v15, s73, v15
    v_add_u32 v15, 0x10000, v15
    v_mfma_f32_16x16x32_bf16 v[224:227], v[60:63], a[68:71], v[224:227]
    s_xor_b32 s64, s64, 384
    v_cvt_pk_bf16_f32 v190, v190, v191
    v_accvgpr_write_b32 a58, v188
    v_mfma_f32_16x16x32_bf16 v[228:231], v[56:59], a[72:75], v[228:231]
    v_accvgpr_write_b32 a59, v190
    v_cvt_pk_bf16_f32 v192, v192, v193
    v_mfma_f32_16x16x32_bf16 v[228:231], v[60:63], a[76:79], v[228:231]
    v_cvt_pk_bf16_f32 v194, v194, v195
    v_accvgpr_write_b32 a4, v192
    v_mfma_f32_16x16x32_bf16 v[232:235], v[56:59], a[80:83], v[232:235]
    v_accvgpr_write_b32 a5, v194
    v_cvt_pk_bf16_f32 v196, v196, v197
    v_mfma_f32_16x16x32_bf16 v[232:235], v[60:63], a[84:87], v[232:235]
    s_add_u32 m0, s69, 131072
    v_cvt_pk_bf16_f32 v198, v198, v199
    v_accvgpr_write_b32 a12, v196
    v_mfma_f32_16x16x32_bf16 v[236:239], v[56:59], a[88:91], v[236:239]
    buffer_load_dwordx4 v2, s[24:27], s60 offen lds
    v_mfma_f32_16x16x32_bf16 v[236:239], v[60:63], a[92:95], v[236:239]
    v_accvgpr_write_b32 a13, v198
    v_cvt_pk_bf16_f32 v200, v200, v201
    v_mfma_f32_16x16x32_bf16 v[240:243], v[56:59], a[96:99], v[240:243]
    v_cvt_pk_bf16_f32 v202, v202, v203
    v_accvgpr_write_b32 a20, v200
    v_mfma_f32_16x16x32_bf16 v[240:243], v[60:63], a[100:103], v[240:243]
    v_accvgpr_write_b32 a21, v202
    v_cvt_pk_bf16_f32 v204, v204, v205
    v_mfma_f32_16x16x32_bf16 v[244:247], v[56:59], a[104:107], v[244:247]
    v_cvt_pk_bf16_f32 v206, v206, v207
    v_accvgpr_write_b32 a28, v204
    v_mfma_f32_16x16x32_bf16 v[244:247], v[60:63], a[108:111], v[244:247]
    v_accvgpr_write_b32 a29, v206
    v_cvt_pk_bf16_f32 v208, v208, v209
    v_mfma_f32_16x16x32_bf16 v[248:251], v[56:59], a[112:115], v[248:251]
    v_cvt_pk_bf16_f32 v210, v210, v211
    v_accvgpr_write_b32 a36, v208
    v_mfma_f32_16x16x32_bf16 v[248:251], v[60:63], a[116:119], v[248:251]
    buffer_load_dwordx4 v3, s[24:27], s60 offen offset:1024 lds
    v_mfma_f32_16x16x32_bf16 v[252:255], v[56:59], a[120:123], v[252:255]
    ds_read_b64_tr_b16 v[56:57], v16 offset:32768
    ds_read_b64_tr_b16 v[58:59], v16 offset:33792
    v_mfma_f32_16x16x32_bf16 v[252:255], v[60:63], a[124:127], v[252:255]
    s_waitcnt lgkmcnt(2)
    ds_read_b64_tr_b16 v[60:61], v16 offset:40960
    ds_read_b64_tr_b16 v[62:63], v16 offset:41984
    v_mfma_f32_16x16x32_bf16 a[128:131], a[64:67], v[40:43], a[128:131]
    v_xor_b32 v16, s73, v16
    v_add_u32 v16, 0x10000, v16
    v_mfma_f32_16x16x32_bf16 a[128:131], a[68:71], v[44:47], a[128:131]
    v_accvgpr_write_b32 a37, v210
    v_cvt_pk_bf16_f32 v212, v212, v213
    v_mfma_f32_16x16x32_bf16 a[132:135], a[72:75], v[40:43], a[132:135]
    ds_read_b128 v[80:83], v24 offset:49152
    v_cvt_pk_bf16_f32 v214, v214, v215
    v_mfma_f32_16x16x32_bf16 a[132:135], a[76:79], v[44:47], a[132:135]
    v_accvgpr_write_b32 a44, v212
    v_accvgpr_write_b32 a45, v214
    v_mfma_f32_16x16x32_bf16 a[136:139], a[80:83], v[40:43], a[136:139]
    v_cvt_pk_bf16_f32 v216, v216, v217
    v_cvt_pk_bf16_f32 v218, v218, v219
    v_mfma_f32_16x16x32_bf16 a[136:139], a[84:87], v[44:47], a[136:139]
    buffer_load_dwordx4 v4, s[24:27], s60 offen offset:2048 lds
    v_mfma_f32_16x16x32_bf16 a[140:143], a[88:91], v[40:43], a[140:143]
    v_accvgpr_write_b32 a52, v216
    v_accvgpr_write_b32 a53, v218
    v_mfma_f32_16x16x32_bf16 a[140:143], a[92:95], v[44:47], a[140:143]
    v_cvt_pk_bf16_f32 v220, v220, v221
    v_cvt_pk_bf16_f32 v222, v222, v223
    v_mfma_f32_16x16x32_bf16 a[144:147], a[96:99], v[40:43], a[144:147]
    v_accvgpr_write_b32 a60, v220
    v_accvgpr_write_b32 a61, v222
    v_mfma_f32_16x16x32_bf16 a[144:147], a[100:103], v[44:47], a[144:147]
    v_cvt_pk_bf16_f32 v224, v224, v225
    v_cvt_pk_bf16_f32 v226, v226, v227
    v_mfma_f32_16x16x32_bf16 a[148:151], a[104:107], v[40:43], a[148:151]
    v_accvgpr_write_b32 a6, v224
    v_accvgpr_write_b32 a7, v226
    v_mfma_f32_16x16x32_bf16 a[148:151], a[108:111], v[44:47], a[148:151]
    v_cvt_pk_bf16_f32 v228, v228, v229
    v_cvt_pk_bf16_f32 v230, v230, v231
    v_mfma_f32_16x16x32_bf16 a[152:155], a[112:115], v[40:43], a[152:155]
    buffer_load_dwordx4 v5, s[24:27], s60 offen offset:3072 lds
    v_mfma_f32_16x16x32_bf16 a[152:155], a[116:119], v[44:47], a[152:155]
    ds_read_b128 v[84:87], v25 offset:49152
    v_accvgpr_write_b32 a14, v228
    v_mfma_f32_16x16x32_bf16 a[156:159], a[120:123], v[40:43], a[156:159]
    ds_read_b64_tr_b16 v[40:41], v17 offset:32768
    ds_read_b64_tr_b16 v[42:43], v17 offset:33792
    v_mfma_f32_16x16x32_bf16 a[156:159], a[124:127], v[44:47], a[156:159]
    s_add_u32 s72, s70, 0
    ds_read_b64_tr_b16 v[44:45], v17 offset:40960
    ds_read_b64_tr_b16 v[46:47], v17 offset:41984
    v_mfma_f32_16x16x32_bf16 a[160:163], a[64:67], v[48:51], a[160:163]
    v_xor_b32 v17, s73, v17
    v_add_u32 v17, 0x10000, v17
    v_mfma_f32_16x16x32_bf16 a[160:163], a[68:71], v[52:55], a[160:163]
    buffer_store_dwordx4 a[0:3], v1, s[36:39], s72 offen sc1
    v_mfma_f32_16x16x32_bf16 a[164:167], a[72:75], v[48:51], a[164:167]
    v_accvgpr_write_b32 a15, v230
    v_cvt_pk_bf16_f32 v232, v232, v233
    v_mfma_f32_16x16x32_bf16 a[164:167], a[76:79], v[52:55], a[164:167]
    s_add_u32 m0, s69, 147456
    v_cvt_pk_bf16_f32 v234, v234, v235
    v_accvgpr_write_b32 a22, v232
    v_mfma_f32_16x16x32_bf16 a[168:171], a[80:83], v[48:51], a[168:171]
    s_xor_b32 s60, s60, 1572864
    buffer_load_dwordx4 v10, s[20:23], s63 offen lds
    v_mfma_f32_16x16x32_bf16 a[168:171], a[84:87], v[52:55], a[168:171]
    v_accvgpr_write_b32 a23, v234
    v_cvt_pk_bf16_f32 v236, v236, v237
    v_mfma_f32_16x16x32_bf16 a[172:175], a[88:91], v[48:51], a[172:175]
    v_cvt_pk_bf16_f32 v238, v238, v239
    v_accvgpr_write_b32 a30, v236
    v_mfma_f32_16x16x32_bf16 a[172:175], a[92:95], v[52:55], a[172:175]
    v_accvgpr_write_b32 a31, v238
    v_cvt_pk_bf16_f32 v240, v240, v241
    v_mfma_f32_16x16x32_bf16 a[176:179], a[96:99], v[48:51], a[176:179]
    ds_read_b128 v[88:91], v24 offset:57344
    v_cvt_pk_bf16_f32 v242, v242, v243
    v_mfma_f32_16x16x32_bf16 a[176:179], a[100:103], v[52:55], a[176:179]
    v_accvgpr_write_b32 a38, v240
    v_accvgpr_write_b32 a39, v242
    v_mfma_f32_16x16x32_bf16 a[180:183], a[104:107], v[48:51], a[180:183]
    v_cvt_pk_bf16_f32 v244, v244, v245
    v_cvt_pk_bf16_f32 v246, v246, v247
    v_mfma_f32_16x16x32_bf16 a[180:183], a[108:111], v[52:55], a[180:183]
    buffer_load_dwordx4 v11, s[20:23], s63 offen offset:1024 lds
    v_mfma_f32_16x16x32_bf16 a[184:187], a[112:115], v[48:51], a[184:187]
    v_accvgpr_write_b32 a46, v244
    v_accvgpr_write_b32 a47, v246
    v_mfma_f32_16x16x32_bf16 a[184:187], a[116:119], v[52:55], a[184:187]
    v_cvt_pk_bf16_f32 v248, v248, v249
    v_cvt_pk_bf16_f32 v250, v250, v251
    v_mfma_f32_16x16x32_bf16 a[188:191], a[120:123], v[48:51], a[188:191]
    v_accvgpr_write_b32 a54, v248
    v_accvgpr_write_b32 a55, v250
    v_mfma_f32_16x16x32_bf16 a[188:191], a[124:127], v[52:55], a[188:191]
    s_waitcnt lgkmcnt(0)
    v_cvt_pk_bf16_f32 v252, v252, v253
    v_cvt_pk_bf16_f32 v254, v254, v255
    v_mfma_f32_16x16x32_bf16 a[192:195], a[64:67], v[56:59], a[192:195]
    v_accvgpr_write_b32 a62, v252
    v_accvgpr_write_b32 a63, v254
    v_mfma_f32_16x16x32_bf16 a[192:195], a[68:71], v[60:63], a[192:195]
    v_accvgpr_write_b32 a0, 0
    v_accvgpr_write_b32 a1, 0
    v_mfma_f32_16x16x32_bf16 a[196:199], a[72:75], v[56:59], a[196:199]
    v_accvgpr_write_b32 a2, 0
    v_accvgpr_write_b32 a3, 0
    v_mfma_f32_16x16x32_bf16 a[196:199], a[76:79], v[60:63], a[196:199]
    buffer_load_dwordx4 v12, s[20:23], s63 offen offset:2048 lds
    v_mfma_f32_16x16x32_bf16 a[200:203], a[80:83], v[56:59], a[200:203]
    ds_read_b128 v[92:95], v25 offset:57344
    v_mfma_f32_16x16x32_bf16 a[200:203], a[84:87], v[60:63], a[200:203]
    s_add_u32 s72, s70, 4096
    v_mfma_f32_16x16x32_bf16 a[204:207], a[88:91], v[56:59], a[204:207]
    buffer_store_dwordx4 a[8:11], v1, s[36:39], s72 offen sc1
    v_mfma_f32_16x16x32_bf16 a[204:207], a[92:95], v[60:63], a[204:207]
    v_mfma_f32_16x16x32_bf16 a[208:211], a[96:99], v[56:59], a[208:211]
    v_accvgpr_write_b32 a8, 0
    v_accvgpr_write_b32 a9, 0
    v_mfma_f32_16x16x32_bf16 a[208:211], a[100:103], v[60:63], a[208:211]
    v_accvgpr_write_b32 a10, 0
    v_accvgpr_write_b32 a11, 0
    v_mfma_f32_16x16x32_bf16 a[212:215], a[104:107], v[56:59], a[212:215]
    buffer_load_dwordx4 v13, s[20:23], s63 offen offset:3072 lds
    v_mfma_f32_16x16x32_bf16 a[212:215], a[108:111], v[60:63], a[212:215]
    v_mfma_f32_16x16x32_bf16 a[216:219], a[112:115], v[56:59], a[216:219]
    v_mfma_f32_16x16x32_bf16 a[216:219], a[116:119], v[60:63], a[216:219]
    v_mfma_f32_16x16x32_bf16 a[220:223], a[120:123], v[56:59], a[220:223]
    v_mfma_f32_16x16x32_bf16 a[220:223], a[124:127], v[60:63], a[220:223]
    v_mfma_f32_16x16x32_bf16 a[224:227], a[64:67], v[40:43], a[224:227]
    v_mfma_f32_16x16x32_bf16 a[224:227], a[68:71], v[44:47], a[224:227]
    s_xor_b32 s63, s63, 128
    v_mfma_f32_16x16x32_bf16 a[228:231], a[72:75], v[40:43], a[228:231]
    v_accvgpr_read_b32 v32, a128
    v_accvgpr_read_b32 v31, a129
    v_mfma_f32_16x16x32_bf16 a[228:231], a[76:79], v[44:47], a[228:231]
    v_cvt_pk_bf16_f32 v32, v32, v31
    v_accvgpr_read_b32 v33, a130
    v_mfma_f32_16x16x32_bf16 a[232:235], a[80:83], v[40:43], a[232:235]
    v_accvgpr_read_b32 v31, a131
    v_cvt_pk_bf16_f32 v33, v33, v31
    v_mfma_f32_16x16x32_bf16 a[232:235], a[84:87], v[44:47], a[232:235]
    s_waitcnt vmcnt(10) lgkmcnt(0)
    s_barrier
    ds_read_b64_tr_b16 v[48:49], v14 offset:0
    v_mfma_f32_16x16x32_bf16 a[236:239], a[88:91], v[40:43], a[236:239]
    s_add_u32 m0, s67, 0
    ds_read_b64_tr_b16 v[50:51], v14 offset:1024
    ds_read_b64_tr_b16 v[52:53], v14 offset:8192
    v_mfma_f32_16x16x32_bf16 a[236:239], a[92:95], v[44:47], a[236:239]
    buffer_load_dwordx4 v1, s[28:31], s65 offen sc1 lds
    v_mfma_f32_16x16x32_bf16 a[240:243], a[96:99], v[40:43], a[240:243]
    ds_read_b64_tr_b16 v[54:55], v14 offset:9216
    ds_read_b64_tr_b16 v[56:57], v15 offset:0
    v_mfma_f32_16x16x32_bf16 a[240:243], a[100:103], v[44:47], a[240:243]
    ds_read_b64_tr_b16 v[58:59], v15 offset:1024
    ds_read_b64_tr_b16 v[60:61], v15 offset:8192
    v_mfma_f32_16x16x32_bf16 a[244:247], a[104:107], v[40:43], a[244:247]
    ds_read_b64_tr_b16 v[62:63], v15 offset:9216
    v_add_u32 v14, 0x10000, v14
    v_mfma_f32_16x16x32_bf16 a[244:247], a[108:111], v[44:47], a[244:247]
    s_add_u32 s72, s71, 0
    v_add_u32 v15, 0x10000, v15
    v_accvgpr_read_b32 v34, a132
    v_mfma_f32_16x16x32_bf16 a[248:251], a[112:115], v[40:43], a[248:251]
    v_accvgpr_read_b32 v31, a133
    v_cvt_pk_bf16_f32 v34, v34, v31
    v_mfma_f32_16x16x32_bf16 a[248:251], a[116:119], v[44:47], a[248:251]
    v_accvgpr_read_b32 v35, a134
    v_accvgpr_read_b32 v31, a135
    v_mfma_f32_16x16x32_bf16 a[252:255], a[120:123], v[40:43], a[252:255]
    buffer_load_dwordx4 v1, s[28:31], s65 offen offset:1024 sc1 lds
    v_mfma_f32_16x16x32_bf16 a[252:255], a[124:127], v[44:47], a[252:255]
    s_waitcnt lgkmcnt(0)
    ds_read_b64_tr_b16 v[40:41], v16 offset:0
    ds_read_b64_tr_b16 v[42:43], v16 offset:1024
    v_mfma_f32_16x16x32_bf16 v[128:131], v[48:51], v[64:67], 0
    ds_read_b64_tr_b16 v[44:45], v16 offset:8192
    ds_read_b64_tr_b16 v[46:47], v16 offset:9216
    v_mfma_f32_16x16x32_bf16 v[128:131], v[52:55], v[68:71], v[128:131]
    v_add_u32 v24, 0x10000, v24
    v_add_u32 v16, 0x10000, v16
    v_mfma_f32_16x16x32_bf16 v[132:135], v[48:51], v[72:75], 0
    ds_read_b128 v[96:99], v24 offset:16384
    v_cvt_pk_bf16_f32 v35, v35, v31
    v_mfma_f32_16x16x32_bf16 v[132:135], v[52:55], v[76:79], v[132:135]
    buffer_store_dwordx4 v[32:35], v1, s[36:39], s72 offen sc1
    v_mfma_f32_16x16x32_bf16 v[136:139], v[48:51], v[80:83], 0
    v_mfma_f32_16x16x32_bf16 v[136:139], v[52:55], v[84:87], v[136:139]
    v_mfma_f32_16x16x32_bf16 v[140:143], v[48:51], v[88:91], 0
    s_add_u32 m0, s68, 8192
    ds_read_b64_tr_b16 v[48:49], v17 offset:0
    ds_read_b64_tr_b16 v[50:51], v17 offset:1024
    v_mfma_f32_16x16x32_bf16 v[140:143], v[52:55], v[92:95], v[140:143]
    buffer_load_dwordx4 v6, s[20:23], s66 offen lds
    v_mfma_f32_16x16x32_bf16 v[144:147], v[56:59], v[64:67], 0
    ds_read_b64_tr_b16 v[52:53], v17 offset:8192
    ds_read_b64_tr_b16 v[54:55], v17 offset:9216
    v_mfma_f32_16x16x32_bf16 v[144:147], v[60:63], v[68:71], v[144:147]
    v_add_u32 v17, 0x10000, v17
    v_mfma_f32_16x16x32_bf16 v[148:151], v[56:59], v[72:75], 0
    v_mfma_f32_16x16x32_bf16 v[148:151], v[60:63], v[76:79], v[148:151]
    v_mfma_f32_16x16x32_bf16 v[152:155], v[56:59], v[80:83], 0
    v_add_u32 v25, 0x10000, v25
    v_mfma_f32_16x16x32_bf16 v[152:155], v[60:63], v[84:87], v[152:155]
    ds_read_b128 v[100:103], v25 offset:16384
    v_mfma_f32_16x16x32_bf16 v[156:159], v[56:59], v[88:91], 0
    s_add_u32 m0, s69, 16384
    ds_read_b64_tr_b16 v[56:57], v18 offset:0
    ds_read_b64_tr_b16 v[58:59], v18 offset:1024
    v_mfma_f32_16x16x32_bf16 v[156:159], v[60:63], v[92:95], v[156:159]
    s_xor_b32 s65, s65, 24576
    buffer_load_dwordx4 v10, s[20:23], s64 offen lds
    s_waitcnt lgkmcnt(3)
    v_mfma_f32_16x16x32_bf16 v[160:163], v[40:43], v[64:67], 0
    s_xor_b32 s66, s66, 384
    ds_read_b64_tr_b16 v[60:61], v18 offset:8192
    ds_read_b64_tr_b16 v[62:63], v18 offset:9216
    v_mfma_f32_16x16x32_bf16 v[160:163], v[44:47], v[68:71], v[160:163]
    s_add_u32 s72, s70, 8192
    v_add_u32 v18, 0x10000, v18
    v_mfma_f32_16x16x32_bf16 v[164:167], v[40:43], v[72:75], 0
    buffer_store_dwordx4 a[16:19], v1, s[36:39], s72 offen sc1
    v_mfma_f32_16x16x32_bf16 v[164:167], v[44:47], v[76:79], v[164:167]
    v_mfma_f32_16x16x32_bf16 v[168:171], v[40:43], v[80:83], 0
    v_accvgpr_write_b32 a16, 0
    v_accvgpr_write_b32 a17, 0
    v_mfma_f32_16x16x32_bf16 v[168:171], v[44:47], v[84:87], v[168:171]
    v_accvgpr_write_b32 a18, 0
    v_accvgpr_write_b32 a19, 0
    v_mfma_f32_16x16x32_bf16 v[172:175], v[40:43], v[88:91], 0
    ds_read_b64_tr_b16 v[40:41], v19 offset:0
    ds_read_b64_tr_b16 v[42:43], v19 offset:1024
    v_mfma_f32_16x16x32_bf16 v[172:175], v[44:47], v[92:95], v[172:175]
    ds_read_b64_tr_b16 v[44:45], v19 offset:8192
    ds_read_b64_tr_b16 v[46:47], v19 offset:9216
    v_mfma_f32_16x16x32_bf16 v[176:179], v[48:51], v[64:67], 0
    buffer_load_dwordx4 v11, s[20:23], s64 offen offset:1024 lds
    v_mfma_f32_16x16x32_bf16 v[176:179], v[52:55], v[68:71], v[176:179]
    ds_read_b128 v[104:107], v24 offset:24576
    v_add_u32 v19, 0x10000, v19
    v_mfma_f32_16x16x32_bf16 v[180:183], v[48:51], v[72:75], 0
    v_mfma_f32_16x16x32_bf16 v[180:183], v[52:55], v[76:79], v[180:183]
    v_mfma_f32_16x16x32_bf16 v[184:187], v[48:51], v[80:83], 0
    v_mfma_f32_16x16x32_bf16 v[184:187], v[52:55], v[84:87], v[184:187]
    v_mfma_f32_16x16x32_bf16 v[188:191], v[48:51], v[88:91], 0
    ds_read_b64_tr_b16 v[48:49], v20 offset:0
    ds_read_b64_tr_b16 v[50:51], v20 offset:1024
    v_mfma_f32_16x16x32_bf16 v[188:191], v[52:55], v[92:95], v[188:191]
    s_waitcnt lgkmcnt(2)
    ds_read_b64_tr_b16 v[52:53], v20 offset:8192
    ds_read_b64_tr_b16 v[54:55], v20 offset:9216
    v_mfma_f32_16x16x32_bf16 v[192:195], v[56:59], v[64:67], 0
    buffer_load_dwordx4 v12, s[20:23], s64 offen offset:2048 lds
    v_mfma_f32_16x16x32_bf16 v[192:195], v[60:63], v[68:71], v[192:195]
    v_add_u32 v20, 0x10000, v20
    v_accvgpr_read_b32 v32, a136
    v_mfma_f32_16x16x32_bf16 v[196:199], v[56:59], v[72:75], 0
    v_accvgpr_read_b32 v31, a137
    v_cvt_pk_bf16_f32 v32, v32, v31
    v_mfma_f32_16x16x32_bf16 v[196:199], v[60:63], v[76:79], v[196:199]
    ds_read_b128 v[108:111], v25 offset:24576
    v_accvgpr_read_b32 v33, a138
    v_mfma_f32_16x16x32_bf16 v[200:203], v[56:59], v[80:83], 0
    v_accvgpr_read_b32 v31, a139
    ds_read_b128 a[136:139], v22 offset:32768
    v_mfma_f32_16x16x32_bf16 v[200:203], v[60:63], v[84:87], v[200:203]
    v_add_u32 v22, 0xffff0000, v22
    v_cvt_pk_bf16_f32 v33, v33, v31
    v_mfma_f32_16x16x32_bf16 v[204:207], v[56:59], v[88:91], 0
    ds_read_b64_tr_b16 v[56:57], v21 offset:0
    ds_read_b64_tr_b16 v[58:59], v21 offset:1024
    v_mfma_f32_16x16x32_bf16 v[204:207], v[60:63], v[92:95], v[204:207]
    s_add_u32 s72, s71, 1024
    ds_read_b64_tr_b16 v[60:61], v21 offset:8192
    ds_read_b64_tr_b16 v[62:63], v21 offset:9216
    v_mfma_f32_16x16x32_bf16 v[208:211], v[40:43], v[64:67], 0
    v_add_u32 v21, 0x10000, v21
    v_accvgpr_read_b32 v34, a140
    v_mfma_f32_16x16x32_bf16 v[208:211], v[44:47], v[68:71], v[208:211]
    buffer_load_dwordx4 v13, s[20:23], s64 offen offset:3072 lds
    v_mfma_f32_16x16x32_bf16 v[212:215], v[40:43], v[72:75], 0
    v_accvgpr_read_b32 v31, a141
    v_cvt_pk_bf16_f32 v34, v34, v31
    v_mfma_f32_16x16x32_bf16 v[212:215], v[44:47], v[76:79], v[212:215]
    v_accvgpr_read_b32 v35, a142
    v_accvgpr_read_b32 v31, a143
    v_mfma_f32_16x16x32_bf16 v[216:219], v[40:43], v[80:83], 0
    ds_read_b128 a[140:143], v23 offset:32768
    v_add_u32 v23, 0xffff0000, v23
    v_mfma_f32_16x16x32_bf16 v[216:219], v[44:47], v[84:87], v[216:219]
    v_cvt_pk_bf16_f32 v35, v35, v31
    v_mfma_f32_16x16x32_bf16 v[220:223], v[40:43], v[88:91], 0
    ds_read_b64_tr_b16 v[40:41], v26 offset:32768
    ds_read_b64_tr_b16 v[42:43], v26 offset:33280
    v_mfma_f32_16x16x32_bf16 v[220:223], v[44:47], v[92:95], v[220:223]
    s_waitcnt lgkmcnt(3)
    ds_read_b64_tr_b16 v[44:45], v26 offset:36864
    ds_read_b64_tr_b16 v[46:47], v26 offset:37376
    v_mfma_f32_16x16x32_bf16 v[224:227], v[48:51], v[64:67], 0
    buffer_store_dwordx4 v[32:35], v1, s[36:39], s72 offen sc1
    v_mfma_f32_16x16x32_bf16 v[224:227], v[52:55], v[68:71], v[224:227]
    s_xor_b32 s64, s64, 128
    v_add_u32 v26, 0xffff0000, v26
    v_mfma_f32_16x16x32_bf16 v[228:231], v[48:51], v[72:75], 0
    v_mfma_f32_16x16x32_bf16 v[228:231], v[52:55], v[76:79], v[228:231]
    v_mfma_f32_16x16x32_bf16 v[232:235], v[48:51], v[80:83], 0
    v_mfma_f32_16x16x32_bf16 v[232:235], v[52:55], v[84:87], v[232:235]
    s_add_u32 m0, s69, 32768
    v_mfma_f32_16x16x32_bf16 v[236:239], v[48:51], v[88:91], 0
    buffer_load_dwordx4 v2, s[24:27], s60 offen lds
    v_mfma_f32_16x16x32_bf16 v[236:239], v[52:55], v[92:95], v[236:239]
    ds_read_b64_tr_b16 v[48:49], v27 offset:32768
    ds_read_b64_tr_b16 v[50:51], v27 offset:33280
    v_mfma_f32_16x16x32_bf16 v[240:243], v[56:59], v[64:67], 0
    ds_read_b64_tr_b16 v[52:53], v27 offset:36864
    ds_read_b64_tr_b16 v[54:55], v27 offset:37376
    v_mfma_f32_16x16x32_bf16 v[240:243], v[60:63], v[68:71], v[240:243]
    v_add_u32 v27, 0xffff0000, v27
    v_mfma_f32_16x16x32_bf16 v[244:247], v[56:59], v[72:75], 0
    buffer_load_dwordx4 v3, s[24:27], s60 offen offset:1024 lds
    v_mfma_f32_16x16x32_bf16 v[244:247], v[60:63], v[76:79], v[244:247]
    v_mfma_f32_16x16x32_bf16 v[248:251], v[56:59], v[80:83], 0
    v_mfma_f32_16x16x32_bf16 v[248:251], v[60:63], v[84:87], v[248:251]
    s_add_u32 s72, s70, 12288
    v_mfma_f32_16x16x32_bf16 v[252:255], v[56:59], v[88:91], 0
    buffer_load_dwordx4 v4, s[24:27], s60 offen offset:2048 lds
    v_mfma_f32_16x16x32_bf16 v[252:255], v[60:63], v[92:95], v[252:255]
    s_waitcnt lgkmcnt(0)
    ds_read_b64_tr_b16 v[56:57], v28 offset:32768
    ds_read_b64_tr_b16 v[58:59], v28 offset:33280
    v_mfma_f32_16x16x32_bf16 a[64:67], v[40:43], v[64:67], 0
    ds_read_b64_tr_b16 v[60:61], v28 offset:36864
    ds_read_b64_tr_b16 v[62:63], v28 offset:37376
    v_mfma_f32_16x16x32_bf16 a[64:67], v[44:47], v[68:71], a[64:67]
    buffer_store_dwordx4 a[24:27], v1, s[36:39], s72 offen sc1
    v_mfma_f32_16x16x32_bf16 a[68:71], v[40:43], v[72:75], 0
    buffer_load_dwordx4 v5, s[24:27], s60 offen offset:3072 lds
    v_mfma_f32_16x16x32_bf16 a[68:71], v[44:47], v[76:79], a[68:71]
    ds_read_b128 v[112:115], v24 offset:49152
    v_add_u32 v28, 0xffff0000, v28
    v_mfma_f32_16x16x32_bf16 a[72:75], v[40:43], v[80:83], 0
    v_accvgpr_write_b32 a24, 0
    v_accvgpr_write_b32 a25, 0
    v_mfma_f32_16x16x32_bf16 a[72:75], v[44:47], v[84:87], a[72:75]
    s_add_u32 m0, s69, 49152
    v_accvgpr_write_b32 a26, 0
    v_accvgpr_write_b32 a27, 0
    v_mfma_f32_16x16x32_bf16 a[76:79], v[40:43], v[88:91], 0
    s_xor_b32 s60, s60, 524288
    buffer_load_dwordx4 v10, s[20:23], s63 offen lds
    v_mfma_f32_16x16x32_bf16 a[76:79], v[44:47], v[92:95], a[76:79]
    ds_read_b128 v[116:119], v25 offset:49152
    v_mfma_f32_16x16x32_bf16 a[128:131], v[40:43], a[136:139], 0
    ds_read_b64_tr_b16 v[40:41], v29 offset:32768
    ds_read_b64_tr_b16 v[42:43], v29 offset:33280
    v_mfma_f32_16x16x32_bf16 a[128:131], v[44:47], a[140:143], a[128:131]
    ds_read_b64_tr_b16 v[44:45], v29 offset:36864
    ds_read_b64_tr_b16 v[46:47], v29 offset:37376
    v_mfma_f32_16x16x32_bf16 a[80:83], v[48:51], v[64:67], 0
    buffer_load_dwordx4 v11, s[20:23], s63 offen offset:1024 lds
    v_mfma_f32_16x16x32_bf16 a[80:83], v[52:55], v[68:71], a[80:83]
    ds_read_b128 v[120:123], v24 offset:57344
    v_add_u32 v29, 0xffff0000, v29
    v_mfma_f32_16x16x32_bf16 a[84:87], v[48:51], v[72:75], 0
    v_mfma_f32_16x16x32_bf16 a[84:87], v[52:55], v[76:79], a[84:87]
    v_mfma_f32_16x16x32_bf16 a[88:91], v[48:51], v[80:83], 0
    buffer_load_dwordx4 v12, s[20:23], s63 offen offset:2048 lds
    v_mfma_f32_16x16x32_bf16 a[88:91], v[52:55], v[84:87], a[88:91]
    ds_read_b128 v[124:127], v25 offset:57344
    v_mfma_f32_16x16x32_bf16 a[92:95], v[48:51], v[88:91], 0
    v_mfma_f32_16x16x32_bf16 a[92:95], v[52:55], v[92:95], a[92:95]
    v_mfma_f32_16x16x32_bf16 a[132:135], v[48:51], a[136:139], 0
    buffer_load_dwordx4 v13, s[20:23], s63 offen offset:3072 lds
    v_mfma_f32_16x16x32_bf16 a[132:135], v[52:55], a[140:143], a[132:135]
    s_add_u32 s72, s70, 32768
    s_waitcnt lgkmcnt(1)
    v_mfma_f32_16x16x32_bf16 a[96:99], v[56:59], v[64:67], 0
    v_mfma_f32_16x16x32_bf16 a[96:99], v[60:63], v[68:71], a[96:99]
    s_xor_b32 s63, s63, 896
    v_mfma_f32_16x16x32_bf16 a[100:103], v[56:59], v[72:75], 0
    buffer_store_dwordx4 a[32:35], v1, s[36:39], s72 offen sc1
    v_mfma_f32_16x16x32_bf16 a[100:103], v[60:63], v[76:79], a[100:103]
    v_mfma_f32_16x16x32_bf16 a[104:107], v[56:59], v[80:83], 0
    v_accvgpr_write_b32 a32, 0
    v_accvgpr_write_b32 a33, 0
    v_mfma_f32_16x16x32_bf16 a[104:107], v[60:63], v[84:87], a[104:107]
    s_waitcnt vmcnt(11) lgkmcnt(0)
    s_barrier
    ds_read_b64_tr_b16 v[48:49], v14 offset:0
    v_mfma_f32_16x16x32_bf16 a[108:111], v[56:59], v[88:91], 0
    s_add_u32 m0, s67, 65536
    ds_read_b64_tr_b16 v[50:51], v14 offset:1024
    ds_read_b64_tr_b16 v[52:53], v14 offset:8192
    v_mfma_f32_16x16x32_bf16 a[108:111], v[60:63], v[92:95], a[108:111]
    buffer_load_dwordx4 v1, s[28:31], s65 offen sc1 lds
    v_mfma_f32_16x16x32_bf16 a[112:115], v[40:43], v[64:67], 0
    ds_read_b64_tr_b16 v[54:55], v14 offset:9216
    ds_read_b64_tr_b16 v[56:57], v15 offset:0
    v_mfma_f32_16x16x32_bf16 a[112:115], v[44:47], v[68:71], a[112:115]
    ds_read_b64_tr_b16 v[58:59], v15 offset:1024
    ds_read_b64_tr_b16 v[60:61], v15 offset:8192
    v_mfma_f32_16x16x32_bf16 a[116:119], v[40:43], v[72:75], 0
    ds_read_b64_tr_b16 v[62:63], v15 offset:9216
    ds_read_b128 a[136:139], v22 offset:0
    v_mfma_f32_16x16x32_bf16 a[116:119], v[44:47], v[76:79], a[116:119]
    ds_read_b128 a[140:143], v23 offset:0
    v_add_u32 v14, 0xfffe0000, v14
    v_mfma_f32_16x16x32_bf16 a[120:123], v[40:43], v[80:83], 0
    v_add_u32 v15, 0xfffe0000, v15
    v_add_u32 v22, 0x10000, v22
    v_mfma_f32_16x16x32_bf16 a[120:123], v[44:47], v[84:87], a[120:123]
    v_add_u32 v23, 0x10000, v23
    v_accvgpr_write_b32 a34, 0
    v_mfma_f32_16x16x32_bf16 a[124:127], v[40:43], v[88:91], 0
    buffer_load_dwordx4 v1, s[28:31], s65 offen offset:1024 sc1 lds
    v_mfma_f32_16x16x32_bf16 a[124:127], v[44:47], v[92:95], a[124:127]
    s_waitcnt lgkmcnt(1)
    ds_read_b64_tr_b16 v[40:41], v16 offset:0
    ds_read_b64_tr_b16 v[42:43], v16 offset:1024
    v_mfma_f32_16x16x32_bf16 v[128:131], v[48:51], v[96:99], v[128:131]
    ds_read_b64_tr_b16 v[44:45], v16 offset:8192
    ds_read_b64_tr_b16 v[46:47], v16 offset:9216
    v_mfma_f32_16x16x32_bf16 v[128:131], v[52:55], v[100:103], v[128:131]
    v_add_u32 v24, 0x10000, v24
    v_add_u32 v16, 0xfffe0000, v16
    v_mfma_f32_16x16x32_bf16 v[132:135], v[48:51], v[104:107], v[132:135]
    ds_read_b128 v[64:67], v24 offset:16384
    v_accvgpr_write_b32 a35, 0
    v_mfma_f32_16x16x32_bf16 v[132:135], v[52:55], v[108:111], v[132:135]
    v_mfma_f32_16x16x32_bf16 v[136:139], v[48:51], v[112:115], v[136:139]
    v_mfma_f32_16x16x32_bf16 v[136:139], v[52:55], v[116:119], v[136:139]
    s_add_u32 s72, s70, 36864
    v_mfma_f32_16x16x32_bf16 v[140:143], v[48:51], v[120:123], v[140:143]
    s_add_u32 m0, s68, 73728
    ds_read_b64_tr_b16 v[48:49], v17 offset:0
    ds_read_b64_tr_b16 v[50:51], v17 offset:1024
    v_mfma_f32_16x16x32_bf16 v[140:143], v[52:55], v[124:127], v[140:143]
    buffer_load_dwordx4 v6, s[20:23], s66 offen lds
    v_mfma_f32_16x16x32_bf16 v[144:147], v[56:59], v[96:99], v[144:147]
    ds_read_b64_tr_b16 v[52:53], v17 offset:8192
    ds_read_b64_tr_b16 v[54:55], v17 offset:9216
    v_mfma_f32_16x16x32_bf16 v[144:147], v[60:63], v[100:103], v[144:147]
    buffer_store_dwordx4 a[40:43], v1, s[36:39], s72 offen sc1
    v_mfma_f32_16x16x32_bf16 v[148:151], v[56:59], v[104:107], v[148:151]
    v_add_u32 v17, 0xfffe0000, v17
    v_accvgpr_write_b32 a40, 0
    v_mfma_f32_16x16x32_bf16 v[148:151], v[60:63], v[108:111], v[148:151]
    v_accvgpr_write_b32 a41, 0
    v_accvgpr_write_b32 a42, 0
    v_mfma_f32_16x16x32_bf16 v[152:155], v[56:59], v[112:115], v[152:155]
    v_add_u32 v25, 0x10000, v25
    v_accvgpr_write_b32 a43, 0
    v_mfma_f32_16x16x32_bf16 v[152:155], v[60:63], v[116:119], v[152:155]
    ds_read_b128 v[68:71], v25 offset:16384
    v_mfma_f32_16x16x32_bf16 v[156:159], v[56:59], v[120:123], v[156:159]
    s_add_u32 m0, s69, 81920
    ds_read_b64_tr_b16 v[56:57], v18 offset:0
    ds_read_b64_tr_b16 v[58:59], v18 offset:1024
    v_mfma_f32_16x16x32_bf16 v[156:159], v[60:63], v[124:127], v[156:159]
    s_xor_b32 s65, s65, 8192
    buffer_load_dwordx4 v10, s[20:23], s64 offen lds
    s_waitcnt lgkmcnt(3)
    v_mfma_f32_16x16x32_bf16 v[160:163], v[40:43], v[96:99], v[160:163]
    s_xor_b32 s66, s66, 128
    ds_read_b64_tr_b16 v[60:61], v18 offset:8192
    ds_read_b64_tr_b16 v[62:63], v18 offset:9216
    v_mfma_f32_16x16x32_bf16 v[160:163], v[44:47], v[100:103], v[160:163]
    v_add_u32 v18, 0xfffe0000, v18
    v_mfma_f32_16x16x32_bf16 v[164:167], v[40:43], v[104:107], v[164:167]
    v_mfma_f32_16x16x32_bf16 v[164:167], v[44:47], v[108:111], v[164:167]
    v_mfma_f32_16x16x32_bf16 v[168:171], v[40:43], v[112:115], v[168:171]
    v_mfma_f32_16x16x32_bf16 v[168:171], v[44:47], v[116:119], v[168:171]
    v_mfma_f32_16x16x32_bf16 v[172:175], v[40:43], v[120:123], v[172:175]
    ds_read_b64_tr_b16 v[40:41], v19 offset:0
    ds_read_b64_tr_b16 v[42:43], v19 offset:1024
    v_mfma_f32_16x16x32_bf16 v[172:175], v[44:47], v[124:127], v[172:175]
    ds_read_b64_tr_b16 v[44:45], v19 offset:8192
    ds_read_b64_tr_b16 v[46:47], v19 offset:9216
    v_mfma_f32_16x16x32_bf16 v[176:179], v[48:51], v[96:99], v[176:179]
    buffer_load_dwordx4 v11, s[20:23], s64 offen offset:1024 lds
    v_mfma_f32_16x16x32_bf16 v[176:179], v[52:55], v[100:103], v[176:179]
    ds_read_b128 v[72:75], v24 offset:24576
    v_add_u32 v19, 0xfffe0000, v19
    v_mfma_f32_16x16x32_bf16 v[180:183], v[48:51], v[104:107], v[180:183]
    v_mfma_f32_16x16x32_bf16 v[180:183], v[52:55], v[108:111], v[180:183]
    s_add_u32 s72, s70, 40960
    v_mfma_f32_16x16x32_bf16 v[184:187], v[48:51], v[112:115], v[184:187]
    buffer_store_dwordx4 a[48:51], v1, s[36:39], s72 offen sc1
    v_mfma_f32_16x16x32_bf16 v[184:187], v[52:55], v[116:119], v[184:187]
    v_mfma_f32_16x16x32_bf16 v[188:191], v[48:51], v[120:123], v[188:191]
    ds_read_b64_tr_b16 v[48:49], v20 offset:0
    ds_read_b64_tr_b16 v[50:51], v20 offset:1024
    v_mfma_f32_16x16x32_bf16 v[188:191], v[52:55], v[124:127], v[188:191]
    s_waitcnt lgkmcnt(2)
    ds_read_b64_tr_b16 v[52:53], v20 offset:8192
    ds_read_b64_tr_b16 v[54:55], v20 offset:9216
    v_mfma_f32_16x16x32_bf16 v[192:195], v[56:59], v[96:99], v[192:195]
    buffer_load_dwordx4 v12, s[20:23], s64 offen offset:2048 lds
    v_mfma_f32_16x16x32_bf16 v[192:195], v[60:63], v[100:103], v[192:195]
    v_add_u32 v20, 0xfffe0000, v20
    v_accvgpr_write_b32 a48, 0
    v_mfma_f32_16x16x32_bf16 v[196:199], v[56:59], v[104:107], v[196:199]
    v_accvgpr_write_b32 a49, 0
    v_accvgpr_write_b32 a50, 0
    v_mfma_f32_16x16x32_bf16 v[196:199], v[60:63], v[108:111], v[196:199]
    ds_read_b128 v[76:79], v25 offset:24576
    v_accvgpr_write_b32 a51, 0
    v_mfma_f32_16x16x32_bf16 v[200:203], v[56:59], v[112:115], v[200:203]
    v_mfma_f32_16x16x32_bf16 v[200:203], v[60:63], v[116:119], v[200:203]
    v_mfma_f32_16x16x32_bf16 v[204:207], v[56:59], v[120:123], v[204:207]
    ds_read_b64_tr_b16 v[56:57], v21 offset:0
    ds_read_b64_tr_b16 v[58:59], v21 offset:1024
    v_mfma_f32_16x16x32_bf16 v[204:207], v[60:63], v[124:127], v[204:207]
    ds_read_b64_tr_b16 v[60:61], v21 offset:8192
    ds_read_b64_tr_b16 v[62:63], v21 offset:9216
    v_mfma_f32_16x16x32_bf16 v[208:211], v[40:43], v[96:99], v[208:211]
    v_add_u32 v21, 0xfffe0000, v21
    v_mfma_f32_16x16x32_bf16 v[208:211], v[44:47], v[100:103], v[208:211]
    buffer_load_dwordx4 v13, s[20:23], s64 offen offset:3072 lds
    v_mfma_f32_16x16x32_bf16 v[212:215], v[40:43], v[104:107], v[212:215]
    v_mfma_f32_16x16x32_bf16 v[212:215], v[44:47], v[108:111], v[212:215]
    v_mfma_f32_16x16x32_bf16 v[216:219], v[40:43], v[112:115], v[216:219]
    v_mfma_f32_16x16x32_bf16 v[216:219], v[44:47], v[116:119], v[216:219]
    v_mfma_f32_16x16x32_bf16 v[220:223], v[40:43], v[120:123], v[220:223]
    ds_read_b64_tr_b16 v[40:41], v26 offset:0
    ds_read_b64_tr_b16 v[42:43], v26 offset:512
    v_mfma_f32_16x16x32_bf16 v[220:223], v[44:47], v[124:127], v[220:223]
    s_waitcnt lgkmcnt(2)
    ds_read_b64_tr_b16 v[44:45], v26 offset:4096
    ds_read_b64_tr_b16 v[46:47], v26 offset:4608
    v_mfma_f32_16x16x32_bf16 v[224:227], v[48:51], v[96:99], v[224:227]
    v_add_u32 v26, 0x10000, v26
    v_mfma_f32_16x16x32_bf16 v[224:227], v[52:55], v[100:103], v[224:227]
    s_xor_b32 s64, s64, 896
    v_mfma_f32_16x16x32_bf16 v[228:231], v[48:51], v[104:107], v[228:231]
    s_add_u32 s72, s70, 45056
    buffer_store_dwordx4 a[56:59], v1, s[36:39], s72 offen sc1
    v_mfma_f32_16x16x32_bf16 v[228:231], v[52:55], v[108:111], v[228:231]
    v_mfma_f32_16x16x32_bf16 v[232:235], v[48:51], v[112:115], v[232:235]
    v_accvgpr_write_b32 a56, 0
    v_accvgpr_write_b32 a57, 0
    v_mfma_f32_16x16x32_bf16 v[232:235], v[52:55], v[116:119], v[232:235]
    s_add_u32 m0, s69, 98304
    v_accvgpr_write_b32 a58, 0
    v_accvgpr_write_b32 a59, 0
    v_mfma_f32_16x16x32_bf16 v[236:239], v[48:51], v[120:123], v[236:239]
    buffer_load_dwordx4 v2, s[24:27], s60 offen lds
    v_mfma_f32_16x16x32_bf16 v[236:239], v[52:55], v[124:127], v[236:239]
    ds_read_b64_tr_b16 v[48:49], v27 offset:0
    ds_read_b64_tr_b16 v[50:51], v27 offset:512
    v_mfma_f32_16x16x32_bf16 v[240:243], v[56:59], v[96:99], v[240:243]
    ds_read_b64_tr_b16 v[52:53], v27 offset:4096
    ds_read_b64_tr_b16 v[54:55], v27 offset:4608
    v_mfma_f32_16x16x32_bf16 v[240:243], v[60:63], v[100:103], v[240:243]
    v_add_u32 v27, 0x10000, v27
    v_mfma_f32_16x16x32_bf16 v[244:247], v[56:59], v[104:107], v[244:247]
    buffer_load_dwordx4 v3, s[24:27], s60 offen offset:1024 lds
    v_mfma_f32_16x16x32_bf16 v[244:247], v[60:63], v[108:111], v[244:247]
    v_mfma_f32_16x16x32_bf16 v[248:251], v[56:59], v[112:115], v[248:251]
    v_mfma_f32_16x16x32_bf16 v[248:251], v[60:63], v[116:119], v[248:251]
    v_mfma_f32_16x16x32_bf16 v[252:255], v[56:59], v[120:123], v[252:255]
    buffer_load_dwordx4 v4, s[24:27], s60 offen offset:2048 lds
    v_mfma_f32_16x16x32_bf16 v[252:255], v[60:63], v[124:127], v[252:255]
    s_waitcnt lgkmcnt(0)
    ds_read_b64_tr_b16 v[56:57], v28 offset:0
    ds_read_b64_tr_b16 v[58:59], v28 offset:512
    v_mfma_f32_16x16x32_bf16 a[64:67], v[40:43], v[96:99], a[64:67]
    ds_read_b64_tr_b16 v[60:61], v28 offset:4096
    ds_read_b64_tr_b16 v[62:63], v28 offset:4608
    v_mfma_f32_16x16x32_bf16 a[64:67], v[44:47], v[100:103], a[64:67]
    v_add_u32 v24, 0xfffe0000, v24
    v_add_u32 v28, 0x10000, v28
    v_mfma_f32_16x16x32_bf16 a[68:71], v[40:43], v[104:107], a[68:71]
    buffer_load_dwordx4 v5, s[24:27], s60 offen offset:3072 lds
    v_mfma_f32_16x16x32_bf16 a[68:71], v[44:47], v[108:111], a[68:71]
    ds_read_b128 v[80:83], v24 offset:16384
    v_mfma_f32_16x16x32_bf16 a[72:75], v[40:43], v[112:115], a[72:75]
    v_mfma_f32_16x16x32_bf16 a[72:75], v[44:47], v[116:119], a[72:75]
    s_add_u32 m0, s69, 114688
    v_add_u32 v25, 0xfffe0000, v25
    v_mfma_f32_16x16x32_bf16 a[76:79], v[40:43], v[120:123], a[76:79]
    s_xor_b32 s60, s60, 3670016
    buffer_load_dwordx4 v10, s[20:23], s63 offen lds
    v_mfma_f32_16x16x32_bf16 a[76:79], v[44:47], v[124:127], a[76:79]
    s_add_u32 s72, s70, 1024
    ds_read_b128 v[84:87], v25 offset:16384
    v_mfma_f32_16x16x32_bf16 a[128:131], v[40:43], a[136:139], a[128:131]
    ds_read_b64_tr_b16 v[40:41], v29 offset:0
    ds_read_b64_tr_b16 v[42:43], v29 offset:512
    v_mfma_f32_16x16x32_bf16 a[128:131], v[44:47], a[140:143], a[128:131]
    ds_read_b64_tr_b16 v[44:45], v29 offset:4096
    ds_read_b64_tr_b16 v[46:47], v29 offset:4608
    v_mfma_f32_16x16x32_bf16 a[80:83], v[48:51], v[96:99], a[80:83]
    buffer_load_dwordx4 v11, s[20:23], s63 offen offset:1024 lds
    v_mfma_f32_16x16x32_bf16 a[80:83], v[52:55], v[100:103], a[80:83]
    ds_read_b128 v[88:91], v24 offset:24576
    v_add_u32 v29, 0x10000, v29
    v_mfma_f32_16x16x32_bf16 a[84:87], v[48:51], v[104:107], a[84:87]
    buffer_store_dwordx4 a[4:7], v1, s[36:39], s72 offen sc1
    v_mfma_f32_16x16x32_bf16 a[84:87], v[52:55], v[108:111], a[84:87]
    v_mfma_f32_16x16x32_bf16 a[88:91], v[48:51], v[112:115], a[88:91]
    buffer_load_dwordx4 v12, s[20:23], s63 offen offset:2048 lds
    v_mfma_f32_16x16x32_bf16 a[88:91], v[52:55], v[116:119], a[88:91]
    ds_read_b128 v[92:95], v25 offset:24576
    v_accvgpr_write_b32 a4, 0
    v_mfma_f32_16x16x32_bf16 a[92:95], v[48:51], v[120:123], a[92:95]
    v_accvgpr_write_b32 a5, 0
    v_accvgpr_write_b32 a6, 0
    v_mfma_f32_16x16x32_bf16 a[92:95], v[52:55], v[124:127], a[92:95]
    v_accvgpr_write_b32 a7, 0
    v_mfma_f32_16x16x32_bf16 a[132:135], v[48:51], a[136:139], a[132:135]
    buffer_load_dwordx4 v13, s[20:23], s63 offen offset:3072 lds
    v_mfma_f32_16x16x32_bf16 a[132:135], v[52:55], a[140:143], a[132:135]
    s_waitcnt lgkmcnt(1)
    v_mfma_f32_16x16x32_bf16 a[96:99], v[56:59], v[96:99], a[96:99]
    v_mfma_f32_16x16x32_bf16 a[96:99], v[60:63], v[100:103], a[96:99]
    s_xor_b32 s63, s63, 128
    v_mfma_f32_16x16x32_bf16 a[100:103], v[56:59], v[104:107], a[100:103]
    v_mfma_f32_16x16x32_bf16 a[100:103], v[60:63], v[108:111], a[100:103]
    v_mfma_f32_16x16x32_bf16 a[104:107], v[56:59], v[112:115], a[104:107]
    v_mfma_f32_16x16x32_bf16 a[104:107], v[60:63], v[116:119], a[104:107]
    s_waitcnt vmcnt(10) lgkmcnt(0)
    s_barrier
    ds_read_b64_tr_b16 v[48:49], v14 offset:32768
    v_mfma_f32_16x16x32_bf16 a[108:111], v[56:59], v[120:123], a[108:111]
    s_add_u32 m0, s67, 131072
    ds_read_b64_tr_b16 v[50:51], v14 offset:33792
    ds_read_b64_tr_b16 v[52:53], v14 offset:40960
    v_mfma_f32_16x16x32_bf16 a[108:111], v[60:63], v[124:127], a[108:111]
    buffer_load_dwordx4 v1, s[28:31], s65 offen sc1 lds
    v_mfma_f32_16x16x32_bf16 a[112:115], v[40:43], v[96:99], a[112:115]
    ds_read_b64_tr_b16 v[54:55], v14 offset:41984
    ds_read_b64_tr_b16 v[56:57], v15 offset:32768
    v_mfma_f32_16x16x32_bf16 a[112:115], v[44:47], v[100:103], a[112:115]
    s_add_u32 s72, s70, 5120
    ds_read_b64_tr_b16 v[58:59], v15 offset:33792
    ds_read_b64_tr_b16 v[60:61], v15 offset:40960
    v_mfma_f32_16x16x32_bf16 a[116:119], v[40:43], v[104:107], a[116:119]
    ds_read_b64_tr_b16 v[62:63], v15 offset:41984
    ds_read_b128 a[136:139], v22 offset:0
    v_mfma_f32_16x16x32_bf16 a[116:119], v[44:47], v[108:111], a[116:119]
    ds_read_b128 a[140:143], v23 offset:0
    v_add_u32 v14, 0x10000, v14
    v_mfma_f32_16x16x32_bf16 a[120:123], v[40:43], v[112:115], a[120:123]
    v_add_u32 v15, 0x10000, v15
    v_add_u32 v22, 0x10000, v22
    v_mfma_f32_16x16x32_bf16 a[120:123], v[44:47], v[116:119], a[120:123]
    buffer_store_dwordx4 a[12:15], v1, s[36:39], s72 offen sc1
    v_mfma_f32_16x16x32_bf16 a[124:127], v[40:43], v[120:123], a[124:127]
    buffer_load_dwordx4 v1, s[28:31], s65 offen offset:1024 sc1 lds
    v_mfma_f32_16x16x32_bf16 a[124:127], v[44:47], v[124:127], a[124:127]
    s_waitcnt lgkmcnt(1)
    ds_read_b64_tr_b16 v[40:41], v16 offset:32768
    ds_read_b64_tr_b16 v[42:43], v16 offset:33792
    v_mfma_f32_16x16x32_bf16 v[128:131], v[48:51], v[64:67], v[128:131]
    ds_read_b64_tr_b16 v[44:45], v16 offset:40960
    ds_read_b64_tr_b16 v[46:47], v16 offset:41984
    v_mfma_f32_16x16x32_bf16 v[128:131], v[52:55], v[68:71], v[128:131]
    v_add_u32 v16, 0x10000, v16
    v_add_u32 v23, 0x10000, v23
    v_mfma_f32_16x16x32_bf16 v[132:135], v[48:51], v[72:75], v[132:135]
    ds_read_b128 v[96:99], v24 offset:49152
    v_accvgpr_write_b32 a12, 0
    v_mfma_f32_16x16x32_bf16 v[132:135], v[52:55], v[76:79], v[132:135]
    v_accvgpr_write_b32 a13, 0
    v_accvgpr_write_b32 a14, 0
    v_mfma_f32_16x16x32_bf16 v[136:139], v[48:51], v[80:83], v[136:139]
    v_accvgpr_write_b32 a15, 0
    v_mfma_f32_16x16x32_bf16 v[136:139], v[52:55], v[84:87], v[136:139]
    v_mfma_f32_16x16x32_bf16 v[140:143], v[48:51], v[88:91], v[140:143]
    s_add_u32 m0, s68, 139264
    ds_read_b64_tr_b16 v[48:49], v17 offset:32768
    ds_read_b64_tr_b16 v[50:51], v17 offset:33792
    v_mfma_f32_16x16x32_bf16 v[140:143], v[52:55], v[92:95], v[140:143]
    buffer_load_dwordx4 v6, s[20:23], s66 offen lds
    v_mfma_f32_16x16x32_bf16 v[144:147], v[56:59], v[64:67], v[144:147]
    ds_read_b64_tr_b16 v[52:53], v17 offset:40960
    ds_read_b64_tr_b16 v[54:55], v17 offset:41984
    v_mfma_f32_16x16x32_bf16 v[144:147], v[60:63], v[68:71], v[144:147]
    v_add_u32 v17, 0x10000, v17
    v_mfma_f32_16x16x32_bf16 v[148:151], v[56:59], v[72:75], v[148:151]
    v_mfma_f32_16x16x32_bf16 v[148:151], v[60:63], v[76:79], v[148:151]
    v_mfma_f32_16x16x32_bf16 v[152:155], v[56:59], v[80:83], v[152:155]
    v_mfma_f32_16x16x32_bf16 v[152:155], v[60:63], v[84:87], v[152:155]
    ds_read_b128 v[100:103], v25 offset:49152
    v_mfma_f32_16x16x32_bf16 v[156:159], v[56:59], v[88:91], v[156:159]
    s_add_u32 m0, s69, 147456
    ds_read_b64_tr_b16 v[56:57], v18 offset:32768
    ds_read_b64_tr_b16 v[58:59], v18 offset:33792
    v_mfma_f32_16x16x32_bf16 v[156:159], v[60:63], v[92:95], v[156:159]
    s_xor_b32 s65, s65, 57344
    buffer_load_dwordx4 v10, s[20:23], s64 offen lds
    s_waitcnt lgkmcnt(3)
    v_mfma_f32_16x16x32_bf16 v[160:163], v[40:43], v[64:67], v[160:163]
    s_xor_b32 s66, s66, 896
    ds_read_b64_tr_b16 v[60:61], v18 offset:40960
    ds_read_b64_tr_b16 v[62:63], v18 offset:41984
    v_mfma_f32_16x16x32_bf16 v[160:163], v[44:47], v[68:71], v[160:163]
    s_add_u32 s72, s70, 9216
    buffer_store_dwordx4 a[20:23], v1, s[36:39], s72 offen sc1
    v_mfma_f32_16x16x32_bf16 v[164:167], v[40:43], v[72:75], v[164:167]
    v_add_u32 v18, 0x10000, v18
    v_accvgpr_write_b32 a20, 0
    v_mfma_f32_16x16x32_bf16 v[164:167], v[44:47], v[76:79], v[164:167]
    v_accvgpr_write_b32 a21, 0
    v_accvgpr_write_b32 a22, 0
    v_mfma_f32_16x16x32_bf16 v[168:171], v[40:43], v[80:83], v[168:171]
    v_accvgpr_write_b32 a23, 0
    v_mfma_f32_16x16x32_bf16 v[168:171], v[44:47], v[84:87], v[168:171]
    v_mfma_f32_16x16x32_bf16 v[172:175], v[40:43], v[88:91], v[172:175]
    ds_read_b64_tr_b16 v[40:41], v19 offset:32768
    ds_read_b64_tr_b16 v[42:43], v19 offset:33792
    v_mfma_f32_16x16x32_bf16 v[172:175], v[44:47], v[92:95], v[172:175]
    ds_read_b64_tr_b16 v[44:45], v19 offset:40960
    ds_read_b64_tr_b16 v[46:47], v19 offset:41984
    v_mfma_f32_16x16x32_bf16 v[176:179], v[48:51], v[64:67], v[176:179]
    buffer_load_dwordx4 v11, s[20:23], s64 offen offset:1024 lds
    v_mfma_f32_16x16x32_bf16 v[176:179], v[52:55], v[68:71], v[176:179]
    ds_read_b128 v[104:107], v24 offset:57344
    v_add_u32 v19, 0x10000, v19
    v_mfma_f32_16x16x32_bf16 v[180:183], v[48:51], v[72:75], v[180:183]
    v_mfma_f32_16x16x32_bf16 v[180:183], v[52:55], v[76:79], v[180:183]
    v_mfma_f32_16x16x32_bf16 v[184:187], v[48:51], v[80:83], v[184:187]
    v_mfma_f32_16x16x32_bf16 v[184:187], v[52:55], v[84:87], v[184:187]
    v_mfma_f32_16x16x32_bf16 v[188:191], v[48:51], v[88:91], v[188:191]
    ds_read_b64_tr_b16 v[48:49], v20 offset:32768
    ds_read_b64_tr_b16 v[50:51], v20 offset:33792
    v_mfma_f32_16x16x32_bf16 v[188:191], v[52:55], v[92:95], v[188:191]
    s_waitcnt lgkmcnt(2)
    ds_read_b64_tr_b16 v[52:53], v20 offset:40960
    ds_read_b64_tr_b16 v[54:55], v20 offset:41984
    v_mfma_f32_16x16x32_bf16 v[192:195], v[56:59], v[64:67], v[192:195]
    buffer_load_dwordx4 v12, s[20:23], s64 offen offset:2048 lds
    v_mfma_f32_16x16x32_bf16 v[192:195], v[60:63], v[68:71], v[192:195]
    v_add_u32 v20, 0x10000, v20
    v_mfma_f32_16x16x32_bf16 v[196:199], v[56:59], v[72:75], v[196:199]
    v_mfma_f32_16x16x32_bf16 v[196:199], v[60:63], v[76:79], v[196:199]
    ds_read_b128 v[108:111], v25 offset:57344
    v_mfma_f32_16x16x32_bf16 v[200:203], v[56:59], v[80:83], v[200:203]
    v_mfma_f32_16x16x32_bf16 v[200:203], v[60:63], v[84:87], v[200:203]
    s_add_u32 s72, s70, 13312
    v_mfma_f32_16x16x32_bf16 v[204:207], v[56:59], v[88:91], v[204:207]
    ds_read_b64_tr_b16 v[56:57], v21 offset:32768
    ds_read_b64_tr_b16 v[58:59], v21 offset:33792
    v_mfma_f32_16x16x32_bf16 v[204:207], v[60:63], v[92:95], v[204:207]
    ds_read_b64_tr_b16 v[60:61], v21 offset:40960
    ds_read_b64_tr_b16 v[62:63], v21 offset:41984
    v_mfma_f32_16x16x32_bf16 v[208:211], v[40:43], v[64:67], v[208:211]
    buffer_store_dwordx4 a[28:31], v1, s[36:39], s72 offen sc1
    v_mfma_f32_16x16x32_bf16 v[208:211], v[44:47], v[68:71], v[208:211]
    buffer_load_dwordx4 v13, s[20:23], s64 offen offset:3072 lds
    v_mfma_f32_16x16x32_bf16 v[212:215], v[40:43], v[72:75], v[212:215]
    v_add_u32 v21, 0x10000, v21
    v_accvgpr_write_b32 a28, 0
    v_mfma_f32_16x16x32_bf16 v[212:215], v[44:47], v[76:79], v[212:215]
    v_accvgpr_write_b32 a29, 0
    v_accvgpr_write_b32 a30, 0
    v_mfma_f32_16x16x32_bf16 v[216:219], v[40:43], v[80:83], v[216:219]
    v_accvgpr_write_b32 a31, 0
    v_mfma_f32_16x16x32_bf16 v[216:219], v[44:47], v[84:87], v[216:219]
    v_mfma_f32_16x16x32_bf16 v[220:223], v[40:43], v[88:91], v[220:223]
    ds_read_b64_tr_b16 v[40:41], v26 offset:0
    ds_read_b64_tr_b16 v[42:43], v26 offset:512
    v_mfma_f32_16x16x32_bf16 v[220:223], v[44:47], v[92:95], v[220:223]
    s_waitcnt lgkmcnt(2)
    ds_read_b64_tr_b16 v[44:45], v26 offset:4096
    ds_read_b64_tr_b16 v[46:47], v26 offset:4608
    v_mfma_f32_16x16x32_bf16 v[224:227], v[48:51], v[64:67], v[224:227]
    v_add_u32 v26, 0x10000, v26
    v_mfma_f32_16x16x32_bf16 v[224:227], v[52:55], v[68:71], v[224:227]
    s_xor_b32 s64, s64, 128
    v_mfma_f32_16x16x32_bf16 v[228:231], v[48:51], v[72:75], v[228:231]
    v_mfma_f32_16x16x32_bf16 v[228:231], v[52:55], v[76:79], v[228:231]
    v_mfma_f32_16x16x32_bf16 v[232:235], v[48:51], v[80:83], v[232:235]
    v_mfma_f32_16x16x32_bf16 v[232:235], v[52:55], v[84:87], v[232:235]
    s_add_u32 m0, s69, 0
    v_mfma_f32_16x16x32_bf16 v[236:239], v[48:51], v[88:91], v[236:239]
    buffer_load_dwordx4 v2, s[24:27], s60 offen lds
    v_mfma_f32_16x16x32_bf16 v[236:239], v[52:55], v[92:95], v[236:239]
    ds_read_b64_tr_b16 v[48:49], v27 offset:0
    ds_read_b64_tr_b16 v[50:51], v27 offset:512
    v_mfma_f32_16x16x32_bf16 v[240:243], v[56:59], v[64:67], v[240:243]
    ds_read_b64_tr_b16 v[52:53], v27 offset:4096
    ds_read_b64_tr_b16 v[54:55], v27 offset:4608
    v_mfma_f32_16x16x32_bf16 v[240:243], v[60:63], v[68:71], v[240:243]
    v_add_u32 v27, 0x10000, v27
    v_mfma_f32_16x16x32_bf16 v[244:247], v[56:59], v[72:75], v[244:247]
    buffer_load_dwordx4 v3, s[24:27], s60 offen offset:1024 lds
    v_mfma_f32_16x16x32_bf16 v[244:247], v[60:63], v[76:79], v[244:247]
    s_add_u32 s72, s70, 33792
    v_mfma_f32_16x16x32_bf16 v[248:251], v[56:59], v[80:83], v[248:251]
    buffer_store_dwordx4 a[36:39], v1, s[36:39], s72 offen sc1
    v_mfma_f32_16x16x32_bf16 v[248:251], v[60:63], v[84:87], v[248:251]
    v_mfma_f32_16x16x32_bf16 v[252:255], v[56:59], v[88:91], v[252:255]
    buffer_load_dwordx4 v4, s[24:27], s60 offen offset:2048 lds
    v_mfma_f32_16x16x32_bf16 v[252:255], v[60:63], v[92:95], v[252:255]
    s_waitcnt lgkmcnt(0)
    ds_read_b64_tr_b16 v[56:57], v28 offset:0
    ds_read_b64_tr_b16 v[58:59], v28 offset:512
    v_mfma_f32_16x16x32_bf16 a[64:67], v[40:43], v[64:67], a[64:67]
    ds_read_b64_tr_b16 v[60:61], v28 offset:4096
    ds_read_b64_tr_b16 v[62:63], v28 offset:4608
    v_mfma_f32_16x16x32_bf16 a[64:67], v[44:47], v[68:71], a[64:67]
    v_add_u32 v24, 0x10000, v24
    v_add_u32 v28, 0x10000, v28
    v_mfma_f32_16x16x32_bf16 a[68:71], v[40:43], v[72:75], a[68:71]
    buffer_load_dwordx4 v5, s[24:27], s60 offen offset:3072 lds
    v_mfma_f32_16x16x32_bf16 a[68:71], v[44:47], v[76:79], a[68:71]
    ds_read_b128 v[112:115], v24 offset:16384
    v_accvgpr_write_b32 a36, 0
    v_mfma_f32_16x16x32_bf16 a[72:75], v[40:43], v[80:83], a[72:75]
    v_accvgpr_write_b32 a37, 0
    v_accvgpr_write_b32 a38, 0
    v_mfma_f32_16x16x32_bf16 a[72:75], v[44:47], v[84:87], a[72:75]
    s_add_u32 m0, s69, 16384
    v_add_u32 v25, 0x10000, v25
    v_accvgpr_write_b32 a39, 0
    v_mfma_f32_16x16x32_bf16 a[76:79], v[40:43], v[88:91], a[76:79]
    s_xor_b32 s60, s60, 524288
    buffer_load_dwordx4 v10, s[20:23], s63 offen lds
    v_mfma_f32_16x16x32_bf16 a[76:79], v[44:47], v[92:95], a[76:79]
    ds_read_b128 v[116:119], v25 offset:16384
    v_mfma_f32_16x16x32_bf16 a[128:131], v[40:43], a[136:139], a[128:131]
    ds_read_b64_tr_b16 v[40:41], v29 offset:0
    ds_read_b64_tr_b16 v[42:43], v29 offset:512
    v_mfma_f32_16x16x32_bf16 a[128:131], v[44:47], a[140:143], a[128:131]
    ds_read_b64_tr_b16 v[44:45], v29 offset:4096
    ds_read_b64_tr_b16 v[46:47], v29 offset:4608
    v_mfma_f32_16x16x32_bf16 a[80:83], v[48:51], v[64:67], a[80:83]
    buffer_load_dwordx4 v11, s[20:23], s63 offen offset:1024 lds
    v_mfma_f32_16x16x32_bf16 a[80:83], v[52:55], v[68:71], a[80:83]
    ds_read_b128 v[120:123], v24 offset:24576
    v_add_u32 v29, 0x10000, v29
    v_mfma_f32_16x16x32_bf16 a[84:87], v[48:51], v[72:75], a[84:87]
    v_mfma_f32_16x16x32_bf16 a[84:87], v[52:55], v[76:79], a[84:87]
    v_mfma_f32_16x16x32_bf16 a[88:91], v[48:51], v[80:83], a[88:91]
    buffer_load_dwordx4 v12, s[20:23], s63 offen offset:2048 lds
    v_mfma_f32_16x16x32_bf16 a[88:91], v[52:55], v[84:87], a[88:91]
    ds_read_b128 v[124:127], v25 offset:24576
    v_mfma_f32_16x16x32_bf16 a[92:95], v[48:51], v[88:91], a[92:95]
    v_mfma_f32_16x16x32_bf16 a[92:95], v[52:55], v[92:95], a[92:95]
    s_add_u32 s72, s70, 37888
    v_mfma_f32_16x16x32_bf16 a[132:135], v[48:51], a[136:139], a[132:135]
    buffer_load_dwordx4 v13, s[20:23], s63 offen offset:3072 lds
    v_mfma_f32_16x16x32_bf16 a[132:135], v[52:55], a[140:143], a[132:135]
    s_waitcnt lgkmcnt(1)
    v_mfma_f32_16x16x32_bf16 a[96:99], v[56:59], v[64:67], a[96:99]
    v_mfma_f32_16x16x32_bf16 a[96:99], v[60:63], v[68:71], a[96:99]
    s_xor_b32 s63, s63, 384
    v_mfma_f32_16x16x32_bf16 a[100:103], v[56:59], v[72:75], a[100:103]
    buffer_store_dwordx4 a[44:47], v1, s[36:39], s72 offen sc1
    v_mfma_f32_16x16x32_bf16 a[100:103], v[60:63], v[76:79], a[100:103]
    v_mfma_f32_16x16x32_bf16 a[104:107], v[56:59], v[80:83], a[104:107]
    v_accvgpr_write_b32 a44, 0
    v_accvgpr_write_b32 a45, 0
    v_mfma_f32_16x16x32_bf16 a[104:107], v[60:63], v[84:87], a[104:107]
    s_waitcnt vmcnt(10) lgkmcnt(0)
    s_barrier
    ds_read_b64_tr_b16 v[48:49], v14 offset:32768
    v_mfma_f32_16x16x32_bf16 a[108:111], v[56:59], v[88:91], a[108:111]
    s_add_u32 m0, s67, 32768
    ds_read_b64_tr_b16 v[50:51], v14 offset:33792
    ds_read_b64_tr_b16 v[52:53], v14 offset:40960
    v_mfma_f32_16x16x32_bf16 a[108:111], v[60:63], v[92:95], a[108:111]
    buffer_load_dwordx4 v1, s[28:31], s65 offen sc1 lds
    v_mfma_f32_16x16x32_bf16 a[112:115], v[40:43], v[64:67], a[112:115]
    ds_read_b64_tr_b16 v[54:55], v14 offset:41984
    ds_read_b64_tr_b16 v[56:57], v15 offset:32768
    v_mfma_f32_16x16x32_bf16 a[112:115], v[44:47], v[68:71], a[112:115]
    ds_read_b64_tr_b16 v[58:59], v15 offset:33792
    ds_read_b64_tr_b16 v[60:61], v15 offset:40960
    v_mfma_f32_16x16x32_bf16 a[116:119], v[40:43], v[72:75], a[116:119]
    ds_read_b64_tr_b16 v[62:63], v15 offset:41984
    ds_read_b128 a[136:139], v22 offset:0
    v_mfma_f32_16x16x32_bf16 a[116:119], v[44:47], v[76:79], a[116:119]
    ds_read_b128 a[140:143], v23 offset:0
    v_add_u32 v14, 0xffff0000, v14
    v_mfma_f32_16x16x32_bf16 a[120:123], v[40:43], v[80:83], a[120:123]
    v_add_u32 v15, 0xffff0000, v15
    v_add_u32 v22, 0xfffe0000, v22
    v_mfma_f32_16x16x32_bf16 a[120:123], v[44:47], v[84:87], a[120:123]
    v_add_u32 v23, 0xfffe0000, v23
    v_accvgpr_write_b32 a46, 0
    v_mfma_f32_16x16x32_bf16 a[124:127], v[40:43], v[88:91], a[124:127]
    buffer_load_dwordx4 v1, s[28:31], s65 offen offset:1024 sc1 lds
    v_mfma_f32_16x16x32_bf16 a[124:127], v[44:47], v[92:95], a[124:127]
    s_waitcnt lgkmcnt(1)
    ds_read_b64_tr_b16 v[40:41], v16 offset:32768
    ds_read_b64_tr_b16 v[42:43], v16 offset:33792
    v_mfma_f32_16x16x32_bf16 v[128:131], v[48:51], v[96:99], v[128:131]
    ds_read_b64_tr_b16 v[44:45], v16 offset:40960
    ds_read_b64_tr_b16 v[46:47], v16 offset:41984
    v_mfma_f32_16x16x32_bf16 v[128:131], v[52:55], v[100:103], v[128:131]
    v_add_u32 v16, 0xffff0000, v16
    v_accvgpr_write_b32 a47, 0
    v_mfma_f32_16x16x32_bf16 v[132:135], v[48:51], v[104:107], v[132:135]
    ds_read_b128 v[64:67], v24 offset:49152
    v_mfma_f32_16x16x32_bf16 v[132:135], v[52:55], v[108:111], v[132:135]
    s_add_u32 s72, s70, 41984
    v_mfma_f32_16x16x32_bf16 v[136:139], v[48:51], v[112:115], v[136:139]
    buffer_store_dwordx4 a[52:55], v1, s[36:39], s72 offen sc1
    v_mfma_f32_16x16x32_bf16 v[136:139], v[52:55], v[116:119], v[136:139]
    v_mfma_f32_16x16x32_bf16 v[140:143], v[48:51], v[120:123], v[140:143]
    s_add_u32 m0, s68, 40960
    ds_read_b64_tr_b16 v[48:49], v17 offset:32768
    ds_read_b64_tr_b16 v[50:51], v17 offset:33792
    v_mfma_f32_16x16x32_bf16 v[140:143], v[52:55], v[124:127], v[140:143]
    buffer_load_dwordx4 v6, s[20:23], s66 offen lds
    v_mfma_f32_16x16x32_bf16 v[144:147], v[56:59], v[96:99], v[144:147]
    ds_read_b64_tr_b16 v[52:53], v17 offset:40960
    ds_read_b64_tr_b16 v[54:55], v17 offset:41984
    v_mfma_f32_16x16x32_bf16 v[144:147], v[60:63], v[100:103], v[144:147]
    v_add_u32 v17, 0xffff0000, v17
    v_accvgpr_write_b32 a52, 0
    v_mfma_f32_16x16x32_bf16 v[148:151], v[56:59], v[104:107], v[148:151]
    v_accvgpr_write_b32 a53, 0
    v_accvgpr_write_b32 a54, 0
    v_mfma_f32_16x16x32_bf16 v[148:151], v[60:63], v[108:111], v[148:151]
    v_accvgpr_write_b32 a55, 0
    v_mfma_f32_16x16x32_bf16 v[152:155], v[56:59], v[112:115], v[152:155]
    v_mfma_f32_16x16x32_bf16 v[152:155], v[60:63], v[116:119], v[152:155]
    ds_read_b128 v[68:71], v25 offset:49152
    v_mfma_f32_16x16x32_bf16 v[156:159], v[56:59], v[120:123], v[156:159]
    s_add_u32 m0, s69, 49152
    ds_read_b64_tr_b16 v[56:57], v18 offset:32768
    ds_read_b64_tr_b16 v[58:59], v18 offset:33792
    v_mfma_f32_16x16x32_bf16 v[156:159], v[60:63], v[124:127], v[156:159]
    s_xor_b32 s65, s65, 8192
    buffer_load_dwordx4 v10, s[20:23], s64 offen lds
    s_waitcnt lgkmcnt(3)
    v_mfma_f32_16x16x32_bf16 v[160:163], v[40:43], v[96:99], v[160:163]
    s_xor_b32 s66, s66, 128
    ds_read_b64_tr_b16 v[60:61], v18 offset:40960
    ds_read_b64_tr_b16 v[62:63], v18 offset:41984
    v_mfma_f32_16x16x32_bf16 v[160:163], v[44:47], v[100:103], v[160:163]
    v_add_u32 v18, 0xffff0000, v18
    v_mfma_f32_16x16x32_bf16 v[164:167], v[40:43], v[104:107], v[164:167]
    v_mfma_f32_16x16x32_bf16 v[164:167], v[44:47], v[108:111], v[164:167]
    v_mfma_f32_16x16x32_bf16 v[168:171], v[40:43], v[112:115], v[168:171]
    v_mfma_f32_16x16x32_bf16 v[168:171], v[44:47], v[116:119], v[168:171]
    v_mfma_f32_16x16x32_bf16 v[172:175], v[40:43], v[120:123], v[172:175]
    ds_read_b64_tr_b16 v[40:41], v19 offset:32768
    ds_read_b64_tr_b16 v[42:43], v19 offset:33792
    v_mfma_f32_16x16x32_bf16 v[172:175], v[44:47], v[124:127], v[172:175]
    ds_read_b64_tr_b16 v[44:45], v19 offset:40960
    ds_read_b64_tr_b16 v[46:47], v19 offset:41984
    v_mfma_f32_16x16x32_bf16 v[176:179], v[48:51], v[96:99], v[176:179]
    buffer_load_dwordx4 v11, s[20:23], s64 offen offset:1024 lds
    v_mfma_f32_16x16x32_bf16 v[176:179], v[52:55], v[100:103], v[176:179]
    s_add_u32 s72, s70, 46080
    ds_read_b128 v[72:75], v24 offset:57344
    v_add_u32 v19, 0xffff0000, v19
    v_mfma_f32_16x16x32_bf16 v[180:183], v[48:51], v[104:107], v[180:183]
    buffer_store_dwordx4 a[60:63], v1, s[36:39], s72 offen sc1
    v_mfma_f32_16x16x32_bf16 v[180:183], v[52:55], v[108:111], v[180:183]
    v_mfma_f32_16x16x32_bf16 v[184:187], v[48:51], v[112:115], v[184:187]
    v_accvgpr_write_b32 a60, 0
    v_accvgpr_write_b32 a61, 0
    v_mfma_f32_16x16x32_bf16 v[184:187], v[52:55], v[116:119], v[184:187]
    v_accvgpr_write_b32 a62, 0
    v_accvgpr_write_b32 a63, 0
    v_mfma_f32_16x16x32_bf16 v[188:191], v[48:51], v[120:123], v[188:191]
    ds_read_b64_tr_b16 v[48:49], v20 offset:32768
    ds_read_b64_tr_b16 v[50:51], v20 offset:33792
    v_mfma_f32_16x16x32_bf16 v[188:191], v[52:55], v[124:127], v[188:191]
    s_waitcnt lgkmcnt(2)
    ds_read_b64_tr_b16 v[52:53], v20 offset:40960
    ds_read_b64_tr_b16 v[54:55], v20 offset:41984
    v_mfma_f32_16x16x32_bf16 v[192:195], v[56:59], v[96:99], v[192:195]
    buffer_load_dwordx4 v12, s[20:23], s64 offen offset:2048 lds
    v_mfma_f32_16x16x32_bf16 v[192:195], v[60:63], v[100:103], v[192:195]
    v_add_u32 v20, 0xffff0000, v20
    v_mfma_f32_16x16x32_bf16 v[196:199], v[56:59], v[104:107], v[196:199]
    v_mfma_f32_16x16x32_bf16 v[196:199], v[60:63], v[108:111], v[196:199]
    ds_read_b128 v[76:79], v25 offset:57344
    v_mfma_f32_16x16x32_bf16 v[200:203], v[56:59], v[112:115], v[200:203]
    v_mfma_f32_16x16x32_bf16 v[200:203], v[60:63], v[116:119], v[200:203]
    v_mfma_f32_16x16x32_bf16 v[204:207], v[56:59], v[120:123], v[204:207]
    ds_read_b64_tr_b16 v[56:57], v21 offset:32768
    ds_read_b64_tr_b16 v[58:59], v21 offset:33792
    v_mfma_f32_16x16x32_bf16 v[204:207], v[60:63], v[124:127], v[204:207]
    ds_read_b64_tr_b16 v[60:61], v21 offset:40960
    ds_read_b64_tr_b16 v[62:63], v21 offset:41984
    v_mfma_f32_16x16x32_bf16 v[208:211], v[40:43], v[96:99], v[208:211]
    v_add_u32 v21, 0xffff0000, v21
    v_accvgpr_read_b32 v32, a144
    v_mfma_f32_16x16x32_bf16 v[208:211], v[44:47], v[100:103], v[208:211]
    buffer_load_dwordx4 v13, s[20:23], s64 offen offset:3072 lds
    v_mfma_f32_16x16x32_bf16 v[212:215], v[40:43], v[104:107], v[212:215]
    v_accvgpr_read_b32 v31, a145
    v_cvt_pk_bf16_f32 v32, v32, v31
    v_mfma_f32_16x16x32_bf16 v[212:215], v[44:47], v[108:111], v[212:215]
    v_accvgpr_read_b32 v33, a146
    v_accvgpr_read_b32 v31, a147
    v_mfma_f32_16x16x32_bf16 v[216:219], v[40:43], v[112:115], v[216:219]
    v_cvt_pk_bf16_f32 v33, v33, v31
    v_accvgpr_read_b32 v34, a148
    v_mfma_f32_16x16x32_bf16 v[216:219], v[44:47], v[116:119], v[216:219]
    v_accvgpr_read_b32 v31, a149
    v_cvt_pk_bf16_f32 v34, v34, v31
    v_mfma_f32_16x16x32_bf16 v[220:223], v[40:43], v[120:123], v[220:223]
    ds_read_b64_tr_b16 v[40:41], v26 offset:0
    ds_read_b64_tr_b16 v[42:43], v26 offset:512
    v_mfma_f32_16x16x32_bf16 v[220:223], v[44:47], v[124:127], v[220:223]
    s_add_u32 s72, s71, 32768
    ds_read_b64_tr_b16 v[44:45], v26 offset:4096
    ds_read_b64_tr_b16 v[46:47], v26 offset:4608
    s_waitcnt lgkmcnt(4)
    v_mfma_f32_16x16x32_bf16 v[224:227], v[48:51], v[96:99], v[224:227]
    v_add_u32 v26, 0xfffe0000, v26
    v_accvgpr_read_b32 v35, a150
    v_mfma_f32_16x16x32_bf16 v[224:227], v[52:55], v[100:103], v[224:227]
    s_xor_b32 s64, s64, 384
    v_accvgpr_read_b32 v31, a151
    v_cvt_pk_bf16_f32 v35, v35, v31
    v_mfma_f32_16x16x32_bf16 v[228:231], v[48:51], v[104:107], v[228:231]
    buffer_store_dwordx4 v[32:35], v1, s[36:39], s72 offen sc1
    v_mfma_f32_16x16x32_bf16 v[228:231], v[52:55], v[108:111], v[228:231]
    v_accvgpr_write_b32 a144, 0
    v_accvgpr_write_b32 a145, 0
    v_mfma_f32_16x16x32_bf16 v[232:235], v[48:51], v[112:115], v[232:235]
    v_accvgpr_write_b32 a146, 0
    v_accvgpr_write_b32 a147, 0
    v_mfma_f32_16x16x32_bf16 v[232:235], v[52:55], v[116:119], v[232:235]
    s_add_u32 m0, s69, 65536
    v_accvgpr_write_b32 a148, 0
    v_accvgpr_write_b32 a149, 0
    v_mfma_f32_16x16x32_bf16 v[236:239], v[48:51], v[120:123], v[236:239]
    buffer_load_dwordx4 v2, s[24:27], s60 offen lds
    v_mfma_f32_16x16x32_bf16 v[236:239], v[52:55], v[124:127], v[236:239]
    ds_read_b64_tr_b16 v[48:49], v27 offset:0
    ds_read_b64_tr_b16 v[50:51], v27 offset:512
    v_mfma_f32_16x16x32_bf16 v[240:243], v[56:59], v[96:99], v[240:243]
    ds_read_b64_tr_b16 v[52:53], v27 offset:4096
    ds_read_b64_tr_b16 v[54:55], v27 offset:4608
    v_mfma_f32_16x16x32_bf16 v[240:243], v[60:63], v[100:103], v[240:243]
    v_add_u32 v27, 0xfffe0000, v27
    v_accvgpr_write_b32 a150, 0
    v_mfma_f32_16x16x32_bf16 v[244:247], v[56:59], v[104:107], v[244:247]
    buffer_load_dwordx4 v3, s[24:27], s60 offen offset:1024 lds
    v_mfma_f32_16x16x32_bf16 v[244:247], v[60:63], v[108:111], v[244:247]
    v_accvgpr_write_b32 a151, 0
    v_mfma_f32_16x16x32_bf16 v[248:251], v[56:59], v[112:115], v[248:251]
    v_accvgpr_read_b32 v32, a152
    v_accvgpr_read_b32 v31, a153
    v_mfma_f32_16x16x32_bf16 v[248:251], v[60:63], v[116:119], v[248:251]
    v_cvt_pk_bf16_f32 v32, v32, v31
    v_accvgpr_read_b32 v33, a154
    v_mfma_f32_16x16x32_bf16 v[252:255], v[56:59], v[120:123], v[252:255]
    buffer_load_dwordx4 v4, s[24:27], s60 offen offset:2048 lds
    v_mfma_f32_16x16x32_bf16 v[252:255], v[60:63], v[124:127], v[252:255]
    s_waitcnt lgkmcnt(0)
    ds_read_b64_tr_b16 v[56:57], v28 offset:0
    ds_read_b64_tr_b16 v[58:59], v28 offset:512
    v_mfma_f32_16x16x32_bf16 a[64:67], v[40:43], v[96:99], a[64:67]
    ds_read_b64_tr_b16 v[60:61], v28 offset:4096
    ds_read_b64_tr_b16 v[62:63], v28 offset:4608
    v_mfma_f32_16x16x32_bf16 a[64:67], v[44:47], v[100:103], a[64:67]
    v_add_u32 v24, 0x10000, v24
    v_add_u32 v28, 0xfffe0000, v28
    v_mfma_f32_16x16x32_bf16 a[68:71], v[40:43], v[104:107], a[68:71]
    buffer_load_dwordx4 v5, s[24:27], s60 offen offset:3072 lds
    v_mfma_f32_16x16x32_bf16 a[68:71], v[44:47], v[108:111], a[68:71]
    ds_read_b128 v[80:83], v24 offset:16384
    v_accvgpr_read_b32 v31, a155
    v_mfma_f32_16x16x32_bf16 a[72:75], v[40:43], v[112:115], a[72:75]
    v_cvt_pk_bf16_f32 v33, v33, v31
    v_accvgpr_read_b32 v34, a156
    v_mfma_f32_16x16x32_bf16 a[72:75], v[44:47], v[116:119], a[72:75]
    s_add_u32 m0, s69, 81920
    v_add_u32 v25, 0x10000, v25
    v_accvgpr_read_b32 v31, a157
    v_mfma_f32_16x16x32_bf16 a[76:79], v[40:43], v[120:123], a[76:79]
    s_xor_b32 s60, s60, 1572864
    buffer_load_dwordx4 v10, s[20:23], s63 offen lds
    v_mfma_f32_16x16x32_bf16 a[76:79], v[44:47], v[124:127], a[76:79]
    s_add_u32 s72, s71, 33792
    ds_read_b128 v[84:87], v25 offset:16384
    v_cvt_pk_bf16_f32 v34, v34, v31
    v_mfma_f32_16x16x32_bf16 a[128:131], v[40:43], a[136:139], a[128:131]
    ds_read_b64_tr_b16 v[40:41], v29 offset:0
    ds_read_b64_tr_b16 v[42:43], v29 offset:512
    v_mfma_f32_16x16x32_bf16 a[128:131], v[44:47], a[140:143], a[128:131]
    ds_read_b64_tr_b16 v[44:45], v29 offset:4096
    ds_read_b64_tr_b16 v[46:47], v29 offset:4608
    v_mfma_f32_16x16x32_bf16 a[80:83], v[48:51], v[96:99], a[80:83]
    buffer_load_dwordx4 v11, s[20:23], s63 offen offset:1024 lds
    v_mfma_f32_16x16x32_bf16 a[80:83], v[52:55], v[100:103], a[80:83]
    ds_read_b128 v[88:91], v24 offset:24576
    v_add_u32 v29, 0xfffe0000, v29
    v_mfma_f32_16x16x32_bf16 a[84:87], v[48:51], v[104:107], a[84:87]
    v_accvgpr_read_b32 v35, a158
    v_accvgpr_read_b32 v31, a159
    v_mfma_f32_16x16x32_bf16 a[84:87], v[52:55], v[108:111], a[84:87]
    v_cvt_pk_bf16_f32 v35, v35, v31
    v_accvgpr_write_b32 a152, 0
    v_mfma_f32_16x16x32_bf16 a[88:91], v[48:51], v[112:115], a[88:91]
    buffer_load_dwordx4 v12, s[20:23], s63 offen offset:2048 lds
    v_mfma_f32_16x16x32_bf16 a[88:91], v[52:55], v[116:119], a[88:91]
    ds_read_b128 v[92:95], v25 offset:24576
    v_accvgpr_write_b32 a153, 0
    v_mfma_f32_16x16x32_bf16 a[92:95], v[48:51], v[120:123], a[92:95]
    buffer_store_dwordx4 v[32:35], v1, s[36:39], s72 offen sc1
    v_mfma_f32_16x16x32_bf16 a[92:95], v[52:55], v[124:127], a[92:95]
    v_accvgpr_write_b32 a154, 0
    v_accvgpr_write_b32 a155, 0
    v_mfma_f32_16x16x32_bf16 a[132:135], v[48:51], a[136:139], a[132:135]
    buffer_load_dwordx4 v13, s[20:23], s63 offen offset:3072 lds
    v_mfma_f32_16x16x32_bf16 a[132:135], v[52:55], a[140:143], a[132:135]
    s_waitcnt lgkmcnt(1)
    v_accvgpr_read_b32 v32, a160
    v_accvgpr_read_b32 v31, a161
    v_mfma_f32_16x16x32_bf16 a[96:99], v[56:59], v[96:99], a[96:99]
    v_cvt_pk_bf16_f32 v32, v32, v31
    v_accvgpr_read_b32 v33, a162
    v_mfma_f32_16x16x32_bf16 a[96:99], v[60:63], v[100:103], a[96:99]
    s_xor_b32 s63, s63, 128
    v_accvgpr_read_b32 v31, a163
    v_cvt_pk_bf16_f32 v33, v33, v31
    v_mfma_f32_16x16x32_bf16 a[100:103], v[56:59], v[104:107], a[100:103]
    v_accvgpr_read_b32 v34, a164
    v_accvgpr_read_b32 v31, a165
    v_mfma_f32_16x16x32_bf16 a[100:103], v[60:63], v[108:111], a[100:103]
    v_cvt_pk_bf16_f32 v34, v34, v31
    v_accvgpr_read_b32 v35, a166
    v_mfma_f32_16x16x32_bf16 a[104:107], v[56:59], v[112:115], a[104:107]
    v_accvgpr_read_b32 v31, a167
    v_cvt_pk_bf16_f32 v35, v35, v31
    v_mfma_f32_16x16x32_bf16 a[104:107], v[60:63], v[116:119], a[104:107]
    s_waitcnt vmcnt(10) lgkmcnt(0)
    s_barrier
    ds_read_b64_tr_b16 v[48:49], v14 offset:0
    v_mfma_f32_16x16x32_bf16 a[108:111], v[56:59], v[120:123], a[108:111]
    s_add_u32 m0, s67, 98304
    ds_read_b64_tr_b16 v[50:51], v14 offset:1024
    ds_read_b64_tr_b16 v[52:53], v14 offset:8192
    v_mfma_f32_16x16x32_bf16 a[108:111], v[60:63], v[124:127], a[108:111]
    s_add_u32 s72, s71, 2048
    buffer_load_dwordx4 v1, s[28:31], s65 offen sc1 lds
    v_mfma_f32_16x16x32_bf16 a[112:115], v[40:43], v[96:99], a[112:115]
    ds_read_b64_tr_b16 v[54:55], v14 offset:9216
    ds_read_b64_tr_b16 v[56:57], v15 offset:0
    v_mfma_f32_16x16x32_bf16 a[112:115], v[44:47], v[100:103], a[112:115]
    ds_read_b64_tr_b16 v[58:59], v15 offset:1024
    ds_read_b64_tr_b16 v[60:61], v15 offset:8192
    v_mfma_f32_16x16x32_bf16 a[116:119], v[40:43], v[104:107], a[116:119]
    ds_read_b64_tr_b16 v[62:63], v15 offset:9216
    ds_read_b128 a[136:139], v22 offset:32768
    v_mfma_f32_16x16x32_bf16 a[116:119], v[44:47], v[108:111], a[116:119]
    ds_read_b128 a[140:143], v23 offset:32768
    v_add_u32 v14, 0x10000, v14
    v_mfma_f32_16x16x32_bf16 a[120:123], v[40:43], v[112:115], a[120:123]
    v_add_u32 v15, 0x10000, v15
    v_add_u32 v22, 0x10000, v22
    v_mfma_f32_16x16x32_bf16 a[120:123], v[44:47], v[116:119], a[120:123]
    v_add_u32 v23, 0x10000, v23
    v_accvgpr_write_b32 a156, 0
    v_mfma_f32_16x16x32_bf16 a[124:127], v[40:43], v[120:123], a[124:127]
    buffer_load_dwordx4 v1, s[28:31], s65 offen offset:1024 sc1 lds
    v_mfma_f32_16x16x32_bf16 a[124:127], v[44:47], v[124:127], a[124:127]
    s_waitcnt lgkmcnt(1)
    ds_read_b64_tr_b16 v[40:41], v16 offset:0
    ds_read_b64_tr_b16 v[42:43], v16 offset:1024
    v_mfma_f32_16x16x32_bf16 v[128:131], v[48:51], v[64:67], v[128:131]
    ds_read_b64_tr_b16 v[44:45], v16 offset:8192
    ds_read_b64_tr_b16 v[46:47], v16 offset:9216
    v_mfma_f32_16x16x32_bf16 v[128:131], v[52:55], v[68:71], v[128:131]
    v_add_u32 v24, 0xfffe0000, v24
    v_add_u32 v16, 0x10000, v16
    v_mfma_f32_16x16x32_bf16 v[132:135], v[48:51], v[72:75], v[132:135]
    ds_read_b128 v[96:99], v24 offset:16384
    v_accvgpr_write_b32 a157, 0
    v_mfma_f32_16x16x32_bf16 v[132:135], v[52:55], v[76:79], v[132:135]
    buffer_store_dwordx4 v[32:35], v1, s[36:39], s72 offen sc1
    v_mfma_f32_16x16x32_bf16 v[136:139], v[48:51], v[80:83], v[136:139]
    v_accvgpr_read_b32 v31, a169
    v_accvgpr_read_b32 v32, a168
    v_mfma_f32_16x16x32_bf16 v[136:139], v[52:55], v[84:87], v[136:139]
    v_cvt_pk_bf16_f32 v32, v32, v31
    v_accvgpr_read_b32 v33, a170
    v_mfma_f32_16x16x32_bf16 v[140:143], v[48:51], v[88:91], v[140:143]
    s_add_u32 m0, s68, 106496
    ds_read_b64_tr_b16 v[48:49], v17 offset:0
    ds_read_b64_tr_b16 v[50:51], v17 offset:1024
    v_mfma_f32_16x16x32_bf16 v[140:143], v[52:55], v[92:95], v[140:143]
    buffer_load_dwordx4 v6, s[20:23], s66 offen lds
    v_mfma_f32_16x16x32_bf16 v[144:147], v[56:59], v[64:67], v[144:147]
    ds_read_b64_tr_b16 v[52:53], v17 offset:8192
    ds_read_b64_tr_b16 v[54:55], v17 offset:9216
    v_mfma_f32_16x16x32_bf16 v[144:147], v[60:63], v[68:71], v[144:147]
    v_add_u32 v17, 0x10000, v17
    v_accvgpr_read_b32 v31, a171
    v_mfma_f32_16x16x32_bf16 v[148:151], v[56:59], v[72:75], v[148:151]
    v_cvt_pk_bf16_f32 v33, v33, v31
    v_accvgpr_read_b32 v34, a172
    v_mfma_f32_16x16x32_bf16 v[148:151], v[60:63], v[76:79], v[148:151]
    v_accvgpr_read_b32 v31, a173
    v_cvt_pk_bf16_f32 v34, v34, v31
    v_mfma_f32_16x16x32_bf16 v[152:155], v[56:59], v[80:83], v[152:155]
    v_add_u32 v25, 0xfffe0000, v25
    v_accvgpr_read_b32 v35, a174
    v_mfma_f32_16x16x32_bf16 v[152:155], v[60:63], v[84:87], v[152:155]
    s_add_u32 s72, s71, 3072
    ds_read_b128 v[100:103], v25 offset:16384
    v_accvgpr_read_b32 v31, a175
    v_mfma_f32_16x16x32_bf16 v[156:159], v[56:59], v[88:91], v[156:159]
    s_add_u32 m0, s69, 114688
    ds_read_b64_tr_b16 v[56:57], v18 offset:0
    ds_read_b64_tr_b16 v[58:59], v18 offset:1024
    v_mfma_f32_16x16x32_bf16 v[156:159], v[60:63], v[92:95], v[156:159]
    s_xor_b32 s65, s65, 24576
    buffer_load_dwordx4 v10, s[20:23], s64 offen lds
    s_waitcnt lgkmcnt(3)
    v_mfma_f32_16x16x32_bf16 v[160:163], v[40:43], v[64:67], v[160:163]
    s_xor_b32 s66, s66, 384
    ds_read_b64_tr_b16 v[60:61], v18 offset:8192
    ds_read_b64_tr_b16 v[62:63], v18 offset:9216
    v_mfma_f32_16x16x32_bf16 v[160:163], v[44:47], v[68:71], v[160:163]
    v_add_u32 v18, 0x10000, v18
    v_cvt_pk_bf16_f32 v35, v35, v31
    v_mfma_f32_16x16x32_bf16 v[164:167], v[40:43], v[72:75], v[164:167]
    buffer_store_dwordx4 v[32:35], v1, s[36:39], s72 offen sc1
    v_mfma_f32_16x16x32_bf16 v[164:167], v[44:47], v[76:79], v[164:167]
    v_accvgpr_write_b32 a158, 0
    v_accvgpr_write_b32 a159, 0
    v_mfma_f32_16x16x32_bf16 v[168:171], v[40:43], v[80:83], v[168:171]
    v_accvgpr_write_b32 a160, 0
    v_accvgpr_write_b32 a161, 0
    v_mfma_f32_16x16x32_bf16 v[168:171], v[44:47], v[84:87], v[168:171]
    v_accvgpr_write_b32 a162, 0
    v_accvgpr_write_b32 a163, 0
    v_mfma_f32_16x16x32_bf16 v[172:175], v[40:43], v[88:91], v[172:175]
    ds_read_b64_tr_b16 v[40:41], v19 offset:0
    ds_read_b64_tr_b16 v[42:43], v19 offset:1024
    v_mfma_f32_16x16x32_bf16 v[172:175], v[44:47], v[92:95], v[172:175]
    ds_read_b64_tr_b16 v[44:45], v19 offset:8192
    ds_read_b64_tr_b16 v[46:47], v19 offset:9216
    v_mfma_f32_16x16x32_bf16 v[176:179], v[48:51], v[64:67], v[176:179]
    buffer_load_dwordx4 v11, s[20:23], s64 offen offset:1024 lds
    v_mfma_f32_16x16x32_bf16 v[176:179], v[52:55], v[68:71], v[176:179]
    ds_read_b128 v[104:107], v24 offset:24576
    v_add_u32 v19, 0x10000, v19
    v_mfma_f32_16x16x32_bf16 v[180:183], v[48:51], v[72:75], v[180:183]
    v_accvgpr_read_b32 v32, a176
    v_accvgpr_read_b32 v31, a177
    v_mfma_f32_16x16x32_bf16 v[180:183], v[52:55], v[76:79], v[180:183]
    v_cvt_pk_bf16_f32 v32, v32, v31
    v_accvgpr_read_b32 v33, a178
    v_mfma_f32_16x16x32_bf16 v[184:187], v[48:51], v[80:83], v[184:187]
    v_accvgpr_read_b32 v31, a179
    v_cvt_pk_bf16_f32 v33, v33, v31
    v_mfma_f32_16x16x32_bf16 v[184:187], v[52:55], v[84:87], v[184:187]
    v_accvgpr_read_b32 v34, a180
    v_accvgpr_read_b32 v31, a181
    v_mfma_f32_16x16x32_bf16 v[188:191], v[48:51], v[88:91], v[188:191]
    ds_read_b64_tr_b16 v[48:49], v20 offset:0
    ds_read_b64_tr_b16 v[50:51], v20 offset:1024
    v_mfma_f32_16x16x32_bf16 v[188:191], v[52:55], v[92:95], v[188:191]
    s_waitcnt lgkmcnt(2)
    ds_read_b64_tr_b16 v[52:53], v20 offset:8192
    ds_read_b64_tr_b16 v[54:55], v20 offset:9216
    v_mfma_f32_16x16x32_bf16 v[192:195], v[56:59], v[64:67], v[192:195]
    buffer_load_dwordx4 v12, s[20:23], s64 offen offset:2048 lds
    v_mfma_f32_16x16x32_bf16 v[192:195], v[60:63], v[68:71], v[192:195]
    v_add_u32 v20, 0x10000, v20
    v_cvt_pk_bf16_f32 v34, v34, v31
    v_mfma_f32_16x16x32_bf16 v[196:199], v[56:59], v[72:75], v[196:199]
    v_accvgpr_read_b32 v35, a182
    v_accvgpr_read_b32 v31, a183
    v_mfma_f32_16x16x32_bf16 v[196:199], v[60:63], v[76:79], v[196:199]
    s_add_u32 s72, s71, 34816
    ds_read_b128 v[108:111], v25 offset:24576
    v_cvt_pk_bf16_f32 v35, v35, v31
    v_mfma_f32_16x16x32_bf16 v[200:203], v[56:59], v[80:83], v[200:203]
    buffer_store_dwordx4 v[32:35], v1, s[36:39], s72 offen sc1
    v_mfma_f32_16x16x32_bf16 v[200:203], v[60:63], v[84:87], v[200:203]
    v_accvgpr_write_b32 a164, 0
    v_accvgpr_write_b32 a165, 0
    v_mfma_f32_16x16x32_bf16 v[204:207], v[56:59], v[88:91], v[204:207]
    ds_read_b64_tr_b16 v[56:57], v21 offset:0
    ds_read_b64_tr_b16 v[58:59], v21 offset:1024
    v_mfma_f32_16x16x32_bf16 v[204:207], v[60:63], v[92:95], v[204:207]
    ds_read_b64_tr_b16 v[60:61], v21 offset:8192
    ds_read_b64_tr_b16 v[62:63], v21 offset:9216
    v_mfma_f32_16x16x32_bf16 v[208:211], v[40:43], v[64:67], v[208:211]
    v_add_u32 v21, 0x10000, v21
    v_accvgpr_write_b32 a166, 0
    v_mfma_f32_16x16x32_bf16 v[208:211], v[44:47], v[68:71], v[208:211]
    buffer_load_dwordx4 v13, s[20:23], s64 offen offset:3072 lds
    v_mfma_f32_16x16x32_bf16 v[212:215], v[40:43], v[72:75], v[212:215]
    v_accvgpr_write_b32 a167, 0
    v_accvgpr_write_b32 a168, 0
    v_mfma_f32_16x16x32_bf16 v[212:215], v[44:47], v[76:79], v[212:215]
    v_accvgpr_write_b32 a169, 0
    v_accvgpr_write_b32 a170, 0
    v_mfma_f32_16x16x32_bf16 v[216:219], v[40:43], v[80:83], v[216:219]
    v_accvgpr_write_b32 a171, 0
    v_accvgpr_write_b32 a172, 0
    v_mfma_f32_16x16x32_bf16 v[216:219], v[44:47], v[84:87], v[216:219]
    v_accvgpr_write_b32 a173, 0
    v_accvgpr_write_b32 a174, 0
    v_mfma_f32_16x16x32_bf16 v[220:223], v[40:43], v[88:91], v[220:223]
    ds_read_b64_tr_b16 v[40:41], v26 offset:32768
    ds_read_b64_tr_b16 v[42:43], v26 offset:33280
    v_mfma_f32_16x16x32_bf16 v[220:223], v[44:47], v[92:95], v[220:223]
    s_waitcnt lgkmcnt(2)
    ds_read_b64_tr_b16 v[44:45], v26 offset:36864
    ds_read_b64_tr_b16 v[46:47], v26 offset:37376
    v_mfma_f32_16x16x32_bf16 v[224:227], v[48:51], v[64:67], v[224:227]
    v_add_u32 v26, 0x10000, v26
    v_accvgpr_read_b32 v32, a184
    v_mfma_f32_16x16x32_bf16 v[224:227], v[52:55], v[68:71], v[224:227]
    s_xor_b32 s64, s64, 128
    v_accvgpr_read_b32 v31, a185
    v_cvt_pk_bf16_f32 v32, v32, v31
    v_mfma_f32_16x16x32_bf16 v[228:231], v[48:51], v[72:75], v[228:231]
    v_accvgpr_read_b32 v33, a186
    v_accvgpr_read_b32 v31, a187
    v_mfma_f32_16x16x32_bf16 v[228:231], v[52:55], v[76:79], v[228:231]
    v_cvt_pk_bf16_f32 v33, v33, v31
    v_accvgpr_read_b32 v34, a188
    v_mfma_f32_16x16x32_bf16 v[232:235], v[48:51], v[80:83], v[232:235]
    v_accvgpr_read_b32 v31, a189
    v_cvt_pk_bf16_f32 v34, v34, v31
    v_mfma_f32_16x16x32_bf16 v[232:235], v[52:55], v[84:87], v[232:235]
    s_add_u32 m0, s69, 131072
    v_accvgpr_read_b32 v35, a190
    v_accvgpr_read_b32 v31, a191
    v_mfma_f32_16x16x32_bf16 v[236:239], v[48:51], v[88:91], v[236:239]
    buffer_load_dwordx4 v2, s[24:27], s60 offen lds
    v_mfma_f32_16x16x32_bf16 v[236:239], v[52:55], v[92:95], v[236:239]
    ds_read_b64_tr_b16 v[48:49], v27 offset:32768
    ds_read_b64_tr_b16 v[50:51], v27 offset:33280
    v_mfma_f32_16x16x32_bf16 v[240:243], v[56:59], v[64:67], v[240:243]
    ds_read_b64_tr_b16 v[52:53], v27 offset:36864
    ds_read_b64_tr_b16 v[54:55], v27 offset:37376
    v_mfma_f32_16x16x32_bf16 v[240:243], v[60:63], v[68:71], v[240:243]
    s_add_u32 s72, s71, 35840
    v_add_u32 v27, 0x10000, v27
    v_cvt_pk_bf16_f32 v35, v35, v31
    v_mfma_f32_16x16x32_bf16 v[244:247], v[56:59], v[72:75], v[244:247]
    buffer_load_dwordx4 v3, s[24:27], s60 offen offset:1024 lds
    v_mfma_f32_16x16x32_bf16 v[244:247], v[60:63], v[76:79], v[244:247]
    buffer_store_dwordx4 v[32:35], v1, s[36:39], s72 offen sc1
    v_mfma_f32_16x16x32_bf16 v[248:251], v[56:59], v[80:83], v[248:251]
    v_accvgpr_write_b32 a175, 0
    v_accvgpr_write_b32 a176, 0
    v_mfma_f32_16x16x32_bf16 v[248:251], v[60:63], v[84:87], v[248:251]
    v_accvgpr_write_b32 a177, 0
    v_accvgpr_write_b32 a178, 0
    v_mfma_f32_16x16x32_bf16 v[252:255], v[56:59], v[88:91], v[252:255]
    buffer_load_dwordx4 v4, s[24:27], s60 offen offset:2048 lds
    v_mfma_f32_16x16x32_bf16 v[252:255], v[60:63], v[92:95], v[252:255]
    s_waitcnt lgkmcnt(0)
    ds_read_b64_tr_b16 v[56:57], v28 offset:32768
    ds_read_b64_tr_b16 v[58:59], v28 offset:33280
    v_mfma_f32_16x16x32_bf16 a[64:67], v[40:43], v[64:67], a[64:67]
    ds_read_b64_tr_b16 v[60:61], v28 offset:36864
    ds_read_b64_tr_b16 v[62:63], v28 offset:37376
    v_mfma_f32_16x16x32_bf16 a[64:67], v[44:47], v[68:71], a[64:67]
    v_add_u32 v28, 0x10000, v28
    v_accvgpr_write_b32 a179, 0
    v_mfma_f32_16x16x32_bf16 a[68:71], v[40:43], v[72:75], a[68:71]
    buffer_load_dwordx4 v5, s[24:27], s60 offen offset:3072 lds
    v_mfma_f32_16x16x32_bf16 a[68:71], v[44:47], v[76:79], a[68:71]
    ds_read_b128 v[112:115], v24 offset:49152
    v_accvgpr_write_b32 a180, 0
    v_mfma_f32_16x16x32_bf16 a[72:75], v[40:43], v[80:83], a[72:75]
    v_accvgpr_write_b32 a181, 0
    v_accvgpr_write_b32 a182, 0
    v_mfma_f32_16x16x32_bf16 a[72:75], v[44:47], v[84:87], a[72:75]
    s_add_u32 m0, s69, 147456
    v_accvgpr_write_b32 a183, 0
    v_accvgpr_write_b32 a184, 0
    v_mfma_f32_16x16x32_bf16 a[76:79], v[40:43], v[88:91], a[76:79]
    s_xor_b32 s60, s60, 524288
    buffer_load_dwordx4 v10, s[20:23], s63 offen lds
    v_mfma_f32_16x16x32_bf16 a[76:79], v[44:47], v[92:95], a[76:79]
    ds_read_b128 v[116:119], v25 offset:49152
    v_accvgpr_read_b32 v32, a192
    v_mfma_f32_16x16x32_bf16 a[128:131], v[40:43], a[136:139], a[128:131]
    ds_read_b64_tr_b16 v[40:41], v29 offset:32768
    ds_read_b64_tr_b16 v[42:43], v29 offset:33280
    v_mfma_f32_16x16x32_bf16 a[128:131], v[44:47], a[140:143], a[128:131]
    ds_read_b64_tr_b16 v[44:45], v29 offset:36864
    ds_read_b64_tr_b16 v[46:47], v29 offset:37376
    v_mfma_f32_16x16x32_bf16 a[80:83], v[48:51], v[64:67], a[80:83]
    buffer_load_dwordx4 v11, s[20:23], s63 offen offset:1024 lds
    v_mfma_f32_16x16x32_bf16 a[80:83], v[52:55], v[68:71], a[80:83]
    ds_read_b128 v[120:123], v24 offset:57344
    v_add_u32 v29, 0x10000, v29
    v_mfma_f32_16x16x32_bf16 a[84:87], v[48:51], v[72:75], a[84:87]
    v_accvgpr_read_b32 v31, a193
    v_cvt_pk_bf16_f32 v32, v32, v31
    v_mfma_f32_16x16x32_bf16 a[84:87], v[52:55], v[76:79], a[84:87]
    v_accvgpr_read_b32 v33, a194
    v_accvgpr_read_b32 v31, a195
    v_mfma_f32_16x16x32_bf16 a[88:91], v[48:51], v[80:83], a[88:91]
    buffer_load_dwordx4 v12, s[20:23], s63 offen offset:2048 lds
    v_mfma_f32_16x16x32_bf16 a[88:91], v[52:55], v[84:87], a[88:91]
    s_add_u32 s72, s71, 4096
    ds_read_b128 v[124:127], v25 offset:57344
    v_cvt_pk_bf16_f32 v33, v33, v31
    v_mfma_f32_16x16x32_bf16 a[92:95], v[48:51], v[88:91], a[92:95]
    v_accvgpr_read_b32 v34, a196
    v_accvgpr_read_b32 v31, a197
    v_mfma_f32_16x16x32_bf16 a[92:95], v[52:55], v[92:95], a[92:95]
    v_cvt_pk_bf16_f32 v34, v34, v31
    v_accvgpr_read_b32 v35, a198
    v_mfma_f32_16x16x32_bf16 a[132:135], v[48:51], a[136:139], a[132:135]
    buffer_load_dwordx4 v13, s[20:23], s63 offen offset:3072 lds
    v_mfma_f32_16x16x32_bf16 a[132:135], v[52:55], a[140:143], a[132:135]
    s_waitcnt lgkmcnt(1)
    v_accvgpr_read_b32 v31, a199
    v_cvt_pk_bf16_f32 v35, v35, v31
    v_mfma_f32_16x16x32_bf16 a[96:99], v[56:59], v[64:67], a[96:99]
    v_accvgpr_write_b32 a185, 0
    v_accvgpr_write_b32 a186, 0
    v_mfma_f32_16x16x32_bf16 a[96:99], v[60:63], v[68:71], a[96:99]
    s_xor_b32 s63, s63, 1920
    v_accvgpr_write_b32 a187, 0
    v_accvgpr_write_b32 a188, 0
    v_mfma_f32_16x16x32_bf16 a[100:103], v[56:59], v[72:75], a[100:103]
    s_andn2_b32 s63, s63, 896
    buffer_store_dwordx4 v[32:35], v1, s[36:39], s72 offen sc1
    v_mfma_f32_16x16x32_bf16 a[100:103], v[60:63], v[76:79], a[100:103]
    v_accvgpr_write_b32 a189, 0
    v_accvgpr_write_b32 a190, 0
    v_mfma_f32_16x16x32_bf16 a[104:107], v[56:59], v[80:83], a[104:107]
    v_accvgpr_write_b32 a191, 0
    v_accvgpr_write_b32 a192, 0
    v_mfma_f32_16x16x32_bf16 a[104:107], v[60:63], v[84:87], a[104:107]
    s_waitcnt vmcnt(10) lgkmcnt(0)
    s_barrier
    ds_read_b64_tr_b16 v[48:49], v14 offset:0
    v_mfma_f32_16x16x32_bf16 a[108:111], v[56:59], v[88:91], a[108:111]
    s_add_u32 m0, s67, 0
    ds_read_b64_tr_b16 v[50:51], v14 offset:1024
    ds_read_b64_tr_b16 v[52:53], v14 offset:8192
    v_mfma_f32_16x16x32_bf16 a[108:111], v[60:63], v[92:95], a[108:111]
    buffer_load_dwordx4 v1, s[28:31], s65 offen sc1 lds
    v_mfma_f32_16x16x32_bf16 a[112:115], v[40:43], v[64:67], a[112:115]
    ds_read_b64_tr_b16 v[54:55], v14 offset:9216
    ds_read_b64_tr_b16 v[56:57], v15 offset:0
    v_mfma_f32_16x16x32_bf16 a[112:115], v[44:47], v[68:71], a[112:115]
    ds_read_b64_tr_b16 v[58:59], v15 offset:1024
    ds_read_b64_tr_b16 v[60:61], v15 offset:8192
    v_mfma_f32_16x16x32_bf16 a[116:119], v[40:43], v[72:75], a[116:119]
    ds_read_b64_tr_b16 v[62:63], v15 offset:9216
    ds_read_b128 a[136:139], v22 offset:32768
    v_mfma_f32_16x16x32_bf16 a[116:119], v[44:47], v[76:79], a[116:119]
    ds_read_b128 a[140:143], v23 offset:32768
    v_add_u32 v14, 0x10000, v14
    v_mfma_f32_16x16x32_bf16 a[120:123], v[40:43], v[80:83], a[120:123]
    v_add_u32 v15, 0x10000, v15
    v_add_u32 v22, 0xffff0000, v22
    v_mfma_f32_16x16x32_bf16 a[120:123], v[44:47], v[84:87], a[120:123]
    v_add_u32 v23, 0xffff0000, v23
    v_accvgpr_read_b32 v32, a200
    v_mfma_f32_16x16x32_bf16 a[124:127], v[40:43], v[88:91], a[124:127]
    buffer_load_dwordx4 v1, s[28:31], s65 offen offset:1024 sc1 lds
    v_mfma_f32_16x16x32_bf16 a[124:127], v[44:47], v[92:95], a[124:127]
    s_waitcnt lgkmcnt(1)
    ds_read_b64_tr_b16 v[40:41], v16 offset:0
    ds_read_b64_tr_b16 v[42:43], v16 offset:1024
    v_mfma_f32_16x16x32_bf16 v[128:131], v[48:51], v[96:99], v[128:131]
    ds_read_b64_tr_b16 v[44:45], v16 offset:8192
    ds_read_b64_tr_b16 v[46:47], v16 offset:9216
    v_mfma_f32_16x16x32_bf16 v[128:131], v[52:55], v[100:103], v[128:131]
    s_add_u32 s72, s71, 5120
    v_add_u32 v24, 0x10000, v24
    v_add_u32 v16, 0x10000, v16
    v_mfma_f32_16x16x32_bf16 v[132:135], v[48:51], v[104:107], v[132:135]
    ds_read_b128 v[64:67], v24 offset:16384
    v_accvgpr_read_b32 v31, a201
    v_mfma_f32_16x16x32_bf16 v[132:135], v[52:55], v[108:111], v[132:135]
    v_cvt_pk_bf16_f32 v32, v32, v31
    v_accvgpr_read_b32 v33, a202
    v_mfma_f32_16x16x32_bf16 v[136:139], v[48:51], v[112:115], v[136:139]
    v_accvgpr_read_b32 v31, a203
    v_cvt_pk_bf16_f32 v33, v33, v31
    v_mfma_f32_16x16x32_bf16 v[136:139], v[52:55], v[116:119], v[136:139]
    v_accvgpr_read_b32 v34, a204
    v_accvgpr_read_b32 v31, a205
    v_mfma_f32_16x16x32_bf16 v[140:143], v[48:51], v[120:123], v[140:143]
    s_add_u32 m0, s68, 8192
    ds_read_b64_tr_b16 v[48:49], v17 offset:0
    ds_read_b64_tr_b16 v[50:51], v17 offset:1024
    v_mfma_f32_16x16x32_bf16 v[140:143], v[52:55], v[124:127], v[140:143]
    buffer_load_dwordx4 v6, s[20:23], s66 offen lds
    v_mfma_f32_16x16x32_bf16 v[144:147], v[56:59], v[96:99], v[144:147]
    ds_read_b64_tr_b16 v[52:53], v17 offset:8192
    ds_read_b64_tr_b16 v[54:55], v17 offset:9216
    v_mfma_f32_16x16x32_bf16 v[144:147], v[60:63], v[100:103], v[144:147]
    v_add_u32 v17, 0x10000, v17
    v_cvt_pk_bf16_f32 v34, v34, v31
    v_mfma_f32_16x16x32_bf16 v[148:151], v[56:59], v[104:107], v[148:151]
    v_accvgpr_read_b32 v35, a206
    v_accvgpr_read_b32 v31, a207
    v_mfma_f32_16x16x32_bf16 v[148:151], v[60:63], v[108:111], v[148:151]
    v_cvt_pk_bf16_f32 v35, v35, v31
    v_accvgpr_write_b32 a193, 0
    v_mfma_f32_16x16x32_bf16 v[152:155], v[56:59], v[112:115], v[152:155]
    v_add_u32 v25, 0x10000, v25
    v_accvgpr_write_b32 a194, 0
    v_mfma_f32_16x16x32_bf16 v[152:155], v[60:63], v[116:119], v[152:155]
    ds_read_b128 v[68:71], v25 offset:16384
    v_accvgpr_write_b32 a195, 0
    v_mfma_f32_16x16x32_bf16 v[156:159], v[56:59], v[120:123], v[156:159]
    s_add_u32 m0, s69, 16384
    ds_read_b64_tr_b16 v[56:57], v18 offset:0
    ds_read_b64_tr_b16 v[58:59], v18 offset:1024
    v_mfma_f32_16x16x32_bf16 v[156:159], v[60:63], v[124:127], v[156:159]
    s_xor_b32 s65, s65, 8192
    buffer_load_dwordx4 v10, s[20:23], s64 offen lds
    s_waitcnt lgkmcnt(3)
    v_mfma_f32_16x16x32_bf16 v[160:163], v[40:43], v[96:99], v[160:163]
    s_xor_b32 s66, s66, 128
    ds_read_b64_tr_b16 v[60:61], v18 offset:8192
    ds_read_b64_tr_b16 v[62:63], v18 offset:9216
    v_mfma_f32_16x16x32_bf16 v[160:163], v[44:47], v[100:103], v[160:163]
    v_add_u32 v18, 0x10000, v18
    v_accvgpr_read_b32 v31, a209
    v_mfma_f32_16x16x32_bf16 v[164:167], v[40:43], v[104:107], v[164:167]
    buffer_store_dwordx4 v[32:35], v1, s[36:39], s72 offen sc1
    v_mfma_f32_16x16x32_bf16 v[164:167], v[44:47], v[108:111], v[164:167]
    v_accvgpr_write_b32 a196, 0
    v_accvgpr_read_b32 v32, a208
    v_mfma_f32_16x16x32_bf16 v[168:171], v[40:43], v[112:115], v[168:171]
    v_cvt_pk_bf16_f32 v32, v32, v31
    v_accvgpr_read_b32 v33, a210
    v_mfma_f32_16x16x32_bf16 v[168:171], v[44:47], v[116:119], v[168:171]
    v_accvgpr_read_b32 v31, a211
    v_cvt_pk_bf16_f32 v33, v33, v31
    v_mfma_f32_16x16x32_bf16 v[172:175], v[40:43], v[120:123], v[172:175]
    ds_read_b64_tr_b16 v[40:41], v19 offset:0
    ds_read_b64_tr_b16 v[42:43], v19 offset:1024
    v_mfma_f32_16x16x32_bf16 v[172:175], v[44:47], v[124:127], v[172:175]
    s_add_u32 s72, s71, 36864
    ds_read_b64_tr_b16 v[44:45], v19 offset:8192
    ds_read_b64_tr_b16 v[46:47], v19 offset:9216
    v_mfma_f32_16x16x32_bf16 v[176:179], v[48:51], v[96:99], v[176:179]
    buffer_load_dwordx4 v11, s[20:23], s64 offen offset:1024 lds
    v_mfma_f32_16x16x32_bf16 v[176:179], v[52:55], v[100:103], v[176:179]
    ds_read_b128 v[72:75], v24 offset:24576
    v_add_u32 v19, 0x10000, v19
    v_mfma_f32_16x16x32_bf16 v[180:183], v[48:51], v[104:107], v[180:183]
    v_accvgpr_read_b32 v34, a212
    v_accvgpr_read_b32 v31, a213
    v_mfma_f32_16x16x32_bf16 v[180:183], v[52:55], v[108:111], v[180:183]
    v_cvt_pk_bf16_f32 v34, v34, v31
    v_accvgpr_read_b32 v35, a214
    v_mfma_f32_16x16x32_bf16 v[184:187], v[48:51], v[112:115], v[184:187]
    v_accvgpr_read_b32 v31, a215
    v_cvt_pk_bf16_f32 v35, v35, v31
    v_mfma_f32_16x16x32_bf16 v[184:187], v[52:55], v[116:119], v[184:187]
    buffer_store_dwordx4 v[32:35], v1, s[36:39], s72 offen sc1
    v_mfma_f32_16x16x32_bf16 v[188:191], v[48:51], v[120:123], v[188:191]
    ds_read_b64_tr_b16 v[48:49], v20 offset:0
    ds_read_b64_tr_b16 v[50:51], v20 offset:1024
    v_mfma_f32_16x16x32_bf16 v[188:191], v[52:55], v[124:127], v[188:191]
    s_waitcnt lgkmcnt(2)
    ds_read_b64_tr_b16 v[52:53], v20 offset:8192
    ds_read_b64_tr_b16 v[54:55], v20 offset:9216
    v_mfma_f32_16x16x32_bf16 v[192:195], v[56:59], v[96:99], v[192:195]
    buffer_load_dwordx4 v12, s[20:23], s64 offen offset:2048 lds
    v_mfma_f32_16x16x32_bf16 v[192:195], v[60:63], v[100:103], v[192:195]
    v_add_u32 v20, 0x10000, v20
    v_accvgpr_write_b32 a197, 0
    v_mfma_f32_16x16x32_bf16 v[196:199], v[56:59], v[104:107], v[196:199]
    v_accvgpr_write_b32 a198, 0
    v_accvgpr_write_b32 a199, 0
    v_mfma_f32_16x16x32_bf16 v[196:199], v[60:63], v[108:111], v[196:199]
    ds_read_b128 v[76:79], v25 offset:24576
    v_accvgpr_write_b32 a200, 0
    v_mfma_f32_16x16x32_bf16 v[200:203], v[56:59], v[112:115], v[200:203]
    v_accvgpr_read_b32 v32, a216
    v_accvgpr_read_b32 v31, a217
    v_mfma_f32_16x16x32_bf16 v[200:203], v[60:63], v[116:119], v[200:203]
    v_cvt_pk_bf16_f32 v32, v32, v31
    v_accvgpr_read_b32 v33, a218
    v_mfma_f32_16x16x32_bf16 v[204:207], v[56:59], v[120:123], v[204:207]
    ds_read_b64_tr_b16 v[56:57], v21 offset:0
    ds_read_b64_tr_b16 v[58:59], v21 offset:1024
    v_mfma_f32_16x16x32_bf16 v[204:207], v[60:63], v[124:127], v[204:207]
    ds_read_b64_tr_b16 v[60:61], v21 offset:8192
    ds_read_b64_tr_b16 v[62:63], v21 offset:9216
    v_mfma_f32_16x16x32_bf16 v[208:211], v[40:43], v[96:99], v[208:211]
    v_add_u32 v21, 0x10000, v21
    v_accvgpr_read_b32 v31, a219
    v_mfma_f32_16x16x32_bf16 v[208:211], v[44:47], v[100:103], v[208:211]
    buffer_load_dwordx4 v13, s[20:23], s64 offen offset:3072 lds
    v_mfma_f32_16x16x32_bf16 v[212:215], v[40:43], v[104:107], v[212:215]
    v_cvt_pk_bf16_f32 v33, v33, v31
    v_accvgpr_read_b32 v34, a220
    v_mfma_f32_16x16x32_bf16 v[212:215], v[44:47], v[108:111], v[212:215]
    v_accvgpr_read_b32 v31, a221
    v_cvt_pk_bf16_f32 v34, v34, v31
    v_mfma_f32_16x16x32_bf16 v[216:219], v[40:43], v[112:115], v[216:219]
    v_accvgpr_read_b32 v35, a222
    v_accvgpr_read_b32 v31, a223
    v_mfma_f32_16x16x32_bf16 v[216:219], v[44:47], v[116:119], v[216:219]
    s_add_u32 s72, s71, 37888
    v_cvt_pk_bf16_f32 v35, v35, v31
    v_accvgpr_write_b32 a201, 0
    v_mfma_f32_16x16x32_bf16 v[220:223], v[40:43], v[120:123], v[220:223]
    ds_read_b64_tr_b16 v[40:41], v26 offset:32768
    ds_read_b64_tr_b16 v[42:43], v26 offset:33280
    v_mfma_f32_16x16x32_bf16 v[220:223], v[44:47], v[124:127], v[220:223]
    s_waitcnt lgkmcnt(2)
    ds_read_b64_tr_b16 v[44:45], v26 offset:36864
    ds_read_b64_tr_b16 v[46:47], v26 offset:37376
    v_mfma_f32_16x16x32_bf16 v[224:227], v[48:51], v[96:99], v[224:227]
    v_add_u32 v26, 0xffff0000, v26
    v_accvgpr_write_b32 a202, 0
    v_mfma_f32_16x16x32_bf16 v[224:227], v[52:55], v[100:103], v[224:227]
    s_xor_b32 s64, s64, 1920
    buffer_store_dwordx4 v[32:35], v1, s[36:39], s72 offen sc1
    v_mfma_f32_16x16x32_bf16 v[228:231], v[48:51], v[104:107], v[228:231]
    s_andn2_b32 s64, s64, 896
    v_accvgpr_write_b32 a203, 0
    v_accvgpr_write_b32 a204, 0
    v_mfma_f32_16x16x32_bf16 v[228:231], v[52:55], v[108:111], v[228:231]
    v_accvgpr_write_b32 a205, 0
    v_accvgpr_write_b32 a206, 0
    v_mfma_f32_16x16x32_bf16 v[232:235], v[48:51], v[112:115], v[232:235]
    v_accvgpr_write_b32 a207, 0
    v_accvgpr_write_b32 a208, 0
    v_mfma_f32_16x16x32_bf16 v[232:235], v[52:55], v[116:119], v[232:235]
    s_add_u32 m0, s69, 32768
    v_accvgpr_write_b32 a209, 0
    v_accvgpr_write_b32 a210, 0
    v_mfma_f32_16x16x32_bf16 v[236:239], v[48:51], v[120:123], v[236:239]
    buffer_load_dwordx4 v2, s[24:27], s60 offen lds
    v_mfma_f32_16x16x32_bf16 v[236:239], v[52:55], v[124:127], v[236:239]
    ds_read_b64_tr_b16 v[48:49], v27 offset:32768
    ds_read_b64_tr_b16 v[50:51], v27 offset:33280
    v_mfma_f32_16x16x32_bf16 v[240:243], v[56:59], v[96:99], v[240:243]
    ds_read_b64_tr_b16 v[52:53], v27 offset:36864
    ds_read_b64_tr_b16 v[54:55], v27 offset:37376
    v_mfma_f32_16x16x32_bf16 v[240:243], v[60:63], v[100:103], v[240:243]
    v_add_u32 v27, 0xffff0000, v27
    v_accvgpr_write_b32 a211, 0
    v_mfma_f32_16x16x32_bf16 v[244:247], v[56:59], v[104:107], v[244:247]
    buffer_load_dwordx4 v3, s[24:27], s60 offen offset:1024 lds
    v_mfma_f32_16x16x32_bf16 v[244:247], v[60:63], v[108:111], v[244:247]
    v_accvgpr_read_b32 v32, a224
    v_accvgpr_read_b32 v31, a225
    v_mfma_f32_16x16x32_bf16 v[248:251], v[56:59], v[112:115], v[248:251]
    v_cvt_pk_bf16_f32 v32, v32, v31
    v_accvgpr_read_b32 v33, a226
    v_mfma_f32_16x16x32_bf16 v[248:251], v[60:63], v[116:119], v[248:251]
    v_accvgpr_read_b32 v31, a227
    v_cvt_pk_bf16_f32 v33, v33, v31
    v_mfma_f32_16x16x32_bf16 v[252:255], v[56:59], v[120:123], v[252:255]
    buffer_load_dwordx4 v4, s[24:27], s60 offen offset:2048 lds
    v_mfma_f32_16x16x32_bf16 v[252:255], v[60:63], v[124:127], v[252:255]
    s_waitcnt lgkmcnt(0)
    ds_read_b64_tr_b16 v[56:57], v28 offset:32768
    ds_read_b64_tr_b16 v[58:59], v28 offset:33280
    v_mfma_f32_16x16x32_bf16 a[64:67], v[40:43], v[96:99], a[64:67]
    ds_read_b64_tr_b16 v[60:61], v28 offset:36864
    ds_read_b64_tr_b16 v[62:63], v28 offset:37376
    v_mfma_f32_16x16x32_bf16 a[64:67], v[44:47], v[100:103], a[64:67]
    v_add_u32 v28, 0xffff0000, v28
    v_accvgpr_read_b32 v34, a228
    v_mfma_f32_16x16x32_bf16 a[68:71], v[40:43], v[104:107], a[68:71]
    buffer_load_dwordx4 v5, s[24:27], s60 offen offset:3072 lds
    v_mfma_f32_16x16x32_bf16 a[68:71], v[44:47], v[108:111], a[68:71]
    s_add_u32 s72, s71, 6144
    ds_read_b128 v[80:83], v24 offset:49152
    v_accvgpr_read_b32 v31, a229
    v_mfma_f32_16x16x32_bf16 a[72:75], v[40:43], v[112:115], a[72:75]
    v_cvt_pk_bf16_f32 v34, v34, v31
    v_accvgpr_read_b32 v35, a230
    v_mfma_f32_16x16x32_bf16 a[72:75], v[44:47], v[116:119], a[72:75]
    s_xor_b32 s60, s60, 7864320
    v_accvgpr_read_b32 v31, a231
    v_cvt_pk_bf16_f32 v35, v35, v31
    v_mfma_f32_16x16x32_bf16 a[76:79], v[40:43], v[120:123], a[76:79]
    s_add_u32 m0, s69, 49152
    ds_read_b128 v[84:87], v25 offset:49152
    v_accvgpr_write_b32 a212, 0
    v_mfma_f32_16x16x32_bf16 a[76:79], v[44:47], v[124:127], a[76:79]
    s_andn2_b32 s60, s60, 3670016
    buffer_load_dwordx4 v10, s[20:23], s63 offen lds
    v_mfma_f32_16x16x32_bf16 a[128:131], v[40:43], a[136:139], a[128:131]
    ds_read_b64_tr_b16 v[40:41], v29 offset:32768
    ds_read_b64_tr_b16 v[42:43], v29 offset:33280
    v_mfma_f32_16x16x32_bf16 a[128:131], v[44:47], a[140:143], a[128:131]
    ds_read_b64_tr_b16 v[44:45], v29 offset:36864
    ds_read_b64_tr_b16 v[46:47], v29 offset:37376
    v_mfma_f32_16x16x32_bf16 a[80:83], v[48:51], v[96:99], a[80:83]
    buffer_load_dwordx4 v11, s[20:23], s63 offen offset:1024 lds
    v_mfma_f32_16x16x32_bf16 a[80:83], v[52:55], v[100:103], a[80:83]
    ds_read_b128 v[88:91], v24 offset:57344
    v_add_u32 v29, 0xffff0000, v29
    v_mfma_f32_16x16x32_bf16 a[84:87], v[48:51], v[104:107], a[84:87]
    buffer_store_dwordx4 v[32:35], v1, s[36:39], s72 offen sc1
    v_mfma_f32_16x16x32_bf16 a[84:87], v[52:55], v[108:111], a[84:87]
    v_accvgpr_write_b32 a213, 0
    v_accvgpr_write_b32 a214, 0
    v_mfma_f32_16x16x32_bf16 a[88:91], v[48:51], v[112:115], a[88:91]
    ds_read_b128 v[92:95], v25 offset:57344
    v_accvgpr_write_b32 a215, 0
    v_mfma_f32_16x16x32_bf16 a[88:91], v[52:55], v[116:119], a[88:91]
    buffer_load_dwordx4 v12, s[20:23], s63 offen offset:2048 lds
    v_mfma_f32_16x16x32_bf16 a[92:95], v[48:51], v[120:123], a[92:95]
    v_accvgpr_read_b32 v32, a232
    v_accvgpr_read_b32 v31, a233
    v_mfma_f32_16x16x32_bf16 a[92:95], v[52:55], v[124:127], a[92:95]
    v_cvt_pk_bf16_f32 v32, v32, v31
    v_accvgpr_read_b32 v33, a234
    v_mfma_f32_16x16x32_bf16 a[132:135], v[48:51], a[136:139], a[132:135]
    v_accvgpr_read_b32 v31, a235
    v_cvt_pk_bf16_f32 v33, v33, v31
    v_mfma_f32_16x16x32_bf16 a[132:135], v[52:55], a[140:143], a[132:135]
    s_waitcnt lgkmcnt(0)
    buffer_load_dwordx4 v13, s[20:23], s63 offen offset:3072 lds
    v_mfma_f32_16x16x32_bf16 a[96:99], v[56:59], v[96:99], a[96:99]
    v_accvgpr_read_b32 v34, a236
    v_accvgpr_read_b32 v31, a237
    v_mfma_f32_16x16x32_bf16 a[96:99], v[60:63], v[100:103], a[96:99]
    s_xor_b32 s63, s63, 128
    v_cvt_pk_bf16_f32 v34, v34, v31
    v_accvgpr_read_b32 v35, a238
    v_mfma_f32_16x16x32_bf16 a[100:103], v[56:59], v[104:107], a[100:103]
    v_accvgpr_read_b32 v31, a239
    v_cvt_pk_bf16_f32 v35, v35, v31
    v_mfma_f32_16x16x32_bf16 a[100:103], v[60:63], v[108:111], a[100:103]
    v_accvgpr_write_b32 a216, 0
    v_accvgpr_write_b32 a217, 0
    v_mfma_f32_16x16x32_bf16 a[104:107], v[56:59], v[112:115], a[104:107]
    v_accvgpr_write_b32 a218, 0
    v_accvgpr_write_b32 a219, 0
    v_mfma_f32_16x16x32_bf16 a[104:107], v[60:63], v[116:119], a[104:107]
    s_waitcnt vmcnt(10) lgkmcnt(0)
    s_barrier
    ds_read_b64_tr_b16 v[48:49], v14 offset:0
    v_mfma_f32_16x16x32_bf16 a[108:111], v[56:59], v[120:123], a[108:111]
    s_add_u32 m0, s67, 65536
    ds_read_b64_tr_b16 v[50:51], v14 offset:1024
    ds_read_b64_tr_b16 v[52:53], v14 offset:8192
    v_mfma_f32_16x16x32_bf16 a[108:111], v[60:63], v[124:127], a[108:111]
    s_add_u32 s72, s71, 7168
    buffer_load_dwordx4 v1, s[28:31], s65 offen sc1 lds
    v_mfma_f32_16x16x32_bf16 a[112:115], v[40:43], v[96:99], a[112:115]
    ds_read_b64_tr_b16 v[54:55], v14 offset:9216
    ds_read_b64_tr_b16 v[56:57], v15 offset:0
    v_mfma_f32_16x16x32_bf16 a[112:115], v[44:47], v[100:103], a[112:115]
    ds_read_b64_tr_b16 v[58:59], v15 offset:1024
    ds_read_b64_tr_b16 v[60:61], v15 offset:8192
    v_mfma_f32_16x16x32_bf16 a[116:119], v[40:43], v[104:107], a[116:119]
    ds_read_b64_tr_b16 v[62:63], v15 offset:9216
    ds_read_b128 a[136:139], v22 offset:0
    v_mfma_f32_16x16x32_bf16 a[116:119], v[44:47], v[108:111], a[116:119]
    ds_read_b128 a[140:143], v23 offset:0
    v_add_u32 v14, 0xfffe0000, v14
    v_mfma_f32_16x16x32_bf16 a[120:123], v[40:43], v[112:115], a[120:123]
    v_add_u32 v15, 0xfffe0000, v15
    v_add_u32 v22, 0x10000, v22
    v_mfma_f32_16x16x32_bf16 a[120:123], v[44:47], v[116:119], a[120:123]
    v_add_u32 v23, 0x10000, v23
    v_accvgpr_write_b32 a220, 0
    v_mfma_f32_16x16x32_bf16 a[124:127], v[40:43], v[120:123], a[124:127]
    buffer_load_dwordx4 v1, s[28:31], s65 offen offset:1024 sc1 lds
    v_mfma_f32_16x16x32_bf16 a[124:127], v[44:47], v[124:127], a[124:127]
    s_waitcnt lgkmcnt(1)
    ds_read_b64_tr_b16 v[40:41], v16 offset:0
    ds_read_b64_tr_b16 v[42:43], v16 offset:1024
    v_mfma_f32_16x16x32_bf16 v[128:131], v[48:51], v[64:67], v[128:131]
    ds_read_b64_tr_b16 v[44:45], v16 offset:8192
    ds_read_b64_tr_b16 v[46:47], v16 offset:9216
    v_mfma_f32_16x16x32_bf16 v[128:131], v[52:55], v[68:71], v[128:131]
    v_add_u32 v24, 0x10000, v24
    v_add_u32 v16, 0xfffe0000, v16
    v_mfma_f32_16x16x32_bf16 v[132:135], v[48:51], v[72:75], v[132:135]
    ds_read_b128 v[96:99], v24 offset:16384
    v_accvgpr_read_b32 v31, a241
    v_mfma_f32_16x16x32_bf16 v[132:135], v[52:55], v[76:79], v[132:135]
    buffer_store_dwordx4 v[32:35], v1, s[36:39], s72 offen sc1
    v_mfma_f32_16x16x32_bf16 v[136:139], v[48:51], v[80:83], v[136:139]
    v_accvgpr_write_b32 a221, 0
    v_accvgpr_read_b32 v32, a240
    v_mfma_f32_16x16x32_bf16 v[136:139], v[52:55], v[84:87], v[136:139]
    v_cvt_pk_bf16_f32 v32, v32, v31
    v_accvgpr_read_b32 v33, a242
    v_mfma_f32_16x16x32_bf16 v[140:143], v[48:51], v[88:91], v[140:143]
    s_add_u32 m0, s68, 73728
    ds_read_b64_tr_b16 v[48:49], v17 offset:0
    ds_read_b64_tr_b16 v[50:51], v17 offset:1024
    v_mfma_f32_16x16x32_bf16 v[140:143], v[52:55], v[92:95], v[140:143]
    buffer_load_dwordx4 v6, s[20:23], s66 offen lds
    v_mfma_f32_16x16x32_bf16 v[144:147], v[56:59], v[64:67], v[144:147]
    ds_read_b64_tr_b16 v[52:53], v17 offset:8192
    ds_read_b64_tr_b16 v[54:55], v17 offset:9216
    v_mfma_f32_16x16x32_bf16 v[144:147], v[60:63], v[68:71], v[144:147]
    v_add_u32 v17, 0xfffe0000, v17
    v_accvgpr_read_b32 v31, a243
    v_mfma_f32_16x16x32_bf16 v[148:151], v[56:59], v[72:75], v[148:151]
    v_cvt_pk_bf16_f32 v33, v33, v31
    v_accvgpr_read_b32 v34, a244
    v_mfma_f32_16x16x32_bf16 v[148:151], v[60:63], v[76:79], v[148:151]
    s_add_u32 s72, s71, 38912
    v_accvgpr_read_b32 v31, a245
    v_cvt_pk_bf16_f32 v34, v34, v31
    v_mfma_f32_16x16x32_bf16 v[152:155], v[56:59], v[80:83], v[152:155]
    v_add_u32 v25, 0x10000, v25
    v_accvgpr_read_b32 v35, a246
    v_mfma_f32_16x16x32_bf16 v[152:155], v[60:63], v[84:87], v[152:155]
    ds_read_b128 v[100:103], v25 offset:16384
    v_accvgpr_read_b32 v31, a247
    v_mfma_f32_16x16x32_bf16 v[156:159], v[56:59], v[88:91], v[156:159]
    s_xor_b32 s65, s65, 122880
    ds_read_b64_tr_b16 v[56:57], v18 offset:0
    ds_read_b64_tr_b16 v[58:59], v18 offset:1024
    v_mfma_f32_16x16x32_bf16 v[156:159], v[60:63], v[92:95], v[156:159]
    s_xor_b32 s66, s66, 1920
    ds_read_b64_tr_b16 v[60:61], v18 offset:8192
    ds_read_b64_tr_b16 v[62:63], v18 offset:9216
    s_waitcnt lgkmcnt(5)
    v_mfma_f32_16x16x32_bf16 v[160:163], v[40:43], v[64:67], v[160:163]
    s_add_u32 m0, s69, 81920
    v_add_u32 v18, 0xfffe0000, v18
    v_cvt_pk_bf16_f32 v35, v35, v31
    v_mfma_f32_16x16x32_bf16 v[160:163], v[44:47], v[68:71], v[160:163]
    s_andn2_b32 s65, s65, 57344
    s_andn2_b32 s66, s66, 896
    v_accvgpr_write_b32 a222, 0
    v_mfma_f32_16x16x32_bf16 v[164:167], v[40:43], v[72:75], v[164:167]
    buffer_load_dwordx4 v10, s[20:23], s64 offen lds
    v_mfma_f32_16x16x32_bf16 v[164:167], v[44:47], v[76:79], v[164:167]
    buffer_store_dwordx4 v[32:35], v1, s[36:39], s72 offen sc1
    v_mfma_f32_16x16x32_bf16 v[168:171], v[40:43], v[80:83], v[168:171]
    v_add_u32 v10, 0, v36
    v_accvgpr_write_b32 a223, 0
    v_mfma_f32_16x16x32_bf16 v[168:171], v[44:47], v[84:87], v[168:171]
    v_mfma_f32_16x16x32_bf16 v[172:175], v[40:43], v[88:91], v[172:175]
    ds_read_b64_tr_b16 v[40:41], v19 offset:0
    ds_read_b64_tr_b16 v[42:43], v19 offset:1024
    v_mfma_f32_16x16x32_bf16 v[172:175], v[44:47], v[92:95], v[172:175]
    ds_read_b64_tr_b16 v[44:45], v19 offset:8192
    ds_read_b64_tr_b16 v[46:47], v19 offset:9216
    v_mfma_f32_16x16x32_bf16 v[176:179], v[48:51], v[64:67], v[176:179]
    buffer_load_dwordx4 v11, s[20:23], s64 offen offset:1024 lds
    v_mfma_f32_16x16x32_bf16 v[176:179], v[52:55], v[68:71], v[176:179]
    ds_read_b128 v[104:107], v24 offset:24576
    v_add_u32 v19, 0xfffe0000, v19
    v_mfma_f32_16x16x32_bf16 v[180:183], v[48:51], v[72:75], v[180:183]
    v_accvgpr_read_b32 v32, a248
    v_accvgpr_read_b32 v31, a249
    v_mfma_f32_16x16x32_bf16 v[180:183], v[52:55], v[76:79], v[180:183]
    v_cvt_pk_bf16_f32 v32, v32, v31
    v_accvgpr_read_b32 v33, a250
    v_mfma_f32_16x16x32_bf16 v[184:187], v[48:51], v[80:83], v[184:187]
    v_accvgpr_read_b32 v31, a251
    v_cvt_pk_bf16_f32 v33, v33, v31
    v_mfma_f32_16x16x32_bf16 v[184:187], v[52:55], v[84:87], v[184:187]
    v_accvgpr_read_b32 v34, a252
    v_accvgpr_read_b32 v31, a253
    v_mfma_f32_16x16x32_bf16 v[188:191], v[48:51], v[88:91], v[188:191]
    ds_read_b64_tr_b16 v[48:49], v20 offset:0
    ds_read_b64_tr_b16 v[50:51], v20 offset:1024
    v_mfma_f32_16x16x32_bf16 v[188:191], v[52:55], v[92:95], v[188:191]
    s_waitcnt lgkmcnt(2)
    ds_read_b64_tr_b16 v[52:53], v20 offset:8192
    ds_read_b64_tr_b16 v[54:55], v20 offset:9216
    v_mfma_f32_16x16x32_bf16 v[192:195], v[56:59], v[64:67], v[192:195]
    buffer_load_dwordx4 v12, s[20:23], s64 offen offset:2048 lds
    v_mfma_f32_16x16x32_bf16 v[192:195], v[60:63], v[68:71], v[192:195]
    s_add_u32 s72, s71, 39936
    v_add_u32 v20, 0xfffe0000, v20
    v_cvt_pk_bf16_f32 v34, v34, v31
    v_mfma_f32_16x16x32_bf16 v[196:199], v[56:59], v[72:75], v[196:199]
    v_accvgpr_read_b32 v35, a254
    v_accvgpr_read_b32 v31, a255
    v_mfma_f32_16x16x32_bf16 v[196:199], v[60:63], v[76:79], v[196:199]
    ds_read_b128 v[108:111], v25 offset:24576
    v_cvt_pk_bf16_f32 v35, v35, v31
    v_mfma_f32_16x16x32_bf16 v[200:203], v[56:59], v[80:83], v[200:203]
    v_mov_b32 v31, 1
    v_add_u32 v11, 8192, v36
    v_mfma_f32_16x16x32_bf16 v[200:203], v[60:63], v[84:87], v[200:203]
    buffer_store_dwordx4 v[32:35], v1, s[36:39], s72 offen sc1
    v_mfma_f32_16x16x32_bf16 v[204:207], v[56:59], v[88:91], v[204:207]
    ds_read_b64_tr_b16 v[56:57], v21 offset:0
    ds_read_b64_tr_b16 v[58:59], v21 offset:1024
    v_mfma_f32_16x16x32_bf16 v[204:207], v[60:63], v[92:95], v[204:207]
    ds_read_b64_tr_b16 v[60:61], v21 offset:8192
    ds_read_b64_tr_b16 v[62:63], v21 offset:9216
    v_mfma_f32_16x16x32_bf16 v[208:211], v[40:43], v[64:67], v[208:211]
    v_add_u32 v21, 0xfffe0000, v21
    v_add_u32 v12, 16384, v36
    v_mfma_f32_16x16x32_bf16 v[208:211], v[44:47], v[68:71], v[208:211]
    buffer_load_dwordx4 v13, s[20:23], s64 offen offset:3072 lds
    v_mfma_f32_16x16x32_bf16 v[212:215], v[40:43], v[72:75], v[212:215]
    v_add_u32 v13, 24576, v36
    v_lshrrev_b32 v36, 8, v1
    v_mfma_f32_16x16x32_bf16 v[212:215], v[44:47], v[76:79], v[212:215]
    v_lshl_add_u32 v36, s7, 2, v36
    v_mul_u32_u24 v38, 171, v36
    v_mfma_f32_16x16x32_bf16 v[216:219], v[40:43], v[80:83], v[216:219]
    v_lshrrev_b32 v38, 9, v38
    v_mul_u32_u24 v39, 3, v38
    v_mfma_f32_16x16x32_bf16 v[216:219], v[44:47], v[84:87], v[216:219]
    v_sub_u32 v39, v36, v39
    v_lshl_add_u32 v39, v39, 3, v37
    v_mfma_f32_16x16x32_bf16 v[220:223], v[40:43], v[88:91], v[220:223]
    ds_read_b64_tr_b16 v[40:41], v26 offset:0
    ds_read_b64_tr_b16 v[42:43], v26 offset:512
    v_mfma_f32_16x16x32_bf16 v[220:223], v[44:47], v[92:95], v[220:223]
    s_waitcnt lgkmcnt(2)
    ds_read_b64_tr_b16 v[44:45], v26 offset:4096
    ds_read_b64_tr_b16 v[46:47], v26 offset:4608
    v_mfma_f32_16x16x32_bf16 v[224:227], v[48:51], v[64:67], v[224:227]
    v_add_u32 v26, 0x10000, v26
    v_mad_u32_u24 v38, v38, 18, v39
    v_mfma_f32_16x16x32_bf16 v[224:227], v[52:55], v[68:71], v[224:227]
    s_xor_b32 s64, s64, 128
    v_add_u32 v38, 0, v38
    v_mul_u32_u24 v38, 1152, v38
    v_mfma_f32_16x16x32_bf16 v[228:231], v[48:51], v[72:75], v[228:231]
    v_cmp_gt_u32 vcc, 18, v39
    v_add_u32 v38, s100, v38
    v_mfma_f32_16x16x32_bf16 v[228:231], v[52:55], v[76:79], v[228:231]
    v_mov_b32 v39, 1073741824
    v_cndmask_b32 v38, v39, v38, vcc
    v_mfma_f32_16x16x32_bf16 v[232:235], v[48:51], v[80:83], v[232:235]
    v_lshrrev_b32 v39, 6, v1
    v_mul_u32_u24 v39, 1152, v39
    v_mfma_f32_16x16x32_bf16 v[232:235], v[52:55], v[84:87], v[232:235]
    s_add_u32 m0, s69, 98304
    v_add_u32 v39, s98, v39
    v_add_u32 v39, 512, v39
    v_mfma_f32_16x16x32_bf16 v[236:239], v[48:51], v[88:91], v[236:239]
    buffer_load_dwordx4 v2, s[24:27], s60 offen lds
    v_mfma_f32_16x16x32_bf16 v[236:239], v[52:55], v[92:95], v[236:239]
    ds_read_b64_tr_b16 v[48:49], v27 offset:0
    ds_read_b64_tr_b16 v[50:51], v27 offset:512
    v_mfma_f32_16x16x32_bf16 v[240:243], v[56:59], v[64:67], v[240:243]
    ds_read_b64_tr_b16 v[52:53], v27 offset:4096
    ds_read_b64_tr_b16 v[54:55], v27 offset:4608
    v_mfma_f32_16x16x32_bf16 v[240:243], v[60:63], v[68:71], v[240:243]
    v_add_u32 v27, 0x10000, v27
    v_mfma_f32_16x16x32_bf16 v[244:247], v[56:59], v[72:75], v[244:247]
    buffer_load_dwordx4 v3, s[24:27], s60 offen offset:1024 lds
    v_mfma_f32_16x16x32_bf16 v[244:247], v[60:63], v[76:79], v[244:247]
    s_cmp_eq_u32 s4, 0
    s_cselect_b64 vcc, -1, 0
    v_cndmask_b32 v38, v38, v39, vcc
    v_mfma_f32_16x16x32_bf16 v[248:251], v[56:59], v[80:83], v[248:251]
    v_and_b32 v39, 0x30, v1
    v_add_u32 v2, v38, v39
    v_mfma_f32_16x16x32_bf16 v[248:251], v[60:63], v[84:87], v[248:251]
    v_mul_u32_u24 v38, 171, v36
    v_lshrrev_b32 v38, 9, v38
    v_mfma_f32_16x16x32_bf16 v[252:255], v[56:59], v[88:91], v[252:255]
    buffer_load_dwordx4 v4, s[24:27], s60 offen offset:2048 lds
    v_mfma_f32_16x16x32_bf16 v[252:255], v[60:63], v[92:95], v[252:255]
    s_waitcnt lgkmcnt(0)
    ds_read_b64_tr_b16 v[56:57], v28 offset:0
    ds_read_b64_tr_b16 v[58:59], v28 offset:512
    v_mfma_f32_16x16x32_bf16 a[64:67], v[40:43], v[64:67], a[64:67]
    ds_read_b64_tr_b16 v[60:61], v28 offset:4096
    ds_read_b64_tr_b16 v[62:63], v28 offset:4608
    v_mfma_f32_16x16x32_bf16 a[64:67], v[44:47], v[68:71], a[64:67]
    v_add_u32 v24, 0xfffe0000, v24
    v_add_u32 v28, 0x10000, v28
    v_mfma_f32_16x16x32_bf16 a[68:71], v[40:43], v[72:75], a[68:71]
    buffer_load_dwordx4 v5, s[24:27], s60 offen offset:3072 lds
    v_mfma_f32_16x16x32_bf16 a[68:71], v[44:47], v[76:79], a[68:71]
    ds_read_b128 v[112:115], v24 offset:16384
    v_mul_u32_u24 v39, 3, v38
    v_mfma_f32_16x16x32_bf16 a[72:75], v[40:43], v[80:83], a[72:75]
    v_sub_u32 v39, v36, v39
    v_lshl_add_u32 v39, v39, 3, v37
    v_mfma_f32_16x16x32_bf16 a[72:75], v[44:47], v[84:87], a[72:75]
    s_add_u32 m0, s69, 114688
    v_add_u32 v25, 0xfffe0000, v25
    v_mad_u32_u24 v38, v38, 18, v39
    v_mfma_f32_16x16x32_bf16 a[76:79], v[40:43], v[88:91], a[76:79]
    s_lshr_b32 s92, s2, 3
    buffer_load_dwordx4 v10, s[48:51], 0 offen nt lds
    v_mfma_f32_16x16x32_bf16 a[76:79], v[44:47], v[92:95], a[76:79]
    s_xor_b32 s60, s60, 524288
    ds_read_b128 v[116:119], v25 offset:16384
    v_lshrrev_b32 v9, 4, v1
    v_mfma_f32_16x16x32_bf16 a[128:131], v[40:43], a[136:139], a[128:131]
    s_lshl2_add_u32 s92, s92, s4
    v_min_u32 v9, 0, v9
    ds_read_b64_tr_b16 v[40:41], v29 offset:0
    v_mfma_f32_16x16x32_bf16 a[128:131], v[44:47], a[140:143], a[128:131]
    s_mul_i32 s92, s92, 1
    ds_read_b64_tr_b16 v[42:43], v29 offset:512
    ds_read_b64_tr_b16 v[44:45], v29 offset:4096
    v_mfma_f32_16x16x32_bf16 a[80:83], v[48:51], v[64:67], a[80:83]
    s_add_u32 s92, s92, 32
    v_add_lshl_u32 v9, v9, s92, 7
    ds_read_b128 v[120:123], v24 offset:24576
    v_mfma_f32_16x16x32_bf16 a[80:83], v[52:55], v[68:71], a[80:83]
    s_getpc_b64 s[92:93]
    global_load_dword v9, v9, s[92:93]
    v_mfma_f32_16x16x32_bf16 a[84:87], v[48:51], v[72:75], a[84:87]
    buffer_load_dwordx4 v11, s[48:51], 0 offen offset:1024 nt lds
    v_mfma_f32_16x16x32_bf16 a[84:87], v[52:55], v[76:79], a[84:87]
    ds_read_b64_tr_b16 v[46:47], v29 offset:4608
    v_add_u32 v29, 0x10000, v29
    v_mfma_f32_16x16x32_bf16 a[88:91], v[48:51], v[80:83], a[88:91]
    ds_read_b128 v[124:127], v25 offset:24576
    v_add_u32 v38, 4, v38
    v_mfma_f32_16x16x32_bf16 a[88:91], v[52:55], v[84:87], a[88:91]
    buffer_load_dwordx4 v12, s[48:51], 0 offen offset:2048 nt lds
    v_mfma_f32_16x16x32_bf16 a[92:95], v[48:51], v[88:91], a[92:95]
    v_mul_u32_u24 v38, 1152, v38
    v_cmp_gt_u32 vcc, 14, v39
    v_mfma_f32_16x16x32_bf16 a[92:95], v[52:55], v[92:95], a[92:95]
    v_add_u32 v38, s100, v38
    v_mov_b32 v39, 1073741824
    v_mfma_f32_16x16x32_bf16 a[132:135], v[48:51], a[136:139], a[132:135]
    v_cndmask_b32 v38, v39, v38, vcc
    v_lshrrev_b32 v39, 6, v1
    v_mfma_f32_16x16x32_bf16 a[132:135], v[52:55], a[140:143], a[132:135]
    s_waitcnt lgkmcnt(0)
    buffer_load_dwordx4 v13, s[48:51], 0 offen offset:3072 nt lds
    v_mfma_f32_16x16x32_bf16 a[96:99], v[56:59], v[64:67], a[96:99]
    v_mul_u32_u24 v39, 1152, v39
    v_add_u32 v39, s98, v39
    v_mfma_f32_16x16x32_bf16 a[96:99], v[60:63], v[68:71], a[96:99]
    v_add_u32 v39, 18944, v39
    v_bfe_u32 v37, v1, 4, 2
    v_mfma_f32_16x16x32_bf16 a[100:103], v[56:59], v[72:75], a[100:103]
    s_cmp_eq_u32 s4, 0
    s_cselect_b64 vcc, -1, 0
    v_cndmask_b32 v38, v38, v39, vcc
    v_mfma_f32_16x16x32_bf16 a[100:103], v[60:63], v[76:79], a[100:103]
    v_and_b32 v39, 0x30, v1
    v_add_u32 v3, v38, v39
    v_mfma_f32_16x16x32_bf16 a[104:107], v[56:59], v[80:83], a[104:107]
    v_lshlrev_b32 v37, 3, v37
    v_lshrrev_b32 v36, 6, v1
    v_mfma_f32_16x16x32_bf16 a[104:107], v[60:63], v[84:87], a[104:107]
    s_waitcnt vmcnt(9) lgkmcnt(0)
    s_barrier
    ds_read_b64_tr_b16 v[48:49], v14 offset:32768
    v_mfma_f32_16x16x32_bf16 a[108:111], v[56:59], v[88:91], a[108:111]
    s_add_u32 m0, s67, 131072
    buffer_store_dword v31, v30, s[32:35], s101 offen sc1
    v_mfma_f32_16x16x32_bf16 a[108:111], v[60:63], v[92:95], a[108:111]
    buffer_load_dwordx4 v1, s[28:31], s65 offen sc1 lds
    v_mfma_f32_16x16x32_bf16 a[112:115], v[40:43], v[64:67], a[112:115]
    ds_read_b64_tr_b16 v[50:51], v14 offset:33792
    ds_read_b64_tr_b16 v[52:53], v14 offset:40960
    v_mfma_f32_16x16x32_bf16 a[112:115], v[44:47], v[68:71], a[112:115]
    ds_read_b64_tr_b16 v[54:55], v14 offset:41984
    ds_read_b64_tr_b16 v[56:57], v15 offset:32768
    v_mfma_f32_16x16x32_bf16 a[116:119], v[40:43], v[72:75], a[116:119]
    ds_read_b64_tr_b16 v[58:59], v15 offset:33792
    ds_read_b64_tr_b16 v[60:61], v15 offset:40960
    v_mfma_f32_16x16x32_bf16 a[116:119], v[44:47], v[76:79], a[116:119]
    ds_read_b64_tr_b16 v[62:63], v15 offset:41984
    ds_read_b128 a[136:139], v22 offset:0
    v_mfma_f32_16x16x32_bf16 a[120:123], v[40:43], v[80:83], a[120:123]
    ds_read_b128 a[140:143], v23 offset:0
    v_add_u32 v14, 0x10000, v14
    v_mfma_f32_16x16x32_bf16 a[120:123], v[44:47], v[84:87], a[120:123]
    v_add_u32 v15, 0x10000, v15
    v_add_u32 v22, 0x10000, v22
    v_mfma_f32_16x16x32_bf16 a[124:127], v[40:43], v[88:91], a[124:127]
    ds_read_b64_tr_b16 v[40:41], v16 offset:32768
    ds_read_b64_tr_b16 v[42:43], v16 offset:33792
    v_mfma_f32_16x16x32_bf16 a[124:127], v[44:47], v[92:95], a[124:127]
    s_waitcnt lgkmcnt(5)
    ds_read_b64_tr_b16 v[44:45], v16 offset:40960
    ds_read_b64_tr_b16 v[46:47], v16 offset:41984
    v_mfma_f32_16x16x32_bf16 v[128:131], v[48:51], v[96:99], v[128:131]
    v_add_u32 v16, 0x10000, v16
    v_add_u32 v23, 0x10000, v23
    v_mfma_f32_16x16x32_bf16 v[128:131], v[52:55], v[100:103], v[128:131]
    v_add_u32 v37, s69, v37
    v_lshl_add_u32 v4, v36, 7, v37
    v_mfma_f32_16x16x32_bf16 v[132:135], v[48:51], v[104:107], v[132:135]
    buffer_load_dwordx4 v1, s[28:31], s65 offen offset:1024 sc1 lds
    v_mfma_f32_16x16x32_bf16 v[132:135], v[52:55], v[108:111], v[132:135]
    ds_read_b128 v[64:67], v24 offset:49152
    v_add_u32 v4, 0x10000, v4
    v_mfma_f32_16x16x32_bf16 v[136:139], v[48:51], v[112:115], v[136:139]
    v_lshl_add_u32 v5, v36, 6, v37
    v_add_u32 v5, 0x20000, v5
    v_mfma_f32_16x16x32_bf16 v[136:139], v[52:55], v[116:119], v[136:139]
    v_mfma_f32_16x16x32_bf16 v[140:143], v[48:51], v[120:123], v[140:143]
    ds_read_b64_tr_b16 v[48:49], v17 offset:32768
    ds_read_b64_tr_b16 v[50:51], v17 offset:33792
    v_mfma_f32_16x16x32_bf16 v[140:143], v[52:55], v[124:127], v[140:143]
    ds_read_b64_tr_b16 v[52:53], v17 offset:40960
    ds_read_b64_tr_b16 v[54:55], v17 offset:41984
    v_mfma_f32_16x16x32_bf16 v[144:147], v[56:59], v[96:99], v[144:147]
    s_waitcnt lgkmcnt(4)
    v_add_u32 v17, 0x10000, v17
    v_mfma_f32_16x16x32_bf16 v[144:147], v[60:63], v[100:103], v[144:147]
    v_mfma_f32_16x16x32_bf16 v[148:151], v[56:59], v[104:107], v[148:151]
    v_mfma_f32_16x16x32_bf16 v[148:151], v[60:63], v[108:111], v[148:151]
    v_mfma_f32_16x16x32_bf16 v[152:155], v[56:59], v[112:115], v[152:155]
    v_mfma_f32_16x16x32_bf16 v[152:155], v[60:63], v[116:119], v[152:155]
    s_add_u32 m0, s68, 139264
    ds_read_b128 v[68:71], v25 offset:49152
    v_mfma_f32_16x16x32_bf16 v[156:159], v[56:59], v[120:123], v[156:159]
    buffer_load_dwordx4 v6, s[20:23], s66 offen lds
    v_mfma_f32_16x16x32_bf16 v[156:159], v[60:63], v[124:127], v[156:159]
    ds_read_b64_tr_b16 v[56:57], v18 offset:32768
    ds_read_b64_tr_b16 v[58:59], v18 offset:33792
    v_mfma_f32_16x16x32_bf16 v[160:163], v[40:43], v[96:99], v[160:163]
    ds_read_b64_tr_b16 v[60:61], v18 offset:40960
    ds_read_b64_tr_b16 v[62:63], v18 offset:41984
    v_mfma_f32_16x16x32_bf16 v[160:163], v[44:47], v[100:103], v[160:163]
    v_add_u32 v18, 0x10000, v18
    v_mfma_f32_16x16x32_bf16 v[164:167], v[40:43], v[104:107], v[164:167]
    v_mfma_f32_16x16x32_bf16 v[164:167], v[44:47], v[108:111], v[164:167]
    v_mfma_f32_16x16x32_bf16 v[168:171], v[40:43], v[112:115], v[168:171]
    v_mfma_f32_16x16x32_bf16 v[168:171], v[44:47], v[116:119], v[168:171]
    v_mfma_f32_16x16x32_bf16 v[172:175], v[40:43], v[120:123], v[172:175]
    ds_read_b64_tr_b16 v[40:41], v19 offset:32768
    ds_read_b64_tr_b16 v[42:43], v19 offset:33792
    v_mfma_f32_16x16x32_bf16 v[172:175], v[44:47], v[124:127], v[172:175]
    s_waitcnt lgkmcnt(2)
    ds_read_b64_tr_b16 v[44:45], v19 offset:40960
    ds_read_b64_tr_b16 v[46:47], v19 offset:41984
    v_mfma_f32_16x16x32_bf16 v[176:179], v[48:51], v[96:99], v[176:179]
    ds_read_b128 v[72:75], v24 offset:57344
    v_add_u32 v19, 0x10000, v19
    v_mfma_f32_16x16x32_bf16 v[176:179], v[52:55], v[100:103], v[176:179]
    s_add_u32 m0, s69, 147456
    v_mfma_f32_16x16x32_bf16 v[180:183], v[48:51], v[104:107], v[180:183]
    s_xor_b32 s65, s65, 8192
    buffer_load_dwordx4 v2, s[52:55], 0 offen lds
    v_mfma_f32_16x16x32_bf16 v[180:183], v[52:55], v[108:111], v[180:183]
    s_xor_b32 s66, s66, 128
    v_mfma_f32_16x16x32_bf16 v[184:187], v[48:51], v[112:115], v[184:187]
    v_mfma_f32_16x16x32_bf16 v[184:187], v[52:55], v[116:119], v[184:187]
    v_mfma_f32_16x16x32_bf16 v[188:191], v[48:51], v[120:123], v[188:191]
    ds_read_b64_tr_b16 v[48:49], v20 offset:32768
    ds_read_b64_tr_b16 v[50:51], v20 offset:33792
    v_mfma_f32_16x16x32_bf16 v[188:191], v[52:55], v[124:127], v[188:191]
    ds_read_b64_tr_b16 v[52:53], v20 offset:40960
    ds_read_b64_tr_b16 v[54:55], v20 offset:41984
    v_mfma_f32_16x16x32_bf16 v[192:195], v[56:59], v[96:99], v[192:195]
    v_add_u32 v20, 0x10000, v20
    v_mfma_f32_16x16x32_bf16 v[192:195], v[60:63], v[100:103], v[192:195]
    v_mfma_f32_16x16x32_bf16 v[196:199], v[56:59], v[104:107], v[196:199]
    v_mfma_f32_16x16x32_bf16 v[196:199], v[60:63], v[108:111], v[196:199]
    ds_read_b128 v[76:79], v25 offset:57344
    v_mfma_f32_16x16x32_bf16 v[200:203], v[56:59], v[112:115], v[200:203]
    v_mfma_f32_16x16x32_bf16 v[200:203], v[60:63], v[116:119], v[200:203]
    s_add_u32 m0, s69, 148480
    v_mfma_f32_16x16x32_bf16 v[204:207], v[56:59], v[120:123], v[204:207]
    buffer_load_dwordx4 v3, s[52:55], 0 offen lds
    v_mfma_f32_16x16x32_bf16 v[204:207], v[60:63], v[124:127], v[204:207]
    s_waitcnt lgkmcnt(1)
    ds_read_b64_tr_b16 v[56:57], v21 offset:32768
    ds_read_b64_tr_b16 v[58:59], v21 offset:33792
    v_mfma_f32_16x16x32_bf16 v[208:211], v[40:43], v[96:99], v[208:211]
    ds_read_b64_tr_b16 v[60:61], v21 offset:40960
    ds_read_b64_tr_b16 v[62:63], v21 offset:41984
    v_mfma_f32_16x16x32_bf16 v[208:211], v[44:47], v[100:103], v[208:211]
    v_add_u32 v21, 0x10000, v21
    v_mfma_f32_16x16x32_bf16 v[212:215], v[40:43], v[104:107], v[212:215]
    v_mfma_f32_16x16x32_bf16 v[212:215], v[44:47], v[108:111], v[212:215]
    v_mfma_f32_16x16x32_bf16 v[216:219], v[40:43], v[112:115], v[216:219]
    v_mfma_f32_16x16x32_bf16 v[216:219], v[44:47], v[116:119], v[216:219]
    v_mfma_f32_16x16x32_bf16 v[220:223], v[40:43], v[120:123], v[220:223]
    ds_read_b64_tr_b16 v[40:41], v26 offset:0
    ds_read_b64_tr_b16 v[42:43], v26 offset:512
    v_mfma_f32_16x16x32_bf16 v[220:223], v[44:47], v[124:127], v[220:223]
    ds_read_b64_tr_b16 v[44:45], v26 offset:4096
    ds_read_b64_tr_b16 v[46:47], v26 offset:4608
    v_mfma_f32_16x16x32_bf16 v[224:227], v[48:51], v[96:99], v[224:227]
    v_add_u32 v26, 0x10000, v26
    v_mfma_f32_16x16x32_bf16 v[224:227], v[52:55], v[100:103], v[224:227]
    v_mfma_f32_16x16x32_bf16 v[228:231], v[48:51], v[104:107], v[228:231]
    v_mfma_f32_16x16x32_bf16 v[228:231], v[52:55], v[108:111], v[228:231]
    v_mfma_f32_16x16x32_bf16 v[232:235], v[48:51], v[112:115], v[232:235]
    v_mfma_f32_16x16x32_bf16 v[232:235], v[52:55], v[116:119], v[232:235]
    v_mfma_f32_16x16x32_bf16 v[236:239], v[48:51], v[120:123], v[236:239]
    ds_read_b64_tr_b16 v[48:49], v27 offset:0
    ds_read_b64_tr_b16 v[50:51], v27 offset:512
    v_mfma_f32_16x16x32_bf16 v[236:239], v[52:55], v[124:127], v[236:239]
    s_waitcnt lgkmcnt(2)
    ds_read_b64_tr_b16 v[52:53], v27 offset:4096
    ds_read_b64_tr_b16 v[54:55], v27 offset:4608
    v_mfma_f32_16x16x32_bf16 v[240:243], v[56:59], v[96:99], v[240:243]
    v_add_u32 v27, 0x10000, v27
    v_mfma_f32_16x16x32_bf16 v[240:243], v[60:63], v[100:103], v[240:243]
    v_mfma_f32_16x16x32_bf16 v[244:247], v[56:59], v[104:107], v[244:247]
    v_mfma_f32_16x16x32_bf16 v[244:247], v[60:63], v[108:111], v[244:247]
    v_mfma_f32_16x16x32_bf16 v[248:251], v[56:59], v[112:115], v[248:251]
    v_mfma_f32_16x16x32_bf16 v[248:251], v[60:63], v[116:119], v[248:251]
    v_mfma_f32_16x16x32_bf16 v[252:255], v[56:59], v[120:123], v[252:255]
    ds_read_b64_tr_b16 v[56:57], v28 offset:0
    ds_read_b64_tr_b16 v[58:59], v28 offset:512
    v_mfma_f32_16x16x32_bf16 v[252:255], v[60:63], v[124:127], v[252:255]
    ds_read_b64_tr_b16 v[60:61], v28 offset:4096
    ds_read_b64_tr_b16 v[62:63], v28 offset:4608
    v_mfma_f32_16x16x32_bf16 a[64:67], v[40:43], v[96:99], a[64:67]
    v_add_u32 v28, 0x10000, v28
    v_mfma_f32_16x16x32_bf16 a[64:67], v[44:47], v[100:103], a[64:67]
    v_add_u32 v24, 0x10000, v24
    v_mfma_f32_16x16x32_bf16 a[68:71], v[40:43], v[104:107], a[68:71]
    ds_read_b128 v[80:83], v24 offset:16384
    v_mfma_f32_16x16x32_bf16 a[68:71], v[44:47], v[108:111], a[68:71]
    v_mfma_f32_16x16x32_bf16 a[72:75], v[40:43], v[112:115], a[72:75]
    v_mfma_f32_16x16x32_bf16 a[72:75], v[44:47], v[116:119], a[72:75]
    v_add_u32 v25, 0x10000, v25
    v_mfma_f32_16x16x32_bf16 a[76:79], v[40:43], v[120:123], a[76:79]
    ds_read_b128 v[84:87], v25 offset:16384
    v_mfma_f32_16x16x32_bf16 a[76:79], v[44:47], v[124:127], a[76:79]
    v_mfma_f32_16x16x32_bf16 a[128:131], v[40:43], a[136:139], a[128:131]
    ds_read_b64_tr_b16 v[40:41], v29 offset:0
    ds_read_b64_tr_b16 v[42:43], v29 offset:512
    v_mfma_f32_16x16x32_bf16 a[128:131], v[44:47], a[140:143], a[128:131]
    s_waitcnt lgkmcnt(3)
    ds_read_b64_tr_b16 v[44:45], v29 offset:4096
    ds_read_b64_tr_b16 v[46:47], v29 offset:4608
    v_mfma_f32_16x16x32_bf16 a[80:83], v[48:51], v[96:99], a[80:83]
    ds_read_b128 v[88:91], v24 offset:24576
    v_add_u32 v29, 0x10000, v29
    v_mfma_f32_16x16x32_bf16 a[80:83], v[52:55], v[100:103], a[80:83]
    v_mfma_f32_16x16x32_bf16 a[84:87], v[48:51], v[104:107], a[84:87]
    v_mfma_f32_16x16x32_bf16 a[84:87], v[52:55], v[108:111], a[84:87]
    v_mfma_f32_16x16x32_bf16 a[88:91], v[48:51], v[112:115], a[88:91]
    ds_read_b128 v[92:95], v25 offset:24576
    v_mfma_f32_16x16x32_bf16 a[88:91], v[52:55], v[116:119], a[88:91]
    v_mfma_f32_16x16x32_bf16 a[92:95], v[48:51], v[120:123], a[92:95]
    v_mfma_f32_16x16x32_bf16 a[92:95], v[52:55], v[124:127], a[92:95]
    v_mfma_f32_16x16x32_bf16 a[132:135], v[48:51], a[136:139], a[132:135]
    v_mfma_f32_16x16x32_bf16 a[132:135], v[52:55], a[140:143], a[132:135]
    v_mfma_f32_16x16x32_bf16 a[96:99], v[56:59], v[96:99], a[96:99]
    v_mfma_f32_16x16x32_bf16 a[96:99], v[60:63], v[100:103], a[96:99]
    v_mfma_f32_16x16x32_bf16 a[100:103], v[56:59], v[104:107], a[100:103]
    v_mfma_f32_16x16x32_bf16 a[100:103], v[60:63], v[108:111], a[100:103]
    v_mfma_f32_16x16x32_bf16 a[104:107], v[56:59], v[112:115], a[104:107]
    v_mfma_f32_16x16x32_bf16 a[104:107], v[60:63], v[116:119], a[104:107]
    s_waitcnt vmcnt(0) lgkmcnt(0)
    s_barrier
    ds_read_b64_tr_b16 v[48:49], v14 offset:32768
    v_mfma_f32_16x16x32_bf16 a[108:111], v[56:59], v[120:123], a[108:111]
    ds_read_b64_tr_b16 v[50:51], v14 offset:33792
    ds_read_b64_tr_b16 v[52:53], v14 offset:40960
    v_mfma_f32_16x16x32_bf16 a[108:111], v[60:63], v[124:127], a[108:111]
    ds_read_b64_tr_b16 v[54:55], v14 offset:41984
    ds_read_b64_tr_b16 v[56:57], v15 offset:32768
    v_mfma_f32_16x16x32_bf16 a[112:115], v[40:43], v[96:99], a[112:115]
    ds_read_b64_tr_b16 v[58:59], v15 offset:33792
    ds_read_b64_tr_b16 v[60:61], v15 offset:40960
    v_mfma_f32_16x16x32_bf16 a[112:115], v[44:47], v[100:103], a[112:115]
    ds_read_b64_tr_b16 v[62:63], v15 offset:41984
    ds_read_b128 a[136:139], v22 offset:0
    v_mfma_f32_16x16x32_bf16 a[116:119], v[40:43], v[104:107], a[116:119]
    ds_read_b128 a[140:143], v23 offset:0
    v_mfma_f32_16x16x32_bf16 a[116:119], v[44:47], v[108:111], a[116:119]
    v_mfma_f32_16x16x32_bf16 a[120:123], v[40:43], v[112:115], a[120:123]
    v_mfma_f32_16x16x32_bf16 a[120:123], v[44:47], v[116:119], a[120:123]
    v_mfma_f32_16x16x32_bf16 a[124:127], v[40:43], v[120:123], a[124:127]
    ds_read_b64_tr_b16 v[40:41], v16 offset:32768
    ds_read_b64_tr_b16 v[42:43], v16 offset:33792
    v_mfma_f32_16x16x32_bf16 a[124:127], v[44:47], v[124:127], a[124:127]
    s_waitcnt lgkmcnt(2)
    ds_read_b64_tr_b16 v[44:45], v16 offset:40960
    ds_read_b64_tr_b16 v[46:47], v16 offset:41984
    v_mfma_f32_16x16x32_bf16 v[128:131], v[48:51], v[64:67], v[128:131]
    v_mfma_f32_16x16x32_bf16 v[128:131], v[52:55], v[68:71], v[128:131]
    ds_read_b64_tr_b16 v[32:33], v4 offset:49152
    ds_read_b64_tr_b16 v[34:35], v4 offset:51200
    v_mfma_f32_16x16x32_bf16 v[132:135], v[48:51], v[72:75], v[132:135]
    v_mfma_f32_16x16x32_bf16 v[132:135], v[52:55], v[76:79], v[132:135]
    v_mfma_f32_16x16x32_bf16 v[136:139], v[48:51], v[80:83], v[136:139]
    v_mfma_f32_16x16x32_bf16 v[136:139], v[52:55], v[84:87], v[136:139]
    v_mfma_f32_16x16x32_bf16 v[140:143], v[48:51], v[88:91], v[140:143]
    ds_read_b64_tr_b16 v[48:49], v17 offset:32768
    ds_read_b64_tr_b16 v[50:51], v17 offset:33792
    v_mfma_f32_16x16x32_bf16 v[140:143], v[52:55], v[92:95], v[140:143]
    ds_read_b64_tr_b16 v[52:53], v17 offset:40960
    ds_read_b64_tr_b16 v[54:55], v17 offset:41984
    v_mfma_f32_16x16x32_bf16 v[144:147], v[56:59], v[64:67], v[144:147]
    s_waitcnt lgkmcnt(4)
    buffer_store_dwordx4 v[32:35], v1, s[56:59], s8 offen offset:0 sc1
    v_mfma_f32_16x16x32_bf16 v[144:147], v[60:63], v[68:71], v[144:147]
    v_mul_f32 v128, s74, v128
    v_mul_f32 v129, s74, v129
    v_mfma_f32_16x16x32_bf16 v[148:151], v[56:59], v[72:75], v[148:151]
    v_mul_f32 v130, s74, v130
    v_mul_f32 v131, s74, v131
    v_mfma_f32_16x16x32_bf16 v[148:151], v[60:63], v[76:79], v[148:151]
    ds_read_b64_tr_b16 v[36:37], v4 offset:49184
    ds_read_b64_tr_b16 v[38:39], v4 offset:51232
    v_mfma_f32_16x16x32_bf16 v[152:155], v[56:59], v[80:83], v[152:155]
    v_mul_f32 v132, s74, v132
    v_mul_f32 v133, s74, v133
    v_mfma_f32_16x16x32_bf16 v[152:155], v[60:63], v[84:87], v[152:155]
    v_mul_f32 v134, s74, v134
    v_mul_f32 v135, s74, v135
    v_mfma_f32_16x16x32_bf16 v[156:159], v[56:59], v[88:91], v[156:159]
    ds_read_b64_tr_b16 v[56:57], v18 offset:32768
    ds_read_b64_tr_b16 v[58:59], v18 offset:33792
    v_mfma_f32_16x16x32_bf16 v[156:159], v[60:63], v[92:95], v[156:159]
    ds_read_b64_tr_b16 v[60:61], v18 offset:40960
    ds_read_b64_tr_b16 v[62:63], v18 offset:41984
    v_mfma_f32_16x16x32_bf16 v[160:163], v[40:43], v[64:67], v[160:163]
    v_mul_f32 v136, s74, v136
    v_mul_f32 v137, s74, v137
    v_mfma_f32_16x16x32_bf16 v[160:163], v[44:47], v[68:71], v[160:163]
    v_mul_f32 v138, s74, v138
    v_mul_f32 v139, s74, v139
    v_mfma_f32_16x16x32_bf16 v[164:167], v[40:43], v[72:75], v[164:167]
    s_waitcnt lgkmcnt(4)
    buffer_store_dwordx4 v[36:39], v1, s[56:59], s8 offen offset:1024 sc1
    v_mfma_f32_16x16x32_bf16 v[164:167], v[44:47], v[76:79], v[164:167]
    buffer_load_dword v7, v8, s[32:35], s61 offen sc1
    v_mfma_f32_16x16x32_bf16 v[168:171], v[40:43], v[80:83], v[168:171]
    v_mul_f32 v140, s74, v140
    v_mul_f32 v141, s74, v141
    v_mfma_f32_16x16x32_bf16 v[168:171], v[44:47], v[84:87], v[168:171]
    ds_read_b64_tr_b16 v[32:33], v4 offset:49216
    ds_read_b64_tr_b16 v[34:35], v4 offset:51264
    v_mfma_f32_16x16x32_bf16 v[172:175], v[40:43], v[88:91], v[172:175]
    ds_read_b64_tr_b16 v[40:41], v19 offset:32768
    ds_read_b64_tr_b16 v[42:43], v19 offset:33792
    v_mfma_f32_16x16x32_bf16 v[172:175], v[44:47], v[92:95], v[172:175]
    ds_read_b64_tr_b16 v[44:45], v19 offset:40960
    ds_read_b64_tr_b16 v[46:47], v19 offset:41984
    v_mfma_f32_16x16x32_bf16 v[176:179], v[48:51], v[64:67], v[176:179]
    v_mul_f32 v142, s74, v142
    v_mul_f32 v143, s74, v143
    v_mfma_f32_16x16x32_bf16 v[176:179], v[52:55], v[68:71], v[176:179]
    v_mul_f32 v144, s74, v144
    v_mul_f32 v145, s74, v145
    v_mfma_f32_16x16x32_bf16 v[180:183], v[48:51], v[72:75], v[180:183]
    v_mul_f32 v146, s74, v146
    v_mul_f32 v147, s74, v147
    v_mfma_f32_16x16x32_bf16 v[180:183], v[52:55], v[76:79], v[180:183]
    v_mul_f32 v148, s74, v148
    v_mul_f32 v149, s74, v149
    v_mfma_f32_16x16x32_bf16 v[184:187], v[48:51], v[80:83], v[184:187]
    s_waitcnt lgkmcnt(0)
    buffer_store_dwordx4 v[32:35], v1, s[56:59], s8 offen offset:2048 sc1
    v_mfma_f32_16x16x32_bf16 v[184:187], v[52:55], v[84:87], v[184:187]
    v_mul_f32 v150, s74, v150
    v_mul_f32 v151, s74, v151
    v_mfma_f32_16x16x32_bf16 v[188:191], v[48:51], v[88:91], v[188:191]
    ds_read_b64_tr_b16 v[48:49], v20 offset:32768
    ds_read_b64_tr_b16 v[50:51], v20 offset:33792
    v_mfma_f32_16x16x32_bf16 v[188:191], v[52:55], v[92:95], v[188:191]
    ds_read_b64_tr_b16 v[52:53], v20 offset:40960
    ds_read_b64_tr_b16 v[54:55], v20 offset:41984
    v_mfma_f32_16x16x32_bf16 v[192:195], v[56:59], v[64:67], v[192:195]
    ds_read_b64_tr_b16 v[36:37], v4 offset:49248
    ds_read_b64_tr_b16 v[38:39], v4 offset:51296
    v_mfma_f32_16x16x32_bf16 v[192:195], v[60:63], v[68:71], v[192:195]
    v_mul_f32 v152, s74, v152
    v_mul_f32 v153, s74, v153
    v_mfma_f32_16x16x32_bf16 v[196:199], v[56:59], v[72:75], v[196:199]
    v_mul_f32 v154, s74, v154
    v_mul_f32 v155, s74, v155
    v_mfma_f32_16x16x32_bf16 v[196:199], v[60:63], v[76:79], v[196:199]
    v_mul_f32 v156, s74, v156
    v_mul_f32 v157, s74, v157
    v_mfma_f32_16x16x32_bf16 v[200:203], v[56:59], v[80:83], v[200:203]
    v_mul_f32 v158, s74, v158
    v_mul_f32 v159, s74, v159
    v_mfma_f32_16x16x32_bf16 v[200:203], v[60:63], v[84:87], v[200:203]
    v_mul_f32 v160, s74, v160
    v_mul_f32 v161, s74, v161
    v_mfma_f32_16x16x32_bf16 v[204:207], v[56:59], v[88:91], v[204:207]
    ds_read_b64_tr_b16 v[56:57], v21 offset:32768
    ds_read_b64_tr_b16 v[58:59], v21 offset:33792
    v_mfma_f32_16x16x32_bf16 v[204:207], v[60:63], v[92:95], v[204:207]
    ds_read_b64_tr_b16 v[60:61], v21 offset:40960
    ds_read_b64_tr_b16 v[62:63], v21 offset:41984
    v_mfma_f32_16x16x32_bf16 v[208:211], v[40:43], v[64:67], v[208:211]
    s_waitcnt lgkmcnt(4)
    buffer_store_dwordx4 v[36:39], v1, s[56:59], s8 offen offset:3072 sc1
    v_mfma_f32_16x16x32_bf16 v[208:211], v[44:47], v[68:71], v[208:211]
    v_mul_f32 v162, s74, v162
    v_mul_f32 v163, s74, v163
    v_mfma_f32_16x16x32_bf16 v[212:215], v[40:43], v[72:75], v[212:215]
    v_mul_f32 v164, s74, v164
    v_mul_f32 v165, s74, v165
    v_mfma_f32_16x16x32_bf16 v[212:215], v[44:47], v[76:79], v[212:215]
    v_mul_f32 v166, s74, v166
    v_mul_f32 v167, s74, v167
    v_mfma_f32_16x16x32_bf16 v[216:219], v[40:43], v[80:83], v[216:219]
    v_mul_f32 v168, s74, v168
    v_mul_f32 v169, s74, v169
    v_mfma_f32_16x16x32_bf16 v[216:219], v[44:47], v[84:87], v[216:219]
    v_mul_f32 v170, s74, v170
    v_mul_f32 v171, s74, v171
    v_mfma_f32_16x16x32_bf16 v[220:223], v[40:43], v[88:91], v[220:223]
    ds_read_b64_tr_b16 v[40:41], v26 offset:0
    ds_read_b64_tr_b16 v[42:43], v26 offset:512
    v_mfma_f32_16x16x32_bf16 v[220:223], v[44:47], v[92:95], v[220:223]
    ds_read_b64_tr_b16 v[44:45], v26 offset:4096
    ds_read_b64_tr_b16 v[46:47], v26 offset:4608
    v_mfma_f32_16x16x32_bf16 v[224:227], v[48:51], v[64:67], v[224:227]
    v_mul_f32 v172, s74, v172
    v_mul_f32 v173, s74, v173
    v_mfma_f32_16x16x32_bf16 v[224:227], v[52:55], v[68:71], v[224:227]
    v_mul_f32 v174, s74, v174
    v_mul_f32 v175, s74, v175
    v_mfma_f32_16x16x32_bf16 v[228:231], v[48:51], v[72:75], v[228:231]
    v_mul_f32 v176, s74, v176
    v_mul_f32 v177, s74, v177
    v_mfma_f32_16x16x32_bf16 v[228:231], v[52:55], v[76:79], v[228:231]
    v_mul_f32 v178, s74, v178
    v_mul_f32 v179, s74, v179
    v_mfma_f32_16x16x32_bf16 v[232:235], v[48:51], v[80:83], v[232:235]
    v_mul_f32 v180, s74, v180
    v_mul_f32 v181, s74, v181
    v_mfma_f32_16x16x32_bf16 v[232:235], v[52:55], v[84:87], v[232:235]
    s_mov_b32 s38, 16384
    v_mul_f32 v182, s74, v182
    v_mul_f32 v183, s74, v183
    s_waitcnt vmcnt(2)
    v_cmp_gt_u32 vcc, 1, v7
    s_nop 1
    s_and_b64 vcc, vcc, exec
    s_cbranch_scc1 SPIN_KV
BACK_KV:
    v_mfma_f32_16x16x32_bf16 v[236:239], v[48:51], v[88:91], v[236:239]
    s_mov_b32 s77, s75
    ds_read_b64_tr_b16 v[48:49], v27 offset:0
    ds_read_b64_tr_b16 v[50:51], v27 offset:512
    v_mfma_f32_16x16x32_bf16 v[236:239], v[52:55], v[92:95], v[236:239]
    s_add_u32 m0, s76, s75
    ds_read_b64_tr_b16 v[52:53], v27 offset:4096
    ds_read_b64_tr_b16 v[54:55], v27 offset:4608
    s_waitcnt lgkmcnt(4)
    v_mfma_f32_16x16x32_bf16 v[240:243], v[56:59], v[64:67], v[240:243]
    buffer_load_dwordx4 v1, s[36:39], s77 offen sc1 lds
    v_mfma_f32_16x16x32_bf16 v[240:243], v[60:63], v[68:71], v[240:243]
    v_mul_f32 v184, s74, v184
    v_mul_f32 v185, s74, v185
    v_mfma_f32_16x16x32_bf16 v[244:247], v[56:59], v[72:75], v[244:247]
    buffer_load_dwordx4 v1, s[36:39], s77 offen offset:1024 sc1 lds
    v_mfma_f32_16x16x32_bf16 v[244:247], v[60:63], v[76:79], v[244:247]
    v_mul_f32 v186, s74, v186
    v_mul_f32 v187, s74, v187
    v_mfma_f32_16x16x32_bf16 v[248:251], v[56:59], v[80:83], v[248:251]
    v_mul_f32 v188, s74, v188
    v_mul_f32 v189, s74, v189
    v_mfma_f32_16x16x32_bf16 v[248:251], v[60:63], v[84:87], v[248:251]
    v_mul_f32 v190, s74, v190
    v_mul_f32 v191, s74, v191
    v_mfma_f32_16x16x32_bf16 v[252:255], v[56:59], v[88:91], v[252:255]
    buffer_load_dwordx4 v1, s[36:39], s77 offen offset:2048 sc1 lds
    v_mfma_f32_16x16x32_bf16 v[252:255], v[60:63], v[92:95], v[252:255]
    ds_read_b64_tr_b16 v[56:57], v28 offset:0
    ds_read_b64_tr_b16 v[58:59], v28 offset:512
    v_mfma_f32_16x16x32_bf16 a[64:67], v[40:43], v[64:67], a[64:67]
    ds_read_b64_tr_b16 v[60:61], v28 offset:4096
    ds_read_b64_tr_b16 v[62:63], v28 offset:4608
    v_mfma_f32_16x16x32_bf16 a[64:67], v[44:47], v[68:71], a[64:67]
    ds_read_b64_tr_b16 v[32:33], v5 offset:16384
    ds_read_b64_tr_b16 v[34:35], v5 offset:17408
    v_mfma_f32_16x16x32_bf16 a[68:71], v[40:43], v[72:75], a[68:71]
    buffer_load_dwordx4 v1, s[36:39], s77 offen offset:3072 sc1 lds
    v_mfma_f32_16x16x32_bf16 a[68:71], v[44:47], v[76:79], a[68:71]
    v_mul_f32 v192, s74, v192
    v_mul_f32 v193, s74, v193
    v_mfma_f32_16x16x32_bf16 a[72:75], v[40:43], v[80:83], a[72:75]
    v_mul_f32 v194, s74, v194
    v_mul_f32 v195, s74, v195
    v_mfma_f32_16x16x32_bf16 a[72:75], v[44:47], v[84:87], a[72:75]
    s_add_u32 s100, s77, 4096
    v_mul_f32 v196, s74, v196
    v_mul_f32 v197, s74, v197
    v_mfma_f32_16x16x32_bf16 a[76:79], v[40:43], v[88:91], a[76:79]
    s_add_u32 m0, m0, 4096
    v_mul_f32 v198, s74, v198
    v_mul_f32 v199, s74, v199
    v_mfma_f32_16x16x32_bf16 a[76:79], v[44:47], v[92:95], a[76:79]
    buffer_load_dwordx4 v1, s[36:39], s100 offen sc1 lds
    v_mfma_f32_16x16x32_bf16 a[128:131], v[40:43], a[136:139], a[128:131]
    ds_read_b64_tr_b16 v[40:41], v29 offset:0
    ds_read_b64_tr_b16 v[42:43], v29 offset:512
    v_mfma_f32_16x16x32_bf16 a[128:131], v[44:47], a[140:143], a[128:131]
    s_waitcnt lgkmcnt(2)
    ds_read_b64_tr_b16 v[44:45], v29 offset:4096
    ds_read_b64_tr_b16 v[46:47], v29 offset:4608
    v_mfma_f32_16x16x32_bf16 a[80:83], v[48:51], v[64:67], a[80:83]
    buffer_load_dwordx4 v1, s[36:39], s100 offen offset:1024 sc1 lds
    v_mfma_f32_16x16x32_bf16 a[80:83], v[52:55], v[68:71], a[80:83]
    ds_read_b64_tr_b16 v[36:37], v5 offset:16416
    ds_read_b64_tr_b16 v[38:39], v5 offset:17440
    v_mfma_f32_16x16x32_bf16 a[84:87], v[48:51], v[72:75], a[84:87]
    v_mul_f32 v200, s74, v200
    v_mul_f32 v201, s74, v201
    v_mfma_f32_16x16x32_bf16 a[84:87], v[52:55], v[76:79], a[84:87]
    v_mul_f32 v202, s74, v202
    v_mul_f32 v203, s74, v203
    v_mfma_f32_16x16x32_bf16 a[88:91], v[48:51], v[80:83], a[88:91]
    buffer_load_dwordx4 v1, s[36:39], s100 offen offset:2048 sc1 lds
    v_mfma_f32_16x16x32_bf16 a[88:91], v[52:55], v[84:87], a[88:91]
    v_mul_f32 v204, s74, v204
    v_mul_f32 v205, s74, v205
    v_mfma_f32_16x16x32_bf16 a[92:95], v[48:51], v[88:91], a[92:95]
    v_mul_f32 v206, s74, v206
    v_mul_f32 v207, s74, v207
    v_mfma_f32_16x16x32_bf16 a[92:95], v[52:55], v[92:95], a[92:95]
    v_mul_f32 v208, s74, v208
    v_mul_f32 v209, s74, v209
    v_mfma_f32_16x16x32_bf16 a[132:135], v[48:51], a[136:139], a[132:135]
    buffer_load_dwordx4 v1, s[36:39], s100 offen offset:3072 sc1 lds
    v_mfma_f32_16x16x32_bf16 a[132:135], v[52:55], a[140:143], a[132:135]
    v_mul_f32 v210, s74, v210
    v_mul_f32 v211, s74, v211
    v_mfma_f32_16x16x32_bf16 a[96:99], v[56:59], v[64:67], a[96:99]
    v_mul_f32 v212, s74, v212
    v_mul_f32 v213, s74, v213
    v_mfma_f32_16x16x32_bf16 a[96:99], v[60:63], v[68:71], a[96:99]
    s_lshr_b32 s82, s4, 1
    s_add_u32 s82, s82, 32
    v_mul_f32 v214, s74, v214
    v_mfma_f32_16x16x32_bf16 a[100:103], v[56:59], v[72:75], a[100:103]
    s_sub_u32 s82, s82, s6
    v_mul_f32 v215, s74, v215
    v_mul_f32 v216, s74, v216
    v_mfma_f32_16x16x32_bf16 a[100:103], v[60:63], v[76:79], a[100:103]
    s_sub_u32 s82, s82, s6
    v_mul_f32 v217, s74, v217
    v_mul_f32 v218, s74, v218
    v_mfma_f32_16x16x32_bf16 a[104:107], v[56:59], v[80:83], a[104:107]
    s_add_u32 s77, s77, 32768
    s_add_u32 s76, s76, 32768
    s_lshl_b32 s38, s82, 15
    v_mfma_f32_16x16x32_bf16 a[104:107], v[60:63], v[84:87], a[104:107]
    v_mul_f32 v219, s74, v219
    v_mul_f32 v220, s74, v220
    v_mfma_f32_16x16x32_bf16 a[108:111], v[56:59], v[88:91], a[108:111]
    v_mul_f32 v221, s74, v221
    v_mul_f32 v222, s74, v222
    v_mfma_f32_16x16x32_bf16 a[108:111], v[60:63], v[92:95], a[108:111]
    s_waitcnt lgkmcnt(0)
    v_mul_f32 v223, s74, v223
    v_mul_f32 v224, s74, v224
    v_mfma_f32_16x16x32_bf16 a[112:115], v[40:43], v[64:67], a[112:115]
    v_mul_f32 v225, s74, v225
    v_mul_f32 v226, s74, v226
    v_mfma_f32_16x16x32_bf16 a[112:115], v[44:47], v[68:71], a[112:115]
    v_mul_f32 v227, s74, v227
    v_mul_f32 v228, s74, v228
    v_mfma_f32_16x16x32_bf16 a[116:119], v[40:43], v[72:75], a[116:119]
    v_mul_f32 v229, s74, v229
    v_mul_f32 v230, s74, v230
    v_mfma_f32_16x16x32_bf16 a[116:119], v[44:47], v[76:79], a[116:119]
    v_mul_f32 v231, s74, v231
    v_mul_f32 v232, s74, v232
    v_mfma_f32_16x16x32_bf16 a[120:123], v[40:43], v[80:83], a[120:123]
    v_mul_f32 v233, s74, v233
    v_mul_f32 v234, s74, v234
    v_mfma_f32_16x16x32_bf16 a[120:123], v[44:47], v[84:87], a[120:123]
    v_mul_f32 v235, s74, v235
    v_mul_f32 v236, s74, v236
    v_mfma_f32_16x16x32_bf16 a[124:127], v[40:43], v[88:91], a[124:127]
    v_mul_f32 v237, s74, v237
    v_mul_f32 v238, s74, v238
    v_mfma_f32_16x16x32_bf16 a[124:127], v[44:47], v[92:95], a[124:127]
    s_add_u32 m0, s76, s75
    s_nop 0
    buffer_load_dwordx4 v1, s[36:39], s77 offen sc1 lds
    v_mul_f32 v239, s74, v239
    v_mul_f32 v240, s74, v240
    v_mul_f32 v241, s74, v241
    v_mul_f32 v242, s74, v242
    v_mul_f32 v243, s74, v243
    v_mul_f32 v244, s74, v244
    v_mul_f32 v245, s74, v245
    v_mul_f32 v246, s74, v246
    v_mul_f32 v247, s74, v247
    v_mul_f32 v248, s74, v248
    v_mul_f32 v249, s74, v249
    v_mul_f32 v250, s74, v250
    v_mul_f32 v251, s74, v251
    v_mul_f32 v252, s74, v252
    v_mul_f32 v253, s74, v253
    v_mul_f32 v254, s74, v254
    buffer_load_dwordx4 v1, s[36:39], s77 offen offset:1024 sc1 lds
    v_mul_f32 v255, s74, v255
    v_cvt_pk_bf16_f32 v128, v128, v129
    v_cvt_pk_bf16_f32 v129, v130, v131
    v_cvt_pk_bf16_f32 v130, v144, v145
    v_cvt_pk_bf16_f32 v131, v146, v147
    v_cvt_pk_bf16_f32 v132, v132, v133
    v_cvt_pk_bf16_f32 v133, v134, v135
    v_cvt_pk_bf16_f32 v134, v148, v149
    v_cvt_pk_bf16_f32 v135, v150, v151
    v_cvt_pk_bf16_f32 v136, v136, v137
    v_cvt_pk_bf16_f32 v137, v138, v139
    v_cvt_pk_bf16_f32 v138, v152, v153
    v_cvt_pk_bf16_f32 v139, v154, v155
    v_cvt_pk_bf16_f32 v140, v140, v141
    v_cvt_pk_bf16_f32 v141, v142, v143
    v_cvt_pk_bf16_f32 v142, v156, v157
    v_cvt_pk_bf16_f32 v143, v158, v159
    buffer_load_dwordx4 v1, s[36:39], s77 offen offset:2048 sc1 lds
    v_cvt_pk_bf16_f32 v160, v160, v161
    v_cvt_pk_bf16_f32 v161, v162, v163
    v_cvt_pk_bf16_f32 v162, v176, v177
    v_cvt_pk_bf16_f32 v163, v178, v179
    v_cvt_pk_bf16_f32 v164, v164, v165
    v_cvt_pk_bf16_f32 v165, v166, v167
    v_cvt_pk_bf16_f32 v166, v180, v181
    v_cvt_pk_bf16_f32 v167, v182, v183
    v_cvt_pk_bf16_f32 v168, v168, v169
    v_cvt_pk_bf16_f32 v169, v170, v171
    v_cvt_pk_bf16_f32 v170, v184, v185
    v_cvt_pk_bf16_f32 v171, v186, v187
    v_cvt_pk_bf16_f32 v172, v172, v173
    v_cvt_pk_bf16_f32 v173, v174, v175
    v_cvt_pk_bf16_f32 v174, v188, v189
    v_cvt_pk_bf16_f32 v175, v190, v191
    v_cvt_pk_bf16_f32 v192, v192, v193
    buffer_load_dwordx4 v1, s[36:39], s77 offen offset:3072 sc1 lds
    v_cvt_pk_bf16_f32 v193, v194, v195
    v_cvt_pk_bf16_f32 v194, v208, v209
    v_cvt_pk_bf16_f32 v195, v210, v211
    v_cvt_pk_bf16_f32 v196, v196, v197
    v_cvt_pk_bf16_f32 v197, v198, v199
    v_cvt_pk_bf16_f32 v198, v212, v213
    v_cvt_pk_bf16_f32 v199, v214, v215
    v_cvt_pk_bf16_f32 v200, v200, v201
    v_cvt_pk_bf16_f32 v201, v202, v203
    v_cvt_pk_bf16_f32 v202, v216, v217
    v_cvt_pk_bf16_f32 v203, v218, v219
    v_cvt_pk_bf16_f32 v204, v204, v205
    v_cvt_pk_bf16_f32 v205, v206, v207
    v_cvt_pk_bf16_f32 v206, v220, v221
    v_cvt_pk_bf16_f32 v207, v222, v223
    v_cvt_pk_bf16_f32 v224, v224, v225
    v_cvt_pk_bf16_f32 v225, v226, v227
    s_add_u32 s100, s77, 4096
    s_add_u32 m0, m0, 4096
    s_nop 0
    buffer_load_dwordx4 v1, s[36:39], s100 offen sc1 lds
    v_cvt_pk_bf16_f32 v226, v240, v241
    v_cvt_pk_bf16_f32 v227, v242, v243
    v_cvt_pk_bf16_f32 v228, v228, v229
    v_cvt_pk_bf16_f32 v229, v230, v231
    v_cvt_pk_bf16_f32 v230, v244, v245
    v_cvt_pk_bf16_f32 v231, v246, v247
    v_cvt_pk_bf16_f32 v232, v232, v233
    v_cvt_pk_bf16_f32 v233, v234, v235
    v_cvt_pk_bf16_f32 v234, v248, v249
    v_cvt_pk_bf16_f32 v235, v250, v251
    v_cvt_pk_bf16_f32 v236, v236, v237
    v_cvt_pk_bf16_f32 v237, v238, v239
    v_cvt_pk_bf16_f32 v238, v252, v253
    v_cvt_pk_bf16_f32 v239, v254, v255
    buffer_store_dwordx4 v[32:35], v1, s[56:59], s9 offen offset:0 sc1
    buffer_store_dwordx4 v[36:39], v1, s[56:59], s9 offen offset:1024 sc1
    buffer_load_dwordx4 v1, s[36:39], s100 offen offset:1024 sc1 lds
    v_mov_b32 v8, 0x3f803f80
    v_accvgpr_write_b32 a136, v8
    v_accvgpr_write_b32 a137, v8
    v_accvgpr_write_b32 a138, v8
    v_accvgpr_write_b32 a139, v8
    v_bfe_u32 v8, v1, 4, 4
    v_lshrrev_b32 v9, 8, v1
    v_lshlrev_b32 v9, 2, v9
    v_sub_u32 v8, v8, v9
    v_mov_b32 v9, 0xf149f2ca
    v_cmp_le_i32 vcc, 0, v8
    s_cmp_eq_u32 s4, 0
    s_cselect_b32 s8, 1.0, 0
    v_cndmask_b32_e64 v208, v9, 0, vcc
    s_cmp_lt_u32 s4, 0
    s_cselect_b32 s12, 0xf149f2ca, 0
    v_cmp_le_i32 vcc, 1, v8
    buffer_load_dwordx4 v1, s[36:39], s100 offen offset:2048 sc1 lds
    s_cmp_eq_u32 s4, 1
    s_cselect_b32 s9, 1.0, 0
    v_cndmask_b32_e64 v209, v9, 0, vcc
    s_cmp_lt_u32 s4, 1
    s_cselect_b32 s13, 0xf149f2ca, 0
    v_cmp_le_i32 vcc, 2, v8
    s_cmp_eq_u32 s4, 2
    s_cselect_b32 s10, 1.0, 0
    v_cndmask_b32_e64 v210, v9, 0, vcc
    s_cmp_lt_u32 s4, 2
    s_cselect_b32 s14, 0xf149f2ca, 0
    v_cmp_le_i32 vcc, 3, v8
    s_cmp_eq_u32 s4, 3
    s_cselect_b32 s11, 1.0, 0
    v_cndmask_b32_e64 v211, v9, 0, vcc
    s_cmp_lt_u32 s4, 3
    s_cselect_b32 s15, 0xf149f2ca, 0
    buffer_load_dwordx4 v1, s[36:39], s100 offen offset:3072 sc1 lds
    s_add_u32 s77, s77, 32768
    s_add_u32 s76, s76, 32768
    s_sub_u32 s40, s56, 20971520
    s_subb_u32 s41, s57, 0
    s_mov_b32 s42, 19922944
    s_mov_b32 s43, 0x20000
    s_lshl3_add_u32 s80, s6, s4
    s_mul_i32 s80, s80, 155648
    s_sub_u32 s7, 15, s6
    s_lshl3_add_u32 s81, s7, s4
    s_mul_i32 s81, s81, 155648
    s_lshl_b32 s7, s5, 12
    s_add_u32 s80, s80, s7
    s_add_u32 s81, s81, s7
    s_mov_b32 s92, 0x55555555
    s_mov_b32 s93, 0x55555555
    s_load_dwordx2 s[24:25], s[0:1], 80
    s_mov_b32 s26, 2359296
    s_mov_b32 s27, 0x20000
K1_ATT:
    s_mov_b32 s82, 0
    s_mov_b32 s60, 131072
    v_mov_b32 v2, v1
    v_mov_b32 v11, 0
    s_cmp_eq_u32 s6, 0
    s_cselect_b32 s16, s8, 0
    s_cselect_b32 s17, s9, 0
    s_cselect_b32 s18, s10, 0
    s_cselect_b32 s19, s11, 0
    s_cselect_b32 s20, s12, 0
    s_cselect_b32 s21, s13, 0
    s_cselect_b32 s22, s14, 0
    s_cselect_b32 s23, s15, 0
    s_waitcnt vmcnt(8) lgkmcnt(0)
    s_barrier
    ds_read_b128 a[224:227], v2 offset:0
    ds_read_b128 a[228:231], v2 offset:1024
    ds_read_b128 a[232:235], v2 offset:2048
    ds_read_b128 a[236:239], v2 offset:3072
    ds_read_b128 v[96:99], v2 offset:16384
    ds_read_b128 v[100:103], v2 offset:17408
    s_cmp_lg_u32 s83, 0
    s_cbranch_scc1 K1_HAVEM_R
    s_add_u32 m0, s76, s75
    s_nop 0
    buffer_load_dwordx4 v1, s[36:39], s77 offen sc1 lds
    v_mul_f32 v176, s16, v208
    v_mul_f32 v177, s16, v209
    v_mul_f32 v178, s16, v210
    v_mul_f32 v179, s16, v211
    s_waitcnt lgkmcnt(2)
    buffer_load_dwordx4 v1, s[36:39], s77 offen offset:1024 sc1 lds
    v_mfma_f32_16x16x32_bf16 v[240:243], a[224:227], v[128:131], v[176:179]
    v_mfma_f32_16x16x32_bf16 v[240:243], a[228:231], v[160:163], v[240:243]
    v_mfma_f32_16x16x32_bf16 v[240:243], a[232:235], v[192:195], v[240:243]
    v_mfma_f32_16x16x32_bf16 v[240:243], a[236:239], v[224:227], v[240:243]
    v_mfma_f32_16x16x32_bf16 v[244:247], a[224:227], v[132:135], 0
    buffer_load_dwordx4 v1, s[36:39], s77 offen offset:2048 sc1 lds
    v_mfma_f32_16x16x32_bf16 v[244:247], a[228:231], v[164:167], v[244:247]
    v_mfma_f32_16x16x32_bf16 v[244:247], a[232:235], v[196:199], v[244:247]
    v_mfma_f32_16x16x32_bf16 v[244:247], a[236:239], v[228:231], v[244:247]
    v_mfma_f32_16x16x32_bf16 v[248:251], a[224:227], v[136:139], 0
    v_mfma_f32_16x16x32_bf16 v[248:251], a[228:231], v[168:171], v[248:251]
    buffer_load_dwordx4 v1, s[36:39], s77 offen offset:3072 sc1 lds
    s_add_u32 s100, s77, 4096
    v_mfma_f32_16x16x32_bf16 v[248:251], a[232:235], v[200:203], v[248:251]
    v_mfma_f32_16x16x32_bf16 v[248:251], a[236:239], v[232:235], v[248:251]
    v_mfma_f32_16x16x32_bf16 v[252:255], a[224:227], v[140:143], 0
    v_mfma_f32_16x16x32_bf16 v[252:255], a[228:231], v[172:175], v[252:255]
    v_mfma_f32_16x16x32_bf16 v[252:255], a[232:235], v[204:207], v[252:255]
    v_mfma_f32_16x16x32_bf16 v[252:255], a[236:239], v[236:239], v[252:255]
    s_add_u32 m0, m0, 4096
    s_nop 0
    buffer_load_dwordx4 v1, s[36:39], s100 offen sc1 lds
    v_max3_f32 v240, v240, v241, v242
    v_max_f32 v240, v240, v243
    v_max3_f32 v244, v244, v245, v246
    v_max_f32 v244, v244, v247
    v_max3_f32 v248, v248, v249, v250
    v_max_f32 v248, v248, v251
    v_max3_f32 v252, v252, v253, v254
    v_max_f32 v252, v252, v255
    v_mov_b32 v241, v240
    v_mov_b32 v245, v244
    v_mov_b32 v249, v248
    v_mov_b32 v253, v252
    buffer_load_dwordx4 v1, s[36:39], s100 offen offset:1024 sc1 lds
    v_permlane32_swap_b32 v240, v241
    v_permlane32_swap_b32 v244, v245
    v_permlane32_swap_b32 v248, v249
    v_permlane32_swap_b32 v252, v253
    v_max_f32 v240, v240, v241
    v_max_f32 v244, v244, v245
    v_max_f32 v248, v248, v249
    v_max_f32 v252, v252, v253
    v_mov_b32 v241, v240
    v_mov_b32 v245, v244
    v_mov_b32 v249, v248
    v_mov_b32 v253, v252
    buffer_load_dwordx4 v1, s[36:39], s100 offen offset:2048 sc1 lds
    v_permlane16_swap_b32 v240, v241
    v_permlane16_swap_b32 v244, v245
    v_permlane16_swap_b32 v248, v249
    v_permlane16_swap_b32 v252, v253
    v_max_f32 v240, v240, v241
    v_max_f32 v244, v244, v245
    v_max_f32 v248, v248, v249
    v_max_f32 v252, v252, v253
    v_sub_f32 v144, 0, v240
    v_sub_f32 v145, 0, v240
    v_sub_f32 v146, 0, v240
    v_sub_f32 v147, 0, v240
    buffer_load_dwordx4 v1, s[36:39], s100 offen offset:3072 sc1 lds
    s_add_u32 s77, s77, 32768
    s_add_u32 s76, s76, 32768
    v_sub_f32 v148, 0, v244
    v_sub_f32 v149, 0, v244
    v_sub_f32 v150, 0, v244
    v_sub_f32 v151, 0, v244
    v_sub_f32 v152, 0, v248
    v_sub_f32 v153, 0, v248
    v_sub_f32 v154, 0, v248
    v_sub_f32 v155, 0, v248
    v_sub_f32 v156, 0, v252
    v_sub_f32 v157, 0, v252
    v_sub_f32 v158, 0, v252
    v_sub_f32 v159, 0, v252
K1_HAVEM:
    v_add_f32 v212, s20, v144
    v_fma_f32 v176, v208, s16, v212
    v_fma_f32 v177, v209, s16, v212
    v_fma_f32 v178, v210, s16, v212
    v_fma_f32 v179, v211, s16, v212
    s_nop 1
    s_waitcnt lgkmcnt(0)
    v_mfma_f32_16x16x32_bf16 v[240:243], a[224:227], v[128:131], v[176:179]
    s_add_u32 m0, s76, s75
    ds_read_b128 a[240:243], v2 offset:4096
    ds_read_b128 a[244:247], v2 offset:5120
    v_mfma_f32_16x16x32_bf16 v[240:243], a[228:231], v[160:163], v[240:243]
    s_mov_b32 s76, s60
    buffer_load_dwordx4 v1, s[36:39], s77 offen sc1 lds
    v_mfma_f32_16x16x32_bf16 v[240:243], a[232:235], v[192:195], v[240:243]
    s_mov_b32 s60, s82
    ds_read_b128 a[248:251], v2 offset:6144
    ds_read_b128 a[252:255], v2 offset:7168
    v_mfma_f32_16x16x32_bf16 v[240:243], a[236:239], v[224:227], v[240:243]
    s_add_u32 s82, s82, 32768
    v_add_f32 v213, s21, v144
    v_fma_f32 v180, v208, s17, v213
    v_mfma_f32_16x16x32_bf16 v[244:247], a[224:227], v[132:135], v[148:151]
    v_fma_f32 v181, v209, s17, v213
    v_fma_f32 v182, v210, s17, v213
    v_mfma_f32_16x16x32_bf16 v[244:247], a[228:231], v[164:167], v[244:247]
    v_fma_f32 v183, v211, s17, v213
    v_add_f32 v214, s22, v144
    v_mfma_f32_16x16x32_bf16 v[244:247], a[232:235], v[196:199], v[244:247]
    buffer_load_dwordx4 v1, s[36:39], s77 offen offset:1024 sc1 lds
    v_mfma_f32_16x16x32_bf16 v[244:247], a[236:239], v[228:231], v[244:247]
    v_exp_f32 v240, v240
    v_mfma_f32_16x16x32_bf16 v[248:251], a[224:227], v[136:139], v[152:155]
    v_exp_f32 v241, v241
    v_mfma_f32_16x16x32_bf16 v[248:251], a[228:231], v[168:171], v[248:251]
    v_exp_f32 v242, v242
    v_mfma_f32_16x16x32_bf16 v[248:251], a[232:235], v[200:203], v[248:251]
    v_exp_f32 v243, v243
    v_mfma_f32_16x16x32_bf16 v[248:251], a[236:239], v[232:235], v[248:251]
    buffer_load_dwordx4 v1, s[36:39], s77 offen offset:2048 sc1 lds
    v_mfma_f32_16x16x32_bf16 v[252:255], a[224:227], v[140:143], v[156:159]
    v_cvt_pk_bf16_f32 v32, v240, v241
    v_cvt_pk_bf16_f32 v33, v242, v243
    v_mfma_f32_16x16x32_bf16 v[252:255], a[228:231], v[172:175], v[252:255]
    v_exp_f32 v244, v244
    v_mfma_f32_16x16x32_bf16 v[252:255], a[232:235], v[204:207], v[252:255]
    v_exp_f32 v245, v245
    v_mfma_f32_16x16x32_bf16 v[252:255], a[236:239], v[236:239], v[252:255]
    s_waitcnt lgkmcnt(0)
    v_exp_f32 v246, v246
    v_mfma_f32_16x16x32_bf16 v[240:243], a[240:243], v[128:131], v[180:183]
    v_exp_f32 v247, v247
    v_mfma_f32_16x16x32_bf16 v[240:243], a[244:247], v[160:163], v[240:243]
    buffer_load_dwordx4 v1, s[36:39], s77 offen offset:3072 sc1 lds
    v_mfma_f32_16x16x32_bf16 v[240:243], a[248:251], v[192:195], v[240:243]
    v_cvt_pk_bf16_f32 v40, v244, v245
    v_cvt_pk_bf16_f32 v41, v246, v247
    v_mfma_f32_16x16x32_bf16 v[240:243], a[252:255], v[224:227], v[240:243]
    v_exp_f32 v248, v248
    v_mfma_f32_16x16x32_bf16 v[244:247], a[240:243], v[132:135], v[148:151]
    v_exp_f32 v249, v249
    v_mfma_f32_16x16x32_bf16 v[244:247], a[244:247], v[164:167], v[244:247]
    s_add_u32 s100, s77, 4096
    v_exp_f32 v250, v250
    v_mfma_f32_16x16x32_bf16 v[244:247], a[248:251], v[196:199], v[244:247]
    s_add_u32 m0, m0, 4096
    v_exp_f32 v251, v251
    v_mfma_f32_16x16x32_bf16 v[244:247], a[252:255], v[228:231], v[244:247]
    v_cvt_pk_bf16_f32 v48, v248, v249
    v_cvt_pk_bf16_f32 v49, v250, v251
    v_mfma_f32_16x16x32_bf16 v[248:251], a[240:243], v[136:139], v[152:155]
    ds_read_b128 a[224:227], v2 offset:8192
    ds_read_b128 a[228:231], v2 offset:9216
    v_mfma_f32_16x16x32_bf16 v[248:251], a[244:247], v[168:171], v[248:251]
    buffer_load_dwordx4 v1, s[36:39], s100 offen sc1 lds
    v_mfma_f32_16x16x32_bf16 v[248:251], a[248:251], v[200:203], v[248:251]
    v_exp_f32 v252, v252
    v_mfma_f32_16x16x32_bf16 v[248:251], a[252:255], v[232:235], v[248:251]
    v_exp_f32 v253, v253
    v_exp_f32 v254, v254
    v_exp_f32 v255, v255
    v_cvt_pk_bf16_f32 v56, v252, v253
    v_cvt_pk_bf16_f32 v57, v254, v255
    v_mfma_f32_16x16x32_bf16 v[252:255], a[240:243], v[140:143], v[156:159]
    ds_read_b128 a[232:235], v2 offset:10240
    ds_read_b128 a[236:239], v2 offset:11264
    v_mfma_f32_16x16x32_bf16 v[252:255], a[244:247], v[172:175], v[252:255]
    buffer_load_dwordx4 v1, s[36:39], s100 offen offset:1024 sc1 lds
    v_mfma_f32_16x16x32_bf16 v[252:255], a[248:251], v[204:207], v[252:255]
    v_exp_f32 v240, v240
    v_mfma_f32_16x16x32_bf16 v[252:255], a[252:255], v[236:239], v[252:255]
    s_waitcnt lgkmcnt(2)
    v_exp_f32 v241, v241
    v_exp_f32 v242, v242
    v_exp_f32 v243, v243
    v_fma_f32 v184, v208, s18, v214
    v_fma_f32 v185, v209, s18, v214
    v_fma_f32 v186, v210, s18, v214
    v_fma_f32 v187, v211, s18, v214
    v_cvt_pk_bf16_f32 v34, v240, v241
    v_cvt_pk_bf16_f32 v35, v242, v243
    v_mfma_f32_16x16x32_bf16 v[240:243], a[224:227], v[128:131], v[184:187]
    v_exp_f32 v244, v244
    v_mfma_f32_16x16x32_bf16 v[240:243], a[228:231], v[160:163], v[240:243]
    s_waitcnt lgkmcnt(0)
    v_exp_f32 v245, v245
    v_mfma_f32_16x16x32_bf16 v[240:243], a[232:235], v[192:195], v[240:243]
    v_exp_f32 v246, v246
    v_mfma_f32_16x16x32_bf16 v[240:243], a[236:239], v[224:227], v[240:243]
    v_exp_f32 v247, v247
    v_cvt_pk_bf16_f32 v42, v244, v245
    v_cvt_pk_bf16_f32 v43, v246, v247
    v_mfma_f32_16x16x32_bf16 v[244:247], a[224:227], v[132:135], v[148:151]
    buffer_load_dwordx4 v1, s[36:39], s100 offen offset:2048 sc1 lds
    v_mfma_f32_16x16x32_bf16 v[244:247], a[228:231], v[164:167], v[244:247]
    v_exp_f32 v248, v248
    v_mfma_f32_16x16x32_bf16 v[244:247], a[232:235], v[196:199], v[244:247]
    v_exp_f32 v249, v249
    v_mfma_f32_16x16x32_bf16 v[244:247], a[236:239], v[228:231], v[244:247]
    v_exp_f32 v250, v250
    v_exp_f32 v251, v251
    v_cvt_pk_bf16_f32 v50, v248, v249
    v_cvt_pk_bf16_f32 v51, v250, v251
    v_mfma_f32_16x16x32_bf16 v[248:251], a[224:227], v[136:139], v[152:155]
    buffer_load_dwordx4 v1, s[36:39], s100 offen offset:3072 sc1 lds
    v_mfma_f32_16x16x32_bf16 v[248:251], a[228:231], v[168:171], v[248:251]
    ds_read_b128 a[240:243], v2 offset:12288
    ds_read_b128 a[244:247], v2 offset:13312
    v_mfma_f32_16x16x32_bf16 v[248:251], a[232:235], v[200:203], v[248:251]
    s_add_u32 s77, s77, 32768
    v_exp_f32 v252, v252
    v_mfma_f32_16x16x32_bf16 v[248:251], a[236:239], v[232:235], v[248:251]
    v_exp_f32 v253, v253
    v_exp_f32 v254, v254
    v_exp_f32 v255, v255
    v_cvt_pk_bf16_f32 v58, v252, v253
    v_cvt_pk_bf16_f32 v59, v254, v255
    v_mfma_f32_16x16x32_bf16 v[252:255], a[224:227], v[140:143], v[156:159]
    ds_read_b128 a[248:251], v2 offset:14336
    ds_read_b128 a[252:255], v2 offset:15360
    v_mfma_f32_16x16x32_bf16 v[252:255], a[228:231], v[172:175], v[252:255]
    v_add_f32 v215, s23, v144
    v_fma_f32 v188, v208, s19, v215
    v_mfma_f32_16x16x32_bf16 v[252:255], a[232:235], v[204:207], v[252:255]
    v_exp_f32 v240, v240
    v_mfma_f32_16x16x32_bf16 v[252:255], a[236:239], v[236:239], v[252:255]
    s_waitcnt lgkmcnt(2)
    v_exp_f32 v241, v241
    v_exp_f32 v242, v242
    v_exp_f32 v243, v243
    v_fma_f32 v189, v209, s19, v215
    v_fma_f32 v190, v210, s19, v215
    v_fma_f32 v191, v211, s19, v215
    v_cvt_pk_bf16_f32 v36, v240, v241
    v_cvt_pk_bf16_f32 v37, v242, v243
    v_mfma_f32_16x16x32_bf16 v[240:243], a[240:243], v[128:131], v[188:191]
    v_exp_f32 v244, v244
    v_mfma_f32_16x16x32_bf16 v[240:243], a[244:247], v[160:163], v[240:243]
    s_cmp_eq_u32 s82, 163840
    s_cselect_b32 s82, 0, s82
    v_add_u32 v2, s82, v1
    s_waitcnt lgkmcnt(0)
    v_mfma_f32_16x16x32_bf16 v[240:243], a[248:251], v[192:195], v[240:243]
    v_exp_f32 v245, v245
    v_mfma_f32_16x16x32_bf16 v[240:243], a[252:255], v[224:227], v[240:243]
    s_waitcnt vmcnt(8) lgkmcnt(0)
    s_barrier
    v_cvt_pk_bf16_f32 v44, v244, v245
    v_exp_f32 v246, v246
    v_exp_f32 v247, v247
    s_nop 0
    v_cvt_pk_bf16_f32 v45, v246, v247
    v_mfma_f32_16x16x32_bf16 v[244:247], a[240:243], v[132:135], v[148:151]
    ds_read_b128 a[224:227], v2 offset:0
    ds_read_b128 a[228:231], v2 offset:1024
    v_mfma_f32_16x16x32_bf16 v[244:247], a[244:247], v[164:167], v[244:247]
    v_exp_f32 v248, v248
    v_mfma_f32_16x16x32_bf16 v[244:247], a[248:251], v[196:199], v[244:247]
    v_exp_f32 v249, v249
    v_mfma_f32_16x16x32_bf16 v[244:247], a[252:255], v[228:231], v[244:247]
    v_exp_f32 v250, v250
    v_exp_f32 v251, v251
    v_cvt_pk_bf16_f32 v52, v248, v249
    v_cvt_pk_bf16_f32 v53, v250, v251
    v_mfma_f32_16x16x32_bf16 v[248:251], a[240:243], v[136:139], v[152:155]
    ds_read_b128 a[232:235], v2 offset:2048
    ds_read_b128 a[236:239], v2 offset:3072
    v_mfma_f32_16x16x32_bf16 v[248:251], a[244:247], v[168:171], v[248:251]
    ds_read_b128 v[96:99], v2 offset:16384
    v_mfma_f32_16x16x32_bf16 v[248:251], a[248:251], v[200:203], v[248:251]
    v_exp_f32 v252, v252
    v_mfma_f32_16x16x32_bf16 v[248:251], a[252:255], v[232:235], v[248:251]
    v_exp_f32 v253, v253
    v_exp_f32 v254, v254
    v_exp_f32 v255, v255
    v_cvt_pk_bf16_f32 v60, v252, v253
    v_cvt_pk_bf16_f32 v61, v254, v255
    v_mfma_f32_16x16x32_bf16 v[252:255], a[240:243], v[140:143], v[156:159]
    ds_read_b128 v[100:103], v2 offset:17408
    v_mfma_f32_16x16x32_bf16 v[252:255], a[244:247], v[172:175], v[252:255]
    v_exp_f32 v240, v240
    v_mfma_f32_16x16x32_bf16 v[252:255], a[248:251], v[204:207], v[252:255]
    v_exp_f32 v241, v241
    v_mfma_f32_16x16x32_bf16 v[252:255], a[252:255], v[236:239], v[252:255]
    v_exp_f32 v242, v242
    v_exp_f32 v243, v243
    v_exp_f32 v244, v244
    v_exp_f32 v245, v245
    v_exp_f32 v246, v246
    v_exp_f32 v247, v247
    v_exp_f32 v248, v248
    v_exp_f32 v249, v249
    v_exp_f32 v250, v250
    v_exp_f32 v251, v251
    v_exp_f32 v252, v252
    v_exp_f32 v253, v253
    v_cvt_pk_bf16_f32 v38, v240, v241
    v_cvt_pk_bf16_f32 v39, v242, v243
    v_cvt_pk_bf16_f32 v46, v244, v245
    v_cvt_pk_bf16_f32 v47, v246, v247
    v_cvt_pk_bf16_f32 v54, v248, v249
    v_cvt_pk_bf16_f32 v55, v250, v251
    v_cvt_pk_bf16_f32 v62, v252, v253
    v_mov_b32 v9, 1
    s_mov_b32 s78, s6
    buffer_atomic_add v9, v30, s[44:47], s95 offen sc1
    s_cmp_eq_u32 s78, 0
    s_cbranch_scc1 K1_LB_END
.p2align 3
K1_LB:
    s_waitcnt lgkmcnt(0)
    v_mfma_f32_16x16x32_bf16 v[240:243], a[224:227], v[128:131], v[176:179]
    s_add_u32 m0, s76, s75
    v_exp_f32 v254, v254
    v_mfma_f32_16x16x32_bf16 v[240:243], a[228:231], v[160:163], v[240:243]
    s_mov_b32 s76, s60
    buffer_load_dwordx4 v1, s[36:39], s77 offen sc1 lds
    v_mfma_f32_16x16x32_bf16 v[240:243], a[232:235], v[192:195], v[240:243]
    s_mov_b32 s60, s82
    v_exp_f32 v255, v255
    v_mfma_f32_16x16x32_bf16 v[240:243], a[236:239], v[224:227], v[240:243]
    s_add_u32 s82, s82, 32768
    ds_read_b128 v[104:107], v2 offset:18432
    v_cvt_pk_bf16_f32 v63, v254, v255
    v_mfma_f32_16x16x32_bf16 a[0:3], v[96:99], v[32:35], a[0:3]
    ds_read_b128 v[108:111], v2 offset:19456
    ds_read_b128 a[240:243], v2 offset:4096
    v_mfma_f32_16x16x32_bf16 a[0:3], v[100:103], v[36:39], a[0:3]
    ds_read_b128 a[244:247], v2 offset:5120
    v_mfma_f32_16x16x32_bf16 a[4:7], v[96:99], v[40:43], a[4:7]
    v_exp_f32 v240, v240
    v_mfma_f32_16x16x32_bf16 a[4:7], v[100:103], v[44:47], a[4:7]
    ds_read_b128 a[248:251], v2 offset:6144
    ds_read_b128 a[252:255], v2 offset:7168
    v_mfma_f32_16x16x32_bf16 v[244:247], a[224:227], v[132:135], v[148:151]
    v_exp_f32 v241, v241
    v_mfma_f32_16x16x32_bf16 v[244:247], a[228:231], v[164:167], v[244:247]
    ds_read_b128 v[112:115], v2 offset:20480
    ds_read_b128 v[116:119], v2 offset:21504
    v_mfma_f32_16x16x32_bf16 v[244:247], a[232:235], v[196:199], v[244:247]
    v_exp_f32 v242, v242
    v_mfma_f32_16x16x32_bf16 v[244:247], a[236:239], v[228:231], v[244:247]
    v_exp_f32 v243, v243
    v_mfma_f32_16x16x32_bf16 a[8:11], v[96:99], v[48:51], a[8:11]
    v_cvt_pk_bf16_f32 v64, v240, v241
    v_cvt_pk_bf16_f32 v65, v242, v243
    v_mfma_f32_16x16x32_bf16 a[8:11], v[100:103], v[52:55], a[8:11]
    ds_read_b128 v[120:123], v2 offset:22528
    ds_read_b128 v[124:127], v2 offset:23552
    v_mfma_f32_16x16x32_bf16 a[12:15], v[96:99], v[56:59], a[12:15]
    v_exp_f32 v244, v244
    v_mfma_f32_16x16x32_bf16 a[12:15], v[100:103], v[60:63], a[12:15]
    buffer_load_dwordx4 v1, s[36:39], s77 offen offset:1024 sc1 lds
    v_mfma_f32_16x16x32_bf16 v[248:251], a[224:227], v[136:139], v[152:155]
    v_exp_f32 v245, v245
    v_mfma_f32_16x16x32_bf16 v[248:251], a[228:231], v[168:171], v[248:251]
    v_exp_f32 v246, v246
    v_mfma_f32_16x16x32_bf16 v[248:251], a[232:235], v[200:203], v[248:251]
    v_exp_f32 v247, v247
    v_mfma_f32_16x16x32_bf16 v[248:251], a[236:239], v[232:235], v[248:251]
    s_waitcnt lgkmcnt(0)
    v_cvt_pk_bf16_f32 v72, v244, v245
    v_cvt_pk_bf16_f32 v73, v246, v247
    v_mfma_f32_16x16x32_bf16 a[16:19], v[104:107], v[32:35], a[16:19]
    ds_read_b128 v[96:99], v2 offset:24576
    ds_read_b128 v[100:103], v2 offset:25600
    v_mfma_f32_16x16x32_bf16 a[16:19], v[108:111], v[36:39], a[16:19]
    v_mfma_f32_16x16x32_bf16 a[20:23], v[104:107], v[40:43], a[20:23]
    v_mfma_f32_16x16x32_bf16 a[20:23], v[108:111], v[44:47], a[20:23]
    v_exp_f32 v248, v248
    v_mfma_f32_16x16x32_bf16 v[252:255], a[224:227], v[140:143], v[156:159]
    v_exp_f32 v249, v249
    v_mfma_f32_16x16x32_bf16 v[252:255], a[228:231], v[172:175], v[252:255]
    v_exp_f32 v250, v250
    v_mfma_f32_16x16x32_bf16 v[252:255], a[232:235], v[204:207], v[252:255]
    v_exp_f32 v251, v251
    v_mfma_f32_16x16x32_bf16 v[252:255], a[236:239], v[236:239], v[252:255]
    v_cvt_pk_bf16_f32 v80, v248, v249
    v_cvt_pk_bf16_f32 v81, v250, v251
    v_mfma_f32_16x16x32_bf16 a[24:27], v[104:107], v[48:51], a[24:27]
    ds_read_b128 a[224:227], v2 offset:8192
    ds_read_b128 a[228:231], v2 offset:9216
    v_mfma_f32_16x16x32_bf16 a[24:27], v[108:111], v[52:55], a[24:27]
    buffer_load_dwordx4 v1, s[36:39], s77 offen offset:2048 sc1 lds
    v_mfma_f32_16x16x32_bf16 a[28:31], v[104:107], v[56:59], a[28:31]
    v_exp_f32 v252, v252
    v_mfma_f32_16x16x32_bf16 a[28:31], v[108:111], v[60:63], a[28:31]
    v_exp_f32 v253, v253
    v_mfma_f32_16x16x32_bf16 v[240:243], a[240:243], v[128:131], v[180:183]
    v_exp_f32 v254, v254
    v_mfma_f32_16x16x32_bf16 v[240:243], a[244:247], v[160:163], v[240:243]
    v_exp_f32 v255, v255
    v_mfma_f32_16x16x32_bf16 v[240:243], a[248:251], v[192:195], v[240:243]
    v_cvt_pk_bf16_f32 v88, v252, v253
    v_cvt_pk_bf16_f32 v89, v254, v255
    v_mfma_f32_16x16x32_bf16 v[240:243], a[252:255], v[224:227], v[240:243]
    ds_read_b128 a[232:235], v2 offset:10240
    ds_read_b128 a[236:239], v2 offset:11264
    v_mfma_f32_16x16x32_bf16 a[32:35], v[112:115], v[32:35], a[32:35]
    ds_read_b128 v[104:107], v2 offset:26624
    v_mfma_f32_16x16x32_bf16 a[32:35], v[116:119], v[36:39], a[32:35]
    ds_read_b128 v[108:111], v2 offset:27648
    v_mfma_f32_16x16x32_bf16 a[36:39], v[112:115], v[40:43], a[36:39]
    v_mfma_f32_16x16x32_bf16 a[36:39], v[116:119], v[44:47], a[36:39]
    v_exp_f32 v240, v240
    v_mfma_f32_16x16x32_bf16 v[244:247], a[240:243], v[132:135], v[148:151]
    v_exp_f32 v241, v241
    v_mfma_f32_16x16x32_bf16 v[244:247], a[244:247], v[164:167], v[244:247]
    v_exp_f32 v242, v242
    v_mfma_f32_16x16x32_bf16 v[244:247], a[248:251], v[196:199], v[244:247]
    v_exp_f32 v243, v243
    v_mfma_f32_16x16x32_bf16 v[244:247], a[252:255], v[228:231], v[244:247]
    buffer_load_dwordx4 v1, s[36:39], s77 offen offset:3072 sc1 lds
    v_mfma_f32_16x16x32_bf16 a[40:43], v[112:115], v[48:51], a[40:43]
    v_cvt_pk_bf16_f32 v66, v240, v241
    v_cvt_pk_bf16_f32 v67, v242, v243
    v_mfma_f32_16x16x32_bf16 a[40:43], v[116:119], v[52:55], a[40:43]
    v_mfma_f32_16x16x32_bf16 a[44:47], v[112:115], v[56:59], a[44:47]
    ds_read_b128 v[112:115], v2 offset:28672
    v_mfma_f32_16x16x32_bf16 a[44:47], v[116:119], v[60:63], a[44:47]
    v_exp_f32 v244, v244
    v_mfma_f32_16x16x32_bf16 v[248:251], a[240:243], v[136:139], v[152:155]
    v_exp_f32 v245, v245
    v_mfma_f32_16x16x32_bf16 v[248:251], a[244:247], v[168:171], v[248:251]
    v_exp_f32 v246, v246
    v_mfma_f32_16x16x32_bf16 v[248:251], a[248:251], v[200:203], v[248:251]
    v_exp_f32 v247, v247
    v_mfma_f32_16x16x32_bf16 v[248:251], a[252:255], v[232:235], v[248:251]
    v_cvt_pk_bf16_f32 v74, v244, v245
    v_cvt_pk_bf16_f32 v75, v246, v247
    v_mfma_f32_16x16x32_bf16 a[48:51], v[120:123], v[32:35], a[48:51]
    ds_read_b128 v[116:119], v2 offset:29696
    v_mfma_f32_16x16x32_bf16 a[48:51], v[124:127], v[36:39], a[48:51]
    v_mfma_f32_16x16x32_bf16 a[52:55], v[120:123], v[40:43], a[52:55]
    v_mfma_f32_16x16x32_bf16 a[52:55], v[124:127], v[44:47], a[52:55]
    v_mfma_f32_16x16x32_bf16 v[252:255], a[240:243], v[140:143], v[156:159]
    v_exp_f32 v248, v248
    v_mfma_f32_16x16x32_bf16 v[252:255], a[244:247], v[172:175], v[252:255]
    s_add_u32 s100, s77, 4096
    v_exp_f32 v249, v249
    v_mfma_f32_16x16x32_bf16 v[252:255], a[248:251], v[204:207], v[252:255]
    s_add_u32 m0, m0, 4096
    v_exp_f32 v250, v250
    v_mfma_f32_16x16x32_bf16 v[252:255], a[252:255], v[236:239], v[252:255]
    buffer_load_dwordx4 v1, s[36:39], s100 offen sc1 lds
    v_mfma_f32_16x16x32_bf16 a[56:59], v[120:123], v[48:51], a[56:59]
    v_exp_f32 v251, v251
    v_mfma_f32_16x16x32_bf16 a[56:59], v[124:127], v[52:55], a[56:59]
    v_cvt_pk_bf16_f32 v82, v248, v249
    v_cvt_pk_bf16_f32 v83, v250, v251
    v_mfma_f32_16x16x32_bf16 a[60:63], v[120:123], v[56:59], a[60:63]
    ds_read_b128 a[240:243], v2 offset:12288
    ds_read_b128 a[244:247], v2 offset:13312
    v_mfma_f32_16x16x32_bf16 a[60:63], v[124:127], v[60:63], a[60:63]
    s_waitcnt lgkmcnt(2)
    v_exp_f32 v252, v252
    v_mfma_f32_16x16x32_bf16 v[240:243], a[224:227], v[128:131], v[184:187]
    v_exp_f32 v253, v253
    v_mfma_f32_16x16x32_bf16 v[240:243], a[228:231], v[160:163], v[240:243]
    v_exp_f32 v254, v254
    v_mfma_f32_16x16x32_bf16 v[240:243], a[232:235], v[192:195], v[240:243]
    v_exp_f32 v255, v255
    v_mfma_f32_16x16x32_bf16 v[240:243], a[236:239], v[224:227], v[240:243]
    v_cvt_pk_bf16_f32 v90, v252, v253
    v_cvt_pk_bf16_f32 v91, v254, v255
    v_mfma_f32_16x16x32_bf16 a[144:147], v[96:99], v[32:35], a[144:147]
    ds_read_b128 a[248:251], v2 offset:14336
    ds_read_b128 a[252:255], v2 offset:15360
    v_mfma_f32_16x16x32_bf16 a[144:147], v[100:103], v[36:39], a[144:147]
    ds_read_b128 v[120:123], v2 offset:30720
    v_mfma_f32_16x16x32_bf16 a[148:151], v[96:99], v[40:43], a[148:151]
    v_exp_f32 v240, v240
    v_mfma_f32_16x16x32_bf16 a[148:151], v[100:103], v[44:47], a[148:151]
    v_exp_f32 v241, v241
    v_mfma_f32_16x16x32_bf16 v[244:247], a[224:227], v[132:135], v[148:151]
    buffer_load_dwordx4 v1, s[36:39], s100 offen offset:1024 sc1 lds
    v_mfma_f32_16x16x32_bf16 v[244:247], a[228:231], v[164:167], v[244:247]
    v_exp_f32 v242, v242
    v_mfma_f32_16x16x32_bf16 v[244:247], a[232:235], v[196:199], v[244:247]
    v_exp_f32 v243, v243
    v_mfma_f32_16x16x32_bf16 v[244:247], a[236:239], v[228:231], v[244:247]
    v_cvt_pk_bf16_f32 v68, v240, v241
    v_cvt_pk_bf16_f32 v69, v242, v243
    v_mfma_f32_16x16x32_bf16 a[152:155], v[96:99], v[48:51], a[152:155]
    ds_read_b128 v[124:127], v2 offset:31744
    v_mfma_f32_16x16x32_bf16 a[152:155], v[100:103], v[52:55], a[152:155]
    v_mfma_f32_16x16x32_bf16 a[156:159], v[96:99], v[56:59], a[156:159]
    v_mfma_f32_16x16x32_bf16 a[156:159], v[100:103], v[60:63], a[156:159]
    v_mfma_f32_16x16x32_bf16 v[248:251], a[224:227], v[136:139], v[152:155]
    v_exp_f32 v244, v244
    v_mfma_f32_16x16x32_bf16 v[248:251], a[228:231], v[168:171], v[248:251]
    v_exp_f32 v245, v245
    v_mfma_f32_16x16x32_bf16 v[248:251], a[232:235], v[200:203], v[248:251]
    v_exp_f32 v246, v246
    v_mfma_f32_16x16x32_bf16 v[248:251], a[236:239], v[232:235], v[248:251]
    v_exp_f32 v247, v247
    v_mfma_f32_16x16x32_bf16 a[160:163], v[104:107], v[32:35], a[160:163]
    v_cvt_pk_bf16_f32 v76, v244, v245
    v_cvt_pk_bf16_f32 v77, v246, v247
    v_mfma_f32_16x16x32_bf16 a[160:163], v[108:111], v[36:39], a[160:163]
    v_mfma_f32_16x16x32_bf16 a[164:167], v[104:107], v[40:43], a[164:167]
    buffer_load_dwordx4 v1, s[36:39], s100 offen offset:2048 sc1 lds
    v_mfma_f32_16x16x32_bf16 a[164:167], v[108:111], v[44:47], a[164:167]
    v_exp_f32 v248, v248
    v_mfma_f32_16x16x32_bf16 v[252:255], a[224:227], v[140:143], v[156:159]
    v_exp_f32 v249, v249
    v_mfma_f32_16x16x32_bf16 v[252:255], a[228:231], v[172:175], v[252:255]
    v_exp_f32 v250, v250
    v_mfma_f32_16x16x32_bf16 v[252:255], a[232:235], v[204:207], v[252:255]
    v_exp_f32 v251, v251
    v_mfma_f32_16x16x32_bf16 v[252:255], a[236:239], v[236:239], v[252:255]
    v_cvt_pk_bf16_f32 v84, v248, v249
    v_cvt_pk_bf16_f32 v85, v250, v251
    v_mfma_f32_16x16x32_bf16 a[168:171], v[104:107], v[48:51], a[168:171]
    v_mfma_f32_16x16x32_bf16 a[168:171], v[108:111], v[52:55], a[168:171]
    v_mfma_f32_16x16x32_bf16 a[172:175], v[104:107], v[56:59], a[172:175]
    v_mfma_f32_16x16x32_bf16 a[172:175], v[108:111], v[60:63], a[172:175]
    s_waitcnt lgkmcnt(0)
    v_mfma_f32_16x16x32_bf16 v[240:243], a[240:243], v[128:131], v[188:191]
    v_mfma_f32_16x16x32_bf16 v[240:243], a[244:247], v[160:163], v[240:243]
    v_exp_f32 v252, v252
    v_mfma_f32_16x16x32_bf16 v[240:243], a[248:251], v[192:195], v[240:243]
    v_exp_f32 v253, v253
    v_mfma_f32_16x16x32_bf16 v[240:243], a[252:255], v[224:227], v[240:243]
    v_exp_f32 v254, v254
    v_mfma_f32_16x16x32_bf16 a[176:179], v[112:115], v[32:35], a[176:179]
    buffer_load_dwordx4 v1, s[36:39], s100 offen offset:3072 sc1 lds
    v_mfma_f32_16x16x32_bf16 a[176:179], v[116:119], v[36:39], a[176:179]
    v_exp_f32 v255, v255
    v_mfma_f32_16x16x32_bf16 a[180:183], v[112:115], v[40:43], a[180:183]
    v_cvt_pk_bf16_f32 v92, v252, v253
    v_cvt_pk_bf16_f32 v93, v254, v255
    v_mfma_f32_16x16x32_bf16 a[180:183], v[116:119], v[44:47], a[180:183]
    s_cmp_eq_u32 s82, 163840
    s_cselect_b32 s82, 0, s82
    v_add_u32 v2, s82, v1
    v_mfma_f32_16x16x32_bf16 v[244:247], a[240:243], v[132:135], v[148:151]
    ds_read_b128 a[224:227], v2 offset:0
    ds_read_b128 a[228:231], v2 offset:1024
    v_mfma_f32_16x16x32_bf16 v[244:247], a[244:247], v[164:167], v[244:247]
    v_exp_f32 v240, v240
    v_mfma_f32_16x16x32_bf16 v[244:247], a[248:251], v[196:199], v[244:247]
    ds_read_b128 a[232:235], v2 offset:2048
    ds_read_b128 a[236:239], v2 offset:3072
    v_mfma_f32_16x16x32_bf16 v[244:247], a[252:255], v[228:231], v[244:247]
    v_exp_f32 v241, v241
    v_mfma_f32_16x16x32_bf16 a[184:187], v[112:115], v[48:51], a[184:187]
    ds_read_b128 v[96:99], v2 offset:16384
    ds_read_b128 v[100:103], v2 offset:17408
    v_mfma_f32_16x16x32_bf16 a[184:187], v[116:119], v[52:55], a[184:187]
    v_exp_f32 v242, v242
    v_mfma_f32_16x16x32_bf16 a[188:191], v[112:115], v[56:59], a[188:191]
    v_exp_f32 v243, v243
    v_mfma_f32_16x16x32_bf16 a[188:191], v[116:119], v[60:63], a[188:191]
    v_exp_f32 v244, v244
    v_mfma_f32_16x16x32_bf16 v[248:251], a[240:243], v[136:139], v[152:155]
    v_exp_f32 v245, v245
    v_mfma_f32_16x16x32_bf16 v[248:251], a[244:247], v[168:171], v[248:251]
    v_exp_f32 v246, v246
    v_mfma_f32_16x16x32_bf16 v[248:251], a[248:251], v[200:203], v[248:251]
    s_add_u32 s77, s77, 32768
    v_exp_f32 v247, v247
    v_mfma_f32_16x16x32_bf16 v[248:251], a[252:255], v[232:235], v[248:251]
    v_cvt_pk_bf16_f32 v70, v240, v241
    v_cvt_pk_bf16_f32 v71, v242, v243
    v_mfma_f32_16x16x32_bf16 a[192:195], v[120:123], v[32:35], a[192:195]
    v_cvt_pk_bf16_f32 v78, v244, v245
    v_cvt_pk_bf16_f32 v79, v246, v247
    v_mfma_f32_16x16x32_bf16 a[192:195], v[124:127], v[36:39], a[192:195]
    v_mfma_f32_16x16x32_bf16 a[196:199], v[120:123], v[40:43], a[196:199]
    v_mfma_f32_16x16x32_bf16 a[196:199], v[124:127], v[44:47], a[196:199]
    v_exp_f32 v248, v248
    v_mfma_f32_16x16x32_bf16 v[252:255], a[240:243], v[140:143], v[156:159]
    v_exp_f32 v249, v249
    v_mfma_f32_16x16x32_bf16 v[252:255], a[244:247], v[172:175], v[252:255]
    v_exp_f32 v250, v250
    v_mfma_f32_16x16x32_bf16 v[252:255], a[248:251], v[204:207], v[252:255]
    v_exp_f32 v251, v251
    v_mfma_f32_16x16x32_bf16 v[252:255], a[252:255], v[236:239], v[252:255]
    v_cvt_pk_bf16_f32 v86, v248, v249
    v_cvt_pk_bf16_f32 v87, v250, v251
    v_mfma_f32_16x16x32_bf16 a[200:203], v[120:123], v[48:51], a[200:203]
    v_mfma_f32_16x16x32_bf16 a[200:203], v[124:127], v[52:55], a[200:203]
    v_mfma_f32_16x16x32_bf16 a[204:207], v[120:123], v[56:59], a[204:207]
    v_mfma_f32_16x16x32_bf16 a[204:207], v[124:127], v[60:63], a[204:207]
    v_mfma_f32_16x16x32_bf16 a[208:211], a[136:139], v[32:35], a[208:211]
    v_mfma_f32_16x16x32_bf16 a[208:211], a[136:139], v[36:39], a[208:211]
    v_exp_f32 v252, v252
    v_mfma_f32_16x16x32_bf16 a[212:215], a[136:139], v[40:43], a[212:215]
    v_exp_f32 v253, v253
    v_mfma_f32_16x16x32_bf16 a[212:215], a[136:139], v[44:47], a[212:215]
    v_cvt_pk_bf16_f32 v94, v252, v253
    v_mfma_f32_16x16x32_bf16 a[216:219], a[136:139], v[48:51], a[216:219]
    v_mfma_f32_16x16x32_bf16 a[216:219], a[136:139], v[52:55], a[216:219]
    v_mfma_f32_16x16x32_bf16 a[220:223], a[136:139], v[56:59], a[220:223]
    v_mfma_f32_16x16x32_bf16 a[220:223], a[136:139], v[60:63], a[220:223]
    s_cmp_eq_u32 s78, 1
    s_cbranch_scc1 K1_LB_MASK
K1_LB_BACK:
    s_waitcnt lgkmcnt(0)
    v_mfma_f32_16x16x32_bf16 v[240:243], a[224:227], v[128:131], v[176:179]
    s_add_u32 m0, s76, s75
    v_exp_f32 v254, v254
    v_mfma_f32_16x16x32_bf16 v[240:243], a[228:231], v[160:163], v[240:243]
    s_mov_b32 s76, s60
    buffer_load_dwordx4 v1, s[36:39], s77 offen sc1 lds
    v_mfma_f32_16x16x32_bf16 v[240:243], a[232:235], v[192:195], v[240:243]
    s_mov_b32 s60, s82
    v_exp_f32 v255, v255
    v_mfma_f32_16x16x32_bf16 v[240:243], a[236:239], v[224:227], v[240:243]
    s_add_u32 s82, s82, 32768
    ds_read_b128 v[104:107], v2 offset:18432
    v_cvt_pk_bf16_f32 v95, v254, v255
    v_mfma_f32_16x16x32_bf16 a[0:3], v[96:99], v[64:67], a[0:3]
    ds_read_b128 v[108:111], v2 offset:19456
    ds_read_b128 a[240:243], v2 offset:4096
    v_mfma_f32_16x16x32_bf16 a[0:3], v[100:103], v[68:71], a[0:3]
    ds_read_b128 a[244:247], v2 offset:5120
    v_mfma_f32_16x16x32_bf16 a[4:7], v[96:99], v[72:75], a[4:7]
    v_exp_f32 v240, v240
    v_mfma_f32_16x16x32_bf16 a[4:7], v[100:103], v[76:79], a[4:7]
    ds_read_b128 a[248:251], v2 offset:6144
    ds_read_b128 a[252:255], v2 offset:7168
    v_mfma_f32_16x16x32_bf16 v[244:247], a[224:227], v[132:135], v[148:151]
    v_exp_f32 v241, v241
    v_mfma_f32_16x16x32_bf16 v[244:247], a[228:231], v[164:167], v[244:247]
    ds_read_b128 v[112:115], v2 offset:20480
    ds_read_b128 v[116:119], v2 offset:21504
    v_mfma_f32_16x16x32_bf16 v[244:247], a[232:235], v[196:199], v[244:247]
    v_exp_f32 v242, v242
    v_mfma_f32_16x16x32_bf16 v[244:247], a[236:239], v[228:231], v[244:247]
    v_exp_f32 v243, v243
    v_mfma_f32_16x16x32_bf16 a[8:11], v[96:99], v[80:83], a[8:11]
    v_cvt_pk_bf16_f32 v32, v240, v241
    v_cvt_pk_bf16_f32 v33, v242, v243
    v_mfma_f32_16x16x32_bf16 a[8:11], v[100:103], v[84:87], a[8:11]
    ds_read_b128 v[120:123], v2 offset:22528
    ds_read_b128 v[124:127], v2 offset:23552
    v_mfma_f32_16x16x32_bf16 a[12:15], v[96:99], v[88:91], a[12:15]
    v_exp_f32 v244, v244
    v_mfma_f32_16x16x32_bf16 a[12:15], v[100:103], v[92:95], a[12:15]
    buffer_load_dwordx4 v1, s[36:39], s77 offen offset:1024 sc1 lds
    v_mfma_f32_16x16x32_bf16 v[248:251], a[224:227], v[136:139], v[152:155]
    v_exp_f32 v245, v245
    v_mfma_f32_16x16x32_bf16 v[248:251], a[228:231], v[168:171], v[248:251]
    v_exp_f32 v246, v246
    v_mfma_f32_16x16x32_bf16 v[248:251], a[232:235], v[200:203], v[248:251]
    v_exp_f32 v247, v247
    v_mfma_f32_16x16x32_bf16 v[248:251], a[236:239], v[232:235], v[248:251]
    s_waitcnt lgkmcnt(0)
    v_cvt_pk_bf16_f32 v40, v244, v245
    v_cvt_pk_bf16_f32 v41, v246, v247
    v_mfma_f32_16x16x32_bf16 a[16:19], v[104:107], v[64:67], a[16:19]
    ds_read_b128 v[96:99], v2 offset:24576
    ds_read_b128 v[100:103], v2 offset:25600
    v_mfma_f32_16x16x32_bf16 a[16:19], v[108:111], v[68:71], a[16:19]
    v_mfma_f32_16x16x32_bf16 a[20:23], v[104:107], v[72:75], a[20:23]
    v_mfma_f32_16x16x32_bf16 a[20:23], v[108:111], v[76:79], a[20:23]
    v_exp_f32 v248, v248
    v_mfma_f32_16x16x32_bf16 v[252:255], a[224:227], v[140:143], v[156:159]
    v_exp_f32 v249, v249
    v_mfma_f32_16x16x32_bf16 v[252:255], a[228:231], v[172:175], v[252:255]
    v_exp_f32 v250, v250
    v_mfma_f32_16x16x32_bf16 v[252:255], a[232:235], v[204:207], v[252:255]
    v_exp_f32 v251, v251
    v_mfma_f32_16x16x32_bf16 v[252:255], a[236:239], v[236:239], v[252:255]
    v_cvt_pk_bf16_f32 v48, v248, v249
    v_cvt_pk_bf16_f32 v49, v250, v251
    v_mfma_f32_16x16x32_bf16 a[24:27], v[104:107], v[80:83], a[24:27]
    ds_read_b128 a[224:227], v2 offset:8192
    ds_read_b128 a[228:231], v2 offset:9216
    v_mfma_f32_16x16x32_bf16 a[24:27], v[108:111], v[84:87], a[24:27]
    buffer_load_dwordx4 v1, s[36:39], s77 offen offset:2048 sc1 lds
    v_mfma_f32_16x16x32_bf16 a[28:31], v[104:107], v[88:91], a[28:31]
    v_exp_f32 v252, v252
    v_mfma_f32_16x16x32_bf16 a[28:31], v[108:111], v[92:95], a[28:31]
    v_exp_f32 v253, v253
    v_mfma_f32_16x16x32_bf16 v[240:243], a[240:243], v[128:131], v[180:183]
    v_exp_f32 v254, v254
    v_mfma_f32_16x16x32_bf16 v[240:243], a[244:247], v[160:163], v[240:243]
    v_exp_f32 v255, v255
    v_mfma_f32_16x16x32_bf16 v[240:243], a[248:251], v[192:195], v[240:243]
    v_cvt_pk_bf16_f32 v56, v252, v253
    v_cvt_pk_bf16_f32 v57, v254, v255
    v_mfma_f32_16x16x32_bf16 v[240:243], a[252:255], v[224:227], v[240:243]
    ds_read_b128 a[232:235], v2 offset:10240
    ds_read_b128 a[236:239], v2 offset:11264
    v_mfma_f32_16x16x32_bf16 a[32:35], v[112:115], v[64:67], a[32:35]
    ds_read_b128 v[104:107], v2 offset:26624
    v_mfma_f32_16x16x32_bf16 a[32:35], v[116:119], v[68:71], a[32:35]
    ds_read_b128 v[108:111], v2 offset:27648
    v_mfma_f32_16x16x32_bf16 a[36:39], v[112:115], v[72:75], a[36:39]
    v_mfma_f32_16x16x32_bf16 a[36:39], v[116:119], v[76:79], a[36:39]
    v_exp_f32 v240, v240
    v_mfma_f32_16x16x32_bf16 v[244:247], a[240:243], v[132:135], v[148:151]
    v_exp_f32 v241, v241
    v_mfma_f32_16x16x32_bf16 v[244:247], a[244:247], v[164:167], v[244:247]
    v_exp_f32 v242, v242
    v_mfma_f32_16x16x32_bf16 v[244:247], a[248:251], v[196:199], v[244:247]
    v_exp_f32 v243, v243
    v_mfma_f32_16x16x32_bf16 v[244:247], a[252:255], v[228:231], v[244:247]
    buffer_load_dwordx4 v1, s[36:39], s77 offen offset:3072 sc1 lds
    v_mfma_f32_16x16x32_bf16 a[40:43], v[112:115], v[80:83], a[40:43]
    v_cvt_pk_bf16_f32 v34, v240, v241
    v_cvt_pk_bf16_f32 v35, v242, v243
    v_mfma_f32_16x16x32_bf16 a[40:43], v[116:119], v[84:87], a[40:43]
    v_mfma_f32_16x16x32_bf16 a[44:47], v[112:115], v[88:91], a[44:47]
    ds_read_b128 v[112:115], v2 offset:28672
    v_mfma_f32_16x16x32_bf16 a[44:47], v[116:119], v[92:95], a[44:47]
    v_exp_f32 v244, v244
    v_mfma_f32_16x16x32_bf16 v[248:251], a[240:243], v[136:139], v[152:155]
    v_exp_f32 v245, v245
    v_mfma_f32_16x16x32_bf16 v[248:251], a[244:247], v[168:171], v[248:251]
    v_exp_f32 v246, v246
    v_mfma_f32_16x16x32_bf16 v[248:251], a[248:251], v[200:203], v[248:251]
    v_exp_f32 v247, v247
    v_mfma_f32_16x16x32_bf16 v[248:251], a[252:255], v[232:235], v[248:251]
    v_cvt_pk_bf16_f32 v42, v244, v245
    v_cvt_pk_bf16_f32 v43, v246, v247
    v_mfma_f32_16x16x32_bf16 a[48:51], v[120:123], v[64:67], a[48:51]
    ds_read_b128 v[116:119], v2 offset:29696
    v_mfma_f32_16x16x32_bf16 a[48:51], v[124:127], v[68:71], a[48:51]
    v_mfma_f32_16x16x32_bf16 a[52:55], v[120:123], v[72:75], a[52:55]
    v_mfma_f32_16x16x32_bf16 a[52:55], v[124:127], v[76:79], a[52:55]
    v_mfma_f32_16x16x32_bf16 v[252:255], a[240:243], v[140:143], v[156:159]
    v_exp_f32 v248, v248
    v_mfma_f32_16x16x32_bf16 v[252:255], a[244:247], v[172:175], v[252:255]
    s_add_u32 s100, s77, 4096
    v_exp_f32 v249, v249
    v_mfma_f32_16x16x32_bf16 v[252:255], a[248:251], v[204:207], v[252:255]
    s_add_u32 m0, m0, 4096
    v_exp_f32 v250, v250
    v_mfma_f32_16x16x32_bf16 v[252:255], a[252:255], v[236:239], v[252:255]
    buffer_load_dwordx4 v1, s[36:39], s100 offen sc1 lds
    v_mfma_f32_16x16x32_bf16 a[56:59], v[120:123], v[80:83], a[56:59]
    v_exp_f32 v251, v251
    v_mfma_f32_16x16x32_bf16 a[56:59], v[124:127], v[84:87], a[56:59]
    v_cvt_pk_bf16_f32 v50, v248, v249
    v_cvt_pk_bf16_f32 v51, v250, v251
    v_mfma_f32_16x16x32_bf16 a[60:63], v[120:123], v[88:91], a[60:63]
    ds_read_b128 a[240:243], v2 offset:12288
    ds_read_b128 a[244:247], v2 offset:13312
    v_mfma_f32_16x16x32_bf16 a[60:63], v[124:127], v[92:95], a[60:63]
    s_waitcnt lgkmcnt(2)
    v_exp_f32 v252, v252
    v_mfma_f32_16x16x32_bf16 v[240:243], a[224:227], v[128:131], v[184:187]
    v_exp_f32 v253, v253
    v_mfma_f32_16x16x32_bf16 v[240:243], a[228:231], v[160:163], v[240:243]
    v_exp_f32 v254, v254
    v_mfma_f32_16x16x32_bf16 v[240:243], a[232:235], v[192:195], v[240:243]
    v_exp_f32 v255, v255
    v_mfma_f32_16x16x32_bf16 v[240:243], a[236:239], v[224:227], v[240:243]
    v_cvt_pk_bf16_f32 v58, v252, v253
    v_cvt_pk_bf16_f32 v59, v254, v255
    v_mfma_f32_16x16x32_bf16 a[144:147], v[96:99], v[64:67], a[144:147]
    ds_read_b128 a[248:251], v2 offset:14336
    ds_read_b128 a[252:255], v2 offset:15360
    v_mfma_f32_16x16x32_bf16 a[144:147], v[100:103], v[68:71], a[144:147]
    ds_read_b128 v[120:123], v2 offset:30720
    v_mfma_f32_16x16x32_bf16 a[148:151], v[96:99], v[72:75], a[148:151]
    v_exp_f32 v240, v240
    v_mfma_f32_16x16x32_bf16 a[148:151], v[100:103], v[76:79], a[148:151]
    v_exp_f32 v241, v241
    v_mfma_f32_16x16x32_bf16 v[244:247], a[224:227], v[132:135], v[148:151]
    buffer_load_dwordx4 v1, s[36:39], s100 offen offset:1024 sc1 lds
    v_mfma_f32_16x16x32_bf16 v[244:247], a[228:231], v[164:167], v[244:247]
    v_exp_f32 v242, v242
    v_mfma_f32_16x16x32_bf16 v[244:247], a[232:235], v[196:199], v[244:247]
    v_exp_f32 v243, v243
    v_mfma_f32_16x16x32_bf16 v[244:247], a[236:239], v[228:231], v[244:247]
    v_cvt_pk_bf16_f32 v36, v240, v241
    v_cvt_pk_bf16_f32 v37, v242, v243
    v_mfma_f32_16x16x32_bf16 a[152:155], v[96:99], v[80:83], a[152:155]
    ds_read_b128 v[124:127], v2 offset:31744
    v_mfma_f32_16x16x32_bf16 a[152:155], v[100:103], v[84:87], a[152:155]
    v_mfma_f32_16x16x32_bf16 a[156:159], v[96:99], v[88:91], a[156:159]
    v_mfma_f32_16x16x32_bf16 a[156:159], v[100:103], v[92:95], a[156:159]
    v_mfma_f32_16x16x32_bf16 v[248:251], a[224:227], v[136:139], v[152:155]
    v_exp_f32 v244, v244
    v_mfma_f32_16x16x32_bf16 v[248:251], a[228:231], v[168:171], v[248:251]
    v_exp_f32 v245, v245
    v_mfma_f32_16x16x32_bf16 v[248:251], a[232:235], v[200:203], v[248:251]
    v_exp_f32 v246, v246
    v_mfma_f32_16x16x32_bf16 v[248:251], a[236:239], v[232:235], v[248:251]
    v_exp_f32 v247, v247
    v_mfma_f32_16x16x32_bf16 a[160:163], v[104:107], v[64:67], a[160:163]
    v_cvt_pk_bf16_f32 v44, v244, v245
    v_cvt_pk_bf16_f32 v45, v246, v247
    v_mfma_f32_16x16x32_bf16 a[160:163], v[108:111], v[68:71], a[160:163]
    v_mfma_f32_16x16x32_bf16 a[164:167], v[104:107], v[72:75], a[164:167]
    buffer_load_dwordx4 v1, s[36:39], s100 offen offset:2048 sc1 lds
    v_mfma_f32_16x16x32_bf16 a[164:167], v[108:111], v[76:79], a[164:167]
    v_exp_f32 v248, v248
    v_mfma_f32_16x16x32_bf16 v[252:255], a[224:227], v[140:143], v[156:159]
    v_exp_f32 v249, v249
    v_mfma_f32_16x16x32_bf16 v[252:255], a[228:231], v[172:175], v[252:255]
    v_exp_f32 v250, v250
    v_mfma_f32_16x16x32_bf16 v[252:255], a[232:235], v[204:207], v[252:255]
    v_exp_f32 v251, v251
    v_mfma_f32_16x16x32_bf16 v[252:255], a[236:239], v[236:239], v[252:255]
    v_cvt_pk_bf16_f32 v52, v248, v249
    v_cvt_pk_bf16_f32 v53, v250, v251
    v_mfma_f32_16x16x32_bf16 a[168:171], v[104:107], v[80:83], a[168:171]
    v_mfma_f32_16x16x32_bf16 a[168:171], v[108:111], v[84:87], a[168:171]
    v_mfma_f32_16x16x32_bf16 a[172:175], v[104:107], v[88:91], a[172:175]
    v_mfma_f32_16x16x32_bf16 a[172:175], v[108:111], v[92:95], a[172:175]
    s_waitcnt lgkmcnt(0)
    v_mfma_f32_16x16x32_bf16 v[240:243], a[240:243], v[128:131], v[188:191]
    v_mfma_f32_16x16x32_bf16 v[240:243], a[244:247], v[160:163], v[240:243]
    v_exp_f32 v252, v252
    v_mfma_f32_16x16x32_bf16 v[240:243], a[248:251], v[192:195], v[240:243]
    v_exp_f32 v253, v253
    v_mfma_f32_16x16x32_bf16 v[240:243], a[252:255], v[224:227], v[240:243]
    v_exp_f32 v254, v254
    v_mfma_f32_16x16x32_bf16 a[176:179], v[112:115], v[64:67], a[176:179]
    buffer_load_dwordx4 v1, s[36:39], s100 offen offset:3072 sc1 lds
    v_mfma_f32_16x16x32_bf16 a[176:179], v[116:119], v[68:71], a[176:179]
    v_exp_f32 v255, v255
    v_mfma_f32_16x16x32_bf16 a[180:183], v[112:115], v[72:75], a[180:183]
    v_cvt_pk_bf16_f32 v60, v252, v253
    v_cvt_pk_bf16_f32 v61, v254, v255
    v_mfma_f32_16x16x32_bf16 a[180:183], v[116:119], v[76:79], a[180:183]
    s_cmp_eq_u32 s82, 163840
    s_cselect_b32 s82, 0, s82
    v_add_u32 v2, s82, v1
    v_mfma_f32_16x16x32_bf16 v[244:247], a[240:243], v[132:135], v[148:151]
    v_exp_f32 v240, v240
    v_mfma_f32_16x16x32_bf16 v[244:247], a[244:247], v[164:167], v[244:247]
    v_exp_f32 v241, v241
    v_mfma_f32_16x16x32_bf16 v[244:247], a[248:251], v[196:199], v[244:247]
    v_exp_f32 v242, v242
    v_mfma_f32_16x16x32_bf16 v[244:247], a[252:255], v[228:231], v[244:247]
    v_exp_f32 v243, v243
    v_mfma_f32_16x16x32_bf16 a[184:187], v[112:115], v[80:83], a[184:187]
    v_cvt_pk_bf16_f32 v38, v240, v241
    v_cvt_pk_bf16_f32 v39, v242, v243
    v_mfma_f32_16x16x32_bf16 a[184:187], v[116:119], v[84:87], a[184:187]
    v_mfma_f32_16x16x32_bf16 a[188:191], v[112:115], v[88:91], a[188:191]
    v_mfma_f32_16x16x32_bf16 a[188:191], v[116:119], v[92:95], a[188:191]
    v_mfma_f32_16x16x32_bf16 v[248:251], a[240:243], v[136:139], v[152:155]
    v_exp_f32 v244, v244
    v_mfma_f32_16x16x32_bf16 v[248:251], a[244:247], v[168:171], v[248:251]
    v_exp_f32 v245, v245
    v_mfma_f32_16x16x32_bf16 v[248:251], a[248:251], v[200:203], v[248:251]
    s_add_u32 s77, s77, 32768
    v_exp_f32 v246, v246
    v_mfma_f32_16x16x32_bf16 v[248:251], a[252:255], v[232:235], v[248:251]
    v_exp_f32 v247, v247
    v_mfma_f32_16x16x32_bf16 a[192:195], v[120:123], v[64:67], a[192:195]
    v_cvt_pk_bf16_f32 v46, v244, v245
    v_cvt_pk_bf16_f32 v47, v246, v247
    v_mfma_f32_16x16x32_bf16 a[192:195], v[124:127], v[68:71], a[192:195]
    v_mfma_f32_16x16x32_bf16 a[196:199], v[120:123], v[72:75], a[196:199]
    v_mfma_f32_16x16x32_bf16 a[196:199], v[124:127], v[76:79], a[196:199]
    v_mfma_f32_16x16x32_bf16 v[252:255], a[240:243], v[140:143], v[156:159]
    v_exp_f32 v248, v248
    v_mfma_f32_16x16x32_bf16 v[252:255], a[244:247], v[172:175], v[252:255]
    v_exp_f32 v249, v249
    v_mfma_f32_16x16x32_bf16 v[252:255], a[248:251], v[204:207], v[252:255]
    v_exp_f32 v250, v250
    v_mfma_f32_16x16x32_bf16 v[252:255], a[252:255], v[236:239], v[252:255]
    s_waitcnt vmcnt(8) lgkmcnt(0)
    s_barrier
    ds_read_b128 a[224:227], v2 offset:0
    v_mfma_f32_16x16x32_bf16 a[200:203], v[120:123], v[80:83], a[200:203]
    ds_read_b128 a[228:231], v2 offset:1024
    ds_read_b128 a[232:235], v2 offset:2048
    v_mfma_f32_16x16x32_bf16 a[200:203], v[124:127], v[84:87], a[200:203]
    ds_read_b128 a[236:239], v2 offset:3072
    v_cvt_pk_bf16_f32 v54, v248, v249
    v_mfma_f32_16x16x32_bf16 a[204:207], v[120:123], v[88:91], a[204:207]
    v_exp_f32 v251, v251
    v_mfma_f32_16x16x32_bf16 a[204:207], v[124:127], v[92:95], a[204:207]
    ds_read_b128 v[96:99], v2 offset:16384
    ds_read_b128 v[100:103], v2 offset:17408
    v_mfma_f32_16x16x32_bf16 a[208:211], a[136:139], v[64:67], a[208:211]
    v_exp_f32 v252, v252
    v_mfma_f32_16x16x32_bf16 a[208:211], a[136:139], v[68:71], a[208:211]
    v_exp_f32 v253, v253
    v_mfma_f32_16x16x32_bf16 a[212:215], a[136:139], v[72:75], a[212:215]
    v_cvt_pk_bf16_f32 v55, v250, v251
    v_cvt_pk_bf16_f32 v62, v252, v253
    v_mfma_f32_16x16x32_bf16 a[212:215], a[136:139], v[76:79], a[212:215]
    v_mfma_f32_16x16x32_bf16 a[216:219], a[136:139], v[80:83], a[216:219]
    v_mfma_f32_16x16x32_bf16 a[216:219], a[136:139], v[84:87], a[216:219]
    v_mfma_f32_16x16x32_bf16 a[220:223], a[136:139], v[88:91], a[220:223]
    v_mfma_f32_16x16x32_bf16 a[220:223], a[136:139], v[92:95], a[220:223]
    s_sub_u32 s78, s78, 1
    s_cmp_lg_u32 s78, 0
    s_cbranch_scc1 K1_LB
K1_LB_END:
    v_add_f32 v212, s12, v148
    v_fma_f32 v176, v208, s8, v212
    v_fma_f32 v177, v209, s8, v212
    v_fma_f32 v178, v210, s8, v212
    v_fma_f32 v179, v211, s8, v212
    s_nop 1
    s_waitcnt lgkmcnt(0)
    v_mfma_f32_16x16x32_bf16 v[240:243], a[224:227], v[132:135], v[176:179]
    s_add_u32 m0, s76, s75
    ds_read_b128 v[104:107], v2 offset:18432
    ds_read_b128 v[108:111], v2 offset:19456
    v_mfma_f32_16x16x32_bf16 v[240:243], a[228:231], v[164:167], v[240:243]
    s_mov_b32 s76, s60
    buffer_load_dwordx4 v1, s[36:39], s77 offen sc1 lds
    v_mfma_f32_16x16x32_bf16 v[240:243], a[232:235], v[196:199], v[240:243]
    s_mov_b32 s60, s82
    v_exp_f32 v254, v254
    v_mfma_f32_16x16x32_bf16 v[240:243], a[236:239], v[228:231], v[240:243]
    s_add_u32 s82, s82, 32768
    v_exp_f32 v255, v255
    v_mfma_f32_16x16x32_bf16 a[0:3], v[96:99], v[32:35], a[0:3]
    s_mov_b32 s98, 0x3fb8aa3b
    v_cvt_pk_bf16_f32 v63, v254, v255
    ds_read_b128 a[240:243], v2 offset:4096
    v_mfma_f32_16x16x32_bf16 a[0:3], v[100:103], v[36:39], a[0:3]
    ds_read_b128 a[244:247], v2 offset:5120
    ds_read_b128 a[248:251], v2 offset:6144
    v_mfma_f32_16x16x32_bf16 a[4:7], v[96:99], v[40:43], a[4:7]
    ds_read_b128 a[252:255], v2 offset:7168
    v_add_f32 v213, s13, v148
    v_mfma_f32_16x16x32_bf16 a[4:7], v[100:103], v[44:47], a[4:7]
    ds_read_b128 v[112:115], v2 offset:20480
    v_fma_f32 v180, v208, s9, v213
    v_mfma_f32_16x16x32_bf16 v[244:247], a[224:227], v[136:139], v[152:155]
    ds_read_b128 v[116:119], v2 offset:21504
    v_fma_f32 v181, v209, s9, v213
    v_mfma_f32_16x16x32_bf16 v[244:247], a[228:231], v[168:171], v[244:247]
    v_fma_f32 v182, v210, s9, v213
    v_fma_f32 v183, v211, s9, v213
    v_mfma_f32_16x16x32_bf16 v[244:247], a[232:235], v[200:203], v[244:247]
    v_exp_f32 v240, v240
    v_mfma_f32_16x16x32_bf16 v[244:247], a[236:239], v[232:235], v[244:247]
    v_exp_f32 v241, v241
    v_mfma_f32_16x16x32_bf16 a[8:11], v[96:99], v[48:51], a[8:11]
    v_exp_f32 v242, v242
    v_mfma_f32_16x16x32_bf16 a[8:11], v[100:103], v[52:55], a[8:11]
    buffer_load_dwordx4 v1, s[36:39], s77 offen offset:1024 sc1 lds
    v_mfma_f32_16x16x32_bf16 a[12:15], v[96:99], v[56:59], a[12:15]
    v_exp_f32 v243, v243
    v_mfma_f32_16x16x32_bf16 a[12:15], v[100:103], v[60:63], a[12:15]
    s_waitcnt lgkmcnt(0)
    v_cvt_pk_bf16_f32 v72, v240, v241
    v_cvt_pk_bf16_f32 v73, v242, v243
    v_mfma_f32_16x16x32_bf16 a[16:19], v[104:107], v[32:35], a[16:19]
    ds_read_b128 v[120:123], v2 offset:22528
    ds_read_b128 v[124:127], v2 offset:23552
    v_mfma_f32_16x16x32_bf16 a[16:19], v[108:111], v[36:39], a[16:19]
    v_exp_f32 v244, v244
    v_mfma_f32_16x16x32_bf16 v[248:251], a[224:227], v[140:143], v[156:159]
    v_exp_f32 v245, v245
    v_mfma_f32_16x16x32_bf16 v[248:251], a[228:231], v[172:175], v[248:251]
    v_exp_f32 v246, v246
    v_mfma_f32_16x16x32_bf16 v[248:251], a[232:235], v[204:207], v[248:251]
    v_exp_f32 v247, v247
    v_mfma_f32_16x16x32_bf16 v[248:251], a[236:239], v[236:239], v[248:251]
    v_cvt_pk_bf16_f32 v80, v244, v245
    v_cvt_pk_bf16_f32 v81, v246, v247
    v_mfma_f32_16x16x32_bf16 a[20:23], v[104:107], v[40:43], a[20:23]
    ds_read_b128 a[224:227], v2 offset:8192
    ds_read_b128 a[228:231], v2 offset:9216
    v_mfma_f32_16x16x32_bf16 a[20:23], v[108:111], v[44:47], a[20:23]
    ds_read_b128 a[232:235], v2 offset:10240
    v_add_f32 v214, s14, v148
    v_mfma_f32_16x16x32_bf16 a[24:27], v[104:107], v[48:51], a[24:27]
    ds_read_b128 a[236:239], v2 offset:11264
    v_fma_f32 v184, v208, s10, v214
    v_mfma_f32_16x16x32_bf16 a[24:27], v[108:111], v[52:55], a[24:27]
    buffer_load_dwordx4 v1, s[36:39], s77 offen offset:2048 sc1 lds
    v_mfma_f32_16x16x32_bf16 a[28:31], v[104:107], v[56:59], a[28:31]
    ds_read_b128 v[96:99], v2 offset:24576
    ds_read_b128 v[100:103], v2 offset:25600
    v_mfma_f32_16x16x32_bf16 a[28:31], v[108:111], v[60:63], a[28:31]
    v_exp_f32 v248, v248
    v_mfma_f32_16x16x32_bf16 v[252:255], a[240:243], v[132:135], v[180:183]
    v_exp_f32 v249, v249
    v_mfma_f32_16x16x32_bf16 v[252:255], a[244:247], v[164:167], v[252:255]
    v_exp_f32 v250, v250
    v_mfma_f32_16x16x32_bf16 v[252:255], a[248:251], v[196:199], v[252:255]
    v_exp_f32 v251, v251
    v_mfma_f32_16x16x32_bf16 v[252:255], a[252:255], v[228:231], v[252:255]
    v_fma_f32 v185, v209, s10, v214
    v_fma_f32 v186, v210, s10, v214
    v_mfma_f32_16x16x32_bf16 a[32:35], v[112:115], v[32:35], a[32:35]
    v_fma_f32 v187, v211, s10, v214
    v_cvt_pk_bf16_f32 v88, v248, v249
    v_mfma_f32_16x16x32_bf16 a[32:35], v[116:119], v[36:39], a[32:35]
    v_cvt_pk_bf16_f32 v89, v250, v251
    ds_read_b128 v[104:107], v2 offset:26624
    v_mfma_f32_16x16x32_bf16 a[36:39], v[112:115], v[40:43], a[36:39]
    v_exp_f32 v252, v252
    v_mfma_f32_16x16x32_bf16 a[36:39], v[116:119], v[44:47], a[36:39]
    v_exp_f32 v253, v253
    v_mfma_f32_16x16x32_bf16 v[240:243], a[240:243], v[136:139], v[152:155]
    v_exp_f32 v254, v254
    v_mfma_f32_16x16x32_bf16 v[240:243], a[244:247], v[168:171], v[240:243]
    buffer_load_dwordx4 v1, s[36:39], s77 offen offset:3072 sc1 lds
    v_mfma_f32_16x16x32_bf16 v[240:243], a[248:251], v[200:203], v[240:243]
    v_exp_f32 v255, v255
    v_mfma_f32_16x16x32_bf16 v[240:243], a[252:255], v[232:235], v[240:243]
    v_cvt_pk_bf16_f32 v74, v252, v253
    v_cvt_pk_bf16_f32 v75, v254, v255
    v_mfma_f32_16x16x32_bf16 a[40:43], v[112:115], v[48:51], a[40:43]
    ds_read_b128 v[108:111], v2 offset:27648
    v_add_f32 v215, s15, v148
    v_mfma_f32_16x16x32_bf16 a[40:43], v[116:119], v[52:55], a[40:43]
    v_fma_f32 v188, v208, s11, v215
    v_fma_f32 v189, v209, s11, v215
    v_mfma_f32_16x16x32_bf16 a[44:47], v[112:115], v[56:59], a[44:47]
    v_exp_f32 v240, v240
    v_mfma_f32_16x16x32_bf16 a[44:47], v[116:119], v[60:63], a[44:47]
    s_waitcnt lgkmcnt(1)
    v_exp_f32 v241, v241
    v_mfma_f32_16x16x32_bf16 a[48:51], v[120:123], v[32:35], a[48:51]
    v_exp_f32 v242, v242
    v_mfma_f32_16x16x32_bf16 a[48:51], v[124:127], v[36:39], a[48:51]
    v_exp_f32 v243, v243
    v_mfma_f32_16x16x32_bf16 v[244:247], a[240:243], v[140:143], v[156:159]
    v_cvt_pk_bf16_f32 v82, v240, v241
    v_cvt_pk_bf16_f32 v83, v242, v243
    v_mfma_f32_16x16x32_bf16 v[244:247], a[244:247], v[172:175], v[244:247]
    ds_read_b128 a[240:243], v2 offset:12288
    ds_read_b128 a[244:247], v2 offset:13312
    v_mfma_f32_16x16x32_bf16 v[244:247], a[248:251], v[204:207], v[244:247]
    ds_read_b128 a[248:251], v2 offset:14336
    v_fma_f32 v190, v210, s11, v215
    v_mfma_f32_16x16x32_bf16 v[244:247], a[252:255], v[236:239], v[244:247]
    s_add_u32 s100, s77, 4096
    ds_read_b128 a[252:255], v2 offset:15360
    v_fma_f32 v191, v211, s11, v215
    v_mfma_f32_16x16x32_bf16 a[52:55], v[120:123], v[40:43], a[52:55]
    s_add_u32 m0, m0, 4096
    ds_read_b128 v[112:115], v2 offset:28672
    v_bfe_u32 v8, v1, 2, 6
    v_mfma_f32_16x16x32_bf16 a[52:55], v[124:127], v[44:47], a[52:55]
    buffer_load_dwordx4 v1, s[36:39], s100 offen sc1 lds
    v_mfma_f32_16x16x32_bf16 a[56:59], v[120:123], v[48:51], a[56:59]
    ds_read_b128 v[116:119], v2 offset:29696
    v_accvgpr_read_b32 v4, a112
    v_mfma_f32_16x16x32_bf16 a[56:59], v[124:127], v[52:55], a[56:59]
    v_exp_f32 v244, v244
    v_mfma_f32_16x16x32_bf16 a[60:63], v[120:123], v[56:59], a[60:63]
    v_exp_f32 v245, v245
    v_mfma_f32_16x16x32_bf16 a[60:63], v[124:127], v[60:63], a[60:63]
    v_exp_f32 v246, v246
    v_mfma_f32_16x16x32_bf16 v[248:251], a[224:227], v[132:135], v[184:187]
    v_exp_f32 v247, v247
    v_mfma_f32_16x16x32_bf16 v[248:251], a[228:231], v[164:167], v[248:251]
    v_cvt_pk_bf16_f32 v90, v244, v245
    v_cvt_pk_bf16_f32 v91, v246, v247
    v_mfma_f32_16x16x32_bf16 v[248:251], a[232:235], v[196:199], v[248:251]
    ds_read_b128 v[120:123], v2 offset:30720
    ds_read_b128 v[124:127], v2 offset:31744
    v_mfma_f32_16x16x32_bf16 v[248:251], a[236:239], v[228:231], v[248:251]
    v_accvgpr_read_b32 v5, a116
    v_accvgpr_read_b32 v6, a120
    v_mfma_f32_16x16x32_bf16 a[144:147], v[96:99], v[32:35], a[144:147]
    v_add_u32 v8, 192, v8
    v_cvt_pk_bf16_f32 v4, 0, v4
    v_mfma_f32_16x16x32_bf16 a[144:147], v[100:103], v[36:39], a[144:147]
    v_cvt_pk_bf16_f32 v5, 0, v5
    v_cvt_pk_bf16_f32 v6, 0, v6
    v_mfma_f32_16x16x32_bf16 a[148:151], v[96:99], v[40:43], a[148:151]
    buffer_load_dwordx4 v1, s[36:39], s100 offen offset:1024 sc1 lds
    v_mfma_f32_16x16x32_bf16 a[148:151], v[100:103], v[44:47], a[148:151]
    v_exp_f32 v248, v248
    v_mfma_f32_16x16x32_bf16 v[252:255], a[224:227], v[136:139], v[152:155]
    v_exp_f32 v249, v249
    v_mfma_f32_16x16x32_bf16 v[252:255], a[228:231], v[168:171], v[252:255]
    v_exp_f32 v250, v250
    v_mfma_f32_16x16x32_bf16 v[252:255], a[232:235], v[200:203], v[252:255]
    v_exp_f32 v251, v251
    v_mfma_f32_16x16x32_bf16 v[252:255], a[236:239], v[232:235], v[252:255]
    v_cvt_pk_bf16_f32 v76, v248, v249
    v_cvt_pk_bf16_f32 v77, v250, v251
    v_mfma_f32_16x16x32_bf16 a[152:155], v[96:99], v[48:51], a[152:155]
    ds_bpermute_b32 v4, v8, v4
    ds_bpermute_b32 v5, v8, v5
    v_mfma_f32_16x16x32_bf16 a[152:155], v[100:103], v[52:55], a[152:155]
    s_waitcnt lgkmcnt(1)
    ds_bpermute_b32 v6, v8, v6
    v_mul_f32 v4, s98, v4
    v_mfma_f32_16x16x32_bf16 a[156:159], v[96:99], v[56:59], a[156:159]
    v_exp_f32 v252, v252
    v_mfma_f32_16x16x32_bf16 a[156:159], v[100:103], v[60:63], a[156:159]
    v_exp_f32 v253, v253
    v_mfma_f32_16x16x32_bf16 a[160:163], v[104:107], v[32:35], a[160:163]
    v_exp_f32 v254, v254
    v_mfma_f32_16x16x32_bf16 a[160:163], v[108:111], v[36:39], a[160:163]
    v_exp_f32 v255, v255
    v_mfma_f32_16x16x32_bf16 v[240:243], a[224:227], v[140:143], v[156:159]
    buffer_load_dwordx4 v1, s[36:39], s100 offen offset:2048 sc1 lds
    v_mfma_f32_16x16x32_bf16 v[240:243], a[228:231], v[172:175], v[240:243]
    v_cvt_pk_bf16_f32 v84, v252, v253
    v_cvt_pk_bf16_f32 v85, v254, v255
    v_mfma_f32_16x16x32_bf16 v[240:243], a[232:235], v[204:207], v[240:243]
    s_cmp_eq_u32 s82, 163840
    s_cselect_b32 s82, 0, s82
    v_add_u32 v2, s82, v1
    v_mfma_f32_16x16x32_bf16 v[240:243], a[236:239], v[236:239], v[240:243]
    ds_read_b128 a[224:227], v2 offset:0
    ds_read_b128 a[228:231], v2 offset:1024
    v_mfma_f32_16x16x32_bf16 a[164:167], v[104:107], v[40:43], a[164:167]
    s_waitcnt lgkmcnt(2)
    ds_read_b128 a[232:235], v2 offset:2048
    v_mul_f32 v5, s98, v5
    v_mfma_f32_16x16x32_bf16 a[164:167], v[108:111], v[44:47], a[164:167]
    ds_read_b128 a[236:239], v2 offset:3072
    v_mul_f32 v6, s98, v6
    v_mfma_f32_16x16x32_bf16 a[168:171], v[104:107], v[48:51], a[168:171]
    v_exp_f32 v240, v240
    v_mfma_f32_16x16x32_bf16 a[168:171], v[108:111], v[52:55], a[168:171]
    ds_read_b128 v[96:99], v2 offset:16384
    ds_read_b128 v[100:103], v2 offset:17408
    v_mfma_f32_16x16x32_bf16 a[172:175], v[104:107], v[56:59], a[172:175]
    v_exp_f32 v241, v241
    v_mfma_f32_16x16x32_bf16 a[172:175], v[108:111], v[60:63], a[172:175]
    v_exp_f32 v242, v242
    v_mfma_f32_16x16x32_bf16 v[244:247], a[240:243], v[132:135], v[188:191]
    v_exp_f32 v243, v243
    v_mfma_f32_16x16x32_bf16 v[244:247], a[244:247], v[164:167], v[244:247]
    v_cvt_pk_bf16_f32 v92, v240, v241
    v_cvt_pk_bf16_f32 v93, v242, v243
    v_mfma_f32_16x16x32_bf16 v[244:247], a[248:251], v[196:199], v[244:247]
    buffer_load_dwordx4 v1, s[36:39], s100 offen offset:3072 sc1 lds
    v_mfma_f32_16x16x32_bf16 v[244:247], a[252:255], v[228:231], v[244:247]
    v_exp_f32 v4, v4
    v_mfma_f32_16x16x32_bf16 a[176:179], v[112:115], v[32:35], a[176:179]
    v_exp_f32 v5, v5
    v_mfma_f32_16x16x32_bf16 a[176:179], v[116:119], v[36:39], a[176:179]
    v_exp_f32 v6, v6
    v_mfma_f32_16x16x32_bf16 a[180:183], v[112:115], v[40:43], a[180:183]
    v_add_f32 v4, 1.0, v4
    v_add_f32 v5, 1.0, v5
    v_mfma_f32_16x16x32_bf16 a[180:183], v[116:119], v[44:47], a[180:183]
    v_exp_f32 v244, v244
    v_mfma_f32_16x16x32_bf16 v[248:251], a[240:243], v[136:139], v[152:155]
    v_exp_f32 v245, v245
    v_mfma_f32_16x16x32_bf16 v[248:251], a[244:247], v[168:171], v[248:251]
    v_exp_f32 v246, v246
    v_mfma_f32_16x16x32_bf16 v[248:251], a[248:251], v[200:203], v[248:251]
    v_exp_f32 v247, v247
    v_mfma_f32_16x16x32_bf16 v[248:251], a[252:255], v[232:235], v[248:251]
    v_cvt_pk_bf16_f32 v78, v244, v245
    v_cvt_pk_bf16_f32 v79, v246, v247
    v_mfma_f32_16x16x32_bf16 a[184:187], v[112:115], v[48:51], a[184:187]
    v_rcp_f32 v4, v4
    v_mfma_f32_16x16x32_bf16 a[184:187], v[116:119], v[52:55], a[184:187]
    v_rcp_f32 v5, v5
    v_mfma_f32_16x16x32_bf16 a[188:191], v[112:115], v[56:59], a[188:191]
    s_add_u32 s77, s77, 32768
    v_exp_f32 v248, v248
    v_mfma_f32_16x16x32_bf16 a[188:191], v[116:119], v[60:63], a[188:191]
    v_exp_f32 v249, v249
    v_mfma_f32_16x16x32_bf16 a[192:195], v[120:123], v[32:35], a[192:195]
    v_exp_f32 v250, v250
    v_mfma_f32_16x16x32_bf16 a[192:195], v[124:127], v[36:39], a[192:195]
    v_exp_f32 v251, v251
    v_mfma_f32_16x16x32_bf16 v[252:255], a[240:243], v[140:143], v[156:159]
    v_cvt_pk_bf16_f32 v86, v248, v249
    v_cvt_pk_bf16_f32 v87, v250, v251
    v_mfma_f32_16x16x32_bf16 v[252:255], a[244:247], v[172:175], v[252:255]
    v_add_f32 v6, 1.0, v6
    v_mfma_f32_16x16x32_bf16 v[252:255], a[248:251], v[204:207], v[252:255]
    v_rcp_f32 v6, v6
    v_mfma_f32_16x16x32_bf16 v[252:255], a[252:255], v[236:239], v[252:255]
    v_mfma_f32_16x16x32_bf16 a[196:199], v[120:123], v[40:43], a[196:199]
    v_mfma_f32_16x16x32_bf16 a[196:199], v[124:127], v[44:47], a[196:199]
    v_mfma_f32_16x16x32_bf16 a[200:203], v[120:123], v[48:51], a[200:203]
    v_mfma_f32_16x16x32_bf16 a[200:203], v[124:127], v[52:55], a[200:203]
    v_mfma_f32_16x16x32_bf16 a[204:207], v[120:123], v[56:59], a[204:207]
    v_mfma_f32_16x16x32_bf16 a[204:207], v[124:127], v[60:63], a[204:207]
    v_mfma_f32_16x16x32_bf16 a[208:211], a[136:139], v[32:35], a[208:211]
    v_mfma_f32_16x16x32_bf16 a[208:211], a[136:139], v[36:39], a[208:211]
    v_exp_f32 v252, v252
    v_mfma_f32_16x16x32_bf16 a[212:215], a[136:139], v[40:43], a[212:215]
    v_exp_f32 v253, v253
    v_mfma_f32_16x16x32_bf16 a[212:215], a[136:139], v[44:47], a[212:215]
    v_cvt_pk_bf16_f32 v94, v252, v253
    v_mfma_f32_16x16x32_bf16 a[216:219], a[136:139], v[48:51], a[216:219]
    v_mfma_f32_16x16x32_bf16 a[216:219], a[136:139], v[52:55], a[216:219]
    v_mfma_f32_16x16x32_bf16 a[220:223], a[136:139], v[56:59], a[220:223]
    v_mfma_f32_16x16x32_bf16 a[220:223], a[136:139], v[60:63], a[220:223]
    s_cmp_eq_u32 s6, 7
    s_cselect_b32 s16, s8, 0
    s_cselect_b32 s17, s9, 0
    s_cselect_b32 s18, s10, 0
    s_cselect_b32 s19, s11, 0
    s_cselect_b32 s20, s12, 0
    s_cselect_b32 s21, s13, 0
    s_cselect_b32 s22, s14, 0
    s_cselect_b32 s23, s15, 0
    v_add_f32 v212, s20, v152
    v_fma_f32 v176, v208, s16, v212
    v_fma_f32 v177, v209, s16, v212
    v_fma_f32 v178, v210, s16, v212
    v_fma_f32 v179, v211, s16, v212
    s_nop 1
    s_waitcnt lgkmcnt(0)
    v_mfma_f32_16x16x32_bf16 v[240:243], a[224:227], v[136:139], v[176:179]
    s_add_u32 m0, s76, s75
    v_exp_f32 v254, v254
    v_mfma_f32_16x16x32_bf16 v[240:243], a[228:231], v[168:171], v[240:243]
    s_mov_b32 s76, s60
    buffer_load_dwordx4 v1, s[36:39], s77 offen sc1 lds
    v_mfma_f32_16x16x32_bf16 v[240:243], a[232:235], v[200:203], v[240:243]
    s_mov_b32 s60, s82
    v_exp_f32 v255, v255
    v_mfma_f32_16x16x32_bf16 v[240:243], a[236:239], v[232:235], v[240:243]
    s_add_u32 s82, s82, 32768
    ds_read_b128 v[104:107], v2 offset:18432
    v_cvt_pk_bf16_f32 v95, v254, v255
    v_mfma_f32_16x16x32_bf16 a[4:7], v[96:99], v[72:75], a[4:7]
    ds_read_b128 v[108:111], v2 offset:19456
    ds_read_b128 a[240:243], v2 offset:4096
    v_mfma_f32_16x16x32_bf16 a[4:7], v[100:103], v[76:79], a[4:7]
    ds_read_b128 a[244:247], v2 offset:5120
    v_add_f32 v213, s21, v152
    v_mfma_f32_16x16x32_bf16 a[8:11], v[96:99], v[80:83], a[8:11]
    ds_read_b128 a[248:251], v2 offset:6144
    v_fma_f32 v180, v208, s17, v213
    v_mfma_f32_16x16x32_bf16 a[8:11], v[100:103], v[84:87], a[8:11]
    ds_read_b128 a[252:255], v2 offset:7168
    v_fma_f32 v181, v209, s17, v213
    v_mfma_f32_16x16x32_bf16 a[12:15], v[96:99], v[88:91], a[12:15]
    ds_read_b128 v[112:115], v2 offset:20480
    v_fma_f32 v182, v210, s17, v213
    v_mfma_f32_16x16x32_bf16 a[12:15], v[100:103], v[92:95], a[12:15]
    buffer_load_dwordx4 v1, s[36:39], s77 offen offset:1024 sc1 lds
    v_mfma_f32_16x16x32_bf16 v[244:247], a[224:227], v[140:143], v[156:159]
    ds_read_b128 v[116:119], v2 offset:21504
    v_fma_f32 v183, v211, s17, v213
    v_mfma_f32_16x16x32_bf16 v[244:247], a[228:231], v[172:175], v[244:247]
    ds_read_b128 v[120:123], v2 offset:22528
    ds_read_b128 v[124:127], v2 offset:23552
    v_mfma_f32_16x16x32_bf16 v[244:247], a[232:235], v[204:207], v[244:247]
    ds_read_b128 a[224:227], v2 offset:8192
    v_add_f32 v214, s22, v152
    v_mfma_f32_16x16x32_bf16 v[244:247], a[236:239], v[236:239], v[244:247]
    s_waitcnt lgkmcnt(4)
    ds_read_b128 a[228:231], v2 offset:9216
    v_fma_f32 v184, v208, s18, v214
    v_mfma_f32_16x16x32_bf16 a[20:23], v[104:107], v[72:75], a[20:23]
    ds_read_b128 a[232:235], v2 offset:10240
    v_fma_f32 v185, v209, s18, v214
    v_mfma_f32_16x16x32_bf16 a[20:23], v[108:111], v[76:79], a[20:23]
    ds_read_b128 a[236:239], v2 offset:11264
    v_fma_f32 v186, v210, s18, v214
    v_mfma_f32_16x16x32_bf16 a[24:27], v[104:107], v[80:83], a[24:27]
    ds_read_b128 v[96:99], v2 offset:24576
    v_fma_f32 v187, v211, s18, v214
    v_mfma_f32_16x16x32_bf16 a[24:27], v[108:111], v[84:87], a[24:27]
    buffer_load_dwordx4 v1, s[36:39], s77 offen offset:2048 sc1 lds
    v_mfma_f32_16x16x32_bf16 a[28:31], v[104:107], v[88:91], a[28:31]
    ds_read_b128 v[100:103], v2 offset:25600
    ds_read_b128 v[104:107], v2 offset:26624
    v_mfma_f32_16x16x32_bf16 a[28:31], v[108:111], v[92:95], a[28:31]
    v_exp_f32 v240, v240
    v_mfma_f32_16x16x32_bf16 v[248:251], a[240:243], v[136:139], v[180:183]
    v_exp_f32 v241, v241
    v_mfma_f32_16x16x32_bf16 v[248:251], a[244:247], v[168:171], v[248:251]
    v_exp_f32 v242, v242
    v_mfma_f32_16x16x32_bf16 v[248:251], a[248:251], v[200:203], v[248:251]
    v_exp_f32 v243, v243
    v_mfma_f32_16x16x32_bf16 v[248:251], a[252:255], v[232:235], v[248:251]
    v_cvt_pk_bf16_f32 v48, v240, v241
    v_cvt_pk_bf16_f32 v49, v242, v243
    v_mfma_f32_16x16x32_bf16 a[36:39], v[112:115], v[72:75], a[36:39]
    s_waitcnt lgkmcnt(0)
    ds_read_b128 v[108:111], v2 offset:27648
    v_add_f32 v215, s23, v152
    v_mfma_f32_16x16x32_bf16 a[36:39], v[116:119], v[76:79], a[36:39]
    buffer_load_dwordx4 v1, s[36:39], s77 offen offset:3072 sc1 lds
    v_mfma_f32_16x16x32_bf16 a[40:43], v[112:115], v[80:83], a[40:43]
    v_exp_f32 v244, v244
    v_mfma_f32_16x16x32_bf16 a[40:43], v[116:119], v[84:87], a[40:43]
    v_exp_f32 v245, v245
    v_mfma_f32_16x16x32_bf16 a[44:47], v[112:115], v[88:91], a[44:47]
    v_exp_f32 v246, v246
    v_mfma_f32_16x16x32_bf16 a[44:47], v[116:119], v[92:95], a[44:47]
    v_exp_f32 v247, v247
    v_mfma_f32_16x16x32_bf16 v[252:255], a[240:243], v[140:143], v[156:159]
    v_cvt_pk_bf16_f32 v56, v244, v245
    v_cvt_pk_bf16_f32 v57, v246, v247
    v_mfma_f32_16x16x32_bf16 v[252:255], a[244:247], v[172:175], v[252:255]
    ds_read_b128 a[240:243], v2 offset:12288
    ds_read_b128 a[244:247], v2 offset:13312
    v_mfma_f32_16x16x32_bf16 v[252:255], a[248:251], v[204:207], v[252:255]
    s_add_u32 s100, s77, 4096
    ds_read_b128 a[248:251], v2 offset:14336
    v_fma_f32 v188, v208, s19, v215
    v_mfma_f32_16x16x32_bf16 v[252:255], a[252:255], v[236:239], v[252:255]
    s_add_u32 m0, m0, 4096
    ds_read_b128 a[252:255], v2 offset:15360
    v_fma_f32 v189, v209, s19, v215
    v_mfma_f32_16x16x32_bf16 a[52:55], v[120:123], v[72:75], a[52:55]
    buffer_load_dwordx4 v1, s[36:39], s100 offen sc1 lds
    v_mfma_f32_16x16x32_bf16 a[52:55], v[124:127], v[76:79], a[52:55]
    ds_read_b128 v[112:115], v2 offset:28672
    ds_read_b128 v[116:119], v2 offset:29696
    v_mfma_f32_16x16x32_bf16 a[56:59], v[120:123], v[80:83], a[56:59]
    v_exp_f32 v248, v248
    v_mfma_f32_16x16x32_bf16 a[56:59], v[124:127], v[84:87], a[56:59]
    v_exp_f32 v249, v249
    v_mfma_f32_16x16x32_bf16 a[60:63], v[120:123], v[88:91], a[60:63]
    v_exp_f32 v250, v250
    v_mfma_f32_16x16x32_bf16 a[60:63], v[124:127], v[92:95], a[60:63]
    v_exp_f32 v251, v251
    v_mfma_f32_16x16x32_bf16 v[240:243], a[224:227], v[136:139], v[184:187]
    v_fma_f32 v190, v210, s19, v215
    v_fma_f32 v191, v211, s19, v215
    v_mfma_f32_16x16x32_bf16 v[240:243], a[228:231], v[168:171], v[240:243]
    buffer_load_dwordx4 v1, s[36:39], s100 offen offset:1024 sc1 lds
    v_mfma_f32_16x16x32_bf16 v[240:243], a[232:235], v[200:203], v[240:243]
    v_cvt_pk_bf16_f32 v50, v248, v249
    v_cvt_pk_bf16_f32 v51, v250, v251
    v_mfma_f32_16x16x32_bf16 v[240:243], a[236:239], v[232:235], v[240:243]
    ds_read_b128 v[120:123], v2 offset:30720
    ds_read_b128 v[124:127], v2 offset:31744
    v_mfma_f32_16x16x32_bf16 a[148:151], v[96:99], v[72:75], a[148:151]
    v_exp_f32 v252, v252
    v_mfma_f32_16x16x32_bf16 a[148:151], v[100:103], v[76:79], a[148:151]
    v_exp_f32 v253, v253
    v_mfma_f32_16x16x32_bf16 a[152:155], v[96:99], v[80:83], a[152:155]
    v_exp_f32 v254, v254
    v_mfma_f32_16x16x32_bf16 a[152:155], v[100:103], v[84:87], a[152:155]
    v_exp_f32 v255, v255
    v_mfma_f32_16x16x32_bf16 a[156:159], v[96:99], v[88:91], a[156:159]
    v_cvt_pk_bf16_f32 v58, v252, v253
    v_cvt_pk_bf16_f32 v59, v254, v255
    v_mfma_f32_16x16x32_bf16 a[156:159], v[100:103], v[92:95], a[156:159]
    buffer_load_dwordx4 v1, s[36:39], s100 offen offset:2048 sc1 lds
    v_mfma_f32_16x16x32_bf16 v[244:247], a[224:227], v[140:143], v[156:159]
    s_cmp_eq_u32 s82, 163840
    s_cselect_b32 s82, 0, s82
    v_add_u32 v2, s82, v1
    v_mfma_f32_16x16x32_bf16 v[244:247], a[228:231], v[172:175], v[244:247]
    v_exp_f32 v240, v240
    v_mfma_f32_16x16x32_bf16 v[244:247], a[232:235], v[204:207], v[244:247]
    v_exp_f32 v241, v241
    v_mfma_f32_16x16x32_bf16 v[244:247], a[236:239], v[236:239], v[244:247]
    v_exp_f32 v242, v242
    v_mfma_f32_16x16x32_bf16 a[164:167], v[104:107], v[72:75], a[164:167]
    s_waitcnt lgkmcnt(0)
    v_exp_f32 v243, v243
    v_mfma_f32_16x16x32_bf16 a[164:167], v[108:111], v[76:79], a[164:167]
    v_cvt_pk_bf16_f32 v52, v240, v241
    v_cvt_pk_bf16_f32 v53, v242, v243
    v_mfma_f32_16x16x32_bf16 a[168:171], v[104:107], v[80:83], a[168:171]
    v_accvgpr_read_b32 v7, a124
    v_cvt_pk_bf16_f32 v7, 0, v7
    v_mfma_f32_16x16x32_bf16 a[168:171], v[108:111], v[84:87], a[168:171]
    buffer_load_dwordx4 v1, s[36:39], s100 offen offset:3072 sc1 lds
    v_mfma_f32_16x16x32_bf16 a[172:175], v[104:107], v[88:91], a[172:175]
    v_exp_f32 v244, v244
    v_mfma_f32_16x16x32_bf16 a[172:175], v[108:111], v[92:95], a[172:175]
    v_exp_f32 v245, v245
    v_mfma_f32_16x16x32_bf16 v[248:251], a[240:243], v[136:139], v[188:191]
    v_exp_f32 v246, v246
    v_mfma_f32_16x16x32_bf16 v[248:251], a[244:247], v[168:171], v[248:251]
    v_exp_f32 v247, v247
    v_mfma_f32_16x16x32_bf16 v[248:251], a[248:251], v[200:203], v[248:251]
    v_cvt_pk_bf16_f32 v60, v244, v245
    v_cvt_pk_bf16_f32 v61, v246, v247
    v_mfma_f32_16x16x32_bf16 v[248:251], a[252:255], v[232:235], v[248:251]
    ds_bpermute_b32 v7, v8, v7
    s_waitcnt lgkmcnt(0)
    v_mul_f32 v7, s98, v7
    v_mfma_f32_16x16x32_bf16 a[180:183], v[112:115], v[72:75], a[180:183]
    s_add_u32 s77, s77, 32768
    v_exp_f32 v7, v7
    v_mfma_f32_16x16x32_bf16 a[180:183], v[116:119], v[76:79], a[180:183]
    v_add_f32 v7, 1.0, v7
    v_mfma_f32_16x16x32_bf16 a[184:187], v[112:115], v[80:83], a[184:187]
    v_exp_f32 v248, v248
    v_mfma_f32_16x16x32_bf16 a[184:187], v[116:119], v[84:87], a[184:187]
    v_exp_f32 v249, v249
    v_mfma_f32_16x16x32_bf16 a[188:191], v[112:115], v[88:91], a[188:191]
    v_exp_f32 v250, v250
    v_mfma_f32_16x16x32_bf16 a[188:191], v[116:119], v[92:95], a[188:191]
    v_exp_f32 v251, v251
    v_mfma_f32_16x16x32_bf16 v[252:255], a[240:243], v[140:143], v[156:159]
    v_cvt_pk_bf16_f32 v54, v248, v249
    v_cvt_pk_bf16_f32 v55, v250, v251
    v_mfma_f32_16x16x32_bf16 v[252:255], a[244:247], v[172:175], v[252:255]
    v_rcp_f32 v7, v7
    v_mfma_f32_16x16x32_bf16 v[252:255], a[248:251], v[204:207], v[252:255]
    v_mfma_f32_16x16x32_bf16 v[252:255], a[252:255], v[236:239], v[252:255]
    s_waitcnt vmcnt(8) lgkmcnt(0)
    s_barrier
    ds_read_b128 a[224:227], v2 offset:0
    v_mfma_f32_16x16x32_bf16 a[196:199], v[120:123], v[72:75], a[196:199]
    ds_read_b128 a[228:231], v2 offset:1024
    ds_read_b128 a[232:235], v2 offset:2048
    v_mfma_f32_16x16x32_bf16 a[196:199], v[124:127], v[76:79], a[196:199]
    ds_read_b128 a[236:239], v2 offset:3072
    v_mfma_f32_16x16x32_bf16 a[200:203], v[120:123], v[80:83], a[200:203]
    v_exp_f32 v252, v252
    v_mfma_f32_16x16x32_bf16 a[200:203], v[124:127], v[84:87], a[200:203]
    ds_read_b128 v[96:99], v2 offset:16384
    ds_read_b128 v[100:103], v2 offset:17408
    v_mfma_f32_16x16x32_bf16 a[204:207], v[120:123], v[88:91], a[204:207]
    v_exp_f32 v253, v253
    v_mfma_f32_16x16x32_bf16 a[204:207], v[124:127], v[92:95], a[204:207]
    v_cvt_pk_bf16_f32 v62, v252, v253
    v_mfma_f32_16x16x32_bf16 a[212:215], a[136:139], v[72:75], a[212:215]
    v_mfma_f32_16x16x32_bf16 a[212:215], a[136:139], v[76:79], a[212:215]
    v_mfma_f32_16x16x32_bf16 a[216:219], a[136:139], v[80:83], a[216:219]
    v_mfma_f32_16x16x32_bf16 a[216:219], a[136:139], v[84:87], a[216:219]
    v_mfma_f32_16x16x32_bf16 a[220:223], a[136:139], v[88:91], a[220:223]
    v_mfma_f32_16x16x32_bf16 a[220:223], a[136:139], v[92:95], a[220:223]
    s_nop 7
    v_accvgpr_read_b32 v8, a208
    v_cmp_nge_f32 vcc, 0x71800000, v8
    v_rcp_f32 v10, v8
    s_nop 0
    s_or_b64 s[84:85], s[84:85], vcc
    v_mul_f32 v10, v10, v4
    v_accvgpr_read_b32 v12, a0
    v_accvgpr_read_b32 v13, a1
    v_accvgpr_read_b32 v14, a2
    v_accvgpr_read_b32 v15, a3
    v_accvgpr_read_b32 v16, a16
    v_accvgpr_read_b32 v17, a17
    v_accvgpr_read_b32 v18, a18
    v_accvgpr_read_b32 v19, a19
    v_pk_mul_f32 v[12:13], v[12:13], v[10:11] op_sel_hi:[1,0]
    v_pk_mul_f32 v[14:15], v[14:15], v[10:11] op_sel_hi:[1,0]
    v_pk_mul_f32 v[16:17], v[16:17], v[10:11] op_sel_hi:[1,0]
    v_pk_mul_f32 v[18:19], v[18:19], v[10:11] op_sel_hi:[1,0]
    v_cvt_pk_bf16_f32 v12, v12, v13
    v_cvt_pk_bf16_f32 v13, v14, v15
    v_cvt_pk_bf16_f32 v14, v16, v17
    v_cvt_pk_bf16_f32 v15, v18, v19
    buffer_store_dwordx4 v[12:15], v1, s[40:43], s80 offen offset:0 sc1
    v_accvgpr_read_b32 v20, a32
    v_accvgpr_read_b32 v21, a33
    v_accvgpr_read_b32 v22, a34
    v_accvgpr_read_b32 v23, a35
    v_accvgpr_read_b32 v24, a48
    v_accvgpr_read_b32 v25, a49
    v_accvgpr_read_b32 v26, a50
    v_accvgpr_read_b32 v27, a51
    v_pk_mul_f32 v[20:21], v[20:21], v[10:11] op_sel_hi:[1,0]
    v_pk_mul_f32 v[22:23], v[22:23], v[10:11] op_sel_hi:[1,0]
    v_pk_mul_f32 v[24:25], v[24:25], v[10:11] op_sel_hi:[1,0]
    v_pk_mul_f32 v[26:27], v[26:27], v[10:11] op_sel_hi:[1,0]
    v_cvt_pk_bf16_f32 v20, v20, v21
    v_cvt_pk_bf16_f32 v21, v22, v23
    v_cvt_pk_bf16_f32 v22, v24, v25
    v_cvt_pk_bf16_f32 v23, v26, v27
    buffer_store_dwordx4 v[20:23], v1, s[40:43], s80 offen offset:1024 sc1
    v_accvgpr_read_b32 v12, a144
    v_accvgpr_read_b32 v13, a145
    v_accvgpr_read_b32 v14, a146
    v_accvgpr_read_b32 v15, a147
    v_accvgpr_read_b32 v16, a160
    v_accvgpr_read_b32 v17, a161
    v_accvgpr_read_b32 v18, a162
    v_accvgpr_read_b32 v19, a163
    v_pk_mul_f32 v[12:13], v[12:13], v[10:11] op_sel_hi:[1,0]
    v_pk_mul_f32 v[14:15], v[14:15], v[10:11] op_sel_hi:[1,0]
    v_pk_mul_f32 v[16:17], v[16:17], v[10:11] op_sel_hi:[1,0]
    v_pk_mul_f32 v[18:19], v[18:19], v[10:11] op_sel_hi:[1,0]
    v_cvt_pk_bf16_f32 v12, v12, v13
    v_cvt_pk_bf16_f32 v13, v14, v15
    v_cvt_pk_bf16_f32 v14, v16, v17
    v_cvt_pk_bf16_f32 v15, v18, v19
    buffer_store_dwordx4 v[12:15], v1, s[40:43], s80 offen offset:2048 sc1
    v_accvgpr_read_b32 v20, a176
    v_accvgpr_read_b32 v21, a177
    v_accvgpr_read_b32 v22, a178
    v_accvgpr_read_b32 v23, a179
    v_accvgpr_read_b32 v24, a192
    v_accvgpr_read_b32 v25, a193
    v_accvgpr_read_b32 v26, a194
    v_accvgpr_read_b32 v27, a195
    v_pk_mul_f32 v[20:21], v[20:21], v[10:11] op_sel_hi:[1,0]
    v_pk_mul_f32 v[22:23], v[22:23], v[10:11] op_sel_hi:[1,0]
    v_pk_mul_f32 v[24:25], v[24:25], v[10:11] op_sel_hi:[1,0]
    v_pk_mul_f32 v[26:27], v[26:27], v[10:11] op_sel_hi:[1,0]
    v_cvt_pk_bf16_f32 v20, v20, v21
    v_cvt_pk_bf16_f32 v21, v22, v23
    v_cvt_pk_bf16_f32 v22, v24, v25
    v_cvt_pk_bf16_f32 v23, v26, v27
    buffer_store_dwordx4 v[20:23], v1, s[40:43], s80 offen offset:3072 sc1
    v_accvgpr_read_b32 v8, a212
    v_cmp_nge_f32 vcc, 0x71800000, v8
    v_rcp_f32 v10, v8
    s_nop 0
    s_or_b64 s[84:85], s[84:85], vcc
    v_mul_f32 v10, v10, v5
    s_add_u32 s72, s80, 622592
    v_accvgpr_read_b32 v12, a4
    v_accvgpr_read_b32 v13, a5
    v_accvgpr_read_b32 v14, a6
    v_accvgpr_read_b32 v15, a7
    v_accvgpr_read_b32 v16, a20
    v_accvgpr_read_b32 v17, a21
    v_accvgpr_read_b32 v18, a22
    v_accvgpr_read_b32 v19, a23
    v_pk_mul_f32 v[12:13], v[12:13], v[10:11] op_sel_hi:[1,0]
    v_pk_mul_f32 v[14:15], v[14:15], v[10:11] op_sel_hi:[1,0]
    v_pk_mul_f32 v[16:17], v[16:17], v[10:11] op_sel_hi:[1,0]
    v_pk_mul_f32 v[18:19], v[18:19], v[10:11] op_sel_hi:[1,0]
    v_cvt_pk_bf16_f32 v12, v12, v13
    v_cvt_pk_bf16_f32 v13, v14, v15
    v_cvt_pk_bf16_f32 v14, v16, v17
    v_cvt_pk_bf16_f32 v15, v18, v19
    buffer_store_dwordx4 v[12:15], v1, s[40:43], s72 offen offset:0 sc1
    v_accvgpr_read_b32 v20, a36
    v_accvgpr_read_b32 v21, a37
    v_accvgpr_read_b32 v22, a38
    v_accvgpr_read_b32 v23, a39
    v_accvgpr_read_b32 v24, a52
    v_accvgpr_read_b32 v25, a53
    v_accvgpr_read_b32 v26, a54
    v_accvgpr_read_b32 v27, a55
    v_pk_mul_f32 v[20:21], v[20:21], v[10:11] op_sel_hi:[1,0]
    v_pk_mul_f32 v[22:23], v[22:23], v[10:11] op_sel_hi:[1,0]
    v_pk_mul_f32 v[24:25], v[24:25], v[10:11] op_sel_hi:[1,0]
    v_pk_mul_f32 v[26:27], v[26:27], v[10:11] op_sel_hi:[1,0]
    v_cvt_pk_bf16_f32 v20, v20, v21
    v_cvt_pk_bf16_f32 v21, v22, v23
    v_cvt_pk_bf16_f32 v22, v24, v25
    v_cvt_pk_bf16_f32 v23, v26, v27
    buffer_store_dwordx4 v[20:23], v1, s[40:43], s72 offen offset:1024 sc1
    v_accvgpr_read_b32 v12, a148
    v_accvgpr_read_b32 v13, a149
    v_accvgpr_read_b32 v14, a150
    v_accvgpr_read_b32 v15, a151
    v_accvgpr_read_b32 v16, a164
    v_accvgpr_read_b32 v17, a165
    v_accvgpr_read_b32 v18, a166
    v_accvgpr_read_b32 v19, a167
    v_pk_mul_f32 v[12:13], v[12:13], v[10:11] op_sel_hi:[1,0]
    v_pk_mul_f32 v[14:15], v[14:15], v[10:11] op_sel_hi:[1,0]
    v_pk_mul_f32 v[16:17], v[16:17], v[10:11] op_sel_hi:[1,0]
    v_pk_mul_f32 v[18:19], v[18:19], v[10:11] op_sel_hi:[1,0]
    v_cvt_pk_bf16_f32 v12, v12, v13
    v_cvt_pk_bf16_f32 v13, v14, v15
    v_cvt_pk_bf16_f32 v14, v16, v17
    v_cvt_pk_bf16_f32 v15, v18, v19
    buffer_store_dwordx4 v[12:15], v1, s[40:43], s72 offen offset:2048 sc1
    v_accvgpr_read_b32 v20, a180
    v_accvgpr_read_b32 v21, a181
    v_accvgpr_read_b32 v22, a182
    v_accvgpr_read_b32 v23, a183
    v_accvgpr_read_b32 v24, a196
    v_accvgpr_read_b32 v25, a197
    v_accvgpr_read_b32 v26, a198
    v_accvgpr_read_b32 v27, a199
    v_pk_mul_f32 v[20:21], v[20:21], v[10:11] op_sel_hi:[1,0]
    v_pk_mul_f32 v[22:23], v[22:23], v[10:11] op_sel_hi:[1,0]
    v_pk_mul_f32 v[24:25], v[24:25], v[10:11] op_sel_hi:[1,0]
    v_pk_mul_f32 v[26:27], v[26:27], v[10:11] op_sel_hi:[1,0]
    v_cvt_pk_bf16_f32 v20, v20, v21
    v_cvt_pk_bf16_f32 v21, v22, v23
    v_cvt_pk_bf16_f32 v22, v24, v25
    v_cvt_pk_bf16_f32 v23, v26, v27
    buffer_store_dwordx4 v[20:23], v1, s[40:43], s72 offen offset:3072 sc1
    s_sub_u32 s78, 14, s6
    s_sub_u32 s78, s78, s6
    s_cmp_eq_u32 s78, 0
    s_cbranch_scc1 K1_LS_END
.p2align 3
K1_LS:
    s_waitcnt lgkmcnt(0)
    v_mfma_f32_16x16x32_bf16 v[240:243], a[224:227], v[136:139], v[176:179]
    s_add_u32 m0, s76, s75
    v_exp_f32 v254, v254
    v_mfma_f32_16x16x32_bf16 v[240:243], a[228:231], v[168:171], v[240:243]
    s_mov_b32 s76, s60
    v_exp_f32 v255, v255
    v_mfma_f32_16x16x32_bf16 v[240:243], a[232:235], v[200:203], v[240:243]
    s_mov_b32 s60, s82
    buffer_load_dwordx4 v1, s[36:39], s77 offen sc1 lds
    v_mfma_f32_16x16x32_bf16 v[240:243], a[236:239], v[232:235], v[240:243]
    s_add_u32 s82, s82, 32768
    ds_read_b128 v[104:107], v2 offset:18432
    v_cvt_pk_bf16_f32 v63, v254, v255
    v_mfma_f32_16x16x32_bf16 a[8:11], v[96:99], v[48:51], a[8:11]
    ds_read_b128 v[108:111], v2 offset:19456
    ds_read_b128 a[240:243], v2 offset:4096
    v_mfma_f32_16x16x32_bf16 a[8:11], v[100:103], v[52:55], a[8:11]
    ds_read_b128 a[244:247], v2 offset:5120
    v_mfma_f32_16x16x32_bf16 a[12:15], v[96:99], v[56:59], a[12:15]
    buffer_load_dwordx4 v1, s[36:39], s77 offen offset:1024 sc1 lds
    v_mfma_f32_16x16x32_bf16 a[12:15], v[100:103], v[60:63], a[12:15]
    ds_read_b128 a[248:251], v2 offset:6144
    ds_read_b128 a[252:255], v2 offset:7168
    v_mfma_f32_16x16x32_bf16 v[244:247], a[224:227], v[140:143], v[156:159]
    v_exp_f32 v240, v240
    v_mfma_f32_16x16x32_bf16 v[244:247], a[228:231], v[172:175], v[244:247]
    ds_read_b128 v[112:115], v2 offset:20480
    ds_read_b128 v[116:119], v2 offset:21504
    v_mfma_f32_16x16x32_bf16 v[244:247], a[232:235], v[204:207], v[244:247]
    v_exp_f32 v241, v241
    v_mfma_f32_16x16x32_bf16 v[244:247], a[236:239], v[236:239], v[244:247]
    s_waitcnt lgkmcnt(4)
    ds_read_b128 v[120:123], v2 offset:22528
    ds_read_b128 v[124:127], v2 offset:23552
    v_mfma_f32_16x16x32_bf16 a[24:27], v[104:107], v[48:51], a[24:27]
    buffer_load_dwordx4 v1, s[36:39], s77 offen offset:2048 sc1 lds
    v_mfma_f32_16x16x32_bf16 a[24:27], v[108:111], v[52:55], a[24:27]
    ds_read_b128 a[224:227], v2 offset:8192
    ds_read_b128 a[228:231], v2 offset:9216
    v_mfma_f32_16x16x32_bf16 a[28:31], v[104:107], v[56:59], a[28:31]
    ds_read_b128 a[232:235], v2 offset:10240
    v_cvt_pk_bf16_f32 v80, v240, v241
    v_mfma_f32_16x16x32_bf16 a[28:31], v[108:111], v[60:63], a[28:31]
    v_exp_f32 v242, v242
    v_mfma_f32_16x16x32_bf16 v[248:251], a[240:243], v[136:139], v[180:183]
    ds_read_b128 a[236:239], v2 offset:11264
    ds_read_b128 v[96:99], v2 offset:24576
    v_mfma_f32_16x16x32_bf16 v[248:251], a[244:247], v[168:171], v[248:251]
    s_waitcnt lgkmcnt(5)
    v_exp_f32 v243, v243
    v_mfma_f32_16x16x32_bf16 v[248:251], a[248:251], v[200:203], v[248:251]
    buffer_load_dwordx4 v1, s[36:39], s77 offen offset:3072 sc1 lds
    v_mfma_f32_16x16x32_bf16 v[248:251], a[252:255], v[232:235], v[248:251]
    ds_read_b128 v[100:103], v2 offset:25600
    v_cvt_pk_bf16_f32 v81, v242, v243
    v_mfma_f32_16x16x32_bf16 a[40:43], v[112:115], v[48:51], a[40:43]
    ds_read_b128 v[104:107], v2 offset:26624
    ds_read_b128 v[108:111], v2 offset:27648
    v_mfma_f32_16x16x32_bf16 a[40:43], v[116:119], v[52:55], a[40:43]
    v_exp_f32 v244, v244
    v_mfma_f32_16x16x32_bf16 a[44:47], v[112:115], v[56:59], a[44:47]
    v_exp_f32 v245, v245
    v_mfma_f32_16x16x32_bf16 a[44:47], v[116:119], v[60:63], a[44:47]
    s_add_u32 s100, s77, 4096
    v_exp_f32 v246, v246
    v_mfma_f32_16x16x32_bf16 v[252:255], a[240:243], v[140:143], v[156:159]
    s_add_u32 m0, m0, 4096
    v_exp_f32 v247, v247
    v_mfma_f32_16x16x32_bf16 v[252:255], a[244:247], v[172:175], v[252:255]
    buffer_load_dwordx4 v1, s[36:39], s100 offen sc1 lds
    v_mfma_f32_16x16x32_bf16 v[252:255], a[248:251], v[204:207], v[252:255]
    v_cvt_pk_bf16_f32 v88, v244, v245
    v_cvt_pk_bf16_f32 v89, v246, v247
    v_mfma_f32_16x16x32_bf16 v[252:255], a[252:255], v[236:239], v[252:255]
    ds_read_b128 a[240:243], v2 offset:12288
    ds_read_b128 a[244:247], v2 offset:13312
    v_mfma_f32_16x16x32_bf16 a[56:59], v[120:123], v[48:51], a[56:59]
    v_exp_f32 v248, v248
    v_mfma_f32_16x16x32_bf16 a[56:59], v[124:127], v[52:55], a[56:59]
    buffer_load_dwordx4 v1, s[36:39], s100 offen offset:1024 sc1 lds
    v_mfma_f32_16x16x32_bf16 a[60:63], v[120:123], v[56:59], a[60:63]
    ds_read_b128 a[248:251], v2 offset:14336
    ds_read_b128 a[252:255], v2 offset:15360
    v_mfma_f32_16x16x32_bf16 a[60:63], v[124:127], v[60:63], a[60:63]
    s_waitcnt lgkmcnt(4)
    v_exp_f32 v249, v249
    v_mfma_f32_16x16x32_bf16 v[240:243], a[224:227], v[136:139], v[184:187]
    ds_read_b128 v[112:115], v2 offset:28672
    ds_read_b128 v[116:119], v2 offset:29696
    v_mfma_f32_16x16x32_bf16 v[240:243], a[228:231], v[168:171], v[240:243]
    v_exp_f32 v250, v250
    v_mfma_f32_16x16x32_bf16 v[240:243], a[232:235], v[200:203], v[240:243]
    v_exp_f32 v251, v251
    v_mfma_f32_16x16x32_bf16 v[240:243], a[236:239], v[232:235], v[240:243]
    buffer_load_dwordx4 v1, s[36:39], s100 offen offset:2048 sc1 lds
    v_mfma_f32_16x16x32_bf16 a[152:155], v[96:99], v[48:51], a[152:155]
    v_cvt_pk_bf16_f32 v82, v248, v249
    v_cvt_pk_bf16_f32 v83, v250, v251
    v_mfma_f32_16x16x32_bf16 a[152:155], v[100:103], v[52:55], a[152:155]
    ds_read_b128 v[120:123], v2 offset:30720
    ds_read_b128 v[124:127], v2 offset:31744
    v_mfma_f32_16x16x32_bf16 a[156:159], v[96:99], v[56:59], a[156:159]
    v_exp_f32 v252, v252
    v_mfma_f32_16x16x32_bf16 a[156:159], v[100:103], v[60:63], a[156:159]
    v_exp_f32 v253, v253
    v_mfma_f32_16x16x32_bf16 v[244:247], a[224:227], v[140:143], v[156:159]
    v_exp_f32 v254, v254
    v_mfma_f32_16x16x32_bf16 v[244:247], a[228:231], v[172:175], v[244:247]
    buffer_load_dwordx4 v1, s[36:39], s100 offen offset:3072 sc1 lds
    v_mfma_f32_16x16x32_bf16 v[244:247], a[232:235], v[204:207], v[244:247]
    v_exp_f32 v255, v255
    v_mfma_f32_16x16x32_bf16 v[244:247], a[236:239], v[236:239], v[244:247]
    s_cmp_eq_u32 s82, 163840
    s_cselect_b32 s82, 0, s82
    v_cvt_pk_bf16_f32 v90, v252, v253
    v_mfma_f32_16x16x32_bf16 a[168:171], v[104:107], v[48:51], a[168:171]
    v_cvt_pk_bf16_f32 v91, v254, v255
    v_add_u32 v2, s82, v1
    v_mfma_f32_16x16x32_bf16 a[168:171], v[108:111], v[52:55], a[168:171]
    ds_read_b128 a[224:227], v2 offset:0
    ds_read_b128 a[228:231], v2 offset:1024
    v_mfma_f32_16x16x32_bf16 a[172:175], v[104:107], v[56:59], a[172:175]
    s_add_u32 s77, s77, 32768
    v_exp_f32 v240, v240
    v_mfma_f32_16x16x32_bf16 a[172:175], v[108:111], v[60:63], a[172:175]
    s_waitcnt lgkmcnt(2)
    ds_read_b128 a[232:235], v2 offset:2048
    ds_read_b128 a[236:239], v2 offset:3072
    v_mfma_f32_16x16x32_bf16 v[248:251], a[240:243], v[136:139], v[188:191]
    v_exp_f32 v241, v241
    v_mfma_f32_16x16x32_bf16 v[248:251], a[244:247], v[168:171], v[248:251]
    ds_read_b128 v[96:99], v2 offset:16384
    ds_read_b128 v[100:103], v2 offset:17408
    v_mfma_f32_16x16x32_bf16 v[248:251], a[248:251], v[200:203], v[248:251]
    v_exp_f32 v242, v242
    v_mfma_f32_16x16x32_bf16 v[248:251], a[252:255], v[232:235], v[248:251]
    v_exp_f32 v243, v243
    v_mfma_f32_16x16x32_bf16 a[184:187], v[112:115], v[48:51], a[184:187]
    v_exp_f32 v244, v244
    v_mfma_f32_16x16x32_bf16 a[184:187], v[116:119], v[52:55], a[184:187]
    v_exp_f32 v245, v245
    v_mfma_f32_16x16x32_bf16 a[188:191], v[112:115], v[56:59], a[188:191]
    v_exp_f32 v246, v246
    v_mfma_f32_16x16x32_bf16 a[188:191], v[116:119], v[60:63], a[188:191]
    v_exp_f32 v247, v247
    v_mfma_f32_16x16x32_bf16 v[252:255], a[240:243], v[140:143], v[156:159]
    v_exp_f32 v248, v248
    v_mfma_f32_16x16x32_bf16 v[252:255], a[244:247], v[172:175], v[252:255]
    v_exp_f32 v249, v249
    v_mfma_f32_16x16x32_bf16 v[252:255], a[248:251], v[204:207], v[252:255]
    v_exp_f32 v250, v250
    v_mfma_f32_16x16x32_bf16 v[252:255], a[252:255], v[236:239], v[252:255]
    v_exp_f32 v251, v251
    v_mfma_f32_16x16x32_bf16 a[200:203], v[120:123], v[48:51], a[200:203]
    v_cvt_pk_bf16_f32 v84, v240, v241
    v_cvt_pk_bf16_f32 v85, v242, v243
    v_mfma_f32_16x16x32_bf16 a[200:203], v[124:127], v[52:55], a[200:203]
    v_cvt_pk_bf16_f32 v92, v244, v245
    v_cvt_pk_bf16_f32 v93, v246, v247
    v_mfma_f32_16x16x32_bf16 a[204:207], v[120:123], v[56:59], a[204:207]
    v_exp_f32 v252, v252
    v_mfma_f32_16x16x32_bf16 a[204:207], v[124:127], v[60:63], a[204:207]
    v_exp_f32 v253, v253
    v_mfma_f32_16x16x32_bf16 a[216:219], a[136:139], v[48:51], a[216:219]
    v_cvt_pk_bf16_f32 v86, v248, v249
    v_cvt_pk_bf16_f32 v87, v250, v251
    v_mfma_f32_16x16x32_bf16 a[216:219], a[136:139], v[52:55], a[216:219]
    v_cvt_pk_bf16_f32 v94, v252, v253
    v_mfma_f32_16x16x32_bf16 a[220:223], a[136:139], v[56:59], a[220:223]
    v_mfma_f32_16x16x32_bf16 a[220:223], a[136:139], v[60:63], a[220:223]
    s_cmp_eq_u32 s78, 1
    s_cbranch_scc1 K1_LS_MASK
K1_LS_BACK:
    s_waitcnt lgkmcnt(0)
    v_mfma_f32_16x16x32_bf16 v[240:243], a[224:227], v[136:139], v[176:179]
    s_add_u32 m0, s76, s75
    v_exp_f32 v254, v254
    v_mfma_f32_16x16x32_bf16 v[240:243], a[228:231], v[168:171], v[240:243]
    s_mov_b32 s76, s60
    v_exp_f32 v255, v255
    v_mfma_f32_16x16x32_bf16 v[240:243], a[232:235], v[200:203], v[240:243]
    s_mov_b32 s60, s82
    buffer_load_dwordx4 v1, s[36:39], s77 offen sc1 lds
    v_mfma_f32_16x16x32_bf16 v[240:243], a[236:239], v[232:235], v[240:243]
    s_add_u32 s82, s82, 32768
    ds_read_b128 v[104:107], v2 offset:18432
    v_cvt_pk_bf16_f32 v95, v254, v255
    v_mfma_f32_16x16x32_bf16 a[8:11], v[96:99], v[80:83], a[8:11]
    ds_read_b128 v[108:111], v2 offset:19456
    ds_read_b128 a[240:243], v2 offset:4096
    v_mfma_f32_16x16x32_bf16 a[8:11], v[100:103], v[84:87], a[8:11]
    ds_read_b128 a[244:247], v2 offset:5120
    v_mfma_f32_16x16x32_bf16 a[12:15], v[96:99], v[88:91], a[12:15]
    buffer_load_dwordx4 v1, s[36:39], s77 offen offset:1024 sc1 lds
    v_mfma_f32_16x16x32_bf16 a[12:15], v[100:103], v[92:95], a[12:15]
    ds_read_b128 a[248:251], v2 offset:6144
    ds_read_b128 a[252:255], v2 offset:7168
    v_mfma_f32_16x16x32_bf16 v[244:247], a[224:227], v[140:143], v[156:159]
    v_exp_f32 v240, v240
    v_mfma_f32_16x16x32_bf16 v[244:247], a[228:231], v[172:175], v[244:247]
    ds_read_b128 v[112:115], v2 offset:20480
    ds_read_b128 v[116:119], v2 offset:21504
    v_mfma_f32_16x16x32_bf16 v[244:247], a[232:235], v[204:207], v[244:247]
    v_exp_f32 v241, v241
    v_mfma_f32_16x16x32_bf16 v[244:247], a[236:239], v[236:239], v[244:247]
    s_waitcnt lgkmcnt(4)
    ds_read_b128 v[120:123], v2 offset:22528
    ds_read_b128 v[124:127], v2 offset:23552
    v_mfma_f32_16x16x32_bf16 a[24:27], v[104:107], v[80:83], a[24:27]
    buffer_load_dwordx4 v1, s[36:39], s77 offen offset:2048 sc1 lds
    v_mfma_f32_16x16x32_bf16 a[24:27], v[108:111], v[84:87], a[24:27]
    ds_read_b128 a[224:227], v2 offset:8192
    ds_read_b128 a[228:231], v2 offset:9216
    v_mfma_f32_16x16x32_bf16 a[28:31], v[104:107], v[88:91], a[28:31]
    ds_read_b128 a[232:235], v2 offset:10240
    v_cvt_pk_bf16_f32 v48, v240, v241
    v_mfma_f32_16x16x32_bf16 a[28:31], v[108:111], v[92:95], a[28:31]
    v_exp_f32 v242, v242
    v_mfma_f32_16x16x32_bf16 v[248:251], a[240:243], v[136:139], v[180:183]
    ds_read_b128 a[236:239], v2 offset:11264
    ds_read_b128 v[96:99], v2 offset:24576
    v_mfma_f32_16x16x32_bf16 v[248:251], a[244:247], v[168:171], v[248:251]
    s_waitcnt lgkmcnt(5)
    v_exp_f32 v243, v243
    v_mfma_f32_16x16x32_bf16 v[248:251], a[248:251], v[200:203], v[248:251]
    buffer_load_dwordx4 v1, s[36:39], s77 offen offset:3072 sc1 lds
    v_mfma_f32_16x16x32_bf16 v[248:251], a[252:255], v[232:235], v[248:251]
    ds_read_b128 v[100:103], v2 offset:25600
    v_cvt_pk_bf16_f32 v49, v242, v243
    v_mfma_f32_16x16x32_bf16 a[40:43], v[112:115], v[80:83], a[40:43]
    ds_read_b128 v[104:107], v2 offset:26624
    ds_read_b128 v[108:111], v2 offset:27648
    v_mfma_f32_16x16x32_bf16 a[40:43], v[116:119], v[84:87], a[40:43]
    v_exp_f32 v244, v244
    v_mfma_f32_16x16x32_bf16 a[44:47], v[112:115], v[88:91], a[44:47]
    v_exp_f32 v245, v245
    v_mfma_f32_16x16x32_bf16 a[44:47], v[116:119], v[92:95], a[44:47]
    s_add_u32 s100, s77, 4096
    v_exp_f32 v246, v246
    v_mfma_f32_16x16x32_bf16 v[252:255], a[240:243], v[140:143], v[156:159]
    s_add_u32 m0, m0, 4096
    v_exp_f32 v247, v247
    v_mfma_f32_16x16x32_bf16 v[252:255], a[244:247], v[172:175], v[252:255]
    buffer_load_dwordx4 v1, s[36:39], s100 offen sc1 lds
    v_mfma_f32_16x16x32_bf16 v[252:255], a[248:251], v[204:207], v[252:255]
    v_cvt_pk_bf16_f32 v56, v244, v245
    v_cvt_pk_bf16_f32 v57, v246, v247
    v_mfma_f32_16x16x32_bf16 v[252:255], a[252:255], v[236:239], v[252:255]
    ds_read_b128 a[240:243], v2 offset:12288
    ds_read_b128 a[244:247], v2 offset:13312
    v_mfma_f32_16x16x32_bf16 a[56:59], v[120:123], v[80:83], a[56:59]
    v_exp_f32 v248, v248
    v_mfma_f32_16x16x32_bf16 a[56:59], v[124:127], v[84:87], a[56:59]
    buffer_load_dwordx4 v1, s[36:39], s100 offen offset:1024 sc1 lds
    v_mfma_f32_16x16x32_bf16 a[60:63], v[120:123], v[88:91], a[60:63]
    ds_read_b128 a[248:251], v2 offset:14336
    ds_read_b128 a[252:255], v2 offset:15360
    v_mfma_f32_16x16x32_bf16 a[60:63], v[124:127], v[92:95], a[60:63]
    s_waitcnt lgkmcnt(4)
    v_exp_f32 v249, v249
    v_mfma_f32_16x16x32_bf16 v[240:243], a[224:227], v[136:139], v[184:187]
    ds_read_b128 v[112:115], v2 offset:28672
    ds_read_b128 v[116:119], v2 offset:29696
    v_mfma_f32_16x16x32_bf16 v[240:243], a[228:231], v[168:171], v[240:243]
    v_exp_f32 v250, v250
    v_mfma_f32_16x16x32_bf16 v[240:243], a[232:235], v[200:203], v[240:243]
    v_exp_f32 v251, v251
    v_mfma_f32_16x16x32_bf16 v[240:243], a[236:239], v[232:235], v[240:243]
    buffer_load_dwordx4 v1, s[36:39], s100 offen offset:2048 sc1 lds
    v_mfma_f32_16x16x32_bf16 a[152:155], v[96:99], v[80:83], a[152:155]
    v_cvt_pk_bf16_f32 v50, v248, v249
    v_cvt_pk_bf16_f32 v51, v250, v251
    v_mfma_f32_16x16x32_bf16 a[152:155], v[100:103], v[84:87], a[152:155]
    ds_read_b128 v[120:123], v2 offset:30720
    ds_read_b128 v[124:127], v2 offset:31744
    v_mfma_f32_16x16x32_bf16 a[156:159], v[96:99], v[88:91], a[156:159]
    v_exp_f32 v252, v252
    v_mfma_f32_16x16x32_bf16 a[156:159], v[100:103], v[92:95], a[156:159]
    v_exp_f32 v253, v253
    v_mfma_f32_16x16x32_bf16 v[244:247], a[224:227], v[140:143], v[156:159]
    v_exp_f32 v254, v254
    v_mfma_f32_16x16x32_bf16 v[244:247], a[228:231], v[172:175], v[244:247]
    buffer_load_dwordx4 v1, s[36:39], s100 offen offset:3072 sc1 lds
    v_mfma_f32_16x16x32_bf16 v[244:247], a[232:235], v[204:207], v[244:247]
    v_exp_f32 v255, v255
    v_mfma_f32_16x16x32_bf16 v[244:247], a[236:239], v[236:239], v[244:247]
    s_cmp_eq_u32 s82, 163840
    s_cselect_b32 s82, 0, s82
    v_cvt_pk_bf16_f32 v58, v252, v253
    v_mfma_f32_16x16x32_bf16 a[168:171], v[104:107], v[80:83], a[168:171]
    v_cvt_pk_bf16_f32 v59, v254, v255
    v_add_u32 v2, s82, v1
    v_mfma_f32_16x16x32_bf16 a[168:171], v[108:111], v[84:87], a[168:171]
    v_exp_f32 v240, v240
    v_mfma_f32_16x16x32_bf16 a[172:175], v[104:107], v[88:91], a[172:175]
    s_add_u32 s77, s77, 32768
    v_exp_f32 v241, v241
    v_mfma_f32_16x16x32_bf16 a[172:175], v[108:111], v[92:95], a[172:175]
    s_waitcnt lgkmcnt(0)
    v_exp_f32 v242, v242
    v_mfma_f32_16x16x32_bf16 v[248:251], a[240:243], v[136:139], v[188:191]
    v_exp_f32 v243, v243
    v_mfma_f32_16x16x32_bf16 v[248:251], a[244:247], v[168:171], v[248:251]
    v_exp_f32 v244, v244
    v_mfma_f32_16x16x32_bf16 v[248:251], a[248:251], v[200:203], v[248:251]
    v_exp_f32 v245, v245
    v_mfma_f32_16x16x32_bf16 v[248:251], a[252:255], v[232:235], v[248:251]
    v_exp_f32 v246, v246
    v_mfma_f32_16x16x32_bf16 a[184:187], v[112:115], v[80:83], a[184:187]
    v_exp_f32 v247, v247
    v_mfma_f32_16x16x32_bf16 a[184:187], v[116:119], v[84:87], a[184:187]
    v_cvt_pk_bf16_f32 v52, v240, v241
    v_cvt_pk_bf16_f32 v53, v242, v243
    v_mfma_f32_16x16x32_bf16 a[188:191], v[112:115], v[88:91], a[188:191]
    v_cvt_pk_bf16_f32 v60, v244, v245
    v_cvt_pk_bf16_f32 v61, v246, v247
    v_mfma_f32_16x16x32_bf16 a[188:191], v[116:119], v[92:95], a[188:191]
    s_waitcnt vmcnt(8) lgkmcnt(0)
    s_barrier
    ds_read_b128 a[224:227], v2 offset:0
    v_mfma_f32_16x16x32_bf16 v[252:255], a[240:243], v[140:143], v[156:159]
    ds_read_b128 a[228:231], v2 offset:1024
    ds_read_b128 a[232:235], v2 offset:2048
    v_mfma_f32_16x16x32_bf16 v[252:255], a[244:247], v[172:175], v[252:255]
    v_exp_f32 v248, v248
    v_mfma_f32_16x16x32_bf16 v[252:255], a[248:251], v[204:207], v[252:255]
    ds_read_b128 a[236:239], v2 offset:3072
    ds_read_b128 v[96:99], v2 offset:16384
    v_mfma_f32_16x16x32_bf16 v[252:255], a[252:255], v[236:239], v[252:255]
    v_exp_f32 v249, v249
    v_mfma_f32_16x16x32_bf16 a[200:203], v[120:123], v[80:83], a[200:203]
    ds_read_b128 v[100:103], v2 offset:17408
    v_cvt_pk_bf16_f32 v54, v248, v249
    v_mfma_f32_16x16x32_bf16 a[200:203], v[124:127], v[84:87], a[200:203]
    v_exp_f32 v250, v250
    v_mfma_f32_16x16x32_bf16 a[204:207], v[120:123], v[88:91], a[204:207]
    v_exp_f32 v251, v251
    v_mfma_f32_16x16x32_bf16 a[204:207], v[124:127], v[92:95], a[204:207]
    v_exp_f32 v252, v252
    v_mfma_f32_16x16x32_bf16 a[216:219], a[136:139], v[80:83], a[216:219]
    v_exp_f32 v253, v253
    v_mfma_f32_16x16x32_bf16 a[216:219], a[136:139], v[84:87], a[216:219]
    v_cvt_pk_bf16_f32 v55, v250, v251
    v_cvt_pk_bf16_f32 v62, v252, v253
    v_mfma_f32_16x16x32_bf16 a[220:223], a[136:139], v[88:91], a[220:223]
    v_mfma_f32_16x16x32_bf16 a[220:223], a[136:139], v[92:95], a[220:223]
    s_sub_u32 s78, s78, 1
    s_cmp_lg_u32 s78, 0
    s_cbranch_scc1 K1_LS
K1_LS_END:
    v_add_f32 v212, s12, v156
    v_fma_f32 v176, v208, s8, v212
    v_fma_f32 v177, v209, s8, v212
    v_fma_f32 v178, v210, s8, v212
    v_fma_f32 v179, v211, s8, v212
    s_nop 1
    s_waitcnt lgkmcnt(0)
    v_mfma_f32_16x16x32_bf16 v[240:243], a[224:227], v[140:143], v[176:179]
    s_mul_i32 s86, s4, 34
    ds_read_b128 v[104:107], v2 offset:18432
    ds_read_b128 v[108:111], v2 offset:19456
    v_mfma_f32_16x16x32_bf16 v[240:243], a[228:231], v[172:175], v[240:243]
    s_add_u32 s86, s86, 8
    v_lshrrev_b32 v29, 2, v1
    ds_read_b128 a[240:243], v2 offset:4096
    v_mfma_f32_16x16x32_bf16 v[240:243], a[232:235], v[204:207], v[240:243]
    s_mov_b32 s76, s60
    v_exp_f32 v254, v254
    v_mfma_f32_16x16x32_bf16 v[240:243], a[236:239], v[236:239], v[240:243]
    s_mov_b32 s60, s82
    v_exp_f32 v255, v255
    v_mfma_f32_16x16x32_bf16 a[8:11], v[96:99], v[48:51], a[8:11]
    s_add_u32 s82, s82, 32768
    buffer_load_dword v3, v29, s[44:47], 0 offen sc1
    v_mfma_f32_16x16x32_bf16 a[8:11], v[100:103], v[52:55], a[8:11]
    v_cvt_pk_bf16_f32 v63, v254, v255
    ds_read_b128 a[244:247], v2 offset:5120
    v_mfma_f32_16x16x32_bf16 a[12:15], v[96:99], v[56:59], a[12:15]
    ds_read_b128 a[248:251], v2 offset:6144
    v_lshrrev_b32 v28, 4, v1
    v_mfma_f32_16x16x32_bf16 a[12:15], v[100:103], v[60:63], a[12:15]
    s_waitcnt lgkmcnt(2)
    ds_read_b128 a[252:255], v2 offset:7168
    v_min_u32 v28, 33, v28
    v_mfma_f32_16x16x32_bf16 a[24:27], v[104:107], v[48:51], a[24:27]
    ds_read_b128 v[112:115], v2 offset:20480
    v_add_lshl_u32 v28, v28, s86, 7
    v_mfma_f32_16x16x32_bf16 a[24:27], v[108:111], v[52:55], a[24:27]
    s_getpc_b64 s[86:87]
    global_load_dword v28, v28, s[86:87]
    v_mfma_f32_16x16x32_bf16 a[28:31], v[104:107], v[56:59], a[28:31]
    v_add_f32 v213, s13, v156
    ds_read_b128 v[116:119], v2 offset:21504
    v_mfma_f32_16x16x32_bf16 a[28:31], v[108:111], v[60:63], a[28:31]
    v_fma_f32 v180, v208, s9, v213
    v_fma_f32 v181, v209, s9, v213
    v_fma_f32 v182, v210, s9, v213
    v_fma_f32 v183, v211, s9, v213
    s_nop 1
    v_mfma_f32_16x16x32_bf16 v[244:247], a[240:243], v[140:143], v[180:183]
    s_waitcnt lgkmcnt(2)
    ds_read_b128 v[120:123], v2 offset:22528
    ds_read_b128 v[124:127], v2 offset:23552
    v_mfma_f32_16x16x32_bf16 v[244:247], a[244:247], v[172:175], v[244:247]
    ds_read_b128 a[224:227], v2 offset:8192
    v_add_f32 v214, s14, v156
    v_mfma_f32_16x16x32_bf16 v[244:247], a[248:251], v[204:207], v[244:247]
    ds_read_b128 a[228:231], v2 offset:9216
    v_fma_f32 v184, v208, s10, v214
    v_mfma_f32_16x16x32_bf16 v[244:247], a[252:255], v[236:239], v[244:247]
    s_waitcnt lgkmcnt(4)
    ds_read_b128 a[232:235], v2 offset:10240
    v_fma_f32 v185, v209, s10, v214
    v_mfma_f32_16x16x32_bf16 a[40:43], v[112:115], v[48:51], a[40:43]
    ds_read_b128 a[236:239], v2 offset:11264
    v_fma_f32 v186, v210, s10, v214
    v_mfma_f32_16x16x32_bf16 a[40:43], v[116:119], v[52:55], a[40:43]
    ds_read_b128 v[96:99], v2 offset:24576
    v_fma_f32 v187, v211, s10, v214
    v_mfma_f32_16x16x32_bf16 a[44:47], v[112:115], v[56:59], a[44:47]
    ds_read_b128 v[100:103], v2 offset:25600
    v_add_f32 v215, s15, v156
    v_mfma_f32_16x16x32_bf16 a[44:47], v[116:119], v[60:63], a[44:47]
    s_waitcnt lgkmcnt(4)
    ds_read_b128 v[104:107], v2 offset:26624
    v_fma_f32 v188, v208, s11, v215
    v_mfma_f32_16x16x32_bf16 a[56:59], v[120:123], v[48:51], a[56:59]
    ds_read_b128 v[108:111], v2 offset:27648
    v_fma_f32 v189, v209, s11, v215
    v_mfma_f32_16x16x32_bf16 a[56:59], v[124:127], v[52:55], a[56:59]
    ds_read_b128 a[240:243], v2 offset:12288
    v_fma_f32 v190, v210, s11, v215
    v_mfma_f32_16x16x32_bf16 a[60:63], v[120:123], v[56:59], a[60:63]
    ds_read_b128 a[244:247], v2 offset:13312
    v_fma_f32 v191, v211, s11, v215
    v_mfma_f32_16x16x32_bf16 a[60:63], v[124:127], v[60:63], a[60:63]
    v_exp_f32 v240, v240
    v_mfma_f32_16x16x32_bf16 v[248:251], a[224:227], v[140:143], v[184:187]
    ds_read_b128 a[248:251], v2 offset:14336
    ds_read_b128 a[252:255], v2 offset:15360
    v_mfma_f32_16x16x32_bf16 v[248:251], a[228:231], v[172:175], v[248:251]
    s_waitcnt lgkmcnt(4)
    v_exp_f32 v241, v241
    v_mfma_f32_16x16x32_bf16 v[248:251], a[232:235], v[204:207], v[248:251]
    ds_read_b128 v[112:115], v2 offset:28672
    ds_read_b128 v[116:119], v2 offset:29696
    v_mfma_f32_16x16x32_bf16 v[248:251], a[236:239], v[236:239], v[248:251]
    ds_read_b128 v[120:123], v2 offset:30720
    v_cvt_pk_bf16_f32 v88, v240, v241
    v_mfma_f32_16x16x32_bf16 a[152:155], v[96:99], v[48:51], a[152:155]
    v_exp_f32 v242, v242
    v_mfma_f32_16x16x32_bf16 a[152:155], v[100:103], v[52:55], a[152:155]
    v_exp_f32 v243, v243
    v_mfma_f32_16x16x32_bf16 a[156:159], v[96:99], v[56:59], a[156:159]
    ds_read_b128 v[124:127], v2 offset:31744
    v_cvt_pk_bf16_f32 v89, v242, v243
    v_mfma_f32_16x16x32_bf16 a[156:159], v[100:103], v[60:63], a[156:159]
    s_cmp_eq_u32 s82, 163840
    s_cselect_b32 s82, 0, s82
    v_add_u32 v2, s82, v1
    v_mfma_f32_16x16x32_bf16 a[168:171], v[104:107], v[48:51], a[168:171]
    ds_read_b128 a[224:227], v2 offset:0
    ds_read_b128 a[228:231], v2 offset:1024
    v_mfma_f32_16x16x32_bf16 a[168:171], v[108:111], v[52:55], a[168:171]
    v_exp_f32 v244, v244
    v_mfma_f32_16x16x32_bf16 a[172:175], v[104:107], v[56:59], a[172:175]
    ds_read_b128 a[232:235], v2 offset:2048
    ds_read_b128 a[236:239], v2 offset:3072
    v_mfma_f32_16x16x32_bf16 a[172:175], v[108:111], v[60:63], a[172:175]
    s_waitcnt lgkmcnt(4)
    v_exp_f32 v245, v245
    v_mfma_f32_16x16x32_bf16 v[252:255], a[240:243], v[140:143], v[188:191]
    ds_read_b128 v[96:99], v2 offset:16384
    ds_read_b128 v[100:103], v2 offset:17408
    v_mfma_f32_16x16x32_bf16 v[252:255], a[244:247], v[172:175], v[252:255]
    v_exp_f32 v246, v246
    v_mfma_f32_16x16x32_bf16 v[252:255], a[248:251], v[204:207], v[252:255]
    v_exp_f32 v247, v247
    v_mfma_f32_16x16x32_bf16 v[252:255], a[252:255], v[236:239], v[252:255]
    v_exp_f32 v248, v248
    v_mfma_f32_16x16x32_bf16 a[184:187], v[112:115], v[48:51], a[184:187]
    v_exp_f32 v249, v249
    v_mfma_f32_16x16x32_bf16 a[184:187], v[116:119], v[52:55], a[184:187]
    v_exp_f32 v250, v250
    v_mfma_f32_16x16x32_bf16 a[188:191], v[112:115], v[56:59], a[188:191]
    v_exp_f32 v251, v251
    v_mfma_f32_16x16x32_bf16 a[188:191], v[116:119], v[60:63], a[188:191]
    v_exp_f32 v252, v252
    v_mfma_f32_16x16x32_bf16 a[200:203], v[120:123], v[48:51], a[200:203]
    v_exp_f32 v253, v253
    v_mfma_f32_16x16x32_bf16 a[200:203], v[124:127], v[52:55], a[200:203]
    v_cvt_pk_bf16_f32 v90, v244, v245
    v_cvt_pk_bf16_f32 v91, v246, v247
    v_mfma_f32_16x16x32_bf16 a[204:207], v[120:123], v[56:59], a[204:207]
    v_cvt_pk_bf16_f32 v92, v248, v249
    v_cvt_pk_bf16_f32 v93, v250, v251
    v_mfma_f32_16x16x32_bf16 a[204:207], v[124:127], v[60:63], a[204:207]
    v_cvt_pk_bf16_f32 v94, v252, v253
    v_mfma_f32_16x16x32_bf16 a[216:219], a[136:139], v[48:51], a[216:219]
    v_mfma_f32_16x16x32_bf16 a[216:219], a[136:139], v[52:55], a[216:219]
    v_mfma_f32_16x16x32_bf16 a[220:223], a[136:139], v[56:59], a[220:223]
    v_mfma_f32_16x16x32_bf16 a[220:223], a[136:139], v[60:63], a[220:223]
    ds_read_b128 v[104:107], v2 offset:18432
    ds_read_b128 v[108:111], v2 offset:19456
    ds_read_b128 v[112:115], v2 offset:20480
    ds_read_b128 v[116:119], v2 offset:21504
    ds_read_b128 v[120:123], v2 offset:22528
    ds_read_b128 v[124:127], v2 offset:23552
    s_waitcnt lgkmcnt(6)
    v_mfma_f32_16x16x32_bf16 a[12:15], v[96:99], v[88:91], a[12:15]
    v_exp_f32 v254, v254
    v_exp_f32 v255, v255
    s_nop 0
    v_cvt_pk_bf16_f32 v95, v254, v255
    s_nop 1
    v_mfma_f32_16x16x32_bf16 a[12:15], v[100:103], v[92:95], a[12:15]
    s_waitcnt lgkmcnt(5)
    ds_read_b128 v[96:99], v2 offset:24576
    ds_read_b128 v[100:103], v2 offset:25600
    v_mfma_f32_16x16x32_bf16 a[28:31], v[104:107], v[88:91], a[28:31]
    s_waitcnt lgkmcnt(6)
    ds_read_b128 v[104:107], v2 offset:26624
    v_mfma_f32_16x16x32_bf16 a[28:31], v[108:111], v[92:95], a[28:31]
    s_waitcnt lgkmcnt(6)
    ds_read_b128 v[108:111], v2 offset:27648
    v_mfma_f32_16x16x32_bf16 a[44:47], v[112:115], v[88:91], a[44:47]
    s_waitcnt lgkmcnt(4)
    ds_read_b128 v[112:115], v2 offset:28672
    v_mfma_f32_16x16x32_bf16 a[44:47], v[116:119], v[92:95], a[44:47]
    ds_read_b128 v[116:119], v2 offset:29696
    v_mfma_f32_16x16x32_bf16 a[60:63], v[120:123], v[88:91], a[60:63]
    ds_read_b128 v[120:123], v2 offset:30720
    v_mfma_f32_16x16x32_bf16 a[60:63], v[124:127], v[92:95], a[60:63]
    s_waitcnt lgkmcnt(4)
    ds_read_b128 v[124:127], v2 offset:31744
    v_mfma_f32_16x16x32_bf16 a[156:159], v[96:99], v[88:91], a[156:159]
    v_mfma_f32_16x16x32_bf16 a[156:159], v[100:103], v[92:95], a[156:159]
    v_mfma_f32_16x16x32_bf16 a[172:175], v[104:107], v[88:91], a[172:175]
    s_waitcnt lgkmcnt(2)
    v_mfma_f32_16x16x32_bf16 a[172:175], v[108:111], v[92:95], a[172:175]
    v_mfma_f32_16x16x32_bf16 a[188:191], v[112:115], v[88:91], a[188:191]
    v_mfma_f32_16x16x32_bf16 a[188:191], v[116:119], v[92:95], a[188:191]
    s_waitcnt lgkmcnt(0)
    v_mfma_f32_16x16x32_bf16 a[204:207], v[120:123], v[88:91], a[204:207]
    v_mfma_f32_16x16x32_bf16 a[204:207], v[124:127], v[92:95], a[204:207]
    v_mfma_f32_16x16x32_bf16 a[220:223], a[136:139], v[88:91], a[220:223]
    v_mfma_f32_16x16x32_bf16 a[220:223], a[136:139], v[92:95], a[220:223]
    s_waitcnt vmcnt(0) lgkmcnt(0)
    s_barrier
    s_lshr_b32 s61, s5, 3
    s_and_b32 s98, s5, 3
    s_add_u32 s20, s98, 32
    s_lshl_b32 s20, s20, 10
    s_mul_i32 s78, s4, 7168
    s_add_u32 s3, s5, s6
    s_and_b32 s3, s3, 3
    s_lshl3_add_u32 s3, s61, s3
    s_add_u32 s99, s61, 0
    s_and_b32 s99, s99, 3
    s_lshl2_add_u32 s99, s99, s98
    s_lshl_b32 s16, s99, 11
    s_add_u32 s99, s61, 1
    s_and_b32 s99, s99, 3
    s_lshl2_add_u32 s99, s99, s98
    s_lshl_b32 s17, s99, 11
    s_add_u32 s99, s61, 2
    s_and_b32 s99, s99, 3
    s_lshl2_add_u32 s99, s99, s98
    s_lshl_b32 s18, s99, 11
    s_add_u32 s99, s61, 3
    s_and_b32 s99, s99, 3
    s_lshl2_add_u32 s99, s99, s98
    s_lshl_b32 s19, s99, 11
    v_cmp_gt_u32 vcc, 16, v3
    s_nop 1
    s_and_b64 vcc, vcc, s[92:93]
    s_cbranch_scc1 SPIN_ALL
BACK_ALL:
    v_accvgpr_read_b32 v8, a216
    v_cmp_nge_f32 vcc, 0x71800000, v8
    v_rcp_f32 v10, v8
    s_nop 0
    s_or_b64 s[84:85], s[84:85], vcc
    v_mul_f32 v10, v10, v6
    v_accvgpr_read_b32 v12, a8
    v_accvgpr_read_b32 v13, a9
    v_accvgpr_read_b32 v14, a10
    v_accvgpr_read_b32 v15, a11
    v_accvgpr_read_b32 v16, a24
    v_accvgpr_read_b32 v17, a25
    v_accvgpr_read_b32 v18, a26
    v_accvgpr_read_b32 v19, a27
    v_pk_mul_f32 v[12:13], v[12:13], v[10:11] op_sel_hi:[1,0]
    v_pk_mul_f32 v[14:15], v[14:15], v[10:11] op_sel_hi:[1,0]
    v_pk_mul_f32 v[16:17], v[16:17], v[10:11] op_sel_hi:[1,0]
    v_pk_mul_f32 v[18:19], v[18:19], v[10:11] op_sel_hi:[1,0]
    v_cvt_pk_bf16_f32 v12, v12, v13
    v_cvt_pk_bf16_f32 v13, v14, v15
    v_cvt_pk_bf16_f32 v14, v16, v17
    v_cvt_pk_bf16_f32 v15, v18, v19
    buffer_store_dwordx4 v[12:15], v1, s[40:43], s81 offen offset:0 sc1
    v_accvgpr_read_b32 v20, a40
    v_accvgpr_read_b32 v21, a41
    v_accvgpr_read_b32 v22, a42
    v_accvgpr_read_b32 v23, a43
    v_accvgpr_read_b32 v24, a56
    v_accvgpr_read_b32 v25, a57
    v_accvgpr_read_b32 v26, a58
    v_accvgpr_read_b32 v27, a59
    v_pk_mul_f32 v[20:21], v[20:21], v[10:11] op_sel_hi:[1,0]
    v_pk_mul_f32 v[22:23], v[22:23], v[10:11] op_sel_hi:[1,0]
    v_pk_mul_f32 v[24:25], v[24:25], v[10:11] op_sel_hi:[1,0]
    v_pk_mul_f32 v[26:27], v[26:27], v[10:11] op_sel_hi:[1,0]
    v_cvt_pk_bf16_f32 v20, v20, v21
    v_cvt_pk_bf16_f32 v21, v22, v23
    v_cvt_pk_bf16_f32 v22, v24, v25
    v_cvt_pk_bf16_f32 v23, v26, v27
    buffer_store_dwordx4 v[20:23], v1, s[40:43], s81 offen offset:1024 sc1
    v_accvgpr_read_b32 v12, a152
    v_accvgpr_read_b32 v13, a153
    v_accvgpr_read_b32 v14, a154
    v_accvgpr_read_b32 v15, a155
    v_accvgpr_read_b32 v16, a168
    v_accvgpr_read_b32 v17, a169
    v_accvgpr_read_b32 v18, a170
    v_accvgpr_read_b32 v19, a171
    v_pk_mul_f32 v[12:13], v[12:13], v[10:11] op_sel_hi:[1,0]
    v_pk_mul_f32 v[14:15], v[14:15], v[10:11] op_sel_hi:[1,0]
    v_pk_mul_f32 v[16:17], v[16:17], v[10:11] op_sel_hi:[1,0]
    v_pk_mul_f32 v[18:19], v[18:19], v[10:11] op_sel_hi:[1,0]
    v_cvt_pk_bf16_f32 v12, v12, v13
    v_cvt_pk_bf16_f32 v13, v14, v15
    v_cvt_pk_bf16_f32 v14, v16, v17
    v_cvt_pk_bf16_f32 v15, v18, v19
    buffer_store_dwordx4 v[12:15], v1, s[40:43], s81 offen offset:2048 sc1
    v_accvgpr_read_b32 v20, a184
    v_accvgpr_read_b32 v21, a185
    v_accvgpr_read_b32 v22, a186
    v_accvgpr_read_b32 v23, a187
    v_accvgpr_read_b32 v24, a200
    v_accvgpr_read_b32 v25, a201
    v_accvgpr_read_b32 v26, a202
    v_accvgpr_read_b32 v27, a203
    v_pk_mul_f32 v[20:21], v[20:21], v[10:11] op_sel_hi:[1,0]
    v_pk_mul_f32 v[22:23], v[22:23], v[10:11] op_sel_hi:[1,0]
    v_pk_mul_f32 v[24:25], v[24:25], v[10:11] op_sel_hi:[1,0]
    v_pk_mul_f32 v[26:27], v[26:27], v[10:11] op_sel_hi:[1,0]
    v_cvt_pk_bf16_f32 v20, v20, v21
    v_cvt_pk_bf16_f32 v21, v22, v23
    v_cvt_pk_bf16_f32 v22, v24, v25
    v_cvt_pk_bf16_f32 v23, v26, v27
    buffer_store_dwordx4 v[20:23], v1, s[40:43], s81 offen offset:3072 sc1
    v_accvgpr_read_b32 v8, a220
    v_cmp_nge_f32 vcc, 0x71800000, v8
    v_rcp_f32 v10, v8
    s_nop 0
    s_or_b64 s[84:85], s[84:85], vcc
    v_mul_f32 v10, v10, v7
    s_add_u32 s72, s81, 622592
    v_accvgpr_read_b32 v12, a12
    v_accvgpr_read_b32 v13, a13
    v_accvgpr_read_b32 v14, a14
    v_accvgpr_read_b32 v15, a15
    v_accvgpr_read_b32 v16, a28
    v_accvgpr_read_b32 v17, a29
    v_accvgpr_read_b32 v18, a30
    v_accvgpr_read_b32 v19, a31
    v_pk_mul_f32 v[12:13], v[12:13], v[10:11] op_sel_hi:[1,0]
    v_pk_mul_f32 v[14:15], v[14:15], v[10:11] op_sel_hi:[1,0]
    v_pk_mul_f32 v[16:17], v[16:17], v[10:11] op_sel_hi:[1,0]
    v_pk_mul_f32 v[18:19], v[18:19], v[10:11] op_sel_hi:[1,0]
    v_cvt_pk_bf16_f32 v12, v12, v13
    v_cvt_pk_bf16_f32 v13, v14, v15
    v_cvt_pk_bf16_f32 v14, v16, v17
    v_cvt_pk_bf16_f32 v15, v18, v19
    buffer_store_dwordx4 v[12:15], v1, s[40:43], s72 offen offset:0 sc1
    v_accvgpr_read_b32 v20, a44
    v_accvgpr_read_b32 v21, a45
    v_accvgpr_read_b32 v22, a46
    v_accvgpr_read_b32 v23, a47
    v_accvgpr_read_b32 v24, a60
    v_accvgpr_read_b32 v25, a61
    v_accvgpr_read_b32 v26, a62
    v_accvgpr_read_b32 v27, a63
    v_pk_mul_f32 v[20:21], v[20:21], v[10:11] op_sel_hi:[1,0]
    v_pk_mul_f32 v[22:23], v[22:23], v[10:11] op_sel_hi:[1,0]
    v_pk_mul_f32 v[24:25], v[24:25], v[10:11] op_sel_hi:[1,0]
    v_pk_mul_f32 v[26:27], v[26:27], v[10:11] op_sel_hi:[1,0]
    v_cvt_pk_bf16_f32 v20, v20, v21
    v_cvt_pk_bf16_f32 v21, v22, v23
    v_cvt_pk_bf16_f32 v22, v24, v25
    v_cvt_pk_bf16_f32 v23, v26, v27
    buffer_store_dwordx4 v[20:23], v1, s[40:43], s72 offen offset:1024 sc1
    v_accvgpr_read_b32 v12, a156
    v_accvgpr_read_b32 v13, a157
    v_accvgpr_read_b32 v14, a158
    v_accvgpr_read_b32 v15, a159
    v_accvgpr_read_b32 v16, a172
    v_accvgpr_read_b32 v17, a173
    v_accvgpr_read_b32 v18, a174
    v_accvgpr_read_b32 v19, a175
    v_pk_mul_f32 v[12:13], v[12:13], v[10:11] op_sel_hi:[1,0]
    v_pk_mul_f32 v[14:15], v[14:15], v[10:11] op_sel_hi:[1,0]
    v_pk_mul_f32 v[16:17], v[16:17], v[10:11] op_sel_hi:[1,0]
    v_pk_mul_f32 v[18:19], v[18:19], v[10:11] op_sel_hi:[1,0]
    v_cvt_pk_bf16_f32 v12, v12, v13
    v_cvt_pk_bf16_f32 v13, v14, v15
    v_cvt_pk_bf16_f32 v14, v16, v17
    v_cvt_pk_bf16_f32 v15, v18, v19
    buffer_store_dwordx4 v[12:15], v1, s[40:43], s72 offen offset:2048 sc1
    v_accvgpr_read_b32 v20, a188
    v_accvgpr_read_b32 v21, a189
    v_accvgpr_read_b32 v22, a190
    v_accvgpr_read_b32 v23, a191
    v_accvgpr_read_b32 v24, a204
    v_accvgpr_read_b32 v25, a205
    v_accvgpr_read_b32 v26, a206
    v_accvgpr_read_b32 v27, a207
    v_pk_mul_f32 v[20:21], v[20:21], v[10:11] op_sel_hi:[1,0]
    v_pk_mul_f32 v[22:23], v[22:23], v[10:11] op_sel_hi:[1,0]
    v_pk_mul_f32 v[24:25], v[24:25], v[10:11] op_sel_hi:[1,0]
    v_pk_mul_f32 v[26:27], v[26:27], v[10:11] op_sel_hi:[1,0]
    v_cvt_pk_bf16_f32 v20, v20, v21
    v_cvt_pk_bf16_f32 v21, v22, v23
    v_cvt_pk_bf16_f32 v22, v24, v25
    v_cvt_pk_bf16_f32 v23, v26, v27
    buffer_store_dwordx4 v[20:23], v1, s[40:43], s72 offen offset:3072 sc1
    s_xor_b32 s21, s3, 0
    s_lshl2_add_u32 s21, s21, s4
    s_mul_i32 s21, s21, 36864
    s_add_u32 s64, s21, s17
    s_add_u32 m0, s78, 0
    s_nop 0
    buffer_load_dwordx4 v1, s[56:59], s64 offen sc1 lds
    s_mov_b32 s79, 114688
    v_bfe_u32 v20, v1, 4, 4
    v_lshrrev_b32 v21, 8, v1
    s_lshl_b32 s98, s4, 4
    s_add_u32 s98, s98, 16
    v_add_u32 v22, s98, v20
    v_mul_u32_u24 v22, 144, v22
    v_add_u32 v22, s79, v22
    v_lshl_add_u32 v9, v21, 3, v22
    s_lshr_b32 s98, s73, 1
    v_add_u32 v8, s98, v9
    v_subrev_u32 v10, s98, v9
    s_and_b32 s99, s4, 1
    s_mul_i32 s99, s99, 20736
    s_add_u32 s99, s99, s79
    v_mul_u32_u24 v23, 144, v20
    v_lshl_add_u32 v23, v21, 3, v23
    v_add_u32 v13, s99, v23
    v_add_u32 v12, s98, v13
    v_accvgpr_read_b32 v32, a64
    v_accvgpr_read_b32 v33, a65
    v_accvgpr_read_b32 v34, a66
    buffer_load_dwordx4 v1, s[56:59], s64 offen offset:1024 sc1 lds
    v_accvgpr_read_b32 v35, a67
    v_cvt_pk_bf16_f32 v32, v32, v33
    v_cvt_pk_bf16_f32 v33, v34, v35
    ds_write_b64 v8, v[32:33] offset:0
    v_accvgpr_read_b32 v36, a68
    v_accvgpr_read_b32 v37, a69
    v_accvgpr_read_b32 v38, a70
    v_accvgpr_read_b32 v39, a71
    v_cvt_pk_bf16_f32 v36, v36, v37
    v_cvt_pk_bf16_f32 v37, v38, v39
    ds_write_b64 v8, v[36:37] offset:9216
    v_accvgpr_read_b32 v40, a72
    v_accvgpr_read_b32 v41, a73
    v_accvgpr_read_b32 v42, a74
    v_accvgpr_read_b32 v43, a75
    v_cvt_pk_bf16_f32 v40, v40, v41
    v_cvt_pk_bf16_f32 v41, v42, v43
    ds_write_b64 v8, v[40:41] offset:20736
    v_accvgpr_read_b32 v44, a76
    v_accvgpr_read_b32 v45, a77
    v_accvgpr_read_b32 v46, a78
    v_accvgpr_read_b32 v47, a79
    s_add_u32 s64, s21, s18
    s_add_u32 m0, s78, 2048
    s_nop 0
    buffer_load_dwordx4 v1, s[56:59], s64 offen sc1 lds
    v_cvt_pk_bf16_f32 v44, v44, v45
    v_cvt_pk_bf16_f32 v45, v46, v47
    ds_write_b64 v8, v[44:45] offset:29952
    v_accvgpr_read_b32 v32, a80
    v_accvgpr_read_b32 v33, a81
    v_accvgpr_read_b32 v34, a82
    v_accvgpr_read_b32 v35, a83
    v_cvt_pk_bf16_f32 v32, v32, v33
    v_cvt_pk_bf16_f32 v33, v34, v35
    ds_write_b64 v9, v[32:33] offset:32
    v_accvgpr_read_b32 v36, a84
    v_accvgpr_read_b32 v37, a85
    v_accvgpr_read_b32 v38, a86
    v_accvgpr_read_b32 v39, a87
    v_cvt_pk_bf16_f32 v36, v36, v37
    v_cvt_pk_bf16_f32 v37, v38, v39
    ds_write_b64 v9, v[36:37] offset:9248
    v_accvgpr_read_b32 v40, a88
    v_accvgpr_read_b32 v41, a89
    v_accvgpr_read_b32 v42, a90
    v_accvgpr_read_b32 v43, a91
    v_cvt_pk_bf16_f32 v40, v40, v41
    buffer_load_dwordx4 v1, s[56:59], s64 offen offset:1024 sc1 lds
    v_cvt_pk_bf16_f32 v41, v42, v43
    ds_write_b64 v9, v[40:41] offset:20768
    v_accvgpr_read_b32 v44, a92
    v_accvgpr_read_b32 v45, a93
    v_accvgpr_read_b32 v46, a94
    v_accvgpr_read_b32 v47, a95
    v_cvt_pk_bf16_f32 v44, v44, v45
    v_cvt_pk_bf16_f32 v45, v46, v47
    ds_write_b64 v9, v[44:45] offset:29984
    v_accvgpr_read_b32 v32, a96
    v_accvgpr_read_b32 v33, a97
    v_accvgpr_read_b32 v34, a98
    v_accvgpr_read_b32 v35, a99
    v_cvt_pk_bf16_f32 v32, v32, v33
    v_cvt_pk_bf16_f32 v33, v34, v35
    ds_write_b64 v10, v[32:33] offset:64
    v_accvgpr_read_b32 v36, a100
    v_accvgpr_read_b32 v37, a101
    v_accvgpr_read_b32 v38, a102
    v_accvgpr_read_b32 v39, a103
    v_cvt_pk_bf16_f32 v36, v36, v37
    v_cvt_pk_bf16_f32 v37, v38, v39
    s_add_u32 s64, s21, s19
    s_add_u32 m0, s78, 4096
    s_nop 0
    buffer_load_dwordx4 v1, s[56:59], s64 offen sc1 lds
    ds_write_b64 v10, v[36:37] offset:9280
    v_accvgpr_read_b32 v40, a104
    v_accvgpr_read_b32 v41, a105
    v_accvgpr_read_b32 v42, a106
    v_accvgpr_read_b32 v43, a107
    v_cvt_pk_bf16_f32 v40, v40, v41
    v_cvt_pk_bf16_f32 v41, v42, v43
    ds_write_b64 v10, v[40:41] offset:20800
    v_accvgpr_read_b32 v44, a108
    v_accvgpr_read_b32 v45, a109
    v_accvgpr_read_b32 v46, a110
    v_accvgpr_read_b32 v47, a111
    v_cvt_pk_bf16_f32 v44, v44, v45
    v_cvt_pk_bf16_f32 v45, v46, v47
    ds_write_b64 v10, v[44:45] offset:30016
    v_accvgpr_read_b32 v32, a112
    v_accvgpr_read_b32 v33, a113
    v_accvgpr_read_b32 v34, a114
    v_accvgpr_read_b32 v35, a115
    v_cvt_pk_bf16_f32 v32, v32, v33
    v_cvt_pk_bf16_f32 v33, v34, v35
    ds_write_b64 v9, v[32:33] offset:96
    buffer_load_dwordx4 v1, s[56:59], s64 offen offset:1024 sc1 lds
    v_accvgpr_read_b32 v36, a116
    v_accvgpr_read_b32 v37, a117
    v_accvgpr_read_b32 v38, a118
    v_accvgpr_read_b32 v39, a119
    v_cvt_pk_bf16_f32 v36, v36, v37
    v_cvt_pk_bf16_f32 v37, v38, v39
    ds_write_b64 v9, v[36:37] offset:9312
    v_accvgpr_read_b32 v40, a120
    v_accvgpr_read_b32 v41, a121
    v_accvgpr_read_b32 v42, a122
    v_accvgpr_read_b32 v43, a123
    v_cvt_pk_bf16_f32 v40, v40, v41
    v_cvt_pk_bf16_f32 v41, v42, v43
    ds_write_b64 v9, v[40:41] offset:20832
    v_accvgpr_read_b32 v44, a124
    v_accvgpr_read_b32 v45, a125
    v_accvgpr_read_b32 v46, a126
    v_accvgpr_read_b32 v47, a127
    v_cvt_pk_bf16_f32 v44, v44, v45
    v_cvt_pk_bf16_f32 v45, v46, v47
    s_waitcnt lgkmcnt(14)
    ds_write_b64 v9, v[44:45] offset:30048
    v_accvgpr_read_b32 v32, a128
    s_add_u32 s64, s21, s20
    s_add_u32 m0, s78, 6144
    s_nop 0
    buffer_load_dwordx4 v1, s[56:59], s64 offen sc1 lds
    v_accvgpr_read_b32 v33, a129
    v_accvgpr_read_b32 v34, a130
    v_accvgpr_read_b32 v35, a131
    v_cvt_pk_bf16_f32 v32, v32, v33
    v_cvt_pk_bf16_f32 v33, v34, v35
    s_waitcnt lgkmcnt(14)
    ds_write_b64 v12, v[32:33] offset:0
    v_accvgpr_read_b32 v36, a132
    v_accvgpr_read_b32 v37, a133
    v_accvgpr_read_b32 v38, a134
    v_accvgpr_read_b32 v39, a135
    v_cvt_pk_bf16_f32 v36, v36, v37
    v_cvt_pk_bf16_f32 v37, v38, v39
    s_cmp_eq_u32 s73, 0
    s_cselect_b64 exec, -1, 0
    s_waitcnt lgkmcnt(14)
    ds_write_b64 v13, v[36:37] offset:32
    s_mov_b64 exec, -1
    s_cmp_lg_u64 s[84:85], 0
    s_cselect_b32 s7, 1, 0
    v_mov_b32 v20, s7
    s_lshl2_add_u32 s98, s4, s79
    v_mov_b32 v21, s98
    s_waitcnt lgkmcnt(14)
    ds_write_b32 v21, v20 offset:41472
    v_mov_b32 v21, s79
    s_waitcnt vmcnt(7)
    s_waitcnt lgkmcnt(0)
    s_barrier
    ds_read_b128 v[24:27], v21 offset:41472
    s_and_b32 s98, s4, 1
    s_lshl_b32 s98, s98, 6
    v_lshrrev_b32 v14, 4, v1
    v_add_u32 v14, s98, v14
    s_lshr_b32 s99, s4, 1
    s_mul_i32 s7, s99, 144
    s_add_u32 s7, s7, 2
    v_add_u32 v2, s7, v14
    v_mul_u32_u24 v2, 144, v2
    v_add_u32 v2, s79, v2
    s_waitcnt lgkmcnt(0)
    v_or3_b32 v24, v24, v25, v26
    v_or_b32 v24, v24, v27
    s_nop 0
    v_readfirstlane_b32 s7, v24
    s_nop 1
    s_andn2_b32 s7, s7, s83
    s_cbranch_scc1 K1_REDO
    v_mov_b32 v31, 2
    buffer_store_dword v31, v30, s[32:35], s101 offen sc1
    s_xor_b32 s21, s3, 1
    s_lshl2_add_u32 s21, s21, s4
    s_mul_i32 s21, s21, 36864
    s_add_u32 s64, s21, s17
    s_add_u32 m0, s78, 28672
    s_nop 0
    buffer_load_dwordx4 v1, s[56:59], s64 offen sc1 lds
    ds_read_b128 v[128:131], v2 offset:2096
    ds_read_b128 v[132:135], v2 offset:2112
    ds_read_b128 v[136:139], v2 offset:2128
    ds_read_b128 v[32:35], v2 offset:2016
    ds_read_b128 v[36:39], v2 offset:2032
    ds_read_b128 v[40:43], v2 offset:2048
    ds_read_b128 v[44:47], v2 offset:1728
    ds_read_b128 v[48:51], v2 offset:1744
    ds_read_b128 v[52:55], v2 offset:1760
    ds_read_b128 v[56:59], v2 offset:1440
    ds_read_b128 v[60:63], v2 offset:1456
    ds_read_b128 v[64:67], v2 offset:1472
    ds_read_b128 v[68:71], v2 offset:1152
    ds_read_b128 v[72:75], v2 offset:1168
    buffer_load_dwordx4 v1, s[56:59], s64 offen offset:1024 sc1 lds
    ds_read_b128 v[76:79], v2 offset:1184
    s_waitcnt lgkmcnt(14)
    ds_read_b128 v[80:83], v2 offset:864
    s_waitcnt lgkmcnt(14)
    ds_read_b128 v[84:87], v2 offset:880
    s_waitcnt lgkmcnt(14)
    ds_read_b128 v[88:91], v2 offset:896
    s_waitcnt lgkmcnt(14)
    ds_read_b128 v[92:95], v2 offset:576
    s_waitcnt lgkmcnt(14)
    ds_read_b128 v[96:99], v2 offset:592
    s_waitcnt lgkmcnt(14)
    ds_read_b128 v[100:103], v2 offset:608
    s_waitcnt lgkmcnt(14)
    ds_read_b128 v[104:107], v2 offset:288
    s_waitcnt lgkmcnt(14)
    ds_read_b128 v[108:111], v2 offset:304
    s_waitcnt lgkmcnt(14)
    ds_read_b128 v[112:115], v2 offset:320
    s_waitcnt lgkmcnt(14)
    ds_read_b128 v[116:119], v2 offset:0
    s_waitcnt lgkmcnt(14)
    ds_read_b128 v[120:123], v2 offset:16
    s_waitcnt lgkmcnt(14)
    ds_read_b128 v[124:127], v2 offset:32
    s_sub_u32 s7, 15, s6
    s_cmp_eq_u32 s99, 0
    s_cselect_b32 s7, s6, s7
    s_add_u32 s64, s21, s18
    s_add_u32 m0, s78, 30720
    s_nop 0
    buffer_load_dwordx4 v1, s[56:59], s64 offen sc1 lds
    s_lshl_b32 s7, s7, 7
    v_add_u32 v14, s7, v14
    v_lshrrev_b32 v15, 4, v14
    s_mov_b32 s98, 155648
    v_mul_lo_u32 v15, v15, s98
    v_and_b32 v23, 0xf0, v1
    v_add_u32 v15, v15, v23
    s_sub_u32 s62, 15, s6
    s_bitcmp1_b32 s5, 2
    s_cselect_b32 s62, s62, s6
    s_lshl2_add_u32 s98, s62, s4
    s_mul_i32 s98, s98, 311296
    v_add_u32 v4, s98, v1
    v_add_u32 v5, 155648, v4
    buffer_load_dwordx4 v1, s[56:59], s64 offen offset:1024 sc1 lds
    s_lshl_b32 s63, s3, 12
    s_lshl2_add_u32 s66, s6, s61
    s_lshl_b32 s66, s66, 10
    v_bfe_u32 v19, v1, 4, 3
    v_lshlrev_b32 v19, 7, v19
    s_add_u32 s48, s32, 1048576
    s_addc_u32 s49, s33, 0
    s_mov_b32 s50, 9437184
    v_mov_b32 v140, 0
    v_mov_b32 v141, 0
    v_mov_b32 v142, 0
    v_mov_b32 v143, 0
    v_mov_b32 v144, 0
    v_mov_b32 v145, 0
    s_add_u32 s64, s21, s19
    s_add_u32 m0, s78, 32768
    s_nop 0
    buffer_load_dwordx4 v1, s[56:59], s64 offen sc1 lds
    v_mov_b32 v146, 0
    v_mov_b32 v147, 0
    v_dot2c_f32_bf16 v140, v128, v32
    v_dot2c_f32_bf16 v141, v128, v44
    v_dot2c_f32_bf16 v142, v128, v56
    s_waitcnt lgkmcnt(14)
    v_dot2c_f32_bf16 v143, v128, v68
    v_dot2c_f32_bf16 v140, v129, v33
    v_dot2c_f32_bf16 v141, v129, v45
    v_dot2c_f32_bf16 v142, v129, v57
    v_dot2c_f32_bf16 v143, v129, v69
    v_dot2c_f32_bf16 v140, v130, v34
    v_dot2c_f32_bf16 v141, v130, v46
    v_dot2c_f32_bf16 v142, v130, v58
    v_dot2c_f32_bf16 v143, v130, v70
    v_dot2c_f32_bf16 v140, v131, v35
    buffer_load_dwordx4 v1, s[56:59], s64 offen offset:1024 sc1 lds
    v_dot2c_f32_bf16 v141, v131, v47
    v_dot2c_f32_bf16 v142, v131, v59
    v_dot2c_f32_bf16 v143, v131, v71
    v_dot2c_f32_bf16 v140, v132, v36
    v_dot2c_f32_bf16 v141, v132, v48
    v_dot2c_f32_bf16 v142, v132, v60
    s_waitcnt lgkmcnt(13)
    v_dot2c_f32_bf16 v143, v132, v72
    v_dot2c_f32_bf16 v140, v133, v37
    v_dot2c_f32_bf16 v141, v133, v49
    v_dot2c_f32_bf16 v142, v133, v61
    v_dot2c_f32_bf16 v143, v133, v73
    v_dot2c_f32_bf16 v140, v134, v38
    v_dot2c_f32_bf16 v141, v134, v50
    v_dot2c_f32_bf16 v142, v134, v62
    v_dot2c_f32_bf16 v143, v134, v74
    s_add_u32 s64, s21, s20
    s_add_u32 m0, s78, 34816
    s_nop 0
    buffer_load_dwordx4 v1, s[56:59], s64 offen sc1 lds
    v_dot2c_f32_bf16 v140, v135, v39
    v_dot2c_f32_bf16 v141, v135, v51
    v_dot2c_f32_bf16 v142, v135, v63
    v_dot2c_f32_bf16 v143, v135, v75
    v_dot2c_f32_bf16 v140, v136, v40
    v_dot2c_f32_bf16 v141, v136, v52
    v_dot2c_f32_bf16 v142, v136, v64
    s_waitcnt lgkmcnt(12)
    v_dot2c_f32_bf16 v143, v136, v76
    ds_read_b128 v[32:35], v2 offset:2064
    ds_read_b128 v[36:39], v2 offset:2080
    ds_read_b128 v[44:47], v2 offset:1776
    s_waitcnt lgkmcnt(14)
    ds_read_b128 v[48:51], v2 offset:1792
    s_waitcnt lgkmcnt(14)
    ds_read_b128 v[56:59], v2 offset:1488
    s_waitcnt lgkmcnt(14)
    ds_read_b128 v[60:63], v2 offset:1504
    s_waitcnt lgkmcnt(14)
    ds_read_b128 v[68:71], v2 offset:1200
    s_xor_b32 s21, s3, 2
    s_lshl2_add_u32 s21, s21, s4
    s_mul_i32 s21, s21, 36864
    s_add_u32 s64, s21, s17
    s_add_u32 m0, s78, 57344
    s_nop 0
    buffer_load_dwordx4 v1, s[56:59], s64 offen sc1 lds
    s_waitcnt lgkmcnt(14)
    ds_read_b128 v[72:75], v2 offset:1216
    v_dot2c_f32_bf16 v144, v128, v80
    v_dot2c_f32_bf16 v145, v128, v92
    s_waitcnt lgkmcnt(13)
    v_dot2c_f32_bf16 v146, v128, v104
    s_waitcnt lgkmcnt(10)
    v_dot2c_f32_bf16 v147, v128, v116
    v_dot2c_f32_bf16 v144, v129, v81
    v_dot2c_f32_bf16 v145, v129, v93
    v_dot2c_f32_bf16 v146, v129, v105
    v_dot2c_f32_bf16 v147, v129, v117
    v_dot2c_f32_bf16 v144, v130, v82
    v_dot2c_f32_bf16 v145, v130, v94
    v_dot2c_f32_bf16 v146, v130, v106
    v_dot2c_f32_bf16 v147, v130, v118
    v_dot2c_f32_bf16 v144, v131, v83
    buffer_load_dwordx4 v1, s[56:59], s64 offen offset:1024 sc1 lds
    v_dot2c_f32_bf16 v145, v131, v95
    v_dot2c_f32_bf16 v146, v131, v107
    v_dot2c_f32_bf16 v147, v131, v119
    v_dot2c_f32_bf16 v144, v132, v84
    v_dot2c_f32_bf16 v145, v132, v96
    v_dot2c_f32_bf16 v146, v132, v108
    s_waitcnt lgkmcnt(9)
    v_dot2c_f32_bf16 v147, v132, v120
    v_dot2c_f32_bf16 v144, v133, v85
    v_dot2c_f32_bf16 v145, v133, v97
    v_dot2c_f32_bf16 v146, v133, v109
    v_dot2c_f32_bf16 v147, v133, v121
    v_dot2c_f32_bf16 v144, v134, v86
    v_dot2c_f32_bf16 v145, v134, v98
    v_dot2c_f32_bf16 v146, v134, v110
    v_dot2c_f32_bf16 v147, v134, v122
    s_add_u32 s64, s21, s18
    s_add_u32 m0, s78, 59392
    s_nop 0
    buffer_load_dwordx4 v1, s[56:59], s64 offen sc1 lds
    v_dot2c_f32_bf16 v144, v135, v87
    v_dot2c_f32_bf16 v145, v135, v99
    v_dot2c_f32_bf16 v146, v135, v111
    v_dot2c_f32_bf16 v147, v135, v123
    v_dot2c_f32_bf16 v144, v136, v88
    v_dot2c_f32_bf16 v145, v136, v100
    v_dot2c_f32_bf16 v146, v136, v112
    s_waitcnt lgkmcnt(8)
    v_dot2c_f32_bf16 v147, v136, v124
    ds_read_b128 v[80:83], v2 offset:912
    ds_read_b128 v[84:87], v2 offset:928
    ds_read_b128 v[92:95], v2 offset:624
    ds_read_b128 v[96:99], v2 offset:640
    ds_read_b128 v[104:107], v2 offset:336
    ds_read_b128 v[108:111], v2 offset:352
    ds_read_b128 v[116:119], v2 offset:48
    buffer_load_dwordx4 v1, s[56:59], s64 offen offset:1024 sc1 lds
    s_waitcnt lgkmcnt(14)
    ds_read_b128 v[120:123], v2 offset:64
    s_mov_b32 s98, 0xbfb8aa3b
    s_mov_b32 s7, 0x3eae1a93
    v_lshlrev_b32 v8, 16, v138
    v_mul_f32 v8, s98, v8
    v_exp_f32 v8, v8
    v_mov_b32 v9, 0xf149f2ca
    v_add_f32 v8, 1.0, v8
    v_rcp_f32 v8, v8
    v_mul_f32 v140, s7, v140
    v_mov_b32 v128, 0
    v_mov_b32 v129, 0
    v_cmp_le_u32 vcc, 2, v14
    v_mul_f32 v141, s7, v141
    s_add_u32 s64, s21, s19
    s_add_u32 m0, s78, 61440
    s_nop 0
    buffer_load_dwordx4 v1, s[56:59], s64 offen sc1 lds
    v_mov_b32 v130, 0
    v_mov_b32 v131, 0
    v_cndmask_b32 v141, v9, v141, vcc
    v_cmp_le_u32 vcc, 4, v14
    v_mul_f32 v142, s7, v142
    v_mov_b32 v132, 0
    v_mov_b32 v133, 0
    v_cndmask_b32 v142, v9, v142, vcc
    v_cmp_le_u32 vcc, 6, v14
    v_mul_f32 v143, s7, v143
    v_mov_b32 v134, 0
    v_mov_b32 v135, 0
    v_cndmask_b32 v143, v9, v143, vcc
    v_cmp_le_u32 vcc, 8, v14
    v_mul_f32 v144, s7, v144
    buffer_load_dwordx4 v1, s[56:59], s64 offen offset:1024 sc1 lds
    v_mov_b32 v136, 0
    v_mov_b32 v137, 0
    v_cndmask_b32 v144, v9, v144, vcc
    v_cmp_le_u32 vcc, 10, v14
    v_mul_f32 v145, s7, v145
    v_mov_b32 v138, 0
    v_mov_b32 v139, 0
    v_cndmask_b32 v145, v9, v145, vcc
    v_cmp_le_u32 vcc, 12, v14
    v_mul_f32 v146, s7, v146
    v_mov_b32 v156, 0
    v_mov_b32 v157, 0
    v_cndmask_b32 v146, v9, v146, vcc
    v_cmp_le_u32 vcc, 14, v14
    v_mul_f32 v147, s7, v147
    s_add_u32 s64, s21, s20
    s_add_u32 m0, s78, 63488
    s_nop 0
    buffer_load_dwordx4 v1, s[56:59], s64 offen sc1 lds
    v_mov_b32 v158, 0
    v_mov_b32 v159, 0
    v_cndmask_b32 v147, v9, v147, vcc
    v_max3_f32 v9, v140, v141, v142
    v_max3_f32 v10, v143, v144, v145
    v_max3_f32 v9, v9, v146, v147
    v_max_f32 v9, v9, v10
    v_sub_f32 v140, v140, v9
    v_sub_f32 v141, v141, v9
    v_sub_f32 v142, v142, v9
    v_sub_f32 v143, v143, v9
    v_sub_f32 v144, v144, v9
    v_sub_f32 v145, v145, v9
    v_sub_f32 v146, v146, v9
    v_sub_f32 v147, v147, v9
    buffer_load_dword v3, v19, s[32:35], s66 offen sc1
    s_xor_b32 s21, s3, 3
    s_lshl2_add_u32 s21, s21, s4
    s_mul_i32 s21, s21, 36864
    s_add_u32 s64, s21, s17
    s_add_u32 m0, s78, 86016
    s_nop 0
    buffer_load_dwordx4 v1, s[56:59], s64 offen sc1 lds
    v_exp_f32 v140, v140
    v_exp_f32 v141, v141
    v_exp_f32 v142, v142
    v_exp_f32 v143, v143
    v_exp_f32 v144, v144
    v_exp_f32 v145, v145
    buffer_load_dwordx4 v1, s[56:59], s64 offen offset:1024 sc1 lds
    v_exp_f32 v146, v146
    v_exp_f32 v147, v147
    v_add_f32 v10, v140, v141
    v_add_f32 v10, v10, v142
    v_add_f32 v10, v10, v143
    v_add_f32 v10, v10, v144
    s_add_u32 s64, s21, s18
    s_add_u32 m0, s78, 88064
    s_nop 0
    buffer_load_dwordx4 v1, s[56:59], s64 offen sc1 lds
    v_add_f32 v10, v10, v145
    v_add_f32 v10, v10, v146
    v_add_f32 v10, v10, v147
    v_rcp_f32 v10, v10
    v_mov_b32 v17, 0
    v_mov_b32 v18, 0
    buffer_load_dwordx4 v1, s[56:59], s64 offen offset:1024 sc1 lds
    v_mul_f32 v140, v140, v10
    v_mul_f32 v141, v141, v10
    v_mul_f32 v142, v142, v10
    v_mul_f32 v143, v143, v10
    v_mul_f32 v144, v144, v10
    v_mul_f32 v145, v145, v10
    s_add_u32 s64, s21, s19
    s_add_u32 m0, s78, 90112
    s_nop 0
    buffer_load_dwordx4 v1, s[56:59], s64 offen sc1 lds
    v_mul_f32 v146, v146, v10
    v_mul_f32 v147, v147, v10
    v_cvt_pk_bf16_f32 v148, 0, v140
    v_cvt_pk_bf16_f32 v149, 0, v141
    v_cvt_pk_bf16_f32 v150, 0, v142
    v_cvt_pk_bf16_f32 v151, 0, v143
    buffer_load_dwordx4 v1, s[56:59], s64 offen offset:1024 sc1 lds
    v_cvt_pk_bf16_f32 v152, 0, v144
    v_cvt_pk_bf16_f32 v153, 0, v145
    v_cvt_pk_bf16_f32 v154, 0, v146
    v_cvt_pk_bf16_f32 v155, 0, v147
    v_lshrrev_b32 v140, 16, v148
    v_lshrrev_b32 v141, 16, v149
    s_add_u32 s64, s21, s20
    s_add_u32 m0, s78, 92160
    s_nop 0
    buffer_load_dwordx4 v1, s[56:59], s64 offen sc1 lds
    v_lshrrev_b32 v142, 16, v150
    v_lshrrev_b32 v143, 16, v151
    v_lshrrev_b32 v144, 16, v152
    v_lshrrev_b32 v145, 16, v153
    v_lshrrev_b32 v146, 16, v154
    v_lshrrev_b32 v147, 16, v155
    s_waitcnt vmcnt(7)
    v_cmp_gt_u32 vcc, 2, v3
    s_nop 1
    s_and_b64 vcc, vcc, exec
    s_cbranch_scc1 SPIN_CTX
BACK_CTX:
    buffer_load_dwordx4 a[0:3], v4, s[40:43], s63 offen offset:0 sc1
    v_dot2c_f32_bf16 v128, v42, v140
    v_dot2c_f32_bf16 v129, v42, v148
    v_dot2c_f32_bf16 v130, v43, v140
    v_dot2c_f32_bf16 v131, v43, v148
    v_dot2c_f32_bf16 v132, v32, v140
    v_dot2c_f32_bf16 v133, v32, v148
    v_dot2c_f32_bf16 v134, v33, v140
    v_dot2c_f32_bf16 v135, v33, v148
    buffer_load_dwordx4 a[4:7], v5, s[40:43], s63 offen offset:0 sc1
    v_dot2c_f32_bf16 v136, v34, v140
    v_dot2c_f32_bf16 v137, v34, v148
    v_dot2c_f32_bf16 v138, v35, v140
    v_dot2c_f32_bf16 v139, v35, v148
    s_waitcnt lgkmcnt(14)
    v_dot2c_f32_bf16 v156, v36, v140
    v_dot2c_f32_bf16 v157, v36, v148
    v_dot2c_f32_bf16 v158, v37, v140
    v_dot2c_f32_bf16 v159, v37, v148
    buffer_load_dwordx4 a[8:11], v4, s[40:43], s63 offen offset:1024 sc1
    v_dot2c_f32_bf16 v17, v38, v140
    v_dot2c_f32_bf16 v18, v38, v148
    v_dot2c_f32_bf16 v128, v54, v141
    v_dot2c_f32_bf16 v129, v54, v149
    v_dot2c_f32_bf16 v130, v55, v141
    v_dot2c_f32_bf16 v131, v55, v149
    s_waitcnt lgkmcnt(13)
    v_dot2c_f32_bf16 v132, v44, v141
    v_dot2c_f32_bf16 v133, v44, v149
    buffer_load_dwordx4 a[12:15], v5, s[40:43], s63 offen offset:1024 sc1
    v_dot2c_f32_bf16 v134, v45, v141
    v_dot2c_f32_bf16 v135, v45, v149
    v_dot2c_f32_bf16 v136, v46, v141
    v_dot2c_f32_bf16 v137, v46, v149
    v_dot2c_f32_bf16 v138, v47, v141
    v_dot2c_f32_bf16 v139, v47, v149
    s_waitcnt lgkmcnt(12)
    v_dot2c_f32_bf16 v156, v48, v141
    v_dot2c_f32_bf16 v157, v48, v149
    v_dot2c_f32_bf16 v158, v49, v141
    buffer_load_dwordx4 a[16:19], v4, s[40:43], s63 offen offset:2048 sc1
    v_dot2c_f32_bf16 v159, v49, v149
    v_dot2c_f32_bf16 v17, v50, v141
    v_dot2c_f32_bf16 v18, v50, v149
    v_dot2c_f32_bf16 v128, v66, v142
    v_dot2c_f32_bf16 v129, v66, v150
    v_dot2c_f32_bf16 v130, v67, v142
    v_dot2c_f32_bf16 v131, v67, v150
    s_waitcnt lgkmcnt(11)
    v_dot2c_f32_bf16 v132, v56, v142
    buffer_load_dwordx4 a[20:23], v5, s[40:43], s63 offen offset:2048 sc1
    v_dot2c_f32_bf16 v133, v56, v150
    v_dot2c_f32_bf16 v134, v57, v142
    v_dot2c_f32_bf16 v135, v57, v150
    v_dot2c_f32_bf16 v136, v58, v142
    v_dot2c_f32_bf16 v137, v58, v150
    v_dot2c_f32_bf16 v138, v59, v142
    v_dot2c_f32_bf16 v139, v59, v150
    s_waitcnt lgkmcnt(10)
    v_dot2c_f32_bf16 v156, v60, v142
    buffer_load_dwordx4 a[24:27], v4, s[40:43], s63 offen offset:3072 sc1
    v_dot2c_f32_bf16 v157, v60, v150
    v_dot2c_f32_bf16 v158, v61, v142
    v_dot2c_f32_bf16 v159, v61, v150
    v_dot2c_f32_bf16 v17, v62, v142
    v_dot2c_f32_bf16 v18, v62, v150
    v_dot2c_f32_bf16 v128, v78, v143
    v_dot2c_f32_bf16 v129, v78, v151
    v_dot2c_f32_bf16 v130, v79, v143
    buffer_load_dwordx4 a[28:31], v5, s[40:43], s63 offen offset:3072 sc1
    v_dot2c_f32_bf16 v131, v79, v151
    s_waitcnt lgkmcnt(9)
    v_dot2c_f32_bf16 v132, v68, v143
    v_dot2c_f32_bf16 v133, v68, v151
    v_dot2c_f32_bf16 v134, v69, v143
    v_dot2c_f32_bf16 v135, v69, v151
    v_dot2c_f32_bf16 v136, v70, v143
    v_dot2c_f32_bf16 v137, v70, v151
    v_dot2c_f32_bf16 v138, v71, v143
    v_dot2c_f32_bf16 v139, v71, v151
    s_xor_b32 s63, s63, 4096
    buffer_load_dwordx4 a[32:35], v4, s[40:43], s63 offen offset:0 sc1
    s_waitcnt lgkmcnt(8)
    v_dot2c_f32_bf16 v156, v72, v143
    v_dot2c_f32_bf16 v157, v72, v151
    v_dot2c_f32_bf16 v158, v73, v143
    v_dot2c_f32_bf16 v159, v73, v151
    v_dot2c_f32_bf16 v17, v74, v143
    v_dot2c_f32_bf16 v18, v74, v151
    v_dot2c_f32_bf16 v128, v90, v144
    v_dot2c_f32_bf16 v129, v90, v152
    buffer_load_dwordx4 a[36:39], v5, s[40:43], s63 offen offset:0 sc1
    v_dot2c_f32_bf16 v130, v91, v144
    v_dot2c_f32_bf16 v131, v91, v152
    s_waitcnt lgkmcnt(7)
    v_dot2c_f32_bf16 v132, v80, v144
    v_dot2c_f32_bf16 v133, v80, v152
    v_dot2c_f32_bf16 v134, v81, v144
    v_dot2c_f32_bf16 v135, v81, v152
    v_dot2c_f32_bf16 v136, v82, v144
    v_dot2c_f32_bf16 v137, v82, v152
    buffer_load_dwordx4 a[40:43], v4, s[40:43], s63 offen offset:1024 sc1
    v_dot2c_f32_bf16 v138, v83, v144
    v_dot2c_f32_bf16 v139, v83, v152
    s_waitcnt lgkmcnt(6)
    v_dot2c_f32_bf16 v156, v84, v144
    v_dot2c_f32_bf16 v157, v84, v152
    v_dot2c_f32_bf16 v158, v85, v144
    v_dot2c_f32_bf16 v159, v85, v152
    v_dot2c_f32_bf16 v17, v86, v144
    v_dot2c_f32_bf16 v18, v86, v152
    buffer_load_dwordx4 a[44:47], v5, s[40:43], s63 offen offset:1024 sc1
    v_dot2c_f32_bf16 v128, v102, v145
    v_dot2c_f32_bf16 v129, v102, v153
    v_dot2c_f32_bf16 v130, v103, v145
    v_dot2c_f32_bf16 v131, v103, v153
    s_waitcnt lgkmcnt(5)
    v_dot2c_f32_bf16 v132, v92, v145
    v_dot2c_f32_bf16 v133, v92, v153
    v_dot2c_f32_bf16 v134, v93, v145
    v_dot2c_f32_bf16 v135, v93, v153
    v_dot2c_f32_bf16 v136, v94, v145
    buffer_load_dwordx4 a[48:51], v4, s[40:43], s63 offen offset:2048 sc1
    v_dot2c_f32_bf16 v137, v94, v153
    v_dot2c_f32_bf16 v138, v95, v145
    v_dot2c_f32_bf16 v139, v95, v153
    s_waitcnt lgkmcnt(4)
    v_dot2c_f32_bf16 v156, v96, v145
    v_dot2c_f32_bf16 v157, v96, v153
    v_dot2c_f32_bf16 v158, v97, v145
    v_dot2c_f32_bf16 v159, v97, v153
    v_dot2c_f32_bf16 v17, v98, v145
    buffer_load_dwordx4 a[52:55], v5, s[40:43], s63 offen offset:2048 sc1
    v_dot2c_f32_bf16 v18, v98, v153
    v_dot2c_f32_bf16 v128, v114, v146
    v_dot2c_f32_bf16 v129, v114, v154
    v_dot2c_f32_bf16 v130, v115, v146
    v_dot2c_f32_bf16 v131, v115, v154
    s_waitcnt lgkmcnt(3)
    v_dot2c_f32_bf16 v132, v104, v146
    v_dot2c_f32_bf16 v133, v104, v154
    v_dot2c_f32_bf16 v134, v105, v146
    buffer_load_dwordx4 a[56:59], v4, s[40:43], s63 offen offset:3072 sc1
    v_dot2c_f32_bf16 v135, v105, v154
    v_dot2c_f32_bf16 v136, v106, v146
    v_dot2c_f32_bf16 v137, v106, v154
    v_dot2c_f32_bf16 v138, v107, v146
    v_dot2c_f32_bf16 v139, v107, v154
    s_waitcnt lgkmcnt(2)
    v_dot2c_f32_bf16 v156, v108, v146
    v_dot2c_f32_bf16 v157, v108, v154
    v_dot2c_f32_bf16 v158, v109, v146
    buffer_load_dwordx4 a[60:63], v5, s[40:43], s63 offen offset:3072 sc1
    s_xor_b32 s63, s63, 12288
    v_dot2c_f32_bf16 v159, v109, v154
    v_dot2c_f32_bf16 v17, v110, v146
    v_dot2c_f32_bf16 v18, v110, v154
    v_dot2c_f32_bf16 v128, v126, v147
    v_dot2c_f32_bf16 v129, v126, v155
    v_dot2c_f32_bf16 v130, v127, v147
    v_dot2c_f32_bf16 v131, v127, v155
    s_waitcnt lgkmcnt(1)
    v_dot2c_f32_bf16 v132, v116, v147
    v_dot2c_f32_bf16 v133, v116, v155
    v_dot2c_f32_bf16 v134, v117, v147
    v_dot2c_f32_bf16 v135, v117, v155
    v_dot2c_f32_bf16 v136, v118, v147
    v_dot2c_f32_bf16 v137, v118, v155
    v_dot2c_f32_bf16 v138, v119, v147
    v_dot2c_f32_bf16 v139, v119, v155
    s_waitcnt lgkmcnt(0)
    v_dot2c_f32_bf16 v156, v120, v147
    v_dot2c_f32_bf16 v157, v120, v155
    v_dot2c_f32_bf16 v158, v121, v147
    v_dot2c_f32_bf16 v159, v121, v155
    v_dot2c_f32_bf16 v17, v122, v147
    v_dot2c_f32_bf16 v18, v122, v155
    v_mul_f32 v128, v8, v128
    v_mul_f32 v129, v8, v129
    v_mul_f32 v130, v8, v130
    v_mul_f32 v131, v8, v131
    v_mul_f32 v132, v8, v132
    v_mul_f32 v133, v8, v133
    v_mul_f32 v134, v8, v134
    v_mul_f32 v135, v8, v135
    v_mul_f32 v136, v8, v136
    v_mul_f32 v137, v8, v137
    v_mul_f32 v138, v8, v138
    v_mul_f32 v139, v8, v139
    v_mul_f32 v156, v8, v156
    v_mul_f32 v157, v8, v157
    v_mul_f32 v158, v8, v158
    v_mul_f32 v159, v8, v159
    v_mul_f32 v17, v8, v17
    v_mul_f32 v18, v8, v18
    v_cvt_pk_bf16_f32 v80, v128, v129
    v_cvt_pk_bf16_f32 v81, v130, v131
    v_cvt_pk_bf16_f32 v82, v132, v133
    v_cvt_pk_bf16_f32 v83, v134, v135
    v_cvt_pk_bf16_f32 v84, v136, v137
    v_cvt_pk_bf16_f32 v85, v138, v139
    v_cvt_pk_bf16_f32 v86, v156, v157
    v_cvt_pk_bf16_f32 v87, v158, v159
    v_cvt_pk_bf16_f32 v88, v17, v18
    v_mov_b32 v89, 0
    v_mov_b32 v90, 0
    v_mov_b32 v91, 0
    s_mul_i32 s98, s5, 768
    s_add_u32 s98, s98, 131072
    buffer_store_dwordx4 v[80:83], v15, s[40:43], s98 offen offset:0 sc1
    buffer_store_dwordx4 v[84:87], v15, s[40:43], s98 offen offset:256 sc1
    buffer_store_dwordx4 v[88:91], v15, s[40:43], s98 offen offset:512 sc1
    v_mov_b32 v8, v1
    v_add_u32 v9, 0x10000, v1
    v_add_u32 v10, 0x20000, v1
    s_waitcnt vmcnt(11)
    s_barrier
    ds_read_b128 v[104:107], v8 offset:0
    ds_read_b128 v[108:111], v8 offset:7168
    ds_read_b128 v[112:115], v8 offset:1024
    ds_read_b128 v[116:119], v8 offset:8192
    s_waitcnt lgkmcnt(3)
    v_mfma_f32_16x16x32_bf16 v[176:179], v[104:107], a[0:3], 0
    s_lshl3_add_u32 s98, 1, s5
    ds_read_b128 v[120:123], v8 offset:2048
    ds_read_b128 v[124:127], v8 offset:9216
    s_waitcnt lgkmcnt(4)
    v_mfma_f32_16x16x32_bf16 v[176:179], v[108:111], a[8:11], v[176:179]
    s_and_b32 s98, s98, 31
    buffer_load_dwordx4 a[64:67], v4, s[40:43], s63 offen offset:0 sc1
    v_mfma_f32_16x16x32_bf16 v[180:183], v[104:107], a[4:7], 0
    s_lshl_b32 s8, s6, 5
    ds_read_b128 v[128:131], v8 offset:3072
    ds_read_b128 v[132:135], v8 offset:10240
    v_mfma_f32_16x16x32_bf16 v[180:183], v[108:111], a[12:15], v[180:183]
    s_add_u32 s98, s98, s8
    ds_read_b128 v[136:139], v8 offset:4096
    s_waitcnt lgkmcnt(6)
    v_mfma_f32_16x16x32_bf16 v[184:187], v[112:115], a[0:3], 0
    s_mul_i32 s98, s98, 3
    buffer_load_dwordx4 a[68:71], v5, s[40:43], s63 offen offset:0 sc1
    s_waitcnt lgkmcnt(5)
    v_mfma_f32_16x16x32_bf16 v[184:187], v[116:119], a[8:11], v[184:187]
    s_sub_u32 s98, s98, 1
    ds_read_b128 v[140:143], v8 offset:11264
    ds_read_b128 v[144:147], v8 offset:5120
    v_mfma_f32_16x16x32_bf16 v[188:191], v[112:115], a[4:7], 0
    s_add_u32 s98, s98, 3
    ds_read_b128 v[148:151], v8 offset:12288
    v_mfma_f32_16x16x32_bf16 v[188:191], v[116:119], a[12:15], v[188:191]
    s_lshl2_add_u32 s98, s98, s4
    ds_read_b128 v[104:107], v8 offset:6144
    s_waitcnt lgkmcnt(5)
    v_mfma_f32_16x16x32_bf16 v[192:195], v[120:123], a[0:3], 0
    s_mul_i32 s8, s98, 3072
    buffer_load_dwordx4 a[72:75], v4, s[40:43], s63 offen offset:1024 sc1
    v_mfma_f32_16x16x32_bf16 v[192:195], v[124:127], a[8:11], v[192:195]
    s_lshl3_add_u32 s98, 2, s5
    ds_read_b128 v[108:111], v8 offset:13312
    ds_read_b128 v[112:115], v8 offset:14336
    v_mfma_f32_16x16x32_bf16 v[196:199], v[120:123], a[4:7], 0
    s_and_b32 s98, s98, 31
    ds_read_b128 v[116:119], v8 offset:21504
    v_mfma_f32_16x16x32_bf16 v[196:199], v[124:127], a[12:15], v[196:199]
    s_lshl_b32 s9, s6, 5
    ds_read_b128 v[120:123], v8 offset:15360
    v_mfma_f32_16x16x32_bf16 v[200:203], v[128:131], a[0:3], 0
    s_add_u32 s98, s98, s9
    buffer_load_dwordx4 a[76:79], v5, s[40:43], s63 offen offset:1024 sc1
    v_mfma_f32_16x16x32_bf16 v[200:203], v[132:135], a[8:11], v[200:203]
    s_mul_i32 s98, s98, 3
    ds_read_b128 v[124:127], v8 offset:22528
    v_mfma_f32_16x16x32_bf16 v[204:207], v[128:131], a[4:7], 0
    s_sub_u32 s98, s98, 2
    ds_read_b128 v[128:131], v8 offset:16384
    v_mfma_f32_16x16x32_bf16 v[204:207], v[132:135], a[12:15], v[204:207]
    s_add_u32 s98, s98, 3
    ds_read_b128 v[132:135], v8 offset:23552
    s_waitcnt lgkmcnt(4)
    v_mfma_f32_16x16x32_bf16 v[208:211], v[136:139], a[0:3], 0
    s_lshl2_add_u32 s98, s98, s4
    buffer_load_dwordx4 a[80:83], v4, s[40:43], s63 offen offset:2048 sc1
    v_mfma_f32_16x16x32_bf16 v[208:211], v[140:143], a[8:11], v[208:211]
    s_mul_i32 s9, s98, 3072
    v_mfma_f32_16x16x32_bf16 v[212:215], v[136:139], a[4:7], 0
    s_lshl3_add_u32 s98, 3, s5
    ds_read_b128 v[136:139], v8 offset:17408
    v_mfma_f32_16x16x32_bf16 v[212:215], v[140:143], a[12:15], v[212:215]
    s_and_b32 s98, s98, 31
    ds_read_b128 v[140:143], v8 offset:24576
    v_mfma_f32_16x16x32_bf16 v[216:219], v[144:147], a[0:3], 0
    s_lshl_b32 s10, s6, 5
    v_mfma_f32_16x16x32_bf16 v[216:219], v[148:151], a[8:11], v[216:219]
    s_add_u32 s98, s98, s10
    buffer_load_dwordx4 a[84:87], v5, s[40:43], s63 offen offset:2048 sc1
    v_mfma_f32_16x16x32_bf16 v[220:223], v[144:147], a[4:7], 0
    s_mul_i32 s98, s98, 3
    ds_read_b128 v[144:147], v8 offset:18432
    v_mfma_f32_16x16x32_bf16 v[220:223], v[148:151], a[12:15], v[220:223]
    s_sub_u32 s98, s98, 3
    ds_read_b128 v[148:151], v8 offset:25600
    v_mfma_f32_16x16x32_bf16 v[224:227], v[104:107], a[0:3], 0
    s_add_u32 s98, s98, 3
    v_mfma_f32_16x16x32_bf16 v[224:227], v[108:111], a[8:11], v[224:227]
    s_lshl2_add_u32 s98, s98, s4
    buffer_load_dwordx4 a[88:91], v4, s[40:43], s63 offen offset:3072 sc1
    v_mfma_f32_16x16x32_bf16 v[228:231], v[104:107], a[4:7], 0
    s_mul_i32 s10, s98, 3072
    ds_read_b128 v[104:107], v8 offset:19456
    v_mfma_f32_16x16x32_bf16 v[228:231], v[108:111], a[12:15], v[228:231]
    s_sub_u32 s99, s4, s61
    ds_read_b128 v[108:111], v8 offset:26624
    v_mfma_f32_16x16x32_bf16 v[176:179], v[112:115], a[16:19], v[176:179]
    s_and_b32 s99, s99, 3
    v_mfma_f32_16x16x32_bf16 v[176:179], v[116:119], a[24:27], v[176:179]
    s_lshl3_add_u32 s98, s99, s5
    buffer_load_dwordx4 a[92:95], v5, s[40:43], s63 offen offset:3072 sc1
    v_mfma_f32_16x16x32_bf16 v[180:183], v[112:115], a[20:23], v[180:183]
    s_xor_b32 s63, s63, 4096
    ds_read_b128 v[112:115], v8 offset:20480
    v_mfma_f32_16x16x32_bf16 v[180:183], v[116:119], a[28:31], v[180:183]
    s_and_b32 s98, s98, 31
    ds_read_b128 v[116:119], v8 offset:27648
    s_waitcnt lgkmcnt(3)
    v_mfma_f32_16x16x32_bf16 v[184:187], v[120:123], a[16:19], v[184:187]
    s_lshl_b32 s11, s6, 5
    v_mfma_f32_16x16x32_bf16 v[184:187], v[124:127], a[24:27], v[184:187]
    s_add_u32 s98, s98, s11
    buffer_load_dwordx4 a[96:99], v4, s[40:43], s63 offen offset:0 sc1
    v_mfma_f32_16x16x32_bf16 v[188:191], v[120:123], a[20:23], v[188:191]
    s_mul_i32 s98, s98, 3
    ds_read_b128 v[120:123], v8 offset:28672
    v_mfma_f32_16x16x32_bf16 v[188:191], v[124:127], a[28:31], v[188:191]
    s_sub_u32 s98, s98, s99
    ds_read_b128 v[124:127], v8 offset:35840
    v_mfma_f32_16x16x32_bf16 v[192:195], v[128:131], a[16:19], v[192:195]
    s_add_u32 s98, s98, 3
    v_mfma_f32_16x16x32_bf16 v[192:195], v[132:135], a[24:27], v[192:195]
    s_lshl2_add_u32 s98, s98, s4
    buffer_load_dwordx4 a[100:103], v5, s[40:43], s63 offen offset:0 sc1
    v_mfma_f32_16x16x32_bf16 v[196:199], v[128:131], a[20:23], v[196:199]
    s_mul_i32 s11, s98, 3072
    ds_read_b128 v[128:131], v8 offset:29696
    v_mfma_f32_16x16x32_bf16 v[196:199], v[132:135], a[28:31], v[196:199]
    ds_read_b128 v[132:135], v8 offset:36864
    v_mfma_f32_16x16x32_bf16 v[200:203], v[136:139], a[16:19], v[200:203]
    s_cmp_eq_u32 s99, 0
    s_cselect_b32 s11, 1073741824, s11
    v_mfma_f32_16x16x32_bf16 v[200:203], v[140:143], a[24:27], v[200:203]
    v_mfma_f32_16x16x32_bf16 v[204:207], v[136:139], a[20:23], v[204:207]
    buffer_load_dwordx4 a[104:107], v4, s[40:43], s63 offen offset:1024 sc1
    v_mfma_f32_16x16x32_bf16 v[204:207], v[140:143], a[28:31], v[204:207]
    s_waitcnt vmcnt(14)
    ds_read_b128 v[136:139], v8 offset:30720
    ds_read_b128 v[140:143], v8 offset:37888
    v_mfma_f32_16x16x32_bf16 v[208:211], v[144:147], a[16:19], v[208:211]
    v_mfma_f32_16x16x32_bf16 v[208:211], v[148:151], a[24:27], v[208:211]
    v_mfma_f32_16x16x32_bf16 v[212:215], v[144:147], a[20:23], v[212:215]
    buffer_load_dwordx4 a[108:111], v5, s[40:43], s63 offen offset:1024 sc1
    v_mfma_f32_16x16x32_bf16 v[212:215], v[148:151], a[28:31], v[212:215]
    ds_read_b128 v[144:147], v8 offset:31744
    ds_read_b128 v[148:151], v8 offset:38912
    v_mfma_f32_16x16x32_bf16 v[216:219], v[104:107], a[16:19], v[216:219]
    s_waitcnt lgkmcnt(2)
    v_mfma_f32_16x16x32_bf16 v[216:219], v[108:111], a[24:27], v[216:219]
    v_mfma_f32_16x16x32_bf16 v[220:223], v[104:107], a[20:23], v[220:223]
    buffer_load_dwordx4 a[112:115], v4, s[40:43], s63 offen offset:2048 sc1
    v_mfma_f32_16x16x32_bf16 v[220:223], v[108:111], a[28:31], v[220:223]
    ds_read_b128 v[104:107], v8 offset:32768
    ds_read_b128 v[108:111], v8 offset:39936
    v_mfma_f32_16x16x32_bf16 v[224:227], v[112:115], a[16:19], v[224:227]
    v_mfma_f32_16x16x32_bf16 v[224:227], v[116:119], a[24:27], v[224:227]
    v_mfma_f32_16x16x32_bf16 v[228:231], v[112:115], a[20:23], v[228:231]
    buffer_load_dwordx4 a[116:119], v5, s[40:43], s63 offen offset:2048 sc1
    v_mfma_f32_16x16x32_bf16 v[228:231], v[116:119], a[28:31], v[228:231]
    ds_read_b128 v[112:115], v8 offset:33792
    ds_read_b128 v[116:119], v8 offset:40960
    v_mfma_f32_16x16x32_bf16 v[176:179], v[120:123], a[32:35], v[176:179]
    v_mfma_f32_16x16x32_bf16 v[176:179], v[124:127], a[40:43], v[176:179]
    v_mfma_f32_16x16x32_bf16 v[180:183], v[120:123], a[36:39], v[180:183]
    buffer_load_dwordx4 a[120:123], v4, s[40:43], s63 offen offset:3072 sc1
    v_mfma_f32_16x16x32_bf16 v[180:183], v[124:127], a[44:47], v[180:183]
    ds_read_b128 v[120:123], v8 offset:34816
    ds_read_b128 v[124:127], v8 offset:41984
    v_mfma_f32_16x16x32_bf16 v[184:187], v[128:131], a[32:35], v[184:187]
    v_mfma_f32_16x16x32_bf16 v[184:187], v[132:135], a[40:43], v[184:187]
    v_mfma_f32_16x16x32_bf16 v[188:191], v[128:131], a[36:39], v[188:191]
    ds_read_b128 v[128:131], v8 offset:43008
    v_mfma_f32_16x16x32_bf16 v[188:191], v[132:135], a[44:47], v[188:191]
    buffer_load_dwordx4 a[124:127], v5, s[40:43], s63 offen offset:3072 sc1
    v_mfma_f32_16x16x32_bf16 v[192:195], v[136:139], a[32:35], v[192:195]
    s_xor_b32 s21, s3, 4
    ds_read_b128 v[132:135], v8 offset:50176
    v_mfma_f32_16x16x32_bf16 v[192:195], v[140:143], a[40:43], v[192:195]
    s_lshl2_add_u32 s21, s21, s4
    v_mfma_f32_16x16x32_bf16 v[196:199], v[136:139], a[36:39], v[196:199]
    s_mul_i32 s21, s21, 36864
    ds_read_b128 v[136:139], v8 offset:44032
    v_mfma_f32_16x16x32_bf16 v[196:199], v[140:143], a[44:47], v[196:199]
    s_add_u32 s64, s21, s17
    s_add_u32 m0, s78, 114688
    ds_read_b128 v[140:143], v8 offset:51200
    s_waitcnt lgkmcnt(3)
    v_mfma_f32_16x16x32_bf16 v[200:203], v[144:147], a[32:35], v[200:203]
    s_xor_b32 s63, s63, 28672
    buffer_load_dwordx4 v1, s[56:59], s64 offen sc1 lds
    v_mfma_f32_16x16x32_bf16 v[200:203], v[148:151], a[40:43], v[200:203]
    v_mfma_f32_16x16x32_bf16 v[204:207], v[144:147], a[36:39], v[204:207]
    ds_read_b128 v[144:147], v8 offset:45056
    v_mfma_f32_16x16x32_bf16 v[204:207], v[148:151], a[44:47], v[204:207]
    buffer_load_dwordx4 v1, s[56:59], s64 offen offset:1024 sc1 lds
    v_mfma_f32_16x16x32_bf16 v[208:211], v[104:107], a[32:35], v[208:211]
    s_add_u32 s64, s21, s18
    ds_read_b128 v[148:151], v8 offset:52224
    v_mfma_f32_16x16x32_bf16 v[208:211], v[108:111], a[40:43], v[208:211]
    s_add_u32 m0, s78, 116736
    v_mfma_f32_16x16x32_bf16 v[212:215], v[104:107], a[36:39], v[212:215]
    ds_read_b128 v[104:107], v8 offset:46080
    v_mfma_f32_16x16x32_bf16 v[212:215], v[108:111], a[44:47], v[212:215]
    buffer_load_dwordx4 v1, s[56:59], s64 offen sc1 lds
    v_mfma_f32_16x16x32_bf16 v[216:219], v[112:115], a[32:35], v[216:219]
    ds_read_b128 v[108:111], v8 offset:53248
    v_mfma_f32_16x16x32_bf16 v[216:219], v[116:119], a[40:43], v[216:219]
    v_mfma_f32_16x16x32_bf16 v[220:223], v[112:115], a[36:39], v[220:223]
    ds_read_b128 v[112:115], v8 offset:47104
    v_mfma_f32_16x16x32_bf16 v[220:223], v[116:119], a[44:47], v[220:223]
    buffer_load_dwordx4 v1, s[56:59], s64 offen offset:1024 sc1 lds
    v_mfma_f32_16x16x32_bf16 v[224:227], v[120:123], a[32:35], v[224:227]
    ds_read_b128 v[116:119], v8 offset:54272
    v_mfma_f32_16x16x32_bf16 v[224:227], v[124:127], a[40:43], v[224:227]
    s_add_u32 s64, s21, s19
    v_mfma_f32_16x16x32_bf16 v[228:231], v[120:123], a[36:39], v[228:231]
    s_add_u32 m0, s78, 118784
    ds_read_b128 v[120:123], v8 offset:48128
    v_mfma_f32_16x16x32_bf16 v[228:231], v[124:127], a[44:47], v[228:231]
    ds_read_b128 v[124:127], v8 offset:55296
    v_mfma_f32_16x16x32_bf16 v[176:179], v[128:131], a[48:51], v[176:179]
    s_waitcnt lgkmcnt(3)
    buffer_load_dwordx4 v1, s[56:59], s64 offen sc1 lds
    v_mfma_f32_16x16x32_bf16 v[176:179], v[132:135], a[56:59], v[176:179]
    v_mfma_f32_16x16x32_bf16 v[180:183], v[128:131], a[52:55], v[180:183]
    ds_read_b128 v[128:131], v8 offset:49152
    v_mfma_f32_16x16x32_bf16 v[180:183], v[132:135], a[60:63], v[180:183]
    ds_read_b128 v[132:135], v8 offset:56320
    v_mfma_f32_16x16x32_bf16 v[184:187], v[136:139], a[48:51], v[184:187]
    buffer_load_dwordx4 v1, s[56:59], s64 offen offset:1024 sc1 lds
    v_mfma_f32_16x16x32_bf16 v[184:187], v[140:143], a[56:59], v[184:187]
    s_add_u32 s64, s21, s20
    v_mfma_f32_16x16x32_bf16 v[188:191], v[136:139], a[52:55], v[188:191]
    s_add_u32 m0, s78, 120832
    ds_read_b128 v[136:139], v8 offset:57344
    v_mfma_f32_16x16x32_bf16 v[188:191], v[140:143], a[60:63], v[188:191]
    ds_read_b128 v[140:143], v8 offset:64512
    v_mfma_f32_16x16x32_bf16 v[192:195], v[144:147], a[48:51], v[192:195]
    buffer_load_dwordx4 v1, s[56:59], s64 offen sc1 lds
    v_mfma_f32_16x16x32_bf16 v[192:195], v[148:151], a[56:59], v[192:195]
    v_mfma_f32_16x16x32_bf16 v[196:199], v[144:147], a[52:55], v[196:199]
    ds_read_b128 v[144:147], v8 offset:58368
    v_mfma_f32_16x16x32_bf16 v[196:199], v[148:151], a[60:63], v[196:199]
    ds_read_b128 v[148:151], v9 offset:0
    v_mfma_f32_16x16x32_bf16 v[200:203], v[104:107], a[48:51], v[200:203]
    buffer_load_dwordx4 a[128:131], v4, s[40:43], s63 offen offset:0 sc1
    v_mfma_f32_16x16x32_bf16 v[200:203], v[108:111], a[56:59], v[200:203]
    v_mfma_f32_16x16x32_bf16 v[204:207], v[104:107], a[52:55], v[204:207]
    ds_read_b128 v[104:107], v8 offset:59392
    v_mfma_f32_16x16x32_bf16 v[204:207], v[108:111], a[60:63], v[204:207]
    s_waitcnt vmcnt(16)
    s_barrier
    v_mov_b32 v31, 3
    v_mfma_f32_16x16x32_bf16 v[208:211], v[112:115], a[48:51], v[208:211]
    s_waitcnt lgkmcnt(1)
    buffer_load_dwordx4 a[132:135], v5, s[40:43], s63 offen offset:0 sc1
    v_mfma_f32_16x16x32_bf16 v[208:211], v[116:119], a[56:59], v[208:211]
    buffer_store_dword v31, v30, s[32:35], s101 offen sc1
    v_mfma_f32_16x16x32_bf16 v[212:215], v[112:115], a[52:55], v[212:215]
    ds_read_b128 v[108:111], v9 offset:1024
    ds_read_b128 v[112:115], v8 offset:60416
    v_mfma_f32_16x16x32_bf16 v[212:215], v[116:119], a[60:63], v[212:215]
    ds_read_b128 v[116:119], v9 offset:2048
    v_mfma_f32_16x16x32_bf16 v[216:219], v[120:123], a[48:51], v[216:219]
    v_mfma_f32_16x16x32_bf16 v[216:219], v[124:127], a[56:59], v[216:219]
    buffer_load_dwordx4 a[136:139], v4, s[40:43], s63 offen offset:1024 sc1
    v_mfma_f32_16x16x32_bf16 v[220:223], v[120:123], a[52:55], v[220:223]
    ds_read_b128 v[120:123], v8 offset:61440
    v_mfma_f32_16x16x32_bf16 v[220:223], v[124:127], a[60:63], v[220:223]
    ds_read_b128 v[124:127], v9 offset:3072
    v_mfma_f32_16x16x32_bf16 v[224:227], v[128:131], a[48:51], v[224:227]
    v_mfma_f32_16x16x32_bf16 v[224:227], v[132:135], a[56:59], v[224:227]
    buffer_load_dwordx4 a[140:143], v5, s[40:43], s63 offen offset:1024 sc1
    v_mfma_f32_16x16x32_bf16 v[228:231], v[128:131], a[52:55], v[228:231]
    ds_read_b128 v[128:131], v8 offset:62464
    v_mfma_f32_16x16x32_bf16 v[228:231], v[132:135], a[60:63], v[228:231]
    ds_read_b128 v[132:135], v9 offset:4096
    v_mfma_f32_16x16x32_bf16 v[176:179], v[136:139], a[64:67], v[176:179]
    v_mfma_f32_16x16x32_bf16 v[176:179], v[140:143], a[72:75], v[176:179]
    buffer_load_dwordx4 a[144:147], v4, s[40:43], s63 offen offset:2048 sc1
    v_mfma_f32_16x16x32_bf16 v[180:183], v[136:139], a[68:71], v[180:183]
    ds_read_b128 v[136:139], v8 offset:63488
    v_mfma_f32_16x16x32_bf16 v[180:183], v[140:143], a[76:79], v[180:183]
    ds_read_b128 v[140:143], v9 offset:5120
    v_mfma_f32_16x16x32_bf16 v[184:187], v[144:147], a[64:67], v[184:187]
    v_mfma_f32_16x16x32_bf16 v[184:187], v[148:151], a[72:75], v[184:187]
    buffer_load_dwordx4 a[148:151], v5, s[40:43], s63 offen offset:2048 sc1
    v_mfma_f32_16x16x32_bf16 v[188:191], v[144:147], a[68:71], v[188:191]
    ds_read_b128 v[144:147], v9 offset:6144
    v_mfma_f32_16x16x32_bf16 v[188:191], v[148:151], a[76:79], v[188:191]
    s_waitcnt lgkmcnt(2)
    ds_read_b128 v[148:151], v9 offset:13312
    v_mfma_f32_16x16x32_bf16 v[192:195], v[104:107], a[64:67], v[192:195]
    v_mfma_f32_16x16x32_bf16 v[192:195], v[108:111], a[72:75], v[192:195]
    buffer_load_dwordx4 a[152:155], v4, s[40:43], s63 offen offset:3072 sc1
    v_mfma_f32_16x16x32_bf16 v[196:199], v[104:107], a[68:71], v[196:199]
    ds_read_b128 v[104:107], v9 offset:7168
    v_mfma_f32_16x16x32_bf16 v[196:199], v[108:111], a[76:79], v[196:199]
    ds_read_b128 v[108:111], v9 offset:14336
    v_mfma_f32_16x16x32_bf16 v[200:203], v[112:115], a[64:67], v[200:203]
    v_mfma_f32_16x16x32_bf16 v[200:203], v[116:119], a[72:75], v[200:203]
    v_mfma_f32_16x16x32_bf16 v[204:207], v[112:115], a[68:71], v[204:207]
    buffer_load_dwordx4 a[156:159], v5, s[40:43], s63 offen offset:3072 sc1
    v_mfma_f32_16x16x32_bf16 v[204:207], v[116:119], a[76:79], v[204:207]
    s_xor_b32 s21, s3, 5
    ds_read_b128 v[112:115], v9 offset:8192
    ds_read_b128 v[116:119], v9 offset:15360
    v_mfma_f32_16x16x32_bf16 v[208:211], v[120:123], a[64:67], v[208:211]
    s_lshl2_add_u32 s21, s21, s4
    v_mfma_f32_16x16x32_bf16 v[208:211], v[124:127], a[72:75], v[208:211]
    s_mul_i32 s21, s21, 36864
    v_mfma_f32_16x16x32_bf16 v[212:215], v[120:123], a[68:71], v[212:215]
    s_add_u32 s64, s21, s17
    s_add_u32 m0, s78, 0
    ds_read_b128 v[120:123], v9 offset:9216
    v_mfma_f32_16x16x32_bf16 v[212:215], v[124:127], a[76:79], v[212:215]
    s_xor_b32 s63, s63, 4096
    buffer_load_dwordx4 v1, s[56:59], s64 offen sc1 lds
    v_mfma_f32_16x16x32_bf16 v[216:219], v[128:131], a[64:67], v[216:219]
    ds_read_b128 v[124:127], v9 offset:16384
    v_mfma_f32_16x16x32_bf16 v[216:219], v[132:135], a[72:75], v[216:219]
    v_mfma_f32_16x16x32_bf16 v[220:223], v[128:131], a[68:71], v[220:223]
    buffer_load_dwordx4 v1, s[56:59], s64 offen offset:1024 sc1 lds
    v_mfma_f32_16x16x32_bf16 v[220:223], v[132:135], a[76:79], v[220:223]
    s_add_u32 s64, s21, s18
    ds_read_b128 v[128:131], v9 offset:10240
    ds_read_b128 v[132:135], v9 offset:17408
    v_mfma_f32_16x16x32_bf16 v[224:227], v[136:139], a[64:67], v[224:227]
    s_add_u32 m0, s78, 2048
    s_waitcnt lgkmcnt(3)
    v_mfma_f32_16x16x32_bf16 v[224:227], v[140:143], a[72:75], v[224:227]
    v_mfma_f32_16x16x32_bf16 v[228:231], v[136:139], a[68:71], v[228:231]
    buffer_load_dwordx4 v1, s[56:59], s64 offen sc1 lds
    v_mfma_f32_16x16x32_bf16 v[228:231], v[140:143], a[76:79], v[228:231]
    ds_read_b128 v[136:139], v9 offset:11264
    ds_read_b128 v[140:143], v9 offset:18432
    v_mfma_f32_16x16x32_bf16 v[176:179], v[144:147], a[80:83], v[176:179]
    v_mfma_f32_16x16x32_bf16 v[176:179], v[148:151], a[88:91], v[176:179]
    v_mfma_f32_16x16x32_bf16 v[180:183], v[144:147], a[84:87], v[180:183]
    buffer_load_dwordx4 v1, s[56:59], s64 offen offset:1024 sc1 lds
    v_mfma_f32_16x16x32_bf16 v[180:183], v[148:151], a[92:95], v[180:183]
    ds_read_b128 v[144:147], v9 offset:12288
    ds_read_b128 v[148:151], v9 offset:19456
    v_mfma_f32_16x16x32_bf16 v[184:187], v[104:107], a[80:83], v[184:187]
    s_add_u32 s64, s21, s19
    v_mfma_f32_16x16x32_bf16 v[184:187], v[108:111], a[88:91], v[184:187]
    s_add_u32 m0, s78, 4096
    v_mfma_f32_16x16x32_bf16 v[188:191], v[104:107], a[84:87], v[188:191]
    ds_read_b128 v[104:107], v9 offset:20480
    v_mfma_f32_16x16x32_bf16 v[188:191], v[108:111], a[92:95], v[188:191]
    buffer_load_dwordx4 v1, s[56:59], s64 offen sc1 lds
    v_mfma_f32_16x16x32_bf16 v[192:195], v[112:115], a[80:83], v[192:195]
    ds_read_b128 v[108:111], v9 offset:27648
    v_mfma_f32_16x16x32_bf16 v[192:195], v[116:119], a[88:91], v[192:195]
    v_mfma_f32_16x16x32_bf16 v[196:199], v[112:115], a[84:87], v[196:199]
    ds_read_b128 v[112:115], v9 offset:21504
    v_mfma_f32_16x16x32_bf16 v[196:199], v[116:119], a[92:95], v[196:199]
    buffer_load_dwordx4 v1, s[56:59], s64 offen offset:1024 sc1 lds
    v_mfma_f32_16x16x32_bf16 v[200:203], v[120:123], a[80:83], v[200:203]
    s_add_u32 s64, s21, s20
    ds_read_b128 v[116:119], v9 offset:28672
    s_waitcnt lgkmcnt(3)
    v_mfma_f32_16x16x32_bf16 v[200:203], v[124:127], a[88:91], v[200:203]
    s_add_u32 m0, s78, 6144
    v_mfma_f32_16x16x32_bf16 v[204:207], v[120:123], a[84:87], v[204:207]
    ds_read_b128 v[120:123], v9 offset:22528
    v_mfma_f32_16x16x32_bf16 v[204:207], v[124:127], a[92:95], v[204:207]
    s_waitcnt vmcnt(22)
    s_barrier
    ds_read_b128 v[124:127], v9 offset:29696
    v_mfma_f32_16x16x32_bf16 v[208:211], v[128:131], a[80:83], v[208:211]
    buffer_load_dwordx4 v1, s[56:59], s64 offen sc1 lds
    v_mfma_f32_16x16x32_bf16 v[208:211], v[132:135], a[88:91], v[208:211]
    v_mfma_f32_16x16x32_bf16 v[212:215], v[128:131], a[84:87], v[212:215]
    ds_read_b128 v[128:131], v9 offset:23552
    v_mfma_f32_16x16x32_bf16 v[212:215], v[132:135], a[92:95], v[212:215]
    buffer_load_dwordx4 a[160:163], v4, s[40:43], s63 offen offset:0 sc1
    v_mfma_f32_16x16x32_bf16 v[216:219], v[136:139], a[80:83], v[216:219]
    ds_read_b128 v[132:135], v9 offset:30720
    v_mfma_f32_16x16x32_bf16 v[216:219], v[140:143], a[88:91], v[216:219]
    v_mfma_f32_16x16x32_bf16 v[220:223], v[136:139], a[84:87], v[220:223]
    ds_read_b128 v[136:139], v9 offset:24576
    v_mfma_f32_16x16x32_bf16 v[220:223], v[140:143], a[92:95], v[220:223]
    buffer_load_dwordx4 a[164:167], v5, s[40:43], s63 offen offset:0 sc1
    v_mfma_f32_16x16x32_bf16 v[224:227], v[144:147], a[80:83], v[224:227]
    ds_read_b128 v[140:143], v9 offset:31744
    v_mfma_f32_16x16x32_bf16 v[224:227], v[148:151], a[88:91], v[224:227]
    v_mfma_f32_16x16x32_bf16 v[228:231], v[144:147], a[84:87], v[228:231]
    ds_read_b128 v[144:147], v9 offset:25600
    v_mfma_f32_16x16x32_bf16 v[228:231], v[148:151], a[92:95], v[228:231]
    buffer_load_dwordx4 a[168:171], v4, s[40:43], s63 offen offset:1024 sc1
    v_mfma_f32_16x16x32_bf16 v[176:179], v[104:107], a[96:99], v[176:179]
    s_waitcnt lgkmcnt(2)
    ds_read_b128 v[148:151], v9 offset:32768
    v_mfma_f32_16x16x32_bf16 v[176:179], v[108:111], a[104:107], v[176:179]
    v_mfma_f32_16x16x32_bf16 v[180:183], v[104:107], a[100:103], v[180:183]
    ds_read_b128 v[104:107], v9 offset:26624
    v_mfma_f32_16x16x32_bf16 v[180:183], v[108:111], a[108:111], v[180:183]
    ds_read_b128 v[108:111], v9 offset:33792
    v_mfma_f32_16x16x32_bf16 v[184:187], v[112:115], a[96:99], v[184:187]
    buffer_load_dwordx4 a[172:175], v5, s[40:43], s63 offen offset:1024 sc1
    v_mfma_f32_16x16x32_bf16 v[184:187], v[116:119], a[104:107], v[184:187]
    v_mfma_f32_16x16x32_bf16 v[188:191], v[112:115], a[100:103], v[188:191]
    ds_read_b128 v[112:115], v9 offset:34816
    v_mfma_f32_16x16x32_bf16 v[188:191], v[116:119], a[108:111], v[188:191]
    ds_read_b128 v[116:119], v9 offset:41984
    v_mfma_f32_16x16x32_bf16 v[192:195], v[120:123], a[96:99], v[192:195]
    buffer_load_dwordx4 a[176:179], v4, s[40:43], s63 offen offset:2048 sc1
    v_mfma_f32_16x16x32_bf16 v[192:195], v[124:127], a[104:107], v[192:195]
    v_mfma_f32_16x16x32_bf16 v[196:199], v[120:123], a[100:103], v[196:199]
    ds_read_b128 v[120:123], v9 offset:35840
    v_mfma_f32_16x16x32_bf16 v[196:199], v[124:127], a[108:111], v[196:199]
    ds_read_b128 v[124:127], v9 offset:43008
    v_mfma_f32_16x16x32_bf16 v[200:203], v[128:131], a[96:99], v[200:203]
    buffer_load_dwordx4 a[180:183], v5, s[40:43], s63 offen offset:2048 sc1
    v_mfma_f32_16x16x32_bf16 v[200:203], v[132:135], a[104:107], v[200:203]
    v_mfma_f32_16x16x32_bf16 v[204:207], v[128:131], a[100:103], v[204:207]
    ds_read_b128 v[128:131], v9 offset:36864
    v_mfma_f32_16x16x32_bf16 v[204:207], v[132:135], a[108:111], v[204:207]
    ds_read_b128 v[132:135], v9 offset:44032
    v_mfma_f32_16x16x32_bf16 v[208:211], v[136:139], a[96:99], v[208:211]
    s_waitcnt lgkmcnt(2)
    buffer_load_dwordx4 a[184:187], v4, s[40:43], s63 offen offset:3072 sc1
    v_mfma_f32_16x16x32_bf16 v[208:211], v[140:143], a[104:107], v[208:211]
    v_mfma_f32_16x16x32_bf16 v[212:215], v[136:139], a[100:103], v[212:215]
    ds_read_b128 v[136:139], v9 offset:37888
    v_mfma_f32_16x16x32_bf16 v[212:215], v[140:143], a[108:111], v[212:215]
    ds_read_b128 v[140:143], v9 offset:45056
    v_mfma_f32_16x16x32_bf16 v[216:219], v[144:147], a[96:99], v[216:219]
    buffer_load_dwordx4 a[188:191], v5, s[40:43], s63 offen offset:3072 sc1
    v_mfma_f32_16x16x32_bf16 v[216:219], v[148:151], a[104:107], v[216:219]
    v_mfma_f32_16x16x32_bf16 v[220:223], v[144:147], a[100:103], v[220:223]
    s_xor_b32 s21, s3, 6
    ds_read_b128 v[144:147], v9 offset:38912
    v_mfma_f32_16x16x32_bf16 v[220:223], v[148:151], a[108:111], v[220:223]
    s_lshl2_add_u32 s21, s21, s4
    ds_read_b128 v[148:151], v9 offset:46080
    v_mfma_f32_16x16x32_bf16 v[224:227], v[104:107], a[96:99], v[224:227]
    s_mul_i32 s21, s21, 36864
    v_mfma_f32_16x16x32_bf16 v[224:227], v[108:111], a[104:107], v[224:227]
    s_add_u32 s64, s21, s17
    s_add_u32 m0, s78, 28672
    v_mfma_f32_16x16x32_bf16 v[228:231], v[104:107], a[100:103], v[228:231]
    s_xor_b32 s63, s63, 12288
    buffer_load_dwordx4 v1, s[56:59], s64 offen sc1 lds
    v_mfma_f32_16x16x32_bf16 v[228:231], v[108:111], a[108:111], v[228:231]
    ds_read_b128 v[104:107], v9 offset:39936
    ds_read_b128 v[108:111], v9 offset:47104
    v_mfma_f32_16x16x32_bf16 v[176:179], v[112:115], a[112:115], v[176:179]
    v_mfma_f32_16x16x32_bf16 v[176:179], v[116:119], a[120:123], v[176:179]
    buffer_load_dwordx4 v1, s[56:59], s64 offen offset:1024 sc1 lds
    v_mfma_f32_16x16x32_bf16 v[180:183], v[112:115], a[116:119], v[180:183]
    s_add_u32 s64, s21, s18
    ds_read_b128 v[112:115], v9 offset:40960
    v_mfma_f32_16x16x32_bf16 v[180:183], v[116:119], a[124:127], v[180:183]
    s_add_u32 m0, s78, 30720
    ds_read_b128 v[116:119], v9 offset:48128
    v_mfma_f32_16x16x32_bf16 v[184:187], v[120:123], a[112:115], v[184:187]
    v_mfma_f32_16x16x32_bf16 v[184:187], v[124:127], a[120:123], v[184:187]
    buffer_load_dwordx4 v1, s[56:59], s64 offen sc1 lds
    v_mfma_f32_16x16x32_bf16 v[188:191], v[120:123], a[116:119], v[188:191]
    v_mfma_f32_16x16x32_bf16 v[188:191], v[124:127], a[124:127], v[188:191]
    s_waitcnt lgkmcnt(1)
    v_mfma_f32_16x16x32_bf16 v[192:195], v[128:131], a[112:115], v[192:195]
    v_mfma_f32_16x16x32_bf16 v[192:195], v[132:135], a[120:123], v[192:195]
    buffer_load_dwordx4 v1, s[56:59], s64 offen offset:1024 sc1 lds
    v_mfma_f32_16x16x32_bf16 v[196:199], v[128:131], a[116:119], v[196:199]
    s_add_u32 s64, s21, s19
    v_mfma_f32_16x16x32_bf16 v[196:199], v[132:135], a[124:127], v[196:199]
    s_add_u32 m0, s78, 32768
    v_mfma_f32_16x16x32_bf16 v[200:203], v[136:139], a[112:115], v[200:203]
    v_mfma_f32_16x16x32_bf16 v[200:203], v[140:143], a[120:123], v[200:203]
    buffer_load_dwordx4 v1, s[56:59], s64 offen sc1 lds
    v_mfma_f32_16x16x32_bf16 v[204:207], v[136:139], a[116:119], v[204:207]
    v_mfma_f32_16x16x32_bf16 v[204:207], v[140:143], a[124:127], v[204:207]
    s_waitcnt vmcnt(20)
    s_barrier
    ds_read_b128 v[120:123], v9 offset:49152
    v_mfma_f32_16x16x32_bf16 v[208:211], v[144:147], a[112:115], v[208:211]
    ds_read_b128 v[124:127], v9 offset:56320
    ds_read_b128 v[128:131], v9 offset:50176
    v_mfma_f32_16x16x32_bf16 v[208:211], v[148:151], a[120:123], v[208:211]
    ds_read_b128 v[132:135], v9 offset:57344
    v_mfma_f32_16x16x32_bf16 v[212:215], v[144:147], a[116:119], v[212:215]
    buffer_load_dwordx4 v1, s[56:59], s64 offen offset:1024 sc1 lds
    v_mfma_f32_16x16x32_bf16 v[212:215], v[148:151], a[124:127], v[212:215]
    s_add_u32 s64, s21, s20
    ds_read_b128 v[136:139], v9 offset:51200
    ds_read_b128 v[140:143], v9 offset:58368
    v_mfma_f32_16x16x32_bf16 v[216:219], v[104:107], a[112:115], v[216:219]
    s_add_u32 m0, s78, 34816
    ds_read_b128 v[144:147], v9 offset:52224
    v_mfma_f32_16x16x32_bf16 v[216:219], v[108:111], a[120:123], v[216:219]
    ds_read_b128 v[148:151], v9 offset:59392
    v_mfma_f32_16x16x32_bf16 v[220:223], v[104:107], a[116:119], v[220:223]
    buffer_load_dwordx4 v1, s[56:59], s64 offen sc1 lds
    v_mfma_f32_16x16x32_bf16 v[220:223], v[108:111], a[124:127], v[220:223]
    ds_read_b128 v[104:107], v9 offset:53248
    ds_read_b128 v[108:111], v9 offset:60416
    v_mfma_f32_16x16x32_bf16 v[224:227], v[112:115], a[112:115], v[224:227]
    s_waitcnt lgkmcnt(4)
    v_mfma_f32_16x16x32_bf16 v[224:227], v[116:119], a[120:123], v[224:227]
    v_mfma_f32_16x16x32_bf16 v[228:231], v[112:115], a[116:119], v[228:231]
    buffer_load_dwordx4 a[192:195], v4, s[40:43], s63 offen offset:0 sc1
    v_mfma_f32_16x16x32_bf16 v[228:231], v[116:119], a[124:127], v[228:231]
    ds_read_b128 v[112:115], v9 offset:54272
    ds_read_b128 v[116:119], v9 offset:61440
    v_mfma_f32_16x16x32_bf16 v[176:179], v[120:123], a[128:131], v[176:179]
    v_mfma_f32_16x16x32_bf16 v[176:179], v[124:127], a[136:139], v[176:179]
    v_mfma_f32_16x16x32_bf16 v[180:183], v[120:123], a[132:135], v[180:183]
    buffer_load_dwordx4 a[196:199], v5, s[40:43], s63 offen offset:0 sc1
    v_mfma_f32_16x16x32_bf16 v[180:183], v[124:127], a[140:143], v[180:183]
    ds_read_b128 v[120:123], v9 offset:55296
    ds_read_b128 v[124:127], v9 offset:62464
    v_mfma_f32_16x16x32_bf16 v[184:187], v[128:131], a[128:131], v[184:187]
    v_mfma_f32_16x16x32_bf16 v[184:187], v[132:135], a[136:139], v[184:187]
    v_mfma_f32_16x16x32_bf16 v[188:191], v[128:131], a[132:135], v[188:191]
    buffer_load_dwordx4 a[200:203], v4, s[40:43], s63 offen offset:1024 sc1
    v_mfma_f32_16x16x32_bf16 v[188:191], v[132:135], a[140:143], v[188:191]
    ds_read_b128 v[128:131], v9 offset:63488
    ds_read_b128 v[132:135], v10 offset:5120
    v_mfma_f32_16x16x32_bf16 v[192:195], v[136:139], a[128:131], v[192:195]
    v_mfma_f32_16x16x32_bf16 v[192:195], v[140:143], a[136:139], v[192:195]
    v_mfma_f32_16x16x32_bf16 v[196:199], v[136:139], a[132:135], v[196:199]
    ds_read_b128 v[136:139], v9 offset:64512
    v_mfma_f32_16x16x32_bf16 v[196:199], v[140:143], a[140:143], v[196:199]
    s_waitcnt lgkmcnt(3)
    buffer_load_dwordx4 a[204:207], v5, s[40:43], s63 offen offset:1024 sc1
    v_mfma_f32_16x16x32_bf16 v[200:203], v[144:147], a[128:131], v[200:203]
    ds_read_b128 v[140:143], v10 offset:6144
    v_mfma_f32_16x16x32_bf16 v[200:203], v[148:151], a[136:139], v[200:203]
    v_mfma_f32_16x16x32_bf16 v[204:207], v[144:147], a[132:135], v[204:207]
    ds_read_b128 v[144:147], v10 offset:0
    v_mfma_f32_16x16x32_bf16 v[204:207], v[148:151], a[140:143], v[204:207]
    buffer_load_dwordx4 a[208:211], v4, s[40:43], s63 offen offset:2048 sc1
    v_mfma_f32_16x16x32_bf16 v[208:211], v[104:107], a[128:131], v[208:211]
    ds_read_b128 v[148:151], v10 offset:7168
    v_mfma_f32_16x16x32_bf16 v[208:211], v[108:111], a[136:139], v[208:211]
    v_mfma_f32_16x16x32_bf16 v[212:215], v[104:107], a[132:135], v[212:215]
    ds_read_b128 v[104:107], v10 offset:1024
    v_mfma_f32_16x16x32_bf16 v[212:215], v[108:111], a[140:143], v[212:215]
    buffer_load_dwordx4 a[212:215], v5, s[40:43], s63 offen offset:2048 sc1
    v_mfma_f32_16x16x32_bf16 v[216:219], v[112:115], a[128:131], v[216:219]
    ds_read_b128 v[108:111], v10 offset:8192
    v_mfma_f32_16x16x32_bf16 v[216:219], v[116:119], a[136:139], v[216:219]
    v_mfma_f32_16x16x32_bf16 v[220:223], v[112:115], a[132:135], v[220:223]
    ds_read_b128 v[112:115], v10 offset:2048
    v_mfma_f32_16x16x32_bf16 v[220:223], v[116:119], a[140:143], v[220:223]
    buffer_load_dwordx4 a[216:219], v4, s[40:43], s63 offen offset:3072 sc1
    v_mfma_f32_16x16x32_bf16 v[224:227], v[120:123], a[128:131], v[224:227]
    ds_read_b128 v[116:119], v10 offset:9216
    v_mfma_f32_16x16x32_bf16 v[224:227], v[124:127], a[136:139], v[224:227]
    v_mfma_f32_16x16x32_bf16 v[228:231], v[120:123], a[132:135], v[228:231]
    ds_read_b128 v[120:123], v10 offset:3072
    v_mfma_f32_16x16x32_bf16 v[228:231], v[124:127], a[140:143], v[228:231]
    s_waitcnt lgkmcnt(2)
    buffer_load_dwordx4 a[220:223], v5, s[40:43], s63 offen offset:3072 sc1
    v_mfma_f32_16x16x32_bf16 v[176:179], v[128:131], a[144:147], v[176:179]
    ds_read_b128 v[124:127], v10 offset:10240
    v_mfma_f32_16x16x32_bf16 v[176:179], v[132:135], a[152:155], v[176:179]
    s_xor_b32 s63, s63, 4096
    v_mfma_f32_16x16x32_bf16 v[180:183], v[128:131], a[148:151], v[180:183]
    ds_read_b128 v[128:131], v10 offset:4096
    v_mfma_f32_16x16x32_bf16 v[180:183], v[132:135], a[156:159], v[180:183]
    ds_read_b128 v[132:135], v10 offset:11264
    v_mfma_f32_16x16x32_bf16 v[184:187], v[136:139], a[144:147], v[184:187]
    buffer_load_dword v3, v19, s[32:35], s66 offen sc1
    v_mfma_f32_16x16x32_bf16 v[184:187], v[140:143], a[152:155], v[184:187]
    s_xor_b32 s21, s3, 7
    v_mfma_f32_16x16x32_bf16 v[188:191], v[136:139], a[148:151], v[188:191]
    s_lshl2_add_u32 s21, s21, s4
    v_mfma_f32_16x16x32_bf16 v[188:191], v[140:143], a[156:159], v[188:191]
    s_mul_i32 s21, s21, 36864
    v_mfma_f32_16x16x32_bf16 v[192:195], v[144:147], a[144:147], v[192:195]
    s_add_u32 s64, s21, s17
    s_add_u32 m0, s78, 57344
    v_mfma_f32_16x16x32_bf16 v[192:195], v[148:151], a[152:155], v[192:195]
    buffer_load_dwordx4 v1, s[56:59], s64 offen sc1 lds
    v_mfma_f32_16x16x32_bf16 v[196:199], v[144:147], a[148:151], v[196:199]
    v_mfma_f32_16x16x32_bf16 v[196:199], v[148:151], a[156:159], v[196:199]
    v_mfma_f32_16x16x32_bf16 v[200:203], v[104:107], a[144:147], v[200:203]
    buffer_load_dwordx4 v1, s[56:59], s64 offen offset:1024 sc1 lds
    v_mfma_f32_16x16x32_bf16 v[200:203], v[108:111], a[152:155], v[200:203]
    s_add_u32 s64, s21, s18
    v_mfma_f32_16x16x32_bf16 v[204:207], v[104:107], a[148:151], v[204:207]
    s_add_u32 m0, s78, 59392
    v_mfma_f32_16x16x32_bf16 v[204:207], v[108:111], a[156:159], v[204:207]
    s_waitcnt vmcnt(18)
    s_barrier
    ds_read_b128 v[136:139], v8 offset:0
    v_mfma_f32_16x16x32_bf16 v[208:211], v[112:115], a[144:147], v[208:211]
    s_waitcnt lgkmcnt(1)
    buffer_load_dwordx4 v1, s[56:59], s64 offen sc1 lds
    v_mfma_f32_16x16x32_bf16 v[208:211], v[116:119], a[152:155], v[208:211]
    ds_read_b128 v[140:143], v8 offset:7168
    ds_read_b128 v[144:147], v8 offset:1024
    v_mfma_f32_16x16x32_bf16 v[212:215], v[112:115], a[148:151], v[212:215]
    ds_read_b128 v[148:151], v8 offset:8192
    v_mfma_f32_16x16x32_bf16 v[212:215], v[116:119], a[156:159], v[212:215]
    ds_read_b128 v[104:107], v8 offset:2048
    v_mfma_f32_16x16x32_bf16 v[216:219], v[120:123], a[144:147], v[216:219]
    buffer_load_dwordx4 v1, s[56:59], s64 offen offset:1024 sc1 lds
    v_mfma_f32_16x16x32_bf16 v[216:219], v[124:127], a[152:155], v[216:219]
    ds_read_b128 v[108:111], v8 offset:9216
    ds_read_b128 v[112:115], v8 offset:3072
    v_mfma_f32_16x16x32_bf16 v[220:223], v[120:123], a[148:151], v[220:223]
    s_add_u32 s64, s21, s19
    ds_read_b128 v[116:119], v8 offset:10240
    v_mfma_f32_16x16x32_bf16 v[220:223], v[124:127], a[156:159], v[220:223]
    s_add_u32 m0, s78, 61440
    ds_read_b128 v[120:123], v8 offset:4096
    v_mfma_f32_16x16x32_bf16 v[224:227], v[128:131], a[144:147], v[224:227]
    ds_read_b128 v[124:127], v8 offset:11264
    v_mfma_f32_16x16x32_bf16 v[224:227], v[132:135], a[152:155], v[224:227]
    buffer_load_dwordx4 v1, s[56:59], s64 offen sc1 lds
    v_mfma_f32_16x16x32_bf16 v[228:231], v[128:131], a[148:151], v[228:231]
    ds_read_b128 v[128:131], v8 offset:5120
    v_mfma_f32_16x16x32_bf16 v[228:231], v[132:135], a[156:159], v[228:231]
    s_waitcnt lgkmcnt(3)
    ds_read_b128 v[132:135], v8 offset:12288
    v_mfma_f32_16x16x32_bf16 v[176:179], v[136:139], a[160:163], v[176:179]
    v_mfma_f32_16x16x32_bf16 v[176:179], v[140:143], a[168:171], v[176:179]
    buffer_load_dwordx4 v1, s[56:59], s64 offen offset:1024 sc1 lds
    v_mfma_f32_16x16x32_bf16 v[180:183], v[136:139], a[164:167], v[180:183]
    s_add_u32 s64, s21, s20
    ds_read_b128 v[136:139], v8 offset:6144
    v_mfma_f32_16x16x32_bf16 v[180:183], v[140:143], a[172:175], v[180:183]
    s_add_u32 m0, s78, 63488
    ds_read_b128 v[140:143], v8 offset:13312
    v_mfma_f32_16x16x32_bf16 v[184:187], v[144:147], a[160:163], v[184:187]
    v_mfma_f32_16x16x32_bf16 v[184:187], v[148:151], a[168:171], v[184:187]
    buffer_load_dwordx4 v1, s[56:59], s64 offen sc1 lds
    v_mfma_f32_16x16x32_bf16 v[188:191], v[144:147], a[164:167], v[188:191]
    ds_read_b128 v[144:147], v8 offset:14336
    v_mfma_f32_16x16x32_bf16 v[188:191], v[148:151], a[172:175], v[188:191]
    ds_read_b128 v[148:151], v8 offset:21504
    v_mfma_f32_16x16x32_bf16 v[192:195], v[104:107], a[160:163], v[192:195]
    v_mfma_f32_16x16x32_bf16 v[192:195], v[108:111], a[168:171], v[192:195]
    buffer_load_dwordx4 a[224:227], v4, s[40:43], s63 offen offset:0 sc1
    v_mfma_f32_16x16x32_bf16 v[196:199], v[104:107], a[164:167], v[196:199]
    ds_read_b128 v[104:107], v8 offset:15360
    v_mfma_f32_16x16x32_bf16 v[196:199], v[108:111], a[172:175], v[196:199]
    ds_read_b128 v[108:111], v8 offset:22528
    v_mfma_f32_16x16x32_bf16 v[200:203], v[112:115], a[160:163], v[200:203]
    v_mfma_f32_16x16x32_bf16 v[200:203], v[116:119], a[168:171], v[200:203]
    buffer_load_dwordx4 a[228:231], v5, s[40:43], s63 offen offset:0 sc1
    v_mfma_f32_16x16x32_bf16 v[204:207], v[112:115], a[164:167], v[204:207]
    ds_read_b128 v[112:115], v8 offset:16384
    v_mfma_f32_16x16x32_bf16 v[204:207], v[116:119], a[172:175], v[204:207]
    s_waitcnt lgkmcnt(2)
    ds_read_b128 v[116:119], v8 offset:23552
    v_mfma_f32_16x16x32_bf16 v[208:211], v[120:123], a[160:163], v[208:211]
    v_mfma_f32_16x16x32_bf16 v[208:211], v[124:127], a[168:171], v[208:211]
    v_mfma_f32_16x16x32_bf16 v[212:215], v[120:123], a[164:167], v[212:215]
    buffer_load_dwordx4 a[232:235], v4, s[40:43], s63 offen offset:1024 sc1
    v_mfma_f32_16x16x32_bf16 v[212:215], v[124:127], a[172:175], v[212:215]
    ds_read_b128 v[120:123], v8 offset:17408
    ds_read_b128 v[124:127], v8 offset:24576
    v_mfma_f32_16x16x32_bf16 v[216:219], v[128:131], a[160:163], v[216:219]
    v_mfma_f32_16x16x32_bf16 v[216:219], v[132:135], a[168:171], v[216:219]
    v_mfma_f32_16x16x32_bf16 v[220:223], v[128:131], a[164:167], v[220:223]
    buffer_load_dwordx4 a[236:239], v5, s[40:43], s63 offen offset:1024 sc1
    v_mfma_f32_16x16x32_bf16 v[220:223], v[132:135], a[172:175], v[220:223]
    ds_read_b128 v[128:131], v8 offset:18432
    ds_read_b128 v[132:135], v8 offset:25600
    v_mfma_f32_16x16x32_bf16 v[224:227], v[136:139], a[160:163], v[224:227]
    v_mfma_f32_16x16x32_bf16 v[224:227], v[140:143], a[168:171], v[224:227]
    v_mfma_f32_16x16x32_bf16 v[228:231], v[136:139], a[164:167], v[228:231]
    buffer_load_dwordx4 a[240:243], v4, s[40:43], s63 offen offset:2048 sc1
    v_mfma_f32_16x16x32_bf16 v[228:231], v[140:143], a[172:175], v[228:231]
    ds_read_b128 v[136:139], v8 offset:19456
    ds_read_b128 v[140:143], v8 offset:26624
    v_mfma_f32_16x16x32_bf16 v[176:179], v[144:147], a[176:179], v[176:179]
    v_mfma_f32_16x16x32_bf16 v[176:179], v[148:151], a[184:187], v[176:179]
    v_mfma_f32_16x16x32_bf16 v[180:183], v[144:147], a[180:183], v[180:183]
    buffer_load_dwordx4 a[244:247], v5, s[40:43], s63 offen offset:2048 sc1
    v_mfma_f32_16x16x32_bf16 v[180:183], v[148:151], a[188:191], v[180:183]
    ds_read_b128 v[144:147], v8 offset:20480
    ds_read_b128 v[148:151], v8 offset:27648
    v_mfma_f32_16x16x32_bf16 v[184:187], v[104:107], a[176:179], v[184:187]
    s_waitcnt lgkmcnt(2)
    v_mfma_f32_16x16x32_bf16 v[184:187], v[108:111], a[184:187], v[184:187]
    v_mfma_f32_16x16x32_bf16 v[188:191], v[104:107], a[180:183], v[188:191]
    buffer_load_dwordx4 a[248:251], v4, s[40:43], s63 offen offset:3072 sc1
    v_mfma_f32_16x16x32_bf16 v[188:191], v[108:111], a[188:191], v[188:191]
    v_mfma_f32_16x16x32_bf16 v[192:195], v[112:115], a[176:179], v[192:195]
    v_mfma_f32_16x16x32_bf16 v[192:195], v[116:119], a[184:187], v[192:195]
    v_mfma_f32_16x16x32_bf16 v[196:199], v[112:115], a[180:183], v[196:199]
    v_mfma_f32_16x16x32_bf16 v[196:199], v[116:119], a[188:191], v[196:199]
    buffer_load_dwordx4 a[252:255], v5, s[40:43], s63 offen offset:3072 sc1
    v_mfma_f32_16x16x32_bf16 v[200:203], v[120:123], a[176:179], v[200:203]
    s_mul_i32 s21, s61, 6
    s_add_u32 s21, s4, s21
    v_mfma_f32_16x16x32_bf16 v[200:203], v[124:127], a[184:187], v[200:203]
    s_add_u32 s21, s21, 128
    v_mfma_f32_16x16x32_bf16 v[204:207], v[120:123], a[180:183], v[204:207]
    s_mul_i32 s21, s21, 36864
    v_mfma_f32_16x16x32_bf16 v[204:207], v[124:127], a[188:191], v[204:207]
    s_add_u32 s64, s21, s17
    s_add_u32 m0, s78, 86016
    s_waitcnt vmcnt(15)
    v_cmp_gt_u32 vcc, 3, v3
    s_nop 1
    s_and_b64 vcc, vcc, exec
    s_cbranch_scc1 SPIN_OA
BACK_OA:
    s_barrier
    v_mfma_f32_16x16x32_bf16 v[208:211], v[128:131], a[176:179], v[208:211]
    s_add_u32 s63, s63, 4096
    buffer_load_dwordx4 v1, s[56:59], s64 offen sc1 lds
    v_mfma_f32_16x16x32_bf16 v[208:211], v[132:135], a[184:187], v[208:211]
    ds_read_b128 v[104:107], v8 offset:28672
    ds_read_b128 v[108:111], v8 offset:35840
    v_mfma_f32_16x16x32_bf16 v[212:215], v[128:131], a[180:183], v[212:215]
    ds_read_b128 v[112:115], v8 offset:29696
    v_mfma_f32_16x16x32_bf16 v[212:215], v[132:135], a[188:191], v[212:215]
    buffer_load_dwordx4 v1, s[56:59], s64 offen offset:1024 sc1 lds
    v_mfma_f32_16x16x32_bf16 v[216:219], v[136:139], a[176:179], v[216:219]
    s_add_u32 s64, s21, s18
    ds_read_b128 v[116:119], v8 offset:36864
    ds_read_b128 v[120:123], v8 offset:30720
    v_mfma_f32_16x16x32_bf16 v[216:219], v[140:143], a[184:187], v[216:219]
    s_add_u32 m0, s78, 88064
    ds_read_b128 v[124:127], v8 offset:37888
    v_mfma_f32_16x16x32_bf16 v[220:223], v[136:139], a[180:183], v[220:223]
    ds_read_b128 v[128:131], v8 offset:31744
    v_mfma_f32_16x16x32_bf16 v[220:223], v[140:143], a[188:191], v[220:223]
    s_waitcnt lgkmcnt(4)
    buffer_load_dwordx4 v1, s[56:59], s64 offen sc1 lds
    v_mfma_f32_16x16x32_bf16 v[224:227], v[144:147], a[176:179], v[224:227]
    ds_read_b128 v[132:135], v8 offset:38912
    ds_read_b128 v[136:139], v8 offset:32768
    v_mfma_f32_16x16x32_bf16 v[224:227], v[148:151], a[184:187], v[224:227]
    ds_read_b128 v[140:143], v8 offset:39936
    v_mfma_f32_16x16x32_bf16 v[228:231], v[144:147], a[180:183], v[228:231]
    ds_read_b128 v[144:147], v8 offset:33792
    v_mfma_f32_16x16x32_bf16 v[228:231], v[148:151], a[188:191], v[228:231]
    buffer_load_dwordx4 v1, s[56:59], s64 offen offset:1024 sc1 lds
    v_mfma_f32_16x16x32_bf16 v[176:179], v[104:107], a[192:195], v[176:179]
    ds_read_b128 v[148:151], v8 offset:40960
    v_mfma_f32_16x16x32_bf16 v[176:179], v[108:111], a[200:203], v[176:179]
    s_add_u32 s64, s21, s19
    v_mfma_f32_16x16x32_bf16 v[180:183], v[104:107], a[196:199], v[180:183]
    s_add_u32 m0, s78, 90112
    ds_read_b128 v[104:107], v8 offset:34816
    v_mfma_f32_16x16x32_bf16 v[180:183], v[108:111], a[204:207], v[180:183]
    ds_read_b128 v[108:111], v8 offset:41984
    v_mfma_f32_16x16x32_bf16 v[184:187], v[112:115], a[192:195], v[184:187]
    s_waitcnt lgkmcnt(3)
    buffer_load_dwordx4 v1, s[56:59], s64 offen sc1 lds
    v_mfma_f32_16x16x32_bf16 v[184:187], v[116:119], a[200:203], v[184:187]
    v_mfma_f32_16x16x32_bf16 v[188:191], v[112:115], a[196:199], v[188:191]
    ds_read_b128 v[112:115], v8 offset:43008
    v_mfma_f32_16x16x32_bf16 v[188:191], v[116:119], a[204:207], v[188:191]
    ds_read_b128 v[116:119], v8 offset:50176
    v_mfma_f32_16x16x32_bf16 v[192:195], v[120:123], a[192:195], v[192:195]
    buffer_load_dwordx4 v1, s[56:59], s64 offen offset:1024 sc1 lds
    v_mfma_f32_16x16x32_bf16 v[192:195], v[124:127], a[200:203], v[192:195]
    s_add_u32 s64, s21, s20
    v_mfma_f32_16x16x32_bf16 v[196:199], v[120:123], a[196:199], v[196:199]
    s_add_u32 m0, s78, 92160
    ds_read_b128 v[120:123], v8 offset:44032
    v_mfma_f32_16x16x32_bf16 v[196:199], v[124:127], a[204:207], v[196:199]
    ds_read_b128 v[124:127], v8 offset:51200
    v_mfma_f32_16x16x32_bf16 v[200:203], v[128:131], a[192:195], v[200:203]
    buffer_load_dwordx4 v1, s[56:59], s64 offen sc1 lds
    v_mfma_f32_16x16x32_bf16 v[200:203], v[132:135], a[200:203], v[200:203]
    s_mul_i32 s63, s61, 6144
    v_mfma_f32_16x16x32_bf16 v[204:207], v[128:131], a[196:199], v[204:207]
    s_add_u32 s63, s63, 131072
    ds_read_b128 v[128:131], v8 offset:45056
    v_mfma_f32_16x16x32_bf16 v[204:207], v[132:135], a[204:207], v[204:207]
    ds_read_b128 v[132:135], v8 offset:52224
    v_mfma_f32_16x16x32_bf16 v[208:211], v[136:139], a[192:195], v[208:211]
    buffer_load_dwordx4 v[32:35], v4, s[40:43], s63 offen offset:0 sc1
    v_mfma_f32_16x16x32_bf16 v[208:211], v[140:143], a[200:203], v[208:211]
    v_mfma_f32_16x16x32_bf16 v[212:215], v[136:139], a[196:199], v[212:215]
    ds_read_b128 v[136:139], v8 offset:46080
    v_mfma_f32_16x16x32_bf16 v[212:215], v[140:143], a[204:207], v[212:215]
    ds_read_b128 v[140:143], v8 offset:53248
    v_mfma_f32_16x16x32_bf16 v[216:219], v[144:147], a[192:195], v[216:219]
    s_waitcnt lgkmcnt(2)
    buffer_load_dwordx4 v[36:39], v5, s[40:43], s63 offen offset:0 sc1
    v_mfma_f32_16x16x32_bf16 v[216:219], v[148:151], a[200:203], v[216:219]
    v_mfma_f32_16x16x32_bf16 v[220:223], v[144:147], a[196:199], v[220:223]
    ds_read_b128 v[144:147], v8 offset:47104
    v_mfma_f32_16x16x32_bf16 v[220:223], v[148:151], a[204:207], v[220:223]
    ds_read_b128 v[148:151], v8 offset:54272
    v_mfma_f32_16x16x32_bf16 v[224:227], v[104:107], a[192:195], v[224:227]
    v_mfma_f32_16x16x32_bf16 v[224:227], v[108:111], a[200:203], v[224:227]
    buffer_load_dwordx4 v[40:43], v4, s[40:43], s63 offen offset:1024 sc1
    v_mfma_f32_16x16x32_bf16 v[228:231], v[104:107], a[196:199], v[228:231]
    ds_read_b128 v[104:107], v8 offset:48128
    v_mfma_f32_16x16x32_bf16 v[228:231], v[108:111], a[204:207], v[228:231]
    ds_read_b128 v[108:111], v8 offset:55296
    v_mfma_f32_16x16x32_bf16 v[176:179], v[112:115], a[208:211], v[176:179]
    v_mfma_f32_16x16x32_bf16 v[176:179], v[116:119], a[216:219], v[176:179]
    buffer_load_dwordx4 v[44:47], v5, s[40:43], s63 offen offset:1024 sc1
    v_mfma_f32_16x16x32_bf16 v[180:183], v[112:115], a[212:215], v[180:183]
    ds_read_b128 v[112:115], v8 offset:49152
    v_mfma_f32_16x16x32_bf16 v[180:183], v[116:119], a[220:223], v[180:183]
    ds_read_b128 v[116:119], v8 offset:56320
    v_mfma_f32_16x16x32_bf16 v[184:187], v[120:123], a[208:211], v[184:187]
    v_mfma_f32_16x16x32_bf16 v[184:187], v[124:127], a[216:219], v[184:187]
    buffer_load_dwordx4 v[48:51], v4, s[40:43], s63 offen offset:2048 sc1
    v_mfma_f32_16x16x32_bf16 v[188:191], v[120:123], a[212:215], v[188:191]
    v_mfma_f32_16x16x32_bf16 v[188:191], v[124:127], a[220:223], v[188:191]
    v_mfma_f32_16x16x32_bf16 v[192:195], v[128:131], a[208:211], v[192:195]
    v_mfma_f32_16x16x32_bf16 v[192:195], v[132:135], a[216:219], v[192:195]
    buffer_load_dwordx4 v[52:55], v5, s[40:43], s63 offen offset:2048 sc1
    v_mfma_f32_16x16x32_bf16 v[196:199], v[128:131], a[212:215], v[196:199]
    v_mfma_f32_16x16x32_bf16 v[196:199], v[132:135], a[220:223], v[196:199]
    s_waitcnt lgkmcnt(0)
    v_mfma_f32_16x16x32_bf16 v[200:203], v[136:139], a[208:211], v[200:203]
    v_mfma_f32_16x16x32_bf16 v[200:203], v[140:143], a[216:219], v[200:203]
    buffer_load_dwordx4 v[56:59], v4, s[40:43], s63 offen offset:3072 sc1
    v_mfma_f32_16x16x32_bf16 v[204:207], v[136:139], a[212:215], v[204:207]
    v_mfma_f32_16x16x32_bf16 v[204:207], v[140:143], a[220:223], v[204:207]
    s_waitcnt vmcnt(14)
    s_barrier
    ds_read_b128 v[120:123], v8 offset:57344
    v_mfma_f32_16x16x32_bf16 v[208:211], v[144:147], a[208:211], v[208:211]
    ds_read_b128 v[124:127], v8 offset:64512
    ds_read_b128 v[128:131], v8 offset:58368
    v_mfma_f32_16x16x32_bf16 v[208:211], v[148:151], a[216:219], v[208:211]
    ds_read_b128 v[132:135], v9 offset:0
    v_mfma_f32_16x16x32_bf16 v[212:215], v[144:147], a[212:215], v[212:215]
    buffer_load_dwordx4 v[60:63], v5, s[40:43], s63 offen offset:3072 sc1
    v_mfma_f32_16x16x32_bf16 v[212:215], v[148:151], a[220:223], v[212:215]
    s_mul_i32 s21, s61, 6
    s_cmp_eq_u32 s4, 0
    s_cselect_b32 s64, s17, s18
    v_mfma_f32_16x16x32_bf16 v[216:219], v[104:107], a[208:211], v[216:219]
    s_add_u32 s21, s21, 132
    s_cmp_eq_u32 s4, 2
    s_cselect_b32 s64, s19, s64
    v_mfma_f32_16x16x32_bf16 v[216:219], v[108:111], a[216:219], v[216:219]
    s_mul_i32 s21, s21, 36864
    s_cmp_eq_u32 s4, 3
    s_cselect_b32 s64, s20, s64
    v_mfma_f32_16x16x32_bf16 v[220:223], v[104:107], a[212:215], v[220:223]
    s_add_u32 s64, s64, s21
    s_add_u32 m0, s67, 114688
    ds_read_b128 v[136:139], v8 offset:59392
    v_mfma_f32_16x16x32_bf16 v[220:223], v[108:111], a[220:223], v[220:223]
    s_add_u32 s63, s63, 4096
    buffer_load_dwordx4 v1, s[56:59], s64 offen sc1 lds
    v_mfma_f32_16x16x32_bf16 v[224:227], v[112:115], a[208:211], v[224:227]
    ds_read_b128 v[140:143], v9 offset:1024
    ds_read_b128 v[144:147], v8 offset:60416
    v_mfma_f32_16x16x32_bf16 v[224:227], v[116:119], a[216:219], v[224:227]
    ds_read_b128 v[148:151], v9 offset:2048
    v_mfma_f32_16x16x32_bf16 v[228:231], v[112:115], a[212:215], v[228:231]
    buffer_load_dwordx4 v1, s[56:59], s64 offen offset:1024 sc1 lds
    v_mfma_f32_16x16x32_bf16 v[228:231], v[116:119], a[220:223], v[228:231]
    s_add_u32 s64, s64, 36864
    ds_read_b128 v[104:107], v8 offset:61440
    ds_read_b128 v[108:111], v9 offset:3072
    s_waitcnt lgkmcnt(5)
    v_mfma_f32_16x16x32_bf16 v[176:179], v[120:123], a[224:227], v[176:179]
    s_add_u32 m0, s67, 122880
    ds_read_b128 v[112:115], v8 offset:62464
    v_lshrrev_b32 v19, 4, v1
    v_mfma_f32_16x16x32_bf16 v[176:179], v[124:127], a[232:235], v[176:179]
    s_add_u32 s23, s5, 8
    ds_read_b128 v[116:119], v9 offset:4096
    v_min_u32 v19, 2, v19
    v_mfma_f32_16x16x32_bf16 v[180:183], v[120:123], a[228:231], v[180:183]
    s_add_u32 s22, s4, 1
    buffer_load_dwordx4 v1, s[56:59], s64 offen sc1 lds
    v_mfma_f32_16x16x32_bf16 v[180:183], v[124:127], a[236:239], v[180:183]
    s_mul_i32 s70, s4, 3072
    ds_read_b128 v[120:123], v8 offset:63488
    ds_read_b128 v[124:127], v9 offset:5120
    v_mfma_f32_16x16x32_bf16 v[184:187], v[128:131], a[224:227], v[184:187]
    s_lshl_b32 s22, s22, 15
    v_lshl_add_u32 v19, v19, 3, s23
    v_bfe_u32 v20, v1, 4, 4
    v_mfma_f32_16x16x32_bf16 v[184:187], v[132:135], a[232:235], v[184:187]
    s_lshl2_add_u32 s23, s62, s4
    v_lshrrev_b32 v21, 8, v1
    v_and_b32 v19, 31, v19
    v_mfma_f32_16x16x32_bf16 v[188:191], v[128:131], a[228:231], v[188:191]
    s_lshl_b32 s23, s23, 5
    buffer_load_dwordx4 v1, s[56:59], s64 offen offset:1024 sc1 lds
    v_mfma_f32_16x16x32_bf16 v[188:191], v[132:135], a[236:239], v[188:191]
    s_lshl_b32 s66, s6, 12
    ds_read_b128 v[128:131], v9 offset:6144
    ds_read_b128 v[132:135], v9 offset:13312
    v_mfma_f32_16x16x32_bf16 v[192:195], v[136:139], a[224:227], v[192:195]
    s_add_u32 s64, s64, 36864
    v_add_u32 v20, s23, v20
    v_mul_u32_u24 v20, 1152, v20
    s_waitcnt lgkmcnt(2)
    v_mfma_f32_16x16x32_bf16 v[192:195], v[140:143], a[232:235], v[192:195]
    s_mul_i32 s23, s101, 288
    v_lshl_add_u32 v20, v21, 3, v20
    v_mov_b32 v31, 1
    v_mfma_f32_16x16x32_bf16 v[196:199], v[136:139], a[228:231], v[196:199]
    s_add_u32 s23, s23, s70
    ds_read_b128 v[136:139], v9 offset:7168
    v_lshlrev_b32 v23, 20, v1
    v_mfma_f32_16x16x32_bf16 v[196:199], v[140:143], a[236:239], v[196:199]
    s_lshr_b32 s65, s20, 5
    buffer_load_dwordx4 v[64:67], v4, s[40:43], s63 offen offset:0 sc1
    v_mfma_f32_16x16x32_bf16 v[200:203], v[144:147], a[224:227], v[200:203]
    s_add_u32 s66, s66, s22
    ds_read_b128 v[140:143], v9 offset:14336
    v_lshlrev_b32 v19, 7, v19
    v_mfma_f32_16x16x32_bf16 v[200:203], v[148:151], a[232:235], v[200:203]
    s_add_u32 s22, s22, s101
    v_add_u32 v21, 18432, v20
    v_mfma_f32_16x16x32_bf16 v[204:207], v[144:147], a[228:231], v[204:207]
    ds_read_b128 v[144:147], v9 offset:8192
    v_mfma_f32_16x16x32_bf16 v[204:207], v[148:151], a[236:239], v[204:207]
    buffer_load_dwordx4 v[68:71], v5, s[40:43], s63 offen offset:0 sc1
    v_mfma_f32_16x16x32_bf16 v[208:211], v[104:107], a[224:227], v[208:211]
    ds_read_b128 v[148:151], v9 offset:15360
    v_mfma_f32_16x16x32_bf16 v[208:211], v[108:111], a[232:235], v[208:211]
    s_cmp_eq_u32 s4, s61
    s_cselect_b32 s65, s65, 1073741824
    s_cselect_b32 s70, s23, 1073741824
    v_mfma_f32_16x16x32_bf16 v[212:215], v[104:107], a[228:231], v[212:215]
    s_add_u32 s98, s70, 0
    ds_read_b128 v[104:107], v9 offset:9216
    v_mfma_f32_16x16x32_bf16 v[212:215], v[108:111], a[236:239], v[212:215]
    buffer_load_dwordx4 v[72:75], v4, s[40:43], s63 offen offset:1024 sc1
    v_mfma_f32_16x16x32_bf16 v[216:219], v[112:115], a[224:227], v[216:219]
    ds_read_b128 v[108:111], v9 offset:16384
    v_mfma_f32_16x16x32_bf16 v[216:219], v[116:119], a[232:235], v[216:219]
    v_mfma_f32_16x16x32_bf16 v[220:223], v[112:115], a[228:231], v[220:223]
    ds_read_b128 v[112:115], v9 offset:10240
    v_mfma_f32_16x16x32_bf16 v[220:223], v[116:119], a[236:239], v[220:223]
    buffer_load_dwordx4 v[76:79], v5, s[40:43], s63 offen offset:1024 sc1
    v_mfma_f32_16x16x32_bf16 v[224:227], v[120:123], a[224:227], v[224:227]
    s_lshr_b32 s64, s4, 1
    s_lshl1_add_u32 s21, s61, s64
    s_mul_i32 s21, s21, 3
    v_mfma_f32_16x16x32_bf16 v[224:227], v[124:127], a[232:235], v[224:227]
    s_add_u32 s21, s21, 128
    s_mul_i32 s21, s21, 36864
    ds_read_b128 v[116:119], v9 offset:17408
    v_mfma_f32_16x16x32_bf16 v[228:231], v[120:123], a[228:231], v[228:231]
    s_add_u32 s21, s21, s16
    s_and_b32 s64, s68, 1024
    ds_read_b128 v[120:123], v9 offset:11264
    v_mfma_f32_16x16x32_bf16 v[228:231], v[124:127], a[236:239], v[228:231]
    s_add_u32 s21, s21, s64
    s_add_u32 m0, s69, 143360
    ds_read_b128 v[124:127], v9 offset:18432
    s_waitcnt lgkmcnt(3)
    v_mfma_f32_16x16x32_bf16 v[176:179], v[128:131], a[240:243], v[176:179]
    s_add_u32 s63, s63, 4096
    buffer_load_dwordx4 v1, s[56:59], s21 offen sc1 lds
    v_mfma_f32_16x16x32_bf16 v[176:179], v[132:135], a[248:251], v[176:179]
    s_add_u32 s21, s21, 36864
    v_mfma_f32_16x16x32_bf16 v[180:183], v[128:131], a[244:247], v[180:183]
    s_add_u32 m0, s69, 144384
    ds_read_b128 v[128:131], v9 offset:12288
    v_mfma_f32_16x16x32_bf16 v[180:183], v[132:135], a[252:255], v[180:183]
    s_lshr_b32 s64, s16, 5
    ds_read_b128 v[132:135], v9 offset:19456
    v_mfma_f32_16x16x32_bf16 v[184:187], v[136:139], a[240:243], v[184:187]
    buffer_load_dwordx4 v1, s[56:59], s21 offen sc1 lds
    v_mfma_f32_16x16x32_bf16 v[184:187], v[140:143], a[248:251], v[184:187]
    s_add_u32 s21, s21, 36864
    v_mfma_f32_16x16x32_bf16 v[188:191], v[136:139], a[244:247], v[188:191]
    s_add_u32 m0, s69, 145408
    v_mfma_f32_16x16x32_bf16 v[188:191], v[140:143], a[252:255], v[188:191]
    v_mfma_f32_16x16x32_bf16 v[192:195], v[144:147], a[240:243], v[192:195]
    buffer_load_dwordx4 v1, s[56:59], s21 offen sc1 lds
    v_mfma_f32_16x16x32_bf16 v[192:195], v[148:151], a[248:251], v[192:195]
    s_add_u32 s21, s21, 36864
    v_mfma_f32_16x16x32_bf16 v[196:199], v[144:147], a[244:247], v[196:199]
    v_mfma_f32_16x16x32_bf16 v[196:199], v[148:151], a[252:255], v[196:199]
    v_mfma_f32_16x16x32_bf16 v[200:203], v[104:107], a[240:243], v[200:203]
    v_mfma_f32_16x16x32_bf16 v[200:203], v[108:111], a[248:251], v[200:203]
    s_add_u32 s21, s4, 0
    v_mfma_f32_16x16x32_bf16 v[204:207], v[104:107], a[244:247], v[204:207]
    s_xor_b32 s21, s21, s3
    v_mfma_f32_16x16x32_bf16 v[204:207], v[108:111], a[252:255], v[204:207]
    s_waitcnt vmcnt(11)
    s_barrier
    s_mul_i32 s21, s21, 147456
    v_mfma_f32_16x16x32_bf16 v[208:211], v[112:115], a[240:243], v[208:211]
    s_add_u32 s21, s21, s16
    s_add_u32 m0, s75, 0
    ds_read_b128 v[136:139], v9 offset:20480
    s_waitcnt lgkmcnt(1)
    v_mfma_f32_16x16x32_bf16 v[208:211], v[116:119], a[248:251], v[208:211]
    buffer_load_dwordx4 v1, s[56:59], s21 offen sc1 lds
    v_mfma_f32_16x16x32_bf16 v[212:215], v[112:115], a[244:247], v[212:215]
    ds_read_b128 v[140:143], v9 offset:27648
    ds_read_b128 v[144:147], v9 offset:21504
    v_mfma_f32_16x16x32_bf16 v[212:215], v[116:119], a[252:255], v[212:215]
    ds_read_b128 v[148:151], v9 offset:28672
    v_mfma_f32_16x16x32_bf16 v[216:219], v[120:123], a[240:243], v[216:219]
    buffer_load_dwordx4 v1, s[56:59], s21 offen offset:1024 sc1 lds
    v_mfma_f32_16x16x32_bf16 v[216:219], v[124:127], a[248:251], v[216:219]
    s_add_u32 s21, s21, 36864
    ds_read_b128 v[104:107], v9 offset:22528
    ds_read_b128 v[108:111], v9 offset:29696
    v_mfma_f32_16x16x32_bf16 v[220:223], v[120:123], a[244:247], v[220:223]
    s_add_u32 m0, s75, 2048
    ds_read_b128 v[112:115], v9 offset:23552
    v_mfma_f32_16x16x32_bf16 v[220:223], v[124:127], a[252:255], v[220:223]
    ds_read_b128 v[116:119], v9 offset:30720
    v_mfma_f32_16x16x32_bf16 v[224:227], v[128:131], a[240:243], v[224:227]
    buffer_load_dwordx4 v1, s[56:59], s21 offen sc1 lds
    v_mfma_f32_16x16x32_bf16 v[224:227], v[132:135], a[248:251], v[224:227]
    ds_read_b128 v[120:123], v9 offset:24576
    ds_read_b128 v[124:127], v9 offset:31744
    v_mfma_f32_16x16x32_bf16 v[228:231], v[128:131], a[244:247], v[228:231]
    ds_read_b128 v[128:131], v9 offset:25600
    v_mfma_f32_16x16x32_bf16 v[228:231], v[132:135], a[252:255], v[228:231]
    s_waitcnt lgkmcnt(4)
    ds_read_b128 v[132:135], v9 offset:32768
    v_mfma_f32_16x16x32_bf16 v[176:179], v[136:139], v[32:35], v[176:179]
    buffer_load_dwordx4 v1, s[56:59], s21 offen offset:1024 sc1 lds
    v_mfma_f32_16x16x32_bf16 v[176:179], v[140:143], v[40:43], v[176:179]
    s_add_u32 s21, s21, 36864
    v_mfma_f32_16x16x32_bf16 v[180:183], v[136:139], v[36:39], v[180:183]
    s_add_u32 m0, s75, 4096
    ds_read_b128 v[136:139], v9 offset:26624
    v_mfma_f32_16x16x32_bf16 v[180:183], v[140:143], v[44:47], v[180:183]
    ds_read_b128 v[140:143], v9 offset:33792
    v_mfma_f32_16x16x32_bf16 v[184:187], v[144:147], v[32:35], v[184:187]
    buffer_load_dwordx4 v1, s[56:59], s21 offen sc1 lds
    v_mfma_f32_16x16x32_bf16 v[184:187], v[148:151], v[40:43], v[184:187]
    v_mfma_f32_16x16x32_bf16 v[188:191], v[144:147], v[36:39], v[188:191]
    ds_read_b128 v[144:147], v9 offset:34816
    v_mfma_f32_16x16x32_bf16 v[188:191], v[148:151], v[44:47], v[188:191]
    ds_read_b128 v[148:151], v9 offset:41984
    v_mfma_f32_16x16x32_bf16 v[192:195], v[104:107], v[32:35], v[192:195]
    buffer_load_dwordx4 v1, s[56:59], s21 offen offset:1024 sc1 lds
    v_mfma_f32_16x16x32_bf16 v[192:195], v[108:111], v[40:43], v[192:195]
    v_mfma_f32_16x16x32_bf16 v[196:199], v[104:107], v[36:39], v[196:199]
    s_add_u32 s21, s21, 36864
    v_mfma_f32_16x16x32_bf16 v[196:199], v[108:111], v[44:47], v[196:199]
    s_add_u32 m0, s75, 6144
    v_mfma_f32_16x16x32_bf16 v[200:203], v[112:115], v[32:35], v[200:203]
    s_waitcnt lgkmcnt(0)
    v_mfma_f32_16x16x32_bf16 v[200:203], v[116:119], v[40:43], v[200:203]
    buffer_load_dwordx4 v1, s[56:59], s21 offen sc1 lds
    v_mfma_f32_16x16x32_bf16 v[204:207], v[112:115], v[36:39], v[204:207]
    ds_read_b128 v[112:115], v9 offset:35840
    v_mfma_f32_16x16x32_bf16 v[204:207], v[116:119], v[44:47], v[204:207]
    s_waitcnt vmcnt(10)
    s_barrier
    ds_read_b128 v[104:107], v9 offset:49152
    v_mfma_f32_16x16x32_bf16 v[208:211], v[120:123], v[32:35], v[208:211]
    ds_read_b128 v[108:111], v9 offset:57344
    ds_read_b128 v[116:119], v9 offset:43008
    v_mfma_f32_16x16x32_bf16 v[208:211], v[124:127], v[40:43], v[208:211]
    buffer_load_dwordx4 v1, s[56:59], s21 offen offset:1024 sc1 lds
    v_mfma_f32_16x16x32_bf16 v[212:215], v[120:123], v[36:39], v[212:215]
    s_add_u32 s21, s21, 36864
    s_add_u32 s21, s4, 4
    ds_read_b128 v[120:123], v9 offset:50176
    v_mfma_f32_16x16x32_bf16 v[212:215], v[124:127], v[44:47], v[212:215]
    s_xor_b32 s21, s21, s3
    ds_read_b128 v[124:127], v9 offset:58368
    v_mfma_f32_16x16x32_bf16 v[216:219], v[128:131], v[32:35], v[216:219]
    s_mul_i32 s21, s21, 147456
    v_mfma_f32_16x16x32_bf16 v[216:219], v[132:135], v[40:43], v[216:219]
    s_add_u32 s21, s21, s16
    s_add_u32 m0, s75, 32768
    v_mfma_f32_16x16x32_bf16 v[220:223], v[128:131], v[36:39], v[220:223]
    buffer_load_dwordx4 v1, s[56:59], s21 offen sc1 lds
    v_mfma_f32_16x16x32_bf16 v[220:223], v[132:135], v[44:47], v[220:223]
    ds_read_b128 v[128:131], v9 offset:36864
    ds_read_b128 v[132:135], v9 offset:44032
    v_mfma_f32_16x16x32_bf16 v[224:227], v[136:139], v[32:35], v[224:227]
    v_mfma_f32_16x16x32_bf16 v[224:227], v[140:143], v[40:43], v[224:227]
    buffer_load_dwordx4 v1, s[56:59], s21 offen offset:1024 sc1 lds
    v_mfma_f32_16x16x32_bf16 v[228:231], v[136:139], v[36:39], v[228:231]
    s_add_u32 s21, s21, 36864
    ds_read_b128 v[136:139], v9 offset:51200
    v_mfma_f32_16x16x32_bf16 v[228:231], v[140:143], v[44:47], v[228:231]
    s_add_u32 m0, s75, 34816
    ds_read_b128 v[140:143], v9 offset:59392
    v_mfma_f32_16x16x32_bf16 v[176:179], v[144:147], v[48:51], v[176:179]
    v_mfma_f32_16x16x32_bf16 v[176:179], v[148:151], v[56:59], v[176:179]
    s_waitcnt lgkmcnt(2)
    buffer_load_dwordx4 v1, s[56:59], s21 offen sc1 lds
    v_mfma_f32_16x16x32_bf16 v[176:179], v[104:107], v[64:67], v[176:179]
    v_mfma_f32_16x16x32_bf16 v[176:179], v[108:111], v[72:75], v[176:179]
    v_mfma_f32_16x16x32_bf16 v[180:183], v[144:147], v[52:55], v[180:183]
    ds_read_b128 v[144:147], v9 offset:37888
    v_mfma_f32_16x16x32_bf16 v[180:183], v[148:151], v[60:63], v[180:183]
    ds_read_b128 v[148:151], v9 offset:45056
    v_mfma_f32_16x16x32_bf16 v[180:183], v[104:107], v[68:71], v[180:183]
    buffer_load_dwordx4 v1, s[56:59], s21 offen offset:1024 sc1 lds
    v_mfma_f32_16x16x32_bf16 v[180:183], v[108:111], v[76:79], v[180:183]
    s_add_u32 s21, s21, 36864
    v_cvt_pk_bf16_f32 v232, v176, v177
    v_cvt_pk_bf16_f32 v233, v178, v179
    v_mfma_f32_16x16x32_bf16 v[184:187], v[112:115], v[48:51], v[184:187]
    s_add_u32 m0, s75, 36864
    ds_read_b128 v[104:107], v9 offset:52224
    ds_read_b128 v[108:111], v9 offset:60416
    v_mfma_f32_16x16x32_bf16 v[184:187], v[116:119], v[56:59], v[184:187]
    v_cvt_pk_bf16_f32 v234, v180, v181
    v_cvt_pk_bf16_f32 v235, v182, v183
    v_mfma_f32_16x16x32_bf16 v[184:187], v[120:123], v[64:67], v[184:187]
    buffer_load_dwordx4 v1, s[56:59], s21 offen sc1 lds
    v_mfma_f32_16x16x32_bf16 v[184:187], v[124:127], v[72:75], v[184:187]
    buffer_store_dwordx4 v[232:235], v1, s[48:51], s8 offen offset:0 sc1
    v_mfma_f32_16x16x32_bf16 v[188:191], v[112:115], v[52:55], v[188:191]
    ds_read_b128 v[112:115], v9 offset:38912
    v_mfma_f32_16x16x32_bf16 v[188:191], v[116:119], v[60:63], v[188:191]
    ds_read_b128 v[116:119], v9 offset:46080
    v_mfma_f32_16x16x32_bf16 v[188:191], v[120:123], v[68:71], v[188:191]
    buffer_load_dwordx4 v1, s[56:59], s21 offen offset:1024 sc1 lds
    v_mfma_f32_16x16x32_bf16 v[188:191], v[124:127], v[76:79], v[188:191]
    s_add_u32 s21, s21, 36864
    v_cvt_pk_bf16_f32 v236, v184, v185
    v_cvt_pk_bf16_f32 v237, v186, v187
    v_mfma_f32_16x16x32_bf16 v[192:195], v[128:131], v[48:51], v[192:195]
    s_add_u32 m0, s75, 38912
    ds_read_b128 v[120:123], v9 offset:53248
    ds_read_b128 v[124:127], v9 offset:61440
    v_mfma_f32_16x16x32_bf16 v[192:195], v[132:135], v[56:59], v[192:195]
    s_waitcnt lgkmcnt(3)
    v_cvt_pk_bf16_f32 v238, v188, v189
    v_cvt_pk_bf16_f32 v239, v190, v191
    v_mfma_f32_16x16x32_bf16 v[192:195], v[136:139], v[64:67], v[192:195]
    buffer_load_dwordx4 v1, s[56:59], s21 offen sc1 lds
    v_mfma_f32_16x16x32_bf16 v[192:195], v[140:143], v[72:75], v[192:195]
    v_mfma_f32_16x16x32_bf16 v[196:199], v[128:131], v[52:55], v[196:199]
    ds_read_b128 v[128:131], v9 offset:39936
    v_mfma_f32_16x16x32_bf16 v[196:199], v[132:135], v[60:63], v[196:199]
    ds_read_b128 v[132:135], v9 offset:47104
    v_mfma_f32_16x16x32_bf16 v[196:199], v[136:139], v[68:71], v[196:199]
    buffer_store_dwordx4 v[236:239], v1, s[48:51], s8 offen offset:1024 sc1
    v_mfma_f32_16x16x32_bf16 v[196:199], v[140:143], v[76:79], v[196:199]
    ds_read_b128 v[136:139], v9 offset:54272
    v_cvt_pk_bf16_f32 v240, v192, v193
    v_mfma_f32_16x16x32_bf16 v[200:203], v[144:147], v[48:51], v[200:203]
    v_cvt_pk_bf16_f32 v241, v194, v195
    ds_read_b128 v[140:143], v9 offset:62464
    v_mfma_f32_16x16x32_bf16 v[200:203], v[148:151], v[56:59], v[200:203]
    v_mfma_f32_16x16x32_bf16 v[200:203], v[104:107], v[64:67], v[200:203]
    buffer_load_dwordx4 v1, s[56:59], s21 offen offset:1024 sc1 lds
    v_mfma_f32_16x16x32_bf16 v[200:203], v[108:111], v[72:75], v[200:203]
    s_add_u32 s21, s21, 36864
    v_cvt_pk_bf16_f32 v242, v196, v197
    v_cvt_pk_bf16_f32 v243, v198, v199
    v_mfma_f32_16x16x32_bf16 v[204:207], v[144:147], v[52:55], v[204:207]
    ds_read_b128 v[144:147], v9 offset:40960
    v_mfma_f32_16x16x32_bf16 v[204:207], v[148:151], v[60:63], v[204:207]
    ds_read_b128 v[148:151], v9 offset:48128
    v_mfma_f32_16x16x32_bf16 v[204:207], v[104:107], v[68:71], v[204:207]
    buffer_store_dwordx4 v[240:243], v1, s[48:51], s9 offen offset:0 sc1
    v_mfma_f32_16x16x32_bf16 v[204:207], v[108:111], v[76:79], v[204:207]
    v_cvt_pk_bf16_f32 v244, v200, v201
    v_cvt_pk_bf16_f32 v245, v202, v203
    v_mfma_f32_16x16x32_bf16 v[208:211], v[112:115], v[48:51], v[208:211]
    s_waitcnt lgkmcnt(2)
    ds_read_b128 v[104:107], v9 offset:55296
    ds_read_b128 v[108:111], v9 offset:63488
    v_mfma_f32_16x16x32_bf16 v[208:211], v[116:119], v[56:59], v[208:211]
    v_mfma_f32_16x16x32_bf16 v[208:211], v[120:123], v[64:67], v[208:211]
    v_mfma_f32_16x16x32_bf16 v[208:211], v[124:127], v[72:75], v[208:211]
    v_cvt_pk_bf16_f32 v246, v204, v205
    v_cvt_pk_bf16_f32 v247, v206, v207
    v_mfma_f32_16x16x32_bf16 v[212:215], v[112:115], v[52:55], v[212:215]
    buffer_store_dwordx4 v[244:247], v1, s[48:51], s9 offen offset:1024 sc1
    v_mfma_f32_16x16x32_bf16 v[212:215], v[116:119], v[60:63], v[212:215]
    v_mfma_f32_16x16x32_bf16 v[212:215], v[120:123], v[68:71], v[212:215]
    v_mfma_f32_16x16x32_bf16 v[212:215], v[124:127], v[76:79], v[212:215]
    v_mfma_f32_16x16x32_bf16 v[216:219], v[128:131], v[48:51], v[216:219]
    v_cvt_pk_bf16_f32 v232, v208, v209
    v_cvt_pk_bf16_f32 v233, v210, v211
    v_mfma_f32_16x16x32_bf16 v[216:219], v[132:135], v[56:59], v[216:219]
    v_mfma_f32_16x16x32_bf16 v[216:219], v[136:139], v[64:67], v[216:219]
    v_mfma_f32_16x16x32_bf16 v[216:219], v[140:143], v[72:75], v[216:219]
    s_waitcnt vmcnt(12)
    s_barrier
    v_cvt_pk_bf16_f32 v234, v212, v213
    v_mfma_f32_16x16x32_bf16 v[220:223], v[128:131], v[52:55], v[220:223]
    v_cvt_pk_bf16_f32 v235, v214, v215
    ds_read_b128 v[112:115], v8 offset:0
    v_mfma_f32_16x16x32_bf16 v[220:223], v[132:135], v[60:63], v[220:223]
    buffer_store_dwordx4 v[232:235], v1, s[48:51], s10 offen offset:0 sc1
    v_mfma_f32_16x16x32_bf16 v[220:223], v[136:139], v[68:71], v[220:223]
    ds_read_b128 v[116:119], v8 offset:2048
    ds_read_b128 v[120:123], v8 offset:4096
    v_mfma_f32_16x16x32_bf16 v[220:223], v[140:143], v[76:79], v[220:223]
    s_waitcnt lgkmcnt(3)
    ds_read_b128 v[124:127], v8 offset:6144
    v_cvt_pk_bf16_f32 v236, v216, v217
    v_mfma_f32_16x16x32_bf16 v[224:227], v[144:147], v[48:51], v[224:227]
    v_cvt_pk_bf16_f32 v237, v218, v219
    ds_read_b128 v[128:131], v8 offset:1024
    v_mfma_f32_16x16x32_bf16 v[224:227], v[148:151], v[56:59], v[224:227]
    ds_read_b128 v[132:135], v8 offset:3072
    v_mfma_f32_16x16x32_bf16 v[224:227], v[104:107], v[64:67], v[224:227]
    v_cvt_pk_bf16_f32 v238, v220, v221
    v_cvt_pk_bf16_f32 v239, v222, v223
    v_mfma_f32_16x16x32_bf16 v[224:227], v[108:111], v[72:75], v[224:227]
    buffer_store_dwordx4 v[236:239], v1, s[48:51], s10 offen offset:1024 sc1
    v_mfma_f32_16x16x32_bf16 v[228:231], v[144:147], v[52:55], v[228:231]
    ds_read_b128 v[136:139], v8 offset:5120
    ds_read_b128 v[140:143], v8 offset:7168
    v_mfma_f32_16x16x32_bf16 v[228:231], v[148:151], v[60:63], v[228:231]
    ds_read_b128 v[144:147], v8 offset:8192
    v_mfma_f32_16x16x32_bf16 v[228:231], v[104:107], v[68:71], v[228:231]
    ds_read_b128 v[148:151], v8 offset:10240
    v_cvt_pk_bf16_f32 v240, v224, v225
    v_mfma_f32_16x16x32_bf16 v[228:231], v[108:111], v[76:79], v[228:231]
    s_waitcnt lgkmcnt(4)
    v_cvt_pk_bf16_f32 v241, v226, v227
    ds_read_b128 v[104:107], v8 offset:12288
    v_mfma_f32_16x16x32_bf16 v[160:163], v[112:115], a[0:3], 0
    ds_read_b128 v[108:111], v8 offset:14336
    v_mfma_f32_16x16x32_bf16 v[160:163], v[116:119], a[8:11], v[160:163]
    v_mfma_f32_16x16x32_bf16 v[160:163], v[120:123], a[16:19], v[160:163]
    v_mfma_f32_16x16x32_bf16 v[160:163], v[124:127], a[24:27], v[160:163]
    v_mfma_f32_16x16x32_bf16 v[164:167], v[112:115], a[4:7], 0
    v_cvt_pk_bf16_f32 v242, v228, v229
    v_cvt_pk_bf16_f32 v243, v230, v231
    v_mfma_f32_16x16x32_bf16 v[164:167], v[116:119], a[12:15], v[164:167]
    buffer_store_dwordx4 v[240:243], v1, s[48:51], s11 offen offset:2048 sc1
    v_mfma_f32_16x16x32_bf16 v[164:167], v[120:123], a[20:23], v[164:167]
    ds_read_b128 v[112:115], v8 offset:9216
    ds_read_b128 v[116:119], v8 offset:11264
    v_mfma_f32_16x16x32_bf16 v[164:167], v[124:127], a[28:31], v[164:167]
    ds_read_b128 v[120:123], v8 offset:13312
    v_mfma_f32_16x16x32_bf16 v[168:171], v[128:131], a[0:3], 0
    ds_read_b128 v[124:127], v8 offset:15360
    v_mfma_f32_16x16x32_bf16 v[168:171], v[132:135], a[8:11], v[168:171]
    s_waitcnt lgkmcnt(4)
    v_mfma_f32_16x16x32_bf16 v[168:171], v[136:139], a[16:19], v[168:171]
    v_mfma_f32_16x16x32_bf16 v[168:171], v[140:143], a[24:27], v[168:171]
    v_mfma_f32_16x16x32_bf16 v[172:175], v[128:131], a[4:7], 0
    ds_read_b128 v[128:131], v8 offset:16384
    v_mfma_f32_16x16x32_bf16 v[172:175], v[132:135], a[12:15], v[172:175]
    ds_read_b128 v[132:135], v8 offset:18432
    v_mfma_f32_16x16x32_bf16 v[172:175], v[136:139], a[20:23], v[172:175]
    ds_read_b128 v[136:139], v8 offset:20480
    v_mfma_f32_16x16x32_bf16 v[172:175], v[140:143], a[28:31], v[172:175]
    ds_read_b128 v[140:143], v8 offset:22528
    v_mfma_f32_16x16x32_bf16 v[160:163], v[144:147], a[32:35], v[160:163]
    v_mfma_f32_16x16x32_bf16 v[160:163], v[148:151], a[40:43], v[160:163]
    v_mfma_f32_16x16x32_bf16 v[160:163], v[104:107], a[48:51], v[160:163]
    v_mfma_f32_16x16x32_bf16 v[160:163], v[108:111], a[56:59], v[160:163]
    v_mfma_f32_16x16x32_bf16 v[164:167], v[144:147], a[36:39], v[164:167]
    ds_read_b128 v[144:147], v8 offset:17408
    v_mfma_f32_16x16x32_bf16 v[164:167], v[148:151], a[44:47], v[164:167]
    ds_read_b128 v[148:151], v8 offset:19456
    v_mfma_f32_16x16x32_bf16 v[164:167], v[104:107], a[52:55], v[164:167]
    ds_read_b128 v[104:107], v8 offset:21504
    v_mfma_f32_16x16x32_bf16 v[164:167], v[108:111], a[60:63], v[164:167]
    s_waitcnt lgkmcnt(3)
    ds_read_b128 v[108:111], v8 offset:23552
    v_mfma_f32_16x16x32_bf16 v[168:171], v[112:115], a[32:35], v[168:171]
    v_mfma_f32_16x16x32_bf16 v[168:171], v[116:119], a[40:43], v[168:171]
    v_mfma_f32_16x16x32_bf16 v[168:171], v[120:123], a[48:51], v[168:171]
    v_mfma_f32_16x16x32_bf16 v[168:171], v[124:127], a[56:59], v[168:171]
    v_mfma_f32_16x16x32_bf16 v[172:175], v[112:115], a[36:39], v[172:175]
    ds_read_b128 v[112:115], v8 offset:24576
    v_mfma_f32_16x16x32_bf16 v[172:175], v[116:119], a[44:47], v[172:175]
    ds_read_b128 v[116:119], v8 offset:26624
    v_mfma_f32_16x16x32_bf16 v[172:175], v[120:123], a[52:55], v[172:175]
    ds_read_b128 v[120:123], v8 offset:28672
    v_mfma_f32_16x16x32_bf16 v[172:175], v[124:127], a[60:63], v[172:175]
    ds_read_b128 v[124:127], v8 offset:30720
    v_mfma_f32_16x16x32_bf16 v[160:163], v[128:131], a[64:67], v[160:163]
    v_mfma_f32_16x16x32_bf16 v[160:163], v[132:135], a[72:75], v[160:163]
    v_mfma_f32_16x16x32_bf16 v[160:163], v[136:139], a[80:83], v[160:163]
    v_mfma_f32_16x16x32_bf16 v[160:163], v[140:143], a[88:91], v[160:163]
    v_mfma_f32_16x16x32_bf16 v[164:167], v[128:131], a[68:71], v[164:167]
    ds_read_b128 v[128:131], v8 offset:25600
    v_mfma_f32_16x16x32_bf16 v[164:167], v[132:135], a[76:79], v[164:167]
    ds_read_b128 v[132:135], v8 offset:27648
    v_mfma_f32_16x16x32_bf16 v[164:167], v[136:139], a[84:87], v[164:167]
    ds_read_b128 v[136:139], v8 offset:29696
    v_mfma_f32_16x16x32_bf16 v[164:167], v[140:143], a[92:95], v[164:167]
    s_waitcnt lgkmcnt(3)
    ds_read_b128 v[140:143], v8 offset:31744
    v_mfma_f32_16x16x32_bf16 v[168:171], v[144:147], a[64:67], v[168:171]
    v_mfma_f32_16x16x32_bf16 v[168:171], v[148:151], a[72:75], v[168:171]
    v_mfma_f32_16x16x32_bf16 v[168:171], v[104:107], a[80:83], v[168:171]
    v_mfma_f32_16x16x32_bf16 v[168:171], v[108:111], a[88:91], v[168:171]
    v_mfma_f32_16x16x32_bf16 v[172:175], v[144:147], a[68:71], v[172:175]
    v_mfma_f32_16x16x32_bf16 v[172:175], v[148:151], a[76:79], v[172:175]
    v_mfma_f32_16x16x32_bf16 v[172:175], v[104:107], a[84:87], v[172:175]
    v_mfma_f32_16x16x32_bf16 v[172:175], v[108:111], a[92:95], v[172:175]
    v_mfma_f32_16x16x32_bf16 v[160:163], v[112:115], a[96:99], v[160:163]
    v_mfma_f32_16x16x32_bf16 v[160:163], v[116:119], a[104:107], v[160:163]
    v_mfma_f32_16x16x32_bf16 v[160:163], v[120:123], a[112:115], v[160:163]
    s_waitcnt vmcnt(0)
    buffer_store_dword v31, v23, s[32:35], s22 offen sc1
    v_mfma_f32_16x16x32_bf16 v[160:163], v[124:127], a[120:123], v[160:163]
    s_waitcnt vmcnt(6)
    s_barrier
    ds_read_b128 v[144:147], v8 offset:32768
    v_mfma_f32_16x16x32_bf16 v[164:167], v[112:115], a[100:103], v[164:167]
    ds_read_b128 v[148:151], v8 offset:34816
    ds_read_b128 v[104:107], v8 offset:36864
    v_mfma_f32_16x16x32_bf16 v[164:167], v[116:119], a[108:111], v[164:167]
    ds_read_b128 v[108:111], v8 offset:38912
    v_mfma_f32_16x16x32_bf16 v[164:167], v[120:123], a[116:119], v[164:167]
    ds_read_b128 v[112:115], v8 offset:33792
    v_mfma_f32_16x16x32_bf16 v[164:167], v[124:127], a[124:127], v[164:167]
    s_waitcnt lgkmcnt(5)
    ds_read_b128 v[116:119], v8 offset:35840
    v_mfma_f32_16x16x32_bf16 v[168:171], v[128:131], a[96:99], v[168:171]
    ds_read_b128 v[120:123], v8 offset:37888
    v_mfma_f32_16x16x32_bf16 v[168:171], v[132:135], a[104:107], v[168:171]
    ds_read_b128 v[124:127], v8 offset:39936
    v_mfma_f32_16x16x32_bf16 v[168:171], v[136:139], a[112:115], v[168:171]
    v_mfma_f32_16x16x32_bf16 v[168:171], v[140:143], a[120:123], v[168:171]
    v_mfma_f32_16x16x32_bf16 v[172:175], v[128:131], a[100:103], v[172:175]
    ds_read_b128 v[128:131], v8 offset:40960
    v_mfma_f32_16x16x32_bf16 v[172:175], v[132:135], a[108:111], v[172:175]
    ds_read_b128 v[132:135], v8 offset:43008
    v_mfma_f32_16x16x32_bf16 v[172:175], v[136:139], a[116:119], v[172:175]
    ds_read_b128 v[136:139], v8 offset:45056
    v_mfma_f32_16x16x32_bf16 v[172:175], v[140:143], a[124:127], v[172:175]
    s_waitcnt lgkmcnt(3)
    ds_read_b128 v[140:143], v8 offset:47104
    v_mfma_f32_16x16x32_bf16 v[160:163], v[144:147], a[128:131], v[160:163]
    v_mfma_f32_16x16x32_bf16 v[160:163], v[148:151], a[136:139], v[160:163]
    v_mfma_f32_16x16x32_bf16 v[160:163], v[104:107], a[144:147], v[160:163]
    v_mfma_f32_16x16x32_bf16 v[160:163], v[108:111], a[152:155], v[160:163]
    v_mfma_f32_16x16x32_bf16 v[164:167], v[144:147], a[132:135], v[164:167]
    ds_read_b128 v[144:147], v8 offset:41984
    v_mfma_f32_16x16x32_bf16 v[164:167], v[148:151], a[140:143], v[164:167]
    ds_read_b128 v[148:151], v8 offset:44032
    v_mfma_f32_16x16x32_bf16 v[164:167], v[104:107], a[148:151], v[164:167]
    ds_read_b128 v[104:107], v8 offset:46080
    v_mfma_f32_16x16x32_bf16 v[164:167], v[108:111], a[156:159], v[164:167]
    ds_read_b128 v[108:111], v8 offset:48128
    v_mfma_f32_16x16x32_bf16 v[168:171], v[112:115], a[128:131], v[168:171]
    v_mfma_f32_16x16x32_bf16 v[168:171], v[116:119], a[136:139], v[168:171]
    v_mfma_f32_16x16x32_bf16 v[168:171], v[120:123], a[144:147], v[168:171]
    v_mfma_f32_16x16x32_bf16 v[168:171], v[124:127], a[152:155], v[168:171]
    v_mfma_f32_16x16x32_bf16 v[172:175], v[112:115], a[132:135], v[172:175]
    ds_read_b128 v[112:115], v8 offset:49152
    v_mfma_f32_16x16x32_bf16 v[172:175], v[116:119], a[140:143], v[172:175]
    ds_read_b128 v[116:119], v8 offset:51200
    v_mfma_f32_16x16x32_bf16 v[172:175], v[120:123], a[148:151], v[172:175]
    ds_read_b128 v[120:123], v8 offset:53248
    v_mfma_f32_16x16x32_bf16 v[172:175], v[124:127], a[156:159], v[172:175]
    s_waitcnt lgkmcnt(3)
    ds_read_b128 v[124:127], v8 offset:55296
    v_mfma_f32_16x16x32_bf16 v[160:163], v[128:131], a[160:163], v[160:163]
    v_mfma_f32_16x16x32_bf16 v[160:163], v[132:135], a[168:171], v[160:163]
    v_mfma_f32_16x16x32_bf16 v[160:163], v[136:139], a[176:179], v[160:163]
    v_mfma_f32_16x16x32_bf16 v[160:163], v[140:143], a[184:187], v[160:163]
    v_mfma_f32_16x16x32_bf16 v[164:167], v[128:131], a[164:167], v[164:167]
    ds_read_b128 v[128:131], v8 offset:50176
    v_mfma_f32_16x16x32_bf16 v[164:167], v[132:135], a[172:175], v[164:167]
    buffer_load_dword v3, v19, s[32:35], s66 offen sc1
    v_mfma_f32_16x16x32_bf16 v[164:167], v[136:139], a[180:183], v[164:167]
    ds_read_b128 v[132:135], v8 offset:52224
    ds_read_b128 v[136:139], v8 offset:54272
    v_mfma_f32_16x16x32_bf16 v[164:167], v[140:143], a[188:191], v[164:167]
    ds_read_b128 v[140:143], v8 offset:56320
    v_mfma_f32_16x16x32_bf16 v[168:171], v[144:147], a[160:163], v[168:171]
    v_mfma_f32_16x16x32_bf16 v[168:171], v[148:151], a[168:171], v[168:171]
    v_mfma_f32_16x16x32_bf16 v[168:171], v[104:107], a[176:179], v[168:171]
    v_mfma_f32_16x16x32_bf16 v[168:171], v[108:111], a[184:187], v[168:171]
    v_mfma_f32_16x16x32_bf16 v[172:175], v[144:147], a[164:167], v[172:175]
    ds_read_b128 v[144:147], v8 offset:57344
    v_mfma_f32_16x16x32_bf16 v[172:175], v[148:151], a[172:175], v[172:175]
    ds_read_b128 v[148:151], v8 offset:59392
    v_mfma_f32_16x16x32_bf16 v[172:175], v[104:107], a[180:183], v[172:175]
    ds_read_b128 v[104:107], v8 offset:61440
    v_mfma_f32_16x16x32_bf16 v[172:175], v[108:111], a[188:191], v[172:175]
    s_waitcnt lgkmcnt(3)
    ds_read_b128 v[108:111], v8 offset:63488
    v_mfma_f32_16x16x32_bf16 v[160:163], v[112:115], a[192:195], v[160:163]
    v_mfma_f32_16x16x32_bf16 v[160:163], v[116:119], a[200:203], v[160:163]
    v_mfma_f32_16x16x32_bf16 v[160:163], v[120:123], a[208:211], v[160:163]
    v_mfma_f32_16x16x32_bf16 v[160:163], v[124:127], a[216:219], v[160:163]
    v_mfma_f32_16x16x32_bf16 v[164:167], v[112:115], a[196:199], v[164:167]
    ds_read_b128 v[112:115], v8 offset:58368
    v_mfma_f32_16x16x32_bf16 v[164:167], v[116:119], a[204:207], v[164:167]
    ds_read_b128 v[116:119], v8 offset:60416
    v_mfma_f32_16x16x32_bf16 v[164:167], v[120:123], a[212:215], v[164:167]
    ds_read_b128 v[120:123], v8 offset:62464
    v_mfma_f32_16x16x32_bf16 v[164:167], v[124:127], a[220:223], v[164:167]
    ds_read_b128 v[124:127], v8 offset:64512
    v_mfma_f32_16x16x32_bf16 v[168:171], v[128:131], a[192:195], v[168:171]
    v_mfma_f32_16x16x32_bf16 v[168:171], v[132:135], a[200:203], v[168:171]
    v_mfma_f32_16x16x32_bf16 v[168:171], v[136:139], a[208:211], v[168:171]
    v_mfma_f32_16x16x32_bf16 v[168:171], v[140:143], a[216:219], v[168:171]
    v_mfma_f32_16x16x32_bf16 v[172:175], v[128:131], a[196:199], v[172:175]
    ds_read_b128 v[128:131], v10 offset:12288
    v_mfma_f32_16x16x32_bf16 v[172:175], v[132:135], a[204:207], v[172:175]
    ds_read_b128 v[132:135], v10 offset:13312
    v_mfma_f32_16x16x32_bf16 v[172:175], v[136:139], a[212:215], v[172:175]
    ds_read_b128 v[136:139], v10 offset:14336
    v_mfma_f32_16x16x32_bf16 v[172:175], v[140:143], a[220:223], v[172:175]
    s_waitcnt lgkmcnt(3)
    ds_read_b128 v[140:143], v10 offset:16384
    v_mfma_f32_16x16x32_bf16 v[160:163], v[144:147], a[224:227], v[160:163]
    s_waitcnt vmcnt(0)
    v_cmp_gt_u32 vcc, 1, v3
    s_nop 1
    s_and_b64 vcc, vcc, exec
    s_cbranch_scc1 SPIN_X
BACK_X:
    v_mfma_f32_16x16x32_bf16 v[160:163], v[148:151], a[232:235], v[160:163]
    buffer_load_dwordx4 v[200:203], v1, s[48:51], s98 offen offset:2048 sc1
    v_mfma_f32_16x16x32_bf16 v[160:163], v[104:107], a[240:243], v[160:163]
    s_add_u32 s98, s70, 12288
    buffer_load_dwordx4 v[204:207], v1, s[48:51], s98 offen offset:2048 sc1
    v_mfma_f32_16x16x32_bf16 v[160:163], v[108:111], a[248:251], v[160:163]
    s_add_u32 s98, s70, 24576
    v_mfma_f32_16x16x32_bf16 v[164:167], v[144:147], a[228:231], v[164:167]
    ds_read_b128 v[144:147], v10 offset:17408
    v_mfma_f32_16x16x32_bf16 v[164:167], v[148:151], a[236:239], v[164:167]
    buffer_load_dwordx4 v[208:211], v1, s[48:51], s98 offen offset:2048 sc1
    v_mfma_f32_16x16x32_bf16 v[164:167], v[104:107], a[244:247], v[164:167]
    s_add_u32 s98, s23, 0
    ds_read_b128 v[148:151], v10 offset:18432
    ds_read_b128 v[104:107], v10 offset:20480
    v_mfma_f32_16x16x32_bf16 v[164:167], v[108:111], a[252:255], v[164:167]
    ds_read_b128 v[108:111], v10 offset:21504
    v_mfma_f32_16x16x32_bf16 v[168:171], v[112:115], a[224:227], v[168:171]
    v_mfma_f32_16x16x32_bf16 v[168:171], v[116:119], a[232:235], v[168:171]
    buffer_load_dwordx4 v[176:179], v1, s[48:51], s98 offen offset:0 sc1
    v_mfma_f32_16x16x32_bf16 v[168:171], v[120:123], a[240:243], v[168:171]
    s_add_u32 s98, s23, 12288
    v_mfma_f32_16x16x32_bf16 v[168:171], v[124:127], a[248:251], v[168:171]
    v_mfma_f32_16x16x32_bf16 v[172:175], v[112:115], a[228:231], v[172:175]
    ds_read_b128 v[112:115], v10 offset:22528
    v_mfma_f32_16x16x32_bf16 v[172:175], v[116:119], a[236:239], v[172:175]
    buffer_load_dwordx4 v[180:183], v1, s[48:51], s98 offen offset:0 sc1
    v_mfma_f32_16x16x32_bf16 v[172:175], v[120:123], a[244:247], v[172:175]
    s_add_u32 s98, s23, 24576
    ds_read_b128 v[116:119], v10 offset:24576
    ds_read_b128 v[120:123], v10 offset:25600
    v_mfma_f32_16x16x32_bf16 v[172:175], v[124:127], a[252:255], v[172:175]
    s_waitcnt lgkmcnt(3)
    ds_read_b128 v[124:127], v10 offset:26624
    v_mfma_f32_16x16x32_bf16 v[160:163], v[128:131], v[32:35], v[160:163]
    v_mfma_f32_16x16x32_bf16 v[160:163], v[132:135], v[40:43], v[160:163]
    buffer_load_dwordx4 v[184:187], v1, s[48:51], s98 offen offset:0 sc1
    v_mfma_f32_16x16x32_bf16 v[160:163], v[136:139], v[48:51], v[160:163]
    s_add_u32 s98, s23, 0
    v_mfma_f32_16x16x32_bf16 v[164:167], v[128:131], v[36:39], v[164:167]
    v_mfma_f32_16x16x32_bf16 v[164:167], v[132:135], v[44:47], v[164:167]
    v_mfma_f32_16x16x32_bf16 v[164:167], v[136:139], v[52:55], v[164:167]
    buffer_load_dwordx4 v[188:191], v1, s[48:51], s98 offen offset:1024 sc1
    v_mfma_f32_16x16x32_bf16 v[168:171], v[140:143], v[32:35], v[168:171]
    s_add_u32 s98, s23, 12288
    v_mfma_f32_16x16x32_bf16 v[168:171], v[144:147], v[40:43], v[168:171]
    v_mfma_f32_16x16x32_bf16 v[168:171], v[148:151], v[48:51], v[168:171]
    v_mfma_f32_16x16x32_bf16 v[172:175], v[140:143], v[36:39], v[172:175]
    buffer_load_dwordx4 v[192:195], v1, s[48:51], s98 offen offset:1024 sc1
    v_mfma_f32_16x16x32_bf16 v[172:175], v[144:147], v[44:47], v[172:175]
    s_add_u32 s98, s23, 24576
    v_mfma_f32_16x16x32_bf16 v[172:175], v[148:151], v[52:55], v[172:175]
    v_mfma_f32_16x16x32_bf16 v[160:163], v[104:107], v[56:59], v[160:163]
    v_mfma_f32_16x16x32_bf16 v[160:163], v[108:111], v[64:67], v[160:163]
    s_waitcnt lgkmcnt(0)
    buffer_load_dwordx4 v[196:199], v1, s[48:51], s98 offen offset:1024 sc1
    v_mfma_f32_16x16x32_bf16 v[160:163], v[112:115], v[72:75], v[160:163]
    v_mfma_f32_16x16x32_bf16 v[164:167], v[104:107], v[60:63], v[164:167]
    v_mfma_f32_16x16x32_bf16 v[164:167], v[108:111], v[68:71], v[164:167]
    v_mfma_f32_16x16x32_bf16 v[164:167], v[112:115], v[76:79], v[164:167]
    v_mfma_f32_16x16x32_bf16 v[168:171], v[116:119], v[56:59], v[168:171]
    v_mfma_f32_16x16x32_bf16 v[168:171], v[120:123], v[64:67], v[168:171]
    v_mfma_f32_16x16x32_bf16 v[168:171], v[124:127], v[72:75], v[168:171]
    v_mfma_f32_16x16x32_bf16 v[172:175], v[116:119], v[60:63], v[172:175]
    v_mfma_f32_16x16x32_bf16 v[172:175], v[120:123], v[68:71], v[172:175]
    v_mfma_f32_16x16x32_bf16 v[172:175], v[124:127], v[76:79], v[172:175]
    s_cmp_lg_u32 s4, s61
    s_cbranch_scc1 K1_X2
    s_waitcnt vmcnt(6)
    v_lshlrev_b32 v80, 16, v200
    v_and_b32 v81, 0xffff0000, v200
    v_lshlrev_b32 v82, 16, v204
    v_and_b32 v83, 0xffff0000, v204
    v_lshlrev_b32 v84, 16, v208
    v_and_b32 v85, 0xffff0000, v208
    v_pk_add_f32 v[80:81], v[80:81], v[82:83]
    v_pk_add_f32 v[224:225], v[224:225], v[84:85]
    v_pk_add_f32 v[224:225], v[224:225], v[80:81]
    v_cvt_pk_bf16_f32 v200, v224, v225
    v_lshlrev_b32 v86, 16, v201
    v_and_b32 v87, 0xffff0000, v201
    v_lshlrev_b32 v88, 16, v205
    v_and_b32 v89, 0xffff0000, v205
    v_lshlrev_b32 v90, 16, v209
    v_and_b32 v91, 0xffff0000, v209
    v_pk_add_f32 v[86:87], v[86:87], v[88:89]
    v_pk_add_f32 v[226:227], v[226:227], v[90:91]
    v_pk_add_f32 v[226:227], v[226:227], v[86:87]
    v_cvt_pk_bf16_f32 v201, v226, v227
    buffer_store_dwordx2 v[200:201], v20, s[24:27], s65 offen
    v_lshlrev_b32 v92, 16, v202
    v_and_b32 v93, 0xffff0000, v202
    v_lshlrev_b32 v94, 16, v206
    v_and_b32 v95, 0xffff0000, v206
    v_lshlrev_b32 v96, 16, v210
    v_and_b32 v97, 0xffff0000, v210
    v_pk_add_f32 v[92:93], v[92:93], v[94:95]
    v_pk_add_f32 v[228:229], v[228:229], v[96:97]
    v_pk_add_f32 v[228:229], v[228:229], v[92:93]
    v_cvt_pk_bf16_f32 v202, v228, v229
    v_lshlrev_b32 v98, 16, v203
    v_and_b32 v99, 0xffff0000, v203
    v_lshlrev_b32 v100, 16, v207
    v_and_b32 v101, 0xffff0000, v207
    v_lshlrev_b32 v102, 16, v211
    v_and_b32 v103, 0xffff0000, v211
    v_pk_add_f32 v[98:99], v[98:99], v[100:101]
    v_pk_add_f32 v[230:231], v[230:231], v[102:103]
    v_pk_add_f32 v[230:231], v[230:231], v[98:99]
    v_cvt_pk_bf16_f32 v203, v230, v231
    buffer_store_dwordx2 v[202:203], v21, s[24:27], s65 offen
    s_waitcnt vmcnt(2)
K1_X2:
    s_waitcnt vmcnt(3)
    v_lshlrev_b32 v80, 16, v176
    v_and_b32 v81, 0xffff0000, v176
    v_lshlrev_b32 v82, 16, v180
    v_and_b32 v83, 0xffff0000, v180
    v_lshlrev_b32 v84, 16, v184
    v_and_b32 v85, 0xffff0000, v184
    v_pk_add_f32 v[80:81], v[80:81], v[82:83]
    v_pk_add_f32 v[160:161], v[160:161], v[84:85]
    v_pk_add_f32 v[160:161], v[160:161], v[80:81]
    v_cvt_pk_bf16_f32 v176, v160, v161
    v_lshlrev_b32 v86, 16, v177
    v_and_b32 v87, 0xffff0000, v177
    v_lshlrev_b32 v88, 16, v181
    v_and_b32 v89, 0xffff0000, v181
    v_lshlrev_b32 v90, 16, v185
    v_and_b32 v91, 0xffff0000, v185
    v_pk_add_f32 v[86:87], v[86:87], v[88:89]
    v_pk_add_f32 v[162:163], v[162:163], v[90:91]
    v_pk_add_f32 v[162:163], v[162:163], v[86:87]
    v_cvt_pk_bf16_f32 v177, v162, v163
    buffer_store_dwordx2 v[176:177], v20, s[24:27], s64 offen
    v_lshlrev_b32 v92, 16, v178
    v_and_b32 v93, 0xffff0000, v178
    v_lshlrev_b32 v94, 16, v182
    v_and_b32 v95, 0xffff0000, v182
    v_lshlrev_b32 v96, 16, v186
    v_and_b32 v97, 0xffff0000, v186
    v_pk_add_f32 v[92:93], v[92:93], v[94:95]
    v_pk_add_f32 v[164:165], v[164:165], v[96:97]
    v_pk_add_f32 v[164:165], v[164:165], v[92:93]
    v_cvt_pk_bf16_f32 v178, v164, v165
    v_lshlrev_b32 v98, 16, v179
    v_and_b32 v99, 0xffff0000, v179
    v_lshlrev_b32 v100, 16, v183
    v_and_b32 v101, 0xffff0000, v183
    v_lshlrev_b32 v102, 16, v187
    v_and_b32 v103, 0xffff0000, v187
    v_pk_add_f32 v[98:99], v[98:99], v[100:101]
    v_pk_add_f32 v[166:167], v[166:167], v[102:103]
    v_pk_add_f32 v[166:167], v[166:167], v[98:99]
    v_cvt_pk_bf16_f32 v179, v166, v167
    buffer_store_dwordx2 v[178:179], v21, s[24:27], s64 offen
    s_waitcnt vmcnt(2)
    v_lshlrev_b32 v80, 16, v188
    v_and_b32 v81, 0xffff0000, v188
    v_lshlrev_b32 v82, 16, v192
    v_and_b32 v83, 0xffff0000, v192
    v_lshlrev_b32 v84, 16, v196
    v_and_b32 v85, 0xffff0000, v196
    v_pk_add_f32 v[80:81], v[80:81], v[82:83]
    v_pk_add_f32 v[168:169], v[168:169], v[84:85]
    v_pk_add_f32 v[168:169], v[168:169], v[80:81]
    v_cvt_pk_bf16_f32 v188, v168, v169
    v_lshlrev_b32 v86, 16, v189
    v_and_b32 v87, 0xffff0000, v189
    v_lshlrev_b32 v88, 16, v193
    v_and_b32 v89, 0xffff0000, v193
    v_lshlrev_b32 v90, 16, v197
    v_and_b32 v91, 0xffff0000, v197
    v_pk_add_f32 v[86:87], v[86:87], v[88:89]
    v_pk_add_f32 v[170:171], v[170:171], v[90:91]
    v_pk_add_f32 v[170:171], v[170:171], v[86:87]
    v_cvt_pk_bf16_f32 v189, v170, v171
    buffer_store_dwordx2 v[188:189], v20, s[24:27], s64 offen offset:32
    v_lshlrev_b32 v92, 16, v190
    v_and_b32 v93, 0xffff0000, v190
    v_lshlrev_b32 v94, 16, v194
    v_and_b32 v95, 0xffff0000, v194
    v_lshlrev_b32 v96, 16, v198
    v_and_b32 v97, 0xffff0000, v198
    v_pk_add_f32 v[92:93], v[92:93], v[94:95]
    v_pk_add_f32 v[172:173], v[172:173], v[96:97]
    v_pk_add_f32 v[172:173], v[172:173], v[92:93]
    v_cvt_pk_bf16_f32 v190, v172, v173
    v_lshlrev_b32 v98, 16, v191
    v_and_b32 v99, 0xffff0000, v191
    v_lshlrev_b32 v100, 16, v195
    v_and_b32 v101, 0xffff0000, v195
    v_lshlrev_b32 v102, 16, v199
    v_and_b32 v103, 0xffff0000, v199
    v_pk_add_f32 v[98:99], v[98:99], v[100:101]
    v_pk_add_f32 v[174:175], v[174:175], v[102:103]
    v_pk_add_f32 v[174:175], v[174:175], v[98:99]
    v_cvt_pk_bf16_f32 v191, v174, v175
    buffer_store_dwordx2 v[190:191], v21, s[24:27], s64 offen offset:32
K1_END:
    s_endpgm
K1_LB_MASK:
    s_nop 1
    v_add_f32 v212, s12, v144
    v_fma_f32 v176, v208, s8, v212
    v_fma_f32 v177, v209, s8, v212
    v_fma_f32 v178, v210, s8, v212
    v_fma_f32 v179, v211, s8, v212
    v_add_f32 v213, s13, v144
    v_fma_f32 v180, v208, s9, v213
    v_fma_f32 v181, v209, s9, v213
    v_fma_f32 v182, v210, s9, v213
    v_fma_f32 v183, v211, s9, v213
    v_add_f32 v214, s14, v144
    v_fma_f32 v184, v208, s10, v214
    v_fma_f32 v185, v209, s10, v214
    v_fma_f32 v186, v210, s10, v214
    v_fma_f32 v187, v211, s10, v214
    v_add_f32 v215, s15, v144
    v_fma_f32 v188, v208, s11, v215
    v_fma_f32 v189, v209, s11, v215
    v_fma_f32 v190, v210, s11, v215
    v_fma_f32 v191, v211, s11, v215
    s_nop 1
    s_branch K1_LB_BACK
K1_LS_MASK:
    s_nop 1
    v_add_f32 v212, s12, v152
    v_fma_f32 v176, v208, s8, v212
    v_fma_f32 v177, v209, s8, v212
    v_fma_f32 v178, v210, s8, v212
    v_fma_f32 v179, v211, s8, v212
    v_add_f32 v213, s13, v152
    v_fma_f32 v180, v208, s9, v213
    v_fma_f32 v181, v209, s9, v213
    v_fma_f32 v182, v210, s9, v213
    v_fma_f32 v183, v211, s9, v213
    v_add_f32 v214, s14, v152
    v_fma_f32 v184, v208, s10, v214
    v_fma_f32 v185, v209, s10, v214
    v_fma_f32 v186, v210, s10, v214
    v_fma_f32 v187, v211, s10, v214
    v_add_f32 v215, s15, v152
    v_fma_f32 v188, v208, s11, v215
    v_fma_f32 v189, v209, s11, v215
    v_fma_f32 v190, v210, s11, v215
    v_fma_f32 v191, v211, s11, v215
    s_nop 1
    s_branch K1_LS_BACK
K1_HAVEM_R:
    s_add_u32 m0, s76, s75
    s_nop 0
    buffer_load_dwordx4 v1, s[36:39], s77 offen sc1 lds
    buffer_load_dwordx4 v1, s[36:39], s77 offen offset:1024 sc1 lds
    buffer_load_dwordx4 v1, s[36:39], s77 offen offset:2048 sc1 lds
    buffer_load_dwordx4 v1, s[36:39], s77 offen offset:3072 sc1 lds
    s_add_u32 s100, s77, 4096
    s_add_u32 m0, m0, 4096
    s_nop 0
    buffer_load_dwordx4 v1, s[36:39], s100 offen sc1 lds
    buffer_load_dwordx4 v1, s[36:39], s100 offen offset:1024 sc1 lds
    buffer_load_dwordx4 v1, s[36:39], s100 offen offset:2048 sc1 lds
    buffer_load_dwordx4 v1, s[36:39], s100 offen offset:3072 sc1 lds
    s_add_u32 s77, s77, 32768
    s_add_u32 s76, s76, 32768
    s_branch K1_HAVEM
K1_REDO:
    s_mov_b32 s83, 1
    s_waitcnt vmcnt(0) lgkmcnt(0)
    s_barrier
    v_lshrrev_b32 v92, 4, v1
    v_and_b32 v64, 15, v92
    v_lshrrev_b32 v92, 4, v92
    v_lshlrev_b32 v92, 2, v92
    v_sub_u32 v92, v64, v92
    s_lshl_b32 s98, s4, 4
    v_add_u32 v92, s98, v92
    s_lshl_b32 s98, s6, 7
    s_sub_u32 s99, 1920, s98
    v_add_u32 v64, s98, v92
    v_add_u32 v65, 64, v64
    v_add_u32 v66, s99, v92
    v_add_u32 v67, 64, v66
    v_mov_b32 v93, 0xf149f2ca
    v_mov_b32 v68, v93
    v_mov_b32 v69, v93
    v_mov_b32 v70, v93
    v_mov_b32 v71, v93
    s_mov_b32 s78, 0
    s_add_u32 s99, s99, 128
K1_REDO_L:
    s_lshr_b32 s7, s78, 6
    s_lshl_b32 s7, s7, 15
    s_bfe_u32 s98, s78, 0x20004
    s_lshl_b32 s98, s98, 12
    s_add_u32 s7, s7, s98
    buffer_load_dwordx4 v[72:75], v1, s[36:39], s7 offen offset:0 sc1
    buffer_load_dwordx4 v[76:79], v1, s[36:39], s7 offen offset:1024 sc1
    buffer_load_dwordx4 v[80:83], v1, s[36:39], s7 offen offset:2048 sc1
    buffer_load_dwordx4 v[84:87], v1, s[36:39], s7 offen offset:3072 sc1
    s_waitcnt vmcnt(0)
    v_mfma_f32_16x16x32_bf16 v[88:91], v[72:75], v[128:131], 0
    v_mfma_f32_16x16x32_bf16 v[88:91], v[76:79], v[160:163], v[88:91]
    v_mfma_f32_16x16x32_bf16 v[88:91], v[80:83], v[192:195], v[88:91]
    v_mfma_f32_16x16x32_bf16 v[88:91], v[84:87], v[224:227], v[88:91]
    v_subrev_u32 v92, s78, v64
    v_cmp_le_i32 vcc, 0, v92
    s_nop 5
    v_cndmask_b32 v88, v93, v88, vcc
    v_max_f32 v68, v68, v88
    v_cmp_le_i32 vcc, 1, v92
    s_nop 1
    v_cndmask_b32 v89, v93, v89, vcc
    v_max_f32 v68, v68, v89
    v_cmp_le_i32 vcc, 2, v92
    s_nop 1
    v_cndmask_b32 v90, v93, v90, vcc
    v_max_f32 v68, v68, v90
    v_cmp_le_i32 vcc, 3, v92
    s_nop 1
    v_cndmask_b32 v91, v93, v91, vcc
    v_max_f32 v68, v68, v91
    v_mfma_f32_16x16x32_bf16 v[88:91], v[72:75], v[132:135], 0
    v_mfma_f32_16x16x32_bf16 v[88:91], v[76:79], v[164:167], v[88:91]
    v_mfma_f32_16x16x32_bf16 v[88:91], v[80:83], v[196:199], v[88:91]
    v_mfma_f32_16x16x32_bf16 v[88:91], v[84:87], v[228:231], v[88:91]
    v_subrev_u32 v92, s78, v65
    v_cmp_le_i32 vcc, 0, v92
    s_nop 5
    v_cndmask_b32 v88, v93, v88, vcc
    v_max_f32 v69, v69, v88
    v_cmp_le_i32 vcc, 1, v92
    s_nop 1
    v_cndmask_b32 v89, v93, v89, vcc
    v_max_f32 v69, v69, v89
    v_cmp_le_i32 vcc, 2, v92
    s_nop 1
    v_cndmask_b32 v90, v93, v90, vcc
    v_max_f32 v69, v69, v90
    v_cmp_le_i32 vcc, 3, v92
    s_nop 1
    v_cndmask_b32 v91, v93, v91, vcc
    v_max_f32 v69, v69, v91
    v_mfma_f32_16x16x32_bf16 v[88:91], v[72:75], v[136:139], 0
    v_mfma_f32_16x16x32_bf16 v[88:91], v[76:79], v[168:171], v[88:91]
    v_mfma_f32_16x16x32_bf16 v[88:91], v[80:83], v[200:203], v[88:91]
    v_mfma_f32_16x16x32_bf16 v[88:91], v[84:87], v[232:235], v[88:91]
    v_subrev_u32 v92, s78, v66
    v_cmp_le_i32 vcc, 0, v92
    s_nop 5
    v_cndmask_b32 v88, v93, v88, vcc
    v_max_f32 v70, v70, v88
    v_cmp_le_i32 vcc, 1, v92
    s_nop 1
    v_cndmask_b32 v89, v93, v89, vcc
    v_max_f32 v70, v70, v89
    v_cmp_le_i32 vcc, 2, v92
    s_nop 1
    v_cndmask_b32 v90, v93, v90, vcc
    v_max_f32 v70, v70, v90
    v_cmp_le_i32 vcc, 3, v92
    s_nop 1
    v_cndmask_b32 v91, v93, v91, vcc
    v_max_f32 v70, v70, v91
    v_mfma_f32_16x16x32_bf16 v[88:91], v[72:75], v[140:143], 0
    v_mfma_f32_16x16x32_bf16 v[88:91], v[76:79], v[172:175], v[88:91]
    v_mfma_f32_16x16x32_bf16 v[88:91], v[80:83], v[204:207], v[88:91]
    v_mfma_f32_16x16x32_bf16 v[88:91], v[84:87], v[236:239], v[88:91]
    v_subrev_u32 v92, s78, v67
    v_cmp_le_i32 vcc, 0, v92
    s_nop 5
    v_cndmask_b32 v88, v93, v88, vcc
    v_max_f32 v71, v71, v88
    v_cmp_le_i32 vcc, 1, v92
    s_nop 1
    v_cndmask_b32 v89, v93, v89, vcc
    v_max_f32 v71, v71, v89
    v_cmp_le_i32 vcc, 2, v92
    s_nop 1
    v_cndmask_b32 v90, v93, v90, vcc
    v_max_f32 v71, v71, v90
    v_cmp_le_i32 vcc, 3, v92
    s_nop 1
    v_cndmask_b32 v91, v93, v91, vcc
    v_max_f32 v71, v71, v91
    s_add_u32 s78, s78, 16
    s_cmp_lt_u32 s78, s99
    s_cbranch_scc1 K1_REDO_L
    v_mov_b32 v92, v68
    s_nop 1
    v_permlane32_swap_b32 v68, v92
    v_max_f32 v68, v68, v92
    v_mov_b32 v92, v68
    s_nop 1
    v_permlane16_swap_b32 v68, v92
    v_max_f32 v68, v68, v92
    v_sub_f32 v144, 0, v68
    v_sub_f32 v145, 0, v68
    v_sub_f32 v146, 0, v68
    v_sub_f32 v147, 0, v68
    v_mov_b32 v92, v69
    s_nop 1
    v_permlane32_swap_b32 v69, v92
    v_max_f32 v69, v69, v92
    v_mov_b32 v92, v69
    s_nop 1
    v_permlane16_swap_b32 v69, v92
    v_max_f32 v69, v69, v92
    v_sub_f32 v148, 0, v69
    v_sub_f32 v149, 0, v69
    v_sub_f32 v150, 0, v69
    v_sub_f32 v151, 0, v69
    v_mov_b32 v92, v70
    s_nop 1
    v_permlane32_swap_b32 v70, v92
    v_max_f32 v70, v70, v92
    v_mov_b32 v92, v70
    s_nop 1
    v_permlane16_swap_b32 v70, v92
    v_max_f32 v70, v70, v92
    v_sub_f32 v152, 0, v70
    v_sub_f32 v153, 0, v70
    v_sub_f32 v154, 0, v70
    v_sub_f32 v155, 0, v70
    v_mov_b32 v92, v71
    s_nop 1
    v_permlane32_swap_b32 v71, v92
    v_max_f32 v71, v71, v92
    v_mov_b32 v92, v71
    s_nop 1
    v_permlane16_swap_b32 v71, v92
    v_max_f32 v71, v71, v92
    v_sub_f32 v156, 0, v71
    v_sub_f32 v157, 0, v71
    v_sub_f32 v158, 0, v71
    v_sub_f32 v159, 0, v71
    v_accvgpr_write_b32 a0, 0
    v_accvgpr_write_b32 a1, 0
    v_accvgpr_write_b32 a2, 0
    v_accvgpr_write_b32 a3, 0
    v_accvgpr_write_b32 a4, 0
    v_accvgpr_write_b32 a5, 0
    v_accvgpr_write_b32 a6, 0
    v_accvgpr_write_b32 a7, 0
    v_accvgpr_write_b32 a8, 0
    v_accvgpr_write_b32 a9, 0
    v_accvgpr_write_b32 a10, 0
    v_accvgpr_write_b32 a11, 0
    v_accvgpr_write_b32 a12, 0
    v_accvgpr_write_b32 a13, 0
    v_accvgpr_write_b32 a14, 0
    v_accvgpr_write_b32 a15, 0
    v_accvgpr_write_b32 a16, 0
    v_accvgpr_write_b32 a17, 0
    v_accvgpr_write_b32 a18, 0
    v_accvgpr_write_b32 a19, 0
    v_accvgpr_write_b32 a20, 0
    v_accvgpr_write_b32 a21, 0
    v_accvgpr_write_b32 a22, 0
    v_accvgpr_write_b32 a23, 0
    v_accvgpr_write_b32 a24, 0
    v_accvgpr_write_b32 a25, 0
    v_accvgpr_write_b32 a26, 0
    v_accvgpr_write_b32 a27, 0
    v_accvgpr_write_b32 a28, 0
    v_accvgpr_write_b32 a29, 0
    v_accvgpr_write_b32 a30, 0
    v_accvgpr_write_b32 a31, 0
    v_accvgpr_write_b32 a32, 0
    v_accvgpr_write_b32 a33, 0
    v_accvgpr_write_b32 a34, 0
    v_accvgpr_write_b32 a35, 0
    v_accvgpr_write_b32 a36, 0
    v_accvgpr_write_b32 a37, 0
    v_accvgpr_write_b32 a38, 0
    v_accvgpr_write_b32 a39, 0
    v_accvgpr_write_b32 a40, 0
    v_accvgpr_write_b32 a41, 0
    v_accvgpr_write_b32 a42, 0
    v_accvgpr_write_b32 a43, 0
    v_accvgpr_write_b32 a44, 0
    v_accvgpr_write_b32 a45, 0
    v_accvgpr_write_b32 a46, 0
    v_accvgpr_write_b32 a47, 0
    v_accvgpr_write_b32 a48, 0
    v_accvgpr_write_b32 a49, 0
    v_accvgpr_write_b32 a50, 0
    v_accvgpr_write_b32 a51, 0
    v_accvgpr_write_b32 a52, 0
    v_accvgpr_write_b32 a53, 0
    v_accvgpr_write_b32 a54, 0
    v_accvgpr_write_b32 a55, 0
    v_accvgpr_write_b32 a56, 0
    v_accvgpr_write_b32 a57, 0
    v_accvgpr_write_b32 a58, 0
    v_accvgpr_write_b32 a59, 0
    v_accvgpr_write_b32 a60, 0
    v_accvgpr_write_b32 a61, 0
    v_accvgpr_write_b32 a62, 0
    v_accvgpr_write_b32 a63, 0
    v_accvgpr_write_b32 a144, 0
    v_accvgpr_write_b32 a145, 0
    v_accvgpr_write_b32 a146, 0
    v_accvgpr_write_b32 a147, 0
    v_accvgpr_write_b32 a148, 0
    v_accvgpr_write_b32 a149, 0
    v_accvgpr_write_b32 a150, 0
    v_accvgpr_write_b32 a151, 0
    v_accvgpr_write_b32 a152, 0
    v_accvgpr_write_b32 a153, 0
    v_accvgpr_write_b32 a154, 0
    v_accvgpr_write_b32 a155, 0
    v_accvgpr_write_b32 a156, 0
    v_accvgpr_write_b32 a157, 0
    v_accvgpr_write_b32 a158, 0
    v_accvgpr_write_b32 a159, 0
    v_accvgpr_write_b32 a160, 0
    v_accvgpr_write_b32 a161, 0
    v_accvgpr_write_b32 a162, 0
    v_accvgpr_write_b32 a163, 0
    v_accvgpr_write_b32 a164, 0
    v_accvgpr_write_b32 a165, 0
    v_accvgpr_write_b32 a166, 0
    v_accvgpr_write_b32 a167, 0
    v_accvgpr_write_b32 a168, 0
    v_accvgpr_write_b32 a169, 0
    v_accvgpr_write_b32 a170, 0
    v_accvgpr_write_b32 a171, 0
    v_accvgpr_write_b32 a172, 0
    v_accvgpr_write_b32 a173, 0
    v_accvgpr_write_b32 a174, 0
    v_accvgpr_write_b32 a175, 0
    v_accvgpr_write_b32 a176, 0
    v_accvgpr_write_b32 a177, 0
    v_accvgpr_write_b32 a178, 0
    v_accvgpr_write_b32 a179, 0
    v_accvgpr_write_b32 a180, 0
    v_accvgpr_write_b32 a181, 0
    v_accvgpr_write_b32 a182, 0
    v_accvgpr_write_b32 a183, 0
    v_accvgpr_write_b32 a184, 0
    v_accvgpr_write_b32 a185, 0
    v_accvgpr_write_b32 a186, 0
    v_accvgpr_write_b32 a187, 0
    v_accvgpr_write_b32 a188, 0
    v_accvgpr_write_b32 a189, 0
    v_accvgpr_write_b32 a190, 0
    v_accvgpr_write_b32 a191, 0
    v_accvgpr_write_b32 a192, 0
    v_accvgpr_write_b32 a193, 0
    v_accvgpr_write_b32 a194, 0
    v_accvgpr_write_b32 a195, 0
    v_accvgpr_write_b32 a196, 0
    v_accvgpr_write_b32 a197, 0
    v_accvgpr_write_b32 a198, 0
    v_accvgpr_write_b32 a199, 0
    v_accvgpr_write_b32 a200, 0
    v_accvgpr_write_b32 a201, 0
    v_accvgpr_write_b32 a202, 0
    v_accvgpr_write_b32 a203, 0
    v_accvgpr_write_b32 a204, 0
    v_accvgpr_write_b32 a205, 0
    v_accvgpr_write_b32 a206, 0
    v_accvgpr_write_b32 a207, 0
    v_accvgpr_write_b32 a208, 0
    v_accvgpr_write_b32 a209, 0
    v_accvgpr_write_b32 a210, 0
    v_accvgpr_write_b32 a211, 0
    v_accvgpr_write_b32 a212, 0
    v_accvgpr_write_b32 a213, 0
    v_accvgpr_write_b32 a214, 0
    v_accvgpr_write_b32 a215, 0
    v_accvgpr_write_b32 a216, 0
    v_accvgpr_write_b32 a217, 0
    v_accvgpr_write_b32 a218, 0
    v_accvgpr_write_b32 a219, 0
    v_accvgpr_write_b32 a220, 0
    v_accvgpr_write_b32 a221, 0
    v_accvgpr_write_b32 a222, 0
    v_accvgpr_write_b32 a223, 0
    v_mov_b32 v92, 0x3f803f80
    v_accvgpr_write_b32 a136, v92
    v_accvgpr_write_b32 a137, v92
    v_accvgpr_write_b32 a138, v92
    v_accvgpr_write_b32 a139, v92
    s_mov_b32 s77, s75
    s_mov_b32 s76, 0
    s_mov_b32 s38, 16384
    s_add_u32 m0, s76, s75
    s_nop 0
    buffer_load_dwordx4 v1, s[36:39], s77 offen sc1 lds
    buffer_load_dwordx4 v1, s[36:39], s77 offen offset:1024 sc1 lds
    buffer_load_dwordx4 v1, s[36:39], s77 offen offset:2048 sc1 lds
    buffer_load_dwordx4 v1, s[36:39], s77 offen offset:3072 sc1 lds
    s_add_u32 s100, s77, 4096
    s_add_u32 m0, m0, 4096
    s_nop 0
    buffer_load_dwordx4 v1, s[36:39], s100 offen sc1 lds
    buffer_load_dwordx4 v1, s[36:39], s100 offen offset:1024 sc1 lds
    buffer_load_dwordx4 v1, s[36:39], s100 offen offset:2048 sc1 lds
    buffer_load_dwordx4 v1, s[36:39], s100 offen offset:3072 sc1 lds
    s_add_u32 s77, s77, 32768
    s_add_u32 s76, s76, 32768
    s_lshr_b32 s82, s4, 1
    s_add_u32 s82, s82, 32
    s_sub_u32 s82, s82, s6
    s_sub_u32 s82, s82, s6
    s_lshl_b32 s38, s82, 15
    s_add_u32 m0, s76, s75
    s_nop 0
    buffer_load_dwordx4 v1, s[36:39], s77 offen sc1 lds
    buffer_load_dwordx4 v1, s[36:39], s77 offen offset:1024 sc1 lds
    buffer_load_dwordx4 v1, s[36:39], s77 offen offset:2048 sc1 lds
    buffer_load_dwordx4 v1, s[36:39], s77 offen offset:3072 sc1 lds
    s_add_u32 s100, s77, 4096
    s_add_u32 m0, m0, 4096
    s_nop 0
    buffer_load_dwordx4 v1, s[36:39], s100 offen sc1 lds
    buffer_load_dwordx4 v1, s[36:39], s100 offen offset:1024 sc1 lds
    buffer_load_dwordx4 v1, s[36:39], s100 offen offset:2048 sc1 lds
    buffer_load_dwordx4 v1, s[36:39], s100 offen offset:3072 sc1 lds
    s_add_u32 s77, s77, 32768
    s_add_u32 s76, s76, 32768
    s_branch K1_ATT
SPIN_WA:
    s_mov_b32 s94, 0
SPIN_WA_L:
    s_sleep 2
    buffer_load_dword v7, v9, s[44:47], s69 offen sc1
    s_add_u32 s94, s94, 1
    s_cmp_ge_u32 s94, 0x40000
    s_waitcnt vmcnt(0)
    s_cbranch_scc1 BACK_WA
    v_cmp_gt_u32 vcc, 8, v7
    s_nop 1
    s_and_b64 vcc, vcc, s[86:87]
    s_cbranch_scc1 SPIN_WA_L
    s_branch BACK_WA
SPIN_KV:
    s_mov_b32 s94, 0
SPIN_KV_L:
    s_sleep 2
    buffer_load_dword v7, v8, s[32:35], s61 offen sc1
    s_add_u32 s94, s94, 1
    s_cmp_ge_u32 s94, 0x40000
    s_waitcnt vmcnt(0)
    s_cbranch_scc1 BACK_KV
    v_cmp_gt_u32 vcc, 1, v7
    s_nop 1
    s_and_b64 vcc, vcc, exec
    s_cbranch_scc1 SPIN_KV_L
    s_branch BACK_KV
SPIN_ALL:
    s_mov_b32 s94, 0
SPIN_ALL_L:
    s_sleep 2
    buffer_load_dword v3, v29, s[44:47], 0 offen sc1
    s_add_u32 s94, s94, 1
    s_cmp_ge_u32 s94, 0x40000
    s_waitcnt vmcnt(0)
    s_cbranch_scc1 BACK_ALL
    v_cmp_gt_u32 vcc, 16, v3
    s_nop 1
    s_and_b64 vcc, vcc, s[92:93]
    s_cbranch_scc1 SPIN_ALL_L
    s_branch BACK_ALL
SPIN_CTX:
    s_mov_b32 s94, 0
SPIN_CTX_L:
    s_sleep 2
    buffer_load_dword v3, v19, s[32:35], s66 offen sc1
    s_add_u32 s94, s94, 1
    s_cmp_ge_u32 s94, 0x40000
    s_waitcnt vmcnt(0)
    s_cbranch_scc1 BACK_CTX
    v_cmp_gt_u32 vcc, 2, v3
    s_nop 1
    s_and_b64 vcc, vcc, exec
    s_cbranch_scc1 SPIN_CTX_L
    s_branch BACK_CTX
SPIN_OA:
    s_mov_b32 s94, 0
SPIN_OA_L:
    s_sleep 2
    buffer_load_dword v3, v19, s[32:35], s66 offen sc1
    s_add_u32 s94, s94, 1
    s_cmp_ge_u32 s94, 0x40000
    s_waitcnt vmcnt(0)
    s_cbranch_scc1 BACK_OA
    v_cmp_gt_u32 vcc, 3, v3
    s_nop 1
    s_and_b64 vcc, vcc, exec
    s_cbranch_scc1 SPIN_OA_L
    s_branch BACK_OA
SPIN_X:
    s_mov_b32 s94, 0
SPIN_X_L:
    s_sleep 2
    buffer_load_dword v3, v19, s[32:35], s66 offen sc1
    s_add_u32 s94, s94, 1
    s_cmp_ge_u32 s94, 0x40000
    s_waitcnt vmcnt(0)
    s_cbranch_scc1 BACK_X
    v_cmp_gt_u32 vcc, 1, v3
    s_nop 1
    s_and_b64 vcc, vcc, exec
    s_cbranch_scc1 SPIN_X_L
    s_branch BACK_X
.section .rodata,"a"
.p2align 6
.amdhsa_kernel gated_mix__sliding_local_dilated__compressed_kv_cla__prompt_kernel
.amdhsa_next_free_vgpr 512
.amdhsa_next_free_sgpr 102
.amdhsa_accum_offset 256
.amdhsa_group_segment_fixed_size 0
.amdhsa_kernarg_size 104
.amdhsa_user_sgpr_count 2
.amdhsa_user_sgpr_kernarg_segment_ptr 1
.amdhsa_system_sgpr_workgroup_id_x 1
.amdhsa_ieee_mode 0
.amdhsa_dx10_clamp 0
.end_amdhsa_kernel
```

```asm
; @launch grid=(256,1,1) block=(256,1,1) lds=163840
.amdgcn_target "amdgcn-amd-amdhsa--gfx950"
.text
.globl gated_mix__sliding_local_dilated__compressed_kv_cla__prompt_kernel
.p2align 8
.type gated_mix__sliding_local_dilated__compressed_kv_cla__prompt_kernel,@function
gated_mix__sliding_local_dilated__compressed_kv_cla__prompt_kernel:
    s_cmp_ge_u32 s2, 256
    s_cbranch_scc1 K1_END
    s_getpc_b64 s[94:95]
    s_load_dwordx8 s[36:43], s[0:1], 32
    v_min_u32 v74, 16, v0
    s_lshr_b32 s7, s2, 3
    s_mul_i32 s7, s7, 17
    v_add_lshl_u32 v74, v74, s7, 7
    global_load_dword v76, v74, s[94:95]
    v_lshrrev_b32 v64, 6, v0
    v_and_b32 v31, 63, v0
    v_readfirstlane_b32 s4, v64
    s_and_b32 s5, s2, 7
    s_lshl_b32 s5, s5, 2
    s_bfe_u32 s7, s2, 0x20003
    s_add_u32 s5, s5, s7
    s_lshr_b32 s6, s2, 5
    s_lshl_b32 s69, s4, 12
    s_mov_b32 s10, 2097152
    s_mov_b32 s11, 0x20000
    s_mov_b32 s14, 4194304
    s_mov_b32 s15, 0x20000
    s_mov_b32 s18, 4194304
    s_mov_b32 s19, 0x20000
    v_lshrrev_b32 v65, 3, v31
    v_and_b32 v66, 7, v31
    v_lshrrev_b32 v67, 1, v65
    v_xor_b32 v66, v66, v67
    v_lshlrev_b32 v66, 4, v66
    v_xor_b32 v67, 64, v66
    s_lshr_b32 s7, s4, 1
    s_lshl_b32 s73, s7, 7
    s_and_b32 s100, s4, 1
    s_lshl_b32 s98, s100, 5
    s_add_u32 s98, s98, s73
    v_add_lshl_u32 v68, v65, s98, 10
    v_add_u32 v6, v68, v66
    v_add_u32 v7, v68, v67
    v_add_u32 v7, 7168, v7
    v_add_u32 v8, v68, v66
    v_add_u32 v8, 14336, v8
    v_add_u32 v9, v68, v67
    v_add_u32 v9, 21504, v9
    v_lshrrev_b32 v69, 4, v31
    v_and_b32 v70, 15, v31
    v_lshlrev_b32 v71, 1, v69
    v_xor_b32 v71, v71, v70
    v_lshlrev_b32 v71, 4, v71
    v_xor_b32 v72, 128, v71
    s_lshl_b32 s98, s4, 4
    v_add_lshl_u32 v73, v69, s98, 13
    v_add_u32 v2, v73, v71
    v_add_u32 v3, v73, v71
    v_add_u32 v3, 31744, v3
    v_add_u32 v4, v73, v72
    v_add_u32 v4, 63488, v4
    v_add_u32 v5, v73, v72
    v_add_u32 v5, 95232, v5
    s_and_b32 s3, s2, 0
    s_lshl_b32 s66, s3, 7
    s_lshl_b32 s60, s3, 11
    s_add_u32 s60, s60, s5
    s_lshl_b32 s60, s60, 8
    s_lshl_b32 s61, s6, 18
    s_add_u32 s61, s61, s66
    s_add_u32 s62, s61, 65536
    s_waitcnt lgkmcnt(0)
    s_mov_b64 s[8:9], s[36:37]
    s_mov_b64 s[24:25], s[38:39]
    s_mov_b64 s[12:13], s[40:41]
    s_mov_b64 s[16:17], s[42:43]
    s_load_dwordx2 s[20:21], s[0:1], 0
    s_load_dwordx2 s[28:29], s[0:1], 8
    s_load_dwordx2 s[32:33], s[0:1], 72
    s_load_dwordx2 s[48:49], s[0:1], 64
    s_load_dwordx2 s[92:93], s[0:1], 16
    s_load_dwordx2 s[44:45], s[0:1], 88
    s_load_dwordx2 s[56:57], s[0:1], 96
    s_add_u32 m0, s69, 0
    s_nop 0
    buffer_load_dwordx4 v6, s[8:11], s61 offen lds
    buffer_load_dwordx4 v7, s[8:11], s61 offen offset:1024 lds
    buffer_load_dwordx4 v8, s[8:11], s61 offen offset:2048 lds
    buffer_load_dwordx4 v9, s[8:11], s61 offen offset:3072 lds
    s_xor_b32 s61, s61, 128
    s_add_u32 m0, s69, 16384
    s_nop 0
    buffer_load_dwordx4 v6, s[8:11], s62 offen lds
    buffer_load_dwordx4 v7, s[8:11], s62 offen offset:1024 lds
    buffer_load_dwordx4 v8, s[8:11], s62 offen offset:2048 lds
    buffer_load_dwordx4 v9, s[8:11], s62 offen offset:3072 lds
    s_xor_b32 s62, s62, 128
    s_add_u32 m0, s69, 32768
    s_nop 0
    buffer_load_dwordx4 v2, s[12:15], s60 offen nt lds
    buffer_load_dwordx4 v3, s[12:15], s60 offen offset:1024 nt lds
    buffer_load_dwordx4 v4, s[12:15], s60 offen offset:2048 nt lds
    buffer_load_dwordx4 v5, s[12:15], s60 offen offset:3072 nt lds
    s_add_u32 m0, s69, 49152
    s_nop 0
    buffer_load_dwordx4 v6, s[8:11], s61 offen lds
    buffer_load_dwordx4 v7, s[8:11], s61 offen offset:1024 lds
    buffer_load_dwordx4 v8, s[8:11], s61 offen offset:2048 lds
    buffer_load_dwordx4 v9, s[8:11], s61 offen offset:3072 lds
    s_xor_b32 s61, s61, 384
    v_min_u32 v74, 15, v31
    s_lshl2_add_u32 s98, s2, s4
    s_lshl_b32 s98, s98, 11
    v_lshlrev_b32 v74, 7, v74
    buffer_load_dword v117, v74, s[8:11], s98 offen
    s_cmp_lt_u32 s4, 2
    s_cselect_b32 s40, s12, s16
    s_cselect_b32 s41, s13, s17
    s_mov_b32 s42, 4194304
    s_mov_b32 s43, 0x20000
    v_min_u32 v120, 7, v31
    v_and_b32 v75, 1, v120
    v_lshrrev_b32 v120, 1, v120
    s_lshl1_add_u32 s98, s6, s100
    s_lshl_b32 s98, s98, 2
    v_add_lshl_u32 v120, v120, s98, 6
    v_add_lshl_u32 v120, v120, v75, 7
    s_lshl_b32 s84, s3, 11
    s_add_u32 s84, s84, s5
    s_lshl_b32 s84, s84, 8
    s_xor_b32 s98, s84, 524544
    buffer_load_dword v121, v120, s[40:43], s98 offen nt
    s_xor_b32 s98, s84, 1049088
    buffer_load_dword v122, v120, s[40:43], s98 offen nt
    s_waitcnt lgkmcnt(0)
    s_mov_b32 s22, 2359296
    s_mov_b32 s23, 0x20000
    s_mov_b32 s26, 4718592
    s_mov_b32 s27, 0x20000
    s_mov_b32 s50, 4718592
    s_mov_b32 s51, 0x20000
    s_mov_b32 s46, 256
    s_mov_b32 s47, 0x20000
    s_mov_b32 s30, 1990656
    s_mov_b32 s31, 0x20000
    s_mov_b32 s34, 1152
    s_mov_b32 s35, 0x20000
    s_mul_i32 s7, s5, 1081344
    s_add_u32 s36, s56, s7
    s_addc_u32 s37, s57, 0
    s_mov_b32 s38, 1081344
    s_mov_b32 s39, 0x20000
    s_cmp_eq_u32 s4, 0
    s_cselect_b32 s86, 0x55555555, 0
    s_cselect_b32 s87, 0x55555555, 0
    s_cselect_b32 s52, s48, s92
    s_cselect_b32 s53, s49, s93
    s_cselect_b32 s54, s50, 663552
    s_mov_b32 s55, 0x20000
    s_mul_i32 s63, s6, 147456
    s_sub_u32 s64, 2211840, s63
    s_add_u32 s63, s63, s66
    s_add_u32 s64, s64, s66
    s_lshl_b32 s67, s4, 11
    s_lshl_b32 s68, s4, 10
    s_lshl_b32 s75, s4, 13
    s_lshl_b32 s65, s3, 13
    s_add_u32 s65, s65, s67
    s_lshl_b32 s70, s6, 2
    s_lshl1_add_u32 s70, s100, s70
    s_lshl_b32 s70, s70, 15
    s_lshl_b32 s98, s73, 6
    s_add_u32 s71, s70, s98
    s_add_u32 s71, s71, 49152
    s_lshl_b32 s98, s73, 4
    s_add_u32 s70, s70, s98
    v_lshlrev_b32 v1, 4, v31
    v_mov_b32 v77, 1073741824
    v_cmp_eq_u32 vcc, 0, v0
    s_nop 1
    v_cndmask_b32_e64 v30, v77, 0, vcc
    v_lshlrev_b32 v103, 7, v31
    v_cmp_gt_u32 vcc, 9, v31
    s_nop 1
    v_cndmask_b32 v103, v77, v103, vcc
    s_lshl_b32 s98, s4, 5
    v_add_u32 v68, s98, v65
    v_mul_u32_u24 v68, 1152, v68
    v_add_u32 v10, v68, v66
    v_add_u32 v11, v68, v67
    v_add_u32 v11, 8192, v11
    v_add_u32 v12, v68, v66
    v_add_u32 v12, 16384, v12
    v_add_u32 v13, v68, v67
    v_add_u32 v13, 24576, v13
    s_sub_u32 s98, 15, s6
    s_cmp_eq_u32 s73, 0
    s_cselect_b32 s98, s6, s98
    s_lshl_b32 s98, s98, 7
    s_sub_u32 s98, s98, 16
    s_max_i32 s98, s98, 0
    s_lshl3_add_u32 s98, s100, s98
    v_add_u32 v68, s98, v65
    v_mul_u32_u24 v68, 1152, v68
    s_lshl_b32 s98, s100, 6
    v_xor_b32 v73, s98, v66
    v_add_u32 v96, v68, v73
    s_add_u32 m0, s69, 65536
    s_nop 0
    buffer_load_dwordx4 v2, s[16:19], s60 offen nt lds
    v_lshrrev_b32 v71, 1, v70
    v_xor_b32 v71, v71, v69
    v_lshlrev_b32 v71, 4, v71
    v_lshl_add_u32 v71, v70, 7, v71
    v_xor_b32 v72, 64, v71
    s_lshl_b32 s98, s100, 13
    v_add_u32 v22, s98, v71
    v_add_u32 v23, s98, v72
    v_add_u32 v24, s67, v71
    v_add_u32 v25, s67, v72
    s_lshl_b32 s98, s100, 11
    s_add_u32 s98, s98, 8192
    v_add_u32 v100, s98, v71
    v_add_u32 v101, s98, v72
    v_bfe_u32 v73, v31, 2, 2
    v_and_b32 v74, 3, v31
    v_lshl_add_u32 v75, v69, 3, v73
    v_and_b32 v78, 1, v69
    buffer_load_dwordx4 v3, s[16:19], s60 offen offset:1024 nt lds
    v_lshl_add_u32 v77, v78, 2, v73
    v_lshlrev_b32 v77, 5, v77
    v_lshl_add_u32 v77, v74, 3, v77
    v_lshl_add_u32 v77, v75, 8, v77
    v_xor_b32 v14, 0, v77
    v_xor_b32 v14, s73, v14
    v_xor_b32 v15, 32, v77
    v_xor_b32 v15, s73, v15
    v_xor_b32 v16, 64, v77
    v_xor_b32 v16, s73, v16
    v_xor_b32 v17, 96, v77
    v_xor_b32 v17, s73, v17
    v_xor_b32 v18, 128, v77
    v_xor_b32 v19, 160, v77
    v_xor_b32 v20, 192, v77
    v_xor_b32 v21, 224, v77
    v_lshrrev_b32 v77, 1, v73
    v_lshl_add_u32 v77, v78, 1, v77
    buffer_load_dwordx4 v4, s[16:19], s60 offen offset:2048 nt lds
    v_lshlrev_b32 v77, 5, v77
    v_lshl_add_u32 v77, v74, 3, v77
    v_lshl_add_u32 v77, v75, 7, v77
    s_lshr_b32 s98, s73, 1
    v_xor_b32 v26, 0, v77
    v_xor_b32 v26, s98, v26
    v_xor_b32 v27, 32, v77
    v_xor_b32 v28, 64, v77
    v_xor_b32 v28, s98, v28
    v_xor_b32 v29, 96, v77
    v_and_b32 v73, 7, v0
    v_lshrrev_b32 v74, 3, v0
    v_lshl_add_u32 v75, v73, 1, 0
    v_mul_u32_u24 v78, 52, v75
    v_lshrrev_b32 v78, 8, v78
    v_mul_u32_u24 v79, 5, v78
    v_sub_u32 v75, v75, v79
    v_add_u32 v78, 1, v78
    buffer_load_dwordx4 v5, s[16:19], s60 offen offset:3072 nt lds
    s_xor_b32 s60, s60, 524288
    v_cmp_le_u32 vcc, 3, v78
    s_nop 1
    v_cndmask_b32_e64 v78, v78, 0, vcc
    v_mul_u32_u24 v78, 1152, v78
    v_lshl_add_u32 v75, v75, 3, v78
    v_mad_u32_u24 v75, v74, 36, v75
    v_lshl_add_u32 v77, v73, 1, 1
    v_mul_u32_u24 v78, 52, v77
    v_lshrrev_b32 v78, 8, v78
    v_mul_u32_u24 v79, 5, v78
    v_sub_u32 v77, v77, v79
    v_add_u32 v78, 1, v78
    v_cmp_le_u32 vcc, 3, v78
    s_nop 1
    v_cndmask_b32_e64 v78, v78, 0, vcc
    v_mul_u32_u24 v78, 1152, v78
    v_lshl_add_u32 v77, v77, 3, v78
    v_mad_u32_u24 v77, v74, 36, v77
    s_mul_i32 s98, s2, 10368
    s_mul_i32 s99, s2, 6
    s_mov_b32 s7, 73728
    v_mul_lo_u32 v95, v74, s7
    v_lshl_add_u32 v95, v73, 4, v95
    v_cmp_eq_u32 s[92:93], 7, v73
    s_add_u32 s56, s56, 56623104
    s_addc_u32 s57, s57, 0
    s_mov_b32 s58, 5603328
    s_mov_b32 s59, 0x20000
    s_lshl_b32 s101, s6, 5
    s_add_u32 s101, s101, s5
    s_lshl_b32 s101, s101, 7
    v_mov_b32 v65, 0
    v_lshlrev_b32 v64, 15, v0
    s_mov_b32 s74, 0x3e0293ee
    s_lshl_b32 s95, s5, 3
    s_waitcnt vmcnt(7)
    s_barrier
    ds_read_b128 a[0:3], v22 offset:0
    ds_read_b64_tr_b16 v[40:41], v14 offset:32768
    ds_read_b64_tr_b16 v[42:43], v14 offset:33792
    ds_read_b128 a[4:7], v23 offset:0
    ds_read_b64_tr_b16 v[44:45], v14 offset:40960
    ds_read_b64_tr_b16 v[46:47], v14 offset:41984
    ds_read_b128 a[8:11], v22 offset:2048
    ds_read_b128 a[12:15], v23 offset:2048
    ds_read_b128 a[16:19], v22 offset:4096
    ds_read_b128 a[20:23], v23 offset:4096
    ds_read_b128 a[24:27], v22 offset:6144
    ds_read_b128 a[28:31], v23 offset:6144
    ds_read_b128 a[32:35], v22 offset:16384
    ds_read_b128 a[36:39], v23 offset:16384
    ds_read_b128 a[40:43], v22 offset:18432
    s_waitcnt lgkmcnt(14)
    ds_read_b128 a[44:47], v23 offset:18432
    s_waitcnt lgkmcnt(14)
    ds_read_b128 a[48:51], v22 offset:20480
    s_waitcnt lgkmcnt(14)
    ds_read_b128 a[52:55], v23 offset:20480
    s_waitcnt lgkmcnt(14)
    ds_read_b128 a[56:59], v22 offset:22528
    s_waitcnt lgkmcnt(14)
    ds_read_b128 a[60:63], v23 offset:22528
    v_mfma_f32_16x16x32_bf16 v[128:131], v[40:43], a[0:3], 0
    s_add_u32 m0, s69, 81920
    s_waitcnt lgkmcnt(14)
    ds_read_b64_tr_b16 v[48:49], v15 offset:32768
    s_waitcnt lgkmcnt(14)
    ds_read_b64_tr_b16 v[50:51], v15 offset:33792
    v_mfma_f32_16x16x32_bf16 v[128:131], v[44:47], a[4:7], v[128:131]
    s_mul_i32 s77, s2, 9216
    buffer_load_dwordx4 v6, s[8:11], s62 offen lds
    v_mfma_f32_16x16x32_bf16 v[132:135], v[40:43], a[8:11], 0
    s_mul_i32 s76, s4, 1152
    s_waitcnt lgkmcnt(14)
    ds_read_b128 a[64:67], v22 offset:49152
    s_waitcnt lgkmcnt(14)
    ds_read_b64_tr_b16 v[52:53], v15 offset:40960
    v_mfma_f32_16x16x32_bf16 v[132:135], v[44:47], a[12:15], v[132:135]
    s_add_u32 s77, s77, s76
    s_waitcnt lgkmcnt(14)
    ds_read_b64_tr_b16 v[54:55], v15 offset:41984
    s_waitcnt lgkmcnt(14)
    ds_read_b64_tr_b16 v[56:57], v16 offset:32768
    v_mfma_f32_16x16x32_bf16 v[136:139], v[40:43], a[16:19], 0
    s_mul_i32 s76, s4, 1152
    buffer_load_dwordx4 v7, s[8:11], s62 offen offset:1024 lds
    v_mfma_f32_16x16x32_bf16 v[136:139], v[44:47], a[20:23], v[136:139]
    s_mul_i32 s72, s2, 3
    s_waitcnt lgkmcnt(4)
    ds_read_b64_tr_b16 v[58:59], v16 offset:33792
    ds_read_b64_tr_b16 v[60:61], v16 offset:40960
    v_mfma_f32_16x16x32_bf16 v[140:143], v[40:43], a[24:27], 0
    s_add_u32 s72, s72, 0
    ds_read_b64_tr_b16 v[62:63], v16 offset:41984
    v_add_u32 v14, 0x10000, v14
    v_mfma_f32_16x16x32_bf16 v[140:143], v[44:47], a[28:31], v[140:143]
    s_mul_i32 s7, s5, 73728
    ds_read_b128 a[68:71], v23 offset:49152
    v_add_u32 v15, 0x10000, v15
    v_mfma_f32_16x16x32_bf16 v[144:147], v[40:43], a[32:35], 0
    s_and_b32 s100, s6, 1
    buffer_load_dwordx4 v8, s[8:11], s62 offen offset:2048 lds
    v_mfma_f32_16x16x32_bf16 v[144:147], v[44:47], a[36:39], v[144:147]
    v_add_u32 v16, 0x10000, v16
    v_mov_b32 v31, 1
    v_mfma_f32_16x16x32_bf16 v[148:151], v[40:43], a[40:43], 0
    v_add_u32 v18, 0x10000, v18
    v_add_u32 v19, 0x10000, v19
    v_mfma_f32_16x16x32_bf16 v[148:151], v[44:47], a[44:47], v[148:151]
    v_add_u32 v20, 0x10000, v20
    v_add_u32 v21, 0x10000, v21
    v_mfma_f32_16x16x32_bf16 v[152:155], v[40:43], a[48:51], 0
    buffer_load_dwordx4 v9, s[8:11], s62 offen offset:3072 lds
    v_mfma_f32_16x16x32_bf16 v[152:155], v[44:47], a[52:55], v[152:155]
    ds_read_b128 a[72:75], v22 offset:51200
    v_add_u32 v26, 0x10000, v26
    v_mfma_f32_16x16x32_bf16 v[156:159], v[40:43], a[56:59], 0
    s_add_u32 m0, s69, 98304
    ds_read_b64_tr_b16 v[40:41], v17 offset:32768
    ds_read_b64_tr_b16 v[42:43], v17 offset:33792
    v_mfma_f32_16x16x32_bf16 v[156:159], v[44:47], a[60:63], v[156:159]
    s_xor_b32 s62, s62, 384
    ds_read_b64_tr_b16 v[44:45], v17 offset:40960
    ds_read_b64_tr_b16 v[46:47], v17 offset:41984
    v_mfma_f32_16x16x32_bf16 v[160:163], v[48:51], a[0:3], 0
    s_waitcnt lgkmcnt(5)
    buffer_load_dwordx4 v2, s[12:15], s60 offen nt lds
    v_mfma_f32_16x16x32_bf16 v[160:163], v[52:55], a[4:7], v[160:163]
    v_add_u32 v17, 0x10000, v17
    v_add_u32 v27, 0x10000, v27
    v_mfma_f32_16x16x32_bf16 v[164:167], v[48:51], a[8:11], 0
    ds_read_b128 a[76:79], v23 offset:51200
    v_add_u32 v28, 0x10000, v28
    v_mfma_f32_16x16x32_bf16 v[164:167], v[52:55], a[12:15], v[164:167]
    v_add_u32 v29, 0x10000, v29
    v_bfe_u32 v37, v1, 4, 4
    v_mfma_f32_16x16x32_bf16 v[168:171], v[48:51], a[16:19], 0
    buffer_load_dwordx4 v3, s[12:15], s60 offen offset:1024 nt lds
    v_mfma_f32_16x16x32_bf16 v[168:171], v[52:55], a[20:23], v[168:171]
    v_mul_u32_u24 v36, 1152, v37
    v_lshrrev_b32 v38, 8, v1
    v_mfma_f32_16x16x32_bf16 v[172:175], v[48:51], a[24:27], 0
    v_lshl_add_u32 v36, v38, 4, v36
    v_lshrrev_b32 v39, 3, v37
    v_mfma_f32_16x16x32_bf16 v[172:175], v[52:55], a[28:31], v[172:175]
    v_mul_u32_u24 v39, 9152, v39
    v_mfma_f32_16x16x32_bf16 v[176:179], v[48:51], a[32:35], 0
    buffer_load_dwordx4 v4, s[12:15], s60 offen offset:2048 nt lds
    v_mfma_f32_16x16x32_bf16 v[176:179], v[52:55], a[36:39], v[176:179]
    ds_read_b128 a[80:83], v22 offset:53248
    v_mfma_f32_16x16x32_bf16 v[180:183], v[48:51], a[40:43], 0
    v_mfma_f32_16x16x32_bf16 v[180:183], v[52:55], a[44:47], v[180:183]
    v_mfma_f32_16x16x32_bf16 v[184:187], v[48:51], a[48:51], 0
    buffer_load_dwordx4 v5, s[12:15], s60 offen offset:3072 nt lds
    v_mfma_f32_16x16x32_bf16 v[184:187], v[52:55], a[52:55], v[184:187]
    ds_read_b128 a[84:87], v23 offset:53248
    v_mfma_f32_16x16x32_bf16 v[188:191], v[48:51], a[56:59], 0
    s_add_u32 m0, s69, 114688
    v_mfma_f32_16x16x32_bf16 v[188:191], v[52:55], a[60:63], v[188:191]
    v_mfma_f32_16x16x32_bf16 v[192:195], v[56:59], a[0:3], 0
    buffer_load_dwordx4 v6, s[8:11], s61 offen lds
    v_mfma_f32_16x16x32_bf16 v[192:195], v[60:63], a[4:7], v[192:195]
    v_mfma_f32_16x16x32_bf16 v[196:199], v[56:59], a[8:11], 0
    v_mfma_f32_16x16x32_bf16 v[196:199], v[60:63], a[12:15], v[196:199]
    ds_read_b128 a[88:91], v22 offset:55296
    v_mfma_f32_16x16x32_bf16 v[200:203], v[56:59], a[16:19], 0
    buffer_load_dwordx4 v7, s[8:11], s61 offen offset:1024 lds
    v_mfma_f32_16x16x32_bf16 v[200:203], v[60:63], a[20:23], v[200:203]
    v_mfma_f32_16x16x32_bf16 v[204:207], v[56:59], a[24:27], 0
    v_mfma_f32_16x16x32_bf16 v[204:207], v[60:63], a[28:31], v[204:207]
    v_mfma_f32_16x16x32_bf16 v[208:211], v[56:59], a[32:35], 0
    buffer_load_dwordx4 v8, s[8:11], s61 offen offset:2048 lds
    v_mfma_f32_16x16x32_bf16 v[208:211], v[60:63], a[36:39], v[208:211]
    ds_read_b128 a[92:95], v23 offset:55296
    v_mfma_f32_16x16x32_bf16 v[212:215], v[56:59], a[40:43], 0
    v_mfma_f32_16x16x32_bf16 v[212:215], v[60:63], a[44:47], v[212:215]
    v_mfma_f32_16x16x32_bf16 v[216:219], v[56:59], a[48:51], 0
    buffer_load_dwordx4 v9, s[8:11], s61 offen offset:3072 lds
    v_mfma_f32_16x16x32_bf16 v[216:219], v[60:63], a[52:55], v[216:219]
    v_mfma_f32_16x16x32_bf16 v[220:223], v[56:59], a[56:59], 0
    s_xor_b32 s61, s61, 128
    v_mfma_f32_16x16x32_bf16 v[220:223], v[60:63], a[60:63], v[220:223]
    s_add_u32 m0, s69, 131072
    s_waitcnt lgkmcnt(0)
    v_mfma_f32_16x16x32_bf16 v[224:227], v[40:43], a[0:3], 0
    s_xor_b32 s82, s84, 1573632
    buffer_load_dwordx4 v2, s[16:19], s60 offen nt lds
    v_mfma_f32_16x16x32_bf16 v[224:227], v[44:47], a[4:7], v[224:227]
    v_mfma_f32_16x16x32_bf16 v[228:231], v[40:43], a[8:11], 0
    buffer_load_dword v123, v120, s[40:43], s82 offen nt
    v_mfma_f32_16x16x32_bf16 v[228:231], v[44:47], a[12:15], v[228:231]
    v_mfma_f32_16x16x32_bf16 v[232:235], v[40:43], a[16:19], 0
    v_mfma_f32_16x16x32_bf16 v[232:235], v[44:47], a[20:23], v[232:235]
    s_waitcnt vmcnt(10)
    s_barrier
    ds_read_b64_tr_b16 v[48:49], v14 offset:0
    v_mfma_f32_16x16x32_bf16 v[236:239], v[40:43], a[24:27], 0
    buffer_load_dword v104, v103, s[20:23], s77 offen
    v_mfma_f32_16x16x32_bf16 v[236:239], v[44:47], a[28:31], v[236:239]
    s_add_u32 s77, s77, 4608
    ds_read_b64_tr_b16 v[50:51], v14 offset:1024
    ds_read_b64_tr_b16 v[52:53], v14 offset:8192
    v_mfma_f32_16x16x32_bf16 v[240:243], v[40:43], a[32:35], 0
    ds_read_b64_tr_b16 v[54:55], v14 offset:9216
    ds_read_b64_tr_b16 v[56:57], v15 offset:0
    v_mfma_f32_16x16x32_bf16 v[240:243], v[44:47], a[36:39], v[240:243]
    buffer_load_dwordx4 v3, s[16:19], s60 offen offset:1024 nt lds
    v_mfma_f32_16x16x32_bf16 v[244:247], v[40:43], a[40:43], 0
    ds_read_b64_tr_b16 v[58:59], v15 offset:1024
    ds_read_b64_tr_b16 v[60:61], v15 offset:8192
    v_mfma_f32_16x16x32_bf16 v[244:247], v[44:47], a[44:47], v[244:247]
    ds_read_b64_tr_b16 v[62:63], v15 offset:9216
    v_mfma_f32_16x16x32_bf16 v[248:251], v[40:43], a[48:51], 0
    v_mfma_f32_16x16x32_bf16 v[248:251], v[44:47], a[52:55], v[248:251]
    buffer_load_dwordx4 v4, s[16:19], s60 offen offset:2048 nt lds
    v_mfma_f32_16x16x32_bf16 v[252:255], v[40:43], a[56:59], 0
    ds_read_b64_tr_b16 v[40:41], v16 offset:0
    ds_read_b64_tr_b16 v[42:43], v16 offset:1024
    v_mfma_f32_16x16x32_bf16 v[252:255], v[44:47], a[60:63], v[252:255]
    s_waitcnt lgkmcnt(3)
    ds_read_b64_tr_b16 v[44:45], v16 offset:8192
    ds_read_b64_tr_b16 v[46:47], v16 offset:9216
    v_mfma_f32_16x16x32_bf16 a[128:131], a[0:3], v[48:51], 0
    v_mfma_f32_16x16x32_bf16 a[128:131], a[4:7], v[52:55], a[128:131]
    buffer_load_dwordx4 v5, s[16:19], s60 offen offset:3072 nt lds
    v_mfma_f32_16x16x32_bf16 a[132:135], a[8:11], v[48:51], 0
    s_add_u32 m0, s69, 147456
    v_add_u32 v22, 0x10000, v22
    ds_read_b128 a[96:99], v22 offset:16384
    v_mfma_f32_16x16x32_bf16 a[132:135], a[12:15], v[52:55], a[132:135]
    s_xor_b32 s60, s60, 1572864
    v_mfma_f32_16x16x32_bf16 a[136:139], a[16:19], v[48:51], 0
    v_mfma_f32_16x16x32_bf16 a[136:139], a[20:23], v[52:55], a[136:139]
    buffer_load_dwordx4 v6, s[8:11], s62 offen lds
    v_mfma_f32_16x16x32_bf16 a[140:143], a[24:27], v[48:51], 0
    v_add_u32 v23, 0x10000, v23
    v_mfma_f32_16x16x32_bf16 a[140:143], a[28:31], v[52:55], a[140:143]
    ds_read_b128 a[100:103], v23 offset:16384
    v_mfma_f32_16x16x32_bf16 a[144:147], a[32:35], v[48:51], 0
    v_mfma_f32_16x16x32_bf16 a[144:147], a[36:39], v[52:55], a[144:147]
    buffer_load_dwordx4 v7, s[8:11], s62 offen offset:1024 lds
    v_mfma_f32_16x16x32_bf16 a[148:151], a[40:43], v[48:51], 0
    v_mfma_f32_16x16x32_bf16 a[148:151], a[44:47], v[52:55], a[148:151]
    v_mfma_f32_16x16x32_bf16 a[152:155], a[48:51], v[48:51], 0
    v_mfma_f32_16x16x32_bf16 a[152:155], a[52:55], v[52:55], a[152:155]
    buffer_load_dwordx4 v8, s[8:11], s62 offen offset:2048 lds
    v_mfma_f32_16x16x32_bf16 a[156:159], a[56:59], v[48:51], 0
    ds_read_b128 a[104:107], v22 offset:18432
    ds_read_b64_tr_b16 v[48:49], v17 offset:0
    v_mfma_f32_16x16x32_bf16 a[156:159], a[60:63], v[52:55], a[156:159]
    ds_read_b64_tr_b16 v[50:51], v17 offset:1024
    ds_read_b64_tr_b16 v[52:53], v17 offset:8192
    v_mfma_f32_16x16x32_bf16 a[160:163], a[0:3], v[56:59], 0
    s_waitcnt lgkmcnt(4)
    ds_read_b64_tr_b16 v[54:55], v17 offset:9216
    v_mfma_f32_16x16x32_bf16 a[160:163], a[4:7], v[60:63], a[160:163]
    buffer_load_dwordx4 v9, s[8:11], s62 offen offset:3072 lds
    v_mfma_f32_16x16x32_bf16 a[164:167], a[8:11], v[56:59], 0
    ds_read_b128 a[108:111], v23 offset:18432
    v_mfma_f32_16x16x32_bf16 a[164:167], a[12:15], v[60:63], a[164:167]
    s_add_u32 m0, s69, 0
    v_mfma_f32_16x16x32_bf16 a[168:171], a[16:19], v[56:59], 0
    s_xor_b32 s62, s62, 128
    v_mfma_f32_16x16x32_bf16 a[168:171], a[20:23], v[60:63], a[168:171]
    buffer_load_dwordx4 v2, s[12:15], s60 offen nt lds
    v_mfma_f32_16x16x32_bf16 a[172:175], a[24:27], v[56:59], 0
    v_mfma_f32_16x16x32_bf16 a[172:175], a[28:31], v[60:63], a[172:175]
    v_mfma_f32_16x16x32_bf16 a[176:179], a[32:35], v[56:59], 0
    ds_read_b128 a[112:115], v22 offset:20480
    v_mfma_f32_16x16x32_bf16 a[176:179], a[36:39], v[60:63], a[176:179]
    buffer_load_dwordx4 v3, s[12:15], s60 offen offset:1024 nt lds
    v_mfma_f32_16x16x32_bf16 a[180:183], a[40:43], v[56:59], 0
    v_mfma_f32_16x16x32_bf16 a[180:183], a[44:47], v[60:63], a[180:183]
    v_mfma_f32_16x16x32_bf16 a[184:187], a[48:51], v[56:59], 0
    v_mfma_f32_16x16x32_bf16 a[184:187], a[52:55], v[60:63], a[184:187]
    buffer_load_dwordx4 v4, s[12:15], s60 offen offset:2048 nt lds
    v_mfma_f32_16x16x32_bf16 a[188:191], a[56:59], v[56:59], 0
    ds_read_b128 a[116:119], v23 offset:20480
    v_mfma_f32_16x16x32_bf16 a[188:191], a[60:63], v[60:63], a[188:191]
    v_mfma_f32_16x16x32_bf16 a[192:195], a[0:3], v[40:43], 0
    v_mfma_f32_16x16x32_bf16 a[192:195], a[4:7], v[44:47], a[192:195]
    buffer_load_dwordx4 v5, s[12:15], s60 offen offset:3072 nt lds
    v_mfma_f32_16x16x32_bf16 a[196:199], a[8:11], v[40:43], 0
    v_mfma_f32_16x16x32_bf16 a[196:199], a[12:15], v[44:47], a[196:199]
    ds_read_b128 a[120:123], v22 offset:22528
    v_mfma_f32_16x16x32_bf16 a[200:203], a[16:19], v[40:43], 0
    v_mfma_f32_16x16x32_bf16 a[200:203], a[20:23], v[44:47], a[200:203]
    s_add_u32 m0, s69, 16384
    v_mfma_f32_16x16x32_bf16 a[204:207], a[24:27], v[40:43], 0
    buffer_load_dwordx4 v6, s[8:11], s61 offen lds
    v_mfma_f32_16x16x32_bf16 a[204:207], a[28:31], v[44:47], a[204:207]
    v_mfma_f32_16x16x32_bf16 a[208:211], a[32:35], v[40:43], 0
    ds_read_b128 a[124:127], v23 offset:22528
    v_mfma_f32_16x16x32_bf16 a[208:211], a[36:39], v[44:47], a[208:211]
    v_mfma_f32_16x16x32_bf16 a[212:215], a[40:43], v[40:43], 0
    buffer_load_dwordx4 v7, s[8:11], s61 offen offset:1024 lds
    v_mfma_f32_16x16x32_bf16 a[212:215], a[44:47], v[44:47], a[212:215]
    v_mfma_f32_16x16x32_bf16 a[216:219], a[48:51], v[40:43], 0
    v_mfma_f32_16x16x32_bf16 a[216:219], a[52:55], v[44:47], a[216:219]
    v_mfma_f32_16x16x32_bf16 a[220:223], a[56:59], v[40:43], 0
    v_mfma_f32_16x16x32_bf16 a[220:223], a[60:63], v[44:47], a[220:223]
    s_waitcnt lgkmcnt(0)
    buffer_load_dwordx4 v8, s[8:11], s61 offen offset:2048 lds
    v_mfma_f32_16x16x32_bf16 a[224:227], a[0:3], v[48:51], 0
    v_mfma_f32_16x16x32_bf16 a[224:227], a[4:7], v[52:55], a[224:227]
    v_mfma_f32_16x16x32_bf16 a[228:231], a[8:11], v[48:51], 0
    v_mfma_f32_16x16x32_bf16 a[228:231], a[12:15], v[52:55], a[228:231]
    buffer_load_dwordx4 v9, s[8:11], s61 offen offset:3072 lds
    v_mfma_f32_16x16x32_bf16 a[232:235], a[16:19], v[48:51], 0
    v_mfma_f32_16x16x32_bf16 a[232:235], a[20:23], v[52:55], a[232:235]
    s_waitcnt vmcnt(8) lgkmcnt(0)
    s_barrier
    ds_read_b64_tr_b16 v[56:57], v14 offset:32768
    v_mfma_f32_16x16x32_bf16 a[236:239], a[24:27], v[48:51], 0
    s_add_u32 m0, s69, 32768
    ds_read_b64_tr_b16 v[58:59], v14 offset:33792
    ds_read_b64_tr_b16 v[60:61], v14 offset:40960
    v_mfma_f32_16x16x32_bf16 a[236:239], a[28:31], v[52:55], a[236:239]
    s_xor_b32 s61, s61, 896
    buffer_load_dwordx4 v2, s[16:19], s60 offen nt lds
    v_mfma_f32_16x16x32_bf16 a[240:243], a[32:35], v[48:51], 0
    ds_read_b64_tr_b16 v[62:63], v14 offset:41984
    ds_read_b64_tr_b16 v[40:41], v15 offset:32768
    v_mfma_f32_16x16x32_bf16 a[240:243], a[36:39], v[52:55], a[240:243]
    ds_read_b64_tr_b16 v[42:43], v15 offset:33792
    ds_read_b64_tr_b16 v[44:45], v15 offset:40960
    v_mfma_f32_16x16x32_bf16 a[244:247], a[40:43], v[48:51], 0
    ds_read_b64_tr_b16 v[46:47], v15 offset:41984
    v_add_u32 v14, 0x10000, v14
    v_mfma_f32_16x16x32_bf16 a[244:247], a[44:47], v[52:55], a[244:247]
    v_add_u32 v15, 0x10000, v15
    v_mfma_f32_16x16x32_bf16 a[248:251], a[48:51], v[48:51], 0
    v_mfma_f32_16x16x32_bf16 a[248:251], a[52:55], v[52:55], a[248:251]
    buffer_load_dwordx4 v3, s[16:19], s60 offen offset:1024 nt lds
    v_mfma_f32_16x16x32_bf16 a[252:255], a[56:59], v[48:51], 0
    ds_read_b64_tr_b16 v[48:49], v16 offset:32768
    ds_read_b64_tr_b16 v[50:51], v16 offset:33792
    v_mfma_f32_16x16x32_bf16 a[252:255], a[60:63], v[52:55], a[252:255]
    s_waitcnt lgkmcnt(2)
    ds_read_b64_tr_b16 v[52:53], v16 offset:40960
    ds_read_b64_tr_b16 v[54:55], v16 offset:41984
    v_mfma_f32_16x16x32_bf16 v[128:131], v[56:59], a[64:67], v[128:131]
    v_add_u32 v16, 0x10000, v16
    v_mfma_f32_16x16x32_bf16 v[128:131], v[60:63], a[68:71], v[128:131]
    v_mfma_f32_16x16x32_bf16 v[132:135], v[56:59], a[72:75], v[132:135]
    ds_read_b128 a[0:3], v22 offset:49152
    v_mfma_f32_16x16x32_bf16 v[132:135], v[60:63], a[76:79], v[132:135]
    v_mfma_f32_16x16x32_bf16 v[136:139], v[56:59], a[80:83], v[136:139]
    v_mfma_f32_16x16x32_bf16 v[136:139], v[60:63], a[84:87], v[136:139]
    buffer_load_dwordx4 v4, s[16:19], s60 offen offset:2048 nt lds
    v_mfma_f32_16x16x32_bf16 v[140:143], v[56:59], a[88:91], v[140:143]
    v_mfma_f32_16x16x32_bf16 v[140:143], v[60:63], a[92:95], v[140:143]
    ds_read_b128 a[4:7], v23 offset:49152
    v_mfma_f32_16x16x32_bf16 v[144:147], v[56:59], a[96:99], v[144:147]
    v_mfma_f32_16x16x32_bf16 v[144:147], v[60:63], a[100:103], v[144:147]
    v_mfma_f32_16x16x32_bf16 v[148:151], v[56:59], a[104:107], v[148:151]
    v_mfma_f32_16x16x32_bf16 v[148:151], v[60:63], a[108:111], v[148:151]
    v_mfma_f32_16x16x32_bf16 v[152:155], v[56:59], a[112:115], v[152:155]
    buffer_load_dwordx4 v5, s[16:19], s60 offen offset:3072 nt lds
    v_mfma_f32_16x16x32_bf16 v[152:155], v[60:63], a[116:119], v[152:155]
    ds_read_b128 a[8:11], v22 offset:51200
    v_mfma_f32_16x16x32_bf16 v[156:159], v[56:59], a[120:123], v[156:159]
    ds_read_b64_tr_b16 v[56:57], v17 offset:32768
    ds_read_b64_tr_b16 v[58:59], v17 offset:33792
    v_mfma_f32_16x16x32_bf16 v[156:159], v[60:63], a[124:127], v[156:159]
    ds_read_b64_tr_b16 v[60:61], v17 offset:40960
    ds_read_b64_tr_b16 v[62:63], v17 offset:41984
    v_mfma_f32_16x16x32_bf16 v[160:163], v[40:43], a[64:67], v[160:163]
    v_add_u32 v17, 0x10000, v17
    v_mfma_f32_16x16x32_bf16 v[160:163], v[44:47], a[68:71], v[160:163]
    v_mfma_f32_16x16x32_bf16 v[164:167], v[40:43], a[72:75], v[164:167]
    ds_read_b128 a[12:15], v23 offset:51200
    v_mfma_f32_16x16x32_bf16 v[164:167], v[44:47], a[76:79], v[164:167]
    s_add_u32 m0, s69, 49152
    v_mfma_f32_16x16x32_bf16 v[168:171], v[40:43], a[80:83], v[168:171]
    s_xor_b32 s60, s60, 524288
    buffer_load_dwordx4 v6, s[8:11], s62 offen lds
    v_mfma_f32_16x16x32_bf16 v[168:171], v[44:47], a[84:87], v[168:171]
    v_mfma_f32_16x16x32_bf16 v[172:175], v[40:43], a[88:91], v[172:175]
    v_mfma_f32_16x16x32_bf16 v[172:175], v[44:47], a[92:95], v[172:175]
    v_mfma_f32_16x16x32_bf16 v[176:179], v[40:43], a[96:99], v[176:179]
    ds_read_b128 a[16:19], v22 offset:53248
    v_mfma_f32_16x16x32_bf16 v[176:179], v[44:47], a[100:103], v[176:179]
    v_mfma_f32_16x16x32_bf16 v[180:183], v[40:43], a[104:107], v[180:183]
    v_mfma_f32_16x16x32_bf16 v[180:183], v[44:47], a[108:111], v[180:183]
    buffer_load_dwordx4 v7, s[8:11], s62 offen offset:1024 lds
    v_mfma_f32_16x16x32_bf16 v[184:187], v[40:43], a[112:115], v[184:187]
    v_mfma_f32_16x16x32_bf16 v[184:187], v[44:47], a[116:119], v[184:187]
    ds_read_b128 a[20:23], v23 offset:53248
    v_mfma_f32_16x16x32_bf16 v[188:191], v[40:43], a[120:123], v[188:191]
    s_waitcnt lgkmcnt(1)
    ds_read_b64_tr_b16 v[40:41], v14 offset:0
    ds_read_b64_tr_b16 v[42:43], v14 offset:1024
    v_mfma_f32_16x16x32_bf16 v[188:191], v[44:47], a[124:127], v[188:191]
    ds_read_b64_tr_b16 v[44:45], v14 offset:8192
    ds_read_b64_tr_b16 v[46:47], v14 offset:9216
    v_mfma_f32_16x16x32_bf16 v[192:195], v[48:51], a[64:67], v[192:195]
    v_add_u32 v14, 0xfffe0000, v14
    v_mfma_f32_16x16x32_bf16 v[192:195], v[52:55], a[68:71], v[192:195]
    v_mfma_f32_16x16x32_bf16 v[196:199], v[48:51], a[72:75], v[196:199]
    v_mfma_f32_16x16x32_bf16 v[196:199], v[52:55], a[76:79], v[196:199]
    buffer_load_dwordx4 v8, s[8:11], s62 offen offset:2048 lds
    v_mfma_f32_16x16x32_bf16 v[200:203], v[48:51], a[80:83], v[200:203]
    ds_read_b128 a[24:27], v22 offset:55296
    v_mfma_f32_16x16x32_bf16 v[200:203], v[52:55], a[84:87], v[200:203]
    v_mfma_f32_16x16x32_bf16 v[204:207], v[48:51], a[88:91], v[204:207]
    v_mfma_f32_16x16x32_bf16 v[204:207], v[52:55], a[92:95], v[204:207]
    v_mfma_f32_16x16x32_bf16 v[208:211], v[48:51], a[96:99], v[208:211]
    ds_read_b128 a[28:31], v23 offset:55296
    v_mfma_f32_16x16x32_bf16 v[208:211], v[52:55], a[100:103], v[208:211]
    v_mfma_f32_16x16x32_bf16 v[212:215], v[48:51], a[104:107], v[212:215]
    buffer_load_dwordx4 v9, s[8:11], s62 offen offset:3072 lds
    v_mfma_f32_16x16x32_bf16 v[212:215], v[52:55], a[108:111], v[212:215]
    v_mfma_f32_16x16x32_bf16 v[216:219], v[48:51], a[112:115], v[216:219]
    v_mfma_f32_16x16x32_bf16 v[216:219], v[52:55], a[116:119], v[216:219]
    v_mfma_f32_16x16x32_bf16 v[220:223], v[48:51], a[120:123], v[220:223]
    s_xor_b32 s82, s84, 2097152
    ds_read_b64_tr_b16 v[48:49], v15 offset:0
    ds_read_b64_tr_b16 v[50:51], v15 offset:1024
    v_mfma_f32_16x16x32_bf16 v[220:223], v[52:55], a[124:127], v[220:223]
    ds_read_b64_tr_b16 v[52:53], v15 offset:8192
    ds_read_b64_tr_b16 v[54:55], v15 offset:9216
    v_mfma_f32_16x16x32_bf16 v[224:227], v[56:59], a[64:67], v[224:227]
    buffer_load_dwordx2 v[80:81], v75, s[28:31], s98 offen nt
    v_mfma_f32_16x16x32_bf16 v[224:227], v[60:63], a[68:71], v[224:227]
    s_xor_b32 s62, s62, 896
    v_add_u32 v15, 0xfffe0000, v15
    v_mfma_f32_16x16x32_bf16 v[228:231], v[56:59], a[72:75], v[228:231]
    buffer_load_dword v124, v120, s[40:43], s82 offen nt
    v_mfma_f32_16x16x32_bf16 v[228:231], v[60:63], a[76:79], v[228:231]
    v_mfma_f32_16x16x32_bf16 v[232:235], v[56:59], a[80:83], v[232:235]
    buffer_load_dword v105, v103, s[20:23], s77 offen
    v_mfma_f32_16x16x32_bf16 v[232:235], v[60:63], a[84:87], v[232:235]
    s_add_u32 m0, s69, 65536
    v_mfma_f32_16x16x32_bf16 v[236:239], v[56:59], a[88:91], v[236:239]
    s_mul_i32 s77, s2, 18432
    v_mfma_f32_16x16x32_bf16 v[236:239], v[60:63], a[92:95], v[236:239]
    s_add_u32 s77, s77, s76
    v_mfma_f32_16x16x32_bf16 v[240:243], v[56:59], a[96:99], v[240:243]
    s_mov_b32 s76, 0
    buffer_load_dwordx2 v[82:83], v77, s[28:31], s98 offen nt
    v_mfma_f32_16x16x32_bf16 v[240:243], v[60:63], a[100:103], v[240:243]
    s_add_u32 s98, s98, 3456
    v_mfma_f32_16x16x32_bf16 v[244:247], v[56:59], a[104:107], v[244:247]
    v_mfma_f32_16x16x32_bf16 v[244:247], v[60:63], a[108:111], v[244:247]
    v_mfma_f32_16x16x32_bf16 v[248:251], v[56:59], a[112:115], v[248:251]
    buffer_load_ushort v92, v65, s[32:35], s99 offen offset:0
    v_mfma_f32_16x16x32_bf16 v[248:251], v[60:63], a[116:119], v[248:251]
    v_mfma_f32_16x16x32_bf16 v[252:255], v[56:59], a[120:123], v[252:255]
    ds_read_b64_tr_b16 v[56:57], v16 offset:0
    ds_read_b64_tr_b16 v[58:59], v16 offset:1024
    v_mfma_f32_16x16x32_bf16 v[252:255], v[60:63], a[124:127], v[252:255]
    s_waitcnt lgkmcnt(2)
    ds_read_b64_tr_b16 v[60:61], v16 offset:8192
    ds_read_b64_tr_b16 v[62:63], v16 offset:9216
    v_mfma_f32_16x16x32_bf16 a[128:131], a[64:67], v[40:43], a[128:131]
    buffer_load_dwordx2 v[84:85], v75, s[28:31], s98 offen nt
    v_mfma_f32_16x16x32_bf16 a[128:131], a[68:71], v[44:47], a[128:131]
    v_add_u32 v22, 0x10000, v22
    v_add_u32 v16, 0xfffe0000, v16
    v_mfma_f32_16x16x32_bf16 a[132:135], a[72:75], v[40:43], a[132:135]
    ds_read_b128 a[32:35], v22 offset:16384
    v_mfma_f32_16x16x32_bf16 a[132:135], a[76:79], v[44:47], a[132:135]
    v_mfma_f32_16x16x32_bf16 a[136:139], a[80:83], v[40:43], a[136:139]
    buffer_load_dwordx4 v2, s[12:15], s60 offen nt lds
    v_mfma_f32_16x16x32_bf16 a[136:139], a[84:87], v[44:47], a[136:139]
    v_mfma_f32_16x16x32_bf16 a[140:143], a[88:91], v[40:43], a[140:143]
    v_add_u32 v23, 0x10000, v23
    v_mfma_f32_16x16x32_bf16 a[140:143], a[92:95], v[44:47], a[140:143]
    ds_read_b128 a[36:39], v23 offset:16384
    v_mfma_f32_16x16x32_bf16 a[144:147], a[96:99], v[40:43], a[144:147]
    buffer_load_dwordx2 v[86:87], v77, s[28:31], s98 offen nt
    v_mfma_f32_16x16x32_bf16 a[144:147], a[100:103], v[44:47], a[144:147]
    s_add_u32 s98, s98, 3456
    v_mfma_f32_16x16x32_bf16 a[148:151], a[104:107], v[40:43], a[148:151]
    v_mfma_f32_16x16x32_bf16 a[148:151], a[108:111], v[44:47], a[148:151]
    v_mfma_f32_16x16x32_bf16 a[152:155], a[112:115], v[40:43], a[152:155]
    buffer_load_ushort v93, v65, s[32:35], s99 offen offset:2
    v_mfma_f32_16x16x32_bf16 a[152:155], a[116:119], v[44:47], a[152:155]
    ds_read_b128 a[40:43], v22 offset:18432
    v_mfma_f32_16x16x32_bf16 a[156:159], a[120:123], v[40:43], a[156:159]
    ds_read_b64_tr_b16 v[40:41], v17 offset:0
    ds_read_b64_tr_b16 v[42:43], v17 offset:1024
    v_mfma_f32_16x16x32_bf16 a[156:159], a[124:127], v[44:47], a[156:159]
    ds_read_b64_tr_b16 v[44:45], v17 offset:8192
    ds_read_b64_tr_b16 v[46:47], v17 offset:9216
    v_mfma_f32_16x16x32_bf16 a[160:163], a[64:67], v[48:51], a[160:163]
    buffer_load_dwordx2 v[88:89], v75, s[28:31], s98 offen nt
    v_mfma_f32_16x16x32_bf16 a[160:163], a[68:71], v[52:55], a[160:163]
    v_add_u32 v17, 0xfffe0000, v17
    v_mfma_f32_16x16x32_bf16 a[164:167], a[72:75], v[48:51], a[164:167]
    ds_read_b128 a[44:47], v23 offset:18432
    v_mfma_f32_16x16x32_bf16 a[164:167], a[76:79], v[52:55], a[164:167]
    v_mfma_f32_16x16x32_bf16 a[168:171], a[80:83], v[48:51], a[168:171]
    buffer_load_dwordx4 v3, s[12:15], s60 offen offset:1024 nt lds
    v_mfma_f32_16x16x32_bf16 a[168:171], a[84:87], v[52:55], a[168:171]
    v_mfma_f32_16x16x32_bf16 a[172:175], a[88:91], v[48:51], a[172:175]
    v_mfma_f32_16x16x32_bf16 a[172:175], a[92:95], v[52:55], a[172:175]
    v_mfma_f32_16x16x32_bf16 a[176:179], a[96:99], v[48:51], a[176:179]
    buffer_load_dwordx2 v[90:91], v77, s[28:31], s98 offen nt
    v_mfma_f32_16x16x32_bf16 a[176:179], a[100:103], v[52:55], a[176:179]
    s_add_u32 s98, s98, 3456
    s_add_u32 s28, s56, 6291456
    s_addc_u32 s29, s57, 0
    v_mfma_f32_16x16x32_bf16 a[180:183], a[104:107], v[48:51], a[180:183]
    s_mov_b32 s30, 2359296
    ds_read_b128 a[48:51], v22 offset:20480
    v_mfma_f32_16x16x32_bf16 a[180:183], a[108:111], v[52:55], a[180:183]
    s_bfe_u32 s98, s72, 0x10001
    v_mfma_f32_16x16x32_bf16 a[184:187], a[112:115], v[48:51], a[184:187]
    buffer_load_ushort v94, v65, s[32:35], s99 offen offset:4
    v_mfma_f32_16x16x32_bf16 a[184:187], a[116:119], v[52:55], a[184:187]
    s_add_u32 s32, s56, 9437184
    s_addc_u32 s33, s57, 0
    s_mov_b32 s34, 163840
    v_mfma_f32_16x16x32_bf16 a[188:191], a[120:123], v[48:51], a[188:191]
    s_bfe_u32 s99, s72, 0x10003
    ds_read_b128 a[52:55], v23 offset:20480
    v_mfma_f32_16x16x32_bf16 a[188:191], a[124:127], v[52:55], a[188:191]
    s_lshl1_add_u32 s98, s99, s98
    s_waitcnt lgkmcnt(1)
    v_mfma_f32_16x16x32_bf16 a[192:195], a[64:67], v[56:59], a[192:195]
    s_lshl_b32 s98, s98, 5
    buffer_store_dword v65, v64, s[32:35], s101 offen sc1
    v_mfma_f32_16x16x32_bf16 a[192:195], a[68:71], v[60:63], a[192:195]
    s_lshl_b32 s72, s72, 7
    v_mfma_f32_16x16x32_bf16 a[196:199], a[72:75], v[56:59], a[196:199]
    v_mfma_f32_16x16x32_bf16 a[196:199], a[76:79], v[60:63], a[196:199]
    ds_read_b128 a[56:59], v22 offset:22528
    v_mfma_f32_16x16x32_bf16 a[200:203], a[80:83], v[56:59], a[200:203]
    buffer_load_dwordx4 v4, s[12:15], s60 offen offset:2048 nt lds
    v_mfma_f32_16x16x32_bf16 a[200:203], a[84:87], v[60:63], a[200:203]
    v_mfma_f32_16x16x32_bf16 a[204:207], a[88:91], v[56:59], a[204:207]
    v_mfma_f32_16x16x32_bf16 a[204:207], a[92:95], v[60:63], a[204:207]
    v_mfma_f32_16x16x32_bf16 a[208:211], a[96:99], v[56:59], a[208:211]
    buffer_load_dwordx4 v5, s[12:15], s60 offen offset:3072 nt lds
    v_mfma_f32_16x16x32_bf16 a[208:211], a[100:103], v[60:63], a[208:211]
    s_add_u32 m0, s69, 81920
    ds_read_b128 a[60:63], v23 offset:22528
    v_mfma_f32_16x16x32_bf16 a[212:215], a[104:107], v[56:59], a[212:215]
    v_mfma_f32_16x16x32_bf16 a[212:215], a[108:111], v[60:63], a[212:215]
    v_mfma_f32_16x16x32_bf16 a[216:219], a[112:115], v[56:59], a[216:219]
    buffer_load_dwordx4 v6, s[8:11], s61 offen lds
    v_mfma_f32_16x16x32_bf16 a[216:219], a[116:119], v[60:63], a[216:219]
    v_mfma_f32_16x16x32_bf16 a[220:223], a[120:123], v[56:59], a[220:223]
    v_mfma_f32_16x16x32_bf16 a[220:223], a[124:127], v[60:63], a[220:223]
    v_mfma_f32_16x16x32_bf16 a[224:227], a[64:67], v[40:43], a[224:227]
    buffer_load_dwordx4 v7, s[8:11], s61 offen offset:1024 lds
    v_mfma_f32_16x16x32_bf16 a[224:227], a[68:71], v[44:47], a[224:227]
    v_mfma_f32_16x16x32_bf16 a[228:231], a[72:75], v[40:43], a[228:231]
    v_mfma_f32_16x16x32_bf16 a[228:231], a[76:79], v[44:47], a[228:231]
    v_mfma_f32_16x16x32_bf16 a[232:235], a[80:83], v[40:43], a[232:235]
    buffer_load_dwordx4 v8, s[8:11], s61 offen offset:2048 lds
    v_mfma_f32_16x16x32_bf16 a[232:235], a[84:87], v[44:47], a[232:235]
    s_waitcnt vmcnt(19) lgkmcnt(0)
    s_barrier
    ds_read_b64_tr_b16 v[48:49], v14 offset:0
    v_mfma_f32_16x16x32_bf16 a[236:239], a[88:91], v[40:43], a[236:239]
    ds_read_b64_tr_b16 v[50:51], v14 offset:1024
    ds_read_b64_tr_b16 v[52:53], v14 offset:8192
    v_mfma_f32_16x16x32_bf16 a[236:239], a[92:95], v[44:47], a[236:239]
    ds_read_b64_tr_b16 v[54:55], v14 offset:9216
    ds_read_b64_tr_b16 v[56:57], v15 offset:0
    v_mfma_f32_16x16x32_bf16 a[240:243], a[96:99], v[40:43], a[240:243]
    buffer_load_dwordx4 v9, s[8:11], s61 offen offset:3072 lds
    v_mfma_f32_16x16x32_bf16 a[240:243], a[100:103], v[44:47], a[240:243]
    s_xor_b32 s61, s61, 128
    s_add_u32 m0, s69, 98304
    ds_read_b64_tr_b16 v[58:59], v15 offset:1024
    v_mfma_f32_16x16x32_bf16 a[244:247], a[104:107], v[40:43], a[244:247]
    ds_read_b64_tr_b16 v[60:61], v15 offset:8192
    ds_read_b64_tr_b16 v[62:63], v15 offset:9216
    v_mfma_f32_16x16x32_bf16 a[244:247], a[108:111], v[44:47], a[244:247]
    v_mfma_f32_16x16x32_bf16 a[248:251], a[112:115], v[40:43], a[248:251]
    buffer_load_dwordx4 v2, s[16:19], s60 offen nt lds
    v_mfma_f32_16x16x32_bf16 a[248:251], a[116:119], v[44:47], a[248:251]
    v_mfma_f32_16x16x32_bf16 a[252:255], a[120:123], v[40:43], a[252:255]
    ds_read_b64_tr_b16 v[40:41], v16 offset:0
    ds_read_b64_tr_b16 v[42:43], v16 offset:1024
    v_mfma_f32_16x16x32_bf16 a[252:255], a[124:127], v[44:47], a[252:255]
    s_waitcnt lgkmcnt(2)
    ds_read_b64_tr_b16 v[44:45], v16 offset:8192
    ds_read_b64_tr_b16 v[46:47], v16 offset:9216
    v_mfma_f32_16x16x32_bf16 v[128:131], v[48:51], a[0:3], v[128:131]
    buffer_load_dwordx4 v3, s[16:19], s60 offen offset:1024 nt lds
    v_mfma_f32_16x16x32_bf16 v[128:131], v[52:55], a[4:7], v[128:131]
    v_add_u32 v22, 0xfffe0000, v22
    v_mfma_f32_16x16x32_bf16 v[132:135], v[48:51], a[8:11], v[132:135]
    ds_read_b128 a[64:67], v22 offset:16384
    v_mfma_f32_16x16x32_bf16 v[132:135], v[52:55], a[12:15], v[132:135]
    s_cmp_lt_u32 s2, 192
    s_cselect_b32 s72, s72, 1073741824
    v_mfma_f32_16x16x32_bf16 v[136:139], v[48:51], a[16:19], v[136:139]
    v_mfma_f32_16x16x32_bf16 v[136:139], v[52:55], a[20:23], v[136:139]
    buffer_load_dwordx4 v4, s[16:19], s60 offen offset:2048 nt lds
    v_mfma_f32_16x16x32_bf16 v[140:143], v[48:51], a[24:27], v[140:143]
    v_add_u32 v23, 0xfffe0000, v23
    v_mfma_f32_16x16x32_bf16 v[140:143], v[52:55], a[28:31], v[140:143]
    ds_read_b128 a[68:71], v23 offset:16384
    v_mfma_f32_16x16x32_bf16 v[144:147], v[48:51], a[32:35], v[144:147]
    v_mfma_f32_16x16x32_bf16 v[144:147], v[52:55], a[36:39], v[144:147]
    v_mfma_f32_16x16x32_bf16 v[148:151], v[48:51], a[40:43], v[148:151]
    v_mfma_f32_16x16x32_bf16 v[148:151], v[52:55], a[44:47], v[148:151]
    v_mfma_f32_16x16x32_bf16 v[152:155], v[48:51], a[48:51], v[152:155]
    buffer_load_dwordx4 v5, s[16:19], s60 offen offset:3072 nt lds
    v_mfma_f32_16x16x32_bf16 v[152:155], v[52:55], a[52:55], v[152:155]
    ds_read_b128 a[72:75], v22 offset:18432
    v_mfma_f32_16x16x32_bf16 v[156:159], v[48:51], a[56:59], v[156:159]
    ds_read_b64_tr_b16 v[48:49], v17 offset:0
    ds_read_b64_tr_b16 v[50:51], v17 offset:1024
    v_mfma_f32_16x16x32_bf16 v[156:159], v[52:55], a[60:63], v[156:159]
    ds_read_b64_tr_b16 v[52:53], v17 offset:8192
    ds_read_b64_tr_b16 v[54:55], v17 offset:9216
    v_mfma_f32_16x16x32_bf16 v[160:163], v[56:59], a[0:3], v[160:163]
    v_mfma_f32_16x16x32_bf16 v[160:163], v[60:63], a[4:7], v[160:163]
    v_mfma_f32_16x16x32_bf16 v[164:167], v[56:59], a[8:11], v[164:167]
    ds_read_b128 a[76:79], v23 offset:18432
    v_mfma_f32_16x16x32_bf16 v[164:167], v[60:63], a[12:15], v[164:167]
    s_add_u32 m0, s69, 114688
    v_mfma_f32_16x16x32_bf16 v[168:171], v[56:59], a[16:19], v[168:171]
    s_xor_b32 s60, s60, 3670016
    buffer_load_dwordx4 v6, s[8:11], s62 offen lds
    v_mfma_f32_16x16x32_bf16 v[168:171], v[60:63], a[20:23], v[168:171]
    v_mfma_f32_16x16x32_bf16 v[172:175], v[56:59], a[24:27], v[172:175]
    v_mfma_f32_16x16x32_bf16 v[172:175], v[60:63], a[28:31], v[172:175]
    v_mfma_f32_16x16x32_bf16 v[176:179], v[56:59], a[32:35], v[176:179]
    ds_read_b128 a[80:83], v22 offset:20480
    v_mfma_f32_16x16x32_bf16 v[176:179], v[60:63], a[36:39], v[176:179]
    v_mfma_f32_16x16x32_bf16 v[180:183], v[56:59], a[40:43], v[180:183]
    v_mfma_f32_16x16x32_bf16 v[180:183], v[60:63], a[44:47], v[180:183]
    buffer_load_dwordx4 v7, s[8:11], s62 offen offset:1024 lds
    v_mfma_f32_16x16x32_bf16 v[184:187], v[56:59], a[48:51], v[184:187]
    v_mfma_f32_16x16x32_bf16 v[184:187], v[60:63], a[52:55], v[184:187]
    ds_read_b128 a[84:87], v23 offset:20480
    v_mfma_f32_16x16x32_bf16 v[188:191], v[56:59], a[56:59], v[188:191]
    s_waitcnt lgkmcnt(1)
    ds_read_b64_tr_b16 v[56:57], v14 offset:32768
    ds_read_b64_tr_b16 v[58:59], v14 offset:33792
    v_mfma_f32_16x16x32_bf16 v[188:191], v[60:63], a[60:63], v[188:191]
    ds_read_b64_tr_b16 v[60:61], v14 offset:40960
    ds_read_b64_tr_b16 v[62:63], v14 offset:41984
    v_mfma_f32_16x16x32_bf16 v[192:195], v[40:43], a[0:3], v[192:195]
    v_add_u32 v14, 0x10000, v14
    v_mfma_f32_16x16x32_bf16 v[192:195], v[44:47], a[4:7], v[192:195]
    v_mfma_f32_16x16x32_bf16 v[196:199], v[40:43], a[8:11], v[196:199]
    v_mfma_f32_16x16x32_bf16 v[196:199], v[44:47], a[12:15], v[196:199]
    buffer_load_dwordx4 v8, s[8:11], s62 offen offset:2048 lds
    v_mfma_f32_16x16x32_bf16 v[200:203], v[40:43], a[16:19], v[200:203]
    ds_read_b128 a[88:91], v22 offset:22528
    v_mfma_f32_16x16x32_bf16 v[200:203], v[44:47], a[20:23], v[200:203]
    v_mfma_f32_16x16x32_bf16 v[204:207], v[40:43], a[24:27], v[204:207]
    v_mfma_f32_16x16x32_bf16 v[204:207], v[44:47], a[28:31], v[204:207]
    v_mfma_f32_16x16x32_bf16 v[208:211], v[40:43], a[32:35], v[208:211]
    ds_read_b128 a[92:95], v23 offset:22528
    v_mfma_f32_16x16x32_bf16 v[208:211], v[44:47], a[36:39], v[208:211]
    v_mfma_f32_16x16x32_bf16 v[212:215], v[40:43], a[40:43], v[212:215]
    buffer_load_dwordx4 v9, s[8:11], s62 offen offset:3072 lds
    v_mfma_f32_16x16x32_bf16 v[212:215], v[44:47], a[44:47], v[212:215]
    v_mfma_f32_16x16x32_bf16 v[216:219], v[40:43], a[48:51], v[216:219]
    v_mfma_f32_16x16x32_bf16 v[216:219], v[44:47], a[52:55], v[216:219]
    v_mfma_f32_16x16x32_bf16 v[220:223], v[40:43], a[56:59], v[220:223]
    s_xor_b32 s82, s84, 2621696
    ds_read_b64_tr_b16 v[40:41], v15 offset:32768
    ds_read_b64_tr_b16 v[42:43], v15 offset:33792
    v_mfma_f32_16x16x32_bf16 v[220:223], v[44:47], a[60:63], v[220:223]
    ds_read_b64_tr_b16 v[44:45], v15 offset:40960
    ds_read_b64_tr_b16 v[46:47], v15 offset:41984
    v_mfma_f32_16x16x32_bf16 v[224:227], v[48:51], a[0:3], v[224:227]
    v_add_u32 v15, 0x10000, v15
    v_mfma_f32_16x16x32_bf16 v[224:227], v[52:55], a[4:7], v[224:227]
    s_xor_b32 s62, s62, 128
    v_mfma_f32_16x16x32_bf16 v[228:231], v[48:51], a[8:11], v[228:231]
    buffer_load_dword v125, v120, s[40:43], s82 offen nt
    v_mfma_f32_16x16x32_bf16 v[228:231], v[52:55], a[12:15], v[228:231]
    buffer_load_dword v106, v103, s[24:27], s77 offen
    v_mfma_f32_16x16x32_bf16 v[232:235], v[48:51], a[16:19], v[232:235]
    s_add_u32 s77, s77, 4608
    v_mfma_f32_16x16x32_bf16 v[232:235], v[52:55], a[20:23], v[232:235]
    s_add_u32 m0, s69, 131072
    v_mfma_f32_16x16x32_bf16 v[236:239], v[48:51], a[24:27], v[236:239]
    buffer_load_dwordx4 v2, s[12:15], s60 offen nt lds
    v_mfma_f32_16x16x32_bf16 v[236:239], v[52:55], a[28:31], v[236:239]
    v_mfma_f32_16x16x32_bf16 v[240:243], v[48:51], a[32:35], v[240:243]
    v_mfma_f32_16x16x32_bf16 v[240:243], v[52:55], a[36:39], v[240:243]
    v_mfma_f32_16x16x32_bf16 v[244:247], v[48:51], a[40:43], v[244:247]
    v_mfma_f32_16x16x32_bf16 v[244:247], v[52:55], a[44:47], v[244:247]
    v_mfma_f32_16x16x32_bf16 v[248:251], v[48:51], a[48:51], v[248:251]
    v_mfma_f32_16x16x32_bf16 v[248:251], v[52:55], a[52:55], v[248:251]
    buffer_load_dwordx4 v3, s[12:15], s60 offen offset:1024 nt lds
    v_mfma_f32_16x16x32_bf16 v[252:255], v[48:51], a[56:59], v[252:255]
    ds_read_b64_tr_b16 v[48:49], v16 offset:32768
    ds_read_b64_tr_b16 v[50:51], v16 offset:33792
    v_mfma_f32_16x16x32_bf16 v[252:255], v[52:55], a[60:63], v[252:255]
    s_waitcnt lgkmcnt(2)
    ds_read_b64_tr_b16 v[52:53], v16 offset:40960
    ds_read_b64_tr_b16 v[54:55], v16 offset:41984
    v_mfma_f32_16x16x32_bf16 a[128:131], a[0:3], v[56:59], a[128:131]
    v_add_u32 v16, 0x10000, v16
    v_mfma_f32_16x16x32_bf16 a[128:131], a[4:7], v[60:63], a[128:131]
    v_mfma_f32_16x16x32_bf16 a[132:135], a[8:11], v[56:59], a[132:135]
    ds_read_b128 a[96:99], v22 offset:49152
    v_mfma_f32_16x16x32_bf16 a[132:135], a[12:15], v[60:63], a[132:135]
    v_mfma_f32_16x16x32_bf16 a[136:139], a[16:19], v[56:59], a[136:139]
    v_mfma_f32_16x16x32_bf16 a[136:139], a[20:23], v[60:63], a[136:139]
    buffer_load_dwordx4 v4, s[12:15], s60 offen offset:2048 nt lds
    v_mfma_f32_16x16x32_bf16 a[140:143], a[24:27], v[56:59], a[140:143]
    v_mfma_f32_16x16x32_bf16 a[140:143], a[28:31], v[60:63], a[140:143]
    ds_read_b128 a[100:103], v23 offset:49152
    v_mfma_f32_16x16x32_bf16 a[144:147], a[32:35], v[56:59], a[144:147]
    v_mfma_f32_16x16x32_bf16 a[144:147], a[36:39], v[60:63], a[144:147]
    v_mfma_f32_16x16x32_bf16 a[148:151], a[40:43], v[56:59], a[148:151]
    v_mfma_f32_16x16x32_bf16 a[148:151], a[44:47], v[60:63], a[148:151]
    v_mfma_f32_16x16x32_bf16 a[152:155], a[48:51], v[56:59], a[152:155]
    buffer_load_dwordx4 v5, s[12:15], s60 offen offset:3072 nt lds
    v_mfma_f32_16x16x32_bf16 a[152:155], a[52:55], v[60:63], a[152:155]
    ds_read_b128 a[104:107], v22 offset:51200
    v_mfma_f32_16x16x32_bf16 a[156:159], a[56:59], v[56:59], a[156:159]
    ds_read_b64_tr_b16 v[56:57], v17 offset:32768
    ds_read_b64_tr_b16 v[58:59], v17 offset:33792
    v_mfma_f32_16x16x32_bf16 a[156:159], a[60:63], v[60:63], a[156:159]
    ds_read_b64_tr_b16 v[60:61], v17 offset:40960
    ds_read_b64_tr_b16 v[62:63], v17 offset:41984
    v_mfma_f32_16x16x32_bf16 a[160:163], a[0:3], v[40:43], a[160:163]
    v_add_u32 v17, 0x10000, v17
    v_mfma_f32_16x16x32_bf16 a[160:163], a[4:7], v[44:47], a[160:163]
    v_mfma_f32_16x16x32_bf16 a[164:167], a[8:11], v[40:43], a[164:167]
    ds_read_b128 a[108:111], v23 offset:51200
    v_mfma_f32_16x16x32_bf16 a[164:167], a[12:15], v[44:47], a[164:167]
    s_add_u32 m0, s69, 147456
    v_mfma_f32_16x16x32_bf16 a[168:171], a[16:19], v[40:43], a[168:171]
    buffer_load_dwordx4 v6, s[8:11], s61 offen lds
    v_mfma_f32_16x16x32_bf16 a[168:171], a[20:23], v[44:47], a[168:171]
    v_mfma_f32_16x16x32_bf16 a[172:175], a[24:27], v[40:43], a[172:175]
    v_mfma_f32_16x16x32_bf16 a[172:175], a[28:31], v[44:47], a[172:175]
    v_mfma_f32_16x16x32_bf16 a[176:179], a[32:35], v[40:43], a[176:179]
    ds_read_b128 a[112:115], v22 offset:53248
    v_mfma_f32_16x16x32_bf16 a[176:179], a[36:39], v[44:47], a[176:179]
    v_mfma_f32_16x16x32_bf16 a[180:183], a[40:43], v[40:43], a[180:183]
    v_mfma_f32_16x16x32_bf16 a[180:183], a[44:47], v[44:47], a[180:183]
    buffer_load_dwordx4 v7, s[8:11], s61 offen offset:1024 lds
    v_mfma_f32_16x16x32_bf16 a[184:187], a[48:51], v[40:43], a[184:187]
    v_mfma_f32_16x16x32_bf16 a[184:187], a[52:55], v[44:47], a[184:187]
    ds_read_b128 a[116:119], v23 offset:53248
    v_mfma_f32_16x16x32_bf16 a[188:191], a[56:59], v[40:43], a[188:191]
    v_mfma_f32_16x16x32_bf16 a[188:191], a[60:63], v[44:47], a[188:191]
    s_waitcnt lgkmcnt(1)
    v_mfma_f32_16x16x32_bf16 a[192:195], a[0:3], v[48:51], a[192:195]
    v_mfma_f32_16x16x32_bf16 a[192:195], a[4:7], v[52:55], a[192:195]
    v_mfma_f32_16x16x32_bf16 a[196:199], a[8:11], v[48:51], a[196:199]
    v_mfma_f32_16x16x32_bf16 a[196:199], a[12:15], v[52:55], a[196:199]
    buffer_load_dwordx4 v8, s[8:11], s61 offen offset:2048 lds
    v_mfma_f32_16x16x32_bf16 a[200:203], a[16:19], v[48:51], a[200:203]
    ds_read_b128 a[120:123], v22 offset:55296
    v_mfma_f32_16x16x32_bf16 a[200:203], a[20:23], v[52:55], a[200:203]
    v_mfma_f32_16x16x32_bf16 a[204:207], a[24:27], v[48:51], a[204:207]
    v_mfma_f32_16x16x32_bf16 a[204:207], a[28:31], v[52:55], a[204:207]
    v_mfma_f32_16x16x32_bf16 a[208:211], a[32:35], v[48:51], a[208:211]
    ds_read_b128 a[124:127], v23 offset:55296
    v_mfma_f32_16x16x32_bf16 a[208:211], a[36:39], v[52:55], a[208:211]
    v_mfma_f32_16x16x32_bf16 a[212:215], a[40:43], v[48:51], a[212:215]
    buffer_load_dwordx4 v9, s[8:11], s61 offen offset:3072 lds
    v_mfma_f32_16x16x32_bf16 a[212:215], a[44:47], v[52:55], a[212:215]
    v_mfma_f32_16x16x32_bf16 a[216:219], a[48:51], v[48:51], a[216:219]
    v_mfma_f32_16x16x32_bf16 a[216:219], a[52:55], v[52:55], a[216:219]
    v_mfma_f32_16x16x32_bf16 a[220:223], a[56:59], v[48:51], a[220:223]
    v_mfma_f32_16x16x32_bf16 a[220:223], a[60:63], v[52:55], a[220:223]
    v_mfma_f32_16x16x32_bf16 a[224:227], a[0:3], v[56:59], a[224:227]
    v_mfma_f32_16x16x32_bf16 a[224:227], a[4:7], v[60:63], a[224:227]
    s_xor_b32 s61, s61, 384
    v_mfma_f32_16x16x32_bf16 a[228:231], a[8:11], v[56:59], a[228:231]
    v_mfma_f32_16x16x32_bf16 a[228:231], a[12:15], v[60:63], a[228:231]
    v_mfma_f32_16x16x32_bf16 a[232:235], a[16:19], v[56:59], a[232:235]
    v_mfma_f32_16x16x32_bf16 a[232:235], a[20:23], v[60:63], a[232:235]
    s_waitcnt vmcnt(10) lgkmcnt(0)
    s_barrier
    ds_read_b64_tr_b16 v[40:41], v14 offset:0
    v_mfma_f32_16x16x32_bf16 a[236:239], a[24:27], v[56:59], a[236:239]
    s_add_u32 m0, s69, 0
    ds_read_b64_tr_b16 v[42:43], v14 offset:1024
    ds_read_b64_tr_b16 v[44:45], v14 offset:8192
    v_mfma_f32_16x16x32_bf16 a[236:239], a[28:31], v[60:63], a[236:239]
    buffer_load_dwordx4 v2, s[16:19], s60 offen nt lds
    v_mfma_f32_16x16x32_bf16 a[240:243], a[32:35], v[56:59], a[240:243]
    ds_read_b64_tr_b16 v[46:47], v14 offset:9216
    v_cndmask_b32 v82, v82, v92, s[92:93]
    v_mfma_f32_16x16x32_bf16 a[240:243], a[36:39], v[60:63], a[240:243]
    v_cndmask_b32_e64 v83, v83, 0, s[92:93]
    v_xor_b32 v92, s98, v95
    v_mfma_f32_16x16x32_bf16 a[244:247], a[40:43], v[56:59], a[244:247]
    buffer_store_dwordx4 v[80:83], v92, s[28:31], s72 offen sc1
    v_mfma_f32_16x16x32_bf16 a[244:247], a[44:47], v[60:63], a[244:247]
    s_mul_i32 s72, s2, 3
    ds_read_b64_tr_b16 v[48:49], v15 offset:0
    ds_read_b64_tr_b16 v[50:51], v15 offset:1024
    v_mfma_f32_16x16x32_bf16 a[248:251], a[48:51], v[56:59], a[248:251]
    s_add_u32 s72, s72, 1
    ds_read_b64_tr_b16 v[52:53], v15 offset:8192
    ds_read_b64_tr_b16 v[54:55], v15 offset:9216
    v_mfma_f32_16x16x32_bf16 a[248:251], a[52:55], v[60:63], a[248:251]
    s_bfe_u32 s98, s72, 0x10001
    buffer_load_dwordx4 v3, s[16:19], s60 offen offset:1024 nt lds
    v_mfma_f32_16x16x32_bf16 a[252:255], a[56:59], v[56:59], a[252:255]
    s_bfe_u32 s99, s72, 0x10003
    v_cndmask_b32 v86, v86, v93, s[92:93]
    v_cndmask_b32_e64 v87, v87, 0, s[92:93]
    v_mfma_f32_16x16x32_bf16 a[252:255], a[60:63], v[60:63], a[252:255]
    s_lshl1_add_u32 s98, s99, s98
    v_cndmask_b32 v90, v90, v94, s[92:93]
    v_cndmask_b32_e64 v91, v91, 0, s[92:93]
    s_waitcnt lgkmcnt(4)
    v_mfma_f32_16x16x32_bf16 v[128:131], v[40:43], a[64:67], v[128:131]
    s_lshl_b32 s98, s98, 5
    v_xor_b32 v93, s98, v95
    ds_read_b64_tr_b16 v[56:57], v16 offset:0
    v_mfma_f32_16x16x32_bf16 v[128:131], v[44:47], a[68:71], v[128:131]
    s_lshl_b32 s72, s72, 7
    v_add_u32 v22, 0x10000, v22
    ds_read_b64_tr_b16 v[58:59], v16 offset:1024
    v_mfma_f32_16x16x32_bf16 v[132:135], v[40:43], a[72:75], v[132:135]
    ds_read_b128 a[0:3], v22 offset:16384
    ds_read_b64_tr_b16 v[60:61], v16 offset:8192
    v_mfma_f32_16x16x32_bf16 v[132:135], v[44:47], a[76:79], v[132:135]
    s_cmp_lt_u32 s2, 192
    s_cselect_b32 s72, s72, 1073741824
    ds_read_b64_tr_b16 v[62:63], v16 offset:9216
    v_mfma_f32_16x16x32_bf16 v[136:139], v[40:43], a[80:83], v[136:139]
    buffer_store_dwordx4 v[84:87], v93, s[28:31], s72 offen sc1
    v_mfma_f32_16x16x32_bf16 v[136:139], v[44:47], a[84:87], v[136:139]
    s_mul_i32 s72, s2, 3
    buffer_load_dwordx4 v4, s[16:19], s60 offen offset:2048 nt lds
    v_mfma_f32_16x16x32_bf16 v[140:143], v[40:43], a[88:91], v[140:143]
    s_add_u32 s72, s72, 2
    v_add_u32 v23, 0x10000, v23
    v_mfma_f32_16x16x32_bf16 v[140:143], v[44:47], a[92:95], v[140:143]
    s_bfe_u32 s98, s72, 0x10001
    ds_read_b128 a[4:7], v23 offset:16384
    v_mfma_f32_16x16x32_bf16 v[144:147], v[40:43], a[96:99], v[144:147]
    s_bfe_u32 s99, s72, 0x10003
    v_mfma_f32_16x16x32_bf16 v[144:147], v[44:47], a[100:103], v[144:147]
    s_lshl1_add_u32 s98, s99, s98
    v_mfma_f32_16x16x32_bf16 v[148:151], v[40:43], a[104:107], v[148:151]
    s_lshl_b32 s98, s98, 5
    v_xor_b32 v94, s98, v95
    v_mfma_f32_16x16x32_bf16 v[148:151], v[44:47], a[108:111], v[148:151]
    s_lshl_b32 s72, s72, 7
    v_mfma_f32_16x16x32_bf16 v[152:155], v[40:43], a[112:115], v[152:155]
    s_lshl2_add_u32 s99, s100, s4
    buffer_load_dwordx4 v5, s[16:19], s60 offen offset:3072 nt lds
    v_mfma_f32_16x16x32_bf16 v[152:155], v[44:47], a[116:119], v[152:155]
    s_lshl_b32 s99, s99, 7
    ds_read_b128 a[8:11], v22 offset:18432
    v_mfma_f32_16x16x32_bf16 v[156:159], v[40:43], a[120:123], v[156:159]
    s_cmp_lt_u32 s2, 192
    s_cselect_b32 s72, s72, 1073741824
    ds_read_b64_tr_b16 v[40:41], v17 offset:0
    v_mfma_f32_16x16x32_bf16 v[156:159], v[44:47], a[124:127], v[156:159]
    s_waitcnt lgkmcnt(2)
    buffer_store_dwordx4 v[88:91], v94, s[28:31], s72 offen sc1
    v_mfma_f32_16x16x32_bf16 v[160:163], v[48:51], a[64:67], v[160:163]
    s_mov_b32 s30, 73728
    ds_read_b64_tr_b16 v[42:43], v17 offset:1024
    ds_read_b64_tr_b16 v[44:45], v17 offset:8192
    v_mfma_f32_16x16x32_bf16 v[160:163], v[52:55], a[68:71], v[160:163]
    ds_read_b64_tr_b16 v[46:47], v17 offset:9216
    v_mfma_f32_16x16x32_bf16 v[164:167], v[48:51], a[72:75], v[164:167]
    ds_read_b128 a[12:15], v23 offset:18432
    v_mfma_f32_16x16x32_bf16 v[164:167], v[52:55], a[76:79], v[164:167]
    s_add_u32 m0, s69, 16384
    v_mfma_f32_16x16x32_bf16 v[168:171], v[48:51], a[80:83], v[168:171]
    s_xor_b32 s60, s60, 524288
    buffer_load_dwordx4 v6, s[8:11], s62 offen lds
    v_mfma_f32_16x16x32_bf16 v[168:171], v[52:55], a[84:87], v[168:171]
    s_add_u32 s28, s28, s7
    s_addc_u32 s29, s29, 0
    v_mfma_f32_16x16x32_bf16 v[172:175], v[48:51], a[88:91], v[172:175]
    s_lshr_b32 s7, s6, 1
    v_mfma_f32_16x16x32_bf16 v[172:175], v[52:55], a[92:95], v[172:175]
    s_lshl2_add_u32 s7, s5, s7
    v_mfma_f32_16x16x32_bf16 v[176:179], v[48:51], a[96:99], v[176:179]
    s_mul_i32 s98, s7, 36864
    ds_read_b128 a[16:19], v22 offset:20480
    v_add_u32 v36, s98, v36
    v_mfma_f32_16x16x32_bf16 v[176:179], v[52:55], a[100:103], v[176:179]
    s_mul_i32 s7, s7, 36864
    v_sub_u32 v39, v36, v39
    v_lshl_add_u32 v36, s100, 6, v36
    v_mfma_f32_16x16x32_bf16 v[180:183], v[48:51], a[104:107], v[180:183]
    v_mfma_f32_16x16x32_bf16 v[180:183], v[52:55], a[108:111], v[180:183]
    buffer_load_dwordx4 v7, s[8:11], s62 offen offset:1024 lds
    v_mfma_f32_16x16x32_bf16 v[184:187], v[48:51], a[112:115], v[184:187]
    v_mfma_f32_16x16x32_bf16 v[184:187], v[52:55], a[116:119], v[184:187]
    ds_read_b128 a[20:23], v23 offset:20480
    v_mfma_f32_16x16x32_bf16 v[188:191], v[48:51], a[120:123], v[188:191]
    ds_read_b64_tr_b16 v[48:49], v14 offset:32768
    ds_read_b64_tr_b16 v[50:51], v14 offset:33792
    v_mfma_f32_16x16x32_bf16 v[188:191], v[52:55], a[124:127], v[188:191]
    ds_read_b64_tr_b16 v[52:53], v14 offset:40960
    ds_read_b64_tr_b16 v[54:55], v14 offset:41984
    v_mfma_f32_16x16x32_bf16 v[192:195], v[56:59], a[64:67], v[192:195]
    v_add_u32 v14, 0x10000, v14
    v_mfma_f32_16x16x32_bf16 v[192:195], v[60:63], a[68:71], v[192:195]
    v_mfma_f32_16x16x32_bf16 v[196:199], v[56:59], a[72:75], v[196:199]
    v_mfma_f32_16x16x32_bf16 v[196:199], v[60:63], a[76:79], v[196:199]
    buffer_load_dwordx4 v8, s[8:11], s62 offen offset:2048 lds
    v_mfma_f32_16x16x32_bf16 v[200:203], v[56:59], a[80:83], v[200:203]
    ds_read_b128 a[24:27], v22 offset:22528
    v_mfma_f32_16x16x32_bf16 v[200:203], v[60:63], a[84:87], v[200:203]
    v_mfma_f32_16x16x32_bf16 v[204:207], v[56:59], a[88:91], v[204:207]
    v_mfma_f32_16x16x32_bf16 v[204:207], v[60:63], a[92:95], v[204:207]
    v_mfma_f32_16x16x32_bf16 v[208:211], v[56:59], a[96:99], v[208:211]
    ds_read_b128 a[28:31], v23 offset:22528
    v_mfma_f32_16x16x32_bf16 v[208:211], v[60:63], a[100:103], v[208:211]
    v_mfma_f32_16x16x32_bf16 v[212:215], v[56:59], a[104:107], v[212:215]
    buffer_load_dwordx4 v9, s[8:11], s62 offen offset:3072 lds
    v_mfma_f32_16x16x32_bf16 v[212:215], v[60:63], a[108:111], v[212:215]
    v_mfma_f32_16x16x32_bf16 v[216:219], v[56:59], a[112:115], v[216:219]
    v_mfma_f32_16x16x32_bf16 v[216:219], v[60:63], a[116:119], v[216:219]
    v_mfma_f32_16x16x32_bf16 v[220:223], v[56:59], a[120:123], v[220:223]
    s_xor_b32 s82, s84, 3146240
    ds_read_b64_tr_b16 v[56:57], v15 offset:32768
    s_waitcnt lgkmcnt(1)
    ds_read_b64_tr_b16 v[58:59], v15 offset:33792
    v_mfma_f32_16x16x32_bf16 v[220:223], v[60:63], a[124:127], v[220:223]
    ds_read_b64_tr_b16 v[60:61], v15 offset:40960
    ds_read_b64_tr_b16 v[62:63], v15 offset:41984
    v_mfma_f32_16x16x32_bf16 v[224:227], v[40:43], a[64:67], v[224:227]
    v_add_u32 v15, 0x10000, v15
    v_mfma_f32_16x16x32_bf16 v[224:227], v[44:47], a[68:71], v[224:227]
    s_xor_b32 s62, s62, 384
    v_mfma_f32_16x16x32_bf16 v[228:231], v[40:43], a[72:75], v[228:231]
    buffer_load_dword v126, v120, s[40:43], s82 offen nt
    v_mfma_f32_16x16x32_bf16 v[228:231], v[44:47], a[76:79], v[228:231]
    buffer_load_dword v107, v103, s[24:27], s77 offen
    v_mfma_f32_16x16x32_bf16 v[232:235], v[40:43], a[80:83], v[232:235]
    s_add_u32 s77, s77, 4608
    v_mfma_f32_16x16x32_bf16 v[232:235], v[44:47], a[84:87], v[232:235]
    s_add_u32 m0, s69, 32768
    v_mfma_f32_16x16x32_bf16 v[236:239], v[40:43], a[88:91], v[236:239]
    buffer_load_dwordx4 v2, s[12:15], s60 offen nt lds
    v_mfma_f32_16x16x32_bf16 v[236:239], v[44:47], a[92:95], v[236:239]
    v_mfma_f32_16x16x32_bf16 v[240:243], v[40:43], a[96:99], v[240:243]
    v_mfma_f32_16x16x32_bf16 v[240:243], v[44:47], a[100:103], v[240:243]
    v_mfma_f32_16x16x32_bf16 v[244:247], v[40:43], a[104:107], v[244:247]
    v_mfma_f32_16x16x32_bf16 v[244:247], v[44:47], a[108:111], v[244:247]
    v_mfma_f32_16x16x32_bf16 v[248:251], v[40:43], a[112:115], v[248:251]
    v_mfma_f32_16x16x32_bf16 v[248:251], v[44:47], a[116:119], v[248:251]
    buffer_load_dwordx4 v3, s[12:15], s60 offen offset:1024 nt lds
    v_mfma_f32_16x16x32_bf16 v[252:255], v[40:43], a[120:123], v[252:255]
    ds_read_b64_tr_b16 v[40:41], v16 offset:32768
    ds_read_b64_tr_b16 v[42:43], v16 offset:33792
    v_mfma_f32_16x16x32_bf16 v[252:255], v[44:47], a[124:127], v[252:255]
    ds_read_b64_tr_b16 v[44:45], v16 offset:40960
    ds_read_b64_tr_b16 v[46:47], v16 offset:41984
    v_mfma_f32_16x16x32_bf16 a[128:131], a[64:67], v[48:51], a[128:131]
    v_add_u32 v16, 0x10000, v16
    v_mfma_f32_16x16x32_bf16 a[128:131], a[68:71], v[52:55], a[128:131]
    v_mfma_f32_16x16x32_bf16 a[132:135], a[72:75], v[48:51], a[132:135]
    ds_read_b128 a[32:35], v22 offset:49152
    v_mfma_f32_16x16x32_bf16 a[132:135], a[76:79], v[52:55], a[132:135]
    v_mfma_f32_16x16x32_bf16 a[136:139], a[80:83], v[48:51], a[136:139]
    v_mfma_f32_16x16x32_bf16 a[136:139], a[84:87], v[52:55], a[136:139]
    buffer_load_dwordx4 v4, s[12:15], s60 offen offset:2048 nt lds
    v_mfma_f32_16x16x32_bf16 a[140:143], a[88:91], v[48:51], a[140:143]
    v_mfma_f32_16x16x32_bf16 a[140:143], a[92:95], v[52:55], a[140:143]
    ds_read_b128 a[36:39], v23 offset:49152
    v_mfma_f32_16x16x32_bf16 a[144:147], a[96:99], v[48:51], a[144:147]
    v_mfma_f32_16x16x32_bf16 a[144:147], a[100:103], v[52:55], a[144:147]
    v_mfma_f32_16x16x32_bf16 a[148:151], a[104:107], v[48:51], a[148:151]
    v_mfma_f32_16x16x32_bf16 a[148:151], a[108:111], v[52:55], a[148:151]
    v_mfma_f32_16x16x32_bf16 a[152:155], a[112:115], v[48:51], a[152:155]
    buffer_load_dwordx4 v5, s[12:15], s60 offen offset:3072 nt lds
    v_mfma_f32_16x16x32_bf16 a[152:155], a[116:119], v[52:55], a[152:155]
    ds_read_b128 a[40:43], v22 offset:51200
    v_mfma_f32_16x16x32_bf16 a[156:159], a[120:123], v[48:51], a[156:159]
    ds_read_b64_tr_b16 v[48:49], v17 offset:32768
    ds_read_b64_tr_b16 v[50:51], v17 offset:33792
    v_mfma_f32_16x16x32_bf16 a[156:159], a[124:127], v[52:55], a[156:159]
    s_waitcnt lgkmcnt(3)
    ds_read_b64_tr_b16 v[52:53], v17 offset:40960
    ds_read_b64_tr_b16 v[54:55], v17 offset:41984
    v_mfma_f32_16x16x32_bf16 a[160:163], a[64:67], v[56:59], a[160:163]
    v_add_u32 v17, 0x10000, v17
    v_mfma_f32_16x16x32_bf16 a[160:163], a[68:71], v[60:63], a[160:163]
    v_mfma_f32_16x16x32_bf16 a[164:167], a[72:75], v[56:59], a[164:167]
    ds_read_b128 a[44:47], v23 offset:51200
    v_mfma_f32_16x16x32_bf16 a[164:167], a[76:79], v[60:63], a[164:167]
    s_add_u32 m0, s69, 49152
    v_mfma_f32_16x16x32_bf16 a[168:171], a[80:83], v[56:59], a[168:171]
    buffer_load_dwordx4 v6, s[8:11], s61 offen lds
    v_mfma_f32_16x16x32_bf16 a[168:171], a[84:87], v[60:63], a[168:171]
    v_mfma_f32_16x16x32_bf16 a[172:175], a[88:91], v[56:59], a[172:175]
    v_mfma_f32_16x16x32_bf16 a[172:175], a[92:95], v[60:63], a[172:175]
    v_mfma_f32_16x16x32_bf16 a[176:179], a[96:99], v[56:59], a[176:179]
    ds_read_b128 a[48:51], v22 offset:53248
    v_mfma_f32_16x16x32_bf16 a[176:179], a[100:103], v[60:63], a[176:179]
    v_mfma_f32_16x16x32_bf16 a[180:183], a[104:107], v[56:59], a[180:183]
    v_mfma_f32_16x16x32_bf16 a[180:183], a[108:111], v[60:63], a[180:183]
    buffer_load_dwordx4 v7, s[8:11], s61 offen offset:1024 lds
    v_mfma_f32_16x16x32_bf16 a[184:187], a[112:115], v[56:59], a[184:187]
    v_mfma_f32_16x16x32_bf16 a[184:187], a[116:119], v[60:63], a[184:187]
    ds_read_b128 a[52:55], v23 offset:53248
    v_mfma_f32_16x16x32_bf16 a[188:191], a[120:123], v[56:59], a[188:191]
    v_mfma_f32_16x16x32_bf16 a[188:191], a[124:127], v[60:63], a[188:191]
    v_mfma_f32_16x16x32_bf16 a[192:195], a[64:67], v[40:43], a[192:195]
    v_mfma_f32_16x16x32_bf16 a[192:195], a[68:71], v[44:47], a[192:195]
    v_mfma_f32_16x16x32_bf16 a[196:199], a[72:75], v[40:43], a[196:199]
    v_mfma_f32_16x16x32_bf16 a[196:199], a[76:79], v[44:47], a[196:199]
    buffer_load_dwordx4 v8, s[8:11], s61 offen offset:2048 lds
    v_mfma_f32_16x16x32_bf16 a[200:203], a[80:83], v[40:43], a[200:203]
    ds_read_b128 a[56:59], v22 offset:55296
    v_mfma_f32_16x16x32_bf16 a[200:203], a[84:87], v[44:47], a[200:203]
    v_mfma_f32_16x16x32_bf16 a[204:207], a[88:91], v[40:43], a[204:207]
    v_mfma_f32_16x16x32_bf16 a[204:207], a[92:95], v[44:47], a[204:207]
    v_mfma_f32_16x16x32_bf16 a[208:211], a[96:99], v[40:43], a[208:211]
    ds_read_b128 a[60:63], v23 offset:55296
    v_mfma_f32_16x16x32_bf16 a[208:211], a[100:103], v[44:47], a[208:211]
    v_mfma_f32_16x16x32_bf16 a[212:215], a[104:107], v[40:43], a[212:215]
    buffer_load_dwordx4 v9, s[8:11], s61 offen offset:3072 lds
    v_mfma_f32_16x16x32_bf16 a[212:215], a[108:111], v[44:47], a[212:215]
    v_mfma_f32_16x16x32_bf16 a[216:219], a[112:115], v[40:43], a[216:219]
    v_mfma_f32_16x16x32_bf16 a[216:219], a[116:119], v[44:47], a[216:219]
    v_mfma_f32_16x16x32_bf16 a[220:223], a[120:123], v[40:43], a[220:223]
    v_mfma_f32_16x16x32_bf16 a[220:223], a[124:127], v[44:47], a[220:223]
    s_waitcnt lgkmcnt(0)
    v_mfma_f32_16x16x32_bf16 a[224:227], a[64:67], v[48:51], a[224:227]
    v_mfma_f32_16x16x32_bf16 a[224:227], a[68:71], v[52:55], a[224:227]
    s_xor_b32 s61, s61, 128
    v_mfma_f32_16x16x32_bf16 a[228:231], a[72:75], v[48:51], a[228:231]
    v_mfma_f32_16x16x32_bf16 a[228:231], a[76:79], v[52:55], a[228:231]
    v_mfma_f32_16x16x32_bf16 a[232:235], a[80:83], v[48:51], a[232:235]
    v_mfma_f32_16x16x32_bf16 a[232:235], a[84:87], v[52:55], a[232:235]
    s_waitcnt vmcnt(10) lgkmcnt(0)
    s_barrier
    ds_read_b64_tr_b16 v[56:57], v14 offset:0
    v_mfma_f32_16x16x32_bf16 a[236:239], a[88:91], v[48:51], a[236:239]
    s_add_u32 m0, s69, 65536
    ds_read_b64_tr_b16 v[58:59], v14 offset:1024
    ds_read_b64_tr_b16 v[60:61], v14 offset:8192
    v_mfma_f32_16x16x32_bf16 a[236:239], a[92:95], v[52:55], a[236:239]
    buffer_load_dwordx4 v2, s[16:19], s60 offen nt lds
    v_mfma_f32_16x16x32_bf16 a[240:243], a[96:99], v[48:51], a[240:243]
    ds_read_b64_tr_b16 v[62:63], v14 offset:9216
    ds_read_b64_tr_b16 v[40:41], v15 offset:0
    v_mfma_f32_16x16x32_bf16 a[240:243], a[100:103], v[52:55], a[240:243]
    buffer_atomic_add v31, v30, s[44:47], s95 offen sc1
    v_mfma_f32_16x16x32_bf16 a[244:247], a[104:107], v[48:51], a[244:247]
    ds_read_b64_tr_b16 v[42:43], v15 offset:1024
    ds_read_b64_tr_b16 v[44:45], v15 offset:8192
    v_mfma_f32_16x16x32_bf16 a[244:247], a[108:111], v[52:55], a[244:247]
    ds_read_b64_tr_b16 v[46:47], v15 offset:9216
    v_add_u32 v14, 0xfffe0000, v14
    v_mfma_f32_16x16x32_bf16 a[248:251], a[112:115], v[48:51], a[248:251]
    v_add_u32 v15, 0xfffe0000, v15
    v_mfma_f32_16x16x32_bf16 a[248:251], a[116:119], v[52:55], a[248:251]
    buffer_load_dwordx4 v3, s[16:19], s60 offen offset:1024 nt lds
    v_mfma_f32_16x16x32_bf16 a[252:255], a[120:123], v[48:51], a[252:255]
    ds_read_b64_tr_b16 v[48:49], v16 offset:0
    ds_read_b64_tr_b16 v[50:51], v16 offset:1024
    v_mfma_f32_16x16x32_bf16 a[252:255], a[124:127], v[52:55], a[252:255]
    s_waitcnt lgkmcnt(3)
    ds_read_b64_tr_b16 v[52:53], v16 offset:8192
    ds_read_b64_tr_b16 v[54:55], v16 offset:9216
    v_mfma_f32_16x16x32_bf16 v[128:131], v[56:59], a[0:3], v[128:131]
    v_add_u32 v16, 0xfffe0000, v16
    v_mfma_f32_16x16x32_bf16 v[128:131], v[60:63], a[4:7], v[128:131]
    v_add_u32 v22, 0x10000, v22
    v_mfma_f32_16x16x32_bf16 v[132:135], v[56:59], a[8:11], v[132:135]
    ds_read_b128 a[64:67], v22 offset:16384
    v_mfma_f32_16x16x32_bf16 v[132:135], v[60:63], a[12:15], v[132:135]
    v_mfma_f32_16x16x32_bf16 v[136:139], v[56:59], a[16:19], v[136:139]
    v_mfma_f32_16x16x32_bf16 v[136:139], v[60:63], a[20:23], v[136:139]
    buffer_load_dwordx4 v4, s[16:19], s60 offen offset:2048 nt lds
    v_mfma_f32_16x16x32_bf16 v[140:143], v[56:59], a[24:27], v[140:143]
    v_add_u32 v23, 0x10000, v23
    v_mfma_f32_16x16x32_bf16 v[140:143], v[60:63], a[28:31], v[140:143]
    ds_read_b128 a[68:71], v23 offset:16384
    v_mfma_f32_16x16x32_bf16 v[144:147], v[56:59], a[32:35], v[144:147]
    v_mfma_f32_16x16x32_bf16 v[144:147], v[60:63], a[36:39], v[144:147]
    v_mfma_f32_16x16x32_bf16 v[148:151], v[56:59], a[40:43], v[148:151]
    v_mfma_f32_16x16x32_bf16 v[148:151], v[60:63], a[44:47], v[148:151]
    v_mfma_f32_16x16x32_bf16 v[152:155], v[56:59], a[48:51], v[152:155]
    buffer_load_dwordx4 v5, s[16:19], s60 offen offset:3072 nt lds
    v_mfma_f32_16x16x32_bf16 v[152:155], v[60:63], a[52:55], v[152:155]
    ds_read_b128 a[72:75], v22 offset:18432
    v_mfma_f32_16x16x32_bf16 v[156:159], v[56:59], a[56:59], v[156:159]
    ds_read_b64_tr_b16 v[56:57], v17 offset:0
    ds_read_b64_tr_b16 v[58:59], v17 offset:1024
    v_mfma_f32_16x16x32_bf16 v[156:159], v[60:63], a[60:63], v[156:159]
    ds_read_b64_tr_b16 v[60:61], v17 offset:8192
    ds_read_b64_tr_b16 v[62:63], v17 offset:9216
    v_mfma_f32_16x16x32_bf16 v[160:163], v[40:43], a[0:3], v[160:163]
    s_waitcnt lgkmcnt(5)
    v_add_u32 v17, 0xfffe0000, v17
    v_mfma_f32_16x16x32_bf16 v[160:163], v[44:47], a[4:7], v[160:163]
    v_mfma_f32_16x16x32_bf16 v[164:167], v[40:43], a[8:11], v[164:167]
    ds_read_b128 a[76:79], v23 offset:18432
    v_mfma_f32_16x16x32_bf16 v[164:167], v[44:47], a[12:15], v[164:167]
    s_add_u32 m0, s69, 81920
    v_mfma_f32_16x16x32_bf16 v[168:171], v[40:43], a[16:19], v[168:171]
    s_xor_b32 s60, s60, 1572864
    buffer_load_dwordx4 v6, s[8:11], s62 offen lds
    v_mfma_f32_16x16x32_bf16 v[168:171], v[44:47], a[20:23], v[168:171]
    v_mfma_f32_16x16x32_bf16 v[172:175], v[40:43], a[24:27], v[172:175]
    v_mfma_f32_16x16x32_bf16 v[172:175], v[44:47], a[28:31], v[172:175]
    v_mfma_f32_16x16x32_bf16 v[176:179], v[40:43], a[32:35], v[176:179]
    ds_read_b128 a[80:83], v22 offset:20480
    v_mfma_f32_16x16x32_bf16 v[176:179], v[44:47], a[36:39], v[176:179]
    v_mfma_f32_16x16x32_bf16 v[180:183], v[40:43], a[40:43], v[180:183]
    v_mfma_f32_16x16x32_bf16 v[180:183], v[44:47], a[44:47], v[180:183]
    buffer_load_dwordx4 v7, s[8:11], s62 offen offset:1024 lds
    v_mfma_f32_16x16x32_bf16 v[184:187], v[40:43], a[48:51], v[184:187]
    v_mfma_f32_16x16x32_bf16 v[184:187], v[44:47], a[52:55], v[184:187]
    ds_read_b128 a[84:87], v23 offset:20480
    v_mfma_f32_16x16x32_bf16 v[188:191], v[40:43], a[56:59], v[188:191]
    ds_read_b64_tr_b16 v[40:41], v14 offset:0
    ds_read_b64_tr_b16 v[42:43], v14 offset:1024
    v_mfma_f32_16x16x32_bf16 v[188:191], v[44:47], a[60:63], v[188:191]
    ds_read_b64_tr_b16 v[44:45], v14 offset:8192
    ds_read_b64_tr_b16 v[46:47], v14 offset:9216
    v_mfma_f32_16x16x32_bf16 v[192:195], v[48:51], a[0:3], v[192:195]
    v_mfma_f32_16x16x32_bf16 v[192:195], v[52:55], a[4:7], v[192:195]
    v_mfma_f32_16x16x32_bf16 v[196:199], v[48:51], a[8:11], v[196:199]
    v_mfma_f32_16x16x32_bf16 v[196:199], v[52:55], a[12:15], v[196:199]
    buffer_load_dwordx4 v8, s[8:11], s62 offen offset:2048 lds
    v_mfma_f32_16x16x32_bf16 v[200:203], v[48:51], a[16:19], v[200:203]
    ds_read_b128 a[88:91], v22 offset:22528
    v_mfma_f32_16x16x32_bf16 v[200:203], v[52:55], a[20:23], v[200:203]
    v_mfma_f32_16x16x32_bf16 v[204:207], v[48:51], a[24:27], v[204:207]
    v_mfma_f32_16x16x32_bf16 v[204:207], v[52:55], a[28:31], v[204:207]
    v_mfma_f32_16x16x32_bf16 v[208:211], v[48:51], a[32:35], v[208:211]
    ds_read_b128 a[92:95], v23 offset:22528
    v_mfma_f32_16x16x32_bf16 v[208:211], v[52:55], a[36:39], v[208:211]
    v_mfma_f32_16x16x32_bf16 v[212:215], v[48:51], a[40:43], v[212:215]
    buffer_load_dwordx4 v9, s[8:11], s62 offen offset:3072 lds
    v_mfma_f32_16x16x32_bf16 v[212:215], v[52:55], a[44:47], v[212:215]
    v_mfma_f32_16x16x32_bf16 v[216:219], v[48:51], a[48:51], v[216:219]
    v_mfma_f32_16x16x32_bf16 v[216:219], v[52:55], a[52:55], v[216:219]
    v_mfma_f32_16x16x32_bf16 v[220:223], v[48:51], a[56:59], v[220:223]
    s_xor_b32 s82, s84, 3670784
    ds_read_b64_tr_b16 v[48:49], v15 offset:0
    s_waitcnt lgkmcnt(1)
    ds_read_b64_tr_b16 v[50:51], v15 offset:1024
    v_mfma_f32_16x16x32_bf16 v[220:223], v[52:55], a[60:63], v[220:223]
    ds_read_b64_tr_b16 v[52:53], v15 offset:8192
    ds_read_b64_tr_b16 v[54:55], v15 offset:9216
    v_mfma_f32_16x16x32_bf16 v[224:227], v[56:59], a[0:3], v[224:227]
    v_mfma_f32_16x16x32_bf16 v[224:227], v[60:63], a[4:7], v[224:227]
    s_xor_b32 s62, s62, 128
    v_mfma_f32_16x16x32_bf16 v[228:231], v[56:59], a[8:11], v[228:231]
    buffer_load_dword v127, v120, s[40:43], s82 offen nt
    v_mfma_f32_16x16x32_bf16 v[228:231], v[60:63], a[12:15], v[228:231]
    buffer_load_dword v108, v103, s[24:27], s77 offen
    v_mfma_f32_16x16x32_bf16 v[232:235], v[56:59], a[16:19], v[232:235]
    s_add_u32 s77, s77, 4608
    v_mfma_f32_16x16x32_bf16 v[232:235], v[60:63], a[20:23], v[232:235]
    s_add_u32 m0, s69, 98304
    v_mfma_f32_16x16x32_bf16 v[236:239], v[56:59], a[24:27], v[236:239]
    buffer_load_dwordx4 v2, s[12:15], s60 offen nt lds
    v_mfma_f32_16x16x32_bf16 v[236:239], v[60:63], a[28:31], v[236:239]
    v_mfma_f32_16x16x32_bf16 v[240:243], v[56:59], a[32:35], v[240:243]
    v_mfma_f32_16x16x32_bf16 v[240:243], v[60:63], a[36:39], v[240:243]
    v_mfma_f32_16x16x32_bf16 v[244:247], v[56:59], a[40:43], v[244:247]
    v_mfma_f32_16x16x32_bf16 v[244:247], v[60:63], a[44:47], v[244:247]
    v_mfma_f32_16x16x32_bf16 v[248:251], v[56:59], a[48:51], v[248:251]
    v_mfma_f32_16x16x32_bf16 v[248:251], v[60:63], a[52:55], v[248:251]
    buffer_load_dwordx4 v3, s[12:15], s60 offen offset:1024 nt lds
    v_mfma_f32_16x16x32_bf16 v[252:255], v[56:59], a[56:59], v[252:255]
    ds_read_b64_tr_b16 v[56:57], v16 offset:0
    ds_read_b64_tr_b16 v[58:59], v16 offset:1024
    v_mfma_f32_16x16x32_bf16 v[252:255], v[60:63], a[60:63], v[252:255]
    ds_read_b64_tr_b16 v[60:61], v16 offset:8192
    ds_read_b64_tr_b16 v[62:63], v16 offset:9216
    v_mfma_f32_16x16x32_bf16 a[128:131], a[0:3], v[40:43], a[128:131]
    v_mfma_f32_16x16x32_bf16 a[128:131], a[4:7], v[44:47], a[128:131]
    v_add_u32 v22, 0xfffe0000, v22
    v_mfma_f32_16x16x32_bf16 a[132:135], a[8:11], v[40:43], a[132:135]
    ds_read_b128 a[96:99], v22 offset:16384
    v_mfma_f32_16x16x32_bf16 a[132:135], a[12:15], v[44:47], a[132:135]
    v_mfma_f32_16x16x32_bf16 a[136:139], a[16:19], v[40:43], a[136:139]
    v_mfma_f32_16x16x32_bf16 a[136:139], a[20:23], v[44:47], a[136:139]
    buffer_load_dwordx4 v4, s[12:15], s60 offen offset:2048 nt lds
    v_mfma_f32_16x16x32_bf16 a[140:143], a[24:27], v[40:43], a[140:143]
    v_add_u32 v23, 0xfffe0000, v23
    v_mfma_f32_16x16x32_bf16 a[140:143], a[28:31], v[44:47], a[140:143]
    ds_read_b128 a[100:103], v23 offset:16384
    v_mfma_f32_16x16x32_bf16 a[144:147], a[32:35], v[40:43], a[144:147]
    v_mfma_f32_16x16x32_bf16 a[144:147], a[36:39], v[44:47], a[144:147]
    v_mfma_f32_16x16x32_bf16 a[148:151], a[40:43], v[40:43], a[148:151]
    v_mfma_f32_16x16x32_bf16 a[148:151], a[44:47], v[44:47], a[148:151]
    v_mfma_f32_16x16x32_bf16 a[152:155], a[48:51], v[40:43], a[152:155]
    buffer_load_dwordx4 v5, s[12:15], s60 offen offset:3072 nt lds
    v_mfma_f32_16x16x32_bf16 a[152:155], a[52:55], v[44:47], a[152:155]
    ds_read_b128 a[104:107], v22 offset:18432
    v_mfma_f32_16x16x32_bf16 a[156:159], a[56:59], v[40:43], a[156:159]
    ds_read_b64_tr_b16 v[40:41], v17 offset:0
    ds_read_b64_tr_b16 v[42:43], v17 offset:1024
    v_mfma_f32_16x16x32_bf16 a[156:159], a[60:63], v[44:47], a[156:159]
    s_waitcnt lgkmcnt(3)
    ds_read_b64_tr_b16 v[44:45], v17 offset:8192
    ds_read_b64_tr_b16 v[46:47], v17 offset:9216
    v_mfma_f32_16x16x32_bf16 a[160:163], a[0:3], v[48:51], a[160:163]
    v_mfma_f32_16x16x32_bf16 a[160:163], a[4:7], v[52:55], a[160:163]
    v_mfma_f32_16x16x32_bf16 a[164:167], a[8:11], v[48:51], a[164:167]
    ds_read_b128 a[108:111], v23 offset:18432
    v_mfma_f32_16x16x32_bf16 a[164:167], a[12:15], v[52:55], a[164:167]
    s_add_u32 m0, s69, 114688
    v_mfma_f32_16x16x32_bf16 a[168:171], a[16:19], v[48:51], a[168:171]
    buffer_load_dwordx4 v6, s[8:11], s61 offen lds
    v_mfma_f32_16x16x32_bf16 a[168:171], a[20:23], v[52:55], a[168:171]
    v_mfma_f32_16x16x32_bf16 a[172:175], a[24:27], v[48:51], a[172:175]
    v_mfma_f32_16x16x32_bf16 a[172:175], a[28:31], v[52:55], a[172:175]
    v_mfma_f32_16x16x32_bf16 a[176:179], a[32:35], v[48:51], a[176:179]
    ds_read_b128 a[112:115], v22 offset:20480
    v_mfma_f32_16x16x32_bf16 a[176:179], a[36:39], v[52:55], a[176:179]
    v_mfma_f32_16x16x32_bf16 a[180:183], a[40:43], v[48:51], a[180:183]
    v_mfma_f32_16x16x32_bf16 a[180:183], a[44:47], v[52:55], a[180:183]
    buffer_load_dwordx4 v7, s[8:11], s61 offen offset:1024 lds
    v_mfma_f32_16x16x32_bf16 a[184:187], a[48:51], v[48:51], a[184:187]
    v_mfma_f32_16x16x32_bf16 a[184:187], a[52:55], v[52:55], a[184:187]
    ds_read_b128 a[116:119], v23 offset:20480
    v_mfma_f32_16x16x32_bf16 a[188:191], a[56:59], v[48:51], a[188:191]
    v_mfma_f32_16x16x32_bf16 a[188:191], a[60:63], v[52:55], a[188:191]
    v_mfma_f32_16x16x32_bf16 a[192:195], a[0:3], v[56:59], a[192:195]
    v_mfma_f32_16x16x32_bf16 a[192:195], a[4:7], v[60:63], a[192:195]
    v_mfma_f32_16x16x32_bf16 a[196:199], a[8:11], v[56:59], a[196:199]
    v_mfma_f32_16x16x32_bf16 a[196:199], a[12:15], v[60:63], a[196:199]
    buffer_load_dwordx4 v8, s[8:11], s61 offen offset:2048 lds
    v_mfma_f32_16x16x32_bf16 a[200:203], a[16:19], v[56:59], a[200:203]
    ds_read_b128 a[120:123], v22 offset:22528
    v_mfma_f32_16x16x32_bf16 a[200:203], a[20:23], v[60:63], a[200:203]
    v_mfma_f32_16x16x32_bf16 a[204:207], a[24:27], v[56:59], a[204:207]
    v_mfma_f32_16x16x32_bf16 a[204:207], a[28:31], v[60:63], a[204:207]
    v_mfma_f32_16x16x32_bf16 a[208:211], a[32:35], v[56:59], a[208:211]
    ds_read_b128 a[124:127], v23 offset:22528
    v_mfma_f32_16x16x32_bf16 a[208:211], a[36:39], v[60:63], a[208:211]
    v_mfma_f32_16x16x32_bf16 a[212:215], a[40:43], v[56:59], a[212:215]
    buffer_load_dwordx4 v9, s[8:11], s61 offen offset:3072 lds
    v_mfma_f32_16x16x32_bf16 a[212:215], a[44:47], v[60:63], a[212:215]
    v_mfma_f32_16x16x32_bf16 a[216:219], a[48:51], v[56:59], a[216:219]
    v_mfma_f32_16x16x32_bf16 a[216:219], a[52:55], v[60:63], a[216:219]
    v_mfma_f32_16x16x32_bf16 a[220:223], a[56:59], v[56:59], a[220:223]
    v_mfma_f32_16x16x32_bf16 a[220:223], a[60:63], v[60:63], a[220:223]
    s_waitcnt lgkmcnt(0)
    v_mfma_f32_16x16x32_bf16 a[224:227], a[0:3], v[40:43], a[224:227]
    v_mfma_f32_16x16x32_bf16 a[224:227], a[4:7], v[44:47], a[224:227]
    s_xor_b32 s61, s61, 1920
    v_mfma_f32_16x16x32_bf16 a[228:231], a[8:11], v[40:43], a[228:231]
    s_andn2_b32 s61, s61, 896
    v_mfma_f32_16x16x32_bf16 a[228:231], a[12:15], v[44:47], a[228:231]
    s_lshl_b32 s61, s5, 7
    v_mfma_f32_16x16x32_bf16 a[232:235], a[16:19], v[40:43], a[232:235]
    v_mfma_f32_16x16x32_bf16 a[232:235], a[20:23], v[44:47], a[232:235]
    s_waitcnt vmcnt(10) lgkmcnt(0)
    s_barrier
    ds_read_b64_tr_b16 v[48:49], v14 offset:32768
    v_mfma_f32_16x16x32_bf16 a[236:239], a[24:27], v[40:43], a[236:239]
    s_add_u32 m0, s69, 131072
    ds_read_b64_tr_b16 v[50:51], v14 offset:33792
    ds_read_b64_tr_b16 v[52:53], v14 offset:40960
    v_mfma_f32_16x16x32_bf16 a[236:239], a[28:31], v[44:47], a[236:239]
    buffer_load_dwordx4 v2, s[16:19], s60 offen nt lds
    v_mfma_f32_16x16x32_bf16 a[240:243], a[32:35], v[40:43], a[240:243]
    ds_read_b64_tr_b16 v[54:55], v14 offset:41984
    ds_read_b64_tr_b16 v[56:57], v15 offset:32768
    v_mfma_f32_16x16x32_bf16 a[240:243], a[36:39], v[44:47], a[240:243]
    ds_read_b64_tr_b16 v[58:59], v15 offset:33792
    ds_read_b64_tr_b16 v[60:61], v15 offset:40960
    v_mfma_f32_16x16x32_bf16 a[244:247], a[40:43], v[40:43], a[244:247]
    ds_read_b64_tr_b16 v[62:63], v15 offset:41984
    v_add_u32 v14, 0x10000, v14
    v_mfma_f32_16x16x32_bf16 a[244:247], a[44:47], v[44:47], a[244:247]
    v_add_u32 v15, 0x10000, v15
    v_mfma_f32_16x16x32_bf16 a[248:251], a[48:51], v[40:43], a[248:251]
    v_mfma_f32_16x16x32_bf16 a[248:251], a[52:55], v[44:47], a[248:251]
    buffer_load_dwordx4 v3, s[16:19], s60 offen offset:1024 nt lds
    v_mfma_f32_16x16x32_bf16 a[252:255], a[56:59], v[40:43], a[252:255]
    ds_read_b64_tr_b16 v[40:41], v16 offset:32768
    ds_read_b64_tr_b16 v[42:43], v16 offset:33792
    v_mfma_f32_16x16x32_bf16 a[252:255], a[60:63], v[44:47], a[252:255]
    s_waitcnt lgkmcnt(2)
    ds_read_b64_tr_b16 v[44:45], v16 offset:40960
    ds_read_b64_tr_b16 v[46:47], v16 offset:41984
    v_mfma_f32_16x16x32_bf16 v[128:131], v[48:51], a[64:67], v[128:131]
    v_add_u32 v16, 0x10000, v16
    v_mfma_f32_16x16x32_bf16 v[128:131], v[52:55], a[68:71], v[128:131]
    v_mfma_f32_16x16x32_bf16 v[132:135], v[48:51], a[72:75], v[132:135]
    ds_read_b128 a[0:3], v22 offset:49152
    v_mfma_f32_16x16x32_bf16 v[132:135], v[52:55], a[76:79], v[132:135]
    v_mfma_f32_16x16x32_bf16 v[136:139], v[48:51], a[80:83], v[136:139]
    v_mfma_f32_16x16x32_bf16 v[136:139], v[52:55], a[84:87], v[136:139]
    buffer_load_dwordx4 v4, s[16:19], s60 offen offset:2048 nt lds
    v_mfma_f32_16x16x32_bf16 v[140:143], v[48:51], a[88:91], v[140:143]
    v_mfma_f32_16x16x32_bf16 v[140:143], v[52:55], a[92:95], v[140:143]
    ds_read_b128 a[4:7], v23 offset:49152
    v_mfma_f32_16x16x32_bf16 v[144:147], v[48:51], a[96:99], v[144:147]
    v_mfma_f32_16x16x32_bf16 v[144:147], v[52:55], a[100:103], v[144:147]
    v_mfma_f32_16x16x32_bf16 v[148:151], v[48:51], a[104:107], v[148:151]
    v_mfma_f32_16x16x32_bf16 v[148:151], v[52:55], a[108:111], v[148:151]
    v_mfma_f32_16x16x32_bf16 v[152:155], v[48:51], a[112:115], v[152:155]
    buffer_load_dwordx4 v5, s[16:19], s60 offen offset:3072 nt lds
    v_mfma_f32_16x16x32_bf16 v[152:155], v[52:55], a[116:119], v[152:155]
    ds_read_b128 a[8:11], v22 offset:51200
    v_mfma_f32_16x16x32_bf16 v[156:159], v[48:51], a[120:123], v[156:159]
    ds_read_b64_tr_b16 v[48:49], v17 offset:32768
    ds_read_b64_tr_b16 v[50:51], v17 offset:33792
    v_mfma_f32_16x16x32_bf16 v[156:159], v[52:55], a[124:127], v[156:159]
    ds_read_b64_tr_b16 v[52:53], v17 offset:40960
    ds_read_b64_tr_b16 v[54:55], v17 offset:41984
    v_mfma_f32_16x16x32_bf16 v[160:163], v[56:59], a[64:67], v[160:163]
    v_add_u32 v17, 0x10000, v17
    v_mfma_f32_16x16x32_bf16 v[160:163], v[60:63], a[68:71], v[160:163]
    v_mfma_f32_16x16x32_bf16 v[164:167], v[56:59], a[72:75], v[164:167]
    ds_read_b128 a[12:15], v23 offset:51200
    v_mfma_f32_16x16x32_bf16 v[164:167], v[60:63], a[76:79], v[164:167]
    s_add_u32 m0, s69, 147456
    v_mfma_f32_16x16x32_bf16 v[168:171], v[56:59], a[80:83], v[168:171]
    s_xor_b32 s60, s60, 524288
    buffer_load_dwordx4 v6, s[8:11], s62 offen lds
    v_mfma_f32_16x16x32_bf16 v[168:171], v[60:63], a[84:87], v[168:171]
    v_mov_b32 v6, v96
    v_mfma_f32_16x16x32_bf16 v[172:175], v[56:59], a[88:91], v[172:175]
    v_mfma_f32_16x16x32_bf16 v[172:175], v[60:63], a[92:95], v[172:175]
    v_mfma_f32_16x16x32_bf16 v[176:179], v[56:59], a[96:99], v[176:179]
    ds_read_b128 a[16:19], v22 offset:53248
    v_mfma_f32_16x16x32_bf16 v[176:179], v[60:63], a[100:103], v[176:179]
    v_mfma_f32_16x16x32_bf16 v[180:183], v[56:59], a[104:107], v[180:183]
    v_mfma_f32_16x16x32_bf16 v[180:183], v[60:63], a[108:111], v[180:183]
    buffer_load_dwordx4 v7, s[8:11], s62 offen offset:1024 lds
    v_mfma_f32_16x16x32_bf16 v[184:187], v[56:59], a[112:115], v[184:187]
    v_mfma_f32_16x16x32_bf16 v[184:187], v[60:63], a[116:119], v[184:187]
    ds_read_b128 a[20:23], v23 offset:53248
    v_mfma_f32_16x16x32_bf16 v[188:191], v[56:59], a[120:123], v[188:191]
    s_waitcnt lgkmcnt(1)
    ds_read_b64_tr_b16 v[56:57], v14 offset:0
    ds_read_b64_tr_b16 v[58:59], v14 offset:1024
    v_mfma_f32_16x16x32_bf16 v[188:191], v[60:63], a[124:127], v[188:191]
    ds_read_b64_tr_b16 v[60:61], v14 offset:8192
    ds_read_b64_tr_b16 v[62:63], v14 offset:9216
    v_mfma_f32_16x16x32_bf16 v[192:195], v[40:43], a[64:67], v[192:195]
    v_mfma_f32_16x16x32_bf16 v[192:195], v[44:47], a[68:71], v[192:195]
    v_mfma_f32_16x16x32_bf16 v[196:199], v[40:43], a[72:75], v[196:199]
    v_mfma_f32_16x16x32_bf16 v[196:199], v[44:47], a[76:79], v[196:199]
    buffer_load_dwordx4 v8, s[8:11], s62 offen offset:2048 lds
    v_mfma_f32_16x16x32_bf16 v[200:203], v[40:43], a[80:83], v[200:203]
    ds_read_b128 a[24:27], v22 offset:55296
    v_bfe_u32 v8, v1, 4, 3
    v_mfma_f32_16x16x32_bf16 v[200:203], v[44:47], a[84:87], v[200:203]
    v_lshlrev_b32 v8, 12, v8
    v_mfma_f32_16x16x32_bf16 v[204:207], v[40:43], a[88:91], v[204:207]
    v_mfma_f32_16x16x32_bf16 v[204:207], v[44:47], a[92:95], v[204:207]
    v_mfma_f32_16x16x32_bf16 v[208:211], v[40:43], a[96:99], v[208:211]
    ds_read_b128 a[28:31], v23 offset:55296
    v_mfma_f32_16x16x32_bf16 v[208:211], v[44:47], a[100:103], v[208:211]
    v_mfma_f32_16x16x32_bf16 v[212:215], v[40:43], a[104:107], v[212:215]
    buffer_load_dwordx4 v9, s[8:11], s62 offen offset:3072 lds
    v_mfma_f32_16x16x32_bf16 v[212:215], v[44:47], a[108:111], v[212:215]
    s_and_b32 s8, s5, 7
    v_lshrrev_b32 v9, 2, v1
    v_mfma_f32_16x16x32_bf16 v[216:219], v[40:43], a[112:115], v[216:219]
    s_lshl3_add_u32 s8, s6, s8
    v_mfma_f32_16x16x32_bf16 v[216:219], v[44:47], a[116:119], v[216:219]
    s_mul_hi_u32 s98, s8, 715827883
    v_mfma_f32_16x16x32_bf16 v[220:223], v[40:43], a[120:123], v[220:223]
    ds_read_b64_tr_b16 v[40:41], v15 offset:0
    ds_read_b64_tr_b16 v[42:43], v15 offset:1024
    v_mfma_f32_16x16x32_bf16 v[220:223], v[44:47], a[124:127], v[220:223]
    ds_read_b64_tr_b16 v[44:45], v15 offset:8192
    ds_read_b64_tr_b16 v[46:47], v15 offset:9216
    v_mfma_f32_16x16x32_bf16 v[224:227], v[48:51], a[64:67], v[224:227]
    v_mfma_f32_16x16x32_bf16 v[224:227], v[52:55], a[68:71], v[224:227]
    s_xor_b32 s62, s62, 1920
    v_mfma_f32_16x16x32_bf16 v[228:231], v[48:51], a[72:75], v[228:231]
    s_andn2_b32 s62, s62, 896
    buffer_load_dword v109, v103, s[24:27], s77 offen
    v_mfma_f32_16x16x32_bf16 v[228:231], v[52:55], a[76:79], v[228:231]
    v_mfma_f32_16x16x32_bf16 v[232:235], v[48:51], a[80:83], v[232:235]
    v_mfma_f32_16x16x32_bf16 v[232:235], v[52:55], a[84:87], v[232:235]
    s_add_u32 m0, s69, 0
    v_mfma_f32_16x16x32_bf16 v[236:239], v[48:51], a[88:91], v[236:239]
    buffer_load_dwordx4 v2, s[12:15], s60 offen nt lds
    v_mfma_f32_16x16x32_bf16 v[236:239], v[52:55], a[92:95], v[236:239]
    v_mfma_f32_16x16x32_bf16 v[240:243], v[48:51], a[96:99], v[240:243]
    v_mfma_f32_16x16x32_bf16 v[240:243], v[52:55], a[100:103], v[240:243]
    v_mfma_f32_16x16x32_bf16 v[244:247], v[48:51], a[104:107], v[244:247]
    v_mfma_f32_16x16x32_bf16 v[244:247], v[52:55], a[108:111], v[244:247]
    v_mfma_f32_16x16x32_bf16 v[248:251], v[48:51], a[112:115], v[248:251]
    v_mfma_f32_16x16x32_bf16 v[248:251], v[52:55], a[116:119], v[248:251]
    buffer_load_dwordx4 v3, s[12:15], s60 offen offset:1024 nt lds
    v_mfma_f32_16x16x32_bf16 v[252:255], v[48:51], a[120:123], v[252:255]
    ds_read_b64_tr_b16 v[48:49], v16 offset:0
    ds_read_b64_tr_b16 v[50:51], v16 offset:1024
    v_mfma_f32_16x16x32_bf16 v[252:255], v[52:55], a[124:127], v[252:255]
    s_waitcnt lgkmcnt(2)
    ds_read_b64_tr_b16 v[52:53], v16 offset:8192
    ds_read_b64_tr_b16 v[54:55], v16 offset:9216
    v_mfma_f32_16x16x32_bf16 a[128:131], a[64:67], v[56:59], a[128:131]
    v_mfma_f32_16x16x32_bf16 a[128:131], a[68:71], v[60:63], a[128:131]
    v_add_u32 v22, 0x10000, v22
    v_mfma_f32_16x16x32_bf16 a[132:135], a[72:75], v[56:59], a[132:135]
    ds_read_b128 a[32:35], v22 offset:16384
    v_mfma_f32_16x16x32_bf16 a[132:135], a[76:79], v[60:63], a[132:135]
    v_mfma_f32_16x16x32_bf16 a[136:139], a[80:83], v[56:59], a[136:139]
    v_mfma_f32_16x16x32_bf16 a[136:139], a[84:87], v[60:63], a[136:139]
    buffer_load_dwordx4 v4, s[12:15], s60 offen offset:2048 nt lds
    v_mfma_f32_16x16x32_bf16 a[140:143], a[88:91], v[56:59], a[140:143]
    v_add_u32 v23, 0x10000, v23
    v_mfma_f32_16x16x32_bf16 a[140:143], a[92:95], v[60:63], a[140:143]
    ds_read_b128 a[36:39], v23 offset:16384
    v_mfma_f32_16x16x32_bf16 a[144:147], a[96:99], v[56:59], a[144:147]
    v_mfma_f32_16x16x32_bf16 a[144:147], a[100:103], v[60:63], a[144:147]
    v_mfma_f32_16x16x32_bf16 a[148:151], a[104:107], v[56:59], a[148:151]
    v_mfma_f32_16x16x32_bf16 a[148:151], a[108:111], v[60:63], a[148:151]
    v_mfma_f32_16x16x32_bf16 a[152:155], a[112:115], v[56:59], a[152:155]
    buffer_load_dwordx4 v5, s[12:15], s60 offen offset:3072 nt lds
    v_mfma_f32_16x16x32_bf16 a[152:155], a[116:119], v[60:63], a[152:155]
    ds_read_b128 a[40:43], v22 offset:18432
    v_mfma_f32_16x16x32_bf16 a[156:159], a[120:123], v[56:59], a[156:159]
    ds_read_b64_tr_b16 v[56:57], v17 offset:0
    ds_read_b64_tr_b16 v[58:59], v17 offset:1024
    v_mfma_f32_16x16x32_bf16 a[156:159], a[124:127], v[60:63], a[156:159]
    ds_read_b64_tr_b16 v[60:61], v17 offset:8192
    ds_read_b64_tr_b16 v[62:63], v17 offset:9216
    v_mfma_f32_16x16x32_bf16 a[160:163], a[64:67], v[40:43], a[160:163]
    v_mfma_f32_16x16x32_bf16 a[160:163], a[68:71], v[44:47], a[160:163]
    v_mfma_f32_16x16x32_bf16 a[164:167], a[72:75], v[40:43], a[164:167]
    ds_read_b128 a[44:47], v23 offset:18432
    v_mfma_f32_16x16x32_bf16 a[164:167], a[76:79], v[44:47], a[164:167]
    s_add_u32 m0, s69, 16384
    v_mfma_f32_16x16x32_bf16 a[168:171], a[80:83], v[40:43], a[168:171]
    buffer_load_dwordx4 v10, s[20:23], s63 offen lds
    v_mfma_f32_16x16x32_bf16 a[168:171], a[84:87], v[44:47], a[168:171]
    v_mfma_f32_16x16x32_bf16 a[172:175], a[88:91], v[40:43], a[172:175]
    v_mfma_f32_16x16x32_bf16 a[172:175], a[92:95], v[44:47], a[172:175]
    v_mfma_f32_16x16x32_bf16 a[176:179], a[96:99], v[40:43], a[176:179]
    ds_read_b128 a[48:51], v22 offset:20480
    v_mfma_f32_16x16x32_bf16 a[176:179], a[100:103], v[44:47], a[176:179]
    v_mfma_f32_16x16x32_bf16 a[180:183], a[104:107], v[40:43], a[180:183]
    v_mfma_f32_16x16x32_bf16 a[180:183], a[108:111], v[44:47], a[180:183]
    buffer_load_dwordx4 v11, s[20:23], s63 offen offset:1024 lds
    v_mfma_f32_16x16x32_bf16 a[184:187], a[112:115], v[40:43], a[184:187]
    v_mfma_f32_16x16x32_bf16 a[184:187], a[116:119], v[44:47], a[184:187]
    ds_read_b128 a[52:55], v23 offset:20480
    v_mfma_f32_16x16x32_bf16 a[188:191], a[120:123], v[40:43], a[188:191]
    v_mfma_f32_16x16x32_bf16 a[188:191], a[124:127], v[44:47], a[188:191]
    s_waitcnt lgkmcnt(1)
    v_mfma_f32_16x16x32_bf16 a[192:195], a[64:67], v[48:51], a[192:195]
    v_mfma_f32_16x16x32_bf16 a[192:195], a[68:71], v[52:55], a[192:195]
    v_mfma_f32_16x16x32_bf16 a[196:199], a[72:75], v[48:51], a[196:199]
    v_mfma_f32_16x16x32_bf16 a[196:199], a[76:79], v[52:55], a[196:199]
    buffer_load_dwordx4 v12, s[20:23], s63 offen offset:2048 lds
    v_mfma_f32_16x16x32_bf16 a[200:203], a[80:83], v[48:51], a[200:203]
    ds_read_b128 a[56:59], v22 offset:22528
    v_mfma_f32_16x16x32_bf16 a[200:203], a[84:87], v[52:55], a[200:203]
    v_mfma_f32_16x16x32_bf16 a[204:207], a[88:91], v[48:51], a[204:207]
    v_mfma_f32_16x16x32_bf16 a[204:207], a[92:95], v[52:55], a[204:207]
    v_mfma_f32_16x16x32_bf16 a[208:211], a[96:99], v[48:51], a[208:211]
    ds_read_b128 a[60:63], v23 offset:22528
    v_mfma_f32_16x16x32_bf16 a[208:211], a[100:103], v[52:55], a[208:211]
    v_mfma_f32_16x16x32_bf16 a[212:215], a[104:107], v[48:51], a[212:215]
    buffer_load_dwordx4 v13, s[20:23], s63 offen offset:3072 lds
    v_mfma_f32_16x16x32_bf16 a[212:215], a[108:111], v[52:55], a[212:215]
    v_mfma_f32_16x16x32_bf16 a[216:219], a[112:115], v[48:51], a[216:219]
    v_mfma_f32_16x16x32_bf16 a[216:219], a[116:119], v[52:55], a[216:219]
    v_mfma_f32_16x16x32_bf16 a[220:223], a[120:123], v[48:51], a[220:223]
    v_mfma_f32_16x16x32_bf16 a[220:223], a[124:127], v[52:55], a[220:223]
    v_mfma_f32_16x16x32_bf16 a[224:227], a[64:67], v[56:59], a[224:227]
    v_mfma_f32_16x16x32_bf16 a[224:227], a[68:71], v[60:63], a[224:227]
    s_xor_b32 s63, s63, 128
    v_mfma_f32_16x16x32_bf16 a[228:231], a[72:75], v[56:59], a[228:231]
    v_mfma_f32_16x16x32_bf16 a[228:231], a[76:79], v[60:63], a[228:231]
    v_mfma_f32_16x16x32_bf16 a[232:235], a[80:83], v[56:59], a[232:235]
    v_mfma_f32_16x16x32_bf16 a[232:235], a[84:87], v[60:63], a[232:235]
    s_waitcnt vmcnt(9) lgkmcnt(0)
    s_barrier
    ds_read_b64_tr_b16 v[40:41], v14 offset:32768
    v_mfma_f32_16x16x32_bf16 a[236:239], a[88:91], v[56:59], a[236:239]
    s_add_u32 m0, s69, 32768
    ds_read_b64_tr_b16 v[42:43], v14 offset:33792
    ds_read_b64_tr_b16 v[44:45], v14 offset:40960
    v_mfma_f32_16x16x32_bf16 a[236:239], a[92:95], v[60:63], a[236:239]
    buffer_load_dwordx4 v2, s[16:19], s60 offen nt lds
    v_mfma_f32_16x16x32_bf16 a[240:243], a[96:99], v[56:59], a[240:243]
    ds_read_b64_tr_b16 v[46:47], v14 offset:41984
    ds_read_b64_tr_b16 v[48:49], v15 offset:32768
    v_mfma_f32_16x16x32_bf16 a[240:243], a[100:103], v[60:63], a[240:243]
    ds_read_b64_tr_b16 v[50:51], v15 offset:33792
    ds_read_b64_tr_b16 v[52:53], v15 offset:40960
    v_mfma_f32_16x16x32_bf16 a[244:247], a[104:107], v[56:59], a[244:247]
    ds_read_b64_tr_b16 v[54:55], v15 offset:41984
    v_add_u32 v14, 0x10000, v14
    v_mfma_f32_16x16x32_bf16 a[244:247], a[108:111], v[60:63], a[244:247]
    v_add_u32 v15, 0x10000, v15
    v_mfma_f32_16x16x32_bf16 a[248:251], a[112:115], v[56:59], a[248:251]
    v_mfma_f32_16x16x32_bf16 a[248:251], a[116:119], v[60:63], a[248:251]
    buffer_load_dwordx4 v3, s[16:19], s60 offen offset:1024 nt lds
    v_mfma_f32_16x16x32_bf16 a[252:255], a[120:123], v[56:59], a[252:255]
    ds_read_b64_tr_b16 v[56:57], v16 offset:32768
    ds_read_b64_tr_b16 v[58:59], v16 offset:33792
    v_mfma_f32_16x16x32_bf16 a[252:255], a[124:127], v[60:63], a[252:255]
    s_waitcnt lgkmcnt(2)
    ds_read_b64_tr_b16 v[60:61], v16 offset:40960
    ds_read_b64_tr_b16 v[62:63], v16 offset:41984
    v_mfma_f32_16x16x32_bf16 v[128:131], v[40:43], a[0:3], v[128:131]
    v_add_u32 v16, 0x10000, v16
    v_mfma_f32_16x16x32_bf16 v[128:131], v[44:47], a[4:7], v[128:131]
    v_mfma_f32_16x16x32_bf16 v[132:135], v[40:43], a[8:11], v[132:135]
    ds_read_b128 a[64:67], v22 offset:49152
    v_mfma_f32_16x16x32_bf16 v[132:135], v[44:47], a[12:15], v[132:135]
    v_mfma_f32_16x16x32_bf16 v[136:139], v[40:43], a[16:19], v[136:139]
    v_mfma_f32_16x16x32_bf16 v[136:139], v[44:47], a[20:23], v[136:139]
    buffer_load_dwordx4 v4, s[16:19], s60 offen offset:2048 nt lds
    v_mfma_f32_16x16x32_bf16 v[140:143], v[40:43], a[24:27], v[140:143]
    v_mfma_f32_16x16x32_bf16 v[140:143], v[44:47], a[28:31], v[140:143]
    ds_read_b128 a[68:71], v23 offset:49152
    v_mfma_f32_16x16x32_bf16 v[144:147], v[40:43], a[32:35], v[144:147]
    v_mfma_f32_16x16x32_bf16 v[144:147], v[44:47], a[36:39], v[144:147]
    v_mfma_f32_16x16x32_bf16 v[148:151], v[40:43], a[40:43], v[148:151]
    v_mfma_f32_16x16x32_bf16 v[148:151], v[44:47], a[44:47], v[148:151]
    v_mfma_f32_16x16x32_bf16 v[152:155], v[40:43], a[48:51], v[152:155]
    buffer_load_dwordx4 v5, s[16:19], s60 offen offset:3072 nt lds
    v_mfma_f32_16x16x32_bf16 v[152:155], v[44:47], a[52:55], v[152:155]
    ds_read_b128 a[72:75], v22 offset:51200
    v_mfma_f32_16x16x32_bf16 v[156:159], v[40:43], a[56:59], v[156:159]
    ds_read_b64_tr_b16 v[40:41], v17 offset:32768
    ds_read_b64_tr_b16 v[42:43], v17 offset:33792
    v_mfma_f32_16x16x32_bf16 v[156:159], v[44:47], a[60:63], v[156:159]
    ds_read_b64_tr_b16 v[44:45], v17 offset:40960
    ds_read_b64_tr_b16 v[46:47], v17 offset:41984
    v_mfma_f32_16x16x32_bf16 v[160:163], v[48:51], a[0:3], v[160:163]
    v_add_u32 v17, 0x10000, v17
    v_mfma_f32_16x16x32_bf16 v[160:163], v[52:55], a[4:7], v[160:163]
    v_mfma_f32_16x16x32_bf16 v[164:167], v[48:51], a[8:11], v[164:167]
    ds_read_b128 a[76:79], v23 offset:51200
    v_mfma_f32_16x16x32_bf16 v[164:167], v[52:55], a[12:15], v[164:167]
    s_add_u32 m0, s69, 49152
    buffer_load_dword v7, v9, s[44:47], s69 offen sc1
    v_mfma_f32_16x16x32_bf16 v[168:171], v[48:51], a[16:19], v[168:171]
    s_xor_b32 s60, s60, 3670016
    buffer_load_dwordx4 v10, s[20:23], s64 offen lds
    v_mfma_f32_16x16x32_bf16 v[168:171], v[52:55], a[20:23], v[168:171]
    v_mfma_f32_16x16x32_bf16 v[172:175], v[48:51], a[24:27], v[172:175]
    v_mfma_f32_16x16x32_bf16 v[172:175], v[52:55], a[28:31], v[172:175]
    v_mfma_f32_16x16x32_bf16 v[176:179], v[48:51], a[32:35], v[176:179]
    ds_read_b128 a[80:83], v22 offset:53248
    v_mfma_f32_16x16x32_bf16 v[176:179], v[52:55], a[36:39], v[176:179]
    v_mfma_f32_16x16x32_bf16 v[180:183], v[48:51], a[40:43], v[180:183]
    v_mfma_f32_16x16x32_bf16 v[180:183], v[52:55], a[44:47], v[180:183]
    buffer_load_dwordx4 v11, s[20:23], s64 offen offset:1024 lds
    v_mfma_f32_16x16x32_bf16 v[184:187], v[48:51], a[48:51], v[184:187]
    v_mfma_f32_16x16x32_bf16 v[184:187], v[52:55], a[52:55], v[184:187]
    ds_read_b128 a[84:87], v23 offset:53248
    v_mfma_f32_16x16x32_bf16 v[188:191], v[48:51], a[56:59], v[188:191]
    s_waitcnt lgkmcnt(1)
    ds_read_b64_tr_b16 v[48:49], v14 offset:0
    ds_read_b64_tr_b16 v[50:51], v14 offset:1024
    v_mfma_f32_16x16x32_bf16 v[188:191], v[52:55], a[60:63], v[188:191]
    ds_read_b64_tr_b16 v[52:53], v14 offset:8192
    ds_read_b64_tr_b16 v[54:55], v14 offset:9216
    v_mfma_f32_16x16x32_bf16 v[192:195], v[56:59], a[0:3], v[192:195]
    v_add_u32 v14, 0xfffe0000, v14
    v_mfma_f32_16x16x32_bf16 v[192:195], v[60:63], a[4:7], v[192:195]
    v_mfma_f32_16x16x32_bf16 v[196:199], v[56:59], a[8:11], v[196:199]
    v_mfma_f32_16x16x32_bf16 v[196:199], v[60:63], a[12:15], v[196:199]
    buffer_load_dwordx4 v12, s[20:23], s64 offen offset:2048 lds
    v_mfma_f32_16x16x32_bf16 v[200:203], v[56:59], a[16:19], v[200:203]
    ds_read_b128 a[88:91], v22 offset:55296
    v_mfma_f32_16x16x32_bf16 v[200:203], v[60:63], a[20:23], v[200:203]
    v_mfma_f32_16x16x32_bf16 v[204:207], v[56:59], a[24:27], v[204:207]
    v_mfma_f32_16x16x32_bf16 v[204:207], v[60:63], a[28:31], v[204:207]
    v_mfma_f32_16x16x32_bf16 v[208:211], v[56:59], a[32:35], v[208:211]
    ds_read_b128 a[92:95], v23 offset:55296
    v_mfma_f32_16x16x32_bf16 v[208:211], v[60:63], a[36:39], v[208:211]
    v_mfma_f32_16x16x32_bf16 v[212:215], v[56:59], a[40:43], v[212:215]
    buffer_load_dwordx4 v13, s[20:23], s64 offen offset:3072 lds
    v_mfma_f32_16x16x32_bf16 v[212:215], v[60:63], a[44:47], v[212:215]
    v_mfma_f32_16x16x32_bf16 v[216:219], v[56:59], a[48:51], v[216:219]
    v_mfma_f32_16x16x32_bf16 v[216:219], v[60:63], a[52:55], v[216:219]
    v_mfma_f32_16x16x32_bf16 v[220:223], v[56:59], a[56:59], v[220:223]
    ds_read_b64_tr_b16 v[56:57], v15 offset:0
    ds_read_b64_tr_b16 v[58:59], v15 offset:1024
    v_mfma_f32_16x16x32_bf16 v[220:223], v[60:63], a[60:63], v[220:223]
    ds_read_b64_tr_b16 v[60:61], v15 offset:8192
    ds_read_b64_tr_b16 v[62:63], v15 offset:9216
    v_mfma_f32_16x16x32_bf16 v[224:227], v[40:43], a[0:3], v[224:227]
    v_add_u32 v15, 0xfffe0000, v15
    v_mfma_f32_16x16x32_bf16 v[224:227], v[44:47], a[4:7], v[224:227]
    s_xor_b32 s64, s64, 128
    v_mfma_f32_16x16x32_bf16 v[228:231], v[40:43], a[8:11], v[228:231]
    v_mfma_f32_16x16x32_bf16 v[228:231], v[44:47], a[12:15], v[228:231]
    v_mfma_f32_16x16x32_bf16 v[232:235], v[40:43], a[16:19], v[232:235]
    v_mfma_f32_16x16x32_bf16 v[232:235], v[44:47], a[20:23], v[232:235]
    s_add_u32 m0, s69, 65536
    v_mfma_f32_16x16x32_bf16 v[236:239], v[40:43], a[24:27], v[236:239]
    buffer_load_dwordx4 v2, s[24:27], s60 offen lds
    v_mfma_f32_16x16x32_bf16 v[236:239], v[44:47], a[28:31], v[236:239]
    v_mfma_f32_16x16x32_bf16 v[240:243], v[40:43], a[32:35], v[240:243]
    v_mfma_f32_16x16x32_bf16 v[240:243], v[44:47], a[36:39], v[240:243]
    v_mfma_f32_16x16x32_bf16 v[244:247], v[40:43], a[40:43], v[244:247]
    v_mfma_f32_16x16x32_bf16 v[244:247], v[44:47], a[44:47], v[244:247]
    v_mfma_f32_16x16x32_bf16 v[248:251], v[40:43], a[48:51], v[248:251]
    v_mfma_f32_16x16x32_bf16 v[248:251], v[44:47], a[52:55], v[248:251]
    buffer_load_dwordx4 v3, s[24:27], s60 offen offset:1024 lds
    v_mfma_f32_16x16x32_bf16 v[252:255], v[40:43], a[56:59], v[252:255]
    ds_read_b64_tr_b16 v[40:41], v16 offset:0
    ds_read_b64_tr_b16 v[42:43], v16 offset:1024
    v_mfma_f32_16x16x32_bf16 v[252:255], v[44:47], a[60:63], v[252:255]
    s_waitcnt lgkmcnt(2)
    ds_read_b64_tr_b16 v[44:45], v16 offset:8192
    ds_read_b64_tr_b16 v[46:47], v16 offset:9216
    v_mfma_f32_16x16x32_bf16 a[128:131], a[0:3], v[48:51], a[128:131]
    v_add_u32 v16, 0xfffe0000, v16
    v_mfma_f32_16x16x32_bf16 a[128:131], a[4:7], v[52:55], a[128:131]
    v_add_u32 v22, 0x10000, v22
    v_mfma_f32_16x16x32_bf16 a[132:135], a[8:11], v[48:51], a[132:135]
    ds_read_b128 a[96:99], v22 offset:16384
    v_mfma_f32_16x16x32_bf16 a[132:135], a[12:15], v[52:55], a[132:135]
    v_mfma_f32_16x16x32_bf16 a[136:139], a[16:19], v[48:51], a[136:139]
    v_mfma_f32_16x16x32_bf16 a[136:139], a[20:23], v[52:55], a[136:139]
    buffer_load_dwordx4 v4, s[24:27], s60 offen offset:2048 lds
    v_mfma_f32_16x16x32_bf16 a[140:143], a[24:27], v[48:51], a[140:143]
    v_add_u32 v23, 0x10000, v23
    v_mfma_f32_16x16x32_bf16 a[140:143], a[28:31], v[52:55], a[140:143]
    ds_read_b128 a[100:103], v23 offset:16384
    v_mfma_f32_16x16x32_bf16 a[144:147], a[32:35], v[48:51], a[144:147]
    v_mfma_f32_16x16x32_bf16 a[144:147], a[36:39], v[52:55], a[144:147]
    v_mfma_f32_16x16x32_bf16 a[148:151], a[40:43], v[48:51], a[148:151]
    v_mfma_f32_16x16x32_bf16 a[148:151], a[44:47], v[52:55], a[148:151]
    v_mfma_f32_16x16x32_bf16 a[152:155], a[48:51], v[48:51], a[152:155]
    buffer_load_dwordx4 v5, s[24:27], s60 offen offset:3072 lds
    v_mfma_f32_16x16x32_bf16 a[152:155], a[52:55], v[52:55], a[152:155]
    ds_read_b128 a[104:107], v22 offset:18432
    v_mfma_f32_16x16x32_bf16 a[156:159], a[56:59], v[48:51], a[156:159]
    ds_read_b64_tr_b16 v[48:49], v17 offset:0
    ds_read_b64_tr_b16 v[50:51], v17 offset:1024
    v_mfma_f32_16x16x32_bf16 a[156:159], a[60:63], v[52:55], a[156:159]
    ds_read_b64_tr_b16 v[52:53], v17 offset:8192
    ds_read_b64_tr_b16 v[54:55], v17 offset:9216
    v_mfma_f32_16x16x32_bf16 a[160:163], a[0:3], v[56:59], a[160:163]
    v_add_u32 v17, 0xfffe0000, v17
    v_mfma_f32_16x16x32_bf16 a[160:163], a[4:7], v[60:63], a[160:163]
    v_mfma_f32_16x16x32_bf16 a[164:167], a[8:11], v[56:59], a[164:167]
    ds_read_b128 a[108:111], v23 offset:18432
    v_mfma_f32_16x16x32_bf16 a[164:167], a[12:15], v[60:63], a[164:167]
    s_add_u32 m0, s69, 81920
    v_mfma_f32_16x16x32_bf16 a[168:171], a[16:19], v[56:59], a[168:171]
    s_xor_b32 s60, s60, 524288
    buffer_load_dwordx4 v10, s[20:23], s63 offen lds
    v_mfma_f32_16x16x32_bf16 a[168:171], a[20:23], v[60:63], a[168:171]
    v_mfma_f32_16x16x32_bf16 a[172:175], a[24:27], v[56:59], a[172:175]
    v_mfma_f32_16x16x32_bf16 a[172:175], a[28:31], v[60:63], a[172:175]
    v_mfma_f32_16x16x32_bf16 a[176:179], a[32:35], v[56:59], a[176:179]
    ds_read_b128 a[112:115], v22 offset:20480
    v_mfma_f32_16x16x32_bf16 a[176:179], a[36:39], v[60:63], a[176:179]
    v_mfma_f32_16x16x32_bf16 a[180:183], a[40:43], v[56:59], a[180:183]
    v_mfma_f32_16x16x32_bf16 a[180:183], a[44:47], v[60:63], a[180:183]
    buffer_load_dwordx4 v11, s[20:23], s63 offen offset:1024 lds
    v_mfma_f32_16x16x32_bf16 a[184:187], a[48:51], v[56:59], a[184:187]
    v_mfma_f32_16x16x32_bf16 a[184:187], a[52:55], v[60:63], a[184:187]
    ds_read_b128 a[116:119], v23 offset:20480
    v_mfma_f32_16x16x32_bf16 a[188:191], a[56:59], v[56:59], a[188:191]
    v_mfma_f32_16x16x32_bf16 a[188:191], a[60:63], v[60:63], a[188:191]
    s_waitcnt lgkmcnt(1)
    v_mfma_f32_16x16x32_bf16 a[192:195], a[0:3], v[40:43], a[192:195]
    v_mfma_f32_16x16x32_bf16 a[192:195], a[4:7], v[44:47], a[192:195]
    v_mfma_f32_16x16x32_bf16 a[196:199], a[8:11], v[40:43], a[196:199]
    v_mfma_f32_16x16x32_bf16 a[196:199], a[12:15], v[44:47], a[196:199]
    buffer_load_dwordx4 v12, s[20:23], s63 offen offset:2048 lds
    v_mfma_f32_16x16x32_bf16 a[200:203], a[16:19], v[40:43], a[200:203]
    ds_read_b128 a[120:123], v22 offset:22528
    v_mov_b32 v22, v100
    v_mfma_f32_16x16x32_bf16 a[200:203], a[20:23], v[44:47], a[200:203]
    v_add_u32 v22, 0x10000, v22
    v_mfma_f32_16x16x32_bf16 a[204:207], a[24:27], v[40:43], a[204:207]
    v_mfma_f32_16x16x32_bf16 a[204:207], a[28:31], v[44:47], a[204:207]
    v_mfma_f32_16x16x32_bf16 a[208:211], a[32:35], v[40:43], a[208:211]
    ds_read_b128 a[124:127], v23 offset:22528
    v_mov_b32 v23, v101
    v_mfma_f32_16x16x32_bf16 a[208:211], a[36:39], v[44:47], a[208:211]
    v_add_u32 v23, 0x10000, v23
    v_mfma_f32_16x16x32_bf16 a[212:215], a[40:43], v[40:43], a[212:215]
    buffer_load_dwordx4 v13, s[20:23], s63 offen offset:3072 lds
    v_mfma_f32_16x16x32_bf16 a[212:215], a[44:47], v[44:47], a[212:215]
    v_mfma_f32_16x16x32_bf16 a[216:219], a[48:51], v[40:43], a[216:219]
    v_mfma_f32_16x16x32_bf16 a[216:219], a[52:55], v[44:47], a[216:219]
    v_mfma_f32_16x16x32_bf16 a[220:223], a[56:59], v[40:43], a[220:223]
    v_mfma_f32_16x16x32_bf16 a[220:223], a[60:63], v[44:47], a[220:223]
    v_mfma_f32_16x16x32_bf16 a[224:227], a[0:3], v[48:51], a[224:227]
    v_mfma_f32_16x16x32_bf16 a[224:227], a[4:7], v[52:55], a[224:227]
    s_xor_b32 s63, s63, 384
    v_mfma_f32_16x16x32_bf16 a[228:231], a[8:11], v[48:51], a[228:231]
    v_mfma_f32_16x16x32_bf16 a[228:231], a[12:15], v[52:55], a[228:231]
    v_mfma_f32_16x16x32_bf16 a[232:235], a[16:19], v[48:51], a[232:235]
    v_mfma_f32_16x16x32_bf16 a[232:235], a[20:23], v[52:55], a[232:235]
    s_add_u32 m0, s67, 98304
    s_waitcnt vmcnt(8) lgkmcnt(0)
    v_cmp_gt_u32 vcc, 8, v7
    s_nop 1
    s_and_b64 vcc, vcc, s[86:87]
    s_cbranch_scc1 SPIN_WA
BACK_WA:
    s_barrier
    v_mfma_f32_16x16x32_bf16 a[236:239], a[24:27], v[48:51], a[236:239]
    buffer_load_dwordx4 v1, s[28:31], s65 offen sc1 lds
    v_mfma_f32_16x16x32_bf16 a[236:239], a[28:31], v[52:55], a[236:239]
    ds_read_b64_tr_b16 v[56:57], v14 offset:0
    ds_read_b64_tr_b16 v[58:59], v14 offset:1024
    v_mfma_f32_16x16x32_bf16 a[240:243], a[32:35], v[48:51], a[240:243]
    ds_read_b64_tr_b16 v[60:61], v14 offset:8192
    ds_read_b64_tr_b16 v[62:63], v14 offset:9216
    v_mfma_f32_16x16x32_bf16 a[240:243], a[36:39], v[52:55], a[240:243]
    ds_read_b64_tr_b16 v[40:41], v15 offset:0
    ds_read_b64_tr_b16 v[42:43], v15 offset:1024
    v_mfma_f32_16x16x32_bf16 a[244:247], a[40:43], v[48:51], a[244:247]
    ds_read_b64_tr_b16 v[44:45], v15 offset:8192
    ds_read_b64_tr_b16 v[46:47], v15 offset:9216
    v_mfma_f32_16x16x32_bf16 a[244:247], a[44:47], v[52:55], a[244:247]
    v_mfma_f32_16x16x32_bf16 a[248:251], a[48:51], v[48:51], a[248:251]
    v_mfma_f32_16x16x32_bf16 a[248:251], a[52:55], v[52:55], a[248:251]
    v_mfma_f32_16x16x32_bf16 a[252:255], a[56:59], v[48:51], a[252:255]
    s_lshr_b32 s92, s2, 3
    buffer_load_dwordx4 v1, s[28:31], s65 offen offset:1024 sc1 lds
    v_mfma_f32_16x16x32_bf16 a[252:255], a[60:63], v[52:55], a[252:255]
    s_lshl2_add_u32 s92, s92, s4
    v_lshrrev_b32 v9, 4, v1
    v_min_u32 v9, 0, v9
    s_waitcnt lgkmcnt(0)
    v_mfma_f32_16x16x32_bf16 v[128:131], v[56:59], a[64:67], v[128:131]
    s_mul_i32 s92, s92, 1
    ds_read_b64_tr_b16 v[48:49], v16 offset:0
    ds_read_b64_tr_b16 v[50:51], v16 offset:1024
    v_mfma_f32_16x16x32_bf16 v[128:131], v[60:63], a[68:71], v[128:131]
    s_add_u32 s92, s92, 32
    v_add_lshl_u32 v9, v9, s92, 7
    ds_read_b64_tr_b16 v[52:53], v16 offset:8192
    v_mfma_f32_16x16x32_bf16 v[132:135], v[56:59], a[72:75], v[132:135]
    s_getpc_b64 s[92:93]
    global_load_dword v9, v9, s[92:93]
    v_mfma_f32_16x16x32_bf16 v[132:135], v[60:63], a[76:79], v[132:135]
    ds_read_b128 v[64:67], v24 offset:16384
    ds_read_b64_tr_b16 v[54:55], v16 offset:9216
    v_mfma_f32_16x16x32_bf16 v[136:139], v[56:59], a[80:83], v[136:139]
    v_cvt_pk_bf16_f32 v128, v128, v129
    v_cvt_pk_bf16_f32 v130, v130, v131
    v_mfma_f32_16x16x32_bf16 v[136:139], v[60:63], a[84:87], v[136:139]
    v_accvgpr_write_b32 a0, v128
    v_accvgpr_write_b32 a1, v130
    v_mfma_f32_16x16x32_bf16 v[140:143], v[56:59], a[88:91], v[140:143]
    s_add_u32 m0, s68, 106496
    v_cvt_pk_bf16_f32 v132, v132, v133
    v_cvt_pk_bf16_f32 v134, v134, v135
    v_mfma_f32_16x16x32_bf16 v[140:143], v[60:63], a[92:95], v[140:143]
    buffer_load_dwordx4 v6, s[20:23], s66 offen lds
    v_mfma_f32_16x16x32_bf16 v[144:147], v[56:59], a[96:99], v[144:147]
    v_accvgpr_write_b32 a8, v132
    v_accvgpr_write_b32 a9, v134
    v_mfma_f32_16x16x32_bf16 v[144:147], v[60:63], a[100:103], v[144:147]
    v_cvt_pk_bf16_f32 v136, v136, v137
    v_cvt_pk_bf16_f32 v138, v138, v139
    v_mfma_f32_16x16x32_bf16 v[148:151], v[56:59], a[104:107], v[148:151]
    v_accvgpr_write_b32 a16, v136
    v_accvgpr_write_b32 a17, v138
    v_mfma_f32_16x16x32_bf16 v[148:151], v[60:63], a[108:111], v[148:151]
    v_cvt_pk_bf16_f32 v140, v140, v141
    v_cvt_pk_bf16_f32 v142, v142, v143
    v_mfma_f32_16x16x32_bf16 v[152:155], v[56:59], a[112:115], v[152:155]
    v_accvgpr_write_b32 a24, v140
    v_accvgpr_write_b32 a25, v142
    v_mfma_f32_16x16x32_bf16 v[152:155], v[60:63], a[116:119], v[152:155]
    ds_read_b128 v[68:71], v25 offset:16384
    v_cvt_pk_bf16_f32 v144, v144, v145
    v_mfma_f32_16x16x32_bf16 v[156:159], v[56:59], a[120:123], v[156:159]
    s_add_u32 m0, s69, 114688
    ds_read_b64_tr_b16 v[56:57], v17 offset:0
    ds_read_b64_tr_b16 v[58:59], v17 offset:1024
    v_mfma_f32_16x16x32_bf16 v[156:159], v[60:63], a[124:127], v[156:159]
    s_xor_b32 s65, s65, 8192
    buffer_load_dwordx4 v10, s[20:23], s64 offen lds
    v_mfma_f32_16x16x32_bf16 v[160:163], v[40:43], a[64:67], v[160:163]
    s_xor_b32 s66, s66, 128
    ds_read_b64_tr_b16 v[60:61], v17 offset:8192
    ds_read_b64_tr_b16 v[62:63], v17 offset:9216
    v_mfma_f32_16x16x32_bf16 v[160:163], v[44:47], a[68:71], v[160:163]
    v_cvt_pk_bf16_f32 v146, v146, v147
    v_accvgpr_write_b32 a32, v144
    v_mfma_f32_16x16x32_bf16 v[164:167], v[40:43], a[72:75], v[164:167]
    v_accvgpr_write_b32 a33, v146
    v_cvt_pk_bf16_f32 v148, v148, v149
    v_mfma_f32_16x16x32_bf16 v[164:167], v[44:47], a[76:79], v[164:167]
    v_cvt_pk_bf16_f32 v150, v150, v151
    v_accvgpr_write_b32 a40, v148
    v_mfma_f32_16x16x32_bf16 v[168:171], v[40:43], a[80:83], v[168:171]
    v_cvt_pk_bf16_f32 v160, v160, v161
    v_cvt_pk_bf16_f32 v162, v162, v163
    v_mfma_f32_16x16x32_bf16 v[168:171], v[44:47], a[84:87], v[168:171]
    v_accvgpr_write_b32 a2, v160
    v_accvgpr_write_b32 a3, v162
    v_mfma_f32_16x16x32_bf16 v[172:175], v[40:43], a[88:91], v[172:175]
    v_cvt_pk_bf16_f32 v164, v164, v165
    v_cvt_pk_bf16_f32 v166, v166, v167
    v_mfma_f32_16x16x32_bf16 v[172:175], v[44:47], a[92:95], v[172:175]
    v_accvgpr_write_b32 a10, v164
    v_accvgpr_write_b32 a11, v166
    v_mfma_f32_16x16x32_bf16 v[176:179], v[40:43], a[96:99], v[176:179]
    buffer_load_dwordx4 v11, s[20:23], s64 offen offset:1024 lds
    v_mfma_f32_16x16x32_bf16 v[176:179], v[44:47], a[100:103], v[176:179]
    ds_read_b128 v[72:75], v24 offset:24576
    v_accvgpr_write_b32 a41, v150
    v_mfma_f32_16x16x32_bf16 v[180:183], v[40:43], a[104:107], v[180:183]
    v_cvt_pk_bf16_f32 v152, v152, v153
    v_cvt_pk_bf16_f32 v154, v154, v155
    v_mfma_f32_16x16x32_bf16 v[180:183], v[44:47], a[108:111], v[180:183]
    v_accvgpr_write_b32 a48, v152
    v_accvgpr_write_b32 a49, v154
    v_mfma_f32_16x16x32_bf16 v[184:187], v[40:43], a[112:115], v[184:187]
    v_cvt_pk_bf16_f32 v156, v156, v157
    v_cvt_pk_bf16_f32 v158, v158, v159
    v_mfma_f32_16x16x32_bf16 v[184:187], v[44:47], a[116:119], v[184:187]
    v_accvgpr_write_b32 a56, v156
    v_accvgpr_write_b32 a57, v158
    v_mfma_f32_16x16x32_bf16 v[188:191], v[40:43], a[120:123], v[188:191]
    ds_read_b64_tr_b16 v[40:41], v14 offset:32768
    ds_read_b64_tr_b16 v[42:43], v14 offset:33792
    v_mfma_f32_16x16x32_bf16 v[188:191], v[44:47], a[124:127], v[188:191]
    s_waitcnt lgkmcnt(2)
    ds_read_b64_tr_b16 v[44:45], v14 offset:40960
    ds_read_b64_tr_b16 v[46:47], v14 offset:41984
    v_mfma_f32_16x16x32_bf16 v[192:195], v[48:51], a[64:67], v[192:195]
    buffer_load_dwordx4 v12, s[20:23], s64 offen offset:2048 lds
    v_mfma_f32_16x16x32_bf16 v[192:195], v[52:55], a[68:71], v[192:195]
    v_xor_b32 v14, s73, v14
    v_add_u32 v14, 0x10000, v14
    v_mfma_f32_16x16x32_bf16 v[196:199], v[48:51], a[72:75], v[196:199]
    v_cvt_pk_bf16_f32 v168, v168, v169
    v_cvt_pk_bf16_f32 v170, v170, v171
    v_mfma_f32_16x16x32_bf16 v[196:199], v[52:55], a[76:79], v[196:199]
    ds_read_b128 v[76:79], v25 offset:24576
    v_accvgpr_write_b32 a18, v168
    v_mfma_f32_16x16x32_bf16 v[200:203], v[48:51], a[80:83], v[200:203]
    v_accvgpr_write_b32 a19, v170
    v_cvt_pk_bf16_f32 v172, v172, v173
    v_mfma_f32_16x16x32_bf16 v[200:203], v[52:55], a[84:87], v[200:203]
    v_cvt_pk_bf16_f32 v174, v174, v175
    v_accvgpr_write_b32 a26, v172
    v_mfma_f32_16x16x32_bf16 v[204:207], v[48:51], a[88:91], v[204:207]
    v_accvgpr_write_b32 a27, v174
    v_cvt_pk_bf16_f32 v176, v176, v177
    v_mfma_f32_16x16x32_bf16 v[204:207], v[52:55], a[92:95], v[204:207]
    v_cvt_pk_bf16_f32 v178, v178, v179
    v_accvgpr_write_b32 a34, v176
    v_mfma_f32_16x16x32_bf16 v[208:211], v[48:51], a[96:99], v[208:211]
    v_accvgpr_write_b32 a35, v178
    v_cvt_pk_bf16_f32 v180, v180, v181
    v_mfma_f32_16x16x32_bf16 v[208:211], v[52:55], a[100:103], v[208:211]
    buffer_load_dwordx4 v13, s[20:23], s64 offen offset:3072 lds
    v_mfma_f32_16x16x32_bf16 v[212:215], v[48:51], a[104:107], v[212:215]
    v_cvt_pk_bf16_f32 v182, v182, v183
    v_accvgpr_write_b32 a42, v180
    v_mfma_f32_16x16x32_bf16 v[212:215], v[52:55], a[108:111], v[212:215]
    v_accvgpr_write_b32 a43, v182
    v_cvt_pk_bf16_f32 v184, v184, v185
    v_mfma_f32_16x16x32_bf16 v[216:219], v[48:51], a[112:115], v[216:219]
    v_cvt_pk_bf16_f32 v186, v186, v187
    v_accvgpr_write_b32 a50, v184
    v_mfma_f32_16x16x32_bf16 v[216:219], v[52:55], a[116:119], v[216:219]
    v_accvgpr_write_b32 a51, v186
    v_cvt_pk_bf16_f32 v188, v188, v189
    v_mfma_f32_16x16x32_bf16 v[220:223], v[48:51], a[120:123], v[220:223]
    ds_read_b64_tr_b16 v[48:49], v15 offset:32768
    ds_read_b64_tr_b16 v[50:51], v15 offset:33792
    v_mfma_f32_16x16x32_bf16 v[220:223], v[52:55], a[124:127], v[220:223]
    ds_read_b64_tr_b16 v[52:53], v15 offset:40960
    ds_read_b64_tr_b16 v[54:55], v15 offset:41984
    v_mfma_f32_16x16x32_bf16 v[224:227], v[56:59], a[64:67], v[224:227]
    v_xor_b32 v15, s73, v15
    v_add_u32 v15, 0x10000, v15
    v_mfma_f32_16x16x32_bf16 v[224:227], v[60:63], a[68:71], v[224:227]
    s_xor_b32 s64, s64, 384
    v_cvt_pk_bf16_f32 v190, v190, v191
    v_accvgpr_write_b32 a58, v188
    v_mfma_f32_16x16x32_bf16 v[228:231], v[56:59], a[72:75], v[228:231]
    v_accvgpr_write_b32 a59, v190
    v_cvt_pk_bf16_f32 v192, v192, v193
    v_mfma_f32_16x16x32_bf16 v[228:231], v[60:63], a[76:79], v[228:231]
    v_cvt_pk_bf16_f32 v194, v194, v195
    v_accvgpr_write_b32 a4, v192
    v_mfma_f32_16x16x32_bf16 v[232:235], v[56:59], a[80:83], v[232:235]
    v_accvgpr_write_b32 a5, v194
    v_cvt_pk_bf16_f32 v196, v196, v197
    v_mfma_f32_16x16x32_bf16 v[232:235], v[60:63], a[84:87], v[232:235]
    s_add_u32 m0, s69, 131072
    v_cvt_pk_bf16_f32 v198, v198, v199
    v_accvgpr_write_b32 a12, v196
    v_mfma_f32_16x16x32_bf16 v[236:239], v[56:59], a[88:91], v[236:239]
    buffer_load_dwordx4 v2, s[24:27], s60 offen lds
    v_mfma_f32_16x16x32_bf16 v[236:239], v[60:63], a[92:95], v[236:239]
    v_accvgpr_write_b32 a13, v198
    v_cvt_pk_bf16_f32 v200, v200, v201
    v_mfma_f32_16x16x32_bf16 v[240:243], v[56:59], a[96:99], v[240:243]
    v_cvt_pk_bf16_f32 v202, v202, v203
    v_accvgpr_write_b32 a20, v200
    v_mfma_f32_16x16x32_bf16 v[240:243], v[60:63], a[100:103], v[240:243]
    v_accvgpr_write_b32 a21, v202
    v_cvt_pk_bf16_f32 v204, v204, v205
    v_mfma_f32_16x16x32_bf16 v[244:247], v[56:59], a[104:107], v[244:247]
    v_cvt_pk_bf16_f32 v206, v206, v207
    v_accvgpr_write_b32 a28, v204
    v_mfma_f32_16x16x32_bf16 v[244:247], v[60:63], a[108:111], v[244:247]
    v_accvgpr_write_b32 a29, v206
    v_cvt_pk_bf16_f32 v208, v208, v209
    v_mfma_f32_16x16x32_bf16 v[248:251], v[56:59], a[112:115], v[248:251]
    v_cvt_pk_bf16_f32 v210, v210, v211
    v_accvgpr_write_b32 a36, v208
    v_mfma_f32_16x16x32_bf16 v[248:251], v[60:63], a[116:119], v[248:251]
    buffer_load_dwordx4 v3, s[24:27], s60 offen offset:1024 lds
    v_mfma_f32_16x16x32_bf16 v[252:255], v[56:59], a[120:123], v[252:255]
    ds_read_b64_tr_b16 v[56:57], v16 offset:32768
    ds_read_b64_tr_b16 v[58:59], v16 offset:33792
    v_mfma_f32_16x16x32_bf16 v[252:255], v[60:63], a[124:127], v[252:255]
    s_waitcnt lgkmcnt(2)
    ds_read_b64_tr_b16 v[60:61], v16 offset:40960
    ds_read_b64_tr_b16 v[62:63], v16 offset:41984
    v_mfma_f32_16x16x32_bf16 a[128:131], a[64:67], v[40:43], a[128:131]
    v_xor_b32 v16, s73, v16
    v_add_u32 v16, 0x10000, v16
    v_mfma_f32_16x16x32_bf16 a[128:131], a[68:71], v[44:47], a[128:131]
    v_accvgpr_write_b32 a37, v210
    v_cvt_pk_bf16_f32 v212, v212, v213
    v_mfma_f32_16x16x32_bf16 a[132:135], a[72:75], v[40:43], a[132:135]
    ds_read_b128 v[80:83], v24 offset:49152
    v_cvt_pk_bf16_f32 v214, v214, v215
    v_mfma_f32_16x16x32_bf16 a[132:135], a[76:79], v[44:47], a[132:135]
    v_accvgpr_write_b32 a44, v212
    v_accvgpr_write_b32 a45, v214
    v_mfma_f32_16x16x32_bf16 a[136:139], a[80:83], v[40:43], a[136:139]
    v_cvt_pk_bf16_f32 v216, v216, v217
    v_cvt_pk_bf16_f32 v218, v218, v219
    v_mfma_f32_16x16x32_bf16 a[136:139], a[84:87], v[44:47], a[136:139]
    buffer_load_dwordx4 v4, s[24:27], s60 offen offset:2048 lds
    v_mfma_f32_16x16x32_bf16 a[140:143], a[88:91], v[40:43], a[140:143]
    v_accvgpr_write_b32 a52, v216
    v_accvgpr_write_b32 a53, v218
    v_mfma_f32_16x16x32_bf16 a[140:143], a[92:95], v[44:47], a[140:143]
    v_cvt_pk_bf16_f32 v220, v220, v221
    v_cvt_pk_bf16_f32 v222, v222, v223
    v_mfma_f32_16x16x32_bf16 a[144:147], a[96:99], v[40:43], a[144:147]
    v_accvgpr_write_b32 a60, v220
    v_accvgpr_write_b32 a61, v222
    v_mfma_f32_16x16x32_bf16 a[144:147], a[100:103], v[44:47], a[144:147]
    v_cvt_pk_bf16_f32 v224, v224, v225
    v_cvt_pk_bf16_f32 v226, v226, v227
    v_mfma_f32_16x16x32_bf16 a[148:151], a[104:107], v[40:43], a[148:151]
    v_accvgpr_write_b32 a6, v224
    v_accvgpr_write_b32 a7, v226
    v_mfma_f32_16x16x32_bf16 a[148:151], a[108:111], v[44:47], a[148:151]
    v_cvt_pk_bf16_f32 v228, v228, v229
    v_cvt_pk_bf16_f32 v230, v230, v231
    v_mfma_f32_16x16x32_bf16 a[152:155], a[112:115], v[40:43], a[152:155]
    buffer_load_dwordx4 v5, s[24:27], s60 offen offset:3072 lds
    v_mfma_f32_16x16x32_bf16 a[152:155], a[116:119], v[44:47], a[152:155]
    ds_read_b128 v[84:87], v25 offset:49152
    v_accvgpr_write_b32 a14, v228
    v_mfma_f32_16x16x32_bf16 a[156:159], a[120:123], v[40:43], a[156:159]
    ds_read_b64_tr_b16 v[40:41], v17 offset:32768
    ds_read_b64_tr_b16 v[42:43], v17 offset:33792
    v_mfma_f32_16x16x32_bf16 a[156:159], a[124:127], v[44:47], a[156:159]
    s_add_u32 s72, s70, 0
    ds_read_b64_tr_b16 v[44:45], v17 offset:40960
    ds_read_b64_tr_b16 v[46:47], v17 offset:41984
    v_mfma_f32_16x16x32_bf16 a[160:163], a[64:67], v[48:51], a[160:163]
    v_xor_b32 v17, s73, v17
    v_add_u32 v17, 0x10000, v17
    v_mfma_f32_16x16x32_bf16 a[160:163], a[68:71], v[52:55], a[160:163]
    buffer_store_dwordx4 a[0:3], v1, s[36:39], s72 offen sc1
    v_mfma_f32_16x16x32_bf16 a[164:167], a[72:75], v[48:51], a[164:167]
    v_accvgpr_write_b32 a15, v230
    v_cvt_pk_bf16_f32 v232, v232, v233
    v_mfma_f32_16x16x32_bf16 a[164:167], a[76:79], v[52:55], a[164:167]
    s_add_u32 m0, s69, 147456
    v_cvt_pk_bf16_f32 v234, v234, v235
    v_accvgpr_write_b32 a22, v232
    v_mfma_f32_16x16x32_bf16 a[168:171], a[80:83], v[48:51], a[168:171]
    s_xor_b32 s60, s60, 1572864
    buffer_load_dwordx4 v10, s[20:23], s63 offen lds
    v_mfma_f32_16x16x32_bf16 a[168:171], a[84:87], v[52:55], a[168:171]
    v_accvgpr_write_b32 a23, v234
    v_cvt_pk_bf16_f32 v236, v236, v237
    v_mfma_f32_16x16x32_bf16 a[172:175], a[88:91], v[48:51], a[172:175]
    v_cvt_pk_bf16_f32 v238, v238, v239
    v_accvgpr_write_b32 a30, v236
    v_mfma_f32_16x16x32_bf16 a[172:175], a[92:95], v[52:55], a[172:175]
    v_accvgpr_write_b32 a31, v238
    v_cvt_pk_bf16_f32 v240, v240, v241
    v_mfma_f32_16x16x32_bf16 a[176:179], a[96:99], v[48:51], a[176:179]
    ds_read_b128 v[88:91], v24 offset:57344
    v_cvt_pk_bf16_f32 v242, v242, v243
    v_mfma_f32_16x16x32_bf16 a[176:179], a[100:103], v[52:55], a[176:179]
    v_accvgpr_write_b32 a38, v240
    v_accvgpr_write_b32 a39, v242
    v_mfma_f32_16x16x32_bf16 a[180:183], a[104:107], v[48:51], a[180:183]
    v_cvt_pk_bf16_f32 v244, v244, v245
    v_cvt_pk_bf16_f32 v246, v246, v247
    v_mfma_f32_16x16x32_bf16 a[180:183], a[108:111], v[52:55], a[180:183]
    buffer_load_dwordx4 v11, s[20:23], s63 offen offset:1024 lds
    v_mfma_f32_16x16x32_bf16 a[184:187], a[112:115], v[48:51], a[184:187]
    v_accvgpr_write_b32 a46, v244
    v_accvgpr_write_b32 a47, v246
    v_mfma_f32_16x16x32_bf16 a[184:187], a[116:119], v[52:55], a[184:187]
    v_cvt_pk_bf16_f32 v248, v248, v249
    v_cvt_pk_bf16_f32 v250, v250, v251
    v_mfma_f32_16x16x32_bf16 a[188:191], a[120:123], v[48:51], a[188:191]
    v_accvgpr_write_b32 a54, v248
    v_accvgpr_write_b32 a55, v250
    v_mfma_f32_16x16x32_bf16 a[188:191], a[124:127], v[52:55], a[188:191]
    s_waitcnt lgkmcnt(0)
    v_cvt_pk_bf16_f32 v252, v252, v253
    v_cvt_pk_bf16_f32 v254, v254, v255
    v_mfma_f32_16x16x32_bf16 a[192:195], a[64:67], v[56:59], a[192:195]
    v_accvgpr_write_b32 a62, v252
    v_accvgpr_write_b32 a63, v254
    v_mfma_f32_16x16x32_bf16 a[192:195], a[68:71], v[60:63], a[192:195]
    v_accvgpr_write_b32 a0, 0
    v_accvgpr_write_b32 a1, 0
    v_mfma_f32_16x16x32_bf16 a[196:199], a[72:75], v[56:59], a[196:199]
    v_accvgpr_write_b32 a2, 0
    v_accvgpr_write_b32 a3, 0
    v_mfma_f32_16x16x32_bf16 a[196:199], a[76:79], v[60:63], a[196:199]
    buffer_load_dwordx4 v12, s[20:23], s63 offen offset:2048 lds
    v_mfma_f32_16x16x32_bf16 a[200:203], a[80:83], v[56:59], a[200:203]
    ds_read_b128 v[92:95], v25 offset:57344
    v_mfma_f32_16x16x32_bf16 a[200:203], a[84:87], v[60:63], a[200:203]
    s_add_u32 s72, s70, 4096
    v_mfma_f32_16x16x32_bf16 a[204:207], a[88:91], v[56:59], a[204:207]
    buffer_store_dwordx4 a[8:11], v1, s[36:39], s72 offen sc1
    v_mfma_f32_16x16x32_bf16 a[204:207], a[92:95], v[60:63], a[204:207]
    v_mfma_f32_16x16x32_bf16 a[208:211], a[96:99], v[56:59], a[208:211]
    v_accvgpr_write_b32 a8, 0
    v_accvgpr_write_b32 a9, 0
    v_mfma_f32_16x16x32_bf16 a[208:211], a[100:103], v[60:63], a[208:211]
    v_accvgpr_write_b32 a10, 0
    v_accvgpr_write_b32 a11, 0
    v_mfma_f32_16x16x32_bf16 a[212:215], a[104:107], v[56:59], a[212:215]
    buffer_load_dwordx4 v13, s[20:23], s63 offen offset:3072 lds
    v_mfma_f32_16x16x32_bf16 a[212:215], a[108:111], v[60:63], a[212:215]
    v_mfma_f32_16x16x32_bf16 a[216:219], a[112:115], v[56:59], a[216:219]
    v_mfma_f32_16x16x32_bf16 a[216:219], a[116:119], v[60:63], a[216:219]
    v_mfma_f32_16x16x32_bf16 a[220:223], a[120:123], v[56:59], a[220:223]
    v_mfma_f32_16x16x32_bf16 a[220:223], a[124:127], v[60:63], a[220:223]
    v_mfma_f32_16x16x32_bf16 a[224:227], a[64:67], v[40:43], a[224:227]
    v_mfma_f32_16x16x32_bf16 a[224:227], a[68:71], v[44:47], a[224:227]
    s_xor_b32 s63, s63, 128
    v_mfma_f32_16x16x32_bf16 a[228:231], a[72:75], v[40:43], a[228:231]
    v_accvgpr_read_b32 v32, a128
    v_accvgpr_read_b32 v31, a129
    v_mfma_f32_16x16x32_bf16 a[228:231], a[76:79], v[44:47], a[228:231]
    v_cvt_pk_bf16_f32 v32, v32, v31
    v_accvgpr_read_b32 v33, a130
    v_mfma_f32_16x16x32_bf16 a[232:235], a[80:83], v[40:43], a[232:235]
    v_accvgpr_read_b32 v31, a131
    v_cvt_pk_bf16_f32 v33, v33, v31
    v_mfma_f32_16x16x32_bf16 a[232:235], a[84:87], v[44:47], a[232:235]
    s_waitcnt vmcnt(10) lgkmcnt(0)
    s_barrier
    ds_read_b64_tr_b16 v[48:49], v14 offset:0
    v_mfma_f32_16x16x32_bf16 a[236:239], a[88:91], v[40:43], a[236:239]
    s_add_u32 m0, s67, 0
    ds_read_b64_tr_b16 v[50:51], v14 offset:1024
    ds_read_b64_tr_b16 v[52:53], v14 offset:8192
    v_mfma_f32_16x16x32_bf16 a[236:239], a[92:95], v[44:47], a[236:239]
    buffer_load_dwordx4 v1, s[28:31], s65 offen sc1 lds
    v_mfma_f32_16x16x32_bf16 a[240:243], a[96:99], v[40:43], a[240:243]
    ds_read_b64_tr_b16 v[54:55], v14 offset:9216
    ds_read_b64_tr_b16 v[56:57], v15 offset:0
    v_mfma_f32_16x16x32_bf16 a[240:243], a[100:103], v[44:47], a[240:243]
    ds_read_b64_tr_b16 v[58:59], v15 offset:1024
    ds_read_b64_tr_b16 v[60:61], v15 offset:8192
    v_mfma_f32_16x16x32_bf16 a[244:247], a[104:107], v[40:43], a[244:247]
    ds_read_b64_tr_b16 v[62:63], v15 offset:9216
    v_add_u32 v14, 0x10000, v14
    v_mfma_f32_16x16x32_bf16 a[244:247], a[108:111], v[44:47], a[244:247]
    s_add_u32 s72, s71, 0
    v_add_u32 v15, 0x10000, v15
    v_accvgpr_read_b32 v34, a132
    v_mfma_f32_16x16x32_bf16 a[248:251], a[112:115], v[40:43], a[248:251]
    v_accvgpr_read_b32 v31, a133
    v_cvt_pk_bf16_f32 v34, v34, v31
    v_mfma_f32_16x16x32_bf16 a[248:251], a[116:119], v[44:47], a[248:251]
    v_accvgpr_read_b32 v35, a134
    v_accvgpr_read_b32 v31, a135
    v_mfma_f32_16x16x32_bf16 a[252:255], a[120:123], v[40:43], a[252:255]
    buffer_load_dwordx4 v1, s[28:31], s65 offen offset:1024 sc1 lds
    v_mfma_f32_16x16x32_bf16 a[252:255], a[124:127], v[44:47], a[252:255]
    s_waitcnt lgkmcnt(0)
    ds_read_b64_tr_b16 v[40:41], v16 offset:0
    ds_read_b64_tr_b16 v[42:43], v16 offset:1024
    v_mfma_f32_16x16x32_bf16 v[128:131], v[48:51], v[64:67], 0
    ds_read_b64_tr_b16 v[44:45], v16 offset:8192
    ds_read_b64_tr_b16 v[46:47], v16 offset:9216
    v_mfma_f32_16x16x32_bf16 v[128:131], v[52:55], v[68:71], v[128:131]
    v_add_u32 v24, 0x10000, v24
    v_add_u32 v16, 0x10000, v16
    v_mfma_f32_16x16x32_bf16 v[132:135], v[48:51], v[72:75], 0
    ds_read_b128 v[96:99], v24 offset:16384
    v_cvt_pk_bf16_f32 v35, v35, v31
    v_mfma_f32_16x16x32_bf16 v[132:135], v[52:55], v[76:79], v[132:135]
    buffer_store_dwordx4 v[32:35], v1, s[36:39], s72 offen sc1
    v_mfma_f32_16x16x32_bf16 v[136:139], v[48:51], v[80:83], 0
    v_mfma_f32_16x16x32_bf16 v[136:139], v[52:55], v[84:87], v[136:139]
    v_mfma_f32_16x16x32_bf16 v[140:143], v[48:51], v[88:91], 0
    s_add_u32 m0, s68, 8192
    ds_read_b64_tr_b16 v[48:49], v17 offset:0
    ds_read_b64_tr_b16 v[50:51], v17 offset:1024
    v_mfma_f32_16x16x32_bf16 v[140:143], v[52:55], v[92:95], v[140:143]
    buffer_load_dwordx4 v6, s[20:23], s66 offen lds
    v_mfma_f32_16x16x32_bf16 v[144:147], v[56:59], v[64:67], 0
    ds_read_b64_tr_b16 v[52:53], v17 offset:8192
    ds_read_b64_tr_b16 v[54:55], v17 offset:9216
    v_mfma_f32_16x16x32_bf16 v[144:147], v[60:63], v[68:71], v[144:147]
    v_add_u32 v17, 0x10000, v17
    v_mfma_f32_16x16x32_bf16 v[148:151], v[56:59], v[72:75], 0
    v_mfma_f32_16x16x32_bf16 v[148:151], v[60:63], v[76:79], v[148:151]
    v_mfma_f32_16x16x32_bf16 v[152:155], v[56:59], v[80:83], 0
    v_add_u32 v25, 0x10000, v25
    v_mfma_f32_16x16x32_bf16 v[152:155], v[60:63], v[84:87], v[152:155]
    ds_read_b128 v[100:103], v25 offset:16384
    v_mfma_f32_16x16x32_bf16 v[156:159], v[56:59], v[88:91], 0
    s_add_u32 m0, s69, 16384
    ds_read_b64_tr_b16 v[56:57], v18 offset:0
    ds_read_b64_tr_b16 v[58:59], v18 offset:1024
    v_mfma_f32_16x16x32_bf16 v[156:159], v[60:63], v[92:95], v[156:159]
    s_xor_b32 s65, s65, 24576
    buffer_load_dwordx4 v10, s[20:23], s64 offen lds
    s_waitcnt lgkmcnt(3)
    v_mfma_f32_16x16x32_bf16 v[160:163], v[40:43], v[64:67], 0
    s_xor_b32 s66, s66, 384
    ds_read_b64_tr_b16 v[60:61], v18 offset:8192
    ds_read_b64_tr_b16 v[62:63], v18 offset:9216
    v_mfma_f32_16x16x32_bf16 v[160:163], v[44:47], v[68:71], v[160:163]
    s_add_u32 s72, s70, 8192
    v_add_u32 v18, 0x10000, v18
    v_mfma_f32_16x16x32_bf16 v[164:167], v[40:43], v[72:75], 0
    buffer_store_dwordx4 a[16:19], v1, s[36:39], s72 offen sc1
    v_mfma_f32_16x16x32_bf16 v[164:167], v[44:47], v[76:79], v[164:167]
    v_mfma_f32_16x16x32_bf16 v[168:171], v[40:43], v[80:83], 0
    v_accvgpr_write_b32 a16, 0
    v_accvgpr_write_b32 a17, 0
    v_mfma_f32_16x16x32_bf16 v[168:171], v[44:47], v[84:87], v[168:171]
    v_accvgpr_write_b32 a18, 0
    v_accvgpr_write_b32 a19, 0
    v_mfma_f32_16x16x32_bf16 v[172:175], v[40:43], v[88:91], 0
    ds_read_b64_tr_b16 v[40:41], v19 offset:0
    ds_read_b64_tr_b16 v[42:43], v19 offset:1024
    v_mfma_f32_16x16x32_bf16 v[172:175], v[44:47], v[92:95], v[172:175]
    ds_read_b64_tr_b16 v[44:45], v19 offset:8192
    ds_read_b64_tr_b16 v[46:47], v19 offset:9216
    v_mfma_f32_16x16x32_bf16 v[176:179], v[48:51], v[64:67], 0
    buffer_load_dwordx4 v11, s[20:23], s64 offen offset:1024 lds
    v_mfma_f32_16x16x32_bf16 v[176:179], v[52:55], v[68:71], v[176:179]
    ds_read_b128 v[104:107], v24 offset:24576
    v_add_u32 v19, 0x10000, v19
    v_mfma_f32_16x16x32_bf16 v[180:183], v[48:51], v[72:75], 0
    v_mfma_f32_16x16x32_bf16 v[180:183], v[52:55], v[76:79], v[180:183]
    v_mfma_f32_16x16x32_bf16 v[184:187], v[48:51], v[80:83], 0
    v_mfma_f32_16x16x32_bf16 v[184:187], v[52:55], v[84:87], v[184:187]
    v_mfma_f32_16x16x32_bf16 v[188:191], v[48:51], v[88:91], 0
    ds_read_b64_tr_b16 v[48:49], v20 offset:0
    ds_read_b64_tr_b16 v[50:51], v20 offset:1024
    v_mfma_f32_16x16x32_bf16 v[188:191], v[52:55], v[92:95], v[188:191]
    s_waitcnt lgkmcnt(2)
    ds_read_b64_tr_b16 v[52:53], v20 offset:8192
    ds_read_b64_tr_b16 v[54:55], v20 offset:9216
    v_mfma_f32_16x16x32_bf16 v[192:195], v[56:59], v[64:67], 0
    buffer_load_dwordx4 v12, s[20:23], s64 offen offset:2048 lds
    v_mfma_f32_16x16x32_bf16 v[192:195], v[60:63], v[68:71], v[192:195]
    v_add_u32 v20, 0x10000, v20
    v_accvgpr_read_b32 v32, a136
    v_mfma_f32_16x16x32_bf16 v[196:199], v[56:59], v[72:75], 0
    v_accvgpr_read_b32 v31, a137
    v_cvt_pk_bf16_f32 v32, v32, v31
    v_mfma_f32_16x16x32_bf16 v[196:199], v[60:63], v[76:79], v[196:199]
    ds_read_b128 v[108:111], v25 offset:24576
    v_accvgpr_read_b32 v33, a138
    v_mfma_f32_16x16x32_bf16 v[200:203], v[56:59], v[80:83], 0
    v_accvgpr_read_b32 v31, a139
    ds_read_b128 a[136:139], v22 offset:32768
    v_mfma_f32_16x16x32_bf16 v[200:203], v[60:63], v[84:87], v[200:203]
    v_add_u32 v22, 0xffff0000, v22
    v_cvt_pk_bf16_f32 v33, v33, v31
    v_mfma_f32_16x16x32_bf16 v[204:207], v[56:59], v[88:91], 0
    ds_read_b64_tr_b16 v[56:57], v21 offset:0
    ds_read_b64_tr_b16 v[58:59], v21 offset:1024
    v_mfma_f32_16x16x32_bf16 v[204:207], v[60:63], v[92:95], v[204:207]
    s_add_u32 s72, s71, 1024
    ds_read_b64_tr_b16 v[60:61], v21 offset:8192
    ds_read_b64_tr_b16 v[62:63], v21 offset:9216
    v_mfma_f32_16x16x32_bf16 v[208:211], v[40:43], v[64:67], 0
    v_add_u32 v21, 0x10000, v21
    v_accvgpr_read_b32 v34, a140
    v_mfma_f32_16x16x32_bf16 v[208:211], v[44:47], v[68:71], v[208:211]
    buffer_load_dwordx4 v13, s[20:23], s64 offen offset:3072 lds
    v_mfma_f32_16x16x32_bf16 v[212:215], v[40:43], v[72:75], 0
    v_accvgpr_read_b32 v31, a141
    v_cvt_pk_bf16_f32 v34, v34, v31
    v_mfma_f32_16x16x32_bf16 v[212:215], v[44:47], v[76:79], v[212:215]
    v_accvgpr_read_b32 v35, a142
    v_accvgpr_read_b32 v31, a143
    v_mfma_f32_16x16x32_bf16 v[216:219], v[40:43], v[80:83], 0
    ds_read_b128 a[140:143], v23 offset:32768
    v_add_u32 v23, 0xffff0000, v23
    v_mfma_f32_16x16x32_bf16 v[216:219], v[44:47], v[84:87], v[216:219]
    v_cvt_pk_bf16_f32 v35, v35, v31
    v_mfma_f32_16x16x32_bf16 v[220:223], v[40:43], v[88:91], 0
    ds_read_b64_tr_b16 v[40:41], v26 offset:32768
    ds_read_b64_tr_b16 v[42:43], v26 offset:33280
    v_mfma_f32_16x16x32_bf16 v[220:223], v[44:47], v[92:95], v[220:223]
    s_waitcnt lgkmcnt(3)
    ds_read_b64_tr_b16 v[44:45], v26 offset:36864
    ds_read_b64_tr_b16 v[46:47], v26 offset:37376
    v_mfma_f32_16x16x32_bf16 v[224:227], v[48:51], v[64:67], 0
    buffer_store_dwordx4 v[32:35], v1, s[36:39], s72 offen sc1
    v_mfma_f32_16x16x32_bf16 v[224:227], v[52:55], v[68:71], v[224:227]
    s_xor_b32 s64, s64, 128
    v_add_u32 v26, 0xffff0000, v26
    v_mfma_f32_16x16x32_bf16 v[228:231], v[48:51], v[72:75], 0
    v_mfma_f32_16x16x32_bf16 v[228:231], v[52:55], v[76:79], v[228:231]
    v_mfma_f32_16x16x32_bf16 v[232:235], v[48:51], v[80:83], 0
    v_mfma_f32_16x16x32_bf16 v[232:235], v[52:55], v[84:87], v[232:235]
    s_add_u32 m0, s69, 32768
    v_mfma_f32_16x16x32_bf16 v[236:239], v[48:51], v[88:91], 0
    buffer_load_dwordx4 v2, s[24:27], s60 offen lds
    v_mfma_f32_16x16x32_bf16 v[236:239], v[52:55], v[92:95], v[236:239]
    ds_read_b64_tr_b16 v[48:49], v27 offset:32768
    ds_read_b64_tr_b16 v[50:51], v27 offset:33280
    v_mfma_f32_16x16x32_bf16 v[240:243], v[56:59], v[64:67], 0
    ds_read_b64_tr_b16 v[52:53], v27 offset:36864
    ds_read_b64_tr_b16 v[54:55], v27 offset:37376
    v_mfma_f32_16x16x32_bf16 v[240:243], v[60:63], v[68:71], v[240:243]
    v_add_u32 v27, 0xffff0000, v27
    v_mfma_f32_16x16x32_bf16 v[244:247], v[56:59], v[72:75], 0
    buffer_load_dwordx4 v3, s[24:27], s60 offen offset:1024 lds
    v_mfma_f32_16x16x32_bf16 v[244:247], v[60:63], v[76:79], v[244:247]
    v_mfma_f32_16x16x32_bf16 v[248:251], v[56:59], v[80:83], 0
    v_mfma_f32_16x16x32_bf16 v[248:251], v[60:63], v[84:87], v[248:251]
    s_add_u32 s72, s70, 12288
    v_mfma_f32_16x16x32_bf16 v[252:255], v[56:59], v[88:91], 0
    buffer_load_dwordx4 v4, s[24:27], s60 offen offset:2048 lds
    v_mfma_f32_16x16x32_bf16 v[252:255], v[60:63], v[92:95], v[252:255]
    s_waitcnt lgkmcnt(0)
    ds_read_b64_tr_b16 v[56:57], v28 offset:32768
    ds_read_b64_tr_b16 v[58:59], v28 offset:33280
    v_mfma_f32_16x16x32_bf16 a[64:67], v[40:43], v[64:67], 0
    ds_read_b64_tr_b16 v[60:61], v28 offset:36864
    ds_read_b64_tr_b16 v[62:63], v28 offset:37376
    v_mfma_f32_16x16x32_bf16 a[64:67], v[44:47], v[68:71], a[64:67]
    buffer_store_dwordx4 a[24:27], v1, s[36:39], s72 offen sc1
    v_mfma_f32_16x16x32_bf16 a[68:71], v[40:43], v[72:75], 0
    buffer_load_dwordx4 v5, s[24:27], s60 offen offset:3072 lds
    v_mfma_f32_16x16x32_bf16 a[68:71], v[44:47], v[76:79], a[68:71]
    ds_read_b128 v[112:115], v24 offset:49152
    v_add_u32 v28, 0xffff0000, v28
    v_mfma_f32_16x16x32_bf16 a[72:75], v[40:43], v[80:83], 0
    v_accvgpr_write_b32 a24, 0
    v_accvgpr_write_b32 a25, 0
    v_mfma_f32_16x16x32_bf16 a[72:75], v[44:47], v[84:87], a[72:75]
    s_add_u32 m0, s69, 49152
    v_accvgpr_write_b32 a26, 0
    v_accvgpr_write_b32 a27, 0
    v_mfma_f32_16x16x32_bf16 a[76:79], v[40:43], v[88:91], 0
    s_xor_b32 s60, s60, 524288
    buffer_load_dwordx4 v10, s[20:23], s63 offen lds
    v_mfma_f32_16x16x32_bf16 a[76:79], v[44:47], v[92:95], a[76:79]
    ds_read_b128 v[116:119], v25 offset:49152
    v_mfma_f32_16x16x32_bf16 a[128:131], v[40:43], a[136:139], 0
    ds_read_b64_tr_b16 v[40:41], v29 offset:32768
    ds_read_b64_tr_b16 v[42:43], v29 offset:33280
    v_mfma_f32_16x16x32_bf16 a[128:131], v[44:47], a[140:143], a[128:131]
    ds_read_b64_tr_b16 v[44:45], v29 offset:36864
    ds_read_b64_tr_b16 v[46:47], v29 offset:37376
    v_mfma_f32_16x16x32_bf16 a[80:83], v[48:51], v[64:67], 0
    buffer_load_dwordx4 v11, s[20:23], s63 offen offset:1024 lds
    v_mfma_f32_16x16x32_bf16 a[80:83], v[52:55], v[68:71], a[80:83]
    ds_read_b128 v[120:123], v24 offset:57344
    v_add_u32 v29, 0xffff0000, v29
    v_mfma_f32_16x16x32_bf16 a[84:87], v[48:51], v[72:75], 0
    v_mfma_f32_16x16x32_bf16 a[84:87], v[52:55], v[76:79], a[84:87]
    v_mfma_f32_16x16x32_bf16 a[88:91], v[48:51], v[80:83], 0
    buffer_load_dwordx4 v12, s[20:23], s63 offen offset:2048 lds
    v_mfma_f32_16x16x32_bf16 a[88:91], v[52:55], v[84:87], a[88:91]
    ds_read_b128 v[124:127], v25 offset:57344
    v_mfma_f32_16x16x32_bf16 a[92:95], v[48:51], v[88:91], 0
    v_mfma_f32_16x16x32_bf16 a[92:95], v[52:55], v[92:95], a[92:95]
    v_mfma_f32_16x16x32_bf16 a[132:135], v[48:51], a[136:139], 0
    buffer_load_dwordx4 v13, s[20:23], s63 offen offset:3072 lds
    v_mfma_f32_16x16x32_bf16 a[132:135], v[52:55], a[140:143], a[132:135]
    s_add_u32 s72, s70, 32768
    s_waitcnt lgkmcnt(1)
    v_mfma_f32_16x16x32_bf16 a[96:99], v[56:59], v[64:67], 0
    v_mfma_f32_16x16x32_bf16 a[96:99], v[60:63], v[68:71], a[96:99]
    s_xor_b32 s63, s63, 896
    v_mfma_f32_16x16x32_bf16 a[100:103], v[56:59], v[72:75], 0
    buffer_store_dwordx4 a[32:35], v1, s[36:39], s72 offen sc1
    v_mfma_f32_16x16x32_bf16 a[100:103], v[60:63], v[76:79], a[100:103]
    v_mfma_f32_16x16x32_bf16 a[104:107], v[56:59], v[80:83], 0
    v_accvgpr_write_b32 a32, 0
    v_accvgpr_write_b32 a33, 0
    v_mfma_f32_16x16x32_bf16 a[104:107], v[60:63], v[84:87], a[104:107]
    s_waitcnt vmcnt(11) lgkmcnt(0)
    s_barrier
    ds_read_b64_tr_b16 v[48:49], v14 offset:0
    v_mfma_f32_16x16x32_bf16 a[108:111], v[56:59], v[88:91], 0
    s_add_u32 m0, s67, 65536
    ds_read_b64_tr_b16 v[50:51], v14 offset:1024
    ds_read_b64_tr_b16 v[52:53], v14 offset:8192
    v_mfma_f32_16x16x32_bf16 a[108:111], v[60:63], v[92:95], a[108:111]
    buffer_load_dwordx4 v1, s[28:31], s65 offen sc1 lds
    v_mfma_f32_16x16x32_bf16 a[112:115], v[40:43], v[64:67], 0
    ds_read_b64_tr_b16 v[54:55], v14 offset:9216
    ds_read_b64_tr_b16 v[56:57], v15 offset:0
    v_mfma_f32_16x16x32_bf16 a[112:115], v[44:47], v[68:71], a[112:115]
    ds_read_b64_tr_b16 v[58:59], v15 offset:1024
    ds_read_b64_tr_b16 v[60:61], v15 offset:8192
    v_mfma_f32_16x16x32_bf16 a[116:119], v[40:43], v[72:75], 0
    ds_read_b64_tr_b16 v[62:63], v15 offset:9216
    ds_read_b128 a[136:139], v22 offset:0
    v_mfma_f32_16x16x32_bf16 a[116:119], v[44:47], v[76:79], a[116:119]
    ds_read_b128 a[140:143], v23 offset:0
    v_add_u32 v14, 0xfffe0000, v14
    v_mfma_f32_16x16x32_bf16 a[120:123], v[40:43], v[80:83], 0
    v_add_u32 v15, 0xfffe0000, v15
    v_add_u32 v22, 0x10000, v22
    v_mfma_f32_16x16x32_bf16 a[120:123], v[44:47], v[84:87], a[120:123]
    v_add_u32 v23, 0x10000, v23
    v_accvgpr_write_b32 a34, 0
    v_mfma_f32_16x16x32_bf16 a[124:127], v[40:43], v[88:91], 0
    buffer_load_dwordx4 v1, s[28:31], s65 offen offset:1024 sc1 lds
    v_mfma_f32_16x16x32_bf16 a[124:127], v[44:47], v[92:95], a[124:127]
    s_waitcnt lgkmcnt(1)
    ds_read_b64_tr_b16 v[40:41], v16 offset:0
    ds_read_b64_tr_b16 v[42:43], v16 offset:1024
    v_mfma_f32_16x16x32_bf16 v[128:131], v[48:51], v[96:99], v[128:131]
    ds_read_b64_tr_b16 v[44:45], v16 offset:8192
    ds_read_b64_tr_b16 v[46:47], v16 offset:9216
    v_mfma_f32_16x16x32_bf16 v[128:131], v[52:55], v[100:103], v[128:131]
    v_add_u32 v24, 0x10000, v24
    v_add_u32 v16, 0xfffe0000, v16
    v_mfma_f32_16x16x32_bf16 v[132:135], v[48:51], v[104:107], v[132:135]
    ds_read_b128 v[64:67], v24 offset:16384
    v_accvgpr_write_b32 a35, 0
    v_mfma_f32_16x16x32_bf16 v[132:135], v[52:55], v[108:111], v[132:135]
    v_mfma_f32_16x16x32_bf16 v[136:139], v[48:51], v[112:115], v[136:139]
    v_mfma_f32_16x16x32_bf16 v[136:139], v[52:55], v[116:119], v[136:139]
    s_add_u32 s72, s70, 36864
    v_mfma_f32_16x16x32_bf16 v[140:143], v[48:51], v[120:123], v[140:143]
    s_add_u32 m0, s68, 73728
    ds_read_b64_tr_b16 v[48:49], v17 offset:0
    ds_read_b64_tr_b16 v[50:51], v17 offset:1024
    v_mfma_f32_16x16x32_bf16 v[140:143], v[52:55], v[124:127], v[140:143]
    buffer_load_dwordx4 v6, s[20:23], s66 offen lds
    v_mfma_f32_16x16x32_bf16 v[144:147], v[56:59], v[96:99], v[144:147]
    ds_read_b64_tr_b16 v[52:53], v17 offset:8192
    ds_read_b64_tr_b16 v[54:55], v17 offset:9216
    v_mfma_f32_16x16x32_bf16 v[144:147], v[60:63], v[100:103], v[144:147]
    buffer_store_dwordx4 a[40:43], v1, s[36:39], s72 offen sc1
    v_mfma_f32_16x16x32_bf16 v[148:151], v[56:59], v[104:107], v[148:151]
    v_add_u32 v17, 0xfffe0000, v17
    v_accvgpr_write_b32 a40, 0
    v_mfma_f32_16x16x32_bf16 v[148:151], v[60:63], v[108:111], v[148:151]
    v_accvgpr_write_b32 a41, 0
    v_accvgpr_write_b32 a42, 0
    v_mfma_f32_16x16x32_bf16 v[152:155], v[56:59], v[112:115], v[152:155]
    v_add_u32 v25, 0x10000, v25
    v_accvgpr_write_b32 a43, 0
    v_mfma_f32_16x16x32_bf16 v[152:155], v[60:63], v[116:119], v[152:155]
    ds_read_b128 v[68:71], v25 offset:16384
    v_mfma_f32_16x16x32_bf16 v[156:159], v[56:59], v[120:123], v[156:159]
    s_add_u32 m0, s69, 81920
    ds_read_b64_tr_b16 v[56:57], v18 offset:0
    ds_read_b64_tr_b16 v[58:59], v18 offset:1024
    v_mfma_f32_16x16x32_bf16 v[156:159], v[60:63], v[124:127], v[156:159]
    s_xor_b32 s65, s65, 8192
    buffer_load_dwordx4 v10, s[20:23], s64 offen lds
    s_waitcnt lgkmcnt(3)
    v_mfma_f32_16x16x32_bf16 v[160:163], v[40:43], v[96:99], v[160:163]
    s_xor_b32 s66, s66, 128
    ds_read_b64_tr_b16 v[60:61], v18 offset:8192
    ds_read_b64_tr_b16 v[62:63], v18 offset:9216
    v_mfma_f32_16x16x32_bf16 v[160:163], v[44:47], v[100:103], v[160:163]
    v_add_u32 v18, 0xfffe0000, v18
    v_mfma_f32_16x16x32_bf16 v[164:167], v[40:43], v[104:107], v[164:167]
    v_mfma_f32_16x16x32_bf16 v[164:167], v[44:47], v[108:111], v[164:167]
    v_mfma_f32_16x16x32_bf16 v[168:171], v[40:43], v[112:115], v[168:171]
    v_mfma_f32_16x16x32_bf16 v[168:171], v[44:47], v[116:119], v[168:171]
    v_mfma_f32_16x16x32_bf16 v[172:175], v[40:43], v[120:123], v[172:175]
    ds_read_b64_tr_b16 v[40:41], v19 offset:0
    ds_read_b64_tr_b16 v[42:43], v19 offset:1024
    v_mfma_f32_16x16x32_bf16 v[172:175], v[44:47], v[124:127], v[172:175]
    ds_read_b64_tr_b16 v[44:45], v19 offset:8192
    ds_read_b64_tr_b16 v[46:47], v19 offset:9216
    v_mfma_f32_16x16x32_bf16 v[176:179], v[48:51], v[96:99], v[176:179]
    buffer_load_dwordx4 v11, s[20:23], s64 offen offset:1024 lds
    v_mfma_f32_16x16x32_bf16 v[176:179], v[52:55], v[100:103], v[176:179]
    ds_read_b128 v[72:75], v24 offset:24576
    v_add_u32 v19, 0xfffe0000, v19
    v_mfma_f32_16x16x32_bf16 v[180:183], v[48:51], v[104:107], v[180:183]
    v_mfma_f32_16x16x32_bf16 v[180:183], v[52:55], v[108:111], v[180:183]
    s_add_u32 s72, s70, 40960
    v_mfma_f32_16x16x32_bf16 v[184:187], v[48:51], v[112:115], v[184:187]
    buffer_store_dwordx4 a[48:51], v1, s[36:39], s72 offen sc1
    v_mfma_f32_16x16x32_bf16 v[184:187], v[52:55], v[116:119], v[184:187]
    v_mfma_f32_16x16x32_bf16 v[188:191], v[48:51], v[120:123], v[188:191]
    ds_read_b64_tr_b16 v[48:49], v20 offset:0
    ds_read_b64_tr_b16 v[50:51], v20 offset:1024
    v_mfma_f32_16x16x32_bf16 v[188:191], v[52:55], v[124:127], v[188:191]
    s_waitcnt lgkmcnt(2)
    ds_read_b64_tr_b16 v[52:53], v20 offset:8192
    ds_read_b64_tr_b16 v[54:55], v20 offset:9216
    v_mfma_f32_16x16x32_bf16 v[192:195], v[56:59], v[96:99], v[192:195]
    buffer_load_dwordx4 v12, s[20:23], s64 offen offset:2048 lds
    v_mfma_f32_16x16x32_bf16 v[192:195], v[60:63], v[100:103], v[192:195]
    v_add_u32 v20, 0xfffe0000, v20
    v_accvgpr_write_b32 a48, 0
    v_mfma_f32_16x16x32_bf16 v[196:199], v[56:59], v[104:107], v[196:199]
    v_accvgpr_write_b32 a49, 0
    v_accvgpr_write_b32 a50, 0
    v_mfma_f32_16x16x32_bf16 v[196:199], v[60:63], v[108:111], v[196:199]
    ds_read_b128 v[76:79], v25 offset:24576
    v_accvgpr_write_b32 a51, 0
    v_mfma_f32_16x16x32_bf16 v[200:203], v[56:59], v[112:115], v[200:203]
    v_mfma_f32_16x16x32_bf16 v[200:203], v[60:63], v[116:119], v[200:203]
    v_mfma_f32_16x16x32_bf16 v[204:207], v[56:59], v[120:123], v[204:207]
    ds_read_b64_tr_b16 v[56:57], v21 offset:0
    ds_read_b64_tr_b16 v[58:59], v21 offset:1024
    v_mfma_f32_16x16x32_bf16 v[204:207], v[60:63], v[124:127], v[204:207]
    ds_read_b64_tr_b16 v[60:61], v21 offset:8192
    ds_read_b64_tr_b16 v[62:63], v21 offset:9216
    v_mfma_f32_16x16x32_bf16 v[208:211], v[40:43], v[96:99], v[208:211]
    v_add_u32 v21, 0xfffe0000, v21
    v_mfma_f32_16x16x32_bf16 v[208:211], v[44:47], v[100:103], v[208:211]
    buffer_load_dwordx4 v13, s[20:23], s64 offen offset:3072 lds
    v_mfma_f32_16x16x32_bf16 v[212:215], v[40:43], v[104:107], v[212:215]
    v_mfma_f32_16x16x32_bf16 v[212:215], v[44:47], v[108:111], v[212:215]
    v_mfma_f32_16x16x32_bf16 v[216:219], v[40:43], v[112:115], v[216:219]
    v_mfma_f32_16x16x32_bf16 v[216:219], v[44:47], v[116:119], v[216:219]
    v_mfma_f32_16x16x32_bf16 v[220:223], v[40:43], v[120:123], v[220:223]
    ds_read_b64_tr_b16 v[40:41], v26 offset:0
    ds_read_b64_tr_b16 v[42:43], v26 offset:512
    v_mfma_f32_16x16x32_bf16 v[220:223], v[44:47], v[124:127], v[220:223]
    s_waitcnt lgkmcnt(2)
    ds_read_b64_tr_b16 v[44:45], v26 offset:4096
    ds_read_b64_tr_b16 v[46:47], v26 offset:4608
    v_mfma_f32_16x16x32_bf16 v[224:227], v[48:51], v[96:99], v[224:227]
    v_add_u32 v26, 0x10000, v26
    v_mfma_f32_16x16x32_bf16 v[224:227], v[52:55], v[100:103], v[224:227]
    s_xor_b32 s64, s64, 896
    v_mfma_f32_16x16x32_bf16 v[228:231], v[48:51], v[104:107], v[228:231]
    s_add_u32 s72, s70, 45056
    buffer_store_dwordx4 a[56:59], v1, s[36:39], s72 offen sc1
    v_mfma_f32_16x16x32_bf16 v[228:231], v[52:55], v[108:111], v[228:231]
    v_mfma_f32_16x16x32_bf16 v[232:235], v[48:51], v[112:115], v[232:235]
    v_accvgpr_write_b32 a56, 0
    v_accvgpr_write_b32 a57, 0
    v_mfma_f32_16x16x32_bf16 v[232:235], v[52:55], v[116:119], v[232:235]
    s_add_u32 m0, s69, 98304
    v_accvgpr_write_b32 a58, 0
    v_accvgpr_write_b32 a59, 0
    v_mfma_f32_16x16x32_bf16 v[236:239], v[48:51], v[120:123], v[236:239]
    buffer_load_dwordx4 v2, s[24:27], s60 offen lds
    v_mfma_f32_16x16x32_bf16 v[236:239], v[52:55], v[124:127], v[236:239]
    ds_read_b64_tr_b16 v[48:49], v27 offset:0
    ds_read_b64_tr_b16 v[50:51], v27 offset:512
    v_mfma_f32_16x16x32_bf16 v[240:243], v[56:59], v[96:99], v[240:243]
    ds_read_b64_tr_b16 v[52:53], v27 offset:4096
    ds_read_b64_tr_b16 v[54:55], v27 offset:4608
    v_mfma_f32_16x16x32_bf16 v[240:243], v[60:63], v[100:103], v[240:243]
    v_add_u32 v27, 0x10000, v27
    v_mfma_f32_16x16x32_bf16 v[244:247], v[56:59], v[104:107], v[244:247]
    buffer_load_dwordx4 v3, s[24:27], s60 offen offset:1024 lds
    v_mfma_f32_16x16x32_bf16 v[244:247], v[60:63], v[108:111], v[244:247]
    v_mfma_f32_16x16x32_bf16 v[248:251], v[56:59], v[112:115], v[248:251]
    v_mfma_f32_16x16x32_bf16 v[248:251], v[60:63], v[116:119], v[248:251]
    v_mfma_f32_16x16x32_bf16 v[252:255], v[56:59], v[120:123], v[252:255]
    buffer_load_dwordx4 v4, s[24:27], s60 offen offset:2048 lds
    v_mfma_f32_16x16x32_bf16 v[252:255], v[60:63], v[124:127], v[252:255]
    s_waitcnt lgkmcnt(0)
    ds_read_b64_tr_b16 v[56:57], v28 offset:0
    ds_read_b64_tr_b16 v[58:59], v28 offset:512
    v_mfma_f32_16x16x32_bf16 a[64:67], v[40:43], v[96:99], a[64:67]
    ds_read_b64_tr_b16 v[60:61], v28 offset:4096
    ds_read_b64_tr_b16 v[62:63], v28 offset:4608
    v_mfma_f32_16x16x32_bf16 a[64:67], v[44:47], v[100:103], a[64:67]
    v_add_u32 v24, 0xfffe0000, v24
    v_add_u32 v28, 0x10000, v28
    v_mfma_f32_16x16x32_bf16 a[68:71], v[40:43], v[104:107], a[68:71]
    buffer_load_dwordx4 v5, s[24:27], s60 offen offset:3072 lds
    v_mfma_f32_16x16x32_bf16 a[68:71], v[44:47], v[108:111], a[68:71]
    ds_read_b128 v[80:83], v24 offset:16384
    v_mfma_f32_16x16x32_bf16 a[72:75], v[40:43], v[112:115], a[72:75]
    v_mfma_f32_16x16x32_bf16 a[72:75], v[44:47], v[116:119], a[72:75]
    s_add_u32 m0, s69, 114688
    v_add_u32 v25, 0xfffe0000, v25
    v_mfma_f32_16x16x32_bf16 a[76:79], v[40:43], v[120:123], a[76:79]
    s_xor_b32 s60, s60, 3670016
    buffer_load_dwordx4 v10, s[20:23], s63 offen lds
    v_mfma_f32_16x16x32_bf16 a[76:79], v[44:47], v[124:127], a[76:79]
    s_add_u32 s72, s70, 1024
    ds_read_b128 v[84:87], v25 offset:16384
    v_mfma_f32_16x16x32_bf16 a[128:131], v[40:43], a[136:139], a[128:131]
    ds_read_b64_tr_b16 v[40:41], v29 offset:0
    ds_read_b64_tr_b16 v[42:43], v29 offset:512
    v_mfma_f32_16x16x32_bf16 a[128:131], v[44:47], a[140:143], a[128:131]
    ds_read_b64_tr_b16 v[44:45], v29 offset:4096
    ds_read_b64_tr_b16 v[46:47], v29 offset:4608
    v_mfma_f32_16x16x32_bf16 a[80:83], v[48:51], v[96:99], a[80:83]
    buffer_load_dwordx4 v11, s[20:23], s63 offen offset:1024 lds
    v_mfma_f32_16x16x32_bf16 a[80:83], v[52:55], v[100:103], a[80:83]
    ds_read_b128 v[88:91], v24 offset:24576
    v_add_u32 v29, 0x10000, v29
    v_mfma_f32_16x16x32_bf16 a[84:87], v[48:51], v[104:107], a[84:87]
    buffer_store_dwordx4 a[4:7], v1, s[36:39], s72 offen sc1
    v_mfma_f32_16x16x32_bf16 a[84:87], v[52:55], v[108:111], a[84:87]
    v_mfma_f32_16x16x32_bf16 a[88:91], v[48:51], v[112:115], a[88:91]
    buffer_load_dwordx4 v12, s[20:23], s63 offen offset:2048 lds
    v_mfma_f32_16x16x32_bf16 a[88:91], v[52:55], v[116:119], a[88:91]
    ds_read_b128 v[92:95], v25 offset:24576
    v_accvgpr_write_b32 a4, 0
    v_mfma_f32_16x16x32_bf16 a[92:95], v[48:51], v[120:123], a[92:95]
    v_accvgpr_write_b32 a5, 0
    v_accvgpr_write_b32 a6, 0
    v_mfma_f32_16x16x32_bf16 a[92:95], v[52:55], v[124:127], a[92:95]
    v_accvgpr_write_b32 a7, 0
    v_mfma_f32_16x16x32_bf16 a[132:135], v[48:51], a[136:139], a[132:135]
    buffer_load_dwordx4 v13, s[20:23], s63 offen offset:3072 lds
    v_mfma_f32_16x16x32_bf16 a[132:135], v[52:55], a[140:143], a[132:135]
    s_waitcnt lgkmcnt(1)
    v_mfma_f32_16x16x32_bf16 a[96:99], v[56:59], v[96:99], a[96:99]
    v_mfma_f32_16x16x32_bf16 a[96:99], v[60:63], v[100:103], a[96:99]
    s_xor_b32 s63, s63, 128
    v_mfma_f32_16x16x32_bf16 a[100:103], v[56:59], v[104:107], a[100:103]
    v_mfma_f32_16x16x32_bf16 a[100:103], v[60:63], v[108:111], a[100:103]
    v_mfma_f32_16x16x32_bf16 a[104:107], v[56:59], v[112:115], a[104:107]
    v_mfma_f32_16x16x32_bf16 a[104:107], v[60:63], v[116:119], a[104:107]
    s_waitcnt vmcnt(10) lgkmcnt(0)
    s_barrier
    ds_read_b64_tr_b16 v[48:49], v14 offset:32768
    v_mfma_f32_16x16x32_bf16 a[108:111], v[56:59], v[120:123], a[108:111]
    s_add_u32 m0, s67, 131072
    ds_read_b64_tr_b16 v[50:51], v14 offset:33792
    ds_read_b64_tr_b16 v[52:53], v14 offset:40960
    v_mfma_f32_16x16x32_bf16 a[108:111], v[60:63], v[124:127], a[108:111]
    buffer_load_dwordx4 v1, s[28:31], s65 offen sc1 lds
    v_mfma_f32_16x16x32_bf16 a[112:115], v[40:43], v[96:99], a[112:115]
    ds_read_b64_tr_b16 v[54:55], v14 offset:41984
    ds_read_b64_tr_b16 v[56:57], v15 offset:32768
    v_mfma_f32_16x16x32_bf16 a[112:115], v[44:47], v[100:103], a[112:115]
    s_add_u32 s72, s70, 5120
    ds_read_b64_tr_b16 v[58:59], v15 offset:33792
    ds_read_b64_tr_b16 v[60:61], v15 offset:40960
    v_mfma_f32_16x16x32_bf16 a[116:119], v[40:43], v[104:107], a[116:119]
    ds_read_b64_tr_b16 v[62:63], v15 offset:41984
    ds_read_b128 a[136:139], v22 offset:0
    v_mfma_f32_16x16x32_bf16 a[116:119], v[44:47], v[108:111], a[116:119]
    ds_read_b128 a[140:143], v23 offset:0
    v_add_u32 v14, 0x10000, v14
    v_mfma_f32_16x16x32_bf16 a[120:123], v[40:43], v[112:115], a[120:123]
    v_add_u32 v15, 0x10000, v15
    v_add_u32 v22, 0x10000, v22
    v_mfma_f32_16x16x32_bf16 a[120:123], v[44:47], v[116:119], a[120:123]
    buffer_store_dwordx4 a[12:15], v1, s[36:39], s72 offen sc1
    v_mfma_f32_16x16x32_bf16 a[124:127], v[40:43], v[120:123], a[124:127]
    buffer_load_dwordx4 v1, s[28:31], s65 offen offset:1024 sc1 lds
    v_mfma_f32_16x16x32_bf16 a[124:127], v[44:47], v[124:127], a[124:127]
    s_waitcnt lgkmcnt(1)
    ds_read_b64_tr_b16 v[40:41], v16 offset:32768
    ds_read_b64_tr_b16 v[42:43], v16 offset:33792
    v_mfma_f32_16x16x32_bf16 v[128:131], v[48:51], v[64:67], v[128:131]
    ds_read_b64_tr_b16 v[44:45], v16 offset:40960
    ds_read_b64_tr_b16 v[46:47], v16 offset:41984
    v_mfma_f32_16x16x32_bf16 v[128:131], v[52:55], v[68:71], v[128:131]
    v_add_u32 v16, 0x10000, v16
    v_add_u32 v23, 0x10000, v23
    v_mfma_f32_16x16x32_bf16 v[132:135], v[48:51], v[72:75], v[132:135]
    ds_read_b128 v[96:99], v24 offset:49152
    v_accvgpr_write_b32 a12, 0
    v_mfma_f32_16x16x32_bf16 v[132:135], v[52:55], v[76:79], v[132:135]
    v_accvgpr_write_b32 a13, 0
    v_accvgpr_write_b32 a14, 0
    v_mfma_f32_16x16x32_bf16 v[136:139], v[48:51], v[80:83], v[136:139]
    v_accvgpr_write_b32 a15, 0
    v_mfma_f32_16x16x32_bf16 v[136:139], v[52:55], v[84:87], v[136:139]
    v_mfma_f32_16x16x32_bf16 v[140:143], v[48:51], v[88:91], v[140:143]
    s_add_u32 m0, s68, 139264
    ds_read_b64_tr_b16 v[48:49], v17 offset:32768
    ds_read_b64_tr_b16 v[50:51], v17 offset:33792
    v_mfma_f32_16x16x32_bf16 v[140:143], v[52:55], v[92:95], v[140:143]
    buffer_load_dwordx4 v6, s[20:23], s66 offen lds
    v_mfma_f32_16x16x32_bf16 v[144:147], v[56:59], v[64:67], v[144:147]
    ds_read_b64_tr_b16 v[52:53], v17 offset:40960
    ds_read_b64_tr_b16 v[54:55], v17 offset:41984
    v_mfma_f32_16x16x32_bf16 v[144:147], v[60:63], v[68:71], v[144:147]
    v_add_u32 v17, 0x10000, v17
    v_mfma_f32_16x16x32_bf16 v[148:151], v[56:59], v[72:75], v[148:151]
    v_mfma_f32_16x16x32_bf16 v[148:151], v[60:63], v[76:79], v[148:151]
    v_mfma_f32_16x16x32_bf16 v[152:155], v[56:59], v[80:83], v[152:155]
    v_mfma_f32_16x16x32_bf16 v[152:155], v[60:63], v[84:87], v[152:155]
    ds_read_b128 v[100:103], v25 offset:49152
    v_mfma_f32_16x16x32_bf16 v[156:159], v[56:59], v[88:91], v[156:159]
    s_add_u32 m0, s69, 147456
    ds_read_b64_tr_b16 v[56:57], v18 offset:32768
    ds_read_b64_tr_b16 v[58:59], v18 offset:33792
    v_mfma_f32_16x16x32_bf16 v[156:159], v[60:63], v[92:95], v[156:159]
    s_xor_b32 s65, s65, 57344
    buffer_load_dwordx4 v10, s[20:23], s64 offen lds
    s_waitcnt lgkmcnt(3)
    v_mfma_f32_16x16x32_bf16 v[160:163], v[40:43], v[64:67], v[160:163]
    s_xor_b32 s66, s66, 896
    ds_read_b64_tr_b16 v[60:61], v18 offset:40960
    ds_read_b64_tr_b16 v[62:63], v18 offset:41984
    v_mfma_f32_16x16x32_bf16 v[160:163], v[44:47], v[68:71], v[160:163]
    s_add_u32 s72, s70, 9216
    buffer_store_dwordx4 a[20:23], v1, s[36:39], s72 offen sc1
    v_mfma_f32_16x16x32_bf16 v[164:167], v[40:43], v[72:75], v[164:167]
    v_add_u32 v18, 0x10000, v18
    v_accvgpr_write_b32 a20, 0
    v_mfma_f32_16x16x32_bf16 v[164:167], v[44:47], v[76:79], v[164:167]
    v_accvgpr_write_b32 a21, 0
    v_accvgpr_write_b32 a22, 0
    v_mfma_f32_16x16x32_bf16 v[168:171], v[40:43], v[80:83], v[168:171]
    v_accvgpr_write_b32 a23, 0
    v_mfma_f32_16x16x32_bf16 v[168:171], v[44:47], v[84:87], v[168:171]
    v_mfma_f32_16x16x32_bf16 v[172:175], v[40:43], v[88:91], v[172:175]
    ds_read_b64_tr_b16 v[40:41], v19 offset:32768
    ds_read_b64_tr_b16 v[42:43], v19 offset:33792
    v_mfma_f32_16x16x32_bf16 v[172:175], v[44:47], v[92:95], v[172:175]
    ds_read_b64_tr_b16 v[44:45], v19 offset:40960
    ds_read_b64_tr_b16 v[46:47], v19 offset:41984
    v_mfma_f32_16x16x32_bf16 v[176:179], v[48:51], v[64:67], v[176:179]
    buffer_load_dwordx4 v11, s[20:23], s64 offen offset:1024 lds
    v_mfma_f32_16x16x32_bf16 v[176:179], v[52:55], v[68:71], v[176:179]
    ds_read_b128 v[104:107], v24 offset:57344
    v_add_u32 v19, 0x10000, v19
    v_mfma_f32_16x16x32_bf16 v[180:183], v[48:51], v[72:75], v[180:183]
    v_mfma_f32_16x16x32_bf16 v[180:183], v[52:55], v[76:79], v[180:183]
    v_mfma_f32_16x16x32_bf16 v[184:187], v[48:51], v[80:83], v[184:187]
    v_mfma_f32_16x16x32_bf16 v[184:187], v[52:55], v[84:87], v[184:187]
    v_mfma_f32_16x16x32_bf16 v[188:191], v[48:51], v[88:91], v[188:191]
    ds_read_b64_tr_b16 v[48:49], v20 offset:32768
    ds_read_b64_tr_b16 v[50:51], v20 offset:33792
    v_mfma_f32_16x16x32_bf16 v[188:191], v[52:55], v[92:95], v[188:191]
    s_waitcnt lgkmcnt(2)
    ds_read_b64_tr_b16 v[52:53], v20 offset:40960
    ds_read_b64_tr_b16 v[54:55], v20 offset:41984
    v_mfma_f32_16x16x32_bf16 v[192:195], v[56:59], v[64:67], v[192:195]
    buffer_load_dwordx4 v12, s[20:23], s64 offen offset:2048 lds
    v_mfma_f32_16x16x32_bf16 v[192:195], v[60:63], v[68:71], v[192:195]
    v_add_u32 v20, 0x10000, v20
    v_mfma_f32_16x16x32_bf16 v[196:199], v[56:59], v[72:75], v[196:199]
    v_mfma_f32_16x16x32_bf16 v[196:199], v[60:63], v[76:79], v[196:199]
    ds_read_b128 v[108:111], v25 offset:57344
    v_mfma_f32_16x16x32_bf16 v[200:203], v[56:59], v[80:83], v[200:203]
    v_mfma_f32_16x16x32_bf16 v[200:203], v[60:63], v[84:87], v[200:203]
    s_add_u32 s72, s70, 13312
    v_mfma_f32_16x16x32_bf16 v[204:207], v[56:59], v[88:91], v[204:207]
    ds_read_b64_tr_b16 v[56:57], v21 offset:32768
    ds_read_b64_tr_b16 v[58:59], v21 offset:33792
    v_mfma_f32_16x16x32_bf16 v[204:207], v[60:63], v[92:95], v[204:207]
    ds_read_b64_tr_b16 v[60:61], v21 offset:40960
    ds_read_b64_tr_b16 v[62:63], v21 offset:41984
    v_mfma_f32_16x16x32_bf16 v[208:211], v[40:43], v[64:67], v[208:211]
    buffer_store_dwordx4 a[28:31], v1, s[36:39], s72 offen sc1
    v_mfma_f32_16x16x32_bf16 v[208:211], v[44:47], v[68:71], v[208:211]
    buffer_load_dwordx4 v13, s[20:23], s64 offen offset:3072 lds
    v_mfma_f32_16x16x32_bf16 v[212:215], v[40:43], v[72:75], v[212:215]
    v_add_u32 v21, 0x10000, v21
    v_accvgpr_write_b32 a28, 0
    v_mfma_f32_16x16x32_bf16 v[212:215], v[44:47], v[76:79], v[212:215]
    v_accvgpr_write_b32 a29, 0
    v_accvgpr_write_b32 a30, 0
    v_mfma_f32_16x16x32_bf16 v[216:219], v[40:43], v[80:83], v[216:219]
    v_accvgpr_write_b32 a31, 0
    v_mfma_f32_16x16x32_bf16 v[216:219], v[44:47], v[84:87], v[216:219]
    v_mfma_f32_16x16x32_bf16 v[220:223], v[40:43], v[88:91], v[220:223]
    ds_read_b64_tr_b16 v[40:41], v26 offset:0
    ds_read_b64_tr_b16 v[42:43], v26 offset:512
    v_mfma_f32_16x16x32_bf16 v[220:223], v[44:47], v[92:95], v[220:223]
    s_waitcnt lgkmcnt(2)
    ds_read_b64_tr_b16 v[44:45], v26 offset:4096
    ds_read_b64_tr_b16 v[46:47], v26 offset:4608
    v_mfma_f32_16x16x32_bf16 v[224:227], v[48:51], v[64:67], v[224:227]
    v_add_u32 v26, 0x10000, v26
    v_mfma_f32_16x16x32_bf16 v[224:227], v[52:55], v[68:71], v[224:227]
    s_xor_b32 s64, s64, 128
    v_mfma_f32_16x16x32_bf16 v[228:231], v[48:51], v[72:75], v[228:231]
    v_mfma_f32_16x16x32_bf16 v[228:231], v[52:55], v[76:79], v[228:231]
    v_mfma_f32_16x16x32_bf16 v[232:235], v[48:51], v[80:83], v[232:235]
    v_mfma_f32_16x16x32_bf16 v[232:235], v[52:55], v[84:87], v[232:235]
    s_add_u32 m0, s69, 0
    v_mfma_f32_16x16x32_bf16 v[236:239], v[48:51], v[88:91], v[236:239]
    buffer_load_dwordx4 v2, s[24:27], s60 offen lds
    v_mfma_f32_16x16x32_bf16 v[236:239], v[52:55], v[92:95], v[236:239]
    ds_read_b64_tr_b16 v[48:49], v27 offset:0
    ds_read_b64_tr_b16 v[50:51], v27 offset:512
    v_mfma_f32_16x16x32_bf16 v[240:243], v[56:59], v[64:67], v[240:243]
    ds_read_b64_tr_b16 v[52:53], v27 offset:4096
    ds_read_b64_tr_b16 v[54:55], v27 offset:4608
    v_mfma_f32_16x16x32_bf16 v[240:243], v[60:63], v[68:71], v[240:243]
    v_add_u32 v27, 0x10000, v27
    v_mfma_f32_16x16x32_bf16 v[244:247], v[56:59], v[72:75], v[244:247]
    buffer_load_dwordx4 v3, s[24:27], s60 offen offset:1024 lds
    v_mfma_f32_16x16x32_bf16 v[244:247], v[60:63], v[76:79], v[244:247]
    s_add_u32 s72, s70, 33792
    v_mfma_f32_16x16x32_bf16 v[248:251], v[56:59], v[80:83], v[248:251]
    buffer_store_dwordx4 a[36:39], v1, s[36:39], s72 offen sc1
    v_mfma_f32_16x16x32_bf16 v[248:251], v[60:63], v[84:87], v[248:251]
    v_mfma_f32_16x16x32_bf16 v[252:255], v[56:59], v[88:91], v[252:255]
    buffer_load_dwordx4 v4, s[24:27], s60 offen offset:2048 lds
    v_mfma_f32_16x16x32_bf16 v[252:255], v[60:63], v[92:95], v[252:255]
    s_waitcnt lgkmcnt(0)
    ds_read_b64_tr_b16 v[56:57], v28 offset:0
    ds_read_b64_tr_b16 v[58:59], v28 offset:512
    v_mfma_f32_16x16x32_bf16 a[64:67], v[40:43], v[64:67], a[64:67]
    ds_read_b64_tr_b16 v[60:61], v28 offset:4096
    ds_read_b64_tr_b16 v[62:63], v28 offset:4608
    v_mfma_f32_16x16x32_bf16 a[64:67], v[44:47], v[68:71], a[64:67]
    v_add_u32 v24, 0x10000, v24
    v_add_u32 v28, 0x10000, v28
    v_mfma_f32_16x16x32_bf16 a[68:71], v[40:43], v[72:75], a[68:71]
    buffer_load_dwordx4 v5, s[24:27], s60 offen offset:3072 lds
    v_mfma_f32_16x16x32_bf16 a[68:71], v[44:47], v[76:79], a[68:71]
    ds_read_b128 v[112:115], v24 offset:16384
    v_accvgpr_write_b32 a36, 0
    v_mfma_f32_16x16x32_bf16 a[72:75], v[40:43], v[80:83], a[72:75]
    v_accvgpr_write_b32 a37, 0
    v_accvgpr_write_b32 a38, 0
    v_mfma_f32_16x16x32_bf16 a[72:75], v[44:47], v[84:87], a[72:75]
    s_add_u32 m0, s69, 16384
    v_add_u32 v25, 0x10000, v25
    v_accvgpr_write_b32 a39, 0
    v_mfma_f32_16x16x32_bf16 a[76:79], v[40:43], v[88:91], a[76:79]
    s_xor_b32 s60, s60, 524288
    buffer_load_dwordx4 v10, s[20:23], s63 offen lds
    v_mfma_f32_16x16x32_bf16 a[76:79], v[44:47], v[92:95], a[76:79]
    ds_read_b128 v[116:119], v25 offset:16384
    v_mfma_f32_16x16x32_bf16 a[128:131], v[40:43], a[136:139], a[128:131]
    ds_read_b64_tr_b16 v[40:41], v29 offset:0
    ds_read_b64_tr_b16 v[42:43], v29 offset:512
    v_mfma_f32_16x16x32_bf16 a[128:131], v[44:47], a[140:143], a[128:131]
    ds_read_b64_tr_b16 v[44:45], v29 offset:4096
    ds_read_b64_tr_b16 v[46:47], v29 offset:4608
    v_mfma_f32_16x16x32_bf16 a[80:83], v[48:51], v[64:67], a[80:83]
    buffer_load_dwordx4 v11, s[20:23], s63 offen offset:1024 lds
    v_mfma_f32_16x16x32_bf16 a[80:83], v[52:55], v[68:71], a[80:83]
    ds_read_b128 v[120:123], v24 offset:24576
    v_add_u32 v29, 0x10000, v29
    v_mfma_f32_16x16x32_bf16 a[84:87], v[48:51], v[72:75], a[84:87]
    v_mfma_f32_16x16x32_bf16 a[84:87], v[52:55], v[76:79], a[84:87]
    v_mfma_f32_16x16x32_bf16 a[88:91], v[48:51], v[80:83], a[88:91]
    buffer_load_dwordx4 v12, s[20:23], s63 offen offset:2048 lds
    v_mfma_f32_16x16x32_bf16 a[88:91], v[52:55], v[84:87], a[88:91]
    ds_read_b128 v[124:127], v25 offset:24576
    v_mfma_f32_16x16x32_bf16 a[92:95], v[48:51], v[88:91], a[92:95]
    v_mfma_f32_16x16x32_bf16 a[92:95], v[52:55], v[92:95], a[92:95]
    s_add_u32 s72, s70, 37888
    v_mfma_f32_16x16x32_bf16 a[132:135], v[48:51], a[136:139], a[132:135]
    buffer_load_dwordx4 v13, s[20:23], s63 offen offset:3072 lds
    v_mfma_f32_16x16x32_bf16 a[132:135], v[52:55], a[140:143], a[132:135]
    s_waitcnt lgkmcnt(1)
    v_mfma_f32_16x16x32_bf16 a[96:99], v[56:59], v[64:67], a[96:99]
    v_mfma_f32_16x16x32_bf16 a[96:99], v[60:63], v[68:71], a[96:99]
    s_xor_b32 s63, s63, 384
    v_mfma_f32_16x16x32_bf16 a[100:103], v[56:59], v[72:75], a[100:103]
    buffer_store_dwordx4 a[44:47], v1, s[36:39], s72 offen sc1
    v_mfma_f32_16x16x32_bf16 a[100:103], v[60:63], v[76:79], a[100:103]
    v_mfma_f32_16x16x32_bf16 a[104:107], v[56:59], v[80:83], a[104:107]
    v_accvgpr_write_b32 a44, 0
    v_accvgpr_write_b32 a45, 0
    v_mfma_f32_16x16x32_bf16 a[104:107], v[60:63], v[84:87], a[104:107]
    s_waitcnt vmcnt(10) lgkmcnt(0)
    s_barrier
    ds_read_b64_tr_b16 v[48:49], v14 offset:32768
    v_mfma_f32_16x16x32_bf16 a[108:111], v[56:59], v[88:91], a[108:111]
    s_add_u32 m0, s67, 32768
    ds_read_b64_tr_b16 v[50:51], v14 offset:33792
    ds_read_b64_tr_b16 v[52:53], v14 offset:40960
    v_mfma_f32_16x16x32_bf16 a[108:111], v[60:63], v[92:95], a[108:111]
    buffer_load_dwordx4 v1, s[28:31], s65 offen sc1 lds
    v_mfma_f32_16x16x32_bf16 a[112:115], v[40:43], v[64:67], a[112:115]
    ds_read_b64_tr_b16 v[54:55], v14 offset:41984
    ds_read_b64_tr_b16 v[56:57], v15 offset:32768
    v_mfma_f32_16x16x32_bf16 a[112:115], v[44:47], v[68:71], a[112:115]
    ds_read_b64_tr_b16 v[58:59], v15 offset:33792
    ds_read_b64_tr_b16 v[60:61], v15 offset:40960
    v_mfma_f32_16x16x32_bf16 a[116:119], v[40:43], v[72:75], a[116:119]
    ds_read_b64_tr_b16 v[62:63], v15 offset:41984
    ds_read_b128 a[136:139], v22 offset:0
    v_mfma_f32_16x16x32_bf16 a[116:119], v[44:47], v[76:79], a[116:119]
    ds_read_b128 a[140:143], v23 offset:0
    v_add_u32 v14, 0xffff0000, v14
    v_mfma_f32_16x16x32_bf16 a[120:123], v[40:43], v[80:83], a[120:123]
    v_add_u32 v15, 0xffff0000, v15
    v_add_u32 v22, 0xfffe0000, v22
    v_mfma_f32_16x16x32_bf16 a[120:123], v[44:47], v[84:87], a[120:123]
    v_add_u32 v23, 0xfffe0000, v23
    v_accvgpr_write_b32 a46, 0
    v_mfma_f32_16x16x32_bf16 a[124:127], v[40:43], v[88:91], a[124:127]
    buffer_load_dwordx4 v1, s[28:31], s65 offen offset:1024 sc1 lds
    v_mfma_f32_16x16x32_bf16 a[124:127], v[44:47], v[92:95], a[124:127]
    s_waitcnt lgkmcnt(1)
    ds_read_b64_tr_b16 v[40:41], v16 offset:32768
    ds_read_b64_tr_b16 v[42:43], v16 offset:33792
    v_mfma_f32_16x16x32_bf16 v[128:131], v[48:51], v[96:99], v[128:131]
    ds_read_b64_tr_b16 v[44:45], v16 offset:40960
    ds_read_b64_tr_b16 v[46:47], v16 offset:41984
    v_mfma_f32_16x16x32_bf16 v[128:131], v[52:55], v[100:103], v[128:131]
    v_add_u32 v16, 0xffff0000, v16
    v_accvgpr_write_b32 a47, 0
    v_mfma_f32_16x16x32_bf16 v[132:135], v[48:51], v[104:107], v[132:135]
    ds_read_b128 v[64:67], v24 offset:49152
    v_mfma_f32_16x16x32_bf16 v[132:135], v[52:55], v[108:111], v[132:135]
    s_add_u32 s72, s70, 41984
    v_mfma_f32_16x16x32_bf16 v[136:139], v[48:51], v[112:115], v[136:139]
    buffer_store_dwordx4 a[52:55], v1, s[36:39], s72 offen sc1
    v_mfma_f32_16x16x32_bf16 v[136:139], v[52:55], v[116:119], v[136:139]
    v_mfma_f32_16x16x32_bf16 v[140:143], v[48:51], v[120:123], v[140:143]
    s_add_u32 m0, s68, 40960
    ds_read_b64_tr_b16 v[48:49], v17 offset:32768
    ds_read_b64_tr_b16 v[50:51], v17 offset:33792
    v_mfma_f32_16x16x32_bf16 v[140:143], v[52:55], v[124:127], v[140:143]
    buffer_load_dwordx4 v6, s[20:23], s66 offen lds
    v_mfma_f32_16x16x32_bf16 v[144:147], v[56:59], v[96:99], v[144:147]
    ds_read_b64_tr_b16 v[52:53], v17 offset:40960
    ds_read_b64_tr_b16 v[54:55], v17 offset:41984
    v_mfma_f32_16x16x32_bf16 v[144:147], v[60:63], v[100:103], v[144:147]
    v_add_u32 v17, 0xffff0000, v17
    v_accvgpr_write_b32 a52, 0
    v_mfma_f32_16x16x32_bf16 v[148:151], v[56:59], v[104:107], v[148:151]
    v_accvgpr_write_b32 a53, 0
    v_accvgpr_write_b32 a54, 0
    v_mfma_f32_16x16x32_bf16 v[148:151], v[60:63], v[108:111], v[148:151]
    v_accvgpr_write_b32 a55, 0
    v_mfma_f32_16x16x32_bf16 v[152:155], v[56:59], v[112:115], v[152:155]
    v_mfma_f32_16x16x32_bf16 v[152:155], v[60:63], v[116:119], v[152:155]
    ds_read_b128 v[68:71], v25 offset:49152
    v_mfma_f32_16x16x32_bf16 v[156:159], v[56:59], v[120:123], v[156:159]
    s_add_u32 m0, s69, 49152
    ds_read_b64_tr_b16 v[56:57], v18 offset:32768
    ds_read_b64_tr_b16 v[58:59], v18 offset:33792
    v_mfma_f32_16x16x32_bf16 v[156:159], v[60:63], v[124:127], v[156:159]
    s_xor_b32 s65, s65, 8192
    buffer_load_dwordx4 v10, s[20:23], s64 offen lds
    s_waitcnt lgkmcnt(3)
    v_mfma_f32_16x16x32_bf16 v[160:163], v[40:43], v[96:99], v[160:163]
    s_xor_b32 s66, s66, 128
    ds_read_b64_tr_b16 v[60:61], v18 offset:40960
    ds_read_b64_tr_b16 v[62:63], v18 offset:41984
    v_mfma_f32_16x16x32_bf16 v[160:163], v[44:47], v[100:103], v[160:163]
    v_add_u32 v18, 0xffff0000, v18
    v_mfma_f32_16x16x32_bf16 v[164:167], v[40:43], v[104:107], v[164:167]
    v_mfma_f32_16x16x32_bf16 v[164:167], v[44:47], v[108:111], v[164:167]
    v_mfma_f32_16x16x32_bf16 v[168:171], v[40:43], v[112:115], v[168:171]
    v_mfma_f32_16x16x32_bf16 v[168:171], v[44:47], v[116:119], v[168:171]
    v_mfma_f32_16x16x32_bf16 v[172:175], v[40:43], v[120:123], v[172:175]
    ds_read_b64_tr_b16 v[40:41], v19 offset:32768
    ds_read_b64_tr_b16 v[42:43], v19 offset:33792
    v_mfma_f32_16x16x32_bf16 v[172:175], v[44:47], v[124:127], v[172:175]
    ds_read_b64_tr_b16 v[44:45], v19 offset:40960
    ds_read_b64_tr_b16 v[46:47], v19 offset:41984
    v_mfma_f32_16x16x32_bf16 v[176:179], v[48:51], v[96:99], v[176:179]
    buffer_load_dwordx4 v11, s[20:23], s64 offen offset:1024 lds
    v_mfma_f32_16x16x32_bf16 v[176:179], v[52:55], v[100:103], v[176:179]
    s_add_u32 s72, s70, 46080
    ds_read_b128 v[72:75], v24 offset:57344
    v_add_u32 v19, 0xffff0000, v19
    v_mfma_f32_16x16x32_bf16 v[180:183], v[48:51], v[104:107], v[180:183]
    buffer_store_dwordx4 a[60:63], v1, s[36:39], s72 offen sc1
    v_mfma_f32_16x16x32_bf16 v[180:183], v[52:55], v[108:111], v[180:183]
    v_mfma_f32_16x16x32_bf16 v[184:187], v[48:51], v[112:115], v[184:187]
    v_accvgpr_write_b32 a60, 0
    v_accvgpr_write_b32 a61, 0
    v_mfma_f32_16x16x32_bf16 v[184:187], v[52:55], v[116:119], v[184:187]
    v_accvgpr_write_b32 a62, 0
    v_accvgpr_write_b32 a63, 0
    v_mfma_f32_16x16x32_bf16 v[188:191], v[48:51], v[120:123], v[188:191]
    ds_read_b64_tr_b16 v[48:49], v20 offset:32768
    ds_read_b64_tr_b16 v[50:51], v20 offset:33792
    v_mfma_f32_16x16x32_bf16 v[188:191], v[52:55], v[124:127], v[188:191]
    s_waitcnt lgkmcnt(2)
    ds_read_b64_tr_b16 v[52:53], v20 offset:40960
    ds_read_b64_tr_b16 v[54:55], v20 offset:41984
    v_mfma_f32_16x16x32_bf16 v[192:195], v[56:59], v[96:99], v[192:195]
    buffer_load_dwordx4 v12, s[20:23], s64 offen offset:2048 lds
    v_mfma_f32_16x16x32_bf16 v[192:195], v[60:63], v[100:103], v[192:195]
    v_add_u32 v20, 0xffff0000, v20
    v_mfma_f32_16x16x32_bf16 v[196:199], v[56:59], v[104:107], v[196:199]
    v_mfma_f32_16x16x32_bf16 v[196:199], v[60:63], v[108:111], v[196:199]
    ds_read_b128 v[76:79], v25 offset:57344
    v_mfma_f32_16x16x32_bf16 v[200:203], v[56:59], v[112:115], v[200:203]
    v_mfma_f32_16x16x32_bf16 v[200:203], v[60:63], v[116:119], v[200:203]
    v_mfma_f32_16x16x32_bf16 v[204:207], v[56:59], v[120:123], v[204:207]
    ds_read_b64_tr_b16 v[56:57], v21 offset:32768
    ds_read_b64_tr_b16 v[58:59], v21 offset:33792
    v_mfma_f32_16x16x32_bf16 v[204:207], v[60:63], v[124:127], v[204:207]
    ds_read_b64_tr_b16 v[60:61], v21 offset:40960
    ds_read_b64_tr_b16 v[62:63], v21 offset:41984
    v_mfma_f32_16x16x32_bf16 v[208:211], v[40:43], v[96:99], v[208:211]
    v_add_u32 v21, 0xffff0000, v21
    v_accvgpr_read_b32 v32, a144
    v_mfma_f32_16x16x32_bf16 v[208:211], v[44:47], v[100:103], v[208:211]
    buffer_load_dwordx4 v13, s[20:23], s64 offen offset:3072 lds
    v_mfma_f32_16x16x32_bf16 v[212:215], v[40:43], v[104:107], v[212:215]
    v_accvgpr_read_b32 v31, a145
    v_cvt_pk_bf16_f32 v32, v32, v31
    v_mfma_f32_16x16x32_bf16 v[212:215], v[44:47], v[108:111], v[212:215]
    v_accvgpr_read_b32 v33, a146
    v_accvgpr_read_b32 v31, a147
    v_mfma_f32_16x16x32_bf16 v[216:219], v[40:43], v[112:115], v[216:219]
    v_cvt_pk_bf16_f32 v33, v33, v31
    v_accvgpr_read_b32 v34, a148
    v_mfma_f32_16x16x32_bf16 v[216:219], v[44:47], v[116:119], v[216:219]
    v_accvgpr_read_b32 v31, a149
    v_cvt_pk_bf16_f32 v34, v34, v31
    v_mfma_f32_16x16x32_bf16 v[220:223], v[40:43], v[120:123], v[220:223]
    ds_read_b64_tr_b16 v[40:41], v26 offset:0
    ds_read_b64_tr_b16 v[42:43], v26 offset:512
    v_mfma_f32_16x16x32_bf16 v[220:223], v[44:47], v[124:127], v[220:223]
    s_add_u32 s72, s71, 32768
    ds_read_b64_tr_b16 v[44:45], v26 offset:4096
    ds_read_b64_tr_b16 v[46:47], v26 offset:4608
    s_waitcnt lgkmcnt(4)
    v_mfma_f32_16x16x32_bf16 v[224:227], v[48:51], v[96:99], v[224:227]
    v_add_u32 v26, 0xfffe0000, v26
    v_accvgpr_read_b32 v35, a150
    v_mfma_f32_16x16x32_bf16 v[224:227], v[52:55], v[100:103], v[224:227]
    s_xor_b32 s64, s64, 384
    v_accvgpr_read_b32 v31, a151
    v_cvt_pk_bf16_f32 v35, v35, v31
    v_mfma_f32_16x16x32_bf16 v[228:231], v[48:51], v[104:107], v[228:231]
    buffer_store_dwordx4 v[32:35], v1, s[36:39], s72 offen sc1
    v_mfma_f32_16x16x32_bf16 v[228:231], v[52:55], v[108:111], v[228:231]
    v_accvgpr_write_b32 a144, 0
    v_accvgpr_write_b32 a145, 0
    v_mfma_f32_16x16x32_bf16 v[232:235], v[48:51], v[112:115], v[232:235]
    v_accvgpr_write_b32 a146, 0
    v_accvgpr_write_b32 a147, 0
    v_mfma_f32_16x16x32_bf16 v[232:235], v[52:55], v[116:119], v[232:235]
    s_add_u32 m0, s69, 65536
    v_accvgpr_write_b32 a148, 0
    v_accvgpr_write_b32 a149, 0
    v_mfma_f32_16x16x32_bf16 v[236:239], v[48:51], v[120:123], v[236:239]
    buffer_load_dwordx4 v2, s[24:27], s60 offen lds
    v_mfma_f32_16x16x32_bf16 v[236:239], v[52:55], v[124:127], v[236:239]
    ds_read_b64_tr_b16 v[48:49], v27 offset:0
    ds_read_b64_tr_b16 v[50:51], v27 offset:512
    v_mfma_f32_16x16x32_bf16 v[240:243], v[56:59], v[96:99], v[240:243]
    ds_read_b64_tr_b16 v[52:53], v27 offset:4096
    ds_read_b64_tr_b16 v[54:55], v27 offset:4608
    v_mfma_f32_16x16x32_bf16 v[240:243], v[60:63], v[100:103], v[240:243]
    v_add_u32 v27, 0xfffe0000, v27
    v_accvgpr_write_b32 a150, 0
    v_mfma_f32_16x16x32_bf16 v[244:247], v[56:59], v[104:107], v[244:247]
    buffer_load_dwordx4 v3, s[24:27], s60 offen offset:1024 lds
    v_mfma_f32_16x16x32_bf16 v[244:247], v[60:63], v[108:111], v[244:247]
    v_accvgpr_write_b32 a151, 0
    v_mfma_f32_16x16x32_bf16 v[248:251], v[56:59], v[112:115], v[248:251]
    v_accvgpr_read_b32 v32, a152
    v_accvgpr_read_b32 v31, a153
    v_mfma_f32_16x16x32_bf16 v[248:251], v[60:63], v[116:119], v[248:251]
    v_cvt_pk_bf16_f32 v32, v32, v31
    v_accvgpr_read_b32 v33, a154
    v_mfma_f32_16x16x32_bf16 v[252:255], v[56:59], v[120:123], v[252:255]
    buffer_load_dwordx4 v4, s[24:27], s60 offen offset:2048 lds
    v_mfma_f32_16x16x32_bf16 v[252:255], v[60:63], v[124:127], v[252:255]
    s_waitcnt lgkmcnt(0)
    ds_read_b64_tr_b16 v[56:57], v28 offset:0
    ds_read_b64_tr_b16 v[58:59], v28 offset:512
    v_mfma_f32_16x16x32_bf16 a[64:67], v[40:43], v[96:99], a[64:67]
    ds_read_b64_tr_b16 v[60:61], v28 offset:4096
    ds_read_b64_tr_b16 v[62:63], v28 offset:4608
    v_mfma_f32_16x16x32_bf16 a[64:67], v[44:47], v[100:103], a[64:67]
    v_add_u32 v24, 0x10000, v24
    v_add_u32 v28, 0xfffe0000, v28
    v_mfma_f32_16x16x32_bf16 a[68:71], v[40:43], v[104:107], a[68:71]
    buffer_load_dwordx4 v5, s[24:27], s60 offen offset:3072 lds
    v_mfma_f32_16x16x32_bf16 a[68:71], v[44:47], v[108:111], a[68:71]
    ds_read_b128 v[80:83], v24 offset:16384
    v_accvgpr_read_b32 v31, a155
    v_mfma_f32_16x16x32_bf16 a[72:75], v[40:43], v[112:115], a[72:75]
    v_cvt_pk_bf16_f32 v33, v33, v31
    v_accvgpr_read_b32 v34, a156
    v_mfma_f32_16x16x32_bf16 a[72:75], v[44:47], v[116:119], a[72:75]
    s_add_u32 m0, s69, 81920
    v_add_u32 v25, 0x10000, v25
    v_accvgpr_read_b32 v31, a157
    v_mfma_f32_16x16x32_bf16 a[76:79], v[40:43], v[120:123], a[76:79]
    s_xor_b32 s60, s60, 1572864
    buffer_load_dwordx4 v10, s[20:23], s63 offen lds
    v_mfma_f32_16x16x32_bf16 a[76:79], v[44:47], v[124:127], a[76:79]
    s_add_u32 s72, s71, 33792
    ds_read_b128 v[84:87], v25 offset:16384
    v_cvt_pk_bf16_f32 v34, v34, v31
    v_mfma_f32_16x16x32_bf16 a[128:131], v[40:43], a[136:139], a[128:131]
    ds_read_b64_tr_b16 v[40:41], v29 offset:0
    ds_read_b64_tr_b16 v[42:43], v29 offset:512
    v_mfma_f32_16x16x32_bf16 a[128:131], v[44:47], a[140:143], a[128:131]
    ds_read_b64_tr_b16 v[44:45], v29 offset:4096
    ds_read_b64_tr_b16 v[46:47], v29 offset:4608
    v_mfma_f32_16x16x32_bf16 a[80:83], v[48:51], v[96:99], a[80:83]
    buffer_load_dwordx4 v11, s[20:23], s63 offen offset:1024 lds
    v_mfma_f32_16x16x32_bf16 a[80:83], v[52:55], v[100:103], a[80:83]
    ds_read_b128 v[88:91], v24 offset:24576
    v_add_u32 v29, 0xfffe0000, v29
    v_mfma_f32_16x16x32_bf16 a[84:87], v[48:51], v[104:107], a[84:87]
    v_accvgpr_read_b32 v35, a158
    v_accvgpr_read_b32 v31, a159
    v_mfma_f32_16x16x32_bf16 a[84:87], v[52:55], v[108:111], a[84:87]
    v_cvt_pk_bf16_f32 v35, v35, v31
    v_accvgpr_write_b32 a152, 0
    v_mfma_f32_16x16x32_bf16 a[88:91], v[48:51], v[112:115], a[88:91]
    buffer_load_dwordx4 v12, s[20:23], s63 offen offset:2048 lds
    v_mfma_f32_16x16x32_bf16 a[88:91], v[52:55], v[116:119], a[88:91]
    ds_read_b128 v[92:95], v25 offset:24576
    v_accvgpr_write_b32 a153, 0
    v_mfma_f32_16x16x32_bf16 a[92:95], v[48:51], v[120:123], a[92:95]
    buffer_store_dwordx4 v[32:35], v1, s[36:39], s72 offen sc1
    v_mfma_f32_16x16x32_bf16 a[92:95], v[52:55], v[124:127], a[92:95]
    v_accvgpr_write_b32 a154, 0
    v_accvgpr_write_b32 a155, 0
    v_mfma_f32_16x16x32_bf16 a[132:135], v[48:51], a[136:139], a[132:135]
    buffer_load_dwordx4 v13, s[20:23], s63 offen offset:3072 lds
    v_mfma_f32_16x16x32_bf16 a[132:135], v[52:55], a[140:143], a[132:135]
    s_waitcnt lgkmcnt(1)
    v_accvgpr_read_b32 v32, a160
    v_accvgpr_read_b32 v31, a161
    v_mfma_f32_16x16x32_bf16 a[96:99], v[56:59], v[96:99], a[96:99]
    v_cvt_pk_bf16_f32 v32, v32, v31
    v_accvgpr_read_b32 v33, a162
    v_mfma_f32_16x16x32_bf16 a[96:99], v[60:63], v[100:103], a[96:99]
    s_xor_b32 s63, s63, 128
    v_accvgpr_read_b32 v31, a163
    v_cvt_pk_bf16_f32 v33, v33, v31
    v_mfma_f32_16x16x32_bf16 a[100:103], v[56:59], v[104:107], a[100:103]
    v_accvgpr_read_b32 v34, a164
    v_accvgpr_read_b32 v31, a165
    v_mfma_f32_16x16x32_bf16 a[100:103], v[60:63], v[108:111], a[100:103]
    v_cvt_pk_bf16_f32 v34, v34, v31
    v_accvgpr_read_b32 v35, a166
    v_mfma_f32_16x16x32_bf16 a[104:107], v[56:59], v[112:115], a[104:107]
    v_accvgpr_read_b32 v31, a167
    v_cvt_pk_bf16_f32 v35, v35, v31
    v_mfma_f32_16x16x32_bf16 a[104:107], v[60:63], v[116:119], a[104:107]
    s_waitcnt vmcnt(10) lgkmcnt(0)
    s_barrier
    ds_read_b64_tr_b16 v[48:49], v14 offset:0
    v_mfma_f32_16x16x32_bf16 a[108:111], v[56:59], v[120:123], a[108:111]
    s_add_u32 m0, s67, 98304
    ds_read_b64_tr_b16 v[50:51], v14 offset:1024
    ds_read_b64_tr_b16 v[52:53], v14 offset:8192
    v_mfma_f32_16x16x32_bf16 a[108:111], v[60:63], v[124:127], a[108:111]
    s_add_u32 s72, s71, 2048
    buffer_load_dwordx4 v1, s[28:31], s65 offen sc1 lds
    v_mfma_f32_16x16x32_bf16 a[112:115], v[40:43], v[96:99], a[112:115]
    ds_read_b64_tr_b16 v[54:55], v14 offset:9216
    ds_read_b64_tr_b16 v[56:57], v15 offset:0
    v_mfma_f32_16x16x32_bf16 a[112:115], v[44:47], v[100:103], a[112:115]
    ds_read_b64_tr_b16 v[58:59], v15 offset:1024
    ds_read_b64_tr_b16 v[60:61], v15 offset:8192
    v_mfma_f32_16x16x32_bf16 a[116:119], v[40:43], v[104:107], a[116:119]
    ds_read_b64_tr_b16 v[62:63], v15 offset:9216
    ds_read_b128 a[136:139], v22 offset:32768
    v_mfma_f32_16x16x32_bf16 a[116:119], v[44:47], v[108:111], a[116:119]
    ds_read_b128 a[140:143], v23 offset:32768
    v_add_u32 v14, 0x10000, v14
    v_mfma_f32_16x16x32_bf16 a[120:123], v[40:43], v[112:115], a[120:123]
    v_add_u32 v15, 0x10000, v15
    v_add_u32 v22, 0x10000, v22
    v_mfma_f32_16x16x32_bf16 a[120:123], v[44:47], v[116:119], a[120:123]
    v_add_u32 v23, 0x10000, v23
    v_accvgpr_write_b32 a156, 0
    v_mfma_f32_16x16x32_bf16 a[124:127], v[40:43], v[120:123], a[124:127]
    buffer_load_dwordx4 v1, s[28:31], s65 offen offset:1024 sc1 lds
    v_mfma_f32_16x16x32_bf16 a[124:127], v[44:47], v[124:127], a[124:127]
    s_waitcnt lgkmcnt(1)
    ds_read_b64_tr_b16 v[40:41], v16 offset:0
    ds_read_b64_tr_b16 v[42:43], v16 offset:1024
    v_mfma_f32_16x16x32_bf16 v[128:131], v[48:51], v[64:67], v[128:131]
    ds_read_b64_tr_b16 v[44:45], v16 offset:8192
    ds_read_b64_tr_b16 v[46:47], v16 offset:9216
    v_mfma_f32_16x16x32_bf16 v[128:131], v[52:55], v[68:71], v[128:131]
    v_add_u32 v24, 0xfffe0000, v24
    v_add_u32 v16, 0x10000, v16
    v_mfma_f32_16x16x32_bf16 v[132:135], v[48:51], v[72:75], v[132:135]
    ds_read_b128 v[96:99], v24 offset:16384
    v_accvgpr_write_b32 a157, 0
    v_mfma_f32_16x16x32_bf16 v[132:135], v[52:55], v[76:79], v[132:135]
    buffer_store_dwordx4 v[32:35], v1, s[36:39], s72 offen sc1
    v_mfma_f32_16x16x32_bf16 v[136:139], v[48:51], v[80:83], v[136:139]
    v_accvgpr_read_b32 v31, a169
    v_accvgpr_read_b32 v32, a168
    v_mfma_f32_16x16x32_bf16 v[136:139], v[52:55], v[84:87], v[136:139]
    v_cvt_pk_bf16_f32 v32, v32, v31
    v_accvgpr_read_b32 v33, a170
    v_mfma_f32_16x16x32_bf16 v[140:143], v[48:51], v[88:91], v[140:143]
    s_add_u32 m0, s68, 106496
    ds_read_b64_tr_b16 v[48:49], v17 offset:0
    ds_read_b64_tr_b16 v[50:51], v17 offset:1024
    v_mfma_f32_16x16x32_bf16 v[140:143], v[52:55], v[92:95], v[140:143]
    buffer_load_dwordx4 v6, s[20:23], s66 offen lds
    v_mfma_f32_16x16x32_bf16 v[144:147], v[56:59], v[64:67], v[144:147]
    ds_read_b64_tr_b16 v[52:53], v17 offset:8192
    ds_read_b64_tr_b16 v[54:55], v17 offset:9216
    v_mfma_f32_16x16x32_bf16 v[144:147], v[60:63], v[68:71], v[144:147]
    v_add_u32 v17, 0x10000, v17
    v_accvgpr_read_b32 v31, a171
    v_mfma_f32_16x16x32_bf16 v[148:151], v[56:59], v[72:75], v[148:151]
    v_cvt_pk_bf16_f32 v33, v33, v31
    v_accvgpr_read_b32 v34, a172
    v_mfma_f32_16x16x32_bf16 v[148:151], v[60:63], v[76:79], v[148:151]
    v_accvgpr_read_b32 v31, a173
    v_cvt_pk_bf16_f32 v34, v34, v31
    v_mfma_f32_16x16x32_bf16 v[152:155], v[56:59], v[80:83], v[152:155]
    v_add_u32 v25, 0xfffe0000, v25
    v_accvgpr_read_b32 v35, a174
    v_mfma_f32_16x16x32_bf16 v[152:155], v[60:63], v[84:87], v[152:155]
    s_add_u32 s72, s71, 3072
    ds_read_b128 v[100:103], v25 offset:16384
    v_accvgpr_read_b32 v31, a175
    v_mfma_f32_16x16x32_bf16 v[156:159], v[56:59], v[88:91], v[156:159]
    s_add_u32 m0, s69, 114688
    ds_read_b64_tr_b16 v[56:57], v18 offset:0
    ds_read_b64_tr_b16 v[58:59], v18 offset:1024
    v_mfma_f32_16x16x32_bf16 v[156:159], v[60:63], v[92:95], v[156:159]
    s_xor_b32 s65, s65, 24576
    buffer_load_dwordx4 v10, s[20:23], s64 offen lds
    s_waitcnt lgkmcnt(3)
    v_mfma_f32_16x16x32_bf16 v[160:163], v[40:43], v[64:67], v[160:163]
    s_xor_b32 s66, s66, 384
    ds_read_b64_tr_b16 v[60:61], v18 offset:8192
    ds_read_b64_tr_b16 v[62:63], v18 offset:9216
    v_mfma_f32_16x16x32_bf16 v[160:163], v[44:47], v[68:71], v[160:163]
    v_add_u32 v18, 0x10000, v18
    v_cvt_pk_bf16_f32 v35, v35, v31
    v_mfma_f32_16x16x32_bf16 v[164:167], v[40:43], v[72:75], v[164:167]
    buffer_store_dwordx4 v[32:35], v1, s[36:39], s72 offen sc1
    v_mfma_f32_16x16x32_bf16 v[164:167], v[44:47], v[76:79], v[164:167]
    v_accvgpr_write_b32 a158, 0
    v_accvgpr_write_b32 a159, 0
    v_mfma_f32_16x16x32_bf16 v[168:171], v[40:43], v[80:83], v[168:171]
    v_accvgpr_write_b32 a160, 0
    v_accvgpr_write_b32 a161, 0
    v_mfma_f32_16x16x32_bf16 v[168:171], v[44:47], v[84:87], v[168:171]
    v_accvgpr_write_b32 a162, 0
    v_accvgpr_write_b32 a163, 0
    v_mfma_f32_16x16x32_bf16 v[172:175], v[40:43], v[88:91], v[172:175]
    ds_read_b64_tr_b16 v[40:41], v19 offset:0
    ds_read_b64_tr_b16 v[42:43], v19 offset:1024
    v_mfma_f32_16x16x32_bf16 v[172:175], v[44:47], v[92:95], v[172:175]
    ds_read_b64_tr_b16 v[44:45], v19 offset:8192
    ds_read_b64_tr_b16 v[46:47], v19 offset:9216
    v_mfma_f32_16x16x32_bf16 v[176:179], v[48:51], v[64:67], v[176:179]
    buffer_load_dwordx4 v11, s[20:23], s64 offen offset:1024 lds
    v_mfma_f32_16x16x32_bf16 v[176:179], v[52:55], v[68:71], v[176:179]
    ds_read_b128 v[104:107], v24 offset:24576
    v_add_u32 v19, 0x10000, v19
    v_mfma_f32_16x16x32_bf16 v[180:183], v[48:51], v[72:75], v[180:183]
    v_accvgpr_read_b32 v32, a176
    v_accvgpr_read_b32 v31, a177
    v_mfma_f32_16x16x32_bf16 v[180:183], v[52:55], v[76:79], v[180:183]
    v_cvt_pk_bf16_f32 v32, v32, v31
    v_accvgpr_read_b32 v33, a178
    v_mfma_f32_16x16x32_bf16 v[184:187], v[48:51], v[80:83], v[184:187]
    v_accvgpr_read_b32 v31, a179
    v_cvt_pk_bf16_f32 v33, v33, v31
    v_mfma_f32_16x16x32_bf16 v[184:187], v[52:55], v[84:87], v[184:187]
    v_accvgpr_read_b32 v34, a180
    v_accvgpr_read_b32 v31, a181
    v_mfma_f32_16x16x32_bf16 v[188:191], v[48:51], v[88:91], v[188:191]
    ds_read_b64_tr_b16 v[48:49], v20 offset:0
    ds_read_b64_tr_b16 v[50:51], v20 offset:1024
    v_mfma_f32_16x16x32_bf16 v[188:191], v[52:55], v[92:95], v[188:191]
    s_waitcnt lgkmcnt(2)
    ds_read_b64_tr_b16 v[52:53], v20 offset:8192
    ds_read_b64_tr_b16 v[54:55], v20 offset:9216
    v_mfma_f32_16x16x32_bf16 v[192:195], v[56:59], v[64:67], v[192:195]
    buffer_load_dwordx4 v12, s[20:23], s64 offen offset:2048 lds
    v_mfma_f32_16x16x32_bf16 v[192:195], v[60:63], v[68:71], v[192:195]
    v_add_u32 v20, 0x10000, v20
    v_cvt_pk_bf16_f32 v34, v34, v31
    v_mfma_f32_16x16x32_bf16 v[196:199], v[56:59], v[72:75], v[196:199]
    v_accvgpr_read_b32 v35, a182
    v_accvgpr_read_b32 v31, a183
    v_mfma_f32_16x16x32_bf16 v[196:199], v[60:63], v[76:79], v[196:199]
    s_add_u32 s72, s71, 34816
    ds_read_b128 v[108:111], v25 offset:24576
    v_cvt_pk_bf16_f32 v35, v35, v31
    v_mfma_f32_16x16x32_bf16 v[200:203], v[56:59], v[80:83], v[200:203]
    buffer_store_dwordx4 v[32:35], v1, s[36:39], s72 offen sc1
    v_mfma_f32_16x16x32_bf16 v[200:203], v[60:63], v[84:87], v[200:203]
    v_accvgpr_write_b32 a164, 0
    v_accvgpr_write_b32 a165, 0
    v_mfma_f32_16x16x32_bf16 v[204:207], v[56:59], v[88:91], v[204:207]
    ds_read_b64_tr_b16 v[56:57], v21 offset:0
    ds_read_b64_tr_b16 v[58:59], v21 offset:1024
    v_mfma_f32_16x16x32_bf16 v[204:207], v[60:63], v[92:95], v[204:207]
    ds_read_b64_tr_b16 v[60:61], v21 offset:8192
    ds_read_b64_tr_b16 v[62:63], v21 offset:9216
    v_mfma_f32_16x16x32_bf16 v[208:211], v[40:43], v[64:67], v[208:211]
    v_add_u32 v21, 0x10000, v21
    v_accvgpr_write_b32 a166, 0
    v_mfma_f32_16x16x32_bf16 v[208:211], v[44:47], v[68:71], v[208:211]
    buffer_load_dwordx4 v13, s[20:23], s64 offen offset:3072 lds
    v_mfma_f32_16x16x32_bf16 v[212:215], v[40:43], v[72:75], v[212:215]
    v_accvgpr_write_b32 a167, 0
    v_accvgpr_write_b32 a168, 0
    v_mfma_f32_16x16x32_bf16 v[212:215], v[44:47], v[76:79], v[212:215]
    v_accvgpr_write_b32 a169, 0
    v_accvgpr_write_b32 a170, 0
    v_mfma_f32_16x16x32_bf16 v[216:219], v[40:43], v[80:83], v[216:219]
    v_accvgpr_write_b32 a171, 0
    v_accvgpr_write_b32 a172, 0
    v_mfma_f32_16x16x32_bf16 v[216:219], v[44:47], v[84:87], v[216:219]
    v_accvgpr_write_b32 a173, 0
    v_accvgpr_write_b32 a174, 0
    v_mfma_f32_16x16x32_bf16 v[220:223], v[40:43], v[88:91], v[220:223]
    ds_read_b64_tr_b16 v[40:41], v26 offset:32768
    ds_read_b64_tr_b16 v[42:43], v26 offset:33280
    v_mfma_f32_16x16x32_bf16 v[220:223], v[44:47], v[92:95], v[220:223]
    s_waitcnt lgkmcnt(2)
    ds_read_b64_tr_b16 v[44:45], v26 offset:36864
    ds_read_b64_tr_b16 v[46:47], v26 offset:37376
    v_mfma_f32_16x16x32_bf16 v[224:227], v[48:51], v[64:67], v[224:227]
    v_add_u32 v26, 0x10000, v26
    v_accvgpr_read_b32 v32, a184
    v_mfma_f32_16x16x32_bf16 v[224:227], v[52:55], v[68:71], v[224:227]
    s_xor_b32 s64, s64, 128
    v_accvgpr_read_b32 v31, a185
    v_cvt_pk_bf16_f32 v32, v32, v31
    v_mfma_f32_16x16x32_bf16 v[228:231], v[48:51], v[72:75], v[228:231]
    v_accvgpr_read_b32 v33, a186
    v_accvgpr_read_b32 v31, a187
    v_mfma_f32_16x16x32_bf16 v[228:231], v[52:55], v[76:79], v[228:231]
    v_cvt_pk_bf16_f32 v33, v33, v31
    v_accvgpr_read_b32 v34, a188
    v_mfma_f32_16x16x32_bf16 v[232:235], v[48:51], v[80:83], v[232:235]
    v_accvgpr_read_b32 v31, a189
    v_cvt_pk_bf16_f32 v34, v34, v31
    v_mfma_f32_16x16x32_bf16 v[232:235], v[52:55], v[84:87], v[232:235]
    s_add_u32 m0, s69, 131072
    v_accvgpr_read_b32 v35, a190
    v_accvgpr_read_b32 v31, a191
    v_mfma_f32_16x16x32_bf16 v[236:239], v[48:51], v[88:91], v[236:239]
    buffer_load_dwordx4 v2, s[24:27], s60 offen lds
    v_mfma_f32_16x16x32_bf16 v[236:239], v[52:55], v[92:95], v[236:239]
    ds_read_b64_tr_b16 v[48:49], v27 offset:32768
    ds_read_b64_tr_b16 v[50:51], v27 offset:33280
    v_mfma_f32_16x16x32_bf16 v[240:243], v[56:59], v[64:67], v[240:243]
    ds_read_b64_tr_b16 v[52:53], v27 offset:36864
    ds_read_b64_tr_b16 v[54:55], v27 offset:37376
    v_mfma_f32_16x16x32_bf16 v[240:243], v[60:63], v[68:71], v[240:243]
    s_add_u32 s72, s71, 35840
    v_add_u32 v27, 0x10000, v27
    v_cvt_pk_bf16_f32 v35, v35, v31
    v_mfma_f32_16x16x32_bf16 v[244:247], v[56:59], v[72:75], v[244:247]
    buffer_load_dwordx4 v3, s[24:27], s60 offen offset:1024 lds
    v_mfma_f32_16x16x32_bf16 v[244:247], v[60:63], v[76:79], v[244:247]
    buffer_store_dwordx4 v[32:35], v1, s[36:39], s72 offen sc1
    v_mfma_f32_16x16x32_bf16 v[248:251], v[56:59], v[80:83], v[248:251]
    v_accvgpr_write_b32 a175, 0
    v_accvgpr_write_b32 a176, 0
    v_mfma_f32_16x16x32_bf16 v[248:251], v[60:63], v[84:87], v[248:251]
    v_accvgpr_write_b32 a177, 0
    v_accvgpr_write_b32 a178, 0
    v_mfma_f32_16x16x32_bf16 v[252:255], v[56:59], v[88:91], v[252:255]
    buffer_load_dwordx4 v4, s[24:27], s60 offen offset:2048 lds
    v_mfma_f32_16x16x32_bf16 v[252:255], v[60:63], v[92:95], v[252:255]
    s_waitcnt lgkmcnt(0)
    ds_read_b64_tr_b16 v[56:57], v28 offset:32768
    ds_read_b64_tr_b16 v[58:59], v28 offset:33280
    v_mfma_f32_16x16x32_bf16 a[64:67], v[40:43], v[64:67], a[64:67]
    ds_read_b64_tr_b16 v[60:61], v28 offset:36864
    ds_read_b64_tr_b16 v[62:63], v28 offset:37376
    v_mfma_f32_16x16x32_bf16 a[64:67], v[44:47], v[68:71], a[64:67]
    v_add_u32 v28, 0x10000, v28
    v_accvgpr_write_b32 a179, 0
    v_mfma_f32_16x16x32_bf16 a[68:71], v[40:43], v[72:75], a[68:71]
    buffer_load_dwordx4 v5, s[24:27], s60 offen offset:3072 lds
    v_mfma_f32_16x16x32_bf16 a[68:71], v[44:47], v[76:79], a[68:71]
    ds_read_b128 v[112:115], v24 offset:49152
    v_accvgpr_write_b32 a180, 0
    v_mfma_f32_16x16x32_bf16 a[72:75], v[40:43], v[80:83], a[72:75]
    v_accvgpr_write_b32 a181, 0
    v_accvgpr_write_b32 a182, 0
    v_mfma_f32_16x16x32_bf16 a[72:75], v[44:47], v[84:87], a[72:75]
    s_add_u32 m0, s69, 147456
    v_accvgpr_write_b32 a183, 0
    v_accvgpr_write_b32 a184, 0
    v_mfma_f32_16x16x32_bf16 a[76:79], v[40:43], v[88:91], a[76:79]
    s_xor_b32 s60, s60, 524288
    buffer_load_dwordx4 v10, s[20:23], s63 offen lds
    v_mfma_f32_16x16x32_bf16 a[76:79], v[44:47], v[92:95], a[76:79]
    ds_read_b128 v[116:119], v25 offset:49152
    v_accvgpr_read_b32 v32, a192
    v_mfma_f32_16x16x32_bf16 a[128:131], v[40:43], a[136:139], a[128:131]
    ds_read_b64_tr_b16 v[40:41], v29 offset:32768
    ds_read_b64_tr_b16 v[42:43], v29 offset:33280
    v_mfma_f32_16x16x32_bf16 a[128:131], v[44:47], a[140:143], a[128:131]
    ds_read_b64_tr_b16 v[44:45], v29 offset:36864
    ds_read_b64_tr_b16 v[46:47], v29 offset:37376
    v_mfma_f32_16x16x32_bf16 a[80:83], v[48:51], v[64:67], a[80:83]
    buffer_load_dwordx4 v11, s[20:23], s63 offen offset:1024 lds
    v_mfma_f32_16x16x32_bf16 a[80:83], v[52:55], v[68:71], a[80:83]
    ds_read_b128 v[120:123], v24 offset:57344
    v_add_u32 v29, 0x10000, v29
    v_mfma_f32_16x16x32_bf16 a[84:87], v[48:51], v[72:75], a[84:87]
    v_accvgpr_read_b32 v31, a193
    v_cvt_pk_bf16_f32 v32, v32, v31
    v_mfma_f32_16x16x32_bf16 a[84:87], v[52:55], v[76:79], a[84:87]
    v_accvgpr_read_b32 v33, a194
    v_accvgpr_read_b32 v31, a195
    v_mfma_f32_16x16x32_bf16 a[88:91], v[48:51], v[80:83], a[88:91]
    buffer_load_dwordx4 v12, s[20:23], s63 offen offset:2048 lds
    v_mfma_f32_16x16x32_bf16 a[88:91], v[52:55], v[84:87], a[88:91]
    s_add_u32 s72, s71, 4096
    ds_read_b128 v[124:127], v25 offset:57344
    v_cvt_pk_bf16_f32 v33, v33, v31
    v_mfma_f32_16x16x32_bf16 a[92:95], v[48:51], v[88:91], a[92:95]
    v_accvgpr_read_b32 v34, a196
    v_accvgpr_read_b32 v31, a197
    v_mfma_f32_16x16x32_bf16 a[92:95], v[52:55], v[92:95], a[92:95]
    v_cvt_pk_bf16_f32 v34, v34, v31
    v_accvgpr_read_b32 v35, a198
    v_mfma_f32_16x16x32_bf16 a[132:135], v[48:51], a[136:139], a[132:135]
    buffer_load_dwordx4 v13, s[20:23], s63 offen offset:3072 lds
    v_mfma_f32_16x16x32_bf16 a[132:135], v[52:55], a[140:143], a[132:135]
    s_waitcnt lgkmcnt(1)
    v_accvgpr_read_b32 v31, a199
    v_cvt_pk_bf16_f32 v35, v35, v31
    v_mfma_f32_16x16x32_bf16 a[96:99], v[56:59], v[64:67], a[96:99]
    v_accvgpr_write_b32 a185, 0
    v_accvgpr_write_b32 a186, 0
    v_mfma_f32_16x16x32_bf16 a[96:99], v[60:63], v[68:71], a[96:99]
    s_xor_b32 s63, s63, 1920
    v_accvgpr_write_b32 a187, 0
    v_accvgpr_write_b32 a188, 0
    v_mfma_f32_16x16x32_bf16 a[100:103], v[56:59], v[72:75], a[100:103]
    s_andn2_b32 s63, s63, 896
    buffer_store_dwordx4 v[32:35], v1, s[36:39], s72 offen sc1
    v_mfma_f32_16x16x32_bf16 a[100:103], v[60:63], v[76:79], a[100:103]
    v_accvgpr_write_b32 a189, 0
    v_accvgpr_write_b32 a190, 0
    v_mfma_f32_16x16x32_bf16 a[104:107], v[56:59], v[80:83], a[104:107]
    v_accvgpr_write_b32 a191, 0
    v_accvgpr_write_b32 a192, 0
    v_mfma_f32_16x16x32_bf16 a[104:107], v[60:63], v[84:87], a[104:107]
    s_waitcnt vmcnt(10) lgkmcnt(0)
    s_barrier
    ds_read_b64_tr_b16 v[48:49], v14 offset:0
    v_mfma_f32_16x16x32_bf16 a[108:111], v[56:59], v[88:91], a[108:111]
    s_add_u32 m0, s67, 0
    ds_read_b64_tr_b16 v[50:51], v14 offset:1024
    ds_read_b64_tr_b16 v[52:53], v14 offset:8192
    v_mfma_f32_16x16x32_bf16 a[108:111], v[60:63], v[92:95], a[108:111]
    buffer_load_dwordx4 v1, s[28:31], s65 offen sc1 lds
    v_mfma_f32_16x16x32_bf16 a[112:115], v[40:43], v[64:67], a[112:115]
    ds_read_b64_tr_b16 v[54:55], v14 offset:9216
    ds_read_b64_tr_b16 v[56:57], v15 offset:0
    v_mfma_f32_16x16x32_bf16 a[112:115], v[44:47], v[68:71], a[112:115]
    ds_read_b64_tr_b16 v[58:59], v15 offset:1024
    ds_read_b64_tr_b16 v[60:61], v15 offset:8192
    v_mfma_f32_16x16x32_bf16 a[116:119], v[40:43], v[72:75], a[116:119]
    ds_read_b64_tr_b16 v[62:63], v15 offset:9216
    ds_read_b128 a[136:139], v22 offset:32768
    v_mfma_f32_16x16x32_bf16 a[116:119], v[44:47], v[76:79], a[116:119]
    ds_read_b128 a[140:143], v23 offset:32768
    v_add_u32 v14, 0x10000, v14
    v_mfma_f32_16x16x32_bf16 a[120:123], v[40:43], v[80:83], a[120:123]
    v_add_u32 v15, 0x10000, v15
    v_add_u32 v22, 0xffff0000, v22
    v_mfma_f32_16x16x32_bf16 a[120:123], v[44:47], v[84:87], a[120:123]
    v_add_u32 v23, 0xffff0000, v23
    v_accvgpr_read_b32 v32, a200
    v_mfma_f32_16x16x32_bf16 a[124:127], v[40:43], v[88:91], a[124:127]
    buffer_load_dwordx4 v1, s[28:31], s65 offen offset:1024 sc1 lds
    v_mfma_f32_16x16x32_bf16 a[124:127], v[44:47], v[92:95], a[124:127]
    s_waitcnt lgkmcnt(1)
    ds_read_b64_tr_b16 v[40:41], v16 offset:0
    ds_read_b64_tr_b16 v[42:43], v16 offset:1024
    v_mfma_f32_16x16x32_bf16 v[128:131], v[48:51], v[96:99], v[128:131]
    ds_read_b64_tr_b16 v[44:45], v16 offset:8192
    ds_read_b64_tr_b16 v[46:47], v16 offset:9216
    v_mfma_f32_16x16x32_bf16 v[128:131], v[52:55], v[100:103], v[128:131]
    s_add_u32 s72, s71, 5120
    v_add_u32 v24, 0x10000, v24
    v_add_u32 v16, 0x10000, v16
    v_mfma_f32_16x16x32_bf16 v[132:135], v[48:51], v[104:107], v[132:135]
    ds_read_b128 v[64:67], v24 offset:16384
    v_accvgpr_read_b32 v31, a201
    v_mfma_f32_16x16x32_bf16 v[132:135], v[52:55], v[108:111], v[132:135]
    v_cvt_pk_bf16_f32 v32, v32, v31
    v_accvgpr_read_b32 v33, a202
    v_mfma_f32_16x16x32_bf16 v[136:139], v[48:51], v[112:115], v[136:139]
    v_accvgpr_read_b32 v31, a203
    v_cvt_pk_bf16_f32 v33, v33, v31
    v_mfma_f32_16x16x32_bf16 v[136:139], v[52:55], v[116:119], v[136:139]
    v_accvgpr_read_b32 v34, a204
    v_accvgpr_read_b32 v31, a205
    v_mfma_f32_16x16x32_bf16 v[140:143], v[48:51], v[120:123], v[140:143]
    s_add_u32 m0, s68, 8192
    ds_read_b64_tr_b16 v[48:49], v17 offset:0
    ds_read_b64_tr_b16 v[50:51], v17 offset:1024
    v_mfma_f32_16x16x32_bf16 v[140:143], v[52:55], v[124:127], v[140:143]
    buffer_load_dwordx4 v6, s[20:23], s66 offen lds
    v_mfma_f32_16x16x32_bf16 v[144:147], v[56:59], v[96:99], v[144:147]
    ds_read_b64_tr_b16 v[52:53], v17 offset:8192
    ds_read_b64_tr_b16 v[54:55], v17 offset:9216
    v_mfma_f32_16x16x32_bf16 v[144:147], v[60:63], v[100:103], v[144:147]
    v_add_u32 v17, 0x10000, v17
    v_cvt_pk_bf16_f32 v34, v34, v31
    v_mfma_f32_16x16x32_bf16 v[148:151], v[56:59], v[104:107], v[148:151]
    v_accvgpr_read_b32 v35, a206
    v_accvgpr_read_b32 v31, a207
    v_mfma_f32_16x16x32_bf16 v[148:151], v[60:63], v[108:111], v[148:151]
    v_cvt_pk_bf16_f32 v35, v35, v31
    v_accvgpr_write_b32 a193, 0
    v_mfma_f32_16x16x32_bf16 v[152:155], v[56:59], v[112:115], v[152:155]
    v_add_u32 v25, 0x10000, v25
    v_accvgpr_write_b32 a194, 0
    v_mfma_f32_16x16x32_bf16 v[152:155], v[60:63], v[116:119], v[152:155]
    ds_read_b128 v[68:71], v25 offset:16384
    v_accvgpr_write_b32 a195, 0
    v_mfma_f32_16x16x32_bf16 v[156:159], v[56:59], v[120:123], v[156:159]
    s_add_u32 m0, s69, 16384
    ds_read_b64_tr_b16 v[56:57], v18 offset:0
    ds_read_b64_tr_b16 v[58:59], v18 offset:1024
    v_mfma_f32_16x16x32_bf16 v[156:159], v[60:63], v[124:127], v[156:159]
    s_xor_b32 s65, s65, 8192
    buffer_load_dwordx4 v10, s[20:23], s64 offen lds
    s_waitcnt lgkmcnt(3)
    v_mfma_f32_16x16x32_bf16 v[160:163], v[40:43], v[96:99], v[160:163]
    s_xor_b32 s66, s66, 128
    ds_read_b64_tr_b16 v[60:61], v18 offset:8192
    ds_read_b64_tr_b16 v[62:63], v18 offset:9216
    v_mfma_f32_16x16x32_bf16 v[160:163], v[44:47], v[100:103], v[160:163]
    v_add_u32 v18, 0x10000, v18
    v_accvgpr_read_b32 v31, a209
    v_mfma_f32_16x16x32_bf16 v[164:167], v[40:43], v[104:107], v[164:167]
    buffer_store_dwordx4 v[32:35], v1, s[36:39], s72 offen sc1
    v_mfma_f32_16x16x32_bf16 v[164:167], v[44:47], v[108:111], v[164:167]
    v_accvgpr_write_b32 a196, 0
    v_accvgpr_read_b32 v32, a208
    v_mfma_f32_16x16x32_bf16 v[168:171], v[40:43], v[112:115], v[168:171]
    v_cvt_pk_bf16_f32 v32, v32, v31
    v_accvgpr_read_b32 v33, a210
    v_mfma_f32_16x16x32_bf16 v[168:171], v[44:47], v[116:119], v[168:171]
    v_accvgpr_read_b32 v31, a211
    v_cvt_pk_bf16_f32 v33, v33, v31
    v_mfma_f32_16x16x32_bf16 v[172:175], v[40:43], v[120:123], v[172:175]
    ds_read_b64_tr_b16 v[40:41], v19 offset:0
    ds_read_b64_tr_b16 v[42:43], v19 offset:1024
    v_mfma_f32_16x16x32_bf16 v[172:175], v[44:47], v[124:127], v[172:175]
    s_add_u32 s72, s71, 36864
    ds_read_b64_tr_b16 v[44:45], v19 offset:8192
    ds_read_b64_tr_b16 v[46:47], v19 offset:9216
    v_mfma_f32_16x16x32_bf16 v[176:179], v[48:51], v[96:99], v[176:179]
    buffer_load_dwordx4 v11, s[20:23], s64 offen offset:1024 lds
    v_mfma_f32_16x16x32_bf16 v[176:179], v[52:55], v[100:103], v[176:179]
    ds_read_b128 v[72:75], v24 offset:24576
    v_add_u32 v19, 0x10000, v19
    v_mfma_f32_16x16x32_bf16 v[180:183], v[48:51], v[104:107], v[180:183]
    v_accvgpr_read_b32 v34, a212
    v_accvgpr_read_b32 v31, a213
    v_mfma_f32_16x16x32_bf16 v[180:183], v[52:55], v[108:111], v[180:183]
    v_cvt_pk_bf16_f32 v34, v34, v31
    v_accvgpr_read_b32 v35, a214
    v_mfma_f32_16x16x32_bf16 v[184:187], v[48:51], v[112:115], v[184:187]
    v_accvgpr_read_b32 v31, a215
    v_cvt_pk_bf16_f32 v35, v35, v31
    v_mfma_f32_16x16x32_bf16 v[184:187], v[52:55], v[116:119], v[184:187]
    buffer_store_dwordx4 v[32:35], v1, s[36:39], s72 offen sc1
    v_mfma_f32_16x16x32_bf16 v[188:191], v[48:51], v[120:123], v[188:191]
    ds_read_b64_tr_b16 v[48:49], v20 offset:0
    ds_read_b64_tr_b16 v[50:51], v20 offset:1024
    v_mfma_f32_16x16x32_bf16 v[188:191], v[52:55], v[124:127], v[188:191]
    s_waitcnt lgkmcnt(2)
    ds_read_b64_tr_b16 v[52:53], v20 offset:8192
    ds_read_b64_tr_b16 v[54:55], v20 offset:9216
    v_mfma_f32_16x16x32_bf16 v[192:195], v[56:59], v[96:99], v[192:195]
    buffer_load_dwordx4 v12, s[20:23], s64 offen offset:2048 lds
    v_mfma_f32_16x16x32_bf16 v[192:195], v[60:63], v[100:103], v[192:195]
    v_add_u32 v20, 0x10000, v20
    v_accvgpr_write_b32 a197, 0
    v_mfma_f32_16x16x32_bf16 v[196:199], v[56:59], v[104:107], v[196:199]
    v_accvgpr_write_b32 a198, 0
    v_accvgpr_write_b32 a199, 0
    v_mfma_f32_16x16x32_bf16 v[196:199], v[60:63], v[108:111], v[196:199]
    ds_read_b128 v[76:79], v25 offset:24576
    v_accvgpr_write_b32 a200, 0
    v_mfma_f32_16x16x32_bf16 v[200:203], v[56:59], v[112:115], v[200:203]
    v_accvgpr_read_b32 v32, a216
    v_accvgpr_read_b32 v31, a217
    v_mfma_f32_16x16x32_bf16 v[200:203], v[60:63], v[116:119], v[200:203]
    v_cvt_pk_bf16_f32 v32, v32, v31
    v_accvgpr_read_b32 v33, a218
    v_mfma_f32_16x16x32_bf16 v[204:207], v[56:59], v[120:123], v[204:207]
    ds_read_b64_tr_b16 v[56:57], v21 offset:0
    ds_read_b64_tr_b16 v[58:59], v21 offset:1024
    v_mfma_f32_16x16x32_bf16 v[204:207], v[60:63], v[124:127], v[204:207]
    ds_read_b64_tr_b16 v[60:61], v21 offset:8192
    ds_read_b64_tr_b16 v[62:63], v21 offset:9216
    v_mfma_f32_16x16x32_bf16 v[208:211], v[40:43], v[96:99], v[208:211]
    v_add_u32 v21, 0x10000, v21
    v_accvgpr_read_b32 v31, a219
    v_mfma_f32_16x16x32_bf16 v[208:211], v[44:47], v[100:103], v[208:211]
    buffer_load_dwordx4 v13, s[20:23], s64 offen offset:3072 lds
    v_mfma_f32_16x16x32_bf16 v[212:215], v[40:43], v[104:107], v[212:215]
    v_cvt_pk_bf16_f32 v33, v33, v31
    v_accvgpr_read_b32 v34, a220
    v_mfma_f32_16x16x32_bf16 v[212:215], v[44:47], v[108:111], v[212:215]
    v_accvgpr_read_b32 v31, a221
    v_cvt_pk_bf16_f32 v34, v34, v31
    v_mfma_f32_16x16x32_bf16 v[216:219], v[40:43], v[112:115], v[216:219]
    v_accvgpr_read_b32 v35, a222
    v_accvgpr_read_b32 v31, a223
    v_mfma_f32_16x16x32_bf16 v[216:219], v[44:47], v[116:119], v[216:219]
    s_add_u32 s72, s71, 37888
    v_cvt_pk_bf16_f32 v35, v35, v31
    v_accvgpr_write_b32 a201, 0
    v_mfma_f32_16x16x32_bf16 v[220:223], v[40:43], v[120:123], v[220:223]
    ds_read_b64_tr_b16 v[40:41], v26 offset:32768
    ds_read_b64_tr_b16 v[42:43], v26 offset:33280
    v_mfma_f32_16x16x32_bf16 v[220:223], v[44:47], v[124:127], v[220:223]
    s_waitcnt lgkmcnt(2)
    ds_read_b64_tr_b16 v[44:45], v26 offset:36864
    ds_read_b64_tr_b16 v[46:47], v26 offset:37376
    v_mfma_f32_16x16x32_bf16 v[224:227], v[48:51], v[96:99], v[224:227]
    v_add_u32 v26, 0xffff0000, v26
    v_accvgpr_write_b32 a202, 0
    v_mfma_f32_16x16x32_bf16 v[224:227], v[52:55], v[100:103], v[224:227]
    s_xor_b32 s64, s64, 1920
    buffer_store_dwordx4 v[32:35], v1, s[36:39], s72 offen sc1
    v_mfma_f32_16x16x32_bf16 v[228:231], v[48:51], v[104:107], v[228:231]
    s_andn2_b32 s64, s64, 896
    v_accvgpr_write_b32 a203, 0
    v_accvgpr_write_b32 a204, 0
    v_mfma_f32_16x16x32_bf16 v[228:231], v[52:55], v[108:111], v[228:231]
    v_accvgpr_write_b32 a205, 0
    v_accvgpr_write_b32 a206, 0
    v_mfma_f32_16x16x32_bf16 v[232:235], v[48:51], v[112:115], v[232:235]
    v_accvgpr_write_b32 a207, 0
    v_accvgpr_write_b32 a208, 0
    v_mfma_f32_16x16x32_bf16 v[232:235], v[52:55], v[116:119], v[232:235]
    s_add_u32 m0, s69, 32768
    v_accvgpr_write_b32 a209, 0
    v_accvgpr_write_b32 a210, 0
    v_mfma_f32_16x16x32_bf16 v[236:239], v[48:51], v[120:123], v[236:239]
    buffer_load_dwordx4 v2, s[24:27], s60 offen lds
    v_mfma_f32_16x16x32_bf16 v[236:239], v[52:55], v[124:127], v[236:239]
    ds_read_b64_tr_b16 v[48:49], v27 offset:32768
    ds_read_b64_tr_b16 v[50:51], v27 offset:33280
    v_mfma_f32_16x16x32_bf16 v[240:243], v[56:59], v[96:99], v[240:243]
    ds_read_b64_tr_b16 v[52:53], v27 offset:36864
    ds_read_b64_tr_b16 v[54:55], v27 offset:37376
    v_mfma_f32_16x16x32_bf16 v[240:243], v[60:63], v[100:103], v[240:243]
    v_add_u32 v27, 0xffff0000, v27
    v_accvgpr_write_b32 a211, 0
    v_mfma_f32_16x16x32_bf16 v[244:247], v[56:59], v[104:107], v[244:247]
    buffer_load_dwordx4 v3, s[24:27], s60 offen offset:1024 lds
    v_mfma_f32_16x16x32_bf16 v[244:247], v[60:63], v[108:111], v[244:247]
    v_accvgpr_read_b32 v32, a224
    v_accvgpr_read_b32 v31, a225
    v_mfma_f32_16x16x32_bf16 v[248:251], v[56:59], v[112:115], v[248:251]
    v_cvt_pk_bf16_f32 v32, v32, v31
    v_accvgpr_read_b32 v33, a226
    v_mfma_f32_16x16x32_bf16 v[248:251], v[60:63], v[116:119], v[248:251]
    v_accvgpr_read_b32 v31, a227
    v_cvt_pk_bf16_f32 v33, v33, v31
    v_mfma_f32_16x16x32_bf16 v[252:255], v[56:59], v[120:123], v[252:255]
    buffer_load_dwordx4 v4, s[24:27], s60 offen offset:2048 lds
    v_mfma_f32_16x16x32_bf16 v[252:255], v[60:63], v[124:127], v[252:255]
    s_waitcnt lgkmcnt(0)
    ds_read_b64_tr_b16 v[56:57], v28 offset:32768
    ds_read_b64_tr_b16 v[58:59], v28 offset:33280
    v_mfma_f32_16x16x32_bf16 a[64:67], v[40:43], v[96:99], a[64:67]
    ds_read_b64_tr_b16 v[60:61], v28 offset:36864
    ds_read_b64_tr_b16 v[62:63], v28 offset:37376
    v_mfma_f32_16x16x32_bf16 a[64:67], v[44:47], v[100:103], a[64:67]
    v_add_u32 v28, 0xffff0000, v28
    v_accvgpr_read_b32 v34, a228
    v_mfma_f32_16x16x32_bf16 a[68:71], v[40:43], v[104:107], a[68:71]
    buffer_load_dwordx4 v5, s[24:27], s60 offen offset:3072 lds
    v_mfma_f32_16x16x32_bf16 a[68:71], v[44:47], v[108:111], a[68:71]
    s_add_u32 s72, s71, 6144
    ds_read_b128 v[80:83], v24 offset:49152
    v_accvgpr_read_b32 v31, a229
    v_mfma_f32_16x16x32_bf16 a[72:75], v[40:43], v[112:115], a[72:75]
    v_cvt_pk_bf16_f32 v34, v34, v31
    v_accvgpr_read_b32 v35, a230
    v_mfma_f32_16x16x32_bf16 a[72:75], v[44:47], v[116:119], a[72:75]
    s_xor_b32 s60, s60, 7864320
    v_accvgpr_read_b32 v31, a231
    v_cvt_pk_bf16_f32 v35, v35, v31
    v_mfma_f32_16x16x32_bf16 a[76:79], v[40:43], v[120:123], a[76:79]
    s_add_u32 m0, s69, 49152
    ds_read_b128 v[84:87], v25 offset:49152
    v_accvgpr_write_b32 a212, 0
    v_mfma_f32_16x16x32_bf16 a[76:79], v[44:47], v[124:127], a[76:79]
    s_andn2_b32 s60, s60, 3670016
    buffer_load_dwordx4 v10, s[20:23], s63 offen lds
    v_mfma_f32_16x16x32_bf16 a[128:131], v[40:43], a[136:139], a[128:131]
    ds_read_b64_tr_b16 v[40:41], v29 offset:32768
    ds_read_b64_tr_b16 v[42:43], v29 offset:33280
    v_mfma_f32_16x16x32_bf16 a[128:131], v[44:47], a[140:143], a[128:131]
    ds_read_b64_tr_b16 v[44:45], v29 offset:36864
    ds_read_b64_tr_b16 v[46:47], v29 offset:37376
    v_mfma_f32_16x16x32_bf16 a[80:83], v[48:51], v[96:99], a[80:83]
    buffer_load_dwordx4 v11, s[20:23], s63 offen offset:1024 lds
    v_mfma_f32_16x16x32_bf16 a[80:83], v[52:55], v[100:103], a[80:83]
    ds_read_b128 v[88:91], v24 offset:57344
    v_add_u32 v29, 0xffff0000, v29
    v_mfma_f32_16x16x32_bf16 a[84:87], v[48:51], v[104:107], a[84:87]
    buffer_store_dwordx4 v[32:35], v1, s[36:39], s72 offen sc1
    v_mfma_f32_16x16x32_bf16 a[84:87], v[52:55], v[108:111], a[84:87]
    v_accvgpr_write_b32 a213, 0
    v_accvgpr_write_b32 a214, 0
    v_mfma_f32_16x16x32_bf16 a[88:91], v[48:51], v[112:115], a[88:91]
    ds_read_b128 v[92:95], v25 offset:57344
    v_accvgpr_write_b32 a215, 0
    v_mfma_f32_16x16x32_bf16 a[88:91], v[52:55], v[116:119], a[88:91]
    buffer_load_dwordx4 v12, s[20:23], s63 offen offset:2048 lds
    v_mfma_f32_16x16x32_bf16 a[92:95], v[48:51], v[120:123], a[92:95]
    v_accvgpr_read_b32 v32, a232
    v_accvgpr_read_b32 v31, a233
    v_mfma_f32_16x16x32_bf16 a[92:95], v[52:55], v[124:127], a[92:95]
    v_cvt_pk_bf16_f32 v32, v32, v31
    v_accvgpr_read_b32 v33, a234
    v_mfma_f32_16x16x32_bf16 a[132:135], v[48:51], a[136:139], a[132:135]
    v_accvgpr_read_b32 v31, a235
    v_cvt_pk_bf16_f32 v33, v33, v31
    v_mfma_f32_16x16x32_bf16 a[132:135], v[52:55], a[140:143], a[132:135]
    s_waitcnt lgkmcnt(0)
    buffer_load_dwordx4 v13, s[20:23], s63 offen offset:3072 lds
    v_mfma_f32_16x16x32_bf16 a[96:99], v[56:59], v[96:99], a[96:99]
    v_accvgpr_read_b32 v34, a236
    v_accvgpr_read_b32 v31, a237
    v_mfma_f32_16x16x32_bf16 a[96:99], v[60:63], v[100:103], a[96:99]
    s_xor_b32 s63, s63, 128
    v_cvt_pk_bf16_f32 v34, v34, v31
    v_accvgpr_read_b32 v35, a238
    v_mfma_f32_16x16x32_bf16 a[100:103], v[56:59], v[104:107], a[100:103]
    v_accvgpr_read_b32 v31, a239
    v_cvt_pk_bf16_f32 v35, v35, v31
    v_mfma_f32_16x16x32_bf16 a[100:103], v[60:63], v[108:111], a[100:103]
    v_accvgpr_write_b32 a216, 0
    v_accvgpr_write_b32 a217, 0
    v_mfma_f32_16x16x32_bf16 a[104:107], v[56:59], v[112:115], a[104:107]
    v_accvgpr_write_b32 a218, 0
    v_accvgpr_write_b32 a219, 0
    v_mfma_f32_16x16x32_bf16 a[104:107], v[60:63], v[116:119], a[104:107]
    s_waitcnt vmcnt(10) lgkmcnt(0)
    s_barrier
    ds_read_b64_tr_b16 v[48:49], v14 offset:0
    v_mfma_f32_16x16x32_bf16 a[108:111], v[56:59], v[120:123], a[108:111]
    s_add_u32 m0, s67, 65536
    ds_read_b64_tr_b16 v[50:51], v14 offset:1024
    ds_read_b64_tr_b16 v[52:53], v14 offset:8192
    v_mfma_f32_16x16x32_bf16 a[108:111], v[60:63], v[124:127], a[108:111]
    s_add_u32 s72, s71, 7168
    buffer_load_dwordx4 v1, s[28:31], s65 offen sc1 lds
    v_mfma_f32_16x16x32_bf16 a[112:115], v[40:43], v[96:99], a[112:115]
    ds_read_b64_tr_b16 v[54:55], v14 offset:9216
    ds_read_b64_tr_b16 v[56:57], v15 offset:0
    v_mfma_f32_16x16x32_bf16 a[112:115], v[44:47], v[100:103], a[112:115]
    ds_read_b64_tr_b16 v[58:59], v15 offset:1024
    ds_read_b64_tr_b16 v[60:61], v15 offset:8192
    v_mfma_f32_16x16x32_bf16 a[116:119], v[40:43], v[104:107], a[116:119]
    ds_read_b64_tr_b16 v[62:63], v15 offset:9216
    ds_read_b128 a[136:139], v22 offset:0
    v_mfma_f32_16x16x32_bf16 a[116:119], v[44:47], v[108:111], a[116:119]
    ds_read_b128 a[140:143], v23 offset:0
    v_add_u32 v14, 0xfffe0000, v14
    v_mfma_f32_16x16x32_bf16 a[120:123], v[40:43], v[112:115], a[120:123]
    v_add_u32 v15, 0xfffe0000, v15
    v_add_u32 v22, 0x10000, v22
    v_mfma_f32_16x16x32_bf16 a[120:123], v[44:47], v[116:119], a[120:123]
    v_add_u32 v23, 0x10000, v23
    v_accvgpr_write_b32 a220, 0
    v_mfma_f32_16x16x32_bf16 a[124:127], v[40:43], v[120:123], a[124:127]
    buffer_load_dwordx4 v1, s[28:31], s65 offen offset:1024 sc1 lds
    v_mfma_f32_16x16x32_bf16 a[124:127], v[44:47], v[124:127], a[124:127]
    s_waitcnt lgkmcnt(1)
    ds_read_b64_tr_b16 v[40:41], v16 offset:0
    ds_read_b64_tr_b16 v[42:43], v16 offset:1024
    v_mfma_f32_16x16x32_bf16 v[128:131], v[48:51], v[64:67], v[128:131]
    ds_read_b64_tr_b16 v[44:45], v16 offset:8192
    ds_read_b64_tr_b16 v[46:47], v16 offset:9216
    v_mfma_f32_16x16x32_bf16 v[128:131], v[52:55], v[68:71], v[128:131]
    v_add_u32 v24, 0x10000, v24
    v_add_u32 v16, 0xfffe0000, v16
    v_mfma_f32_16x16x32_bf16 v[132:135], v[48:51], v[72:75], v[132:135]
    ds_read_b128 v[96:99], v24 offset:16384
    v_accvgpr_read_b32 v31, a241
    v_mfma_f32_16x16x32_bf16 v[132:135], v[52:55], v[76:79], v[132:135]
    buffer_store_dwordx4 v[32:35], v1, s[36:39], s72 offen sc1
    v_mfma_f32_16x16x32_bf16 v[136:139], v[48:51], v[80:83], v[136:139]
    v_accvgpr_write_b32 a221, 0
    v_accvgpr_read_b32 v32, a240
    v_mfma_f32_16x16x32_bf16 v[136:139], v[52:55], v[84:87], v[136:139]
    v_cvt_pk_bf16_f32 v32, v32, v31
    v_accvgpr_read_b32 v33, a242
    v_mfma_f32_16x16x32_bf16 v[140:143], v[48:51], v[88:91], v[140:143]
    s_add_u32 m0, s68, 73728
    ds_read_b64_tr_b16 v[48:49], v17 offset:0
    ds_read_b64_tr_b16 v[50:51], v17 offset:1024
    v_mfma_f32_16x16x32_bf16 v[140:143], v[52:55], v[92:95], v[140:143]
    buffer_load_dwordx4 v6, s[20:23], s66 offen lds
    v_mfma_f32_16x16x32_bf16 v[144:147], v[56:59], v[64:67], v[144:147]
    ds_read_b64_tr_b16 v[52:53], v17 offset:8192
    ds_read_b64_tr_b16 v[54:55], v17 offset:9216
    v_mfma_f32_16x16x32_bf16 v[144:147], v[60:63], v[68:71], v[144:147]
    v_add_u32 v17, 0xfffe0000, v17
    v_accvgpr_read_b32 v31, a243
    v_mfma_f32_16x16x32_bf16 v[148:151], v[56:59], v[72:75], v[148:151]
    v_cvt_pk_bf16_f32 v33, v33, v31
    v_accvgpr_read_b32 v34, a244
    v_mfma_f32_16x16x32_bf16 v[148:151], v[60:63], v[76:79], v[148:151]
    s_add_u32 s72, s71, 38912
    v_accvgpr_read_b32 v31, a245
    v_cvt_pk_bf16_f32 v34, v34, v31
    v_mfma_f32_16x16x32_bf16 v[152:155], v[56:59], v[80:83], v[152:155]
    v_add_u32 v25, 0x10000, v25
    v_accvgpr_read_b32 v35, a246
    v_mfma_f32_16x16x32_bf16 v[152:155], v[60:63], v[84:87], v[152:155]
    ds_read_b128 v[100:103], v25 offset:16384
    v_accvgpr_read_b32 v31, a247
    v_mfma_f32_16x16x32_bf16 v[156:159], v[56:59], v[88:91], v[156:159]
    s_xor_b32 s65, s65, 122880
    ds_read_b64_tr_b16 v[56:57], v18 offset:0
    ds_read_b64_tr_b16 v[58:59], v18 offset:1024
    v_mfma_f32_16x16x32_bf16 v[156:159], v[60:63], v[92:95], v[156:159]
    s_xor_b32 s66, s66, 1920
    ds_read_b64_tr_b16 v[60:61], v18 offset:8192
    ds_read_b64_tr_b16 v[62:63], v18 offset:9216
    s_waitcnt lgkmcnt(5)
    v_mfma_f32_16x16x32_bf16 v[160:163], v[40:43], v[64:67], v[160:163]
    s_add_u32 m0, s69, 81920
    v_add_u32 v18, 0xfffe0000, v18
    v_cvt_pk_bf16_f32 v35, v35, v31
    v_mfma_f32_16x16x32_bf16 v[160:163], v[44:47], v[68:71], v[160:163]
    s_andn2_b32 s65, s65, 57344
    s_andn2_b32 s66, s66, 896
    v_accvgpr_write_b32 a222, 0
    v_mfma_f32_16x16x32_bf16 v[164:167], v[40:43], v[72:75], v[164:167]
    buffer_load_dwordx4 v10, s[20:23], s64 offen lds
    v_mfma_f32_16x16x32_bf16 v[164:167], v[44:47], v[76:79], v[164:167]
    buffer_store_dwordx4 v[32:35], v1, s[36:39], s72 offen sc1
    v_mfma_f32_16x16x32_bf16 v[168:171], v[40:43], v[80:83], v[168:171]
    v_accvgpr_write_b32 a223, 0
    v_mfma_f32_16x16x32_bf16 v[168:171], v[44:47], v[84:87], v[168:171]
    v_mfma_f32_16x16x32_bf16 v[172:175], v[40:43], v[88:91], v[172:175]
    ds_read_b64_tr_b16 v[40:41], v19 offset:0
    ds_read_b64_tr_b16 v[42:43], v19 offset:1024
    v_mfma_f32_16x16x32_bf16 v[172:175], v[44:47], v[92:95], v[172:175]
    ds_read_b64_tr_b16 v[44:45], v19 offset:8192
    ds_read_b64_tr_b16 v[46:47], v19 offset:9216
    v_mfma_f32_16x16x32_bf16 v[176:179], v[48:51], v[64:67], v[176:179]
    buffer_load_dwordx4 v11, s[20:23], s64 offen offset:1024 lds
    v_mfma_f32_16x16x32_bf16 v[176:179], v[52:55], v[68:71], v[176:179]
    ds_read_b128 v[104:107], v24 offset:24576
    v_add_u32 v19, 0xfffe0000, v19
    v_mfma_f32_16x16x32_bf16 v[180:183], v[48:51], v[72:75], v[180:183]
    v_accvgpr_read_b32 v32, a248
    v_accvgpr_read_b32 v31, a249
    v_mfma_f32_16x16x32_bf16 v[180:183], v[52:55], v[76:79], v[180:183]
    v_cvt_pk_bf16_f32 v32, v32, v31
    v_accvgpr_read_b32 v33, a250
    v_mfma_f32_16x16x32_bf16 v[184:187], v[48:51], v[80:83], v[184:187]
    v_accvgpr_read_b32 v31, a251
    v_cvt_pk_bf16_f32 v33, v33, v31
    v_mfma_f32_16x16x32_bf16 v[184:187], v[52:55], v[84:87], v[184:187]
    v_accvgpr_read_b32 v34, a252
    v_accvgpr_read_b32 v31, a253
    v_mfma_f32_16x16x32_bf16 v[188:191], v[48:51], v[88:91], v[188:191]
    ds_read_b64_tr_b16 v[48:49], v20 offset:0
    ds_read_b64_tr_b16 v[50:51], v20 offset:1024
    v_mfma_f32_16x16x32_bf16 v[188:191], v[52:55], v[92:95], v[188:191]
    s_waitcnt lgkmcnt(2)
    ds_read_b64_tr_b16 v[52:53], v20 offset:8192
    ds_read_b64_tr_b16 v[54:55], v20 offset:9216
    v_mfma_f32_16x16x32_bf16 v[192:195], v[56:59], v[64:67], v[192:195]
    buffer_load_dwordx4 v12, s[20:23], s64 offen offset:2048 lds
    v_mfma_f32_16x16x32_bf16 v[192:195], v[60:63], v[68:71], v[192:195]
    s_add_u32 s72, s71, 39936
    v_add_u32 v20, 0xfffe0000, v20
    v_cvt_pk_bf16_f32 v34, v34, v31
    v_mfma_f32_16x16x32_bf16 v[196:199], v[56:59], v[72:75], v[196:199]
    v_accvgpr_read_b32 v35, a254
    v_accvgpr_read_b32 v31, a255
    v_mfma_f32_16x16x32_bf16 v[196:199], v[60:63], v[76:79], v[196:199]
    ds_read_b128 v[108:111], v25 offset:24576
    v_cvt_pk_bf16_f32 v35, v35, v31
    v_mfma_f32_16x16x32_bf16 v[200:203], v[56:59], v[80:83], v[200:203]
    v_mov_b32 v31, 1
    v_add_u32 v11, s99, v39
    v_mfma_f32_16x16x32_bf16 v[200:203], v[60:63], v[84:87], v[200:203]
    s_mul_i32 s99, s98, 6
    buffer_store_dwordx4 v[32:35], v1, s[36:39], s72 offen sc1
    v_mfma_f32_16x16x32_bf16 v[204:207], v[56:59], v[88:91], v[204:207]
    s_sub_u32 s99, s8, s99
    ds_read_b64_tr_b16 v[56:57], v21 offset:0
    ds_read_b64_tr_b16 v[58:59], v21 offset:1024
    v_mfma_f32_16x16x32_bf16 v[204:207], v[60:63], v[92:95], v[204:207]
    s_mul_i32 s99, s99, 6
    ds_read_b64_tr_b16 v[60:61], v21 offset:8192
    ds_read_b64_tr_b16 v[62:63], v21 offset:9216
    v_mfma_f32_16x16x32_bf16 v[208:211], v[40:43], v[64:67], v[208:211]
    s_lshr_b32 s8, s5, 3
    v_add_u32 v21, 0xfffe0000, v21
    v_mfma_f32_16x16x32_bf16 v[208:211], v[44:47], v[68:71], v[208:211]
    s_lshl1_add_u32 s99, s4, s99
    buffer_load_dwordx4 v13, s[20:23], s64 offen offset:3072 lds
    v_mfma_f32_16x16x32_bf16 v[212:215], v[40:43], v[72:75], v[212:215]
    s_cmp_lt_u32 s98, 6
    s_cselect_b32 s98, s98, 40
    v_mfma_f32_16x16x32_bf16 v[212:215], v[44:47], v[76:79], v[212:215]
    s_mul_i32 s8, s8, 6
    v_mfma_f32_16x16x32_bf16 v[216:219], v[40:43], v[80:83], v[216:219]
    s_sub_u32 s99, s99, 2
    v_mfma_f32_16x16x32_bf16 v[216:219], v[44:47], v[84:87], v[216:219]
    s_add_u32 s98, s98, s8
    v_mfma_f32_16x16x32_bf16 v[220:223], v[40:43], v[88:91], v[220:223]
    s_lshl_b32 s8, s99, 5
    ds_read_b64_tr_b16 v[40:41], v26 offset:0
    ds_read_b64_tr_b16 v[42:43], v26 offset:512
    v_mfma_f32_16x16x32_bf16 v[220:223], v[44:47], v[92:95], v[220:223]
    s_waitcnt lgkmcnt(2)
    ds_read_b64_tr_b16 v[44:45], v26 offset:4096
    ds_read_b64_tr_b16 v[46:47], v26 offset:4608
    v_mfma_f32_16x16x32_bf16 v[224:227], v[48:51], v[64:67], v[224:227]
    v_add_u32 v26, 0x10000, v26
    v_lshl_add_u32 v10, v38, 4, s8
    v_mfma_f32_16x16x32_bf16 v[224:227], v[52:55], v[68:71], v[224:227]
    s_xor_b32 s64, s64, 128
    v_lshrrev_b32 v38, 2, v37
    v_lshl_add_u32 v38, s98, 2, v38
    v_mfma_f32_16x16x32_bf16 v[228:231], v[48:51], v[72:75], v[228:231]
    s_add_u32 s98, s98, 128
    v_mul_u32_u24 v39, 171, v38
    v_and_b32 v37, 3, v37
    v_mfma_f32_16x16x32_bf16 v[228:231], v[52:55], v[76:79], v[228:231]
    s_mul_i32 s98, s98, 36
    v_lshrrev_b32 v39, 9, v39
    v_lshl_add_u32 v37, v38, 3, v37
    v_mfma_f32_16x16x32_bf16 v[232:235], v[48:51], v[80:83], v[232:235]
    s_add_u32 s98, s98, s99
    v_mul_u32_u24 v38, 24, v39
    v_sub_u32 v37, v37, v38
    v_mfma_f32_16x16x32_bf16 v[232:235], v[52:55], v[84:87], v[232:235]
    s_add_u32 m0, s69, 98304
    v_mad_u32_u24 v39, v39, 18, v37
    v_mul_u32_u24 v39, 1152, v39
    v_mfma_f32_16x16x32_bf16 v[236:239], v[48:51], v[88:91], v[236:239]
    s_lshl_b32 s99, s100, 14
    buffer_load_dwordx4 v2, s[24:27], s60 offen lds
    v_mfma_f32_16x16x32_bf16 v[236:239], v[52:55], v[92:95], v[236:239]
    s_add_u32 s99, s99, s69
    ds_read_b64_tr_b16 v[48:49], v27 offset:0
    ds_read_b64_tr_b16 v[50:51], v27 offset:512
    v_mfma_f32_16x16x32_bf16 v[240:243], v[56:59], v[64:67], v[240:243]
    s_add_u32 s63, s7, s99
    ds_read_b64_tr_b16 v[52:53], v27 offset:4096
    ds_read_b64_tr_b16 v[54:55], v27 offset:4608
    v_mfma_f32_16x16x32_bf16 v[240:243], v[60:63], v[68:71], v[240:243]
    s_lshl_b32 s99, s100, 11
    v_add_u32 v27, 0x10000, v27
    v_add_u32 v39, v39, v10
    v_mfma_f32_16x16x32_bf16 v[244:247], v[56:59], v[72:75], v[244:247]
    s_add_u32 s7, s7, s99
    v_add_u32 v12, 0, v39
    v_mov_b32 v38, 1073741824
    v_mfma_f32_16x16x32_bf16 v[244:247], v[60:63], v[76:79], v[244:247]
    s_lshl_b32 s64, s98, 10
    v_cmp_gt_u32 vcc, 18, v37
    v_add_u32 v13, 4608, v39
    v_mfma_f32_16x16x32_bf16 v[248:251], v[56:59], v[80:83], v[248:251]
    s_add_u32 s7, s7, 32768
    v_cndmask_b32 v12, v38, v12, vcc
    v_add_u32 v38, 1024, v36
    v_mfma_f32_16x16x32_bf16 v[248:251], v[60:63], v[84:87], v[248:251]
    s_cmp_eq_u32 s4, 0
    s_cselect_b64 vcc, -1, 0
    v_cndmask_b32 v12, v12, v38, vcc
    v_mfma_f32_16x16x32_bf16 v[252:255], v[56:59], v[88:91], v[252:255]
    buffer_load_dwordx4 v3, s[24:27], s60 offen offset:1024 lds
    v_mfma_f32_16x16x32_bf16 v[252:255], v[60:63], v[92:95], v[252:255]
    s_waitcnt lgkmcnt(0)
    ds_read_b64_tr_b16 v[56:57], v28 offset:0
    ds_read_b64_tr_b16 v[58:59], v28 offset:512
    v_mfma_f32_16x16x32_bf16 a[64:67], v[40:43], v[64:67], a[64:67]
    ds_read_b64_tr_b16 v[60:61], v28 offset:4096
    ds_read_b64_tr_b16 v[62:63], v28 offset:4608
    v_mfma_f32_16x16x32_bf16 a[64:67], v[44:47], v[68:71], a[64:67]
    v_add_u32 v24, 0xfffe0000, v24
    v_add_u32 v28, 0x10000, v28
    v_mfma_f32_16x16x32_bf16 a[68:71], v[40:43], v[72:75], a[68:71]
    ds_read_b128 v[112:115], v24 offset:16384
    v_mov_b32 v38, 1073741824
    v_mfma_f32_16x16x32_bf16 a[68:71], v[44:47], v[76:79], a[68:71]
    v_cmp_gt_u32 vcc, 14, v37
    v_mfma_f32_16x16x32_bf16 a[72:75], v[40:43], v[80:83], a[72:75]
    v_mfma_f32_16x16x32_bf16 a[72:75], v[44:47], v[84:87], a[72:75]
    v_add_u32 v25, 0xfffe0000, v25
    v_cndmask_b32 v13, v38, v13, vcc
    v_mfma_f32_16x16x32_bf16 a[76:79], v[40:43], v[88:91], a[76:79]
    s_lshr_b32 s92, s2, 3
    buffer_load_dwordx4 v4, s[24:27], s60 offen offset:2048 lds
    v_mfma_f32_16x16x32_bf16 a[76:79], v[44:47], v[92:95], a[76:79]
    s_lshl2_add_u32 s92, s92, s4
    ds_read_b128 v[116:119], v25 offset:16384
    v_lshrrev_b32 v9, 4, v1
    v_mfma_f32_16x16x32_bf16 a[128:131], v[40:43], a[136:139], a[128:131]
    s_mul_i32 s92, s92, 1
    v_min_u32 v9, 0, v9
    ds_read_b64_tr_b16 v[40:41], v29 offset:0
    v_mfma_f32_16x16x32_bf16 a[128:131], v[44:47], a[140:143], a[128:131]
    s_add_u32 s92, s92, 32
    v_add_lshl_u32 v9, v9, s92, 7
    ds_read_b64_tr_b16 v[42:43], v29 offset:512
    v_mfma_f32_16x16x32_bf16 a[80:83], v[48:51], v[64:67], a[80:83]
    s_getpc_b64 s[92:93]
    global_load_dword v9, v9, s[92:93]
    v_mfma_f32_16x16x32_bf16 a[80:83], v[52:55], v[68:71], a[80:83]
    ds_read_b128 v[120:123], v24 offset:24576
    ds_read_b64_tr_b16 v[44:45], v29 offset:4096
    v_mfma_f32_16x16x32_bf16 a[84:87], v[48:51], v[72:75], a[84:87]
    ds_read_b64_tr_b16 v[46:47], v29 offset:4608
    v_add_u32 v29, 0x10000, v29
    v_mfma_f32_16x16x32_bf16 a[84:87], v[52:55], v[76:79], a[84:87]
    v_add_u32 v38, 19456, v36
    v_mfma_f32_16x16x32_bf16 a[88:91], v[48:51], v[80:83], a[88:91]
    buffer_load_dwordx4 v5, s[24:27], s60 offen offset:3072 lds
    v_mfma_f32_16x16x32_bf16 a[88:91], v[52:55], v[84:87], a[88:91]
    ds_read_b128 v[124:127], v25 offset:24576
    v_mfma_f32_16x16x32_bf16 a[92:95], v[48:51], v[88:91], a[92:95]
    s_cmp_eq_u32 s4, 0
    s_cselect_b64 vcc, -1, 0
    v_cndmask_b32 v13, v13, v38, vcc
    v_mfma_f32_16x16x32_bf16 a[92:95], v[52:55], v[92:95], a[92:95]
    s_cmp_eq_u32 s4, 0
    s_cselect_b32 s64, s7, s64
    v_mfma_f32_16x16x32_bf16 a[132:135], v[48:51], a[136:139], a[132:135]
    v_mfma_f32_16x16x32_bf16 a[132:135], v[52:55], a[140:143], a[132:135]
    s_waitcnt lgkmcnt(1)
    v_mfma_f32_16x16x32_bf16 a[96:99], v[56:59], v[64:67], a[96:99]
    v_mfma_f32_16x16x32_bf16 a[96:99], v[60:63], v[68:71], a[96:99]
    s_xor_b32 s60, s60, 524288
    v_mfma_f32_16x16x32_bf16 a[100:103], v[56:59], v[72:75], a[100:103]
    v_mfma_f32_16x16x32_bf16 a[100:103], v[60:63], v[76:79], a[100:103]
    v_mfma_f32_16x16x32_bf16 a[104:107], v[56:59], v[80:83], a[104:107]
    v_mfma_f32_16x16x32_bf16 a[104:107], v[60:63], v[84:87], a[104:107]
    s_waitcnt vmcnt(5) lgkmcnt(0)
    s_barrier
    ds_read_b64_tr_b16 v[48:49], v14 offset:32768
    v_mfma_f32_16x16x32_bf16 a[108:111], v[56:59], v[88:91], a[108:111]
    s_add_u32 m0, s67, 131072
    buffer_store_dword v31, v30, s[32:35], s101 offen sc1
    v_mfma_f32_16x16x32_bf16 a[108:111], v[60:63], v[92:95], a[108:111]
    buffer_load_dwordx4 v1, s[28:31], s65 offen sc1 lds
    v_mfma_f32_16x16x32_bf16 a[112:115], v[40:43], v[64:67], a[112:115]
    ds_read_b64_tr_b16 v[50:51], v14 offset:33792
    ds_read_b64_tr_b16 v[52:53], v14 offset:40960
    v_mfma_f32_16x16x32_bf16 a[112:115], v[44:47], v[68:71], a[112:115]
    ds_read_b64_tr_b16 v[54:55], v14 offset:41984
    ds_read_b64_tr_b16 v[56:57], v15 offset:32768
    v_mfma_f32_16x16x32_bf16 a[116:119], v[40:43], v[72:75], a[116:119]
    ds_read_b64_tr_b16 v[58:59], v15 offset:33792
    ds_read_b64_tr_b16 v[60:61], v15 offset:40960
    v_mfma_f32_16x16x32_bf16 a[116:119], v[44:47], v[76:79], a[116:119]
    ds_read_b64_tr_b16 v[62:63], v15 offset:41984
    ds_read_b128 a[136:139], v22 offset:0
    v_mfma_f32_16x16x32_bf16 a[120:123], v[40:43], v[80:83], a[120:123]
    ds_read_b128 a[140:143], v23 offset:0
    v_add_u32 v14, 0x10000, v14
    v_mfma_f32_16x16x32_bf16 a[120:123], v[44:47], v[84:87], a[120:123]
    v_add_u32 v15, 0x10000, v15
    v_add_u32 v22, 0x10000, v22
    v_mfma_f32_16x16x32_bf16 a[124:127], v[40:43], v[88:91], a[124:127]
    ds_read_b64_tr_b16 v[40:41], v16 offset:32768
    ds_read_b64_tr_b16 v[42:43], v16 offset:33792
    v_mfma_f32_16x16x32_bf16 a[124:127], v[44:47], v[92:95], a[124:127]
    s_waitcnt lgkmcnt(5)
    ds_read_b64_tr_b16 v[44:45], v16 offset:40960
    ds_read_b64_tr_b16 v[46:47], v16 offset:41984
    v_mfma_f32_16x16x32_bf16 v[128:131], v[48:51], v[96:99], v[128:131]
    v_add_u32 v16, 0x10000, v16
    v_add_u32 v23, 0x10000, v23
    v_mfma_f32_16x16x32_bf16 v[128:131], v[52:55], v[100:103], v[128:131]
    v_mfma_f32_16x16x32_bf16 v[132:135], v[48:51], v[104:107], v[132:135]
    ds_read_b128 v[64:67], v24 offset:49152
    v_mfma_f32_16x16x32_bf16 v[132:135], v[52:55], v[108:111], v[132:135]
    v_mfma_f32_16x16x32_bf16 v[136:139], v[48:51], v[112:115], v[136:139]
    v_mfma_f32_16x16x32_bf16 v[136:139], v[52:55], v[116:119], v[136:139]
    v_mfma_f32_16x16x32_bf16 v[140:143], v[48:51], v[120:123], v[140:143]
    ds_read_b64_tr_b16 v[48:49], v17 offset:32768
    ds_read_b64_tr_b16 v[50:51], v17 offset:33792
    v_mfma_f32_16x16x32_bf16 v[140:143], v[52:55], v[124:127], v[140:143]
    ds_read_b64_tr_b16 v[52:53], v17 offset:40960
    ds_read_b64_tr_b16 v[54:55], v17 offset:41984
    v_mfma_f32_16x16x32_bf16 v[144:147], v[56:59], v[96:99], v[144:147]
    s_waitcnt lgkmcnt(4)
    v_add_u32 v17, 0x10000, v17
    v_mfma_f32_16x16x32_bf16 v[144:147], v[60:63], v[100:103], v[144:147]
    v_mfma_f32_16x16x32_bf16 v[148:151], v[56:59], v[104:107], v[148:151]
    buffer_load_dwordx4 v1, s[28:31], s65 offen offset:1024 sc1 lds
    v_mfma_f32_16x16x32_bf16 v[148:151], v[60:63], v[108:111], v[148:151]
    v_mfma_f32_16x16x32_bf16 v[152:155], v[56:59], v[112:115], v[152:155]
    v_mfma_f32_16x16x32_bf16 v[152:155], v[60:63], v[116:119], v[152:155]
    ds_read_b128 v[68:71], v25 offset:49152
    v_mfma_f32_16x16x32_bf16 v[156:159], v[56:59], v[120:123], v[156:159]
    ds_read_b64_tr_b16 v[56:57], v18 offset:32768
    ds_read_b64_tr_b16 v[58:59], v18 offset:33792
    v_mfma_f32_16x16x32_bf16 v[156:159], v[60:63], v[124:127], v[156:159]
    ds_read_b64_tr_b16 v[60:61], v18 offset:40960
    ds_read_b64_tr_b16 v[62:63], v18 offset:41984
    v_mfma_f32_16x16x32_bf16 v[160:163], v[40:43], v[96:99], v[160:163]
    v_add_u32 v18, 0x10000, v18
    v_mfma_f32_16x16x32_bf16 v[160:163], v[44:47], v[100:103], v[160:163]
    v_mfma_f32_16x16x32_bf16 v[164:167], v[40:43], v[104:107], v[164:167]
    v_mfma_f32_16x16x32_bf16 v[164:167], v[44:47], v[108:111], v[164:167]
    v_mfma_f32_16x16x32_bf16 v[168:171], v[40:43], v[112:115], v[168:171]
    v_mfma_f32_16x16x32_bf16 v[168:171], v[44:47], v[116:119], v[168:171]
    v_mfma_f32_16x16x32_bf16 v[172:175], v[40:43], v[120:123], v[172:175]
    ds_read_b64_tr_b16 v[40:41], v19 offset:32768
    ds_read_b64_tr_b16 v[42:43], v19 offset:33792
    v_mfma_f32_16x16x32_bf16 v[172:175], v[44:47], v[124:127], v[172:175]
    s_waitcnt lgkmcnt(2)
    ds_read_b64_tr_b16 v[44:45], v19 offset:40960
    ds_read_b64_tr_b16 v[46:47], v19 offset:41984
    v_mfma_f32_16x16x32_bf16 v[176:179], v[48:51], v[96:99], v[176:179]
    ds_read_b128 v[72:75], v24 offset:57344
    v_add_u32 v19, 0x10000, v19
    v_mfma_f32_16x16x32_bf16 v[176:179], v[52:55], v[100:103], v[176:179]
    v_mfma_f32_16x16x32_bf16 v[180:183], v[48:51], v[104:107], v[180:183]
    v_mfma_f32_16x16x32_bf16 v[180:183], v[52:55], v[108:111], v[180:183]
    v_mfma_f32_16x16x32_bf16 v[184:187], v[48:51], v[112:115], v[184:187]
    v_mfma_f32_16x16x32_bf16 v[184:187], v[52:55], v[116:119], v[184:187]
    s_add_u32 m0, s68, 139264
    v_mfma_f32_16x16x32_bf16 v[188:191], v[48:51], v[120:123], v[188:191]
    buffer_load_dwordx4 v6, s[20:23], s66 offen lds
    v_mfma_f32_16x16x32_bf16 v[188:191], v[52:55], v[124:127], v[188:191]
    ds_read_b64_tr_b16 v[48:49], v20 offset:32768
    ds_read_b64_tr_b16 v[50:51], v20 offset:33792
    v_mfma_f32_16x16x32_bf16 v[192:195], v[56:59], v[96:99], v[192:195]
    ds_read_b64_tr_b16 v[52:53], v20 offset:40960
    ds_read_b64_tr_b16 v[54:55], v20 offset:41984
    v_mfma_f32_16x16x32_bf16 v[192:195], v[60:63], v[100:103], v[192:195]
    v_add_u32 v20, 0x10000, v20
    v_mfma_f32_16x16x32_bf16 v[196:199], v[56:59], v[104:107], v[196:199]
    v_mfma_f32_16x16x32_bf16 v[196:199], v[60:63], v[108:111], v[196:199]
    ds_read_b128 v[76:79], v25 offset:57344
    v_mfma_f32_16x16x32_bf16 v[200:203], v[56:59], v[112:115], v[200:203]
    v_mfma_f32_16x16x32_bf16 v[200:203], v[60:63], v[116:119], v[200:203]
    v_mfma_f32_16x16x32_bf16 v[204:207], v[56:59], v[120:123], v[204:207]
    ds_read_b64_tr_b16 v[56:57], v21 offset:32768
    ds_read_b64_tr_b16 v[58:59], v21 offset:33792
    v_mfma_f32_16x16x32_bf16 v[204:207], v[60:63], v[124:127], v[204:207]
    s_waitcnt lgkmcnt(3)
    ds_read_b64_tr_b16 v[60:61], v21 offset:40960
    ds_read_b64_tr_b16 v[62:63], v21 offset:41984
    v_mfma_f32_16x16x32_bf16 v[208:211], v[40:43], v[96:99], v[208:211]
    v_add_u32 v21, 0x10000, v21
    v_mfma_f32_16x16x32_bf16 v[208:211], v[44:47], v[100:103], v[208:211]
    v_mfma_f32_16x16x32_bf16 v[212:215], v[40:43], v[104:107], v[212:215]
    v_mfma_f32_16x16x32_bf16 v[212:215], v[44:47], v[108:111], v[212:215]
    v_mfma_f32_16x16x32_bf16 v[216:219], v[40:43], v[112:115], v[216:219]
    v_mfma_f32_16x16x32_bf16 v[216:219], v[44:47], v[116:119], v[216:219]
    v_mfma_f32_16x16x32_bf16 v[220:223], v[40:43], v[120:123], v[220:223]
    ds_read_b64_tr_b16 v[40:41], v26 offset:0
    ds_read_b64_tr_b16 v[42:43], v26 offset:512
    v_mfma_f32_16x16x32_bf16 v[220:223], v[44:47], v[124:127], v[220:223]
    ds_read_b64_tr_b16 v[44:45], v26 offset:4096
    ds_read_b64_tr_b16 v[46:47], v26 offset:4608
    v_mfma_f32_16x16x32_bf16 v[224:227], v[48:51], v[96:99], v[224:227]
    v_add_u32 v26, 0x10000, v26
    v_mfma_f32_16x16x32_bf16 v[224:227], v[52:55], v[100:103], v[224:227]
    s_xor_b32 s65, s65, 8192
    v_mfma_f32_16x16x32_bf16 v[228:231], v[48:51], v[104:107], v[228:231]
    s_xor_b32 s66, s66, 128
    v_mfma_f32_16x16x32_bf16 v[228:231], v[52:55], v[108:111], v[228:231]
    v_mfma_f32_16x16x32_bf16 v[232:235], v[48:51], v[112:115], v[232:235]
    v_mfma_f32_16x16x32_bf16 v[232:235], v[52:55], v[116:119], v[232:235]
    v_mfma_f32_16x16x32_bf16 v[236:239], v[48:51], v[120:123], v[236:239]
    ds_read_b64_tr_b16 v[48:49], v27 offset:0
    ds_read_b64_tr_b16 v[50:51], v27 offset:512
    v_mfma_f32_16x16x32_bf16 v[236:239], v[52:55], v[124:127], v[236:239]
    s_waitcnt lgkmcnt(2)
    ds_read_b64_tr_b16 v[52:53], v27 offset:4096
    ds_read_b64_tr_b16 v[54:55], v27 offset:4608
    v_mfma_f32_16x16x32_bf16 v[240:243], v[56:59], v[96:99], v[240:243]
    v_add_u32 v27, 0x10000, v27
    v_mfma_f32_16x16x32_bf16 v[240:243], v[60:63], v[100:103], v[240:243]
    v_mfma_f32_16x16x32_bf16 v[244:247], v[56:59], v[104:107], v[244:247]
    v_mfma_f32_16x16x32_bf16 v[244:247], v[60:63], v[108:111], v[244:247]
    v_mfma_f32_16x16x32_bf16 v[248:251], v[56:59], v[112:115], v[248:251]
    v_mfma_f32_16x16x32_bf16 v[248:251], v[60:63], v[116:119], v[248:251]
    v_mfma_f32_16x16x32_bf16 v[252:255], v[56:59], v[120:123], v[252:255]
    ds_read_b64_tr_b16 v[56:57], v28 offset:0
    ds_read_b64_tr_b16 v[58:59], v28 offset:512
    v_mfma_f32_16x16x32_bf16 v[252:255], v[60:63], v[124:127], v[252:255]
    ds_read_b64_tr_b16 v[60:61], v28 offset:4096
    ds_read_b64_tr_b16 v[62:63], v28 offset:4608
    v_mfma_f32_16x16x32_bf16 a[64:67], v[40:43], v[96:99], a[64:67]
    v_add_u32 v28, 0x10000, v28
    v_mfma_f32_16x16x32_bf16 a[64:67], v[44:47], v[100:103], a[64:67]
    v_add_u32 v24, 0x10000, v24
    v_mfma_f32_16x16x32_bf16 a[68:71], v[40:43], v[104:107], a[68:71]
    ds_read_b128 v[80:83], v24 offset:16384
    v_mfma_f32_16x16x32_bf16 a[68:71], v[44:47], v[108:111], a[68:71]
    v_mfma_f32_16x16x32_bf16 a[72:75], v[40:43], v[112:115], a[72:75]
    v_mfma_f32_16x16x32_bf16 a[72:75], v[44:47], v[116:119], a[72:75]
    v_add_u32 v25, 0x10000, v25
    v_mfma_f32_16x16x32_bf16 a[76:79], v[40:43], v[120:123], a[76:79]
    ds_read_b128 v[84:87], v25 offset:16384
    v_mfma_f32_16x16x32_bf16 a[76:79], v[44:47], v[124:127], a[76:79]
    v_mfma_f32_16x16x32_bf16 a[128:131], v[40:43], a[136:139], a[128:131]
    ds_read_b64_tr_b16 v[40:41], v29 offset:0
    ds_read_b64_tr_b16 v[42:43], v29 offset:512
    v_mfma_f32_16x16x32_bf16 a[128:131], v[44:47], a[140:143], a[128:131]
    s_waitcnt lgkmcnt(3)
    ds_read_b64_tr_b16 v[44:45], v29 offset:4096
    ds_read_b64_tr_b16 v[46:47], v29 offset:4608
    v_mfma_f32_16x16x32_bf16 a[80:83], v[48:51], v[96:99], a[80:83]
    ds_read_b128 v[88:91], v24 offset:24576
    v_add_u32 v29, 0x10000, v29
    v_mfma_f32_16x16x32_bf16 a[80:83], v[52:55], v[100:103], a[80:83]
    v_mfma_f32_16x16x32_bf16 a[84:87], v[48:51], v[104:107], a[84:87]
    v_mfma_f32_16x16x32_bf16 a[84:87], v[52:55], v[108:111], a[84:87]
    v_mfma_f32_16x16x32_bf16 a[88:91], v[48:51], v[112:115], a[88:91]
    ds_read_b128 v[92:95], v25 offset:24576
    v_mfma_f32_16x16x32_bf16 a[88:91], v[52:55], v[116:119], a[88:91]
    v_mfma_f32_16x16x32_bf16 a[92:95], v[48:51], v[120:123], a[92:95]
    v_mfma_f32_16x16x32_bf16 a[92:95], v[52:55], v[124:127], a[92:95]
    v_mfma_f32_16x16x32_bf16 a[132:135], v[48:51], a[136:139], a[132:135]
    v_mfma_f32_16x16x32_bf16 a[132:135], v[52:55], a[140:143], a[132:135]
    v_mfma_f32_16x16x32_bf16 a[96:99], v[56:59], v[96:99], a[96:99]
    v_mfma_f32_16x16x32_bf16 a[96:99], v[60:63], v[100:103], a[96:99]
    v_mfma_f32_16x16x32_bf16 a[100:103], v[56:59], v[104:107], a[100:103]
    v_mfma_f32_16x16x32_bf16 a[100:103], v[60:63], v[108:111], a[100:103]
    v_mfma_f32_16x16x32_bf16 a[104:107], v[56:59], v[112:115], a[104:107]
    v_mfma_f32_16x16x32_bf16 a[104:107], v[60:63], v[116:119], a[104:107]
    s_waitcnt vmcnt(0) lgkmcnt(0)
    s_barrier
    ds_read_b64_tr_b16 v[48:49], v14 offset:32768
    v_mfma_f32_16x16x32_bf16 a[108:111], v[56:59], v[120:123], a[108:111]
    ds_read_b64_tr_b16 v[50:51], v14 offset:33792
    ds_read_b64_tr_b16 v[52:53], v14 offset:40960
    v_mfma_f32_16x16x32_bf16 a[108:111], v[60:63], v[124:127], a[108:111]
    ds_read_b64_tr_b16 v[54:55], v14 offset:41984
    ds_read_b64_tr_b16 v[56:57], v15 offset:32768
    v_mfma_f32_16x16x32_bf16 a[112:115], v[40:43], v[96:99], a[112:115]
    ds_read_b64_tr_b16 v[58:59], v15 offset:33792
    ds_read_b64_tr_b16 v[60:61], v15 offset:40960
    v_mfma_f32_16x16x32_bf16 a[112:115], v[44:47], v[100:103], a[112:115]
    ds_read_b64_tr_b16 v[62:63], v15 offset:41984
    ds_read_b128 a[136:139], v22 offset:0
    v_mfma_f32_16x16x32_bf16 a[116:119], v[40:43], v[104:107], a[116:119]
    ds_read_b128 a[140:143], v23 offset:0
    v_mfma_f32_16x16x32_bf16 a[116:119], v[44:47], v[108:111], a[116:119]
    v_mfma_f32_16x16x32_bf16 a[120:123], v[40:43], v[112:115], a[120:123]
    v_mfma_f32_16x16x32_bf16 a[120:123], v[44:47], v[116:119], a[120:123]
    v_mfma_f32_16x16x32_bf16 a[124:127], v[40:43], v[120:123], a[124:127]
    ds_read_b64_tr_b16 v[40:41], v16 offset:32768
    ds_read_b64_tr_b16 v[42:43], v16 offset:33792
    v_mfma_f32_16x16x32_bf16 a[124:127], v[44:47], v[124:127], a[124:127]
    s_waitcnt lgkmcnt(2)
    ds_read_b64_tr_b16 v[44:45], v16 offset:40960
    ds_read_b64_tr_b16 v[46:47], v16 offset:41984
    v_mfma_f32_16x16x32_bf16 v[128:131], v[48:51], v[64:67], v[128:131]
    v_mfma_f32_16x16x32_bf16 v[128:131], v[52:55], v[68:71], v[128:131]
    v_mfma_f32_16x16x32_bf16 v[132:135], v[48:51], v[72:75], v[132:135]
    v_mfma_f32_16x16x32_bf16 v[132:135], v[52:55], v[76:79], v[132:135]
    v_mfma_f32_16x16x32_bf16 v[136:139], v[48:51], v[80:83], v[136:139]
    v_mfma_f32_16x16x32_bf16 v[136:139], v[52:55], v[84:87], v[136:139]
    v_mfma_f32_16x16x32_bf16 v[140:143], v[48:51], v[88:91], v[140:143]
    ds_read_b64_tr_b16 v[48:49], v17 offset:32768
    ds_read_b64_tr_b16 v[50:51], v17 offset:33792
    v_mfma_f32_16x16x32_bf16 v[140:143], v[52:55], v[92:95], v[140:143]
    ds_read_b64_tr_b16 v[52:53], v17 offset:40960
    ds_read_b64_tr_b16 v[54:55], v17 offset:41984
    v_mfma_f32_16x16x32_bf16 v[144:147], v[56:59], v[64:67], v[144:147]
    v_mul_f32 v128, s74, v128
    v_mul_f32 v129, s74, v129
    v_mfma_f32_16x16x32_bf16 v[144:147], v[60:63], v[68:71], v[144:147]
    v_mul_f32 v130, s74, v130
    v_mul_f32 v131, s74, v131
    v_mfma_f32_16x16x32_bf16 v[148:151], v[56:59], v[72:75], v[148:151]
    v_mul_f32 v132, s74, v132
    v_mul_f32 v133, s74, v133
    v_mfma_f32_16x16x32_bf16 v[148:151], v[60:63], v[76:79], v[148:151]
    v_mul_f32 v134, s74, v134
    v_mul_f32 v135, s74, v135
    v_mfma_f32_16x16x32_bf16 v[152:155], v[56:59], v[80:83], v[152:155]
    v_mul_f32 v136, s74, v136
    v_mul_f32 v137, s74, v137
    v_mfma_f32_16x16x32_bf16 v[152:155], v[60:63], v[84:87], v[152:155]
    v_mul_f32 v138, s74, v138
    v_mul_f32 v139, s74, v139
    v_mfma_f32_16x16x32_bf16 v[156:159], v[56:59], v[88:91], v[156:159]
    ds_read_b64_tr_b16 v[56:57], v18 offset:32768
    ds_read_b64_tr_b16 v[58:59], v18 offset:33792
    v_mfma_f32_16x16x32_bf16 v[156:159], v[60:63], v[92:95], v[156:159]
    s_waitcnt lgkmcnt(2)
    ds_read_b64_tr_b16 v[60:61], v18 offset:40960
    ds_read_b64_tr_b16 v[62:63], v18 offset:41984
    v_mfma_f32_16x16x32_bf16 v[160:163], v[40:43], v[64:67], v[160:163]
    v_mul_f32 v140, s74, v140
    v_mul_f32 v141, s74, v141
    v_mfma_f32_16x16x32_bf16 v[160:163], v[44:47], v[68:71], v[160:163]
    v_mul_f32 v142, s74, v142
    v_mul_f32 v143, s74, v143
    v_mfma_f32_16x16x32_bf16 v[164:167], v[40:43], v[72:75], v[164:167]
    v_mul_f32 v144, s74, v144
    v_mul_f32 v145, s74, v145
    v_mfma_f32_16x16x32_bf16 v[164:167], v[44:47], v[76:79], v[164:167]
    buffer_load_dword v7, v8, s[32:35], s61 offen sc1
    v_mfma_f32_16x16x32_bf16 v[168:171], v[40:43], v[80:83], v[168:171]
    v_mul_f32 v146, s74, v146
    v_mul_f32 v147, s74, v147
    v_mfma_f32_16x16x32_bf16 v[168:171], v[44:47], v[84:87], v[168:171]
    v_mul_f32 v148, s74, v148
    v_mul_f32 v149, s74, v149
    v_mfma_f32_16x16x32_bf16 v[172:175], v[40:43], v[88:91], v[172:175]
    ds_read_b64_tr_b16 v[40:41], v19 offset:32768
    ds_read_b64_tr_b16 v[42:43], v19 offset:33792
    v_mfma_f32_16x16x32_bf16 v[172:175], v[44:47], v[92:95], v[172:175]
    ds_read_b64_tr_b16 v[44:45], v19 offset:40960
    ds_read_b64_tr_b16 v[46:47], v19 offset:41984
    v_mfma_f32_16x16x32_bf16 v[176:179], v[48:51], v[64:67], v[176:179]
    v_mul_f32 v150, s74, v150
    v_mul_f32 v151, s74, v151
    v_mfma_f32_16x16x32_bf16 v[176:179], v[52:55], v[68:71], v[176:179]
    v_mul_f32 v152, s74, v152
    v_mul_f32 v153, s74, v153
    v_mfma_f32_16x16x32_bf16 v[180:183], v[48:51], v[72:75], v[180:183]
    v_mul_f32 v154, s74, v154
    v_mul_f32 v155, s74, v155
    v_mfma_f32_16x16x32_bf16 v[180:183], v[52:55], v[76:79], v[180:183]
    v_mul_f32 v156, s74, v156
    v_mul_f32 v157, s74, v157
    v_mfma_f32_16x16x32_bf16 v[184:187], v[48:51], v[80:83], v[184:187]
    v_mul_f32 v158, s74, v158
    v_mul_f32 v159, s74, v159
    v_mfma_f32_16x16x32_bf16 v[184:187], v[52:55], v[84:87], v[184:187]
    v_mul_f32 v160, s74, v160
    v_mul_f32 v161, s74, v161
    v_mfma_f32_16x16x32_bf16 v[188:191], v[48:51], v[88:91], v[188:191]
    ds_read_b64_tr_b16 v[48:49], v20 offset:32768
    ds_read_b64_tr_b16 v[50:51], v20 offset:33792
    v_mfma_f32_16x16x32_bf16 v[188:191], v[52:55], v[92:95], v[188:191]
    s_waitcnt lgkmcnt(2)
    ds_read_b64_tr_b16 v[52:53], v20 offset:40960
    ds_read_b64_tr_b16 v[54:55], v20 offset:41984
    v_mfma_f32_16x16x32_bf16 v[192:195], v[56:59], v[64:67], v[192:195]
    v_mul_f32 v162, s74, v162
    v_mul_f32 v163, s74, v163
    v_mfma_f32_16x16x32_bf16 v[192:195], v[60:63], v[68:71], v[192:195]
    v_mul_f32 v164, s74, v164
    v_mul_f32 v165, s74, v165
    v_mfma_f32_16x16x32_bf16 v[196:199], v[56:59], v[72:75], v[196:199]
    v_mul_f32 v166, s74, v166
    v_mul_f32 v167, s74, v167
    v_mfma_f32_16x16x32_bf16 v[196:199], v[60:63], v[76:79], v[196:199]
    v_mul_f32 v168, s74, v168
    v_mul_f32 v169, s74, v169
    v_mfma_f32_16x16x32_bf16 v[200:203], v[56:59], v[80:83], v[200:203]
    v_mul_f32 v170, s74, v170
    v_mul_f32 v171, s74, v171
    v_mfma_f32_16x16x32_bf16 v[200:203], v[60:63], v[84:87], v[200:203]
    v_mul_f32 v172, s74, v172
    v_mul_f32 v173, s74, v173
    v_mfma_f32_16x16x32_bf16 v[204:207], v[56:59], v[88:91], v[204:207]
    ds_read_b64_tr_b16 v[56:57], v21 offset:32768
    ds_read_b64_tr_b16 v[58:59], v21 offset:33792
    v_mfma_f32_16x16x32_bf16 v[204:207], v[60:63], v[92:95], v[204:207]
    ds_read_b64_tr_b16 v[60:61], v21 offset:40960
    ds_read_b64_tr_b16 v[62:63], v21 offset:41984
    v_mfma_f32_16x16x32_bf16 v[208:211], v[40:43], v[64:67], v[208:211]
    v_mul_f32 v174, s74, v174
    v_mul_f32 v175, s74, v175
    v_mfma_f32_16x16x32_bf16 v[208:211], v[44:47], v[68:71], v[208:211]
    v_mul_f32 v176, s74, v176
    v_mul_f32 v177, s74, v177
    v_mfma_f32_16x16x32_bf16 v[212:215], v[40:43], v[72:75], v[212:215]
    v_mul_f32 v178, s74, v178
    v_mul_f32 v179, s74, v179
    v_mfma_f32_16x16x32_bf16 v[212:215], v[44:47], v[76:79], v[212:215]
    v_mul_f32 v180, s74, v180
    v_mul_f32 v181, s74, v181
    v_mfma_f32_16x16x32_bf16 v[216:219], v[40:43], v[80:83], v[216:219]
    v_mul_f32 v182, s74, v182
    v_mul_f32 v183, s74, v183
    v_mfma_f32_16x16x32_bf16 v[216:219], v[44:47], v[84:87], v[216:219]
    v_mul_f32 v184, s74, v184
    v_mul_f32 v185, s74, v185
    v_mfma_f32_16x16x32_bf16 v[220:223], v[40:43], v[88:91], v[220:223]
    ds_read_b64_tr_b16 v[40:41], v26 offset:0
    ds_read_b64_tr_b16 v[42:43], v26 offset:512
    v_mfma_f32_16x16x32_bf16 v[220:223], v[44:47], v[92:95], v[220:223]
    s_waitcnt lgkmcnt(2)
    ds_read_b64_tr_b16 v[44:45], v26 offset:4096
    ds_read_b64_tr_b16 v[46:47], v26 offset:4608
    v_mfma_f32_16x16x32_bf16 v[224:227], v[48:51], v[64:67], v[224:227]
    v_mul_f32 v186, s74, v186
    v_mul_f32 v187, s74, v187
    v_mfma_f32_16x16x32_bf16 v[224:227], v[52:55], v[68:71], v[224:227]
    v_mul_f32 v188, s74, v188
    v_mul_f32 v189, s74, v189
    v_mfma_f32_16x16x32_bf16 v[228:231], v[48:51], v[72:75], v[228:231]
    v_mul_f32 v190, s74, v190
    v_mul_f32 v191, s74, v191
    v_mfma_f32_16x16x32_bf16 v[228:231], v[52:55], v[76:79], v[228:231]
    v_mul_f32 v192, s74, v192
    v_mul_f32 v193, s74, v193
    v_mfma_f32_16x16x32_bf16 v[232:235], v[48:51], v[80:83], v[232:235]
    v_mul_f32 v194, s74, v194
    v_mul_f32 v195, s74, v195
    v_mfma_f32_16x16x32_bf16 v[232:235], v[52:55], v[84:87], v[232:235]
    s_mov_b32 s38, 16384
    v_mul_f32 v196, s74, v196
    v_mul_f32 v197, s74, v197
    s_waitcnt vmcnt(0)
    v_cmp_gt_u32 vcc, 1, v7
    s_nop 1
    s_and_b64 vcc, vcc, exec
    s_cbranch_scc1 SPIN_KV
BACK_KV:
    v_mfma_f32_16x16x32_bf16 v[236:239], v[48:51], v[88:91], v[236:239]
    s_mov_b32 s77, s75
    ds_read_b64_tr_b16 v[48:49], v27 offset:0
    ds_read_b64_tr_b16 v[50:51], v27 offset:512
    v_mfma_f32_16x16x32_bf16 v[236:239], v[52:55], v[92:95], v[236:239]
    s_add_u32 m0, s76, s75
    ds_read_b64_tr_b16 v[52:53], v27 offset:4096
    ds_read_b64_tr_b16 v[54:55], v27 offset:4608
    v_mfma_f32_16x16x32_bf16 v[240:243], v[56:59], v[64:67], v[240:243]
    buffer_load_dwordx4 v1, s[36:39], s77 offen sc1 lds
    v_mfma_f32_16x16x32_bf16 v[240:243], v[60:63], v[68:71], v[240:243]
    v_mul_f32 v198, s74, v198
    v_mul_f32 v199, s74, v199
    v_mfma_f32_16x16x32_bf16 v[244:247], v[56:59], v[72:75], v[244:247]
    buffer_load_dwordx4 v1, s[36:39], s77 offen offset:1024 sc1 lds
    v_mfma_f32_16x16x32_bf16 v[244:247], v[60:63], v[76:79], v[244:247]
    v_mul_f32 v200, s74, v200
    v_mul_f32 v201, s74, v201
    v_mfma_f32_16x16x32_bf16 v[248:251], v[56:59], v[80:83], v[248:251]
    v_mul_f32 v202, s74, v202
    v_mul_f32 v203, s74, v203
    v_mfma_f32_16x16x32_bf16 v[248:251], v[60:63], v[84:87], v[248:251]
    v_mul_f32 v204, s74, v204
    v_mul_f32 v205, s74, v205
    v_mfma_f32_16x16x32_bf16 v[252:255], v[56:59], v[88:91], v[252:255]
    buffer_load_dwordx4 v1, s[36:39], s77 offen offset:2048 sc1 lds
    v_mfma_f32_16x16x32_bf16 v[252:255], v[60:63], v[92:95], v[252:255]
    s_waitcnt lgkmcnt(0)
    ds_read_b64_tr_b16 v[56:57], v28 offset:0
    ds_read_b64_tr_b16 v[58:59], v28 offset:512
    v_mfma_f32_16x16x32_bf16 a[64:67], v[40:43], v[64:67], a[64:67]
    ds_read_b64_tr_b16 v[60:61], v28 offset:4096
    ds_read_b64_tr_b16 v[62:63], v28 offset:4608
    v_mfma_f32_16x16x32_bf16 a[64:67], v[44:47], v[68:71], a[64:67]
    v_mul_f32 v206, s74, v206
    v_mul_f32 v207, s74, v207
    v_mfma_f32_16x16x32_bf16 a[68:71], v[40:43], v[72:75], a[68:71]
    buffer_load_dwordx4 v1, s[36:39], s77 offen offset:3072 sc1 lds
    v_mfma_f32_16x16x32_bf16 a[68:71], v[44:47], v[76:79], a[68:71]
    v_mul_f32 v208, s74, v208
    v_mul_f32 v209, s74, v209
    v_mfma_f32_16x16x32_bf16 a[72:75], v[40:43], v[80:83], a[72:75]
    v_mul_f32 v210, s74, v210
    v_mul_f32 v211, s74, v211
    v_mfma_f32_16x16x32_bf16 a[72:75], v[44:47], v[84:87], a[72:75]
    s_add_u32 s100, s77, 4096
    v_mul_f32 v212, s74, v212
    v_mul_f32 v213, s74, v213
    v_mfma_f32_16x16x32_bf16 a[76:79], v[40:43], v[88:91], a[76:79]
    s_add_u32 m0, m0, 4096
    v_mul_f32 v214, s74, v214
    v_mul_f32 v215, s74, v215
    v_mfma_f32_16x16x32_bf16 a[76:79], v[44:47], v[92:95], a[76:79]
    buffer_load_dwordx4 v1, s[36:39], s100 offen sc1 lds
    v_mfma_f32_16x16x32_bf16 a[128:131], v[40:43], a[136:139], a[128:131]
    ds_read_b64_tr_b16 v[40:41], v29 offset:0
    ds_read_b64_tr_b16 v[42:43], v29 offset:512
    v_mfma_f32_16x16x32_bf16 a[128:131], v[44:47], a[140:143], a[128:131]
    ds_read_b64_tr_b16 v[44:45], v29 offset:4096
    ds_read_b64_tr_b16 v[46:47], v29 offset:4608
    v_mfma_f32_16x16x32_bf16 a[80:83], v[48:51], v[64:67], a[80:83]
    buffer_load_dwordx4 v1, s[36:39], s100 offen offset:1024 sc1 lds
    v_mfma_f32_16x16x32_bf16 a[80:83], v[52:55], v[68:71], a[80:83]
    v_mul_f32 v216, s74, v216
    v_mul_f32 v217, s74, v217
    v_mfma_f32_16x16x32_bf16 a[84:87], v[48:51], v[72:75], a[84:87]
    v_mul_f32 v218, s74, v218
    v_mul_f32 v219, s74, v219
    v_mfma_f32_16x16x32_bf16 a[84:87], v[52:55], v[76:79], a[84:87]
    v_mul_f32 v220, s74, v220
    v_mul_f32 v221, s74, v221
    v_mfma_f32_16x16x32_bf16 a[88:91], v[48:51], v[80:83], a[88:91]
    buffer_load_dwordx4 v1, s[36:39], s100 offen offset:2048 sc1 lds
    v_mfma_f32_16x16x32_bf16 a[88:91], v[52:55], v[84:87], a[88:91]
    v_mul_f32 v222, s74, v222
    v_mul_f32 v223, s74, v223
    v_mfma_f32_16x16x32_bf16 a[92:95], v[48:51], v[88:91], a[92:95]
    v_mul_f32 v224, s74, v224
    v_mul_f32 v225, s74, v225
    v_mfma_f32_16x16x32_bf16 a[92:95], v[52:55], v[92:95], a[92:95]
    v_mul_f32 v226, s74, v226
    v_mul_f32 v227, s74, v227
    v_mfma_f32_16x16x32_bf16 a[132:135], v[48:51], a[136:139], a[132:135]
    buffer_load_dwordx4 v1, s[36:39], s100 offen offset:3072 sc1 lds
    v_mfma_f32_16x16x32_bf16 a[132:135], v[52:55], a[140:143], a[132:135]
    s_waitcnt lgkmcnt(0)
    v_mul_f32 v228, s74, v228
    v_mul_f32 v229, s74, v229
    v_mfma_f32_16x16x32_bf16 a[96:99], v[56:59], v[64:67], a[96:99]
    v_mul_f32 v230, s74, v230
    v_mul_f32 v231, s74, v231
    v_mfma_f32_16x16x32_bf16 a[96:99], v[60:63], v[68:71], a[96:99]
    s_lshr_b32 s82, s4, 1
    s_add_u32 s82, s82, 32
    v_mul_f32 v232, s74, v232
    v_mfma_f32_16x16x32_bf16 a[100:103], v[56:59], v[72:75], a[100:103]
    s_sub_u32 s82, s82, s6
    v_mul_f32 v233, s74, v233
    v_mul_f32 v234, s74, v234
    v_mfma_f32_16x16x32_bf16 a[100:103], v[60:63], v[76:79], a[100:103]
    s_sub_u32 s82, s82, s6
    v_mul_f32 v235, s74, v235
    v_mul_f32 v236, s74, v236
    v_mfma_f32_16x16x32_bf16 a[104:107], v[56:59], v[80:83], a[104:107]
    s_add_u32 s77, s77, 32768
    s_add_u32 s76, s76, 32768
    s_lshl_b32 s38, s82, 15
    v_mfma_f32_16x16x32_bf16 a[104:107], v[60:63], v[84:87], a[104:107]
    v_mul_f32 v237, s74, v237
    v_mul_f32 v238, s74, v238
    v_mfma_f32_16x16x32_bf16 a[108:111], v[56:59], v[88:91], a[108:111]
    v_mul_f32 v239, s74, v239
    v_mul_f32 v240, s74, v240
    v_mfma_f32_16x16x32_bf16 a[108:111], v[60:63], v[92:95], a[108:111]
    v_mul_f32 v241, s74, v241
    v_mul_f32 v242, s74, v242
    v_mfma_f32_16x16x32_bf16 a[112:115], v[40:43], v[64:67], a[112:115]
    v_mul_f32 v243, s74, v243
    v_mul_f32 v244, s74, v244
    v_mfma_f32_16x16x32_bf16 a[112:115], v[44:47], v[68:71], a[112:115]
    v_mul_f32 v245, s74, v245
    v_mul_f32 v246, s74, v246
    v_mfma_f32_16x16x32_bf16 a[116:119], v[40:43], v[72:75], a[116:119]
    v_mul_f32 v247, s74, v247
    v_mul_f32 v248, s74, v248
    v_mfma_f32_16x16x32_bf16 a[116:119], v[44:47], v[76:79], a[116:119]
    v_mul_f32 v249, s74, v249
    v_mul_f32 v250, s74, v250
    v_mfma_f32_16x16x32_bf16 a[120:123], v[40:43], v[80:83], a[120:123]
    v_mul_f32 v251, s74, v251
    v_mul_f32 v252, s74, v252
    v_mfma_f32_16x16x32_bf16 a[120:123], v[44:47], v[84:87], a[120:123]
    v_mul_f32 v253, s74, v253
    v_mul_f32 v254, s74, v254
    v_mfma_f32_16x16x32_bf16 a[124:127], v[40:43], v[88:91], a[124:127]
    v_mul_f32 v255, s74, v255
    v_cvt_pk_bf16_f32 v128, v128, v129
    v_mfma_f32_16x16x32_bf16 a[124:127], v[44:47], v[92:95], a[124:127]
    s_add_u32 m0, s76, s75
    s_nop 0
    buffer_load_dwordx4 v1, s[36:39], s77 offen sc1 lds
    v_cvt_pk_bf16_f32 v129, v130, v131
    v_cvt_pk_bf16_f32 v130, v144, v145
    v_cvt_pk_bf16_f32 v131, v146, v147
    v_cvt_pk_bf16_f32 v132, v132, v133
    v_cvt_pk_bf16_f32 v133, v134, v135
    v_cvt_pk_bf16_f32 v134, v148, v149
    v_cvt_pk_bf16_f32 v135, v150, v151
    v_cvt_pk_bf16_f32 v136, v136, v137
    v_cvt_pk_bf16_f32 v137, v138, v139
    v_cvt_pk_bf16_f32 v138, v152, v153
    v_cvt_pk_bf16_f32 v139, v154, v155
    v_cvt_pk_bf16_f32 v140, v140, v141
    v_cvt_pk_bf16_f32 v141, v142, v143
    v_cvt_pk_bf16_f32 v142, v156, v157
    buffer_load_dwordx4 v1, s[36:39], s77 offen offset:1024 sc1 lds
    v_cvt_pk_bf16_f32 v143, v158, v159
    v_cvt_pk_bf16_f32 v160, v160, v161
    v_cvt_pk_bf16_f32 v161, v162, v163
    v_cvt_pk_bf16_f32 v162, v176, v177
    v_cvt_pk_bf16_f32 v163, v178, v179
    v_cvt_pk_bf16_f32 v164, v164, v165
    v_cvt_pk_bf16_f32 v165, v166, v167
    v_cvt_pk_bf16_f32 v166, v180, v181
    v_cvt_pk_bf16_f32 v167, v182, v183
    v_cvt_pk_bf16_f32 v168, v168, v169
    v_cvt_pk_bf16_f32 v169, v170, v171
    v_cvt_pk_bf16_f32 v170, v184, v185
    v_cvt_pk_bf16_f32 v171, v186, v187
    v_cvt_pk_bf16_f32 v172, v172, v173
    v_cvt_pk_bf16_f32 v173, v174, v175
    buffer_load_dwordx4 v1, s[36:39], s77 offen offset:2048 sc1 lds
    v_cvt_pk_bf16_f32 v174, v188, v189
    v_cvt_pk_bf16_f32 v175, v190, v191
    v_cvt_pk_bf16_f32 v192, v192, v193
    v_cvt_pk_bf16_f32 v193, v194, v195
    v_cvt_pk_bf16_f32 v194, v208, v209
    v_cvt_pk_bf16_f32 v195, v210, v211
    v_cvt_pk_bf16_f32 v196, v196, v197
    v_cvt_pk_bf16_f32 v197, v198, v199
    v_cvt_pk_bf16_f32 v198, v212, v213
    v_cvt_pk_bf16_f32 v199, v214, v215
    v_cvt_pk_bf16_f32 v200, v200, v201
    v_cvt_pk_bf16_f32 v201, v202, v203
    v_cvt_pk_bf16_f32 v202, v216, v217
    v_cvt_pk_bf16_f32 v203, v218, v219
    v_cvt_pk_bf16_f32 v204, v204, v205
    buffer_load_dwordx4 v1, s[36:39], s77 offen offset:3072 sc1 lds
    v_cvt_pk_bf16_f32 v205, v206, v207
    v_cvt_pk_bf16_f32 v206, v220, v221
    v_cvt_pk_bf16_f32 v207, v222, v223
    v_cvt_pk_bf16_f32 v224, v224, v225
    v_cvt_pk_bf16_f32 v225, v226, v227
    v_cvt_pk_bf16_f32 v226, v240, v241
    v_cvt_pk_bf16_f32 v227, v242, v243
    v_cvt_pk_bf16_f32 v228, v228, v229
    v_cvt_pk_bf16_f32 v229, v230, v231
    v_cvt_pk_bf16_f32 v230, v244, v245
    v_cvt_pk_bf16_f32 v231, v246, v247
    v_cvt_pk_bf16_f32 v232, v232, v233
    v_cvt_pk_bf16_f32 v233, v234, v235
    v_cvt_pk_bf16_f32 v234, v248, v249
    v_cvt_pk_bf16_f32 v235, v250, v251
    s_add_u32 s100, s77, 4096
    s_add_u32 m0, m0, 4096
    s_nop 0
    buffer_load_dwordx4 v1, s[36:39], s100 offen sc1 lds
    v_cvt_pk_bf16_f32 v236, v236, v237
    v_cvt_pk_bf16_f32 v237, v238, v239
    v_cvt_pk_bf16_f32 v238, v252, v253
    v_cvt_pk_bf16_f32 v239, v254, v255
    v_mov_b32 v8, 0x3f803f80
    v_accvgpr_write_b32 a136, v8
    v_accvgpr_write_b32 a137, v8
    v_accvgpr_write_b32 a138, v8
    v_accvgpr_write_b32 a139, v8
    s_mov_b64 s[84:85], 0
    s_mov_b32 s83, 0
    v_bfe_u32 v8, v1, 4, 4
    v_lshrrev_b32 v9, 8, v1
    v_lshlrev_b32 v9, 2, v9
    buffer_load_dwordx4 v1, s[36:39], s100 offen offset:1024 sc1 lds
    v_sub_u32 v8, v8, v9
    v_mov_b32 v9, 0xf149f2ca
    v_cmp_le_i32 vcc, 0, v8
    s_cmp_eq_u32 s4, 0
    s_cselect_b32 s8, 1.0, 0
    v_cndmask_b32_e64 v208, v9, 0, vcc
    s_cmp_lt_u32 s4, 0
    s_cselect_b32 s12, 0xf149f2ca, 0
    v_cmp_le_i32 vcc, 1, v8
    s_cmp_eq_u32 s4, 1
    s_cselect_b32 s9, 1.0, 0
    v_cndmask_b32_e64 v209, v9, 0, vcc
    s_cmp_lt_u32 s4, 1
    s_cselect_b32 s13, 0xf149f2ca, 0
    v_cmp_le_i32 vcc, 2, v8
    buffer_load_dwordx4 v1, s[36:39], s100 offen offset:2048 sc1 lds
    s_cmp_eq_u32 s4, 2
    s_cselect_b32 s10, 1.0, 0
    v_cndmask_b32_e64 v210, v9, 0, vcc
    s_cmp_lt_u32 s4, 2
    s_cselect_b32 s14, 0xf149f2ca, 0
    v_cmp_le_i32 vcc, 3, v8
    s_cmp_eq_u32 s4, 3
    s_cselect_b32 s11, 1.0, 0
    v_cndmask_b32_e64 v211, v9, 0, vcc
    s_cmp_lt_u32 s4, 3
    s_cselect_b32 s15, 0xf149f2ca, 0
    s_sub_u32 s40, s56, 20971520
    s_subb_u32 s41, s57, 0
    s_mov_b32 s42, 19922944
    s_mov_b32 s43, 0x20000
    buffer_load_dwordx4 v1, s[36:39], s100 offen offset:3072 sc1 lds
    s_add_u32 s77, s77, 32768
    s_add_u32 s76, s76, 32768
    s_lshl3_add_u32 s80, s6, s4
    s_mul_i32 s80, s80, 155648
    s_sub_u32 s7, 15, s6
    s_lshl3_add_u32 s81, s7, s4
    s_mul_i32 s81, s81, 155648
    s_lshl_b32 s7, s5, 12
    s_add_u32 s80, s80, s7
    s_add_u32 s81, s81, s7
    s_lshr_b32 s7, s5, 3
    s_lshl_b32 s7, s7, 10
    s_lshl2_add_u32 s7, s75, s7
    s_add_u32 s92, s7, 32768
    s_load_dwordx2 s[24:25], s[0:1], 80
    s_mov_b32 s26, 2359296
    s_mov_b32 s27, 0x20000
K1_ATT:
    s_mov_b32 s82, 0
    s_mov_b32 s60, 131072
    v_mov_b32 v2, v1
    s_cmp_eq_u32 s6, 0
    s_cselect_b32 s16, s8, 0
    s_cselect_b32 s17, s9, 0
    s_cselect_b32 s18, s10, 0
    s_cselect_b32 s19, s11, 0
    s_cselect_b32 s20, s12, 0
    s_cselect_b32 s21, s13, 0
    s_cselect_b32 s22, s14, 0
    s_cselect_b32 s23, s15, 0
    s_waitcnt vmcnt(8) lgkmcnt(0)
    s_barrier
    ds_read_b128 a[224:227], v2 offset:0
    ds_read_b128 a[228:231], v2 offset:1024
    ds_read_b128 a[232:235], v2 offset:2048
    ds_read_b128 a[236:239], v2 offset:3072
    ds_read_b128 v[96:99], v2 offset:16384
    ds_read_b128 v[100:103], v2 offset:17408
    s_cmp_lg_u32 s83, 0
    s_cbranch_scc1 K1_HAVEM_R
    s_add_u32 m0, s76, s75
    s_nop 0
    buffer_load_dwordx4 v1, s[36:39], s77 offen sc1 lds
    v_mul_f32 v176, s16, v208
    v_mul_f32 v177, s16, v209
    v_mul_f32 v178, s16, v210
    v_mul_f32 v179, s16, v211
    s_waitcnt lgkmcnt(2)
    buffer_load_dwordx4 v1, s[36:39], s77 offen offset:1024 sc1 lds
    v_mfma_f32_16x16x32_bf16 v[240:243], a[224:227], v[128:131], v[176:179]
    v_mfma_f32_16x16x32_bf16 v[240:243], a[228:231], v[160:163], v[240:243]
    v_mfma_f32_16x16x32_bf16 v[240:243], a[232:235], v[192:195], v[240:243]
    v_mfma_f32_16x16x32_bf16 v[240:243], a[236:239], v[224:227], v[240:243]
    v_mfma_f32_16x16x32_bf16 v[244:247], a[224:227], v[132:135], 0
    buffer_load_dwordx4 v1, s[36:39], s77 offen offset:2048 sc1 lds
    v_mfma_f32_16x16x32_bf16 v[244:247], a[228:231], v[164:167], v[244:247]
    v_mfma_f32_16x16x32_bf16 v[244:247], a[232:235], v[196:199], v[244:247]
    v_mfma_f32_16x16x32_bf16 v[244:247], a[236:239], v[228:231], v[244:247]
    v_mfma_f32_16x16x32_bf16 v[248:251], a[224:227], v[136:139], 0
    v_mfma_f32_16x16x32_bf16 v[248:251], a[228:231], v[168:171], v[248:251]
    buffer_load_dwordx4 v1, s[36:39], s77 offen offset:3072 sc1 lds
    s_add_u32 s100, s77, 4096
    v_mfma_f32_16x16x32_bf16 v[248:251], a[232:235], v[200:203], v[248:251]
    v_mfma_f32_16x16x32_bf16 v[248:251], a[236:239], v[232:235], v[248:251]
    v_mfma_f32_16x16x32_bf16 v[252:255], a[224:227], v[140:143], 0
    v_mfma_f32_16x16x32_bf16 v[252:255], a[228:231], v[172:175], v[252:255]
    v_mfma_f32_16x16x32_bf16 v[252:255], a[232:235], v[204:207], v[252:255]
    v_mfma_f32_16x16x32_bf16 v[252:255], a[236:239], v[236:239], v[252:255]
    s_add_u32 m0, m0, 4096
    s_nop 0
    buffer_load_dwordx4 v1, s[36:39], s100 offen sc1 lds
    v_max3_f32 v240, v240, v241, v242
    v_max_f32 v240, v240, v243
    v_max3_f32 v244, v244, v245, v246
    v_max_f32 v244, v244, v247
    v_max3_f32 v248, v248, v249, v250
    v_max_f32 v248, v248, v251
    v_max3_f32 v252, v252, v253, v254
    v_max_f32 v252, v252, v255
    v_mov_b32 v241, v240
    v_mov_b32 v245, v244
    v_mov_b32 v249, v248
    v_mov_b32 v253, v252
    buffer_load_dwordx4 v1, s[36:39], s100 offen offset:1024 sc1 lds
    v_permlane32_swap_b32 v240, v241
    v_permlane32_swap_b32 v244, v245
    v_permlane32_swap_b32 v248, v249
    v_permlane32_swap_b32 v252, v253
    v_max_f32 v240, v240, v241
    v_max_f32 v244, v244, v245
    v_max_f32 v248, v248, v249
    v_max_f32 v252, v252, v253
    v_mov_b32 v241, v240
    v_mov_b32 v245, v244
    v_mov_b32 v249, v248
    v_mov_b32 v253, v252
    buffer_load_dwordx4 v1, s[36:39], s100 offen offset:2048 sc1 lds
    v_permlane16_swap_b32 v240, v241
    v_permlane16_swap_b32 v244, v245
    v_permlane16_swap_b32 v248, v249
    v_permlane16_swap_b32 v252, v253
    v_max_f32 v240, v240, v241
    v_max_f32 v244, v244, v245
    v_max_f32 v248, v248, v249
    v_max_f32 v252, v252, v253
    v_sub_f32 v144, 0, v240
    v_sub_f32 v145, 0, v240
    v_sub_f32 v146, 0, v240
    v_sub_f32 v147, 0, v240
    buffer_load_dwordx4 v1, s[36:39], s100 offen offset:3072 sc1 lds
    s_add_u32 s77, s77, 32768
    s_add_u32 s76, s76, 32768
    v_sub_f32 v148, 0, v244
    v_sub_f32 v149, 0, v244
    v_sub_f32 v150, 0, v244
    v_sub_f32 v151, 0, v244
    v_sub_f32 v152, 0, v248
    v_sub_f32 v153, 0, v248
    v_sub_f32 v154, 0, v248
    v_sub_f32 v155, 0, v248
    v_sub_f32 v156, 0, v252
    v_sub_f32 v157, 0, v252
    v_sub_f32 v158, 0, v252
    v_sub_f32 v159, 0, v252
K1_HAVEM:
    v_add_f32 v212, s20, v144
    v_fma_f32 v176, v208, s16, v212
    v_fma_f32 v177, v209, s16, v212
    v_fma_f32 v178, v210, s16, v212
    v_fma_f32 v179, v211, s16, v212
    s_nop 1
    s_waitcnt lgkmcnt(0)
    v_mfma_f32_16x16x32_bf16 v[240:243], a[224:227], v[128:131], v[176:179]
    s_add_u32 m0, s76, s75
    ds_read_b128 a[240:243], v2 offset:4096
    ds_read_b128 a[244:247], v2 offset:5120
    v_mfma_f32_16x16x32_bf16 v[240:243], a[228:231], v[160:163], v[240:243]
    s_mov_b32 s76, s60
    buffer_load_dwordx4 v1, s[36:39], s77 offen sc1 lds
    v_mfma_f32_16x16x32_bf16 v[240:243], a[232:235], v[192:195], v[240:243]
    s_mov_b32 s60, s82
    ds_read_b128 a[248:251], v2 offset:6144
    ds_read_b128 a[252:255], v2 offset:7168
    v_mfma_f32_16x16x32_bf16 v[240:243], a[236:239], v[224:227], v[240:243]
    s_add_u32 s82, s82, 32768
    v_add_f32 v213, s21, v144
    v_fma_f32 v180, v208, s17, v213
    v_mfma_f32_16x16x32_bf16 v[244:247], a[224:227], v[132:135], v[148:151]
    v_fma_f32 v181, v209, s17, v213
    v_fma_f32 v182, v210, s17, v213
    v_mfma_f32_16x16x32_bf16 v[244:247], a[228:231], v[164:167], v[244:247]
    v_fma_f32 v183, v211, s17, v213
    v_add_f32 v214, s22, v144
    v_mfma_f32_16x16x32_bf16 v[244:247], a[232:235], v[196:199], v[244:247]
    buffer_load_dwordx4 v1, s[36:39], s77 offen offset:1024 sc1 lds
    v_mfma_f32_16x16x32_bf16 v[244:247], a[236:239], v[228:231], v[244:247]
    v_exp_f32 v240, v240
    v_mfma_f32_16x16x32_bf16 v[248:251], a[224:227], v[136:139], v[152:155]
    v_exp_f32 v241, v241
    v_mfma_f32_16x16x32_bf16 v[248:251], a[228:231], v[168:171], v[248:251]
    v_exp_f32 v242, v242
    v_mfma_f32_16x16x32_bf16 v[248:251], a[232:235], v[200:203], v[248:251]
    v_exp_f32 v243, v243
    v_mfma_f32_16x16x32_bf16 v[248:251], a[236:239], v[232:235], v[248:251]
    buffer_load_dwordx4 v1, s[36:39], s77 offen offset:2048 sc1 lds
    v_mfma_f32_16x16x32_bf16 v[252:255], a[224:227], v[140:143], v[156:159]
    v_cvt_pk_bf16_f32 v32, v240, v241
    v_cvt_pk_bf16_f32 v33, v242, v243
    v_mfma_f32_16x16x32_bf16 v[252:255], a[228:231], v[172:175], v[252:255]
    v_exp_f32 v244, v244
    v_mfma_f32_16x16x32_bf16 v[252:255], a[232:235], v[204:207], v[252:255]
    v_exp_f32 v245, v245
    v_mfma_f32_16x16x32_bf16 v[252:255], a[236:239], v[236:239], v[252:255]
    s_waitcnt lgkmcnt(0)
    v_exp_f32 v246, v246
    v_mfma_f32_16x16x32_bf16 v[240:243], a[240:243], v[128:131], v[180:183]
    v_exp_f32 v247, v247
    v_mfma_f32_16x16x32_bf16 v[240:243], a[244:247], v[160:163], v[240:243]
    buffer_load_dwordx4 v1, s[36:39], s77 offen offset:3072 sc1 lds
    v_mfma_f32_16x16x32_bf16 v[240:243], a[248:251], v[192:195], v[240:243]
    v_cvt_pk_bf16_f32 v40, v244, v245
    v_cvt_pk_bf16_f32 v41, v246, v247
    v_mfma_f32_16x16x32_bf16 v[240:243], a[252:255], v[224:227], v[240:243]
    v_exp_f32 v248, v248
    v_mfma_f32_16x16x32_bf16 v[244:247], a[240:243], v[132:135], v[148:151]
    v_exp_f32 v249, v249
    v_mfma_f32_16x16x32_bf16 v[244:247], a[244:247], v[164:167], v[244:247]
    s_add_u32 s100, s77, 4096
    v_exp_f32 v250, v250
    v_mfma_f32_16x16x32_bf16 v[244:247], a[248:251], v[196:199], v[244:247]
    s_add_u32 m0, m0, 4096
    v_exp_f32 v251, v251
    v_mfma_f32_16x16x32_bf16 v[244:247], a[252:255], v[228:231], v[244:247]
    v_cvt_pk_bf16_f32 v48, v248, v249
    v_cvt_pk_bf16_f32 v49, v250, v251
    v_mfma_f32_16x16x32_bf16 v[248:251], a[240:243], v[136:139], v[152:155]
    ds_read_b128 a[224:227], v2 offset:8192
    ds_read_b128 a[228:231], v2 offset:9216
    v_mfma_f32_16x16x32_bf16 v[248:251], a[244:247], v[168:171], v[248:251]
    buffer_load_dwordx4 v1, s[36:39], s100 offen sc1 lds
    v_mfma_f32_16x16x32_bf16 v[248:251], a[248:251], v[200:203], v[248:251]
    v_exp_f32 v252, v252
    v_mfma_f32_16x16x32_bf16 v[248:251], a[252:255], v[232:235], v[248:251]
    v_exp_f32 v253, v253
    v_exp_f32 v254, v254
    v_exp_f32 v255, v255
    v_cvt_pk_bf16_f32 v56, v252, v253
    v_cvt_pk_bf16_f32 v57, v254, v255
    v_mfma_f32_16x16x32_bf16 v[252:255], a[240:243], v[140:143], v[156:159]
    ds_read_b128 a[232:235], v2 offset:10240
    ds_read_b128 a[236:239], v2 offset:11264
    v_mfma_f32_16x16x32_bf16 v[252:255], a[244:247], v[172:175], v[252:255]
    buffer_load_dwordx4 v1, s[36:39], s100 offen offset:1024 sc1 lds
    v_mfma_f32_16x16x32_bf16 v[252:255], a[248:251], v[204:207], v[252:255]
    v_exp_f32 v240, v240
    v_mfma_f32_16x16x32_bf16 v[252:255], a[252:255], v[236:239], v[252:255]
    s_waitcnt lgkmcnt(2)
    v_exp_f32 v241, v241
    v_exp_f32 v242, v242
    v_exp_f32 v243, v243
    v_fma_f32 v184, v208, s18, v214
    v_fma_f32 v185, v209, s18, v214
    v_fma_f32 v186, v210, s18, v214
    v_fma_f32 v187, v211, s18, v214
    v_cvt_pk_bf16_f32 v34, v240, v241
    v_cvt_pk_bf16_f32 v35, v242, v243
    v_mfma_f32_16x16x32_bf16 v[240:243], a[224:227], v[128:131], v[184:187]
    v_exp_f32 v244, v244
    v_mfma_f32_16x16x32_bf16 v[240:243], a[228:231], v[160:163], v[240:243]
    s_waitcnt lgkmcnt(0)
    v_exp_f32 v245, v245
    v_mfma_f32_16x16x32_bf16 v[240:243], a[232:235], v[192:195], v[240:243]
    v_exp_f32 v246, v246
    v_mfma_f32_16x16x32_bf16 v[240:243], a[236:239], v[224:227], v[240:243]
    v_exp_f32 v247, v247
    v_cvt_pk_bf16_f32 v42, v244, v245
    v_cvt_pk_bf16_f32 v43, v246, v247
    v_mfma_f32_16x16x32_bf16 v[244:247], a[224:227], v[132:135], v[148:151]
    buffer_load_dwordx4 v1, s[36:39], s100 offen offset:2048 sc1 lds
    v_mfma_f32_16x16x32_bf16 v[244:247], a[228:231], v[164:167], v[244:247]
    v_exp_f32 v248, v248
    v_mfma_f32_16x16x32_bf16 v[244:247], a[232:235], v[196:199], v[244:247]
    v_exp_f32 v249, v249
    v_mfma_f32_16x16x32_bf16 v[244:247], a[236:239], v[228:231], v[244:247]
    v_exp_f32 v250, v250
    v_exp_f32 v251, v251
    v_cvt_pk_bf16_f32 v50, v248, v249
    v_cvt_pk_bf16_f32 v51, v250, v251
    v_mfma_f32_16x16x32_bf16 v[248:251], a[224:227], v[136:139], v[152:155]
    buffer_load_dwordx4 v1, s[36:39], s100 offen offset:3072 sc1 lds
    v_mfma_f32_16x16x32_bf16 v[248:251], a[228:231], v[168:171], v[248:251]
    ds_read_b128 a[240:243], v2 offset:12288
    ds_read_b128 a[244:247], v2 offset:13312
    v_mfma_f32_16x16x32_bf16 v[248:251], a[232:235], v[200:203], v[248:251]
    s_add_u32 s77, s77, 32768
    v_exp_f32 v252, v252
    v_mfma_f32_16x16x32_bf16 v[248:251], a[236:239], v[232:235], v[248:251]
    v_exp_f32 v253, v253
    v_exp_f32 v254, v254
    v_exp_f32 v255, v255
    v_cvt_pk_bf16_f32 v58, v252, v253
    v_cvt_pk_bf16_f32 v59, v254, v255
    v_mfma_f32_16x16x32_bf16 v[252:255], a[224:227], v[140:143], v[156:159]
    ds_read_b128 a[248:251], v2 offset:14336
    ds_read_b128 a[252:255], v2 offset:15360
    v_mfma_f32_16x16x32_bf16 v[252:255], a[228:231], v[172:175], v[252:255]
    v_add_f32 v215, s23, v144
    v_fma_f32 v188, v208, s19, v215
    v_mfma_f32_16x16x32_bf16 v[252:255], a[232:235], v[204:207], v[252:255]
    v_exp_f32 v240, v240
    v_mfma_f32_16x16x32_bf16 v[252:255], a[236:239], v[236:239], v[252:255]
    s_waitcnt lgkmcnt(2)
    v_exp_f32 v241, v241
    v_exp_f32 v242, v242
    v_exp_f32 v243, v243
    v_fma_f32 v189, v209, s19, v215
    v_fma_f32 v190, v210, s19, v215
    v_fma_f32 v191, v211, s19, v215
    v_cvt_pk_bf16_f32 v36, v240, v241
    v_cvt_pk_bf16_f32 v37, v242, v243
    v_mfma_f32_16x16x32_bf16 v[240:243], a[240:243], v[128:131], v[188:191]
    v_exp_f32 v244, v244
    v_mfma_f32_16x16x32_bf16 v[240:243], a[244:247], v[160:163], v[240:243]
    s_cmp_eq_u32 s82, 163840
    s_cselect_b32 s82, 0, s82
    v_add_u32 v2, s82, v1
    s_waitcnt lgkmcnt(0)
    v_mfma_f32_16x16x32_bf16 v[240:243], a[248:251], v[192:195], v[240:243]
    v_exp_f32 v245, v245
    v_mfma_f32_16x16x32_bf16 v[240:243], a[252:255], v[224:227], v[240:243]
    s_waitcnt vmcnt(8) lgkmcnt(0)
    s_barrier
    v_cvt_pk_bf16_f32 v44, v244, v245
    v_exp_f32 v246, v246
    v_exp_f32 v247, v247
    s_nop 0
    v_cvt_pk_bf16_f32 v45, v246, v247
    v_mfma_f32_16x16x32_bf16 v[244:247], a[240:243], v[132:135], v[148:151]
    ds_read_b128 a[224:227], v2 offset:0
    ds_read_b128 a[228:231], v2 offset:1024
    v_mfma_f32_16x16x32_bf16 v[244:247], a[244:247], v[164:167], v[244:247]
    v_exp_f32 v248, v248
    v_mfma_f32_16x16x32_bf16 v[244:247], a[248:251], v[196:199], v[244:247]
    v_exp_f32 v249, v249
    v_mfma_f32_16x16x32_bf16 v[244:247], a[252:255], v[228:231], v[244:247]
    v_exp_f32 v250, v250
    v_exp_f32 v251, v251
    v_cvt_pk_bf16_f32 v52, v248, v249
    v_cvt_pk_bf16_f32 v53, v250, v251
    v_mfma_f32_16x16x32_bf16 v[248:251], a[240:243], v[136:139], v[152:155]
    ds_read_b128 a[232:235], v2 offset:2048
    ds_read_b128 a[236:239], v2 offset:3072
    v_mfma_f32_16x16x32_bf16 v[248:251], a[244:247], v[168:171], v[248:251]
    ds_read_b128 v[96:99], v2 offset:16384
    v_mfma_f32_16x16x32_bf16 v[248:251], a[248:251], v[200:203], v[248:251]
    v_exp_f32 v252, v252
    v_mfma_f32_16x16x32_bf16 v[248:251], a[252:255], v[232:235], v[248:251]
    v_exp_f32 v253, v253
    v_exp_f32 v254, v254
    v_exp_f32 v255, v255
    v_cvt_pk_bf16_f32 v60, v252, v253
    v_cvt_pk_bf16_f32 v61, v254, v255
    v_mfma_f32_16x16x32_bf16 v[252:255], a[240:243], v[140:143], v[156:159]
    ds_read_b128 v[100:103], v2 offset:17408
    v_mfma_f32_16x16x32_bf16 v[252:255], a[244:247], v[172:175], v[252:255]
    v_exp_f32 v240, v240
    v_mfma_f32_16x16x32_bf16 v[252:255], a[248:251], v[204:207], v[252:255]
    v_exp_f32 v241, v241
    v_mfma_f32_16x16x32_bf16 v[252:255], a[252:255], v[236:239], v[252:255]
    v_exp_f32 v242, v242
    v_exp_f32 v243, v243
    v_exp_f32 v244, v244
    v_exp_f32 v245, v245
    v_exp_f32 v246, v246
    v_exp_f32 v247, v247
    v_exp_f32 v248, v248
    v_exp_f32 v249, v249
    v_exp_f32 v250, v250
    v_exp_f32 v251, v251
    v_exp_f32 v252, v252
    v_exp_f32 v253, v253
    v_cvt_pk_bf16_f32 v38, v240, v241
    v_cvt_pk_bf16_f32 v39, v242, v243
    v_cvt_pk_bf16_f32 v46, v244, v245
    v_cvt_pk_bf16_f32 v47, v246, v247
    v_cvt_pk_bf16_f32 v54, v248, v249
    v_cvt_pk_bf16_f32 v55, v250, v251
    v_cvt_pk_bf16_f32 v62, v252, v253
    s_mov_b32 s78, s6
    s_cmp_eq_u32 s78, 0
    s_cbranch_scc1 K1_LB_END
.p2align 3
K1_LB:
    s_waitcnt lgkmcnt(0)
    v_mfma_f32_16x16x32_bf16 v[240:243], a[224:227], v[128:131], v[176:179]
    s_add_u32 m0, s76, s75
    v_exp_f32 v254, v254
    v_mfma_f32_16x16x32_bf16 v[240:243], a[228:231], v[160:163], v[240:243]
    s_mov_b32 s76, s60
    buffer_load_dwordx4 v1, s[36:39], s77 offen sc1 lds
    v_mfma_f32_16x16x32_bf16 v[240:243], a[232:235], v[192:195], v[240:243]
    s_mov_b32 s60, s82
    v_exp_f32 v255, v255
    v_mfma_f32_16x16x32_bf16 v[240:243], a[236:239], v[224:227], v[240:243]
    s_add_u32 s82, s82, 32768
    ds_read_b128 v[104:107], v2 offset:18432
    v_cvt_pk_bf16_f32 v63, v254, v255
    v_mfma_f32_16x16x32_bf16 a[0:3], v[96:99], v[32:35], a[0:3]
    ds_read_b128 v[108:111], v2 offset:19456
    ds_read_b128 a[240:243], v2 offset:4096
    v_mfma_f32_16x16x32_bf16 a[0:3], v[100:103], v[36:39], a[0:3]
    ds_read_b128 a[244:247], v2 offset:5120
    v_mfma_f32_16x16x32_bf16 a[4:7], v[96:99], v[40:43], a[4:7]
    v_exp_f32 v240, v240
    v_mfma_f32_16x16x32_bf16 a[4:7], v[100:103], v[44:47], a[4:7]
    ds_read_b128 a[248:251], v2 offset:6144
    ds_read_b128 a[252:255], v2 offset:7168
    v_mfma_f32_16x16x32_bf16 v[244:247], a[224:227], v[132:135], v[148:151]
    v_exp_f32 v241, v241
    v_mfma_f32_16x16x32_bf16 v[244:247], a[228:231], v[164:167], v[244:247]
    ds_read_b128 v[112:115], v2 offset:20480
    ds_read_b128 v[116:119], v2 offset:21504
    v_mfma_f32_16x16x32_bf16 v[244:247], a[232:235], v[196:199], v[244:247]
    v_exp_f32 v242, v242
    v_mfma_f32_16x16x32_bf16 v[244:247], a[236:239], v[228:231], v[244:247]
    v_exp_f32 v243, v243
    v_mfma_f32_16x16x32_bf16 a[8:11], v[96:99], v[48:51], a[8:11]
    v_cvt_pk_bf16_f32 v64, v240, v241
    v_cvt_pk_bf16_f32 v65, v242, v243
    v_mfma_f32_16x16x32_bf16 a[8:11], v[100:103], v[52:55], a[8:11]
    ds_read_b128 v[120:123], v2 offset:22528
    ds_read_b128 v[124:127], v2 offset:23552
    v_mfma_f32_16x16x32_bf16 a[12:15], v[96:99], v[56:59], a[12:15]
    v_exp_f32 v244, v244
    v_mfma_f32_16x16x32_bf16 a[12:15], v[100:103], v[60:63], a[12:15]
    buffer_load_dwordx4 v1, s[36:39], s77 offen offset:1024 sc1 lds
    v_mfma_f32_16x16x32_bf16 v[248:251], a[224:227], v[136:139], v[152:155]
    v_exp_f32 v245, v245
    v_mfma_f32_16x16x32_bf16 v[248:251], a[228:231], v[168:171], v[248:251]
    v_exp_f32 v246, v246
    v_mfma_f32_16x16x32_bf16 v[248:251], a[232:235], v[200:203], v[248:251]
    v_exp_f32 v247, v247
    v_mfma_f32_16x16x32_bf16 v[248:251], a[236:239], v[232:235], v[248:251]
    s_waitcnt lgkmcnt(0)
    v_cvt_pk_bf16_f32 v72, v244, v245
    v_cvt_pk_bf16_f32 v73, v246, v247
    v_mfma_f32_16x16x32_bf16 a[16:19], v[104:107], v[32:35], a[16:19]
    ds_read_b128 v[96:99], v2 offset:24576
    ds_read_b128 v[100:103], v2 offset:25600
    v_mfma_f32_16x16x32_bf16 a[16:19], v[108:111], v[36:39], a[16:19]
    v_mfma_f32_16x16x32_bf16 a[20:23], v[104:107], v[40:43], a[20:23]
    v_mfma_f32_16x16x32_bf16 a[20:23], v[108:111], v[44:47], a[20:23]
    v_exp_f32 v248, v248
    v_mfma_f32_16x16x32_bf16 v[252:255], a[224:227], v[140:143], v[156:159]
    v_exp_f32 v249, v249
    v_mfma_f32_16x16x32_bf16 v[252:255], a[228:231], v[172:175], v[252:255]
    v_exp_f32 v250, v250
    v_mfma_f32_16x16x32_bf16 v[252:255], a[232:235], v[204:207], v[252:255]
    v_exp_f32 v251, v251
    v_mfma_f32_16x16x32_bf16 v[252:255], a[236:239], v[236:239], v[252:255]
    v_cvt_pk_bf16_f32 v80, v248, v249
    v_cvt_pk_bf16_f32 v81, v250, v251
    v_mfma_f32_16x16x32_bf16 a[24:27], v[104:107], v[48:51], a[24:27]
    ds_read_b128 a[224:227], v2 offset:8192
    ds_read_b128 a[228:231], v2 offset:9216
    v_mfma_f32_16x16x32_bf16 a[24:27], v[108:111], v[52:55], a[24:27]
    buffer_load_dwordx4 v1, s[36:39], s77 offen offset:2048 sc1 lds
    v_mfma_f32_16x16x32_bf16 a[28:31], v[104:107], v[56:59], a[28:31]
    v_exp_f32 v252, v252
    v_mfma_f32_16x16x32_bf16 a[28:31], v[108:111], v[60:63], a[28:31]
    v_exp_f32 v253, v253
    v_mfma_f32_16x16x32_bf16 v[240:243], a[240:243], v[128:131], v[180:183]
    v_exp_f32 v254, v254
    v_mfma_f32_16x16x32_bf16 v[240:243], a[244:247], v[160:163], v[240:243]
    v_exp_f32 v255, v255
    v_mfma_f32_16x16x32_bf16 v[240:243], a[248:251], v[192:195], v[240:243]
    v_cvt_pk_bf16_f32 v88, v252, v253
    v_cvt_pk_bf16_f32 v89, v254, v255
    v_mfma_f32_16x16x32_bf16 v[240:243], a[252:255], v[224:227], v[240:243]
    ds_read_b128 a[232:235], v2 offset:10240
    ds_read_b128 a[236:239], v2 offset:11264
    v_mfma_f32_16x16x32_bf16 a[32:35], v[112:115], v[32:35], a[32:35]
    ds_read_b128 v[104:107], v2 offset:26624
    v_mfma_f32_16x16x32_bf16 a[32:35], v[116:119], v[36:39], a[32:35]
    ds_read_b128 v[108:111], v2 offset:27648
    v_mfma_f32_16x16x32_bf16 a[36:39], v[112:115], v[40:43], a[36:39]
    v_mfma_f32_16x16x32_bf16 a[36:39], v[116:119], v[44:47], a[36:39]
    v_exp_f32 v240, v240
    v_mfma_f32_16x16x32_bf16 v[244:247], a[240:243], v[132:135], v[148:151]
    v_exp_f32 v241, v241
    v_mfma_f32_16x16x32_bf16 v[244:247], a[244:247], v[164:167], v[244:247]
    v_exp_f32 v242, v242
    v_mfma_f32_16x16x32_bf16 v[244:247], a[248:251], v[196:199], v[244:247]
    v_exp_f32 v243, v243
    v_mfma_f32_16x16x32_bf16 v[244:247], a[252:255], v[228:231], v[244:247]
    buffer_load_dwordx4 v1, s[36:39], s77 offen offset:3072 sc1 lds
    v_mfma_f32_16x16x32_bf16 a[40:43], v[112:115], v[48:51], a[40:43]
    v_cvt_pk_bf16_f32 v66, v240, v241
    v_cvt_pk_bf16_f32 v67, v242, v243
    v_mfma_f32_16x16x32_bf16 a[40:43], v[116:119], v[52:55], a[40:43]
    v_mfma_f32_16x16x32_bf16 a[44:47], v[112:115], v[56:59], a[44:47]
    ds_read_b128 v[112:115], v2 offset:28672
    v_mfma_f32_16x16x32_bf16 a[44:47], v[116:119], v[60:63], a[44:47]
    v_exp_f32 v244, v244
    v_mfma_f32_16x16x32_bf16 v[248:251], a[240:243], v[136:139], v[152:155]
    v_exp_f32 v245, v245
    v_mfma_f32_16x16x32_bf16 v[248:251], a[244:247], v[168:171], v[248:251]
    v_exp_f32 v246, v246
    v_mfma_f32_16x16x32_bf16 v[248:251], a[248:251], v[200:203], v[248:251]
    v_exp_f32 v247, v247
    v_mfma_f32_16x16x32_bf16 v[248:251], a[252:255], v[232:235], v[248:251]
    v_cvt_pk_bf16_f32 v74, v244, v245
    v_cvt_pk_bf16_f32 v75, v246, v247
    v_mfma_f32_16x16x32_bf16 a[48:51], v[120:123], v[32:35], a[48:51]
    ds_read_b128 v[116:119], v2 offset:29696
    v_mfma_f32_16x16x32_bf16 a[48:51], v[124:127], v[36:39], a[48:51]
    v_mfma_f32_16x16x32_bf16 a[52:55], v[120:123], v[40:43], a[52:55]
    v_mfma_f32_16x16x32_bf16 a[52:55], v[124:127], v[44:47], a[52:55]
    v_mfma_f32_16x16x32_bf16 v[252:255], a[240:243], v[140:143], v[156:159]
    v_exp_f32 v248, v248
    v_mfma_f32_16x16x32_bf16 v[252:255], a[244:247], v[172:175], v[252:255]
    s_add_u32 s100, s77, 4096
    v_exp_f32 v249, v249
    v_mfma_f32_16x16x32_bf16 v[252:255], a[248:251], v[204:207], v[252:255]
    s_add_u32 m0, m0, 4096
    v_exp_f32 v250, v250
    v_mfma_f32_16x16x32_bf16 v[252:255], a[252:255], v[236:239], v[252:255]
    buffer_load_dwordx4 v1, s[36:39], s100 offen sc1 lds
    v_mfma_f32_16x16x32_bf16 a[56:59], v[120:123], v[48:51], a[56:59]
    v_exp_f32 v251, v251
    v_mfma_f32_16x16x32_bf16 a[56:59], v[124:127], v[52:55], a[56:59]
    v_cvt_pk_bf16_f32 v82, v248, v249
    v_cvt_pk_bf16_f32 v83, v250, v251
    v_mfma_f32_16x16x32_bf16 a[60:63], v[120:123], v[56:59], a[60:63]
    ds_read_b128 a[240:243], v2 offset:12288
    ds_read_b128 a[244:247], v2 offset:13312
    v_mfma_f32_16x16x32_bf16 a[60:63], v[124:127], v[60:63], a[60:63]
    s_waitcnt lgkmcnt(2)
    v_exp_f32 v252, v252
    v_mfma_f32_16x16x32_bf16 v[240:243], a[224:227], v[128:131], v[184:187]
    v_exp_f32 v253, v253
    v_mfma_f32_16x16x32_bf16 v[240:243], a[228:231], v[160:163], v[240:243]
    v_exp_f32 v254, v254
    v_mfma_f32_16x16x32_bf16 v[240:243], a[232:235], v[192:195], v[240:243]
    v_exp_f32 v255, v255
    v_mfma_f32_16x16x32_bf16 v[240:243], a[236:239], v[224:227], v[240:243]
    v_cvt_pk_bf16_f32 v90, v252, v253
    v_cvt_pk_bf16_f32 v91, v254, v255
    v_mfma_f32_16x16x32_bf16 a[144:147], v[96:99], v[32:35], a[144:147]
    ds_read_b128 a[248:251], v2 offset:14336
    ds_read_b128 a[252:255], v2 offset:15360
    v_mfma_f32_16x16x32_bf16 a[144:147], v[100:103], v[36:39], a[144:147]
    ds_read_b128 v[120:123], v2 offset:30720
    v_mfma_f32_16x16x32_bf16 a[148:151], v[96:99], v[40:43], a[148:151]
    v_exp_f32 v240, v240
    v_mfma_f32_16x16x32_bf16 a[148:151], v[100:103], v[44:47], a[148:151]
    v_exp_f32 v241, v241
    v_mfma_f32_16x16x32_bf16 v[244:247], a[224:227], v[132:135], v[148:151]
    buffer_load_dwordx4 v1, s[36:39], s100 offen offset:1024 sc1 lds
    v_mfma_f32_16x16x32_bf16 v[244:247], a[228:231], v[164:167], v[244:247]
    v_exp_f32 v242, v242
    v_mfma_f32_16x16x32_bf16 v[244:247], a[232:235], v[196:199], v[244:247]
    v_exp_f32 v243, v243
    v_mfma_f32_16x16x32_bf16 v[244:247], a[236:239], v[228:231], v[244:247]
    v_cvt_pk_bf16_f32 v68, v240, v241
    v_cvt_pk_bf16_f32 v69, v242, v243
    v_mfma_f32_16x16x32_bf16 a[152:155], v[96:99], v[48:51], a[152:155]
    ds_read_b128 v[124:127], v2 offset:31744
    v_mfma_f32_16x16x32_bf16 a[152:155], v[100:103], v[52:55], a[152:155]
    v_mfma_f32_16x16x32_bf16 a[156:159], v[96:99], v[56:59], a[156:159]
    v_mfma_f32_16x16x32_bf16 a[156:159], v[100:103], v[60:63], a[156:159]
    v_mfma_f32_16x16x32_bf16 v[248:251], a[224:227], v[136:139], v[152:155]
    v_exp_f32 v244, v244
    v_mfma_f32_16x16x32_bf16 v[248:251], a[228:231], v[168:171], v[248:251]
    v_exp_f32 v245, v245
    v_mfma_f32_16x16x32_bf16 v[248:251], a[232:235], v[200:203], v[248:251]
    v_exp_f32 v246, v246
    v_mfma_f32_16x16x32_bf16 v[248:251], a[236:239], v[232:235], v[248:251]
    v_exp_f32 v247, v247
    v_mfma_f32_16x16x32_bf16 a[160:163], v[104:107], v[32:35], a[160:163]
    v_cvt_pk_bf16_f32 v76, v244, v245
    v_cvt_pk_bf16_f32 v77, v246, v247
    v_mfma_f32_16x16x32_bf16 a[160:163], v[108:111], v[36:39], a[160:163]
    v_mfma_f32_16x16x32_bf16 a[164:167], v[104:107], v[40:43], a[164:167]
    buffer_load_dwordx4 v1, s[36:39], s100 offen offset:2048 sc1 lds
    v_mfma_f32_16x16x32_bf16 a[164:167], v[108:111], v[44:47], a[164:167]
    v_exp_f32 v248, v248
    v_mfma_f32_16x16x32_bf16 v[252:255], a[224:227], v[140:143], v[156:159]
    v_exp_f32 v249, v249
    v_mfma_f32_16x16x32_bf16 v[252:255], a[228:231], v[172:175], v[252:255]
    v_exp_f32 v250, v250
    v_mfma_f32_16x16x32_bf16 v[252:255], a[232:235], v[204:207], v[252:255]
    v_exp_f32 v251, v251
    v_mfma_f32_16x16x32_bf16 v[252:255], a[236:239], v[236:239], v[252:255]
    v_cvt_pk_bf16_f32 v84, v248, v249
    v_cvt_pk_bf16_f32 v85, v250, v251
    v_mfma_f32_16x16x32_bf16 a[168:171], v[104:107], v[48:51], a[168:171]
    v_mfma_f32_16x16x32_bf16 a[168:171], v[108:111], v[52:55], a[168:171]
    v_mfma_f32_16x16x32_bf16 a[172:175], v[104:107], v[56:59], a[172:175]
    v_mfma_f32_16x16x32_bf16 a[172:175], v[108:111], v[60:63], a[172:175]
    s_waitcnt lgkmcnt(0)
    v_mfma_f32_16x16x32_bf16 v[240:243], a[240:243], v[128:131], v[188:191]
    v_mfma_f32_16x16x32_bf16 v[240:243], a[244:247], v[160:163], v[240:243]
    v_exp_f32 v252, v252
    v_mfma_f32_16x16x32_bf16 v[240:243], a[248:251], v[192:195], v[240:243]
    v_exp_f32 v253, v253
    v_mfma_f32_16x16x32_bf16 v[240:243], a[252:255], v[224:227], v[240:243]
    v_exp_f32 v254, v254
    v_mfma_f32_16x16x32_bf16 a[176:179], v[112:115], v[32:35], a[176:179]
    buffer_load_dwordx4 v1, s[36:39], s100 offen offset:3072 sc1 lds
    v_mfma_f32_16x16x32_bf16 a[176:179], v[116:119], v[36:39], a[176:179]
    v_exp_f32 v255, v255
    v_mfma_f32_16x16x32_bf16 a[180:183], v[112:115], v[40:43], a[180:183]
    v_cvt_pk_bf16_f32 v92, v252, v253
    v_cvt_pk_bf16_f32 v93, v254, v255
    v_mfma_f32_16x16x32_bf16 a[180:183], v[116:119], v[44:47], a[180:183]
    s_cmp_eq_u32 s82, 163840
    s_cselect_b32 s82, 0, s82
    v_add_u32 v2, s82, v1
    v_mfma_f32_16x16x32_bf16 v[244:247], a[240:243], v[132:135], v[148:151]
    ds_read_b128 a[224:227], v2 offset:0
    ds_read_b128 a[228:231], v2 offset:1024
    v_mfma_f32_16x16x32_bf16 v[244:247], a[244:247], v[164:167], v[244:247]
    v_exp_f32 v240, v240
    v_mfma_f32_16x16x32_bf16 v[244:247], a[248:251], v[196:199], v[244:247]
    ds_read_b128 a[232:235], v2 offset:2048
    ds_read_b128 a[236:239], v2 offset:3072
    v_mfma_f32_16x16x32_bf16 v[244:247], a[252:255], v[228:231], v[244:247]
    v_exp_f32 v241, v241
    v_mfma_f32_16x16x32_bf16 a[184:187], v[112:115], v[48:51], a[184:187]
    ds_read_b128 v[96:99], v2 offset:16384
    ds_read_b128 v[100:103], v2 offset:17408
    v_mfma_f32_16x16x32_bf16 a[184:187], v[116:119], v[52:55], a[184:187]
    v_exp_f32 v242, v242
    v_mfma_f32_16x16x32_bf16 a[188:191], v[112:115], v[56:59], a[188:191]
    v_exp_f32 v243, v243
    v_mfma_f32_16x16x32_bf16 a[188:191], v[116:119], v[60:63], a[188:191]
    v_exp_f32 v244, v244
    v_mfma_f32_16x16x32_bf16 v[248:251], a[240:243], v[136:139], v[152:155]
    v_exp_f32 v245, v245
    v_mfma_f32_16x16x32_bf16 v[248:251], a[244:247], v[168:171], v[248:251]
    v_exp_f32 v246, v246
    v_mfma_f32_16x16x32_bf16 v[248:251], a[248:251], v[200:203], v[248:251]
    s_add_u32 s77, s77, 32768
    v_exp_f32 v247, v247
    v_mfma_f32_16x16x32_bf16 v[248:251], a[252:255], v[232:235], v[248:251]
    v_cvt_pk_bf16_f32 v70, v240, v241
    v_cvt_pk_bf16_f32 v71, v242, v243
    v_mfma_f32_16x16x32_bf16 a[192:195], v[120:123], v[32:35], a[192:195]
    v_cvt_pk_bf16_f32 v78, v244, v245
    v_cvt_pk_bf16_f32 v79, v246, v247
    v_mfma_f32_16x16x32_bf16 a[192:195], v[124:127], v[36:39], a[192:195]
    v_mfma_f32_16x16x32_bf16 a[196:199], v[120:123], v[40:43], a[196:199]
    v_mfma_f32_16x16x32_bf16 a[196:199], v[124:127], v[44:47], a[196:199]
    v_exp_f32 v248, v248
    v_mfma_f32_16x16x32_bf16 v[252:255], a[240:243], v[140:143], v[156:159]
    v_exp_f32 v249, v249
    v_mfma_f32_16x16x32_bf16 v[252:255], a[244:247], v[172:175], v[252:255]
    v_exp_f32 v250, v250
    v_mfma_f32_16x16x32_bf16 v[252:255], a[248:251], v[204:207], v[252:255]
    v_exp_f32 v251, v251
    v_mfma_f32_16x16x32_bf16 v[252:255], a[252:255], v[236:239], v[252:255]
    v_cvt_pk_bf16_f32 v86, v248, v249
    v_cvt_pk_bf16_f32 v87, v250, v251
    v_mfma_f32_16x16x32_bf16 a[200:203], v[120:123], v[48:51], a[200:203]
    v_mfma_f32_16x16x32_bf16 a[200:203], v[124:127], v[52:55], a[200:203]
    v_mfma_f32_16x16x32_bf16 a[204:207], v[120:123], v[56:59], a[204:207]
    v_mfma_f32_16x16x32_bf16 a[204:207], v[124:127], v[60:63], a[204:207]
    v_mfma_f32_16x16x32_bf16 a[208:211], a[136:139], v[32:35], a[208:211]
    v_mfma_f32_16x16x32_bf16 a[208:211], a[136:139], v[36:39], a[208:211]
    v_exp_f32 v252, v252
    v_mfma_f32_16x16x32_bf16 a[212:215], a[136:139], v[40:43], a[212:215]
    v_exp_f32 v253, v253
    v_mfma_f32_16x16x32_bf16 a[212:215], a[136:139], v[44:47], a[212:215]
    v_cvt_pk_bf16_f32 v94, v252, v253
    v_mfma_f32_16x16x32_bf16 a[216:219], a[136:139], v[48:51], a[216:219]
    v_mfma_f32_16x16x32_bf16 a[216:219], a[136:139], v[52:55], a[216:219]
    v_mfma_f32_16x16x32_bf16 a[220:223], a[136:139], v[56:59], a[220:223]
    v_mfma_f32_16x16x32_bf16 a[220:223], a[136:139], v[60:63], a[220:223]
    s_cmp_eq_u32 s78, 1
    s_cbranch_scc1 K1_LB_MASK
K1_LB_BACK:
    s_waitcnt lgkmcnt(0)
    v_mfma_f32_16x16x32_bf16 v[240:243], a[224:227], v[128:131], v[176:179]
    s_add_u32 m0, s76, s75
    v_exp_f32 v254, v254
    v_mfma_f32_16x16x32_bf16 v[240:243], a[228:231], v[160:163], v[240:243]
    s_mov_b32 s76, s60
    buffer_load_dwordx4 v1, s[36:39], s77 offen sc1 lds
    v_mfma_f32_16x16x32_bf16 v[240:243], a[232:235], v[192:195], v[240:243]
    s_mov_b32 s60, s82
    v_exp_f32 v255, v255
    v_mfma_f32_16x16x32_bf16 v[240:243], a[236:239], v[224:227], v[240:243]
    s_add_u32 s82, s82, 32768
    ds_read_b128 v[104:107], v2 offset:18432
    v_cvt_pk_bf16_f32 v95, v254, v255
    v_mfma_f32_16x16x32_bf16 a[0:3], v[96:99], v[64:67], a[0:3]
    ds_read_b128 v[108:111], v2 offset:19456
    ds_read_b128 a[240:243], v2 offset:4096
    v_mfma_f32_16x16x32_bf16 a[0:3], v[100:103], v[68:71], a[0:3]
    ds_read_b128 a[244:247], v2 offset:5120
    v_mfma_f32_16x16x32_bf16 a[4:7], v[96:99], v[72:75], a[4:7]
    v_exp_f32 v240, v240
    v_mfma_f32_16x16x32_bf16 a[4:7], v[100:103], v[76:79], a[4:7]
    ds_read_b128 a[248:251], v2 offset:6144
    ds_read_b128 a[252:255], v2 offset:7168
    v_mfma_f32_16x16x32_bf16 v[244:247], a[224:227], v[132:135], v[148:151]
    v_exp_f32 v241, v241
    v_mfma_f32_16x16x32_bf16 v[244:247], a[228:231], v[164:167], v[244:247]
    ds_read_b128 v[112:115], v2 offset:20480
    ds_read_b128 v[116:119], v2 offset:21504
    v_mfma_f32_16x16x32_bf16 v[244:247], a[232:235], v[196:199], v[244:247]
    v_exp_f32 v242, v242
    v_mfma_f32_16x16x32_bf16 v[244:247], a[236:239], v[228:231], v[244:247]
    v_exp_f32 v243, v243
    v_mfma_f32_16x16x32_bf16 a[8:11], v[96:99], v[80:83], a[8:11]
    v_cvt_pk_bf16_f32 v32, v240, v241
    v_cvt_pk_bf16_f32 v33, v242, v243
    v_mfma_f32_16x16x32_bf16 a[8:11], v[100:103], v[84:87], a[8:11]
    ds_read_b128 v[120:123], v2 offset:22528
    ds_read_b128 v[124:127], v2 offset:23552
    v_mfma_f32_16x16x32_bf16 a[12:15], v[96:99], v[88:91], a[12:15]
    v_exp_f32 v244, v244
    v_mfma_f32_16x16x32_bf16 a[12:15], v[100:103], v[92:95], a[12:15]
    buffer_load_dwordx4 v1, s[36:39], s77 offen offset:1024 sc1 lds
    v_mfma_f32_16x16x32_bf16 v[248:251], a[224:227], v[136:139], v[152:155]
    v_exp_f32 v245, v245
    v_mfma_f32_16x16x32_bf16 v[248:251], a[228:231], v[168:171], v[248:251]
    v_exp_f32 v246, v246
    v_mfma_f32_16x16x32_bf16 v[248:251], a[232:235], v[200:203], v[248:251]
    v_exp_f32 v247, v247
    v_mfma_f32_16x16x32_bf16 v[248:251], a[236:239], v[232:235], v[248:251]
    s_waitcnt lgkmcnt(0)
    v_cvt_pk_bf16_f32 v40, v244, v245
    v_cvt_pk_bf16_f32 v41, v246, v247
    v_mfma_f32_16x16x32_bf16 a[16:19], v[104:107], v[64:67], a[16:19]
    ds_read_b128 v[96:99], v2 offset:24576
    ds_read_b128 v[100:103], v2 offset:25600
    v_mfma_f32_16x16x32_bf16 a[16:19], v[108:111], v[68:71], a[16:19]
    v_mfma_f32_16x16x32_bf16 a[20:23], v[104:107], v[72:75], a[20:23]
    v_mfma_f32_16x16x32_bf16 a[20:23], v[108:111], v[76:79], a[20:23]
    v_exp_f32 v248, v248
    v_mfma_f32_16x16x32_bf16 v[252:255], a[224:227], v[140:143], v[156:159]
    v_exp_f32 v249, v249
    v_mfma_f32_16x16x32_bf16 v[252:255], a[228:231], v[172:175], v[252:255]
    v_exp_f32 v250, v250
    v_mfma_f32_16x16x32_bf16 v[252:255], a[232:235], v[204:207], v[252:255]
    v_exp_f32 v251, v251
    v_mfma_f32_16x16x32_bf16 v[252:255], a[236:239], v[236:239], v[252:255]
    v_cvt_pk_bf16_f32 v48, v248, v249
    v_cvt_pk_bf16_f32 v49, v250, v251
    v_mfma_f32_16x16x32_bf16 a[24:27], v[104:107], v[80:83], a[24:27]
    ds_read_b128 a[224:227], v2 offset:8192
    ds_read_b128 a[228:231], v2 offset:9216
    v_mfma_f32_16x16x32_bf16 a[24:27], v[108:111], v[84:87], a[24:27]
    buffer_load_dwordx4 v1, s[36:39], s77 offen offset:2048 sc1 lds
    v_mfma_f32_16x16x32_bf16 a[28:31], v[104:107], v[88:91], a[28:31]
    v_exp_f32 v252, v252
    v_mfma_f32_16x16x32_bf16 a[28:31], v[108:111], v[92:95], a[28:31]
    v_exp_f32 v253, v253
    v_mfma_f32_16x16x32_bf16 v[240:243], a[240:243], v[128:131], v[180:183]
    v_exp_f32 v254, v254
    v_mfma_f32_16x16x32_bf16 v[240:243], a[244:247], v[160:163], v[240:243]
    v_exp_f32 v255, v255
    v_mfma_f32_16x16x32_bf16 v[240:243], a[248:251], v[192:195], v[240:243]
    v_cvt_pk_bf16_f32 v56, v252, v253
    v_cvt_pk_bf16_f32 v57, v254, v255
    v_mfma_f32_16x16x32_bf16 v[240:243], a[252:255], v[224:227], v[240:243]
    ds_read_b128 a[232:235], v2 offset:10240
    ds_read_b128 a[236:239], v2 offset:11264
    v_mfma_f32_16x16x32_bf16 a[32:35], v[112:115], v[64:67], a[32:35]
    ds_read_b128 v[104:107], v2 offset:26624
    v_mfma_f32_16x16x32_bf16 a[32:35], v[116:119], v[68:71], a[32:35]
    ds_read_b128 v[108:111], v2 offset:27648
    v_mfma_f32_16x16x32_bf16 a[36:39], v[112:115], v[72:75], a[36:39]
    v_mfma_f32_16x16x32_bf16 a[36:39], v[116:119], v[76:79], a[36:39]
    v_exp_f32 v240, v240
    v_mfma_f32_16x16x32_bf16 v[244:247], a[240:243], v[132:135], v[148:151]
    v_exp_f32 v241, v241
    v_mfma_f32_16x16x32_bf16 v[244:247], a[244:247], v[164:167], v[244:247]
    v_exp_f32 v242, v242
    v_mfma_f32_16x16x32_bf16 v[244:247], a[248:251], v[196:199], v[244:247]
    v_exp_f32 v243, v243
    v_mfma_f32_16x16x32_bf16 v[244:247], a[252:255], v[228:231], v[244:247]
    buffer_load_dwordx4 v1, s[36:39], s77 offen offset:3072 sc1 lds
    v_mfma_f32_16x16x32_bf16 a[40:43], v[112:115], v[80:83], a[40:43]
    v_cvt_pk_bf16_f32 v34, v240, v241
    v_cvt_pk_bf16_f32 v35, v242, v243
    v_mfma_f32_16x16x32_bf16 a[40:43], v[116:119], v[84:87], a[40:43]
    v_mfma_f32_16x16x32_bf16 a[44:47], v[112:115], v[88:91], a[44:47]
    ds_read_b128 v[112:115], v2 offset:28672
    v_mfma_f32_16x16x32_bf16 a[44:47], v[116:119], v[92:95], a[44:47]
    v_exp_f32 v244, v244
    v_mfma_f32_16x16x32_bf16 v[248:251], a[240:243], v[136:139], v[152:155]
    v_exp_f32 v245, v245
    v_mfma_f32_16x16x32_bf16 v[248:251], a[244:247], v[168:171], v[248:251]
    v_exp_f32 v246, v246
    v_mfma_f32_16x16x32_bf16 v[248:251], a[248:251], v[200:203], v[248:251]
    v_exp_f32 v247, v247
    v_mfma_f32_16x16x32_bf16 v[248:251], a[252:255], v[232:235], v[248:251]
    v_cvt_pk_bf16_f32 v42, v244, v245
    v_cvt_pk_bf16_f32 v43, v246, v247
    v_mfma_f32_16x16x32_bf16 a[48:51], v[120:123], v[64:67], a[48:51]
    ds_read_b128 v[116:119], v2 offset:29696
    v_mfma_f32_16x16x32_bf16 a[48:51], v[124:127], v[68:71], a[48:51]
    v_mfma_f32_16x16x32_bf16 a[52:55], v[120:123], v[72:75], a[52:55]
    v_mfma_f32_16x16x32_bf16 a[52:55], v[124:127], v[76:79], a[52:55]
    v_mfma_f32_16x16x32_bf16 v[252:255], a[240:243], v[140:143], v[156:159]
    v_exp_f32 v248, v248
    v_mfma_f32_16x16x32_bf16 v[252:255], a[244:247], v[172:175], v[252:255]
    s_add_u32 s100, s77, 4096
    v_exp_f32 v249, v249
    v_mfma_f32_16x16x32_bf16 v[252:255], a[248:251], v[204:207], v[252:255]
    s_add_u32 m0, m0, 4096
    v_exp_f32 v250, v250
    v_mfma_f32_16x16x32_bf16 v[252:255], a[252:255], v[236:239], v[252:255]
    buffer_load_dwordx4 v1, s[36:39], s100 offen sc1 lds
    v_mfma_f32_16x16x32_bf16 a[56:59], v[120:123], v[80:83], a[56:59]
    v_exp_f32 v251, v251
    v_mfma_f32_16x16x32_bf16 a[56:59], v[124:127], v[84:87], a[56:59]
    v_cvt_pk_bf16_f32 v50, v248, v249
    v_cvt_pk_bf16_f32 v51, v250, v251
    v_mfma_f32_16x16x32_bf16 a[60:63], v[120:123], v[88:91], a[60:63]
    ds_read_b128 a[240:243], v2 offset:12288
    ds_read_b128 a[244:247], v2 offset:13312
    v_mfma_f32_16x16x32_bf16 a[60:63], v[124:127], v[92:95], a[60:63]
    s_waitcnt lgkmcnt(2)
    v_exp_f32 v252, v252
    v_mfma_f32_16x16x32_bf16 v[240:243], a[224:227], v[128:131], v[184:187]
    v_exp_f32 v253, v253
    v_mfma_f32_16x16x32_bf16 v[240:243], a[228:231], v[160:163], v[240:243]
    v_exp_f32 v254, v254
    v_mfma_f32_16x16x32_bf16 v[240:243], a[232:235], v[192:195], v[240:243]
    v_exp_f32 v255, v255
    v_mfma_f32_16x16x32_bf16 v[240:243], a[236:239], v[224:227], v[240:243]
    v_cvt_pk_bf16_f32 v58, v252, v253
    v_cvt_pk_bf16_f32 v59, v254, v255
    v_mfma_f32_16x16x32_bf16 a[144:147], v[96:99], v[64:67], a[144:147]
    ds_read_b128 a[248:251], v2 offset:14336
    ds_read_b128 a[252:255], v2 offset:15360
    v_mfma_f32_16x16x32_bf16 a[144:147], v[100:103], v[68:71], a[144:147]
    ds_read_b128 v[120:123], v2 offset:30720
    v_mfma_f32_16x16x32_bf16 a[148:151], v[96:99], v[72:75], a[148:151]
    v_exp_f32 v240, v240
    v_mfma_f32_16x16x32_bf16 a[148:151], v[100:103], v[76:79], a[148:151]
    v_exp_f32 v241, v241
    v_mfma_f32_16x16x32_bf16 v[244:247], a[224:227], v[132:135], v[148:151]
    buffer_load_dwordx4 v1, s[36:39], s100 offen offset:1024 sc1 lds
    v_mfma_f32_16x16x32_bf16 v[244:247], a[228:231], v[164:167], v[244:247]
    v_exp_f32 v242, v242
    v_mfma_f32_16x16x32_bf16 v[244:247], a[232:235], v[196:199], v[244:247]
    v_exp_f32 v243, v243
    v_mfma_f32_16x16x32_bf16 v[244:247], a[236:239], v[228:231], v[244:247]
    v_cvt_pk_bf16_f32 v36, v240, v241
    v_cvt_pk_bf16_f32 v37, v242, v243
    v_mfma_f32_16x16x32_bf16 a[152:155], v[96:99], v[80:83], a[152:155]
    ds_read_b128 v[124:127], v2 offset:31744
    v_mfma_f32_16x16x32_bf16 a[152:155], v[100:103], v[84:87], a[152:155]
    v_mfma_f32_16x16x32_bf16 a[156:159], v[96:99], v[88:91], a[156:159]
    v_mfma_f32_16x16x32_bf16 a[156:159], v[100:103], v[92:95], a[156:159]
    v_mfma_f32_16x16x32_bf16 v[248:251], a[224:227], v[136:139], v[152:155]
    v_exp_f32 v244, v244
    v_mfma_f32_16x16x32_bf16 v[248:251], a[228:231], v[168:171], v[248:251]
    v_exp_f32 v245, v245
    v_mfma_f32_16x16x32_bf16 v[248:251], a[232:235], v[200:203], v[248:251]
    v_exp_f32 v246, v246
    v_mfma_f32_16x16x32_bf16 v[248:251], a[236:239], v[232:235], v[248:251]
    v_exp_f32 v247, v247
    v_mfma_f32_16x16x32_bf16 a[160:163], v[104:107], v[64:67], a[160:163]
    v_cvt_pk_bf16_f32 v44, v244, v245
    v_cvt_pk_bf16_f32 v45, v246, v247
    v_mfma_f32_16x16x32_bf16 a[160:163], v[108:111], v[68:71], a[160:163]
    v_mfma_f32_16x16x32_bf16 a[164:167], v[104:107], v[72:75], a[164:167]
    buffer_load_dwordx4 v1, s[36:39], s100 offen offset:2048 sc1 lds
    v_mfma_f32_16x16x32_bf16 a[164:167], v[108:111], v[76:79], a[164:167]
    v_exp_f32 v248, v248
    v_mfma_f32_16x16x32_bf16 v[252:255], a[224:227], v[140:143], v[156:159]
    v_exp_f32 v249, v249
    v_mfma_f32_16x16x32_bf16 v[252:255], a[228:231], v[172:175], v[252:255]
    v_exp_f32 v250, v250
    v_mfma_f32_16x16x32_bf16 v[252:255], a[232:235], v[204:207], v[252:255]
    v_exp_f32 v251, v251
    v_mfma_f32_16x16x32_bf16 v[252:255], a[236:239], v[236:239], v[252:255]
    v_cvt_pk_bf16_f32 v52, v248, v249
    v_cvt_pk_bf16_f32 v53, v250, v251
    v_mfma_f32_16x16x32_bf16 a[168:171], v[104:107], v[80:83], a[168:171]
    v_mfma_f32_16x16x32_bf16 a[168:171], v[108:111], v[84:87], a[168:171]
    v_mfma_f32_16x16x32_bf16 a[172:175], v[104:107], v[88:91], a[172:175]
    v_mfma_f32_16x16x32_bf16 a[172:175], v[108:111], v[92:95], a[172:175]
    s_waitcnt lgkmcnt(0)
    v_mfma_f32_16x16x32_bf16 v[240:243], a[240:243], v[128:131], v[188:191]
    v_mfma_f32_16x16x32_bf16 v[240:243], a[244:247], v[160:163], v[240:243]
    v_exp_f32 v252, v252
    v_mfma_f32_16x16x32_bf16 v[240:243], a[248:251], v[192:195], v[240:243]
    v_exp_f32 v253, v253
    v_mfma_f32_16x16x32_bf16 v[240:243], a[252:255], v[224:227], v[240:243]
    v_exp_f32 v254, v254
    v_mfma_f32_16x16x32_bf16 a[176:179], v[112:115], v[64:67], a[176:179]
    buffer_load_dwordx4 v1, s[36:39], s100 offen offset:3072 sc1 lds
    v_mfma_f32_16x16x32_bf16 a[176:179], v[116:119], v[68:71], a[176:179]
    v_exp_f32 v255, v255
    v_mfma_f32_16x16x32_bf16 a[180:183], v[112:115], v[72:75], a[180:183]
    v_cvt_pk_bf16_f32 v60, v252, v253
    v_cvt_pk_bf16_f32 v61, v254, v255
    v_mfma_f32_16x16x32_bf16 a[180:183], v[116:119], v[76:79], a[180:183]
    s_cmp_eq_u32 s82, 163840
    s_cselect_b32 s82, 0, s82
    v_add_u32 v2, s82, v1
    v_mfma_f32_16x16x32_bf16 v[244:247], a[240:243], v[132:135], v[148:151]
    v_exp_f32 v240, v240
    v_mfma_f32_16x16x32_bf16 v[244:247], a[244:247], v[164:167], v[244:247]
    v_exp_f32 v241, v241
    v_mfma_f32_16x16x32_bf16 v[244:247], a[248:251], v[196:199], v[244:247]
    v_exp_f32 v242, v242
    v_mfma_f32_16x16x32_bf16 v[244:247], a[252:255], v[228:231], v[244:247]
    v_exp_f32 v243, v243
    v_mfma_f32_16x16x32_bf16 a[184:187], v[112:115], v[80:83], a[184:187]
    v_cvt_pk_bf16_f32 v38, v240, v241
    v_cvt_pk_bf16_f32 v39, v242, v243
    v_mfma_f32_16x16x32_bf16 a[184:187], v[116:119], v[84:87], a[184:187]
    v_mfma_f32_16x16x32_bf16 a[188:191], v[112:115], v[88:91], a[188:191]
    v_mfma_f32_16x16x32_bf16 a[188:191], v[116:119], v[92:95], a[188:191]
    v_mfma_f32_16x16x32_bf16 v[248:251], a[240:243], v[136:139], v[152:155]
    v_exp_f32 v244, v244
    v_mfma_f32_16x16x32_bf16 v[248:251], a[244:247], v[168:171], v[248:251]
    v_exp_f32 v245, v245
    v_mfma_f32_16x16x32_bf16 v[248:251], a[248:251], v[200:203], v[248:251]
    s_add_u32 s77, s77, 32768
    v_exp_f32 v246, v246
    v_mfma_f32_16x16x32_bf16 v[248:251], a[252:255], v[232:235], v[248:251]
    v_exp_f32 v247, v247
    v_mfma_f32_16x16x32_bf16 a[192:195], v[120:123], v[64:67], a[192:195]
    v_cvt_pk_bf16_f32 v46, v244, v245
    v_cvt_pk_bf16_f32 v47, v246, v247
    v_mfma_f32_16x16x32_bf16 a[192:195], v[124:127], v[68:71], a[192:195]
    v_mfma_f32_16x16x32_bf16 a[196:199], v[120:123], v[72:75], a[196:199]
    v_mfma_f32_16x16x32_bf16 a[196:199], v[124:127], v[76:79], a[196:199]
    v_mfma_f32_16x16x32_bf16 v[252:255], a[240:243], v[140:143], v[156:159]
    v_exp_f32 v248, v248
    v_mfma_f32_16x16x32_bf16 v[252:255], a[244:247], v[172:175], v[252:255]
    v_exp_f32 v249, v249
    v_mfma_f32_16x16x32_bf16 v[252:255], a[248:251], v[204:207], v[252:255]
    v_exp_f32 v250, v250
    v_mfma_f32_16x16x32_bf16 v[252:255], a[252:255], v[236:239], v[252:255]
    s_waitcnt vmcnt(8) lgkmcnt(0)
    s_barrier
    ds_read_b128 a[224:227], v2 offset:0
    v_mfma_f32_16x16x32_bf16 a[200:203], v[120:123], v[80:83], a[200:203]
    ds_read_b128 a[228:231], v2 offset:1024
    ds_read_b128 a[232:235], v2 offset:2048
    v_mfma_f32_16x16x32_bf16 a[200:203], v[124:127], v[84:87], a[200:203]
    ds_read_b128 a[236:239], v2 offset:3072
    v_cvt_pk_bf16_f32 v54, v248, v249
    v_mfma_f32_16x16x32_bf16 a[204:207], v[120:123], v[88:91], a[204:207]
    v_exp_f32 v251, v251
    v_mfma_f32_16x16x32_bf16 a[204:207], v[124:127], v[92:95], a[204:207]
    ds_read_b128 v[96:99], v2 offset:16384
    ds_read_b128 v[100:103], v2 offset:17408
    v_mfma_f32_16x16x32_bf16 a[208:211], a[136:139], v[64:67], a[208:211]
    v_exp_f32 v252, v252
    v_mfma_f32_16x16x32_bf16 a[208:211], a[136:139], v[68:71], a[208:211]
    v_exp_f32 v253, v253
    v_mfma_f32_16x16x32_bf16 a[212:215], a[136:139], v[72:75], a[212:215]
    v_cvt_pk_bf16_f32 v55, v250, v251
    v_cvt_pk_bf16_f32 v62, v252, v253
    v_mfma_f32_16x16x32_bf16 a[212:215], a[136:139], v[76:79], a[212:215]
    v_mfma_f32_16x16x32_bf16 a[216:219], a[136:139], v[80:83], a[216:219]
    v_mfma_f32_16x16x32_bf16 a[216:219], a[136:139], v[84:87], a[216:219]
    v_mfma_f32_16x16x32_bf16 a[220:223], a[136:139], v[88:91], a[220:223]
    v_mfma_f32_16x16x32_bf16 a[220:223], a[136:139], v[92:95], a[220:223]
    s_sub_u32 s78, s78, 1
    s_cmp_lg_u32 s78, 0
    s_cbranch_scc1 K1_LB
K1_LB_END:
    v_add_f32 v212, s12, v148
    v_fma_f32 v176, v208, s8, v212
    v_fma_f32 v177, v209, s8, v212
    v_fma_f32 v178, v210, s8, v212
    v_fma_f32 v179, v211, s8, v212
    s_nop 1
    s_waitcnt lgkmcnt(0)
    v_mfma_f32_16x16x32_bf16 v[240:243], a[224:227], v[132:135], v[176:179]
    s_mov_b32 s7, 0
    ds_read_b128 v[104:107], v2 offset:18432
    ds_read_b128 v[108:111], v2 offset:19456
    v_mfma_f32_16x16x32_bf16 v[240:243], a[228:231], v[164:167], v[240:243]
    s_mov_b32 s98, 0x3fb8aa3b
    buffer_load_dwordx4 v[64:67], v11, s[48:51], s7 offen nt
    v_mfma_f32_16x16x32_bf16 v[240:243], a[232:235], v[196:199], v[240:243]
    s_mov_b32 s7, 18432
    v_exp_f32 v254, v254
    v_mfma_f32_16x16x32_bf16 v[240:243], a[236:239], v[228:231], v[240:243]
    v_exp_f32 v255, v255
    v_mfma_f32_16x16x32_bf16 a[0:3], v[96:99], v[32:35], a[0:3]
    v_cvt_pk_bf16_f32 v63, v254, v255
    ds_read_b128 a[240:243], v2 offset:4096
    v_mfma_f32_16x16x32_bf16 a[0:3], v[100:103], v[36:39], a[0:3]
    buffer_load_dwordx4 v[68:71], v11, s[48:51], s7 offen nt
    v_mfma_f32_16x16x32_bf16 a[4:7], v[96:99], v[40:43], a[4:7]
    s_mov_b32 s7, 9216
    ds_read_b128 a[244:247], v2 offset:5120
    ds_read_b128 a[248:251], v2 offset:6144
    v_mfma_f32_16x16x32_bf16 a[4:7], v[100:103], v[44:47], a[4:7]
    ds_read_b128 a[252:255], v2 offset:7168
    v_add_f32 v213, s13, v148
    v_mfma_f32_16x16x32_bf16 v[244:247], a[224:227], v[136:139], v[152:155]
    ds_read_b128 v[112:115], v2 offset:20480
    v_fma_f32 v180, v208, s9, v213
    v_mfma_f32_16x16x32_bf16 v[244:247], a[228:231], v[168:171], v[244:247]
    buffer_load_dwordx4 v[20:23], v11, s[48:51], s7 offen nt
    v_mfma_f32_16x16x32_bf16 v[244:247], a[232:235], v[200:203], v[244:247]
    s_mov_b32 s7, 27648
    ds_read_b128 v[116:119], v2 offset:21504
    v_fma_f32 v181, v209, s9, v213
    v_mfma_f32_16x16x32_bf16 v[244:247], a[236:239], v[232:235], v[244:247]
    v_fma_f32 v182, v210, s9, v213
    v_fma_f32 v183, v211, s9, v213
    v_mfma_f32_16x16x32_bf16 a[8:11], v[96:99], v[48:51], a[8:11]
    v_exp_f32 v240, v240
    v_mfma_f32_16x16x32_bf16 a[8:11], v[100:103], v[52:55], a[8:11]
    buffer_load_dwordx4 v[24:27], v11, s[48:51], s7 offen nt
    v_mfma_f32_16x16x32_bf16 a[12:15], v[96:99], v[56:59], a[12:15]
    v_exp_f32 v241, v241
    v_mfma_f32_16x16x32_bf16 a[12:15], v[100:103], v[60:63], a[12:15]
    s_waitcnt lgkmcnt(0)
    v_exp_f32 v242, v242
    v_mfma_f32_16x16x32_bf16 a[16:19], v[104:107], v[32:35], a[16:19]
    v_exp_f32 v243, v243
    v_mfma_f32_16x16x32_bf16 a[16:19], v[108:111], v[36:39], a[16:19]
    buffer_load_dwordx4 v[144:147], v12, s[52:55], 0 offen nt
    v_mfma_f32_16x16x32_bf16 v[248:251], a[224:227], v[140:143], v[156:159]
    v_cvt_pk_bf16_f32 v72, v240, v241
    v_cvt_pk_bf16_f32 v73, v242, v243
    v_mfma_f32_16x16x32_bf16 v[248:251], a[228:231], v[172:175], v[248:251]
    ds_read_b128 v[120:123], v2 offset:22528
    ds_read_b128 v[124:127], v2 offset:23552
    v_mfma_f32_16x16x32_bf16 v[248:251], a[232:235], v[204:207], v[248:251]
    v_exp_f32 v244, v244
    v_mfma_f32_16x16x32_bf16 v[248:251], a[236:239], v[236:239], v[248:251]
    buffer_load_dwordx4 a[140:143], v13, s[52:55], 0 offen nt
    v_mfma_f32_16x16x32_bf16 a[20:23], v[104:107], v[40:43], a[20:23]
    v_exp_f32 v245, v245
    v_mfma_f32_16x16x32_bf16 a[20:23], v[108:111], v[44:47], a[20:23]
    v_exp_f32 v246, v246
    v_mfma_f32_16x16x32_bf16 a[24:27], v[104:107], v[48:51], a[24:27]
    v_exp_f32 v247, v247
    v_mfma_f32_16x16x32_bf16 a[24:27], v[108:111], v[52:55], a[24:27]
    v_cvt_pk_bf16_f32 v80, v244, v245
    v_cvt_pk_bf16_f32 v81, v246, v247
    v_mfma_f32_16x16x32_bf16 a[28:31], v[104:107], v[56:59], a[28:31]
    ds_read_b128 a[224:227], v2 offset:8192
    ds_read_b128 a[228:231], v2 offset:9216
    v_mfma_f32_16x16x32_bf16 a[28:31], v[108:111], v[60:63], a[28:31]
    ds_read_b128 a[232:235], v2 offset:10240
    v_add_f32 v214, s14, v148
    v_mfma_f32_16x16x32_bf16 v[252:255], a[240:243], v[132:135], v[180:183]
    ds_read_b128 a[236:239], v2 offset:11264
    v_fma_f32 v184, v208, s10, v214
    v_mfma_f32_16x16x32_bf16 v[252:255], a[244:247], v[164:167], v[252:255]
    ds_read_b128 v[96:99], v2 offset:24576
    v_fma_f32 v185, v209, s10, v214
    v_mfma_f32_16x16x32_bf16 v[252:255], a[248:251], v[196:199], v[252:255]
    ds_read_b128 v[100:103], v2 offset:25600
    v_fma_f32 v186, v210, s10, v214
    v_mfma_f32_16x16x32_bf16 v[252:255], a[252:255], v[228:231], v[252:255]
    v_exp_f32 v248, v248
    v_mfma_f32_16x16x32_bf16 a[32:35], v[112:115], v[32:35], a[32:35]
    v_exp_f32 v249, v249
    v_mfma_f32_16x16x32_bf16 a[32:35], v[116:119], v[36:39], a[32:35]
    v_exp_f32 v250, v250
    v_mfma_f32_16x16x32_bf16 a[36:39], v[112:115], v[40:43], a[36:39]
    v_exp_f32 v251, v251
    v_mfma_f32_16x16x32_bf16 a[36:39], v[116:119], v[44:47], a[36:39]
    v_fma_f32 v187, v211, s10, v214
    v_cvt_pk_bf16_f32 v88, v248, v249
    v_mfma_f32_16x16x32_bf16 v[240:243], a[240:243], v[136:139], v[152:155]
    v_cvt_pk_bf16_f32 v89, v250, v251
    ds_read_b128 v[104:107], v2 offset:26624
    v_mfma_f32_16x16x32_bf16 v[240:243], a[244:247], v[168:171], v[240:243]
    v_exp_f32 v252, v252
    v_mfma_f32_16x16x32_bf16 v[240:243], a[248:251], v[200:203], v[240:243]
    v_exp_f32 v253, v253
    v_mfma_f32_16x16x32_bf16 v[240:243], a[252:255], v[232:235], v[240:243]
    v_exp_f32 v254, v254
    v_mfma_f32_16x16x32_bf16 a[40:43], v[112:115], v[48:51], a[40:43]
    v_exp_f32 v255, v255
    v_mfma_f32_16x16x32_bf16 a[40:43], v[116:119], v[52:55], a[40:43]
    v_cvt_pk_bf16_f32 v74, v252, v253
    v_cvt_pk_bf16_f32 v75, v254, v255
    v_mfma_f32_16x16x32_bf16 a[44:47], v[112:115], v[56:59], a[44:47]
    ds_read_b128 v[108:111], v2 offset:27648
    ds_read_b128 v[112:115], v2 offset:28672
    v_mfma_f32_16x16x32_bf16 a[44:47], v[116:119], v[60:63], a[44:47]
    s_waitcnt lgkmcnt(2)
    v_exp_f32 v240, v240
    v_mfma_f32_16x16x32_bf16 a[48:51], v[120:123], v[32:35], a[48:51]
    v_exp_f32 v241, v241
    v_mfma_f32_16x16x32_bf16 a[48:51], v[124:127], v[36:39], a[48:51]
    v_exp_f32 v242, v242
    v_mfma_f32_16x16x32_bf16 v[244:247], a[240:243], v[140:143], v[156:159]
    v_exp_f32 v243, v243
    v_mfma_f32_16x16x32_bf16 v[244:247], a[244:247], v[172:175], v[244:247]
    v_cvt_pk_bf16_f32 v82, v240, v241
    v_cvt_pk_bf16_f32 v83, v242, v243
    v_mfma_f32_16x16x32_bf16 v[244:247], a[248:251], v[204:207], v[244:247]
    ds_read_b128 a[240:243], v2 offset:12288
    ds_read_b128 a[244:247], v2 offset:13312
    v_mfma_f32_16x16x32_bf16 v[244:247], a[252:255], v[236:239], v[244:247]
    ds_read_b128 a[248:251], v2 offset:14336
    v_add_f32 v215, s15, v148
    v_mfma_f32_16x16x32_bf16 a[52:55], v[120:123], v[40:43], a[52:55]
    ds_read_b128 a[252:255], v2 offset:15360
    v_fma_f32 v188, v208, s11, v215
    v_mfma_f32_16x16x32_bf16 a[52:55], v[124:127], v[44:47], a[52:55]
    ds_read_b128 v[116:119], v2 offset:29696
    v_fma_f32 v189, v209, s11, v215
    v_mfma_f32_16x16x32_bf16 a[56:59], v[120:123], v[48:51], a[56:59]
    v_exp_f32 v244, v244
    v_mfma_f32_16x16x32_bf16 a[56:59], v[124:127], v[52:55], a[56:59]
    v_exp_f32 v245, v245
    v_mfma_f32_16x16x32_bf16 a[60:63], v[120:123], v[56:59], a[60:63]
    v_exp_f32 v246, v246
    v_mfma_f32_16x16x32_bf16 a[60:63], v[124:127], v[60:63], a[60:63]
    v_exp_f32 v247, v247
    v_mfma_f32_16x16x32_bf16 v[248:251], a[224:227], v[132:135], v[184:187]
    v_fma_f32 v190, v210, s11, v215
    v_fma_f32 v191, v211, s11, v215
    v_mfma_f32_16x16x32_bf16 v[248:251], a[228:231], v[164:167], v[248:251]
    v_cvt_pk_bf16_f32 v90, v244, v245
    v_cvt_pk_bf16_f32 v91, v246, v247
    v_mfma_f32_16x16x32_bf16 v[248:251], a[232:235], v[196:199], v[248:251]
    ds_read_b128 v[120:123], v2 offset:30720
    ds_read_b128 v[124:127], v2 offset:31744
    v_mfma_f32_16x16x32_bf16 v[248:251], a[236:239], v[228:231], v[248:251]
    s_add_u32 m0, s76, s75
    v_bfe_u32 v8, v1, 2, 6
    v_accvgpr_read_b32 v4, a112
    v_mfma_f32_16x16x32_bf16 a[144:147], v[96:99], v[32:35], a[144:147]
    s_mov_b32 s76, s60
    buffer_load_dwordx4 v1, s[36:39], s77 offen sc1 lds
    v_mfma_f32_16x16x32_bf16 a[144:147], v[100:103], v[36:39], a[144:147]
    s_mov_b32 s60, s82
    v_exp_f32 v248, v248
    v_mfma_f32_16x16x32_bf16 a[148:151], v[96:99], v[40:43], a[148:151]
    s_add_u32 s82, s82, 32768
    v_exp_f32 v249, v249
    v_mfma_f32_16x16x32_bf16 a[148:151], v[100:103], v[44:47], a[148:151]
    v_exp_f32 v250, v250
    v_mfma_f32_16x16x32_bf16 v[252:255], a[224:227], v[136:139], v[152:155]
    v_exp_f32 v251, v251
    v_mfma_f32_16x16x32_bf16 v[252:255], a[228:231], v[168:171], v[252:255]
    v_cvt_pk_bf16_f32 v76, v248, v249
    v_cvt_pk_bf16_f32 v77, v250, v251
    v_mfma_f32_16x16x32_bf16 v[252:255], a[232:235], v[200:203], v[252:255]
    s_cmp_eq_u32 s82, 163840
    s_cselect_b32 s82, 0, s82
    v_add_u32 v2, s82, v1
    v_mfma_f32_16x16x32_bf16 v[252:255], a[236:239], v[232:235], v[252:255]
    buffer_load_dwordx4 v1, s[36:39], s77 offen offset:1024 sc1 lds
    v_mfma_f32_16x16x32_bf16 a[152:155], v[96:99], v[48:51], a[152:155]
    v_accvgpr_read_b32 v5, a116
    v_add_u32 v8, 192, v8
    v_mfma_f32_16x16x32_bf16 a[152:155], v[100:103], v[52:55], a[152:155]
    v_cvt_pk_bf16_f32 v4, 0, v4
    v_cvt_pk_bf16_f32 v5, 0, v5
    v_mfma_f32_16x16x32_bf16 a[156:159], v[96:99], v[56:59], a[156:159]
    v_exp_f32 v252, v252
    v_mfma_f32_16x16x32_bf16 a[156:159], v[100:103], v[60:63], a[156:159]
    v_exp_f32 v253, v253
    v_mfma_f32_16x16x32_bf16 a[160:163], v[104:107], v[32:35], a[160:163]
    s_waitcnt lgkmcnt(0)
    v_exp_f32 v254, v254
    v_mfma_f32_16x16x32_bf16 a[160:163], v[108:111], v[36:39], a[160:163]
    v_exp_f32 v255, v255
    v_mfma_f32_16x16x32_bf16 v[240:243], a[224:227], v[140:143], v[156:159]
    v_cvt_pk_bf16_f32 v84, v252, v253
    v_cvt_pk_bf16_f32 v85, v254, v255
    v_mfma_f32_16x16x32_bf16 v[240:243], a[228:231], v[172:175], v[240:243]
    buffer_load_dwordx4 v1, s[36:39], s77 offen offset:2048 sc1 lds
    v_mfma_f32_16x16x32_bf16 v[240:243], a[232:235], v[204:207], v[240:243]
    v_lshrrev_b32 v15, 8, v1
    ds_bpermute_b32 v4, v8, v4
    v_mfma_f32_16x16x32_bf16 v[240:243], a[236:239], v[236:239], v[240:243]
    ds_bpermute_b32 v5, v8, v5
    ds_read_b128 a[224:227], v2 offset:0
    v_mfma_f32_16x16x32_bf16 a[164:167], v[104:107], v[40:43], a[164:167]
    ds_read_b128 a[228:231], v2 offset:1024
    v_bfe_u32 v14, v1, 4, 4
    v_mfma_f32_16x16x32_bf16 a[164:167], v[108:111], v[44:47], a[164:167]
    ds_read_b128 a[232:235], v2 offset:2048
    v_lshlrev_b32 v15, 3, v15
    v_mfma_f32_16x16x32_bf16 a[168:171], v[104:107], v[48:51], a[168:171]
    ds_read_b128 a[236:239], v2 offset:3072
    v_sub_u32 v14, v14, v15
    v_mfma_f32_16x16x32_bf16 a[168:171], v[108:111], v[52:55], a[168:171]
    ds_read_b128 v[96:99], v2 offset:16384
    v_and_b32 v15, 16, v1
    v_mfma_f32_16x16x32_bf16 a[172:175], v[104:107], v[56:59], a[172:175]
    buffer_load_dwordx4 v1, s[36:39], s77 offen offset:3072 sc1 lds
    v_mfma_f32_16x16x32_bf16 a[172:175], v[108:111], v[60:63], a[172:175]
    ds_read_b128 v[100:103], v2 offset:17408
    v_mov_b32 v31, 0x3f80
    v_mfma_f32_16x16x32_bf16 v[244:247], a[240:243], v[132:135], v[188:191]
    v_exp_f32 v240, v240
    v_mfma_f32_16x16x32_bf16 v[244:247], a[244:247], v[164:167], v[244:247]
    v_exp_f32 v241, v241
    v_mfma_f32_16x16x32_bf16 v[244:247], a[248:251], v[196:199], v[244:247]
    v_exp_f32 v242, v242
    v_mfma_f32_16x16x32_bf16 v[244:247], a[252:255], v[228:231], v[244:247]
    v_exp_f32 v243, v243
    v_mfma_f32_16x16x32_bf16 a[176:179], v[112:115], v[32:35], a[176:179]
    v_cvt_pk_bf16_f32 v92, v240, v241
    v_cvt_pk_bf16_f32 v93, v242, v243
    v_mfma_f32_16x16x32_bf16 a[176:179], v[116:119], v[36:39], a[176:179]
    s_add_u32 s100, s77, 4096
    v_ashrrev_i32 v14, 1, v14
    v_lshlrev_b32 v15, v15, v31
    v_mfma_f32_16x16x32_bf16 a[180:183], v[112:115], v[40:43], a[180:183]
    s_add_u32 m0, m0, 4096
    v_exp_f32 v244, v244
    v_mfma_f32_16x16x32_bf16 a[180:183], v[116:119], v[44:47], a[180:183]
    buffer_load_dwordx4 v1, s[36:39], s100 offen sc1 lds
    v_mfma_f32_16x16x32_bf16 v[248:251], a[240:243], v[136:139], v[152:155]
    v_exp_f32 v245, v245
    v_mfma_f32_16x16x32_bf16 v[248:251], a[244:247], v[168:171], v[248:251]
    v_exp_f32 v246, v246
    v_mfma_f32_16x16x32_bf16 v[248:251], a[248:251], v[200:203], v[248:251]
    v_exp_f32 v247, v247
    v_mfma_f32_16x16x32_bf16 v[248:251], a[252:255], v[232:235], v[248:251]
    v_cvt_pk_bf16_f32 v78, v244, v245
    v_cvt_pk_bf16_f32 v79, v246, v247
    v_mfma_f32_16x16x32_bf16 a[184:187], v[112:115], v[48:51], a[184:187]
    s_waitcnt lgkmcnt(0)
    v_cmp_eq_i32 vcc, 0, v14
    v_mul_f32 v4, s98, v4
    v_mfma_f32_16x16x32_bf16 a[184:187], v[116:119], v[52:55], a[184:187]
    buffer_load_dwordx4 v1, s[36:39], s100 offen offset:1024 sc1 lds
    v_mfma_f32_16x16x32_bf16 a[188:191], v[112:115], v[56:59], a[188:191]
    v_exp_f32 v248, v248
    v_mfma_f32_16x16x32_bf16 a[188:191], v[116:119], v[60:63], a[188:191]
    v_exp_f32 v249, v249
    v_mfma_f32_16x16x32_bf16 a[192:195], v[120:123], v[32:35], a[192:195]
    v_exp_f32 v250, v250
    v_mfma_f32_16x16x32_bf16 a[192:195], v[124:127], v[36:39], a[192:195]
    v_exp_f32 v251, v251
    v_mfma_f32_16x16x32_bf16 v[252:255], a[240:243], v[140:143], v[156:159]
    v_cvt_pk_bf16_f32 v86, v248, v249
    v_cvt_pk_bf16_f32 v87, v250, v251
    v_mfma_f32_16x16x32_bf16 v[252:255], a[244:247], v[172:175], v[252:255]
    v_cndmask_b32 v216, 0, v15, vcc
    v_cmp_eq_i32 vcc, 1, v14
    v_mfma_f32_16x16x32_bf16 v[252:255], a[248:251], v[204:207], v[252:255]
    v_mul_f32 v5, s98, v5
    v_cndmask_b32 v217, 0, v15, vcc
    v_mfma_f32_16x16x32_bf16 v[252:255], a[252:255], v[236:239], v[252:255]
    buffer_load_dwordx4 v1, s[36:39], s100 offen offset:2048 sc1 lds
    v_mfma_f32_16x16x32_bf16 a[196:199], v[120:123], v[40:43], a[196:199]
    v_cmp_eq_i32 vcc, 2, v14
    v_and_b32 v31, 512, v1
    v_mfma_f32_16x16x32_bf16 a[196:199], v[124:127], v[44:47], a[196:199]
    v_cndmask_b32 v218, 0, v15, vcc
    v_cmp_eq_i32 vcc, 3, v14
    v_mfma_f32_16x16x32_bf16 a[200:203], v[120:123], v[48:51], a[200:203]
    v_exp_f32 v252, v252
    v_mfma_f32_16x16x32_bf16 a[200:203], v[124:127], v[52:55], a[200:203]
    v_exp_f32 v253, v253
    v_mfma_f32_16x16x32_bf16 a[204:207], v[120:123], v[56:59], a[204:207]
    v_cvt_pk_bf16_f32 v94, v252, v253
    v_cndmask_b32 v219, 0, v15, vcc
    v_mfma_f32_16x16x32_bf16 a[204:207], v[124:127], v[60:63], a[204:207]
    v_cmp_eq_i32 vcc, -8, v14
    v_mad_u32_u24 v31, v31, 3, v1
    v_mfma_f32_16x16x32_bf16 a[208:211], a[136:139], v[32:35], a[208:211]
    buffer_load_dwordx4 v1, s[36:39], s100 offen offset:3072 sc1 lds
    v_mfma_f32_16x16x32_bf16 a[208:211], a[136:139], v[36:39], a[208:211]
    v_cndmask_b32 v220, 0, v15, vcc
    v_cmp_eq_i32 vcc, -7, v14
    v_mfma_f32_16x16x32_bf16 a[212:215], a[136:139], v[40:43], a[212:215]
    v_exp_f32 v4, v4
    v_mfma_f32_16x16x32_bf16 a[212:215], a[136:139], v[44:47], a[212:215]
    v_exp_f32 v5, v5
    v_mfma_f32_16x16x32_bf16 a[216:219], a[136:139], v[48:51], a[216:219]
    v_cndmask_b32 v221, 0, v15, vcc
    v_cmp_eq_i32 vcc, -6, v14
    v_mfma_f32_16x16x32_bf16 a[216:219], a[136:139], v[52:55], a[216:219]
    v_add_f32 v4, 1.0, v4
    v_add_f32 v5, 1.0, v5
    v_mfma_f32_16x16x32_bf16 a[220:223], a[136:139], v[56:59], a[220:223]
    v_cndmask_b32 v222, 0, v15, vcc
    v_cmp_eq_i32 vcc, -5, v14
    v_mfma_f32_16x16x32_bf16 a[220:223], a[136:139], v[60:63], a[220:223]
    s_add_u32 s77, s77, 32768
    v_rcp_f32 v4, v4
    v_rcp_f32 v5, v5
    v_cndmask_b32 v223, 0, v15, vcc
    s_cmp_eq_u32 s6, 7
    s_cselect_b32 s16, s8, 0
    s_cselect_b32 s17, s9, 0
    s_cselect_b32 s18, s10, 0
    s_cselect_b32 s19, s11, 0
    s_cselect_b32 s20, s12, 0
    s_cselect_b32 s21, s13, 0
    s_cselect_b32 s22, s14, 0
    s_cselect_b32 s23, s15, 0
    v_add_f32 v212, s20, v152
    v_fma_f32 v176, v208, s16, v212
    v_fma_f32 v177, v209, s16, v212
    v_fma_f32 v178, v210, s16, v212
    v_fma_f32 v179, v211, s16, v212
    s_nop 1
    s_waitcnt lgkmcnt(0)
    v_mfma_f32_16x16x32_bf16 v[240:243], a[224:227], v[136:139], v[176:179]
    s_add_u32 m0, s76, s75
    v_exp_f32 v254, v254
    v_mfma_f32_16x16x32_bf16 v[240:243], a[228:231], v[168:171], v[240:243]
    s_mov_b32 s76, s60
    buffer_load_dwordx4 v1, s[36:39], s77 offen sc1 lds
    v_mfma_f32_16x16x32_bf16 v[240:243], a[232:235], v[200:203], v[240:243]
    s_mov_b32 s60, s82
    v_exp_f32 v255, v255
    v_mfma_f32_16x16x32_bf16 v[240:243], a[236:239], v[232:235], v[240:243]
    s_add_u32 s82, s82, 32768
    ds_read_b128 v[104:107], v2 offset:18432
    v_cvt_pk_bf16_f32 v95, v254, v255
    v_mfma_f32_16x16x32_bf16 a[4:7], v[96:99], v[72:75], a[4:7]
    ds_read_b128 v[108:111], v2 offset:19456
    ds_read_b128 a[240:243], v2 offset:4096
    v_mfma_f32_16x16x32_bf16 a[4:7], v[100:103], v[76:79], a[4:7]
    ds_read_b128 a[244:247], v2 offset:5120
    v_add_f32 v213, s21, v152
    v_mfma_f32_16x16x32_bf16 a[8:11], v[96:99], v[80:83], a[8:11]
    ds_read_b128 a[248:251], v2 offset:6144
    v_fma_f32 v180, v208, s17, v213
    v_mfma_f32_16x16x32_bf16 a[8:11], v[100:103], v[84:87], a[8:11]
    ds_read_b128 a[252:255], v2 offset:7168
    v_fma_f32 v181, v209, s17, v213
    v_mfma_f32_16x16x32_bf16 a[12:15], v[96:99], v[88:91], a[12:15]
    ds_read_b128 v[112:115], v2 offset:20480
    v_fma_f32 v182, v210, s17, v213
    v_mfma_f32_16x16x32_bf16 a[12:15], v[100:103], v[92:95], a[12:15]
    ds_read_b128 v[116:119], v2 offset:21504
    v_fma_f32 v183, v211, s17, v213
    v_mfma_f32_16x16x32_bf16 v[244:247], a[224:227], v[140:143], v[156:159]
    buffer_load_dwordx4 v1, s[36:39], s77 offen offset:1024 sc1 lds
    v_mfma_f32_16x16x32_bf16 v[244:247], a[228:231], v[172:175], v[244:247]
    ds_read_b128 v[120:123], v2 offset:22528
    ds_read_b128 v[124:127], v2 offset:23552
    v_mfma_f32_16x16x32_bf16 v[244:247], a[232:235], v[204:207], v[244:247]
    ds_read_b128 a[224:227], v2 offset:8192
    v_add_f32 v214, s22, v152
    v_mfma_f32_16x16x32_bf16 v[244:247], a[236:239], v[236:239], v[244:247]
    s_waitcnt lgkmcnt(4)
    ds_read_b128 a[228:231], v2 offset:9216
    v_fma_f32 v184, v208, s18, v214
    v_mfma_f32_16x16x32_bf16 a[20:23], v[104:107], v[72:75], a[20:23]
    ds_read_b128 a[232:235], v2 offset:10240
    v_fma_f32 v185, v209, s18, v214
    v_mfma_f32_16x16x32_bf16 a[20:23], v[108:111], v[76:79], a[20:23]
    ds_read_b128 a[236:239], v2 offset:11264
    v_fma_f32 v186, v210, s18, v214
    v_mfma_f32_16x16x32_bf16 a[24:27], v[104:107], v[80:83], a[24:27]
    ds_read_b128 v[96:99], v2 offset:24576
    v_fma_f32 v187, v211, s18, v214
    v_mfma_f32_16x16x32_bf16 a[24:27], v[108:111], v[84:87], a[24:27]
    ds_read_b128 v[100:103], v2 offset:25600
    v_add_f32 v215, s23, v152
    v_mfma_f32_16x16x32_bf16 a[28:31], v[104:107], v[88:91], a[28:31]
    v_exp_f32 v240, v240
    v_mfma_f32_16x16x32_bf16 a[28:31], v[108:111], v[92:95], a[28:31]
    v_exp_f32 v241, v241
    v_mfma_f32_16x16x32_bf16 v[248:251], a[240:243], v[136:139], v[180:183]
    buffer_load_dwordx4 v1, s[36:39], s77 offen offset:2048 sc1 lds
    v_mfma_f32_16x16x32_bf16 v[248:251], a[244:247], v[168:171], v[248:251]
    v_exp_f32 v242, v242
    v_mfma_f32_16x16x32_bf16 v[248:251], a[248:251], v[200:203], v[248:251]
    v_exp_f32 v243, v243
    v_mfma_f32_16x16x32_bf16 v[248:251], a[252:255], v[232:235], v[248:251]
    v_cvt_pk_bf16_f32 v48, v240, v241
    v_cvt_pk_bf16_f32 v49, v242, v243
    v_mfma_f32_16x16x32_bf16 a[36:39], v[112:115], v[72:75], a[36:39]
    s_waitcnt lgkmcnt(0)
    ds_read_b128 v[104:107], v2 offset:26624
    ds_read_b128 v[108:111], v2 offset:27648
    v_mfma_f32_16x16x32_bf16 a[36:39], v[116:119], v[76:79], a[36:39]
    v_exp_f32 v244, v244
    v_mfma_f32_16x16x32_bf16 a[40:43], v[112:115], v[80:83], a[40:43]
    v_exp_f32 v245, v245
    v_mfma_f32_16x16x32_bf16 a[40:43], v[116:119], v[84:87], a[40:43]
    v_exp_f32 v246, v246
    v_mfma_f32_16x16x32_bf16 a[44:47], v[112:115], v[88:91], a[44:47]
    v_exp_f32 v247, v247
    v_mfma_f32_16x16x32_bf16 a[44:47], v[116:119], v[92:95], a[44:47]
    s_waitcnt vmcnt(11)
    buffer_load_dwordx4 v1, s[36:39], s77 offen offset:3072 sc1 lds
    v_mfma_f32_16x16x32_bf16 v[12:15], v[64:67], v[216:219], 0
    v_cvt_pk_bf16_f32 v56, v244, v245
    v_cvt_pk_bf16_f32 v57, v246, v247
    v_mfma_f32_16x16x32_bf16 v[16:19], v[68:71], v[216:219], 0
    ds_read_b128 v[112:115], v2 offset:28672
    ds_read_b128 v[116:119], v2 offset:29696
    v_mfma_f32_16x16x32_bf16 v[252:255], a[240:243], v[140:143], v[156:159]
    ds_read_b128 a[240:243], v2 offset:12288
    v_fma_f32 v188, v208, s19, v215
    v_mfma_f32_16x16x32_bf16 v[252:255], a[244:247], v[172:175], v[252:255]
    v_cvt_pk_bf16_f32 v12, v12, v13
    v_cvt_pk_bf16_f32 v13, v14, v15
    v_mfma_f32_16x16x32_bf16 v[252:255], a[248:251], v[204:207], v[252:255]
    v_cvt_pk_bf16_f32 v14, v16, v17
    v_cvt_pk_bf16_f32 v15, v18, v19
    v_mfma_f32_16x16x32_bf16 v[252:255], a[252:255], v[236:239], v[252:255]
    buffer_store_dwordx4 v[12:15], v31, s[56:59], s63 offen offset:0 sc1
    v_mfma_f32_16x16x32_bf16 a[52:55], v[120:123], v[72:75], a[52:55]
    ds_read_b128 a[244:247], v2 offset:13312
    ds_read_b128 a[248:251], v2 offset:14336
    v_mfma_f32_16x16x32_bf16 a[52:55], v[124:127], v[76:79], a[52:55]
    ds_read_b128 a[252:255], v2 offset:15360
    v_fma_f32 v189, v209, s19, v215
    v_mfma_f32_16x16x32_bf16 a[56:59], v[120:123], v[80:83], a[56:59]
    s_add_u32 s100, s77, 4096
    v_exp_f32 v248, v248
    v_mfma_f32_16x16x32_bf16 a[56:59], v[124:127], v[84:87], a[56:59]
    s_add_u32 m0, m0, 4096
    v_exp_f32 v249, v249
    v_mfma_f32_16x16x32_bf16 a[60:63], v[120:123], v[88:91], a[60:63]
    buffer_load_dwordx4 v1, s[36:39], s100 offen sc1 lds
    v_mfma_f32_16x16x32_bf16 a[60:63], v[124:127], v[92:95], a[60:63]
    v_exp_f32 v250, v250
    v_mfma_f32_16x16x32_bf16 v[12:15], v[64:67], v[220:223], 0
    v_exp_f32 v251, v251
    v_mfma_f32_16x16x32_bf16 v[16:19], v[68:71], v[220:223], 0
    v_fma_f32 v190, v210, s19, v215
    v_fma_f32 v191, v211, s19, v215
    v_mfma_f32_16x16x32_bf16 v[240:243], a[224:227], v[136:139], v[184:187]
    v_cvt_pk_bf16_f32 v50, v248, v249
    v_cvt_pk_bf16_f32 v51, v250, v251
    v_mfma_f32_16x16x32_bf16 v[240:243], a[228:231], v[168:171], v[240:243]
    v_cvt_pk_bf16_f32 v12, v12, v13
    v_cvt_pk_bf16_f32 v13, v14, v15
    v_mfma_f32_16x16x32_bf16 v[240:243], a[232:235], v[200:203], v[240:243]
    v_cvt_pk_bf16_f32 v14, v16, v17
    v_cvt_pk_bf16_f32 v15, v18, v19
    v_mfma_f32_16x16x32_bf16 v[240:243], a[236:239], v[232:235], v[240:243]
    buffer_store_dwordx4 v[12:15], v31, s[56:59], s63 offen offset:1024 sc1
    v_mfma_f32_16x16x32_bf16 a[148:151], v[96:99], v[72:75], a[148:151]
    buffer_load_dwordx4 v1, s[36:39], s100 offen offset:1024 sc1 lds
    v_mfma_f32_16x16x32_bf16 a[148:151], v[100:103], v[76:79], a[148:151]
    ds_read_b128 v[120:123], v2 offset:30720
    ds_read_b128 v[124:127], v2 offset:31744
    v_mfma_f32_16x16x32_bf16 a[152:155], v[96:99], v[80:83], a[152:155]
    v_exp_f32 v252, v252
    v_mfma_f32_16x16x32_bf16 a[152:155], v[100:103], v[84:87], a[152:155]
    v_exp_f32 v253, v253
    v_mfma_f32_16x16x32_bf16 a[156:159], v[96:99], v[88:91], a[156:159]
    v_exp_f32 v254, v254
    v_mfma_f32_16x16x32_bf16 a[156:159], v[100:103], v[92:95], a[156:159]
    v_exp_f32 v255, v255
    v_mfma_f32_16x16x32_bf16 v[12:15], v[20:23], v[216:219], 0
    v_cvt_pk_bf16_f32 v58, v252, v253
    v_cvt_pk_bf16_f32 v59, v254, v255
    v_mfma_f32_16x16x32_bf16 v[16:19], v[24:27], v[216:219], 0
    v_exp_f32 v240, v240
    v_mfma_f32_16x16x32_bf16 v[244:247], a[224:227], v[140:143], v[156:159]
    v_exp_f32 v241, v241
    v_mfma_f32_16x16x32_bf16 v[244:247], a[228:231], v[172:175], v[244:247]
    v_exp_f32 v242, v242
    v_mfma_f32_16x16x32_bf16 v[244:247], a[232:235], v[204:207], v[244:247]
    buffer_load_dwordx4 v1, s[36:39], s100 offen offset:2048 sc1 lds
    v_mfma_f32_16x16x32_bf16 v[244:247], a[236:239], v[236:239], v[244:247]
    s_waitcnt lgkmcnt(0)
    v_cvt_pk_bf16_f32 v12, v12, v13
    v_cvt_pk_bf16_f32 v13, v14, v15
    v_mfma_f32_16x16x32_bf16 a[164:167], v[104:107], v[72:75], a[164:167]
    v_cvt_pk_bf16_f32 v14, v16, v17
    v_cvt_pk_bf16_f32 v15, v18, v19
    v_mfma_f32_16x16x32_bf16 a[164:167], v[108:111], v[76:79], a[164:167]
    buffer_store_dwordx4 v[12:15], v31, s[56:59], s63 offen offset:512 sc1
    v_mfma_f32_16x16x32_bf16 a[168:171], v[104:107], v[80:83], a[168:171]
    s_cmp_eq_u32 s82, 163840
    s_cselect_b32 s82, 0, s82
    v_add_u32 v2, s82, v1
    v_mfma_f32_16x16x32_bf16 a[168:171], v[108:111], v[84:87], a[168:171]
    v_exp_f32 v243, v243
    v_mfma_f32_16x16x32_bf16 a[172:175], v[104:107], v[88:91], a[172:175]
    v_exp_f32 v244, v244
    v_mfma_f32_16x16x32_bf16 a[172:175], v[108:111], v[92:95], a[172:175]
    v_exp_f32 v245, v245
    v_mfma_f32_16x16x32_bf16 v[12:15], v[20:23], v[220:223], 0
    v_exp_f32 v246, v246
    v_mfma_f32_16x16x32_bf16 v[16:19], v[24:27], v[220:223], 0
    buffer_load_dwordx4 v1, s[36:39], s100 offen offset:3072 sc1 lds
    v_mfma_f32_16x16x32_bf16 v[248:251], a[240:243], v[136:139], v[188:191]
    v_exp_f32 v247, v247
    v_mfma_f32_16x16x32_bf16 v[248:251], a[244:247], v[168:171], v[248:251]
    v_cvt_pk_bf16_f32 v52, v240, v241
    v_cvt_pk_bf16_f32 v53, v242, v243
    v_mfma_f32_16x16x32_bf16 v[248:251], a[248:251], v[200:203], v[248:251]
    v_cvt_pk_bf16_f32 v12, v12, v13
    v_cvt_pk_bf16_f32 v13, v14, v15
    v_mfma_f32_16x16x32_bf16 v[248:251], a[252:255], v[232:235], v[248:251]
    v_cvt_pk_bf16_f32 v14, v16, v17
    v_cvt_pk_bf16_f32 v15, v18, v19
    v_mfma_f32_16x16x32_bf16 a[180:183], v[112:115], v[72:75], a[180:183]
    buffer_store_dwordx4 v[12:15], v31, s[56:59], s63 offen offset:1536 sc1
    v_mfma_f32_16x16x32_bf16 a[180:183], v[116:119], v[76:79], a[180:183]
    v_cvt_pk_bf16_f32 v60, v244, v245
    v_cvt_pk_bf16_f32 v61, v246, v247
    v_mfma_f32_16x16x32_bf16 a[184:187], v[112:115], v[80:83], a[184:187]
    v_exp_f32 v248, v248
    v_mfma_f32_16x16x32_bf16 a[184:187], v[116:119], v[84:87], a[184:187]
    v_exp_f32 v249, v249
    v_mfma_f32_16x16x32_bf16 a[188:191], v[112:115], v[88:91], a[188:191]
    s_add_u32 s77, s77, 32768
    v_exp_f32 v250, v250
    v_mfma_f32_16x16x32_bf16 a[188:191], v[116:119], v[92:95], a[188:191]
    v_exp_f32 v251, v251
    v_mfma_f32_16x16x32_bf16 v[12:15], v[144:147], v[216:219], 0
    v_cvt_pk_bf16_f32 v54, v248, v249
    v_cvt_pk_bf16_f32 v55, v250, v251
    v_mfma_f32_16x16x32_bf16 v[16:19], a[140:143], v[216:219], 0
    v_accvgpr_read_b32 v6, a120
    v_accvgpr_read_b32 v7, a124
    v_mfma_f32_16x16x32_bf16 v[252:255], a[240:243], v[140:143], v[156:159]
    v_cvt_pk_bf16_f32 v6, 0, v6
    v_cvt_pk_bf16_f32 v7, 0, v7
    v_mfma_f32_16x16x32_bf16 v[252:255], a[244:247], v[172:175], v[252:255]
    v_cvt_pk_bf16_f32 v12, v12, v13
    v_cvt_pk_bf16_f32 v13, v14, v15
    v_mfma_f32_16x16x32_bf16 v[252:255], a[248:251], v[204:207], v[252:255]
    v_cvt_pk_bf16_f32 v14, v16, v17
    v_cvt_pk_bf16_f32 v15, v18, v19
    v_mfma_f32_16x16x32_bf16 v[252:255], a[252:255], v[236:239], v[252:255]
    buffer_store_dwordx4 v[12:15], v1, s[56:59], s64 offen offset:0 sc1
    v_mfma_f32_16x16x32_bf16 a[196:199], v[120:123], v[72:75], a[196:199]
    ds_bpermute_b32 v6, v8, v6
    ds_bpermute_b32 v7, v8, v7
    v_mfma_f32_16x16x32_bf16 a[196:199], v[124:127], v[76:79], a[196:199]
    s_waitcnt vmcnt(8) lgkmcnt(0)
    s_barrier
    ds_read_b128 a[224:227], v2 offset:0
    v_mfma_f32_16x16x32_bf16 a[200:203], v[120:123], v[80:83], a[200:203]
    ds_read_b128 a[228:231], v2 offset:1024
    ds_read_b128 a[232:235], v2 offset:2048
    v_mfma_f32_16x16x32_bf16 a[200:203], v[124:127], v[84:87], a[200:203]
    ds_read_b128 a[236:239], v2 offset:3072
    v_mul_f32 v6, s98, v6
    v_mfma_f32_16x16x32_bf16 a[204:207], v[120:123], v[88:91], a[204:207]
    ds_read_b128 v[96:99], v2 offset:16384
    v_mul_f32 v7, s98, v7
    v_mfma_f32_16x16x32_bf16 a[204:207], v[124:127], v[92:95], a[204:207]
    v_exp_f32 v252, v252
    v_mfma_f32_16x16x32_bf16 v[12:15], v[144:147], v[220:223], 0
    v_exp_f32 v253, v253
    v_mfma_f32_16x16x32_bf16 v[16:19], a[140:143], v[220:223], 0
    ds_read_b128 v[100:103], v2 offset:17408
    v_cvt_pk_bf16_f32 v62, v252, v253
    v_mfma_f32_16x16x32_bf16 a[212:215], a[136:139], v[72:75], a[212:215]
    v_exp_f32 v6, v6
    v_mfma_f32_16x16x32_bf16 a[212:215], a[136:139], v[76:79], a[212:215]
    v_exp_f32 v7, v7
    v_mfma_f32_16x16x32_bf16 a[216:219], a[136:139], v[80:83], a[216:219]
    v_cvt_pk_bf16_f32 v12, v12, v13
    v_cvt_pk_bf16_f32 v13, v14, v15
    v_mfma_f32_16x16x32_bf16 a[216:219], a[136:139], v[84:87], a[216:219]
    v_cvt_pk_bf16_f32 v14, v16, v17
    v_cvt_pk_bf16_f32 v15, v18, v19
    v_mfma_f32_16x16x32_bf16 a[220:223], a[136:139], v[88:91], a[220:223]
    buffer_store_dwordx4 v[12:15], v1, s[56:59], s64 offen offset:1024 sc1
    v_mfma_f32_16x16x32_bf16 a[220:223], a[136:139], v[92:95], a[220:223]
    v_add_f32 v6, 1.0, v6
    v_add_f32 v7, 1.0, v7
    v_rcp_f32 v6, v6
    v_rcp_f32 v7, v7
    s_nop 1
    v_accvgpr_read_b32 v9, a208
    v_cmp_nge_f32 vcc, 0x71800000, v9
    v_rcp_f32 v10, v9
    s_nop 0
    s_or_b64 s[84:85], s[84:85], vcc
    v_mul_f32 v10, v10, v4
    v_accvgpr_read_b32 v12, a0
    v_accvgpr_read_b32 v13, a1
    v_accvgpr_read_b32 v14, a2
    v_accvgpr_read_b32 v15, a3
    v_accvgpr_read_b32 v16, a16
    v_accvgpr_read_b32 v17, a17
    v_accvgpr_read_b32 v18, a18
    v_accvgpr_read_b32 v19, a19
    v_pk_mul_f32 v[12:13], v[12:13], v[10:11] op_sel_hi:[1,0]
    v_pk_mul_f32 v[14:15], v[14:15], v[10:11] op_sel_hi:[1,0]
    v_pk_mul_f32 v[16:17], v[16:17], v[10:11] op_sel_hi:[1,0]
    v_pk_mul_f32 v[18:19], v[18:19], v[10:11] op_sel_hi:[1,0]
    v_cvt_pk_bf16_f32 v12, v12, v13
    v_cvt_pk_bf16_f32 v13, v14, v15
    v_cvt_pk_bf16_f32 v14, v16, v17
    v_cvt_pk_bf16_f32 v15, v18, v19
    buffer_store_dwordx4 v[12:15], v1, s[40:43], s80 offen offset:0 sc1
    v_accvgpr_read_b32 v20, a32
    v_accvgpr_read_b32 v21, a33
    v_accvgpr_read_b32 v22, a34
    v_accvgpr_read_b32 v23, a35
    v_accvgpr_read_b32 v24, a48
    v_accvgpr_read_b32 v25, a49
    v_accvgpr_read_b32 v26, a50
    v_accvgpr_read_b32 v27, a51
    v_pk_mul_f32 v[20:21], v[20:21], v[10:11] op_sel_hi:[1,0]
    v_pk_mul_f32 v[22:23], v[22:23], v[10:11] op_sel_hi:[1,0]
    v_pk_mul_f32 v[24:25], v[24:25], v[10:11] op_sel_hi:[1,0]
    v_pk_mul_f32 v[26:27], v[26:27], v[10:11] op_sel_hi:[1,0]
    v_cvt_pk_bf16_f32 v20, v20, v21
    v_cvt_pk_bf16_f32 v21, v22, v23
    v_cvt_pk_bf16_f32 v22, v24, v25
    v_cvt_pk_bf16_f32 v23, v26, v27
    buffer_store_dwordx4 v[20:23], v1, s[40:43], s80 offen offset:1024 sc1
    v_accvgpr_read_b32 v12, a144
    v_accvgpr_read_b32 v13, a145
    v_accvgpr_read_b32 v14, a146
    v_accvgpr_read_b32 v15, a147
    v_accvgpr_read_b32 v16, a160
    v_accvgpr_read_b32 v17, a161
    v_accvgpr_read_b32 v18, a162
    v_accvgpr_read_b32 v19, a163
    v_pk_mul_f32 v[12:13], v[12:13], v[10:11] op_sel_hi:[1,0]
    v_pk_mul_f32 v[14:15], v[14:15], v[10:11] op_sel_hi:[1,0]
    v_pk_mul_f32 v[16:17], v[16:17], v[10:11] op_sel_hi:[1,0]
    v_pk_mul_f32 v[18:19], v[18:19], v[10:11] op_sel_hi:[1,0]
    v_cvt_pk_bf16_f32 v12, v12, v13
    v_cvt_pk_bf16_f32 v13, v14, v15
    v_cvt_pk_bf16_f32 v14, v16, v17
    v_cvt_pk_bf16_f32 v15, v18, v19
    buffer_store_dwordx4 v[12:15], v1, s[40:43], s80 offen offset:2048 sc1
    v_accvgpr_read_b32 v20, a176
    v_accvgpr_read_b32 v21, a177
    v_accvgpr_read_b32 v22, a178
    v_accvgpr_read_b32 v23, a179
    v_accvgpr_read_b32 v24, a192
    v_accvgpr_read_b32 v25, a193
    v_accvgpr_read_b32 v26, a194
    v_accvgpr_read_b32 v27, a195
    v_pk_mul_f32 v[20:21], v[20:21], v[10:11] op_sel_hi:[1,0]
    v_pk_mul_f32 v[22:23], v[22:23], v[10:11] op_sel_hi:[1,0]
    v_pk_mul_f32 v[24:25], v[24:25], v[10:11] op_sel_hi:[1,0]
    v_pk_mul_f32 v[26:27], v[26:27], v[10:11] op_sel_hi:[1,0]
    v_cvt_pk_bf16_f32 v20, v20, v21
    v_cvt_pk_bf16_f32 v21, v22, v23
    v_cvt_pk_bf16_f32 v22, v24, v25
    v_cvt_pk_bf16_f32 v23, v26, v27
    buffer_store_dwordx4 v[20:23], v1, s[40:43], s80 offen offset:3072 sc1
    v_accvgpr_read_b32 v9, a212
    v_cmp_nge_f32 vcc, 0x71800000, v9
    v_rcp_f32 v10, v9
    s_nop 0
    s_or_b64 s[84:85], s[84:85], vcc
    v_mul_f32 v10, v10, v5
    s_add_u32 s72, s80, 622592
    v_accvgpr_read_b32 v12, a4
    v_accvgpr_read_b32 v13, a5
    v_accvgpr_read_b32 v14, a6
    v_accvgpr_read_b32 v15, a7
    v_accvgpr_read_b32 v16, a20
    v_accvgpr_read_b32 v17, a21
    v_accvgpr_read_b32 v18, a22
    v_accvgpr_read_b32 v19, a23
    v_pk_mul_f32 v[12:13], v[12:13], v[10:11] op_sel_hi:[1,0]
    v_pk_mul_f32 v[14:15], v[14:15], v[10:11] op_sel_hi:[1,0]
    v_pk_mul_f32 v[16:17], v[16:17], v[10:11] op_sel_hi:[1,0]
    v_pk_mul_f32 v[18:19], v[18:19], v[10:11] op_sel_hi:[1,0]
    v_cvt_pk_bf16_f32 v12, v12, v13
    v_cvt_pk_bf16_f32 v13, v14, v15
    v_cvt_pk_bf16_f32 v14, v16, v17
    v_cvt_pk_bf16_f32 v15, v18, v19
    buffer_store_dwordx4 v[12:15], v1, s[40:43], s72 offen offset:0 sc1
    v_accvgpr_read_b32 v20, a36
    v_accvgpr_read_b32 v21, a37
    v_accvgpr_read_b32 v22, a38
    v_accvgpr_read_b32 v23, a39
    v_accvgpr_read_b32 v24, a52
    v_accvgpr_read_b32 v25, a53
    v_accvgpr_read_b32 v26, a54
    v_accvgpr_read_b32 v27, a55
    v_pk_mul_f32 v[20:21], v[20:21], v[10:11] op_sel_hi:[1,0]
    v_pk_mul_f32 v[22:23], v[22:23], v[10:11] op_sel_hi:[1,0]
    v_pk_mul_f32 v[24:25], v[24:25], v[10:11] op_sel_hi:[1,0]
    v_pk_mul_f32 v[26:27], v[26:27], v[10:11] op_sel_hi:[1,0]
    v_cvt_pk_bf16_f32 v20, v20, v21
    v_cvt_pk_bf16_f32 v21, v22, v23
    v_cvt_pk_bf16_f32 v22, v24, v25
    v_cvt_pk_bf16_f32 v23, v26, v27
    buffer_store_dwordx4 v[20:23], v1, s[40:43], s72 offen offset:1024 sc1
    v_accvgpr_read_b32 v12, a148
    v_accvgpr_read_b32 v13, a149
    v_accvgpr_read_b32 v14, a150
    v_accvgpr_read_b32 v15, a151
    v_accvgpr_read_b32 v16, a164
    v_accvgpr_read_b32 v17, a165
    v_accvgpr_read_b32 v18, a166
    v_accvgpr_read_b32 v19, a167
    v_pk_mul_f32 v[12:13], v[12:13], v[10:11] op_sel_hi:[1,0]
    v_pk_mul_f32 v[14:15], v[14:15], v[10:11] op_sel_hi:[1,0]
    v_pk_mul_f32 v[16:17], v[16:17], v[10:11] op_sel_hi:[1,0]
    v_pk_mul_f32 v[18:19], v[18:19], v[10:11] op_sel_hi:[1,0]
    v_cvt_pk_bf16_f32 v12, v12, v13
    v_cvt_pk_bf16_f32 v13, v14, v15
    v_cvt_pk_bf16_f32 v14, v16, v17
    v_cvt_pk_bf16_f32 v15, v18, v19
    buffer_store_dwordx4 v[12:15], v1, s[40:43], s72 offen offset:2048 sc1
    v_accvgpr_read_b32 v20, a180
    v_accvgpr_read_b32 v21, a181
    v_accvgpr_read_b32 v22, a182
    v_accvgpr_read_b32 v23, a183
    v_accvgpr_read_b32 v24, a196
    v_accvgpr_read_b32 v25, a197
    v_accvgpr_read_b32 v26, a198
    v_accvgpr_read_b32 v27, a199
    v_pk_mul_f32 v[20:21], v[20:21], v[10:11] op_sel_hi:[1,0]
    v_pk_mul_f32 v[22:23], v[22:23], v[10:11] op_sel_hi:[1,0]
    v_pk_mul_f32 v[24:25], v[24:25], v[10:11] op_sel_hi:[1,0]
    v_pk_mul_f32 v[26:27], v[26:27], v[10:11] op_sel_hi:[1,0]
    v_cvt_pk_bf16_f32 v20, v20, v21
    v_cvt_pk_bf16_f32 v21, v22, v23
    v_cvt_pk_bf16_f32 v22, v24, v25
    v_cvt_pk_bf16_f32 v23, v26, v27
    buffer_store_dwordx4 v[20:23], v1, s[40:43], s72 offen offset:3072 sc1
    v_mov_b32 v9, 1
    v_lshlrev_b32 v8, 20, v1
    s_lshl2_add_u32 s7, s75, s101
    s_add_u32 s7, s7, 32768
    s_waitcnt vmcnt(8)
    buffer_store_dword v9, v8, s[32:35], s7 offen sc1
    s_sub_u32 s78, 14, s6
    s_sub_u32 s78, s78, s6
    s_cmp_eq_u32 s78, 0
    s_cbranch_scc1 K1_LS_END
.p2align 3
K1_LS:
    s_waitcnt lgkmcnt(0)
    v_mfma_f32_16x16x32_bf16 v[240:243], a[224:227], v[136:139], v[176:179]
    s_add_u32 m0, s76, s75
    v_exp_f32 v254, v254
    v_mfma_f32_16x16x32_bf16 v[240:243], a[228:231], v[168:171], v[240:243]
    s_mov_b32 s76, s60
    v_exp_f32 v255, v255
    v_mfma_f32_16x16x32_bf16 v[240:243], a[232:235], v[200:203], v[240:243]
    s_mov_b32 s60, s82
    buffer_load_dwordx4 v1, s[36:39], s77 offen sc1 lds
    v_mfma_f32_16x16x32_bf16 v[240:243], a[236:239], v[232:235], v[240:243]
    s_add_u32 s82, s82, 32768
    ds_read_b128 v[104:107], v2 offset:18432
    v_cvt_pk_bf16_f32 v63, v254, v255
    v_mfma_f32_16x16x32_bf16 a[8:11], v[96:99], v[48:51], a[8:11]
    ds_read_b128 v[108:111], v2 offset:19456
    ds_read_b128 a[240:243], v2 offset:4096
    v_mfma_f32_16x16x32_bf16 a[8:11], v[100:103], v[52:55], a[8:11]
    ds_read_b128 a[244:247], v2 offset:5120
    v_mfma_f32_16x16x32_bf16 a[12:15], v[96:99], v[56:59], a[12:15]
    buffer_load_dwordx4 v1, s[36:39], s77 offen offset:1024 sc1 lds
    v_mfma_f32_16x16x32_bf16 a[12:15], v[100:103], v[60:63], a[12:15]
    ds_read_b128 a[248:251], v2 offset:6144
    ds_read_b128 a[252:255], v2 offset:7168
    v_mfma_f32_16x16x32_bf16 v[244:247], a[224:227], v[140:143], v[156:159]
    v_exp_f32 v240, v240
    v_mfma_f32_16x16x32_bf16 v[244:247], a[228:231], v[172:175], v[244:247]
    ds_read_b128 v[112:115], v2 offset:20480
    ds_read_b128 v[116:119], v2 offset:21504
    v_mfma_f32_16x16x32_bf16 v[244:247], a[232:235], v[204:207], v[244:247]
    v_exp_f32 v241, v241
    v_mfma_f32_16x16x32_bf16 v[244:247], a[236:239], v[236:239], v[244:247]
    s_waitcnt lgkmcnt(4)
    ds_read_b128 v[120:123], v2 offset:22528
    ds_read_b128 v[124:127], v2 offset:23552
    v_mfma_f32_16x16x32_bf16 a[24:27], v[104:107], v[48:51], a[24:27]
    buffer_load_dwordx4 v1, s[36:39], s77 offen offset:2048 sc1 lds
    v_mfma_f32_16x16x32_bf16 a[24:27], v[108:111], v[52:55], a[24:27]
    ds_read_b128 a[224:227], v2 offset:8192
    ds_read_b128 a[228:231], v2 offset:9216
    v_mfma_f32_16x16x32_bf16 a[28:31], v[104:107], v[56:59], a[28:31]
    ds_read_b128 a[232:235], v2 offset:10240
    v_cvt_pk_bf16_f32 v80, v240, v241
    v_mfma_f32_16x16x32_bf16 a[28:31], v[108:111], v[60:63], a[28:31]
    v_exp_f32 v242, v242
    v_mfma_f32_16x16x32_bf16 v[248:251], a[240:243], v[136:139], v[180:183]
    ds_read_b128 a[236:239], v2 offset:11264
    ds_read_b128 v[96:99], v2 offset:24576
    v_mfma_f32_16x16x32_bf16 v[248:251], a[244:247], v[168:171], v[248:251]
    s_waitcnt lgkmcnt(5)
    v_exp_f32 v243, v243
    v_mfma_f32_16x16x32_bf16 v[248:251], a[248:251], v[200:203], v[248:251]
    buffer_load_dwordx4 v1, s[36:39], s77 offen offset:3072 sc1 lds
    v_mfma_f32_16x16x32_bf16 v[248:251], a[252:255], v[232:235], v[248:251]
    ds_read_b128 v[100:103], v2 offset:25600
    v_cvt_pk_bf16_f32 v81, v242, v243
    v_mfma_f32_16x16x32_bf16 a[40:43], v[112:115], v[48:51], a[40:43]
    ds_read_b128 v[104:107], v2 offset:26624
    ds_read_b128 v[108:111], v2 offset:27648
    v_mfma_f32_16x16x32_bf16 a[40:43], v[116:119], v[52:55], a[40:43]
    v_exp_f32 v244, v244
    v_mfma_f32_16x16x32_bf16 a[44:47], v[112:115], v[56:59], a[44:47]
    v_exp_f32 v245, v245
    v_mfma_f32_16x16x32_bf16 a[44:47], v[116:119], v[60:63], a[44:47]
    s_add_u32 s100, s77, 4096
    v_exp_f32 v246, v246
    v_mfma_f32_16x16x32_bf16 v[252:255], a[240:243], v[140:143], v[156:159]
    s_add_u32 m0, m0, 4096
    v_exp_f32 v247, v247
    v_mfma_f32_16x16x32_bf16 v[252:255], a[244:247], v[172:175], v[252:255]
    buffer_load_dwordx4 v1, s[36:39], s100 offen sc1 lds
    v_mfma_f32_16x16x32_bf16 v[252:255], a[248:251], v[204:207], v[252:255]
    v_cvt_pk_bf16_f32 v88, v244, v245
    v_cvt_pk_bf16_f32 v89, v246, v247
    v_mfma_f32_16x16x32_bf16 v[252:255], a[252:255], v[236:239], v[252:255]
    ds_read_b128 a[240:243], v2 offset:12288
    ds_read_b128 a[244:247], v2 offset:13312
    v_mfma_f32_16x16x32_bf16 a[56:59], v[120:123], v[48:51], a[56:59]
    v_exp_f32 v248, v248
    v_mfma_f32_16x16x32_bf16 a[56:59], v[124:127], v[52:55], a[56:59]
    buffer_load_dwordx4 v1, s[36:39], s100 offen offset:1024 sc1 lds
    v_mfma_f32_16x16x32_bf16 a[60:63], v[120:123], v[56:59], a[60:63]
    ds_read_b128 a[248:251], v2 offset:14336
    ds_read_b128 a[252:255], v2 offset:15360
    v_mfma_f32_16x16x32_bf16 a[60:63], v[124:127], v[60:63], a[60:63]
    s_waitcnt lgkmcnt(4)
    v_exp_f32 v249, v249
    v_mfma_f32_16x16x32_bf16 v[240:243], a[224:227], v[136:139], v[184:187]
    ds_read_b128 v[112:115], v2 offset:28672
    ds_read_b128 v[116:119], v2 offset:29696
    v_mfma_f32_16x16x32_bf16 v[240:243], a[228:231], v[168:171], v[240:243]
    v_exp_f32 v250, v250
    v_mfma_f32_16x16x32_bf16 v[240:243], a[232:235], v[200:203], v[240:243]
    v_exp_f32 v251, v251
    v_mfma_f32_16x16x32_bf16 v[240:243], a[236:239], v[232:235], v[240:243]
    buffer_load_dwordx4 v1, s[36:39], s100 offen offset:2048 sc1 lds
    v_mfma_f32_16x16x32_bf16 a[152:155], v[96:99], v[48:51], a[152:155]
    v_cvt_pk_bf16_f32 v82, v248, v249
    v_cvt_pk_bf16_f32 v83, v250, v251
    v_mfma_f32_16x16x32_bf16 a[152:155], v[100:103], v[52:55], a[152:155]
    ds_read_b128 v[120:123], v2 offset:30720
    ds_read_b128 v[124:127], v2 offset:31744
    v_mfma_f32_16x16x32_bf16 a[156:159], v[96:99], v[56:59], a[156:159]
    v_exp_f32 v252, v252
    v_mfma_f32_16x16x32_bf16 a[156:159], v[100:103], v[60:63], a[156:159]
    v_exp_f32 v253, v253
    v_mfma_f32_16x16x32_bf16 v[244:247], a[224:227], v[140:143], v[156:159]
    v_exp_f32 v254, v254
    v_mfma_f32_16x16x32_bf16 v[244:247], a[228:231], v[172:175], v[244:247]
    buffer_load_dwordx4 v1, s[36:39], s100 offen offset:3072 sc1 lds
    v_mfma_f32_16x16x32_bf16 v[244:247], a[232:235], v[204:207], v[244:247]
    v_exp_f32 v255, v255
    v_mfma_f32_16x16x32_bf16 v[244:247], a[236:239], v[236:239], v[244:247]
    s_cmp_eq_u32 s82, 163840
    s_cselect_b32 s82, 0, s82
    v_cvt_pk_bf16_f32 v90, v252, v253
    v_mfma_f32_16x16x32_bf16 a[168:171], v[104:107], v[48:51], a[168:171]
    v_cvt_pk_bf16_f32 v91, v254, v255
    v_add_u32 v2, s82, v1
    v_mfma_f32_16x16x32_bf16 a[168:171], v[108:111], v[52:55], a[168:171]
    ds_read_b128 a[224:227], v2 offset:0
    ds_read_b128 a[228:231], v2 offset:1024
    v_mfma_f32_16x16x32_bf16 a[172:175], v[104:107], v[56:59], a[172:175]
    s_add_u32 s77, s77, 32768
    v_exp_f32 v240, v240
    v_mfma_f32_16x16x32_bf16 a[172:175], v[108:111], v[60:63], a[172:175]
    s_waitcnt lgkmcnt(2)
    ds_read_b128 a[232:235], v2 offset:2048
    ds_read_b128 a[236:239], v2 offset:3072
    v_mfma_f32_16x16x32_bf16 v[248:251], a[240:243], v[136:139], v[188:191]
    v_exp_f32 v241, v241
    v_mfma_f32_16x16x32_bf16 v[248:251], a[244:247], v[168:171], v[248:251]
    ds_read_b128 v[96:99], v2 offset:16384
    ds_read_b128 v[100:103], v2 offset:17408
    v_mfma_f32_16x16x32_bf16 v[248:251], a[248:251], v[200:203], v[248:251]
    v_exp_f32 v242, v242
    v_mfma_f32_16x16x32_bf16 v[248:251], a[252:255], v[232:235], v[248:251]
    v_exp_f32 v243, v243
    v_mfma_f32_16x16x32_bf16 a[184:187], v[112:115], v[48:51], a[184:187]
    v_exp_f32 v244, v244
    v_mfma_f32_16x16x32_bf16 a[184:187], v[116:119], v[52:55], a[184:187]
    v_exp_f32 v245, v245
    v_mfma_f32_16x16x32_bf16 a[188:191], v[112:115], v[56:59], a[188:191]
    v_exp_f32 v246, v246
    v_mfma_f32_16x16x32_bf16 a[188:191], v[116:119], v[60:63], a[188:191]
    v_exp_f32 v247, v247
    v_mfma_f32_16x16x32_bf16 v[252:255], a[240:243], v[140:143], v[156:159]
    v_exp_f32 v248, v248
    v_mfma_f32_16x16x32_bf16 v[252:255], a[244:247], v[172:175], v[252:255]
    v_exp_f32 v249, v249
    v_mfma_f32_16x16x32_bf16 v[252:255], a[248:251], v[204:207], v[252:255]
    v_exp_f32 v250, v250
    v_mfma_f32_16x16x32_bf16 v[252:255], a[252:255], v[236:239], v[252:255]
    v_exp_f32 v251, v251
    v_mfma_f32_16x16x32_bf16 a[200:203], v[120:123], v[48:51], a[200:203]
    v_cvt_pk_bf16_f32 v84, v240, v241
    v_cvt_pk_bf16_f32 v85, v242, v243
    v_mfma_f32_16x16x32_bf16 a[200:203], v[124:127], v[52:55], a[200:203]
    v_cvt_pk_bf16_f32 v92, v244, v245
    v_cvt_pk_bf16_f32 v93, v246, v247
    v_mfma_f32_16x16x32_bf16 a[204:207], v[120:123], v[56:59], a[204:207]
    v_exp_f32 v252, v252
    v_mfma_f32_16x16x32_bf16 a[204:207], v[124:127], v[60:63], a[204:207]
    v_exp_f32 v253, v253
    v_mfma_f32_16x16x32_bf16 a[216:219], a[136:139], v[48:51], a[216:219]
    v_cvt_pk_bf16_f32 v86, v248, v249
    v_cvt_pk_bf16_f32 v87, v250, v251
    v_mfma_f32_16x16x32_bf16 a[216:219], a[136:139], v[52:55], a[216:219]
    v_cvt_pk_bf16_f32 v94, v252, v253
    v_mfma_f32_16x16x32_bf16 a[220:223], a[136:139], v[56:59], a[220:223]
    v_mfma_f32_16x16x32_bf16 a[220:223], a[136:139], v[60:63], a[220:223]
    s_cmp_eq_u32 s78, 1
    s_cbranch_scc1 K1_LS_MASK
K1_LS_BACK:
    s_waitcnt lgkmcnt(0)
    v_mfma_f32_16x16x32_bf16 v[240:243], a[224:227], v[136:139], v[176:179]
    s_add_u32 m0, s76, s75
    v_exp_f32 v254, v254
    v_mfma_f32_16x16x32_bf16 v[240:243], a[228:231], v[168:171], v[240:243]
    s_mov_b32 s76, s60
    v_exp_f32 v255, v255
    v_mfma_f32_16x16x32_bf16 v[240:243], a[232:235], v[200:203], v[240:243]
    s_mov_b32 s60, s82
    buffer_load_dwordx4 v1, s[36:39], s77 offen sc1 lds
    v_mfma_f32_16x16x32_bf16 v[240:243], a[236:239], v[232:235], v[240:243]
    s_add_u32 s82, s82, 32768
    ds_read_b128 v[104:107], v2 offset:18432
    v_cvt_pk_bf16_f32 v95, v254, v255
    v_mfma_f32_16x16x32_bf16 a[8:11], v[96:99], v[80:83], a[8:11]
    ds_read_b128 v[108:111], v2 offset:19456
    ds_read_b128 a[240:243], v2 offset:4096
    v_mfma_f32_16x16x32_bf16 a[8:11], v[100:103], v[84:87], a[8:11]
    ds_read_b128 a[244:247], v2 offset:5120
    v_mfma_f32_16x16x32_bf16 a[12:15], v[96:99], v[88:91], a[12:15]
    buffer_load_dwordx4 v1, s[36:39], s77 offen offset:1024 sc1 lds
    v_mfma_f32_16x16x32_bf16 a[12:15], v[100:103], v[92:95], a[12:15]
    ds_read_b128 a[248:251], v2 offset:6144
    ds_read_b128 a[252:255], v2 offset:7168
    v_mfma_f32_16x16x32_bf16 v[244:247], a[224:227], v[140:143], v[156:159]
    v_exp_f32 v240, v240
    v_mfma_f32_16x16x32_bf16 v[244:247], a[228:231], v[172:175], v[244:247]
    ds_read_b128 v[112:115], v2 offset:20480
    ds_read_b128 v[116:119], v2 offset:21504
    v_mfma_f32_16x16x32_bf16 v[244:247], a[232:235], v[204:207], v[244:247]
    v_exp_f32 v241, v241
    v_mfma_f32_16x16x32_bf16 v[244:247], a[236:239], v[236:239], v[244:247]
    s_waitcnt lgkmcnt(4)
    ds_read_b128 v[120:123], v2 offset:22528
    ds_read_b128 v[124:127], v2 offset:23552
    v_mfma_f32_16x16x32_bf16 a[24:27], v[104:107], v[80:83], a[24:27]
    buffer_load_dwordx4 v1, s[36:39], s77 offen offset:2048 sc1 lds
    v_mfma_f32_16x16x32_bf16 a[24:27], v[108:111], v[84:87], a[24:27]
    ds_read_b128 a[224:227], v2 offset:8192
    ds_read_b128 a[228:231], v2 offset:9216
    v_mfma_f32_16x16x32_bf16 a[28:31], v[104:107], v[88:91], a[28:31]
    ds_read_b128 a[232:235], v2 offset:10240
    v_cvt_pk_bf16_f32 v48, v240, v241
    v_mfma_f32_16x16x32_bf16 a[28:31], v[108:111], v[92:95], a[28:31]
    v_exp_f32 v242, v242
    v_mfma_f32_16x16x32_bf16 v[248:251], a[240:243], v[136:139], v[180:183]
    ds_read_b128 a[236:239], v2 offset:11264
    ds_read_b128 v[96:99], v2 offset:24576
    v_mfma_f32_16x16x32_bf16 v[248:251], a[244:247], v[168:171], v[248:251]
    s_waitcnt lgkmcnt(5)
    v_exp_f32 v243, v243
    v_mfma_f32_16x16x32_bf16 v[248:251], a[248:251], v[200:203], v[248:251]
    buffer_load_dwordx4 v1, s[36:39], s77 offen offset:3072 sc1 lds
    v_mfma_f32_16x16x32_bf16 v[248:251], a[252:255], v[232:235], v[248:251]
    ds_read_b128 v[100:103], v2 offset:25600
    v_cvt_pk_bf16_f32 v49, v242, v243
    v_mfma_f32_16x16x32_bf16 a[40:43], v[112:115], v[80:83], a[40:43]
    ds_read_b128 v[104:107], v2 offset:26624
    ds_read_b128 v[108:111], v2 offset:27648
    v_mfma_f32_16x16x32_bf16 a[40:43], v[116:119], v[84:87], a[40:43]
    v_exp_f32 v244, v244
    v_mfma_f32_16x16x32_bf16 a[44:47], v[112:115], v[88:91], a[44:47]
    v_exp_f32 v245, v245
    v_mfma_f32_16x16x32_bf16 a[44:47], v[116:119], v[92:95], a[44:47]
    s_add_u32 s100, s77, 4096
    v_exp_f32 v246, v246
    v_mfma_f32_16x16x32_bf16 v[252:255], a[240:243], v[140:143], v[156:159]
    s_add_u32 m0, m0, 4096
    v_exp_f32 v247, v247
    v_mfma_f32_16x16x32_bf16 v[252:255], a[244:247], v[172:175], v[252:255]
    buffer_load_dwordx4 v1, s[36:39], s100 offen sc1 lds
    v_mfma_f32_16x16x32_bf16 v[252:255], a[248:251], v[204:207], v[252:255]
    v_cvt_pk_bf16_f32 v56, v244, v245
    v_cvt_pk_bf16_f32 v57, v246, v247
    v_mfma_f32_16x16x32_bf16 v[252:255], a[252:255], v[236:239], v[252:255]
    ds_read_b128 a[240:243], v2 offset:12288
    ds_read_b128 a[244:247], v2 offset:13312
    v_mfma_f32_16x16x32_bf16 a[56:59], v[120:123], v[80:83], a[56:59]
    v_exp_f32 v248, v248
    v_mfma_f32_16x16x32_bf16 a[56:59], v[124:127], v[84:87], a[56:59]
    buffer_load_dwordx4 v1, s[36:39], s100 offen offset:1024 sc1 lds
    v_mfma_f32_16x16x32_bf16 a[60:63], v[120:123], v[88:91], a[60:63]
    ds_read_b128 a[248:251], v2 offset:14336
    ds_read_b128 a[252:255], v2 offset:15360
    v_mfma_f32_16x16x32_bf16 a[60:63], v[124:127], v[92:95], a[60:63]
    s_waitcnt lgkmcnt(4)
    v_exp_f32 v249, v249
    v_mfma_f32_16x16x32_bf16 v[240:243], a[224:227], v[136:139], v[184:187]
    ds_read_b128 v[112:115], v2 offset:28672
    ds_read_b128 v[116:119], v2 offset:29696
    v_mfma_f32_16x16x32_bf16 v[240:243], a[228:231], v[168:171], v[240:243]
    v_exp_f32 v250, v250
    v_mfma_f32_16x16x32_bf16 v[240:243], a[232:235], v[200:203], v[240:243]
    v_exp_f32 v251, v251
    v_mfma_f32_16x16x32_bf16 v[240:243], a[236:239], v[232:235], v[240:243]
    buffer_load_dwordx4 v1, s[36:39], s100 offen offset:2048 sc1 lds
    v_mfma_f32_16x16x32_bf16 a[152:155], v[96:99], v[80:83], a[152:155]
    v_cvt_pk_bf16_f32 v50, v248, v249
    v_cvt_pk_bf16_f32 v51, v250, v251
    v_mfma_f32_16x16x32_bf16 a[152:155], v[100:103], v[84:87], a[152:155]
    ds_read_b128 v[120:123], v2 offset:30720
    ds_read_b128 v[124:127], v2 offset:31744
    v_mfma_f32_16x16x32_bf16 a[156:159], v[96:99], v[88:91], a[156:159]
    v_exp_f32 v252, v252
    v_mfma_f32_16x16x32_bf16 a[156:159], v[100:103], v[92:95], a[156:159]
    v_exp_f32 v253, v253
    v_mfma_f32_16x16x32_bf16 v[244:247], a[224:227], v[140:143], v[156:159]
    v_exp_f32 v254, v254
    v_mfma_f32_16x16x32_bf16 v[244:247], a[228:231], v[172:175], v[244:247]
    buffer_load_dwordx4 v1, s[36:39], s100 offen offset:3072 sc1 lds
    v_mfma_f32_16x16x32_bf16 v[244:247], a[232:235], v[204:207], v[244:247]
    v_exp_f32 v255, v255
    v_mfma_f32_16x16x32_bf16 v[244:247], a[236:239], v[236:239], v[244:247]
    s_cmp_eq_u32 s82, 163840
    s_cselect_b32 s82, 0, s82
    v_cvt_pk_bf16_f32 v58, v252, v253
    v_mfma_f32_16x16x32_bf16 a[168:171], v[104:107], v[80:83], a[168:171]
    v_cvt_pk_bf16_f32 v59, v254, v255
    v_add_u32 v2, s82, v1
    v_mfma_f32_16x16x32_bf16 a[168:171], v[108:111], v[84:87], a[168:171]
    v_exp_f32 v240, v240
    v_mfma_f32_16x16x32_bf16 a[172:175], v[104:107], v[88:91], a[172:175]
    s_add_u32 s77, s77, 32768
    v_exp_f32 v241, v241
    v_mfma_f32_16x16x32_bf16 a[172:175], v[108:111], v[92:95], a[172:175]
    s_waitcnt lgkmcnt(0)
    v_exp_f32 v242, v242
    v_mfma_f32_16x16x32_bf16 v[248:251], a[240:243], v[136:139], v[188:191]
    v_exp_f32 v243, v243
    v_mfma_f32_16x16x32_bf16 v[248:251], a[244:247], v[168:171], v[248:251]
    v_exp_f32 v244, v244
    v_mfma_f32_16x16x32_bf16 v[248:251], a[248:251], v[200:203], v[248:251]
    v_exp_f32 v245, v245
    v_mfma_f32_16x16x32_bf16 v[248:251], a[252:255], v[232:235], v[248:251]
    v_exp_f32 v246, v246
    v_mfma_f32_16x16x32_bf16 a[184:187], v[112:115], v[80:83], a[184:187]
    v_exp_f32 v247, v247
    v_mfma_f32_16x16x32_bf16 a[184:187], v[116:119], v[84:87], a[184:187]
    v_cvt_pk_bf16_f32 v52, v240, v241
    v_cvt_pk_bf16_f32 v53, v242, v243
    v_mfma_f32_16x16x32_bf16 a[188:191], v[112:115], v[88:91], a[188:191]
    v_cvt_pk_bf16_f32 v60, v244, v245
    v_cvt_pk_bf16_f32 v61, v246, v247
    v_mfma_f32_16x16x32_bf16 a[188:191], v[116:119], v[92:95], a[188:191]
    s_waitcnt vmcnt(8) lgkmcnt(0)
    s_barrier
    ds_read_b128 a[224:227], v2 offset:0
    v_mfma_f32_16x16x32_bf16 v[252:255], a[240:243], v[140:143], v[156:159]
    ds_read_b128 a[228:231], v2 offset:1024
    ds_read_b128 a[232:235], v2 offset:2048
    v_mfma_f32_16x16x32_bf16 v[252:255], a[244:247], v[172:175], v[252:255]
    v_exp_f32 v248, v248
    v_mfma_f32_16x16x32_bf16 v[252:255], a[248:251], v[204:207], v[252:255]
    ds_read_b128 a[236:239], v2 offset:3072
    ds_read_b128 v[96:99], v2 offset:16384
    v_mfma_f32_16x16x32_bf16 v[252:255], a[252:255], v[236:239], v[252:255]
    v_exp_f32 v249, v249
    v_mfma_f32_16x16x32_bf16 a[200:203], v[120:123], v[80:83], a[200:203]
    ds_read_b128 v[100:103], v2 offset:17408
    v_cvt_pk_bf16_f32 v54, v248, v249
    v_mfma_f32_16x16x32_bf16 a[200:203], v[124:127], v[84:87], a[200:203]
    v_exp_f32 v250, v250
    v_mfma_f32_16x16x32_bf16 a[204:207], v[120:123], v[88:91], a[204:207]
    v_exp_f32 v251, v251
    v_mfma_f32_16x16x32_bf16 a[204:207], v[124:127], v[92:95], a[204:207]
    v_exp_f32 v252, v252
    v_mfma_f32_16x16x32_bf16 a[216:219], a[136:139], v[80:83], a[216:219]
    v_exp_f32 v253, v253
    v_mfma_f32_16x16x32_bf16 a[216:219], a[136:139], v[84:87], a[216:219]
    v_cvt_pk_bf16_f32 v55, v250, v251
    v_cvt_pk_bf16_f32 v62, v252, v253
    v_mfma_f32_16x16x32_bf16 a[220:223], a[136:139], v[88:91], a[220:223]
    v_mfma_f32_16x16x32_bf16 a[220:223], a[136:139], v[92:95], a[220:223]
    s_sub_u32 s78, s78, 1
    s_cmp_lg_u32 s78, 0
    s_cbranch_scc1 K1_LS
K1_LS_END:
    v_add_f32 v212, s12, v156
    v_fma_f32 v176, v208, s8, v212
    v_fma_f32 v177, v209, s8, v212
    v_fma_f32 v178, v210, s8, v212
    v_fma_f32 v179, v211, s8, v212
    s_nop 1
    s_waitcnt lgkmcnt(0)
    v_mfma_f32_16x16x32_bf16 v[240:243], a[224:227], v[140:143], v[176:179]
    s_mul_i32 s86, s4, 34
    ds_read_b128 v[104:107], v2 offset:18432
    ds_read_b128 v[108:111], v2 offset:19456
    v_mfma_f32_16x16x32_bf16 v[240:243], a[228:231], v[172:175], v[240:243]
    s_add_u32 s86, s86, 8
    v_exp_f32 v254, v254
    v_mfma_f32_16x16x32_bf16 v[240:243], a[232:235], v[204:207], v[240:243]
    s_mov_b32 s76, s60
    v_exp_f32 v255, v255
    v_mfma_f32_16x16x32_bf16 v[240:243], a[236:239], v[236:239], v[240:243]
    s_mov_b32 s60, s82
    ds_read_b128 a[240:243], v2 offset:4096
    v_cvt_pk_bf16_f32 v63, v254, v255
    v_mfma_f32_16x16x32_bf16 a[8:11], v[96:99], v[48:51], a[8:11]
    s_add_u32 s82, s82, 32768
    ds_read_b128 a[244:247], v2 offset:5120
    ds_read_b128 a[248:251], v2 offset:6144
    v_mfma_f32_16x16x32_bf16 a[8:11], v[100:103], v[52:55], a[8:11]
    s_lshr_b32 s61, s5, 3
    v_lshrrev_b32 v28, 4, v1
    ds_read_b128 a[252:255], v2 offset:7168
    v_mfma_f32_16x16x32_bf16 a[12:15], v[96:99], v[56:59], a[12:15]
    s_add_u32 s99, s61, 0
    v_min_u32 v28, 33, v28
    ds_read_b128 v[112:115], v2 offset:20480
    v_mfma_f32_16x16x32_bf16 a[12:15], v[100:103], v[60:63], a[12:15]
    s_and_b32 s98, s5, 3
    v_add_lshl_u32 v28, v28, s86, 7
    v_add_f32 v213, s13, v156
    s_waitcnt lgkmcnt(5)
    v_mfma_f32_16x16x32_bf16 a[24:27], v[104:107], v[48:51], a[24:27]
    s_and_b32 s99, s99, 3
    ds_read_b128 v[116:119], v2 offset:21504
    v_fma_f32 v180, v208, s9, v213
    v_mfma_f32_16x16x32_bf16 a[24:27], v[108:111], v[52:55], a[24:27]
    s_getpc_b64 s[86:87]
    global_load_dword v28, v28, s[86:87]
    v_mfma_f32_16x16x32_bf16 a[28:31], v[104:107], v[56:59], a[28:31]
    s_lshl2_add_u32 s99, s99, s98
    v_fma_f32 v181, v209, s9, v213
    v_fma_f32 v182, v210, s9, v213
    v_mfma_f32_16x16x32_bf16 a[28:31], v[108:111], v[60:63], a[28:31]
    s_lshl_b32 s16, s99, 11
    v_fma_f32 v183, v211, s9, v213
    ds_read_b128 v[120:123], v2 offset:22528
    s_nop 0
    s_waitcnt lgkmcnt(2)
    v_mfma_f32_16x16x32_bf16 v[244:247], a[240:243], v[140:143], v[180:183]
    s_add_u32 s99, s61, 1
    ds_read_b128 v[124:127], v2 offset:23552
    ds_read_b128 a[224:227], v2 offset:8192
    v_mfma_f32_16x16x32_bf16 v[244:247], a[244:247], v[172:175], v[244:247]
    s_and_b32 s99, s99, 3
    ds_read_b128 a[228:231], v2 offset:9216
    v_add_f32 v214, s14, v156
    v_mfma_f32_16x16x32_bf16 v[244:247], a[248:251], v[204:207], v[244:247]
    s_lshl2_add_u32 s99, s99, s98
    ds_read_b128 a[232:235], v2 offset:10240
    v_fma_f32 v184, v208, s10, v214
    v_mfma_f32_16x16x32_bf16 v[244:247], a[252:255], v[236:239], v[244:247]
    s_lshl_b32 s17, s99, 11
    ds_read_b128 a[236:239], v2 offset:11264
    v_fma_f32 v185, v209, s10, v214
    v_mfma_f32_16x16x32_bf16 a[40:43], v[112:115], v[48:51], a[40:43]
    s_add_u32 s99, s61, 2
    ds_read_b128 v[96:99], v2 offset:24576
    v_fma_f32 v186, v210, s10, v214
    s_waitcnt lgkmcnt(6)
    v_mfma_f32_16x16x32_bf16 a[40:43], v[116:119], v[52:55], a[40:43]
    s_and_b32 s99, s99, 3
    ds_read_b128 v[100:103], v2 offset:25600
    v_fma_f32 v187, v211, s10, v214
    v_mfma_f32_16x16x32_bf16 a[44:47], v[112:115], v[56:59], a[44:47]
    s_lshl2_add_u32 s99, s99, s98
    ds_read_b128 v[104:107], v2 offset:26624
    v_add_f32 v215, s15, v156
    v_mfma_f32_16x16x32_bf16 a[44:47], v[116:119], v[60:63], a[44:47]
    s_add_u32 s3, s5, s6
    ds_read_b128 v[108:111], v2 offset:27648
    v_fma_f32 v188, v208, s11, v215
    v_mfma_f32_16x16x32_bf16 a[56:59], v[120:123], v[48:51], a[56:59]
    s_lshl_b32 s18, s99, 11
    ds_read_b128 a[240:243], v2 offset:12288
    v_fma_f32 v189, v209, s11, v215
    s_waitcnt lgkmcnt(5)
    v_mfma_f32_16x16x32_bf16 a[56:59], v[124:127], v[52:55], a[56:59]
    s_add_u32 s99, s61, 3
    ds_read_b128 a[244:247], v2 offset:13312
    v_fma_f32 v190, v210, s11, v215
    v_mfma_f32_16x16x32_bf16 a[60:63], v[120:123], v[56:59], a[60:63]
    s_and_b32 s3, s3, 3
    ds_read_b128 a[248:251], v2 offset:14336
    v_fma_f32 v191, v211, s11, v215
    v_mfma_f32_16x16x32_bf16 a[60:63], v[124:127], v[60:63], a[60:63]
    s_and_b32 s99, s99, 3
    ds_read_b128 a[252:255], v2 offset:15360
    v_and_b32 v31, 0x70, v1
    v_mfma_f32_16x16x32_bf16 v[248:251], a[224:227], v[140:143], v[184:187]
    s_add_u32 s20, s98, 32
    ds_read_b128 v[112:115], v2 offset:28672
    v_lshrrev_b32 v29, 7, v1
    v_mfma_f32_16x16x32_bf16 v[248:251], a[228:231], v[172:175], v[248:251]
    s_lshl3_add_u32 s3, s61, s3
    ds_read_b128 v[116:119], v2 offset:29696
    v_lshlrev_b32 v31, 3, v31
    v_mfma_f32_16x16x32_bf16 v[248:251], a[232:235], v[204:207], v[248:251]
    s_lshl2_add_u32 s99, s99, s98
    ds_read_b128 v[120:123], v2 offset:30720
    v_lshl_add_u32 v29, v29, 12, v31
    v_mfma_f32_16x16x32_bf16 v[248:251], a[236:239], v[236:239], v[248:251]
    s_sub_u32 s62, 15, s6
    v_exp_f32 v240, v240
    s_waitcnt lgkmcnt(4)
    v_mfma_f32_16x16x32_bf16 a[152:155], v[96:99], v[48:51], a[152:155]
    s_lshl2_add_u32 s66, s6, s61
    v_exp_f32 v241, v241
    v_mfma_f32_16x16x32_bf16 a[152:155], v[100:103], v[52:55], a[152:155]
    s_mul_i32 s71, s5, 768
    ds_read_b128 v[124:127], v2 offset:31744
    v_cvt_pk_bf16_f32 v88, v240, v241
    v_mfma_f32_16x16x32_bf16 a[156:159], v[96:99], v[56:59], a[156:159]
    s_cmp_eq_u32 s82, 163840
    s_cselect_b32 s82, 0, s82
    v_add_u32 v2, s82, v1
    v_mfma_f32_16x16x32_bf16 a[156:159], v[100:103], v[60:63], a[156:159]
    s_lshl_b32 s20, s20, 10
    ds_read_b128 a[224:227], v2 offset:0
    ds_read_b128 a[228:231], v2 offset:1024
    v_mfma_f32_16x16x32_bf16 a[168:171], v[104:107], v[48:51], a[168:171]
    s_mul_i32 s78, s4, 7168
    v_exp_f32 v242, v242
    v_mfma_f32_16x16x32_bf16 a[168:171], v[108:111], v[52:55], a[168:171]
    s_lshl_b32 s19, s99, 11
    ds_read_b128 a[232:235], v2 offset:2048
    ds_read_b128 a[236:239], v2 offset:3072
    v_mfma_f32_16x16x32_bf16 a[172:175], v[104:107], v[56:59], a[172:175]
    s_lshl_b32 s63, s3, 12
    v_exp_f32 v243, v243
    v_mfma_f32_16x16x32_bf16 a[172:175], v[108:111], v[60:63], a[172:175]
    s_lshl_b32 s66, s66, 10
    ds_read_b128 v[96:99], v2 offset:16384
    ds_read_b128 v[100:103], v2 offset:17408
    v_mfma_f32_16x16x32_bf16 v[252:255], a[240:243], v[140:143], v[188:191]
    s_add_u32 s71, s71, 131072
    v_exp_f32 v244, v244
    v_mfma_f32_16x16x32_bf16 v[252:255], a[244:247], v[172:175], v[252:255]
    s_mov_b32 s50, 9437184
    v_exp_f32 v245, v245
    v_mfma_f32_16x16x32_bf16 v[252:255], a[248:251], v[204:207], v[252:255]
    s_waitcnt lgkmcnt(2)
    v_exp_f32 v246, v246
    v_mfma_f32_16x16x32_bf16 v[252:255], a[252:255], v[236:239], v[252:255]
    v_exp_f32 v247, v247
    v_mfma_f32_16x16x32_bf16 a[184:187], v[112:115], v[48:51], a[184:187]
    v_exp_f32 v248, v248
    v_mfma_f32_16x16x32_bf16 a[184:187], v[116:119], v[52:55], a[184:187]
    v_exp_f32 v249, v249
    v_mfma_f32_16x16x32_bf16 a[188:191], v[112:115], v[56:59], a[188:191]
    v_exp_f32 v250, v250
    v_mfma_f32_16x16x32_bf16 a[188:191], v[116:119], v[60:63], a[188:191]
    v_exp_f32 v251, v251
    v_mfma_f32_16x16x32_bf16 a[200:203], v[120:123], v[48:51], a[200:203]
    v_exp_f32 v252, v252
    v_mfma_f32_16x16x32_bf16 a[200:203], v[124:127], v[52:55], a[200:203]
    v_exp_f32 v253, v253
    v_mfma_f32_16x16x32_bf16 a[204:207], v[120:123], v[56:59], a[204:207]
    buffer_load_dword v3, v29, s[32:35], s92 offen sc1
    v_mfma_f32_16x16x32_bf16 a[204:207], v[124:127], v[60:63], a[204:207]
    v_cvt_pk_bf16_f32 v89, v242, v243
    v_cvt_pk_bf16_f32 v90, v244, v245
    v_mfma_f32_16x16x32_bf16 a[216:219], a[136:139], v[48:51], a[216:219]
    v_cvt_pk_bf16_f32 v91, v246, v247
    v_cvt_pk_bf16_f32 v92, v248, v249
    v_mfma_f32_16x16x32_bf16 a[216:219], a[136:139], v[52:55], a[216:219]
    v_cvt_pk_bf16_f32 v93, v250, v251
    v_cvt_pk_bf16_f32 v94, v252, v253
    v_mfma_f32_16x16x32_bf16 a[220:223], a[136:139], v[56:59], a[220:223]
    s_bitcmp1_b32 s5, 2
    s_cselect_b32 s62, s62, s6
    v_mfma_f32_16x16x32_bf16 a[220:223], a[136:139], v[60:63], a[220:223]
    s_add_u32 s48, s32, 1048576
    s_addc_u32 s49, s33, 0
    ds_read_b128 v[104:107], v2 offset:18432
    ds_read_b128 v[108:111], v2 offset:19456
    ds_read_b128 v[112:115], v2 offset:20480
    ds_read_b128 v[116:119], v2 offset:21504
    ds_read_b128 v[120:123], v2 offset:22528
    ds_read_b128 v[124:127], v2 offset:23552
    s_waitcnt lgkmcnt(6)
    v_mfma_f32_16x16x32_bf16 a[12:15], v[96:99], v[88:91], a[12:15]
    v_exp_f32 v254, v254
    v_exp_f32 v255, v255
    s_nop 0
    v_cvt_pk_bf16_f32 v95, v254, v255
    s_nop 1
    v_mfma_f32_16x16x32_bf16 a[12:15], v[100:103], v[92:95], a[12:15]
    s_waitcnt lgkmcnt(5)
    ds_read_b128 v[96:99], v2 offset:24576
    ds_read_b128 v[100:103], v2 offset:25600
    v_accvgpr_read_b32 v9, a216
    v_rcp_f32 v10, v9
    v_mfma_f32_16x16x32_bf16 a[28:31], v[104:107], v[88:91], a[28:31]
    s_waitcnt lgkmcnt(6)
    ds_read_b128 v[104:107], v2 offset:26624
    v_mul_f32 v10, v10, v6
    v_accvgpr_read_b32 v12, a8
    v_accvgpr_read_b32 v13, a9
    v_accvgpr_read_b32 v14, a10
    v_mfma_f32_16x16x32_bf16 a[28:31], v[108:111], v[92:95], a[28:31]
    s_waitcnt lgkmcnt(6)
    ds_read_b128 v[108:111], v2 offset:27648
    v_accvgpr_read_b32 v15, a11
    v_accvgpr_read_b32 v16, a24
    v_accvgpr_read_b32 v17, a25
    v_accvgpr_read_b32 v18, a26
    v_mfma_f32_16x16x32_bf16 a[44:47], v[112:115], v[88:91], a[44:47]
    s_waitcnt lgkmcnt(4)
    ds_read_b128 v[112:115], v2 offset:28672
    v_accvgpr_read_b32 v19, a27
    v_accvgpr_read_b32 v20, a40
    v_accvgpr_read_b32 v21, a41
    v_accvgpr_read_b32 v22, a42
    v_mfma_f32_16x16x32_bf16 a[44:47], v[116:119], v[92:95], a[44:47]
    ds_read_b128 v[116:119], v2 offset:29696
    v_accvgpr_read_b32 v23, a43
    v_accvgpr_read_b32 v24, a56
    v_accvgpr_read_b32 v25, a57
    v_accvgpr_read_b32 v26, a58
    v_mfma_f32_16x16x32_bf16 a[60:63], v[120:123], v[88:91], a[60:63]
    ds_read_b128 v[120:123], v2 offset:30720
    v_accvgpr_read_b32 v27, a59
    v_mul_f32 v12, v10, v12
    v_mul_f32 v13, v10, v13
    v_mul_f32 v14, v10, v14
    v_mfma_f32_16x16x32_bf16 a[60:63], v[124:127], v[92:95], a[60:63]
    s_waitcnt lgkmcnt(4)
    ds_read_b128 v[124:127], v2 offset:31744
    v_mul_f32 v15, v10, v15
    v_mul_f32 v16, v10, v16
    v_mul_f32 v17, v10, v17
    v_mul_f32 v18, v10, v18
    v_mfma_f32_16x16x32_bf16 a[156:159], v[96:99], v[88:91], a[156:159]
    v_mul_f32 v19, v10, v19
    v_mul_f32 v20, v10, v20
    v_mul_f32 v21, v10, v21
    v_mul_f32 v22, v10, v22
    v_mul_f32 v23, v10, v23
    v_mfma_f32_16x16x32_bf16 a[156:159], v[100:103], v[92:95], a[156:159]
    v_mul_f32 v24, v10, v24
    v_mul_f32 v25, v10, v25
    v_mul_f32 v26, v10, v26
    v_mul_f32 v27, v10, v27
    v_cvt_pk_bf16_f32 v12, v12, v13
    v_mfma_f32_16x16x32_bf16 a[172:175], v[104:107], v[88:91], a[172:175]
    s_waitcnt lgkmcnt(2)
    v_cvt_pk_bf16_f32 v13, v14, v15
    v_cvt_pk_bf16_f32 v14, v16, v17
    v_cvt_pk_bf16_f32 v15, v18, v19
    v_cvt_pk_bf16_f32 v20, v20, v21
    v_cvt_pk_bf16_f32 v21, v22, v23
    v_mfma_f32_16x16x32_bf16 a[172:175], v[108:111], v[92:95], a[172:175]
    v_cvt_pk_bf16_f32 v22, v24, v25
    v_cvt_pk_bf16_f32 v23, v26, v27
    buffer_store_dwordx4 v[12:15], v1, s[40:43], s81 offen offset:0 sc1
    v_accvgpr_read_b32 v16, a168
    v_mfma_f32_16x16x32_bf16 a[188:191], v[112:115], v[88:91], a[188:191]
    buffer_store_dwordx4 v[20:23], v1, s[40:43], s81 offen offset:1024 sc1
    v_accvgpr_read_b32 v12, a152
    v_accvgpr_read_b32 v13, a153
    v_accvgpr_read_b32 v14, a154
    v_mfma_f32_16x16x32_bf16 a[188:191], v[116:119], v[92:95], a[188:191]
    s_waitcnt lgkmcnt(0)
    v_accvgpr_read_b32 v15, a155
    v_accvgpr_read_b32 v17, a169
    v_accvgpr_read_b32 v18, a170
    v_accvgpr_read_b32 v19, a171
    v_accvgpr_read_b32 v20, a184
    v_mfma_f32_16x16x32_bf16 a[204:207], v[120:123], v[88:91], a[204:207]
    v_accvgpr_read_b32 v21, a185
    v_accvgpr_read_b32 v22, a186
    v_accvgpr_read_b32 v23, a187
    v_accvgpr_read_b32 v24, a200
    v_accvgpr_read_b32 v25, a201
    v_mfma_f32_16x16x32_bf16 a[204:207], v[124:127], v[92:95], a[204:207]
    v_accvgpr_read_b32 v26, a202
    v_accvgpr_read_b32 v27, a203
    v_mul_f32 v12, v10, v12
    v_mul_f32 v13, v10, v13
    v_mul_f32 v14, v10, v14
    v_mfma_f32_16x16x32_bf16 a[220:223], a[136:139], v[88:91], a[220:223]
    v_mul_f32 v15, v10, v15
    v_mul_f32 v16, v10, v16
    v_mul_f32 v17, v10, v17
    v_mul_f32 v18, v10, v18
    v_mul_f32 v19, v10, v19
    v_mfma_f32_16x16x32_bf16 a[220:223], a[136:139], v[92:95], a[220:223]
    v_mul_f32 v20, v10, v20
    v_mul_f32 v21, v10, v21
    v_mul_f32 v22, v10, v22
    v_mul_f32 v23, v10, v23
    v_mul_f32 v24, v10, v24
    v_mul_f32 v25, v10, v25
    v_mul_f32 v26, v10, v26
    v_mul_f32 v27, v10, v27
    v_cmp_nge_f32 vcc, 0x71800000, v9
    v_cvt_pk_bf16_f32 v12, v12, v13
    v_cvt_pk_bf16_f32 v13, v14, v15
    v_cvt_pk_bf16_f32 v14, v16, v17
    v_cvt_pk_bf16_f32 v15, v18, v19
    v_cvt_pk_bf16_f32 v20, v20, v21
    v_cvt_pk_bf16_f32 v21, v22, v23
    v_cvt_pk_bf16_f32 v22, v24, v25
    v_cvt_pk_bf16_f32 v23, v26, v27
    s_or_b64 s[84:85], s[84:85], vcc
    buffer_store_dwordx4 v[12:15], v1, s[40:43], s81 offen offset:2048 sc1
    buffer_store_dwordx4 v[20:23], v1, s[40:43], s81 offen offset:3072 sc1
    s_nop 3
    v_accvgpr_read_b32 v9, a220
    v_cmp_nge_f32 vcc, 0x71800000, v9
    v_rcp_f32 v10, v9
    s_nop 0
    s_or_b64 s[84:85], s[84:85], vcc
    v_mul_f32 v10, v10, v7
    s_add_u32 s72, s81, 622592
    v_accvgpr_read_b32 v12, a12
    v_accvgpr_read_b32 v13, a13
    v_accvgpr_read_b32 v14, a14
    v_accvgpr_read_b32 v15, a15
    v_accvgpr_read_b32 v16, a28
    v_accvgpr_read_b32 v17, a29
    v_accvgpr_read_b32 v18, a30
    v_accvgpr_read_b32 v19, a31
    v_pk_mul_f32 v[12:13], v[12:13], v[10:11] op_sel_hi:[1,0]
    v_pk_mul_f32 v[14:15], v[14:15], v[10:11] op_sel_hi:[1,0]
    v_pk_mul_f32 v[16:17], v[16:17], v[10:11] op_sel_hi:[1,0]
    v_pk_mul_f32 v[18:19], v[18:19], v[10:11] op_sel_hi:[1,0]
    v_cvt_pk_bf16_f32 v12, v12, v13
    v_cvt_pk_bf16_f32 v13, v14, v15
    v_cvt_pk_bf16_f32 v14, v16, v17
    v_cvt_pk_bf16_f32 v15, v18, v19
    buffer_store_dwordx4 v[12:15], v1, s[40:43], s72 offen offset:0 sc1
    v_accvgpr_read_b32 v20, a44
    v_accvgpr_read_b32 v21, a45
    v_accvgpr_read_b32 v22, a46
    v_accvgpr_read_b32 v23, a47
    v_accvgpr_read_b32 v24, a60
    v_accvgpr_read_b32 v25, a61
    v_accvgpr_read_b32 v26, a62
    v_accvgpr_read_b32 v27, a63
    v_pk_mul_f32 v[20:21], v[20:21], v[10:11] op_sel_hi:[1,0]
    v_pk_mul_f32 v[22:23], v[22:23], v[10:11] op_sel_hi:[1,0]
    v_pk_mul_f32 v[24:25], v[24:25], v[10:11] op_sel_hi:[1,0]
    v_pk_mul_f32 v[26:27], v[26:27], v[10:11] op_sel_hi:[1,0]
    v_cvt_pk_bf16_f32 v20, v20, v21
    v_cvt_pk_bf16_f32 v21, v22, v23
    v_cvt_pk_bf16_f32 v22, v24, v25
    v_cvt_pk_bf16_f32 v23, v26, v27
    buffer_store_dwordx4 v[20:23], v1, s[40:43], s72 offen offset:1024 sc1
    v_accvgpr_read_b32 v12, a156
    v_accvgpr_read_b32 v13, a157
    v_accvgpr_read_b32 v14, a158
    v_accvgpr_read_b32 v15, a159
    v_accvgpr_read_b32 v16, a172
    v_accvgpr_read_b32 v17, a173
    v_accvgpr_read_b32 v18, a174
    v_accvgpr_read_b32 v19, a175
    v_pk_mul_f32 v[12:13], v[12:13], v[10:11] op_sel_hi:[1,0]
    v_pk_mul_f32 v[14:15], v[14:15], v[10:11] op_sel_hi:[1,0]
    v_pk_mul_f32 v[16:17], v[16:17], v[10:11] op_sel_hi:[1,0]
    v_pk_mul_f32 v[18:19], v[18:19], v[10:11] op_sel_hi:[1,0]
    v_cvt_pk_bf16_f32 v12, v12, v13
    v_cvt_pk_bf16_f32 v13, v14, v15
    v_cvt_pk_bf16_f32 v14, v16, v17
    v_cvt_pk_bf16_f32 v15, v18, v19
    buffer_store_dwordx4 v[12:15], v1, s[40:43], s72 offen offset:2048 sc1
    v_accvgpr_read_b32 v20, a188
    v_accvgpr_read_b32 v21, a189
    v_accvgpr_read_b32 v22, a190
    v_accvgpr_read_b32 v23, a191
    v_accvgpr_read_b32 v24, a204
    v_accvgpr_read_b32 v25, a205
    v_accvgpr_read_b32 v26, a206
    v_accvgpr_read_b32 v27, a207
    v_pk_mul_f32 v[20:21], v[20:21], v[10:11] op_sel_hi:[1,0]
    v_pk_mul_f32 v[22:23], v[22:23], v[10:11] op_sel_hi:[1,0]
    v_pk_mul_f32 v[24:25], v[24:25], v[10:11] op_sel_hi:[1,0]
    v_pk_mul_f32 v[26:27], v[26:27], v[10:11] op_sel_hi:[1,0]
    v_cvt_pk_bf16_f32 v20, v20, v21
    v_cvt_pk_bf16_f32 v21, v22, v23
    v_cvt_pk_bf16_f32 v22, v24, v25
    v_cvt_pk_bf16_f32 v23, v26, v27
    buffer_store_dwordx4 v[20:23], v1, s[40:43], s72 offen offset:3072 sc1
    s_waitcnt vmcnt(8) lgkmcnt(0)
    v_cmp_gt_u32 vcc, 1, v3
    s_nop 1
    s_and_b64 vcc, vcc, exec
    s_cbranch_scc1 SPIN_ALL
BACK_ALL:
    s_barrier
    s_mov_b32 s79, 114688
    v_bfe_u32 v20, v1, 4, 4
    v_lshrrev_b32 v21, 8, v1
    s_lshl_b32 s98, s4, 4
    s_add_u32 s98, s98, 16
    v_add_u32 v22, s98, v20
    v_mul_u32_u24 v22, 144, v22
    v_add_u32 v22, s79, v22
    v_lshl_add_u32 v9, v21, 3, v22
    s_lshr_b32 s98, s73, 1
    v_add_u32 v8, s98, v9
    v_subrev_u32 v10, s98, v9
    s_and_b32 s99, s4, 1
    s_mul_i32 s99, s99, 20736
    s_add_u32 s99, s99, s79
    v_mul_u32_u24 v23, 144, v20
    v_lshl_add_u32 v23, v21, 3, v23
    v_add_u32 v13, s99, v23
    v_add_u32 v12, s98, v13
    v_accvgpr_read_b32 v32, a64
    v_accvgpr_read_b32 v33, a65
    v_accvgpr_read_b32 v34, a66
    v_accvgpr_read_b32 v35, a67
    v_cvt_pk_bf16_f32 v32, v32, v33
    v_cvt_pk_bf16_f32 v33, v34, v35
    ds_write_b64 v8, v[32:33] offset:0
    v_accvgpr_read_b32 v36, a68
    v_accvgpr_read_b32 v37, a69
    v_accvgpr_read_b32 v38, a70
    v_accvgpr_read_b32 v39, a71
    v_cvt_pk_bf16_f32 v36, v36, v37
    v_cvt_pk_bf16_f32 v37, v38, v39
    ds_write_b64 v8, v[36:37] offset:9216
    v_accvgpr_read_b32 v40, a72
    v_accvgpr_read_b32 v41, a73
    v_accvgpr_read_b32 v42, a74
    v_accvgpr_read_b32 v43, a75
    v_cvt_pk_bf16_f32 v40, v40, v41
    v_cvt_pk_bf16_f32 v41, v42, v43
    ds_write_b64 v8, v[40:41] offset:20736
    v_accvgpr_read_b32 v44, a76
    v_accvgpr_read_b32 v45, a77
    v_accvgpr_read_b32 v46, a78
    v_accvgpr_read_b32 v47, a79
    v_cvt_pk_bf16_f32 v44, v44, v45
    v_cvt_pk_bf16_f32 v45, v46, v47
    ds_write_b64 v8, v[44:45] offset:29952
    v_accvgpr_read_b32 v32, a80
    v_accvgpr_read_b32 v33, a81
    v_accvgpr_read_b32 v34, a82
    v_accvgpr_read_b32 v35, a83
    v_cvt_pk_bf16_f32 v32, v32, v33
    v_cvt_pk_bf16_f32 v33, v34, v35
    ds_write_b64 v9, v[32:33] offset:32
    v_accvgpr_read_b32 v36, a84
    v_accvgpr_read_b32 v37, a85
    v_accvgpr_read_b32 v38, a86
    v_accvgpr_read_b32 v39, a87
    v_cvt_pk_bf16_f32 v36, v36, v37
    v_cvt_pk_bf16_f32 v37, v38, v39
    ds_write_b64 v9, v[36:37] offset:9248
    v_accvgpr_read_b32 v40, a88
    v_accvgpr_read_b32 v41, a89
    v_accvgpr_read_b32 v42, a90
    v_accvgpr_read_b32 v43, a91
    v_cvt_pk_bf16_f32 v40, v40, v41
    v_cvt_pk_bf16_f32 v41, v42, v43
    ds_write_b64 v9, v[40:41] offset:20768
    v_accvgpr_read_b32 v44, a92
    v_accvgpr_read_b32 v45, a93
    v_accvgpr_read_b32 v46, a94
    v_accvgpr_read_b32 v47, a95
    v_cvt_pk_bf16_f32 v44, v44, v45
    v_cvt_pk_bf16_f32 v45, v46, v47
    ds_write_b64 v9, v[44:45] offset:29984
    v_accvgpr_read_b32 v32, a96
    v_accvgpr_read_b32 v33, a97
    v_accvgpr_read_b32 v34, a98
    v_accvgpr_read_b32 v35, a99
    v_cvt_pk_bf16_f32 v32, v32, v33
    v_cvt_pk_bf16_f32 v33, v34, v35
    ds_write_b64 v10, v[32:33] offset:64
    v_accvgpr_read_b32 v36, a100
    v_accvgpr_read_b32 v37, a101
    v_accvgpr_read_b32 v38, a102
    v_accvgpr_read_b32 v39, a103
    v_cvt_pk_bf16_f32 v36, v36, v37
    v_cvt_pk_bf16_f32 v37, v38, v39
    ds_write_b64 v10, v[36:37] offset:9280
    v_accvgpr_read_b32 v40, a104
    v_accvgpr_read_b32 v41, a105
    v_accvgpr_read_b32 v42, a106
    v_accvgpr_read_b32 v43, a107
    s_xor_b32 s21, s3, 0
    s_lshl2_add_u32 s21, s21, s4
    s_mul_i32 s21, s21, 36864
    s_add_u32 s64, s21, s17
    s_add_u32 m0, s78, 0
    s_nop 0
    buffer_load_dwordx4 v1, s[56:59], s64 offen sc1 lds
    v_cvt_pk_bf16_f32 v40, v40, v41
    v_cvt_pk_bf16_f32 v41, v42, v43
    ds_write_b64 v10, v[40:41] offset:20800
    v_accvgpr_read_b32 v44, a108
    v_accvgpr_read_b32 v45, a109
    v_accvgpr_read_b32 v46, a110
    v_accvgpr_read_b32 v47, a111
    v_cvt_pk_bf16_f32 v44, v44, v45
    v_cvt_pk_bf16_f32 v45, v46, v47
    ds_write_b64 v10, v[44:45] offset:30016
    v_accvgpr_read_b32 v32, a112
    v_accvgpr_read_b32 v33, a113
    v_accvgpr_read_b32 v34, a114
    buffer_load_dwordx4 v1, s[56:59], s64 offen offset:1024 sc1 lds
    v_accvgpr_read_b32 v35, a115
    v_cvt_pk_bf16_f32 v32, v32, v33
    v_cvt_pk_bf16_f32 v33, v34, v35
    ds_write_b64 v9, v[32:33] offset:96
    v_accvgpr_read_b32 v36, a116
    v_accvgpr_read_b32 v37, a117
    v_accvgpr_read_b32 v38, a118
    v_accvgpr_read_b32 v39, a119
    v_cvt_pk_bf16_f32 v36, v36, v37
    v_cvt_pk_bf16_f32 v37, v38, v39
    ds_write_b64 v9, v[36:37] offset:9312
    v_accvgpr_read_b32 v40, a120
    v_accvgpr_read_b32 v41, a121
    s_add_u32 s64, s21, s18
    s_add_u32 m0, s78, 2048
    s_nop 0
    buffer_load_dwordx4 v1, s[56:59], s64 offen sc1 lds
    v_accvgpr_read_b32 v42, a122
    v_accvgpr_read_b32 v43, a123
    v_cvt_pk_bf16_f32 v40, v40, v41
    v_cvt_pk_bf16_f32 v41, v42, v43
    ds_write_b64 v9, v[40:41] offset:20832
    v_accvgpr_read_b32 v44, a124
    v_accvgpr_read_b32 v45, a125
    v_accvgpr_read_b32 v46, a126
    v_accvgpr_read_b32 v47, a127
    v_cvt_pk_bf16_f32 v44, v44, v45
    v_cvt_pk_bf16_f32 v45, v46, v47
    s_waitcnt lgkmcnt(14)
    ds_write_b64 v9, v[44:45] offset:30048
    v_accvgpr_read_b32 v32, a128
    buffer_load_dwordx4 v1, s[56:59], s64 offen offset:1024 sc1 lds
    v_accvgpr_read_b32 v33, a129
    v_accvgpr_read_b32 v34, a130
    v_accvgpr_read_b32 v35, a131
    v_cvt_pk_bf16_f32 v32, v32, v33
    v_cvt_pk_bf16_f32 v33, v34, v35
    s_waitcnt lgkmcnt(14)
    ds_write_b64 v12, v[32:33] offset:0
    v_accvgpr_read_b32 v36, a132
    v_accvgpr_read_b32 v37, a133
    v_accvgpr_read_b32 v38, a134
    v_accvgpr_read_b32 v39, a135
    v_cvt_pk_bf16_f32 v36, v36, v37
    v_cvt_pk_bf16_f32 v37, v38, v39
    s_cmp_eq_u32 s73, 0
    s_cselect_b64 exec, -1, 0
    s_waitcnt lgkmcnt(14)
    ds_write_b64 v13, v[36:37] offset:32
    s_mov_b64 exec, -1
    s_add_u32 s64, s21, s19
    s_add_u32 m0, s78, 4096
    s_nop 0
    buffer_load_dwordx4 v1, s[56:59], s64 offen sc1 lds
    s_cmp_lg_u64 s[84:85], 0
    s_cselect_b32 s7, 1, 0
    v_mov_b32 v20, s7
    s_lshl2_add_u32 s98, s4, s79
    v_mov_b32 v21, s98
    s_waitcnt lgkmcnt(14)
    ds_write_b32 v21, v20 offset:41472
    v_mov_b32 v21, s79
    s_and_b32 s98, s4, 1
    s_lshl_b32 s98, s98, 6
    v_lshrrev_b32 v14, 4, v1
    v_add_u32 v14, s98, v14
    buffer_load_dwordx4 v1, s[56:59], s64 offen offset:1024 sc1 lds
    s_lshr_b32 s99, s4, 1
    s_mul_i32 s7, s99, 144
    s_add_u32 s7, s7, 2
    v_add_u32 v2, s7, v14
    v_mul_u32_u24 v2, 144, v2
    v_add_u32 v2, s79, v2
    s_sub_u32 s7, 15, s6
    s_cmp_eq_u32 s99, 0
    s_cselect_b32 s7, s6, s7
    s_lshl_b32 s7, s7, 7
    v_add_u32 v14, s7, v14
    v_lshrrev_b32 v15, 4, v14
    s_mov_b32 s98, 155648
    s_add_u32 s64, s21, s20
    s_add_u32 m0, s78, 6144
    s_nop 0
    buffer_load_dwordx4 v1, s[56:59], s64 offen sc1 lds
    v_mul_lo_u32 v15, v15, s98
    v_and_b32 v23, 0xf0, v1
    v_add_u32 v15, v15, v23
    s_lshl2_add_u32 s98, s62, s4
    s_mul_i32 s98, s98, 311296
    v_add_u32 v4, s98, v1
    v_add_u32 v5, 155648, v4
    v_bfe_u32 v19, v1, 4, 3
    v_lshlrev_b32 v19, 7, v19
    v_mov_b32 v11, v1
    v_add_u32 v12, 0x10000, v1
    v_add_u32 v13, 0x20000, v1
    s_mov_b32 s98, 0xbfb8aa3b
    s_mov_b32 s99, 0x3eae1a93
    s_waitcnt vmcnt(7) lgkmcnt(0)
    s_barrier
    ds_read_b128 v[24:27], v21 offset:41472
    ds_read_b128 v[32:35], v2 offset:2016
    ds_read_b128 v[36:39], v2 offset:2032
    ds_read_b128 v[40:43], v2 offset:2048
    ds_read_b128 v[44:47], v2 offset:1728
    ds_read_b128 v[48:51], v2 offset:1744
    ds_read_b128 v[52:55], v2 offset:1760
    s_waitcnt lgkmcnt(6)
    v_or3_b32 v24, v24, v25, v26
    v_or_b32 v24, v24, v27
    s_nop 0
    v_readfirstlane_b32 s7, v24
    s_nop 1
    s_andn2_b32 s7, s7, s83
    s_cbranch_scc1 K1_REDO
    v_mov_b32 v31, 2
    buffer_store_dword v31, v30, s[32:35], s101 offen sc1
    s_xor_b32 s21, s3, 1
    s_lshl2_add_u32 s21, s21, s4
    s_mul_i32 s21, s21, 36864
    s_add_u32 s64, s21, s17
    s_add_u32 m0, s78, 28672
    s_nop 0
    buffer_load_dwordx4 v1, s[56:59], s64 offen sc1 lds
    ds_read_b128 v[128:131], v2 offset:2096
    ds_read_b128 v[132:135], v2 offset:2112
    ds_read_b128 v[136:139], v2 offset:2128
    ds_read_b128 v[56:59], v2 offset:1440
    ds_read_b128 v[60:63], v2 offset:1456
    ds_read_b128 v[64:67], v2 offset:1472
    ds_read_b128 v[68:71], v2 offset:1152
    ds_read_b128 v[72:75], v2 offset:1168
    ds_read_b128 v[76:79], v2 offset:1184
    s_waitcnt lgkmcnt(8)
    v_dot2_f32_bf16 v140, v128, v32, 0
    buffer_load_dwordx4 v1, s[56:59], s64 offen offset:1024 sc1 lds
    v_dot2_f32_bf16 v141, v128, v44, 0
    ds_read_b128 v[80:83], v2 offset:864
    s_waitcnt lgkmcnt(6)
    v_dot2_f32_bf16 v142, v128, v56, 0
    s_waitcnt lgkmcnt(3)
    v_dot2_f32_bf16 v143, v128, v68, 0
    ds_read_b128 v[84:87], v2 offset:880
    v_dot2c_f32_bf16 v140, v129, v33
    v_dot2c_f32_bf16 v141, v129, v45
    ds_read_b128 v[88:91], v2 offset:896
    v_dot2c_f32_bf16 v142, v129, v57
    v_dot2c_f32_bf16 v143, v129, v69
    s_add_u32 s64, s21, s18
    s_add_u32 m0, s78, 30720
    s_nop 0
    buffer_load_dwordx4 v1, s[56:59], s64 offen sc1 lds
    ds_read_b128 v[92:95], v2 offset:576
    v_dot2c_f32_bf16 v140, v130, v34
    v_dot2c_f32_bf16 v141, v130, v46
    ds_read_b128 v[96:99], v2 offset:592
    v_dot2c_f32_bf16 v142, v130, v58
    v_dot2c_f32_bf16 v143, v130, v70
    ds_read_b128 v[100:103], v2 offset:608
    v_dot2c_f32_bf16 v140, v131, v35
    v_dot2c_f32_bf16 v141, v131, v47
    ds_read_b128 v[104:107], v2 offset:288
    buffer_load_dwordx4 v1, s[56:59], s64 offen offset:1024 sc1 lds
    v_dot2c_f32_bf16 v142, v131, v59
    v_dot2c_f32_bf16 v143, v131, v71
    ds_read_b128 v[108:111], v2 offset:304
    v_dot2c_f32_bf16 v140, v132, v36
    v_dot2c_f32_bf16 v141, v132, v48
    ds_read_b128 v[112:115], v2 offset:320
    v_dot2c_f32_bf16 v142, v132, v60
    s_waitcnt lgkmcnt(10)
    v_dot2c_f32_bf16 v143, v132, v72
    ds_read_b128 v[116:119], v2 offset:0
    v_dot2c_f32_bf16 v140, v133, v37
    s_add_u32 s64, s21, s19
    s_add_u32 m0, s78, 32768
    s_nop 0
    buffer_load_dwordx4 v1, s[56:59], s64 offen sc1 lds
    v_dot2c_f32_bf16 v141, v133, v49
    ds_read_b128 v[120:123], v2 offset:16
    v_dot2c_f32_bf16 v142, v133, v61
    v_dot2c_f32_bf16 v143, v133, v73
    ds_read_b128 v[124:127], v2 offset:32
    v_dot2c_f32_bf16 v140, v134, v38
    v_dot2c_f32_bf16 v141, v134, v50
    v_dot2c_f32_bf16 v142, v134, v62
    v_dot2c_f32_bf16 v143, v134, v74
    v_dot2c_f32_bf16 v140, v135, v39
    buffer_load_dwordx4 v1, s[56:59], s64 offen offset:1024 sc1 lds
    v_dot2c_f32_bf16 v141, v135, v51
    v_dot2c_f32_bf16 v142, v135, v63
    v_dot2c_f32_bf16 v143, v135, v75
    v_dot2c_f32_bf16 v140, v136, v40
    v_dot2c_f32_bf16 v141, v136, v52
    v_dot2c_f32_bf16 v142, v136, v64
    s_waitcnt lgkmcnt(12)
    v_dot2c_f32_bf16 v143, v136, v76
    s_waitcnt lgkmcnt(11)
    v_dot2_f32_bf16 v144, v128, v80, 0
    s_waitcnt lgkmcnt(8)
    v_dot2_f32_bf16 v145, v128, v92, 0
    ds_read_b128 v[32:35], v2 offset:2064
    s_add_u32 s64, s21, s20
    s_add_u32 m0, s78, 34816
    s_nop 0
    buffer_load_dwordx4 v1, s[56:59], s64 offen sc1 lds
    s_waitcnt lgkmcnt(6)
    v_dot2_f32_bf16 v146, v128, v104, 0
    s_waitcnt lgkmcnt(3)
    v_dot2_f32_bf16 v147, v128, v116, 0
    ds_read_b128 v[36:39], v2 offset:2080
    v_dot2c_f32_bf16 v144, v129, v81
    v_dot2c_f32_bf16 v145, v129, v93
    ds_read_b128 v[44:47], v2 offset:1776
    v_dot2c_f32_bf16 v146, v129, v105
    v_dot2c_f32_bf16 v147, v129, v117
    ds_read_b128 v[48:51], v2 offset:1792
    v_dot2c_f32_bf16 v144, v130, v82
    s_xor_b32 s21, s3, 2
    s_lshl2_add_u32 s21, s21, s4
    s_mul_i32 s21, s21, 36864
    s_add_u32 s64, s21, s17
    s_add_u32 m0, s78, 57344
    s_nop 0
    buffer_load_dwordx4 v1, s[56:59], s64 offen sc1 lds
    v_dot2c_f32_bf16 v145, v130, v94
    ds_read_b128 v[56:59], v2 offset:1488
    v_dot2c_f32_bf16 v146, v130, v106
    v_dot2c_f32_bf16 v147, v130, v118
    ds_read_b128 v[60:63], v2 offset:1504
    v_dot2c_f32_bf16 v144, v131, v83
    v_dot2c_f32_bf16 v145, v131, v95
    ds_read_b128 v[68:71], v2 offset:1200
    v_dot2c_f32_bf16 v146, v131, v107
    v_dot2c_f32_bf16 v147, v131, v119
    buffer_load_dwordx4 v1, s[56:59], s64 offen offset:1024 sc1 lds
    ds_read_b128 v[72:75], v2 offset:1216
    v_dot2c_f32_bf16 v144, v132, v84
    v_dot2c_f32_bf16 v145, v132, v96
    v_dot2c_f32_bf16 v146, v132, v108
    s_waitcnt lgkmcnt(9)
    v_dot2c_f32_bf16 v147, v132, v120
    v_dot2c_f32_bf16 v144, v133, v85
    v_dot2c_f32_bf16 v145, v133, v97
    v_dot2c_f32_bf16 v146, v133, v109
    v_dot2c_f32_bf16 v147, v133, v121
    v_dot2c_f32_bf16 v144, v134, v86
    s_add_u32 s64, s21, s18
    s_add_u32 m0, s78, 59392
    s_nop 0
    buffer_load_dwordx4 v1, s[56:59], s64 offen sc1 lds
    v_dot2c_f32_bf16 v145, v134, v98
    v_dot2c_f32_bf16 v146, v134, v110
    v_dot2c_f32_bf16 v147, v134, v122
    v_dot2c_f32_bf16 v144, v135, v87
    v_dot2c_f32_bf16 v145, v135, v99
    v_dot2c_f32_bf16 v146, v135, v111
    v_dot2c_f32_bf16 v147, v135, v123
    v_dot2c_f32_bf16 v144, v136, v88
    v_dot2c_f32_bf16 v145, v136, v100
    v_dot2c_f32_bf16 v146, v136, v112
    buffer_load_dwordx4 v1, s[56:59], s64 offen offset:1024 sc1 lds
    s_waitcnt lgkmcnt(8)
    v_dot2c_f32_bf16 v147, v136, v124
    v_lshlrev_b32 v8, 16, v138
    v_mul_f32 v8, s98, v8
    v_exp_f32 v8, v8
    v_mov_b32 v9, 0xf149f2ca
    ds_read_b128 v[80:83], v2 offset:912
    v_cmp_le_u32 vcc, 2, v14
    ds_read_b128 v[84:87], v2 offset:928
    s_nop 0
    v_cndmask_b32 v141, v9, v141, vcc
    v_cmp_le_u32 vcc, 4, v14
    s_add_u32 s64, s21, s19
    s_add_u32 m0, s78, 61440
    s_nop 0
    buffer_load_dwordx4 v1, s[56:59], s64 offen sc1 lds
    ds_read_b128 v[92:95], v2 offset:624
    v_cndmask_b32 v142, v9, v142, vcc
    v_cmp_le_u32 vcc, 6, v14
    ds_read_b128 v[96:99], v2 offset:640
    s_nop 0
    v_cndmask_b32 v143, v9, v143, vcc
    v_cmp_le_u32 vcc, 8, v14
    ds_read_b128 v[104:107], v2 offset:336
    s_nop 0
    v_cndmask_b32 v144, v9, v144, vcc
    v_cmp_le_u32 vcc, 10, v14
    ds_read_b128 v[108:111], v2 offset:352
    buffer_load_dwordx4 v1, s[56:59], s64 offen offset:1024 sc1 lds
    v_cndmask_b32 v145, v9, v145, vcc
    v_cmp_le_u32 vcc, 12, v14
    ds_read_b128 v[116:119], v2 offset:48
    s_nop 0
    v_cndmask_b32 v146, v9, v146, vcc
    v_cmp_le_u32 vcc, 14, v14
    s_waitcnt lgkmcnt(14)
    ds_read_b128 v[120:123], v2 offset:64
    s_nop 0
    v_cndmask_b32 v147, v9, v147, vcc
    v_max3_f32 v9, v140, v141, v142
    v_max3_f32 v10, v143, v144, v145
    v_max3_f32 v9, v9, v146, v147
    s_add_u32 s64, s21, s20
    s_add_u32 m0, s78, 63488
    s_nop 0
    buffer_load_dwordx4 v1, s[56:59], s64 offen sc1 lds
    v_max_f32 v9, v9, v10
    v_mul_f32 v9, s99, v9
    v_add_f32 v8, 1.0, v8
    v_fma_f32 v140, v140, s99, -v9
    v_fma_f32 v141, v141, s99, -v9
    v_fma_f32 v142, v142, s99, -v9
    v_fma_f32 v143, v143, s99, -v9
    v_fma_f32 v144, v144, s99, -v9
    v_fma_f32 v145, v145, s99, -v9
    v_fma_f32 v146, v146, s99, -v9
    v_fma_f32 v147, v147, s99, -v9
    buffer_load_dword v3, v19, s[32:35], s66 offen sc1
    s_xor_b32 s21, s3, 3
    s_lshl2_add_u32 s21, s21, s4
    s_mul_i32 s21, s21, 36864
    s_add_u32 s64, s21, s17
    s_add_u32 m0, s78, 86016
    s_nop 0
    buffer_load_dwordx4 v1, s[56:59], s64 offen sc1 lds
    v_exp_f32 v140, v140
    v_exp_f32 v141, v141
    v_exp_f32 v142, v142
    v_exp_f32 v143, v143
    v_exp_f32 v144, v144
    v_exp_f32 v145, v145
    v_exp_f32 v146, v146
    v_exp_f32 v147, v147
    buffer_load_dwordx4 v1, s[56:59], s64 offen offset:1024 sc1 lds
    v_add_f32 v10, v140, v141
    v_add_f32 v10, v10, v142
    v_add_f32 v10, v10, v143
    v_add_f32 v10, v10, v144
    v_add_f32 v10, v10, v145
    v_add_f32 v10, v10, v146
    v_add_f32 v10, v10, v147
    v_mul_f32 v10, v10, v8
    s_add_u32 s64, s21, s18
    s_add_u32 m0, s78, 88064
    s_nop 0
    buffer_load_dwordx4 v1, s[56:59], s64 offen sc1 lds
    v_rcp_f32 v10, v10
    s_nop 0
    v_mul_f32 v140, v140, v10
    v_mul_f32 v141, v141, v10
    v_mul_f32 v142, v142, v10
    v_mul_f32 v143, v143, v10
    v_mul_f32 v144, v144, v10
    v_mul_f32 v145, v145, v10
    v_mul_f32 v146, v146, v10
    v_mul_f32 v147, v147, v10
    buffer_load_dwordx4 v1, s[56:59], s64 offen offset:1024 sc1 lds
    v_cvt_pk_bf16_f32 v148, 0, v140
    v_cvt_pk_bf16_f32 v149, 0, v141
    v_cvt_pk_bf16_f32 v150, 0, v142
    v_cvt_pk_bf16_f32 v151, 0, v143
    v_cvt_pk_bf16_f32 v152, 0, v144
    v_cvt_pk_bf16_f32 v153, 0, v145
    v_cvt_pk_bf16_f32 v154, 0, v146
    v_cvt_pk_bf16_f32 v155, 0, v147
    s_add_u32 s64, s21, s19
    s_add_u32 m0, s78, 90112
    s_nop 0
    buffer_load_dwordx4 v1, s[56:59], s64 offen sc1 lds
    v_lshrrev_b32 v140, 16, v148
    v_lshrrev_b32 v141, 16, v149
    v_lshrrev_b32 v142, 16, v150
    v_lshrrev_b32 v143, 16, v151
    v_lshrrev_b32 v144, 16, v152
    v_lshrrev_b32 v145, 16, v153
    v_lshrrev_b32 v146, 16, v154
    v_lshrrev_b32 v147, 16, v155
    v_dot2_f32_bf16 v128, v42, v140, 0
    buffer_load_dwordx4 v1, s[56:59], s64 offen offset:1024 sc1 lds
    v_dot2_f32_bf16 v129, v42, v148, 0
    v_dot2_f32_bf16 v130, v43, v140, 0
    v_dot2_f32_bf16 v131, v43, v148, 0
    v_dot2_f32_bf16 v132, v32, v140, 0
    v_dot2_f32_bf16 v133, v32, v148, 0
    v_dot2_f32_bf16 v134, v33, v140, 0
    v_dot2_f32_bf16 v135, v33, v148, 0
    v_dot2_f32_bf16 v136, v34, v140, 0
    s_add_u32 s64, s21, s20
    s_add_u32 m0, s78, 92160
    s_nop 0
    buffer_load_dwordx4 v1, s[56:59], s64 offen sc1 lds
    v_dot2_f32_bf16 v137, v34, v148, 0
    v_dot2_f32_bf16 v138, v35, v140, 0
    v_dot2_f32_bf16 v139, v35, v148, 0
    s_waitcnt lgkmcnt(14)
    v_dot2_f32_bf16 v156, v36, v140, 0
    v_dot2_f32_bf16 v157, v36, v148, 0
    v_dot2_f32_bf16 v158, v37, v140, 0
    v_dot2_f32_bf16 v159, v37, v148, 0
    v_dot2_f32_bf16 v17, v38, v140, 0
    v_dot2_f32_bf16 v18, v38, v148, 0
    s_waitcnt vmcnt(7)
    v_cmp_gt_u32 vcc, 2, v3
    s_nop 1
    s_and_b64 vcc, vcc, exec
    s_cbranch_scc1 SPIN_CTX
BACK_CTX:
    buffer_load_dwordx4 a[0:3], v4, s[40:43], s63 offen offset:0 sc1
    v_dot2c_f32_bf16 v128, v54, v141
    v_dot2c_f32_bf16 v129, v54, v149
    v_dot2c_f32_bf16 v130, v55, v141
    v_dot2c_f32_bf16 v131, v55, v149
    s_waitcnt lgkmcnt(13)
    v_dot2c_f32_bf16 v132, v44, v141
    v_dot2c_f32_bf16 v133, v44, v149
    v_dot2c_f32_bf16 v134, v45, v141
    v_dot2c_f32_bf16 v135, v45, v149
    buffer_load_dwordx4 a[4:7], v5, s[40:43], s63 offen offset:0 sc1
    v_dot2c_f32_bf16 v136, v46, v141
    v_dot2c_f32_bf16 v137, v46, v149
    v_dot2c_f32_bf16 v138, v47, v141
    v_dot2c_f32_bf16 v139, v47, v149
    s_waitcnt lgkmcnt(12)
    v_dot2c_f32_bf16 v156, v48, v141
    v_dot2c_f32_bf16 v157, v48, v149
    v_dot2c_f32_bf16 v158, v49, v141
    v_dot2c_f32_bf16 v159, v49, v149
    v_dot2c_f32_bf16 v17, v50, v141
    buffer_load_dwordx4 a[8:11], v4, s[40:43], s63 offen offset:1024 sc1
    v_dot2c_f32_bf16 v18, v50, v149
    v_dot2c_f32_bf16 v128, v66, v142
    v_dot2c_f32_bf16 v129, v66, v150
    v_dot2c_f32_bf16 v130, v67, v142
    v_dot2c_f32_bf16 v131, v67, v150
    s_waitcnt lgkmcnt(11)
    v_dot2c_f32_bf16 v132, v56, v142
    v_dot2c_f32_bf16 v133, v56, v150
    v_dot2c_f32_bf16 v134, v57, v142
    buffer_load_dwordx4 a[12:15], v5, s[40:43], s63 offen offset:1024 sc1
    v_dot2c_f32_bf16 v135, v57, v150
    v_dot2c_f32_bf16 v136, v58, v142
    v_dot2c_f32_bf16 v137, v58, v150
    v_dot2c_f32_bf16 v138, v59, v142
    v_dot2c_f32_bf16 v139, v59, v150
    s_waitcnt lgkmcnt(10)
    v_dot2c_f32_bf16 v156, v60, v142
    v_dot2c_f32_bf16 v157, v60, v150
    v_dot2c_f32_bf16 v158, v61, v142
    v_dot2c_f32_bf16 v159, v61, v150
    buffer_load_dwordx4 a[16:19], v4, s[40:43], s63 offen offset:2048 sc1
    v_dot2c_f32_bf16 v17, v62, v142
    v_dot2c_f32_bf16 v18, v62, v150
    v_dot2c_f32_bf16 v128, v78, v143
    v_dot2c_f32_bf16 v129, v78, v151
    v_dot2c_f32_bf16 v130, v79, v143
    v_dot2c_f32_bf16 v131, v79, v151
    s_waitcnt lgkmcnt(9)
    v_dot2c_f32_bf16 v132, v68, v143
    v_dot2c_f32_bf16 v133, v68, v151
    v_dot2c_f32_bf16 v134, v69, v143
    buffer_load_dwordx4 a[20:23], v5, s[40:43], s63 offen offset:2048 sc1
    v_dot2c_f32_bf16 v135, v69, v151
    v_dot2c_f32_bf16 v136, v70, v143
    v_dot2c_f32_bf16 v137, v70, v151
    v_dot2c_f32_bf16 v138, v71, v143
    v_dot2c_f32_bf16 v139, v71, v151
    s_waitcnt lgkmcnt(8)
    v_dot2c_f32_bf16 v156, v72, v143
    v_dot2c_f32_bf16 v157, v72, v151
    v_dot2c_f32_bf16 v158, v73, v143
    buffer_load_dwordx4 a[24:27], v4, s[40:43], s63 offen offset:3072 sc1
    v_dot2c_f32_bf16 v159, v73, v151
    v_dot2c_f32_bf16 v17, v74, v143
    v_dot2c_f32_bf16 v18, v74, v151
    v_dot2c_f32_bf16 v128, v90, v144
    v_dot2c_f32_bf16 v129, v90, v152
    v_dot2c_f32_bf16 v130, v91, v144
    v_dot2c_f32_bf16 v131, v91, v152
    s_waitcnt lgkmcnt(7)
    v_dot2c_f32_bf16 v132, v80, v144
    v_dot2c_f32_bf16 v133, v80, v152
    buffer_load_dwordx4 a[28:31], v5, s[40:43], s63 offen offset:3072 sc1
    v_dot2c_f32_bf16 v134, v81, v144
    v_dot2c_f32_bf16 v135, v81, v152
    v_dot2c_f32_bf16 v136, v82, v144
    v_dot2c_f32_bf16 v137, v82, v152
    v_dot2c_f32_bf16 v138, v83, v144
    v_dot2c_f32_bf16 v139, v83, v152
    s_waitcnt lgkmcnt(6)
    v_dot2c_f32_bf16 v156, v84, v144
    v_dot2c_f32_bf16 v157, v84, v152
    v_dot2c_f32_bf16 v158, v85, v144
    s_xor_b32 s63, s63, 4096
    buffer_load_dwordx4 a[32:35], v4, s[40:43], s63 offen offset:0 sc1
    v_dot2c_f32_bf16 v159, v85, v152
    v_dot2c_f32_bf16 v17, v86, v144
    v_dot2c_f32_bf16 v18, v86, v152
    v_dot2c_f32_bf16 v128, v102, v145
    v_dot2c_f32_bf16 v129, v102, v153
    v_dot2c_f32_bf16 v130, v103, v145
    v_dot2c_f32_bf16 v131, v103, v153
    s_waitcnt lgkmcnt(5)
    v_dot2c_f32_bf16 v132, v92, v145
    buffer_load_dwordx4 a[36:39], v5, s[40:43], s63 offen offset:0 sc1
    v_dot2c_f32_bf16 v133, v92, v153
    v_dot2c_f32_bf16 v134, v93, v145
    v_dot2c_f32_bf16 v135, v93, v153
    v_dot2c_f32_bf16 v136, v94, v145
    v_dot2c_f32_bf16 v137, v94, v153
    v_dot2c_f32_bf16 v138, v95, v145
    v_dot2c_f32_bf16 v139, v95, v153
    s_waitcnt lgkmcnt(4)
    v_dot2c_f32_bf16 v156, v96, v145
    v_dot2c_f32_bf16 v157, v96, v153
    buffer_load_dwordx4 a[40:43], v4, s[40:43], s63 offen offset:1024 sc1
    v_dot2c_f32_bf16 v158, v97, v145
    v_dot2c_f32_bf16 v159, v97, v153
    v_dot2c_f32_bf16 v17, v98, v145
    v_dot2c_f32_bf16 v18, v98, v153
    v_dot2c_f32_bf16 v128, v114, v146
    v_dot2c_f32_bf16 v129, v114, v154
    v_dot2c_f32_bf16 v130, v115, v146
    v_dot2c_f32_bf16 v131, v115, v154
    buffer_load_dwordx4 a[44:47], v5, s[40:43], s63 offen offset:1024 sc1
    s_waitcnt lgkmcnt(3)
    v_dot2c_f32_bf16 v132, v104, v146
    v_dot2c_f32_bf16 v133, v104, v154
    v_dot2c_f32_bf16 v134, v105, v146
    v_dot2c_f32_bf16 v135, v105, v154
    v_dot2c_f32_bf16 v136, v106, v146
    v_dot2c_f32_bf16 v137, v106, v154
    v_dot2c_f32_bf16 v138, v107, v146
    v_dot2c_f32_bf16 v139, v107, v154
    s_waitcnt lgkmcnt(2)
    v_dot2c_f32_bf16 v156, v108, v146
    buffer_load_dwordx4 a[48:51], v4, s[40:43], s63 offen offset:2048 sc1
    v_dot2c_f32_bf16 v157, v108, v154
    v_dot2c_f32_bf16 v158, v109, v146
    v_dot2c_f32_bf16 v159, v109, v154
    v_dot2c_f32_bf16 v17, v110, v146
    v_dot2c_f32_bf16 v18, v110, v154
    v_dot2c_f32_bf16 v128, v126, v147
    v_dot2c_f32_bf16 v129, v126, v155
    v_dot2c_f32_bf16 v130, v127, v147
    v_dot2c_f32_bf16 v131, v127, v155
    buffer_load_dwordx4 a[52:55], v5, s[40:43], s63 offen offset:2048 sc1
    s_waitcnt lgkmcnt(1)
    v_dot2c_f32_bf16 v132, v116, v147
    v_dot2c_f32_bf16 v133, v116, v155
    v_dot2c_f32_bf16 v134, v117, v147
    v_dot2c_f32_bf16 v135, v117, v155
    v_dot2c_f32_bf16 v136, v118, v147
    v_dot2c_f32_bf16 v137, v118, v155
    v_dot2c_f32_bf16 v138, v119, v147
    v_dot2c_f32_bf16 v139, v119, v155
    buffer_load_dwordx4 a[56:59], v4, s[40:43], s63 offen offset:3072 sc1
    s_waitcnt lgkmcnt(0)
    v_dot2c_f32_bf16 v156, v120, v147
    v_dot2c_f32_bf16 v157, v120, v155
    v_dot2c_f32_bf16 v158, v121, v147
    v_dot2c_f32_bf16 v159, v121, v155
    v_dot2c_f32_bf16 v17, v122, v147
    v_dot2c_f32_bf16 v18, v122, v155
    v_mov_b32 v89, 0
    v_mov_b32 v90, 0
    v_mov_b32 v91, 0
    buffer_load_dwordx4 a[60:63], v5, s[40:43], s63 offen offset:3072 sc1
    s_xor_b32 s63, s63, 12288
    v_cvt_pk_bf16_f32 v80, v128, v129
    v_cvt_pk_bf16_f32 v81, v130, v131
    v_cvt_pk_bf16_f32 v82, v132, v133
    v_cvt_pk_bf16_f32 v83, v134, v135
    v_cvt_pk_bf16_f32 v84, v136, v137
    v_cvt_pk_bf16_f32 v85, v138, v139
    v_cvt_pk_bf16_f32 v86, v156, v157
    v_cvt_pk_bf16_f32 v87, v158, v159
    v_cvt_pk_bf16_f32 v88, v17, v18
    s_waitcnt vmcnt(8)
    s_barrier
    ds_read_b128 v[104:107], v11 offset:0
    ds_read_b128 v[108:111], v11 offset:7168
    ds_read_b128 v[112:115], v11 offset:1024
    ds_read_b128 v[116:119], v11 offset:8192
    s_waitcnt lgkmcnt(3)
    v_mfma_f32_16x16x32_bf16 v[176:179], v[104:107], a[0:3], 0
    s_lshl3_add_u32 s98, 1, s5
    ds_read_b128 v[120:123], v11 offset:2048
    ds_read_b128 v[124:127], v11 offset:9216
    s_waitcnt lgkmcnt(4)
    v_mfma_f32_16x16x32_bf16 v[176:179], v[108:111], a[8:11], v[176:179]
    s_and_b32 s98, s98, 31
    buffer_load_dwordx4 a[64:67], v4, s[40:43], s63 offen offset:0 sc1
    v_mfma_f32_16x16x32_bf16 v[180:183], v[104:107], a[4:7], 0
    s_lshl_b32 s8, s6, 5
    ds_read_b128 v[128:131], v11 offset:3072
    ds_read_b128 v[132:135], v11 offset:10240
    v_mfma_f32_16x16x32_bf16 v[180:183], v[108:111], a[12:15], v[180:183]
    s_add_u32 s98, s98, s8
    ds_read_b128 v[136:139], v11 offset:4096
    s_waitcnt lgkmcnt(6)
    v_mfma_f32_16x16x32_bf16 v[184:187], v[112:115], a[0:3], 0
    s_mul_i32 s98, s98, 3
    buffer_load_dwordx4 a[68:71], v5, s[40:43], s63 offen offset:0 sc1
    s_waitcnt lgkmcnt(5)
    v_mfma_f32_16x16x32_bf16 v[184:187], v[116:119], a[8:11], v[184:187]
    s_sub_u32 s98, s98, 1
    ds_read_b128 v[140:143], v11 offset:11264
    ds_read_b128 v[144:147], v11 offset:5120
    v_mfma_f32_16x16x32_bf16 v[188:191], v[112:115], a[4:7], 0
    s_add_u32 s98, s98, 3
    ds_read_b128 v[148:151], v11 offset:12288
    v_mfma_f32_16x16x32_bf16 v[188:191], v[116:119], a[12:15], v[188:191]
    s_lshl2_add_u32 s98, s98, s4
    ds_read_b128 v[104:107], v11 offset:6144
    s_waitcnt lgkmcnt(5)
    v_mfma_f32_16x16x32_bf16 v[192:195], v[120:123], a[0:3], 0
    s_mul_i32 s8, s98, 3072
    buffer_load_dwordx4 a[72:75], v4, s[40:43], s63 offen offset:1024 sc1
    v_mfma_f32_16x16x32_bf16 v[192:195], v[124:127], a[8:11], v[192:195]
    s_lshl3_add_u32 s98, 2, s5
    ds_read_b128 v[108:111], v11 offset:13312
    ds_read_b128 v[112:115], v11 offset:14336
    v_mfma_f32_16x16x32_bf16 v[196:199], v[120:123], a[4:7], 0
    s_and_b32 s98, s98, 31
    ds_read_b128 v[116:119], v11 offset:21504
    v_mfma_f32_16x16x32_bf16 v[196:199], v[124:127], a[12:15], v[196:199]
    s_lshl_b32 s9, s6, 5
    ds_read_b128 v[120:123], v11 offset:15360
    v_mfma_f32_16x16x32_bf16 v[200:203], v[128:131], a[0:3], 0
    s_add_u32 s98, s98, s9
    buffer_load_dwordx4 a[76:79], v5, s[40:43], s63 offen offset:1024 sc1
    v_mfma_f32_16x16x32_bf16 v[200:203], v[132:135], a[8:11], v[200:203]
    s_mul_i32 s98, s98, 3
    ds_read_b128 v[124:127], v11 offset:22528
    v_mfma_f32_16x16x32_bf16 v[204:207], v[128:131], a[4:7], 0
    s_sub_u32 s98, s98, 2
    ds_read_b128 v[128:131], v11 offset:16384
    v_mfma_f32_16x16x32_bf16 v[204:207], v[132:135], a[12:15], v[204:207]
    s_add_u32 s98, s98, 3
    ds_read_b128 v[132:135], v11 offset:23552
    s_waitcnt lgkmcnt(4)
    v_mfma_f32_16x16x32_bf16 v[208:211], v[136:139], a[0:3], 0
    s_lshl2_add_u32 s98, s98, s4
    buffer_load_dwordx4 a[80:83], v4, s[40:43], s63 offen offset:2048 sc1
    v_mfma_f32_16x16x32_bf16 v[208:211], v[140:143], a[8:11], v[208:211]
    s_mul_i32 s9, s98, 3072
    v_mfma_f32_16x16x32_bf16 v[212:215], v[136:139], a[4:7], 0
    s_lshl3_add_u32 s98, 3, s5
    ds_read_b128 v[136:139], v11 offset:17408
    v_mfma_f32_16x16x32_bf16 v[212:215], v[140:143], a[12:15], v[212:215]
    s_and_b32 s98, s98, 31
    ds_read_b128 v[140:143], v11 offset:24576
    v_mfma_f32_16x16x32_bf16 v[216:219], v[144:147], a[0:3], 0
    s_lshl_b32 s10, s6, 5
    buffer_load_dwordx4 a[84:87], v5, s[40:43], s63 offen offset:2048 sc1
    v_mfma_f32_16x16x32_bf16 v[216:219], v[148:151], a[8:11], v[216:219]
    s_add_u32 s98, s98, s10
    v_mfma_f32_16x16x32_bf16 v[220:223], v[144:147], a[4:7], 0
    s_mul_i32 s98, s98, 3
    ds_read_b128 v[144:147], v11 offset:18432
    v_mfma_f32_16x16x32_bf16 v[220:223], v[148:151], a[12:15], v[220:223]
    s_sub_u32 s98, s98, 3
    ds_read_b128 v[148:151], v11 offset:25600
    v_mfma_f32_16x16x32_bf16 v[224:227], v[104:107], a[0:3], 0
    s_add_u32 s98, s98, 3
    buffer_load_dwordx4 a[88:91], v4, s[40:43], s63 offen offset:3072 sc1
    v_mfma_f32_16x16x32_bf16 v[224:227], v[108:111], a[8:11], v[224:227]
    s_lshl2_add_u32 s98, s98, s4
    v_mfma_f32_16x16x32_bf16 v[228:231], v[104:107], a[4:7], 0
    s_mul_i32 s10, s98, 3072
    ds_read_b128 v[104:107], v11 offset:19456
    v_mfma_f32_16x16x32_bf16 v[228:231], v[108:111], a[12:15], v[228:231]
    s_sub_u32 s99, s4, s61
    ds_read_b128 v[108:111], v11 offset:26624
    v_mfma_f32_16x16x32_bf16 v[176:179], v[112:115], a[16:19], v[176:179]
    s_and_b32 s99, s99, 3
    buffer_load_dwordx4 a[92:95], v5, s[40:43], s63 offen offset:3072 sc1
    v_mfma_f32_16x16x32_bf16 v[176:179], v[116:119], a[24:27], v[176:179]
    s_lshl3_add_u32 s98, s99, s5
    v_mfma_f32_16x16x32_bf16 v[180:183], v[112:115], a[20:23], v[180:183]
    s_xor_b32 s63, s63, 4096
    ds_read_b128 v[112:115], v11 offset:20480
    v_mfma_f32_16x16x32_bf16 v[180:183], v[116:119], a[28:31], v[180:183]
    s_and_b32 s98, s98, 31
    ds_read_b128 v[116:119], v11 offset:27648
    s_waitcnt lgkmcnt(3)
    v_mfma_f32_16x16x32_bf16 v[184:187], v[120:123], a[16:19], v[184:187]
    s_lshl_b32 s11, s6, 5
    v_mfma_f32_16x16x32_bf16 v[184:187], v[124:127], a[24:27], v[184:187]
    s_add_u32 s98, s98, s11
    buffer_store_dwordx4 v[80:83], v15, s[40:43], s71 offen offset:0 sc1
    v_mfma_f32_16x16x32_bf16 v[188:191], v[120:123], a[20:23], v[188:191]
    s_mul_i32 s98, s98, 3
    ds_read_b128 v[120:123], v11 offset:28672
    v_mfma_f32_16x16x32_bf16 v[188:191], v[124:127], a[28:31], v[188:191]
    s_sub_u32 s98, s98, s99
    ds_read_b128 v[124:127], v11 offset:35840
    v_mfma_f32_16x16x32_bf16 v[192:195], v[128:131], a[16:19], v[192:195]
    s_add_u32 s98, s98, 3
    v_mfma_f32_16x16x32_bf16 v[192:195], v[132:135], a[24:27], v[192:195]
    s_lshl2_add_u32 s98, s98, s4
    buffer_store_dwordx4 v[84:87], v15, s[40:43], s71 offen offset:256 sc1
    v_mfma_f32_16x16x32_bf16 v[196:199], v[128:131], a[20:23], v[196:199]
    s_mul_i32 s11, s98, 3072
    ds_read_b128 v[128:131], v11 offset:29696
    v_mfma_f32_16x16x32_bf16 v[196:199], v[132:135], a[28:31], v[196:199]
    ds_read_b128 v[132:135], v11 offset:36864
    v_mfma_f32_16x16x32_bf16 v[200:203], v[136:139], a[16:19], v[200:203]
    s_cmp_eq_u32 s99, 0
    s_cselect_b32 s11, 1073741824, s11
    v_mfma_f32_16x16x32_bf16 v[200:203], v[140:143], a[24:27], v[200:203]
    buffer_store_dwordx4 v[88:91], v15, s[40:43], s71 offen offset:512 sc1
    v_mfma_f32_16x16x32_bf16 v[204:207], v[136:139], a[20:23], v[204:207]
    ds_read_b128 v[136:139], v11 offset:30720
    v_mfma_f32_16x16x32_bf16 v[204:207], v[140:143], a[28:31], v[204:207]
    s_waitcnt vmcnt(11)
    ds_read_b128 v[140:143], v11 offset:37888
    v_mfma_f32_16x16x32_bf16 v[208:211], v[144:147], a[16:19], v[208:211]
    v_mfma_f32_16x16x32_bf16 v[208:211], v[148:151], a[24:27], v[208:211]
    buffer_load_dwordx4 a[96:99], v4, s[40:43], s63 offen offset:0 sc1
    v_mfma_f32_16x16x32_bf16 v[212:215], v[144:147], a[20:23], v[212:215]
    ds_read_b128 v[144:147], v11 offset:31744
    v_mfma_f32_16x16x32_bf16 v[212:215], v[148:151], a[28:31], v[212:215]
    ds_read_b128 v[148:151], v11 offset:38912
    v_mfma_f32_16x16x32_bf16 v[216:219], v[104:107], a[16:19], v[216:219]
    s_waitcnt lgkmcnt(2)
    v_mfma_f32_16x16x32_bf16 v[216:219], v[108:111], a[24:27], v[216:219]
    buffer_load_dwordx4 a[100:103], v5, s[40:43], s63 offen offset:0 sc1
    v_mfma_f32_16x16x32_bf16 v[220:223], v[104:107], a[20:23], v[220:223]
    ds_read_b128 v[104:107], v11 offset:32768
    v_mfma_f32_16x16x32_bf16 v[220:223], v[108:111], a[28:31], v[220:223]
    ds_read_b128 v[108:111], v11 offset:39936
    v_mfma_f32_16x16x32_bf16 v[224:227], v[112:115], a[16:19], v[224:227]
    v_mfma_f32_16x16x32_bf16 v[224:227], v[116:119], a[24:27], v[224:227]
    buffer_load_dwordx4 a[104:107], v4, s[40:43], s63 offen offset:1024 sc1
    v_mfma_f32_16x16x32_bf16 v[228:231], v[112:115], a[20:23], v[228:231]
    ds_read_b128 v[112:115], v11 offset:33792
    v_mfma_f32_16x16x32_bf16 v[228:231], v[116:119], a[28:31], v[228:231]
    ds_read_b128 v[116:119], v11 offset:40960
    v_mfma_f32_16x16x32_bf16 v[176:179], v[120:123], a[32:35], v[176:179]
    v_mfma_f32_16x16x32_bf16 v[176:179], v[124:127], a[40:43], v[176:179]
    buffer_load_dwordx4 a[108:111], v5, s[40:43], s63 offen offset:1024 sc1
    v_mfma_f32_16x16x32_bf16 v[180:183], v[120:123], a[36:39], v[180:183]
    ds_read_b128 v[120:123], v11 offset:34816
    v_mfma_f32_16x16x32_bf16 v[180:183], v[124:127], a[44:47], v[180:183]
    ds_read_b128 v[124:127], v11 offset:41984
    v_mfma_f32_16x16x32_bf16 v[184:187], v[128:131], a[32:35], v[184:187]
    v_mfma_f32_16x16x32_bf16 v[184:187], v[132:135], a[40:43], v[184:187]
    buffer_load_dwordx4 a[112:115], v4, s[40:43], s63 offen offset:2048 sc1
    v_mfma_f32_16x16x32_bf16 v[188:191], v[128:131], a[36:39], v[188:191]
    ds_read_b128 v[128:131], v11 offset:43008
    v_mfma_f32_16x16x32_bf16 v[188:191], v[132:135], a[44:47], v[188:191]
    ds_read_b128 v[132:135], v11 offset:50176
    v_mfma_f32_16x16x32_bf16 v[192:195], v[136:139], a[32:35], v[192:195]
    v_mfma_f32_16x16x32_bf16 v[192:195], v[140:143], a[40:43], v[192:195]
    v_mfma_f32_16x16x32_bf16 v[196:199], v[136:139], a[36:39], v[196:199]
    buffer_load_dwordx4 a[116:119], v5, s[40:43], s63 offen offset:2048 sc1
    v_mfma_f32_16x16x32_bf16 v[196:199], v[140:143], a[44:47], v[196:199]
    s_waitcnt lgkmcnt(1)
    ds_read_b128 v[136:139], v11 offset:44032
    ds_read_b128 v[140:143], v11 offset:51200
    v_mfma_f32_16x16x32_bf16 v[200:203], v[144:147], a[32:35], v[200:203]
    v_mfma_f32_16x16x32_bf16 v[200:203], v[148:151], a[40:43], v[200:203]
    v_mfma_f32_16x16x32_bf16 v[204:207], v[144:147], a[36:39], v[204:207]
    buffer_load_dwordx4 a[120:123], v4, s[40:43], s63 offen offset:3072 sc1
    v_mfma_f32_16x16x32_bf16 v[204:207], v[148:151], a[44:47], v[204:207]
    ds_read_b128 v[144:147], v11 offset:45056
    ds_read_b128 v[148:151], v11 offset:52224
    v_mfma_f32_16x16x32_bf16 v[208:211], v[104:107], a[32:35], v[208:211]
    v_mfma_f32_16x16x32_bf16 v[208:211], v[108:111], a[40:43], v[208:211]
    v_mfma_f32_16x16x32_bf16 v[212:215], v[104:107], a[36:39], v[212:215]
    buffer_load_dwordx4 a[124:127], v5, s[40:43], s63 offen offset:3072 sc1
    v_mfma_f32_16x16x32_bf16 v[212:215], v[108:111], a[44:47], v[212:215]
    s_xor_b32 s21, s3, 4
    ds_read_b128 v[104:107], v11 offset:46080
    ds_read_b128 v[108:111], v11 offset:53248
    v_mfma_f32_16x16x32_bf16 v[216:219], v[112:115], a[32:35], v[216:219]
    s_lshl2_add_u32 s21, s21, s4
    v_mfma_f32_16x16x32_bf16 v[216:219], v[116:119], a[40:43], v[216:219]
    s_mul_i32 s21, s21, 36864
    v_mfma_f32_16x16x32_bf16 v[220:223], v[112:115], a[36:39], v[220:223]
    s_add_u32 s64, s21, s17
    s_add_u32 m0, s78, 114688
    ds_read_b128 v[112:115], v11 offset:47104
    v_mfma_f32_16x16x32_bf16 v[220:223], v[116:119], a[44:47], v[220:223]
    s_xor_b32 s63, s63, 28672
    buffer_load_dwordx4 v1, s[56:59], s64 offen sc1 lds
    v_mfma_f32_16x16x32_bf16 v[224:227], v[120:123], a[32:35], v[224:227]
    ds_read_b128 v[116:119], v11 offset:54272
    v_mfma_f32_16x16x32_bf16 v[224:227], v[124:127], a[40:43], v[224:227]
    v_mfma_f32_16x16x32_bf16 v[228:231], v[120:123], a[36:39], v[228:231]
    buffer_load_dwordx4 v1, s[56:59], s64 offen offset:1024 sc1 lds
    v_mfma_f32_16x16x32_bf16 v[228:231], v[124:127], a[44:47], v[228:231]
    s_add_u32 s64, s21, s18
    ds_read_b128 v[120:123], v11 offset:48128
    ds_read_b128 v[124:127], v11 offset:55296
    v_mfma_f32_16x16x32_bf16 v[176:179], v[128:131], a[48:51], v[176:179]
    s_add_u32 m0, s78, 116736
    s_waitcnt lgkmcnt(3)
    v_mfma_f32_16x16x32_bf16 v[176:179], v[132:135], a[56:59], v[176:179]
    v_mfma_f32_16x16x32_bf16 v[180:183], v[128:131], a[52:55], v[180:183]
    buffer_load_dwordx4 v1, s[56:59], s64 offen sc1 lds
    v_mfma_f32_16x16x32_bf16 v[180:183], v[132:135], a[60:63], v[180:183]
    ds_read_b128 v[128:131], v11 offset:49152
    ds_read_b128 v[132:135], v11 offset:56320
    v_mfma_f32_16x16x32_bf16 v[184:187], v[136:139], a[48:51], v[184:187]
    v_mfma_f32_16x16x32_bf16 v[184:187], v[140:143], a[56:59], v[184:187]
    v_mfma_f32_16x16x32_bf16 v[188:191], v[136:139], a[52:55], v[188:191]
    buffer_load_dwordx4 v1, s[56:59], s64 offen offset:1024 sc1 lds
    v_mfma_f32_16x16x32_bf16 v[188:191], v[140:143], a[60:63], v[188:191]
    s_add_u32 s64, s21, s19
    ds_read_b128 v[136:139], v11 offset:57344
    ds_read_b128 v[140:143], v11 offset:64512
    v_mfma_f32_16x16x32_bf16 v[192:195], v[144:147], a[48:51], v[192:195]
    s_add_u32 m0, s78, 118784
    v_mfma_f32_16x16x32_bf16 v[192:195], v[148:151], a[56:59], v[192:195]
    v_mfma_f32_16x16x32_bf16 v[196:199], v[144:147], a[52:55], v[196:199]
    buffer_load_dwordx4 v1, s[56:59], s64 offen sc1 lds
    v_mfma_f32_16x16x32_bf16 v[196:199], v[148:151], a[60:63], v[196:199]
    ds_read_b128 v[144:147], v11 offset:58368
    ds_read_b128 v[148:151], v12 offset:0
    v_mfma_f32_16x16x32_bf16 v[200:203], v[104:107], a[48:51], v[200:203]
    v_mfma_f32_16x16x32_bf16 v[200:203], v[108:111], a[56:59], v[200:203]
    v_mfma_f32_16x16x32_bf16 v[204:207], v[104:107], a[52:55], v[204:207]
    ds_read_b128 v[104:107], v11 offset:59392
    v_mfma_f32_16x16x32_bf16 v[204:207], v[108:111], a[60:63], v[204:207]
    s_waitcnt vmcnt(16)
    s_barrier
    ds_read_b128 v[108:111], v12 offset:1024
    v_mfma_f32_16x16x32_bf16 v[208:211], v[112:115], a[48:51], v[208:211]
    s_waitcnt lgkmcnt(2)
    buffer_load_dwordx4 v1, s[56:59], s64 offen offset:1024 sc1 lds
    v_mfma_f32_16x16x32_bf16 v[208:211], v[116:119], a[56:59], v[208:211]
    s_add_u32 s64, s21, s20
    v_mfma_f32_16x16x32_bf16 v[212:215], v[112:115], a[52:55], v[212:215]
    s_add_u32 m0, s78, 120832
    ds_read_b128 v[112:115], v11 offset:60416
    v_mfma_f32_16x16x32_bf16 v[212:215], v[116:119], a[60:63], v[212:215]
    buffer_load_dwordx4 v1, s[56:59], s64 offen sc1 lds
    v_mfma_f32_16x16x32_bf16 v[216:219], v[120:123], a[48:51], v[216:219]
    ds_read_b128 v[116:119], v12 offset:2048
    v_mfma_f32_16x16x32_bf16 v[216:219], v[124:127], a[56:59], v[216:219]
    v_mfma_f32_16x16x32_bf16 v[220:223], v[120:123], a[52:55], v[220:223]
    ds_read_b128 v[120:123], v11 offset:61440
    v_mfma_f32_16x16x32_bf16 v[220:223], v[124:127], a[60:63], v[220:223]
    buffer_load_dwordx4 a[128:131], v4, s[40:43], s63 offen offset:0 sc1
    v_mfma_f32_16x16x32_bf16 v[224:227], v[128:131], a[48:51], v[224:227]
    ds_read_b128 v[124:127], v12 offset:3072
    v_mfma_f32_16x16x32_bf16 v[224:227], v[132:135], a[56:59], v[224:227]
    v_mfma_f32_16x16x32_bf16 v[228:231], v[128:131], a[52:55], v[228:231]
    ds_read_b128 v[128:131], v11 offset:62464
    v_mfma_f32_16x16x32_bf16 v[228:231], v[132:135], a[60:63], v[228:231]
    buffer_load_dwordx4 a[132:135], v5, s[40:43], s63 offen offset:0 sc1
    v_mfma_f32_16x16x32_bf16 v[176:179], v[136:139], a[64:67], v[176:179]
    ds_read_b128 v[132:135], v12 offset:4096
    v_mfma_f32_16x16x32_bf16 v[176:179], v[140:143], a[72:75], v[176:179]
    v_mfma_f32_16x16x32_bf16 v[180:183], v[136:139], a[68:71], v[180:183]
    ds_read_b128 v[136:139], v11 offset:63488
    v_mfma_f32_16x16x32_bf16 v[180:183], v[140:143], a[76:79], v[180:183]
    buffer_load_dwordx4 a[136:139], v4, s[40:43], s63 offen offset:1024 sc1
    v_mfma_f32_16x16x32_bf16 v[184:187], v[144:147], a[64:67], v[184:187]
    ds_read_b128 v[140:143], v12 offset:5120
    v_mfma_f32_16x16x32_bf16 v[184:187], v[148:151], a[72:75], v[184:187]
    v_mfma_f32_16x16x32_bf16 v[188:191], v[144:147], a[68:71], v[188:191]
    ds_read_b128 v[144:147], v12 offset:6144
    v_mfma_f32_16x16x32_bf16 v[188:191], v[148:151], a[76:79], v[188:191]
    s_waitcnt lgkmcnt(2)
    buffer_load_dwordx4 a[140:143], v5, s[40:43], s63 offen offset:1024 sc1
    v_mfma_f32_16x16x32_bf16 v[192:195], v[104:107], a[64:67], v[192:195]
    ds_read_b128 v[148:151], v12 offset:13312
    v_mfma_f32_16x16x32_bf16 v[192:195], v[108:111], a[72:75], v[192:195]
    v_mfma_f32_16x16x32_bf16 v[196:199], v[104:107], a[68:71], v[196:199]
    ds_read_b128 v[104:107], v12 offset:7168
    v_mfma_f32_16x16x32_bf16 v[196:199], v[108:111], a[76:79], v[196:199]
    buffer_load_dwordx4 a[144:147], v4, s[40:43], s63 offen offset:2048 sc1
    v_mfma_f32_16x16x32_bf16 v[200:203], v[112:115], a[64:67], v[200:203]
    ds_read_b128 v[108:111], v12 offset:14336
    v_mfma_f32_16x16x32_bf16 v[200:203], v[116:119], a[72:75], v[200:203]
    v_mfma_f32_16x16x32_bf16 v[204:207], v[112:115], a[68:71], v[204:207]
    ds_read_b128 v[112:115], v12 offset:8192
    v_mfma_f32_16x16x32_bf16 v[204:207], v[116:119], a[76:79], v[204:207]
    buffer_load_dwordx4 a[148:151], v5, s[40:43], s63 offen offset:2048 sc1
    v_mfma_f32_16x16x32_bf16 v[208:211], v[120:123], a[64:67], v[208:211]
    ds_read_b128 v[116:119], v12 offset:15360
    v_mfma_f32_16x16x32_bf16 v[208:211], v[124:127], a[72:75], v[208:211]
    v_mfma_f32_16x16x32_bf16 v[212:215], v[120:123], a[68:71], v[212:215]
    ds_read_b128 v[120:123], v12 offset:9216
    v_mfma_f32_16x16x32_bf16 v[212:215], v[124:127], a[76:79], v[212:215]
    ds_read_b128 v[124:127], v12 offset:16384
    v_mfma_f32_16x16x32_bf16 v[216:219], v[128:131], a[64:67], v[216:219]
    buffer_load_dwordx4 a[152:155], v4, s[40:43], s63 offen offset:3072 sc1
    v_mfma_f32_16x16x32_bf16 v[216:219], v[132:135], a[72:75], v[216:219]
    v_mfma_f32_16x16x32_bf16 v[220:223], v[128:131], a[68:71], v[220:223]
    ds_read_b128 v[128:131], v12 offset:10240
    v_mfma_f32_16x16x32_bf16 v[220:223], v[132:135], a[76:79], v[220:223]
    ds_read_b128 v[132:135], v12 offset:17408
    v_mfma_f32_16x16x32_bf16 v[224:227], v[136:139], a[64:67], v[224:227]
    s_waitcnt lgkmcnt(2)
    buffer_load_dwordx4 a[156:159], v5, s[40:43], s63 offen offset:3072 sc1
    v_mfma_f32_16x16x32_bf16 v[224:227], v[140:143], a[72:75], v[224:227]
    s_xor_b32 s21, s3, 5
    v_mfma_f32_16x16x32_bf16 v[228:231], v[136:139], a[68:71], v[228:231]
    s_lshl2_add_u32 s21, s21, s4
    ds_read_b128 v[136:139], v12 offset:11264
    v_mfma_f32_16x16x32_bf16 v[228:231], v[140:143], a[76:79], v[228:231]
    s_mul_i32 s21, s21, 36864
    ds_read_b128 v[140:143], v12 offset:18432
    v_mfma_f32_16x16x32_bf16 v[176:179], v[144:147], a[80:83], v[176:179]
    s_add_u32 s64, s21, s17
    s_add_u32 m0, s78, 0
    v_mfma_f32_16x16x32_bf16 v[176:179], v[148:151], a[88:91], v[176:179]
    s_xor_b32 s63, s63, 4096
    buffer_load_dwordx4 v1, s[56:59], s64 offen sc1 lds
    v_mfma_f32_16x16x32_bf16 v[180:183], v[144:147], a[84:87], v[180:183]
    ds_read_b128 v[144:147], v12 offset:12288
    v_mfma_f32_16x16x32_bf16 v[180:183], v[148:151], a[92:95], v[180:183]
    ds_read_b128 v[148:151], v12 offset:19456
    v_mfma_f32_16x16x32_bf16 v[184:187], v[104:107], a[80:83], v[184:187]
    buffer_load_dwordx4 v1, s[56:59], s64 offen offset:1024 sc1 lds
    v_mfma_f32_16x16x32_bf16 v[184:187], v[108:111], a[88:91], v[184:187]
    s_add_u32 s64, s21, s18
    v_mfma_f32_16x16x32_bf16 v[188:191], v[104:107], a[84:87], v[188:191]
    s_add_u32 m0, s78, 2048
    ds_read_b128 v[104:107], v12 offset:20480
    v_mfma_f32_16x16x32_bf16 v[188:191], v[108:111], a[92:95], v[188:191]
    ds_read_b128 v[108:111], v12 offset:27648
    v_mfma_f32_16x16x32_bf16 v[192:195], v[112:115], a[80:83], v[192:195]
    buffer_load_dwordx4 v1, s[56:59], s64 offen sc1 lds
    v_mfma_f32_16x16x32_bf16 v[192:195], v[116:119], a[88:91], v[192:195]
    v_mfma_f32_16x16x32_bf16 v[196:199], v[112:115], a[84:87], v[196:199]
    ds_read_b128 v[112:115], v12 offset:21504
    v_mfma_f32_16x16x32_bf16 v[196:199], v[116:119], a[92:95], v[196:199]
    ds_read_b128 v[116:119], v12 offset:28672
    v_mfma_f32_16x16x32_bf16 v[200:203], v[120:123], a[80:83], v[200:203]
    buffer_load_dwordx4 v1, s[56:59], s64 offen offset:1024 sc1 lds
    v_mfma_f32_16x16x32_bf16 v[200:203], v[124:127], a[88:91], v[200:203]
    s_add_u32 s64, s21, s19
    v_mfma_f32_16x16x32_bf16 v[204:207], v[120:123], a[84:87], v[204:207]
    s_add_u32 m0, s78, 4096
    ds_read_b128 v[120:123], v12 offset:22528
    v_mfma_f32_16x16x32_bf16 v[204:207], v[124:127], a[92:95], v[204:207]
    s_waitcnt vmcnt(19)
    s_barrier
    v_mov_b32 v31, 3
    s_waitcnt lgkmcnt(2)
    v_mfma_f32_16x16x32_bf16 v[208:211], v[128:131], a[80:83], v[208:211]
    buffer_load_dwordx4 v1, s[56:59], s64 offen sc1 lds
    v_mfma_f32_16x16x32_bf16 v[208:211], v[132:135], a[88:91], v[208:211]
    buffer_store_dword v31, v30, s[32:35], s101 offen sc1
    v_mfma_f32_16x16x32_bf16 v[212:215], v[128:131], a[84:87], v[212:215]
    ds_read_b128 v[124:127], v12 offset:29696
    ds_read_b128 v[128:131], v12 offset:23552
    v_mfma_f32_16x16x32_bf16 v[212:215], v[132:135], a[92:95], v[212:215]
    ds_read_b128 v[132:135], v12 offset:30720
    v_mfma_f32_16x16x32_bf16 v[216:219], v[136:139], a[80:83], v[216:219]
    v_mfma_f32_16x16x32_bf16 v[216:219], v[140:143], a[88:91], v[216:219]
    buffer_load_dwordx4 v1, s[56:59], s64 offen offset:1024 sc1 lds
    v_mfma_f32_16x16x32_bf16 v[220:223], v[136:139], a[84:87], v[220:223]
    s_add_u32 s64, s21, s20
    ds_read_b128 v[136:139], v12 offset:24576
    v_mfma_f32_16x16x32_bf16 v[220:223], v[140:143], a[92:95], v[220:223]
    s_add_u32 m0, s78, 6144
    ds_read_b128 v[140:143], v12 offset:31744
    v_mfma_f32_16x16x32_bf16 v[224:227], v[144:147], a[80:83], v[224:227]
    v_mfma_f32_16x16x32_bf16 v[224:227], v[148:151], a[88:91], v[224:227]
    buffer_load_dwordx4 v1, s[56:59], s64 offen sc1 lds
    v_mfma_f32_16x16x32_bf16 v[228:231], v[144:147], a[84:87], v[228:231]
    ds_read_b128 v[144:147], v12 offset:25600
    v_mfma_f32_16x16x32_bf16 v[228:231], v[148:151], a[92:95], v[228:231]
    ds_read_b128 v[148:151], v12 offset:32768
    v_mfma_f32_16x16x32_bf16 v[176:179], v[104:107], a[96:99], v[176:179]
    v_mfma_f32_16x16x32_bf16 v[176:179], v[108:111], a[104:107], v[176:179]
    buffer_load_dwordx4 a[160:163], v4, s[40:43], s63 offen offset:0 sc1
    v_mfma_f32_16x16x32_bf16 v[180:183], v[104:107], a[100:103], v[180:183]
    ds_read_b128 v[104:107], v12 offset:26624
    v_mfma_f32_16x16x32_bf16 v[180:183], v[108:111], a[108:111], v[180:183]
    ds_read_b128 v[108:111], v12 offset:33792
    v_mfma_f32_16x16x32_bf16 v[184:187], v[112:115], a[96:99], v[184:187]
    s_waitcnt lgkmcnt(2)
    v_mfma_f32_16x16x32_bf16 v[184:187], v[116:119], a[104:107], v[184:187]
    buffer_load_dwordx4 a[164:167], v5, s[40:43], s63 offen offset:0 sc1
    v_mfma_f32_16x16x32_bf16 v[188:191], v[112:115], a[100:103], v[188:191]
    ds_read_b128 v[112:115], v12 offset:34816
    v_mfma_f32_16x16x32_bf16 v[188:191], v[116:119], a[108:111], v[188:191]
    ds_read_b128 v[116:119], v12 offset:41984
    v_mfma_f32_16x16x32_bf16 v[192:195], v[120:123], a[96:99], v[192:195]
    v_mfma_f32_16x16x32_bf16 v[192:195], v[124:127], a[104:107], v[192:195]
    buffer_load_dwordx4 a[168:171], v4, s[40:43], s63 offen offset:1024 sc1
    v_mfma_f32_16x16x32_bf16 v[196:199], v[120:123], a[100:103], v[196:199]
    ds_read_b128 v[120:123], v12 offset:35840
    v_mfma_f32_16x16x32_bf16 v[196:199], v[124:127], a[108:111], v[196:199]
    ds_read_b128 v[124:127], v12 offset:43008
    v_mfma_f32_16x16x32_bf16 v[200:203], v[128:131], a[96:99], v[200:203]
    v_mfma_f32_16x16x32_bf16 v[200:203], v[132:135], a[104:107], v[200:203]
    buffer_load_dwordx4 a[172:175], v5, s[40:43], s63 offen offset:1024 sc1
    v_mfma_f32_16x16x32_bf16 v[204:207], v[128:131], a[100:103], v[204:207]
    ds_read_b128 v[128:131], v12 offset:36864
    v_mfma_f32_16x16x32_bf16 v[204:207], v[132:135], a[108:111], v[204:207]
    ds_read_b128 v[132:135], v12 offset:44032
    v_mfma_f32_16x16x32_bf16 v[208:211], v[136:139], a[96:99], v[208:211]
    v_mfma_f32_16x16x32_bf16 v[208:211], v[140:143], a[104:107], v[208:211]
    buffer_load_dwordx4 a[176:179], v4, s[40:43], s63 offen offset:2048 sc1
    v_mfma_f32_16x16x32_bf16 v[212:215], v[136:139], a[100:103], v[212:215]
    ds_read_b128 v[136:139], v12 offset:37888
    v_mfma_f32_16x16x32_bf16 v[212:215], v[140:143], a[108:111], v[212:215]
    ds_read_b128 v[140:143], v12 offset:45056
    v_mfma_f32_16x16x32_bf16 v[216:219], v[144:147], a[96:99], v[216:219]
    v_mfma_f32_16x16x32_bf16 v[216:219], v[148:151], a[104:107], v[216:219]
    buffer_load_dwordx4 a[180:183], v5, s[40:43], s63 offen offset:2048 sc1
    v_mfma_f32_16x16x32_bf16 v[220:223], v[144:147], a[100:103], v[220:223]
    ds_read_b128 v[144:147], v12 offset:38912
    v_mfma_f32_16x16x32_bf16 v[220:223], v[148:151], a[108:111], v[220:223]
    s_waitcnt lgkmcnt(2)
    ds_read_b128 v[148:151], v12 offset:46080
    v_mfma_f32_16x16x32_bf16 v[224:227], v[104:107], a[96:99], v[224:227]
    v_mfma_f32_16x16x32_bf16 v[224:227], v[108:111], a[104:107], v[224:227]
    buffer_load_dwordx4 a[184:187], v4, s[40:43], s63 offen offset:3072 sc1
    v_mfma_f32_16x16x32_bf16 v[228:231], v[104:107], a[100:103], v[228:231]
    ds_read_b128 v[104:107], v12 offset:39936
    v_mfma_f32_16x16x32_bf16 v[228:231], v[108:111], a[108:111], v[228:231]
    ds_read_b128 v[108:111], v12 offset:47104
    v_mfma_f32_16x16x32_bf16 v[176:179], v[112:115], a[112:115], v[176:179]
    v_mfma_f32_16x16x32_bf16 v[176:179], v[116:119], a[120:123], v[176:179]
    v_mfma_f32_16x16x32_bf16 v[180:183], v[112:115], a[116:119], v[180:183]
    buffer_load_dwordx4 a[188:191], v5, s[40:43], s63 offen offset:3072 sc1
    v_mfma_f32_16x16x32_bf16 v[180:183], v[116:119], a[124:127], v[180:183]
    s_xor_b32 s21, s3, 6
    ds_read_b128 v[112:115], v12 offset:40960
    ds_read_b128 v[116:119], v12 offset:48128
    v_mfma_f32_16x16x32_bf16 v[184:187], v[120:123], a[112:115], v[184:187]
    s_lshl2_add_u32 s21, s21, s4
    v_mfma_f32_16x16x32_bf16 v[184:187], v[124:127], a[120:123], v[184:187]
    s_mul_i32 s21, s21, 36864
    v_mfma_f32_16x16x32_bf16 v[188:191], v[120:123], a[116:119], v[188:191]
    s_add_u32 s64, s21, s17
    s_add_u32 m0, s78, 28672
    v_mfma_f32_16x16x32_bf16 v[188:191], v[124:127], a[124:127], v[188:191]
    s_xor_b32 s63, s63, 12288
    buffer_load_dwordx4 v1, s[56:59], s64 offen sc1 lds
    v_mfma_f32_16x16x32_bf16 v[192:195], v[128:131], a[112:115], v[192:195]
    v_mfma_f32_16x16x32_bf16 v[192:195], v[132:135], a[120:123], v[192:195]
    v_mfma_f32_16x16x32_bf16 v[196:199], v[128:131], a[116:119], v[196:199]
    buffer_load_dwordx4 v1, s[56:59], s64 offen offset:1024 sc1 lds
    v_mfma_f32_16x16x32_bf16 v[196:199], v[132:135], a[124:127], v[196:199]
    s_add_u32 s64, s21, s18
    v_mfma_f32_16x16x32_bf16 v[200:203], v[136:139], a[112:115], v[200:203]
    s_add_u32 m0, s78, 30720
    s_waitcnt lgkmcnt(0)
    v_mfma_f32_16x16x32_bf16 v[200:203], v[140:143], a[120:123], v[200:203]
    v_mfma_f32_16x16x32_bf16 v[204:207], v[136:139], a[116:119], v[204:207]
    buffer_load_dwordx4 v1, s[56:59], s64 offen sc1 lds
    v_mfma_f32_16x16x32_bf16 v[204:207], v[140:143], a[124:127], v[204:207]
    s_waitcnt vmcnt(19)
    s_barrier
    ds_read_b128 v[120:123], v12 offset:49152
    v_mfma_f32_16x16x32_bf16 v[208:211], v[144:147], a[112:115], v[208:211]
    ds_read_b128 v[124:127], v12 offset:56320
    ds_read_b128 v[128:131], v12 offset:50176
    v_mfma_f32_16x16x32_bf16 v[208:211], v[148:151], a[120:123], v[208:211]
    ds_read_b128 v[132:135], v12 offset:57344
    v_mfma_f32_16x16x32_bf16 v[212:215], v[144:147], a[116:119], v[212:215]
    buffer_load_dwordx4 v1, s[56:59], s64 offen offset:1024 sc1 lds
    v_mfma_f32_16x16x32_bf16 v[212:215], v[148:151], a[124:127], v[212:215]
    s_add_u32 s64, s21, s19
    ds_read_b128 v[136:139], v12 offset:51200
    ds_read_b128 v[140:143], v12 offset:58368
    v_mfma_f32_16x16x32_bf16 v[216:219], v[104:107], a[112:115], v[216:219]
    s_add_u32 m0, s78, 32768
    ds_read_b128 v[144:147], v12 offset:52224
    v_mfma_f32_16x16x32_bf16 v[216:219], v[108:111], a[120:123], v[216:219]
    ds_read_b128 v[148:151], v12 offset:59392
    v_mfma_f32_16x16x32_bf16 v[220:223], v[104:107], a[116:119], v[220:223]
    buffer_load_dwordx4 v1, s[56:59], s64 offen sc1 lds
    v_mfma_f32_16x16x32_bf16 v[220:223], v[108:111], a[124:127], v[220:223]
    ds_read_b128 v[104:107], v12 offset:53248
    ds_read_b128 v[108:111], v12 offset:60416
    v_mfma_f32_16x16x32_bf16 v[224:227], v[112:115], a[112:115], v[224:227]
    v_mfma_f32_16x16x32_bf16 v[224:227], v[116:119], a[120:123], v[224:227]
    v_mfma_f32_16x16x32_bf16 v[228:231], v[112:115], a[116:119], v[228:231]
    buffer_load_dwordx4 v1, s[56:59], s64 offen offset:1024 sc1 lds
    v_mfma_f32_16x16x32_bf16 v[228:231], v[116:119], a[124:127], v[228:231]
    s_add_u32 s64, s21, s20
    ds_read_b128 v[112:115], v12 offset:54272
    ds_read_b128 v[116:119], v12 offset:61440
    s_waitcnt lgkmcnt(4)
    v_mfma_f32_16x16x32_bf16 v[176:179], v[120:123], a[128:131], v[176:179]
    s_add_u32 m0, s78, 34816
    v_mfma_f32_16x16x32_bf16 v[176:179], v[124:127], a[136:139], v[176:179]
    v_mfma_f32_16x16x32_bf16 v[180:183], v[120:123], a[132:135], v[180:183]
    buffer_load_dwordx4 v1, s[56:59], s64 offen sc1 lds
    v_mfma_f32_16x16x32_bf16 v[180:183], v[124:127], a[140:143], v[180:183]
    ds_read_b128 v[120:123], v12 offset:55296
    ds_read_b128 v[124:127], v12 offset:62464
    v_mfma_f32_16x16x32_bf16 v[184:187], v[128:131], a[128:131], v[184:187]
    v_mfma_f32_16x16x32_bf16 v[184:187], v[132:135], a[136:139], v[184:187]
    v_mfma_f32_16x16x32_bf16 v[188:191], v[128:131], a[132:135], v[188:191]
    ds_read_b128 v[128:131], v12 offset:63488
    v_mfma_f32_16x16x32_bf16 v[188:191], v[132:135], a[140:143], v[188:191]
    buffer_load_dwordx4 a[192:195], v4, s[40:43], s63 offen offset:0 sc1
    v_mfma_f32_16x16x32_bf16 v[192:195], v[136:139], a[128:131], v[192:195]
    ds_read_b128 v[132:135], v13 offset:5120
    v_mfma_f32_16x16x32_bf16 v[192:195], v[140:143], a[136:139], v[192:195]
    v_mfma_f32_16x16x32_bf16 v[196:199], v[136:139], a[132:135], v[196:199]
    ds_read_b128 v[136:139], v12 offset:64512
    v_mfma_f32_16x16x32_bf16 v[196:199], v[140:143], a[140:143], v[196:199]
    buffer_load_dwordx4 a[196:199], v5, s[40:43], s63 offen offset:0 sc1
    v_mfma_f32_16x16x32_bf16 v[200:203], v[144:147], a[128:131], v[200:203]
    ds_read_b128 v[140:143], v13 offset:6144
    v_mfma_f32_16x16x32_bf16 v[200:203], v[148:151], a[136:139], v[200:203]
    v_mfma_f32_16x16x32_bf16 v[204:207], v[144:147], a[132:135], v[204:207]
    ds_read_b128 v[144:147], v13 offset:0
    v_mfma_f32_16x16x32_bf16 v[204:207], v[148:151], a[140:143], v[204:207]
    s_waitcnt lgkmcnt(2)
    buffer_load_dwordx4 a[200:203], v4, s[40:43], s63 offen offset:1024 sc1
    v_mfma_f32_16x16x32_bf16 v[208:211], v[104:107], a[128:131], v[208:211]
    ds_read_b128 v[148:151], v13 offset:7168
    v_mfma_f32_16x16x32_bf16 v[208:211], v[108:111], a[136:139], v[208:211]
    v_mfma_f32_16x16x32_bf16 v[212:215], v[104:107], a[132:135], v[212:215]
    ds_read_b128 v[104:107], v13 offset:1024
    v_mfma_f32_16x16x32_bf16 v[212:215], v[108:111], a[140:143], v[212:215]
    buffer_load_dwordx4 a[204:207], v5, s[40:43], s63 offen offset:1024 sc1
    v_mfma_f32_16x16x32_bf16 v[216:219], v[112:115], a[128:131], v[216:219]
    ds_read_b128 v[108:111], v13 offset:8192
    v_mfma_f32_16x16x32_bf16 v[216:219], v[116:119], a[136:139], v[216:219]
    v_mfma_f32_16x16x32_bf16 v[220:223], v[112:115], a[132:135], v[220:223]
    ds_read_b128 v[112:115], v13 offset:2048
    v_mfma_f32_16x16x32_bf16 v[220:223], v[116:119], a[140:143], v[220:223]
    buffer_load_dwordx4 a[208:211], v4, s[40:43], s63 offen offset:2048 sc1
    v_mfma_f32_16x16x32_bf16 v[224:227], v[120:123], a[128:131], v[224:227]
    ds_read_b128 v[116:119], v13 offset:9216
    v_mfma_f32_16x16x32_bf16 v[224:227], v[124:127], a[136:139], v[224:227]
    v_mfma_f32_16x16x32_bf16 v[228:231], v[120:123], a[132:135], v[228:231]
    ds_read_b128 v[120:123], v13 offset:3072
    v_mfma_f32_16x16x32_bf16 v[228:231], v[124:127], a[140:143], v[228:231]
    buffer_load_dwordx4 a[212:215], v5, s[40:43], s63 offen offset:2048 sc1
    v_mfma_f32_16x16x32_bf16 v[176:179], v[128:131], a[144:147], v[176:179]
    ds_read_b128 v[124:127], v13 offset:10240
    v_mfma_f32_16x16x32_bf16 v[176:179], v[132:135], a[152:155], v[176:179]
    v_mfma_f32_16x16x32_bf16 v[180:183], v[128:131], a[148:151], v[180:183]
    ds_read_b128 v[128:131], v13 offset:4096
    v_mfma_f32_16x16x32_bf16 v[180:183], v[132:135], a[156:159], v[180:183]
    buffer_load_dwordx4 a[216:219], v4, s[40:43], s63 offen offset:3072 sc1
    v_mfma_f32_16x16x32_bf16 v[184:187], v[136:139], a[144:147], v[184:187]
    s_waitcnt lgkmcnt(2)
    ds_read_b128 v[132:135], v13 offset:11264
    v_mfma_f32_16x16x32_bf16 v[184:187], v[140:143], a[152:155], v[184:187]
    v_mfma_f32_16x16x32_bf16 v[188:191], v[136:139], a[148:151], v[188:191]
    v_mfma_f32_16x16x32_bf16 v[188:191], v[140:143], a[156:159], v[188:191]
    buffer_load_dwordx4 a[220:223], v5, s[40:43], s63 offen offset:3072 sc1
    v_mfma_f32_16x16x32_bf16 v[192:195], v[144:147], a[144:147], v[192:195]
    v_mfma_f32_16x16x32_bf16 v[192:195], v[148:151], a[152:155], v[192:195]
    s_xor_b32 s63, s63, 4096
    v_mfma_f32_16x16x32_bf16 v[196:199], v[144:147], a[148:151], v[196:199]
    v_mfma_f32_16x16x32_bf16 v[196:199], v[148:151], a[156:159], v[196:199]
    v_mfma_f32_16x16x32_bf16 v[200:203], v[104:107], a[144:147], v[200:203]
    buffer_load_dword v3, v19, s[32:35], s66 offen sc1
    v_mfma_f32_16x16x32_bf16 v[200:203], v[108:111], a[152:155], v[200:203]
    s_xor_b32 s21, s3, 7
    v_mfma_f32_16x16x32_bf16 v[204:207], v[104:107], a[148:151], v[204:207]
    s_lshl2_add_u32 s21, s21, s4
    v_mfma_f32_16x16x32_bf16 v[204:207], v[108:111], a[156:159], v[204:207]
    s_mul_i32 s21, s21, 36864
    s_waitcnt vmcnt(16)
    s_barrier
    v_mfma_f32_16x16x32_bf16 v[208:211], v[112:115], a[144:147], v[208:211]
    s_add_u32 s64, s21, s17
    s_add_u32 m0, s78, 57344
    ds_read_b128 v[136:139], v11 offset:0
    v_mfma_f32_16x16x32_bf16 v[208:211], v[116:119], a[152:155], v[208:211]
    buffer_load_dwordx4 v1, s[56:59], s64 offen sc1 lds
    v_mfma_f32_16x16x32_bf16 v[212:215], v[112:115], a[148:151], v[212:215]
    ds_read_b128 v[140:143], v11 offset:7168
    ds_read_b128 v[144:147], v11 offset:1024
    v_mfma_f32_16x16x32_bf16 v[212:215], v[116:119], a[156:159], v[212:215]
    ds_read_b128 v[148:151], v11 offset:8192
    v_mfma_f32_16x16x32_bf16 v[216:219], v[120:123], a[144:147], v[216:219]
    s_waitcnt lgkmcnt(4)
    buffer_load_dwordx4 v1, s[56:59], s64 offen offset:1024 sc1 lds
    v_mfma_f32_16x16x32_bf16 v[216:219], v[124:127], a[152:155], v[216:219]
    s_add_u32 s64, s21, s18
    ds_read_b128 v[104:107], v11 offset:2048
    ds_read_b128 v[108:111], v11 offset:9216
    v_mfma_f32_16x16x32_bf16 v[220:223], v[120:123], a[148:151], v[220:223]
    s_add_u32 m0, s78, 59392
    ds_read_b128 v[112:115], v11 offset:3072
    v_mfma_f32_16x16x32_bf16 v[220:223], v[124:127], a[156:159], v[220:223]
    ds_read_b128 v[116:119], v11 offset:10240
    v_mfma_f32_16x16x32_bf16 v[224:227], v[128:131], a[144:147], v[224:227]
    buffer_load_dwordx4 v1, s[56:59], s64 offen sc1 lds
    v_mfma_f32_16x16x32_bf16 v[224:227], v[132:135], a[152:155], v[224:227]
    ds_read_b128 v[120:123], v11 offset:4096
    ds_read_b128 v[124:127], v11 offset:11264
    v_mfma_f32_16x16x32_bf16 v[228:231], v[128:131], a[148:151], v[228:231]
    ds_read_b128 v[128:131], v11 offset:5120
    v_mfma_f32_16x16x32_bf16 v[228:231], v[132:135], a[156:159], v[228:231]
    s_waitcnt lgkmcnt(4)
    ds_read_b128 v[132:135], v11 offset:12288
    v_mfma_f32_16x16x32_bf16 v[176:179], v[136:139], a[160:163], v[176:179]
    buffer_load_dwordx4 v1, s[56:59], s64 offen offset:1024 sc1 lds
    v_mfma_f32_16x16x32_bf16 v[176:179], v[140:143], a[168:171], v[176:179]
    s_add_u32 s64, s21, s19
    v_mfma_f32_16x16x32_bf16 v[180:183], v[136:139], a[164:167], v[180:183]
    s_add_u32 m0, s78, 61440
    ds_read_b128 v[136:139], v11 offset:6144
    v_mfma_f32_16x16x32_bf16 v[180:183], v[140:143], a[172:175], v[180:183]
    ds_read_b128 v[140:143], v11 offset:13312
    v_mfma_f32_16x16x32_bf16 v[184:187], v[144:147], a[160:163], v[184:187]
    buffer_load_dwordx4 v1, s[56:59], s64 offen sc1 lds
    v_mfma_f32_16x16x32_bf16 v[184:187], v[148:151], a[168:171], v[184:187]
    v_mfma_f32_16x16x32_bf16 v[188:191], v[144:147], a[164:167], v[188:191]
    ds_read_b128 v[144:147], v11 offset:14336
    v_mfma_f32_16x16x32_bf16 v[188:191], v[148:151], a[172:175], v[188:191]
    ds_read_b128 v[148:151], v11 offset:21504
    v_mfma_f32_16x16x32_bf16 v[192:195], v[104:107], a[160:163], v[192:195]
    buffer_load_dwordx4 v1, s[56:59], s64 offen offset:1024 sc1 lds
    v_mfma_f32_16x16x32_bf16 v[192:195], v[108:111], a[168:171], v[192:195]
    s_add_u32 s64, s21, s20
    v_mfma_f32_16x16x32_bf16 v[196:199], v[104:107], a[164:167], v[196:199]
    s_add_u32 m0, s78, 63488
    ds_read_b128 v[104:107], v11 offset:15360
    v_mfma_f32_16x16x32_bf16 v[196:199], v[108:111], a[172:175], v[196:199]
    ds_read_b128 v[108:111], v11 offset:22528
    v_mfma_f32_16x16x32_bf16 v[200:203], v[112:115], a[160:163], v[200:203]
    s_waitcnt lgkmcnt(2)
    buffer_load_dwordx4 v1, s[56:59], s64 offen sc1 lds
    v_mfma_f32_16x16x32_bf16 v[200:203], v[116:119], a[168:171], v[200:203]
    v_mfma_f32_16x16x32_bf16 v[204:207], v[112:115], a[164:167], v[204:207]
    ds_read_b128 v[112:115], v11 offset:16384
    v_mfma_f32_16x16x32_bf16 v[204:207], v[116:119], a[172:175], v[204:207]
    ds_read_b128 v[116:119], v11 offset:23552
    v_mfma_f32_16x16x32_bf16 v[208:211], v[120:123], a[160:163], v[208:211]
    v_mfma_f32_16x16x32_bf16 v[208:211], v[124:127], a[168:171], v[208:211]
    buffer_load_dwordx4 a[224:227], v4, s[40:43], s63 offen offset:0 sc1
    v_mfma_f32_16x16x32_bf16 v[212:215], v[120:123], a[164:167], v[212:215]
    ds_read_b128 v[120:123], v11 offset:17408
    v_mfma_f32_16x16x32_bf16 v[212:215], v[124:127], a[172:175], v[212:215]
    ds_read_b128 v[124:127], v11 offset:24576
    v_mfma_f32_16x16x32_bf16 v[216:219], v[128:131], a[160:163], v[216:219]
    v_mfma_f32_16x16x32_bf16 v[216:219], v[132:135], a[168:171], v[216:219]
    buffer_load_dwordx4 a[228:231], v5, s[40:43], s63 offen offset:0 sc1
    v_mfma_f32_16x16x32_bf16 v[220:223], v[128:131], a[164:167], v[220:223]
    ds_read_b128 v[128:131], v11 offset:18432
    v_mfma_f32_16x16x32_bf16 v[220:223], v[132:135], a[172:175], v[220:223]
    ds_read_b128 v[132:135], v11 offset:25600
    v_mfma_f32_16x16x32_bf16 v[224:227], v[136:139], a[160:163], v[224:227]
    v_mfma_f32_16x16x32_bf16 v[224:227], v[140:143], a[168:171], v[224:227]
    buffer_load_dwordx4 a[232:235], v4, s[40:43], s63 offen offset:1024 sc1
    v_mfma_f32_16x16x32_bf16 v[228:231], v[136:139], a[164:167], v[228:231]
    ds_read_b128 v[136:139], v11 offset:19456
    v_mfma_f32_16x16x32_bf16 v[228:231], v[140:143], a[172:175], v[228:231]
    ds_read_b128 v[140:143], v11 offset:26624
    v_mfma_f32_16x16x32_bf16 v[176:179], v[144:147], a[176:179], v[176:179]
    v_mfma_f32_16x16x32_bf16 v[176:179], v[148:151], a[184:187], v[176:179]
    buffer_load_dwordx4 a[236:239], v5, s[40:43], s63 offen offset:1024 sc1
    v_mfma_f32_16x16x32_bf16 v[180:183], v[144:147], a[180:183], v[180:183]
    ds_read_b128 v[144:147], v11 offset:20480
    v_mfma_f32_16x16x32_bf16 v[180:183], v[148:151], a[188:191], v[180:183]
    s_waitcnt lgkmcnt(2)
    ds_read_b128 v[148:151], v11 offset:27648
    v_mfma_f32_16x16x32_bf16 v[184:187], v[104:107], a[176:179], v[184:187]
    v_mfma_f32_16x16x32_bf16 v[184:187], v[108:111], a[184:187], v[184:187]
    buffer_load_dwordx4 a[240:243], v4, s[40:43], s63 offen offset:2048 sc1
    v_mfma_f32_16x16x32_bf16 v[188:191], v[104:107], a[180:183], v[188:191]
    v_mfma_f32_16x16x32_bf16 v[188:191], v[108:111], a[188:191], v[188:191]
    v_mfma_f32_16x16x32_bf16 v[192:195], v[112:115], a[176:179], v[192:195]
    v_mfma_f32_16x16x32_bf16 v[192:195], v[116:119], a[184:187], v[192:195]
    buffer_load_dwordx4 a[244:247], v5, s[40:43], s63 offen offset:2048 sc1
    v_mfma_f32_16x16x32_bf16 v[196:199], v[112:115], a[180:183], v[196:199]
    v_mfma_f32_16x16x32_bf16 v[196:199], v[116:119], a[188:191], v[196:199]
    v_mfma_f32_16x16x32_bf16 v[200:203], v[120:123], a[176:179], v[200:203]
    v_mfma_f32_16x16x32_bf16 v[200:203], v[124:127], a[184:187], v[200:203]
    buffer_load_dwordx4 a[248:251], v4, s[40:43], s63 offen offset:3072 sc1
    v_mfma_f32_16x16x32_bf16 v[204:207], v[120:123], a[180:183], v[204:207]
    v_mfma_f32_16x16x32_bf16 v[204:207], v[124:127], a[188:191], v[204:207]
    s_waitcnt vmcnt(14)
    v_cmp_gt_u32 vcc, 3, v3
    s_nop 1
    s_and_b64 vcc, vcc, exec
    s_cbranch_scc1 SPIN_OA
BACK_OA:
    s_barrier
    v_mfma_f32_16x16x32_bf16 v[208:211], v[128:131], a[176:179], v[208:211]
    ds_read_b128 v[104:107], v11 offset:28672
    ds_read_b128 v[108:111], v11 offset:35840
    v_mfma_f32_16x16x32_bf16 v[208:211], v[132:135], a[184:187], v[208:211]
    buffer_load_dwordx4 a[252:255], v5, s[40:43], s63 offen offset:3072 sc1
    v_mfma_f32_16x16x32_bf16 v[212:215], v[128:131], a[180:183], v[212:215]
    ds_read_b128 v[112:115], v11 offset:29696
    ds_read_b128 v[116:119], v11 offset:36864
    v_mfma_f32_16x16x32_bf16 v[212:215], v[132:135], a[188:191], v[212:215]
    s_mul_i32 s21, s61, 6
    s_add_u32 s21, s4, s21
    ds_read_b128 v[120:123], v11 offset:30720
    v_mfma_f32_16x16x32_bf16 v[216:219], v[136:139], a[176:179], v[216:219]
    s_add_u32 s21, s21, 128
    ds_read_b128 v[124:127], v11 offset:37888
    s_waitcnt lgkmcnt(6)
    v_mfma_f32_16x16x32_bf16 v[216:219], v[140:143], a[184:187], v[216:219]
    s_mul_i32 s21, s21, 36864
    ds_read_b128 v[128:131], v11 offset:31744
    v_mfma_f32_16x16x32_bf16 v[220:223], v[136:139], a[180:183], v[220:223]
    s_add_u32 s64, s21, s17
    s_add_u32 m0, s78, 86016
    ds_read_b128 v[132:135], v11 offset:38912
    v_mfma_f32_16x16x32_bf16 v[220:223], v[140:143], a[188:191], v[220:223]
    s_add_u32 s63, s63, 4096
    buffer_load_dwordx4 v1, s[56:59], s64 offen sc1 lds
    v_mfma_f32_16x16x32_bf16 v[224:227], v[144:147], a[176:179], v[224:227]
    ds_read_b128 v[136:139], v11 offset:32768
    ds_read_b128 v[140:143], v11 offset:39936
    v_mfma_f32_16x16x32_bf16 v[224:227], v[148:151], a[184:187], v[224:227]
    v_mfma_f32_16x16x32_bf16 v[228:231], v[144:147], a[180:183], v[228:231]
    buffer_load_dwordx4 v1, s[56:59], s64 offen offset:1024 sc1 lds
    v_mfma_f32_16x16x32_bf16 v[228:231], v[148:151], a[188:191], v[228:231]
    s_add_u32 s64, s21, s18
    ds_read_b128 v[144:147], v11 offset:33792
    ds_read_b128 v[148:151], v11 offset:40960
    s_waitcnt lgkmcnt(4)
    v_mfma_f32_16x16x32_bf16 v[176:179], v[104:107], a[192:195], v[176:179]
    s_add_u32 m0, s78, 88064
    v_mfma_f32_16x16x32_bf16 v[176:179], v[108:111], a[200:203], v[176:179]
    v_mfma_f32_16x16x32_bf16 v[180:183], v[104:107], a[196:199], v[180:183]
    buffer_load_dwordx4 v1, s[56:59], s64 offen sc1 lds
    v_mfma_f32_16x16x32_bf16 v[180:183], v[108:111], a[204:207], v[180:183]
    ds_read_b128 v[104:107], v11 offset:34816
    ds_read_b128 v[108:111], v11 offset:41984
    v_mfma_f32_16x16x32_bf16 v[184:187], v[112:115], a[192:195], v[184:187]
    v_mfma_f32_16x16x32_bf16 v[184:187], v[116:119], a[200:203], v[184:187]
    v_mfma_f32_16x16x32_bf16 v[188:191], v[112:115], a[196:199], v[188:191]
    buffer_load_dwordx4 v1, s[56:59], s64 offen offset:1024 sc1 lds
    v_mfma_f32_16x16x32_bf16 v[188:191], v[116:119], a[204:207], v[188:191]
    s_add_u32 s64, s21, s19
    ds_read_b128 v[112:115], v11 offset:43008
    ds_read_b128 v[116:119], v11 offset:50176
    v_mfma_f32_16x16x32_bf16 v[192:195], v[120:123], a[192:195], v[192:195]
    s_add_u32 m0, s78, 90112
    v_mfma_f32_16x16x32_bf16 v[192:195], v[124:127], a[200:203], v[192:195]
    v_mfma_f32_16x16x32_bf16 v[196:199], v[120:123], a[196:199], v[196:199]
    buffer_load_dwordx4 v1, s[56:59], s64 offen sc1 lds
    v_mfma_f32_16x16x32_bf16 v[196:199], v[124:127], a[204:207], v[196:199]
    ds_read_b128 v[120:123], v11 offset:44032
    ds_read_b128 v[124:127], v11 offset:51200
    v_mfma_f32_16x16x32_bf16 v[200:203], v[128:131], a[192:195], v[200:203]
    v_mfma_f32_16x16x32_bf16 v[200:203], v[132:135], a[200:203], v[200:203]
    v_mfma_f32_16x16x32_bf16 v[204:207], v[128:131], a[196:199], v[204:207]
    buffer_load_dwordx4 v1, s[56:59], s64 offen offset:1024 sc1 lds
    v_mfma_f32_16x16x32_bf16 v[204:207], v[132:135], a[204:207], v[204:207]
    s_add_u32 s64, s21, s20
    ds_read_b128 v[128:131], v11 offset:45056
    ds_read_b128 v[132:135], v11 offset:52224
    s_waitcnt lgkmcnt(4)
    v_mfma_f32_16x16x32_bf16 v[208:211], v[136:139], a[192:195], v[208:211]
    s_add_u32 m0, s78, 92160
    v_mfma_f32_16x16x32_bf16 v[208:211], v[140:143], a[200:203], v[208:211]
    v_mfma_f32_16x16x32_bf16 v[212:215], v[136:139], a[196:199], v[212:215]
    buffer_load_dwordx4 v1, s[56:59], s64 offen sc1 lds
    v_mfma_f32_16x16x32_bf16 v[212:215], v[140:143], a[204:207], v[212:215]
    s_mul_i32 s63, s61, 6144
    ds_read_b128 v[136:139], v11 offset:46080
    ds_read_b128 v[140:143], v11 offset:53248
    v_mfma_f32_16x16x32_bf16 v[216:219], v[144:147], a[192:195], v[216:219]
    s_add_u32 s63, s63, 131072
    v_mfma_f32_16x16x32_bf16 v[216:219], v[148:151], a[200:203], v[216:219]
    v_mfma_f32_16x16x32_bf16 v[220:223], v[144:147], a[196:199], v[220:223]
    buffer_load_dwordx4 v[32:35], v4, s[40:43], s63 offen offset:0 sc1
    v_mfma_f32_16x16x32_bf16 v[220:223], v[148:151], a[204:207], v[220:223]
    ds_read_b128 v[144:147], v11 offset:47104
    ds_read_b128 v[148:151], v11 offset:54272
    v_mfma_f32_16x16x32_bf16 v[224:227], v[104:107], a[192:195], v[224:227]
    v_mfma_f32_16x16x32_bf16 v[224:227], v[108:111], a[200:203], v[224:227]
    v_mfma_f32_16x16x32_bf16 v[228:231], v[104:107], a[196:199], v[228:231]
    ds_read_b128 v[104:107], v11 offset:48128
    v_mfma_f32_16x16x32_bf16 v[228:231], v[108:111], a[204:207], v[228:231]
    buffer_load_dwordx4 v[36:39], v5, s[40:43], s63 offen offset:0 sc1
    v_mfma_f32_16x16x32_bf16 v[176:179], v[112:115], a[208:211], v[176:179]
    ds_read_b128 v[108:111], v11 offset:55296
    v_mfma_f32_16x16x32_bf16 v[176:179], v[116:119], a[216:219], v[176:179]
    v_mfma_f32_16x16x32_bf16 v[180:183], v[112:115], a[212:215], v[180:183]
    ds_read_b128 v[112:115], v11 offset:49152
    v_mfma_f32_16x16x32_bf16 v[180:183], v[116:119], a[220:223], v[180:183]
    s_waitcnt lgkmcnt(2)
    buffer_load_dwordx4 v[40:43], v4, s[40:43], s63 offen offset:1024 sc1
    v_mfma_f32_16x16x32_bf16 v[184:187], v[120:123], a[208:211], v[184:187]
    ds_read_b128 v[116:119], v11 offset:56320
    v_mfma_f32_16x16x32_bf16 v[184:187], v[124:127], a[216:219], v[184:187]
    v_mfma_f32_16x16x32_bf16 v[188:191], v[120:123], a[212:215], v[188:191]
    v_mfma_f32_16x16x32_bf16 v[188:191], v[124:127], a[220:223], v[188:191]
    buffer_load_dwordx4 v[44:47], v5, s[40:43], s63 offen offset:1024 sc1
    v_mfma_f32_16x16x32_bf16 v[192:195], v[128:131], a[208:211], v[192:195]
    v_mfma_f32_16x16x32_bf16 v[192:195], v[132:135], a[216:219], v[192:195]
    v_mfma_f32_16x16x32_bf16 v[196:199], v[128:131], a[212:215], v[196:199]
    v_mfma_f32_16x16x32_bf16 v[196:199], v[132:135], a[220:223], v[196:199]
    buffer_load_dwordx4 v[48:51], v4, s[40:43], s63 offen offset:2048 sc1
    v_mfma_f32_16x16x32_bf16 v[200:203], v[136:139], a[208:211], v[200:203]
    v_mfma_f32_16x16x32_bf16 v[200:203], v[140:143], a[216:219], v[200:203]
    v_mfma_f32_16x16x32_bf16 v[204:207], v[136:139], a[212:215], v[204:207]
    v_mfma_f32_16x16x32_bf16 v[204:207], v[140:143], a[220:223], v[204:207]
    s_waitcnt vmcnt(12)
    s_barrier
    ds_read_b128 v[120:123], v11 offset:57344
    v_mfma_f32_16x16x32_bf16 v[208:211], v[144:147], a[208:211], v[208:211]
    buffer_load_dwordx4 v[52:55], v5, s[40:43], s63 offen offset:2048 sc1
    v_mfma_f32_16x16x32_bf16 v[208:211], v[148:151], a[216:219], v[208:211]
    ds_read_b128 v[124:127], v11 offset:64512
    ds_read_b128 v[128:131], v11 offset:58368
    v_mfma_f32_16x16x32_bf16 v[212:215], v[144:147], a[212:215], v[212:215]
    ds_read_b128 v[132:135], v12 offset:0
    v_mfma_f32_16x16x32_bf16 v[212:215], v[148:151], a[220:223], v[212:215]
    buffer_load_dwordx4 v[56:59], v4, s[40:43], s63 offen offset:3072 sc1
    v_mfma_f32_16x16x32_bf16 v[216:219], v[104:107], a[208:211], v[216:219]
    s_waitcnt lgkmcnt(3)
    ds_read_b128 v[136:139], v11 offset:59392
    ds_read_b128 v[140:143], v12 offset:1024
    v_mfma_f32_16x16x32_bf16 v[216:219], v[108:111], a[216:219], v[216:219]
    ds_read_b128 v[144:147], v11 offset:60416
    v_mfma_f32_16x16x32_bf16 v[220:223], v[104:107], a[212:215], v[220:223]
    ds_read_b128 v[148:151], v12 offset:2048
    v_mfma_f32_16x16x32_bf16 v[220:223], v[108:111], a[220:223], v[220:223]
    buffer_load_dwordx4 v[60:63], v5, s[40:43], s63 offen offset:3072 sc1
    v_mfma_f32_16x16x32_bf16 v[224:227], v[112:115], a[208:211], v[224:227]
    s_mul_i32 s21, s61, 6
    s_cmp_eq_u32 s4, 0
    s_cselect_b32 s64, s17, s18
    v_mfma_f32_16x16x32_bf16 v[224:227], v[116:119], a[216:219], v[224:227]
    s_add_u32 s21, s21, 132
    s_cmp_eq_u32 s4, 2
    s_cselect_b32 s64, s19, s64
    v_mfma_f32_16x16x32_bf16 v[228:231], v[112:115], a[212:215], v[228:231]
    s_mul_i32 s21, s21, 36864
    s_cmp_eq_u32 s4, 3
    s_cselect_b32 s64, s20, s64
    v_mfma_f32_16x16x32_bf16 v[228:231], v[116:119], a[220:223], v[228:231]
    s_add_u32 s64, s64, s21
    s_add_u32 m0, s67, 114688
    ds_read_b128 v[104:107], v11 offset:61440
    v_mfma_f32_16x16x32_bf16 v[176:179], v[120:123], a[224:227], v[176:179]
    s_add_u32 s63, s63, 4096
    buffer_load_dwordx4 v1, s[56:59], s64 offen sc1 lds
    s_waitcnt lgkmcnt(1)
    v_mfma_f32_16x16x32_bf16 v[176:179], v[124:127], a[232:235], v[176:179]
    s_add_u32 s23, s5, 8
    ds_read_b128 v[108:111], v12 offset:3072
    ds_read_b128 v[112:115], v11 offset:62464
    v_mfma_f32_16x16x32_bf16 v[180:183], v[120:123], a[228:231], v[180:183]
    s_add_u32 s22, s4, 1
    ds_read_b128 v[116:119], v12 offset:4096
    v_lshrrev_b32 v19, 4, v1
    v_mfma_f32_16x16x32_bf16 v[180:183], v[124:127], a[236:239], v[180:183]
    s_mul_i32 s70, s4, 3072
    ds_read_b128 v[120:123], v11 offset:63488
    v_min_u32 v19, 2, v19
    v_mfma_f32_16x16x32_bf16 v[184:187], v[128:131], a[224:227], v[184:187]
    s_lshl_b32 s22, s22, 15
    buffer_load_dwordx4 v1, s[56:59], s64 offen offset:1024 sc1 lds
    v_mfma_f32_16x16x32_bf16 v[184:187], v[132:135], a[232:235], v[184:187]
    s_add_u32 s64, s64, 36864
    ds_read_b128 v[124:127], v12 offset:5120
    v_lshl_add_u32 v19, v19, 3, s23
    v_mfma_f32_16x16x32_bf16 v[188:191], v[128:131], a[228:231], v[188:191]
    s_add_u32 m0, s67, 122880
    ds_read_b128 v[128:131], v12 offset:6144
    v_bfe_u32 v20, v1, 4, 4
    v_mfma_f32_16x16x32_bf16 v[188:191], v[132:135], a[236:239], v[188:191]
    s_lshl2_add_u32 s23, s62, s4
    ds_read_b128 v[132:135], v12 offset:13312
    v_lshrrev_b32 v21, 8, v1
    v_mfma_f32_16x16x32_bf16 v[192:195], v[136:139], a[224:227], v[192:195]
    s_lshl_b32 s23, s23, 5
    buffer_load_dwordx4 v1, s[56:59], s64 offen sc1 lds
    v_mfma_f32_16x16x32_bf16 v[192:195], v[140:143], a[232:235], v[192:195]
    s_lshl_b32 s66, s6, 12
    v_add_u32 v20, s23, v20
    v_mul_u32_u24 v20, 1152, v20
    v_mfma_f32_16x16x32_bf16 v[196:199], v[136:139], a[228:231], v[196:199]
    s_mul_i32 s23, s101, 288
    ds_read_b128 v[136:139], v12 offset:7168
    v_and_b32 v19, 31, v19
    v_mfma_f32_16x16x32_bf16 v[196:199], v[140:143], a[236:239], v[196:199]
    s_add_u32 s23, s23, s70
    ds_read_b128 v[140:143], v12 offset:14336
    v_lshl_add_u32 v20, v21, 3, v20
    v_mfma_f32_16x16x32_bf16 v[200:203], v[144:147], a[224:227], v[200:203]
    s_lshr_b32 s65, s20, 5
    buffer_load_dwordx4 v1, s[56:59], s64 offen offset:1024 sc1 lds
    v_mfma_f32_16x16x32_bf16 v[200:203], v[148:151], a[232:235], v[200:203]
    s_add_u32 s64, s64, 36864
    v_mov_b32 v31, 2
    v_lshlrev_b32 v23, 20, v1
    v_mfma_f32_16x16x32_bf16 v[204:207], v[144:147], a[228:231], v[204:207]
    s_add_u32 s66, s66, s22
    ds_read_b128 v[144:147], v12 offset:8192
    v_lshlrev_b32 v19, 7, v19
    v_mfma_f32_16x16x32_bf16 v[204:207], v[148:151], a[236:239], v[204:207]
    s_add_u32 s22, s22, s101
    ds_read_b128 v[148:151], v12 offset:15360
    v_add_u32 v21, 18432, v20
    s_waitcnt lgkmcnt(3)
    v_mfma_f32_16x16x32_bf16 v[208:211], v[104:107], a[224:227], v[208:211]
    buffer_load_dwordx4 v[64:67], v4, s[40:43], s63 offen offset:0 sc1
    v_mfma_f32_16x16x32_bf16 v[208:211], v[108:111], a[232:235], v[208:211]
    s_cmp_eq_u32 s4, s61
    s_cselect_b32 s65, s65, 1073741824
    s_cselect_b32 s70, s23, 1073741824
    v_mfma_f32_16x16x32_bf16 v[212:215], v[104:107], a[228:231], v[212:215]
    s_add_u32 s98, s70, 0
    ds_read_b128 v[104:107], v12 offset:9216
    v_mfma_f32_16x16x32_bf16 v[212:215], v[108:111], a[236:239], v[212:215]
    ds_read_b128 v[108:111], v12 offset:16384
    v_mfma_f32_16x16x32_bf16 v[216:219], v[112:115], a[224:227], v[216:219]
    buffer_load_dwordx4 v[68:71], v5, s[40:43], s63 offen offset:0 sc1
    v_mfma_f32_16x16x32_bf16 v[216:219], v[116:119], a[232:235], v[216:219]
    v_mfma_f32_16x16x32_bf16 v[220:223], v[112:115], a[228:231], v[220:223]
    ds_read_b128 v[112:115], v12 offset:10240
    v_mfma_f32_16x16x32_bf16 v[220:223], v[116:119], a[236:239], v[220:223]
    ds_read_b128 v[116:119], v12 offset:17408
    v_mfma_f32_16x16x32_bf16 v[224:227], v[120:123], a[224:227], v[224:227]
    buffer_load_dwordx4 v[72:75], v4, s[40:43], s63 offen offset:1024 sc1
    v_mfma_f32_16x16x32_bf16 v[224:227], v[124:127], a[232:235], v[224:227]
    v_mfma_f32_16x16x32_bf16 v[228:231], v[120:123], a[228:231], v[228:231]
    ds_read_b128 v[120:123], v12 offset:11264
    v_mfma_f32_16x16x32_bf16 v[228:231], v[124:127], a[236:239], v[228:231]
    ds_read_b128 v[124:127], v12 offset:18432
    v_mfma_f32_16x16x32_bf16 v[176:179], v[128:131], a[240:243], v[176:179]
    buffer_load_dwordx4 v[76:79], v5, s[40:43], s63 offen offset:1024 sc1
    v_mfma_f32_16x16x32_bf16 v[176:179], v[132:135], a[248:251], v[176:179]
    s_lshr_b32 s64, s4, 1
    s_lshl1_add_u32 s21, s61, s64
    s_mul_i32 s21, s21, 3
    v_mfma_f32_16x16x32_bf16 v[180:183], v[128:131], a[244:247], v[180:183]
    s_add_u32 s21, s21, 128
    s_mul_i32 s21, s21, 36864
    ds_read_b128 v[128:131], v12 offset:12288
    v_mfma_f32_16x16x32_bf16 v[180:183], v[132:135], a[252:255], v[180:183]
    s_add_u32 s21, s21, s16
    s_and_b32 s64, s68, 1024
    ds_read_b128 v[132:135], v12 offset:19456
    v_mfma_f32_16x16x32_bf16 v[184:187], v[136:139], a[240:243], v[184:187]
    s_add_u32 s21, s21, s64
    s_add_u32 m0, s69, 143360
    s_waitcnt lgkmcnt(2)
    v_mfma_f32_16x16x32_bf16 v[184:187], v[140:143], a[248:251], v[184:187]
    s_add_u32 s63, s63, 4096
    buffer_load_dwordx4 v1, s[56:59], s21 offen sc1 lds
    v_mfma_f32_16x16x32_bf16 v[188:191], v[136:139], a[244:247], v[188:191]
    s_add_u32 s21, s21, 36864
    v_mfma_f32_16x16x32_bf16 v[188:191], v[140:143], a[252:255], v[188:191]
    s_add_u32 m0, s69, 144384
    v_mfma_f32_16x16x32_bf16 v[192:195], v[144:147], a[240:243], v[192:195]
    s_lshr_b32 s64, s16, 5
    v_mfma_f32_16x16x32_bf16 v[192:195], v[148:151], a[248:251], v[192:195]
    buffer_load_dwordx4 v1, s[56:59], s21 offen sc1 lds
    v_mfma_f32_16x16x32_bf16 v[196:199], v[144:147], a[244:247], v[196:199]
    s_add_u32 s21, s21, 36864
    v_mfma_f32_16x16x32_bf16 v[196:199], v[148:151], a[252:255], v[196:199]
    s_add_u32 m0, s69, 145408
    v_mfma_f32_16x16x32_bf16 v[200:203], v[104:107], a[240:243], v[200:203]
    v_mfma_f32_16x16x32_bf16 v[200:203], v[108:111], a[248:251], v[200:203]
    buffer_load_dwordx4 v1, s[56:59], s21 offen sc1 lds
    v_mfma_f32_16x16x32_bf16 v[204:207], v[104:107], a[244:247], v[204:207]
    s_add_u32 s21, s21, 36864
    s_add_u32 s21, s4, 0
    v_mfma_f32_16x16x32_bf16 v[204:207], v[108:111], a[252:255], v[204:207]
    s_waitcnt vmcnt(11)
    s_barrier
    s_xor_b32 s21, s21, s3
    v_mfma_f32_16x16x32_bf16 v[208:211], v[112:115], a[240:243], v[208:211]
    s_mul_i32 s21, s21, 147456
    ds_read_b128 v[136:139], v12 offset:20480
    ds_read_b128 v[140:143], v12 offset:27648
    v_mfma_f32_16x16x32_bf16 v[208:211], v[116:119], a[248:251], v[208:211]
    s_add_u32 s21, s21, s16
    s_add_u32 m0, s75, 0
    ds_read_b128 v[144:147], v12 offset:21504
    v_mfma_f32_16x16x32_bf16 v[212:215], v[112:115], a[244:247], v[212:215]
    buffer_load_dwordx4 v1, s[56:59], s21 offen sc1 lds
    v_mfma_f32_16x16x32_bf16 v[212:215], v[116:119], a[252:255], v[212:215]
    ds_read_b128 v[148:151], v12 offset:28672
    ds_read_b128 v[104:107], v12 offset:22528
    v_mfma_f32_16x16x32_bf16 v[216:219], v[120:123], a[240:243], v[216:219]
    ds_read_b128 v[108:111], v12 offset:29696
    v_mfma_f32_16x16x32_bf16 v[216:219], v[124:127], a[248:251], v[216:219]
    buffer_load_dwordx4 v1, s[56:59], s21 offen offset:1024 sc1 lds
    v_mfma_f32_16x16x32_bf16 v[220:223], v[120:123], a[244:247], v[220:223]
    s_add_u32 s21, s21, 36864
    ds_read_b128 v[112:115], v12 offset:23552
    ds_read_b128 v[116:119], v12 offset:30720
    v_mfma_f32_16x16x32_bf16 v[220:223], v[124:127], a[252:255], v[220:223]
    s_add_u32 m0, s75, 2048
    ds_read_b128 v[120:123], v12 offset:24576
    s_waitcnt lgkmcnt(6)
    v_mfma_f32_16x16x32_bf16 v[224:227], v[128:131], a[240:243], v[224:227]
    ds_read_b128 v[124:127], v12 offset:31744
    v_mfma_f32_16x16x32_bf16 v[224:227], v[132:135], a[248:251], v[224:227]
    buffer_load_dwordx4 v1, s[56:59], s21 offen sc1 lds
    v_mfma_f32_16x16x32_bf16 v[228:231], v[128:131], a[244:247], v[228:231]
    ds_read_b128 v[128:131], v12 offset:25600
    v_mfma_f32_16x16x32_bf16 v[228:231], v[132:135], a[252:255], v[228:231]
    ds_read_b128 v[132:135], v12 offset:32768
    v_mfma_f32_16x16x32_bf16 v[176:179], v[136:139], v[32:35], v[176:179]
    v_mfma_f32_16x16x32_bf16 v[176:179], v[140:143], v[40:43], v[176:179]
    buffer_load_dwordx4 v1, s[56:59], s21 offen offset:1024 sc1 lds
    v_mfma_f32_16x16x32_bf16 v[180:183], v[136:139], v[36:39], v[180:183]
    s_add_u32 s21, s21, 36864
    ds_read_b128 v[136:139], v12 offset:26624
    v_mfma_f32_16x16x32_bf16 v[180:183], v[140:143], v[44:47], v[180:183]
    s_add_u32 m0, s75, 4096
    ds_read_b128 v[140:143], v12 offset:33792
    v_mfma_f32_16x16x32_bf16 v[184:187], v[144:147], v[32:35], v[184:187]
    s_waitcnt lgkmcnt(2)
    v_mfma_f32_16x16x32_bf16 v[184:187], v[148:151], v[40:43], v[184:187]
    buffer_load_dwordx4 v1, s[56:59], s21 offen sc1 lds
    v_mfma_f32_16x16x32_bf16 v[188:191], v[144:147], v[36:39], v[188:191]
    ds_read_b128 v[144:147], v12 offset:34816
    v_mfma_f32_16x16x32_bf16 v[188:191], v[148:151], v[44:47], v[188:191]
    ds_read_b128 v[148:151], v12 offset:41984
    v_mfma_f32_16x16x32_bf16 v[192:195], v[104:107], v[32:35], v[192:195]
    v_mfma_f32_16x16x32_bf16 v[192:195], v[108:111], v[40:43], v[192:195]
    v_mfma_f32_16x16x32_bf16 v[196:199], v[104:107], v[36:39], v[196:199]
    buffer_load_dwordx4 v1, s[56:59], s21 offen offset:1024 sc1 lds
    v_mfma_f32_16x16x32_bf16 v[196:199], v[108:111], v[44:47], v[196:199]
    s_add_u32 s21, s21, 36864
    v_mfma_f32_16x16x32_bf16 v[200:203], v[112:115], v[32:35], v[200:203]
    s_add_u32 m0, s75, 6144
    v_mfma_f32_16x16x32_bf16 v[200:203], v[116:119], v[40:43], v[200:203]
    v_mfma_f32_16x16x32_bf16 v[204:207], v[112:115], v[36:39], v[204:207]
    buffer_load_dwordx4 v1, s[56:59], s21 offen sc1 lds
    v_mfma_f32_16x16x32_bf16 v[204:207], v[116:119], v[44:47], v[204:207]
    s_waitcnt vmcnt(10)
    s_barrier
    ds_read_b128 v[104:107], v12 offset:49152
    v_mfma_f32_16x16x32_bf16 v[208:211], v[120:123], v[32:35], v[208:211]
    ds_read_b128 v[108:111], v12 offset:57344
    ds_read_b128 v[112:115], v12 offset:35840
    v_mfma_f32_16x16x32_bf16 v[208:211], v[124:127], v[40:43], v[208:211]
    ds_read_b128 v[116:119], v12 offset:43008
    v_mfma_f32_16x16x32_bf16 v[212:215], v[120:123], v[36:39], v[212:215]
    buffer_load_dwordx4 v1, s[56:59], s21 offen offset:1024 sc1 lds
    v_mfma_f32_16x16x32_bf16 v[212:215], v[124:127], v[44:47], v[212:215]
    s_add_u32 s21, s21, 36864
    s_add_u32 s21, s4, 4
    ds_read_b128 v[120:123], v12 offset:50176
    v_mfma_f32_16x16x32_bf16 v[216:219], v[128:131], v[32:35], v[216:219]
    s_xor_b32 s21, s21, s3
    ds_read_b128 v[124:127], v12 offset:58368
    v_mfma_f32_16x16x32_bf16 v[216:219], v[132:135], v[40:43], v[216:219]
    s_mul_i32 s21, s21, 147456
    v_mfma_f32_16x16x32_bf16 v[220:223], v[128:131], v[36:39], v[220:223]
    s_add_u32 s21, s21, s16
    s_add_u32 m0, s75, 32768
    ds_read_b128 v[128:131], v12 offset:36864
    v_mfma_f32_16x16x32_bf16 v[220:223], v[132:135], v[44:47], v[220:223]
    s_waitcnt lgkmcnt(3)
    buffer_load_dwordx4 v1, s[56:59], s21 offen sc1 lds
    v_mfma_f32_16x16x32_bf16 v[224:227], v[136:139], v[32:35], v[224:227]
    ds_read_b128 v[132:135], v12 offset:44032
    v_mfma_f32_16x16x32_bf16 v[224:227], v[140:143], v[40:43], v[224:227]
    v_mfma_f32_16x16x32_bf16 v[228:231], v[136:139], v[36:39], v[228:231]
    buffer_load_dwordx4 v1, s[56:59], s21 offen offset:1024 sc1 lds
    v_mfma_f32_16x16x32_bf16 v[228:231], v[140:143], v[44:47], v[228:231]
    s_add_u32 s21, s21, 36864
    ds_read_b128 v[136:139], v12 offset:51200
    ds_read_b128 v[140:143], v12 offset:59392
    v_mfma_f32_16x16x32_bf16 v[176:179], v[144:147], v[48:51], v[176:179]
    s_add_u32 m0, s75, 34816
    v_mfma_f32_16x16x32_bf16 v[176:179], v[148:151], v[56:59], v[176:179]
    v_mfma_f32_16x16x32_bf16 v[176:179], v[104:107], v[64:67], v[176:179]
    buffer_load_dwordx4 v1, s[56:59], s21 offen sc1 lds
    v_mfma_f32_16x16x32_bf16 v[176:179], v[108:111], v[72:75], v[176:179]
    v_mfma_f32_16x16x32_bf16 v[180:183], v[144:147], v[52:55], v[180:183]
    ds_read_b128 v[144:147], v12 offset:37888
    v_mfma_f32_16x16x32_bf16 v[180:183], v[148:151], v[60:63], v[180:183]
    ds_read_b128 v[148:151], v12 offset:45056
    v_mfma_f32_16x16x32_bf16 v[180:183], v[104:107], v[68:71], v[180:183]
    buffer_load_dwordx4 v1, s[56:59], s21 offen offset:1024 sc1 lds
    v_mfma_f32_16x16x32_bf16 v[180:183], v[108:111], v[76:79], v[180:183]
    s_add_u32 s21, s21, 36864
    v_cvt_pk_bf16_f32 v232, v176, v177
    v_cvt_pk_bf16_f32 v233, v178, v179
    v_mfma_f32_16x16x32_bf16 v[184:187], v[112:115], v[48:51], v[184:187]
    s_add_u32 m0, s75, 36864
    ds_read_b128 v[104:107], v12 offset:52224
    ds_read_b128 v[108:111], v12 offset:60416
    v_mfma_f32_16x16x32_bf16 v[184:187], v[116:119], v[56:59], v[184:187]
    s_waitcnt lgkmcnt(3)
    v_cvt_pk_bf16_f32 v234, v180, v181
    v_cvt_pk_bf16_f32 v235, v182, v183
    v_mfma_f32_16x16x32_bf16 v[184:187], v[120:123], v[64:67], v[184:187]
    buffer_load_dwordx4 v1, s[56:59], s21 offen sc1 lds
    v_mfma_f32_16x16x32_bf16 v[184:187], v[124:127], v[72:75], v[184:187]
    buffer_store_dwordx4 v[232:235], v1, s[48:51], s8 offen offset:0 sc1
    v_mfma_f32_16x16x32_bf16 v[188:191], v[112:115], v[52:55], v[188:191]
    ds_read_b128 v[112:115], v12 offset:38912
    v_mfma_f32_16x16x32_bf16 v[188:191], v[116:119], v[60:63], v[188:191]
    ds_read_b128 v[116:119], v12 offset:46080
    v_mfma_f32_16x16x32_bf16 v[188:191], v[120:123], v[68:71], v[188:191]
    ds_read_b128 v[120:123], v12 offset:53248
    v_mfma_f32_16x16x32_bf16 v[188:191], v[124:127], v[76:79], v[188:191]
    buffer_load_dwordx4 v1, s[56:59], s21 offen offset:1024 sc1 lds
    v_mfma_f32_16x16x32_bf16 v[192:195], v[128:131], v[48:51], v[192:195]
    s_add_u32 s21, s21, 36864
    v_cvt_pk_bf16_f32 v236, v184, v185
    v_cvt_pk_bf16_f32 v237, v186, v187
    v_mfma_f32_16x16x32_bf16 v[192:195], v[132:135], v[56:59], v[192:195]
    s_add_u32 m0, s75, 38912
    ds_read_b128 v[124:127], v12 offset:61440
    v_cvt_pk_bf16_f32 v238, v188, v189
    v_mfma_f32_16x16x32_bf16 v[192:195], v[136:139], v[64:67], v[192:195]
    v_cvt_pk_bf16_f32 v239, v190, v191
    v_mfma_f32_16x16x32_bf16 v[192:195], v[140:143], v[72:75], v[192:195]
    buffer_load_dwordx4 v1, s[56:59], s21 offen sc1 lds
    v_mfma_f32_16x16x32_bf16 v[196:199], v[128:131], v[52:55], v[196:199]
    ds_read_b128 v[128:131], v12 offset:39936
    v_mfma_f32_16x16x32_bf16 v[196:199], v[132:135], v[60:63], v[196:199]
    ds_read_b128 v[132:135], v12 offset:47104
    v_mfma_f32_16x16x32_bf16 v[196:199], v[136:139], v[68:71], v[196:199]
    ds_read_b128 v[136:139], v12 offset:54272
    v_mfma_f32_16x16x32_bf16 v[196:199], v[140:143], v[76:79], v[196:199]
    buffer_store_dwordx4 v[236:239], v1, s[48:51], s8 offen offset:1024 sc1
    v_mfma_f32_16x16x32_bf16 v[200:203], v[144:147], v[48:51], v[200:203]
    s_waitcnt lgkmcnt(3)
    v_cvt_pk_bf16_f32 v240, v192, v193
    v_cvt_pk_bf16_f32 v241, v194, v195
    v_mfma_f32_16x16x32_bf16 v[200:203], v[148:151], v[56:59], v[200:203]
    ds_read_b128 v[140:143], v12 offset:62464
    v_mfma_f32_16x16x32_bf16 v[200:203], v[104:107], v[64:67], v[200:203]
    v_mfma_f32_16x16x32_bf16 v[200:203], v[108:111], v[72:75], v[200:203]
    buffer_load_dwordx4 v1, s[56:59], s21 offen offset:1024 sc1 lds
    v_mfma_f32_16x16x32_bf16 v[204:207], v[144:147], v[52:55], v[204:207]
    s_add_u32 s21, s21, 36864
    v_cvt_pk_bf16_f32 v242, v196, v197
    v_cvt_pk_bf16_f32 v243, v198, v199
    v_mfma_f32_16x16x32_bf16 v[204:207], v[148:151], v[60:63], v[204:207]
    ds_read_b128 v[144:147], v12 offset:40960
    ds_read_b128 v[148:151], v12 offset:48128
    v_mfma_f32_16x16x32_bf16 v[204:207], v[104:107], v[68:71], v[204:207]
    v_cvt_pk_bf16_f32 v244, v200, v201
    v_cvt_pk_bf16_f32 v245, v202, v203
    v_mfma_f32_16x16x32_bf16 v[204:207], v[108:111], v[76:79], v[204:207]
    buffer_store_dwordx4 v[240:243], v1, s[48:51], s9 offen offset:0 sc1
    v_mfma_f32_16x16x32_bf16 v[208:211], v[112:115], v[48:51], v[208:211]
    ds_read_b128 v[104:107], v12 offset:55296
    ds_read_b128 v[108:111], v12 offset:63488
    v_mfma_f32_16x16x32_bf16 v[208:211], v[116:119], v[56:59], v[208:211]
    v_mfma_f32_16x16x32_bf16 v[208:211], v[120:123], v[64:67], v[208:211]
    v_mfma_f32_16x16x32_bf16 v[208:211], v[124:127], v[72:75], v[208:211]
    v_mfma_f32_16x16x32_bf16 v[212:215], v[112:115], v[52:55], v[212:215]
    v_cvt_pk_bf16_f32 v246, v204, v205
    v_cvt_pk_bf16_f32 v247, v206, v207
    v_mfma_f32_16x16x32_bf16 v[212:215], v[116:119], v[60:63], v[212:215]
    buffer_store_dwordx4 v[244:247], v1, s[48:51], s9 offen offset:1024 sc1
    v_mfma_f32_16x16x32_bf16 v[212:215], v[120:123], v[68:71], v[212:215]
    v_mfma_f32_16x16x32_bf16 v[212:215], v[124:127], v[76:79], v[212:215]
    s_waitcnt lgkmcnt(0)
    v_mfma_f32_16x16x32_bf16 v[216:219], v[128:131], v[48:51], v[216:219]
    v_cvt_pk_bf16_f32 v232, v208, v209
    v_cvt_pk_bf16_f32 v233, v210, v211
    v_mfma_f32_16x16x32_bf16 v[216:219], v[132:135], v[56:59], v[216:219]
    v_mfma_f32_16x16x32_bf16 v[216:219], v[136:139], v[64:67], v[216:219]
    v_mfma_f32_16x16x32_bf16 v[216:219], v[140:143], v[72:75], v[216:219]
    s_waitcnt vmcnt(12)
    s_barrier
    v_cvt_pk_bf16_f32 v234, v212, v213
    v_mfma_f32_16x16x32_bf16 v[220:223], v[128:131], v[52:55], v[220:223]
    v_cvt_pk_bf16_f32 v235, v214, v215
    ds_read_b128 v[112:115], v11 offset:0
    v_mfma_f32_16x16x32_bf16 v[220:223], v[132:135], v[60:63], v[220:223]
    buffer_store_dwordx4 v[232:235], v1, s[48:51], s10 offen offset:0 sc1
    v_mfma_f32_16x16x32_bf16 v[220:223], v[136:139], v[68:71], v[220:223]
    ds_read_b128 v[116:119], v11 offset:2048
    ds_read_b128 v[120:123], v11 offset:4096
    v_mfma_f32_16x16x32_bf16 v[220:223], v[140:143], v[76:79], v[220:223]
    ds_read_b128 v[124:127], v11 offset:6144
    v_cvt_pk_bf16_f32 v236, v216, v217
    v_mfma_f32_16x16x32_bf16 v[224:227], v[144:147], v[48:51], v[224:227]
    v_cvt_pk_bf16_f32 v237, v218, v219
    ds_read_b128 v[128:131], v11 offset:1024
    v_mfma_f32_16x16x32_bf16 v[224:227], v[148:151], v[56:59], v[224:227]
    ds_read_b128 v[132:135], v11 offset:3072
    v_mfma_f32_16x16x32_bf16 v[224:227], v[104:107], v[64:67], v[224:227]
    v_cvt_pk_bf16_f32 v238, v220, v221
    v_cvt_pk_bf16_f32 v239, v222, v223
    v_mfma_f32_16x16x32_bf16 v[224:227], v[108:111], v[72:75], v[224:227]
    buffer_store_dwordx4 v[236:239], v1, s[48:51], s10 offen offset:1024 sc1
    v_mfma_f32_16x16x32_bf16 v[228:231], v[144:147], v[52:55], v[228:231]
    ds_read_b128 v[136:139], v11 offset:5120
    ds_read_b128 v[140:143], v11 offset:7168
    v_mfma_f32_16x16x32_bf16 v[228:231], v[148:151], v[60:63], v[228:231]
    ds_read_b128 v[144:147], v11 offset:8192
    v_mfma_f32_16x16x32_bf16 v[228:231], v[104:107], v[68:71], v[228:231]
    ds_read_b128 v[148:151], v11 offset:10240
    v_cvt_pk_bf16_f32 v240, v224, v225
    v_mfma_f32_16x16x32_bf16 v[228:231], v[108:111], v[76:79], v[228:231]
    s_waitcnt lgkmcnt(4)
    v_cvt_pk_bf16_f32 v241, v226, v227
    ds_read_b128 v[104:107], v11 offset:12288
    v_mfma_f32_16x16x32_bf16 v[160:163], v[112:115], a[0:3], 0
    ds_read_b128 v[108:111], v11 offset:14336
    v_mfma_f32_16x16x32_bf16 v[160:163], v[116:119], a[8:11], v[160:163]
    v_mfma_f32_16x16x32_bf16 v[160:163], v[120:123], a[16:19], v[160:163]
    v_mfma_f32_16x16x32_bf16 v[160:163], v[124:127], a[24:27], v[160:163]
    v_mfma_f32_16x16x32_bf16 v[164:167], v[112:115], a[4:7], 0
    v_cvt_pk_bf16_f32 v242, v228, v229
    v_cvt_pk_bf16_f32 v243, v230, v231
    v_mfma_f32_16x16x32_bf16 v[164:167], v[116:119], a[12:15], v[164:167]
    buffer_store_dwordx4 v[240:243], v1, s[48:51], s11 offen offset:2048 sc1
    v_mfma_f32_16x16x32_bf16 v[164:167], v[120:123], a[20:23], v[164:167]
    ds_read_b128 v[112:115], v11 offset:9216
    ds_read_b128 v[116:119], v11 offset:11264
    v_mfma_f32_16x16x32_bf16 v[164:167], v[124:127], a[28:31], v[164:167]
    ds_read_b128 v[120:123], v11 offset:13312
    v_mfma_f32_16x16x32_bf16 v[168:171], v[128:131], a[0:3], 0
    ds_read_b128 v[124:127], v11 offset:15360
    v_mfma_f32_16x16x32_bf16 v[168:171], v[132:135], a[8:11], v[168:171]
    s_waitcnt lgkmcnt(4)
    v_mfma_f32_16x16x32_bf16 v[168:171], v[136:139], a[16:19], v[168:171]
    v_mfma_f32_16x16x32_bf16 v[168:171], v[140:143], a[24:27], v[168:171]
    v_mfma_f32_16x16x32_bf16 v[172:175], v[128:131], a[4:7], 0
    ds_read_b128 v[128:131], v11 offset:16384
    v_mfma_f32_16x16x32_bf16 v[172:175], v[132:135], a[12:15], v[172:175]
    ds_read_b128 v[132:135], v11 offset:18432
    v_mfma_f32_16x16x32_bf16 v[172:175], v[136:139], a[20:23], v[172:175]
    ds_read_b128 v[136:139], v11 offset:20480
    v_mfma_f32_16x16x32_bf16 v[172:175], v[140:143], a[28:31], v[172:175]
    ds_read_b128 v[140:143], v11 offset:22528
    v_mfma_f32_16x16x32_bf16 v[160:163], v[144:147], a[32:35], v[160:163]
    v_mfma_f32_16x16x32_bf16 v[160:163], v[148:151], a[40:43], v[160:163]
    v_mfma_f32_16x16x32_bf16 v[160:163], v[104:107], a[48:51], v[160:163]
    v_mfma_f32_16x16x32_bf16 v[160:163], v[108:111], a[56:59], v[160:163]
    v_mfma_f32_16x16x32_bf16 v[164:167], v[144:147], a[36:39], v[164:167]
    ds_read_b128 v[144:147], v11 offset:17408
    v_mfma_f32_16x16x32_bf16 v[164:167], v[148:151], a[44:47], v[164:167]
    ds_read_b128 v[148:151], v11 offset:19456
    v_mfma_f32_16x16x32_bf16 v[164:167], v[104:107], a[52:55], v[164:167]
    ds_read_b128 v[104:107], v11 offset:21504
    v_mfma_f32_16x16x32_bf16 v[164:167], v[108:111], a[60:63], v[164:167]
    s_waitcnt lgkmcnt(3)
    ds_read_b128 v[108:111], v11 offset:23552
    v_mfma_f32_16x16x32_bf16 v[168:171], v[112:115], a[32:35], v[168:171]
    v_mfma_f32_16x16x32_bf16 v[168:171], v[116:119], a[40:43], v[168:171]
    v_mfma_f32_16x16x32_bf16 v[168:171], v[120:123], a[48:51], v[168:171]
    v_mfma_f32_16x16x32_bf16 v[168:171], v[124:127], a[56:59], v[168:171]
    v_mfma_f32_16x16x32_bf16 v[172:175], v[112:115], a[36:39], v[172:175]
    ds_read_b128 v[112:115], v11 offset:24576
    v_mfma_f32_16x16x32_bf16 v[172:175], v[116:119], a[44:47], v[172:175]
    ds_read_b128 v[116:119], v11 offset:26624
    v_mfma_f32_16x16x32_bf16 v[172:175], v[120:123], a[52:55], v[172:175]
    ds_read_b128 v[120:123], v11 offset:28672
    v_mfma_f32_16x16x32_bf16 v[172:175], v[124:127], a[60:63], v[172:175]
    ds_read_b128 v[124:127], v11 offset:30720
    v_mfma_f32_16x16x32_bf16 v[160:163], v[128:131], a[64:67], v[160:163]
    v_mfma_f32_16x16x32_bf16 v[160:163], v[132:135], a[72:75], v[160:163]
    v_mfma_f32_16x16x32_bf16 v[160:163], v[136:139], a[80:83], v[160:163]
    v_mfma_f32_16x16x32_bf16 v[160:163], v[140:143], a[88:91], v[160:163]
    v_mfma_f32_16x16x32_bf16 v[164:167], v[128:131], a[68:71], v[164:167]
    ds_read_b128 v[128:131], v11 offset:25600
    v_mfma_f32_16x16x32_bf16 v[164:167], v[132:135], a[76:79], v[164:167]
    ds_read_b128 v[132:135], v11 offset:27648
    v_mfma_f32_16x16x32_bf16 v[164:167], v[136:139], a[84:87], v[164:167]
    ds_read_b128 v[136:139], v11 offset:29696
    v_mfma_f32_16x16x32_bf16 v[164:167], v[140:143], a[92:95], v[164:167]
    s_waitcnt lgkmcnt(3)
    ds_read_b128 v[140:143], v11 offset:31744
    v_mfma_f32_16x16x32_bf16 v[168:171], v[144:147], a[64:67], v[168:171]
    v_mfma_f32_16x16x32_bf16 v[168:171], v[148:151], a[72:75], v[168:171]
    v_mfma_f32_16x16x32_bf16 v[168:171], v[104:107], a[80:83], v[168:171]
    v_mfma_f32_16x16x32_bf16 v[168:171], v[108:111], a[88:91], v[168:171]
    v_mfma_f32_16x16x32_bf16 v[172:175], v[144:147], a[68:71], v[172:175]
    v_mfma_f32_16x16x32_bf16 v[172:175], v[148:151], a[76:79], v[172:175]
    v_mfma_f32_16x16x32_bf16 v[172:175], v[104:107], a[84:87], v[172:175]
    v_mfma_f32_16x16x32_bf16 v[172:175], v[108:111], a[92:95], v[172:175]
    v_mfma_f32_16x16x32_bf16 v[160:163], v[112:115], a[96:99], v[160:163]
    v_mfma_f32_16x16x32_bf16 v[160:163], v[116:119], a[104:107], v[160:163]
    v_mfma_f32_16x16x32_bf16 v[160:163], v[120:123], a[112:115], v[160:163]
    s_waitcnt vmcnt(0)
    buffer_store_dword v31, v23, s[32:35], s22 offen sc1
    v_mfma_f32_16x16x32_bf16 v[160:163], v[124:127], a[120:123], v[160:163]
    s_waitcnt vmcnt(6)
    s_barrier
    ds_read_b128 v[144:147], v11 offset:32768
    v_mfma_f32_16x16x32_bf16 v[164:167], v[112:115], a[100:103], v[164:167]
    ds_read_b128 v[148:151], v11 offset:34816
    ds_read_b128 v[104:107], v11 offset:36864
    v_mfma_f32_16x16x32_bf16 v[164:167], v[116:119], a[108:111], v[164:167]
    ds_read_b128 v[108:111], v11 offset:38912
    v_mfma_f32_16x16x32_bf16 v[164:167], v[120:123], a[116:119], v[164:167]
    ds_read_b128 v[112:115], v11 offset:33792
    v_mfma_f32_16x16x32_bf16 v[164:167], v[124:127], a[124:127], v[164:167]
    s_waitcnt lgkmcnt(5)
    ds_read_b128 v[116:119], v11 offset:35840
    v_mfma_f32_16x16x32_bf16 v[168:171], v[128:131], a[96:99], v[168:171]
    ds_read_b128 v[120:123], v11 offset:37888
    v_mfma_f32_16x16x32_bf16 v[168:171], v[132:135], a[104:107], v[168:171]
    ds_read_b128 v[124:127], v11 offset:39936
    v_mfma_f32_16x16x32_bf16 v[168:171], v[136:139], a[112:115], v[168:171]
    v_mfma_f32_16x16x32_bf16 v[168:171], v[140:143], a[120:123], v[168:171]
    v_mfma_f32_16x16x32_bf16 v[172:175], v[128:131], a[100:103], v[172:175]
    ds_read_b128 v[128:131], v11 offset:40960
    v_mfma_f32_16x16x32_bf16 v[172:175], v[132:135], a[108:111], v[172:175]
    ds_read_b128 v[132:135], v11 offset:43008
    v_mfma_f32_16x16x32_bf16 v[172:175], v[136:139], a[116:119], v[172:175]
    ds_read_b128 v[136:139], v11 offset:45056
    v_mfma_f32_16x16x32_bf16 v[172:175], v[140:143], a[124:127], v[172:175]
    s_waitcnt lgkmcnt(3)
    ds_read_b128 v[140:143], v11 offset:47104
    v_mfma_f32_16x16x32_bf16 v[160:163], v[144:147], a[128:131], v[160:163]
    v_mfma_f32_16x16x32_bf16 v[160:163], v[148:151], a[136:139], v[160:163]
    v_mfma_f32_16x16x32_bf16 v[160:163], v[104:107], a[144:147], v[160:163]
    v_mfma_f32_16x16x32_bf16 v[160:163], v[108:111], a[152:155], v[160:163]
    v_mfma_f32_16x16x32_bf16 v[164:167], v[144:147], a[132:135], v[164:167]
    ds_read_b128 v[144:147], v11 offset:41984
    v_mfma_f32_16x16x32_bf16 v[164:167], v[148:151], a[140:143], v[164:167]
    ds_read_b128 v[148:151], v11 offset:44032
    v_mfma_f32_16x16x32_bf16 v[164:167], v[104:107], a[148:151], v[164:167]
    ds_read_b128 v[104:107], v11 offset:46080
    v_mfma_f32_16x16x32_bf16 v[164:167], v[108:111], a[156:159], v[164:167]
    ds_read_b128 v[108:111], v11 offset:48128
    v_mfma_f32_16x16x32_bf16 v[168:171], v[112:115], a[128:131], v[168:171]
    v_mfma_f32_16x16x32_bf16 v[168:171], v[116:119], a[136:139], v[168:171]
    v_mfma_f32_16x16x32_bf16 v[168:171], v[120:123], a[144:147], v[168:171]
    v_mfma_f32_16x16x32_bf16 v[168:171], v[124:127], a[152:155], v[168:171]
    v_mfma_f32_16x16x32_bf16 v[172:175], v[112:115], a[132:135], v[172:175]
    ds_read_b128 v[112:115], v11 offset:49152
    v_mfma_f32_16x16x32_bf16 v[172:175], v[116:119], a[140:143], v[172:175]
    ds_read_b128 v[116:119], v11 offset:51200
    v_mfma_f32_16x16x32_bf16 v[172:175], v[120:123], a[148:151], v[172:175]
    ds_read_b128 v[120:123], v11 offset:53248
    v_mfma_f32_16x16x32_bf16 v[172:175], v[124:127], a[156:159], v[172:175]
    s_waitcnt lgkmcnt(3)
    ds_read_b128 v[124:127], v11 offset:55296
    v_mfma_f32_16x16x32_bf16 v[160:163], v[128:131], a[160:163], v[160:163]
    v_mfma_f32_16x16x32_bf16 v[160:163], v[132:135], a[168:171], v[160:163]
    v_mfma_f32_16x16x32_bf16 v[160:163], v[136:139], a[176:179], v[160:163]
    v_mfma_f32_16x16x32_bf16 v[160:163], v[140:143], a[184:187], v[160:163]
    v_mfma_f32_16x16x32_bf16 v[164:167], v[128:131], a[164:167], v[164:167]
    ds_read_b128 v[128:131], v11 offset:50176
    v_mfma_f32_16x16x32_bf16 v[164:167], v[132:135], a[172:175], v[164:167]
    buffer_load_dword v3, v19, s[32:35], s66 offen sc1
    v_mfma_f32_16x16x32_bf16 v[164:167], v[136:139], a[180:183], v[164:167]
    ds_read_b128 v[132:135], v11 offset:52224
    ds_read_b128 v[136:139], v11 offset:54272
    v_mfma_f32_16x16x32_bf16 v[164:167], v[140:143], a[188:191], v[164:167]
    ds_read_b128 v[140:143], v11 offset:56320
    v_mfma_f32_16x16x32_bf16 v[168:171], v[144:147], a[160:163], v[168:171]
    v_mfma_f32_16x16x32_bf16 v[168:171], v[148:151], a[168:171], v[168:171]
    v_mfma_f32_16x16x32_bf16 v[168:171], v[104:107], a[176:179], v[168:171]
    v_mfma_f32_16x16x32_bf16 v[168:171], v[108:111], a[184:187], v[168:171]
    v_mfma_f32_16x16x32_bf16 v[172:175], v[144:147], a[164:167], v[172:175]
    ds_read_b128 v[144:147], v11 offset:57344
    v_mfma_f32_16x16x32_bf16 v[172:175], v[148:151], a[172:175], v[172:175]
    ds_read_b128 v[148:151], v11 offset:59392
    v_mfma_f32_16x16x32_bf16 v[172:175], v[104:107], a[180:183], v[172:175]
    ds_read_b128 v[104:107], v11 offset:61440
    v_mfma_f32_16x16x32_bf16 v[172:175], v[108:111], a[188:191], v[172:175]
    s_waitcnt lgkmcnt(3)
    ds_read_b128 v[108:111], v11 offset:63488
    v_mfma_f32_16x16x32_bf16 v[160:163], v[112:115], a[192:195], v[160:163]
    v_mfma_f32_16x16x32_bf16 v[160:163], v[116:119], a[200:203], v[160:163]
    v_mfma_f32_16x16x32_bf16 v[160:163], v[120:123], a[208:211], v[160:163]
    v_mfma_f32_16x16x32_bf16 v[160:163], v[124:127], a[216:219], v[160:163]
    v_mfma_f32_16x16x32_bf16 v[164:167], v[112:115], a[196:199], v[164:167]
    ds_read_b128 v[112:115], v11 offset:58368
    v_mfma_f32_16x16x32_bf16 v[164:167], v[116:119], a[204:207], v[164:167]
    ds_read_b128 v[116:119], v11 offset:60416
    v_mfma_f32_16x16x32_bf16 v[164:167], v[120:123], a[212:215], v[164:167]
    ds_read_b128 v[120:123], v11 offset:62464
    v_mfma_f32_16x16x32_bf16 v[164:167], v[124:127], a[220:223], v[164:167]
    ds_read_b128 v[124:127], v11 offset:64512
    v_mfma_f32_16x16x32_bf16 v[168:171], v[128:131], a[192:195], v[168:171]
    v_mfma_f32_16x16x32_bf16 v[168:171], v[132:135], a[200:203], v[168:171]
    v_mfma_f32_16x16x32_bf16 v[168:171], v[136:139], a[208:211], v[168:171]
    v_mfma_f32_16x16x32_bf16 v[168:171], v[140:143], a[216:219], v[168:171]
    v_mfma_f32_16x16x32_bf16 v[172:175], v[128:131], a[196:199], v[172:175]
    ds_read_b128 v[128:131], v13 offset:12288
    v_mfma_f32_16x16x32_bf16 v[172:175], v[132:135], a[204:207], v[172:175]
    ds_read_b128 v[132:135], v13 offset:13312
    v_mfma_f32_16x16x32_bf16 v[172:175], v[136:139], a[212:215], v[172:175]
    ds_read_b128 v[136:139], v13 offset:14336
    v_mfma_f32_16x16x32_bf16 v[172:175], v[140:143], a[220:223], v[172:175]
    s_waitcnt lgkmcnt(3)
    ds_read_b128 v[140:143], v13 offset:16384
    v_mfma_f32_16x16x32_bf16 v[160:163], v[144:147], a[224:227], v[160:163]
    s_waitcnt vmcnt(0)
    v_cmp_gt_u32 vcc, 2, v3
    s_nop 1
    s_and_b64 vcc, vcc, exec
    s_cbranch_scc1 SPIN_X
BACK_X:
    v_mfma_f32_16x16x32_bf16 v[160:163], v[148:151], a[232:235], v[160:163]
    buffer_load_dwordx4 v[200:203], v1, s[48:51], s98 offen offset:2048 sc1
    v_mfma_f32_16x16x32_bf16 v[160:163], v[104:107], a[240:243], v[160:163]
    s_add_u32 s98, s70, 12288
    buffer_load_dwordx4 v[204:207], v1, s[48:51], s98 offen offset:2048 sc1
    v_mfma_f32_16x16x32_bf16 v[160:163], v[108:111], a[248:251], v[160:163]
    s_add_u32 s98, s70, 24576
    v_mfma_f32_16x16x32_bf16 v[164:167], v[144:147], a[228:231], v[164:167]
    ds_read_b128 v[144:147], v13 offset:17408
    v_mfma_f32_16x16x32_bf16 v[164:167], v[148:151], a[236:239], v[164:167]
    buffer_load_dwordx4 v[208:211], v1, s[48:51], s98 offen offset:2048 sc1
    v_mfma_f32_16x16x32_bf16 v[164:167], v[104:107], a[244:247], v[164:167]
    s_add_u32 s98, s23, 0
    ds_read_b128 v[148:151], v13 offset:18432
    ds_read_b128 v[104:107], v13 offset:20480
    v_mfma_f32_16x16x32_bf16 v[164:167], v[108:111], a[252:255], v[164:167]
    ds_read_b128 v[108:111], v13 offset:21504
    v_mfma_f32_16x16x32_bf16 v[168:171], v[112:115], a[224:227], v[168:171]
    v_mfma_f32_16x16x32_bf16 v[168:171], v[116:119], a[232:235], v[168:171]
    buffer_load_dwordx4 v[176:179], v1, s[48:51], s98 offen offset:0 sc1
    v_mfma_f32_16x16x32_bf16 v[168:171], v[120:123], a[240:243], v[168:171]
    s_add_u32 s98, s23, 12288
    v_mfma_f32_16x16x32_bf16 v[168:171], v[124:127], a[248:251], v[168:171]
    v_mfma_f32_16x16x32_bf16 v[172:175], v[112:115], a[228:231], v[172:175]
    ds_read_b128 v[112:115], v13 offset:22528
    v_mfma_f32_16x16x32_bf16 v[172:175], v[116:119], a[236:239], v[172:175]
    buffer_load_dwordx4 v[180:183], v1, s[48:51], s98 offen offset:0 sc1
    v_mfma_f32_16x16x32_bf16 v[172:175], v[120:123], a[244:247], v[172:175]
    s_add_u32 s98, s23, 24576
    ds_read_b128 v[116:119], v13 offset:24576
    ds_read_b128 v[120:123], v13 offset:25600
    v_mfma_f32_16x16x32_bf16 v[172:175], v[124:127], a[252:255], v[172:175]
    s_waitcnt lgkmcnt(3)
    ds_read_b128 v[124:127], v13 offset:26624
    v_mfma_f32_16x16x32_bf16 v[160:163], v[128:131], v[32:35], v[160:163]
    v_mfma_f32_16x16x32_bf16 v[160:163], v[132:135], v[40:43], v[160:163]
    buffer_load_dwordx4 v[184:187], v1, s[48:51], s98 offen offset:0 sc1
    v_mfma_f32_16x16x32_bf16 v[160:163], v[136:139], v[48:51], v[160:163]
    s_add_u32 s98, s23, 0
    v_mfma_f32_16x16x32_bf16 v[164:167], v[128:131], v[36:39], v[164:167]
    v_mfma_f32_16x16x32_bf16 v[164:167], v[132:135], v[44:47], v[164:167]
    v_mfma_f32_16x16x32_bf16 v[164:167], v[136:139], v[52:55], v[164:167]
    buffer_load_dwordx4 v[188:191], v1, s[48:51], s98 offen offset:1024 sc1
    v_mfma_f32_16x16x32_bf16 v[168:171], v[140:143], v[32:35], v[168:171]
    s_add_u32 s98, s23, 12288
    v_mfma_f32_16x16x32_bf16 v[168:171], v[144:147], v[40:43], v[168:171]
    v_mfma_f32_16x16x32_bf16 v[168:171], v[148:151], v[48:51], v[168:171]
    v_mfma_f32_16x16x32_bf16 v[172:175], v[140:143], v[36:39], v[172:175]
    buffer_load_dwordx4 v[192:195], v1, s[48:51], s98 offen offset:1024 sc1
    v_mfma_f32_16x16x32_bf16 v[172:175], v[144:147], v[44:47], v[172:175]
    s_add_u32 s98, s23, 24576
    v_mfma_f32_16x16x32_bf16 v[172:175], v[148:151], v[52:55], v[172:175]
    v_mfma_f32_16x16x32_bf16 v[160:163], v[104:107], v[56:59], v[160:163]
    v_mfma_f32_16x16x32_bf16 v[160:163], v[108:111], v[64:67], v[160:163]
    s_waitcnt lgkmcnt(0)
    buffer_load_dwordx4 v[196:199], v1, s[48:51], s98 offen offset:1024 sc1
    v_mfma_f32_16x16x32_bf16 v[160:163], v[112:115], v[72:75], v[160:163]
    v_mfma_f32_16x16x32_bf16 v[164:167], v[104:107], v[60:63], v[164:167]
    v_mfma_f32_16x16x32_bf16 v[164:167], v[108:111], v[68:71], v[164:167]
    v_mfma_f32_16x16x32_bf16 v[164:167], v[112:115], v[76:79], v[164:167]
    v_mfma_f32_16x16x32_bf16 v[168:171], v[116:119], v[56:59], v[168:171]
    v_mfma_f32_16x16x32_bf16 v[168:171], v[120:123], v[64:67], v[168:171]
    v_mfma_f32_16x16x32_bf16 v[168:171], v[124:127], v[72:75], v[168:171]
    v_mfma_f32_16x16x32_bf16 v[172:175], v[116:119], v[60:63], v[172:175]
    v_mfma_f32_16x16x32_bf16 v[172:175], v[120:123], v[68:71], v[172:175]
    v_mfma_f32_16x16x32_bf16 v[172:175], v[124:127], v[76:79], v[172:175]
    s_cmp_lg_u32 s4, s61
    s_cbranch_scc1 K1_X2
    s_waitcnt vmcnt(6)
    v_lshlrev_b32 v80, 16, v200
    v_and_b32 v81, 0xffff0000, v200
    v_lshlrev_b32 v82, 16, v204
    v_and_b32 v83, 0xffff0000, v204
    v_lshlrev_b32 v84, 16, v208
    v_and_b32 v85, 0xffff0000, v208
    v_pk_add_f32 v[80:81], v[80:81], v[82:83]
    v_pk_add_f32 v[224:225], v[224:225], v[84:85]
    v_pk_add_f32 v[224:225], v[224:225], v[80:81]
    v_cvt_pk_bf16_f32 v200, v224, v225
    v_lshlrev_b32 v86, 16, v201
    v_and_b32 v87, 0xffff0000, v201
    v_lshlrev_b32 v88, 16, v205
    v_and_b32 v89, 0xffff0000, v205
    v_lshlrev_b32 v90, 16, v209
    v_and_b32 v91, 0xffff0000, v209
    v_pk_add_f32 v[86:87], v[86:87], v[88:89]
    v_pk_add_f32 v[226:227], v[226:227], v[90:91]
    v_pk_add_f32 v[226:227], v[226:227], v[86:87]
    v_cvt_pk_bf16_f32 v201, v226, v227
    buffer_store_dwordx2 v[200:201], v20, s[24:27], s65 offen
    v_lshlrev_b32 v92, 16, v202
    v_and_b32 v93, 0xffff0000, v202
    v_lshlrev_b32 v94, 16, v206
    v_and_b32 v95, 0xffff0000, v206
    v_lshlrev_b32 v96, 16, v210
    v_and_b32 v97, 0xffff0000, v210
    v_pk_add_f32 v[92:93], v[92:93], v[94:95]
    v_pk_add_f32 v[228:229], v[228:229], v[96:97]
    v_pk_add_f32 v[228:229], v[228:229], v[92:93]
    v_cvt_pk_bf16_f32 v202, v228, v229
    v_lshlrev_b32 v98, 16, v203
    v_and_b32 v99, 0xffff0000, v203
    v_lshlrev_b32 v100, 16, v207
    v_and_b32 v101, 0xffff0000, v207
    v_lshlrev_b32 v102, 16, v211
    v_and_b32 v103, 0xffff0000, v211
    v_pk_add_f32 v[98:99], v[98:99], v[100:101]
    v_pk_add_f32 v[230:231], v[230:231], v[102:103]
    v_pk_add_f32 v[230:231], v[230:231], v[98:99]
    v_cvt_pk_bf16_f32 v203, v230, v231
    buffer_store_dwordx2 v[202:203], v21, s[24:27], s65 offen
    s_waitcnt vmcnt(2)
K1_X2:
    s_waitcnt vmcnt(3)
    v_lshlrev_b32 v80, 16, v176
    v_and_b32 v81, 0xffff0000, v176
    v_lshlrev_b32 v82, 16, v180
    v_and_b32 v83, 0xffff0000, v180
    v_lshlrev_b32 v84, 16, v184
    v_and_b32 v85, 0xffff0000, v184
    v_pk_add_f32 v[80:81], v[80:81], v[82:83]
    v_pk_add_f32 v[160:161], v[160:161], v[84:85]
    v_pk_add_f32 v[160:161], v[160:161], v[80:81]
    v_cvt_pk_bf16_f32 v176, v160, v161
    v_lshlrev_b32 v86, 16, v177
    v_and_b32 v87, 0xffff0000, v177
    v_lshlrev_b32 v88, 16, v181
    v_and_b32 v89, 0xffff0000, v181
    v_lshlrev_b32 v90, 16, v185
    v_and_b32 v91, 0xffff0000, v185
    v_pk_add_f32 v[86:87], v[86:87], v[88:89]
    v_pk_add_f32 v[162:163], v[162:163], v[90:91]
    v_pk_add_f32 v[162:163], v[162:163], v[86:87]
    v_cvt_pk_bf16_f32 v177, v162, v163
    buffer_store_dwordx2 v[176:177], v20, s[24:27], s64 offen
    v_lshlrev_b32 v92, 16, v178
    v_and_b32 v93, 0xffff0000, v178
    v_lshlrev_b32 v94, 16, v182
    v_and_b32 v95, 0xffff0000, v182
    v_lshlrev_b32 v96, 16, v186
    v_and_b32 v97, 0xffff0000, v186
    v_pk_add_f32 v[92:93], v[92:93], v[94:95]
    v_pk_add_f32 v[164:165], v[164:165], v[96:97]
    v_pk_add_f32 v[164:165], v[164:165], v[92:93]
    v_cvt_pk_bf16_f32 v178, v164, v165
    v_lshlrev_b32 v98, 16, v179
    v_and_b32 v99, 0xffff0000, v179
    v_lshlrev_b32 v100, 16, v183
    v_and_b32 v101, 0xffff0000, v183
    v_lshlrev_b32 v102, 16, v187
    v_and_b32 v103, 0xffff0000, v187
    v_pk_add_f32 v[98:99], v[98:99], v[100:101]
    v_pk_add_f32 v[166:167], v[166:167], v[102:103]
    v_pk_add_f32 v[166:167], v[166:167], v[98:99]
    v_cvt_pk_bf16_f32 v179, v166, v167
    buffer_store_dwordx2 v[178:179], v21, s[24:27], s64 offen
    s_waitcnt vmcnt(2)
    v_lshlrev_b32 v80, 16, v188
    v_and_b32 v81, 0xffff0000, v188
    v_lshlrev_b32 v82, 16, v192
    v_and_b32 v83, 0xffff0000, v192
    v_lshlrev_b32 v84, 16, v196
    v_and_b32 v85, 0xffff0000, v196
    v_pk_add_f32 v[80:81], v[80:81], v[82:83]
    v_pk_add_f32 v[168:169], v[168:169], v[84:85]
    v_pk_add_f32 v[168:169], v[168:169], v[80:81]
    v_cvt_pk_bf16_f32 v188, v168, v169
    v_lshlrev_b32 v86, 16, v189
    v_and_b32 v87, 0xffff0000, v189
    v_lshlrev_b32 v88, 16, v193
    v_and_b32 v89, 0xffff0000, v193
    v_lshlrev_b32 v90, 16, v197
    v_and_b32 v91, 0xffff0000, v197
    v_pk_add_f32 v[86:87], v[86:87], v[88:89]
    v_pk_add_f32 v[170:171], v[170:171], v[90:91]
    v_pk_add_f32 v[170:171], v[170:171], v[86:87]
    v_cvt_pk_bf16_f32 v189, v170, v171
    buffer_store_dwordx2 v[188:189], v20, s[24:27], s64 offen offset:32
    v_lshlrev_b32 v92, 16, v190
    v_and_b32 v93, 0xffff0000, v190
    v_lshlrev_b32 v94, 16, v194
    v_and_b32 v95, 0xffff0000, v194
    v_lshlrev_b32 v96, 16, v198
    v_and_b32 v97, 0xffff0000, v198
    v_pk_add_f32 v[92:93], v[92:93], v[94:95]
    v_pk_add_f32 v[172:173], v[172:173], v[96:97]
    v_pk_add_f32 v[172:173], v[172:173], v[92:93]
    v_cvt_pk_bf16_f32 v190, v172, v173
    v_lshlrev_b32 v98, 16, v191
    v_and_b32 v99, 0xffff0000, v191
    v_lshlrev_b32 v100, 16, v195
    v_and_b32 v101, 0xffff0000, v195
    v_lshlrev_b32 v102, 16, v199
    v_and_b32 v103, 0xffff0000, v199
    v_pk_add_f32 v[98:99], v[98:99], v[100:101]
    v_pk_add_f32 v[174:175], v[174:175], v[102:103]
    v_pk_add_f32 v[174:175], v[174:175], v[98:99]
    v_cvt_pk_bf16_f32 v191, v174, v175
    buffer_store_dwordx2 v[190:191], v21, s[24:27], s64 offen offset:32
K1_END:
    s_endpgm
K1_LB_MASK:
    s_nop 1
    v_add_f32 v212, s12, v144
    v_fma_f32 v176, v208, s8, v212
    v_fma_f32 v177, v209, s8, v212
    v_fma_f32 v178, v210, s8, v212
    v_fma_f32 v179, v211, s8, v212
    v_add_f32 v213, s13, v144
    v_fma_f32 v180, v208, s9, v213
    v_fma_f32 v181, v209, s9, v213
    v_fma_f32 v182, v210, s9, v213
    v_fma_f32 v183, v211, s9, v213
    v_add_f32 v214, s14, v144
    v_fma_f32 v184, v208, s10, v214
    v_fma_f32 v185, v209, s10, v214
    v_fma_f32 v186, v210, s10, v214
    v_fma_f32 v187, v211, s10, v214
    v_add_f32 v215, s15, v144
    v_fma_f32 v188, v208, s11, v215
    v_fma_f32 v189, v209, s11, v215
    v_fma_f32 v190, v210, s11, v215
    v_fma_f32 v191, v211, s11, v215
    s_nop 1
    s_branch K1_LB_BACK
K1_LS_MASK:
    s_nop 1
    v_add_f32 v212, s12, v152
    v_fma_f32 v176, v208, s8, v212
    v_fma_f32 v177, v209, s8, v212
    v_fma_f32 v178, v210, s8, v212
    v_fma_f32 v179, v211, s8, v212
    v_add_f32 v213, s13, v152
    v_fma_f32 v180, v208, s9, v213
    v_fma_f32 v181, v209, s9, v213
    v_fma_f32 v182, v210, s9, v213
    v_fma_f32 v183, v211, s9, v213
    v_add_f32 v214, s14, v152
    v_fma_f32 v184, v208, s10, v214
    v_fma_f32 v185, v209, s10, v214
    v_fma_f32 v186, v210, s10, v214
    v_fma_f32 v187, v211, s10, v214
    v_add_f32 v215, s15, v152
    v_fma_f32 v188, v208, s11, v215
    v_fma_f32 v189, v209, s11, v215
    v_fma_f32 v190, v210, s11, v215
    v_fma_f32 v191, v211, s11, v215
    s_nop 1
    s_branch K1_LS_BACK
K1_HAVEM_R:
    s_add_u32 m0, s76, s75
    s_nop 0
    buffer_load_dwordx4 v1, s[36:39], s77 offen sc1 lds
    buffer_load_dwordx4 v1, s[36:39], s77 offen offset:1024 sc1 lds
    buffer_load_dwordx4 v1, s[36:39], s77 offen offset:2048 sc1 lds
    buffer_load_dwordx4 v1, s[36:39], s77 offen offset:3072 sc1 lds
    s_add_u32 s100, s77, 4096
    s_add_u32 m0, m0, 4096
    s_nop 0
    buffer_load_dwordx4 v1, s[36:39], s100 offen sc1 lds
    buffer_load_dwordx4 v1, s[36:39], s100 offen offset:1024 sc1 lds
    buffer_load_dwordx4 v1, s[36:39], s100 offen offset:2048 sc1 lds
    buffer_load_dwordx4 v1, s[36:39], s100 offen offset:3072 sc1 lds
    s_add_u32 s77, s77, 32768
    s_add_u32 s76, s76, 32768
    s_branch K1_HAVEM
K1_REDO:
    s_mov_b32 s83, 1
    s_mov_b32 s63, 1073741824
    s_mov_b32 s64, 1073741824
    s_mov_b32 s50, 0
    s_mov_b32 s54, 0
    s_waitcnt vmcnt(0) lgkmcnt(0)
    s_barrier
    v_lshrrev_b32 v92, 4, v1
    v_and_b32 v64, 15, v92
    v_lshrrev_b32 v92, 4, v92
    v_lshlrev_b32 v92, 2, v92
    v_sub_u32 v92, v64, v92
    s_lshl_b32 s98, s4, 4
    v_add_u32 v92, s98, v92
    s_lshl_b32 s98, s6, 7
    s_sub_u32 s99, 1920, s98
    v_add_u32 v64, s98, v92
    v_add_u32 v65, 64, v64
    v_add_u32 v66, s99, v92
    v_add_u32 v67, 64, v66
    v_mov_b32 v93, 0xf149f2ca
    v_mov_b32 v68, v93
    v_mov_b32 v69, v93
    v_mov_b32 v70, v93
    v_mov_b32 v71, v93
    s_mov_b32 s78, 0
    s_add_u32 s99, s99, 128
K1_REDO_L:
    s_lshr_b32 s7, s78, 6
    s_lshl_b32 s7, s7, 15
    s_bfe_u32 s98, s78, 0x20004
    s_lshl_b32 s98, s98, 12
    s_add_u32 s7, s7, s98
    buffer_load_dwordx4 v[72:75], v1, s[36:39], s7 offen offset:0 sc1
    buffer_load_dwordx4 v[76:79], v1, s[36:39], s7 offen offset:1024 sc1
    buffer_load_dwordx4 v[80:83], v1, s[36:39], s7 offen offset:2048 sc1
    buffer_load_dwordx4 v[84:87], v1, s[36:39], s7 offen offset:3072 sc1
    s_waitcnt vmcnt(0)
    v_mfma_f32_16x16x32_bf16 v[88:91], v[72:75], v[128:131], 0
    v_mfma_f32_16x16x32_bf16 v[88:91], v[76:79], v[160:163], v[88:91]
    v_mfma_f32_16x16x32_bf16 v[88:91], v[80:83], v[192:195], v[88:91]
    v_mfma_f32_16x16x32_bf16 v[88:91], v[84:87], v[224:227], v[88:91]
    v_subrev_u32 v92, s78, v64
    v_cmp_le_i32 vcc, 0, v92
    s_nop 5
    v_cndmask_b32 v88, v93, v88, vcc
    v_max_f32 v68, v68, v88
    v_cmp_le_i32 vcc, 1, v92
    s_nop 1
    v_cndmask_b32 v89, v93, v89, vcc
    v_max_f32 v68, v68, v89
    v_cmp_le_i32 vcc, 2, v92
    s_nop 1
    v_cndmask_b32 v90, v93, v90, vcc
    v_max_f32 v68, v68, v90
    v_cmp_le_i32 vcc, 3, v92
    s_nop 1
    v_cndmask_b32 v91, v93, v91, vcc
    v_max_f32 v68, v68, v91
    v_mfma_f32_16x16x32_bf16 v[88:91], v[72:75], v[132:135], 0
    v_mfma_f32_16x16x32_bf16 v[88:91], v[76:79], v[164:167], v[88:91]
    v_mfma_f32_16x16x32_bf16 v[88:91], v[80:83], v[196:199], v[88:91]
    v_mfma_f32_16x16x32_bf16 v[88:91], v[84:87], v[228:231], v[88:91]
    v_subrev_u32 v92, s78, v65
    v_cmp_le_i32 vcc, 0, v92
    s_nop 5
    v_cndmask_b32 v88, v93, v88, vcc
    v_max_f32 v69, v69, v88
    v_cmp_le_i32 vcc, 1, v92
    s_nop 1
    v_cndmask_b32 v89, v93, v89, vcc
    v_max_f32 v69, v69, v89
    v_cmp_le_i32 vcc, 2, v92
    s_nop 1
    v_cndmask_b32 v90, v93, v90, vcc
    v_max_f32 v69, v69, v90
    v_cmp_le_i32 vcc, 3, v92
    s_nop 1
    v_cndmask_b32 v91, v93, v91, vcc
    v_max_f32 v69, v69, v91
    v_mfma_f32_16x16x32_bf16 v[88:91], v[72:75], v[136:139], 0
    v_mfma_f32_16x16x32_bf16 v[88:91], v[76:79], v[168:171], v[88:91]
    v_mfma_f32_16x16x32_bf16 v[88:91], v[80:83], v[200:203], v[88:91]
    v_mfma_f32_16x16x32_bf16 v[88:91], v[84:87], v[232:235], v[88:91]
    v_subrev_u32 v92, s78, v66
    v_cmp_le_i32 vcc, 0, v92
    s_nop 5
    v_cndmask_b32 v88, v93, v88, vcc
    v_max_f32 v70, v70, v88
    v_cmp_le_i32 vcc, 1, v92
    s_nop 1
    v_cndmask_b32 v89, v93, v89, vcc
    v_max_f32 v70, v70, v89
    v_cmp_le_i32 vcc, 2, v92
    s_nop 1
    v_cndmask_b32 v90, v93, v90, vcc
    v_max_f32 v70, v70, v90
    v_cmp_le_i32 vcc, 3, v92
    s_nop 1
    v_cndmask_b32 v91, v93, v91, vcc
    v_max_f32 v70, v70, v91
    v_mfma_f32_16x16x32_bf16 v[88:91], v[72:75], v[140:143], 0
    v_mfma_f32_16x16x32_bf16 v[88:91], v[76:79], v[172:175], v[88:91]
    v_mfma_f32_16x16x32_bf16 v[88:91], v[80:83], v[204:207], v[88:91]
    v_mfma_f32_16x16x32_bf16 v[88:91], v[84:87], v[236:239], v[88:91]
    v_subrev_u32 v92, s78, v67
    v_cmp_le_i32 vcc, 0, v92
    s_nop 5
    v_cndmask_b32 v88, v93, v88, vcc
    v_max_f32 v71, v71, v88
    v_cmp_le_i32 vcc, 1, v92
    s_nop 1
    v_cndmask_b32 v89, v93, v89, vcc
    v_max_f32 v71, v71, v89
    v_cmp_le_i32 vcc, 2, v92
    s_nop 1
    v_cndmask_b32 v90, v93, v90, vcc
    v_max_f32 v71, v71, v90
    v_cmp_le_i32 vcc, 3, v92
    s_nop 1
    v_cndmask_b32 v91, v93, v91, vcc
    v_max_f32 v71, v71, v91
    s_add_u32 s78, s78, 16
    s_cmp_lt_u32 s78, s99
    s_cbranch_scc1 K1_REDO_L
    v_mov_b32 v92, v68
    s_nop 1
    v_permlane32_swap_b32 v68, v92
    v_max_f32 v68, v68, v92
    v_mov_b32 v92, v68
    s_nop 1
    v_permlane16_swap_b32 v68, v92
    v_max_f32 v68, v68, v92
    v_sub_f32 v144, 0, v68
    v_sub_f32 v145, 0, v68
    v_sub_f32 v146, 0, v68
    v_sub_f32 v147, 0, v68
    v_mov_b32 v92, v69
    s_nop 1
    v_permlane32_swap_b32 v69, v92
    v_max_f32 v69, v69, v92
    v_mov_b32 v92, v69
    s_nop 1
    v_permlane16_swap_b32 v69, v92
    v_max_f32 v69, v69, v92
    v_sub_f32 v148, 0, v69
    v_sub_f32 v149, 0, v69
    v_sub_f32 v150, 0, v69
    v_sub_f32 v151, 0, v69
    v_mov_b32 v92, v70
    s_nop 1
    v_permlane32_swap_b32 v70, v92
    v_max_f32 v70, v70, v92
    v_mov_b32 v92, v70
    s_nop 1
    v_permlane16_swap_b32 v70, v92
    v_max_f32 v70, v70, v92
    v_sub_f32 v152, 0, v70
    v_sub_f32 v153, 0, v70
    v_sub_f32 v154, 0, v70
    v_sub_f32 v155, 0, v70
    v_mov_b32 v92, v71
    s_nop 1
    v_permlane32_swap_b32 v71, v92
    v_max_f32 v71, v71, v92
    v_mov_b32 v92, v71
    s_nop 1
    v_permlane16_swap_b32 v71, v92
    v_max_f32 v71, v71, v92
    v_sub_f32 v156, 0, v71
    v_sub_f32 v157, 0, v71
    v_sub_f32 v158, 0, v71
    v_sub_f32 v159, 0, v71
    v_accvgpr_write_b32 a0, 0
    v_accvgpr_write_b32 a1, 0
    v_accvgpr_write_b32 a2, 0
    v_accvgpr_write_b32 a3, 0
    v_accvgpr_write_b32 a4, 0
    v_accvgpr_write_b32 a5, 0
    v_accvgpr_write_b32 a6, 0
    v_accvgpr_write_b32 a7, 0
    v_accvgpr_write_b32 a8, 0
    v_accvgpr_write_b32 a9, 0
    v_accvgpr_write_b32 a10, 0
    v_accvgpr_write_b32 a11, 0
    v_accvgpr_write_b32 a12, 0
    v_accvgpr_write_b32 a13, 0
    v_accvgpr_write_b32 a14, 0
    v_accvgpr_write_b32 a15, 0
    v_accvgpr_write_b32 a16, 0
    v_accvgpr_write_b32 a17, 0
    v_accvgpr_write_b32 a18, 0
    v_accvgpr_write_b32 a19, 0
    v_accvgpr_write_b32 a20, 0
    v_accvgpr_write_b32 a21, 0
    v_accvgpr_write_b32 a22, 0
    v_accvgpr_write_b32 a23, 0
    v_accvgpr_write_b32 a24, 0
    v_accvgpr_write_b32 a25, 0
    v_accvgpr_write_b32 a26, 0
    v_accvgpr_write_b32 a27, 0
    v_accvgpr_write_b32 a28, 0
    v_accvgpr_write_b32 a29, 0
    v_accvgpr_write_b32 a30, 0
    v_accvgpr_write_b32 a31, 0
    v_accvgpr_write_b32 a32, 0
    v_accvgpr_write_b32 a33, 0
    v_accvgpr_write_b32 a34, 0
    v_accvgpr_write_b32 a35, 0
    v_accvgpr_write_b32 a36, 0
    v_accvgpr_write_b32 a37, 0
    v_accvgpr_write_b32 a38, 0
    v_accvgpr_write_b32 a39, 0
    v_accvgpr_write_b32 a40, 0
    v_accvgpr_write_b32 a41, 0
    v_accvgpr_write_b32 a42, 0
    v_accvgpr_write_b32 a43, 0
    v_accvgpr_write_b32 a44, 0
    v_accvgpr_write_b32 a45, 0
    v_accvgpr_write_b32 a46, 0
    v_accvgpr_write_b32 a47, 0
    v_accvgpr_write_b32 a48, 0
    v_accvgpr_write_b32 a49, 0
    v_accvgpr_write_b32 a50, 0
    v_accvgpr_write_b32 a51, 0
    v_accvgpr_write_b32 a52, 0
    v_accvgpr_write_b32 a53, 0
    v_accvgpr_write_b32 a54, 0
    v_accvgpr_write_b32 a55, 0
    v_accvgpr_write_b32 a56, 0
    v_accvgpr_write_b32 a57, 0
    v_accvgpr_write_b32 a58, 0
    v_accvgpr_write_b32 a59, 0
    v_accvgpr_write_b32 a60, 0
    v_accvgpr_write_b32 a61, 0
    v_accvgpr_write_b32 a62, 0
    v_accvgpr_write_b32 a63, 0
    v_accvgpr_write_b32 a144, 0
    v_accvgpr_write_b32 a145, 0
    v_accvgpr_write_b32 a146, 0
    v_accvgpr_write_b32 a147, 0
    v_accvgpr_write_b32 a148, 0
    v_accvgpr_write_b32 a149, 0
    v_accvgpr_write_b32 a150, 0
    v_accvgpr_write_b32 a151, 0
    v_accvgpr_write_b32 a152, 0
    v_accvgpr_write_b32 a153, 0
    v_accvgpr_write_b32 a154, 0
    v_accvgpr_write_b32 a155, 0
    v_accvgpr_write_b32 a156, 0
    v_accvgpr_write_b32 a157, 0
    v_accvgpr_write_b32 a158, 0
    v_accvgpr_write_b32 a159, 0
    v_accvgpr_write_b32 a160, 0
    v_accvgpr_write_b32 a161, 0
    v_accvgpr_write_b32 a162, 0
    v_accvgpr_write_b32 a163, 0
    v_accvgpr_write_b32 a164, 0
    v_accvgpr_write_b32 a165, 0
    v_accvgpr_write_b32 a166, 0
    v_accvgpr_write_b32 a167, 0
    v_accvgpr_write_b32 a168, 0
    v_accvgpr_write_b32 a169, 0
    v_accvgpr_write_b32 a170, 0
    v_accvgpr_write_b32 a171, 0
    v_accvgpr_write_b32 a172, 0
    v_accvgpr_write_b32 a173, 0
    v_accvgpr_write_b32 a174, 0
    v_accvgpr_write_b32 a175, 0
    v_accvgpr_write_b32 a176, 0
    v_accvgpr_write_b32 a177, 0
    v_accvgpr_write_b32 a178, 0
    v_accvgpr_write_b32 a179, 0
    v_accvgpr_write_b32 a180, 0
    v_accvgpr_write_b32 a181, 0
    v_accvgpr_write_b32 a182, 0
    v_accvgpr_write_b32 a183, 0
    v_accvgpr_write_b32 a184, 0
    v_accvgpr_write_b32 a185, 0
    v_accvgpr_write_b32 a186, 0
    v_accvgpr_write_b32 a187, 0
    v_accvgpr_write_b32 a188, 0
    v_accvgpr_write_b32 a189, 0
    v_accvgpr_write_b32 a190, 0
    v_accvgpr_write_b32 a191, 0
    v_accvgpr_write_b32 a192, 0
    v_accvgpr_write_b32 a193, 0
    v_accvgpr_write_b32 a194, 0
    v_accvgpr_write_b32 a195, 0
    v_accvgpr_write_b32 a196, 0
    v_accvgpr_write_b32 a197, 0
    v_accvgpr_write_b32 a198, 0
    v_accvgpr_write_b32 a199, 0
    v_accvgpr_write_b32 a200, 0
    v_accvgpr_write_b32 a201, 0
    v_accvgpr_write_b32 a202, 0
    v_accvgpr_write_b32 a203, 0
    v_accvgpr_write_b32 a204, 0
    v_accvgpr_write_b32 a205, 0
    v_accvgpr_write_b32 a206, 0
    v_accvgpr_write_b32 a207, 0
    v_accvgpr_write_b32 a208, 0
    v_accvgpr_write_b32 a209, 0
    v_accvgpr_write_b32 a210, 0
    v_accvgpr_write_b32 a211, 0
    v_accvgpr_write_b32 a212, 0
    v_accvgpr_write_b32 a213, 0
    v_accvgpr_write_b32 a214, 0
    v_accvgpr_write_b32 a215, 0
    v_accvgpr_write_b32 a216, 0
    v_accvgpr_write_b32 a217, 0
    v_accvgpr_write_b32 a218, 0
    v_accvgpr_write_b32 a219, 0
    v_accvgpr_write_b32 a220, 0
    v_accvgpr_write_b32 a221, 0
    v_accvgpr_write_b32 a222, 0
    v_accvgpr_write_b32 a223, 0
    v_mov_b32 v92, 0x3f803f80
    v_accvgpr_write_b32 a136, v92
    v_accvgpr_write_b32 a137, v92
    v_accvgpr_write_b32 a138, v92
    v_accvgpr_write_b32 a139, v92
    s_mov_b32 s77, s75
    s_mov_b32 s76, 0
    s_mov_b32 s38, 16384
    s_add_u32 m0, s76, s75
    s_nop 0
    buffer_load_dwordx4 v1, s[36:39], s77 offen sc1 lds
    buffer_load_dwordx4 v1, s[36:39], s77 offen offset:1024 sc1 lds
    buffer_load_dwordx4 v1, s[36:39], s77 offen offset:2048 sc1 lds
    buffer_load_dwordx4 v1, s[36:39], s77 offen offset:3072 sc1 lds
    s_add_u32 s100, s77, 4096
    s_add_u32 m0, m0, 4096
    s_nop 0
    buffer_load_dwordx4 v1, s[36:39], s100 offen sc1 lds
    buffer_load_dwordx4 v1, s[36:39], s100 offen offset:1024 sc1 lds
    buffer_load_dwordx4 v1, s[36:39], s100 offen offset:2048 sc1 lds
    buffer_load_dwordx4 v1, s[36:39], s100 offen offset:3072 sc1 lds
    s_add_u32 s77, s77, 32768
    s_add_u32 s76, s76, 32768
    s_lshr_b32 s82, s4, 1
    s_add_u32 s82, s82, 32
    s_sub_u32 s82, s82, s6
    s_sub_u32 s82, s82, s6
    s_lshl_b32 s38, s82, 15
    s_add_u32 m0, s76, s75
    s_nop 0
    buffer_load_dwordx4 v1, s[36:39], s77 offen sc1 lds
    buffer_load_dwordx4 v1, s[36:39], s77 offen offset:1024 sc1 lds
    buffer_load_dwordx4 v1, s[36:39], s77 offen offset:2048 sc1 lds
    buffer_load_dwordx4 v1, s[36:39], s77 offen offset:3072 sc1 lds
    s_add_u32 s100, s77, 4096
    s_add_u32 m0, m0, 4096
    s_nop 0
    buffer_load_dwordx4 v1, s[36:39], s100 offen sc1 lds
    buffer_load_dwordx4 v1, s[36:39], s100 offen offset:1024 sc1 lds
    buffer_load_dwordx4 v1, s[36:39], s100 offen offset:2048 sc1 lds
    buffer_load_dwordx4 v1, s[36:39], s100 offen offset:3072 sc1 lds
    s_add_u32 s77, s77, 32768
    s_add_u32 s76, s76, 32768
    s_branch K1_ATT
SPIN_WA:
    s_mov_b32 s94, 0
SPIN_WA_L:
    s_sleep 2
    buffer_load_dword v7, v9, s[44:47], s69 offen sc1
    s_add_u32 s94, s94, 1
    s_cmp_ge_u32 s94, 0x40000
    s_waitcnt vmcnt(0)
    s_cbranch_scc1 BACK_WA
    v_cmp_gt_u32 vcc, 8, v7
    s_nop 1
    s_and_b64 vcc, vcc, s[86:87]
    s_cbranch_scc1 SPIN_WA_L
    s_branch BACK_WA
SPIN_KV:
    s_mov_b32 s94, 0
SPIN_KV_L:
    s_sleep 2
    buffer_load_dword v7, v8, s[32:35], s61 offen sc1
    s_add_u32 s94, s94, 1
    s_cmp_ge_u32 s94, 0x40000
    s_waitcnt vmcnt(0)
    s_cbranch_scc1 BACK_KV
    v_cmp_gt_u32 vcc, 1, v7
    s_nop 1
    s_and_b64 vcc, vcc, exec
    s_cbranch_scc1 SPIN_KV_L
    s_branch BACK_KV
SPIN_ALL:
    s_mov_b32 s94, 0
SPIN_ALL_L:
    s_sleep 2
    buffer_load_dword v3, v29, s[32:35], s92 offen sc1
    s_add_u32 s94, s94, 1
    s_cmp_ge_u32 s94, 0x40000
    s_waitcnt vmcnt(0)
    s_cbranch_scc1 BACK_ALL
    v_cmp_gt_u32 vcc, 1, v3
    s_nop 1
    s_and_b64 vcc, vcc, exec
    s_cbranch_scc1 SPIN_ALL_L
    s_branch BACK_ALL
SPIN_CTX:
    s_mov_b32 s94, 0
SPIN_CTX_L:
    s_sleep 2
    buffer_load_dword v3, v19, s[32:35], s66 offen sc1
    s_add_u32 s94, s94, 1
    s_cmp_ge_u32 s94, 0x40000
    s_waitcnt vmcnt(0)
    s_cbranch_scc1 BACK_CTX
    v_cmp_gt_u32 vcc, 2, v3
    s_nop 1
    s_and_b64 vcc, vcc, exec
    s_cbranch_scc1 SPIN_CTX_L
    s_branch BACK_CTX
SPIN_OA:
    s_mov_b32 s94, 0
SPIN_OA_L:
    s_sleep 2
    buffer_load_dword v3, v19, s[32:35], s66 offen sc1
    s_add_u32 s94, s94, 1
    s_cmp_ge_u32 s94, 0x40000
    s_waitcnt vmcnt(0)
    s_cbranch_scc1 BACK_OA
    v_cmp_gt_u32 vcc, 3, v3
    s_nop 1
    s_and_b64 vcc, vcc, exec
    s_cbranch_scc1 SPIN_OA_L
    s_branch BACK_OA
SPIN_X:
    s_mov_b32 s94, 0
SPIN_X_L:
    s_sleep 2
    buffer_load_dword v3, v19, s[32:35], s66 offen sc1
    s_add_u32 s94, s94, 1
    s_cmp_ge_u32 s94, 0x40000
    s_waitcnt vmcnt(0)
    s_cbranch_scc1 BACK_X
    v_cmp_gt_u32 vcc, 2, v3
    s_nop 1
    s_and_b64 vcc, vcc, exec
    s_cbranch_scc1 SPIN_X_L
    s_branch BACK_X
.section .rodata,"a"
.p2align 6
.amdhsa_kernel gated_mix__sliding_local_dilated__compressed_kv_cla__prompt_kernel
.amdhsa_next_free_vgpr 512
.amdhsa_next_free_sgpr 102
.amdhsa_accum_offset 256
.amdhsa_group_segment_fixed_size 0
.amdhsa_kernarg_size 104
.amdhsa_user_sgpr_count 2
.amdhsa_user_sgpr_kernarg_segment_ptr 1
.amdhsa_system_sgpr_workgroup_id_x 1
.amdhsa_ieee_mode 0
.amdhsa_dx10_clamp 0
.end_amdhsa_kernel
```

```asm
; @launch grid=(256,1,1) block=(256,1,1) lds=163840
.amdgcn_target "amdgcn-amd-amdhsa--gfx950"
.text
.globl gated_mix__sliding_local_dilated__compressed_kv_cla__prompt_kernel
.p2align 8
.type gated_mix__sliding_local_dilated__compressed_kv_cla__prompt_kernel,@function
gated_mix__sliding_local_dilated__compressed_kv_cla__prompt_kernel:
    s_cmp_ge_u32 s2, 256
    s_cbranch_scc1 K1_END
    s_getpc_b64 s[94:95]
    s_load_dwordx8 s[36:43], s[0:1], 32
    v_min_u32 v74, 16, v0
    s_lshr_b32 s7, s2, 3
    s_mul_i32 s7, s7, 17
    v_add_lshl_u32 v74, v74, s7, 7
    global_load_dword v76, v74, s[94:95]
    v_lshrrev_b32 v64, 6, v0
    v_and_b32 v31, 63, v0
    v_readfirstlane_b32 s4, v64
    s_and_b32 s5, s2, 7
    s_lshl_b32 s5, s5, 2
    s_bfe_u32 s7, s2, 0x20003
    s_add_u32 s5, s5, s7
    s_lshr_b32 s6, s2, 5
    s_lshl_b32 s69, s4, 12
    s_mov_b32 s10, 2097152
    s_mov_b32 s11, 0x20000
    s_mov_b32 s14, 4194304
    s_mov_b32 s15, 0x20000
    s_mov_b32 s18, 4194304
    s_mov_b32 s19, 0x20000
    v_lshrrev_b32 v65, 3, v31
    v_and_b32 v66, 7, v31
    v_lshrrev_b32 v67, 1, v65
    v_xor_b32 v66, v66, v67
    v_lshlrev_b32 v66, 4, v66
    v_xor_b32 v67, 64, v66
    s_lshr_b32 s7, s4, 1
    s_lshl_b32 s73, s7, 7
    s_and_b32 s100, s4, 1
    s_lshl_b32 s98, s100, 5
    s_add_u32 s98, s98, s73
    v_add_lshl_u32 v68, v65, s98, 10
    v_add_u32 v6, v68, v66
    v_add_u32 v7, v68, v67
    v_add_u32 v7, 7168, v7
    v_add_u32 v8, v68, v66
    v_add_u32 v8, 14336, v8
    v_add_u32 v9, v68, v67
    v_add_u32 v9, 21504, v9
    v_lshrrev_b32 v69, 4, v31
    v_and_b32 v70, 15, v31
    v_lshlrev_b32 v71, 1, v69
    v_xor_b32 v71, v71, v70
    v_lshlrev_b32 v71, 4, v71
    v_xor_b32 v72, 128, v71
    s_lshl_b32 s98, s4, 4
    v_add_lshl_u32 v73, v69, s98, 13
    v_add_u32 v2, v73, v71
    v_add_u32 v3, v73, v71
    v_add_u32 v3, 31744, v3
    v_add_u32 v4, v73, v72
    v_add_u32 v4, 63488, v4
    v_add_u32 v5, v73, v72
    v_add_u32 v5, 95232, v5
    s_and_b32 s3, s2, 0
    s_lshl_b32 s66, s3, 7
    s_lshl_b32 s60, s3, 11
    s_add_u32 s60, s60, s5
    s_lshl_b32 s60, s60, 8
    s_lshl_b32 s61, s6, 18
    s_add_u32 s61, s61, s66
    s_add_u32 s62, s61, 65536
    s_waitcnt lgkmcnt(0)
    s_mov_b64 s[8:9], s[36:37]
    s_mov_b64 s[24:25], s[38:39]
    s_mov_b64 s[12:13], s[40:41]
    s_mov_b64 s[16:17], s[42:43]
    s_load_dwordx2 s[20:21], s[0:1], 0
    s_load_dwordx2 s[28:29], s[0:1], 8
    s_load_dwordx2 s[32:33], s[0:1], 72
    s_load_dwordx2 s[48:49], s[0:1], 64
    s_load_dwordx2 s[92:93], s[0:1], 16
    s_load_dwordx2 s[44:45], s[0:1], 88
    s_load_dwordx2 s[56:57], s[0:1], 96
    s_load_dwordx2 s[0:1], s[0:1], 80
    s_add_u32 m0, s69, 0
    s_nop 0
    buffer_load_dwordx4 v6, s[8:11], s61 offen lds
    buffer_load_dwordx4 v7, s[8:11], s61 offen offset:1024 lds
    buffer_load_dwordx4 v8, s[8:11], s61 offen offset:2048 lds
    buffer_load_dwordx4 v9, s[8:11], s61 offen offset:3072 lds
    s_xor_b32 s61, s61, 128
    s_add_u32 m0, s69, 16384
    s_nop 0
    buffer_load_dwordx4 v6, s[8:11], s62 offen lds
    buffer_load_dwordx4 v7, s[8:11], s62 offen offset:1024 lds
    buffer_load_dwordx4 v8, s[8:11], s62 offen offset:2048 lds
    buffer_load_dwordx4 v9, s[8:11], s62 offen offset:3072 lds
    s_xor_b32 s62, s62, 128
    s_add_u32 m0, s69, 32768
    s_nop 0
    buffer_load_dwordx4 v2, s[12:15], s60 offen nt lds
    buffer_load_dwordx4 v3, s[12:15], s60 offen offset:1024 nt lds
    buffer_load_dwordx4 v4, s[12:15], s60 offen offset:2048 nt lds
    buffer_load_dwordx4 v5, s[12:15], s60 offen offset:3072 nt lds
    s_add_u32 m0, s69, 49152
    s_nop 0
    buffer_load_dwordx4 v6, s[8:11], s61 offen lds
    buffer_load_dwordx4 v7, s[8:11], s61 offen offset:1024 lds
    buffer_load_dwordx4 v8, s[8:11], s61 offen offset:2048 lds
    buffer_load_dwordx4 v9, s[8:11], s61 offen offset:3072 lds
    s_xor_b32 s61, s61, 384
    v_min_u32 v74, 15, v31
    s_lshl2_add_u32 s98, s2, s4
    s_lshl_b32 s98, s98, 11
    v_lshlrev_b32 v74, 7, v74
    buffer_load_dword v117, v74, s[8:11], s98 offen
    s_cmp_lt_u32 s4, 2
    s_cselect_b32 s40, s12, s16
    s_cselect_b32 s41, s13, s17
    s_mov_b32 s42, 4194304
    s_mov_b32 s43, 0x20000
    v_min_u32 v120, 7, v31
    v_and_b32 v75, 1, v120
    v_lshrrev_b32 v120, 1, v120
    s_lshl1_add_u32 s98, s6, s100
    s_lshl_b32 s98, s98, 2
    v_add_lshl_u32 v120, v120, s98, 6
    v_add_lshl_u32 v120, v120, v75, 7
    s_lshl_b32 s84, s3, 11
    s_add_u32 s84, s84, s5
    s_lshl_b32 s84, s84, 8
    s_xor_b32 s98, s84, 524544
    buffer_load_dword v121, v120, s[40:43], s98 offen nt
    s_xor_b32 s98, s84, 1049088
    buffer_load_dword v122, v120, s[40:43], s98 offen nt
    s_waitcnt lgkmcnt(0)
    s_mov_b32 s22, 2359296
    s_mov_b32 s23, 0x20000
    s_mov_b32 s26, 4718592
    s_mov_b32 s27, 0x20000
    s_mov_b32 s50, 4718592
    s_mov_b32 s51, 0x20000
    s_mov_b32 s46, 256
    s_mov_b32 s47, 0x20000
    s_mov_b32 s30, 1990656
    s_mov_b32 s31, 0x20000
    s_mov_b32 s34, 1152
    s_mov_b32 s35, 0x20000
    s_mul_i32 s7, s5, 1081344
    s_add_u32 s36, s56, s7
    s_addc_u32 s37, s57, 0
    s_mov_b32 s38, 1081344
    s_mov_b32 s39, 0x20000
    s_cmp_eq_u32 s4, 0
    s_cselect_b32 s86, 0x55555555, 0
    s_cselect_b32 s87, 0x55555555, 0
    s_cselect_b32 s52, s48, s92
    s_cselect_b32 s53, s49, s93
    s_cselect_b32 s54, s50, 663552
    s_mov_b32 s55, 0x20000
    s_mul_i32 s63, s6, 147456
    s_sub_u32 s64, 2211840, s63
    s_add_u32 s63, s63, s66
    s_add_u32 s64, s64, s66
    s_lshl_b32 s67, s4, 11
    s_lshl_b32 s68, s4, 10
    s_lshl_b32 s75, s4, 13
    s_lshl_b32 s65, s3, 13
    s_add_u32 s65, s65, s67
    s_lshl_b32 s70, s6, 2
    s_lshl1_add_u32 s70, s100, s70
    s_lshl_b32 s70, s70, 15
    s_lshl_b32 s98, s73, 6
    s_add_u32 s71, s70, s98
    s_add_u32 s71, s71, 49152
    s_lshl_b32 s98, s73, 4
    s_add_u32 s70, s70, s98
    v_lshlrev_b32 v1, 4, v31
    v_mov_b32 v77, 1073741824
    v_cmp_eq_u32 vcc, 0, v0
    s_nop 1
    v_cndmask_b32_e64 v30, v77, 0, vcc
    v_lshlrev_b32 v103, 7, v31
    v_cmp_gt_u32 vcc, 9, v31
    s_nop 1
    v_cndmask_b32 v103, v77, v103, vcc
    s_lshl_b32 s98, s4, 5
    v_add_u32 v68, s98, v65
    v_mul_u32_u24 v68, 1152, v68
    v_add_u32 v10, v68, v66
    v_add_u32 v11, v68, v67
    v_add_u32 v11, 8192, v11
    v_add_u32 v12, v68, v66
    v_add_u32 v12, 16384, v12
    v_add_u32 v13, v68, v67
    v_add_u32 v13, 24576, v13
    s_sub_u32 s98, 15, s6
    s_cmp_eq_u32 s73, 0
    s_cselect_b32 s98, s6, s98
    s_lshl_b32 s98, s98, 7
    s_sub_u32 s98, s98, 16
    s_max_i32 s98, s98, 0
    s_lshl3_add_u32 s98, s100, s98
    v_add_u32 v68, s98, v65
    v_mul_u32_u24 v68, 1152, v68
    s_lshl_b32 s98, s100, 6
    v_xor_b32 v73, s98, v66
    v_add_u32 v96, v68, v73
    s_add_u32 m0, s69, 65536
    s_nop 0
    buffer_load_dwordx4 v2, s[16:19], s60 offen nt lds
    v_lshrrev_b32 v71, 1, v70
    v_xor_b32 v71, v71, v69
    v_lshlrev_b32 v71, 4, v71
    v_lshl_add_u32 v71, v70, 7, v71
    v_xor_b32 v72, 64, v71
    s_lshl_b32 s98, s100, 13
    v_add_u32 v22, s98, v71
    v_add_u32 v23, s98, v72
    v_add_u32 v24, s67, v71
    v_add_u32 v25, s67, v72
    s_lshl_b32 s98, s100, 11
    s_add_u32 s98, s98, 8192
    v_add_u32 v100, s98, v71
    v_add_u32 v101, s98, v72
    v_bfe_u32 v73, v31, 2, 2
    v_and_b32 v74, 3, v31
    v_lshl_add_u32 v75, v69, 3, v73
    v_and_b32 v78, 1, v69
    buffer_load_dwordx4 v3, s[16:19], s60 offen offset:1024 nt lds
    v_lshl_add_u32 v77, v78, 2, v73
    v_lshlrev_b32 v77, 5, v77
    v_lshl_add_u32 v77, v74, 3, v77
    v_lshl_add_u32 v77, v75, 8, v77
    v_xor_b32 v14, 0, v77
    v_xor_b32 v14, s73, v14
    v_xor_b32 v15, 32, v77
    v_xor_b32 v15, s73, v15
    v_xor_b32 v16, 64, v77
    v_xor_b32 v16, s73, v16
    v_xor_b32 v17, 96, v77
    v_xor_b32 v17, s73, v17
    v_xor_b32 v18, 128, v77
    v_xor_b32 v19, 160, v77
    v_xor_b32 v20, 192, v77
    v_xor_b32 v21, 224, v77
    v_lshrrev_b32 v77, 1, v73
    v_lshl_add_u32 v77, v78, 1, v77
    buffer_load_dwordx4 v4, s[16:19], s60 offen offset:2048 nt lds
    v_lshlrev_b32 v77, 5, v77
    v_lshl_add_u32 v77, v74, 3, v77
    v_lshl_add_u32 v77, v75, 7, v77
    s_lshr_b32 s98, s73, 1
    v_xor_b32 v26, 0, v77
    v_xor_b32 v26, s98, v26
    v_xor_b32 v27, 32, v77
    v_xor_b32 v28, 64, v77
    v_xor_b32 v28, s98, v28
    v_xor_b32 v29, 96, v77
    v_and_b32 v73, 7, v0
    v_lshrrev_b32 v74, 3, v0
    v_lshl_add_u32 v75, v73, 1, 0
    v_mul_u32_u24 v78, 52, v75
    v_lshrrev_b32 v78, 8, v78
    v_mul_u32_u24 v79, 5, v78
    v_sub_u32 v75, v75, v79
    v_add_u32 v78, 1, v78
    buffer_load_dwordx4 v5, s[16:19], s60 offen offset:3072 nt lds
    s_xor_b32 s60, s60, 524288
    v_cmp_le_u32 vcc, 3, v78
    s_nop 1
    v_cndmask_b32_e64 v78, v78, 0, vcc
    v_mul_u32_u24 v78, 1152, v78
    v_lshl_add_u32 v75, v75, 3, v78
    v_mad_u32_u24 v75, v74, 36, v75
    v_lshl_add_u32 v77, v73, 1, 1
    v_mul_u32_u24 v78, 52, v77
    v_lshrrev_b32 v78, 8, v78
    v_mul_u32_u24 v79, 5, v78
    v_sub_u32 v77, v77, v79
    v_add_u32 v78, 1, v78
    v_cmp_le_u32 vcc, 3, v78
    s_nop 1
    v_cndmask_b32_e64 v78, v78, 0, vcc
    v_mul_u32_u24 v78, 1152, v78
    v_lshl_add_u32 v77, v77, 3, v78
    v_mad_u32_u24 v77, v74, 36, v77
    s_mul_i32 s98, s2, 10368
    s_mul_i32 s99, s2, 6
    s_mov_b32 s7, 73728
    v_mul_lo_u32 v95, v74, s7
    v_lshl_add_u32 v95, v73, 4, v95
    v_cmp_eq_u32 s[92:93], 7, v73
    s_add_u32 s56, s56, 56623104
    s_addc_u32 s57, s57, 0
    s_mov_b32 s58, 5603328
    s_mov_b32 s59, 0x20000
    s_lshl_b32 s101, s6, 5
    s_add_u32 s101, s101, s5
    s_lshl_b32 s101, s101, 7
    v_mov_b32 v65, 0
    v_lshlrev_b32 v64, 15, v0
    s_mov_b32 s74, 0x3e0293ee
    s_lshl_b32 s95, s5, 3
    s_waitcnt vmcnt(7)
    s_barrier
    ds_read_b128 a[0:3], v22 offset:0
    ds_read_b64_tr_b16 v[40:41], v14 offset:32768
    ds_read_b64_tr_b16 v[42:43], v14 offset:33792
    ds_read_b128 a[4:7], v23 offset:0
    ds_read_b64_tr_b16 v[44:45], v14 offset:40960
    ds_read_b64_tr_b16 v[46:47], v14 offset:41984
    ds_read_b128 a[8:11], v22 offset:2048
    ds_read_b128 a[12:15], v23 offset:2048
    ds_read_b128 a[16:19], v22 offset:4096
    ds_read_b128 a[20:23], v23 offset:4096
    ds_read_b128 a[24:27], v22 offset:6144
    ds_read_b128 a[28:31], v23 offset:6144
    ds_read_b128 a[32:35], v22 offset:16384
    ds_read_b128 a[36:39], v23 offset:16384
    ds_read_b128 a[40:43], v22 offset:18432
    s_waitcnt lgkmcnt(14)
    ds_read_b128 a[44:47], v23 offset:18432
    s_waitcnt lgkmcnt(14)
    ds_read_b128 a[48:51], v22 offset:20480
    s_waitcnt lgkmcnt(14)
    ds_read_b128 a[52:55], v23 offset:20480
    s_waitcnt lgkmcnt(14)
    ds_read_b128 a[56:59], v22 offset:22528
    s_waitcnt lgkmcnt(14)
    ds_read_b128 a[60:63], v23 offset:22528
    v_mfma_f32_16x16x32_bf16 v[128:131], v[40:43], a[0:3], 0
    s_add_u32 m0, s69, 81920
    s_waitcnt lgkmcnt(14)
    ds_read_b64_tr_b16 v[48:49], v15 offset:32768
    s_waitcnt lgkmcnt(14)
    ds_read_b64_tr_b16 v[50:51], v15 offset:33792
    v_mfma_f32_16x16x32_bf16 v[128:131], v[44:47], a[4:7], v[128:131]
    s_mul_i32 s77, s2, 9216
    buffer_load_dwordx4 v6, s[8:11], s62 offen lds
    v_mfma_f32_16x16x32_bf16 v[132:135], v[40:43], a[8:11], 0
    s_mul_i32 s76, s4, 1152
    s_waitcnt lgkmcnt(14)
    ds_read_b128 a[64:67], v22 offset:49152
    s_waitcnt lgkmcnt(14)
    ds_read_b64_tr_b16 v[52:53], v15 offset:40960
    v_mfma_f32_16x16x32_bf16 v[132:135], v[44:47], a[12:15], v[132:135]
    s_add_u32 s77, s77, s76
    s_waitcnt lgkmcnt(14)
    ds_read_b64_tr_b16 v[54:55], v15 offset:41984
    s_waitcnt lgkmcnt(14)
    ds_read_b64_tr_b16 v[56:57], v16 offset:32768
    v_mfma_f32_16x16x32_bf16 v[136:139], v[40:43], a[16:19], 0
    s_mul_i32 s76, s4, 1152
    buffer_load_dwordx4 v7, s[8:11], s62 offen offset:1024 lds
    v_mfma_f32_16x16x32_bf16 v[136:139], v[44:47], a[20:23], v[136:139]
    s_mul_i32 s72, s2, 3
    s_waitcnt lgkmcnt(4)
    ds_read_b64_tr_b16 v[58:59], v16 offset:33792
    ds_read_b64_tr_b16 v[60:61], v16 offset:40960
    v_mfma_f32_16x16x32_bf16 v[140:143], v[40:43], a[24:27], 0
    s_add_u32 s72, s72, 0
    ds_read_b64_tr_b16 v[62:63], v16 offset:41984
    v_add_u32 v14, 0x10000, v14
    v_mfma_f32_16x16x32_bf16 v[140:143], v[44:47], a[28:31], v[140:143]
    s_mul_i32 s7, s5, 73728
    ds_read_b128 a[68:71], v23 offset:49152
    v_add_u32 v15, 0x10000, v15
    v_mfma_f32_16x16x32_bf16 v[144:147], v[40:43], a[32:35], 0
    s_and_b32 s100, s6, 1
    buffer_load_dwordx4 v8, s[8:11], s62 offen offset:2048 lds
    v_mfma_f32_16x16x32_bf16 v[144:147], v[44:47], a[36:39], v[144:147]
    s_mov_b32 s83, 0
    v_add_u32 v16, 0x10000, v16
    v_mov_b32 v31, 1
    v_mfma_f32_16x16x32_bf16 v[148:151], v[40:43], a[40:43], 0
    v_add_u32 v18, 0x10000, v18
    v_add_u32 v19, 0x10000, v19
    v_mfma_f32_16x16x32_bf16 v[148:151], v[44:47], a[44:47], v[148:151]
    v_add_u32 v20, 0x10000, v20
    v_add_u32 v21, 0x10000, v21
    v_mfma_f32_16x16x32_bf16 v[152:155], v[40:43], a[48:51], 0
    buffer_load_dwordx4 v9, s[8:11], s62 offen offset:3072 lds
    v_mfma_f32_16x16x32_bf16 v[152:155], v[44:47], a[52:55], v[152:155]
    ds_read_b128 a[72:75], v22 offset:51200
    v_add_u32 v26, 0x10000, v26
    v_mfma_f32_16x16x32_bf16 v[156:159], v[40:43], a[56:59], 0
    s_add_u32 m0, s69, 98304
    ds_read_b64_tr_b16 v[40:41], v17 offset:32768
    ds_read_b64_tr_b16 v[42:43], v17 offset:33792
    v_mfma_f32_16x16x32_bf16 v[156:159], v[44:47], a[60:63], v[156:159]
    s_xor_b32 s62, s62, 384
    ds_read_b64_tr_b16 v[44:45], v17 offset:40960
    ds_read_b64_tr_b16 v[46:47], v17 offset:41984
    v_mfma_f32_16x16x32_bf16 v[160:163], v[48:51], a[0:3], 0
    s_waitcnt lgkmcnt(5)
    buffer_load_dwordx4 v2, s[12:15], s60 offen nt lds
    v_mfma_f32_16x16x32_bf16 v[160:163], v[52:55], a[4:7], v[160:163]
    v_add_u32 v17, 0x10000, v17
    v_add_u32 v27, 0x10000, v27
    v_mfma_f32_16x16x32_bf16 v[164:167], v[48:51], a[8:11], 0
    ds_read_b128 a[76:79], v23 offset:51200
    v_add_u32 v28, 0x10000, v28
    v_mfma_f32_16x16x32_bf16 v[164:167], v[52:55], a[12:15], v[164:167]
    v_add_u32 v29, 0x10000, v29
    v_bfe_u32 v37, v1, 4, 4
    v_mfma_f32_16x16x32_bf16 v[168:171], v[48:51], a[16:19], 0
    buffer_load_dwordx4 v3, s[12:15], s60 offen offset:1024 nt lds
    v_mfma_f32_16x16x32_bf16 v[168:171], v[52:55], a[20:23], v[168:171]
    v_mul_u32_u24 v36, 1152, v37
    v_lshrrev_b32 v38, 8, v1
    v_mfma_f32_16x16x32_bf16 v[172:175], v[48:51], a[24:27], 0
    v_lshl_add_u32 v36, v38, 4, v36
    v_lshrrev_b32 v39, 3, v37
    v_mfma_f32_16x16x32_bf16 v[172:175], v[52:55], a[28:31], v[172:175]
    v_mul_u32_u24 v39, 9152, v39
    v_mfma_f32_16x16x32_bf16 v[176:179], v[48:51], a[32:35], 0
    buffer_load_dwordx4 v4, s[12:15], s60 offen offset:2048 nt lds
    v_mfma_f32_16x16x32_bf16 v[176:179], v[52:55], a[36:39], v[176:179]
    ds_read_b128 a[80:83], v22 offset:53248
    v_mfma_f32_16x16x32_bf16 v[180:183], v[48:51], a[40:43], 0
    v_mfma_f32_16x16x32_bf16 v[180:183], v[52:55], a[44:47], v[180:183]
    v_mfma_f32_16x16x32_bf16 v[184:187], v[48:51], a[48:51], 0
    buffer_load_dwordx4 v5, s[12:15], s60 offen offset:3072 nt lds
    v_mfma_f32_16x16x32_bf16 v[184:187], v[52:55], a[52:55], v[184:187]
    ds_read_b128 a[84:87], v23 offset:53248
    v_mfma_f32_16x16x32_bf16 v[188:191], v[48:51], a[56:59], 0
    s_add_u32 m0, s69, 114688
    v_mfma_f32_16x16x32_bf16 v[188:191], v[52:55], a[60:63], v[188:191]
    v_mfma_f32_16x16x32_bf16 v[192:195], v[56:59], a[0:3], 0
    buffer_load_dwordx4 v6, s[8:11], s61 offen lds
    v_mfma_f32_16x16x32_bf16 v[192:195], v[60:63], a[4:7], v[192:195]
    v_mfma_f32_16x16x32_bf16 v[196:199], v[56:59], a[8:11], 0
    v_mfma_f32_16x16x32_bf16 v[196:199], v[60:63], a[12:15], v[196:199]
    ds_read_b128 a[88:91], v22 offset:55296
    v_mfma_f32_16x16x32_bf16 v[200:203], v[56:59], a[16:19], 0
    buffer_load_dwordx4 v7, s[8:11], s61 offen offset:1024 lds
    v_mfma_f32_16x16x32_bf16 v[200:203], v[60:63], a[20:23], v[200:203]
    v_mfma_f32_16x16x32_bf16 v[204:207], v[56:59], a[24:27], 0
    v_mfma_f32_16x16x32_bf16 v[204:207], v[60:63], a[28:31], v[204:207]
    v_mfma_f32_16x16x32_bf16 v[208:211], v[56:59], a[32:35], 0
    buffer_load_dwordx4 v8, s[8:11], s61 offen offset:2048 lds
    v_mfma_f32_16x16x32_bf16 v[208:211], v[60:63], a[36:39], v[208:211]
    ds_read_b128 a[92:95], v23 offset:55296
    v_mfma_f32_16x16x32_bf16 v[212:215], v[56:59], a[40:43], 0
    v_mfma_f32_16x16x32_bf16 v[212:215], v[60:63], a[44:47], v[212:215]
    v_mfma_f32_16x16x32_bf16 v[216:219], v[56:59], a[48:51], 0
    buffer_load_dwordx4 v9, s[8:11], s61 offen offset:3072 lds
    v_mfma_f32_16x16x32_bf16 v[216:219], v[60:63], a[52:55], v[216:219]
    v_mfma_f32_16x16x32_bf16 v[220:223], v[56:59], a[56:59], 0
    s_xor_b32 s61, s61, 128
    v_mfma_f32_16x16x32_bf16 v[220:223], v[60:63], a[60:63], v[220:223]
    s_add_u32 m0, s69, 131072
    s_waitcnt lgkmcnt(0)
    v_mfma_f32_16x16x32_bf16 v[224:227], v[40:43], a[0:3], 0
    s_xor_b32 s82, s84, 1573632
    buffer_load_dwordx4 v2, s[16:19], s60 offen nt lds
    v_mfma_f32_16x16x32_bf16 v[224:227], v[44:47], a[4:7], v[224:227]
    v_mfma_f32_16x16x32_bf16 v[228:231], v[40:43], a[8:11], 0
    buffer_load_dword v123, v120, s[40:43], s82 offen nt
    v_mfma_f32_16x16x32_bf16 v[228:231], v[44:47], a[12:15], v[228:231]
    v_mfma_f32_16x16x32_bf16 v[232:235], v[40:43], a[16:19], 0
    v_mfma_f32_16x16x32_bf16 v[232:235], v[44:47], a[20:23], v[232:235]
    s_waitcnt vmcnt(10)
    s_barrier
    ds_read_b64_tr_b16 v[48:49], v14 offset:0
    v_mfma_f32_16x16x32_bf16 v[236:239], v[40:43], a[24:27], 0
    buffer_load_dword v104, v103, s[20:23], s77 offen
    v_mfma_f32_16x16x32_bf16 v[236:239], v[44:47], a[28:31], v[236:239]
    s_add_u32 s77, s77, 4608
    ds_read_b64_tr_b16 v[50:51], v14 offset:1024
    ds_read_b64_tr_b16 v[52:53], v14 offset:8192
    v_mfma_f32_16x16x32_bf16 v[240:243], v[40:43], a[32:35], 0
    ds_read_b64_tr_b16 v[54:55], v14 offset:9216
    ds_read_b64_tr_b16 v[56:57], v15 offset:0
    v_mfma_f32_16x16x32_bf16 v[240:243], v[44:47], a[36:39], v[240:243]
    buffer_load_dwordx4 v3, s[16:19], s60 offen offset:1024 nt lds
    v_mfma_f32_16x16x32_bf16 v[244:247], v[40:43], a[40:43], 0
    ds_read_b64_tr_b16 v[58:59], v15 offset:1024
    ds_read_b64_tr_b16 v[60:61], v15 offset:8192
    v_mfma_f32_16x16x32_bf16 v[244:247], v[44:47], a[44:47], v[244:247]
    ds_read_b64_tr_b16 v[62:63], v15 offset:9216
    v_mfma_f32_16x16x32_bf16 v[248:251], v[40:43], a[48:51], 0
    v_mfma_f32_16x16x32_bf16 v[248:251], v[44:47], a[52:55], v[248:251]
    buffer_load_dwordx4 v4, s[16:19], s60 offen offset:2048 nt lds
    v_mfma_f32_16x16x32_bf16 v[252:255], v[40:43], a[56:59], 0
    ds_read_b64_tr_b16 v[40:41], v16 offset:0
    ds_read_b64_tr_b16 v[42:43], v16 offset:1024
    v_mfma_f32_16x16x32_bf16 v[252:255], v[44:47], a[60:63], v[252:255]
    s_waitcnt lgkmcnt(3)
    ds_read_b64_tr_b16 v[44:45], v16 offset:8192
    ds_read_b64_tr_b16 v[46:47], v16 offset:9216
    v_mfma_f32_16x16x32_bf16 a[128:131], a[0:3], v[48:51], 0
    v_mfma_f32_16x16x32_bf16 a[128:131], a[4:7], v[52:55], a[128:131]
    buffer_load_dwordx4 v5, s[16:19], s60 offen offset:3072 nt lds
    v_mfma_f32_16x16x32_bf16 a[132:135], a[8:11], v[48:51], 0
    s_add_u32 m0, s69, 147456
    v_add_u32 v22, 0x10000, v22
    ds_read_b128 a[96:99], v22 offset:16384
    v_mfma_f32_16x16x32_bf16 a[132:135], a[12:15], v[52:55], a[132:135]
    s_xor_b32 s60, s60, 1572864
    v_mfma_f32_16x16x32_bf16 a[136:139], a[16:19], v[48:51], 0
    v_mfma_f32_16x16x32_bf16 a[136:139], a[20:23], v[52:55], a[136:139]
    buffer_load_dwordx4 v6, s[8:11], s62 offen lds
    v_mfma_f32_16x16x32_bf16 a[140:143], a[24:27], v[48:51], 0
    v_add_u32 v23, 0x10000, v23
    v_mfma_f32_16x16x32_bf16 a[140:143], a[28:31], v[52:55], a[140:143]
    ds_read_b128 a[100:103], v23 offset:16384
    v_mfma_f32_16x16x32_bf16 a[144:147], a[32:35], v[48:51], 0
    v_mfma_f32_16x16x32_bf16 a[144:147], a[36:39], v[52:55], a[144:147]
    buffer_load_dwordx4 v7, s[8:11], s62 offen offset:1024 lds
    v_mfma_f32_16x16x32_bf16 a[148:151], a[40:43], v[48:51], 0
    v_mfma_f32_16x16x32_bf16 a[148:151], a[44:47], v[52:55], a[148:151]
    v_mfma_f32_16x16x32_bf16 a[152:155], a[48:51], v[48:51], 0
    v_mfma_f32_16x16x32_bf16 a[152:155], a[52:55], v[52:55], a[152:155]
    buffer_load_dwordx4 v8, s[8:11], s62 offen offset:2048 lds
    v_mfma_f32_16x16x32_bf16 a[156:159], a[56:59], v[48:51], 0
    ds_read_b128 a[104:107], v22 offset:18432
    ds_read_b64_tr_b16 v[48:49], v17 offset:0
    v_mfma_f32_16x16x32_bf16 a[156:159], a[60:63], v[52:55], a[156:159]
    ds_read_b64_tr_b16 v[50:51], v17 offset:1024
    ds_read_b64_tr_b16 v[52:53], v17 offset:8192
    v_mfma_f32_16x16x32_bf16 a[160:163], a[0:3], v[56:59], 0
    s_waitcnt lgkmcnt(4)
    ds_read_b64_tr_b16 v[54:55], v17 offset:9216
    v_mfma_f32_16x16x32_bf16 a[160:163], a[4:7], v[60:63], a[160:163]
    buffer_load_dwordx4 v9, s[8:11], s62 offen offset:3072 lds
    v_mfma_f32_16x16x32_bf16 a[164:167], a[8:11], v[56:59], 0
    ds_read_b128 a[108:111], v23 offset:18432
    v_mfma_f32_16x16x32_bf16 a[164:167], a[12:15], v[60:63], a[164:167]
    s_add_u32 m0, s69, 0
    v_mfma_f32_16x16x32_bf16 a[168:171], a[16:19], v[56:59], 0
    s_xor_b32 s62, s62, 128
    v_mfma_f32_16x16x32_bf16 a[168:171], a[20:23], v[60:63], a[168:171]
    buffer_load_dwordx4 v2, s[12:15], s60 offen nt lds
    v_mfma_f32_16x16x32_bf16 a[172:175], a[24:27], v[56:59], 0
    v_mfma_f32_16x16x32_bf16 a[172:175], a[28:31], v[60:63], a[172:175]
    v_mfma_f32_16x16x32_bf16 a[176:179], a[32:35], v[56:59], 0
    ds_read_b128 a[112:115], v22 offset:20480
    v_mfma_f32_16x16x32_bf16 a[176:179], a[36:39], v[60:63], a[176:179]
    buffer_load_dwordx4 v3, s[12:15], s60 offen offset:1024 nt lds
    v_mfma_f32_16x16x32_bf16 a[180:183], a[40:43], v[56:59], 0
    v_mfma_f32_16x16x32_bf16 a[180:183], a[44:47], v[60:63], a[180:183]
    v_mfma_f32_16x16x32_bf16 a[184:187], a[48:51], v[56:59], 0
    v_mfma_f32_16x16x32_bf16 a[184:187], a[52:55], v[60:63], a[184:187]
    buffer_load_dwordx4 v4, s[12:15], s60 offen offset:2048 nt lds
    v_mfma_f32_16x16x32_bf16 a[188:191], a[56:59], v[56:59], 0
    ds_read_b128 a[116:119], v23 offset:20480
    v_mfma_f32_16x16x32_bf16 a[188:191], a[60:63], v[60:63], a[188:191]
    v_mfma_f32_16x16x32_bf16 a[192:195], a[0:3], v[40:43], 0
    v_mfma_f32_16x16x32_bf16 a[192:195], a[4:7], v[44:47], a[192:195]
    buffer_load_dwordx4 v5, s[12:15], s60 offen offset:3072 nt lds
    v_mfma_f32_16x16x32_bf16 a[196:199], a[8:11], v[40:43], 0
    v_mfma_f32_16x16x32_bf16 a[196:199], a[12:15], v[44:47], a[196:199]
    ds_read_b128 a[120:123], v22 offset:22528
    v_mfma_f32_16x16x32_bf16 a[200:203], a[16:19], v[40:43], 0
    v_mfma_f32_16x16x32_bf16 a[200:203], a[20:23], v[44:47], a[200:203]
    s_add_u32 m0, s69, 16384
    v_mfma_f32_16x16x32_bf16 a[204:207], a[24:27], v[40:43], 0
    buffer_load_dwordx4 v6, s[8:11], s61 offen lds
    v_mfma_f32_16x16x32_bf16 a[204:207], a[28:31], v[44:47], a[204:207]
    v_mfma_f32_16x16x32_bf16 a[208:211], a[32:35], v[40:43], 0
    ds_read_b128 a[124:127], v23 offset:22528
    v_mfma_f32_16x16x32_bf16 a[208:211], a[36:39], v[44:47], a[208:211]
    v_mfma_f32_16x16x32_bf16 a[212:215], a[40:43], v[40:43], 0
    buffer_load_dwordx4 v7, s[8:11], s61 offen offset:1024 lds
    v_mfma_f32_16x16x32_bf16 a[212:215], a[44:47], v[44:47], a[212:215]
    v_mfma_f32_16x16x32_bf16 a[216:219], a[48:51], v[40:43], 0
    v_mfma_f32_16x16x32_bf16 a[216:219], a[52:55], v[44:47], a[216:219]
    v_mfma_f32_16x16x32_bf16 a[220:223], a[56:59], v[40:43], 0
    v_mfma_f32_16x16x32_bf16 a[220:223], a[60:63], v[44:47], a[220:223]
    s_waitcnt lgkmcnt(0)
    buffer_load_dwordx4 v8, s[8:11], s61 offen offset:2048 lds
    v_mfma_f32_16x16x32_bf16 a[224:227], a[0:3], v[48:51], 0
    v_mfma_f32_16x16x32_bf16 a[224:227], a[4:7], v[52:55], a[224:227]
    v_mfma_f32_16x16x32_bf16 a[228:231], a[8:11], v[48:51], 0
    v_mfma_f32_16x16x32_bf16 a[228:231], a[12:15], v[52:55], a[228:231]
    buffer_load_dwordx4 v9, s[8:11], s61 offen offset:3072 lds
    v_mfma_f32_16x16x32_bf16 a[232:235], a[16:19], v[48:51], 0
    v_mfma_f32_16x16x32_bf16 a[232:235], a[20:23], v[52:55], a[232:235]
    s_waitcnt vmcnt(8) lgkmcnt(0)
    s_barrier
    ds_read_b64_tr_b16 v[56:57], v14 offset:32768
    v_mfma_f32_16x16x32_bf16 a[236:239], a[24:27], v[48:51], 0
    s_add_u32 m0, s69, 32768
    ds_read_b64_tr_b16 v[58:59], v14 offset:33792
    ds_read_b64_tr_b16 v[60:61], v14 offset:40960
    v_mfma_f32_16x16x32_bf16 a[236:239], a[28:31], v[52:55], a[236:239]
    s_xor_b32 s61, s61, 896
    buffer_load_dwordx4 v2, s[16:19], s60 offen nt lds
    v_mfma_f32_16x16x32_bf16 a[240:243], a[32:35], v[48:51], 0
    ds_read_b64_tr_b16 v[62:63], v14 offset:41984
    ds_read_b64_tr_b16 v[40:41], v15 offset:32768
    v_mfma_f32_16x16x32_bf16 a[240:243], a[36:39], v[52:55], a[240:243]
    ds_read_b64_tr_b16 v[42:43], v15 offset:33792
    ds_read_b64_tr_b16 v[44:45], v15 offset:40960
    v_mfma_f32_16x16x32_bf16 a[244:247], a[40:43], v[48:51], 0
    ds_read_b64_tr_b16 v[46:47], v15 offset:41984
    v_add_u32 v14, 0x10000, v14
    v_mfma_f32_16x16x32_bf16 a[244:247], a[44:47], v[52:55], a[244:247]
    v_add_u32 v15, 0x10000, v15
    v_mfma_f32_16x16x32_bf16 a[248:251], a[48:51], v[48:51], 0
    v_mfma_f32_16x16x32_bf16 a[248:251], a[52:55], v[52:55], a[248:251]
    buffer_load_dwordx4 v3, s[16:19], s60 offen offset:1024 nt lds
    v_mfma_f32_16x16x32_bf16 a[252:255], a[56:59], v[48:51], 0
    ds_read_b64_tr_b16 v[48:49], v16 offset:32768
    ds_read_b64_tr_b16 v[50:51], v16 offset:33792
    v_mfma_f32_16x16x32_bf16 a[252:255], a[60:63], v[52:55], a[252:255]
    s_waitcnt lgkmcnt(2)
    ds_read_b64_tr_b16 v[52:53], v16 offset:40960
    ds_read_b64_tr_b16 v[54:55], v16 offset:41984
    v_mfma_f32_16x16x32_bf16 v[128:131], v[56:59], a[64:67], v[128:131]
    v_add_u32 v16, 0x10000, v16
    v_mfma_f32_16x16x32_bf16 v[128:131], v[60:63], a[68:71], v[128:131]
    v_mfma_f32_16x16x32_bf16 v[132:135], v[56:59], a[72:75], v[132:135]
    ds_read_b128 a[0:3], v22 offset:49152
    v_mfma_f32_16x16x32_bf16 v[132:135], v[60:63], a[76:79], v[132:135]
    v_mfma_f32_16x16x32_bf16 v[136:139], v[56:59], a[80:83], v[136:139]
    v_mfma_f32_16x16x32_bf16 v[136:139], v[60:63], a[84:87], v[136:139]
    buffer_load_dwordx4 v4, s[16:19], s60 offen offset:2048 nt lds
    v_mfma_f32_16x16x32_bf16 v[140:143], v[56:59], a[88:91], v[140:143]
    v_mfma_f32_16x16x32_bf16 v[140:143], v[60:63], a[92:95], v[140:143]
    ds_read_b128 a[4:7], v23 offset:49152
    v_mfma_f32_16x16x32_bf16 v[144:147], v[56:59], a[96:99], v[144:147]
    v_mfma_f32_16x16x32_bf16 v[144:147], v[60:63], a[100:103], v[144:147]
    v_mfma_f32_16x16x32_bf16 v[148:151], v[56:59], a[104:107], v[148:151]
    v_mfma_f32_16x16x32_bf16 v[148:151], v[60:63], a[108:111], v[148:151]
    v_mfma_f32_16x16x32_bf16 v[152:155], v[56:59], a[112:115], v[152:155]
    buffer_load_dwordx4 v5, s[16:19], s60 offen offset:3072 nt lds
    v_mfma_f32_16x16x32_bf16 v[152:155], v[60:63], a[116:119], v[152:155]
    ds_read_b128 a[8:11], v22 offset:51200
    v_mfma_f32_16x16x32_bf16 v[156:159], v[56:59], a[120:123], v[156:159]
    ds_read_b64_tr_b16 v[56:57], v17 offset:32768
    ds_read_b64_tr_b16 v[58:59], v17 offset:33792
    v_mfma_f32_16x16x32_bf16 v[156:159], v[60:63], a[124:127], v[156:159]
    ds_read_b64_tr_b16 v[60:61], v17 offset:40960
    ds_read_b64_tr_b16 v[62:63], v17 offset:41984
    v_mfma_f32_16x16x32_bf16 v[160:163], v[40:43], a[64:67], v[160:163]
    v_add_u32 v17, 0x10000, v17
    v_mfma_f32_16x16x32_bf16 v[160:163], v[44:47], a[68:71], v[160:163]
    v_mfma_f32_16x16x32_bf16 v[164:167], v[40:43], a[72:75], v[164:167]
    ds_read_b128 a[12:15], v23 offset:51200
    v_mfma_f32_16x16x32_bf16 v[164:167], v[44:47], a[76:79], v[164:167]
    s_add_u32 m0, s69, 49152
    v_mfma_f32_16x16x32_bf16 v[168:171], v[40:43], a[80:83], v[168:171]
    s_xor_b32 s60, s60, 524288
    buffer_load_dwordx4 v6, s[8:11], s62 offen lds
    v_mfma_f32_16x16x32_bf16 v[168:171], v[44:47], a[84:87], v[168:171]
    v_mfma_f32_16x16x32_bf16 v[172:175], v[40:43], a[88:91], v[172:175]
    v_mfma_f32_16x16x32_bf16 v[172:175], v[44:47], a[92:95], v[172:175]
    v_mfma_f32_16x16x32_bf16 v[176:179], v[40:43], a[96:99], v[176:179]
    ds_read_b128 a[16:19], v22 offset:53248
    v_mfma_f32_16x16x32_bf16 v[176:179], v[44:47], a[100:103], v[176:179]
    v_mfma_f32_16x16x32_bf16 v[180:183], v[40:43], a[104:107], v[180:183]
    v_mfma_f32_16x16x32_bf16 v[180:183], v[44:47], a[108:111], v[180:183]
    buffer_load_dwordx4 v7, s[8:11], s62 offen offset:1024 lds
    v_mfma_f32_16x16x32_bf16 v[184:187], v[40:43], a[112:115], v[184:187]
    v_mfma_f32_16x16x32_bf16 v[184:187], v[44:47], a[116:119], v[184:187]
    ds_read_b128 a[20:23], v23 offset:53248
    v_mfma_f32_16x16x32_bf16 v[188:191], v[40:43], a[120:123], v[188:191]
    s_waitcnt lgkmcnt(1)
    ds_read_b64_tr_b16 v[40:41], v14 offset:0
    ds_read_b64_tr_b16 v[42:43], v14 offset:1024
    v_mfma_f32_16x16x32_bf16 v[188:191], v[44:47], a[124:127], v[188:191]
    ds_read_b64_tr_b16 v[44:45], v14 offset:8192
    ds_read_b64_tr_b16 v[46:47], v14 offset:9216
    v_mfma_f32_16x16x32_bf16 v[192:195], v[48:51], a[64:67], v[192:195]
    v_add_u32 v14, 0xfffe0000, v14
    v_mfma_f32_16x16x32_bf16 v[192:195], v[52:55], a[68:71], v[192:195]
    v_mfma_f32_16x16x32_bf16 v[196:199], v[48:51], a[72:75], v[196:199]
    v_mfma_f32_16x16x32_bf16 v[196:199], v[52:55], a[76:79], v[196:199]
    buffer_load_dwordx4 v8, s[8:11], s62 offen offset:2048 lds
    v_mfma_f32_16x16x32_bf16 v[200:203], v[48:51], a[80:83], v[200:203]
    ds_read_b128 a[24:27], v22 offset:55296
    v_mfma_f32_16x16x32_bf16 v[200:203], v[52:55], a[84:87], v[200:203]
    v_mfma_f32_16x16x32_bf16 v[204:207], v[48:51], a[88:91], v[204:207]
    v_mfma_f32_16x16x32_bf16 v[204:207], v[52:55], a[92:95], v[204:207]
    v_mfma_f32_16x16x32_bf16 v[208:211], v[48:51], a[96:99], v[208:211]
    ds_read_b128 a[28:31], v23 offset:55296
    v_mfma_f32_16x16x32_bf16 v[208:211], v[52:55], a[100:103], v[208:211]
    v_mfma_f32_16x16x32_bf16 v[212:215], v[48:51], a[104:107], v[212:215]
    buffer_load_dwordx4 v9, s[8:11], s62 offen offset:3072 lds
    v_mfma_f32_16x16x32_bf16 v[212:215], v[52:55], a[108:111], v[212:215]
    v_mfma_f32_16x16x32_bf16 v[216:219], v[48:51], a[112:115], v[216:219]
    v_mfma_f32_16x16x32_bf16 v[216:219], v[52:55], a[116:119], v[216:219]
    v_mfma_f32_16x16x32_bf16 v[220:223], v[48:51], a[120:123], v[220:223]
    s_xor_b32 s82, s84, 2097152
    ds_read_b64_tr_b16 v[48:49], v15 offset:0
    ds_read_b64_tr_b16 v[50:51], v15 offset:1024
    v_mfma_f32_16x16x32_bf16 v[220:223], v[52:55], a[124:127], v[220:223]
    ds_read_b64_tr_b16 v[52:53], v15 offset:8192
    ds_read_b64_tr_b16 v[54:55], v15 offset:9216
    v_mfma_f32_16x16x32_bf16 v[224:227], v[56:59], a[64:67], v[224:227]
    buffer_load_dwordx2 v[80:81], v75, s[28:31], s98 offen nt
    v_mfma_f32_16x16x32_bf16 v[224:227], v[60:63], a[68:71], v[224:227]
    s_xor_b32 s62, s62, 896
    v_add_u32 v15, 0xfffe0000, v15
    v_mfma_f32_16x16x32_bf16 v[228:231], v[56:59], a[72:75], v[228:231]
    buffer_load_dword v124, v120, s[40:43], s82 offen nt
    v_mfma_f32_16x16x32_bf16 v[228:231], v[60:63], a[76:79], v[228:231]
    v_mfma_f32_16x16x32_bf16 v[232:235], v[56:59], a[80:83], v[232:235]
    buffer_load_dword v105, v103, s[20:23], s77 offen
    v_mfma_f32_16x16x32_bf16 v[232:235], v[60:63], a[84:87], v[232:235]
    s_add_u32 m0, s69, 65536
    v_mfma_f32_16x16x32_bf16 v[236:239], v[56:59], a[88:91], v[236:239]
    s_mul_i32 s77, s2, 18432
    v_mfma_f32_16x16x32_bf16 v[236:239], v[60:63], a[92:95], v[236:239]
    s_add_u32 s77, s77, s76
    v_mfma_f32_16x16x32_bf16 v[240:243], v[56:59], a[96:99], v[240:243]
    s_mov_b32 s76, 0
    buffer_load_dwordx2 v[82:83], v77, s[28:31], s98 offen nt
    v_mfma_f32_16x16x32_bf16 v[240:243], v[60:63], a[100:103], v[240:243]
    s_add_u32 s98, s98, 3456
    v_mfma_f32_16x16x32_bf16 v[244:247], v[56:59], a[104:107], v[244:247]
    v_mfma_f32_16x16x32_bf16 v[244:247], v[60:63], a[108:111], v[244:247]
    v_mfma_f32_16x16x32_bf16 v[248:251], v[56:59], a[112:115], v[248:251]
    buffer_load_ushort v92, v65, s[32:35], s99 offen offset:0
    v_mfma_f32_16x16x32_bf16 v[248:251], v[60:63], a[116:119], v[248:251]
    v_mfma_f32_16x16x32_bf16 v[252:255], v[56:59], a[120:123], v[252:255]
    ds_read_b64_tr_b16 v[56:57], v16 offset:0
    ds_read_b64_tr_b16 v[58:59], v16 offset:1024
    v_mfma_f32_16x16x32_bf16 v[252:255], v[60:63], a[124:127], v[252:255]
    s_waitcnt lgkmcnt(2)
    ds_read_b64_tr_b16 v[60:61], v16 offset:8192
    ds_read_b64_tr_b16 v[62:63], v16 offset:9216
    v_mfma_f32_16x16x32_bf16 a[128:131], a[64:67], v[40:43], a[128:131]
    buffer_load_dwordx2 v[84:85], v75, s[28:31], s98 offen nt
    v_mfma_f32_16x16x32_bf16 a[128:131], a[68:71], v[44:47], a[128:131]
    v_add_u32 v22, 0x10000, v22
    v_add_u32 v16, 0xfffe0000, v16
    v_mfma_f32_16x16x32_bf16 a[132:135], a[72:75], v[40:43], a[132:135]
    ds_read_b128 a[32:35], v22 offset:16384
    v_mfma_f32_16x16x32_bf16 a[132:135], a[76:79], v[44:47], a[132:135]
    v_mfma_f32_16x16x32_bf16 a[136:139], a[80:83], v[40:43], a[136:139]
    buffer_load_dwordx4 v2, s[12:15], s60 offen nt lds
    v_mfma_f32_16x16x32_bf16 a[136:139], a[84:87], v[44:47], a[136:139]
    v_mfma_f32_16x16x32_bf16 a[140:143], a[88:91], v[40:43], a[140:143]
    v_add_u32 v23, 0x10000, v23
    v_mfma_f32_16x16x32_bf16 a[140:143], a[92:95], v[44:47], a[140:143]
    ds_read_b128 a[36:39], v23 offset:16384
    v_mfma_f32_16x16x32_bf16 a[144:147], a[96:99], v[40:43], a[144:147]
    buffer_load_dwordx2 v[86:87], v77, s[28:31], s98 offen nt
    v_mfma_f32_16x16x32_bf16 a[144:147], a[100:103], v[44:47], a[144:147]
    s_add_u32 s98, s98, 3456
    v_mfma_f32_16x16x32_bf16 a[148:151], a[104:107], v[40:43], a[148:151]
    v_mfma_f32_16x16x32_bf16 a[148:151], a[108:111], v[44:47], a[148:151]
    v_mfma_f32_16x16x32_bf16 a[152:155], a[112:115], v[40:43], a[152:155]
    buffer_load_ushort v93, v65, s[32:35], s99 offen offset:2
    v_mfma_f32_16x16x32_bf16 a[152:155], a[116:119], v[44:47], a[152:155]
    ds_read_b128 a[40:43], v22 offset:18432
    v_mfma_f32_16x16x32_bf16 a[156:159], a[120:123], v[40:43], a[156:159]
    ds_read_b64_tr_b16 v[40:41], v17 offset:0
    ds_read_b64_tr_b16 v[42:43], v17 offset:1024
    v_mfma_f32_16x16x32_bf16 a[156:159], a[124:127], v[44:47], a[156:159]
    ds_read_b64_tr_b16 v[44:45], v17 offset:8192
    ds_read_b64_tr_b16 v[46:47], v17 offset:9216
    v_mfma_f32_16x16x32_bf16 a[160:163], a[64:67], v[48:51], a[160:163]
    buffer_load_dwordx2 v[88:89], v75, s[28:31], s98 offen nt
    v_mfma_f32_16x16x32_bf16 a[160:163], a[68:71], v[52:55], a[160:163]
    v_add_u32 v17, 0xfffe0000, v17
    v_mfma_f32_16x16x32_bf16 a[164:167], a[72:75], v[48:51], a[164:167]
    ds_read_b128 a[44:47], v23 offset:18432
    v_mfma_f32_16x16x32_bf16 a[164:167], a[76:79], v[52:55], a[164:167]
    v_mfma_f32_16x16x32_bf16 a[168:171], a[80:83], v[48:51], a[168:171]
    buffer_load_dwordx4 v3, s[12:15], s60 offen offset:1024 nt lds
    v_mfma_f32_16x16x32_bf16 a[168:171], a[84:87], v[52:55], a[168:171]
    v_mfma_f32_16x16x32_bf16 a[172:175], a[88:91], v[48:51], a[172:175]
    v_mfma_f32_16x16x32_bf16 a[172:175], a[92:95], v[52:55], a[172:175]
    v_mfma_f32_16x16x32_bf16 a[176:179], a[96:99], v[48:51], a[176:179]
    buffer_load_dwordx2 v[90:91], v77, s[28:31], s98 offen nt
    v_mfma_f32_16x16x32_bf16 a[176:179], a[100:103], v[52:55], a[176:179]
    s_add_u32 s98, s98, 3456
    s_add_u32 s28, s56, 6291456
    s_addc_u32 s29, s57, 0
    v_mfma_f32_16x16x32_bf16 a[180:183], a[104:107], v[48:51], a[180:183]
    s_mov_b32 s30, 2359296
    ds_read_b128 a[48:51], v22 offset:20480
    v_mfma_f32_16x16x32_bf16 a[180:183], a[108:111], v[52:55], a[180:183]
    s_bfe_u32 s98, s72, 0x10001
    v_mfma_f32_16x16x32_bf16 a[184:187], a[112:115], v[48:51], a[184:187]
    buffer_load_ushort v94, v65, s[32:35], s99 offen offset:4
    v_mfma_f32_16x16x32_bf16 a[184:187], a[116:119], v[52:55], a[184:187]
    s_add_u32 s32, s56, 9437184
    s_addc_u32 s33, s57, 0
    s_mov_b32 s34, 163840
    v_mfma_f32_16x16x32_bf16 a[188:191], a[120:123], v[48:51], a[188:191]
    s_bfe_u32 s99, s72, 0x10003
    ds_read_b128 a[52:55], v23 offset:20480
    v_mfma_f32_16x16x32_bf16 a[188:191], a[124:127], v[52:55], a[188:191]
    s_lshl1_add_u32 s98, s99, s98
    s_waitcnt lgkmcnt(1)
    v_mfma_f32_16x16x32_bf16 a[192:195], a[64:67], v[56:59], a[192:195]
    s_lshl_b32 s98, s98, 5
    buffer_store_dword v65, v64, s[32:35], s101 offen sc1
    v_mfma_f32_16x16x32_bf16 a[192:195], a[68:71], v[60:63], a[192:195]
    s_lshl_b32 s72, s72, 7
    v_mfma_f32_16x16x32_bf16 a[196:199], a[72:75], v[56:59], a[196:199]
    v_mfma_f32_16x16x32_bf16 a[196:199], a[76:79], v[60:63], a[196:199]
    ds_read_b128 a[56:59], v22 offset:22528
    v_mfma_f32_16x16x32_bf16 a[200:203], a[80:83], v[56:59], a[200:203]
    buffer_load_dwordx4 v4, s[12:15], s60 offen offset:2048 nt lds
    v_mfma_f32_16x16x32_bf16 a[200:203], a[84:87], v[60:63], a[200:203]
    v_mfma_f32_16x16x32_bf16 a[204:207], a[88:91], v[56:59], a[204:207]
    v_mfma_f32_16x16x32_bf16 a[204:207], a[92:95], v[60:63], a[204:207]
    v_mfma_f32_16x16x32_bf16 a[208:211], a[96:99], v[56:59], a[208:211]
    buffer_load_dwordx4 v5, s[12:15], s60 offen offset:3072 nt lds
    v_mfma_f32_16x16x32_bf16 a[208:211], a[100:103], v[60:63], a[208:211]
    s_add_u32 m0, s69, 81920
    ds_read_b128 a[60:63], v23 offset:22528
    v_mfma_f32_16x16x32_bf16 a[212:215], a[104:107], v[56:59], a[212:215]
    v_mfma_f32_16x16x32_bf16 a[212:215], a[108:111], v[60:63], a[212:215]
    v_mfma_f32_16x16x32_bf16 a[216:219], a[112:115], v[56:59], a[216:219]
    buffer_load_dwordx4 v6, s[8:11], s61 offen lds
    v_mfma_f32_16x16x32_bf16 a[216:219], a[116:119], v[60:63], a[216:219]
    v_mfma_f32_16x16x32_bf16 a[220:223], a[120:123], v[56:59], a[220:223]
    v_mfma_f32_16x16x32_bf16 a[220:223], a[124:127], v[60:63], a[220:223]
    v_mfma_f32_16x16x32_bf16 a[224:227], a[64:67], v[40:43], a[224:227]
    buffer_load_dwordx4 v7, s[8:11], s61 offen offset:1024 lds
    v_mfma_f32_16x16x32_bf16 a[224:227], a[68:71], v[44:47], a[224:227]
    v_mfma_f32_16x16x32_bf16 a[228:231], a[72:75], v[40:43], a[228:231]
    v_mfma_f32_16x16x32_bf16 a[228:231], a[76:79], v[44:47], a[228:231]
    v_mfma_f32_16x16x32_bf16 a[232:235], a[80:83], v[40:43], a[232:235]
    buffer_load_dwordx4 v8, s[8:11], s61 offen offset:2048 lds
    v_mfma_f32_16x16x32_bf16 a[232:235], a[84:87], v[44:47], a[232:235]
    s_waitcnt vmcnt(19) lgkmcnt(0)
    s_barrier
    ds_read_b64_tr_b16 v[48:49], v14 offset:0
    v_mfma_f32_16x16x32_bf16 a[236:239], a[88:91], v[40:43], a[236:239]
    ds_read_b64_tr_b16 v[50:51], v14 offset:1024
    ds_read_b64_tr_b16 v[52:53], v14 offset:8192
    v_mfma_f32_16x16x32_bf16 a[236:239], a[92:95], v[44:47], a[236:239]
    ds_read_b64_tr_b16 v[54:55], v14 offset:9216
    ds_read_b64_tr_b16 v[56:57], v15 offset:0
    v_mfma_f32_16x16x32_bf16 a[240:243], a[96:99], v[40:43], a[240:243]
    buffer_load_dwordx4 v9, s[8:11], s61 offen offset:3072 lds
    v_mfma_f32_16x16x32_bf16 a[240:243], a[100:103], v[44:47], a[240:243]
    s_xor_b32 s61, s61, 128
    s_add_u32 m0, s69, 98304
    ds_read_b64_tr_b16 v[58:59], v15 offset:1024
    v_mfma_f32_16x16x32_bf16 a[244:247], a[104:107], v[40:43], a[244:247]
    ds_read_b64_tr_b16 v[60:61], v15 offset:8192
    ds_read_b64_tr_b16 v[62:63], v15 offset:9216
    v_mfma_f32_16x16x32_bf16 a[244:247], a[108:111], v[44:47], a[244:247]
    v_mfma_f32_16x16x32_bf16 a[248:251], a[112:115], v[40:43], a[248:251]
    buffer_load_dwordx4 v2, s[16:19], s60 offen nt lds
    v_mfma_f32_16x16x32_bf16 a[248:251], a[116:119], v[44:47], a[248:251]
    v_mfma_f32_16x16x32_bf16 a[252:255], a[120:123], v[40:43], a[252:255]
    ds_read_b64_tr_b16 v[40:41], v16 offset:0
    ds_read_b64_tr_b16 v[42:43], v16 offset:1024
    v_mfma_f32_16x16x32_bf16 a[252:255], a[124:127], v[44:47], a[252:255]
    s_waitcnt lgkmcnt(2)
    ds_read_b64_tr_b16 v[44:45], v16 offset:8192
    ds_read_b64_tr_b16 v[46:47], v16 offset:9216
    v_mfma_f32_16x16x32_bf16 v[128:131], v[48:51], a[0:3], v[128:131]
    buffer_load_dwordx4 v3, s[16:19], s60 offen offset:1024 nt lds
    v_mfma_f32_16x16x32_bf16 v[128:131], v[52:55], a[4:7], v[128:131]
    v_add_u32 v22, 0xfffe0000, v22
    v_mfma_f32_16x16x32_bf16 v[132:135], v[48:51], a[8:11], v[132:135]
    ds_read_b128 a[64:67], v22 offset:16384
    v_mfma_f32_16x16x32_bf16 v[132:135], v[52:55], a[12:15], v[132:135]
    s_cmp_lt_u32 s2, 192
    s_cselect_b32 s72, s72, 1073741824
    v_mfma_f32_16x16x32_bf16 v[136:139], v[48:51], a[16:19], v[136:139]
    v_mfma_f32_16x16x32_bf16 v[136:139], v[52:55], a[20:23], v[136:139]
    buffer_load_dwordx4 v4, s[16:19], s60 offen offset:2048 nt lds
    v_mfma_f32_16x16x32_bf16 v[140:143], v[48:51], a[24:27], v[140:143]
    v_add_u32 v23, 0xfffe0000, v23
    v_mfma_f32_16x16x32_bf16 v[140:143], v[52:55], a[28:31], v[140:143]
    ds_read_b128 a[68:71], v23 offset:16384
    v_mfma_f32_16x16x32_bf16 v[144:147], v[48:51], a[32:35], v[144:147]
    v_mfma_f32_16x16x32_bf16 v[144:147], v[52:55], a[36:39], v[144:147]
    v_mfma_f32_16x16x32_bf16 v[148:151], v[48:51], a[40:43], v[148:151]
    v_mfma_f32_16x16x32_bf16 v[148:151], v[52:55], a[44:47], v[148:151]
    v_mfma_f32_16x16x32_bf16 v[152:155], v[48:51], a[48:51], v[152:155]
    buffer_load_dwordx4 v5, s[16:19], s60 offen offset:3072 nt lds
    v_mfma_f32_16x16x32_bf16 v[152:155], v[52:55], a[52:55], v[152:155]
    ds_read_b128 a[72:75], v22 offset:18432
    v_mfma_f32_16x16x32_bf16 v[156:159], v[48:51], a[56:59], v[156:159]
    ds_read_b64_tr_b16 v[48:49], v17 offset:0
    ds_read_b64_tr_b16 v[50:51], v17 offset:1024
    v_mfma_f32_16x16x32_bf16 v[156:159], v[52:55], a[60:63], v[156:159]
    ds_read_b64_tr_b16 v[52:53], v17 offset:8192
    ds_read_b64_tr_b16 v[54:55], v17 offset:9216
    v_mfma_f32_16x16x32_bf16 v[160:163], v[56:59], a[0:3], v[160:163]
    v_mfma_f32_16x16x32_bf16 v[160:163], v[60:63], a[4:7], v[160:163]
    v_mfma_f32_16x16x32_bf16 v[164:167], v[56:59], a[8:11], v[164:167]
    ds_read_b128 a[76:79], v23 offset:18432
    v_mfma_f32_16x16x32_bf16 v[164:167], v[60:63], a[12:15], v[164:167]
    s_add_u32 m0, s69, 114688
    v_mfma_f32_16x16x32_bf16 v[168:171], v[56:59], a[16:19], v[168:171]
    s_xor_b32 s60, s60, 3670016
    buffer_load_dwordx4 v6, s[8:11], s62 offen lds
    v_mfma_f32_16x16x32_bf16 v[168:171], v[60:63], a[20:23], v[168:171]
    v_mfma_f32_16x16x32_bf16 v[172:175], v[56:59], a[24:27], v[172:175]
    v_mfma_f32_16x16x32_bf16 v[172:175], v[60:63], a[28:31], v[172:175]
    v_mfma_f32_16x16x32_bf16 v[176:179], v[56:59], a[32:35], v[176:179]
    ds_read_b128 a[80:83], v22 offset:20480
    v_mfma_f32_16x16x32_bf16 v[176:179], v[60:63], a[36:39], v[176:179]
    v_mfma_f32_16x16x32_bf16 v[180:183], v[56:59], a[40:43], v[180:183]
    v_mfma_f32_16x16x32_bf16 v[180:183], v[60:63], a[44:47], v[180:183]
    buffer_load_dwordx4 v7, s[8:11], s62 offen offset:1024 lds
    v_mfma_f32_16x16x32_bf16 v[184:187], v[56:59], a[48:51], v[184:187]
    v_mfma_f32_16x16x32_bf16 v[184:187], v[60:63], a[52:55], v[184:187]
    ds_read_b128 a[84:87], v23 offset:20480
    v_mfma_f32_16x16x32_bf16 v[188:191], v[56:59], a[56:59], v[188:191]
    s_waitcnt lgkmcnt(1)
    ds_read_b64_tr_b16 v[56:57], v14 offset:32768
    ds_read_b64_tr_b16 v[58:59], v14 offset:33792
    v_mfma_f32_16x16x32_bf16 v[188:191], v[60:63], a[60:63], v[188:191]
    ds_read_b64_tr_b16 v[60:61], v14 offset:40960
    ds_read_b64_tr_b16 v[62:63], v14 offset:41984
    v_mfma_f32_16x16x32_bf16 v[192:195], v[40:43], a[0:3], v[192:195]
    v_add_u32 v14, 0x10000, v14
    v_mfma_f32_16x16x32_bf16 v[192:195], v[44:47], a[4:7], v[192:195]
    v_mfma_f32_16x16x32_bf16 v[196:199], v[40:43], a[8:11], v[196:199]
    v_mfma_f32_16x16x32_bf16 v[196:199], v[44:47], a[12:15], v[196:199]
    buffer_load_dwordx4 v8, s[8:11], s62 offen offset:2048 lds
    v_mfma_f32_16x16x32_bf16 v[200:203], v[40:43], a[16:19], v[200:203]
    ds_read_b128 a[88:91], v22 offset:22528
    v_mfma_f32_16x16x32_bf16 v[200:203], v[44:47], a[20:23], v[200:203]
    v_mfma_f32_16x16x32_bf16 v[204:207], v[40:43], a[24:27], v[204:207]
    v_mfma_f32_16x16x32_bf16 v[204:207], v[44:47], a[28:31], v[204:207]
    v_mfma_f32_16x16x32_bf16 v[208:211], v[40:43], a[32:35], v[208:211]
    ds_read_b128 a[92:95], v23 offset:22528
    v_mfma_f32_16x16x32_bf16 v[208:211], v[44:47], a[36:39], v[208:211]
    v_mfma_f32_16x16x32_bf16 v[212:215], v[40:43], a[40:43], v[212:215]
    buffer_load_dwordx4 v9, s[8:11], s62 offen offset:3072 lds
    v_mfma_f32_16x16x32_bf16 v[212:215], v[44:47], a[44:47], v[212:215]
    v_mfma_f32_16x16x32_bf16 v[216:219], v[40:43], a[48:51], v[216:219]
    v_mfma_f32_16x16x32_bf16 v[216:219], v[44:47], a[52:55], v[216:219]
    v_mfma_f32_16x16x32_bf16 v[220:223], v[40:43], a[56:59], v[220:223]
    s_xor_b32 s82, s84, 2621696
    ds_read_b64_tr_b16 v[40:41], v15 offset:32768
    ds_read_b64_tr_b16 v[42:43], v15 offset:33792
    v_mfma_f32_16x16x32_bf16 v[220:223], v[44:47], a[60:63], v[220:223]
    ds_read_b64_tr_b16 v[44:45], v15 offset:40960
    ds_read_b64_tr_b16 v[46:47], v15 offset:41984
    v_mfma_f32_16x16x32_bf16 v[224:227], v[48:51], a[0:3], v[224:227]
    v_add_u32 v15, 0x10000, v15
    v_mfma_f32_16x16x32_bf16 v[224:227], v[52:55], a[4:7], v[224:227]
    s_xor_b32 s62, s62, 128
    v_mfma_f32_16x16x32_bf16 v[228:231], v[48:51], a[8:11], v[228:231]
    buffer_load_dword v125, v120, s[40:43], s82 offen nt
    v_mfma_f32_16x16x32_bf16 v[228:231], v[52:55], a[12:15], v[228:231]
    buffer_load_dword v106, v103, s[24:27], s77 offen
    v_mfma_f32_16x16x32_bf16 v[232:235], v[48:51], a[16:19], v[232:235]
    s_add_u32 s77, s77, 4608
    v_mfma_f32_16x16x32_bf16 v[232:235], v[52:55], a[20:23], v[232:235]
    s_add_u32 m0, s69, 131072
    v_mfma_f32_16x16x32_bf16 v[236:239], v[48:51], a[24:27], v[236:239]
    buffer_load_dwordx4 v2, s[12:15], s60 offen nt lds
    v_mfma_f32_16x16x32_bf16 v[236:239], v[52:55], a[28:31], v[236:239]
    v_mfma_f32_16x16x32_bf16 v[240:243], v[48:51], a[32:35], v[240:243]
    v_mfma_f32_16x16x32_bf16 v[240:243], v[52:55], a[36:39], v[240:243]
    v_mfma_f32_16x16x32_bf16 v[244:247], v[48:51], a[40:43], v[244:247]
    v_mfma_f32_16x16x32_bf16 v[244:247], v[52:55], a[44:47], v[244:247]
    v_mfma_f32_16x16x32_bf16 v[248:251], v[48:51], a[48:51], v[248:251]
    v_mfma_f32_16x16x32_bf16 v[248:251], v[52:55], a[52:55], v[248:251]
    buffer_load_dwordx4 v3, s[12:15], s60 offen offset:1024 nt lds
    v_mfma_f32_16x16x32_bf16 v[252:255], v[48:51], a[56:59], v[252:255]
    ds_read_b64_tr_b16 v[48:49], v16 offset:32768
    ds_read_b64_tr_b16 v[50:51], v16 offset:33792
    v_mfma_f32_16x16x32_bf16 v[252:255], v[52:55], a[60:63], v[252:255]
    s_waitcnt lgkmcnt(2)
    ds_read_b64_tr_b16 v[52:53], v16 offset:40960
    ds_read_b64_tr_b16 v[54:55], v16 offset:41984
    v_mfma_f32_16x16x32_bf16 a[128:131], a[0:3], v[56:59], a[128:131]
    v_add_u32 v16, 0x10000, v16
    v_mfma_f32_16x16x32_bf16 a[128:131], a[4:7], v[60:63], a[128:131]
    v_mfma_f32_16x16x32_bf16 a[132:135], a[8:11], v[56:59], a[132:135]
    ds_read_b128 a[96:99], v22 offset:49152
    v_mfma_f32_16x16x32_bf16 a[132:135], a[12:15], v[60:63], a[132:135]
    v_mfma_f32_16x16x32_bf16 a[136:139], a[16:19], v[56:59], a[136:139]
    v_mfma_f32_16x16x32_bf16 a[136:139], a[20:23], v[60:63], a[136:139]
    buffer_load_dwordx4 v4, s[12:15], s60 offen offset:2048 nt lds
    v_mfma_f32_16x16x32_bf16 a[140:143], a[24:27], v[56:59], a[140:143]
    v_mfma_f32_16x16x32_bf16 a[140:143], a[28:31], v[60:63], a[140:143]
    ds_read_b128 a[100:103], v23 offset:49152
    v_mfma_f32_16x16x32_bf16 a[144:147], a[32:35], v[56:59], a[144:147]
    v_mfma_f32_16x16x32_bf16 a[144:147], a[36:39], v[60:63], a[144:147]
    v_mfma_f32_16x16x32_bf16 a[148:151], a[40:43], v[56:59], a[148:151]
    v_mfma_f32_16x16x32_bf16 a[148:151], a[44:47], v[60:63], a[148:151]
    v_mfma_f32_16x16x32_bf16 a[152:155], a[48:51], v[56:59], a[152:155]
    buffer_load_dwordx4 v5, s[12:15], s60 offen offset:3072 nt lds
    v_mfma_f32_16x16x32_bf16 a[152:155], a[52:55], v[60:63], a[152:155]
    ds_read_b128 a[104:107], v22 offset:51200
    v_mfma_f32_16x16x32_bf16 a[156:159], a[56:59], v[56:59], a[156:159]
    ds_read_b64_tr_b16 v[56:57], v17 offset:32768
    ds_read_b64_tr_b16 v[58:59], v17 offset:33792
    v_mfma_f32_16x16x32_bf16 a[156:159], a[60:63], v[60:63], a[156:159]
    ds_read_b64_tr_b16 v[60:61], v17 offset:40960
    ds_read_b64_tr_b16 v[62:63], v17 offset:41984
    v_mfma_f32_16x16x32_bf16 a[160:163], a[0:3], v[40:43], a[160:163]
    v_add_u32 v17, 0x10000, v17
    v_mfma_f32_16x16x32_bf16 a[160:163], a[4:7], v[44:47], a[160:163]
    v_mfma_f32_16x16x32_bf16 a[164:167], a[8:11], v[40:43], a[164:167]
    ds_read_b128 a[108:111], v23 offset:51200
    v_mfma_f32_16x16x32_bf16 a[164:167], a[12:15], v[44:47], a[164:167]
    s_add_u32 m0, s69, 147456
    v_mfma_f32_16x16x32_bf16 a[168:171], a[16:19], v[40:43], a[168:171]
    buffer_load_dwordx4 v6, s[8:11], s61 offen lds
    v_mfma_f32_16x16x32_bf16 a[168:171], a[20:23], v[44:47], a[168:171]
    v_mfma_f32_16x16x32_bf16 a[172:175], a[24:27], v[40:43], a[172:175]
    v_mfma_f32_16x16x32_bf16 a[172:175], a[28:31], v[44:47], a[172:175]
    v_mfma_f32_16x16x32_bf16 a[176:179], a[32:35], v[40:43], a[176:179]
    ds_read_b128 a[112:115], v22 offset:53248
    v_mfma_f32_16x16x32_bf16 a[176:179], a[36:39], v[44:47], a[176:179]
    v_mfma_f32_16x16x32_bf16 a[180:183], a[40:43], v[40:43], a[180:183]
    v_mfma_f32_16x16x32_bf16 a[180:183], a[44:47], v[44:47], a[180:183]
    buffer_load_dwordx4 v7, s[8:11], s61 offen offset:1024 lds
    v_mfma_f32_16x16x32_bf16 a[184:187], a[48:51], v[40:43], a[184:187]
    v_mfma_f32_16x16x32_bf16 a[184:187], a[52:55], v[44:47], a[184:187]
    ds_read_b128 a[116:119], v23 offset:53248
    v_mfma_f32_16x16x32_bf16 a[188:191], a[56:59], v[40:43], a[188:191]
    v_mfma_f32_16x16x32_bf16 a[188:191], a[60:63], v[44:47], a[188:191]
    s_waitcnt lgkmcnt(1)
    v_mfma_f32_16x16x32_bf16 a[192:195], a[0:3], v[48:51], a[192:195]
    v_mfma_f32_16x16x32_bf16 a[192:195], a[4:7], v[52:55], a[192:195]
    v_mfma_f32_16x16x32_bf16 a[196:199], a[8:11], v[48:51], a[196:199]
    v_mfma_f32_16x16x32_bf16 a[196:199], a[12:15], v[52:55], a[196:199]
    buffer_load_dwordx4 v8, s[8:11], s61 offen offset:2048 lds
    v_mfma_f32_16x16x32_bf16 a[200:203], a[16:19], v[48:51], a[200:203]
    ds_read_b128 a[120:123], v22 offset:55296
    v_mfma_f32_16x16x32_bf16 a[200:203], a[20:23], v[52:55], a[200:203]
    v_mfma_f32_16x16x32_bf16 a[204:207], a[24:27], v[48:51], a[204:207]
    v_mfma_f32_16x16x32_bf16 a[204:207], a[28:31], v[52:55], a[204:207]
    v_mfma_f32_16x16x32_bf16 a[208:211], a[32:35], v[48:51], a[208:211]
    ds_read_b128 a[124:127], v23 offset:55296
    v_mfma_f32_16x16x32_bf16 a[208:211], a[36:39], v[52:55], a[208:211]
    v_mfma_f32_16x16x32_bf16 a[212:215], a[40:43], v[48:51], a[212:215]
    buffer_load_dwordx4 v9, s[8:11], s61 offen offset:3072 lds
    v_mfma_f32_16x16x32_bf16 a[212:215], a[44:47], v[52:55], a[212:215]
    v_mfma_f32_16x16x32_bf16 a[216:219], a[48:51], v[48:51], a[216:219]
    v_mfma_f32_16x16x32_bf16 a[216:219], a[52:55], v[52:55], a[216:219]
    v_mfma_f32_16x16x32_bf16 a[220:223], a[56:59], v[48:51], a[220:223]
    v_mfma_f32_16x16x32_bf16 a[220:223], a[60:63], v[52:55], a[220:223]
    v_mfma_f32_16x16x32_bf16 a[224:227], a[0:3], v[56:59], a[224:227]
    v_mfma_f32_16x16x32_bf16 a[224:227], a[4:7], v[60:63], a[224:227]
    s_xor_b32 s61, s61, 384
    v_mfma_f32_16x16x32_bf16 a[228:231], a[8:11], v[56:59], a[228:231]
    v_mfma_f32_16x16x32_bf16 a[228:231], a[12:15], v[60:63], a[228:231]
    v_mfma_f32_16x16x32_bf16 a[232:235], a[16:19], v[56:59], a[232:235]
    v_mfma_f32_16x16x32_bf16 a[232:235], a[20:23], v[60:63], a[232:235]
    s_waitcnt vmcnt(10) lgkmcnt(0)
    s_barrier
    ds_read_b64_tr_b16 v[40:41], v14 offset:0
    v_mfma_f32_16x16x32_bf16 a[236:239], a[24:27], v[56:59], a[236:239]
    s_add_u32 m0, s69, 0
    ds_read_b64_tr_b16 v[42:43], v14 offset:1024
    ds_read_b64_tr_b16 v[44:45], v14 offset:8192
    v_mfma_f32_16x16x32_bf16 a[236:239], a[28:31], v[60:63], a[236:239]
    buffer_load_dwordx4 v2, s[16:19], s60 offen nt lds
    v_mfma_f32_16x16x32_bf16 a[240:243], a[32:35], v[56:59], a[240:243]
    ds_read_b64_tr_b16 v[46:47], v14 offset:9216
    v_cndmask_b32 v82, v82, v92, s[92:93]
    v_mfma_f32_16x16x32_bf16 a[240:243], a[36:39], v[60:63], a[240:243]
    v_cndmask_b32_e64 v83, v83, 0, s[92:93]
    v_xor_b32 v92, s98, v95
    v_mfma_f32_16x16x32_bf16 a[244:247], a[40:43], v[56:59], a[244:247]
    buffer_store_dwordx4 v[80:83], v92, s[28:31], s72 offen sc1
    v_mfma_f32_16x16x32_bf16 a[244:247], a[44:47], v[60:63], a[244:247]
    s_mul_i32 s72, s2, 3
    ds_read_b64_tr_b16 v[48:49], v15 offset:0
    ds_read_b64_tr_b16 v[50:51], v15 offset:1024
    v_mfma_f32_16x16x32_bf16 a[248:251], a[48:51], v[56:59], a[248:251]
    s_add_u32 s72, s72, 1
    ds_read_b64_tr_b16 v[52:53], v15 offset:8192
    ds_read_b64_tr_b16 v[54:55], v15 offset:9216
    v_mfma_f32_16x16x32_bf16 a[248:251], a[52:55], v[60:63], a[248:251]
    s_bfe_u32 s98, s72, 0x10001
    buffer_load_dwordx4 v3, s[16:19], s60 offen offset:1024 nt lds
    v_mfma_f32_16x16x32_bf16 a[252:255], a[56:59], v[56:59], a[252:255]
    s_bfe_u32 s99, s72, 0x10003
    v_cndmask_b32 v86, v86, v93, s[92:93]
    v_cndmask_b32_e64 v87, v87, 0, s[92:93]
    v_mfma_f32_16x16x32_bf16 a[252:255], a[60:63], v[60:63], a[252:255]
    s_lshl1_add_u32 s98, s99, s98
    v_cndmask_b32 v90, v90, v94, s[92:93]
    v_cndmask_b32_e64 v91, v91, 0, s[92:93]
    s_waitcnt lgkmcnt(4)
    v_mfma_f32_16x16x32_bf16 v[128:131], v[40:43], a[64:67], v[128:131]
    s_lshl_b32 s98, s98, 5
    v_xor_b32 v93, s98, v95
    ds_read_b64_tr_b16 v[56:57], v16 offset:0
    v_mfma_f32_16x16x32_bf16 v[128:131], v[44:47], a[68:71], v[128:131]
    s_lshl_b32 s72, s72, 7
    v_add_u32 v22, 0x10000, v22
    ds_read_b64_tr_b16 v[58:59], v16 offset:1024
    v_mfma_f32_16x16x32_bf16 v[132:135], v[40:43], a[72:75], v[132:135]
    ds_read_b128 a[0:3], v22 offset:16384
    ds_read_b64_tr_b16 v[60:61], v16 offset:8192
    v_mfma_f32_16x16x32_bf16 v[132:135], v[44:47], a[76:79], v[132:135]
    s_cmp_lt_u32 s2, 192
    s_cselect_b32 s72, s72, 1073741824
    ds_read_b64_tr_b16 v[62:63], v16 offset:9216
    v_mfma_f32_16x16x32_bf16 v[136:139], v[40:43], a[80:83], v[136:139]
    buffer_store_dwordx4 v[84:87], v93, s[28:31], s72 offen sc1
    v_mfma_f32_16x16x32_bf16 v[136:139], v[44:47], a[84:87], v[136:139]
    s_mul_i32 s72, s2, 3
    buffer_load_dwordx4 v4, s[16:19], s60 offen offset:2048 nt lds
    v_mfma_f32_16x16x32_bf16 v[140:143], v[40:43], a[88:91], v[140:143]
    s_add_u32 s72, s72, 2
    v_add_u32 v23, 0x10000, v23
    v_mfma_f32_16x16x32_bf16 v[140:143], v[44:47], a[92:95], v[140:143]
    s_bfe_u32 s98, s72, 0x10001
    ds_read_b128 a[4:7], v23 offset:16384
    v_mfma_f32_16x16x32_bf16 v[144:147], v[40:43], a[96:99], v[144:147]
    s_bfe_u32 s99, s72, 0x10003
    v_mfma_f32_16x16x32_bf16 v[144:147], v[44:47], a[100:103], v[144:147]
    s_lshl1_add_u32 s98, s99, s98
    v_mfma_f32_16x16x32_bf16 v[148:151], v[40:43], a[104:107], v[148:151]
    s_lshl_b32 s98, s98, 5
    v_xor_b32 v94, s98, v95
    v_mfma_f32_16x16x32_bf16 v[148:151], v[44:47], a[108:111], v[148:151]
    s_lshl_b32 s72, s72, 7
    v_mfma_f32_16x16x32_bf16 v[152:155], v[40:43], a[112:115], v[152:155]
    s_lshl2_add_u32 s99, s100, s4
    buffer_load_dwordx4 v5, s[16:19], s60 offen offset:3072 nt lds
    v_mfma_f32_16x16x32_bf16 v[152:155], v[44:47], a[116:119], v[152:155]
    s_lshl_b32 s99, s99, 7
    ds_read_b128 a[8:11], v22 offset:18432
    v_mfma_f32_16x16x32_bf16 v[156:159], v[40:43], a[120:123], v[156:159]
    s_cmp_lt_u32 s2, 192
    s_cselect_b32 s72, s72, 1073741824
    ds_read_b64_tr_b16 v[40:41], v17 offset:0
    v_mfma_f32_16x16x32_bf16 v[156:159], v[44:47], a[124:127], v[156:159]
    s_waitcnt lgkmcnt(2)
    buffer_store_dwordx4 v[88:91], v94, s[28:31], s72 offen sc1
    v_mfma_f32_16x16x32_bf16 v[160:163], v[48:51], a[64:67], v[160:163]
    s_mov_b32 s30, 73728
    ds_read_b64_tr_b16 v[42:43], v17 offset:1024
    ds_read_b64_tr_b16 v[44:45], v17 offset:8192
    v_mfma_f32_16x16x32_bf16 v[160:163], v[52:55], a[68:71], v[160:163]
    ds_read_b64_tr_b16 v[46:47], v17 offset:9216
    v_mfma_f32_16x16x32_bf16 v[164:167], v[48:51], a[72:75], v[164:167]
    ds_read_b128 a[12:15], v23 offset:18432
    v_mfma_f32_16x16x32_bf16 v[164:167], v[52:55], a[76:79], v[164:167]
    s_add_u32 m0, s69, 16384
    v_mfma_f32_16x16x32_bf16 v[168:171], v[48:51], a[80:83], v[168:171]
    s_xor_b32 s60, s60, 524288
    buffer_load_dwordx4 v6, s[8:11], s62 offen lds
    v_mfma_f32_16x16x32_bf16 v[168:171], v[52:55], a[84:87], v[168:171]
    s_add_u32 s28, s28, s7
    s_addc_u32 s29, s29, 0
    v_mfma_f32_16x16x32_bf16 v[172:175], v[48:51], a[88:91], v[172:175]
    s_lshr_b32 s7, s6, 1
    v_mfma_f32_16x16x32_bf16 v[172:175], v[52:55], a[92:95], v[172:175]
    s_lshl2_add_u32 s7, s5, s7
    v_mfma_f32_16x16x32_bf16 v[176:179], v[48:51], a[96:99], v[176:179]
    s_mul_i32 s98, s7, 36864
    ds_read_b128 a[16:19], v22 offset:20480
    v_add_u32 v36, s98, v36
    v_mfma_f32_16x16x32_bf16 v[176:179], v[52:55], a[100:103], v[176:179]
    s_mul_i32 s7, s7, 36864
    v_sub_u32 v39, v36, v39
    v_lshl_add_u32 v36, s100, 6, v36
    v_mfma_f32_16x16x32_bf16 v[180:183], v[48:51], a[104:107], v[180:183]
    v_mfma_f32_16x16x32_bf16 v[180:183], v[52:55], a[108:111], v[180:183]
    buffer_load_dwordx4 v7, s[8:11], s62 offen offset:1024 lds
    v_mfma_f32_16x16x32_bf16 v[184:187], v[48:51], a[112:115], v[184:187]
    v_mfma_f32_16x16x32_bf16 v[184:187], v[52:55], a[116:119], v[184:187]
    ds_read_b128 a[20:23], v23 offset:20480
    v_mfma_f32_16x16x32_bf16 v[188:191], v[48:51], a[120:123], v[188:191]
    ds_read_b64_tr_b16 v[48:49], v14 offset:32768
    ds_read_b64_tr_b16 v[50:51], v14 offset:33792
    v_mfma_f32_16x16x32_bf16 v[188:191], v[52:55], a[124:127], v[188:191]
    ds_read_b64_tr_b16 v[52:53], v14 offset:40960
    ds_read_b64_tr_b16 v[54:55], v14 offset:41984
    v_mfma_f32_16x16x32_bf16 v[192:195], v[56:59], a[64:67], v[192:195]
    v_add_u32 v14, 0x10000, v14
    v_mfma_f32_16x16x32_bf16 v[192:195], v[60:63], a[68:71], v[192:195]
    v_mfma_f32_16x16x32_bf16 v[196:199], v[56:59], a[72:75], v[196:199]
    v_mfma_f32_16x16x32_bf16 v[196:199], v[60:63], a[76:79], v[196:199]
    buffer_load_dwordx4 v8, s[8:11], s62 offen offset:2048 lds
    v_mfma_f32_16x16x32_bf16 v[200:203], v[56:59], a[80:83], v[200:203]
    ds_read_b128 a[24:27], v22 offset:22528
    v_mfma_f32_16x16x32_bf16 v[200:203], v[60:63], a[84:87], v[200:203]
    v_mfma_f32_16x16x32_bf16 v[204:207], v[56:59], a[88:91], v[204:207]
    v_mfma_f32_16x16x32_bf16 v[204:207], v[60:63], a[92:95], v[204:207]
    v_mfma_f32_16x16x32_bf16 v[208:211], v[56:59], a[96:99], v[208:211]
    ds_read_b128 a[28:31], v23 offset:22528
    v_mfma_f32_16x16x32_bf16 v[208:211], v[60:63], a[100:103], v[208:211]
    v_mfma_f32_16x16x32_bf16 v[212:215], v[56:59], a[104:107], v[212:215]
    buffer_load_dwordx4 v9, s[8:11], s62 offen offset:3072 lds
    v_mfma_f32_16x16x32_bf16 v[212:215], v[60:63], a[108:111], v[212:215]
    v_mfma_f32_16x16x32_bf16 v[216:219], v[56:59], a[112:115], v[216:219]
    v_mfma_f32_16x16x32_bf16 v[216:219], v[60:63], a[116:119], v[216:219]
    v_mfma_f32_16x16x32_bf16 v[220:223], v[56:59], a[120:123], v[220:223]
    s_xor_b32 s82, s84, 3146240
    ds_read_b64_tr_b16 v[56:57], v15 offset:32768
    s_waitcnt lgkmcnt(1)
    ds_read_b64_tr_b16 v[58:59], v15 offset:33792
    v_mfma_f32_16x16x32_bf16 v[220:223], v[60:63], a[124:127], v[220:223]
    ds_read_b64_tr_b16 v[60:61], v15 offset:40960
    ds_read_b64_tr_b16 v[62:63], v15 offset:41984
    v_mfma_f32_16x16x32_bf16 v[224:227], v[40:43], a[64:67], v[224:227]
    v_add_u32 v15, 0x10000, v15
    v_mfma_f32_16x16x32_bf16 v[224:227], v[44:47], a[68:71], v[224:227]
    s_xor_b32 s62, s62, 384
    v_mfma_f32_16x16x32_bf16 v[228:231], v[40:43], a[72:75], v[228:231]
    buffer_load_dword v126, v120, s[40:43], s82 offen nt
    v_mfma_f32_16x16x32_bf16 v[228:231], v[44:47], a[76:79], v[228:231]
    buffer_load_dword v107, v103, s[24:27], s77 offen
    v_mfma_f32_16x16x32_bf16 v[232:235], v[40:43], a[80:83], v[232:235]
    s_add_u32 s77, s77, 4608
    v_mfma_f32_16x16x32_bf16 v[232:235], v[44:47], a[84:87], v[232:235]
    s_add_u32 m0, s69, 32768
    v_mfma_f32_16x16x32_bf16 v[236:239], v[40:43], a[88:91], v[236:239]
    buffer_load_dwordx4 v2, s[12:15], s60 offen nt lds
    v_mfma_f32_16x16x32_bf16 v[236:239], v[44:47], a[92:95], v[236:239]
    v_mfma_f32_16x16x32_bf16 v[240:243], v[40:43], a[96:99], v[240:243]
    v_mfma_f32_16x16x32_bf16 v[240:243], v[44:47], a[100:103], v[240:243]
    v_mfma_f32_16x16x32_bf16 v[244:247], v[40:43], a[104:107], v[244:247]
    v_mfma_f32_16x16x32_bf16 v[244:247], v[44:47], a[108:111], v[244:247]
    v_mfma_f32_16x16x32_bf16 v[248:251], v[40:43], a[112:115], v[248:251]
    v_mfma_f32_16x16x32_bf16 v[248:251], v[44:47], a[116:119], v[248:251]
    buffer_load_dwordx4 v3, s[12:15], s60 offen offset:1024 nt lds
    v_mfma_f32_16x16x32_bf16 v[252:255], v[40:43], a[120:123], v[252:255]
    ds_read_b64_tr_b16 v[40:41], v16 offset:32768
    ds_read_b64_tr_b16 v[42:43], v16 offset:33792
    v_mfma_f32_16x16x32_bf16 v[252:255], v[44:47], a[124:127], v[252:255]
    ds_read_b64_tr_b16 v[44:45], v16 offset:40960
    ds_read_b64_tr_b16 v[46:47], v16 offset:41984
    v_mfma_f32_16x16x32_bf16 a[128:131], a[64:67], v[48:51], a[128:131]
    v_add_u32 v16, 0x10000, v16
    v_mfma_f32_16x16x32_bf16 a[128:131], a[68:71], v[52:55], a[128:131]
    v_mfma_f32_16x16x32_bf16 a[132:135], a[72:75], v[48:51], a[132:135]
    ds_read_b128 a[32:35], v22 offset:49152
    v_mfma_f32_16x16x32_bf16 a[132:135], a[76:79], v[52:55], a[132:135]
    v_mfma_f32_16x16x32_bf16 a[136:139], a[80:83], v[48:51], a[136:139]
    v_mfma_f32_16x16x32_bf16 a[136:139], a[84:87], v[52:55], a[136:139]
    buffer_load_dwordx4 v4, s[12:15], s60 offen offset:2048 nt lds
    v_mfma_f32_16x16x32_bf16 a[140:143], a[88:91], v[48:51], a[140:143]
    v_mfma_f32_16x16x32_bf16 a[140:143], a[92:95], v[52:55], a[140:143]
    ds_read_b128 a[36:39], v23 offset:49152
    v_mfma_f32_16x16x32_bf16 a[144:147], a[96:99], v[48:51], a[144:147]
    v_mfma_f32_16x16x32_bf16 a[144:147], a[100:103], v[52:55], a[144:147]
    v_mfma_f32_16x16x32_bf16 a[148:151], a[104:107], v[48:51], a[148:151]
    v_mfma_f32_16x16x32_bf16 a[148:151], a[108:111], v[52:55], a[148:151]
    v_mfma_f32_16x16x32_bf16 a[152:155], a[112:115], v[48:51], a[152:155]
    buffer_load_dwordx4 v5, s[12:15], s60 offen offset:3072 nt lds
    v_mfma_f32_16x16x32_bf16 a[152:155], a[116:119], v[52:55], a[152:155]
    ds_read_b128 a[40:43], v22 offset:51200
    v_mfma_f32_16x16x32_bf16 a[156:159], a[120:123], v[48:51], a[156:159]
    ds_read_b64_tr_b16 v[48:49], v17 offset:32768
    ds_read_b64_tr_b16 v[50:51], v17 offset:33792
    v_mfma_f32_16x16x32_bf16 a[156:159], a[124:127], v[52:55], a[156:159]
    s_waitcnt lgkmcnt(3)
    ds_read_b64_tr_b16 v[52:53], v17 offset:40960
    ds_read_b64_tr_b16 v[54:55], v17 offset:41984
    v_mfma_f32_16x16x32_bf16 a[160:163], a[64:67], v[56:59], a[160:163]
    v_add_u32 v17, 0x10000, v17
    v_mfma_f32_16x16x32_bf16 a[160:163], a[68:71], v[60:63], a[160:163]
    v_mfma_f32_16x16x32_bf16 a[164:167], a[72:75], v[56:59], a[164:167]
    ds_read_b128 a[44:47], v23 offset:51200
    v_mfma_f32_16x16x32_bf16 a[164:167], a[76:79], v[60:63], a[164:167]
    s_add_u32 m0, s69, 49152
    v_mfma_f32_16x16x32_bf16 a[168:171], a[80:83], v[56:59], a[168:171]
    buffer_load_dwordx4 v6, s[8:11], s61 offen lds
    v_mfma_f32_16x16x32_bf16 a[168:171], a[84:87], v[60:63], a[168:171]
    v_mfma_f32_16x16x32_bf16 a[172:175], a[88:91], v[56:59], a[172:175]
    v_mfma_f32_16x16x32_bf16 a[172:175], a[92:95], v[60:63], a[172:175]
    v_mfma_f32_16x16x32_bf16 a[176:179], a[96:99], v[56:59], a[176:179]
    ds_read_b128 a[48:51], v22 offset:53248
    v_mfma_f32_16x16x32_bf16 a[176:179], a[100:103], v[60:63], a[176:179]
    v_mfma_f32_16x16x32_bf16 a[180:183], a[104:107], v[56:59], a[180:183]
    v_mfma_f32_16x16x32_bf16 a[180:183], a[108:111], v[60:63], a[180:183]
    buffer_load_dwordx4 v7, s[8:11], s61 offen offset:1024 lds
    v_mfma_f32_16x16x32_bf16 a[184:187], a[112:115], v[56:59], a[184:187]
    v_mfma_f32_16x16x32_bf16 a[184:187], a[116:119], v[60:63], a[184:187]
    ds_read_b128 a[52:55], v23 offset:53248
    v_mfma_f32_16x16x32_bf16 a[188:191], a[120:123], v[56:59], a[188:191]
    v_mfma_f32_16x16x32_bf16 a[188:191], a[124:127], v[60:63], a[188:191]
    v_mfma_f32_16x16x32_bf16 a[192:195], a[64:67], v[40:43], a[192:195]
    v_mfma_f32_16x16x32_bf16 a[192:195], a[68:71], v[44:47], a[192:195]
    v_mfma_f32_16x16x32_bf16 a[196:199], a[72:75], v[40:43], a[196:199]
    v_mfma_f32_16x16x32_bf16 a[196:199], a[76:79], v[44:47], a[196:199]
    buffer_load_dwordx4 v8, s[8:11], s61 offen offset:2048 lds
    v_mfma_f32_16x16x32_bf16 a[200:203], a[80:83], v[40:43], a[200:203]
    ds_read_b128 a[56:59], v22 offset:55296
    v_mfma_f32_16x16x32_bf16 a[200:203], a[84:87], v[44:47], a[200:203]
    v_mfma_f32_16x16x32_bf16 a[204:207], a[88:91], v[40:43], a[204:207]
    v_mfma_f32_16x16x32_bf16 a[204:207], a[92:95], v[44:47], a[204:207]
    v_mfma_f32_16x16x32_bf16 a[208:211], a[96:99], v[40:43], a[208:211]
    ds_read_b128 a[60:63], v23 offset:55296
    v_mfma_f32_16x16x32_bf16 a[208:211], a[100:103], v[44:47], a[208:211]
    v_mfma_f32_16x16x32_bf16 a[212:215], a[104:107], v[40:43], a[212:215]
    buffer_load_dwordx4 v9, s[8:11], s61 offen offset:3072 lds
    v_mfma_f32_16x16x32_bf16 a[212:215], a[108:111], v[44:47], a[212:215]
    v_mfma_f32_16x16x32_bf16 a[216:219], a[112:115], v[40:43], a[216:219]
    v_mfma_f32_16x16x32_bf16 a[216:219], a[116:119], v[44:47], a[216:219]
    v_mfma_f32_16x16x32_bf16 a[220:223], a[120:123], v[40:43], a[220:223]
    v_mfma_f32_16x16x32_bf16 a[220:223], a[124:127], v[44:47], a[220:223]
    s_waitcnt lgkmcnt(0)
    v_mfma_f32_16x16x32_bf16 a[224:227], a[64:67], v[48:51], a[224:227]
    v_mfma_f32_16x16x32_bf16 a[224:227], a[68:71], v[52:55], a[224:227]
    s_xor_b32 s61, s61, 128
    v_mfma_f32_16x16x32_bf16 a[228:231], a[72:75], v[48:51], a[228:231]
    v_mfma_f32_16x16x32_bf16 a[228:231], a[76:79], v[52:55], a[228:231]
    v_mfma_f32_16x16x32_bf16 a[232:235], a[80:83], v[48:51], a[232:235]
    v_mfma_f32_16x16x32_bf16 a[232:235], a[84:87], v[52:55], a[232:235]
    s_waitcnt vmcnt(10) lgkmcnt(0)
    s_barrier
    ds_read_b64_tr_b16 v[56:57], v14 offset:0
    v_mfma_f32_16x16x32_bf16 a[236:239], a[88:91], v[48:51], a[236:239]
    s_add_u32 m0, s69, 65536
    ds_read_b64_tr_b16 v[58:59], v14 offset:1024
    ds_read_b64_tr_b16 v[60:61], v14 offset:8192
    v_mfma_f32_16x16x32_bf16 a[236:239], a[92:95], v[52:55], a[236:239]
    buffer_load_dwordx4 v2, s[16:19], s60 offen nt lds
    v_mfma_f32_16x16x32_bf16 a[240:243], a[96:99], v[48:51], a[240:243]
    ds_read_b64_tr_b16 v[62:63], v14 offset:9216
    ds_read_b64_tr_b16 v[40:41], v15 offset:0
    v_mfma_f32_16x16x32_bf16 a[240:243], a[100:103], v[52:55], a[240:243]
    buffer_atomic_add v31, v30, s[44:47], s95 offen sc1
    v_mfma_f32_16x16x32_bf16 a[244:247], a[104:107], v[48:51], a[244:247]
    ds_read_b64_tr_b16 v[42:43], v15 offset:1024
    ds_read_b64_tr_b16 v[44:45], v15 offset:8192
    v_mfma_f32_16x16x32_bf16 a[244:247], a[108:111], v[52:55], a[244:247]
    ds_read_b64_tr_b16 v[46:47], v15 offset:9216
    v_add_u32 v14, 0xfffe0000, v14
    v_mfma_f32_16x16x32_bf16 a[248:251], a[112:115], v[48:51], a[248:251]
    v_add_u32 v15, 0xfffe0000, v15
    v_mfma_f32_16x16x32_bf16 a[248:251], a[116:119], v[52:55], a[248:251]
    buffer_load_dwordx4 v3, s[16:19], s60 offen offset:1024 nt lds
    v_mfma_f32_16x16x32_bf16 a[252:255], a[120:123], v[48:51], a[252:255]
    ds_read_b64_tr_b16 v[48:49], v16 offset:0
    ds_read_b64_tr_b16 v[50:51], v16 offset:1024
    v_mfma_f32_16x16x32_bf16 a[252:255], a[124:127], v[52:55], a[252:255]
    s_waitcnt lgkmcnt(3)
    ds_read_b64_tr_b16 v[52:53], v16 offset:8192
    ds_read_b64_tr_b16 v[54:55], v16 offset:9216
    v_mfma_f32_16x16x32_bf16 v[128:131], v[56:59], a[0:3], v[128:131]
    v_add_u32 v16, 0xfffe0000, v16
    v_mfma_f32_16x16x32_bf16 v[128:131], v[60:63], a[4:7], v[128:131]
    v_add_u32 v22, 0x10000, v22
    v_mfma_f32_16x16x32_bf16 v[132:135], v[56:59], a[8:11], v[132:135]
    ds_read_b128 a[64:67], v22 offset:16384
    v_mfma_f32_16x16x32_bf16 v[132:135], v[60:63], a[12:15], v[132:135]
    v_mfma_f32_16x16x32_bf16 v[136:139], v[56:59], a[16:19], v[136:139]
    v_mfma_f32_16x16x32_bf16 v[136:139], v[60:63], a[20:23], v[136:139]
    buffer_load_dwordx4 v4, s[16:19], s60 offen offset:2048 nt lds
    v_mfma_f32_16x16x32_bf16 v[140:143], v[56:59], a[24:27], v[140:143]
    v_add_u32 v23, 0x10000, v23
    v_mfma_f32_16x16x32_bf16 v[140:143], v[60:63], a[28:31], v[140:143]
    ds_read_b128 a[68:71], v23 offset:16384
    v_mfma_f32_16x16x32_bf16 v[144:147], v[56:59], a[32:35], v[144:147]
    v_mfma_f32_16x16x32_bf16 v[144:147], v[60:63], a[36:39], v[144:147]
    v_mfma_f32_16x16x32_bf16 v[148:151], v[56:59], a[40:43], v[148:151]
    v_mfma_f32_16x16x32_bf16 v[148:151], v[60:63], a[44:47], v[148:151]
    v_mfma_f32_16x16x32_bf16 v[152:155], v[56:59], a[48:51], v[152:155]
    buffer_load_dwordx4 v5, s[16:19], s60 offen offset:3072 nt lds
    v_mfma_f32_16x16x32_bf16 v[152:155], v[60:63], a[52:55], v[152:155]
    ds_read_b128 a[72:75], v22 offset:18432
    v_mfma_f32_16x16x32_bf16 v[156:159], v[56:59], a[56:59], v[156:159]
    ds_read_b64_tr_b16 v[56:57], v17 offset:0
    ds_read_b64_tr_b16 v[58:59], v17 offset:1024
    v_mfma_f32_16x16x32_bf16 v[156:159], v[60:63], a[60:63], v[156:159]
    ds_read_b64_tr_b16 v[60:61], v17 offset:8192
    ds_read_b64_tr_b16 v[62:63], v17 offset:9216
    v_mfma_f32_16x16x32_bf16 v[160:163], v[40:43], a[0:3], v[160:163]
    s_waitcnt lgkmcnt(5)
    v_add_u32 v17, 0xfffe0000, v17
    v_mfma_f32_16x16x32_bf16 v[160:163], v[44:47], a[4:7], v[160:163]
    v_mfma_f32_16x16x32_bf16 v[164:167], v[40:43], a[8:11], v[164:167]
    ds_read_b128 a[76:79], v23 offset:18432
    v_mfma_f32_16x16x32_bf16 v[164:167], v[44:47], a[12:15], v[164:167]
    s_add_u32 m0, s69, 81920
    v_mfma_f32_16x16x32_bf16 v[168:171], v[40:43], a[16:19], v[168:171]
    s_xor_b32 s60, s60, 1572864
    buffer_load_dwordx4 v6, s[8:11], s62 offen lds
    v_mfma_f32_16x16x32_bf16 v[168:171], v[44:47], a[20:23], v[168:171]
    v_mfma_f32_16x16x32_bf16 v[172:175], v[40:43], a[24:27], v[172:175]
    v_mfma_f32_16x16x32_bf16 v[172:175], v[44:47], a[28:31], v[172:175]
    v_mfma_f32_16x16x32_bf16 v[176:179], v[40:43], a[32:35], v[176:179]
    ds_read_b128 a[80:83], v22 offset:20480
    v_mfma_f32_16x16x32_bf16 v[176:179], v[44:47], a[36:39], v[176:179]
    v_mfma_f32_16x16x32_bf16 v[180:183], v[40:43], a[40:43], v[180:183]
    v_mfma_f32_16x16x32_bf16 v[180:183], v[44:47], a[44:47], v[180:183]
    buffer_load_dwordx4 v7, s[8:11], s62 offen offset:1024 lds
    v_mfma_f32_16x16x32_bf16 v[184:187], v[40:43], a[48:51], v[184:187]
    v_mfma_f32_16x16x32_bf16 v[184:187], v[44:47], a[52:55], v[184:187]
    ds_read_b128 a[84:87], v23 offset:20480
    v_mfma_f32_16x16x32_bf16 v[188:191], v[40:43], a[56:59], v[188:191]
    ds_read_b64_tr_b16 v[40:41], v14 offset:0
    ds_read_b64_tr_b16 v[42:43], v14 offset:1024
    v_mfma_f32_16x16x32_bf16 v[188:191], v[44:47], a[60:63], v[188:191]
    ds_read_b64_tr_b16 v[44:45], v14 offset:8192
    ds_read_b64_tr_b16 v[46:47], v14 offset:9216
    v_mfma_f32_16x16x32_bf16 v[192:195], v[48:51], a[0:3], v[192:195]
    v_mfma_f32_16x16x32_bf16 v[192:195], v[52:55], a[4:7], v[192:195]
    v_mfma_f32_16x16x32_bf16 v[196:199], v[48:51], a[8:11], v[196:199]
    v_mfma_f32_16x16x32_bf16 v[196:199], v[52:55], a[12:15], v[196:199]
    buffer_load_dwordx4 v8, s[8:11], s62 offen offset:2048 lds
    v_mfma_f32_16x16x32_bf16 v[200:203], v[48:51], a[16:19], v[200:203]
    ds_read_b128 a[88:91], v22 offset:22528
    v_mfma_f32_16x16x32_bf16 v[200:203], v[52:55], a[20:23], v[200:203]
    v_mfma_f32_16x16x32_bf16 v[204:207], v[48:51], a[24:27], v[204:207]
    v_mfma_f32_16x16x32_bf16 v[204:207], v[52:55], a[28:31], v[204:207]
    v_mfma_f32_16x16x32_bf16 v[208:211], v[48:51], a[32:35], v[208:211]
    ds_read_b128 a[92:95], v23 offset:22528
    v_mfma_f32_16x16x32_bf16 v[208:211], v[52:55], a[36:39], v[208:211]
    v_mfma_f32_16x16x32_bf16 v[212:215], v[48:51], a[40:43], v[212:215]
    buffer_load_dwordx4 v9, s[8:11], s62 offen offset:3072 lds
    v_mfma_f32_16x16x32_bf16 v[212:215], v[52:55], a[44:47], v[212:215]
    v_mfma_f32_16x16x32_bf16 v[216:219], v[48:51], a[48:51], v[216:219]
    v_mfma_f32_16x16x32_bf16 v[216:219], v[52:55], a[52:55], v[216:219]
    v_mfma_f32_16x16x32_bf16 v[220:223], v[48:51], a[56:59], v[220:223]
    s_xor_b32 s82, s84, 3670784
    ds_read_b64_tr_b16 v[48:49], v15 offset:0
    s_waitcnt lgkmcnt(1)
    ds_read_b64_tr_b16 v[50:51], v15 offset:1024
    v_mfma_f32_16x16x32_bf16 v[220:223], v[52:55], a[60:63], v[220:223]
    s_mov_b64 s[84:85], 0
    ds_read_b64_tr_b16 v[52:53], v15 offset:8192
    ds_read_b64_tr_b16 v[54:55], v15 offset:9216
    v_mfma_f32_16x16x32_bf16 v[224:227], v[56:59], a[0:3], v[224:227]
    v_mfma_f32_16x16x32_bf16 v[224:227], v[60:63], a[4:7], v[224:227]
    s_xor_b32 s62, s62, 128
    v_mfma_f32_16x16x32_bf16 v[228:231], v[56:59], a[8:11], v[228:231]
    buffer_load_dword v127, v120, s[40:43], s82 offen nt
    v_mfma_f32_16x16x32_bf16 v[228:231], v[60:63], a[12:15], v[228:231]
    buffer_load_dword v108, v103, s[24:27], s77 offen
    v_mfma_f32_16x16x32_bf16 v[232:235], v[56:59], a[16:19], v[232:235]
    s_add_u32 s77, s77, 4608
    v_mfma_f32_16x16x32_bf16 v[232:235], v[60:63], a[20:23], v[232:235]
    s_add_u32 m0, s69, 98304
    v_mfma_f32_16x16x32_bf16 v[236:239], v[56:59], a[24:27], v[236:239]
    buffer_load_dwordx4 v2, s[12:15], s60 offen nt lds
    v_mfma_f32_16x16x32_bf16 v[236:239], v[60:63], a[28:31], v[236:239]
    v_mfma_f32_16x16x32_bf16 v[240:243], v[56:59], a[32:35], v[240:243]
    v_mfma_f32_16x16x32_bf16 v[240:243], v[60:63], a[36:39], v[240:243]
    v_mfma_f32_16x16x32_bf16 v[244:247], v[56:59], a[40:43], v[244:247]
    v_mfma_f32_16x16x32_bf16 v[244:247], v[60:63], a[44:47], v[244:247]
    v_mfma_f32_16x16x32_bf16 v[248:251], v[56:59], a[48:51], v[248:251]
    v_mfma_f32_16x16x32_bf16 v[248:251], v[60:63], a[52:55], v[248:251]
    buffer_load_dwordx4 v3, s[12:15], s60 offen offset:1024 nt lds
    v_mfma_f32_16x16x32_bf16 v[252:255], v[56:59], a[56:59], v[252:255]
    ds_read_b64_tr_b16 v[56:57], v16 offset:0
    ds_read_b64_tr_b16 v[58:59], v16 offset:1024
    v_mfma_f32_16x16x32_bf16 v[252:255], v[60:63], a[60:63], v[252:255]
    ds_read_b64_tr_b16 v[60:61], v16 offset:8192
    ds_read_b64_tr_b16 v[62:63], v16 offset:9216
    v_mfma_f32_16x16x32_bf16 a[128:131], a[0:3], v[40:43], a[128:131]
    v_mfma_f32_16x16x32_bf16 a[128:131], a[4:7], v[44:47], a[128:131]
    v_add_u32 v22, 0xfffe0000, v22
    v_mfma_f32_16x16x32_bf16 a[132:135], a[8:11], v[40:43], a[132:135]
    ds_read_b128 a[96:99], v22 offset:16384
    v_mfma_f32_16x16x32_bf16 a[132:135], a[12:15], v[44:47], a[132:135]
    v_mfma_f32_16x16x32_bf16 a[136:139], a[16:19], v[40:43], a[136:139]
    v_mfma_f32_16x16x32_bf16 a[136:139], a[20:23], v[44:47], a[136:139]
    buffer_load_dwordx4 v4, s[12:15], s60 offen offset:2048 nt lds
    v_mfma_f32_16x16x32_bf16 a[140:143], a[24:27], v[40:43], a[140:143]
    v_add_u32 v23, 0xfffe0000, v23
    v_mfma_f32_16x16x32_bf16 a[140:143], a[28:31], v[44:47], a[140:143]
    ds_read_b128 a[100:103], v23 offset:16384
    v_mfma_f32_16x16x32_bf16 a[144:147], a[32:35], v[40:43], a[144:147]
    v_mfma_f32_16x16x32_bf16 a[144:147], a[36:39], v[44:47], a[144:147]
    v_mfma_f32_16x16x32_bf16 a[148:151], a[40:43], v[40:43], a[148:151]
    v_mfma_f32_16x16x32_bf16 a[148:151], a[44:47], v[44:47], a[148:151]
    v_mfma_f32_16x16x32_bf16 a[152:155], a[48:51], v[40:43], a[152:155]
    buffer_load_dwordx4 v5, s[12:15], s60 offen offset:3072 nt lds
    v_mfma_f32_16x16x32_bf16 a[152:155], a[52:55], v[44:47], a[152:155]
    ds_read_b128 a[104:107], v22 offset:18432
    v_mfma_f32_16x16x32_bf16 a[156:159], a[56:59], v[40:43], a[156:159]
    ds_read_b64_tr_b16 v[40:41], v17 offset:0
    ds_read_b64_tr_b16 v[42:43], v17 offset:1024
    v_mfma_f32_16x16x32_bf16 a[156:159], a[60:63], v[44:47], a[156:159]
    s_waitcnt lgkmcnt(3)
    ds_read_b64_tr_b16 v[44:45], v17 offset:8192
    ds_read_b64_tr_b16 v[46:47], v17 offset:9216
    v_mfma_f32_16x16x32_bf16 a[160:163], a[0:3], v[48:51], a[160:163]
    v_mfma_f32_16x16x32_bf16 a[160:163], a[4:7], v[52:55], a[160:163]
    v_mfma_f32_16x16x32_bf16 a[164:167], a[8:11], v[48:51], a[164:167]
    ds_read_b128 a[108:111], v23 offset:18432
    v_mfma_f32_16x16x32_bf16 a[164:167], a[12:15], v[52:55], a[164:167]
    s_add_u32 m0, s69, 114688
    v_mfma_f32_16x16x32_bf16 a[168:171], a[16:19], v[48:51], a[168:171]
    s_xor_b32 s60, s60, 524288
    buffer_load_dwordx4 v6, s[8:11], s61 offen lds
    v_mfma_f32_16x16x32_bf16 a[168:171], a[20:23], v[52:55], a[168:171]
    v_mfma_f32_16x16x32_bf16 a[172:175], a[24:27], v[48:51], a[172:175]
    v_mfma_f32_16x16x32_bf16 a[172:175], a[28:31], v[52:55], a[172:175]
    v_mfma_f32_16x16x32_bf16 a[176:179], a[32:35], v[48:51], a[176:179]
    ds_read_b128 a[112:115], v22 offset:20480
    v_mfma_f32_16x16x32_bf16 a[176:179], a[36:39], v[52:55], a[176:179]
    v_mfma_f32_16x16x32_bf16 a[180:183], a[40:43], v[48:51], a[180:183]
    v_mfma_f32_16x16x32_bf16 a[180:183], a[44:47], v[52:55], a[180:183]
    buffer_load_dwordx4 v7, s[8:11], s61 offen offset:1024 lds
    v_mfma_f32_16x16x32_bf16 a[184:187], a[48:51], v[48:51], a[184:187]
    v_mfma_f32_16x16x32_bf16 a[184:187], a[52:55], v[52:55], a[184:187]
    ds_read_b128 a[116:119], v23 offset:20480
    v_mfma_f32_16x16x32_bf16 a[188:191], a[56:59], v[48:51], a[188:191]
    v_mfma_f32_16x16x32_bf16 a[188:191], a[60:63], v[52:55], a[188:191]
    v_mfma_f32_16x16x32_bf16 a[192:195], a[0:3], v[56:59], a[192:195]
    v_mfma_f32_16x16x32_bf16 a[192:195], a[4:7], v[60:63], a[192:195]
    v_mfma_f32_16x16x32_bf16 a[196:199], a[8:11], v[56:59], a[196:199]
    v_mfma_f32_16x16x32_bf16 a[196:199], a[12:15], v[60:63], a[196:199]
    buffer_load_dwordx4 v8, s[8:11], s61 offen offset:2048 lds
    v_mfma_f32_16x16x32_bf16 a[200:203], a[16:19], v[56:59], a[200:203]
    ds_read_b128 a[120:123], v22 offset:22528
    v_mfma_f32_16x16x32_bf16 a[200:203], a[20:23], v[60:63], a[200:203]
    v_mfma_f32_16x16x32_bf16 a[204:207], a[24:27], v[56:59], a[204:207]
    v_mfma_f32_16x16x32_bf16 a[204:207], a[28:31], v[60:63], a[204:207]
    v_mfma_f32_16x16x32_bf16 a[208:211], a[32:35], v[56:59], a[208:211]
    ds_read_b128 a[124:127], v23 offset:22528
    v_mfma_f32_16x16x32_bf16 a[208:211], a[36:39], v[60:63], a[208:211]
    v_mfma_f32_16x16x32_bf16 a[212:215], a[40:43], v[56:59], a[212:215]
    buffer_load_dwordx4 v9, s[8:11], s61 offen offset:3072 lds
    v_mfma_f32_16x16x32_bf16 a[212:215], a[44:47], v[60:63], a[212:215]
    v_mfma_f32_16x16x32_bf16 a[216:219], a[48:51], v[56:59], a[216:219]
    v_mfma_f32_16x16x32_bf16 a[216:219], a[52:55], v[60:63], a[216:219]
    v_mfma_f32_16x16x32_bf16 a[220:223], a[56:59], v[56:59], a[220:223]
    v_mfma_f32_16x16x32_bf16 a[220:223], a[60:63], v[60:63], a[220:223]
    s_waitcnt lgkmcnt(0)
    v_mfma_f32_16x16x32_bf16 a[224:227], a[0:3], v[40:43], a[224:227]
    v_mfma_f32_16x16x32_bf16 a[224:227], a[4:7], v[44:47], a[224:227]
    s_xor_b32 s61, s61, 1920
    v_mfma_f32_16x16x32_bf16 a[228:231], a[8:11], v[40:43], a[228:231]
    s_andn2_b32 s61, s61, 896
    v_mfma_f32_16x16x32_bf16 a[228:231], a[12:15], v[44:47], a[228:231]
    s_lshl_b32 s61, s5, 7
    v_mfma_f32_16x16x32_bf16 a[232:235], a[16:19], v[40:43], a[232:235]
    v_mfma_f32_16x16x32_bf16 a[232:235], a[20:23], v[44:47], a[232:235]
    s_waitcnt vmcnt(10) lgkmcnt(0)
    s_barrier
    ds_read_b64_tr_b16 v[48:49], v14 offset:32768
    v_mfma_f32_16x16x32_bf16 a[236:239], a[24:27], v[40:43], a[236:239]
    s_add_u32 m0, s69, 131072
    ds_read_b64_tr_b16 v[50:51], v14 offset:33792
    ds_read_b64_tr_b16 v[52:53], v14 offset:40960
    v_mfma_f32_16x16x32_bf16 a[236:239], a[28:31], v[44:47], a[236:239]
    buffer_load_dwordx4 v2, s[12:15], s60 offen nt lds
    v_mfma_f32_16x16x32_bf16 a[240:243], a[32:35], v[40:43], a[240:243]
    ds_read_b64_tr_b16 v[54:55], v14 offset:41984
    ds_read_b64_tr_b16 v[56:57], v15 offset:32768
    v_mfma_f32_16x16x32_bf16 a[240:243], a[36:39], v[44:47], a[240:243]
    ds_read_b64_tr_b16 v[58:59], v15 offset:33792
    ds_read_b64_tr_b16 v[60:61], v15 offset:40960
    v_mfma_f32_16x16x32_bf16 a[244:247], a[40:43], v[40:43], a[244:247]
    ds_read_b64_tr_b16 v[62:63], v15 offset:41984
    v_add_u32 v14, 0x10000, v14
    v_mfma_f32_16x16x32_bf16 a[244:247], a[44:47], v[44:47], a[244:247]
    v_add_u32 v15, 0x10000, v15
    v_mfma_f32_16x16x32_bf16 a[248:251], a[48:51], v[40:43], a[248:251]
    v_mfma_f32_16x16x32_bf16 a[248:251], a[52:55], v[44:47], a[248:251]
    buffer_load_dwordx4 v3, s[12:15], s60 offen offset:1024 nt lds
    v_mfma_f32_16x16x32_bf16 a[252:255], a[56:59], v[40:43], a[252:255]
    ds_read_b64_tr_b16 v[40:41], v16 offset:32768
    ds_read_b64_tr_b16 v[42:43], v16 offset:33792
    v_mfma_f32_16x16x32_bf16 a[252:255], a[60:63], v[44:47], a[252:255]
    s_waitcnt lgkmcnt(2)
    ds_read_b64_tr_b16 v[44:45], v16 offset:40960
    ds_read_b64_tr_b16 v[46:47], v16 offset:41984
    v_mfma_f32_16x16x32_bf16 v[128:131], v[48:51], a[64:67], v[128:131]
    v_add_u32 v16, 0x10000, v16
    v_mfma_f32_16x16x32_bf16 v[128:131], v[52:55], a[68:71], v[128:131]
    v_mfma_f32_16x16x32_bf16 v[132:135], v[48:51], a[72:75], v[132:135]
    ds_read_b128 a[0:3], v22 offset:49152
    v_mfma_f32_16x16x32_bf16 v[132:135], v[52:55], a[76:79], v[132:135]
    v_mfma_f32_16x16x32_bf16 v[136:139], v[48:51], a[80:83], v[136:139]
    v_mfma_f32_16x16x32_bf16 v[136:139], v[52:55], a[84:87], v[136:139]
    buffer_load_dwordx4 v4, s[12:15], s60 offen offset:2048 nt lds
    v_mfma_f32_16x16x32_bf16 v[140:143], v[48:51], a[88:91], v[140:143]
    v_mfma_f32_16x16x32_bf16 v[140:143], v[52:55], a[92:95], v[140:143]
    ds_read_b128 a[4:7], v23 offset:49152
    v_mfma_f32_16x16x32_bf16 v[144:147], v[48:51], a[96:99], v[144:147]
    v_mfma_f32_16x16x32_bf16 v[144:147], v[52:55], a[100:103], v[144:147]
    v_mfma_f32_16x16x32_bf16 v[148:151], v[48:51], a[104:107], v[148:151]
    v_mfma_f32_16x16x32_bf16 v[148:151], v[52:55], a[108:111], v[148:151]
    v_mfma_f32_16x16x32_bf16 v[152:155], v[48:51], a[112:115], v[152:155]
    buffer_load_dwordx4 v5, s[12:15], s60 offen offset:3072 nt lds
    v_mfma_f32_16x16x32_bf16 v[152:155], v[52:55], a[116:119], v[152:155]
    ds_read_b128 a[8:11], v22 offset:51200
    v_mfma_f32_16x16x32_bf16 v[156:159], v[48:51], a[120:123], v[156:159]
    ds_read_b64_tr_b16 v[48:49], v17 offset:32768
    ds_read_b64_tr_b16 v[50:51], v17 offset:33792
    v_mfma_f32_16x16x32_bf16 v[156:159], v[52:55], a[124:127], v[156:159]
    ds_read_b64_tr_b16 v[52:53], v17 offset:40960
    ds_read_b64_tr_b16 v[54:55], v17 offset:41984
    v_mfma_f32_16x16x32_bf16 v[160:163], v[56:59], a[64:67], v[160:163]
    v_add_u32 v17, 0x10000, v17
    v_mfma_f32_16x16x32_bf16 v[160:163], v[60:63], a[68:71], v[160:163]
    s_cmp_lt_u32 s4, 0
    s_cselect_b32 s12, 0xf149f2ca, 0
    v_mfma_f32_16x16x32_bf16 v[164:167], v[56:59], a[72:75], v[164:167]
    ds_read_b128 a[12:15], v23 offset:51200
    v_mfma_f32_16x16x32_bf16 v[164:167], v[60:63], a[76:79], v[164:167]
    s_add_u32 m0, s69, 147456
    v_mfma_f32_16x16x32_bf16 v[168:171], v[56:59], a[80:83], v[168:171]
    s_xor_b32 s60, s60, 524288
    buffer_load_dwordx4 v6, s[8:11], s62 offen lds
    v_mfma_f32_16x16x32_bf16 v[168:171], v[60:63], a[84:87], v[168:171]
    v_mov_b32 v6, v96
    v_mfma_f32_16x16x32_bf16 v[172:175], v[56:59], a[88:91], v[172:175]
    s_cmp_lt_u32 s4, 1
    s_cselect_b32 s13, 0xf149f2ca, 0
    v_mfma_f32_16x16x32_bf16 v[172:175], v[60:63], a[92:95], v[172:175]
    s_cmp_lt_u32 s4, 2
    s_cselect_b32 s14, 0xf149f2ca, 0
    v_mfma_f32_16x16x32_bf16 v[176:179], v[56:59], a[96:99], v[176:179]
    ds_read_b128 a[16:19], v22 offset:53248
    v_mfma_f32_16x16x32_bf16 v[176:179], v[60:63], a[100:103], v[176:179]
    s_cmp_lt_u32 s4, 3
    s_cselect_b32 s15, 0xf149f2ca, 0
    v_mfma_f32_16x16x32_bf16 v[180:183], v[56:59], a[104:107], v[180:183]
    v_mfma_f32_16x16x32_bf16 v[180:183], v[60:63], a[108:111], v[180:183]
    buffer_load_dwordx4 v7, s[8:11], s62 offen offset:1024 lds
    v_mfma_f32_16x16x32_bf16 v[184:187], v[56:59], a[112:115], v[184:187]
    v_mfma_f32_16x16x32_bf16 v[184:187], v[60:63], a[116:119], v[184:187]
    ds_read_b128 a[20:23], v23 offset:53248
    v_mfma_f32_16x16x32_bf16 v[188:191], v[56:59], a[120:123], v[188:191]
    s_waitcnt lgkmcnt(1)
    ds_read_b64_tr_b16 v[56:57], v14 offset:0
    ds_read_b64_tr_b16 v[58:59], v14 offset:1024
    v_mfma_f32_16x16x32_bf16 v[188:191], v[60:63], a[124:127], v[188:191]
    ds_read_b64_tr_b16 v[60:61], v14 offset:8192
    ds_read_b64_tr_b16 v[62:63], v14 offset:9216
    v_mfma_f32_16x16x32_bf16 v[192:195], v[40:43], a[64:67], v[192:195]
    v_mfma_f32_16x16x32_bf16 v[192:195], v[44:47], a[68:71], v[192:195]
    v_mfma_f32_16x16x32_bf16 v[196:199], v[40:43], a[72:75], v[196:199]
    v_mfma_f32_16x16x32_bf16 v[196:199], v[44:47], a[76:79], v[196:199]
    buffer_load_dwordx4 v8, s[8:11], s62 offen offset:2048 lds
    v_mfma_f32_16x16x32_bf16 v[200:203], v[40:43], a[80:83], v[200:203]
    ds_read_b128 a[24:27], v22 offset:55296
    v_bfe_u32 v8, v1, 4, 3
    v_mfma_f32_16x16x32_bf16 v[200:203], v[44:47], a[84:87], v[200:203]
    v_lshlrev_b32 v8, 12, v8
    v_mfma_f32_16x16x32_bf16 v[204:207], v[40:43], a[88:91], v[204:207]
    v_mfma_f32_16x16x32_bf16 v[204:207], v[44:47], a[92:95], v[204:207]
    v_mfma_f32_16x16x32_bf16 v[208:211], v[40:43], a[96:99], v[208:211]
    ds_read_b128 a[28:31], v23 offset:55296
    v_mfma_f32_16x16x32_bf16 v[208:211], v[44:47], a[100:103], v[208:211]
    v_mfma_f32_16x16x32_bf16 v[212:215], v[40:43], a[104:107], v[212:215]
    buffer_load_dwordx4 v9, s[8:11], s62 offen offset:3072 lds
    v_mfma_f32_16x16x32_bf16 v[212:215], v[44:47], a[108:111], v[212:215]
    s_and_b32 s8, s5, 7
    v_lshrrev_b32 v9, 2, v1
    v_mfma_f32_16x16x32_bf16 v[216:219], v[40:43], a[112:115], v[216:219]
    s_lshl3_add_u32 s8, s6, s8
    v_mfma_f32_16x16x32_bf16 v[216:219], v[44:47], a[116:119], v[216:219]
    s_mul_hi_u32 s98, s8, 715827883
    v_mfma_f32_16x16x32_bf16 v[220:223], v[40:43], a[120:123], v[220:223]
    ds_read_b64_tr_b16 v[40:41], v15 offset:0
    ds_read_b64_tr_b16 v[42:43], v15 offset:1024
    v_mfma_f32_16x16x32_bf16 v[220:223], v[44:47], a[124:127], v[220:223]
    ds_read_b64_tr_b16 v[44:45], v15 offset:8192
    ds_read_b64_tr_b16 v[46:47], v15 offset:9216
    v_mfma_f32_16x16x32_bf16 v[224:227], v[48:51], a[64:67], v[224:227]
    s_cmp_eq_u32 s4, 1
    s_cselect_b32 s9, 1.0, 0
    v_mfma_f32_16x16x32_bf16 v[224:227], v[52:55], a[68:71], v[224:227]
    s_xor_b32 s62, s62, 1920
    v_mfma_f32_16x16x32_bf16 v[228:231], v[48:51], a[72:75], v[228:231]
    s_andn2_b32 s62, s62, 896
    buffer_load_dword v109, v103, s[24:27], s77 offen
    v_mfma_f32_16x16x32_bf16 v[228:231], v[52:55], a[76:79], v[228:231]
    s_cmp_eq_u32 s4, 2
    s_cselect_b32 s10, 1.0, 0
    v_mfma_f32_16x16x32_bf16 v[232:235], v[48:51], a[80:83], v[232:235]
    s_cmp_eq_u32 s4, 3
    s_cselect_b32 s11, 1.0, 0
    v_mfma_f32_16x16x32_bf16 v[232:235], v[52:55], a[84:87], v[232:235]
    s_add_u32 m0, s69, 0
    v_mfma_f32_16x16x32_bf16 v[236:239], v[48:51], a[88:91], v[236:239]
    buffer_load_dwordx4 v2, s[16:19], s60 offen nt lds
    v_mfma_f32_16x16x32_bf16 v[236:239], v[52:55], a[92:95], v[236:239]
    v_mfma_f32_16x16x32_bf16 v[240:243], v[48:51], a[96:99], v[240:243]
    v_mfma_f32_16x16x32_bf16 v[240:243], v[52:55], a[100:103], v[240:243]
    v_mfma_f32_16x16x32_bf16 v[244:247], v[48:51], a[104:107], v[244:247]
    v_mfma_f32_16x16x32_bf16 v[244:247], v[52:55], a[108:111], v[244:247]
    v_mfma_f32_16x16x32_bf16 v[248:251], v[48:51], a[112:115], v[248:251]
    v_mfma_f32_16x16x32_bf16 v[248:251], v[52:55], a[116:119], v[248:251]
    buffer_load_dwordx4 v3, s[16:19], s60 offen offset:1024 nt lds
    v_mfma_f32_16x16x32_bf16 v[252:255], v[48:51], a[120:123], v[252:255]
    ds_read_b64_tr_b16 v[48:49], v16 offset:0
    ds_read_b64_tr_b16 v[50:51], v16 offset:1024
    v_mfma_f32_16x16x32_bf16 v[252:255], v[52:55], a[124:127], v[252:255]
    s_waitcnt lgkmcnt(2)
    ds_read_b64_tr_b16 v[52:53], v16 offset:8192
    ds_read_b64_tr_b16 v[54:55], v16 offset:9216
    v_mfma_f32_16x16x32_bf16 a[128:131], a[64:67], v[56:59], a[128:131]
    v_mfma_f32_16x16x32_bf16 a[128:131], a[68:71], v[60:63], a[128:131]
    v_add_u32 v22, 0x10000, v22
    v_mfma_f32_16x16x32_bf16 a[132:135], a[72:75], v[56:59], a[132:135]
    ds_read_b128 a[32:35], v22 offset:16384
    v_mfma_f32_16x16x32_bf16 a[132:135], a[76:79], v[60:63], a[132:135]
    v_mfma_f32_16x16x32_bf16 a[136:139], a[80:83], v[56:59], a[136:139]
    v_mfma_f32_16x16x32_bf16 a[136:139], a[84:87], v[60:63], a[136:139]
    buffer_load_dwordx4 v4, s[16:19], s60 offen offset:2048 nt lds
    v_mfma_f32_16x16x32_bf16 a[140:143], a[88:91], v[56:59], a[140:143]
    v_add_u32 v23, 0x10000, v23
    v_mfma_f32_16x16x32_bf16 a[140:143], a[92:95], v[60:63], a[140:143]
    ds_read_b128 a[36:39], v23 offset:16384
    v_mfma_f32_16x16x32_bf16 a[144:147], a[96:99], v[56:59], a[144:147]
    v_mfma_f32_16x16x32_bf16 a[144:147], a[100:103], v[60:63], a[144:147]
    v_mfma_f32_16x16x32_bf16 a[148:151], a[104:107], v[56:59], a[148:151]
    v_mfma_f32_16x16x32_bf16 a[148:151], a[108:111], v[60:63], a[148:151]
    v_mfma_f32_16x16x32_bf16 a[152:155], a[112:115], v[56:59], a[152:155]
    buffer_load_dwordx4 v5, s[16:19], s60 offen offset:3072 nt lds
    v_mfma_f32_16x16x32_bf16 a[152:155], a[116:119], v[60:63], a[152:155]
    ds_read_b128 a[40:43], v22 offset:18432
    v_mfma_f32_16x16x32_bf16 a[156:159], a[120:123], v[56:59], a[156:159]
    ds_read_b64_tr_b16 v[56:57], v17 offset:0
    ds_read_b64_tr_b16 v[58:59], v17 offset:1024
    v_mfma_f32_16x16x32_bf16 a[156:159], a[124:127], v[60:63], a[156:159]
    ds_read_b64_tr_b16 v[60:61], v17 offset:8192
    ds_read_b64_tr_b16 v[62:63], v17 offset:9216
    v_mfma_f32_16x16x32_bf16 a[160:163], a[64:67], v[40:43], a[160:163]
    v_mfma_f32_16x16x32_bf16 a[160:163], a[68:71], v[44:47], a[160:163]
    v_mfma_f32_16x16x32_bf16 a[164:167], a[72:75], v[40:43], a[164:167]
    ds_read_b128 a[44:47], v23 offset:18432
    v_mfma_f32_16x16x32_bf16 a[164:167], a[76:79], v[44:47], a[164:167]
    s_add_u32 m0, s69, 16384
    v_mfma_f32_16x16x32_bf16 a[168:171], a[80:83], v[40:43], a[168:171]
    s_xor_b32 s60, s60, 524288
    buffer_load_dwordx4 v10, s[20:23], s63 offen lds
    v_mfma_f32_16x16x32_bf16 a[168:171], a[84:87], v[44:47], a[168:171]
    v_mfma_f32_16x16x32_bf16 a[172:175], a[88:91], v[40:43], a[172:175]
    v_mfma_f32_16x16x32_bf16 a[172:175], a[92:95], v[44:47], a[172:175]
    v_mfma_f32_16x16x32_bf16 a[176:179], a[96:99], v[40:43], a[176:179]
    ds_read_b128 a[48:51], v22 offset:20480
    v_mfma_f32_16x16x32_bf16 a[176:179], a[100:103], v[44:47], a[176:179]
    v_mfma_f32_16x16x32_bf16 a[180:183], a[104:107], v[40:43], a[180:183]
    v_mfma_f32_16x16x32_bf16 a[180:183], a[108:111], v[44:47], a[180:183]
    buffer_load_dwordx4 v11, s[20:23], s63 offen offset:1024 lds
    v_mfma_f32_16x16x32_bf16 a[184:187], a[112:115], v[40:43], a[184:187]
    v_mfma_f32_16x16x32_bf16 a[184:187], a[116:119], v[44:47], a[184:187]
    ds_read_b128 a[52:55], v23 offset:20480
    v_mfma_f32_16x16x32_bf16 a[188:191], a[120:123], v[40:43], a[188:191]
    v_mfma_f32_16x16x32_bf16 a[188:191], a[124:127], v[44:47], a[188:191]
    s_waitcnt lgkmcnt(1)
    v_mfma_f32_16x16x32_bf16 a[192:195], a[64:67], v[48:51], a[192:195]
    v_mfma_f32_16x16x32_bf16 a[192:195], a[68:71], v[52:55], a[192:195]
    v_mfma_f32_16x16x32_bf16 a[196:199], a[72:75], v[48:51], a[196:199]
    v_mfma_f32_16x16x32_bf16 a[196:199], a[76:79], v[52:55], a[196:199]
    buffer_load_dwordx4 v12, s[20:23], s63 offen offset:2048 lds
    v_mfma_f32_16x16x32_bf16 a[200:203], a[80:83], v[48:51], a[200:203]
    ds_read_b128 a[56:59], v22 offset:22528
    v_mfma_f32_16x16x32_bf16 a[200:203], a[84:87], v[52:55], a[200:203]
    v_mfma_f32_16x16x32_bf16 a[204:207], a[88:91], v[48:51], a[204:207]
    v_mfma_f32_16x16x32_bf16 a[204:207], a[92:95], v[52:55], a[204:207]
    v_mfma_f32_16x16x32_bf16 a[208:211], a[96:99], v[48:51], a[208:211]
    ds_read_b128 a[60:63], v23 offset:22528
    v_mfma_f32_16x16x32_bf16 a[208:211], a[100:103], v[52:55], a[208:211]
    v_mfma_f32_16x16x32_bf16 a[212:215], a[104:107], v[48:51], a[212:215]
    buffer_load_dwordx4 v13, s[20:23], s63 offen offset:3072 lds
    v_mfma_f32_16x16x32_bf16 a[212:215], a[108:111], v[52:55], a[212:215]
    v_mfma_f32_16x16x32_bf16 a[216:219], a[112:115], v[48:51], a[216:219]
    v_mfma_f32_16x16x32_bf16 a[216:219], a[116:119], v[52:55], a[216:219]
    v_mfma_f32_16x16x32_bf16 a[220:223], a[120:123], v[48:51], a[220:223]
    v_mfma_f32_16x16x32_bf16 a[220:223], a[124:127], v[52:55], a[220:223]
    v_mfma_f32_16x16x32_bf16 a[224:227], a[64:67], v[56:59], a[224:227]
    v_mfma_f32_16x16x32_bf16 a[224:227], a[68:71], v[60:63], a[224:227]
    s_xor_b32 s63, s63, 128
    v_mfma_f32_16x16x32_bf16 a[228:231], a[72:75], v[56:59], a[228:231]
    v_mfma_f32_16x16x32_bf16 a[228:231], a[76:79], v[60:63], a[228:231]
    v_mfma_f32_16x16x32_bf16 a[232:235], a[80:83], v[56:59], a[232:235]
    v_mfma_f32_16x16x32_bf16 a[232:235], a[84:87], v[60:63], a[232:235]
    s_waitcnt vmcnt(9) lgkmcnt(0)
    s_barrier
    ds_read_b64_tr_b16 v[40:41], v14 offset:32768
    v_mfma_f32_16x16x32_bf16 a[236:239], a[88:91], v[56:59], a[236:239]
    s_add_u32 m0, s69, 32768
    ds_read_b64_tr_b16 v[42:43], v14 offset:33792
    ds_read_b64_tr_b16 v[44:45], v14 offset:40960
    v_mfma_f32_16x16x32_bf16 a[236:239], a[92:95], v[60:63], a[236:239]
    buffer_load_dwordx4 v2, s[16:19], s60 offen nt lds
    v_mfma_f32_16x16x32_bf16 a[240:243], a[96:99], v[56:59], a[240:243]
    ds_read_b64_tr_b16 v[46:47], v14 offset:41984
    ds_read_b64_tr_b16 v[48:49], v15 offset:32768
    v_mfma_f32_16x16x32_bf16 a[240:243], a[100:103], v[60:63], a[240:243]
    ds_read_b64_tr_b16 v[50:51], v15 offset:33792
    ds_read_b64_tr_b16 v[52:53], v15 offset:40960
    v_mfma_f32_16x16x32_bf16 a[244:247], a[104:107], v[56:59], a[244:247]
    ds_read_b64_tr_b16 v[54:55], v15 offset:41984
    v_add_u32 v14, 0x10000, v14
    v_mfma_f32_16x16x32_bf16 a[244:247], a[108:111], v[60:63], a[244:247]
    v_add_u32 v15, 0x10000, v15
    v_mfma_f32_16x16x32_bf16 a[248:251], a[112:115], v[56:59], a[248:251]
    v_mfma_f32_16x16x32_bf16 a[248:251], a[116:119], v[60:63], a[248:251]
    buffer_load_dwordx4 v3, s[16:19], s60 offen offset:1024 nt lds
    v_mfma_f32_16x16x32_bf16 a[252:255], a[120:123], v[56:59], a[252:255]
    ds_read_b64_tr_b16 v[56:57], v16 offset:32768
    ds_read_b64_tr_b16 v[58:59], v16 offset:33792
    v_mfma_f32_16x16x32_bf16 a[252:255], a[124:127], v[60:63], a[252:255]
    s_waitcnt lgkmcnt(2)
    ds_read_b64_tr_b16 v[60:61], v16 offset:40960
    ds_read_b64_tr_b16 v[62:63], v16 offset:41984
    v_mfma_f32_16x16x32_bf16 v[128:131], v[40:43], a[0:3], v[128:131]
    v_add_u32 v16, 0x10000, v16
    v_mfma_f32_16x16x32_bf16 v[128:131], v[44:47], a[4:7], v[128:131]
    ds_read_b128 a[64:67], v22 offset:49152
    v_mfma_f32_16x16x32_bf16 v[132:135], v[40:43], a[8:11], v[132:135]
    v_mfma_f32_16x16x32_bf16 v[132:135], v[44:47], a[12:15], v[132:135]
    v_mfma_f32_16x16x32_bf16 v[136:139], v[40:43], a[16:19], v[136:139]
    ds_read_b128 a[68:71], v23 offset:49152
    v_mfma_f32_16x16x32_bf16 v[136:139], v[44:47], a[20:23], v[136:139]
    buffer_load_dwordx4 v4, s[16:19], s60 offen offset:2048 nt lds
    v_mfma_f32_16x16x32_bf16 v[140:143], v[40:43], a[24:27], v[140:143]
    v_mfma_f32_16x16x32_bf16 v[140:143], v[44:47], a[28:31], v[140:143]
    ds_read_b128 a[72:75], v22 offset:51200
    v_mfma_f32_16x16x32_bf16 v[144:147], v[40:43], a[32:35], v[144:147]
    v_mfma_f32_16x16x32_bf16 v[144:147], v[44:47], a[36:39], v[144:147]
    v_mfma_f32_16x16x32_bf16 v[148:151], v[40:43], a[40:43], v[148:151]
    ds_read_b128 a[76:79], v23 offset:51200
    v_mfma_f32_16x16x32_bf16 v[148:151], v[44:47], a[44:47], v[148:151]
    v_mfma_f32_16x16x32_bf16 v[152:155], v[40:43], a[48:51], v[152:155]
    buffer_load_dwordx4 v5, s[16:19], s60 offen offset:3072 nt lds
    v_mfma_f32_16x16x32_bf16 v[152:155], v[44:47], a[52:55], v[152:155]
    s_cmp_eq_u32 s6, 0
    s_cselect_b32 s18, s10, 0
    s_cselect_b32 s19, s11, 0
    v_mfma_f32_16x16x32_bf16 v[156:159], v[40:43], a[56:59], v[156:159]
    ds_read_b128 a[80:83], v22 offset:53248
    ds_read_b64_tr_b16 v[40:41], v17 offset:32768
    v_mfma_f32_16x16x32_bf16 v[156:159], v[44:47], a[60:63], v[156:159]
    ds_read_b64_tr_b16 v[42:43], v17 offset:33792
    ds_read_b64_tr_b16 v[44:45], v17 offset:40960
    v_mfma_f32_16x16x32_bf16 v[160:163], v[48:51], a[0:3], v[160:163]
    ds_read_b64_tr_b16 v[46:47], v17 offset:41984
    v_add_u32 v17, 0x10000, v17
    v_mfma_f32_16x16x32_bf16 v[160:163], v[52:55], a[4:7], v[160:163]
    ds_read_b128 a[84:87], v23 offset:53248
    v_mfma_f32_16x16x32_bf16 v[164:167], v[48:51], a[8:11], v[164:167]
    v_mfma_f32_16x16x32_bf16 v[164:167], v[52:55], a[12:15], v[164:167]
    s_add_u32 m0, s69, 49152
    buffer_load_dword v7, v9, s[44:47], s69 offen sc1
    v_mfma_f32_16x16x32_bf16 v[168:171], v[48:51], a[16:19], v[168:171]
    s_xor_b32 s60, s60, 3670016
    buffer_load_dwordx4 v10, s[20:23], s64 offen lds
    v_mfma_f32_16x16x32_bf16 v[168:171], v[52:55], a[20:23], v[168:171]
    ds_read_b128 a[88:91], v22 offset:55296
    v_mfma_f32_16x16x32_bf16 v[172:175], v[48:51], a[24:27], v[172:175]
    v_mfma_f32_16x16x32_bf16 v[172:175], v[52:55], a[28:31], v[172:175]
    s_waitcnt lgkmcnt(1)
    ds_read_b128 a[92:95], v23 offset:55296
    v_mfma_f32_16x16x32_bf16 v[176:179], v[48:51], a[32:35], v[176:179]
    v_mfma_f32_16x16x32_bf16 v[176:179], v[52:55], a[36:39], v[176:179]
    v_mfma_f32_16x16x32_bf16 v[180:183], v[48:51], a[40:43], v[180:183]
    v_mfma_f32_16x16x32_bf16 v[180:183], v[52:55], a[44:47], v[180:183]
    buffer_load_dwordx4 v11, s[20:23], s64 offen offset:1024 lds
    v_mfma_f32_16x16x32_bf16 v[184:187], v[48:51], a[48:51], v[184:187]
    v_add_u32 v22, 0x10000, v22
    ds_read_b128 a[96:99], v22 offset:16384
    v_mfma_f32_16x16x32_bf16 v[184:187], v[52:55], a[52:55], v[184:187]
    v_mfma_f32_16x16x32_bf16 v[188:191], v[48:51], a[56:59], v[188:191]
    v_add_u32 v23, 0x10000, v23
    ds_read_b64_tr_b16 v[48:49], v14 offset:0
    v_mfma_f32_16x16x32_bf16 v[188:191], v[52:55], a[60:63], v[188:191]
    ds_read_b128 a[100:103], v23 offset:16384
    ds_read_b64_tr_b16 v[50:51], v14 offset:1024
    v_mfma_f32_16x16x32_bf16 v[192:195], v[56:59], a[0:3], v[192:195]
    ds_read_b64_tr_b16 v[52:53], v14 offset:8192
    ds_read_b64_tr_b16 v[54:55], v14 offset:9216
    v_mfma_f32_16x16x32_bf16 v[192:195], v[60:63], a[4:7], v[192:195]
    v_add_u32 v14, 0xfffe0000, v14
    v_mfma_f32_16x16x32_bf16 v[196:199], v[56:59], a[8:11], v[196:199]
    ds_read_b128 a[104:107], v22 offset:18432
    v_mfma_f32_16x16x32_bf16 v[196:199], v[60:63], a[12:15], v[196:199]
    buffer_load_dwordx4 v12, s[20:23], s64 offen offset:2048 lds
    v_mfma_f32_16x16x32_bf16 v[200:203], v[56:59], a[16:19], v[200:203]
    v_mfma_f32_16x16x32_bf16 v[200:203], v[60:63], a[20:23], v[200:203]
    ds_read_b128 a[108:111], v23 offset:18432
    v_mfma_f32_16x16x32_bf16 v[204:207], v[56:59], a[24:27], v[204:207]
    v_mfma_f32_16x16x32_bf16 v[204:207], v[60:63], a[28:31], v[204:207]
    v_mfma_f32_16x16x32_bf16 v[208:211], v[56:59], a[32:35], v[208:211]
    v_mfma_f32_16x16x32_bf16 v[208:211], v[60:63], a[36:39], v[208:211]
    ds_read_b128 a[112:115], v22 offset:20480
    v_mfma_f32_16x16x32_bf16 v[212:215], v[56:59], a[40:43], v[212:215]
    buffer_load_dwordx4 v13, s[20:23], s64 offen offset:3072 lds
    v_mfma_f32_16x16x32_bf16 v[212:215], v[60:63], a[44:47], v[212:215]
    v_mfma_f32_16x16x32_bf16 v[216:219], v[56:59], a[48:51], v[216:219]
    ds_read_b128 a[116:119], v23 offset:20480
    v_mfma_f32_16x16x32_bf16 v[216:219], v[60:63], a[52:55], v[216:219]
    v_mfma_f32_16x16x32_bf16 v[220:223], v[56:59], a[56:59], v[220:223]
    ds_read_b64_tr_b16 v[56:57], v15 offset:0
    ds_read_b64_tr_b16 v[58:59], v15 offset:1024
    v_mfma_f32_16x16x32_bf16 v[220:223], v[60:63], a[60:63], v[220:223]
    s_waitcnt lgkmcnt(3)
    ds_read_b128 a[120:123], v22 offset:22528
    ds_read_b64_tr_b16 v[60:61], v15 offset:8192
    v_mfma_f32_16x16x32_bf16 v[224:227], v[40:43], a[0:3], v[224:227]
    ds_read_b64_tr_b16 v[62:63], v15 offset:9216
    v_add_u32 v15, 0xfffe0000, v15
    v_mfma_f32_16x16x32_bf16 v[224:227], v[44:47], a[4:7], v[224:227]
    s_xor_b32 s64, s64, 128
    v_mov_b32 v22, v100
    v_add_u32 v22, 0x10000, v22
    v_mfma_f32_16x16x32_bf16 v[228:231], v[40:43], a[8:11], v[228:231]
    ds_read_b128 a[124:127], v23 offset:22528
    v_mov_b32 v23, v101
    v_mfma_f32_16x16x32_bf16 v[228:231], v[44:47], a[12:15], v[228:231]
    v_add_u32 v23, 0x10000, v23
    v_mfma_f32_16x16x32_bf16 v[232:235], v[40:43], a[16:19], v[232:235]
    v_mfma_f32_16x16x32_bf16 v[232:235], v[44:47], a[20:23], v[232:235]
    s_add_u32 m0, s69, 65536
    v_mfma_f32_16x16x32_bf16 v[236:239], v[40:43], a[24:27], v[236:239]
    buffer_load_dwordx4 v2, s[24:27], s60 offen lds
    v_mfma_f32_16x16x32_bf16 v[236:239], v[44:47], a[28:31], v[236:239]
    v_mfma_f32_16x16x32_bf16 v[240:243], v[40:43], a[32:35], v[240:243]
    v_mfma_f32_16x16x32_bf16 v[240:243], v[44:47], a[36:39], v[240:243]
    v_mfma_f32_16x16x32_bf16 v[244:247], v[40:43], a[40:43], v[244:247]
    v_mfma_f32_16x16x32_bf16 v[244:247], v[44:47], a[44:47], v[244:247]
    v_mfma_f32_16x16x32_bf16 v[248:251], v[40:43], a[48:51], v[248:251]
    v_mfma_f32_16x16x32_bf16 v[248:251], v[44:47], a[52:55], v[248:251]
    buffer_load_dwordx4 v3, s[24:27], s60 offen offset:1024 lds
    v_mfma_f32_16x16x32_bf16 v[252:255], v[40:43], a[56:59], v[252:255]
    ds_read_b64_tr_b16 v[40:41], v16 offset:0
    ds_read_b64_tr_b16 v[42:43], v16 offset:1024
    v_mfma_f32_16x16x32_bf16 v[252:255], v[44:47], a[60:63], v[252:255]
    ds_read_b64_tr_b16 v[44:45], v16 offset:8192
    ds_read_b64_tr_b16 v[46:47], v16 offset:9216
    v_mfma_f32_16x16x32_bf16 v[128:131], v[48:51], a[64:67], v[128:131]
    v_add_u32 v16, 0xfffe0000, v16
    v_mfma_f32_16x16x32_bf16 v[128:131], v[52:55], a[68:71], v[128:131]
    v_mfma_f32_16x16x32_bf16 v[132:135], v[48:51], a[72:75], v[132:135]
    v_mfma_f32_16x16x32_bf16 v[132:135], v[52:55], a[76:79], v[132:135]
    v_mfma_f32_16x16x32_bf16 v[136:139], v[48:51], a[80:83], v[136:139]
    v_mfma_f32_16x16x32_bf16 v[136:139], v[52:55], a[84:87], v[136:139]
    buffer_load_dwordx4 v4, s[24:27], s60 offen offset:2048 lds
    v_mfma_f32_16x16x32_bf16 v[140:143], v[48:51], a[88:91], v[140:143]
    v_mfma_f32_16x16x32_bf16 v[140:143], v[52:55], a[92:95], v[140:143]
    v_mfma_f32_16x16x32_bf16 v[144:147], v[48:51], a[96:99], v[144:147]
    v_mul_f32 v128, s74, v128
    v_mul_f32 v129, s74, v129
    v_mfma_f32_16x16x32_bf16 v[144:147], v[52:55], a[100:103], v[144:147]
    v_mul_f32 v130, s74, v130
    v_mul_f32 v131, s74, v131
    v_mfma_f32_16x16x32_bf16 v[148:151], v[48:51], a[104:107], v[148:151]
    v_cvt_pk_bf16_f32 v128, v128, v129
    v_cvt_pk_bf16_f32 v129, v130, v131
    v_mfma_f32_16x16x32_bf16 v[148:151], v[52:55], a[108:111], v[148:151]
    v_mul_f32 v132, s74, v132
    v_mul_f32 v133, s74, v133
    v_mfma_f32_16x16x32_bf16 v[152:155], v[48:51], a[112:115], v[152:155]
    s_waitcnt lgkmcnt(0)
    buffer_load_dwordx4 v5, s[24:27], s60 offen offset:3072 lds
    v_mfma_f32_16x16x32_bf16 v[152:155], v[52:55], a[116:119], v[152:155]
    v_mul_f32 v134, s74, v134
    v_mul_f32 v135, s74, v135
    v_mfma_f32_16x16x32_bf16 v[156:159], v[48:51], a[120:123], v[156:159]
    ds_read_b64_tr_b16 v[48:49], v17 offset:0
    ds_read_b64_tr_b16 v[50:51], v17 offset:1024
    v_mfma_f32_16x16x32_bf16 v[156:159], v[52:55], a[124:127], v[156:159]
    ds_read_b64_tr_b16 v[52:53], v17 offset:8192
    ds_read_b64_tr_b16 v[54:55], v17 offset:9216
    v_mfma_f32_16x16x32_bf16 v[160:163], v[56:59], a[64:67], v[160:163]
    v_add_u32 v17, 0xfffe0000, v17
    v_cvt_pk_bf16_f32 v132, v132, v133
    v_mfma_f32_16x16x32_bf16 v[160:163], v[60:63], a[68:71], v[160:163]
    v_cvt_pk_bf16_f32 v133, v134, v135
    v_mul_f32 v136, s74, v136
    v_mfma_f32_16x16x32_bf16 v[164:167], v[56:59], a[72:75], v[164:167]
    v_mul_f32 v137, s74, v137
    v_mul_f32 v138, s74, v138
    v_mfma_f32_16x16x32_bf16 v[164:167], v[60:63], a[76:79], v[164:167]
    s_add_u32 m0, s69, 81920
    v_mul_f32 v139, s74, v139
    v_mul_f32 v160, s74, v160
    v_mfma_f32_16x16x32_bf16 v[168:171], v[56:59], a[80:83], v[168:171]
    s_xor_b32 s60, s60, 524288
    buffer_load_dwordx4 v10, s[20:23], s63 offen lds
    v_mfma_f32_16x16x32_bf16 v[168:171], v[60:63], a[84:87], v[168:171]
    v_mul_f32 v161, s74, v161
    v_mul_f32 v162, s74, v162
    v_mfma_f32_16x16x32_bf16 v[172:175], v[56:59], a[88:91], v[172:175]
    v_mul_f32 v163, s74, v163
    v_cvt_pk_bf16_f32 v130, v160, v161
    v_mfma_f32_16x16x32_bf16 v[172:175], v[60:63], a[92:95], v[172:175]
    v_cvt_pk_bf16_f32 v131, v162, v163
    v_mul_f32 v164, s74, v164
    v_mfma_f32_16x16x32_bf16 v[176:179], v[56:59], a[96:99], v[176:179]
    v_mul_f32 v165, s74, v165
    v_mul_f32 v166, s74, v166
    v_mfma_f32_16x16x32_bf16 v[176:179], v[60:63], a[100:103], v[176:179]
    v_mul_f32 v167, s74, v167
    v_cvt_pk_bf16_f32 v134, v164, v165
    v_mfma_f32_16x16x32_bf16 v[180:183], v[56:59], a[104:107], v[180:183]
    v_cvt_pk_bf16_f32 v135, v166, v167
    v_mul_f32 v168, s74, v168
    v_mfma_f32_16x16x32_bf16 v[180:183], v[60:63], a[108:111], v[180:183]
    buffer_load_dwordx4 v11, s[20:23], s63 offen offset:1024 lds
    v_mfma_f32_16x16x32_bf16 v[184:187], v[56:59], a[112:115], v[184:187]
    v_mul_f32 v169, s74, v169
    v_mul_f32 v170, s74, v170
    v_mfma_f32_16x16x32_bf16 v[184:187], v[60:63], a[116:119], v[184:187]
    v_mul_f32 v171, s74, v171
    v_cvt_pk_bf16_f32 v136, v136, v137
    v_mfma_f32_16x16x32_bf16 v[188:191], v[56:59], a[120:123], v[188:191]
    v_cvt_pk_bf16_f32 v137, v138, v139
    v_cvt_pk_bf16_f32 v138, v168, v169
    v_mfma_f32_16x16x32_bf16 v[188:191], v[60:63], a[124:127], v[188:191]
    v_cvt_pk_bf16_f32 v139, v170, v171
    v_mul_f32 v140, s74, v140
    v_mfma_f32_16x16x32_bf16 v[192:195], v[40:43], a[64:67], v[192:195]
    v_mul_f32 v141, s74, v141
    v_mul_f32 v142, s74, v142
    v_mfma_f32_16x16x32_bf16 v[192:195], v[44:47], a[68:71], v[192:195]
    v_mul_f32 v143, s74, v143
    v_mul_f32 v172, s74, v172
    v_mfma_f32_16x16x32_bf16 v[196:199], v[40:43], a[72:75], v[196:199]
    v_mul_f32 v173, s74, v173
    v_mul_f32 v174, s74, v174
    v_mfma_f32_16x16x32_bf16 v[196:199], v[44:47], a[76:79], v[196:199]
    buffer_load_dwordx4 v12, s[20:23], s63 offen offset:2048 lds
    v_mfma_f32_16x16x32_bf16 v[200:203], v[40:43], a[80:83], v[200:203]
    v_mul_f32 v175, s74, v175
    v_cvt_pk_bf16_f32 v140, v140, v141
    v_mfma_f32_16x16x32_bf16 v[200:203], v[44:47], a[84:87], v[200:203]
    v_cvt_pk_bf16_f32 v141, v142, v143
    v_cvt_pk_bf16_f32 v142, v172, v173
    v_mfma_f32_16x16x32_bf16 v[204:207], v[40:43], a[88:91], v[204:207]
    v_cvt_pk_bf16_f32 v143, v174, v175
    v_mul_f32 v144, s74, v144
    v_mfma_f32_16x16x32_bf16 v[204:207], v[44:47], a[92:95], v[204:207]
    v_mul_f32 v145, s74, v145
    v_mul_f32 v146, s74, v146
    v_mfma_f32_16x16x32_bf16 v[208:211], v[40:43], a[96:99], v[208:211]
    v_mul_f32 v147, s74, v147
    v_mul_f32 v176, s74, v176
    v_mfma_f32_16x16x32_bf16 v[208:211], v[44:47], a[100:103], v[208:211]
    v_mul_f32 v177, s74, v177
    v_mul_f32 v178, s74, v178
    v_mfma_f32_16x16x32_bf16 v[212:215], v[40:43], a[104:107], v[212:215]
    buffer_load_dwordx4 v13, s[20:23], s63 offen offset:3072 lds
    v_mfma_f32_16x16x32_bf16 v[212:215], v[44:47], a[108:111], v[212:215]
    v_mul_f32 v179, s74, v179
    v_cvt_pk_bf16_f32 v144, v144, v145
    v_mfma_f32_16x16x32_bf16 v[216:219], v[40:43], a[112:115], v[216:219]
    v_cvt_pk_bf16_f32 v145, v146, v147
    v_cvt_pk_bf16_f32 v146, v176, v177
    v_mfma_f32_16x16x32_bf16 v[216:219], v[44:47], a[116:119], v[216:219]
    v_cvt_pk_bf16_f32 v147, v178, v179
    v_mul_f32 v148, s74, v148
    v_mfma_f32_16x16x32_bf16 v[220:223], v[40:43], a[120:123], v[220:223]
    v_mul_f32 v149, s74, v149
    v_mul_f32 v150, s74, v150
    v_mfma_f32_16x16x32_bf16 v[220:223], v[44:47], a[124:127], v[220:223]
    s_add_u32 s72, s70, 0
    v_mul_f32 v151, s74, v151
    v_mul_f32 v180, s74, v180
    s_waitcnt lgkmcnt(0)
    v_mfma_f32_16x16x32_bf16 v[224:227], v[48:51], a[64:67], v[224:227]
    buffer_store_dwordx4 v[128:131], v1, s[36:39], s72 offen sc1
    v_mfma_f32_16x16x32_bf16 v[224:227], v[52:55], a[68:71], v[224:227]
    s_xor_b32 s63, s63, 384
    v_mul_f32 v181, s74, v181
    v_mul_f32 v182, s74, v182
    v_mfma_f32_16x16x32_bf16 v[228:231], v[48:51], a[72:75], v[228:231]
    v_mul_f32 v183, s74, v183
    v_cvt_pk_bf16_f32 v148, v148, v149
    v_mfma_f32_16x16x32_bf16 v[228:231], v[52:55], a[76:79], v[228:231]
    v_cvt_pk_bf16_f32 v149, v150, v151
    v_cvt_pk_bf16_f32 v150, v180, v181
    v_mfma_f32_16x16x32_bf16 v[232:235], v[48:51], a[80:83], v[232:235]
    v_cvt_pk_bf16_f32 v151, v182, v183
    v_mul_f32 v152, s74, v152
    v_mfma_f32_16x16x32_bf16 v[232:235], v[52:55], a[84:87], v[232:235]
    s_add_u32 m0, s67, 98304
    v_mul_f32 v153, s74, v153
    v_mul_f32 v154, s74, v154
    s_waitcnt vmcnt(9) lgkmcnt(0)
    v_cmp_gt_u32 vcc, 8, v7
    s_nop 1
    s_and_b64 vcc, vcc, s[86:87]
    s_cbranch_scc1 SPIN_WA
BACK_WA:
    s_barrier
    v_mfma_f32_16x16x32_bf16 v[236:239], v[48:51], a[88:91], v[236:239]
    buffer_load_dwordx4 v1, s[28:31], s65 offen sc1 lds
    v_mfma_f32_16x16x32_bf16 v[236:239], v[52:55], a[92:95], v[236:239]
    ds_read_b64_tr_b16 v[56:57], v14 offset:0
    ds_read_b64_tr_b16 v[58:59], v14 offset:1024
    v_mfma_f32_16x16x32_bf16 v[240:243], v[48:51], a[96:99], v[240:243]
    ds_read_b64_tr_b16 v[60:61], v14 offset:8192
    ds_read_b64_tr_b16 v[62:63], v14 offset:9216
    v_mfma_f32_16x16x32_bf16 v[240:243], v[52:55], a[100:103], v[240:243]
    ds_read_b64_tr_b16 v[40:41], v15 offset:0
    ds_read_b64_tr_b16 v[42:43], v15 offset:1024
    v_mfma_f32_16x16x32_bf16 v[244:247], v[48:51], a[104:107], v[244:247]
    ds_read_b64_tr_b16 v[44:45], v15 offset:8192
    ds_read_b64_tr_b16 v[46:47], v15 offset:9216
    v_mfma_f32_16x16x32_bf16 v[244:247], v[52:55], a[108:111], v[244:247]
    v_mul_f32 v155, s74, v155
    v_mul_f32 v184, s74, v184
    v_mfma_f32_16x16x32_bf16 v[248:251], v[48:51], a[112:115], v[248:251]
    v_mul_f32 v185, s74, v185
    v_mul_f32 v186, s74, v186
    v_mfma_f32_16x16x32_bf16 v[248:251], v[52:55], a[116:119], v[248:251]
    v_mul_f32 v187, s74, v187
    v_cvt_pk_bf16_f32 v152, v152, v153
    v_mfma_f32_16x16x32_bf16 v[252:255], v[48:51], a[120:123], v[252:255]
    s_lshr_b32 s92, s2, 3
    buffer_load_dwordx4 v1, s[28:31], s65 offen offset:1024 sc1 lds
    v_mfma_f32_16x16x32_bf16 v[252:255], v[52:55], a[124:127], v[252:255]
    s_lshl2_add_u32 s92, s92, s4
    v_lshrrev_b32 v9, 4, v1
    v_min_u32 v9, 0, v9
    s_waitcnt lgkmcnt(0)
    v_mfma_f32_16x16x32_bf16 a[128:131], a[0:3], v[56:59], a[128:131]
    s_mul_i32 s92, s92, 1
    ds_read_b64_tr_b16 v[48:49], v16 offset:0
    ds_read_b64_tr_b16 v[50:51], v16 offset:1024
    v_mfma_f32_16x16x32_bf16 a[128:131], a[4:7], v[60:63], a[128:131]
    s_add_u32 s92, s92, 32
    v_add_lshl_u32 v9, v9, s92, 7
    ds_read_b64_tr_b16 v[52:53], v16 offset:8192
    v_mfma_f32_16x16x32_bf16 a[132:135], a[8:11], v[56:59], a[132:135]
    s_getpc_b64 s[92:93]
    global_load_dword v9, v9, s[92:93]
    v_mfma_f32_16x16x32_bf16 a[132:135], a[12:15], v[60:63], a[132:135]
    ds_read_b128 v[64:67], v24 offset:16384
    ds_read_b64_tr_b16 v[54:55], v16 offset:9216
    v_mfma_f32_16x16x32_bf16 a[136:139], a[16:19], v[56:59], a[136:139]
    v_cvt_pk_bf16_f32 v153, v154, v155
    v_cvt_pk_bf16_f32 v154, v184, v185
    v_mfma_f32_16x16x32_bf16 a[136:139], a[20:23], v[60:63], a[136:139]
    v_cvt_pk_bf16_f32 v155, v186, v187
    v_mul_f32 v156, s74, v156
    v_mfma_f32_16x16x32_bf16 a[140:143], a[24:27], v[56:59], a[140:143]
    s_add_u32 m0, s68, 106496
    v_mul_f32 v157, s74, v157
    v_mul_f32 v158, s74, v158
    v_mfma_f32_16x16x32_bf16 a[140:143], a[28:31], v[60:63], a[140:143]
    buffer_load_dwordx4 v6, s[20:23], s66 offen lds
    v_mfma_f32_16x16x32_bf16 a[144:147], a[32:35], v[56:59], a[144:147]
    s_add_u32 s72, s70, 4096
    v_mul_f32 v159, s74, v159
    v_mul_f32 v188, s74, v188
    v_mfma_f32_16x16x32_bf16 a[144:147], a[36:39], v[60:63], a[144:147]
    buffer_store_dwordx4 v[132:135], v1, s[36:39], s72 offen sc1
    v_mfma_f32_16x16x32_bf16 a[148:151], a[40:43], v[56:59], a[148:151]
    v_mul_f32 v189, s74, v189
    v_mul_f32 v190, s74, v190
    v_mfma_f32_16x16x32_bf16 a[148:151], a[44:47], v[60:63], a[148:151]
    v_mul_f32 v191, s74, v191
    v_cvt_pk_bf16_f32 v156, v156, v157
    v_mfma_f32_16x16x32_bf16 a[152:155], a[48:51], v[56:59], a[152:155]
    v_cvt_pk_bf16_f32 v157, v158, v159
    v_cvt_pk_bf16_f32 v158, v188, v189
    v_mfma_f32_16x16x32_bf16 a[152:155], a[52:55], v[60:63], a[152:155]
    ds_read_b128 v[68:71], v25 offset:16384
    v_cvt_pk_bf16_f32 v159, v190, v191
    v_mfma_f32_16x16x32_bf16 a[156:159], a[56:59], v[56:59], a[156:159]
    s_add_u32 m0, s69, 114688
    ds_read_b64_tr_b16 v[56:57], v17 offset:0
    ds_read_b64_tr_b16 v[58:59], v17 offset:1024
    v_mfma_f32_16x16x32_bf16 a[156:159], a[60:63], v[60:63], a[156:159]
    s_xor_b32 s65, s65, 8192
    buffer_load_dwordx4 v10, s[20:23], s64 offen lds
    v_mfma_f32_16x16x32_bf16 a[160:163], a[0:3], v[40:43], a[160:163]
    s_xor_b32 s66, s66, 128
    ds_read_b64_tr_b16 v[60:61], v17 offset:8192
    ds_read_b64_tr_b16 v[62:63], v17 offset:9216
    v_mfma_f32_16x16x32_bf16 a[160:163], a[4:7], v[44:47], a[160:163]
    v_mul_f32 v192, s74, v192
    v_mul_f32 v193, s74, v193
    v_mfma_f32_16x16x32_bf16 a[164:167], a[8:11], v[40:43], a[164:167]
    v_mul_f32 v194, s74, v194
    v_mul_f32 v195, s74, v195
    v_mfma_f32_16x16x32_bf16 a[164:167], a[12:15], v[44:47], a[164:167]
    v_mul_f32 v224, s74, v224
    v_mul_f32 v225, s74, v225
    v_mfma_f32_16x16x32_bf16 a[168:171], a[16:19], v[40:43], a[168:171]
    v_mul_f32 v226, s74, v226
    v_mul_f32 v227, s74, v227
    v_mfma_f32_16x16x32_bf16 a[168:171], a[20:23], v[44:47], a[168:171]
    v_cvt_pk_bf16_f32 v192, v192, v193
    v_cvt_pk_bf16_f32 v193, v194, v195
    v_mfma_f32_16x16x32_bf16 a[172:175], a[24:27], v[40:43], a[172:175]
    v_cvt_pk_bf16_f32 v194, v224, v225
    v_cvt_pk_bf16_f32 v195, v226, v227
    v_mfma_f32_16x16x32_bf16 a[172:175], a[28:31], v[44:47], a[172:175]
    v_mul_f32 v196, s74, v196
    v_mul_f32 v197, s74, v197
    v_mfma_f32_16x16x32_bf16 a[176:179], a[32:35], v[40:43], a[176:179]
    buffer_load_dwordx4 v11, s[20:23], s64 offen offset:1024 lds
    v_mfma_f32_16x16x32_bf16 a[176:179], a[36:39], v[44:47], a[176:179]
    ds_read_b128 v[72:75], v24 offset:24576
    v_mul_f32 v198, s74, v198
    v_mfma_f32_16x16x32_bf16 a[180:183], a[40:43], v[40:43], a[180:183]
    v_mul_f32 v199, s74, v199
    v_mul_f32 v228, s74, v228
    v_mfma_f32_16x16x32_bf16 a[180:183], a[44:47], v[44:47], a[180:183]
    v_mul_f32 v229, s74, v229
    v_mul_f32 v230, s74, v230
    v_mfma_f32_16x16x32_bf16 a[184:187], a[48:51], v[40:43], a[184:187]
    v_mul_f32 v231, s74, v231
    v_cvt_pk_bf16_f32 v196, v196, v197
    v_mfma_f32_16x16x32_bf16 a[184:187], a[52:55], v[44:47], a[184:187]
    v_cvt_pk_bf16_f32 v197, v198, v199
    v_cvt_pk_bf16_f32 v198, v228, v229
    v_mfma_f32_16x16x32_bf16 a[188:191], a[56:59], v[40:43], a[188:191]
    ds_read_b64_tr_b16 v[40:41], v14 offset:32768
    ds_read_b64_tr_b16 v[42:43], v14 offset:33792
    v_mfma_f32_16x16x32_bf16 a[188:191], a[60:63], v[44:47], a[188:191]
    s_waitcnt lgkmcnt(2)
    ds_read_b64_tr_b16 v[44:45], v14 offset:40960
    ds_read_b64_tr_b16 v[46:47], v14 offset:41984
    v_mfma_f32_16x16x32_bf16 a[192:195], a[0:3], v[48:51], a[192:195]
    buffer_load_dwordx4 v12, s[20:23], s64 offen offset:2048 lds
    v_mfma_f32_16x16x32_bf16 a[192:195], a[4:7], v[52:55], a[192:195]
    s_add_u32 s72, s70, 8192
    v_xor_b32 v14, s73, v14
    v_add_u32 v14, 0x10000, v14
    v_mfma_f32_16x16x32_bf16 a[196:199], a[8:11], v[48:51], a[196:199]
    buffer_store_dwordx4 v[136:139], v1, s[36:39], s72 offen sc1
    v_mfma_f32_16x16x32_bf16 a[196:199], a[12:15], v[52:55], a[196:199]
    ds_read_b128 v[76:79], v25 offset:24576
    v_cvt_pk_bf16_f32 v199, v230, v231
    v_mfma_f32_16x16x32_bf16 a[200:203], a[16:19], v[48:51], a[200:203]
    v_mul_f32 v200, s74, v200
    v_mul_f32 v201, s74, v201
    v_mfma_f32_16x16x32_bf16 a[200:203], a[20:23], v[52:55], a[200:203]
    v_mul_f32 v202, s74, v202
    v_mul_f32 v203, s74, v203
    v_mfma_f32_16x16x32_bf16 a[204:207], a[24:27], v[48:51], a[204:207]
    v_mul_f32 v232, s74, v232
    v_mul_f32 v233, s74, v233
    v_mfma_f32_16x16x32_bf16 a[204:207], a[28:31], v[52:55], a[204:207]
    v_mul_f32 v234, s74, v234
    v_mul_f32 v235, s74, v235
    v_mfma_f32_16x16x32_bf16 a[208:211], a[32:35], v[48:51], a[208:211]
    v_cvt_pk_bf16_f32 v200, v200, v201
    v_cvt_pk_bf16_f32 v201, v202, v203
    v_mfma_f32_16x16x32_bf16 a[208:211], a[36:39], v[52:55], a[208:211]
    buffer_load_dwordx4 v13, s[20:23], s64 offen offset:3072 lds
    v_mfma_f32_16x16x32_bf16 a[212:215], a[40:43], v[48:51], a[212:215]
    v_cvt_pk_bf16_f32 v202, v232, v233
    v_cvt_pk_bf16_f32 v203, v234, v235
    v_mfma_f32_16x16x32_bf16 a[212:215], a[44:47], v[52:55], a[212:215]
    v_mul_f32 v204, s74, v204
    v_mul_f32 v205, s74, v205
    v_mfma_f32_16x16x32_bf16 a[216:219], a[48:51], v[48:51], a[216:219]
    v_mul_f32 v206, s74, v206
    v_mul_f32 v207, s74, v207
    v_mfma_f32_16x16x32_bf16 a[216:219], a[52:55], v[52:55], a[216:219]
    v_mul_f32 v236, s74, v236
    v_mul_f32 v237, s74, v237
    v_mfma_f32_16x16x32_bf16 a[220:223], a[56:59], v[48:51], a[220:223]
    ds_read_b64_tr_b16 v[48:49], v15 offset:32768
    ds_read_b64_tr_b16 v[50:51], v15 offset:33792
    v_mfma_f32_16x16x32_bf16 a[220:223], a[60:63], v[52:55], a[220:223]
    ds_read_b64_tr_b16 v[52:53], v15 offset:40960
    ds_read_b64_tr_b16 v[54:55], v15 offset:41984
    v_mfma_f32_16x16x32_bf16 a[224:227], a[0:3], v[56:59], a[224:227]
    v_xor_b32 v15, s73, v15
    v_add_u32 v15, 0x10000, v15
    v_mfma_f32_16x16x32_bf16 a[224:227], a[4:7], v[60:63], a[224:227]
    s_xor_b32 s64, s64, 384
    v_accvgpr_write_b32 a4, v192
    v_accvgpr_write_b32 a5, v193
    v_mfma_f32_16x16x32_bf16 a[228:231], a[8:11], v[56:59], a[228:231]
    v_accvgpr_write_b32 a6, v194
    v_accvgpr_write_b32 a7, v195
    v_mfma_f32_16x16x32_bf16 a[228:231], a[12:15], v[60:63], a[228:231]
    v_accvgpr_write_b32 a12, v196
    v_accvgpr_write_b32 a13, v197
    v_mfma_f32_16x16x32_bf16 a[232:235], a[16:19], v[56:59], a[232:235]
    v_accvgpr_write_b32 a14, v198
    v_accvgpr_write_b32 a15, v199
    v_mfma_f32_16x16x32_bf16 a[232:235], a[20:23], v[60:63], a[232:235]
    s_add_u32 m0, s69, 131072
    v_mul_f32 v238, s74, v238
    v_mul_f32 v239, s74, v239
    v_mfma_f32_16x16x32_bf16 a[236:239], a[24:27], v[56:59], a[236:239]
    buffer_load_dwordx4 v2, s[24:27], s60 offen lds
    v_mfma_f32_16x16x32_bf16 a[236:239], a[28:31], v[60:63], a[236:239]
    v_accvgpr_write_b32 a20, v200
    v_accvgpr_write_b32 a21, v201
    v_mfma_f32_16x16x32_bf16 a[240:243], a[32:35], v[56:59], a[240:243]
    v_accvgpr_write_b32 a22, v202
    v_accvgpr_write_b32 a23, v203
    v_mfma_f32_16x16x32_bf16 a[240:243], a[36:39], v[60:63], a[240:243]
    v_cvt_pk_bf16_f32 v204, v204, v205
    v_cvt_pk_bf16_f32 v205, v206, v207
    v_mfma_f32_16x16x32_bf16 a[244:247], a[40:43], v[56:59], a[244:247]
    s_add_u32 s72, s70, 12288
    v_accvgpr_write_b32 a40, v148
    v_accvgpr_write_b32 a41, v149
    v_mfma_f32_16x16x32_bf16 a[244:247], a[44:47], v[60:63], a[244:247]
    buffer_store_dwordx4 v[140:143], v1, s[36:39], s72 offen sc1
    v_mfma_f32_16x16x32_bf16 a[248:251], a[48:51], v[56:59], a[248:251]
    v_accvgpr_write_b32 a42, v150
    v_accvgpr_write_b32 a43, v151
    v_mfma_f32_16x16x32_bf16 a[248:251], a[52:55], v[60:63], a[248:251]
    buffer_load_dwordx4 v3, s[24:27], s60 offen offset:1024 lds
    v_mfma_f32_16x16x32_bf16 a[252:255], a[56:59], v[56:59], a[252:255]
    ds_read_b64_tr_b16 v[56:57], v16 offset:32768
    ds_read_b64_tr_b16 v[58:59], v16 offset:33792
    v_mfma_f32_16x16x32_bf16 a[252:255], a[60:63], v[60:63], a[252:255]
    s_waitcnt lgkmcnt(2)
    ds_read_b64_tr_b16 v[60:61], v16 offset:40960
    ds_read_b64_tr_b16 v[62:63], v16 offset:41984
    v_mfma_f32_16x16x32_bf16 a[128:131], a[64:67], v[40:43], a[128:131]
    v_xor_b32 v16, s73, v16
    v_add_u32 v16, 0x10000, v16
    v_mfma_f32_16x16x32_bf16 a[128:131], a[68:71], v[44:47], a[128:131]
    v_accvgpr_write_b32 a48, v152
    v_accvgpr_write_b32 a49, v153
    v_mfma_f32_16x16x32_bf16 a[132:135], a[72:75], v[40:43], a[132:135]
    ds_read_b128 v[80:83], v24 offset:49152
    v_accvgpr_write_b32 a50, v154
    v_mfma_f32_16x16x32_bf16 a[132:135], a[76:79], v[44:47], a[132:135]
    v_accvgpr_write_b32 a51, v155
    v_accvgpr_write_b32 a56, v156
    v_mfma_f32_16x16x32_bf16 a[136:139], a[80:83], v[40:43], a[136:139]
    v_accvgpr_write_b32 a57, v157
    v_accvgpr_write_b32 a58, v158
    v_mfma_f32_16x16x32_bf16 a[136:139], a[84:87], v[44:47], a[136:139]
    buffer_load_dwordx4 v4, s[24:27], s60 offen offset:2048 lds
    v_mfma_f32_16x16x32_bf16 a[140:143], a[88:91], v[40:43], a[140:143]
    v_accvgpr_write_b32 a59, v159
    v_cvt_pk_bf16_f32 v206, v236, v237
    v_mfma_f32_16x16x32_bf16 a[140:143], a[92:95], v[44:47], a[140:143]
    v_cvt_pk_bf16_f32 v207, v238, v239
    v_mul_f32 v208, s74, v208
    v_mfma_f32_16x16x32_bf16 a[144:147], a[96:99], v[40:43], a[144:147]
    v_mul_f32 v209, s74, v209
    v_mul_f32 v210, s74, v210
    v_mfma_f32_16x16x32_bf16 a[144:147], a[100:103], v[44:47], a[144:147]
    v_mul_f32 v211, s74, v211
    v_mul_f32 v240, s74, v240
    v_mfma_f32_16x16x32_bf16 a[148:151], a[104:107], v[40:43], a[148:151]
    v_mul_f32 v241, s74, v241
    v_mul_f32 v242, s74, v242
    v_mfma_f32_16x16x32_bf16 a[148:151], a[108:111], v[44:47], a[148:151]
    v_mul_f32 v243, s74, v243
    v_accvgpr_write_b32 a28, v204
    v_mfma_f32_16x16x32_bf16 a[152:155], a[112:115], v[40:43], a[152:155]
    buffer_load_dwordx4 v5, s[24:27], s60 offen offset:3072 lds
    v_mfma_f32_16x16x32_bf16 a[152:155], a[116:119], v[44:47], a[152:155]
    ds_read_b128 v[84:87], v25 offset:49152
    v_accvgpr_write_b32 a29, v205
    v_mfma_f32_16x16x32_bf16 a[156:159], a[120:123], v[40:43], a[156:159]
    ds_read_b64_tr_b16 v[40:41], v17 offset:32768
    ds_read_b64_tr_b16 v[42:43], v17 offset:33792
    v_mfma_f32_16x16x32_bf16 a[156:159], a[124:127], v[44:47], a[156:159]
    ds_read_b64_tr_b16 v[44:45], v17 offset:40960
    ds_read_b64_tr_b16 v[46:47], v17 offset:41984
    v_mfma_f32_16x16x32_bf16 a[160:163], a[64:67], v[48:51], a[160:163]
    v_xor_b32 v17, s73, v17
    v_add_u32 v17, 0x10000, v17
    v_mfma_f32_16x16x32_bf16 a[160:163], a[68:71], v[52:55], a[160:163]
    v_accvgpr_write_b32 a30, v206
    v_accvgpr_write_b32 a31, v207
    v_mfma_f32_16x16x32_bf16 a[164:167], a[72:75], v[48:51], a[164:167]
    v_cvt_pk_bf16_f32 v208, v208, v209
    v_cvt_pk_bf16_f32 v209, v210, v211
    v_mfma_f32_16x16x32_bf16 a[164:167], a[76:79], v[52:55], a[164:167]
    s_add_u32 m0, s69, 147456
    v_cvt_pk_bf16_f32 v210, v240, v241
    v_cvt_pk_bf16_f32 v211, v242, v243
    v_mfma_f32_16x16x32_bf16 a[168:171], a[80:83], v[48:51], a[168:171]
    s_xor_b32 s60, s60, 1572864
    buffer_load_dwordx4 v10, s[20:23], s63 offen lds
    v_mfma_f32_16x16x32_bf16 a[168:171], a[84:87], v[52:55], a[168:171]
    s_add_u32 s72, s70, 32768
    buffer_store_dwordx4 v[144:147], v1, s[36:39], s72 offen sc1
    v_mfma_f32_16x16x32_bf16 a[172:175], a[88:91], v[48:51], a[172:175]
    v_mul_f32 v212, s74, v212
    v_mul_f32 v213, s74, v213
    v_mfma_f32_16x16x32_bf16 a[172:175], a[92:95], v[52:55], a[172:175]
    v_mul_f32 v214, s74, v214
    v_mul_f32 v215, s74, v215
    v_mfma_f32_16x16x32_bf16 a[176:179], a[96:99], v[48:51], a[176:179]
    ds_read_b128 v[88:91], v24 offset:57344
    v_mul_f32 v244, s74, v244
    v_mfma_f32_16x16x32_bf16 a[176:179], a[100:103], v[52:55], a[176:179]
    v_mul_f32 v245, s74, v245
    v_mul_f32 v246, s74, v246
    v_mfma_f32_16x16x32_bf16 a[180:183], a[104:107], v[48:51], a[180:183]
    v_mul_f32 v247, s74, v247
    v_accvgpr_write_b32 a36, v208
    v_mfma_f32_16x16x32_bf16 a[180:183], a[108:111], v[52:55], a[180:183]
    buffer_load_dwordx4 v11, s[20:23], s63 offen offset:1024 lds
    v_mfma_f32_16x16x32_bf16 a[184:187], a[112:115], v[48:51], a[184:187]
    v_accvgpr_write_b32 a37, v209
    v_accvgpr_write_b32 a38, v210
    v_mfma_f32_16x16x32_bf16 a[184:187], a[116:119], v[52:55], a[184:187]
    v_accvgpr_write_b32 a39, v211
    v_cvt_pk_bf16_f32 v212, v212, v213
    v_mfma_f32_16x16x32_bf16 a[188:191], a[120:123], v[48:51], a[188:191]
    v_cvt_pk_bf16_f32 v213, v214, v215
    v_cvt_pk_bf16_f32 v214, v244, v245
    v_mfma_f32_16x16x32_bf16 a[188:191], a[124:127], v[52:55], a[188:191]
    s_waitcnt lgkmcnt(0)
    v_cvt_pk_bf16_f32 v215, v246, v247
    v_mul_f32 v216, s74, v216
    v_mfma_f32_16x16x32_bf16 a[192:195], a[64:67], v[56:59], a[192:195]
    v_mul_f32 v217, s74, v217
    v_mul_f32 v218, s74, v218
    v_mfma_f32_16x16x32_bf16 a[192:195], a[68:71], v[60:63], a[192:195]
    v_accvgpr_read_b32 v32, a128
    v_accvgpr_read_b32 v31, a129
    v_mfma_f32_16x16x32_bf16 a[196:199], a[72:75], v[56:59], a[196:199]
    v_cvt_pk_bf16_f32 v32, v32, v31
    v_accvgpr_read_b32 v33, a130
    v_mfma_f32_16x16x32_bf16 a[196:199], a[76:79], v[60:63], a[196:199]
    buffer_load_dwordx4 v12, s[20:23], s63 offen offset:2048 lds
    v_mfma_f32_16x16x32_bf16 a[200:203], a[80:83], v[56:59], a[200:203]
    ds_read_b128 v[92:95], v25 offset:57344
    v_accvgpr_read_b32 v31, a131
    v_mfma_f32_16x16x32_bf16 a[200:203], a[84:87], v[60:63], a[200:203]
    v_cvt_pk_bf16_f32 v33, v33, v31
    v_accvgpr_read_b32 v34, a132
    v_mfma_f32_16x16x32_bf16 a[204:207], a[88:91], v[56:59], a[204:207]
    v_accvgpr_read_b32 v31, a133
    v_cvt_pk_bf16_f32 v34, v34, v31
    v_mfma_f32_16x16x32_bf16 a[204:207], a[92:95], v[60:63], a[204:207]
    v_accvgpr_read_b32 v35, a134
    v_accvgpr_read_b32 v31, a135
    v_mfma_f32_16x16x32_bf16 a[208:211], a[96:99], v[56:59], a[208:211]
    v_cvt_pk_bf16_f32 v35, v35, v31
    v_mul_f32 v219, s74, v219
    v_mfma_f32_16x16x32_bf16 a[208:211], a[100:103], v[60:63], a[208:211]
    v_mul_f32 v248, s74, v248
    v_mul_f32 v249, s74, v249
    v_mfma_f32_16x16x32_bf16 a[212:215], a[104:107], v[56:59], a[212:215]
    buffer_load_dwordx4 v13, s[20:23], s63 offen offset:3072 lds
    v_mfma_f32_16x16x32_bf16 a[212:215], a[108:111], v[60:63], a[212:215]
    v_mul_f32 v250, s74, v250
    v_mul_f32 v251, s74, v251
    v_mfma_f32_16x16x32_bf16 a[216:219], a[112:115], v[56:59], a[216:219]
    s_add_u32 s72, s71, 0
    v_accvgpr_write_b32 a44, v212
    v_accvgpr_write_b32 a45, v213
    v_mfma_f32_16x16x32_bf16 a[216:219], a[116:119], v[60:63], a[216:219]
    buffer_store_dwordx4 v[32:35], v1, s[36:39], s72 offen sc1
    v_mfma_f32_16x16x32_bf16 a[220:223], a[120:123], v[56:59], a[220:223]
    v_accvgpr_write_b32 a46, v214
    v_accvgpr_write_b32 a47, v215
    v_mfma_f32_16x16x32_bf16 a[220:223], a[124:127], v[60:63], a[220:223]
    v_cvt_pk_bf16_f32 v216, v216, v217
    v_cvt_pk_bf16_f32 v217, v218, v219
    v_mfma_f32_16x16x32_bf16 a[224:227], a[64:67], v[40:43], a[224:227]
    v_cvt_pk_bf16_f32 v218, v248, v249
    v_cvt_pk_bf16_f32 v219, v250, v251
    v_mfma_f32_16x16x32_bf16 a[224:227], a[68:71], v[44:47], a[224:227]
    s_xor_b32 s63, s63, 128
    v_mul_f32 v220, s74, v220
    v_mul_f32 v221, s74, v221
    v_mfma_f32_16x16x32_bf16 a[228:231], a[72:75], v[40:43], a[228:231]
    v_mul_f32 v222, s74, v222
    v_mul_f32 v223, s74, v223
    v_mfma_f32_16x16x32_bf16 a[228:231], a[76:79], v[44:47], a[228:231]
    v_mul_f32 v252, s74, v252
    v_mul_f32 v253, s74, v253
    v_mfma_f32_16x16x32_bf16 a[232:235], a[80:83], v[40:43], a[232:235]
    v_mul_f32 v254, s74, v254
    v_mul_f32 v255, s74, v255
    v_mfma_f32_16x16x32_bf16 a[232:235], a[84:87], v[44:47], a[232:235]
    s_waitcnt vmcnt(11) lgkmcnt(0)
    s_barrier
    ds_read_b64_tr_b16 v[48:49], v14 offset:0
    v_mfma_f32_16x16x32_bf16 a[236:239], a[88:91], v[40:43], a[236:239]
    s_add_u32 m0, s67, 0
    ds_read_b64_tr_b16 v[50:51], v14 offset:1024
    ds_read_b64_tr_b16 v[52:53], v14 offset:8192
    v_mfma_f32_16x16x32_bf16 a[236:239], a[92:95], v[44:47], a[236:239]
    buffer_load_dwordx4 v1, s[28:31], s65 offen sc1 lds
    v_mfma_f32_16x16x32_bf16 a[240:243], a[96:99], v[40:43], a[240:243]
    ds_read_b64_tr_b16 v[54:55], v14 offset:9216
    ds_read_b64_tr_b16 v[56:57], v15 offset:0
    v_mfma_f32_16x16x32_bf16 a[240:243], a[100:103], v[44:47], a[240:243]
    ds_read_b64_tr_b16 v[58:59], v15 offset:1024
    ds_read_b64_tr_b16 v[60:61], v15 offset:8192
    v_mfma_f32_16x16x32_bf16 a[244:247], a[104:107], v[40:43], a[244:247]
    ds_read_b64_tr_b16 v[62:63], v15 offset:9216
    v_add_u32 v14, 0x10000, v14
    v_mfma_f32_16x16x32_bf16 a[244:247], a[108:111], v[44:47], a[244:247]
    v_add_u32 v15, 0x10000, v15
    v_accvgpr_read_b32 v32, a136
    v_mfma_f32_16x16x32_bf16 a[248:251], a[112:115], v[40:43], a[248:251]
    v_accvgpr_read_b32 v31, a137
    v_cvt_pk_bf16_f32 v32, v32, v31
    v_mfma_f32_16x16x32_bf16 a[248:251], a[116:119], v[44:47], a[248:251]
    v_accvgpr_read_b32 v33, a138
    v_accvgpr_read_b32 v31, a139
    v_mfma_f32_16x16x32_bf16 a[252:255], a[120:123], v[40:43], a[252:255]
    buffer_load_dwordx4 v1, s[28:31], s65 offen offset:1024 sc1 lds
    v_mfma_f32_16x16x32_bf16 a[252:255], a[124:127], v[44:47], a[252:255]
    s_waitcnt lgkmcnt(0)
    ds_read_b64_tr_b16 v[40:41], v16 offset:0
    ds_read_b64_tr_b16 v[42:43], v16 offset:1024
    v_mfma_f32_16x16x32_bf16 v[128:131], v[48:51], v[64:67], 0
    ds_read_b64_tr_b16 v[44:45], v16 offset:8192
    ds_read_b64_tr_b16 v[46:47], v16 offset:9216
    v_mfma_f32_16x16x32_bf16 v[128:131], v[52:55], v[68:71], v[128:131]
    v_add_u32 v24, 0x10000, v24
    ds_read_b128 a[136:139], v22 offset:32768
    v_mfma_f32_16x16x32_bf16 v[132:135], v[48:51], v[72:75], 0
    ds_read_b128 v[96:99], v24 offset:16384
    v_add_u32 v16, 0x10000, v16
    v_mfma_f32_16x16x32_bf16 v[132:135], v[52:55], v[76:79], v[132:135]
    v_add_u32 v22, 0xffff0000, v22
    v_cvt_pk_bf16_f32 v33, v33, v31
    v_mfma_f32_16x16x32_bf16 v[136:139], v[48:51], v[80:83], 0
    v_accvgpr_read_b32 v34, a140
    v_accvgpr_read_b32 v31, a141
    v_mfma_f32_16x16x32_bf16 v[136:139], v[52:55], v[84:87], v[136:139]
    s_add_u32 s72, s71, 1024
    v_cvt_pk_bf16_f32 v34, v34, v31
    v_accvgpr_read_b32 v35, a142
    v_mfma_f32_16x16x32_bf16 v[140:143], v[48:51], v[88:91], 0
    s_add_u32 m0, s68, 8192
    ds_read_b64_tr_b16 v[48:49], v17 offset:0
    ds_read_b64_tr_b16 v[50:51], v17 offset:1024
    v_mfma_f32_16x16x32_bf16 v[140:143], v[52:55], v[92:95], v[140:143]
    buffer_load_dwordx4 v6, s[20:23], s66 offen lds
    v_mfma_f32_16x16x32_bf16 v[144:147], v[56:59], v[64:67], 0
    ds_read_b64_tr_b16 v[52:53], v17 offset:8192
    ds_read_b64_tr_b16 v[54:55], v17 offset:9216
    v_mfma_f32_16x16x32_bf16 v[144:147], v[60:63], v[68:71], v[144:147]
    v_add_u32 v17, 0x10000, v17
    v_accvgpr_read_b32 v31, a143
    v_mfma_f32_16x16x32_bf16 v[148:151], v[56:59], v[72:75], 0
    ds_read_b128 a[140:143], v23 offset:32768
    v_add_u32 v23, 0xffff0000, v23
    v_mfma_f32_16x16x32_bf16 v[148:151], v[60:63], v[76:79], v[148:151]
    v_cvt_pk_bf16_f32 v35, v35, v31
    v_accvgpr_write_b32 a52, v216
    v_mfma_f32_16x16x32_bf16 v[152:155], v[56:59], v[80:83], 0
    v_add_u32 v25, 0x10000, v25
    v_accvgpr_write_b32 a53, v217
    v_mfma_f32_16x16x32_bf16 v[152:155], v[60:63], v[84:87], v[152:155]
    ds_read_b128 v[100:103], v25 offset:16384
    v_accvgpr_write_b32 a54, v218
    v_mfma_f32_16x16x32_bf16 v[156:159], v[56:59], v[88:91], 0
    s_add_u32 m0, s69, 16384
    ds_read_b64_tr_b16 v[56:57], v18 offset:0
    ds_read_b64_tr_b16 v[58:59], v18 offset:1024
    v_mfma_f32_16x16x32_bf16 v[156:159], v[60:63], v[92:95], v[156:159]
    s_xor_b32 s65, s65, 24576
    buffer_load_dwordx4 v10, s[20:23], s64 offen lds
    s_waitcnt lgkmcnt(3)
    v_mfma_f32_16x16x32_bf16 v[160:163], v[40:43], v[64:67], 0
    s_xor_b32 s66, s66, 384
    ds_read_b64_tr_b16 v[60:61], v18 offset:8192
    ds_read_b64_tr_b16 v[62:63], v18 offset:9216
    v_mfma_f32_16x16x32_bf16 v[160:163], v[44:47], v[68:71], v[160:163]
    v_add_u32 v18, 0x10000, v18
    v_accvgpr_write_b32 a55, v219
    v_mfma_f32_16x16x32_bf16 v[164:167], v[40:43], v[72:75], 0
    buffer_store_dwordx4 v[32:35], v1, s[36:39], s72 offen sc1
    v_mfma_f32_16x16x32_bf16 v[164:167], v[44:47], v[76:79], v[164:167]
    v_cvt_pk_bf16_f32 v220, v220, v221
    v_cvt_pk_bf16_f32 v221, v222, v223
    v_mfma_f32_16x16x32_bf16 v[168:171], v[40:43], v[80:83], 0
    v_cvt_pk_bf16_f32 v222, v252, v253
    v_cvt_pk_bf16_f32 v223, v254, v255
    v_mfma_f32_16x16x32_bf16 v[168:171], v[44:47], v[84:87], v[168:171]
    v_accvgpr_write_b32 a60, v220
    v_accvgpr_write_b32 a61, v221
    v_mfma_f32_16x16x32_bf16 v[172:175], v[40:43], v[88:91], 0
    ds_read_b64_tr_b16 v[40:41], v19 offset:0
    ds_read_b64_tr_b16 v[42:43], v19 offset:1024
    v_mfma_f32_16x16x32_bf16 v[172:175], v[44:47], v[92:95], v[172:175]
    ds_read_b64_tr_b16 v[44:45], v19 offset:8192
    ds_read_b64_tr_b16 v[46:47], v19 offset:9216
    v_mfma_f32_16x16x32_bf16 v[176:179], v[48:51], v[64:67], 0
    buffer_load_dwordx4 v11, s[20:23], s64 offen offset:1024 lds
    v_mfma_f32_16x16x32_bf16 v[176:179], v[52:55], v[68:71], v[176:179]
    ds_read_b128 v[104:107], v24 offset:24576
    v_add_u32 v19, 0x10000, v19
    v_mfma_f32_16x16x32_bf16 v[180:183], v[48:51], v[72:75], 0
    v_accvgpr_write_b32 a62, v222
    v_accvgpr_write_b32 a63, v223
    v_mfma_f32_16x16x32_bf16 v[180:183], v[52:55], v[76:79], v[180:183]
    v_accvgpr_write_b32 a0, 0
    v_accvgpr_write_b32 a1, 0
    v_mfma_f32_16x16x32_bf16 v[184:187], v[48:51], v[80:83], 0
    v_accvgpr_write_b32 a2, 0
    v_accvgpr_write_b32 a3, 0
    v_mfma_f32_16x16x32_bf16 v[184:187], v[52:55], v[84:87], v[184:187]
    v_accvgpr_write_b32 a8, 0
    v_accvgpr_write_b32 a9, 0
    v_mfma_f32_16x16x32_bf16 v[188:191], v[48:51], v[88:91], 0
    s_add_u32 s72, s70, 36864
    ds_read_b64_tr_b16 v[48:49], v20 offset:0
    ds_read_b64_tr_b16 v[50:51], v20 offset:1024
    v_mfma_f32_16x16x32_bf16 v[188:191], v[52:55], v[92:95], v[188:191]
    s_waitcnt lgkmcnt(2)
    ds_read_b64_tr_b16 v[52:53], v20 offset:8192
    ds_read_b64_tr_b16 v[54:55], v20 offset:9216
    v_mfma_f32_16x16x32_bf16 v[192:195], v[56:59], v[64:67], 0
    buffer_load_dwordx4 v12, s[20:23], s64 offen offset:2048 lds
    v_mfma_f32_16x16x32_bf16 v[192:195], v[60:63], v[68:71], v[192:195]
    v_add_u32 v20, 0x10000, v20
    v_accvgpr_write_b32 a10, 0
    v_mfma_f32_16x16x32_bf16 v[196:199], v[56:59], v[72:75], 0
    buffer_store_dwordx4 a[40:43], v1, s[36:39], s72 offen sc1
    v_mfma_f32_16x16x32_bf16 v[196:199], v[60:63], v[76:79], v[196:199]
    ds_read_b128 v[108:111], v25 offset:24576
    v_accvgpr_write_b32 a11, 0
    v_mfma_f32_16x16x32_bf16 v[200:203], v[56:59], v[80:83], 0
    v_accvgpr_write_b32 a16, 0
    v_accvgpr_write_b32 a17, 0
    v_mfma_f32_16x16x32_bf16 v[200:203], v[60:63], v[84:87], v[200:203]
    v_accvgpr_write_b32 a18, 0
    v_accvgpr_write_b32 a19, 0
    v_mfma_f32_16x16x32_bf16 v[204:207], v[56:59], v[88:91], 0
    ds_read_b64_tr_b16 v[56:57], v21 offset:0
    ds_read_b64_tr_b16 v[58:59], v21 offset:1024
    v_mfma_f32_16x16x32_bf16 v[204:207], v[60:63], v[92:95], v[204:207]
    ds_read_b64_tr_b16 v[60:61], v21 offset:8192
    ds_read_b64_tr_b16 v[62:63], v21 offset:9216
    v_mfma_f32_16x16x32_bf16 v[208:211], v[40:43], v[64:67], 0
    v_add_u32 v21, 0x10000, v21
    v_accvgpr_write_b32 a24, 0
    v_mfma_f32_16x16x32_bf16 v[208:211], v[44:47], v[68:71], v[208:211]
    buffer_load_dwordx4 v13, s[20:23], s64 offen offset:3072 lds
    v_mfma_f32_16x16x32_bf16 v[212:215], v[40:43], v[72:75], 0
    v_accvgpr_write_b32 a25, 0
    v_accvgpr_write_b32 a26, 0
    v_mfma_f32_16x16x32_bf16 v[212:215], v[44:47], v[76:79], v[212:215]
    v_accvgpr_write_b32 a27, 0
    v_accvgpr_write_b32 a32, 0
    v_mfma_f32_16x16x32_bf16 v[216:219], v[40:43], v[80:83], 0
    v_accvgpr_write_b32 a33, 0
    v_accvgpr_write_b32 a34, 0
    v_mfma_f32_16x16x32_bf16 v[216:219], v[44:47], v[84:87], v[216:219]
    v_accvgpr_write_b32 a35, 0
    v_accvgpr_write_b32 a40, 0
    v_mfma_f32_16x16x32_bf16 v[220:223], v[40:43], v[88:91], 0
    ds_read_b64_tr_b16 v[40:41], v26 offset:32768
    ds_read_b64_tr_b16 v[42:43], v26 offset:33280
    v_mfma_f32_16x16x32_bf16 v[220:223], v[44:47], v[92:95], v[220:223]
    s_waitcnt lgkmcnt(2)
    ds_read_b64_tr_b16 v[44:45], v26 offset:36864
    ds_read_b64_tr_b16 v[46:47], v26 offset:37376
    v_mfma_f32_16x16x32_bf16 v[224:227], v[48:51], v[64:67], 0
    v_add_u32 v26, 0xffff0000, v26
    v_accvgpr_write_b32 a41, 0
    v_mfma_f32_16x16x32_bf16 v[224:227], v[52:55], v[68:71], v[224:227]
    s_xor_b32 s64, s64, 128
    v_accvgpr_write_b32 a42, 0
    v_accvgpr_write_b32 a43, 0
    v_mfma_f32_16x16x32_bf16 v[228:231], v[48:51], v[72:75], 0
    v_mfma_f32_16x16x32_bf16 v[228:231], v[52:55], v[76:79], v[228:231]
    v_mfma_f32_16x16x32_bf16 v[232:235], v[48:51], v[80:83], 0
    v_mfma_f32_16x16x32_bf16 v[232:235], v[52:55], v[84:87], v[232:235]
    s_add_u32 m0, s69, 32768
    v_mfma_f32_16x16x32_bf16 v[236:239], v[48:51], v[88:91], 0
    buffer_load_dwordx4 v2, s[24:27], s60 offen lds
    v_mfma_f32_16x16x32_bf16 v[236:239], v[52:55], v[92:95], v[236:239]
    s_add_u32 s72, s70, 40960
    ds_read_b64_tr_b16 v[48:49], v27 offset:32768
    ds_read_b64_tr_b16 v[50:51], v27 offset:33280
    v_mfma_f32_16x16x32_bf16 v[240:243], v[56:59], v[64:67], 0
    ds_read_b64_tr_b16 v[52:53], v27 offset:36864
    ds_read_b64_tr_b16 v[54:55], v27 offset:37376
    v_mfma_f32_16x16x32_bf16 v[240:243], v[60:63], v[68:71], v[240:243]
    buffer_store_dwordx4 a[48:51], v1, s[36:39], s72 offen sc1
    v_mfma_f32_16x16x32_bf16 v[244:247], v[56:59], v[72:75], 0
    buffer_load_dwordx4 v3, s[24:27], s60 offen offset:1024 lds
    v_mfma_f32_16x16x32_bf16 v[244:247], v[60:63], v[76:79], v[244:247]
    v_add_u32 v27, 0xffff0000, v27
    v_accvgpr_write_b32 a48, 0
    v_mfma_f32_16x16x32_bf16 v[248:251], v[56:59], v[80:83], 0
    v_accvgpr_write_b32 a49, 0
    v_accvgpr_write_b32 a50, 0
    v_mfma_f32_16x16x32_bf16 v[248:251], v[60:63], v[84:87], v[248:251]
    v_accvgpr_write_b32 a51, 0
    v_mfma_f32_16x16x32_bf16 v[252:255], v[56:59], v[88:91], 0
    buffer_load_dwordx4 v4, s[24:27], s60 offen offset:2048 lds
    v_mfma_f32_16x16x32_bf16 v[252:255], v[60:63], v[92:95], v[252:255]
    s_waitcnt lgkmcnt(0)
    ds_read_b64_tr_b16 v[56:57], v28 offset:32768
    ds_read_b64_tr_b16 v[58:59], v28 offset:33280
    v_mfma_f32_16x16x32_bf16 a[64:67], v[40:43], v[64:67], 0
    ds_read_b64_tr_b16 v[60:61], v28 offset:36864
    ds_read_b64_tr_b16 v[62:63], v28 offset:37376
    v_mfma_f32_16x16x32_bf16 a[64:67], v[44:47], v[68:71], a[64:67]
    v_add_u32 v28, 0xffff0000, v28
    v_mfma_f32_16x16x32_bf16 a[68:71], v[40:43], v[72:75], 0
    buffer_load_dwordx4 v5, s[24:27], s60 offen offset:3072 lds
    v_mfma_f32_16x16x32_bf16 a[68:71], v[44:47], v[76:79], a[68:71]
    ds_read_b128 v[112:115], v24 offset:49152
    v_mfma_f32_16x16x32_bf16 a[72:75], v[40:43], v[80:83], 0
    v_mfma_f32_16x16x32_bf16 a[72:75], v[44:47], v[84:87], a[72:75]
    s_add_u32 m0, s69, 49152
    v_mfma_f32_16x16x32_bf16 a[76:79], v[40:43], v[88:91], 0
    s_xor_b32 s60, s60, 524288
    buffer_load_dwordx4 v10, s[20:23], s63 offen lds
    v_mfma_f32_16x16x32_bf16 a[76:79], v[44:47], v[92:95], a[76:79]
    ds_read_b128 v[116:119], v25 offset:49152
    v_mfma_f32_16x16x32_bf16 a[128:131], v[40:43], a[136:139], 0
    ds_read_b64_tr_b16 v[40:41], v29 offset:32768
    ds_read_b64_tr_b16 v[42:43], v29 offset:33280
    v_mfma_f32_16x16x32_bf16 a[128:131], v[44:47], a[140:143], a[128:131]
    ds_read_b64_tr_b16 v[44:45], v29 offset:36864
    ds_read_b64_tr_b16 v[46:47], v29 offset:37376
    v_mfma_f32_16x16x32_bf16 a[80:83], v[48:51], v[64:67], 0
    buffer_load_dwordx4 v11, s[20:23], s63 offen offset:1024 lds
    v_mfma_f32_16x16x32_bf16 a[80:83], v[52:55], v[68:71], a[80:83]
    ds_read_b128 v[120:123], v24 offset:57344
    v_add_u32 v29, 0xffff0000, v29
    v_mfma_f32_16x16x32_bf16 a[84:87], v[48:51], v[72:75], 0
    v_mfma_f32_16x16x32_bf16 a[84:87], v[52:55], v[76:79], a[84:87]
    v_mfma_f32_16x16x32_bf16 a[88:91], v[48:51], v[80:83], 0
    buffer_load_dwordx4 v12, s[20:23], s63 offen offset:2048 lds
    v_mfma_f32_16x16x32_bf16 a[88:91], v[52:55], v[84:87], a[88:91]
    ds_read_b128 v[124:127], v25 offset:57344
    v_mfma_f32_16x16x32_bf16 a[92:95], v[48:51], v[88:91], 0
    s_add_u32 s72, s70, 45056
    v_mfma_f32_16x16x32_bf16 a[92:95], v[52:55], v[92:95], a[92:95]
    v_mfma_f32_16x16x32_bf16 a[132:135], v[48:51], a[136:139], 0
    buffer_load_dwordx4 v13, s[20:23], s63 offen offset:3072 lds
    v_mfma_f32_16x16x32_bf16 a[132:135], v[52:55], a[140:143], a[132:135]
    s_waitcnt lgkmcnt(1)
    v_mfma_f32_16x16x32_bf16 a[96:99], v[56:59], v[64:67], 0
    v_mfma_f32_16x16x32_bf16 a[96:99], v[60:63], v[68:71], a[96:99]
    s_xor_b32 s63, s63, 896
    v_mfma_f32_16x16x32_bf16 a[100:103], v[56:59], v[72:75], 0
    buffer_store_dwordx4 a[56:59], v1, s[36:39], s72 offen sc1
    v_mfma_f32_16x16x32_bf16 a[100:103], v[60:63], v[76:79], a[100:103]
    v_mfma_f32_16x16x32_bf16 a[104:107], v[56:59], v[80:83], 0
    v_accvgpr_write_b32 a56, 0
    v_accvgpr_write_b32 a57, 0
    v_mfma_f32_16x16x32_bf16 a[104:107], v[60:63], v[84:87], a[104:107]
    s_waitcnt vmcnt(10) lgkmcnt(0)
    s_barrier
    ds_read_b64_tr_b16 v[48:49], v14 offset:0
    v_mfma_f32_16x16x32_bf16 a[108:111], v[56:59], v[88:91], 0
    s_add_u32 m0, s67, 65536
    ds_read_b64_tr_b16 v[50:51], v14 offset:1024
    ds_read_b64_tr_b16 v[52:53], v14 offset:8192
    v_mfma_f32_16x16x32_bf16 a[108:111], v[60:63], v[92:95], a[108:111]
    buffer_load_dwordx4 v1, s[28:31], s65 offen sc1 lds
    v_mfma_f32_16x16x32_bf16 a[112:115], v[40:43], v[64:67], 0
    ds_read_b64_tr_b16 v[54:55], v14 offset:9216
    ds_read_b64_tr_b16 v[56:57], v15 offset:0
    v_mfma_f32_16x16x32_bf16 a[112:115], v[44:47], v[68:71], a[112:115]
    ds_read_b64_tr_b16 v[58:59], v15 offset:1024
    ds_read_b64_tr_b16 v[60:61], v15 offset:8192
    v_mfma_f32_16x16x32_bf16 a[116:119], v[40:43], v[72:75], 0
    ds_read_b64_tr_b16 v[62:63], v15 offset:9216
    ds_read_b128 a[136:139], v22 offset:0
    v_mfma_f32_16x16x32_bf16 a[116:119], v[44:47], v[76:79], a[116:119]
    ds_read_b128 a[140:143], v23 offset:0
    v_add_u32 v14, 0xfffe0000, v14
    v_mfma_f32_16x16x32_bf16 a[120:123], v[40:43], v[80:83], 0
    v_add_u32 v15, 0xfffe0000, v15
    v_add_u32 v22, 0x10000, v22
    v_mfma_f32_16x16x32_bf16 a[120:123], v[44:47], v[84:87], a[120:123]
    v_add_u32 v23, 0x10000, v23
    v_accvgpr_write_b32 a58, 0
    v_mfma_f32_16x16x32_bf16 a[124:127], v[40:43], v[88:91], 0
    buffer_load_dwordx4 v1, s[28:31], s65 offen offset:1024 sc1 lds
    v_mfma_f32_16x16x32_bf16 a[124:127], v[44:47], v[92:95], a[124:127]
    s_waitcnt lgkmcnt(1)
    ds_read_b64_tr_b16 v[40:41], v16 offset:0
    ds_read_b64_tr_b16 v[42:43], v16 offset:1024
    v_mfma_f32_16x16x32_bf16 v[128:131], v[48:51], v[96:99], v[128:131]
    ds_read_b64_tr_b16 v[44:45], v16 offset:8192
    ds_read_b64_tr_b16 v[46:47], v16 offset:9216
    v_mfma_f32_16x16x32_bf16 v[128:131], v[52:55], v[100:103], v[128:131]
    v_add_u32 v24, 0x10000, v24
    v_add_u32 v16, 0xfffe0000, v16
    v_mfma_f32_16x16x32_bf16 v[132:135], v[48:51], v[104:107], v[132:135]
    ds_read_b128 v[64:67], v24 offset:16384
    v_accvgpr_write_b32 a59, 0
    v_mfma_f32_16x16x32_bf16 v[132:135], v[52:55], v[108:111], v[132:135]
    v_mfma_f32_16x16x32_bf16 v[136:139], v[48:51], v[112:115], v[136:139]
    v_mfma_f32_16x16x32_bf16 v[136:139], v[52:55], v[116:119], v[136:139]
    s_add_u32 s72, s70, 1024
    v_mfma_f32_16x16x32_bf16 v[140:143], v[48:51], v[120:123], v[140:143]
    s_add_u32 m0, s68, 73728
    ds_read_b64_tr_b16 v[48:49], v17 offset:0
    ds_read_b64_tr_b16 v[50:51], v17 offset:1024
    v_mfma_f32_16x16x32_bf16 v[140:143], v[52:55], v[124:127], v[140:143]
    buffer_load_dwordx4 v6, s[20:23], s66 offen lds
    v_mfma_f32_16x16x32_bf16 v[144:147], v[56:59], v[96:99], v[144:147]
    ds_read_b64_tr_b16 v[52:53], v17 offset:8192
    ds_read_b64_tr_b16 v[54:55], v17 offset:9216
    v_mfma_f32_16x16x32_bf16 v[144:147], v[60:63], v[100:103], v[144:147]
    buffer_store_dwordx4 a[4:7], v1, s[36:39], s72 offen sc1
    v_mfma_f32_16x16x32_bf16 v[148:151], v[56:59], v[104:107], v[148:151]
    v_add_u32 v17, 0xfffe0000, v17
    v_accvgpr_write_b32 a4, 0
    v_mfma_f32_16x16x32_bf16 v[148:151], v[60:63], v[108:111], v[148:151]
    v_accvgpr_write_b32 a5, 0
    v_accvgpr_write_b32 a6, 0
    v_mfma_f32_16x16x32_bf16 v[152:155], v[56:59], v[112:115], v[152:155]
    v_add_u32 v25, 0x10000, v25
    v_accvgpr_write_b32 a7, 0
    v_mfma_f32_16x16x32_bf16 v[152:155], v[60:63], v[116:119], v[152:155]
    ds_read_b128 v[68:71], v25 offset:16384
    v_mfma_f32_16x16x32_bf16 v[156:159], v[56:59], v[120:123], v[156:159]
    s_add_u32 m0, s69, 81920
    ds_read_b64_tr_b16 v[56:57], v18 offset:0
    ds_read_b64_tr_b16 v[58:59], v18 offset:1024
    v_mfma_f32_16x16x32_bf16 v[156:159], v[60:63], v[124:127], v[156:159]
    s_xor_b32 s65, s65, 8192
    buffer_load_dwordx4 v10, s[20:23], s64 offen lds
    s_waitcnt lgkmcnt(3)
    v_mfma_f32_16x16x32_bf16 v[160:163], v[40:43], v[96:99], v[160:163]
    s_xor_b32 s66, s66, 128
    ds_read_b64_tr_b16 v[60:61], v18 offset:8192
    ds_read_b64_tr_b16 v[62:63], v18 offset:9216
    v_mfma_f32_16x16x32_bf16 v[160:163], v[44:47], v[100:103], v[160:163]
    v_add_u32 v18, 0xfffe0000, v18
    v_mfma_f32_16x16x32_bf16 v[164:167], v[40:43], v[104:107], v[164:167]
    v_mfma_f32_16x16x32_bf16 v[164:167], v[44:47], v[108:111], v[164:167]
    v_mfma_f32_16x16x32_bf16 v[168:171], v[40:43], v[112:115], v[168:171]
    v_mfma_f32_16x16x32_bf16 v[168:171], v[44:47], v[116:119], v[168:171]
    v_mfma_f32_16x16x32_bf16 v[172:175], v[40:43], v[120:123], v[172:175]
    ds_read_b64_tr_b16 v[40:41], v19 offset:0
    ds_read_b64_tr_b16 v[42:43], v19 offset:1024
    v_mfma_f32_16x16x32_bf16 v[172:175], v[44:47], v[124:127], v[172:175]
    ds_read_b64_tr_b16 v[44:45], v19 offset:8192
    ds_read_b64_tr_b16 v[46:47], v19 offset:9216
    v_mfma_f32_16x16x32_bf16 v[176:179], v[48:51], v[96:99], v[176:179]
    buffer_load_dwordx4 v11, s[20:23], s64 offen offset:1024 lds
    v_mfma_f32_16x16x32_bf16 v[176:179], v[52:55], v[100:103], v[176:179]
    ds_read_b128 v[72:75], v24 offset:24576
    v_add_u32 v19, 0xfffe0000, v19
    v_mfma_f32_16x16x32_bf16 v[180:183], v[48:51], v[104:107], v[180:183]
    v_mfma_f32_16x16x32_bf16 v[180:183], v[52:55], v[108:111], v[180:183]
    v_mfma_f32_16x16x32_bf16 v[184:187], v[48:51], v[112:115], v[184:187]
    v_mfma_f32_16x16x32_bf16 v[184:187], v[52:55], v[116:119], v[184:187]
    v_mfma_f32_16x16x32_bf16 v[188:191], v[48:51], v[120:123], v[188:191]
    s_add_u32 s72, s70, 5120
    ds_read_b64_tr_b16 v[48:49], v20 offset:0
    ds_read_b64_tr_b16 v[50:51], v20 offset:1024
    v_mfma_f32_16x16x32_bf16 v[188:191], v[52:55], v[124:127], v[188:191]
    s_waitcnt lgkmcnt(2)
    ds_read_b64_tr_b16 v[52:53], v20 offset:8192
    ds_read_b64_tr_b16 v[54:55], v20 offset:9216
    v_mfma_f32_16x16x32_bf16 v[192:195], v[56:59], v[96:99], v[192:195]
    buffer_load_dwordx4 v12, s[20:23], s64 offen offset:2048 lds
    v_mfma_f32_16x16x32_bf16 v[192:195], v[60:63], v[100:103], v[192:195]
    buffer_store_dwordx4 a[12:15], v1, s[36:39], s72 offen sc1
    v_mfma_f32_16x16x32_bf16 v[196:199], v[56:59], v[104:107], v[196:199]
    v_add_u32 v20, 0xfffe0000, v20
    v_accvgpr_write_b32 a12, 0
    v_mfma_f32_16x16x32_bf16 v[196:199], v[60:63], v[108:111], v[196:199]
    ds_read_b128 v[76:79], v25 offset:24576
    v_accvgpr_write_b32 a13, 0
    v_mfma_f32_16x16x32_bf16 v[200:203], v[56:59], v[112:115], v[200:203]
    v_accvgpr_write_b32 a14, 0
    v_accvgpr_write_b32 a15, 0
    v_mfma_f32_16x16x32_bf16 v[200:203], v[60:63], v[116:119], v[200:203]
    v_mfma_f32_16x16x32_bf16 v[204:207], v[56:59], v[120:123], v[204:207]
    ds_read_b64_tr_b16 v[56:57], v21 offset:0
    ds_read_b64_tr_b16 v[58:59], v21 offset:1024
    v_mfma_f32_16x16x32_bf16 v[204:207], v[60:63], v[124:127], v[204:207]
    ds_read_b64_tr_b16 v[60:61], v21 offset:8192
    ds_read_b64_tr_b16 v[62:63], v21 offset:9216
    v_mfma_f32_16x16x32_bf16 v[208:211], v[40:43], v[96:99], v[208:211]
    v_add_u32 v21, 0xfffe0000, v21
    v_mfma_f32_16x16x32_bf16 v[208:211], v[44:47], v[100:103], v[208:211]
    buffer_load_dwordx4 v13, s[20:23], s64 offen offset:3072 lds
    v_mfma_f32_16x16x32_bf16 v[212:215], v[40:43], v[104:107], v[212:215]
    v_mfma_f32_16x16x32_bf16 v[212:215], v[44:47], v[108:111], v[212:215]
    v_mfma_f32_16x16x32_bf16 v[216:219], v[40:43], v[112:115], v[216:219]
    v_mfma_f32_16x16x32_bf16 v[216:219], v[44:47], v[116:119], v[216:219]
    v_mfma_f32_16x16x32_bf16 v[220:223], v[40:43], v[120:123], v[220:223]
    ds_read_b64_tr_b16 v[40:41], v26 offset:0
    ds_read_b64_tr_b16 v[42:43], v26 offset:512
    v_mfma_f32_16x16x32_bf16 v[220:223], v[44:47], v[124:127], v[220:223]
    s_waitcnt lgkmcnt(2)
    ds_read_b64_tr_b16 v[44:45], v26 offset:4096
    ds_read_b64_tr_b16 v[46:47], v26 offset:4608
    v_mfma_f32_16x16x32_bf16 v[224:227], v[48:51], v[96:99], v[224:227]
    v_add_u32 v26, 0x10000, v26
    v_mfma_f32_16x16x32_bf16 v[224:227], v[52:55], v[100:103], v[224:227]
    s_xor_b32 s64, s64, 896
    v_mfma_f32_16x16x32_bf16 v[228:231], v[48:51], v[104:107], v[228:231]
    v_mfma_f32_16x16x32_bf16 v[228:231], v[52:55], v[108:111], v[228:231]
    v_mfma_f32_16x16x32_bf16 v[232:235], v[48:51], v[112:115], v[232:235]
    v_mfma_f32_16x16x32_bf16 v[232:235], v[52:55], v[116:119], v[232:235]
    s_add_u32 m0, s69, 98304
    v_mfma_f32_16x16x32_bf16 v[236:239], v[48:51], v[120:123], v[236:239]
    buffer_load_dwordx4 v2, s[24:27], s60 offen lds
    v_mfma_f32_16x16x32_bf16 v[236:239], v[52:55], v[124:127], v[236:239]
    s_add_u32 s72, s70, 9216
    ds_read_b64_tr_b16 v[48:49], v27 offset:0
    ds_read_b64_tr_b16 v[50:51], v27 offset:512
    v_mfma_f32_16x16x32_bf16 v[240:243], v[56:59], v[96:99], v[240:243]
    ds_read_b64_tr_b16 v[52:53], v27 offset:4096
    ds_read_b64_tr_b16 v[54:55], v27 offset:4608
    v_mfma_f32_16x16x32_bf16 v[240:243], v[60:63], v[100:103], v[240:243]
    buffer_store_dwordx4 a[20:23], v1, s[36:39], s72 offen sc1
    v_mfma_f32_16x16x32_bf16 v[244:247], v[56:59], v[104:107], v[244:247]
    buffer_load_dwordx4 v3, s[24:27], s60 offen offset:1024 lds
    v_mfma_f32_16x16x32_bf16 v[244:247], v[60:63], v[108:111], v[244:247]
    v_add_u32 v27, 0x10000, v27
    v_accvgpr_write_b32 a20, 0
    v_mfma_f32_16x16x32_bf16 v[248:251], v[56:59], v[112:115], v[248:251]
    v_accvgpr_write_b32 a21, 0
    v_accvgpr_write_b32 a22, 0
    v_mfma_f32_16x16x32_bf16 v[248:251], v[60:63], v[116:119], v[248:251]
    v_accvgpr_write_b32 a23, 0
    v_mfma_f32_16x16x32_bf16 v[252:255], v[56:59], v[120:123], v[252:255]
    buffer_load_dwordx4 v4, s[24:27], s60 offen offset:2048 lds
    v_mfma_f32_16x16x32_bf16 v[252:255], v[60:63], v[124:127], v[252:255]
    s_waitcnt lgkmcnt(0)
    ds_read_b64_tr_b16 v[56:57], v28 offset:0
    ds_read_b64_tr_b16 v[58:59], v28 offset:512
    v_mfma_f32_16x16x32_bf16 a[64:67], v[40:43], v[96:99], a[64:67]
    ds_read_b64_tr_b16 v[60:61], v28 offset:4096
    ds_read_b64_tr_b16 v[62:63], v28 offset:4608
    v_mfma_f32_16x16x32_bf16 a[64:67], v[44:47], v[100:103], a[64:67]
    v_add_u32 v24, 0xfffe0000, v24
    v_add_u32 v28, 0x10000, v28
    v_mfma_f32_16x16x32_bf16 a[68:71], v[40:43], v[104:107], a[68:71]
    buffer_load_dwordx4 v5, s[24:27], s60 offen offset:3072 lds
    v_mfma_f32_16x16x32_bf16 a[68:71], v[44:47], v[108:111], a[68:71]
    ds_read_b128 v[80:83], v24 offset:16384
    v_mfma_f32_16x16x32_bf16 a[72:75], v[40:43], v[112:115], a[72:75]
    v_mfma_f32_16x16x32_bf16 a[72:75], v[44:47], v[116:119], a[72:75]
    s_add_u32 m0, s69, 114688
    v_add_u32 v25, 0xfffe0000, v25
    v_mfma_f32_16x16x32_bf16 a[76:79], v[40:43], v[120:123], a[76:79]
    s_xor_b32 s60, s60, 3670016
    buffer_load_dwordx4 v10, s[20:23], s63 offen lds
    v_mfma_f32_16x16x32_bf16 a[76:79], v[44:47], v[124:127], a[76:79]
    ds_read_b128 v[84:87], v25 offset:16384
    v_mfma_f32_16x16x32_bf16 a[128:131], v[40:43], a[136:139], a[128:131]
    ds_read_b64_tr_b16 v[40:41], v29 offset:0
    ds_read_b64_tr_b16 v[42:43], v29 offset:512
    v_mfma_f32_16x16x32_bf16 a[128:131], v[44:47], a[140:143], a[128:131]
    ds_read_b64_tr_b16 v[44:45], v29 offset:4096
    ds_read_b64_tr_b16 v[46:47], v29 offset:4608
    v_mfma_f32_16x16x32_bf16 a[80:83], v[48:51], v[96:99], a[80:83]
    buffer_load_dwordx4 v11, s[20:23], s63 offen offset:1024 lds
    v_mfma_f32_16x16x32_bf16 a[80:83], v[52:55], v[100:103], a[80:83]
    ds_read_b128 v[88:91], v24 offset:24576
    v_add_u32 v29, 0x10000, v29
    v_mfma_f32_16x16x32_bf16 a[84:87], v[48:51], v[104:107], a[84:87]
    v_mfma_f32_16x16x32_bf16 a[84:87], v[52:55], v[108:111], a[84:87]
    v_mfma_f32_16x16x32_bf16 a[88:91], v[48:51], v[112:115], a[88:91]
    buffer_load_dwordx4 v12, s[20:23], s63 offen offset:2048 lds
    v_mfma_f32_16x16x32_bf16 a[88:91], v[52:55], v[116:119], a[88:91]
    ds_read_b128 v[92:95], v25 offset:24576
    v_mfma_f32_16x16x32_bf16 a[92:95], v[48:51], v[120:123], a[92:95]
    s_add_u32 s72, s70, 13312
    v_mfma_f32_16x16x32_bf16 a[92:95], v[52:55], v[124:127], a[92:95]
    v_mfma_f32_16x16x32_bf16 a[132:135], v[48:51], a[136:139], a[132:135]
    buffer_load_dwordx4 v13, s[20:23], s63 offen offset:3072 lds
    v_mfma_f32_16x16x32_bf16 a[132:135], v[52:55], a[140:143], a[132:135]
    s_waitcnt lgkmcnt(1)
    v_mfma_f32_16x16x32_bf16 a[96:99], v[56:59], v[96:99], a[96:99]
    v_mfma_f32_16x16x32_bf16 a[96:99], v[60:63], v[100:103], a[96:99]
    s_xor_b32 s63, s63, 128
    v_mfma_f32_16x16x32_bf16 a[100:103], v[56:59], v[104:107], a[100:103]
    buffer_store_dwordx4 a[28:31], v1, s[36:39], s72 offen sc1
    v_mfma_f32_16x16x32_bf16 a[100:103], v[60:63], v[108:111], a[100:103]
    v_mfma_f32_16x16x32_bf16 a[104:107], v[56:59], v[112:115], a[104:107]
    v_accvgpr_write_b32 a28, 0
    v_accvgpr_write_b32 a29, 0
    v_mfma_f32_16x16x32_bf16 a[104:107], v[60:63], v[116:119], a[104:107]
    s_waitcnt vmcnt(10) lgkmcnt(0)
    s_barrier
    ds_read_b64_tr_b16 v[48:49], v14 offset:32768
    v_mfma_f32_16x16x32_bf16 a[108:111], v[56:59], v[120:123], a[108:111]
    s_add_u32 m0, s67, 131072
    ds_read_b64_tr_b16 v[50:51], v14 offset:33792
    ds_read_b64_tr_b16 v[52:53], v14 offset:40960
    v_mfma_f32_16x16x32_bf16 a[108:111], v[60:63], v[124:127], a[108:111]
    buffer_load_dwordx4 v1, s[28:31], s65 offen sc1 lds
    v_mfma_f32_16x16x32_bf16 a[112:115], v[40:43], v[96:99], a[112:115]
    ds_read_b64_tr_b16 v[54:55], v14 offset:41984
    ds_read_b64_tr_b16 v[56:57], v15 offset:32768
    v_mfma_f32_16x16x32_bf16 a[112:115], v[44:47], v[100:103], a[112:115]
    ds_read_b64_tr_b16 v[58:59], v15 offset:33792
    ds_read_b64_tr_b16 v[60:61], v15 offset:40960
    v_mfma_f32_16x16x32_bf16 a[116:119], v[40:43], v[104:107], a[116:119]
    ds_read_b64_tr_b16 v[62:63], v15 offset:41984
    ds_read_b128 a[136:139], v22 offset:0
    v_mfma_f32_16x16x32_bf16 a[116:119], v[44:47], v[108:111], a[116:119]
    ds_read_b128 a[140:143], v23 offset:0
    v_add_u32 v14, 0x10000, v14
    v_mfma_f32_16x16x32_bf16 a[120:123], v[40:43], v[112:115], a[120:123]
    v_add_u32 v15, 0x10000, v15
    v_add_u32 v22, 0x10000, v22
    v_mfma_f32_16x16x32_bf16 a[120:123], v[44:47], v[116:119], a[120:123]
    v_add_u32 v23, 0x10000, v23
    v_accvgpr_write_b32 a30, 0
    v_mfma_f32_16x16x32_bf16 a[124:127], v[40:43], v[120:123], a[124:127]
    buffer_load_dwordx4 v1, s[28:31], s65 offen offset:1024 sc1 lds
    v_mfma_f32_16x16x32_bf16 a[124:127], v[44:47], v[124:127], a[124:127]
    s_waitcnt lgkmcnt(1)
    ds_read_b64_tr_b16 v[40:41], v16 offset:32768
    ds_read_b64_tr_b16 v[42:43], v16 offset:33792
    v_mfma_f32_16x16x32_bf16 v[128:131], v[48:51], v[64:67], v[128:131]
    ds_read_b64_tr_b16 v[44:45], v16 offset:40960
    ds_read_b64_tr_b16 v[46:47], v16 offset:41984
    v_mfma_f32_16x16x32_bf16 v[128:131], v[52:55], v[68:71], v[128:131]
    v_add_u32 v16, 0x10000, v16
    v_accvgpr_write_b32 a31, 0
    v_mfma_f32_16x16x32_bf16 v[132:135], v[48:51], v[72:75], v[132:135]
    ds_read_b128 v[96:99], v24 offset:49152
    v_mfma_f32_16x16x32_bf16 v[132:135], v[52:55], v[76:79], v[132:135]
    v_mfma_f32_16x16x32_bf16 v[136:139], v[48:51], v[80:83], v[136:139]
    v_mfma_f32_16x16x32_bf16 v[136:139], v[52:55], v[84:87], v[136:139]
    s_add_u32 s72, s70, 33792
    v_mfma_f32_16x16x32_bf16 v[140:143], v[48:51], v[88:91], v[140:143]
    s_add_u32 m0, s68, 139264
    ds_read_b64_tr_b16 v[48:49], v17 offset:32768
    ds_read_b64_tr_b16 v[50:51], v17 offset:33792
    v_mfma_f32_16x16x32_bf16 v[140:143], v[52:55], v[92:95], v[140:143]
    buffer_load_dwordx4 v6, s[20:23], s66 offen lds
    v_mfma_f32_16x16x32_bf16 v[144:147], v[56:59], v[64:67], v[144:147]
    ds_read_b64_tr_b16 v[52:53], v17 offset:40960
    ds_read_b64_tr_b16 v[54:55], v17 offset:41984
    v_mfma_f32_16x16x32_bf16 v[144:147], v[60:63], v[68:71], v[144:147]
    buffer_store_dwordx4 a[36:39], v1, s[36:39], s72 offen sc1
    v_mfma_f32_16x16x32_bf16 v[148:151], v[56:59], v[72:75], v[148:151]
    v_add_u32 v17, 0x10000, v17
    v_accvgpr_write_b32 a36, 0
    v_mfma_f32_16x16x32_bf16 v[148:151], v[60:63], v[76:79], v[148:151]
    v_accvgpr_write_b32 a37, 0
    v_accvgpr_write_b32 a38, 0
    v_mfma_f32_16x16x32_bf16 v[152:155], v[56:59], v[80:83], v[152:155]
    v_accvgpr_write_b32 a39, 0
    v_mfma_f32_16x16x32_bf16 v[152:155], v[60:63], v[84:87], v[152:155]
    ds_read_b128 v[100:103], v25 offset:49152
    v_mfma_f32_16x16x32_bf16 v[156:159], v[56:59], v[88:91], v[156:159]
    s_add_u32 m0, s69, 147456
    ds_read_b64_tr_b16 v[56:57], v18 offset:32768
    ds_read_b64_tr_b16 v[58:59], v18 offset:33792
    v_mfma_f32_16x16x32_bf16 v[156:159], v[60:63], v[92:95], v[156:159]
    s_xor_b32 s65, s65, 57344
    buffer_load_dwordx4 v10, s[20:23], s64 offen lds
    s_waitcnt lgkmcnt(3)
    v_mfma_f32_16x16x32_bf16 v[160:163], v[40:43], v[64:67], v[160:163]
    s_xor_b32 s66, s66, 896
    ds_read_b64_tr_b16 v[60:61], v18 offset:40960
    ds_read_b64_tr_b16 v[62:63], v18 offset:41984
    v_mfma_f32_16x16x32_bf16 v[160:163], v[44:47], v[68:71], v[160:163]
    v_add_u32 v18, 0x10000, v18
    v_mfma_f32_16x16x32_bf16 v[164:167], v[40:43], v[72:75], v[164:167]
    v_mfma_f32_16x16x32_bf16 v[164:167], v[44:47], v[76:79], v[164:167]
    v_mfma_f32_16x16x32_bf16 v[168:171], v[40:43], v[80:83], v[168:171]
    v_mfma_f32_16x16x32_bf16 v[168:171], v[44:47], v[84:87], v[168:171]
    v_mfma_f32_16x16x32_bf16 v[172:175], v[40:43], v[88:91], v[172:175]
    ds_read_b64_tr_b16 v[40:41], v19 offset:32768
    ds_read_b64_tr_b16 v[42:43], v19 offset:33792
    v_mfma_f32_16x16x32_bf16 v[172:175], v[44:47], v[92:95], v[172:175]
    ds_read_b64_tr_b16 v[44:45], v19 offset:40960
    ds_read_b64_tr_b16 v[46:47], v19 offset:41984
    v_mfma_f32_16x16x32_bf16 v[176:179], v[48:51], v[64:67], v[176:179]
    buffer_load_dwordx4 v11, s[20:23], s64 offen offset:1024 lds
    v_mfma_f32_16x16x32_bf16 v[176:179], v[52:55], v[68:71], v[176:179]
    ds_read_b128 v[104:107], v24 offset:57344
    v_add_u32 v19, 0x10000, v19
    v_mfma_f32_16x16x32_bf16 v[180:183], v[48:51], v[72:75], v[180:183]
    v_mfma_f32_16x16x32_bf16 v[180:183], v[52:55], v[76:79], v[180:183]
    v_mfma_f32_16x16x32_bf16 v[184:187], v[48:51], v[80:83], v[184:187]
    v_mfma_f32_16x16x32_bf16 v[184:187], v[52:55], v[84:87], v[184:187]
    v_mfma_f32_16x16x32_bf16 v[188:191], v[48:51], v[88:91], v[188:191]
    s_add_u32 s72, s70, 37888
    ds_read_b64_tr_b16 v[48:49], v20 offset:32768
    ds_read_b64_tr_b16 v[50:51], v20 offset:33792
    v_mfma_f32_16x16x32_bf16 v[188:191], v[52:55], v[92:95], v[188:191]
    s_waitcnt lgkmcnt(2)
    ds_read_b64_tr_b16 v[52:53], v20 offset:40960
    ds_read_b64_tr_b16 v[54:55], v20 offset:41984
    v_mfma_f32_16x16x32_bf16 v[192:195], v[56:59], v[64:67], v[192:195]
    buffer_load_dwordx4 v12, s[20:23], s64 offen offset:2048 lds
    v_mfma_f32_16x16x32_bf16 v[192:195], v[60:63], v[68:71], v[192:195]
    buffer_store_dwordx4 a[44:47], v1, s[36:39], s72 offen sc1
    v_mfma_f32_16x16x32_bf16 v[196:199], v[56:59], v[72:75], v[196:199]
    v_add_u32 v20, 0x10000, v20
    v_accvgpr_write_b32 a44, 0
    v_mfma_f32_16x16x32_bf16 v[196:199], v[60:63], v[76:79], v[196:199]
    ds_read_b128 v[108:111], v25 offset:57344
    v_accvgpr_write_b32 a45, 0
    v_mfma_f32_16x16x32_bf16 v[200:203], v[56:59], v[80:83], v[200:203]
    v_accvgpr_write_b32 a46, 0
    v_accvgpr_write_b32 a47, 0
    v_mfma_f32_16x16x32_bf16 v[200:203], v[60:63], v[84:87], v[200:203]
    v_mfma_f32_16x16x32_bf16 v[204:207], v[56:59], v[88:91], v[204:207]
    ds_read_b64_tr_b16 v[56:57], v21 offset:32768
    ds_read_b64_tr_b16 v[58:59], v21 offset:33792
    v_mfma_f32_16x16x32_bf16 v[204:207], v[60:63], v[92:95], v[204:207]
    ds_read_b64_tr_b16 v[60:61], v21 offset:40960
    ds_read_b64_tr_b16 v[62:63], v21 offset:41984
    v_mfma_f32_16x16x32_bf16 v[208:211], v[40:43], v[64:67], v[208:211]
    v_add_u32 v21, 0x10000, v21
    v_mfma_f32_16x16x32_bf16 v[208:211], v[44:47], v[68:71], v[208:211]
    buffer_load_dwordx4 v13, s[20:23], s64 offen offset:3072 lds
    v_mfma_f32_16x16x32_bf16 v[212:215], v[40:43], v[72:75], v[212:215]
    v_mfma_f32_16x16x32_bf16 v[212:215], v[44:47], v[76:79], v[212:215]
    v_mfma_f32_16x16x32_bf16 v[216:219], v[40:43], v[80:83], v[216:219]
    v_mfma_f32_16x16x32_bf16 v[216:219], v[44:47], v[84:87], v[216:219]
    v_mfma_f32_16x16x32_bf16 v[220:223], v[40:43], v[88:91], v[220:223]
    ds_read_b64_tr_b16 v[40:41], v26 offset:0
    ds_read_b64_tr_b16 v[42:43], v26 offset:512
    v_mfma_f32_16x16x32_bf16 v[220:223], v[44:47], v[92:95], v[220:223]
    s_waitcnt lgkmcnt(2)
    ds_read_b64_tr_b16 v[44:45], v26 offset:4096
    ds_read_b64_tr_b16 v[46:47], v26 offset:4608
    v_mfma_f32_16x16x32_bf16 v[224:227], v[48:51], v[64:67], v[224:227]
    v_add_u32 v26, 0x10000, v26
    v_mfma_f32_16x16x32_bf16 v[224:227], v[52:55], v[68:71], v[224:227]
    s_xor_b32 s64, s64, 128
    v_mfma_f32_16x16x32_bf16 v[228:231], v[48:51], v[72:75], v[228:231]
    v_mfma_f32_16x16x32_bf16 v[228:231], v[52:55], v[76:79], v[228:231]
    v_mfma_f32_16x16x32_bf16 v[232:235], v[48:51], v[80:83], v[232:235]
    v_mfma_f32_16x16x32_bf16 v[232:235], v[52:55], v[84:87], v[232:235]
    s_add_u32 m0, s69, 0
    v_mfma_f32_16x16x32_bf16 v[236:239], v[48:51], v[88:91], v[236:239]
    buffer_load_dwordx4 v2, s[24:27], s60 offen lds
    v_mfma_f32_16x16x32_bf16 v[236:239], v[52:55], v[92:95], v[236:239]
    s_add_u32 s72, s70, 41984
    ds_read_b64_tr_b16 v[48:49], v27 offset:0
    ds_read_b64_tr_b16 v[50:51], v27 offset:512
    v_mfma_f32_16x16x32_bf16 v[240:243], v[56:59], v[64:67], v[240:243]
    ds_read_b64_tr_b16 v[52:53], v27 offset:4096
    ds_read_b64_tr_b16 v[54:55], v27 offset:4608
    v_mfma_f32_16x16x32_bf16 v[240:243], v[60:63], v[68:71], v[240:243]
    buffer_store_dwordx4 a[52:55], v1, s[36:39], s72 offen sc1
    v_mfma_f32_16x16x32_bf16 v[244:247], v[56:59], v[72:75], v[244:247]
    buffer_load_dwordx4 v3, s[24:27], s60 offen offset:1024 lds
    v_mfma_f32_16x16x32_bf16 v[244:247], v[60:63], v[76:79], v[244:247]
    v_add_u32 v27, 0x10000, v27
    v_accvgpr_write_b32 a52, 0
    v_mfma_f32_16x16x32_bf16 v[248:251], v[56:59], v[80:83], v[248:251]
    v_accvgpr_write_b32 a53, 0
    v_accvgpr_write_b32 a54, 0
    v_mfma_f32_16x16x32_bf16 v[248:251], v[60:63], v[84:87], v[248:251]
    v_accvgpr_write_b32 a55, 0
    v_mfma_f32_16x16x32_bf16 v[252:255], v[56:59], v[88:91], v[252:255]
    buffer_load_dwordx4 v4, s[24:27], s60 offen offset:2048 lds
    v_mfma_f32_16x16x32_bf16 v[252:255], v[60:63], v[92:95], v[252:255]
    s_waitcnt lgkmcnt(0)
    ds_read_b64_tr_b16 v[56:57], v28 offset:0
    ds_read_b64_tr_b16 v[58:59], v28 offset:512
    v_mfma_f32_16x16x32_bf16 a[64:67], v[40:43], v[64:67], a[64:67]
    ds_read_b64_tr_b16 v[60:61], v28 offset:4096
    ds_read_b64_tr_b16 v[62:63], v28 offset:4608
    v_mfma_f32_16x16x32_bf16 a[64:67], v[44:47], v[68:71], a[64:67]
    v_add_u32 v24, 0x10000, v24
    v_add_u32 v28, 0x10000, v28
    v_mfma_f32_16x16x32_bf16 a[68:71], v[40:43], v[72:75], a[68:71]
    buffer_load_dwordx4 v5, s[24:27], s60 offen offset:3072 lds
    v_mfma_f32_16x16x32_bf16 a[68:71], v[44:47], v[76:79], a[68:71]
    ds_read_b128 v[112:115], v24 offset:16384
    v_mfma_f32_16x16x32_bf16 a[72:75], v[40:43], v[80:83], a[72:75]
    v_mfma_f32_16x16x32_bf16 a[72:75], v[44:47], v[84:87], a[72:75]
    s_add_u32 m0, s69, 16384
    v_add_u32 v25, 0x10000, v25
    v_mfma_f32_16x16x32_bf16 a[76:79], v[40:43], v[88:91], a[76:79]
    s_xor_b32 s60, s60, 524288
    buffer_load_dwordx4 v10, s[20:23], s63 offen lds
    v_mfma_f32_16x16x32_bf16 a[76:79], v[44:47], v[92:95], a[76:79]
    ds_read_b128 v[116:119], v25 offset:16384
    v_mfma_f32_16x16x32_bf16 a[128:131], v[40:43], a[136:139], a[128:131]
    ds_read_b64_tr_b16 v[40:41], v29 offset:0
    ds_read_b64_tr_b16 v[42:43], v29 offset:512
    v_mfma_f32_16x16x32_bf16 a[128:131], v[44:47], a[140:143], a[128:131]
    ds_read_b64_tr_b16 v[44:45], v29 offset:4096
    ds_read_b64_tr_b16 v[46:47], v29 offset:4608
    v_mfma_f32_16x16x32_bf16 a[80:83], v[48:51], v[64:67], a[80:83]
    buffer_load_dwordx4 v11, s[20:23], s63 offen offset:1024 lds
    v_mfma_f32_16x16x32_bf16 a[80:83], v[52:55], v[68:71], a[80:83]
    ds_read_b128 v[120:123], v24 offset:24576
    v_add_u32 v29, 0x10000, v29
    v_mfma_f32_16x16x32_bf16 a[84:87], v[48:51], v[72:75], a[84:87]
    v_mfma_f32_16x16x32_bf16 a[84:87], v[52:55], v[76:79], a[84:87]
    v_mfma_f32_16x16x32_bf16 a[88:91], v[48:51], v[80:83], a[88:91]
    buffer_load_dwordx4 v12, s[20:23], s63 offen offset:2048 lds
    v_mfma_f32_16x16x32_bf16 a[88:91], v[52:55], v[84:87], a[88:91]
    ds_read_b128 v[124:127], v25 offset:24576
    v_mfma_f32_16x16x32_bf16 a[92:95], v[48:51], v[88:91], a[92:95]
    s_add_u32 s72, s70, 46080
    v_mfma_f32_16x16x32_bf16 a[92:95], v[52:55], v[92:95], a[92:95]
    v_mfma_f32_16x16x32_bf16 a[132:135], v[48:51], a[136:139], a[132:135]
    buffer_load_dwordx4 v13, s[20:23], s63 offen offset:3072 lds
    v_mfma_f32_16x16x32_bf16 a[132:135], v[52:55], a[140:143], a[132:135]
    s_waitcnt lgkmcnt(1)
    v_mfma_f32_16x16x32_bf16 a[96:99], v[56:59], v[64:67], a[96:99]
    v_mfma_f32_16x16x32_bf16 a[96:99], v[60:63], v[68:71], a[96:99]
    s_xor_b32 s63, s63, 384
    v_mfma_f32_16x16x32_bf16 a[100:103], v[56:59], v[72:75], a[100:103]
    buffer_store_dwordx4 a[60:63], v1, s[36:39], s72 offen sc1
    v_mfma_f32_16x16x32_bf16 a[100:103], v[60:63], v[76:79], a[100:103]
    v_mfma_f32_16x16x32_bf16 a[104:107], v[56:59], v[80:83], a[104:107]
    v_accvgpr_write_b32 a60, 0
    v_accvgpr_write_b32 a61, 0
    v_mfma_f32_16x16x32_bf16 a[104:107], v[60:63], v[84:87], a[104:107]
    s_waitcnt vmcnt(10) lgkmcnt(0)
    s_barrier
    ds_read_b64_tr_b16 v[48:49], v14 offset:32768
    v_mfma_f32_16x16x32_bf16 a[108:111], v[56:59], v[88:91], a[108:111]
    s_add_u32 m0, s67, 32768
    ds_read_b64_tr_b16 v[50:51], v14 offset:33792
    ds_read_b64_tr_b16 v[52:53], v14 offset:40960
    v_mfma_f32_16x16x32_bf16 a[108:111], v[60:63], v[92:95], a[108:111]
    buffer_load_dwordx4 v1, s[28:31], s65 offen sc1 lds
    v_mfma_f32_16x16x32_bf16 a[112:115], v[40:43], v[64:67], a[112:115]
    ds_read_b64_tr_b16 v[54:55], v14 offset:41984
    ds_read_b64_tr_b16 v[56:57], v15 offset:32768
    v_mfma_f32_16x16x32_bf16 a[112:115], v[44:47], v[68:71], a[112:115]
    ds_read_b64_tr_b16 v[58:59], v15 offset:33792
    ds_read_b64_tr_b16 v[60:61], v15 offset:40960
    v_mfma_f32_16x16x32_bf16 a[116:119], v[40:43], v[72:75], a[116:119]
    ds_read_b64_tr_b16 v[62:63], v15 offset:41984
    ds_read_b128 a[136:139], v22 offset:0
    v_mfma_f32_16x16x32_bf16 a[116:119], v[44:47], v[76:79], a[116:119]
    ds_read_b128 a[140:143], v23 offset:0
    v_add_u32 v14, 0xffff0000, v14
    v_mfma_f32_16x16x32_bf16 a[120:123], v[40:43], v[80:83], a[120:123]
    v_add_u32 v15, 0xffff0000, v15
    v_add_u32 v22, 0xfffe0000, v22
    v_mfma_f32_16x16x32_bf16 a[120:123], v[44:47], v[84:87], a[120:123]
    v_add_u32 v23, 0xfffe0000, v23
    v_accvgpr_read_b32 v32, a144
    v_mfma_f32_16x16x32_bf16 a[124:127], v[40:43], v[88:91], a[124:127]
    buffer_load_dwordx4 v1, s[28:31], s65 offen offset:1024 sc1 lds
    v_mfma_f32_16x16x32_bf16 a[124:127], v[44:47], v[92:95], a[124:127]
    s_waitcnt lgkmcnt(1)
    ds_read_b64_tr_b16 v[40:41], v16 offset:32768
    ds_read_b64_tr_b16 v[42:43], v16 offset:33792
    v_mfma_f32_16x16x32_bf16 v[128:131], v[48:51], v[96:99], v[128:131]
    ds_read_b64_tr_b16 v[44:45], v16 offset:40960
    ds_read_b64_tr_b16 v[46:47], v16 offset:41984
    v_mfma_f32_16x16x32_bf16 v[128:131], v[52:55], v[100:103], v[128:131]
    v_add_u32 v16, 0xffff0000, v16
    v_accvgpr_read_b32 v31, a145
    v_mfma_f32_16x16x32_bf16 v[132:135], v[48:51], v[104:107], v[132:135]
    ds_read_b128 v[64:67], v24 offset:49152
    v_cvt_pk_bf16_f32 v32, v32, v31
    v_mfma_f32_16x16x32_bf16 v[132:135], v[52:55], v[108:111], v[132:135]
    v_accvgpr_read_b32 v33, a146
    v_accvgpr_read_b32 v31, a147
    v_mfma_f32_16x16x32_bf16 v[136:139], v[48:51], v[112:115], v[136:139]
    v_cvt_pk_bf16_f32 v33, v33, v31
    v_accvgpr_read_b32 v34, a148
    v_mfma_f32_16x16x32_bf16 v[136:139], v[52:55], v[116:119], v[136:139]
    s_add_u32 s72, s71, 32768
    v_accvgpr_read_b32 v31, a149
    v_cvt_pk_bf16_f32 v34, v34, v31
    v_mfma_f32_16x16x32_bf16 v[140:143], v[48:51], v[120:123], v[140:143]
    s_add_u32 m0, s68, 40960
    ds_read_b64_tr_b16 v[48:49], v17 offset:32768
    ds_read_b64_tr_b16 v[50:51], v17 offset:33792
    v_mfma_f32_16x16x32_bf16 v[140:143], v[52:55], v[124:127], v[140:143]
    buffer_load_dwordx4 v6, s[20:23], s66 offen lds
    v_mfma_f32_16x16x32_bf16 v[144:147], v[56:59], v[96:99], v[144:147]
    ds_read_b64_tr_b16 v[52:53], v17 offset:40960
    ds_read_b64_tr_b16 v[54:55], v17 offset:41984
    v_mfma_f32_16x16x32_bf16 v[144:147], v[60:63], v[100:103], v[144:147]
    v_add_u32 v17, 0xffff0000, v17
    v_accvgpr_read_b32 v35, a150
    v_mfma_f32_16x16x32_bf16 v[148:151], v[56:59], v[104:107], v[148:151]
    v_accvgpr_read_b32 v31, a151
    v_cvt_pk_bf16_f32 v35, v35, v31
    v_mfma_f32_16x16x32_bf16 v[148:151], v[60:63], v[108:111], v[148:151]
    buffer_store_dwordx4 v[32:35], v1, s[36:39], s72 offen sc1
    v_mfma_f32_16x16x32_bf16 v[152:155], v[56:59], v[112:115], v[152:155]
    v_accvgpr_write_b32 a62, 0
    v_accvgpr_write_b32 a63, 0
    v_mfma_f32_16x16x32_bf16 v[152:155], v[60:63], v[116:119], v[152:155]
    ds_read_b128 v[68:71], v25 offset:49152
    v_accvgpr_write_b32 a144, 0
    v_mfma_f32_16x16x32_bf16 v[156:159], v[56:59], v[120:123], v[156:159]
    s_add_u32 m0, s69, 49152
    ds_read_b64_tr_b16 v[56:57], v18 offset:32768
    ds_read_b64_tr_b16 v[58:59], v18 offset:33792
    v_mfma_f32_16x16x32_bf16 v[156:159], v[60:63], v[124:127], v[156:159]
    s_xor_b32 s65, s65, 8192
    buffer_load_dwordx4 v10, s[20:23], s64 offen lds
    s_waitcnt lgkmcnt(3)
    v_mfma_f32_16x16x32_bf16 v[160:163], v[40:43], v[96:99], v[160:163]
    s_xor_b32 s66, s66, 128
    ds_read_b64_tr_b16 v[60:61], v18 offset:40960
    ds_read_b64_tr_b16 v[62:63], v18 offset:41984
    v_mfma_f32_16x16x32_bf16 v[160:163], v[44:47], v[100:103], v[160:163]
    v_add_u32 v18, 0xffff0000, v18
    v_accvgpr_write_b32 a145, 0
    v_mfma_f32_16x16x32_bf16 v[164:167], v[40:43], v[104:107], v[164:167]
    v_accvgpr_write_b32 a146, 0
    v_accvgpr_write_b32 a147, 0
    v_mfma_f32_16x16x32_bf16 v[164:167], v[44:47], v[108:111], v[164:167]
    v_accvgpr_read_b32 v32, a152
    v_accvgpr_read_b32 v31, a153
    v_mfma_f32_16x16x32_bf16 v[168:171], v[40:43], v[112:115], v[168:171]
    v_cvt_pk_bf16_f32 v32, v32, v31
    v_accvgpr_read_b32 v33, a154
    v_mfma_f32_16x16x32_bf16 v[168:171], v[44:47], v[116:119], v[168:171]
    v_accvgpr_read_b32 v31, a155
    v_cvt_pk_bf16_f32 v33, v33, v31
    v_mfma_f32_16x16x32_bf16 v[172:175], v[40:43], v[120:123], v[172:175]
    ds_read_b64_tr_b16 v[40:41], v19 offset:32768
    ds_read_b64_tr_b16 v[42:43], v19 offset:33792
    v_mfma_f32_16x16x32_bf16 v[172:175], v[44:47], v[124:127], v[172:175]
    ds_read_b64_tr_b16 v[44:45], v19 offset:40960
    ds_read_b64_tr_b16 v[46:47], v19 offset:41984
    v_mfma_f32_16x16x32_bf16 v[176:179], v[48:51], v[96:99], v[176:179]
    buffer_load_dwordx4 v11, s[20:23], s64 offen offset:1024 lds
    v_mfma_f32_16x16x32_bf16 v[176:179], v[52:55], v[100:103], v[176:179]
    ds_read_b128 v[72:75], v24 offset:57344
    v_add_u32 v19, 0xffff0000, v19
    v_mfma_f32_16x16x32_bf16 v[180:183], v[48:51], v[104:107], v[180:183]
    v_accvgpr_read_b32 v34, a156
    v_accvgpr_read_b32 v31, a157
    v_mfma_f32_16x16x32_bf16 v[180:183], v[52:55], v[108:111], v[180:183]
    v_cvt_pk_bf16_f32 v34, v34, v31
    v_accvgpr_read_b32 v35, a158
    v_mfma_f32_16x16x32_bf16 v[184:187], v[48:51], v[112:115], v[184:187]
    v_accvgpr_read_b32 v31, a159
    v_cvt_pk_bf16_f32 v35, v35, v31
    v_mfma_f32_16x16x32_bf16 v[184:187], v[52:55], v[116:119], v[184:187]
    v_accvgpr_write_b32 a148, 0
    v_accvgpr_write_b32 a149, 0
    v_mfma_f32_16x16x32_bf16 v[188:191], v[48:51], v[120:123], v[188:191]
    s_add_u32 s72, s71, 33792
    ds_read_b64_tr_b16 v[48:49], v20 offset:32768
    ds_read_b64_tr_b16 v[50:51], v20 offset:33792
    v_mfma_f32_16x16x32_bf16 v[188:191], v[52:55], v[124:127], v[188:191]
    s_waitcnt lgkmcnt(2)
    ds_read_b64_tr_b16 v[52:53], v20 offset:40960
    ds_read_b64_tr_b16 v[54:55], v20 offset:41984
    v_mfma_f32_16x16x32_bf16 v[192:195], v[56:59], v[96:99], v[192:195]
    buffer_load_dwordx4 v12, s[20:23], s64 offen offset:2048 lds
    v_mfma_f32_16x16x32_bf16 v[192:195], v[60:63], v[100:103], v[192:195]
    v_add_u32 v20, 0xffff0000, v20
    v_accvgpr_write_b32 a150, 0
    v_mfma_f32_16x16x32_bf16 v[196:199], v[56:59], v[104:107], v[196:199]
    buffer_store_dwordx4 v[32:35], v1, s[36:39], s72 offen sc1
    v_mfma_f32_16x16x32_bf16 v[196:199], v[60:63], v[108:111], v[196:199]
    ds_read_b128 v[76:79], v25 offset:57344
    v_accvgpr_write_b32 a151, 0
    v_mfma_f32_16x16x32_bf16 v[200:203], v[56:59], v[112:115], v[200:203]
    v_accvgpr_write_b32 a152, 0
    v_accvgpr_write_b32 a153, 0
    v_mfma_f32_16x16x32_bf16 v[200:203], v[60:63], v[116:119], v[200:203]
    v_accvgpr_write_b32 a154, 0
    v_accvgpr_write_b32 a155, 0
    v_mfma_f32_16x16x32_bf16 v[204:207], v[56:59], v[120:123], v[204:207]
    ds_read_b64_tr_b16 v[56:57], v21 offset:32768
    ds_read_b64_tr_b16 v[58:59], v21 offset:33792
    v_mfma_f32_16x16x32_bf16 v[204:207], v[60:63], v[124:127], v[204:207]
    ds_read_b64_tr_b16 v[60:61], v21 offset:40960
    ds_read_b64_tr_b16 v[62:63], v21 offset:41984
    v_mfma_f32_16x16x32_bf16 v[208:211], v[40:43], v[96:99], v[208:211]
    v_add_u32 v21, 0xffff0000, v21
    v_accvgpr_write_b32 a156, 0
    v_mfma_f32_16x16x32_bf16 v[208:211], v[44:47], v[100:103], v[208:211]
    buffer_load_dwordx4 v13, s[20:23], s64 offen offset:3072 lds
    v_mfma_f32_16x16x32_bf16 v[212:215], v[40:43], v[104:107], v[212:215]
    v_accvgpr_write_b32 a157, 0
    v_accvgpr_write_b32 a158, 0
    v_mfma_f32_16x16x32_bf16 v[212:215], v[44:47], v[108:111], v[212:215]
    v_accvgpr_write_b32 a159, 0
    v_mfma_f32_16x16x32_bf16 v[216:219], v[40:43], v[112:115], v[216:219]
    v_accvgpr_read_b32 v32, a160
    v_accvgpr_read_b32 v31, a161
    v_mfma_f32_16x16x32_bf16 v[216:219], v[44:47], v[116:119], v[216:219]
    v_cvt_pk_bf16_f32 v32, v32, v31
    v_accvgpr_read_b32 v33, a162
    v_mfma_f32_16x16x32_bf16 v[220:223], v[40:43], v[120:123], v[220:223]
    ds_read_b64_tr_b16 v[40:41], v26 offset:0
    ds_read_b64_tr_b16 v[42:43], v26 offset:512
    v_mfma_f32_16x16x32_bf16 v[220:223], v[44:47], v[124:127], v[220:223]
    s_waitcnt lgkmcnt(2)
    ds_read_b64_tr_b16 v[44:45], v26 offset:4096
    ds_read_b64_tr_b16 v[46:47], v26 offset:4608
    v_mfma_f32_16x16x32_bf16 v[224:227], v[48:51], v[96:99], v[224:227]
    v_add_u32 v26, 0xfffe0000, v26
    v_accvgpr_read_b32 v31, a163
    v_mfma_f32_16x16x32_bf16 v[224:227], v[52:55], v[100:103], v[224:227]
    s_xor_b32 s64, s64, 384
    v_cvt_pk_bf16_f32 v33, v33, v31
    v_accvgpr_read_b32 v34, a164
    v_mfma_f32_16x16x32_bf16 v[228:231], v[48:51], v[104:107], v[228:231]
    v_accvgpr_read_b32 v31, a165
    v_cvt_pk_bf16_f32 v34, v34, v31
    v_mfma_f32_16x16x32_bf16 v[228:231], v[52:55], v[108:111], v[228:231]
    v_accvgpr_read_b32 v35, a166
    v_accvgpr_read_b32 v31, a167
    v_mfma_f32_16x16x32_bf16 v[232:235], v[48:51], v[112:115], v[232:235]
    v_cvt_pk_bf16_f32 v35, v35, v31
    v_accvgpr_write_b32 a160, 0
    v_mfma_f32_16x16x32_bf16 v[232:235], v[52:55], v[116:119], v[232:235]
    s_add_u32 m0, s69, 65536
    v_accvgpr_write_b32 a161, 0
    v_accvgpr_write_b32 a162, 0
    v_mfma_f32_16x16x32_bf16 v[236:239], v[48:51], v[120:123], v[236:239]
    buffer_load_dwordx4 v2, s[24:27], s60 offen lds
    v_mfma_f32_16x16x32_bf16 v[236:239], v[52:55], v[124:127], v[236:239]
    s_add_u32 s72, s71, 2048
    ds_read_b64_tr_b16 v[48:49], v27 offset:0
    ds_read_b64_tr_b16 v[50:51], v27 offset:512
    v_mfma_f32_16x16x32_bf16 v[240:243], v[56:59], v[96:99], v[240:243]
    ds_read_b64_tr_b16 v[52:53], v27 offset:4096
    ds_read_b64_tr_b16 v[54:55], v27 offset:4608
    v_mfma_f32_16x16x32_bf16 v[240:243], v[60:63], v[100:103], v[240:243]
    v_add_u32 v27, 0xfffe0000, v27
    v_accvgpr_write_b32 a163, 0
    v_mfma_f32_16x16x32_bf16 v[244:247], v[56:59], v[104:107], v[244:247]
    buffer_load_dwordx4 v3, s[24:27], s60 offen offset:1024 lds
    v_mfma_f32_16x16x32_bf16 v[244:247], v[60:63], v[108:111], v[244:247]
    buffer_store_dwordx4 v[32:35], v1, s[36:39], s72 offen sc1
    v_mfma_f32_16x16x32_bf16 v[248:251], v[56:59], v[112:115], v[248:251]
    v_accvgpr_write_b32 a164, 0
    v_accvgpr_write_b32 a165, 0
    v_mfma_f32_16x16x32_bf16 v[248:251], v[60:63], v[116:119], v[248:251]
    v_accvgpr_write_b32 a166, 0
    v_accvgpr_write_b32 a167, 0
    v_mfma_f32_16x16x32_bf16 v[252:255], v[56:59], v[120:123], v[252:255]
    buffer_load_dwordx4 v4, s[24:27], s60 offen offset:2048 lds
    v_mfma_f32_16x16x32_bf16 v[252:255], v[60:63], v[124:127], v[252:255]
    s_waitcnt lgkmcnt(0)
    ds_read_b64_tr_b16 v[56:57], v28 offset:0
    ds_read_b64_tr_b16 v[58:59], v28 offset:512
    v_mfma_f32_16x16x32_bf16 a[64:67], v[40:43], v[96:99], a[64:67]
    ds_read_b64_tr_b16 v[60:61], v28 offset:4096
    ds_read_b64_tr_b16 v[62:63], v28 offset:4608
    v_mfma_f32_16x16x32_bf16 a[64:67], v[44:47], v[100:103], a[64:67]
    v_add_u32 v24, 0x10000, v24
    v_add_u32 v28, 0xfffe0000, v28
    v_mfma_f32_16x16x32_bf16 a[68:71], v[40:43], v[104:107], a[68:71]
    buffer_load_dwordx4 v5, s[24:27], s60 offen offset:3072 lds
    v_mfma_f32_16x16x32_bf16 a[68:71], v[44:47], v[108:111], a[68:71]
    ds_read_b128 v[80:83], v24 offset:16384
    v_mfma_f32_16x16x32_bf16 a[72:75], v[40:43], v[112:115], a[72:75]
    v_mfma_f32_16x16x32_bf16 a[72:75], v[44:47], v[116:119], a[72:75]
    s_add_u32 m0, s69, 81920
    v_add_u32 v25, 0x10000, v25
    v_accvgpr_read_b32 v32, a168
    v_mfma_f32_16x16x32_bf16 a[76:79], v[40:43], v[120:123], a[76:79]
    s_xor_b32 s60, s60, 1572864
    buffer_load_dwordx4 v10, s[20:23], s63 offen lds
    v_mfma_f32_16x16x32_bf16 a[76:79], v[44:47], v[124:127], a[76:79]
    ds_read_b128 v[84:87], v25 offset:16384
    v_accvgpr_read_b32 v31, a169
    v_mfma_f32_16x16x32_bf16 a[128:131], v[40:43], a[136:139], a[128:131]
    ds_read_b64_tr_b16 v[40:41], v29 offset:0
    ds_read_b64_tr_b16 v[42:43], v29 offset:512
    v_mfma_f32_16x16x32_bf16 a[128:131], v[44:47], a[140:143], a[128:131]
    ds_read_b64_tr_b16 v[44:45], v29 offset:4096
    ds_read_b64_tr_b16 v[46:47], v29 offset:4608
    v_mfma_f32_16x16x32_bf16 a[80:83], v[48:51], v[96:99], a[80:83]
    buffer_load_dwordx4 v11, s[20:23], s63 offen offset:1024 lds
    v_mfma_f32_16x16x32_bf16 a[80:83], v[52:55], v[100:103], a[80:83]
    ds_read_b128 v[88:91], v24 offset:24576
    v_add_u32 v29, 0xfffe0000, v29
    v_mfma_f32_16x16x32_bf16 a[84:87], v[48:51], v[104:107], a[84:87]
    v_cvt_pk_bf16_f32 v32, v32, v31
    v_accvgpr_read_b32 v33, a170
    v_mfma_f32_16x16x32_bf16 a[84:87], v[52:55], v[108:111], a[84:87]
    v_accvgpr_read_b32 v31, a171
    v_cvt_pk_bf16_f32 v33, v33, v31
    v_mfma_f32_16x16x32_bf16 a[88:91], v[48:51], v[112:115], a[88:91]
    buffer_load_dwordx4 v12, s[20:23], s63 offen offset:2048 lds
    v_mfma_f32_16x16x32_bf16 a[88:91], v[52:55], v[116:119], a[88:91]
    ds_read_b128 v[92:95], v25 offset:24576
    v_accvgpr_read_b32 v34, a172
    v_mfma_f32_16x16x32_bf16 a[92:95], v[48:51], v[120:123], a[92:95]
    s_add_u32 s72, s71, 3072
    v_accvgpr_read_b32 v31, a173
    v_cvt_pk_bf16_f32 v34, v34, v31
    v_mfma_f32_16x16x32_bf16 a[92:95], v[52:55], v[124:127], a[92:95]
    v_accvgpr_read_b32 v35, a174
    v_accvgpr_read_b32 v31, a175
    v_mfma_f32_16x16x32_bf16 a[132:135], v[48:51], a[136:139], a[132:135]
    buffer_load_dwordx4 v13, s[20:23], s63 offen offset:3072 lds
    v_mfma_f32_16x16x32_bf16 a[132:135], v[52:55], a[140:143], a[132:135]
    s_waitcnt lgkmcnt(1)
    v_cvt_pk_bf16_f32 v35, v35, v31
    v_accvgpr_write_b32 a168, 0
    v_mfma_f32_16x16x32_bf16 a[96:99], v[56:59], v[96:99], a[96:99]
    v_accvgpr_write_b32 a169, 0
    v_accvgpr_write_b32 a170, 0
    v_mfma_f32_16x16x32_bf16 a[96:99], v[60:63], v[100:103], a[96:99]
    s_xor_b32 s63, s63, 128
    v_accvgpr_write_b32 a171, 0
    v_accvgpr_write_b32 a172, 0
    v_mfma_f32_16x16x32_bf16 a[100:103], v[56:59], v[104:107], a[100:103]
    buffer_store_dwordx4 v[32:35], v1, s[36:39], s72 offen sc1
    v_mfma_f32_16x16x32_bf16 a[100:103], v[60:63], v[108:111], a[100:103]
    v_accvgpr_write_b32 a173, 0
    v_accvgpr_write_b32 a174, 0
    v_mfma_f32_16x16x32_bf16 a[104:107], v[56:59], v[112:115], a[104:107]
    v_accvgpr_write_b32 a175, 0
    v_mfma_f32_16x16x32_bf16 a[104:107], v[60:63], v[116:119], a[104:107]
    s_waitcnt vmcnt(10) lgkmcnt(0)
    s_barrier
    ds_read_b64_tr_b16 v[48:49], v14 offset:0
    v_mfma_f32_16x16x32_bf16 a[108:111], v[56:59], v[120:123], a[108:111]
    s_add_u32 m0, s67, 98304
    ds_read_b64_tr_b16 v[50:51], v14 offset:1024
    ds_read_b64_tr_b16 v[52:53], v14 offset:8192
    v_mfma_f32_16x16x32_bf16 a[108:111], v[60:63], v[124:127], a[108:111]
    buffer_load_dwordx4 v1, s[28:31], s65 offen sc1 lds
    v_mfma_f32_16x16x32_bf16 a[112:115], v[40:43], v[96:99], a[112:115]
    ds_read_b64_tr_b16 v[54:55], v14 offset:9216
    ds_read_b64_tr_b16 v[56:57], v15 offset:0
    v_mfma_f32_16x16x32_bf16 a[112:115], v[44:47], v[100:103], a[112:115]
    ds_read_b64_tr_b16 v[58:59], v15 offset:1024
    ds_read_b64_tr_b16 v[60:61], v15 offset:8192
    v_mfma_f32_16x16x32_bf16 a[116:119], v[40:43], v[104:107], a[116:119]
    ds_read_b64_tr_b16 v[62:63], v15 offset:9216
    ds_read_b128 a[136:139], v22 offset:32768
    v_mfma_f32_16x16x32_bf16 a[116:119], v[44:47], v[108:111], a[116:119]
    ds_read_b128 a[140:143], v23 offset:32768
    v_add_u32 v14, 0x10000, v14
    v_mfma_f32_16x16x32_bf16 a[120:123], v[40:43], v[112:115], a[120:123]
    v_add_u32 v15, 0x10000, v15
    v_add_u32 v22, 0x10000, v22
    v_mfma_f32_16x16x32_bf16 a[120:123], v[44:47], v[116:119], a[120:123]
    v_add_u32 v23, 0x10000, v23
    v_accvgpr_read_b32 v32, a176
    v_mfma_f32_16x16x32_bf16 a[124:127], v[40:43], v[120:123], a[124:127]
    buffer_load_dwordx4 v1, s[28:31], s65 offen offset:1024 sc1 lds
    v_mfma_f32_16x16x32_bf16 a[124:127], v[44:47], v[124:127], a[124:127]
    s_waitcnt lgkmcnt(1)
    ds_read_b64_tr_b16 v[40:41], v16 offset:0
    ds_read_b64_tr_b16 v[42:43], v16 offset:1024
    v_mfma_f32_16x16x32_bf16 v[128:131], v[48:51], v[64:67], v[128:131]
    ds_read_b64_tr_b16 v[44:45], v16 offset:8192
    ds_read_b64_tr_b16 v[46:47], v16 offset:9216
    v_mfma_f32_16x16x32_bf16 v[128:131], v[52:55], v[68:71], v[128:131]
    v_add_u32 v24, 0xfffe0000, v24
    v_add_u32 v16, 0x10000, v16
    v_mfma_f32_16x16x32_bf16 v[132:135], v[48:51], v[72:75], v[132:135]
    ds_read_b128 v[96:99], v24 offset:16384
    v_accvgpr_read_b32 v31, a177
    v_mfma_f32_16x16x32_bf16 v[132:135], v[52:55], v[76:79], v[132:135]
    v_cvt_pk_bf16_f32 v32, v32, v31
    v_accvgpr_read_b32 v33, a178
    v_mfma_f32_16x16x32_bf16 v[136:139], v[48:51], v[80:83], v[136:139]
    v_accvgpr_read_b32 v31, a179
    v_cvt_pk_bf16_f32 v33, v33, v31
    v_mfma_f32_16x16x32_bf16 v[136:139], v[52:55], v[84:87], v[136:139]
    s_add_u32 s72, s71, 34816
    v_accvgpr_read_b32 v34, a180
    v_accvgpr_read_b32 v31, a181
    v_mfma_f32_16x16x32_bf16 v[140:143], v[48:51], v[88:91], v[140:143]
    s_add_u32 m0, s68, 106496
    ds_read_b64_tr_b16 v[48:49], v17 offset:0
    ds_read_b64_tr_b16 v[50:51], v17 offset:1024
    v_mfma_f32_16x16x32_bf16 v[140:143], v[52:55], v[92:95], v[140:143]
    buffer_load_dwordx4 v6, s[20:23], s66 offen lds
    v_mfma_f32_16x16x32_bf16 v[144:147], v[56:59], v[64:67], v[144:147]
    ds_read_b64_tr_b16 v[52:53], v17 offset:8192
    ds_read_b64_tr_b16 v[54:55], v17 offset:9216
    v_mfma_f32_16x16x32_bf16 v[144:147], v[60:63], v[68:71], v[144:147]
    v_add_u32 v17, 0x10000, v17
    v_cvt_pk_bf16_f32 v34, v34, v31
    v_mfma_f32_16x16x32_bf16 v[148:151], v[56:59], v[72:75], v[148:151]
    v_accvgpr_read_b32 v35, a182
    v_accvgpr_read_b32 v31, a183
    v_mfma_f32_16x16x32_bf16 v[148:151], v[60:63], v[76:79], v[148:151]
    v_cvt_pk_bf16_f32 v35, v35, v31
    v_accvgpr_write_b32 a176, 0
    v_mfma_f32_16x16x32_bf16 v[152:155], v[56:59], v[80:83], v[152:155]
    v_add_u32 v25, 0xfffe0000, v25
    v_accvgpr_write_b32 a177, 0
    v_mfma_f32_16x16x32_bf16 v[152:155], v[60:63], v[84:87], v[152:155]
    ds_read_b128 v[100:103], v25 offset:16384
    v_accvgpr_write_b32 a178, 0
    v_mfma_f32_16x16x32_bf16 v[156:159], v[56:59], v[88:91], v[156:159]
    s_add_u32 m0, s69, 114688
    ds_read_b64_tr_b16 v[56:57], v18 offset:0
    ds_read_b64_tr_b16 v[58:59], v18 offset:1024
    v_mfma_f32_16x16x32_bf16 v[156:159], v[60:63], v[92:95], v[156:159]
    s_xor_b32 s65, s65, 24576
    buffer_load_dwordx4 v10, s[20:23], s64 offen lds
    s_waitcnt lgkmcnt(3)
    v_mfma_f32_16x16x32_bf16 v[160:163], v[40:43], v[64:67], v[160:163]
    s_xor_b32 s66, s66, 384
    ds_read_b64_tr_b16 v[60:61], v18 offset:8192
    ds_read_b64_tr_b16 v[62:63], v18 offset:9216
    v_mfma_f32_16x16x32_bf16 v[160:163], v[44:47], v[68:71], v[160:163]
    v_add_u32 v18, 0x10000, v18
    v_accvgpr_write_b32 a179, 0
    v_mfma_f32_16x16x32_bf16 v[164:167], v[40:43], v[72:75], v[164:167]
    buffer_store_dwordx4 v[32:35], v1, s[36:39], s72 offen sc1
    v_mfma_f32_16x16x32_bf16 v[164:167], v[44:47], v[76:79], v[164:167]
    v_accvgpr_read_b32 v31, a185
    v_accvgpr_read_b32 v32, a184
    v_mfma_f32_16x16x32_bf16 v[168:171], v[40:43], v[80:83], v[168:171]
    v_cvt_pk_bf16_f32 v32, v32, v31
    v_accvgpr_read_b32 v33, a186
    v_mfma_f32_16x16x32_bf16 v[168:171], v[44:47], v[84:87], v[168:171]
    v_accvgpr_read_b32 v31, a187
    v_cvt_pk_bf16_f32 v33, v33, v31
    v_mfma_f32_16x16x32_bf16 v[172:175], v[40:43], v[88:91], v[172:175]
    ds_read_b64_tr_b16 v[40:41], v19 offset:0
    ds_read_b64_tr_b16 v[42:43], v19 offset:1024
    v_mfma_f32_16x16x32_bf16 v[172:175], v[44:47], v[92:95], v[172:175]
    ds_read_b64_tr_b16 v[44:45], v19 offset:8192
    ds_read_b64_tr_b16 v[46:47], v19 offset:9216
    v_mfma_f32_16x16x32_bf16 v[176:179], v[48:51], v[64:67], v[176:179]
    buffer_load_dwordx4 v11, s[20:23], s64 offen offset:1024 lds
    v_mfma_f32_16x16x32_bf16 v[176:179], v[52:55], v[68:71], v[176:179]
    ds_read_b128 v[104:107], v24 offset:24576
    v_add_u32 v19, 0x10000, v19
    v_mfma_f32_16x16x32_bf16 v[180:183], v[48:51], v[72:75], v[180:183]
    v_accvgpr_read_b32 v34, a188
    v_accvgpr_read_b32 v31, a189
    v_mfma_f32_16x16x32_bf16 v[180:183], v[52:55], v[76:79], v[180:183]
    v_cvt_pk_bf16_f32 v34, v34, v31
    v_accvgpr_read_b32 v35, a190
    v_mfma_f32_16x16x32_bf16 v[184:187], v[48:51], v[80:83], v[184:187]
    v_accvgpr_read_b32 v31, a191
    v_cvt_pk_bf16_f32 v35, v35, v31
    v_mfma_f32_16x16x32_bf16 v[184:187], v[52:55], v[84:87], v[184:187]
    v_accvgpr_write_b32 a180, 0
    v_accvgpr_write_b32 a181, 0
    v_mfma_f32_16x16x32_bf16 v[188:191], v[48:51], v[88:91], v[188:191]
    s_add_u32 s72, s71, 35840
    ds_read_b64_tr_b16 v[48:49], v20 offset:0
    ds_read_b64_tr_b16 v[50:51], v20 offset:1024
    v_mfma_f32_16x16x32_bf16 v[188:191], v[52:55], v[92:95], v[188:191]
    s_waitcnt lgkmcnt(2)
    ds_read_b64_tr_b16 v[52:53], v20 offset:8192
    ds_read_b64_tr_b16 v[54:55], v20 offset:9216
    v_mfma_f32_16x16x32_bf16 v[192:195], v[56:59], v[64:67], v[192:195]
    buffer_load_dwordx4 v12, s[20:23], s64 offen offset:2048 lds
    v_mfma_f32_16x16x32_bf16 v[192:195], v[60:63], v[68:71], v[192:195]
    v_add_u32 v20, 0x10000, v20
    v_accvgpr_write_b32 a182, 0
    v_mfma_f32_16x16x32_bf16 v[196:199], v[56:59], v[72:75], v[196:199]
    buffer_store_dwordx4 v[32:35], v1, s[36:39], s72 offen sc1
    v_mfma_f32_16x16x32_bf16 v[196:199], v[60:63], v[76:79], v[196:199]
    ds_read_b128 v[108:111], v25 offset:24576
    v_accvgpr_write_b32 a183, 0
    v_mfma_f32_16x16x32_bf16 v[200:203], v[56:59], v[80:83], v[200:203]
    v_accvgpr_write_b32 a184, 0
    v_accvgpr_write_b32 a185, 0
    v_mfma_f32_16x16x32_bf16 v[200:203], v[60:63], v[84:87], v[200:203]
    v_accvgpr_write_b32 a186, 0
    v_accvgpr_write_b32 a187, 0
    v_mfma_f32_16x16x32_bf16 v[204:207], v[56:59], v[88:91], v[204:207]
    ds_read_b64_tr_b16 v[56:57], v21 offset:0
    ds_read_b64_tr_b16 v[58:59], v21 offset:1024
    v_mfma_f32_16x16x32_bf16 v[204:207], v[60:63], v[92:95], v[204:207]
    ds_read_b64_tr_b16 v[60:61], v21 offset:8192
    ds_read_b64_tr_b16 v[62:63], v21 offset:9216
    v_mfma_f32_16x16x32_bf16 v[208:211], v[40:43], v[64:67], v[208:211]
    v_add_u32 v21, 0x10000, v21
    v_accvgpr_write_b32 a188, 0
    v_mfma_f32_16x16x32_bf16 v[208:211], v[44:47], v[68:71], v[208:211]
    buffer_load_dwordx4 v13, s[20:23], s64 offen offset:3072 lds
    v_mfma_f32_16x16x32_bf16 v[212:215], v[40:43], v[72:75], v[212:215]
    v_accvgpr_write_b32 a189, 0
    v_accvgpr_write_b32 a190, 0
    v_mfma_f32_16x16x32_bf16 v[212:215], v[44:47], v[76:79], v[212:215]
    v_accvgpr_write_b32 a191, 0
    v_mfma_f32_16x16x32_bf16 v[216:219], v[40:43], v[80:83], v[216:219]
    v_accvgpr_read_b32 v32, a192
    v_accvgpr_read_b32 v31, a193
    v_mfma_f32_16x16x32_bf16 v[216:219], v[44:47], v[84:87], v[216:219]
    v_cvt_pk_bf16_f32 v32, v32, v31
    v_accvgpr_read_b32 v33, a194
    v_mfma_f32_16x16x32_bf16 v[220:223], v[40:43], v[88:91], v[220:223]
    ds_read_b64_tr_b16 v[40:41], v26 offset:32768
    ds_read_b64_tr_b16 v[42:43], v26 offset:33280
    v_mfma_f32_16x16x32_bf16 v[220:223], v[44:47], v[92:95], v[220:223]
    s_waitcnt lgkmcnt(2)
    ds_read_b64_tr_b16 v[44:45], v26 offset:36864
    ds_read_b64_tr_b16 v[46:47], v26 offset:37376
    v_mfma_f32_16x16x32_bf16 v[224:227], v[48:51], v[64:67], v[224:227]
    v_add_u32 v26, 0x10000, v26
    v_accvgpr_read_b32 v31, a195
    v_mfma_f32_16x16x32_bf16 v[224:227], v[52:55], v[68:71], v[224:227]
    s_xor_b32 s64, s64, 128
    v_cvt_pk_bf16_f32 v33, v33, v31
    v_accvgpr_read_b32 v34, a196
    v_mfma_f32_16x16x32_bf16 v[228:231], v[48:51], v[72:75], v[228:231]
    v_accvgpr_read_b32 v31, a197
    v_cvt_pk_bf16_f32 v34, v34, v31
    v_mfma_f32_16x16x32_bf16 v[228:231], v[52:55], v[76:79], v[228:231]
    v_accvgpr_read_b32 v35, a198
    v_accvgpr_read_b32 v31, a199
    v_mfma_f32_16x16x32_bf16 v[232:235], v[48:51], v[80:83], v[232:235]
    v_cvt_pk_bf16_f32 v35, v35, v31
    v_accvgpr_write_b32 a192, 0
    v_mfma_f32_16x16x32_bf16 v[232:235], v[52:55], v[84:87], v[232:235]
    s_add_u32 m0, s69, 131072
    v_accvgpr_write_b32 a193, 0
    v_accvgpr_write_b32 a194, 0
    v_mfma_f32_16x16x32_bf16 v[236:239], v[48:51], v[88:91], v[236:239]
    buffer_load_dwordx4 v2, s[24:27], s60 offen lds
    v_mfma_f32_16x16x32_bf16 v[236:239], v[52:55], v[92:95], v[236:239]
    s_add_u32 s72, s71, 4096
    ds_read_b64_tr_b16 v[48:49], v27 offset:32768
    ds_read_b64_tr_b16 v[50:51], v27 offset:33280
    v_mfma_f32_16x16x32_bf16 v[240:243], v[56:59], v[64:67], v[240:243]
    ds_read_b64_tr_b16 v[52:53], v27 offset:36864
    ds_read_b64_tr_b16 v[54:55], v27 offset:37376
    v_mfma_f32_16x16x32_bf16 v[240:243], v[60:63], v[68:71], v[240:243]
    v_add_u32 v27, 0x10000, v27
    v_accvgpr_write_b32 a195, 0
    v_mfma_f32_16x16x32_bf16 v[244:247], v[56:59], v[72:75], v[244:247]
    buffer_load_dwordx4 v3, s[24:27], s60 offen offset:1024 lds
    v_mfma_f32_16x16x32_bf16 v[244:247], v[60:63], v[76:79], v[244:247]
    buffer_store_dwordx4 v[32:35], v1, s[36:39], s72 offen sc1
    v_mfma_f32_16x16x32_bf16 v[248:251], v[56:59], v[80:83], v[248:251]
    v_accvgpr_write_b32 a196, 0
    v_accvgpr_write_b32 a197, 0
    v_mfma_f32_16x16x32_bf16 v[248:251], v[60:63], v[84:87], v[248:251]
    v_accvgpr_write_b32 a198, 0
    v_accvgpr_write_b32 a199, 0
    v_mfma_f32_16x16x32_bf16 v[252:255], v[56:59], v[88:91], v[252:255]
    buffer_load_dwordx4 v4, s[24:27], s60 offen offset:2048 lds
    v_mfma_f32_16x16x32_bf16 v[252:255], v[60:63], v[92:95], v[252:255]
    s_waitcnt lgkmcnt(0)
    ds_read_b64_tr_b16 v[56:57], v28 offset:32768
    ds_read_b64_tr_b16 v[58:59], v28 offset:33280
    v_mfma_f32_16x16x32_bf16 a[64:67], v[40:43], v[64:67], a[64:67]
    ds_read_b64_tr_b16 v[60:61], v28 offset:36864
    ds_read_b64_tr_b16 v[62:63], v28 offset:37376
    v_mfma_f32_16x16x32_bf16 a[64:67], v[44:47], v[68:71], a[64:67]
    v_add_u32 v28, 0x10000, v28
    v_mfma_f32_16x16x32_bf16 a[68:71], v[40:43], v[72:75], a[68:71]
    buffer_load_dwordx4 v5, s[24:27], s60 offen offset:3072 lds
    v_mfma_f32_16x16x32_bf16 a[68:71], v[44:47], v[76:79], a[68:71]
    ds_read_b128 v[112:115], v24 offset:49152
    v_mfma_f32_16x16x32_bf16 a[72:75], v[40:43], v[80:83], a[72:75]
    v_mfma_f32_16x16x32_bf16 a[72:75], v[44:47], v[84:87], a[72:75]
    s_add_u32 m0, s69, 147456
    v_accvgpr_read_b32 v32, a200
    v_accvgpr_read_b32 v31, a201
    v_mfma_f32_16x16x32_bf16 a[76:79], v[40:43], v[88:91], a[76:79]
    s_xor_b32 s60, s60, 524288
    buffer_load_dwordx4 v10, s[20:23], s63 offen lds
    v_mfma_f32_16x16x32_bf16 a[76:79], v[44:47], v[92:95], a[76:79]
    ds_read_b128 v[116:119], v25 offset:49152
    v_cvt_pk_bf16_f32 v32, v32, v31
    v_mfma_f32_16x16x32_bf16 a[128:131], v[40:43], a[136:139], a[128:131]
    ds_read_b64_tr_b16 v[40:41], v29 offset:32768
    ds_read_b64_tr_b16 v[42:43], v29 offset:33280
    v_mfma_f32_16x16x32_bf16 a[128:131], v[44:47], a[140:143], a[128:131]
    ds_read_b64_tr_b16 v[44:45], v29 offset:36864
    ds_read_b64_tr_b16 v[46:47], v29 offset:37376
    v_mfma_f32_16x16x32_bf16 a[80:83], v[48:51], v[64:67], a[80:83]
    buffer_load_dwordx4 v11, s[20:23], s63 offen offset:1024 lds
    v_mfma_f32_16x16x32_bf16 a[80:83], v[52:55], v[68:71], a[80:83]
    ds_read_b128 v[120:123], v24 offset:57344
    v_add_u32 v29, 0x10000, v29
    v_mfma_f32_16x16x32_bf16 a[84:87], v[48:51], v[72:75], a[84:87]
    v_accvgpr_read_b32 v33, a202
    v_accvgpr_read_b32 v31, a203
    v_mfma_f32_16x16x32_bf16 a[84:87], v[52:55], v[76:79], a[84:87]
    v_cvt_pk_bf16_f32 v33, v33, v31
    v_accvgpr_read_b32 v34, a204
    v_mfma_f32_16x16x32_bf16 a[88:91], v[48:51], v[80:83], a[88:91]
    buffer_load_dwordx4 v12, s[20:23], s63 offen offset:2048 lds
    v_mfma_f32_16x16x32_bf16 a[88:91], v[52:55], v[84:87], a[88:91]
    ds_read_b128 v[124:127], v25 offset:57344
    v_accvgpr_read_b32 v31, a205
    v_mfma_f32_16x16x32_bf16 a[92:95], v[48:51], v[88:91], a[92:95]
    s_add_u32 s72, s71, 5120
    v_cvt_pk_bf16_f32 v34, v34, v31
    v_accvgpr_read_b32 v35, a206
    v_mfma_f32_16x16x32_bf16 a[92:95], v[52:55], v[92:95], a[92:95]
    v_accvgpr_read_b32 v31, a207
    v_cvt_pk_bf16_f32 v35, v35, v31
    v_mfma_f32_16x16x32_bf16 a[132:135], v[48:51], a[136:139], a[132:135]
    buffer_load_dwordx4 v13, s[20:23], s63 offen offset:3072 lds
    v_mfma_f32_16x16x32_bf16 a[132:135], v[52:55], a[140:143], a[132:135]
    s_waitcnt lgkmcnt(1)
    v_accvgpr_write_b32 a200, 0
    v_accvgpr_write_b32 a201, 0
    v_mfma_f32_16x16x32_bf16 a[96:99], v[56:59], v[64:67], a[96:99]
    v_accvgpr_write_b32 a202, 0
    v_accvgpr_write_b32 a203, 0
    v_mfma_f32_16x16x32_bf16 a[96:99], v[60:63], v[68:71], a[96:99]
    s_xor_b32 s63, s63, 1920
    v_accvgpr_write_b32 a204, 0
    v_accvgpr_write_b32 a205, 0
    v_mfma_f32_16x16x32_bf16 a[100:103], v[56:59], v[72:75], a[100:103]
    s_andn2_b32 s63, s63, 896
    buffer_store_dwordx4 v[32:35], v1, s[36:39], s72 offen sc1
    v_mfma_f32_16x16x32_bf16 a[100:103], v[60:63], v[76:79], a[100:103]
    v_accvgpr_write_b32 a206, 0
    v_accvgpr_write_b32 a207, 0
    v_mfma_f32_16x16x32_bf16 a[104:107], v[56:59], v[80:83], a[104:107]
    v_mfma_f32_16x16x32_bf16 a[104:107], v[60:63], v[84:87], a[104:107]
    s_waitcnt vmcnt(10) lgkmcnt(0)
    s_barrier
    ds_read_b64_tr_b16 v[48:49], v14 offset:0
    v_mfma_f32_16x16x32_bf16 a[108:111], v[56:59], v[88:91], a[108:111]
    s_add_u32 m0, s67, 0
    ds_read_b64_tr_b16 v[50:51], v14 offset:1024
    ds_read_b64_tr_b16 v[52:53], v14 offset:8192
    v_mfma_f32_16x16x32_bf16 a[108:111], v[60:63], v[92:95], a[108:111]
    buffer_load_dwordx4 v1, s[28:31], s65 offen sc1 lds
    v_mfma_f32_16x16x32_bf16 a[112:115], v[40:43], v[64:67], a[112:115]
    ds_read_b64_tr_b16 v[54:55], v14 offset:9216
    ds_read_b64_tr_b16 v[56:57], v15 offset:0
    v_mfma_f32_16x16x32_bf16 a[112:115], v[44:47], v[68:71], a[112:115]
    ds_read_b64_tr_b16 v[58:59], v15 offset:1024
    ds_read_b64_tr_b16 v[60:61], v15 offset:8192
    v_mfma_f32_16x16x32_bf16 a[116:119], v[40:43], v[72:75], a[116:119]
    ds_read_b64_tr_b16 v[62:63], v15 offset:9216
    ds_read_b128 a[136:139], v22 offset:32768
    v_mfma_f32_16x16x32_bf16 a[116:119], v[44:47], v[76:79], a[116:119]
    ds_read_b128 a[140:143], v23 offset:32768
    v_add_u32 v14, 0x10000, v14
    v_mfma_f32_16x16x32_bf16 a[120:123], v[40:43], v[80:83], a[120:123]
    v_add_u32 v15, 0x10000, v15
    v_add_u32 v22, 0xffff0000, v22
    v_mfma_f32_16x16x32_bf16 a[120:123], v[44:47], v[84:87], a[120:123]
    v_add_u32 v23, 0xffff0000, v23
    v_accvgpr_read_b32 v32, a208
    v_mfma_f32_16x16x32_bf16 a[124:127], v[40:43], v[88:91], a[124:127]
    buffer_load_dwordx4 v1, s[28:31], s65 offen offset:1024 sc1 lds
    v_mfma_f32_16x16x32_bf16 a[124:127], v[44:47], v[92:95], a[124:127]
    s_waitcnt lgkmcnt(1)
    ds_read_b64_tr_b16 v[40:41], v16 offset:0
    ds_read_b64_tr_b16 v[42:43], v16 offset:1024
    v_mfma_f32_16x16x32_bf16 v[128:131], v[48:51], v[96:99], v[128:131]
    ds_read_b64_tr_b16 v[44:45], v16 offset:8192
    ds_read_b64_tr_b16 v[46:47], v16 offset:9216
    v_mfma_f32_16x16x32_bf16 v[128:131], v[52:55], v[100:103], v[128:131]
    v_add_u32 v24, 0x10000, v24
    v_add_u32 v16, 0x10000, v16
    v_mfma_f32_16x16x32_bf16 v[132:135], v[48:51], v[104:107], v[132:135]
    ds_read_b128 v[64:67], v24 offset:16384
    v_accvgpr_read_b32 v31, a209
    v_mfma_f32_16x16x32_bf16 v[132:135], v[52:55], v[108:111], v[132:135]
    v_cvt_pk_bf16_f32 v32, v32, v31
    v_accvgpr_read_b32 v33, a210
    v_mfma_f32_16x16x32_bf16 v[136:139], v[48:51], v[112:115], v[136:139]
    v_accvgpr_read_b32 v31, a211
    v_cvt_pk_bf16_f32 v33, v33, v31
    v_mfma_f32_16x16x32_bf16 v[136:139], v[52:55], v[116:119], v[136:139]
    s_add_u32 s72, s71, 36864
    v_accvgpr_read_b32 v34, a212
    v_accvgpr_read_b32 v31, a213
    v_mfma_f32_16x16x32_bf16 v[140:143], v[48:51], v[120:123], v[140:143]
    s_add_u32 m0, s68, 8192
    ds_read_b64_tr_b16 v[48:49], v17 offset:0
    ds_read_b64_tr_b16 v[50:51], v17 offset:1024
    v_mfma_f32_16x16x32_bf16 v[140:143], v[52:55], v[124:127], v[140:143]
    buffer_load_dwordx4 v6, s[20:23], s66 offen lds
    v_mfma_f32_16x16x32_bf16 v[144:147], v[56:59], v[96:99], v[144:147]
    ds_read_b64_tr_b16 v[52:53], v17 offset:8192
    ds_read_b64_tr_b16 v[54:55], v17 offset:9216
    v_mfma_f32_16x16x32_bf16 v[144:147], v[60:63], v[100:103], v[144:147]
    v_add_u32 v17, 0x10000, v17
    v_cvt_pk_bf16_f32 v34, v34, v31
    v_mfma_f32_16x16x32_bf16 v[148:151], v[56:59], v[104:107], v[148:151]
    v_accvgpr_read_b32 v35, a214
    v_accvgpr_read_b32 v31, a215
    v_mfma_f32_16x16x32_bf16 v[148:151], v[60:63], v[108:111], v[148:151]
    v_cvt_pk_bf16_f32 v35, v35, v31
    v_accvgpr_write_b32 a208, 0
    v_mfma_f32_16x16x32_bf16 v[152:155], v[56:59], v[112:115], v[152:155]
    v_add_u32 v25, 0x10000, v25
    v_accvgpr_write_b32 a209, 0
    v_mfma_f32_16x16x32_bf16 v[152:155], v[60:63], v[116:119], v[152:155]
    ds_read_b128 v[68:71], v25 offset:16384
    v_accvgpr_write_b32 a210, 0
    v_mfma_f32_16x16x32_bf16 v[156:159], v[56:59], v[120:123], v[156:159]
    s_add_u32 m0, s69, 16384
    ds_read_b64_tr_b16 v[56:57], v18 offset:0
    ds_read_b64_tr_b16 v[58:59], v18 offset:1024
    v_mfma_f32_16x16x32_bf16 v[156:159], v[60:63], v[124:127], v[156:159]
    s_xor_b32 s65, s65, 8192
    buffer_load_dwordx4 v10, s[20:23], s64 offen lds
    s_waitcnt lgkmcnt(3)
    v_mfma_f32_16x16x32_bf16 v[160:163], v[40:43], v[96:99], v[160:163]
    s_xor_b32 s66, s66, 128
    ds_read_b64_tr_b16 v[60:61], v18 offset:8192
    ds_read_b64_tr_b16 v[62:63], v18 offset:9216
    v_mfma_f32_16x16x32_bf16 v[160:163], v[44:47], v[100:103], v[160:163]
    v_add_u32 v18, 0x10000, v18
    v_accvgpr_write_b32 a211, 0
    v_mfma_f32_16x16x32_bf16 v[164:167], v[40:43], v[104:107], v[164:167]
    buffer_store_dwordx4 v[32:35], v1, s[36:39], s72 offen sc1
    v_mfma_f32_16x16x32_bf16 v[164:167], v[44:47], v[108:111], v[164:167]
    v_accvgpr_read_b32 v31, a217
    v_accvgpr_read_b32 v32, a216
    v_mfma_f32_16x16x32_bf16 v[168:171], v[40:43], v[112:115], v[168:171]
    v_cvt_pk_bf16_f32 v32, v32, v31
    v_accvgpr_read_b32 v33, a218
    v_mfma_f32_16x16x32_bf16 v[168:171], v[44:47], v[116:119], v[168:171]
    v_accvgpr_read_b32 v31, a219
    v_cvt_pk_bf16_f32 v33, v33, v31
    v_mfma_f32_16x16x32_bf16 v[172:175], v[40:43], v[120:123], v[172:175]
    ds_read_b64_tr_b16 v[40:41], v19 offset:0
    ds_read_b64_tr_b16 v[42:43], v19 offset:1024
    v_mfma_f32_16x16x32_bf16 v[172:175], v[44:47], v[124:127], v[172:175]
    ds_read_b64_tr_b16 v[44:45], v19 offset:8192
    ds_read_b64_tr_b16 v[46:47], v19 offset:9216
    v_mfma_f32_16x16x32_bf16 v[176:179], v[48:51], v[96:99], v[176:179]
    buffer_load_dwordx4 v11, s[20:23], s64 offen offset:1024 lds
    v_mfma_f32_16x16x32_bf16 v[176:179], v[52:55], v[100:103], v[176:179]
    ds_read_b128 v[72:75], v24 offset:24576
    v_add_u32 v19, 0x10000, v19
    v_mfma_f32_16x16x32_bf16 v[180:183], v[48:51], v[104:107], v[180:183]
    v_accvgpr_read_b32 v34, a220
    v_accvgpr_read_b32 v31, a221
    v_mfma_f32_16x16x32_bf16 v[180:183], v[52:55], v[108:111], v[180:183]
    v_cvt_pk_bf16_f32 v34, v34, v31
    v_accvgpr_read_b32 v35, a222
    v_mfma_f32_16x16x32_bf16 v[184:187], v[48:51], v[112:115], v[184:187]
    v_accvgpr_read_b32 v31, a223
    v_cvt_pk_bf16_f32 v35, v35, v31
    v_mfma_f32_16x16x32_bf16 v[184:187], v[52:55], v[116:119], v[184:187]
    v_accvgpr_write_b32 a212, 0
    v_accvgpr_write_b32 a213, 0
    v_mfma_f32_16x16x32_bf16 v[188:191], v[48:51], v[120:123], v[188:191]
    s_add_u32 s72, s71, 37888
    ds_read_b64_tr_b16 v[48:49], v20 offset:0
    ds_read_b64_tr_b16 v[50:51], v20 offset:1024
    v_mfma_f32_16x16x32_bf16 v[188:191], v[52:55], v[124:127], v[188:191]
    s_waitcnt lgkmcnt(2)
    ds_read_b64_tr_b16 v[52:53], v20 offset:8192
    ds_read_b64_tr_b16 v[54:55], v20 offset:9216
    v_mfma_f32_16x16x32_bf16 v[192:195], v[56:59], v[96:99], v[192:195]
    buffer_load_dwordx4 v12, s[20:23], s64 offen offset:2048 lds
    v_mfma_f32_16x16x32_bf16 v[192:195], v[60:63], v[100:103], v[192:195]
    v_add_u32 v20, 0x10000, v20
    v_accvgpr_write_b32 a214, 0
    v_mfma_f32_16x16x32_bf16 v[196:199], v[56:59], v[104:107], v[196:199]
    buffer_store_dwordx4 v[32:35], v1, s[36:39], s72 offen sc1
    v_mfma_f32_16x16x32_bf16 v[196:199], v[60:63], v[108:111], v[196:199]
    ds_read_b128 v[76:79], v25 offset:24576
    v_accvgpr_write_b32 a215, 0
    v_mfma_f32_16x16x32_bf16 v[200:203], v[56:59], v[112:115], v[200:203]
    v_accvgpr_write_b32 a216, 0
    v_accvgpr_write_b32 a217, 0
    v_mfma_f32_16x16x32_bf16 v[200:203], v[60:63], v[116:119], v[200:203]
    v_accvgpr_write_b32 a218, 0
    v_accvgpr_write_b32 a219, 0
    v_mfma_f32_16x16x32_bf16 v[204:207], v[56:59], v[120:123], v[204:207]
    ds_read_b64_tr_b16 v[56:57], v21 offset:0
    ds_read_b64_tr_b16 v[58:59], v21 offset:1024
    v_mfma_f32_16x16x32_bf16 v[204:207], v[60:63], v[124:127], v[204:207]
    ds_read_b64_tr_b16 v[60:61], v21 offset:8192
    ds_read_b64_tr_b16 v[62:63], v21 offset:9216
    v_mfma_f32_16x16x32_bf16 v[208:211], v[40:43], v[96:99], v[208:211]
    v_add_u32 v21, 0x10000, v21
    v_accvgpr_write_b32 a220, 0
    v_mfma_f32_16x16x32_bf16 v[208:211], v[44:47], v[100:103], v[208:211]
    buffer_load_dwordx4 v13, s[20:23], s64 offen offset:3072 lds
    v_mfma_f32_16x16x32_bf16 v[212:215], v[40:43], v[104:107], v[212:215]
    v_accvgpr_write_b32 a221, 0
    v_accvgpr_write_b32 a222, 0
    v_mfma_f32_16x16x32_bf16 v[212:215], v[44:47], v[108:111], v[212:215]
    v_accvgpr_write_b32 a223, 0
    v_mfma_f32_16x16x32_bf16 v[216:219], v[40:43], v[112:115], v[216:219]
    v_accvgpr_read_b32 v32, a224
    v_accvgpr_read_b32 v31, a225
    v_mfma_f32_16x16x32_bf16 v[216:219], v[44:47], v[116:119], v[216:219]
    v_cvt_pk_bf16_f32 v32, v32, v31
    v_accvgpr_read_b32 v33, a226
    v_mfma_f32_16x16x32_bf16 v[220:223], v[40:43], v[120:123], v[220:223]
    ds_read_b64_tr_b16 v[40:41], v26 offset:32768
    ds_read_b64_tr_b16 v[42:43], v26 offset:33280
    v_mfma_f32_16x16x32_bf16 v[220:223], v[44:47], v[124:127], v[220:223]
    s_waitcnt lgkmcnt(2)
    ds_read_b64_tr_b16 v[44:45], v26 offset:36864
    ds_read_b64_tr_b16 v[46:47], v26 offset:37376
    v_mfma_f32_16x16x32_bf16 v[224:227], v[48:51], v[96:99], v[224:227]
    v_add_u32 v26, 0xffff0000, v26
    v_accvgpr_read_b32 v31, a227
    v_mfma_f32_16x16x32_bf16 v[224:227], v[52:55], v[100:103], v[224:227]
    s_xor_b32 s64, s64, 1920
    v_cvt_pk_bf16_f32 v33, v33, v31
    v_accvgpr_read_b32 v34, a228
    v_mfma_f32_16x16x32_bf16 v[228:231], v[48:51], v[104:107], v[228:231]
    s_andn2_b32 s64, s64, 896
    v_accvgpr_read_b32 v31, a229
    v_cvt_pk_bf16_f32 v34, v34, v31
    v_mfma_f32_16x16x32_bf16 v[228:231], v[52:55], v[108:111], v[228:231]
    v_accvgpr_read_b32 v35, a230
    v_accvgpr_read_b32 v31, a231
    v_mfma_f32_16x16x32_bf16 v[232:235], v[48:51], v[112:115], v[232:235]
    v_cvt_pk_bf16_f32 v35, v35, v31
    v_mfma_f32_16x16x32_bf16 v[232:235], v[52:55], v[116:119], v[232:235]
    s_add_u32 m0, s69, 32768
    v_mfma_f32_16x16x32_bf16 v[236:239], v[48:51], v[120:123], v[236:239]
    buffer_load_dwordx4 v2, s[24:27], s60 offen lds
    v_mfma_f32_16x16x32_bf16 v[236:239], v[52:55], v[124:127], v[236:239]
    s_add_u32 s72, s71, 6144
    ds_read_b64_tr_b16 v[48:49], v27 offset:32768
    ds_read_b64_tr_b16 v[50:51], v27 offset:33280
    v_mfma_f32_16x16x32_bf16 v[240:243], v[56:59], v[96:99], v[240:243]
    ds_read_b64_tr_b16 v[52:53], v27 offset:36864
    ds_read_b64_tr_b16 v[54:55], v27 offset:37376
    v_mfma_f32_16x16x32_bf16 v[240:243], v[60:63], v[100:103], v[240:243]
    buffer_store_dwordx4 v[32:35], v1, s[36:39], s72 offen sc1
    v_mfma_f32_16x16x32_bf16 v[244:247], v[56:59], v[104:107], v[244:247]
    buffer_load_dwordx4 v3, s[24:27], s60 offen offset:1024 lds
    v_mfma_f32_16x16x32_bf16 v[244:247], v[60:63], v[108:111], v[244:247]
    v_add_u32 v27, 0xffff0000, v27
    v_mfma_f32_16x16x32_bf16 v[248:251], v[56:59], v[112:115], v[248:251]
    v_mfma_f32_16x16x32_bf16 v[248:251], v[60:63], v[116:119], v[248:251]
    v_mfma_f32_16x16x32_bf16 v[252:255], v[56:59], v[120:123], v[252:255]
    buffer_load_dwordx4 v4, s[24:27], s60 offen offset:2048 lds
    v_mfma_f32_16x16x32_bf16 v[252:255], v[60:63], v[124:127], v[252:255]
    s_waitcnt lgkmcnt(0)
    ds_read_b64_tr_b16 v[56:57], v28 offset:32768
    ds_read_b64_tr_b16 v[58:59], v28 offset:33280
    v_mfma_f32_16x16x32_bf16 a[64:67], v[40:43], v[96:99], a[64:67]
    ds_read_b64_tr_b16 v[60:61], v28 offset:36864
    ds_read_b64_tr_b16 v[62:63], v28 offset:37376
    v_mfma_f32_16x16x32_bf16 a[64:67], v[44:47], v[100:103], a[64:67]
    v_add_u32 v28, 0xffff0000, v28
    v_mfma_f32_16x16x32_bf16 a[68:71], v[40:43], v[104:107], a[68:71]
    buffer_load_dwordx4 v5, s[24:27], s60 offen offset:3072 lds
    v_mfma_f32_16x16x32_bf16 a[68:71], v[44:47], v[108:111], a[68:71]
    ds_read_b128 v[80:83], v24 offset:49152
    v_mfma_f32_16x16x32_bf16 a[72:75], v[40:43], v[112:115], a[72:75]
    v_mfma_f32_16x16x32_bf16 a[72:75], v[44:47], v[116:119], a[72:75]
    s_xor_b32 s60, s60, 7864320
    v_accvgpr_read_b32 v32, a232
    v_accvgpr_read_b32 v31, a233
    v_mfma_f32_16x16x32_bf16 a[76:79], v[40:43], v[120:123], a[76:79]
    s_add_u32 m0, s69, 49152
    ds_read_b128 v[84:87], v25 offset:49152
    v_cvt_pk_bf16_f32 v32, v32, v31
    v_mfma_f32_16x16x32_bf16 a[76:79], v[44:47], v[124:127], a[76:79]
    s_andn2_b32 s60, s60, 3670016
    buffer_load_dwordx4 v10, s[20:23], s63 offen lds
    v_mfma_f32_16x16x32_bf16 a[128:131], v[40:43], a[136:139], a[128:131]
    ds_read_b64_tr_b16 v[40:41], v29 offset:32768
    ds_read_b64_tr_b16 v[42:43], v29 offset:33280
    v_mfma_f32_16x16x32_bf16 a[128:131], v[44:47], a[140:143], a[128:131]
    ds_read_b64_tr_b16 v[44:45], v29 offset:36864
    ds_read_b64_tr_b16 v[46:47], v29 offset:37376
    v_mfma_f32_16x16x32_bf16 a[80:83], v[48:51], v[96:99], a[80:83]
    buffer_load_dwordx4 v11, s[20:23], s63 offen offset:1024 lds
    v_mfma_f32_16x16x32_bf16 a[80:83], v[52:55], v[100:103], a[80:83]
    ds_read_b128 v[88:91], v24 offset:57344
    v_add_u32 v29, 0xffff0000, v29
    v_mfma_f32_16x16x32_bf16 a[84:87], v[48:51], v[104:107], a[84:87]
    v_accvgpr_read_b32 v33, a234
    v_accvgpr_read_b32 v31, a235
    v_mfma_f32_16x16x32_bf16 a[84:87], v[52:55], v[108:111], a[84:87]
    v_cvt_pk_bf16_f32 v33, v33, v31
    v_accvgpr_read_b32 v34, a236
    v_mfma_f32_16x16x32_bf16 a[88:91], v[48:51], v[112:115], a[88:91]
    buffer_load_dwordx4 v12, s[20:23], s63 offen offset:2048 lds
    v_mfma_f32_16x16x32_bf16 a[88:91], v[52:55], v[116:119], a[88:91]
    ds_read_b128 v[92:95], v25 offset:57344
    v_accvgpr_read_b32 v31, a237
    v_mfma_f32_16x16x32_bf16 a[92:95], v[48:51], v[120:123], a[92:95]
    s_add_u32 s72, s71, 7168
    v_cvt_pk_bf16_f32 v34, v34, v31
    v_accvgpr_read_b32 v35, a238
    v_mfma_f32_16x16x32_bf16 a[92:95], v[52:55], v[124:127], a[92:95]
    v_accvgpr_read_b32 v31, a239
    v_cvt_pk_bf16_f32 v35, v35, v31
    v_mfma_f32_16x16x32_bf16 a[132:135], v[48:51], a[136:139], a[132:135]
    buffer_load_dwordx4 v13, s[20:23], s63 offen offset:3072 lds
    v_mfma_f32_16x16x32_bf16 a[132:135], v[52:55], a[140:143], a[132:135]
    s_waitcnt lgkmcnt(1)
    v_mfma_f32_16x16x32_bf16 a[96:99], v[56:59], v[96:99], a[96:99]
    v_mfma_f32_16x16x32_bf16 a[96:99], v[60:63], v[100:103], a[96:99]
    s_xor_b32 s63, s63, 128
    v_mfma_f32_16x16x32_bf16 a[100:103], v[56:59], v[104:107], a[100:103]
    buffer_store_dwordx4 v[32:35], v1, s[36:39], s72 offen sc1
    v_mfma_f32_16x16x32_bf16 a[100:103], v[60:63], v[108:111], a[100:103]
    v_mfma_f32_16x16x32_bf16 a[104:107], v[56:59], v[112:115], a[104:107]
    v_mfma_f32_16x16x32_bf16 a[104:107], v[60:63], v[116:119], a[104:107]
    s_waitcnt vmcnt(10) lgkmcnt(0)
    s_barrier
    ds_read_b64_tr_b16 v[48:49], v14 offset:0
    v_mfma_f32_16x16x32_bf16 a[108:111], v[56:59], v[120:123], a[108:111]
    s_add_u32 m0, s69, 65536
    ds_read_b64_tr_b16 v[50:51], v14 offset:1024
    ds_read_b64_tr_b16 v[52:53], v14 offset:8192
    v_mfma_f32_16x16x32_bf16 a[108:111], v[60:63], v[124:127], a[108:111]
    buffer_load_dwordx4 v2, s[24:27], s60 offen lds
    v_mfma_f32_16x16x32_bf16 a[112:115], v[40:43], v[96:99], a[112:115]
    ds_read_b64_tr_b16 v[54:55], v14 offset:9216
    ds_read_b64_tr_b16 v[56:57], v15 offset:0
    v_mfma_f32_16x16x32_bf16 a[112:115], v[44:47], v[100:103], a[112:115]
    ds_read_b64_tr_b16 v[58:59], v15 offset:1024
    ds_read_b64_tr_b16 v[60:61], v15 offset:8192
    v_mfma_f32_16x16x32_bf16 a[116:119], v[40:43], v[104:107], a[116:119]
    ds_read_b64_tr_b16 v[62:63], v15 offset:9216
    ds_read_b128 a[136:139], v22 offset:0
    v_mfma_f32_16x16x32_bf16 a[116:119], v[44:47], v[108:111], a[116:119]
    ds_read_b128 a[140:143], v23 offset:0
    v_add_u32 v14, 0xfffe0000, v14
    v_mfma_f32_16x16x32_bf16 a[120:123], v[40:43], v[112:115], a[120:123]
    v_add_u32 v15, 0xfffe0000, v15
    v_add_u32 v22, 0x10000, v22
    v_mfma_f32_16x16x32_bf16 a[120:123], v[44:47], v[116:119], a[120:123]
    buffer_load_dwordx4 v3, s[24:27], s60 offen offset:1024 lds
    v_mfma_f32_16x16x32_bf16 a[124:127], v[40:43], v[120:123], a[124:127]
    ds_read_b64_tr_b16 v[40:41], v16 offset:0
    ds_read_b64_tr_b16 v[42:43], v16 offset:1024
    v_mfma_f32_16x16x32_bf16 a[124:127], v[44:47], v[124:127], a[124:127]
    s_waitcnt lgkmcnt(3)
    ds_read_b64_tr_b16 v[44:45], v16 offset:8192
    ds_read_b64_tr_b16 v[46:47], v16 offset:9216
    v_mfma_f32_16x16x32_bf16 v[128:131], v[48:51], v[64:67], v[128:131]
    v_add_u32 v16, 0xfffe0000, v16
    v_add_u32 v23, 0x10000, v23
    v_mfma_f32_16x16x32_bf16 v[128:131], v[52:55], v[68:71], v[128:131]
    v_add_u32 v24, 0x10000, v24
    v_accvgpr_read_b32 v32, a240
    v_mfma_f32_16x16x32_bf16 v[132:135], v[48:51], v[72:75], v[132:135]
    ds_read_b128 v[96:99], v24 offset:16384
    v_accvgpr_read_b32 v31, a241
    v_mfma_f32_16x16x32_bf16 v[132:135], v[52:55], v[76:79], v[132:135]
    v_cvt_pk_bf16_f32 v32, v32, v31
    v_accvgpr_read_b32 v33, a242
    v_mfma_f32_16x16x32_bf16 v[136:139], v[48:51], v[80:83], v[136:139]
    v_accvgpr_read_b32 v31, a243
    v_cvt_pk_bf16_f32 v33, v33, v31
    v_mfma_f32_16x16x32_bf16 v[136:139], v[52:55], v[84:87], v[136:139]
    s_add_u32 s72, s71, 38912
    buffer_load_dwordx4 v4, s[24:27], s60 offen offset:2048 lds
    v_mfma_f32_16x16x32_bf16 v[140:143], v[48:51], v[88:91], v[140:143]
    ds_read_b64_tr_b16 v[48:49], v17 offset:0
    ds_read_b64_tr_b16 v[50:51], v17 offset:1024
    v_mfma_f32_16x16x32_bf16 v[140:143], v[52:55], v[92:95], v[140:143]
    ds_read_b64_tr_b16 v[52:53], v17 offset:8192
    ds_read_b64_tr_b16 v[54:55], v17 offset:9216
    v_mfma_f32_16x16x32_bf16 v[144:147], v[56:59], v[64:67], v[144:147]
    v_add_u32 v17, 0xfffe0000, v17
    v_accvgpr_read_b32 v34, a244
    v_mfma_f32_16x16x32_bf16 v[144:147], v[60:63], v[68:71], v[144:147]
    v_accvgpr_read_b32 v31, a245
    v_cvt_pk_bf16_f32 v34, v34, v31
    v_mfma_f32_16x16x32_bf16 v[148:151], v[56:59], v[72:75], v[148:151]
    v_accvgpr_read_b32 v35, a246
    v_accvgpr_read_b32 v31, a247
    v_mfma_f32_16x16x32_bf16 v[148:151], v[60:63], v[76:79], v[148:151]
    v_cvt_pk_bf16_f32 v35, v35, v31
    v_mov_b32 v2, v1
    v_mfma_f32_16x16x32_bf16 v[152:155], v[56:59], v[80:83], v[152:155]
    buffer_load_dwordx4 v5, s[24:27], s60 offen offset:3072 lds
    v_mfma_f32_16x16x32_bf16 v[152:155], v[60:63], v[84:87], v[152:155]
    v_add_u32 v25, 0x10000, v25
    ds_read_b128 v[100:103], v25 offset:16384
    v_mfma_f32_16x16x32_bf16 v[156:159], v[56:59], v[88:91], v[156:159]
    ds_read_b64_tr_b16 v[56:57], v18 offset:0
    ds_read_b64_tr_b16 v[58:59], v18 offset:1024
    v_mfma_f32_16x16x32_bf16 v[156:159], v[60:63], v[92:95], v[156:159]
    s_waitcnt lgkmcnt(3)
    ds_read_b64_tr_b16 v[60:61], v18 offset:8192
    ds_read_b64_tr_b16 v[62:63], v18 offset:9216
    v_mfma_f32_16x16x32_bf16 v[160:163], v[40:43], v[64:67], v[160:163]
    buffer_store_dwordx4 v[32:35], v1, s[36:39], s72 offen sc1
    v_mfma_f32_16x16x32_bf16 v[160:163], v[44:47], v[68:71], v[160:163]
    v_add_u32 v18, 0xfffe0000, v18
    v_mfma_f32_16x16x32_bf16 v[164:167], v[40:43], v[72:75], v[164:167]
    v_mfma_f32_16x16x32_bf16 v[164:167], v[44:47], v[76:79], v[164:167]
    s_add_u32 m0, s69, 81920
    v_accvgpr_read_b32 v32, a248
    v_accvgpr_read_b32 v31, a249
    v_mfma_f32_16x16x32_bf16 v[168:171], v[40:43], v[80:83], v[168:171]
    s_xor_b32 s60, s60, 524288
    buffer_load_dwordx4 v10, s[20:23], s64 offen lds
    v_mfma_f32_16x16x32_bf16 v[168:171], v[44:47], v[84:87], v[168:171]
    s_mov_b32 s60, 131072
    v_cvt_pk_bf16_f32 v32, v32, v31
    v_accvgpr_read_b32 v33, a250
    v_mfma_f32_16x16x32_bf16 v[172:175], v[40:43], v[88:91], v[172:175]
    ds_read_b64_tr_b16 v[40:41], v19 offset:0
    ds_read_b64_tr_b16 v[42:43], v19 offset:1024
    v_mfma_f32_16x16x32_bf16 v[172:175], v[44:47], v[92:95], v[172:175]
    ds_read_b64_tr_b16 v[44:45], v19 offset:8192
    ds_read_b64_tr_b16 v[46:47], v19 offset:9216
    v_mfma_f32_16x16x32_bf16 v[176:179], v[48:51], v[64:67], v[176:179]
    ds_read_b128 v[104:107], v24 offset:24576
    v_add_u32 v19, 0xfffe0000, v19
    v_mfma_f32_16x16x32_bf16 v[176:179], v[52:55], v[68:71], v[176:179]
    v_accvgpr_read_b32 v31, a251
    v_cvt_pk_bf16_f32 v33, v33, v31
    v_mfma_f32_16x16x32_bf16 v[180:183], v[48:51], v[72:75], v[180:183]
    v_accvgpr_read_b32 v34, a252
    v_accvgpr_read_b32 v31, a253
    v_mfma_f32_16x16x32_bf16 v[180:183], v[52:55], v[76:79], v[180:183]
    buffer_load_dwordx4 v11, s[20:23], s64 offen offset:1024 lds
    v_mfma_f32_16x16x32_bf16 v[184:187], v[48:51], v[80:83], v[184:187]
    v_cvt_pk_bf16_f32 v34, v34, v31
    v_accvgpr_read_b32 v35, a254
    v_mfma_f32_16x16x32_bf16 v[184:187], v[52:55], v[84:87], v[184:187]
    v_accvgpr_read_b32 v31, a255
    v_cvt_pk_bf16_f32 v35, v35, v31
    v_mfma_f32_16x16x32_bf16 v[188:191], v[48:51], v[88:91], v[188:191]
    s_add_u32 s72, s71, 39936
    ds_read_b64_tr_b16 v[48:49], v20 offset:0
    ds_read_b64_tr_b16 v[50:51], v20 offset:1024
    v_mfma_f32_16x16x32_bf16 v[188:191], v[52:55], v[92:95], v[188:191]
    s_waitcnt lgkmcnt(2)
    ds_read_b64_tr_b16 v[52:53], v20 offset:8192
    ds_read_b64_tr_b16 v[54:55], v20 offset:9216
    v_mfma_f32_16x16x32_bf16 v[192:195], v[56:59], v[64:67], v[192:195]
    v_mov_b32 v31, 1
    v_add_u32 v20, 0xfffe0000, v20
    v_mfma_f32_16x16x32_bf16 v[192:195], v[60:63], v[68:71], v[192:195]
    buffer_store_dwordx4 v[32:35], v1, s[36:39], s72 offen sc1
    v_mfma_f32_16x16x32_bf16 v[196:199], v[56:59], v[72:75], v[196:199]
    v_add_u32 v11, s99, v39
    v_mfma_f32_16x16x32_bf16 v[196:199], v[60:63], v[76:79], v[196:199]
    s_mul_i32 s99, s98, 6
    buffer_load_dwordx4 v12, s[20:23], s64 offen offset:2048 lds
    v_mfma_f32_16x16x32_bf16 v[200:203], v[56:59], v[80:83], v[200:203]
    s_sub_u32 s99, s8, s99
    ds_read_b128 v[108:111], v25 offset:24576
    v_mfma_f32_16x16x32_bf16 v[200:203], v[60:63], v[84:87], v[200:203]
    s_mul_i32 s99, s99, 6
    v_mfma_f32_16x16x32_bf16 v[204:207], v[56:59], v[88:91], v[204:207]
    s_lshr_b32 s8, s5, 3
    ds_read_b64_tr_b16 v[56:57], v21 offset:0
    ds_read_b64_tr_b16 v[58:59], v21 offset:1024
    v_mfma_f32_16x16x32_bf16 v[204:207], v[60:63], v[92:95], v[204:207]
    s_lshl1_add_u32 s99, s4, s99
    ds_read_b64_tr_b16 v[60:61], v21 offset:8192
    ds_read_b64_tr_b16 v[62:63], v21 offset:9216
    v_mfma_f32_16x16x32_bf16 v[208:211], v[40:43], v[64:67], v[208:211]
    s_mul_i32 s8, s8, 6
    v_add_u32 v21, 0xfffe0000, v21
    v_mfma_f32_16x16x32_bf16 v[208:211], v[44:47], v[68:71], v[208:211]
    s_cmp_lt_u32 s98, 6
    s_cselect_b32 s98, s98, 40
    v_mfma_f32_16x16x32_bf16 v[212:215], v[40:43], v[72:75], v[212:215]
    s_sub_u32 s99, s99, 2
    buffer_load_dwordx4 v13, s[20:23], s64 offen offset:3072 lds
    v_mfma_f32_16x16x32_bf16 v[212:215], v[44:47], v[76:79], v[212:215]
    s_add_u32 s98, s98, s8
    v_mfma_f32_16x16x32_bf16 v[216:219], v[40:43], v[80:83], v[216:219]
    s_lshl_b32 s8, s99, 5
    v_lshl_add_u32 v10, v38, 4, s8
    v_lshrrev_b32 v38, 2, v37
    v_mfma_f32_16x16x32_bf16 v[216:219], v[44:47], v[84:87], v[216:219]
    v_lshl_add_u32 v38, s98, 2, v38
    v_mul_u32_u24 v39, 171, v38
    v_mfma_f32_16x16x32_bf16 v[220:223], v[40:43], v[88:91], v[220:223]
    s_add_u32 s98, s98, 128
    ds_read_b64_tr_b16 v[40:41], v26 offset:0
    ds_read_b64_tr_b16 v[42:43], v26 offset:512
    v_mfma_f32_16x16x32_bf16 v[220:223], v[44:47], v[92:95], v[220:223]
    s_mul_i32 s98, s98, 36
    ds_read_b64_tr_b16 v[44:45], v26 offset:4096
    ds_read_b64_tr_b16 v[46:47], v26 offset:4608
    s_waitcnt lgkmcnt(4)
    v_mfma_f32_16x16x32_bf16 v[224:227], v[48:51], v[64:67], v[224:227]
    s_add_u32 s98, s98, s99
    v_add_u32 v26, 0x10000, v26
    v_and_b32 v37, 3, v37
    v_mfma_f32_16x16x32_bf16 v[224:227], v[52:55], v[68:71], v[224:227]
    s_xor_b32 s64, s64, 128
    v_lshrrev_b32 v39, 9, v39
    v_lshl_add_u32 v37, v38, 3, v37
    v_mfma_f32_16x16x32_bf16 v[228:231], v[48:51], v[72:75], v[228:231]
    s_lshl_b32 s99, s100, 14
    v_mul_u32_u24 v38, 24, v39
    v_sub_u32 v37, v37, v38
    v_mfma_f32_16x16x32_bf16 v[228:231], v[52:55], v[76:79], v[228:231]
    s_add_u32 s99, s99, s69
    v_mad_u32_u24 v39, v39, 18, v37
    v_mul_u32_u24 v39, 1152, v39
    v_mfma_f32_16x16x32_bf16 v[232:235], v[48:51], v[80:83], v[232:235]
    s_add_u32 s63, s7, s99
    v_add_u32 v39, v39, v10
    v_add_u32 v12, 0, v39
    v_mfma_f32_16x16x32_bf16 v[232:235], v[52:55], v[84:87], v[232:235]
    s_add_u32 m0, s67, 98304
    v_mov_b32 v38, 1073741824
    v_cmp_gt_u32 vcc, 18, v37
    v_mfma_f32_16x16x32_bf16 v[236:239], v[48:51], v[88:91], v[236:239]
    s_lshl_b32 s99, s100, 11
    buffer_load_dwordx4 v1, s[28:31], s65 offen sc1 lds
    v_mfma_f32_16x16x32_bf16 v[236:239], v[52:55], v[92:95], v[236:239]
    s_add_u32 s7, s7, s99
    ds_read_b64_tr_b16 v[48:49], v27 offset:0
    ds_read_b64_tr_b16 v[50:51], v27 offset:512
    v_mfma_f32_16x16x32_bf16 v[240:243], v[56:59], v[64:67], v[240:243]
    s_lshl_b32 s64, s98, 10
    ds_read_b64_tr_b16 v[52:53], v27 offset:4096
    ds_read_b64_tr_b16 v[54:55], v27 offset:4608
    v_mfma_f32_16x16x32_bf16 v[240:243], v[60:63], v[68:71], v[240:243]
    s_add_u32 s7, s7, 32768
    v_add_u32 v27, 0x10000, v27
    v_cndmask_b32 v12, v38, v12, vcc
    v_mfma_f32_16x16x32_bf16 v[244:247], v[56:59], v[72:75], v[244:247]
    v_add_u32 v38, 1024, v36
    v_add_u32 v13, 4608, v39
    v_mfma_f32_16x16x32_bf16 v[244:247], v[60:63], v[76:79], v[244:247]
    s_cmp_eq_u32 s4, 0
    s_cselect_b64 vcc, -1, 0
    v_cndmask_b32 v12, v12, v38, vcc
    v_mfma_f32_16x16x32_bf16 v[248:251], v[56:59], v[80:83], v[248:251]
    v_mov_b32 v38, 1073741824
    v_cmp_gt_u32 vcc, 14, v37
    v_mfma_f32_16x16x32_bf16 v[248:251], v[60:63], v[84:87], v[248:251]
    v_lshrrev_b32 v37, 8, v1
    v_cndmask_b32 v13, v38, v13, vcc
    v_mfma_f32_16x16x32_bf16 v[252:255], v[56:59], v[88:91], v[252:255]
    ds_read_b64_tr_b16 v[56:57], v28 offset:0
    ds_read_b64_tr_b16 v[58:59], v28 offset:512
    v_mfma_f32_16x16x32_bf16 v[252:255], v[60:63], v[92:95], v[252:255]
    s_waitcnt lgkmcnt(2)
    ds_read_b64_tr_b16 v[60:61], v28 offset:4096
    ds_read_b64_tr_b16 v[62:63], v28 offset:4608
    v_mfma_f32_16x16x32_bf16 a[64:67], v[40:43], v[64:67], a[64:67]
    buffer_load_dwordx4 v1, s[28:31], s65 offen offset:1024 sc1 lds
    v_mfma_f32_16x16x32_bf16 a[64:67], v[44:47], v[68:71], a[64:67]
    v_add_u32 v24, 0xfffe0000, v24
    v_add_u32 v28, 0x10000, v28
    v_mfma_f32_16x16x32_bf16 a[68:71], v[40:43], v[72:75], a[68:71]
    ds_read_b128 v[112:115], v24 offset:16384
    v_add_u32 v38, 19456, v36
    v_mfma_f32_16x16x32_bf16 a[68:71], v[44:47], v[76:79], a[68:71]
    s_cmp_eq_u32 s4, 0
    s_cselect_b64 vcc, -1, 0
    v_cndmask_b32 v13, v13, v38, vcc
    v_mfma_f32_16x16x32_bf16 a[72:75], v[40:43], v[80:83], a[72:75]
    v_bfe_u32 v36, v1, 4, 4
    v_lshlrev_b32 v37, 2, v37
    v_mfma_f32_16x16x32_bf16 a[72:75], v[44:47], v[84:87], a[72:75]
    v_add_u32 v25, 0xfffe0000, v25
    v_sub_u32 v36, v36, v37
    v_mfma_f32_16x16x32_bf16 a[76:79], v[40:43], v[88:91], a[76:79]
    s_lshr_b32 s92, s2, 3
    ds_read_b128 v[116:119], v25 offset:16384
    v_lshrrev_b32 v9, 4, v1
    v_mfma_f32_16x16x32_bf16 a[76:79], v[44:47], v[92:95], a[76:79]
    s_lshl2_add_u32 s92, s92, s4
    v_min_u32 v9, 0, v9
    v_mov_b32 v37, 0xf149f2ca
    v_mfma_f32_16x16x32_bf16 a[128:131], v[40:43], a[136:139], a[128:131]
    s_mul_i32 s92, s92, 1
    ds_read_b64_tr_b16 v[40:41], v29 offset:0
    ds_read_b64_tr_b16 v[42:43], v29 offset:512
    v_mfma_f32_16x16x32_bf16 a[128:131], v[44:47], a[140:143], a[128:131]
    s_add_u32 s92, s92, 32
    v_add_lshl_u32 v9, v9, s92, 7
    ds_read_b64_tr_b16 v[44:45], v29 offset:4096
    v_mfma_f32_16x16x32_bf16 a[80:83], v[48:51], v[64:67], a[80:83]
    s_add_u32 m0, s68, 106496
    ds_read_b128 v[120:123], v24 offset:24576
    ds_read_b64_tr_b16 v[46:47], v29 offset:4608
    v_mfma_f32_16x16x32_bf16 a[80:83], v[52:55], v[68:71], a[80:83]
    s_getpc_b64 s[92:93]
    global_load_dword v9, v9, s[92:93]
    v_mfma_f32_16x16x32_bf16 a[84:87], v[48:51], v[72:75], a[84:87]
    buffer_load_dwordx4 v6, s[20:23], s66 offen lds
    v_mfma_f32_16x16x32_bf16 a[84:87], v[52:55], v[76:79], a[84:87]
    v_add_u32 v29, 0x10000, v29
    v_bfe_u32 v38, v1, 4, 2
    v_mfma_f32_16x16x32_bf16 a[88:91], v[48:51], v[80:83], a[88:91]
    ds_read_b128 v[124:127], v25 offset:24576
    v_mfma_f32_16x16x32_bf16 a[88:91], v[52:55], v[84:87], a[88:91]
    s_cmp_eq_u32 s4, 0
    s_cselect_b32 s8, 1.0, 0
    v_mfma_f32_16x16x32_bf16 a[92:95], v[48:51], v[88:91], a[92:95]
    s_cmp_eq_u32 s6, 0
    s_cselect_b32 s16, s8, 0
    s_cselect_b32 s17, s9, 0
    v_mfma_f32_16x16x32_bf16 a[92:95], v[52:55], v[92:95], a[92:95]
    s_cmp_eq_u32 s4, 0
    s_cselect_b32 s64, s7, s64
    v_mfma_f32_16x16x32_bf16 a[132:135], v[48:51], a[136:139], a[132:135]
    v_mfma_f32_16x16x32_bf16 a[132:135], v[52:55], a[140:143], a[132:135]
    s_waitcnt lgkmcnt(0)
    v_mfma_f32_16x16x32_bf16 a[96:99], v[56:59], v[64:67], a[96:99]
    v_mfma_f32_16x16x32_bf16 a[96:99], v[60:63], v[68:71], a[96:99]
    s_xor_b32 s65, s65, 122880
    v_mfma_f32_16x16x32_bf16 a[100:103], v[56:59], v[72:75], a[100:103]
    s_xor_b32 s66, s66, 1920
    v_mfma_f32_16x16x32_bf16 a[100:103], v[60:63], v[76:79], a[100:103]
    s_andn2_b32 s65, s65, 57344
    v_mfma_f32_16x16x32_bf16 a[104:107], v[56:59], v[80:83], a[104:107]
    s_andn2_b32 s66, s66, 896
    v_mfma_f32_16x16x32_bf16 a[104:107], v[60:63], v[84:87], a[104:107]
    s_waitcnt vmcnt(4) lgkmcnt(0)
    s_barrier
    ds_read_b64_tr_b16 v[48:49], v14 offset:32768
    v_mfma_f32_16x16x32_bf16 a[108:111], v[56:59], v[88:91], a[108:111]
    s_add_u32 m0, s67, 131072
    buffer_store_dword v31, v30, s[32:35], s101 offen sc1
    v_mfma_f32_16x16x32_bf16 a[108:111], v[60:63], v[92:95], a[108:111]
    buffer_load_dwordx4 v1, s[28:31], s65 offen sc1 lds
    v_mfma_f32_16x16x32_bf16 a[112:115], v[40:43], v[64:67], a[112:115]
    ds_read_b64_tr_b16 v[50:51], v14 offset:33792
    ds_read_b64_tr_b16 v[52:53], v14 offset:40960
    v_mfma_f32_16x16x32_bf16 a[112:115], v[44:47], v[68:71], a[112:115]
    ds_read_b64_tr_b16 v[54:55], v14 offset:41984
    ds_read_b64_tr_b16 v[56:57], v15 offset:32768
    v_mfma_f32_16x16x32_bf16 a[116:119], v[40:43], v[72:75], a[116:119]
    ds_read_b64_tr_b16 v[58:59], v15 offset:33792
    ds_read_b64_tr_b16 v[60:61], v15 offset:40960
    v_mfma_f32_16x16x32_bf16 a[116:119], v[44:47], v[76:79], a[116:119]
    ds_read_b64_tr_b16 v[62:63], v15 offset:41984
    v_add_u32 v14, 0x10000, v14
    v_mfma_f32_16x16x32_bf16 a[120:123], v[40:43], v[80:83], a[120:123]
    v_add_u32 v15, 0x10000, v15
    v_mfma_f32_16x16x32_bf16 a[120:123], v[44:47], v[84:87], a[120:123]
    v_mfma_f32_16x16x32_bf16 a[124:127], v[40:43], v[88:91], a[124:127]
    ds_read_b64_tr_b16 v[40:41], v16 offset:32768
    ds_read_b64_tr_b16 v[42:43], v16 offset:33792
    v_mfma_f32_16x16x32_bf16 a[124:127], v[44:47], v[92:95], a[124:127]
    s_waitcnt lgkmcnt(3)
    ds_read_b64_tr_b16 v[44:45], v16 offset:40960
    ds_read_b64_tr_b16 v[46:47], v16 offset:41984
    v_mfma_f32_16x16x32_bf16 v[128:131], v[48:51], v[96:99], v[128:131]
    v_add_u32 v16, 0x10000, v16
    v_mfma_f32_16x16x32_bf16 v[128:131], v[52:55], v[100:103], v[128:131]
    v_mfma_f32_16x16x32_bf16 v[132:135], v[48:51], v[104:107], v[132:135]
    ds_read_b128 v[64:67], v24 offset:49152
    v_mfma_f32_16x16x32_bf16 v[132:135], v[52:55], v[108:111], v[132:135]
    v_mfma_f32_16x16x32_bf16 v[136:139], v[48:51], v[112:115], v[136:139]
    v_mfma_f32_16x16x32_bf16 v[136:139], v[52:55], v[116:119], v[136:139]
    v_mfma_f32_16x16x32_bf16 v[140:143], v[48:51], v[120:123], v[140:143]
    ds_read_b64_tr_b16 v[48:49], v17 offset:32768
    ds_read_b64_tr_b16 v[50:51], v17 offset:33792
    v_mfma_f32_16x16x32_bf16 v[140:143], v[52:55], v[124:127], v[140:143]
    ds_read_b64_tr_b16 v[52:53], v17 offset:40960
    ds_read_b64_tr_b16 v[54:55], v17 offset:41984
    v_mfma_f32_16x16x32_bf16 v[144:147], v[56:59], v[96:99], v[144:147]
    s_waitcnt lgkmcnt(4)
    ds_read_b128 v[68:71], v25 offset:49152
    v_add_u32 v17, 0x10000, v17
    v_mfma_f32_16x16x32_bf16 v[144:147], v[60:63], v[100:103], v[144:147]
    v_mfma_f32_16x16x32_bf16 v[148:151], v[56:59], v[104:107], v[148:151]
    buffer_load_dwordx4 v1, s[28:31], s65 offen offset:1024 sc1 lds
    v_mfma_f32_16x16x32_bf16 v[148:151], v[60:63], v[108:111], v[148:151]
    v_mfma_f32_16x16x32_bf16 v[152:155], v[56:59], v[112:115], v[152:155]
    v_mfma_f32_16x16x32_bf16 v[152:155], v[60:63], v[116:119], v[152:155]
    v_mfma_f32_16x16x32_bf16 v[156:159], v[56:59], v[120:123], v[156:159]
    ds_read_b128 v[72:75], v24 offset:57344
    ds_read_b64_tr_b16 v[56:57], v18 offset:32768
    v_mfma_f32_16x16x32_bf16 v[156:159], v[60:63], v[124:127], v[156:159]
    ds_read_b64_tr_b16 v[58:59], v18 offset:33792
    ds_read_b64_tr_b16 v[60:61], v18 offset:40960
    v_mfma_f32_16x16x32_bf16 v[160:163], v[40:43], v[96:99], v[160:163]
    ds_read_b64_tr_b16 v[62:63], v18 offset:41984
    v_add_u32 v18, 0x10000, v18
    v_mfma_f32_16x16x32_bf16 v[160:163], v[44:47], v[100:103], v[160:163]
    v_mfma_f32_16x16x32_bf16 v[164:167], v[40:43], v[104:107], v[164:167]
    v_mfma_f32_16x16x32_bf16 v[164:167], v[44:47], v[108:111], v[164:167]
    v_mfma_f32_16x16x32_bf16 v[168:171], v[40:43], v[112:115], v[168:171]
    ds_read_b128 v[76:79], v25 offset:57344
    v_mfma_f32_16x16x32_bf16 v[168:171], v[44:47], v[116:119], v[168:171]
    v_mfma_f32_16x16x32_bf16 v[172:175], v[40:43], v[120:123], v[172:175]
    ds_read_b64_tr_b16 v[40:41], v19 offset:32768
    ds_read_b64_tr_b16 v[42:43], v19 offset:33792
    v_mfma_f32_16x16x32_bf16 v[172:175], v[44:47], v[124:127], v[172:175]
    s_waitcnt lgkmcnt(3)
    ds_read_b64_tr_b16 v[44:45], v19 offset:40960
    ds_read_b64_tr_b16 v[46:47], v19 offset:41984
    v_mfma_f32_16x16x32_bf16 v[176:179], v[48:51], v[96:99], v[176:179]
    v_add_u32 v19, 0x10000, v19
    v_mfma_f32_16x16x32_bf16 v[176:179], v[52:55], v[100:103], v[176:179]
    v_mfma_f32_16x16x32_bf16 v[180:183], v[48:51], v[104:107], v[180:183]
    v_mfma_f32_16x16x32_bf16 v[180:183], v[52:55], v[108:111], v[180:183]
    v_add_u32 v24, 0x10000, v24
    v_mfma_f32_16x16x32_bf16 v[184:187], v[48:51], v[112:115], v[184:187]
    ds_read_b128 v[80:83], v24 offset:16384
    v_mfma_f32_16x16x32_bf16 v[184:187], v[52:55], v[116:119], v[184:187]
    s_add_u32 m0, s68, 139264
    v_mfma_f32_16x16x32_bf16 v[188:191], v[48:51], v[120:123], v[188:191]
    buffer_load_dwordx4 v6, s[20:23], s66 offen lds
    v_mfma_f32_16x16x32_bf16 v[188:191], v[52:55], v[124:127], v[188:191]
    ds_read_b64_tr_b16 v[48:49], v20 offset:32768
    ds_read_b64_tr_b16 v[50:51], v20 offset:33792
    v_mfma_f32_16x16x32_bf16 v[192:195], v[56:59], v[96:99], v[192:195]
    ds_read_b64_tr_b16 v[52:53], v20 offset:40960
    ds_read_b64_tr_b16 v[54:55], v20 offset:41984
    v_mfma_f32_16x16x32_bf16 v[192:195], v[60:63], v[100:103], v[192:195]
    v_add_u32 v25, 0x10000, v25
    v_add_u32 v20, 0x10000, v20
    v_mfma_f32_16x16x32_bf16 v[196:199], v[56:59], v[104:107], v[196:199]
    ds_read_b128 v[84:87], v25 offset:16384
    v_mfma_f32_16x16x32_bf16 v[196:199], v[60:63], v[108:111], v[196:199]
    s_cmp_eq_u32 s6, 0
    s_cselect_b32 s20, s12, 0
    s_cselect_b32 s21, s13, 0
    v_mfma_f32_16x16x32_bf16 v[200:203], v[56:59], v[112:115], v[200:203]
    s_cmp_eq_u32 s6, 0
    s_cselect_b32 s22, s14, 0
    s_cselect_b32 s23, s15, 0
    v_mfma_f32_16x16x32_bf16 v[200:203], v[60:63], v[116:119], v[200:203]
    v_mfma_f32_16x16x32_bf16 v[204:207], v[56:59], v[120:123], v[204:207]
    ds_read_b64_tr_b16 v[56:57], v21 offset:32768
    ds_read_b64_tr_b16 v[58:59], v21 offset:33792
    v_mfma_f32_16x16x32_bf16 v[204:207], v[60:63], v[124:127], v[204:207]
    s_waitcnt lgkmcnt(2)
    ds_read_b64_tr_b16 v[60:61], v21 offset:40960
    ds_read_b64_tr_b16 v[62:63], v21 offset:41984
    v_mfma_f32_16x16x32_bf16 v[208:211], v[40:43], v[96:99], v[208:211]
    ds_read_b128 v[88:91], v24 offset:24576
    v_add_u32 v21, 0x10000, v21
    v_mfma_f32_16x16x32_bf16 v[208:211], v[44:47], v[100:103], v[208:211]
    v_mfma_f32_16x16x32_bf16 v[212:215], v[40:43], v[104:107], v[212:215]
    v_mfma_f32_16x16x32_bf16 v[212:215], v[44:47], v[108:111], v[212:215]
    v_mfma_f32_16x16x32_bf16 v[216:219], v[40:43], v[112:115], v[216:219]
    v_mfma_f32_16x16x32_bf16 v[216:219], v[44:47], v[116:119], v[216:219]
    v_mfma_f32_16x16x32_bf16 v[220:223], v[40:43], v[120:123], v[220:223]
    ds_read_b128 v[92:95], v25 offset:24576
    ds_read_b64_tr_b16 v[40:41], v14 offset:0
    v_mfma_f32_16x16x32_bf16 v[220:223], v[44:47], v[124:127], v[220:223]
    ds_read_b64_tr_b16 v[42:43], v14 offset:1024
    ds_read_b64_tr_b16 v[44:45], v14 offset:8192
    v_mfma_f32_16x16x32_bf16 v[224:227], v[48:51], v[96:99], v[224:227]
    ds_read_b64_tr_b16 v[46:47], v14 offset:9216
    v_mfma_f32_16x16x32_bf16 v[224:227], v[52:55], v[100:103], v[224:227]
    s_xor_b32 s65, s65, 8192
    v_mfma_f32_16x16x32_bf16 v[228:231], v[48:51], v[104:107], v[228:231]
    s_xor_b32 s66, s66, 128
    v_mfma_f32_16x16x32_bf16 v[228:231], v[52:55], v[108:111], v[228:231]
    v_mfma_f32_16x16x32_bf16 v[232:235], v[48:51], v[112:115], v[232:235]
    v_mfma_f32_16x16x32_bf16 v[232:235], v[52:55], v[116:119], v[232:235]
    v_mfma_f32_16x16x32_bf16 v[236:239], v[48:51], v[120:123], v[236:239]
    ds_read_b64_tr_b16 v[48:49], v15 offset:0
    ds_read_b64_tr_b16 v[50:51], v15 offset:1024
    v_mfma_f32_16x16x32_bf16 v[236:239], v[52:55], v[124:127], v[236:239]
    s_waitcnt lgkmcnt(2)
    ds_read_b64_tr_b16 v[52:53], v15 offset:8192
    ds_read_b64_tr_b16 v[54:55], v15 offset:9216
    v_mfma_f32_16x16x32_bf16 v[240:243], v[56:59], v[96:99], v[240:243]
    v_mfma_f32_16x16x32_bf16 v[240:243], v[60:63], v[100:103], v[240:243]
    v_mfma_f32_16x16x32_bf16 v[244:247], v[56:59], v[104:107], v[244:247]
    v_mfma_f32_16x16x32_bf16 v[244:247], v[60:63], v[108:111], v[244:247]
    v_mfma_f32_16x16x32_bf16 v[248:251], v[56:59], v[112:115], v[248:251]
    v_mfma_f32_16x16x32_bf16 v[248:251], v[60:63], v[116:119], v[248:251]
    v_mfma_f32_16x16x32_bf16 v[252:255], v[56:59], v[120:123], v[252:255]
    ds_read_b64_tr_b16 v[56:57], v16 offset:0
    ds_read_b64_tr_b16 v[58:59], v16 offset:1024
    v_mfma_f32_16x16x32_bf16 v[252:255], v[60:63], v[124:127], v[252:255]
    buffer_load_dword v7, v8, s[32:35], s61 offen sc1
    v_mfma_f32_16x16x32_bf16 v[128:131], v[40:43], v[64:67], v[128:131]
    ds_read_b64_tr_b16 v[60:61], v16 offset:8192
    ds_read_b64_tr_b16 v[62:63], v16 offset:9216
    v_mfma_f32_16x16x32_bf16 v[128:131], v[44:47], v[68:71], v[128:131]
    v_mfma_f32_16x16x32_bf16 v[132:135], v[40:43], v[72:75], v[132:135]
    v_mfma_f32_16x16x32_bf16 v[132:135], v[44:47], v[76:79], v[132:135]
    v_mfma_f32_16x16x32_bf16 v[136:139], v[40:43], v[80:83], v[136:139]
    v_mfma_f32_16x16x32_bf16 v[136:139], v[44:47], v[84:87], v[136:139]
    v_mfma_f32_16x16x32_bf16 v[140:143], v[40:43], v[88:91], v[140:143]
    ds_read_b64_tr_b16 v[40:41], v17 offset:0
    ds_read_b64_tr_b16 v[42:43], v17 offset:1024
    v_mfma_f32_16x16x32_bf16 v[140:143], v[44:47], v[92:95], v[140:143]
    s_waitcnt lgkmcnt(2)
    ds_read_b64_tr_b16 v[44:45], v17 offset:8192
    ds_read_b64_tr_b16 v[46:47], v17 offset:9216
    v_mfma_f32_16x16x32_bf16 v[144:147], v[48:51], v[64:67], v[144:147]
    v_cvt_pk_bf16_f32 v128, v128, v129
    v_cvt_pk_bf16_f32 v129, v130, v131
    v_mfma_f32_16x16x32_bf16 v[144:147], v[52:55], v[68:71], v[144:147]
    v_cvt_pk_bf16_f32 v132, v132, v133
    v_cvt_pk_bf16_f32 v133, v134, v135
    v_mfma_f32_16x16x32_bf16 v[148:151], v[48:51], v[72:75], v[148:151]
    v_cvt_pk_bf16_f32 v136, v136, v137
    v_cvt_pk_bf16_f32 v137, v138, v139
    v_mfma_f32_16x16x32_bf16 v[148:151], v[52:55], v[76:79], v[148:151]
    v_cvt_pk_bf16_f32 v140, v140, v141
    v_cvt_pk_bf16_f32 v141, v142, v143
    v_mfma_f32_16x16x32_bf16 v[152:155], v[48:51], v[80:83], v[152:155]
    v_cvt_pk_bf16_f32 v130, v144, v145
    v_cvt_pk_bf16_f32 v131, v146, v147
    v_mfma_f32_16x16x32_bf16 v[152:155], v[52:55], v[84:87], v[152:155]
    v_mfma_f32_16x16x32_bf16 v[156:159], v[48:51], v[88:91], v[156:159]
    ds_read_b64_tr_b16 v[48:49], v18 offset:0
    ds_read_b64_tr_b16 v[50:51], v18 offset:1024
    v_mfma_f32_16x16x32_bf16 v[156:159], v[52:55], v[92:95], v[156:159]
    ds_read_b64_tr_b16 v[52:53], v18 offset:8192
    ds_read_b64_tr_b16 v[54:55], v18 offset:9216
    v_mfma_f32_16x16x32_bf16 v[160:163], v[56:59], v[64:67], v[160:163]
    v_cvt_pk_bf16_f32 v134, v148, v149
    v_cvt_pk_bf16_f32 v135, v150, v151
    v_mfma_f32_16x16x32_bf16 v[160:163], v[60:63], v[68:71], v[160:163]
    v_cvt_pk_bf16_f32 v138, v152, v153
    v_cvt_pk_bf16_f32 v139, v154, v155
    v_mfma_f32_16x16x32_bf16 v[164:167], v[56:59], v[72:75], v[164:167]
    v_cvt_pk_bf16_f32 v142, v156, v157
    v_cvt_pk_bf16_f32 v143, v158, v159
    v_mfma_f32_16x16x32_bf16 v[164:167], v[60:63], v[76:79], v[164:167]
    v_mfma_f32_16x16x32_bf16 v[168:171], v[56:59], v[80:83], v[168:171]
    v_mfma_f32_16x16x32_bf16 v[168:171], v[60:63], v[84:87], v[168:171]
    v_cvt_pk_bf16_f32 v160, v160, v161
    v_cvt_pk_bf16_f32 v161, v162, v163
    v_mfma_f32_16x16x32_bf16 v[172:175], v[56:59], v[88:91], v[172:175]
    ds_read_b64_tr_b16 v[56:57], v19 offset:0
    ds_read_b64_tr_b16 v[58:59], v19 offset:1024
    v_mfma_f32_16x16x32_bf16 v[172:175], v[60:63], v[92:95], v[172:175]
    s_waitcnt lgkmcnt(2)
    ds_read_b64_tr_b16 v[60:61], v19 offset:8192
    ds_read_b64_tr_b16 v[62:63], v19 offset:9216
    v_mfma_f32_16x16x32_bf16 v[176:179], v[40:43], v[64:67], v[176:179]
    v_cvt_pk_bf16_f32 v164, v164, v165
    v_cvt_pk_bf16_f32 v165, v166, v167
    v_mfma_f32_16x16x32_bf16 v[176:179], v[44:47], v[68:71], v[176:179]
    v_cvt_pk_bf16_f32 v168, v168, v169
    v_cvt_pk_bf16_f32 v169, v170, v171
    v_mfma_f32_16x16x32_bf16 v[180:183], v[40:43], v[72:75], v[180:183]
    v_cvt_pk_bf16_f32 v172, v172, v173
    v_cvt_pk_bf16_f32 v173, v174, v175
    v_mfma_f32_16x16x32_bf16 v[180:183], v[44:47], v[76:79], v[180:183]
    v_mfma_f32_16x16x32_bf16 v[184:187], v[40:43], v[80:83], v[184:187]
    v_mfma_f32_16x16x32_bf16 v[184:187], v[44:47], v[84:87], v[184:187]
    v_cvt_pk_bf16_f32 v162, v176, v177
    v_cvt_pk_bf16_f32 v163, v178, v179
    v_mfma_f32_16x16x32_bf16 v[188:191], v[40:43], v[88:91], v[188:191]
    ds_read_b64_tr_b16 v[40:41], v20 offset:0
    ds_read_b64_tr_b16 v[42:43], v20 offset:1024
    v_mfma_f32_16x16x32_bf16 v[188:191], v[44:47], v[92:95], v[188:191]
    ds_read_b64_tr_b16 v[44:45], v20 offset:8192
    ds_read_b64_tr_b16 v[46:47], v20 offset:9216
    v_mfma_f32_16x16x32_bf16 v[192:195], v[48:51], v[64:67], v[192:195]
    v_cvt_pk_bf16_f32 v166, v180, v181
    v_cvt_pk_bf16_f32 v167, v182, v183
    v_mfma_f32_16x16x32_bf16 v[192:195], v[52:55], v[68:71], v[192:195]
    v_cvt_pk_bf16_f32 v170, v184, v185
    v_cvt_pk_bf16_f32 v171, v186, v187
    s_waitcnt vmcnt(0)
    v_cmp_gt_u32 vcc, 1, v7
    s_nop 1
    s_and_b64 vcc, vcc, exec
    s_cbranch_scc1 SPIN_KV
BACK_KV:
    v_mfma_f32_16x16x32_bf16 v[196:199], v[48:51], v[72:75], v[196:199]
    s_mov_b32 s77, s75
    buffer_load_dwordx4 a[224:227], v1, s[36:39], 0 offen offset:0 sc1
    v_mfma_f32_16x16x32_bf16 v[196:199], v[52:55], v[76:79], v[196:199]
    buffer_load_dwordx4 a[228:231], v1, s[36:39], 0 offen offset:1024 sc1
    v_mfma_f32_16x16x32_bf16 v[200:203], v[48:51], v[80:83], v[200:203]
    v_cmp_le_i32 vcc, 0, v36
    v_cvt_pk_bf16_f32 v192, v192, v193
    v_mfma_f32_16x16x32_bf16 v[200:203], v[52:55], v[84:87], v[200:203]
    v_cvt_pk_bf16_f32 v193, v194, v195
    v_cvt_pk_bf16_f32 v174, v188, v189
    v_mfma_f32_16x16x32_bf16 v[204:207], v[48:51], v[88:91], v[204:207]
    buffer_load_dwordx4 a[232:235], v1, s[36:39], 0 offen offset:2048 sc1
    v_mfma_f32_16x16x32_bf16 v[204:207], v[52:55], v[92:95], v[204:207]
    s_waitcnt lgkmcnt(0)
    ds_read_b64_tr_b16 v[48:49], v21 offset:0
    ds_read_b64_tr_b16 v[50:51], v21 offset:1024
    v_mfma_f32_16x16x32_bf16 v[208:211], v[56:59], v[64:67], v[208:211]
    ds_read_b64_tr_b16 v[52:53], v21 offset:8192
    ds_read_b64_tr_b16 v[54:55], v21 offset:9216
    v_mfma_f32_16x16x32_bf16 v[208:211], v[60:63], v[68:71], v[208:211]
    v_cvt_pk_bf16_f32 v196, v196, v197
    v_cvt_pk_bf16_f32 v197, v198, v199
    v_mfma_f32_16x16x32_bf16 v[212:215], v[56:59], v[72:75], v[212:215]
    buffer_load_dwordx4 a[236:239], v1, s[36:39], 0 offen offset:3072 sc1
    v_mfma_f32_16x16x32_bf16 v[212:215], v[60:63], v[76:79], v[212:215]
    v_cvt_pk_bf16_f32 v200, v200, v201
    v_cvt_pk_bf16_f32 v201, v202, v203
    v_mfma_f32_16x16x32_bf16 v[216:219], v[56:59], v[80:83], v[216:219]
    v_cvt_pk_bf16_f32 v194, v208, v209
    v_cndmask_b32_e64 v208, v37, 0, vcc
    v_mfma_f32_16x16x32_bf16 v[216:219], v[60:63], v[84:87], v[216:219]
    v_mul_f32 v176, s16, v208
    v_cmp_le_i32 vcc, 1, v36
    v_mfma_f32_16x16x32_bf16 v[220:223], v[56:59], v[88:91], v[220:223]
    v_cvt_pk_bf16_f32 v195, v210, v211
    v_cndmask_b32_e64 v209, v37, 0, vcc
    v_mfma_f32_16x16x32_bf16 v[220:223], v[60:63], v[92:95], v[220:223]
    v_mul_f32 v177, s16, v209
    v_cmp_le_i32 vcc, 2, v36
    v_mfma_f32_16x16x32_bf16 v[224:227], v[40:43], v[64:67], v[224:227]
    s_mov_b32 s38, 16384
    v_cndmask_b32_e64 v210, v37, 0, vcc
    v_mul_f32 v178, s16, v210
    v_mfma_f32_16x16x32_bf16 v[224:227], v[44:47], v[68:71], v[224:227]
    s_add_u32 m0, s76, s75
    v_cmp_le_i32 vcc, 3, v36
    v_cvt_pk_bf16_f32 v198, v212, v213
    v_mfma_f32_16x16x32_bf16 v[228:231], v[40:43], v[72:75], v[228:231]
    buffer_load_dwordx4 v1, s[36:39], s77 offen sc1 lds
    v_mfma_f32_16x16x32_bf16 v[228:231], v[44:47], v[76:79], v[228:231]
    v_cndmask_b32_e64 v211, v37, 0, vcc
    v_mul_f32 v179, s16, v211
    v_mfma_f32_16x16x32_bf16 v[232:235], v[40:43], v[80:83], v[232:235]
    v_cvt_pk_bf16_f32 v224, v224, v225
    v_cvt_pk_bf16_f32 v225, v226, v227
    v_mfma_f32_16x16x32_bf16 v[232:235], v[44:47], v[84:87], v[232:235]
    s_waitcnt vmcnt(6) lgkmcnt(0)
    s_barrier
    ds_read_b64_tr_b16 v[56:57], v26 offset:32768
    v_mfma_f32_16x16x32_bf16 v[236:239], v[40:43], v[88:91], v[236:239]
    buffer_load_dwordx4 v1, s[36:39], s77 offen offset:1024 sc1 lds
    v_mfma_f32_16x16x32_bf16 v[236:239], v[44:47], v[92:95], v[236:239]
    ds_read_b64_tr_b16 v[58:59], v26 offset:33280
    ds_read_b64_tr_b16 v[60:61], v26 offset:36864
    v_mfma_f32_16x16x32_bf16 v[240:243], v[48:51], v[64:67], v[240:243]
    ds_read_b64_tr_b16 v[62:63], v26 offset:37376
    ds_read_b128 a[136:139], v22 offset:32768
    v_mfma_f32_16x16x32_bf16 v[240:243], v[52:55], v[68:71], v[240:243]
    ds_read_b128 a[140:143], v23 offset:32768
    v_add_u32 v26, 0x10000, v26
    v_mfma_f32_16x16x32_bf16 v[244:247], v[48:51], v[72:75], v[244:247]
    buffer_load_dwordx4 v1, s[36:39], s77 offen offset:2048 sc1 lds
    v_mfma_f32_16x16x32_bf16 v[244:247], v[52:55], v[76:79], v[244:247]
    ds_read_b64_tr_b16 v[40:41], v27 offset:32768
    ds_read_b64_tr_b16 v[42:43], v27 offset:33280
    v_mfma_f32_16x16x32_bf16 v[248:251], v[48:51], v[80:83], v[248:251]
    ds_read_b64_tr_b16 v[44:45], v27 offset:36864
    ds_read_b64_tr_b16 v[46:47], v27 offset:37376
    v_mfma_f32_16x16x32_bf16 v[248:251], v[52:55], v[84:87], v[248:251]
    v_add_u32 v22, 0x10000, v22
    v_add_u32 v23, 0x10000, v23
    v_mfma_f32_16x16x32_bf16 v[252:255], v[48:51], v[88:91], v[252:255]
    buffer_load_dwordx4 v1, s[36:39], s77 offen offset:3072 sc1 lds
    v_mfma_f32_16x16x32_bf16 v[252:255], v[52:55], v[92:95], v[252:255]
    s_waitcnt lgkmcnt(4)
    ds_read_b64_tr_b16 v[48:49], v28 offset:32768
    ds_read_b64_tr_b16 v[50:51], v28 offset:33280
    v_mfma_f32_16x16x32_bf16 a[64:67], v[56:59], v[96:99], a[64:67]
    s_add_u32 s100, s77, 4096
    ds_read_b64_tr_b16 v[52:53], v28 offset:36864
    ds_read_b64_tr_b16 v[54:55], v28 offset:37376
    v_mfma_f32_16x16x32_bf16 a[64:67], v[60:63], v[100:103], a[64:67]
    s_add_u32 m0, m0, 4096
    v_add_u32 v27, 0x10000, v27
    v_add_u32 v28, 0x10000, v28
    v_mfma_f32_16x16x32_bf16 a[68:71], v[56:59], v[104:107], a[68:71]
    buffer_load_dwordx4 v1, s[36:39], s100 offen sc1 lds
    v_mfma_f32_16x16x32_bf16 a[68:71], v[60:63], v[108:111], a[68:71]
    v_cvt_pk_bf16_f32 v226, v240, v241
    v_cvt_pk_bf16_f32 v227, v242, v243
    v_mfma_f32_16x16x32_bf16 a[72:75], v[56:59], v[112:115], a[72:75]
    v_cvt_pk_bf16_f32 v228, v228, v229
    v_cvt_pk_bf16_f32 v229, v230, v231
    v_mfma_f32_16x16x32_bf16 a[72:75], v[60:63], v[116:119], a[72:75]
    v_cvt_pk_bf16_f32 v230, v244, v245
    v_cvt_pk_bf16_f32 v231, v246, v247
    v_mfma_f32_16x16x32_bf16 a[76:79], v[56:59], v[120:123], a[76:79]
    buffer_load_dwordx4 v1, s[36:39], s100 offen offset:1024 sc1 lds
    v_mfma_f32_16x16x32_bf16 a[76:79], v[60:63], v[124:127], a[76:79]
    v_cvt_pk_bf16_f32 v199, v214, v215
    v_cvt_pk_bf16_f32 v232, v232, v233
    v_mfma_f32_16x16x32_bf16 a[128:131], v[56:59], a[136:139], a[128:131]
    ds_read_b64_tr_b16 v[56:57], v29 offset:32768
    ds_read_b64_tr_b16 v[58:59], v29 offset:33280
    v_mfma_f32_16x16x32_bf16 a[128:131], v[60:63], a[140:143], a[128:131]
    s_waitcnt lgkmcnt(2)
    ds_read_b64_tr_b16 v[60:61], v29 offset:36864
    ds_read_b64_tr_b16 v[62:63], v29 offset:37376
    v_mfma_f32_16x16x32_bf16 a[80:83], v[40:43], v[96:99], a[80:83]
    buffer_load_dwordx4 v1, s[36:39], s100 offen offset:2048 sc1 lds
    v_mfma_f32_16x16x32_bf16 a[80:83], v[44:47], v[100:103], a[80:83]
    v_add_u32 v29, 0x10000, v29
    v_cvt_pk_bf16_f32 v233, v234, v235
    v_mfma_f32_16x16x32_bf16 a[84:87], v[40:43], v[104:107], a[84:87]
    v_cvt_pk_bf16_f32 v234, v248, v249
    v_cvt_pk_bf16_f32 v235, v250, v251
    v_mfma_f32_16x16x32_bf16 a[84:87], v[44:47], v[108:111], a[84:87]
    v_cvt_pk_bf16_f32 v202, v216, v217
    v_cvt_pk_bf16_f32 v203, v218, v219
    v_mfma_f32_16x16x32_bf16 a[88:91], v[40:43], v[112:115], a[88:91]
    buffer_load_dwordx4 v1, s[36:39], s100 offen offset:3072 sc1 lds
    v_mfma_f32_16x16x32_bf16 a[88:91], v[44:47], v[116:119], a[88:91]
    v_cvt_pk_bf16_f32 v175, v190, v191
    v_cvt_pk_bf16_f32 v236, v236, v237
    v_mfma_f32_16x16x32_bf16 a[92:95], v[40:43], v[120:123], a[92:95]
    s_lshr_b32 s82, s4, 1
    s_add_u32 s82, s82, 32
    v_cvt_pk_bf16_f32 v237, v238, v239
    v_mfma_f32_16x16x32_bf16 a[92:95], v[44:47], v[124:127], a[92:95]
    s_sub_u32 s82, s82, s6
    v_cvt_pk_bf16_f32 v238, v252, v253
    v_cvt_pk_bf16_f32 v239, v254, v255
    v_mfma_f32_16x16x32_bf16 a[132:135], v[40:43], a[136:139], a[132:135]
    s_add_u32 s76, s76, 32768
    s_sub_u32 s82, s82, s6
    ds_read_b64_tr_b16 v[40:41], v26 offset:0
    v_mfma_f32_16x16x32_bf16 a[132:135], v[44:47], a[140:143], a[132:135]
    s_add_u32 s77, s77, 32768
    s_lshl_b32 s38, s82, 15
    s_add_u32 m0, s76, s75
    v_mfma_f32_16x16x32_bf16 a[96:99], v[48:51], v[96:99], a[96:99]
    s_mov_b32 s82, 0
    buffer_load_dwordx4 v1, s[36:39], s77 offen sc1 lds
    v_mfma_f32_16x16x32_bf16 a[96:99], v[52:55], v[100:103], a[96:99]
    ds_read_b64_tr_b16 v[42:43], v26 offset:512
    ds_read_b64_tr_b16 v[44:45], v26 offset:4096
    v_mfma_f32_16x16x32_bf16 a[100:103], v[48:51], v[104:107], a[100:103]
    buffer_load_dwordx4 v1, s[36:39], s77 offen offset:1024 sc1 lds
    v_mfma_f32_16x16x32_bf16 a[100:103], v[52:55], v[108:111], a[100:103]
    ds_read_b64_tr_b16 v[46:47], v26 offset:4608
    ds_read_b128 a[136:139], v22 offset:0
    v_mfma_f32_16x16x32_bf16 a[104:107], v[48:51], v[112:115], a[104:107]
    ds_read_b128 a[140:143], v23 offset:0
    v_cvt_pk_bf16_f32 v204, v204, v205
    v_mfma_f32_16x16x32_bf16 a[104:107], v[52:55], v[116:119], a[104:107]
    v_cvt_pk_bf16_f32 v205, v206, v207
    v_cvt_pk_bf16_f32 v206, v220, v221
    v_mfma_f32_16x16x32_bf16 a[108:111], v[48:51], v[120:123], a[108:111]
    buffer_load_dwordx4 v1, s[36:39], s77 offen offset:2048 sc1 lds
    v_mfma_f32_16x16x32_bf16 a[108:111], v[52:55], v[124:127], a[108:111]
    s_waitcnt lgkmcnt(3)
    ds_read_b64_tr_b16 v[48:49], v27 offset:0
    ds_read_b64_tr_b16 v[50:51], v27 offset:512
    v_mfma_f32_16x16x32_bf16 a[112:115], v[56:59], v[96:99], a[112:115]
    ds_read_b64_tr_b16 v[52:53], v27 offset:4096
    ds_read_b64_tr_b16 v[54:55], v27 offset:4608
    v_mfma_f32_16x16x32_bf16 a[112:115], v[60:63], v[100:103], a[112:115]
    v_cvt_pk_bf16_f32 v207, v222, v223
    v_cmp_eq_u32 vcc, 0, v38
    v_mfma_f32_16x16x32_bf16 a[116:119], v[56:59], v[104:107], a[116:119]
    buffer_load_dwordx4 v1, s[36:39], s77 offen offset:3072 sc1 lds
    v_mfma_f32_16x16x32_bf16 a[116:119], v[60:63], v[108:111], a[116:119]
    v_mov_b32 v38, 0x3f803f80
    v_cndmask_b32 v38, 0, v38, vcc
    v_mfma_f32_16x16x32_bf16 a[120:123], v[56:59], v[112:115], a[120:123]
    s_add_u32 s100, s77, 4096
    v_mfma_f32_16x16x32_bf16 a[120:123], v[60:63], v[116:119], a[120:123]
    s_add_u32 m0, m0, 4096
    v_mfma_f32_16x16x32_bf16 a[124:127], v[56:59], v[120:123], a[124:127]
    buffer_load_dwordx4 v1, s[36:39], s100 offen sc1 lds
    v_mfma_f32_16x16x32_bf16 a[124:127], v[60:63], v[124:127], a[124:127]
    s_waitcnt vmcnt(13)
    ds_read_b64_tr_b16 v[56:57], v28 offset:0
    ds_read_b64_tr_b16 v[58:59], v28 offset:512
    v_mfma_f32_16x16x32_bf16 v[240:243], a[224:227], v[128:131], v[176:179]
    ds_read_b64_tr_b16 v[60:61], v28 offset:4096
    ds_read_b64_tr_b16 v[62:63], v28 offset:4608
    v_mfma_f32_16x16x32_bf16 v[240:243], a[228:231], v[160:163], v[240:243]
    v_mfma_f32_16x16x32_bf16 v[240:243], a[232:235], v[192:195], v[240:243]
    buffer_load_dwordx4 v1, s[36:39], s100 offen offset:1024 sc1 lds
    v_mfma_f32_16x16x32_bf16 v[240:243], a[236:239], v[224:227], v[240:243]
    v_mfma_f32_16x16x32_bf16 v[244:247], a[224:227], v[132:135], 0
    v_mfma_f32_16x16x32_bf16 v[244:247], a[228:231], v[164:167], v[244:247]
    v_mfma_f32_16x16x32_bf16 v[244:247], a[232:235], v[196:199], v[244:247]
    buffer_load_dwordx4 v1, s[36:39], s100 offen offset:2048 sc1 lds
    v_mfma_f32_16x16x32_bf16 v[244:247], a[236:239], v[228:231], v[244:247]
    v_mfma_f32_16x16x32_bf16 v[248:251], a[224:227], v[136:139], 0
    v_mfma_f32_16x16x32_bf16 v[248:251], a[228:231], v[168:171], v[248:251]
    v_mfma_f32_16x16x32_bf16 v[248:251], a[232:235], v[200:203], v[248:251]
    buffer_load_dwordx4 v1, s[36:39], s100 offen offset:3072 sc1 lds
    v_mfma_f32_16x16x32_bf16 v[248:251], a[236:239], v[232:235], v[248:251]
    v_max3_f32 v240, v240, v241, v242
    v_max_f32 v240, v240, v243
    v_mfma_f32_16x16x32_bf16 v[252:255], a[224:227], v[140:143], 0
    s_add_u32 s76, s76, 32768
    v_max3_f32 v244, v244, v245, v246
    v_max_f32 v244, v244, v247
    v_mfma_f32_16x16x32_bf16 v[252:255], a[228:231], v[172:175], v[252:255]
    s_add_u32 s77, s77, 32768
    v_max3_f32 v248, v248, v249, v250
    v_max_f32 v248, v248, v251
    v_mfma_f32_16x16x32_bf16 v[252:255], a[232:235], v[204:207], v[252:255]
    s_add_u32 m0, s76, s75
    v_mov_b32 v241, v240
    v_mov_b32 v245, v244
    v_mfma_f32_16x16x32_bf16 v[252:255], a[236:239], v[236:239], v[252:255]
    buffer_load_dwordx4 v1, s[36:39], s77 offen sc1 lds
    v_mfma_f32_16x16x32_bf16 a[64:67], v[40:43], v[64:67], a[64:67]
    s_waitcnt lgkmcnt(0)
    v_mov_b32 v249, v248
    v_permlane32_swap_b32 v240, v241
    v_mfma_f32_16x16x32_bf16 a[64:67], v[44:47], v[68:71], a[64:67]
    v_permlane32_swap_b32 v244, v245
    v_permlane32_swap_b32 v248, v249
    v_mfma_f32_16x16x32_bf16 a[68:71], v[40:43], v[72:75], a[68:71]
    buffer_load_dwordx4 v1, s[36:39], s77 offen offset:1024 sc1 lds
    v_mfma_f32_16x16x32_bf16 a[68:71], v[44:47], v[76:79], a[68:71]
    v_max3_f32 v252, v252, v253, v254
    v_max_f32 v252, v252, v255
    v_mfma_f32_16x16x32_bf16 a[72:75], v[40:43], v[80:83], a[72:75]
    v_mov_b32 v253, v252
    v_max_f32 v240, v240, v241
    v_mfma_f32_16x16x32_bf16 a[72:75], v[44:47], v[84:87], a[72:75]
    v_permlane32_swap_b32 v252, v253
    v_max_f32 v244, v244, v245
    v_mfma_f32_16x16x32_bf16 a[76:79], v[40:43], v[88:91], a[76:79]
    buffer_load_dwordx4 v1, s[36:39], s77 offen offset:2048 sc1 lds
    v_mfma_f32_16x16x32_bf16 a[76:79], v[44:47], v[92:95], a[76:79]
    v_max_f32 v248, v248, v249
    v_max_f32 v252, v252, v253
    v_mfma_f32_16x16x32_bf16 a[128:131], v[40:43], a[136:139], a[128:131]
    ds_read_b64_tr_b16 v[40:41], v29 offset:0
    ds_read_b64_tr_b16 v[42:43], v29 offset:512
    v_mfma_f32_16x16x32_bf16 a[128:131], v[44:47], a[140:143], a[128:131]
    ds_read_b64_tr_b16 v[44:45], v29 offset:4096
    ds_read_b64_tr_b16 v[46:47], v29 offset:4608
    v_mfma_f32_16x16x32_bf16 a[80:83], v[48:51], v[64:67], a[80:83]
    buffer_load_dwordx4 v1, s[36:39], s77 offen offset:3072 sc1 lds
    v_mfma_f32_16x16x32_bf16 a[80:83], v[52:55], v[68:71], a[80:83]
    v_mov_b32 v241, v240
    v_mov_b32 v245, v244
    v_mfma_f32_16x16x32_bf16 a[84:87], v[48:51], v[72:75], a[84:87]
    s_add_u32 s100, s77, 4096
    v_mov_b32 v249, v248
    v_mov_b32 v253, v252
    v_mfma_f32_16x16x32_bf16 a[84:87], v[52:55], v[76:79], a[84:87]
    s_add_u32 m0, m0, 4096
    v_permlane16_swap_b32 v240, v241
    v_permlane16_swap_b32 v244, v245
    v_mfma_f32_16x16x32_bf16 a[88:91], v[48:51], v[80:83], a[88:91]
    buffer_load_dwordx4 v1, s[36:39], s100 offen sc1 lds
    v_mfma_f32_16x16x32_bf16 a[88:91], v[52:55], v[84:87], a[88:91]
    v_permlane16_swap_b32 v248, v249
    v_permlane16_swap_b32 v252, v253
    v_mfma_f32_16x16x32_bf16 a[92:95], v[48:51], v[88:91], a[92:95]
    v_max_f32 v240, v240, v241
    v_max_f32 v244, v244, v245
    v_mfma_f32_16x16x32_bf16 a[92:95], v[52:55], v[92:95], a[92:95]
    v_max_f32 v248, v248, v249
    v_max_f32 v252, v252, v253
    v_mfma_f32_16x16x32_bf16 a[132:135], v[48:51], a[136:139], a[132:135]
    buffer_load_dwordx4 v1, s[36:39], s100 offen offset:1024 sc1 lds
    v_mfma_f32_16x16x32_bf16 a[132:135], v[52:55], a[140:143], a[132:135]
    v_sub_f32 v144, 0, v240
    v_sub_f32 v145, 0, v240
    v_mfma_f32_16x16x32_bf16 a[96:99], v[56:59], v[64:67], a[96:99]
    v_sub_f32 v146, 0, v240
    v_sub_f32 v147, 0, v240
    v_mfma_f32_16x16x32_bf16 a[96:99], v[60:63], v[68:71], a[96:99]
    v_sub_f32 v148, 0, v244
    v_sub_f32 v149, 0, v244
    v_mfma_f32_16x16x32_bf16 a[100:103], v[56:59], v[72:75], a[100:103]
    buffer_load_dwordx4 v1, s[36:39], s100 offen offset:2048 sc1 lds
    v_mfma_f32_16x16x32_bf16 a[100:103], v[60:63], v[76:79], a[100:103]
    v_sub_f32 v150, 0, v244
    v_sub_f32 v151, 0, v244
    v_mfma_f32_16x16x32_bf16 a[104:107], v[56:59], v[80:83], a[104:107]
    v_sub_f32 v152, 0, v248
    v_sub_f32 v153, 0, v248
    v_mfma_f32_16x16x32_bf16 a[104:107], v[60:63], v[84:87], a[104:107]
    v_sub_f32 v154, 0, v248
    v_sub_f32 v155, 0, v248
    v_mfma_f32_16x16x32_bf16 a[108:111], v[56:59], v[88:91], a[108:111]
    buffer_load_dwordx4 v1, s[36:39], s100 offen offset:3072 sc1 lds
    v_mfma_f32_16x16x32_bf16 a[108:111], v[60:63], v[92:95], a[108:111]
    s_waitcnt lgkmcnt(0)
    v_sub_f32 v156, 0, v252
    v_sub_f32 v157, 0, v252
    v_mfma_f32_16x16x32_bf16 a[112:115], v[40:43], v[64:67], a[112:115]
    s_add_u32 s77, s77, 32768
    v_sub_f32 v158, 0, v252
    v_sub_f32 v159, 0, v252
    v_mfma_f32_16x16x32_bf16 a[112:115], v[44:47], v[68:71], a[112:115]
    s_add_u32 s76, s76, 32768
    v_accvgpr_write_b32 a136, v38
    v_accvgpr_write_b32 a137, v38
    v_mfma_f32_16x16x32_bf16 a[116:119], v[40:43], v[72:75], a[116:119]
    v_accvgpr_write_b32 a138, v38
    v_accvgpr_write_b32 a139, v38
    v_mfma_f32_16x16x32_bf16 a[116:119], v[44:47], v[76:79], a[116:119]
    v_mfma_f32_16x16x32_bf16 a[120:123], v[40:43], v[80:83], a[120:123]
    v_mfma_f32_16x16x32_bf16 a[120:123], v[44:47], v[84:87], a[120:123]
    s_waitcnt vmcnt(16) lgkmcnt(0)
    s_barrier
    v_mfma_f32_16x16x32_bf16 a[124:127], v[40:43], v[88:91], a[124:127]
    v_mfma_f32_16x16x32_bf16 a[124:127], v[44:47], v[92:95], a[124:127]
K1_ATT:
    v_add_f32 v212, s20, v144
    v_fma_f32 v176, v208, s16, v212
    v_fma_f32 v177, v209, s16, v212
    v_fma_f32 v178, v210, s16, v212
    v_fma_f32 v179, v211, s16, v212
    s_nop 1
    s_waitcnt lgkmcnt(0)
    v_mfma_f32_16x16x32_bf16 v[240:243], a[224:227], v[128:131], v[176:179]
    s_add_u32 m0, s76, s75
    ds_read_b128 a[240:243], v2 offset:4096
    ds_read_b128 a[244:247], v2 offset:5120
    v_mfma_f32_16x16x32_bf16 v[240:243], a[228:231], v[160:163], v[240:243]
    s_mov_b32 s76, s60
    buffer_load_dwordx4 v1, s[36:39], s77 offen sc1 lds
    v_mfma_f32_16x16x32_bf16 v[240:243], a[232:235], v[192:195], v[240:243]
    s_mov_b32 s60, s82
    ds_read_b128 a[248:251], v2 offset:6144
    ds_read_b128 a[252:255], v2 offset:7168
    v_mfma_f32_16x16x32_bf16 v[240:243], a[236:239], v[224:227], v[240:243]
    s_add_u32 s82, s82, 32768
    v_add_f32 v213, s21, v144
    v_fma_f32 v180, v208, s17, v213
    v_mfma_f32_16x16x32_bf16 v[244:247], a[224:227], v[132:135], v[148:151]
    s_sub_u32 s7, 15, s6
    v_fma_f32 v181, v209, s17, v213
    v_fma_f32 v182, v210, s17, v213
    v_mfma_f32_16x16x32_bf16 v[244:247], a[228:231], v[164:167], v[244:247]
    s_lshl3_add_u32 s80, s6, s4
    v_exp_f32 v240, v240
    v_mfma_f32_16x16x32_bf16 v[244:247], a[232:235], v[196:199], v[244:247]
    s_lshl3_add_u32 s81, s7, s4
    buffer_load_dwordx4 v1, s[36:39], s77 offen offset:1024 sc1 lds
    v_mfma_f32_16x16x32_bf16 v[244:247], a[236:239], v[228:231], v[244:247]
    s_mul_i32 s80, s80, 155648
    v_exp_f32 v241, v241
    v_mfma_f32_16x16x32_bf16 v[248:251], a[224:227], v[136:139], v[152:155]
    s_mul_i32 s81, s81, 155648
    v_exp_f32 v242, v242
    v_mfma_f32_16x16x32_bf16 v[248:251], a[228:231], v[168:171], v[248:251]
    s_lshl_b32 s7, s5, 12
    v_exp_f32 v243, v243
    v_mfma_f32_16x16x32_bf16 v[248:251], a[232:235], v[200:203], v[248:251]
    s_add_u32 s80, s80, s7
    v_fma_f32 v183, v211, s17, v213
    v_cvt_pk_bf16_f32 v32, v240, v241
    v_mfma_f32_16x16x32_bf16 v[248:251], a[236:239], v[232:235], v[248:251]
    s_add_u32 s81, s81, s7
    buffer_load_dwordx4 v1, s[36:39], s77 offen offset:2048 sc1 lds
    v_mfma_f32_16x16x32_bf16 v[252:255], a[224:227], v[140:143], v[156:159]
    s_lshr_b32 s7, s5, 3
    v_cvt_pk_bf16_f32 v33, v242, v243
    ds_read_b128 a[224:227], v2 offset:8192
    v_mfma_f32_16x16x32_bf16 v[252:255], a[228:231], v[172:175], v[252:255]
    s_lshl_b32 s7, s7, 10
    v_exp_f32 v244, v244
    v_mfma_f32_16x16x32_bf16 v[252:255], a[232:235], v[204:207], v[252:255]
    s_lshl2_add_u32 s7, s75, s7
    v_exp_f32 v245, v245
    v_mfma_f32_16x16x32_bf16 v[252:255], a[236:239], v[236:239], v[252:255]
    s_mov_b32 s42, 19922944
    v_exp_f32 v246, v246
    s_waitcnt lgkmcnt(1)
    v_mfma_f32_16x16x32_bf16 v[240:243], a[240:243], v[128:131], v[180:183]
    s_mov_b32 s43, 0x20000
    v_exp_f32 v247, v247
    v_mfma_f32_16x16x32_bf16 v[240:243], a[244:247], v[160:163], v[240:243]
    s_add_u32 s92, s7, 32768
    buffer_load_dwordx4 v1, s[36:39], s77 offen offset:3072 sc1 lds
    v_mfma_f32_16x16x32_bf16 v[240:243], a[248:251], v[192:195], v[240:243]
    s_mov_b64 s[24:25], s[0:1]
    v_cvt_pk_bf16_f32 v40, v244, v245
    v_cvt_pk_bf16_f32 v41, v246, v247
    v_mfma_f32_16x16x32_bf16 v[240:243], a[252:255], v[224:227], v[240:243]
    s_mov_b32 s78, s6
    v_exp_f32 v248, v248
    v_mfma_f32_16x16x32_bf16 v[244:247], a[240:243], v[132:135], v[148:151]
    s_mov_b32 s26, 2359296
    v_exp_f32 v249, v249
    v_mfma_f32_16x16x32_bf16 v[244:247], a[244:247], v[164:167], v[244:247]
    s_add_u32 s100, s77, 4096
    v_exp_f32 v250, v250
    v_mfma_f32_16x16x32_bf16 v[244:247], a[248:251], v[196:199], v[244:247]
    s_add_u32 m0, m0, 4096
    v_exp_f32 v251, v251
    v_mfma_f32_16x16x32_bf16 v[244:247], a[252:255], v[228:231], v[244:247]
    s_mov_b32 s27, 0x20000
    v_cvt_pk_bf16_f32 v48, v248, v249
    v_cvt_pk_bf16_f32 v49, v250, v251
    v_mfma_f32_16x16x32_bf16 v[248:251], a[240:243], v[136:139], v[152:155]
    buffer_load_dwordx4 v1, s[36:39], s100 offen sc1 lds
    v_mfma_f32_16x16x32_bf16 v[248:251], a[244:247], v[168:171], v[248:251]
    ds_read_b128 a[228:231], v2 offset:9216
    ds_read_b128 a[232:235], v2 offset:10240
    v_mfma_f32_16x16x32_bf16 v[248:251], a[248:251], v[200:203], v[248:251]
    v_exp_f32 v252, v252
    v_mfma_f32_16x16x32_bf16 v[248:251], a[252:255], v[232:235], v[248:251]
    v_exp_f32 v253, v253
    v_exp_f32 v254, v254
    v_exp_f32 v255, v255
    v_cvt_pk_bf16_f32 v56, v252, v253
    v_cvt_pk_bf16_f32 v57, v254, v255
    v_mfma_f32_16x16x32_bf16 v[252:255], a[240:243], v[140:143], v[156:159]
    ds_read_b128 a[236:239], v2 offset:11264
    v_add_f32 v214, s22, v144
    v_mfma_f32_16x16x32_bf16 v[252:255], a[244:247], v[172:175], v[252:255]
    buffer_load_dwordx4 v1, s[36:39], s100 offen offset:1024 sc1 lds
    v_mfma_f32_16x16x32_bf16 v[252:255], a[248:251], v[204:207], v[252:255]
    v_exp_f32 v240, v240
    v_mfma_f32_16x16x32_bf16 v[252:255], a[252:255], v[236:239], v[252:255]
    s_waitcnt lgkmcnt(1)
    v_exp_f32 v241, v241
    v_exp_f32 v242, v242
    v_exp_f32 v243, v243
    v_fma_f32 v184, v208, s18, v214
    v_fma_f32 v185, v209, s18, v214
    v_fma_f32 v186, v210, s18, v214
    v_fma_f32 v187, v211, s18, v214
    v_cvt_pk_bf16_f32 v34, v240, v241
    v_cvt_pk_bf16_f32 v35, v242, v243
    v_mfma_f32_16x16x32_bf16 v[240:243], a[224:227], v[128:131], v[184:187]
    v_exp_f32 v244, v244
    v_mfma_f32_16x16x32_bf16 v[240:243], a[228:231], v[160:163], v[240:243]
    v_exp_f32 v245, v245
    v_mfma_f32_16x16x32_bf16 v[240:243], a[232:235], v[192:195], v[240:243]
    s_waitcnt lgkmcnt(0)
    v_exp_f32 v246, v246
    v_mfma_f32_16x16x32_bf16 v[240:243], a[236:239], v[224:227], v[240:243]
    v_exp_f32 v247, v247
    v_cvt_pk_bf16_f32 v42, v244, v245
    v_cvt_pk_bf16_f32 v43, v246, v247
    v_mfma_f32_16x16x32_bf16 v[244:247], a[224:227], v[132:135], v[148:151]
    buffer_load_dwordx4 v1, s[36:39], s100 offen offset:2048 sc1 lds
    v_mfma_f32_16x16x32_bf16 v[244:247], a[228:231], v[164:167], v[244:247]
    v_exp_f32 v248, v248
    v_mfma_f32_16x16x32_bf16 v[244:247], a[232:235], v[196:199], v[244:247]
    v_exp_f32 v249, v249
    v_mfma_f32_16x16x32_bf16 v[244:247], a[236:239], v[228:231], v[244:247]
    v_exp_f32 v250, v250
    v_exp_f32 v251, v251
    v_cvt_pk_bf16_f32 v50, v248, v249
    v_cvt_pk_bf16_f32 v51, v250, v251
    v_mfma_f32_16x16x32_bf16 v[248:251], a[224:227], v[136:139], v[152:155]
    buffer_load_dwordx4 v1, s[36:39], s100 offen offset:3072 sc1 lds
    v_mfma_f32_16x16x32_bf16 v[248:251], a[228:231], v[168:171], v[248:251]
    ds_read_b128 a[240:243], v2 offset:12288
    ds_read_b128 a[244:247], v2 offset:13312
    v_mfma_f32_16x16x32_bf16 v[248:251], a[232:235], v[200:203], v[248:251]
    s_add_u32 s77, s77, 32768
    v_exp_f32 v252, v252
    v_mfma_f32_16x16x32_bf16 v[248:251], a[236:239], v[232:235], v[248:251]
    v_exp_f32 v253, v253
    v_exp_f32 v254, v254
    v_exp_f32 v255, v255
    v_cvt_pk_bf16_f32 v58, v252, v253
    v_cvt_pk_bf16_f32 v59, v254, v255
    v_mfma_f32_16x16x32_bf16 v[252:255], a[224:227], v[140:143], v[156:159]
    ds_read_b128 a[248:251], v2 offset:14336
    ds_read_b128 a[252:255], v2 offset:15360
    v_mfma_f32_16x16x32_bf16 v[252:255], a[228:231], v[172:175], v[252:255]
    v_add_f32 v215, s23, v144
    v_fma_f32 v188, v208, s19, v215
    v_mfma_f32_16x16x32_bf16 v[252:255], a[232:235], v[204:207], v[252:255]
    v_exp_f32 v240, v240
    v_mfma_f32_16x16x32_bf16 v[252:255], a[236:239], v[236:239], v[252:255]
    s_waitcnt lgkmcnt(2)
    v_exp_f32 v241, v241
    v_exp_f32 v242, v242
    v_exp_f32 v243, v243
    v_fma_f32 v189, v209, s19, v215
    v_fma_f32 v190, v210, s19, v215
    v_fma_f32 v191, v211, s19, v215
    v_cvt_pk_bf16_f32 v36, v240, v241
    v_cvt_pk_bf16_f32 v37, v242, v243
    v_mfma_f32_16x16x32_bf16 v[240:243], a[240:243], v[128:131], v[188:191]
    v_exp_f32 v244, v244
    v_mfma_f32_16x16x32_bf16 v[240:243], a[244:247], v[160:163], v[240:243]
    s_cmp_eq_u32 s82, 163840
    s_cselect_b32 s82, 0, s82
    v_add_u32 v2, s82, v1
    s_waitcnt lgkmcnt(0)
    v_mfma_f32_16x16x32_bf16 v[240:243], a[248:251], v[192:195], v[240:243]
    v_exp_f32 v245, v245
    v_mfma_f32_16x16x32_bf16 v[240:243], a[252:255], v[224:227], v[240:243]
    s_waitcnt vmcnt(8) lgkmcnt(0)
    s_barrier
    v_cvt_pk_bf16_f32 v44, v244, v245
    v_exp_f32 v246, v246
    v_exp_f32 v247, v247
    s_nop 0
    v_cvt_pk_bf16_f32 v45, v246, v247
    v_mfma_f32_16x16x32_bf16 v[244:247], a[240:243], v[132:135], v[148:151]
    ds_read_b128 a[224:227], v2 offset:0
    ds_read_b128 a[228:231], v2 offset:1024
    v_mfma_f32_16x16x32_bf16 v[244:247], a[244:247], v[164:167], v[244:247]
    v_exp_f32 v248, v248
    v_mfma_f32_16x16x32_bf16 v[244:247], a[248:251], v[196:199], v[244:247]
    v_exp_f32 v249, v249
    v_mfma_f32_16x16x32_bf16 v[244:247], a[252:255], v[228:231], v[244:247]
    v_exp_f32 v250, v250
    v_exp_f32 v251, v251
    v_cvt_pk_bf16_f32 v52, v248, v249
    v_cvt_pk_bf16_f32 v53, v250, v251
    v_mfma_f32_16x16x32_bf16 v[248:251], a[240:243], v[136:139], v[152:155]
    ds_read_b128 a[232:235], v2 offset:2048
    ds_read_b128 a[236:239], v2 offset:3072
    v_mfma_f32_16x16x32_bf16 v[248:251], a[244:247], v[168:171], v[248:251]
    ds_read_b128 v[96:99], v2 offset:16384
    v_mfma_f32_16x16x32_bf16 v[248:251], a[248:251], v[200:203], v[248:251]
    v_exp_f32 v252, v252
    v_mfma_f32_16x16x32_bf16 v[248:251], a[252:255], v[232:235], v[248:251]
    v_exp_f32 v253, v253
    v_exp_f32 v254, v254
    v_exp_f32 v255, v255
    v_cvt_pk_bf16_f32 v60, v252, v253
    v_cvt_pk_bf16_f32 v61, v254, v255
    v_mfma_f32_16x16x32_bf16 v[252:255], a[240:243], v[140:143], v[156:159]
    ds_read_b128 v[100:103], v2 offset:17408
    v_mfma_f32_16x16x32_bf16 v[252:255], a[244:247], v[172:175], v[252:255]
    v_exp_f32 v240, v240
    v_mfma_f32_16x16x32_bf16 v[252:255], a[248:251], v[204:207], v[252:255]
    s_sub_u32 s40, s56, 20971520
    s_subb_u32 s41, s57, 0
    v_mfma_f32_16x16x32_bf16 v[252:255], a[252:255], v[236:239], v[252:255]
    v_exp_f32 v241, v241
    v_exp_f32 v242, v242
    v_exp_f32 v243, v243
    v_exp_f32 v244, v244
    v_exp_f32 v245, v245
    v_exp_f32 v246, v246
    v_exp_f32 v247, v247
    v_exp_f32 v248, v248
    v_exp_f32 v249, v249
    v_exp_f32 v250, v250
    v_exp_f32 v251, v251
    v_exp_f32 v252, v252
    v_exp_f32 v253, v253
    v_cvt_pk_bf16_f32 v38, v240, v241
    v_cvt_pk_bf16_f32 v39, v242, v243
    v_cvt_pk_bf16_f32 v46, v244, v245
    v_cvt_pk_bf16_f32 v47, v246, v247
    v_cvt_pk_bf16_f32 v54, v248, v249
    v_cvt_pk_bf16_f32 v55, v250, v251
    v_cvt_pk_bf16_f32 v62, v252, v253
    s_cmp_eq_u32 s78, 0
    s_cbranch_scc1 K1_LB_END
.p2align 3
K1_LB:
    s_waitcnt lgkmcnt(0)
    v_mfma_f32_16x16x32_bf16 v[240:243], a[224:227], v[128:131], v[176:179]
    s_add_u32 m0, s76, s75
    v_exp_f32 v254, v254
    v_mfma_f32_16x16x32_bf16 v[240:243], a[228:231], v[160:163], v[240:243]
    s_mov_b32 s76, s60
    buffer_load_dwordx4 v1, s[36:39], s77 offen sc1 lds
    v_mfma_f32_16x16x32_bf16 v[240:243], a[232:235], v[192:195], v[240:243]
    s_mov_b32 s60, s82
    v_exp_f32 v255, v255
    v_mfma_f32_16x16x32_bf16 v[240:243], a[236:239], v[224:227], v[240:243]
    s_add_u32 s82, s82, 32768
    ds_read_b128 v[104:107], v2 offset:18432
    v_cvt_pk_bf16_f32 v63, v254, v255
    v_mfma_f32_16x16x32_bf16 a[0:3], v[96:99], v[32:35], a[0:3]
    ds_read_b128 v[108:111], v2 offset:19456
    ds_read_b128 a[240:243], v2 offset:4096
    v_mfma_f32_16x16x32_bf16 a[0:3], v[100:103], v[36:39], a[0:3]
    ds_read_b128 a[244:247], v2 offset:5120
    v_mfma_f32_16x16x32_bf16 a[4:7], v[96:99], v[40:43], a[4:7]
    v_exp_f32 v240, v240
    v_mfma_f32_16x16x32_bf16 a[4:7], v[100:103], v[44:47], a[4:7]
    ds_read_b128 a[248:251], v2 offset:6144
    ds_read_b128 a[252:255], v2 offset:7168
    v_mfma_f32_16x16x32_bf16 v[244:247], a[224:227], v[132:135], v[148:151]
    v_exp_f32 v241, v241
    v_mfma_f32_16x16x32_bf16 v[244:247], a[228:231], v[164:167], v[244:247]
    ds_read_b128 v[112:115], v2 offset:20480
    ds_read_b128 v[116:119], v2 offset:21504
    v_mfma_f32_16x16x32_bf16 v[244:247], a[232:235], v[196:199], v[244:247]
    v_exp_f32 v242, v242
    v_mfma_f32_16x16x32_bf16 v[244:247], a[236:239], v[228:231], v[244:247]
    v_exp_f32 v243, v243
    v_mfma_f32_16x16x32_bf16 a[8:11], v[96:99], v[48:51], a[8:11]
    v_cvt_pk_bf16_f32 v64, v240, v241
    v_cvt_pk_bf16_f32 v65, v242, v243
    v_mfma_f32_16x16x32_bf16 a[8:11], v[100:103], v[52:55], a[8:11]
    ds_read_b128 v[120:123], v2 offset:22528
    ds_read_b128 v[124:127], v2 offset:23552
    v_mfma_f32_16x16x32_bf16 a[12:15], v[96:99], v[56:59], a[12:15]
    v_exp_f32 v244, v244
    v_mfma_f32_16x16x32_bf16 a[12:15], v[100:103], v[60:63], a[12:15]
    buffer_load_dwordx4 v1, s[36:39], s77 offen offset:1024 sc1 lds
    v_mfma_f32_16x16x32_bf16 v[248:251], a[224:227], v[136:139], v[152:155]
    v_exp_f32 v245, v245
    v_mfma_f32_16x16x32_bf16 v[248:251], a[228:231], v[168:171], v[248:251]
    v_exp_f32 v246, v246
    v_mfma_f32_16x16x32_bf16 v[248:251], a[232:235], v[200:203], v[248:251]
    v_exp_f32 v247, v247
    v_mfma_f32_16x16x32_bf16 v[248:251], a[236:239], v[232:235], v[248:251]
    s_waitcnt lgkmcnt(0)
    v_cvt_pk_bf16_f32 v72, v244, v245
    v_cvt_pk_bf16_f32 v73, v246, v247
    v_mfma_f32_16x16x32_bf16 a[16:19], v[104:107], v[32:35], a[16:19]
    ds_read_b128 v[96:99], v2 offset:24576
    ds_read_b128 v[100:103], v2 offset:25600
    v_mfma_f32_16x16x32_bf16 a[16:19], v[108:111], v[36:39], a[16:19]
    v_mfma_f32_16x16x32_bf16 a[20:23], v[104:107], v[40:43], a[20:23]
    v_mfma_f32_16x16x32_bf16 a[20:23], v[108:111], v[44:47], a[20:23]
    v_exp_f32 v248, v248
    v_mfma_f32_16x16x32_bf16 v[252:255], a[224:227], v[140:143], v[156:159]
    v_exp_f32 v249, v249
    v_mfma_f32_16x16x32_bf16 v[252:255], a[228:231], v[172:175], v[252:255]
    v_exp_f32 v250, v250
    v_mfma_f32_16x16x32_bf16 v[252:255], a[232:235], v[204:207], v[252:255]
    v_exp_f32 v251, v251
    v_mfma_f32_16x16x32_bf16 v[252:255], a[236:239], v[236:239], v[252:255]
    v_cvt_pk_bf16_f32 v80, v248, v249
    v_cvt_pk_bf16_f32 v81, v250, v251
    v_mfma_f32_16x16x32_bf16 a[24:27], v[104:107], v[48:51], a[24:27]
    ds_read_b128 a[224:227], v2 offset:8192
    ds_read_b128 a[228:231], v2 offset:9216
    v_mfma_f32_16x16x32_bf16 a[24:27], v[108:111], v[52:55], a[24:27]
    buffer_load_dwordx4 v1, s[36:39], s77 offen offset:2048 sc1 lds
    v_mfma_f32_16x16x32_bf16 a[28:31], v[104:107], v[56:59], a[28:31]
    v_exp_f32 v252, v252
    v_mfma_f32_16x16x32_bf16 a[28:31], v[108:111], v[60:63], a[28:31]
    v_exp_f32 v253, v253
    v_mfma_f32_16x16x32_bf16 v[240:243], a[240:243], v[128:131], v[180:183]
    v_exp_f32 v254, v254
    v_mfma_f32_16x16x32_bf16 v[240:243], a[244:247], v[160:163], v[240:243]
    v_exp_f32 v255, v255
    v_mfma_f32_16x16x32_bf16 v[240:243], a[248:251], v[192:195], v[240:243]
    v_cvt_pk_bf16_f32 v88, v252, v253
    v_cvt_pk_bf16_f32 v89, v254, v255
    v_mfma_f32_16x16x32_bf16 v[240:243], a[252:255], v[224:227], v[240:243]
    ds_read_b128 a[232:235], v2 offset:10240
    ds_read_b128 a[236:239], v2 offset:11264
    v_mfma_f32_16x16x32_bf16 a[32:35], v[112:115], v[32:35], a[32:35]
    ds_read_b128 v[104:107], v2 offset:26624
    v_mfma_f32_16x16x32_bf16 a[32:35], v[116:119], v[36:39], a[32:35]
    ds_read_b128 v[108:111], v2 offset:27648
    v_mfma_f32_16x16x32_bf16 a[36:39], v[112:115], v[40:43], a[36:39]
    v_mfma_f32_16x16x32_bf16 a[36:39], v[116:119], v[44:47], a[36:39]
    v_exp_f32 v240, v240
    v_mfma_f32_16x16x32_bf16 v[244:247], a[240:243], v[132:135], v[148:151]
    v_exp_f32 v241, v241
    v_mfma_f32_16x16x32_bf16 v[244:247], a[244:247], v[164:167], v[244:247]
    v_exp_f32 v242, v242
    v_mfma_f32_16x16x32_bf16 v[244:247], a[248:251], v[196:199], v[244:247]
    v_exp_f32 v243, v243
    v_mfma_f32_16x16x32_bf16 v[244:247], a[252:255], v[228:231], v[244:247]
    buffer_load_dwordx4 v1, s[36:39], s77 offen offset:3072 sc1 lds
    v_mfma_f32_16x16x32_bf16 a[40:43], v[112:115], v[48:51], a[40:43]
    v_cvt_pk_bf16_f32 v66, v240, v241
    v_cvt_pk_bf16_f32 v67, v242, v243
    v_mfma_f32_16x16x32_bf16 a[40:43], v[116:119], v[52:55], a[40:43]
    v_mfma_f32_16x16x32_bf16 a[44:47], v[112:115], v[56:59], a[44:47]
    ds_read_b128 v[112:115], v2 offset:28672
    v_mfma_f32_16x16x32_bf16 a[44:47], v[116:119], v[60:63], a[44:47]
    v_exp_f32 v244, v244
    v_mfma_f32_16x16x32_bf16 v[248:251], a[240:243], v[136:139], v[152:155]
    v_exp_f32 v245, v245
    v_mfma_f32_16x16x32_bf16 v[248:251], a[244:247], v[168:171], v[248:251]
    v_exp_f32 v246, v246
    v_mfma_f32_16x16x32_bf16 v[248:251], a[248:251], v[200:203], v[248:251]
    v_exp_f32 v247, v247
    v_mfma_f32_16x16x32_bf16 v[248:251], a[252:255], v[232:235], v[248:251]
    v_cvt_pk_bf16_f32 v74, v244, v245
    v_cvt_pk_bf16_f32 v75, v246, v247
    v_mfma_f32_16x16x32_bf16 a[48:51], v[120:123], v[32:35], a[48:51]
    ds_read_b128 v[116:119], v2 offset:29696
    v_mfma_f32_16x16x32_bf16 a[48:51], v[124:127], v[36:39], a[48:51]
    v_mfma_f32_16x16x32_bf16 a[52:55], v[120:123], v[40:43], a[52:55]
    v_mfma_f32_16x16x32_bf16 a[52:55], v[124:127], v[44:47], a[52:55]
    v_mfma_f32_16x16x32_bf16 v[252:255], a[240:243], v[140:143], v[156:159]
    v_exp_f32 v248, v248
    v_mfma_f32_16x16x32_bf16 v[252:255], a[244:247], v[172:175], v[252:255]
    s_add_u32 s100, s77, 4096
    v_exp_f32 v249, v249
    v_mfma_f32_16x16x32_bf16 v[252:255], a[248:251], v[204:207], v[252:255]
    s_add_u32 m0, m0, 4096
    v_exp_f32 v250, v250
    v_mfma_f32_16x16x32_bf16 v[252:255], a[252:255], v[236:239], v[252:255]
    buffer_load_dwordx4 v1, s[36:39], s100 offen sc1 lds
    v_mfma_f32_16x16x32_bf16 a[56:59], v[120:123], v[48:51], a[56:59]
    v_exp_f32 v251, v251
    v_mfma_f32_16x16x32_bf16 a[56:59], v[124:127], v[52:55], a[56:59]
    v_cvt_pk_bf16_f32 v82, v248, v249
    v_cvt_pk_bf16_f32 v83, v250, v251
    v_mfma_f32_16x16x32_bf16 a[60:63], v[120:123], v[56:59], a[60:63]
    ds_read_b128 a[240:243], v2 offset:12288
    ds_read_b128 a[244:247], v2 offset:13312
    v_mfma_f32_16x16x32_bf16 a[60:63], v[124:127], v[60:63], a[60:63]
    s_waitcnt lgkmcnt(2)
    v_exp_f32 v252, v252
    v_mfma_f32_16x16x32_bf16 v[240:243], a[224:227], v[128:131], v[184:187]
    v_exp_f32 v253, v253
    v_mfma_f32_16x16x32_bf16 v[240:243], a[228:231], v[160:163], v[240:243]
    v_exp_f32 v254, v254
    v_mfma_f32_16x16x32_bf16 v[240:243], a[232:235], v[192:195], v[240:243]
    v_exp_f32 v255, v255
    v_mfma_f32_16x16x32_bf16 v[240:243], a[236:239], v[224:227], v[240:243]
    v_cvt_pk_bf16_f32 v90, v252, v253
    v_cvt_pk_bf16_f32 v91, v254, v255
    v_mfma_f32_16x16x32_bf16 a[144:147], v[96:99], v[32:35], a[144:147]
    ds_read_b128 a[248:251], v2 offset:14336
    ds_read_b128 a[252:255], v2 offset:15360
    v_mfma_f32_16x16x32_bf16 a[144:147], v[100:103], v[36:39], a[144:147]
    ds_read_b128 v[120:123], v2 offset:30720
    v_mfma_f32_16x16x32_bf16 a[148:151], v[96:99], v[40:43], a[148:151]
    v_exp_f32 v240, v240
    v_mfma_f32_16x16x32_bf16 a[148:151], v[100:103], v[44:47], a[148:151]
    v_exp_f32 v241, v241
    v_mfma_f32_16x16x32_bf16 v[244:247], a[224:227], v[132:135], v[148:151]
    buffer_load_dwordx4 v1, s[36:39], s100 offen offset:1024 sc1 lds
    v_mfma_f32_16x16x32_bf16 v[244:247], a[228:231], v[164:167], v[244:247]
    v_exp_f32 v242, v242
    v_mfma_f32_16x16x32_bf16 v[244:247], a[232:235], v[196:199], v[244:247]
    v_exp_f32 v243, v243
    v_mfma_f32_16x16x32_bf16 v[244:247], a[236:239], v[228:231], v[244:247]
    v_cvt_pk_bf16_f32 v68, v240, v241
    v_cvt_pk_bf16_f32 v69, v242, v243
    v_mfma_f32_16x16x32_bf16 a[152:155], v[96:99], v[48:51], a[152:155]
    ds_read_b128 v[124:127], v2 offset:31744
    v_mfma_f32_16x16x32_bf16 a[152:155], v[100:103], v[52:55], a[152:155]
    v_mfma_f32_16x16x32_bf16 a[156:159], v[96:99], v[56:59], a[156:159]
    v_mfma_f32_16x16x32_bf16 a[156:159], v[100:103], v[60:63], a[156:159]
    v_mfma_f32_16x16x32_bf16 v[248:251], a[224:227], v[136:139], v[152:155]
    v_exp_f32 v244, v244
    v_mfma_f32_16x16x32_bf16 v[248:251], a[228:231], v[168:171], v[248:251]
    v_exp_f32 v245, v245
    v_mfma_f32_16x16x32_bf16 v[248:251], a[232:235], v[200:203], v[248:251]
    v_exp_f32 v246, v246
    v_mfma_f32_16x16x32_bf16 v[248:251], a[236:239], v[232:235], v[248:251]
    v_exp_f32 v247, v247
    v_mfma_f32_16x16x32_bf16 a[160:163], v[104:107], v[32:35], a[160:163]
    v_cvt_pk_bf16_f32 v76, v244, v245
    v_cvt_pk_bf16_f32 v77, v246, v247
    v_mfma_f32_16x16x32_bf16 a[160:163], v[108:111], v[36:39], a[160:163]
    v_mfma_f32_16x16x32_bf16 a[164:167], v[104:107], v[40:43], a[164:167]
    buffer_load_dwordx4 v1, s[36:39], s100 offen offset:2048 sc1 lds
    v_mfma_f32_16x16x32_bf16 a[164:167], v[108:111], v[44:47], a[164:167]
    v_exp_f32 v248, v248
    v_mfma_f32_16x16x32_bf16 v[252:255], a[224:227], v[140:143], v[156:159]
    v_exp_f32 v249, v249
    v_mfma_f32_16x16x32_bf16 v[252:255], a[228:231], v[172:175], v[252:255]
    v_exp_f32 v250, v250
    v_mfma_f32_16x16x32_bf16 v[252:255], a[232:235], v[204:207], v[252:255]
    v_exp_f32 v251, v251
    v_mfma_f32_16x16x32_bf16 v[252:255], a[236:239], v[236:239], v[252:255]
    v_cvt_pk_bf16_f32 v84, v248, v249
    v_cvt_pk_bf16_f32 v85, v250, v251
    v_mfma_f32_16x16x32_bf16 a[168:171], v[104:107], v[48:51], a[168:171]
    v_mfma_f32_16x16x32_bf16 a[168:171], v[108:111], v[52:55], a[168:171]
    v_mfma_f32_16x16x32_bf16 a[172:175], v[104:107], v[56:59], a[172:175]
    v_mfma_f32_16x16x32_bf16 a[172:175], v[108:111], v[60:63], a[172:175]
    s_waitcnt lgkmcnt(0)
    v_mfma_f32_16x16x32_bf16 v[240:243], a[240:243], v[128:131], v[188:191]
    v_mfma_f32_16x16x32_bf16 v[240:243], a[244:247], v[160:163], v[240:243]
    v_exp_f32 v252, v252
    v_mfma_f32_16x16x32_bf16 v[240:243], a[248:251], v[192:195], v[240:243]
    v_exp_f32 v253, v253
    v_mfma_f32_16x16x32_bf16 v[240:243], a[252:255], v[224:227], v[240:243]
    v_exp_f32 v254, v254
    v_mfma_f32_16x16x32_bf16 a[176:179], v[112:115], v[32:35], a[176:179]
    buffer_load_dwordx4 v1, s[36:39], s100 offen offset:3072 sc1 lds
    v_mfma_f32_16x16x32_bf16 a[176:179], v[116:119], v[36:39], a[176:179]
    v_exp_f32 v255, v255
    v_mfma_f32_16x16x32_bf16 a[180:183], v[112:115], v[40:43], a[180:183]
    v_cvt_pk_bf16_f32 v92, v252, v253
    v_cvt_pk_bf16_f32 v93, v254, v255
    v_mfma_f32_16x16x32_bf16 a[180:183], v[116:119], v[44:47], a[180:183]
    s_cmp_eq_u32 s82, 163840
    s_cselect_b32 s82, 0, s82
    v_add_u32 v2, s82, v1
    v_mfma_f32_16x16x32_bf16 v[244:247], a[240:243], v[132:135], v[148:151]
    ds_read_b128 a[224:227], v2 offset:0
    ds_read_b128 a[228:231], v2 offset:1024
    v_mfma_f32_16x16x32_bf16 v[244:247], a[244:247], v[164:167], v[244:247]
    v_exp_f32 v240, v240
    v_mfma_f32_16x16x32_bf16 v[244:247], a[248:251], v[196:199], v[244:247]
    ds_read_b128 a[232:235], v2 offset:2048
    ds_read_b128 a[236:239], v2 offset:3072
    v_mfma_f32_16x16x32_bf16 v[244:247], a[252:255], v[228:231], v[244:247]
    v_exp_f32 v241, v241
    v_mfma_f32_16x16x32_bf16 a[184:187], v[112:115], v[48:51], a[184:187]
    ds_read_b128 v[96:99], v2 offset:16384
    ds_read_b128 v[100:103], v2 offset:17408
    v_mfma_f32_16x16x32_bf16 a[184:187], v[116:119], v[52:55], a[184:187]
    v_exp_f32 v242, v242
    v_mfma_f32_16x16x32_bf16 a[188:191], v[112:115], v[56:59], a[188:191]
    v_exp_f32 v243, v243
    v_mfma_f32_16x16x32_bf16 a[188:191], v[116:119], v[60:63], a[188:191]
    v_exp_f32 v244, v244
    v_mfma_f32_16x16x32_bf16 v[248:251], a[240:243], v[136:139], v[152:155]
    v_exp_f32 v245, v245
    v_mfma_f32_16x16x32_bf16 v[248:251], a[244:247], v[168:171], v[248:251]
    v_exp_f32 v246, v246
    v_mfma_f32_16x16x32_bf16 v[248:251], a[248:251], v[200:203], v[248:251]
    s_add_u32 s77, s77, 32768
    v_exp_f32 v247, v247
    v_mfma_f32_16x16x32_bf16 v[248:251], a[252:255], v[232:235], v[248:251]
    v_cvt_pk_bf16_f32 v70, v240, v241
    v_cvt_pk_bf16_f32 v71, v242, v243
    v_mfma_f32_16x16x32_bf16 a[192:195], v[120:123], v[32:35], a[192:195]
    v_cvt_pk_bf16_f32 v78, v244, v245
    v_cvt_pk_bf16_f32 v79, v246, v247
    v_mfma_f32_16x16x32_bf16 a[192:195], v[124:127], v[36:39], a[192:195]
    v_mfma_f32_16x16x32_bf16 a[196:199], v[120:123], v[40:43], a[196:199]
    v_mfma_f32_16x16x32_bf16 a[196:199], v[124:127], v[44:47], a[196:199]
    v_exp_f32 v248, v248
    v_mfma_f32_16x16x32_bf16 v[252:255], a[240:243], v[140:143], v[156:159]
    v_exp_f32 v249, v249
    v_mfma_f32_16x16x32_bf16 v[252:255], a[244:247], v[172:175], v[252:255]
    v_exp_f32 v250, v250
    v_mfma_f32_16x16x32_bf16 v[252:255], a[248:251], v[204:207], v[252:255]
    v_exp_f32 v251, v251
    v_mfma_f32_16x16x32_bf16 v[252:255], a[252:255], v[236:239], v[252:255]
    v_cvt_pk_bf16_f32 v86, v248, v249
    v_cvt_pk_bf16_f32 v87, v250, v251
    v_mfma_f32_16x16x32_bf16 a[200:203], v[120:123], v[48:51], a[200:203]
    v_mfma_f32_16x16x32_bf16 a[200:203], v[124:127], v[52:55], a[200:203]
    v_mfma_f32_16x16x32_bf16 a[204:207], v[120:123], v[56:59], a[204:207]
    v_mfma_f32_16x16x32_bf16 a[204:207], v[124:127], v[60:63], a[204:207]
    v_mfma_f32_16x16x32_bf16 a[208:211], a[136:139], v[32:35], a[208:211]
    v_mfma_f32_16x16x32_bf16 a[208:211], a[136:139], v[36:39], a[208:211]
    v_exp_f32 v252, v252
    v_mfma_f32_16x16x32_bf16 a[212:215], a[136:139], v[40:43], a[212:215]
    v_exp_f32 v253, v253
    v_mfma_f32_16x16x32_bf16 a[212:215], a[136:139], v[44:47], a[212:215]
    v_cvt_pk_bf16_f32 v94, v252, v253
    v_mfma_f32_16x16x32_bf16 a[216:219], a[136:139], v[48:51], a[216:219]
    v_mfma_f32_16x16x32_bf16 a[216:219], a[136:139], v[52:55], a[216:219]
    v_mfma_f32_16x16x32_bf16 a[220:223], a[136:139], v[56:59], a[220:223]
    v_mfma_f32_16x16x32_bf16 a[220:223], a[136:139], v[60:63], a[220:223]
    s_cmp_eq_u32 s78, 1
    s_cbranch_scc1 K1_LB_MASK
K1_LB_BACK:
    s_waitcnt lgkmcnt(0)
    v_mfma_f32_16x16x32_bf16 v[240:243], a[224:227], v[128:131], v[176:179]
    s_add_u32 m0, s76, s75
    v_exp_f32 v254, v254
    v_mfma_f32_16x16x32_bf16 v[240:243], a[228:231], v[160:163], v[240:243]
    s_mov_b32 s76, s60
    buffer_load_dwordx4 v1, s[36:39], s77 offen sc1 lds
    v_mfma_f32_16x16x32_bf16 v[240:243], a[232:235], v[192:195], v[240:243]
    s_mov_b32 s60, s82
    v_exp_f32 v255, v255
    v_mfma_f32_16x16x32_bf16 v[240:243], a[236:239], v[224:227], v[240:243]
    s_add_u32 s82, s82, 32768
    ds_read_b128 v[104:107], v2 offset:18432
    v_cvt_pk_bf16_f32 v95, v254, v255
    v_mfma_f32_16x16x32_bf16 a[0:3], v[96:99], v[64:67], a[0:3]
    ds_read_b128 v[108:111], v2 offset:19456
    ds_read_b128 a[240:243], v2 offset:4096
    v_mfma_f32_16x16x32_bf16 a[0:3], v[100:103], v[68:71], a[0:3]
    ds_read_b128 a[244:247], v2 offset:5120
    v_mfma_f32_16x16x32_bf16 a[4:7], v[96:99], v[72:75], a[4:7]
    v_exp_f32 v240, v240
    v_mfma_f32_16x16x32_bf16 a[4:7], v[100:103], v[76:79], a[4:7]
    ds_read_b128 a[248:251], v2 offset:6144
    ds_read_b128 a[252:255], v2 offset:7168
    v_mfma_f32_16x16x32_bf16 v[244:247], a[224:227], v[132:135], v[148:151]
    v_exp_f32 v241, v241
    v_mfma_f32_16x16x32_bf16 v[244:247], a[228:231], v[164:167], v[244:247]
    ds_read_b128 v[112:115], v2 offset:20480
    ds_read_b128 v[116:119], v2 offset:21504
    v_mfma_f32_16x16x32_bf16 v[244:247], a[232:235], v[196:199], v[244:247]
    v_exp_f32 v242, v242
    v_mfma_f32_16x16x32_bf16 v[244:247], a[236:239], v[228:231], v[244:247]
    v_exp_f32 v243, v243
    v_mfma_f32_16x16x32_bf16 a[8:11], v[96:99], v[80:83], a[8:11]
    v_cvt_pk_bf16_f32 v32, v240, v241
    v_cvt_pk_bf16_f32 v33, v242, v243
    v_mfma_f32_16x16x32_bf16 a[8:11], v[100:103], v[84:87], a[8:11]
    ds_read_b128 v[120:123], v2 offset:22528
    ds_read_b128 v[124:127], v2 offset:23552
    v_mfma_f32_16x16x32_bf16 a[12:15], v[96:99], v[88:91], a[12:15]
    v_exp_f32 v244, v244
    v_mfma_f32_16x16x32_bf16 a[12:15], v[100:103], v[92:95], a[12:15]
    buffer_load_dwordx4 v1, s[36:39], s77 offen offset:1024 sc1 lds
    v_mfma_f32_16x16x32_bf16 v[248:251], a[224:227], v[136:139], v[152:155]
    v_exp_f32 v245, v245
    v_mfma_f32_16x16x32_bf16 v[248:251], a[228:231], v[168:171], v[248:251]
    v_exp_f32 v246, v246
    v_mfma_f32_16x16x32_bf16 v[248:251], a[232:235], v[200:203], v[248:251]
    v_exp_f32 v247, v247
    v_mfma_f32_16x16x32_bf16 v[248:251], a[236:239], v[232:235], v[248:251]
    s_waitcnt lgkmcnt(0)
    v_cvt_pk_bf16_f32 v40, v244, v245
    v_cvt_pk_bf16_f32 v41, v246, v247
    v_mfma_f32_16x16x32_bf16 a[16:19], v[104:107], v[64:67], a[16:19]
    ds_read_b128 v[96:99], v2 offset:24576
    ds_read_b128 v[100:103], v2 offset:25600
    v_mfma_f32_16x16x32_bf16 a[16:19], v[108:111], v[68:71], a[16:19]
    v_mfma_f32_16x16x32_bf16 a[20:23], v[104:107], v[72:75], a[20:23]
    v_mfma_f32_16x16x32_bf16 a[20:23], v[108:111], v[76:79], a[20:23]
    v_exp_f32 v248, v248
    v_mfma_f32_16x16x32_bf16 v[252:255], a[224:227], v[140:143], v[156:159]
    v_exp_f32 v249, v249
    v_mfma_f32_16x16x32_bf16 v[252:255], a[228:231], v[172:175], v[252:255]
    v_exp_f32 v250, v250
    v_mfma_f32_16x16x32_bf16 v[252:255], a[232:235], v[204:207], v[252:255]
    v_exp_f32 v251, v251
    v_mfma_f32_16x16x32_bf16 v[252:255], a[236:239], v[236:239], v[252:255]
    v_cvt_pk_bf16_f32 v48, v248, v249
    v_cvt_pk_bf16_f32 v49, v250, v251
    v_mfma_f32_16x16x32_bf16 a[24:27], v[104:107], v[80:83], a[24:27]
    ds_read_b128 a[224:227], v2 offset:8192
    ds_read_b128 a[228:231], v2 offset:9216
    v_mfma_f32_16x16x32_bf16 a[24:27], v[108:111], v[84:87], a[24:27]
    buffer_load_dwordx4 v1, s[36:39], s77 offen offset:2048 sc1 lds
    v_mfma_f32_16x16x32_bf16 a[28:31], v[104:107], v[88:91], a[28:31]
    v_exp_f32 v252, v252
    v_mfma_f32_16x16x32_bf16 a[28:31], v[108:111], v[92:95], a[28:31]
    v_exp_f32 v253, v253
    v_mfma_f32_16x16x32_bf16 v[240:243], a[240:243], v[128:131], v[180:183]
    v_exp_f32 v254, v254
    v_mfma_f32_16x16x32_bf16 v[240:243], a[244:247], v[160:163], v[240:243]
    v_exp_f32 v255, v255
    v_mfma_f32_16x16x32_bf16 v[240:243], a[248:251], v[192:195], v[240:243]
    v_cvt_pk_bf16_f32 v56, v252, v253
    v_cvt_pk_bf16_f32 v57, v254, v255
    v_mfma_f32_16x16x32_bf16 v[240:243], a[252:255], v[224:227], v[240:243]
    ds_read_b128 a[232:235], v2 offset:10240
    ds_read_b128 a[236:239], v2 offset:11264
    v_mfma_f32_16x16x32_bf16 a[32:35], v[112:115], v[64:67], a[32:35]
    ds_read_b128 v[104:107], v2 offset:26624
    v_mfma_f32_16x16x32_bf16 a[32:35], v[116:119], v[68:71], a[32:35]
    ds_read_b128 v[108:111], v2 offset:27648
    v_mfma_f32_16x16x32_bf16 a[36:39], v[112:115], v[72:75], a[36:39]
    v_mfma_f32_16x16x32_bf16 a[36:39], v[116:119], v[76:79], a[36:39]
    v_exp_f32 v240, v240
    v_mfma_f32_16x16x32_bf16 v[244:247], a[240:243], v[132:135], v[148:151]
    v_exp_f32 v241, v241
    v_mfma_f32_16x16x32_bf16 v[244:247], a[244:247], v[164:167], v[244:247]
    v_exp_f32 v242, v242
    v_mfma_f32_16x16x32_bf16 v[244:247], a[248:251], v[196:199], v[244:247]
    v_exp_f32 v243, v243
    v_mfma_f32_16x16x32_bf16 v[244:247], a[252:255], v[228:231], v[244:247]
    buffer_load_dwordx4 v1, s[36:39], s77 offen offset:3072 sc1 lds
    v_mfma_f32_16x16x32_bf16 a[40:43], v[112:115], v[80:83], a[40:43]
    v_cvt_pk_bf16_f32 v34, v240, v241
    v_cvt_pk_bf16_f32 v35, v242, v243
    v_mfma_f32_16x16x32_bf16 a[40:43], v[116:119], v[84:87], a[40:43]
    v_mfma_f32_16x16x32_bf16 a[44:47], v[112:115], v[88:91], a[44:47]
    ds_read_b128 v[112:115], v2 offset:28672
    v_mfma_f32_16x16x32_bf16 a[44:47], v[116:119], v[92:95], a[44:47]
    v_exp_f32 v244, v244
    v_mfma_f32_16x16x32_bf16 v[248:251], a[240:243], v[136:139], v[152:155]
    v_exp_f32 v245, v245
    v_mfma_f32_16x16x32_bf16 v[248:251], a[244:247], v[168:171], v[248:251]
    v_exp_f32 v246, v246
    v_mfma_f32_16x16x32_bf16 v[248:251], a[248:251], v[200:203], v[248:251]
    v_exp_f32 v247, v247
    v_mfma_f32_16x16x32_bf16 v[248:251], a[252:255], v[232:235], v[248:251]
    v_cvt_pk_bf16_f32 v42, v244, v245
    v_cvt_pk_bf16_f32 v43, v246, v247
    v_mfma_f32_16x16x32_bf16 a[48:51], v[120:123], v[64:67], a[48:51]
    ds_read_b128 v[116:119], v2 offset:29696
    v_mfma_f32_16x16x32_bf16 a[48:51], v[124:127], v[68:71], a[48:51]
    v_mfma_f32_16x16x32_bf16 a[52:55], v[120:123], v[72:75], a[52:55]
    v_mfma_f32_16x16x32_bf16 a[52:55], v[124:127], v[76:79], a[52:55]
    v_mfma_f32_16x16x32_bf16 v[252:255], a[240:243], v[140:143], v[156:159]
    v_exp_f32 v248, v248
    v_mfma_f32_16x16x32_bf16 v[252:255], a[244:247], v[172:175], v[252:255]
    s_add_u32 s100, s77, 4096
    v_exp_f32 v249, v249
    v_mfma_f32_16x16x32_bf16 v[252:255], a[248:251], v[204:207], v[252:255]
    s_add_u32 m0, m0, 4096
    v_exp_f32 v250, v250
    v_mfma_f32_16x16x32_bf16 v[252:255], a[252:255], v[236:239], v[252:255]
    buffer_load_dwordx4 v1, s[36:39], s100 offen sc1 lds
    v_mfma_f32_16x16x32_bf16 a[56:59], v[120:123], v[80:83], a[56:59]
    v_exp_f32 v251, v251
    v_mfma_f32_16x16x32_bf16 a[56:59], v[124:127], v[84:87], a[56:59]
    v_cvt_pk_bf16_f32 v50, v248, v249
    v_cvt_pk_bf16_f32 v51, v250, v251
    v_mfma_f32_16x16x32_bf16 a[60:63], v[120:123], v[88:91], a[60:63]
    ds_read_b128 a[240:243], v2 offset:12288
    ds_read_b128 a[244:247], v2 offset:13312
    v_mfma_f32_16x16x32_bf16 a[60:63], v[124:127], v[92:95], a[60:63]
    s_waitcnt lgkmcnt(2)
    v_exp_f32 v252, v252
    v_mfma_f32_16x16x32_bf16 v[240:243], a[224:227], v[128:131], v[184:187]
    v_exp_f32 v253, v253
    v_mfma_f32_16x16x32_bf16 v[240:243], a[228:231], v[160:163], v[240:243]
    v_exp_f32 v254, v254
    v_mfma_f32_16x16x32_bf16 v[240:243], a[232:235], v[192:195], v[240:243]
    v_exp_f32 v255, v255
    v_mfma_f32_16x16x32_bf16 v[240:243], a[236:239], v[224:227], v[240:243]
    v_cvt_pk_bf16_f32 v58, v252, v253
    v_cvt_pk_bf16_f32 v59, v254, v255
    v_mfma_f32_16x16x32_bf16 a[144:147], v[96:99], v[64:67], a[144:147]
    ds_read_b128 a[248:251], v2 offset:14336
    ds_read_b128 a[252:255], v2 offset:15360
    v_mfma_f32_16x16x32_bf16 a[144:147], v[100:103], v[68:71], a[144:147]
    ds_read_b128 v[120:123], v2 offset:30720
    v_mfma_f32_16x16x32_bf16 a[148:151], v[96:99], v[72:75], a[148:151]
    v_exp_f32 v240, v240
    v_mfma_f32_16x16x32_bf16 a[148:151], v[100:103], v[76:79], a[148:151]
    v_exp_f32 v241, v241
    v_mfma_f32_16x16x32_bf16 v[244:247], a[224:227], v[132:135], v[148:151]
    buffer_load_dwordx4 v1, s[36:39], s100 offen offset:1024 sc1 lds
    v_mfma_f32_16x16x32_bf16 v[244:247], a[228:231], v[164:167], v[244:247]
    v_exp_f32 v242, v242
    v_mfma_f32_16x16x32_bf16 v[244:247], a[232:235], v[196:199], v[244:247]
    v_exp_f32 v243, v243
    v_mfma_f32_16x16x32_bf16 v[244:247], a[236:239], v[228:231], v[244:247]
    v_cvt_pk_bf16_f32 v36, v240, v241
    v_cvt_pk_bf16_f32 v37, v242, v243
    v_mfma_f32_16x16x32_bf16 a[152:155], v[96:99], v[80:83], a[152:155]
    ds_read_b128 v[124:127], v2 offset:31744
    v_mfma_f32_16x16x32_bf16 a[152:155], v[100:103], v[84:87], a[152:155]
    v_mfma_f32_16x16x32_bf16 a[156:159], v[96:99], v[88:91], a[156:159]
    v_mfma_f32_16x16x32_bf16 a[156:159], v[100:103], v[92:95], a[156:159]
    v_mfma_f32_16x16x32_bf16 v[248:251], a[224:227], v[136:139], v[152:155]
    v_exp_f32 v244, v244
    v_mfma_f32_16x16x32_bf16 v[248:251], a[228:231], v[168:171], v[248:251]
    v_exp_f32 v245, v245
    v_mfma_f32_16x16x32_bf16 v[248:251], a[232:235], v[200:203], v[248:251]
    v_exp_f32 v246, v246
    v_mfma_f32_16x16x32_bf16 v[248:251], a[236:239], v[232:235], v[248:251]
    v_exp_f32 v247, v247
    v_mfma_f32_16x16x32_bf16 a[160:163], v[104:107], v[64:67], a[160:163]
    v_cvt_pk_bf16_f32 v44, v244, v245
    v_cvt_pk_bf16_f32 v45, v246, v247
    v_mfma_f32_16x16x32_bf16 a[160:163], v[108:111], v[68:71], a[160:163]
    v_mfma_f32_16x16x32_bf16 a[164:167], v[104:107], v[72:75], a[164:167]
    buffer_load_dwordx4 v1, s[36:39], s100 offen offset:2048 sc1 lds
    v_mfma_f32_16x16x32_bf16 a[164:167], v[108:111], v[76:79], a[164:167]
    v_exp_f32 v248, v248
    v_mfma_f32_16x16x32_bf16 v[252:255], a[224:227], v[140:143], v[156:159]
    v_exp_f32 v249, v249
    v_mfma_f32_16x16x32_bf16 v[252:255], a[228:231], v[172:175], v[252:255]
    v_exp_f32 v250, v250
    v_mfma_f32_16x16x32_bf16 v[252:255], a[232:235], v[204:207], v[252:255]
    v_exp_f32 v251, v251
    v_mfma_f32_16x16x32_bf16 v[252:255], a[236:239], v[236:239], v[252:255]
    v_cvt_pk_bf16_f32 v52, v248, v249
    v_cvt_pk_bf16_f32 v53, v250, v251
    v_mfma_f32_16x16x32_bf16 a[168:171], v[104:107], v[80:83], a[168:171]
    v_mfma_f32_16x16x32_bf16 a[168:171], v[108:111], v[84:87], a[168:171]
    v_mfma_f32_16x16x32_bf16 a[172:175], v[104:107], v[88:91], a[172:175]
    v_mfma_f32_16x16x32_bf16 a[172:175], v[108:111], v[92:95], a[172:175]
    s_waitcnt lgkmcnt(0)
    v_mfma_f32_16x16x32_bf16 v[240:243], a[240:243], v[128:131], v[188:191]
    v_mfma_f32_16x16x32_bf16 v[240:243], a[244:247], v[160:163], v[240:243]
    v_exp_f32 v252, v252
    v_mfma_f32_16x16x32_bf16 v[240:243], a[248:251], v[192:195], v[240:243]
    v_exp_f32 v253, v253
    v_mfma_f32_16x16x32_bf16 v[240:243], a[252:255], v[224:227], v[240:243]
    v_exp_f32 v254, v254
    v_mfma_f32_16x16x32_bf16 a[176:179], v[112:115], v[64:67], a[176:179]
    buffer_load_dwordx4 v1, s[36:39], s100 offen offset:3072 sc1 lds
    v_mfma_f32_16x16x32_bf16 a[176:179], v[116:119], v[68:71], a[176:179]
    v_exp_f32 v255, v255
    v_mfma_f32_16x16x32_bf16 a[180:183], v[112:115], v[72:75], a[180:183]
    v_cvt_pk_bf16_f32 v60, v252, v253
    v_cvt_pk_bf16_f32 v61, v254, v255
    v_mfma_f32_16x16x32_bf16 a[180:183], v[116:119], v[76:79], a[180:183]
    s_cmp_eq_u32 s82, 163840
    s_cselect_b32 s82, 0, s82
    v_add_u32 v2, s82, v1
    v_mfma_f32_16x16x32_bf16 v[244:247], a[240:243], v[132:135], v[148:151]
    v_exp_f32 v240, v240
    v_mfma_f32_16x16x32_bf16 v[244:247], a[244:247], v[164:167], v[244:247]
    v_exp_f32 v241, v241
    v_mfma_f32_16x16x32_bf16 v[244:247], a[248:251], v[196:199], v[244:247]
    v_exp_f32 v242, v242
    v_mfma_f32_16x16x32_bf16 v[244:247], a[252:255], v[228:231], v[244:247]
    v_exp_f32 v243, v243
    v_mfma_f32_16x16x32_bf16 a[184:187], v[112:115], v[80:83], a[184:187]
    v_cvt_pk_bf16_f32 v38, v240, v241
    v_cvt_pk_bf16_f32 v39, v242, v243
    v_mfma_f32_16x16x32_bf16 a[184:187], v[116:119], v[84:87], a[184:187]
    v_mfma_f32_16x16x32_bf16 a[188:191], v[112:115], v[88:91], a[188:191]
    v_mfma_f32_16x16x32_bf16 a[188:191], v[116:119], v[92:95], a[188:191]
    v_mfma_f32_16x16x32_bf16 v[248:251], a[240:243], v[136:139], v[152:155]
    v_exp_f32 v244, v244
    v_mfma_f32_16x16x32_bf16 v[248:251], a[244:247], v[168:171], v[248:251]
    v_exp_f32 v245, v245
    v_mfma_f32_16x16x32_bf16 v[248:251], a[248:251], v[200:203], v[248:251]
    s_add_u32 s77, s77, 32768
    v_exp_f32 v246, v246
    v_mfma_f32_16x16x32_bf16 v[248:251], a[252:255], v[232:235], v[248:251]
    v_exp_f32 v247, v247
    v_mfma_f32_16x16x32_bf16 a[192:195], v[120:123], v[64:67], a[192:195]
    v_cvt_pk_bf16_f32 v46, v244, v245
    v_cvt_pk_bf16_f32 v47, v246, v247
    v_mfma_f32_16x16x32_bf16 a[192:195], v[124:127], v[68:71], a[192:195]
    v_mfma_f32_16x16x32_bf16 a[196:199], v[120:123], v[72:75], a[196:199]
    v_mfma_f32_16x16x32_bf16 a[196:199], v[124:127], v[76:79], a[196:199]
    v_mfma_f32_16x16x32_bf16 v[252:255], a[240:243], v[140:143], v[156:159]
    v_exp_f32 v248, v248
    v_mfma_f32_16x16x32_bf16 v[252:255], a[244:247], v[172:175], v[252:255]
    v_exp_f32 v249, v249
    v_mfma_f32_16x16x32_bf16 v[252:255], a[248:251], v[204:207], v[252:255]
    v_exp_f32 v250, v250
    v_mfma_f32_16x16x32_bf16 v[252:255], a[252:255], v[236:239], v[252:255]
    s_waitcnt vmcnt(8) lgkmcnt(0)
    s_barrier
    ds_read_b128 a[224:227], v2 offset:0
    v_mfma_f32_16x16x32_bf16 a[200:203], v[120:123], v[80:83], a[200:203]
    ds_read_b128 a[228:231], v2 offset:1024
    ds_read_b128 a[232:235], v2 offset:2048
    v_mfma_f32_16x16x32_bf16 a[200:203], v[124:127], v[84:87], a[200:203]
    ds_read_b128 a[236:239], v2 offset:3072
    v_cvt_pk_bf16_f32 v54, v248, v249
    v_mfma_f32_16x16x32_bf16 a[204:207], v[120:123], v[88:91], a[204:207]
    v_exp_f32 v251, v251
    v_mfma_f32_16x16x32_bf16 a[204:207], v[124:127], v[92:95], a[204:207]
    ds_read_b128 v[96:99], v2 offset:16384
    ds_read_b128 v[100:103], v2 offset:17408
    v_mfma_f32_16x16x32_bf16 a[208:211], a[136:139], v[64:67], a[208:211]
    v_exp_f32 v252, v252
    v_mfma_f32_16x16x32_bf16 a[208:211], a[136:139], v[68:71], a[208:211]
    v_exp_f32 v253, v253
    v_mfma_f32_16x16x32_bf16 a[212:215], a[136:139], v[72:75], a[212:215]
    v_cvt_pk_bf16_f32 v55, v250, v251
    v_cvt_pk_bf16_f32 v62, v252, v253
    v_mfma_f32_16x16x32_bf16 a[212:215], a[136:139], v[76:79], a[212:215]
    v_mfma_f32_16x16x32_bf16 a[216:219], a[136:139], v[80:83], a[216:219]
    v_mfma_f32_16x16x32_bf16 a[216:219], a[136:139], v[84:87], a[216:219]
    v_mfma_f32_16x16x32_bf16 a[220:223], a[136:139], v[88:91], a[220:223]
    v_mfma_f32_16x16x32_bf16 a[220:223], a[136:139], v[92:95], a[220:223]
    s_sub_u32 s78, s78, 1
    s_cmp_lg_u32 s78, 0
    s_cbranch_scc1 K1_LB
K1_LB_END:
    v_add_f32 v212, s12, v148
    v_fma_f32 v176, v208, s8, v212
    v_fma_f32 v177, v209, s8, v212
    v_fma_f32 v178, v210, s8, v212
    v_fma_f32 v179, v211, s8, v212
    s_nop 1
    s_waitcnt lgkmcnt(0)
    v_mfma_f32_16x16x32_bf16 v[240:243], a[224:227], v[132:135], v[176:179]
    s_mov_b32 s7, 0
    ds_read_b128 v[104:107], v2 offset:18432
    ds_read_b128 v[108:111], v2 offset:19456
    v_mfma_f32_16x16x32_bf16 v[240:243], a[228:231], v[164:167], v[240:243]
    s_mov_b32 s98, 0x3fb8aa3b
    buffer_load_dwordx4 v[64:67], v11, s[48:51], s7 offen nt
    v_mfma_f32_16x16x32_bf16 v[240:243], a[232:235], v[196:199], v[240:243]
    s_mov_b32 s7, 18432
    v_exp_f32 v254, v254
    v_mfma_f32_16x16x32_bf16 v[240:243], a[236:239], v[228:231], v[240:243]
    v_exp_f32 v255, v255
    v_mfma_f32_16x16x32_bf16 a[0:3], v[96:99], v[32:35], a[0:3]
    v_cvt_pk_bf16_f32 v63, v254, v255
    ds_read_b128 a[240:243], v2 offset:4096
    v_mfma_f32_16x16x32_bf16 a[0:3], v[100:103], v[36:39], a[0:3]
    buffer_load_dwordx4 v[68:71], v11, s[48:51], s7 offen nt
    v_mfma_f32_16x16x32_bf16 a[4:7], v[96:99], v[40:43], a[4:7]
    s_mov_b32 s7, 9216
    ds_read_b128 a[244:247], v2 offset:5120
    ds_read_b128 a[248:251], v2 offset:6144
    v_mfma_f32_16x16x32_bf16 a[4:7], v[100:103], v[44:47], a[4:7]
    ds_read_b128 a[252:255], v2 offset:7168
    v_add_f32 v213, s13, v148
    v_mfma_f32_16x16x32_bf16 v[244:247], a[224:227], v[136:139], v[152:155]
    ds_read_b128 v[112:115], v2 offset:20480
    v_fma_f32 v180, v208, s9, v213
    v_mfma_f32_16x16x32_bf16 v[244:247], a[228:231], v[168:171], v[244:247]
    buffer_load_dwordx4 v[20:23], v11, s[48:51], s7 offen nt
    v_mfma_f32_16x16x32_bf16 v[244:247], a[232:235], v[200:203], v[244:247]
    s_mov_b32 s7, 27648
    ds_read_b128 v[116:119], v2 offset:21504
    v_fma_f32 v181, v209, s9, v213
    v_mfma_f32_16x16x32_bf16 v[244:247], a[236:239], v[232:235], v[244:247]
    v_fma_f32 v182, v210, s9, v213
    v_fma_f32 v183, v211, s9, v213
    v_mfma_f32_16x16x32_bf16 a[8:11], v[96:99], v[48:51], a[8:11]
    v_exp_f32 v240, v240
    v_mfma_f32_16x16x32_bf16 a[8:11], v[100:103], v[52:55], a[8:11]
    buffer_load_dwordx4 v[24:27], v11, s[48:51], s7 offen nt
    v_mfma_f32_16x16x32_bf16 a[12:15], v[96:99], v[56:59], a[12:15]
    v_exp_f32 v241, v241
    v_mfma_f32_16x16x32_bf16 a[12:15], v[100:103], v[60:63], a[12:15]
    s_waitcnt lgkmcnt(0)
    v_exp_f32 v242, v242
    v_mfma_f32_16x16x32_bf16 a[16:19], v[104:107], v[32:35], a[16:19]
    v_exp_f32 v243, v243
    v_mfma_f32_16x16x32_bf16 a[16:19], v[108:111], v[36:39], a[16:19]
    buffer_load_dwordx4 v[144:147], v12, s[52:55], 0 offen nt
    v_mfma_f32_16x16x32_bf16 v[248:251], a[224:227], v[140:143], v[156:159]
    v_cvt_pk_bf16_f32 v72, v240, v241
    v_cvt_pk_bf16_f32 v73, v242, v243
    v_mfma_f32_16x16x32_bf16 v[248:251], a[228:231], v[172:175], v[248:251]
    ds_read_b128 v[120:123], v2 offset:22528
    ds_read_b128 v[124:127], v2 offset:23552
    v_mfma_f32_16x16x32_bf16 v[248:251], a[232:235], v[204:207], v[248:251]
    v_exp_f32 v244, v244
    v_mfma_f32_16x16x32_bf16 v[248:251], a[236:239], v[236:239], v[248:251]
    buffer_load_dwordx4 a[140:143], v13, s[52:55], 0 offen nt
    v_mfma_f32_16x16x32_bf16 a[20:23], v[104:107], v[40:43], a[20:23]
    v_exp_f32 v245, v245
    v_mfma_f32_16x16x32_bf16 a[20:23], v[108:111], v[44:47], a[20:23]
    v_exp_f32 v246, v246
    v_mfma_f32_16x16x32_bf16 a[24:27], v[104:107], v[48:51], a[24:27]
    v_exp_f32 v247, v247
    v_mfma_f32_16x16x32_bf16 a[24:27], v[108:111], v[52:55], a[24:27]
    v_cvt_pk_bf16_f32 v80, v244, v245
    v_cvt_pk_bf16_f32 v81, v246, v247
    v_mfma_f32_16x16x32_bf16 a[28:31], v[104:107], v[56:59], a[28:31]
    ds_read_b128 a[224:227], v2 offset:8192
    ds_read_b128 a[228:231], v2 offset:9216
    v_mfma_f32_16x16x32_bf16 a[28:31], v[108:111], v[60:63], a[28:31]
    ds_read_b128 a[232:235], v2 offset:10240
    v_add_f32 v214, s14, v148
    v_mfma_f32_16x16x32_bf16 v[252:255], a[240:243], v[132:135], v[180:183]
    ds_read_b128 a[236:239], v2 offset:11264
    v_fma_f32 v184, v208, s10, v214
    v_mfma_f32_16x16x32_bf16 v[252:255], a[244:247], v[164:167], v[252:255]
    ds_read_b128 v[96:99], v2 offset:24576
    v_fma_f32 v185, v209, s10, v214
    v_mfma_f32_16x16x32_bf16 v[252:255], a[248:251], v[196:199], v[252:255]
    ds_read_b128 v[100:103], v2 offset:25600
    v_fma_f32 v186, v210, s10, v214
    v_mfma_f32_16x16x32_bf16 v[252:255], a[252:255], v[228:231], v[252:255]
    v_exp_f32 v248, v248
    v_mfma_f32_16x16x32_bf16 a[32:35], v[112:115], v[32:35], a[32:35]
    v_exp_f32 v249, v249
    v_mfma_f32_16x16x32_bf16 a[32:35], v[116:119], v[36:39], a[32:35]
    v_exp_f32 v250, v250
    v_mfma_f32_16x16x32_bf16 a[36:39], v[112:115], v[40:43], a[36:39]
    v_exp_f32 v251, v251
    v_mfma_f32_16x16x32_bf16 a[36:39], v[116:119], v[44:47], a[36:39]
    v_fma_f32 v187, v211, s10, v214
    v_cvt_pk_bf16_f32 v88, v248, v249
    v_mfma_f32_16x16x32_bf16 v[240:243], a[240:243], v[136:139], v[152:155]
    v_cvt_pk_bf16_f32 v89, v250, v251
    ds_read_b128 v[104:107], v2 offset:26624
    v_mfma_f32_16x16x32_bf16 v[240:243], a[244:247], v[168:171], v[240:243]
    v_exp_f32 v252, v252
    v_mfma_f32_16x16x32_bf16 v[240:243], a[248:251], v[200:203], v[240:243]
    v_exp_f32 v253, v253
    v_mfma_f32_16x16x32_bf16 v[240:243], a[252:255], v[232:235], v[240:243]
    v_exp_f32 v254, v254
    v_mfma_f32_16x16x32_bf16 a[40:43], v[112:115], v[48:51], a[40:43]
    v_exp_f32 v255, v255
    v_mfma_f32_16x16x32_bf16 a[40:43], v[116:119], v[52:55], a[40:43]
    v_cvt_pk_bf16_f32 v74, v252, v253
    v_cvt_pk_bf16_f32 v75, v254, v255
    v_mfma_f32_16x16x32_bf16 a[44:47], v[112:115], v[56:59], a[44:47]
    ds_read_b128 v[108:111], v2 offset:27648
    ds_read_b128 v[112:115], v2 offset:28672
    v_mfma_f32_16x16x32_bf16 a[44:47], v[116:119], v[60:63], a[44:47]
    s_waitcnt lgkmcnt(2)
    v_exp_f32 v240, v240
    v_mfma_f32_16x16x32_bf16 a[48:51], v[120:123], v[32:35], a[48:51]
    v_exp_f32 v241, v241
    v_mfma_f32_16x16x32_bf16 a[48:51], v[124:127], v[36:39], a[48:51]
    v_exp_f32 v242, v242
    v_mfma_f32_16x16x32_bf16 v[244:247], a[240:243], v[140:143], v[156:159]
    v_exp_f32 v243, v243
    v_mfma_f32_16x16x32_bf16 v[244:247], a[244:247], v[172:175], v[244:247]
    v_cvt_pk_bf16_f32 v82, v240, v241
    v_cvt_pk_bf16_f32 v83, v242, v243
    v_mfma_f32_16x16x32_bf16 v[244:247], a[248:251], v[204:207], v[244:247]
    ds_read_b128 a[240:243], v2 offset:12288
    ds_read_b128 a[244:247], v2 offset:13312
    v_mfma_f32_16x16x32_bf16 v[244:247], a[252:255], v[236:239], v[244:247]
    ds_read_b128 a[248:251], v2 offset:14336
    v_add_f32 v215, s15, v148
    v_mfma_f32_16x16x32_bf16 a[52:55], v[120:123], v[40:43], a[52:55]
    ds_read_b128 a[252:255], v2 offset:15360
    v_fma_f32 v188, v208, s11, v215
    v_mfma_f32_16x16x32_bf16 a[52:55], v[124:127], v[44:47], a[52:55]
    ds_read_b128 v[116:119], v2 offset:29696
    v_fma_f32 v189, v209, s11, v215
    v_mfma_f32_16x16x32_bf16 a[56:59], v[120:123], v[48:51], a[56:59]
    v_exp_f32 v244, v244
    v_mfma_f32_16x16x32_bf16 a[56:59], v[124:127], v[52:55], a[56:59]
    v_exp_f32 v245, v245
    v_mfma_f32_16x16x32_bf16 a[60:63], v[120:123], v[56:59], a[60:63]
    v_exp_f32 v246, v246
    v_mfma_f32_16x16x32_bf16 a[60:63], v[124:127], v[60:63], a[60:63]
    v_exp_f32 v247, v247
    v_mfma_f32_16x16x32_bf16 v[248:251], a[224:227], v[132:135], v[184:187]
    v_fma_f32 v190, v210, s11, v215
    v_fma_f32 v191, v211, s11, v215
    v_mfma_f32_16x16x32_bf16 v[248:251], a[228:231], v[164:167], v[248:251]
    v_cvt_pk_bf16_f32 v90, v244, v245
    v_cvt_pk_bf16_f32 v91, v246, v247
    v_mfma_f32_16x16x32_bf16 v[248:251], a[232:235], v[196:199], v[248:251]
    ds_read_b128 v[120:123], v2 offset:30720
    ds_read_b128 v[124:127], v2 offset:31744
    v_mfma_f32_16x16x32_bf16 v[248:251], a[236:239], v[228:231], v[248:251]
    s_add_u32 m0, s76, s75
    v_bfe_u32 v8, v1, 2, 6
    v_accvgpr_read_b32 v4, a112
    v_mfma_f32_16x16x32_bf16 a[144:147], v[96:99], v[32:35], a[144:147]
    s_mov_b32 s76, s60
    buffer_load_dwordx4 v1, s[36:39], s77 offen sc1 lds
    v_mfma_f32_16x16x32_bf16 a[144:147], v[100:103], v[36:39], a[144:147]
    s_mov_b32 s60, s82
    v_exp_f32 v248, v248
    v_mfma_f32_16x16x32_bf16 a[148:151], v[96:99], v[40:43], a[148:151]
    s_add_u32 s82, s82, 32768
    v_exp_f32 v249, v249
    v_mfma_f32_16x16x32_bf16 a[148:151], v[100:103], v[44:47], a[148:151]
    v_exp_f32 v250, v250
    v_mfma_f32_16x16x32_bf16 v[252:255], a[224:227], v[136:139], v[152:155]
    v_exp_f32 v251, v251
    v_mfma_f32_16x16x32_bf16 v[252:255], a[228:231], v[168:171], v[252:255]
    v_cvt_pk_bf16_f32 v76, v248, v249
    v_cvt_pk_bf16_f32 v77, v250, v251
    v_mfma_f32_16x16x32_bf16 v[252:255], a[232:235], v[200:203], v[252:255]
    s_cmp_eq_u32 s82, 163840
    s_cselect_b32 s82, 0, s82
    v_add_u32 v2, s82, v1
    v_mfma_f32_16x16x32_bf16 v[252:255], a[236:239], v[232:235], v[252:255]
    buffer_load_dwordx4 v1, s[36:39], s77 offen offset:1024 sc1 lds
    v_mfma_f32_16x16x32_bf16 a[152:155], v[96:99], v[48:51], a[152:155]
    v_accvgpr_read_b32 v5, a116
    v_add_u32 v8, 192, v8
    v_mfma_f32_16x16x32_bf16 a[152:155], v[100:103], v[52:55], a[152:155]
    v_cvt_pk_bf16_f32 v4, 0, v4
    v_cvt_pk_bf16_f32 v5, 0, v5
    v_mfma_f32_16x16x32_bf16 a[156:159], v[96:99], v[56:59], a[156:159]
    v_exp_f32 v252, v252
    v_mfma_f32_16x16x32_bf16 a[156:159], v[100:103], v[60:63], a[156:159]
    v_exp_f32 v253, v253
    v_mfma_f32_16x16x32_bf16 a[160:163], v[104:107], v[32:35], a[160:163]
    s_waitcnt lgkmcnt(0)
    v_exp_f32 v254, v254
    v_mfma_f32_16x16x32_bf16 a[160:163], v[108:111], v[36:39], a[160:163]
    v_exp_f32 v255, v255
    v_mfma_f32_16x16x32_bf16 v[240:243], a[224:227], v[140:143], v[156:159]
    v_cvt_pk_bf16_f32 v84, v252, v253
    v_cvt_pk_bf16_f32 v85, v254, v255
    v_mfma_f32_16x16x32_bf16 v[240:243], a[228:231], v[172:175], v[240:243]
    buffer_load_dwordx4 v1, s[36:39], s77 offen offset:2048 sc1 lds
    v_mfma_f32_16x16x32_bf16 v[240:243], a[232:235], v[204:207], v[240:243]
    v_lshrrev_b32 v15, 8, v1
    ds_bpermute_b32 v4, v8, v4
    v_mfma_f32_16x16x32_bf16 v[240:243], a[236:239], v[236:239], v[240:243]
    ds_bpermute_b32 v5, v8, v5
    ds_read_b128 a[224:227], v2 offset:0
    v_mfma_f32_16x16x32_bf16 a[164:167], v[104:107], v[40:43], a[164:167]
    ds_read_b128 a[228:231], v2 offset:1024
    v_bfe_u32 v14, v1, 4, 4
    v_mfma_f32_16x16x32_bf16 a[164:167], v[108:111], v[44:47], a[164:167]
    ds_read_b128 a[232:235], v2 offset:2048
    v_lshlrev_b32 v15, 3, v15
    v_mfma_f32_16x16x32_bf16 a[168:171], v[104:107], v[48:51], a[168:171]
    ds_read_b128 a[236:239], v2 offset:3072
    v_sub_u32 v14, v14, v15
    v_mfma_f32_16x16x32_bf16 a[168:171], v[108:111], v[52:55], a[168:171]
    ds_read_b128 v[96:99], v2 offset:16384
    v_and_b32 v15, 16, v1
    v_mfma_f32_16x16x32_bf16 a[172:175], v[104:107], v[56:59], a[172:175]
    buffer_load_dwordx4 v1, s[36:39], s77 offen offset:3072 sc1 lds
    v_mfma_f32_16x16x32_bf16 a[172:175], v[108:111], v[60:63], a[172:175]
    ds_read_b128 v[100:103], v2 offset:17408
    v_mov_b32 v31, 0x3f80
    v_mfma_f32_16x16x32_bf16 v[244:247], a[240:243], v[132:135], v[188:191]
    v_exp_f32 v240, v240
    v_mfma_f32_16x16x32_bf16 v[244:247], a[244:247], v[164:167], v[244:247]
    v_exp_f32 v241, v241
    v_mfma_f32_16x16x32_bf16 v[244:247], a[248:251], v[196:199], v[244:247]
    v_exp_f32 v242, v242
    v_mfma_f32_16x16x32_bf16 v[244:247], a[252:255], v[228:231], v[244:247]
    v_exp_f32 v243, v243
    v_mfma_f32_16x16x32_bf16 a[176:179], v[112:115], v[32:35], a[176:179]
    v_cvt_pk_bf16_f32 v92, v240, v241
    v_cvt_pk_bf16_f32 v93, v242, v243
    v_mfma_f32_16x16x32_bf16 a[176:179], v[116:119], v[36:39], a[176:179]
    s_add_u32 s100, s77, 4096
    v_ashrrev_i32 v14, 1, v14
    v_lshlrev_b32 v15, v15, v31
    v_mfma_f32_16x16x32_bf16 a[180:183], v[112:115], v[40:43], a[180:183]
    s_add_u32 m0, m0, 4096
    v_exp_f32 v244, v244
    v_mfma_f32_16x16x32_bf16 a[180:183], v[116:119], v[44:47], a[180:183]
    buffer_load_dwordx4 v1, s[36:39], s100 offen sc1 lds
    v_mfma_f32_16x16x32_bf16 v[248:251], a[240:243], v[136:139], v[152:155]
    v_exp_f32 v245, v245
    v_mfma_f32_16x16x32_bf16 v[248:251], a[244:247], v[168:171], v[248:251]
    v_exp_f32 v246, v246
    v_mfma_f32_16x16x32_bf16 v[248:251], a[248:251], v[200:203], v[248:251]
    v_exp_f32 v247, v247
    v_mfma_f32_16x16x32_bf16 v[248:251], a[252:255], v[232:235], v[248:251]
    v_cvt_pk_bf16_f32 v78, v244, v245
    v_cvt_pk_bf16_f32 v79, v246, v247
    v_mfma_f32_16x16x32_bf16 a[184:187], v[112:115], v[48:51], a[184:187]
    s_waitcnt lgkmcnt(0)
    v_cmp_eq_i32 vcc, 0, v14
    v_mul_f32 v4, s98, v4
    v_mfma_f32_16x16x32_bf16 a[184:187], v[116:119], v[52:55], a[184:187]
    buffer_load_dwordx4 v1, s[36:39], s100 offen offset:1024 sc1 lds
    v_mfma_f32_16x16x32_bf16 a[188:191], v[112:115], v[56:59], a[188:191]
    v_exp_f32 v248, v248
    v_mfma_f32_16x16x32_bf16 a[188:191], v[116:119], v[60:63], a[188:191]
    v_exp_f32 v249, v249
    v_mfma_f32_16x16x32_bf16 a[192:195], v[120:123], v[32:35], a[192:195]
    v_exp_f32 v250, v250
    v_mfma_f32_16x16x32_bf16 a[192:195], v[124:127], v[36:39], a[192:195]
    v_exp_f32 v251, v251
    v_mfma_f32_16x16x32_bf16 v[252:255], a[240:243], v[140:143], v[156:159]
    v_cvt_pk_bf16_f32 v86, v248, v249
    v_cvt_pk_bf16_f32 v87, v250, v251
    v_mfma_f32_16x16x32_bf16 v[252:255], a[244:247], v[172:175], v[252:255]
    v_cndmask_b32 v216, 0, v15, vcc
    v_cmp_eq_i32 vcc, 1, v14
    v_mfma_f32_16x16x32_bf16 v[252:255], a[248:251], v[204:207], v[252:255]
    v_mul_f32 v5, s98, v5
    v_cndmask_b32 v217, 0, v15, vcc
    v_mfma_f32_16x16x32_bf16 v[252:255], a[252:255], v[236:239], v[252:255]
    buffer_load_dwordx4 v1, s[36:39], s100 offen offset:2048 sc1 lds
    v_mfma_f32_16x16x32_bf16 a[196:199], v[120:123], v[40:43], a[196:199]
    v_cmp_eq_i32 vcc, 2, v14
    v_and_b32 v31, 512, v1
    v_mfma_f32_16x16x32_bf16 a[196:199], v[124:127], v[44:47], a[196:199]
    v_cndmask_b32 v218, 0, v15, vcc
    v_cmp_eq_i32 vcc, 3, v14
    v_mfma_f32_16x16x32_bf16 a[200:203], v[120:123], v[48:51], a[200:203]
    v_exp_f32 v252, v252
    v_mfma_f32_16x16x32_bf16 a[200:203], v[124:127], v[52:55], a[200:203]
    v_exp_f32 v253, v253
    v_mfma_f32_16x16x32_bf16 a[204:207], v[120:123], v[56:59], a[204:207]
    v_cvt_pk_bf16_f32 v94, v252, v253
    v_cndmask_b32 v219, 0, v15, vcc
    v_mfma_f32_16x16x32_bf16 a[204:207], v[124:127], v[60:63], a[204:207]
    v_cmp_eq_i32 vcc, -8, v14
    v_mad_u32_u24 v31, v31, 3, v1
    v_mfma_f32_16x16x32_bf16 a[208:211], a[136:139], v[32:35], a[208:211]
    buffer_load_dwordx4 v1, s[36:39], s100 offen offset:3072 sc1 lds
    v_mfma_f32_16x16x32_bf16 a[208:211], a[136:139], v[36:39], a[208:211]
    v_cndmask_b32 v220, 0, v15, vcc
    v_cmp_eq_i32 vcc, -7, v14
    v_mfma_f32_16x16x32_bf16 a[212:215], a[136:139], v[40:43], a[212:215]
    v_exp_f32 v4, v4
    v_mfma_f32_16x16x32_bf16 a[212:215], a[136:139], v[44:47], a[212:215]
    v_exp_f32 v5, v5
    v_mfma_f32_16x16x32_bf16 a[216:219], a[136:139], v[48:51], a[216:219]
    v_cndmask_b32 v221, 0, v15, vcc
    v_cmp_eq_i32 vcc, -6, v14
    v_mfma_f32_16x16x32_bf16 a[216:219], a[136:139], v[52:55], a[216:219]
    v_add_f32 v4, 1.0, v4
    v_add_f32 v5, 1.0, v5
    v_mfma_f32_16x16x32_bf16 a[220:223], a[136:139], v[56:59], a[220:223]
    v_cndmask_b32 v222, 0, v15, vcc
    v_cmp_eq_i32 vcc, -5, v14
    v_mfma_f32_16x16x32_bf16 a[220:223], a[136:139], v[60:63], a[220:223]
    s_add_u32 s77, s77, 32768
    v_rcp_f32 v4, v4
    v_rcp_f32 v5, v5
    v_cndmask_b32 v223, 0, v15, vcc
    s_cmp_eq_u32 s6, 7
    s_cselect_b32 s16, s8, 0
    s_cselect_b32 s17, s9, 0
    s_cselect_b32 s18, s10, 0
    s_cselect_b32 s19, s11, 0
    s_cselect_b32 s20, s12, 0
    s_cselect_b32 s21, s13, 0
    s_cselect_b32 s22, s14, 0
    s_cselect_b32 s23, s15, 0
    v_add_f32 v212, s20, v152
    v_fma_f32 v176, v208, s16, v212
    v_fma_f32 v177, v209, s16, v212
    v_fma_f32 v178, v210, s16, v212
    v_fma_f32 v179, v211, s16, v212
    s_nop 1
    s_waitcnt lgkmcnt(0)
    v_mfma_f32_16x16x32_bf16 v[240:243], a[224:227], v[136:139], v[176:179]
    s_add_u32 m0, s76, s75
    v_exp_f32 v254, v254
    v_mfma_f32_16x16x32_bf16 v[240:243], a[228:231], v[168:171], v[240:243]
    s_mov_b32 s76, s60
    buffer_load_dwordx4 v1, s[36:39], s77 offen sc1 lds
    v_mfma_f32_16x16x32_bf16 v[240:243], a[232:235], v[200:203], v[240:243]
    s_mov_b32 s60, s82
    v_exp_f32 v255, v255
    v_mfma_f32_16x16x32_bf16 v[240:243], a[236:239], v[232:235], v[240:243]
    s_add_u32 s82, s82, 32768
    ds_read_b128 v[104:107], v2 offset:18432
    v_cvt_pk_bf16_f32 v95, v254, v255
    v_mfma_f32_16x16x32_bf16 a[4:7], v[96:99], v[72:75], a[4:7]
    ds_read_b128 v[108:111], v2 offset:19456
    ds_read_b128 a[240:243], v2 offset:4096
    v_mfma_f32_16x16x32_bf16 a[4:7], v[100:103], v[76:79], a[4:7]
    ds_read_b128 a[244:247], v2 offset:5120
    v_add_f32 v213, s21, v152
    v_mfma_f32_16x16x32_bf16 a[8:11], v[96:99], v[80:83], a[8:11]
    ds_read_b128 a[248:251], v2 offset:6144
    v_fma_f32 v180, v208, s17, v213
    v_mfma_f32_16x16x32_bf16 a[8:11], v[100:103], v[84:87], a[8:11]
    ds_read_b128 a[252:255], v2 offset:7168
    v_fma_f32 v181, v209, s17, v213
    v_mfma_f32_16x16x32_bf16 a[12:15], v[96:99], v[88:91], a[12:15]
    ds_read_b128 v[112:115], v2 offset:20480
    v_fma_f32 v182, v210, s17, v213
    v_mfma_f32_16x16x32_bf16 a[12:15], v[100:103], v[92:95], a[12:15]
    ds_read_b128 v[116:119], v2 offset:21504
    v_fma_f32 v183, v211, s17, v213
    v_mfma_f32_16x16x32_bf16 v[244:247], a[224:227], v[140:143], v[156:159]
    buffer_load_dwordx4 v1, s[36:39], s77 offen offset:1024 sc1 lds
    v_mfma_f32_16x16x32_bf16 v[244:247], a[228:231], v[172:175], v[244:247]
    ds_read_b128 v[120:123], v2 offset:22528
    ds_read_b128 v[124:127], v2 offset:23552
    v_mfma_f32_16x16x32_bf16 v[244:247], a[232:235], v[204:207], v[244:247]
    ds_read_b128 a[224:227], v2 offset:8192
    v_add_f32 v214, s22, v152
    v_mfma_f32_16x16x32_bf16 v[244:247], a[236:239], v[236:239], v[244:247]
    s_waitcnt lgkmcnt(4)
    ds_read_b128 a[228:231], v2 offset:9216
    v_fma_f32 v184, v208, s18, v214
    v_mfma_f32_16x16x32_bf16 a[20:23], v[104:107], v[72:75], a[20:23]
    ds_read_b128 a[232:235], v2 offset:10240
    v_fma_f32 v185, v209, s18, v214
    v_mfma_f32_16x16x32_bf16 a[20:23], v[108:111], v[76:79], a[20:23]
    ds_read_b128 a[236:239], v2 offset:11264
    v_fma_f32 v186, v210, s18, v214
    v_mfma_f32_16x16x32_bf16 a[24:27], v[104:107], v[80:83], a[24:27]
    ds_read_b128 v[96:99], v2 offset:24576
    v_fma_f32 v187, v211, s18, v214
    v_mfma_f32_16x16x32_bf16 a[24:27], v[108:111], v[84:87], a[24:27]
    ds_read_b128 v[100:103], v2 offset:25600
    v_add_f32 v215, s23, v152
    v_mfma_f32_16x16x32_bf16 a[28:31], v[104:107], v[88:91], a[28:31]
    v_exp_f32 v240, v240
    v_mfma_f32_16x16x32_bf16 a[28:31], v[108:111], v[92:95], a[28:31]
    v_exp_f32 v241, v241
    v_mfma_f32_16x16x32_bf16 v[248:251], a[240:243], v[136:139], v[180:183]
    buffer_load_dwordx4 v1, s[36:39], s77 offen offset:2048 sc1 lds
    v_mfma_f32_16x16x32_bf16 v[248:251], a[244:247], v[168:171], v[248:251]
    v_exp_f32 v242, v242
    v_mfma_f32_16x16x32_bf16 v[248:251], a[248:251], v[200:203], v[248:251]
    v_exp_f32 v243, v243
    v_mfma_f32_16x16x32_bf16 v[248:251], a[252:255], v[232:235], v[248:251]
    v_cvt_pk_bf16_f32 v48, v240, v241
    v_cvt_pk_bf16_f32 v49, v242, v243
    v_mfma_f32_16x16x32_bf16 a[36:39], v[112:115], v[72:75], a[36:39]
    s_waitcnt lgkmcnt(0)
    ds_read_b128 v[104:107], v2 offset:26624
    ds_read_b128 v[108:111], v2 offset:27648
    v_mfma_f32_16x16x32_bf16 a[36:39], v[116:119], v[76:79], a[36:39]
    v_exp_f32 v244, v244
    v_mfma_f32_16x16x32_bf16 a[40:43], v[112:115], v[80:83], a[40:43]
    v_exp_f32 v245, v245
    v_mfma_f32_16x16x32_bf16 a[40:43], v[116:119], v[84:87], a[40:43]
    v_exp_f32 v246, v246
    v_mfma_f32_16x16x32_bf16 a[44:47], v[112:115], v[88:91], a[44:47]
    v_exp_f32 v247, v247
    v_mfma_f32_16x16x32_bf16 a[44:47], v[116:119], v[92:95], a[44:47]
    s_waitcnt vmcnt(11)
    buffer_load_dwordx4 v1, s[36:39], s77 offen offset:3072 sc1 lds
    v_mfma_f32_16x16x32_bf16 v[12:15], v[64:67], v[216:219], 0
    v_cvt_pk_bf16_f32 v56, v244, v245
    v_cvt_pk_bf16_f32 v57, v246, v247
    v_mfma_f32_16x16x32_bf16 v[16:19], v[68:71], v[216:219], 0
    ds_read_b128 v[112:115], v2 offset:28672
    ds_read_b128 v[116:119], v2 offset:29696
    v_mfma_f32_16x16x32_bf16 v[252:255], a[240:243], v[140:143], v[156:159]
    ds_read_b128 a[240:243], v2 offset:12288
    v_fma_f32 v188, v208, s19, v215
    v_mfma_f32_16x16x32_bf16 v[252:255], a[244:247], v[172:175], v[252:255]
    v_cvt_pk_bf16_f32 v12, v12, v13
    v_cvt_pk_bf16_f32 v13, v14, v15
    v_mfma_f32_16x16x32_bf16 v[252:255], a[248:251], v[204:207], v[252:255]
    v_cvt_pk_bf16_f32 v14, v16, v17
    v_cvt_pk_bf16_f32 v15, v18, v19
    v_mfma_f32_16x16x32_bf16 v[252:255], a[252:255], v[236:239], v[252:255]
    buffer_store_dwordx4 v[12:15], v31, s[56:59], s63 offen offset:0 sc1
    v_mfma_f32_16x16x32_bf16 a[52:55], v[120:123], v[72:75], a[52:55]
    ds_read_b128 a[244:247], v2 offset:13312
    ds_read_b128 a[248:251], v2 offset:14336
    v_mfma_f32_16x16x32_bf16 a[52:55], v[124:127], v[76:79], a[52:55]
    ds_read_b128 a[252:255], v2 offset:15360
    v_fma_f32 v189, v209, s19, v215
    v_mfma_f32_16x16x32_bf16 a[56:59], v[120:123], v[80:83], a[56:59]
    s_add_u32 s100, s77, 4096
    v_exp_f32 v248, v248
    v_mfma_f32_16x16x32_bf16 a[56:59], v[124:127], v[84:87], a[56:59]
    s_add_u32 m0, m0, 4096
    v_exp_f32 v249, v249
    v_mfma_f32_16x16x32_bf16 a[60:63], v[120:123], v[88:91], a[60:63]
    buffer_load_dwordx4 v1, s[36:39], s100 offen sc1 lds
    v_mfma_f32_16x16x32_bf16 a[60:63], v[124:127], v[92:95], a[60:63]
    v_exp_f32 v250, v250
    v_mfma_f32_16x16x32_bf16 v[12:15], v[64:67], v[220:223], 0
    v_exp_f32 v251, v251
    v_mfma_f32_16x16x32_bf16 v[16:19], v[68:71], v[220:223], 0
    v_fma_f32 v190, v210, s19, v215
    v_fma_f32 v191, v211, s19, v215
    v_mfma_f32_16x16x32_bf16 v[240:243], a[224:227], v[136:139], v[184:187]
    v_cvt_pk_bf16_f32 v50, v248, v249
    v_cvt_pk_bf16_f32 v51, v250, v251
    v_mfma_f32_16x16x32_bf16 v[240:243], a[228:231], v[168:171], v[240:243]
    v_cvt_pk_bf16_f32 v12, v12, v13
    v_cvt_pk_bf16_f32 v13, v14, v15
    v_mfma_f32_16x16x32_bf16 v[240:243], a[232:235], v[200:203], v[240:243]
    v_cvt_pk_bf16_f32 v14, v16, v17
    v_cvt_pk_bf16_f32 v15, v18, v19
    v_mfma_f32_16x16x32_bf16 v[240:243], a[236:239], v[232:235], v[240:243]
    buffer_store_dwordx4 v[12:15], v31, s[56:59], s63 offen offset:1024 sc1
    v_mfma_f32_16x16x32_bf16 a[148:151], v[96:99], v[72:75], a[148:151]
    buffer_load_dwordx4 v1, s[36:39], s100 offen offset:1024 sc1 lds
    v_mfma_f32_16x16x32_bf16 a[148:151], v[100:103], v[76:79], a[148:151]
    ds_read_b128 v[120:123], v2 offset:30720
    ds_read_b128 v[124:127], v2 offset:31744
    v_mfma_f32_16x16x32_bf16 a[152:155], v[96:99], v[80:83], a[152:155]
    v_exp_f32 v252, v252
    v_mfma_f32_16x16x32_bf16 a[152:155], v[100:103], v[84:87], a[152:155]
    v_exp_f32 v253, v253
    v_mfma_f32_16x16x32_bf16 a[156:159], v[96:99], v[88:91], a[156:159]
    v_exp_f32 v254, v254
    v_mfma_f32_16x16x32_bf16 a[156:159], v[100:103], v[92:95], a[156:159]
    v_exp_f32 v255, v255
    v_mfma_f32_16x16x32_bf16 v[12:15], v[20:23], v[216:219], 0
    v_cvt_pk_bf16_f32 v58, v252, v253
    v_cvt_pk_bf16_f32 v59, v254, v255
    v_mfma_f32_16x16x32_bf16 v[16:19], v[24:27], v[216:219], 0
    v_exp_f32 v240, v240
    v_mfma_f32_16x16x32_bf16 v[244:247], a[224:227], v[140:143], v[156:159]
    v_exp_f32 v241, v241
    v_mfma_f32_16x16x32_bf16 v[244:247], a[228:231], v[172:175], v[244:247]
    v_exp_f32 v242, v242
    v_mfma_f32_16x16x32_bf16 v[244:247], a[232:235], v[204:207], v[244:247]
    buffer_load_dwordx4 v1, s[36:39], s100 offen offset:2048 sc1 lds
    v_mfma_f32_16x16x32_bf16 v[244:247], a[236:239], v[236:239], v[244:247]
    s_waitcnt lgkmcnt(0)
    v_cvt_pk_bf16_f32 v12, v12, v13
    v_cvt_pk_bf16_f32 v13, v14, v15
    v_mfma_f32_16x16x32_bf16 a[164:167], v[104:107], v[72:75], a[164:167]
    v_cvt_pk_bf16_f32 v14, v16, v17
    v_cvt_pk_bf16_f32 v15, v18, v19
    v_mfma_f32_16x16x32_bf16 a[164:167], v[108:111], v[76:79], a[164:167]
    buffer_store_dwordx4 v[12:15], v31, s[56:59], s63 offen offset:512 sc1
    v_mfma_f32_16x16x32_bf16 a[168:171], v[104:107], v[80:83], a[168:171]
    s_cmp_eq_u32 s82, 163840
    s_cselect_b32 s82, 0, s82
    v_add_u32 v2, s82, v1
    v_mfma_f32_16x16x32_bf16 a[168:171], v[108:111], v[84:87], a[168:171]
    v_exp_f32 v243, v243
    v_mfma_f32_16x16x32_bf16 a[172:175], v[104:107], v[88:91], a[172:175]
    v_exp_f32 v244, v244
    v_mfma_f32_16x16x32_bf16 a[172:175], v[108:111], v[92:95], a[172:175]
    v_exp_f32 v245, v245
    v_mfma_f32_16x16x32_bf16 v[12:15], v[20:23], v[220:223], 0
    v_exp_f32 v246, v246
    v_mfma_f32_16x16x32_bf16 v[16:19], v[24:27], v[220:223], 0
    buffer_load_dwordx4 v1, s[36:39], s100 offen offset:3072 sc1 lds
    v_mfma_f32_16x16x32_bf16 v[248:251], a[240:243], v[136:139], v[188:191]
    v_exp_f32 v247, v247
    v_mfma_f32_16x16x32_bf16 v[248:251], a[244:247], v[168:171], v[248:251]
    v_cvt_pk_bf16_f32 v52, v240, v241
    v_cvt_pk_bf16_f32 v53, v242, v243
    v_mfma_f32_16x16x32_bf16 v[248:251], a[248:251], v[200:203], v[248:251]
    v_cvt_pk_bf16_f32 v12, v12, v13
    v_cvt_pk_bf16_f32 v13, v14, v15
    v_mfma_f32_16x16x32_bf16 v[248:251], a[252:255], v[232:235], v[248:251]
    v_cvt_pk_bf16_f32 v14, v16, v17
    v_cvt_pk_bf16_f32 v15, v18, v19
    v_mfma_f32_16x16x32_bf16 a[180:183], v[112:115], v[72:75], a[180:183]
    buffer_store_dwordx4 v[12:15], v31, s[56:59], s63 offen offset:1536 sc1
    v_mfma_f32_16x16x32_bf16 a[180:183], v[116:119], v[76:79], a[180:183]
    v_cvt_pk_bf16_f32 v60, v244, v245
    v_cvt_pk_bf16_f32 v61, v246, v247
    v_mfma_f32_16x16x32_bf16 a[184:187], v[112:115], v[80:83], a[184:187]
    v_exp_f32 v248, v248
    v_mfma_f32_16x16x32_bf16 a[184:187], v[116:119], v[84:87], a[184:187]
    v_exp_f32 v249, v249
    v_mfma_f32_16x16x32_bf16 a[188:191], v[112:115], v[88:91], a[188:191]
    s_add_u32 s77, s77, 32768
    v_exp_f32 v250, v250
    v_mfma_f32_16x16x32_bf16 a[188:191], v[116:119], v[92:95], a[188:191]
    v_exp_f32 v251, v251
    v_mfma_f32_16x16x32_bf16 v[12:15], v[144:147], v[216:219], 0
    v_cvt_pk_bf16_f32 v54, v248, v249
    v_cvt_pk_bf16_f32 v55, v250, v251
    v_mfma_f32_16x16x32_bf16 v[16:19], a[140:143], v[216:219], 0
    v_accvgpr_read_b32 v6, a120
    v_accvgpr_read_b32 v7, a124
    v_mfma_f32_16x16x32_bf16 v[252:255], a[240:243], v[140:143], v[156:159]
    v_cvt_pk_bf16_f32 v6, 0, v6
    v_cvt_pk_bf16_f32 v7, 0, v7
    v_mfma_f32_16x16x32_bf16 v[252:255], a[244:247], v[172:175], v[252:255]
    v_cvt_pk_bf16_f32 v12, v12, v13
    v_cvt_pk_bf16_f32 v13, v14, v15
    v_mfma_f32_16x16x32_bf16 v[252:255], a[248:251], v[204:207], v[252:255]
    v_cvt_pk_bf16_f32 v14, v16, v17
    v_cvt_pk_bf16_f32 v15, v18, v19
    v_mfma_f32_16x16x32_bf16 v[252:255], a[252:255], v[236:239], v[252:255]
    buffer_store_dwordx4 v[12:15], v1, s[56:59], s64 offen offset:0 sc1
    v_mfma_f32_16x16x32_bf16 a[196:199], v[120:123], v[72:75], a[196:199]
    ds_bpermute_b32 v6, v8, v6
    ds_bpermute_b32 v7, v8, v7
    v_mfma_f32_16x16x32_bf16 a[196:199], v[124:127], v[76:79], a[196:199]
    s_waitcnt vmcnt(8) lgkmcnt(0)
    s_barrier
    ds_read_b128 a[224:227], v2 offset:0
    v_mfma_f32_16x16x32_bf16 a[200:203], v[120:123], v[80:83], a[200:203]
    ds_read_b128 a[228:231], v2 offset:1024
    ds_read_b128 a[232:235], v2 offset:2048
    v_mfma_f32_16x16x32_bf16 a[200:203], v[124:127], v[84:87], a[200:203]
    ds_read_b128 a[236:239], v2 offset:3072
    v_mul_f32 v6, s98, v6
    v_mfma_f32_16x16x32_bf16 a[204:207], v[120:123], v[88:91], a[204:207]
    ds_read_b128 v[96:99], v2 offset:16384
    v_mul_f32 v7, s98, v7
    v_mfma_f32_16x16x32_bf16 a[204:207], v[124:127], v[92:95], a[204:207]
    v_exp_f32 v252, v252
    v_mfma_f32_16x16x32_bf16 v[12:15], v[144:147], v[220:223], 0
    v_exp_f32 v253, v253
    v_mfma_f32_16x16x32_bf16 v[16:19], a[140:143], v[220:223], 0
    ds_read_b128 v[100:103], v2 offset:17408
    v_cvt_pk_bf16_f32 v62, v252, v253
    v_mfma_f32_16x16x32_bf16 a[212:215], a[136:139], v[72:75], a[212:215]
    v_exp_f32 v6, v6
    v_mfma_f32_16x16x32_bf16 a[212:215], a[136:139], v[76:79], a[212:215]
    v_exp_f32 v7, v7
    v_mfma_f32_16x16x32_bf16 a[216:219], a[136:139], v[80:83], a[216:219]
    v_cvt_pk_bf16_f32 v12, v12, v13
    v_cvt_pk_bf16_f32 v13, v14, v15
    v_mfma_f32_16x16x32_bf16 a[216:219], a[136:139], v[84:87], a[216:219]
    v_cvt_pk_bf16_f32 v14, v16, v17
    v_cvt_pk_bf16_f32 v15, v18, v19
    v_mfma_f32_16x16x32_bf16 a[220:223], a[136:139], v[88:91], a[220:223]
    buffer_store_dwordx4 v[12:15], v1, s[56:59], s64 offen offset:1024 sc1
    v_mfma_f32_16x16x32_bf16 a[220:223], a[136:139], v[92:95], a[220:223]
    v_add_f32 v6, 1.0, v6
    v_add_f32 v7, 1.0, v7
    v_rcp_f32 v6, v6
    v_rcp_f32 v7, v7
    s_nop 1
    v_accvgpr_read_b32 v9, a208
    v_cmp_nge_f32 vcc, 0x71800000, v9
    v_rcp_f32 v10, v9
    s_nop 0
    s_or_b64 s[84:85], s[84:85], vcc
    v_mul_f32 v10, v10, v4
    v_accvgpr_read_b32 v12, a0
    v_accvgpr_read_b32 v13, a1
    v_accvgpr_read_b32 v14, a2
    v_accvgpr_read_b32 v15, a3
    v_accvgpr_read_b32 v16, a16
    v_accvgpr_read_b32 v17, a17
    v_accvgpr_read_b32 v18, a18
    v_accvgpr_read_b32 v19, a19
    v_pk_mul_f32 v[12:13], v[12:13], v[10:11] op_sel_hi:[1,0]
    v_pk_mul_f32 v[14:15], v[14:15], v[10:11] op_sel_hi:[1,0]
    v_pk_mul_f32 v[16:17], v[16:17], v[10:11] op_sel_hi:[1,0]
    v_pk_mul_f32 v[18:19], v[18:19], v[10:11] op_sel_hi:[1,0]
    v_cvt_pk_bf16_f32 v12, v12, v13
    v_cvt_pk_bf16_f32 v13, v14, v15
    v_cvt_pk_bf16_f32 v14, v16, v17
    v_cvt_pk_bf16_f32 v15, v18, v19
    buffer_store_dwordx4 v[12:15], v1, s[40:43], s80 offen offset:0 sc1
    v_accvgpr_read_b32 v20, a32
    v_accvgpr_read_b32 v21, a33
    v_accvgpr_read_b32 v22, a34
    v_accvgpr_read_b32 v23, a35
    v_accvgpr_read_b32 v24, a48
    v_accvgpr_read_b32 v25, a49
    v_accvgpr_read_b32 v26, a50
    v_accvgpr_read_b32 v27, a51
    v_pk_mul_f32 v[20:21], v[20:21], v[10:11] op_sel_hi:[1,0]
    v_pk_mul_f32 v[22:23], v[22:23], v[10:11] op_sel_hi:[1,0]
    v_pk_mul_f32 v[24:25], v[24:25], v[10:11] op_sel_hi:[1,0]
    v_pk_mul_f32 v[26:27], v[26:27], v[10:11] op_sel_hi:[1,0]
    v_cvt_pk_bf16_f32 v20, v20, v21
    v_cvt_pk_bf16_f32 v21, v22, v23
    v_cvt_pk_bf16_f32 v22, v24, v25
    v_cvt_pk_bf16_f32 v23, v26, v27
    buffer_store_dwordx4 v[20:23], v1, s[40:43], s80 offen offset:1024 sc1
    v_accvgpr_read_b32 v12, a144
    v_accvgpr_read_b32 v13, a145
    v_accvgpr_read_b32 v14, a146
    v_accvgpr_read_b32 v15, a147
    v_accvgpr_read_b32 v16, a160
    v_accvgpr_read_b32 v17, a161
    v_accvgpr_read_b32 v18, a162
    v_accvgpr_read_b32 v19, a163
    v_pk_mul_f32 v[12:13], v[12:13], v[10:11] op_sel_hi:[1,0]
    v_pk_mul_f32 v[14:15], v[14:15], v[10:11] op_sel_hi:[1,0]
    v_pk_mul_f32 v[16:17], v[16:17], v[10:11] op_sel_hi:[1,0]
    v_pk_mul_f32 v[18:19], v[18:19], v[10:11] op_sel_hi:[1,0]
    v_cvt_pk_bf16_f32 v12, v12, v13
    v_cvt_pk_bf16_f32 v13, v14, v15
    v_cvt_pk_bf16_f32 v14, v16, v17
    v_cvt_pk_bf16_f32 v15, v18, v19
    buffer_store_dwordx4 v[12:15], v1, s[40:43], s80 offen offset:2048 sc1
    v_accvgpr_read_b32 v20, a176
    v_accvgpr_read_b32 v21, a177
    v_accvgpr_read_b32 v22, a178
    v_accvgpr_read_b32 v23, a179
    v_accvgpr_read_b32 v24, a192
    v_accvgpr_read_b32 v25, a193
    v_accvgpr_read_b32 v26, a194
    v_accvgpr_read_b32 v27, a195
    v_pk_mul_f32 v[20:21], v[20:21], v[10:11] op_sel_hi:[1,0]
    v_pk_mul_f32 v[22:23], v[22:23], v[10:11] op_sel_hi:[1,0]
    v_pk_mul_f32 v[24:25], v[24:25], v[10:11] op_sel_hi:[1,0]
    v_pk_mul_f32 v[26:27], v[26:27], v[10:11] op_sel_hi:[1,0]
    v_cvt_pk_bf16_f32 v20, v20, v21
    v_cvt_pk_bf16_f32 v21, v22, v23
    v_cvt_pk_bf16_f32 v22, v24, v25
    v_cvt_pk_bf16_f32 v23, v26, v27
    buffer_store_dwordx4 v[20:23], v1, s[40:43], s80 offen offset:3072 sc1
    v_accvgpr_read_b32 v9, a212
    v_cmp_nge_f32 vcc, 0x71800000, v9
    v_rcp_f32 v10, v9
    s_nop 0
    s_or_b64 s[84:85], s[84:85], vcc
    v_mul_f32 v10, v10, v5
    s_add_u32 s72, s80, 622592
    v_accvgpr_read_b32 v12, a4
    v_accvgpr_read_b32 v13, a5
    v_accvgpr_read_b32 v14, a6
    v_accvgpr_read_b32 v15, a7
    v_accvgpr_read_b32 v16, a20
    v_accvgpr_read_b32 v17, a21
    v_accvgpr_read_b32 v18, a22
    v_accvgpr_read_b32 v19, a23
    v_pk_mul_f32 v[12:13], v[12:13], v[10:11] op_sel_hi:[1,0]
    v_pk_mul_f32 v[14:15], v[14:15], v[10:11] op_sel_hi:[1,0]
    v_pk_mul_f32 v[16:17], v[16:17], v[10:11] op_sel_hi:[1,0]
    v_pk_mul_f32 v[18:19], v[18:19], v[10:11] op_sel_hi:[1,0]
    v_cvt_pk_bf16_f32 v12, v12, v13
    v_cvt_pk_bf16_f32 v13, v14, v15
    v_cvt_pk_bf16_f32 v14, v16, v17
    v_cvt_pk_bf16_f32 v15, v18, v19
    buffer_store_dwordx4 v[12:15], v1, s[40:43], s72 offen offset:0 sc1
    v_accvgpr_read_b32 v20, a36
    v_accvgpr_read_b32 v21, a37
    v_accvgpr_read_b32 v22, a38
    v_accvgpr_read_b32 v23, a39
    v_accvgpr_read_b32 v24, a52
    v_accvgpr_read_b32 v25, a53
    v_accvgpr_read_b32 v26, a54
    v_accvgpr_read_b32 v27, a55
    v_pk_mul_f32 v[20:21], v[20:21], v[10:11] op_sel_hi:[1,0]
    v_pk_mul_f32 v[22:23], v[22:23], v[10:11] op_sel_hi:[1,0]
    v_pk_mul_f32 v[24:25], v[24:25], v[10:11] op_sel_hi:[1,0]
    v_pk_mul_f32 v[26:27], v[26:27], v[10:11] op_sel_hi:[1,0]
    v_cvt_pk_bf16_f32 v20, v20, v21
    v_cvt_pk_bf16_f32 v21, v22, v23
    v_cvt_pk_bf16_f32 v22, v24, v25
    v_cvt_pk_bf16_f32 v23, v26, v27
    buffer_store_dwordx4 v[20:23], v1, s[40:43], s72 offen offset:1024 sc1
    v_accvgpr_read_b32 v12, a148
    v_accvgpr_read_b32 v13, a149
    v_accvgpr_read_b32 v14, a150
    v_accvgpr_read_b32 v15, a151
    v_accvgpr_read_b32 v16, a164
    v_accvgpr_read_b32 v17, a165
    v_accvgpr_read_b32 v18, a166
    v_accvgpr_read_b32 v19, a167
    v_pk_mul_f32 v[12:13], v[12:13], v[10:11] op_sel_hi:[1,0]
    v_pk_mul_f32 v[14:15], v[14:15], v[10:11] op_sel_hi:[1,0]
    v_pk_mul_f32 v[16:17], v[16:17], v[10:11] op_sel_hi:[1,0]
    v_pk_mul_f32 v[18:19], v[18:19], v[10:11] op_sel_hi:[1,0]
    v_cvt_pk_bf16_f32 v12, v12, v13
    v_cvt_pk_bf16_f32 v13, v14, v15
    v_cvt_pk_bf16_f32 v14, v16, v17
    v_cvt_pk_bf16_f32 v15, v18, v19
    buffer_store_dwordx4 v[12:15], v1, s[40:43], s72 offen offset:2048 sc1
    v_accvgpr_read_b32 v20, a180
    v_accvgpr_read_b32 v21, a181
    v_accvgpr_read_b32 v22, a182
    v_accvgpr_read_b32 v23, a183
    v_accvgpr_read_b32 v24, a196
    v_accvgpr_read_b32 v25, a197
    v_accvgpr_read_b32 v26, a198
    v_accvgpr_read_b32 v27, a199
    v_pk_mul_f32 v[20:21], v[20:21], v[10:11] op_sel_hi:[1,0]
    v_pk_mul_f32 v[22:23], v[22:23], v[10:11] op_sel_hi:[1,0]
    v_pk_mul_f32 v[24:25], v[24:25], v[10:11] op_sel_hi:[1,0]
    v_pk_mul_f32 v[26:27], v[26:27], v[10:11] op_sel_hi:[1,0]
    v_cvt_pk_bf16_f32 v20, v20, v21
    v_cvt_pk_bf16_f32 v21, v22, v23
    v_cvt_pk_bf16_f32 v22, v24, v25
    v_cvt_pk_bf16_f32 v23, v26, v27
    buffer_store_dwordx4 v[20:23], v1, s[40:43], s72 offen offset:3072 sc1
    v_mov_b32 v9, 1
    v_lshlrev_b32 v8, 20, v1
    s_lshl2_add_u32 s7, s75, s101
    s_add_u32 s7, s7, 32768
    s_waitcnt vmcnt(8)
    buffer_store_dword v9, v8, s[32:35], s7 offen sc1
    s_sub_u32 s78, 14, s6
    s_sub_u32 s78, s78, s6
    s_cmp_eq_u32 s78, 0
    s_cbranch_scc1 K1_LS_END
.p2align 3
K1_LS:
    s_waitcnt lgkmcnt(0)
    v_mfma_f32_16x16x32_bf16 v[240:243], a[224:227], v[136:139], v[176:179]
    s_add_u32 m0, s76, s75
    v_exp_f32 v254, v254
    v_mfma_f32_16x16x32_bf16 v[240:243], a[228:231], v[168:171], v[240:243]
    s_mov_b32 s76, s60
    v_exp_f32 v255, v255
    v_mfma_f32_16x16x32_bf16 v[240:243], a[232:235], v[200:203], v[240:243]
    s_mov_b32 s60, s82
    buffer_load_dwordx4 v1, s[36:39], s77 offen sc1 lds
    v_mfma_f32_16x16x32_bf16 v[240:243], a[236:239], v[232:235], v[240:243]
    s_add_u32 s82, s82, 32768
    ds_read_b128 v[104:107], v2 offset:18432
    v_cvt_pk_bf16_f32 v63, v254, v255
    v_mfma_f32_16x16x32_bf16 a[8:11], v[96:99], v[48:51], a[8:11]
    ds_read_b128 v[108:111], v2 offset:19456
    ds_read_b128 a[240:243], v2 offset:4096
    v_mfma_f32_16x16x32_bf16 a[8:11], v[100:103], v[52:55], a[8:11]
    ds_read_b128 a[244:247], v2 offset:5120
    v_mfma_f32_16x16x32_bf16 a[12:15], v[96:99], v[56:59], a[12:15]
    buffer_load_dwordx4 v1, s[36:39], s77 offen offset:1024 sc1 lds
    v_mfma_f32_16x16x32_bf16 a[12:15], v[100:103], v[60:63], a[12:15]
    ds_read_b128 a[248:251], v2 offset:6144
    ds_read_b128 a[252:255], v2 offset:7168
    v_mfma_f32_16x16x32_bf16 v[244:247], a[224:227], v[140:143], v[156:159]
    v_exp_f32 v240, v240
    v_mfma_f32_16x16x32_bf16 v[244:247], a[228:231], v[172:175], v[244:247]
    ds_read_b128 v[112:115], v2 offset:20480
    ds_read_b128 v[116:119], v2 offset:21504
    v_mfma_f32_16x16x32_bf16 v[244:247], a[232:235], v[204:207], v[244:247]
    v_exp_f32 v241, v241
    v_mfma_f32_16x16x32_bf16 v[244:247], a[236:239], v[236:239], v[244:247]
    s_waitcnt lgkmcnt(4)
    ds_read_b128 v[120:123], v2 offset:22528
    ds_read_b128 v[124:127], v2 offset:23552
    v_mfma_f32_16x16x32_bf16 a[24:27], v[104:107], v[48:51], a[24:27]
    buffer_load_dwordx4 v1, s[36:39], s77 offen offset:2048 sc1 lds
    v_mfma_f32_16x16x32_bf16 a[24:27], v[108:111], v[52:55], a[24:27]
    ds_read_b128 a[224:227], v2 offset:8192
    ds_read_b128 a[228:231], v2 offset:9216
    v_mfma_f32_16x16x32_bf16 a[28:31], v[104:107], v[56:59], a[28:31]
    ds_read_b128 a[232:235], v2 offset:10240
    v_cvt_pk_bf16_f32 v80, v240, v241
    v_mfma_f32_16x16x32_bf16 a[28:31], v[108:111], v[60:63], a[28:31]
    v_exp_f32 v242, v242
    v_mfma_f32_16x16x32_bf16 v[248:251], a[240:243], v[136:139], v[180:183]
    ds_read_b128 a[236:239], v2 offset:11264
    ds_read_b128 v[96:99], v2 offset:24576
    v_mfma_f32_16x16x32_bf16 v[248:251], a[244:247], v[168:171], v[248:251]
    s_waitcnt lgkmcnt(5)
    v_exp_f32 v243, v243
    v_mfma_f32_16x16x32_bf16 v[248:251], a[248:251], v[200:203], v[248:251]
    buffer_load_dwordx4 v1, s[36:39], s77 offen offset:3072 sc1 lds
    v_mfma_f32_16x16x32_bf16 v[248:251], a[252:255], v[232:235], v[248:251]
    ds_read_b128 v[100:103], v2 offset:25600
    v_cvt_pk_bf16_f32 v81, v242, v243
    v_mfma_f32_16x16x32_bf16 a[40:43], v[112:115], v[48:51], a[40:43]
    ds_read_b128 v[104:107], v2 offset:26624
    ds_read_b128 v[108:111], v2 offset:27648
    v_mfma_f32_16x16x32_bf16 a[40:43], v[116:119], v[52:55], a[40:43]
    v_exp_f32 v244, v244
    v_mfma_f32_16x16x32_bf16 a[44:47], v[112:115], v[56:59], a[44:47]
    v_exp_f32 v245, v245
    v_mfma_f32_16x16x32_bf16 a[44:47], v[116:119], v[60:63], a[44:47]
    s_add_u32 s100, s77, 4096
    v_exp_f32 v246, v246
    v_mfma_f32_16x16x32_bf16 v[252:255], a[240:243], v[140:143], v[156:159]
    s_add_u32 m0, m0, 4096
    v_exp_f32 v247, v247
    v_mfma_f32_16x16x32_bf16 v[252:255], a[244:247], v[172:175], v[252:255]
    buffer_load_dwordx4 v1, s[36:39], s100 offen sc1 lds
    v_mfma_f32_16x16x32_bf16 v[252:255], a[248:251], v[204:207], v[252:255]
    v_cvt_pk_bf16_f32 v88, v244, v245
    v_cvt_pk_bf16_f32 v89, v246, v247
    v_mfma_f32_16x16x32_bf16 v[252:255], a[252:255], v[236:239], v[252:255]
    ds_read_b128 a[240:243], v2 offset:12288
    ds_read_b128 a[244:247], v2 offset:13312
    v_mfma_f32_16x16x32_bf16 a[56:59], v[120:123], v[48:51], a[56:59]
    v_exp_f32 v248, v248
    v_mfma_f32_16x16x32_bf16 a[56:59], v[124:127], v[52:55], a[56:59]
    buffer_load_dwordx4 v1, s[36:39], s100 offen offset:1024 sc1 lds
    v_mfma_f32_16x16x32_bf16 a[60:63], v[120:123], v[56:59], a[60:63]
    ds_read_b128 a[248:251], v2 offset:14336
    ds_read_b128 a[252:255], v2 offset:15360
    v_mfma_f32_16x16x32_bf16 a[60:63], v[124:127], v[60:63], a[60:63]
    s_waitcnt lgkmcnt(4)
    v_exp_f32 v249, v249
    v_mfma_f32_16x16x32_bf16 v[240:243], a[224:227], v[136:139], v[184:187]
    ds_read_b128 v[112:115], v2 offset:28672
    ds_read_b128 v[116:119], v2 offset:29696
    v_mfma_f32_16x16x32_bf16 v[240:243], a[228:231], v[168:171], v[240:243]
    v_exp_f32 v250, v250
    v_mfma_f32_16x16x32_bf16 v[240:243], a[232:235], v[200:203], v[240:243]
    v_exp_f32 v251, v251
    v_mfma_f32_16x16x32_bf16 v[240:243], a[236:239], v[232:235], v[240:243]
    buffer_load_dwordx4 v1, s[36:39], s100 offen offset:2048 sc1 lds
    v_mfma_f32_16x16x32_bf16 a[152:155], v[96:99], v[48:51], a[152:155]
    v_cvt_pk_bf16_f32 v82, v248, v249
    v_cvt_pk_bf16_f32 v83, v250, v251
    v_mfma_f32_16x16x32_bf16 a[152:155], v[100:103], v[52:55], a[152:155]
    ds_read_b128 v[120:123], v2 offset:30720
    ds_read_b128 v[124:127], v2 offset:31744
    v_mfma_f32_16x16x32_bf16 a[156:159], v[96:99], v[56:59], a[156:159]
    v_exp_f32 v252, v252
    v_mfma_f32_16x16x32_bf16 a[156:159], v[100:103], v[60:63], a[156:159]
    v_exp_f32 v253, v253
    v_mfma_f32_16x16x32_bf16 v[244:247], a[224:227], v[140:143], v[156:159]
    v_exp_f32 v254, v254
    v_mfma_f32_16x16x32_bf16 v[244:247], a[228:231], v[172:175], v[244:247]
    buffer_load_dwordx4 v1, s[36:39], s100 offen offset:3072 sc1 lds
    v_mfma_f32_16x16x32_bf16 v[244:247], a[232:235], v[204:207], v[244:247]
    v_exp_f32 v255, v255
    v_mfma_f32_16x16x32_bf16 v[244:247], a[236:239], v[236:239], v[244:247]
    s_cmp_eq_u32 s82, 163840
    s_cselect_b32 s82, 0, s82
    v_cvt_pk_bf16_f32 v90, v252, v253
    v_mfma_f32_16x16x32_bf16 a[168:171], v[104:107], v[48:51], a[168:171]
    v_cvt_pk_bf16_f32 v91, v254, v255
    v_add_u32 v2, s82, v1
    v_mfma_f32_16x16x32_bf16 a[168:171], v[108:111], v[52:55], a[168:171]
    ds_read_b128 a[224:227], v2 offset:0
    ds_read_b128 a[228:231], v2 offset:1024
    v_mfma_f32_16x16x32_bf16 a[172:175], v[104:107], v[56:59], a[172:175]
    s_add_u32 s77, s77, 32768
    v_exp_f32 v240, v240
    v_mfma_f32_16x16x32_bf16 a[172:175], v[108:111], v[60:63], a[172:175]
    s_waitcnt lgkmcnt(2)
    ds_read_b128 a[232:235], v2 offset:2048
    ds_read_b128 a[236:239], v2 offset:3072
    v_mfma_f32_16x16x32_bf16 v[248:251], a[240:243], v[136:139], v[188:191]
    v_exp_f32 v241, v241
    v_mfma_f32_16x16x32_bf16 v[248:251], a[244:247], v[168:171], v[248:251]
    ds_read_b128 v[96:99], v2 offset:16384
    ds_read_b128 v[100:103], v2 offset:17408
    v_mfma_f32_16x16x32_bf16 v[248:251], a[248:251], v[200:203], v[248:251]
    v_exp_f32 v242, v242
    v_mfma_f32_16x16x32_bf16 v[248:251], a[252:255], v[232:235], v[248:251]
    v_exp_f32 v243, v243
    v_mfma_f32_16x16x32_bf16 a[184:187], v[112:115], v[48:51], a[184:187]
    v_exp_f32 v244, v244
    v_mfma_f32_16x16x32_bf16 a[184:187], v[116:119], v[52:55], a[184:187]
    v_exp_f32 v245, v245
    v_mfma_f32_16x16x32_bf16 a[188:191], v[112:115], v[56:59], a[188:191]
    v_exp_f32 v246, v246
    v_mfma_f32_16x16x32_bf16 a[188:191], v[116:119], v[60:63], a[188:191]
    v_exp_f32 v247, v247
    v_mfma_f32_16x16x32_bf16 v[252:255], a[240:243], v[140:143], v[156:159]
    v_exp_f32 v248, v248
    v_mfma_f32_16x16x32_bf16 v[252:255], a[244:247], v[172:175], v[252:255]
    v_exp_f32 v249, v249
    v_mfma_f32_16x16x32_bf16 v[252:255], a[248:251], v[204:207], v[252:255]
    v_exp_f32 v250, v250
    v_mfma_f32_16x16x32_bf16 v[252:255], a[252:255], v[236:239], v[252:255]
    v_exp_f32 v251, v251
    v_mfma_f32_16x16x32_bf16 a[200:203], v[120:123], v[48:51], a[200:203]
    v_cvt_pk_bf16_f32 v84, v240, v241
    v_cvt_pk_bf16_f32 v85, v242, v243
    v_mfma_f32_16x16x32_bf16 a[200:203], v[124:127], v[52:55], a[200:203]
    v_cvt_pk_bf16_f32 v92, v244, v245
    v_cvt_pk_bf16_f32 v93, v246, v247
    v_mfma_f32_16x16x32_bf16 a[204:207], v[120:123], v[56:59], a[204:207]
    v_exp_f32 v252, v252
    v_mfma_f32_16x16x32_bf16 a[204:207], v[124:127], v[60:63], a[204:207]
    v_exp_f32 v253, v253
    v_mfma_f32_16x16x32_bf16 a[216:219], a[136:139], v[48:51], a[216:219]
    v_cvt_pk_bf16_f32 v86, v248, v249
    v_cvt_pk_bf16_f32 v87, v250, v251
    v_mfma_f32_16x16x32_bf16 a[216:219], a[136:139], v[52:55], a[216:219]
    v_cvt_pk_bf16_f32 v94, v252, v253
    v_mfma_f32_16x16x32_bf16 a[220:223], a[136:139], v[56:59], a[220:223]
    v_mfma_f32_16x16x32_bf16 a[220:223], a[136:139], v[60:63], a[220:223]
    s_cmp_eq_u32 s78, 1
    s_cbranch_scc1 K1_LS_MASK
K1_LS_BACK:
    s_waitcnt lgkmcnt(0)
    v_mfma_f32_16x16x32_bf16 v[240:243], a[224:227], v[136:139], v[176:179]
    s_add_u32 m0, s76, s75
    v_exp_f32 v254, v254
    v_mfma_f32_16x16x32_bf16 v[240:243], a[228:231], v[168:171], v[240:243]
    s_mov_b32 s76, s60
    v_exp_f32 v255, v255
    v_mfma_f32_16x16x32_bf16 v[240:243], a[232:235], v[200:203], v[240:243]
    s_mov_b32 s60, s82
    buffer_load_dwordx4 v1, s[36:39], s77 offen sc1 lds
    v_mfma_f32_16x16x32_bf16 v[240:243], a[236:239], v[232:235], v[240:243]
    s_add_u32 s82, s82, 32768
    ds_read_b128 v[104:107], v2 offset:18432
    v_cvt_pk_bf16_f32 v95, v254, v255
    v_mfma_f32_16x16x32_bf16 a[8:11], v[96:99], v[80:83], a[8:11]
    ds_read_b128 v[108:111], v2 offset:19456
    ds_read_b128 a[240:243], v2 offset:4096
    v_mfma_f32_16x16x32_bf16 a[8:11], v[100:103], v[84:87], a[8:11]
    ds_read_b128 a[244:247], v2 offset:5120
    v_mfma_f32_16x16x32_bf16 a[12:15], v[96:99], v[88:91], a[12:15]
    buffer_load_dwordx4 v1, s[36:39], s77 offen offset:1024 sc1 lds
    v_mfma_f32_16x16x32_bf16 a[12:15], v[100:103], v[92:95], a[12:15]
    ds_read_b128 a[248:251], v2 offset:6144
    ds_read_b128 a[252:255], v2 offset:7168
    v_mfma_f32_16x16x32_bf16 v[244:247], a[224:227], v[140:143], v[156:159]
    v_exp_f32 v240, v240
    v_mfma_f32_16x16x32_bf16 v[244:247], a[228:231], v[172:175], v[244:247]
    ds_read_b128 v[112:115], v2 offset:20480
    ds_read_b128 v[116:119], v2 offset:21504
    v_mfma_f32_16x16x32_bf16 v[244:247], a[232:235], v[204:207], v[244:247]
    v_exp_f32 v241, v241
    v_mfma_f32_16x16x32_bf16 v[244:247], a[236:239], v[236:239], v[244:247]
    s_waitcnt lgkmcnt(4)
    ds_read_b128 v[120:123], v2 offset:22528
    ds_read_b128 v[124:127], v2 offset:23552
    v_mfma_f32_16x16x32_bf16 a[24:27], v[104:107], v[80:83], a[24:27]
    buffer_load_dwordx4 v1, s[36:39], s77 offen offset:2048 sc1 lds
    v_mfma_f32_16x16x32_bf16 a[24:27], v[108:111], v[84:87], a[24:27]
    ds_read_b128 a[224:227], v2 offset:8192
    ds_read_b128 a[228:231], v2 offset:9216
    v_mfma_f32_16x16x32_bf16 a[28:31], v[104:107], v[88:91], a[28:31]
    ds_read_b128 a[232:235], v2 offset:10240
    v_cvt_pk_bf16_f32 v48, v240, v241
    v_mfma_f32_16x16x32_bf16 a[28:31], v[108:111], v[92:95], a[28:31]
    v_exp_f32 v242, v242
    v_mfma_f32_16x16x32_bf16 v[248:251], a[240:243], v[136:139], v[180:183]
    ds_read_b128 a[236:239], v2 offset:11264
    ds_read_b128 v[96:99], v2 offset:24576
    v_mfma_f32_16x16x32_bf16 v[248:251], a[244:247], v[168:171], v[248:251]
    s_waitcnt lgkmcnt(5)
    v_exp_f32 v243, v243
    v_mfma_f32_16x16x32_bf16 v[248:251], a[248:251], v[200:203], v[248:251]
    buffer_load_dwordx4 v1, s[36:39], s77 offen offset:3072 sc1 lds
    v_mfma_f32_16x16x32_bf16 v[248:251], a[252:255], v[232:235], v[248:251]
    ds_read_b128 v[100:103], v2 offset:25600
    v_cvt_pk_bf16_f32 v49, v242, v243
    v_mfma_f32_16x16x32_bf16 a[40:43], v[112:115], v[80:83], a[40:43]
    ds_read_b128 v[104:107], v2 offset:26624
    ds_read_b128 v[108:111], v2 offset:27648
    v_mfma_f32_16x16x32_bf16 a[40:43], v[116:119], v[84:87], a[40:43]
    v_exp_f32 v244, v244
    v_mfma_f32_16x16x32_bf16 a[44:47], v[112:115], v[88:91], a[44:47]
    v_exp_f32 v245, v245
    v_mfma_f32_16x16x32_bf16 a[44:47], v[116:119], v[92:95], a[44:47]
    s_add_u32 s100, s77, 4096
    v_exp_f32 v246, v246
    v_mfma_f32_16x16x32_bf16 v[252:255], a[240:243], v[140:143], v[156:159]
    s_add_u32 m0, m0, 4096
    v_exp_f32 v247, v247
    v_mfma_f32_16x16x32_bf16 v[252:255], a[244:247], v[172:175], v[252:255]
    buffer_load_dwordx4 v1, s[36:39], s100 offen sc1 lds
    v_mfma_f32_16x16x32_bf16 v[252:255], a[248:251], v[204:207], v[252:255]
    v_cvt_pk_bf16_f32 v56, v244, v245
    v_cvt_pk_bf16_f32 v57, v246, v247
    v_mfma_f32_16x16x32_bf16 v[252:255], a[252:255], v[236:239], v[252:255]
    ds_read_b128 a[240:243], v2 offset:12288
    ds_read_b128 a[244:247], v2 offset:13312
    v_mfma_f32_16x16x32_bf16 a[56:59], v[120:123], v[80:83], a[56:59]
    v_exp_f32 v248, v248
    v_mfma_f32_16x16x32_bf16 a[56:59], v[124:127], v[84:87], a[56:59]
    buffer_load_dwordx4 v1, s[36:39], s100 offen offset:1024 sc1 lds
    v_mfma_f32_16x16x32_bf16 a[60:63], v[120:123], v[88:91], a[60:63]
    ds_read_b128 a[248:251], v2 offset:14336
    ds_read_b128 a[252:255], v2 offset:15360
    v_mfma_f32_16x16x32_bf16 a[60:63], v[124:127], v[92:95], a[60:63]
    s_waitcnt lgkmcnt(4)
    v_exp_f32 v249, v249
    v_mfma_f32_16x16x32_bf16 v[240:243], a[224:227], v[136:139], v[184:187]
    ds_read_b128 v[112:115], v2 offset:28672
    ds_read_b128 v[116:119], v2 offset:29696
    v_mfma_f32_16x16x32_bf16 v[240:243], a[228:231], v[168:171], v[240:243]
    v_exp_f32 v250, v250
    v_mfma_f32_16x16x32_bf16 v[240:243], a[232:235], v[200:203], v[240:243]
    v_exp_f32 v251, v251
    v_mfma_f32_16x16x32_bf16 v[240:243], a[236:239], v[232:235], v[240:243]
    buffer_load_dwordx4 v1, s[36:39], s100 offen offset:2048 sc1 lds
    v_mfma_f32_16x16x32_bf16 a[152:155], v[96:99], v[80:83], a[152:155]
    v_cvt_pk_bf16_f32 v50, v248, v249
    v_cvt_pk_bf16_f32 v51, v250, v251
    v_mfma_f32_16x16x32_bf16 a[152:155], v[100:103], v[84:87], a[152:155]
    ds_read_b128 v[120:123], v2 offset:30720
    ds_read_b128 v[124:127], v2 offset:31744
    v_mfma_f32_16x16x32_bf16 a[156:159], v[96:99], v[88:91], a[156:159]
    v_exp_f32 v252, v252
    v_mfma_f32_16x16x32_bf16 a[156:159], v[100:103], v[92:95], a[156:159]
    v_exp_f32 v253, v253
    v_mfma_f32_16x16x32_bf16 v[244:247], a[224:227], v[140:143], v[156:159]
    v_exp_f32 v254, v254
    v_mfma_f32_16x16x32_bf16 v[244:247], a[228:231], v[172:175], v[244:247]
    buffer_load_dwordx4 v1, s[36:39], s100 offen offset:3072 sc1 lds
    v_mfma_f32_16x16x32_bf16 v[244:247], a[232:235], v[204:207], v[244:247]
    v_exp_f32 v255, v255
    v_mfma_f32_16x16x32_bf16 v[244:247], a[236:239], v[236:239], v[244:247]
    s_cmp_eq_u32 s82, 163840
    s_cselect_b32 s82, 0, s82
    v_cvt_pk_bf16_f32 v58, v252, v253
    v_mfma_f32_16x16x32_bf16 a[168:171], v[104:107], v[80:83], a[168:171]
    v_cvt_pk_bf16_f32 v59, v254, v255
    v_add_u32 v2, s82, v1
    v_mfma_f32_16x16x32_bf16 a[168:171], v[108:111], v[84:87], a[168:171]
    v_exp_f32 v240, v240
    v_mfma_f32_16x16x32_bf16 a[172:175], v[104:107], v[88:91], a[172:175]
    s_add_u32 s77, s77, 32768
    v_exp_f32 v241, v241
    v_mfma_f32_16x16x32_bf16 a[172:175], v[108:111], v[92:95], a[172:175]
    s_waitcnt lgkmcnt(0)
    v_exp_f32 v242, v242
    v_mfma_f32_16x16x32_bf16 v[248:251], a[240:243], v[136:139], v[188:191]
    v_exp_f32 v243, v243
    v_mfma_f32_16x16x32_bf16 v[248:251], a[244:247], v[168:171], v[248:251]
    v_exp_f32 v244, v244
    v_mfma_f32_16x16x32_bf16 v[248:251], a[248:251], v[200:203], v[248:251]
    v_exp_f32 v245, v245
    v_mfma_f32_16x16x32_bf16 v[248:251], a[252:255], v[232:235], v[248:251]
    v_exp_f32 v246, v246
    v_mfma_f32_16x16x32_bf16 a[184:187], v[112:115], v[80:83], a[184:187]
    v_exp_f32 v247, v247
    v_mfma_f32_16x16x32_bf16 a[184:187], v[116:119], v[84:87], a[184:187]
    v_cvt_pk_bf16_f32 v52, v240, v241
    v_cvt_pk_bf16_f32 v53, v242, v243
    v_mfma_f32_16x16x32_bf16 a[188:191], v[112:115], v[88:91], a[188:191]
    v_cvt_pk_bf16_f32 v60, v244, v245
    v_cvt_pk_bf16_f32 v61, v246, v247
    v_mfma_f32_16x16x32_bf16 a[188:191], v[116:119], v[92:95], a[188:191]
    s_waitcnt vmcnt(8) lgkmcnt(0)
    s_barrier
    ds_read_b128 a[224:227], v2 offset:0
    v_mfma_f32_16x16x32_bf16 v[252:255], a[240:243], v[140:143], v[156:159]
    ds_read_b128 a[228:231], v2 offset:1024
    ds_read_b128 a[232:235], v2 offset:2048
    v_mfma_f32_16x16x32_bf16 v[252:255], a[244:247], v[172:175], v[252:255]
    v_exp_f32 v248, v248
    v_mfma_f32_16x16x32_bf16 v[252:255], a[248:251], v[204:207], v[252:255]
    ds_read_b128 a[236:239], v2 offset:3072
    ds_read_b128 v[96:99], v2 offset:16384
    v_mfma_f32_16x16x32_bf16 v[252:255], a[252:255], v[236:239], v[252:255]
    v_exp_f32 v249, v249
    v_mfma_f32_16x16x32_bf16 a[200:203], v[120:123], v[80:83], a[200:203]
    ds_read_b128 v[100:103], v2 offset:17408
    v_cvt_pk_bf16_f32 v54, v248, v249
    v_mfma_f32_16x16x32_bf16 a[200:203], v[124:127], v[84:87], a[200:203]
    v_exp_f32 v250, v250
    v_mfma_f32_16x16x32_bf16 a[204:207], v[120:123], v[88:91], a[204:207]
    v_exp_f32 v251, v251
    v_mfma_f32_16x16x32_bf16 a[204:207], v[124:127], v[92:95], a[204:207]
    v_exp_f32 v252, v252
    v_mfma_f32_16x16x32_bf16 a[216:219], a[136:139], v[80:83], a[216:219]
    v_exp_f32 v253, v253
    v_mfma_f32_16x16x32_bf16 a[216:219], a[136:139], v[84:87], a[216:219]
    v_cvt_pk_bf16_f32 v55, v250, v251
    v_cvt_pk_bf16_f32 v62, v252, v253
    v_mfma_f32_16x16x32_bf16 a[220:223], a[136:139], v[88:91], a[220:223]
    v_mfma_f32_16x16x32_bf16 a[220:223], a[136:139], v[92:95], a[220:223]
    s_sub_u32 s78, s78, 1
    s_cmp_lg_u32 s78, 0
    s_cbranch_scc1 K1_LS
K1_LS_END:
    v_add_f32 v212, s12, v156
    v_fma_f32 v176, v208, s8, v212
    v_fma_f32 v177, v209, s8, v212
    v_fma_f32 v178, v210, s8, v212
    v_fma_f32 v179, v211, s8, v212
    s_nop 1
    s_waitcnt lgkmcnt(0)
    v_mfma_f32_16x16x32_bf16 v[240:243], a[224:227], v[140:143], v[176:179]
    s_mul_i32 s86, s4, 34
    ds_read_b128 v[104:107], v2 offset:18432
    ds_read_b128 v[108:111], v2 offset:19456
    v_mfma_f32_16x16x32_bf16 v[240:243], a[228:231], v[172:175], v[240:243]
    s_add_u32 s86, s86, 8
    v_exp_f32 v254, v254
    v_mfma_f32_16x16x32_bf16 v[240:243], a[232:235], v[204:207], v[240:243]
    s_mov_b32 s76, s60
    v_exp_f32 v255, v255
    v_mfma_f32_16x16x32_bf16 v[240:243], a[236:239], v[236:239], v[240:243]
    s_mov_b32 s60, s82
    ds_read_b128 a[240:243], v2 offset:4096
    v_cvt_pk_bf16_f32 v63, v254, v255
    v_mfma_f32_16x16x32_bf16 a[8:11], v[96:99], v[48:51], a[8:11]
    s_add_u32 s82, s82, 32768
    ds_read_b128 a[244:247], v2 offset:5120
    ds_read_b128 a[248:251], v2 offset:6144
    v_mfma_f32_16x16x32_bf16 a[8:11], v[100:103], v[52:55], a[8:11]
    s_lshr_b32 s61, s5, 3
    v_lshrrev_b32 v28, 4, v1
    ds_read_b128 a[252:255], v2 offset:7168
    v_mfma_f32_16x16x32_bf16 a[12:15], v[96:99], v[56:59], a[12:15]
    s_add_u32 s99, s61, 0
    v_min_u32 v28, 33, v28
    ds_read_b128 v[112:115], v2 offset:20480
    v_mfma_f32_16x16x32_bf16 a[12:15], v[100:103], v[60:63], a[12:15]
    s_and_b32 s98, s5, 3
    v_add_lshl_u32 v28, v28, s86, 7
    v_add_f32 v213, s13, v156
    s_waitcnt lgkmcnt(5)
    v_mfma_f32_16x16x32_bf16 a[24:27], v[104:107], v[48:51], a[24:27]
    s_and_b32 s99, s99, 3
    ds_read_b128 v[116:119], v2 offset:21504
    v_fma_f32 v180, v208, s9, v213
    v_mfma_f32_16x16x32_bf16 a[24:27], v[108:111], v[52:55], a[24:27]
    s_getpc_b64 s[86:87]
    global_load_dword v28, v28, s[86:87]
    v_mfma_f32_16x16x32_bf16 a[28:31], v[104:107], v[56:59], a[28:31]
    s_lshl2_add_u32 s99, s99, s98
    v_fma_f32 v181, v209, s9, v213
    v_fma_f32 v182, v210, s9, v213
    v_mfma_f32_16x16x32_bf16 a[28:31], v[108:111], v[60:63], a[28:31]
    s_lshl_b32 s16, s99, 11
    v_fma_f32 v183, v211, s9, v213
    ds_read_b128 v[120:123], v2 offset:22528
    s_nop 0
    s_waitcnt lgkmcnt(2)
    v_mfma_f32_16x16x32_bf16 v[244:247], a[240:243], v[140:143], v[180:183]
    s_add_u32 s99, s61, 1
    ds_read_b128 v[124:127], v2 offset:23552
    ds_read_b128 a[224:227], v2 offset:8192
    v_mfma_f32_16x16x32_bf16 v[244:247], a[244:247], v[172:175], v[244:247]
    s_and_b32 s99, s99, 3
    ds_read_b128 a[228:231], v2 offset:9216
    v_add_f32 v214, s14, v156
    v_mfma_f32_16x16x32_bf16 v[244:247], a[248:251], v[204:207], v[244:247]
    s_lshl2_add_u32 s99, s99, s98
    ds_read_b128 a[232:235], v2 offset:10240
    v_fma_f32 v184, v208, s10, v214
    v_mfma_f32_16x16x32_bf16 v[244:247], a[252:255], v[236:239], v[244:247]
    s_lshl_b32 s17, s99, 11
    ds_read_b128 a[236:239], v2 offset:11264
    v_fma_f32 v185, v209, s10, v214
    v_mfma_f32_16x16x32_bf16 a[40:43], v[112:115], v[48:51], a[40:43]
    s_add_u32 s99, s61, 2
    ds_read_b128 v[96:99], v2 offset:24576
    v_fma_f32 v186, v210, s10, v214
    s_waitcnt lgkmcnt(6)
    v_mfma_f32_16x16x32_bf16 a[40:43], v[116:119], v[52:55], a[40:43]
    s_and_b32 s99, s99, 3
    ds_read_b128 v[100:103], v2 offset:25600
    v_fma_f32 v187, v211, s10, v214
    v_mfma_f32_16x16x32_bf16 a[44:47], v[112:115], v[56:59], a[44:47]
    s_lshl2_add_u32 s99, s99, s98
    ds_read_b128 v[104:107], v2 offset:26624
    v_add_f32 v215, s15, v156
    v_mfma_f32_16x16x32_bf16 a[44:47], v[116:119], v[60:63], a[44:47]
    s_add_u32 s3, s5, s6
    ds_read_b128 v[108:111], v2 offset:27648
    v_fma_f32 v188, v208, s11, v215
    v_mfma_f32_16x16x32_bf16 a[56:59], v[120:123], v[48:51], a[56:59]
    s_lshl_b32 s18, s99, 11
    ds_read_b128 a[240:243], v2 offset:12288
    v_fma_f32 v189, v209, s11, v215
    s_waitcnt lgkmcnt(5)
    v_mfma_f32_16x16x32_bf16 a[56:59], v[124:127], v[52:55], a[56:59]
    s_add_u32 s99, s61, 3
    ds_read_b128 a[244:247], v2 offset:13312
    v_fma_f32 v190, v210, s11, v215
    v_mfma_f32_16x16x32_bf16 a[60:63], v[120:123], v[56:59], a[60:63]
    s_and_b32 s3, s3, 3
    ds_read_b128 a[248:251], v2 offset:14336
    v_fma_f32 v191, v211, s11, v215
    v_mfma_f32_16x16x32_bf16 a[60:63], v[124:127], v[60:63], a[60:63]
    s_and_b32 s99, s99, 3
    ds_read_b128 a[252:255], v2 offset:15360
    v_and_b32 v31, 0x70, v1
    v_mfma_f32_16x16x32_bf16 v[248:251], a[224:227], v[140:143], v[184:187]
    s_add_u32 s20, s98, 32
    ds_read_b128 v[112:115], v2 offset:28672
    v_lshrrev_b32 v29, 7, v1
    v_mfma_f32_16x16x32_bf16 v[248:251], a[228:231], v[172:175], v[248:251]
    s_lshl3_add_u32 s3, s61, s3
    ds_read_b128 v[116:119], v2 offset:29696
    v_lshlrev_b32 v31, 3, v31
    v_mfma_f32_16x16x32_bf16 v[248:251], a[232:235], v[204:207], v[248:251]
    s_lshl2_add_u32 s99, s99, s98
    ds_read_b128 v[120:123], v2 offset:30720
    v_lshl_add_u32 v29, v29, 12, v31
    v_mfma_f32_16x16x32_bf16 v[248:251], a[236:239], v[236:239], v[248:251]
    s_sub_u32 s62, 15, s6
    v_exp_f32 v240, v240
    s_waitcnt lgkmcnt(4)
    v_mfma_f32_16x16x32_bf16 a[152:155], v[96:99], v[48:51], a[152:155]
    s_lshl2_add_u32 s66, s6, s61
    v_exp_f32 v241, v241
    v_mfma_f32_16x16x32_bf16 a[152:155], v[100:103], v[52:55], a[152:155]
    s_mul_i32 s71, s5, 768
    ds_read_b128 v[124:127], v2 offset:31744
    v_cvt_pk_bf16_f32 v88, v240, v241
    v_mfma_f32_16x16x32_bf16 a[156:159], v[96:99], v[56:59], a[156:159]
    s_cmp_eq_u32 s82, 163840
    s_cselect_b32 s82, 0, s82
    v_add_u32 v2, s82, v1
    v_mfma_f32_16x16x32_bf16 a[156:159], v[100:103], v[60:63], a[156:159]
    s_lshl_b32 s20, s20, 10
    ds_read_b128 a[224:227], v2 offset:0
    ds_read_b128 a[228:231], v2 offset:1024
    v_mfma_f32_16x16x32_bf16 a[168:171], v[104:107], v[48:51], a[168:171]
    s_mul_i32 s78, s4, 7168
    v_exp_f32 v242, v242
    v_mfma_f32_16x16x32_bf16 a[168:171], v[108:111], v[52:55], a[168:171]
    s_lshl_b32 s19, s99, 11
    ds_read_b128 a[232:235], v2 offset:2048
    ds_read_b128 a[236:239], v2 offset:3072
    v_mfma_f32_16x16x32_bf16 a[172:175], v[104:107], v[56:59], a[172:175]
    s_lshl_b32 s63, s3, 12
    v_exp_f32 v243, v243
    v_mfma_f32_16x16x32_bf16 a[172:175], v[108:111], v[60:63], a[172:175]
    s_lshl_b32 s66, s66, 10
    ds_read_b128 v[96:99], v2 offset:16384
    ds_read_b128 v[100:103], v2 offset:17408
    v_mfma_f32_16x16x32_bf16 v[252:255], a[240:243], v[140:143], v[188:191]
    s_add_u32 s71, s71, 131072
    v_exp_f32 v244, v244
    v_mfma_f32_16x16x32_bf16 v[252:255], a[244:247], v[172:175], v[252:255]
    s_mov_b32 s50, 9437184
    v_exp_f32 v245, v245
    v_mfma_f32_16x16x32_bf16 v[252:255], a[248:251], v[204:207], v[252:255]
    s_waitcnt lgkmcnt(2)
    v_exp_f32 v246, v246
    v_mfma_f32_16x16x32_bf16 v[252:255], a[252:255], v[236:239], v[252:255]
    v_exp_f32 v247, v247
    v_mfma_f32_16x16x32_bf16 a[184:187], v[112:115], v[48:51], a[184:187]
    v_exp_f32 v248, v248
    v_mfma_f32_16x16x32_bf16 a[184:187], v[116:119], v[52:55], a[184:187]
    v_exp_f32 v249, v249
    v_mfma_f32_16x16x32_bf16 a[188:191], v[112:115], v[56:59], a[188:191]
    v_exp_f32 v250, v250
    v_mfma_f32_16x16x32_bf16 a[188:191], v[116:119], v[60:63], a[188:191]
    v_exp_f32 v251, v251
    v_mfma_f32_16x16x32_bf16 a[200:203], v[120:123], v[48:51], a[200:203]
    v_exp_f32 v252, v252
    v_mfma_f32_16x16x32_bf16 a[200:203], v[124:127], v[52:55], a[200:203]
    v_exp_f32 v253, v253
    v_mfma_f32_16x16x32_bf16 a[204:207], v[120:123], v[56:59], a[204:207]
    buffer_load_dword v3, v29, s[32:35], s92 offen sc1
    v_mfma_f32_16x16x32_bf16 a[204:207], v[124:127], v[60:63], a[204:207]
    v_cvt_pk_bf16_f32 v89, v242, v243
    v_cvt_pk_bf16_f32 v90, v244, v245
    v_mfma_f32_16x16x32_bf16 a[216:219], a[136:139], v[48:51], a[216:219]
    v_cvt_pk_bf16_f32 v91, v246, v247
    v_cvt_pk_bf16_f32 v92, v248, v249
    v_mfma_f32_16x16x32_bf16 a[216:219], a[136:139], v[52:55], a[216:219]
    v_cvt_pk_bf16_f32 v93, v250, v251
    v_cvt_pk_bf16_f32 v94, v252, v253
    v_mfma_f32_16x16x32_bf16 a[220:223], a[136:139], v[56:59], a[220:223]
    s_bitcmp1_b32 s5, 2
    s_cselect_b32 s62, s62, s6
    v_mfma_f32_16x16x32_bf16 a[220:223], a[136:139], v[60:63], a[220:223]
    s_add_u32 s48, s32, 1048576
    s_addc_u32 s49, s33, 0
    ds_read_b128 v[104:107], v2 offset:18432
    ds_read_b128 v[108:111], v2 offset:19456
    ds_read_b128 v[112:115], v2 offset:20480
    ds_read_b128 v[116:119], v2 offset:21504
    ds_read_b128 v[120:123], v2 offset:22528
    ds_read_b128 v[124:127], v2 offset:23552
    s_waitcnt lgkmcnt(6)
    v_mfma_f32_16x16x32_bf16 a[12:15], v[96:99], v[88:91], a[12:15]
    v_exp_f32 v254, v254
    v_exp_f32 v255, v255
    s_nop 0
    v_cvt_pk_bf16_f32 v95, v254, v255
    s_nop 1
    v_mfma_f32_16x16x32_bf16 a[12:15], v[100:103], v[92:95], a[12:15]
    s_waitcnt lgkmcnt(5)
    ds_read_b128 v[96:99], v2 offset:24576
    ds_read_b128 v[100:103], v2 offset:25600
    v_accvgpr_read_b32 v9, a216
    v_rcp_f32 v10, v9
    v_mfma_f32_16x16x32_bf16 a[28:31], v[104:107], v[88:91], a[28:31]
    s_waitcnt lgkmcnt(6)
    ds_read_b128 v[104:107], v2 offset:26624
    v_mul_f32 v10, v10, v6
    v_accvgpr_read_b32 v12, a8
    v_accvgpr_read_b32 v13, a9
    v_accvgpr_read_b32 v14, a10
    v_mfma_f32_16x16x32_bf16 a[28:31], v[108:111], v[92:95], a[28:31]
    s_waitcnt lgkmcnt(6)
    ds_read_b128 v[108:111], v2 offset:27648
    v_accvgpr_read_b32 v15, a11
    v_accvgpr_read_b32 v16, a24
    v_accvgpr_read_b32 v17, a25
    v_accvgpr_read_b32 v18, a26
    v_mfma_f32_16x16x32_bf16 a[44:47], v[112:115], v[88:91], a[44:47]
    s_waitcnt lgkmcnt(4)
    ds_read_b128 v[112:115], v2 offset:28672
    v_accvgpr_read_b32 v19, a27
    v_accvgpr_read_b32 v20, a40
    v_accvgpr_read_b32 v21, a41
    v_accvgpr_read_b32 v22, a42
    v_mfma_f32_16x16x32_bf16 a[44:47], v[116:119], v[92:95], a[44:47]
    ds_read_b128 v[116:119], v2 offset:29696
    v_accvgpr_read_b32 v23, a43
    v_accvgpr_read_b32 v24, a56
    v_accvgpr_read_b32 v25, a57
    v_accvgpr_read_b32 v26, a58
    v_mfma_f32_16x16x32_bf16 a[60:63], v[120:123], v[88:91], a[60:63]
    ds_read_b128 v[120:123], v2 offset:30720
    v_accvgpr_read_b32 v27, a59
    v_mul_f32 v12, v10, v12
    v_mul_f32 v13, v10, v13
    v_mul_f32 v14, v10, v14
    v_mfma_f32_16x16x32_bf16 a[60:63], v[124:127], v[92:95], a[60:63]
    s_waitcnt lgkmcnt(4)
    ds_read_b128 v[124:127], v2 offset:31744
    v_mul_f32 v15, v10, v15
    v_mul_f32 v16, v10, v16
    v_mul_f32 v17, v10, v17
    v_mul_f32 v18, v10, v18
    v_mfma_f32_16x16x32_bf16 a[156:159], v[96:99], v[88:91], a[156:159]
    v_mul_f32 v19, v10, v19
    v_mul_f32 v20, v10, v20
    v_mul_f32 v21, v10, v21
    v_mul_f32 v22, v10, v22
    v_mul_f32 v23, v10, v23
    v_mfma_f32_16x16x32_bf16 a[156:159], v[100:103], v[92:95], a[156:159]
    v_mul_f32 v24, v10, v24
    v_mul_f32 v25, v10, v25
    v_mul_f32 v26, v10, v26
    v_mul_f32 v27, v10, v27
    v_cvt_pk_bf16_f32 v12, v12, v13
    v_mfma_f32_16x16x32_bf16 a[172:175], v[104:107], v[88:91], a[172:175]
    s_waitcnt lgkmcnt(2)
    v_cvt_pk_bf16_f32 v13, v14, v15
    v_cvt_pk_bf16_f32 v14, v16, v17
    v_cvt_pk_bf16_f32 v15, v18, v19
    v_cvt_pk_bf16_f32 v20, v20, v21
    v_cvt_pk_bf16_f32 v21, v22, v23
    v_mfma_f32_16x16x32_bf16 a[172:175], v[108:111], v[92:95], a[172:175]
    v_cvt_pk_bf16_f32 v22, v24, v25
    v_cvt_pk_bf16_f32 v23, v26, v27
    buffer_store_dwordx4 v[12:15], v1, s[40:43], s81 offen offset:0 sc1
    v_accvgpr_read_b32 v16, a168
    v_mfma_f32_16x16x32_bf16 a[188:191], v[112:115], v[88:91], a[188:191]
    buffer_store_dwordx4 v[20:23], v1, s[40:43], s81 offen offset:1024 sc1
    v_accvgpr_read_b32 v12, a152
    v_accvgpr_read_b32 v13, a153
    v_accvgpr_read_b32 v14, a154
    v_mfma_f32_16x16x32_bf16 a[188:191], v[116:119], v[92:95], a[188:191]
    s_waitcnt lgkmcnt(0)
    v_accvgpr_read_b32 v15, a155
    v_accvgpr_read_b32 v17, a169
    v_accvgpr_read_b32 v18, a170
    v_accvgpr_read_b32 v19, a171
    v_accvgpr_read_b32 v20, a184
    v_mfma_f32_16x16x32_bf16 a[204:207], v[120:123], v[88:91], a[204:207]
    v_accvgpr_read_b32 v21, a185
    v_accvgpr_read_b32 v22, a186
    v_accvgpr_read_b32 v23, a187
    v_accvgpr_read_b32 v24, a200
    v_accvgpr_read_b32 v25, a201
    v_mfma_f32_16x16x32_bf16 a[204:207], v[124:127], v[92:95], a[204:207]
    v_accvgpr_read_b32 v26, a202
    v_accvgpr_read_b32 v27, a203
    v_mul_f32 v12, v10, v12
    v_mul_f32 v13, v10, v13
    v_mul_f32 v14, v10, v14
    v_mfma_f32_16x16x32_bf16 a[220:223], a[136:139], v[88:91], a[220:223]
    v_mul_f32 v15, v10, v15
    v_mul_f32 v16, v10, v16
    v_mul_f32 v17, v10, v17
    v_mul_f32 v18, v10, v18
    v_mul_f32 v19, v10, v19
    v_mfma_f32_16x16x32_bf16 a[220:223], a[136:139], v[92:95], a[220:223]
    v_mul_f32 v20, v10, v20
    v_mul_f32 v21, v10, v21
    v_mul_f32 v22, v10, v22
    v_mul_f32 v23, v10, v23
    v_mul_f32 v24, v10, v24
    v_mul_f32 v25, v10, v25
    v_mul_f32 v26, v10, v26
    v_mul_f32 v27, v10, v27
    v_cmp_nge_f32 vcc, 0x71800000, v9
    v_cvt_pk_bf16_f32 v12, v12, v13
    v_cvt_pk_bf16_f32 v13, v14, v15
    v_cvt_pk_bf16_f32 v14, v16, v17
    v_cvt_pk_bf16_f32 v15, v18, v19
    v_cvt_pk_bf16_f32 v20, v20, v21
    v_cvt_pk_bf16_f32 v21, v22, v23
    v_cvt_pk_bf16_f32 v22, v24, v25
    v_cvt_pk_bf16_f32 v23, v26, v27
    s_or_b64 s[84:85], s[84:85], vcc
    buffer_store_dwordx4 v[12:15], v1, s[40:43], s81 offen offset:2048 sc1
    buffer_store_dwordx4 v[20:23], v1, s[40:43], s81 offen offset:3072 sc1
    s_nop 3
    v_accvgpr_read_b32 v9, a220
    v_cmp_nge_f32 vcc, 0x71800000, v9
    v_rcp_f32 v10, v9
    s_nop 0
    s_or_b64 s[84:85], s[84:85], vcc
    v_mul_f32 v10, v10, v7
    s_add_u32 s72, s81, 622592
    v_accvgpr_read_b32 v12, a12
    v_accvgpr_read_b32 v13, a13
    v_accvgpr_read_b32 v14, a14
    v_accvgpr_read_b32 v15, a15
    v_accvgpr_read_b32 v16, a28
    v_accvgpr_read_b32 v17, a29
    v_accvgpr_read_b32 v18, a30
    v_accvgpr_read_b32 v19, a31
    v_pk_mul_f32 v[12:13], v[12:13], v[10:11] op_sel_hi:[1,0]
    v_pk_mul_f32 v[14:15], v[14:15], v[10:11] op_sel_hi:[1,0]
    v_pk_mul_f32 v[16:17], v[16:17], v[10:11] op_sel_hi:[1,0]
    v_pk_mul_f32 v[18:19], v[18:19], v[10:11] op_sel_hi:[1,0]
    v_cvt_pk_bf16_f32 v12, v12, v13
    v_cvt_pk_bf16_f32 v13, v14, v15
    v_cvt_pk_bf16_f32 v14, v16, v17
    v_cvt_pk_bf16_f32 v15, v18, v19
    buffer_store_dwordx4 v[12:15], v1, s[40:43], s72 offen offset:0 sc1
    v_accvgpr_read_b32 v20, a44
    v_accvgpr_read_b32 v21, a45
    v_accvgpr_read_b32 v22, a46
    v_accvgpr_read_b32 v23, a47
    v_accvgpr_read_b32 v24, a60
    v_accvgpr_read_b32 v25, a61
    v_accvgpr_read_b32 v26, a62
    v_accvgpr_read_b32 v27, a63
    v_pk_mul_f32 v[20:21], v[20:21], v[10:11] op_sel_hi:[1,0]
    v_pk_mul_f32 v[22:23], v[22:23], v[10:11] op_sel_hi:[1,0]
    v_pk_mul_f32 v[24:25], v[24:25], v[10:11] op_sel_hi:[1,0]
    v_pk_mul_f32 v[26:27], v[26:27], v[10:11] op_sel_hi:[1,0]
    v_cvt_pk_bf16_f32 v20, v20, v21
    v_cvt_pk_bf16_f32 v21, v22, v23
    v_cvt_pk_bf16_f32 v22, v24, v25
    v_cvt_pk_bf16_f32 v23, v26, v27
    buffer_store_dwordx4 v[20:23], v1, s[40:43], s72 offen offset:1024 sc1
    v_accvgpr_read_b32 v12, a156
    v_accvgpr_read_b32 v13, a157
    v_accvgpr_read_b32 v14, a158
    v_accvgpr_read_b32 v15, a159
    v_accvgpr_read_b32 v16, a172
    v_accvgpr_read_b32 v17, a173
    v_accvgpr_read_b32 v18, a174
    v_accvgpr_read_b32 v19, a175
    v_pk_mul_f32 v[12:13], v[12:13], v[10:11] op_sel_hi:[1,0]
    v_pk_mul_f32 v[14:15], v[14:15], v[10:11] op_sel_hi:[1,0]
    v_pk_mul_f32 v[16:17], v[16:17], v[10:11] op_sel_hi:[1,0]
    v_pk_mul_f32 v[18:19], v[18:19], v[10:11] op_sel_hi:[1,0]
    v_cvt_pk_bf16_f32 v12, v12, v13
    v_cvt_pk_bf16_f32 v13, v14, v15
    v_cvt_pk_bf16_f32 v14, v16, v17
    v_cvt_pk_bf16_f32 v15, v18, v19
    buffer_store_dwordx4 v[12:15], v1, s[40:43], s72 offen offset:2048 sc1
    v_accvgpr_read_b32 v20, a188
    v_accvgpr_read_b32 v21, a189
    v_accvgpr_read_b32 v22, a190
    v_accvgpr_read_b32 v23, a191
    v_accvgpr_read_b32 v24, a204
    v_accvgpr_read_b32 v25, a205
    v_accvgpr_read_b32 v26, a206
    v_accvgpr_read_b32 v27, a207
    v_pk_mul_f32 v[20:21], v[20:21], v[10:11] op_sel_hi:[1,0]
    v_pk_mul_f32 v[22:23], v[22:23], v[10:11] op_sel_hi:[1,0]
    v_pk_mul_f32 v[24:25], v[24:25], v[10:11] op_sel_hi:[1,0]
    v_pk_mul_f32 v[26:27], v[26:27], v[10:11] op_sel_hi:[1,0]
    v_cvt_pk_bf16_f32 v20, v20, v21
    v_cvt_pk_bf16_f32 v21, v22, v23
    v_cvt_pk_bf16_f32 v22, v24, v25
    v_cvt_pk_bf16_f32 v23, v26, v27
    buffer_store_dwordx4 v[20:23], v1, s[40:43], s72 offen offset:3072 sc1
    s_waitcnt vmcnt(8) lgkmcnt(0)
    v_cmp_gt_u32 vcc, 1, v3
    s_nop 1
    s_and_b64 vcc, vcc, exec
    s_cbranch_scc1 SPIN_ALL
BACK_ALL:
    s_barrier
    s_mov_b32 s79, 114688
    v_bfe_u32 v20, v1, 4, 4
    v_lshrrev_b32 v21, 8, v1
    s_lshl_b32 s98, s4, 4
    s_add_u32 s98, s98, 16
    v_add_u32 v22, s98, v20
    v_mul_u32_u24 v22, 144, v22
    v_add_u32 v22, s79, v22
    v_lshl_add_u32 v9, v21, 3, v22
    s_lshr_b32 s98, s73, 1
    v_add_u32 v8, s98, v9
    v_subrev_u32 v10, s98, v9
    s_and_b32 s99, s4, 1
    s_mul_i32 s99, s99, 20736
    s_add_u32 s99, s99, s79
    v_mul_u32_u24 v23, 144, v20
    v_lshl_add_u32 v23, v21, 3, v23
    v_add_u32 v13, s99, v23
    v_add_u32 v12, s98, v13
    v_accvgpr_read_b32 v32, a64
    v_accvgpr_read_b32 v33, a65
    v_accvgpr_read_b32 v34, a66
    v_accvgpr_read_b32 v35, a67
    v_cvt_pk_bf16_f32 v32, v32, v33
    v_cvt_pk_bf16_f32 v33, v34, v35
    ds_write_b64 v8, v[32:33] offset:0
    v_accvgpr_read_b32 v36, a68
    v_accvgpr_read_b32 v37, a69
    v_accvgpr_read_b32 v38, a70
    v_accvgpr_read_b32 v39, a71
    v_cvt_pk_bf16_f32 v36, v36, v37
    v_cvt_pk_bf16_f32 v37, v38, v39
    ds_write_b64 v8, v[36:37] offset:9216
    v_accvgpr_read_b32 v40, a72
    v_accvgpr_read_b32 v41, a73
    v_accvgpr_read_b32 v42, a74
    v_accvgpr_read_b32 v43, a75
    v_cvt_pk_bf16_f32 v40, v40, v41
    v_cvt_pk_bf16_f32 v41, v42, v43
    ds_write_b64 v8, v[40:41] offset:20736
    v_accvgpr_read_b32 v44, a76
    v_accvgpr_read_b32 v45, a77
    v_accvgpr_read_b32 v46, a78
    v_accvgpr_read_b32 v47, a79
    v_cvt_pk_bf16_f32 v44, v44, v45
    v_cvt_pk_bf16_f32 v45, v46, v47
    ds_write_b64 v8, v[44:45] offset:29952
    v_accvgpr_read_b32 v32, a80
    v_accvgpr_read_b32 v33, a81
    v_accvgpr_read_b32 v34, a82
    v_accvgpr_read_b32 v35, a83
    v_cvt_pk_bf16_f32 v32, v32, v33
    v_cvt_pk_bf16_f32 v33, v34, v35
    ds_write_b64 v9, v[32:33] offset:32
    v_accvgpr_read_b32 v36, a84
    v_accvgpr_read_b32 v37, a85
    v_accvgpr_read_b32 v38, a86
    v_accvgpr_read_b32 v39, a87
    v_cvt_pk_bf16_f32 v36, v36, v37
    v_cvt_pk_bf16_f32 v37, v38, v39
    ds_write_b64 v9, v[36:37] offset:9248
    v_accvgpr_read_b32 v40, a88
    v_accvgpr_read_b32 v41, a89
    v_accvgpr_read_b32 v42, a90
    v_accvgpr_read_b32 v43, a91
    v_cvt_pk_bf16_f32 v40, v40, v41
    v_cvt_pk_bf16_f32 v41, v42, v43
    ds_write_b64 v9, v[40:41] offset:20768
    v_accvgpr_read_b32 v44, a92
    v_accvgpr_read_b32 v45, a93
    v_accvgpr_read_b32 v46, a94
    v_accvgpr_read_b32 v47, a95
    v_cvt_pk_bf16_f32 v44, v44, v45
    v_cvt_pk_bf16_f32 v45, v46, v47
    ds_write_b64 v9, v[44:45] offset:29984
    v_accvgpr_read_b32 v32, a96
    v_accvgpr_read_b32 v33, a97
    v_accvgpr_read_b32 v34, a98
    v_accvgpr_read_b32 v35, a99
    v_cvt_pk_bf16_f32 v32, v32, v33
    v_cvt_pk_bf16_f32 v33, v34, v35
    ds_write_b64 v10, v[32:33] offset:64
    v_accvgpr_read_b32 v36, a100
    v_accvgpr_read_b32 v37, a101
    v_accvgpr_read_b32 v38, a102
    v_accvgpr_read_b32 v39, a103
    v_cvt_pk_bf16_f32 v36, v36, v37
    v_cvt_pk_bf16_f32 v37, v38, v39
    ds_write_b64 v10, v[36:37] offset:9280
    v_accvgpr_read_b32 v40, a104
    v_accvgpr_read_b32 v41, a105
    v_accvgpr_read_b32 v42, a106
    v_accvgpr_read_b32 v43, a107
    s_xor_b32 s21, s3, 0
    s_lshl2_add_u32 s21, s21, s4
    s_mul_i32 s21, s21, 36864
    s_add_u32 s64, s21, s17
    s_add_u32 m0, s78, 0
    s_nop 0
    buffer_load_dwordx4 v1, s[56:59], s64 offen sc1 lds
    v_cvt_pk_bf16_f32 v40, v40, v41
    v_cvt_pk_bf16_f32 v41, v42, v43
    ds_write_b64 v10, v[40:41] offset:20800
    v_accvgpr_read_b32 v44, a108
    v_accvgpr_read_b32 v45, a109
    v_accvgpr_read_b32 v46, a110
    v_accvgpr_read_b32 v47, a111
    v_cvt_pk_bf16_f32 v44, v44, v45
    v_cvt_pk_bf16_f32 v45, v46, v47
    ds_write_b64 v10, v[44:45] offset:30016
    v_accvgpr_read_b32 v32, a112
    v_accvgpr_read_b32 v33, a113
    v_accvgpr_read_b32 v34, a114
    buffer_load_dwordx4 v1, s[56:59], s64 offen offset:1024 sc1 lds
    v_accvgpr_read_b32 v35, a115
    v_cvt_pk_bf16_f32 v32, v32, v33
    v_cvt_pk_bf16_f32 v33, v34, v35
    ds_write_b64 v9, v[32:33] offset:96
    v_accvgpr_read_b32 v36, a116
    v_accvgpr_read_b32 v37, a117
    v_accvgpr_read_b32 v38, a118
    v_accvgpr_read_b32 v39, a119
    v_cvt_pk_bf16_f32 v36, v36, v37
    v_cvt_pk_bf16_f32 v37, v38, v39
    ds_write_b64 v9, v[36:37] offset:9312
    v_accvgpr_read_b32 v40, a120
    v_accvgpr_read_b32 v41, a121
    s_add_u32 s64, s21, s18
    s_add_u32 m0, s78, 2048
    s_nop 0
    buffer_load_dwordx4 v1, s[56:59], s64 offen sc1 lds
    v_accvgpr_read_b32 v42, a122
    v_accvgpr_read_b32 v43, a123
    v_cvt_pk_bf16_f32 v40, v40, v41
    v_cvt_pk_bf16_f32 v41, v42, v43
    ds_write_b64 v9, v[40:41] offset:20832
    v_accvgpr_read_b32 v44, a124
    v_accvgpr_read_b32 v45, a125
    v_accvgpr_read_b32 v46, a126
    v_accvgpr_read_b32 v47, a127
    v_cvt_pk_bf16_f32 v44, v44, v45
    v_cvt_pk_bf16_f32 v45, v46, v47
    s_waitcnt lgkmcnt(14)
    ds_write_b64 v9, v[44:45] offset:30048
    v_accvgpr_read_b32 v32, a128
    buffer_load_dwordx4 v1, s[56:59], s64 offen offset:1024 sc1 lds
    v_accvgpr_read_b32 v33, a129
    v_accvgpr_read_b32 v34, a130
    v_accvgpr_read_b32 v35, a131
    v_cvt_pk_bf16_f32 v32, v32, v33
    v_cvt_pk_bf16_f32 v33, v34, v35
    s_waitcnt lgkmcnt(14)
    ds_write_b64 v12, v[32:33] offset:0
    v_accvgpr_read_b32 v36, a132
    v_accvgpr_read_b32 v37, a133
    v_accvgpr_read_b32 v38, a134
    v_accvgpr_read_b32 v39, a135
    v_cvt_pk_bf16_f32 v36, v36, v37
    v_cvt_pk_bf16_f32 v37, v38, v39
    s_cmp_eq_u32 s73, 0
    s_cselect_b64 exec, -1, 0
    s_waitcnt lgkmcnt(14)
    ds_write_b64 v13, v[36:37] offset:32
    s_mov_b64 exec, -1
    s_add_u32 s64, s21, s19
    s_add_u32 m0, s78, 4096
    s_nop 0
    buffer_load_dwordx4 v1, s[56:59], s64 offen sc1 lds
    s_cmp_lg_u64 s[84:85], 0
    s_cselect_b32 s7, 1, 0
    v_mov_b32 v20, s7
    s_lshl2_add_u32 s98, s4, s79
    v_mov_b32 v21, s98
    s_waitcnt lgkmcnt(14)
    ds_write_b32 v21, v20 offset:41472
    v_mov_b32 v21, s79
    s_and_b32 s98, s4, 1
    s_lshl_b32 s98, s98, 6
    v_lshrrev_b32 v14, 4, v1
    v_add_u32 v14, s98, v14
    buffer_load_dwordx4 v1, s[56:59], s64 offen offset:1024 sc1 lds
    s_lshr_b32 s99, s4, 1
    s_mul_i32 s7, s99, 144
    s_add_u32 s7, s7, 2
    v_add_u32 v2, s7, v14
    v_mul_u32_u24 v2, 144, v2
    v_add_u32 v2, s79, v2
    s_sub_u32 s7, 15, s6
    s_cmp_eq_u32 s99, 0
    s_cselect_b32 s7, s6, s7
    s_lshl_b32 s7, s7, 7
    v_add_u32 v14, s7, v14
    v_lshrrev_b32 v15, 4, v14
    s_mov_b32 s98, 155648
    s_add_u32 s64, s21, s20
    s_add_u32 m0, s78, 6144
    s_nop 0
    buffer_load_dwordx4 v1, s[56:59], s64 offen sc1 lds
    v_mul_lo_u32 v15, v15, s98
    v_and_b32 v23, 0xf0, v1
    v_add_u32 v15, v15, v23
    s_lshl2_add_u32 s98, s62, s4
    s_mul_i32 s98, s98, 311296
    v_add_u32 v4, s98, v1
    v_add_u32 v5, 155648, v4
    v_bfe_u32 v19, v1, 4, 3
    v_lshlrev_b32 v19, 7, v19
    v_mov_b32 v11, v1
    v_add_u32 v12, 0x10000, v1
    v_add_u32 v13, 0x20000, v1
    s_mov_b32 s98, 0xbfb8aa3b
    s_mov_b32 s99, 0x3eae1a93
    s_waitcnt vmcnt(7) lgkmcnt(0)
    s_barrier
    ds_read_b128 v[24:27], v21 offset:41472
    ds_read_b128 v[32:35], v2 offset:2016
    ds_read_b128 v[36:39], v2 offset:2032
    ds_read_b128 v[40:43], v2 offset:2048
    ds_read_b128 v[44:47], v2 offset:1728
    ds_read_b128 v[48:51], v2 offset:1744
    ds_read_b128 v[52:55], v2 offset:1760
    s_waitcnt lgkmcnt(6)
    v_or3_b32 v24, v24, v25, v26
    v_or_b32 v24, v24, v27
    s_nop 0
    v_readfirstlane_b32 s7, v24
    s_nop 1
    s_andn2_b32 s7, s7, s83
    s_cbranch_scc1 K1_REDO
    v_mov_b32 v31, 2
    buffer_store_dword v31, v30, s[32:35], s101 offen sc1
    s_xor_b32 s21, s3, 1
    s_lshl2_add_u32 s21, s21, s4
    s_mul_i32 s21, s21, 36864
    s_add_u32 s64, s21, s17
    s_add_u32 m0, s78, 28672
    s_nop 0
    buffer_load_dwordx4 v1, s[56:59], s64 offen sc1 lds
    ds_read_b128 v[128:131], v2 offset:2096
    ds_read_b128 v[132:135], v2 offset:2112
    ds_read_b128 v[136:139], v2 offset:2128
    ds_read_b128 v[56:59], v2 offset:1440
    ds_read_b128 v[60:63], v2 offset:1456
    ds_read_b128 v[64:67], v2 offset:1472
    ds_read_b128 v[68:71], v2 offset:1152
    ds_read_b128 v[72:75], v2 offset:1168
    ds_read_b128 v[76:79], v2 offset:1184
    s_waitcnt lgkmcnt(8)
    v_dot2_f32_bf16 v140, v128, v32, 0
    buffer_load_dwordx4 v1, s[56:59], s64 offen offset:1024 sc1 lds
    v_dot2_f32_bf16 v141, v128, v44, 0
    ds_read_b128 v[80:83], v2 offset:864
    s_waitcnt lgkmcnt(6)
    v_dot2_f32_bf16 v142, v128, v56, 0
    s_waitcnt lgkmcnt(3)
    v_dot2_f32_bf16 v143, v128, v68, 0
    ds_read_b128 v[84:87], v2 offset:880
    v_dot2c_f32_bf16 v140, v129, v33
    v_dot2c_f32_bf16 v141, v129, v45
    ds_read_b128 v[88:91], v2 offset:896
    v_dot2c_f32_bf16 v142, v129, v57
    v_dot2c_f32_bf16 v143, v129, v69
    s_add_u32 s64, s21, s18
    s_add_u32 m0, s78, 30720
    s_nop 0
    buffer_load_dwordx4 v1, s[56:59], s64 offen sc1 lds
    ds_read_b128 v[92:95], v2 offset:576
    v_dot2c_f32_bf16 v140, v130, v34
    v_dot2c_f32_bf16 v141, v130, v46
    ds_read_b128 v[96:99], v2 offset:592
    v_dot2c_f32_bf16 v142, v130, v58
    v_dot2c_f32_bf16 v143, v130, v70
    ds_read_b128 v[100:103], v2 offset:608
    v_dot2c_f32_bf16 v140, v131, v35
    v_dot2c_f32_bf16 v141, v131, v47
    ds_read_b128 v[104:107], v2 offset:288
    buffer_load_dwordx4 v1, s[56:59], s64 offen offset:1024 sc1 lds
    v_dot2c_f32_bf16 v142, v131, v59
    v_dot2c_f32_bf16 v143, v131, v71
    ds_read_b128 v[108:111], v2 offset:304
    v_dot2c_f32_bf16 v140, v132, v36
    v_dot2c_f32_bf16 v141, v132, v48
    ds_read_b128 v[112:115], v2 offset:320
    v_dot2c_f32_bf16 v142, v132, v60
    s_waitcnt lgkmcnt(10)
    v_dot2c_f32_bf16 v143, v132, v72
    ds_read_b128 v[116:119], v2 offset:0
    v_dot2c_f32_bf16 v140, v133, v37
    s_add_u32 s64, s21, s19
    s_add_u32 m0, s78, 32768
    s_nop 0
    buffer_load_dwordx4 v1, s[56:59], s64 offen sc1 lds
    v_dot2c_f32_bf16 v141, v133, v49
    ds_read_b128 v[120:123], v2 offset:16
    v_dot2c_f32_bf16 v142, v133, v61
    v_dot2c_f32_bf16 v143, v133, v73
    ds_read_b128 v[124:127], v2 offset:32
    v_dot2c_f32_bf16 v140, v134, v38
    v_dot2c_f32_bf16 v141, v134, v50
    v_dot2c_f32_bf16 v142, v134, v62
    v_dot2c_f32_bf16 v143, v134, v74
    v_dot2c_f32_bf16 v140, v135, v39
    buffer_load_dwordx4 v1, s[56:59], s64 offen offset:1024 sc1 lds
    v_dot2c_f32_bf16 v141, v135, v51
    v_dot2c_f32_bf16 v142, v135, v63
    v_dot2c_f32_bf16 v143, v135, v75
    v_dot2c_f32_bf16 v140, v136, v40
    v_dot2c_f32_bf16 v141, v136, v52
    v_dot2c_f32_bf16 v142, v136, v64
    s_waitcnt lgkmcnt(12)
    v_dot2c_f32_bf16 v143, v136, v76
    s_waitcnt lgkmcnt(11)
    v_dot2_f32_bf16 v144, v128, v80, 0
    s_waitcnt lgkmcnt(8)
    v_dot2_f32_bf16 v145, v128, v92, 0
    ds_read_b128 v[32:35], v2 offset:2064
    s_add_u32 s64, s21, s20
    s_add_u32 m0, s78, 34816
    s_nop 0
    buffer_load_dwordx4 v1, s[56:59], s64 offen sc1 lds
    s_waitcnt lgkmcnt(6)
    v_dot2_f32_bf16 v146, v128, v104, 0
    s_waitcnt lgkmcnt(3)
    v_dot2_f32_bf16 v147, v128, v116, 0
    ds_read_b128 v[36:39], v2 offset:2080
    v_dot2c_f32_bf16 v144, v129, v81
    v_dot2c_f32_bf16 v145, v129, v93
    ds_read_b128 v[44:47], v2 offset:1776
    v_dot2c_f32_bf16 v146, v129, v105
    v_dot2c_f32_bf16 v147, v129, v117
    ds_read_b128 v[48:51], v2 offset:1792
    v_dot2c_f32_bf16 v144, v130, v82
    s_xor_b32 s21, s3, 2
    s_lshl2_add_u32 s21, s21, s4
    s_mul_i32 s21, s21, 36864
    s_add_u32 s64, s21, s17
    s_add_u32 m0, s78, 57344
    s_nop 0
    buffer_load_dwordx4 v1, s[56:59], s64 offen sc1 lds
    v_dot2c_f32_bf16 v145, v130, v94
    ds_read_b128 v[56:59], v2 offset:1488
    v_dot2c_f32_bf16 v146, v130, v106
    v_dot2c_f32_bf16 v147, v130, v118
    ds_read_b128 v[60:63], v2 offset:1504
    v_dot2c_f32_bf16 v144, v131, v83
    v_dot2c_f32_bf16 v145, v131, v95
    ds_read_b128 v[68:71], v2 offset:1200
    v_dot2c_f32_bf16 v146, v131, v107
    v_dot2c_f32_bf16 v147, v131, v119
    buffer_load_dwordx4 v1, s[56:59], s64 offen offset:1024 sc1 lds
    ds_read_b128 v[72:75], v2 offset:1216
    v_dot2c_f32_bf16 v144, v132, v84
    v_dot2c_f32_bf16 v145, v132, v96
    v_dot2c_f32_bf16 v146, v132, v108
    s_waitcnt lgkmcnt(9)
    v_dot2c_f32_bf16 v147, v132, v120
    v_dot2c_f32_bf16 v144, v133, v85
    v_dot2c_f32_bf16 v145, v133, v97
    v_dot2c_f32_bf16 v146, v133, v109
    v_dot2c_f32_bf16 v147, v133, v121
    v_dot2c_f32_bf16 v144, v134, v86
    s_add_u32 s64, s21, s18
    s_add_u32 m0, s78, 59392
    s_nop 0
    buffer_load_dwordx4 v1, s[56:59], s64 offen sc1 lds
    v_dot2c_f32_bf16 v145, v134, v98
    v_dot2c_f32_bf16 v146, v134, v110
    v_dot2c_f32_bf16 v147, v134, v122
    v_dot2c_f32_bf16 v144, v135, v87
    v_dot2c_f32_bf16 v145, v135, v99
    v_dot2c_f32_bf16 v146, v135, v111
    v_dot2c_f32_bf16 v147, v135, v123
    v_dot2c_f32_bf16 v144, v136, v88
    v_dot2c_f32_bf16 v145, v136, v100
    v_dot2c_f32_bf16 v146, v136, v112
    buffer_load_dwordx4 v1, s[56:59], s64 offen offset:1024 sc1 lds
    s_waitcnt lgkmcnt(8)
    v_dot2c_f32_bf16 v147, v136, v124
    v_lshlrev_b32 v8, 16, v138
    v_mul_f32 v8, s98, v8
    v_exp_f32 v8, v8
    v_mov_b32 v9, 0xf149f2ca
    ds_read_b128 v[80:83], v2 offset:912
    v_cmp_le_u32 vcc, 2, v14
    ds_read_b128 v[84:87], v2 offset:928
    s_nop 0
    v_cndmask_b32 v141, v9, v141, vcc
    v_cmp_le_u32 vcc, 4, v14
    s_add_u32 s64, s21, s19
    s_add_u32 m0, s78, 61440
    s_nop 0
    buffer_load_dwordx4 v1, s[56:59], s64 offen sc1 lds
    ds_read_b128 v[92:95], v2 offset:624
    v_cndmask_b32 v142, v9, v142, vcc
    v_cmp_le_u32 vcc, 6, v14
    ds_read_b128 v[96:99], v2 offset:640
    s_nop 0
    v_cndmask_b32 v143, v9, v143, vcc
    v_cmp_le_u32 vcc, 8, v14
    ds_read_b128 v[104:107], v2 offset:336
    s_nop 0
    v_cndmask_b32 v144, v9, v144, vcc
    v_cmp_le_u32 vcc, 10, v14
    ds_read_b128 v[108:111], v2 offset:352
    buffer_load_dwordx4 v1, s[56:59], s64 offen offset:1024 sc1 lds
    v_cndmask_b32 v145, v9, v145, vcc
    v_cmp_le_u32 vcc, 12, v14
    ds_read_b128 v[116:119], v2 offset:48
    s_nop 0
    v_cndmask_b32 v146, v9, v146, vcc
    v_cmp_le_u32 vcc, 14, v14
    s_waitcnt lgkmcnt(14)
    ds_read_b128 v[120:123], v2 offset:64
    s_nop 0
    v_cndmask_b32 v147, v9, v147, vcc
    v_max3_f32 v9, v140, v141, v142
    v_max3_f32 v10, v143, v144, v145
    v_max3_f32 v9, v9, v146, v147
    s_add_u32 s64, s21, s20
    s_add_u32 m0, s78, 63488
    s_nop 0
    buffer_load_dwordx4 v1, s[56:59], s64 offen sc1 lds
    v_max_f32 v9, v9, v10
    v_mul_f32 v9, s99, v9
    v_add_f32 v8, 1.0, v8
    v_fma_f32 v140, v140, s99, -v9
    v_fma_f32 v141, v141, s99, -v9
    v_fma_f32 v142, v142, s99, -v9
    v_fma_f32 v143, v143, s99, -v9
    v_fma_f32 v144, v144, s99, -v9
    v_fma_f32 v145, v145, s99, -v9
    v_fma_f32 v146, v146, s99, -v9
    v_fma_f32 v147, v147, s99, -v9
    buffer_load_dword v3, v19, s[32:35], s66 offen sc1
    s_xor_b32 s21, s3, 3
    s_lshl2_add_u32 s21, s21, s4
    s_mul_i32 s21, s21, 36864
    s_add_u32 s64, s21, s17
    s_add_u32 m0, s78, 86016
    s_nop 0
    buffer_load_dwordx4 v1, s[56:59], s64 offen sc1 lds
    v_exp_f32 v140, v140
    v_exp_f32 v141, v141
    v_exp_f32 v142, v142
    v_exp_f32 v143, v143
    v_exp_f32 v144, v144
    v_exp_f32 v145, v145
    v_exp_f32 v146, v146
    v_exp_f32 v147, v147
    buffer_load_dwordx4 v1, s[56:59], s64 offen offset:1024 sc1 lds
    v_add_f32 v10, v140, v141
    v_add_f32 v10, v10, v142
    v_add_f32 v10, v10, v143
    v_add_f32 v10, v10, v144
    v_add_f32 v10, v10, v145
    v_add_f32 v10, v10, v146
    v_add_f32 v10, v10, v147
    v_mul_f32 v10, v10, v8
    s_add_u32 s64, s21, s18
    s_add_u32 m0, s78, 88064
    s_nop 0
    buffer_load_dwordx4 v1, s[56:59], s64 offen sc1 lds
    v_rcp_f32 v10, v10
    s_nop 0
    v_mul_f32 v140, v140, v10
    v_mul_f32 v141, v141, v10
    v_mul_f32 v142, v142, v10
    v_mul_f32 v143, v143, v10
    v_mul_f32 v144, v144, v10
    v_mul_f32 v145, v145, v10
    v_mul_f32 v146, v146, v10
    v_mul_f32 v147, v147, v10
    buffer_load_dwordx4 v1, s[56:59], s64 offen offset:1024 sc1 lds
    v_cvt_pk_bf16_f32 v148, 0, v140
    v_cvt_pk_bf16_f32 v149, 0, v141
    v_cvt_pk_bf16_f32 v150, 0, v142
    v_cvt_pk_bf16_f32 v151, 0, v143
    v_cvt_pk_bf16_f32 v152, 0, v144
    v_cvt_pk_bf16_f32 v153, 0, v145
    v_cvt_pk_bf16_f32 v154, 0, v146
    v_cvt_pk_bf16_f32 v155, 0, v147
    s_add_u32 s64, s21, s19
    s_add_u32 m0, s78, 90112
    s_nop 0
    buffer_load_dwordx4 v1, s[56:59], s64 offen sc1 lds
    v_lshrrev_b32 v140, 16, v148
    v_lshrrev_b32 v141, 16, v149
    v_lshrrev_b32 v142, 16, v150
    v_lshrrev_b32 v143, 16, v151
    v_lshrrev_b32 v144, 16, v152
    v_lshrrev_b32 v145, 16, v153
    v_lshrrev_b32 v146, 16, v154
    v_lshrrev_b32 v147, 16, v155
    v_dot2_f32_bf16 v128, v42, v140, 0
    buffer_load_dwordx4 v1, s[56:59], s64 offen offset:1024 sc1 lds
    v_dot2_f32_bf16 v129, v42, v148, 0
    v_dot2_f32_bf16 v130, v43, v140, 0
    v_dot2_f32_bf16 v131, v43, v148, 0
    v_dot2_f32_bf16 v132, v32, v140, 0
    v_dot2_f32_bf16 v133, v32, v148, 0
    v_dot2_f32_bf16 v134, v33, v140, 0
    v_dot2_f32_bf16 v135, v33, v148, 0
    v_dot2_f32_bf16 v136, v34, v140, 0
    s_add_u32 s64, s21, s20
    s_add_u32 m0, s78, 92160
    s_nop 0
    buffer_load_dwordx4 v1, s[56:59], s64 offen sc1 lds
    v_dot2_f32_bf16 v137, v34, v148, 0
    v_dot2_f32_bf16 v138, v35, v140, 0
    v_dot2_f32_bf16 v139, v35, v148, 0
    s_waitcnt lgkmcnt(14)
    v_dot2_f32_bf16 v156, v36, v140, 0
    v_dot2_f32_bf16 v157, v36, v148, 0
    v_dot2_f32_bf16 v158, v37, v140, 0
    v_dot2_f32_bf16 v159, v37, v148, 0
    v_dot2_f32_bf16 v17, v38, v140, 0
    v_dot2_f32_bf16 v18, v38, v148, 0
    s_waitcnt vmcnt(7)
    v_cmp_gt_u32 vcc, 2, v3
    s_nop 1
    s_and_b64 vcc, vcc, exec
    s_cbranch_scc1 SPIN_CTX
BACK_CTX:
    buffer_load_dwordx4 a[0:3], v4, s[40:43], s63 offen offset:0 sc1
    v_dot2c_f32_bf16 v128, v54, v141
    v_dot2c_f32_bf16 v129, v54, v149
    v_dot2c_f32_bf16 v130, v55, v141
    v_dot2c_f32_bf16 v131, v55, v149
    s_waitcnt lgkmcnt(13)
    v_dot2c_f32_bf16 v132, v44, v141
    v_dot2c_f32_bf16 v133, v44, v149
    v_dot2c_f32_bf16 v134, v45, v141
    v_dot2c_f32_bf16 v135, v45, v149
    buffer_load_dwordx4 a[4:7], v5, s[40:43], s63 offen offset:0 sc1
    v_dot2c_f32_bf16 v136, v46, v141
    v_dot2c_f32_bf16 v137, v46, v149
    v_dot2c_f32_bf16 v138, v47, v141
    v_dot2c_f32_bf16 v139, v47, v149
    s_waitcnt lgkmcnt(12)
    v_dot2c_f32_bf16 v156, v48, v141
    v_dot2c_f32_bf16 v157, v48, v149
    v_dot2c_f32_bf16 v158, v49, v141
    v_dot2c_f32_bf16 v159, v49, v149
    v_dot2c_f32_bf16 v17, v50, v141
    buffer_load_dwordx4 a[8:11], v4, s[40:43], s63 offen offset:1024 sc1
    v_dot2c_f32_bf16 v18, v50, v149
    v_dot2c_f32_bf16 v128, v66, v142
    v_dot2c_f32_bf16 v129, v66, v150
    v_dot2c_f32_bf16 v130, v67, v142
    v_dot2c_f32_bf16 v131, v67, v150
    s_waitcnt lgkmcnt(11)
    v_dot2c_f32_bf16 v132, v56, v142
    v_dot2c_f32_bf16 v133, v56, v150
    v_dot2c_f32_bf16 v134, v57, v142
    buffer_load_dwordx4 a[12:15], v5, s[40:43], s63 offen offset:1024 sc1
    v_dot2c_f32_bf16 v135, v57, v150
    v_dot2c_f32_bf16 v136, v58, v142
    v_dot2c_f32_bf16 v137, v58, v150
    v_dot2c_f32_bf16 v138, v59, v142
    v_dot2c_f32_bf16 v139, v59, v150
    s_waitcnt lgkmcnt(10)
    v_dot2c_f32_bf16 v156, v60, v142
    v_dot2c_f32_bf16 v157, v60, v150
    v_dot2c_f32_bf16 v158, v61, v142
    v_dot2c_f32_bf16 v159, v61, v150
    buffer_load_dwordx4 a[16:19], v4, s[40:43], s63 offen offset:2048 sc1
    v_dot2c_f32_bf16 v17, v62, v142
    v_dot2c_f32_bf16 v18, v62, v150
    v_dot2c_f32_bf16 v128, v78, v143
    v_dot2c_f32_bf16 v129, v78, v151
    v_dot2c_f32_bf16 v130, v79, v143
    v_dot2c_f32_bf16 v131, v79, v151
    s_waitcnt lgkmcnt(9)
    v_dot2c_f32_bf16 v132, v68, v143
    v_dot2c_f32_bf16 v133, v68, v151
    v_dot2c_f32_bf16 v134, v69, v143
    buffer_load_dwordx4 a[20:23], v5, s[40:43], s63 offen offset:2048 sc1
    v_dot2c_f32_bf16 v135, v69, v151
    v_dot2c_f32_bf16 v136, v70, v143
    v_dot2c_f32_bf16 v137, v70, v151
    v_dot2c_f32_bf16 v138, v71, v143
    v_dot2c_f32_bf16 v139, v71, v151
    s_waitcnt lgkmcnt(8)
    v_dot2c_f32_bf16 v156, v72, v143
    v_dot2c_f32_bf16 v157, v72, v151
    v_dot2c_f32_bf16 v158, v73, v143
    buffer_load_dwordx4 a[24:27], v4, s[40:43], s63 offen offset:3072 sc1
    v_dot2c_f32_bf16 v159, v73, v151
    v_dot2c_f32_bf16 v17, v74, v143
    v_dot2c_f32_bf16 v18, v74, v151
    v_dot2c_f32_bf16 v128, v90, v144
    v_dot2c_f32_bf16 v129, v90, v152
    v_dot2c_f32_bf16 v130, v91, v144
    v_dot2c_f32_bf16 v131, v91, v152
    s_waitcnt lgkmcnt(7)
    v_dot2c_f32_bf16 v132, v80, v144
    v_dot2c_f32_bf16 v133, v80, v152
    buffer_load_dwordx4 a[28:31], v5, s[40:43], s63 offen offset:3072 sc1
    v_dot2c_f32_bf16 v134, v81, v144
    v_dot2c_f32_bf16 v135, v81, v152
    v_dot2c_f32_bf16 v136, v82, v144
    v_dot2c_f32_bf16 v137, v82, v152
    v_dot2c_f32_bf16 v138, v83, v144
    v_dot2c_f32_bf16 v139, v83, v152
    s_waitcnt lgkmcnt(6)
    v_dot2c_f32_bf16 v156, v84, v144
    v_dot2c_f32_bf16 v157, v84, v152
    v_dot2c_f32_bf16 v158, v85, v144
    s_xor_b32 s63, s63, 4096
    buffer_load_dwordx4 a[32:35], v4, s[40:43], s63 offen offset:0 sc1
    v_dot2c_f32_bf16 v159, v85, v152
    v_dot2c_f32_bf16 v17, v86, v144
    v_dot2c_f32_bf16 v18, v86, v152
    v_dot2c_f32_bf16 v128, v102, v145
    v_dot2c_f32_bf16 v129, v102, v153
    v_dot2c_f32_bf16 v130, v103, v145
    v_dot2c_f32_bf16 v131, v103, v153
    s_waitcnt lgkmcnt(5)
    v_dot2c_f32_bf16 v132, v92, v145
    buffer_load_dwordx4 a[36:39], v5, s[40:43], s63 offen offset:0 sc1
    v_dot2c_f32_bf16 v133, v92, v153
    v_dot2c_f32_bf16 v134, v93, v145
    v_dot2c_f32_bf16 v135, v93, v153
    v_dot2c_f32_bf16 v136, v94, v145
    v_dot2c_f32_bf16 v137, v94, v153
    v_dot2c_f32_bf16 v138, v95, v145
    v_dot2c_f32_bf16 v139, v95, v153
    s_waitcnt lgkmcnt(4)
    v_dot2c_f32_bf16 v156, v96, v145
    v_dot2c_f32_bf16 v157, v96, v153
    buffer_load_dwordx4 a[40:43], v4, s[40:43], s63 offen offset:1024 sc1
    v_dot2c_f32_bf16 v158, v97, v145
    v_dot2c_f32_bf16 v159, v97, v153
    v_dot2c_f32_bf16 v17, v98, v145
    v_dot2c_f32_bf16 v18, v98, v153
    v_dot2c_f32_bf16 v128, v114, v146
    v_dot2c_f32_bf16 v129, v114, v154
    v_dot2c_f32_bf16 v130, v115, v146
    v_dot2c_f32_bf16 v131, v115, v154
    buffer_load_dwordx4 a[44:47], v5, s[40:43], s63 offen offset:1024 sc1
    s_waitcnt lgkmcnt(3)
    v_dot2c_f32_bf16 v132, v104, v146
    v_dot2c_f32_bf16 v133, v104, v154
    v_dot2c_f32_bf16 v134, v105, v146
    v_dot2c_f32_bf16 v135, v105, v154
    v_dot2c_f32_bf16 v136, v106, v146
    v_dot2c_f32_bf16 v137, v106, v154
    v_dot2c_f32_bf16 v138, v107, v146
    v_dot2c_f32_bf16 v139, v107, v154
    s_waitcnt lgkmcnt(2)
    v_dot2c_f32_bf16 v156, v108, v146
    buffer_load_dwordx4 a[48:51], v4, s[40:43], s63 offen offset:2048 sc1
    v_dot2c_f32_bf16 v157, v108, v154
    v_dot2c_f32_bf16 v158, v109, v146
    v_dot2c_f32_bf16 v159, v109, v154
    v_dot2c_f32_bf16 v17, v110, v146
    v_dot2c_f32_bf16 v18, v110, v154
    v_dot2c_f32_bf16 v128, v126, v147
    v_dot2c_f32_bf16 v129, v126, v155
    v_dot2c_f32_bf16 v130, v127, v147
    v_dot2c_f32_bf16 v131, v127, v155
    buffer_load_dwordx4 a[52:55], v5, s[40:43], s63 offen offset:2048 sc1
    s_waitcnt lgkmcnt(1)
    v_dot2c_f32_bf16 v132, v116, v147
    v_dot2c_f32_bf16 v133, v116, v155
    v_dot2c_f32_bf16 v134, v117, v147
    v_dot2c_f32_bf16 v135, v117, v155
    v_dot2c_f32_bf16 v136, v118, v147
    v_dot2c_f32_bf16 v137, v118, v155
    v_dot2c_f32_bf16 v138, v119, v147
    v_dot2c_f32_bf16 v139, v119, v155
    buffer_load_dwordx4 a[56:59], v4, s[40:43], s63 offen offset:3072 sc1
    s_waitcnt lgkmcnt(0)
    v_dot2c_f32_bf16 v156, v120, v147
    v_dot2c_f32_bf16 v157, v120, v155
    v_dot2c_f32_bf16 v158, v121, v147
    v_dot2c_f32_bf16 v159, v121, v155
    v_dot2c_f32_bf16 v17, v122, v147
    v_dot2c_f32_bf16 v18, v122, v155
    v_mov_b32 v89, 0
    v_mov_b32 v90, 0
    v_mov_b32 v91, 0
    buffer_load_dwordx4 a[60:63], v5, s[40:43], s63 offen offset:3072 sc1
    s_xor_b32 s63, s63, 12288
    v_cvt_pk_bf16_f32 v80, v128, v129
    v_cvt_pk_bf16_f32 v81, v130, v131
    v_cvt_pk_bf16_f32 v82, v132, v133
    v_cvt_pk_bf16_f32 v83, v134, v135
    v_cvt_pk_bf16_f32 v84, v136, v137
    v_cvt_pk_bf16_f32 v85, v138, v139
    v_cvt_pk_bf16_f32 v86, v156, v157
    v_cvt_pk_bf16_f32 v87, v158, v159
    v_cvt_pk_bf16_f32 v88, v17, v18
    s_waitcnt vmcnt(8)
    s_barrier
    ds_read_b128 v[104:107], v11 offset:0
    ds_read_b128 v[108:111], v11 offset:7168
    ds_read_b128 v[112:115], v11 offset:1024
    ds_read_b128 v[116:119], v11 offset:8192
    s_waitcnt lgkmcnt(3)
    v_mfma_f32_16x16x32_bf16 v[176:179], v[104:107], a[0:3], 0
    s_lshl3_add_u32 s98, 1, s5
    ds_read_b128 v[120:123], v11 offset:2048
    ds_read_b128 v[124:127], v11 offset:9216
    s_waitcnt lgkmcnt(4)
    v_mfma_f32_16x16x32_bf16 v[176:179], v[108:111], a[8:11], v[176:179]
    s_and_b32 s98, s98, 31
    buffer_load_dwordx4 a[64:67], v4, s[40:43], s63 offen offset:0 sc1
    v_mfma_f32_16x16x32_bf16 v[180:183], v[104:107], a[4:7], 0
    s_lshl_b32 s8, s6, 5
    ds_read_b128 v[128:131], v11 offset:3072
    ds_read_b128 v[132:135], v11 offset:10240
    v_mfma_f32_16x16x32_bf16 v[180:183], v[108:111], a[12:15], v[180:183]
    s_add_u32 s98, s98, s8
    ds_read_b128 v[136:139], v11 offset:4096
    s_waitcnt lgkmcnt(6)
    v_mfma_f32_16x16x32_bf16 v[184:187], v[112:115], a[0:3], 0
    s_mul_i32 s98, s98, 3
    buffer_load_dwordx4 a[68:71], v5, s[40:43], s63 offen offset:0 sc1
    s_waitcnt lgkmcnt(5)
    v_mfma_f32_16x16x32_bf16 v[184:187], v[116:119], a[8:11], v[184:187]
    s_sub_u32 s98, s98, 1
    ds_read_b128 v[140:143], v11 offset:11264
    ds_read_b128 v[144:147], v11 offset:5120
    v_mfma_f32_16x16x32_bf16 v[188:191], v[112:115], a[4:7], 0
    s_add_u32 s98, s98, 3
    ds_read_b128 v[148:151], v11 offset:12288
    v_mfma_f32_16x16x32_bf16 v[188:191], v[116:119], a[12:15], v[188:191]
    s_lshl2_add_u32 s98, s98, s4
    ds_read_b128 v[104:107], v11 offset:6144
    s_waitcnt lgkmcnt(5)
    v_mfma_f32_16x16x32_bf16 v[192:195], v[120:123], a[0:3], 0
    s_mul_i32 s8, s98, 3072
    buffer_load_dwordx4 a[72:75], v4, s[40:43], s63 offen offset:1024 sc1
    v_mfma_f32_16x16x32_bf16 v[192:195], v[124:127], a[8:11], v[192:195]
    s_lshl3_add_u32 s98, 2, s5
    ds_read_b128 v[108:111], v11 offset:13312
    ds_read_b128 v[112:115], v11 offset:14336
    v_mfma_f32_16x16x32_bf16 v[196:199], v[120:123], a[4:7], 0
    s_and_b32 s98, s98, 31
    ds_read_b128 v[116:119], v11 offset:21504
    v_mfma_f32_16x16x32_bf16 v[196:199], v[124:127], a[12:15], v[196:199]
    s_lshl_b32 s9, s6, 5
    ds_read_b128 v[120:123], v11 offset:15360
    v_mfma_f32_16x16x32_bf16 v[200:203], v[128:131], a[0:3], 0
    s_add_u32 s98, s98, s9
    buffer_load_dwordx4 a[76:79], v5, s[40:43], s63 offen offset:1024 sc1
    v_mfma_f32_16x16x32_bf16 v[200:203], v[132:135], a[8:11], v[200:203]
    s_mul_i32 s98, s98, 3
    ds_read_b128 v[124:127], v11 offset:22528
    v_mfma_f32_16x16x32_bf16 v[204:207], v[128:131], a[4:7], 0
    s_sub_u32 s98, s98, 2
    ds_read_b128 v[128:131], v11 offset:16384
    v_mfma_f32_16x16x32_bf16 v[204:207], v[132:135], a[12:15], v[204:207]
    s_add_u32 s98, s98, 3
    ds_read_b128 v[132:135], v11 offset:23552
    s_waitcnt lgkmcnt(4)
    v_mfma_f32_16x16x32_bf16 v[208:211], v[136:139], a[0:3], 0
    s_lshl2_add_u32 s98, s98, s4
    buffer_load_dwordx4 a[80:83], v4, s[40:43], s63 offen offset:2048 sc1
    v_mfma_f32_16x16x32_bf16 v[208:211], v[140:143], a[8:11], v[208:211]
    s_mul_i32 s9, s98, 3072
    v_mfma_f32_16x16x32_bf16 v[212:215], v[136:139], a[4:7], 0
    s_lshl3_add_u32 s98, 3, s5
    ds_read_b128 v[136:139], v11 offset:17408
    v_mfma_f32_16x16x32_bf16 v[212:215], v[140:143], a[12:15], v[212:215]
    s_and_b32 s98, s98, 31
    ds_read_b128 v[140:143], v11 offset:24576
    v_mfma_f32_16x16x32_bf16 v[216:219], v[144:147], a[0:3], 0
    s_lshl_b32 s10, s6, 5
    buffer_load_dwordx4 a[84:87], v5, s[40:43], s63 offen offset:2048 sc1
    v_mfma_f32_16x16x32_bf16 v[216:219], v[148:151], a[8:11], v[216:219]
    s_add_u32 s98, s98, s10
    v_mfma_f32_16x16x32_bf16 v[220:223], v[144:147], a[4:7], 0
    s_mul_i32 s98, s98, 3
    ds_read_b128 v[144:147], v11 offset:18432
    v_mfma_f32_16x16x32_bf16 v[220:223], v[148:151], a[12:15], v[220:223]
    s_sub_u32 s98, s98, 3
    ds_read_b128 v[148:151], v11 offset:25600
    v_mfma_f32_16x16x32_bf16 v[224:227], v[104:107], a[0:3], 0
    s_add_u32 s98, s98, 3
    buffer_load_dwordx4 a[88:91], v4, s[40:43], s63 offen offset:3072 sc1
    v_mfma_f32_16x16x32_bf16 v[224:227], v[108:111], a[8:11], v[224:227]
    s_lshl2_add_u32 s98, s98, s4
    v_mfma_f32_16x16x32_bf16 v[228:231], v[104:107], a[4:7], 0
    s_mul_i32 s10, s98, 3072
    ds_read_b128 v[104:107], v11 offset:19456
    v_mfma_f32_16x16x32_bf16 v[228:231], v[108:111], a[12:15], v[228:231]
    s_sub_u32 s99, s4, s61
    ds_read_b128 v[108:111], v11 offset:26624
    v_mfma_f32_16x16x32_bf16 v[176:179], v[112:115], a[16:19], v[176:179]
    s_and_b32 s99, s99, 3
    buffer_load_dwordx4 a[92:95], v5, s[40:43], s63 offen offset:3072 sc1
    v_mfma_f32_16x16x32_bf16 v[176:179], v[116:119], a[24:27], v[176:179]
    s_lshl3_add_u32 s98, s99, s5
    v_mfma_f32_16x16x32_bf16 v[180:183], v[112:115], a[20:23], v[180:183]
    s_xor_b32 s63, s63, 4096
    ds_read_b128 v[112:115], v11 offset:20480
    v_mfma_f32_16x16x32_bf16 v[180:183], v[116:119], a[28:31], v[180:183]
    s_and_b32 s98, s98, 31
    ds_read_b128 v[116:119], v11 offset:27648
    s_waitcnt lgkmcnt(3)
    v_mfma_f32_16x16x32_bf16 v[184:187], v[120:123], a[16:19], v[184:187]
    s_lshl_b32 s11, s6, 5
    v_mfma_f32_16x16x32_bf16 v[184:187], v[124:127], a[24:27], v[184:187]
    s_add_u32 s98, s98, s11
    buffer_store_dwordx4 v[80:83], v15, s[40:43], s71 offen offset:0 sc1
    v_mfma_f32_16x16x32_bf16 v[188:191], v[120:123], a[20:23], v[188:191]
    s_mul_i32 s98, s98, 3
    ds_read_b128 v[120:123], v11 offset:28672
    v_mfma_f32_16x16x32_bf16 v[188:191], v[124:127], a[28:31], v[188:191]
    s_sub_u32 s98, s98, s99
    ds_read_b128 v[124:127], v11 offset:35840
    v_mfma_f32_16x16x32_bf16 v[192:195], v[128:131], a[16:19], v[192:195]
    s_add_u32 s98, s98, 3
    v_mfma_f32_16x16x32_bf16 v[192:195], v[132:135], a[24:27], v[192:195]
    s_lshl2_add_u32 s98, s98, s4
    buffer_store_dwordx4 v[84:87], v15, s[40:43], s71 offen offset:256 sc1
    v_mfma_f32_16x16x32_bf16 v[196:199], v[128:131], a[20:23], v[196:199]
    s_mul_i32 s11, s98, 3072
    ds_read_b128 v[128:131], v11 offset:29696
    v_mfma_f32_16x16x32_bf16 v[196:199], v[132:135], a[28:31], v[196:199]
    ds_read_b128 v[132:135], v11 offset:36864
    v_mfma_f32_16x16x32_bf16 v[200:203], v[136:139], a[16:19], v[200:203]
    s_cmp_eq_u32 s99, 0
    s_cselect_b32 s11, 1073741824, s11
    v_mfma_f32_16x16x32_bf16 v[200:203], v[140:143], a[24:27], v[200:203]
    buffer_store_dwordx4 v[88:91], v15, s[40:43], s71 offen offset:512 sc1
    v_mfma_f32_16x16x32_bf16 v[204:207], v[136:139], a[20:23], v[204:207]
    ds_read_b128 v[136:139], v11 offset:30720
    v_mfma_f32_16x16x32_bf16 v[204:207], v[140:143], a[28:31], v[204:207]
    s_waitcnt vmcnt(11)
    ds_read_b128 v[140:143], v11 offset:37888
    v_mfma_f32_16x16x32_bf16 v[208:211], v[144:147], a[16:19], v[208:211]
    v_mfma_f32_16x16x32_bf16 v[208:211], v[148:151], a[24:27], v[208:211]
    buffer_load_dwordx4 a[96:99], v4, s[40:43], s63 offen offset:0 sc1
    v_mfma_f32_16x16x32_bf16 v[212:215], v[144:147], a[20:23], v[212:215]
    ds_read_b128 v[144:147], v11 offset:31744
    v_mfma_f32_16x16x32_bf16 v[212:215], v[148:151], a[28:31], v[212:215]
    ds_read_b128 v[148:151], v11 offset:38912
    v_mfma_f32_16x16x32_bf16 v[216:219], v[104:107], a[16:19], v[216:219]
    s_waitcnt lgkmcnt(2)
    v_mfma_f32_16x16x32_bf16 v[216:219], v[108:111], a[24:27], v[216:219]
    buffer_load_dwordx4 a[100:103], v5, s[40:43], s63 offen offset:0 sc1
    v_mfma_f32_16x16x32_bf16 v[220:223], v[104:107], a[20:23], v[220:223]
    ds_read_b128 v[104:107], v11 offset:32768
    v_mfma_f32_16x16x32_bf16 v[220:223], v[108:111], a[28:31], v[220:223]
    ds_read_b128 v[108:111], v11 offset:39936
    v_mfma_f32_16x16x32_bf16 v[224:227], v[112:115], a[16:19], v[224:227]
    v_mfma_f32_16x16x32_bf16 v[224:227], v[116:119], a[24:27], v[224:227]
    buffer_load_dwordx4 a[104:107], v4, s[40:43], s63 offen offset:1024 sc1
    v_mfma_f32_16x16x32_bf16 v[228:231], v[112:115], a[20:23], v[228:231]
    ds_read_b128 v[112:115], v11 offset:33792
    v_mfma_f32_16x16x32_bf16 v[228:231], v[116:119], a[28:31], v[228:231]
    ds_read_b128 v[116:119], v11 offset:40960
    v_mfma_f32_16x16x32_bf16 v[176:179], v[120:123], a[32:35], v[176:179]
    v_mfma_f32_16x16x32_bf16 v[176:179], v[124:127], a[40:43], v[176:179]
    buffer_load_dwordx4 a[108:111], v5, s[40:43], s63 offen offset:1024 sc1
    v_mfma_f32_16x16x32_bf16 v[180:183], v[120:123], a[36:39], v[180:183]
    ds_read_b128 v[120:123], v11 offset:34816
    v_mfma_f32_16x16x32_bf16 v[180:183], v[124:127], a[44:47], v[180:183]
    ds_read_b128 v[124:127], v11 offset:41984
    v_mfma_f32_16x16x32_bf16 v[184:187], v[128:131], a[32:35], v[184:187]
    v_mfma_f32_16x16x32_bf16 v[184:187], v[132:135], a[40:43], v[184:187]
    buffer_load_dwordx4 a[112:115], v4, s[40:43], s63 offen offset:2048 sc1
    v_mfma_f32_16x16x32_bf16 v[188:191], v[128:131], a[36:39], v[188:191]
    ds_read_b128 v[128:131], v11 offset:43008
    v_mfma_f32_16x16x32_bf16 v[188:191], v[132:135], a[44:47], v[188:191]
    ds_read_b128 v[132:135], v11 offset:50176
    v_mfma_f32_16x16x32_bf16 v[192:195], v[136:139], a[32:35], v[192:195]
    v_mfma_f32_16x16x32_bf16 v[192:195], v[140:143], a[40:43], v[192:195]
    v_mfma_f32_16x16x32_bf16 v[196:199], v[136:139], a[36:39], v[196:199]
    buffer_load_dwordx4 a[116:119], v5, s[40:43], s63 offen offset:2048 sc1
    v_mfma_f32_16x16x32_bf16 v[196:199], v[140:143], a[44:47], v[196:199]
    s_waitcnt lgkmcnt(1)
    ds_read_b128 v[136:139], v11 offset:44032
    ds_read_b128 v[140:143], v11 offset:51200
    v_mfma_f32_16x16x32_bf16 v[200:203], v[144:147], a[32:35], v[200:203]
    v_mfma_f32_16x16x32_bf16 v[200:203], v[148:151], a[40:43], v[200:203]
    v_mfma_f32_16x16x32_bf16 v[204:207], v[144:147], a[36:39], v[204:207]
    buffer_load_dwordx4 a[120:123], v4, s[40:43], s63 offen offset:3072 sc1
    v_mfma_f32_16x16x32_bf16 v[204:207], v[148:151], a[44:47], v[204:207]
    ds_read_b128 v[144:147], v11 offset:45056
    ds_read_b128 v[148:151], v11 offset:52224
    v_mfma_f32_16x16x32_bf16 v[208:211], v[104:107], a[32:35], v[208:211]
    v_mfma_f32_16x16x32_bf16 v[208:211], v[108:111], a[40:43], v[208:211]
    v_mfma_f32_16x16x32_bf16 v[212:215], v[104:107], a[36:39], v[212:215]
    buffer_load_dwordx4 a[124:127], v5, s[40:43], s63 offen offset:3072 sc1
    v_mfma_f32_16x16x32_bf16 v[212:215], v[108:111], a[44:47], v[212:215]
    s_xor_b32 s21, s3, 4
    ds_read_b128 v[104:107], v11 offset:46080
    ds_read_b128 v[108:111], v11 offset:53248
    v_mfma_f32_16x16x32_bf16 v[216:219], v[112:115], a[32:35], v[216:219]
    s_lshl2_add_u32 s21, s21, s4
    v_mfma_f32_16x16x32_bf16 v[216:219], v[116:119], a[40:43], v[216:219]
    s_mul_i32 s21, s21, 36864
    v_mfma_f32_16x16x32_bf16 v[220:223], v[112:115], a[36:39], v[220:223]
    s_add_u32 s64, s21, s17
    s_add_u32 m0, s78, 114688
    ds_read_b128 v[112:115], v11 offset:47104
    v_mfma_f32_16x16x32_bf16 v[220:223], v[116:119], a[44:47], v[220:223]
    s_xor_b32 s63, s63, 28672
    buffer_load_dwordx4 v1, s[56:59], s64 offen sc1 lds
    v_mfma_f32_16x16x32_bf16 v[224:227], v[120:123], a[32:35], v[224:227]
    ds_read_b128 v[116:119], v11 offset:54272
    v_mfma_f32_16x16x32_bf16 v[224:227], v[124:127], a[40:43], v[224:227]
    v_mfma_f32_16x16x32_bf16 v[228:231], v[120:123], a[36:39], v[228:231]
    buffer_load_dwordx4 v1, s[56:59], s64 offen offset:1024 sc1 lds
    v_mfma_f32_16x16x32_bf16 v[228:231], v[124:127], a[44:47], v[228:231]
    s_add_u32 s64, s21, s18
    ds_read_b128 v[120:123], v11 offset:48128
    ds_read_b128 v[124:127], v11 offset:55296
    v_mfma_f32_16x16x32_bf16 v[176:179], v[128:131], a[48:51], v[176:179]
    s_add_u32 m0, s78, 116736
    s_waitcnt lgkmcnt(3)
    v_mfma_f32_16x16x32_bf16 v[176:179], v[132:135], a[56:59], v[176:179]
    v_mfma_f32_16x16x32_bf16 v[180:183], v[128:131], a[52:55], v[180:183]
    buffer_load_dwordx4 v1, s[56:59], s64 offen sc1 lds
    v_mfma_f32_16x16x32_bf16 v[180:183], v[132:135], a[60:63], v[180:183]
    ds_read_b128 v[128:131], v11 offset:49152
    ds_read_b128 v[132:135], v11 offset:56320
    v_mfma_f32_16x16x32_bf16 v[184:187], v[136:139], a[48:51], v[184:187]
    v_mfma_f32_16x16x32_bf16 v[184:187], v[140:143], a[56:59], v[184:187]
    v_mfma_f32_16x16x32_bf16 v[188:191], v[136:139], a[52:55], v[188:191]
    buffer_load_dwordx4 v1, s[56:59], s64 offen offset:1024 sc1 lds
    v_mfma_f32_16x16x32_bf16 v[188:191], v[140:143], a[60:63], v[188:191]
    s_add_u32 s64, s21, s19
    ds_read_b128 v[136:139], v11 offset:57344
    ds_read_b128 v[140:143], v11 offset:64512
    v_mfma_f32_16x16x32_bf16 v[192:195], v[144:147], a[48:51], v[192:195]
    s_add_u32 m0, s78, 118784
    v_mfma_f32_16x16x32_bf16 v[192:195], v[148:151], a[56:59], v[192:195]
    v_mfma_f32_16x16x32_bf16 v[196:199], v[144:147], a[52:55], v[196:199]
    buffer_load_dwordx4 v1, s[56:59], s64 offen sc1 lds
    v_mfma_f32_16x16x32_bf16 v[196:199], v[148:151], a[60:63], v[196:199]
    ds_read_b128 v[144:147], v11 offset:58368
    ds_read_b128 v[148:151], v12 offset:0
    v_mfma_f32_16x16x32_bf16 v[200:203], v[104:107], a[48:51], v[200:203]
    v_mfma_f32_16x16x32_bf16 v[200:203], v[108:111], a[56:59], v[200:203]
    v_mfma_f32_16x16x32_bf16 v[204:207], v[104:107], a[52:55], v[204:207]
    ds_read_b128 v[104:107], v11 offset:59392
    v_mfma_f32_16x16x32_bf16 v[204:207], v[108:111], a[60:63], v[204:207]
    s_waitcnt vmcnt(16)
    s_barrier
    ds_read_b128 v[108:111], v12 offset:1024
    v_mfma_f32_16x16x32_bf16 v[208:211], v[112:115], a[48:51], v[208:211]
    s_waitcnt lgkmcnt(2)
    buffer_load_dwordx4 v1, s[56:59], s64 offen offset:1024 sc1 lds
    v_mfma_f32_16x16x32_bf16 v[208:211], v[116:119], a[56:59], v[208:211]
    s_add_u32 s64, s21, s20
    v_mfma_f32_16x16x32_bf16 v[212:215], v[112:115], a[52:55], v[212:215]
    s_add_u32 m0, s78, 120832
    ds_read_b128 v[112:115], v11 offset:60416
    v_mfma_f32_16x16x32_bf16 v[212:215], v[116:119], a[60:63], v[212:215]
    buffer_load_dwordx4 v1, s[56:59], s64 offen sc1 lds
    v_mfma_f32_16x16x32_bf16 v[216:219], v[120:123], a[48:51], v[216:219]
    ds_read_b128 v[116:119], v12 offset:2048
    v_mfma_f32_16x16x32_bf16 v[216:219], v[124:127], a[56:59], v[216:219]
    v_mfma_f32_16x16x32_bf16 v[220:223], v[120:123], a[52:55], v[220:223]
    ds_read_b128 v[120:123], v11 offset:61440
    v_mfma_f32_16x16x32_bf16 v[220:223], v[124:127], a[60:63], v[220:223]
    buffer_load_dwordx4 a[128:131], v4, s[40:43], s63 offen offset:0 sc1
    v_mfma_f32_16x16x32_bf16 v[224:227], v[128:131], a[48:51], v[224:227]
    ds_read_b128 v[124:127], v12 offset:3072
    v_mfma_f32_16x16x32_bf16 v[224:227], v[132:135], a[56:59], v[224:227]
    v_mfma_f32_16x16x32_bf16 v[228:231], v[128:131], a[52:55], v[228:231]
    ds_read_b128 v[128:131], v11 offset:62464
    v_mfma_f32_16x16x32_bf16 v[228:231], v[132:135], a[60:63], v[228:231]
    buffer_load_dwordx4 a[132:135], v5, s[40:43], s63 offen offset:0 sc1
    v_mfma_f32_16x16x32_bf16 v[176:179], v[136:139], a[64:67], v[176:179]
    ds_read_b128 v[132:135], v12 offset:4096
    v_mfma_f32_16x16x32_bf16 v[176:179], v[140:143], a[72:75], v[176:179]
    v_mfma_f32_16x16x32_bf16 v[180:183], v[136:139], a[68:71], v[180:183]
    ds_read_b128 v[136:139], v11 offset:63488
    v_mfma_f32_16x16x32_bf16 v[180:183], v[140:143], a[76:79], v[180:183]
    buffer_load_dwordx4 a[136:139], v4, s[40:43], s63 offen offset:1024 sc1
    v_mfma_f32_16x16x32_bf16 v[184:187], v[144:147], a[64:67], v[184:187]
    ds_read_b128 v[140:143], v12 offset:5120
    v_mfma_f32_16x16x32_bf16 v[184:187], v[148:151], a[72:75], v[184:187]
    v_mfma_f32_16x16x32_bf16 v[188:191], v[144:147], a[68:71], v[188:191]
    ds_read_b128 v[144:147], v12 offset:6144
    v_mfma_f32_16x16x32_bf16 v[188:191], v[148:151], a[76:79], v[188:191]
    s_waitcnt lgkmcnt(2)
    buffer_load_dwordx4 a[140:143], v5, s[40:43], s63 offen offset:1024 sc1
    v_mfma_f32_16x16x32_bf16 v[192:195], v[104:107], a[64:67], v[192:195]
    ds_read_b128 v[148:151], v12 offset:13312
    v_mfma_f32_16x16x32_bf16 v[192:195], v[108:111], a[72:75], v[192:195]
    v_mfma_f32_16x16x32_bf16 v[196:199], v[104:107], a[68:71], v[196:199]
    ds_read_b128 v[104:107], v12 offset:7168
    v_mfma_f32_16x16x32_bf16 v[196:199], v[108:111], a[76:79], v[196:199]
    buffer_load_dwordx4 a[144:147], v4, s[40:43], s63 offen offset:2048 sc1
    v_mfma_f32_16x16x32_bf16 v[200:203], v[112:115], a[64:67], v[200:203]
    ds_read_b128 v[108:111], v12 offset:14336
    v_mfma_f32_16x16x32_bf16 v[200:203], v[116:119], a[72:75], v[200:203]
    v_mfma_f32_16x16x32_bf16 v[204:207], v[112:115], a[68:71], v[204:207]
    ds_read_b128 v[112:115], v12 offset:8192
    v_mfma_f32_16x16x32_bf16 v[204:207], v[116:119], a[76:79], v[204:207]
    buffer_load_dwordx4 a[148:151], v5, s[40:43], s63 offen offset:2048 sc1
    v_mfma_f32_16x16x32_bf16 v[208:211], v[120:123], a[64:67], v[208:211]
    ds_read_b128 v[116:119], v12 offset:15360
    v_mfma_f32_16x16x32_bf16 v[208:211], v[124:127], a[72:75], v[208:211]
    v_mfma_f32_16x16x32_bf16 v[212:215], v[120:123], a[68:71], v[212:215]
    ds_read_b128 v[120:123], v12 offset:9216
    v_mfma_f32_16x16x32_bf16 v[212:215], v[124:127], a[76:79], v[212:215]
    ds_read_b128 v[124:127], v12 offset:16384
    v_mfma_f32_16x16x32_bf16 v[216:219], v[128:131], a[64:67], v[216:219]
    buffer_load_dwordx4 a[152:155], v4, s[40:43], s63 offen offset:3072 sc1
    v_mfma_f32_16x16x32_bf16 v[216:219], v[132:135], a[72:75], v[216:219]
    v_mfma_f32_16x16x32_bf16 v[220:223], v[128:131], a[68:71], v[220:223]
    ds_read_b128 v[128:131], v12 offset:10240
    v_mfma_f32_16x16x32_bf16 v[220:223], v[132:135], a[76:79], v[220:223]
    ds_read_b128 v[132:135], v12 offset:17408
    v_mfma_f32_16x16x32_bf16 v[224:227], v[136:139], a[64:67], v[224:227]
    s_waitcnt lgkmcnt(2)
    buffer_load_dwordx4 a[156:159], v5, s[40:43], s63 offen offset:3072 sc1
    v_mfma_f32_16x16x32_bf16 v[224:227], v[140:143], a[72:75], v[224:227]
    s_xor_b32 s21, s3, 5
    v_mfma_f32_16x16x32_bf16 v[228:231], v[136:139], a[68:71], v[228:231]
    s_lshl2_add_u32 s21, s21, s4
    ds_read_b128 v[136:139], v12 offset:11264
    v_mfma_f32_16x16x32_bf16 v[228:231], v[140:143], a[76:79], v[228:231]
    s_mul_i32 s21, s21, 36864
    ds_read_b128 v[140:143], v12 offset:18432
    v_mfma_f32_16x16x32_bf16 v[176:179], v[144:147], a[80:83], v[176:179]
    s_add_u32 s64, s21, s17
    s_add_u32 m0, s78, 0
    v_mfma_f32_16x16x32_bf16 v[176:179], v[148:151], a[88:91], v[176:179]
    s_xor_b32 s63, s63, 4096
    buffer_load_dwordx4 v1, s[56:59], s64 offen sc1 lds
    v_mfma_f32_16x16x32_bf16 v[180:183], v[144:147], a[84:87], v[180:183]
    ds_read_b128 v[144:147], v12 offset:12288
    v_mfma_f32_16x16x32_bf16 v[180:183], v[148:151], a[92:95], v[180:183]
    ds_read_b128 v[148:151], v12 offset:19456
    v_mfma_f32_16x16x32_bf16 v[184:187], v[104:107], a[80:83], v[184:187]
    buffer_load_dwordx4 v1, s[56:59], s64 offen offset:1024 sc1 lds
    v_mfma_f32_16x16x32_bf16 v[184:187], v[108:111], a[88:91], v[184:187]
    s_add_u32 s64, s21, s18
    v_mfma_f32_16x16x32_bf16 v[188:191], v[104:107], a[84:87], v[188:191]
    s_add_u32 m0, s78, 2048
    ds_read_b128 v[104:107], v12 offset:20480
    v_mfma_f32_16x16x32_bf16 v[188:191], v[108:111], a[92:95], v[188:191]
    ds_read_b128 v[108:111], v12 offset:27648
    v_mfma_f32_16x16x32_bf16 v[192:195], v[112:115], a[80:83], v[192:195]
    buffer_load_dwordx4 v1, s[56:59], s64 offen sc1 lds
    v_mfma_f32_16x16x32_bf16 v[192:195], v[116:119], a[88:91], v[192:195]
    v_mfma_f32_16x16x32_bf16 v[196:199], v[112:115], a[84:87], v[196:199]
    ds_read_b128 v[112:115], v12 offset:21504
    v_mfma_f32_16x16x32_bf16 v[196:199], v[116:119], a[92:95], v[196:199]
    ds_read_b128 v[116:119], v12 offset:28672
    v_mfma_f32_16x16x32_bf16 v[200:203], v[120:123], a[80:83], v[200:203]
    buffer_load_dwordx4 v1, s[56:59], s64 offen offset:1024 sc1 lds
    v_mfma_f32_16x16x32_bf16 v[200:203], v[124:127], a[88:91], v[200:203]
    s_add_u32 s64, s21, s19
    v_mfma_f32_16x16x32_bf16 v[204:207], v[120:123], a[84:87], v[204:207]
    s_add_u32 m0, s78, 4096
    ds_read_b128 v[120:123], v12 offset:22528
    v_mfma_f32_16x16x32_bf16 v[204:207], v[124:127], a[92:95], v[204:207]
    s_waitcnt vmcnt(19)
    s_barrier
    v_mov_b32 v31, 3
    s_waitcnt lgkmcnt(2)
    v_mfma_f32_16x16x32_bf16 v[208:211], v[128:131], a[80:83], v[208:211]
    buffer_load_dwordx4 v1, s[56:59], s64 offen sc1 lds
    v_mfma_f32_16x16x32_bf16 v[208:211], v[132:135], a[88:91], v[208:211]
    buffer_store_dword v31, v30, s[32:35], s101 offen sc1
    v_mfma_f32_16x16x32_bf16 v[212:215], v[128:131], a[84:87], v[212:215]
    ds_read_b128 v[124:127], v12 offset:29696
    ds_read_b128 v[128:131], v12 offset:23552
    v_mfma_f32_16x16x32_bf16 v[212:215], v[132:135], a[92:95], v[212:215]
    ds_read_b128 v[132:135], v12 offset:30720
    v_mfma_f32_16x16x32_bf16 v[216:219], v[136:139], a[80:83], v[216:219]
    v_mfma_f32_16x16x32_bf16 v[216:219], v[140:143], a[88:91], v[216:219]
    buffer_load_dwordx4 v1, s[56:59], s64 offen offset:1024 sc1 lds
    v_mfma_f32_16x16x32_bf16 v[220:223], v[136:139], a[84:87], v[220:223]
    s_add_u32 s64, s21, s20
    ds_read_b128 v[136:139], v12 offset:24576
    v_mfma_f32_16x16x32_bf16 v[220:223], v[140:143], a[92:95], v[220:223]
    s_add_u32 m0, s78, 6144
    ds_read_b128 v[140:143], v12 offset:31744
    v_mfma_f32_16x16x32_bf16 v[224:227], v[144:147], a[80:83], v[224:227]
    v_mfma_f32_16x16x32_bf16 v[224:227], v[148:151], a[88:91], v[224:227]
    buffer_load_dwordx4 v1, s[56:59], s64 offen sc1 lds
    v_mfma_f32_16x16x32_bf16 v[228:231], v[144:147], a[84:87], v[228:231]
    ds_read_b128 v[144:147], v12 offset:25600
    v_mfma_f32_16x16x32_bf16 v[228:231], v[148:151], a[92:95], v[228:231]
    ds_read_b128 v[148:151], v12 offset:32768
    v_mfma_f32_16x16x32_bf16 v[176:179], v[104:107], a[96:99], v[176:179]
    v_mfma_f32_16x16x32_bf16 v[176:179], v[108:111], a[104:107], v[176:179]
    buffer_load_dwordx4 a[160:163], v4, s[40:43], s63 offen offset:0 sc1
    v_mfma_f32_16x16x32_bf16 v[180:183], v[104:107], a[100:103], v[180:183]
    ds_read_b128 v[104:107], v12 offset:26624
    v_mfma_f32_16x16x32_bf16 v[180:183], v[108:111], a[108:111], v[180:183]
    ds_read_b128 v[108:111], v12 offset:33792
    v_mfma_f32_16x16x32_bf16 v[184:187], v[112:115], a[96:99], v[184:187]
    s_waitcnt lgkmcnt(2)
    v_mfma_f32_16x16x32_bf16 v[184:187], v[116:119], a[104:107], v[184:187]
    buffer_load_dwordx4 a[164:167], v5, s[40:43], s63 offen offset:0 sc1
    v_mfma_f32_16x16x32_bf16 v[188:191], v[112:115], a[100:103], v[188:191]
    ds_read_b128 v[112:115], v12 offset:34816
    v_mfma_f32_16x16x32_bf16 v[188:191], v[116:119], a[108:111], v[188:191]
    ds_read_b128 v[116:119], v12 offset:41984
    v_mfma_f32_16x16x32_bf16 v[192:195], v[120:123], a[96:99], v[192:195]
    v_mfma_f32_16x16x32_bf16 v[192:195], v[124:127], a[104:107], v[192:195]
    buffer_load_dwordx4 a[168:171], v4, s[40:43], s63 offen offset:1024 sc1
    v_mfma_f32_16x16x32_bf16 v[196:199], v[120:123], a[100:103], v[196:199]
    ds_read_b128 v[120:123], v12 offset:35840
    v_mfma_f32_16x16x32_bf16 v[196:199], v[124:127], a[108:111], v[196:199]
    ds_read_b128 v[124:127], v12 offset:43008
    v_mfma_f32_16x16x32_bf16 v[200:203], v[128:131], a[96:99], v[200:203]
    v_mfma_f32_16x16x32_bf16 v[200:203], v[132:135], a[104:107], v[200:203]
    buffer_load_dwordx4 a[172:175], v5, s[40:43], s63 offen offset:1024 sc1
    v_mfma_f32_16x16x32_bf16 v[204:207], v[128:131], a[100:103], v[204:207]
    ds_read_b128 v[128:131], v12 offset:36864
    v_mfma_f32_16x16x32_bf16 v[204:207], v[132:135], a[108:111], v[204:207]
    ds_read_b128 v[132:135], v12 offset:44032
    v_mfma_f32_16x16x32_bf16 v[208:211], v[136:139], a[96:99], v[208:211]
    v_mfma_f32_16x16x32_bf16 v[208:211], v[140:143], a[104:107], v[208:211]
    buffer_load_dwordx4 a[176:179], v4, s[40:43], s63 offen offset:2048 sc1
    v_mfma_f32_16x16x32_bf16 v[212:215], v[136:139], a[100:103], v[212:215]
    ds_read_b128 v[136:139], v12 offset:37888
    v_mfma_f32_16x16x32_bf16 v[212:215], v[140:143], a[108:111], v[212:215]
    ds_read_b128 v[140:143], v12 offset:45056
    v_mfma_f32_16x16x32_bf16 v[216:219], v[144:147], a[96:99], v[216:219]
    v_mfma_f32_16x16x32_bf16 v[216:219], v[148:151], a[104:107], v[216:219]
    buffer_load_dwordx4 a[180:183], v5, s[40:43], s63 offen offset:2048 sc1
    v_mfma_f32_16x16x32_bf16 v[220:223], v[144:147], a[100:103], v[220:223]
    ds_read_b128 v[144:147], v12 offset:38912
    v_mfma_f32_16x16x32_bf16 v[220:223], v[148:151], a[108:111], v[220:223]
    s_waitcnt lgkmcnt(2)
    ds_read_b128 v[148:151], v12 offset:46080
    v_mfma_f32_16x16x32_bf16 v[224:227], v[104:107], a[96:99], v[224:227]
    v_mfma_f32_16x16x32_bf16 v[224:227], v[108:111], a[104:107], v[224:227]
    buffer_load_dwordx4 a[184:187], v4, s[40:43], s63 offen offset:3072 sc1
    v_mfma_f32_16x16x32_bf16 v[228:231], v[104:107], a[100:103], v[228:231]
    ds_read_b128 v[104:107], v12 offset:39936
    v_mfma_f32_16x16x32_bf16 v[228:231], v[108:111], a[108:111], v[228:231]
    ds_read_b128 v[108:111], v12 offset:47104
    v_mfma_f32_16x16x32_bf16 v[176:179], v[112:115], a[112:115], v[176:179]
    v_mfma_f32_16x16x32_bf16 v[176:179], v[116:119], a[120:123], v[176:179]
    v_mfma_f32_16x16x32_bf16 v[180:183], v[112:115], a[116:119], v[180:183]
    buffer_load_dwordx4 a[188:191], v5, s[40:43], s63 offen offset:3072 sc1
    v_mfma_f32_16x16x32_bf16 v[180:183], v[116:119], a[124:127], v[180:183]
    s_xor_b32 s21, s3, 6
    ds_read_b128 v[112:115], v12 offset:40960
    ds_read_b128 v[116:119], v12 offset:48128
    v_mfma_f32_16x16x32_bf16 v[184:187], v[120:123], a[112:115], v[184:187]
    s_lshl2_add_u32 s21, s21, s4
    v_mfma_f32_16x16x32_bf16 v[184:187], v[124:127], a[120:123], v[184:187]
    s_mul_i32 s21, s21, 36864
    v_mfma_f32_16x16x32_bf16 v[188:191], v[120:123], a[116:119], v[188:191]
    s_add_u32 s64, s21, s17
    s_add_u32 m0, s78, 28672
    v_mfma_f32_16x16x32_bf16 v[188:191], v[124:127], a[124:127], v[188:191]
    s_xor_b32 s63, s63, 12288
    buffer_load_dwordx4 v1, s[56:59], s64 offen sc1 lds
    v_mfma_f32_16x16x32_bf16 v[192:195], v[128:131], a[112:115], v[192:195]
    v_mfma_f32_16x16x32_bf16 v[192:195], v[132:135], a[120:123], v[192:195]
    v_mfma_f32_16x16x32_bf16 v[196:199], v[128:131], a[116:119], v[196:199]
    buffer_load_dwordx4 v1, s[56:59], s64 offen offset:1024 sc1 lds
    v_mfma_f32_16x16x32_bf16 v[196:199], v[132:135], a[124:127], v[196:199]
    s_add_u32 s64, s21, s18
    v_mfma_f32_16x16x32_bf16 v[200:203], v[136:139], a[112:115], v[200:203]
    s_add_u32 m0, s78, 30720
    s_waitcnt lgkmcnt(0)
    v_mfma_f32_16x16x32_bf16 v[200:203], v[140:143], a[120:123], v[200:203]
    v_mfma_f32_16x16x32_bf16 v[204:207], v[136:139], a[116:119], v[204:207]
    buffer_load_dwordx4 v1, s[56:59], s64 offen sc1 lds
    v_mfma_f32_16x16x32_bf16 v[204:207], v[140:143], a[124:127], v[204:207]
    s_waitcnt vmcnt(19)
    s_barrier
    ds_read_b128 v[120:123], v12 offset:49152
    v_mfma_f32_16x16x32_bf16 v[208:211], v[144:147], a[112:115], v[208:211]
    ds_read_b128 v[124:127], v12 offset:56320
    ds_read_b128 v[128:131], v12 offset:50176
    v_mfma_f32_16x16x32_bf16 v[208:211], v[148:151], a[120:123], v[208:211]
    ds_read_b128 v[132:135], v12 offset:57344
    v_mfma_f32_16x16x32_bf16 v[212:215], v[144:147], a[116:119], v[212:215]
    buffer_load_dwordx4 v1, s[56:59], s64 offen offset:1024 sc1 lds
    v_mfma_f32_16x16x32_bf16 v[212:215], v[148:151], a[124:127], v[212:215]
    s_add_u32 s64, s21, s19
    ds_read_b128 v[136:139], v12 offset:51200
    ds_read_b128 v[140:143], v12 offset:58368
    v_mfma_f32_16x16x32_bf16 v[216:219], v[104:107], a[112:115], v[216:219]
    s_add_u32 m0, s78, 32768
    ds_read_b128 v[144:147], v12 offset:52224
    v_mfma_f32_16x16x32_bf16 v[216:219], v[108:111], a[120:123], v[216:219]
    ds_read_b128 v[148:151], v12 offset:59392
    v_mfma_f32_16x16x32_bf16 v[220:223], v[104:107], a[116:119], v[220:223]
    buffer_load_dwordx4 v1, s[56:59], s64 offen sc1 lds
    v_mfma_f32_16x16x32_bf16 v[220:223], v[108:111], a[124:127], v[220:223]
    ds_read_b128 v[104:107], v12 offset:53248
    ds_read_b128 v[108:111], v12 offset:60416
    v_mfma_f32_16x16x32_bf16 v[224:227], v[112:115], a[112:115], v[224:227]
    v_mfma_f32_16x16x32_bf16 v[224:227], v[116:119], a[120:123], v[224:227]
    v_mfma_f32_16x16x32_bf16 v[228:231], v[112:115], a[116:119], v[228:231]
    buffer_load_dwordx4 v1, s[56:59], s64 offen offset:1024 sc1 lds
    v_mfma_f32_16x16x32_bf16 v[228:231], v[116:119], a[124:127], v[228:231]
    s_add_u32 s64, s21, s20
    ds_read_b128 v[112:115], v12 offset:54272
    ds_read_b128 v[116:119], v12 offset:61440
    s_waitcnt lgkmcnt(4)
    v_mfma_f32_16x16x32_bf16 v[176:179], v[120:123], a[128:131], v[176:179]
    s_add_u32 m0, s78, 34816
    v_mfma_f32_16x16x32_bf16 v[176:179], v[124:127], a[136:139], v[176:179]
    v_mfma_f32_16x16x32_bf16 v[180:183], v[120:123], a[132:135], v[180:183]
    buffer_load_dwordx4 v1, s[56:59], s64 offen sc1 lds
    v_mfma_f32_16x16x32_bf16 v[180:183], v[124:127], a[140:143], v[180:183]
    ds_read_b128 v[120:123], v12 offset:55296
    ds_read_b128 v[124:127], v12 offset:62464
    v_mfma_f32_16x16x32_bf16 v[184:187], v[128:131], a[128:131], v[184:187]
    v_mfma_f32_16x16x32_bf16 v[184:187], v[132:135], a[136:139], v[184:187]
    v_mfma_f32_16x16x32_bf16 v[188:191], v[128:131], a[132:135], v[188:191]
    ds_read_b128 v[128:131], v12 offset:63488
    v_mfma_f32_16x16x32_bf16 v[188:191], v[132:135], a[140:143], v[188:191]
    buffer_load_dwordx4 a[192:195], v4, s[40:43], s63 offen offset:0 sc1
    v_mfma_f32_16x16x32_bf16 v[192:195], v[136:139], a[128:131], v[192:195]
    ds_read_b128 v[132:135], v13 offset:5120
    v_mfma_f32_16x16x32_bf16 v[192:195], v[140:143], a[136:139], v[192:195]
    v_mfma_f32_16x16x32_bf16 v[196:199], v[136:139], a[132:135], v[196:199]
    ds_read_b128 v[136:139], v12 offset:64512
    v_mfma_f32_16x16x32_bf16 v[196:199], v[140:143], a[140:143], v[196:199]
    buffer_load_dwordx4 a[196:199], v5, s[40:43], s63 offen offset:0 sc1
    v_mfma_f32_16x16x32_bf16 v[200:203], v[144:147], a[128:131], v[200:203]
    ds_read_b128 v[140:143], v13 offset:6144
    v_mfma_f32_16x16x32_bf16 v[200:203], v[148:151], a[136:139], v[200:203]
    v_mfma_f32_16x16x32_bf16 v[204:207], v[144:147], a[132:135], v[204:207]
    ds_read_b128 v[144:147], v13 offset:0
    v_mfma_f32_16x16x32_bf16 v[204:207], v[148:151], a[140:143], v[204:207]
    s_waitcnt lgkmcnt(2)
    buffer_load_dwordx4 a[200:203], v4, s[40:43], s63 offen offset:1024 sc1
    v_mfma_f32_16x16x32_bf16 v[208:211], v[104:107], a[128:131], v[208:211]
    ds_read_b128 v[148:151], v13 offset:7168
    v_mfma_f32_16x16x32_bf16 v[208:211], v[108:111], a[136:139], v[208:211]
    v_mfma_f32_16x16x32_bf16 v[212:215], v[104:107], a[132:135], v[212:215]
    ds_read_b128 v[104:107], v13 offset:1024
    v_mfma_f32_16x16x32_bf16 v[212:215], v[108:111], a[140:143], v[212:215]
    buffer_load_dwordx4 a[204:207], v5, s[40:43], s63 offen offset:1024 sc1
    v_mfma_f32_16x16x32_bf16 v[216:219], v[112:115], a[128:131], v[216:219]
    ds_read_b128 v[108:111], v13 offset:8192
    v_mfma_f32_16x16x32_bf16 v[216:219], v[116:119], a[136:139], v[216:219]
    v_mfma_f32_16x16x32_bf16 v[220:223], v[112:115], a[132:135], v[220:223]
    ds_read_b128 v[112:115], v13 offset:2048
    v_mfma_f32_16x16x32_bf16 v[220:223], v[116:119], a[140:143], v[220:223]
    buffer_load_dwordx4 a[208:211], v4, s[40:43], s63 offen offset:2048 sc1
    v_mfma_f32_16x16x32_bf16 v[224:227], v[120:123], a[128:131], v[224:227]
    ds_read_b128 v[116:119], v13 offset:9216
    v_mfma_f32_16x16x32_bf16 v[224:227], v[124:127], a[136:139], v[224:227]
    v_mfma_f32_16x16x32_bf16 v[228:231], v[120:123], a[132:135], v[228:231]
    ds_read_b128 v[120:123], v13 offset:3072
    v_mfma_f32_16x16x32_bf16 v[228:231], v[124:127], a[140:143], v[228:231]
    buffer_load_dwordx4 a[212:215], v5, s[40:43], s63 offen offset:2048 sc1
    v_mfma_f32_16x16x32_bf16 v[176:179], v[128:131], a[144:147], v[176:179]
    ds_read_b128 v[124:127], v13 offset:10240
    v_mfma_f32_16x16x32_bf16 v[176:179], v[132:135], a[152:155], v[176:179]
    v_mfma_f32_16x16x32_bf16 v[180:183], v[128:131], a[148:151], v[180:183]
    ds_read_b128 v[128:131], v13 offset:4096
    v_mfma_f32_16x16x32_bf16 v[180:183], v[132:135], a[156:159], v[180:183]
    buffer_load_dwordx4 a[216:219], v4, s[40:43], s63 offen offset:3072 sc1
    v_mfma_f32_16x16x32_bf16 v[184:187], v[136:139], a[144:147], v[184:187]
    s_waitcnt lgkmcnt(2)
    ds_read_b128 v[132:135], v13 offset:11264
    v_mfma_f32_16x16x32_bf16 v[184:187], v[140:143], a[152:155], v[184:187]
    v_mfma_f32_16x16x32_bf16 v[188:191], v[136:139], a[148:151], v[188:191]
    v_mfma_f32_16x16x32_bf16 v[188:191], v[140:143], a[156:159], v[188:191]
    buffer_load_dwordx4 a[220:223], v5, s[40:43], s63 offen offset:3072 sc1
    v_mfma_f32_16x16x32_bf16 v[192:195], v[144:147], a[144:147], v[192:195]
    v_mfma_f32_16x16x32_bf16 v[192:195], v[148:151], a[152:155], v[192:195]
    s_xor_b32 s63, s63, 4096
    v_mfma_f32_16x16x32_bf16 v[196:199], v[144:147], a[148:151], v[196:199]
    v_mfma_f32_16x16x32_bf16 v[196:199], v[148:151], a[156:159], v[196:199]
    v_mfma_f32_16x16x32_bf16 v[200:203], v[104:107], a[144:147], v[200:203]
    buffer_load_dword v3, v19, s[32:35], s66 offen sc1
    v_mfma_f32_16x16x32_bf16 v[200:203], v[108:111], a[152:155], v[200:203]
    s_xor_b32 s21, s3, 7
    v_mfma_f32_16x16x32_bf16 v[204:207], v[104:107], a[148:151], v[204:207]
    s_lshl2_add_u32 s21, s21, s4
    v_mfma_f32_16x16x32_bf16 v[204:207], v[108:111], a[156:159], v[204:207]
    s_mul_i32 s21, s21, 36864
    s_waitcnt vmcnt(16)
    s_barrier
    v_mfma_f32_16x16x32_bf16 v[208:211], v[112:115], a[144:147], v[208:211]
    s_add_u32 s64, s21, s17
    s_add_u32 m0, s78, 57344
    ds_read_b128 v[136:139], v11 offset:0
    v_mfma_f32_16x16x32_bf16 v[208:211], v[116:119], a[152:155], v[208:211]
    buffer_load_dwordx4 v1, s[56:59], s64 offen sc1 lds
    v_mfma_f32_16x16x32_bf16 v[212:215], v[112:115], a[148:151], v[212:215]
    ds_read_b128 v[140:143], v11 offset:7168
    ds_read_b128 v[144:147], v11 offset:1024
    v_mfma_f32_16x16x32_bf16 v[212:215], v[116:119], a[156:159], v[212:215]
    ds_read_b128 v[148:151], v11 offset:8192
    v_mfma_f32_16x16x32_bf16 v[216:219], v[120:123], a[144:147], v[216:219]
    s_waitcnt lgkmcnt(4)
    buffer_load_dwordx4 v1, s[56:59], s64 offen offset:1024 sc1 lds
    v_mfma_f32_16x16x32_bf16 v[216:219], v[124:127], a[152:155], v[216:219]
    s_add_u32 s64, s21, s18
    ds_read_b128 v[104:107], v11 offset:2048
    ds_read_b128 v[108:111], v11 offset:9216
    v_mfma_f32_16x16x32_bf16 v[220:223], v[120:123], a[148:151], v[220:223]
    s_add_u32 m0, s78, 59392
    ds_read_b128 v[112:115], v11 offset:3072
    v_mfma_f32_16x16x32_bf16 v[220:223], v[124:127], a[156:159], v[220:223]
    ds_read_b128 v[116:119], v11 offset:10240
    v_mfma_f32_16x16x32_bf16 v[224:227], v[128:131], a[144:147], v[224:227]
    buffer_load_dwordx4 v1, s[56:59], s64 offen sc1 lds
    v_mfma_f32_16x16x32_bf16 v[224:227], v[132:135], a[152:155], v[224:227]
    ds_read_b128 v[120:123], v11 offset:4096
    ds_read_b128 v[124:127], v11 offset:11264
    v_mfma_f32_16x16x32_bf16 v[228:231], v[128:131], a[148:151], v[228:231]
    ds_read_b128 v[128:131], v11 offset:5120
    v_mfma_f32_16x16x32_bf16 v[228:231], v[132:135], a[156:159], v[228:231]
    s_waitcnt lgkmcnt(4)
    ds_read_b128 v[132:135], v11 offset:12288
    v_mfma_f32_16x16x32_bf16 v[176:179], v[136:139], a[160:163], v[176:179]
    buffer_load_dwordx4 v1, s[56:59], s64 offen offset:1024 sc1 lds
    v_mfma_f32_16x16x32_bf16 v[176:179], v[140:143], a[168:171], v[176:179]
    s_add_u32 s64, s21, s19
    v_mfma_f32_16x16x32_bf16 v[180:183], v[136:139], a[164:167], v[180:183]
    s_add_u32 m0, s78, 61440
    ds_read_b128 v[136:139], v11 offset:6144
    v_mfma_f32_16x16x32_bf16 v[180:183], v[140:143], a[172:175], v[180:183]
    ds_read_b128 v[140:143], v11 offset:13312
    v_mfma_f32_16x16x32_bf16 v[184:187], v[144:147], a[160:163], v[184:187]
    buffer_load_dwordx4 v1, s[56:59], s64 offen sc1 lds
    v_mfma_f32_16x16x32_bf16 v[184:187], v[148:151], a[168:171], v[184:187]
    v_mfma_f32_16x16x32_bf16 v[188:191], v[144:147], a[164:167], v[188:191]
    ds_read_b128 v[144:147], v11 offset:14336
    v_mfma_f32_16x16x32_bf16 v[188:191], v[148:151], a[172:175], v[188:191]
    ds_read_b128 v[148:151], v11 offset:21504
    v_mfma_f32_16x16x32_bf16 v[192:195], v[104:107], a[160:163], v[192:195]
    buffer_load_dwordx4 v1, s[56:59], s64 offen offset:1024 sc1 lds
    v_mfma_f32_16x16x32_bf16 v[192:195], v[108:111], a[168:171], v[192:195]
    s_add_u32 s64, s21, s20
    v_mfma_f32_16x16x32_bf16 v[196:199], v[104:107], a[164:167], v[196:199]
    s_add_u32 m0, s78, 63488
    ds_read_b128 v[104:107], v11 offset:15360
    v_mfma_f32_16x16x32_bf16 v[196:199], v[108:111], a[172:175], v[196:199]
    ds_read_b128 v[108:111], v11 offset:22528
    v_mfma_f32_16x16x32_bf16 v[200:203], v[112:115], a[160:163], v[200:203]
    s_waitcnt lgkmcnt(2)
    buffer_load_dwordx4 v1, s[56:59], s64 offen sc1 lds
    v_mfma_f32_16x16x32_bf16 v[200:203], v[116:119], a[168:171], v[200:203]
    v_mfma_f32_16x16x32_bf16 v[204:207], v[112:115], a[164:167], v[204:207]
    ds_read_b128 v[112:115], v11 offset:16384
    v_mfma_f32_16x16x32_bf16 v[204:207], v[116:119], a[172:175], v[204:207]
    ds_read_b128 v[116:119], v11 offset:23552
    v_mfma_f32_16x16x32_bf16 v[208:211], v[120:123], a[160:163], v[208:211]
    v_mfma_f32_16x16x32_bf16 v[208:211], v[124:127], a[168:171], v[208:211]
    buffer_load_dwordx4 a[224:227], v4, s[40:43], s63 offen offset:0 sc1
    v_mfma_f32_16x16x32_bf16 v[212:215], v[120:123], a[164:167], v[212:215]
    ds_read_b128 v[120:123], v11 offset:17408
    v_mfma_f32_16x16x32_bf16 v[212:215], v[124:127], a[172:175], v[212:215]
    ds_read_b128 v[124:127], v11 offset:24576
    v_mfma_f32_16x16x32_bf16 v[216:219], v[128:131], a[160:163], v[216:219]
    v_mfma_f32_16x16x32_bf16 v[216:219], v[132:135], a[168:171], v[216:219]
    buffer_load_dwordx4 a[228:231], v5, s[40:43], s63 offen offset:0 sc1
    v_mfma_f32_16x16x32_bf16 v[220:223], v[128:131], a[164:167], v[220:223]
    ds_read_b128 v[128:131], v11 offset:18432
    v_mfma_f32_16x16x32_bf16 v[220:223], v[132:135], a[172:175], v[220:223]
    ds_read_b128 v[132:135], v11 offset:25600
    v_mfma_f32_16x16x32_bf16 v[224:227], v[136:139], a[160:163], v[224:227]
    v_mfma_f32_16x16x32_bf16 v[224:227], v[140:143], a[168:171], v[224:227]
    buffer_load_dwordx4 a[232:235], v4, s[40:43], s63 offen offset:1024 sc1
    v_mfma_f32_16x16x32_bf16 v[228:231], v[136:139], a[164:167], v[228:231]
    ds_read_b128 v[136:139], v11 offset:19456
    v_mfma_f32_16x16x32_bf16 v[228:231], v[140:143], a[172:175], v[228:231]
    ds_read_b128 v[140:143], v11 offset:26624
    v_mfma_f32_16x16x32_bf16 v[176:179], v[144:147], a[176:179], v[176:179]
    v_mfma_f32_16x16x32_bf16 v[176:179], v[148:151], a[184:187], v[176:179]
    buffer_load_dwordx4 a[236:239], v5, s[40:43], s63 offen offset:1024 sc1
    v_mfma_f32_16x16x32_bf16 v[180:183], v[144:147], a[180:183], v[180:183]
    ds_read_b128 v[144:147], v11 offset:20480
    v_mfma_f32_16x16x32_bf16 v[180:183], v[148:151], a[188:191], v[180:183]
    s_waitcnt lgkmcnt(2)
    ds_read_b128 v[148:151], v11 offset:27648
    v_mfma_f32_16x16x32_bf16 v[184:187], v[104:107], a[176:179], v[184:187]
    v_mfma_f32_16x16x32_bf16 v[184:187], v[108:111], a[184:187], v[184:187]
    buffer_load_dwordx4 a[240:243], v4, s[40:43], s63 offen offset:2048 sc1
    v_mfma_f32_16x16x32_bf16 v[188:191], v[104:107], a[180:183], v[188:191]
    v_mfma_f32_16x16x32_bf16 v[188:191], v[108:111], a[188:191], v[188:191]
    v_mfma_f32_16x16x32_bf16 v[192:195], v[112:115], a[176:179], v[192:195]
    v_mfma_f32_16x16x32_bf16 v[192:195], v[116:119], a[184:187], v[192:195]
    buffer_load_dwordx4 a[244:247], v5, s[40:43], s63 offen offset:2048 sc1
    v_mfma_f32_16x16x32_bf16 v[196:199], v[112:115], a[180:183], v[196:199]
    v_mfma_f32_16x16x32_bf16 v[196:199], v[116:119], a[188:191], v[196:199]
    v_mfma_f32_16x16x32_bf16 v[200:203], v[120:123], a[176:179], v[200:203]
    v_mfma_f32_16x16x32_bf16 v[200:203], v[124:127], a[184:187], v[200:203]
    buffer_load_dwordx4 a[248:251], v4, s[40:43], s63 offen offset:3072 sc1
    v_mfma_f32_16x16x32_bf16 v[204:207], v[120:123], a[180:183], v[204:207]
    v_mfma_f32_16x16x32_bf16 v[204:207], v[124:127], a[188:191], v[204:207]
    s_waitcnt vmcnt(14)
    v_cmp_gt_u32 vcc, 3, v3
    s_nop 1
    s_and_b64 vcc, vcc, exec
    s_cbranch_scc1 SPIN_OA
BACK_OA:
    s_barrier
    v_mfma_f32_16x16x32_bf16 v[208:211], v[128:131], a[176:179], v[208:211]
    ds_read_b128 v[104:107], v11 offset:28672
    ds_read_b128 v[108:111], v11 offset:35840
    v_mfma_f32_16x16x32_bf16 v[208:211], v[132:135], a[184:187], v[208:211]
    buffer_load_dwordx4 a[252:255], v5, s[40:43], s63 offen offset:3072 sc1
    v_mfma_f32_16x16x32_bf16 v[212:215], v[128:131], a[180:183], v[212:215]
    ds_read_b128 v[112:115], v11 offset:29696
    ds_read_b128 v[116:119], v11 offset:36864
    v_mfma_f32_16x16x32_bf16 v[212:215], v[132:135], a[188:191], v[212:215]
    s_mul_i32 s21, s61, 6
    s_add_u32 s21, s4, s21
    ds_read_b128 v[120:123], v11 offset:30720
    v_mfma_f32_16x16x32_bf16 v[216:219], v[136:139], a[176:179], v[216:219]
    s_add_u32 s21, s21, 128
    ds_read_b128 v[124:127], v11 offset:37888
    s_waitcnt lgkmcnt(6)
    v_mfma_f32_16x16x32_bf16 v[216:219], v[140:143], a[184:187], v[216:219]
    s_mul_i32 s21, s21, 36864
    ds_read_b128 v[128:131], v11 offset:31744
    v_mfma_f32_16x16x32_bf16 v[220:223], v[136:139], a[180:183], v[220:223]
    s_add_u32 s64, s21, s17
    s_add_u32 m0, s78, 86016
    ds_read_b128 v[132:135], v11 offset:38912
    v_mfma_f32_16x16x32_bf16 v[220:223], v[140:143], a[188:191], v[220:223]
    s_add_u32 s63, s63, 4096
    buffer_load_dwordx4 v1, s[56:59], s64 offen sc1 lds
    v_mfma_f32_16x16x32_bf16 v[224:227], v[144:147], a[176:179], v[224:227]
    ds_read_b128 v[136:139], v11 offset:32768
    ds_read_b128 v[140:143], v11 offset:39936
    v_mfma_f32_16x16x32_bf16 v[224:227], v[148:151], a[184:187], v[224:227]
    v_mfma_f32_16x16x32_bf16 v[228:231], v[144:147], a[180:183], v[228:231]
    buffer_load_dwordx4 v1, s[56:59], s64 offen offset:1024 sc1 lds
    v_mfma_f32_16x16x32_bf16 v[228:231], v[148:151], a[188:191], v[228:231]
    s_add_u32 s64, s21, s18
    ds_read_b128 v[144:147], v11 offset:33792
    ds_read_b128 v[148:151], v11 offset:40960
    s_waitcnt lgkmcnt(4)
    v_mfma_f32_16x16x32_bf16 v[176:179], v[104:107], a[192:195], v[176:179]
    s_add_u32 m0, s78, 88064
    v_mfma_f32_16x16x32_bf16 v[176:179], v[108:111], a[200:203], v[176:179]
    v_mfma_f32_16x16x32_bf16 v[180:183], v[104:107], a[196:199], v[180:183]
    buffer_load_dwordx4 v1, s[56:59], s64 offen sc1 lds
    v_mfma_f32_16x16x32_bf16 v[180:183], v[108:111], a[204:207], v[180:183]
    ds_read_b128 v[104:107], v11 offset:34816
    ds_read_b128 v[108:111], v11 offset:41984
    v_mfma_f32_16x16x32_bf16 v[184:187], v[112:115], a[192:195], v[184:187]
    v_mfma_f32_16x16x32_bf16 v[184:187], v[116:119], a[200:203], v[184:187]
    v_mfma_f32_16x16x32_bf16 v[188:191], v[112:115], a[196:199], v[188:191]
    buffer_load_dwordx4 v1, s[56:59], s64 offen offset:1024 sc1 lds
    v_mfma_f32_16x16x32_bf16 v[188:191], v[116:119], a[204:207], v[188:191]
    s_add_u32 s64, s21, s19
    ds_read_b128 v[112:115], v11 offset:43008
    ds_read_b128 v[116:119], v11 offset:50176
    v_mfma_f32_16x16x32_bf16 v[192:195], v[120:123], a[192:195], v[192:195]
    s_add_u32 m0, s78, 90112
    v_mfma_f32_16x16x32_bf16 v[192:195], v[124:127], a[200:203], v[192:195]
    v_mfma_f32_16x16x32_bf16 v[196:199], v[120:123], a[196:199], v[196:199]
    buffer_load_dwordx4 v1, s[56:59], s64 offen sc1 lds
    v_mfma_f32_16x16x32_bf16 v[196:199], v[124:127], a[204:207], v[196:199]
    ds_read_b128 v[120:123], v11 offset:44032
    ds_read_b128 v[124:127], v11 offset:51200
    v_mfma_f32_16x16x32_bf16 v[200:203], v[128:131], a[192:195], v[200:203]
    v_mfma_f32_16x16x32_bf16 v[200:203], v[132:135], a[200:203], v[200:203]
    v_mfma_f32_16x16x32_bf16 v[204:207], v[128:131], a[196:199], v[204:207]
    buffer_load_dwordx4 v1, s[56:59], s64 offen offset:1024 sc1 lds
    v_mfma_f32_16x16x32_bf16 v[204:207], v[132:135], a[204:207], v[204:207]
    s_add_u32 s64, s21, s20
    ds_read_b128 v[128:131], v11 offset:45056
    ds_read_b128 v[132:135], v11 offset:52224
    s_waitcnt lgkmcnt(4)
    v_mfma_f32_16x16x32_bf16 v[208:211], v[136:139], a[192:195], v[208:211]
    s_add_u32 m0, s78, 92160
    v_mfma_f32_16x16x32_bf16 v[208:211], v[140:143], a[200:203], v[208:211]
    v_mfma_f32_16x16x32_bf16 v[212:215], v[136:139], a[196:199], v[212:215]
    buffer_load_dwordx4 v1, s[56:59], s64 offen sc1 lds
    v_mfma_f32_16x16x32_bf16 v[212:215], v[140:143], a[204:207], v[212:215]
    s_mul_i32 s63, s61, 6144
    ds_read_b128 v[136:139], v11 offset:46080
    ds_read_b128 v[140:143], v11 offset:53248
    v_mfma_f32_16x16x32_bf16 v[216:219], v[144:147], a[192:195], v[216:219]
    s_add_u32 s63, s63, 131072
    v_mfma_f32_16x16x32_bf16 v[216:219], v[148:151], a[200:203], v[216:219]
    v_mfma_f32_16x16x32_bf16 v[220:223], v[144:147], a[196:199], v[220:223]
    buffer_load_dwordx4 v[32:35], v4, s[40:43], s63 offen offset:0 sc1
    v_mfma_f32_16x16x32_bf16 v[220:223], v[148:151], a[204:207], v[220:223]
    ds_read_b128 v[144:147], v11 offset:47104
    ds_read_b128 v[148:151], v11 offset:54272
    v_mfma_f32_16x16x32_bf16 v[224:227], v[104:107], a[192:195], v[224:227]
    v_mfma_f32_16x16x32_bf16 v[224:227], v[108:111], a[200:203], v[224:227]
    v_mfma_f32_16x16x32_bf16 v[228:231], v[104:107], a[196:199], v[228:231]
    ds_read_b128 v[104:107], v11 offset:48128
    v_mfma_f32_16x16x32_bf16 v[228:231], v[108:111], a[204:207], v[228:231]
    buffer_load_dwordx4 v[36:39], v5, s[40:43], s63 offen offset:0 sc1
    v_mfma_f32_16x16x32_bf16 v[176:179], v[112:115], a[208:211], v[176:179]
    ds_read_b128 v[108:111], v11 offset:55296
    v_mfma_f32_16x16x32_bf16 v[176:179], v[116:119], a[216:219], v[176:179]
    v_mfma_f32_16x16x32_bf16 v[180:183], v[112:115], a[212:215], v[180:183]
    ds_read_b128 v[112:115], v11 offset:49152
    v_mfma_f32_16x16x32_bf16 v[180:183], v[116:119], a[220:223], v[180:183]
    s_waitcnt lgkmcnt(2)
    buffer_load_dwordx4 v[40:43], v4, s[40:43], s63 offen offset:1024 sc1
    v_mfma_f32_16x16x32_bf16 v[184:187], v[120:123], a[208:211], v[184:187]
    ds_read_b128 v[116:119], v11 offset:56320
    v_mfma_f32_16x16x32_bf16 v[184:187], v[124:127], a[216:219], v[184:187]
    v_mfma_f32_16x16x32_bf16 v[188:191], v[120:123], a[212:215], v[188:191]
    v_mfma_f32_16x16x32_bf16 v[188:191], v[124:127], a[220:223], v[188:191]
    buffer_load_dwordx4 v[44:47], v5, s[40:43], s63 offen offset:1024 sc1
    v_mfma_f32_16x16x32_bf16 v[192:195], v[128:131], a[208:211], v[192:195]
    v_mfma_f32_16x16x32_bf16 v[192:195], v[132:135], a[216:219], v[192:195]
    v_mfma_f32_16x16x32_bf16 v[196:199], v[128:131], a[212:215], v[196:199]
    v_mfma_f32_16x16x32_bf16 v[196:199], v[132:135], a[220:223], v[196:199]
    buffer_load_dwordx4 v[48:51], v4, s[40:43], s63 offen offset:2048 sc1
    v_mfma_f32_16x16x32_bf16 v[200:203], v[136:139], a[208:211], v[200:203]
    v_mfma_f32_16x16x32_bf16 v[200:203], v[140:143], a[216:219], v[200:203]
    v_mfma_f32_16x16x32_bf16 v[204:207], v[136:139], a[212:215], v[204:207]
    v_mfma_f32_16x16x32_bf16 v[204:207], v[140:143], a[220:223], v[204:207]
    s_waitcnt vmcnt(12)
    s_barrier
    ds_read_b128 v[120:123], v11 offset:57344
    v_mfma_f32_16x16x32_bf16 v[208:211], v[144:147], a[208:211], v[208:211]
    buffer_load_dwordx4 v[52:55], v5, s[40:43], s63 offen offset:2048 sc1
    v_mfma_f32_16x16x32_bf16 v[208:211], v[148:151], a[216:219], v[208:211]
    ds_read_b128 v[124:127], v11 offset:64512
    ds_read_b128 v[128:131], v11 offset:58368
    v_mfma_f32_16x16x32_bf16 v[212:215], v[144:147], a[212:215], v[212:215]
    ds_read_b128 v[132:135], v12 offset:0
    v_mfma_f32_16x16x32_bf16 v[212:215], v[148:151], a[220:223], v[212:215]
    buffer_load_dwordx4 v[56:59], v4, s[40:43], s63 offen offset:3072 sc1
    v_mfma_f32_16x16x32_bf16 v[216:219], v[104:107], a[208:211], v[216:219]
    s_waitcnt lgkmcnt(3)
    ds_read_b128 v[136:139], v11 offset:59392
    ds_read_b128 v[140:143], v12 offset:1024
    v_mfma_f32_16x16x32_bf16 v[216:219], v[108:111], a[216:219], v[216:219]
    ds_read_b128 v[144:147], v11 offset:60416
    v_mfma_f32_16x16x32_bf16 v[220:223], v[104:107], a[212:215], v[220:223]
    ds_read_b128 v[148:151], v12 offset:2048
    v_mfma_f32_16x16x32_bf16 v[220:223], v[108:111], a[220:223], v[220:223]
    buffer_load_dwordx4 v[60:63], v5, s[40:43], s63 offen offset:3072 sc1
    v_mfma_f32_16x16x32_bf16 v[224:227], v[112:115], a[208:211], v[224:227]
    s_mul_i32 s21, s61, 6
    s_cmp_eq_u32 s4, 0
    s_cselect_b32 s64, s17, s18
    v_mfma_f32_16x16x32_bf16 v[224:227], v[116:119], a[216:219], v[224:227]
    s_add_u32 s21, s21, 132
    s_cmp_eq_u32 s4, 2
    s_cselect_b32 s64, s19, s64
    v_mfma_f32_16x16x32_bf16 v[228:231], v[112:115], a[212:215], v[228:231]
    s_mul_i32 s21, s21, 36864
    s_cmp_eq_u32 s4, 3
    s_cselect_b32 s64, s20, s64
    v_mfma_f32_16x16x32_bf16 v[228:231], v[116:119], a[220:223], v[228:231]
    s_add_u32 s64, s64, s21
    s_add_u32 m0, s67, 114688
    ds_read_b128 v[104:107], v11 offset:61440
    v_mfma_f32_16x16x32_bf16 v[176:179], v[120:123], a[224:227], v[176:179]
    s_add_u32 s63, s63, 4096
    buffer_load_dwordx4 v1, s[56:59], s64 offen sc1 lds
    s_waitcnt lgkmcnt(1)
    v_mfma_f32_16x16x32_bf16 v[176:179], v[124:127], a[232:235], v[176:179]
    s_add_u32 s23, s5, 8
    ds_read_b128 v[108:111], v12 offset:3072
    ds_read_b128 v[112:115], v11 offset:62464
    v_mfma_f32_16x16x32_bf16 v[180:183], v[120:123], a[228:231], v[180:183]
    s_add_u32 s22, s4, 1
    ds_read_b128 v[116:119], v12 offset:4096
    v_lshrrev_b32 v19, 4, v1
    v_mfma_f32_16x16x32_bf16 v[180:183], v[124:127], a[236:239], v[180:183]
    s_mul_i32 s70, s4, 3072
    ds_read_b128 v[120:123], v11 offset:63488
    v_min_u32 v19, 2, v19
    v_mfma_f32_16x16x32_bf16 v[184:187], v[128:131], a[224:227], v[184:187]
    s_lshl_b32 s22, s22, 15
    buffer_load_dwordx4 v1, s[56:59], s64 offen offset:1024 sc1 lds
    v_mfma_f32_16x16x32_bf16 v[184:187], v[132:135], a[232:235], v[184:187]
    s_add_u32 s64, s64, 36864
    ds_read_b128 v[124:127], v12 offset:5120
    v_lshl_add_u32 v19, v19, 3, s23
    v_mfma_f32_16x16x32_bf16 v[188:191], v[128:131], a[228:231], v[188:191]
    s_add_u32 m0, s67, 122880
    ds_read_b128 v[128:131], v12 offset:6144
    v_bfe_u32 v20, v1, 4, 4
    v_mfma_f32_16x16x32_bf16 v[188:191], v[132:135], a[236:239], v[188:191]
    s_lshl2_add_u32 s23, s62, s4
    ds_read_b128 v[132:135], v12 offset:13312
    v_lshrrev_b32 v21, 8, v1
    v_mfma_f32_16x16x32_bf16 v[192:195], v[136:139], a[224:227], v[192:195]
    s_lshl_b32 s23, s23, 5
    buffer_load_dwordx4 v1, s[56:59], s64 offen sc1 lds
    v_mfma_f32_16x16x32_bf16 v[192:195], v[140:143], a[232:235], v[192:195]
    s_lshl_b32 s66, s6, 12
    v_add_u32 v20, s23, v20
    v_mul_u32_u24 v20, 1152, v20
    v_mfma_f32_16x16x32_bf16 v[196:199], v[136:139], a[228:231], v[196:199]
    s_mul_i32 s23, s101, 288
    ds_read_b128 v[136:139], v12 offset:7168
    v_and_b32 v19, 31, v19
    v_mfma_f32_16x16x32_bf16 v[196:199], v[140:143], a[236:239], v[196:199]
    s_add_u32 s23, s23, s70
    ds_read_b128 v[140:143], v12 offset:14336
    v_lshl_add_u32 v20, v21, 3, v20
    v_mfma_f32_16x16x32_bf16 v[200:203], v[144:147], a[224:227], v[200:203]
    s_lshr_b32 s65, s20, 5
    buffer_load_dwordx4 v1, s[56:59], s64 offen offset:1024 sc1 lds
    v_mfma_f32_16x16x32_bf16 v[200:203], v[148:151], a[232:235], v[200:203]
    s_add_u32 s64, s64, 36864
    v_mov_b32 v31, 2
    v_lshlrev_b32 v23, 20, v1
    v_mfma_f32_16x16x32_bf16 v[204:207], v[144:147], a[228:231], v[204:207]
    s_add_u32 s66, s66, s22
    ds_read_b128 v[144:147], v12 offset:8192
    v_lshlrev_b32 v19, 7, v19
    v_mfma_f32_16x16x32_bf16 v[204:207], v[148:151], a[236:239], v[204:207]
    s_add_u32 s22, s22, s101
    ds_read_b128 v[148:151], v12 offset:15360
    v_add_u32 v21, 18432, v20
    s_waitcnt lgkmcnt(3)
    v_mfma_f32_16x16x32_bf16 v[208:211], v[104:107], a[224:227], v[208:211]
    buffer_load_dwordx4 v[64:67], v4, s[40:43], s63 offen offset:0 sc1
    v_mfma_f32_16x16x32_bf16 v[208:211], v[108:111], a[232:235], v[208:211]
    s_cmp_eq_u32 s4, s61
    s_cselect_b32 s65, s65, 1073741824
    s_cselect_b32 s70, s23, 1073741824
    v_mfma_f32_16x16x32_bf16 v[212:215], v[104:107], a[228:231], v[212:215]
    s_add_u32 s98, s70, 0
    ds_read_b128 v[104:107], v12 offset:9216
    v_mfma_f32_16x16x32_bf16 v[212:215], v[108:111], a[236:239], v[212:215]
    ds_read_b128 v[108:111], v12 offset:16384
    v_mfma_f32_16x16x32_bf16 v[216:219], v[112:115], a[224:227], v[216:219]
    buffer_load_dwordx4 v[68:71], v5, s[40:43], s63 offen offset:0 sc1
    v_mfma_f32_16x16x32_bf16 v[216:219], v[116:119], a[232:235], v[216:219]
    v_mfma_f32_16x16x32_bf16 v[220:223], v[112:115], a[228:231], v[220:223]
    ds_read_b128 v[112:115], v12 offset:10240
    v_mfma_f32_16x16x32_bf16 v[220:223], v[116:119], a[236:239], v[220:223]
    ds_read_b128 v[116:119], v12 offset:17408
    v_mfma_f32_16x16x32_bf16 v[224:227], v[120:123], a[224:227], v[224:227]
    buffer_load_dwordx4 v[72:75], v4, s[40:43], s63 offen offset:1024 sc1
    v_mfma_f32_16x16x32_bf16 v[224:227], v[124:127], a[232:235], v[224:227]
    v_mfma_f32_16x16x32_bf16 v[228:231], v[120:123], a[228:231], v[228:231]
    ds_read_b128 v[120:123], v12 offset:11264
    v_mfma_f32_16x16x32_bf16 v[228:231], v[124:127], a[236:239], v[228:231]
    ds_read_b128 v[124:127], v12 offset:18432
    v_mfma_f32_16x16x32_bf16 v[176:179], v[128:131], a[240:243], v[176:179]
    buffer_load_dwordx4 v[76:79], v5, s[40:43], s63 offen offset:1024 sc1
    v_mfma_f32_16x16x32_bf16 v[176:179], v[132:135], a[248:251], v[176:179]
    s_lshr_b32 s64, s4, 1
    s_lshl1_add_u32 s21, s61, s64
    s_mul_i32 s21, s21, 3
    v_mfma_f32_16x16x32_bf16 v[180:183], v[128:131], a[244:247], v[180:183]
    s_add_u32 s21, s21, 128
    s_mul_i32 s21, s21, 36864
    ds_read_b128 v[128:131], v12 offset:12288
    v_mfma_f32_16x16x32_bf16 v[180:183], v[132:135], a[252:255], v[180:183]
    s_add_u32 s21, s21, s16
    s_and_b32 s64, s68, 1024
    ds_read_b128 v[132:135], v12 offset:19456
    v_mfma_f32_16x16x32_bf16 v[184:187], v[136:139], a[240:243], v[184:187]
    s_add_u32 s21, s21, s64
    s_add_u32 m0, s69, 143360
    s_waitcnt lgkmcnt(2)
    v_mfma_f32_16x16x32_bf16 v[184:187], v[140:143], a[248:251], v[184:187]
    s_add_u32 s63, s63, 4096
    buffer_load_dwordx4 v1, s[56:59], s21 offen sc1 lds
    v_mfma_f32_16x16x32_bf16 v[188:191], v[136:139], a[244:247], v[188:191]
    s_add_u32 s21, s21, 36864
    v_mfma_f32_16x16x32_bf16 v[188:191], v[140:143], a[252:255], v[188:191]
    s_add_u32 m0, s69, 144384
    v_mfma_f32_16x16x32_bf16 v[192:195], v[144:147], a[240:243], v[192:195]
    s_lshr_b32 s64, s16, 5
    v_mfma_f32_16x16x32_bf16 v[192:195], v[148:151], a[248:251], v[192:195]
    buffer_load_dwordx4 v1, s[56:59], s21 offen sc1 lds
    v_mfma_f32_16x16x32_bf16 v[196:199], v[144:147], a[244:247], v[196:199]
    s_add_u32 s21, s21, 36864
    v_mfma_f32_16x16x32_bf16 v[196:199], v[148:151], a[252:255], v[196:199]
    s_add_u32 m0, s69, 145408
    v_mfma_f32_16x16x32_bf16 v[200:203], v[104:107], a[240:243], v[200:203]
    v_mfma_f32_16x16x32_bf16 v[200:203], v[108:111], a[248:251], v[200:203]
    buffer_load_dwordx4 v1, s[56:59], s21 offen sc1 lds
    v_mfma_f32_16x16x32_bf16 v[204:207], v[104:107], a[244:247], v[204:207]
    s_add_u32 s21, s21, 36864
    s_add_u32 s21, s4, 0
    v_mfma_f32_16x16x32_bf16 v[204:207], v[108:111], a[252:255], v[204:207]
    s_waitcnt vmcnt(11)
    s_barrier
    s_xor_b32 s21, s21, s3
    v_mfma_f32_16x16x32_bf16 v[208:211], v[112:115], a[240:243], v[208:211]
    s_mul_i32 s21, s21, 147456
    ds_read_b128 v[136:139], v12 offset:20480
    ds_read_b128 v[140:143], v12 offset:27648
    v_mfma_f32_16x16x32_bf16 v[208:211], v[116:119], a[248:251], v[208:211]
    s_add_u32 s21, s21, s16
    s_add_u32 m0, s75, 0
    ds_read_b128 v[144:147], v12 offset:21504
    v_mfma_f32_16x16x32_bf16 v[212:215], v[112:115], a[244:247], v[212:215]
    buffer_load_dwordx4 v1, s[56:59], s21 offen sc1 lds
    v_mfma_f32_16x16x32_bf16 v[212:215], v[116:119], a[252:255], v[212:215]
    ds_read_b128 v[148:151], v12 offset:28672
    ds_read_b128 v[104:107], v12 offset:22528
    v_mfma_f32_16x16x32_bf16 v[216:219], v[120:123], a[240:243], v[216:219]
    ds_read_b128 v[108:111], v12 offset:29696
    v_mfma_f32_16x16x32_bf16 v[216:219], v[124:127], a[248:251], v[216:219]
    buffer_load_dwordx4 v1, s[56:59], s21 offen offset:1024 sc1 lds
    v_mfma_f32_16x16x32_bf16 v[220:223], v[120:123], a[244:247], v[220:223]
    s_add_u32 s21, s21, 36864
    ds_read_b128 v[112:115], v12 offset:23552
    ds_read_b128 v[116:119], v12 offset:30720
    v_mfma_f32_16x16x32_bf16 v[220:223], v[124:127], a[252:255], v[220:223]
    s_add_u32 m0, s75, 2048
    ds_read_b128 v[120:123], v12 offset:24576
    s_waitcnt lgkmcnt(6)
    v_mfma_f32_16x16x32_bf16 v[224:227], v[128:131], a[240:243], v[224:227]
    ds_read_b128 v[124:127], v12 offset:31744
    v_mfma_f32_16x16x32_bf16 v[224:227], v[132:135], a[248:251], v[224:227]
    buffer_load_dwordx4 v1, s[56:59], s21 offen sc1 lds
    v_mfma_f32_16x16x32_bf16 v[228:231], v[128:131], a[244:247], v[228:231]
    ds_read_b128 v[128:131], v12 offset:25600
    v_mfma_f32_16x16x32_bf16 v[228:231], v[132:135], a[252:255], v[228:231]
    ds_read_b128 v[132:135], v12 offset:32768
    v_mfma_f32_16x16x32_bf16 v[176:179], v[136:139], v[32:35], v[176:179]
    v_mfma_f32_16x16x32_bf16 v[176:179], v[140:143], v[40:43], v[176:179]
    buffer_load_dwordx4 v1, s[56:59], s21 offen offset:1024 sc1 lds
    v_mfma_f32_16x16x32_bf16 v[180:183], v[136:139], v[36:39], v[180:183]
    s_add_u32 s21, s21, 36864
    ds_read_b128 v[136:139], v12 offset:26624
    v_mfma_f32_16x16x32_bf16 v[180:183], v[140:143], v[44:47], v[180:183]
    s_add_u32 m0, s75, 4096
    ds_read_b128 v[140:143], v12 offset:33792
    v_mfma_f32_16x16x32_bf16 v[184:187], v[144:147], v[32:35], v[184:187]
    s_waitcnt lgkmcnt(2)
    v_mfma_f32_16x16x32_bf16 v[184:187], v[148:151], v[40:43], v[184:187]
    buffer_load_dwordx4 v1, s[56:59], s21 offen sc1 lds
    v_mfma_f32_16x16x32_bf16 v[188:191], v[144:147], v[36:39], v[188:191]
    ds_read_b128 v[144:147], v12 offset:34816
    v_mfma_f32_16x16x32_bf16 v[188:191], v[148:151], v[44:47], v[188:191]
    ds_read_b128 v[148:151], v12 offset:41984
    v_mfma_f32_16x16x32_bf16 v[192:195], v[104:107], v[32:35], v[192:195]
    v_mfma_f32_16x16x32_bf16 v[192:195], v[108:111], v[40:43], v[192:195]
    v_mfma_f32_16x16x32_bf16 v[196:199], v[104:107], v[36:39], v[196:199]
    buffer_load_dwordx4 v1, s[56:59], s21 offen offset:1024 sc1 lds
    v_mfma_f32_16x16x32_bf16 v[196:199], v[108:111], v[44:47], v[196:199]
    s_add_u32 s21, s21, 36864
    v_mfma_f32_16x16x32_bf16 v[200:203], v[112:115], v[32:35], v[200:203]
    s_add_u32 m0, s75, 6144
    v_mfma_f32_16x16x32_bf16 v[200:203], v[116:119], v[40:43], v[200:203]
    v_mfma_f32_16x16x32_bf16 v[204:207], v[112:115], v[36:39], v[204:207]
    buffer_load_dwordx4 v1, s[56:59], s21 offen sc1 lds
    v_mfma_f32_16x16x32_bf16 v[204:207], v[116:119], v[44:47], v[204:207]
    s_waitcnt vmcnt(10)
    s_barrier
    ds_read_b128 v[104:107], v12 offset:49152
    v_mfma_f32_16x16x32_bf16 v[208:211], v[120:123], v[32:35], v[208:211]
    ds_read_b128 v[108:111], v12 offset:57344
    ds_read_b128 v[112:115], v12 offset:35840
    v_mfma_f32_16x16x32_bf16 v[208:211], v[124:127], v[40:43], v[208:211]
    ds_read_b128 v[116:119], v12 offset:43008
    v_mfma_f32_16x16x32_bf16 v[212:215], v[120:123], v[36:39], v[212:215]
    buffer_load_dwordx4 v1, s[56:59], s21 offen offset:1024 sc1 lds
    v_mfma_f32_16x16x32_bf16 v[212:215], v[124:127], v[44:47], v[212:215]
    s_add_u32 s21, s21, 36864
    s_add_u32 s21, s4, 4
    ds_read_b128 v[120:123], v12 offset:50176
    v_mfma_f32_16x16x32_bf16 v[216:219], v[128:131], v[32:35], v[216:219]
    s_xor_b32 s21, s21, s3
    ds_read_b128 v[124:127], v12 offset:58368
    v_mfma_f32_16x16x32_bf16 v[216:219], v[132:135], v[40:43], v[216:219]
    s_mul_i32 s21, s21, 147456
    v_mfma_f32_16x16x32_bf16 v[220:223], v[128:131], v[36:39], v[220:223]
    s_add_u32 s21, s21, s16
    s_add_u32 m0, s75, 32768
    ds_read_b128 v[128:131], v12 offset:36864
    v_mfma_f32_16x16x32_bf16 v[220:223], v[132:135], v[44:47], v[220:223]
    s_waitcnt lgkmcnt(3)
    buffer_load_dwordx4 v1, s[56:59], s21 offen sc1 lds
    v_mfma_f32_16x16x32_bf16 v[224:227], v[136:139], v[32:35], v[224:227]
    ds_read_b128 v[132:135], v12 offset:44032
    v_mfma_f32_16x16x32_bf16 v[224:227], v[140:143], v[40:43], v[224:227]
    v_mfma_f32_16x16x32_bf16 v[228:231], v[136:139], v[36:39], v[228:231]
    buffer_load_dwordx4 v1, s[56:59], s21 offen offset:1024 sc1 lds
    v_mfma_f32_16x16x32_bf16 v[228:231], v[140:143], v[44:47], v[228:231]
    s_add_u32 s21, s21, 36864
    ds_read_b128 v[136:139], v12 offset:51200
    ds_read_b128 v[140:143], v12 offset:59392
    v_mfma_f32_16x16x32_bf16 v[176:179], v[144:147], v[48:51], v[176:179]
    s_add_u32 m0, s75, 34816
    v_mfma_f32_16x16x32_bf16 v[176:179], v[148:151], v[56:59], v[176:179]
    v_mfma_f32_16x16x32_bf16 v[176:179], v[104:107], v[64:67], v[176:179]
    buffer_load_dwordx4 v1, s[56:59], s21 offen sc1 lds
    v_mfma_f32_16x16x32_bf16 v[176:179], v[108:111], v[72:75], v[176:179]
    v_mfma_f32_16x16x32_bf16 v[180:183], v[144:147], v[52:55], v[180:183]
    ds_read_b128 v[144:147], v12 offset:37888
    v_mfma_f32_16x16x32_bf16 v[180:183], v[148:151], v[60:63], v[180:183]
    ds_read_b128 v[148:151], v12 offset:45056
    v_mfma_f32_16x16x32_bf16 v[180:183], v[104:107], v[68:71], v[180:183]
    buffer_load_dwordx4 v1, s[56:59], s21 offen offset:1024 sc1 lds
    v_mfma_f32_16x16x32_bf16 v[180:183], v[108:111], v[76:79], v[180:183]
    s_add_u32 s21, s21, 36864
    v_cvt_pk_bf16_f32 v232, v176, v177
    v_cvt_pk_bf16_f32 v233, v178, v179
    v_mfma_f32_16x16x32_bf16 v[184:187], v[112:115], v[48:51], v[184:187]
    s_add_u32 m0, s75, 36864
    ds_read_b128 v[104:107], v12 offset:52224
    ds_read_b128 v[108:111], v12 offset:60416
    v_mfma_f32_16x16x32_bf16 v[184:187], v[116:119], v[56:59], v[184:187]
    s_waitcnt lgkmcnt(3)
    v_cvt_pk_bf16_f32 v234, v180, v181
    v_cvt_pk_bf16_f32 v235, v182, v183
    v_mfma_f32_16x16x32_bf16 v[184:187], v[120:123], v[64:67], v[184:187]
    buffer_load_dwordx4 v1, s[56:59], s21 offen sc1 lds
    v_mfma_f32_16x16x32_bf16 v[184:187], v[124:127], v[72:75], v[184:187]
    buffer_store_dwordx4 v[232:235], v1, s[48:51], s8 offen offset:0 sc1
    v_mfma_f32_16x16x32_bf16 v[188:191], v[112:115], v[52:55], v[188:191]
    ds_read_b128 v[112:115], v12 offset:38912
    v_mfma_f32_16x16x32_bf16 v[188:191], v[116:119], v[60:63], v[188:191]
    ds_read_b128 v[116:119], v12 offset:46080
    v_mfma_f32_16x16x32_bf16 v[188:191], v[120:123], v[68:71], v[188:191]
    ds_read_b128 v[120:123], v12 offset:53248
    v_mfma_f32_16x16x32_bf16 v[188:191], v[124:127], v[76:79], v[188:191]
    buffer_load_dwordx4 v1, s[56:59], s21 offen offset:1024 sc1 lds
    v_mfma_f32_16x16x32_bf16 v[192:195], v[128:131], v[48:51], v[192:195]
    s_add_u32 s21, s21, 36864
    v_cvt_pk_bf16_f32 v236, v184, v185
    v_cvt_pk_bf16_f32 v237, v186, v187
    v_mfma_f32_16x16x32_bf16 v[192:195], v[132:135], v[56:59], v[192:195]
    s_add_u32 m0, s75, 38912
    ds_read_b128 v[124:127], v12 offset:61440
    v_cvt_pk_bf16_f32 v238, v188, v189
    v_mfma_f32_16x16x32_bf16 v[192:195], v[136:139], v[64:67], v[192:195]
    v_cvt_pk_bf16_f32 v239, v190, v191
    v_mfma_f32_16x16x32_bf16 v[192:195], v[140:143], v[72:75], v[192:195]
    buffer_load_dwordx4 v1, s[56:59], s21 offen sc1 lds
    v_mfma_f32_16x16x32_bf16 v[196:199], v[128:131], v[52:55], v[196:199]
    ds_read_b128 v[128:131], v12 offset:39936
    v_mfma_f32_16x16x32_bf16 v[196:199], v[132:135], v[60:63], v[196:199]
    ds_read_b128 v[132:135], v12 offset:47104
    v_mfma_f32_16x16x32_bf16 v[196:199], v[136:139], v[68:71], v[196:199]
    ds_read_b128 v[136:139], v12 offset:54272
    v_mfma_f32_16x16x32_bf16 v[196:199], v[140:143], v[76:79], v[196:199]
    buffer_store_dwordx4 v[236:239], v1, s[48:51], s8 offen offset:1024 sc1
    v_mfma_f32_16x16x32_bf16 v[200:203], v[144:147], v[48:51], v[200:203]
    s_waitcnt lgkmcnt(3)
    v_cvt_pk_bf16_f32 v240, v192, v193
    v_cvt_pk_bf16_f32 v241, v194, v195
    v_mfma_f32_16x16x32_bf16 v[200:203], v[148:151], v[56:59], v[200:203]
    ds_read_b128 v[140:143], v12 offset:62464
    v_mfma_f32_16x16x32_bf16 v[200:203], v[104:107], v[64:67], v[200:203]
    v_mfma_f32_16x16x32_bf16 v[200:203], v[108:111], v[72:75], v[200:203]
    buffer_load_dwordx4 v1, s[56:59], s21 offen offset:1024 sc1 lds
    v_mfma_f32_16x16x32_bf16 v[204:207], v[144:147], v[52:55], v[204:207]
    s_add_u32 s21, s21, 36864
    v_cvt_pk_bf16_f32 v242, v196, v197
    v_cvt_pk_bf16_f32 v243, v198, v199
    v_mfma_f32_16x16x32_bf16 v[204:207], v[148:151], v[60:63], v[204:207]
    ds_read_b128 v[144:147], v12 offset:40960
    ds_read_b128 v[148:151], v12 offset:48128
    v_mfma_f32_16x16x32_bf16 v[204:207], v[104:107], v[68:71], v[204:207]
    v_cvt_pk_bf16_f32 v244, v200, v201
    v_cvt_pk_bf16_f32 v245, v202, v203
    v_mfma_f32_16x16x32_bf16 v[204:207], v[108:111], v[76:79], v[204:207]
    buffer_store_dwordx4 v[240:243], v1, s[48:51], s9 offen offset:0 sc1
    v_mfma_f32_16x16x32_bf16 v[208:211], v[112:115], v[48:51], v[208:211]
    ds_read_b128 v[104:107], v12 offset:55296
    ds_read_b128 v[108:111], v12 offset:63488
    v_mfma_f32_16x16x32_bf16 v[208:211], v[116:119], v[56:59], v[208:211]
    v_mfma_f32_16x16x32_bf16 v[208:211], v[120:123], v[64:67], v[208:211]
    v_mfma_f32_16x16x32_bf16 v[208:211], v[124:127], v[72:75], v[208:211]
    v_mfma_f32_16x16x32_bf16 v[212:215], v[112:115], v[52:55], v[212:215]
    v_cvt_pk_bf16_f32 v246, v204, v205
    v_cvt_pk_bf16_f32 v247, v206, v207
    v_mfma_f32_16x16x32_bf16 v[212:215], v[116:119], v[60:63], v[212:215]
    buffer_store_dwordx4 v[244:247], v1, s[48:51], s9 offen offset:1024 sc1
    v_mfma_f32_16x16x32_bf16 v[212:215], v[120:123], v[68:71], v[212:215]
    v_mfma_f32_16x16x32_bf16 v[212:215], v[124:127], v[76:79], v[212:215]
    s_waitcnt lgkmcnt(0)
    v_mfma_f32_16x16x32_bf16 v[216:219], v[128:131], v[48:51], v[216:219]
    v_cvt_pk_bf16_f32 v232, v208, v209
    v_cvt_pk_bf16_f32 v233, v210, v211
    v_mfma_f32_16x16x32_bf16 v[216:219], v[132:135], v[56:59], v[216:219]
    v_mfma_f32_16x16x32_bf16 v[216:219], v[136:139], v[64:67], v[216:219]
    v_mfma_f32_16x16x32_bf16 v[216:219], v[140:143], v[72:75], v[216:219]
    s_waitcnt vmcnt(12)
    s_barrier
    v_cvt_pk_bf16_f32 v234, v212, v213
    v_mfma_f32_16x16x32_bf16 v[220:223], v[128:131], v[52:55], v[220:223]
    v_cvt_pk_bf16_f32 v235, v214, v215
    ds_read_b128 v[112:115], v11 offset:0
    v_mfma_f32_16x16x32_bf16 v[220:223], v[132:135], v[60:63], v[220:223]
    buffer_store_dwordx4 v[232:235], v1, s[48:51], s10 offen offset:0 sc1
    v_mfma_f32_16x16x32_bf16 v[220:223], v[136:139], v[68:71], v[220:223]
    ds_read_b128 v[116:119], v11 offset:2048
    ds_read_b128 v[120:123], v11 offset:4096
    v_mfma_f32_16x16x32_bf16 v[220:223], v[140:143], v[76:79], v[220:223]
    ds_read_b128 v[124:127], v11 offset:6144
    v_cvt_pk_bf16_f32 v236, v216, v217
    v_mfma_f32_16x16x32_bf16 v[224:227], v[144:147], v[48:51], v[224:227]
    v_cvt_pk_bf16_f32 v237, v218, v219
    ds_read_b128 v[128:131], v11 offset:1024
    v_mfma_f32_16x16x32_bf16 v[224:227], v[148:151], v[56:59], v[224:227]
    ds_read_b128 v[132:135], v11 offset:3072
    v_mfma_f32_16x16x32_bf16 v[224:227], v[104:107], v[64:67], v[224:227]
    v_cvt_pk_bf16_f32 v238, v220, v221
    v_cvt_pk_bf16_f32 v239, v222, v223
    v_mfma_f32_16x16x32_bf16 v[224:227], v[108:111], v[72:75], v[224:227]
    buffer_store_dwordx4 v[236:239], v1, s[48:51], s10 offen offset:1024 sc1
    v_mfma_f32_16x16x32_bf16 v[228:231], v[144:147], v[52:55], v[228:231]
    ds_read_b128 v[136:139], v11 offset:5120
    ds_read_b128 v[140:143], v11 offset:7168
    v_mfma_f32_16x16x32_bf16 v[228:231], v[148:151], v[60:63], v[228:231]
    ds_read_b128 v[144:147], v11 offset:8192
    v_mfma_f32_16x16x32_bf16 v[228:231], v[104:107], v[68:71], v[228:231]
    ds_read_b128 v[148:151], v11 offset:10240
    v_cvt_pk_bf16_f32 v240, v224, v225
    v_mfma_f32_16x16x32_bf16 v[228:231], v[108:111], v[76:79], v[228:231]
    s_waitcnt lgkmcnt(4)
    v_cvt_pk_bf16_f32 v241, v226, v227
    ds_read_b128 v[104:107], v11 offset:12288
    v_mfma_f32_16x16x32_bf16 v[160:163], v[112:115], a[0:3], 0
    ds_read_b128 v[108:111], v11 offset:14336
    v_mfma_f32_16x16x32_bf16 v[160:163], v[116:119], a[8:11], v[160:163]
    v_mfma_f32_16x16x32_bf16 v[160:163], v[120:123], a[16:19], v[160:163]
    v_mfma_f32_16x16x32_bf16 v[160:163], v[124:127], a[24:27], v[160:163]
    v_mfma_f32_16x16x32_bf16 v[164:167], v[112:115], a[4:7], 0
    v_cvt_pk_bf16_f32 v242, v228, v229
    v_cvt_pk_bf16_f32 v243, v230, v231
    v_mfma_f32_16x16x32_bf16 v[164:167], v[116:119], a[12:15], v[164:167]
    buffer_store_dwordx4 v[240:243], v1, s[48:51], s11 offen offset:2048 sc1
    v_mfma_f32_16x16x32_bf16 v[164:167], v[120:123], a[20:23], v[164:167]
    ds_read_b128 v[112:115], v11 offset:9216
    ds_read_b128 v[116:119], v11 offset:11264
    v_mfma_f32_16x16x32_bf16 v[164:167], v[124:127], a[28:31], v[164:167]
    ds_read_b128 v[120:123], v11 offset:13312
    v_mfma_f32_16x16x32_bf16 v[168:171], v[128:131], a[0:3], 0
    ds_read_b128 v[124:127], v11 offset:15360
    v_mfma_f32_16x16x32_bf16 v[168:171], v[132:135], a[8:11], v[168:171]
    s_waitcnt lgkmcnt(4)
    v_mfma_f32_16x16x32_bf16 v[168:171], v[136:139], a[16:19], v[168:171]
    v_mfma_f32_16x16x32_bf16 v[168:171], v[140:143], a[24:27], v[168:171]
    v_mfma_f32_16x16x32_bf16 v[172:175], v[128:131], a[4:7], 0
    ds_read_b128 v[128:131], v11 offset:16384
    v_mfma_f32_16x16x32_bf16 v[172:175], v[132:135], a[12:15], v[172:175]
    ds_read_b128 v[132:135], v11 offset:18432
    v_mfma_f32_16x16x32_bf16 v[172:175], v[136:139], a[20:23], v[172:175]
    ds_read_b128 v[136:139], v11 offset:20480
    v_mfma_f32_16x16x32_bf16 v[172:175], v[140:143], a[28:31], v[172:175]
    ds_read_b128 v[140:143], v11 offset:22528
    v_mfma_f32_16x16x32_bf16 v[160:163], v[144:147], a[32:35], v[160:163]
    v_mfma_f32_16x16x32_bf16 v[160:163], v[148:151], a[40:43], v[160:163]
    v_mfma_f32_16x16x32_bf16 v[160:163], v[104:107], a[48:51], v[160:163]
    v_mfma_f32_16x16x32_bf16 v[160:163], v[108:111], a[56:59], v[160:163]
    v_mfma_f32_16x16x32_bf16 v[164:167], v[144:147], a[36:39], v[164:167]
    ds_read_b128 v[144:147], v11 offset:17408
    v_mfma_f32_16x16x32_bf16 v[164:167], v[148:151], a[44:47], v[164:167]
    ds_read_b128 v[148:151], v11 offset:19456
    v_mfma_f32_16x16x32_bf16 v[164:167], v[104:107], a[52:55], v[164:167]
    ds_read_b128 v[104:107], v11 offset:21504
    v_mfma_f32_16x16x32_bf16 v[164:167], v[108:111], a[60:63], v[164:167]
    s_waitcnt lgkmcnt(3)
    ds_read_b128 v[108:111], v11 offset:23552
    v_mfma_f32_16x16x32_bf16 v[168:171], v[112:115], a[32:35], v[168:171]
    v_mfma_f32_16x16x32_bf16 v[168:171], v[116:119], a[40:43], v[168:171]
    v_mfma_f32_16x16x32_bf16 v[168:171], v[120:123], a[48:51], v[168:171]
    v_mfma_f32_16x16x32_bf16 v[168:171], v[124:127], a[56:59], v[168:171]
    v_mfma_f32_16x16x32_bf16 v[172:175], v[112:115], a[36:39], v[172:175]
    ds_read_b128 v[112:115], v11 offset:24576
    v_mfma_f32_16x16x32_bf16 v[172:175], v[116:119], a[44:47], v[172:175]
    ds_read_b128 v[116:119], v11 offset:26624
    v_mfma_f32_16x16x32_bf16 v[172:175], v[120:123], a[52:55], v[172:175]
    ds_read_b128 v[120:123], v11 offset:28672
    v_mfma_f32_16x16x32_bf16 v[172:175], v[124:127], a[60:63], v[172:175]
    ds_read_b128 v[124:127], v11 offset:30720
    v_mfma_f32_16x16x32_bf16 v[160:163], v[128:131], a[64:67], v[160:163]
    v_mfma_f32_16x16x32_bf16 v[160:163], v[132:135], a[72:75], v[160:163]
    v_mfma_f32_16x16x32_bf16 v[160:163], v[136:139], a[80:83], v[160:163]
    v_mfma_f32_16x16x32_bf16 v[160:163], v[140:143], a[88:91], v[160:163]
    v_mfma_f32_16x16x32_bf16 v[164:167], v[128:131], a[68:71], v[164:167]
    ds_read_b128 v[128:131], v11 offset:25600
    v_mfma_f32_16x16x32_bf16 v[164:167], v[132:135], a[76:79], v[164:167]
    ds_read_b128 v[132:135], v11 offset:27648
    v_mfma_f32_16x16x32_bf16 v[164:167], v[136:139], a[84:87], v[164:167]
    ds_read_b128 v[136:139], v11 offset:29696
    v_mfma_f32_16x16x32_bf16 v[164:167], v[140:143], a[92:95], v[164:167]
    s_waitcnt lgkmcnt(3)
    ds_read_b128 v[140:143], v11 offset:31744
    v_mfma_f32_16x16x32_bf16 v[168:171], v[144:147], a[64:67], v[168:171]
    v_mfma_f32_16x16x32_bf16 v[168:171], v[148:151], a[72:75], v[168:171]
    v_mfma_f32_16x16x32_bf16 v[168:171], v[104:107], a[80:83], v[168:171]
    v_mfma_f32_16x16x32_bf16 v[168:171], v[108:111], a[88:91], v[168:171]
    v_mfma_f32_16x16x32_bf16 v[172:175], v[144:147], a[68:71], v[172:175]
    v_mfma_f32_16x16x32_bf16 v[172:175], v[148:151], a[76:79], v[172:175]
    v_mfma_f32_16x16x32_bf16 v[172:175], v[104:107], a[84:87], v[172:175]
    v_mfma_f32_16x16x32_bf16 v[172:175], v[108:111], a[92:95], v[172:175]
    v_mfma_f32_16x16x32_bf16 v[160:163], v[112:115], a[96:99], v[160:163]
    v_mfma_f32_16x16x32_bf16 v[160:163], v[116:119], a[104:107], v[160:163]
    v_mfma_f32_16x16x32_bf16 v[160:163], v[120:123], a[112:115], v[160:163]
    s_waitcnt vmcnt(0)
    buffer_store_dword v31, v23, s[32:35], s22 offen sc1
    v_mfma_f32_16x16x32_bf16 v[160:163], v[124:127], a[120:123], v[160:163]
    s_waitcnt vmcnt(6)
    s_barrier
    ds_read_b128 v[144:147], v11 offset:32768
    v_mfma_f32_16x16x32_bf16 v[164:167], v[112:115], a[100:103], v[164:167]
    ds_read_b128 v[148:151], v11 offset:34816
    ds_read_b128 v[104:107], v11 offset:36864
    v_mfma_f32_16x16x32_bf16 v[164:167], v[116:119], a[108:111], v[164:167]
    ds_read_b128 v[108:111], v11 offset:38912
    v_mfma_f32_16x16x32_bf16 v[164:167], v[120:123], a[116:119], v[164:167]
    ds_read_b128 v[112:115], v11 offset:33792
    v_mfma_f32_16x16x32_bf16 v[164:167], v[124:127], a[124:127], v[164:167]
    s_waitcnt lgkmcnt(5)
    ds_read_b128 v[116:119], v11 offset:35840
    v_mfma_f32_16x16x32_bf16 v[168:171], v[128:131], a[96:99], v[168:171]
    ds_read_b128 v[120:123], v11 offset:37888
    v_mfma_f32_16x16x32_bf16 v[168:171], v[132:135], a[104:107], v[168:171]
    ds_read_b128 v[124:127], v11 offset:39936
    v_mfma_f32_16x16x32_bf16 v[168:171], v[136:139], a[112:115], v[168:171]
    v_mfma_f32_16x16x32_bf16 v[168:171], v[140:143], a[120:123], v[168:171]
    v_mfma_f32_16x16x32_bf16 v[172:175], v[128:131], a[100:103], v[172:175]
    ds_read_b128 v[128:131], v11 offset:40960
    v_mfma_f32_16x16x32_bf16 v[172:175], v[132:135], a[108:111], v[172:175]
    ds_read_b128 v[132:135], v11 offset:43008
    v_mfma_f32_16x16x32_bf16 v[172:175], v[136:139], a[116:119], v[172:175]
    ds_read_b128 v[136:139], v11 offset:45056
    v_mfma_f32_16x16x32_bf16 v[172:175], v[140:143], a[124:127], v[172:175]
    s_waitcnt lgkmcnt(3)
    ds_read_b128 v[140:143], v11 offset:47104
    v_mfma_f32_16x16x32_bf16 v[160:163], v[144:147], a[128:131], v[160:163]
    v_mfma_f32_16x16x32_bf16 v[160:163], v[148:151], a[136:139], v[160:163]
    v_mfma_f32_16x16x32_bf16 v[160:163], v[104:107], a[144:147], v[160:163]
    v_mfma_f32_16x16x32_bf16 v[160:163], v[108:111], a[152:155], v[160:163]
    v_mfma_f32_16x16x32_bf16 v[164:167], v[144:147], a[132:135], v[164:167]
    ds_read_b128 v[144:147], v11 offset:41984
    v_mfma_f32_16x16x32_bf16 v[164:167], v[148:151], a[140:143], v[164:167]
    ds_read_b128 v[148:151], v11 offset:44032
    v_mfma_f32_16x16x32_bf16 v[164:167], v[104:107], a[148:151], v[164:167]
    ds_read_b128 v[104:107], v11 offset:46080
    v_mfma_f32_16x16x32_bf16 v[164:167], v[108:111], a[156:159], v[164:167]
    ds_read_b128 v[108:111], v11 offset:48128
    v_mfma_f32_16x16x32_bf16 v[168:171], v[112:115], a[128:131], v[168:171]
    v_mfma_f32_16x16x32_bf16 v[168:171], v[116:119], a[136:139], v[168:171]
    v_mfma_f32_16x16x32_bf16 v[168:171], v[120:123], a[144:147], v[168:171]
    v_mfma_f32_16x16x32_bf16 v[168:171], v[124:127], a[152:155], v[168:171]
    v_mfma_f32_16x16x32_bf16 v[172:175], v[112:115], a[132:135], v[172:175]
    ds_read_b128 v[112:115], v11 offset:49152
    v_mfma_f32_16x16x32_bf16 v[172:175], v[116:119], a[140:143], v[172:175]
    ds_read_b128 v[116:119], v11 offset:51200
    v_mfma_f32_16x16x32_bf16 v[172:175], v[120:123], a[148:151], v[172:175]
    ds_read_b128 v[120:123], v11 offset:53248
    v_mfma_f32_16x16x32_bf16 v[172:175], v[124:127], a[156:159], v[172:175]
    s_waitcnt lgkmcnt(3)
    ds_read_b128 v[124:127], v11 offset:55296
    v_mfma_f32_16x16x32_bf16 v[160:163], v[128:131], a[160:163], v[160:163]
    v_mfma_f32_16x16x32_bf16 v[160:163], v[132:135], a[168:171], v[160:163]
    v_mfma_f32_16x16x32_bf16 v[160:163], v[136:139], a[176:179], v[160:163]
    v_mfma_f32_16x16x32_bf16 v[160:163], v[140:143], a[184:187], v[160:163]
    v_mfma_f32_16x16x32_bf16 v[164:167], v[128:131], a[164:167], v[164:167]
    ds_read_b128 v[128:131], v11 offset:50176
    v_mfma_f32_16x16x32_bf16 v[164:167], v[132:135], a[172:175], v[164:167]
    buffer_load_dword v3, v19, s[32:35], s66 offen sc1
    v_mfma_f32_16x16x32_bf16 v[164:167], v[136:139], a[180:183], v[164:167]
    ds_read_b128 v[132:135], v11 offset:52224
    ds_read_b128 v[136:139], v11 offset:54272
    v_mfma_f32_16x16x32_bf16 v[164:167], v[140:143], a[188:191], v[164:167]
    ds_read_b128 v[140:143], v11 offset:56320
    v_mfma_f32_16x16x32_bf16 v[168:171], v[144:147], a[160:163], v[168:171]
    v_mfma_f32_16x16x32_bf16 v[168:171], v[148:151], a[168:171], v[168:171]
    v_mfma_f32_16x16x32_bf16 v[168:171], v[104:107], a[176:179], v[168:171]
    v_mfma_f32_16x16x32_bf16 v[168:171], v[108:111], a[184:187], v[168:171]
    v_mfma_f32_16x16x32_bf16 v[172:175], v[144:147], a[164:167], v[172:175]
    ds_read_b128 v[144:147], v11 offset:57344
    v_mfma_f32_16x16x32_bf16 v[172:175], v[148:151], a[172:175], v[172:175]
    ds_read_b128 v[148:151], v11 offset:59392
    v_mfma_f32_16x16x32_bf16 v[172:175], v[104:107], a[180:183], v[172:175]
    ds_read_b128 v[104:107], v11 offset:61440
    v_mfma_f32_16x16x32_bf16 v[172:175], v[108:111], a[188:191], v[172:175]
    s_waitcnt lgkmcnt(3)
    ds_read_b128 v[108:111], v11 offset:63488
    v_mfma_f32_16x16x32_bf16 v[160:163], v[112:115], a[192:195], v[160:163]
    v_mfma_f32_16x16x32_bf16 v[160:163], v[116:119], a[200:203], v[160:163]
    v_mfma_f32_16x16x32_bf16 v[160:163], v[120:123], a[208:211], v[160:163]
    v_mfma_f32_16x16x32_bf16 v[160:163], v[124:127], a[216:219], v[160:163]
    v_mfma_f32_16x16x32_bf16 v[164:167], v[112:115], a[196:199], v[164:167]
    ds_read_b128 v[112:115], v11 offset:58368
    v_mfma_f32_16x16x32_bf16 v[164:167], v[116:119], a[204:207], v[164:167]
    ds_read_b128 v[116:119], v11 offset:60416
    v_mfma_f32_16x16x32_bf16 v[164:167], v[120:123], a[212:215], v[164:167]
    ds_read_b128 v[120:123], v11 offset:62464
    v_mfma_f32_16x16x32_bf16 v[164:167], v[124:127], a[220:223], v[164:167]
    ds_read_b128 v[124:127], v11 offset:64512
    v_mfma_f32_16x16x32_bf16 v[168:171], v[128:131], a[192:195], v[168:171]
    v_mfma_f32_16x16x32_bf16 v[168:171], v[132:135], a[200:203], v[168:171]
    v_mfma_f32_16x16x32_bf16 v[168:171], v[136:139], a[208:211], v[168:171]
    v_mfma_f32_16x16x32_bf16 v[168:171], v[140:143], a[216:219], v[168:171]
    v_mfma_f32_16x16x32_bf16 v[172:175], v[128:131], a[196:199], v[172:175]
    ds_read_b128 v[128:131], v13 offset:12288
    v_mfma_f32_16x16x32_bf16 v[172:175], v[132:135], a[204:207], v[172:175]
    ds_read_b128 v[132:135], v13 offset:13312
    v_mfma_f32_16x16x32_bf16 v[172:175], v[136:139], a[212:215], v[172:175]
    ds_read_b128 v[136:139], v13 offset:14336
    v_mfma_f32_16x16x32_bf16 v[172:175], v[140:143], a[220:223], v[172:175]
    s_waitcnt lgkmcnt(3)
    ds_read_b128 v[140:143], v13 offset:16384
    v_mfma_f32_16x16x32_bf16 v[160:163], v[144:147], a[224:227], v[160:163]
    s_waitcnt vmcnt(0)
    v_cmp_gt_u32 vcc, 2, v3
    s_nop 1
    s_and_b64 vcc, vcc, exec
    s_cbranch_scc1 SPIN_X
BACK_X:
    v_mfma_f32_16x16x32_bf16 v[160:163], v[148:151], a[232:235], v[160:163]
    buffer_load_dwordx4 v[200:203], v1, s[48:51], s98 offen offset:2048 sc1
    v_mfma_f32_16x16x32_bf16 v[160:163], v[104:107], a[240:243], v[160:163]
    s_add_u32 s98, s70, 12288
    buffer_load_dwordx4 v[204:207], v1, s[48:51], s98 offen offset:2048 sc1
    v_mfma_f32_16x16x32_bf16 v[160:163], v[108:111], a[248:251], v[160:163]
    s_add_u32 s98, s70, 24576
    v_mfma_f32_16x16x32_bf16 v[164:167], v[144:147], a[228:231], v[164:167]
    ds_read_b128 v[144:147], v13 offset:17408
    v_mfma_f32_16x16x32_bf16 v[164:167], v[148:151], a[236:239], v[164:167]
    buffer_load_dwordx4 v[208:211], v1, s[48:51], s98 offen offset:2048 sc1
    v_mfma_f32_16x16x32_bf16 v[164:167], v[104:107], a[244:247], v[164:167]
    s_add_u32 s98, s23, 0
    ds_read_b128 v[148:151], v13 offset:18432
    ds_read_b128 v[104:107], v13 offset:20480
    v_mfma_f32_16x16x32_bf16 v[164:167], v[108:111], a[252:255], v[164:167]
    ds_read_b128 v[108:111], v13 offset:21504
    v_mfma_f32_16x16x32_bf16 v[168:171], v[112:115], a[224:227], v[168:171]
    v_mfma_f32_16x16x32_bf16 v[168:171], v[116:119], a[232:235], v[168:171]
    buffer_load_dwordx4 v[176:179], v1, s[48:51], s98 offen offset:0 sc1
    v_mfma_f32_16x16x32_bf16 v[168:171], v[120:123], a[240:243], v[168:171]
    s_add_u32 s98, s23, 12288
    v_mfma_f32_16x16x32_bf16 v[168:171], v[124:127], a[248:251], v[168:171]
    v_mfma_f32_16x16x32_bf16 v[172:175], v[112:115], a[228:231], v[172:175]
    ds_read_b128 v[112:115], v13 offset:22528
    v_mfma_f32_16x16x32_bf16 v[172:175], v[116:119], a[236:239], v[172:175]
    buffer_load_dwordx4 v[180:183], v1, s[48:51], s98 offen offset:0 sc1
    v_mfma_f32_16x16x32_bf16 v[172:175], v[120:123], a[244:247], v[172:175]
    s_add_u32 s98, s23, 24576
    ds_read_b128 v[116:119], v13 offset:24576
    ds_read_b128 v[120:123], v13 offset:25600
    v_mfma_f32_16x16x32_bf16 v[172:175], v[124:127], a[252:255], v[172:175]
    s_waitcnt lgkmcnt(3)
    ds_read_b128 v[124:127], v13 offset:26624
    v_mfma_f32_16x16x32_bf16 v[160:163], v[128:131], v[32:35], v[160:163]
    v_mfma_f32_16x16x32_bf16 v[160:163], v[132:135], v[40:43], v[160:163]
    buffer_load_dwordx4 v[184:187], v1, s[48:51], s98 offen offset:0 sc1
    v_mfma_f32_16x16x32_bf16 v[160:163], v[136:139], v[48:51], v[160:163]
    s_add_u32 s98, s23, 0
    v_mfma_f32_16x16x32_bf16 v[164:167], v[128:131], v[36:39], v[164:167]
    v_mfma_f32_16x16x32_bf16 v[164:167], v[132:135], v[44:47], v[164:167]
    v_mfma_f32_16x16x32_bf16 v[164:167], v[136:139], v[52:55], v[164:167]
    buffer_load_dwordx4 v[188:191], v1, s[48:51], s98 offen offset:1024 sc1
    v_mfma_f32_16x16x32_bf16 v[168:171], v[140:143], v[32:35], v[168:171]
    s_add_u32 s98, s23, 12288
    v_mfma_f32_16x16x32_bf16 v[168:171], v[144:147], v[40:43], v[168:171]
    v_mfma_f32_16x16x32_bf16 v[168:171], v[148:151], v[48:51], v[168:171]
    v_mfma_f32_16x16x32_bf16 v[172:175], v[140:143], v[36:39], v[172:175]
    buffer_load_dwordx4 v[192:195], v1, s[48:51], s98 offen offset:1024 sc1
    v_mfma_f32_16x16x32_bf16 v[172:175], v[144:147], v[44:47], v[172:175]
    s_add_u32 s98, s23, 24576
    v_mfma_f32_16x16x32_bf16 v[172:175], v[148:151], v[52:55], v[172:175]
    v_mfma_f32_16x16x32_bf16 v[160:163], v[104:107], v[56:59], v[160:163]
    v_mfma_f32_16x16x32_bf16 v[160:163], v[108:111], v[64:67], v[160:163]
    s_waitcnt lgkmcnt(0)
    buffer_load_dwordx4 v[196:199], v1, s[48:51], s98 offen offset:1024 sc1
    v_mfma_f32_16x16x32_bf16 v[160:163], v[112:115], v[72:75], v[160:163]
    v_mfma_f32_16x16x32_bf16 v[164:167], v[104:107], v[60:63], v[164:167]
    v_mfma_f32_16x16x32_bf16 v[164:167], v[108:111], v[68:71], v[164:167]
    v_mfma_f32_16x16x32_bf16 v[164:167], v[112:115], v[76:79], v[164:167]
    v_mfma_f32_16x16x32_bf16 v[168:171], v[116:119], v[56:59], v[168:171]
    v_mfma_f32_16x16x32_bf16 v[168:171], v[120:123], v[64:67], v[168:171]
    v_mfma_f32_16x16x32_bf16 v[168:171], v[124:127], v[72:75], v[168:171]
    v_mfma_f32_16x16x32_bf16 v[172:175], v[116:119], v[60:63], v[172:175]
    v_mfma_f32_16x16x32_bf16 v[172:175], v[120:123], v[68:71], v[172:175]
    v_mfma_f32_16x16x32_bf16 v[172:175], v[124:127], v[76:79], v[172:175]
    s_cmp_lg_u32 s4, s61
    s_cbranch_scc1 K1_X2
    s_waitcnt vmcnt(6)
    v_lshlrev_b32 v80, 16, v200
    v_and_b32 v81, 0xffff0000, v200
    v_lshlrev_b32 v82, 16, v204
    v_and_b32 v83, 0xffff0000, v204
    v_lshlrev_b32 v84, 16, v208
    v_and_b32 v85, 0xffff0000, v208
    v_pk_add_f32 v[80:81], v[80:81], v[82:83]
    v_pk_add_f32 v[224:225], v[224:225], v[84:85]
    v_pk_add_f32 v[224:225], v[224:225], v[80:81]
    v_cvt_pk_bf16_f32 v200, v224, v225
    v_lshlrev_b32 v86, 16, v201
    v_and_b32 v87, 0xffff0000, v201
    v_lshlrev_b32 v88, 16, v205
    v_and_b32 v89, 0xffff0000, v205
    v_lshlrev_b32 v90, 16, v209
    v_and_b32 v91, 0xffff0000, v209
    v_pk_add_f32 v[86:87], v[86:87], v[88:89]
    v_pk_add_f32 v[226:227], v[226:227], v[90:91]
    v_pk_add_f32 v[226:227], v[226:227], v[86:87]
    v_cvt_pk_bf16_f32 v201, v226, v227
    buffer_store_dwordx2 v[200:201], v20, s[24:27], s65 offen
    v_lshlrev_b32 v92, 16, v202
    v_and_b32 v93, 0xffff0000, v202
    v_lshlrev_b32 v94, 16, v206
    v_and_b32 v95, 0xffff0000, v206
    v_lshlrev_b32 v96, 16, v210
    v_and_b32 v97, 0xffff0000, v210
    v_pk_add_f32 v[92:93], v[92:93], v[94:95]
    v_pk_add_f32 v[228:229], v[228:229], v[96:97]
    v_pk_add_f32 v[228:229], v[228:229], v[92:93]
    v_cvt_pk_bf16_f32 v202, v228, v229
    v_lshlrev_b32 v98, 16, v203
    v_and_b32 v99, 0xffff0000, v203
    v_lshlrev_b32 v100, 16, v207
    v_and_b32 v101, 0xffff0000, v207
    v_lshlrev_b32 v102, 16, v211
    v_and_b32 v103, 0xffff0000, v211
    v_pk_add_f32 v[98:99], v[98:99], v[100:101]
    v_pk_add_f32 v[230:231], v[230:231], v[102:103]
    v_pk_add_f32 v[230:231], v[230:231], v[98:99]
    v_cvt_pk_bf16_f32 v203, v230, v231
    buffer_store_dwordx2 v[202:203], v21, s[24:27], s65 offen
    s_waitcnt vmcnt(2)
K1_X2:
    s_waitcnt vmcnt(3)
    v_lshlrev_b32 v80, 16, v176
    v_and_b32 v81, 0xffff0000, v176
    v_lshlrev_b32 v82, 16, v180
    v_and_b32 v83, 0xffff0000, v180
    v_lshlrev_b32 v84, 16, v184
    v_and_b32 v85, 0xffff0000, v184
    v_pk_add_f32 v[80:81], v[80:81], v[82:83]
    v_pk_add_f32 v[160:161], v[160:161], v[84:85]
    v_pk_add_f32 v[160:161], v[160:161], v[80:81]
    v_cvt_pk_bf16_f32 v176, v160, v161
    v_lshlrev_b32 v86, 16, v177
    v_and_b32 v87, 0xffff0000, v177
    v_lshlrev_b32 v88, 16, v181
    v_and_b32 v89, 0xffff0000, v181
    v_lshlrev_b32 v90, 16, v185
    v_and_b32 v91, 0xffff0000, v185
    v_pk_add_f32 v[86:87], v[86:87], v[88:89]
    v_pk_add_f32 v[162:163], v[162:163], v[90:91]
    v_pk_add_f32 v[162:163], v[162:163], v[86:87]
    v_cvt_pk_bf16_f32 v177, v162, v163
    buffer_store_dwordx2 v[176:177], v20, s[24:27], s64 offen
    v_lshlrev_b32 v92, 16, v178
    v_and_b32 v93, 0xffff0000, v178
    v_lshlrev_b32 v94, 16, v182
    v_and_b32 v95, 0xffff0000, v182
    v_lshlrev_b32 v96, 16, v186
    v_and_b32 v97, 0xffff0000, v186
    v_pk_add_f32 v[92:93], v[92:93], v[94:95]
    v_pk_add_f32 v[164:165], v[164:165], v[96:97]
    v_pk_add_f32 v[164:165], v[164:165], v[92:93]
    v_cvt_pk_bf16_f32 v178, v164, v165
    v_lshlrev_b32 v98, 16, v179
    v_and_b32 v99, 0xffff0000, v179
    v_lshlrev_b32 v100, 16, v183
    v_and_b32 v101, 0xffff0000, v183
    v_lshlrev_b32 v102, 16, v187
    v_and_b32 v103, 0xffff0000, v187
    v_pk_add_f32 v[98:99], v[98:99], v[100:101]
    v_pk_add_f32 v[166:167], v[166:167], v[102:103]
    v_pk_add_f32 v[166:167], v[166:167], v[98:99]
    v_cvt_pk_bf16_f32 v179, v166, v167
    buffer_store_dwordx2 v[178:179], v21, s[24:27], s64 offen
    s_waitcnt vmcnt(2)
    v_lshlrev_b32 v80, 16, v188
    v_and_b32 v81, 0xffff0000, v188
    v_lshlrev_b32 v82, 16, v192
    v_and_b32 v83, 0xffff0000, v192
    v_lshlrev_b32 v84, 16, v196
    v_and_b32 v85, 0xffff0000, v196
    v_pk_add_f32 v[80:81], v[80:81], v[82:83]
    v_pk_add_f32 v[168:169], v[168:169], v[84:85]
    v_pk_add_f32 v[168:169], v[168:169], v[80:81]
    v_cvt_pk_bf16_f32 v188, v168, v169
    v_lshlrev_b32 v86, 16, v189
    v_and_b32 v87, 0xffff0000, v189
    v_lshlrev_b32 v88, 16, v193
    v_and_b32 v89, 0xffff0000, v193
    v_lshlrev_b32 v90, 16, v197
    v_and_b32 v91, 0xffff0000, v197
    v_pk_add_f32 v[86:87], v[86:87], v[88:89]
    v_pk_add_f32 v[170:171], v[170:171], v[90:91]
    v_pk_add_f32 v[170:171], v[170:171], v[86:87]
    v_cvt_pk_bf16_f32 v189, v170, v171
    buffer_store_dwordx2 v[188:189], v20, s[24:27], s64 offen offset:32
    v_lshlrev_b32 v92, 16, v190
    v_and_b32 v93, 0xffff0000, v190
    v_lshlrev_b32 v94, 16, v194
    v_and_b32 v95, 0xffff0000, v194
    v_lshlrev_b32 v96, 16, v198
    v_and_b32 v97, 0xffff0000, v198
    v_pk_add_f32 v[92:93], v[92:93], v[94:95]
    v_pk_add_f32 v[172:173], v[172:173], v[96:97]
    v_pk_add_f32 v[172:173], v[172:173], v[92:93]
    v_cvt_pk_bf16_f32 v190, v172, v173
    v_lshlrev_b32 v98, 16, v191
    v_and_b32 v99, 0xffff0000, v191
    v_lshlrev_b32 v100, 16, v195
    v_and_b32 v101, 0xffff0000, v195
    v_lshlrev_b32 v102, 16, v199
    v_and_b32 v103, 0xffff0000, v199
    v_pk_add_f32 v[98:99], v[98:99], v[100:101]
    v_pk_add_f32 v[174:175], v[174:175], v[102:103]
    v_pk_add_f32 v[174:175], v[174:175], v[98:99]
    v_cvt_pk_bf16_f32 v191, v174, v175
    buffer_store_dwordx2 v[190:191], v21, s[24:27], s64 offen offset:32
K1_END:
    s_endpgm
K1_LB_MASK:
    s_nop 1
    v_add_f32 v212, s12, v144
    v_fma_f32 v176, v208, s8, v212
    v_fma_f32 v177, v209, s8, v212
    v_fma_f32 v178, v210, s8, v212
    v_fma_f32 v179, v211, s8, v212
    v_add_f32 v213, s13, v144
    v_fma_f32 v180, v208, s9, v213
    v_fma_f32 v181, v209, s9, v213
    v_fma_f32 v182, v210, s9, v213
    v_fma_f32 v183, v211, s9, v213
    v_add_f32 v214, s14, v144
    v_fma_f32 v184, v208, s10, v214
    v_fma_f32 v185, v209, s10, v214
    v_fma_f32 v186, v210, s10, v214
    v_fma_f32 v187, v211, s10, v214
    v_add_f32 v215, s15, v144
    v_fma_f32 v188, v208, s11, v215
    v_fma_f32 v189, v209, s11, v215
    v_fma_f32 v190, v210, s11, v215
    v_fma_f32 v191, v211, s11, v215
    s_nop 1
    s_branch K1_LB_BACK
K1_LS_MASK:
    s_nop 1
    v_add_f32 v212, s12, v152
    v_fma_f32 v176, v208, s8, v212
    v_fma_f32 v177, v209, s8, v212
    v_fma_f32 v178, v210, s8, v212
    v_fma_f32 v179, v211, s8, v212
    v_add_f32 v213, s13, v152
    v_fma_f32 v180, v208, s9, v213
    v_fma_f32 v181, v209, s9, v213
    v_fma_f32 v182, v210, s9, v213
    v_fma_f32 v183, v211, s9, v213
    v_add_f32 v214, s14, v152
    v_fma_f32 v184, v208, s10, v214
    v_fma_f32 v185, v209, s10, v214
    v_fma_f32 v186, v210, s10, v214
    v_fma_f32 v187, v211, s10, v214
    v_add_f32 v215, s15, v152
    v_fma_f32 v188, v208, s11, v215
    v_fma_f32 v189, v209, s11, v215
    v_fma_f32 v190, v210, s11, v215
    v_fma_f32 v191, v211, s11, v215
    s_nop 1
    s_branch K1_LS_BACK
K1_REDO:
    s_mov_b32 s83, 1
    s_mov_b32 s63, 1073741824
    s_mov_b32 s64, 1073741824
    s_mov_b32 s50, 0
    s_mov_b32 s54, 0
    s_waitcnt vmcnt(0) lgkmcnt(0)
    s_barrier
    v_lshrrev_b32 v92, 4, v1
    v_and_b32 v64, 15, v92
    v_lshrrev_b32 v92, 4, v92
    v_lshlrev_b32 v92, 2, v92
    v_sub_u32 v92, v64, v92
    s_lshl_b32 s98, s4, 4
    v_add_u32 v92, s98, v92
    s_lshl_b32 s98, s6, 7
    s_sub_u32 s99, 1920, s98
    v_add_u32 v64, s98, v92
    v_add_u32 v65, 64, v64
    v_add_u32 v66, s99, v92
    v_add_u32 v67, 64, v66
    v_mov_b32 v93, 0xf149f2ca
    v_mov_b32 v68, v93
    v_mov_b32 v69, v93
    v_mov_b32 v70, v93
    v_mov_b32 v71, v93
    s_mov_b32 s78, 0
    s_add_u32 s99, s99, 128
K1_REDO_L:
    s_lshr_b32 s7, s78, 6
    s_lshl_b32 s7, s7, 15
    s_bfe_u32 s98, s78, 0x20004
    s_lshl_b32 s98, s98, 12
    s_add_u32 s7, s7, s98
    buffer_load_dwordx4 v[72:75], v1, s[36:39], s7 offen offset:0 sc1
    buffer_load_dwordx4 v[76:79], v1, s[36:39], s7 offen offset:1024 sc1
    buffer_load_dwordx4 v[80:83], v1, s[36:39], s7 offen offset:2048 sc1
    buffer_load_dwordx4 v[84:87], v1, s[36:39], s7 offen offset:3072 sc1
    s_waitcnt vmcnt(0)
    v_mfma_f32_16x16x32_bf16 v[88:91], v[72:75], v[128:131], 0
    v_mfma_f32_16x16x32_bf16 v[88:91], v[76:79], v[160:163], v[88:91]
    v_mfma_f32_16x16x32_bf16 v[88:91], v[80:83], v[192:195], v[88:91]
    v_mfma_f32_16x16x32_bf16 v[88:91], v[84:87], v[224:227], v[88:91]
    v_subrev_u32 v92, s78, v64
    v_cmp_le_i32 vcc, 0, v92
    s_nop 5
    v_cndmask_b32 v88, v93, v88, vcc
    v_max_f32 v68, v68, v88
    v_cmp_le_i32 vcc, 1, v92
    s_nop 1
    v_cndmask_b32 v89, v93, v89, vcc
    v_max_f32 v68, v68, v89
    v_cmp_le_i32 vcc, 2, v92
    s_nop 1
    v_cndmask_b32 v90, v93, v90, vcc
    v_max_f32 v68, v68, v90
    v_cmp_le_i32 vcc, 3, v92
    s_nop 1
    v_cndmask_b32 v91, v93, v91, vcc
    v_max_f32 v68, v68, v91
    v_mfma_f32_16x16x32_bf16 v[88:91], v[72:75], v[132:135], 0
    v_mfma_f32_16x16x32_bf16 v[88:91], v[76:79], v[164:167], v[88:91]
    v_mfma_f32_16x16x32_bf16 v[88:91], v[80:83], v[196:199], v[88:91]
    v_mfma_f32_16x16x32_bf16 v[88:91], v[84:87], v[228:231], v[88:91]
    v_subrev_u32 v92, s78, v65
    v_cmp_le_i32 vcc, 0, v92
    s_nop 5
    v_cndmask_b32 v88, v93, v88, vcc
    v_max_f32 v69, v69, v88
    v_cmp_le_i32 vcc, 1, v92
    s_nop 1
    v_cndmask_b32 v89, v93, v89, vcc
    v_max_f32 v69, v69, v89
    v_cmp_le_i32 vcc, 2, v92
    s_nop 1
    v_cndmask_b32 v90, v93, v90, vcc
    v_max_f32 v69, v69, v90
    v_cmp_le_i32 vcc, 3, v92
    s_nop 1
    v_cndmask_b32 v91, v93, v91, vcc
    v_max_f32 v69, v69, v91
    v_mfma_f32_16x16x32_bf16 v[88:91], v[72:75], v[136:139], 0
    v_mfma_f32_16x16x32_bf16 v[88:91], v[76:79], v[168:171], v[88:91]
    v_mfma_f32_16x16x32_bf16 v[88:91], v[80:83], v[200:203], v[88:91]
    v_mfma_f32_16x16x32_bf16 v[88:91], v[84:87], v[232:235], v[88:91]
    v_subrev_u32 v92, s78, v66
    v_cmp_le_i32 vcc, 0, v92
    s_nop 5
    v_cndmask_b32 v88, v93, v88, vcc
    v_max_f32 v70, v70, v88
    v_cmp_le_i32 vcc, 1, v92
    s_nop 1
    v_cndmask_b32 v89, v93, v89, vcc
    v_max_f32 v70, v70, v89
    v_cmp_le_i32 vcc, 2, v92
    s_nop 1
    v_cndmask_b32 v90, v93, v90, vcc
    v_max_f32 v70, v70, v90
    v_cmp_le_i32 vcc, 3, v92
    s_nop 1
    v_cndmask_b32 v91, v93, v91, vcc
    v_max_f32 v70, v70, v91
    v_mfma_f32_16x16x32_bf16 v[88:91], v[72:75], v[140:143], 0
    v_mfma_f32_16x16x32_bf16 v[88:91], v[76:79], v[172:175], v[88:91]
    v_mfma_f32_16x16x32_bf16 v[88:91], v[80:83], v[204:207], v[88:91]
    v_mfma_f32_16x16x32_bf16 v[88:91], v[84:87], v[236:239], v[88:91]
    v_subrev_u32 v92, s78, v67
    v_cmp_le_i32 vcc, 0, v92
    s_nop 5
    v_cndmask_b32 v88, v93, v88, vcc
    v_max_f32 v71, v71, v88
    v_cmp_le_i32 vcc, 1, v92
    s_nop 1
    v_cndmask_b32 v89, v93, v89, vcc
    v_max_f32 v71, v71, v89
    v_cmp_le_i32 vcc, 2, v92
    s_nop 1
    v_cndmask_b32 v90, v93, v90, vcc
    v_max_f32 v71, v71, v90
    v_cmp_le_i32 vcc, 3, v92
    s_nop 1
    v_cndmask_b32 v91, v93, v91, vcc
    v_max_f32 v71, v71, v91
    s_add_u32 s78, s78, 16
    s_cmp_lt_u32 s78, s99
    s_cbranch_scc1 K1_REDO_L
    v_mov_b32 v92, v68
    s_nop 1
    v_permlane32_swap_b32 v68, v92
    v_max_f32 v68, v68, v92
    v_mov_b32 v92, v68
    s_nop 1
    v_permlane16_swap_b32 v68, v92
    v_max_f32 v68, v68, v92
    v_sub_f32 v144, 0, v68
    v_sub_f32 v145, 0, v68
    v_sub_f32 v146, 0, v68
    v_sub_f32 v147, 0, v68
    v_mov_b32 v92, v69
    s_nop 1
    v_permlane32_swap_b32 v69, v92
    v_max_f32 v69, v69, v92
    v_mov_b32 v92, v69
    s_nop 1
    v_permlane16_swap_b32 v69, v92
    v_max_f32 v69, v69, v92
    v_sub_f32 v148, 0, v69
    v_sub_f32 v149, 0, v69
    v_sub_f32 v150, 0, v69
    v_sub_f32 v151, 0, v69
    v_mov_b32 v92, v70
    s_nop 1
    v_permlane32_swap_b32 v70, v92
    v_max_f32 v70, v70, v92
    v_mov_b32 v92, v70
    s_nop 1
    v_permlane16_swap_b32 v70, v92
    v_max_f32 v70, v70, v92
    v_sub_f32 v152, 0, v70
    v_sub_f32 v153, 0, v70
    v_sub_f32 v154, 0, v70
    v_sub_f32 v155, 0, v70
    v_mov_b32 v92, v71
    s_nop 1
    v_permlane32_swap_b32 v71, v92
    v_max_f32 v71, v71, v92
    v_mov_b32 v92, v71
    s_nop 1
    v_permlane16_swap_b32 v71, v92
    v_max_f32 v71, v71, v92
    v_sub_f32 v156, 0, v71
    v_sub_f32 v157, 0, v71
    v_sub_f32 v158, 0, v71
    v_sub_f32 v159, 0, v71
    v_accvgpr_write_b32 a0, 0
    v_accvgpr_write_b32 a1, 0
    v_accvgpr_write_b32 a2, 0
    v_accvgpr_write_b32 a3, 0
    v_accvgpr_write_b32 a4, 0
    v_accvgpr_write_b32 a5, 0
    v_accvgpr_write_b32 a6, 0
    v_accvgpr_write_b32 a7, 0
    v_accvgpr_write_b32 a8, 0
    v_accvgpr_write_b32 a9, 0
    v_accvgpr_write_b32 a10, 0
    v_accvgpr_write_b32 a11, 0
    v_accvgpr_write_b32 a12, 0
    v_accvgpr_write_b32 a13, 0
    v_accvgpr_write_b32 a14, 0
    v_accvgpr_write_b32 a15, 0
    v_accvgpr_write_b32 a16, 0
    v_accvgpr_write_b32 a17, 0
    v_accvgpr_write_b32 a18, 0
    v_accvgpr_write_b32 a19, 0
    v_accvgpr_write_b32 a20, 0
    v_accvgpr_write_b32 a21, 0
    v_accvgpr_write_b32 a22, 0
    v_accvgpr_write_b32 a23, 0
    v_accvgpr_write_b32 a24, 0
    v_accvgpr_write_b32 a25, 0
    v_accvgpr_write_b32 a26, 0
    v_accvgpr_write_b32 a27, 0
    v_accvgpr_write_b32 a28, 0
    v_accvgpr_write_b32 a29, 0
    v_accvgpr_write_b32 a30, 0
    v_accvgpr_write_b32 a31, 0
    v_accvgpr_write_b32 a32, 0
    v_accvgpr_write_b32 a33, 0
    v_accvgpr_write_b32 a34, 0
    v_accvgpr_write_b32 a35, 0
    v_accvgpr_write_b32 a36, 0
    v_accvgpr_write_b32 a37, 0
    v_accvgpr_write_b32 a38, 0
    v_accvgpr_write_b32 a39, 0
    v_accvgpr_write_b32 a40, 0
    v_accvgpr_write_b32 a41, 0
    v_accvgpr_write_b32 a42, 0
    v_accvgpr_write_b32 a43, 0
    v_accvgpr_write_b32 a44, 0
    v_accvgpr_write_b32 a45, 0
    v_accvgpr_write_b32 a46, 0
    v_accvgpr_write_b32 a47, 0
    v_accvgpr_write_b32 a48, 0
    v_accvgpr_write_b32 a49, 0
    v_accvgpr_write_b32 a50, 0
    v_accvgpr_write_b32 a51, 0
    v_accvgpr_write_b32 a52, 0
    v_accvgpr_write_b32 a53, 0
    v_accvgpr_write_b32 a54, 0
    v_accvgpr_write_b32 a55, 0
    v_accvgpr_write_b32 a56, 0
    v_accvgpr_write_b32 a57, 0
    v_accvgpr_write_b32 a58, 0
    v_accvgpr_write_b32 a59, 0
    v_accvgpr_write_b32 a60, 0
    v_accvgpr_write_b32 a61, 0
    v_accvgpr_write_b32 a62, 0
    v_accvgpr_write_b32 a63, 0
    v_accvgpr_write_b32 a144, 0
    v_accvgpr_write_b32 a145, 0
    v_accvgpr_write_b32 a146, 0
    v_accvgpr_write_b32 a147, 0
    v_accvgpr_write_b32 a148, 0
    v_accvgpr_write_b32 a149, 0
    v_accvgpr_write_b32 a150, 0
    v_accvgpr_write_b32 a151, 0
    v_accvgpr_write_b32 a152, 0
    v_accvgpr_write_b32 a153, 0
    v_accvgpr_write_b32 a154, 0
    v_accvgpr_write_b32 a155, 0
    v_accvgpr_write_b32 a156, 0
    v_accvgpr_write_b32 a157, 0
    v_accvgpr_write_b32 a158, 0
    v_accvgpr_write_b32 a159, 0
    v_accvgpr_write_b32 a160, 0
    v_accvgpr_write_b32 a161, 0
    v_accvgpr_write_b32 a162, 0
    v_accvgpr_write_b32 a163, 0
    v_accvgpr_write_b32 a164, 0
    v_accvgpr_write_b32 a165, 0
    v_accvgpr_write_b32 a166, 0
    v_accvgpr_write_b32 a167, 0
    v_accvgpr_write_b32 a168, 0
    v_accvgpr_write_b32 a169, 0
    v_accvgpr_write_b32 a170, 0
    v_accvgpr_write_b32 a171, 0
    v_accvgpr_write_b32 a172, 0
    v_accvgpr_write_b32 a173, 0
    v_accvgpr_write_b32 a174, 0
    v_accvgpr_write_b32 a175, 0
    v_accvgpr_write_b32 a176, 0
    v_accvgpr_write_b32 a177, 0
    v_accvgpr_write_b32 a178, 0
    v_accvgpr_write_b32 a179, 0
    v_accvgpr_write_b32 a180, 0
    v_accvgpr_write_b32 a181, 0
    v_accvgpr_write_b32 a182, 0
    v_accvgpr_write_b32 a183, 0
    v_accvgpr_write_b32 a184, 0
    v_accvgpr_write_b32 a185, 0
    v_accvgpr_write_b32 a186, 0
    v_accvgpr_write_b32 a187, 0
    v_accvgpr_write_b32 a188, 0
    v_accvgpr_write_b32 a189, 0
    v_accvgpr_write_b32 a190, 0
    v_accvgpr_write_b32 a191, 0
    v_accvgpr_write_b32 a192, 0
    v_accvgpr_write_b32 a193, 0
    v_accvgpr_write_b32 a194, 0
    v_accvgpr_write_b32 a195, 0
    v_accvgpr_write_b32 a196, 0
    v_accvgpr_write_b32 a197, 0
    v_accvgpr_write_b32 a198, 0
    v_accvgpr_write_b32 a199, 0
    v_accvgpr_write_b32 a200, 0
    v_accvgpr_write_b32 a201, 0
    v_accvgpr_write_b32 a202, 0
    v_accvgpr_write_b32 a203, 0
    v_accvgpr_write_b32 a204, 0
    v_accvgpr_write_b32 a205, 0
    v_accvgpr_write_b32 a206, 0
    v_accvgpr_write_b32 a207, 0
    v_accvgpr_write_b32 a208, 0
    v_accvgpr_write_b32 a209, 0
    v_accvgpr_write_b32 a210, 0
    v_accvgpr_write_b32 a211, 0
    v_accvgpr_write_b32 a212, 0
    v_accvgpr_write_b32 a213, 0
    v_accvgpr_write_b32 a214, 0
    v_accvgpr_write_b32 a215, 0
    v_accvgpr_write_b32 a216, 0
    v_accvgpr_write_b32 a217, 0
    v_accvgpr_write_b32 a218, 0
    v_accvgpr_write_b32 a219, 0
    v_accvgpr_write_b32 a220, 0
    v_accvgpr_write_b32 a221, 0
    v_accvgpr_write_b32 a222, 0
    v_accvgpr_write_b32 a223, 0
    v_bfe_u32 v92, v1, 4, 2
    v_cmp_eq_u32 vcc, 0, v92
    v_mov_b32 v92, 0x3f803f80
    s_nop 0
    v_cndmask_b32 v92, 0, v92, vcc
    v_accvgpr_write_b32 a136, v92
    v_accvgpr_write_b32 a137, v92
    v_accvgpr_write_b32 a138, v92
    v_accvgpr_write_b32 a139, v92
    s_mov_b32 s77, s75
    s_mov_b32 s76, 0
    s_mov_b32 s38, 16384
    s_add_u32 m0, s76, s75
    s_nop 0
    buffer_load_dwordx4 v1, s[36:39], s77 offen sc1 lds
    buffer_load_dwordx4 v1, s[36:39], s77 offen offset:1024 sc1 lds
    buffer_load_dwordx4 v1, s[36:39], s77 offen offset:2048 sc1 lds
    buffer_load_dwordx4 v1, s[36:39], s77 offen offset:3072 sc1 lds
    s_add_u32 s100, s77, 4096
    s_add_u32 m0, m0, 4096
    s_nop 0
    buffer_load_dwordx4 v1, s[36:39], s100 offen sc1 lds
    buffer_load_dwordx4 v1, s[36:39], s100 offen offset:1024 sc1 lds
    buffer_load_dwordx4 v1, s[36:39], s100 offen offset:2048 sc1 lds
    buffer_load_dwordx4 v1, s[36:39], s100 offen offset:3072 sc1 lds
    s_add_u32 s77, s77, 32768
    s_add_u32 s76, s76, 32768
    s_lshr_b32 s82, s4, 1
    s_add_u32 s82, s82, 32
    s_sub_u32 s82, s82, s6
    s_sub_u32 s82, s82, s6
    s_lshl_b32 s38, s82, 15
    s_add_u32 m0, s76, s75
    s_nop 0
    buffer_load_dwordx4 v1, s[36:39], s77 offen sc1 lds
    buffer_load_dwordx4 v1, s[36:39], s77 offen offset:1024 sc1 lds
    buffer_load_dwordx4 v1, s[36:39], s77 offen offset:2048 sc1 lds
    buffer_load_dwordx4 v1, s[36:39], s77 offen offset:3072 sc1 lds
    s_add_u32 s100, s77, 4096
    s_add_u32 m0, m0, 4096
    s_nop 0
    buffer_load_dwordx4 v1, s[36:39], s100 offen sc1 lds
    buffer_load_dwordx4 v1, s[36:39], s100 offen offset:1024 sc1 lds
    buffer_load_dwordx4 v1, s[36:39], s100 offen offset:2048 sc1 lds
    buffer_load_dwordx4 v1, s[36:39], s100 offen offset:3072 sc1 lds
    s_add_u32 s77, s77, 32768
    s_add_u32 s76, s76, 32768
    s_add_u32 m0, s76, s75
    s_nop 0
    buffer_load_dwordx4 v1, s[36:39], s77 offen sc1 lds
    buffer_load_dwordx4 v1, s[36:39], s77 offen offset:1024 sc1 lds
    buffer_load_dwordx4 v1, s[36:39], s77 offen offset:2048 sc1 lds
    buffer_load_dwordx4 v1, s[36:39], s77 offen offset:3072 sc1 lds
    s_add_u32 s100, s77, 4096
    s_add_u32 m0, m0, 4096
    s_nop 0
    buffer_load_dwordx4 v1, s[36:39], s100 offen sc1 lds
    buffer_load_dwordx4 v1, s[36:39], s100 offen offset:1024 sc1 lds
    buffer_load_dwordx4 v1, s[36:39], s100 offen offset:2048 sc1 lds
    buffer_load_dwordx4 v1, s[36:39], s100 offen offset:3072 sc1 lds
    s_add_u32 s77, s77, 32768
    s_add_u32 s76, s76, 32768
    s_mov_b32 s82, 0
    s_mov_b32 s60, 131072
    v_mov_b32 v2, v1
    s_cmp_eq_u32 s6, 0
    s_cselect_b32 s16, s8, 0
    s_cselect_b32 s17, s9, 0
    s_cmp_eq_u32 s6, 0
    s_cselect_b32 s18, s10, 0
    s_cselect_b32 s19, s11, 0
    s_cmp_eq_u32 s6, 0
    s_cselect_b32 s20, s12, 0
    s_cselect_b32 s21, s13, 0
    s_cmp_eq_u32 s6, 0
    s_cselect_b32 s22, s14, 0
    s_cselect_b32 s23, s15, 0
    s_waitcnt vmcnt(16)
    s_barrier
    ds_read_b128 a[224:227], v2 offset:0
    ds_read_b128 a[228:231], v2 offset:1024
    ds_read_b128 a[232:235], v2 offset:2048
    ds_read_b128 a[236:239], v2 offset:3072
    s_waitcnt lgkmcnt(0)
    s_branch K1_ATT
SPIN_WA:
    s_mov_b32 s94, 0
SPIN_WA_L:
    s_sleep 2
    buffer_load_dword v7, v9, s[44:47], s69 offen sc1
    s_add_u32 s94, s94, 1
    s_cmp_ge_u32 s94, 0x40000
    s_waitcnt vmcnt(0)
    s_cbranch_scc1 BACK_WA
    v_cmp_gt_u32 vcc, 8, v7
    s_nop 1
    s_and_b64 vcc, vcc, s[86:87]
    s_cbranch_scc1 SPIN_WA_L
    s_branch BACK_WA
SPIN_KV:
    s_mov_b32 s94, 0
SPIN_KV_L:
    s_sleep 2
    buffer_load_dword v7, v8, s[32:35], s61 offen sc1
    s_add_u32 s94, s94, 1
    s_cmp_ge_u32 s94, 0x40000
    s_waitcnt vmcnt(0)
    s_cbranch_scc1 BACK_KV
    v_cmp_gt_u32 vcc, 1, v7
    s_nop 1
    s_and_b64 vcc, vcc, exec
    s_cbranch_scc1 SPIN_KV_L
    s_branch BACK_KV
SPIN_ALL:
    s_mov_b32 s94, 0
SPIN_ALL_L:
    s_sleep 2
    buffer_load_dword v3, v29, s[32:35], s92 offen sc1
    s_add_u32 s94, s94, 1
    s_cmp_ge_u32 s94, 0x40000
    s_waitcnt vmcnt(0)
    s_cbranch_scc1 BACK_ALL
    v_cmp_gt_u32 vcc, 1, v3
    s_nop 1
    s_and_b64 vcc, vcc, exec
    s_cbranch_scc1 SPIN_ALL_L
    s_branch BACK_ALL
SPIN_CTX:
    s_mov_b32 s94, 0
SPIN_CTX_L:
    s_sleep 2
    buffer_load_dword v3, v19, s[32:35], s66 offen sc1
    s_add_u32 s94, s94, 1
    s_cmp_ge_u32 s94, 0x40000
    s_waitcnt vmcnt(0)
    s_cbranch_scc1 BACK_CTX
    v_cmp_gt_u32 vcc, 2, v3
    s_nop 1
    s_and_b64 vcc, vcc, exec
    s_cbranch_scc1 SPIN_CTX_L
    s_branch BACK_CTX
SPIN_OA:
    s_mov_b32 s94, 0
SPIN_OA_L:
    s_sleep 2
    buffer_load_dword v3, v19, s[32:35], s66 offen sc1
    s_add_u32 s94, s94, 1
    s_cmp_ge_u32 s94, 0x40000
    s_waitcnt vmcnt(0)
    s_cbranch_scc1 BACK_OA
    v_cmp_gt_u32 vcc, 3, v3
    s_nop 1
    s_and_b64 vcc, vcc, exec
    s_cbranch_scc1 SPIN_OA_L
    s_branch BACK_OA
SPIN_X:
    s_mov_b32 s94, 0
SPIN_X_L:
    s_sleep 2
    buffer_load_dword v3, v19, s[32:35], s66 offen sc1
    s_add_u32 s94, s94, 1
    s_cmp_ge_u32 s94, 0x40000
    s_waitcnt vmcnt(0)
    s_cbranch_scc1 BACK_X
    v_cmp_gt_u32 vcc, 2, v3
    s_nop 1
    s_and_b64 vcc, vcc, exec
    s_cbranch_scc1 SPIN_X_L
    s_branch BACK_X
.section .rodata,"a"
.p2align 6
.amdhsa_kernel gated_mix__sliding_local_dilated__compressed_kv_cla__prompt_kernel
.amdhsa_next_free_vgpr 512
.amdhsa_next_free_sgpr 102
.amdhsa_accum_offset 256
.amdhsa_group_segment_fixed_size 0
.amdhsa_kernarg_size 104
.amdhsa_user_sgpr_count 2
.amdhsa_user_sgpr_kernarg_segment_ptr 1
.amdhsa_system_sgpr_workgroup_id_x 1
.amdhsa_ieee_mode 0
.amdhsa_dx10_clamp 0
.end_amdhsa_kernel
```

```asm
; @launch grid=(256,1,1) block=(256,1,1) lds=163840
.amdgcn_target "amdgcn-amd-amdhsa--gfx950"
.text
.globl gated_mix__sliding_local_dilated__compressed_kv_cla__prompt_kernel
.p2align 8
.type gated_mix__sliding_local_dilated__compressed_kv_cla__prompt_kernel,@function
gated_mix__sliding_local_dilated__compressed_kv_cla__prompt_kernel:
    s_cmp_ge_u32 s2, 256
    s_cbranch_scc1 K1_END
    s_getpc_b64 s[94:95]
    s_load_dwordx8 s[36:43], s[0:1], 32
    v_min_u32 v74, 16, v0
    s_lshr_b32 s7, s2, 3
    s_mul_i32 s7, s7, 17
    v_add_lshl_u32 v74, v74, s7, 7
    global_load_dword v76, v74, s[94:95]
    v_lshrrev_b32 v64, 6, v0
    v_and_b32 v31, 63, v0
    v_readfirstlane_b32 s4, v64
    s_and_b32 s5, s2, 7
    s_lshl_b32 s5, s5, 2
    s_bfe_u32 s7, s2, 0x20003
    s_add_u32 s5, s5, s7
    s_lshr_b32 s6, s2, 5
    s_lshl_b32 s69, s4, 12
    s_mov_b32 s10, 2097152
    s_mov_b32 s11, 0x20000
    s_mov_b32 s14, 4194304
    s_mov_b32 s15, 0x20000
    s_mov_b32 s18, 4194304
    s_mov_b32 s19, 0x20000
    v_lshrrev_b32 v65, 3, v31
    v_and_b32 v66, 7, v31
    v_lshrrev_b32 v67, 1, v65
    v_xor_b32 v66, v66, v67
    v_lshlrev_b32 v66, 4, v66
    v_xor_b32 v67, 64, v66
    s_lshr_b32 s7, s4, 1
    s_lshl_b32 s73, s7, 7
    s_and_b32 s100, s4, 1
    s_lshl_b32 s98, s100, 5
    s_add_u32 s98, s98, s73
    v_add_lshl_u32 v68, v65, s98, 10
    v_add_u32 v6, v68, v66
    v_add_u32 v7, v68, v67
    v_add_u32 v7, 7168, v7
    v_add_u32 v8, v68, v66
    v_add_u32 v8, 14336, v8
    v_add_u32 v9, v68, v67
    v_add_u32 v9, 21504, v9
    v_lshrrev_b32 v69, 4, v31
    v_and_b32 v70, 15, v31
    v_lshlrev_b32 v71, 1, v69
    v_xor_b32 v71, v71, v70
    v_lshlrev_b32 v71, 4, v71
    v_xor_b32 v72, 128, v71
    s_lshl_b32 s98, s4, 4
    v_add_lshl_u32 v73, v69, s98, 13
    v_add_u32 v2, v73, v71
    v_add_u32 v3, v73, v71
    v_add_u32 v3, 31744, v3
    v_add_u32 v4, v73, v72
    v_add_u32 v4, 63488, v4
    v_add_u32 v5, v73, v72
    v_add_u32 v5, 95232, v5
    s_and_b32 s3, s2, 0
    s_lshl_b32 s66, s3, 7
    s_lshl_b32 s60, s3, 11
    s_add_u32 s60, s60, s5
    s_lshl_b32 s60, s60, 8
    s_lshl_b32 s61, s6, 18
    s_add_u32 s61, s61, s66
    s_add_u32 s62, s61, 65536
    s_waitcnt lgkmcnt(0)
    s_mov_b64 s[8:9], s[36:37]
    s_mov_b64 s[24:25], s[38:39]
    s_mov_b64 s[12:13], s[40:41]
    s_mov_b64 s[16:17], s[42:43]
    s_load_dwordx2 s[20:21], s[0:1], 0
    s_load_dwordx2 s[28:29], s[0:1], 8
    s_load_dwordx2 s[32:33], s[0:1], 72
    s_load_dwordx2 s[48:49], s[0:1], 64
    s_load_dwordx2 s[92:93], s[0:1], 16
    s_load_dwordx2 s[44:45], s[0:1], 88
    s_load_dwordx2 s[56:57], s[0:1], 96
    s_load_dwordx2 s[0:1], s[0:1], 80
    s_add_u32 m0, s69, 0
    s_nop 0
    buffer_load_dwordx4 v6, s[8:11], s61 offen lds
    buffer_load_dwordx4 v7, s[8:11], s61 offen offset:1024 lds
    buffer_load_dwordx4 v8, s[8:11], s61 offen offset:2048 lds
    buffer_load_dwordx4 v9, s[8:11], s61 offen offset:3072 lds
    s_xor_b32 s61, s61, 128
    s_add_u32 m0, s69, 16384
    s_nop 0
    buffer_load_dwordx4 v6, s[8:11], s62 offen lds
    buffer_load_dwordx4 v7, s[8:11], s62 offen offset:1024 lds
    buffer_load_dwordx4 v8, s[8:11], s62 offen offset:2048 lds
    buffer_load_dwordx4 v9, s[8:11], s62 offen offset:3072 lds
    s_xor_b32 s62, s62, 128
    s_add_u32 m0, s69, 32768
    s_nop 0
    buffer_load_dwordx4 v2, s[12:15], s60 offen nt lds
    buffer_load_dwordx4 v3, s[12:15], s60 offen offset:1024 nt lds
    buffer_load_dwordx4 v4, s[12:15], s60 offen offset:2048 nt lds
    buffer_load_dwordx4 v5, s[12:15], s60 offen offset:3072 nt lds
    s_add_u32 m0, s69, 49152
    s_nop 0
    buffer_load_dwordx4 v6, s[8:11], s61 offen lds
    buffer_load_dwordx4 v7, s[8:11], s61 offen offset:1024 lds
    buffer_load_dwordx4 v8, s[8:11], s61 offen offset:2048 lds
    buffer_load_dwordx4 v9, s[8:11], s61 offen offset:3072 lds
    s_xor_b32 s61, s61, 384
    v_min_u32 v74, 15, v31
    s_lshl2_add_u32 s98, s2, s4
    s_lshl_b32 s98, s98, 11
    v_lshlrev_b32 v74, 7, v74
    buffer_load_dword v117, v74, s[8:11], s98 offen
    s_waitcnt lgkmcnt(0)
    s_mov_b32 s22, 2359296
    s_mov_b32 s23, 0x20000
    s_mov_b32 s26, 4718592
    s_mov_b32 s27, 0x20000
    s_mov_b32 s50, 4718592
    s_mov_b32 s51, 0x20000
    s_mov_b32 s46, 256
    s_mov_b32 s47, 0x20000
    s_mov_b32 s30, 1990656
    s_mov_b32 s31, 0x20000
    s_mov_b32 s34, 1152
    s_mov_b32 s35, 0x20000
    s_mul_i32 s7, s5, 1081344
    s_add_u32 s36, s56, s7
    s_addc_u32 s37, s57, 0
    s_mov_b32 s38, 1081344
    s_mov_b32 s39, 0x20000
    s_cmp_eq_u32 s4, 0
    s_cselect_b32 s86, 0x55555555, 0
    s_cselect_b32 s87, 0x55555555, 0
    s_cselect_b32 s52, s48, s92
    s_cselect_b32 s53, s49, s93
    s_cselect_b32 s54, s50, 663552
    s_mov_b32 s55, 0x20000
    s_mul_i32 s63, s6, 147456
    s_sub_u32 s64, 2211840, s63
    s_add_u32 s63, s63, s66
    s_add_u32 s64, s64, s66
    s_lshl_b32 s67, s4, 11
    s_lshl_b32 s68, s4, 10
    s_lshl_b32 s75, s4, 13
    s_lshl_b32 s65, s3, 13
    s_add_u32 s65, s65, s67
    s_lshl_b32 s70, s6, 2
    s_lshl1_add_u32 s70, s100, s70
    s_lshl_b32 s70, s70, 15
    s_lshl_b32 s98, s73, 6
    s_add_u32 s71, s70, s98
    s_add_u32 s71, s71, 49152
    s_lshl_b32 s98, s73, 4
    s_add_u32 s70, s70, s98
    v_lshlrev_b32 v1, 4, v31
    v_mov_b32 v77, 1073741824
    v_cmp_eq_u32 vcc, 0, v0
    s_nop 1
    v_cndmask_b32_e64 v30, v77, 0, vcc
    v_lshlrev_b32 v103, 7, v31
    v_cmp_gt_u32 vcc, 9, v31
    s_nop 1
    v_cndmask_b32 v103, v77, v103, vcc
    s_lshl_b32 s98, s4, 5
    v_add_u32 v68, s98, v65
    v_mul_u32_u24 v68, 1152, v68
    v_add_u32 v10, v68, v66
    v_add_u32 v11, v68, v67
    v_add_u32 v11, 8192, v11
    v_add_u32 v12, v68, v66
    v_add_u32 v12, 16384, v12
    v_add_u32 v13, v68, v67
    v_add_u32 v13, 24576, v13
    s_sub_u32 s98, 15, s6
    s_cmp_eq_u32 s73, 0
    s_cselect_b32 s98, s6, s98
    s_lshl_b32 s98, s98, 7
    s_sub_u32 s98, s98, 16
    s_max_i32 s98, s98, 0
    s_lshl3_add_u32 s98, s100, s98
    v_add_u32 v68, s98, v65
    v_mul_u32_u24 v68, 1152, v68
    s_lshl_b32 s98, s100, 6
    v_xor_b32 v73, s98, v66
    v_add_u32 v96, v68, v73
    s_add_u32 m0, s69, 65536
    s_nop 0
    buffer_load_dwordx4 v2, s[16:19], s60 offen nt lds
    v_lshrrev_b32 v71, 1, v70
    v_xor_b32 v71, v71, v69
    v_lshlrev_b32 v71, 4, v71
    v_lshl_add_u32 v71, v70, 7, v71
    v_xor_b32 v72, 64, v71
    s_lshl_b32 s98, s100, 13
    v_add_u32 v22, s98, v71
    v_add_u32 v23, s98, v72
    v_add_u32 v24, s67, v71
    v_add_u32 v25, s67, v72
    s_lshl_b32 s98, s100, 11
    s_add_u32 s98, s98, 8192
    v_add_u32 v100, s98, v71
    v_add_u32 v101, s98, v72
    v_bfe_u32 v73, v31, 2, 2
    v_and_b32 v74, 3, v31
    v_lshl_add_u32 v75, v69, 3, v73
    v_and_b32 v78, 1, v69
    buffer_load_dwordx4 v3, s[16:19], s60 offen offset:1024 nt lds
    v_lshl_add_u32 v77, v78, 2, v73
    v_lshlrev_b32 v77, 5, v77
    v_lshl_add_u32 v77, v74, 3, v77
    v_lshl_add_u32 v77, v75, 8, v77
    v_xor_b32 v14, 0, v77
    v_xor_b32 v14, s73, v14
    v_xor_b32 v15, 32, v77
    v_xor_b32 v15, s73, v15
    v_xor_b32 v16, 64, v77
    v_xor_b32 v16, s73, v16
    v_xor_b32 v17, 96, v77
    v_xor_b32 v17, s73, v17
    v_xor_b32 v18, 128, v77
    v_xor_b32 v19, 160, v77
    v_xor_b32 v20, 192, v77
    v_xor_b32 v21, 224, v77
    v_lshrrev_b32 v77, 1, v73
    v_lshl_add_u32 v77, v78, 1, v77
    buffer_load_dwordx4 v4, s[16:19], s60 offen offset:2048 nt lds
    v_lshlrev_b32 v77, 5, v77
    v_lshl_add_u32 v77, v74, 3, v77
    v_lshl_add_u32 v77, v75, 7, v77
    s_lshr_b32 s98, s73, 1
    v_xor_b32 v26, 0, v77
    v_xor_b32 v26, s98, v26
    v_xor_b32 v27, 32, v77
    v_xor_b32 v28, 64, v77
    v_xor_b32 v28, s98, v28
    v_xor_b32 v29, 96, v77
    v_and_b32 v73, 7, v0
    v_lshrrev_b32 v74, 3, v0
    v_lshl_add_u32 v75, v73, 1, 0
    v_mul_u32_u24 v78, 52, v75
    v_lshrrev_b32 v78, 8, v78
    v_mul_u32_u24 v79, 5, v78
    v_sub_u32 v75, v75, v79
    v_add_u32 v78, 1, v78
    buffer_load_dwordx4 v5, s[16:19], s60 offen offset:3072 nt lds
    s_xor_b32 s60, s60, 524288
    v_cmp_le_u32 vcc, 3, v78
    s_nop 1
    v_cndmask_b32_e64 v78, v78, 0, vcc
    v_mul_u32_u24 v78, 1152, v78
    v_lshl_add_u32 v75, v75, 3, v78
    v_mad_u32_u24 v75, v74, 36, v75
    v_lshl_add_u32 v77, v73, 1, 1
    v_mul_u32_u24 v78, 52, v77
    v_lshrrev_b32 v78, 8, v78
    v_mul_u32_u24 v79, 5, v78
    v_sub_u32 v77, v77, v79
    v_add_u32 v78, 1, v78
    v_cmp_le_u32 vcc, 3, v78
    s_nop 1
    v_cndmask_b32_e64 v78, v78, 0, vcc
    v_mul_u32_u24 v78, 1152, v78
    v_lshl_add_u32 v77, v77, 3, v78
    v_mad_u32_u24 v77, v74, 36, v77
    s_mul_i32 s98, s2, 10368
    s_mul_i32 s99, s2, 6
    s_mov_b32 s7, 73728
    v_mul_lo_u32 v95, v74, s7
    v_lshl_add_u32 v95, v73, 4, v95
    v_cmp_eq_u32 s[92:93], 7, v73
    s_add_u32 s56, s56, 56623104
    s_addc_u32 s57, s57, 0
    s_mov_b32 s58, 5603328
    s_mov_b32 s59, 0x20000
    s_lshl_b32 s101, s6, 5
    s_add_u32 s101, s101, s5
    s_lshl_b32 s101, s101, 7
    v_mov_b32 v65, 0
    v_lshlrev_b32 v64, 15, v0
    s_mov_b32 s74, 0x3e0293ee
    s_lshl_b32 s95, s5, 3
    s_waitcnt vmcnt(5)
    s_barrier
    ds_read_b128 a[0:3], v22 offset:0
    ds_read_b64_tr_b16 v[40:41], v14 offset:32768
    ds_read_b64_tr_b16 v[42:43], v14 offset:33792
    ds_read_b128 a[4:7], v23 offset:0
    ds_read_b64_tr_b16 v[44:45], v14 offset:40960
    ds_read_b64_tr_b16 v[46:47], v14 offset:41984
    ds_read_b128 a[8:11], v22 offset:2048
    ds_read_b128 a[12:15], v23 offset:2048
    ds_read_b128 a[16:19], v22 offset:4096
    ds_read_b128 a[20:23], v23 offset:4096
    ds_read_b128 a[24:27], v22 offset:6144
    ds_read_b128 a[28:31], v23 offset:6144
    ds_read_b128 a[32:35], v22 offset:16384
    ds_read_b128 a[36:39], v23 offset:16384
    ds_read_b128 a[40:43], v22 offset:18432
    s_waitcnt lgkmcnt(14)
    ds_read_b128 a[44:47], v23 offset:18432
    s_waitcnt lgkmcnt(14)
    ds_read_b128 a[48:51], v22 offset:20480
    s_waitcnt lgkmcnt(14)
    ds_read_b128 a[52:55], v23 offset:20480
    s_waitcnt lgkmcnt(14)
    ds_read_b128 a[56:59], v22 offset:22528
    s_waitcnt lgkmcnt(14)
    ds_read_b128 a[60:63], v23 offset:22528
    v_mfma_f32_16x16x32_bf16 v[128:131], v[40:43], a[0:3], 0
    s_add_u32 m0, s69, 81920
    s_waitcnt lgkmcnt(14)
    ds_read_b64_tr_b16 v[48:49], v15 offset:32768
    s_waitcnt lgkmcnt(14)
    ds_read_b64_tr_b16 v[50:51], v15 offset:33792
    v_mfma_f32_16x16x32_bf16 v[128:131], v[44:47], a[4:7], v[128:131]
    s_mul_i32 s77, s2, 9216
    buffer_load_dwordx4 v6, s[8:11], s62 offen lds
    v_mfma_f32_16x16x32_bf16 v[132:135], v[40:43], a[8:11], 0
    s_mul_i32 s76, s4, 1152
    s_waitcnt lgkmcnt(14)
    ds_read_b128 a[64:67], v22 offset:49152
    s_waitcnt lgkmcnt(14)
    ds_read_b64_tr_b16 v[52:53], v15 offset:40960
    v_mfma_f32_16x16x32_bf16 v[132:135], v[44:47], a[12:15], v[132:135]
    s_add_u32 s77, s77, s76
    s_waitcnt lgkmcnt(14)
    ds_read_b64_tr_b16 v[54:55], v15 offset:41984
    s_waitcnt lgkmcnt(14)
    ds_read_b64_tr_b16 v[56:57], v16 offset:32768
    v_mfma_f32_16x16x32_bf16 v[136:139], v[40:43], a[16:19], 0
    s_mul_i32 s76, s4, 1152
    buffer_load_dwordx4 v7, s[8:11], s62 offen offset:1024 lds
    v_mfma_f32_16x16x32_bf16 v[136:139], v[44:47], a[20:23], v[136:139]
    s_mul_i32 s72, s2, 3
    s_waitcnt lgkmcnt(4)
    ds_read_b64_tr_b16 v[58:59], v16 offset:33792
    ds_read_b64_tr_b16 v[60:61], v16 offset:40960
    v_mfma_f32_16x16x32_bf16 v[140:143], v[40:43], a[24:27], 0
    s_add_u32 s72, s72, 0
    ds_read_b64_tr_b16 v[62:63], v16 offset:41984
    v_add_u32 v14, 0x10000, v14
    v_mfma_f32_16x16x32_bf16 v[140:143], v[44:47], a[28:31], v[140:143]
    s_mul_i32 s7, s5, 73728
    ds_read_b128 a[68:71], v23 offset:49152
    v_add_u32 v15, 0x10000, v15
    v_mfma_f32_16x16x32_bf16 v[144:147], v[40:43], a[32:35], 0
    s_and_b32 s100, s6, 1
    buffer_load_dwordx4 v8, s[8:11], s62 offen offset:2048 lds
    v_mfma_f32_16x16x32_bf16 v[144:147], v[44:47], a[36:39], v[144:147]
    s_mov_b64 s[84:85], 0
    v_add_u32 v16, 0x10000, v16
    v_mov_b32 v31, 1
    v_mfma_f32_16x16x32_bf16 v[148:151], v[40:43], a[40:43], 0
    s_mov_b32 s83, 0
    v_add_u32 v18, 0x10000, v18
    v_add_u32 v19, 0x10000, v19
    v_mfma_f32_16x16x32_bf16 v[148:151], v[44:47], a[44:47], v[148:151]
    v_add_u32 v20, 0x10000, v20
    v_add_u32 v21, 0x10000, v21
    v_mfma_f32_16x16x32_bf16 v[152:155], v[40:43], a[48:51], 0
    buffer_load_dwordx4 v9, s[8:11], s62 offen offset:3072 lds
    v_mfma_f32_16x16x32_bf16 v[152:155], v[44:47], a[52:55], v[152:155]
    ds_read_b128 a[72:75], v22 offset:51200
    v_add_u32 v26, 0x10000, v26
    v_mfma_f32_16x16x32_bf16 v[156:159], v[40:43], a[56:59], 0
    s_add_u32 m0, s69, 98304
    ds_read_b64_tr_b16 v[40:41], v17 offset:32768
    ds_read_b64_tr_b16 v[42:43], v17 offset:33792
    v_mfma_f32_16x16x32_bf16 v[156:159], v[44:47], a[60:63], v[156:159]
    s_xor_b32 s62, s62, 384
    ds_read_b64_tr_b16 v[44:45], v17 offset:40960
    ds_read_b64_tr_b16 v[46:47], v17 offset:41984
    v_mfma_f32_16x16x32_bf16 v[160:163], v[48:51], a[0:3], 0
    s_waitcnt lgkmcnt(5)
    buffer_load_dwordx4 v2, s[12:15], s60 offen nt lds
    v_mfma_f32_16x16x32_bf16 v[160:163], v[52:55], a[4:7], v[160:163]
    v_add_u32 v17, 0x10000, v17
    v_add_u32 v27, 0x10000, v27
    v_mfma_f32_16x16x32_bf16 v[164:167], v[48:51], a[8:11], 0
    ds_read_b128 a[76:79], v23 offset:51200
    v_add_u32 v28, 0x10000, v28
    v_mfma_f32_16x16x32_bf16 v[164:167], v[52:55], a[12:15], v[164:167]
    v_add_u32 v29, 0x10000, v29
    v_bfe_u32 v37, v1, 4, 4
    v_mfma_f32_16x16x32_bf16 v[168:171], v[48:51], a[16:19], 0
    buffer_load_dwordx4 v3, s[12:15], s60 offen offset:1024 nt lds
    v_mfma_f32_16x16x32_bf16 v[168:171], v[52:55], a[20:23], v[168:171]
    v_mul_u32_u24 v36, 1152, v37
    v_lshrrev_b32 v38, 8, v1
    v_mfma_f32_16x16x32_bf16 v[172:175], v[48:51], a[24:27], 0
    v_lshl_add_u32 v36, v38, 4, v36
    v_lshrrev_b32 v39, 3, v37
    v_mfma_f32_16x16x32_bf16 v[172:175], v[52:55], a[28:31], v[172:175]
    v_mul_u32_u24 v39, 9152, v39
    v_mfma_f32_16x16x32_bf16 v[176:179], v[48:51], a[32:35], 0
    buffer_load_dwordx4 v4, s[12:15], s60 offen offset:2048 nt lds
    v_mfma_f32_16x16x32_bf16 v[176:179], v[52:55], a[36:39], v[176:179]
    ds_read_b128 a[80:83], v22 offset:53248
    v_mfma_f32_16x16x32_bf16 v[180:183], v[48:51], a[40:43], 0
    v_mfma_f32_16x16x32_bf16 v[180:183], v[52:55], a[44:47], v[180:183]
    v_mfma_f32_16x16x32_bf16 v[184:187], v[48:51], a[48:51], 0
    buffer_load_dwordx4 v5, s[12:15], s60 offen offset:3072 nt lds
    v_mfma_f32_16x16x32_bf16 v[184:187], v[52:55], a[52:55], v[184:187]
    ds_read_b128 a[84:87], v23 offset:53248
    v_mfma_f32_16x16x32_bf16 v[188:191], v[48:51], a[56:59], 0
    s_add_u32 m0, s69, 114688
    v_mfma_f32_16x16x32_bf16 v[188:191], v[52:55], a[60:63], v[188:191]
    v_mfma_f32_16x16x32_bf16 v[192:195], v[56:59], a[0:3], 0
    buffer_load_dwordx4 v6, s[8:11], s61 offen lds
    v_mfma_f32_16x16x32_bf16 v[192:195], v[60:63], a[4:7], v[192:195]
    v_mfma_f32_16x16x32_bf16 v[196:199], v[56:59], a[8:11], 0
    v_mfma_f32_16x16x32_bf16 v[196:199], v[60:63], a[12:15], v[196:199]
    ds_read_b128 a[88:91], v22 offset:55296
    v_mfma_f32_16x16x32_bf16 v[200:203], v[56:59], a[16:19], 0
    buffer_load_dwordx4 v7, s[8:11], s61 offen offset:1024 lds
    v_mfma_f32_16x16x32_bf16 v[200:203], v[60:63], a[20:23], v[200:203]
    v_mfma_f32_16x16x32_bf16 v[204:207], v[56:59], a[24:27], 0
    v_mfma_f32_16x16x32_bf16 v[204:207], v[60:63], a[28:31], v[204:207]
    v_mfma_f32_16x16x32_bf16 v[208:211], v[56:59], a[32:35], 0
    buffer_load_dwordx4 v8, s[8:11], s61 offen offset:2048 lds
    v_mfma_f32_16x16x32_bf16 v[208:211], v[60:63], a[36:39], v[208:211]
    ds_read_b128 a[92:95], v23 offset:55296
    v_mfma_f32_16x16x32_bf16 v[212:215], v[56:59], a[40:43], 0
    v_mfma_f32_16x16x32_bf16 v[212:215], v[60:63], a[44:47], v[212:215]
    v_mfma_f32_16x16x32_bf16 v[216:219], v[56:59], a[48:51], 0
    buffer_load_dwordx4 v9, s[8:11], s61 offen offset:3072 lds
    v_mfma_f32_16x16x32_bf16 v[216:219], v[60:63], a[52:55], v[216:219]
    v_mfma_f32_16x16x32_bf16 v[220:223], v[56:59], a[56:59], 0
    s_xor_b32 s61, s61, 128
    v_mfma_f32_16x16x32_bf16 v[220:223], v[60:63], a[60:63], v[220:223]
    s_add_u32 m0, s69, 131072
    s_waitcnt lgkmcnt(0)
    v_mfma_f32_16x16x32_bf16 v[224:227], v[40:43], a[0:3], 0
    buffer_load_dwordx4 v2, s[16:19], s60 offen nt lds
    v_mfma_f32_16x16x32_bf16 v[224:227], v[44:47], a[4:7], v[224:227]
    v_mfma_f32_16x16x32_bf16 v[228:231], v[40:43], a[8:11], 0
    buffer_load_dword v104, v103, s[20:23], s77 offen
    v_mfma_f32_16x16x32_bf16 v[228:231], v[44:47], a[12:15], v[228:231]
    s_add_u32 s77, s77, 4608
    v_mfma_f32_16x16x32_bf16 v[232:235], v[40:43], a[16:19], 0
    v_mfma_f32_16x16x32_bf16 v[232:235], v[44:47], a[20:23], v[232:235]
    s_waitcnt vmcnt(10)
    s_barrier
    ds_read_b64_tr_b16 v[48:49], v14 offset:0
    v_mfma_f32_16x16x32_bf16 v[236:239], v[40:43], a[24:27], 0
    buffer_load_dwordx4 v3, s[16:19], s60 offen offset:1024 nt lds
    v_mfma_f32_16x16x32_bf16 v[236:239], v[44:47], a[28:31], v[236:239]
    ds_read_b64_tr_b16 v[50:51], v14 offset:1024
    ds_read_b64_tr_b16 v[52:53], v14 offset:8192
    v_mfma_f32_16x16x32_bf16 v[240:243], v[40:43], a[32:35], 0
    ds_read_b64_tr_b16 v[54:55], v14 offset:9216
    ds_read_b64_tr_b16 v[56:57], v15 offset:0
    v_mfma_f32_16x16x32_bf16 v[240:243], v[44:47], a[36:39], v[240:243]
    buffer_load_dwordx4 v4, s[16:19], s60 offen offset:2048 nt lds
    v_mfma_f32_16x16x32_bf16 v[244:247], v[40:43], a[40:43], 0
    ds_read_b64_tr_b16 v[58:59], v15 offset:1024
    ds_read_b64_tr_b16 v[60:61], v15 offset:8192
    v_mfma_f32_16x16x32_bf16 v[244:247], v[44:47], a[44:47], v[244:247]
    ds_read_b64_tr_b16 v[62:63], v15 offset:9216
    v_mfma_f32_16x16x32_bf16 v[248:251], v[40:43], a[48:51], 0
    v_mfma_f32_16x16x32_bf16 v[248:251], v[44:47], a[52:55], v[248:251]
    buffer_load_dwordx4 v5, s[16:19], s60 offen offset:3072 nt lds
    v_mfma_f32_16x16x32_bf16 v[252:255], v[40:43], a[56:59], 0
    ds_read_b64_tr_b16 v[40:41], v16 offset:0
    ds_read_b64_tr_b16 v[42:43], v16 offset:1024
    v_mfma_f32_16x16x32_bf16 v[252:255], v[44:47], a[60:63], v[252:255]
    s_waitcnt lgkmcnt(3)
    ds_read_b64_tr_b16 v[44:45], v16 offset:8192
    ds_read_b64_tr_b16 v[46:47], v16 offset:9216
    v_mfma_f32_16x16x32_bf16 a[128:131], a[0:3], v[48:51], 0
    v_mfma_f32_16x16x32_bf16 a[128:131], a[4:7], v[52:55], a[128:131]
    s_add_u32 m0, s69, 147456
    v_add_u32 v22, 0x10000, v22
    v_mfma_f32_16x16x32_bf16 a[132:135], a[8:11], v[48:51], 0
    s_xor_b32 s60, s60, 1572864
    buffer_load_dwordx4 v6, s[8:11], s62 offen lds
    v_mfma_f32_16x16x32_bf16 a[132:135], a[12:15], v[52:55], a[132:135]
    ds_read_b128 a[96:99], v22 offset:16384
    v_mfma_f32_16x16x32_bf16 a[136:139], a[16:19], v[48:51], 0
    v_mfma_f32_16x16x32_bf16 a[136:139], a[20:23], v[52:55], a[136:139]
    v_mfma_f32_16x16x32_bf16 a[140:143], a[24:27], v[48:51], 0
    buffer_load_dwordx4 v7, s[8:11], s62 offen offset:1024 lds
    v_mfma_f32_16x16x32_bf16 a[140:143], a[28:31], v[52:55], a[140:143]
    v_add_u32 v23, 0x10000, v23
    ds_read_b128 a[100:103], v23 offset:16384
    v_mfma_f32_16x16x32_bf16 a[144:147], a[32:35], v[48:51], 0
    v_mfma_f32_16x16x32_bf16 a[144:147], a[36:39], v[52:55], a[144:147]
    v_mfma_f32_16x16x32_bf16 a[148:151], a[40:43], v[48:51], 0
    v_mfma_f32_16x16x32_bf16 a[148:151], a[44:47], v[52:55], a[148:151]
    buffer_load_dwordx4 v8, s[8:11], s62 offen offset:2048 lds
    v_mfma_f32_16x16x32_bf16 a[152:155], a[48:51], v[48:51], 0
    v_mfma_f32_16x16x32_bf16 a[152:155], a[52:55], v[52:55], a[152:155]
    ds_read_b128 a[104:107], v22 offset:18432
    v_mfma_f32_16x16x32_bf16 a[156:159], a[56:59], v[48:51], 0
    ds_read_b64_tr_b16 v[48:49], v17 offset:0
    ds_read_b64_tr_b16 v[50:51], v17 offset:1024
    v_mfma_f32_16x16x32_bf16 a[156:159], a[60:63], v[52:55], a[156:159]
    buffer_load_dwordx4 v9, s[8:11], s62 offen offset:3072 lds
    v_mfma_f32_16x16x32_bf16 a[160:163], a[0:3], v[56:59], 0
    s_waitcnt lgkmcnt(3)
    ds_read_b64_tr_b16 v[52:53], v17 offset:8192
    ds_read_b64_tr_b16 v[54:55], v17 offset:9216
    v_mfma_f32_16x16x32_bf16 a[160:163], a[4:7], v[60:63], a[160:163]
    v_mfma_f32_16x16x32_bf16 a[164:167], a[8:11], v[56:59], 0
    ds_read_b128 a[108:111], v23 offset:18432
    v_mfma_f32_16x16x32_bf16 a[164:167], a[12:15], v[60:63], a[164:167]
    s_add_u32 m0, s69, 0
    v_mfma_f32_16x16x32_bf16 a[168:171], a[16:19], v[56:59], 0
    s_xor_b32 s62, s62, 128
    buffer_load_dwordx4 v2, s[12:15], s60 offen nt lds
    v_mfma_f32_16x16x32_bf16 a[168:171], a[20:23], v[60:63], a[168:171]
    v_mfma_f32_16x16x32_bf16 a[172:175], a[24:27], v[56:59], 0
    v_mfma_f32_16x16x32_bf16 a[172:175], a[28:31], v[60:63], a[172:175]
    v_mfma_f32_16x16x32_bf16 a[176:179], a[32:35], v[56:59], 0
    buffer_load_dwordx4 v3, s[12:15], s60 offen offset:1024 nt lds
    v_mfma_f32_16x16x32_bf16 a[176:179], a[36:39], v[60:63], a[176:179]
    ds_read_b128 a[112:115], v22 offset:20480
    v_mfma_f32_16x16x32_bf16 a[180:183], a[40:43], v[56:59], 0
    v_mfma_f32_16x16x32_bf16 a[180:183], a[44:47], v[60:63], a[180:183]
    v_mfma_f32_16x16x32_bf16 a[184:187], a[48:51], v[56:59], 0
    v_mfma_f32_16x16x32_bf16 a[184:187], a[52:55], v[60:63], a[184:187]
    buffer_load_dwordx4 v4, s[12:15], s60 offen offset:2048 nt lds
    v_mfma_f32_16x16x32_bf16 a[188:191], a[56:59], v[56:59], 0
    ds_read_b128 a[116:119], v23 offset:20480
    v_mfma_f32_16x16x32_bf16 a[188:191], a[60:63], v[60:63], a[188:191]
    v_mfma_f32_16x16x32_bf16 a[192:195], a[0:3], v[40:43], 0
    v_mfma_f32_16x16x32_bf16 a[192:195], a[4:7], v[44:47], a[192:195]
    buffer_load_dwordx4 v5, s[12:15], s60 offen offset:3072 nt lds
    v_mfma_f32_16x16x32_bf16 a[196:199], a[8:11], v[40:43], 0
    v_mfma_f32_16x16x32_bf16 a[196:199], a[12:15], v[44:47], a[196:199]
    ds_read_b128 a[120:123], v22 offset:22528
    v_mfma_f32_16x16x32_bf16 a[200:203], a[16:19], v[40:43], 0
    v_mfma_f32_16x16x32_bf16 a[200:203], a[20:23], v[44:47], a[200:203]
    s_add_u32 m0, s69, 16384
    v_mfma_f32_16x16x32_bf16 a[204:207], a[24:27], v[40:43], 0
    buffer_load_dwordx4 v6, s[8:11], s61 offen lds
    v_mfma_f32_16x16x32_bf16 a[204:207], a[28:31], v[44:47], a[204:207]
    v_mfma_f32_16x16x32_bf16 a[208:211], a[32:35], v[40:43], 0
    ds_read_b128 a[124:127], v23 offset:22528
    v_mfma_f32_16x16x32_bf16 a[208:211], a[36:39], v[44:47], a[208:211]
    v_mfma_f32_16x16x32_bf16 a[212:215], a[40:43], v[40:43], 0
    buffer_load_dwordx4 v7, s[8:11], s61 offen offset:1024 lds
    v_mfma_f32_16x16x32_bf16 a[212:215], a[44:47], v[44:47], a[212:215]
    v_mfma_f32_16x16x32_bf16 a[216:219], a[48:51], v[40:43], 0
    v_mfma_f32_16x16x32_bf16 a[216:219], a[52:55], v[44:47], a[216:219]
    v_mfma_f32_16x16x32_bf16 a[220:223], a[56:59], v[40:43], 0
    v_mfma_f32_16x16x32_bf16 a[220:223], a[60:63], v[44:47], a[220:223]
    s_waitcnt lgkmcnt(0)
    buffer_load_dwordx4 v8, s[8:11], s61 offen offset:2048 lds
    v_mfma_f32_16x16x32_bf16 a[224:227], a[0:3], v[48:51], 0
    v_mfma_f32_16x16x32_bf16 a[224:227], a[4:7], v[52:55], a[224:227]
    v_mfma_f32_16x16x32_bf16 a[228:231], a[8:11], v[48:51], 0
    v_mfma_f32_16x16x32_bf16 a[228:231], a[12:15], v[52:55], a[228:231]
    buffer_load_dwordx4 v9, s[8:11], s61 offen offset:3072 lds
    v_mfma_f32_16x16x32_bf16 a[232:235], a[16:19], v[48:51], 0
    v_mfma_f32_16x16x32_bf16 a[232:235], a[20:23], v[52:55], a[232:235]
    s_waitcnt vmcnt(8) lgkmcnt(0)
    s_barrier
    ds_read_b64_tr_b16 v[56:57], v14 offset:32768
    v_mfma_f32_16x16x32_bf16 a[236:239], a[24:27], v[48:51], 0
    s_add_u32 m0, s69, 32768
    ds_read_b64_tr_b16 v[58:59], v14 offset:33792
    ds_read_b64_tr_b16 v[60:61], v14 offset:40960
    v_mfma_f32_16x16x32_bf16 a[236:239], a[28:31], v[52:55], a[236:239]
    s_xor_b32 s61, s61, 896
    buffer_load_dwordx4 v2, s[16:19], s60 offen nt lds
    v_mfma_f32_16x16x32_bf16 a[240:243], a[32:35], v[48:51], 0
    ds_read_b64_tr_b16 v[62:63], v14 offset:41984
    ds_read_b64_tr_b16 v[40:41], v15 offset:32768
    v_mfma_f32_16x16x32_bf16 a[240:243], a[36:39], v[52:55], a[240:243]
    ds_read_b64_tr_b16 v[42:43], v15 offset:33792
    ds_read_b64_tr_b16 v[44:45], v15 offset:40960
    v_mfma_f32_16x16x32_bf16 a[244:247], a[40:43], v[48:51], 0
    ds_read_b64_tr_b16 v[46:47], v15 offset:41984
    v_add_u32 v14, 0x10000, v14
    v_mfma_f32_16x16x32_bf16 a[244:247], a[44:47], v[52:55], a[244:247]
    v_add_u32 v15, 0x10000, v15
    v_mfma_f32_16x16x32_bf16 a[248:251], a[48:51], v[48:51], 0
    v_mfma_f32_16x16x32_bf16 a[248:251], a[52:55], v[52:55], a[248:251]
    buffer_load_dwordx4 v3, s[16:19], s60 offen offset:1024 nt lds
    v_mfma_f32_16x16x32_bf16 a[252:255], a[56:59], v[48:51], 0
    ds_read_b64_tr_b16 v[48:49], v16 offset:32768
    ds_read_b64_tr_b16 v[50:51], v16 offset:33792
    v_mfma_f32_16x16x32_bf16 a[252:255], a[60:63], v[52:55], a[252:255]
    s_waitcnt lgkmcnt(2)
    ds_read_b64_tr_b16 v[52:53], v16 offset:40960
    ds_read_b64_tr_b16 v[54:55], v16 offset:41984
    v_mfma_f32_16x16x32_bf16 v[128:131], v[56:59], a[64:67], v[128:131]
    v_add_u32 v16, 0x10000, v16
    v_mfma_f32_16x16x32_bf16 v[128:131], v[60:63], a[68:71], v[128:131]
    v_mfma_f32_16x16x32_bf16 v[132:135], v[56:59], a[72:75], v[132:135]
    ds_read_b128 a[0:3], v22 offset:49152
    v_mfma_f32_16x16x32_bf16 v[132:135], v[60:63], a[76:79], v[132:135]
    v_mfma_f32_16x16x32_bf16 v[136:139], v[56:59], a[80:83], v[136:139]
    v_mfma_f32_16x16x32_bf16 v[136:139], v[60:63], a[84:87], v[136:139]
    buffer_load_dwordx4 v4, s[16:19], s60 offen offset:2048 nt lds
    v_mfma_f32_16x16x32_bf16 v[140:143], v[56:59], a[88:91], v[140:143]
    v_mfma_f32_16x16x32_bf16 v[140:143], v[60:63], a[92:95], v[140:143]
    ds_read_b128 a[4:7], v23 offset:49152
    v_mfma_f32_16x16x32_bf16 v[144:147], v[56:59], a[96:99], v[144:147]
    v_mfma_f32_16x16x32_bf16 v[144:147], v[60:63], a[100:103], v[144:147]
    v_mfma_f32_16x16x32_bf16 v[148:151], v[56:59], a[104:107], v[148:151]
    v_mfma_f32_16x16x32_bf16 v[148:151], v[60:63], a[108:111], v[148:151]
    v_mfma_f32_16x16x32_bf16 v[152:155], v[56:59], a[112:115], v[152:155]
    buffer_load_dwordx4 v5, s[16:19], s60 offen offset:3072 nt lds
    v_mfma_f32_16x16x32_bf16 v[152:155], v[60:63], a[116:119], v[152:155]
    ds_read_b128 a[8:11], v22 offset:51200
    v_mfma_f32_16x16x32_bf16 v[156:159], v[56:59], a[120:123], v[156:159]
    ds_read_b64_tr_b16 v[56:57], v17 offset:32768
    ds_read_b64_tr_b16 v[58:59], v17 offset:33792
    v_mfma_f32_16x16x32_bf16 v[156:159], v[60:63], a[124:127], v[156:159]
    ds_read_b64_tr_b16 v[60:61], v17 offset:40960
    ds_read_b64_tr_b16 v[62:63], v17 offset:41984
    v_mfma_f32_16x16x32_bf16 v[160:163], v[40:43], a[64:67], v[160:163]
    v_add_u32 v17, 0x10000, v17
    v_mfma_f32_16x16x32_bf16 v[160:163], v[44:47], a[68:71], v[160:163]
    v_mfma_f32_16x16x32_bf16 v[164:167], v[40:43], a[72:75], v[164:167]
    ds_read_b128 a[12:15], v23 offset:51200
    v_mfma_f32_16x16x32_bf16 v[164:167], v[44:47], a[76:79], v[164:167]
    s_add_u32 m0, s69, 49152
    v_mfma_f32_16x16x32_bf16 v[168:171], v[40:43], a[80:83], v[168:171]
    s_xor_b32 s60, s60, 524288
    buffer_load_dwordx4 v6, s[8:11], s62 offen lds
    v_mfma_f32_16x16x32_bf16 v[168:171], v[44:47], a[84:87], v[168:171]
    v_mfma_f32_16x16x32_bf16 v[172:175], v[40:43], a[88:91], v[172:175]
    v_mfma_f32_16x16x32_bf16 v[172:175], v[44:47], a[92:95], v[172:175]
    v_mfma_f32_16x16x32_bf16 v[176:179], v[40:43], a[96:99], v[176:179]
    ds_read_b128 a[16:19], v22 offset:53248
    v_mfma_f32_16x16x32_bf16 v[176:179], v[44:47], a[100:103], v[176:179]
    v_mfma_f32_16x16x32_bf16 v[180:183], v[40:43], a[104:107], v[180:183]
    v_mfma_f32_16x16x32_bf16 v[180:183], v[44:47], a[108:111], v[180:183]
    buffer_load_dwordx4 v7, s[8:11], s62 offen offset:1024 lds
    v_mfma_f32_16x16x32_bf16 v[184:187], v[40:43], a[112:115], v[184:187]
    v_mfma_f32_16x16x32_bf16 v[184:187], v[44:47], a[116:119], v[184:187]
    ds_read_b128 a[20:23], v23 offset:53248
    v_mfma_f32_16x16x32_bf16 v[188:191], v[40:43], a[120:123], v[188:191]
    s_waitcnt lgkmcnt(1)
    ds_read_b64_tr_b16 v[40:41], v14 offset:0
    ds_read_b64_tr_b16 v[42:43], v14 offset:1024
    v_mfma_f32_16x16x32_bf16 v[188:191], v[44:47], a[124:127], v[188:191]
    ds_read_b64_tr_b16 v[44:45], v14 offset:8192
    ds_read_b64_tr_b16 v[46:47], v14 offset:9216
    v_mfma_f32_16x16x32_bf16 v[192:195], v[48:51], a[64:67], v[192:195]
    v_add_u32 v14, 0xfffe0000, v14
    v_mfma_f32_16x16x32_bf16 v[192:195], v[52:55], a[68:71], v[192:195]
    v_mfma_f32_16x16x32_bf16 v[196:199], v[48:51], a[72:75], v[196:199]
    v_mfma_f32_16x16x32_bf16 v[196:199], v[52:55], a[76:79], v[196:199]
    buffer_load_dwordx4 v8, s[8:11], s62 offen offset:2048 lds
    v_mfma_f32_16x16x32_bf16 v[200:203], v[48:51], a[80:83], v[200:203]
    ds_read_b128 a[24:27], v22 offset:55296
    v_mfma_f32_16x16x32_bf16 v[200:203], v[52:55], a[84:87], v[200:203]
    v_mfma_f32_16x16x32_bf16 v[204:207], v[48:51], a[88:91], v[204:207]
    v_mfma_f32_16x16x32_bf16 v[204:207], v[52:55], a[92:95], v[204:207]
    v_mfma_f32_16x16x32_bf16 v[208:211], v[48:51], a[96:99], v[208:211]
    ds_read_b128 a[28:31], v23 offset:55296
    v_mfma_f32_16x16x32_bf16 v[208:211], v[52:55], a[100:103], v[208:211]
    v_mfma_f32_16x16x32_bf16 v[212:215], v[48:51], a[104:107], v[212:215]
    buffer_load_dwordx4 v9, s[8:11], s62 offen offset:3072 lds
    v_mfma_f32_16x16x32_bf16 v[212:215], v[52:55], a[108:111], v[212:215]
    v_mfma_f32_16x16x32_bf16 v[216:219], v[48:51], a[112:115], v[216:219]
    v_mfma_f32_16x16x32_bf16 v[216:219], v[52:55], a[116:119], v[216:219]
    v_mfma_f32_16x16x32_bf16 v[220:223], v[48:51], a[120:123], v[220:223]
    ds_read_b64_tr_b16 v[48:49], v15 offset:0
    ds_read_b64_tr_b16 v[50:51], v15 offset:1024
    v_mfma_f32_16x16x32_bf16 v[220:223], v[52:55], a[124:127], v[220:223]
    ds_read_b64_tr_b16 v[52:53], v15 offset:8192
    ds_read_b64_tr_b16 v[54:55], v15 offset:9216
    v_mfma_f32_16x16x32_bf16 v[224:227], v[56:59], a[64:67], v[224:227]
    buffer_load_dwordx2 v[80:81], v75, s[28:31], s98 offen nt
    v_mfma_f32_16x16x32_bf16 v[224:227], v[60:63], a[68:71], v[224:227]
    s_xor_b32 s62, s62, 896
    v_add_u32 v15, 0xfffe0000, v15
    v_mfma_f32_16x16x32_bf16 v[228:231], v[56:59], a[72:75], v[228:231]
    buffer_load_dword v105, v103, s[20:23], s77 offen
    v_mfma_f32_16x16x32_bf16 v[228:231], v[60:63], a[76:79], v[228:231]
    s_mul_i32 s77, s2, 18432
    v_mfma_f32_16x16x32_bf16 v[232:235], v[56:59], a[80:83], v[232:235]
    s_add_u32 s77, s77, s76
    buffer_load_dwordx2 v[82:83], v77, s[28:31], s98 offen nt
    v_mfma_f32_16x16x32_bf16 v[232:235], v[60:63], a[84:87], v[232:235]
    s_add_u32 s98, s98, 3456
    v_mfma_f32_16x16x32_bf16 v[236:239], v[56:59], a[88:91], v[236:239]
    s_add_u32 m0, s69, 65536
    v_mfma_f32_16x16x32_bf16 v[236:239], v[60:63], a[92:95], v[236:239]
    s_mov_b32 s76, 0
    v_mfma_f32_16x16x32_bf16 v[240:243], v[56:59], a[96:99], v[240:243]
    buffer_load_ushort v92, v65, s[32:35], s99 offen offset:0
    v_mfma_f32_16x16x32_bf16 v[240:243], v[60:63], a[100:103], v[240:243]
    v_mfma_f32_16x16x32_bf16 v[244:247], v[56:59], a[104:107], v[244:247]
    v_mfma_f32_16x16x32_bf16 v[244:247], v[60:63], a[108:111], v[244:247]
    v_mfma_f32_16x16x32_bf16 v[248:251], v[56:59], a[112:115], v[248:251]
    buffer_load_dwordx2 v[84:85], v75, s[28:31], s98 offen nt
    v_mfma_f32_16x16x32_bf16 v[248:251], v[60:63], a[116:119], v[248:251]
    v_mfma_f32_16x16x32_bf16 v[252:255], v[56:59], a[120:123], v[252:255]
    ds_read_b64_tr_b16 v[56:57], v16 offset:0
    ds_read_b64_tr_b16 v[58:59], v16 offset:1024
    v_mfma_f32_16x16x32_bf16 v[252:255], v[60:63], a[124:127], v[252:255]
    s_waitcnt lgkmcnt(2)
    ds_read_b64_tr_b16 v[60:61], v16 offset:8192
    ds_read_b64_tr_b16 v[62:63], v16 offset:9216
    v_mfma_f32_16x16x32_bf16 a[128:131], a[64:67], v[40:43], a[128:131]
    buffer_load_dwordx4 v2, s[12:15], s60 offen nt lds
    v_mfma_f32_16x16x32_bf16 a[128:131], a[68:71], v[44:47], a[128:131]
    v_add_u32 v22, 0x10000, v22
    v_add_u32 v16, 0xfffe0000, v16
    v_mfma_f32_16x16x32_bf16 a[132:135], a[72:75], v[40:43], a[132:135]
    ds_read_b128 a[32:35], v22 offset:16384
    v_mfma_f32_16x16x32_bf16 a[132:135], a[76:79], v[44:47], a[132:135]
    v_mfma_f32_16x16x32_bf16 a[136:139], a[80:83], v[40:43], a[136:139]
    buffer_load_dwordx2 v[86:87], v77, s[28:31], s98 offen nt
    v_mfma_f32_16x16x32_bf16 a[136:139], a[84:87], v[44:47], a[136:139]
    s_add_u32 s98, s98, 3456
    v_mfma_f32_16x16x32_bf16 a[140:143], a[88:91], v[40:43], a[140:143]
    v_add_u32 v23, 0x10000, v23
    v_mfma_f32_16x16x32_bf16 a[140:143], a[92:95], v[44:47], a[140:143]
    ds_read_b128 a[36:39], v23 offset:16384
    v_mfma_f32_16x16x32_bf16 a[144:147], a[96:99], v[40:43], a[144:147]
    buffer_load_ushort v93, v65, s[32:35], s99 offen offset:2
    v_mfma_f32_16x16x32_bf16 a[144:147], a[100:103], v[44:47], a[144:147]
    v_mfma_f32_16x16x32_bf16 a[148:151], a[104:107], v[40:43], a[148:151]
    v_mfma_f32_16x16x32_bf16 a[148:151], a[108:111], v[44:47], a[148:151]
    v_mfma_f32_16x16x32_bf16 a[152:155], a[112:115], v[40:43], a[152:155]
    buffer_load_dwordx2 v[88:89], v75, s[28:31], s98 offen nt
    v_mfma_f32_16x16x32_bf16 a[152:155], a[116:119], v[44:47], a[152:155]
    ds_read_b128 a[40:43], v22 offset:18432
    v_mfma_f32_16x16x32_bf16 a[156:159], a[120:123], v[40:43], a[156:159]
    ds_read_b64_tr_b16 v[40:41], v17 offset:0
    ds_read_b64_tr_b16 v[42:43], v17 offset:1024
    v_mfma_f32_16x16x32_bf16 a[156:159], a[124:127], v[44:47], a[156:159]
    ds_read_b64_tr_b16 v[44:45], v17 offset:8192
    ds_read_b64_tr_b16 v[46:47], v17 offset:9216
    v_mfma_f32_16x16x32_bf16 a[160:163], a[64:67], v[48:51], a[160:163]
    buffer_load_dwordx4 v3, s[12:15], s60 offen offset:1024 nt lds
    v_mfma_f32_16x16x32_bf16 a[160:163], a[68:71], v[52:55], a[160:163]
    v_add_u32 v17, 0xfffe0000, v17
    v_mfma_f32_16x16x32_bf16 a[164:167], a[72:75], v[48:51], a[164:167]
    ds_read_b128 a[44:47], v23 offset:18432
    v_mfma_f32_16x16x32_bf16 a[164:167], a[76:79], v[52:55], a[164:167]
    v_mfma_f32_16x16x32_bf16 a[168:171], a[80:83], v[48:51], a[168:171]
    buffer_load_dwordx2 v[90:91], v77, s[28:31], s98 offen nt
    v_mfma_f32_16x16x32_bf16 a[168:171], a[84:87], v[52:55], a[168:171]
    s_add_u32 s98, s98, 3456
    s_add_u32 s28, s56, 6291456
    s_addc_u32 s29, s57, 0
    v_mfma_f32_16x16x32_bf16 a[172:175], a[88:91], v[48:51], a[172:175]
    s_mov_b32 s30, 2359296
    v_mfma_f32_16x16x32_bf16 a[172:175], a[92:95], v[52:55], a[172:175]
    s_bfe_u32 s98, s72, 0x10001
    v_mfma_f32_16x16x32_bf16 a[176:179], a[96:99], v[48:51], a[176:179]
    buffer_load_ushort v94, v65, s[32:35], s99 offen offset:4
    v_mfma_f32_16x16x32_bf16 a[176:179], a[100:103], v[52:55], a[176:179]
    s_add_u32 s32, s56, 9437184
    s_addc_u32 s33, s57, 0
    s_mov_b32 s34, 163840
    v_mfma_f32_16x16x32_bf16 a[180:183], a[104:107], v[48:51], a[180:183]
    s_bfe_u32 s99, s72, 0x10003
    ds_read_b128 a[48:51], v22 offset:20480
    v_mfma_f32_16x16x32_bf16 a[180:183], a[108:111], v[52:55], a[180:183]
    s_lshl1_add_u32 s98, s99, s98
    v_mfma_f32_16x16x32_bf16 a[184:187], a[112:115], v[48:51], a[184:187]
    s_lshl_b32 s98, s98, 5
    buffer_store_dword v65, v64, s[32:35], s101 offen sc1
    v_mfma_f32_16x16x32_bf16 a[184:187], a[116:119], v[52:55], a[184:187]
    s_lshl_b32 s72, s72, 7
    ds_read_b128 a[52:55], v23 offset:20480
    v_mfma_f32_16x16x32_bf16 a[188:191], a[120:123], v[48:51], a[188:191]
    v_mfma_f32_16x16x32_bf16 a[188:191], a[124:127], v[52:55], a[188:191]
    s_waitcnt lgkmcnt(1)
    v_mfma_f32_16x16x32_bf16 a[192:195], a[64:67], v[56:59], a[192:195]
    buffer_load_dwordx4 v4, s[12:15], s60 offen offset:2048 nt lds
    v_mfma_f32_16x16x32_bf16 a[192:195], a[68:71], v[60:63], a[192:195]
    v_mfma_f32_16x16x32_bf16 a[196:199], a[72:75], v[56:59], a[196:199]
    v_mfma_f32_16x16x32_bf16 a[196:199], a[76:79], v[60:63], a[196:199]
    ds_read_b128 a[56:59], v22 offset:22528
    v_mfma_f32_16x16x32_bf16 a[200:203], a[80:83], v[56:59], a[200:203]
    buffer_load_dwordx4 v5, s[12:15], s60 offen offset:3072 nt lds
    v_mfma_f32_16x16x32_bf16 a[200:203], a[84:87], v[60:63], a[200:203]
    s_add_u32 m0, s69, 81920
    v_mfma_f32_16x16x32_bf16 a[204:207], a[88:91], v[56:59], a[204:207]
    v_mfma_f32_16x16x32_bf16 a[204:207], a[92:95], v[60:63], a[204:207]
    v_mfma_f32_16x16x32_bf16 a[208:211], a[96:99], v[56:59], a[208:211]
    buffer_load_dwordx4 v6, s[8:11], s61 offen lds
    v_mfma_f32_16x16x32_bf16 a[208:211], a[100:103], v[60:63], a[208:211]
    ds_read_b128 a[60:63], v23 offset:22528
    v_mfma_f32_16x16x32_bf16 a[212:215], a[104:107], v[56:59], a[212:215]
    v_mfma_f32_16x16x32_bf16 a[212:215], a[108:111], v[60:63], a[212:215]
    v_mfma_f32_16x16x32_bf16 a[216:219], a[112:115], v[56:59], a[216:219]
    buffer_load_dwordx4 v7, s[8:11], s61 offen offset:1024 lds
    v_mfma_f32_16x16x32_bf16 a[216:219], a[116:119], v[60:63], a[216:219]
    v_mfma_f32_16x16x32_bf16 a[220:223], a[120:123], v[56:59], a[220:223]
    v_mfma_f32_16x16x32_bf16 a[220:223], a[124:127], v[60:63], a[220:223]
    v_mfma_f32_16x16x32_bf16 a[224:227], a[64:67], v[40:43], a[224:227]
    buffer_load_dwordx4 v8, s[8:11], s61 offen offset:2048 lds
    v_mfma_f32_16x16x32_bf16 a[224:227], a[68:71], v[44:47], a[224:227]
    v_mfma_f32_16x16x32_bf16 a[228:231], a[72:75], v[40:43], a[228:231]
    v_mfma_f32_16x16x32_bf16 a[228:231], a[76:79], v[44:47], a[228:231]
    v_mfma_f32_16x16x32_bf16 a[232:235], a[80:83], v[40:43], a[232:235]
    buffer_load_dwordx4 v9, s[8:11], s61 offen offset:3072 lds
    v_mfma_f32_16x16x32_bf16 a[232:235], a[84:87], v[44:47], a[232:235]
    s_xor_b32 s61, s61, 128
    s_waitcnt vmcnt(19) lgkmcnt(0)
    s_barrier
    v_mfma_f32_16x16x32_bf16 a[236:239], a[88:91], v[40:43], a[236:239]
    s_add_u32 m0, s69, 98304
    ds_read_b64_tr_b16 v[48:49], v14 offset:0
    ds_read_b64_tr_b16 v[50:51], v14 offset:1024
    v_mfma_f32_16x16x32_bf16 a[236:239], a[92:95], v[44:47], a[236:239]
    ds_read_b64_tr_b16 v[52:53], v14 offset:8192
    ds_read_b64_tr_b16 v[54:55], v14 offset:9216
    v_mfma_f32_16x16x32_bf16 a[240:243], a[96:99], v[40:43], a[240:243]
    buffer_load_dwordx4 v2, s[16:19], s60 offen nt lds
    v_mfma_f32_16x16x32_bf16 a[240:243], a[100:103], v[44:47], a[240:243]
    ds_read_b64_tr_b16 v[56:57], v15 offset:0
    ds_read_b64_tr_b16 v[58:59], v15 offset:1024
    v_mfma_f32_16x16x32_bf16 a[244:247], a[104:107], v[40:43], a[244:247]
    ds_read_b64_tr_b16 v[60:61], v15 offset:8192
    ds_read_b64_tr_b16 v[62:63], v15 offset:9216
    v_mfma_f32_16x16x32_bf16 a[244:247], a[108:111], v[44:47], a[244:247]
    s_cmp_lt_u32 s2, 192
    s_cselect_b32 s72, s72, 1073741824
    v_mfma_f32_16x16x32_bf16 a[248:251], a[112:115], v[40:43], a[248:251]
    v_mfma_f32_16x16x32_bf16 a[248:251], a[116:119], v[44:47], a[248:251]
    buffer_load_dwordx4 v3, s[16:19], s60 offen offset:1024 nt lds
    v_mfma_f32_16x16x32_bf16 a[252:255], a[120:123], v[40:43], a[252:255]
    ds_read_b64_tr_b16 v[40:41], v16 offset:0
    ds_read_b64_tr_b16 v[42:43], v16 offset:1024
    v_mfma_f32_16x16x32_bf16 a[252:255], a[124:127], v[44:47], a[252:255]
    s_waitcnt lgkmcnt(2)
    ds_read_b64_tr_b16 v[44:45], v16 offset:8192
    ds_read_b64_tr_b16 v[46:47], v16 offset:9216
    v_mfma_f32_16x16x32_bf16 v[128:131], v[48:51], a[0:3], v[128:131]
    v_mfma_f32_16x16x32_bf16 v[128:131], v[52:55], a[4:7], v[128:131]
    v_add_u32 v22, 0xfffe0000, v22
    v_mfma_f32_16x16x32_bf16 v[132:135], v[48:51], a[8:11], v[132:135]
    ds_read_b128 a[64:67], v22 offset:16384
    v_mfma_f32_16x16x32_bf16 v[132:135], v[52:55], a[12:15], v[132:135]
    v_mfma_f32_16x16x32_bf16 v[136:139], v[48:51], a[16:19], v[136:139]
    v_mfma_f32_16x16x32_bf16 v[136:139], v[52:55], a[20:23], v[136:139]
    buffer_load_dwordx4 v4, s[16:19], s60 offen offset:2048 nt lds
    v_mfma_f32_16x16x32_bf16 v[140:143], v[48:51], a[24:27], v[140:143]
    v_add_u32 v23, 0xfffe0000, v23
    v_mfma_f32_16x16x32_bf16 v[140:143], v[52:55], a[28:31], v[140:143]
    ds_read_b128 a[68:71], v23 offset:16384
    v_mfma_f32_16x16x32_bf16 v[144:147], v[48:51], a[32:35], v[144:147]
    v_mfma_f32_16x16x32_bf16 v[144:147], v[52:55], a[36:39], v[144:147]
    v_mfma_f32_16x16x32_bf16 v[148:151], v[48:51], a[40:43], v[148:151]
    v_mfma_f32_16x16x32_bf16 v[148:151], v[52:55], a[44:47], v[148:151]
    v_mfma_f32_16x16x32_bf16 v[152:155], v[48:51], a[48:51], v[152:155]
    buffer_load_dwordx4 v5, s[16:19], s60 offen offset:3072 nt lds
    v_mfma_f32_16x16x32_bf16 v[152:155], v[52:55], a[52:55], v[152:155]
    ds_read_b128 a[72:75], v22 offset:18432
    v_mfma_f32_16x16x32_bf16 v[156:159], v[48:51], a[56:59], v[156:159]
    ds_read_b64_tr_b16 v[48:49], v17 offset:0
    ds_read_b64_tr_b16 v[50:51], v17 offset:1024
    v_mfma_f32_16x16x32_bf16 v[156:159], v[52:55], a[60:63], v[156:159]
    ds_read_b64_tr_b16 v[52:53], v17 offset:8192
    ds_read_b64_tr_b16 v[54:55], v17 offset:9216
    v_mfma_f32_16x16x32_bf16 v[160:163], v[56:59], a[0:3], v[160:163]
    v_mfma_f32_16x16x32_bf16 v[160:163], v[60:63], a[4:7], v[160:163]
    v_mfma_f32_16x16x32_bf16 v[164:167], v[56:59], a[8:11], v[164:167]
    ds_read_b128 a[76:79], v23 offset:18432
    v_mfma_f32_16x16x32_bf16 v[164:167], v[60:63], a[12:15], v[164:167]
    s_add_u32 m0, s69, 114688
    v_mfma_f32_16x16x32_bf16 v[168:171], v[56:59], a[16:19], v[168:171]
    s_xor_b32 s60, s60, 3670016
    buffer_load_dwordx4 v6, s[8:11], s62 offen lds
    v_mfma_f32_16x16x32_bf16 v[168:171], v[60:63], a[20:23], v[168:171]
    v_mfma_f32_16x16x32_bf16 v[172:175], v[56:59], a[24:27], v[172:175]
    v_mfma_f32_16x16x32_bf16 v[172:175], v[60:63], a[28:31], v[172:175]
    v_mfma_f32_16x16x32_bf16 v[176:179], v[56:59], a[32:35], v[176:179]
    ds_read_b128 a[80:83], v22 offset:20480
    v_mfma_f32_16x16x32_bf16 v[176:179], v[60:63], a[36:39], v[176:179]
    v_mfma_f32_16x16x32_bf16 v[180:183], v[56:59], a[40:43], v[180:183]
    v_mfma_f32_16x16x32_bf16 v[180:183], v[60:63], a[44:47], v[180:183]
    buffer_load_dwordx4 v7, s[8:11], s62 offen offset:1024 lds
    v_mfma_f32_16x16x32_bf16 v[184:187], v[56:59], a[48:51], v[184:187]
    v_mfma_f32_16x16x32_bf16 v[184:187], v[60:63], a[52:55], v[184:187]
    ds_read_b128 a[84:87], v23 offset:20480
    v_mfma_f32_16x16x32_bf16 v[188:191], v[56:59], a[56:59], v[188:191]
    s_waitcnt lgkmcnt(1)
    ds_read_b64_tr_b16 v[56:57], v14 offset:32768
    ds_read_b64_tr_b16 v[58:59], v14 offset:33792
    v_mfma_f32_16x16x32_bf16 v[188:191], v[60:63], a[60:63], v[188:191]
    ds_read_b64_tr_b16 v[60:61], v14 offset:40960
    ds_read_b64_tr_b16 v[62:63], v14 offset:41984
    v_mfma_f32_16x16x32_bf16 v[192:195], v[40:43], a[0:3], v[192:195]
    v_add_u32 v14, 0x10000, v14
    v_mfma_f32_16x16x32_bf16 v[192:195], v[44:47], a[4:7], v[192:195]
    v_mfma_f32_16x16x32_bf16 v[196:199], v[40:43], a[8:11], v[196:199]
    v_mfma_f32_16x16x32_bf16 v[196:199], v[44:47], a[12:15], v[196:199]
    buffer_load_dwordx4 v8, s[8:11], s62 offen offset:2048 lds
    v_mfma_f32_16x16x32_bf16 v[200:203], v[40:43], a[16:19], v[200:203]
    ds_read_b128 a[88:91], v22 offset:22528
    v_mfma_f32_16x16x32_bf16 v[200:203], v[44:47], a[20:23], v[200:203]
    v_mfma_f32_16x16x32_bf16 v[204:207], v[40:43], a[24:27], v[204:207]
    v_mfma_f32_16x16x32_bf16 v[204:207], v[44:47], a[28:31], v[204:207]
    v_mfma_f32_16x16x32_bf16 v[208:211], v[40:43], a[32:35], v[208:211]
    ds_read_b128 a[92:95], v23 offset:22528
    v_mfma_f32_16x16x32_bf16 v[208:211], v[44:47], a[36:39], v[208:211]
    v_mfma_f32_16x16x32_bf16 v[212:215], v[40:43], a[40:43], v[212:215]
    buffer_load_dwordx4 v9, s[8:11], s62 offen offset:3072 lds
    v_mfma_f32_16x16x32_bf16 v[212:215], v[44:47], a[44:47], v[212:215]
    v_mfma_f32_16x16x32_bf16 v[216:219], v[40:43], a[48:51], v[216:219]
    v_mfma_f32_16x16x32_bf16 v[216:219], v[44:47], a[52:55], v[216:219]
    v_mfma_f32_16x16x32_bf16 v[220:223], v[40:43], a[56:59], v[220:223]
    ds_read_b64_tr_b16 v[40:41], v15 offset:32768
    ds_read_b64_tr_b16 v[42:43], v15 offset:33792
    v_mfma_f32_16x16x32_bf16 v[220:223], v[44:47], a[60:63], v[220:223]
    ds_read_b64_tr_b16 v[44:45], v15 offset:40960
    ds_read_b64_tr_b16 v[46:47], v15 offset:41984
    v_mfma_f32_16x16x32_bf16 v[224:227], v[48:51], a[0:3], v[224:227]
    v_add_u32 v15, 0x10000, v15
    v_mfma_f32_16x16x32_bf16 v[224:227], v[52:55], a[4:7], v[224:227]
    s_xor_b32 s62, s62, 128
    v_mfma_f32_16x16x32_bf16 v[228:231], v[48:51], a[8:11], v[228:231]
    buffer_load_dword v106, v103, s[24:27], s77 offen
    v_mfma_f32_16x16x32_bf16 v[228:231], v[52:55], a[12:15], v[228:231]
    s_add_u32 s77, s77, 4608
    v_mfma_f32_16x16x32_bf16 v[232:235], v[48:51], a[16:19], v[232:235]
    v_mfma_f32_16x16x32_bf16 v[232:235], v[52:55], a[20:23], v[232:235]
    s_add_u32 m0, s69, 131072
    v_mfma_f32_16x16x32_bf16 v[236:239], v[48:51], a[24:27], v[236:239]
    buffer_load_dwordx4 v2, s[12:15], s60 offen nt lds
    v_mfma_f32_16x16x32_bf16 v[236:239], v[52:55], a[28:31], v[236:239]
    v_mfma_f32_16x16x32_bf16 v[240:243], v[48:51], a[32:35], v[240:243]
    v_mfma_f32_16x16x32_bf16 v[240:243], v[52:55], a[36:39], v[240:243]
    v_mfma_f32_16x16x32_bf16 v[244:247], v[48:51], a[40:43], v[244:247]
    v_mfma_f32_16x16x32_bf16 v[244:247], v[52:55], a[44:47], v[244:247]
    v_mfma_f32_16x16x32_bf16 v[248:251], v[48:51], a[48:51], v[248:251]
    v_mfma_f32_16x16x32_bf16 v[248:251], v[52:55], a[52:55], v[248:251]
    buffer_load_dwordx4 v3, s[12:15], s60 offen offset:1024 nt lds
    v_mfma_f32_16x16x32_bf16 v[252:255], v[48:51], a[56:59], v[252:255]
    ds_read_b64_tr_b16 v[48:49], v16 offset:32768
    ds_read_b64_tr_b16 v[50:51], v16 offset:33792
    v_mfma_f32_16x16x32_bf16 v[252:255], v[52:55], a[60:63], v[252:255]
    s_waitcnt lgkmcnt(2)
    ds_read_b64_tr_b16 v[52:53], v16 offset:40960
    ds_read_b64_tr_b16 v[54:55], v16 offset:41984
    v_mfma_f32_16x16x32_bf16 a[128:131], a[0:3], v[56:59], a[128:131]
    v_add_u32 v16, 0x10000, v16
    v_mfma_f32_16x16x32_bf16 a[128:131], a[4:7], v[60:63], a[128:131]
    v_mfma_f32_16x16x32_bf16 a[132:135], a[8:11], v[56:59], a[132:135]
    ds_read_b128 a[96:99], v22 offset:49152
    v_mfma_f32_16x16x32_bf16 a[132:135], a[12:15], v[60:63], a[132:135]
    v_mfma_f32_16x16x32_bf16 a[136:139], a[16:19], v[56:59], a[136:139]
    v_mfma_f32_16x16x32_bf16 a[136:139], a[20:23], v[60:63], a[136:139]
    buffer_load_dwordx4 v4, s[12:15], s60 offen offset:2048 nt lds
    v_mfma_f32_16x16x32_bf16 a[140:143], a[24:27], v[56:59], a[140:143]
    v_mfma_f32_16x16x32_bf16 a[140:143], a[28:31], v[60:63], a[140:143]
    ds_read_b128 a[100:103], v23 offset:49152
    v_mfma_f32_16x16x32_bf16 a[144:147], a[32:35], v[56:59], a[144:147]
    v_mfma_f32_16x16x32_bf16 a[144:147], a[36:39], v[60:63], a[144:147]
    v_mfma_f32_16x16x32_bf16 a[148:151], a[40:43], v[56:59], a[148:151]
    v_mfma_f32_16x16x32_bf16 a[148:151], a[44:47], v[60:63], a[148:151]
    v_mfma_f32_16x16x32_bf16 a[152:155], a[48:51], v[56:59], a[152:155]
    buffer_load_dwordx4 v5, s[12:15], s60 offen offset:3072 nt lds
    v_mfma_f32_16x16x32_bf16 a[152:155], a[52:55], v[60:63], a[152:155]
    ds_read_b128 a[104:107], v22 offset:51200
    v_mfma_f32_16x16x32_bf16 a[156:159], a[56:59], v[56:59], a[156:159]
    ds_read_b64_tr_b16 v[56:57], v17 offset:32768
    ds_read_b64_tr_b16 v[58:59], v17 offset:33792
    v_mfma_f32_16x16x32_bf16 a[156:159], a[60:63], v[60:63], a[156:159]
    ds_read_b64_tr_b16 v[60:61], v17 offset:40960
    ds_read_b64_tr_b16 v[62:63], v17 offset:41984
    v_mfma_f32_16x16x32_bf16 a[160:163], a[0:3], v[40:43], a[160:163]
    v_add_u32 v17, 0x10000, v17
    v_mfma_f32_16x16x32_bf16 a[160:163], a[4:7], v[44:47], a[160:163]
    v_mfma_f32_16x16x32_bf16 a[164:167], a[8:11], v[40:43], a[164:167]
    ds_read_b128 a[108:111], v23 offset:51200
    v_mfma_f32_16x16x32_bf16 a[164:167], a[12:15], v[44:47], a[164:167]
    s_add_u32 m0, s69, 147456
    v_mfma_f32_16x16x32_bf16 a[168:171], a[16:19], v[40:43], a[168:171]
    buffer_load_dwordx4 v6, s[8:11], s61 offen lds
    v_mfma_f32_16x16x32_bf16 a[168:171], a[20:23], v[44:47], a[168:171]
    v_mfma_f32_16x16x32_bf16 a[172:175], a[24:27], v[40:43], a[172:175]
    v_mfma_f32_16x16x32_bf16 a[172:175], a[28:31], v[44:47], a[172:175]
    v_mfma_f32_16x16x32_bf16 a[176:179], a[32:35], v[40:43], a[176:179]
    ds_read_b128 a[112:115], v22 offset:53248
    v_mfma_f32_16x16x32_bf16 a[176:179], a[36:39], v[44:47], a[176:179]
    v_mfma_f32_16x16x32_bf16 a[180:183], a[40:43], v[40:43], a[180:183]
    v_mfma_f32_16x16x32_bf16 a[180:183], a[44:47], v[44:47], a[180:183]
    buffer_load_dwordx4 v7, s[8:11], s61 offen offset:1024 lds
    v_mfma_f32_16x16x32_bf16 a[184:187], a[48:51], v[40:43], a[184:187]
    v_mfma_f32_16x16x32_bf16 a[184:187], a[52:55], v[44:47], a[184:187]
    ds_read_b128 a[116:119], v23 offset:53248
    v_mfma_f32_16x16x32_bf16 a[188:191], a[56:59], v[40:43], a[188:191]
    v_mfma_f32_16x16x32_bf16 a[188:191], a[60:63], v[44:47], a[188:191]
    s_waitcnt lgkmcnt(1)
    v_mfma_f32_16x16x32_bf16 a[192:195], a[0:3], v[48:51], a[192:195]
    v_mfma_f32_16x16x32_bf16 a[192:195], a[4:7], v[52:55], a[192:195]
    v_mfma_f32_16x16x32_bf16 a[196:199], a[8:11], v[48:51], a[196:199]
    v_mfma_f32_16x16x32_bf16 a[196:199], a[12:15], v[52:55], a[196:199]
    buffer_load_dwordx4 v8, s[8:11], s61 offen offset:2048 lds
    v_mfma_f32_16x16x32_bf16 a[200:203], a[16:19], v[48:51], a[200:203]
    ds_read_b128 a[120:123], v22 offset:55296
    v_mfma_f32_16x16x32_bf16 a[200:203], a[20:23], v[52:55], a[200:203]
    v_mfma_f32_16x16x32_bf16 a[204:207], a[24:27], v[48:51], a[204:207]
    v_mfma_f32_16x16x32_bf16 a[204:207], a[28:31], v[52:55], a[204:207]
    v_mfma_f32_16x16x32_bf16 a[208:211], a[32:35], v[48:51], a[208:211]
    ds_read_b128 a[124:127], v23 offset:55296
    v_mfma_f32_16x16x32_bf16 a[208:211], a[36:39], v[52:55], a[208:211]
    v_mfma_f32_16x16x32_bf16 a[212:215], a[40:43], v[48:51], a[212:215]
    buffer_load_dwordx4 v9, s[8:11], s61 offen offset:3072 lds
    v_mfma_f32_16x16x32_bf16 a[212:215], a[44:47], v[52:55], a[212:215]
    v_mfma_f32_16x16x32_bf16 a[216:219], a[48:51], v[48:51], a[216:219]
    v_mfma_f32_16x16x32_bf16 a[216:219], a[52:55], v[52:55], a[216:219]
    v_mfma_f32_16x16x32_bf16 a[220:223], a[56:59], v[48:51], a[220:223]
    v_mfma_f32_16x16x32_bf16 a[220:223], a[60:63], v[52:55], a[220:223]
    v_mfma_f32_16x16x32_bf16 a[224:227], a[0:3], v[56:59], a[224:227]
    v_mfma_f32_16x16x32_bf16 a[224:227], a[4:7], v[60:63], a[224:227]
    s_xor_b32 s61, s61, 384
    v_mfma_f32_16x16x32_bf16 a[228:231], a[8:11], v[56:59], a[228:231]
    v_mfma_f32_16x16x32_bf16 a[228:231], a[12:15], v[60:63], a[228:231]
    v_mfma_f32_16x16x32_bf16 a[232:235], a[16:19], v[56:59], a[232:235]
    v_mfma_f32_16x16x32_bf16 a[232:235], a[20:23], v[60:63], a[232:235]
    s_waitcnt vmcnt(9) lgkmcnt(0)
    s_barrier
    ds_read_b64_tr_b16 v[40:41], v14 offset:0
    v_mfma_f32_16x16x32_bf16 a[236:239], a[24:27], v[56:59], a[236:239]
    s_add_u32 m0, s69, 0
    ds_read_b64_tr_b16 v[42:43], v14 offset:1024
    ds_read_b64_tr_b16 v[44:45], v14 offset:8192
    v_mfma_f32_16x16x32_bf16 a[236:239], a[28:31], v[60:63], a[236:239]
    buffer_load_dwordx4 v2, s[16:19], s60 offen nt lds
    v_mfma_f32_16x16x32_bf16 a[240:243], a[32:35], v[56:59], a[240:243]
    ds_read_b64_tr_b16 v[46:47], v14 offset:9216
    v_cndmask_b32 v82, v82, v92, s[92:93]
    v_mfma_f32_16x16x32_bf16 a[240:243], a[36:39], v[60:63], a[240:243]
    v_cndmask_b32_e64 v83, v83, 0, s[92:93]
    v_xor_b32 v92, s98, v95
    v_mfma_f32_16x16x32_bf16 a[244:247], a[40:43], v[56:59], a[244:247]
    buffer_store_dwordx4 v[80:83], v92, s[28:31], s72 offen sc1
    v_mfma_f32_16x16x32_bf16 a[244:247], a[44:47], v[60:63], a[244:247]
    s_mul_i32 s72, s2, 3
    ds_read_b64_tr_b16 v[48:49], v15 offset:0
    ds_read_b64_tr_b16 v[50:51], v15 offset:1024
    v_mfma_f32_16x16x32_bf16 a[248:251], a[48:51], v[56:59], a[248:251]
    s_add_u32 s72, s72, 1
    ds_read_b64_tr_b16 v[52:53], v15 offset:8192
    ds_read_b64_tr_b16 v[54:55], v15 offset:9216
    v_mfma_f32_16x16x32_bf16 a[248:251], a[52:55], v[60:63], a[248:251]
    s_bfe_u32 s98, s72, 0x10001
    buffer_load_dwordx4 v3, s[16:19], s60 offen offset:1024 nt lds
    v_mfma_f32_16x16x32_bf16 a[252:255], a[56:59], v[56:59], a[252:255]
    s_bfe_u32 s99, s72, 0x10003
    v_cndmask_b32 v86, v86, v93, s[92:93]
    v_cndmask_b32_e64 v87, v87, 0, s[92:93]
    v_mfma_f32_16x16x32_bf16 a[252:255], a[60:63], v[60:63], a[252:255]
    s_lshl1_add_u32 s98, s99, s98
    v_cndmask_b32 v90, v90, v94, s[92:93]
    v_cndmask_b32_e64 v91, v91, 0, s[92:93]
    s_waitcnt lgkmcnt(4)
    v_mfma_f32_16x16x32_bf16 v[128:131], v[40:43], a[64:67], v[128:131]
    s_lshl_b32 s98, s98, 5
    v_xor_b32 v93, s98, v95
    ds_read_b64_tr_b16 v[56:57], v16 offset:0
    v_mfma_f32_16x16x32_bf16 v[128:131], v[44:47], a[68:71], v[128:131]
    s_lshl_b32 s72, s72, 7
    v_add_u32 v22, 0x10000, v22
    ds_read_b64_tr_b16 v[58:59], v16 offset:1024
    v_mfma_f32_16x16x32_bf16 v[132:135], v[40:43], a[72:75], v[132:135]
    ds_read_b128 a[0:3], v22 offset:16384
    ds_read_b64_tr_b16 v[60:61], v16 offset:8192
    v_mfma_f32_16x16x32_bf16 v[132:135], v[44:47], a[76:79], v[132:135]
    s_cmp_lt_u32 s2, 192
    s_cselect_b32 s72, s72, 1073741824
    ds_read_b64_tr_b16 v[62:63], v16 offset:9216
    v_mfma_f32_16x16x32_bf16 v[136:139], v[40:43], a[80:83], v[136:139]
    buffer_store_dwordx4 v[84:87], v93, s[28:31], s72 offen sc1
    v_mfma_f32_16x16x32_bf16 v[136:139], v[44:47], a[84:87], v[136:139]
    s_mul_i32 s72, s2, 3
    buffer_load_dwordx4 v4, s[16:19], s60 offen offset:2048 nt lds
    v_mfma_f32_16x16x32_bf16 v[140:143], v[40:43], a[88:91], v[140:143]
    s_add_u32 s72, s72, 2
    v_add_u32 v23, 0x10000, v23
    v_mfma_f32_16x16x32_bf16 v[140:143], v[44:47], a[92:95], v[140:143]
    s_bfe_u32 s98, s72, 0x10001
    ds_read_b128 a[4:7], v23 offset:16384
    v_mfma_f32_16x16x32_bf16 v[144:147], v[40:43], a[96:99], v[144:147]
    s_bfe_u32 s99, s72, 0x10003
    v_mfma_f32_16x16x32_bf16 v[144:147], v[44:47], a[100:103], v[144:147]
    s_lshl1_add_u32 s98, s99, s98
    v_mfma_f32_16x16x32_bf16 v[148:151], v[40:43], a[104:107], v[148:151]
    s_lshl_b32 s98, s98, 5
    v_xor_b32 v94, s98, v95
    v_mfma_f32_16x16x32_bf16 v[148:151], v[44:47], a[108:111], v[148:151]
    s_lshl_b32 s72, s72, 7
    v_mfma_f32_16x16x32_bf16 v[152:155], v[40:43], a[112:115], v[152:155]
    s_lshl2_add_u32 s99, s100, s4
    buffer_load_dwordx4 v5, s[16:19], s60 offen offset:3072 nt lds
    v_mfma_f32_16x16x32_bf16 v[152:155], v[44:47], a[116:119], v[152:155]
    s_lshl_b32 s99, s99, 7
    ds_read_b128 a[8:11], v22 offset:18432
    v_mfma_f32_16x16x32_bf16 v[156:159], v[40:43], a[120:123], v[156:159]
    s_cmp_lt_u32 s2, 192
    s_cselect_b32 s72, s72, 1073741824
    ds_read_b64_tr_b16 v[40:41], v17 offset:0
    v_mfma_f32_16x16x32_bf16 v[156:159], v[44:47], a[124:127], v[156:159]
    s_waitcnt lgkmcnt(2)
    buffer_store_dwordx4 v[88:91], v94, s[28:31], s72 offen sc1
    v_mfma_f32_16x16x32_bf16 v[160:163], v[48:51], a[64:67], v[160:163]
    s_mov_b32 s30, 73728
    ds_read_b64_tr_b16 v[42:43], v17 offset:1024
    ds_read_b64_tr_b16 v[44:45], v17 offset:8192
    v_mfma_f32_16x16x32_bf16 v[160:163], v[52:55], a[68:71], v[160:163]
    ds_read_b64_tr_b16 v[46:47], v17 offset:9216
    v_mfma_f32_16x16x32_bf16 v[164:167], v[48:51], a[72:75], v[164:167]
    ds_read_b128 a[12:15], v23 offset:18432
    v_mfma_f32_16x16x32_bf16 v[164:167], v[52:55], a[76:79], v[164:167]
    s_add_u32 m0, s69, 16384
    v_mfma_f32_16x16x32_bf16 v[168:171], v[48:51], a[80:83], v[168:171]
    s_xor_b32 s60, s60, 524288
    buffer_load_dwordx4 v6, s[8:11], s62 offen lds
    v_mfma_f32_16x16x32_bf16 v[168:171], v[52:55], a[84:87], v[168:171]
    s_add_u32 s28, s28, s7
    s_addc_u32 s29, s29, 0
    v_mfma_f32_16x16x32_bf16 v[172:175], v[48:51], a[88:91], v[172:175]
    s_lshr_b32 s7, s6, 1
    v_mfma_f32_16x16x32_bf16 v[172:175], v[52:55], a[92:95], v[172:175]
    s_lshl2_add_u32 s7, s5, s7
    v_mfma_f32_16x16x32_bf16 v[176:179], v[48:51], a[96:99], v[176:179]
    s_mul_i32 s98, s7, 36864
    ds_read_b128 a[16:19], v22 offset:20480
    v_add_u32 v36, s98, v36
    v_mfma_f32_16x16x32_bf16 v[176:179], v[52:55], a[100:103], v[176:179]
    s_mul_i32 s7, s7, 36864
    v_sub_u32 v39, v36, v39
    v_lshl_add_u32 v36, s100, 6, v36
    v_mfma_f32_16x16x32_bf16 v[180:183], v[48:51], a[104:107], v[180:183]
    v_mfma_f32_16x16x32_bf16 v[180:183], v[52:55], a[108:111], v[180:183]
    buffer_load_dwordx4 v7, s[8:11], s62 offen offset:1024 lds
    v_mfma_f32_16x16x32_bf16 v[184:187], v[48:51], a[112:115], v[184:187]
    v_mfma_f32_16x16x32_bf16 v[184:187], v[52:55], a[116:119], v[184:187]
    ds_read_b128 a[20:23], v23 offset:20480
    v_mfma_f32_16x16x32_bf16 v[188:191], v[48:51], a[120:123], v[188:191]
    ds_read_b64_tr_b16 v[48:49], v14 offset:32768
    ds_read_b64_tr_b16 v[50:51], v14 offset:33792
    v_mfma_f32_16x16x32_bf16 v[188:191], v[52:55], a[124:127], v[188:191]
    ds_read_b64_tr_b16 v[52:53], v14 offset:40960
    ds_read_b64_tr_b16 v[54:55], v14 offset:41984
    v_mfma_f32_16x16x32_bf16 v[192:195], v[56:59], a[64:67], v[192:195]
    v_add_u32 v14, 0x10000, v14
    v_mfma_f32_16x16x32_bf16 v[192:195], v[60:63], a[68:71], v[192:195]
    v_mfma_f32_16x16x32_bf16 v[196:199], v[56:59], a[72:75], v[196:199]
    v_mfma_f32_16x16x32_bf16 v[196:199], v[60:63], a[76:79], v[196:199]
    buffer_load_dwordx4 v8, s[8:11], s62 offen offset:2048 lds
    v_mfma_f32_16x16x32_bf16 v[200:203], v[56:59], a[80:83], v[200:203]
    ds_read_b128 a[24:27], v22 offset:22528
    v_mfma_f32_16x16x32_bf16 v[200:203], v[60:63], a[84:87], v[200:203]
    v_mfma_f32_16x16x32_bf16 v[204:207], v[56:59], a[88:91], v[204:207]
    v_mfma_f32_16x16x32_bf16 v[204:207], v[60:63], a[92:95], v[204:207]
    v_mfma_f32_16x16x32_bf16 v[208:211], v[56:59], a[96:99], v[208:211]
    ds_read_b128 a[28:31], v23 offset:22528
    v_mfma_f32_16x16x32_bf16 v[208:211], v[60:63], a[100:103], v[208:211]
    v_mfma_f32_16x16x32_bf16 v[212:215], v[56:59], a[104:107], v[212:215]
    buffer_load_dwordx4 v9, s[8:11], s62 offen offset:3072 lds
    v_mfma_f32_16x16x32_bf16 v[212:215], v[60:63], a[108:111], v[212:215]
    v_mfma_f32_16x16x32_bf16 v[216:219], v[56:59], a[112:115], v[216:219]
    v_mfma_f32_16x16x32_bf16 v[216:219], v[60:63], a[116:119], v[216:219]
    v_mfma_f32_16x16x32_bf16 v[220:223], v[56:59], a[120:123], v[220:223]
    s_waitcnt lgkmcnt(0)
    ds_read_b64_tr_b16 v[56:57], v15 offset:32768
    ds_read_b64_tr_b16 v[58:59], v15 offset:33792
    v_mfma_f32_16x16x32_bf16 v[220:223], v[60:63], a[124:127], v[220:223]
    ds_read_b64_tr_b16 v[60:61], v15 offset:40960
    ds_read_b64_tr_b16 v[62:63], v15 offset:41984
    v_mfma_f32_16x16x32_bf16 v[224:227], v[40:43], a[64:67], v[224:227]
    v_add_u32 v15, 0x10000, v15
    v_mfma_f32_16x16x32_bf16 v[224:227], v[44:47], a[68:71], v[224:227]
    s_xor_b32 s62, s62, 384
    v_mfma_f32_16x16x32_bf16 v[228:231], v[40:43], a[72:75], v[228:231]
    buffer_load_dword v107, v103, s[24:27], s77 offen
    v_mfma_f32_16x16x32_bf16 v[228:231], v[44:47], a[76:79], v[228:231]
    s_add_u32 s77, s77, 4608
    v_mfma_f32_16x16x32_bf16 v[232:235], v[40:43], a[80:83], v[232:235]
    v_mfma_f32_16x16x32_bf16 v[232:235], v[44:47], a[84:87], v[232:235]
    s_add_u32 m0, s69, 32768
    v_mfma_f32_16x16x32_bf16 v[236:239], v[40:43], a[88:91], v[236:239]
    buffer_load_dwordx4 v2, s[12:15], s60 offen nt lds
    v_mfma_f32_16x16x32_bf16 v[236:239], v[44:47], a[92:95], v[236:239]
    v_mfma_f32_16x16x32_bf16 v[240:243], v[40:43], a[96:99], v[240:243]
    v_mfma_f32_16x16x32_bf16 v[240:243], v[44:47], a[100:103], v[240:243]
    v_mfma_f32_16x16x32_bf16 v[244:247], v[40:43], a[104:107], v[244:247]
    v_mfma_f32_16x16x32_bf16 v[244:247], v[44:47], a[108:111], v[244:247]
    v_mfma_f32_16x16x32_bf16 v[248:251], v[40:43], a[112:115], v[248:251]
    v_mfma_f32_16x16x32_bf16 v[248:251], v[44:47], a[116:119], v[248:251]
    buffer_load_dwordx4 v3, s[12:15], s60 offen offset:1024 nt lds
    v_mfma_f32_16x16x32_bf16 v[252:255], v[40:43], a[120:123], v[252:255]
    ds_read_b64_tr_b16 v[40:41], v16 offset:32768
    ds_read_b64_tr_b16 v[42:43], v16 offset:33792
    v_mfma_f32_16x16x32_bf16 v[252:255], v[44:47], a[124:127], v[252:255]
    ds_read_b64_tr_b16 v[44:45], v16 offset:40960
    ds_read_b64_tr_b16 v[46:47], v16 offset:41984
    v_mfma_f32_16x16x32_bf16 a[128:131], a[64:67], v[48:51], a[128:131]
    v_add_u32 v16, 0x10000, v16
    v_mfma_f32_16x16x32_bf16 a[128:131], a[68:71], v[52:55], a[128:131]
    v_mfma_f32_16x16x32_bf16 a[132:135], a[72:75], v[48:51], a[132:135]
    ds_read_b128 a[32:35], v22 offset:49152
    v_mfma_f32_16x16x32_bf16 a[132:135], a[76:79], v[52:55], a[132:135]
    v_mfma_f32_16x16x32_bf16 a[136:139], a[80:83], v[48:51], a[136:139]
    v_mfma_f32_16x16x32_bf16 a[136:139], a[84:87], v[52:55], a[136:139]
    buffer_load_dwordx4 v4, s[12:15], s60 offen offset:2048 nt lds
    v_mfma_f32_16x16x32_bf16 a[140:143], a[88:91], v[48:51], a[140:143]
    v_mfma_f32_16x16x32_bf16 a[140:143], a[92:95], v[52:55], a[140:143]
    ds_read_b128 a[36:39], v23 offset:49152
    v_mfma_f32_16x16x32_bf16 a[144:147], a[96:99], v[48:51], a[144:147]
    v_mfma_f32_16x16x32_bf16 a[144:147], a[100:103], v[52:55], a[144:147]
    v_mfma_f32_16x16x32_bf16 a[148:151], a[104:107], v[48:51], a[148:151]
    v_mfma_f32_16x16x32_bf16 a[148:151], a[108:111], v[52:55], a[148:151]
    v_mfma_f32_16x16x32_bf16 a[152:155], a[112:115], v[48:51], a[152:155]
    buffer_load_dwordx4 v5, s[12:15], s60 offen offset:3072 nt lds
    v_mfma_f32_16x16x32_bf16 a[152:155], a[116:119], v[52:55], a[152:155]
    ds_read_b128 a[40:43], v22 offset:51200
    v_mfma_f32_16x16x32_bf16 a[156:159], a[120:123], v[48:51], a[156:159]
    ds_read_b64_tr_b16 v[48:49], v17 offset:32768
    ds_read_b64_tr_b16 v[50:51], v17 offset:33792
    v_mfma_f32_16x16x32_bf16 a[156:159], a[124:127], v[52:55], a[156:159]
    s_waitcnt lgkmcnt(3)
    ds_read_b64_tr_b16 v[52:53], v17 offset:40960
    ds_read_b64_tr_b16 v[54:55], v17 offset:41984
    v_mfma_f32_16x16x32_bf16 a[160:163], a[64:67], v[56:59], a[160:163]
    v_add_u32 v17, 0x10000, v17
    v_mfma_f32_16x16x32_bf16 a[160:163], a[68:71], v[60:63], a[160:163]
    v_mfma_f32_16x16x32_bf16 a[164:167], a[72:75], v[56:59], a[164:167]
    ds_read_b128 a[44:47], v23 offset:51200
    v_mfma_f32_16x16x32_bf16 a[164:167], a[76:79], v[60:63], a[164:167]
    s_add_u32 m0, s69, 49152
    v_mfma_f32_16x16x32_bf16 a[168:171], a[80:83], v[56:59], a[168:171]
    buffer_load_dwordx4 v6, s[8:11], s61 offen lds
    v_mfma_f32_16x16x32_bf16 a[168:171], a[84:87], v[60:63], a[168:171]
    v_mfma_f32_16x16x32_bf16 a[172:175], a[88:91], v[56:59], a[172:175]
    v_mfma_f32_16x16x32_bf16 a[172:175], a[92:95], v[60:63], a[172:175]
    v_mfma_f32_16x16x32_bf16 a[176:179], a[96:99], v[56:59], a[176:179]
    ds_read_b128 a[48:51], v22 offset:53248
    v_mfma_f32_16x16x32_bf16 a[176:179], a[100:103], v[60:63], a[176:179]
    v_mfma_f32_16x16x32_bf16 a[180:183], a[104:107], v[56:59], a[180:183]
    v_mfma_f32_16x16x32_bf16 a[180:183], a[108:111], v[60:63], a[180:183]
    buffer_load_dwordx4 v7, s[8:11], s61 offen offset:1024 lds
    v_mfma_f32_16x16x32_bf16 a[184:187], a[112:115], v[56:59], a[184:187]
    v_mfma_f32_16x16x32_bf16 a[184:187], a[116:119], v[60:63], a[184:187]
    ds_read_b128 a[52:55], v23 offset:53248
    v_mfma_f32_16x16x32_bf16 a[188:191], a[120:123], v[56:59], a[188:191]
    v_mfma_f32_16x16x32_bf16 a[188:191], a[124:127], v[60:63], a[188:191]
    v_mfma_f32_16x16x32_bf16 a[192:195], a[64:67], v[40:43], a[192:195]
    v_mfma_f32_16x16x32_bf16 a[192:195], a[68:71], v[44:47], a[192:195]
    v_mfma_f32_16x16x32_bf16 a[196:199], a[72:75], v[40:43], a[196:199]
    v_mfma_f32_16x16x32_bf16 a[196:199], a[76:79], v[44:47], a[196:199]
    buffer_load_dwordx4 v8, s[8:11], s61 offen offset:2048 lds
    v_mfma_f32_16x16x32_bf16 a[200:203], a[80:83], v[40:43], a[200:203]
    ds_read_b128 a[56:59], v22 offset:55296
    v_mfma_f32_16x16x32_bf16 a[200:203], a[84:87], v[44:47], a[200:203]
    v_mfma_f32_16x16x32_bf16 a[204:207], a[88:91], v[40:43], a[204:207]
    v_mfma_f32_16x16x32_bf16 a[204:207], a[92:95], v[44:47], a[204:207]
    v_mfma_f32_16x16x32_bf16 a[208:211], a[96:99], v[40:43], a[208:211]
    ds_read_b128 a[60:63], v23 offset:55296
    v_mfma_f32_16x16x32_bf16 a[208:211], a[100:103], v[44:47], a[208:211]
    v_mfma_f32_16x16x32_bf16 a[212:215], a[104:107], v[40:43], a[212:215]
    buffer_load_dwordx4 v9, s[8:11], s61 offen offset:3072 lds
    v_mfma_f32_16x16x32_bf16 a[212:215], a[108:111], v[44:47], a[212:215]
    v_mfma_f32_16x16x32_bf16 a[216:219], a[112:115], v[40:43], a[216:219]
    v_mfma_f32_16x16x32_bf16 a[216:219], a[116:119], v[44:47], a[216:219]
    v_mfma_f32_16x16x32_bf16 a[220:223], a[120:123], v[40:43], a[220:223]
    v_mfma_f32_16x16x32_bf16 a[220:223], a[124:127], v[44:47], a[220:223]
    s_waitcnt lgkmcnt(0)
    v_mfma_f32_16x16x32_bf16 a[224:227], a[64:67], v[48:51], a[224:227]
    v_mfma_f32_16x16x32_bf16 a[224:227], a[68:71], v[52:55], a[224:227]
    s_xor_b32 s61, s61, 128
    v_mfma_f32_16x16x32_bf16 a[228:231], a[72:75], v[48:51], a[228:231]
    v_mfma_f32_16x16x32_bf16 a[228:231], a[76:79], v[52:55], a[228:231]
    v_mfma_f32_16x16x32_bf16 a[232:235], a[80:83], v[48:51], a[232:235]
    v_mfma_f32_16x16x32_bf16 a[232:235], a[84:87], v[52:55], a[232:235]
    s_waitcnt vmcnt(9) lgkmcnt(0)
    s_barrier
    ds_read_b64_tr_b16 v[56:57], v14 offset:0
    v_mfma_f32_16x16x32_bf16 a[236:239], a[88:91], v[48:51], a[236:239]
    s_add_u32 m0, s69, 65536
    ds_read_b64_tr_b16 v[58:59], v14 offset:1024
    ds_read_b64_tr_b16 v[60:61], v14 offset:8192
    v_mfma_f32_16x16x32_bf16 a[236:239], a[92:95], v[52:55], a[236:239]
    buffer_load_dwordx4 v2, s[16:19], s60 offen nt lds
    v_mfma_f32_16x16x32_bf16 a[240:243], a[96:99], v[48:51], a[240:243]
    ds_read_b64_tr_b16 v[62:63], v14 offset:9216
    ds_read_b64_tr_b16 v[40:41], v15 offset:0
    v_mfma_f32_16x16x32_bf16 a[240:243], a[100:103], v[52:55], a[240:243]
    buffer_atomic_add v31, v30, s[44:47], s95 offen sc1
    v_mfma_f32_16x16x32_bf16 a[244:247], a[104:107], v[48:51], a[244:247]
    ds_read_b64_tr_b16 v[42:43], v15 offset:1024
    ds_read_b64_tr_b16 v[44:45], v15 offset:8192
    v_mfma_f32_16x16x32_bf16 a[244:247], a[108:111], v[52:55], a[244:247]
    ds_read_b64_tr_b16 v[46:47], v15 offset:9216
    v_add_u32 v14, 0xfffe0000, v14
    v_mfma_f32_16x16x32_bf16 a[248:251], a[112:115], v[48:51], a[248:251]
    v_add_u32 v15, 0xfffe0000, v15
    v_mfma_f32_16x16x32_bf16 a[248:251], a[116:119], v[52:55], a[248:251]
    buffer_load_dwordx4 v3, s[16:19], s60 offen offset:1024 nt lds
    v_mfma_f32_16x16x32_bf16 a[252:255], a[120:123], v[48:51], a[252:255]
    ds_read_b64_tr_b16 v[48:49], v16 offset:0
    ds_read_b64_tr_b16 v[50:51], v16 offset:1024
    v_mfma_f32_16x16x32_bf16 a[252:255], a[124:127], v[52:55], a[252:255]
    s_waitcnt lgkmcnt(3)
    ds_read_b64_tr_b16 v[52:53], v16 offset:8192
    ds_read_b64_tr_b16 v[54:55], v16 offset:9216
    v_mfma_f32_16x16x32_bf16 v[128:131], v[56:59], a[0:3], v[128:131]
    v_add_u32 v16, 0xfffe0000, v16
    v_mfma_f32_16x16x32_bf16 v[128:131], v[60:63], a[4:7], v[128:131]
    v_add_u32 v22, 0x10000, v22
    v_mfma_f32_16x16x32_bf16 v[132:135], v[56:59], a[8:11], v[132:135]
    ds_read_b128 a[64:67], v22 offset:16384
    v_mfma_f32_16x16x32_bf16 v[132:135], v[60:63], a[12:15], v[132:135]
    v_mfma_f32_16x16x32_bf16 v[136:139], v[56:59], a[16:19], v[136:139]
    v_mfma_f32_16x16x32_bf16 v[136:139], v[60:63], a[20:23], v[136:139]
    buffer_load_dwordx4 v4, s[16:19], s60 offen offset:2048 nt lds
    v_mfma_f32_16x16x32_bf16 v[140:143], v[56:59], a[24:27], v[140:143]
    v_add_u32 v23, 0x10000, v23
    v_mfma_f32_16x16x32_bf16 v[140:143], v[60:63], a[28:31], v[140:143]
    ds_read_b128 a[68:71], v23 offset:16384
    v_mfma_f32_16x16x32_bf16 v[144:147], v[56:59], a[32:35], v[144:147]
    v_mfma_f32_16x16x32_bf16 v[144:147], v[60:63], a[36:39], v[144:147]
    v_mfma_f32_16x16x32_bf16 v[148:151], v[56:59], a[40:43], v[148:151]
    v_mfma_f32_16x16x32_bf16 v[148:151], v[60:63], a[44:47], v[148:151]
    v_mfma_f32_16x16x32_bf16 v[152:155], v[56:59], a[48:51], v[152:155]
    buffer_load_dwordx4 v5, s[16:19], s60 offen offset:3072 nt lds
    v_mfma_f32_16x16x32_bf16 v[152:155], v[60:63], a[52:55], v[152:155]
    ds_read_b128 a[72:75], v22 offset:18432
    v_mfma_f32_16x16x32_bf16 v[156:159], v[56:59], a[56:59], v[156:159]
    ds_read_b64_tr_b16 v[56:57], v17 offset:0
    ds_read_b64_tr_b16 v[58:59], v17 offset:1024
    v_mfma_f32_16x16x32_bf16 v[156:159], v[60:63], a[60:63], v[156:159]
    ds_read_b64_tr_b16 v[60:61], v17 offset:8192
    ds_read_b64_tr_b16 v[62:63], v17 offset:9216
    v_mfma_f32_16x16x32_bf16 v[160:163], v[40:43], a[0:3], v[160:163]
    s_waitcnt lgkmcnt(5)
    v_add_u32 v17, 0xfffe0000, v17
    v_mfma_f32_16x16x32_bf16 v[160:163], v[44:47], a[4:7], v[160:163]
    v_mfma_f32_16x16x32_bf16 v[164:167], v[40:43], a[8:11], v[164:167]
    ds_read_b128 a[76:79], v23 offset:18432
    v_mfma_f32_16x16x32_bf16 v[164:167], v[44:47], a[12:15], v[164:167]
    s_add_u32 m0, s69, 81920
    v_mfma_f32_16x16x32_bf16 v[168:171], v[40:43], a[16:19], v[168:171]
    s_xor_b32 s60, s60, 1572864
    buffer_load_dwordx4 v6, s[8:11], s62 offen lds
    v_mfma_f32_16x16x32_bf16 v[168:171], v[44:47], a[20:23], v[168:171]
    v_mfma_f32_16x16x32_bf16 v[172:175], v[40:43], a[24:27], v[172:175]
    v_mfma_f32_16x16x32_bf16 v[172:175], v[44:47], a[28:31], v[172:175]
    v_mfma_f32_16x16x32_bf16 v[176:179], v[40:43], a[32:35], v[176:179]
    ds_read_b128 a[80:83], v22 offset:20480
    v_mfma_f32_16x16x32_bf16 v[176:179], v[44:47], a[36:39], v[176:179]
    v_mfma_f32_16x16x32_bf16 v[180:183], v[40:43], a[40:43], v[180:183]
    v_mfma_f32_16x16x32_bf16 v[180:183], v[44:47], a[44:47], v[180:183]
    buffer_load_dwordx4 v7, s[8:11], s62 offen offset:1024 lds
    v_mfma_f32_16x16x32_bf16 v[184:187], v[40:43], a[48:51], v[184:187]
    v_mfma_f32_16x16x32_bf16 v[184:187], v[44:47], a[52:55], v[184:187]
    ds_read_b128 a[84:87], v23 offset:20480
    v_mfma_f32_16x16x32_bf16 v[188:191], v[40:43], a[56:59], v[188:191]
    ds_read_b64_tr_b16 v[40:41], v14 offset:0
    ds_read_b64_tr_b16 v[42:43], v14 offset:1024
    v_mfma_f32_16x16x32_bf16 v[188:191], v[44:47], a[60:63], v[188:191]
    ds_read_b64_tr_b16 v[44:45], v14 offset:8192
    ds_read_b64_tr_b16 v[46:47], v14 offset:9216
    v_mfma_f32_16x16x32_bf16 v[192:195], v[48:51], a[0:3], v[192:195]
    v_mfma_f32_16x16x32_bf16 v[192:195], v[52:55], a[4:7], v[192:195]
    v_mfma_f32_16x16x32_bf16 v[196:199], v[48:51], a[8:11], v[196:199]
    v_mfma_f32_16x16x32_bf16 v[196:199], v[52:55], a[12:15], v[196:199]
    buffer_load_dwordx4 v8, s[8:11], s62 offen offset:2048 lds
    v_mfma_f32_16x16x32_bf16 v[200:203], v[48:51], a[16:19], v[200:203]
    ds_read_b128 a[88:91], v22 offset:22528
    v_mfma_f32_16x16x32_bf16 v[200:203], v[52:55], a[20:23], v[200:203]
    v_mfma_f32_16x16x32_bf16 v[204:207], v[48:51], a[24:27], v[204:207]
    v_mfma_f32_16x16x32_bf16 v[204:207], v[52:55], a[28:31], v[204:207]
    v_mfma_f32_16x16x32_bf16 v[208:211], v[48:51], a[32:35], v[208:211]
    ds_read_b128 a[92:95], v23 offset:22528
    v_mfma_f32_16x16x32_bf16 v[208:211], v[52:55], a[36:39], v[208:211]
    v_mfma_f32_16x16x32_bf16 v[212:215], v[48:51], a[40:43], v[212:215]
    buffer_load_dwordx4 v9, s[8:11], s62 offen offset:3072 lds
    v_mfma_f32_16x16x32_bf16 v[212:215], v[52:55], a[44:47], v[212:215]
    v_mfma_f32_16x16x32_bf16 v[216:219], v[48:51], a[48:51], v[216:219]
    v_mfma_f32_16x16x32_bf16 v[216:219], v[52:55], a[52:55], v[216:219]
    v_mfma_f32_16x16x32_bf16 v[220:223], v[48:51], a[56:59], v[220:223]
    s_waitcnt lgkmcnt(0)
    ds_read_b64_tr_b16 v[48:49], v15 offset:0
    ds_read_b64_tr_b16 v[50:51], v15 offset:1024
    v_mfma_f32_16x16x32_bf16 v[220:223], v[52:55], a[60:63], v[220:223]
    ds_read_b64_tr_b16 v[52:53], v15 offset:8192
    ds_read_b64_tr_b16 v[54:55], v15 offset:9216
    v_mfma_f32_16x16x32_bf16 v[224:227], v[56:59], a[0:3], v[224:227]
    v_mfma_f32_16x16x32_bf16 v[224:227], v[60:63], a[4:7], v[224:227]
    s_xor_b32 s62, s62, 128
    v_mfma_f32_16x16x32_bf16 v[228:231], v[56:59], a[8:11], v[228:231]
    buffer_load_dword v108, v103, s[24:27], s77 offen
    v_mfma_f32_16x16x32_bf16 v[228:231], v[60:63], a[12:15], v[228:231]
    s_add_u32 s77, s77, 4608
    v_mfma_f32_16x16x32_bf16 v[232:235], v[56:59], a[16:19], v[232:235]
    v_mfma_f32_16x16x32_bf16 v[232:235], v[60:63], a[20:23], v[232:235]
    s_add_u32 m0, s69, 98304
    v_mfma_f32_16x16x32_bf16 v[236:239], v[56:59], a[24:27], v[236:239]
    buffer_load_dwordx4 v2, s[12:15], s60 offen nt lds
    v_mfma_f32_16x16x32_bf16 v[236:239], v[60:63], a[28:31], v[236:239]
    v_mfma_f32_16x16x32_bf16 v[240:243], v[56:59], a[32:35], v[240:243]
    v_mfma_f32_16x16x32_bf16 v[240:243], v[60:63], a[36:39], v[240:243]
    v_mfma_f32_16x16x32_bf16 v[244:247], v[56:59], a[40:43], v[244:247]
    v_mfma_f32_16x16x32_bf16 v[244:247], v[60:63], a[44:47], v[244:247]
    v_mfma_f32_16x16x32_bf16 v[248:251], v[56:59], a[48:51], v[248:251]
    v_mfma_f32_16x16x32_bf16 v[248:251], v[60:63], a[52:55], v[248:251]
    buffer_load_dwordx4 v3, s[12:15], s60 offen offset:1024 nt lds
    v_mfma_f32_16x16x32_bf16 v[252:255], v[56:59], a[56:59], v[252:255]
    ds_read_b64_tr_b16 v[56:57], v16 offset:0
    ds_read_b64_tr_b16 v[58:59], v16 offset:1024
    v_mfma_f32_16x16x32_bf16 v[252:255], v[60:63], a[60:63], v[252:255]
    ds_read_b64_tr_b16 v[60:61], v16 offset:8192
    ds_read_b64_tr_b16 v[62:63], v16 offset:9216
    v_mfma_f32_16x16x32_bf16 a[128:131], a[0:3], v[40:43], a[128:131]
    v_mfma_f32_16x16x32_bf16 a[128:131], a[4:7], v[44:47], a[128:131]
    v_add_u32 v22, 0xfffe0000, v22
    v_mfma_f32_16x16x32_bf16 a[132:135], a[8:11], v[40:43], a[132:135]
    ds_read_b128 a[96:99], v22 offset:16384
    v_mfma_f32_16x16x32_bf16 a[132:135], a[12:15], v[44:47], a[132:135]
    v_mfma_f32_16x16x32_bf16 a[136:139], a[16:19], v[40:43], a[136:139]
    v_mfma_f32_16x16x32_bf16 a[136:139], a[20:23], v[44:47], a[136:139]
    buffer_load_dwordx4 v4, s[12:15], s60 offen offset:2048 nt lds
    v_mfma_f32_16x16x32_bf16 a[140:143], a[24:27], v[40:43], a[140:143]
    v_add_u32 v23, 0xfffe0000, v23
    v_mfma_f32_16x16x32_bf16 a[140:143], a[28:31], v[44:47], a[140:143]
    ds_read_b128 a[100:103], v23 offset:16384
    v_mfma_f32_16x16x32_bf16 a[144:147], a[32:35], v[40:43], a[144:147]
    v_mfma_f32_16x16x32_bf16 a[144:147], a[36:39], v[44:47], a[144:147]
    v_mfma_f32_16x16x32_bf16 a[148:151], a[40:43], v[40:43], a[148:151]
    v_mfma_f32_16x16x32_bf16 a[148:151], a[44:47], v[44:47], a[148:151]
    v_mfma_f32_16x16x32_bf16 a[152:155], a[48:51], v[40:43], a[152:155]
    buffer_load_dwordx4 v5, s[12:15], s60 offen offset:3072 nt lds
    v_mfma_f32_16x16x32_bf16 a[152:155], a[52:55], v[44:47], a[152:155]
    ds_read_b128 a[104:107], v22 offset:18432
    v_mfma_f32_16x16x32_bf16 a[156:159], a[56:59], v[40:43], a[156:159]
    ds_read_b64_tr_b16 v[40:41], v17 offset:0
    ds_read_b64_tr_b16 v[42:43], v17 offset:1024
    v_mfma_f32_16x16x32_bf16 a[156:159], a[60:63], v[44:47], a[156:159]
    s_waitcnt lgkmcnt(3)
    ds_read_b64_tr_b16 v[44:45], v17 offset:8192
    ds_read_b64_tr_b16 v[46:47], v17 offset:9216
    v_mfma_f32_16x16x32_bf16 a[160:163], a[0:3], v[48:51], a[160:163]
    v_mfma_f32_16x16x32_bf16 a[160:163], a[4:7], v[52:55], a[160:163]
    v_mfma_f32_16x16x32_bf16 a[164:167], a[8:11], v[48:51], a[164:167]
    ds_read_b128 a[108:111], v23 offset:18432
    v_mfma_f32_16x16x32_bf16 a[164:167], a[12:15], v[52:55], a[164:167]
    s_add_u32 m0, s69, 114688
    v_mfma_f32_16x16x32_bf16 a[168:171], a[16:19], v[48:51], a[168:171]
    s_xor_b32 s60, s60, 524288
    buffer_load_dwordx4 v6, s[8:11], s61 offen lds
    v_mfma_f32_16x16x32_bf16 a[168:171], a[20:23], v[52:55], a[168:171]
    v_mfma_f32_16x16x32_bf16 a[172:175], a[24:27], v[48:51], a[172:175]
    v_mfma_f32_16x16x32_bf16 a[172:175], a[28:31], v[52:55], a[172:175]
    v_mfma_f32_16x16x32_bf16 a[176:179], a[32:35], v[48:51], a[176:179]
    ds_read_b128 a[112:115], v22 offset:20480
    v_mfma_f32_16x16x32_bf16 a[176:179], a[36:39], v[52:55], a[176:179]
    v_mfma_f32_16x16x32_bf16 a[180:183], a[40:43], v[48:51], a[180:183]
    v_mfma_f32_16x16x32_bf16 a[180:183], a[44:47], v[52:55], a[180:183]
    buffer_load_dwordx4 v7, s[8:11], s61 offen offset:1024 lds
    v_mfma_f32_16x16x32_bf16 a[184:187], a[48:51], v[48:51], a[184:187]
    v_mfma_f32_16x16x32_bf16 a[184:187], a[52:55], v[52:55], a[184:187]
    ds_read_b128 a[116:119], v23 offset:20480
    v_mfma_f32_16x16x32_bf16 a[188:191], a[56:59], v[48:51], a[188:191]
    v_mfma_f32_16x16x32_bf16 a[188:191], a[60:63], v[52:55], a[188:191]
    v_mfma_f32_16x16x32_bf16 a[192:195], a[0:3], v[56:59], a[192:195]
    v_mfma_f32_16x16x32_bf16 a[192:195], a[4:7], v[60:63], a[192:195]
    v_mfma_f32_16x16x32_bf16 a[196:199], a[8:11], v[56:59], a[196:199]
    v_mfma_f32_16x16x32_bf16 a[196:199], a[12:15], v[60:63], a[196:199]
    buffer_load_dwordx4 v8, s[8:11], s61 offen offset:2048 lds
    v_mfma_f32_16x16x32_bf16 a[200:203], a[16:19], v[56:59], a[200:203]
    ds_read_b128 a[120:123], v22 offset:22528
    v_mfma_f32_16x16x32_bf16 a[200:203], a[20:23], v[60:63], a[200:203]
    v_mfma_f32_16x16x32_bf16 a[204:207], a[24:27], v[56:59], a[204:207]
    v_mfma_f32_16x16x32_bf16 a[204:207], a[28:31], v[60:63], a[204:207]
    v_mfma_f32_16x16x32_bf16 a[208:211], a[32:35], v[56:59], a[208:211]
    ds_read_b128 a[124:127], v23 offset:22528
    v_mfma_f32_16x16x32_bf16 a[208:211], a[36:39], v[60:63], a[208:211]
    v_mfma_f32_16x16x32_bf16 a[212:215], a[40:43], v[56:59], a[212:215]
    buffer_load_dwordx4 v9, s[8:11], s61 offen offset:3072 lds
    v_mfma_f32_16x16x32_bf16 a[212:215], a[44:47], v[60:63], a[212:215]
    v_mfma_f32_16x16x32_bf16 a[216:219], a[48:51], v[56:59], a[216:219]
    v_mfma_f32_16x16x32_bf16 a[216:219], a[52:55], v[60:63], a[216:219]
    v_mfma_f32_16x16x32_bf16 a[220:223], a[56:59], v[56:59], a[220:223]
    v_mfma_f32_16x16x32_bf16 a[220:223], a[60:63], v[60:63], a[220:223]
    s_waitcnt lgkmcnt(0)
    v_mfma_f32_16x16x32_bf16 a[224:227], a[0:3], v[40:43], a[224:227]
    v_mfma_f32_16x16x32_bf16 a[224:227], a[4:7], v[44:47], a[224:227]
    s_xor_b32 s61, s61, 1920
    v_mfma_f32_16x16x32_bf16 a[228:231], a[8:11], v[40:43], a[228:231]
    s_andn2_b32 s61, s61, 896
    v_mfma_f32_16x16x32_bf16 a[228:231], a[12:15], v[44:47], a[228:231]
    s_lshl_b32 s61, s5, 7
    v_mfma_f32_16x16x32_bf16 a[232:235], a[16:19], v[40:43], a[232:235]
    v_mfma_f32_16x16x32_bf16 a[232:235], a[20:23], v[44:47], a[232:235]
    s_waitcnt vmcnt(9) lgkmcnt(0)
    s_barrier
    ds_read_b64_tr_b16 v[48:49], v14 offset:32768
    v_mfma_f32_16x16x32_bf16 a[236:239], a[24:27], v[40:43], a[236:239]
    s_add_u32 m0, s69, 131072
    ds_read_b64_tr_b16 v[50:51], v14 offset:33792
    ds_read_b64_tr_b16 v[52:53], v14 offset:40960
    v_mfma_f32_16x16x32_bf16 a[236:239], a[28:31], v[44:47], a[236:239]
    buffer_load_dwordx4 v2, s[12:15], s60 offen nt lds
    v_mfma_f32_16x16x32_bf16 a[240:243], a[32:35], v[40:43], a[240:243]
    ds_read_b64_tr_b16 v[54:55], v14 offset:41984
    ds_read_b64_tr_b16 v[56:57], v15 offset:32768
    v_mfma_f32_16x16x32_bf16 a[240:243], a[36:39], v[44:47], a[240:243]
    ds_read_b64_tr_b16 v[58:59], v15 offset:33792
    ds_read_b64_tr_b16 v[60:61], v15 offset:40960
    v_mfma_f32_16x16x32_bf16 a[244:247], a[40:43], v[40:43], a[244:247]
    ds_read_b64_tr_b16 v[62:63], v15 offset:41984
    v_add_u32 v14, 0x10000, v14
    v_mfma_f32_16x16x32_bf16 a[244:247], a[44:47], v[44:47], a[244:247]
    v_add_u32 v15, 0x10000, v15
    v_mfma_f32_16x16x32_bf16 a[248:251], a[48:51], v[40:43], a[248:251]
    v_mfma_f32_16x16x32_bf16 a[248:251], a[52:55], v[44:47], a[248:251]
    buffer_load_dwordx4 v3, s[12:15], s60 offen offset:1024 nt lds
    v_mfma_f32_16x16x32_bf16 a[252:255], a[56:59], v[40:43], a[252:255]
    ds_read_b64_tr_b16 v[40:41], v16 offset:32768
    ds_read_b64_tr_b16 v[42:43], v16 offset:33792
    v_mfma_f32_16x16x32_bf16 a[252:255], a[60:63], v[44:47], a[252:255]
    s_waitcnt lgkmcnt(2)
    ds_read_b64_tr_b16 v[44:45], v16 offset:40960
    ds_read_b64_tr_b16 v[46:47], v16 offset:41984
    v_mfma_f32_16x16x32_bf16 v[128:131], v[48:51], a[64:67], v[128:131]
    v_add_u32 v16, 0x10000, v16
    v_mfma_f32_16x16x32_bf16 v[128:131], v[52:55], a[68:71], v[128:131]
    v_mfma_f32_16x16x32_bf16 v[132:135], v[48:51], a[72:75], v[132:135]
    ds_read_b128 a[0:3], v22 offset:49152
    v_mfma_f32_16x16x32_bf16 v[132:135], v[52:55], a[76:79], v[132:135]
    v_mfma_f32_16x16x32_bf16 v[136:139], v[48:51], a[80:83], v[136:139]
    v_mfma_f32_16x16x32_bf16 v[136:139], v[52:55], a[84:87], v[136:139]
    buffer_load_dwordx4 v4, s[12:15], s60 offen offset:2048 nt lds
    v_mfma_f32_16x16x32_bf16 v[140:143], v[48:51], a[88:91], v[140:143]
    v_mfma_f32_16x16x32_bf16 v[140:143], v[52:55], a[92:95], v[140:143]
    ds_read_b128 a[4:7], v23 offset:49152
    v_mfma_f32_16x16x32_bf16 v[144:147], v[48:51], a[96:99], v[144:147]
    v_mfma_f32_16x16x32_bf16 v[144:147], v[52:55], a[100:103], v[144:147]
    v_mfma_f32_16x16x32_bf16 v[148:151], v[48:51], a[104:107], v[148:151]
    v_mfma_f32_16x16x32_bf16 v[148:151], v[52:55], a[108:111], v[148:151]
    v_mfma_f32_16x16x32_bf16 v[152:155], v[48:51], a[112:115], v[152:155]
    buffer_load_dwordx4 v5, s[12:15], s60 offen offset:3072 nt lds
    v_mfma_f32_16x16x32_bf16 v[152:155], v[52:55], a[116:119], v[152:155]
    ds_read_b128 a[8:11], v22 offset:51200
    v_mfma_f32_16x16x32_bf16 v[156:159], v[48:51], a[120:123], v[156:159]
    ds_read_b64_tr_b16 v[48:49], v17 offset:32768
    ds_read_b64_tr_b16 v[50:51], v17 offset:33792
    v_mfma_f32_16x16x32_bf16 v[156:159], v[52:55], a[124:127], v[156:159]
    ds_read_b64_tr_b16 v[52:53], v17 offset:40960
    ds_read_b64_tr_b16 v[54:55], v17 offset:41984
    v_mfma_f32_16x16x32_bf16 v[160:163], v[56:59], a[64:67], v[160:163]
    v_add_u32 v17, 0x10000, v17
    v_mfma_f32_16x16x32_bf16 v[160:163], v[60:63], a[68:71], v[160:163]
    s_cmp_lt_u32 s4, 0
    s_cselect_b32 s12, 0xf149f2ca, 0
    v_mfma_f32_16x16x32_bf16 v[164:167], v[56:59], a[72:75], v[164:167]
    ds_read_b128 a[12:15], v23 offset:51200
    v_mfma_f32_16x16x32_bf16 v[164:167], v[60:63], a[76:79], v[164:167]
    s_add_u32 m0, s69, 147456
    v_mfma_f32_16x16x32_bf16 v[168:171], v[56:59], a[80:83], v[168:171]
    s_xor_b32 s60, s60, 524288
    buffer_load_dwordx4 v6, s[8:11], s62 offen lds
    v_mfma_f32_16x16x32_bf16 v[168:171], v[60:63], a[84:87], v[168:171]
    v_mov_b32 v6, v96
    v_mfma_f32_16x16x32_bf16 v[172:175], v[56:59], a[88:91], v[172:175]
    s_cmp_lt_u32 s4, 1
    s_cselect_b32 s13, 0xf149f2ca, 0
    v_mfma_f32_16x16x32_bf16 v[172:175], v[60:63], a[92:95], v[172:175]
    s_cmp_lt_u32 s4, 2
    s_cselect_b32 s14, 0xf149f2ca, 0
    v_mfma_f32_16x16x32_bf16 v[176:179], v[56:59], a[96:99], v[176:179]
    ds_read_b128 a[16:19], v22 offset:53248
    v_mfma_f32_16x16x32_bf16 v[176:179], v[60:63], a[100:103], v[176:179]
    s_cmp_lt_u32 s4, 3
    s_cselect_b32 s15, 0xf149f2ca, 0
    v_mfma_f32_16x16x32_bf16 v[180:183], v[56:59], a[104:107], v[180:183]
    v_mfma_f32_16x16x32_bf16 v[180:183], v[60:63], a[108:111], v[180:183]
    buffer_load_dwordx4 v7, s[8:11], s62 offen offset:1024 lds
    v_mfma_f32_16x16x32_bf16 v[184:187], v[56:59], a[112:115], v[184:187]
    v_mfma_f32_16x16x32_bf16 v[184:187], v[60:63], a[116:119], v[184:187]
    ds_read_b128 a[20:23], v23 offset:53248
    v_mfma_f32_16x16x32_bf16 v[188:191], v[56:59], a[120:123], v[188:191]
    s_waitcnt lgkmcnt(1)
    ds_read_b64_tr_b16 v[56:57], v14 offset:0
    ds_read_b64_tr_b16 v[58:59], v14 offset:1024
    v_mfma_f32_16x16x32_bf16 v[188:191], v[60:63], a[124:127], v[188:191]
    ds_read_b64_tr_b16 v[60:61], v14 offset:8192
    ds_read_b64_tr_b16 v[62:63], v14 offset:9216
    v_mfma_f32_16x16x32_bf16 v[192:195], v[40:43], a[64:67], v[192:195]
    v_mfma_f32_16x16x32_bf16 v[192:195], v[44:47], a[68:71], v[192:195]
    v_mfma_f32_16x16x32_bf16 v[196:199], v[40:43], a[72:75], v[196:199]
    v_mfma_f32_16x16x32_bf16 v[196:199], v[44:47], a[76:79], v[196:199]
    buffer_load_dwordx4 v8, s[8:11], s62 offen offset:2048 lds
    v_mfma_f32_16x16x32_bf16 v[200:203], v[40:43], a[80:83], v[200:203]
    ds_read_b128 a[24:27], v22 offset:55296
    v_bfe_u32 v8, v1, 4, 3
    v_mfma_f32_16x16x32_bf16 v[200:203], v[44:47], a[84:87], v[200:203]
    v_lshlrev_b32 v8, 12, v8
    v_mfma_f32_16x16x32_bf16 v[204:207], v[40:43], a[88:91], v[204:207]
    v_mfma_f32_16x16x32_bf16 v[204:207], v[44:47], a[92:95], v[204:207]
    v_mfma_f32_16x16x32_bf16 v[208:211], v[40:43], a[96:99], v[208:211]
    ds_read_b128 a[28:31], v23 offset:55296
    v_mfma_f32_16x16x32_bf16 v[208:211], v[44:47], a[100:103], v[208:211]
    v_mfma_f32_16x16x32_bf16 v[212:215], v[40:43], a[104:107], v[212:215]
    buffer_load_dwordx4 v9, s[8:11], s62 offen offset:3072 lds
    v_mfma_f32_16x16x32_bf16 v[212:215], v[44:47], a[108:111], v[212:215]
    s_and_b32 s8, s5, 7
    v_lshrrev_b32 v9, 2, v1
    v_mfma_f32_16x16x32_bf16 v[216:219], v[40:43], a[112:115], v[216:219]
    s_lshl3_add_u32 s8, s6, s8
    v_mfma_f32_16x16x32_bf16 v[216:219], v[44:47], a[116:119], v[216:219]
    s_mul_hi_u32 s98, s8, 715827883
    v_mfma_f32_16x16x32_bf16 v[220:223], v[40:43], a[120:123], v[220:223]
    ds_read_b64_tr_b16 v[40:41], v15 offset:0
    ds_read_b64_tr_b16 v[42:43], v15 offset:1024
    v_mfma_f32_16x16x32_bf16 v[220:223], v[44:47], a[124:127], v[220:223]
    ds_read_b64_tr_b16 v[44:45], v15 offset:8192
    ds_read_b64_tr_b16 v[46:47], v15 offset:9216
    v_mfma_f32_16x16x32_bf16 v[224:227], v[48:51], a[64:67], v[224:227]
    s_cmp_eq_u32 s4, 1
    s_cselect_b32 s9, 1.0, 0
    v_mfma_f32_16x16x32_bf16 v[224:227], v[52:55], a[68:71], v[224:227]
    s_xor_b32 s62, s62, 1920
    v_mfma_f32_16x16x32_bf16 v[228:231], v[48:51], a[72:75], v[228:231]
    s_andn2_b32 s62, s62, 896
    buffer_load_dword v109, v103, s[24:27], s77 offen
    v_mfma_f32_16x16x32_bf16 v[228:231], v[52:55], a[76:79], v[228:231]
    s_cmp_eq_u32 s4, 2
    s_cselect_b32 s10, 1.0, 0
    v_mfma_f32_16x16x32_bf16 v[232:235], v[48:51], a[80:83], v[232:235]
    s_cmp_eq_u32 s4, 3
    s_cselect_b32 s11, 1.0, 0
    v_mfma_f32_16x16x32_bf16 v[232:235], v[52:55], a[84:87], v[232:235]
    s_add_u32 m0, s69, 0
    v_mfma_f32_16x16x32_bf16 v[236:239], v[48:51], a[88:91], v[236:239]
    buffer_load_dwordx4 v2, s[16:19], s60 offen nt lds
    v_mfma_f32_16x16x32_bf16 v[236:239], v[52:55], a[92:95], v[236:239]
    v_mfma_f32_16x16x32_bf16 v[240:243], v[48:51], a[96:99], v[240:243]
    v_mfma_f32_16x16x32_bf16 v[240:243], v[52:55], a[100:103], v[240:243]
    v_mfma_f32_16x16x32_bf16 v[244:247], v[48:51], a[104:107], v[244:247]
    v_mfma_f32_16x16x32_bf16 v[244:247], v[52:55], a[108:111], v[244:247]
    v_mfma_f32_16x16x32_bf16 v[248:251], v[48:51], a[112:115], v[248:251]
    v_mfma_f32_16x16x32_bf16 v[248:251], v[52:55], a[116:119], v[248:251]
    buffer_load_dwordx4 v3, s[16:19], s60 offen offset:1024 nt lds
    v_mfma_f32_16x16x32_bf16 v[252:255], v[48:51], a[120:123], v[252:255]
    ds_read_b64_tr_b16 v[48:49], v16 offset:0
    ds_read_b64_tr_b16 v[50:51], v16 offset:1024
    v_mfma_f32_16x16x32_bf16 v[252:255], v[52:55], a[124:127], v[252:255]
    s_waitcnt lgkmcnt(2)
    ds_read_b64_tr_b16 v[52:53], v16 offset:8192
    ds_read_b64_tr_b16 v[54:55], v16 offset:9216
    v_mfma_f32_16x16x32_bf16 a[128:131], a[64:67], v[56:59], a[128:131]
    v_mfma_f32_16x16x32_bf16 a[128:131], a[68:71], v[60:63], a[128:131]
    v_add_u32 v22, 0x10000, v22
    v_mfma_f32_16x16x32_bf16 a[132:135], a[72:75], v[56:59], a[132:135]
    ds_read_b128 a[32:35], v22 offset:16384
    v_mfma_f32_16x16x32_bf16 a[132:135], a[76:79], v[60:63], a[132:135]
    v_mfma_f32_16x16x32_bf16 a[136:139], a[80:83], v[56:59], a[136:139]
    v_mfma_f32_16x16x32_bf16 a[136:139], a[84:87], v[60:63], a[136:139]
    buffer_load_dwordx4 v4, s[16:19], s60 offen offset:2048 nt lds
    v_mfma_f32_16x16x32_bf16 a[140:143], a[88:91], v[56:59], a[140:143]
    v_add_u32 v23, 0x10000, v23
    v_mfma_f32_16x16x32_bf16 a[140:143], a[92:95], v[60:63], a[140:143]
    ds_read_b128 a[36:39], v23 offset:16384
    v_mfma_f32_16x16x32_bf16 a[144:147], a[96:99], v[56:59], a[144:147]
    v_mfma_f32_16x16x32_bf16 a[144:147], a[100:103], v[60:63], a[144:147]
    v_mfma_f32_16x16x32_bf16 a[148:151], a[104:107], v[56:59], a[148:151]
    v_mfma_f32_16x16x32_bf16 a[148:151], a[108:111], v[60:63], a[148:151]
    v_mfma_f32_16x16x32_bf16 a[152:155], a[112:115], v[56:59], a[152:155]
    buffer_load_dwordx4 v5, s[16:19], s60 offen offset:3072 nt lds
    v_mfma_f32_16x16x32_bf16 a[152:155], a[116:119], v[60:63], a[152:155]
    ds_read_b128 a[40:43], v22 offset:18432
    v_mfma_f32_16x16x32_bf16 a[156:159], a[120:123], v[56:59], a[156:159]
    ds_read_b64_tr_b16 v[56:57], v17 offset:0
    ds_read_b64_tr_b16 v[58:59], v17 offset:1024
    v_mfma_f32_16x16x32_bf16 a[156:159], a[124:127], v[60:63], a[156:159]
    ds_read_b64_tr_b16 v[60:61], v17 offset:8192
    ds_read_b64_tr_b16 v[62:63], v17 offset:9216
    v_mfma_f32_16x16x32_bf16 a[160:163], a[64:67], v[40:43], a[160:163]
    v_mfma_f32_16x16x32_bf16 a[160:163], a[68:71], v[44:47], a[160:163]
    v_mfma_f32_16x16x32_bf16 a[164:167], a[72:75], v[40:43], a[164:167]
    ds_read_b128 a[44:47], v23 offset:18432
    v_mfma_f32_16x16x32_bf16 a[164:167], a[76:79], v[44:47], a[164:167]
    s_add_u32 m0, s69, 16384
    v_mfma_f32_16x16x32_bf16 a[168:171], a[80:83], v[40:43], a[168:171]
    s_xor_b32 s60, s60, 524288
    buffer_load_dwordx4 v10, s[20:23], s63 offen lds
    v_mfma_f32_16x16x32_bf16 a[168:171], a[84:87], v[44:47], a[168:171]
    v_mfma_f32_16x16x32_bf16 a[172:175], a[88:91], v[40:43], a[172:175]
    v_mfma_f32_16x16x32_bf16 a[172:175], a[92:95], v[44:47], a[172:175]
    v_mfma_f32_16x16x32_bf16 a[176:179], a[96:99], v[40:43], a[176:179]
    ds_read_b128 a[48:51], v22 offset:20480
    v_mfma_f32_16x16x32_bf16 a[176:179], a[100:103], v[44:47], a[176:179]
    v_mfma_f32_16x16x32_bf16 a[180:183], a[104:107], v[40:43], a[180:183]
    v_mfma_f32_16x16x32_bf16 a[180:183], a[108:111], v[44:47], a[180:183]
    buffer_load_dwordx4 v11, s[20:23], s63 offen offset:1024 lds
    v_mfma_f32_16x16x32_bf16 a[184:187], a[112:115], v[40:43], a[184:187]
    v_mfma_f32_16x16x32_bf16 a[184:187], a[116:119], v[44:47], a[184:187]
    ds_read_b128 a[52:55], v23 offset:20480
    v_mfma_f32_16x16x32_bf16 a[188:191], a[120:123], v[40:43], a[188:191]
    v_mfma_f32_16x16x32_bf16 a[188:191], a[124:127], v[44:47], a[188:191]
    s_waitcnt lgkmcnt(1)
    v_mfma_f32_16x16x32_bf16 a[192:195], a[64:67], v[48:51], a[192:195]
    v_mfma_f32_16x16x32_bf16 a[192:195], a[68:71], v[52:55], a[192:195]
    v_mfma_f32_16x16x32_bf16 a[196:199], a[72:75], v[48:51], a[196:199]
    v_mfma_f32_16x16x32_bf16 a[196:199], a[76:79], v[52:55], a[196:199]
    buffer_load_dwordx4 v12, s[20:23], s63 offen offset:2048 lds
    v_mfma_f32_16x16x32_bf16 a[200:203], a[80:83], v[48:51], a[200:203]
    ds_read_b128 a[56:59], v22 offset:22528
    v_mfma_f32_16x16x32_bf16 a[200:203], a[84:87], v[52:55], a[200:203]
    v_mfma_f32_16x16x32_bf16 a[204:207], a[88:91], v[48:51], a[204:207]
    v_mfma_f32_16x16x32_bf16 a[204:207], a[92:95], v[52:55], a[204:207]
    v_mfma_f32_16x16x32_bf16 a[208:211], a[96:99], v[48:51], a[208:211]
    ds_read_b128 a[60:63], v23 offset:22528
    v_mfma_f32_16x16x32_bf16 a[208:211], a[100:103], v[52:55], a[208:211]
    v_mfma_f32_16x16x32_bf16 a[212:215], a[104:107], v[48:51], a[212:215]
    buffer_load_dwordx4 v13, s[20:23], s63 offen offset:3072 lds
    v_mfma_f32_16x16x32_bf16 a[212:215], a[108:111], v[52:55], a[212:215]
    v_mfma_f32_16x16x32_bf16 a[216:219], a[112:115], v[48:51], a[216:219]
    v_mfma_f32_16x16x32_bf16 a[216:219], a[116:119], v[52:55], a[216:219]
    v_mfma_f32_16x16x32_bf16 a[220:223], a[120:123], v[48:51], a[220:223]
    v_mfma_f32_16x16x32_bf16 a[220:223], a[124:127], v[52:55], a[220:223]
    v_mfma_f32_16x16x32_bf16 a[224:227], a[64:67], v[56:59], a[224:227]
    v_mfma_f32_16x16x32_bf16 a[224:227], a[68:71], v[60:63], a[224:227]
    s_xor_b32 s63, s63, 128
    v_mfma_f32_16x16x32_bf16 a[228:231], a[72:75], v[56:59], a[228:231]
    v_mfma_f32_16x16x32_bf16 a[228:231], a[76:79], v[60:63], a[228:231]
    v_mfma_f32_16x16x32_bf16 a[232:235], a[80:83], v[56:59], a[232:235]
    v_mfma_f32_16x16x32_bf16 a[232:235], a[84:87], v[60:63], a[232:235]
    s_waitcnt vmcnt(9) lgkmcnt(0)
    s_barrier
    ds_read_b64_tr_b16 v[40:41], v14 offset:32768
    v_mfma_f32_16x16x32_bf16 a[236:239], a[88:91], v[56:59], a[236:239]
    s_add_u32 m0, s69, 32768
    ds_read_b64_tr_b16 v[42:43], v14 offset:33792
    ds_read_b64_tr_b16 v[44:45], v14 offset:40960
    v_mfma_f32_16x16x32_bf16 a[236:239], a[92:95], v[60:63], a[236:239]
    buffer_load_dwordx4 v2, s[16:19], s60 offen nt lds
    v_mfma_f32_16x16x32_bf16 a[240:243], a[96:99], v[56:59], a[240:243]
    ds_read_b64_tr_b16 v[46:47], v14 offset:41984
    ds_read_b64_tr_b16 v[48:49], v15 offset:32768
    v_mfma_f32_16x16x32_bf16 a[240:243], a[100:103], v[60:63], a[240:243]
    ds_read_b64_tr_b16 v[50:51], v15 offset:33792
    ds_read_b64_tr_b16 v[52:53], v15 offset:40960
    v_mfma_f32_16x16x32_bf16 a[244:247], a[104:107], v[56:59], a[244:247]
    ds_read_b64_tr_b16 v[54:55], v15 offset:41984
    v_add_u32 v14, 0x10000, v14
    v_mfma_f32_16x16x32_bf16 a[244:247], a[108:111], v[60:63], a[244:247]
    v_add_u32 v15, 0x10000, v15
    v_mfma_f32_16x16x32_bf16 a[248:251], a[112:115], v[56:59], a[248:251]
    v_mfma_f32_16x16x32_bf16 a[248:251], a[116:119], v[60:63], a[248:251]
    buffer_load_dwordx4 v3, s[16:19], s60 offen offset:1024 nt lds
    v_mfma_f32_16x16x32_bf16 a[252:255], a[120:123], v[56:59], a[252:255]
    ds_read_b64_tr_b16 v[56:57], v16 offset:32768
    ds_read_b64_tr_b16 v[58:59], v16 offset:33792
    v_mfma_f32_16x16x32_bf16 a[252:255], a[124:127], v[60:63], a[252:255]
    s_waitcnt lgkmcnt(2)
    ds_read_b64_tr_b16 v[60:61], v16 offset:40960
    ds_read_b64_tr_b16 v[62:63], v16 offset:41984
    v_mfma_f32_16x16x32_bf16 v[128:131], v[40:43], a[0:3], v[128:131]
    v_add_u32 v16, 0x10000, v16
    v_mfma_f32_16x16x32_bf16 v[128:131], v[44:47], a[4:7], v[128:131]
    ds_read_b128 a[64:67], v22 offset:49152
    v_mfma_f32_16x16x32_bf16 v[132:135], v[40:43], a[8:11], v[132:135]
    v_mfma_f32_16x16x32_bf16 v[132:135], v[44:47], a[12:15], v[132:135]
    v_mfma_f32_16x16x32_bf16 v[136:139], v[40:43], a[16:19], v[136:139]
    ds_read_b128 a[68:71], v23 offset:49152
    v_mfma_f32_16x16x32_bf16 v[136:139], v[44:47], a[20:23], v[136:139]
    buffer_load_dwordx4 v4, s[16:19], s60 offen offset:2048 nt lds
    v_mfma_f32_16x16x32_bf16 v[140:143], v[40:43], a[24:27], v[140:143]
    v_mfma_f32_16x16x32_bf16 v[140:143], v[44:47], a[28:31], v[140:143]
    ds_read_b128 a[72:75], v22 offset:51200
    v_mfma_f32_16x16x32_bf16 v[144:147], v[40:43], a[32:35], v[144:147]
    v_mfma_f32_16x16x32_bf16 v[144:147], v[44:47], a[36:39], v[144:147]
    v_mfma_f32_16x16x32_bf16 v[148:151], v[40:43], a[40:43], v[148:151]
    ds_read_b128 a[76:79], v23 offset:51200
    v_mfma_f32_16x16x32_bf16 v[148:151], v[44:47], a[44:47], v[148:151]
    v_mfma_f32_16x16x32_bf16 v[152:155], v[40:43], a[48:51], v[152:155]
    buffer_load_dwordx4 v5, s[16:19], s60 offen offset:3072 nt lds
    v_mfma_f32_16x16x32_bf16 v[152:155], v[44:47], a[52:55], v[152:155]
    s_cmp_eq_u32 s6, 0
    s_cselect_b32 s18, s10, 0
    s_cselect_b32 s19, s11, 0
    v_mfma_f32_16x16x32_bf16 v[156:159], v[40:43], a[56:59], v[156:159]
    ds_read_b128 a[80:83], v22 offset:53248
    ds_read_b64_tr_b16 v[40:41], v17 offset:32768
    v_mfma_f32_16x16x32_bf16 v[156:159], v[44:47], a[60:63], v[156:159]
    ds_read_b64_tr_b16 v[42:43], v17 offset:33792
    ds_read_b64_tr_b16 v[44:45], v17 offset:40960
    v_mfma_f32_16x16x32_bf16 v[160:163], v[48:51], a[0:3], v[160:163]
    ds_read_b64_tr_b16 v[46:47], v17 offset:41984
    v_add_u32 v17, 0x10000, v17
    v_mfma_f32_16x16x32_bf16 v[160:163], v[52:55], a[4:7], v[160:163]
    ds_read_b128 a[84:87], v23 offset:53248
    v_mfma_f32_16x16x32_bf16 v[164:167], v[48:51], a[8:11], v[164:167]
    v_mfma_f32_16x16x32_bf16 v[164:167], v[52:55], a[12:15], v[164:167]
    s_add_u32 m0, s69, 49152
    buffer_load_dword v7, v9, s[44:47], s69 offen sc1
    v_mfma_f32_16x16x32_bf16 v[168:171], v[48:51], a[16:19], v[168:171]
    s_xor_b32 s60, s60, 3670016
    buffer_load_dwordx4 v10, s[20:23], s64 offen lds
    v_mfma_f32_16x16x32_bf16 v[168:171], v[52:55], a[20:23], v[168:171]
    ds_read_b128 a[88:91], v22 offset:55296
    v_mfma_f32_16x16x32_bf16 v[172:175], v[48:51], a[24:27], v[172:175]
    v_mfma_f32_16x16x32_bf16 v[172:175], v[52:55], a[28:31], v[172:175]
    s_waitcnt lgkmcnt(1)
    ds_read_b128 a[92:95], v23 offset:55296
    v_mfma_f32_16x16x32_bf16 v[176:179], v[48:51], a[32:35], v[176:179]
    v_mfma_f32_16x16x32_bf16 v[176:179], v[52:55], a[36:39], v[176:179]
    v_mfma_f32_16x16x32_bf16 v[180:183], v[48:51], a[40:43], v[180:183]
    v_mfma_f32_16x16x32_bf16 v[180:183], v[52:55], a[44:47], v[180:183]
    buffer_load_dwordx4 v11, s[20:23], s64 offen offset:1024 lds
    v_mfma_f32_16x16x32_bf16 v[184:187], v[48:51], a[48:51], v[184:187]
    v_add_u32 v22, 0x10000, v22
    ds_read_b128 a[96:99], v22 offset:16384
    v_mfma_f32_16x16x32_bf16 v[184:187], v[52:55], a[52:55], v[184:187]
    v_mfma_f32_16x16x32_bf16 v[188:191], v[48:51], a[56:59], v[188:191]
    v_add_u32 v23, 0x10000, v23
    ds_read_b64_tr_b16 v[48:49], v14 offset:0
    v_mfma_f32_16x16x32_bf16 v[188:191], v[52:55], a[60:63], v[188:191]
    ds_read_b128 a[100:103], v23 offset:16384
    ds_read_b64_tr_b16 v[50:51], v14 offset:1024
    v_mfma_f32_16x16x32_bf16 v[192:195], v[56:59], a[0:3], v[192:195]
    ds_read_b64_tr_b16 v[52:53], v14 offset:8192
    ds_read_b64_tr_b16 v[54:55], v14 offset:9216
    v_mfma_f32_16x16x32_bf16 v[192:195], v[60:63], a[4:7], v[192:195]
    v_add_u32 v14, 0xfffe0000, v14
    v_mfma_f32_16x16x32_bf16 v[196:199], v[56:59], a[8:11], v[196:199]
    ds_read_b128 a[104:107], v22 offset:18432
    v_mfma_f32_16x16x32_bf16 v[196:199], v[60:63], a[12:15], v[196:199]
    buffer_load_dwordx4 v12, s[20:23], s64 offen offset:2048 lds
    v_mfma_f32_16x16x32_bf16 v[200:203], v[56:59], a[16:19], v[200:203]
    v_mfma_f32_16x16x32_bf16 v[200:203], v[60:63], a[20:23], v[200:203]
    ds_read_b128 a[108:111], v23 offset:18432
    v_mfma_f32_16x16x32_bf16 v[204:207], v[56:59], a[24:27], v[204:207]
    v_mfma_f32_16x16x32_bf16 v[204:207], v[60:63], a[28:31], v[204:207]
    v_mfma_f32_16x16x32_bf16 v[208:211], v[56:59], a[32:35], v[208:211]
    v_mfma_f32_16x16x32_bf16 v[208:211], v[60:63], a[36:39], v[208:211]
    ds_read_b128 a[112:115], v22 offset:20480
    v_mfma_f32_16x16x32_bf16 v[212:215], v[56:59], a[40:43], v[212:215]
    buffer_load_dwordx4 v13, s[20:23], s64 offen offset:3072 lds
    v_mfma_f32_16x16x32_bf16 v[212:215], v[60:63], a[44:47], v[212:215]
    v_mfma_f32_16x16x32_bf16 v[216:219], v[56:59], a[48:51], v[216:219]
    ds_read_b128 a[116:119], v23 offset:20480
    v_mfma_f32_16x16x32_bf16 v[216:219], v[60:63], a[52:55], v[216:219]
    v_mfma_f32_16x16x32_bf16 v[220:223], v[56:59], a[56:59], v[220:223]
    ds_read_b64_tr_b16 v[56:57], v15 offset:0
    ds_read_b64_tr_b16 v[58:59], v15 offset:1024
    v_mfma_f32_16x16x32_bf16 v[220:223], v[60:63], a[60:63], v[220:223]
    s_waitcnt lgkmcnt(3)
    ds_read_b128 a[120:123], v22 offset:22528
    ds_read_b64_tr_b16 v[60:61], v15 offset:8192
    v_mfma_f32_16x16x32_bf16 v[224:227], v[40:43], a[0:3], v[224:227]
    ds_read_b64_tr_b16 v[62:63], v15 offset:9216
    v_add_u32 v15, 0xfffe0000, v15
    v_mfma_f32_16x16x32_bf16 v[224:227], v[44:47], a[4:7], v[224:227]
    s_xor_b32 s64, s64, 128
    v_mov_b32 v22, v100
    v_add_u32 v22, 0x10000, v22
    v_mfma_f32_16x16x32_bf16 v[228:231], v[40:43], a[8:11], v[228:231]
    ds_read_b128 a[124:127], v23 offset:22528
    v_mov_b32 v23, v101
    v_mfma_f32_16x16x32_bf16 v[228:231], v[44:47], a[12:15], v[228:231]
    v_add_u32 v23, 0x10000, v23
    v_mfma_f32_16x16x32_bf16 v[232:235], v[40:43], a[16:19], v[232:235]
    v_mfma_f32_16x16x32_bf16 v[232:235], v[44:47], a[20:23], v[232:235]
    s_add_u32 m0, s69, 65536
    v_mfma_f32_16x16x32_bf16 v[236:239], v[40:43], a[24:27], v[236:239]
    buffer_load_dwordx4 v2, s[24:27], s60 offen lds
    v_mfma_f32_16x16x32_bf16 v[236:239], v[44:47], a[28:31], v[236:239]
    v_mfma_f32_16x16x32_bf16 v[240:243], v[40:43], a[32:35], v[240:243]
    v_mfma_f32_16x16x32_bf16 v[240:243], v[44:47], a[36:39], v[240:243]
    v_mfma_f32_16x16x32_bf16 v[244:247], v[40:43], a[40:43], v[244:247]
    v_mfma_f32_16x16x32_bf16 v[244:247], v[44:47], a[44:47], v[244:247]
    v_mfma_f32_16x16x32_bf16 v[248:251], v[40:43], a[48:51], v[248:251]
    v_mfma_f32_16x16x32_bf16 v[248:251], v[44:47], a[52:55], v[248:251]
    buffer_load_dwordx4 v3, s[24:27], s60 offen offset:1024 lds
    v_mfma_f32_16x16x32_bf16 v[252:255], v[40:43], a[56:59], v[252:255]
    ds_read_b64_tr_b16 v[40:41], v16 offset:0
    ds_read_b64_tr_b16 v[42:43], v16 offset:1024
    v_mfma_f32_16x16x32_bf16 v[252:255], v[44:47], a[60:63], v[252:255]
    ds_read_b64_tr_b16 v[44:45], v16 offset:8192
    ds_read_b64_tr_b16 v[46:47], v16 offset:9216
    v_mfma_f32_16x16x32_bf16 v[128:131], v[48:51], a[64:67], v[128:131]
    v_add_u32 v16, 0xfffe0000, v16
    v_mfma_f32_16x16x32_bf16 v[128:131], v[52:55], a[68:71], v[128:131]
    v_mfma_f32_16x16x32_bf16 v[132:135], v[48:51], a[72:75], v[132:135]
    v_mfma_f32_16x16x32_bf16 v[132:135], v[52:55], a[76:79], v[132:135]
    v_mfma_f32_16x16x32_bf16 v[136:139], v[48:51], a[80:83], v[136:139]
    v_mfma_f32_16x16x32_bf16 v[136:139], v[52:55], a[84:87], v[136:139]
    buffer_load_dwordx4 v4, s[24:27], s60 offen offset:2048 lds
    v_mfma_f32_16x16x32_bf16 v[140:143], v[48:51], a[88:91], v[140:143]
    v_mfma_f32_16x16x32_bf16 v[140:143], v[52:55], a[92:95], v[140:143]
    v_mfma_f32_16x16x32_bf16 v[144:147], v[48:51], a[96:99], v[144:147]
    v_mul_f32 v128, s74, v128
    v_mul_f32 v129, s74, v129
    v_mfma_f32_16x16x32_bf16 v[144:147], v[52:55], a[100:103], v[144:147]
    v_mul_f32 v130, s74, v130
    v_mul_f32 v131, s74, v131
    v_mfma_f32_16x16x32_bf16 v[148:151], v[48:51], a[104:107], v[148:151]
    v_cvt_pk_bf16_f32 v128, v128, v129
    v_cvt_pk_bf16_f32 v129, v130, v131
    v_mfma_f32_16x16x32_bf16 v[148:151], v[52:55], a[108:111], v[148:151]
    v_mul_f32 v132, s74, v132
    v_mul_f32 v133, s74, v133
    v_mfma_f32_16x16x32_bf16 v[152:155], v[48:51], a[112:115], v[152:155]
    s_waitcnt lgkmcnt(0)
    buffer_load_dwordx4 v5, s[24:27], s60 offen offset:3072 lds
    v_mfma_f32_16x16x32_bf16 v[152:155], v[52:55], a[116:119], v[152:155]
    v_mul_f32 v134, s74, v134
    v_mul_f32 v135, s74, v135
    v_mfma_f32_16x16x32_bf16 v[156:159], v[48:51], a[120:123], v[156:159]
    ds_read_b64_tr_b16 v[48:49], v17 offset:0
    ds_read_b64_tr_b16 v[50:51], v17 offset:1024
    v_mfma_f32_16x16x32_bf16 v[156:159], v[52:55], a[124:127], v[156:159]
    ds_read_b64_tr_b16 v[52:53], v17 offset:8192
    ds_read_b64_tr_b16 v[54:55], v17 offset:9216
    v_mfma_f32_16x16x32_bf16 v[160:163], v[56:59], a[64:67], v[160:163]
    v_add_u32 v17, 0xfffe0000, v17
    v_cvt_pk_bf16_f32 v132, v132, v133
    v_mfma_f32_16x16x32_bf16 v[160:163], v[60:63], a[68:71], v[160:163]
    v_cvt_pk_bf16_f32 v133, v134, v135
    v_mul_f32 v136, s74, v136
    v_mfma_f32_16x16x32_bf16 v[164:167], v[56:59], a[72:75], v[164:167]
    v_mul_f32 v137, s74, v137
    v_mul_f32 v138, s74, v138
    v_mfma_f32_16x16x32_bf16 v[164:167], v[60:63], a[76:79], v[164:167]
    s_add_u32 m0, s69, 81920
    v_mul_f32 v139, s74, v139
    v_mul_f32 v160, s74, v160
    v_mfma_f32_16x16x32_bf16 v[168:171], v[56:59], a[80:83], v[168:171]
    s_xor_b32 s60, s60, 524288
    buffer_load_dwordx4 v10, s[20:23], s63 offen lds
    v_mfma_f32_16x16x32_bf16 v[168:171], v[60:63], a[84:87], v[168:171]
    v_mul_f32 v161, s74, v161
    v_mul_f32 v162, s74, v162
    v_mfma_f32_16x16x32_bf16 v[172:175], v[56:59], a[88:91], v[172:175]
    v_mul_f32 v163, s74, v163
    v_cvt_pk_bf16_f32 v130, v160, v161
    v_mfma_f32_16x16x32_bf16 v[172:175], v[60:63], a[92:95], v[172:175]
    v_cvt_pk_bf16_f32 v131, v162, v163
    v_mul_f32 v164, s74, v164
    v_mfma_f32_16x16x32_bf16 v[176:179], v[56:59], a[96:99], v[176:179]
    v_mul_f32 v165, s74, v165
    v_mul_f32 v166, s74, v166
    v_mfma_f32_16x16x32_bf16 v[176:179], v[60:63], a[100:103], v[176:179]
    v_mul_f32 v167, s74, v167
    v_cvt_pk_bf16_f32 v134, v164, v165
    v_mfma_f32_16x16x32_bf16 v[180:183], v[56:59], a[104:107], v[180:183]
    v_cvt_pk_bf16_f32 v135, v166, v167
    v_mul_f32 v168, s74, v168
    v_mfma_f32_16x16x32_bf16 v[180:183], v[60:63], a[108:111], v[180:183]
    buffer_load_dwordx4 v11, s[20:23], s63 offen offset:1024 lds
    v_mfma_f32_16x16x32_bf16 v[184:187], v[56:59], a[112:115], v[184:187]
    v_mul_f32 v169, s74, v169
    v_mul_f32 v170, s74, v170
    v_mfma_f32_16x16x32_bf16 v[184:187], v[60:63], a[116:119], v[184:187]
    v_mul_f32 v171, s74, v171
    v_cvt_pk_bf16_f32 v136, v136, v137
    v_mfma_f32_16x16x32_bf16 v[188:191], v[56:59], a[120:123], v[188:191]
    v_cvt_pk_bf16_f32 v137, v138, v139
    v_cvt_pk_bf16_f32 v138, v168, v169
    v_mfma_f32_16x16x32_bf16 v[188:191], v[60:63], a[124:127], v[188:191]
    v_cvt_pk_bf16_f32 v139, v170, v171
    v_mul_f32 v140, s74, v140
    v_mfma_f32_16x16x32_bf16 v[192:195], v[40:43], a[64:67], v[192:195]
    v_mul_f32 v141, s74, v141
    v_mul_f32 v142, s74, v142
    v_mfma_f32_16x16x32_bf16 v[192:195], v[44:47], a[68:71], v[192:195]
    v_mul_f32 v143, s74, v143
    v_mul_f32 v172, s74, v172
    v_mfma_f32_16x16x32_bf16 v[196:199], v[40:43], a[72:75], v[196:199]
    v_mul_f32 v173, s74, v173
    v_mul_f32 v174, s74, v174
    v_mfma_f32_16x16x32_bf16 v[196:199], v[44:47], a[76:79], v[196:199]
    buffer_load_dwordx4 v12, s[20:23], s63 offen offset:2048 lds
    v_mfma_f32_16x16x32_bf16 v[200:203], v[40:43], a[80:83], v[200:203]
    v_mul_f32 v175, s74, v175
    v_cvt_pk_bf16_f32 v140, v140, v141
    v_mfma_f32_16x16x32_bf16 v[200:203], v[44:47], a[84:87], v[200:203]
    v_cvt_pk_bf16_f32 v141, v142, v143
    v_cvt_pk_bf16_f32 v142, v172, v173
    v_mfma_f32_16x16x32_bf16 v[204:207], v[40:43], a[88:91], v[204:207]
    v_cvt_pk_bf16_f32 v143, v174, v175
    v_mul_f32 v144, s74, v144
    v_mfma_f32_16x16x32_bf16 v[204:207], v[44:47], a[92:95], v[204:207]
    v_mul_f32 v145, s74, v145
    v_mul_f32 v146, s74, v146
    v_mfma_f32_16x16x32_bf16 v[208:211], v[40:43], a[96:99], v[208:211]
    v_mul_f32 v147, s74, v147
    v_mul_f32 v176, s74, v176
    v_mfma_f32_16x16x32_bf16 v[208:211], v[44:47], a[100:103], v[208:211]
    v_mul_f32 v177, s74, v177
    v_mul_f32 v178, s74, v178
    v_mfma_f32_16x16x32_bf16 v[212:215], v[40:43], a[104:107], v[212:215]
    buffer_load_dwordx4 v13, s[20:23], s63 offen offset:3072 lds
    v_mfma_f32_16x16x32_bf16 v[212:215], v[44:47], a[108:111], v[212:215]
    v_mul_f32 v179, s74, v179
    v_cvt_pk_bf16_f32 v144, v144, v145
    v_mfma_f32_16x16x32_bf16 v[216:219], v[40:43], a[112:115], v[216:219]
    v_cvt_pk_bf16_f32 v145, v146, v147
    v_cvt_pk_bf16_f32 v146, v176, v177
    v_mfma_f32_16x16x32_bf16 v[216:219], v[44:47], a[116:119], v[216:219]
    v_cvt_pk_bf16_f32 v147, v178, v179
    v_mul_f32 v148, s74, v148
    v_mfma_f32_16x16x32_bf16 v[220:223], v[40:43], a[120:123], v[220:223]
    v_mul_f32 v149, s74, v149
    v_mul_f32 v150, s74, v150
    v_mfma_f32_16x16x32_bf16 v[220:223], v[44:47], a[124:127], v[220:223]
    s_add_u32 s72, s70, 0
    v_mul_f32 v151, s74, v151
    v_mul_f32 v180, s74, v180
    s_waitcnt lgkmcnt(0)
    v_mfma_f32_16x16x32_bf16 v[224:227], v[48:51], a[64:67], v[224:227]
    buffer_store_dwordx4 v[128:131], v1, s[36:39], s72 offen sc1
    v_mfma_f32_16x16x32_bf16 v[224:227], v[52:55], a[68:71], v[224:227]
    s_xor_b32 s63, s63, 384
    v_mul_f32 v181, s74, v181
    v_mul_f32 v182, s74, v182
    v_mfma_f32_16x16x32_bf16 v[228:231], v[48:51], a[72:75], v[228:231]
    v_mul_f32 v183, s74, v183
    v_cvt_pk_bf16_f32 v148, v148, v149
    v_mfma_f32_16x16x32_bf16 v[228:231], v[52:55], a[76:79], v[228:231]
    v_cvt_pk_bf16_f32 v149, v150, v151
    v_cvt_pk_bf16_f32 v150, v180, v181
    v_mfma_f32_16x16x32_bf16 v[232:235], v[48:51], a[80:83], v[232:235]
    v_cvt_pk_bf16_f32 v151, v182, v183
    v_mul_f32 v152, s74, v152
    v_mfma_f32_16x16x32_bf16 v[232:235], v[52:55], a[84:87], v[232:235]
    s_add_u32 m0, s67, 98304
    v_mul_f32 v153, s74, v153
    v_mul_f32 v154, s74, v154
    s_waitcnt vmcnt(9) lgkmcnt(0)
    v_cmp_gt_u32 vcc, 8, v7
    s_nop 1
    s_and_b64 vcc, vcc, s[86:87]
    s_cbranch_scc1 SPIN_WA
BACK_WA:
    s_barrier
    v_mfma_f32_16x16x32_bf16 v[236:239], v[48:51], a[88:91], v[236:239]
    buffer_load_dwordx4 v1, s[28:31], s65 offen sc1 lds
    v_mfma_f32_16x16x32_bf16 v[236:239], v[52:55], a[92:95], v[236:239]
    ds_read_b64_tr_b16 v[56:57], v14 offset:0
    ds_read_b64_tr_b16 v[58:59], v14 offset:1024
    v_mfma_f32_16x16x32_bf16 v[240:243], v[48:51], a[96:99], v[240:243]
    ds_read_b64_tr_b16 v[60:61], v14 offset:8192
    ds_read_b64_tr_b16 v[62:63], v14 offset:9216
    v_mfma_f32_16x16x32_bf16 v[240:243], v[52:55], a[100:103], v[240:243]
    ds_read_b64_tr_b16 v[40:41], v15 offset:0
    ds_read_b64_tr_b16 v[42:43], v15 offset:1024
    v_mfma_f32_16x16x32_bf16 v[244:247], v[48:51], a[104:107], v[244:247]
    ds_read_b64_tr_b16 v[44:45], v15 offset:8192
    ds_read_b64_tr_b16 v[46:47], v15 offset:9216
    v_mfma_f32_16x16x32_bf16 v[244:247], v[52:55], a[108:111], v[244:247]
    v_mul_f32 v155, s74, v155
    v_mul_f32 v184, s74, v184
    v_mfma_f32_16x16x32_bf16 v[248:251], v[48:51], a[112:115], v[248:251]
    v_mul_f32 v185, s74, v185
    v_mul_f32 v186, s74, v186
    v_mfma_f32_16x16x32_bf16 v[248:251], v[52:55], a[116:119], v[248:251]
    v_mul_f32 v187, s74, v187
    v_cvt_pk_bf16_f32 v152, v152, v153
    v_mfma_f32_16x16x32_bf16 v[252:255], v[48:51], a[120:123], v[252:255]
    s_lshr_b32 s92, s2, 3
    buffer_load_dwordx4 v1, s[28:31], s65 offen offset:1024 sc1 lds
    v_mfma_f32_16x16x32_bf16 v[252:255], v[52:55], a[124:127], v[252:255]
    s_lshl2_add_u32 s92, s92, s4
    v_lshrrev_b32 v9, 4, v1
    v_min_u32 v9, 0, v9
    s_waitcnt lgkmcnt(0)
    v_mfma_f32_16x16x32_bf16 a[128:131], a[0:3], v[56:59], a[128:131]
    s_mul_i32 s92, s92, 1
    ds_read_b64_tr_b16 v[48:49], v16 offset:0
    ds_read_b64_tr_b16 v[50:51], v16 offset:1024
    v_mfma_f32_16x16x32_bf16 a[128:131], a[4:7], v[60:63], a[128:131]
    s_add_u32 s92, s92, 32
    v_add_lshl_u32 v9, v9, s92, 7
    ds_read_b64_tr_b16 v[52:53], v16 offset:8192
    v_mfma_f32_16x16x32_bf16 a[132:135], a[8:11], v[56:59], a[132:135]
    s_getpc_b64 s[92:93]
    global_load_dword v9, v9, s[92:93]
    v_mfma_f32_16x16x32_bf16 a[132:135], a[12:15], v[60:63], a[132:135]
    ds_read_b128 v[64:67], v24 offset:16384
    ds_read_b64_tr_b16 v[54:55], v16 offset:9216
    v_mfma_f32_16x16x32_bf16 a[136:139], a[16:19], v[56:59], a[136:139]
    v_cvt_pk_bf16_f32 v153, v154, v155
    v_cvt_pk_bf16_f32 v154, v184, v185
    v_mfma_f32_16x16x32_bf16 a[136:139], a[20:23], v[60:63], a[136:139]
    v_cvt_pk_bf16_f32 v155, v186, v187
    v_mul_f32 v156, s74, v156
    v_mfma_f32_16x16x32_bf16 a[140:143], a[24:27], v[56:59], a[140:143]
    s_add_u32 m0, s68, 106496
    v_mul_f32 v157, s74, v157
    v_mul_f32 v158, s74, v158
    v_mfma_f32_16x16x32_bf16 a[140:143], a[28:31], v[60:63], a[140:143]
    buffer_load_dwordx4 v6, s[20:23], s66 offen lds
    v_mfma_f32_16x16x32_bf16 a[144:147], a[32:35], v[56:59], a[144:147]
    s_add_u32 s72, s70, 4096
    v_mul_f32 v159, s74, v159
    v_mul_f32 v188, s74, v188
    v_mfma_f32_16x16x32_bf16 a[144:147], a[36:39], v[60:63], a[144:147]
    buffer_store_dwordx4 v[132:135], v1, s[36:39], s72 offen sc1
    v_mfma_f32_16x16x32_bf16 a[148:151], a[40:43], v[56:59], a[148:151]
    v_mul_f32 v189, s74, v189
    v_mul_f32 v190, s74, v190
    v_mfma_f32_16x16x32_bf16 a[148:151], a[44:47], v[60:63], a[148:151]
    v_mul_f32 v191, s74, v191
    v_cvt_pk_bf16_f32 v156, v156, v157
    v_mfma_f32_16x16x32_bf16 a[152:155], a[48:51], v[56:59], a[152:155]
    v_cvt_pk_bf16_f32 v157, v158, v159
    v_cvt_pk_bf16_f32 v158, v188, v189
    v_mfma_f32_16x16x32_bf16 a[152:155], a[52:55], v[60:63], a[152:155]
    ds_read_b128 v[68:71], v25 offset:16384
    v_cvt_pk_bf16_f32 v159, v190, v191
    v_mfma_f32_16x16x32_bf16 a[156:159], a[56:59], v[56:59], a[156:159]
    s_add_u32 m0, s69, 114688
    ds_read_b64_tr_b16 v[56:57], v17 offset:0
    ds_read_b64_tr_b16 v[58:59], v17 offset:1024
    v_mfma_f32_16x16x32_bf16 a[156:159], a[60:63], v[60:63], a[156:159]
    s_xor_b32 s65, s65, 8192
    buffer_load_dwordx4 v10, s[20:23], s64 offen lds
    v_mfma_f32_16x16x32_bf16 a[160:163], a[0:3], v[40:43], a[160:163]
    s_xor_b32 s66, s66, 128
    ds_read_b64_tr_b16 v[60:61], v17 offset:8192
    ds_read_b64_tr_b16 v[62:63], v17 offset:9216
    v_mfma_f32_16x16x32_bf16 a[160:163], a[4:7], v[44:47], a[160:163]
    v_mul_f32 v192, s74, v192
    v_mul_f32 v193, s74, v193
    v_mfma_f32_16x16x32_bf16 a[164:167], a[8:11], v[40:43], a[164:167]
    v_mul_f32 v194, s74, v194
    v_mul_f32 v195, s74, v195
    v_mfma_f32_16x16x32_bf16 a[164:167], a[12:15], v[44:47], a[164:167]
    v_mul_f32 v224, s74, v224
    v_mul_f32 v225, s74, v225
    v_mfma_f32_16x16x32_bf16 a[168:171], a[16:19], v[40:43], a[168:171]
    v_mul_f32 v226, s74, v226
    v_mul_f32 v227, s74, v227
    v_mfma_f32_16x16x32_bf16 a[168:171], a[20:23], v[44:47], a[168:171]
    v_cvt_pk_bf16_f32 v192, v192, v193
    v_cvt_pk_bf16_f32 v193, v194, v195
    v_mfma_f32_16x16x32_bf16 a[172:175], a[24:27], v[40:43], a[172:175]
    v_cvt_pk_bf16_f32 v194, v224, v225
    v_cvt_pk_bf16_f32 v195, v226, v227
    v_mfma_f32_16x16x32_bf16 a[172:175], a[28:31], v[44:47], a[172:175]
    v_mul_f32 v196, s74, v196
    v_mul_f32 v197, s74, v197
    v_mfma_f32_16x16x32_bf16 a[176:179], a[32:35], v[40:43], a[176:179]
    buffer_load_dwordx4 v11, s[20:23], s64 offen offset:1024 lds
    v_mfma_f32_16x16x32_bf16 a[176:179], a[36:39], v[44:47], a[176:179]
    ds_read_b128 v[72:75], v24 offset:24576
    v_mul_f32 v198, s74, v198
    v_mfma_f32_16x16x32_bf16 a[180:183], a[40:43], v[40:43], a[180:183]
    v_mul_f32 v199, s74, v199
    v_mul_f32 v228, s74, v228
    v_mfma_f32_16x16x32_bf16 a[180:183], a[44:47], v[44:47], a[180:183]
    v_mul_f32 v229, s74, v229
    v_mul_f32 v230, s74, v230
    v_mfma_f32_16x16x32_bf16 a[184:187], a[48:51], v[40:43], a[184:187]
    v_mul_f32 v231, s74, v231
    v_cvt_pk_bf16_f32 v196, v196, v197
    v_mfma_f32_16x16x32_bf16 a[184:187], a[52:55], v[44:47], a[184:187]
    v_cvt_pk_bf16_f32 v197, v198, v199
    v_cvt_pk_bf16_f32 v198, v228, v229
    v_mfma_f32_16x16x32_bf16 a[188:191], a[56:59], v[40:43], a[188:191]
    ds_read_b64_tr_b16 v[40:41], v14 offset:32768
    ds_read_b64_tr_b16 v[42:43], v14 offset:33792
    v_mfma_f32_16x16x32_bf16 a[188:191], a[60:63], v[44:47], a[188:191]
    s_waitcnt lgkmcnt(2)
    ds_read_b64_tr_b16 v[44:45], v14 offset:40960
    ds_read_b64_tr_b16 v[46:47], v14 offset:41984
    v_mfma_f32_16x16x32_bf16 a[192:195], a[0:3], v[48:51], a[192:195]
    buffer_load_dwordx4 v12, s[20:23], s64 offen offset:2048 lds
    v_mfma_f32_16x16x32_bf16 a[192:195], a[4:7], v[52:55], a[192:195]
    s_add_u32 s72, s70, 8192
    v_xor_b32 v14, s73, v14
    v_add_u32 v14, 0x10000, v14
    v_mfma_f32_16x16x32_bf16 a[196:199], a[8:11], v[48:51], a[196:199]
    buffer_store_dwordx4 v[136:139], v1, s[36:39], s72 offen sc1
    v_mfma_f32_16x16x32_bf16 a[196:199], a[12:15], v[52:55], a[196:199]
    ds_read_b128 v[76:79], v25 offset:24576
    v_cvt_pk_bf16_f32 v199, v230, v231
    v_mfma_f32_16x16x32_bf16 a[200:203], a[16:19], v[48:51], a[200:203]
    v_mul_f32 v200, s74, v200
    v_mul_f32 v201, s74, v201
    v_mfma_f32_16x16x32_bf16 a[200:203], a[20:23], v[52:55], a[200:203]
    v_mul_f32 v202, s74, v202
    v_mul_f32 v203, s74, v203
    v_mfma_f32_16x16x32_bf16 a[204:207], a[24:27], v[48:51], a[204:207]
    v_mul_f32 v232, s74, v232
    v_mul_f32 v233, s74, v233
    v_mfma_f32_16x16x32_bf16 a[204:207], a[28:31], v[52:55], a[204:207]
    v_mul_f32 v234, s74, v234
    v_mul_f32 v235, s74, v235
    v_mfma_f32_16x16x32_bf16 a[208:211], a[32:35], v[48:51], a[208:211]
    v_cvt_pk_bf16_f32 v200, v200, v201
    v_cvt_pk_bf16_f32 v201, v202, v203
    v_mfma_f32_16x16x32_bf16 a[208:211], a[36:39], v[52:55], a[208:211]
    buffer_load_dwordx4 v13, s[20:23], s64 offen offset:3072 lds
    v_mfma_f32_16x16x32_bf16 a[212:215], a[40:43], v[48:51], a[212:215]
    v_cvt_pk_bf16_f32 v202, v232, v233
    v_cvt_pk_bf16_f32 v203, v234, v235
    v_mfma_f32_16x16x32_bf16 a[212:215], a[44:47], v[52:55], a[212:215]
    v_mul_f32 v204, s74, v204
    v_mul_f32 v205, s74, v205
    v_mfma_f32_16x16x32_bf16 a[216:219], a[48:51], v[48:51], a[216:219]
    v_mul_f32 v206, s74, v206
    v_mul_f32 v207, s74, v207
    v_mfma_f32_16x16x32_bf16 a[216:219], a[52:55], v[52:55], a[216:219]
    v_mul_f32 v236, s74, v236
    v_mul_f32 v237, s74, v237
    v_mfma_f32_16x16x32_bf16 a[220:223], a[56:59], v[48:51], a[220:223]
    ds_read_b64_tr_b16 v[48:49], v15 offset:32768
    ds_read_b64_tr_b16 v[50:51], v15 offset:33792
    v_mfma_f32_16x16x32_bf16 a[220:223], a[60:63], v[52:55], a[220:223]
    ds_read_b64_tr_b16 v[52:53], v15 offset:40960
    ds_read_b64_tr_b16 v[54:55], v15 offset:41984
    v_mfma_f32_16x16x32_bf16 a[224:227], a[0:3], v[56:59], a[224:227]
    v_xor_b32 v15, s73, v15
    v_add_u32 v15, 0x10000, v15
    v_mfma_f32_16x16x32_bf16 a[224:227], a[4:7], v[60:63], a[224:227]
    s_xor_b32 s64, s64, 384
    v_accvgpr_write_b32 a4, v192
    v_accvgpr_write_b32 a5, v193
    v_mfma_f32_16x16x32_bf16 a[228:231], a[8:11], v[56:59], a[228:231]
    v_accvgpr_write_b32 a6, v194
    v_accvgpr_write_b32 a7, v195
    v_mfma_f32_16x16x32_bf16 a[228:231], a[12:15], v[60:63], a[228:231]
    v_accvgpr_write_b32 a12, v196
    v_accvgpr_write_b32 a13, v197
    v_mfma_f32_16x16x32_bf16 a[232:235], a[16:19], v[56:59], a[232:235]
    v_accvgpr_write_b32 a14, v198
    v_accvgpr_write_b32 a15, v199
    v_mfma_f32_16x16x32_bf16 a[232:235], a[20:23], v[60:63], a[232:235]
    s_add_u32 m0, s69, 131072
    v_mul_f32 v238, s74, v238
    v_mul_f32 v239, s74, v239
    v_mfma_f32_16x16x32_bf16 a[236:239], a[24:27], v[56:59], a[236:239]
    buffer_load_dwordx4 v2, s[24:27], s60 offen lds
    v_mfma_f32_16x16x32_bf16 a[236:239], a[28:31], v[60:63], a[236:239]
    v_accvgpr_write_b32 a20, v200
    v_accvgpr_write_b32 a21, v201
    v_mfma_f32_16x16x32_bf16 a[240:243], a[32:35], v[56:59], a[240:243]
    v_accvgpr_write_b32 a22, v202
    v_accvgpr_write_b32 a23, v203
    v_mfma_f32_16x16x32_bf16 a[240:243], a[36:39], v[60:63], a[240:243]
    v_cvt_pk_bf16_f32 v204, v204, v205
    v_cvt_pk_bf16_f32 v205, v206, v207
    v_mfma_f32_16x16x32_bf16 a[244:247], a[40:43], v[56:59], a[244:247]
    s_add_u32 s72, s70, 12288
    v_accvgpr_write_b32 a40, v148
    v_accvgpr_write_b32 a41, v149
    v_mfma_f32_16x16x32_bf16 a[244:247], a[44:47], v[60:63], a[244:247]
    buffer_store_dwordx4 v[140:143], v1, s[36:39], s72 offen sc1
    v_mfma_f32_16x16x32_bf16 a[248:251], a[48:51], v[56:59], a[248:251]
    v_accvgpr_write_b32 a42, v150
    v_accvgpr_write_b32 a43, v151
    v_mfma_f32_16x16x32_bf16 a[248:251], a[52:55], v[60:63], a[248:251]
    buffer_load_dwordx4 v3, s[24:27], s60 offen offset:1024 lds
    v_mfma_f32_16x16x32_bf16 a[252:255], a[56:59], v[56:59], a[252:255]
    ds_read_b64_tr_b16 v[56:57], v16 offset:32768
    ds_read_b64_tr_b16 v[58:59], v16 offset:33792
    v_mfma_f32_16x16x32_bf16 a[252:255], a[60:63], v[60:63], a[252:255]
    s_waitcnt lgkmcnt(2)
    ds_read_b64_tr_b16 v[60:61], v16 offset:40960
    ds_read_b64_tr_b16 v[62:63], v16 offset:41984
    v_mfma_f32_16x16x32_bf16 a[128:131], a[64:67], v[40:43], a[128:131]
    v_xor_b32 v16, s73, v16
    v_add_u32 v16, 0x10000, v16
    v_mfma_f32_16x16x32_bf16 a[128:131], a[68:71], v[44:47], a[128:131]
    v_accvgpr_write_b32 a48, v152
    v_accvgpr_write_b32 a49, v153
    v_mfma_f32_16x16x32_bf16 a[132:135], a[72:75], v[40:43], a[132:135]
    ds_read_b128 v[80:83], v24 offset:49152
    v_accvgpr_write_b32 a50, v154
    v_mfma_f32_16x16x32_bf16 a[132:135], a[76:79], v[44:47], a[132:135]
    v_accvgpr_write_b32 a51, v155
    v_accvgpr_write_b32 a56, v156
    v_mfma_f32_16x16x32_bf16 a[136:139], a[80:83], v[40:43], a[136:139]
    v_accvgpr_write_b32 a57, v157
    v_accvgpr_write_b32 a58, v158
    v_mfma_f32_16x16x32_bf16 a[136:139], a[84:87], v[44:47], a[136:139]
    buffer_load_dwordx4 v4, s[24:27], s60 offen offset:2048 lds
    v_mfma_f32_16x16x32_bf16 a[140:143], a[88:91], v[40:43], a[140:143]
    v_accvgpr_write_b32 a59, v159
    v_cvt_pk_bf16_f32 v206, v236, v237
    v_mfma_f32_16x16x32_bf16 a[140:143], a[92:95], v[44:47], a[140:143]
    v_cvt_pk_bf16_f32 v207, v238, v239
    v_mul_f32 v208, s74, v208
    v_mfma_f32_16x16x32_bf16 a[144:147], a[96:99], v[40:43], a[144:147]
    v_mul_f32 v209, s74, v209
    v_mul_f32 v210, s74, v210
    v_mfma_f32_16x16x32_bf16 a[144:147], a[100:103], v[44:47], a[144:147]
    v_mul_f32 v211, s74, v211
    v_mul_f32 v240, s74, v240
    v_mfma_f32_16x16x32_bf16 a[148:151], a[104:107], v[40:43], a[148:151]
    v_mul_f32 v241, s74, v241
    v_mul_f32 v242, s74, v242
    v_mfma_f32_16x16x32_bf16 a[148:151], a[108:111], v[44:47], a[148:151]
    v_mul_f32 v243, s74, v243
    v_accvgpr_write_b32 a28, v204
    v_mfma_f32_16x16x32_bf16 a[152:155], a[112:115], v[40:43], a[152:155]
    buffer_load_dwordx4 v5, s[24:27], s60 offen offset:3072 lds
    v_mfma_f32_16x16x32_bf16 a[152:155], a[116:119], v[44:47], a[152:155]
    ds_read_b128 v[84:87], v25 offset:49152
    v_accvgpr_write_b32 a29, v205
    v_mfma_f32_16x16x32_bf16 a[156:159], a[120:123], v[40:43], a[156:159]
    ds_read_b64_tr_b16 v[40:41], v17 offset:32768
    ds_read_b64_tr_b16 v[42:43], v17 offset:33792
    v_mfma_f32_16x16x32_bf16 a[156:159], a[124:127], v[44:47], a[156:159]
    ds_read_b64_tr_b16 v[44:45], v17 offset:40960
    ds_read_b64_tr_b16 v[46:47], v17 offset:41984
    v_mfma_f32_16x16x32_bf16 a[160:163], a[64:67], v[48:51], a[160:163]
    v_xor_b32 v17, s73, v17
    v_add_u32 v17, 0x10000, v17
    v_mfma_f32_16x16x32_bf16 a[160:163], a[68:71], v[52:55], a[160:163]
    v_accvgpr_write_b32 a30, v206
    v_accvgpr_write_b32 a31, v207
    v_mfma_f32_16x16x32_bf16 a[164:167], a[72:75], v[48:51], a[164:167]
    v_cvt_pk_bf16_f32 v208, v208, v209
    v_cvt_pk_bf16_f32 v209, v210, v211
    v_mfma_f32_16x16x32_bf16 a[164:167], a[76:79], v[52:55], a[164:167]
    s_add_u32 m0, s69, 147456
    v_cvt_pk_bf16_f32 v210, v240, v241
    v_cvt_pk_bf16_f32 v211, v242, v243
    v_mfma_f32_16x16x32_bf16 a[168:171], a[80:83], v[48:51], a[168:171]
    s_xor_b32 s60, s60, 1572864
    buffer_load_dwordx4 v10, s[20:23], s63 offen lds
    v_mfma_f32_16x16x32_bf16 a[168:171], a[84:87], v[52:55], a[168:171]
    s_add_u32 s72, s70, 32768
    buffer_store_dwordx4 v[144:147], v1, s[36:39], s72 offen sc1
    v_mfma_f32_16x16x32_bf16 a[172:175], a[88:91], v[48:51], a[172:175]
    v_mul_f32 v212, s74, v212
    v_mul_f32 v213, s74, v213
    v_mfma_f32_16x16x32_bf16 a[172:175], a[92:95], v[52:55], a[172:175]
    v_mul_f32 v214, s74, v214
    v_mul_f32 v215, s74, v215
    v_mfma_f32_16x16x32_bf16 a[176:179], a[96:99], v[48:51], a[176:179]
    ds_read_b128 v[88:91], v24 offset:57344
    v_mul_f32 v244, s74, v244
    v_mfma_f32_16x16x32_bf16 a[176:179], a[100:103], v[52:55], a[176:179]
    v_mul_f32 v245, s74, v245
    v_mul_f32 v246, s74, v246
    v_mfma_f32_16x16x32_bf16 a[180:183], a[104:107], v[48:51], a[180:183]
    v_mul_f32 v247, s74, v247
    v_accvgpr_write_b32 a36, v208
    v_mfma_f32_16x16x32_bf16 a[180:183], a[108:111], v[52:55], a[180:183]
    buffer_load_dwordx4 v11, s[20:23], s63 offen offset:1024 lds
    v_mfma_f32_16x16x32_bf16 a[184:187], a[112:115], v[48:51], a[184:187]
    v_accvgpr_write_b32 a37, v209
    v_accvgpr_write_b32 a38, v210
    v_mfma_f32_16x16x32_bf16 a[184:187], a[116:119], v[52:55], a[184:187]
    v_accvgpr_write_b32 a39, v211
    v_cvt_pk_bf16_f32 v212, v212, v213
    v_mfma_f32_16x16x32_bf16 a[188:191], a[120:123], v[48:51], a[188:191]
    v_cvt_pk_bf16_f32 v213, v214, v215
    v_cvt_pk_bf16_f32 v214, v244, v245
    v_mfma_f32_16x16x32_bf16 a[188:191], a[124:127], v[52:55], a[188:191]
    s_waitcnt lgkmcnt(0)
    v_cvt_pk_bf16_f32 v215, v246, v247
    v_mul_f32 v216, s74, v216
    v_mfma_f32_16x16x32_bf16 a[192:195], a[64:67], v[56:59], a[192:195]
    v_mul_f32 v217, s74, v217
    v_mul_f32 v218, s74, v218
    v_mfma_f32_16x16x32_bf16 a[192:195], a[68:71], v[60:63], a[192:195]
    v_accvgpr_read_b32 v32, a128
    v_accvgpr_read_b32 v31, a129
    v_mfma_f32_16x16x32_bf16 a[196:199], a[72:75], v[56:59], a[196:199]
    v_cvt_pk_bf16_f32 v32, v32, v31
    v_accvgpr_read_b32 v33, a130
    v_mfma_f32_16x16x32_bf16 a[196:199], a[76:79], v[60:63], a[196:199]
    buffer_load_dwordx4 v12, s[20:23], s63 offen offset:2048 lds
    v_mfma_f32_16x16x32_bf16 a[200:203], a[80:83], v[56:59], a[200:203]
    ds_read_b128 v[92:95], v25 offset:57344
    v_accvgpr_read_b32 v31, a131
    v_mfma_f32_16x16x32_bf16 a[200:203], a[84:87], v[60:63], a[200:203]
    v_cvt_pk_bf16_f32 v33, v33, v31
    v_accvgpr_read_b32 v34, a132
    v_mfma_f32_16x16x32_bf16 a[204:207], a[88:91], v[56:59], a[204:207]
    v_accvgpr_read_b32 v31, a133
    v_cvt_pk_bf16_f32 v34, v34, v31
    v_mfma_f32_16x16x32_bf16 a[204:207], a[92:95], v[60:63], a[204:207]
    v_accvgpr_read_b32 v35, a134
    v_accvgpr_read_b32 v31, a135
    v_mfma_f32_16x16x32_bf16 a[208:211], a[96:99], v[56:59], a[208:211]
    v_cvt_pk_bf16_f32 v35, v35, v31
    v_mul_f32 v219, s74, v219
    v_mfma_f32_16x16x32_bf16 a[208:211], a[100:103], v[60:63], a[208:211]
    v_mul_f32 v248, s74, v248
    v_mul_f32 v249, s74, v249
    v_mfma_f32_16x16x32_bf16 a[212:215], a[104:107], v[56:59], a[212:215]
    buffer_load_dwordx4 v13, s[20:23], s63 offen offset:3072 lds
    v_mfma_f32_16x16x32_bf16 a[212:215], a[108:111], v[60:63], a[212:215]
    v_mul_f32 v250, s74, v250
    v_mul_f32 v251, s74, v251
    v_mfma_f32_16x16x32_bf16 a[216:219], a[112:115], v[56:59], a[216:219]
    s_add_u32 s72, s71, 0
    v_accvgpr_write_b32 a44, v212
    v_accvgpr_write_b32 a45, v213
    v_mfma_f32_16x16x32_bf16 a[216:219], a[116:119], v[60:63], a[216:219]
    buffer_store_dwordx4 v[32:35], v1, s[36:39], s72 offen sc1
    v_mfma_f32_16x16x32_bf16 a[220:223], a[120:123], v[56:59], a[220:223]
    v_accvgpr_write_b32 a46, v214
    v_accvgpr_write_b32 a47, v215
    v_mfma_f32_16x16x32_bf16 a[220:223], a[124:127], v[60:63], a[220:223]
    v_cvt_pk_bf16_f32 v216, v216, v217
    v_cvt_pk_bf16_f32 v217, v218, v219
    v_mfma_f32_16x16x32_bf16 a[224:227], a[64:67], v[40:43], a[224:227]
    v_cvt_pk_bf16_f32 v218, v248, v249
    v_cvt_pk_bf16_f32 v219, v250, v251
    v_mfma_f32_16x16x32_bf16 a[224:227], a[68:71], v[44:47], a[224:227]
    s_xor_b32 s63, s63, 128
    v_mul_f32 v220, s74, v220
    v_mul_f32 v221, s74, v221
    v_mfma_f32_16x16x32_bf16 a[228:231], a[72:75], v[40:43], a[228:231]
    v_mul_f32 v222, s74, v222
    v_mul_f32 v223, s74, v223
    v_mfma_f32_16x16x32_bf16 a[228:231], a[76:79], v[44:47], a[228:231]
    v_mul_f32 v252, s74, v252
    v_mul_f32 v253, s74, v253
    v_mfma_f32_16x16x32_bf16 a[232:235], a[80:83], v[40:43], a[232:235]
    v_mul_f32 v254, s74, v254
    v_mul_f32 v255, s74, v255
    v_mfma_f32_16x16x32_bf16 a[232:235], a[84:87], v[44:47], a[232:235]
    s_waitcnt vmcnt(11) lgkmcnt(0)
    s_barrier
    ds_read_b64_tr_b16 v[48:49], v14 offset:0
    v_mfma_f32_16x16x32_bf16 a[236:239], a[88:91], v[40:43], a[236:239]
    s_add_u32 m0, s67, 0
    ds_read_b64_tr_b16 v[50:51], v14 offset:1024
    ds_read_b64_tr_b16 v[52:53], v14 offset:8192
    v_mfma_f32_16x16x32_bf16 a[236:239], a[92:95], v[44:47], a[236:239]
    buffer_load_dwordx4 v1, s[28:31], s65 offen sc1 lds
    v_mfma_f32_16x16x32_bf16 a[240:243], a[96:99], v[40:43], a[240:243]
    ds_read_b64_tr_b16 v[54:55], v14 offset:9216
    ds_read_b64_tr_b16 v[56:57], v15 offset:0
    v_mfma_f32_16x16x32_bf16 a[240:243], a[100:103], v[44:47], a[240:243]
    ds_read_b64_tr_b16 v[58:59], v15 offset:1024
    ds_read_b64_tr_b16 v[60:61], v15 offset:8192
    v_mfma_f32_16x16x32_bf16 a[244:247], a[104:107], v[40:43], a[244:247]
    ds_read_b64_tr_b16 v[62:63], v15 offset:9216
    v_add_u32 v14, 0x10000, v14
    v_mfma_f32_16x16x32_bf16 a[244:247], a[108:111], v[44:47], a[244:247]
    v_add_u32 v15, 0x10000, v15
    v_accvgpr_read_b32 v32, a136
    v_mfma_f32_16x16x32_bf16 a[248:251], a[112:115], v[40:43], a[248:251]
    v_accvgpr_read_b32 v31, a137
    v_cvt_pk_bf16_f32 v32, v32, v31
    v_mfma_f32_16x16x32_bf16 a[248:251], a[116:119], v[44:47], a[248:251]
    v_accvgpr_read_b32 v33, a138
    v_accvgpr_read_b32 v31, a139
    v_mfma_f32_16x16x32_bf16 a[252:255], a[120:123], v[40:43], a[252:255]
    buffer_load_dwordx4 v1, s[28:31], s65 offen offset:1024 sc1 lds
    v_mfma_f32_16x16x32_bf16 a[252:255], a[124:127], v[44:47], a[252:255]
    s_waitcnt lgkmcnt(0)
    ds_read_b64_tr_b16 v[40:41], v16 offset:0
    ds_read_b64_tr_b16 v[42:43], v16 offset:1024
    v_mfma_f32_16x16x32_bf16 v[128:131], v[48:51], v[64:67], 0
    ds_read_b64_tr_b16 v[44:45], v16 offset:8192
    ds_read_b64_tr_b16 v[46:47], v16 offset:9216
    v_mfma_f32_16x16x32_bf16 v[128:131], v[52:55], v[68:71], v[128:131]
    v_add_u32 v24, 0x10000, v24
    ds_read_b128 a[136:139], v22 offset:32768
    v_mfma_f32_16x16x32_bf16 v[132:135], v[48:51], v[72:75], 0
    ds_read_b128 v[96:99], v24 offset:16384
    v_add_u32 v16, 0x10000, v16
    v_mfma_f32_16x16x32_bf16 v[132:135], v[52:55], v[76:79], v[132:135]
    v_add_u32 v22, 0xffff0000, v22
    v_cvt_pk_bf16_f32 v33, v33, v31
    v_mfma_f32_16x16x32_bf16 v[136:139], v[48:51], v[80:83], 0
    v_accvgpr_read_b32 v34, a140
    v_accvgpr_read_b32 v31, a141
    v_mfma_f32_16x16x32_bf16 v[136:139], v[52:55], v[84:87], v[136:139]
    s_add_u32 s72, s71, 1024
    v_cvt_pk_bf16_f32 v34, v34, v31
    v_accvgpr_read_b32 v35, a142
    v_mfma_f32_16x16x32_bf16 v[140:143], v[48:51], v[88:91], 0
    s_add_u32 m0, s68, 8192
    ds_read_b64_tr_b16 v[48:49], v17 offset:0
    ds_read_b64_tr_b16 v[50:51], v17 offset:1024
    v_mfma_f32_16x16x32_bf16 v[140:143], v[52:55], v[92:95], v[140:143]
    buffer_load_dwordx4 v6, s[20:23], s66 offen lds
    v_mfma_f32_16x16x32_bf16 v[144:147], v[56:59], v[64:67], 0
    ds_read_b64_tr_b16 v[52:53], v17 offset:8192
    ds_read_b64_tr_b16 v[54:55], v17 offset:9216
    v_mfma_f32_16x16x32_bf16 v[144:147], v[60:63], v[68:71], v[144:147]
    v_add_u32 v17, 0x10000, v17
    v_accvgpr_read_b32 v31, a143
    v_mfma_f32_16x16x32_bf16 v[148:151], v[56:59], v[72:75], 0
    ds_read_b128 a[140:143], v23 offset:32768
    v_add_u32 v23, 0xffff0000, v23
    v_mfma_f32_16x16x32_bf16 v[148:151], v[60:63], v[76:79], v[148:151]
    v_cvt_pk_bf16_f32 v35, v35, v31
    v_accvgpr_write_b32 a52, v216
    v_mfma_f32_16x16x32_bf16 v[152:155], v[56:59], v[80:83], 0
    v_add_u32 v25, 0x10000, v25
    v_accvgpr_write_b32 a53, v217
    v_mfma_f32_16x16x32_bf16 v[152:155], v[60:63], v[84:87], v[152:155]
    ds_read_b128 v[100:103], v25 offset:16384
    v_accvgpr_write_b32 a54, v218
    v_mfma_f32_16x16x32_bf16 v[156:159], v[56:59], v[88:91], 0
    s_add_u32 m0, s69, 16384
    ds_read_b64_tr_b16 v[56:57], v18 offset:0
    ds_read_b64_tr_b16 v[58:59], v18 offset:1024
    v_mfma_f32_16x16x32_bf16 v[156:159], v[60:63], v[92:95], v[156:159]
    s_xor_b32 s65, s65, 24576
    buffer_load_dwordx4 v10, s[20:23], s64 offen lds
    s_waitcnt lgkmcnt(3)
    v_mfma_f32_16x16x32_bf16 v[160:163], v[40:43], v[64:67], 0
    s_xor_b32 s66, s66, 384
    ds_read_b64_tr_b16 v[60:61], v18 offset:8192
    ds_read_b64_tr_b16 v[62:63], v18 offset:9216
    v_mfma_f32_16x16x32_bf16 v[160:163], v[44:47], v[68:71], v[160:163]
    v_add_u32 v18, 0x10000, v18
    v_accvgpr_write_b32 a55, v219
    v_mfma_f32_16x16x32_bf16 v[164:167], v[40:43], v[72:75], 0
    buffer_store_dwordx4 v[32:35], v1, s[36:39], s72 offen sc1
    v_mfma_f32_16x16x32_bf16 v[164:167], v[44:47], v[76:79], v[164:167]
    v_cvt_pk_bf16_f32 v220, v220, v221
    v_cvt_pk_bf16_f32 v221, v222, v223
    v_mfma_f32_16x16x32_bf16 v[168:171], v[40:43], v[80:83], 0
    v_cvt_pk_bf16_f32 v222, v252, v253
    v_cvt_pk_bf16_f32 v223, v254, v255
    v_mfma_f32_16x16x32_bf16 v[168:171], v[44:47], v[84:87], v[168:171]
    v_accvgpr_write_b32 a60, v220
    v_accvgpr_write_b32 a61, v221
    v_mfma_f32_16x16x32_bf16 v[172:175], v[40:43], v[88:91], 0
    ds_read_b64_tr_b16 v[40:41], v19 offset:0
    ds_read_b64_tr_b16 v[42:43], v19 offset:1024
    v_mfma_f32_16x16x32_bf16 v[172:175], v[44:47], v[92:95], v[172:175]
    ds_read_b64_tr_b16 v[44:45], v19 offset:8192
    ds_read_b64_tr_b16 v[46:47], v19 offset:9216
    v_mfma_f32_16x16x32_bf16 v[176:179], v[48:51], v[64:67], 0
    buffer_load_dwordx4 v11, s[20:23], s64 offen offset:1024 lds
    v_mfma_f32_16x16x32_bf16 v[176:179], v[52:55], v[68:71], v[176:179]
    ds_read_b128 v[104:107], v24 offset:24576
    v_add_u32 v19, 0x10000, v19
    v_mfma_f32_16x16x32_bf16 v[180:183], v[48:51], v[72:75], 0
    v_accvgpr_write_b32 a62, v222
    v_accvgpr_write_b32 a63, v223
    v_mfma_f32_16x16x32_bf16 v[180:183], v[52:55], v[76:79], v[180:183]
    v_accvgpr_write_b32 a0, 0
    v_accvgpr_write_b32 a1, 0
    v_mfma_f32_16x16x32_bf16 v[184:187], v[48:51], v[80:83], 0
    v_accvgpr_write_b32 a2, 0
    v_accvgpr_write_b32 a3, 0
    v_mfma_f32_16x16x32_bf16 v[184:187], v[52:55], v[84:87], v[184:187]
    v_accvgpr_write_b32 a8, 0
    v_accvgpr_write_b32 a9, 0
    v_mfma_f32_16x16x32_bf16 v[188:191], v[48:51], v[88:91], 0
    s_add_u32 s72, s70, 36864
    ds_read_b64_tr_b16 v[48:49], v20 offset:0
    ds_read_b64_tr_b16 v[50:51], v20 offset:1024
    v_mfma_f32_16x16x32_bf16 v[188:191], v[52:55], v[92:95], v[188:191]
    s_waitcnt lgkmcnt(2)
    ds_read_b64_tr_b16 v[52:53], v20 offset:8192
    ds_read_b64_tr_b16 v[54:55], v20 offset:9216
    v_mfma_f32_16x16x32_bf16 v[192:195], v[56:59], v[64:67], 0
    buffer_load_dwordx4 v12, s[20:23], s64 offen offset:2048 lds
    v_mfma_f32_16x16x32_bf16 v[192:195], v[60:63], v[68:71], v[192:195]
    v_add_u32 v20, 0x10000, v20
    v_accvgpr_write_b32 a10, 0
    v_mfma_f32_16x16x32_bf16 v[196:199], v[56:59], v[72:75], 0
    buffer_store_dwordx4 a[40:43], v1, s[36:39], s72 offen sc1
    v_mfma_f32_16x16x32_bf16 v[196:199], v[60:63], v[76:79], v[196:199]
    ds_read_b128 v[108:111], v25 offset:24576
    v_accvgpr_write_b32 a11, 0
    v_mfma_f32_16x16x32_bf16 v[200:203], v[56:59], v[80:83], 0
    v_accvgpr_write_b32 a16, 0
    v_accvgpr_write_b32 a17, 0
    v_mfma_f32_16x16x32_bf16 v[200:203], v[60:63], v[84:87], v[200:203]
    v_accvgpr_write_b32 a18, 0
    v_accvgpr_write_b32 a19, 0
    v_mfma_f32_16x16x32_bf16 v[204:207], v[56:59], v[88:91], 0
    ds_read_b64_tr_b16 v[56:57], v21 offset:0
    ds_read_b64_tr_b16 v[58:59], v21 offset:1024
    v_mfma_f32_16x16x32_bf16 v[204:207], v[60:63], v[92:95], v[204:207]
    ds_read_b64_tr_b16 v[60:61], v21 offset:8192
    ds_read_b64_tr_b16 v[62:63], v21 offset:9216
    v_mfma_f32_16x16x32_bf16 v[208:211], v[40:43], v[64:67], 0
    v_add_u32 v21, 0x10000, v21
    v_accvgpr_write_b32 a24, 0
    v_mfma_f32_16x16x32_bf16 v[208:211], v[44:47], v[68:71], v[208:211]
    buffer_load_dwordx4 v13, s[20:23], s64 offen offset:3072 lds
    v_mfma_f32_16x16x32_bf16 v[212:215], v[40:43], v[72:75], 0
    v_accvgpr_write_b32 a25, 0
    v_accvgpr_write_b32 a26, 0
    v_mfma_f32_16x16x32_bf16 v[212:215], v[44:47], v[76:79], v[212:215]
    v_accvgpr_write_b32 a27, 0
    v_accvgpr_write_b32 a32, 0
    v_mfma_f32_16x16x32_bf16 v[216:219], v[40:43], v[80:83], 0
    v_accvgpr_write_b32 a33, 0
    v_accvgpr_write_b32 a34, 0
    v_mfma_f32_16x16x32_bf16 v[216:219], v[44:47], v[84:87], v[216:219]
    v_accvgpr_write_b32 a35, 0
    v_accvgpr_write_b32 a40, 0
    v_mfma_f32_16x16x32_bf16 v[220:223], v[40:43], v[88:91], 0
    ds_read_b64_tr_b16 v[40:41], v26 offset:32768
    ds_read_b64_tr_b16 v[42:43], v26 offset:33280
    v_mfma_f32_16x16x32_bf16 v[220:223], v[44:47], v[92:95], v[220:223]
    s_waitcnt lgkmcnt(2)
    ds_read_b64_tr_b16 v[44:45], v26 offset:36864
    ds_read_b64_tr_b16 v[46:47], v26 offset:37376
    v_mfma_f32_16x16x32_bf16 v[224:227], v[48:51], v[64:67], 0
    v_add_u32 v26, 0xffff0000, v26
    v_accvgpr_write_b32 a41, 0
    v_mfma_f32_16x16x32_bf16 v[224:227], v[52:55], v[68:71], v[224:227]
    s_xor_b32 s64, s64, 128
    v_accvgpr_write_b32 a42, 0
    v_accvgpr_write_b32 a43, 0
    v_mfma_f32_16x16x32_bf16 v[228:231], v[48:51], v[72:75], 0
    v_mfma_f32_16x16x32_bf16 v[228:231], v[52:55], v[76:79], v[228:231]
    v_mfma_f32_16x16x32_bf16 v[232:235], v[48:51], v[80:83], 0
    v_mfma_f32_16x16x32_bf16 v[232:235], v[52:55], v[84:87], v[232:235]
    s_add_u32 m0, s69, 32768
    v_mfma_f32_16x16x32_bf16 v[236:239], v[48:51], v[88:91], 0
    buffer_load_dwordx4 v2, s[24:27], s60 offen lds
    v_mfma_f32_16x16x32_bf16 v[236:239], v[52:55], v[92:95], v[236:239]
    s_add_u32 s72, s70, 40960
    ds_read_b64_tr_b16 v[48:49], v27 offset:32768
    ds_read_b64_tr_b16 v[50:51], v27 offset:33280
    v_mfma_f32_16x16x32_bf16 v[240:243], v[56:59], v[64:67], 0
    ds_read_b64_tr_b16 v[52:53], v27 offset:36864
    ds_read_b64_tr_b16 v[54:55], v27 offset:37376
    v_mfma_f32_16x16x32_bf16 v[240:243], v[60:63], v[68:71], v[240:243]
    buffer_store_dwordx4 a[48:51], v1, s[36:39], s72 offen sc1
    v_mfma_f32_16x16x32_bf16 v[244:247], v[56:59], v[72:75], 0
    buffer_load_dwordx4 v3, s[24:27], s60 offen offset:1024 lds
    v_mfma_f32_16x16x32_bf16 v[244:247], v[60:63], v[76:79], v[244:247]
    v_add_u32 v27, 0xffff0000, v27
    v_accvgpr_write_b32 a48, 0
    v_mfma_f32_16x16x32_bf16 v[248:251], v[56:59], v[80:83], 0
    v_accvgpr_write_b32 a49, 0
    v_accvgpr_write_b32 a50, 0
    v_mfma_f32_16x16x32_bf16 v[248:251], v[60:63], v[84:87], v[248:251]
    v_accvgpr_write_b32 a51, 0
    v_mfma_f32_16x16x32_bf16 v[252:255], v[56:59], v[88:91], 0
    buffer_load_dwordx4 v4, s[24:27], s60 offen offset:2048 lds
    v_mfma_f32_16x16x32_bf16 v[252:255], v[60:63], v[92:95], v[252:255]
    s_waitcnt lgkmcnt(0)
    ds_read_b64_tr_b16 v[56:57], v28 offset:32768
    ds_read_b64_tr_b16 v[58:59], v28 offset:33280
    v_mfma_f32_16x16x32_bf16 a[64:67], v[40:43], v[64:67], 0
    ds_read_b64_tr_b16 v[60:61], v28 offset:36864
    ds_read_b64_tr_b16 v[62:63], v28 offset:37376
    v_mfma_f32_16x16x32_bf16 a[64:67], v[44:47], v[68:71], a[64:67]
    v_add_u32 v28, 0xffff0000, v28
    v_mfma_f32_16x16x32_bf16 a[68:71], v[40:43], v[72:75], 0
    buffer_load_dwordx4 v5, s[24:27], s60 offen offset:3072 lds
    v_mfma_f32_16x16x32_bf16 a[68:71], v[44:47], v[76:79], a[68:71]
    ds_read_b128 v[112:115], v24 offset:49152
    v_mfma_f32_16x16x32_bf16 a[72:75], v[40:43], v[80:83], 0
    v_mfma_f32_16x16x32_bf16 a[72:75], v[44:47], v[84:87], a[72:75]
    s_add_u32 m0, s69, 49152
    v_mfma_f32_16x16x32_bf16 a[76:79], v[40:43], v[88:91], 0
    s_xor_b32 s60, s60, 524288
    buffer_load_dwordx4 v10, s[20:23], s63 offen lds
    v_mfma_f32_16x16x32_bf16 a[76:79], v[44:47], v[92:95], a[76:79]
    ds_read_b128 v[116:119], v25 offset:49152
    v_mfma_f32_16x16x32_bf16 a[128:131], v[40:43], a[136:139], 0
    ds_read_b64_tr_b16 v[40:41], v29 offset:32768
    ds_read_b64_tr_b16 v[42:43], v29 offset:33280
    v_mfma_f32_16x16x32_bf16 a[128:131], v[44:47], a[140:143], a[128:131]
    ds_read_b64_tr_b16 v[44:45], v29 offset:36864
    ds_read_b64_tr_b16 v[46:47], v29 offset:37376
    v_mfma_f32_16x16x32_bf16 a[80:83], v[48:51], v[64:67], 0
    buffer_load_dwordx4 v11, s[20:23], s63 offen offset:1024 lds
    v_mfma_f32_16x16x32_bf16 a[80:83], v[52:55], v[68:71], a[80:83]
    ds_read_b128 v[120:123], v24 offset:57344
    v_add_u32 v29, 0xffff0000, v29
    v_mfma_f32_16x16x32_bf16 a[84:87], v[48:51], v[72:75], 0
    v_mfma_f32_16x16x32_bf16 a[84:87], v[52:55], v[76:79], a[84:87]
    v_mfma_f32_16x16x32_bf16 a[88:91], v[48:51], v[80:83], 0
    buffer_load_dwordx4 v12, s[20:23], s63 offen offset:2048 lds
    v_mfma_f32_16x16x32_bf16 a[88:91], v[52:55], v[84:87], a[88:91]
    ds_read_b128 v[124:127], v25 offset:57344
    v_mfma_f32_16x16x32_bf16 a[92:95], v[48:51], v[88:91], 0
    s_add_u32 s72, s70, 45056
    v_mfma_f32_16x16x32_bf16 a[92:95], v[52:55], v[92:95], a[92:95]
    v_mfma_f32_16x16x32_bf16 a[132:135], v[48:51], a[136:139], 0
    buffer_load_dwordx4 v13, s[20:23], s63 offen offset:3072 lds
    v_mfma_f32_16x16x32_bf16 a[132:135], v[52:55], a[140:143], a[132:135]
    s_waitcnt lgkmcnt(1)
    v_mfma_f32_16x16x32_bf16 a[96:99], v[56:59], v[64:67], 0
    v_mfma_f32_16x16x32_bf16 a[96:99], v[60:63], v[68:71], a[96:99]
    s_xor_b32 s63, s63, 896
    v_mfma_f32_16x16x32_bf16 a[100:103], v[56:59], v[72:75], 0
    buffer_store_dwordx4 a[56:59], v1, s[36:39], s72 offen sc1
    v_mfma_f32_16x16x32_bf16 a[100:103], v[60:63], v[76:79], a[100:103]
    v_mfma_f32_16x16x32_bf16 a[104:107], v[56:59], v[80:83], 0
    v_accvgpr_write_b32 a56, 0
    v_accvgpr_write_b32 a57, 0
    v_mfma_f32_16x16x32_bf16 a[104:107], v[60:63], v[84:87], a[104:107]
    s_waitcnt vmcnt(10) lgkmcnt(0)
    s_barrier
    ds_read_b64_tr_b16 v[48:49], v14 offset:0
    v_mfma_f32_16x16x32_bf16 a[108:111], v[56:59], v[88:91], 0
    s_add_u32 m0, s67, 65536
    ds_read_b64_tr_b16 v[50:51], v14 offset:1024
    ds_read_b64_tr_b16 v[52:53], v14 offset:8192
    v_mfma_f32_16x16x32_bf16 a[108:111], v[60:63], v[92:95], a[108:111]
    buffer_load_dwordx4 v1, s[28:31], s65 offen sc1 lds
    v_mfma_f32_16x16x32_bf16 a[112:115], v[40:43], v[64:67], 0
    ds_read_b64_tr_b16 v[54:55], v14 offset:9216
    ds_read_b64_tr_b16 v[56:57], v15 offset:0
    v_mfma_f32_16x16x32_bf16 a[112:115], v[44:47], v[68:71], a[112:115]
    ds_read_b64_tr_b16 v[58:59], v15 offset:1024
    ds_read_b64_tr_b16 v[60:61], v15 offset:8192
    v_mfma_f32_16x16x32_bf16 a[116:119], v[40:43], v[72:75], 0
    ds_read_b64_tr_b16 v[62:63], v15 offset:9216
    ds_read_b128 a[136:139], v22 offset:0
    v_mfma_f32_16x16x32_bf16 a[116:119], v[44:47], v[76:79], a[116:119]
    ds_read_b128 a[140:143], v23 offset:0
    v_add_u32 v14, 0xfffe0000, v14
    v_mfma_f32_16x16x32_bf16 a[120:123], v[40:43], v[80:83], 0
    v_add_u32 v15, 0xfffe0000, v15
    v_add_u32 v22, 0x10000, v22
    v_mfma_f32_16x16x32_bf16 a[120:123], v[44:47], v[84:87], a[120:123]
    v_add_u32 v23, 0x10000, v23
    v_accvgpr_write_b32 a58, 0
    v_mfma_f32_16x16x32_bf16 a[124:127], v[40:43], v[88:91], 0
    buffer_load_dwordx4 v1, s[28:31], s65 offen offset:1024 sc1 lds
    v_mfma_f32_16x16x32_bf16 a[124:127], v[44:47], v[92:95], a[124:127]
    s_waitcnt lgkmcnt(1)
    ds_read_b64_tr_b16 v[40:41], v16 offset:0
    ds_read_b64_tr_b16 v[42:43], v16 offset:1024
    v_mfma_f32_16x16x32_bf16 v[128:131], v[48:51], v[96:99], v[128:131]
    ds_read_b64_tr_b16 v[44:45], v16 offset:8192
    ds_read_b64_tr_b16 v[46:47], v16 offset:9216
    v_mfma_f32_16x16x32_bf16 v[128:131], v[52:55], v[100:103], v[128:131]
    v_add_u32 v24, 0x10000, v24
    v_add_u32 v16, 0xfffe0000, v16
    v_mfma_f32_16x16x32_bf16 v[132:135], v[48:51], v[104:107], v[132:135]
    ds_read_b128 v[64:67], v24 offset:16384
    v_accvgpr_write_b32 a59, 0
    v_mfma_f32_16x16x32_bf16 v[132:135], v[52:55], v[108:111], v[132:135]
    v_mfma_f32_16x16x32_bf16 v[136:139], v[48:51], v[112:115], v[136:139]
    v_mfma_f32_16x16x32_bf16 v[136:139], v[52:55], v[116:119], v[136:139]
    s_add_u32 s72, s70, 1024
    v_mfma_f32_16x16x32_bf16 v[140:143], v[48:51], v[120:123], v[140:143]
    s_add_u32 m0, s68, 73728
    ds_read_b64_tr_b16 v[48:49], v17 offset:0
    ds_read_b64_tr_b16 v[50:51], v17 offset:1024
    v_mfma_f32_16x16x32_bf16 v[140:143], v[52:55], v[124:127], v[140:143]
    buffer_load_dwordx4 v6, s[20:23], s66 offen lds
    v_mfma_f32_16x16x32_bf16 v[144:147], v[56:59], v[96:99], v[144:147]
    ds_read_b64_tr_b16 v[52:53], v17 offset:8192
    ds_read_b64_tr_b16 v[54:55], v17 offset:9216
    v_mfma_f32_16x16x32_bf16 v[144:147], v[60:63], v[100:103], v[144:147]
    buffer_store_dwordx4 a[4:7], v1, s[36:39], s72 offen sc1
    v_mfma_f32_16x16x32_bf16 v[148:151], v[56:59], v[104:107], v[148:151]
    v_add_u32 v17, 0xfffe0000, v17
    v_accvgpr_write_b32 a4, 0
    v_mfma_f32_16x16x32_bf16 v[148:151], v[60:63], v[108:111], v[148:151]
    v_accvgpr_write_b32 a5, 0
    v_accvgpr_write_b32 a6, 0
    v_mfma_f32_16x16x32_bf16 v[152:155], v[56:59], v[112:115], v[152:155]
    v_add_u32 v25, 0x10000, v25
    v_accvgpr_write_b32 a7, 0
    v_mfma_f32_16x16x32_bf16 v[152:155], v[60:63], v[116:119], v[152:155]
    ds_read_b128 v[68:71], v25 offset:16384
    v_mfma_f32_16x16x32_bf16 v[156:159], v[56:59], v[120:123], v[156:159]
    s_add_u32 m0, s69, 81920
    ds_read_b64_tr_b16 v[56:57], v18 offset:0
    ds_read_b64_tr_b16 v[58:59], v18 offset:1024
    v_mfma_f32_16x16x32_bf16 v[156:159], v[60:63], v[124:127], v[156:159]
    s_xor_b32 s65, s65, 8192
    buffer_load_dwordx4 v10, s[20:23], s64 offen lds
    s_waitcnt lgkmcnt(3)
    v_mfma_f32_16x16x32_bf16 v[160:163], v[40:43], v[96:99], v[160:163]
    s_xor_b32 s66, s66, 128
    ds_read_b64_tr_b16 v[60:61], v18 offset:8192
    ds_read_b64_tr_b16 v[62:63], v18 offset:9216
    v_mfma_f32_16x16x32_bf16 v[160:163], v[44:47], v[100:103], v[160:163]
    v_add_u32 v18, 0xfffe0000, v18
    v_mfma_f32_16x16x32_bf16 v[164:167], v[40:43], v[104:107], v[164:167]
    v_mfma_f32_16x16x32_bf16 v[164:167], v[44:47], v[108:111], v[164:167]
    v_mfma_f32_16x16x32_bf16 v[168:171], v[40:43], v[112:115], v[168:171]
    v_mfma_f32_16x16x32_bf16 v[168:171], v[44:47], v[116:119], v[168:171]
    v_mfma_f32_16x16x32_bf16 v[172:175], v[40:43], v[120:123], v[172:175]
    ds_read_b64_tr_b16 v[40:41], v19 offset:0
    ds_read_b64_tr_b16 v[42:43], v19 offset:1024
    v_mfma_f32_16x16x32_bf16 v[172:175], v[44:47], v[124:127], v[172:175]
    ds_read_b64_tr_b16 v[44:45], v19 offset:8192
    ds_read_b64_tr_b16 v[46:47], v19 offset:9216
    v_mfma_f32_16x16x32_bf16 v[176:179], v[48:51], v[96:99], v[176:179]
    buffer_load_dwordx4 v11, s[20:23], s64 offen offset:1024 lds
    v_mfma_f32_16x16x32_bf16 v[176:179], v[52:55], v[100:103], v[176:179]
    ds_read_b128 v[72:75], v24 offset:24576
    v_add_u32 v19, 0xfffe0000, v19
    v_mfma_f32_16x16x32_bf16 v[180:183], v[48:51], v[104:107], v[180:183]
    v_mfma_f32_16x16x32_bf16 v[180:183], v[52:55], v[108:111], v[180:183]
    v_mfma_f32_16x16x32_bf16 v[184:187], v[48:51], v[112:115], v[184:187]
    v_mfma_f32_16x16x32_bf16 v[184:187], v[52:55], v[116:119], v[184:187]
    v_mfma_f32_16x16x32_bf16 v[188:191], v[48:51], v[120:123], v[188:191]
    s_add_u32 s72, s70, 5120
    ds_read_b64_tr_b16 v[48:49], v20 offset:0
    ds_read_b64_tr_b16 v[50:51], v20 offset:1024
    v_mfma_f32_16x16x32_bf16 v[188:191], v[52:55], v[124:127], v[188:191]
    s_waitcnt lgkmcnt(2)
    ds_read_b64_tr_b16 v[52:53], v20 offset:8192
    ds_read_b64_tr_b16 v[54:55], v20 offset:9216
    v_mfma_f32_16x16x32_bf16 v[192:195], v[56:59], v[96:99], v[192:195]
    buffer_load_dwordx4 v12, s[20:23], s64 offen offset:2048 lds
    v_mfma_f32_16x16x32_bf16 v[192:195], v[60:63], v[100:103], v[192:195]
    buffer_store_dwordx4 a[12:15], v1, s[36:39], s72 offen sc1
    v_mfma_f32_16x16x32_bf16 v[196:199], v[56:59], v[104:107], v[196:199]
    v_add_u32 v20, 0xfffe0000, v20
    v_accvgpr_write_b32 a12, 0
    v_mfma_f32_16x16x32_bf16 v[196:199], v[60:63], v[108:111], v[196:199]
    ds_read_b128 v[76:79], v25 offset:24576
    v_accvgpr_write_b32 a13, 0
    v_mfma_f32_16x16x32_bf16 v[200:203], v[56:59], v[112:115], v[200:203]
    v_accvgpr_write_b32 a14, 0
    v_accvgpr_write_b32 a15, 0
    v_mfma_f32_16x16x32_bf16 v[200:203], v[60:63], v[116:119], v[200:203]
    v_mfma_f32_16x16x32_bf16 v[204:207], v[56:59], v[120:123], v[204:207]
    ds_read_b64_tr_b16 v[56:57], v21 offset:0
    ds_read_b64_tr_b16 v[58:59], v21 offset:1024
    v_mfma_f32_16x16x32_bf16 v[204:207], v[60:63], v[124:127], v[204:207]
    ds_read_b64_tr_b16 v[60:61], v21 offset:8192
    ds_read_b64_tr_b16 v[62:63], v21 offset:9216
    v_mfma_f32_16x16x32_bf16 v[208:211], v[40:43], v[96:99], v[208:211]
    v_add_u32 v21, 0xfffe0000, v21
    v_mfma_f32_16x16x32_bf16 v[208:211], v[44:47], v[100:103], v[208:211]
    buffer_load_dwordx4 v13, s[20:23], s64 offen offset:3072 lds
    v_mfma_f32_16x16x32_bf16 v[212:215], v[40:43], v[104:107], v[212:215]
    v_mfma_f32_16x16x32_bf16 v[212:215], v[44:47], v[108:111], v[212:215]
    v_mfma_f32_16x16x32_bf16 v[216:219], v[40:43], v[112:115], v[216:219]
    v_mfma_f32_16x16x32_bf16 v[216:219], v[44:47], v[116:119], v[216:219]
    v_mfma_f32_16x16x32_bf16 v[220:223], v[40:43], v[120:123], v[220:223]
    ds_read_b64_tr_b16 v[40:41], v26 offset:0
    ds_read_b64_tr_b16 v[42:43], v26 offset:512
    v_mfma_f32_16x16x32_bf16 v[220:223], v[44:47], v[124:127], v[220:223]
    s_waitcnt lgkmcnt(2)
    ds_read_b64_tr_b16 v[44:45], v26 offset:4096
    ds_read_b64_tr_b16 v[46:47], v26 offset:4608
    v_mfma_f32_16x16x32_bf16 v[224:227], v[48:51], v[96:99], v[224:227]
    v_add_u32 v26, 0x10000, v26
    v_mfma_f32_16x16x32_bf16 v[224:227], v[52:55], v[100:103], v[224:227]
    s_xor_b32 s64, s64, 896
    v_mfma_f32_16x16x32_bf16 v[228:231], v[48:51], v[104:107], v[228:231]
    v_mfma_f32_16x16x32_bf16 v[228:231], v[52:55], v[108:111], v[228:231]
    v_mfma_f32_16x16x32_bf16 v[232:235], v[48:51], v[112:115], v[232:235]
    v_mfma_f32_16x16x32_bf16 v[232:235], v[52:55], v[116:119], v[232:235]
    s_add_u32 m0, s69, 98304
    v_mfma_f32_16x16x32_bf16 v[236:239], v[48:51], v[120:123], v[236:239]
    buffer_load_dwordx4 v2, s[24:27], s60 offen lds
    v_mfma_f32_16x16x32_bf16 v[236:239], v[52:55], v[124:127], v[236:239]
    s_add_u32 s72, s70, 9216
    ds_read_b64_tr_b16 v[48:49], v27 offset:0
    ds_read_b64_tr_b16 v[50:51], v27 offset:512
    v_mfma_f32_16x16x32_bf16 v[240:243], v[56:59], v[96:99], v[240:243]
    ds_read_b64_tr_b16 v[52:53], v27 offset:4096
    ds_read_b64_tr_b16 v[54:55], v27 offset:4608
    v_mfma_f32_16x16x32_bf16 v[240:243], v[60:63], v[100:103], v[240:243]
    buffer_store_dwordx4 a[20:23], v1, s[36:39], s72 offen sc1
    v_mfma_f32_16x16x32_bf16 v[244:247], v[56:59], v[104:107], v[244:247]
    buffer_load_dwordx4 v3, s[24:27], s60 offen offset:1024 lds
    v_mfma_f32_16x16x32_bf16 v[244:247], v[60:63], v[108:111], v[244:247]
    v_add_u32 v27, 0x10000, v27
    v_accvgpr_write_b32 a20, 0
    v_mfma_f32_16x16x32_bf16 v[248:251], v[56:59], v[112:115], v[248:251]
    v_accvgpr_write_b32 a21, 0
    v_accvgpr_write_b32 a22, 0
    v_mfma_f32_16x16x32_bf16 v[248:251], v[60:63], v[116:119], v[248:251]
    v_accvgpr_write_b32 a23, 0
    v_mfma_f32_16x16x32_bf16 v[252:255], v[56:59], v[120:123], v[252:255]
    buffer_load_dwordx4 v4, s[24:27], s60 offen offset:2048 lds
    v_mfma_f32_16x16x32_bf16 v[252:255], v[60:63], v[124:127], v[252:255]
    s_waitcnt lgkmcnt(0)
    ds_read_b64_tr_b16 v[56:57], v28 offset:0
    ds_read_b64_tr_b16 v[58:59], v28 offset:512
    v_mfma_f32_16x16x32_bf16 a[64:67], v[40:43], v[96:99], a[64:67]
    ds_read_b64_tr_b16 v[60:61], v28 offset:4096
    ds_read_b64_tr_b16 v[62:63], v28 offset:4608
    v_mfma_f32_16x16x32_bf16 a[64:67], v[44:47], v[100:103], a[64:67]
    v_add_u32 v24, 0xfffe0000, v24
    v_add_u32 v28, 0x10000, v28
    v_mfma_f32_16x16x32_bf16 a[68:71], v[40:43], v[104:107], a[68:71]
    buffer_load_dwordx4 v5, s[24:27], s60 offen offset:3072 lds
    v_mfma_f32_16x16x32_bf16 a[68:71], v[44:47], v[108:111], a[68:71]
    ds_read_b128 v[80:83], v24 offset:16384
    v_mfma_f32_16x16x32_bf16 a[72:75], v[40:43], v[112:115], a[72:75]
    v_mfma_f32_16x16x32_bf16 a[72:75], v[44:47], v[116:119], a[72:75]
    s_add_u32 m0, s69, 114688
    v_add_u32 v25, 0xfffe0000, v25
    v_mfma_f32_16x16x32_bf16 a[76:79], v[40:43], v[120:123], a[76:79]
    s_xor_b32 s60, s60, 3670016
    buffer_load_dwordx4 v10, s[20:23], s63 offen lds
    v_mfma_f32_16x16x32_bf16 a[76:79], v[44:47], v[124:127], a[76:79]
    ds_read_b128 v[84:87], v25 offset:16384
    v_mfma_f32_16x16x32_bf16 a[128:131], v[40:43], a[136:139], a[128:131]
    ds_read_b64_tr_b16 v[40:41], v29 offset:0
    ds_read_b64_tr_b16 v[42:43], v29 offset:512
    v_mfma_f32_16x16x32_bf16 a[128:131], v[44:47], a[140:143], a[128:131]
    ds_read_b64_tr_b16 v[44:45], v29 offset:4096
    ds_read_b64_tr_b16 v[46:47], v29 offset:4608
    v_mfma_f32_16x16x32_bf16 a[80:83], v[48:51], v[96:99], a[80:83]
    buffer_load_dwordx4 v11, s[20:23], s63 offen offset:1024 lds
    v_mfma_f32_16x16x32_bf16 a[80:83], v[52:55], v[100:103], a[80:83]
    ds_read_b128 v[88:91], v24 offset:24576
    v_add_u32 v29, 0x10000, v29
    v_mfma_f32_16x16x32_bf16 a[84:87], v[48:51], v[104:107], a[84:87]
    v_mfma_f32_16x16x32_bf16 a[84:87], v[52:55], v[108:111], a[84:87]
    v_mfma_f32_16x16x32_bf16 a[88:91], v[48:51], v[112:115], a[88:91]
    buffer_load_dwordx4 v12, s[20:23], s63 offen offset:2048 lds
    v_mfma_f32_16x16x32_bf16 a[88:91], v[52:55], v[116:119], a[88:91]
    ds_read_b128 v[92:95], v25 offset:24576
    v_mfma_f32_16x16x32_bf16 a[92:95], v[48:51], v[120:123], a[92:95]
    s_add_u32 s72, s70, 13312
    v_mfma_f32_16x16x32_bf16 a[92:95], v[52:55], v[124:127], a[92:95]
    v_mfma_f32_16x16x32_bf16 a[132:135], v[48:51], a[136:139], a[132:135]
    buffer_load_dwordx4 v13, s[20:23], s63 offen offset:3072 lds
    v_mfma_f32_16x16x32_bf16 a[132:135], v[52:55], a[140:143], a[132:135]
    s_waitcnt lgkmcnt(1)
    v_mfma_f32_16x16x32_bf16 a[96:99], v[56:59], v[96:99], a[96:99]
    v_mfma_f32_16x16x32_bf16 a[96:99], v[60:63], v[100:103], a[96:99]
    s_xor_b32 s63, s63, 128
    v_mfma_f32_16x16x32_bf16 a[100:103], v[56:59], v[104:107], a[100:103]
    buffer_store_dwordx4 a[28:31], v1, s[36:39], s72 offen sc1
    v_mfma_f32_16x16x32_bf16 a[100:103], v[60:63], v[108:111], a[100:103]
    v_mfma_f32_16x16x32_bf16 a[104:107], v[56:59], v[112:115], a[104:107]
    v_accvgpr_write_b32 a28, 0
    v_accvgpr_write_b32 a29, 0
    v_mfma_f32_16x16x32_bf16 a[104:107], v[60:63], v[116:119], a[104:107]
    s_waitcnt vmcnt(10) lgkmcnt(0)
    s_barrier
    ds_read_b64_tr_b16 v[48:49], v14 offset:32768
    v_mfma_f32_16x16x32_bf16 a[108:111], v[56:59], v[120:123], a[108:111]
    s_add_u32 m0, s67, 131072
    ds_read_b64_tr_b16 v[50:51], v14 offset:33792
    ds_read_b64_tr_b16 v[52:53], v14 offset:40960
    v_mfma_f32_16x16x32_bf16 a[108:111], v[60:63], v[124:127], a[108:111]
    buffer_load_dwordx4 v1, s[28:31], s65 offen sc1 lds
    v_mfma_f32_16x16x32_bf16 a[112:115], v[40:43], v[96:99], a[112:115]
    ds_read_b64_tr_b16 v[54:55], v14 offset:41984
    ds_read_b64_tr_b16 v[56:57], v15 offset:32768
    v_mfma_f32_16x16x32_bf16 a[112:115], v[44:47], v[100:103], a[112:115]
    ds_read_b64_tr_b16 v[58:59], v15 offset:33792
    ds_read_b64_tr_b16 v[60:61], v15 offset:40960
    v_mfma_f32_16x16x32_bf16 a[116:119], v[40:43], v[104:107], a[116:119]
    ds_read_b64_tr_b16 v[62:63], v15 offset:41984
    ds_read_b128 a[136:139], v22 offset:0
    v_mfma_f32_16x16x32_bf16 a[116:119], v[44:47], v[108:111], a[116:119]
    ds_read_b128 a[140:143], v23 offset:0
    v_add_u32 v14, 0x10000, v14
    v_mfma_f32_16x16x32_bf16 a[120:123], v[40:43], v[112:115], a[120:123]
    v_add_u32 v15, 0x10000, v15
    v_add_u32 v22, 0x10000, v22
    v_mfma_f32_16x16x32_bf16 a[120:123], v[44:47], v[116:119], a[120:123]
    v_add_u32 v23, 0x10000, v23
    v_accvgpr_write_b32 a30, 0
    v_mfma_f32_16x16x32_bf16 a[124:127], v[40:43], v[120:123], a[124:127]
    buffer_load_dwordx4 v1, s[28:31], s65 offen offset:1024 sc1 lds
    v_mfma_f32_16x16x32_bf16 a[124:127], v[44:47], v[124:127], a[124:127]
    s_waitcnt lgkmcnt(1)
    ds_read_b64_tr_b16 v[40:41], v16 offset:32768
    ds_read_b64_tr_b16 v[42:43], v16 offset:33792
    v_mfma_f32_16x16x32_bf16 v[128:131], v[48:51], v[64:67], v[128:131]
    ds_read_b64_tr_b16 v[44:45], v16 offset:40960
    ds_read_b64_tr_b16 v[46:47], v16 offset:41984
    v_mfma_f32_16x16x32_bf16 v[128:131], v[52:55], v[68:71], v[128:131]
    v_add_u32 v16, 0x10000, v16
    v_accvgpr_write_b32 a31, 0
    v_mfma_f32_16x16x32_bf16 v[132:135], v[48:51], v[72:75], v[132:135]
    ds_read_b128 v[96:99], v24 offset:49152
    v_mfma_f32_16x16x32_bf16 v[132:135], v[52:55], v[76:79], v[132:135]
    v_mfma_f32_16x16x32_bf16 v[136:139], v[48:51], v[80:83], v[136:139]
    v_mfma_f32_16x16x32_bf16 v[136:139], v[52:55], v[84:87], v[136:139]
    s_add_u32 s72, s70, 33792
    v_mfma_f32_16x16x32_bf16 v[140:143], v[48:51], v[88:91], v[140:143]
    s_add_u32 m0, s68, 139264
    ds_read_b64_tr_b16 v[48:49], v17 offset:32768
    ds_read_b64_tr_b16 v[50:51], v17 offset:33792
    v_mfma_f32_16x16x32_bf16 v[140:143], v[52:55], v[92:95], v[140:143]
    buffer_load_dwordx4 v6, s[20:23], s66 offen lds
    v_mfma_f32_16x16x32_bf16 v[144:147], v[56:59], v[64:67], v[144:147]
    ds_read_b64_tr_b16 v[52:53], v17 offset:40960
    ds_read_b64_tr_b16 v[54:55], v17 offset:41984
    v_mfma_f32_16x16x32_bf16 v[144:147], v[60:63], v[68:71], v[144:147]
    buffer_store_dwordx4 a[36:39], v1, s[36:39], s72 offen sc1
    v_mfma_f32_16x16x32_bf16 v[148:151], v[56:59], v[72:75], v[148:151]
    v_add_u32 v17, 0x10000, v17
    v_accvgpr_write_b32 a36, 0
    v_mfma_f32_16x16x32_bf16 v[148:151], v[60:63], v[76:79], v[148:151]
    v_accvgpr_write_b32 a37, 0
    v_accvgpr_write_b32 a38, 0
    v_mfma_f32_16x16x32_bf16 v[152:155], v[56:59], v[80:83], v[152:155]
    v_accvgpr_write_b32 a39, 0
    v_mfma_f32_16x16x32_bf16 v[152:155], v[60:63], v[84:87], v[152:155]
    ds_read_b128 v[100:103], v25 offset:49152
    v_mfma_f32_16x16x32_bf16 v[156:159], v[56:59], v[88:91], v[156:159]
    s_add_u32 m0, s69, 147456
    ds_read_b64_tr_b16 v[56:57], v18 offset:32768
    ds_read_b64_tr_b16 v[58:59], v18 offset:33792
    v_mfma_f32_16x16x32_bf16 v[156:159], v[60:63], v[92:95], v[156:159]
    s_xor_b32 s65, s65, 57344
    buffer_load_dwordx4 v10, s[20:23], s64 offen lds
    s_waitcnt lgkmcnt(3)
    v_mfma_f32_16x16x32_bf16 v[160:163], v[40:43], v[64:67], v[160:163]
    s_xor_b32 s66, s66, 896
    ds_read_b64_tr_b16 v[60:61], v18 offset:40960
    ds_read_b64_tr_b16 v[62:63], v18 offset:41984
    v_mfma_f32_16x16x32_bf16 v[160:163], v[44:47], v[68:71], v[160:163]
    v_add_u32 v18, 0x10000, v18
    v_mfma_f32_16x16x32_bf16 v[164:167], v[40:43], v[72:75], v[164:167]
    v_mfma_f32_16x16x32_bf16 v[164:167], v[44:47], v[76:79], v[164:167]
    v_mfma_f32_16x16x32_bf16 v[168:171], v[40:43], v[80:83], v[168:171]
    v_mfma_f32_16x16x32_bf16 v[168:171], v[44:47], v[84:87], v[168:171]
    v_mfma_f32_16x16x32_bf16 v[172:175], v[40:43], v[88:91], v[172:175]
    ds_read_b64_tr_b16 v[40:41], v19 offset:32768
    ds_read_b64_tr_b16 v[42:43], v19 offset:33792
    v_mfma_f32_16x16x32_bf16 v[172:175], v[44:47], v[92:95], v[172:175]
    ds_read_b64_tr_b16 v[44:45], v19 offset:40960
    ds_read_b64_tr_b16 v[46:47], v19 offset:41984
    v_mfma_f32_16x16x32_bf16 v[176:179], v[48:51], v[64:67], v[176:179]
    buffer_load_dwordx4 v11, s[20:23], s64 offen offset:1024 lds
    v_mfma_f32_16x16x32_bf16 v[176:179], v[52:55], v[68:71], v[176:179]
    ds_read_b128 v[104:107], v24 offset:57344
    v_add_u32 v19, 0x10000, v19
    v_mfma_f32_16x16x32_bf16 v[180:183], v[48:51], v[72:75], v[180:183]
    v_mfma_f32_16x16x32_bf16 v[180:183], v[52:55], v[76:79], v[180:183]
    v_mfma_f32_16x16x32_bf16 v[184:187], v[48:51], v[80:83], v[184:187]
    v_mfma_f32_16x16x32_bf16 v[184:187], v[52:55], v[84:87], v[184:187]
    v_mfma_f32_16x16x32_bf16 v[188:191], v[48:51], v[88:91], v[188:191]
    s_add_u32 s72, s70, 37888
    ds_read_b64_tr_b16 v[48:49], v20 offset:32768
    ds_read_b64_tr_b16 v[50:51], v20 offset:33792
    v_mfma_f32_16x16x32_bf16 v[188:191], v[52:55], v[92:95], v[188:191]
    s_waitcnt lgkmcnt(2)
    ds_read_b64_tr_b16 v[52:53], v20 offset:40960
    ds_read_b64_tr_b16 v[54:55], v20 offset:41984
    v_mfma_f32_16x16x32_bf16 v[192:195], v[56:59], v[64:67], v[192:195]
    buffer_load_dwordx4 v12, s[20:23], s64 offen offset:2048 lds
    v_mfma_f32_16x16x32_bf16 v[192:195], v[60:63], v[68:71], v[192:195]
    buffer_store_dwordx4 a[44:47], v1, s[36:39], s72 offen sc1
    v_mfma_f32_16x16x32_bf16 v[196:199], v[56:59], v[72:75], v[196:199]
    v_add_u32 v20, 0x10000, v20
    v_accvgpr_write_b32 a44, 0
    v_mfma_f32_16x16x32_bf16 v[196:199], v[60:63], v[76:79], v[196:199]
    ds_read_b128 v[108:111], v25 offset:57344
    v_accvgpr_write_b32 a45, 0
    v_mfma_f32_16x16x32_bf16 v[200:203], v[56:59], v[80:83], v[200:203]
    v_accvgpr_write_b32 a46, 0
    v_accvgpr_write_b32 a47, 0
    v_mfma_f32_16x16x32_bf16 v[200:203], v[60:63], v[84:87], v[200:203]
    v_mfma_f32_16x16x32_bf16 v[204:207], v[56:59], v[88:91], v[204:207]
    ds_read_b64_tr_b16 v[56:57], v21 offset:32768
    ds_read_b64_tr_b16 v[58:59], v21 offset:33792
    v_mfma_f32_16x16x32_bf16 v[204:207], v[60:63], v[92:95], v[204:207]
    ds_read_b64_tr_b16 v[60:61], v21 offset:40960
    ds_read_b64_tr_b16 v[62:63], v21 offset:41984
    v_mfma_f32_16x16x32_bf16 v[208:211], v[40:43], v[64:67], v[208:211]
    v_add_u32 v21, 0x10000, v21
    v_mfma_f32_16x16x32_bf16 v[208:211], v[44:47], v[68:71], v[208:211]
    buffer_load_dwordx4 v13, s[20:23], s64 offen offset:3072 lds
    v_mfma_f32_16x16x32_bf16 v[212:215], v[40:43], v[72:75], v[212:215]
    v_mfma_f32_16x16x32_bf16 v[212:215], v[44:47], v[76:79], v[212:215]
    v_mfma_f32_16x16x32_bf16 v[216:219], v[40:43], v[80:83], v[216:219]
    v_mfma_f32_16x16x32_bf16 v[216:219], v[44:47], v[84:87], v[216:219]
    v_mfma_f32_16x16x32_bf16 v[220:223], v[40:43], v[88:91], v[220:223]
    ds_read_b64_tr_b16 v[40:41], v26 offset:0
    ds_read_b64_tr_b16 v[42:43], v26 offset:512
    v_mfma_f32_16x16x32_bf16 v[220:223], v[44:47], v[92:95], v[220:223]
    s_waitcnt lgkmcnt(2)
    ds_read_b64_tr_b16 v[44:45], v26 offset:4096
    ds_read_b64_tr_b16 v[46:47], v26 offset:4608
    v_mfma_f32_16x16x32_bf16 v[224:227], v[48:51], v[64:67], v[224:227]
    v_add_u32 v26, 0x10000, v26
    v_mfma_f32_16x16x32_bf16 v[224:227], v[52:55], v[68:71], v[224:227]
    s_xor_b32 s64, s64, 128
    v_mfma_f32_16x16x32_bf16 v[228:231], v[48:51], v[72:75], v[228:231]
    v_mfma_f32_16x16x32_bf16 v[228:231], v[52:55], v[76:79], v[228:231]
    v_mfma_f32_16x16x32_bf16 v[232:235], v[48:51], v[80:83], v[232:235]
    v_mfma_f32_16x16x32_bf16 v[232:235], v[52:55], v[84:87], v[232:235]
    s_add_u32 m0, s69, 0
    v_mfma_f32_16x16x32_bf16 v[236:239], v[48:51], v[88:91], v[236:239]
    buffer_load_dwordx4 v2, s[24:27], s60 offen lds
    v_mfma_f32_16x16x32_bf16 v[236:239], v[52:55], v[92:95], v[236:239]
    s_add_u32 s72, s70, 41984
    ds_read_b64_tr_b16 v[48:49], v27 offset:0
    ds_read_b64_tr_b16 v[50:51], v27 offset:512
    v_mfma_f32_16x16x32_bf16 v[240:243], v[56:59], v[64:67], v[240:243]
    ds_read_b64_tr_b16 v[52:53], v27 offset:4096
    ds_read_b64_tr_b16 v[54:55], v27 offset:4608
    v_mfma_f32_16x16x32_bf16 v[240:243], v[60:63], v[68:71], v[240:243]
    buffer_store_dwordx4 a[52:55], v1, s[36:39], s72 offen sc1
    v_mfma_f32_16x16x32_bf16 v[244:247], v[56:59], v[72:75], v[244:247]
    buffer_load_dwordx4 v3, s[24:27], s60 offen offset:1024 lds
    v_mfma_f32_16x16x32_bf16 v[244:247], v[60:63], v[76:79], v[244:247]
    v_add_u32 v27, 0x10000, v27
    v_accvgpr_write_b32 a52, 0
    v_mfma_f32_16x16x32_bf16 v[248:251], v[56:59], v[80:83], v[248:251]
    v_accvgpr_write_b32 a53, 0
    v_accvgpr_write_b32 a54, 0
    v_mfma_f32_16x16x32_bf16 v[248:251], v[60:63], v[84:87], v[248:251]
    v_accvgpr_write_b32 a55, 0
    v_mfma_f32_16x16x32_bf16 v[252:255], v[56:59], v[88:91], v[252:255]
    buffer_load_dwordx4 v4, s[24:27], s60 offen offset:2048 lds
    v_mfma_f32_16x16x32_bf16 v[252:255], v[60:63], v[92:95], v[252:255]
    s_waitcnt lgkmcnt(0)
    ds_read_b64_tr_b16 v[56:57], v28 offset:0
    ds_read_b64_tr_b16 v[58:59], v28 offset:512
    v_mfma_f32_16x16x32_bf16 a[64:67], v[40:43], v[64:67], a[64:67]
    ds_read_b64_tr_b16 v[60:61], v28 offset:4096
    ds_read_b64_tr_b16 v[62:63], v28 offset:4608
    v_mfma_f32_16x16x32_bf16 a[64:67], v[44:47], v[68:71], a[64:67]
    v_add_u32 v24, 0x10000, v24
    v_add_u32 v28, 0x10000, v28
    v_mfma_f32_16x16x32_bf16 a[68:71], v[40:43], v[72:75], a[68:71]
    buffer_load_dwordx4 v5, s[24:27], s60 offen offset:3072 lds
    v_mfma_f32_16x16x32_bf16 a[68:71], v[44:47], v[76:79], a[68:71]
    ds_read_b128 v[112:115], v24 offset:16384
    v_mfma_f32_16x16x32_bf16 a[72:75], v[40:43], v[80:83], a[72:75]
    v_mfma_f32_16x16x32_bf16 a[72:75], v[44:47], v[84:87], a[72:75]
    s_add_u32 m0, s69, 16384
    v_add_u32 v25, 0x10000, v25
    v_mfma_f32_16x16x32_bf16 a[76:79], v[40:43], v[88:91], a[76:79]
    s_xor_b32 s60, s60, 524288
    buffer_load_dwordx4 v10, s[20:23], s63 offen lds
    v_mfma_f32_16x16x32_bf16 a[76:79], v[44:47], v[92:95], a[76:79]
    ds_read_b128 v[116:119], v25 offset:16384
    v_mfma_f32_16x16x32_bf16 a[128:131], v[40:43], a[136:139], a[128:131]
    ds_read_b64_tr_b16 v[40:41], v29 offset:0
    ds_read_b64_tr_b16 v[42:43], v29 offset:512
    v_mfma_f32_16x16x32_bf16 a[128:131], v[44:47], a[140:143], a[128:131]
    ds_read_b64_tr_b16 v[44:45], v29 offset:4096
    ds_read_b64_tr_b16 v[46:47], v29 offset:4608
    v_mfma_f32_16x16x32_bf16 a[80:83], v[48:51], v[64:67], a[80:83]
    buffer_load_dwordx4 v11, s[20:23], s63 offen offset:1024 lds
    v_mfma_f32_16x16x32_bf16 a[80:83], v[52:55], v[68:71], a[80:83]
    ds_read_b128 v[120:123], v24 offset:24576
    v_add_u32 v29, 0x10000, v29
    v_mfma_f32_16x16x32_bf16 a[84:87], v[48:51], v[72:75], a[84:87]
    v_mfma_f32_16x16x32_bf16 a[84:87], v[52:55], v[76:79], a[84:87]
    v_mfma_f32_16x16x32_bf16 a[88:91], v[48:51], v[80:83], a[88:91]
    buffer_load_dwordx4 v12, s[20:23], s63 offen offset:2048 lds
    v_mfma_f32_16x16x32_bf16 a[88:91], v[52:55], v[84:87], a[88:91]
    ds_read_b128 v[124:127], v25 offset:24576
    v_mfma_f32_16x16x32_bf16 a[92:95], v[48:51], v[88:91], a[92:95]
    s_add_u32 s72, s70, 46080
    v_mfma_f32_16x16x32_bf16 a[92:95], v[52:55], v[92:95], a[92:95]
    v_mfma_f32_16x16x32_bf16 a[132:135], v[48:51], a[136:139], a[132:135]
    buffer_load_dwordx4 v13, s[20:23], s63 offen offset:3072 lds
    v_mfma_f32_16x16x32_bf16 a[132:135], v[52:55], a[140:143], a[132:135]
    s_waitcnt lgkmcnt(1)
    v_mfma_f32_16x16x32_bf16 a[96:99], v[56:59], v[64:67], a[96:99]
    v_mfma_f32_16x16x32_bf16 a[96:99], v[60:63], v[68:71], a[96:99]
    s_xor_b32 s63, s63, 384
    v_mfma_f32_16x16x32_bf16 a[100:103], v[56:59], v[72:75], a[100:103]
    buffer_store_dwordx4 a[60:63], v1, s[36:39], s72 offen sc1
    v_mfma_f32_16x16x32_bf16 a[100:103], v[60:63], v[76:79], a[100:103]
    v_mfma_f32_16x16x32_bf16 a[104:107], v[56:59], v[80:83], a[104:107]
    v_accvgpr_write_b32 a60, 0
    v_accvgpr_write_b32 a61, 0
    v_mfma_f32_16x16x32_bf16 a[104:107], v[60:63], v[84:87], a[104:107]
    s_waitcnt vmcnt(10) lgkmcnt(0)
    s_barrier
    ds_read_b64_tr_b16 v[48:49], v14 offset:32768
    v_mfma_f32_16x16x32_bf16 a[108:111], v[56:59], v[88:91], a[108:111]
    s_add_u32 m0, s67, 32768
    ds_read_b64_tr_b16 v[50:51], v14 offset:33792
    ds_read_b64_tr_b16 v[52:53], v14 offset:40960
    v_mfma_f32_16x16x32_bf16 a[108:111], v[60:63], v[92:95], a[108:111]
    buffer_load_dwordx4 v1, s[28:31], s65 offen sc1 lds
    v_mfma_f32_16x16x32_bf16 a[112:115], v[40:43], v[64:67], a[112:115]
    ds_read_b64_tr_b16 v[54:55], v14 offset:41984
    ds_read_b64_tr_b16 v[56:57], v15 offset:32768
    v_mfma_f32_16x16x32_bf16 a[112:115], v[44:47], v[68:71], a[112:115]
    ds_read_b64_tr_b16 v[58:59], v15 offset:33792
    ds_read_b64_tr_b16 v[60:61], v15 offset:40960
    v_mfma_f32_16x16x32_bf16 a[116:119], v[40:43], v[72:75], a[116:119]
    ds_read_b64_tr_b16 v[62:63], v15 offset:41984
    ds_read_b128 a[136:139], v22 offset:0
    v_mfma_f32_16x16x32_bf16 a[116:119], v[44:47], v[76:79], a[116:119]
    ds_read_b128 a[140:143], v23 offset:0
    v_add_u32 v14, 0xffff0000, v14
    v_mfma_f32_16x16x32_bf16 a[120:123], v[40:43], v[80:83], a[120:123]
    v_add_u32 v15, 0xffff0000, v15
    v_add_u32 v22, 0xfffe0000, v22
    v_mfma_f32_16x16x32_bf16 a[120:123], v[44:47], v[84:87], a[120:123]
    v_add_u32 v23, 0xfffe0000, v23
    v_accvgpr_read_b32 v32, a144
    v_mfma_f32_16x16x32_bf16 a[124:127], v[40:43], v[88:91], a[124:127]
    buffer_load_dwordx4 v1, s[28:31], s65 offen offset:1024 sc1 lds
    v_mfma_f32_16x16x32_bf16 a[124:127], v[44:47], v[92:95], a[124:127]
    s_waitcnt lgkmcnt(1)
    ds_read_b64_tr_b16 v[40:41], v16 offset:32768
    ds_read_b64_tr_b16 v[42:43], v16 offset:33792
    v_mfma_f32_16x16x32_bf16 v[128:131], v[48:51], v[96:99], v[128:131]
    ds_read_b64_tr_b16 v[44:45], v16 offset:40960
    ds_read_b64_tr_b16 v[46:47], v16 offset:41984
    v_mfma_f32_16x16x32_bf16 v[128:131], v[52:55], v[100:103], v[128:131]
    v_add_u32 v16, 0xffff0000, v16
    v_accvgpr_read_b32 v31, a145
    v_mfma_f32_16x16x32_bf16 v[132:135], v[48:51], v[104:107], v[132:135]
    ds_read_b128 v[64:67], v24 offset:49152
    v_cvt_pk_bf16_f32 v32, v32, v31
    v_mfma_f32_16x16x32_bf16 v[132:135], v[52:55], v[108:111], v[132:135]
    v_accvgpr_read_b32 v33, a146
    v_accvgpr_read_b32 v31, a147
    v_mfma_f32_16x16x32_bf16 v[136:139], v[48:51], v[112:115], v[136:139]
    v_cvt_pk_bf16_f32 v33, v33, v31
    v_accvgpr_read_b32 v34, a148
    v_mfma_f32_16x16x32_bf16 v[136:139], v[52:55], v[116:119], v[136:139]
    s_add_u32 s72, s71, 32768
    v_accvgpr_read_b32 v31, a149
    v_cvt_pk_bf16_f32 v34, v34, v31
    v_mfma_f32_16x16x32_bf16 v[140:143], v[48:51], v[120:123], v[140:143]
    s_add_u32 m0, s68, 40960
    ds_read_b64_tr_b16 v[48:49], v17 offset:32768
    ds_read_b64_tr_b16 v[50:51], v17 offset:33792
    v_mfma_f32_16x16x32_bf16 v[140:143], v[52:55], v[124:127], v[140:143]
    buffer_load_dwordx4 v6, s[20:23], s66 offen lds
    v_mfma_f32_16x16x32_bf16 v[144:147], v[56:59], v[96:99], v[144:147]
    ds_read_b64_tr_b16 v[52:53], v17 offset:40960
    ds_read_b64_tr_b16 v[54:55], v17 offset:41984
    v_mfma_f32_16x16x32_bf16 v[144:147], v[60:63], v[100:103], v[144:147]
    v_add_u32 v17, 0xffff0000, v17
    v_accvgpr_read_b32 v35, a150
    v_mfma_f32_16x16x32_bf16 v[148:151], v[56:59], v[104:107], v[148:151]
    v_accvgpr_read_b32 v31, a151
    v_cvt_pk_bf16_f32 v35, v35, v31
    v_mfma_f32_16x16x32_bf16 v[148:151], v[60:63], v[108:111], v[148:151]
    buffer_store_dwordx4 v[32:35], v1, s[36:39], s72 offen sc1
    v_mfma_f32_16x16x32_bf16 v[152:155], v[56:59], v[112:115], v[152:155]
    v_accvgpr_write_b32 a62, 0
    v_accvgpr_write_b32 a63, 0
    v_mfma_f32_16x16x32_bf16 v[152:155], v[60:63], v[116:119], v[152:155]
    ds_read_b128 v[68:71], v25 offset:49152
    v_accvgpr_write_b32 a144, 0
    v_mfma_f32_16x16x32_bf16 v[156:159], v[56:59], v[120:123], v[156:159]
    s_add_u32 m0, s69, 49152
    ds_read_b64_tr_b16 v[56:57], v18 offset:32768
    ds_read_b64_tr_b16 v[58:59], v18 offset:33792
    v_mfma_f32_16x16x32_bf16 v[156:159], v[60:63], v[124:127], v[156:159]
    s_xor_b32 s65, s65, 8192
    buffer_load_dwordx4 v10, s[20:23], s64 offen lds
    s_waitcnt lgkmcnt(3)
    v_mfma_f32_16x16x32_bf16 v[160:163], v[40:43], v[96:99], v[160:163]
    s_xor_b32 s66, s66, 128
    ds_read_b64_tr_b16 v[60:61], v18 offset:40960
    ds_read_b64_tr_b16 v[62:63], v18 offset:41984
    v_mfma_f32_16x16x32_bf16 v[160:163], v[44:47], v[100:103], v[160:163]
    v_add_u32 v18, 0xffff0000, v18
    v_accvgpr_write_b32 a145, 0
    v_mfma_f32_16x16x32_bf16 v[164:167], v[40:43], v[104:107], v[164:167]
    v_accvgpr_write_b32 a146, 0
    v_accvgpr_write_b32 a147, 0
    v_mfma_f32_16x16x32_bf16 v[164:167], v[44:47], v[108:111], v[164:167]
    v_accvgpr_read_b32 v32, a152
    v_accvgpr_read_b32 v31, a153
    v_mfma_f32_16x16x32_bf16 v[168:171], v[40:43], v[112:115], v[168:171]
    v_cvt_pk_bf16_f32 v32, v32, v31
    v_accvgpr_read_b32 v33, a154
    v_mfma_f32_16x16x32_bf16 v[168:171], v[44:47], v[116:119], v[168:171]
    v_accvgpr_read_b32 v31, a155
    v_cvt_pk_bf16_f32 v33, v33, v31
    v_mfma_f32_16x16x32_bf16 v[172:175], v[40:43], v[120:123], v[172:175]
    ds_read_b64_tr_b16 v[40:41], v19 offset:32768
    ds_read_b64_tr_b16 v[42:43], v19 offset:33792
    v_mfma_f32_16x16x32_bf16 v[172:175], v[44:47], v[124:127], v[172:175]
    ds_read_b64_tr_b16 v[44:45], v19 offset:40960
    ds_read_b64_tr_b16 v[46:47], v19 offset:41984
    v_mfma_f32_16x16x32_bf16 v[176:179], v[48:51], v[96:99], v[176:179]
    buffer_load_dwordx4 v11, s[20:23], s64 offen offset:1024 lds
    v_mfma_f32_16x16x32_bf16 v[176:179], v[52:55], v[100:103], v[176:179]
    ds_read_b128 v[72:75], v24 offset:57344
    v_add_u32 v19, 0xffff0000, v19
    v_mfma_f32_16x16x32_bf16 v[180:183], v[48:51], v[104:107], v[180:183]
    v_accvgpr_read_b32 v34, a156
    v_accvgpr_read_b32 v31, a157
    v_mfma_f32_16x16x32_bf16 v[180:183], v[52:55], v[108:111], v[180:183]
    v_cvt_pk_bf16_f32 v34, v34, v31
    v_accvgpr_read_b32 v35, a158
    v_mfma_f32_16x16x32_bf16 v[184:187], v[48:51], v[112:115], v[184:187]
    v_accvgpr_read_b32 v31, a159
    v_cvt_pk_bf16_f32 v35, v35, v31
    v_mfma_f32_16x16x32_bf16 v[184:187], v[52:55], v[116:119], v[184:187]
    v_accvgpr_write_b32 a148, 0
    v_accvgpr_write_b32 a149, 0
    v_mfma_f32_16x16x32_bf16 v[188:191], v[48:51], v[120:123], v[188:191]
    s_add_u32 s72, s71, 33792
    ds_read_b64_tr_b16 v[48:49], v20 offset:32768
    ds_read_b64_tr_b16 v[50:51], v20 offset:33792
    v_mfma_f32_16x16x32_bf16 v[188:191], v[52:55], v[124:127], v[188:191]
    s_waitcnt lgkmcnt(2)
    ds_read_b64_tr_b16 v[52:53], v20 offset:40960
    ds_read_b64_tr_b16 v[54:55], v20 offset:41984
    v_mfma_f32_16x16x32_bf16 v[192:195], v[56:59], v[96:99], v[192:195]
    buffer_load_dwordx4 v12, s[20:23], s64 offen offset:2048 lds
    v_mfma_f32_16x16x32_bf16 v[192:195], v[60:63], v[100:103], v[192:195]
    v_add_u32 v20, 0xffff0000, v20
    v_accvgpr_write_b32 a150, 0
    v_mfma_f32_16x16x32_bf16 v[196:199], v[56:59], v[104:107], v[196:199]
    buffer_store_dwordx4 v[32:35], v1, s[36:39], s72 offen sc1
    v_mfma_f32_16x16x32_bf16 v[196:199], v[60:63], v[108:111], v[196:199]
    ds_read_b128 v[76:79], v25 offset:57344
    v_accvgpr_write_b32 a151, 0
    v_mfma_f32_16x16x32_bf16 v[200:203], v[56:59], v[112:115], v[200:203]
    v_accvgpr_write_b32 a152, 0
    v_accvgpr_write_b32 a153, 0
    v_mfma_f32_16x16x32_bf16 v[200:203], v[60:63], v[116:119], v[200:203]
    v_accvgpr_write_b32 a154, 0
    v_accvgpr_write_b32 a155, 0
    v_mfma_f32_16x16x32_bf16 v[204:207], v[56:59], v[120:123], v[204:207]
    ds_read_b64_tr_b16 v[56:57], v21 offset:32768
    ds_read_b64_tr_b16 v[58:59], v21 offset:33792
    v_mfma_f32_16x16x32_bf16 v[204:207], v[60:63], v[124:127], v[204:207]
    ds_read_b64_tr_b16 v[60:61], v21 offset:40960
    ds_read_b64_tr_b16 v[62:63], v21 offset:41984
    v_mfma_f32_16x16x32_bf16 v[208:211], v[40:43], v[96:99], v[208:211]
    v_add_u32 v21, 0xffff0000, v21
    v_accvgpr_write_b32 a156, 0
    v_mfma_f32_16x16x32_bf16 v[208:211], v[44:47], v[100:103], v[208:211]
    buffer_load_dwordx4 v13, s[20:23], s64 offen offset:3072 lds
    v_mfma_f32_16x16x32_bf16 v[212:215], v[40:43], v[104:107], v[212:215]
    v_accvgpr_write_b32 a157, 0
    v_accvgpr_write_b32 a158, 0
    v_mfma_f32_16x16x32_bf16 v[212:215], v[44:47], v[108:111], v[212:215]
    v_accvgpr_write_b32 a159, 0
    v_mfma_f32_16x16x32_bf16 v[216:219], v[40:43], v[112:115], v[216:219]
    v_accvgpr_read_b32 v32, a160
    v_accvgpr_read_b32 v31, a161
    v_mfma_f32_16x16x32_bf16 v[216:219], v[44:47], v[116:119], v[216:219]
    v_cvt_pk_bf16_f32 v32, v32, v31
    v_accvgpr_read_b32 v33, a162
    v_mfma_f32_16x16x32_bf16 v[220:223], v[40:43], v[120:123], v[220:223]
    ds_read_b64_tr_b16 v[40:41], v26 offset:0
    ds_read_b64_tr_b16 v[42:43], v26 offset:512
    v_mfma_f32_16x16x32_bf16 v[220:223], v[44:47], v[124:127], v[220:223]
    s_waitcnt lgkmcnt(2)
    ds_read_b64_tr_b16 v[44:45], v26 offset:4096
    ds_read_b64_tr_b16 v[46:47], v26 offset:4608
    v_mfma_f32_16x16x32_bf16 v[224:227], v[48:51], v[96:99], v[224:227]
    v_add_u32 v26, 0xfffe0000, v26
    v_accvgpr_read_b32 v31, a163
    v_mfma_f32_16x16x32_bf16 v[224:227], v[52:55], v[100:103], v[224:227]
    s_xor_b32 s64, s64, 384
    v_cvt_pk_bf16_f32 v33, v33, v31
    v_accvgpr_read_b32 v34, a164
    v_mfma_f32_16x16x32_bf16 v[228:231], v[48:51], v[104:107], v[228:231]
    v_accvgpr_read_b32 v31, a165
    v_cvt_pk_bf16_f32 v34, v34, v31
    v_mfma_f32_16x16x32_bf16 v[228:231], v[52:55], v[108:111], v[228:231]
    v_accvgpr_read_b32 v35, a166
    v_accvgpr_read_b32 v31, a167
    v_mfma_f32_16x16x32_bf16 v[232:235], v[48:51], v[112:115], v[232:235]
    v_cvt_pk_bf16_f32 v35, v35, v31
    v_accvgpr_write_b32 a160, 0
    v_mfma_f32_16x16x32_bf16 v[232:235], v[52:55], v[116:119], v[232:235]
    s_add_u32 m0, s69, 65536
    v_accvgpr_write_b32 a161, 0
    v_accvgpr_write_b32 a162, 0
    v_mfma_f32_16x16x32_bf16 v[236:239], v[48:51], v[120:123], v[236:239]
    buffer_load_dwordx4 v2, s[24:27], s60 offen lds
    v_mfma_f32_16x16x32_bf16 v[236:239], v[52:55], v[124:127], v[236:239]
    s_add_u32 s72, s71, 2048
    ds_read_b64_tr_b16 v[48:49], v27 offset:0
    ds_read_b64_tr_b16 v[50:51], v27 offset:512
    v_mfma_f32_16x16x32_bf16 v[240:243], v[56:59], v[96:99], v[240:243]
    ds_read_b64_tr_b16 v[52:53], v27 offset:4096
    ds_read_b64_tr_b16 v[54:55], v27 offset:4608
    v_mfma_f32_16x16x32_bf16 v[240:243], v[60:63], v[100:103], v[240:243]
    v_add_u32 v27, 0xfffe0000, v27
    v_accvgpr_write_b32 a163, 0
    v_mfma_f32_16x16x32_bf16 v[244:247], v[56:59], v[104:107], v[244:247]
    buffer_load_dwordx4 v3, s[24:27], s60 offen offset:1024 lds
    v_mfma_f32_16x16x32_bf16 v[244:247], v[60:63], v[108:111], v[244:247]
    buffer_store_dwordx4 v[32:35], v1, s[36:39], s72 offen sc1
    v_mfma_f32_16x16x32_bf16 v[248:251], v[56:59], v[112:115], v[248:251]
    v_accvgpr_write_b32 a164, 0
    v_accvgpr_write_b32 a165, 0
    v_mfma_f32_16x16x32_bf16 v[248:251], v[60:63], v[116:119], v[248:251]
    v_accvgpr_write_b32 a166, 0
    v_accvgpr_write_b32 a167, 0
    v_mfma_f32_16x16x32_bf16 v[252:255], v[56:59], v[120:123], v[252:255]
    buffer_load_dwordx4 v4, s[24:27], s60 offen offset:2048 lds
    v_mfma_f32_16x16x32_bf16 v[252:255], v[60:63], v[124:127], v[252:255]
    s_waitcnt lgkmcnt(0)
    ds_read_b64_tr_b16 v[56:57], v28 offset:0
    ds_read_b64_tr_b16 v[58:59], v28 offset:512
    v_mfma_f32_16x16x32_bf16 a[64:67], v[40:43], v[96:99], a[64:67]
    ds_read_b64_tr_b16 v[60:61], v28 offset:4096
    ds_read_b64_tr_b16 v[62:63], v28 offset:4608
    v_mfma_f32_16x16x32_bf16 a[64:67], v[44:47], v[100:103], a[64:67]
    v_add_u32 v24, 0x10000, v24
    v_add_u32 v28, 0xfffe0000, v28
    v_mfma_f32_16x16x32_bf16 a[68:71], v[40:43], v[104:107], a[68:71]
    buffer_load_dwordx4 v5, s[24:27], s60 offen offset:3072 lds
    v_mfma_f32_16x16x32_bf16 a[68:71], v[44:47], v[108:111], a[68:71]
    ds_read_b128 v[80:83], v24 offset:16384
    v_mfma_f32_16x16x32_bf16 a[72:75], v[40:43], v[112:115], a[72:75]
    v_mfma_f32_16x16x32_bf16 a[72:75], v[44:47], v[116:119], a[72:75]
    s_add_u32 m0, s69, 81920
    v_add_u32 v25, 0x10000, v25
    v_accvgpr_read_b32 v32, a168
    v_mfma_f32_16x16x32_bf16 a[76:79], v[40:43], v[120:123], a[76:79]
    s_xor_b32 s60, s60, 1572864
    buffer_load_dwordx4 v10, s[20:23], s63 offen lds
    v_mfma_f32_16x16x32_bf16 a[76:79], v[44:47], v[124:127], a[76:79]
    ds_read_b128 v[84:87], v25 offset:16384
    v_accvgpr_read_b32 v31, a169
    v_mfma_f32_16x16x32_bf16 a[128:131], v[40:43], a[136:139], a[128:131]
    ds_read_b64_tr_b16 v[40:41], v29 offset:0
    ds_read_b64_tr_b16 v[42:43], v29 offset:512
    v_mfma_f32_16x16x32_bf16 a[128:131], v[44:47], a[140:143], a[128:131]
    ds_read_b64_tr_b16 v[44:45], v29 offset:4096
    ds_read_b64_tr_b16 v[46:47], v29 offset:4608
    v_mfma_f32_16x16x32_bf16 a[80:83], v[48:51], v[96:99], a[80:83]
    buffer_load_dwordx4 v11, s[20:23], s63 offen offset:1024 lds
    v_mfma_f32_16x16x32_bf16 a[80:83], v[52:55], v[100:103], a[80:83]
    ds_read_b128 v[88:91], v24 offset:24576
    v_add_u32 v29, 0xfffe0000, v29
    v_mfma_f32_16x16x32_bf16 a[84:87], v[48:51], v[104:107], a[84:87]
    v_cvt_pk_bf16_f32 v32, v32, v31
    v_accvgpr_read_b32 v33, a170
    v_mfma_f32_16x16x32_bf16 a[84:87], v[52:55], v[108:111], a[84:87]
    v_accvgpr_read_b32 v31, a171
    v_cvt_pk_bf16_f32 v33, v33, v31
    v_mfma_f32_16x16x32_bf16 a[88:91], v[48:51], v[112:115], a[88:91]
    buffer_load_dwordx4 v12, s[20:23], s63 offen offset:2048 lds
    v_mfma_f32_16x16x32_bf16 a[88:91], v[52:55], v[116:119], a[88:91]
    ds_read_b128 v[92:95], v25 offset:24576
    v_accvgpr_read_b32 v34, a172
    v_mfma_f32_16x16x32_bf16 a[92:95], v[48:51], v[120:123], a[92:95]
    s_add_u32 s72, s71, 3072
    v_accvgpr_read_b32 v31, a173
    v_cvt_pk_bf16_f32 v34, v34, v31
    v_mfma_f32_16x16x32_bf16 a[92:95], v[52:55], v[124:127], a[92:95]
    v_accvgpr_read_b32 v35, a174
    v_accvgpr_read_b32 v31, a175
    v_mfma_f32_16x16x32_bf16 a[132:135], v[48:51], a[136:139], a[132:135]
    buffer_load_dwordx4 v13, s[20:23], s63 offen offset:3072 lds
    v_mfma_f32_16x16x32_bf16 a[132:135], v[52:55], a[140:143], a[132:135]
    s_waitcnt lgkmcnt(1)
    v_cvt_pk_bf16_f32 v35, v35, v31
    v_accvgpr_write_b32 a168, 0
    v_mfma_f32_16x16x32_bf16 a[96:99], v[56:59], v[96:99], a[96:99]
    v_accvgpr_write_b32 a169, 0
    v_accvgpr_write_b32 a170, 0
    v_mfma_f32_16x16x32_bf16 a[96:99], v[60:63], v[100:103], a[96:99]
    s_xor_b32 s63, s63, 128
    v_accvgpr_write_b32 a171, 0
    v_accvgpr_write_b32 a172, 0
    v_mfma_f32_16x16x32_bf16 a[100:103], v[56:59], v[104:107], a[100:103]
    buffer_store_dwordx4 v[32:35], v1, s[36:39], s72 offen sc1
    v_mfma_f32_16x16x32_bf16 a[100:103], v[60:63], v[108:111], a[100:103]
    v_accvgpr_write_b32 a173, 0
    v_accvgpr_write_b32 a174, 0
    v_mfma_f32_16x16x32_bf16 a[104:107], v[56:59], v[112:115], a[104:107]
    v_accvgpr_write_b32 a175, 0
    v_mfma_f32_16x16x32_bf16 a[104:107], v[60:63], v[116:119], a[104:107]
    s_waitcnt vmcnt(10) lgkmcnt(0)
    s_barrier
    ds_read_b64_tr_b16 v[48:49], v14 offset:0
    v_mfma_f32_16x16x32_bf16 a[108:111], v[56:59], v[120:123], a[108:111]
    s_add_u32 m0, s67, 98304
    ds_read_b64_tr_b16 v[50:51], v14 offset:1024
    ds_read_b64_tr_b16 v[52:53], v14 offset:8192
    v_mfma_f32_16x16x32_bf16 a[108:111], v[60:63], v[124:127], a[108:111]
    buffer_load_dwordx4 v1, s[28:31], s65 offen sc1 lds
    v_mfma_f32_16x16x32_bf16 a[112:115], v[40:43], v[96:99], a[112:115]
    ds_read_b64_tr_b16 v[54:55], v14 offset:9216
    ds_read_b64_tr_b16 v[56:57], v15 offset:0
    v_mfma_f32_16x16x32_bf16 a[112:115], v[44:47], v[100:103], a[112:115]
    ds_read_b64_tr_b16 v[58:59], v15 offset:1024
    ds_read_b64_tr_b16 v[60:61], v15 offset:8192
    v_mfma_f32_16x16x32_bf16 a[116:119], v[40:43], v[104:107], a[116:119]
    ds_read_b64_tr_b16 v[62:63], v15 offset:9216
    ds_read_b128 a[136:139], v22 offset:32768
    v_mfma_f32_16x16x32_bf16 a[116:119], v[44:47], v[108:111], a[116:119]
    ds_read_b128 a[140:143], v23 offset:32768
    v_add_u32 v14, 0x10000, v14
    v_mfma_f32_16x16x32_bf16 a[120:123], v[40:43], v[112:115], a[120:123]
    v_add_u32 v15, 0x10000, v15
    v_add_u32 v22, 0x10000, v22
    v_mfma_f32_16x16x32_bf16 a[120:123], v[44:47], v[116:119], a[120:123]
    v_add_u32 v23, 0x10000, v23
    v_accvgpr_read_b32 v32, a176
    v_mfma_f32_16x16x32_bf16 a[124:127], v[40:43], v[120:123], a[124:127]
    buffer_load_dwordx4 v1, s[28:31], s65 offen offset:1024 sc1 lds
    v_mfma_f32_16x16x32_bf16 a[124:127], v[44:47], v[124:127], a[124:127]
    s_waitcnt lgkmcnt(1)
    ds_read_b64_tr_b16 v[40:41], v16 offset:0
    ds_read_b64_tr_b16 v[42:43], v16 offset:1024
    v_mfma_f32_16x16x32_bf16 v[128:131], v[48:51], v[64:67], v[128:131]
    ds_read_b64_tr_b16 v[44:45], v16 offset:8192
    ds_read_b64_tr_b16 v[46:47], v16 offset:9216
    v_mfma_f32_16x16x32_bf16 v[128:131], v[52:55], v[68:71], v[128:131]
    v_add_u32 v24, 0xfffe0000, v24
    v_add_u32 v16, 0x10000, v16
    v_mfma_f32_16x16x32_bf16 v[132:135], v[48:51], v[72:75], v[132:135]
    ds_read_b128 v[96:99], v24 offset:16384
    v_accvgpr_read_b32 v31, a177
    v_mfma_f32_16x16x32_bf16 v[132:135], v[52:55], v[76:79], v[132:135]
    v_cvt_pk_bf16_f32 v32, v32, v31
    v_accvgpr_read_b32 v33, a178
    v_mfma_f32_16x16x32_bf16 v[136:139], v[48:51], v[80:83], v[136:139]
    v_accvgpr_read_b32 v31, a179
    v_cvt_pk_bf16_f32 v33, v33, v31
    v_mfma_f32_16x16x32_bf16 v[136:139], v[52:55], v[84:87], v[136:139]
    s_add_u32 s72, s71, 34816
    v_accvgpr_read_b32 v34, a180
    v_accvgpr_read_b32 v31, a181
    v_mfma_f32_16x16x32_bf16 v[140:143], v[48:51], v[88:91], v[140:143]
    s_add_u32 m0, s68, 106496
    ds_read_b64_tr_b16 v[48:49], v17 offset:0
    ds_read_b64_tr_b16 v[50:51], v17 offset:1024
    v_mfma_f32_16x16x32_bf16 v[140:143], v[52:55], v[92:95], v[140:143]
    buffer_load_dwordx4 v6, s[20:23], s66 offen lds
    v_mfma_f32_16x16x32_bf16 v[144:147], v[56:59], v[64:67], v[144:147]
    ds_read_b64_tr_b16 v[52:53], v17 offset:8192
    ds_read_b64_tr_b16 v[54:55], v17 offset:9216
    v_mfma_f32_16x16x32_bf16 v[144:147], v[60:63], v[68:71], v[144:147]
    v_add_u32 v17, 0x10000, v17
    v_cvt_pk_bf16_f32 v34, v34, v31
    v_mfma_f32_16x16x32_bf16 v[148:151], v[56:59], v[72:75], v[148:151]
    v_accvgpr_read_b32 v35, a182
    v_accvgpr_read_b32 v31, a183
    v_mfma_f32_16x16x32_bf16 v[148:151], v[60:63], v[76:79], v[148:151]
    v_cvt_pk_bf16_f32 v35, v35, v31
    v_accvgpr_write_b32 a176, 0
    v_mfma_f32_16x16x32_bf16 v[152:155], v[56:59], v[80:83], v[152:155]
    v_add_u32 v25, 0xfffe0000, v25
    v_accvgpr_write_b32 a177, 0
    v_mfma_f32_16x16x32_bf16 v[152:155], v[60:63], v[84:87], v[152:155]
    ds_read_b128 v[100:103], v25 offset:16384
    v_accvgpr_write_b32 a178, 0
    v_mfma_f32_16x16x32_bf16 v[156:159], v[56:59], v[88:91], v[156:159]
    s_add_u32 m0, s69, 114688
    ds_read_b64_tr_b16 v[56:57], v18 offset:0
    ds_read_b64_tr_b16 v[58:59], v18 offset:1024
    v_mfma_f32_16x16x32_bf16 v[156:159], v[60:63], v[92:95], v[156:159]
    s_xor_b32 s65, s65, 24576
    buffer_load_dwordx4 v10, s[20:23], s64 offen lds
    s_waitcnt lgkmcnt(3)
    v_mfma_f32_16x16x32_bf16 v[160:163], v[40:43], v[64:67], v[160:163]
    s_xor_b32 s66, s66, 384
    ds_read_b64_tr_b16 v[60:61], v18 offset:8192
    ds_read_b64_tr_b16 v[62:63], v18 offset:9216
    v_mfma_f32_16x16x32_bf16 v[160:163], v[44:47], v[68:71], v[160:163]
    v_add_u32 v18, 0x10000, v18
    v_accvgpr_write_b32 a179, 0
    v_mfma_f32_16x16x32_bf16 v[164:167], v[40:43], v[72:75], v[164:167]
    buffer_store_dwordx4 v[32:35], v1, s[36:39], s72 offen sc1
    v_mfma_f32_16x16x32_bf16 v[164:167], v[44:47], v[76:79], v[164:167]
    v_accvgpr_read_b32 v31, a185
    v_accvgpr_read_b32 v32, a184
    v_mfma_f32_16x16x32_bf16 v[168:171], v[40:43], v[80:83], v[168:171]
    v_cvt_pk_bf16_f32 v32, v32, v31
    v_accvgpr_read_b32 v33, a186
    v_mfma_f32_16x16x32_bf16 v[168:171], v[44:47], v[84:87], v[168:171]
    v_accvgpr_read_b32 v31, a187
    v_cvt_pk_bf16_f32 v33, v33, v31
    v_mfma_f32_16x16x32_bf16 v[172:175], v[40:43], v[88:91], v[172:175]
    ds_read_b64_tr_b16 v[40:41], v19 offset:0
    ds_read_b64_tr_b16 v[42:43], v19 offset:1024
    v_mfma_f32_16x16x32_bf16 v[172:175], v[44:47], v[92:95], v[172:175]
    ds_read_b64_tr_b16 v[44:45], v19 offset:8192
    ds_read_b64_tr_b16 v[46:47], v19 offset:9216
    v_mfma_f32_16x16x32_bf16 v[176:179], v[48:51], v[64:67], v[176:179]
    buffer_load_dwordx4 v11, s[20:23], s64 offen offset:1024 lds
    v_mfma_f32_16x16x32_bf16 v[176:179], v[52:55], v[68:71], v[176:179]
    ds_read_b128 v[104:107], v24 offset:24576
    v_add_u32 v19, 0x10000, v19
    v_mfma_f32_16x16x32_bf16 v[180:183], v[48:51], v[72:75], v[180:183]
    v_accvgpr_read_b32 v34, a188
    v_accvgpr_read_b32 v31, a189
    v_mfma_f32_16x16x32_bf16 v[180:183], v[52:55], v[76:79], v[180:183]
    v_cvt_pk_bf16_f32 v34, v34, v31
    v_accvgpr_read_b32 v35, a190
    v_mfma_f32_16x16x32_bf16 v[184:187], v[48:51], v[80:83], v[184:187]
    v_accvgpr_read_b32 v31, a191
    v_cvt_pk_bf16_f32 v35, v35, v31
    v_mfma_f32_16x16x32_bf16 v[184:187], v[52:55], v[84:87], v[184:187]
    v_accvgpr_write_b32 a180, 0
    v_accvgpr_write_b32 a181, 0
    v_mfma_f32_16x16x32_bf16 v[188:191], v[48:51], v[88:91], v[188:191]
    s_add_u32 s72, s71, 35840
    ds_read_b64_tr_b16 v[48:49], v20 offset:0
    ds_read_b64_tr_b16 v[50:51], v20 offset:1024
    v_mfma_f32_16x16x32_bf16 v[188:191], v[52:55], v[92:95], v[188:191]
    s_waitcnt lgkmcnt(2)
    ds_read_b64_tr_b16 v[52:53], v20 offset:8192
    ds_read_b64_tr_b16 v[54:55], v20 offset:9216
    v_mfma_f32_16x16x32_bf16 v[192:195], v[56:59], v[64:67], v[192:195]
    buffer_load_dwordx4 v12, s[20:23], s64 offen offset:2048 lds
    v_mfma_f32_16x16x32_bf16 v[192:195], v[60:63], v[68:71], v[192:195]
    v_add_u32 v20, 0x10000, v20
    v_accvgpr_write_b32 a182, 0
    v_mfma_f32_16x16x32_bf16 v[196:199], v[56:59], v[72:75], v[196:199]
    buffer_store_dwordx4 v[32:35], v1, s[36:39], s72 offen sc1
    v_mfma_f32_16x16x32_bf16 v[196:199], v[60:63], v[76:79], v[196:199]
    ds_read_b128 v[108:111], v25 offset:24576
    v_accvgpr_write_b32 a183, 0
    v_mfma_f32_16x16x32_bf16 v[200:203], v[56:59], v[80:83], v[200:203]
    v_accvgpr_write_b32 a184, 0
    v_accvgpr_write_b32 a185, 0
    v_mfma_f32_16x16x32_bf16 v[200:203], v[60:63], v[84:87], v[200:203]
    v_accvgpr_write_b32 a186, 0
    v_accvgpr_write_b32 a187, 0
    v_mfma_f32_16x16x32_bf16 v[204:207], v[56:59], v[88:91], v[204:207]
    ds_read_b64_tr_b16 v[56:57], v21 offset:0
    ds_read_b64_tr_b16 v[58:59], v21 offset:1024
    v_mfma_f32_16x16x32_bf16 v[204:207], v[60:63], v[92:95], v[204:207]
    ds_read_b64_tr_b16 v[60:61], v21 offset:8192
    ds_read_b64_tr_b16 v[62:63], v21 offset:9216
    v_mfma_f32_16x16x32_bf16 v[208:211], v[40:43], v[64:67], v[208:211]
    v_add_u32 v21, 0x10000, v21
    v_accvgpr_write_b32 a188, 0
    v_mfma_f32_16x16x32_bf16 v[208:211], v[44:47], v[68:71], v[208:211]
    buffer_load_dwordx4 v13, s[20:23], s64 offen offset:3072 lds
    v_mfma_f32_16x16x32_bf16 v[212:215], v[40:43], v[72:75], v[212:215]
    v_accvgpr_write_b32 a189, 0
    v_accvgpr_write_b32 a190, 0
    v_mfma_f32_16x16x32_bf16 v[212:215], v[44:47], v[76:79], v[212:215]
    v_accvgpr_write_b32 a191, 0
    v_mfma_f32_16x16x32_bf16 v[216:219], v[40:43], v[80:83], v[216:219]
    v_accvgpr_read_b32 v32, a192
    v_accvgpr_read_b32 v31, a193
    v_mfma_f32_16x16x32_bf16 v[216:219], v[44:47], v[84:87], v[216:219]
    v_cvt_pk_bf16_f32 v32, v32, v31
    v_accvgpr_read_b32 v33, a194
    v_mfma_f32_16x16x32_bf16 v[220:223], v[40:43], v[88:91], v[220:223]
    ds_read_b64_tr_b16 v[40:41], v26 offset:32768
    ds_read_b64_tr_b16 v[42:43], v26 offset:33280
    v_mfma_f32_16x16x32_bf16 v[220:223], v[44:47], v[92:95], v[220:223]
    s_waitcnt lgkmcnt(2)
    ds_read_b64_tr_b16 v[44:45], v26 offset:36864
    ds_read_b64_tr_b16 v[46:47], v26 offset:37376
    v_mfma_f32_16x16x32_bf16 v[224:227], v[48:51], v[64:67], v[224:227]
    v_add_u32 v26, 0x10000, v26
    v_accvgpr_read_b32 v31, a195
    v_mfma_f32_16x16x32_bf16 v[224:227], v[52:55], v[68:71], v[224:227]
    s_xor_b32 s64, s64, 128
    v_cvt_pk_bf16_f32 v33, v33, v31
    v_accvgpr_read_b32 v34, a196
    v_mfma_f32_16x16x32_bf16 v[228:231], v[48:51], v[72:75], v[228:231]
    v_accvgpr_read_b32 v31, a197
    v_cvt_pk_bf16_f32 v34, v34, v31
    v_mfma_f32_16x16x32_bf16 v[228:231], v[52:55], v[76:79], v[228:231]
    v_accvgpr_read_b32 v35, a198
    v_accvgpr_read_b32 v31, a199
    v_mfma_f32_16x16x32_bf16 v[232:235], v[48:51], v[80:83], v[232:235]
    v_cvt_pk_bf16_f32 v35, v35, v31
    v_accvgpr_write_b32 a192, 0
    v_mfma_f32_16x16x32_bf16 v[232:235], v[52:55], v[84:87], v[232:235]
    s_add_u32 m0, s69, 131072
    v_accvgpr_write_b32 a193, 0
    v_accvgpr_write_b32 a194, 0
    v_mfma_f32_16x16x32_bf16 v[236:239], v[48:51], v[88:91], v[236:239]
    buffer_load_dwordx4 v2, s[24:27], s60 offen lds
    v_mfma_f32_16x16x32_bf16 v[236:239], v[52:55], v[92:95], v[236:239]
    s_add_u32 s72, s71, 4096
    ds_read_b64_tr_b16 v[48:49], v27 offset:32768
    ds_read_b64_tr_b16 v[50:51], v27 offset:33280
    v_mfma_f32_16x16x32_bf16 v[240:243], v[56:59], v[64:67], v[240:243]
    ds_read_b64_tr_b16 v[52:53], v27 offset:36864
    ds_read_b64_tr_b16 v[54:55], v27 offset:37376
    v_mfma_f32_16x16x32_bf16 v[240:243], v[60:63], v[68:71], v[240:243]
    v_add_u32 v27, 0x10000, v27
    v_accvgpr_write_b32 a195, 0
    v_mfma_f32_16x16x32_bf16 v[244:247], v[56:59], v[72:75], v[244:247]
    buffer_load_dwordx4 v3, s[24:27], s60 offen offset:1024 lds
    v_mfma_f32_16x16x32_bf16 v[244:247], v[60:63], v[76:79], v[244:247]
    buffer_store_dwordx4 v[32:35], v1, s[36:39], s72 offen sc1
    v_mfma_f32_16x16x32_bf16 v[248:251], v[56:59], v[80:83], v[248:251]
    v_accvgpr_write_b32 a196, 0
    v_accvgpr_write_b32 a197, 0
    v_mfma_f32_16x16x32_bf16 v[248:251], v[60:63], v[84:87], v[248:251]
    v_accvgpr_write_b32 a198, 0
    v_accvgpr_write_b32 a199, 0
    v_mfma_f32_16x16x32_bf16 v[252:255], v[56:59], v[88:91], v[252:255]
    buffer_load_dwordx4 v4, s[24:27], s60 offen offset:2048 lds
    v_mfma_f32_16x16x32_bf16 v[252:255], v[60:63], v[92:95], v[252:255]
    s_waitcnt lgkmcnt(0)
    ds_read_b64_tr_b16 v[56:57], v28 offset:32768
    ds_read_b64_tr_b16 v[58:59], v28 offset:33280
    v_mfma_f32_16x16x32_bf16 a[64:67], v[40:43], v[64:67], a[64:67]
    ds_read_b64_tr_b16 v[60:61], v28 offset:36864
    ds_read_b64_tr_b16 v[62:63], v28 offset:37376
    v_mfma_f32_16x16x32_bf16 a[64:67], v[44:47], v[68:71], a[64:67]
    v_add_u32 v28, 0x10000, v28
    v_mfma_f32_16x16x32_bf16 a[68:71], v[40:43], v[72:75], a[68:71]
    buffer_load_dwordx4 v5, s[24:27], s60 offen offset:3072 lds
    v_mfma_f32_16x16x32_bf16 a[68:71], v[44:47], v[76:79], a[68:71]
    ds_read_b128 v[112:115], v24 offset:49152
    v_mfma_f32_16x16x32_bf16 a[72:75], v[40:43], v[80:83], a[72:75]
    v_mfma_f32_16x16x32_bf16 a[72:75], v[44:47], v[84:87], a[72:75]
    s_add_u32 m0, s69, 147456
    v_accvgpr_read_b32 v32, a200
    v_accvgpr_read_b32 v31, a201
    v_mfma_f32_16x16x32_bf16 a[76:79], v[40:43], v[88:91], a[76:79]
    s_xor_b32 s60, s60, 524288
    buffer_load_dwordx4 v10, s[20:23], s63 offen lds
    v_mfma_f32_16x16x32_bf16 a[76:79], v[44:47], v[92:95], a[76:79]
    ds_read_b128 v[116:119], v25 offset:49152
    v_cvt_pk_bf16_f32 v32, v32, v31
    v_mfma_f32_16x16x32_bf16 a[128:131], v[40:43], a[136:139], a[128:131]
    ds_read_b64_tr_b16 v[40:41], v29 offset:32768
    ds_read_b64_tr_b16 v[42:43], v29 offset:33280
    v_mfma_f32_16x16x32_bf16 a[128:131], v[44:47], a[140:143], a[128:131]
    ds_read_b64_tr_b16 v[44:45], v29 offset:36864
    ds_read_b64_tr_b16 v[46:47], v29 offset:37376
    v_mfma_f32_16x16x32_bf16 a[80:83], v[48:51], v[64:67], a[80:83]
    buffer_load_dwordx4 v11, s[20:23], s63 offen offset:1024 lds
    v_mfma_f32_16x16x32_bf16 a[80:83], v[52:55], v[68:71], a[80:83]
    ds_read_b128 v[120:123], v24 offset:57344
    v_add_u32 v29, 0x10000, v29
    v_mfma_f32_16x16x32_bf16 a[84:87], v[48:51], v[72:75], a[84:87]
    v_accvgpr_read_b32 v33, a202
    v_accvgpr_read_b32 v31, a203
    v_mfma_f32_16x16x32_bf16 a[84:87], v[52:55], v[76:79], a[84:87]
    v_cvt_pk_bf16_f32 v33, v33, v31
    v_accvgpr_read_b32 v34, a204
    v_mfma_f32_16x16x32_bf16 a[88:91], v[48:51], v[80:83], a[88:91]
    buffer_load_dwordx4 v12, s[20:23], s63 offen offset:2048 lds
    v_mfma_f32_16x16x32_bf16 a[88:91], v[52:55], v[84:87], a[88:91]
    ds_read_b128 v[124:127], v25 offset:57344
    v_accvgpr_read_b32 v31, a205
    v_mfma_f32_16x16x32_bf16 a[92:95], v[48:51], v[88:91], a[92:95]
    s_add_u32 s72, s71, 5120
    v_cvt_pk_bf16_f32 v34, v34, v31
    v_accvgpr_read_b32 v35, a206
    v_mfma_f32_16x16x32_bf16 a[92:95], v[52:55], v[92:95], a[92:95]
    v_accvgpr_read_b32 v31, a207
    v_cvt_pk_bf16_f32 v35, v35, v31
    v_mfma_f32_16x16x32_bf16 a[132:135], v[48:51], a[136:139], a[132:135]
    buffer_load_dwordx4 v13, s[20:23], s63 offen offset:3072 lds
    v_mfma_f32_16x16x32_bf16 a[132:135], v[52:55], a[140:143], a[132:135]
    s_waitcnt lgkmcnt(1)
    v_accvgpr_write_b32 a200, 0
    v_accvgpr_write_b32 a201, 0
    v_mfma_f32_16x16x32_bf16 a[96:99], v[56:59], v[64:67], a[96:99]
    v_accvgpr_write_b32 a202, 0
    v_accvgpr_write_b32 a203, 0
    v_mfma_f32_16x16x32_bf16 a[96:99], v[60:63], v[68:71], a[96:99]
    s_xor_b32 s63, s63, 1920
    v_accvgpr_write_b32 a204, 0
    v_accvgpr_write_b32 a205, 0
    v_mfma_f32_16x16x32_bf16 a[100:103], v[56:59], v[72:75], a[100:103]
    s_andn2_b32 s63, s63, 896
    buffer_store_dwordx4 v[32:35], v1, s[36:39], s72 offen sc1
    v_mfma_f32_16x16x32_bf16 a[100:103], v[60:63], v[76:79], a[100:103]
    v_accvgpr_write_b32 a206, 0
    v_accvgpr_write_b32 a207, 0
    v_mfma_f32_16x16x32_bf16 a[104:107], v[56:59], v[80:83], a[104:107]
    v_mfma_f32_16x16x32_bf16 a[104:107], v[60:63], v[84:87], a[104:107]
    s_waitcnt vmcnt(10) lgkmcnt(0)
    s_barrier
    ds_read_b64_tr_b16 v[48:49], v14 offset:0
    v_mfma_f32_16x16x32_bf16 a[108:111], v[56:59], v[88:91], a[108:111]
    s_add_u32 m0, s67, 0
    ds_read_b64_tr_b16 v[50:51], v14 offset:1024
    ds_read_b64_tr_b16 v[52:53], v14 offset:8192
    v_mfma_f32_16x16x32_bf16 a[108:111], v[60:63], v[92:95], a[108:111]
    buffer_load_dwordx4 v1, s[28:31], s65 offen sc1 lds
    v_mfma_f32_16x16x32_bf16 a[112:115], v[40:43], v[64:67], a[112:115]
    ds_read_b64_tr_b16 v[54:55], v14 offset:9216
    ds_read_b64_tr_b16 v[56:57], v15 offset:0
    v_mfma_f32_16x16x32_bf16 a[112:115], v[44:47], v[68:71], a[112:115]
    ds_read_b64_tr_b16 v[58:59], v15 offset:1024
    ds_read_b64_tr_b16 v[60:61], v15 offset:8192
    v_mfma_f32_16x16x32_bf16 a[116:119], v[40:43], v[72:75], a[116:119]
    ds_read_b64_tr_b16 v[62:63], v15 offset:9216
    ds_read_b128 a[136:139], v22 offset:32768
    v_mfma_f32_16x16x32_bf16 a[116:119], v[44:47], v[76:79], a[116:119]
    ds_read_b128 a[140:143], v23 offset:32768
    v_add_u32 v14, 0x10000, v14
    v_mfma_f32_16x16x32_bf16 a[120:123], v[40:43], v[80:83], a[120:123]
    v_add_u32 v15, 0x10000, v15
    v_add_u32 v22, 0xffff0000, v22
    v_mfma_f32_16x16x32_bf16 a[120:123], v[44:47], v[84:87], a[120:123]
    v_add_u32 v23, 0xffff0000, v23
    v_accvgpr_read_b32 v32, a208
    v_mfma_f32_16x16x32_bf16 a[124:127], v[40:43], v[88:91], a[124:127]
    buffer_load_dwordx4 v1, s[28:31], s65 offen offset:1024 sc1 lds
    v_mfma_f32_16x16x32_bf16 a[124:127], v[44:47], v[92:95], a[124:127]
    s_waitcnt lgkmcnt(1)
    ds_read_b64_tr_b16 v[40:41], v16 offset:0
    ds_read_b64_tr_b16 v[42:43], v16 offset:1024
    v_mfma_f32_16x16x32_bf16 v[128:131], v[48:51], v[96:99], v[128:131]
    ds_read_b64_tr_b16 v[44:45], v16 offset:8192
    ds_read_b64_tr_b16 v[46:47], v16 offset:9216
    v_mfma_f32_16x16x32_bf16 v[128:131], v[52:55], v[100:103], v[128:131]
    v_add_u32 v24, 0x10000, v24
    v_add_u32 v16, 0x10000, v16
    v_mfma_f32_16x16x32_bf16 v[132:135], v[48:51], v[104:107], v[132:135]
    ds_read_b128 v[64:67], v24 offset:16384
    v_accvgpr_read_b32 v31, a209
    v_mfma_f32_16x16x32_bf16 v[132:135], v[52:55], v[108:111], v[132:135]
    v_cvt_pk_bf16_f32 v32, v32, v31
    v_accvgpr_read_b32 v33, a210
    v_mfma_f32_16x16x32_bf16 v[136:139], v[48:51], v[112:115], v[136:139]
    v_accvgpr_read_b32 v31, a211
    v_cvt_pk_bf16_f32 v33, v33, v31
    v_mfma_f32_16x16x32_bf16 v[136:139], v[52:55], v[116:119], v[136:139]
    s_add_u32 s72, s71, 36864
    v_accvgpr_read_b32 v34, a212
    v_accvgpr_read_b32 v31, a213
    v_mfma_f32_16x16x32_bf16 v[140:143], v[48:51], v[120:123], v[140:143]
    s_add_u32 m0, s68, 8192
    ds_read_b64_tr_b16 v[48:49], v17 offset:0
    ds_read_b64_tr_b16 v[50:51], v17 offset:1024
    v_mfma_f32_16x16x32_bf16 v[140:143], v[52:55], v[124:127], v[140:143]
    buffer_load_dwordx4 v6, s[20:23], s66 offen lds
    v_mfma_f32_16x16x32_bf16 v[144:147], v[56:59], v[96:99], v[144:147]
    ds_read_b64_tr_b16 v[52:53], v17 offset:8192
    ds_read_b64_tr_b16 v[54:55], v17 offset:9216
    v_mfma_f32_16x16x32_bf16 v[144:147], v[60:63], v[100:103], v[144:147]
    v_add_u32 v17, 0x10000, v17
    v_cvt_pk_bf16_f32 v34, v34, v31
    v_mfma_f32_16x16x32_bf16 v[148:151], v[56:59], v[104:107], v[148:151]
    v_accvgpr_read_b32 v35, a214
    v_accvgpr_read_b32 v31, a215
    v_mfma_f32_16x16x32_bf16 v[148:151], v[60:63], v[108:111], v[148:151]
    v_cvt_pk_bf16_f32 v35, v35, v31
    v_accvgpr_write_b32 a208, 0
    v_mfma_f32_16x16x32_bf16 v[152:155], v[56:59], v[112:115], v[152:155]
    v_add_u32 v25, 0x10000, v25
    v_accvgpr_write_b32 a209, 0
    v_mfma_f32_16x16x32_bf16 v[152:155], v[60:63], v[116:119], v[152:155]
    ds_read_b128 v[68:71], v25 offset:16384
    v_accvgpr_write_b32 a210, 0
    v_mfma_f32_16x16x32_bf16 v[156:159], v[56:59], v[120:123], v[156:159]
    s_add_u32 m0, s69, 16384
    ds_read_b64_tr_b16 v[56:57], v18 offset:0
    ds_read_b64_tr_b16 v[58:59], v18 offset:1024
    v_mfma_f32_16x16x32_bf16 v[156:159], v[60:63], v[124:127], v[156:159]
    s_xor_b32 s65, s65, 8192
    buffer_load_dwordx4 v10, s[20:23], s64 offen lds
    s_waitcnt lgkmcnt(3)
    v_mfma_f32_16x16x32_bf16 v[160:163], v[40:43], v[96:99], v[160:163]
    s_xor_b32 s66, s66, 128
    ds_read_b64_tr_b16 v[60:61], v18 offset:8192
    ds_read_b64_tr_b16 v[62:63], v18 offset:9216
    v_mfma_f32_16x16x32_bf16 v[160:163], v[44:47], v[100:103], v[160:163]
    v_add_u32 v18, 0x10000, v18
    v_accvgpr_write_b32 a211, 0
    v_mfma_f32_16x16x32_bf16 v[164:167], v[40:43], v[104:107], v[164:167]
    buffer_store_dwordx4 v[32:35], v1, s[36:39], s72 offen sc1
    v_mfma_f32_16x16x32_bf16 v[164:167], v[44:47], v[108:111], v[164:167]
    v_accvgpr_read_b32 v31, a217
    v_accvgpr_read_b32 v32, a216
    v_mfma_f32_16x16x32_bf16 v[168:171], v[40:43], v[112:115], v[168:171]
    v_cvt_pk_bf16_f32 v32, v32, v31
    v_accvgpr_read_b32 v33, a218
    v_mfma_f32_16x16x32_bf16 v[168:171], v[44:47], v[116:119], v[168:171]
    v_accvgpr_read_b32 v31, a219
    v_cvt_pk_bf16_f32 v33, v33, v31
    v_mfma_f32_16x16x32_bf16 v[172:175], v[40:43], v[120:123], v[172:175]
    ds_read_b64_tr_b16 v[40:41], v19 offset:0
    ds_read_b64_tr_b16 v[42:43], v19 offset:1024
    v_mfma_f32_16x16x32_bf16 v[172:175], v[44:47], v[124:127], v[172:175]
    ds_read_b64_tr_b16 v[44:45], v19 offset:8192
    ds_read_b64_tr_b16 v[46:47], v19 offset:9216
    v_mfma_f32_16x16x32_bf16 v[176:179], v[48:51], v[96:99], v[176:179]
    buffer_load_dwordx4 v11, s[20:23], s64 offen offset:1024 lds
    v_mfma_f32_16x16x32_bf16 v[176:179], v[52:55], v[100:103], v[176:179]
    ds_read_b128 v[72:75], v24 offset:24576
    v_add_u32 v19, 0x10000, v19
    v_mfma_f32_16x16x32_bf16 v[180:183], v[48:51], v[104:107], v[180:183]
    v_accvgpr_read_b32 v34, a220
    v_accvgpr_read_b32 v31, a221
    v_mfma_f32_16x16x32_bf16 v[180:183], v[52:55], v[108:111], v[180:183]
    v_cvt_pk_bf16_f32 v34, v34, v31
    v_accvgpr_read_b32 v35, a222
    v_mfma_f32_16x16x32_bf16 v[184:187], v[48:51], v[112:115], v[184:187]
    v_accvgpr_read_b32 v31, a223
    v_cvt_pk_bf16_f32 v35, v35, v31
    v_mfma_f32_16x16x32_bf16 v[184:187], v[52:55], v[116:119], v[184:187]
    v_accvgpr_write_b32 a212, 0
    v_accvgpr_write_b32 a213, 0
    v_mfma_f32_16x16x32_bf16 v[188:191], v[48:51], v[120:123], v[188:191]
    s_add_u32 s72, s71, 37888
    ds_read_b64_tr_b16 v[48:49], v20 offset:0
    ds_read_b64_tr_b16 v[50:51], v20 offset:1024
    v_mfma_f32_16x16x32_bf16 v[188:191], v[52:55], v[124:127], v[188:191]
    s_waitcnt lgkmcnt(2)
    ds_read_b64_tr_b16 v[52:53], v20 offset:8192
    ds_read_b64_tr_b16 v[54:55], v20 offset:9216
    v_mfma_f32_16x16x32_bf16 v[192:195], v[56:59], v[96:99], v[192:195]
    buffer_load_dwordx4 v12, s[20:23], s64 offen offset:2048 lds
    v_mfma_f32_16x16x32_bf16 v[192:195], v[60:63], v[100:103], v[192:195]
    v_add_u32 v20, 0x10000, v20
    v_accvgpr_write_b32 a214, 0
    v_mfma_f32_16x16x32_bf16 v[196:199], v[56:59], v[104:107], v[196:199]
    buffer_store_dwordx4 v[32:35], v1, s[36:39], s72 offen sc1
    v_mfma_f32_16x16x32_bf16 v[196:199], v[60:63], v[108:111], v[196:199]
    ds_read_b128 v[76:79], v25 offset:24576
    v_accvgpr_write_b32 a215, 0
    v_mfma_f32_16x16x32_bf16 v[200:203], v[56:59], v[112:115], v[200:203]
    v_accvgpr_write_b32 a216, 0
    v_accvgpr_write_b32 a217, 0
    v_mfma_f32_16x16x32_bf16 v[200:203], v[60:63], v[116:119], v[200:203]
    v_accvgpr_write_b32 a218, 0
    v_accvgpr_write_b32 a219, 0
    v_mfma_f32_16x16x32_bf16 v[204:207], v[56:59], v[120:123], v[204:207]
    ds_read_b64_tr_b16 v[56:57], v21 offset:0
    ds_read_b64_tr_b16 v[58:59], v21 offset:1024
    v_mfma_f32_16x16x32_bf16 v[204:207], v[60:63], v[124:127], v[204:207]
    ds_read_b64_tr_b16 v[60:61], v21 offset:8192
    ds_read_b64_tr_b16 v[62:63], v21 offset:9216
    v_mfma_f32_16x16x32_bf16 v[208:211], v[40:43], v[96:99], v[208:211]
    v_add_u32 v21, 0x10000, v21
    v_accvgpr_write_b32 a220, 0
    v_mfma_f32_16x16x32_bf16 v[208:211], v[44:47], v[100:103], v[208:211]
    buffer_load_dwordx4 v13, s[20:23], s64 offen offset:3072 lds
    v_mfma_f32_16x16x32_bf16 v[212:215], v[40:43], v[104:107], v[212:215]
    v_accvgpr_write_b32 a221, 0
    v_accvgpr_write_b32 a222, 0
    v_mfma_f32_16x16x32_bf16 v[212:215], v[44:47], v[108:111], v[212:215]
    v_accvgpr_write_b32 a223, 0
    v_mfma_f32_16x16x32_bf16 v[216:219], v[40:43], v[112:115], v[216:219]
    v_accvgpr_read_b32 v32, a224
    v_accvgpr_read_b32 v31, a225
    v_mfma_f32_16x16x32_bf16 v[216:219], v[44:47], v[116:119], v[216:219]
    v_cvt_pk_bf16_f32 v32, v32, v31
    v_accvgpr_read_b32 v33, a226
    v_mfma_f32_16x16x32_bf16 v[220:223], v[40:43], v[120:123], v[220:223]
    ds_read_b64_tr_b16 v[40:41], v26 offset:32768
    ds_read_b64_tr_b16 v[42:43], v26 offset:33280
    v_mfma_f32_16x16x32_bf16 v[220:223], v[44:47], v[124:127], v[220:223]
    s_waitcnt lgkmcnt(2)
    ds_read_b64_tr_b16 v[44:45], v26 offset:36864
    ds_read_b64_tr_b16 v[46:47], v26 offset:37376
    v_mfma_f32_16x16x32_bf16 v[224:227], v[48:51], v[96:99], v[224:227]
    v_add_u32 v26, 0xffff0000, v26
    v_accvgpr_read_b32 v31, a227
    v_mfma_f32_16x16x32_bf16 v[224:227], v[52:55], v[100:103], v[224:227]
    s_xor_b32 s64, s64, 1920
    v_cvt_pk_bf16_f32 v33, v33, v31
    v_accvgpr_read_b32 v34, a228
    v_mfma_f32_16x16x32_bf16 v[228:231], v[48:51], v[104:107], v[228:231]
    s_andn2_b32 s64, s64, 896
    v_accvgpr_read_b32 v31, a229
    v_cvt_pk_bf16_f32 v34, v34, v31
    v_mfma_f32_16x16x32_bf16 v[228:231], v[52:55], v[108:111], v[228:231]
    v_accvgpr_read_b32 v35, a230
    v_accvgpr_read_b32 v31, a231
    v_mfma_f32_16x16x32_bf16 v[232:235], v[48:51], v[112:115], v[232:235]
    v_cvt_pk_bf16_f32 v35, v35, v31
    v_mfma_f32_16x16x32_bf16 v[232:235], v[52:55], v[116:119], v[232:235]
    s_add_u32 m0, s69, 32768
    v_mfma_f32_16x16x32_bf16 v[236:239], v[48:51], v[120:123], v[236:239]
    buffer_load_dwordx4 v2, s[24:27], s60 offen lds
    v_mfma_f32_16x16x32_bf16 v[236:239], v[52:55], v[124:127], v[236:239]
    s_add_u32 s72, s71, 6144
    ds_read_b64_tr_b16 v[48:49], v27 offset:32768
    ds_read_b64_tr_b16 v[50:51], v27 offset:33280
    v_mfma_f32_16x16x32_bf16 v[240:243], v[56:59], v[96:99], v[240:243]
    ds_read_b64_tr_b16 v[52:53], v27 offset:36864
    ds_read_b64_tr_b16 v[54:55], v27 offset:37376
    v_mfma_f32_16x16x32_bf16 v[240:243], v[60:63], v[100:103], v[240:243]
    buffer_store_dwordx4 v[32:35], v1, s[36:39], s72 offen sc1
    v_mfma_f32_16x16x32_bf16 v[244:247], v[56:59], v[104:107], v[244:247]
    buffer_load_dwordx4 v3, s[24:27], s60 offen offset:1024 lds
    v_mfma_f32_16x16x32_bf16 v[244:247], v[60:63], v[108:111], v[244:247]
    v_add_u32 v27, 0xffff0000, v27
    v_mfma_f32_16x16x32_bf16 v[248:251], v[56:59], v[112:115], v[248:251]
    v_mfma_f32_16x16x32_bf16 v[248:251], v[60:63], v[116:119], v[248:251]
    v_mfma_f32_16x16x32_bf16 v[252:255], v[56:59], v[120:123], v[252:255]
    buffer_load_dwordx4 v4, s[24:27], s60 offen offset:2048 lds
    v_mfma_f32_16x16x32_bf16 v[252:255], v[60:63], v[124:127], v[252:255]
    s_waitcnt lgkmcnt(0)
    ds_read_b64_tr_b16 v[56:57], v28 offset:32768
    ds_read_b64_tr_b16 v[58:59], v28 offset:33280
    v_mfma_f32_16x16x32_bf16 a[64:67], v[40:43], v[96:99], a[64:67]
    ds_read_b64_tr_b16 v[60:61], v28 offset:36864
    ds_read_b64_tr_b16 v[62:63], v28 offset:37376
    v_mfma_f32_16x16x32_bf16 a[64:67], v[44:47], v[100:103], a[64:67]
    v_add_u32 v28, 0xffff0000, v28
    v_mfma_f32_16x16x32_bf16 a[68:71], v[40:43], v[104:107], a[68:71]
    buffer_load_dwordx4 v5, s[24:27], s60 offen offset:3072 lds
    v_mfma_f32_16x16x32_bf16 a[68:71], v[44:47], v[108:111], a[68:71]
    ds_read_b128 v[80:83], v24 offset:49152
    v_mfma_f32_16x16x32_bf16 a[72:75], v[40:43], v[112:115], a[72:75]
    v_mfma_f32_16x16x32_bf16 a[72:75], v[44:47], v[116:119], a[72:75]
    s_xor_b32 s60, s60, 7864320
    v_accvgpr_read_b32 v32, a232
    v_accvgpr_read_b32 v31, a233
    v_mfma_f32_16x16x32_bf16 a[76:79], v[40:43], v[120:123], a[76:79]
    s_add_u32 m0, s69, 49152
    ds_read_b128 v[84:87], v25 offset:49152
    v_cvt_pk_bf16_f32 v32, v32, v31
    v_mfma_f32_16x16x32_bf16 a[76:79], v[44:47], v[124:127], a[76:79]
    s_andn2_b32 s60, s60, 3670016
    buffer_load_dwordx4 v10, s[20:23], s63 offen lds
    v_mfma_f32_16x16x32_bf16 a[128:131], v[40:43], a[136:139], a[128:131]
    ds_read_b64_tr_b16 v[40:41], v29 offset:32768
    ds_read_b64_tr_b16 v[42:43], v29 offset:33280
    v_mfma_f32_16x16x32_bf16 a[128:131], v[44:47], a[140:143], a[128:131]
    ds_read_b64_tr_b16 v[44:45], v29 offset:36864
    ds_read_b64_tr_b16 v[46:47], v29 offset:37376
    v_mfma_f32_16x16x32_bf16 a[80:83], v[48:51], v[96:99], a[80:83]
    buffer_load_dwordx4 v11, s[20:23], s63 offen offset:1024 lds
    v_mfma_f32_16x16x32_bf16 a[80:83], v[52:55], v[100:103], a[80:83]
    ds_read_b128 v[88:91], v24 offset:57344
    v_add_u32 v29, 0xffff0000, v29
    v_mfma_f32_16x16x32_bf16 a[84:87], v[48:51], v[104:107], a[84:87]
    v_accvgpr_read_b32 v33, a234
    v_accvgpr_read_b32 v31, a235
    v_mfma_f32_16x16x32_bf16 a[84:87], v[52:55], v[108:111], a[84:87]
    v_cvt_pk_bf16_f32 v33, v33, v31
    v_accvgpr_read_b32 v34, a236
    v_mfma_f32_16x16x32_bf16 a[88:91], v[48:51], v[112:115], a[88:91]
    buffer_load_dwordx4 v12, s[20:23], s63 offen offset:2048 lds
    v_mfma_f32_16x16x32_bf16 a[88:91], v[52:55], v[116:119], a[88:91]
    ds_read_b128 v[92:95], v25 offset:57344
    v_accvgpr_read_b32 v31, a237
    v_mfma_f32_16x16x32_bf16 a[92:95], v[48:51], v[120:123], a[92:95]
    s_add_u32 s72, s71, 7168
    v_cvt_pk_bf16_f32 v34, v34, v31
    v_accvgpr_read_b32 v35, a238
    v_mfma_f32_16x16x32_bf16 a[92:95], v[52:55], v[124:127], a[92:95]
    v_accvgpr_read_b32 v31, a239
    v_cvt_pk_bf16_f32 v35, v35, v31
    v_mfma_f32_16x16x32_bf16 a[132:135], v[48:51], a[136:139], a[132:135]
    buffer_load_dwordx4 v13, s[20:23], s63 offen offset:3072 lds
    v_mfma_f32_16x16x32_bf16 a[132:135], v[52:55], a[140:143], a[132:135]
    s_waitcnt lgkmcnt(1)
    v_mfma_f32_16x16x32_bf16 a[96:99], v[56:59], v[96:99], a[96:99]
    v_mfma_f32_16x16x32_bf16 a[96:99], v[60:63], v[100:103], a[96:99]
    s_xor_b32 s63, s63, 128
    v_mfma_f32_16x16x32_bf16 a[100:103], v[56:59], v[104:107], a[100:103]
    buffer_store_dwordx4 v[32:35], v1, s[36:39], s72 offen sc1
    v_mfma_f32_16x16x32_bf16 a[100:103], v[60:63], v[108:111], a[100:103]
    v_mfma_f32_16x16x32_bf16 a[104:107], v[56:59], v[112:115], a[104:107]
    v_mfma_f32_16x16x32_bf16 a[104:107], v[60:63], v[116:119], a[104:107]
    s_waitcnt vmcnt(10) lgkmcnt(0)
    s_barrier
    ds_read_b64_tr_b16 v[48:49], v14 offset:0
    v_mfma_f32_16x16x32_bf16 a[108:111], v[56:59], v[120:123], a[108:111]
    s_add_u32 m0, s69, 65536
    ds_read_b64_tr_b16 v[50:51], v14 offset:1024
    ds_read_b64_tr_b16 v[52:53], v14 offset:8192
    v_mfma_f32_16x16x32_bf16 a[108:111], v[60:63], v[124:127], a[108:111]
    buffer_load_dwordx4 v2, s[24:27], s60 offen lds
    v_mfma_f32_16x16x32_bf16 a[112:115], v[40:43], v[96:99], a[112:115]
    ds_read_b64_tr_b16 v[54:55], v14 offset:9216
    ds_read_b64_tr_b16 v[56:57], v15 offset:0
    v_mfma_f32_16x16x32_bf16 a[112:115], v[44:47], v[100:103], a[112:115]
    ds_read_b64_tr_b16 v[58:59], v15 offset:1024
    ds_read_b64_tr_b16 v[60:61], v15 offset:8192
    v_mfma_f32_16x16x32_bf16 a[116:119], v[40:43], v[104:107], a[116:119]
    ds_read_b64_tr_b16 v[62:63], v15 offset:9216
    ds_read_b128 a[136:139], v22 offset:0
    v_mfma_f32_16x16x32_bf16 a[116:119], v[44:47], v[108:111], a[116:119]
    ds_read_b128 a[140:143], v23 offset:0
    v_add_u32 v14, 0xfffe0000, v14
    v_mfma_f32_16x16x32_bf16 a[120:123], v[40:43], v[112:115], a[120:123]
    v_add_u32 v15, 0xfffe0000, v15
    v_add_u32 v22, 0x10000, v22
    v_mfma_f32_16x16x32_bf16 a[120:123], v[44:47], v[116:119], a[120:123]
    buffer_load_dwordx4 v3, s[24:27], s60 offen offset:1024 lds
    v_mfma_f32_16x16x32_bf16 a[124:127], v[40:43], v[120:123], a[124:127]
    ds_read_b64_tr_b16 v[40:41], v16 offset:0
    ds_read_b64_tr_b16 v[42:43], v16 offset:1024
    v_mfma_f32_16x16x32_bf16 a[124:127], v[44:47], v[124:127], a[124:127]
    s_waitcnt lgkmcnt(3)
    ds_read_b64_tr_b16 v[44:45], v16 offset:8192
    ds_read_b64_tr_b16 v[46:47], v16 offset:9216
    v_mfma_f32_16x16x32_bf16 v[128:131], v[48:51], v[64:67], v[128:131]
    v_add_u32 v16, 0xfffe0000, v16
    v_add_u32 v23, 0x10000, v23
    v_mfma_f32_16x16x32_bf16 v[128:131], v[52:55], v[68:71], v[128:131]
    v_add_u32 v24, 0x10000, v24
    v_accvgpr_read_b32 v32, a240
    v_mfma_f32_16x16x32_bf16 v[132:135], v[48:51], v[72:75], v[132:135]
    ds_read_b128 v[96:99], v24 offset:16384
    v_accvgpr_read_b32 v31, a241
    v_mfma_f32_16x16x32_bf16 v[132:135], v[52:55], v[76:79], v[132:135]
    v_cvt_pk_bf16_f32 v32, v32, v31
    v_accvgpr_read_b32 v33, a242
    v_mfma_f32_16x16x32_bf16 v[136:139], v[48:51], v[80:83], v[136:139]
    v_accvgpr_read_b32 v31, a243
    v_cvt_pk_bf16_f32 v33, v33, v31
    v_mfma_f32_16x16x32_bf16 v[136:139], v[52:55], v[84:87], v[136:139]
    s_add_u32 s72, s71, 38912
    buffer_load_dwordx4 v4, s[24:27], s60 offen offset:2048 lds
    v_mfma_f32_16x16x32_bf16 v[140:143], v[48:51], v[88:91], v[140:143]
    ds_read_b64_tr_b16 v[48:49], v17 offset:0
    ds_read_b64_tr_b16 v[50:51], v17 offset:1024
    v_mfma_f32_16x16x32_bf16 v[140:143], v[52:55], v[92:95], v[140:143]
    ds_read_b64_tr_b16 v[52:53], v17 offset:8192
    ds_read_b64_tr_b16 v[54:55], v17 offset:9216
    v_mfma_f32_16x16x32_bf16 v[144:147], v[56:59], v[64:67], v[144:147]
    v_add_u32 v17, 0xfffe0000, v17
    v_accvgpr_read_b32 v34, a244
    v_mfma_f32_16x16x32_bf16 v[144:147], v[60:63], v[68:71], v[144:147]
    v_accvgpr_read_b32 v31, a245
    v_cvt_pk_bf16_f32 v34, v34, v31
    v_mfma_f32_16x16x32_bf16 v[148:151], v[56:59], v[72:75], v[148:151]
    v_accvgpr_read_b32 v35, a246
    v_accvgpr_read_b32 v31, a247
    v_mfma_f32_16x16x32_bf16 v[148:151], v[60:63], v[76:79], v[148:151]
    v_cvt_pk_bf16_f32 v35, v35, v31
    v_mov_b32 v2, v1
    v_mfma_f32_16x16x32_bf16 v[152:155], v[56:59], v[80:83], v[152:155]
    buffer_load_dwordx4 v5, s[24:27], s60 offen offset:3072 lds
    v_mfma_f32_16x16x32_bf16 v[152:155], v[60:63], v[84:87], v[152:155]
    v_add_u32 v25, 0x10000, v25
    ds_read_b128 v[100:103], v25 offset:16384
    v_mfma_f32_16x16x32_bf16 v[156:159], v[56:59], v[88:91], v[156:159]
    ds_read_b64_tr_b16 v[56:57], v18 offset:0
    ds_read_b64_tr_b16 v[58:59], v18 offset:1024
    v_mfma_f32_16x16x32_bf16 v[156:159], v[60:63], v[92:95], v[156:159]
    s_waitcnt lgkmcnt(3)
    ds_read_b64_tr_b16 v[60:61], v18 offset:8192
    ds_read_b64_tr_b16 v[62:63], v18 offset:9216
    v_mfma_f32_16x16x32_bf16 v[160:163], v[40:43], v[64:67], v[160:163]
    buffer_store_dwordx4 v[32:35], v1, s[36:39], s72 offen sc1
    v_mfma_f32_16x16x32_bf16 v[160:163], v[44:47], v[68:71], v[160:163]
    v_add_u32 v18, 0xfffe0000, v18
    v_mfma_f32_16x16x32_bf16 v[164:167], v[40:43], v[72:75], v[164:167]
    v_mfma_f32_16x16x32_bf16 v[164:167], v[44:47], v[76:79], v[164:167]
    s_add_u32 m0, s69, 81920
    v_accvgpr_read_b32 v32, a248
    v_accvgpr_read_b32 v31, a249
    v_mfma_f32_16x16x32_bf16 v[168:171], v[40:43], v[80:83], v[168:171]
    s_xor_b32 s60, s60, 524288
    buffer_load_dwordx4 v10, s[20:23], s64 offen lds
    v_mfma_f32_16x16x32_bf16 v[168:171], v[44:47], v[84:87], v[168:171]
    s_mov_b32 s60, 131072
    v_cvt_pk_bf16_f32 v32, v32, v31
    v_accvgpr_read_b32 v33, a250
    v_mfma_f32_16x16x32_bf16 v[172:175], v[40:43], v[88:91], v[172:175]
    ds_read_b64_tr_b16 v[40:41], v19 offset:0
    ds_read_b64_tr_b16 v[42:43], v19 offset:1024
    v_mfma_f32_16x16x32_bf16 v[172:175], v[44:47], v[92:95], v[172:175]
    ds_read_b64_tr_b16 v[44:45], v19 offset:8192
    ds_read_b64_tr_b16 v[46:47], v19 offset:9216
    v_mfma_f32_16x16x32_bf16 v[176:179], v[48:51], v[64:67], v[176:179]
    ds_read_b128 v[104:107], v24 offset:24576
    v_add_u32 v19, 0xfffe0000, v19
    v_mfma_f32_16x16x32_bf16 v[176:179], v[52:55], v[68:71], v[176:179]
    v_accvgpr_read_b32 v31, a251
    v_cvt_pk_bf16_f32 v33, v33, v31
    v_mfma_f32_16x16x32_bf16 v[180:183], v[48:51], v[72:75], v[180:183]
    v_accvgpr_read_b32 v34, a252
    v_accvgpr_read_b32 v31, a253
    v_mfma_f32_16x16x32_bf16 v[180:183], v[52:55], v[76:79], v[180:183]
    buffer_load_dwordx4 v11, s[20:23], s64 offen offset:1024 lds
    v_mfma_f32_16x16x32_bf16 v[184:187], v[48:51], v[80:83], v[184:187]
    v_cvt_pk_bf16_f32 v34, v34, v31
    v_accvgpr_read_b32 v35, a254
    v_mfma_f32_16x16x32_bf16 v[184:187], v[52:55], v[84:87], v[184:187]
    v_accvgpr_read_b32 v31, a255
    v_cvt_pk_bf16_f32 v35, v35, v31
    v_mfma_f32_16x16x32_bf16 v[188:191], v[48:51], v[88:91], v[188:191]
    s_add_u32 s72, s71, 39936
    ds_read_b64_tr_b16 v[48:49], v20 offset:0
    ds_read_b64_tr_b16 v[50:51], v20 offset:1024
    v_mfma_f32_16x16x32_bf16 v[188:191], v[52:55], v[92:95], v[188:191]
    s_waitcnt lgkmcnt(2)
    ds_read_b64_tr_b16 v[52:53], v20 offset:8192
    ds_read_b64_tr_b16 v[54:55], v20 offset:9216
    v_mfma_f32_16x16x32_bf16 v[192:195], v[56:59], v[64:67], v[192:195]
    v_mov_b32 v31, 1
    v_add_u32 v20, 0xfffe0000, v20
    v_mfma_f32_16x16x32_bf16 v[192:195], v[60:63], v[68:71], v[192:195]
    buffer_store_dwordx4 v[32:35], v1, s[36:39], s72 offen sc1
    v_mfma_f32_16x16x32_bf16 v[196:199], v[56:59], v[72:75], v[196:199]
    v_add_u32 v11, s99, v39
    v_mfma_f32_16x16x32_bf16 v[196:199], v[60:63], v[76:79], v[196:199]
    s_mul_i32 s99, s98, 6
    buffer_load_dwordx4 v12, s[20:23], s64 offen offset:2048 lds
    v_mfma_f32_16x16x32_bf16 v[200:203], v[56:59], v[80:83], v[200:203]
    s_sub_u32 s99, s8, s99
    ds_read_b128 v[108:111], v25 offset:24576
    v_mfma_f32_16x16x32_bf16 v[200:203], v[60:63], v[84:87], v[200:203]
    s_mul_i32 s99, s99, 6
    v_mfma_f32_16x16x32_bf16 v[204:207], v[56:59], v[88:91], v[204:207]
    s_lshr_b32 s8, s5, 3
    ds_read_b64_tr_b16 v[56:57], v21 offset:0
    ds_read_b64_tr_b16 v[58:59], v21 offset:1024
    v_mfma_f32_16x16x32_bf16 v[204:207], v[60:63], v[92:95], v[204:207]
    s_lshl1_add_u32 s99, s4, s99
    ds_read_b64_tr_b16 v[60:61], v21 offset:8192
    ds_read_b64_tr_b16 v[62:63], v21 offset:9216
    v_mfma_f32_16x16x32_bf16 v[208:211], v[40:43], v[64:67], v[208:211]
    s_mul_i32 s8, s8, 6
    v_add_u32 v21, 0xfffe0000, v21
    v_mfma_f32_16x16x32_bf16 v[208:211], v[44:47], v[68:71], v[208:211]
    s_cmp_lt_u32 s98, 6
    s_cselect_b32 s98, s98, 40
    v_mfma_f32_16x16x32_bf16 v[212:215], v[40:43], v[72:75], v[212:215]
    s_sub_u32 s99, s99, 2
    buffer_load_dwordx4 v13, s[20:23], s64 offen offset:3072 lds
    v_mfma_f32_16x16x32_bf16 v[212:215], v[44:47], v[76:79], v[212:215]
    s_add_u32 s98, s98, s8
    v_mfma_f32_16x16x32_bf16 v[216:219], v[40:43], v[80:83], v[216:219]
    s_lshl_b32 s8, s99, 5
    v_lshl_add_u32 v10, v38, 4, s8
    v_lshrrev_b32 v38, 2, v37
    v_mfma_f32_16x16x32_bf16 v[216:219], v[44:47], v[84:87], v[216:219]
    v_lshl_add_u32 v38, s98, 2, v38
    v_mul_u32_u24 v39, 171, v38
    v_mfma_f32_16x16x32_bf16 v[220:223], v[40:43], v[88:91], v[220:223]
    s_add_u32 s98, s98, 128
    ds_read_b64_tr_b16 v[40:41], v26 offset:0
    ds_read_b64_tr_b16 v[42:43], v26 offset:512
    v_mfma_f32_16x16x32_bf16 v[220:223], v[44:47], v[92:95], v[220:223]
    s_mul_i32 s98, s98, 36
    ds_read_b64_tr_b16 v[44:45], v26 offset:4096
    ds_read_b64_tr_b16 v[46:47], v26 offset:4608
    s_waitcnt lgkmcnt(4)
    v_mfma_f32_16x16x32_bf16 v[224:227], v[48:51], v[64:67], v[224:227]
    s_add_u32 s98, s98, s99
    v_add_u32 v26, 0x10000, v26
    v_and_b32 v37, 3, v37
    v_mfma_f32_16x16x32_bf16 v[224:227], v[52:55], v[68:71], v[224:227]
    s_xor_b32 s64, s64, 128
    v_lshrrev_b32 v39, 9, v39
    v_lshl_add_u32 v37, v38, 3, v37
    v_mfma_f32_16x16x32_bf16 v[228:231], v[48:51], v[72:75], v[228:231]
    s_lshl_b32 s99, s100, 14
    v_mul_u32_u24 v38, 24, v39
    v_sub_u32 v37, v37, v38
    v_mfma_f32_16x16x32_bf16 v[228:231], v[52:55], v[76:79], v[228:231]
    s_add_u32 s99, s99, s69
    v_mad_u32_u24 v39, v39, 18, v37
    v_mul_u32_u24 v39, 1152, v39
    v_mfma_f32_16x16x32_bf16 v[232:235], v[48:51], v[80:83], v[232:235]
    s_add_u32 s63, s7, s99
    v_add_u32 v39, v39, v10
    v_add_u32 v12, 0, v39
    v_mfma_f32_16x16x32_bf16 v[232:235], v[52:55], v[84:87], v[232:235]
    s_add_u32 m0, s67, 98304
    v_mov_b32 v38, 1073741824
    v_cmp_gt_u32 vcc, 18, v37
    v_mfma_f32_16x16x32_bf16 v[236:239], v[48:51], v[88:91], v[236:239]
    s_lshl_b32 s99, s100, 11
    buffer_load_dwordx4 v1, s[28:31], s65 offen sc1 lds
    v_mfma_f32_16x16x32_bf16 v[236:239], v[52:55], v[92:95], v[236:239]
    s_add_u32 s7, s7, s99
    ds_read_b64_tr_b16 v[48:49], v27 offset:0
    ds_read_b64_tr_b16 v[50:51], v27 offset:512
    v_mfma_f32_16x16x32_bf16 v[240:243], v[56:59], v[64:67], v[240:243]
    s_lshl_b32 s64, s98, 10
    ds_read_b64_tr_b16 v[52:53], v27 offset:4096
    ds_read_b64_tr_b16 v[54:55], v27 offset:4608
    v_mfma_f32_16x16x32_bf16 v[240:243], v[60:63], v[68:71], v[240:243]
    s_add_u32 s7, s7, 32768
    v_add_u32 v27, 0x10000, v27
    v_cndmask_b32 v12, v38, v12, vcc
    v_mfma_f32_16x16x32_bf16 v[244:247], v[56:59], v[72:75], v[244:247]
    v_add_u32 v38, 1024, v36
    v_add_u32 v13, 4608, v39
    v_mfma_f32_16x16x32_bf16 v[244:247], v[60:63], v[76:79], v[244:247]
    s_cmp_eq_u32 s4, 0
    s_cselect_b64 vcc, -1, 0
    v_cndmask_b32 v12, v12, v38, vcc
    v_mfma_f32_16x16x32_bf16 v[248:251], v[56:59], v[80:83], v[248:251]
    v_mov_b32 v38, 1073741824
    v_cmp_gt_u32 vcc, 14, v37
    v_mfma_f32_16x16x32_bf16 v[248:251], v[60:63], v[84:87], v[248:251]
    v_lshrrev_b32 v37, 8, v1
    v_cndmask_b32 v13, v38, v13, vcc
    v_mfma_f32_16x16x32_bf16 v[252:255], v[56:59], v[88:91], v[252:255]
    ds_read_b64_tr_b16 v[56:57], v28 offset:0
    ds_read_b64_tr_b16 v[58:59], v28 offset:512
    v_mfma_f32_16x16x32_bf16 v[252:255], v[60:63], v[92:95], v[252:255]
    s_waitcnt lgkmcnt(2)
    ds_read_b64_tr_b16 v[60:61], v28 offset:4096
    ds_read_b64_tr_b16 v[62:63], v28 offset:4608
    v_mfma_f32_16x16x32_bf16 a[64:67], v[40:43], v[64:67], a[64:67]
    buffer_load_dwordx4 v1, s[28:31], s65 offen offset:1024 sc1 lds
    v_mfma_f32_16x16x32_bf16 a[64:67], v[44:47], v[68:71], a[64:67]
    v_add_u32 v24, 0xfffe0000, v24
    v_add_u32 v28, 0x10000, v28
    v_mfma_f32_16x16x32_bf16 a[68:71], v[40:43], v[72:75], a[68:71]
    ds_read_b128 v[112:115], v24 offset:16384
    v_add_u32 v38, 19456, v36
    v_mfma_f32_16x16x32_bf16 a[68:71], v[44:47], v[76:79], a[68:71]
    s_cmp_eq_u32 s4, 0
    s_cselect_b64 vcc, -1, 0
    v_cndmask_b32 v13, v13, v38, vcc
    v_mfma_f32_16x16x32_bf16 a[72:75], v[40:43], v[80:83], a[72:75]
    v_bfe_u32 v36, v1, 4, 4
    v_lshlrev_b32 v37, 2, v37
    v_mfma_f32_16x16x32_bf16 a[72:75], v[44:47], v[84:87], a[72:75]
    v_add_u32 v25, 0xfffe0000, v25
    v_sub_u32 v36, v36, v37
    v_mfma_f32_16x16x32_bf16 a[76:79], v[40:43], v[88:91], a[76:79]
    s_lshr_b32 s92, s2, 3
    ds_read_b128 v[116:119], v25 offset:16384
    v_lshrrev_b32 v9, 4, v1
    v_mfma_f32_16x16x32_bf16 a[76:79], v[44:47], v[92:95], a[76:79]
    s_lshl2_add_u32 s92, s92, s4
    v_min_u32 v9, 0, v9
    v_mov_b32 v37, 0xf149f2ca
    v_mfma_f32_16x16x32_bf16 a[128:131], v[40:43], a[136:139], a[128:131]
    s_mul_i32 s92, s92, 1
    ds_read_b64_tr_b16 v[40:41], v29 offset:0
    ds_read_b64_tr_b16 v[42:43], v29 offset:512
    v_mfma_f32_16x16x32_bf16 a[128:131], v[44:47], a[140:143], a[128:131]
    s_add_u32 s92, s92, 32
    v_add_lshl_u32 v9, v9, s92, 7
    ds_read_b64_tr_b16 v[44:45], v29 offset:4096
    v_mfma_f32_16x16x32_bf16 a[80:83], v[48:51], v[64:67], a[80:83]
    s_add_u32 m0, s68, 106496
    ds_read_b128 v[120:123], v24 offset:24576
    ds_read_b64_tr_b16 v[46:47], v29 offset:4608
    v_mfma_f32_16x16x32_bf16 a[80:83], v[52:55], v[68:71], a[80:83]
    s_getpc_b64 s[92:93]
    global_load_dword v9, v9, s[92:93]
    v_mfma_f32_16x16x32_bf16 a[84:87], v[48:51], v[72:75], a[84:87]
    buffer_load_dwordx4 v6, s[20:23], s66 offen lds
    v_mfma_f32_16x16x32_bf16 a[84:87], v[52:55], v[76:79], a[84:87]
    v_add_u32 v29, 0x10000, v29
    v_bfe_u32 v38, v1, 4, 2
    v_mfma_f32_16x16x32_bf16 a[88:91], v[48:51], v[80:83], a[88:91]
    ds_read_b128 v[124:127], v25 offset:24576
    v_mfma_f32_16x16x32_bf16 a[88:91], v[52:55], v[84:87], a[88:91]
    s_cmp_eq_u32 s4, 0
    s_cselect_b32 s8, 1.0, 0
    v_mfma_f32_16x16x32_bf16 a[92:95], v[48:51], v[88:91], a[92:95]
    s_cmp_eq_u32 s6, 0
    s_cselect_b32 s16, s8, 0
    s_cselect_b32 s17, s9, 0
    v_mfma_f32_16x16x32_bf16 a[92:95], v[52:55], v[92:95], a[92:95]
    s_cmp_eq_u32 s4, 0
    s_cselect_b32 s64, s7, s64
    v_mfma_f32_16x16x32_bf16 a[132:135], v[48:51], a[136:139], a[132:135]
    v_mfma_f32_16x16x32_bf16 a[132:135], v[52:55], a[140:143], a[132:135]
    s_waitcnt lgkmcnt(0)
    v_mfma_f32_16x16x32_bf16 a[96:99], v[56:59], v[64:67], a[96:99]
    v_mfma_f32_16x16x32_bf16 a[96:99], v[60:63], v[68:71], a[96:99]
    s_xor_b32 s65, s65, 122880
    v_mfma_f32_16x16x32_bf16 a[100:103], v[56:59], v[72:75], a[100:103]
    s_xor_b32 s66, s66, 1920
    v_mfma_f32_16x16x32_bf16 a[100:103], v[60:63], v[76:79], a[100:103]
    s_andn2_b32 s65, s65, 57344
    v_mfma_f32_16x16x32_bf16 a[104:107], v[56:59], v[80:83], a[104:107]
    s_andn2_b32 s66, s66, 896
    v_mfma_f32_16x16x32_bf16 a[104:107], v[60:63], v[84:87], a[104:107]
    s_waitcnt vmcnt(4) lgkmcnt(0)
    s_barrier
    ds_read_b64_tr_b16 v[48:49], v14 offset:32768
    v_mfma_f32_16x16x32_bf16 a[108:111], v[56:59], v[88:91], a[108:111]
    s_add_u32 m0, s67, 131072
    buffer_store_dword v31, v30, s[32:35], s101 offen sc1
    v_mfma_f32_16x16x32_bf16 a[108:111], v[60:63], v[92:95], a[108:111]
    buffer_load_dwordx4 v1, s[28:31], s65 offen sc1 lds
    v_mfma_f32_16x16x32_bf16 a[112:115], v[40:43], v[64:67], a[112:115]
    ds_read_b64_tr_b16 v[50:51], v14 offset:33792
    ds_read_b64_tr_b16 v[52:53], v14 offset:40960
    v_mfma_f32_16x16x32_bf16 a[112:115], v[44:47], v[68:71], a[112:115]
    ds_read_b64_tr_b16 v[54:55], v14 offset:41984
    ds_read_b64_tr_b16 v[56:57], v15 offset:32768
    v_mfma_f32_16x16x32_bf16 a[116:119], v[40:43], v[72:75], a[116:119]
    ds_read_b64_tr_b16 v[58:59], v15 offset:33792
    ds_read_b64_tr_b16 v[60:61], v15 offset:40960
    v_mfma_f32_16x16x32_bf16 a[116:119], v[44:47], v[76:79], a[116:119]
    ds_read_b64_tr_b16 v[62:63], v15 offset:41984
    v_add_u32 v14, 0x10000, v14
    v_mfma_f32_16x16x32_bf16 a[120:123], v[40:43], v[80:83], a[120:123]
    v_add_u32 v15, 0x10000, v15
    v_mfma_f32_16x16x32_bf16 a[120:123], v[44:47], v[84:87], a[120:123]
    v_mfma_f32_16x16x32_bf16 a[124:127], v[40:43], v[88:91], a[124:127]
    ds_read_b64_tr_b16 v[40:41], v16 offset:32768
    ds_read_b64_tr_b16 v[42:43], v16 offset:33792
    v_mfma_f32_16x16x32_bf16 a[124:127], v[44:47], v[92:95], a[124:127]
    s_waitcnt lgkmcnt(3)
    ds_read_b64_tr_b16 v[44:45], v16 offset:40960
    ds_read_b64_tr_b16 v[46:47], v16 offset:41984
    v_mfma_f32_16x16x32_bf16 v[128:131], v[48:51], v[96:99], v[128:131]
    v_add_u32 v16, 0x10000, v16
    v_mfma_f32_16x16x32_bf16 v[128:131], v[52:55], v[100:103], v[128:131]
    v_mfma_f32_16x16x32_bf16 v[132:135], v[48:51], v[104:107], v[132:135]
    ds_read_b128 v[64:67], v24 offset:49152
    v_mfma_f32_16x16x32_bf16 v[132:135], v[52:55], v[108:111], v[132:135]
    v_mfma_f32_16x16x32_bf16 v[136:139], v[48:51], v[112:115], v[136:139]
    v_mfma_f32_16x16x32_bf16 v[136:139], v[52:55], v[116:119], v[136:139]
    v_mfma_f32_16x16x32_bf16 v[140:143], v[48:51], v[120:123], v[140:143]
    ds_read_b64_tr_b16 v[48:49], v17 offset:32768
    ds_read_b64_tr_b16 v[50:51], v17 offset:33792
    v_mfma_f32_16x16x32_bf16 v[140:143], v[52:55], v[124:127], v[140:143]
    ds_read_b64_tr_b16 v[52:53], v17 offset:40960
    ds_read_b64_tr_b16 v[54:55], v17 offset:41984
    v_mfma_f32_16x16x32_bf16 v[144:147], v[56:59], v[96:99], v[144:147]
    s_waitcnt lgkmcnt(4)
    ds_read_b128 v[68:71], v25 offset:49152
    v_add_u32 v17, 0x10000, v17
    v_mfma_f32_16x16x32_bf16 v[144:147], v[60:63], v[100:103], v[144:147]
    v_mfma_f32_16x16x32_bf16 v[148:151], v[56:59], v[104:107], v[148:151]
    buffer_load_dwordx4 v1, s[28:31], s65 offen offset:1024 sc1 lds
    v_mfma_f32_16x16x32_bf16 v[148:151], v[60:63], v[108:111], v[148:151]
    v_mfma_f32_16x16x32_bf16 v[152:155], v[56:59], v[112:115], v[152:155]
    v_mfma_f32_16x16x32_bf16 v[152:155], v[60:63], v[116:119], v[152:155]
    v_mfma_f32_16x16x32_bf16 v[156:159], v[56:59], v[120:123], v[156:159]
    ds_read_b128 v[72:75], v24 offset:57344
    ds_read_b64_tr_b16 v[56:57], v18 offset:32768
    v_mfma_f32_16x16x32_bf16 v[156:159], v[60:63], v[124:127], v[156:159]
    ds_read_b64_tr_b16 v[58:59], v18 offset:33792
    ds_read_b64_tr_b16 v[60:61], v18 offset:40960
    v_mfma_f32_16x16x32_bf16 v[160:163], v[40:43], v[96:99], v[160:163]
    ds_read_b64_tr_b16 v[62:63], v18 offset:41984
    v_add_u32 v18, 0x10000, v18
    v_mfma_f32_16x16x32_bf16 v[160:163], v[44:47], v[100:103], v[160:163]
    v_mfma_f32_16x16x32_bf16 v[164:167], v[40:43], v[104:107], v[164:167]
    v_mfma_f32_16x16x32_bf16 v[164:167], v[44:47], v[108:111], v[164:167]
    v_mfma_f32_16x16x32_bf16 v[168:171], v[40:43], v[112:115], v[168:171]
    ds_read_b128 v[76:79], v25 offset:57344
    v_mfma_f32_16x16x32_bf16 v[168:171], v[44:47], v[116:119], v[168:171]
    v_mfma_f32_16x16x32_bf16 v[172:175], v[40:43], v[120:123], v[172:175]
    ds_read_b64_tr_b16 v[40:41], v19 offset:32768
    ds_read_b64_tr_b16 v[42:43], v19 offset:33792
    v_mfma_f32_16x16x32_bf16 v[172:175], v[44:47], v[124:127], v[172:175]
    s_waitcnt lgkmcnt(3)
    ds_read_b64_tr_b16 v[44:45], v19 offset:40960
    ds_read_b64_tr_b16 v[46:47], v19 offset:41984
    v_mfma_f32_16x16x32_bf16 v[176:179], v[48:51], v[96:99], v[176:179]
    v_add_u32 v19, 0x10000, v19
    v_mfma_f32_16x16x32_bf16 v[176:179], v[52:55], v[100:103], v[176:179]
    v_mfma_f32_16x16x32_bf16 v[180:183], v[48:51], v[104:107], v[180:183]
    v_mfma_f32_16x16x32_bf16 v[180:183], v[52:55], v[108:111], v[180:183]
    v_add_u32 v24, 0x10000, v24
    v_mfma_f32_16x16x32_bf16 v[184:187], v[48:51], v[112:115], v[184:187]
    ds_read_b128 v[80:83], v24 offset:16384
    v_mfma_f32_16x16x32_bf16 v[184:187], v[52:55], v[116:119], v[184:187]
    s_add_u32 m0, s68, 139264
    v_mfma_f32_16x16x32_bf16 v[188:191], v[48:51], v[120:123], v[188:191]
    buffer_load_dwordx4 v6, s[20:23], s66 offen lds
    v_mfma_f32_16x16x32_bf16 v[188:191], v[52:55], v[124:127], v[188:191]
    ds_read_b64_tr_b16 v[48:49], v20 offset:32768
    ds_read_b64_tr_b16 v[50:51], v20 offset:33792
    v_mfma_f32_16x16x32_bf16 v[192:195], v[56:59], v[96:99], v[192:195]
    ds_read_b64_tr_b16 v[52:53], v20 offset:40960
    ds_read_b64_tr_b16 v[54:55], v20 offset:41984
    v_mfma_f32_16x16x32_bf16 v[192:195], v[60:63], v[100:103], v[192:195]
    v_add_u32 v25, 0x10000, v25
    v_add_u32 v20, 0x10000, v20
    v_mfma_f32_16x16x32_bf16 v[196:199], v[56:59], v[104:107], v[196:199]
    ds_read_b128 v[84:87], v25 offset:16384
    v_mfma_f32_16x16x32_bf16 v[196:199], v[60:63], v[108:111], v[196:199]
    s_cmp_eq_u32 s6, 0
    s_cselect_b32 s20, s12, 0
    s_cselect_b32 s21, s13, 0
    v_mfma_f32_16x16x32_bf16 v[200:203], v[56:59], v[112:115], v[200:203]
    s_cmp_eq_u32 s6, 0
    s_cselect_b32 s22, s14, 0
    s_cselect_b32 s23, s15, 0
    v_mfma_f32_16x16x32_bf16 v[200:203], v[60:63], v[116:119], v[200:203]
    v_mfma_f32_16x16x32_bf16 v[204:207], v[56:59], v[120:123], v[204:207]
    ds_read_b64_tr_b16 v[56:57], v21 offset:32768
    ds_read_b64_tr_b16 v[58:59], v21 offset:33792
    v_mfma_f32_16x16x32_bf16 v[204:207], v[60:63], v[124:127], v[204:207]
    s_waitcnt lgkmcnt(2)
    ds_read_b64_tr_b16 v[60:61], v21 offset:40960
    ds_read_b64_tr_b16 v[62:63], v21 offset:41984
    v_mfma_f32_16x16x32_bf16 v[208:211], v[40:43], v[96:99], v[208:211]
    ds_read_b128 v[88:91], v24 offset:24576
    v_add_u32 v21, 0x10000, v21
    v_mfma_f32_16x16x32_bf16 v[208:211], v[44:47], v[100:103], v[208:211]
    v_mfma_f32_16x16x32_bf16 v[212:215], v[40:43], v[104:107], v[212:215]
    v_mfma_f32_16x16x32_bf16 v[212:215], v[44:47], v[108:111], v[212:215]
    v_mfma_f32_16x16x32_bf16 v[216:219], v[40:43], v[112:115], v[216:219]
    v_mfma_f32_16x16x32_bf16 v[216:219], v[44:47], v[116:119], v[216:219]
    v_mfma_f32_16x16x32_bf16 v[220:223], v[40:43], v[120:123], v[220:223]
    ds_read_b128 v[92:95], v25 offset:24576
    ds_read_b64_tr_b16 v[40:41], v14 offset:0
    v_mfma_f32_16x16x32_bf16 v[220:223], v[44:47], v[124:127], v[220:223]
    ds_read_b64_tr_b16 v[42:43], v14 offset:1024
    ds_read_b64_tr_b16 v[44:45], v14 offset:8192
    v_mfma_f32_16x16x32_bf16 v[224:227], v[48:51], v[96:99], v[224:227]
    ds_read_b64_tr_b16 v[46:47], v14 offset:9216
    v_mfma_f32_16x16x32_bf16 v[224:227], v[52:55], v[100:103], v[224:227]
    s_xor_b32 s65, s65, 8192
    v_mfma_f32_16x16x32_bf16 v[228:231], v[48:51], v[104:107], v[228:231]
    s_xor_b32 s66, s66, 128
    v_mfma_f32_16x16x32_bf16 v[228:231], v[52:55], v[108:111], v[228:231]
    v_mfma_f32_16x16x32_bf16 v[232:235], v[48:51], v[112:115], v[232:235]
    v_mfma_f32_16x16x32_bf16 v[232:235], v[52:55], v[116:119], v[232:235]
    v_mfma_f32_16x16x32_bf16 v[236:239], v[48:51], v[120:123], v[236:239]
    ds_read_b64_tr_b16 v[48:49], v15 offset:0
    ds_read_b64_tr_b16 v[50:51], v15 offset:1024
    v_mfma_f32_16x16x32_bf16 v[236:239], v[52:55], v[124:127], v[236:239]
    s_waitcnt lgkmcnt(2)
    ds_read_b64_tr_b16 v[52:53], v15 offset:8192
    ds_read_b64_tr_b16 v[54:55], v15 offset:9216
    v_mfma_f32_16x16x32_bf16 v[240:243], v[56:59], v[96:99], v[240:243]
    v_mfma_f32_16x16x32_bf16 v[240:243], v[60:63], v[100:103], v[240:243]
    v_mfma_f32_16x16x32_bf16 v[244:247], v[56:59], v[104:107], v[244:247]
    v_mfma_f32_16x16x32_bf16 v[244:247], v[60:63], v[108:111], v[244:247]
    v_mfma_f32_16x16x32_bf16 v[248:251], v[56:59], v[112:115], v[248:251]
    v_mfma_f32_16x16x32_bf16 v[248:251], v[60:63], v[116:119], v[248:251]
    v_mfma_f32_16x16x32_bf16 v[252:255], v[56:59], v[120:123], v[252:255]
    ds_read_b64_tr_b16 v[56:57], v16 offset:0
    ds_read_b64_tr_b16 v[58:59], v16 offset:1024
    v_mfma_f32_16x16x32_bf16 v[252:255], v[60:63], v[124:127], v[252:255]
    buffer_load_dword v7, v8, s[32:35], s61 offen sc1
    v_mfma_f32_16x16x32_bf16 v[128:131], v[40:43], v[64:67], v[128:131]
    ds_read_b64_tr_b16 v[60:61], v16 offset:8192
    ds_read_b64_tr_b16 v[62:63], v16 offset:9216
    v_mfma_f32_16x16x32_bf16 v[128:131], v[44:47], v[68:71], v[128:131]
    v_mfma_f32_16x16x32_bf16 v[132:135], v[40:43], v[72:75], v[132:135]
    v_mfma_f32_16x16x32_bf16 v[132:135], v[44:47], v[76:79], v[132:135]
    v_mfma_f32_16x16x32_bf16 v[136:139], v[40:43], v[80:83], v[136:139]
    v_mfma_f32_16x16x32_bf16 v[136:139], v[44:47], v[84:87], v[136:139]
    v_mfma_f32_16x16x32_bf16 v[140:143], v[40:43], v[88:91], v[140:143]
    ds_read_b64_tr_b16 v[40:41], v17 offset:0
    ds_read_b64_tr_b16 v[42:43], v17 offset:1024
    v_mfma_f32_16x16x32_bf16 v[140:143], v[44:47], v[92:95], v[140:143]
    s_waitcnt lgkmcnt(2)
    ds_read_b64_tr_b16 v[44:45], v17 offset:8192
    ds_read_b64_tr_b16 v[46:47], v17 offset:9216
    v_mfma_f32_16x16x32_bf16 v[144:147], v[48:51], v[64:67], v[144:147]
    v_cvt_pk_bf16_f32 v128, v128, v129
    v_cvt_pk_bf16_f32 v129, v130, v131
    v_mfma_f32_16x16x32_bf16 v[144:147], v[52:55], v[68:71], v[144:147]
    v_cvt_pk_bf16_f32 v132, v132, v133
    v_cvt_pk_bf16_f32 v133, v134, v135
    v_mfma_f32_16x16x32_bf16 v[148:151], v[48:51], v[72:75], v[148:151]
    v_cvt_pk_bf16_f32 v136, v136, v137
    v_cvt_pk_bf16_f32 v137, v138, v139
    v_mfma_f32_16x16x32_bf16 v[148:151], v[52:55], v[76:79], v[148:151]
    v_cvt_pk_bf16_f32 v140, v140, v141
    v_cvt_pk_bf16_f32 v141, v142, v143
    v_mfma_f32_16x16x32_bf16 v[152:155], v[48:51], v[80:83], v[152:155]
    v_cvt_pk_bf16_f32 v130, v144, v145
    v_cvt_pk_bf16_f32 v131, v146, v147
    v_mfma_f32_16x16x32_bf16 v[152:155], v[52:55], v[84:87], v[152:155]
    v_mfma_f32_16x16x32_bf16 v[156:159], v[48:51], v[88:91], v[156:159]
    ds_read_b64_tr_b16 v[48:49], v18 offset:0
    ds_read_b64_tr_b16 v[50:51], v18 offset:1024
    v_mfma_f32_16x16x32_bf16 v[156:159], v[52:55], v[92:95], v[156:159]
    ds_read_b64_tr_b16 v[52:53], v18 offset:8192
    ds_read_b64_tr_b16 v[54:55], v18 offset:9216
    v_mfma_f32_16x16x32_bf16 v[160:163], v[56:59], v[64:67], v[160:163]
    v_cvt_pk_bf16_f32 v134, v148, v149
    v_cvt_pk_bf16_f32 v135, v150, v151
    v_mfma_f32_16x16x32_bf16 v[160:163], v[60:63], v[68:71], v[160:163]
    v_cvt_pk_bf16_f32 v138, v152, v153
    v_cvt_pk_bf16_f32 v139, v154, v155
    v_mfma_f32_16x16x32_bf16 v[164:167], v[56:59], v[72:75], v[164:167]
    v_cvt_pk_bf16_f32 v142, v156, v157
    v_cvt_pk_bf16_f32 v143, v158, v159
    v_mfma_f32_16x16x32_bf16 v[164:167], v[60:63], v[76:79], v[164:167]
    v_mfma_f32_16x16x32_bf16 v[168:171], v[56:59], v[80:83], v[168:171]
    v_mfma_f32_16x16x32_bf16 v[168:171], v[60:63], v[84:87], v[168:171]
    v_cvt_pk_bf16_f32 v160, v160, v161
    v_cvt_pk_bf16_f32 v161, v162, v163
    v_mfma_f32_16x16x32_bf16 v[172:175], v[56:59], v[88:91], v[172:175]
    ds_read_b64_tr_b16 v[56:57], v19 offset:0
    ds_read_b64_tr_b16 v[58:59], v19 offset:1024
    v_mfma_f32_16x16x32_bf16 v[172:175], v[60:63], v[92:95], v[172:175]
    s_waitcnt lgkmcnt(2)
    ds_read_b64_tr_b16 v[60:61], v19 offset:8192
    ds_read_b64_tr_b16 v[62:63], v19 offset:9216
    v_mfma_f32_16x16x32_bf16 v[176:179], v[40:43], v[64:67], v[176:179]
    v_cvt_pk_bf16_f32 v164, v164, v165
    v_cvt_pk_bf16_f32 v165, v166, v167
    v_mfma_f32_16x16x32_bf16 v[176:179], v[44:47], v[68:71], v[176:179]
    v_cvt_pk_bf16_f32 v168, v168, v169
    v_cvt_pk_bf16_f32 v169, v170, v171
    v_mfma_f32_16x16x32_bf16 v[180:183], v[40:43], v[72:75], v[180:183]
    v_cvt_pk_bf16_f32 v172, v172, v173
    v_cvt_pk_bf16_f32 v173, v174, v175
    v_mfma_f32_16x16x32_bf16 v[180:183], v[44:47], v[76:79], v[180:183]
    v_mfma_f32_16x16x32_bf16 v[184:187], v[40:43], v[80:83], v[184:187]
    v_mfma_f32_16x16x32_bf16 v[184:187], v[44:47], v[84:87], v[184:187]
    v_cvt_pk_bf16_f32 v162, v176, v177
    v_cvt_pk_bf16_f32 v163, v178, v179
    v_mfma_f32_16x16x32_bf16 v[188:191], v[40:43], v[88:91], v[188:191]
    ds_read_b64_tr_b16 v[40:41], v20 offset:0
    ds_read_b64_tr_b16 v[42:43], v20 offset:1024
    v_mfma_f32_16x16x32_bf16 v[188:191], v[44:47], v[92:95], v[188:191]
    ds_read_b64_tr_b16 v[44:45], v20 offset:8192
    ds_read_b64_tr_b16 v[46:47], v20 offset:9216
    v_mfma_f32_16x16x32_bf16 v[192:195], v[48:51], v[64:67], v[192:195]
    v_cvt_pk_bf16_f32 v166, v180, v181
    v_cvt_pk_bf16_f32 v167, v182, v183
    v_mfma_f32_16x16x32_bf16 v[192:195], v[52:55], v[68:71], v[192:195]
    v_cvt_pk_bf16_f32 v170, v184, v185
    v_cvt_pk_bf16_f32 v171, v186, v187
    s_waitcnt vmcnt(0)
    v_cmp_gt_u32 vcc, 1, v7
    s_nop 1
    s_and_b64 vcc, vcc, exec
    s_cbranch_scc1 SPIN_KV
BACK_KV:
    v_mfma_f32_16x16x32_bf16 v[196:199], v[48:51], v[72:75], v[196:199]
    s_mov_b32 s77, s75
    buffer_load_dwordx4 a[224:227], v1, s[36:39], 0 offen offset:0 sc1
    v_mfma_f32_16x16x32_bf16 v[196:199], v[52:55], v[76:79], v[196:199]
    buffer_load_dwordx4 a[228:231], v1, s[36:39], 0 offen offset:1024 sc1
    v_mfma_f32_16x16x32_bf16 v[200:203], v[48:51], v[80:83], v[200:203]
    v_cmp_le_i32 vcc, 0, v36
    v_cvt_pk_bf16_f32 v192, v192, v193
    v_mfma_f32_16x16x32_bf16 v[200:203], v[52:55], v[84:87], v[200:203]
    v_cvt_pk_bf16_f32 v193, v194, v195
    v_cvt_pk_bf16_f32 v174, v188, v189
    v_mfma_f32_16x16x32_bf16 v[204:207], v[48:51], v[88:91], v[204:207]
    buffer_load_dwordx4 a[232:235], v1, s[36:39], 0 offen offset:2048 sc1
    v_mfma_f32_16x16x32_bf16 v[204:207], v[52:55], v[92:95], v[204:207]
    s_waitcnt lgkmcnt(0)
    ds_read_b64_tr_b16 v[48:49], v21 offset:0
    ds_read_b64_tr_b16 v[50:51], v21 offset:1024
    v_mfma_f32_16x16x32_bf16 v[208:211], v[56:59], v[64:67], v[208:211]
    ds_read_b64_tr_b16 v[52:53], v21 offset:8192
    ds_read_b64_tr_b16 v[54:55], v21 offset:9216
    v_mfma_f32_16x16x32_bf16 v[208:211], v[60:63], v[68:71], v[208:211]
    v_cvt_pk_bf16_f32 v196, v196, v197
    v_cvt_pk_bf16_f32 v197, v198, v199
    v_mfma_f32_16x16x32_bf16 v[212:215], v[56:59], v[72:75], v[212:215]
    buffer_load_dwordx4 a[236:239], v1, s[36:39], 0 offen offset:3072 sc1
    v_mfma_f32_16x16x32_bf16 v[212:215], v[60:63], v[76:79], v[212:215]
    v_cvt_pk_bf16_f32 v200, v200, v201
    v_cvt_pk_bf16_f32 v201, v202, v203
    v_mfma_f32_16x16x32_bf16 v[216:219], v[56:59], v[80:83], v[216:219]
    v_cvt_pk_bf16_f32 v194, v208, v209
    v_cndmask_b32_e64 v208, v37, 0, vcc
    v_mfma_f32_16x16x32_bf16 v[216:219], v[60:63], v[84:87], v[216:219]
    v_mul_f32 v176, s16, v208
    v_cmp_le_i32 vcc, 1, v36
    v_mfma_f32_16x16x32_bf16 v[220:223], v[56:59], v[88:91], v[220:223]
    v_cvt_pk_bf16_f32 v195, v210, v211
    v_cndmask_b32_e64 v209, v37, 0, vcc
    v_mfma_f32_16x16x32_bf16 v[220:223], v[60:63], v[92:95], v[220:223]
    v_mul_f32 v177, s16, v209
    v_cmp_le_i32 vcc, 2, v36
    v_mfma_f32_16x16x32_bf16 v[224:227], v[40:43], v[64:67], v[224:227]
    s_mov_b32 s38, 16384
    v_cndmask_b32_e64 v210, v37, 0, vcc
    v_mul_f32 v178, s16, v210
    v_mfma_f32_16x16x32_bf16 v[224:227], v[44:47], v[68:71], v[224:227]
    s_add_u32 m0, s76, s75
    v_cmp_le_i32 vcc, 3, v36
    v_cvt_pk_bf16_f32 v198, v212, v213
    v_mfma_f32_16x16x32_bf16 v[228:231], v[40:43], v[72:75], v[228:231]
    buffer_load_dwordx4 v1, s[36:39], s77 offen sc1 lds
    v_mfma_f32_16x16x32_bf16 v[228:231], v[44:47], v[76:79], v[228:231]
    v_cndmask_b32_e64 v211, v37, 0, vcc
    v_mul_f32 v179, s16, v211
    v_mfma_f32_16x16x32_bf16 v[232:235], v[40:43], v[80:83], v[232:235]
    v_cvt_pk_bf16_f32 v224, v224, v225
    v_cvt_pk_bf16_f32 v225, v226, v227
    v_mfma_f32_16x16x32_bf16 v[232:235], v[44:47], v[84:87], v[232:235]
    s_waitcnt vmcnt(6) lgkmcnt(0)
    s_barrier
    ds_read_b64_tr_b16 v[56:57], v26 offset:32768
    v_mfma_f32_16x16x32_bf16 v[236:239], v[40:43], v[88:91], v[236:239]
    buffer_load_dwordx4 v1, s[36:39], s77 offen offset:1024 sc1 lds
    v_mfma_f32_16x16x32_bf16 v[236:239], v[44:47], v[92:95], v[236:239]
    ds_read_b64_tr_b16 v[58:59], v26 offset:33280
    ds_read_b64_tr_b16 v[60:61], v26 offset:36864
    v_mfma_f32_16x16x32_bf16 v[240:243], v[48:51], v[64:67], v[240:243]
    ds_read_b64_tr_b16 v[62:63], v26 offset:37376
    ds_read_b128 a[136:139], v22 offset:32768
    v_mfma_f32_16x16x32_bf16 v[240:243], v[52:55], v[68:71], v[240:243]
    ds_read_b128 a[140:143], v23 offset:32768
    v_add_u32 v26, 0x10000, v26
    v_mfma_f32_16x16x32_bf16 v[244:247], v[48:51], v[72:75], v[244:247]
    buffer_load_dwordx4 v1, s[36:39], s77 offen offset:2048 sc1 lds
    v_mfma_f32_16x16x32_bf16 v[244:247], v[52:55], v[76:79], v[244:247]
    ds_read_b64_tr_b16 v[40:41], v27 offset:32768
    ds_read_b64_tr_b16 v[42:43], v27 offset:33280
    v_mfma_f32_16x16x32_bf16 v[248:251], v[48:51], v[80:83], v[248:251]
    ds_read_b64_tr_b16 v[44:45], v27 offset:36864
    ds_read_b64_tr_b16 v[46:47], v27 offset:37376
    v_mfma_f32_16x16x32_bf16 v[248:251], v[52:55], v[84:87], v[248:251]
    v_add_u32 v22, 0x10000, v22
    v_add_u32 v23, 0x10000, v23
    v_mfma_f32_16x16x32_bf16 v[252:255], v[48:51], v[88:91], v[252:255]
    buffer_load_dwordx4 v1, s[36:39], s77 offen offset:3072 sc1 lds
    v_mfma_f32_16x16x32_bf16 v[252:255], v[52:55], v[92:95], v[252:255]
    s_waitcnt lgkmcnt(4)
    ds_read_b64_tr_b16 v[48:49], v28 offset:32768
    ds_read_b64_tr_b16 v[50:51], v28 offset:33280
    v_mfma_f32_16x16x32_bf16 a[64:67], v[56:59], v[96:99], a[64:67]
    s_add_u32 s100, s77, 4096
    ds_read_b64_tr_b16 v[52:53], v28 offset:36864
    ds_read_b64_tr_b16 v[54:55], v28 offset:37376
    v_mfma_f32_16x16x32_bf16 a[64:67], v[60:63], v[100:103], a[64:67]
    s_add_u32 m0, m0, 4096
    v_add_u32 v27, 0x10000, v27
    v_add_u32 v28, 0x10000, v28
    v_mfma_f32_16x16x32_bf16 a[68:71], v[56:59], v[104:107], a[68:71]
    buffer_load_dwordx4 v1, s[36:39], s100 offen sc1 lds
    v_mfma_f32_16x16x32_bf16 a[68:71], v[60:63], v[108:111], a[68:71]
    v_cvt_pk_bf16_f32 v226, v240, v241
    v_cvt_pk_bf16_f32 v227, v242, v243
    v_mfma_f32_16x16x32_bf16 a[72:75], v[56:59], v[112:115], a[72:75]
    v_cvt_pk_bf16_f32 v228, v228, v229
    v_cvt_pk_bf16_f32 v229, v230, v231
    v_mfma_f32_16x16x32_bf16 a[72:75], v[60:63], v[116:119], a[72:75]
    v_cvt_pk_bf16_f32 v230, v244, v245
    v_cvt_pk_bf16_f32 v231, v246, v247
    v_mfma_f32_16x16x32_bf16 a[76:79], v[56:59], v[120:123], a[76:79]
    buffer_load_dwordx4 v1, s[36:39], s100 offen offset:1024 sc1 lds
    v_mfma_f32_16x16x32_bf16 a[76:79], v[60:63], v[124:127], a[76:79]
    v_cvt_pk_bf16_f32 v199, v214, v215
    v_cvt_pk_bf16_f32 v232, v232, v233
    v_mfma_f32_16x16x32_bf16 a[128:131], v[56:59], a[136:139], a[128:131]
    ds_read_b64_tr_b16 v[56:57], v29 offset:32768
    ds_read_b64_tr_b16 v[58:59], v29 offset:33280
    v_mfma_f32_16x16x32_bf16 a[128:131], v[60:63], a[140:143], a[128:131]
    s_waitcnt lgkmcnt(2)
    ds_read_b64_tr_b16 v[60:61], v29 offset:36864
    ds_read_b64_tr_b16 v[62:63], v29 offset:37376
    v_mfma_f32_16x16x32_bf16 a[80:83], v[40:43], v[96:99], a[80:83]
    buffer_load_dwordx4 v1, s[36:39], s100 offen offset:2048 sc1 lds
    v_mfma_f32_16x16x32_bf16 a[80:83], v[44:47], v[100:103], a[80:83]
    v_add_u32 v29, 0x10000, v29
    v_cvt_pk_bf16_f32 v233, v234, v235
    v_mfma_f32_16x16x32_bf16 a[84:87], v[40:43], v[104:107], a[84:87]
    v_cvt_pk_bf16_f32 v234, v248, v249
    v_cvt_pk_bf16_f32 v235, v250, v251
    v_mfma_f32_16x16x32_bf16 a[84:87], v[44:47], v[108:111], a[84:87]
    v_cvt_pk_bf16_f32 v202, v216, v217
    v_cvt_pk_bf16_f32 v203, v218, v219
    v_mfma_f32_16x16x32_bf16 a[88:91], v[40:43], v[112:115], a[88:91]
    buffer_load_dwordx4 v1, s[36:39], s100 offen offset:3072 sc1 lds
    v_mfma_f32_16x16x32_bf16 a[88:91], v[44:47], v[116:119], a[88:91]
    v_cvt_pk_bf16_f32 v175, v190, v191
    v_cvt_pk_bf16_f32 v236, v236, v237
    v_mfma_f32_16x16x32_bf16 a[92:95], v[40:43], v[120:123], a[92:95]
    s_lshr_b32 s82, s4, 1
    s_add_u32 s82, s82, 32
    v_cvt_pk_bf16_f32 v237, v238, v239
    v_mfma_f32_16x16x32_bf16 a[92:95], v[44:47], v[124:127], a[92:95]
    s_sub_u32 s82, s82, s6
    v_cvt_pk_bf16_f32 v238, v252, v253
    v_cvt_pk_bf16_f32 v239, v254, v255
    v_mfma_f32_16x16x32_bf16 a[132:135], v[40:43], a[136:139], a[132:135]
    s_add_u32 s76, s76, 32768
    s_sub_u32 s82, s82, s6
    ds_read_b64_tr_b16 v[40:41], v26 offset:0
    v_mfma_f32_16x16x32_bf16 a[132:135], v[44:47], a[140:143], a[132:135]
    s_add_u32 s77, s77, 32768
    s_lshl_b32 s38, s82, 15
    s_add_u32 m0, s76, s75
    v_mfma_f32_16x16x32_bf16 a[96:99], v[48:51], v[96:99], a[96:99]
    s_mov_b32 s82, 0
    buffer_load_dwordx4 v1, s[36:39], s77 offen sc1 lds
    v_mfma_f32_16x16x32_bf16 a[96:99], v[52:55], v[100:103], a[96:99]
    ds_read_b64_tr_b16 v[42:43], v26 offset:512
    ds_read_b64_tr_b16 v[44:45], v26 offset:4096
    v_mfma_f32_16x16x32_bf16 a[100:103], v[48:51], v[104:107], a[100:103]
    buffer_load_dwordx4 v1, s[36:39], s77 offen offset:1024 sc1 lds
    v_mfma_f32_16x16x32_bf16 a[100:103], v[52:55], v[108:111], a[100:103]
    ds_read_b64_tr_b16 v[46:47], v26 offset:4608
    ds_read_b128 a[136:139], v22 offset:0
    v_mfma_f32_16x16x32_bf16 a[104:107], v[48:51], v[112:115], a[104:107]
    ds_read_b128 a[140:143], v23 offset:0
    v_cvt_pk_bf16_f32 v204, v204, v205
    v_mfma_f32_16x16x32_bf16 a[104:107], v[52:55], v[116:119], a[104:107]
    v_cvt_pk_bf16_f32 v205, v206, v207
    v_cvt_pk_bf16_f32 v206, v220, v221
    v_mfma_f32_16x16x32_bf16 a[108:111], v[48:51], v[120:123], a[108:111]
    buffer_load_dwordx4 v1, s[36:39], s77 offen offset:2048 sc1 lds
    v_mfma_f32_16x16x32_bf16 a[108:111], v[52:55], v[124:127], a[108:111]
    s_waitcnt lgkmcnt(3)
    ds_read_b64_tr_b16 v[48:49], v27 offset:0
    ds_read_b64_tr_b16 v[50:51], v27 offset:512
    v_mfma_f32_16x16x32_bf16 a[112:115], v[56:59], v[96:99], a[112:115]
    ds_read_b64_tr_b16 v[52:53], v27 offset:4096
    ds_read_b64_tr_b16 v[54:55], v27 offset:4608
    v_mfma_f32_16x16x32_bf16 a[112:115], v[60:63], v[100:103], a[112:115]
    v_cvt_pk_bf16_f32 v207, v222, v223
    v_cmp_eq_u32 vcc, 0, v38
    v_mfma_f32_16x16x32_bf16 a[116:119], v[56:59], v[104:107], a[116:119]
    buffer_load_dwordx4 v1, s[36:39], s77 offen offset:3072 sc1 lds
    v_mfma_f32_16x16x32_bf16 a[116:119], v[60:63], v[108:111], a[116:119]
    v_mov_b32 v38, 0x3f803f80
    v_cndmask_b32 v38, 0, v38, vcc
    v_mfma_f32_16x16x32_bf16 a[120:123], v[56:59], v[112:115], a[120:123]
    s_add_u32 s100, s77, 4096
    v_mfma_f32_16x16x32_bf16 a[120:123], v[60:63], v[116:119], a[120:123]
    s_add_u32 m0, m0, 4096
    v_mfma_f32_16x16x32_bf16 a[124:127], v[56:59], v[120:123], a[124:127]
    buffer_load_dwordx4 v1, s[36:39], s100 offen sc1 lds
    v_mfma_f32_16x16x32_bf16 a[124:127], v[60:63], v[124:127], a[124:127]
    s_waitcnt vmcnt(13)
    ds_read_b64_tr_b16 v[56:57], v28 offset:0
    ds_read_b64_tr_b16 v[58:59], v28 offset:512
    v_mfma_f32_16x16x32_bf16 v[240:243], a[224:227], v[128:131], v[176:179]
    ds_read_b64_tr_b16 v[60:61], v28 offset:4096
    ds_read_b64_tr_b16 v[62:63], v28 offset:4608
    v_mfma_f32_16x16x32_bf16 v[240:243], a[228:231], v[160:163], v[240:243]
    v_mfma_f32_16x16x32_bf16 v[240:243], a[232:235], v[192:195], v[240:243]
    buffer_load_dwordx4 v1, s[36:39], s100 offen offset:1024 sc1 lds
    v_mfma_f32_16x16x32_bf16 v[240:243], a[236:239], v[224:227], v[240:243]
    v_mfma_f32_16x16x32_bf16 v[244:247], a[224:227], v[132:135], 0
    v_mfma_f32_16x16x32_bf16 v[244:247], a[228:231], v[164:167], v[244:247]
    v_mfma_f32_16x16x32_bf16 v[244:247], a[232:235], v[196:199], v[244:247]
    buffer_load_dwordx4 v1, s[36:39], s100 offen offset:2048 sc1 lds
    v_mfma_f32_16x16x32_bf16 v[244:247], a[236:239], v[228:231], v[244:247]
    v_mfma_f32_16x16x32_bf16 v[248:251], a[224:227], v[136:139], 0
    v_mfma_f32_16x16x32_bf16 v[248:251], a[228:231], v[168:171], v[248:251]
    v_mfma_f32_16x16x32_bf16 v[248:251], a[232:235], v[200:203], v[248:251]
    buffer_load_dwordx4 v1, s[36:39], s100 offen offset:3072 sc1 lds
    v_mfma_f32_16x16x32_bf16 v[248:251], a[236:239], v[232:235], v[248:251]
    v_max3_f32 v240, v240, v241, v242
    v_max_f32 v240, v240, v243
    v_mfma_f32_16x16x32_bf16 v[252:255], a[224:227], v[140:143], 0
    s_add_u32 s76, s76, 32768
    v_max3_f32 v244, v244, v245, v246
    v_max_f32 v244, v244, v247
    v_mfma_f32_16x16x32_bf16 v[252:255], a[228:231], v[172:175], v[252:255]
    s_add_u32 s77, s77, 32768
    v_max3_f32 v248, v248, v249, v250
    v_max_f32 v248, v248, v251
    v_mfma_f32_16x16x32_bf16 v[252:255], a[232:235], v[204:207], v[252:255]
    s_add_u32 m0, s76, s75
    v_mov_b32 v241, v240
    v_mov_b32 v245, v244
    v_mfma_f32_16x16x32_bf16 v[252:255], a[236:239], v[236:239], v[252:255]
    buffer_load_dwordx4 v1, s[36:39], s77 offen sc1 lds
    v_mfma_f32_16x16x32_bf16 a[64:67], v[40:43], v[64:67], a[64:67]
    s_waitcnt lgkmcnt(0)
    v_mov_b32 v249, v248
    v_permlane32_swap_b32 v240, v241
    v_mfma_f32_16x16x32_bf16 a[64:67], v[44:47], v[68:71], a[64:67]
    v_permlane32_swap_b32 v244, v245
    v_permlane32_swap_b32 v248, v249
    v_mfma_f32_16x16x32_bf16 a[68:71], v[40:43], v[72:75], a[68:71]
    buffer_load_dwordx4 v1, s[36:39], s77 offen offset:1024 sc1 lds
    v_mfma_f32_16x16x32_bf16 a[68:71], v[44:47], v[76:79], a[68:71]
    v_max3_f32 v252, v252, v253, v254
    v_max_f32 v252, v252, v255
    v_mfma_f32_16x16x32_bf16 a[72:75], v[40:43], v[80:83], a[72:75]
    v_mov_b32 v253, v252
    v_max_f32 v240, v240, v241
    v_mfma_f32_16x16x32_bf16 a[72:75], v[44:47], v[84:87], a[72:75]
    v_permlane32_swap_b32 v252, v253
    v_max_f32 v244, v244, v245
    v_mfma_f32_16x16x32_bf16 a[76:79], v[40:43], v[88:91], a[76:79]
    buffer_load_dwordx4 v1, s[36:39], s77 offen offset:2048 sc1 lds
    v_mfma_f32_16x16x32_bf16 a[76:79], v[44:47], v[92:95], a[76:79]
    v_max_f32 v248, v248, v249
    v_max_f32 v252, v252, v253
    v_mfma_f32_16x16x32_bf16 a[128:131], v[40:43], a[136:139], a[128:131]
    ds_read_b64_tr_b16 v[40:41], v29 offset:0
    ds_read_b64_tr_b16 v[42:43], v29 offset:512
    v_mfma_f32_16x16x32_bf16 a[128:131], v[44:47], a[140:143], a[128:131]
    ds_read_b64_tr_b16 v[44:45], v29 offset:4096
    ds_read_b64_tr_b16 v[46:47], v29 offset:4608
    v_mfma_f32_16x16x32_bf16 a[80:83], v[48:51], v[64:67], a[80:83]
    buffer_load_dwordx4 v1, s[36:39], s77 offen offset:3072 sc1 lds
    v_mfma_f32_16x16x32_bf16 a[80:83], v[52:55], v[68:71], a[80:83]
    v_mov_b32 v241, v240
    v_mov_b32 v245, v244
    v_mfma_f32_16x16x32_bf16 a[84:87], v[48:51], v[72:75], a[84:87]
    s_add_u32 s100, s77, 4096
    v_mov_b32 v249, v248
    v_mov_b32 v253, v252
    v_mfma_f32_16x16x32_bf16 a[84:87], v[52:55], v[76:79], a[84:87]
    s_add_u32 m0, m0, 4096
    v_permlane16_swap_b32 v240, v241
    v_permlane16_swap_b32 v244, v245
    v_mfma_f32_16x16x32_bf16 a[88:91], v[48:51], v[80:83], a[88:91]
    buffer_load_dwordx4 v1, s[36:39], s100 offen sc1 lds
    v_mfma_f32_16x16x32_bf16 a[88:91], v[52:55], v[84:87], a[88:91]
    v_permlane16_swap_b32 v248, v249
    v_permlane16_swap_b32 v252, v253
    v_mfma_f32_16x16x32_bf16 a[92:95], v[48:51], v[88:91], a[92:95]
    v_max_f32 v240, v240, v241
    v_max_f32 v244, v244, v245
    v_mfma_f32_16x16x32_bf16 a[92:95], v[52:55], v[92:95], a[92:95]
    v_max_f32 v248, v248, v249
    v_max_f32 v252, v252, v253
    v_mfma_f32_16x16x32_bf16 a[132:135], v[48:51], a[136:139], a[132:135]
    buffer_load_dwordx4 v1, s[36:39], s100 offen offset:1024 sc1 lds
    v_mfma_f32_16x16x32_bf16 a[132:135], v[52:55], a[140:143], a[132:135]
    v_sub_f32 v144, 0, v240
    v_sub_f32 v145, 0, v240
    v_mfma_f32_16x16x32_bf16 a[96:99], v[56:59], v[64:67], a[96:99]
    v_sub_f32 v146, 0, v240
    v_sub_f32 v147, 0, v240
    v_mfma_f32_16x16x32_bf16 a[96:99], v[60:63], v[68:71], a[96:99]
    v_sub_f32 v148, 0, v244
    v_sub_f32 v149, 0, v244
    v_mfma_f32_16x16x32_bf16 a[100:103], v[56:59], v[72:75], a[100:103]
    buffer_load_dwordx4 v1, s[36:39], s100 offen offset:2048 sc1 lds
    v_mfma_f32_16x16x32_bf16 a[100:103], v[60:63], v[76:79], a[100:103]
    v_sub_f32 v150, 0, v244
    v_sub_f32 v151, 0, v244
    v_mfma_f32_16x16x32_bf16 a[104:107], v[56:59], v[80:83], a[104:107]
    v_sub_f32 v152, 0, v248
    v_sub_f32 v153, 0, v248
    v_mfma_f32_16x16x32_bf16 a[104:107], v[60:63], v[84:87], a[104:107]
    v_sub_f32 v154, 0, v248
    v_sub_f32 v155, 0, v248
    v_mfma_f32_16x16x32_bf16 a[108:111], v[56:59], v[88:91], a[108:111]
    buffer_load_dwordx4 v1, s[36:39], s100 offen offset:3072 sc1 lds
    v_mfma_f32_16x16x32_bf16 a[108:111], v[60:63], v[92:95], a[108:111]
    s_waitcnt lgkmcnt(0)
    v_sub_f32 v156, 0, v252
    v_sub_f32 v157, 0, v252
    v_mfma_f32_16x16x32_bf16 a[112:115], v[40:43], v[64:67], a[112:115]
    s_add_u32 s77, s77, 32768
    v_sub_f32 v158, 0, v252
    v_sub_f32 v159, 0, v252
    v_mfma_f32_16x16x32_bf16 a[112:115], v[44:47], v[68:71], a[112:115]
    s_add_u32 s76, s76, 32768
    v_accvgpr_write_b32 a136, v38
    v_accvgpr_write_b32 a137, v38
    v_mfma_f32_16x16x32_bf16 a[116:119], v[40:43], v[72:75], a[116:119]
    v_accvgpr_write_b32 a138, v38
    v_accvgpr_write_b32 a139, v38
    v_mfma_f32_16x16x32_bf16 a[116:119], v[44:47], v[76:79], a[116:119]
    v_mfma_f32_16x16x32_bf16 a[120:123], v[40:43], v[80:83], a[120:123]
    v_mfma_f32_16x16x32_bf16 a[120:123], v[44:47], v[84:87], a[120:123]
    s_waitcnt vmcnt(16) lgkmcnt(0)
    s_barrier
    v_mfma_f32_16x16x32_bf16 a[124:127], v[40:43], v[88:91], a[124:127]
    v_mfma_f32_16x16x32_bf16 a[124:127], v[44:47], v[92:95], a[124:127]
K1_ATT:
    v_add_f32 v212, s20, v144
    v_fma_f32 v176, v208, s16, v212
    v_fma_f32 v177, v209, s16, v212
    v_fma_f32 v178, v210, s16, v212
    v_fma_f32 v179, v211, s16, v212
    s_nop 1
    s_waitcnt lgkmcnt(0)
    v_mfma_f32_16x16x32_bf16 v[240:243], a[224:227], v[128:131], v[176:179]
    s_add_u32 m0, s76, s75
    ds_read_b128 a[240:243], v2 offset:4096
    ds_read_b128 a[244:247], v2 offset:5120
    v_mfma_f32_16x16x32_bf16 v[240:243], a[228:231], v[160:163], v[240:243]
    s_mov_b32 s76, s60
    buffer_load_dwordx4 v1, s[36:39], s77 offen sc1 lds
    v_mfma_f32_16x16x32_bf16 v[240:243], a[232:235], v[192:195], v[240:243]
    s_mov_b32 s60, s82
    ds_read_b128 a[248:251], v2 offset:6144
    ds_read_b128 a[252:255], v2 offset:7168
    v_mfma_f32_16x16x32_bf16 v[240:243], a[236:239], v[224:227], v[240:243]
    s_add_u32 s82, s82, 32768
    v_add_f32 v213, s21, v144
    v_fma_f32 v180, v208, s17, v213
    v_mfma_f32_16x16x32_bf16 v[244:247], a[224:227], v[132:135], v[148:151]
    s_sub_u32 s7, 15, s6
    v_fma_f32 v181, v209, s17, v213
    v_fma_f32 v182, v210, s17, v213
    v_mfma_f32_16x16x32_bf16 v[244:247], a[228:231], v[164:167], v[244:247]
    s_lshl3_add_u32 s80, s6, s4
    v_exp_f32 v240, v240
    v_mfma_f32_16x16x32_bf16 v[244:247], a[232:235], v[196:199], v[244:247]
    s_lshl3_add_u32 s81, s7, s4
    buffer_load_dwordx4 v1, s[36:39], s77 offen offset:1024 sc1 lds
    v_mfma_f32_16x16x32_bf16 v[244:247], a[236:239], v[228:231], v[244:247]
    s_mul_i32 s80, s80, 155648
    v_exp_f32 v241, v241
    v_mfma_f32_16x16x32_bf16 v[248:251], a[224:227], v[136:139], v[152:155]
    s_mul_i32 s81, s81, 155648
    v_exp_f32 v242, v242
    v_mfma_f32_16x16x32_bf16 v[248:251], a[228:231], v[168:171], v[248:251]
    s_lshl_b32 s7, s5, 12
    v_exp_f32 v243, v243
    v_mfma_f32_16x16x32_bf16 v[248:251], a[232:235], v[200:203], v[248:251]
    s_add_u32 s80, s80, s7
    v_fma_f32 v183, v211, s17, v213
    v_cvt_pk_bf16_f32 v32, v240, v241
    v_mfma_f32_16x16x32_bf16 v[248:251], a[236:239], v[232:235], v[248:251]
    s_add_u32 s81, s81, s7
    buffer_load_dwordx4 v1, s[36:39], s77 offen offset:2048 sc1 lds
    v_mfma_f32_16x16x32_bf16 v[252:255], a[224:227], v[140:143], v[156:159]
    s_lshr_b32 s7, s5, 3
    v_cvt_pk_bf16_f32 v33, v242, v243
    ds_read_b128 a[224:227], v2 offset:8192
    v_mfma_f32_16x16x32_bf16 v[252:255], a[228:231], v[172:175], v[252:255]
    s_lshl_b32 s7, s7, 10
    v_exp_f32 v244, v244
    v_mfma_f32_16x16x32_bf16 v[252:255], a[232:235], v[204:207], v[252:255]
    s_lshl2_add_u32 s7, s75, s7
    v_exp_f32 v245, v245
    v_mfma_f32_16x16x32_bf16 v[252:255], a[236:239], v[236:239], v[252:255]
    s_mov_b32 s42, 19922944
    v_exp_f32 v246, v246
    s_waitcnt lgkmcnt(1)
    v_mfma_f32_16x16x32_bf16 v[240:243], a[240:243], v[128:131], v[180:183]
    s_mov_b32 s43, 0x20000
    v_exp_f32 v247, v247
    v_mfma_f32_16x16x32_bf16 v[240:243], a[244:247], v[160:163], v[240:243]
    s_add_u32 s92, s7, 32768
    buffer_load_dwordx4 v1, s[36:39], s77 offen offset:3072 sc1 lds
    v_mfma_f32_16x16x32_bf16 v[240:243], a[248:251], v[192:195], v[240:243]
    s_mov_b64 s[24:25], s[0:1]
    v_cvt_pk_bf16_f32 v40, v244, v245
    v_cvt_pk_bf16_f32 v41, v246, v247
    v_mfma_f32_16x16x32_bf16 v[240:243], a[252:255], v[224:227], v[240:243]
    s_mov_b32 s78, s6
    v_exp_f32 v248, v248
    v_mfma_f32_16x16x32_bf16 v[244:247], a[240:243], v[132:135], v[148:151]
    s_mov_b32 s26, 2359296
    v_exp_f32 v249, v249
    v_mfma_f32_16x16x32_bf16 v[244:247], a[244:247], v[164:167], v[244:247]
    s_add_u32 s100, s77, 4096
    v_exp_f32 v250, v250
    v_mfma_f32_16x16x32_bf16 v[244:247], a[248:251], v[196:199], v[244:247]
    s_add_u32 m0, m0, 4096
    v_exp_f32 v251, v251
    v_mfma_f32_16x16x32_bf16 v[244:247], a[252:255], v[228:231], v[244:247]
    s_mov_b32 s27, 0x20000
    v_cvt_pk_bf16_f32 v48, v248, v249
    v_cvt_pk_bf16_f32 v49, v250, v251
    v_mfma_f32_16x16x32_bf16 v[248:251], a[240:243], v[136:139], v[152:155]
    buffer_load_dwordx4 v1, s[36:39], s100 offen sc1 lds
    v_mfma_f32_16x16x32_bf16 v[248:251], a[244:247], v[168:171], v[248:251]
    ds_read_b128 a[228:231], v2 offset:9216
    ds_read_b128 a[232:235], v2 offset:10240
    v_mfma_f32_16x16x32_bf16 v[248:251], a[248:251], v[200:203], v[248:251]
    v_exp_f32 v252, v252
    v_mfma_f32_16x16x32_bf16 v[248:251], a[252:255], v[232:235], v[248:251]
    v_exp_f32 v253, v253
    v_exp_f32 v254, v254
    v_exp_f32 v255, v255
    v_cvt_pk_bf16_f32 v56, v252, v253
    v_cvt_pk_bf16_f32 v57, v254, v255
    v_mfma_f32_16x16x32_bf16 v[252:255], a[240:243], v[140:143], v[156:159]
    ds_read_b128 a[236:239], v2 offset:11264
    v_add_f32 v214, s22, v144
    v_mfma_f32_16x16x32_bf16 v[252:255], a[244:247], v[172:175], v[252:255]
    buffer_load_dwordx4 v1, s[36:39], s100 offen offset:1024 sc1 lds
    v_mfma_f32_16x16x32_bf16 v[252:255], a[248:251], v[204:207], v[252:255]
    v_exp_f32 v240, v240
    v_mfma_f32_16x16x32_bf16 v[252:255], a[252:255], v[236:239], v[252:255]
    s_waitcnt lgkmcnt(1)
    v_exp_f32 v241, v241
    v_exp_f32 v242, v242
    v_exp_f32 v243, v243
    v_fma_f32 v184, v208, s18, v214
    v_fma_f32 v185, v209, s18, v214
    v_fma_f32 v186, v210, s18, v214
    v_fma_f32 v187, v211, s18, v214
    v_cvt_pk_bf16_f32 v34, v240, v241
    v_cvt_pk_bf16_f32 v35, v242, v243
    v_mfma_f32_16x16x32_bf16 v[240:243], a[224:227], v[128:131], v[184:187]
    v_exp_f32 v244, v244
    v_mfma_f32_16x16x32_bf16 v[240:243], a[228:231], v[160:163], v[240:243]
    v_exp_f32 v245, v245
    v_mfma_f32_16x16x32_bf16 v[240:243], a[232:235], v[192:195], v[240:243]
    s_waitcnt lgkmcnt(0)
    v_exp_f32 v246, v246
    v_mfma_f32_16x16x32_bf16 v[240:243], a[236:239], v[224:227], v[240:243]
    v_exp_f32 v247, v247
    v_cvt_pk_bf16_f32 v42, v244, v245
    v_cvt_pk_bf16_f32 v43, v246, v247
    v_mfma_f32_16x16x32_bf16 v[244:247], a[224:227], v[132:135], v[148:151]
    buffer_load_dwordx4 v1, s[36:39], s100 offen offset:2048 sc1 lds
    v_mfma_f32_16x16x32_bf16 v[244:247], a[228:231], v[164:167], v[244:247]
    v_exp_f32 v248, v248
    v_mfma_f32_16x16x32_bf16 v[244:247], a[232:235], v[196:199], v[244:247]
    v_exp_f32 v249, v249
    v_mfma_f32_16x16x32_bf16 v[244:247], a[236:239], v[228:231], v[244:247]
    v_exp_f32 v250, v250
    v_exp_f32 v251, v251
    v_cvt_pk_bf16_f32 v50, v248, v249
    v_cvt_pk_bf16_f32 v51, v250, v251
    v_mfma_f32_16x16x32_bf16 v[248:251], a[224:227], v[136:139], v[152:155]
    buffer_load_dwordx4 v1, s[36:39], s100 offen offset:3072 sc1 lds
    v_mfma_f32_16x16x32_bf16 v[248:251], a[228:231], v[168:171], v[248:251]
    ds_read_b128 a[240:243], v2 offset:12288
    ds_read_b128 a[244:247], v2 offset:13312
    v_mfma_f32_16x16x32_bf16 v[248:251], a[232:235], v[200:203], v[248:251]
    s_add_u32 s77, s77, 32768
    v_exp_f32 v252, v252
    v_mfma_f32_16x16x32_bf16 v[248:251], a[236:239], v[232:235], v[248:251]
    v_exp_f32 v253, v253
    v_exp_f32 v254, v254
    v_exp_f32 v255, v255
    v_cvt_pk_bf16_f32 v58, v252, v253
    v_cvt_pk_bf16_f32 v59, v254, v255
    v_mfma_f32_16x16x32_bf16 v[252:255], a[224:227], v[140:143], v[156:159]
    ds_read_b128 a[248:251], v2 offset:14336
    ds_read_b128 a[252:255], v2 offset:15360
    v_mfma_f32_16x16x32_bf16 v[252:255], a[228:231], v[172:175], v[252:255]
    v_add_f32 v215, s23, v144
    v_fma_f32 v188, v208, s19, v215
    v_mfma_f32_16x16x32_bf16 v[252:255], a[232:235], v[204:207], v[252:255]
    v_exp_f32 v240, v240
    v_mfma_f32_16x16x32_bf16 v[252:255], a[236:239], v[236:239], v[252:255]
    s_waitcnt lgkmcnt(2)
    v_exp_f32 v241, v241
    v_exp_f32 v242, v242
    v_exp_f32 v243, v243
    v_fma_f32 v189, v209, s19, v215
    v_fma_f32 v190, v210, s19, v215
    v_fma_f32 v191, v211, s19, v215
    v_cvt_pk_bf16_f32 v36, v240, v241
    v_cvt_pk_bf16_f32 v37, v242, v243
    v_mfma_f32_16x16x32_bf16 v[240:243], a[240:243], v[128:131], v[188:191]
    v_exp_f32 v244, v244
    v_mfma_f32_16x16x32_bf16 v[240:243], a[244:247], v[160:163], v[240:243]
    s_cmp_eq_u32 s82, 163840
    s_cselect_b32 s82, 0, s82
    v_add_u32 v2, s82, v1
    s_waitcnt lgkmcnt(0)
    v_mfma_f32_16x16x32_bf16 v[240:243], a[248:251], v[192:195], v[240:243]
    v_exp_f32 v245, v245
    v_mfma_f32_16x16x32_bf16 v[240:243], a[252:255], v[224:227], v[240:243]
    s_waitcnt vmcnt(8) lgkmcnt(0)
    s_barrier
    v_cvt_pk_bf16_f32 v44, v244, v245
    v_exp_f32 v246, v246
    v_exp_f32 v247, v247
    s_nop 0
    v_cvt_pk_bf16_f32 v45, v246, v247
    v_mfma_f32_16x16x32_bf16 v[244:247], a[240:243], v[132:135], v[148:151]
    ds_read_b128 a[224:227], v2 offset:0
    ds_read_b128 a[228:231], v2 offset:1024
    v_mfma_f32_16x16x32_bf16 v[244:247], a[244:247], v[164:167], v[244:247]
    v_exp_f32 v248, v248
    v_mfma_f32_16x16x32_bf16 v[244:247], a[248:251], v[196:199], v[244:247]
    v_exp_f32 v249, v249
    v_mfma_f32_16x16x32_bf16 v[244:247], a[252:255], v[228:231], v[244:247]
    v_exp_f32 v250, v250
    v_exp_f32 v251, v251
    v_cvt_pk_bf16_f32 v52, v248, v249
    v_cvt_pk_bf16_f32 v53, v250, v251
    v_mfma_f32_16x16x32_bf16 v[248:251], a[240:243], v[136:139], v[152:155]
    ds_read_b128 a[232:235], v2 offset:2048
    ds_read_b128 a[236:239], v2 offset:3072
    v_mfma_f32_16x16x32_bf16 v[248:251], a[244:247], v[168:171], v[248:251]
    ds_read_b128 v[96:99], v2 offset:16384
    v_mfma_f32_16x16x32_bf16 v[248:251], a[248:251], v[200:203], v[248:251]
    v_exp_f32 v252, v252
    v_mfma_f32_16x16x32_bf16 v[248:251], a[252:255], v[232:235], v[248:251]
    v_exp_f32 v253, v253
    v_exp_f32 v254, v254
    v_exp_f32 v255, v255
    v_cvt_pk_bf16_f32 v60, v252, v253
    v_cvt_pk_bf16_f32 v61, v254, v255
    v_mfma_f32_16x16x32_bf16 v[252:255], a[240:243], v[140:143], v[156:159]
    ds_read_b128 v[100:103], v2 offset:17408
    v_mfma_f32_16x16x32_bf16 v[252:255], a[244:247], v[172:175], v[252:255]
    v_exp_f32 v240, v240
    v_mfma_f32_16x16x32_bf16 v[252:255], a[248:251], v[204:207], v[252:255]
    s_sub_u32 s40, s56, 20971520
    s_subb_u32 s41, s57, 0
    v_mfma_f32_16x16x32_bf16 v[252:255], a[252:255], v[236:239], v[252:255]
    v_exp_f32 v241, v241
    v_exp_f32 v242, v242
    v_exp_f32 v243, v243
    v_exp_f32 v244, v244
    v_exp_f32 v245, v245
    v_exp_f32 v246, v246
    v_exp_f32 v247, v247
    v_exp_f32 v248, v248
    v_exp_f32 v249, v249
    v_exp_f32 v250, v250
    v_exp_f32 v251, v251
    v_exp_f32 v252, v252
    v_exp_f32 v253, v253
    v_cvt_pk_bf16_f32 v38, v240, v241
    v_cvt_pk_bf16_f32 v39, v242, v243
    v_cvt_pk_bf16_f32 v46, v244, v245
    v_cvt_pk_bf16_f32 v47, v246, v247
    v_cvt_pk_bf16_f32 v54, v248, v249
    v_cvt_pk_bf16_f32 v55, v250, v251
    v_cvt_pk_bf16_f32 v62, v252, v253
    s_cmp_eq_u32 s78, 0
    s_cbranch_scc1 K1_LB_END
.p2align 3
K1_LB:
    s_waitcnt lgkmcnt(0)
    v_mfma_f32_16x16x32_bf16 v[240:243], a[224:227], v[128:131], v[176:179]
    s_add_u32 m0, s76, s75
    v_exp_f32 v254, v254
    v_mfma_f32_16x16x32_bf16 v[240:243], a[228:231], v[160:163], v[240:243]
    s_mov_b32 s76, s60
    buffer_load_dwordx4 v1, s[36:39], s77 offen sc1 lds
    v_mfma_f32_16x16x32_bf16 v[240:243], a[232:235], v[192:195], v[240:243]
    s_mov_b32 s60, s82
    v_exp_f32 v255, v255
    v_mfma_f32_16x16x32_bf16 v[240:243], a[236:239], v[224:227], v[240:243]
    s_add_u32 s82, s82, 32768
    ds_read_b128 v[104:107], v2 offset:18432
    v_cvt_pk_bf16_f32 v63, v254, v255
    v_mfma_f32_16x16x32_bf16 a[0:3], v[96:99], v[32:35], a[0:3]
    ds_read_b128 v[108:111], v2 offset:19456
    ds_read_b128 a[240:243], v2 offset:4096
    v_mfma_f32_16x16x32_bf16 a[0:3], v[100:103], v[36:39], a[0:3]
    ds_read_b128 a[244:247], v2 offset:5120
    v_mfma_f32_16x16x32_bf16 a[4:7], v[96:99], v[40:43], a[4:7]
    v_exp_f32 v240, v240
    v_mfma_f32_16x16x32_bf16 a[4:7], v[100:103], v[44:47], a[4:7]
    ds_read_b128 a[248:251], v2 offset:6144
    ds_read_b128 a[252:255], v2 offset:7168
    v_mfma_f32_16x16x32_bf16 v[244:247], a[224:227], v[132:135], v[148:151]
    v_exp_f32 v241, v241
    v_mfma_f32_16x16x32_bf16 v[244:247], a[228:231], v[164:167], v[244:247]
    ds_read_b128 v[112:115], v2 offset:20480
    ds_read_b128 v[116:119], v2 offset:21504
    v_mfma_f32_16x16x32_bf16 v[244:247], a[232:235], v[196:199], v[244:247]
    v_exp_f32 v242, v242
    v_mfma_f32_16x16x32_bf16 v[244:247], a[236:239], v[228:231], v[244:247]
    v_exp_f32 v243, v243
    v_mfma_f32_16x16x32_bf16 a[8:11], v[96:99], v[48:51], a[8:11]
    v_cvt_pk_bf16_f32 v64, v240, v241
    v_cvt_pk_bf16_f32 v65, v242, v243
    v_mfma_f32_16x16x32_bf16 a[8:11], v[100:103], v[52:55], a[8:11]
    ds_read_b128 v[120:123], v2 offset:22528
    ds_read_b128 v[124:127], v2 offset:23552
    v_mfma_f32_16x16x32_bf16 a[12:15], v[96:99], v[56:59], a[12:15]
    v_exp_f32 v244, v244
    v_mfma_f32_16x16x32_bf16 a[12:15], v[100:103], v[60:63], a[12:15]
    buffer_load_dwordx4 v1, s[36:39], s77 offen offset:1024 sc1 lds
    v_mfma_f32_16x16x32_bf16 v[248:251], a[224:227], v[136:139], v[152:155]
    v_exp_f32 v245, v245
    v_mfma_f32_16x16x32_bf16 v[248:251], a[228:231], v[168:171], v[248:251]
    v_exp_f32 v246, v246
    v_mfma_f32_16x16x32_bf16 v[248:251], a[232:235], v[200:203], v[248:251]
    v_exp_f32 v247, v247
    v_mfma_f32_16x16x32_bf16 v[248:251], a[236:239], v[232:235], v[248:251]
    s_waitcnt lgkmcnt(0)
    v_cvt_pk_bf16_f32 v72, v244, v245
    v_cvt_pk_bf16_f32 v73, v246, v247
    v_mfma_f32_16x16x32_bf16 a[16:19], v[104:107], v[32:35], a[16:19]
    ds_read_b128 v[96:99], v2 offset:24576
    ds_read_b128 v[100:103], v2 offset:25600
    v_mfma_f32_16x16x32_bf16 a[16:19], v[108:111], v[36:39], a[16:19]
    v_mfma_f32_16x16x32_bf16 a[20:23], v[104:107], v[40:43], a[20:23]
    v_mfma_f32_16x16x32_bf16 a[20:23], v[108:111], v[44:47], a[20:23]
    v_exp_f32 v248, v248
    v_mfma_f32_16x16x32_bf16 v[252:255], a[224:227], v[140:143], v[156:159]
    v_exp_f32 v249, v249
    v_mfma_f32_16x16x32_bf16 v[252:255], a[228:231], v[172:175], v[252:255]
    v_exp_f32 v250, v250
    v_mfma_f32_16x16x32_bf16 v[252:255], a[232:235], v[204:207], v[252:255]
    v_exp_f32 v251, v251
    v_mfma_f32_16x16x32_bf16 v[252:255], a[236:239], v[236:239], v[252:255]
    v_cvt_pk_bf16_f32 v80, v248, v249
    v_cvt_pk_bf16_f32 v81, v250, v251
    v_mfma_f32_16x16x32_bf16 a[24:27], v[104:107], v[48:51], a[24:27]
    ds_read_b128 a[224:227], v2 offset:8192
    ds_read_b128 a[228:231], v2 offset:9216
    v_mfma_f32_16x16x32_bf16 a[24:27], v[108:111], v[52:55], a[24:27]
    buffer_load_dwordx4 v1, s[36:39], s77 offen offset:2048 sc1 lds
    v_mfma_f32_16x16x32_bf16 a[28:31], v[104:107], v[56:59], a[28:31]
    v_exp_f32 v252, v252
    v_mfma_f32_16x16x32_bf16 a[28:31], v[108:111], v[60:63], a[28:31]
    v_exp_f32 v253, v253
    v_mfma_f32_16x16x32_bf16 v[240:243], a[240:243], v[128:131], v[180:183]
    v_exp_f32 v254, v254
    v_mfma_f32_16x16x32_bf16 v[240:243], a[244:247], v[160:163], v[240:243]
    v_exp_f32 v255, v255
    v_mfma_f32_16x16x32_bf16 v[240:243], a[248:251], v[192:195], v[240:243]
    v_cvt_pk_bf16_f32 v88, v252, v253
    v_cvt_pk_bf16_f32 v89, v254, v255
    v_mfma_f32_16x16x32_bf16 v[240:243], a[252:255], v[224:227], v[240:243]
    ds_read_b128 a[232:235], v2 offset:10240
    ds_read_b128 a[236:239], v2 offset:11264
    v_mfma_f32_16x16x32_bf16 a[32:35], v[112:115], v[32:35], a[32:35]
    ds_read_b128 v[104:107], v2 offset:26624
    v_mfma_f32_16x16x32_bf16 a[32:35], v[116:119], v[36:39], a[32:35]
    ds_read_b128 v[108:111], v2 offset:27648
    v_mfma_f32_16x16x32_bf16 a[36:39], v[112:115], v[40:43], a[36:39]
    v_mfma_f32_16x16x32_bf16 a[36:39], v[116:119], v[44:47], a[36:39]
    v_exp_f32 v240, v240
    v_mfma_f32_16x16x32_bf16 v[244:247], a[240:243], v[132:135], v[148:151]
    v_exp_f32 v241, v241
    v_mfma_f32_16x16x32_bf16 v[244:247], a[244:247], v[164:167], v[244:247]
    v_exp_f32 v242, v242
    v_mfma_f32_16x16x32_bf16 v[244:247], a[248:251], v[196:199], v[244:247]
    v_exp_f32 v243, v243
    v_mfma_f32_16x16x32_bf16 v[244:247], a[252:255], v[228:231], v[244:247]
    buffer_load_dwordx4 v1, s[36:39], s77 offen offset:3072 sc1 lds
    v_mfma_f32_16x16x32_bf16 a[40:43], v[112:115], v[48:51], a[40:43]
    v_cvt_pk_bf16_f32 v66, v240, v241
    v_cvt_pk_bf16_f32 v67, v242, v243
    v_mfma_f32_16x16x32_bf16 a[40:43], v[116:119], v[52:55], a[40:43]
    v_mfma_f32_16x16x32_bf16 a[44:47], v[112:115], v[56:59], a[44:47]
    ds_read_b128 v[112:115], v2 offset:28672
    v_mfma_f32_16x16x32_bf16 a[44:47], v[116:119], v[60:63], a[44:47]
    v_exp_f32 v244, v244
    v_mfma_f32_16x16x32_bf16 v[248:251], a[240:243], v[136:139], v[152:155]
    v_exp_f32 v245, v245
    v_mfma_f32_16x16x32_bf16 v[248:251], a[244:247], v[168:171], v[248:251]
    v_exp_f32 v246, v246
    v_mfma_f32_16x16x32_bf16 v[248:251], a[248:251], v[200:203], v[248:251]
    v_exp_f32 v247, v247
    v_mfma_f32_16x16x32_bf16 v[248:251], a[252:255], v[232:235], v[248:251]
    v_cvt_pk_bf16_f32 v74, v244, v245
    v_cvt_pk_bf16_f32 v75, v246, v247
    v_mfma_f32_16x16x32_bf16 a[48:51], v[120:123], v[32:35], a[48:51]
    ds_read_b128 v[116:119], v2 offset:29696
    v_mfma_f32_16x16x32_bf16 a[48:51], v[124:127], v[36:39], a[48:51]
    v_mfma_f32_16x16x32_bf16 a[52:55], v[120:123], v[40:43], a[52:55]
    v_mfma_f32_16x16x32_bf16 a[52:55], v[124:127], v[44:47], a[52:55]
    v_mfma_f32_16x16x32_bf16 v[252:255], a[240:243], v[140:143], v[156:159]
    v_exp_f32 v248, v248
    v_mfma_f32_16x16x32_bf16 v[252:255], a[244:247], v[172:175], v[252:255]
    s_add_u32 s100, s77, 4096
    v_exp_f32 v249, v249
    v_mfma_f32_16x16x32_bf16 v[252:255], a[248:251], v[204:207], v[252:255]
    s_add_u32 m0, m0, 4096
    v_exp_f32 v250, v250
    v_mfma_f32_16x16x32_bf16 v[252:255], a[252:255], v[236:239], v[252:255]
    buffer_load_dwordx4 v1, s[36:39], s100 offen sc1 lds
    v_mfma_f32_16x16x32_bf16 a[56:59], v[120:123], v[48:51], a[56:59]
    v_exp_f32 v251, v251
    v_mfma_f32_16x16x32_bf16 a[56:59], v[124:127], v[52:55], a[56:59]
    v_cvt_pk_bf16_f32 v82, v248, v249
    v_cvt_pk_bf16_f32 v83, v250, v251
    v_mfma_f32_16x16x32_bf16 a[60:63], v[120:123], v[56:59], a[60:63]
    ds_read_b128 a[240:243], v2 offset:12288
    ds_read_b128 a[244:247], v2 offset:13312
    v_mfma_f32_16x16x32_bf16 a[60:63], v[124:127], v[60:63], a[60:63]
    s_waitcnt lgkmcnt(2)
    v_exp_f32 v252, v252
    v_mfma_f32_16x16x32_bf16 v[240:243], a[224:227], v[128:131], v[184:187]
    v_exp_f32 v253, v253
    v_mfma_f32_16x16x32_bf16 v[240:243], a[228:231], v[160:163], v[240:243]
    v_exp_f32 v254, v254
    v_mfma_f32_16x16x32_bf16 v[240:243], a[232:235], v[192:195], v[240:243]
    v_exp_f32 v255, v255
    v_mfma_f32_16x16x32_bf16 v[240:243], a[236:239], v[224:227], v[240:243]
    v_cvt_pk_bf16_f32 v90, v252, v253
    v_cvt_pk_bf16_f32 v91, v254, v255
    v_mfma_f32_16x16x32_bf16 a[144:147], v[96:99], v[32:35], a[144:147]
    ds_read_b128 a[248:251], v2 offset:14336
    ds_read_b128 a[252:255], v2 offset:15360
    v_mfma_f32_16x16x32_bf16 a[144:147], v[100:103], v[36:39], a[144:147]
    ds_read_b128 v[120:123], v2 offset:30720
    v_mfma_f32_16x16x32_bf16 a[148:151], v[96:99], v[40:43], a[148:151]
    v_exp_f32 v240, v240
    v_mfma_f32_16x16x32_bf16 a[148:151], v[100:103], v[44:47], a[148:151]
    v_exp_f32 v241, v241
    v_mfma_f32_16x16x32_bf16 v[244:247], a[224:227], v[132:135], v[148:151]
    buffer_load_dwordx4 v1, s[36:39], s100 offen offset:1024 sc1 lds
    v_mfma_f32_16x16x32_bf16 v[244:247], a[228:231], v[164:167], v[244:247]
    v_exp_f32 v242, v242
    v_mfma_f32_16x16x32_bf16 v[244:247], a[232:235], v[196:199], v[244:247]
    v_exp_f32 v243, v243
    v_mfma_f32_16x16x32_bf16 v[244:247], a[236:239], v[228:231], v[244:247]
    v_cvt_pk_bf16_f32 v68, v240, v241
    v_cvt_pk_bf16_f32 v69, v242, v243
    v_mfma_f32_16x16x32_bf16 a[152:155], v[96:99], v[48:51], a[152:155]
    ds_read_b128 v[124:127], v2 offset:31744
    v_mfma_f32_16x16x32_bf16 a[152:155], v[100:103], v[52:55], a[152:155]
    v_mfma_f32_16x16x32_bf16 a[156:159], v[96:99], v[56:59], a[156:159]
    v_mfma_f32_16x16x32_bf16 a[156:159], v[100:103], v[60:63], a[156:159]
    v_mfma_f32_16x16x32_bf16 v[248:251], a[224:227], v[136:139], v[152:155]
    v_exp_f32 v244, v244
    v_mfma_f32_16x16x32_bf16 v[248:251], a[228:231], v[168:171], v[248:251]
    v_exp_f32 v245, v245
    v_mfma_f32_16x16x32_bf16 v[248:251], a[232:235], v[200:203], v[248:251]
    v_exp_f32 v246, v246
    v_mfma_f32_16x16x32_bf16 v[248:251], a[236:239], v[232:235], v[248:251]
    v_exp_f32 v247, v247
    v_mfma_f32_16x16x32_bf16 a[160:163], v[104:107], v[32:35], a[160:163]
    v_cvt_pk_bf16_f32 v76, v244, v245
    v_cvt_pk_bf16_f32 v77, v246, v247
    v_mfma_f32_16x16x32_bf16 a[160:163], v[108:111], v[36:39], a[160:163]
    v_mfma_f32_16x16x32_bf16 a[164:167], v[104:107], v[40:43], a[164:167]
    buffer_load_dwordx4 v1, s[36:39], s100 offen offset:2048 sc1 lds
    v_mfma_f32_16x16x32_bf16 a[164:167], v[108:111], v[44:47], a[164:167]
    v_exp_f32 v248, v248
    v_mfma_f32_16x16x32_bf16 v[252:255], a[224:227], v[140:143], v[156:159]
    v_exp_f32 v249, v249
    v_mfma_f32_16x16x32_bf16 v[252:255], a[228:231], v[172:175], v[252:255]
    v_exp_f32 v250, v250
    v_mfma_f32_16x16x32_bf16 v[252:255], a[232:235], v[204:207], v[252:255]
    v_exp_f32 v251, v251
    v_mfma_f32_16x16x32_bf16 v[252:255], a[236:239], v[236:239], v[252:255]
    v_cvt_pk_bf16_f32 v84, v248, v249
    v_cvt_pk_bf16_f32 v85, v250, v251
    v_mfma_f32_16x16x32_bf16 a[168:171], v[104:107], v[48:51], a[168:171]
    v_mfma_f32_16x16x32_bf16 a[168:171], v[108:111], v[52:55], a[168:171]
    v_mfma_f32_16x16x32_bf16 a[172:175], v[104:107], v[56:59], a[172:175]
    v_mfma_f32_16x16x32_bf16 a[172:175], v[108:111], v[60:63], a[172:175]
    s_waitcnt lgkmcnt(0)
    v_mfma_f32_16x16x32_bf16 v[240:243], a[240:243], v[128:131], v[188:191]
    v_mfma_f32_16x16x32_bf16 v[240:243], a[244:247], v[160:163], v[240:243]
    v_exp_f32 v252, v252
    v_mfma_f32_16x16x32_bf16 v[240:243], a[248:251], v[192:195], v[240:243]
    v_exp_f32 v253, v253
    v_mfma_f32_16x16x32_bf16 v[240:243], a[252:255], v[224:227], v[240:243]
    v_exp_f32 v254, v254
    v_mfma_f32_16x16x32_bf16 a[176:179], v[112:115], v[32:35], a[176:179]
    buffer_load_dwordx4 v1, s[36:39], s100 offen offset:3072 sc1 lds
    v_mfma_f32_16x16x32_bf16 a[176:179], v[116:119], v[36:39], a[176:179]
    v_exp_f32 v255, v255
    v_mfma_f32_16x16x32_bf16 a[180:183], v[112:115], v[40:43], a[180:183]
    v_cvt_pk_bf16_f32 v92, v252, v253
    v_cvt_pk_bf16_f32 v93, v254, v255
    v_mfma_f32_16x16x32_bf16 a[180:183], v[116:119], v[44:47], a[180:183]
    s_cmp_eq_u32 s82, 163840
    s_cselect_b32 s82, 0, s82
    v_add_u32 v2, s82, v1
    v_mfma_f32_16x16x32_bf16 v[244:247], a[240:243], v[132:135], v[148:151]
    ds_read_b128 a[224:227], v2 offset:0
    ds_read_b128 a[228:231], v2 offset:1024
    v_mfma_f32_16x16x32_bf16 v[244:247], a[244:247], v[164:167], v[244:247]
    v_exp_f32 v240, v240
    v_mfma_f32_16x16x32_bf16 v[244:247], a[248:251], v[196:199], v[244:247]
    ds_read_b128 a[232:235], v2 offset:2048
    ds_read_b128 a[236:239], v2 offset:3072
    v_mfma_f32_16x16x32_bf16 v[244:247], a[252:255], v[228:231], v[244:247]
    v_exp_f32 v241, v241
    v_mfma_f32_16x16x32_bf16 a[184:187], v[112:115], v[48:51], a[184:187]
    ds_read_b128 v[96:99], v2 offset:16384
    ds_read_b128 v[100:103], v2 offset:17408
    v_mfma_f32_16x16x32_bf16 a[184:187], v[116:119], v[52:55], a[184:187]
    v_exp_f32 v242, v242
    v_mfma_f32_16x16x32_bf16 a[188:191], v[112:115], v[56:59], a[188:191]
    v_exp_f32 v243, v243
    v_mfma_f32_16x16x32_bf16 a[188:191], v[116:119], v[60:63], a[188:191]
    v_exp_f32 v244, v244
    v_mfma_f32_16x16x32_bf16 v[248:251], a[240:243], v[136:139], v[152:155]
    v_exp_f32 v245, v245
    v_mfma_f32_16x16x32_bf16 v[248:251], a[244:247], v[168:171], v[248:251]
    v_exp_f32 v246, v246
    v_mfma_f32_16x16x32_bf16 v[248:251], a[248:251], v[200:203], v[248:251]
    s_add_u32 s77, s77, 32768
    v_exp_f32 v247, v247
    v_mfma_f32_16x16x32_bf16 v[248:251], a[252:255], v[232:235], v[248:251]
    v_cvt_pk_bf16_f32 v70, v240, v241
    v_cvt_pk_bf16_f32 v71, v242, v243
    v_mfma_f32_16x16x32_bf16 a[192:195], v[120:123], v[32:35], a[192:195]
    v_cvt_pk_bf16_f32 v78, v244, v245
    v_cvt_pk_bf16_f32 v79, v246, v247
    v_mfma_f32_16x16x32_bf16 a[192:195], v[124:127], v[36:39], a[192:195]
    v_mfma_f32_16x16x32_bf16 a[196:199], v[120:123], v[40:43], a[196:199]
    v_mfma_f32_16x16x32_bf16 a[196:199], v[124:127], v[44:47], a[196:199]
    v_exp_f32 v248, v248
    v_mfma_f32_16x16x32_bf16 v[252:255], a[240:243], v[140:143], v[156:159]
    v_exp_f32 v249, v249
    v_mfma_f32_16x16x32_bf16 v[252:255], a[244:247], v[172:175], v[252:255]
    v_exp_f32 v250, v250
    v_mfma_f32_16x16x32_bf16 v[252:255], a[248:251], v[204:207], v[252:255]
    v_exp_f32 v251, v251
    v_mfma_f32_16x16x32_bf16 v[252:255], a[252:255], v[236:239], v[252:255]
    v_cvt_pk_bf16_f32 v86, v248, v249
    v_cvt_pk_bf16_f32 v87, v250, v251
    v_mfma_f32_16x16x32_bf16 a[200:203], v[120:123], v[48:51], a[200:203]
    v_mfma_f32_16x16x32_bf16 a[200:203], v[124:127], v[52:55], a[200:203]
    v_mfma_f32_16x16x32_bf16 a[204:207], v[120:123], v[56:59], a[204:207]
    v_mfma_f32_16x16x32_bf16 a[204:207], v[124:127], v[60:63], a[204:207]
    v_mfma_f32_16x16x32_bf16 a[208:211], a[136:139], v[32:35], a[208:211]
    v_mfma_f32_16x16x32_bf16 a[208:211], a[136:139], v[36:39], a[208:211]
    v_exp_f32 v252, v252
    v_mfma_f32_16x16x32_bf16 a[212:215], a[136:139], v[40:43], a[212:215]
    v_exp_f32 v253, v253
    v_mfma_f32_16x16x32_bf16 a[212:215], a[136:139], v[44:47], a[212:215]
    v_cvt_pk_bf16_f32 v94, v252, v253
    v_mfma_f32_16x16x32_bf16 a[216:219], a[136:139], v[48:51], a[216:219]
    v_mfma_f32_16x16x32_bf16 a[216:219], a[136:139], v[52:55], a[216:219]
    v_mfma_f32_16x16x32_bf16 a[220:223], a[136:139], v[56:59], a[220:223]
    v_mfma_f32_16x16x32_bf16 a[220:223], a[136:139], v[60:63], a[220:223]
    s_cmp_eq_u32 s78, 1
    s_cbranch_scc1 K1_LB_MASK
K1_LB_BACK:
    s_waitcnt lgkmcnt(0)
    v_mfma_f32_16x16x32_bf16 v[240:243], a[224:227], v[128:131], v[176:179]
    s_add_u32 m0, s76, s75
    v_exp_f32 v254, v254
    v_mfma_f32_16x16x32_bf16 v[240:243], a[228:231], v[160:163], v[240:243]
    s_mov_b32 s76, s60
    buffer_load_dwordx4 v1, s[36:39], s77 offen sc1 lds
    v_mfma_f32_16x16x32_bf16 v[240:243], a[232:235], v[192:195], v[240:243]
    s_mov_b32 s60, s82
    v_exp_f32 v255, v255
    v_mfma_f32_16x16x32_bf16 v[240:243], a[236:239], v[224:227], v[240:243]
    s_add_u32 s82, s82, 32768
    ds_read_b128 v[104:107], v2 offset:18432
    v_cvt_pk_bf16_f32 v95, v254, v255
    v_mfma_f32_16x16x32_bf16 a[0:3], v[96:99], v[64:67], a[0:3]
    ds_read_b128 v[108:111], v2 offset:19456
    ds_read_b128 a[240:243], v2 offset:4096
    v_mfma_f32_16x16x32_bf16 a[0:3], v[100:103], v[68:71], a[0:3]
    ds_read_b128 a[244:247], v2 offset:5120
    v_mfma_f32_16x16x32_bf16 a[4:7], v[96:99], v[72:75], a[4:7]
    v_exp_f32 v240, v240
    v_mfma_f32_16x16x32_bf16 a[4:7], v[100:103], v[76:79], a[4:7]
    ds_read_b128 a[248:251], v2 offset:6144
    ds_read_b128 a[252:255], v2 offset:7168
    v_mfma_f32_16x16x32_bf16 v[244:247], a[224:227], v[132:135], v[148:151]
    v_exp_f32 v241, v241
    v_mfma_f32_16x16x32_bf16 v[244:247], a[228:231], v[164:167], v[244:247]
    ds_read_b128 v[112:115], v2 offset:20480
    ds_read_b128 v[116:119], v2 offset:21504
    v_mfma_f32_16x16x32_bf16 v[244:247], a[232:235], v[196:199], v[244:247]
    v_exp_f32 v242, v242
    v_mfma_f32_16x16x32_bf16 v[244:247], a[236:239], v[228:231], v[244:247]
    v_exp_f32 v243, v243
    v_mfma_f32_16x16x32_bf16 a[8:11], v[96:99], v[80:83], a[8:11]
    v_cvt_pk_bf16_f32 v32, v240, v241
    v_cvt_pk_bf16_f32 v33, v242, v243
    v_mfma_f32_16x16x32_bf16 a[8:11], v[100:103], v[84:87], a[8:11]
    ds_read_b128 v[120:123], v2 offset:22528
    ds_read_b128 v[124:127], v2 offset:23552
    v_mfma_f32_16x16x32_bf16 a[12:15], v[96:99], v[88:91], a[12:15]
    v_exp_f32 v244, v244
    v_mfma_f32_16x16x32_bf16 a[12:15], v[100:103], v[92:95], a[12:15]
    buffer_load_dwordx4 v1, s[36:39], s77 offen offset:1024 sc1 lds
    v_mfma_f32_16x16x32_bf16 v[248:251], a[224:227], v[136:139], v[152:155]
    v_exp_f32 v245, v245
    v_mfma_f32_16x16x32_bf16 v[248:251], a[228:231], v[168:171], v[248:251]
    v_exp_f32 v246, v246
    v_mfma_f32_16x16x32_bf16 v[248:251], a[232:235], v[200:203], v[248:251]
    v_exp_f32 v247, v247
    v_mfma_f32_16x16x32_bf16 v[248:251], a[236:239], v[232:235], v[248:251]
    s_waitcnt lgkmcnt(0)
    v_cvt_pk_bf16_f32 v40, v244, v245
    v_cvt_pk_bf16_f32 v41, v246, v247
    v_mfma_f32_16x16x32_bf16 a[16:19], v[104:107], v[64:67], a[16:19]
    ds_read_b128 v[96:99], v2 offset:24576
    ds_read_b128 v[100:103], v2 offset:25600
    v_mfma_f32_16x16x32_bf16 a[16:19], v[108:111], v[68:71], a[16:19]
    v_mfma_f32_16x16x32_bf16 a[20:23], v[104:107], v[72:75], a[20:23]
    v_mfma_f32_16x16x32_bf16 a[20:23], v[108:111], v[76:79], a[20:23]
    v_exp_f32 v248, v248
    v_mfma_f32_16x16x32_bf16 v[252:255], a[224:227], v[140:143], v[156:159]
    v_exp_f32 v249, v249
    v_mfma_f32_16x16x32_bf16 v[252:255], a[228:231], v[172:175], v[252:255]
    v_exp_f32 v250, v250
    v_mfma_f32_16x16x32_bf16 v[252:255], a[232:235], v[204:207], v[252:255]
    v_exp_f32 v251, v251
    v_mfma_f32_16x16x32_bf16 v[252:255], a[236:239], v[236:239], v[252:255]
    v_cvt_pk_bf16_f32 v48, v248, v249
    v_cvt_pk_bf16_f32 v49, v250, v251
    v_mfma_f32_16x16x32_bf16 a[24:27], v[104:107], v[80:83], a[24:27]
    ds_read_b128 a[224:227], v2 offset:8192
    ds_read_b128 a[228:231], v2 offset:9216
    v_mfma_f32_16x16x32_bf16 a[24:27], v[108:111], v[84:87], a[24:27]
    buffer_load_dwordx4 v1, s[36:39], s77 offen offset:2048 sc1 lds
    v_mfma_f32_16x16x32_bf16 a[28:31], v[104:107], v[88:91], a[28:31]
    v_exp_f32 v252, v252
    v_mfma_f32_16x16x32_bf16 a[28:31], v[108:111], v[92:95], a[28:31]
    v_exp_f32 v253, v253
    v_mfma_f32_16x16x32_bf16 v[240:243], a[240:243], v[128:131], v[180:183]
    v_exp_f32 v254, v254
    v_mfma_f32_16x16x32_bf16 v[240:243], a[244:247], v[160:163], v[240:243]
    v_exp_f32 v255, v255
    v_mfma_f32_16x16x32_bf16 v[240:243], a[248:251], v[192:195], v[240:243]
    v_cvt_pk_bf16_f32 v56, v252, v253
    v_cvt_pk_bf16_f32 v57, v254, v255
    v_mfma_f32_16x16x32_bf16 v[240:243], a[252:255], v[224:227], v[240:243]
    ds_read_b128 a[232:235], v2 offset:10240
    ds_read_b128 a[236:239], v2 offset:11264
    v_mfma_f32_16x16x32_bf16 a[32:35], v[112:115], v[64:67], a[32:35]
    ds_read_b128 v[104:107], v2 offset:26624
    v_mfma_f32_16x16x32_bf16 a[32:35], v[116:119], v[68:71], a[32:35]
    ds_read_b128 v[108:111], v2 offset:27648
    v_mfma_f32_16x16x32_bf16 a[36:39], v[112:115], v[72:75], a[36:39]
    v_mfma_f32_16x16x32_bf16 a[36:39], v[116:119], v[76:79], a[36:39]
    v_exp_f32 v240, v240
    v_mfma_f32_16x16x32_bf16 v[244:247], a[240:243], v[132:135], v[148:151]
    v_exp_f32 v241, v241
    v_mfma_f32_16x16x32_bf16 v[244:247], a[244:247], v[164:167], v[244:247]
    v_exp_f32 v242, v242
    v_mfma_f32_16x16x32_bf16 v[244:247], a[248:251], v[196:199], v[244:247]
    v_exp_f32 v243, v243
    v_mfma_f32_16x16x32_bf16 v[244:247], a[252:255], v[228:231], v[244:247]
    buffer_load_dwordx4 v1, s[36:39], s77 offen offset:3072 sc1 lds
    v_mfma_f32_16x16x32_bf16 a[40:43], v[112:115], v[80:83], a[40:43]
    v_cvt_pk_bf16_f32 v34, v240, v241
    v_cvt_pk_bf16_f32 v35, v242, v243
    v_mfma_f32_16x16x32_bf16 a[40:43], v[116:119], v[84:87], a[40:43]
    v_mfma_f32_16x16x32_bf16 a[44:47], v[112:115], v[88:91], a[44:47]
    ds_read_b128 v[112:115], v2 offset:28672
    v_mfma_f32_16x16x32_bf16 a[44:47], v[116:119], v[92:95], a[44:47]
    v_exp_f32 v244, v244
    v_mfma_f32_16x16x32_bf16 v[248:251], a[240:243], v[136:139], v[152:155]
    v_exp_f32 v245, v245
    v_mfma_f32_16x16x32_bf16 v[248:251], a[244:247], v[168:171], v[248:251]
    v_exp_f32 v246, v246
    v_mfma_f32_16x16x32_bf16 v[248:251], a[248:251], v[200:203], v[248:251]
    v_exp_f32 v247, v247
    v_mfma_f32_16x16x32_bf16 v[248:251], a[252:255], v[232:235], v[248:251]
    v_cvt_pk_bf16_f32 v42, v244, v245
    v_cvt_pk_bf16_f32 v43, v246, v247
    v_mfma_f32_16x16x32_bf16 a[48:51], v[120:123], v[64:67], a[48:51]
    ds_read_b128 v[116:119], v2 offset:29696
    v_mfma_f32_16x16x32_bf16 a[48:51], v[124:127], v[68:71], a[48:51]
    v_mfma_f32_16x16x32_bf16 a[52:55], v[120:123], v[72:75], a[52:55]
    v_mfma_f32_16x16x32_bf16 a[52:55], v[124:127], v[76:79], a[52:55]
    v_mfma_f32_16x16x32_bf16 v[252:255], a[240:243], v[140:143], v[156:159]
    v_exp_f32 v248, v248
    v_mfma_f32_16x16x32_bf16 v[252:255], a[244:247], v[172:175], v[252:255]
    s_add_u32 s100, s77, 4096
    v_exp_f32 v249, v249
    v_mfma_f32_16x16x32_bf16 v[252:255], a[248:251], v[204:207], v[252:255]
    s_add_u32 m0, m0, 4096
    v_exp_f32 v250, v250
    v_mfma_f32_16x16x32_bf16 v[252:255], a[252:255], v[236:239], v[252:255]
    buffer_load_dwordx4 v1, s[36:39], s100 offen sc1 lds
    v_mfma_f32_16x16x32_bf16 a[56:59], v[120:123], v[80:83], a[56:59]
    v_exp_f32 v251, v251
    v_mfma_f32_16x16x32_bf16 a[56:59], v[124:127], v[84:87], a[56:59]
    v_cvt_pk_bf16_f32 v50, v248, v249
    v_cvt_pk_bf16_f32 v51, v250, v251
    v_mfma_f32_16x16x32_bf16 a[60:63], v[120:123], v[88:91], a[60:63]
    ds_read_b128 a[240:243], v2 offset:12288
    ds_read_b128 a[244:247], v2 offset:13312
    v_mfma_f32_16x16x32_bf16 a[60:63], v[124:127], v[92:95], a[60:63]
    s_waitcnt lgkmcnt(2)
    v_exp_f32 v252, v252
    v_mfma_f32_16x16x32_bf16 v[240:243], a[224:227], v[128:131], v[184:187]
    v_exp_f32 v253, v253
    v_mfma_f32_16x16x32_bf16 v[240:243], a[228:231], v[160:163], v[240:243]
    v_exp_f32 v254, v254
    v_mfma_f32_16x16x32_bf16 v[240:243], a[232:235], v[192:195], v[240:243]
    v_exp_f32 v255, v255
    v_mfma_f32_16x16x32_bf16 v[240:243], a[236:239], v[224:227], v[240:243]
    v_cvt_pk_bf16_f32 v58, v252, v253
    v_cvt_pk_bf16_f32 v59, v254, v255
    v_mfma_f32_16x16x32_bf16 a[144:147], v[96:99], v[64:67], a[144:147]
    ds_read_b128 a[248:251], v2 offset:14336
    ds_read_b128 a[252:255], v2 offset:15360
    v_mfma_f32_16x16x32_bf16 a[144:147], v[100:103], v[68:71], a[144:147]
    ds_read_b128 v[120:123], v2 offset:30720
    v_mfma_f32_16x16x32_bf16 a[148:151], v[96:99], v[72:75], a[148:151]
    v_exp_f32 v240, v240
    v_mfma_f32_16x16x32_bf16 a[148:151], v[100:103], v[76:79], a[148:151]
    v_exp_f32 v241, v241
    v_mfma_f32_16x16x32_bf16 v[244:247], a[224:227], v[132:135], v[148:151]
    buffer_load_dwordx4 v1, s[36:39], s100 offen offset:1024 sc1 lds
    v_mfma_f32_16x16x32_bf16 v[244:247], a[228:231], v[164:167], v[244:247]
    v_exp_f32 v242, v242
    v_mfma_f32_16x16x32_bf16 v[244:247], a[232:235], v[196:199], v[244:247]
    v_exp_f32 v243, v243
    v_mfma_f32_16x16x32_bf16 v[244:247], a[236:239], v[228:231], v[244:247]
    v_cvt_pk_bf16_f32 v36, v240, v241
    v_cvt_pk_bf16_f32 v37, v242, v243
    v_mfma_f32_16x16x32_bf16 a[152:155], v[96:99], v[80:83], a[152:155]
    ds_read_b128 v[124:127], v2 offset:31744
    v_mfma_f32_16x16x32_bf16 a[152:155], v[100:103], v[84:87], a[152:155]
    v_mfma_f32_16x16x32_bf16 a[156:159], v[96:99], v[88:91], a[156:159]
    v_mfma_f32_16x16x32_bf16 a[156:159], v[100:103], v[92:95], a[156:159]
    v_mfma_f32_16x16x32_bf16 v[248:251], a[224:227], v[136:139], v[152:155]
    v_exp_f32 v244, v244
    v_mfma_f32_16x16x32_bf16 v[248:251], a[228:231], v[168:171], v[248:251]
    v_exp_f32 v245, v245
    v_mfma_f32_16x16x32_bf16 v[248:251], a[232:235], v[200:203], v[248:251]
    v_exp_f32 v246, v246
    v_mfma_f32_16x16x32_bf16 v[248:251], a[236:239], v[232:235], v[248:251]
    v_exp_f32 v247, v247
    v_mfma_f32_16x16x32_bf16 a[160:163], v[104:107], v[64:67], a[160:163]
    v_cvt_pk_bf16_f32 v44, v244, v245
    v_cvt_pk_bf16_f32 v45, v246, v247
    v_mfma_f32_16x16x32_bf16 a[160:163], v[108:111], v[68:71], a[160:163]
    v_mfma_f32_16x16x32_bf16 a[164:167], v[104:107], v[72:75], a[164:167]
    buffer_load_dwordx4 v1, s[36:39], s100 offen offset:2048 sc1 lds
    v_mfma_f32_16x16x32_bf16 a[164:167], v[108:111], v[76:79], a[164:167]
    v_exp_f32 v248, v248
    v_mfma_f32_16x16x32_bf16 v[252:255], a[224:227], v[140:143], v[156:159]
    v_exp_f32 v249, v249
    v_mfma_f32_16x16x32_bf16 v[252:255], a[228:231], v[172:175], v[252:255]
    v_exp_f32 v250, v250
    v_mfma_f32_16x16x32_bf16 v[252:255], a[232:235], v[204:207], v[252:255]
    v_exp_f32 v251, v251
    v_mfma_f32_16x16x32_bf16 v[252:255], a[236:239], v[236:239], v[252:255]
    v_cvt_pk_bf16_f32 v52, v248, v249
    v_cvt_pk_bf16_f32 v53, v250, v251
    v_mfma_f32_16x16x32_bf16 a[168:171], v[104:107], v[80:83], a[168:171]
    v_mfma_f32_16x16x32_bf16 a[168:171], v[108:111], v[84:87], a[168:171]
    v_mfma_f32_16x16x32_bf16 a[172:175], v[104:107], v[88:91], a[172:175]
    v_mfma_f32_16x16x32_bf16 a[172:175], v[108:111], v[92:95], a[172:175]
    s_waitcnt lgkmcnt(0)
    v_mfma_f32_16x16x32_bf16 v[240:243], a[240:243], v[128:131], v[188:191]
    v_mfma_f32_16x16x32_bf16 v[240:243], a[244:247], v[160:163], v[240:243]
    v_exp_f32 v252, v252
    v_mfma_f32_16x16x32_bf16 v[240:243], a[248:251], v[192:195], v[240:243]
    v_exp_f32 v253, v253
    v_mfma_f32_16x16x32_bf16 v[240:243], a[252:255], v[224:227], v[240:243]
    v_exp_f32 v254, v254
    v_mfma_f32_16x16x32_bf16 a[176:179], v[112:115], v[64:67], a[176:179]
    buffer_load_dwordx4 v1, s[36:39], s100 offen offset:3072 sc1 lds
    v_mfma_f32_16x16x32_bf16 a[176:179], v[116:119], v[68:71], a[176:179]
    v_exp_f32 v255, v255
    v_mfma_f32_16x16x32_bf16 a[180:183], v[112:115], v[72:75], a[180:183]
    v_cvt_pk_bf16_f32 v60, v252, v253
    v_cvt_pk_bf16_f32 v61, v254, v255
    v_mfma_f32_16x16x32_bf16 a[180:183], v[116:119], v[76:79], a[180:183]
    s_cmp_eq_u32 s82, 163840
    s_cselect_b32 s82, 0, s82
    v_add_u32 v2, s82, v1
    v_mfma_f32_16x16x32_bf16 v[244:247], a[240:243], v[132:135], v[148:151]
    v_exp_f32 v240, v240
    v_mfma_f32_16x16x32_bf16 v[244:247], a[244:247], v[164:167], v[244:247]
    v_exp_f32 v241, v241
    v_mfma_f32_16x16x32_bf16 v[244:247], a[248:251], v[196:199], v[244:247]
    v_exp_f32 v242, v242
    v_mfma_f32_16x16x32_bf16 v[244:247], a[252:255], v[228:231], v[244:247]
    v_exp_f32 v243, v243
    v_mfma_f32_16x16x32_bf16 a[184:187], v[112:115], v[80:83], a[184:187]
    v_cvt_pk_bf16_f32 v38, v240, v241
    v_cvt_pk_bf16_f32 v39, v242, v243
    v_mfma_f32_16x16x32_bf16 a[184:187], v[116:119], v[84:87], a[184:187]
    v_mfma_f32_16x16x32_bf16 a[188:191], v[112:115], v[88:91], a[188:191]
    v_mfma_f32_16x16x32_bf16 a[188:191], v[116:119], v[92:95], a[188:191]
    v_mfma_f32_16x16x32_bf16 v[248:251], a[240:243], v[136:139], v[152:155]
    v_exp_f32 v244, v244
    v_mfma_f32_16x16x32_bf16 v[248:251], a[244:247], v[168:171], v[248:251]
    v_exp_f32 v245, v245
    v_mfma_f32_16x16x32_bf16 v[248:251], a[248:251], v[200:203], v[248:251]
    s_add_u32 s77, s77, 32768
    v_exp_f32 v246, v246
    v_mfma_f32_16x16x32_bf16 v[248:251], a[252:255], v[232:235], v[248:251]
    v_exp_f32 v247, v247
    v_mfma_f32_16x16x32_bf16 a[192:195], v[120:123], v[64:67], a[192:195]
    v_cvt_pk_bf16_f32 v46, v244, v245
    v_cvt_pk_bf16_f32 v47, v246, v247
    v_mfma_f32_16x16x32_bf16 a[192:195], v[124:127], v[68:71], a[192:195]
    v_mfma_f32_16x16x32_bf16 a[196:199], v[120:123], v[72:75], a[196:199]
    v_mfma_f32_16x16x32_bf16 a[196:199], v[124:127], v[76:79], a[196:199]
    v_mfma_f32_16x16x32_bf16 v[252:255], a[240:243], v[140:143], v[156:159]
    v_exp_f32 v248, v248
    v_mfma_f32_16x16x32_bf16 v[252:255], a[244:247], v[172:175], v[252:255]
    v_exp_f32 v249, v249
    v_mfma_f32_16x16x32_bf16 v[252:255], a[248:251], v[204:207], v[252:255]
    v_exp_f32 v250, v250
    v_mfma_f32_16x16x32_bf16 v[252:255], a[252:255], v[236:239], v[252:255]
    s_waitcnt vmcnt(8) lgkmcnt(0)
    s_barrier
    ds_read_b128 a[224:227], v2 offset:0
    v_mfma_f32_16x16x32_bf16 a[200:203], v[120:123], v[80:83], a[200:203]
    ds_read_b128 a[228:231], v2 offset:1024
    ds_read_b128 a[232:235], v2 offset:2048
    v_mfma_f32_16x16x32_bf16 a[200:203], v[124:127], v[84:87], a[200:203]
    ds_read_b128 a[236:239], v2 offset:3072
    v_cvt_pk_bf16_f32 v54, v248, v249
    v_mfma_f32_16x16x32_bf16 a[204:207], v[120:123], v[88:91], a[204:207]
    v_exp_f32 v251, v251
    v_mfma_f32_16x16x32_bf16 a[204:207], v[124:127], v[92:95], a[204:207]
    ds_read_b128 v[96:99], v2 offset:16384
    ds_read_b128 v[100:103], v2 offset:17408
    v_mfma_f32_16x16x32_bf16 a[208:211], a[136:139], v[64:67], a[208:211]
    v_exp_f32 v252, v252
    v_mfma_f32_16x16x32_bf16 a[208:211], a[136:139], v[68:71], a[208:211]
    v_exp_f32 v253, v253
    v_mfma_f32_16x16x32_bf16 a[212:215], a[136:139], v[72:75], a[212:215]
    v_cvt_pk_bf16_f32 v55, v250, v251
    v_cvt_pk_bf16_f32 v62, v252, v253
    v_mfma_f32_16x16x32_bf16 a[212:215], a[136:139], v[76:79], a[212:215]
    v_mfma_f32_16x16x32_bf16 a[216:219], a[136:139], v[80:83], a[216:219]
    v_mfma_f32_16x16x32_bf16 a[216:219], a[136:139], v[84:87], a[216:219]
    v_mfma_f32_16x16x32_bf16 a[220:223], a[136:139], v[88:91], a[220:223]
    v_mfma_f32_16x16x32_bf16 a[220:223], a[136:139], v[92:95], a[220:223]
    s_sub_u32 s78, s78, 1
    s_cmp_lg_u32 s78, 0
    s_cbranch_scc1 K1_LB
K1_LB_END:
    v_add_f32 v212, s12, v148
    v_fma_f32 v176, v208, s8, v212
    v_fma_f32 v177, v209, s8, v212
    v_fma_f32 v178, v210, s8, v212
    v_fma_f32 v179, v211, s8, v212
    s_nop 1
    s_waitcnt lgkmcnt(0)
    v_mfma_f32_16x16x32_bf16 v[240:243], a[224:227], v[132:135], v[176:179]
    s_mov_b32 s7, 0
    ds_read_b128 v[104:107], v2 offset:18432
    ds_read_b128 v[108:111], v2 offset:19456
    v_mfma_f32_16x16x32_bf16 v[240:243], a[228:231], v[164:167], v[240:243]
    s_mov_b32 s98, 0x3fb8aa3b
    buffer_load_dwordx4 v[64:67], v11, s[48:51], s7 offen nt
    v_mfma_f32_16x16x32_bf16 v[240:243], a[232:235], v[196:199], v[240:243]
    s_mov_b32 s7, 18432
    v_exp_f32 v254, v254
    v_mfma_f32_16x16x32_bf16 v[240:243], a[236:239], v[228:231], v[240:243]
    v_exp_f32 v255, v255
    v_mfma_f32_16x16x32_bf16 a[0:3], v[96:99], v[32:35], a[0:3]
    v_cvt_pk_bf16_f32 v63, v254, v255
    ds_read_b128 a[240:243], v2 offset:4096
    v_mfma_f32_16x16x32_bf16 a[0:3], v[100:103], v[36:39], a[0:3]
    buffer_load_dwordx4 v[68:71], v11, s[48:51], s7 offen nt
    v_mfma_f32_16x16x32_bf16 a[4:7], v[96:99], v[40:43], a[4:7]
    s_mov_b32 s7, 9216
    ds_read_b128 a[244:247], v2 offset:5120
    ds_read_b128 a[248:251], v2 offset:6144
    v_mfma_f32_16x16x32_bf16 a[4:7], v[100:103], v[44:47], a[4:7]
    ds_read_b128 a[252:255], v2 offset:7168
    v_add_f32 v213, s13, v148
    v_mfma_f32_16x16x32_bf16 v[244:247], a[224:227], v[136:139], v[152:155]
    ds_read_b128 v[112:115], v2 offset:20480
    v_fma_f32 v180, v208, s9, v213
    v_mfma_f32_16x16x32_bf16 v[244:247], a[228:231], v[168:171], v[244:247]
    buffer_load_dwordx4 v[20:23], v11, s[48:51], s7 offen nt
    v_mfma_f32_16x16x32_bf16 v[244:247], a[232:235], v[200:203], v[244:247]
    s_mov_b32 s7, 27648
    ds_read_b128 v[116:119], v2 offset:21504
    v_fma_f32 v181, v209, s9, v213
    v_mfma_f32_16x16x32_bf16 v[244:247], a[236:239], v[232:235], v[244:247]
    v_fma_f32 v182, v210, s9, v213
    v_fma_f32 v183, v211, s9, v213
    v_mfma_f32_16x16x32_bf16 a[8:11], v[96:99], v[48:51], a[8:11]
    v_exp_f32 v240, v240
    v_mfma_f32_16x16x32_bf16 a[8:11], v[100:103], v[52:55], a[8:11]
    buffer_load_dwordx4 v[24:27], v11, s[48:51], s7 offen nt
    v_mfma_f32_16x16x32_bf16 a[12:15], v[96:99], v[56:59], a[12:15]
    v_exp_f32 v241, v241
    v_mfma_f32_16x16x32_bf16 a[12:15], v[100:103], v[60:63], a[12:15]
    s_waitcnt lgkmcnt(0)
    v_exp_f32 v242, v242
    v_mfma_f32_16x16x32_bf16 a[16:19], v[104:107], v[32:35], a[16:19]
    v_exp_f32 v243, v243
    v_mfma_f32_16x16x32_bf16 a[16:19], v[108:111], v[36:39], a[16:19]
    buffer_load_dwordx4 v[144:147], v12, s[52:55], 0 offen nt
    v_mfma_f32_16x16x32_bf16 v[248:251], a[224:227], v[140:143], v[156:159]
    v_cvt_pk_bf16_f32 v72, v240, v241
    v_cvt_pk_bf16_f32 v73, v242, v243
    v_mfma_f32_16x16x32_bf16 v[248:251], a[228:231], v[172:175], v[248:251]
    ds_read_b128 v[120:123], v2 offset:22528
    ds_read_b128 v[124:127], v2 offset:23552
    v_mfma_f32_16x16x32_bf16 v[248:251], a[232:235], v[204:207], v[248:251]
    v_exp_f32 v244, v244
    v_mfma_f32_16x16x32_bf16 v[248:251], a[236:239], v[236:239], v[248:251]
    buffer_load_dwordx4 a[140:143], v13, s[52:55], 0 offen nt
    v_mfma_f32_16x16x32_bf16 a[20:23], v[104:107], v[40:43], a[20:23]
    v_exp_f32 v245, v245
    v_mfma_f32_16x16x32_bf16 a[20:23], v[108:111], v[44:47], a[20:23]
    v_exp_f32 v246, v246
    v_mfma_f32_16x16x32_bf16 a[24:27], v[104:107], v[48:51], a[24:27]
    v_exp_f32 v247, v247
    v_mfma_f32_16x16x32_bf16 a[24:27], v[108:111], v[52:55], a[24:27]
    v_cvt_pk_bf16_f32 v80, v244, v245
    v_cvt_pk_bf16_f32 v81, v246, v247
    v_mfma_f32_16x16x32_bf16 a[28:31], v[104:107], v[56:59], a[28:31]
    ds_read_b128 a[224:227], v2 offset:8192
    ds_read_b128 a[228:231], v2 offset:9216
    v_mfma_f32_16x16x32_bf16 a[28:31], v[108:111], v[60:63], a[28:31]
    ds_read_b128 a[232:235], v2 offset:10240
    v_add_f32 v214, s14, v148
    v_mfma_f32_16x16x32_bf16 v[252:255], a[240:243], v[132:135], v[180:183]
    ds_read_b128 a[236:239], v2 offset:11264
    v_fma_f32 v184, v208, s10, v214
    v_mfma_f32_16x16x32_bf16 v[252:255], a[244:247], v[164:167], v[252:255]
    ds_read_b128 v[96:99], v2 offset:24576
    v_fma_f32 v185, v209, s10, v214
    v_mfma_f32_16x16x32_bf16 v[252:255], a[248:251], v[196:199], v[252:255]
    ds_read_b128 v[100:103], v2 offset:25600
    v_fma_f32 v186, v210, s10, v214
    v_mfma_f32_16x16x32_bf16 v[252:255], a[252:255], v[228:231], v[252:255]
    v_exp_f32 v248, v248
    v_mfma_f32_16x16x32_bf16 a[32:35], v[112:115], v[32:35], a[32:35]
    v_exp_f32 v249, v249
    v_mfma_f32_16x16x32_bf16 a[32:35], v[116:119], v[36:39], a[32:35]
    v_exp_f32 v250, v250
    v_mfma_f32_16x16x32_bf16 a[36:39], v[112:115], v[40:43], a[36:39]
    v_exp_f32 v251, v251
    v_mfma_f32_16x16x32_bf16 a[36:39], v[116:119], v[44:47], a[36:39]
    v_fma_f32 v187, v211, s10, v214
    v_cvt_pk_bf16_f32 v88, v248, v249
    v_mfma_f32_16x16x32_bf16 v[240:243], a[240:243], v[136:139], v[152:155]
    v_cvt_pk_bf16_f32 v89, v250, v251
    ds_read_b128 v[104:107], v2 offset:26624
    v_mfma_f32_16x16x32_bf16 v[240:243], a[244:247], v[168:171], v[240:243]
    v_exp_f32 v252, v252
    v_mfma_f32_16x16x32_bf16 v[240:243], a[248:251], v[200:203], v[240:243]
    v_exp_f32 v253, v253
    v_mfma_f32_16x16x32_bf16 v[240:243], a[252:255], v[232:235], v[240:243]
    v_exp_f32 v254, v254
    v_mfma_f32_16x16x32_bf16 a[40:43], v[112:115], v[48:51], a[40:43]
    v_exp_f32 v255, v255
    v_mfma_f32_16x16x32_bf16 a[40:43], v[116:119], v[52:55], a[40:43]
    v_cvt_pk_bf16_f32 v74, v252, v253
    v_cvt_pk_bf16_f32 v75, v254, v255
    v_mfma_f32_16x16x32_bf16 a[44:47], v[112:115], v[56:59], a[44:47]
    ds_read_b128 v[108:111], v2 offset:27648
    ds_read_b128 v[112:115], v2 offset:28672
    v_mfma_f32_16x16x32_bf16 a[44:47], v[116:119], v[60:63], a[44:47]
    s_waitcnt lgkmcnt(2)
    v_exp_f32 v240, v240
    v_mfma_f32_16x16x32_bf16 a[48:51], v[120:123], v[32:35], a[48:51]
    v_exp_f32 v241, v241
    v_mfma_f32_16x16x32_bf16 a[48:51], v[124:127], v[36:39], a[48:51]
    v_exp_f32 v242, v242
    v_mfma_f32_16x16x32_bf16 v[244:247], a[240:243], v[140:143], v[156:159]
    v_exp_f32 v243, v243
    v_mfma_f32_16x16x32_bf16 v[244:247], a[244:247], v[172:175], v[244:247]
    v_cvt_pk_bf16_f32 v82, v240, v241
    v_cvt_pk_bf16_f32 v83, v242, v243
    v_mfma_f32_16x16x32_bf16 v[244:247], a[248:251], v[204:207], v[244:247]
    ds_read_b128 a[240:243], v2 offset:12288
    ds_read_b128 a[244:247], v2 offset:13312
    v_mfma_f32_16x16x32_bf16 v[244:247], a[252:255], v[236:239], v[244:247]
    ds_read_b128 a[248:251], v2 offset:14336
    v_add_f32 v215, s15, v148
    v_mfma_f32_16x16x32_bf16 a[52:55], v[120:123], v[40:43], a[52:55]
    ds_read_b128 a[252:255], v2 offset:15360
    v_fma_f32 v188, v208, s11, v215
    v_mfma_f32_16x16x32_bf16 a[52:55], v[124:127], v[44:47], a[52:55]
    ds_read_b128 v[116:119], v2 offset:29696
    v_fma_f32 v189, v209, s11, v215
    v_mfma_f32_16x16x32_bf16 a[56:59], v[120:123], v[48:51], a[56:59]
    v_exp_f32 v244, v244
    v_mfma_f32_16x16x32_bf16 a[56:59], v[124:127], v[52:55], a[56:59]
    v_exp_f32 v245, v245
    v_mfma_f32_16x16x32_bf16 a[60:63], v[120:123], v[56:59], a[60:63]
    v_exp_f32 v246, v246
    v_mfma_f32_16x16x32_bf16 a[60:63], v[124:127], v[60:63], a[60:63]
    v_exp_f32 v247, v247
    v_mfma_f32_16x16x32_bf16 v[248:251], a[224:227], v[132:135], v[184:187]
    v_fma_f32 v190, v210, s11, v215
    v_fma_f32 v191, v211, s11, v215
    v_mfma_f32_16x16x32_bf16 v[248:251], a[228:231], v[164:167], v[248:251]
    v_cvt_pk_bf16_f32 v90, v244, v245
    v_cvt_pk_bf16_f32 v91, v246, v247
    v_mfma_f32_16x16x32_bf16 v[248:251], a[232:235], v[196:199], v[248:251]
    ds_read_b128 v[120:123], v2 offset:30720
    ds_read_b128 v[124:127], v2 offset:31744
    v_mfma_f32_16x16x32_bf16 v[248:251], a[236:239], v[228:231], v[248:251]
    s_add_u32 m0, s76, s75
    v_bfe_u32 v8, v1, 2, 6
    v_accvgpr_read_b32 v4, a112
    v_mfma_f32_16x16x32_bf16 a[144:147], v[96:99], v[32:35], a[144:147]
    s_mov_b32 s76, s60
    buffer_load_dwordx4 v1, s[36:39], s77 offen sc1 lds
    v_mfma_f32_16x16x32_bf16 a[144:147], v[100:103], v[36:39], a[144:147]
    s_mov_b32 s60, s82
    v_exp_f32 v248, v248
    v_mfma_f32_16x16x32_bf16 a[148:151], v[96:99], v[40:43], a[148:151]
    s_add_u32 s82, s82, 32768
    v_exp_f32 v249, v249
    v_mfma_f32_16x16x32_bf16 a[148:151], v[100:103], v[44:47], a[148:151]
    v_exp_f32 v250, v250
    v_mfma_f32_16x16x32_bf16 v[252:255], a[224:227], v[136:139], v[152:155]
    v_exp_f32 v251, v251
    v_mfma_f32_16x16x32_bf16 v[252:255], a[228:231], v[168:171], v[252:255]
    v_cvt_pk_bf16_f32 v76, v248, v249
    v_cvt_pk_bf16_f32 v77, v250, v251
    v_mfma_f32_16x16x32_bf16 v[252:255], a[232:235], v[200:203], v[252:255]
    s_cmp_eq_u32 s82, 163840
    s_cselect_b32 s82, 0, s82
    v_add_u32 v2, s82, v1
    v_mfma_f32_16x16x32_bf16 v[252:255], a[236:239], v[232:235], v[252:255]
    buffer_load_dwordx4 v1, s[36:39], s77 offen offset:1024 sc1 lds
    v_mfma_f32_16x16x32_bf16 a[152:155], v[96:99], v[48:51], a[152:155]
    v_accvgpr_read_b32 v5, a116
    v_add_u32 v8, 192, v8
    v_mfma_f32_16x16x32_bf16 a[152:155], v[100:103], v[52:55], a[152:155]
    v_cvt_pk_bf16_f32 v4, 0, v4
    v_cvt_pk_bf16_f32 v5, 0, v5
    v_mfma_f32_16x16x32_bf16 a[156:159], v[96:99], v[56:59], a[156:159]
    v_exp_f32 v252, v252
    v_mfma_f32_16x16x32_bf16 a[156:159], v[100:103], v[60:63], a[156:159]
    v_exp_f32 v253, v253
    v_mfma_f32_16x16x32_bf16 a[160:163], v[104:107], v[32:35], a[160:163]
    s_waitcnt lgkmcnt(0)
    v_exp_f32 v254, v254
    v_mfma_f32_16x16x32_bf16 a[160:163], v[108:111], v[36:39], a[160:163]
    v_exp_f32 v255, v255
    v_mfma_f32_16x16x32_bf16 v[240:243], a[224:227], v[140:143], v[156:159]
    v_cvt_pk_bf16_f32 v84, v252, v253
    v_cvt_pk_bf16_f32 v85, v254, v255
    v_mfma_f32_16x16x32_bf16 v[240:243], a[228:231], v[172:175], v[240:243]
    buffer_load_dwordx4 v1, s[36:39], s77 offen offset:2048 sc1 lds
    v_mfma_f32_16x16x32_bf16 v[240:243], a[232:235], v[204:207], v[240:243]
    v_lshrrev_b32 v15, 8, v1
    ds_bpermute_b32 v4, v8, v4
    v_mfma_f32_16x16x32_bf16 v[240:243], a[236:239], v[236:239], v[240:243]
    ds_bpermute_b32 v5, v8, v5
    ds_read_b128 a[224:227], v2 offset:0
    v_mfma_f32_16x16x32_bf16 a[164:167], v[104:107], v[40:43], a[164:167]
    ds_read_b128 a[228:231], v2 offset:1024
    v_bfe_u32 v14, v1, 4, 4
    v_mfma_f32_16x16x32_bf16 a[164:167], v[108:111], v[44:47], a[164:167]
    ds_read_b128 a[232:235], v2 offset:2048
    v_lshlrev_b32 v15, 3, v15
    v_mfma_f32_16x16x32_bf16 a[168:171], v[104:107], v[48:51], a[168:171]
    ds_read_b128 a[236:239], v2 offset:3072
    v_sub_u32 v14, v14, v15
    v_mfma_f32_16x16x32_bf16 a[168:171], v[108:111], v[52:55], a[168:171]
    ds_read_b128 v[96:99], v2 offset:16384
    v_and_b32 v15, 16, v1
    v_mfma_f32_16x16x32_bf16 a[172:175], v[104:107], v[56:59], a[172:175]
    buffer_load_dwordx4 v1, s[36:39], s77 offen offset:3072 sc1 lds
    v_mfma_f32_16x16x32_bf16 a[172:175], v[108:111], v[60:63], a[172:175]
    ds_read_b128 v[100:103], v2 offset:17408
    v_mov_b32 v31, 0x3f80
    v_mfma_f32_16x16x32_bf16 v[244:247], a[240:243], v[132:135], v[188:191]
    v_exp_f32 v240, v240
    v_mfma_f32_16x16x32_bf16 v[244:247], a[244:247], v[164:167], v[244:247]
    v_exp_f32 v241, v241
    v_mfma_f32_16x16x32_bf16 v[244:247], a[248:251], v[196:199], v[244:247]
    v_exp_f32 v242, v242
    v_mfma_f32_16x16x32_bf16 v[244:247], a[252:255], v[228:231], v[244:247]
    v_exp_f32 v243, v243
    v_mfma_f32_16x16x32_bf16 a[176:179], v[112:115], v[32:35], a[176:179]
    v_cvt_pk_bf16_f32 v92, v240, v241
    v_cvt_pk_bf16_f32 v93, v242, v243
    v_mfma_f32_16x16x32_bf16 a[176:179], v[116:119], v[36:39], a[176:179]
    s_add_u32 s100, s77, 4096
    v_ashrrev_i32 v14, 1, v14
    v_lshlrev_b32 v15, v15, v31
    v_mfma_f32_16x16x32_bf16 a[180:183], v[112:115], v[40:43], a[180:183]
    s_add_u32 m0, m0, 4096
    v_exp_f32 v244, v244
    v_mfma_f32_16x16x32_bf16 a[180:183], v[116:119], v[44:47], a[180:183]
    buffer_load_dwordx4 v1, s[36:39], s100 offen sc1 lds
    v_mfma_f32_16x16x32_bf16 v[248:251], a[240:243], v[136:139], v[152:155]
    v_exp_f32 v245, v245
    v_mfma_f32_16x16x32_bf16 v[248:251], a[244:247], v[168:171], v[248:251]
    v_exp_f32 v246, v246
    v_mfma_f32_16x16x32_bf16 v[248:251], a[248:251], v[200:203], v[248:251]
    v_exp_f32 v247, v247
    v_mfma_f32_16x16x32_bf16 v[248:251], a[252:255], v[232:235], v[248:251]
    v_cvt_pk_bf16_f32 v78, v244, v245
    v_cvt_pk_bf16_f32 v79, v246, v247
    v_mfma_f32_16x16x32_bf16 a[184:187], v[112:115], v[48:51], a[184:187]
    s_waitcnt lgkmcnt(0)
    v_cmp_eq_i32 vcc, 0, v14
    v_mul_f32 v4, s98, v4
    v_mfma_f32_16x16x32_bf16 a[184:187], v[116:119], v[52:55], a[184:187]
    buffer_load_dwordx4 v1, s[36:39], s100 offen offset:1024 sc1 lds
    v_mfma_f32_16x16x32_bf16 a[188:191], v[112:115], v[56:59], a[188:191]
    v_exp_f32 v248, v248
    v_mfma_f32_16x16x32_bf16 a[188:191], v[116:119], v[60:63], a[188:191]
    v_exp_f32 v249, v249
    v_mfma_f32_16x16x32_bf16 a[192:195], v[120:123], v[32:35], a[192:195]
    v_exp_f32 v250, v250
    v_mfma_f32_16x16x32_bf16 a[192:195], v[124:127], v[36:39], a[192:195]
    v_exp_f32 v251, v251
    v_mfma_f32_16x16x32_bf16 v[252:255], a[240:243], v[140:143], v[156:159]
    v_cvt_pk_bf16_f32 v86, v248, v249
    v_cvt_pk_bf16_f32 v87, v250, v251
    v_mfma_f32_16x16x32_bf16 v[252:255], a[244:247], v[172:175], v[252:255]
    v_cndmask_b32 v216, 0, v15, vcc
    v_cmp_eq_i32 vcc, 1, v14
    v_mfma_f32_16x16x32_bf16 v[252:255], a[248:251], v[204:207], v[252:255]
    v_mul_f32 v5, s98, v5
    v_cndmask_b32 v217, 0, v15, vcc
    v_mfma_f32_16x16x32_bf16 v[252:255], a[252:255], v[236:239], v[252:255]
    buffer_load_dwordx4 v1, s[36:39], s100 offen offset:2048 sc1 lds
    v_mfma_f32_16x16x32_bf16 a[196:199], v[120:123], v[40:43], a[196:199]
    v_cmp_eq_i32 vcc, 2, v14
    v_and_b32 v31, 512, v1
    v_mfma_f32_16x16x32_bf16 a[196:199], v[124:127], v[44:47], a[196:199]
    v_cndmask_b32 v218, 0, v15, vcc
    v_cmp_eq_i32 vcc, 3, v14
    v_mfma_f32_16x16x32_bf16 a[200:203], v[120:123], v[48:51], a[200:203]
    v_exp_f32 v252, v252
    v_mfma_f32_16x16x32_bf16 a[200:203], v[124:127], v[52:55], a[200:203]
    v_exp_f32 v253, v253
    v_mfma_f32_16x16x32_bf16 a[204:207], v[120:123], v[56:59], a[204:207]
    v_cvt_pk_bf16_f32 v94, v252, v253
    v_cndmask_b32 v219, 0, v15, vcc
    v_mfma_f32_16x16x32_bf16 a[204:207], v[124:127], v[60:63], a[204:207]
    v_cmp_eq_i32 vcc, -8, v14
    v_mad_u32_u24 v31, v31, 3, v1
    v_mfma_f32_16x16x32_bf16 a[208:211], a[136:139], v[32:35], a[208:211]
    buffer_load_dwordx4 v1, s[36:39], s100 offen offset:3072 sc1 lds
    v_mfma_f32_16x16x32_bf16 a[208:211], a[136:139], v[36:39], a[208:211]
    v_cndmask_b32 v220, 0, v15, vcc
    v_cmp_eq_i32 vcc, -7, v14
    v_mfma_f32_16x16x32_bf16 a[212:215], a[136:139], v[40:43], a[212:215]
    v_exp_f32 v4, v4
    v_mfma_f32_16x16x32_bf16 a[212:215], a[136:139], v[44:47], a[212:215]
    v_exp_f32 v5, v5
    v_mfma_f32_16x16x32_bf16 a[216:219], a[136:139], v[48:51], a[216:219]
    v_cndmask_b32 v221, 0, v15, vcc
    v_cmp_eq_i32 vcc, -6, v14
    v_mfma_f32_16x16x32_bf16 a[216:219], a[136:139], v[52:55], a[216:219]
    v_add_f32 v4, 1.0, v4
    v_add_f32 v5, 1.0, v5
    v_mfma_f32_16x16x32_bf16 a[220:223], a[136:139], v[56:59], a[220:223]
    v_cndmask_b32 v222, 0, v15, vcc
    v_cmp_eq_i32 vcc, -5, v14
    v_mfma_f32_16x16x32_bf16 a[220:223], a[136:139], v[60:63], a[220:223]
    s_add_u32 s77, s77, 32768
    v_rcp_f32 v4, v4
    v_rcp_f32 v5, v5
    v_cndmask_b32 v223, 0, v15, vcc
    s_cmp_eq_u32 s6, 7
    s_cselect_b32 s16, s8, 0
    s_cselect_b32 s17, s9, 0
    s_cselect_b32 s18, s10, 0
    s_cselect_b32 s19, s11, 0
    s_cselect_b32 s20, s12, 0
    s_cselect_b32 s21, s13, 0
    s_cselect_b32 s22, s14, 0
    s_cselect_b32 s23, s15, 0
    v_add_f32 v212, s20, v152
    v_fma_f32 v176, v208, s16, v212
    v_fma_f32 v177, v209, s16, v212
    v_fma_f32 v178, v210, s16, v212
    v_fma_f32 v179, v211, s16, v212
    s_nop 1
    s_waitcnt lgkmcnt(0)
    v_mfma_f32_16x16x32_bf16 v[240:243], a[224:227], v[136:139], v[176:179]
    s_add_u32 m0, s76, s75
    v_exp_f32 v254, v254
    v_mfma_f32_16x16x32_bf16 v[240:243], a[228:231], v[168:171], v[240:243]
    s_mov_b32 s76, s60
    buffer_load_dwordx4 v1, s[36:39], s77 offen sc1 lds
    v_mfma_f32_16x16x32_bf16 v[240:243], a[232:235], v[200:203], v[240:243]
    s_mov_b32 s60, s82
    v_exp_f32 v255, v255
    v_mfma_f32_16x16x32_bf16 v[240:243], a[236:239], v[232:235], v[240:243]
    s_add_u32 s82, s82, 32768
    ds_read_b128 v[104:107], v2 offset:18432
    v_cvt_pk_bf16_f32 v95, v254, v255
    v_mfma_f32_16x16x32_bf16 a[4:7], v[96:99], v[72:75], a[4:7]
    ds_read_b128 v[108:111], v2 offset:19456
    ds_read_b128 a[240:243], v2 offset:4096
    v_mfma_f32_16x16x32_bf16 a[4:7], v[100:103], v[76:79], a[4:7]
    ds_read_b128 a[244:247], v2 offset:5120
    v_add_f32 v213, s21, v152
    v_mfma_f32_16x16x32_bf16 a[8:11], v[96:99], v[80:83], a[8:11]
    ds_read_b128 a[248:251], v2 offset:6144
    v_fma_f32 v180, v208, s17, v213
    v_mfma_f32_16x16x32_bf16 a[8:11], v[100:103], v[84:87], a[8:11]
    ds_read_b128 a[252:255], v2 offset:7168
    v_fma_f32 v181, v209, s17, v213
    v_mfma_f32_16x16x32_bf16 a[12:15], v[96:99], v[88:91], a[12:15]
    ds_read_b128 v[112:115], v2 offset:20480
    v_fma_f32 v182, v210, s17, v213
    v_mfma_f32_16x16x32_bf16 a[12:15], v[100:103], v[92:95], a[12:15]
    ds_read_b128 v[116:119], v2 offset:21504
    v_fma_f32 v183, v211, s17, v213
    v_mfma_f32_16x16x32_bf16 v[244:247], a[224:227], v[140:143], v[156:159]
    buffer_load_dwordx4 v1, s[36:39], s77 offen offset:1024 sc1 lds
    v_mfma_f32_16x16x32_bf16 v[244:247], a[228:231], v[172:175], v[244:247]
    ds_read_b128 v[120:123], v2 offset:22528
    ds_read_b128 v[124:127], v2 offset:23552
    v_mfma_f32_16x16x32_bf16 v[244:247], a[232:235], v[204:207], v[244:247]
    ds_read_b128 a[224:227], v2 offset:8192
    v_add_f32 v214, s22, v152
    v_mfma_f32_16x16x32_bf16 v[244:247], a[236:239], v[236:239], v[244:247]
    s_waitcnt lgkmcnt(4)
    ds_read_b128 a[228:231], v2 offset:9216
    v_fma_f32 v184, v208, s18, v214
    v_mfma_f32_16x16x32_bf16 a[20:23], v[104:107], v[72:75], a[20:23]
    ds_read_b128 a[232:235], v2 offset:10240
    v_fma_f32 v185, v209, s18, v214
    v_mfma_f32_16x16x32_bf16 a[20:23], v[108:111], v[76:79], a[20:23]
    ds_read_b128 a[236:239], v2 offset:11264
    v_fma_f32 v186, v210, s18, v214
    v_mfma_f32_16x16x32_bf16 a[24:27], v[104:107], v[80:83], a[24:27]
    ds_read_b128 v[96:99], v2 offset:24576
    v_fma_f32 v187, v211, s18, v214
    v_mfma_f32_16x16x32_bf16 a[24:27], v[108:111], v[84:87], a[24:27]
    ds_read_b128 v[100:103], v2 offset:25600
    v_add_f32 v215, s23, v152
    v_mfma_f32_16x16x32_bf16 a[28:31], v[104:107], v[88:91], a[28:31]
    v_exp_f32 v240, v240
    v_mfma_f32_16x16x32_bf16 a[28:31], v[108:111], v[92:95], a[28:31]
    v_exp_f32 v241, v241
    v_mfma_f32_16x16x32_bf16 v[248:251], a[240:243], v[136:139], v[180:183]
    buffer_load_dwordx4 v1, s[36:39], s77 offen offset:2048 sc1 lds
    v_mfma_f32_16x16x32_bf16 v[248:251], a[244:247], v[168:171], v[248:251]
    v_exp_f32 v242, v242
    v_mfma_f32_16x16x32_bf16 v[248:251], a[248:251], v[200:203], v[248:251]
    v_exp_f32 v243, v243
    v_mfma_f32_16x16x32_bf16 v[248:251], a[252:255], v[232:235], v[248:251]
    v_cvt_pk_bf16_f32 v48, v240, v241
    v_cvt_pk_bf16_f32 v49, v242, v243
    v_mfma_f32_16x16x32_bf16 a[36:39], v[112:115], v[72:75], a[36:39]
    s_waitcnt lgkmcnt(0)
    ds_read_b128 v[104:107], v2 offset:26624
    ds_read_b128 v[108:111], v2 offset:27648
    v_mfma_f32_16x16x32_bf16 a[36:39], v[116:119], v[76:79], a[36:39]
    v_exp_f32 v244, v244
    v_mfma_f32_16x16x32_bf16 a[40:43], v[112:115], v[80:83], a[40:43]
    v_exp_f32 v245, v245
    v_mfma_f32_16x16x32_bf16 a[40:43], v[116:119], v[84:87], a[40:43]
    v_exp_f32 v246, v246
    v_mfma_f32_16x16x32_bf16 a[44:47], v[112:115], v[88:91], a[44:47]
    v_exp_f32 v247, v247
    v_mfma_f32_16x16x32_bf16 a[44:47], v[116:119], v[92:95], a[44:47]
    s_waitcnt vmcnt(11)
    buffer_load_dwordx4 v1, s[36:39], s77 offen offset:3072 sc1 lds
    v_mfma_f32_16x16x32_bf16 v[12:15], v[64:67], v[216:219], 0
    v_cvt_pk_bf16_f32 v56, v244, v245
    v_cvt_pk_bf16_f32 v57, v246, v247
    v_mfma_f32_16x16x32_bf16 v[16:19], v[68:71], v[216:219], 0
    ds_read_b128 v[112:115], v2 offset:28672
    ds_read_b128 v[116:119], v2 offset:29696
    v_mfma_f32_16x16x32_bf16 v[252:255], a[240:243], v[140:143], v[156:159]
    ds_read_b128 a[240:243], v2 offset:12288
    v_fma_f32 v188, v208, s19, v215
    v_mfma_f32_16x16x32_bf16 v[252:255], a[244:247], v[172:175], v[252:255]
    v_cvt_pk_bf16_f32 v12, v12, v13
    v_cvt_pk_bf16_f32 v13, v14, v15
    v_mfma_f32_16x16x32_bf16 v[252:255], a[248:251], v[204:207], v[252:255]
    v_cvt_pk_bf16_f32 v14, v16, v17
    v_cvt_pk_bf16_f32 v15, v18, v19
    v_mfma_f32_16x16x32_bf16 v[252:255], a[252:255], v[236:239], v[252:255]
    buffer_store_dwordx4 v[12:15], v31, s[56:59], s63 offen offset:0 sc1
    v_mfma_f32_16x16x32_bf16 a[52:55], v[120:123], v[72:75], a[52:55]
    ds_read_b128 a[244:247], v2 offset:13312
    ds_read_b128 a[248:251], v2 offset:14336
    v_mfma_f32_16x16x32_bf16 a[52:55], v[124:127], v[76:79], a[52:55]
    ds_read_b128 a[252:255], v2 offset:15360
    v_fma_f32 v189, v209, s19, v215
    v_mfma_f32_16x16x32_bf16 a[56:59], v[120:123], v[80:83], a[56:59]
    s_add_u32 s100, s77, 4096
    v_exp_f32 v248, v248
    v_mfma_f32_16x16x32_bf16 a[56:59], v[124:127], v[84:87], a[56:59]
    s_add_u32 m0, m0, 4096
    v_exp_f32 v249, v249
    v_mfma_f32_16x16x32_bf16 a[60:63], v[120:123], v[88:91], a[60:63]
    buffer_load_dwordx4 v1, s[36:39], s100 offen sc1 lds
    v_mfma_f32_16x16x32_bf16 a[60:63], v[124:127], v[92:95], a[60:63]
    v_exp_f32 v250, v250
    v_mfma_f32_16x16x32_bf16 v[12:15], v[64:67], v[220:223], 0
    v_exp_f32 v251, v251
    v_mfma_f32_16x16x32_bf16 v[16:19], v[68:71], v[220:223], 0
    v_fma_f32 v190, v210, s19, v215
    v_fma_f32 v191, v211, s19, v215
    v_mfma_f32_16x16x32_bf16 v[240:243], a[224:227], v[136:139], v[184:187]
    v_cvt_pk_bf16_f32 v50, v248, v249
    v_cvt_pk_bf16_f32 v51, v250, v251
    v_mfma_f32_16x16x32_bf16 v[240:243], a[228:231], v[168:171], v[240:243]
    v_cvt_pk_bf16_f32 v12, v12, v13
    v_cvt_pk_bf16_f32 v13, v14, v15
    v_mfma_f32_16x16x32_bf16 v[240:243], a[232:235], v[200:203], v[240:243]
    v_cvt_pk_bf16_f32 v14, v16, v17
    v_cvt_pk_bf16_f32 v15, v18, v19
    v_mfma_f32_16x16x32_bf16 v[240:243], a[236:239], v[232:235], v[240:243]
    buffer_store_dwordx4 v[12:15], v31, s[56:59], s63 offen offset:1024 sc1
    v_mfma_f32_16x16x32_bf16 a[148:151], v[96:99], v[72:75], a[148:151]
    buffer_load_dwordx4 v1, s[36:39], s100 offen offset:1024 sc1 lds
    v_mfma_f32_16x16x32_bf16 a[148:151], v[100:103], v[76:79], a[148:151]
    ds_read_b128 v[120:123], v2 offset:30720
    ds_read_b128 v[124:127], v2 offset:31744
    v_mfma_f32_16x16x32_bf16 a[152:155], v[96:99], v[80:83], a[152:155]
    v_exp_f32 v252, v252
    v_mfma_f32_16x16x32_bf16 a[152:155], v[100:103], v[84:87], a[152:155]
    v_exp_f32 v253, v253
    v_mfma_f32_16x16x32_bf16 a[156:159], v[96:99], v[88:91], a[156:159]
    v_exp_f32 v254, v254
    v_mfma_f32_16x16x32_bf16 a[156:159], v[100:103], v[92:95], a[156:159]
    v_exp_f32 v255, v255
    v_mfma_f32_16x16x32_bf16 v[12:15], v[20:23], v[216:219], 0
    v_cvt_pk_bf16_f32 v58, v252, v253
    v_cvt_pk_bf16_f32 v59, v254, v255
    v_mfma_f32_16x16x32_bf16 v[16:19], v[24:27], v[216:219], 0
    v_exp_f32 v240, v240
    v_mfma_f32_16x16x32_bf16 v[244:247], a[224:227], v[140:143], v[156:159]
    v_exp_f32 v241, v241
    v_mfma_f32_16x16x32_bf16 v[244:247], a[228:231], v[172:175], v[244:247]
    v_exp_f32 v242, v242
    v_mfma_f32_16x16x32_bf16 v[244:247], a[232:235], v[204:207], v[244:247]
    buffer_load_dwordx4 v1, s[36:39], s100 offen offset:2048 sc1 lds
    v_mfma_f32_16x16x32_bf16 v[244:247], a[236:239], v[236:239], v[244:247]
    s_waitcnt lgkmcnt(0)
    v_cvt_pk_bf16_f32 v12, v12, v13
    v_cvt_pk_bf16_f32 v13, v14, v15
    v_mfma_f32_16x16x32_bf16 a[164:167], v[104:107], v[72:75], a[164:167]
    v_cvt_pk_bf16_f32 v14, v16, v17
    v_cvt_pk_bf16_f32 v15, v18, v19
    v_mfma_f32_16x16x32_bf16 a[164:167], v[108:111], v[76:79], a[164:167]
    buffer_store_dwordx4 v[12:15], v31, s[56:59], s63 offen offset:512 sc1
    v_mfma_f32_16x16x32_bf16 a[168:171], v[104:107], v[80:83], a[168:171]
    s_cmp_eq_u32 s82, 163840
    s_cselect_b32 s82, 0, s82
    v_add_u32 v2, s82, v1
    v_mfma_f32_16x16x32_bf16 a[168:171], v[108:111], v[84:87], a[168:171]
    v_exp_f32 v243, v243
    v_mfma_f32_16x16x32_bf16 a[172:175], v[104:107], v[88:91], a[172:175]
    v_exp_f32 v244, v244
    v_mfma_f32_16x16x32_bf16 a[172:175], v[108:111], v[92:95], a[172:175]
    v_exp_f32 v245, v245
    v_mfma_f32_16x16x32_bf16 v[12:15], v[20:23], v[220:223], 0
    v_exp_f32 v246, v246
    v_mfma_f32_16x16x32_bf16 v[16:19], v[24:27], v[220:223], 0
    buffer_load_dwordx4 v1, s[36:39], s100 offen offset:3072 sc1 lds
    v_mfma_f32_16x16x32_bf16 v[248:251], a[240:243], v[136:139], v[188:191]
    v_exp_f32 v247, v247
    v_mfma_f32_16x16x32_bf16 v[248:251], a[244:247], v[168:171], v[248:251]
    v_cvt_pk_bf16_f32 v52, v240, v241
    v_cvt_pk_bf16_f32 v53, v242, v243
    v_mfma_f32_16x16x32_bf16 v[248:251], a[248:251], v[200:203], v[248:251]
    v_cvt_pk_bf16_f32 v12, v12, v13
    v_cvt_pk_bf16_f32 v13, v14, v15
    v_mfma_f32_16x16x32_bf16 v[248:251], a[252:255], v[232:235], v[248:251]
    v_cvt_pk_bf16_f32 v14, v16, v17
    v_cvt_pk_bf16_f32 v15, v18, v19
    v_mfma_f32_16x16x32_bf16 a[180:183], v[112:115], v[72:75], a[180:183]
    buffer_store_dwordx4 v[12:15], v31, s[56:59], s63 offen offset:1536 sc1
    v_mfma_f32_16x16x32_bf16 a[180:183], v[116:119], v[76:79], a[180:183]
    v_cvt_pk_bf16_f32 v60, v244, v245
    v_cvt_pk_bf16_f32 v61, v246, v247
    v_mfma_f32_16x16x32_bf16 a[184:187], v[112:115], v[80:83], a[184:187]
    v_exp_f32 v248, v248
    v_mfma_f32_16x16x32_bf16 a[184:187], v[116:119], v[84:87], a[184:187]
    v_exp_f32 v249, v249
    v_mfma_f32_16x16x32_bf16 a[188:191], v[112:115], v[88:91], a[188:191]
    s_add_u32 s77, s77, 32768
    v_exp_f32 v250, v250
    v_mfma_f32_16x16x32_bf16 a[188:191], v[116:119], v[92:95], a[188:191]
    v_exp_f32 v251, v251
    v_mfma_f32_16x16x32_bf16 v[12:15], v[144:147], v[216:219], 0
    v_cvt_pk_bf16_f32 v54, v248, v249
    v_cvt_pk_bf16_f32 v55, v250, v251
    v_mfma_f32_16x16x32_bf16 v[16:19], a[140:143], v[216:219], 0
    v_accvgpr_read_b32 v6, a120
    v_accvgpr_read_b32 v7, a124
    v_mfma_f32_16x16x32_bf16 v[252:255], a[240:243], v[140:143], v[156:159]
    v_cvt_pk_bf16_f32 v6, 0, v6
    v_cvt_pk_bf16_f32 v7, 0, v7
    v_mfma_f32_16x16x32_bf16 v[252:255], a[244:247], v[172:175], v[252:255]
    v_cvt_pk_bf16_f32 v12, v12, v13
    v_cvt_pk_bf16_f32 v13, v14, v15
    v_mfma_f32_16x16x32_bf16 v[252:255], a[248:251], v[204:207], v[252:255]
    v_cvt_pk_bf16_f32 v14, v16, v17
    v_cvt_pk_bf16_f32 v15, v18, v19
    v_mfma_f32_16x16x32_bf16 v[252:255], a[252:255], v[236:239], v[252:255]
    buffer_store_dwordx4 v[12:15], v1, s[56:59], s64 offen offset:0 sc1
    v_mfma_f32_16x16x32_bf16 a[196:199], v[120:123], v[72:75], a[196:199]
    ds_bpermute_b32 v6, v8, v6
    ds_bpermute_b32 v7, v8, v7
    v_mfma_f32_16x16x32_bf16 a[196:199], v[124:127], v[76:79], a[196:199]
    s_waitcnt vmcnt(8) lgkmcnt(0)
    s_barrier
    ds_read_b128 a[224:227], v2 offset:0
    v_mfma_f32_16x16x32_bf16 a[200:203], v[120:123], v[80:83], a[200:203]
    ds_read_b128 a[228:231], v2 offset:1024
    ds_read_b128 a[232:235], v2 offset:2048
    v_mfma_f32_16x16x32_bf16 a[200:203], v[124:127], v[84:87], a[200:203]
    ds_read_b128 a[236:239], v2 offset:3072
    v_mul_f32 v6, s98, v6
    v_mfma_f32_16x16x32_bf16 a[204:207], v[120:123], v[88:91], a[204:207]
    ds_read_b128 v[96:99], v2 offset:16384
    v_mul_f32 v7, s98, v7
    v_mfma_f32_16x16x32_bf16 a[204:207], v[124:127], v[92:95], a[204:207]
    v_exp_f32 v252, v252
    v_mfma_f32_16x16x32_bf16 v[12:15], v[144:147], v[220:223], 0
    v_exp_f32 v253, v253
    v_mfma_f32_16x16x32_bf16 v[16:19], a[140:143], v[220:223], 0
    ds_read_b128 v[100:103], v2 offset:17408
    v_cvt_pk_bf16_f32 v62, v252, v253
    v_mfma_f32_16x16x32_bf16 a[212:215], a[136:139], v[72:75], a[212:215]
    v_exp_f32 v6, v6
    v_mfma_f32_16x16x32_bf16 a[212:215], a[136:139], v[76:79], a[212:215]
    v_exp_f32 v7, v7
    v_mfma_f32_16x16x32_bf16 a[216:219], a[136:139], v[80:83], a[216:219]
    v_cvt_pk_bf16_f32 v12, v12, v13
    v_cvt_pk_bf16_f32 v13, v14, v15
    v_mfma_f32_16x16x32_bf16 a[216:219], a[136:139], v[84:87], a[216:219]
    v_cvt_pk_bf16_f32 v14, v16, v17
    v_cvt_pk_bf16_f32 v15, v18, v19
    v_mfma_f32_16x16x32_bf16 a[220:223], a[136:139], v[88:91], a[220:223]
    buffer_store_dwordx4 v[12:15], v1, s[56:59], s64 offen offset:1024 sc1
    v_mfma_f32_16x16x32_bf16 a[220:223], a[136:139], v[92:95], a[220:223]
    v_add_f32 v6, 1.0, v6
    v_add_f32 v7, 1.0, v7
    v_rcp_f32 v6, v6
    v_rcp_f32 v7, v7
    s_nop 1
    v_accvgpr_read_b32 v9, a208
    v_cmp_nge_f32 vcc, 0x71800000, v9
    v_rcp_f32 v10, v9
    s_nop 0
    s_or_b64 s[84:85], s[84:85], vcc
    v_mul_f32 v10, v10, v4
    v_accvgpr_read_b32 v12, a0
    v_accvgpr_read_b32 v13, a1
    v_accvgpr_read_b32 v14, a2
    v_accvgpr_read_b32 v15, a3
    v_accvgpr_read_b32 v16, a16
    v_accvgpr_read_b32 v17, a17
    v_accvgpr_read_b32 v18, a18
    v_accvgpr_read_b32 v19, a19
    v_pk_mul_f32 v[12:13], v[12:13], v[10:11] op_sel_hi:[1,0]
    v_pk_mul_f32 v[14:15], v[14:15], v[10:11] op_sel_hi:[1,0]
    v_pk_mul_f32 v[16:17], v[16:17], v[10:11] op_sel_hi:[1,0]
    v_pk_mul_f32 v[18:19], v[18:19], v[10:11] op_sel_hi:[1,0]
    v_cvt_pk_bf16_f32 v12, v12, v13
    v_cvt_pk_bf16_f32 v13, v14, v15
    v_cvt_pk_bf16_f32 v14, v16, v17
    v_cvt_pk_bf16_f32 v15, v18, v19
    buffer_store_dwordx4 v[12:15], v1, s[40:43], s80 offen offset:0 sc1
    v_accvgpr_read_b32 v20, a32
    v_accvgpr_read_b32 v21, a33
    v_accvgpr_read_b32 v22, a34
    v_accvgpr_read_b32 v23, a35
    v_accvgpr_read_b32 v24, a48
    v_accvgpr_read_b32 v25, a49
    v_accvgpr_read_b32 v26, a50
    v_accvgpr_read_b32 v27, a51
    v_pk_mul_f32 v[20:21], v[20:21], v[10:11] op_sel_hi:[1,0]
    v_pk_mul_f32 v[22:23], v[22:23], v[10:11] op_sel_hi:[1,0]
    v_pk_mul_f32 v[24:25], v[24:25], v[10:11] op_sel_hi:[1,0]
    v_pk_mul_f32 v[26:27], v[26:27], v[10:11] op_sel_hi:[1,0]
    v_cvt_pk_bf16_f32 v20, v20, v21
    v_cvt_pk_bf16_f32 v21, v22, v23
    v_cvt_pk_bf16_f32 v22, v24, v25
    v_cvt_pk_bf16_f32 v23, v26, v27
    buffer_store_dwordx4 v[20:23], v1, s[40:43], s80 offen offset:1024 sc1
    v_accvgpr_read_b32 v12, a144
    v_accvgpr_read_b32 v13, a145
    v_accvgpr_read_b32 v14, a146
    v_accvgpr_read_b32 v15, a147
    v_accvgpr_read_b32 v16, a160
    v_accvgpr_read_b32 v17, a161
    v_accvgpr_read_b32 v18, a162
    v_accvgpr_read_b32 v19, a163
    v_pk_mul_f32 v[12:13], v[12:13], v[10:11] op_sel_hi:[1,0]
    v_pk_mul_f32 v[14:15], v[14:15], v[10:11] op_sel_hi:[1,0]
    v_pk_mul_f32 v[16:17], v[16:17], v[10:11] op_sel_hi:[1,0]
    v_pk_mul_f32 v[18:19], v[18:19], v[10:11] op_sel_hi:[1,0]
    v_cvt_pk_bf16_f32 v12, v12, v13
    v_cvt_pk_bf16_f32 v13, v14, v15
    v_cvt_pk_bf16_f32 v14, v16, v17
    v_cvt_pk_bf16_f32 v15, v18, v19
    buffer_store_dwordx4 v[12:15], v1, s[40:43], s80 offen offset:2048 sc1
    v_accvgpr_read_b32 v20, a176
    v_accvgpr_read_b32 v21, a177
    v_accvgpr_read_b32 v22, a178
    v_accvgpr_read_b32 v23, a179
    v_accvgpr_read_b32 v24, a192
    v_accvgpr_read_b32 v25, a193
    v_accvgpr_read_b32 v26, a194
    v_accvgpr_read_b32 v27, a195
    v_pk_mul_f32 v[20:21], v[20:21], v[10:11] op_sel_hi:[1,0]
    v_pk_mul_f32 v[22:23], v[22:23], v[10:11] op_sel_hi:[1,0]
    v_pk_mul_f32 v[24:25], v[24:25], v[10:11] op_sel_hi:[1,0]
    v_pk_mul_f32 v[26:27], v[26:27], v[10:11] op_sel_hi:[1,0]
    v_cvt_pk_bf16_f32 v20, v20, v21
    v_cvt_pk_bf16_f32 v21, v22, v23
    v_cvt_pk_bf16_f32 v22, v24, v25
    v_cvt_pk_bf16_f32 v23, v26, v27
    buffer_store_dwordx4 v[20:23], v1, s[40:43], s80 offen offset:3072 sc1
    v_accvgpr_read_b32 v9, a212
    v_cmp_nge_f32 vcc, 0x71800000, v9
    v_rcp_f32 v10, v9
    s_nop 0
    s_or_b64 s[84:85], s[84:85], vcc
    v_mul_f32 v10, v10, v5
    s_add_u32 s72, s80, 622592
    v_accvgpr_read_b32 v12, a4
    v_accvgpr_read_b32 v13, a5
    v_accvgpr_read_b32 v14, a6
    v_accvgpr_read_b32 v15, a7
    v_accvgpr_read_b32 v16, a20
    v_accvgpr_read_b32 v17, a21
    v_accvgpr_read_b32 v18, a22
    v_accvgpr_read_b32 v19, a23
    v_pk_mul_f32 v[12:13], v[12:13], v[10:11] op_sel_hi:[1,0]
    v_pk_mul_f32 v[14:15], v[14:15], v[10:11] op_sel_hi:[1,0]
    v_pk_mul_f32 v[16:17], v[16:17], v[10:11] op_sel_hi:[1,0]
    v_pk_mul_f32 v[18:19], v[18:19], v[10:11] op_sel_hi:[1,0]
    v_cvt_pk_bf16_f32 v12, v12, v13
    v_cvt_pk_bf16_f32 v13, v14, v15
    v_cvt_pk_bf16_f32 v14, v16, v17
    v_cvt_pk_bf16_f32 v15, v18, v19
    buffer_store_dwordx4 v[12:15], v1, s[40:43], s72 offen offset:0 sc1
    v_accvgpr_read_b32 v20, a36
    v_accvgpr_read_b32 v21, a37
    v_accvgpr_read_b32 v22, a38
    v_accvgpr_read_b32 v23, a39
    v_accvgpr_read_b32 v24, a52
    v_accvgpr_read_b32 v25, a53
    v_accvgpr_read_b32 v26, a54
    v_accvgpr_read_b32 v27, a55
    v_pk_mul_f32 v[20:21], v[20:21], v[10:11] op_sel_hi:[1,0]
    v_pk_mul_f32 v[22:23], v[22:23], v[10:11] op_sel_hi:[1,0]
    v_pk_mul_f32 v[24:25], v[24:25], v[10:11] op_sel_hi:[1,0]
    v_pk_mul_f32 v[26:27], v[26:27], v[10:11] op_sel_hi:[1,0]
    v_cvt_pk_bf16_f32 v20, v20, v21
    v_cvt_pk_bf16_f32 v21, v22, v23
    v_cvt_pk_bf16_f32 v22, v24, v25
    v_cvt_pk_bf16_f32 v23, v26, v27
    buffer_store_dwordx4 v[20:23], v1, s[40:43], s72 offen offset:1024 sc1
    v_accvgpr_read_b32 v12, a148
    v_accvgpr_read_b32 v13, a149
    v_accvgpr_read_b32 v14, a150
    v_accvgpr_read_b32 v15, a151
    v_accvgpr_read_b32 v16, a164
    v_accvgpr_read_b32 v17, a165
    v_accvgpr_read_b32 v18, a166
    v_accvgpr_read_b32 v19, a167
    v_pk_mul_f32 v[12:13], v[12:13], v[10:11] op_sel_hi:[1,0]
    v_pk_mul_f32 v[14:15], v[14:15], v[10:11] op_sel_hi:[1,0]
    v_pk_mul_f32 v[16:17], v[16:17], v[10:11] op_sel_hi:[1,0]
    v_pk_mul_f32 v[18:19], v[18:19], v[10:11] op_sel_hi:[1,0]
    v_cvt_pk_bf16_f32 v12, v12, v13
    v_cvt_pk_bf16_f32 v13, v14, v15
    v_cvt_pk_bf16_f32 v14, v16, v17
    v_cvt_pk_bf16_f32 v15, v18, v19
    buffer_store_dwordx4 v[12:15], v1, s[40:43], s72 offen offset:2048 sc1
    v_accvgpr_read_b32 v20, a180
    v_accvgpr_read_b32 v21, a181
    v_accvgpr_read_b32 v22, a182
    v_accvgpr_read_b32 v23, a183
    v_accvgpr_read_b32 v24, a196
    v_accvgpr_read_b32 v25, a197
    v_accvgpr_read_b32 v26, a198
    v_accvgpr_read_b32 v27, a199
    v_pk_mul_f32 v[20:21], v[20:21], v[10:11] op_sel_hi:[1,0]
    v_pk_mul_f32 v[22:23], v[22:23], v[10:11] op_sel_hi:[1,0]
    v_pk_mul_f32 v[24:25], v[24:25], v[10:11] op_sel_hi:[1,0]
    v_pk_mul_f32 v[26:27], v[26:27], v[10:11] op_sel_hi:[1,0]
    v_cvt_pk_bf16_f32 v20, v20, v21
    v_cvt_pk_bf16_f32 v21, v22, v23
    v_cvt_pk_bf16_f32 v22, v24, v25
    v_cvt_pk_bf16_f32 v23, v26, v27
    buffer_store_dwordx4 v[20:23], v1, s[40:43], s72 offen offset:3072 sc1
    v_mov_b32 v9, 1
    v_lshlrev_b32 v8, 20, v1
    s_lshl2_add_u32 s7, s75, s101
    s_add_u32 s7, s7, 32768
    s_waitcnt vmcnt(8)
    buffer_store_dword v9, v8, s[32:35], s7 offen sc1
    s_sub_u32 s78, 14, s6
    s_sub_u32 s78, s78, s6
    s_cmp_eq_u32 s78, 0
    s_cbranch_scc1 K1_LS_END
.p2align 3
K1_LS:
    s_waitcnt lgkmcnt(0)
    v_mfma_f32_16x16x32_bf16 v[240:243], a[224:227], v[136:139], v[176:179]
    s_add_u32 m0, s76, s75
    v_exp_f32 v254, v254
    v_mfma_f32_16x16x32_bf16 v[240:243], a[228:231], v[168:171], v[240:243]
    s_mov_b32 s76, s60
    v_exp_f32 v255, v255
    v_mfma_f32_16x16x32_bf16 v[240:243], a[232:235], v[200:203], v[240:243]
    s_mov_b32 s60, s82
    buffer_load_dwordx4 v1, s[36:39], s77 offen sc1 lds
    v_mfma_f32_16x16x32_bf16 v[240:243], a[236:239], v[232:235], v[240:243]
    s_add_u32 s82, s82, 32768
    ds_read_b128 v[104:107], v2 offset:18432
    v_cvt_pk_bf16_f32 v63, v254, v255
    v_mfma_f32_16x16x32_bf16 a[8:11], v[96:99], v[48:51], a[8:11]
    ds_read_b128 v[108:111], v2 offset:19456
    ds_read_b128 a[240:243], v2 offset:4096
    v_mfma_f32_16x16x32_bf16 a[8:11], v[100:103], v[52:55], a[8:11]
    ds_read_b128 a[244:247], v2 offset:5120
    v_mfma_f32_16x16x32_bf16 a[12:15], v[96:99], v[56:59], a[12:15]
    buffer_load_dwordx4 v1, s[36:39], s77 offen offset:1024 sc1 lds
    v_mfma_f32_16x16x32_bf16 a[12:15], v[100:103], v[60:63], a[12:15]
    ds_read_b128 a[248:251], v2 offset:6144
    ds_read_b128 a[252:255], v2 offset:7168
    v_mfma_f32_16x16x32_bf16 v[244:247], a[224:227], v[140:143], v[156:159]
    v_exp_f32 v240, v240
    v_mfma_f32_16x16x32_bf16 v[244:247], a[228:231], v[172:175], v[244:247]
    ds_read_b128 v[112:115], v2 offset:20480
    ds_read_b128 v[116:119], v2 offset:21504
    v_mfma_f32_16x16x32_bf16 v[244:247], a[232:235], v[204:207], v[244:247]
    v_exp_f32 v241, v241
    v_mfma_f32_16x16x32_bf16 v[244:247], a[236:239], v[236:239], v[244:247]
    s_waitcnt lgkmcnt(4)
    ds_read_b128 v[120:123], v2 offset:22528
    ds_read_b128 v[124:127], v2 offset:23552
    v_mfma_f32_16x16x32_bf16 a[24:27], v[104:107], v[48:51], a[24:27]
    buffer_load_dwordx4 v1, s[36:39], s77 offen offset:2048 sc1 lds
    v_mfma_f32_16x16x32_bf16 a[24:27], v[108:111], v[52:55], a[24:27]
    ds_read_b128 a[224:227], v2 offset:8192
    ds_read_b128 a[228:231], v2 offset:9216
    v_mfma_f32_16x16x32_bf16 a[28:31], v[104:107], v[56:59], a[28:31]
    ds_read_b128 a[232:235], v2 offset:10240
    v_cvt_pk_bf16_f32 v80, v240, v241
    v_mfma_f32_16x16x32_bf16 a[28:31], v[108:111], v[60:63], a[28:31]
    v_exp_f32 v242, v242
    v_mfma_f32_16x16x32_bf16 v[248:251], a[240:243], v[136:139], v[180:183]
    ds_read_b128 a[236:239], v2 offset:11264
    ds_read_b128 v[96:99], v2 offset:24576
    v_mfma_f32_16x16x32_bf16 v[248:251], a[244:247], v[168:171], v[248:251]
    s_waitcnt lgkmcnt(5)
    v_exp_f32 v243, v243
    v_mfma_f32_16x16x32_bf16 v[248:251], a[248:251], v[200:203], v[248:251]
    buffer_load_dwordx4 v1, s[36:39], s77 offen offset:3072 sc1 lds
    v_mfma_f32_16x16x32_bf16 v[248:251], a[252:255], v[232:235], v[248:251]
    ds_read_b128 v[100:103], v2 offset:25600
    v_cvt_pk_bf16_f32 v81, v242, v243
    v_mfma_f32_16x16x32_bf16 a[40:43], v[112:115], v[48:51], a[40:43]
    ds_read_b128 v[104:107], v2 offset:26624
    ds_read_b128 v[108:111], v2 offset:27648
    v_mfma_f32_16x16x32_bf16 a[40:43], v[116:119], v[52:55], a[40:43]
    v_exp_f32 v244, v244
    v_mfma_f32_16x16x32_bf16 a[44:47], v[112:115], v[56:59], a[44:47]
    v_exp_f32 v245, v245
    v_mfma_f32_16x16x32_bf16 a[44:47], v[116:119], v[60:63], a[44:47]
    s_add_u32 s100, s77, 4096
    v_exp_f32 v246, v246
    v_mfma_f32_16x16x32_bf16 v[252:255], a[240:243], v[140:143], v[156:159]
    s_add_u32 m0, m0, 4096
    v_exp_f32 v247, v247
    v_mfma_f32_16x16x32_bf16 v[252:255], a[244:247], v[172:175], v[252:255]
    buffer_load_dwordx4 v1, s[36:39], s100 offen sc1 lds
    v_mfma_f32_16x16x32_bf16 v[252:255], a[248:251], v[204:207], v[252:255]
    v_cvt_pk_bf16_f32 v88, v244, v245
    v_cvt_pk_bf16_f32 v89, v246, v247
    v_mfma_f32_16x16x32_bf16 v[252:255], a[252:255], v[236:239], v[252:255]
    ds_read_b128 a[240:243], v2 offset:12288
    ds_read_b128 a[244:247], v2 offset:13312
    v_mfma_f32_16x16x32_bf16 a[56:59], v[120:123], v[48:51], a[56:59]
    v_exp_f32 v248, v248
    v_mfma_f32_16x16x32_bf16 a[56:59], v[124:127], v[52:55], a[56:59]
    buffer_load_dwordx4 v1, s[36:39], s100 offen offset:1024 sc1 lds
    v_mfma_f32_16x16x32_bf16 a[60:63], v[120:123], v[56:59], a[60:63]
    ds_read_b128 a[248:251], v2 offset:14336
    ds_read_b128 a[252:255], v2 offset:15360
    v_mfma_f32_16x16x32_bf16 a[60:63], v[124:127], v[60:63], a[60:63]
    s_waitcnt lgkmcnt(4)
    v_exp_f32 v249, v249
    v_mfma_f32_16x16x32_bf16 v[240:243], a[224:227], v[136:139], v[184:187]
    ds_read_b128 v[112:115], v2 offset:28672
    ds_read_b128 v[116:119], v2 offset:29696
    v_mfma_f32_16x16x32_bf16 v[240:243], a[228:231], v[168:171], v[240:243]
    v_exp_f32 v250, v250
    v_mfma_f32_16x16x32_bf16 v[240:243], a[232:235], v[200:203], v[240:243]
    v_exp_f32 v251, v251
    v_mfma_f32_16x16x32_bf16 v[240:243], a[236:239], v[232:235], v[240:243]
    buffer_load_dwordx4 v1, s[36:39], s100 offen offset:2048 sc1 lds
    v_mfma_f32_16x16x32_bf16 a[152:155], v[96:99], v[48:51], a[152:155]
    v_cvt_pk_bf16_f32 v82, v248, v249
    v_cvt_pk_bf16_f32 v83, v250, v251
    v_mfma_f32_16x16x32_bf16 a[152:155], v[100:103], v[52:55], a[152:155]
    ds_read_b128 v[120:123], v2 offset:30720
    ds_read_b128 v[124:127], v2 offset:31744
    v_mfma_f32_16x16x32_bf16 a[156:159], v[96:99], v[56:59], a[156:159]
    v_exp_f32 v252, v252
    v_mfma_f32_16x16x32_bf16 a[156:159], v[100:103], v[60:63], a[156:159]
    v_exp_f32 v253, v253
    v_mfma_f32_16x16x32_bf16 v[244:247], a[224:227], v[140:143], v[156:159]
    v_exp_f32 v254, v254
    v_mfma_f32_16x16x32_bf16 v[244:247], a[228:231], v[172:175], v[244:247]
    buffer_load_dwordx4 v1, s[36:39], s100 offen offset:3072 sc1 lds
    v_mfma_f32_16x16x32_bf16 v[244:247], a[232:235], v[204:207], v[244:247]
    v_exp_f32 v255, v255
    v_mfma_f32_16x16x32_bf16 v[244:247], a[236:239], v[236:239], v[244:247]
    s_cmp_eq_u32 s82, 163840
    s_cselect_b32 s82, 0, s82
    v_cvt_pk_bf16_f32 v90, v252, v253
    v_mfma_f32_16x16x32_bf16 a[168:171], v[104:107], v[48:51], a[168:171]
    v_cvt_pk_bf16_f32 v91, v254, v255
    v_add_u32 v2, s82, v1
    v_mfma_f32_16x16x32_bf16 a[168:171], v[108:111], v[52:55], a[168:171]
    ds_read_b128 a[224:227], v2 offset:0
    ds_read_b128 a[228:231], v2 offset:1024
    v_mfma_f32_16x16x32_bf16 a[172:175], v[104:107], v[56:59], a[172:175]
    s_add_u32 s77, s77, 32768
    v_exp_f32 v240, v240
    v_mfma_f32_16x16x32_bf16 a[172:175], v[108:111], v[60:63], a[172:175]
    s_waitcnt lgkmcnt(2)
    ds_read_b128 a[232:235], v2 offset:2048
    ds_read_b128 a[236:239], v2 offset:3072
    v_mfma_f32_16x16x32_bf16 v[248:251], a[240:243], v[136:139], v[188:191]
    v_exp_f32 v241, v241
    v_mfma_f32_16x16x32_bf16 v[248:251], a[244:247], v[168:171], v[248:251]
    ds_read_b128 v[96:99], v2 offset:16384
    ds_read_b128 v[100:103], v2 offset:17408
    v_mfma_f32_16x16x32_bf16 v[248:251], a[248:251], v[200:203], v[248:251]
    v_exp_f32 v242, v242
    v_mfma_f32_16x16x32_bf16 v[248:251], a[252:255], v[232:235], v[248:251]
    v_exp_f32 v243, v243
    v_mfma_f32_16x16x32_bf16 a[184:187], v[112:115], v[48:51], a[184:187]
    v_exp_f32 v244, v244
    v_mfma_f32_16x16x32_bf16 a[184:187], v[116:119], v[52:55], a[184:187]
    v_exp_f32 v245, v245
    v_mfma_f32_16x16x32_bf16 a[188:191], v[112:115], v[56:59], a[188:191]
    v_exp_f32 v246, v246
    v_mfma_f32_16x16x32_bf16 a[188:191], v[116:119], v[60:63], a[188:191]
    v_exp_f32 v247, v247
    v_mfma_f32_16x16x32_bf16 v[252:255], a[240:243], v[140:143], v[156:159]
    v_exp_f32 v248, v248
    v_mfma_f32_16x16x32_bf16 v[252:255], a[244:247], v[172:175], v[252:255]
    v_exp_f32 v249, v249
    v_mfma_f32_16x16x32_bf16 v[252:255], a[248:251], v[204:207], v[252:255]
    v_exp_f32 v250, v250
    v_mfma_f32_16x16x32_bf16 v[252:255], a[252:255], v[236:239], v[252:255]
    v_exp_f32 v251, v251
    v_mfma_f32_16x16x32_bf16 a[200:203], v[120:123], v[48:51], a[200:203]
    v_cvt_pk_bf16_f32 v84, v240, v241
    v_cvt_pk_bf16_f32 v85, v242, v243
    v_mfma_f32_16x16x32_bf16 a[200:203], v[124:127], v[52:55], a[200:203]
    v_cvt_pk_bf16_f32 v92, v244, v245
    v_cvt_pk_bf16_f32 v93, v246, v247
    v_mfma_f32_16x16x32_bf16 a[204:207], v[120:123], v[56:59], a[204:207]
    v_exp_f32 v252, v252
    v_mfma_f32_16x16x32_bf16 a[204:207], v[124:127], v[60:63], a[204:207]
    v_exp_f32 v253, v253
    v_mfma_f32_16x16x32_bf16 a[216:219], a[136:139], v[48:51], a[216:219]
    v_cvt_pk_bf16_f32 v86, v248, v249
    v_cvt_pk_bf16_f32 v87, v250, v251
    v_mfma_f32_16x16x32_bf16 a[216:219], a[136:139], v[52:55], a[216:219]
    v_cvt_pk_bf16_f32 v94, v252, v253
    v_mfma_f32_16x16x32_bf16 a[220:223], a[136:139], v[56:59], a[220:223]
    v_mfma_f32_16x16x32_bf16 a[220:223], a[136:139], v[60:63], a[220:223]
    s_cmp_eq_u32 s78, 1
    s_cbranch_scc1 K1_LS_MASK
K1_LS_BACK:
    s_waitcnt lgkmcnt(0)
    v_mfma_f32_16x16x32_bf16 v[240:243], a[224:227], v[136:139], v[176:179]
    s_add_u32 m0, s76, s75
    v_exp_f32 v254, v254
    v_mfma_f32_16x16x32_bf16 v[240:243], a[228:231], v[168:171], v[240:243]
    s_mov_b32 s76, s60
    v_exp_f32 v255, v255
    v_mfma_f32_16x16x32_bf16 v[240:243], a[232:235], v[200:203], v[240:243]
    s_mov_b32 s60, s82
    buffer_load_dwordx4 v1, s[36:39], s77 offen sc1 lds
    v_mfma_f32_16x16x32_bf16 v[240:243], a[236:239], v[232:235], v[240:243]
    s_add_u32 s82, s82, 32768
    ds_read_b128 v[104:107], v2 offset:18432
    v_cvt_pk_bf16_f32 v95, v254, v255
    v_mfma_f32_16x16x32_bf16 a[8:11], v[96:99], v[80:83], a[8:11]
    ds_read_b128 v[108:111], v2 offset:19456
    ds_read_b128 a[240:243], v2 offset:4096
    v_mfma_f32_16x16x32_bf16 a[8:11], v[100:103], v[84:87], a[8:11]
    ds_read_b128 a[244:247], v2 offset:5120
    v_mfma_f32_16x16x32_bf16 a[12:15], v[96:99], v[88:91], a[12:15]
    buffer_load_dwordx4 v1, s[36:39], s77 offen offset:1024 sc1 lds
    v_mfma_f32_16x16x32_bf16 a[12:15], v[100:103], v[92:95], a[12:15]
    ds_read_b128 a[248:251], v2 offset:6144
    ds_read_b128 a[252:255], v2 offset:7168
    v_mfma_f32_16x16x32_bf16 v[244:247], a[224:227], v[140:143], v[156:159]
    v_exp_f32 v240, v240
    v_mfma_f32_16x16x32_bf16 v[244:247], a[228:231], v[172:175], v[244:247]
    ds_read_b128 v[112:115], v2 offset:20480
    ds_read_b128 v[116:119], v2 offset:21504
    v_mfma_f32_16x16x32_bf16 v[244:247], a[232:235], v[204:207], v[244:247]
    v_exp_f32 v241, v241
    v_mfma_f32_16x16x32_bf16 v[244:247], a[236:239], v[236:239], v[244:247]
    s_waitcnt lgkmcnt(4)
    ds_read_b128 v[120:123], v2 offset:22528
    ds_read_b128 v[124:127], v2 offset:23552
    v_mfma_f32_16x16x32_bf16 a[24:27], v[104:107], v[80:83], a[24:27]
    buffer_load_dwordx4 v1, s[36:39], s77 offen offset:2048 sc1 lds
    v_mfma_f32_16x16x32_bf16 a[24:27], v[108:111], v[84:87], a[24:27]
    ds_read_b128 a[224:227], v2 offset:8192
    ds_read_b128 a[228:231], v2 offset:9216
    v_mfma_f32_16x16x32_bf16 a[28:31], v[104:107], v[88:91], a[28:31]
    ds_read_b128 a[232:235], v2 offset:10240
    v_cvt_pk_bf16_f32 v48, v240, v241
    v_mfma_f32_16x16x32_bf16 a[28:31], v[108:111], v[92:95], a[28:31]
    v_exp_f32 v242, v242
    v_mfma_f32_16x16x32_bf16 v[248:251], a[240:243], v[136:139], v[180:183]
    ds_read_b128 a[236:239], v2 offset:11264
    ds_read_b128 v[96:99], v2 offset:24576
    v_mfma_f32_16x16x32_bf16 v[248:251], a[244:247], v[168:171], v[248:251]
    s_waitcnt lgkmcnt(5)
    v_exp_f32 v243, v243
    v_mfma_f32_16x16x32_bf16 v[248:251], a[248:251], v[200:203], v[248:251]
    buffer_load_dwordx4 v1, s[36:39], s77 offen offset:3072 sc1 lds
    v_mfma_f32_16x16x32_bf16 v[248:251], a[252:255], v[232:235], v[248:251]
    ds_read_b128 v[100:103], v2 offset:25600
    v_cvt_pk_bf16_f32 v49, v242, v243
    v_mfma_f32_16x16x32_bf16 a[40:43], v[112:115], v[80:83], a[40:43]
    ds_read_b128 v[104:107], v2 offset:26624
    ds_read_b128 v[108:111], v2 offset:27648
    v_mfma_f32_16x16x32_bf16 a[40:43], v[116:119], v[84:87], a[40:43]
    v_exp_f32 v244, v244
    v_mfma_f32_16x16x32_bf16 a[44:47], v[112:115], v[88:91], a[44:47]
    v_exp_f32 v245, v245
    v_mfma_f32_16x16x32_bf16 a[44:47], v[116:119], v[92:95], a[44:47]
    s_add_u32 s100, s77, 4096
    v_exp_f32 v246, v246
    v_mfma_f32_16x16x32_bf16 v[252:255], a[240:243], v[140:143], v[156:159]
    s_add_u32 m0, m0, 4096
    v_exp_f32 v247, v247
    v_mfma_f32_16x16x32_bf16 v[252:255], a[244:247], v[172:175], v[252:255]
    buffer_load_dwordx4 v1, s[36:39], s100 offen sc1 lds
    v_mfma_f32_16x16x32_bf16 v[252:255], a[248:251], v[204:207], v[252:255]
    v_cvt_pk_bf16_f32 v56, v244, v245
    v_cvt_pk_bf16_f32 v57, v246, v247
    v_mfma_f32_16x16x32_bf16 v[252:255], a[252:255], v[236:239], v[252:255]
    ds_read_b128 a[240:243], v2 offset:12288
    ds_read_b128 a[244:247], v2 offset:13312
    v_mfma_f32_16x16x32_bf16 a[56:59], v[120:123], v[80:83], a[56:59]
    v_exp_f32 v248, v248
    v_mfma_f32_16x16x32_bf16 a[56:59], v[124:127], v[84:87], a[56:59]
    buffer_load_dwordx4 v1, s[36:39], s100 offen offset:1024 sc1 lds
    v_mfma_f32_16x16x32_bf16 a[60:63], v[120:123], v[88:91], a[60:63]
    ds_read_b128 a[248:251], v2 offset:14336
    ds_read_b128 a[252:255], v2 offset:15360
    v_mfma_f32_16x16x32_bf16 a[60:63], v[124:127], v[92:95], a[60:63]
    s_waitcnt lgkmcnt(4)
    v_exp_f32 v249, v249
    v_mfma_f32_16x16x32_bf16 v[240:243], a[224:227], v[136:139], v[184:187]
    ds_read_b128 v[112:115], v2 offset:28672
    ds_read_b128 v[116:119], v2 offset:29696
    v_mfma_f32_16x16x32_bf16 v[240:243], a[228:231], v[168:171], v[240:243]
    v_exp_f32 v250, v250
    v_mfma_f32_16x16x32_bf16 v[240:243], a[232:235], v[200:203], v[240:243]
    v_exp_f32 v251, v251
    v_mfma_f32_16x16x32_bf16 v[240:243], a[236:239], v[232:235], v[240:243]
    buffer_load_dwordx4 v1, s[36:39], s100 offen offset:2048 sc1 lds
    v_mfma_f32_16x16x32_bf16 a[152:155], v[96:99], v[80:83], a[152:155]
    v_cvt_pk_bf16_f32 v50, v248, v249
    v_cvt_pk_bf16_f32 v51, v250, v251
    v_mfma_f32_16x16x32_bf16 a[152:155], v[100:103], v[84:87], a[152:155]
    ds_read_b128 v[120:123], v2 offset:30720
    ds_read_b128 v[124:127], v2 offset:31744
    v_mfma_f32_16x16x32_bf16 a[156:159], v[96:99], v[88:91], a[156:159]
    v_exp_f32 v252, v252
    v_mfma_f32_16x16x32_bf16 a[156:159], v[100:103], v[92:95], a[156:159]
    v_exp_f32 v253, v253
    v_mfma_f32_16x16x32_bf16 v[244:247], a[224:227], v[140:143], v[156:159]
    v_exp_f32 v254, v254
    v_mfma_f32_16x16x32_bf16 v[244:247], a[228:231], v[172:175], v[244:247]
    buffer_load_dwordx4 v1, s[36:39], s100 offen offset:3072 sc1 lds
    v_mfma_f32_16x16x32_bf16 v[244:247], a[232:235], v[204:207], v[244:247]
    v_exp_f32 v255, v255
    v_mfma_f32_16x16x32_bf16 v[244:247], a[236:239], v[236:239], v[244:247]
    s_cmp_eq_u32 s82, 163840
    s_cselect_b32 s82, 0, s82
    v_cvt_pk_bf16_f32 v58, v252, v253
    v_mfma_f32_16x16x32_bf16 a[168:171], v[104:107], v[80:83], a[168:171]
    v_cvt_pk_bf16_f32 v59, v254, v255
    v_add_u32 v2, s82, v1
    v_mfma_f32_16x16x32_bf16 a[168:171], v[108:111], v[84:87], a[168:171]
    v_exp_f32 v240, v240
    v_mfma_f32_16x16x32_bf16 a[172:175], v[104:107], v[88:91], a[172:175]
    s_add_u32 s77, s77, 32768
    v_exp_f32 v241, v241
    v_mfma_f32_16x16x32_bf16 a[172:175], v[108:111], v[92:95], a[172:175]
    s_waitcnt lgkmcnt(0)
    v_exp_f32 v242, v242
    v_mfma_f32_16x16x32_bf16 v[248:251], a[240:243], v[136:139], v[188:191]
    v_exp_f32 v243, v243
    v_mfma_f32_16x16x32_bf16 v[248:251], a[244:247], v[168:171], v[248:251]
    v_exp_f32 v244, v244
    v_mfma_f32_16x16x32_bf16 v[248:251], a[248:251], v[200:203], v[248:251]
    v_exp_f32 v245, v245
    v_mfma_f32_16x16x32_bf16 v[248:251], a[252:255], v[232:235], v[248:251]
    v_exp_f32 v246, v246
    v_mfma_f32_16x16x32_bf16 a[184:187], v[112:115], v[80:83], a[184:187]
    v_exp_f32 v247, v247
    v_mfma_f32_16x16x32_bf16 a[184:187], v[116:119], v[84:87], a[184:187]
    v_cvt_pk_bf16_f32 v52, v240, v241
    v_cvt_pk_bf16_f32 v53, v242, v243
    v_mfma_f32_16x16x32_bf16 a[188:191], v[112:115], v[88:91], a[188:191]
    v_cvt_pk_bf16_f32 v60, v244, v245
    v_cvt_pk_bf16_f32 v61, v246, v247
    v_mfma_f32_16x16x32_bf16 a[188:191], v[116:119], v[92:95], a[188:191]
    s_waitcnt vmcnt(8) lgkmcnt(0)
    s_barrier
    ds_read_b128 a[224:227], v2 offset:0
    v_mfma_f32_16x16x32_bf16 v[252:255], a[240:243], v[140:143], v[156:159]
    ds_read_b128 a[228:231], v2 offset:1024
    ds_read_b128 a[232:235], v2 offset:2048
    v_mfma_f32_16x16x32_bf16 v[252:255], a[244:247], v[172:175], v[252:255]
    v_exp_f32 v248, v248
    v_mfma_f32_16x16x32_bf16 v[252:255], a[248:251], v[204:207], v[252:255]
    ds_read_b128 a[236:239], v2 offset:3072
    ds_read_b128 v[96:99], v2 offset:16384
    v_mfma_f32_16x16x32_bf16 v[252:255], a[252:255], v[236:239], v[252:255]
    v_exp_f32 v249, v249
    v_mfma_f32_16x16x32_bf16 a[200:203], v[120:123], v[80:83], a[200:203]
    ds_read_b128 v[100:103], v2 offset:17408
    v_cvt_pk_bf16_f32 v54, v248, v249
    v_mfma_f32_16x16x32_bf16 a[200:203], v[124:127], v[84:87], a[200:203]
    v_exp_f32 v250, v250
    v_mfma_f32_16x16x32_bf16 a[204:207], v[120:123], v[88:91], a[204:207]
    v_exp_f32 v251, v251
    v_mfma_f32_16x16x32_bf16 a[204:207], v[124:127], v[92:95], a[204:207]
    v_exp_f32 v252, v252
    v_mfma_f32_16x16x32_bf16 a[216:219], a[136:139], v[80:83], a[216:219]
    v_exp_f32 v253, v253
    v_mfma_f32_16x16x32_bf16 a[216:219], a[136:139], v[84:87], a[216:219]
    v_cvt_pk_bf16_f32 v55, v250, v251
    v_cvt_pk_bf16_f32 v62, v252, v253
    v_mfma_f32_16x16x32_bf16 a[220:223], a[136:139], v[88:91], a[220:223]
    v_mfma_f32_16x16x32_bf16 a[220:223], a[136:139], v[92:95], a[220:223]
    s_sub_u32 s78, s78, 1
    s_cmp_lg_u32 s78, 0
    s_cbranch_scc1 K1_LS
K1_LS_END:
    v_add_f32 v212, s12, v156
    v_fma_f32 v176, v208, s8, v212
    v_fma_f32 v177, v209, s8, v212
    v_fma_f32 v178, v210, s8, v212
    v_fma_f32 v179, v211, s8, v212
    s_nop 1
    s_waitcnt lgkmcnt(0)
    v_mfma_f32_16x16x32_bf16 v[240:243], a[224:227], v[140:143], v[176:179]
    s_mul_i32 s86, s4, 34
    ds_read_b128 v[104:107], v2 offset:18432
    ds_read_b128 v[108:111], v2 offset:19456
    v_mfma_f32_16x16x32_bf16 v[240:243], a[228:231], v[172:175], v[240:243]
    s_add_u32 s86, s86, 8
    v_exp_f32 v254, v254
    v_mfma_f32_16x16x32_bf16 v[240:243], a[232:235], v[204:207], v[240:243]
    s_mov_b32 s76, s60
    v_exp_f32 v255, v255
    v_mfma_f32_16x16x32_bf16 v[240:243], a[236:239], v[236:239], v[240:243]
    s_mov_b32 s60, s82
    ds_read_b128 a[240:243], v2 offset:4096
    v_cvt_pk_bf16_f32 v63, v254, v255
    v_mfma_f32_16x16x32_bf16 a[8:11], v[96:99], v[48:51], a[8:11]
    s_add_u32 s82, s82, 32768
    ds_read_b128 a[244:247], v2 offset:5120
    ds_read_b128 a[248:251], v2 offset:6144
    v_mfma_f32_16x16x32_bf16 a[8:11], v[100:103], v[52:55], a[8:11]
    s_lshr_b32 s61, s5, 3
    v_lshrrev_b32 v28, 4, v1
    ds_read_b128 a[252:255], v2 offset:7168
    v_mfma_f32_16x16x32_bf16 a[12:15], v[96:99], v[56:59], a[12:15]
    s_add_u32 s99, s61, 0
    v_min_u32 v28, 33, v28
    ds_read_b128 v[112:115], v2 offset:20480
    v_mfma_f32_16x16x32_bf16 a[12:15], v[100:103], v[60:63], a[12:15]
    s_and_b32 s98, s5, 3
    v_add_lshl_u32 v28, v28, s86, 7
    v_add_f32 v213, s13, v156
    s_waitcnt lgkmcnt(5)
    v_mfma_f32_16x16x32_bf16 a[24:27], v[104:107], v[48:51], a[24:27]
    s_and_b32 s99, s99, 3
    ds_read_b128 v[116:119], v2 offset:21504
    v_fma_f32 v180, v208, s9, v213
    v_mfma_f32_16x16x32_bf16 a[24:27], v[108:111], v[52:55], a[24:27]
    s_getpc_b64 s[86:87]
    global_load_dword v28, v28, s[86:87]
    v_mfma_f32_16x16x32_bf16 a[28:31], v[104:107], v[56:59], a[28:31]
    s_lshl2_add_u32 s99, s99, s98
    v_fma_f32 v181, v209, s9, v213
    v_fma_f32 v182, v210, s9, v213
    v_mfma_f32_16x16x32_bf16 a[28:31], v[108:111], v[60:63], a[28:31]
    s_lshl_b32 s16, s99, 11
    v_fma_f32 v183, v211, s9, v213
    ds_read_b128 v[120:123], v2 offset:22528
    s_nop 0
    s_waitcnt lgkmcnt(2)
    v_mfma_f32_16x16x32_bf16 v[244:247], a[240:243], v[140:143], v[180:183]
    s_add_u32 s99, s61, 1
    ds_read_b128 v[124:127], v2 offset:23552
    ds_read_b128 a[224:227], v2 offset:8192
    v_mfma_f32_16x16x32_bf16 v[244:247], a[244:247], v[172:175], v[244:247]
    s_and_b32 s99, s99, 3
    ds_read_b128 a[228:231], v2 offset:9216
    v_add_f32 v214, s14, v156
    v_mfma_f32_16x16x32_bf16 v[244:247], a[248:251], v[204:207], v[244:247]
    s_lshl2_add_u32 s99, s99, s98
    ds_read_b128 a[232:235], v2 offset:10240
    v_fma_f32 v184, v208, s10, v214
    v_mfma_f32_16x16x32_bf16 v[244:247], a[252:255], v[236:239], v[244:247]
    s_lshl_b32 s17, s99, 11
    ds_read_b128 a[236:239], v2 offset:11264
    v_fma_f32 v185, v209, s10, v214
    v_mfma_f32_16x16x32_bf16 a[40:43], v[112:115], v[48:51], a[40:43]
    s_add_u32 s99, s61, 2
    ds_read_b128 v[96:99], v2 offset:24576
    v_fma_f32 v186, v210, s10, v214
    s_waitcnt lgkmcnt(6)
    v_mfma_f32_16x16x32_bf16 a[40:43], v[116:119], v[52:55], a[40:43]
    s_and_b32 s99, s99, 3
    ds_read_b128 v[100:103], v2 offset:25600
    v_fma_f32 v187, v211, s10, v214
    v_mfma_f32_16x16x32_bf16 a[44:47], v[112:115], v[56:59], a[44:47]
    s_lshl2_add_u32 s99, s99, s98
    ds_read_b128 v[104:107], v2 offset:26624
    v_add_f32 v215, s15, v156
    v_mfma_f32_16x16x32_bf16 a[44:47], v[116:119], v[60:63], a[44:47]
    s_add_u32 s3, s5, s6
    ds_read_b128 v[108:111], v2 offset:27648
    v_fma_f32 v188, v208, s11, v215
    v_mfma_f32_16x16x32_bf16 a[56:59], v[120:123], v[48:51], a[56:59]
    s_lshl_b32 s18, s99, 11
    ds_read_b128 a[240:243], v2 offset:12288
    v_fma_f32 v189, v209, s11, v215
    s_waitcnt lgkmcnt(5)
    v_mfma_f32_16x16x32_bf16 a[56:59], v[124:127], v[52:55], a[56:59]
    s_add_u32 s99, s61, 3
    ds_read_b128 a[244:247], v2 offset:13312
    v_fma_f32 v190, v210, s11, v215
    v_mfma_f32_16x16x32_bf16 a[60:63], v[120:123], v[56:59], a[60:63]
    s_and_b32 s3, s3, 3
    ds_read_b128 a[248:251], v2 offset:14336
    v_fma_f32 v191, v211, s11, v215
    v_mfma_f32_16x16x32_bf16 a[60:63], v[124:127], v[60:63], a[60:63]
    s_and_b32 s99, s99, 3
    ds_read_b128 a[252:255], v2 offset:15360
    v_and_b32 v31, 0x70, v1
    v_mfma_f32_16x16x32_bf16 v[248:251], a[224:227], v[140:143], v[184:187]
    s_add_u32 s20, s98, 32
    ds_read_b128 v[112:115], v2 offset:28672
    v_lshrrev_b32 v29, 7, v1
    v_mfma_f32_16x16x32_bf16 v[248:251], a[228:231], v[172:175], v[248:251]
    s_lshl3_add_u32 s3, s61, s3
    ds_read_b128 v[116:119], v2 offset:29696
    v_lshlrev_b32 v31, 3, v31
    v_mfma_f32_16x16x32_bf16 v[248:251], a[232:235], v[204:207], v[248:251]
    s_lshl2_add_u32 s99, s99, s98
    ds_read_b128 v[120:123], v2 offset:30720
    v_lshl_add_u32 v29, v29, 12, v31
    v_mfma_f32_16x16x32_bf16 v[248:251], a[236:239], v[236:239], v[248:251]
    s_sub_u32 s62, 15, s6
    v_exp_f32 v240, v240
    s_waitcnt lgkmcnt(4)
    v_mfma_f32_16x16x32_bf16 a[152:155], v[96:99], v[48:51], a[152:155]
    s_lshl2_add_u32 s66, s6, s61
    v_exp_f32 v241, v241
    v_mfma_f32_16x16x32_bf16 a[152:155], v[100:103], v[52:55], a[152:155]
    s_mul_i32 s71, s5, 768
    ds_read_b128 v[124:127], v2 offset:31744
    v_cvt_pk_bf16_f32 v88, v240, v241
    v_mfma_f32_16x16x32_bf16 a[156:159], v[96:99], v[56:59], a[156:159]
    s_cmp_eq_u32 s82, 163840
    s_cselect_b32 s82, 0, s82
    v_add_u32 v2, s82, v1
    v_mfma_f32_16x16x32_bf16 a[156:159], v[100:103], v[60:63], a[156:159]
    s_lshl_b32 s20, s20, 10
    ds_read_b128 a[224:227], v2 offset:0
    ds_read_b128 a[228:231], v2 offset:1024
    v_mfma_f32_16x16x32_bf16 a[168:171], v[104:107], v[48:51], a[168:171]
    s_mul_i32 s78, s4, 7168
    v_exp_f32 v242, v242
    v_mfma_f32_16x16x32_bf16 a[168:171], v[108:111], v[52:55], a[168:171]
    s_lshl_b32 s19, s99, 11
    ds_read_b128 a[232:235], v2 offset:2048
    ds_read_b128 a[236:239], v2 offset:3072
    v_mfma_f32_16x16x32_bf16 a[172:175], v[104:107], v[56:59], a[172:175]
    s_lshl_b32 s63, s3, 12
    v_exp_f32 v243, v243
    v_mfma_f32_16x16x32_bf16 a[172:175], v[108:111], v[60:63], a[172:175]
    s_lshl_b32 s66, s66, 10
    ds_read_b128 v[96:99], v2 offset:16384
    ds_read_b128 v[100:103], v2 offset:17408
    v_mfma_f32_16x16x32_bf16 v[252:255], a[240:243], v[140:143], v[188:191]
    s_add_u32 s71, s71, 131072
    v_exp_f32 v244, v244
    v_mfma_f32_16x16x32_bf16 v[252:255], a[244:247], v[172:175], v[252:255]
    s_mov_b32 s50, 9437184
    v_exp_f32 v245, v245
    v_mfma_f32_16x16x32_bf16 v[252:255], a[248:251], v[204:207], v[252:255]
    s_waitcnt lgkmcnt(2)
    v_exp_f32 v246, v246
    v_mfma_f32_16x16x32_bf16 v[252:255], a[252:255], v[236:239], v[252:255]
    v_exp_f32 v247, v247
    v_mfma_f32_16x16x32_bf16 a[184:187], v[112:115], v[48:51], a[184:187]
    v_exp_f32 v248, v248
    v_mfma_f32_16x16x32_bf16 a[184:187], v[116:119], v[52:55], a[184:187]
    v_exp_f32 v249, v249
    v_mfma_f32_16x16x32_bf16 a[188:191], v[112:115], v[56:59], a[188:191]
    v_exp_f32 v250, v250
    v_mfma_f32_16x16x32_bf16 a[188:191], v[116:119], v[60:63], a[188:191]
    v_exp_f32 v251, v251
    v_mfma_f32_16x16x32_bf16 a[200:203], v[120:123], v[48:51], a[200:203]
    v_exp_f32 v252, v252
    v_mfma_f32_16x16x32_bf16 a[200:203], v[124:127], v[52:55], a[200:203]
    v_exp_f32 v253, v253
    v_mfma_f32_16x16x32_bf16 a[204:207], v[120:123], v[56:59], a[204:207]
    buffer_load_dword v3, v29, s[32:35], s92 offen sc1
    v_mfma_f32_16x16x32_bf16 a[204:207], v[124:127], v[60:63], a[204:207]
    v_cvt_pk_bf16_f32 v89, v242, v243
    v_cvt_pk_bf16_f32 v90, v244, v245
    v_mfma_f32_16x16x32_bf16 a[216:219], a[136:139], v[48:51], a[216:219]
    v_cvt_pk_bf16_f32 v91, v246, v247
    v_cvt_pk_bf16_f32 v92, v248, v249
    v_mfma_f32_16x16x32_bf16 a[216:219], a[136:139], v[52:55], a[216:219]
    v_cvt_pk_bf16_f32 v93, v250, v251
    v_cvt_pk_bf16_f32 v94, v252, v253
    v_mfma_f32_16x16x32_bf16 a[220:223], a[136:139], v[56:59], a[220:223]
    s_bitcmp1_b32 s5, 2
    s_cselect_b32 s62, s62, s6
    v_mfma_f32_16x16x32_bf16 a[220:223], a[136:139], v[60:63], a[220:223]
    s_add_u32 s48, s32, 1048576
    s_addc_u32 s49, s33, 0
    ds_read_b128 v[104:107], v2 offset:18432
    ds_read_b128 v[108:111], v2 offset:19456
    ds_read_b128 v[112:115], v2 offset:20480
    ds_read_b128 v[116:119], v2 offset:21504
    ds_read_b128 v[120:123], v2 offset:22528
    ds_read_b128 v[124:127], v2 offset:23552
    s_waitcnt lgkmcnt(6)
    v_mfma_f32_16x16x32_bf16 a[12:15], v[96:99], v[88:91], a[12:15]
    v_exp_f32 v254, v254
    v_exp_f32 v255, v255
    s_nop 0
    v_cvt_pk_bf16_f32 v95, v254, v255
    s_nop 1
    v_mfma_f32_16x16x32_bf16 a[12:15], v[100:103], v[92:95], a[12:15]
    s_waitcnt lgkmcnt(5)
    ds_read_b128 v[96:99], v2 offset:24576
    ds_read_b128 v[100:103], v2 offset:25600
    v_accvgpr_read_b32 v9, a216
    v_rcp_f32 v10, v9
    v_mfma_f32_16x16x32_bf16 a[28:31], v[104:107], v[88:91], a[28:31]
    s_waitcnt lgkmcnt(6)
    ds_read_b128 v[104:107], v2 offset:26624
    v_mul_f32 v10, v10, v6
    v_accvgpr_read_b32 v12, a8
    v_accvgpr_read_b32 v13, a9
    v_accvgpr_read_b32 v14, a10
    v_mfma_f32_16x16x32_bf16 a[28:31], v[108:111], v[92:95], a[28:31]
    s_waitcnt lgkmcnt(6)
    ds_read_b128 v[108:111], v2 offset:27648
    v_accvgpr_read_b32 v15, a11
    v_accvgpr_read_b32 v16, a24
    v_accvgpr_read_b32 v17, a25
    v_accvgpr_read_b32 v18, a26
    v_mfma_f32_16x16x32_bf16 a[44:47], v[112:115], v[88:91], a[44:47]
    s_waitcnt lgkmcnt(4)
    ds_read_b128 v[112:115], v2 offset:28672
    v_accvgpr_read_b32 v19, a27
    v_accvgpr_read_b32 v20, a40
    v_accvgpr_read_b32 v21, a41
    v_accvgpr_read_b32 v22, a42
    v_mfma_f32_16x16x32_bf16 a[44:47], v[116:119], v[92:95], a[44:47]
    ds_read_b128 v[116:119], v2 offset:29696
    v_accvgpr_read_b32 v23, a43
    v_accvgpr_read_b32 v24, a56
    v_accvgpr_read_b32 v25, a57
    v_accvgpr_read_b32 v26, a58
    v_mfma_f32_16x16x32_bf16 a[60:63], v[120:123], v[88:91], a[60:63]
    ds_read_b128 v[120:123], v2 offset:30720
    v_accvgpr_read_b32 v27, a59
    v_mul_f32 v12, v10, v12
    v_mul_f32 v13, v10, v13
    v_mul_f32 v14, v10, v14
    v_mfma_f32_16x16x32_bf16 a[60:63], v[124:127], v[92:95], a[60:63]
    s_waitcnt lgkmcnt(4)
    ds_read_b128 v[124:127], v2 offset:31744
    v_mul_f32 v15, v10, v15
    v_mul_f32 v16, v10, v16
    v_mul_f32 v17, v10, v17
    v_mul_f32 v18, v10, v18
    v_mfma_f32_16x16x32_bf16 a[156:159], v[96:99], v[88:91], a[156:159]
    v_mul_f32 v19, v10, v19
    v_mul_f32 v20, v10, v20
    v_mul_f32 v21, v10, v21
    v_mul_f32 v22, v10, v22
    v_mul_f32 v23, v10, v23
    v_mfma_f32_16x16x32_bf16 a[156:159], v[100:103], v[92:95], a[156:159]
    v_mul_f32 v24, v10, v24
    v_mul_f32 v25, v10, v25
    v_mul_f32 v26, v10, v26
    v_mul_f32 v27, v10, v27
    v_cvt_pk_bf16_f32 v12, v12, v13
    v_mfma_f32_16x16x32_bf16 a[172:175], v[104:107], v[88:91], a[172:175]
    s_waitcnt lgkmcnt(2)
    v_cvt_pk_bf16_f32 v13, v14, v15
    v_cvt_pk_bf16_f32 v14, v16, v17
    v_cvt_pk_bf16_f32 v15, v18, v19
    v_cvt_pk_bf16_f32 v20, v20, v21
    v_cvt_pk_bf16_f32 v21, v22, v23
    v_mfma_f32_16x16x32_bf16 a[172:175], v[108:111], v[92:95], a[172:175]
    v_cvt_pk_bf16_f32 v22, v24, v25
    v_cvt_pk_bf16_f32 v23, v26, v27
    buffer_store_dwordx4 v[12:15], v1, s[40:43], s81 offen offset:0 sc1
    v_accvgpr_read_b32 v16, a168
    v_mfma_f32_16x16x32_bf16 a[188:191], v[112:115], v[88:91], a[188:191]
    buffer_store_dwordx4 v[20:23], v1, s[40:43], s81 offen offset:1024 sc1
    v_accvgpr_read_b32 v12, a152
    v_accvgpr_read_b32 v13, a153
    v_accvgpr_read_b32 v14, a154
    v_mfma_f32_16x16x32_bf16 a[188:191], v[116:119], v[92:95], a[188:191]
    s_waitcnt lgkmcnt(0)
    v_accvgpr_read_b32 v15, a155
    v_accvgpr_read_b32 v17, a169
    v_accvgpr_read_b32 v18, a170
    v_accvgpr_read_b32 v19, a171
    v_accvgpr_read_b32 v20, a184
    v_mfma_f32_16x16x32_bf16 a[204:207], v[120:123], v[88:91], a[204:207]
    v_accvgpr_read_b32 v21, a185
    v_accvgpr_read_b32 v22, a186
    v_accvgpr_read_b32 v23, a187
    v_accvgpr_read_b32 v24, a200
    v_accvgpr_read_b32 v25, a201
    v_mfma_f32_16x16x32_bf16 a[204:207], v[124:127], v[92:95], a[204:207]
    v_accvgpr_read_b32 v26, a202
    v_accvgpr_read_b32 v27, a203
    v_mul_f32 v12, v10, v12
    v_mul_f32 v13, v10, v13
    v_mul_f32 v14, v10, v14
    v_mfma_f32_16x16x32_bf16 a[220:223], a[136:139], v[88:91], a[220:223]
    v_mul_f32 v15, v10, v15
    v_mul_f32 v16, v10, v16
    v_mul_f32 v17, v10, v17
    v_mul_f32 v18, v10, v18
    v_mul_f32 v19, v10, v19
    v_mfma_f32_16x16x32_bf16 a[220:223], a[136:139], v[92:95], a[220:223]
    v_mul_f32 v20, v10, v20
    v_mul_f32 v21, v10, v21
    v_mul_f32 v22, v10, v22
    v_mul_f32 v23, v10, v23
    v_mul_f32 v24, v10, v24
    v_mul_f32 v25, v10, v25
    v_mul_f32 v26, v10, v26
    v_mul_f32 v27, v10, v27
    v_cmp_nge_f32 vcc, 0x71800000, v9
    v_cvt_pk_bf16_f32 v12, v12, v13
    v_cvt_pk_bf16_f32 v13, v14, v15
    v_cvt_pk_bf16_f32 v14, v16, v17
    v_cvt_pk_bf16_f32 v15, v18, v19
    v_cvt_pk_bf16_f32 v20, v20, v21
    v_cvt_pk_bf16_f32 v21, v22, v23
    v_cvt_pk_bf16_f32 v22, v24, v25
    v_cvt_pk_bf16_f32 v23, v26, v27
    s_or_b64 s[84:85], s[84:85], vcc
    buffer_store_dwordx4 v[12:15], v1, s[40:43], s81 offen offset:2048 sc1
    buffer_store_dwordx4 v[20:23], v1, s[40:43], s81 offen offset:3072 sc1
    s_nop 3
    v_accvgpr_read_b32 v9, a220
    v_cmp_nge_f32 vcc, 0x71800000, v9
    v_rcp_f32 v10, v9
    s_nop 0
    s_or_b64 s[84:85], s[84:85], vcc
    v_mul_f32 v10, v10, v7
    s_add_u32 s72, s81, 622592
    v_accvgpr_read_b32 v12, a12
    v_accvgpr_read_b32 v13, a13
    v_accvgpr_read_b32 v14, a14
    v_accvgpr_read_b32 v15, a15
    v_accvgpr_read_b32 v16, a28
    v_accvgpr_read_b32 v17, a29
    v_accvgpr_read_b32 v18, a30
    v_accvgpr_read_b32 v19, a31
    v_pk_mul_f32 v[12:13], v[12:13], v[10:11] op_sel_hi:[1,0]
    v_pk_mul_f32 v[14:15], v[14:15], v[10:11] op_sel_hi:[1,0]
    v_pk_mul_f32 v[16:17], v[16:17], v[10:11] op_sel_hi:[1,0]
    v_pk_mul_f32 v[18:19], v[18:19], v[10:11] op_sel_hi:[1,0]
    v_cvt_pk_bf16_f32 v12, v12, v13
    v_cvt_pk_bf16_f32 v13, v14, v15
    v_cvt_pk_bf16_f32 v14, v16, v17
    v_cvt_pk_bf16_f32 v15, v18, v19
    buffer_store_dwordx4 v[12:15], v1, s[40:43], s72 offen offset:0 sc1
    v_accvgpr_read_b32 v20, a44
    v_accvgpr_read_b32 v21, a45
    v_accvgpr_read_b32 v22, a46
    v_accvgpr_read_b32 v23, a47
    v_accvgpr_read_b32 v24, a60
    v_accvgpr_read_b32 v25, a61
    v_accvgpr_read_b32 v26, a62
    v_accvgpr_read_b32 v27, a63
    v_pk_mul_f32 v[20:21], v[20:21], v[10:11] op_sel_hi:[1,0]
    v_pk_mul_f32 v[22:23], v[22:23], v[10:11] op_sel_hi:[1,0]
    v_pk_mul_f32 v[24:25], v[24:25], v[10:11] op_sel_hi:[1,0]
    v_pk_mul_f32 v[26:27], v[26:27], v[10:11] op_sel_hi:[1,0]
    v_cvt_pk_bf16_f32 v20, v20, v21
    v_cvt_pk_bf16_f32 v21, v22, v23
    v_cvt_pk_bf16_f32 v22, v24, v25
    v_cvt_pk_bf16_f32 v23, v26, v27
    buffer_store_dwordx4 v[20:23], v1, s[40:43], s72 offen offset:1024 sc1
    v_accvgpr_read_b32 v12, a156
    v_accvgpr_read_b32 v13, a157
    v_accvgpr_read_b32 v14, a158
    v_accvgpr_read_b32 v15, a159
    v_accvgpr_read_b32 v16, a172
    v_accvgpr_read_b32 v17, a173
    v_accvgpr_read_b32 v18, a174
    v_accvgpr_read_b32 v19, a175
    v_pk_mul_f32 v[12:13], v[12:13], v[10:11] op_sel_hi:[1,0]
    v_pk_mul_f32 v[14:15], v[14:15], v[10:11] op_sel_hi:[1,0]
    v_pk_mul_f32 v[16:17], v[16:17], v[10:11] op_sel_hi:[1,0]
    v_pk_mul_f32 v[18:19], v[18:19], v[10:11] op_sel_hi:[1,0]
    v_cvt_pk_bf16_f32 v12, v12, v13
    v_cvt_pk_bf16_f32 v13, v14, v15
    v_cvt_pk_bf16_f32 v14, v16, v17
    v_cvt_pk_bf16_f32 v15, v18, v19
    buffer_store_dwordx4 v[12:15], v1, s[40:43], s72 offen offset:2048 sc1
    v_accvgpr_read_b32 v20, a188
    v_accvgpr_read_b32 v21, a189
    v_accvgpr_read_b32 v22, a190
    v_accvgpr_read_b32 v23, a191
    v_accvgpr_read_b32 v24, a204
    v_accvgpr_read_b32 v25, a205
    v_accvgpr_read_b32 v26, a206
    v_accvgpr_read_b32 v27, a207
    v_pk_mul_f32 v[20:21], v[20:21], v[10:11] op_sel_hi:[1,0]
    v_pk_mul_f32 v[22:23], v[22:23], v[10:11] op_sel_hi:[1,0]
    v_pk_mul_f32 v[24:25], v[24:25], v[10:11] op_sel_hi:[1,0]
    v_pk_mul_f32 v[26:27], v[26:27], v[10:11] op_sel_hi:[1,0]
    v_cvt_pk_bf16_f32 v20, v20, v21
    v_cvt_pk_bf16_f32 v21, v22, v23
    v_cvt_pk_bf16_f32 v22, v24, v25
    v_cvt_pk_bf16_f32 v23, v26, v27
    buffer_store_dwordx4 v[20:23], v1, s[40:43], s72 offen offset:3072 sc1
    s_waitcnt vmcnt(8) lgkmcnt(0)
    v_cmp_gt_u32 vcc, 1, v3
    s_nop 1
    s_and_b64 vcc, vcc, exec
    s_cbranch_scc1 SPIN_ALL
BACK_ALL:
    s_barrier
    s_mov_b32 s79, 114688
    v_bfe_u32 v20, v1, 4, 4
    v_lshrrev_b32 v21, 8, v1
    s_lshl_b32 s98, s4, 4
    s_add_u32 s98, s98, 16
    v_add_u32 v22, s98, v20
    v_mul_u32_u24 v22, 144, v22
    v_add_u32 v22, s79, v22
    v_lshl_add_u32 v9, v21, 3, v22
    s_lshr_b32 s98, s73, 1
    v_add_u32 v8, s98, v9
    v_subrev_u32 v10, s98, v9
    s_and_b32 s99, s4, 1
    s_mul_i32 s99, s99, 20736
    s_add_u32 s99, s99, s79
    v_mul_u32_u24 v23, 144, v20
    v_lshl_add_u32 v23, v21, 3, v23
    v_add_u32 v13, s99, v23
    v_add_u32 v12, s98, v13
    v_accvgpr_read_b32 v32, a64
    v_accvgpr_read_b32 v33, a65
    v_accvgpr_read_b32 v34, a66
    v_accvgpr_read_b32 v35, a67
    v_cvt_pk_bf16_f32 v32, v32, v33
    v_cvt_pk_bf16_f32 v33, v34, v35
    ds_write_b64 v8, v[32:33] offset:0
    v_accvgpr_read_b32 v36, a68
    v_accvgpr_read_b32 v37, a69
    v_accvgpr_read_b32 v38, a70
    v_accvgpr_read_b32 v39, a71
    v_cvt_pk_bf16_f32 v36, v36, v37
    v_cvt_pk_bf16_f32 v37, v38, v39
    ds_write_b64 v8, v[36:37] offset:9216
    v_accvgpr_read_b32 v40, a72
    v_accvgpr_read_b32 v41, a73
    v_accvgpr_read_b32 v42, a74
    v_accvgpr_read_b32 v43, a75
    v_cvt_pk_bf16_f32 v40, v40, v41
    v_cvt_pk_bf16_f32 v41, v42, v43
    ds_write_b64 v8, v[40:41] offset:20736
    v_accvgpr_read_b32 v44, a76
    v_accvgpr_read_b32 v45, a77
    v_accvgpr_read_b32 v46, a78
    v_accvgpr_read_b32 v47, a79
    v_cvt_pk_bf16_f32 v44, v44, v45
    v_cvt_pk_bf16_f32 v45, v46, v47
    ds_write_b64 v8, v[44:45] offset:29952
    v_accvgpr_read_b32 v32, a80
    v_accvgpr_read_b32 v33, a81
    v_accvgpr_read_b32 v34, a82
    v_accvgpr_read_b32 v35, a83
    v_cvt_pk_bf16_f32 v32, v32, v33
    v_cvt_pk_bf16_f32 v33, v34, v35
    ds_write_b64 v9, v[32:33] offset:32
    v_accvgpr_read_b32 v36, a84
    v_accvgpr_read_b32 v37, a85
    v_accvgpr_read_b32 v38, a86
    v_accvgpr_read_b32 v39, a87
    v_cvt_pk_bf16_f32 v36, v36, v37
    v_cvt_pk_bf16_f32 v37, v38, v39
    ds_write_b64 v9, v[36:37] offset:9248
    v_accvgpr_read_b32 v40, a88
    v_accvgpr_read_b32 v41, a89
    v_accvgpr_read_b32 v42, a90
    v_accvgpr_read_b32 v43, a91
    v_cvt_pk_bf16_f32 v40, v40, v41
    v_cvt_pk_bf16_f32 v41, v42, v43
    ds_write_b64 v9, v[40:41] offset:20768
    v_accvgpr_read_b32 v44, a92
    v_accvgpr_read_b32 v45, a93
    v_accvgpr_read_b32 v46, a94
    v_accvgpr_read_b32 v47, a95
    v_cvt_pk_bf16_f32 v44, v44, v45
    v_cvt_pk_bf16_f32 v45, v46, v47
    ds_write_b64 v9, v[44:45] offset:29984
    v_accvgpr_read_b32 v32, a96
    v_accvgpr_read_b32 v33, a97
    v_accvgpr_read_b32 v34, a98
    v_accvgpr_read_b32 v35, a99
    v_cvt_pk_bf16_f32 v32, v32, v33
    v_cvt_pk_bf16_f32 v33, v34, v35
    ds_write_b64 v10, v[32:33] offset:64
    v_accvgpr_read_b32 v36, a100
    v_accvgpr_read_b32 v37, a101
    v_accvgpr_read_b32 v38, a102
    v_accvgpr_read_b32 v39, a103
    v_cvt_pk_bf16_f32 v36, v36, v37
    v_cvt_pk_bf16_f32 v37, v38, v39
    ds_write_b64 v10, v[36:37] offset:9280
    v_accvgpr_read_b32 v40, a104
    v_accvgpr_read_b32 v41, a105
    v_accvgpr_read_b32 v42, a106
    v_accvgpr_read_b32 v43, a107
    s_xor_b32 s21, s3, 0
    s_lshl2_add_u32 s21, s21, s4
    s_mul_i32 s21, s21, 36864
    s_add_u32 s64, s21, s17
    s_add_u32 m0, s78, 0
    s_nop 0
    buffer_load_dwordx4 v1, s[56:59], s64 offen sc1 lds
    v_cvt_pk_bf16_f32 v40, v40, v41
    v_cvt_pk_bf16_f32 v41, v42, v43
    ds_write_b64 v10, v[40:41] offset:20800
    v_accvgpr_read_b32 v44, a108
    v_accvgpr_read_b32 v45, a109
    v_accvgpr_read_b32 v46, a110
    v_accvgpr_read_b32 v47, a111
    v_cvt_pk_bf16_f32 v44, v44, v45
    v_cvt_pk_bf16_f32 v45, v46, v47
    ds_write_b64 v10, v[44:45] offset:30016
    v_accvgpr_read_b32 v32, a112
    v_accvgpr_read_b32 v33, a113
    v_accvgpr_read_b32 v34, a114
    buffer_load_dwordx4 v1, s[56:59], s64 offen offset:1024 sc1 lds
    v_accvgpr_read_b32 v35, a115
    v_cvt_pk_bf16_f32 v32, v32, v33
    v_cvt_pk_bf16_f32 v33, v34, v35
    ds_write_b64 v9, v[32:33] offset:96
    v_accvgpr_read_b32 v36, a116
    v_accvgpr_read_b32 v37, a117
    v_accvgpr_read_b32 v38, a118
    v_accvgpr_read_b32 v39, a119
    v_cvt_pk_bf16_f32 v36, v36, v37
    v_cvt_pk_bf16_f32 v37, v38, v39
    ds_write_b64 v9, v[36:37] offset:9312
    v_accvgpr_read_b32 v40, a120
    v_accvgpr_read_b32 v41, a121
    s_add_u32 s64, s21, s18
    s_add_u32 m0, s78, 2048
    s_nop 0
    buffer_load_dwordx4 v1, s[56:59], s64 offen sc1 lds
    v_accvgpr_read_b32 v42, a122
    v_accvgpr_read_b32 v43, a123
    v_cvt_pk_bf16_f32 v40, v40, v41
    v_cvt_pk_bf16_f32 v41, v42, v43
    ds_write_b64 v9, v[40:41] offset:20832
    v_accvgpr_read_b32 v44, a124
    v_accvgpr_read_b32 v45, a125
    v_accvgpr_read_b32 v46, a126
    v_accvgpr_read_b32 v47, a127
    v_cvt_pk_bf16_f32 v44, v44, v45
    v_cvt_pk_bf16_f32 v45, v46, v47
    s_waitcnt lgkmcnt(14)
    ds_write_b64 v9, v[44:45] offset:30048
    v_accvgpr_read_b32 v32, a128
    buffer_load_dwordx4 v1, s[56:59], s64 offen offset:1024 sc1 lds
    v_accvgpr_read_b32 v33, a129
    v_accvgpr_read_b32 v34, a130
    v_accvgpr_read_b32 v35, a131
    v_cvt_pk_bf16_f32 v32, v32, v33
    v_cvt_pk_bf16_f32 v33, v34, v35
    s_waitcnt lgkmcnt(14)
    ds_write_b64 v12, v[32:33] offset:0
    v_accvgpr_read_b32 v36, a132
    v_accvgpr_read_b32 v37, a133
    v_accvgpr_read_b32 v38, a134
    v_accvgpr_read_b32 v39, a135
    v_cvt_pk_bf16_f32 v36, v36, v37
    v_cvt_pk_bf16_f32 v37, v38, v39
    s_cmp_eq_u32 s73, 0
    s_cselect_b64 exec, -1, 0
    s_waitcnt lgkmcnt(14)
    ds_write_b64 v13, v[36:37] offset:32
    s_mov_b64 exec, -1
    s_add_u32 s64, s21, s19
    s_add_u32 m0, s78, 4096
    s_nop 0
    buffer_load_dwordx4 v1, s[56:59], s64 offen sc1 lds
    s_cmp_lg_u64 s[84:85], 0
    s_cselect_b32 s7, 1, 0
    v_mov_b32 v20, s7
    s_lshl2_add_u32 s98, s4, s79
    v_mov_b32 v21, s98
    s_waitcnt lgkmcnt(14)
    ds_write_b32 v21, v20 offset:41472
    v_mov_b32 v21, s79
    s_and_b32 s98, s4, 1
    s_lshl_b32 s98, s98, 6
    v_lshrrev_b32 v14, 4, v1
    v_add_u32 v14, s98, v14
    buffer_load_dwordx4 v1, s[56:59], s64 offen offset:1024 sc1 lds
    s_lshr_b32 s99, s4, 1
    s_mul_i32 s7, s99, 144
    s_add_u32 s7, s7, 2
    v_add_u32 v2, s7, v14
    v_mul_u32_u24 v2, 144, v2
    v_add_u32 v2, s79, v2
    s_sub_u32 s7, 15, s6
    s_cmp_eq_u32 s99, 0
    s_cselect_b32 s7, s6, s7
    s_lshl_b32 s7, s7, 7
    v_add_u32 v14, s7, v14
    v_lshrrev_b32 v15, 4, v14
    s_mov_b32 s98, 155648
    s_add_u32 s64, s21, s20
    s_add_u32 m0, s78, 6144
    s_nop 0
    buffer_load_dwordx4 v1, s[56:59], s64 offen sc1 lds
    v_mul_lo_u32 v15, v15, s98
    v_and_b32 v23, 0xf0, v1
    v_add_u32 v15, v15, v23
    s_lshl2_add_u32 s98, s62, s4
    s_mul_i32 s98, s98, 311296
    v_add_u32 v4, s98, v1
    v_add_u32 v5, 155648, v4
    v_bfe_u32 v19, v1, 4, 3
    v_lshlrev_b32 v19, 7, v19
    v_mov_b32 v11, v1
    v_add_u32 v12, 0x10000, v1
    v_add_u32 v13, 0x20000, v1
    s_mov_b32 s98, 0xbfb8aa3b
    s_mov_b32 s99, 0x3eae1a93
    s_waitcnt vmcnt(7) lgkmcnt(0)
    s_barrier
    ds_read_b128 v[24:27], v21 offset:41472
    ds_read_b128 v[32:35], v2 offset:2016
    ds_read_b128 v[36:39], v2 offset:2032
    ds_read_b128 v[40:43], v2 offset:2048
    ds_read_b128 v[44:47], v2 offset:1728
    ds_read_b128 v[48:51], v2 offset:1744
    ds_read_b128 v[52:55], v2 offset:1760
    s_waitcnt lgkmcnt(6)
    v_or3_b32 v24, v24, v25, v26
    v_or_b32 v24, v24, v27
    s_nop 0
    v_readfirstlane_b32 s7, v24
    s_nop 1
    s_andn2_b32 s7, s7, s83
    s_cbranch_scc1 K1_REDO
    v_mov_b32 v31, 2
    buffer_store_dword v31, v30, s[32:35], s101 offen sc1
    s_xor_b32 s21, s3, 1
    s_lshl2_add_u32 s21, s21, s4
    s_mul_i32 s21, s21, 36864
    s_add_u32 s64, s21, s17
    s_add_u32 m0, s78, 28672
    s_nop 0
    buffer_load_dwordx4 v1, s[56:59], s64 offen sc1 lds
    ds_read_b128 v[128:131], v2 offset:2096
    ds_read_b128 v[132:135], v2 offset:2112
    ds_read_b128 v[136:139], v2 offset:2128
    ds_read_b128 v[56:59], v2 offset:1440
    ds_read_b128 v[60:63], v2 offset:1456
    ds_read_b128 v[64:67], v2 offset:1472
    ds_read_b128 v[68:71], v2 offset:1152
    ds_read_b128 v[72:75], v2 offset:1168
    ds_read_b128 v[76:79], v2 offset:1184
    s_waitcnt lgkmcnt(8)
    v_dot2_f32_bf16 v140, v128, v32, 0
    buffer_load_dwordx4 v1, s[56:59], s64 offen offset:1024 sc1 lds
    v_dot2_f32_bf16 v141, v128, v44, 0
    ds_read_b128 v[80:83], v2 offset:864
    s_waitcnt lgkmcnt(6)
    v_dot2_f32_bf16 v142, v128, v56, 0
    s_waitcnt lgkmcnt(3)
    v_dot2_f32_bf16 v143, v128, v68, 0
    ds_read_b128 v[84:87], v2 offset:880
    v_dot2c_f32_bf16 v140, v129, v33
    v_dot2c_f32_bf16 v141, v129, v45
    ds_read_b128 v[88:91], v2 offset:896
    v_dot2c_f32_bf16 v142, v129, v57
    v_dot2c_f32_bf16 v143, v129, v69
    s_add_u32 s64, s21, s18
    s_add_u32 m0, s78, 30720
    s_nop 0
    buffer_load_dwordx4 v1, s[56:59], s64 offen sc1 lds
    ds_read_b128 v[92:95], v2 offset:576
    v_dot2c_f32_bf16 v140, v130, v34
    v_dot2c_f32_bf16 v141, v130, v46
    ds_read_b128 v[96:99], v2 offset:592
    v_dot2c_f32_bf16 v142, v130, v58
    v_dot2c_f32_bf16 v143, v130, v70
    ds_read_b128 v[100:103], v2 offset:608
    v_dot2c_f32_bf16 v140, v131, v35
    v_dot2c_f32_bf16 v141, v131, v47
    ds_read_b128 v[104:107], v2 offset:288
    buffer_load_dwordx4 v1, s[56:59], s64 offen offset:1024 sc1 lds
    v_dot2c_f32_bf16 v142, v131, v59
    v_dot2c_f32_bf16 v143, v131, v71
    ds_read_b128 v[108:111], v2 offset:304
    v_dot2c_f32_bf16 v140, v132, v36
    v_dot2c_f32_bf16 v141, v132, v48
    ds_read_b128 v[112:115], v2 offset:320
    v_dot2c_f32_bf16 v142, v132, v60
    s_waitcnt lgkmcnt(10)
    v_dot2c_f32_bf16 v143, v132, v72
    ds_read_b128 v[116:119], v2 offset:0
    v_dot2c_f32_bf16 v140, v133, v37
    s_add_u32 s64, s21, s19
    s_add_u32 m0, s78, 32768
    s_nop 0
    buffer_load_dwordx4 v1, s[56:59], s64 offen sc1 lds
    v_dot2c_f32_bf16 v141, v133, v49
    ds_read_b128 v[120:123], v2 offset:16
    v_dot2c_f32_bf16 v142, v133, v61
    v_dot2c_f32_bf16 v143, v133, v73
    ds_read_b128 v[124:127], v2 offset:32
    v_dot2c_f32_bf16 v140, v134, v38
    v_dot2c_f32_bf16 v141, v134, v50
    v_dot2c_f32_bf16 v142, v134, v62
    v_dot2c_f32_bf16 v143, v134, v74
    v_dot2c_f32_bf16 v140, v135, v39
    buffer_load_dwordx4 v1, s[56:59], s64 offen offset:1024 sc1 lds
    v_dot2c_f32_bf16 v141, v135, v51
    v_dot2c_f32_bf16 v142, v135, v63
    v_dot2c_f32_bf16 v143, v135, v75
    v_dot2c_f32_bf16 v140, v136, v40
    v_dot2c_f32_bf16 v141, v136, v52
    v_dot2c_f32_bf16 v142, v136, v64
    s_waitcnt lgkmcnt(12)
    v_dot2c_f32_bf16 v143, v136, v76
    s_waitcnt lgkmcnt(11)
    v_dot2_f32_bf16 v144, v128, v80, 0
    s_waitcnt lgkmcnt(8)
    v_dot2_f32_bf16 v145, v128, v92, 0
    ds_read_b128 v[32:35], v2 offset:2064
    s_add_u32 s64, s21, s20
    s_add_u32 m0, s78, 34816
    s_nop 0
    buffer_load_dwordx4 v1, s[56:59], s64 offen sc1 lds
    s_waitcnt lgkmcnt(6)
    v_dot2_f32_bf16 v146, v128, v104, 0
    s_waitcnt lgkmcnt(3)
    v_dot2_f32_bf16 v147, v128, v116, 0
    ds_read_b128 v[36:39], v2 offset:2080
    v_dot2c_f32_bf16 v144, v129, v81
    v_dot2c_f32_bf16 v145, v129, v93
    ds_read_b128 v[44:47], v2 offset:1776
    v_dot2c_f32_bf16 v146, v129, v105
    v_dot2c_f32_bf16 v147, v129, v117
    ds_read_b128 v[48:51], v2 offset:1792
    v_dot2c_f32_bf16 v144, v130, v82
    s_xor_b32 s21, s3, 2
    s_lshl2_add_u32 s21, s21, s4
    s_mul_i32 s21, s21, 36864
    s_add_u32 s64, s21, s17
    s_add_u32 m0, s78, 57344
    s_nop 0
    buffer_load_dwordx4 v1, s[56:59], s64 offen sc1 lds
    v_dot2c_f32_bf16 v145, v130, v94
    ds_read_b128 v[56:59], v2 offset:1488
    v_dot2c_f32_bf16 v146, v130, v106
    v_dot2c_f32_bf16 v147, v130, v118
    ds_read_b128 v[60:63], v2 offset:1504
    v_dot2c_f32_bf16 v144, v131, v83
    v_dot2c_f32_bf16 v145, v131, v95
    ds_read_b128 v[68:71], v2 offset:1200
    v_dot2c_f32_bf16 v146, v131, v107
    v_dot2c_f32_bf16 v147, v131, v119
    buffer_load_dwordx4 v1, s[56:59], s64 offen offset:1024 sc1 lds
    ds_read_b128 v[72:75], v2 offset:1216
    v_dot2c_f32_bf16 v144, v132, v84
    v_dot2c_f32_bf16 v145, v132, v96
    v_dot2c_f32_bf16 v146, v132, v108
    s_waitcnt lgkmcnt(9)
    v_dot2c_f32_bf16 v147, v132, v120
    v_dot2c_f32_bf16 v144, v133, v85
    v_dot2c_f32_bf16 v145, v133, v97
    v_dot2c_f32_bf16 v146, v133, v109
    v_dot2c_f32_bf16 v147, v133, v121
    v_dot2c_f32_bf16 v144, v134, v86
    s_add_u32 s64, s21, s18
    s_add_u32 m0, s78, 59392
    s_nop 0
    buffer_load_dwordx4 v1, s[56:59], s64 offen sc1 lds
    v_dot2c_f32_bf16 v145, v134, v98
    v_dot2c_f32_bf16 v146, v134, v110
    v_dot2c_f32_bf16 v147, v134, v122
    v_dot2c_f32_bf16 v144, v135, v87
    v_dot2c_f32_bf16 v145, v135, v99
    v_dot2c_f32_bf16 v146, v135, v111
    v_dot2c_f32_bf16 v147, v135, v123
    v_dot2c_f32_bf16 v144, v136, v88
    v_dot2c_f32_bf16 v145, v136, v100
    v_dot2c_f32_bf16 v146, v136, v112
    buffer_load_dwordx4 v1, s[56:59], s64 offen offset:1024 sc1 lds
    s_waitcnt lgkmcnt(8)
    v_dot2c_f32_bf16 v147, v136, v124
    v_lshlrev_b32 v8, 16, v138
    v_mul_f32 v8, s98, v8
    v_exp_f32 v8, v8
    v_mov_b32 v9, 0xf149f2ca
    ds_read_b128 v[80:83], v2 offset:912
    v_cmp_le_u32 vcc, 2, v14
    ds_read_b128 v[84:87], v2 offset:928
    s_nop 0
    v_cndmask_b32 v141, v9, v141, vcc
    v_cmp_le_u32 vcc, 4, v14
    s_add_u32 s64, s21, s19
    s_add_u32 m0, s78, 61440
    s_nop 0
    buffer_load_dwordx4 v1, s[56:59], s64 offen sc1 lds
    ds_read_b128 v[92:95], v2 offset:624
    v_cndmask_b32 v142, v9, v142, vcc
    v_cmp_le_u32 vcc, 6, v14
    ds_read_b128 v[96:99], v2 offset:640
    s_nop 0
    v_cndmask_b32 v143, v9, v143, vcc
    v_cmp_le_u32 vcc, 8, v14
    ds_read_b128 v[104:107], v2 offset:336
    s_nop 0
    v_cndmask_b32 v144, v9, v144, vcc
    v_cmp_le_u32 vcc, 10, v14
    ds_read_b128 v[108:111], v2 offset:352
    buffer_load_dwordx4 v1, s[56:59], s64 offen offset:1024 sc1 lds
    v_cndmask_b32 v145, v9, v145, vcc
    v_cmp_le_u32 vcc, 12, v14
    ds_read_b128 v[116:119], v2 offset:48
    s_nop 0
    v_cndmask_b32 v146, v9, v146, vcc
    v_cmp_le_u32 vcc, 14, v14
    s_waitcnt lgkmcnt(14)
    ds_read_b128 v[120:123], v2 offset:64
    s_nop 0
    v_cndmask_b32 v147, v9, v147, vcc
    v_max3_f32 v9, v140, v141, v142
    v_max3_f32 v10, v143, v144, v145
    v_max3_f32 v9, v9, v146, v147
    s_add_u32 s64, s21, s20
    s_add_u32 m0, s78, 63488
    s_nop 0
    buffer_load_dwordx4 v1, s[56:59], s64 offen sc1 lds
    v_max_f32 v9, v9, v10
    v_mul_f32 v9, s99, v9
    v_add_f32 v8, 1.0, v8
    v_fma_f32 v140, v140, s99, -v9
    v_fma_f32 v141, v141, s99, -v9
    v_fma_f32 v142, v142, s99, -v9
    v_fma_f32 v143, v143, s99, -v9
    v_fma_f32 v144, v144, s99, -v9
    v_fma_f32 v145, v145, s99, -v9
    v_fma_f32 v146, v146, s99, -v9
    v_fma_f32 v147, v147, s99, -v9
    buffer_load_dword v3, v19, s[32:35], s66 offen sc1
    s_xor_b32 s21, s3, 3
    s_lshl2_add_u32 s21, s21, s4
    s_mul_i32 s21, s21, 36864
    s_add_u32 s64, s21, s17
    s_add_u32 m0, s78, 86016
    s_nop 0
    buffer_load_dwordx4 v1, s[56:59], s64 offen sc1 lds
    v_exp_f32 v140, v140
    v_exp_f32 v141, v141
    v_exp_f32 v142, v142
    v_exp_f32 v143, v143
    v_exp_f32 v144, v144
    v_exp_f32 v145, v145
    v_exp_f32 v146, v146
    v_exp_f32 v147, v147
    buffer_load_dwordx4 v1, s[56:59], s64 offen offset:1024 sc1 lds
    v_add_f32 v10, v140, v141
    v_add_f32 v10, v10, v142
    v_add_f32 v10, v10, v143
    v_add_f32 v10, v10, v144
    v_add_f32 v10, v10, v145
    v_add_f32 v10, v10, v146
    v_add_f32 v10, v10, v147
    v_mul_f32 v10, v10, v8
    s_add_u32 s64, s21, s18
    s_add_u32 m0, s78, 88064
    s_nop 0
    buffer_load_dwordx4 v1, s[56:59], s64 offen sc1 lds
    v_rcp_f32 v10, v10
    s_nop 0
    v_mul_f32 v140, v140, v10
    v_mul_f32 v141, v141, v10
    v_mul_f32 v142, v142, v10
    v_mul_f32 v143, v143, v10
    v_mul_f32 v144, v144, v10
    v_mul_f32 v145, v145, v10
    v_mul_f32 v146, v146, v10
    v_mul_f32 v147, v147, v10
    buffer_load_dwordx4 v1, s[56:59], s64 offen offset:1024 sc1 lds
    v_cvt_pk_bf16_f32 v148, 0, v140
    v_cvt_pk_bf16_f32 v149, 0, v141
    v_cvt_pk_bf16_f32 v150, 0, v142
    v_cvt_pk_bf16_f32 v151, 0, v143
    v_cvt_pk_bf16_f32 v152, 0, v144
    v_cvt_pk_bf16_f32 v153, 0, v145
    v_cvt_pk_bf16_f32 v154, 0, v146
    v_cvt_pk_bf16_f32 v155, 0, v147
    s_add_u32 s64, s21, s19
    s_add_u32 m0, s78, 90112
    s_nop 0
    buffer_load_dwordx4 v1, s[56:59], s64 offen sc1 lds
    v_lshrrev_b32 v140, 16, v148
    v_lshrrev_b32 v141, 16, v149
    v_lshrrev_b32 v142, 16, v150
    v_lshrrev_b32 v143, 16, v151
    v_lshrrev_b32 v144, 16, v152
    v_lshrrev_b32 v145, 16, v153
    v_lshrrev_b32 v146, 16, v154
    v_lshrrev_b32 v147, 16, v155
    v_dot2_f32_bf16 v128, v42, v140, 0
    buffer_load_dwordx4 v1, s[56:59], s64 offen offset:1024 sc1 lds
    v_dot2_f32_bf16 v129, v42, v148, 0
    v_dot2_f32_bf16 v130, v43, v140, 0
    v_dot2_f32_bf16 v131, v43, v148, 0
    v_dot2_f32_bf16 v132, v32, v140, 0
    v_dot2_f32_bf16 v133, v32, v148, 0
    v_dot2_f32_bf16 v134, v33, v140, 0
    v_dot2_f32_bf16 v135, v33, v148, 0
    v_dot2_f32_bf16 v136, v34, v140, 0
    s_add_u32 s64, s21, s20
    s_add_u32 m0, s78, 92160
    s_nop 0
    buffer_load_dwordx4 v1, s[56:59], s64 offen sc1 lds
    v_dot2_f32_bf16 v137, v34, v148, 0
    v_dot2_f32_bf16 v138, v35, v140, 0
    v_dot2_f32_bf16 v139, v35, v148, 0
    s_waitcnt lgkmcnt(14)
    v_dot2_f32_bf16 v156, v36, v140, 0
    v_dot2_f32_bf16 v157, v36, v148, 0
    v_dot2_f32_bf16 v158, v37, v140, 0
    v_dot2_f32_bf16 v159, v37, v148, 0
    v_dot2_f32_bf16 v17, v38, v140, 0
    v_dot2_f32_bf16 v18, v38, v148, 0
    s_waitcnt vmcnt(7)
    v_cmp_gt_u32 vcc, 2, v3
    s_nop 1
    s_and_b64 vcc, vcc, exec
    s_cbranch_scc1 SPIN_CTX
BACK_CTX:
    buffer_load_dwordx4 a[0:3], v4, s[40:43], s63 offen offset:0 sc1
    v_dot2c_f32_bf16 v128, v54, v141
    v_dot2c_f32_bf16 v129, v54, v149
    v_dot2c_f32_bf16 v130, v55, v141
    v_dot2c_f32_bf16 v131, v55, v149
    s_waitcnt lgkmcnt(13)
    v_dot2c_f32_bf16 v132, v44, v141
    v_dot2c_f32_bf16 v133, v44, v149
    v_dot2c_f32_bf16 v134, v45, v141
    v_dot2c_f32_bf16 v135, v45, v149
    buffer_load_dwordx4 a[4:7], v5, s[40:43], s63 offen offset:0 sc1
    v_dot2c_f32_bf16 v136, v46, v141
    v_dot2c_f32_bf16 v137, v46, v149
    v_dot2c_f32_bf16 v138, v47, v141
    v_dot2c_f32_bf16 v139, v47, v149
    s_waitcnt lgkmcnt(12)
    v_dot2c_f32_bf16 v156, v48, v141
    v_dot2c_f32_bf16 v157, v48, v149
    v_dot2c_f32_bf16 v158, v49, v141
    v_dot2c_f32_bf16 v159, v49, v149
    v_dot2c_f32_bf16 v17, v50, v141
    buffer_load_dwordx4 a[8:11], v4, s[40:43], s63 offen offset:1024 sc1
    v_dot2c_f32_bf16 v18, v50, v149
    v_dot2c_f32_bf16 v128, v66, v142
    v_dot2c_f32_bf16 v129, v66, v150
    v_dot2c_f32_bf16 v130, v67, v142
    v_dot2c_f32_bf16 v131, v67, v150
    s_waitcnt lgkmcnt(11)
    v_dot2c_f32_bf16 v132, v56, v142
    v_dot2c_f32_bf16 v133, v56, v150
    v_dot2c_f32_bf16 v134, v57, v142
    buffer_load_dwordx4 a[12:15], v5, s[40:43], s63 offen offset:1024 sc1
    v_dot2c_f32_bf16 v135, v57, v150
    v_dot2c_f32_bf16 v136, v58, v142
    v_dot2c_f32_bf16 v137, v58, v150
    v_dot2c_f32_bf16 v138, v59, v142
    v_dot2c_f32_bf16 v139, v59, v150
    s_waitcnt lgkmcnt(10)
    v_dot2c_f32_bf16 v156, v60, v142
    v_dot2c_f32_bf16 v157, v60, v150
    v_dot2c_f32_bf16 v158, v61, v142
    v_dot2c_f32_bf16 v159, v61, v150
    buffer_load_dwordx4 a[16:19], v4, s[40:43], s63 offen offset:2048 sc1
    v_dot2c_f32_bf16 v17, v62, v142
    v_dot2c_f32_bf16 v18, v62, v150
    v_dot2c_f32_bf16 v128, v78, v143
    v_dot2c_f32_bf16 v129, v78, v151
    v_dot2c_f32_bf16 v130, v79, v143
    v_dot2c_f32_bf16 v131, v79, v151
    s_waitcnt lgkmcnt(9)
    v_dot2c_f32_bf16 v132, v68, v143
    v_dot2c_f32_bf16 v133, v68, v151
    v_dot2c_f32_bf16 v134, v69, v143
    buffer_load_dwordx4 a[20:23], v5, s[40:43], s63 offen offset:2048 sc1
    v_dot2c_f32_bf16 v135, v69, v151
    v_dot2c_f32_bf16 v136, v70, v143
    v_dot2c_f32_bf16 v137, v70, v151
    v_dot2c_f32_bf16 v138, v71, v143
    v_dot2c_f32_bf16 v139, v71, v151
    s_waitcnt lgkmcnt(8)
    v_dot2c_f32_bf16 v156, v72, v143
    v_dot2c_f32_bf16 v157, v72, v151
    v_dot2c_f32_bf16 v158, v73, v143
    buffer_load_dwordx4 a[24:27], v4, s[40:43], s63 offen offset:3072 sc1
    v_dot2c_f32_bf16 v159, v73, v151
    v_dot2c_f32_bf16 v17, v74, v143
    v_dot2c_f32_bf16 v18, v74, v151
    v_dot2c_f32_bf16 v128, v90, v144
    v_dot2c_f32_bf16 v129, v90, v152
    v_dot2c_f32_bf16 v130, v91, v144
    v_dot2c_f32_bf16 v131, v91, v152
    s_waitcnt lgkmcnt(7)
    v_dot2c_f32_bf16 v132, v80, v144
    v_dot2c_f32_bf16 v133, v80, v152
    buffer_load_dwordx4 a[28:31], v5, s[40:43], s63 offen offset:3072 sc1
    v_dot2c_f32_bf16 v134, v81, v144
    v_dot2c_f32_bf16 v135, v81, v152
    v_dot2c_f32_bf16 v136, v82, v144
    v_dot2c_f32_bf16 v137, v82, v152
    v_dot2c_f32_bf16 v138, v83, v144
    v_dot2c_f32_bf16 v139, v83, v152
    s_waitcnt lgkmcnt(6)
    v_dot2c_f32_bf16 v156, v84, v144
    v_dot2c_f32_bf16 v157, v84, v152
    v_dot2c_f32_bf16 v158, v85, v144
    s_xor_b32 s63, s63, 4096
    buffer_load_dwordx4 a[32:35], v4, s[40:43], s63 offen offset:0 sc1
    v_dot2c_f32_bf16 v159, v85, v152
    v_dot2c_f32_bf16 v17, v86, v144
    v_dot2c_f32_bf16 v18, v86, v152
    v_dot2c_f32_bf16 v128, v102, v145
    v_dot2c_f32_bf16 v129, v102, v153
    v_dot2c_f32_bf16 v130, v103, v145
    v_dot2c_f32_bf16 v131, v103, v153
    s_waitcnt lgkmcnt(5)
    v_dot2c_f32_bf16 v132, v92, v145
    buffer_load_dwordx4 a[36:39], v5, s[40:43], s63 offen offset:0 sc1
    v_dot2c_f32_bf16 v133, v92, v153
    v_dot2c_f32_bf16 v134, v93, v145
    v_dot2c_f32_bf16 v135, v93, v153
    v_dot2c_f32_bf16 v136, v94, v145
    v_dot2c_f32_bf16 v137, v94, v153
    v_dot2c_f32_bf16 v138, v95, v145
    v_dot2c_f32_bf16 v139, v95, v153
    s_waitcnt lgkmcnt(4)
    v_dot2c_f32_bf16 v156, v96, v145
    v_dot2c_f32_bf16 v157, v96, v153
    buffer_load_dwordx4 a[40:43], v4, s[40:43], s63 offen offset:1024 sc1
    v_dot2c_f32_bf16 v158, v97, v145
    v_dot2c_f32_bf16 v159, v97, v153
    v_dot2c_f32_bf16 v17, v98, v145
    v_dot2c_f32_bf16 v18, v98, v153
    v_dot2c_f32_bf16 v128, v114, v146
    v_dot2c_f32_bf16 v129, v114, v154
    v_dot2c_f32_bf16 v130, v115, v146
    v_dot2c_f32_bf16 v131, v115, v154
    buffer_load_dwordx4 a[44:47], v5, s[40:43], s63 offen offset:1024 sc1
    s_waitcnt lgkmcnt(3)
    v_dot2c_f32_bf16 v132, v104, v146
    v_dot2c_f32_bf16 v133, v104, v154
    v_dot2c_f32_bf16 v134, v105, v146
    v_dot2c_f32_bf16 v135, v105, v154
    v_dot2c_f32_bf16 v136, v106, v146
    v_dot2c_f32_bf16 v137, v106, v154
    v_dot2c_f32_bf16 v138, v107, v146
    v_dot2c_f32_bf16 v139, v107, v154
    s_waitcnt lgkmcnt(2)
    v_dot2c_f32_bf16 v156, v108, v146
    buffer_load_dwordx4 a[48:51], v4, s[40:43], s63 offen offset:2048 sc1
    v_dot2c_f32_bf16 v157, v108, v154
    v_dot2c_f32_bf16 v158, v109, v146
    v_dot2c_f32_bf16 v159, v109, v154
    v_dot2c_f32_bf16 v17, v110, v146
    v_dot2c_f32_bf16 v18, v110, v154
    v_dot2c_f32_bf16 v128, v126, v147
    v_dot2c_f32_bf16 v129, v126, v155
    v_dot2c_f32_bf16 v130, v127, v147
    v_dot2c_f32_bf16 v131, v127, v155
    buffer_load_dwordx4 a[52:55], v5, s[40:43], s63 offen offset:2048 sc1
    s_waitcnt lgkmcnt(1)
    v_dot2c_f32_bf16 v132, v116, v147
    v_dot2c_f32_bf16 v133, v116, v155
    v_dot2c_f32_bf16 v134, v117, v147
    v_dot2c_f32_bf16 v135, v117, v155
    v_dot2c_f32_bf16 v136, v118, v147
    v_dot2c_f32_bf16 v137, v118, v155
    v_dot2c_f32_bf16 v138, v119, v147
    v_dot2c_f32_bf16 v139, v119, v155
    buffer_load_dwordx4 a[56:59], v4, s[40:43], s63 offen offset:3072 sc1
    s_waitcnt lgkmcnt(0)
    v_dot2c_f32_bf16 v156, v120, v147
    v_dot2c_f32_bf16 v157, v120, v155
    v_dot2c_f32_bf16 v158, v121, v147
    v_dot2c_f32_bf16 v159, v121, v155
    v_dot2c_f32_bf16 v17, v122, v147
    v_dot2c_f32_bf16 v18, v122, v155
    v_mov_b32 v89, 0
    v_mov_b32 v90, 0
    v_mov_b32 v91, 0
    buffer_load_dwordx4 a[60:63], v5, s[40:43], s63 offen offset:3072 sc1
    s_xor_b32 s63, s63, 12288
    v_cvt_pk_bf16_f32 v80, v128, v129
    v_cvt_pk_bf16_f32 v81, v130, v131
    v_cvt_pk_bf16_f32 v82, v132, v133
    v_cvt_pk_bf16_f32 v83, v134, v135
    v_cvt_pk_bf16_f32 v84, v136, v137
    v_cvt_pk_bf16_f32 v85, v138, v139
    v_cvt_pk_bf16_f32 v86, v156, v157
    v_cvt_pk_bf16_f32 v87, v158, v159
    v_cvt_pk_bf16_f32 v88, v17, v18
    s_waitcnt vmcnt(8)
    s_barrier
    ds_read_b128 v[104:107], v11 offset:0
    ds_read_b128 v[108:111], v11 offset:7168
    ds_read_b128 v[112:115], v11 offset:1024
    ds_read_b128 v[116:119], v11 offset:8192
    s_waitcnt lgkmcnt(3)
    v_mfma_f32_16x16x32_bf16 v[176:179], v[104:107], a[0:3], 0
    s_lshl3_add_u32 s98, 1, s5
    ds_read_b128 v[120:123], v11 offset:2048
    ds_read_b128 v[124:127], v11 offset:9216
    s_waitcnt lgkmcnt(4)
    v_mfma_f32_16x16x32_bf16 v[176:179], v[108:111], a[8:11], v[176:179]
    s_and_b32 s98, s98, 31
    buffer_load_dwordx4 a[64:67], v4, s[40:43], s63 offen offset:0 sc1
    v_mfma_f32_16x16x32_bf16 v[180:183], v[104:107], a[4:7], 0
    s_lshl_b32 s8, s6, 5
    ds_read_b128 v[128:131], v11 offset:3072
    ds_read_b128 v[132:135], v11 offset:10240
    v_mfma_f32_16x16x32_bf16 v[180:183], v[108:111], a[12:15], v[180:183]
    s_add_u32 s98, s98, s8
    ds_read_b128 v[136:139], v11 offset:4096
    s_waitcnt lgkmcnt(6)
    v_mfma_f32_16x16x32_bf16 v[184:187], v[112:115], a[0:3], 0
    s_mul_i32 s98, s98, 3
    buffer_load_dwordx4 a[68:71], v5, s[40:43], s63 offen offset:0 sc1
    s_waitcnt lgkmcnt(5)
    v_mfma_f32_16x16x32_bf16 v[184:187], v[116:119], a[8:11], v[184:187]
    s_sub_u32 s98, s98, 1
    ds_read_b128 v[140:143], v11 offset:11264
    ds_read_b128 v[144:147], v11 offset:5120
    v_mfma_f32_16x16x32_bf16 v[188:191], v[112:115], a[4:7], 0
    s_add_u32 s98, s98, 3
    ds_read_b128 v[148:151], v11 offset:12288
    v_mfma_f32_16x16x32_bf16 v[188:191], v[116:119], a[12:15], v[188:191]
    s_lshl2_add_u32 s98, s98, s4
    ds_read_b128 v[104:107], v11 offset:6144
    s_waitcnt lgkmcnt(5)
    v_mfma_f32_16x16x32_bf16 v[192:195], v[120:123], a[0:3], 0
    s_mul_i32 s8, s98, 3072
    buffer_load_dwordx4 a[72:75], v4, s[40:43], s63 offen offset:1024 sc1
    v_mfma_f32_16x16x32_bf16 v[192:195], v[124:127], a[8:11], v[192:195]
    s_lshl3_add_u32 s98, 2, s5
    ds_read_b128 v[108:111], v11 offset:13312
    ds_read_b128 v[112:115], v11 offset:14336
    v_mfma_f32_16x16x32_bf16 v[196:199], v[120:123], a[4:7], 0
    s_and_b32 s98, s98, 31
    ds_read_b128 v[116:119], v11 offset:21504
    v_mfma_f32_16x16x32_bf16 v[196:199], v[124:127], a[12:15], v[196:199]
    s_lshl_b32 s9, s6, 5
    ds_read_b128 v[120:123], v11 offset:15360
    v_mfma_f32_16x16x32_bf16 v[200:203], v[128:131], a[0:3], 0
    s_add_u32 s98, s98, s9
    buffer_load_dwordx4 a[76:79], v5, s[40:43], s63 offen offset:1024 sc1
    v_mfma_f32_16x16x32_bf16 v[200:203], v[132:135], a[8:11], v[200:203]
    s_mul_i32 s98, s98, 3
    ds_read_b128 v[124:127], v11 offset:22528
    v_mfma_f32_16x16x32_bf16 v[204:207], v[128:131], a[4:7], 0
    s_sub_u32 s98, s98, 2
    ds_read_b128 v[128:131], v11 offset:16384
    v_mfma_f32_16x16x32_bf16 v[204:207], v[132:135], a[12:15], v[204:207]
    s_add_u32 s98, s98, 3
    ds_read_b128 v[132:135], v11 offset:23552
    s_waitcnt lgkmcnt(4)
    v_mfma_f32_16x16x32_bf16 v[208:211], v[136:139], a[0:3], 0
    s_lshl2_add_u32 s98, s98, s4
    buffer_load_dwordx4 a[80:83], v4, s[40:43], s63 offen offset:2048 sc1
    v_mfma_f32_16x16x32_bf16 v[208:211], v[140:143], a[8:11], v[208:211]
    s_mul_i32 s9, s98, 3072
    v_mfma_f32_16x16x32_bf16 v[212:215], v[136:139], a[4:7], 0
    s_lshl3_add_u32 s98, 3, s5
    ds_read_b128 v[136:139], v11 offset:17408
    v_mfma_f32_16x16x32_bf16 v[212:215], v[140:143], a[12:15], v[212:215]
    s_and_b32 s98, s98, 31
    ds_read_b128 v[140:143], v11 offset:24576
    v_mfma_f32_16x16x32_bf16 v[216:219], v[144:147], a[0:3], 0
    s_lshl_b32 s10, s6, 5
    buffer_load_dwordx4 a[84:87], v5, s[40:43], s63 offen offset:2048 sc1
    v_mfma_f32_16x16x32_bf16 v[216:219], v[148:151], a[8:11], v[216:219]
    s_add_u32 s98, s98, s10
    v_mfma_f32_16x16x32_bf16 v[220:223], v[144:147], a[4:7], 0
    s_mul_i32 s98, s98, 3
    ds_read_b128 v[144:147], v11 offset:18432
    v_mfma_f32_16x16x32_bf16 v[220:223], v[148:151], a[12:15], v[220:223]
    s_sub_u32 s98, s98, 3
    ds_read_b128 v[148:151], v11 offset:25600
    v_mfma_f32_16x16x32_bf16 v[224:227], v[104:107], a[0:3], 0
    s_add_u32 s98, s98, 3
    buffer_load_dwordx4 a[88:91], v4, s[40:43], s63 offen offset:3072 sc1
    v_mfma_f32_16x16x32_bf16 v[224:227], v[108:111], a[8:11], v[224:227]
    s_lshl2_add_u32 s98, s98, s4
    v_mfma_f32_16x16x32_bf16 v[228:231], v[104:107], a[4:7], 0
    s_mul_i32 s10, s98, 3072
    ds_read_b128 v[104:107], v11 offset:19456
    v_mfma_f32_16x16x32_bf16 v[228:231], v[108:111], a[12:15], v[228:231]
    s_sub_u32 s99, s4, s61
    ds_read_b128 v[108:111], v11 offset:26624
    v_mfma_f32_16x16x32_bf16 v[176:179], v[112:115], a[16:19], v[176:179]
    s_and_b32 s99, s99, 3
    buffer_load_dwordx4 a[92:95], v5, s[40:43], s63 offen offset:3072 sc1
    v_mfma_f32_16x16x32_bf16 v[176:179], v[116:119], a[24:27], v[176:179]
    s_lshl3_add_u32 s98, s99, s5
    v_mfma_f32_16x16x32_bf16 v[180:183], v[112:115], a[20:23], v[180:183]
    s_xor_b32 s63, s63, 4096
    ds_read_b128 v[112:115], v11 offset:20480
    v_mfma_f32_16x16x32_bf16 v[180:183], v[116:119], a[28:31], v[180:183]
    s_and_b32 s98, s98, 31
    ds_read_b128 v[116:119], v11 offset:27648
    s_waitcnt lgkmcnt(3)
    v_mfma_f32_16x16x32_bf16 v[184:187], v[120:123], a[16:19], v[184:187]
    s_lshl_b32 s11, s6, 5
    v_mfma_f32_16x16x32_bf16 v[184:187], v[124:127], a[24:27], v[184:187]
    s_add_u32 s98, s98, s11
    buffer_store_dwordx4 v[80:83], v15, s[40:43], s71 offen offset:0 sc1
    v_mfma_f32_16x16x32_bf16 v[188:191], v[120:123], a[20:23], v[188:191]
    s_mul_i32 s98, s98, 3
    ds_read_b128 v[120:123], v11 offset:28672
    v_mfma_f32_16x16x32_bf16 v[188:191], v[124:127], a[28:31], v[188:191]
    s_sub_u32 s98, s98, s99
    ds_read_b128 v[124:127], v11 offset:35840
    v_mfma_f32_16x16x32_bf16 v[192:195], v[128:131], a[16:19], v[192:195]
    s_add_u32 s98, s98, 3
    v_mfma_f32_16x16x32_bf16 v[192:195], v[132:135], a[24:27], v[192:195]
    s_lshl2_add_u32 s98, s98, s4
    buffer_store_dwordx4 v[84:87], v15, s[40:43], s71 offen offset:256 sc1
    v_mfma_f32_16x16x32_bf16 v[196:199], v[128:131], a[20:23], v[196:199]
    s_mul_i32 s11, s98, 3072
    ds_read_b128 v[128:131], v11 offset:29696
    v_mfma_f32_16x16x32_bf16 v[196:199], v[132:135], a[28:31], v[196:199]
    ds_read_b128 v[132:135], v11 offset:36864
    v_mfma_f32_16x16x32_bf16 v[200:203], v[136:139], a[16:19], v[200:203]
    s_cmp_eq_u32 s99, 0
    s_cselect_b32 s11, 1073741824, s11
    v_mfma_f32_16x16x32_bf16 v[200:203], v[140:143], a[24:27], v[200:203]
    buffer_store_dwordx4 v[88:91], v15, s[40:43], s71 offen offset:512 sc1
    v_mfma_f32_16x16x32_bf16 v[204:207], v[136:139], a[20:23], v[204:207]
    ds_read_b128 v[136:139], v11 offset:30720
    v_mfma_f32_16x16x32_bf16 v[204:207], v[140:143], a[28:31], v[204:207]
    s_waitcnt vmcnt(11)
    ds_read_b128 v[140:143], v11 offset:37888
    v_mfma_f32_16x16x32_bf16 v[208:211], v[144:147], a[16:19], v[208:211]
    v_mfma_f32_16x16x32_bf16 v[208:211], v[148:151], a[24:27], v[208:211]
    buffer_load_dwordx4 a[96:99], v4, s[40:43], s63 offen offset:0 sc1
    v_mfma_f32_16x16x32_bf16 v[212:215], v[144:147], a[20:23], v[212:215]
    ds_read_b128 v[144:147], v11 offset:31744
    v_mfma_f32_16x16x32_bf16 v[212:215], v[148:151], a[28:31], v[212:215]
    ds_read_b128 v[148:151], v11 offset:38912
    v_mfma_f32_16x16x32_bf16 v[216:219], v[104:107], a[16:19], v[216:219]
    s_waitcnt lgkmcnt(2)
    v_mfma_f32_16x16x32_bf16 v[216:219], v[108:111], a[24:27], v[216:219]
    buffer_load_dwordx4 a[100:103], v5, s[40:43], s63 offen offset:0 sc1
    v_mfma_f32_16x16x32_bf16 v[220:223], v[104:107], a[20:23], v[220:223]
    ds_read_b128 v[104:107], v11 offset:32768
    v_mfma_f32_16x16x32_bf16 v[220:223], v[108:111], a[28:31], v[220:223]
    ds_read_b128 v[108:111], v11 offset:39936
    v_mfma_f32_16x16x32_bf16 v[224:227], v[112:115], a[16:19], v[224:227]
    v_mfma_f32_16x16x32_bf16 v[224:227], v[116:119], a[24:27], v[224:227]
    buffer_load_dwordx4 a[104:107], v4, s[40:43], s63 offen offset:1024 sc1
    v_mfma_f32_16x16x32_bf16 v[228:231], v[112:115], a[20:23], v[228:231]
    ds_read_b128 v[112:115], v11 offset:33792
    v_mfma_f32_16x16x32_bf16 v[228:231], v[116:119], a[28:31], v[228:231]
    ds_read_b128 v[116:119], v11 offset:40960
    v_mfma_f32_16x16x32_bf16 v[176:179], v[120:123], a[32:35], v[176:179]
    v_mfma_f32_16x16x32_bf16 v[176:179], v[124:127], a[40:43], v[176:179]
    buffer_load_dwordx4 a[108:111], v5, s[40:43], s63 offen offset:1024 sc1
    v_mfma_f32_16x16x32_bf16 v[180:183], v[120:123], a[36:39], v[180:183]
    ds_read_b128 v[120:123], v11 offset:34816
    v_mfma_f32_16x16x32_bf16 v[180:183], v[124:127], a[44:47], v[180:183]
    ds_read_b128 v[124:127], v11 offset:41984
    v_mfma_f32_16x16x32_bf16 v[184:187], v[128:131], a[32:35], v[184:187]
    v_mfma_f32_16x16x32_bf16 v[184:187], v[132:135], a[40:43], v[184:187]
    buffer_load_dwordx4 a[112:115], v4, s[40:43], s63 offen offset:2048 sc1
    v_mfma_f32_16x16x32_bf16 v[188:191], v[128:131], a[36:39], v[188:191]
    ds_read_b128 v[128:131], v11 offset:43008
    v_mfma_f32_16x16x32_bf16 v[188:191], v[132:135], a[44:47], v[188:191]
    ds_read_b128 v[132:135], v11 offset:50176
    v_mfma_f32_16x16x32_bf16 v[192:195], v[136:139], a[32:35], v[192:195]
    v_mfma_f32_16x16x32_bf16 v[192:195], v[140:143], a[40:43], v[192:195]
    v_mfma_f32_16x16x32_bf16 v[196:199], v[136:139], a[36:39], v[196:199]
    buffer_load_dwordx4 a[116:119], v5, s[40:43], s63 offen offset:2048 sc1
    v_mfma_f32_16x16x32_bf16 v[196:199], v[140:143], a[44:47], v[196:199]
    s_waitcnt lgkmcnt(1)
    ds_read_b128 v[136:139], v11 offset:44032
    ds_read_b128 v[140:143], v11 offset:51200
    v_mfma_f32_16x16x32_bf16 v[200:203], v[144:147], a[32:35], v[200:203]
    v_mfma_f32_16x16x32_bf16 v[200:203], v[148:151], a[40:43], v[200:203]
    v_mfma_f32_16x16x32_bf16 v[204:207], v[144:147], a[36:39], v[204:207]
    buffer_load_dwordx4 a[120:123], v4, s[40:43], s63 offen offset:3072 sc1
    v_mfma_f32_16x16x32_bf16 v[204:207], v[148:151], a[44:47], v[204:207]
    ds_read_b128 v[144:147], v11 offset:45056
    ds_read_b128 v[148:151], v11 offset:52224
    v_mfma_f32_16x16x32_bf16 v[208:211], v[104:107], a[32:35], v[208:211]
    v_mfma_f32_16x16x32_bf16 v[208:211], v[108:111], a[40:43], v[208:211]
    v_mfma_f32_16x16x32_bf16 v[212:215], v[104:107], a[36:39], v[212:215]
    buffer_load_dwordx4 a[124:127], v5, s[40:43], s63 offen offset:3072 sc1
    v_mfma_f32_16x16x32_bf16 v[212:215], v[108:111], a[44:47], v[212:215]
    s_xor_b32 s21, s3, 4
    ds_read_b128 v[104:107], v11 offset:46080
    ds_read_b128 v[108:111], v11 offset:53248
    v_mfma_f32_16x16x32_bf16 v[216:219], v[112:115], a[32:35], v[216:219]
    s_lshl2_add_u32 s21, s21, s4
    v_mfma_f32_16x16x32_bf16 v[216:219], v[116:119], a[40:43], v[216:219]
    s_mul_i32 s21, s21, 36864
    v_mfma_f32_16x16x32_bf16 v[220:223], v[112:115], a[36:39], v[220:223]
    s_add_u32 s64, s21, s17
    s_add_u32 m0, s78, 114688
    ds_read_b128 v[112:115], v11 offset:47104
    v_mfma_f32_16x16x32_bf16 v[220:223], v[116:119], a[44:47], v[220:223]
    s_xor_b32 s63, s63, 28672
    buffer_load_dwordx4 v1, s[56:59], s64 offen sc1 lds
    v_mfma_f32_16x16x32_bf16 v[224:227], v[120:123], a[32:35], v[224:227]
    ds_read_b128 v[116:119], v11 offset:54272
    v_mfma_f32_16x16x32_bf16 v[224:227], v[124:127], a[40:43], v[224:227]
    v_mfma_f32_16x16x32_bf16 v[228:231], v[120:123], a[36:39], v[228:231]
    buffer_load_dwordx4 v1, s[56:59], s64 offen offset:1024 sc1 lds
    v_mfma_f32_16x16x32_bf16 v[228:231], v[124:127], a[44:47], v[228:231]
    s_add_u32 s64, s21, s18
    ds_read_b128 v[120:123], v11 offset:48128
    ds_read_b128 v[124:127], v11 offset:55296
    v_mfma_f32_16x16x32_bf16 v[176:179], v[128:131], a[48:51], v[176:179]
    s_add_u32 m0, s78, 116736
    s_waitcnt lgkmcnt(3)
    v_mfma_f32_16x16x32_bf16 v[176:179], v[132:135], a[56:59], v[176:179]
    v_mfma_f32_16x16x32_bf16 v[180:183], v[128:131], a[52:55], v[180:183]
    buffer_load_dwordx4 v1, s[56:59], s64 offen sc1 lds
    v_mfma_f32_16x16x32_bf16 v[180:183], v[132:135], a[60:63], v[180:183]
    ds_read_b128 v[128:131], v11 offset:49152
    ds_read_b128 v[132:135], v11 offset:56320
    v_mfma_f32_16x16x32_bf16 v[184:187], v[136:139], a[48:51], v[184:187]
    v_mfma_f32_16x16x32_bf16 v[184:187], v[140:143], a[56:59], v[184:187]
    v_mfma_f32_16x16x32_bf16 v[188:191], v[136:139], a[52:55], v[188:191]
    buffer_load_dwordx4 v1, s[56:59], s64 offen offset:1024 sc1 lds
    v_mfma_f32_16x16x32_bf16 v[188:191], v[140:143], a[60:63], v[188:191]
    s_add_u32 s64, s21, s19
    ds_read_b128 v[136:139], v11 offset:57344
    ds_read_b128 v[140:143], v11 offset:64512
    v_mfma_f32_16x16x32_bf16 v[192:195], v[144:147], a[48:51], v[192:195]
    s_add_u32 m0, s78, 118784
    v_mfma_f32_16x16x32_bf16 v[192:195], v[148:151], a[56:59], v[192:195]
    v_mfma_f32_16x16x32_bf16 v[196:199], v[144:147], a[52:55], v[196:199]
    buffer_load_dwordx4 v1, s[56:59], s64 offen sc1 lds
    v_mfma_f32_16x16x32_bf16 v[196:199], v[148:151], a[60:63], v[196:199]
    ds_read_b128 v[144:147], v11 offset:58368
    ds_read_b128 v[148:151], v12 offset:0
    v_mfma_f32_16x16x32_bf16 v[200:203], v[104:107], a[48:51], v[200:203]
    v_mfma_f32_16x16x32_bf16 v[200:203], v[108:111], a[56:59], v[200:203]
    v_mfma_f32_16x16x32_bf16 v[204:207], v[104:107], a[52:55], v[204:207]
    ds_read_b128 v[104:107], v11 offset:59392
    v_mfma_f32_16x16x32_bf16 v[204:207], v[108:111], a[60:63], v[204:207]
    s_waitcnt vmcnt(16)
    s_barrier
    ds_read_b128 v[108:111], v12 offset:1024
    v_mfma_f32_16x16x32_bf16 v[208:211], v[112:115], a[48:51], v[208:211]
    s_waitcnt lgkmcnt(2)
    buffer_load_dwordx4 v1, s[56:59], s64 offen offset:1024 sc1 lds
    v_mfma_f32_16x16x32_bf16 v[208:211], v[116:119], a[56:59], v[208:211]
    s_add_u32 s64, s21, s20
    v_mfma_f32_16x16x32_bf16 v[212:215], v[112:115], a[52:55], v[212:215]
    s_add_u32 m0, s78, 120832
    ds_read_b128 v[112:115], v11 offset:60416
    v_mfma_f32_16x16x32_bf16 v[212:215], v[116:119], a[60:63], v[212:215]
    buffer_load_dwordx4 v1, s[56:59], s64 offen sc1 lds
    v_mfma_f32_16x16x32_bf16 v[216:219], v[120:123], a[48:51], v[216:219]
    ds_read_b128 v[116:119], v12 offset:2048
    v_mfma_f32_16x16x32_bf16 v[216:219], v[124:127], a[56:59], v[216:219]
    v_mfma_f32_16x16x32_bf16 v[220:223], v[120:123], a[52:55], v[220:223]
    ds_read_b128 v[120:123], v11 offset:61440
    v_mfma_f32_16x16x32_bf16 v[220:223], v[124:127], a[60:63], v[220:223]
    buffer_load_dwordx4 a[128:131], v4, s[40:43], s63 offen offset:0 sc1
    v_mfma_f32_16x16x32_bf16 v[224:227], v[128:131], a[48:51], v[224:227]
    ds_read_b128 v[124:127], v12 offset:3072
    v_mfma_f32_16x16x32_bf16 v[224:227], v[132:135], a[56:59], v[224:227]
    v_mfma_f32_16x16x32_bf16 v[228:231], v[128:131], a[52:55], v[228:231]
    ds_read_b128 v[128:131], v11 offset:62464
    v_mfma_f32_16x16x32_bf16 v[228:231], v[132:135], a[60:63], v[228:231]
    buffer_load_dwordx4 a[132:135], v5, s[40:43], s63 offen offset:0 sc1
    v_mfma_f32_16x16x32_bf16 v[176:179], v[136:139], a[64:67], v[176:179]
    ds_read_b128 v[132:135], v12 offset:4096
    v_mfma_f32_16x16x32_bf16 v[176:179], v[140:143], a[72:75], v[176:179]
    v_mfma_f32_16x16x32_bf16 v[180:183], v[136:139], a[68:71], v[180:183]
    ds_read_b128 v[136:139], v11 offset:63488
    v_mfma_f32_16x16x32_bf16 v[180:183], v[140:143], a[76:79], v[180:183]
    buffer_load_dwordx4 a[136:139], v4, s[40:43], s63 offen offset:1024 sc1
    v_mfma_f32_16x16x32_bf16 v[184:187], v[144:147], a[64:67], v[184:187]
    ds_read_b128 v[140:143], v12 offset:5120
    v_mfma_f32_16x16x32_bf16 v[184:187], v[148:151], a[72:75], v[184:187]
    v_mfma_f32_16x16x32_bf16 v[188:191], v[144:147], a[68:71], v[188:191]
    ds_read_b128 v[144:147], v12 offset:6144
    v_mfma_f32_16x16x32_bf16 v[188:191], v[148:151], a[76:79], v[188:191]
    s_waitcnt lgkmcnt(2)
    buffer_load_dwordx4 a[140:143], v5, s[40:43], s63 offen offset:1024 sc1
    v_mfma_f32_16x16x32_bf16 v[192:195], v[104:107], a[64:67], v[192:195]
    ds_read_b128 v[148:151], v12 offset:13312
    v_mfma_f32_16x16x32_bf16 v[192:195], v[108:111], a[72:75], v[192:195]
    v_mfma_f32_16x16x32_bf16 v[196:199], v[104:107], a[68:71], v[196:199]
    ds_read_b128 v[104:107], v12 offset:7168
    v_mfma_f32_16x16x32_bf16 v[196:199], v[108:111], a[76:79], v[196:199]
    buffer_load_dwordx4 a[144:147], v4, s[40:43], s63 offen offset:2048 sc1
    v_mfma_f32_16x16x32_bf16 v[200:203], v[112:115], a[64:67], v[200:203]
    ds_read_b128 v[108:111], v12 offset:14336
    v_mfma_f32_16x16x32_bf16 v[200:203], v[116:119], a[72:75], v[200:203]
    v_mfma_f32_16x16x32_bf16 v[204:207], v[112:115], a[68:71], v[204:207]
    ds_read_b128 v[112:115], v12 offset:8192
    v_mfma_f32_16x16x32_bf16 v[204:207], v[116:119], a[76:79], v[204:207]
    buffer_load_dwordx4 a[148:151], v5, s[40:43], s63 offen offset:2048 sc1
    v_mfma_f32_16x16x32_bf16 v[208:211], v[120:123], a[64:67], v[208:211]
    ds_read_b128 v[116:119], v12 offset:15360
    v_mfma_f32_16x16x32_bf16 v[208:211], v[124:127], a[72:75], v[208:211]
    v_mfma_f32_16x16x32_bf16 v[212:215], v[120:123], a[68:71], v[212:215]
    ds_read_b128 v[120:123], v12 offset:9216
    v_mfma_f32_16x16x32_bf16 v[212:215], v[124:127], a[76:79], v[212:215]
    ds_read_b128 v[124:127], v12 offset:16384
    v_mfma_f32_16x16x32_bf16 v[216:219], v[128:131], a[64:67], v[216:219]
    buffer_load_dwordx4 a[152:155], v4, s[40:43], s63 offen offset:3072 sc1
    v_mfma_f32_16x16x32_bf16 v[216:219], v[132:135], a[72:75], v[216:219]
    v_mfma_f32_16x16x32_bf16 v[220:223], v[128:131], a[68:71], v[220:223]
    ds_read_b128 v[128:131], v12 offset:10240
    v_mfma_f32_16x16x32_bf16 v[220:223], v[132:135], a[76:79], v[220:223]
    ds_read_b128 v[132:135], v12 offset:17408
    v_mfma_f32_16x16x32_bf16 v[224:227], v[136:139], a[64:67], v[224:227]
    s_waitcnt lgkmcnt(2)
    buffer_load_dwordx4 a[156:159], v5, s[40:43], s63 offen offset:3072 sc1
    v_mfma_f32_16x16x32_bf16 v[224:227], v[140:143], a[72:75], v[224:227]
    s_xor_b32 s21, s3, 5
    v_mfma_f32_16x16x32_bf16 v[228:231], v[136:139], a[68:71], v[228:231]
    s_lshl2_add_u32 s21, s21, s4
    ds_read_b128 v[136:139], v12 offset:11264
    v_mfma_f32_16x16x32_bf16 v[228:231], v[140:143], a[76:79], v[228:231]
    s_mul_i32 s21, s21, 36864
    ds_read_b128 v[140:143], v12 offset:18432
    v_mfma_f32_16x16x32_bf16 v[176:179], v[144:147], a[80:83], v[176:179]
    s_add_u32 s64, s21, s17
    s_add_u32 m0, s78, 0
    v_mfma_f32_16x16x32_bf16 v[176:179], v[148:151], a[88:91], v[176:179]
    s_xor_b32 s63, s63, 4096
    buffer_load_dwordx4 v1, s[56:59], s64 offen sc1 lds
    v_mfma_f32_16x16x32_bf16 v[180:183], v[144:147], a[84:87], v[180:183]
    ds_read_b128 v[144:147], v12 offset:12288
    v_mfma_f32_16x16x32_bf16 v[180:183], v[148:151], a[92:95], v[180:183]
    ds_read_b128 v[148:151], v12 offset:19456
    v_mfma_f32_16x16x32_bf16 v[184:187], v[104:107], a[80:83], v[184:187]
    buffer_load_dwordx4 v1, s[56:59], s64 offen offset:1024 sc1 lds
    v_mfma_f32_16x16x32_bf16 v[184:187], v[108:111], a[88:91], v[184:187]
    s_add_u32 s64, s21, s18
    v_mfma_f32_16x16x32_bf16 v[188:191], v[104:107], a[84:87], v[188:191]
    s_add_u32 m0, s78, 2048
    ds_read_b128 v[104:107], v12 offset:20480
    v_mfma_f32_16x16x32_bf16 v[188:191], v[108:111], a[92:95], v[188:191]
    ds_read_b128 v[108:111], v12 offset:27648
    v_mfma_f32_16x16x32_bf16 v[192:195], v[112:115], a[80:83], v[192:195]
    buffer_load_dwordx4 v1, s[56:59], s64 offen sc1 lds
    v_mfma_f32_16x16x32_bf16 v[192:195], v[116:119], a[88:91], v[192:195]
    v_mfma_f32_16x16x32_bf16 v[196:199], v[112:115], a[84:87], v[196:199]
    ds_read_b128 v[112:115], v12 offset:21504
    v_mfma_f32_16x16x32_bf16 v[196:199], v[116:119], a[92:95], v[196:199]
    ds_read_b128 v[116:119], v12 offset:28672
    v_mfma_f32_16x16x32_bf16 v[200:203], v[120:123], a[80:83], v[200:203]
    buffer_load_dwordx4 v1, s[56:59], s64 offen offset:1024 sc1 lds
    v_mfma_f32_16x16x32_bf16 v[200:203], v[124:127], a[88:91], v[200:203]
    s_add_u32 s64, s21, s19
    v_mfma_f32_16x16x32_bf16 v[204:207], v[120:123], a[84:87], v[204:207]
    s_add_u32 m0, s78, 4096
    ds_read_b128 v[120:123], v12 offset:22528
    v_mfma_f32_16x16x32_bf16 v[204:207], v[124:127], a[92:95], v[204:207]
    s_waitcnt vmcnt(19)
    s_barrier
    v_mov_b32 v31, 3
    s_waitcnt lgkmcnt(2)
    v_mfma_f32_16x16x32_bf16 v[208:211], v[128:131], a[80:83], v[208:211]
    buffer_load_dwordx4 v1, s[56:59], s64 offen sc1 lds
    v_mfma_f32_16x16x32_bf16 v[208:211], v[132:135], a[88:91], v[208:211]
    buffer_store_dword v31, v30, s[32:35], s101 offen sc1
    v_mfma_f32_16x16x32_bf16 v[212:215], v[128:131], a[84:87], v[212:215]
    ds_read_b128 v[124:127], v12 offset:29696
    ds_read_b128 v[128:131], v12 offset:23552
    v_mfma_f32_16x16x32_bf16 v[212:215], v[132:135], a[92:95], v[212:215]
    ds_read_b128 v[132:135], v12 offset:30720
    v_mfma_f32_16x16x32_bf16 v[216:219], v[136:139], a[80:83], v[216:219]
    v_mfma_f32_16x16x32_bf16 v[216:219], v[140:143], a[88:91], v[216:219]
    buffer_load_dwordx4 v1, s[56:59], s64 offen offset:1024 sc1 lds
    v_mfma_f32_16x16x32_bf16 v[220:223], v[136:139], a[84:87], v[220:223]
    s_add_u32 s64, s21, s20
    ds_read_b128 v[136:139], v12 offset:24576
    v_mfma_f32_16x16x32_bf16 v[220:223], v[140:143], a[92:95], v[220:223]
    s_add_u32 m0, s78, 6144
    ds_read_b128 v[140:143], v12 offset:31744
    v_mfma_f32_16x16x32_bf16 v[224:227], v[144:147], a[80:83], v[224:227]
    v_mfma_f32_16x16x32_bf16 v[224:227], v[148:151], a[88:91], v[224:227]
    buffer_load_dwordx4 v1, s[56:59], s64 offen sc1 lds
    v_mfma_f32_16x16x32_bf16 v[228:231], v[144:147], a[84:87], v[228:231]
    ds_read_b128 v[144:147], v12 offset:25600
    v_mfma_f32_16x16x32_bf16 v[228:231], v[148:151], a[92:95], v[228:231]
    ds_read_b128 v[148:151], v12 offset:32768
    v_mfma_f32_16x16x32_bf16 v[176:179], v[104:107], a[96:99], v[176:179]
    v_mfma_f32_16x16x32_bf16 v[176:179], v[108:111], a[104:107], v[176:179]
    buffer_load_dwordx4 a[160:163], v4, s[40:43], s63 offen offset:0 sc1
    v_mfma_f32_16x16x32_bf16 v[180:183], v[104:107], a[100:103], v[180:183]
    ds_read_b128 v[104:107], v12 offset:26624
    v_mfma_f32_16x16x32_bf16 v[180:183], v[108:111], a[108:111], v[180:183]
    ds_read_b128 v[108:111], v12 offset:33792
    v_mfma_f32_16x16x32_bf16 v[184:187], v[112:115], a[96:99], v[184:187]
    s_waitcnt lgkmcnt(2)
    v_mfma_f32_16x16x32_bf16 v[184:187], v[116:119], a[104:107], v[184:187]
    buffer_load_dwordx4 a[164:167], v5, s[40:43], s63 offen offset:0 sc1
    v_mfma_f32_16x16x32_bf16 v[188:191], v[112:115], a[100:103], v[188:191]
    ds_read_b128 v[112:115], v12 offset:34816
    v_mfma_f32_16x16x32_bf16 v[188:191], v[116:119], a[108:111], v[188:191]
    ds_read_b128 v[116:119], v12 offset:41984
    v_mfma_f32_16x16x32_bf16 v[192:195], v[120:123], a[96:99], v[192:195]
    v_mfma_f32_16x16x32_bf16 v[192:195], v[124:127], a[104:107], v[192:195]
    buffer_load_dwordx4 a[168:171], v4, s[40:43], s63 offen offset:1024 sc1
    v_mfma_f32_16x16x32_bf16 v[196:199], v[120:123], a[100:103], v[196:199]
    ds_read_b128 v[120:123], v12 offset:35840
    v_mfma_f32_16x16x32_bf16 v[196:199], v[124:127], a[108:111], v[196:199]
    ds_read_b128 v[124:127], v12 offset:43008
    v_mfma_f32_16x16x32_bf16 v[200:203], v[128:131], a[96:99], v[200:203]
    v_mfma_f32_16x16x32_bf16 v[200:203], v[132:135], a[104:107], v[200:203]
    buffer_load_dwordx4 a[172:175], v5, s[40:43], s63 offen offset:1024 sc1
    v_mfma_f32_16x16x32_bf16 v[204:207], v[128:131], a[100:103], v[204:207]
    ds_read_b128 v[128:131], v12 offset:36864
    v_mfma_f32_16x16x32_bf16 v[204:207], v[132:135], a[108:111], v[204:207]
    ds_read_b128 v[132:135], v12 offset:44032
    v_mfma_f32_16x16x32_bf16 v[208:211], v[136:139], a[96:99], v[208:211]
    v_mfma_f32_16x16x32_bf16 v[208:211], v[140:143], a[104:107], v[208:211]
    buffer_load_dwordx4 a[176:179], v4, s[40:43], s63 offen offset:2048 sc1
    v_mfma_f32_16x16x32_bf16 v[212:215], v[136:139], a[100:103], v[212:215]
    ds_read_b128 v[136:139], v12 offset:37888
    v_mfma_f32_16x16x32_bf16 v[212:215], v[140:143], a[108:111], v[212:215]
    ds_read_b128 v[140:143], v12 offset:45056
    v_mfma_f32_16x16x32_bf16 v[216:219], v[144:147], a[96:99], v[216:219]
    v_mfma_f32_16x16x32_bf16 v[216:219], v[148:151], a[104:107], v[216:219]
    buffer_load_dwordx4 a[180:183], v5, s[40:43], s63 offen offset:2048 sc1
    v_mfma_f32_16x16x32_bf16 v[220:223], v[144:147], a[100:103], v[220:223]
    ds_read_b128 v[144:147], v12 offset:38912
    v_mfma_f32_16x16x32_bf16 v[220:223], v[148:151], a[108:111], v[220:223]
    s_waitcnt lgkmcnt(2)
    ds_read_b128 v[148:151], v12 offset:46080
    v_mfma_f32_16x16x32_bf16 v[224:227], v[104:107], a[96:99], v[224:227]
    v_mfma_f32_16x16x32_bf16 v[224:227], v[108:111], a[104:107], v[224:227]
    buffer_load_dwordx4 a[184:187], v4, s[40:43], s63 offen offset:3072 sc1
    v_mfma_f32_16x16x32_bf16 v[228:231], v[104:107], a[100:103], v[228:231]
    ds_read_b128 v[104:107], v12 offset:39936
    v_mfma_f32_16x16x32_bf16 v[228:231], v[108:111], a[108:111], v[228:231]
    ds_read_b128 v[108:111], v12 offset:47104
    v_mfma_f32_16x16x32_bf16 v[176:179], v[112:115], a[112:115], v[176:179]
    v_mfma_f32_16x16x32_bf16 v[176:179], v[116:119], a[120:123], v[176:179]
    v_mfma_f32_16x16x32_bf16 v[180:183], v[112:115], a[116:119], v[180:183]
    buffer_load_dwordx4 a[188:191], v5, s[40:43], s63 offen offset:3072 sc1
    v_mfma_f32_16x16x32_bf16 v[180:183], v[116:119], a[124:127], v[180:183]
    s_xor_b32 s21, s3, 6
    ds_read_b128 v[112:115], v12 offset:40960
    ds_read_b128 v[116:119], v12 offset:48128
    v_mfma_f32_16x16x32_bf16 v[184:187], v[120:123], a[112:115], v[184:187]
    s_lshl2_add_u32 s21, s21, s4
    v_mfma_f32_16x16x32_bf16 v[184:187], v[124:127], a[120:123], v[184:187]
    s_mul_i32 s21, s21, 36864
    v_mfma_f32_16x16x32_bf16 v[188:191], v[120:123], a[116:119], v[188:191]
    s_add_u32 s64, s21, s17
    s_add_u32 m0, s78, 28672
    v_mfma_f32_16x16x32_bf16 v[188:191], v[124:127], a[124:127], v[188:191]
    s_xor_b32 s63, s63, 12288
    buffer_load_dwordx4 v1, s[56:59], s64 offen sc1 lds
    v_mfma_f32_16x16x32_bf16 v[192:195], v[128:131], a[112:115], v[192:195]
    v_mfma_f32_16x16x32_bf16 v[192:195], v[132:135], a[120:123], v[192:195]
    v_mfma_f32_16x16x32_bf16 v[196:199], v[128:131], a[116:119], v[196:199]
    buffer_load_dwordx4 v1, s[56:59], s64 offen offset:1024 sc1 lds
    v_mfma_f32_16x16x32_bf16 v[196:199], v[132:135], a[124:127], v[196:199]
    s_add_u32 s64, s21, s18
    v_mfma_f32_16x16x32_bf16 v[200:203], v[136:139], a[112:115], v[200:203]
    s_add_u32 m0, s78, 30720
    s_waitcnt lgkmcnt(0)
    v_mfma_f32_16x16x32_bf16 v[200:203], v[140:143], a[120:123], v[200:203]
    v_mfma_f32_16x16x32_bf16 v[204:207], v[136:139], a[116:119], v[204:207]
    buffer_load_dwordx4 v1, s[56:59], s64 offen sc1 lds
    v_mfma_f32_16x16x32_bf16 v[204:207], v[140:143], a[124:127], v[204:207]
    s_waitcnt vmcnt(19)
    s_barrier
    ds_read_b128 v[120:123], v12 offset:49152
    v_mfma_f32_16x16x32_bf16 v[208:211], v[144:147], a[112:115], v[208:211]
    ds_read_b128 v[124:127], v12 offset:56320
    ds_read_b128 v[128:131], v12 offset:50176
    v_mfma_f32_16x16x32_bf16 v[208:211], v[148:151], a[120:123], v[208:211]
    ds_read_b128 v[132:135], v12 offset:57344
    v_mfma_f32_16x16x32_bf16 v[212:215], v[144:147], a[116:119], v[212:215]
    buffer_load_dwordx4 v1, s[56:59], s64 offen offset:1024 sc1 lds
    v_mfma_f32_16x16x32_bf16 v[212:215], v[148:151], a[124:127], v[212:215]
    s_add_u32 s64, s21, s19
    ds_read_b128 v[136:139], v12 offset:51200
    ds_read_b128 v[140:143], v12 offset:58368
    v_mfma_f32_16x16x32_bf16 v[216:219], v[104:107], a[112:115], v[216:219]
    s_add_u32 m0, s78, 32768
    ds_read_b128 v[144:147], v12 offset:52224
    v_mfma_f32_16x16x32_bf16 v[216:219], v[108:111], a[120:123], v[216:219]
    ds_read_b128 v[148:151], v12 offset:59392
    v_mfma_f32_16x16x32_bf16 v[220:223], v[104:107], a[116:119], v[220:223]
    buffer_load_dwordx4 v1, s[56:59], s64 offen sc1 lds
    v_mfma_f32_16x16x32_bf16 v[220:223], v[108:111], a[124:127], v[220:223]
    ds_read_b128 v[104:107], v12 offset:53248
    ds_read_b128 v[108:111], v12 offset:60416
    v_mfma_f32_16x16x32_bf16 v[224:227], v[112:115], a[112:115], v[224:227]
    v_mfma_f32_16x16x32_bf16 v[224:227], v[116:119], a[120:123], v[224:227]
    v_mfma_f32_16x16x32_bf16 v[228:231], v[112:115], a[116:119], v[228:231]
    buffer_load_dwordx4 v1, s[56:59], s64 offen offset:1024 sc1 lds
    v_mfma_f32_16x16x32_bf16 v[228:231], v[116:119], a[124:127], v[228:231]
    s_add_u32 s64, s21, s20
    ds_read_b128 v[112:115], v12 offset:54272
    ds_read_b128 v[116:119], v12 offset:61440
    s_waitcnt lgkmcnt(4)
    v_mfma_f32_16x16x32_bf16 v[176:179], v[120:123], a[128:131], v[176:179]
    s_add_u32 m0, s78, 34816
    v_mfma_f32_16x16x32_bf16 v[176:179], v[124:127], a[136:139], v[176:179]
    v_mfma_f32_16x16x32_bf16 v[180:183], v[120:123], a[132:135], v[180:183]
    buffer_load_dwordx4 v1, s[56:59], s64 offen sc1 lds
    v_mfma_f32_16x16x32_bf16 v[180:183], v[124:127], a[140:143], v[180:183]
    ds_read_b128 v[120:123], v12 offset:55296
    ds_read_b128 v[124:127], v12 offset:62464
    v_mfma_f32_16x16x32_bf16 v[184:187], v[128:131], a[128:131], v[184:187]
    v_mfma_f32_16x16x32_bf16 v[184:187], v[132:135], a[136:139], v[184:187]
    v_mfma_f32_16x16x32_bf16 v[188:191], v[128:131], a[132:135], v[188:191]
    ds_read_b128 v[128:131], v12 offset:63488
    v_mfma_f32_16x16x32_bf16 v[188:191], v[132:135], a[140:143], v[188:191]
    buffer_load_dwordx4 a[192:195], v4, s[40:43], s63 offen offset:0 sc1
    v_mfma_f32_16x16x32_bf16 v[192:195], v[136:139], a[128:131], v[192:195]
    ds_read_b128 v[132:135], v13 offset:5120
    v_mfma_f32_16x16x32_bf16 v[192:195], v[140:143], a[136:139], v[192:195]
    v_mfma_f32_16x16x32_bf16 v[196:199], v[136:139], a[132:135], v[196:199]
    ds_read_b128 v[136:139], v12 offset:64512
    v_mfma_f32_16x16x32_bf16 v[196:199], v[140:143], a[140:143], v[196:199]
    buffer_load_dwordx4 a[196:199], v5, s[40:43], s63 offen offset:0 sc1
    v_mfma_f32_16x16x32_bf16 v[200:203], v[144:147], a[128:131], v[200:203]
    ds_read_b128 v[140:143], v13 offset:6144
    v_mfma_f32_16x16x32_bf16 v[200:203], v[148:151], a[136:139], v[200:203]
    v_mfma_f32_16x16x32_bf16 v[204:207], v[144:147], a[132:135], v[204:207]
    ds_read_b128 v[144:147], v13 offset:0
    v_mfma_f32_16x16x32_bf16 v[204:207], v[148:151], a[140:143], v[204:207]
    s_waitcnt lgkmcnt(2)
    buffer_load_dwordx4 a[200:203], v4, s[40:43], s63 offen offset:1024 sc1
    v_mfma_f32_16x16x32_bf16 v[208:211], v[104:107], a[128:131], v[208:211]
    ds_read_b128 v[148:151], v13 offset:7168
    v_mfma_f32_16x16x32_bf16 v[208:211], v[108:111], a[136:139], v[208:211]
    v_mfma_f32_16x16x32_bf16 v[212:215], v[104:107], a[132:135], v[212:215]
    ds_read_b128 v[104:107], v13 offset:1024
    v_mfma_f32_16x16x32_bf16 v[212:215], v[108:111], a[140:143], v[212:215]
    buffer_load_dwordx4 a[204:207], v5, s[40:43], s63 offen offset:1024 sc1
    v_mfma_f32_16x16x32_bf16 v[216:219], v[112:115], a[128:131], v[216:219]
    ds_read_b128 v[108:111], v13 offset:8192
    v_mfma_f32_16x16x32_bf16 v[216:219], v[116:119], a[136:139], v[216:219]
    v_mfma_f32_16x16x32_bf16 v[220:223], v[112:115], a[132:135], v[220:223]
    ds_read_b128 v[112:115], v13 offset:2048
    v_mfma_f32_16x16x32_bf16 v[220:223], v[116:119], a[140:143], v[220:223]
    buffer_load_dwordx4 a[208:211], v4, s[40:43], s63 offen offset:2048 sc1
    v_mfma_f32_16x16x32_bf16 v[224:227], v[120:123], a[128:131], v[224:227]
    ds_read_b128 v[116:119], v13 offset:9216
    v_mfma_f32_16x16x32_bf16 v[224:227], v[124:127], a[136:139], v[224:227]
    v_mfma_f32_16x16x32_bf16 v[228:231], v[120:123], a[132:135], v[228:231]
    ds_read_b128 v[120:123], v13 offset:3072
    v_mfma_f32_16x16x32_bf16 v[228:231], v[124:127], a[140:143], v[228:231]
    buffer_load_dwordx4 a[212:215], v5, s[40:43], s63 offen offset:2048 sc1
    v_mfma_f32_16x16x32_bf16 v[176:179], v[128:131], a[144:147], v[176:179]
    ds_read_b128 v[124:127], v13 offset:10240
    v_mfma_f32_16x16x32_bf16 v[176:179], v[132:135], a[152:155], v[176:179]
    v_mfma_f32_16x16x32_bf16 v[180:183], v[128:131], a[148:151], v[180:183]
    ds_read_b128 v[128:131], v13 offset:4096
    v_mfma_f32_16x16x32_bf16 v[180:183], v[132:135], a[156:159], v[180:183]
    buffer_load_dwordx4 a[216:219], v4, s[40:43], s63 offen offset:3072 sc1
    v_mfma_f32_16x16x32_bf16 v[184:187], v[136:139], a[144:147], v[184:187]
    s_waitcnt lgkmcnt(2)
    ds_read_b128 v[132:135], v13 offset:11264
    v_mfma_f32_16x16x32_bf16 v[184:187], v[140:143], a[152:155], v[184:187]
    v_mfma_f32_16x16x32_bf16 v[188:191], v[136:139], a[148:151], v[188:191]
    v_mfma_f32_16x16x32_bf16 v[188:191], v[140:143], a[156:159], v[188:191]
    buffer_load_dwordx4 a[220:223], v5, s[40:43], s63 offen offset:3072 sc1
    v_mfma_f32_16x16x32_bf16 v[192:195], v[144:147], a[144:147], v[192:195]
    v_mfma_f32_16x16x32_bf16 v[192:195], v[148:151], a[152:155], v[192:195]
    s_xor_b32 s63, s63, 4096
    v_mfma_f32_16x16x32_bf16 v[196:199], v[144:147], a[148:151], v[196:199]
    v_mfma_f32_16x16x32_bf16 v[196:199], v[148:151], a[156:159], v[196:199]
    v_mfma_f32_16x16x32_bf16 v[200:203], v[104:107], a[144:147], v[200:203]
    buffer_load_dword v3, v19, s[32:35], s66 offen sc1
    v_mfma_f32_16x16x32_bf16 v[200:203], v[108:111], a[152:155], v[200:203]
    s_xor_b32 s21, s3, 7
    v_mfma_f32_16x16x32_bf16 v[204:207], v[104:107], a[148:151], v[204:207]
    s_lshl2_add_u32 s21, s21, s4
    v_mfma_f32_16x16x32_bf16 v[204:207], v[108:111], a[156:159], v[204:207]
    s_mul_i32 s21, s21, 36864
    s_waitcnt vmcnt(16)
    s_barrier
    v_mfma_f32_16x16x32_bf16 v[208:211], v[112:115], a[144:147], v[208:211]
    s_add_u32 s64, s21, s17
    s_add_u32 m0, s78, 57344
    ds_read_b128 v[136:139], v11 offset:0
    v_mfma_f32_16x16x32_bf16 v[208:211], v[116:119], a[152:155], v[208:211]
    buffer_load_dwordx4 v1, s[56:59], s64 offen sc1 lds
    v_mfma_f32_16x16x32_bf16 v[212:215], v[112:115], a[148:151], v[212:215]
    ds_read_b128 v[140:143], v11 offset:7168
    ds_read_b128 v[144:147], v11 offset:1024
    v_mfma_f32_16x16x32_bf16 v[212:215], v[116:119], a[156:159], v[212:215]
    ds_read_b128 v[148:151], v11 offset:8192
    v_mfma_f32_16x16x32_bf16 v[216:219], v[120:123], a[144:147], v[216:219]
    s_waitcnt lgkmcnt(4)
    buffer_load_dwordx4 v1, s[56:59], s64 offen offset:1024 sc1 lds
    v_mfma_f32_16x16x32_bf16 v[216:219], v[124:127], a[152:155], v[216:219]
    s_add_u32 s64, s21, s18
    ds_read_b128 v[104:107], v11 offset:2048
    ds_read_b128 v[108:111], v11 offset:9216
    v_mfma_f32_16x16x32_bf16 v[220:223], v[120:123], a[148:151], v[220:223]
    s_add_u32 m0, s78, 59392
    ds_read_b128 v[112:115], v11 offset:3072
    v_mfma_f32_16x16x32_bf16 v[220:223], v[124:127], a[156:159], v[220:223]
    ds_read_b128 v[116:119], v11 offset:10240
    v_mfma_f32_16x16x32_bf16 v[224:227], v[128:131], a[144:147], v[224:227]
    buffer_load_dwordx4 v1, s[56:59], s64 offen sc1 lds
    v_mfma_f32_16x16x32_bf16 v[224:227], v[132:135], a[152:155], v[224:227]
    ds_read_b128 v[120:123], v11 offset:4096
    ds_read_b128 v[124:127], v11 offset:11264
    v_mfma_f32_16x16x32_bf16 v[228:231], v[128:131], a[148:151], v[228:231]
    ds_read_b128 v[128:131], v11 offset:5120
    v_mfma_f32_16x16x32_bf16 v[228:231], v[132:135], a[156:159], v[228:231]
    s_waitcnt lgkmcnt(4)
    ds_read_b128 v[132:135], v11 offset:12288
    v_mfma_f32_16x16x32_bf16 v[176:179], v[136:139], a[160:163], v[176:179]
    buffer_load_dwordx4 v1, s[56:59], s64 offen offset:1024 sc1 lds
    v_mfma_f32_16x16x32_bf16 v[176:179], v[140:143], a[168:171], v[176:179]
    s_add_u32 s64, s21, s19
    v_mfma_f32_16x16x32_bf16 v[180:183], v[136:139], a[164:167], v[180:183]
    s_add_u32 m0, s78, 61440
    ds_read_b128 v[136:139], v11 offset:6144
    v_mfma_f32_16x16x32_bf16 v[180:183], v[140:143], a[172:175], v[180:183]
    ds_read_b128 v[140:143], v11 offset:13312
    v_mfma_f32_16x16x32_bf16 v[184:187], v[144:147], a[160:163], v[184:187]
    buffer_load_dwordx4 v1, s[56:59], s64 offen sc1 lds
    v_mfma_f32_16x16x32_bf16 v[184:187], v[148:151], a[168:171], v[184:187]
    v_mfma_f32_16x16x32_bf16 v[188:191], v[144:147], a[164:167], v[188:191]
    ds_read_b128 v[144:147], v11 offset:14336
    v_mfma_f32_16x16x32_bf16 v[188:191], v[148:151], a[172:175], v[188:191]
    ds_read_b128 v[148:151], v11 offset:21504
    v_mfma_f32_16x16x32_bf16 v[192:195], v[104:107], a[160:163], v[192:195]
    buffer_load_dwordx4 v1, s[56:59], s64 offen offset:1024 sc1 lds
    v_mfma_f32_16x16x32_bf16 v[192:195], v[108:111], a[168:171], v[192:195]
    s_add_u32 s64, s21, s20
    v_mfma_f32_16x16x32_bf16 v[196:199], v[104:107], a[164:167], v[196:199]
    s_add_u32 m0, s78, 63488
    ds_read_b128 v[104:107], v11 offset:15360
    v_mfma_f32_16x16x32_bf16 v[196:199], v[108:111], a[172:175], v[196:199]
    ds_read_b128 v[108:111], v11 offset:22528
    v_mfma_f32_16x16x32_bf16 v[200:203], v[112:115], a[160:163], v[200:203]
    s_waitcnt lgkmcnt(2)
    buffer_load_dwordx4 v1, s[56:59], s64 offen sc1 lds
    v_mfma_f32_16x16x32_bf16 v[200:203], v[116:119], a[168:171], v[200:203]
    v_mfma_f32_16x16x32_bf16 v[204:207], v[112:115], a[164:167], v[204:207]
    ds_read_b128 v[112:115], v11 offset:16384
    v_mfma_f32_16x16x32_bf16 v[204:207], v[116:119], a[172:175], v[204:207]
    ds_read_b128 v[116:119], v11 offset:23552
    v_mfma_f32_16x16x32_bf16 v[208:211], v[120:123], a[160:163], v[208:211]
    v_mfma_f32_16x16x32_bf16 v[208:211], v[124:127], a[168:171], v[208:211]
    buffer_load_dwordx4 a[224:227], v4, s[40:43], s63 offen offset:0 sc1
    v_mfma_f32_16x16x32_bf16 v[212:215], v[120:123], a[164:167], v[212:215]
    ds_read_b128 v[120:123], v11 offset:17408
    v_mfma_f32_16x16x32_bf16 v[212:215], v[124:127], a[172:175], v[212:215]
    ds_read_b128 v[124:127], v11 offset:24576
    v_mfma_f32_16x16x32_bf16 v[216:219], v[128:131], a[160:163], v[216:219]
    v_mfma_f32_16x16x32_bf16 v[216:219], v[132:135], a[168:171], v[216:219]
    buffer_load_dwordx4 a[228:231], v5, s[40:43], s63 offen offset:0 sc1
    v_mfma_f32_16x16x32_bf16 v[220:223], v[128:131], a[164:167], v[220:223]
    ds_read_b128 v[128:131], v11 offset:18432
    v_mfma_f32_16x16x32_bf16 v[220:223], v[132:135], a[172:175], v[220:223]
    ds_read_b128 v[132:135], v11 offset:25600
    v_mfma_f32_16x16x32_bf16 v[224:227], v[136:139], a[160:163], v[224:227]
    v_mfma_f32_16x16x32_bf16 v[224:227], v[140:143], a[168:171], v[224:227]
    buffer_load_dwordx4 a[232:235], v4, s[40:43], s63 offen offset:1024 sc1
    v_mfma_f32_16x16x32_bf16 v[228:231], v[136:139], a[164:167], v[228:231]
    ds_read_b128 v[136:139], v11 offset:19456
    v_mfma_f32_16x16x32_bf16 v[228:231], v[140:143], a[172:175], v[228:231]
    ds_read_b128 v[140:143], v11 offset:26624
    v_mfma_f32_16x16x32_bf16 v[176:179], v[144:147], a[176:179], v[176:179]
    v_mfma_f32_16x16x32_bf16 v[176:179], v[148:151], a[184:187], v[176:179]
    buffer_load_dwordx4 a[236:239], v5, s[40:43], s63 offen offset:1024 sc1
    v_mfma_f32_16x16x32_bf16 v[180:183], v[144:147], a[180:183], v[180:183]
    ds_read_b128 v[144:147], v11 offset:20480
    v_mfma_f32_16x16x32_bf16 v[180:183], v[148:151], a[188:191], v[180:183]
    s_waitcnt lgkmcnt(2)
    ds_read_b128 v[148:151], v11 offset:27648
    v_mfma_f32_16x16x32_bf16 v[184:187], v[104:107], a[176:179], v[184:187]
    v_mfma_f32_16x16x32_bf16 v[184:187], v[108:111], a[184:187], v[184:187]
    buffer_load_dwordx4 a[240:243], v4, s[40:43], s63 offen offset:2048 sc1
    v_mfma_f32_16x16x32_bf16 v[188:191], v[104:107], a[180:183], v[188:191]
    v_mfma_f32_16x16x32_bf16 v[188:191], v[108:111], a[188:191], v[188:191]
    v_mfma_f32_16x16x32_bf16 v[192:195], v[112:115], a[176:179], v[192:195]
    v_mfma_f32_16x16x32_bf16 v[192:195], v[116:119], a[184:187], v[192:195]
    buffer_load_dwordx4 a[244:247], v5, s[40:43], s63 offen offset:2048 sc1
    v_mfma_f32_16x16x32_bf16 v[196:199], v[112:115], a[180:183], v[196:199]
    v_mfma_f32_16x16x32_bf16 v[196:199], v[116:119], a[188:191], v[196:199]
    v_mfma_f32_16x16x32_bf16 v[200:203], v[120:123], a[176:179], v[200:203]
    v_mfma_f32_16x16x32_bf16 v[200:203], v[124:127], a[184:187], v[200:203]
    buffer_load_dwordx4 a[248:251], v4, s[40:43], s63 offen offset:3072 sc1
    v_mfma_f32_16x16x32_bf16 v[204:207], v[120:123], a[180:183], v[204:207]
    v_mfma_f32_16x16x32_bf16 v[204:207], v[124:127], a[188:191], v[204:207]
    s_waitcnt vmcnt(14)
    v_cmp_gt_u32 vcc, 3, v3
    s_nop 1
    s_and_b64 vcc, vcc, exec
    s_cbranch_scc1 SPIN_OA
BACK_OA:
    s_barrier
    v_mfma_f32_16x16x32_bf16 v[208:211], v[128:131], a[176:179], v[208:211]
    ds_read_b128 v[104:107], v11 offset:28672
    ds_read_b128 v[108:111], v11 offset:35840
    v_mfma_f32_16x16x32_bf16 v[208:211], v[132:135], a[184:187], v[208:211]
    buffer_load_dwordx4 a[252:255], v5, s[40:43], s63 offen offset:3072 sc1
    v_mfma_f32_16x16x32_bf16 v[212:215], v[128:131], a[180:183], v[212:215]
    ds_read_b128 v[112:115], v11 offset:29696
    ds_read_b128 v[116:119], v11 offset:36864
    v_mfma_f32_16x16x32_bf16 v[212:215], v[132:135], a[188:191], v[212:215]
    s_mul_i32 s21, s61, 6
    s_add_u32 s21, s4, s21
    ds_read_b128 v[120:123], v11 offset:30720
    v_mfma_f32_16x16x32_bf16 v[216:219], v[136:139], a[176:179], v[216:219]
    s_add_u32 s21, s21, 128
    ds_read_b128 v[124:127], v11 offset:37888
    s_waitcnt lgkmcnt(6)
    v_mfma_f32_16x16x32_bf16 v[216:219], v[140:143], a[184:187], v[216:219]
    s_mul_i32 s21, s21, 36864
    ds_read_b128 v[128:131], v11 offset:31744
    v_mfma_f32_16x16x32_bf16 v[220:223], v[136:139], a[180:183], v[220:223]
    s_add_u32 s64, s21, s17
    s_add_u32 m0, s78, 86016
    ds_read_b128 v[132:135], v11 offset:38912
    v_mfma_f32_16x16x32_bf16 v[220:223], v[140:143], a[188:191], v[220:223]
    s_add_u32 s63, s63, 4096
    buffer_load_dwordx4 v1, s[56:59], s64 offen sc1 lds
    v_mfma_f32_16x16x32_bf16 v[224:227], v[144:147], a[176:179], v[224:227]
    ds_read_b128 v[136:139], v11 offset:32768
    ds_read_b128 v[140:143], v11 offset:39936
    v_mfma_f32_16x16x32_bf16 v[224:227], v[148:151], a[184:187], v[224:227]
    v_mfma_f32_16x16x32_bf16 v[228:231], v[144:147], a[180:183], v[228:231]
    buffer_load_dwordx4 v1, s[56:59], s64 offen offset:1024 sc1 lds
    v_mfma_f32_16x16x32_bf16 v[228:231], v[148:151], a[188:191], v[228:231]
    s_add_u32 s64, s21, s18
    ds_read_b128 v[144:147], v11 offset:33792
    ds_read_b128 v[148:151], v11 offset:40960
    s_waitcnt lgkmcnt(4)
    v_mfma_f32_16x16x32_bf16 v[176:179], v[104:107], a[192:195], v[176:179]
    s_add_u32 m0, s78, 88064
    v_mfma_f32_16x16x32_bf16 v[176:179], v[108:111], a[200:203], v[176:179]
    v_mfma_f32_16x16x32_bf16 v[180:183], v[104:107], a[196:199], v[180:183]
    buffer_load_dwordx4 v1, s[56:59], s64 offen sc1 lds
    v_mfma_f32_16x16x32_bf16 v[180:183], v[108:111], a[204:207], v[180:183]
    ds_read_b128 v[104:107], v11 offset:34816
    ds_read_b128 v[108:111], v11 offset:41984
    v_mfma_f32_16x16x32_bf16 v[184:187], v[112:115], a[192:195], v[184:187]
    v_mfma_f32_16x16x32_bf16 v[184:187], v[116:119], a[200:203], v[184:187]
    v_mfma_f32_16x16x32_bf16 v[188:191], v[112:115], a[196:199], v[188:191]
    buffer_load_dwordx4 v1, s[56:59], s64 offen offset:1024 sc1 lds
    v_mfma_f32_16x16x32_bf16 v[188:191], v[116:119], a[204:207], v[188:191]
    s_add_u32 s64, s21, s19
    ds_read_b128 v[112:115], v11 offset:43008
    ds_read_b128 v[116:119], v11 offset:50176
    v_mfma_f32_16x16x32_bf16 v[192:195], v[120:123], a[192:195], v[192:195]
    s_add_u32 m0, s78, 90112
    v_mfma_f32_16x16x32_bf16 v[192:195], v[124:127], a[200:203], v[192:195]
    v_mfma_f32_16x16x32_bf16 v[196:199], v[120:123], a[196:199], v[196:199]
    buffer_load_dwordx4 v1, s[56:59], s64 offen sc1 lds
    v_mfma_f32_16x16x32_bf16 v[196:199], v[124:127], a[204:207], v[196:199]
    ds_read_b128 v[120:123], v11 offset:44032
    ds_read_b128 v[124:127], v11 offset:51200
    v_mfma_f32_16x16x32_bf16 v[200:203], v[128:131], a[192:195], v[200:203]
    v_mfma_f32_16x16x32_bf16 v[200:203], v[132:135], a[200:203], v[200:203]
    v_mfma_f32_16x16x32_bf16 v[204:207], v[128:131], a[196:199], v[204:207]
    buffer_load_dwordx4 v1, s[56:59], s64 offen offset:1024 sc1 lds
    v_mfma_f32_16x16x32_bf16 v[204:207], v[132:135], a[204:207], v[204:207]
    s_add_u32 s64, s21, s20
    ds_read_b128 v[128:131], v11 offset:45056
    ds_read_b128 v[132:135], v11 offset:52224
    s_waitcnt lgkmcnt(4)
    v_mfma_f32_16x16x32_bf16 v[208:211], v[136:139], a[192:195], v[208:211]
    s_add_u32 m0, s78, 92160
    v_mfma_f32_16x16x32_bf16 v[208:211], v[140:143], a[200:203], v[208:211]
    v_mfma_f32_16x16x32_bf16 v[212:215], v[136:139], a[196:199], v[212:215]
    buffer_load_dwordx4 v1, s[56:59], s64 offen sc1 lds
    v_mfma_f32_16x16x32_bf16 v[212:215], v[140:143], a[204:207], v[212:215]
    s_mul_i32 s63, s61, 6144
    ds_read_b128 v[136:139], v11 offset:46080
    ds_read_b128 v[140:143], v11 offset:53248
    v_mfma_f32_16x16x32_bf16 v[216:219], v[144:147], a[192:195], v[216:219]
    s_add_u32 s63, s63, 131072
    v_mfma_f32_16x16x32_bf16 v[216:219], v[148:151], a[200:203], v[216:219]
    v_mfma_f32_16x16x32_bf16 v[220:223], v[144:147], a[196:199], v[220:223]
    buffer_load_dwordx4 v[32:35], v4, s[40:43], s63 offen offset:0 sc1
    v_mfma_f32_16x16x32_bf16 v[220:223], v[148:151], a[204:207], v[220:223]
    ds_read_b128 v[144:147], v11 offset:47104
    ds_read_b128 v[148:151], v11 offset:54272
    v_mfma_f32_16x16x32_bf16 v[224:227], v[104:107], a[192:195], v[224:227]
    v_mfma_f32_16x16x32_bf16 v[224:227], v[108:111], a[200:203], v[224:227]
    v_mfma_f32_16x16x32_bf16 v[228:231], v[104:107], a[196:199], v[228:231]
    ds_read_b128 v[104:107], v11 offset:48128
    v_mfma_f32_16x16x32_bf16 v[228:231], v[108:111], a[204:207], v[228:231]
    buffer_load_dwordx4 v[36:39], v5, s[40:43], s63 offen offset:0 sc1
    v_mfma_f32_16x16x32_bf16 v[176:179], v[112:115], a[208:211], v[176:179]
    ds_read_b128 v[108:111], v11 offset:55296
    v_mfma_f32_16x16x32_bf16 v[176:179], v[116:119], a[216:219], v[176:179]
    v_mfma_f32_16x16x32_bf16 v[180:183], v[112:115], a[212:215], v[180:183]
    ds_read_b128 v[112:115], v11 offset:49152
    v_mfma_f32_16x16x32_bf16 v[180:183], v[116:119], a[220:223], v[180:183]
    s_waitcnt lgkmcnt(2)
    buffer_load_dwordx4 v[40:43], v4, s[40:43], s63 offen offset:1024 sc1
    v_mfma_f32_16x16x32_bf16 v[184:187], v[120:123], a[208:211], v[184:187]
    ds_read_b128 v[116:119], v11 offset:56320
    v_mfma_f32_16x16x32_bf16 v[184:187], v[124:127], a[216:219], v[184:187]
    v_mfma_f32_16x16x32_bf16 v[188:191], v[120:123], a[212:215], v[188:191]
    v_mfma_f32_16x16x32_bf16 v[188:191], v[124:127], a[220:223], v[188:191]
    buffer_load_dwordx4 v[44:47], v5, s[40:43], s63 offen offset:1024 sc1
    v_mfma_f32_16x16x32_bf16 v[192:195], v[128:131], a[208:211], v[192:195]
    v_mfma_f32_16x16x32_bf16 v[192:195], v[132:135], a[216:219], v[192:195]
    v_mfma_f32_16x16x32_bf16 v[196:199], v[128:131], a[212:215], v[196:199]
    v_mfma_f32_16x16x32_bf16 v[196:199], v[132:135], a[220:223], v[196:199]
    buffer_load_dwordx4 v[48:51], v4, s[40:43], s63 offen offset:2048 sc1
    v_mfma_f32_16x16x32_bf16 v[200:203], v[136:139], a[208:211], v[200:203]
    v_mfma_f32_16x16x32_bf16 v[200:203], v[140:143], a[216:219], v[200:203]
    v_mfma_f32_16x16x32_bf16 v[204:207], v[136:139], a[212:215], v[204:207]
    v_mfma_f32_16x16x32_bf16 v[204:207], v[140:143], a[220:223], v[204:207]
    s_waitcnt vmcnt(12)
    s_barrier
    ds_read_b128 v[120:123], v11 offset:57344
    v_mfma_f32_16x16x32_bf16 v[208:211], v[144:147], a[208:211], v[208:211]
    buffer_load_dwordx4 v[52:55], v5, s[40:43], s63 offen offset:2048 sc1
    v_mfma_f32_16x16x32_bf16 v[208:211], v[148:151], a[216:219], v[208:211]
    ds_read_b128 v[124:127], v11 offset:64512
    ds_read_b128 v[128:131], v11 offset:58368
    v_mfma_f32_16x16x32_bf16 v[212:215], v[144:147], a[212:215], v[212:215]
    ds_read_b128 v[132:135], v12 offset:0
    v_mfma_f32_16x16x32_bf16 v[212:215], v[148:151], a[220:223], v[212:215]
    buffer_load_dwordx4 v[56:59], v4, s[40:43], s63 offen offset:3072 sc1
    v_mfma_f32_16x16x32_bf16 v[216:219], v[104:107], a[208:211], v[216:219]
    s_waitcnt lgkmcnt(3)
    ds_read_b128 v[136:139], v11 offset:59392
    ds_read_b128 v[140:143], v12 offset:1024
    v_mfma_f32_16x16x32_bf16 v[216:219], v[108:111], a[216:219], v[216:219]
    ds_read_b128 v[144:147], v11 offset:60416
    v_mfma_f32_16x16x32_bf16 v[220:223], v[104:107], a[212:215], v[220:223]
    ds_read_b128 v[148:151], v12 offset:2048
    v_mfma_f32_16x16x32_bf16 v[220:223], v[108:111], a[220:223], v[220:223]
    buffer_load_dwordx4 v[60:63], v5, s[40:43], s63 offen offset:3072 sc1
    v_mfma_f32_16x16x32_bf16 v[224:227], v[112:115], a[208:211], v[224:227]
    s_mul_i32 s21, s61, 6
    s_cmp_eq_u32 s4, 0
    s_cselect_b32 s64, s17, s18
    v_mfma_f32_16x16x32_bf16 v[224:227], v[116:119], a[216:219], v[224:227]
    s_add_u32 s21, s21, 132
    s_cmp_eq_u32 s4, 2
    s_cselect_b32 s64, s19, s64
    v_mfma_f32_16x16x32_bf16 v[228:231], v[112:115], a[212:215], v[228:231]
    s_mul_i32 s21, s21, 36864
    s_cmp_eq_u32 s4, 3
    s_cselect_b32 s64, s20, s64
    v_mfma_f32_16x16x32_bf16 v[228:231], v[116:119], a[220:223], v[228:231]
    s_add_u32 s64, s64, s21
    s_add_u32 m0, s67, 114688
    ds_read_b128 v[104:107], v11 offset:61440
    v_mfma_f32_16x16x32_bf16 v[176:179], v[120:123], a[224:227], v[176:179]
    s_add_u32 s63, s63, 4096
    buffer_load_dwordx4 v1, s[56:59], s64 offen sc1 lds
    s_waitcnt lgkmcnt(1)
    v_mfma_f32_16x16x32_bf16 v[176:179], v[124:127], a[232:235], v[176:179]
    s_add_u32 s23, s5, 8
    ds_read_b128 v[108:111], v12 offset:3072
    ds_read_b128 v[112:115], v11 offset:62464
    v_mfma_f32_16x16x32_bf16 v[180:183], v[120:123], a[228:231], v[180:183]
    s_add_u32 s22, s4, 1
    ds_read_b128 v[116:119], v12 offset:4096
    v_lshrrev_b32 v19, 4, v1
    v_mfma_f32_16x16x32_bf16 v[180:183], v[124:127], a[236:239], v[180:183]
    s_mul_i32 s70, s4, 3072
    ds_read_b128 v[120:123], v11 offset:63488
    v_min_u32 v19, 2, v19
    v_mfma_f32_16x16x32_bf16 v[184:187], v[128:131], a[224:227], v[184:187]
    s_lshl_b32 s22, s22, 15
    buffer_load_dwordx4 v1, s[56:59], s64 offen offset:1024 sc1 lds
    v_mfma_f32_16x16x32_bf16 v[184:187], v[132:135], a[232:235], v[184:187]
    s_add_u32 s64, s64, 36864
    ds_read_b128 v[124:127], v12 offset:5120
    v_lshl_add_u32 v19, v19, 3, s23
    v_mfma_f32_16x16x32_bf16 v[188:191], v[128:131], a[228:231], v[188:191]
    s_add_u32 m0, s67, 122880
    ds_read_b128 v[128:131], v12 offset:6144
    v_bfe_u32 v20, v1, 4, 4
    v_mfma_f32_16x16x32_bf16 v[188:191], v[132:135], a[236:239], v[188:191]
    s_lshl2_add_u32 s23, s62, s4
    ds_read_b128 v[132:135], v12 offset:13312
    v_lshrrev_b32 v21, 8, v1
    v_mfma_f32_16x16x32_bf16 v[192:195], v[136:139], a[224:227], v[192:195]
    s_lshl_b32 s23, s23, 5
    buffer_load_dwordx4 v1, s[56:59], s64 offen sc1 lds
    v_mfma_f32_16x16x32_bf16 v[192:195], v[140:143], a[232:235], v[192:195]
    s_lshl_b32 s66, s6, 12
    v_add_u32 v20, s23, v20
    v_mul_u32_u24 v20, 1152, v20
    v_mfma_f32_16x16x32_bf16 v[196:199], v[136:139], a[228:231], v[196:199]
    s_mul_i32 s23, s101, 288
    ds_read_b128 v[136:139], v12 offset:7168
    v_and_b32 v19, 31, v19
    v_mfma_f32_16x16x32_bf16 v[196:199], v[140:143], a[236:239], v[196:199]
    s_add_u32 s23, s23, s70
    ds_read_b128 v[140:143], v12 offset:14336
    v_lshl_add_u32 v20, v21, 3, v20
    v_mfma_f32_16x16x32_bf16 v[200:203], v[144:147], a[224:227], v[200:203]
    s_lshr_b32 s65, s20, 5
    buffer_load_dwordx4 v1, s[56:59], s64 offen offset:1024 sc1 lds
    v_mfma_f32_16x16x32_bf16 v[200:203], v[148:151], a[232:235], v[200:203]
    s_add_u32 s64, s64, 36864
    v_mov_b32 v31, 2
    v_lshlrev_b32 v23, 20, v1
    v_mfma_f32_16x16x32_bf16 v[204:207], v[144:147], a[228:231], v[204:207]
    s_add_u32 s66, s66, s22
    ds_read_b128 v[144:147], v12 offset:8192
    v_lshlrev_b32 v19, 7, v19
    v_mfma_f32_16x16x32_bf16 v[204:207], v[148:151], a[236:239], v[204:207]
    s_add_u32 s22, s22, s101
    ds_read_b128 v[148:151], v12 offset:15360
    v_add_u32 v21, 18432, v20
    s_waitcnt lgkmcnt(3)
    v_mfma_f32_16x16x32_bf16 v[208:211], v[104:107], a[224:227], v[208:211]
    buffer_load_dwordx4 v[64:67], v4, s[40:43], s63 offen offset:0 sc1
    v_mfma_f32_16x16x32_bf16 v[208:211], v[108:111], a[232:235], v[208:211]
    s_cmp_eq_u32 s4, s61
    s_cselect_b32 s65, s65, 1073741824
    s_cselect_b32 s70, s23, 1073741824
    v_mfma_f32_16x16x32_bf16 v[212:215], v[104:107], a[228:231], v[212:215]
    s_add_u32 s98, s70, 0
    ds_read_b128 v[104:107], v12 offset:9216
    v_mfma_f32_16x16x32_bf16 v[212:215], v[108:111], a[236:239], v[212:215]
    ds_read_b128 v[108:111], v12 offset:16384
    v_mfma_f32_16x16x32_bf16 v[216:219], v[112:115], a[224:227], v[216:219]
    buffer_load_dwordx4 v[68:71], v5, s[40:43], s63 offen offset:0 sc1
    v_mfma_f32_16x16x32_bf16 v[216:219], v[116:119], a[232:235], v[216:219]
    v_mfma_f32_16x16x32_bf16 v[220:223], v[112:115], a[228:231], v[220:223]
    ds_read_b128 v[112:115], v12 offset:10240
    v_mfma_f32_16x16x32_bf16 v[220:223], v[116:119], a[236:239], v[220:223]
    ds_read_b128 v[116:119], v12 offset:17408
    v_mfma_f32_16x16x32_bf16 v[224:227], v[120:123], a[224:227], v[224:227]
    buffer_load_dwordx4 v[72:75], v4, s[40:43], s63 offen offset:1024 sc1
    v_mfma_f32_16x16x32_bf16 v[224:227], v[124:127], a[232:235], v[224:227]
    v_mfma_f32_16x16x32_bf16 v[228:231], v[120:123], a[228:231], v[228:231]
    ds_read_b128 v[120:123], v12 offset:11264
    v_mfma_f32_16x16x32_bf16 v[228:231], v[124:127], a[236:239], v[228:231]
    ds_read_b128 v[124:127], v12 offset:18432
    v_mfma_f32_16x16x32_bf16 v[176:179], v[128:131], a[240:243], v[176:179]
    buffer_load_dwordx4 v[76:79], v5, s[40:43], s63 offen offset:1024 sc1
    v_mfma_f32_16x16x32_bf16 v[176:179], v[132:135], a[248:251], v[176:179]
    s_lshr_b32 s64, s4, 1
    s_lshl1_add_u32 s21, s61, s64
    s_mul_i32 s21, s21, 3
    v_mfma_f32_16x16x32_bf16 v[180:183], v[128:131], a[244:247], v[180:183]
    s_add_u32 s21, s21, 128
    s_mul_i32 s21, s21, 36864
    ds_read_b128 v[128:131], v12 offset:12288
    v_mfma_f32_16x16x32_bf16 v[180:183], v[132:135], a[252:255], v[180:183]
    s_add_u32 s21, s21, s16
    s_and_b32 s64, s68, 1024
    ds_read_b128 v[132:135], v12 offset:19456
    v_mfma_f32_16x16x32_bf16 v[184:187], v[136:139], a[240:243], v[184:187]
    s_add_u32 s21, s21, s64
    s_add_u32 m0, s69, 143360
    s_waitcnt lgkmcnt(2)
    v_mfma_f32_16x16x32_bf16 v[184:187], v[140:143], a[248:251], v[184:187]
    s_add_u32 s63, s63, 4096
    buffer_load_dwordx4 v1, s[56:59], s21 offen sc1 lds
    v_mfma_f32_16x16x32_bf16 v[188:191], v[136:139], a[244:247], v[188:191]
    s_add_u32 s21, s21, 36864
    v_mfma_f32_16x16x32_bf16 v[188:191], v[140:143], a[252:255], v[188:191]
    s_add_u32 m0, s69, 144384
    v_mfma_f32_16x16x32_bf16 v[192:195], v[144:147], a[240:243], v[192:195]
    s_lshr_b32 s64, s16, 5
    v_mfma_f32_16x16x32_bf16 v[192:195], v[148:151], a[248:251], v[192:195]
    buffer_load_dwordx4 v1, s[56:59], s21 offen sc1 lds
    v_mfma_f32_16x16x32_bf16 v[196:199], v[144:147], a[244:247], v[196:199]
    s_add_u32 s21, s21, 36864
    v_mfma_f32_16x16x32_bf16 v[196:199], v[148:151], a[252:255], v[196:199]
    s_add_u32 m0, s69, 145408
    v_mfma_f32_16x16x32_bf16 v[200:203], v[104:107], a[240:243], v[200:203]
    v_mfma_f32_16x16x32_bf16 v[200:203], v[108:111], a[248:251], v[200:203]
    buffer_load_dwordx4 v1, s[56:59], s21 offen sc1 lds
    v_mfma_f32_16x16x32_bf16 v[204:207], v[104:107], a[244:247], v[204:207]
    s_add_u32 s21, s21, 36864
    s_add_u32 s21, s4, 0
    v_mfma_f32_16x16x32_bf16 v[204:207], v[108:111], a[252:255], v[204:207]
    s_waitcnt vmcnt(11)
    s_barrier
    s_xor_b32 s21, s21, s3
    v_mfma_f32_16x16x32_bf16 v[208:211], v[112:115], a[240:243], v[208:211]
    s_mul_i32 s21, s21, 147456
    ds_read_b128 v[136:139], v12 offset:20480
    ds_read_b128 v[140:143], v12 offset:27648
    v_mfma_f32_16x16x32_bf16 v[208:211], v[116:119], a[248:251], v[208:211]
    s_add_u32 s21, s21, s16
    s_add_u32 m0, s75, 0
    ds_read_b128 v[144:147], v12 offset:21504
    v_mfma_f32_16x16x32_bf16 v[212:215], v[112:115], a[244:247], v[212:215]
    buffer_load_dwordx4 v1, s[56:59], s21 offen sc1 lds
    v_mfma_f32_16x16x32_bf16 v[212:215], v[116:119], a[252:255], v[212:215]
    ds_read_b128 v[148:151], v12 offset:28672
    ds_read_b128 v[104:107], v12 offset:22528
    v_mfma_f32_16x16x32_bf16 v[216:219], v[120:123], a[240:243], v[216:219]
    ds_read_b128 v[108:111], v12 offset:29696
    v_mfma_f32_16x16x32_bf16 v[216:219], v[124:127], a[248:251], v[216:219]
    buffer_load_dwordx4 v1, s[56:59], s21 offen offset:1024 sc1 lds
    v_mfma_f32_16x16x32_bf16 v[220:223], v[120:123], a[244:247], v[220:223]
    s_add_u32 s21, s21, 36864
    ds_read_b128 v[112:115], v12 offset:23552
    ds_read_b128 v[116:119], v12 offset:30720
    v_mfma_f32_16x16x32_bf16 v[220:223], v[124:127], a[252:255], v[220:223]
    s_add_u32 m0, s75, 2048
    ds_read_b128 v[120:123], v12 offset:24576
    s_waitcnt lgkmcnt(6)
    v_mfma_f32_16x16x32_bf16 v[224:227], v[128:131], a[240:243], v[224:227]
    ds_read_b128 v[124:127], v12 offset:31744
    v_mfma_f32_16x16x32_bf16 v[224:227], v[132:135], a[248:251], v[224:227]
    buffer_load_dwordx4 v1, s[56:59], s21 offen sc1 lds
    v_mfma_f32_16x16x32_bf16 v[228:231], v[128:131], a[244:247], v[228:231]
    ds_read_b128 v[128:131], v12 offset:25600
    v_mfma_f32_16x16x32_bf16 v[228:231], v[132:135], a[252:255], v[228:231]
    ds_read_b128 v[132:135], v12 offset:32768
    v_mfma_f32_16x16x32_bf16 v[176:179], v[136:139], v[32:35], v[176:179]
    v_mfma_f32_16x16x32_bf16 v[176:179], v[140:143], v[40:43], v[176:179]
    buffer_load_dwordx4 v1, s[56:59], s21 offen offset:1024 sc1 lds
    v_mfma_f32_16x16x32_bf16 v[180:183], v[136:139], v[36:39], v[180:183]
    s_add_u32 s21, s21, 36864
    ds_read_b128 v[136:139], v12 offset:26624
    v_mfma_f32_16x16x32_bf16 v[180:183], v[140:143], v[44:47], v[180:183]
    s_add_u32 m0, s75, 4096
    ds_read_b128 v[140:143], v12 offset:33792
    v_mfma_f32_16x16x32_bf16 v[184:187], v[144:147], v[32:35], v[184:187]
    s_waitcnt lgkmcnt(2)
    v_mfma_f32_16x16x32_bf16 v[184:187], v[148:151], v[40:43], v[184:187]
    buffer_load_dwordx4 v1, s[56:59], s21 offen sc1 lds
    v_mfma_f32_16x16x32_bf16 v[188:191], v[144:147], v[36:39], v[188:191]
    ds_read_b128 v[144:147], v12 offset:34816
    v_mfma_f32_16x16x32_bf16 v[188:191], v[148:151], v[44:47], v[188:191]
    ds_read_b128 v[148:151], v12 offset:41984
    v_mfma_f32_16x16x32_bf16 v[192:195], v[104:107], v[32:35], v[192:195]
    v_mfma_f32_16x16x32_bf16 v[192:195], v[108:111], v[40:43], v[192:195]
    v_mfma_f32_16x16x32_bf16 v[196:199], v[104:107], v[36:39], v[196:199]
    buffer_load_dwordx4 v1, s[56:59], s21 offen offset:1024 sc1 lds
    v_mfma_f32_16x16x32_bf16 v[196:199], v[108:111], v[44:47], v[196:199]
    s_add_u32 s21, s21, 36864
    v_mfma_f32_16x16x32_bf16 v[200:203], v[112:115], v[32:35], v[200:203]
    s_add_u32 m0, s75, 6144
    v_mfma_f32_16x16x32_bf16 v[200:203], v[116:119], v[40:43], v[200:203]
    v_mfma_f32_16x16x32_bf16 v[204:207], v[112:115], v[36:39], v[204:207]
    buffer_load_dwordx4 v1, s[56:59], s21 offen sc1 lds
    v_mfma_f32_16x16x32_bf16 v[204:207], v[116:119], v[44:47], v[204:207]
    s_waitcnt vmcnt(10)
    s_barrier
    ds_read_b128 v[104:107], v12 offset:49152
    v_mfma_f32_16x16x32_bf16 v[208:211], v[120:123], v[32:35], v[208:211]
    ds_read_b128 v[108:111], v12 offset:57344
    ds_read_b128 v[112:115], v12 offset:35840
    v_mfma_f32_16x16x32_bf16 v[208:211], v[124:127], v[40:43], v[208:211]
    ds_read_b128 v[116:119], v12 offset:43008
    v_mfma_f32_16x16x32_bf16 v[212:215], v[120:123], v[36:39], v[212:215]
    buffer_load_dwordx4 v1, s[56:59], s21 offen offset:1024 sc1 lds
    v_mfma_f32_16x16x32_bf16 v[212:215], v[124:127], v[44:47], v[212:215]
    s_add_u32 s21, s21, 36864
    s_add_u32 s21, s4, 4
    ds_read_b128 v[120:123], v12 offset:50176
    v_mfma_f32_16x16x32_bf16 v[216:219], v[128:131], v[32:35], v[216:219]
    s_xor_b32 s21, s21, s3
    ds_read_b128 v[124:127], v12 offset:58368
    v_mfma_f32_16x16x32_bf16 v[216:219], v[132:135], v[40:43], v[216:219]
    s_mul_i32 s21, s21, 147456
    v_mfma_f32_16x16x32_bf16 v[220:223], v[128:131], v[36:39], v[220:223]
    s_add_u32 s21, s21, s16
    s_add_u32 m0, s75, 32768
    ds_read_b128 v[128:131], v12 offset:36864
    v_mfma_f32_16x16x32_bf16 v[220:223], v[132:135], v[44:47], v[220:223]
    s_waitcnt lgkmcnt(3)
    buffer_load_dwordx4 v1, s[56:59], s21 offen sc1 lds
    v_mfma_f32_16x16x32_bf16 v[224:227], v[136:139], v[32:35], v[224:227]
    ds_read_b128 v[132:135], v12 offset:44032
    v_mfma_f32_16x16x32_bf16 v[224:227], v[140:143], v[40:43], v[224:227]
    v_mfma_f32_16x16x32_bf16 v[228:231], v[136:139], v[36:39], v[228:231]
    buffer_load_dwordx4 v1, s[56:59], s21 offen offset:1024 sc1 lds
    v_mfma_f32_16x16x32_bf16 v[228:231], v[140:143], v[44:47], v[228:231]
    s_add_u32 s21, s21, 36864
    ds_read_b128 v[136:139], v12 offset:51200
    ds_read_b128 v[140:143], v12 offset:59392
    v_mfma_f32_16x16x32_bf16 v[176:179], v[144:147], v[48:51], v[176:179]
    s_add_u32 m0, s75, 34816
    v_mfma_f32_16x16x32_bf16 v[176:179], v[148:151], v[56:59], v[176:179]
    v_mfma_f32_16x16x32_bf16 v[176:179], v[104:107], v[64:67], v[176:179]
    buffer_load_dwordx4 v1, s[56:59], s21 offen sc1 lds
    v_mfma_f32_16x16x32_bf16 v[176:179], v[108:111], v[72:75], v[176:179]
    v_mfma_f32_16x16x32_bf16 v[180:183], v[144:147], v[52:55], v[180:183]
    ds_read_b128 v[144:147], v12 offset:37888
    v_mfma_f32_16x16x32_bf16 v[180:183], v[148:151], v[60:63], v[180:183]
    ds_read_b128 v[148:151], v12 offset:45056
    v_mfma_f32_16x16x32_bf16 v[180:183], v[104:107], v[68:71], v[180:183]
    buffer_load_dwordx4 v1, s[56:59], s21 offen offset:1024 sc1 lds
    v_mfma_f32_16x16x32_bf16 v[180:183], v[108:111], v[76:79], v[180:183]
    s_add_u32 s21, s21, 36864
    v_cvt_pk_bf16_f32 v232, v176, v177
    v_cvt_pk_bf16_f32 v233, v178, v179
    v_mfma_f32_16x16x32_bf16 v[184:187], v[112:115], v[48:51], v[184:187]
    s_add_u32 m0, s75, 36864
    ds_read_b128 v[104:107], v12 offset:52224
    ds_read_b128 v[108:111], v12 offset:60416
    v_mfma_f32_16x16x32_bf16 v[184:187], v[116:119], v[56:59], v[184:187]
    s_waitcnt lgkmcnt(3)
    v_cvt_pk_bf16_f32 v234, v180, v181
    v_cvt_pk_bf16_f32 v235, v182, v183
    v_mfma_f32_16x16x32_bf16 v[184:187], v[120:123], v[64:67], v[184:187]
    buffer_load_dwordx4 v1, s[56:59], s21 offen sc1 lds
    v_mfma_f32_16x16x32_bf16 v[184:187], v[124:127], v[72:75], v[184:187]
    buffer_store_dwordx4 v[232:235], v1, s[48:51], s8 offen offset:0 sc1
    v_mfma_f32_16x16x32_bf16 v[188:191], v[112:115], v[52:55], v[188:191]
    ds_read_b128 v[112:115], v12 offset:38912
    v_mfma_f32_16x16x32_bf16 v[188:191], v[116:119], v[60:63], v[188:191]
    ds_read_b128 v[116:119], v12 offset:46080
    v_mfma_f32_16x16x32_bf16 v[188:191], v[120:123], v[68:71], v[188:191]
    ds_read_b128 v[120:123], v12 offset:53248
    v_mfma_f32_16x16x32_bf16 v[188:191], v[124:127], v[76:79], v[188:191]
    buffer_load_dwordx4 v1, s[56:59], s21 offen offset:1024 sc1 lds
    v_mfma_f32_16x16x32_bf16 v[192:195], v[128:131], v[48:51], v[192:195]
    s_add_u32 s21, s21, 36864
    v_cvt_pk_bf16_f32 v236, v184, v185
    v_cvt_pk_bf16_f32 v237, v186, v187
    v_mfma_f32_16x16x32_bf16 v[192:195], v[132:135], v[56:59], v[192:195]
    s_add_u32 m0, s75, 38912
    ds_read_b128 v[124:127], v12 offset:61440
    v_cvt_pk_bf16_f32 v238, v188, v189
    v_mfma_f32_16x16x32_bf16 v[192:195], v[136:139], v[64:67], v[192:195]
    v_cvt_pk_bf16_f32 v239, v190, v191
    v_mfma_f32_16x16x32_bf16 v[192:195], v[140:143], v[72:75], v[192:195]
    buffer_load_dwordx4 v1, s[56:59], s21 offen sc1 lds
    v_mfma_f32_16x16x32_bf16 v[196:199], v[128:131], v[52:55], v[196:199]
    ds_read_b128 v[128:131], v12 offset:39936
    v_mfma_f32_16x16x32_bf16 v[196:199], v[132:135], v[60:63], v[196:199]
    ds_read_b128 v[132:135], v12 offset:47104
    v_mfma_f32_16x16x32_bf16 v[196:199], v[136:139], v[68:71], v[196:199]
    ds_read_b128 v[136:139], v12 offset:54272
    v_mfma_f32_16x16x32_bf16 v[196:199], v[140:143], v[76:79], v[196:199]
    buffer_store_dwordx4 v[236:239], v1, s[48:51], s8 offen offset:1024 sc1
    v_mfma_f32_16x16x32_bf16 v[200:203], v[144:147], v[48:51], v[200:203]
    s_waitcnt lgkmcnt(3)
    v_cvt_pk_bf16_f32 v240, v192, v193
    v_cvt_pk_bf16_f32 v241, v194, v195
    v_mfma_f32_16x16x32_bf16 v[200:203], v[148:151], v[56:59], v[200:203]
    ds_read_b128 v[140:143], v12 offset:62464
    v_mfma_f32_16x16x32_bf16 v[200:203], v[104:107], v[64:67], v[200:203]
    v_mfma_f32_16x16x32_bf16 v[200:203], v[108:111], v[72:75], v[200:203]
    buffer_load_dwordx4 v1, s[56:59], s21 offen offset:1024 sc1 lds
    v_mfma_f32_16x16x32_bf16 v[204:207], v[144:147], v[52:55], v[204:207]
    s_add_u32 s21, s21, 36864
    v_cvt_pk_bf16_f32 v242, v196, v197
    v_cvt_pk_bf16_f32 v243, v198, v199
    v_mfma_f32_16x16x32_bf16 v[204:207], v[148:151], v[60:63], v[204:207]
    ds_read_b128 v[144:147], v12 offset:40960
    ds_read_b128 v[148:151], v12 offset:48128
    v_mfma_f32_16x16x32_bf16 v[204:207], v[104:107], v[68:71], v[204:207]
    v_cvt_pk_bf16_f32 v244, v200, v201
    v_cvt_pk_bf16_f32 v245, v202, v203
    v_mfma_f32_16x16x32_bf16 v[204:207], v[108:111], v[76:79], v[204:207]
    buffer_store_dwordx4 v[240:243], v1, s[48:51], s9 offen offset:0 sc1
    v_mfma_f32_16x16x32_bf16 v[208:211], v[112:115], v[48:51], v[208:211]
    ds_read_b128 v[104:107], v12 offset:55296
    ds_read_b128 v[108:111], v12 offset:63488
    v_mfma_f32_16x16x32_bf16 v[208:211], v[116:119], v[56:59], v[208:211]
    v_mfma_f32_16x16x32_bf16 v[208:211], v[120:123], v[64:67], v[208:211]
    v_mfma_f32_16x16x32_bf16 v[208:211], v[124:127], v[72:75], v[208:211]
    v_mfma_f32_16x16x32_bf16 v[212:215], v[112:115], v[52:55], v[212:215]
    v_cvt_pk_bf16_f32 v246, v204, v205
    v_cvt_pk_bf16_f32 v247, v206, v207
    v_mfma_f32_16x16x32_bf16 v[212:215], v[116:119], v[60:63], v[212:215]
    buffer_store_dwordx4 v[244:247], v1, s[48:51], s9 offen offset:1024 sc1
    v_mfma_f32_16x16x32_bf16 v[212:215], v[120:123], v[68:71], v[212:215]
    v_mfma_f32_16x16x32_bf16 v[212:215], v[124:127], v[76:79], v[212:215]
    s_waitcnt lgkmcnt(0)
    v_mfma_f32_16x16x32_bf16 v[216:219], v[128:131], v[48:51], v[216:219]
    v_cvt_pk_bf16_f32 v232, v208, v209
    v_cvt_pk_bf16_f32 v233, v210, v211
    v_mfma_f32_16x16x32_bf16 v[216:219], v[132:135], v[56:59], v[216:219]
    v_mfma_f32_16x16x32_bf16 v[216:219], v[136:139], v[64:67], v[216:219]
    v_mfma_f32_16x16x32_bf16 v[216:219], v[140:143], v[72:75], v[216:219]
    s_waitcnt vmcnt(12)
    s_barrier
    v_cvt_pk_bf16_f32 v234, v212, v213
    v_mfma_f32_16x16x32_bf16 v[220:223], v[128:131], v[52:55], v[220:223]
    v_cvt_pk_bf16_f32 v235, v214, v215
    ds_read_b128 v[112:115], v11 offset:0
    v_mfma_f32_16x16x32_bf16 v[220:223], v[132:135], v[60:63], v[220:223]
    buffer_store_dwordx4 v[232:235], v1, s[48:51], s10 offen offset:0 sc1
    v_mfma_f32_16x16x32_bf16 v[220:223], v[136:139], v[68:71], v[220:223]
    ds_read_b128 v[116:119], v11 offset:2048
    ds_read_b128 v[120:123], v11 offset:4096
    v_mfma_f32_16x16x32_bf16 v[220:223], v[140:143], v[76:79], v[220:223]
    ds_read_b128 v[124:127], v11 offset:6144
    v_cvt_pk_bf16_f32 v236, v216, v217
    v_mfma_f32_16x16x32_bf16 v[224:227], v[144:147], v[48:51], v[224:227]
    v_cvt_pk_bf16_f32 v237, v218, v219
    ds_read_b128 v[128:131], v11 offset:1024
    v_mfma_f32_16x16x32_bf16 v[224:227], v[148:151], v[56:59], v[224:227]
    ds_read_b128 v[132:135], v11 offset:3072
    v_mfma_f32_16x16x32_bf16 v[224:227], v[104:107], v[64:67], v[224:227]
    v_cvt_pk_bf16_f32 v238, v220, v221
    v_cvt_pk_bf16_f32 v239, v222, v223
    v_mfma_f32_16x16x32_bf16 v[224:227], v[108:111], v[72:75], v[224:227]
    buffer_store_dwordx4 v[236:239], v1, s[48:51], s10 offen offset:1024 sc1
    v_mfma_f32_16x16x32_bf16 v[228:231], v[144:147], v[52:55], v[228:231]
    ds_read_b128 v[136:139], v11 offset:5120
    ds_read_b128 v[140:143], v11 offset:7168
    v_mfma_f32_16x16x32_bf16 v[228:231], v[148:151], v[60:63], v[228:231]
    ds_read_b128 v[144:147], v11 offset:8192
    v_mfma_f32_16x16x32_bf16 v[228:231], v[104:107], v[68:71], v[228:231]
    ds_read_b128 v[148:151], v11 offset:10240
    v_cvt_pk_bf16_f32 v240, v224, v225
    v_mfma_f32_16x16x32_bf16 v[228:231], v[108:111], v[76:79], v[228:231]
    s_waitcnt lgkmcnt(4)
    v_cvt_pk_bf16_f32 v241, v226, v227
    ds_read_b128 v[104:107], v11 offset:12288
    v_mfma_f32_16x16x32_bf16 v[160:163], v[112:115], a[0:3], 0
    ds_read_b128 v[108:111], v11 offset:14336
    v_mfma_f32_16x16x32_bf16 v[160:163], v[116:119], a[8:11], v[160:163]
    v_mfma_f32_16x16x32_bf16 v[160:163], v[120:123], a[16:19], v[160:163]
    v_mfma_f32_16x16x32_bf16 v[160:163], v[124:127], a[24:27], v[160:163]
    v_mfma_f32_16x16x32_bf16 v[164:167], v[112:115], a[4:7], 0
    v_cvt_pk_bf16_f32 v242, v228, v229
    v_cvt_pk_bf16_f32 v243, v230, v231
    v_mfma_f32_16x16x32_bf16 v[164:167], v[116:119], a[12:15], v[164:167]
    buffer_store_dwordx4 v[240:243], v1, s[48:51], s11 offen offset:2048 sc1
    v_mfma_f32_16x16x32_bf16 v[164:167], v[120:123], a[20:23], v[164:167]
    ds_read_b128 v[112:115], v11 offset:9216
    ds_read_b128 v[116:119], v11 offset:11264
    v_mfma_f32_16x16x32_bf16 v[164:167], v[124:127], a[28:31], v[164:167]
    ds_read_b128 v[120:123], v11 offset:13312
    v_mfma_f32_16x16x32_bf16 v[168:171], v[128:131], a[0:3], 0
    ds_read_b128 v[124:127], v11 offset:15360
    v_mfma_f32_16x16x32_bf16 v[168:171], v[132:135], a[8:11], v[168:171]
    s_waitcnt lgkmcnt(4)
    v_mfma_f32_16x16x32_bf16 v[168:171], v[136:139], a[16:19], v[168:171]
    v_mfma_f32_16x16x32_bf16 v[168:171], v[140:143], a[24:27], v[168:171]
    v_mfma_f32_16x16x32_bf16 v[172:175], v[128:131], a[4:7], 0
    ds_read_b128 v[128:131], v11 offset:16384
    v_mfma_f32_16x16x32_bf16 v[172:175], v[132:135], a[12:15], v[172:175]
    ds_read_b128 v[132:135], v11 offset:18432
    v_mfma_f32_16x16x32_bf16 v[172:175], v[136:139], a[20:23], v[172:175]
    ds_read_b128 v[136:139], v11 offset:20480
    v_mfma_f32_16x16x32_bf16 v[172:175], v[140:143], a[28:31], v[172:175]
    ds_read_b128 v[140:143], v11 offset:22528
    v_mfma_f32_16x16x32_bf16 v[160:163], v[144:147], a[32:35], v[160:163]
    v_mfma_f32_16x16x32_bf16 v[160:163], v[148:151], a[40:43], v[160:163]
    v_mfma_f32_16x16x32_bf16 v[160:163], v[104:107], a[48:51], v[160:163]
    v_mfma_f32_16x16x32_bf16 v[160:163], v[108:111], a[56:59], v[160:163]
    v_mfma_f32_16x16x32_bf16 v[164:167], v[144:147], a[36:39], v[164:167]
    ds_read_b128 v[144:147], v11 offset:17408
    v_mfma_f32_16x16x32_bf16 v[164:167], v[148:151], a[44:47], v[164:167]
    ds_read_b128 v[148:151], v11 offset:19456
    v_mfma_f32_16x16x32_bf16 v[164:167], v[104:107], a[52:55], v[164:167]
    ds_read_b128 v[104:107], v11 offset:21504
    v_mfma_f32_16x16x32_bf16 v[164:167], v[108:111], a[60:63], v[164:167]
    s_waitcnt lgkmcnt(3)
    ds_read_b128 v[108:111], v11 offset:23552
    v_mfma_f32_16x16x32_bf16 v[168:171], v[112:115], a[32:35], v[168:171]
    v_mfma_f32_16x16x32_bf16 v[168:171], v[116:119], a[40:43], v[168:171]
    v_mfma_f32_16x16x32_bf16 v[168:171], v[120:123], a[48:51], v[168:171]
    v_mfma_f32_16x16x32_bf16 v[168:171], v[124:127], a[56:59], v[168:171]
    v_mfma_f32_16x16x32_bf16 v[172:175], v[112:115], a[36:39], v[172:175]
    ds_read_b128 v[112:115], v11 offset:24576
    v_mfma_f32_16x16x32_bf16 v[172:175], v[116:119], a[44:47], v[172:175]
    ds_read_b128 v[116:119], v11 offset:26624
    v_mfma_f32_16x16x32_bf16 v[172:175], v[120:123], a[52:55], v[172:175]
    ds_read_b128 v[120:123], v11 offset:28672
    v_mfma_f32_16x16x32_bf16 v[172:175], v[124:127], a[60:63], v[172:175]
    ds_read_b128 v[124:127], v11 offset:30720
    v_mfma_f32_16x16x32_bf16 v[160:163], v[128:131], a[64:67], v[160:163]
    v_mfma_f32_16x16x32_bf16 v[160:163], v[132:135], a[72:75], v[160:163]
    v_mfma_f32_16x16x32_bf16 v[160:163], v[136:139], a[80:83], v[160:163]
    v_mfma_f32_16x16x32_bf16 v[160:163], v[140:143], a[88:91], v[160:163]
    v_mfma_f32_16x16x32_bf16 v[164:167], v[128:131], a[68:71], v[164:167]
    ds_read_b128 v[128:131], v11 offset:25600
    v_mfma_f32_16x16x32_bf16 v[164:167], v[132:135], a[76:79], v[164:167]
    ds_read_b128 v[132:135], v11 offset:27648
    v_mfma_f32_16x16x32_bf16 v[164:167], v[136:139], a[84:87], v[164:167]
    ds_read_b128 v[136:139], v11 offset:29696
    v_mfma_f32_16x16x32_bf16 v[164:167], v[140:143], a[92:95], v[164:167]
    s_waitcnt lgkmcnt(3)
    ds_read_b128 v[140:143], v11 offset:31744
    v_mfma_f32_16x16x32_bf16 v[168:171], v[144:147], a[64:67], v[168:171]
    v_mfma_f32_16x16x32_bf16 v[168:171], v[148:151], a[72:75], v[168:171]
    v_mfma_f32_16x16x32_bf16 v[168:171], v[104:107], a[80:83], v[168:171]
    v_mfma_f32_16x16x32_bf16 v[168:171], v[108:111], a[88:91], v[168:171]
    v_mfma_f32_16x16x32_bf16 v[172:175], v[144:147], a[68:71], v[172:175]
    v_mfma_f32_16x16x32_bf16 v[172:175], v[148:151], a[76:79], v[172:175]
    v_mfma_f32_16x16x32_bf16 v[172:175], v[104:107], a[84:87], v[172:175]
    v_mfma_f32_16x16x32_bf16 v[172:175], v[108:111], a[92:95], v[172:175]
    v_mfma_f32_16x16x32_bf16 v[160:163], v[112:115], a[96:99], v[160:163]
    v_mfma_f32_16x16x32_bf16 v[160:163], v[116:119], a[104:107], v[160:163]
    v_mfma_f32_16x16x32_bf16 v[160:163], v[120:123], a[112:115], v[160:163]
    s_waitcnt vmcnt(0)
    buffer_store_dword v31, v23, s[32:35], s22 offen sc1
    v_mfma_f32_16x16x32_bf16 v[160:163], v[124:127], a[120:123], v[160:163]
    s_waitcnt vmcnt(6)
    s_barrier
    ds_read_b128 v[144:147], v11 offset:32768
    v_mfma_f32_16x16x32_bf16 v[164:167], v[112:115], a[100:103], v[164:167]
    ds_read_b128 v[148:151], v11 offset:34816
    ds_read_b128 v[104:107], v11 offset:36864
    v_mfma_f32_16x16x32_bf16 v[164:167], v[116:119], a[108:111], v[164:167]
    ds_read_b128 v[108:111], v11 offset:38912
    v_mfma_f32_16x16x32_bf16 v[164:167], v[120:123], a[116:119], v[164:167]
    ds_read_b128 v[112:115], v11 offset:33792
    v_mfma_f32_16x16x32_bf16 v[164:167], v[124:127], a[124:127], v[164:167]
    s_waitcnt lgkmcnt(5)
    ds_read_b128 v[116:119], v11 offset:35840
    v_mfma_f32_16x16x32_bf16 v[168:171], v[128:131], a[96:99], v[168:171]
    ds_read_b128 v[120:123], v11 offset:37888
    v_mfma_f32_16x16x32_bf16 v[168:171], v[132:135], a[104:107], v[168:171]
    ds_read_b128 v[124:127], v11 offset:39936
    v_mfma_f32_16x16x32_bf16 v[168:171], v[136:139], a[112:115], v[168:171]
    v_mfma_f32_16x16x32_bf16 v[168:171], v[140:143], a[120:123], v[168:171]
    v_mfma_f32_16x16x32_bf16 v[172:175], v[128:131], a[100:103], v[172:175]
    ds_read_b128 v[128:131], v11 offset:40960
    v_mfma_f32_16x16x32_bf16 v[172:175], v[132:135], a[108:111], v[172:175]
    ds_read_b128 v[132:135], v11 offset:43008
    v_mfma_f32_16x16x32_bf16 v[172:175], v[136:139], a[116:119], v[172:175]
    ds_read_b128 v[136:139], v11 offset:45056
    v_mfma_f32_16x16x32_bf16 v[172:175], v[140:143], a[124:127], v[172:175]
    s_waitcnt lgkmcnt(3)
    ds_read_b128 v[140:143], v11 offset:47104
    v_mfma_f32_16x16x32_bf16 v[160:163], v[144:147], a[128:131], v[160:163]
    v_mfma_f32_16x16x32_bf16 v[160:163], v[148:151], a[136:139], v[160:163]
    v_mfma_f32_16x16x32_bf16 v[160:163], v[104:107], a[144:147], v[160:163]
    v_mfma_f32_16x16x32_bf16 v[160:163], v[108:111], a[152:155], v[160:163]
    v_mfma_f32_16x16x32_bf16 v[164:167], v[144:147], a[132:135], v[164:167]
    ds_read_b128 v[144:147], v11 offset:41984
    v_mfma_f32_16x16x32_bf16 v[164:167], v[148:151], a[140:143], v[164:167]
    ds_read_b128 v[148:151], v11 offset:44032
    v_mfma_f32_16x16x32_bf16 v[164:167], v[104:107], a[148:151], v[164:167]
    ds_read_b128 v[104:107], v11 offset:46080
    v_mfma_f32_16x16x32_bf16 v[164:167], v[108:111], a[156:159], v[164:167]
    ds_read_b128 v[108:111], v11 offset:48128
    v_mfma_f32_16x16x32_bf16 v[168:171], v[112:115], a[128:131], v[168:171]
    v_mfma_f32_16x16x32_bf16 v[168:171], v[116:119], a[136:139], v[168:171]
    v_mfma_f32_16x16x32_bf16 v[168:171], v[120:123], a[144:147], v[168:171]
    v_mfma_f32_16x16x32_bf16 v[168:171], v[124:127], a[152:155], v[168:171]
    v_mfma_f32_16x16x32_bf16 v[172:175], v[112:115], a[132:135], v[172:175]
    ds_read_b128 v[112:115], v11 offset:49152
    v_mfma_f32_16x16x32_bf16 v[172:175], v[116:119], a[140:143], v[172:175]
    ds_read_b128 v[116:119], v11 offset:51200
    v_mfma_f32_16x16x32_bf16 v[172:175], v[120:123], a[148:151], v[172:175]
    ds_read_b128 v[120:123], v11 offset:53248
    v_mfma_f32_16x16x32_bf16 v[172:175], v[124:127], a[156:159], v[172:175]
    s_waitcnt lgkmcnt(3)
    ds_read_b128 v[124:127], v11 offset:55296
    v_mfma_f32_16x16x32_bf16 v[160:163], v[128:131], a[160:163], v[160:163]
    v_mfma_f32_16x16x32_bf16 v[160:163], v[132:135], a[168:171], v[160:163]
    v_mfma_f32_16x16x32_bf16 v[160:163], v[136:139], a[176:179], v[160:163]
    v_mfma_f32_16x16x32_bf16 v[160:163], v[140:143], a[184:187], v[160:163]
    v_mfma_f32_16x16x32_bf16 v[164:167], v[128:131], a[164:167], v[164:167]
    ds_read_b128 v[128:131], v11 offset:50176
    v_mfma_f32_16x16x32_bf16 v[164:167], v[132:135], a[172:175], v[164:167]
    buffer_load_dword v3, v19, s[32:35], s66 offen sc1
    v_mfma_f32_16x16x32_bf16 v[164:167], v[136:139], a[180:183], v[164:167]
    ds_read_b128 v[132:135], v11 offset:52224
    ds_read_b128 v[136:139], v11 offset:54272
    v_mfma_f32_16x16x32_bf16 v[164:167], v[140:143], a[188:191], v[164:167]
    ds_read_b128 v[140:143], v11 offset:56320
    v_mfma_f32_16x16x32_bf16 v[168:171], v[144:147], a[160:163], v[168:171]
    v_mfma_f32_16x16x32_bf16 v[168:171], v[148:151], a[168:171], v[168:171]
    v_mfma_f32_16x16x32_bf16 v[168:171], v[104:107], a[176:179], v[168:171]
    v_mfma_f32_16x16x32_bf16 v[168:171], v[108:111], a[184:187], v[168:171]
    v_mfma_f32_16x16x32_bf16 v[172:175], v[144:147], a[164:167], v[172:175]
    ds_read_b128 v[144:147], v11 offset:57344
    v_mfma_f32_16x16x32_bf16 v[172:175], v[148:151], a[172:175], v[172:175]
    ds_read_b128 v[148:151], v11 offset:59392
    v_mfma_f32_16x16x32_bf16 v[172:175], v[104:107], a[180:183], v[172:175]
    ds_read_b128 v[104:107], v11 offset:61440
    v_mfma_f32_16x16x32_bf16 v[172:175], v[108:111], a[188:191], v[172:175]
    s_waitcnt lgkmcnt(3)
    ds_read_b128 v[108:111], v11 offset:63488
    v_mfma_f32_16x16x32_bf16 v[160:163], v[112:115], a[192:195], v[160:163]
    v_mfma_f32_16x16x32_bf16 v[160:163], v[116:119], a[200:203], v[160:163]
    v_mfma_f32_16x16x32_bf16 v[160:163], v[120:123], a[208:211], v[160:163]
    v_mfma_f32_16x16x32_bf16 v[160:163], v[124:127], a[216:219], v[160:163]
    v_mfma_f32_16x16x32_bf16 v[164:167], v[112:115], a[196:199], v[164:167]
    ds_read_b128 v[112:115], v11 offset:58368
    v_mfma_f32_16x16x32_bf16 v[164:167], v[116:119], a[204:207], v[164:167]
    ds_read_b128 v[116:119], v11 offset:60416
    v_mfma_f32_16x16x32_bf16 v[164:167], v[120:123], a[212:215], v[164:167]
    ds_read_b128 v[120:123], v11 offset:62464
    v_mfma_f32_16x16x32_bf16 v[164:167], v[124:127], a[220:223], v[164:167]
    ds_read_b128 v[124:127], v11 offset:64512
    v_mfma_f32_16x16x32_bf16 v[168:171], v[128:131], a[192:195], v[168:171]
    v_mfma_f32_16x16x32_bf16 v[168:171], v[132:135], a[200:203], v[168:171]
    v_mfma_f32_16x16x32_bf16 v[168:171], v[136:139], a[208:211], v[168:171]
    v_mfma_f32_16x16x32_bf16 v[168:171], v[140:143], a[216:219], v[168:171]
    v_mfma_f32_16x16x32_bf16 v[172:175], v[128:131], a[196:199], v[172:175]
    ds_read_b128 v[128:131], v13 offset:12288
    v_mfma_f32_16x16x32_bf16 v[172:175], v[132:135], a[204:207], v[172:175]
    ds_read_b128 v[132:135], v13 offset:13312
    v_mfma_f32_16x16x32_bf16 v[172:175], v[136:139], a[212:215], v[172:175]
    ds_read_b128 v[136:139], v13 offset:14336
    v_mfma_f32_16x16x32_bf16 v[172:175], v[140:143], a[220:223], v[172:175]
    s_waitcnt lgkmcnt(3)
    ds_read_b128 v[140:143], v13 offset:16384
    v_mfma_f32_16x16x32_bf16 v[160:163], v[144:147], a[224:227], v[160:163]
    s_waitcnt vmcnt(0)
    v_cmp_gt_u32 vcc, 2, v3
    s_nop 1
    s_and_b64 vcc, vcc, exec
    s_cbranch_scc1 SPIN_X
BACK_X:
    v_mfma_f32_16x16x32_bf16 v[160:163], v[148:151], a[232:235], v[160:163]
    buffer_load_dwordx4 v[200:203], v1, s[48:51], s98 offen offset:2048 sc1
    v_mfma_f32_16x16x32_bf16 v[160:163], v[104:107], a[240:243], v[160:163]
    s_add_u32 s98, s70, 12288
    buffer_load_dwordx4 v[204:207], v1, s[48:51], s98 offen offset:2048 sc1
    v_mfma_f32_16x16x32_bf16 v[160:163], v[108:111], a[248:251], v[160:163]
    s_add_u32 s98, s70, 24576
    v_mfma_f32_16x16x32_bf16 v[164:167], v[144:147], a[228:231], v[164:167]
    ds_read_b128 v[144:147], v13 offset:17408
    v_mfma_f32_16x16x32_bf16 v[164:167], v[148:151], a[236:239], v[164:167]
    buffer_load_dwordx4 v[208:211], v1, s[48:51], s98 offen offset:2048 sc1
    v_mfma_f32_16x16x32_bf16 v[164:167], v[104:107], a[244:247], v[164:167]
    s_add_u32 s98, s23, 0
    ds_read_b128 v[148:151], v13 offset:18432
    ds_read_b128 v[104:107], v13 offset:20480
    v_mfma_f32_16x16x32_bf16 v[164:167], v[108:111], a[252:255], v[164:167]
    ds_read_b128 v[108:111], v13 offset:21504
    v_mfma_f32_16x16x32_bf16 v[168:171], v[112:115], a[224:227], v[168:171]
    v_mfma_f32_16x16x32_bf16 v[168:171], v[116:119], a[232:235], v[168:171]
    buffer_load_dwordx4 v[176:179], v1, s[48:51], s98 offen offset:0 sc1
    v_mfma_f32_16x16x32_bf16 v[168:171], v[120:123], a[240:243], v[168:171]
    s_add_u32 s98, s23, 12288
    v_mfma_f32_16x16x32_bf16 v[168:171], v[124:127], a[248:251], v[168:171]
    v_mfma_f32_16x16x32_bf16 v[172:175], v[112:115], a[228:231], v[172:175]
    ds_read_b128 v[112:115], v13 offset:22528
    v_mfma_f32_16x16x32_bf16 v[172:175], v[116:119], a[236:239], v[172:175]
    buffer_load_dwordx4 v[180:183], v1, s[48:51], s98 offen offset:0 sc1
    v_mfma_f32_16x16x32_bf16 v[172:175], v[120:123], a[244:247], v[172:175]
    s_add_u32 s98, s23, 24576
    ds_read_b128 v[116:119], v13 offset:24576
    ds_read_b128 v[120:123], v13 offset:25600
    v_mfma_f32_16x16x32_bf16 v[172:175], v[124:127], a[252:255], v[172:175]
    s_waitcnt lgkmcnt(3)
    ds_read_b128 v[124:127], v13 offset:26624
    v_mfma_f32_16x16x32_bf16 v[160:163], v[128:131], v[32:35], v[160:163]
    v_mfma_f32_16x16x32_bf16 v[160:163], v[132:135], v[40:43], v[160:163]
    buffer_load_dwordx4 v[184:187], v1, s[48:51], s98 offen offset:0 sc1
    v_mfma_f32_16x16x32_bf16 v[160:163], v[136:139], v[48:51], v[160:163]
    s_add_u32 s98, s23, 0
    v_mfma_f32_16x16x32_bf16 v[164:167], v[128:131], v[36:39], v[164:167]
    v_mfma_f32_16x16x32_bf16 v[164:167], v[132:135], v[44:47], v[164:167]
    v_mfma_f32_16x16x32_bf16 v[164:167], v[136:139], v[52:55], v[164:167]
    buffer_load_dwordx4 v[188:191], v1, s[48:51], s98 offen offset:1024 sc1
    v_mfma_f32_16x16x32_bf16 v[168:171], v[140:143], v[32:35], v[168:171]
    s_add_u32 s98, s23, 12288
    v_mfma_f32_16x16x32_bf16 v[168:171], v[144:147], v[40:43], v[168:171]
    v_mfma_f32_16x16x32_bf16 v[168:171], v[148:151], v[48:51], v[168:171]
    v_mfma_f32_16x16x32_bf16 v[172:175], v[140:143], v[36:39], v[172:175]
    buffer_load_dwordx4 v[192:195], v1, s[48:51], s98 offen offset:1024 sc1
    v_mfma_f32_16x16x32_bf16 v[172:175], v[144:147], v[44:47], v[172:175]
    s_add_u32 s98, s23, 24576
    v_mfma_f32_16x16x32_bf16 v[172:175], v[148:151], v[52:55], v[172:175]
    v_mfma_f32_16x16x32_bf16 v[160:163], v[104:107], v[56:59], v[160:163]
    v_mfma_f32_16x16x32_bf16 v[160:163], v[108:111], v[64:67], v[160:163]
    s_waitcnt lgkmcnt(0)
    buffer_load_dwordx4 v[196:199], v1, s[48:51], s98 offen offset:1024 sc1
    v_mfma_f32_16x16x32_bf16 v[160:163], v[112:115], v[72:75], v[160:163]
    v_mfma_f32_16x16x32_bf16 v[164:167], v[104:107], v[60:63], v[164:167]
    v_mfma_f32_16x16x32_bf16 v[164:167], v[108:111], v[68:71], v[164:167]
    v_mfma_f32_16x16x32_bf16 v[164:167], v[112:115], v[76:79], v[164:167]
    v_mfma_f32_16x16x32_bf16 v[168:171], v[116:119], v[56:59], v[168:171]
    v_mfma_f32_16x16x32_bf16 v[168:171], v[120:123], v[64:67], v[168:171]
    v_mfma_f32_16x16x32_bf16 v[168:171], v[124:127], v[72:75], v[168:171]
    v_mfma_f32_16x16x32_bf16 v[172:175], v[116:119], v[60:63], v[172:175]
    v_mfma_f32_16x16x32_bf16 v[172:175], v[120:123], v[68:71], v[172:175]
    v_mfma_f32_16x16x32_bf16 v[172:175], v[124:127], v[76:79], v[172:175]
    s_cmp_lg_u32 s4, s61
    s_cbranch_scc1 K1_X2
    s_waitcnt vmcnt(6)
    v_lshlrev_b32 v80, 16, v200
    v_and_b32 v81, 0xffff0000, v200
    v_lshlrev_b32 v82, 16, v204
    v_and_b32 v83, 0xffff0000, v204
    v_lshlrev_b32 v84, 16, v208
    v_and_b32 v85, 0xffff0000, v208
    v_pk_add_f32 v[80:81], v[80:81], v[82:83]
    v_pk_add_f32 v[224:225], v[224:225], v[84:85]
    v_pk_add_f32 v[224:225], v[224:225], v[80:81]
    v_cvt_pk_bf16_f32 v200, v224, v225
    v_lshlrev_b32 v86, 16, v201
    v_and_b32 v87, 0xffff0000, v201
    v_lshlrev_b32 v88, 16, v205
    v_and_b32 v89, 0xffff0000, v205
    v_lshlrev_b32 v90, 16, v209
    v_and_b32 v91, 0xffff0000, v209
    v_pk_add_f32 v[86:87], v[86:87], v[88:89]
    v_pk_add_f32 v[226:227], v[226:227], v[90:91]
    v_pk_add_f32 v[226:227], v[226:227], v[86:87]
    v_cvt_pk_bf16_f32 v201, v226, v227
    buffer_store_dwordx2 v[200:201], v20, s[24:27], s65 offen
    v_lshlrev_b32 v92, 16, v202
    v_and_b32 v93, 0xffff0000, v202
    v_lshlrev_b32 v94, 16, v206
    v_and_b32 v95, 0xffff0000, v206
    v_lshlrev_b32 v96, 16, v210
    v_and_b32 v97, 0xffff0000, v210
    v_pk_add_f32 v[92:93], v[92:93], v[94:95]
    v_pk_add_f32 v[228:229], v[228:229], v[96:97]
    v_pk_add_f32 v[228:229], v[228:229], v[92:93]
    v_cvt_pk_bf16_f32 v202, v228, v229
    v_lshlrev_b32 v98, 16, v203
    v_and_b32 v99, 0xffff0000, v203
    v_lshlrev_b32 v100, 16, v207
    v_and_b32 v101, 0xffff0000, v207
    v_lshlrev_b32 v102, 16, v211
    v_and_b32 v103, 0xffff0000, v211
    v_pk_add_f32 v[98:99], v[98:99], v[100:101]
    v_pk_add_f32 v[230:231], v[230:231], v[102:103]
    v_pk_add_f32 v[230:231], v[230:231], v[98:99]
    v_cvt_pk_bf16_f32 v203, v230, v231
    buffer_store_dwordx2 v[202:203], v21, s[24:27], s65 offen
    s_waitcnt vmcnt(2)
K1_X2:
    s_waitcnt vmcnt(3)
    v_lshlrev_b32 v80, 16, v176
    v_and_b32 v81, 0xffff0000, v176
    v_lshlrev_b32 v82, 16, v180
    v_and_b32 v83, 0xffff0000, v180
    v_lshlrev_b32 v84, 16, v184
    v_and_b32 v85, 0xffff0000, v184
    v_pk_add_f32 v[80:81], v[80:81], v[82:83]
    v_pk_add_f32 v[160:161], v[160:161], v[84:85]
    v_pk_add_f32 v[160:161], v[160:161], v[80:81]
    v_cvt_pk_bf16_f32 v176, v160, v161
    v_lshlrev_b32 v86, 16, v177
    v_and_b32 v87, 0xffff0000, v177
    v_lshlrev_b32 v88, 16, v181
    v_and_b32 v89, 0xffff0000, v181
    v_lshlrev_b32 v90, 16, v185
    v_and_b32 v91, 0xffff0000, v185
    v_pk_add_f32 v[86:87], v[86:87], v[88:89]
    v_pk_add_f32 v[162:163], v[162:163], v[90:91]
    v_pk_add_f32 v[162:163], v[162:163], v[86:87]
    v_cvt_pk_bf16_f32 v177, v162, v163
    buffer_store_dwordx2 v[176:177], v20, s[24:27], s64 offen
    v_lshlrev_b32 v92, 16, v178
    v_and_b32 v93, 0xffff0000, v178
    v_lshlrev_b32 v94, 16, v182
    v_and_b32 v95, 0xffff0000, v182
    v_lshlrev_b32 v96, 16, v186
    v_and_b32 v97, 0xffff0000, v186
    v_pk_add_f32 v[92:93], v[92:93], v[94:95]
    v_pk_add_f32 v[164:165], v[164:165], v[96:97]
    v_pk_add_f32 v[164:165], v[164:165], v[92:93]
    v_cvt_pk_bf16_f32 v178, v164, v165
    v_lshlrev_b32 v98, 16, v179
    v_and_b32 v99, 0xffff0000, v179
    v_lshlrev_b32 v100, 16, v183
    v_and_b32 v101, 0xffff0000, v183
    v_lshlrev_b32 v102, 16, v187
    v_and_b32 v103, 0xffff0000, v187
    v_pk_add_f32 v[98:99], v[98:99], v[100:101]
    v_pk_add_f32 v[166:167], v[166:167], v[102:103]
    v_pk_add_f32 v[166:167], v[166:167], v[98:99]
    v_cvt_pk_bf16_f32 v179, v166, v167
    buffer_store_dwordx2 v[178:179], v21, s[24:27], s64 offen
    s_waitcnt vmcnt(2)
    v_lshlrev_b32 v80, 16, v188
    v_and_b32 v81, 0xffff0000, v188
    v_lshlrev_b32 v82, 16, v192
    v_and_b32 v83, 0xffff0000, v192
    v_lshlrev_b32 v84, 16, v196
    v_and_b32 v85, 0xffff0000, v196
    v_pk_add_f32 v[80:81], v[80:81], v[82:83]
    v_pk_add_f32 v[168:169], v[168:169], v[84:85]
    v_pk_add_f32 v[168:169], v[168:169], v[80:81]
    v_cvt_pk_bf16_f32 v188, v168, v169
    v_lshlrev_b32 v86, 16, v189
    v_and_b32 v87, 0xffff0000, v189
    v_lshlrev_b32 v88, 16, v193
    v_and_b32 v89, 0xffff0000, v193
    v_lshlrev_b32 v90, 16, v197
    v_and_b32 v91, 0xffff0000, v197
    v_pk_add_f32 v[86:87], v[86:87], v[88:89]
    v_pk_add_f32 v[170:171], v[170:171], v[90:91]
    v_pk_add_f32 v[170:171], v[170:171], v[86:87]
    v_cvt_pk_bf16_f32 v189, v170, v171
    buffer_store_dwordx2 v[188:189], v20, s[24:27], s64 offen offset:32
    v_lshlrev_b32 v92, 16, v190
    v_and_b32 v93, 0xffff0000, v190
    v_lshlrev_b32 v94, 16, v194
    v_and_b32 v95, 0xffff0000, v194
    v_lshlrev_b32 v96, 16, v198
    v_and_b32 v97, 0xffff0000, v198
    v_pk_add_f32 v[92:93], v[92:93], v[94:95]
    v_pk_add_f32 v[172:173], v[172:173], v[96:97]
    v_pk_add_f32 v[172:173], v[172:173], v[92:93]
    v_cvt_pk_bf16_f32 v190, v172, v173
    v_lshlrev_b32 v98, 16, v191
    v_and_b32 v99, 0xffff0000, v191
    v_lshlrev_b32 v100, 16, v195
    v_and_b32 v101, 0xffff0000, v195
    v_lshlrev_b32 v102, 16, v199
    v_and_b32 v103, 0xffff0000, v199
    v_pk_add_f32 v[98:99], v[98:99], v[100:101]
    v_pk_add_f32 v[174:175], v[174:175], v[102:103]
    v_pk_add_f32 v[174:175], v[174:175], v[98:99]
    v_cvt_pk_bf16_f32 v191, v174, v175
    buffer_store_dwordx2 v[190:191], v21, s[24:27], s64 offen offset:32
K1_END:
    s_endpgm
K1_LB_MASK:
    s_nop 1
    v_add_f32 v212, s12, v144
    v_fma_f32 v176, v208, s8, v212
    v_fma_f32 v177, v209, s8, v212
    v_fma_f32 v178, v210, s8, v212
    v_fma_f32 v179, v211, s8, v212
    v_add_f32 v213, s13, v144
    v_fma_f32 v180, v208, s9, v213
    v_fma_f32 v181, v209, s9, v213
    v_fma_f32 v182, v210, s9, v213
    v_fma_f32 v183, v211, s9, v213
    v_add_f32 v214, s14, v144
    v_fma_f32 v184, v208, s10, v214
    v_fma_f32 v185, v209, s10, v214
    v_fma_f32 v186, v210, s10, v214
    v_fma_f32 v187, v211, s10, v214
    v_add_f32 v215, s15, v144
    v_fma_f32 v188, v208, s11, v215
    v_fma_f32 v189, v209, s11, v215
    v_fma_f32 v190, v210, s11, v215
    v_fma_f32 v191, v211, s11, v215
    s_nop 1
    s_branch K1_LB_BACK
K1_LS_MASK:
    s_nop 1
    v_add_f32 v212, s12, v152
    v_fma_f32 v176, v208, s8, v212
    v_fma_f32 v177, v209, s8, v212
    v_fma_f32 v178, v210, s8, v212
    v_fma_f32 v179, v211, s8, v212
    v_add_f32 v213, s13, v152
    v_fma_f32 v180, v208, s9, v213
    v_fma_f32 v181, v209, s9, v213
    v_fma_f32 v182, v210, s9, v213
    v_fma_f32 v183, v211, s9, v213
    v_add_f32 v214, s14, v152
    v_fma_f32 v184, v208, s10, v214
    v_fma_f32 v185, v209, s10, v214
    v_fma_f32 v186, v210, s10, v214
    v_fma_f32 v187, v211, s10, v214
    v_add_f32 v215, s15, v152
    v_fma_f32 v188, v208, s11, v215
    v_fma_f32 v189, v209, s11, v215
    v_fma_f32 v190, v210, s11, v215
    v_fma_f32 v191, v211, s11, v215
    s_nop 1
    s_branch K1_LS_BACK
K1_REDO:
    s_mov_b32 s83, 1
    s_mov_b32 s63, 1073741824
    s_mov_b32 s64, 1073741824
    s_mov_b32 s50, 0
    s_mov_b32 s54, 0
    s_waitcnt vmcnt(0) lgkmcnt(0)
    s_barrier
    v_lshrrev_b32 v92, 4, v1
    v_and_b32 v64, 15, v92
    v_lshrrev_b32 v92, 4, v92
    v_lshlrev_b32 v92, 2, v92
    v_sub_u32 v92, v64, v92
    s_lshl_b32 s98, s4, 4
    v_add_u32 v92, s98, v92
    s_lshl_b32 s98, s6, 7
    s_sub_u32 s99, 1920, s98
    v_add_u32 v64, s98, v92
    v_add_u32 v65, 64, v64
    v_add_u32 v66, s99, v92
    v_add_u32 v67, 64, v66
    v_mov_b32 v93, 0xf149f2ca
    v_mov_b32 v68, v93
    v_mov_b32 v69, v93
    v_mov_b32 v70, v93
    v_mov_b32 v71, v93
    s_mov_b32 s78, 0
    s_add_u32 s99, s99, 128
K1_REDO_L:
    s_lshr_b32 s7, s78, 6
    s_lshl_b32 s7, s7, 15
    s_bfe_u32 s98, s78, 0x20004
    s_lshl_b32 s98, s98, 12
    s_add_u32 s7, s7, s98
    buffer_load_dwordx4 v[72:75], v1, s[36:39], s7 offen offset:0 sc1
    buffer_load_dwordx4 v[76:79], v1, s[36:39], s7 offen offset:1024 sc1
    buffer_load_dwordx4 v[80:83], v1, s[36:39], s7 offen offset:2048 sc1
    buffer_load_dwordx4 v[84:87], v1, s[36:39], s7 offen offset:3072 sc1
    s_waitcnt vmcnt(0)
    v_mfma_f32_16x16x32_bf16 v[88:91], v[72:75], v[128:131], 0
    v_mfma_f32_16x16x32_bf16 v[88:91], v[76:79], v[160:163], v[88:91]
    v_mfma_f32_16x16x32_bf16 v[88:91], v[80:83], v[192:195], v[88:91]
    v_mfma_f32_16x16x32_bf16 v[88:91], v[84:87], v[224:227], v[88:91]
    v_subrev_u32 v92, s78, v64
    v_cmp_le_i32 vcc, 0, v92
    s_nop 5
    v_cndmask_b32 v88, v93, v88, vcc
    v_max_f32 v68, v68, v88
    v_cmp_le_i32 vcc, 1, v92
    s_nop 1
    v_cndmask_b32 v89, v93, v89, vcc
    v_max_f32 v68, v68, v89
    v_cmp_le_i32 vcc, 2, v92
    s_nop 1
    v_cndmask_b32 v90, v93, v90, vcc
    v_max_f32 v68, v68, v90
    v_cmp_le_i32 vcc, 3, v92
    s_nop 1
    v_cndmask_b32 v91, v93, v91, vcc
    v_max_f32 v68, v68, v91
    v_mfma_f32_16x16x32_bf16 v[88:91], v[72:75], v[132:135], 0
    v_mfma_f32_16x16x32_bf16 v[88:91], v[76:79], v[164:167], v[88:91]
    v_mfma_f32_16x16x32_bf16 v[88:91], v[80:83], v[196:199], v[88:91]
    v_mfma_f32_16x16x32_bf16 v[88:91], v[84:87], v[228:231], v[88:91]
    v_subrev_u32 v92, s78, v65
    v_cmp_le_i32 vcc, 0, v92
    s_nop 5
    v_cndmask_b32 v88, v93, v88, vcc
    v_max_f32 v69, v69, v88
    v_cmp_le_i32 vcc, 1, v92
    s_nop 1
    v_cndmask_b32 v89, v93, v89, vcc
    v_max_f32 v69, v69, v89
    v_cmp_le_i32 vcc, 2, v92
    s_nop 1
    v_cndmask_b32 v90, v93, v90, vcc
    v_max_f32 v69, v69, v90
    v_cmp_le_i32 vcc, 3, v92
    s_nop 1
    v_cndmask_b32 v91, v93, v91, vcc
    v_max_f32 v69, v69, v91
    v_mfma_f32_16x16x32_bf16 v[88:91], v[72:75], v[136:139], 0
    v_mfma_f32_16x16x32_bf16 v[88:91], v[76:79], v[168:171], v[88:91]
    v_mfma_f32_16x16x32_bf16 v[88:91], v[80:83], v[200:203], v[88:91]
    v_mfma_f32_16x16x32_bf16 v[88:91], v[84:87], v[232:235], v[88:91]
    v_subrev_u32 v92, s78, v66
    v_cmp_le_i32 vcc, 0, v92
    s_nop 5
    v_cndmask_b32 v88, v93, v88, vcc
    v_max_f32 v70, v70, v88
    v_cmp_le_i32 vcc, 1, v92
    s_nop 1
    v_cndmask_b32 v89, v93, v89, vcc
    v_max_f32 v70, v70, v89
    v_cmp_le_i32 vcc, 2, v92
    s_nop 1
    v_cndmask_b32 v90, v93, v90, vcc
    v_max_f32 v70, v70, v90
    v_cmp_le_i32 vcc, 3, v92
    s_nop 1
    v_cndmask_b32 v91, v93, v91, vcc
    v_max_f32 v70, v70, v91
    v_mfma_f32_16x16x32_bf16 v[88:91], v[72:75], v[140:143], 0
    v_mfma_f32_16x16x32_bf16 v[88:91], v[76:79], v[172:175], v[88:91]
    v_mfma_f32_16x16x32_bf16 v[88:91], v[80:83], v[204:207], v[88:91]
    v_mfma_f32_16x16x32_bf16 v[88:91], v[84:87], v[236:239], v[88:91]
    v_subrev_u32 v92, s78, v67
    v_cmp_le_i32 vcc, 0, v92
    s_nop 5
    v_cndmask_b32 v88, v93, v88, vcc
    v_max_f32 v71, v71, v88
    v_cmp_le_i32 vcc, 1, v92
    s_nop 1
    v_cndmask_b32 v89, v93, v89, vcc
    v_max_f32 v71, v71, v89
    v_cmp_le_i32 vcc, 2, v92
    s_nop 1
    v_cndmask_b32 v90, v93, v90, vcc
    v_max_f32 v71, v71, v90
    v_cmp_le_i32 vcc, 3, v92
    s_nop 1
    v_cndmask_b32 v91, v93, v91, vcc
    v_max_f32 v71, v71, v91
    s_add_u32 s78, s78, 16
    s_cmp_lt_u32 s78, s99
    s_cbranch_scc1 K1_REDO_L
    v_mov_b32 v92, v68
    s_nop 1
    v_permlane32_swap_b32 v68, v92
    v_max_f32 v68, v68, v92
    v_mov_b32 v92, v68
    s_nop 1
    v_permlane16_swap_b32 v68, v92
    v_max_f32 v68, v68, v92
    v_sub_f32 v144, 0, v68
    v_sub_f32 v145, 0, v68
    v_sub_f32 v146, 0, v68
    v_sub_f32 v147, 0, v68
    v_mov_b32 v92, v69
    s_nop 1
    v_permlane32_swap_b32 v69, v92
    v_max_f32 v69, v69, v92
    v_mov_b32 v92, v69
    s_nop 1
    v_permlane16_swap_b32 v69, v92
    v_max_f32 v69, v69, v92
    v_sub_f32 v148, 0, v69
    v_sub_f32 v149, 0, v69
    v_sub_f32 v150, 0, v69
    v_sub_f32 v151, 0, v69
    v_mov_b32 v92, v70
    s_nop 1
    v_permlane32_swap_b32 v70, v92
    v_max_f32 v70, v70, v92
    v_mov_b32 v92, v70
    s_nop 1
    v_permlane16_swap_b32 v70, v92
    v_max_f32 v70, v70, v92
    v_sub_f32 v152, 0, v70
    v_sub_f32 v153, 0, v70
    v_sub_f32 v154, 0, v70
    v_sub_f32 v155, 0, v70
    v_mov_b32 v92, v71
    s_nop 1
    v_permlane32_swap_b32 v71, v92
    v_max_f32 v71, v71, v92
    v_mov_b32 v92, v71
    s_nop 1
    v_permlane16_swap_b32 v71, v92
    v_max_f32 v71, v71, v92
    v_sub_f32 v156, 0, v71
    v_sub_f32 v157, 0, v71
    v_sub_f32 v158, 0, v71
    v_sub_f32 v159, 0, v71
    v_accvgpr_write_b32 a0, 0
    v_accvgpr_write_b32 a1, 0
    v_accvgpr_write_b32 a2, 0
    v_accvgpr_write_b32 a3, 0
    v_accvgpr_write_b32 a4, 0
    v_accvgpr_write_b32 a5, 0
    v_accvgpr_write_b32 a6, 0
    v_accvgpr_write_b32 a7, 0
    v_accvgpr_write_b32 a8, 0
    v_accvgpr_write_b32 a9, 0
    v_accvgpr_write_b32 a10, 0
    v_accvgpr_write_b32 a11, 0
    v_accvgpr_write_b32 a12, 0
    v_accvgpr_write_b32 a13, 0
    v_accvgpr_write_b32 a14, 0
    v_accvgpr_write_b32 a15, 0
    v_accvgpr_write_b32 a16, 0
    v_accvgpr_write_b32 a17, 0
    v_accvgpr_write_b32 a18, 0
    v_accvgpr_write_b32 a19, 0
    v_accvgpr_write_b32 a20, 0
    v_accvgpr_write_b32 a21, 0
    v_accvgpr_write_b32 a22, 0
    v_accvgpr_write_b32 a23, 0
    v_accvgpr_write_b32 a24, 0
    v_accvgpr_write_b32 a25, 0
    v_accvgpr_write_b32 a26, 0
    v_accvgpr_write_b32 a27, 0
    v_accvgpr_write_b32 a28, 0
    v_accvgpr_write_b32 a29, 0
    v_accvgpr_write_b32 a30, 0
    v_accvgpr_write_b32 a31, 0
    v_accvgpr_write_b32 a32, 0
    v_accvgpr_write_b32 a33, 0
    v_accvgpr_write_b32 a34, 0
    v_accvgpr_write_b32 a35, 0
    v_accvgpr_write_b32 a36, 0
    v_accvgpr_write_b32 a37, 0
    v_accvgpr_write_b32 a38, 0
    v_accvgpr_write_b32 a39, 0
    v_accvgpr_write_b32 a40, 0
    v_accvgpr_write_b32 a41, 0
    v_accvgpr_write_b32 a42, 0
    v_accvgpr_write_b32 a43, 0
    v_accvgpr_write_b32 a44, 0
    v_accvgpr_write_b32 a45, 0
    v_accvgpr_write_b32 a46, 0
    v_accvgpr_write_b32 a47, 0
    v_accvgpr_write_b32 a48, 0
    v_accvgpr_write_b32 a49, 0
    v_accvgpr_write_b32 a50, 0
    v_accvgpr_write_b32 a51, 0
    v_accvgpr_write_b32 a52, 0
    v_accvgpr_write_b32 a53, 0
    v_accvgpr_write_b32 a54, 0
    v_accvgpr_write_b32 a55, 0
    v_accvgpr_write_b32 a56, 0
    v_accvgpr_write_b32 a57, 0
    v_accvgpr_write_b32 a58, 0
    v_accvgpr_write_b32 a59, 0
    v_accvgpr_write_b32 a60, 0
    v_accvgpr_write_b32 a61, 0
    v_accvgpr_write_b32 a62, 0
    v_accvgpr_write_b32 a63, 0
    v_accvgpr_write_b32 a144, 0
    v_accvgpr_write_b32 a145, 0
    v_accvgpr_write_b32 a146, 0
    v_accvgpr_write_b32 a147, 0
    v_accvgpr_write_b32 a148, 0
    v_accvgpr_write_b32 a149, 0
    v_accvgpr_write_b32 a150, 0
    v_accvgpr_write_b32 a151, 0
    v_accvgpr_write_b32 a152, 0
    v_accvgpr_write_b32 a153, 0
    v_accvgpr_write_b32 a154, 0
    v_accvgpr_write_b32 a155, 0
    v_accvgpr_write_b32 a156, 0
    v_accvgpr_write_b32 a157, 0
    v_accvgpr_write_b32 a158, 0
    v_accvgpr_write_b32 a159, 0
    v_accvgpr_write_b32 a160, 0
    v_accvgpr_write_b32 a161, 0
    v_accvgpr_write_b32 a162, 0
    v_accvgpr_write_b32 a163, 0
    v_accvgpr_write_b32 a164, 0
    v_accvgpr_write_b32 a165, 0
    v_accvgpr_write_b32 a166, 0
    v_accvgpr_write_b32 a167, 0
    v_accvgpr_write_b32 a168, 0
    v_accvgpr_write_b32 a169, 0
    v_accvgpr_write_b32 a170, 0
    v_accvgpr_write_b32 a171, 0
    v_accvgpr_write_b32 a172, 0
    v_accvgpr_write_b32 a173, 0
    v_accvgpr_write_b32 a174, 0
    v_accvgpr_write_b32 a175, 0
    v_accvgpr_write_b32 a176, 0
    v_accvgpr_write_b32 a177, 0
    v_accvgpr_write_b32 a178, 0
    v_accvgpr_write_b32 a179, 0
    v_accvgpr_write_b32 a180, 0
    v_accvgpr_write_b32 a181, 0
    v_accvgpr_write_b32 a182, 0
    v_accvgpr_write_b32 a183, 0
    v_accvgpr_write_b32 a184, 0
    v_accvgpr_write_b32 a185, 0
    v_accvgpr_write_b32 a186, 0
    v_accvgpr_write_b32 a187, 0
    v_accvgpr_write_b32 a188, 0
    v_accvgpr_write_b32 a189, 0
    v_accvgpr_write_b32 a190, 0
    v_accvgpr_write_b32 a191, 0
    v_accvgpr_write_b32 a192, 0
    v_accvgpr_write_b32 a193, 0
    v_accvgpr_write_b32 a194, 0
    v_accvgpr_write_b32 a195, 0
    v_accvgpr_write_b32 a196, 0
    v_accvgpr_write_b32 a197, 0
    v_accvgpr_write_b32 a198, 0
    v_accvgpr_write_b32 a199, 0
    v_accvgpr_write_b32 a200, 0
    v_accvgpr_write_b32 a201, 0
    v_accvgpr_write_b32 a202, 0
    v_accvgpr_write_b32 a203, 0
    v_accvgpr_write_b32 a204, 0
    v_accvgpr_write_b32 a205, 0
    v_accvgpr_write_b32 a206, 0
    v_accvgpr_write_b32 a207, 0
    v_accvgpr_write_b32 a208, 0
    v_accvgpr_write_b32 a209, 0
    v_accvgpr_write_b32 a210, 0
    v_accvgpr_write_b32 a211, 0
    v_accvgpr_write_b32 a212, 0
    v_accvgpr_write_b32 a213, 0
    v_accvgpr_write_b32 a214, 0
    v_accvgpr_write_b32 a215, 0
    v_accvgpr_write_b32 a216, 0
    v_accvgpr_write_b32 a217, 0
    v_accvgpr_write_b32 a218, 0
    v_accvgpr_write_b32 a219, 0
    v_accvgpr_write_b32 a220, 0
    v_accvgpr_write_b32 a221, 0
    v_accvgpr_write_b32 a222, 0
    v_accvgpr_write_b32 a223, 0
    v_bfe_u32 v92, v1, 4, 2
    v_cmp_eq_u32 vcc, 0, v92
    v_mov_b32 v92, 0x3f803f80
    s_nop 0
    v_cndmask_b32 v92, 0, v92, vcc
    v_accvgpr_write_b32 a136, v92
    v_accvgpr_write_b32 a137, v92
    v_accvgpr_write_b32 a138, v92
    v_accvgpr_write_b32 a139, v92
    s_mov_b32 s77, s75
    s_mov_b32 s76, 0
    s_mov_b32 s38, 16384
    s_add_u32 m0, s76, s75
    s_nop 0
    buffer_load_dwordx4 v1, s[36:39], s77 offen sc1 lds
    buffer_load_dwordx4 v1, s[36:39], s77 offen offset:1024 sc1 lds
    buffer_load_dwordx4 v1, s[36:39], s77 offen offset:2048 sc1 lds
    buffer_load_dwordx4 v1, s[36:39], s77 offen offset:3072 sc1 lds
    s_add_u32 s100, s77, 4096
    s_add_u32 m0, m0, 4096
    s_nop 0
    buffer_load_dwordx4 v1, s[36:39], s100 offen sc1 lds
    buffer_load_dwordx4 v1, s[36:39], s100 offen offset:1024 sc1 lds
    buffer_load_dwordx4 v1, s[36:39], s100 offen offset:2048 sc1 lds
    buffer_load_dwordx4 v1, s[36:39], s100 offen offset:3072 sc1 lds
    s_add_u32 s77, s77, 32768
    s_add_u32 s76, s76, 32768
    s_lshr_b32 s82, s4, 1
    s_add_u32 s82, s82, 32
    s_sub_u32 s82, s82, s6
    s_sub_u32 s82, s82, s6
    s_lshl_b32 s38, s82, 15
    s_add_u32 m0, s76, s75
    s_nop 0
    buffer_load_dwordx4 v1, s[36:39], s77 offen sc1 lds
    buffer_load_dwordx4 v1, s[36:39], s77 offen offset:1024 sc1 lds
    buffer_load_dwordx4 v1, s[36:39], s77 offen offset:2048 sc1 lds
    buffer_load_dwordx4 v1, s[36:39], s77 offen offset:3072 sc1 lds
    s_add_u32 s100, s77, 4096
    s_add_u32 m0, m0, 4096
    s_nop 0
    buffer_load_dwordx4 v1, s[36:39], s100 offen sc1 lds
    buffer_load_dwordx4 v1, s[36:39], s100 offen offset:1024 sc1 lds
    buffer_load_dwordx4 v1, s[36:39], s100 offen offset:2048 sc1 lds
    buffer_load_dwordx4 v1, s[36:39], s100 offen offset:3072 sc1 lds
    s_add_u32 s77, s77, 32768
    s_add_u32 s76, s76, 32768
    s_add_u32 m0, s76, s75
    s_nop 0
    buffer_load_dwordx4 v1, s[36:39], s77 offen sc1 lds
    buffer_load_dwordx4 v1, s[36:39], s77 offen offset:1024 sc1 lds
    buffer_load_dwordx4 v1, s[36:39], s77 offen offset:2048 sc1 lds
    buffer_load_dwordx4 v1, s[36:39], s77 offen offset:3072 sc1 lds
    s_add_u32 s100, s77, 4096
    s_add_u32 m0, m0, 4096
    s_nop 0
    buffer_load_dwordx4 v1, s[36:39], s100 offen sc1 lds
    buffer_load_dwordx4 v1, s[36:39], s100 offen offset:1024 sc1 lds
    buffer_load_dwordx4 v1, s[36:39], s100 offen offset:2048 sc1 lds
    buffer_load_dwordx4 v1, s[36:39], s100 offen offset:3072 sc1 lds
    s_add_u32 s77, s77, 32768
    s_add_u32 s76, s76, 32768
    s_mov_b32 s82, 0
    s_mov_b32 s60, 131072
    v_mov_b32 v2, v1
    s_cmp_eq_u32 s6, 0
    s_cselect_b32 s16, s8, 0
    s_cselect_b32 s17, s9, 0
    s_cmp_eq_u32 s6, 0
    s_cselect_b32 s18, s10, 0
    s_cselect_b32 s19, s11, 0
    s_cmp_eq_u32 s6, 0
    s_cselect_b32 s20, s12, 0
    s_cselect_b32 s21, s13, 0
    s_cmp_eq_u32 s6, 0
    s_cselect_b32 s22, s14, 0
    s_cselect_b32 s23, s15, 0
    s_waitcnt vmcnt(16)
    s_barrier
    ds_read_b128 a[224:227], v2 offset:0
    ds_read_b128 a[228:231], v2 offset:1024
    ds_read_b128 a[232:235], v2 offset:2048
    ds_read_b128 a[236:239], v2 offset:3072
    s_waitcnt lgkmcnt(0)
    s_branch K1_ATT
SPIN_WA:
    s_mov_b32 s94, 0
SPIN_WA_L:
    s_sleep 2
    buffer_load_dword v7, v9, s[44:47], s69 offen sc1
    s_add_u32 s94, s94, 1
    s_cmp_ge_u32 s94, 0x40000
    s_waitcnt vmcnt(0)
    s_cbranch_scc1 BACK_WA
    v_cmp_gt_u32 vcc, 8, v7
    s_nop 1
    s_and_b64 vcc, vcc, s[86:87]
    s_cbranch_scc1 SPIN_WA_L
    s_branch BACK_WA
SPIN_KV:
    s_mov_b32 s94, 0
SPIN_KV_L:
    s_sleep 2
    buffer_load_dword v7, v8, s[32:35], s61 offen sc1
    s_add_u32 s94, s94, 1
    s_cmp_ge_u32 s94, 0x40000
    s_waitcnt vmcnt(0)
    s_cbranch_scc1 BACK_KV
    v_cmp_gt_u32 vcc, 1, v7
    s_nop 1
    s_and_b64 vcc, vcc, exec
    s_cbranch_scc1 SPIN_KV_L
    s_branch BACK_KV
SPIN_ALL:
    s_mov_b32 s94, 0
SPIN_ALL_L:
    s_sleep 2
    buffer_load_dword v3, v29, s[32:35], s92 offen sc1
    s_add_u32 s94, s94, 1
    s_cmp_ge_u32 s94, 0x40000
    s_waitcnt vmcnt(0)
    s_cbranch_scc1 BACK_ALL
    v_cmp_gt_u32 vcc, 1, v3
    s_nop 1
    s_and_b64 vcc, vcc, exec
    s_cbranch_scc1 SPIN_ALL_L
    s_branch BACK_ALL
SPIN_CTX:
    s_mov_b32 s94, 0
SPIN_CTX_L:
    s_sleep 2
    buffer_load_dword v3, v19, s[32:35], s66 offen sc1
    s_add_u32 s94, s94, 1
    s_cmp_ge_u32 s94, 0x40000
    s_waitcnt vmcnt(0)
    s_cbranch_scc1 BACK_CTX
    v_cmp_gt_u32 vcc, 2, v3
    s_nop 1
    s_and_b64 vcc, vcc, exec
    s_cbranch_scc1 SPIN_CTX_L
    s_branch BACK_CTX
SPIN_OA:
    s_mov_b32 s94, 0
SPIN_OA_L:
    s_sleep 2
    buffer_load_dword v3, v19, s[32:35], s66 offen sc1
    s_add_u32 s94, s94, 1
    s_cmp_ge_u32 s94, 0x40000
    s_waitcnt vmcnt(0)
    s_cbranch_scc1 BACK_OA
    v_cmp_gt_u32 vcc, 3, v3
    s_nop 1
    s_and_b64 vcc, vcc, exec
    s_cbranch_scc1 SPIN_OA_L
    s_branch BACK_OA
SPIN_X:
    s_mov_b32 s94, 0
SPIN_X_L:
    s_sleep 2
    buffer_load_dword v3, v19, s[32:35], s66 offen sc1
    s_add_u32 s94, s94, 1
    s_cmp_ge_u32 s94, 0x40000
    s_waitcnt vmcnt(0)
    s_cbranch_scc1 BACK_X
    v_cmp_gt_u32 vcc, 2, v3
    s_nop 1
    s_and_b64 vcc, vcc, exec
    s_cbranch_scc1 SPIN_X_L
    s_branch BACK_X
.section .rodata,"a"
.p2align 6
.amdhsa_kernel gated_mix__sliding_local_dilated__compressed_kv_cla__prompt_kernel
.amdhsa_next_free_vgpr 512
.amdhsa_next_free_sgpr 102
.amdhsa_accum_offset 256
.amdhsa_group_segment_fixed_size 0
.amdhsa_kernarg_size 104
.amdhsa_user_sgpr_count 2
.amdhsa_user_sgpr_kernarg_segment_ptr 1
.amdhsa_system_sgpr_workgroup_id_x 1
.amdhsa_ieee_mode 0
.amdhsa_dx10_clamp 0
.end_amdhsa_kernel
```

```asm
; @launch grid=(256,1,1) block=(256,1,1) lds=163840
.amdgcn_target "amdgcn-amd-amdhsa--gfx950"
.text
.globl gated_mix__sliding_local_dilated__compressed_kv_cla__prompt_kernel
.p2align 8
.type gated_mix__sliding_local_dilated__compressed_kv_cla__prompt_kernel,@function
gated_mix__sliding_local_dilated__compressed_kv_cla__prompt_kernel:
    s_cmp_ge_u32 s2, 256
    s_cbranch_scc1 K1_END
    s_getpc_b64 s[94:95]
    s_load_dwordx8 s[36:43], s[0:1], 32
    v_min_u32 v74, 16, v0
    s_lshr_b32 s7, s2, 3
    s_mul_i32 s7, s7, 17
    v_add_lshl_u32 v74, v74, s7, 7
    global_load_dword v76, v74, s[94:95]
    v_lshrrev_b32 v64, 6, v0
    v_and_b32 v31, 63, v0
    v_readfirstlane_b32 s4, v64
    s_and_b32 s5, s2, 7
    s_lshl_b32 s5, s5, 2
    s_bfe_u32 s7, s2, 0x20003
    s_add_u32 s5, s5, s7
    s_lshr_b32 s6, s2, 5
    s_lshl_b32 s69, s4, 12
    s_mov_b32 s10, 2097152
    s_mov_b32 s11, 0x20000
    s_mov_b32 s14, 4194304
    s_mov_b32 s15, 0x20000
    s_mov_b32 s18, 4194304
    s_mov_b32 s19, 0x20000
    v_lshrrev_b32 v65, 3, v31
    v_and_b32 v66, 7, v31
    v_lshrrev_b32 v67, 1, v65
    v_xor_b32 v66, v66, v67
    v_lshlrev_b32 v66, 4, v66
    v_xor_b32 v67, 64, v66
    s_lshr_b32 s7, s4, 1
    s_lshl_b32 s73, s7, 7
    s_and_b32 s100, s4, 1
    s_lshl_b32 s98, s100, 5
    s_add_u32 s98, s98, s73
    v_add_lshl_u32 v68, v65, s98, 10
    v_add_u32 v6, v68, v66
    v_add_u32 v7, v68, v67
    v_add_u32 v7, 7168, v7
    v_add_u32 v8, v68, v66
    v_add_u32 v8, 14336, v8
    v_add_u32 v9, v68, v67
    v_add_u32 v9, 21504, v9
    v_lshrrev_b32 v69, 4, v31
    v_and_b32 v70, 15, v31
    v_lshlrev_b32 v71, 1, v69
    v_xor_b32 v71, v71, v70
    v_lshlrev_b32 v71, 4, v71
    v_xor_b32 v72, 128, v71
    s_lshl_b32 s98, s4, 4
    v_add_lshl_u32 v73, v69, s98, 13
    v_add_u32 v2, v73, v71
    v_add_u32 v3, v73, v71
    v_add_u32 v3, 31744, v3
    v_add_u32 v4, v73, v72
    v_add_u32 v4, 63488, v4
    v_add_u32 v5, v73, v72
    v_add_u32 v5, 95232, v5
    s_and_b32 s3, s2, 0
    s_lshl_b32 s66, s3, 7
    s_lshl_b32 s60, s3, 11
    s_add_u32 s60, s60, s5
    s_lshl_b32 s60, s60, 8
    s_lshl_b32 s61, s6, 18
    s_add_u32 s61, s61, s66
    s_add_u32 s62, s61, 65536
    s_waitcnt lgkmcnt(0)
    s_mov_b64 s[8:9], s[36:37]
    s_mov_b64 s[24:25], s[38:39]
    s_mov_b64 s[12:13], s[40:41]
    s_mov_b64 s[16:17], s[42:43]
    s_load_dwordx2 s[20:21], s[0:1], 0
    s_load_dwordx2 s[28:29], s[0:1], 8
    s_load_dwordx2 s[32:33], s[0:1], 72
    s_load_dwordx2 s[48:49], s[0:1], 64
    s_load_dwordx2 s[92:93], s[0:1], 16
    s_load_dwordx2 s[44:45], s[0:1], 88
    s_load_dwordx2 s[56:57], s[0:1], 96
    s_load_dwordx2 s[0:1], s[0:1], 80
    s_add_u32 m0, s69, 0
    s_nop 0
    buffer_load_dwordx4 v6, s[8:11], s61 offen lds
    buffer_load_dwordx4 v7, s[8:11], s61 offen offset:1024 lds
    buffer_load_dwordx4 v8, s[8:11], s61 offen offset:2048 lds
    buffer_load_dwordx4 v9, s[8:11], s61 offen offset:3072 lds
    s_xor_b32 s61, s61, 128
    s_add_u32 m0, s69, 16384
    s_nop 0
    buffer_load_dwordx4 v6, s[8:11], s62 offen lds
    buffer_load_dwordx4 v7, s[8:11], s62 offen offset:1024 lds
    buffer_load_dwordx4 v8, s[8:11], s62 offen offset:2048 lds
    buffer_load_dwordx4 v9, s[8:11], s62 offen offset:3072 lds
    s_xor_b32 s62, s62, 128
    s_add_u32 m0, s69, 32768
    s_nop 0
    buffer_load_dwordx4 v2, s[12:15], s60 offen nt lds
    buffer_load_dwordx4 v3, s[12:15], s60 offen offset:1024 nt lds
    buffer_load_dwordx4 v4, s[12:15], s60 offen offset:2048 nt lds
    buffer_load_dwordx4 v5, s[12:15], s60 offen offset:3072 nt lds
    s_add_u32 m0, s69, 49152
    s_nop 0
    buffer_load_dwordx4 v6, s[8:11], s61 offen lds
    buffer_load_dwordx4 v7, s[8:11], s61 offen offset:1024 lds
    buffer_load_dwordx4 v8, s[8:11], s61 offen offset:2048 lds
    buffer_load_dwordx4 v9, s[8:11], s61 offen offset:3072 lds
    s_xor_b32 s61, s61, 384
    v_min_u32 v74, 15, v31
    s_lshl2_add_u32 s98, s2, s4
    s_lshl_b32 s98, s98, 11
    v_lshlrev_b32 v74, 7, v74
    buffer_load_dword v117, v74, s[8:11], s98 offen
    s_waitcnt lgkmcnt(0)
    s_mov_b32 s22, 2359296
    s_mov_b32 s23, 0x20000
    s_mov_b32 s26, 4718592
    s_mov_b32 s27, 0x20000
    s_mov_b32 s50, 4718592
    s_mov_b32 s51, 0x20000
    s_mov_b32 s46, 256
    s_mov_b32 s47, 0x20000
    s_mov_b32 s30, 1990656
    s_mov_b32 s31, 0x20000
    s_mov_b32 s34, 1152
    s_mov_b32 s35, 0x20000
    s_mul_i32 s7, s5, 1081344
    s_add_u32 s36, s56, s7
    s_addc_u32 s37, s57, 0
    s_mov_b32 s38, 1081344
    s_mov_b32 s39, 0x20000
    s_cmp_eq_u32 s4, 0
    s_cselect_b32 s86, 0x55555555, 0
    s_cselect_b32 s87, 0x55555555, 0
    s_cselect_b32 s52, s48, s92
    s_cselect_b32 s53, s49, s93
    s_cselect_b32 s54, s50, 663552
    s_mov_b32 s55, 0x20000
    s_mul_i32 s63, s6, 147456
    s_sub_u32 s64, 2211840, s63
    s_add_u32 s63, s63, s66
    s_add_u32 s64, s64, s66
    s_lshl_b32 s67, s4, 11
    s_lshl_b32 s68, s4, 10
    s_lshl_b32 s75, s4, 13
    s_lshl_b32 s65, s3, 13
    s_add_u32 s65, s65, s67
    s_lshl_b32 s70, s6, 2
    s_lshl1_add_u32 s70, s100, s70
    s_lshl_b32 s70, s70, 15
    s_lshl_b32 s98, s73, 6
    s_add_u32 s71, s70, s98
    s_add_u32 s71, s71, 49152
    s_lshl_b32 s98, s73, 4
    s_add_u32 s70, s70, s98
    v_lshlrev_b32 v1, 4, v31
    v_mov_b32 v77, 1073741824
    v_cmp_eq_u32 vcc, 0, v0
    s_nop 1
    v_cndmask_b32_e64 v30, v77, 0, vcc
    v_lshlrev_b32 v103, 7, v31
    v_cmp_gt_u32 vcc, 9, v31
    s_nop 1
    v_cndmask_b32 v103, v77, v103, vcc
    s_lshl_b32 s98, s4, 5
    v_add_u32 v68, s98, v65
    v_mul_u32_u24 v68, 1152, v68
    v_add_u32 v10, v68, v66
    v_add_u32 v11, v68, v67
    v_add_u32 v11, 8192, v11
    v_add_u32 v12, v68, v66
    v_add_u32 v12, 16384, v12
    v_add_u32 v13, v68, v67
    v_add_u32 v13, 24576, v13
    s_sub_u32 s98, 15, s6
    s_cmp_eq_u32 s73, 0
    s_cselect_b32 s98, s6, s98
    s_lshl_b32 s98, s98, 7
    s_sub_u32 s98, s98, 16
    s_max_i32 s98, s98, 0
    s_lshl3_add_u32 s98, s100, s98
    v_add_u32 v68, s98, v65
    v_mul_u32_u24 v68, 1152, v68
    s_lshl_b32 s98, s100, 6
    v_xor_b32 v73, s98, v66
    v_add_u32 v96, v68, v73
    s_add_u32 m0, s69, 65536
    s_nop 0
    buffer_load_dwordx4 v2, s[16:19], s60 offen nt lds
    v_lshrrev_b32 v71, 1, v70
    v_xor_b32 v71, v71, v69
    v_lshlrev_b32 v71, 4, v71
    v_lshl_add_u32 v71, v70, 7, v71
    v_xor_b32 v72, 64, v71
    s_lshl_b32 s98, s100, 13
    v_add_u32 v22, s98, v71
    v_add_u32 v23, s98, v72
    v_add_u32 v24, s67, v71
    v_add_u32 v25, s67, v72
    s_lshl_b32 s98, s100, 11
    s_add_u32 s98, s98, 8192
    v_add_u32 v100, s98, v71
    v_add_u32 v101, s98, v72
    v_bfe_u32 v73, v31, 2, 2
    v_and_b32 v74, 3, v31
    v_lshl_add_u32 v75, v69, 3, v73
    v_and_b32 v78, 1, v69
    buffer_load_dwordx4 v3, s[16:19], s60 offen offset:1024 nt lds
    v_lshl_add_u32 v77, v78, 2, v73
    v_lshlrev_b32 v77, 5, v77
    v_lshl_add_u32 v77, v74, 3, v77
    v_lshl_add_u32 v77, v75, 8, v77
    v_xor_b32 v14, 0, v77
    v_xor_b32 v14, s73, v14
    v_xor_b32 v15, 32, v77
    v_xor_b32 v15, s73, v15
    v_xor_b32 v16, 64, v77
    v_xor_b32 v16, s73, v16
    v_xor_b32 v17, 96, v77
    v_xor_b32 v17, s73, v17
    v_xor_b32 v18, 128, v77
    v_xor_b32 v19, 160, v77
    v_xor_b32 v20, 192, v77
    v_xor_b32 v21, 224, v77
    v_lshrrev_b32 v77, 1, v73
    v_lshl_add_u32 v77, v78, 1, v77
    buffer_load_dwordx4 v4, s[16:19], s60 offen offset:2048 nt lds
    v_lshlrev_b32 v77, 5, v77
    v_lshl_add_u32 v77, v74, 3, v77
    v_lshl_add_u32 v77, v75, 7, v77
    s_lshr_b32 s98, s73, 1
    v_xor_b32 v26, 0, v77
    v_xor_b32 v26, s98, v26
    v_xor_b32 v27, 32, v77
    v_xor_b32 v28, 64, v77
    v_xor_b32 v28, s98, v28
    v_xor_b32 v29, 96, v77
    v_and_b32 v73, 7, v0
    v_lshrrev_b32 v74, 3, v0
    v_lshl_add_u32 v75, v73, 1, 0
    v_mul_u32_u24 v78, 52, v75
    v_lshrrev_b32 v78, 8, v78
    v_mul_u32_u24 v79, 5, v78
    v_sub_u32 v75, v75, v79
    v_add_u32 v78, 1, v78
    buffer_load_dwordx4 v5, s[16:19], s60 offen offset:3072 nt lds
    s_xor_b32 s60, s60, 524288
    v_cmp_le_u32 vcc, 3, v78
    s_nop 1
    v_cndmask_b32_e64 v78, v78, 0, vcc
    v_mul_u32_u24 v78, 1152, v78
    v_lshl_add_u32 v75, v75, 3, v78
    v_mad_u32_u24 v75, v74, 36, v75
    v_lshl_add_u32 v77, v73, 1, 1
    v_mul_u32_u24 v78, 52, v77
    v_lshrrev_b32 v78, 8, v78
    v_mul_u32_u24 v79, 5, v78
    v_sub_u32 v77, v77, v79
    v_add_u32 v78, 1, v78
    v_cmp_le_u32 vcc, 3, v78
    s_nop 1
    v_cndmask_b32_e64 v78, v78, 0, vcc
    v_mul_u32_u24 v78, 1152, v78
    v_lshl_add_u32 v77, v77, 3, v78
    v_mad_u32_u24 v77, v74, 36, v77
    s_mul_i32 s98, s2, 10368
    s_mul_i32 s99, s2, 6
    s_mov_b32 s7, 73728
    v_mul_lo_u32 v95, v74, s7
    v_lshl_add_u32 v95, v73, 4, v95
    v_cmp_eq_u32 s[92:93], 7, v73
    s_add_u32 s56, s56, 56623104
    s_addc_u32 s57, s57, 0
    s_mov_b32 s58, 5603328
    s_mov_b32 s59, 0x20000
    s_lshl_b32 s101, s6, 5
    s_add_u32 s101, s101, s5
    s_lshl_b32 s101, s101, 7
    v_mov_b32 v65, 0
    v_lshrrev_b32 v64, 2, v0
    v_lshlrev_b32 v64, 15, v64
    v_and_b32 v79, 3, v0
    v_lshl_add_u32 v64, v79, 2, v64
    s_mov_b32 s74, 0x3e0293ee
    s_lshl_b32 s95, s5, 3
    s_waitcnt vmcnt(5)
    s_barrier
    ds_read_b128 a[0:3], v22 offset:0
    ds_read_b64_tr_b16 v[40:41], v14 offset:32768
    ds_read_b64_tr_b16 v[42:43], v14 offset:33792
    ds_read_b128 a[4:7], v23 offset:0
    ds_read_b64_tr_b16 v[44:45], v14 offset:40960
    ds_read_b64_tr_b16 v[46:47], v14 offset:41984
    ds_read_b128 a[8:11], v22 offset:2048
    ds_read_b128 a[12:15], v23 offset:2048
    ds_read_b128 a[16:19], v22 offset:4096
    ds_read_b128 a[20:23], v23 offset:4096
    ds_read_b128 a[24:27], v22 offset:6144
    ds_read_b128 a[28:31], v23 offset:6144
    ds_read_b128 a[32:35], v22 offset:16384
    ds_read_b128 a[36:39], v23 offset:16384
    ds_read_b128 a[40:43], v22 offset:18432
    s_waitcnt lgkmcnt(14)
    ds_read_b128 a[44:47], v23 offset:18432
    s_waitcnt lgkmcnt(14)
    ds_read_b128 a[48:51], v22 offset:20480
    s_waitcnt lgkmcnt(14)
    ds_read_b128 a[52:55], v23 offset:20480
    s_waitcnt lgkmcnt(14)
    ds_read_b128 a[56:59], v22 offset:22528
    s_waitcnt lgkmcnt(14)
    ds_read_b128 a[60:63], v23 offset:22528
    v_mfma_f32_16x16x32_bf16 v[128:131], v[40:43], a[0:3], 0
    s_add_u32 m0, s69, 81920
    s_waitcnt lgkmcnt(14)
    ds_read_b64_tr_b16 v[48:49], v15 offset:32768
    s_waitcnt lgkmcnt(14)
    ds_read_b64_tr_b16 v[50:51], v15 offset:33792
    v_mfma_f32_16x16x32_bf16 v[128:131], v[44:47], a[4:7], v[128:131]
    s_mul_i32 s77, s2, 9216
    buffer_load_dwordx4 v6, s[8:11], s62 offen lds
    v_mfma_f32_16x16x32_bf16 v[132:135], v[40:43], a[8:11], 0
    s_mul_i32 s76, s4, 1152
    s_waitcnt lgkmcnt(14)
    ds_read_b128 a[64:67], v22 offset:49152
    s_waitcnt lgkmcnt(14)
    ds_read_b64_tr_b16 v[52:53], v15 offset:40960
    v_mfma_f32_16x16x32_bf16 v[132:135], v[44:47], a[12:15], v[132:135]
    s_add_u32 s77, s77, s76
    s_waitcnt lgkmcnt(14)
    ds_read_b64_tr_b16 v[54:55], v15 offset:41984
    s_waitcnt lgkmcnt(14)
    ds_read_b64_tr_b16 v[56:57], v16 offset:32768
    v_mfma_f32_16x16x32_bf16 v[136:139], v[40:43], a[16:19], 0
    s_mul_i32 s76, s4, 1152
    buffer_load_dwordx4 v7, s[8:11], s62 offen offset:1024 lds
    v_mfma_f32_16x16x32_bf16 v[136:139], v[44:47], a[20:23], v[136:139]
    s_mul_i32 s72, s2, 3
    s_waitcnt lgkmcnt(4)
    ds_read_b64_tr_b16 v[58:59], v16 offset:33792
    ds_read_b64_tr_b16 v[60:61], v16 offset:40960
    v_mfma_f32_16x16x32_bf16 v[140:143], v[40:43], a[24:27], 0
    s_add_u32 s72, s72, 0
    ds_read_b64_tr_b16 v[62:63], v16 offset:41984
    v_add_u32 v14, 0x10000, v14
    v_mfma_f32_16x16x32_bf16 v[140:143], v[44:47], a[28:31], v[140:143]
    s_mul_i32 s7, s5, 73728
    ds_read_b128 a[68:71], v23 offset:49152
    v_add_u32 v15, 0x10000, v15
    v_mfma_f32_16x16x32_bf16 v[144:147], v[40:43], a[32:35], 0
    s_and_b32 s100, s5, 1
    buffer_load_dwordx4 v8, s[8:11], s62 offen offset:2048 lds
    v_mfma_f32_16x16x32_bf16 v[144:147], v[44:47], a[36:39], v[144:147]
    s_mov_b64 s[84:85], 0
    v_add_u32 v16, 0x10000, v16
    v_mov_b32 v31, 1
    v_mfma_f32_16x16x32_bf16 v[148:151], v[40:43], a[40:43], 0
    s_mov_b32 s83, 0
    v_add_u32 v18, 0x10000, v18
    v_add_u32 v19, 0x10000, v19
    v_mfma_f32_16x16x32_bf16 v[148:151], v[44:47], a[44:47], v[148:151]
    v_add_u32 v20, 0x10000, v20
    v_add_u32 v21, 0x10000, v21
    v_mfma_f32_16x16x32_bf16 v[152:155], v[40:43], a[48:51], 0
    buffer_load_dwordx4 v9, s[8:11], s62 offen offset:3072 lds
    v_mfma_f32_16x16x32_bf16 v[152:155], v[44:47], a[52:55], v[152:155]
    ds_read_b128 a[72:75], v22 offset:51200
    v_add_u32 v26, 0x10000, v26
    v_mfma_f32_16x16x32_bf16 v[156:159], v[40:43], a[56:59], 0
    s_add_u32 m0, s69, 98304
    ds_read_b64_tr_b16 v[40:41], v17 offset:32768
    ds_read_b64_tr_b16 v[42:43], v17 offset:33792
    v_mfma_f32_16x16x32_bf16 v[156:159], v[44:47], a[60:63], v[156:159]
    s_xor_b32 s62, s62, 384
    ds_read_b64_tr_b16 v[44:45], v17 offset:40960
    ds_read_b64_tr_b16 v[46:47], v17 offset:41984
    v_mfma_f32_16x16x32_bf16 v[160:163], v[48:51], a[0:3], 0
    s_waitcnt lgkmcnt(5)
    buffer_load_dwordx4 v2, s[12:15], s60 offen nt lds
    v_mfma_f32_16x16x32_bf16 v[160:163], v[52:55], a[4:7], v[160:163]
    v_add_u32 v17, 0x10000, v17
    v_add_u32 v27, 0x10000, v27
    v_mfma_f32_16x16x32_bf16 v[164:167], v[48:51], a[8:11], 0
    ds_read_b128 a[76:79], v23 offset:51200
    v_add_u32 v28, 0x10000, v28
    v_mfma_f32_16x16x32_bf16 v[164:167], v[52:55], a[12:15], v[164:167]
    v_add_u32 v29, 0x10000, v29
    v_bfe_u32 v37, v1, 4, 4
    v_mfma_f32_16x16x32_bf16 v[168:171], v[48:51], a[16:19], 0
    buffer_load_dwordx4 v3, s[12:15], s60 offen offset:1024 nt lds
    v_mfma_f32_16x16x32_bf16 v[168:171], v[52:55], a[20:23], v[168:171]
    v_mul_u32_u24 v36, 1152, v37
    v_lshrrev_b32 v38, 8, v1
    v_mfma_f32_16x16x32_bf16 v[172:175], v[48:51], a[24:27], 0
    v_lshl_add_u32 v36, v38, 4, v36
    v_lshrrev_b32 v39, 3, v37
    v_mfma_f32_16x16x32_bf16 v[172:175], v[52:55], a[28:31], v[172:175]
    v_mul_u32_u24 v39, 9152, v39
    v_mfma_f32_16x16x32_bf16 v[176:179], v[48:51], a[32:35], 0
    buffer_load_dwordx4 v4, s[12:15], s60 offen offset:2048 nt lds
    v_mfma_f32_16x16x32_bf16 v[176:179], v[52:55], a[36:39], v[176:179]
    ds_read_b128 a[80:83], v22 offset:53248
    v_mfma_f32_16x16x32_bf16 v[180:183], v[48:51], a[40:43], 0
    v_mfma_f32_16x16x32_bf16 v[180:183], v[52:55], a[44:47], v[180:183]
    v_mfma_f32_16x16x32_bf16 v[184:187], v[48:51], a[48:51], 0
    buffer_load_dwordx4 v5, s[12:15], s60 offen offset:3072 nt lds
    v_mfma_f32_16x16x32_bf16 v[184:187], v[52:55], a[52:55], v[184:187]
    ds_read_b128 a[84:87], v23 offset:53248
    v_mfma_f32_16x16x32_bf16 v[188:191], v[48:51], a[56:59], 0
    s_add_u32 m0, s69, 114688
    v_mfma_f32_16x16x32_bf16 v[188:191], v[52:55], a[60:63], v[188:191]
    v_mfma_f32_16x16x32_bf16 v[192:195], v[56:59], a[0:3], 0
    buffer_load_dwordx4 v6, s[8:11], s61 offen lds
    v_mfma_f32_16x16x32_bf16 v[192:195], v[60:63], a[4:7], v[192:195]
    v_mfma_f32_16x16x32_bf16 v[196:199], v[56:59], a[8:11], 0
    v_mfma_f32_16x16x32_bf16 v[196:199], v[60:63], a[12:15], v[196:199]
    ds_read_b128 a[88:91], v22 offset:55296
    v_mfma_f32_16x16x32_bf16 v[200:203], v[56:59], a[16:19], 0
    buffer_load_dwordx4 v7, s[8:11], s61 offen offset:1024 lds
    v_mfma_f32_16x16x32_bf16 v[200:203], v[60:63], a[20:23], v[200:203]
    v_mfma_f32_16x16x32_bf16 v[204:207], v[56:59], a[24:27], 0
    v_mfma_f32_16x16x32_bf16 v[204:207], v[60:63], a[28:31], v[204:207]
    v_mfma_f32_16x16x32_bf16 v[208:211], v[56:59], a[32:35], 0
    buffer_load_dwordx4 v8, s[8:11], s61 offen offset:2048 lds
    v_mfma_f32_16x16x32_bf16 v[208:211], v[60:63], a[36:39], v[208:211]
    ds_read_b128 a[92:95], v23 offset:55296
    v_mfma_f32_16x16x32_bf16 v[212:215], v[56:59], a[40:43], 0
    v_mfma_f32_16x16x32_bf16 v[212:215], v[60:63], a[44:47], v[212:215]
    v_mfma_f32_16x16x32_bf16 v[216:219], v[56:59], a[48:51], 0
    buffer_load_dwordx4 v9, s[8:11], s61 offen offset:3072 lds
    v_mfma_f32_16x16x32_bf16 v[216:219], v[60:63], a[52:55], v[216:219]
    v_mfma_f32_16x16x32_bf16 v[220:223], v[56:59], a[56:59], 0
    s_xor_b32 s61, s61, 128
    v_mfma_f32_16x16x32_bf16 v[220:223], v[60:63], a[60:63], v[220:223]
    s_add_u32 m0, s69, 131072
    s_waitcnt lgkmcnt(0)
    v_mfma_f32_16x16x32_bf16 v[224:227], v[40:43], a[0:3], 0
    buffer_load_dwordx4 v2, s[16:19], s60 offen nt lds
    v_mfma_f32_16x16x32_bf16 v[224:227], v[44:47], a[4:7], v[224:227]
    v_mfma_f32_16x16x32_bf16 v[228:231], v[40:43], a[8:11], 0
    buffer_load_dword v104, v103, s[20:23], s77 offen
    v_mfma_f32_16x16x32_bf16 v[228:231], v[44:47], a[12:15], v[228:231]
    s_add_u32 s77, s77, 4608
    v_mfma_f32_16x16x32_bf16 v[232:235], v[40:43], a[16:19], 0
    v_mfma_f32_16x16x32_bf16 v[232:235], v[44:47], a[20:23], v[232:235]
    s_waitcnt vmcnt(10)
    s_barrier
    ds_read_b64_tr_b16 v[48:49], v14 offset:0
    v_mfma_f32_16x16x32_bf16 v[236:239], v[40:43], a[24:27], 0
    buffer_load_dwordx4 v3, s[16:19], s60 offen offset:1024 nt lds
    v_mfma_f32_16x16x32_bf16 v[236:239], v[44:47], a[28:31], v[236:239]
    ds_read_b64_tr_b16 v[50:51], v14 offset:1024
    ds_read_b64_tr_b16 v[52:53], v14 offset:8192
    v_mfma_f32_16x16x32_bf16 v[240:243], v[40:43], a[32:35], 0
    ds_read_b64_tr_b16 v[54:55], v14 offset:9216
    ds_read_b64_tr_b16 v[56:57], v15 offset:0
    v_mfma_f32_16x16x32_bf16 v[240:243], v[44:47], a[36:39], v[240:243]
    buffer_load_dwordx4 v4, s[16:19], s60 offen offset:2048 nt lds
    v_mfma_f32_16x16x32_bf16 v[244:247], v[40:43], a[40:43], 0
    ds_read_b64_tr_b16 v[58:59], v15 offset:1024
    ds_read_b64_tr_b16 v[60:61], v15 offset:8192
    v_mfma_f32_16x16x32_bf16 v[244:247], v[44:47], a[44:47], v[244:247]
    ds_read_b64_tr_b16 v[62:63], v15 offset:9216
    v_mfma_f32_16x16x32_bf16 v[248:251], v[40:43], a[48:51], 0
    v_mfma_f32_16x16x32_bf16 v[248:251], v[44:47], a[52:55], v[248:251]
    buffer_load_dwordx4 v5, s[16:19], s60 offen offset:3072 nt lds
    v_mfma_f32_16x16x32_bf16 v[252:255], v[40:43], a[56:59], 0
    ds_read_b64_tr_b16 v[40:41], v16 offset:0
    ds_read_b64_tr_b16 v[42:43], v16 offset:1024
    v_mfma_f32_16x16x32_bf16 v[252:255], v[44:47], a[60:63], v[252:255]
    s_waitcnt lgkmcnt(3)
    ds_read_b64_tr_b16 v[44:45], v16 offset:8192
    ds_read_b64_tr_b16 v[46:47], v16 offset:9216
    v_mfma_f32_16x16x32_bf16 a[128:131], a[0:3], v[48:51], 0
    v_mfma_f32_16x16x32_bf16 a[128:131], a[4:7], v[52:55], a[128:131]
    s_add_u32 m0, s69, 147456
    v_add_u32 v22, 0x10000, v22
    v_mfma_f32_16x16x32_bf16 a[132:135], a[8:11], v[48:51], 0
    s_xor_b32 s60, s60, 1572864
    buffer_load_dwordx4 v6, s[8:11], s62 offen lds
    v_mfma_f32_16x16x32_bf16 a[132:135], a[12:15], v[52:55], a[132:135]
    ds_read_b128 a[96:99], v22 offset:16384
    v_mfma_f32_16x16x32_bf16 a[136:139], a[16:19], v[48:51], 0
    v_mfma_f32_16x16x32_bf16 a[136:139], a[20:23], v[52:55], a[136:139]
    v_mfma_f32_16x16x32_bf16 a[140:143], a[24:27], v[48:51], 0
    buffer_load_dwordx4 v7, s[8:11], s62 offen offset:1024 lds
    v_mfma_f32_16x16x32_bf16 a[140:143], a[28:31], v[52:55], a[140:143]
    v_add_u32 v23, 0x10000, v23
    ds_read_b128 a[100:103], v23 offset:16384
    v_mfma_f32_16x16x32_bf16 a[144:147], a[32:35], v[48:51], 0
    v_mfma_f32_16x16x32_bf16 a[144:147], a[36:39], v[52:55], a[144:147]
    v_mfma_f32_16x16x32_bf16 a[148:151], a[40:43], v[48:51], 0
    v_mfma_f32_16x16x32_bf16 a[148:151], a[44:47], v[52:55], a[148:151]
    buffer_load_dwordx4 v8, s[8:11], s62 offen offset:2048 lds
    v_mfma_f32_16x16x32_bf16 a[152:155], a[48:51], v[48:51], 0
    v_mfma_f32_16x16x32_bf16 a[152:155], a[52:55], v[52:55], a[152:155]
    ds_read_b128 a[104:107], v22 offset:18432
    v_mfma_f32_16x16x32_bf16 a[156:159], a[56:59], v[48:51], 0
    ds_read_b64_tr_b16 v[48:49], v17 offset:0
    ds_read_b64_tr_b16 v[50:51], v17 offset:1024
    v_mfma_f32_16x16x32_bf16 a[156:159], a[60:63], v[52:55], a[156:159]
    buffer_load_dwordx4 v9, s[8:11], s62 offen offset:3072 lds
    v_mfma_f32_16x16x32_bf16 a[160:163], a[0:3], v[56:59], 0
    s_waitcnt lgkmcnt(3)
    ds_read_b64_tr_b16 v[52:53], v17 offset:8192
    ds_read_b64_tr_b16 v[54:55], v17 offset:9216
    v_mfma_f32_16x16x32_bf16 a[160:163], a[4:7], v[60:63], a[160:163]
    v_mfma_f32_16x16x32_bf16 a[164:167], a[8:11], v[56:59], 0
    ds_read_b128 a[108:111], v23 offset:18432
    v_mfma_f32_16x16x32_bf16 a[164:167], a[12:15], v[60:63], a[164:167]
    s_add_u32 m0, s69, 0
    v_mfma_f32_16x16x32_bf16 a[168:171], a[16:19], v[56:59], 0
    s_xor_b32 s62, s62, 128
    buffer_load_dwordx4 v2, s[12:15], s60 offen nt lds
    v_mfma_f32_16x16x32_bf16 a[168:171], a[20:23], v[60:63], a[168:171]
    v_mfma_f32_16x16x32_bf16 a[172:175], a[24:27], v[56:59], 0
    v_mfma_f32_16x16x32_bf16 a[172:175], a[28:31], v[60:63], a[172:175]
    v_mfma_f32_16x16x32_bf16 a[176:179], a[32:35], v[56:59], 0
    buffer_load_dwordx4 v3, s[12:15], s60 offen offset:1024 nt lds
    v_mfma_f32_16x16x32_bf16 a[176:179], a[36:39], v[60:63], a[176:179]
    ds_read_b128 a[112:115], v22 offset:20480
    v_mfma_f32_16x16x32_bf16 a[180:183], a[40:43], v[56:59], 0
    v_mfma_f32_16x16x32_bf16 a[180:183], a[44:47], v[60:63], a[180:183]
    v_mfma_f32_16x16x32_bf16 a[184:187], a[48:51], v[56:59], 0
    v_mfma_f32_16x16x32_bf16 a[184:187], a[52:55], v[60:63], a[184:187]
    buffer_load_dwordx4 v4, s[12:15], s60 offen offset:2048 nt lds
    v_mfma_f32_16x16x32_bf16 a[188:191], a[56:59], v[56:59], 0
    ds_read_b128 a[116:119], v23 offset:20480
    v_mfma_f32_16x16x32_bf16 a[188:191], a[60:63], v[60:63], a[188:191]
    v_mfma_f32_16x16x32_bf16 a[192:195], a[0:3], v[40:43], 0
    v_mfma_f32_16x16x32_bf16 a[192:195], a[4:7], v[44:47], a[192:195]
    buffer_load_dwordx4 v5, s[12:15], s60 offen offset:3072 nt lds
    v_mfma_f32_16x16x32_bf16 a[196:199], a[8:11], v[40:43], 0
    v_mfma_f32_16x16x32_bf16 a[196:199], a[12:15], v[44:47], a[196:199]
    ds_read_b128 a[120:123], v22 offset:22528
    v_mfma_f32_16x16x32_bf16 a[200:203], a[16:19], v[40:43], 0
    v_mfma_f32_16x16x32_bf16 a[200:203], a[20:23], v[44:47], a[200:203]
    s_add_u32 m0, s69, 16384
    v_mfma_f32_16x16x32_bf16 a[204:207], a[24:27], v[40:43], 0
    buffer_load_dwordx4 v6, s[8:11], s61 offen lds
    v_mfma_f32_16x16x32_bf16 a[204:207], a[28:31], v[44:47], a[204:207]
    v_mfma_f32_16x16x32_bf16 a[208:211], a[32:35], v[40:43], 0
    ds_read_b128 a[124:127], v23 offset:22528
    v_mfma_f32_16x16x32_bf16 a[208:211], a[36:39], v[44:47], a[208:211]
    v_mfma_f32_16x16x32_bf16 a[212:215], a[40:43], v[40:43], 0
    buffer_load_dwordx4 v7, s[8:11], s61 offen offset:1024 lds
    v_mfma_f32_16x16x32_bf16 a[212:215], a[44:47], v[44:47], a[212:215]
    v_mfma_f32_16x16x32_bf16 a[216:219], a[48:51], v[40:43], 0
    v_mfma_f32_16x16x32_bf16 a[216:219], a[52:55], v[44:47], a[216:219]
    v_mfma_f32_16x16x32_bf16 a[220:223], a[56:59], v[40:43], 0
    v_mfma_f32_16x16x32_bf16 a[220:223], a[60:63], v[44:47], a[220:223]
    s_waitcnt lgkmcnt(0)
    buffer_load_dwordx4 v8, s[8:11], s61 offen offset:2048 lds
    v_mfma_f32_16x16x32_bf16 a[224:227], a[0:3], v[48:51], 0
    v_mfma_f32_16x16x32_bf16 a[224:227], a[4:7], v[52:55], a[224:227]
    v_mfma_f32_16x16x32_bf16 a[228:231], a[8:11], v[48:51], 0
    v_mfma_f32_16x16x32_bf16 a[228:231], a[12:15], v[52:55], a[228:231]
    buffer_load_dwordx4 v9, s[8:11], s61 offen offset:3072 lds
    v_mfma_f32_16x16x32_bf16 a[232:235], a[16:19], v[48:51], 0
    v_mfma_f32_16x16x32_bf16 a[232:235], a[20:23], v[52:55], a[232:235]
    s_waitcnt vmcnt(8) lgkmcnt(0)
    s_barrier
    ds_read_b64_tr_b16 v[56:57], v14 offset:32768
    v_mfma_f32_16x16x32_bf16 a[236:239], a[24:27], v[48:51], 0
    s_add_u32 m0, s69, 32768
    ds_read_b64_tr_b16 v[58:59], v14 offset:33792
    ds_read_b64_tr_b16 v[60:61], v14 offset:40960
    v_mfma_f32_16x16x32_bf16 a[236:239], a[28:31], v[52:55], a[236:239]
    s_xor_b32 s61, s61, 896
    buffer_load_dwordx4 v2, s[16:19], s60 offen nt lds
    v_mfma_f32_16x16x32_bf16 a[240:243], a[32:35], v[48:51], 0
    ds_read_b64_tr_b16 v[62:63], v14 offset:41984
    ds_read_b64_tr_b16 v[40:41], v15 offset:32768
    v_mfma_f32_16x16x32_bf16 a[240:243], a[36:39], v[52:55], a[240:243]
    ds_read_b64_tr_b16 v[42:43], v15 offset:33792
    ds_read_b64_tr_b16 v[44:45], v15 offset:40960
    v_mfma_f32_16x16x32_bf16 a[244:247], a[40:43], v[48:51], 0
    ds_read_b64_tr_b16 v[46:47], v15 offset:41984
    v_add_u32 v14, 0x10000, v14
    v_mfma_f32_16x16x32_bf16 a[244:247], a[44:47], v[52:55], a[244:247]
    v_add_u32 v15, 0x10000, v15
    v_mfma_f32_16x16x32_bf16 a[248:251], a[48:51], v[48:51], 0
    v_mfma_f32_16x16x32_bf16 a[248:251], a[52:55], v[52:55], a[248:251]
    buffer_load_dwordx4 v3, s[16:19], s60 offen offset:1024 nt lds
    v_mfma_f32_16x16x32_bf16 a[252:255], a[56:59], v[48:51], 0
    ds_read_b64_tr_b16 v[48:49], v16 offset:32768
    ds_read_b64_tr_b16 v[50:51], v16 offset:33792
    v_mfma_f32_16x16x32_bf16 a[252:255], a[60:63], v[52:55], a[252:255]
    s_waitcnt lgkmcnt(2)
    ds_read_b64_tr_b16 v[52:53], v16 offset:40960
    ds_read_b64_tr_b16 v[54:55], v16 offset:41984
    v_mfma_f32_16x16x32_bf16 v[128:131], v[56:59], a[64:67], v[128:131]
    v_add_u32 v16, 0x10000, v16
    v_mfma_f32_16x16x32_bf16 v[128:131], v[60:63], a[68:71], v[128:131]
    v_mfma_f32_16x16x32_bf16 v[132:135], v[56:59], a[72:75], v[132:135]
    ds_read_b128 a[0:3], v22 offset:49152
    v_mfma_f32_16x16x32_bf16 v[132:135], v[60:63], a[76:79], v[132:135]
    v_mfma_f32_16x16x32_bf16 v[136:139], v[56:59], a[80:83], v[136:139]
    v_mfma_f32_16x16x32_bf16 v[136:139], v[60:63], a[84:87], v[136:139]
    buffer_load_dwordx4 v4, s[16:19], s60 offen offset:2048 nt lds
    v_mfma_f32_16x16x32_bf16 v[140:143], v[56:59], a[88:91], v[140:143]
    v_mfma_f32_16x16x32_bf16 v[140:143], v[60:63], a[92:95], v[140:143]
    ds_read_b128 a[4:7], v23 offset:49152
    v_mfma_f32_16x16x32_bf16 v[144:147], v[56:59], a[96:99], v[144:147]
    v_mfma_f32_16x16x32_bf16 v[144:147], v[60:63], a[100:103], v[144:147]
    v_mfma_f32_16x16x32_bf16 v[148:151], v[56:59], a[104:107], v[148:151]
    v_mfma_f32_16x16x32_bf16 v[148:151], v[60:63], a[108:111], v[148:151]
    v_mfma_f32_16x16x32_bf16 v[152:155], v[56:59], a[112:115], v[152:155]
    buffer_load_dwordx4 v5, s[16:19], s60 offen offset:3072 nt lds
    v_mfma_f32_16x16x32_bf16 v[152:155], v[60:63], a[116:119], v[152:155]
    ds_read_b128 a[8:11], v22 offset:51200
    v_mfma_f32_16x16x32_bf16 v[156:159], v[56:59], a[120:123], v[156:159]
    ds_read_b64_tr_b16 v[56:57], v17 offset:32768
    ds_read_b64_tr_b16 v[58:59], v17 offset:33792
    v_mfma_f32_16x16x32_bf16 v[156:159], v[60:63], a[124:127], v[156:159]
    ds_read_b64_tr_b16 v[60:61], v17 offset:40960
    ds_read_b64_tr_b16 v[62:63], v17 offset:41984
    v_mfma_f32_16x16x32_bf16 v[160:163], v[40:43], a[64:67], v[160:163]
    v_add_u32 v17, 0x10000, v17
    v_mfma_f32_16x16x32_bf16 v[160:163], v[44:47], a[68:71], v[160:163]
    v_mfma_f32_16x16x32_bf16 v[164:167], v[40:43], a[72:75], v[164:167]
    ds_read_b128 a[12:15], v23 offset:51200
    v_mfma_f32_16x16x32_bf16 v[164:167], v[44:47], a[76:79], v[164:167]
    s_add_u32 m0, s69, 49152
    v_mfma_f32_16x16x32_bf16 v[168:171], v[40:43], a[80:83], v[168:171]
    s_xor_b32 s60, s60, 524288
    buffer_load_dwordx4 v6, s[8:11], s62 offen lds
    v_mfma_f32_16x16x32_bf16 v[168:171], v[44:47], a[84:87], v[168:171]
    v_mfma_f32_16x16x32_bf16 v[172:175], v[40:43], a[88:91], v[172:175]
    v_mfma_f32_16x16x32_bf16 v[172:175], v[44:47], a[92:95], v[172:175]
    v_mfma_f32_16x16x32_bf16 v[176:179], v[40:43], a[96:99], v[176:179]
    ds_read_b128 a[16:19], v22 offset:53248
    v_mfma_f32_16x16x32_bf16 v[176:179], v[44:47], a[100:103], v[176:179]
    v_mfma_f32_16x16x32_bf16 v[180:183], v[40:43], a[104:107], v[180:183]
    v_mfma_f32_16x16x32_bf16 v[180:183], v[44:47], a[108:111], v[180:183]
    buffer_load_dwordx4 v7, s[8:11], s62 offen offset:1024 lds
    v_mfma_f32_16x16x32_bf16 v[184:187], v[40:43], a[112:115], v[184:187]
    v_mfma_f32_16x16x32_bf16 v[184:187], v[44:47], a[116:119], v[184:187]
    ds_read_b128 a[20:23], v23 offset:53248
    v_mfma_f32_16x16x32_bf16 v[188:191], v[40:43], a[120:123], v[188:191]
    s_waitcnt lgkmcnt(1)
    ds_read_b64_tr_b16 v[40:41], v14 offset:0
    ds_read_b64_tr_b16 v[42:43], v14 offset:1024
    v_mfma_f32_16x16x32_bf16 v[188:191], v[44:47], a[124:127], v[188:191]
    ds_read_b64_tr_b16 v[44:45], v14 offset:8192
    ds_read_b64_tr_b16 v[46:47], v14 offset:9216
    v_mfma_f32_16x16x32_bf16 v[192:195], v[48:51], a[64:67], v[192:195]
    v_add_u32 v14, 0xfffe0000, v14
    v_mfma_f32_16x16x32_bf16 v[192:195], v[52:55], a[68:71], v[192:195]
    v_mfma_f32_16x16x32_bf16 v[196:199], v[48:51], a[72:75], v[196:199]
    v_mfma_f32_16x16x32_bf16 v[196:199], v[52:55], a[76:79], v[196:199]
    buffer_load_dwordx4 v8, s[8:11], s62 offen offset:2048 lds
    v_mfma_f32_16x16x32_bf16 v[200:203], v[48:51], a[80:83], v[200:203]
    ds_read_b128 a[24:27], v22 offset:55296
    v_mfma_f32_16x16x32_bf16 v[200:203], v[52:55], a[84:87], v[200:203]
    v_mfma_f32_16x16x32_bf16 v[204:207], v[48:51], a[88:91], v[204:207]
    v_mfma_f32_16x16x32_bf16 v[204:207], v[52:55], a[92:95], v[204:207]
    v_mfma_f32_16x16x32_bf16 v[208:211], v[48:51], a[96:99], v[208:211]
    ds_read_b128 a[28:31], v23 offset:55296
    v_mfma_f32_16x16x32_bf16 v[208:211], v[52:55], a[100:103], v[208:211]
    v_mfma_f32_16x16x32_bf16 v[212:215], v[48:51], a[104:107], v[212:215]
    buffer_load_dwordx4 v9, s[8:11], s62 offen offset:3072 lds
    v_mfma_f32_16x16x32_bf16 v[212:215], v[52:55], a[108:111], v[212:215]
    v_mfma_f32_16x16x32_bf16 v[216:219], v[48:51], a[112:115], v[216:219]
    v_mfma_f32_16x16x32_bf16 v[216:219], v[52:55], a[116:119], v[216:219]
    v_mfma_f32_16x16x32_bf16 v[220:223], v[48:51], a[120:123], v[220:223]
    ds_read_b64_tr_b16 v[48:49], v15 offset:0
    ds_read_b64_tr_b16 v[50:51], v15 offset:1024
    v_mfma_f32_16x16x32_bf16 v[220:223], v[52:55], a[124:127], v[220:223]
    ds_read_b64_tr_b16 v[52:53], v15 offset:8192
    ds_read_b64_tr_b16 v[54:55], v15 offset:9216
    v_mfma_f32_16x16x32_bf16 v[224:227], v[56:59], a[64:67], v[224:227]
    buffer_load_dwordx2 v[80:81], v75, s[28:31], s98 offen nt
    v_mfma_f32_16x16x32_bf16 v[224:227], v[60:63], a[68:71], v[224:227]
    s_xor_b32 s62, s62, 896
    v_add_u32 v15, 0xfffe0000, v15
    v_mfma_f32_16x16x32_bf16 v[228:231], v[56:59], a[72:75], v[228:231]
    buffer_load_dword v105, v103, s[20:23], s77 offen
    v_mfma_f32_16x16x32_bf16 v[228:231], v[60:63], a[76:79], v[228:231]
    s_mul_i32 s77, s2, 18432
    v_mfma_f32_16x16x32_bf16 v[232:235], v[56:59], a[80:83], v[232:235]
    s_add_u32 s77, s77, s76
    buffer_load_dwordx2 v[82:83], v77, s[28:31], s98 offen nt
    v_mfma_f32_16x16x32_bf16 v[232:235], v[60:63], a[84:87], v[232:235]
    s_add_u32 s98, s98, 3456
    v_mfma_f32_16x16x32_bf16 v[236:239], v[56:59], a[88:91], v[236:239]
    s_add_u32 m0, s69, 65536
    v_mfma_f32_16x16x32_bf16 v[236:239], v[60:63], a[92:95], v[236:239]
    s_mov_b32 s76, 0
    v_mfma_f32_16x16x32_bf16 v[240:243], v[56:59], a[96:99], v[240:243]
    buffer_load_ushort v92, v65, s[32:35], s99 offen offset:0
    v_mfma_f32_16x16x32_bf16 v[240:243], v[60:63], a[100:103], v[240:243]
    v_mfma_f32_16x16x32_bf16 v[244:247], v[56:59], a[104:107], v[244:247]
    v_mfma_f32_16x16x32_bf16 v[244:247], v[60:63], a[108:111], v[244:247]
    v_mfma_f32_16x16x32_bf16 v[248:251], v[56:59], a[112:115], v[248:251]
    buffer_load_dwordx2 v[84:85], v75, s[28:31], s98 offen nt
    v_mfma_f32_16x16x32_bf16 v[248:251], v[60:63], a[116:119], v[248:251]
    v_mfma_f32_16x16x32_bf16 v[252:255], v[56:59], a[120:123], v[252:255]
    ds_read_b64_tr_b16 v[56:57], v16 offset:0
    ds_read_b64_tr_b16 v[58:59], v16 offset:1024
    v_mfma_f32_16x16x32_bf16 v[252:255], v[60:63], a[124:127], v[252:255]
    s_waitcnt lgkmcnt(2)
    ds_read_b64_tr_b16 v[60:61], v16 offset:8192
    ds_read_b64_tr_b16 v[62:63], v16 offset:9216
    v_mfma_f32_16x16x32_bf16 a[128:131], a[64:67], v[40:43], a[128:131]
    buffer_load_dwordx4 v2, s[12:15], s60 offen nt lds
    v_mfma_f32_16x16x32_bf16 a[128:131], a[68:71], v[44:47], a[128:131]
    v_add_u32 v22, 0x10000, v22
    v_add_u32 v16, 0xfffe0000, v16
    v_mfma_f32_16x16x32_bf16 a[132:135], a[72:75], v[40:43], a[132:135]
    ds_read_b128 a[32:35], v22 offset:16384
    v_mfma_f32_16x16x32_bf16 a[132:135], a[76:79], v[44:47], a[132:135]
    v_mfma_f32_16x16x32_bf16 a[136:139], a[80:83], v[40:43], a[136:139]
    buffer_load_dwordx2 v[86:87], v77, s[28:31], s98 offen nt
    v_mfma_f32_16x16x32_bf16 a[136:139], a[84:87], v[44:47], a[136:139]
    s_add_u32 s98, s98, 3456
    v_mfma_f32_16x16x32_bf16 a[140:143], a[88:91], v[40:43], a[140:143]
    v_add_u32 v23, 0x10000, v23
    v_mfma_f32_16x16x32_bf16 a[140:143], a[92:95], v[44:47], a[140:143]
    ds_read_b128 a[36:39], v23 offset:16384
    v_mfma_f32_16x16x32_bf16 a[144:147], a[96:99], v[40:43], a[144:147]
    buffer_load_ushort v93, v65, s[32:35], s99 offen offset:2
    v_mfma_f32_16x16x32_bf16 a[144:147], a[100:103], v[44:47], a[144:147]
    v_mfma_f32_16x16x32_bf16 a[148:151], a[104:107], v[40:43], a[148:151]
    v_mfma_f32_16x16x32_bf16 a[148:151], a[108:111], v[44:47], a[148:151]
    v_mfma_f32_16x16x32_bf16 a[152:155], a[112:115], v[40:43], a[152:155]
    buffer_load_dwordx2 v[88:89], v75, s[28:31], s98 offen nt
    v_mfma_f32_16x16x32_bf16 a[152:155], a[116:119], v[44:47], a[152:155]
    ds_read_b128 a[40:43], v22 offset:18432
    v_mfma_f32_16x16x32_bf16 a[156:159], a[120:123], v[40:43], a[156:159]
    ds_read_b64_tr_b16 v[40:41], v17 offset:0
    ds_read_b64_tr_b16 v[42:43], v17 offset:1024
    v_mfma_f32_16x16x32_bf16 a[156:159], a[124:127], v[44:47], a[156:159]
    ds_read_b64_tr_b16 v[44:45], v17 offset:8192
    ds_read_b64_tr_b16 v[46:47], v17 offset:9216
    v_mfma_f32_16x16x32_bf16 a[160:163], a[64:67], v[48:51], a[160:163]
    buffer_load_dwordx4 v3, s[12:15], s60 offen offset:1024 nt lds
    v_mfma_f32_16x16x32_bf16 a[160:163], a[68:71], v[52:55], a[160:163]
    v_add_u32 v17, 0xfffe0000, v17
    v_mfma_f32_16x16x32_bf16 a[164:167], a[72:75], v[48:51], a[164:167]
    ds_read_b128 a[44:47], v23 offset:18432
    v_mfma_f32_16x16x32_bf16 a[164:167], a[76:79], v[52:55], a[164:167]
    v_mfma_f32_16x16x32_bf16 a[168:171], a[80:83], v[48:51], a[168:171]
    buffer_load_dwordx2 v[90:91], v77, s[28:31], s98 offen nt
    v_mfma_f32_16x16x32_bf16 a[168:171], a[84:87], v[52:55], a[168:171]
    s_add_u32 s98, s98, 3456
    s_add_u32 s28, s56, 6291456
    s_addc_u32 s29, s57, 0
    v_mfma_f32_16x16x32_bf16 a[172:175], a[88:91], v[48:51], a[172:175]
    s_mov_b32 s30, 2359296
    v_mfma_f32_16x16x32_bf16 a[172:175], a[92:95], v[52:55], a[172:175]
    s_bfe_u32 s98, s72, 0x10001
    v_mfma_f32_16x16x32_bf16 a[176:179], a[96:99], v[48:51], a[176:179]
    buffer_load_ushort v94, v65, s[32:35], s99 offen offset:4
    v_mfma_f32_16x16x32_bf16 a[176:179], a[100:103], v[52:55], a[176:179]
    s_add_u32 s32, s56, 9437184
    s_addc_u32 s33, s57, 0
    s_mov_b32 s34, 196608
    v_mfma_f32_16x16x32_bf16 a[180:183], a[104:107], v[48:51], a[180:183]
    s_bfe_u32 s99, s72, 0x10003
    ds_read_b128 a[48:51], v22 offset:20480
    v_mfma_f32_16x16x32_bf16 a[180:183], a[108:111], v[52:55], a[180:183]
    s_lshl1_add_u32 s98, s99, s98
    v_mfma_f32_16x16x32_bf16 a[184:187], a[112:115], v[48:51], a[184:187]
    s_lshl_b32 s98, s98, 5
    buffer_store_dword v65, v64, s[32:35], s101 offen sc1
    v_mfma_f32_16x16x32_bf16 a[184:187], a[116:119], v[52:55], a[184:187]
    s_lshl_b32 s72, s72, 7
    ds_read_b128 a[52:55], v23 offset:20480
    v_mfma_f32_16x16x32_bf16 a[188:191], a[120:123], v[48:51], a[188:191]
    v_mfma_f32_16x16x32_bf16 a[188:191], a[124:127], v[52:55], a[188:191]
    s_waitcnt lgkmcnt(1)
    v_mfma_f32_16x16x32_bf16 a[192:195], a[64:67], v[56:59], a[192:195]
    buffer_load_dwordx4 v4, s[12:15], s60 offen offset:2048 nt lds
    v_mfma_f32_16x16x32_bf16 a[192:195], a[68:71], v[60:63], a[192:195]
    v_mfma_f32_16x16x32_bf16 a[196:199], a[72:75], v[56:59], a[196:199]
    v_mfma_f32_16x16x32_bf16 a[196:199], a[76:79], v[60:63], a[196:199]
    ds_read_b128 a[56:59], v22 offset:22528
    v_mfma_f32_16x16x32_bf16 a[200:203], a[80:83], v[56:59], a[200:203]
    buffer_load_dwordx4 v5, s[12:15], s60 offen offset:3072 nt lds
    v_mfma_f32_16x16x32_bf16 a[200:203], a[84:87], v[60:63], a[200:203]
    s_add_u32 m0, s69, 81920
    v_mfma_f32_16x16x32_bf16 a[204:207], a[88:91], v[56:59], a[204:207]
    v_mfma_f32_16x16x32_bf16 a[204:207], a[92:95], v[60:63], a[204:207]
    v_mfma_f32_16x16x32_bf16 a[208:211], a[96:99], v[56:59], a[208:211]
    buffer_load_dwordx4 v6, s[8:11], s61 offen lds
    v_mfma_f32_16x16x32_bf16 a[208:211], a[100:103], v[60:63], a[208:211]
    ds_read_b128 a[60:63], v23 offset:22528
    v_mfma_f32_16x16x32_bf16 a[212:215], a[104:107], v[56:59], a[212:215]
    v_mfma_f32_16x16x32_bf16 a[212:215], a[108:111], v[60:63], a[212:215]
    v_mfma_f32_16x16x32_bf16 a[216:219], a[112:115], v[56:59], a[216:219]
    buffer_load_dwordx4 v7, s[8:11], s61 offen offset:1024 lds
    v_mfma_f32_16x16x32_bf16 a[216:219], a[116:119], v[60:63], a[216:219]
    v_mfma_f32_16x16x32_bf16 a[220:223], a[120:123], v[56:59], a[220:223]
    v_mfma_f32_16x16x32_bf16 a[220:223], a[124:127], v[60:63], a[220:223]
    v_mfma_f32_16x16x32_bf16 a[224:227], a[64:67], v[40:43], a[224:227]
    buffer_load_dwordx4 v8, s[8:11], s61 offen offset:2048 lds
    v_mfma_f32_16x16x32_bf16 a[224:227], a[68:71], v[44:47], a[224:227]
    v_mfma_f32_16x16x32_bf16 a[228:231], a[72:75], v[40:43], a[228:231]
    v_mfma_f32_16x16x32_bf16 a[228:231], a[76:79], v[44:47], a[228:231]
    v_mfma_f32_16x16x32_bf16 a[232:235], a[80:83], v[40:43], a[232:235]
    buffer_load_dwordx4 v9, s[8:11], s61 offen offset:3072 lds
    v_mfma_f32_16x16x32_bf16 a[232:235], a[84:87], v[44:47], a[232:235]
    s_xor_b32 s61, s61, 128
    s_waitcnt vmcnt(19) lgkmcnt(0)
    s_barrier
    v_mfma_f32_16x16x32_bf16 a[236:239], a[88:91], v[40:43], a[236:239]
    s_add_u32 m0, s69, 98304
    ds_read_b64_tr_b16 v[48:49], v14 offset:0
    ds_read_b64_tr_b16 v[50:51], v14 offset:1024
    v_mfma_f32_16x16x32_bf16 a[236:239], a[92:95], v[44:47], a[236:239]
    ds_read_b64_tr_b16 v[52:53], v14 offset:8192
    ds_read_b64_tr_b16 v[54:55], v14 offset:9216
    v_mfma_f32_16x16x32_bf16 a[240:243], a[96:99], v[40:43], a[240:243]
    buffer_load_dwordx4 v2, s[16:19], s60 offen nt lds
    v_mfma_f32_16x16x32_bf16 a[240:243], a[100:103], v[44:47], a[240:243]
    ds_read_b64_tr_b16 v[56:57], v15 offset:0
    ds_read_b64_tr_b16 v[58:59], v15 offset:1024
    v_mfma_f32_16x16x32_bf16 a[244:247], a[104:107], v[40:43], a[244:247]
    ds_read_b64_tr_b16 v[60:61], v15 offset:8192
    ds_read_b64_tr_b16 v[62:63], v15 offset:9216
    v_mfma_f32_16x16x32_bf16 a[244:247], a[108:111], v[44:47], a[244:247]
    s_cmp_lt_u32 s2, 192
    s_cselect_b32 s72, s72, 1073741824
    v_mfma_f32_16x16x32_bf16 a[248:251], a[112:115], v[40:43], a[248:251]
    v_mfma_f32_16x16x32_bf16 a[248:251], a[116:119], v[44:47], a[248:251]
    buffer_load_dwordx4 v3, s[16:19], s60 offen offset:1024 nt lds
    v_mfma_f32_16x16x32_bf16 a[252:255], a[120:123], v[40:43], a[252:255]
    ds_read_b64_tr_b16 v[40:41], v16 offset:0
    ds_read_b64_tr_b16 v[42:43], v16 offset:1024
    v_mfma_f32_16x16x32_bf16 a[252:255], a[124:127], v[44:47], a[252:255]
    s_waitcnt lgkmcnt(2)
    ds_read_b64_tr_b16 v[44:45], v16 offset:8192
    ds_read_b64_tr_b16 v[46:47], v16 offset:9216
    v_mfma_f32_16x16x32_bf16 v[128:131], v[48:51], a[0:3], v[128:131]
    v_mfma_f32_16x16x32_bf16 v[128:131], v[52:55], a[4:7], v[128:131]
    v_add_u32 v22, 0xfffe0000, v22
    v_mfma_f32_16x16x32_bf16 v[132:135], v[48:51], a[8:11], v[132:135]
    ds_read_b128 a[64:67], v22 offset:16384
    v_mfma_f32_16x16x32_bf16 v[132:135], v[52:55], a[12:15], v[132:135]
    v_mfma_f32_16x16x32_bf16 v[136:139], v[48:51], a[16:19], v[136:139]
    v_mfma_f32_16x16x32_bf16 v[136:139], v[52:55], a[20:23], v[136:139]
    buffer_load_dwordx4 v4, s[16:19], s60 offen offset:2048 nt lds
    v_mfma_f32_16x16x32_bf16 v[140:143], v[48:51], a[24:27], v[140:143]
    v_add_u32 v23, 0xfffe0000, v23
    v_mfma_f32_16x16x32_bf16 v[140:143], v[52:55], a[28:31], v[140:143]
    ds_read_b128 a[68:71], v23 offset:16384
    v_mfma_f32_16x16x32_bf16 v[144:147], v[48:51], a[32:35], v[144:147]
    v_mfma_f32_16x16x32_bf16 v[144:147], v[52:55], a[36:39], v[144:147]
    v_mfma_f32_16x16x32_bf16 v[148:151], v[48:51], a[40:43], v[148:151]
    v_mfma_f32_16x16x32_bf16 v[148:151], v[52:55], a[44:47], v[148:151]
    v_mfma_f32_16x16x32_bf16 v[152:155], v[48:51], a[48:51], v[152:155]
    buffer_load_dwordx4 v5, s[16:19], s60 offen offset:3072 nt lds
    v_mfma_f32_16x16x32_bf16 v[152:155], v[52:55], a[52:55], v[152:155]
    ds_read_b128 a[72:75], v22 offset:18432
    v_mfma_f32_16x16x32_bf16 v[156:159], v[48:51], a[56:59], v[156:159]
    ds_read_b64_tr_b16 v[48:49], v17 offset:0
    ds_read_b64_tr_b16 v[50:51], v17 offset:1024
    v_mfma_f32_16x16x32_bf16 v[156:159], v[52:55], a[60:63], v[156:159]
    ds_read_b64_tr_b16 v[52:53], v17 offset:8192
    ds_read_b64_tr_b16 v[54:55], v17 offset:9216
    v_mfma_f32_16x16x32_bf16 v[160:163], v[56:59], a[0:3], v[160:163]
    v_mfma_f32_16x16x32_bf16 v[160:163], v[60:63], a[4:7], v[160:163]
    v_mfma_f32_16x16x32_bf16 v[164:167], v[56:59], a[8:11], v[164:167]
    ds_read_b128 a[76:79], v23 offset:18432
    v_mfma_f32_16x16x32_bf16 v[164:167], v[60:63], a[12:15], v[164:167]
    s_add_u32 m0, s69, 114688
    v_mfma_f32_16x16x32_bf16 v[168:171], v[56:59], a[16:19], v[168:171]
    s_xor_b32 s60, s60, 3670016
    buffer_load_dwordx4 v6, s[8:11], s62 offen lds
    v_mfma_f32_16x16x32_bf16 v[168:171], v[60:63], a[20:23], v[168:171]
    v_mfma_f32_16x16x32_bf16 v[172:175], v[56:59], a[24:27], v[172:175]
    v_mfma_f32_16x16x32_bf16 v[172:175], v[60:63], a[28:31], v[172:175]
    v_mfma_f32_16x16x32_bf16 v[176:179], v[56:59], a[32:35], v[176:179]
    ds_read_b128 a[80:83], v22 offset:20480
    v_mfma_f32_16x16x32_bf16 v[176:179], v[60:63], a[36:39], v[176:179]
    v_mfma_f32_16x16x32_bf16 v[180:183], v[56:59], a[40:43], v[180:183]
    v_mfma_f32_16x16x32_bf16 v[180:183], v[60:63], a[44:47], v[180:183]
    buffer_load_dwordx4 v7, s[8:11], s62 offen offset:1024 lds
    v_mfma_f32_16x16x32_bf16 v[184:187], v[56:59], a[48:51], v[184:187]
    v_mfma_f32_16x16x32_bf16 v[184:187], v[60:63], a[52:55], v[184:187]
    ds_read_b128 a[84:87], v23 offset:20480
    v_mfma_f32_16x16x32_bf16 v[188:191], v[56:59], a[56:59], v[188:191]
    s_waitcnt lgkmcnt(1)
    ds_read_b64_tr_b16 v[56:57], v14 offset:32768
    ds_read_b64_tr_b16 v[58:59], v14 offset:33792
    v_mfma_f32_16x16x32_bf16 v[188:191], v[60:63], a[60:63], v[188:191]
    ds_read_b64_tr_b16 v[60:61], v14 offset:40960
    ds_read_b64_tr_b16 v[62:63], v14 offset:41984
    v_mfma_f32_16x16x32_bf16 v[192:195], v[40:43], a[0:3], v[192:195]
    v_add_u32 v14, 0x10000, v14
    v_mfma_f32_16x16x32_bf16 v[192:195], v[44:47], a[4:7], v[192:195]
    v_mfma_f32_16x16x32_bf16 v[196:199], v[40:43], a[8:11], v[196:199]
    v_mfma_f32_16x16x32_bf16 v[196:199], v[44:47], a[12:15], v[196:199]
    buffer_load_dwordx4 v8, s[8:11], s62 offen offset:2048 lds
    v_mfma_f32_16x16x32_bf16 v[200:203], v[40:43], a[16:19], v[200:203]
    ds_read_b128 a[88:91], v22 offset:22528
    v_mfma_f32_16x16x32_bf16 v[200:203], v[44:47], a[20:23], v[200:203]
    v_mfma_f32_16x16x32_bf16 v[204:207], v[40:43], a[24:27], v[204:207]
    v_mfma_f32_16x16x32_bf16 v[204:207], v[44:47], a[28:31], v[204:207]
    v_mfma_f32_16x16x32_bf16 v[208:211], v[40:43], a[32:35], v[208:211]
    ds_read_b128 a[92:95], v23 offset:22528
    v_mfma_f32_16x16x32_bf16 v[208:211], v[44:47], a[36:39], v[208:211]
    v_mfma_f32_16x16x32_bf16 v[212:215], v[40:43], a[40:43], v[212:215]
    buffer_load_dwordx4 v9, s[8:11], s62 offen offset:3072 lds
    v_mfma_f32_16x16x32_bf16 v[212:215], v[44:47], a[44:47], v[212:215]
    v_mfma_f32_16x16x32_bf16 v[216:219], v[40:43], a[48:51], v[216:219]
    v_mfma_f32_16x16x32_bf16 v[216:219], v[44:47], a[52:55], v[216:219]
    v_mfma_f32_16x16x32_bf16 v[220:223], v[40:43], a[56:59], v[220:223]
    ds_read_b64_tr_b16 v[40:41], v15 offset:32768
    ds_read_b64_tr_b16 v[42:43], v15 offset:33792
    v_mfma_f32_16x16x32_bf16 v[220:223], v[44:47], a[60:63], v[220:223]
    ds_read_b64_tr_b16 v[44:45], v15 offset:40960
    ds_read_b64_tr_b16 v[46:47], v15 offset:41984
    v_mfma_f32_16x16x32_bf16 v[224:227], v[48:51], a[0:3], v[224:227]
    v_add_u32 v15, 0x10000, v15
    v_mfma_f32_16x16x32_bf16 v[224:227], v[52:55], a[4:7], v[224:227]
    s_xor_b32 s62, s62, 128
    v_mfma_f32_16x16x32_bf16 v[228:231], v[48:51], a[8:11], v[228:231]
    buffer_load_dword v106, v103, s[24:27], s77 offen
    v_mfma_f32_16x16x32_bf16 v[228:231], v[52:55], a[12:15], v[228:231]
    s_add_u32 s77, s77, 4608
    v_mfma_f32_16x16x32_bf16 v[232:235], v[48:51], a[16:19], v[232:235]
    v_mfma_f32_16x16x32_bf16 v[232:235], v[52:55], a[20:23], v[232:235]
    s_add_u32 m0, s69, 131072
    v_mfma_f32_16x16x32_bf16 v[236:239], v[48:51], a[24:27], v[236:239]
    buffer_load_dwordx4 v2, s[12:15], s60 offen nt lds
    v_mfma_f32_16x16x32_bf16 v[236:239], v[52:55], a[28:31], v[236:239]
    v_mfma_f32_16x16x32_bf16 v[240:243], v[48:51], a[32:35], v[240:243]
    v_mfma_f32_16x16x32_bf16 v[240:243], v[52:55], a[36:39], v[240:243]
    v_mfma_f32_16x16x32_bf16 v[244:247], v[48:51], a[40:43], v[244:247]
    v_mfma_f32_16x16x32_bf16 v[244:247], v[52:55], a[44:47], v[244:247]
    v_mfma_f32_16x16x32_bf16 v[248:251], v[48:51], a[48:51], v[248:251]
    v_mfma_f32_16x16x32_bf16 v[248:251], v[52:55], a[52:55], v[248:251]
    buffer_load_dwordx4 v3, s[12:15], s60 offen offset:1024 nt lds
    v_mfma_f32_16x16x32_bf16 v[252:255], v[48:51], a[56:59], v[252:255]
    ds_read_b64_tr_b16 v[48:49], v16 offset:32768
    ds_read_b64_tr_b16 v[50:51], v16 offset:33792
    v_mfma_f32_16x16x32_bf16 v[252:255], v[52:55], a[60:63], v[252:255]
    s_waitcnt lgkmcnt(2)
    ds_read_b64_tr_b16 v[52:53], v16 offset:40960
    ds_read_b64_tr_b16 v[54:55], v16 offset:41984
    v_mfma_f32_16x16x32_bf16 a[128:131], a[0:3], v[56:59], a[128:131]
    v_add_u32 v16, 0x10000, v16
    v_mfma_f32_16x16x32_bf16 a[128:131], a[4:7], v[60:63], a[128:131]
    v_mfma_f32_16x16x32_bf16 a[132:135], a[8:11], v[56:59], a[132:135]
    ds_read_b128 a[96:99], v22 offset:49152
    v_mfma_f32_16x16x32_bf16 a[132:135], a[12:15], v[60:63], a[132:135]
    v_mfma_f32_16x16x32_bf16 a[136:139], a[16:19], v[56:59], a[136:139]
    v_mfma_f32_16x16x32_bf16 a[136:139], a[20:23], v[60:63], a[136:139]
    buffer_load_dwordx4 v4, s[12:15], s60 offen offset:2048 nt lds
    v_mfma_f32_16x16x32_bf16 a[140:143], a[24:27], v[56:59], a[140:143]
    v_mfma_f32_16x16x32_bf16 a[140:143], a[28:31], v[60:63], a[140:143]
    ds_read_b128 a[100:103], v23 offset:49152
    v_mfma_f32_16x16x32_bf16 a[144:147], a[32:35], v[56:59], a[144:147]
    v_mfma_f32_16x16x32_bf16 a[144:147], a[36:39], v[60:63], a[144:147]
    v_mfma_f32_16x16x32_bf16 a[148:151], a[40:43], v[56:59], a[148:151]
    v_mfma_f32_16x16x32_bf16 a[148:151], a[44:47], v[60:63], a[148:151]
    v_mfma_f32_16x16x32_bf16 a[152:155], a[48:51], v[56:59], a[152:155]
    buffer_load_dwordx4 v5, s[12:15], s60 offen offset:3072 nt lds
    v_mfma_f32_16x16x32_bf16 a[152:155], a[52:55], v[60:63], a[152:155]
    ds_read_b128 a[104:107], v22 offset:51200
    v_mfma_f32_16x16x32_bf16 a[156:159], a[56:59], v[56:59], a[156:159]
    ds_read_b64_tr_b16 v[56:57], v17 offset:32768
    ds_read_b64_tr_b16 v[58:59], v17 offset:33792
    v_mfma_f32_16x16x32_bf16 a[156:159], a[60:63], v[60:63], a[156:159]
    ds_read_b64_tr_b16 v[60:61], v17 offset:40960
    ds_read_b64_tr_b16 v[62:63], v17 offset:41984
    v_mfma_f32_16x16x32_bf16 a[160:163], a[0:3], v[40:43], a[160:163]
    v_add_u32 v17, 0x10000, v17
    v_mfma_f32_16x16x32_bf16 a[160:163], a[4:7], v[44:47], a[160:163]
    v_mfma_f32_16x16x32_bf16 a[164:167], a[8:11], v[40:43], a[164:167]
    ds_read_b128 a[108:111], v23 offset:51200
    v_mfma_f32_16x16x32_bf16 a[164:167], a[12:15], v[44:47], a[164:167]
    s_add_u32 m0, s69, 147456
    v_mfma_f32_16x16x32_bf16 a[168:171], a[16:19], v[40:43], a[168:171]
    buffer_load_dwordx4 v6, s[8:11], s61 offen lds
    v_mfma_f32_16x16x32_bf16 a[168:171], a[20:23], v[44:47], a[168:171]
    v_mfma_f32_16x16x32_bf16 a[172:175], a[24:27], v[40:43], a[172:175]
    v_mfma_f32_16x16x32_bf16 a[172:175], a[28:31], v[44:47], a[172:175]
    v_mfma_f32_16x16x32_bf16 a[176:179], a[32:35], v[40:43], a[176:179]
    ds_read_b128 a[112:115], v22 offset:53248
    v_mfma_f32_16x16x32_bf16 a[176:179], a[36:39], v[44:47], a[176:179]
    v_mfma_f32_16x16x32_bf16 a[180:183], a[40:43], v[40:43], a[180:183]
    v_mfma_f32_16x16x32_bf16 a[180:183], a[44:47], v[44:47], a[180:183]
    buffer_load_dwordx4 v7, s[8:11], s61 offen offset:1024 lds
    v_mfma_f32_16x16x32_bf16 a[184:187], a[48:51], v[40:43], a[184:187]
    v_mfma_f32_16x16x32_bf16 a[184:187], a[52:55], v[44:47], a[184:187]
    ds_read_b128 a[116:119], v23 offset:53248
    v_mfma_f32_16x16x32_bf16 a[188:191], a[56:59], v[40:43], a[188:191]
    v_mfma_f32_16x16x32_bf16 a[188:191], a[60:63], v[44:47], a[188:191]
    s_waitcnt lgkmcnt(1)
    v_mfma_f32_16x16x32_bf16 a[192:195], a[0:3], v[48:51], a[192:195]
    v_mfma_f32_16x16x32_bf16 a[192:195], a[4:7], v[52:55], a[192:195]
    v_mfma_f32_16x16x32_bf16 a[196:199], a[8:11], v[48:51], a[196:199]
    v_mfma_f32_16x16x32_bf16 a[196:199], a[12:15], v[52:55], a[196:199]
    buffer_load_dwordx4 v8, s[8:11], s61 offen offset:2048 lds
    v_mfma_f32_16x16x32_bf16 a[200:203], a[16:19], v[48:51], a[200:203]
    ds_read_b128 a[120:123], v22 offset:55296
    v_mfma_f32_16x16x32_bf16 a[200:203], a[20:23], v[52:55], a[200:203]
    v_mfma_f32_16x16x32_bf16 a[204:207], a[24:27], v[48:51], a[204:207]
    v_mfma_f32_16x16x32_bf16 a[204:207], a[28:31], v[52:55], a[204:207]
    v_mfma_f32_16x16x32_bf16 a[208:211], a[32:35], v[48:51], a[208:211]
    ds_read_b128 a[124:127], v23 offset:55296
    v_mfma_f32_16x16x32_bf16 a[208:211], a[36:39], v[52:55], a[208:211]
    v_mfma_f32_16x16x32_bf16 a[212:215], a[40:43], v[48:51], a[212:215]
    buffer_load_dwordx4 v9, s[8:11], s61 offen offset:3072 lds
    v_mfma_f32_16x16x32_bf16 a[212:215], a[44:47], v[52:55], a[212:215]
    v_mfma_f32_16x16x32_bf16 a[216:219], a[48:51], v[48:51], a[216:219]
    v_mfma_f32_16x16x32_bf16 a[216:219], a[52:55], v[52:55], a[216:219]
    v_mfma_f32_16x16x32_bf16 a[220:223], a[56:59], v[48:51], a[220:223]
    v_mfma_f32_16x16x32_bf16 a[220:223], a[60:63], v[52:55], a[220:223]
    v_mfma_f32_16x16x32_bf16 a[224:227], a[0:3], v[56:59], a[224:227]
    v_mfma_f32_16x16x32_bf16 a[224:227], a[4:7], v[60:63], a[224:227]
    s_xor_b32 s61, s61, 384
    v_mfma_f32_16x16x32_bf16 a[228:231], a[8:11], v[56:59], a[228:231]
    v_mfma_f32_16x16x32_bf16 a[228:231], a[12:15], v[60:63], a[228:231]
    v_mfma_f32_16x16x32_bf16 a[232:235], a[16:19], v[56:59], a[232:235]
    v_mfma_f32_16x16x32_bf16 a[232:235], a[20:23], v[60:63], a[232:235]
    s_waitcnt vmcnt(9) lgkmcnt(0)
    s_barrier
    ds_read_b64_tr_b16 v[40:41], v14 offset:0
    v_mfma_f32_16x16x32_bf16 a[236:239], a[24:27], v[56:59], a[236:239]
    s_add_u32 m0, s69, 0
    ds_read_b64_tr_b16 v[42:43], v14 offset:1024
    ds_read_b64_tr_b16 v[44:45], v14 offset:8192
    v_mfma_f32_16x16x32_bf16 a[236:239], a[28:31], v[60:63], a[236:239]
    buffer_load_dwordx4 v2, s[16:19], s60 offen nt lds
    v_mfma_f32_16x16x32_bf16 a[240:243], a[32:35], v[56:59], a[240:243]
    ds_read_b64_tr_b16 v[46:47], v14 offset:9216
    v_cndmask_b32 v82, v82, v92, s[92:93]
    v_mfma_f32_16x16x32_bf16 a[240:243], a[36:39], v[60:63], a[240:243]
    v_cndmask_b32_e64 v83, v83, 0, s[92:93]
    v_xor_b32 v92, s98, v95
    v_mfma_f32_16x16x32_bf16 a[244:247], a[40:43], v[56:59], a[244:247]
    buffer_store_dwordx4 v[80:83], v92, s[28:31], s72 offen sc1
    v_mfma_f32_16x16x32_bf16 a[244:247], a[44:47], v[60:63], a[244:247]
    s_mul_i32 s72, s2, 3
    ds_read_b64_tr_b16 v[48:49], v15 offset:0
    ds_read_b64_tr_b16 v[50:51], v15 offset:1024
    v_mfma_f32_16x16x32_bf16 a[248:251], a[48:51], v[56:59], a[248:251]
    s_add_u32 s72, s72, 1
    ds_read_b64_tr_b16 v[52:53], v15 offset:8192
    ds_read_b64_tr_b16 v[54:55], v15 offset:9216
    v_mfma_f32_16x16x32_bf16 a[248:251], a[52:55], v[60:63], a[248:251]
    s_bfe_u32 s98, s72, 0x10001
    buffer_load_dwordx4 v3, s[16:19], s60 offen offset:1024 nt lds
    v_mfma_f32_16x16x32_bf16 a[252:255], a[56:59], v[56:59], a[252:255]
    s_bfe_u32 s99, s72, 0x10003
    v_cndmask_b32 v86, v86, v93, s[92:93]
    v_cndmask_b32_e64 v87, v87, 0, s[92:93]
    v_mfma_f32_16x16x32_bf16 a[252:255], a[60:63], v[60:63], a[252:255]
    s_lshl1_add_u32 s98, s99, s98
    v_cndmask_b32 v90, v90, v94, s[92:93]
    v_cndmask_b32_e64 v91, v91, 0, s[92:93]
    s_waitcnt lgkmcnt(4)
    v_mfma_f32_16x16x32_bf16 v[128:131], v[40:43], a[64:67], v[128:131]
    s_lshl_b32 s98, s98, 5
    v_xor_b32 v93, s98, v95
    ds_read_b64_tr_b16 v[56:57], v16 offset:0
    v_mfma_f32_16x16x32_bf16 v[128:131], v[44:47], a[68:71], v[128:131]
    s_lshl_b32 s72, s72, 7
    v_add_u32 v22, 0x10000, v22
    ds_read_b64_tr_b16 v[58:59], v16 offset:1024
    v_mfma_f32_16x16x32_bf16 v[132:135], v[40:43], a[72:75], v[132:135]
    ds_read_b128 a[0:3], v22 offset:16384
    ds_read_b64_tr_b16 v[60:61], v16 offset:8192
    v_mfma_f32_16x16x32_bf16 v[132:135], v[44:47], a[76:79], v[132:135]
    s_cmp_lt_u32 s2, 192
    s_cselect_b32 s72, s72, 1073741824
    ds_read_b64_tr_b16 v[62:63], v16 offset:9216
    v_mfma_f32_16x16x32_bf16 v[136:139], v[40:43], a[80:83], v[136:139]
    buffer_store_dwordx4 v[84:87], v93, s[28:31], s72 offen sc1
    v_mfma_f32_16x16x32_bf16 v[136:139], v[44:47], a[84:87], v[136:139]
    s_mul_i32 s72, s2, 3
    buffer_load_dwordx4 v4, s[16:19], s60 offen offset:2048 nt lds
    v_mfma_f32_16x16x32_bf16 v[140:143], v[40:43], a[88:91], v[140:143]
    s_add_u32 s72, s72, 2
    v_add_u32 v23, 0x10000, v23
    v_mfma_f32_16x16x32_bf16 v[140:143], v[44:47], a[92:95], v[140:143]
    s_bfe_u32 s98, s72, 0x10001
    ds_read_b128 a[4:7], v23 offset:16384
    v_mfma_f32_16x16x32_bf16 v[144:147], v[40:43], a[96:99], v[144:147]
    s_bfe_u32 s99, s72, 0x10003
    v_mfma_f32_16x16x32_bf16 v[144:147], v[44:47], a[100:103], v[144:147]
    s_lshl1_add_u32 s98, s99, s98
    v_mfma_f32_16x16x32_bf16 v[148:151], v[40:43], a[104:107], v[148:151]
    s_lshl_b32 s98, s98, 5
    v_xor_b32 v94, s98, v95
    v_mfma_f32_16x16x32_bf16 v[148:151], v[44:47], a[108:111], v[148:151]
    s_lshl_b32 s72, s72, 7
    v_mfma_f32_16x16x32_bf16 v[152:155], v[40:43], a[112:115], v[152:155]
    s_bfe_u32 s98, s5, 0x20001
    buffer_load_dwordx4 v5, s[16:19], s60 offen offset:3072 nt lds
    v_mfma_f32_16x16x32_bf16 v[152:155], v[44:47], a[116:119], v[152:155]
    s_lshl2_add_u32 s99, s100, s4
    ds_read_b128 a[8:11], v22 offset:18432
    v_mfma_f32_16x16x32_bf16 v[156:159], v[40:43], a[120:123], v[156:159]
    s_cmp_lt_u32 s2, 192
    s_cselect_b32 s72, s72, 1073741824
    ds_read_b64_tr_b16 v[40:41], v17 offset:0
    v_mfma_f32_16x16x32_bf16 v[156:159], v[44:47], a[124:127], v[156:159]
    s_lshl_b32 s99, s99, 7
    buffer_store_dwordx4 v[88:91], v94, s[28:31], s72 offen sc1
    s_waitcnt lgkmcnt(2)
    v_mfma_f32_16x16x32_bf16 v[160:163], v[48:51], a[64:67], v[160:163]
    s_mov_b32 s30, 73728
    ds_read_b64_tr_b16 v[42:43], v17 offset:1024
    ds_read_b64_tr_b16 v[44:45], v17 offset:8192
    v_mfma_f32_16x16x32_bf16 v[160:163], v[52:55], a[68:71], v[160:163]
    ds_read_b64_tr_b16 v[46:47], v17 offset:9216
    v_mfma_f32_16x16x32_bf16 v[164:167], v[48:51], a[72:75], v[164:167]
    ds_read_b128 a[12:15], v23 offset:18432
    v_mfma_f32_16x16x32_bf16 v[164:167], v[52:55], a[76:79], v[164:167]
    s_add_u32 m0, s69, 16384
    v_mfma_f32_16x16x32_bf16 v[168:171], v[48:51], a[80:83], v[168:171]
    s_xor_b32 s60, s60, 524288
    buffer_load_dwordx4 v6, s[8:11], s62 offen lds
    v_mfma_f32_16x16x32_bf16 v[168:171], v[52:55], a[84:87], v[168:171]
    s_add_u32 s28, s28, s7
    s_addc_u32 s29, s29, 0
    v_mfma_f32_16x16x32_bf16 v[172:175], v[48:51], a[88:91], v[172:175]
    s_and_b32 s7, s5, 24
    v_mfma_f32_16x16x32_bf16 v[172:175], v[52:55], a[92:95], v[172:175]
    s_add_u32 s7, s7, s6
    v_mfma_f32_16x16x32_bf16 v[176:179], v[48:51], a[96:99], v[176:179]
    s_lshl2_add_u32 s7, s7, s98
    ds_read_b128 a[16:19], v22 offset:20480
    v_mfma_f32_16x16x32_bf16 v[176:179], v[52:55], a[100:103], v[176:179]
    s_mul_i32 s98, s7, 36864
    v_add_u32 v36, s98, v36
    v_sub_u32 v39, v36, v39
    v_mfma_f32_16x16x32_bf16 v[180:183], v[48:51], a[104:107], v[180:183]
    v_lshl_add_u32 v36, s100, 6, v36
    v_mfma_f32_16x16x32_bf16 v[180:183], v[52:55], a[108:111], v[180:183]
    buffer_load_dwordx4 v7, s[8:11], s62 offen offset:1024 lds
    v_mfma_f32_16x16x32_bf16 v[184:187], v[48:51], a[112:115], v[184:187]
    v_mfma_f32_16x16x32_bf16 v[184:187], v[52:55], a[116:119], v[184:187]
    ds_read_b128 a[20:23], v23 offset:20480
    v_mfma_f32_16x16x32_bf16 v[188:191], v[48:51], a[120:123], v[188:191]
    ds_read_b64_tr_b16 v[48:49], v14 offset:32768
    ds_read_b64_tr_b16 v[50:51], v14 offset:33792
    v_mfma_f32_16x16x32_bf16 v[188:191], v[52:55], a[124:127], v[188:191]
    ds_read_b64_tr_b16 v[52:53], v14 offset:40960
    ds_read_b64_tr_b16 v[54:55], v14 offset:41984
    v_mfma_f32_16x16x32_bf16 v[192:195], v[56:59], a[64:67], v[192:195]
    v_add_u32 v14, 0x10000, v14
    v_mfma_f32_16x16x32_bf16 v[192:195], v[60:63], a[68:71], v[192:195]
    v_mfma_f32_16x16x32_bf16 v[196:199], v[56:59], a[72:75], v[196:199]
    v_mfma_f32_16x16x32_bf16 v[196:199], v[60:63], a[76:79], v[196:199]
    buffer_load_dwordx4 v8, s[8:11], s62 offen offset:2048 lds
    v_mfma_f32_16x16x32_bf16 v[200:203], v[56:59], a[80:83], v[200:203]
    ds_read_b128 a[24:27], v22 offset:22528
    v_mfma_f32_16x16x32_bf16 v[200:203], v[60:63], a[84:87], v[200:203]
    v_mfma_f32_16x16x32_bf16 v[204:207], v[56:59], a[88:91], v[204:207]
    v_mfma_f32_16x16x32_bf16 v[204:207], v[60:63], a[92:95], v[204:207]
    v_mfma_f32_16x16x32_bf16 v[208:211], v[56:59], a[96:99], v[208:211]
    ds_read_b128 a[28:31], v23 offset:22528
    v_mfma_f32_16x16x32_bf16 v[208:211], v[60:63], a[100:103], v[208:211]
    v_mfma_f32_16x16x32_bf16 v[212:215], v[56:59], a[104:107], v[212:215]
    buffer_load_dwordx4 v9, s[8:11], s62 offen offset:3072 lds
    v_mfma_f32_16x16x32_bf16 v[212:215], v[60:63], a[108:111], v[212:215]
    v_mfma_f32_16x16x32_bf16 v[216:219], v[56:59], a[112:115], v[216:219]
    v_mfma_f32_16x16x32_bf16 v[216:219], v[60:63], a[116:119], v[216:219]
    v_mfma_f32_16x16x32_bf16 v[220:223], v[56:59], a[120:123], v[220:223]
    s_waitcnt lgkmcnt(0)
    ds_read_b64_tr_b16 v[56:57], v15 offset:32768
    ds_read_b64_tr_b16 v[58:59], v15 offset:33792
    v_mfma_f32_16x16x32_bf16 v[220:223], v[60:63], a[124:127], v[220:223]
    ds_read_b64_tr_b16 v[60:61], v15 offset:40960
    ds_read_b64_tr_b16 v[62:63], v15 offset:41984
    v_mfma_f32_16x16x32_bf16 v[224:227], v[40:43], a[64:67], v[224:227]
    v_add_u32 v15, 0x10000, v15
    v_mfma_f32_16x16x32_bf16 v[224:227], v[44:47], a[68:71], v[224:227]
    s_xor_b32 s62, s62, 384
    v_mfma_f32_16x16x32_bf16 v[228:231], v[40:43], a[72:75], v[228:231]
    buffer_load_dword v107, v103, s[24:27], s77 offen
    v_mfma_f32_16x16x32_bf16 v[228:231], v[44:47], a[76:79], v[228:231]
    s_add_u32 s77, s77, 4608
    v_mfma_f32_16x16x32_bf16 v[232:235], v[40:43], a[80:83], v[232:235]
    v_mfma_f32_16x16x32_bf16 v[232:235], v[44:47], a[84:87], v[232:235]
    s_add_u32 m0, s69, 32768
    v_mfma_f32_16x16x32_bf16 v[236:239], v[40:43], a[88:91], v[236:239]
    buffer_load_dwordx4 v2, s[12:15], s60 offen nt lds
    v_mfma_f32_16x16x32_bf16 v[236:239], v[44:47], a[92:95], v[236:239]
    v_mfma_f32_16x16x32_bf16 v[240:243], v[40:43], a[96:99], v[240:243]
    v_mfma_f32_16x16x32_bf16 v[240:243], v[44:47], a[100:103], v[240:243]
    v_mfma_f32_16x16x32_bf16 v[244:247], v[40:43], a[104:107], v[244:247]
    v_mfma_f32_16x16x32_bf16 v[244:247], v[44:47], a[108:111], v[244:247]
    v_mfma_f32_16x16x32_bf16 v[248:251], v[40:43], a[112:115], v[248:251]
    v_mfma_f32_16x16x32_bf16 v[248:251], v[44:47], a[116:119], v[248:251]
    buffer_load_dwordx4 v3, s[12:15], s60 offen offset:1024 nt lds
    v_mfma_f32_16x16x32_bf16 v[252:255], v[40:43], a[120:123], v[252:255]
    ds_read_b64_tr_b16 v[40:41], v16 offset:32768
    ds_read_b64_tr_b16 v[42:43], v16 offset:33792
    v_mfma_f32_16x16x32_bf16 v[252:255], v[44:47], a[124:127], v[252:255]
    ds_read_b64_tr_b16 v[44:45], v16 offset:40960
    ds_read_b64_tr_b16 v[46:47], v16 offset:41984
    v_mfma_f32_16x16x32_bf16 a[128:131], a[64:67], v[48:51], a[128:131]
    v_add_u32 v16, 0x10000, v16
    v_mfma_f32_16x16x32_bf16 a[128:131], a[68:71], v[52:55], a[128:131]
    v_mfma_f32_16x16x32_bf16 a[132:135], a[72:75], v[48:51], a[132:135]
    ds_read_b128 a[32:35], v22 offset:49152
    v_mfma_f32_16x16x32_bf16 a[132:135], a[76:79], v[52:55], a[132:135]
    v_mfma_f32_16x16x32_bf16 a[136:139], a[80:83], v[48:51], a[136:139]
    v_mfma_f32_16x16x32_bf16 a[136:139], a[84:87], v[52:55], a[136:139]
    buffer_load_dwordx4 v4, s[12:15], s60 offen offset:2048 nt lds
    v_mfma_f32_16x16x32_bf16 a[140:143], a[88:91], v[48:51], a[140:143]
    v_mfma_f32_16x16x32_bf16 a[140:143], a[92:95], v[52:55], a[140:143]
    ds_read_b128 a[36:39], v23 offset:49152
    v_mfma_f32_16x16x32_bf16 a[144:147], a[96:99], v[48:51], a[144:147]
    v_mfma_f32_16x16x32_bf16 a[144:147], a[100:103], v[52:55], a[144:147]
    v_mfma_f32_16x16x32_bf16 a[148:151], a[104:107], v[48:51], a[148:151]
    v_mfma_f32_16x16x32_bf16 a[148:151], a[108:111], v[52:55], a[148:151]
    v_mfma_f32_16x16x32_bf16 a[152:155], a[112:115], v[48:51], a[152:155]
    buffer_load_dwordx4 v5, s[12:15], s60 offen offset:3072 nt lds
    v_mfma_f32_16x16x32_bf16 a[152:155], a[116:119], v[52:55], a[152:155]
    ds_read_b128 a[40:43], v22 offset:51200
    v_mfma_f32_16x16x32_bf16 a[156:159], a[120:123], v[48:51], a[156:159]
    ds_read_b64_tr_b16 v[48:49], v17 offset:32768
    ds_read_b64_tr_b16 v[50:51], v17 offset:33792
    v_mfma_f32_16x16x32_bf16 a[156:159], a[124:127], v[52:55], a[156:159]
    s_waitcnt lgkmcnt(3)
    ds_read_b64_tr_b16 v[52:53], v17 offset:40960
    ds_read_b64_tr_b16 v[54:55], v17 offset:41984
    v_mfma_f32_16x16x32_bf16 a[160:163], a[64:67], v[56:59], a[160:163]
    v_add_u32 v17, 0x10000, v17
    v_mfma_f32_16x16x32_bf16 a[160:163], a[68:71], v[60:63], a[160:163]
    v_mfma_f32_16x16x32_bf16 a[164:167], a[72:75], v[56:59], a[164:167]
    ds_read_b128 a[44:47], v23 offset:51200
    v_mfma_f32_16x16x32_bf16 a[164:167], a[76:79], v[60:63], a[164:167]
    s_add_u32 m0, s69, 49152
    v_mfma_f32_16x16x32_bf16 a[168:171], a[80:83], v[56:59], a[168:171]
    buffer_load_dwordx4 v6, s[8:11], s61 offen lds
    v_mfma_f32_16x16x32_bf16 a[168:171], a[84:87], v[60:63], a[168:171]
    v_mfma_f32_16x16x32_bf16 a[172:175], a[88:91], v[56:59], a[172:175]
    v_mfma_f32_16x16x32_bf16 a[172:175], a[92:95], v[60:63], a[172:175]
    v_mfma_f32_16x16x32_bf16 a[176:179], a[96:99], v[56:59], a[176:179]
    ds_read_b128 a[48:51], v22 offset:53248
    v_mfma_f32_16x16x32_bf16 a[176:179], a[100:103], v[60:63], a[176:179]
    v_mfma_f32_16x16x32_bf16 a[180:183], a[104:107], v[56:59], a[180:183]
    v_mfma_f32_16x16x32_bf16 a[180:183], a[108:111], v[60:63], a[180:183]
    buffer_load_dwordx4 v7, s[8:11], s61 offen offset:1024 lds
    v_mfma_f32_16x16x32_bf16 a[184:187], a[112:115], v[56:59], a[184:187]
    v_mfma_f32_16x16x32_bf16 a[184:187], a[116:119], v[60:63], a[184:187]
    ds_read_b128 a[52:55], v23 offset:53248
    v_mfma_f32_16x16x32_bf16 a[188:191], a[120:123], v[56:59], a[188:191]
    v_mfma_f32_16x16x32_bf16 a[188:191], a[124:127], v[60:63], a[188:191]
    v_mfma_f32_16x16x32_bf16 a[192:195], a[64:67], v[40:43], a[192:195]
    v_mfma_f32_16x16x32_bf16 a[192:195], a[68:71], v[44:47], a[192:195]
    v_mfma_f32_16x16x32_bf16 a[196:199], a[72:75], v[40:43], a[196:199]
    v_mfma_f32_16x16x32_bf16 a[196:199], a[76:79], v[44:47], a[196:199]
    buffer_load_dwordx4 v8, s[8:11], s61 offen offset:2048 lds
    v_mfma_f32_16x16x32_bf16 a[200:203], a[80:83], v[40:43], a[200:203]
    ds_read_b128 a[56:59], v22 offset:55296
    v_mfma_f32_16x16x32_bf16 a[200:203], a[84:87], v[44:47], a[200:203]
    v_mfma_f32_16x16x32_bf16 a[204:207], a[88:91], v[40:43], a[204:207]
    v_mfma_f32_16x16x32_bf16 a[204:207], a[92:95], v[44:47], a[204:207]
    v_mfma_f32_16x16x32_bf16 a[208:211], a[96:99], v[40:43], a[208:211]
    ds_read_b128 a[60:63], v23 offset:55296
    v_mfma_f32_16x16x32_bf16 a[208:211], a[100:103], v[44:47], a[208:211]
    v_mfma_f32_16x16x32_bf16 a[212:215], a[104:107], v[40:43], a[212:215]
    buffer_load_dwordx4 v9, s[8:11], s61 offen offset:3072 lds
    v_mfma_f32_16x16x32_bf16 a[212:215], a[108:111], v[44:47], a[212:215]
    v_mfma_f32_16x16x32_bf16 a[216:219], a[112:115], v[40:43], a[216:219]
    v_mfma_f32_16x16x32_bf16 a[216:219], a[116:119], v[44:47], a[216:219]
    v_mfma_f32_16x16x32_bf16 a[220:223], a[120:123], v[40:43], a[220:223]
    v_mfma_f32_16x16x32_bf16 a[220:223], a[124:127], v[44:47], a[220:223]
    s_waitcnt lgkmcnt(0)
    v_mfma_f32_16x16x32_bf16 a[224:227], a[64:67], v[48:51], a[224:227]
    v_mfma_f32_16x16x32_bf16 a[224:227], a[68:71], v[52:55], a[224:227]
    s_xor_b32 s61, s61, 128
    v_mfma_f32_16x16x32_bf16 a[228:231], a[72:75], v[48:51], a[228:231]
    v_mfma_f32_16x16x32_bf16 a[228:231], a[76:79], v[52:55], a[228:231]
    v_mfma_f32_16x16x32_bf16 a[232:235], a[80:83], v[48:51], a[232:235]
    v_mfma_f32_16x16x32_bf16 a[232:235], a[84:87], v[52:55], a[232:235]
    s_waitcnt vmcnt(9) lgkmcnt(0)
    s_barrier
    ds_read_b64_tr_b16 v[56:57], v14 offset:0
    v_mfma_f32_16x16x32_bf16 a[236:239], a[88:91], v[48:51], a[236:239]
    s_add_u32 m0, s69, 65536
    ds_read_b64_tr_b16 v[58:59], v14 offset:1024
    ds_read_b64_tr_b16 v[60:61], v14 offset:8192
    v_mfma_f32_16x16x32_bf16 a[236:239], a[92:95], v[52:55], a[236:239]
    buffer_load_dwordx4 v2, s[16:19], s60 offen nt lds
    v_mfma_f32_16x16x32_bf16 a[240:243], a[96:99], v[48:51], a[240:243]
    ds_read_b64_tr_b16 v[62:63], v14 offset:9216
    ds_read_b64_tr_b16 v[40:41], v15 offset:0
    v_mfma_f32_16x16x32_bf16 a[240:243], a[100:103], v[52:55], a[240:243]
    buffer_atomic_add v31, v30, s[44:47], s95 offen sc1
    v_mfma_f32_16x16x32_bf16 a[244:247], a[104:107], v[48:51], a[244:247]
    ds_read_b64_tr_b16 v[42:43], v15 offset:1024
    ds_read_b64_tr_b16 v[44:45], v15 offset:8192
    v_mfma_f32_16x16x32_bf16 a[244:247], a[108:111], v[52:55], a[244:247]
    ds_read_b64_tr_b16 v[46:47], v15 offset:9216
    v_add_u32 v14, 0xfffe0000, v14
    v_mfma_f32_16x16x32_bf16 a[248:251], a[112:115], v[48:51], a[248:251]
    v_add_u32 v15, 0xfffe0000, v15
    v_mfma_f32_16x16x32_bf16 a[248:251], a[116:119], v[52:55], a[248:251]
    buffer_load_dwordx4 v3, s[16:19], s60 offen offset:1024 nt lds
    v_mfma_f32_16x16x32_bf16 a[252:255], a[120:123], v[48:51], a[252:255]
    ds_read_b64_tr_b16 v[48:49], v16 offset:0
    ds_read_b64_tr_b16 v[50:51], v16 offset:1024
    v_mfma_f32_16x16x32_bf16 a[252:255], a[124:127], v[52:55], a[252:255]
    s_waitcnt lgkmcnt(3)
    ds_read_b64_tr_b16 v[52:53], v16 offset:8192
    ds_read_b64_tr_b16 v[54:55], v16 offset:9216
    v_mfma_f32_16x16x32_bf16 v[128:131], v[56:59], a[0:3], v[128:131]
    v_add_u32 v16, 0xfffe0000, v16
    v_mfma_f32_16x16x32_bf16 v[128:131], v[60:63], a[4:7], v[128:131]
    v_add_u32 v22, 0x10000, v22
    v_mfma_f32_16x16x32_bf16 v[132:135], v[56:59], a[8:11], v[132:135]
    ds_read_b128 a[64:67], v22 offset:16384
    v_mfma_f32_16x16x32_bf16 v[132:135], v[60:63], a[12:15], v[132:135]
    v_mfma_f32_16x16x32_bf16 v[136:139], v[56:59], a[16:19], v[136:139]
    v_mfma_f32_16x16x32_bf16 v[136:139], v[60:63], a[20:23], v[136:139]
    buffer_load_dwordx4 v4, s[16:19], s60 offen offset:2048 nt lds
    v_mfma_f32_16x16x32_bf16 v[140:143], v[56:59], a[24:27], v[140:143]
    v_add_u32 v23, 0x10000, v23
    v_mfma_f32_16x16x32_bf16 v[140:143], v[60:63], a[28:31], v[140:143]
    ds_read_b128 a[68:71], v23 offset:16384
    v_mfma_f32_16x16x32_bf16 v[144:147], v[56:59], a[32:35], v[144:147]
    v_mfma_f32_16x16x32_bf16 v[144:147], v[60:63], a[36:39], v[144:147]
    v_mfma_f32_16x16x32_bf16 v[148:151], v[56:59], a[40:43], v[148:151]
    v_mfma_f32_16x16x32_bf16 v[148:151], v[60:63], a[44:47], v[148:151]
    v_mfma_f32_16x16x32_bf16 v[152:155], v[56:59], a[48:51], v[152:155]
    buffer_load_dwordx4 v5, s[16:19], s60 offen offset:3072 nt lds
    v_mfma_f32_16x16x32_bf16 v[152:155], v[60:63], a[52:55], v[152:155]
    ds_read_b128 a[72:75], v22 offset:18432
    v_mfma_f32_16x16x32_bf16 v[156:159], v[56:59], a[56:59], v[156:159]
    ds_read_b64_tr_b16 v[56:57], v17 offset:0
    ds_read_b64_tr_b16 v[58:59], v17 offset:1024
    v_mfma_f32_16x16x32_bf16 v[156:159], v[60:63], a[60:63], v[156:159]
    ds_read_b64_tr_b16 v[60:61], v17 offset:8192
    ds_read_b64_tr_b16 v[62:63], v17 offset:9216
    v_mfma_f32_16x16x32_bf16 v[160:163], v[40:43], a[0:3], v[160:163]
    s_waitcnt lgkmcnt(5)
    v_add_u32 v17, 0xfffe0000, v17
    v_mfma_f32_16x16x32_bf16 v[160:163], v[44:47], a[4:7], v[160:163]
    v_mfma_f32_16x16x32_bf16 v[164:167], v[40:43], a[8:11], v[164:167]
    ds_read_b128 a[76:79], v23 offset:18432
    v_mfma_f32_16x16x32_bf16 v[164:167], v[44:47], a[12:15], v[164:167]
    s_add_u32 m0, s69, 81920
    v_mfma_f32_16x16x32_bf16 v[168:171], v[40:43], a[16:19], v[168:171]
    s_xor_b32 s60, s60, 1572864
    buffer_load_dwordx4 v6, s[8:11], s62 offen lds
    v_mfma_f32_16x16x32_bf16 v[168:171], v[44:47], a[20:23], v[168:171]
    v_mfma_f32_16x16x32_bf16 v[172:175], v[40:43], a[24:27], v[172:175]
    v_mfma_f32_16x16x32_bf16 v[172:175], v[44:47], a[28:31], v[172:175]
    v_mfma_f32_16x16x32_bf16 v[176:179], v[40:43], a[32:35], v[176:179]
    ds_read_b128 a[80:83], v22 offset:20480
    v_mfma_f32_16x16x32_bf16 v[176:179], v[44:47], a[36:39], v[176:179]
    v_mfma_f32_16x16x32_bf16 v[180:183], v[40:43], a[40:43], v[180:183]
    v_mfma_f32_16x16x32_bf16 v[180:183], v[44:47], a[44:47], v[180:183]
    buffer_load_dwordx4 v7, s[8:11], s62 offen offset:1024 lds
    v_mfma_f32_16x16x32_bf16 v[184:187], v[40:43], a[48:51], v[184:187]
    v_mfma_f32_16x16x32_bf16 v[184:187], v[44:47], a[52:55], v[184:187]
    ds_read_b128 a[84:87], v23 offset:20480
    v_mfma_f32_16x16x32_bf16 v[188:191], v[40:43], a[56:59], v[188:191]
    ds_read_b64_tr_b16 v[40:41], v14 offset:0
    ds_read_b64_tr_b16 v[42:43], v14 offset:1024
    v_mfma_f32_16x16x32_bf16 v[188:191], v[44:47], a[60:63], v[188:191]
    ds_read_b64_tr_b16 v[44:45], v14 offset:8192
    ds_read_b64_tr_b16 v[46:47], v14 offset:9216
    v_mfma_f32_16x16x32_bf16 v[192:195], v[48:51], a[0:3], v[192:195]
    v_mfma_f32_16x16x32_bf16 v[192:195], v[52:55], a[4:7], v[192:195]
    v_mfma_f32_16x16x32_bf16 v[196:199], v[48:51], a[8:11], v[196:199]
    v_mfma_f32_16x16x32_bf16 v[196:199], v[52:55], a[12:15], v[196:199]
    buffer_load_dwordx4 v8, s[8:11], s62 offen offset:2048 lds
    v_mfma_f32_16x16x32_bf16 v[200:203], v[48:51], a[16:19], v[200:203]
    ds_read_b128 a[88:91], v22 offset:22528
    v_mfma_f32_16x16x32_bf16 v[200:203], v[52:55], a[20:23], v[200:203]
    v_mfma_f32_16x16x32_bf16 v[204:207], v[48:51], a[24:27], v[204:207]
    v_mfma_f32_16x16x32_bf16 v[204:207], v[52:55], a[28:31], v[204:207]
    v_mfma_f32_16x16x32_bf16 v[208:211], v[48:51], a[32:35], v[208:211]
    ds_read_b128 a[92:95], v23 offset:22528
    v_mfma_f32_16x16x32_bf16 v[208:211], v[52:55], a[36:39], v[208:211]
    v_mfma_f32_16x16x32_bf16 v[212:215], v[48:51], a[40:43], v[212:215]
    buffer_load_dwordx4 v9, s[8:11], s62 offen offset:3072 lds
    v_mfma_f32_16x16x32_bf16 v[212:215], v[52:55], a[44:47], v[212:215]
    v_mfma_f32_16x16x32_bf16 v[216:219], v[48:51], a[48:51], v[216:219]
    v_mfma_f32_16x16x32_bf16 v[216:219], v[52:55], a[52:55], v[216:219]
    v_mfma_f32_16x16x32_bf16 v[220:223], v[48:51], a[56:59], v[220:223]
    s_waitcnt lgkmcnt(0)
    ds_read_b64_tr_b16 v[48:49], v15 offset:0
    ds_read_b64_tr_b16 v[50:51], v15 offset:1024
    v_mfma_f32_16x16x32_bf16 v[220:223], v[52:55], a[60:63], v[220:223]
    ds_read_b64_tr_b16 v[52:53], v15 offset:8192
    ds_read_b64_tr_b16 v[54:55], v15 offset:9216
    v_mfma_f32_16x16x32_bf16 v[224:227], v[56:59], a[0:3], v[224:227]
    v_mfma_f32_16x16x32_bf16 v[224:227], v[60:63], a[4:7], v[224:227]
    s_xor_b32 s62, s62, 128
    v_mfma_f32_16x16x32_bf16 v[228:231], v[56:59], a[8:11], v[228:231]
    buffer_load_dword v108, v103, s[24:27], s77 offen
    v_mfma_f32_16x16x32_bf16 v[228:231], v[60:63], a[12:15], v[228:231]
    s_add_u32 s77, s77, 4608
    v_mfma_f32_16x16x32_bf16 v[232:235], v[56:59], a[16:19], v[232:235]
    v_mfma_f32_16x16x32_bf16 v[232:235], v[60:63], a[20:23], v[232:235]
    s_add_u32 m0, s69, 98304
    v_mfma_f32_16x16x32_bf16 v[236:239], v[56:59], a[24:27], v[236:239]
    buffer_load_dwordx4 v2, s[12:15], s60 offen nt lds
    v_mfma_f32_16x16x32_bf16 v[236:239], v[60:63], a[28:31], v[236:239]
    v_mfma_f32_16x16x32_bf16 v[240:243], v[56:59], a[32:35], v[240:243]
    v_mfma_f32_16x16x32_bf16 v[240:243], v[60:63], a[36:39], v[240:243]
    v_mfma_f32_16x16x32_bf16 v[244:247], v[56:59], a[40:43], v[244:247]
    v_mfma_f32_16x16x32_bf16 v[244:247], v[60:63], a[44:47], v[244:247]
    v_mfma_f32_16x16x32_bf16 v[248:251], v[56:59], a[48:51], v[248:251]
    v_mfma_f32_16x16x32_bf16 v[248:251], v[60:63], a[52:55], v[248:251]
    buffer_load_dwordx4 v3, s[12:15], s60 offen offset:1024 nt lds
    v_mfma_f32_16x16x32_bf16 v[252:255], v[56:59], a[56:59], v[252:255]
    ds_read_b64_tr_b16 v[56:57], v16 offset:0
    ds_read_b64_tr_b16 v[58:59], v16 offset:1024
    v_mfma_f32_16x16x32_bf16 v[252:255], v[60:63], a[60:63], v[252:255]
    ds_read_b64_tr_b16 v[60:61], v16 offset:8192
    ds_read_b64_tr_b16 v[62:63], v16 offset:9216
    v_mfma_f32_16x16x32_bf16 a[128:131], a[0:3], v[40:43], a[128:131]
    v_mfma_f32_16x16x32_bf16 a[128:131], a[4:7], v[44:47], a[128:131]
    v_add_u32 v22, 0xfffe0000, v22
    v_mfma_f32_16x16x32_bf16 a[132:135], a[8:11], v[40:43], a[132:135]
    ds_read_b128 a[96:99], v22 offset:16384
    v_mfma_f32_16x16x32_bf16 a[132:135], a[12:15], v[44:47], a[132:135]
    v_mfma_f32_16x16x32_bf16 a[136:139], a[16:19], v[40:43], a[136:139]
    v_mfma_f32_16x16x32_bf16 a[136:139], a[20:23], v[44:47], a[136:139]
    buffer_load_dwordx4 v4, s[12:15], s60 offen offset:2048 nt lds
    v_mfma_f32_16x16x32_bf16 a[140:143], a[24:27], v[40:43], a[140:143]
    v_add_u32 v23, 0xfffe0000, v23
    v_mfma_f32_16x16x32_bf16 a[140:143], a[28:31], v[44:47], a[140:143]
    ds_read_b128 a[100:103], v23 offset:16384
    v_mfma_f32_16x16x32_bf16 a[144:147], a[32:35], v[40:43], a[144:147]
    v_mfma_f32_16x16x32_bf16 a[144:147], a[36:39], v[44:47], a[144:147]
    v_mfma_f32_16x16x32_bf16 a[148:151], a[40:43], v[40:43], a[148:151]
    v_mfma_f32_16x16x32_bf16 a[148:151], a[44:47], v[44:47], a[148:151]
    v_mfma_f32_16x16x32_bf16 a[152:155], a[48:51], v[40:43], a[152:155]
    buffer_load_dwordx4 v5, s[12:15], s60 offen offset:3072 nt lds
    v_mfma_f32_16x16x32_bf16 a[152:155], a[52:55], v[44:47], a[152:155]
    ds_read_b128 a[104:107], v22 offset:18432
    v_mfma_f32_16x16x32_bf16 a[156:159], a[56:59], v[40:43], a[156:159]
    ds_read_b64_tr_b16 v[40:41], v17 offset:0
    ds_read_b64_tr_b16 v[42:43], v17 offset:1024
    v_mfma_f32_16x16x32_bf16 a[156:159], a[60:63], v[44:47], a[156:159]
    s_waitcnt lgkmcnt(3)
    ds_read_b64_tr_b16 v[44:45], v17 offset:8192
    ds_read_b64_tr_b16 v[46:47], v17 offset:9216
    v_mfma_f32_16x16x32_bf16 a[160:163], a[0:3], v[48:51], a[160:163]
    v_mfma_f32_16x16x32_bf16 a[160:163], a[4:7], v[52:55], a[160:163]
    v_mfma_f32_16x16x32_bf16 a[164:167], a[8:11], v[48:51], a[164:167]
    ds_read_b128 a[108:111], v23 offset:18432
    v_mfma_f32_16x16x32_bf16 a[164:167], a[12:15], v[52:55], a[164:167]
    s_add_u32 m0, s69, 114688
    v_mfma_f32_16x16x32_bf16 a[168:171], a[16:19], v[48:51], a[168:171]
    s_xor_b32 s60, s60, 524288
    buffer_load_dwordx4 v6, s[8:11], s61 offen lds
    v_mfma_f32_16x16x32_bf16 a[168:171], a[20:23], v[52:55], a[168:171]
    v_mfma_f32_16x16x32_bf16 a[172:175], a[24:27], v[48:51], a[172:175]
    v_mfma_f32_16x16x32_bf16 a[172:175], a[28:31], v[52:55], a[172:175]
    v_mfma_f32_16x16x32_bf16 a[176:179], a[32:35], v[48:51], a[176:179]
    ds_read_b128 a[112:115], v22 offset:20480
    v_mfma_f32_16x16x32_bf16 a[176:179], a[36:39], v[52:55], a[176:179]
    v_mfma_f32_16x16x32_bf16 a[180:183], a[40:43], v[48:51], a[180:183]
    v_mfma_f32_16x16x32_bf16 a[180:183], a[44:47], v[52:55], a[180:183]
    buffer_load_dwordx4 v7, s[8:11], s61 offen offset:1024 lds
    v_mfma_f32_16x16x32_bf16 a[184:187], a[48:51], v[48:51], a[184:187]
    v_mfma_f32_16x16x32_bf16 a[184:187], a[52:55], v[52:55], a[184:187]
    ds_read_b128 a[116:119], v23 offset:20480
    v_mfma_f32_16x16x32_bf16 a[188:191], a[56:59], v[48:51], a[188:191]
    v_mfma_f32_16x16x32_bf16 a[188:191], a[60:63], v[52:55], a[188:191]
    v_mfma_f32_16x16x32_bf16 a[192:195], a[0:3], v[56:59], a[192:195]
    v_mfma_f32_16x16x32_bf16 a[192:195], a[4:7], v[60:63], a[192:195]
    v_mfma_f32_16x16x32_bf16 a[196:199], a[8:11], v[56:59], a[196:199]
    v_mfma_f32_16x16x32_bf16 a[196:199], a[12:15], v[60:63], a[196:199]
    buffer_load_dwordx4 v8, s[8:11], s61 offen offset:2048 lds
    v_mfma_f32_16x16x32_bf16 a[200:203], a[16:19], v[56:59], a[200:203]
    ds_read_b128 a[120:123], v22 offset:22528
    v_mfma_f32_16x16x32_bf16 a[200:203], a[20:23], v[60:63], a[200:203]
    v_mfma_f32_16x16x32_bf16 a[204:207], a[24:27], v[56:59], a[204:207]
    v_mfma_f32_16x16x32_bf16 a[204:207], a[28:31], v[60:63], a[204:207]
    v_mfma_f32_16x16x32_bf16 a[208:211], a[32:35], v[56:59], a[208:211]
    ds_read_b128 a[124:127], v23 offset:22528
    v_mfma_f32_16x16x32_bf16 a[208:211], a[36:39], v[60:63], a[208:211]
    v_mfma_f32_16x16x32_bf16 a[212:215], a[40:43], v[56:59], a[212:215]
    buffer_load_dwordx4 v9, s[8:11], s61 offen offset:3072 lds
    v_mfma_f32_16x16x32_bf16 a[212:215], a[44:47], v[60:63], a[212:215]
    v_mfma_f32_16x16x32_bf16 a[216:219], a[48:51], v[56:59], a[216:219]
    v_mfma_f32_16x16x32_bf16 a[216:219], a[52:55], v[60:63], a[216:219]
    v_mfma_f32_16x16x32_bf16 a[220:223], a[56:59], v[56:59], a[220:223]
    v_mfma_f32_16x16x32_bf16 a[220:223], a[60:63], v[60:63], a[220:223]
    s_waitcnt lgkmcnt(0)
    v_mfma_f32_16x16x32_bf16 a[224:227], a[0:3], v[40:43], a[224:227]
    v_mfma_f32_16x16x32_bf16 a[224:227], a[4:7], v[44:47], a[224:227]
    s_xor_b32 s61, s61, 1920
    v_mfma_f32_16x16x32_bf16 a[228:231], a[8:11], v[40:43], a[228:231]
    s_andn2_b32 s61, s61, 896
    v_mfma_f32_16x16x32_bf16 a[228:231], a[12:15], v[44:47], a[228:231]
    s_lshl_b32 s61, s5, 7
    v_mfma_f32_16x16x32_bf16 a[232:235], a[16:19], v[40:43], a[232:235]
    v_mfma_f32_16x16x32_bf16 a[232:235], a[20:23], v[44:47], a[232:235]
    s_waitcnt vmcnt(9) lgkmcnt(0)
    s_barrier
    ds_read_b64_tr_b16 v[48:49], v14 offset:32768
    v_mfma_f32_16x16x32_bf16 a[236:239], a[24:27], v[40:43], a[236:239]
    s_add_u32 m0, s69, 131072
    ds_read_b64_tr_b16 v[50:51], v14 offset:33792
    ds_read_b64_tr_b16 v[52:53], v14 offset:40960
    v_mfma_f32_16x16x32_bf16 a[236:239], a[28:31], v[44:47], a[236:239]
    buffer_load_dwordx4 v2, s[12:15], s60 offen nt lds
    v_mfma_f32_16x16x32_bf16 a[240:243], a[32:35], v[40:43], a[240:243]
    ds_read_b64_tr_b16 v[54:55], v14 offset:41984
    ds_read_b64_tr_b16 v[56:57], v15 offset:32768
    v_mfma_f32_16x16x32_bf16 a[240:243], a[36:39], v[44:47], a[240:243]
    ds_read_b64_tr_b16 v[58:59], v15 offset:33792
    ds_read_b64_tr_b16 v[60:61], v15 offset:40960
    v_mfma_f32_16x16x32_bf16 a[244:247], a[40:43], v[40:43], a[244:247]
    ds_read_b64_tr_b16 v[62:63], v15 offset:41984
    v_add_u32 v14, 0x10000, v14
    v_mfma_f32_16x16x32_bf16 a[244:247], a[44:47], v[44:47], a[244:247]
    v_add_u32 v15, 0x10000, v15
    v_mfma_f32_16x16x32_bf16 a[248:251], a[48:51], v[40:43], a[248:251]
    v_mfma_f32_16x16x32_bf16 a[248:251], a[52:55], v[44:47], a[248:251]
    buffer_load_dwordx4 v3, s[12:15], s60 offen offset:1024 nt lds
    v_mfma_f32_16x16x32_bf16 a[252:255], a[56:59], v[40:43], a[252:255]
    ds_read_b64_tr_b16 v[40:41], v16 offset:32768
    ds_read_b64_tr_b16 v[42:43], v16 offset:33792
    v_mfma_f32_16x16x32_bf16 a[252:255], a[60:63], v[44:47], a[252:255]
    s_waitcnt lgkmcnt(2)
    ds_read_b64_tr_b16 v[44:45], v16 offset:40960
    ds_read_b64_tr_b16 v[46:47], v16 offset:41984
    v_mfma_f32_16x16x32_bf16 v[128:131], v[48:51], a[64:67], v[128:131]
    v_add_u32 v16, 0x10000, v16
    v_mfma_f32_16x16x32_bf16 v[128:131], v[52:55], a[68:71], v[128:131]
    v_mfma_f32_16x16x32_bf16 v[132:135], v[48:51], a[72:75], v[132:135]
    ds_read_b128 a[0:3], v22 offset:49152
    v_mfma_f32_16x16x32_bf16 v[132:135], v[52:55], a[76:79], v[132:135]
    v_mfma_f32_16x16x32_bf16 v[136:139], v[48:51], a[80:83], v[136:139]
    v_mfma_f32_16x16x32_bf16 v[136:139], v[52:55], a[84:87], v[136:139]
    buffer_load_dwordx4 v4, s[12:15], s60 offen offset:2048 nt lds
    v_mfma_f32_16x16x32_bf16 v[140:143], v[48:51], a[88:91], v[140:143]
    v_mfma_f32_16x16x32_bf16 v[140:143], v[52:55], a[92:95], v[140:143]
    ds_read_b128 a[4:7], v23 offset:49152
    v_mfma_f32_16x16x32_bf16 v[144:147], v[48:51], a[96:99], v[144:147]
    v_mfma_f32_16x16x32_bf16 v[144:147], v[52:55], a[100:103], v[144:147]
    v_mfma_f32_16x16x32_bf16 v[148:151], v[48:51], a[104:107], v[148:151]
    v_mfma_f32_16x16x32_bf16 v[148:151], v[52:55], a[108:111], v[148:151]
    v_mfma_f32_16x16x32_bf16 v[152:155], v[48:51], a[112:115], v[152:155]
    buffer_load_dwordx4 v5, s[12:15], s60 offen offset:3072 nt lds
    v_mfma_f32_16x16x32_bf16 v[152:155], v[52:55], a[116:119], v[152:155]
    ds_read_b128 a[8:11], v22 offset:51200
    v_mfma_f32_16x16x32_bf16 v[156:159], v[48:51], a[120:123], v[156:159]
    ds_read_b64_tr_b16 v[48:49], v17 offset:32768
    ds_read_b64_tr_b16 v[50:51], v17 offset:33792
    v_mfma_f32_16x16x32_bf16 v[156:159], v[52:55], a[124:127], v[156:159]
    ds_read_b64_tr_b16 v[52:53], v17 offset:40960
    ds_read_b64_tr_b16 v[54:55], v17 offset:41984
    v_mfma_f32_16x16x32_bf16 v[160:163], v[56:59], a[64:67], v[160:163]
    v_add_u32 v17, 0x10000, v17
    v_mfma_f32_16x16x32_bf16 v[160:163], v[60:63], a[68:71], v[160:163]
    s_cmp_lt_u32 s4, 0
    s_cselect_b32 s12, 0xf149f2ca, 0
    v_mfma_f32_16x16x32_bf16 v[164:167], v[56:59], a[72:75], v[164:167]
    ds_read_b128 a[12:15], v23 offset:51200
    v_mfma_f32_16x16x32_bf16 v[164:167], v[60:63], a[76:79], v[164:167]
    s_add_u32 m0, s69, 147456
    v_mfma_f32_16x16x32_bf16 v[168:171], v[56:59], a[80:83], v[168:171]
    s_xor_b32 s60, s60, 524288
    buffer_load_dwordx4 v6, s[8:11], s62 offen lds
    v_mfma_f32_16x16x32_bf16 v[168:171], v[60:63], a[84:87], v[168:171]
    v_mov_b32 v6, v96
    v_mfma_f32_16x16x32_bf16 v[172:175], v[56:59], a[88:91], v[172:175]
    s_cmp_lt_u32 s4, 1
    s_cselect_b32 s13, 0xf149f2ca, 0
    v_mfma_f32_16x16x32_bf16 v[172:175], v[60:63], a[92:95], v[172:175]
    s_cmp_lt_u32 s4, 2
    s_cselect_b32 s14, 0xf149f2ca, 0
    v_mfma_f32_16x16x32_bf16 v[176:179], v[56:59], a[96:99], v[176:179]
    ds_read_b128 a[16:19], v22 offset:53248
    v_mfma_f32_16x16x32_bf16 v[176:179], v[60:63], a[100:103], v[176:179]
    s_cmp_lt_u32 s4, 3
    s_cselect_b32 s15, 0xf149f2ca, 0
    v_mfma_f32_16x16x32_bf16 v[180:183], v[56:59], a[104:107], v[180:183]
    v_mfma_f32_16x16x32_bf16 v[180:183], v[60:63], a[108:111], v[180:183]
    buffer_load_dwordx4 v7, s[8:11], s62 offen offset:1024 lds
    v_mfma_f32_16x16x32_bf16 v[184:187], v[56:59], a[112:115], v[184:187]
    v_mfma_f32_16x16x32_bf16 v[184:187], v[60:63], a[116:119], v[184:187]
    ds_read_b128 a[20:23], v23 offset:53248
    v_mfma_f32_16x16x32_bf16 v[188:191], v[56:59], a[120:123], v[188:191]
    s_waitcnt lgkmcnt(1)
    ds_read_b64_tr_b16 v[56:57], v14 offset:0
    ds_read_b64_tr_b16 v[58:59], v14 offset:1024
    v_mfma_f32_16x16x32_bf16 v[188:191], v[60:63], a[124:127], v[188:191]
    ds_read_b64_tr_b16 v[60:61], v14 offset:8192
    ds_read_b64_tr_b16 v[62:63], v14 offset:9216
    v_mfma_f32_16x16x32_bf16 v[192:195], v[40:43], a[64:67], v[192:195]
    v_mfma_f32_16x16x32_bf16 v[192:195], v[44:47], a[68:71], v[192:195]
    v_mfma_f32_16x16x32_bf16 v[196:199], v[40:43], a[72:75], v[196:199]
    v_mfma_f32_16x16x32_bf16 v[196:199], v[44:47], a[76:79], v[196:199]
    buffer_load_dwordx4 v8, s[8:11], s62 offen offset:2048 lds
    v_mfma_f32_16x16x32_bf16 v[200:203], v[40:43], a[80:83], v[200:203]
    ds_read_b128 a[24:27], v22 offset:55296
    v_bfe_u32 v8, v1, 4, 3
    v_mfma_f32_16x16x32_bf16 v[200:203], v[44:47], a[84:87], v[200:203]
    v_lshlrev_b32 v8, 12, v8
    v_mfma_f32_16x16x32_bf16 v[204:207], v[40:43], a[88:91], v[204:207]
    v_mfma_f32_16x16x32_bf16 v[204:207], v[44:47], a[92:95], v[204:207]
    v_mfma_f32_16x16x32_bf16 v[208:211], v[40:43], a[96:99], v[208:211]
    ds_read_b128 a[28:31], v23 offset:55296
    v_mfma_f32_16x16x32_bf16 v[208:211], v[44:47], a[100:103], v[208:211]
    v_mfma_f32_16x16x32_bf16 v[212:215], v[40:43], a[104:107], v[212:215]
    buffer_load_dwordx4 v9, s[8:11], s62 offen offset:3072 lds
    v_mfma_f32_16x16x32_bf16 v[212:215], v[44:47], a[108:111], v[212:215]
    s_and_b32 s8, s5, 7
    v_lshrrev_b32 v9, 2, v1
    v_mfma_f32_16x16x32_bf16 v[216:219], v[40:43], a[112:115], v[216:219]
    s_lshl3_add_u32 s8, s6, s8
    v_mfma_f32_16x16x32_bf16 v[216:219], v[44:47], a[116:119], v[216:219]
    s_mul_hi_u32 s98, s8, 715827883
    v_mfma_f32_16x16x32_bf16 v[220:223], v[40:43], a[120:123], v[220:223]
    s_lshr_b32 s10, s5, 3
    ds_read_b64_tr_b16 v[40:41], v15 offset:0
    ds_read_b64_tr_b16 v[42:43], v15 offset:1024
    v_mfma_f32_16x16x32_bf16 v[220:223], v[44:47], a[124:127], v[220:223]
    ds_read_b64_tr_b16 v[44:45], v15 offset:8192
    ds_read_b64_tr_b16 v[46:47], v15 offset:9216
    v_mfma_f32_16x16x32_bf16 v[224:227], v[48:51], a[64:67], v[224:227]
    s_cmp_eq_u32 s4, 3
    s_cselect_b32 s11, 1.0, 0
    v_mfma_f32_16x16x32_bf16 v[224:227], v[52:55], a[68:71], v[224:227]
    s_xor_b32 s62, s62, 1920
    v_mfma_f32_16x16x32_bf16 v[228:231], v[48:51], a[72:75], v[228:231]
    s_andn2_b32 s62, s62, 896
    buffer_load_dword v109, v103, s[24:27], s77 offen
    v_mfma_f32_16x16x32_bf16 v[228:231], v[52:55], a[76:79], v[228:231]
    v_mfma_f32_16x16x32_bf16 v[232:235], v[48:51], a[80:83], v[232:235]
    v_mfma_f32_16x16x32_bf16 v[232:235], v[52:55], a[84:87], v[232:235]
    s_add_u32 m0, s69, 0
    v_mfma_f32_16x16x32_bf16 v[236:239], v[48:51], a[88:91], v[236:239]
    buffer_load_dwordx4 v2, s[16:19], s60 offen nt lds
    v_mfma_f32_16x16x32_bf16 v[236:239], v[52:55], a[92:95], v[236:239]
    v_mfma_f32_16x16x32_bf16 v[240:243], v[48:51], a[96:99], v[240:243]
    v_mfma_f32_16x16x32_bf16 v[240:243], v[52:55], a[100:103], v[240:243]
    v_mfma_f32_16x16x32_bf16 v[244:247], v[48:51], a[104:107], v[244:247]
    v_mfma_f32_16x16x32_bf16 v[244:247], v[52:55], a[108:111], v[244:247]
    v_mfma_f32_16x16x32_bf16 v[248:251], v[48:51], a[112:115], v[248:251]
    v_mfma_f32_16x16x32_bf16 v[248:251], v[52:55], a[116:119], v[248:251]
    buffer_load_dwordx4 v3, s[16:19], s60 offen offset:1024 nt lds
    v_mfma_f32_16x16x32_bf16 v[252:255], v[48:51], a[120:123], v[252:255]
    ds_read_b64_tr_b16 v[48:49], v16 offset:0
    ds_read_b64_tr_b16 v[50:51], v16 offset:1024
    v_mfma_f32_16x16x32_bf16 v[252:255], v[52:55], a[124:127], v[252:255]
    s_waitcnt lgkmcnt(2)
    ds_read_b64_tr_b16 v[52:53], v16 offset:8192
    ds_read_b64_tr_b16 v[54:55], v16 offset:9216
    v_mfma_f32_16x16x32_bf16 a[128:131], a[64:67], v[56:59], a[128:131]
    v_mfma_f32_16x16x32_bf16 a[128:131], a[68:71], v[60:63], a[128:131]
    v_add_u32 v22, 0x10000, v22
    v_mfma_f32_16x16x32_bf16 a[132:135], a[72:75], v[56:59], a[132:135]
    ds_read_b128 a[32:35], v22 offset:16384
    v_mfma_f32_16x16x32_bf16 a[132:135], a[76:79], v[60:63], a[132:135]
    v_mfma_f32_16x16x32_bf16 a[136:139], a[80:83], v[56:59], a[136:139]
    v_mfma_f32_16x16x32_bf16 a[136:139], a[84:87], v[60:63], a[136:139]
    buffer_load_dwordx4 v4, s[16:19], s60 offen offset:2048 nt lds
    v_mfma_f32_16x16x32_bf16 a[140:143], a[88:91], v[56:59], a[140:143]
    v_add_u32 v23, 0x10000, v23
    v_mfma_f32_16x16x32_bf16 a[140:143], a[92:95], v[60:63], a[140:143]
    ds_read_b128 a[36:39], v23 offset:16384
    v_mfma_f32_16x16x32_bf16 a[144:147], a[96:99], v[56:59], a[144:147]
    v_mfma_f32_16x16x32_bf16 a[144:147], a[100:103], v[60:63], a[144:147]
    v_mfma_f32_16x16x32_bf16 a[148:151], a[104:107], v[56:59], a[148:151]
    v_mfma_f32_16x16x32_bf16 a[148:151], a[108:111], v[60:63], a[148:151]
    v_mfma_f32_16x16x32_bf16 a[152:155], a[112:115], v[56:59], a[152:155]
    buffer_load_dwordx4 v5, s[16:19], s60 offen offset:3072 nt lds
    v_mfma_f32_16x16x32_bf16 a[152:155], a[116:119], v[60:63], a[152:155]
    ds_read_b128 a[40:43], v22 offset:18432
    v_mfma_f32_16x16x32_bf16 a[156:159], a[120:123], v[56:59], a[156:159]
    ds_read_b64_tr_b16 v[56:57], v17 offset:0
    ds_read_b64_tr_b16 v[58:59], v17 offset:1024
    v_mfma_f32_16x16x32_bf16 a[156:159], a[124:127], v[60:63], a[156:159]
    ds_read_b64_tr_b16 v[60:61], v17 offset:8192
    ds_read_b64_tr_b16 v[62:63], v17 offset:9216
    v_mfma_f32_16x16x32_bf16 a[160:163], a[64:67], v[40:43], a[160:163]
    v_mfma_f32_16x16x32_bf16 a[160:163], a[68:71], v[44:47], a[160:163]
    v_mfma_f32_16x16x32_bf16 a[164:167], a[72:75], v[40:43], a[164:167]
    ds_read_b128 a[44:47], v23 offset:18432
    v_mfma_f32_16x16x32_bf16 a[164:167], a[76:79], v[44:47], a[164:167]
    s_add_u32 m0, s69, 16384
    v_mfma_f32_16x16x32_bf16 a[168:171], a[80:83], v[40:43], a[168:171]
    s_xor_b32 s60, s60, 524288
    buffer_load_dwordx4 v10, s[20:23], s63 offen lds
    v_mfma_f32_16x16x32_bf16 a[168:171], a[84:87], v[44:47], a[168:171]
    v_mfma_f32_16x16x32_bf16 a[172:175], a[88:91], v[40:43], a[172:175]
    v_mfma_f32_16x16x32_bf16 a[172:175], a[92:95], v[44:47], a[172:175]
    v_mfma_f32_16x16x32_bf16 a[176:179], a[96:99], v[40:43], a[176:179]
    ds_read_b128 a[48:51], v22 offset:20480
    v_mfma_f32_16x16x32_bf16 a[176:179], a[100:103], v[44:47], a[176:179]
    v_mfma_f32_16x16x32_bf16 a[180:183], a[104:107], v[40:43], a[180:183]
    v_mfma_f32_16x16x32_bf16 a[180:183], a[108:111], v[44:47], a[180:183]
    buffer_load_dwordx4 v11, s[20:23], s63 offen offset:1024 lds
    v_mfma_f32_16x16x32_bf16 a[184:187], a[112:115], v[40:43], a[184:187]
    v_mfma_f32_16x16x32_bf16 a[184:187], a[116:119], v[44:47], a[184:187]
    ds_read_b128 a[52:55], v23 offset:20480
    v_mfma_f32_16x16x32_bf16 a[188:191], a[120:123], v[40:43], a[188:191]
    v_mfma_f32_16x16x32_bf16 a[188:191], a[124:127], v[44:47], a[188:191]
    s_waitcnt lgkmcnt(1)
    v_mfma_f32_16x16x32_bf16 a[192:195], a[64:67], v[48:51], a[192:195]
    v_mfma_f32_16x16x32_bf16 a[192:195], a[68:71], v[52:55], a[192:195]
    v_mfma_f32_16x16x32_bf16 a[196:199], a[72:75], v[48:51], a[196:199]
    v_mfma_f32_16x16x32_bf16 a[196:199], a[76:79], v[52:55], a[196:199]
    buffer_load_dwordx4 v12, s[20:23], s63 offen offset:2048 lds
    v_mfma_f32_16x16x32_bf16 a[200:203], a[80:83], v[48:51], a[200:203]
    ds_read_b128 a[56:59], v22 offset:22528
    v_mfma_f32_16x16x32_bf16 a[200:203], a[84:87], v[52:55], a[200:203]
    v_mfma_f32_16x16x32_bf16 a[204:207], a[88:91], v[48:51], a[204:207]
    v_mfma_f32_16x16x32_bf16 a[204:207], a[92:95], v[52:55], a[204:207]
    v_mfma_f32_16x16x32_bf16 a[208:211], a[96:99], v[48:51], a[208:211]
    ds_read_b128 a[60:63], v23 offset:22528
    v_mfma_f32_16x16x32_bf16 a[208:211], a[100:103], v[52:55], a[208:211]
    v_mfma_f32_16x16x32_bf16 a[212:215], a[104:107], v[48:51], a[212:215]
    buffer_load_dwordx4 v13, s[20:23], s63 offen offset:3072 lds
    v_mfma_f32_16x16x32_bf16 a[212:215], a[108:111], v[52:55], a[212:215]
    v_mfma_f32_16x16x32_bf16 a[216:219], a[112:115], v[48:51], a[216:219]
    v_mfma_f32_16x16x32_bf16 a[216:219], a[116:119], v[52:55], a[216:219]
    v_mfma_f32_16x16x32_bf16 a[220:223], a[120:123], v[48:51], a[220:223]
    v_mfma_f32_16x16x32_bf16 a[220:223], a[124:127], v[52:55], a[220:223]
    v_mfma_f32_16x16x32_bf16 a[224:227], a[64:67], v[56:59], a[224:227]
    v_mfma_f32_16x16x32_bf16 a[224:227], a[68:71], v[60:63], a[224:227]
    s_xor_b32 s63, s63, 128
    v_mfma_f32_16x16x32_bf16 a[228:231], a[72:75], v[56:59], a[228:231]
    v_mfma_f32_16x16x32_bf16 a[228:231], a[76:79], v[60:63], a[228:231]
    v_mfma_f32_16x16x32_bf16 a[232:235], a[80:83], v[56:59], a[232:235]
    v_mfma_f32_16x16x32_bf16 a[232:235], a[84:87], v[60:63], a[232:235]
    s_waitcnt vmcnt(9) lgkmcnt(0)
    s_barrier
    ds_read_b64_tr_b16 v[40:41], v14 offset:32768
    v_mfma_f32_16x16x32_bf16 a[236:239], a[88:91], v[56:59], a[236:239]
    s_add_u32 m0, s69, 32768
    ds_read_b64_tr_b16 v[42:43], v14 offset:33792
    ds_read_b64_tr_b16 v[44:45], v14 offset:40960
    v_mfma_f32_16x16x32_bf16 a[236:239], a[92:95], v[60:63], a[236:239]
    buffer_load_dwordx4 v2, s[16:19], s60 offen nt lds
    v_mfma_f32_16x16x32_bf16 a[240:243], a[96:99], v[56:59], a[240:243]
    ds_read_b64_tr_b16 v[46:47], v14 offset:41984
    ds_read_b64_tr_b16 v[48:49], v15 offset:32768
    v_mfma_f32_16x16x32_bf16 a[240:243], a[100:103], v[60:63], a[240:243]
    ds_read_b64_tr_b16 v[50:51], v15 offset:33792
    ds_read_b64_tr_b16 v[52:53], v15 offset:40960
    v_mfma_f32_16x16x32_bf16 a[244:247], a[104:107], v[56:59], a[244:247]
    ds_read_b64_tr_b16 v[54:55], v15 offset:41984
    v_add_u32 v14, 0x10000, v14
    v_mfma_f32_16x16x32_bf16 a[244:247], a[108:111], v[60:63], a[244:247]
    v_add_u32 v15, 0x10000, v15
    v_mfma_f32_16x16x32_bf16 a[248:251], a[112:115], v[56:59], a[248:251]
    v_mfma_f32_16x16x32_bf16 a[248:251], a[116:119], v[60:63], a[248:251]
    buffer_load_dwordx4 v3, s[16:19], s60 offen offset:1024 nt lds
    v_mfma_f32_16x16x32_bf16 a[252:255], a[120:123], v[56:59], a[252:255]
    ds_read_b64_tr_b16 v[56:57], v16 offset:32768
    ds_read_b64_tr_b16 v[58:59], v16 offset:33792
    v_mfma_f32_16x16x32_bf16 a[252:255], a[124:127], v[60:63], a[252:255]
    s_waitcnt lgkmcnt(2)
    ds_read_b64_tr_b16 v[60:61], v16 offset:40960
    ds_read_b64_tr_b16 v[62:63], v16 offset:41984
    v_mfma_f32_16x16x32_bf16 v[128:131], v[40:43], a[0:3], v[128:131]
    v_add_u32 v16, 0x10000, v16
    v_mfma_f32_16x16x32_bf16 v[128:131], v[44:47], a[4:7], v[128:131]
    ds_read_b128 a[64:67], v22 offset:49152
    v_mfma_f32_16x16x32_bf16 v[132:135], v[40:43], a[8:11], v[132:135]
    v_mfma_f32_16x16x32_bf16 v[132:135], v[44:47], a[12:15], v[132:135]
    v_mfma_f32_16x16x32_bf16 v[136:139], v[40:43], a[16:19], v[136:139]
    ds_read_b128 a[68:71], v23 offset:49152
    v_mfma_f32_16x16x32_bf16 v[136:139], v[44:47], a[20:23], v[136:139]
    buffer_load_dwordx4 v4, s[16:19], s60 offen offset:2048 nt lds
    v_mfma_f32_16x16x32_bf16 v[140:143], v[40:43], a[24:27], v[140:143]
    v_mfma_f32_16x16x32_bf16 v[140:143], v[44:47], a[28:31], v[140:143]
    ds_read_b128 a[72:75], v22 offset:51200
    v_mfma_f32_16x16x32_bf16 v[144:147], v[40:43], a[32:35], v[144:147]
    v_mfma_f32_16x16x32_bf16 v[144:147], v[44:47], a[36:39], v[144:147]
    v_mfma_f32_16x16x32_bf16 v[148:151], v[40:43], a[40:43], v[148:151]
    ds_read_b128 a[76:79], v23 offset:51200
    v_mfma_f32_16x16x32_bf16 v[148:151], v[44:47], a[44:47], v[148:151]
    v_mfma_f32_16x16x32_bf16 v[152:155], v[40:43], a[48:51], v[152:155]
    buffer_load_dwordx4 v5, s[16:19], s60 offen offset:3072 nt lds
    v_mfma_f32_16x16x32_bf16 v[152:155], v[44:47], a[52:55], v[152:155]
    v_mfma_f32_16x16x32_bf16 v[156:159], v[40:43], a[56:59], v[156:159]
    ds_read_b128 a[80:83], v22 offset:53248
    ds_read_b64_tr_b16 v[40:41], v17 offset:32768
    v_mfma_f32_16x16x32_bf16 v[156:159], v[44:47], a[60:63], v[156:159]
    ds_read_b64_tr_b16 v[42:43], v17 offset:33792
    ds_read_b64_tr_b16 v[44:45], v17 offset:40960
    v_mfma_f32_16x16x32_bf16 v[160:163], v[48:51], a[0:3], v[160:163]
    ds_read_b64_tr_b16 v[46:47], v17 offset:41984
    v_add_u32 v17, 0x10000, v17
    v_mfma_f32_16x16x32_bf16 v[160:163], v[52:55], a[4:7], v[160:163]
    ds_read_b128 a[84:87], v23 offset:53248
    v_mfma_f32_16x16x32_bf16 v[164:167], v[48:51], a[8:11], v[164:167]
    v_mfma_f32_16x16x32_bf16 v[164:167], v[52:55], a[12:15], v[164:167]
    s_add_u32 m0, s69, 49152
    buffer_load_dword v7, v9, s[44:47], s69 offen sc1
    v_mfma_f32_16x16x32_bf16 v[168:171], v[48:51], a[16:19], v[168:171]
    s_xor_b32 s60, s60, 3670016
    buffer_load_dwordx4 v10, s[20:23], s64 offen lds
    v_mfma_f32_16x16x32_bf16 v[168:171], v[52:55], a[20:23], v[168:171]
    ds_read_b128 a[88:91], v22 offset:55296
    v_mfma_f32_16x16x32_bf16 v[172:175], v[48:51], a[24:27], v[172:175]
    v_mfma_f32_16x16x32_bf16 v[172:175], v[52:55], a[28:31], v[172:175]
    s_waitcnt lgkmcnt(1)
    ds_read_b128 a[92:95], v23 offset:55296
    v_mfma_f32_16x16x32_bf16 v[176:179], v[48:51], a[32:35], v[176:179]
    v_mfma_f32_16x16x32_bf16 v[176:179], v[52:55], a[36:39], v[176:179]
    v_mfma_f32_16x16x32_bf16 v[180:183], v[48:51], a[40:43], v[180:183]
    v_mfma_f32_16x16x32_bf16 v[180:183], v[52:55], a[44:47], v[180:183]
    buffer_load_dwordx4 v11, s[20:23], s64 offen offset:1024 lds
    v_mfma_f32_16x16x32_bf16 v[184:187], v[48:51], a[48:51], v[184:187]
    v_add_u32 v22, 0x10000, v22
    ds_read_b128 a[96:99], v22 offset:16384
    v_mfma_f32_16x16x32_bf16 v[184:187], v[52:55], a[52:55], v[184:187]
    v_mfma_f32_16x16x32_bf16 v[188:191], v[48:51], a[56:59], v[188:191]
    v_add_u32 v23, 0x10000, v23
    ds_read_b64_tr_b16 v[48:49], v14 offset:0
    v_mfma_f32_16x16x32_bf16 v[188:191], v[52:55], a[60:63], v[188:191]
    ds_read_b128 a[100:103], v23 offset:16384
    ds_read_b64_tr_b16 v[50:51], v14 offset:1024
    v_mfma_f32_16x16x32_bf16 v[192:195], v[56:59], a[0:3], v[192:195]
    ds_read_b64_tr_b16 v[52:53], v14 offset:8192
    ds_read_b64_tr_b16 v[54:55], v14 offset:9216
    v_mfma_f32_16x16x32_bf16 v[192:195], v[60:63], a[4:7], v[192:195]
    v_add_u32 v14, 0xfffe0000, v14
    v_mfma_f32_16x16x32_bf16 v[196:199], v[56:59], a[8:11], v[196:199]
    ds_read_b128 a[104:107], v22 offset:18432
    v_mfma_f32_16x16x32_bf16 v[196:199], v[60:63], a[12:15], v[196:199]
    buffer_load_dwordx4 v12, s[20:23], s64 offen offset:2048 lds
    v_mfma_f32_16x16x32_bf16 v[200:203], v[56:59], a[16:19], v[200:203]
    v_mfma_f32_16x16x32_bf16 v[200:203], v[60:63], a[20:23], v[200:203]
    ds_read_b128 a[108:111], v23 offset:18432
    v_mfma_f32_16x16x32_bf16 v[204:207], v[56:59], a[24:27], v[204:207]
    v_mfma_f32_16x16x32_bf16 v[204:207], v[60:63], a[28:31], v[204:207]
    v_mfma_f32_16x16x32_bf16 v[208:211], v[56:59], a[32:35], v[208:211]
    v_mfma_f32_16x16x32_bf16 v[208:211], v[60:63], a[36:39], v[208:211]
    ds_read_b128 a[112:115], v22 offset:20480
    v_mfma_f32_16x16x32_bf16 v[212:215], v[56:59], a[40:43], v[212:215]
    buffer_load_dwordx4 v13, s[20:23], s64 offen offset:3072 lds
    v_mfma_f32_16x16x32_bf16 v[212:215], v[60:63], a[44:47], v[212:215]
    v_mfma_f32_16x16x32_bf16 v[216:219], v[56:59], a[48:51], v[216:219]
    ds_read_b128 a[116:119], v23 offset:20480
    v_mfma_f32_16x16x32_bf16 v[216:219], v[60:63], a[52:55], v[216:219]
    v_mfma_f32_16x16x32_bf16 v[220:223], v[56:59], a[56:59], v[220:223]
    ds_read_b64_tr_b16 v[56:57], v15 offset:0
    ds_read_b64_tr_b16 v[58:59], v15 offset:1024
    v_mfma_f32_16x16x32_bf16 v[220:223], v[60:63], a[60:63], v[220:223]
    s_waitcnt lgkmcnt(3)
    ds_read_b128 a[120:123], v22 offset:22528
    ds_read_b64_tr_b16 v[60:61], v15 offset:8192
    v_mfma_f32_16x16x32_bf16 v[224:227], v[40:43], a[0:3], v[224:227]
    ds_read_b64_tr_b16 v[62:63], v15 offset:9216
    v_add_u32 v15, 0xfffe0000, v15
    v_mfma_f32_16x16x32_bf16 v[224:227], v[44:47], a[4:7], v[224:227]
    s_xor_b32 s64, s64, 128
    v_mov_b32 v22, v100
    v_add_u32 v22, 0x10000, v22
    v_mfma_f32_16x16x32_bf16 v[228:231], v[40:43], a[8:11], v[228:231]
    ds_read_b128 a[124:127], v23 offset:22528
    v_mov_b32 v23, v101
    v_mfma_f32_16x16x32_bf16 v[228:231], v[44:47], a[12:15], v[228:231]
    v_add_u32 v23, 0x10000, v23
    v_mfma_f32_16x16x32_bf16 v[232:235], v[40:43], a[16:19], v[232:235]
    v_mfma_f32_16x16x32_bf16 v[232:235], v[44:47], a[20:23], v[232:235]
    s_add_u32 m0, s69, 65536
    v_mfma_f32_16x16x32_bf16 v[236:239], v[40:43], a[24:27], v[236:239]
    buffer_load_dwordx4 v2, s[24:27], s60 offen lds
    v_mfma_f32_16x16x32_bf16 v[236:239], v[44:47], a[28:31], v[236:239]
    v_mfma_f32_16x16x32_bf16 v[240:243], v[40:43], a[32:35], v[240:243]
    v_mfma_f32_16x16x32_bf16 v[240:243], v[44:47], a[36:39], v[240:243]
    v_mfma_f32_16x16x32_bf16 v[244:247], v[40:43], a[40:43], v[244:247]
    v_mfma_f32_16x16x32_bf16 v[244:247], v[44:47], a[44:47], v[244:247]
    v_mfma_f32_16x16x32_bf16 v[248:251], v[40:43], a[48:51], v[248:251]
    v_mfma_f32_16x16x32_bf16 v[248:251], v[44:47], a[52:55], v[248:251]
    buffer_load_dwordx4 v3, s[24:27], s60 offen offset:1024 lds
    v_mfma_f32_16x16x32_bf16 v[252:255], v[40:43], a[56:59], v[252:255]
    ds_read_b64_tr_b16 v[40:41], v16 offset:0
    ds_read_b64_tr_b16 v[42:43], v16 offset:1024
    v_mfma_f32_16x16x32_bf16 v[252:255], v[44:47], a[60:63], v[252:255]
    ds_read_b64_tr_b16 v[44:45], v16 offset:8192
    ds_read_b64_tr_b16 v[46:47], v16 offset:9216
    v_mfma_f32_16x16x32_bf16 v[128:131], v[48:51], a[64:67], v[128:131]
    v_add_u32 v16, 0xfffe0000, v16
    v_mfma_f32_16x16x32_bf16 v[128:131], v[52:55], a[68:71], v[128:131]
    v_mfma_f32_16x16x32_bf16 v[132:135], v[48:51], a[72:75], v[132:135]
    v_mfma_f32_16x16x32_bf16 v[132:135], v[52:55], a[76:79], v[132:135]
    v_mfma_f32_16x16x32_bf16 v[136:139], v[48:51], a[80:83], v[136:139]
    v_mfma_f32_16x16x32_bf16 v[136:139], v[52:55], a[84:87], v[136:139]
    buffer_load_dwordx4 v4, s[24:27], s60 offen offset:2048 lds
    v_mfma_f32_16x16x32_bf16 v[140:143], v[48:51], a[88:91], v[140:143]
    v_mfma_f32_16x16x32_bf16 v[140:143], v[52:55], a[92:95], v[140:143]
    v_mfma_f32_16x16x32_bf16 v[144:147], v[48:51], a[96:99], v[144:147]
    v_mul_f32 v128, s74, v128
    v_mul_f32 v129, s74, v129
    v_mfma_f32_16x16x32_bf16 v[144:147], v[52:55], a[100:103], v[144:147]
    v_mul_f32 v130, s74, v130
    v_mul_f32 v131, s74, v131
    v_mfma_f32_16x16x32_bf16 v[148:151], v[48:51], a[104:107], v[148:151]
    v_cvt_pk_bf16_f32 v128, v128, v129
    v_cvt_pk_bf16_f32 v129, v130, v131
    v_mfma_f32_16x16x32_bf16 v[148:151], v[52:55], a[108:111], v[148:151]
    v_mul_f32 v132, s74, v132
    v_mul_f32 v133, s74, v133
    v_mfma_f32_16x16x32_bf16 v[152:155], v[48:51], a[112:115], v[152:155]
    s_waitcnt lgkmcnt(0)
    buffer_load_dwordx4 v5, s[24:27], s60 offen offset:3072 lds
    v_mfma_f32_16x16x32_bf16 v[152:155], v[52:55], a[116:119], v[152:155]
    v_mul_f32 v134, s74, v134
    v_mul_f32 v135, s74, v135
    v_mfma_f32_16x16x32_bf16 v[156:159], v[48:51], a[120:123], v[156:159]
    ds_read_b64_tr_b16 v[48:49], v17 offset:0
    ds_read_b64_tr_b16 v[50:51], v17 offset:1024
    v_mfma_f32_16x16x32_bf16 v[156:159], v[52:55], a[124:127], v[156:159]
    ds_read_b64_tr_b16 v[52:53], v17 offset:8192
    ds_read_b64_tr_b16 v[54:55], v17 offset:9216
    v_mfma_f32_16x16x32_bf16 v[160:163], v[56:59], a[64:67], v[160:163]
    v_add_u32 v17, 0xfffe0000, v17
    v_cvt_pk_bf16_f32 v132, v132, v133
    v_mfma_f32_16x16x32_bf16 v[160:163], v[60:63], a[68:71], v[160:163]
    v_cvt_pk_bf16_f32 v133, v134, v135
    v_mul_f32 v136, s74, v136
    v_mfma_f32_16x16x32_bf16 v[164:167], v[56:59], a[72:75], v[164:167]
    v_mul_f32 v137, s74, v137
    v_mul_f32 v138, s74, v138
    v_mfma_f32_16x16x32_bf16 v[164:167], v[60:63], a[76:79], v[164:167]
    s_add_u32 m0, s69, 81920
    v_mul_f32 v139, s74, v139
    v_mul_f32 v160, s74, v160
    v_mfma_f32_16x16x32_bf16 v[168:171], v[56:59], a[80:83], v[168:171]
    s_xor_b32 s60, s60, 524288
    buffer_load_dwordx4 v10, s[20:23], s63 offen lds
    v_mfma_f32_16x16x32_bf16 v[168:171], v[60:63], a[84:87], v[168:171]
    v_mul_f32 v161, s74, v161
    v_mul_f32 v162, s74, v162
    v_mfma_f32_16x16x32_bf16 v[172:175], v[56:59], a[88:91], v[172:175]
    v_mul_f32 v163, s74, v163
    v_cvt_pk_bf16_f32 v130, v160, v161
    v_mfma_f32_16x16x32_bf16 v[172:175], v[60:63], a[92:95], v[172:175]
    v_cvt_pk_bf16_f32 v131, v162, v163
    v_mul_f32 v164, s74, v164
    v_mfma_f32_16x16x32_bf16 v[176:179], v[56:59], a[96:99], v[176:179]
    v_mul_f32 v165, s74, v165
    v_mul_f32 v166, s74, v166
    v_mfma_f32_16x16x32_bf16 v[176:179], v[60:63], a[100:103], v[176:179]
    v_mul_f32 v167, s74, v167
    v_cvt_pk_bf16_f32 v134, v164, v165
    v_mfma_f32_16x16x32_bf16 v[180:183], v[56:59], a[104:107], v[180:183]
    v_cvt_pk_bf16_f32 v135, v166, v167
    v_mul_f32 v168, s74, v168
    v_mfma_f32_16x16x32_bf16 v[180:183], v[60:63], a[108:111], v[180:183]
    buffer_load_dwordx4 v11, s[20:23], s63 offen offset:1024 lds
    v_mfma_f32_16x16x32_bf16 v[184:187], v[56:59], a[112:115], v[184:187]
    v_mul_f32 v169, s74, v169
    v_mul_f32 v170, s74, v170
    v_mfma_f32_16x16x32_bf16 v[184:187], v[60:63], a[116:119], v[184:187]
    v_mul_f32 v171, s74, v171
    v_cvt_pk_bf16_f32 v136, v136, v137
    v_mfma_f32_16x16x32_bf16 v[188:191], v[56:59], a[120:123], v[188:191]
    v_cvt_pk_bf16_f32 v137, v138, v139
    v_cvt_pk_bf16_f32 v138, v168, v169
    v_mfma_f32_16x16x32_bf16 v[188:191], v[60:63], a[124:127], v[188:191]
    v_cvt_pk_bf16_f32 v139, v170, v171
    v_mul_f32 v140, s74, v140
    v_mfma_f32_16x16x32_bf16 v[192:195], v[40:43], a[64:67], v[192:195]
    v_mul_f32 v141, s74, v141
    v_mul_f32 v142, s74, v142
    v_mfma_f32_16x16x32_bf16 v[192:195], v[44:47], a[68:71], v[192:195]
    v_mul_f32 v143, s74, v143
    v_mul_f32 v172, s74, v172
    v_mfma_f32_16x16x32_bf16 v[196:199], v[40:43], a[72:75], v[196:199]
    v_mul_f32 v173, s74, v173
    v_mul_f32 v174, s74, v174
    v_mfma_f32_16x16x32_bf16 v[196:199], v[44:47], a[76:79], v[196:199]
    buffer_load_dwordx4 v12, s[20:23], s63 offen offset:2048 lds
    v_mfma_f32_16x16x32_bf16 v[200:203], v[40:43], a[80:83], v[200:203]
    v_mul_f32 v175, s74, v175
    v_cvt_pk_bf16_f32 v140, v140, v141
    v_mfma_f32_16x16x32_bf16 v[200:203], v[44:47], a[84:87], v[200:203]
    v_cvt_pk_bf16_f32 v141, v142, v143
    v_cvt_pk_bf16_f32 v142, v172, v173
    v_mfma_f32_16x16x32_bf16 v[204:207], v[40:43], a[88:91], v[204:207]
    v_cvt_pk_bf16_f32 v143, v174, v175
    v_mul_f32 v144, s74, v144
    v_mfma_f32_16x16x32_bf16 v[204:207], v[44:47], a[92:95], v[204:207]
    v_mul_f32 v145, s74, v145
    v_mul_f32 v146, s74, v146
    v_mfma_f32_16x16x32_bf16 v[208:211], v[40:43], a[96:99], v[208:211]
    v_mul_f32 v147, s74, v147
    v_mul_f32 v176, s74, v176
    v_mfma_f32_16x16x32_bf16 v[208:211], v[44:47], a[100:103], v[208:211]
    v_mul_f32 v177, s74, v177
    v_mul_f32 v178, s74, v178
    v_mfma_f32_16x16x32_bf16 v[212:215], v[40:43], a[104:107], v[212:215]
    buffer_load_dwordx4 v13, s[20:23], s63 offen offset:3072 lds
    v_mfma_f32_16x16x32_bf16 v[212:215], v[44:47], a[108:111], v[212:215]
    v_mul_f32 v179, s74, v179
    v_cvt_pk_bf16_f32 v144, v144, v145
    v_mfma_f32_16x16x32_bf16 v[216:219], v[40:43], a[112:115], v[216:219]
    v_cvt_pk_bf16_f32 v145, v146, v147
    v_cvt_pk_bf16_f32 v146, v176, v177
    v_mfma_f32_16x16x32_bf16 v[216:219], v[44:47], a[116:119], v[216:219]
    v_cvt_pk_bf16_f32 v147, v178, v179
    v_mul_f32 v148, s74, v148
    v_mfma_f32_16x16x32_bf16 v[220:223], v[40:43], a[120:123], v[220:223]
    v_mul_f32 v149, s74, v149
    v_mul_f32 v150, s74, v150
    v_mfma_f32_16x16x32_bf16 v[220:223], v[44:47], a[124:127], v[220:223]
    s_add_u32 s72, s70, 0
    v_mul_f32 v151, s74, v151
    v_mul_f32 v180, s74, v180
    s_waitcnt lgkmcnt(0)
    v_mfma_f32_16x16x32_bf16 v[224:227], v[48:51], a[64:67], v[224:227]
    buffer_store_dwordx4 v[128:131], v1, s[36:39], s72 offen sc1
    v_mfma_f32_16x16x32_bf16 v[224:227], v[52:55], a[68:71], v[224:227]
    s_xor_b32 s63, s63, 384
    v_mul_f32 v181, s74, v181
    v_mul_f32 v182, s74, v182
    v_mfma_f32_16x16x32_bf16 v[228:231], v[48:51], a[72:75], v[228:231]
    v_mul_f32 v183, s74, v183
    v_cvt_pk_bf16_f32 v148, v148, v149
    v_mfma_f32_16x16x32_bf16 v[228:231], v[52:55], a[76:79], v[228:231]
    v_cvt_pk_bf16_f32 v149, v150, v151
    v_cvt_pk_bf16_f32 v150, v180, v181
    v_mfma_f32_16x16x32_bf16 v[232:235], v[48:51], a[80:83], v[232:235]
    v_cvt_pk_bf16_f32 v151, v182, v183
    v_mul_f32 v152, s74, v152
    v_mfma_f32_16x16x32_bf16 v[232:235], v[52:55], a[84:87], v[232:235]
    s_add_u32 m0, s67, 98304
    v_mul_f32 v153, s74, v153
    v_mul_f32 v154, s74, v154
    s_waitcnt vmcnt(9) lgkmcnt(0)
    v_cmp_gt_u32 vcc, 8, v7
    s_nop 1
    s_and_b64 vcc, vcc, s[86:87]
    s_cbranch_scc1 SPIN_WA
BACK_WA:
    s_barrier
    v_mfma_f32_16x16x32_bf16 v[236:239], v[48:51], a[88:91], v[236:239]
    buffer_load_dwordx4 v1, s[28:31], s65 offen sc1 lds
    v_mfma_f32_16x16x32_bf16 v[236:239], v[52:55], a[92:95], v[236:239]
    ds_read_b64_tr_b16 v[56:57], v14 offset:0
    ds_read_b64_tr_b16 v[58:59], v14 offset:1024
    v_mfma_f32_16x16x32_bf16 v[240:243], v[48:51], a[96:99], v[240:243]
    ds_read_b64_tr_b16 v[60:61], v14 offset:8192
    ds_read_b64_tr_b16 v[62:63], v14 offset:9216
    v_mfma_f32_16x16x32_bf16 v[240:243], v[52:55], a[100:103], v[240:243]
    ds_read_b64_tr_b16 v[40:41], v15 offset:0
    ds_read_b64_tr_b16 v[42:43], v15 offset:1024
    v_mfma_f32_16x16x32_bf16 v[244:247], v[48:51], a[104:107], v[244:247]
    ds_read_b64_tr_b16 v[44:45], v15 offset:8192
    ds_read_b64_tr_b16 v[46:47], v15 offset:9216
    v_mfma_f32_16x16x32_bf16 v[244:247], v[52:55], a[108:111], v[244:247]
    v_mul_f32 v155, s74, v155
    v_mul_f32 v184, s74, v184
    v_mfma_f32_16x16x32_bf16 v[248:251], v[48:51], a[112:115], v[248:251]
    v_mul_f32 v185, s74, v185
    v_mul_f32 v186, s74, v186
    v_mfma_f32_16x16x32_bf16 v[248:251], v[52:55], a[116:119], v[248:251]
    v_mul_f32 v187, s74, v187
    v_cvt_pk_bf16_f32 v152, v152, v153
    v_mfma_f32_16x16x32_bf16 v[252:255], v[48:51], a[120:123], v[252:255]
    s_lshr_b32 s92, s2, 3
    buffer_load_dwordx4 v1, s[28:31], s65 offen offset:1024 sc1 lds
    v_mfma_f32_16x16x32_bf16 v[252:255], v[52:55], a[124:127], v[252:255]
    s_lshl2_add_u32 s92, s92, s4
    v_lshrrev_b32 v9, 4, v1
    v_min_u32 v9, 0, v9
    s_waitcnt lgkmcnt(0)
    v_mfma_f32_16x16x32_bf16 a[128:131], a[0:3], v[56:59], a[128:131]
    s_mul_i32 s92, s92, 1
    ds_read_b64_tr_b16 v[48:49], v16 offset:0
    ds_read_b64_tr_b16 v[50:51], v16 offset:1024
    v_mfma_f32_16x16x32_bf16 a[128:131], a[4:7], v[60:63], a[128:131]
    s_add_u32 s92, s92, 32
    v_add_lshl_u32 v9, v9, s92, 7
    ds_read_b64_tr_b16 v[52:53], v16 offset:8192
    v_mfma_f32_16x16x32_bf16 a[132:135], a[8:11], v[56:59], a[132:135]
    s_getpc_b64 s[92:93]
    global_load_dword v9, v9, s[92:93]
    v_mfma_f32_16x16x32_bf16 a[132:135], a[12:15], v[60:63], a[132:135]
    ds_read_b128 v[64:67], v24 offset:16384
    ds_read_b64_tr_b16 v[54:55], v16 offset:9216
    v_mfma_f32_16x16x32_bf16 a[136:139], a[16:19], v[56:59], a[136:139]
    v_cvt_pk_bf16_f32 v153, v154, v155
    v_cvt_pk_bf16_f32 v154, v184, v185
    v_mfma_f32_16x16x32_bf16 a[136:139], a[20:23], v[60:63], a[136:139]
    v_cvt_pk_bf16_f32 v155, v186, v187
    v_mul_f32 v156, s74, v156
    v_mfma_f32_16x16x32_bf16 a[140:143], a[24:27], v[56:59], a[140:143]
    s_add_u32 m0, s68, 106496
    v_mul_f32 v157, s74, v157
    v_mul_f32 v158, s74, v158
    v_mfma_f32_16x16x32_bf16 a[140:143], a[28:31], v[60:63], a[140:143]
    buffer_load_dwordx4 v6, s[20:23], s66 offen lds
    v_mfma_f32_16x16x32_bf16 a[144:147], a[32:35], v[56:59], a[144:147]
    s_add_u32 s72, s70, 4096
    v_mul_f32 v159, s74, v159
    v_mul_f32 v188, s74, v188
    v_mfma_f32_16x16x32_bf16 a[144:147], a[36:39], v[60:63], a[144:147]
    buffer_store_dwordx4 v[132:135], v1, s[36:39], s72 offen sc1
    v_mfma_f32_16x16x32_bf16 a[148:151], a[40:43], v[56:59], a[148:151]
    v_mul_f32 v189, s74, v189
    v_mul_f32 v190, s74, v190
    v_mfma_f32_16x16x32_bf16 a[148:151], a[44:47], v[60:63], a[148:151]
    v_mul_f32 v191, s74, v191
    v_cvt_pk_bf16_f32 v156, v156, v157
    v_mfma_f32_16x16x32_bf16 a[152:155], a[48:51], v[56:59], a[152:155]
    v_cvt_pk_bf16_f32 v157, v158, v159
    v_cvt_pk_bf16_f32 v158, v188, v189
    v_mfma_f32_16x16x32_bf16 a[152:155], a[52:55], v[60:63], a[152:155]
    ds_read_b128 v[68:71], v25 offset:16384
    v_cvt_pk_bf16_f32 v159, v190, v191
    v_mfma_f32_16x16x32_bf16 a[156:159], a[56:59], v[56:59], a[156:159]
    s_add_u32 m0, s69, 114688
    ds_read_b64_tr_b16 v[56:57], v17 offset:0
    ds_read_b64_tr_b16 v[58:59], v17 offset:1024
    v_mfma_f32_16x16x32_bf16 a[156:159], a[60:63], v[60:63], a[156:159]
    s_xor_b32 s65, s65, 8192
    buffer_load_dwordx4 v10, s[20:23], s64 offen lds
    v_mfma_f32_16x16x32_bf16 a[160:163], a[0:3], v[40:43], a[160:163]
    s_xor_b32 s66, s66, 128
    ds_read_b64_tr_b16 v[60:61], v17 offset:8192
    ds_read_b64_tr_b16 v[62:63], v17 offset:9216
    v_mfma_f32_16x16x32_bf16 a[160:163], a[4:7], v[44:47], a[160:163]
    v_mul_f32 v192, s74, v192
    v_mul_f32 v193, s74, v193
    v_mfma_f32_16x16x32_bf16 a[164:167], a[8:11], v[40:43], a[164:167]
    v_mul_f32 v194, s74, v194
    v_mul_f32 v195, s74, v195
    v_mfma_f32_16x16x32_bf16 a[164:167], a[12:15], v[44:47], a[164:167]
    v_mul_f32 v224, s74, v224
    v_mul_f32 v225, s74, v225
    v_mfma_f32_16x16x32_bf16 a[168:171], a[16:19], v[40:43], a[168:171]
    v_mul_f32 v226, s74, v226
    v_mul_f32 v227, s74, v227
    v_mfma_f32_16x16x32_bf16 a[168:171], a[20:23], v[44:47], a[168:171]
    v_cvt_pk_bf16_f32 v192, v192, v193
    v_cvt_pk_bf16_f32 v193, v194, v195
    v_mfma_f32_16x16x32_bf16 a[172:175], a[24:27], v[40:43], a[172:175]
    v_cvt_pk_bf16_f32 v194, v224, v225
    v_cvt_pk_bf16_f32 v195, v226, v227
    v_mfma_f32_16x16x32_bf16 a[172:175], a[28:31], v[44:47], a[172:175]
    v_mul_f32 v196, s74, v196
    v_mul_f32 v197, s74, v197
    v_mfma_f32_16x16x32_bf16 a[176:179], a[32:35], v[40:43], a[176:179]
    buffer_load_dwordx4 v11, s[20:23], s64 offen offset:1024 lds
    v_mfma_f32_16x16x32_bf16 a[176:179], a[36:39], v[44:47], a[176:179]
    ds_read_b128 v[72:75], v24 offset:24576
    v_mul_f32 v198, s74, v198
    v_mfma_f32_16x16x32_bf16 a[180:183], a[40:43], v[40:43], a[180:183]
    v_mul_f32 v199, s74, v199
    v_mul_f32 v228, s74, v228
    v_mfma_f32_16x16x32_bf16 a[180:183], a[44:47], v[44:47], a[180:183]
    v_mul_f32 v229, s74, v229
    v_mul_f32 v230, s74, v230
    v_mfma_f32_16x16x32_bf16 a[184:187], a[48:51], v[40:43], a[184:187]
    v_mul_f32 v231, s74, v231
    v_cvt_pk_bf16_f32 v196, v196, v197
    v_mfma_f32_16x16x32_bf16 a[184:187], a[52:55], v[44:47], a[184:187]
    v_cvt_pk_bf16_f32 v197, v198, v199
    v_cvt_pk_bf16_f32 v198, v228, v229
    v_mfma_f32_16x16x32_bf16 a[188:191], a[56:59], v[40:43], a[188:191]
    ds_read_b64_tr_b16 v[40:41], v14 offset:32768
    ds_read_b64_tr_b16 v[42:43], v14 offset:33792
    v_mfma_f32_16x16x32_bf16 a[188:191], a[60:63], v[44:47], a[188:191]
    s_waitcnt lgkmcnt(2)
    ds_read_b64_tr_b16 v[44:45], v14 offset:40960
    ds_read_b64_tr_b16 v[46:47], v14 offset:41984
    v_mfma_f32_16x16x32_bf16 a[192:195], a[0:3], v[48:51], a[192:195]
    buffer_load_dwordx4 v12, s[20:23], s64 offen offset:2048 lds
    v_mfma_f32_16x16x32_bf16 a[192:195], a[4:7], v[52:55], a[192:195]
    s_add_u32 s72, s70, 8192
    v_xor_b32 v14, s73, v14
    v_add_u32 v14, 0x10000, v14
    v_mfma_f32_16x16x32_bf16 a[196:199], a[8:11], v[48:51], a[196:199]
    buffer_store_dwordx4 v[136:139], v1, s[36:39], s72 offen sc1
    v_mfma_f32_16x16x32_bf16 a[196:199], a[12:15], v[52:55], a[196:199]
    ds_read_b128 v[76:79], v25 offset:24576
    v_cvt_pk_bf16_f32 v199, v230, v231
    v_mfma_f32_16x16x32_bf16 a[200:203], a[16:19], v[48:51], a[200:203]
    v_mul_f32 v200, s74, v200
    v_mul_f32 v201, s74, v201
    v_mfma_f32_16x16x32_bf16 a[200:203], a[20:23], v[52:55], a[200:203]
    v_mul_f32 v202, s74, v202
    v_mul_f32 v203, s74, v203
    v_mfma_f32_16x16x32_bf16 a[204:207], a[24:27], v[48:51], a[204:207]
    v_mul_f32 v232, s74, v232
    v_mul_f32 v233, s74, v233
    v_mfma_f32_16x16x32_bf16 a[204:207], a[28:31], v[52:55], a[204:207]
    v_mul_f32 v234, s74, v234
    v_mul_f32 v235, s74, v235
    v_mfma_f32_16x16x32_bf16 a[208:211], a[32:35], v[48:51], a[208:211]
    v_cvt_pk_bf16_f32 v200, v200, v201
    v_cvt_pk_bf16_f32 v201, v202, v203
    v_mfma_f32_16x16x32_bf16 a[208:211], a[36:39], v[52:55], a[208:211]
    buffer_load_dwordx4 v13, s[20:23], s64 offen offset:3072 lds
    v_mfma_f32_16x16x32_bf16 a[212:215], a[40:43], v[48:51], a[212:215]
    v_cvt_pk_bf16_f32 v202, v232, v233
    v_cvt_pk_bf16_f32 v203, v234, v235
    v_mfma_f32_16x16x32_bf16 a[212:215], a[44:47], v[52:55], a[212:215]
    v_mul_f32 v204, s74, v204
    v_mul_f32 v205, s74, v205
    v_mfma_f32_16x16x32_bf16 a[216:219], a[48:51], v[48:51], a[216:219]
    v_mul_f32 v206, s74, v206
    v_mul_f32 v207, s74, v207
    v_mfma_f32_16x16x32_bf16 a[216:219], a[52:55], v[52:55], a[216:219]
    v_mul_f32 v236, s74, v236
    v_mul_f32 v237, s74, v237
    v_mfma_f32_16x16x32_bf16 a[220:223], a[56:59], v[48:51], a[220:223]
    ds_read_b64_tr_b16 v[48:49], v15 offset:32768
    ds_read_b64_tr_b16 v[50:51], v15 offset:33792
    v_mfma_f32_16x16x32_bf16 a[220:223], a[60:63], v[52:55], a[220:223]
    ds_read_b64_tr_b16 v[52:53], v15 offset:40960
    ds_read_b64_tr_b16 v[54:55], v15 offset:41984
    v_mfma_f32_16x16x32_bf16 a[224:227], a[0:3], v[56:59], a[224:227]
    v_xor_b32 v15, s73, v15
    v_add_u32 v15, 0x10000, v15
    v_mfma_f32_16x16x32_bf16 a[224:227], a[4:7], v[60:63], a[224:227]
    s_xor_b32 s64, s64, 384
    v_accvgpr_write_b32 a4, v192
    v_accvgpr_write_b32 a5, v193
    v_mfma_f32_16x16x32_bf16 a[228:231], a[8:11], v[56:59], a[228:231]
    v_accvgpr_write_b32 a6, v194
    v_accvgpr_write_b32 a7, v195
    v_mfma_f32_16x16x32_bf16 a[228:231], a[12:15], v[60:63], a[228:231]
    v_accvgpr_write_b32 a12, v196
    v_accvgpr_write_b32 a13, v197
    v_mfma_f32_16x16x32_bf16 a[232:235], a[16:19], v[56:59], a[232:235]
    v_accvgpr_write_b32 a14, v198
    v_accvgpr_write_b32 a15, v199
    v_mfma_f32_16x16x32_bf16 a[232:235], a[20:23], v[60:63], a[232:235]
    s_add_u32 m0, s69, 131072
    v_mul_f32 v238, s74, v238
    v_mul_f32 v239, s74, v239
    v_mfma_f32_16x16x32_bf16 a[236:239], a[24:27], v[56:59], a[236:239]
    buffer_load_dwordx4 v2, s[24:27], s60 offen lds
    v_mfma_f32_16x16x32_bf16 a[236:239], a[28:31], v[60:63], a[236:239]
    v_accvgpr_write_b32 a20, v200
    v_accvgpr_write_b32 a21, v201
    v_mfma_f32_16x16x32_bf16 a[240:243], a[32:35], v[56:59], a[240:243]
    v_accvgpr_write_b32 a22, v202
    v_accvgpr_write_b32 a23, v203
    v_mfma_f32_16x16x32_bf16 a[240:243], a[36:39], v[60:63], a[240:243]
    v_cvt_pk_bf16_f32 v204, v204, v205
    v_cvt_pk_bf16_f32 v205, v206, v207
    v_mfma_f32_16x16x32_bf16 a[244:247], a[40:43], v[56:59], a[244:247]
    s_add_u32 s72, s70, 12288
    v_accvgpr_write_b32 a40, v148
    v_accvgpr_write_b32 a41, v149
    v_mfma_f32_16x16x32_bf16 a[244:247], a[44:47], v[60:63], a[244:247]
    buffer_store_dwordx4 v[140:143], v1, s[36:39], s72 offen sc1
    v_mfma_f32_16x16x32_bf16 a[248:251], a[48:51], v[56:59], a[248:251]
    v_accvgpr_write_b32 a42, v150
    v_accvgpr_write_b32 a43, v151
    v_mfma_f32_16x16x32_bf16 a[248:251], a[52:55], v[60:63], a[248:251]
    buffer_load_dwordx4 v3, s[24:27], s60 offen offset:1024 lds
    v_mfma_f32_16x16x32_bf16 a[252:255], a[56:59], v[56:59], a[252:255]
    ds_read_b64_tr_b16 v[56:57], v16 offset:32768
    ds_read_b64_tr_b16 v[58:59], v16 offset:33792
    v_mfma_f32_16x16x32_bf16 a[252:255], a[60:63], v[60:63], a[252:255]
    s_waitcnt lgkmcnt(2)
    ds_read_b64_tr_b16 v[60:61], v16 offset:40960
    ds_read_b64_tr_b16 v[62:63], v16 offset:41984
    v_mfma_f32_16x16x32_bf16 a[128:131], a[64:67], v[40:43], a[128:131]
    v_xor_b32 v16, s73, v16
    v_add_u32 v16, 0x10000, v16
    v_mfma_f32_16x16x32_bf16 a[128:131], a[68:71], v[44:47], a[128:131]
    v_accvgpr_write_b32 a48, v152
    v_accvgpr_write_b32 a49, v153
    v_mfma_f32_16x16x32_bf16 a[132:135], a[72:75], v[40:43], a[132:135]
    ds_read_b128 v[80:83], v24 offset:49152
    v_accvgpr_write_b32 a50, v154
    v_mfma_f32_16x16x32_bf16 a[132:135], a[76:79], v[44:47], a[132:135]
    v_accvgpr_write_b32 a51, v155
    v_accvgpr_write_b32 a56, v156
    v_mfma_f32_16x16x32_bf16 a[136:139], a[80:83], v[40:43], a[136:139]
    v_accvgpr_write_b32 a57, v157
    v_accvgpr_write_b32 a58, v158
    v_mfma_f32_16x16x32_bf16 a[136:139], a[84:87], v[44:47], a[136:139]
    buffer_load_dwordx4 v4, s[24:27], s60 offen offset:2048 lds
    v_mfma_f32_16x16x32_bf16 a[140:143], a[88:91], v[40:43], a[140:143]
    v_accvgpr_write_b32 a59, v159
    v_cvt_pk_bf16_f32 v206, v236, v237
    v_mfma_f32_16x16x32_bf16 a[140:143], a[92:95], v[44:47], a[140:143]
    v_cvt_pk_bf16_f32 v207, v238, v239
    v_mul_f32 v208, s74, v208
    v_mfma_f32_16x16x32_bf16 a[144:147], a[96:99], v[40:43], a[144:147]
    v_mul_f32 v209, s74, v209
    v_mul_f32 v210, s74, v210
    v_mfma_f32_16x16x32_bf16 a[144:147], a[100:103], v[44:47], a[144:147]
    v_mul_f32 v211, s74, v211
    v_mul_f32 v240, s74, v240
    v_mfma_f32_16x16x32_bf16 a[148:151], a[104:107], v[40:43], a[148:151]
    v_mul_f32 v241, s74, v241
    v_mul_f32 v242, s74, v242
    v_mfma_f32_16x16x32_bf16 a[148:151], a[108:111], v[44:47], a[148:151]
    v_mul_f32 v243, s74, v243
    v_accvgpr_write_b32 a28, v204
    v_mfma_f32_16x16x32_bf16 a[152:155], a[112:115], v[40:43], a[152:155]
    buffer_load_dwordx4 v5, s[24:27], s60 offen offset:3072 lds
    v_mfma_f32_16x16x32_bf16 a[152:155], a[116:119], v[44:47], a[152:155]
    ds_read_b128 v[84:87], v25 offset:49152
    v_accvgpr_write_b32 a29, v205
    v_mfma_f32_16x16x32_bf16 a[156:159], a[120:123], v[40:43], a[156:159]
    ds_read_b64_tr_b16 v[40:41], v17 offset:32768
    ds_read_b64_tr_b16 v[42:43], v17 offset:33792
    v_mfma_f32_16x16x32_bf16 a[156:159], a[124:127], v[44:47], a[156:159]
    ds_read_b64_tr_b16 v[44:45], v17 offset:40960
    ds_read_b64_tr_b16 v[46:47], v17 offset:41984
    v_mfma_f32_16x16x32_bf16 a[160:163], a[64:67], v[48:51], a[160:163]
    v_xor_b32 v17, s73, v17
    v_add_u32 v17, 0x10000, v17
    v_mfma_f32_16x16x32_bf16 a[160:163], a[68:71], v[52:55], a[160:163]
    v_accvgpr_write_b32 a30, v206
    v_accvgpr_write_b32 a31, v207
    v_mfma_f32_16x16x32_bf16 a[164:167], a[72:75], v[48:51], a[164:167]
    v_cvt_pk_bf16_f32 v208, v208, v209
    v_cvt_pk_bf16_f32 v209, v210, v211
    v_mfma_f32_16x16x32_bf16 a[164:167], a[76:79], v[52:55], a[164:167]
    s_add_u32 m0, s69, 147456
    v_cvt_pk_bf16_f32 v210, v240, v241
    v_cvt_pk_bf16_f32 v211, v242, v243
    v_mfma_f32_16x16x32_bf16 a[168:171], a[80:83], v[48:51], a[168:171]
    s_xor_b32 s60, s60, 1572864
    buffer_load_dwordx4 v10, s[20:23], s63 offen lds
    v_mfma_f32_16x16x32_bf16 a[168:171], a[84:87], v[52:55], a[168:171]
    s_add_u32 s72, s70, 32768
    buffer_store_dwordx4 v[144:147], v1, s[36:39], s72 offen sc1
    v_mfma_f32_16x16x32_bf16 a[172:175], a[88:91], v[48:51], a[172:175]
    v_mul_f32 v212, s74, v212
    v_mul_f32 v213, s74, v213
    v_mfma_f32_16x16x32_bf16 a[172:175], a[92:95], v[52:55], a[172:175]
    v_mul_f32 v214, s74, v214
    v_mul_f32 v215, s74, v215
    v_mfma_f32_16x16x32_bf16 a[176:179], a[96:99], v[48:51], a[176:179]
    ds_read_b128 v[88:91], v24 offset:57344
    v_mul_f32 v244, s74, v244
    v_mfma_f32_16x16x32_bf16 a[176:179], a[100:103], v[52:55], a[176:179]
    v_mul_f32 v245, s74, v245
    v_mul_f32 v246, s74, v246
    v_mfma_f32_16x16x32_bf16 a[180:183], a[104:107], v[48:51], a[180:183]
    v_mul_f32 v247, s74, v247
    v_accvgpr_write_b32 a36, v208
    v_mfma_f32_16x16x32_bf16 a[180:183], a[108:111], v[52:55], a[180:183]
    buffer_load_dwordx4 v11, s[20:23], s63 offen offset:1024 lds
    v_mfma_f32_16x16x32_bf16 a[184:187], a[112:115], v[48:51], a[184:187]
    v_accvgpr_write_b32 a37, v209
    v_accvgpr_write_b32 a38, v210
    v_mfma_f32_16x16x32_bf16 a[184:187], a[116:119], v[52:55], a[184:187]
    v_accvgpr_write_b32 a39, v211
    v_cvt_pk_bf16_f32 v212, v212, v213
    v_mfma_f32_16x16x32_bf16 a[188:191], a[120:123], v[48:51], a[188:191]
    v_cvt_pk_bf16_f32 v213, v214, v215
    v_cvt_pk_bf16_f32 v214, v244, v245
    v_mfma_f32_16x16x32_bf16 a[188:191], a[124:127], v[52:55], a[188:191]
    s_waitcnt lgkmcnt(0)
    v_cvt_pk_bf16_f32 v215, v246, v247
    v_mul_f32 v216, s74, v216
    v_mfma_f32_16x16x32_bf16 a[192:195], a[64:67], v[56:59], a[192:195]
    v_mul_f32 v217, s74, v217
    v_mul_f32 v218, s74, v218
    v_mfma_f32_16x16x32_bf16 a[192:195], a[68:71], v[60:63], a[192:195]
    v_accvgpr_read_b32 v32, a128
    v_accvgpr_read_b32 v31, a129
    v_mfma_f32_16x16x32_bf16 a[196:199], a[72:75], v[56:59], a[196:199]
    v_cvt_pk_bf16_f32 v32, v32, v31
    v_accvgpr_read_b32 v33, a130
    v_mfma_f32_16x16x32_bf16 a[196:199], a[76:79], v[60:63], a[196:199]
    buffer_load_dwordx4 v12, s[20:23], s63 offen offset:2048 lds
    v_mfma_f32_16x16x32_bf16 a[200:203], a[80:83], v[56:59], a[200:203]
    ds_read_b128 v[92:95], v25 offset:57344
    v_accvgpr_read_b32 v31, a131
    v_mfma_f32_16x16x32_bf16 a[200:203], a[84:87], v[60:63], a[200:203]
    v_cvt_pk_bf16_f32 v33, v33, v31
    v_accvgpr_read_b32 v34, a132
    v_mfma_f32_16x16x32_bf16 a[204:207], a[88:91], v[56:59], a[204:207]
    v_accvgpr_read_b32 v31, a133
    v_cvt_pk_bf16_f32 v34, v34, v31
    v_mfma_f32_16x16x32_bf16 a[204:207], a[92:95], v[60:63], a[204:207]
    v_accvgpr_read_b32 v35, a134
    v_accvgpr_read_b32 v31, a135
    v_mfma_f32_16x16x32_bf16 a[208:211], a[96:99], v[56:59], a[208:211]
    v_cvt_pk_bf16_f32 v35, v35, v31
    v_mul_f32 v219, s74, v219
    v_mfma_f32_16x16x32_bf16 a[208:211], a[100:103], v[60:63], a[208:211]
    v_mul_f32 v248, s74, v248
    v_mul_f32 v249, s74, v249
    v_mfma_f32_16x16x32_bf16 a[212:215], a[104:107], v[56:59], a[212:215]
    buffer_load_dwordx4 v13, s[20:23], s63 offen offset:3072 lds
    v_mfma_f32_16x16x32_bf16 a[212:215], a[108:111], v[60:63], a[212:215]
    v_mul_f32 v250, s74, v250
    v_mul_f32 v251, s74, v251
    v_mfma_f32_16x16x32_bf16 a[216:219], a[112:115], v[56:59], a[216:219]
    s_add_u32 s72, s71, 0
    v_accvgpr_write_b32 a44, v212
    v_accvgpr_write_b32 a45, v213
    v_mfma_f32_16x16x32_bf16 a[216:219], a[116:119], v[60:63], a[216:219]
    buffer_store_dwordx4 v[32:35], v1, s[36:39], s72 offen sc1
    v_mfma_f32_16x16x32_bf16 a[220:223], a[120:123], v[56:59], a[220:223]
    v_accvgpr_write_b32 a46, v214
    v_accvgpr_write_b32 a47, v215
    v_mfma_f32_16x16x32_bf16 a[220:223], a[124:127], v[60:63], a[220:223]
    v_cvt_pk_bf16_f32 v216, v216, v217
    v_cvt_pk_bf16_f32 v217, v218, v219
    v_mfma_f32_16x16x32_bf16 a[224:227], a[64:67], v[40:43], a[224:227]
    v_cvt_pk_bf16_f32 v218, v248, v249
    v_cvt_pk_bf16_f32 v219, v250, v251
    v_mfma_f32_16x16x32_bf16 a[224:227], a[68:71], v[44:47], a[224:227]
    s_xor_b32 s63, s63, 128
    v_mul_f32 v220, s74, v220
    v_mul_f32 v221, s74, v221
    v_mfma_f32_16x16x32_bf16 a[228:231], a[72:75], v[40:43], a[228:231]
    v_mul_f32 v222, s74, v222
    v_mul_f32 v223, s74, v223
    v_mfma_f32_16x16x32_bf16 a[228:231], a[76:79], v[44:47], a[228:231]
    v_mul_f32 v252, s74, v252
    v_mul_f32 v253, s74, v253
    v_mfma_f32_16x16x32_bf16 a[232:235], a[80:83], v[40:43], a[232:235]
    v_mul_f32 v254, s74, v254
    v_mul_f32 v255, s74, v255
    v_mfma_f32_16x16x32_bf16 a[232:235], a[84:87], v[44:47], a[232:235]
    s_waitcnt vmcnt(11) lgkmcnt(0)
    s_barrier
    ds_read_b64_tr_b16 v[48:49], v14 offset:0
    v_mfma_f32_16x16x32_bf16 a[236:239], a[88:91], v[40:43], a[236:239]
    s_add_u32 m0, s67, 0
    ds_read_b64_tr_b16 v[50:51], v14 offset:1024
    ds_read_b64_tr_b16 v[52:53], v14 offset:8192
    v_mfma_f32_16x16x32_bf16 a[236:239], a[92:95], v[44:47], a[236:239]
    buffer_load_dwordx4 v1, s[28:31], s65 offen sc1 lds
    v_mfma_f32_16x16x32_bf16 a[240:243], a[96:99], v[40:43], a[240:243]
    ds_read_b64_tr_b16 v[54:55], v14 offset:9216
    ds_read_b64_tr_b16 v[56:57], v15 offset:0
    v_mfma_f32_16x16x32_bf16 a[240:243], a[100:103], v[44:47], a[240:243]
    ds_read_b64_tr_b16 v[58:59], v15 offset:1024
    ds_read_b64_tr_b16 v[60:61], v15 offset:8192
    v_mfma_f32_16x16x32_bf16 a[244:247], a[104:107], v[40:43], a[244:247]
    ds_read_b64_tr_b16 v[62:63], v15 offset:9216
    v_add_u32 v14, 0x10000, v14
    v_mfma_f32_16x16x32_bf16 a[244:247], a[108:111], v[44:47], a[244:247]
    v_add_u32 v15, 0x10000, v15
    v_accvgpr_read_b32 v32, a136
    v_mfma_f32_16x16x32_bf16 a[248:251], a[112:115], v[40:43], a[248:251]
    v_accvgpr_read_b32 v31, a137
    v_cvt_pk_bf16_f32 v32, v32, v31
    v_mfma_f32_16x16x32_bf16 a[248:251], a[116:119], v[44:47], a[248:251]
    v_accvgpr_read_b32 v33, a138
    v_accvgpr_read_b32 v31, a139
    v_mfma_f32_16x16x32_bf16 a[252:255], a[120:123], v[40:43], a[252:255]
    buffer_load_dwordx4 v1, s[28:31], s65 offen offset:1024 sc1 lds
    v_mfma_f32_16x16x32_bf16 a[252:255], a[124:127], v[44:47], a[252:255]
    s_waitcnt lgkmcnt(0)
    ds_read_b64_tr_b16 v[40:41], v16 offset:0
    ds_read_b64_tr_b16 v[42:43], v16 offset:1024
    v_mfma_f32_16x16x32_bf16 v[128:131], v[48:51], v[64:67], 0
    ds_read_b64_tr_b16 v[44:45], v16 offset:8192
    ds_read_b64_tr_b16 v[46:47], v16 offset:9216
    v_mfma_f32_16x16x32_bf16 v[128:131], v[52:55], v[68:71], v[128:131]
    v_add_u32 v24, 0x10000, v24
    ds_read_b128 a[136:139], v22 offset:32768
    v_mfma_f32_16x16x32_bf16 v[132:135], v[48:51], v[72:75], 0
    ds_read_b128 v[96:99], v24 offset:16384
    v_add_u32 v16, 0x10000, v16
    v_mfma_f32_16x16x32_bf16 v[132:135], v[52:55], v[76:79], v[132:135]
    v_add_u32 v22, 0xffff0000, v22
    v_cvt_pk_bf16_f32 v33, v33, v31
    v_mfma_f32_16x16x32_bf16 v[136:139], v[48:51], v[80:83], 0
    v_accvgpr_read_b32 v34, a140
    v_accvgpr_read_b32 v31, a141
    v_mfma_f32_16x16x32_bf16 v[136:139], v[52:55], v[84:87], v[136:139]
    s_add_u32 s72, s71, 1024
    v_cvt_pk_bf16_f32 v34, v34, v31
    v_accvgpr_read_b32 v35, a142
    v_mfma_f32_16x16x32_bf16 v[140:143], v[48:51], v[88:91], 0
    s_add_u32 m0, s68, 8192
    ds_read_b64_tr_b16 v[48:49], v17 offset:0
    ds_read_b64_tr_b16 v[50:51], v17 offset:1024
    v_mfma_f32_16x16x32_bf16 v[140:143], v[52:55], v[92:95], v[140:143]
    buffer_load_dwordx4 v6, s[20:23], s66 offen lds
    v_mfma_f32_16x16x32_bf16 v[144:147], v[56:59], v[64:67], 0
    ds_read_b64_tr_b16 v[52:53], v17 offset:8192
    ds_read_b64_tr_b16 v[54:55], v17 offset:9216
    v_mfma_f32_16x16x32_bf16 v[144:147], v[60:63], v[68:71], v[144:147]
    v_add_u32 v17, 0x10000, v17
    v_accvgpr_read_b32 v31, a143
    v_mfma_f32_16x16x32_bf16 v[148:151], v[56:59], v[72:75], 0
    ds_read_b128 a[140:143], v23 offset:32768
    v_add_u32 v23, 0xffff0000, v23
    v_mfma_f32_16x16x32_bf16 v[148:151], v[60:63], v[76:79], v[148:151]
    v_cvt_pk_bf16_f32 v35, v35, v31
    v_accvgpr_write_b32 a52, v216
    v_mfma_f32_16x16x32_bf16 v[152:155], v[56:59], v[80:83], 0
    v_add_u32 v25, 0x10000, v25
    v_accvgpr_write_b32 a53, v217
    v_mfma_f32_16x16x32_bf16 v[152:155], v[60:63], v[84:87], v[152:155]
    ds_read_b128 v[100:103], v25 offset:16384
    v_accvgpr_write_b32 a54, v218
    v_mfma_f32_16x16x32_bf16 v[156:159], v[56:59], v[88:91], 0
    s_add_u32 m0, s69, 16384
    ds_read_b64_tr_b16 v[56:57], v18 offset:0
    ds_read_b64_tr_b16 v[58:59], v18 offset:1024
    v_mfma_f32_16x16x32_bf16 v[156:159], v[60:63], v[92:95], v[156:159]
    s_xor_b32 s65, s65, 24576
    buffer_load_dwordx4 v10, s[20:23], s64 offen lds
    s_waitcnt lgkmcnt(3)
    v_mfma_f32_16x16x32_bf16 v[160:163], v[40:43], v[64:67], 0
    s_xor_b32 s66, s66, 384
    ds_read_b64_tr_b16 v[60:61], v18 offset:8192
    ds_read_b64_tr_b16 v[62:63], v18 offset:9216
    v_mfma_f32_16x16x32_bf16 v[160:163], v[44:47], v[68:71], v[160:163]
    v_add_u32 v18, 0x10000, v18
    v_accvgpr_write_b32 a55, v219
    v_mfma_f32_16x16x32_bf16 v[164:167], v[40:43], v[72:75], 0
    buffer_store_dwordx4 v[32:35], v1, s[36:39], s72 offen sc1
    v_mfma_f32_16x16x32_bf16 v[164:167], v[44:47], v[76:79], v[164:167]
    v_cvt_pk_bf16_f32 v220, v220, v221
    v_cvt_pk_bf16_f32 v221, v222, v223
    v_mfma_f32_16x16x32_bf16 v[168:171], v[40:43], v[80:83], 0
    v_cvt_pk_bf16_f32 v222, v252, v253
    v_cvt_pk_bf16_f32 v223, v254, v255
    v_mfma_f32_16x16x32_bf16 v[168:171], v[44:47], v[84:87], v[168:171]
    v_accvgpr_write_b32 a60, v220
    v_accvgpr_write_b32 a61, v221
    v_mfma_f32_16x16x32_bf16 v[172:175], v[40:43], v[88:91], 0
    ds_read_b64_tr_b16 v[40:41], v19 offset:0
    ds_read_b64_tr_b16 v[42:43], v19 offset:1024
    v_mfma_f32_16x16x32_bf16 v[172:175], v[44:47], v[92:95], v[172:175]
    ds_read_b64_tr_b16 v[44:45], v19 offset:8192
    ds_read_b64_tr_b16 v[46:47], v19 offset:9216
    v_mfma_f32_16x16x32_bf16 v[176:179], v[48:51], v[64:67], 0
    buffer_load_dwordx4 v11, s[20:23], s64 offen offset:1024 lds
    v_mfma_f32_16x16x32_bf16 v[176:179], v[52:55], v[68:71], v[176:179]
    ds_read_b128 v[104:107], v24 offset:24576
    v_add_u32 v19, 0x10000, v19
    v_mfma_f32_16x16x32_bf16 v[180:183], v[48:51], v[72:75], 0
    v_accvgpr_write_b32 a62, v222
    v_accvgpr_write_b32 a63, v223
    v_mfma_f32_16x16x32_bf16 v[180:183], v[52:55], v[76:79], v[180:183]
    v_accvgpr_write_b32 a0, 0
    v_accvgpr_write_b32 a1, 0
    v_mfma_f32_16x16x32_bf16 v[184:187], v[48:51], v[80:83], 0
    v_accvgpr_write_b32 a2, 0
    v_accvgpr_write_b32 a3, 0
    v_mfma_f32_16x16x32_bf16 v[184:187], v[52:55], v[84:87], v[184:187]
    v_accvgpr_write_b32 a8, 0
    v_accvgpr_write_b32 a9, 0
    v_mfma_f32_16x16x32_bf16 v[188:191], v[48:51], v[88:91], 0
    s_add_u32 s72, s70, 36864
    ds_read_b64_tr_b16 v[48:49], v20 offset:0
    ds_read_b64_tr_b16 v[50:51], v20 offset:1024
    v_mfma_f32_16x16x32_bf16 v[188:191], v[52:55], v[92:95], v[188:191]
    s_waitcnt lgkmcnt(2)
    ds_read_b64_tr_b16 v[52:53], v20 offset:8192
    ds_read_b64_tr_b16 v[54:55], v20 offset:9216
    v_mfma_f32_16x16x32_bf16 v[192:195], v[56:59], v[64:67], 0
    buffer_load_dwordx4 v12, s[20:23], s64 offen offset:2048 lds
    v_mfma_f32_16x16x32_bf16 v[192:195], v[60:63], v[68:71], v[192:195]
    v_add_u32 v20, 0x10000, v20
    v_accvgpr_write_b32 a10, 0
    v_mfma_f32_16x16x32_bf16 v[196:199], v[56:59], v[72:75], 0
    buffer_store_dwordx4 a[40:43], v1, s[36:39], s72 offen sc1
    v_mfma_f32_16x16x32_bf16 v[196:199], v[60:63], v[76:79], v[196:199]
    ds_read_b128 v[108:111], v25 offset:24576
    v_accvgpr_write_b32 a11, 0
    v_mfma_f32_16x16x32_bf16 v[200:203], v[56:59], v[80:83], 0
    v_accvgpr_write_b32 a16, 0
    v_accvgpr_write_b32 a17, 0
    v_mfma_f32_16x16x32_bf16 v[200:203], v[60:63], v[84:87], v[200:203]
    v_accvgpr_write_b32 a18, 0
    v_accvgpr_write_b32 a19, 0
    v_mfma_f32_16x16x32_bf16 v[204:207], v[56:59], v[88:91], 0
    ds_read_b64_tr_b16 v[56:57], v21 offset:0
    ds_read_b64_tr_b16 v[58:59], v21 offset:1024
    v_mfma_f32_16x16x32_bf16 v[204:207], v[60:63], v[92:95], v[204:207]
    ds_read_b64_tr_b16 v[60:61], v21 offset:8192
    ds_read_b64_tr_b16 v[62:63], v21 offset:9216
    v_mfma_f32_16x16x32_bf16 v[208:211], v[40:43], v[64:67], 0
    v_add_u32 v21, 0x10000, v21
    v_accvgpr_write_b32 a24, 0
    v_mfma_f32_16x16x32_bf16 v[208:211], v[44:47], v[68:71], v[208:211]
    buffer_load_dwordx4 v13, s[20:23], s64 offen offset:3072 lds
    v_mfma_f32_16x16x32_bf16 v[212:215], v[40:43], v[72:75], 0
    v_accvgpr_write_b32 a25, 0
    v_accvgpr_write_b32 a26, 0
    v_mfma_f32_16x16x32_bf16 v[212:215], v[44:47], v[76:79], v[212:215]
    v_accvgpr_write_b32 a27, 0
    v_accvgpr_write_b32 a32, 0
    v_mfma_f32_16x16x32_bf16 v[216:219], v[40:43], v[80:83], 0
    v_accvgpr_write_b32 a33, 0
    v_accvgpr_write_b32 a34, 0
    v_mfma_f32_16x16x32_bf16 v[216:219], v[44:47], v[84:87], v[216:219]
    v_accvgpr_write_b32 a35, 0
    v_accvgpr_write_b32 a40, 0
    v_mfma_f32_16x16x32_bf16 v[220:223], v[40:43], v[88:91], 0
    ds_read_b64_tr_b16 v[40:41], v26 offset:32768
    ds_read_b64_tr_b16 v[42:43], v26 offset:33280
    v_mfma_f32_16x16x32_bf16 v[220:223], v[44:47], v[92:95], v[220:223]
    s_waitcnt lgkmcnt(2)
    ds_read_b64_tr_b16 v[44:45], v26 offset:36864
    ds_read_b64_tr_b16 v[46:47], v26 offset:37376
    v_mfma_f32_16x16x32_bf16 v[224:227], v[48:51], v[64:67], 0
    v_add_u32 v26, 0xffff0000, v26
    v_accvgpr_write_b32 a41, 0
    v_mfma_f32_16x16x32_bf16 v[224:227], v[52:55], v[68:71], v[224:227]
    s_xor_b32 s64, s64, 128
    v_accvgpr_write_b32 a42, 0
    v_accvgpr_write_b32 a43, 0
    v_mfma_f32_16x16x32_bf16 v[228:231], v[48:51], v[72:75], 0
    v_mfma_f32_16x16x32_bf16 v[228:231], v[52:55], v[76:79], v[228:231]
    v_mfma_f32_16x16x32_bf16 v[232:235], v[48:51], v[80:83], 0
    v_mfma_f32_16x16x32_bf16 v[232:235], v[52:55], v[84:87], v[232:235]
    s_add_u32 m0, s69, 32768
    v_mfma_f32_16x16x32_bf16 v[236:239], v[48:51], v[88:91], 0
    buffer_load_dwordx4 v2, s[24:27], s60 offen lds
    v_mfma_f32_16x16x32_bf16 v[236:239], v[52:55], v[92:95], v[236:239]
    s_add_u32 s72, s70, 40960
    ds_read_b64_tr_b16 v[48:49], v27 offset:32768
    ds_read_b64_tr_b16 v[50:51], v27 offset:33280
    v_mfma_f32_16x16x32_bf16 v[240:243], v[56:59], v[64:67], 0
    ds_read_b64_tr_b16 v[52:53], v27 offset:36864
    ds_read_b64_tr_b16 v[54:55], v27 offset:37376
    v_mfma_f32_16x16x32_bf16 v[240:243], v[60:63], v[68:71], v[240:243]
    buffer_store_dwordx4 a[48:51], v1, s[36:39], s72 offen sc1
    v_mfma_f32_16x16x32_bf16 v[244:247], v[56:59], v[72:75], 0
    buffer_load_dwordx4 v3, s[24:27], s60 offen offset:1024 lds
    v_mfma_f32_16x16x32_bf16 v[244:247], v[60:63], v[76:79], v[244:247]
    v_add_u32 v27, 0xffff0000, v27
    v_accvgpr_write_b32 a48, 0
    v_mfma_f32_16x16x32_bf16 v[248:251], v[56:59], v[80:83], 0
    v_accvgpr_write_b32 a49, 0
    v_accvgpr_write_b32 a50, 0
    v_mfma_f32_16x16x32_bf16 v[248:251], v[60:63], v[84:87], v[248:251]
    v_accvgpr_write_b32 a51, 0
    v_mfma_f32_16x16x32_bf16 v[252:255], v[56:59], v[88:91], 0
    buffer_load_dwordx4 v4, s[24:27], s60 offen offset:2048 lds
    v_mfma_f32_16x16x32_bf16 v[252:255], v[60:63], v[92:95], v[252:255]
    s_waitcnt lgkmcnt(0)
    ds_read_b64_tr_b16 v[56:57], v28 offset:32768
    ds_read_b64_tr_b16 v[58:59], v28 offset:33280
    v_mfma_f32_16x16x32_bf16 a[64:67], v[40:43], v[64:67], 0
    ds_read_b64_tr_b16 v[60:61], v28 offset:36864
    ds_read_b64_tr_b16 v[62:63], v28 offset:37376
    v_mfma_f32_16x16x32_bf16 a[64:67], v[44:47], v[68:71], a[64:67]
    v_add_u32 v28, 0xffff0000, v28
    v_mfma_f32_16x16x32_bf16 a[68:71], v[40:43], v[72:75], 0
    buffer_load_dwordx4 v5, s[24:27], s60 offen offset:3072 lds
    v_mfma_f32_16x16x32_bf16 a[68:71], v[44:47], v[76:79], a[68:71]
    ds_read_b128 v[112:115], v24 offset:49152
    v_mfma_f32_16x16x32_bf16 a[72:75], v[40:43], v[80:83], 0
    v_mfma_f32_16x16x32_bf16 a[72:75], v[44:47], v[84:87], a[72:75]
    s_add_u32 m0, s69, 49152
    v_mfma_f32_16x16x32_bf16 a[76:79], v[40:43], v[88:91], 0
    s_xor_b32 s60, s60, 524288
    buffer_load_dwordx4 v10, s[20:23], s63 offen lds
    v_mfma_f32_16x16x32_bf16 a[76:79], v[44:47], v[92:95], a[76:79]
    ds_read_b128 v[116:119], v25 offset:49152
    v_mfma_f32_16x16x32_bf16 a[128:131], v[40:43], a[136:139], 0
    ds_read_b64_tr_b16 v[40:41], v29 offset:32768
    ds_read_b64_tr_b16 v[42:43], v29 offset:33280
    v_mfma_f32_16x16x32_bf16 a[128:131], v[44:47], a[140:143], a[128:131]
    ds_read_b64_tr_b16 v[44:45], v29 offset:36864
    ds_read_b64_tr_b16 v[46:47], v29 offset:37376
    v_mfma_f32_16x16x32_bf16 a[80:83], v[48:51], v[64:67], 0
    buffer_load_dwordx4 v11, s[20:23], s63 offen offset:1024 lds
    v_mfma_f32_16x16x32_bf16 a[80:83], v[52:55], v[68:71], a[80:83]
    ds_read_b128 v[120:123], v24 offset:57344
    v_add_u32 v29, 0xffff0000, v29
    v_mfma_f32_16x16x32_bf16 a[84:87], v[48:51], v[72:75], 0
    v_mfma_f32_16x16x32_bf16 a[84:87], v[52:55], v[76:79], a[84:87]
    v_mfma_f32_16x16x32_bf16 a[88:91], v[48:51], v[80:83], 0
    buffer_load_dwordx4 v12, s[20:23], s63 offen offset:2048 lds
    v_mfma_f32_16x16x32_bf16 a[88:91], v[52:55], v[84:87], a[88:91]
    ds_read_b128 v[124:127], v25 offset:57344
    v_mfma_f32_16x16x32_bf16 a[92:95], v[48:51], v[88:91], 0
    s_add_u32 s72, s70, 45056
    v_mfma_f32_16x16x32_bf16 a[92:95], v[52:55], v[92:95], a[92:95]
    v_mfma_f32_16x16x32_bf16 a[132:135], v[48:51], a[136:139], 0
    buffer_load_dwordx4 v13, s[20:23], s63 offen offset:3072 lds
    v_mfma_f32_16x16x32_bf16 a[132:135], v[52:55], a[140:143], a[132:135]
    s_waitcnt lgkmcnt(1)
    v_mfma_f32_16x16x32_bf16 a[96:99], v[56:59], v[64:67], 0
    v_mfma_f32_16x16x32_bf16 a[96:99], v[60:63], v[68:71], a[96:99]
    s_xor_b32 s63, s63, 896
    v_mfma_f32_16x16x32_bf16 a[100:103], v[56:59], v[72:75], 0
    buffer_store_dwordx4 a[56:59], v1, s[36:39], s72 offen sc1
    v_mfma_f32_16x16x32_bf16 a[100:103], v[60:63], v[76:79], a[100:103]
    v_mfma_f32_16x16x32_bf16 a[104:107], v[56:59], v[80:83], 0
    v_accvgpr_write_b32 a56, 0
    v_accvgpr_write_b32 a57, 0
    v_mfma_f32_16x16x32_bf16 a[104:107], v[60:63], v[84:87], a[104:107]
    s_waitcnt vmcnt(10) lgkmcnt(0)
    s_barrier
    ds_read_b64_tr_b16 v[48:49], v14 offset:0
    v_mfma_f32_16x16x32_bf16 a[108:111], v[56:59], v[88:91], 0
    s_add_u32 m0, s67, 65536
    ds_read_b64_tr_b16 v[50:51], v14 offset:1024
    ds_read_b64_tr_b16 v[52:53], v14 offset:8192
    v_mfma_f32_16x16x32_bf16 a[108:111], v[60:63], v[92:95], a[108:111]
    buffer_load_dwordx4 v1, s[28:31], s65 offen sc1 lds
    v_mfma_f32_16x16x32_bf16 a[112:115], v[40:43], v[64:67], 0
    ds_read_b64_tr_b16 v[54:55], v14 offset:9216
    ds_read_b64_tr_b16 v[56:57], v15 offset:0
    v_mfma_f32_16x16x32_bf16 a[112:115], v[44:47], v[68:71], a[112:115]
    ds_read_b64_tr_b16 v[58:59], v15 offset:1024
    ds_read_b64_tr_b16 v[60:61], v15 offset:8192
    v_mfma_f32_16x16x32_bf16 a[116:119], v[40:43], v[72:75], 0
    ds_read_b64_tr_b16 v[62:63], v15 offset:9216
    ds_read_b128 a[136:139], v22 offset:0
    v_mfma_f32_16x16x32_bf16 a[116:119], v[44:47], v[76:79], a[116:119]
    ds_read_b128 a[140:143], v23 offset:0
    v_add_u32 v14, 0xfffe0000, v14
    v_mfma_f32_16x16x32_bf16 a[120:123], v[40:43], v[80:83], 0
    v_add_u32 v15, 0xfffe0000, v15
    v_add_u32 v22, 0x10000, v22
    v_mfma_f32_16x16x32_bf16 a[120:123], v[44:47], v[84:87], a[120:123]
    v_add_u32 v23, 0x10000, v23
    v_accvgpr_write_b32 a58, 0
    v_mfma_f32_16x16x32_bf16 a[124:127], v[40:43], v[88:91], 0
    buffer_load_dwordx4 v1, s[28:31], s65 offen offset:1024 sc1 lds
    v_mfma_f32_16x16x32_bf16 a[124:127], v[44:47], v[92:95], a[124:127]
    s_waitcnt lgkmcnt(1)
    ds_read_b64_tr_b16 v[40:41], v16 offset:0
    ds_read_b64_tr_b16 v[42:43], v16 offset:1024
    v_mfma_f32_16x16x32_bf16 v[128:131], v[48:51], v[96:99], v[128:131]
    ds_read_b64_tr_b16 v[44:45], v16 offset:8192
    ds_read_b64_tr_b16 v[46:47], v16 offset:9216
    v_mfma_f32_16x16x32_bf16 v[128:131], v[52:55], v[100:103], v[128:131]
    v_add_u32 v24, 0x10000, v24
    v_add_u32 v16, 0xfffe0000, v16
    v_mfma_f32_16x16x32_bf16 v[132:135], v[48:51], v[104:107], v[132:135]
    ds_read_b128 v[64:67], v24 offset:16384
    v_accvgpr_write_b32 a59, 0
    v_mfma_f32_16x16x32_bf16 v[132:135], v[52:55], v[108:111], v[132:135]
    v_mfma_f32_16x16x32_bf16 v[136:139], v[48:51], v[112:115], v[136:139]
    v_mfma_f32_16x16x32_bf16 v[136:139], v[52:55], v[116:119], v[136:139]
    s_add_u32 s72, s70, 1024
    v_mfma_f32_16x16x32_bf16 v[140:143], v[48:51], v[120:123], v[140:143]
    s_add_u32 m0, s68, 73728
    ds_read_b64_tr_b16 v[48:49], v17 offset:0
    ds_read_b64_tr_b16 v[50:51], v17 offset:1024
    v_mfma_f32_16x16x32_bf16 v[140:143], v[52:55], v[124:127], v[140:143]
    buffer_load_dwordx4 v6, s[20:23], s66 offen lds
    v_mfma_f32_16x16x32_bf16 v[144:147], v[56:59], v[96:99], v[144:147]
    ds_read_b64_tr_b16 v[52:53], v17 offset:8192
    ds_read_b64_tr_b16 v[54:55], v17 offset:9216
    v_mfma_f32_16x16x32_bf16 v[144:147], v[60:63], v[100:103], v[144:147]
    buffer_store_dwordx4 a[4:7], v1, s[36:39], s72 offen sc1
    v_mfma_f32_16x16x32_bf16 v[148:151], v[56:59], v[104:107], v[148:151]
    v_add_u32 v17, 0xfffe0000, v17
    v_accvgpr_write_b32 a4, 0
    v_mfma_f32_16x16x32_bf16 v[148:151], v[60:63], v[108:111], v[148:151]
    v_accvgpr_write_b32 a5, 0
    v_accvgpr_write_b32 a6, 0
    v_mfma_f32_16x16x32_bf16 v[152:155], v[56:59], v[112:115], v[152:155]
    v_add_u32 v25, 0x10000, v25
    v_accvgpr_write_b32 a7, 0
    v_mfma_f32_16x16x32_bf16 v[152:155], v[60:63], v[116:119], v[152:155]
    ds_read_b128 v[68:71], v25 offset:16384
    v_mfma_f32_16x16x32_bf16 v[156:159], v[56:59], v[120:123], v[156:159]
    s_add_u32 m0, s69, 81920
    ds_read_b64_tr_b16 v[56:57], v18 offset:0
    ds_read_b64_tr_b16 v[58:59], v18 offset:1024
    v_mfma_f32_16x16x32_bf16 v[156:159], v[60:63], v[124:127], v[156:159]
    s_xor_b32 s65, s65, 8192
    buffer_load_dwordx4 v10, s[20:23], s64 offen lds
    s_waitcnt lgkmcnt(3)
    v_mfma_f32_16x16x32_bf16 v[160:163], v[40:43], v[96:99], v[160:163]
    s_xor_b32 s66, s66, 128
    ds_read_b64_tr_b16 v[60:61], v18 offset:8192
    ds_read_b64_tr_b16 v[62:63], v18 offset:9216
    v_mfma_f32_16x16x32_bf16 v[160:163], v[44:47], v[100:103], v[160:163]
    v_add_u32 v18, 0xfffe0000, v18
    v_mfma_f32_16x16x32_bf16 v[164:167], v[40:43], v[104:107], v[164:167]
    v_mfma_f32_16x16x32_bf16 v[164:167], v[44:47], v[108:111], v[164:167]
    v_mfma_f32_16x16x32_bf16 v[168:171], v[40:43], v[112:115], v[168:171]
    v_mfma_f32_16x16x32_bf16 v[168:171], v[44:47], v[116:119], v[168:171]
    v_mfma_f32_16x16x32_bf16 v[172:175], v[40:43], v[120:123], v[172:175]
    ds_read_b64_tr_b16 v[40:41], v19 offset:0
    ds_read_b64_tr_b16 v[42:43], v19 offset:1024
    v_mfma_f32_16x16x32_bf16 v[172:175], v[44:47], v[124:127], v[172:175]
    ds_read_b64_tr_b16 v[44:45], v19 offset:8192
    ds_read_b64_tr_b16 v[46:47], v19 offset:9216
    v_mfma_f32_16x16x32_bf16 v[176:179], v[48:51], v[96:99], v[176:179]
    buffer_load_dwordx4 v11, s[20:23], s64 offen offset:1024 lds
    v_mfma_f32_16x16x32_bf16 v[176:179], v[52:55], v[100:103], v[176:179]
    ds_read_b128 v[72:75], v24 offset:24576
    v_add_u32 v19, 0xfffe0000, v19
    v_mfma_f32_16x16x32_bf16 v[180:183], v[48:51], v[104:107], v[180:183]
    v_mfma_f32_16x16x32_bf16 v[180:183], v[52:55], v[108:111], v[180:183]
    v_mfma_f32_16x16x32_bf16 v[184:187], v[48:51], v[112:115], v[184:187]
    v_mfma_f32_16x16x32_bf16 v[184:187], v[52:55], v[116:119], v[184:187]
    v_mfma_f32_16x16x32_bf16 v[188:191], v[48:51], v[120:123], v[188:191]
    s_add_u32 s72, s70, 5120
    ds_read_b64_tr_b16 v[48:49], v20 offset:0
    ds_read_b64_tr_b16 v[50:51], v20 offset:1024
    v_mfma_f32_16x16x32_bf16 v[188:191], v[52:55], v[124:127], v[188:191]
    s_waitcnt lgkmcnt(2)
    ds_read_b64_tr_b16 v[52:53], v20 offset:8192
    ds_read_b64_tr_b16 v[54:55], v20 offset:9216
    v_mfma_f32_16x16x32_bf16 v[192:195], v[56:59], v[96:99], v[192:195]
    buffer_load_dwordx4 v12, s[20:23], s64 offen offset:2048 lds
    v_mfma_f32_16x16x32_bf16 v[192:195], v[60:63], v[100:103], v[192:195]
    buffer_store_dwordx4 a[12:15], v1, s[36:39], s72 offen sc1
    v_mfma_f32_16x16x32_bf16 v[196:199], v[56:59], v[104:107], v[196:199]
    v_add_u32 v20, 0xfffe0000, v20
    v_accvgpr_write_b32 a12, 0
    v_mfma_f32_16x16x32_bf16 v[196:199], v[60:63], v[108:111], v[196:199]
    ds_read_b128 v[76:79], v25 offset:24576
    v_accvgpr_write_b32 a13, 0
    v_mfma_f32_16x16x32_bf16 v[200:203], v[56:59], v[112:115], v[200:203]
    v_accvgpr_write_b32 a14, 0
    v_accvgpr_write_b32 a15, 0
    v_mfma_f32_16x16x32_bf16 v[200:203], v[60:63], v[116:119], v[200:203]
    v_mfma_f32_16x16x32_bf16 v[204:207], v[56:59], v[120:123], v[204:207]
    ds_read_b64_tr_b16 v[56:57], v21 offset:0
    ds_read_b64_tr_b16 v[58:59], v21 offset:1024
    v_mfma_f32_16x16x32_bf16 v[204:207], v[60:63], v[124:127], v[204:207]
    ds_read_b64_tr_b16 v[60:61], v21 offset:8192
    ds_read_b64_tr_b16 v[62:63], v21 offset:9216
    v_mfma_f32_16x16x32_bf16 v[208:211], v[40:43], v[96:99], v[208:211]
    v_add_u32 v21, 0xfffe0000, v21
    v_mfma_f32_16x16x32_bf16 v[208:211], v[44:47], v[100:103], v[208:211]
    buffer_load_dwordx4 v13, s[20:23], s64 offen offset:3072 lds
    v_mfma_f32_16x16x32_bf16 v[212:215], v[40:43], v[104:107], v[212:215]
    v_mfma_f32_16x16x32_bf16 v[212:215], v[44:47], v[108:111], v[212:215]
    v_mfma_f32_16x16x32_bf16 v[216:219], v[40:43], v[112:115], v[216:219]
    v_mfma_f32_16x16x32_bf16 v[216:219], v[44:47], v[116:119], v[216:219]
    v_mfma_f32_16x16x32_bf16 v[220:223], v[40:43], v[120:123], v[220:223]
    ds_read_b64_tr_b16 v[40:41], v26 offset:0
    ds_read_b64_tr_b16 v[42:43], v26 offset:512
    v_mfma_f32_16x16x32_bf16 v[220:223], v[44:47], v[124:127], v[220:223]
    s_waitcnt lgkmcnt(2)
    ds_read_b64_tr_b16 v[44:45], v26 offset:4096
    ds_read_b64_tr_b16 v[46:47], v26 offset:4608
    v_mfma_f32_16x16x32_bf16 v[224:227], v[48:51], v[96:99], v[224:227]
    v_add_u32 v26, 0x10000, v26
    v_mfma_f32_16x16x32_bf16 v[224:227], v[52:55], v[100:103], v[224:227]
    s_xor_b32 s64, s64, 896
    v_mfma_f32_16x16x32_bf16 v[228:231], v[48:51], v[104:107], v[228:231]
    v_mfma_f32_16x16x32_bf16 v[228:231], v[52:55], v[108:111], v[228:231]
    v_mfma_f32_16x16x32_bf16 v[232:235], v[48:51], v[112:115], v[232:235]
    v_mfma_f32_16x16x32_bf16 v[232:235], v[52:55], v[116:119], v[232:235]
    s_add_u32 m0, s69, 98304
    v_mfma_f32_16x16x32_bf16 v[236:239], v[48:51], v[120:123], v[236:239]
    buffer_load_dwordx4 v2, s[24:27], s60 offen lds
    v_mfma_f32_16x16x32_bf16 v[236:239], v[52:55], v[124:127], v[236:239]
    s_add_u32 s72, s70, 9216
    ds_read_b64_tr_b16 v[48:49], v27 offset:0
    ds_read_b64_tr_b16 v[50:51], v27 offset:512
    v_mfma_f32_16x16x32_bf16 v[240:243], v[56:59], v[96:99], v[240:243]
    ds_read_b64_tr_b16 v[52:53], v27 offset:4096
    ds_read_b64_tr_b16 v[54:55], v27 offset:4608
    v_mfma_f32_16x16x32_bf16 v[240:243], v[60:63], v[100:103], v[240:243]
    buffer_store_dwordx4 a[20:23], v1, s[36:39], s72 offen sc1
    v_mfma_f32_16x16x32_bf16 v[244:247], v[56:59], v[104:107], v[244:247]
    buffer_load_dwordx4 v3, s[24:27], s60 offen offset:1024 lds
    v_mfma_f32_16x16x32_bf16 v[244:247], v[60:63], v[108:111], v[244:247]
    v_add_u32 v27, 0x10000, v27
    v_accvgpr_write_b32 a20, 0
    v_mfma_f32_16x16x32_bf16 v[248:251], v[56:59], v[112:115], v[248:251]
    v_accvgpr_write_b32 a21, 0
    v_accvgpr_write_b32 a22, 0
    v_mfma_f32_16x16x32_bf16 v[248:251], v[60:63], v[116:119], v[248:251]
    v_accvgpr_write_b32 a23, 0
    v_mfma_f32_16x16x32_bf16 v[252:255], v[56:59], v[120:123], v[252:255]
    buffer_load_dwordx4 v4, s[24:27], s60 offen offset:2048 lds
    v_mfma_f32_16x16x32_bf16 v[252:255], v[60:63], v[124:127], v[252:255]
    s_waitcnt lgkmcnt(0)
    ds_read_b64_tr_b16 v[56:57], v28 offset:0
    ds_read_b64_tr_b16 v[58:59], v28 offset:512
    v_mfma_f32_16x16x32_bf16 a[64:67], v[40:43], v[96:99], a[64:67]
    ds_read_b64_tr_b16 v[60:61], v28 offset:4096
    ds_read_b64_tr_b16 v[62:63], v28 offset:4608
    v_mfma_f32_16x16x32_bf16 a[64:67], v[44:47], v[100:103], a[64:67]
    v_add_u32 v24, 0xfffe0000, v24
    v_add_u32 v28, 0x10000, v28
    v_mfma_f32_16x16x32_bf16 a[68:71], v[40:43], v[104:107], a[68:71]
    buffer_load_dwordx4 v5, s[24:27], s60 offen offset:3072 lds
    v_mfma_f32_16x16x32_bf16 a[68:71], v[44:47], v[108:111], a[68:71]
    ds_read_b128 v[80:83], v24 offset:16384
    v_mfma_f32_16x16x32_bf16 a[72:75], v[40:43], v[112:115], a[72:75]
    v_mfma_f32_16x16x32_bf16 a[72:75], v[44:47], v[116:119], a[72:75]
    s_add_u32 m0, s69, 114688
    v_add_u32 v25, 0xfffe0000, v25
    v_mfma_f32_16x16x32_bf16 a[76:79], v[40:43], v[120:123], a[76:79]
    s_xor_b32 s60, s60, 3670016
    buffer_load_dwordx4 v10, s[20:23], s63 offen lds
    v_mfma_f32_16x16x32_bf16 a[76:79], v[44:47], v[124:127], a[76:79]
    ds_read_b128 v[84:87], v25 offset:16384
    v_mfma_f32_16x16x32_bf16 a[128:131], v[40:43], a[136:139], a[128:131]
    ds_read_b64_tr_b16 v[40:41], v29 offset:0
    ds_read_b64_tr_b16 v[42:43], v29 offset:512
    v_mfma_f32_16x16x32_bf16 a[128:131], v[44:47], a[140:143], a[128:131]
    ds_read_b64_tr_b16 v[44:45], v29 offset:4096
    ds_read_b64_tr_b16 v[46:47], v29 offset:4608
    v_mfma_f32_16x16x32_bf16 a[80:83], v[48:51], v[96:99], a[80:83]
    buffer_load_dwordx4 v11, s[20:23], s63 offen offset:1024 lds
    v_mfma_f32_16x16x32_bf16 a[80:83], v[52:55], v[100:103], a[80:83]
    ds_read_b128 v[88:91], v24 offset:24576
    v_add_u32 v29, 0x10000, v29
    v_mfma_f32_16x16x32_bf16 a[84:87], v[48:51], v[104:107], a[84:87]
    v_mfma_f32_16x16x32_bf16 a[84:87], v[52:55], v[108:111], a[84:87]
    v_mfma_f32_16x16x32_bf16 a[88:91], v[48:51], v[112:115], a[88:91]
    buffer_load_dwordx4 v12, s[20:23], s63 offen offset:2048 lds
    v_mfma_f32_16x16x32_bf16 a[88:91], v[52:55], v[116:119], a[88:91]
    ds_read_b128 v[92:95], v25 offset:24576
    v_mfma_f32_16x16x32_bf16 a[92:95], v[48:51], v[120:123], a[92:95]
    s_add_u32 s72, s70, 13312
    v_mfma_f32_16x16x32_bf16 a[92:95], v[52:55], v[124:127], a[92:95]
    v_mfma_f32_16x16x32_bf16 a[132:135], v[48:51], a[136:139], a[132:135]
    buffer_load_dwordx4 v13, s[20:23], s63 offen offset:3072 lds
    v_mfma_f32_16x16x32_bf16 a[132:135], v[52:55], a[140:143], a[132:135]
    s_waitcnt lgkmcnt(1)
    v_mfma_f32_16x16x32_bf16 a[96:99], v[56:59], v[96:99], a[96:99]
    v_mfma_f32_16x16x32_bf16 a[96:99], v[60:63], v[100:103], a[96:99]
    s_xor_b32 s63, s63, 128
    v_mfma_f32_16x16x32_bf16 a[100:103], v[56:59], v[104:107], a[100:103]
    buffer_store_dwordx4 a[28:31], v1, s[36:39], s72 offen sc1
    v_mfma_f32_16x16x32_bf16 a[100:103], v[60:63], v[108:111], a[100:103]
    v_mfma_f32_16x16x32_bf16 a[104:107], v[56:59], v[112:115], a[104:107]
    v_accvgpr_write_b32 a28, 0
    v_accvgpr_write_b32 a29, 0
    v_mfma_f32_16x16x32_bf16 a[104:107], v[60:63], v[116:119], a[104:107]
    s_waitcnt vmcnt(10) lgkmcnt(0)
    s_barrier
    ds_read_b64_tr_b16 v[48:49], v14 offset:32768
    v_mfma_f32_16x16x32_bf16 a[108:111], v[56:59], v[120:123], a[108:111]
    s_add_u32 m0, s67, 131072
    ds_read_b64_tr_b16 v[50:51], v14 offset:33792
    ds_read_b64_tr_b16 v[52:53], v14 offset:40960
    v_mfma_f32_16x16x32_bf16 a[108:111], v[60:63], v[124:127], a[108:111]
    buffer_load_dwordx4 v1, s[28:31], s65 offen sc1 lds
    v_mfma_f32_16x16x32_bf16 a[112:115], v[40:43], v[96:99], a[112:115]
    ds_read_b64_tr_b16 v[54:55], v14 offset:41984
    ds_read_b64_tr_b16 v[56:57], v15 offset:32768
    v_mfma_f32_16x16x32_bf16 a[112:115], v[44:47], v[100:103], a[112:115]
    ds_read_b64_tr_b16 v[58:59], v15 offset:33792
    ds_read_b64_tr_b16 v[60:61], v15 offset:40960
    v_mfma_f32_16x16x32_bf16 a[116:119], v[40:43], v[104:107], a[116:119]
    ds_read_b64_tr_b16 v[62:63], v15 offset:41984
    ds_read_b128 a[136:139], v22 offset:0
    v_mfma_f32_16x16x32_bf16 a[116:119], v[44:47], v[108:111], a[116:119]
    ds_read_b128 a[140:143], v23 offset:0
    v_add_u32 v14, 0x10000, v14
    v_mfma_f32_16x16x32_bf16 a[120:123], v[40:43], v[112:115], a[120:123]
    v_add_u32 v15, 0x10000, v15
    v_add_u32 v22, 0x10000, v22
    v_mfma_f32_16x16x32_bf16 a[120:123], v[44:47], v[116:119], a[120:123]
    v_add_u32 v23, 0x10000, v23
    v_accvgpr_write_b32 a30, 0
    v_mfma_f32_16x16x32_bf16 a[124:127], v[40:43], v[120:123], a[124:127]
    buffer_load_dwordx4 v1, s[28:31], s65 offen offset:1024 sc1 lds
    v_mfma_f32_16x16x32_bf16 a[124:127], v[44:47], v[124:127], a[124:127]
    s_waitcnt lgkmcnt(1)
    ds_read_b64_tr_b16 v[40:41], v16 offset:32768
    ds_read_b64_tr_b16 v[42:43], v16 offset:33792
    v_mfma_f32_16x16x32_bf16 v[128:131], v[48:51], v[64:67], v[128:131]
    ds_read_b64_tr_b16 v[44:45], v16 offset:40960
    ds_read_b64_tr_b16 v[46:47], v16 offset:41984
    v_mfma_f32_16x16x32_bf16 v[128:131], v[52:55], v[68:71], v[128:131]
    v_add_u32 v16, 0x10000, v16
    v_accvgpr_write_b32 a31, 0
    v_mfma_f32_16x16x32_bf16 v[132:135], v[48:51], v[72:75], v[132:135]
    ds_read_b128 v[96:99], v24 offset:49152
    v_mfma_f32_16x16x32_bf16 v[132:135], v[52:55], v[76:79], v[132:135]
    v_mfma_f32_16x16x32_bf16 v[136:139], v[48:51], v[80:83], v[136:139]
    v_mfma_f32_16x16x32_bf16 v[136:139], v[52:55], v[84:87], v[136:139]
    s_add_u32 s72, s70, 33792
    v_mfma_f32_16x16x32_bf16 v[140:143], v[48:51], v[88:91], v[140:143]
    s_add_u32 m0, s68, 139264
    ds_read_b64_tr_b16 v[48:49], v17 offset:32768
    ds_read_b64_tr_b16 v[50:51], v17 offset:33792
    v_mfma_f32_16x16x32_bf16 v[140:143], v[52:55], v[92:95], v[140:143]
    buffer_load_dwordx4 v6, s[20:23], s66 offen lds
    v_mfma_f32_16x16x32_bf16 v[144:147], v[56:59], v[64:67], v[144:147]
    ds_read_b64_tr_b16 v[52:53], v17 offset:40960
    ds_read_b64_tr_b16 v[54:55], v17 offset:41984
    v_mfma_f32_16x16x32_bf16 v[144:147], v[60:63], v[68:71], v[144:147]
    buffer_store_dwordx4 a[36:39], v1, s[36:39], s72 offen sc1
    v_mfma_f32_16x16x32_bf16 v[148:151], v[56:59], v[72:75], v[148:151]
    v_add_u32 v17, 0x10000, v17
    v_accvgpr_write_b32 a36, 0
    v_mfma_f32_16x16x32_bf16 v[148:151], v[60:63], v[76:79], v[148:151]
    v_accvgpr_write_b32 a37, 0
    v_accvgpr_write_b32 a38, 0
    v_mfma_f32_16x16x32_bf16 v[152:155], v[56:59], v[80:83], v[152:155]
    v_accvgpr_write_b32 a39, 0
    v_mfma_f32_16x16x32_bf16 v[152:155], v[60:63], v[84:87], v[152:155]
    ds_read_b128 v[100:103], v25 offset:49152
    v_mfma_f32_16x16x32_bf16 v[156:159], v[56:59], v[88:91], v[156:159]
    s_add_u32 m0, s69, 147456
    ds_read_b64_tr_b16 v[56:57], v18 offset:32768
    ds_read_b64_tr_b16 v[58:59], v18 offset:33792
    v_mfma_f32_16x16x32_bf16 v[156:159], v[60:63], v[92:95], v[156:159]
    s_xor_b32 s65, s65, 57344
    buffer_load_dwordx4 v10, s[20:23], s64 offen lds
    s_waitcnt lgkmcnt(3)
    v_mfma_f32_16x16x32_bf16 v[160:163], v[40:43], v[64:67], v[160:163]
    s_xor_b32 s66, s66, 896
    ds_read_b64_tr_b16 v[60:61], v18 offset:40960
    ds_read_b64_tr_b16 v[62:63], v18 offset:41984
    v_mfma_f32_16x16x32_bf16 v[160:163], v[44:47], v[68:71], v[160:163]
    v_add_u32 v18, 0x10000, v18
    v_mfma_f32_16x16x32_bf16 v[164:167], v[40:43], v[72:75], v[164:167]
    v_mfma_f32_16x16x32_bf16 v[164:167], v[44:47], v[76:79], v[164:167]
    v_mfma_f32_16x16x32_bf16 v[168:171], v[40:43], v[80:83], v[168:171]
    v_mfma_f32_16x16x32_bf16 v[168:171], v[44:47], v[84:87], v[168:171]
    v_mfma_f32_16x16x32_bf16 v[172:175], v[40:43], v[88:91], v[172:175]
    ds_read_b64_tr_b16 v[40:41], v19 offset:32768
    ds_read_b64_tr_b16 v[42:43], v19 offset:33792
    v_mfma_f32_16x16x32_bf16 v[172:175], v[44:47], v[92:95], v[172:175]
    ds_read_b64_tr_b16 v[44:45], v19 offset:40960
    ds_read_b64_tr_b16 v[46:47], v19 offset:41984
    v_mfma_f32_16x16x32_bf16 v[176:179], v[48:51], v[64:67], v[176:179]
    buffer_load_dwordx4 v11, s[20:23], s64 offen offset:1024 lds
    v_mfma_f32_16x16x32_bf16 v[176:179], v[52:55], v[68:71], v[176:179]
    ds_read_b128 v[104:107], v24 offset:57344
    v_add_u32 v19, 0x10000, v19
    v_mfma_f32_16x16x32_bf16 v[180:183], v[48:51], v[72:75], v[180:183]
    v_mfma_f32_16x16x32_bf16 v[180:183], v[52:55], v[76:79], v[180:183]
    v_mfma_f32_16x16x32_bf16 v[184:187], v[48:51], v[80:83], v[184:187]
    v_mfma_f32_16x16x32_bf16 v[184:187], v[52:55], v[84:87], v[184:187]
    v_mfma_f32_16x16x32_bf16 v[188:191], v[48:51], v[88:91], v[188:191]
    s_add_u32 s72, s70, 37888
    ds_read_b64_tr_b16 v[48:49], v20 offset:32768
    ds_read_b64_tr_b16 v[50:51], v20 offset:33792
    v_mfma_f32_16x16x32_bf16 v[188:191], v[52:55], v[92:95], v[188:191]
    s_waitcnt lgkmcnt(2)
    ds_read_b64_tr_b16 v[52:53], v20 offset:40960
    ds_read_b64_tr_b16 v[54:55], v20 offset:41984
    v_mfma_f32_16x16x32_bf16 v[192:195], v[56:59], v[64:67], v[192:195]
    buffer_load_dwordx4 v12, s[20:23], s64 offen offset:2048 lds
    v_mfma_f32_16x16x32_bf16 v[192:195], v[60:63], v[68:71], v[192:195]
    buffer_store_dwordx4 a[44:47], v1, s[36:39], s72 offen sc1
    v_mfma_f32_16x16x32_bf16 v[196:199], v[56:59], v[72:75], v[196:199]
    v_add_u32 v20, 0x10000, v20
    v_accvgpr_write_b32 a44, 0
    v_mfma_f32_16x16x32_bf16 v[196:199], v[60:63], v[76:79], v[196:199]
    ds_read_b128 v[108:111], v25 offset:57344
    v_accvgpr_write_b32 a45, 0
    v_mfma_f32_16x16x32_bf16 v[200:203], v[56:59], v[80:83], v[200:203]
    v_accvgpr_write_b32 a46, 0
    v_accvgpr_write_b32 a47, 0
    v_mfma_f32_16x16x32_bf16 v[200:203], v[60:63], v[84:87], v[200:203]
    v_mfma_f32_16x16x32_bf16 v[204:207], v[56:59], v[88:91], v[204:207]
    ds_read_b64_tr_b16 v[56:57], v21 offset:32768
    ds_read_b64_tr_b16 v[58:59], v21 offset:33792
    v_mfma_f32_16x16x32_bf16 v[204:207], v[60:63], v[92:95], v[204:207]
    ds_read_b64_tr_b16 v[60:61], v21 offset:40960
    ds_read_b64_tr_b16 v[62:63], v21 offset:41984
    v_mfma_f32_16x16x32_bf16 v[208:211], v[40:43], v[64:67], v[208:211]
    v_add_u32 v21, 0x10000, v21
    v_mfma_f32_16x16x32_bf16 v[208:211], v[44:47], v[68:71], v[208:211]
    buffer_load_dwordx4 v13, s[20:23], s64 offen offset:3072 lds
    v_mfma_f32_16x16x32_bf16 v[212:215], v[40:43], v[72:75], v[212:215]
    v_mfma_f32_16x16x32_bf16 v[212:215], v[44:47], v[76:79], v[212:215]
    v_mfma_f32_16x16x32_bf16 v[216:219], v[40:43], v[80:83], v[216:219]
    v_mfma_f32_16x16x32_bf16 v[216:219], v[44:47], v[84:87], v[216:219]
    v_mfma_f32_16x16x32_bf16 v[220:223], v[40:43], v[88:91], v[220:223]
    ds_read_b64_tr_b16 v[40:41], v26 offset:0
    ds_read_b64_tr_b16 v[42:43], v26 offset:512
    v_mfma_f32_16x16x32_bf16 v[220:223], v[44:47], v[92:95], v[220:223]
    s_waitcnt lgkmcnt(2)
    ds_read_b64_tr_b16 v[44:45], v26 offset:4096
    ds_read_b64_tr_b16 v[46:47], v26 offset:4608
    v_mfma_f32_16x16x32_bf16 v[224:227], v[48:51], v[64:67], v[224:227]
    v_add_u32 v26, 0x10000, v26
    v_mfma_f32_16x16x32_bf16 v[224:227], v[52:55], v[68:71], v[224:227]
    s_xor_b32 s64, s64, 128
    v_mfma_f32_16x16x32_bf16 v[228:231], v[48:51], v[72:75], v[228:231]
    v_mfma_f32_16x16x32_bf16 v[228:231], v[52:55], v[76:79], v[228:231]
    v_mfma_f32_16x16x32_bf16 v[232:235], v[48:51], v[80:83], v[232:235]
    v_mfma_f32_16x16x32_bf16 v[232:235], v[52:55], v[84:87], v[232:235]
    s_add_u32 m0, s69, 0
    v_mfma_f32_16x16x32_bf16 v[236:239], v[48:51], v[88:91], v[236:239]
    buffer_load_dwordx4 v2, s[24:27], s60 offen lds
    v_mfma_f32_16x16x32_bf16 v[236:239], v[52:55], v[92:95], v[236:239]
    s_add_u32 s72, s70, 41984
    ds_read_b64_tr_b16 v[48:49], v27 offset:0
    ds_read_b64_tr_b16 v[50:51], v27 offset:512
    v_mfma_f32_16x16x32_bf16 v[240:243], v[56:59], v[64:67], v[240:243]
    ds_read_b64_tr_b16 v[52:53], v27 offset:4096
    ds_read_b64_tr_b16 v[54:55], v27 offset:4608
    v_mfma_f32_16x16x32_bf16 v[240:243], v[60:63], v[68:71], v[240:243]
    buffer_store_dwordx4 a[52:55], v1, s[36:39], s72 offen sc1
    v_mfma_f32_16x16x32_bf16 v[244:247], v[56:59], v[72:75], v[244:247]
    buffer_load_dwordx4 v3, s[24:27], s60 offen offset:1024 lds
    v_mfma_f32_16x16x32_bf16 v[244:247], v[60:63], v[76:79], v[244:247]
    v_add_u32 v27, 0x10000, v27
    v_accvgpr_write_b32 a52, 0
    v_mfma_f32_16x16x32_bf16 v[248:251], v[56:59], v[80:83], v[248:251]
    v_accvgpr_write_b32 a53, 0
    v_accvgpr_write_b32 a54, 0
    v_mfma_f32_16x16x32_bf16 v[248:251], v[60:63], v[84:87], v[248:251]
    v_accvgpr_write_b32 a55, 0
    v_mfma_f32_16x16x32_bf16 v[252:255], v[56:59], v[88:91], v[252:255]
    buffer_load_dwordx4 v4, s[24:27], s60 offen offset:2048 lds
    v_mfma_f32_16x16x32_bf16 v[252:255], v[60:63], v[92:95], v[252:255]
    s_waitcnt lgkmcnt(0)
    ds_read_b64_tr_b16 v[56:57], v28 offset:0
    ds_read_b64_tr_b16 v[58:59], v28 offset:512
    v_mfma_f32_16x16x32_bf16 a[64:67], v[40:43], v[64:67], a[64:67]
    ds_read_b64_tr_b16 v[60:61], v28 offset:4096
    ds_read_b64_tr_b16 v[62:63], v28 offset:4608
    v_mfma_f32_16x16x32_bf16 a[64:67], v[44:47], v[68:71], a[64:67]
    v_add_u32 v24, 0x10000, v24
    v_add_u32 v28, 0x10000, v28
    v_mfma_f32_16x16x32_bf16 a[68:71], v[40:43], v[72:75], a[68:71]
    buffer_load_dwordx4 v5, s[24:27], s60 offen offset:3072 lds
    v_mfma_f32_16x16x32_bf16 a[68:71], v[44:47], v[76:79], a[68:71]
    ds_read_b128 v[112:115], v24 offset:16384
    v_mfma_f32_16x16x32_bf16 a[72:75], v[40:43], v[80:83], a[72:75]
    v_mfma_f32_16x16x32_bf16 a[72:75], v[44:47], v[84:87], a[72:75]
    s_add_u32 m0, s69, 16384
    v_add_u32 v25, 0x10000, v25
    v_mfma_f32_16x16x32_bf16 a[76:79], v[40:43], v[88:91], a[76:79]
    s_xor_b32 s60, s60, 524288
    buffer_load_dwordx4 v10, s[20:23], s63 offen lds
    v_mfma_f32_16x16x32_bf16 a[76:79], v[44:47], v[92:95], a[76:79]
    ds_read_b128 v[116:119], v25 offset:16384
    v_mfma_f32_16x16x32_bf16 a[128:131], v[40:43], a[136:139], a[128:131]
    ds_read_b64_tr_b16 v[40:41], v29 offset:0
    ds_read_b64_tr_b16 v[42:43], v29 offset:512
    v_mfma_f32_16x16x32_bf16 a[128:131], v[44:47], a[140:143], a[128:131]
    ds_read_b64_tr_b16 v[44:45], v29 offset:4096
    ds_read_b64_tr_b16 v[46:47], v29 offset:4608
    v_mfma_f32_16x16x32_bf16 a[80:83], v[48:51], v[64:67], a[80:83]
    buffer_load_dwordx4 v11, s[20:23], s63 offen offset:1024 lds
    v_mfma_f32_16x16x32_bf16 a[80:83], v[52:55], v[68:71], a[80:83]
    ds_read_b128 v[120:123], v24 offset:24576
    v_add_u32 v29, 0x10000, v29
    v_mfma_f32_16x16x32_bf16 a[84:87], v[48:51], v[72:75], a[84:87]
    v_mfma_f32_16x16x32_bf16 a[84:87], v[52:55], v[76:79], a[84:87]
    v_mfma_f32_16x16x32_bf16 a[88:91], v[48:51], v[80:83], a[88:91]
    buffer_load_dwordx4 v12, s[20:23], s63 offen offset:2048 lds
    v_mfma_f32_16x16x32_bf16 a[88:91], v[52:55], v[84:87], a[88:91]
    ds_read_b128 v[124:127], v25 offset:24576
    v_mfma_f32_16x16x32_bf16 a[92:95], v[48:51], v[88:91], a[92:95]
    s_add_u32 s72, s70, 46080
    v_mfma_f32_16x16x32_bf16 a[92:95], v[52:55], v[92:95], a[92:95]
    v_mfma_f32_16x16x32_bf16 a[132:135], v[48:51], a[136:139], a[132:135]
    buffer_load_dwordx4 v13, s[20:23], s63 offen offset:3072 lds
    v_mfma_f32_16x16x32_bf16 a[132:135], v[52:55], a[140:143], a[132:135]
    s_waitcnt lgkmcnt(1)
    v_mfma_f32_16x16x32_bf16 a[96:99], v[56:59], v[64:67], a[96:99]
    v_mfma_f32_16x16x32_bf16 a[96:99], v[60:63], v[68:71], a[96:99]
    s_xor_b32 s63, s63, 384
    v_mfma_f32_16x16x32_bf16 a[100:103], v[56:59], v[72:75], a[100:103]
    buffer_store_dwordx4 a[60:63], v1, s[36:39], s72 offen sc1
    v_mfma_f32_16x16x32_bf16 a[100:103], v[60:63], v[76:79], a[100:103]
    v_mfma_f32_16x16x32_bf16 a[104:107], v[56:59], v[80:83], a[104:107]
    v_accvgpr_write_b32 a60, 0
    v_accvgpr_write_b32 a61, 0
    v_mfma_f32_16x16x32_bf16 a[104:107], v[60:63], v[84:87], a[104:107]
    s_waitcnt vmcnt(10) lgkmcnt(0)
    s_barrier
    ds_read_b64_tr_b16 v[48:49], v14 offset:32768
    v_mfma_f32_16x16x32_bf16 a[108:111], v[56:59], v[88:91], a[108:111]
    s_add_u32 m0, s67, 32768
    ds_read_b64_tr_b16 v[50:51], v14 offset:33792
    ds_read_b64_tr_b16 v[52:53], v14 offset:40960
    v_mfma_f32_16x16x32_bf16 a[108:111], v[60:63], v[92:95], a[108:111]
    buffer_load_dwordx4 v1, s[28:31], s65 offen sc1 lds
    v_mfma_f32_16x16x32_bf16 a[112:115], v[40:43], v[64:67], a[112:115]
    ds_read_b64_tr_b16 v[54:55], v14 offset:41984
    ds_read_b64_tr_b16 v[56:57], v15 offset:32768
    v_mfma_f32_16x16x32_bf16 a[112:115], v[44:47], v[68:71], a[112:115]
    ds_read_b64_tr_b16 v[58:59], v15 offset:33792
    ds_read_b64_tr_b16 v[60:61], v15 offset:40960
    v_mfma_f32_16x16x32_bf16 a[116:119], v[40:43], v[72:75], a[116:119]
    ds_read_b64_tr_b16 v[62:63], v15 offset:41984
    ds_read_b128 a[136:139], v22 offset:0
    v_mfma_f32_16x16x32_bf16 a[116:119], v[44:47], v[76:79], a[116:119]
    ds_read_b128 a[140:143], v23 offset:0
    v_add_u32 v14, 0xffff0000, v14
    v_mfma_f32_16x16x32_bf16 a[120:123], v[40:43], v[80:83], a[120:123]
    v_add_u32 v15, 0xffff0000, v15
    v_add_u32 v22, 0xfffe0000, v22
    v_mfma_f32_16x16x32_bf16 a[120:123], v[44:47], v[84:87], a[120:123]
    v_add_u32 v23, 0xfffe0000, v23
    v_accvgpr_read_b32 v32, a144
    v_mfma_f32_16x16x32_bf16 a[124:127], v[40:43], v[88:91], a[124:127]
    buffer_load_dwordx4 v1, s[28:31], s65 offen offset:1024 sc1 lds
    v_mfma_f32_16x16x32_bf16 a[124:127], v[44:47], v[92:95], a[124:127]
    s_waitcnt lgkmcnt(1)
    ds_read_b64_tr_b16 v[40:41], v16 offset:32768
    ds_read_b64_tr_b16 v[42:43], v16 offset:33792
    v_mfma_f32_16x16x32_bf16 v[128:131], v[48:51], v[96:99], v[128:131]
    ds_read_b64_tr_b16 v[44:45], v16 offset:40960
    ds_read_b64_tr_b16 v[46:47], v16 offset:41984
    v_mfma_f32_16x16x32_bf16 v[128:131], v[52:55], v[100:103], v[128:131]
    v_add_u32 v16, 0xffff0000, v16
    v_accvgpr_read_b32 v31, a145
    v_mfma_f32_16x16x32_bf16 v[132:135], v[48:51], v[104:107], v[132:135]
    ds_read_b128 v[64:67], v24 offset:49152
    v_cvt_pk_bf16_f32 v32, v32, v31
    v_mfma_f32_16x16x32_bf16 v[132:135], v[52:55], v[108:111], v[132:135]
    v_accvgpr_read_b32 v33, a146
    v_accvgpr_read_b32 v31, a147
    v_mfma_f32_16x16x32_bf16 v[136:139], v[48:51], v[112:115], v[136:139]
    v_cvt_pk_bf16_f32 v33, v33, v31
    v_accvgpr_read_b32 v34, a148
    v_mfma_f32_16x16x32_bf16 v[136:139], v[52:55], v[116:119], v[136:139]
    s_add_u32 s72, s71, 32768
    v_accvgpr_read_b32 v31, a149
    v_cvt_pk_bf16_f32 v34, v34, v31
    v_mfma_f32_16x16x32_bf16 v[140:143], v[48:51], v[120:123], v[140:143]
    s_add_u32 m0, s68, 40960
    ds_read_b64_tr_b16 v[48:49], v17 offset:32768
    ds_read_b64_tr_b16 v[50:51], v17 offset:33792
    v_mfma_f32_16x16x32_bf16 v[140:143], v[52:55], v[124:127], v[140:143]
    buffer_load_dwordx4 v6, s[20:23], s66 offen lds
    v_mfma_f32_16x16x32_bf16 v[144:147], v[56:59], v[96:99], v[144:147]
    ds_read_b64_tr_b16 v[52:53], v17 offset:40960
    ds_read_b64_tr_b16 v[54:55], v17 offset:41984
    v_mfma_f32_16x16x32_bf16 v[144:147], v[60:63], v[100:103], v[144:147]
    v_add_u32 v17, 0xffff0000, v17
    v_accvgpr_read_b32 v35, a150
    v_mfma_f32_16x16x32_bf16 v[148:151], v[56:59], v[104:107], v[148:151]
    v_accvgpr_read_b32 v31, a151
    v_cvt_pk_bf16_f32 v35, v35, v31
    v_mfma_f32_16x16x32_bf16 v[148:151], v[60:63], v[108:111], v[148:151]
    buffer_store_dwordx4 v[32:35], v1, s[36:39], s72 offen sc1
    v_mfma_f32_16x16x32_bf16 v[152:155], v[56:59], v[112:115], v[152:155]
    v_accvgpr_write_b32 a62, 0
    v_accvgpr_write_b32 a63, 0
    v_mfma_f32_16x16x32_bf16 v[152:155], v[60:63], v[116:119], v[152:155]
    ds_read_b128 v[68:71], v25 offset:49152
    v_accvgpr_write_b32 a144, 0
    v_mfma_f32_16x16x32_bf16 v[156:159], v[56:59], v[120:123], v[156:159]
    s_add_u32 m0, s69, 49152
    ds_read_b64_tr_b16 v[56:57], v18 offset:32768
    ds_read_b64_tr_b16 v[58:59], v18 offset:33792
    v_mfma_f32_16x16x32_bf16 v[156:159], v[60:63], v[124:127], v[156:159]
    s_xor_b32 s65, s65, 8192
    buffer_load_dwordx4 v10, s[20:23], s64 offen lds
    s_waitcnt lgkmcnt(3)
    v_mfma_f32_16x16x32_bf16 v[160:163], v[40:43], v[96:99], v[160:163]
    s_xor_b32 s66, s66, 128
    ds_read_b64_tr_b16 v[60:61], v18 offset:40960
    ds_read_b64_tr_b16 v[62:63], v18 offset:41984
    v_mfma_f32_16x16x32_bf16 v[160:163], v[44:47], v[100:103], v[160:163]
    v_add_u32 v18, 0xffff0000, v18
    v_accvgpr_write_b32 a145, 0
    v_mfma_f32_16x16x32_bf16 v[164:167], v[40:43], v[104:107], v[164:167]
    v_accvgpr_write_b32 a146, 0
    v_accvgpr_write_b32 a147, 0
    v_mfma_f32_16x16x32_bf16 v[164:167], v[44:47], v[108:111], v[164:167]
    v_accvgpr_read_b32 v32, a152
    v_accvgpr_read_b32 v31, a153
    v_mfma_f32_16x16x32_bf16 v[168:171], v[40:43], v[112:115], v[168:171]
    v_cvt_pk_bf16_f32 v32, v32, v31
    v_accvgpr_read_b32 v33, a154
    v_mfma_f32_16x16x32_bf16 v[168:171], v[44:47], v[116:119], v[168:171]
    v_accvgpr_read_b32 v31, a155
    v_cvt_pk_bf16_f32 v33, v33, v31
    v_mfma_f32_16x16x32_bf16 v[172:175], v[40:43], v[120:123], v[172:175]
    ds_read_b64_tr_b16 v[40:41], v19 offset:32768
    ds_read_b64_tr_b16 v[42:43], v19 offset:33792
    v_mfma_f32_16x16x32_bf16 v[172:175], v[44:47], v[124:127], v[172:175]
    ds_read_b64_tr_b16 v[44:45], v19 offset:40960
    ds_read_b64_tr_b16 v[46:47], v19 offset:41984
    v_mfma_f32_16x16x32_bf16 v[176:179], v[48:51], v[96:99], v[176:179]
    buffer_load_dwordx4 v11, s[20:23], s64 offen offset:1024 lds
    v_mfma_f32_16x16x32_bf16 v[176:179], v[52:55], v[100:103], v[176:179]
    ds_read_b128 v[72:75], v24 offset:57344
    v_add_u32 v19, 0xffff0000, v19
    v_mfma_f32_16x16x32_bf16 v[180:183], v[48:51], v[104:107], v[180:183]
    v_accvgpr_read_b32 v34, a156
    v_accvgpr_read_b32 v31, a157
    v_mfma_f32_16x16x32_bf16 v[180:183], v[52:55], v[108:111], v[180:183]
    v_cvt_pk_bf16_f32 v34, v34, v31
    v_accvgpr_read_b32 v35, a158
    v_mfma_f32_16x16x32_bf16 v[184:187], v[48:51], v[112:115], v[184:187]
    v_accvgpr_read_b32 v31, a159
    v_cvt_pk_bf16_f32 v35, v35, v31
    v_mfma_f32_16x16x32_bf16 v[184:187], v[52:55], v[116:119], v[184:187]
    v_accvgpr_write_b32 a148, 0
    v_accvgpr_write_b32 a149, 0
    v_mfma_f32_16x16x32_bf16 v[188:191], v[48:51], v[120:123], v[188:191]
    s_add_u32 s72, s71, 33792
    ds_read_b64_tr_b16 v[48:49], v20 offset:32768
    ds_read_b64_tr_b16 v[50:51], v20 offset:33792
    v_mfma_f32_16x16x32_bf16 v[188:191], v[52:55], v[124:127], v[188:191]
    s_waitcnt lgkmcnt(2)
    ds_read_b64_tr_b16 v[52:53], v20 offset:40960
    ds_read_b64_tr_b16 v[54:55], v20 offset:41984
    v_mfma_f32_16x16x32_bf16 v[192:195], v[56:59], v[96:99], v[192:195]
    buffer_load_dwordx4 v12, s[20:23], s64 offen offset:2048 lds
    v_mfma_f32_16x16x32_bf16 v[192:195], v[60:63], v[100:103], v[192:195]
    v_add_u32 v20, 0xffff0000, v20
    v_accvgpr_write_b32 a150, 0
    v_mfma_f32_16x16x32_bf16 v[196:199], v[56:59], v[104:107], v[196:199]
    buffer_store_dwordx4 v[32:35], v1, s[36:39], s72 offen sc1
    v_mfma_f32_16x16x32_bf16 v[196:199], v[60:63], v[108:111], v[196:199]
    ds_read_b128 v[76:79], v25 offset:57344
    v_accvgpr_write_b32 a151, 0
    v_mfma_f32_16x16x32_bf16 v[200:203], v[56:59], v[112:115], v[200:203]
    v_accvgpr_write_b32 a152, 0
    v_accvgpr_write_b32 a153, 0
    v_mfma_f32_16x16x32_bf16 v[200:203], v[60:63], v[116:119], v[200:203]
    v_accvgpr_write_b32 a154, 0
    v_accvgpr_write_b32 a155, 0
    v_mfma_f32_16x16x32_bf16 v[204:207], v[56:59], v[120:123], v[204:207]
    ds_read_b64_tr_b16 v[56:57], v21 offset:32768
    ds_read_b64_tr_b16 v[58:59], v21 offset:33792
    v_mfma_f32_16x16x32_bf16 v[204:207], v[60:63], v[124:127], v[204:207]
    ds_read_b64_tr_b16 v[60:61], v21 offset:40960
    ds_read_b64_tr_b16 v[62:63], v21 offset:41984
    v_mfma_f32_16x16x32_bf16 v[208:211], v[40:43], v[96:99], v[208:211]
    v_add_u32 v21, 0xffff0000, v21
    v_accvgpr_write_b32 a156, 0
    v_mfma_f32_16x16x32_bf16 v[208:211], v[44:47], v[100:103], v[208:211]
    buffer_load_dwordx4 v13, s[20:23], s64 offen offset:3072 lds
    v_mfma_f32_16x16x32_bf16 v[212:215], v[40:43], v[104:107], v[212:215]
    v_accvgpr_write_b32 a157, 0
    v_accvgpr_write_b32 a158, 0
    v_mfma_f32_16x16x32_bf16 v[212:215], v[44:47], v[108:111], v[212:215]
    v_accvgpr_write_b32 a159, 0
    v_mfma_f32_16x16x32_bf16 v[216:219], v[40:43], v[112:115], v[216:219]
    v_accvgpr_read_b32 v32, a160
    v_accvgpr_read_b32 v31, a161
    v_mfma_f32_16x16x32_bf16 v[216:219], v[44:47], v[116:119], v[216:219]
    v_cvt_pk_bf16_f32 v32, v32, v31
    v_accvgpr_read_b32 v33, a162
    v_mfma_f32_16x16x32_bf16 v[220:223], v[40:43], v[120:123], v[220:223]
    ds_read_b64_tr_b16 v[40:41], v26 offset:0
    ds_read_b64_tr_b16 v[42:43], v26 offset:512
    v_mfma_f32_16x16x32_bf16 v[220:223], v[44:47], v[124:127], v[220:223]
    s_waitcnt lgkmcnt(2)
    ds_read_b64_tr_b16 v[44:45], v26 offset:4096
    ds_read_b64_tr_b16 v[46:47], v26 offset:4608
    v_mfma_f32_16x16x32_bf16 v[224:227], v[48:51], v[96:99], v[224:227]
    v_add_u32 v26, 0xfffe0000, v26
    v_accvgpr_read_b32 v31, a163
    v_mfma_f32_16x16x32_bf16 v[224:227], v[52:55], v[100:103], v[224:227]
    s_xor_b32 s64, s64, 384
    v_cvt_pk_bf16_f32 v33, v33, v31
    v_accvgpr_read_b32 v34, a164
    v_mfma_f32_16x16x32_bf16 v[228:231], v[48:51], v[104:107], v[228:231]
    v_accvgpr_read_b32 v31, a165
    v_cvt_pk_bf16_f32 v34, v34, v31
    v_mfma_f32_16x16x32_bf16 v[228:231], v[52:55], v[108:111], v[228:231]
    v_accvgpr_read_b32 v35, a166
    v_accvgpr_read_b32 v31, a167
    v_mfma_f32_16x16x32_bf16 v[232:235], v[48:51], v[112:115], v[232:235]
    v_cvt_pk_bf16_f32 v35, v35, v31
    v_accvgpr_write_b32 a160, 0
    v_mfma_f32_16x16x32_bf16 v[232:235], v[52:55], v[116:119], v[232:235]
    s_add_u32 m0, s69, 65536
    v_accvgpr_write_b32 a161, 0
    v_accvgpr_write_b32 a162, 0
    v_mfma_f32_16x16x32_bf16 v[236:239], v[48:51], v[120:123], v[236:239]
    buffer_load_dwordx4 v2, s[24:27], s60 offen lds
    v_mfma_f32_16x16x32_bf16 v[236:239], v[52:55], v[124:127], v[236:239]
    s_add_u32 s72, s71, 2048
    ds_read_b64_tr_b16 v[48:49], v27 offset:0
    ds_read_b64_tr_b16 v[50:51], v27 offset:512
    v_mfma_f32_16x16x32_bf16 v[240:243], v[56:59], v[96:99], v[240:243]
    ds_read_b64_tr_b16 v[52:53], v27 offset:4096
    ds_read_b64_tr_b16 v[54:55], v27 offset:4608
    v_mfma_f32_16x16x32_bf16 v[240:243], v[60:63], v[100:103], v[240:243]
    v_add_u32 v27, 0xfffe0000, v27
    v_accvgpr_write_b32 a163, 0
    v_mfma_f32_16x16x32_bf16 v[244:247], v[56:59], v[104:107], v[244:247]
    buffer_load_dwordx4 v3, s[24:27], s60 offen offset:1024 lds
    v_mfma_f32_16x16x32_bf16 v[244:247], v[60:63], v[108:111], v[244:247]
    buffer_store_dwordx4 v[32:35], v1, s[36:39], s72 offen sc1
    v_mfma_f32_16x16x32_bf16 v[248:251], v[56:59], v[112:115], v[248:251]
    v_accvgpr_write_b32 a164, 0
    v_accvgpr_write_b32 a165, 0
    v_mfma_f32_16x16x32_bf16 v[248:251], v[60:63], v[116:119], v[248:251]
    v_accvgpr_write_b32 a166, 0
    v_accvgpr_write_b32 a167, 0
    v_mfma_f32_16x16x32_bf16 v[252:255], v[56:59], v[120:123], v[252:255]
    buffer_load_dwordx4 v4, s[24:27], s60 offen offset:2048 lds
    v_mfma_f32_16x16x32_bf16 v[252:255], v[60:63], v[124:127], v[252:255]
    s_waitcnt lgkmcnt(0)
    ds_read_b64_tr_b16 v[56:57], v28 offset:0
    ds_read_b64_tr_b16 v[58:59], v28 offset:512
    v_mfma_f32_16x16x32_bf16 a[64:67], v[40:43], v[96:99], a[64:67]
    ds_read_b64_tr_b16 v[60:61], v28 offset:4096
    ds_read_b64_tr_b16 v[62:63], v28 offset:4608
    v_mfma_f32_16x16x32_bf16 a[64:67], v[44:47], v[100:103], a[64:67]
    v_add_u32 v24, 0x10000, v24
    v_add_u32 v28, 0xfffe0000, v28
    v_mfma_f32_16x16x32_bf16 a[68:71], v[40:43], v[104:107], a[68:71]
    buffer_load_dwordx4 v5, s[24:27], s60 offen offset:3072 lds
    v_mfma_f32_16x16x32_bf16 a[68:71], v[44:47], v[108:111], a[68:71]
    ds_read_b128 v[80:83], v24 offset:16384
    v_mfma_f32_16x16x32_bf16 a[72:75], v[40:43], v[112:115], a[72:75]
    v_mfma_f32_16x16x32_bf16 a[72:75], v[44:47], v[116:119], a[72:75]
    s_add_u32 m0, s69, 81920
    v_add_u32 v25, 0x10000, v25
    v_accvgpr_read_b32 v32, a168
    v_mfma_f32_16x16x32_bf16 a[76:79], v[40:43], v[120:123], a[76:79]
    s_xor_b32 s60, s60, 1572864
    buffer_load_dwordx4 v10, s[20:23], s63 offen lds
    v_mfma_f32_16x16x32_bf16 a[76:79], v[44:47], v[124:127], a[76:79]
    ds_read_b128 v[84:87], v25 offset:16384
    v_accvgpr_read_b32 v31, a169
    v_mfma_f32_16x16x32_bf16 a[128:131], v[40:43], a[136:139], a[128:131]
    ds_read_b64_tr_b16 v[40:41], v29 offset:0
    ds_read_b64_tr_b16 v[42:43], v29 offset:512
    v_mfma_f32_16x16x32_bf16 a[128:131], v[44:47], a[140:143], a[128:131]
    ds_read_b64_tr_b16 v[44:45], v29 offset:4096
    ds_read_b64_tr_b16 v[46:47], v29 offset:4608
    v_mfma_f32_16x16x32_bf16 a[80:83], v[48:51], v[96:99], a[80:83]
    buffer_load_dwordx4 v11, s[20:23], s63 offen offset:1024 lds
    v_mfma_f32_16x16x32_bf16 a[80:83], v[52:55], v[100:103], a[80:83]
    ds_read_b128 v[88:91], v24 offset:24576
    v_add_u32 v29, 0xfffe0000, v29
    v_mfma_f32_16x16x32_bf16 a[84:87], v[48:51], v[104:107], a[84:87]
    v_cvt_pk_bf16_f32 v32, v32, v31
    v_accvgpr_read_b32 v33, a170
    v_mfma_f32_16x16x32_bf16 a[84:87], v[52:55], v[108:111], a[84:87]
    v_accvgpr_read_b32 v31, a171
    v_cvt_pk_bf16_f32 v33, v33, v31
    v_mfma_f32_16x16x32_bf16 a[88:91], v[48:51], v[112:115], a[88:91]
    buffer_load_dwordx4 v12, s[20:23], s63 offen offset:2048 lds
    v_mfma_f32_16x16x32_bf16 a[88:91], v[52:55], v[116:119], a[88:91]
    ds_read_b128 v[92:95], v25 offset:24576
    v_accvgpr_read_b32 v34, a172
    v_mfma_f32_16x16x32_bf16 a[92:95], v[48:51], v[120:123], a[92:95]
    s_add_u32 s72, s71, 3072
    v_accvgpr_read_b32 v31, a173
    v_cvt_pk_bf16_f32 v34, v34, v31
    v_mfma_f32_16x16x32_bf16 a[92:95], v[52:55], v[124:127], a[92:95]
    v_accvgpr_read_b32 v35, a174
    v_accvgpr_read_b32 v31, a175
    v_mfma_f32_16x16x32_bf16 a[132:135], v[48:51], a[136:139], a[132:135]
    buffer_load_dwordx4 v13, s[20:23], s63 offen offset:3072 lds
    v_mfma_f32_16x16x32_bf16 a[132:135], v[52:55], a[140:143], a[132:135]
    s_waitcnt lgkmcnt(1)
    v_cvt_pk_bf16_f32 v35, v35, v31
    v_accvgpr_write_b32 a168, 0
    v_mfma_f32_16x16x32_bf16 a[96:99], v[56:59], v[96:99], a[96:99]
    v_accvgpr_write_b32 a169, 0
    v_accvgpr_write_b32 a170, 0
    v_mfma_f32_16x16x32_bf16 a[96:99], v[60:63], v[100:103], a[96:99]
    s_xor_b32 s63, s63, 128
    v_accvgpr_write_b32 a171, 0
    v_accvgpr_write_b32 a172, 0
    v_mfma_f32_16x16x32_bf16 a[100:103], v[56:59], v[104:107], a[100:103]
    buffer_store_dwordx4 v[32:35], v1, s[36:39], s72 offen sc1
    v_mfma_f32_16x16x32_bf16 a[100:103], v[60:63], v[108:111], a[100:103]
    v_accvgpr_write_b32 a173, 0
    v_accvgpr_write_b32 a174, 0
    v_mfma_f32_16x16x32_bf16 a[104:107], v[56:59], v[112:115], a[104:107]
    v_accvgpr_write_b32 a175, 0
    v_mfma_f32_16x16x32_bf16 a[104:107], v[60:63], v[116:119], a[104:107]
    s_waitcnt vmcnt(10) lgkmcnt(0)
    s_barrier
    ds_read_b64_tr_b16 v[48:49], v14 offset:0
    v_mfma_f32_16x16x32_bf16 a[108:111], v[56:59], v[120:123], a[108:111]
    s_add_u32 m0, s67, 98304
    ds_read_b64_tr_b16 v[50:51], v14 offset:1024
    ds_read_b64_tr_b16 v[52:53], v14 offset:8192
    v_mfma_f32_16x16x32_bf16 a[108:111], v[60:63], v[124:127], a[108:111]
    buffer_load_dwordx4 v1, s[28:31], s65 offen sc1 lds
    v_mfma_f32_16x16x32_bf16 a[112:115], v[40:43], v[96:99], a[112:115]
    ds_read_b64_tr_b16 v[54:55], v14 offset:9216
    ds_read_b64_tr_b16 v[56:57], v15 offset:0
    v_mfma_f32_16x16x32_bf16 a[112:115], v[44:47], v[100:103], a[112:115]
    ds_read_b64_tr_b16 v[58:59], v15 offset:1024
    ds_read_b64_tr_b16 v[60:61], v15 offset:8192
    v_mfma_f32_16x16x32_bf16 a[116:119], v[40:43], v[104:107], a[116:119]
    ds_read_b64_tr_b16 v[62:63], v15 offset:9216
    ds_read_b128 a[136:139], v22 offset:32768
    v_mfma_f32_16x16x32_bf16 a[116:119], v[44:47], v[108:111], a[116:119]
    ds_read_b128 a[140:143], v23 offset:32768
    v_add_u32 v14, 0x10000, v14
    v_mfma_f32_16x16x32_bf16 a[120:123], v[40:43], v[112:115], a[120:123]
    v_add_u32 v15, 0x10000, v15
    v_add_u32 v22, 0x10000, v22
    v_mfma_f32_16x16x32_bf16 a[120:123], v[44:47], v[116:119], a[120:123]
    v_add_u32 v23, 0x10000, v23
    v_accvgpr_read_b32 v32, a176
    v_mfma_f32_16x16x32_bf16 a[124:127], v[40:43], v[120:123], a[124:127]
    buffer_load_dwordx4 v1, s[28:31], s65 offen offset:1024 sc1 lds
    v_mfma_f32_16x16x32_bf16 a[124:127], v[44:47], v[124:127], a[124:127]
    s_waitcnt lgkmcnt(1)
    ds_read_b64_tr_b16 v[40:41], v16 offset:0
    ds_read_b64_tr_b16 v[42:43], v16 offset:1024
    v_mfma_f32_16x16x32_bf16 v[128:131], v[48:51], v[64:67], v[128:131]
    ds_read_b64_tr_b16 v[44:45], v16 offset:8192
    ds_read_b64_tr_b16 v[46:47], v16 offset:9216
    v_mfma_f32_16x16x32_bf16 v[128:131], v[52:55], v[68:71], v[128:131]
    v_add_u32 v24, 0xfffe0000, v24
    v_add_u32 v16, 0x10000, v16
    v_mfma_f32_16x16x32_bf16 v[132:135], v[48:51], v[72:75], v[132:135]
    ds_read_b128 v[96:99], v24 offset:16384
    v_accvgpr_read_b32 v31, a177
    v_mfma_f32_16x16x32_bf16 v[132:135], v[52:55], v[76:79], v[132:135]
    v_cvt_pk_bf16_f32 v32, v32, v31
    v_accvgpr_read_b32 v33, a178
    v_mfma_f32_16x16x32_bf16 v[136:139], v[48:51], v[80:83], v[136:139]
    v_accvgpr_read_b32 v31, a179
    v_cvt_pk_bf16_f32 v33, v33, v31
    v_mfma_f32_16x16x32_bf16 v[136:139], v[52:55], v[84:87], v[136:139]
    s_add_u32 s72, s71, 34816
    v_accvgpr_read_b32 v34, a180
    v_accvgpr_read_b32 v31, a181
    v_mfma_f32_16x16x32_bf16 v[140:143], v[48:51], v[88:91], v[140:143]
    s_add_u32 m0, s68, 106496
    ds_read_b64_tr_b16 v[48:49], v17 offset:0
    ds_read_b64_tr_b16 v[50:51], v17 offset:1024
    v_mfma_f32_16x16x32_bf16 v[140:143], v[52:55], v[92:95], v[140:143]
    buffer_load_dwordx4 v6, s[20:23], s66 offen lds
    v_mfma_f32_16x16x32_bf16 v[144:147], v[56:59], v[64:67], v[144:147]
    ds_read_b64_tr_b16 v[52:53], v17 offset:8192
    ds_read_b64_tr_b16 v[54:55], v17 offset:9216
    v_mfma_f32_16x16x32_bf16 v[144:147], v[60:63], v[68:71], v[144:147]
    v_add_u32 v17, 0x10000, v17
    v_cvt_pk_bf16_f32 v34, v34, v31
    v_mfma_f32_16x16x32_bf16 v[148:151], v[56:59], v[72:75], v[148:151]
    v_accvgpr_read_b32 v35, a182
    v_accvgpr_read_b32 v31, a183
    v_mfma_f32_16x16x32_bf16 v[148:151], v[60:63], v[76:79], v[148:151]
    v_cvt_pk_bf16_f32 v35, v35, v31
    v_accvgpr_write_b32 a176, 0
    v_mfma_f32_16x16x32_bf16 v[152:155], v[56:59], v[80:83], v[152:155]
    v_add_u32 v25, 0xfffe0000, v25
    v_accvgpr_write_b32 a177, 0
    v_mfma_f32_16x16x32_bf16 v[152:155], v[60:63], v[84:87], v[152:155]
    ds_read_b128 v[100:103], v25 offset:16384
    v_accvgpr_write_b32 a178, 0
    v_mfma_f32_16x16x32_bf16 v[156:159], v[56:59], v[88:91], v[156:159]
    s_add_u32 m0, s69, 114688
    ds_read_b64_tr_b16 v[56:57], v18 offset:0
    ds_read_b64_tr_b16 v[58:59], v18 offset:1024
    v_mfma_f32_16x16x32_bf16 v[156:159], v[60:63], v[92:95], v[156:159]
    s_xor_b32 s65, s65, 24576
    buffer_load_dwordx4 v10, s[20:23], s64 offen lds
    s_waitcnt lgkmcnt(3)
    v_mfma_f32_16x16x32_bf16 v[160:163], v[40:43], v[64:67], v[160:163]
    s_xor_b32 s66, s66, 384
    ds_read_b64_tr_b16 v[60:61], v18 offset:8192
    ds_read_b64_tr_b16 v[62:63], v18 offset:9216
    v_mfma_f32_16x16x32_bf16 v[160:163], v[44:47], v[68:71], v[160:163]
    v_add_u32 v18, 0x10000, v18
    v_accvgpr_write_b32 a179, 0
    v_mfma_f32_16x16x32_bf16 v[164:167], v[40:43], v[72:75], v[164:167]
    buffer_store_dwordx4 v[32:35], v1, s[36:39], s72 offen sc1
    v_mfma_f32_16x16x32_bf16 v[164:167], v[44:47], v[76:79], v[164:167]
    v_accvgpr_read_b32 v31, a185
    v_accvgpr_read_b32 v32, a184
    v_mfma_f32_16x16x32_bf16 v[168:171], v[40:43], v[80:83], v[168:171]
    v_cvt_pk_bf16_f32 v32, v32, v31
    v_accvgpr_read_b32 v33, a186
    v_mfma_f32_16x16x32_bf16 v[168:171], v[44:47], v[84:87], v[168:171]
    v_accvgpr_read_b32 v31, a187
    v_cvt_pk_bf16_f32 v33, v33, v31
    v_mfma_f32_16x16x32_bf16 v[172:175], v[40:43], v[88:91], v[172:175]
    ds_read_b64_tr_b16 v[40:41], v19 offset:0
    ds_read_b64_tr_b16 v[42:43], v19 offset:1024
    v_mfma_f32_16x16x32_bf16 v[172:175], v[44:47], v[92:95], v[172:175]
    ds_read_b64_tr_b16 v[44:45], v19 offset:8192
    ds_read_b64_tr_b16 v[46:47], v19 offset:9216
    v_mfma_f32_16x16x32_bf16 v[176:179], v[48:51], v[64:67], v[176:179]
    buffer_load_dwordx4 v11, s[20:23], s64 offen offset:1024 lds
    v_mfma_f32_16x16x32_bf16 v[176:179], v[52:55], v[68:71], v[176:179]
    ds_read_b128 v[104:107], v24 offset:24576
    v_add_u32 v19, 0x10000, v19
    v_mfma_f32_16x16x32_bf16 v[180:183], v[48:51], v[72:75], v[180:183]
    v_accvgpr_read_b32 v34, a188
    v_accvgpr_read_b32 v31, a189
    v_mfma_f32_16x16x32_bf16 v[180:183], v[52:55], v[76:79], v[180:183]
    v_cvt_pk_bf16_f32 v34, v34, v31
    v_accvgpr_read_b32 v35, a190
    v_mfma_f32_16x16x32_bf16 v[184:187], v[48:51], v[80:83], v[184:187]
    v_accvgpr_read_b32 v31, a191
    v_cvt_pk_bf16_f32 v35, v35, v31
    v_mfma_f32_16x16x32_bf16 v[184:187], v[52:55], v[84:87], v[184:187]
    v_accvgpr_write_b32 a180, 0
    v_accvgpr_write_b32 a181, 0
    v_mfma_f32_16x16x32_bf16 v[188:191], v[48:51], v[88:91], v[188:191]
    s_add_u32 s72, s71, 35840
    ds_read_b64_tr_b16 v[48:49], v20 offset:0
    ds_read_b64_tr_b16 v[50:51], v20 offset:1024
    v_mfma_f32_16x16x32_bf16 v[188:191], v[52:55], v[92:95], v[188:191]
    s_waitcnt lgkmcnt(2)
    ds_read_b64_tr_b16 v[52:53], v20 offset:8192
    ds_read_b64_tr_b16 v[54:55], v20 offset:9216
    v_mfma_f32_16x16x32_bf16 v[192:195], v[56:59], v[64:67], v[192:195]
    buffer_load_dwordx4 v12, s[20:23], s64 offen offset:2048 lds
    v_mfma_f32_16x16x32_bf16 v[192:195], v[60:63], v[68:71], v[192:195]
    v_add_u32 v20, 0x10000, v20
    v_accvgpr_write_b32 a182, 0
    v_mfma_f32_16x16x32_bf16 v[196:199], v[56:59], v[72:75], v[196:199]
    buffer_store_dwordx4 v[32:35], v1, s[36:39], s72 offen sc1
    v_mfma_f32_16x16x32_bf16 v[196:199], v[60:63], v[76:79], v[196:199]
    ds_read_b128 v[108:111], v25 offset:24576
    v_accvgpr_write_b32 a183, 0
    v_mfma_f32_16x16x32_bf16 v[200:203], v[56:59], v[80:83], v[200:203]
    v_accvgpr_write_b32 a184, 0
    v_accvgpr_write_b32 a185, 0
    v_mfma_f32_16x16x32_bf16 v[200:203], v[60:63], v[84:87], v[200:203]
    v_accvgpr_write_b32 a186, 0
    v_accvgpr_write_b32 a187, 0
    v_mfma_f32_16x16x32_bf16 v[204:207], v[56:59], v[88:91], v[204:207]
    ds_read_b64_tr_b16 v[56:57], v21 offset:0
    ds_read_b64_tr_b16 v[58:59], v21 offset:1024
    v_mfma_f32_16x16x32_bf16 v[204:207], v[60:63], v[92:95], v[204:207]
    ds_read_b64_tr_b16 v[60:61], v21 offset:8192
    ds_read_b64_tr_b16 v[62:63], v21 offset:9216
    v_mfma_f32_16x16x32_bf16 v[208:211], v[40:43], v[64:67], v[208:211]
    v_add_u32 v21, 0x10000, v21
    v_accvgpr_write_b32 a188, 0
    v_mfma_f32_16x16x32_bf16 v[208:211], v[44:47], v[68:71], v[208:211]
    buffer_load_dwordx4 v13, s[20:23], s64 offen offset:3072 lds
    v_mfma_f32_16x16x32_bf16 v[212:215], v[40:43], v[72:75], v[212:215]
    v_accvgpr_write_b32 a189, 0
    v_accvgpr_write_b32 a190, 0
    v_mfma_f32_16x16x32_bf16 v[212:215], v[44:47], v[76:79], v[212:215]
    v_accvgpr_write_b32 a191, 0
    v_mfma_f32_16x16x32_bf16 v[216:219], v[40:43], v[80:83], v[216:219]
    v_accvgpr_read_b32 v32, a192
    v_accvgpr_read_b32 v31, a193
    v_mfma_f32_16x16x32_bf16 v[216:219], v[44:47], v[84:87], v[216:219]
    v_cvt_pk_bf16_f32 v32, v32, v31
    v_accvgpr_read_b32 v33, a194
    v_mfma_f32_16x16x32_bf16 v[220:223], v[40:43], v[88:91], v[220:223]
    ds_read_b64_tr_b16 v[40:41], v26 offset:32768
    ds_read_b64_tr_b16 v[42:43], v26 offset:33280
    v_mfma_f32_16x16x32_bf16 v[220:223], v[44:47], v[92:95], v[220:223]
    s_waitcnt lgkmcnt(2)
    ds_read_b64_tr_b16 v[44:45], v26 offset:36864
    ds_read_b64_tr_b16 v[46:47], v26 offset:37376
    v_mfma_f32_16x16x32_bf16 v[224:227], v[48:51], v[64:67], v[224:227]
    v_add_u32 v26, 0x10000, v26
    v_accvgpr_read_b32 v31, a195
    v_mfma_f32_16x16x32_bf16 v[224:227], v[52:55], v[68:71], v[224:227]
    s_xor_b32 s64, s64, 128
    v_cvt_pk_bf16_f32 v33, v33, v31
    v_accvgpr_read_b32 v34, a196
    v_mfma_f32_16x16x32_bf16 v[228:231], v[48:51], v[72:75], v[228:231]
    v_accvgpr_read_b32 v31, a197
    v_cvt_pk_bf16_f32 v34, v34, v31
    v_mfma_f32_16x16x32_bf16 v[228:231], v[52:55], v[76:79], v[228:231]
    v_accvgpr_read_b32 v35, a198
    v_accvgpr_read_b32 v31, a199
    v_mfma_f32_16x16x32_bf16 v[232:235], v[48:51], v[80:83], v[232:235]
    v_cvt_pk_bf16_f32 v35, v35, v31
    v_accvgpr_write_b32 a192, 0
    v_mfma_f32_16x16x32_bf16 v[232:235], v[52:55], v[84:87], v[232:235]
    s_add_u32 m0, s69, 131072
    v_accvgpr_write_b32 a193, 0
    v_accvgpr_write_b32 a194, 0
    v_mfma_f32_16x16x32_bf16 v[236:239], v[48:51], v[88:91], v[236:239]
    buffer_load_dwordx4 v2, s[24:27], s60 offen lds
    v_mfma_f32_16x16x32_bf16 v[236:239], v[52:55], v[92:95], v[236:239]
    s_add_u32 s72, s71, 4096
    ds_read_b64_tr_b16 v[48:49], v27 offset:32768
    ds_read_b64_tr_b16 v[50:51], v27 offset:33280
    v_mfma_f32_16x16x32_bf16 v[240:243], v[56:59], v[64:67], v[240:243]
    ds_read_b64_tr_b16 v[52:53], v27 offset:36864
    ds_read_b64_tr_b16 v[54:55], v27 offset:37376
    v_mfma_f32_16x16x32_bf16 v[240:243], v[60:63], v[68:71], v[240:243]
    v_add_u32 v27, 0x10000, v27
    v_accvgpr_write_b32 a195, 0
    v_mfma_f32_16x16x32_bf16 v[244:247], v[56:59], v[72:75], v[244:247]
    buffer_load_dwordx4 v3, s[24:27], s60 offen offset:1024 lds
    v_mfma_f32_16x16x32_bf16 v[244:247], v[60:63], v[76:79], v[244:247]
    buffer_store_dwordx4 v[32:35], v1, s[36:39], s72 offen sc1
    v_mfma_f32_16x16x32_bf16 v[248:251], v[56:59], v[80:83], v[248:251]
    v_accvgpr_write_b32 a196, 0
    v_accvgpr_write_b32 a197, 0
    v_mfma_f32_16x16x32_bf16 v[248:251], v[60:63], v[84:87], v[248:251]
    v_accvgpr_write_b32 a198, 0
    v_accvgpr_write_b32 a199, 0
    v_mfma_f32_16x16x32_bf16 v[252:255], v[56:59], v[88:91], v[252:255]
    buffer_load_dwordx4 v4, s[24:27], s60 offen offset:2048 lds
    v_mfma_f32_16x16x32_bf16 v[252:255], v[60:63], v[92:95], v[252:255]
    s_waitcnt lgkmcnt(0)
    ds_read_b64_tr_b16 v[56:57], v28 offset:32768
    ds_read_b64_tr_b16 v[58:59], v28 offset:33280
    v_mfma_f32_16x16x32_bf16 a[64:67], v[40:43], v[64:67], a[64:67]
    ds_read_b64_tr_b16 v[60:61], v28 offset:36864
    ds_read_b64_tr_b16 v[62:63], v28 offset:37376
    v_mfma_f32_16x16x32_bf16 a[64:67], v[44:47], v[68:71], a[64:67]
    v_add_u32 v28, 0x10000, v28
    v_mfma_f32_16x16x32_bf16 a[68:71], v[40:43], v[72:75], a[68:71]
    buffer_load_dwordx4 v5, s[24:27], s60 offen offset:3072 lds
    v_mfma_f32_16x16x32_bf16 a[68:71], v[44:47], v[76:79], a[68:71]
    ds_read_b128 v[112:115], v24 offset:49152
    v_mfma_f32_16x16x32_bf16 a[72:75], v[40:43], v[80:83], a[72:75]
    v_mfma_f32_16x16x32_bf16 a[72:75], v[44:47], v[84:87], a[72:75]
    s_add_u32 m0, s69, 147456
    v_accvgpr_read_b32 v32, a200
    v_accvgpr_read_b32 v31, a201
    v_mfma_f32_16x16x32_bf16 a[76:79], v[40:43], v[88:91], a[76:79]
    s_xor_b32 s60, s60, 524288
    buffer_load_dwordx4 v10, s[20:23], s63 offen lds
    v_mfma_f32_16x16x32_bf16 a[76:79], v[44:47], v[92:95], a[76:79]
    ds_read_b128 v[116:119], v25 offset:49152
    v_cvt_pk_bf16_f32 v32, v32, v31
    v_mfma_f32_16x16x32_bf16 a[128:131], v[40:43], a[136:139], a[128:131]
    ds_read_b64_tr_b16 v[40:41], v29 offset:32768
    ds_read_b64_tr_b16 v[42:43], v29 offset:33280
    v_mfma_f32_16x16x32_bf16 a[128:131], v[44:47], a[140:143], a[128:131]
    ds_read_b64_tr_b16 v[44:45], v29 offset:36864
    ds_read_b64_tr_b16 v[46:47], v29 offset:37376
    v_mfma_f32_16x16x32_bf16 a[80:83], v[48:51], v[64:67], a[80:83]
    buffer_load_dwordx4 v11, s[20:23], s63 offen offset:1024 lds
    v_mfma_f32_16x16x32_bf16 a[80:83], v[52:55], v[68:71], a[80:83]
    ds_read_b128 v[120:123], v24 offset:57344
    v_add_u32 v29, 0x10000, v29
    v_mfma_f32_16x16x32_bf16 a[84:87], v[48:51], v[72:75], a[84:87]
    v_accvgpr_read_b32 v33, a202
    v_accvgpr_read_b32 v31, a203
    v_mfma_f32_16x16x32_bf16 a[84:87], v[52:55], v[76:79], a[84:87]
    v_cvt_pk_bf16_f32 v33, v33, v31
    v_accvgpr_read_b32 v34, a204
    v_mfma_f32_16x16x32_bf16 a[88:91], v[48:51], v[80:83], a[88:91]
    buffer_load_dwordx4 v12, s[20:23], s63 offen offset:2048 lds
    v_mfma_f32_16x16x32_bf16 a[88:91], v[52:55], v[84:87], a[88:91]
    ds_read_b128 v[124:127], v25 offset:57344
    v_accvgpr_read_b32 v31, a205
    v_mfma_f32_16x16x32_bf16 a[92:95], v[48:51], v[88:91], a[92:95]
    s_add_u32 s72, s71, 5120
    v_cvt_pk_bf16_f32 v34, v34, v31
    v_accvgpr_read_b32 v35, a206
    v_mfma_f32_16x16x32_bf16 a[92:95], v[52:55], v[92:95], a[92:95]
    v_accvgpr_read_b32 v31, a207
    v_cvt_pk_bf16_f32 v35, v35, v31
    v_mfma_f32_16x16x32_bf16 a[132:135], v[48:51], a[136:139], a[132:135]
    buffer_load_dwordx4 v13, s[20:23], s63 offen offset:3072 lds
    v_mfma_f32_16x16x32_bf16 a[132:135], v[52:55], a[140:143], a[132:135]
    s_waitcnt lgkmcnt(1)
    v_accvgpr_write_b32 a200, 0
    v_accvgpr_write_b32 a201, 0
    v_mfma_f32_16x16x32_bf16 a[96:99], v[56:59], v[64:67], a[96:99]
    v_accvgpr_write_b32 a202, 0
    v_accvgpr_write_b32 a203, 0
    v_mfma_f32_16x16x32_bf16 a[96:99], v[60:63], v[68:71], a[96:99]
    s_xor_b32 s63, s63, 1920
    v_accvgpr_write_b32 a204, 0
    v_accvgpr_write_b32 a205, 0
    v_mfma_f32_16x16x32_bf16 a[100:103], v[56:59], v[72:75], a[100:103]
    s_andn2_b32 s63, s63, 896
    buffer_store_dwordx4 v[32:35], v1, s[36:39], s72 offen sc1
    v_mfma_f32_16x16x32_bf16 a[100:103], v[60:63], v[76:79], a[100:103]
    v_accvgpr_write_b32 a206, 0
    v_accvgpr_write_b32 a207, 0
    v_mfma_f32_16x16x32_bf16 a[104:107], v[56:59], v[80:83], a[104:107]
    v_mfma_f32_16x16x32_bf16 a[104:107], v[60:63], v[84:87], a[104:107]
    s_waitcnt vmcnt(10) lgkmcnt(0)
    s_barrier
    ds_read_b64_tr_b16 v[48:49], v14 offset:0
    v_mfma_f32_16x16x32_bf16 a[108:111], v[56:59], v[88:91], a[108:111]
    s_add_u32 m0, s67, 0
    ds_read_b64_tr_b16 v[50:51], v14 offset:1024
    ds_read_b64_tr_b16 v[52:53], v14 offset:8192
    v_mfma_f32_16x16x32_bf16 a[108:111], v[60:63], v[92:95], a[108:111]
    buffer_load_dwordx4 v1, s[28:31], s65 offen sc1 lds
    v_mfma_f32_16x16x32_bf16 a[112:115], v[40:43], v[64:67], a[112:115]
    ds_read_b64_tr_b16 v[54:55], v14 offset:9216
    ds_read_b64_tr_b16 v[56:57], v15 offset:0
    v_mfma_f32_16x16x32_bf16 a[112:115], v[44:47], v[68:71], a[112:115]
    ds_read_b64_tr_b16 v[58:59], v15 offset:1024
    ds_read_b64_tr_b16 v[60:61], v15 offset:8192
    v_mfma_f32_16x16x32_bf16 a[116:119], v[40:43], v[72:75], a[116:119]
    ds_read_b64_tr_b16 v[62:63], v15 offset:9216
    ds_read_b128 a[136:139], v22 offset:32768
    v_mfma_f32_16x16x32_bf16 a[116:119], v[44:47], v[76:79], a[116:119]
    ds_read_b128 a[140:143], v23 offset:32768
    v_add_u32 v14, 0x10000, v14
    v_mfma_f32_16x16x32_bf16 a[120:123], v[40:43], v[80:83], a[120:123]
    v_add_u32 v15, 0x10000, v15
    v_add_u32 v22, 0xffff0000, v22
    v_mfma_f32_16x16x32_bf16 a[120:123], v[44:47], v[84:87], a[120:123]
    v_add_u32 v23, 0xffff0000, v23
    v_accvgpr_read_b32 v32, a208
    v_mfma_f32_16x16x32_bf16 a[124:127], v[40:43], v[88:91], a[124:127]
    buffer_load_dwordx4 v1, s[28:31], s65 offen offset:1024 sc1 lds
    v_mfma_f32_16x16x32_bf16 a[124:127], v[44:47], v[92:95], a[124:127]
    s_waitcnt lgkmcnt(1)
    ds_read_b64_tr_b16 v[40:41], v16 offset:0
    ds_read_b64_tr_b16 v[42:43], v16 offset:1024
    v_mfma_f32_16x16x32_bf16 v[128:131], v[48:51], v[96:99], v[128:131]
    ds_read_b64_tr_b16 v[44:45], v16 offset:8192
    ds_read_b64_tr_b16 v[46:47], v16 offset:9216
    v_mfma_f32_16x16x32_bf16 v[128:131], v[52:55], v[100:103], v[128:131]
    v_add_u32 v24, 0x10000, v24
    v_add_u32 v16, 0x10000, v16
    v_mfma_f32_16x16x32_bf16 v[132:135], v[48:51], v[104:107], v[132:135]
    ds_read_b128 v[64:67], v24 offset:16384
    v_accvgpr_read_b32 v31, a209
    v_mfma_f32_16x16x32_bf16 v[132:135], v[52:55], v[108:111], v[132:135]
    v_cvt_pk_bf16_f32 v32, v32, v31
    v_accvgpr_read_b32 v33, a210
    v_mfma_f32_16x16x32_bf16 v[136:139], v[48:51], v[112:115], v[136:139]
    v_accvgpr_read_b32 v31, a211
    v_cvt_pk_bf16_f32 v33, v33, v31
    v_mfma_f32_16x16x32_bf16 v[136:139], v[52:55], v[116:119], v[136:139]
    s_add_u32 s72, s71, 36864
    v_accvgpr_read_b32 v34, a212
    v_accvgpr_read_b32 v31, a213
    v_mfma_f32_16x16x32_bf16 v[140:143], v[48:51], v[120:123], v[140:143]
    s_add_u32 m0, s68, 8192
    ds_read_b64_tr_b16 v[48:49], v17 offset:0
    ds_read_b64_tr_b16 v[50:51], v17 offset:1024
    v_mfma_f32_16x16x32_bf16 v[140:143], v[52:55], v[124:127], v[140:143]
    buffer_load_dwordx4 v6, s[20:23], s66 offen lds
    v_mfma_f32_16x16x32_bf16 v[144:147], v[56:59], v[96:99], v[144:147]
    ds_read_b64_tr_b16 v[52:53], v17 offset:8192
    ds_read_b64_tr_b16 v[54:55], v17 offset:9216
    v_mfma_f32_16x16x32_bf16 v[144:147], v[60:63], v[100:103], v[144:147]
    v_add_u32 v17, 0x10000, v17
    v_cvt_pk_bf16_f32 v34, v34, v31
    v_mfma_f32_16x16x32_bf16 v[148:151], v[56:59], v[104:107], v[148:151]
    v_accvgpr_read_b32 v35, a214
    v_accvgpr_read_b32 v31, a215
    v_mfma_f32_16x16x32_bf16 v[148:151], v[60:63], v[108:111], v[148:151]
    v_cvt_pk_bf16_f32 v35, v35, v31
    v_accvgpr_write_b32 a208, 0
    v_mfma_f32_16x16x32_bf16 v[152:155], v[56:59], v[112:115], v[152:155]
    v_add_u32 v25, 0x10000, v25
    v_accvgpr_write_b32 a209, 0
    v_mfma_f32_16x16x32_bf16 v[152:155], v[60:63], v[116:119], v[152:155]
    ds_read_b128 v[68:71], v25 offset:16384
    v_accvgpr_write_b32 a210, 0
    v_mfma_f32_16x16x32_bf16 v[156:159], v[56:59], v[120:123], v[156:159]
    s_add_u32 m0, s69, 16384
    ds_read_b64_tr_b16 v[56:57], v18 offset:0
    ds_read_b64_tr_b16 v[58:59], v18 offset:1024
    v_mfma_f32_16x16x32_bf16 v[156:159], v[60:63], v[124:127], v[156:159]
    s_xor_b32 s65, s65, 8192
    buffer_load_dwordx4 v10, s[20:23], s64 offen lds
    s_waitcnt lgkmcnt(3)
    v_mfma_f32_16x16x32_bf16 v[160:163], v[40:43], v[96:99], v[160:163]
    s_xor_b32 s66, s66, 128
    ds_read_b64_tr_b16 v[60:61], v18 offset:8192
    ds_read_b64_tr_b16 v[62:63], v18 offset:9216
    v_mfma_f32_16x16x32_bf16 v[160:163], v[44:47], v[100:103], v[160:163]
    v_add_u32 v18, 0x10000, v18
    v_accvgpr_write_b32 a211, 0
    v_mfma_f32_16x16x32_bf16 v[164:167], v[40:43], v[104:107], v[164:167]
    buffer_store_dwordx4 v[32:35], v1, s[36:39], s72 offen sc1
    v_mfma_f32_16x16x32_bf16 v[164:167], v[44:47], v[108:111], v[164:167]
    v_accvgpr_read_b32 v31, a217
    v_accvgpr_read_b32 v32, a216
    v_mfma_f32_16x16x32_bf16 v[168:171], v[40:43], v[112:115], v[168:171]
    v_cvt_pk_bf16_f32 v32, v32, v31
    v_accvgpr_read_b32 v33, a218
    v_mfma_f32_16x16x32_bf16 v[168:171], v[44:47], v[116:119], v[168:171]
    v_accvgpr_read_b32 v31, a219
    v_cvt_pk_bf16_f32 v33, v33, v31
    v_mfma_f32_16x16x32_bf16 v[172:175], v[40:43], v[120:123], v[172:175]
    ds_read_b64_tr_b16 v[40:41], v19 offset:0
    ds_read_b64_tr_b16 v[42:43], v19 offset:1024
    v_mfma_f32_16x16x32_bf16 v[172:175], v[44:47], v[124:127], v[172:175]
    ds_read_b64_tr_b16 v[44:45], v19 offset:8192
    ds_read_b64_tr_b16 v[46:47], v19 offset:9216
    v_mfma_f32_16x16x32_bf16 v[176:179], v[48:51], v[96:99], v[176:179]
    buffer_load_dwordx4 v11, s[20:23], s64 offen offset:1024 lds
    v_mfma_f32_16x16x32_bf16 v[176:179], v[52:55], v[100:103], v[176:179]
    ds_read_b128 v[72:75], v24 offset:24576
    v_add_u32 v19, 0x10000, v19
    v_mfma_f32_16x16x32_bf16 v[180:183], v[48:51], v[104:107], v[180:183]
    v_accvgpr_read_b32 v34, a220
    v_accvgpr_read_b32 v31, a221
    v_mfma_f32_16x16x32_bf16 v[180:183], v[52:55], v[108:111], v[180:183]
    v_cvt_pk_bf16_f32 v34, v34, v31
    v_accvgpr_read_b32 v35, a222
    v_mfma_f32_16x16x32_bf16 v[184:187], v[48:51], v[112:115], v[184:187]
    v_accvgpr_read_b32 v31, a223
    v_cvt_pk_bf16_f32 v35, v35, v31
    v_mfma_f32_16x16x32_bf16 v[184:187], v[52:55], v[116:119], v[184:187]
    v_accvgpr_write_b32 a212, 0
    v_accvgpr_write_b32 a213, 0
    v_mfma_f32_16x16x32_bf16 v[188:191], v[48:51], v[120:123], v[188:191]
    s_add_u32 s72, s71, 37888
    ds_read_b64_tr_b16 v[48:49], v20 offset:0
    ds_read_b64_tr_b16 v[50:51], v20 offset:1024
    v_mfma_f32_16x16x32_bf16 v[188:191], v[52:55], v[124:127], v[188:191]
    s_waitcnt lgkmcnt(2)
    ds_read_b64_tr_b16 v[52:53], v20 offset:8192
    ds_read_b64_tr_b16 v[54:55], v20 offset:9216
    v_mfma_f32_16x16x32_bf16 v[192:195], v[56:59], v[96:99], v[192:195]
    buffer_load_dwordx4 v12, s[20:23], s64 offen offset:2048 lds
    v_mfma_f32_16x16x32_bf16 v[192:195], v[60:63], v[100:103], v[192:195]
    v_add_u32 v20, 0x10000, v20
    v_accvgpr_write_b32 a214, 0
    v_mfma_f32_16x16x32_bf16 v[196:199], v[56:59], v[104:107], v[196:199]
    buffer_store_dwordx4 v[32:35], v1, s[36:39], s72 offen sc1
    v_mfma_f32_16x16x32_bf16 v[196:199], v[60:63], v[108:111], v[196:199]
    ds_read_b128 v[76:79], v25 offset:24576
    v_accvgpr_write_b32 a215, 0
    v_mfma_f32_16x16x32_bf16 v[200:203], v[56:59], v[112:115], v[200:203]
    v_accvgpr_write_b32 a216, 0
    v_accvgpr_write_b32 a217, 0
    v_mfma_f32_16x16x32_bf16 v[200:203], v[60:63], v[116:119], v[200:203]
    v_accvgpr_write_b32 a218, 0
    v_accvgpr_write_b32 a219, 0
    v_mfma_f32_16x16x32_bf16 v[204:207], v[56:59], v[120:123], v[204:207]
    ds_read_b64_tr_b16 v[56:57], v21 offset:0
    ds_read_b64_tr_b16 v[58:59], v21 offset:1024
    v_mfma_f32_16x16x32_bf16 v[204:207], v[60:63], v[124:127], v[204:207]
    ds_read_b64_tr_b16 v[60:61], v21 offset:8192
    ds_read_b64_tr_b16 v[62:63], v21 offset:9216
    v_mfma_f32_16x16x32_bf16 v[208:211], v[40:43], v[96:99], v[208:211]
    v_add_u32 v21, 0x10000, v21
    v_accvgpr_write_b32 a220, 0
    v_mfma_f32_16x16x32_bf16 v[208:211], v[44:47], v[100:103], v[208:211]
    buffer_load_dwordx4 v13, s[20:23], s64 offen offset:3072 lds
    v_mfma_f32_16x16x32_bf16 v[212:215], v[40:43], v[104:107], v[212:215]
    v_accvgpr_write_b32 a221, 0
    v_accvgpr_write_b32 a222, 0
    v_mfma_f32_16x16x32_bf16 v[212:215], v[44:47], v[108:111], v[212:215]
    v_accvgpr_write_b32 a223, 0
    v_mfma_f32_16x16x32_bf16 v[216:219], v[40:43], v[112:115], v[216:219]
    v_accvgpr_read_b32 v32, a224
    v_accvgpr_read_b32 v31, a225
    v_mfma_f32_16x16x32_bf16 v[216:219], v[44:47], v[116:119], v[216:219]
    v_cvt_pk_bf16_f32 v32, v32, v31
    v_accvgpr_read_b32 v33, a226
    v_mfma_f32_16x16x32_bf16 v[220:223], v[40:43], v[120:123], v[220:223]
    ds_read_b64_tr_b16 v[40:41], v26 offset:32768
    ds_read_b64_tr_b16 v[42:43], v26 offset:33280
    v_mfma_f32_16x16x32_bf16 v[220:223], v[44:47], v[124:127], v[220:223]
    s_waitcnt lgkmcnt(2)
    ds_read_b64_tr_b16 v[44:45], v26 offset:36864
    ds_read_b64_tr_b16 v[46:47], v26 offset:37376
    v_mfma_f32_16x16x32_bf16 v[224:227], v[48:51], v[96:99], v[224:227]
    v_add_u32 v26, 0xffff0000, v26
    v_accvgpr_read_b32 v31, a227
    v_mfma_f32_16x16x32_bf16 v[224:227], v[52:55], v[100:103], v[224:227]
    s_xor_b32 s64, s64, 1920
    v_cvt_pk_bf16_f32 v33, v33, v31
    v_accvgpr_read_b32 v34, a228
    v_mfma_f32_16x16x32_bf16 v[228:231], v[48:51], v[104:107], v[228:231]
    s_andn2_b32 s64, s64, 896
    v_accvgpr_read_b32 v31, a229
    v_cvt_pk_bf16_f32 v34, v34, v31
    v_mfma_f32_16x16x32_bf16 v[228:231], v[52:55], v[108:111], v[228:231]
    v_accvgpr_read_b32 v35, a230
    v_accvgpr_read_b32 v31, a231
    v_mfma_f32_16x16x32_bf16 v[232:235], v[48:51], v[112:115], v[232:235]
    v_cvt_pk_bf16_f32 v35, v35, v31
    v_mfma_f32_16x16x32_bf16 v[232:235], v[52:55], v[116:119], v[232:235]
    s_add_u32 m0, s69, 32768
    v_mfma_f32_16x16x32_bf16 v[236:239], v[48:51], v[120:123], v[236:239]
    buffer_load_dwordx4 v2, s[24:27], s60 offen lds
    v_mfma_f32_16x16x32_bf16 v[236:239], v[52:55], v[124:127], v[236:239]
    s_add_u32 s72, s71, 6144
    ds_read_b64_tr_b16 v[48:49], v27 offset:32768
    ds_read_b64_tr_b16 v[50:51], v27 offset:33280
    v_mfma_f32_16x16x32_bf16 v[240:243], v[56:59], v[96:99], v[240:243]
    ds_read_b64_tr_b16 v[52:53], v27 offset:36864
    ds_read_b64_tr_b16 v[54:55], v27 offset:37376
    v_mfma_f32_16x16x32_bf16 v[240:243], v[60:63], v[100:103], v[240:243]
    buffer_store_dwordx4 v[32:35], v1, s[36:39], s72 offen sc1
    v_mfma_f32_16x16x32_bf16 v[244:247], v[56:59], v[104:107], v[244:247]
    buffer_load_dwordx4 v3, s[24:27], s60 offen offset:1024 lds
    v_mfma_f32_16x16x32_bf16 v[244:247], v[60:63], v[108:111], v[244:247]
    v_add_u32 v27, 0xffff0000, v27
    v_mfma_f32_16x16x32_bf16 v[248:251], v[56:59], v[112:115], v[248:251]
    v_mfma_f32_16x16x32_bf16 v[248:251], v[60:63], v[116:119], v[248:251]
    v_mfma_f32_16x16x32_bf16 v[252:255], v[56:59], v[120:123], v[252:255]
    buffer_load_dwordx4 v4, s[24:27], s60 offen offset:2048 lds
    v_mfma_f32_16x16x32_bf16 v[252:255], v[60:63], v[124:127], v[252:255]
    s_waitcnt lgkmcnt(0)
    ds_read_b64_tr_b16 v[56:57], v28 offset:32768
    ds_read_b64_tr_b16 v[58:59], v28 offset:33280
    v_mfma_f32_16x16x32_bf16 a[64:67], v[40:43], v[96:99], a[64:67]
    ds_read_b64_tr_b16 v[60:61], v28 offset:36864
    ds_read_b64_tr_b16 v[62:63], v28 offset:37376
    v_mfma_f32_16x16x32_bf16 a[64:67], v[44:47], v[100:103], a[64:67]
    v_add_u32 v28, 0xffff0000, v28
    v_mfma_f32_16x16x32_bf16 a[68:71], v[40:43], v[104:107], a[68:71]
    buffer_load_dwordx4 v5, s[24:27], s60 offen offset:3072 lds
    v_mfma_f32_16x16x32_bf16 a[68:71], v[44:47], v[108:111], a[68:71]
    ds_read_b128 v[80:83], v24 offset:49152
    v_mfma_f32_16x16x32_bf16 a[72:75], v[40:43], v[112:115], a[72:75]
    v_mfma_f32_16x16x32_bf16 a[72:75], v[44:47], v[116:119], a[72:75]
    s_xor_b32 s60, s60, 7864320
    v_accvgpr_read_b32 v32, a232
    v_accvgpr_read_b32 v31, a233
    v_mfma_f32_16x16x32_bf16 a[76:79], v[40:43], v[120:123], a[76:79]
    s_add_u32 m0, s69, 49152
    ds_read_b128 v[84:87], v25 offset:49152
    v_cvt_pk_bf16_f32 v32, v32, v31
    v_mfma_f32_16x16x32_bf16 a[76:79], v[44:47], v[124:127], a[76:79]
    s_andn2_b32 s60, s60, 3670016
    buffer_load_dwordx4 v10, s[20:23], s63 offen lds
    v_mfma_f32_16x16x32_bf16 a[128:131], v[40:43], a[136:139], a[128:131]
    ds_read_b64_tr_b16 v[40:41], v29 offset:32768
    ds_read_b64_tr_b16 v[42:43], v29 offset:33280
    v_mfma_f32_16x16x32_bf16 a[128:131], v[44:47], a[140:143], a[128:131]
    ds_read_b64_tr_b16 v[44:45], v29 offset:36864
    ds_read_b64_tr_b16 v[46:47], v29 offset:37376
    v_mfma_f32_16x16x32_bf16 a[80:83], v[48:51], v[96:99], a[80:83]
    buffer_load_dwordx4 v11, s[20:23], s63 offen offset:1024 lds
    v_mfma_f32_16x16x32_bf16 a[80:83], v[52:55], v[100:103], a[80:83]
    ds_read_b128 v[88:91], v24 offset:57344
    v_add_u32 v29, 0xffff0000, v29
    v_mfma_f32_16x16x32_bf16 a[84:87], v[48:51], v[104:107], a[84:87]
    v_accvgpr_read_b32 v33, a234
    v_accvgpr_read_b32 v31, a235
    v_mfma_f32_16x16x32_bf16 a[84:87], v[52:55], v[108:111], a[84:87]
    v_cvt_pk_bf16_f32 v33, v33, v31
    v_accvgpr_read_b32 v34, a236
    v_mfma_f32_16x16x32_bf16 a[88:91], v[48:51], v[112:115], a[88:91]
    buffer_load_dwordx4 v12, s[20:23], s63 offen offset:2048 lds
    v_mfma_f32_16x16x32_bf16 a[88:91], v[52:55], v[116:119], a[88:91]
    ds_read_b128 v[92:95], v25 offset:57344
    v_accvgpr_read_b32 v31, a237
    v_mfma_f32_16x16x32_bf16 a[92:95], v[48:51], v[120:123], a[92:95]
    s_add_u32 s72, s71, 7168
    v_cvt_pk_bf16_f32 v34, v34, v31
    v_accvgpr_read_b32 v35, a238
    v_mfma_f32_16x16x32_bf16 a[92:95], v[52:55], v[124:127], a[92:95]
    v_accvgpr_read_b32 v31, a239
    v_cvt_pk_bf16_f32 v35, v35, v31
    v_mfma_f32_16x16x32_bf16 a[132:135], v[48:51], a[136:139], a[132:135]
    buffer_load_dwordx4 v13, s[20:23], s63 offen offset:3072 lds
    v_mfma_f32_16x16x32_bf16 a[132:135], v[52:55], a[140:143], a[132:135]
    s_waitcnt lgkmcnt(1)
    v_mfma_f32_16x16x32_bf16 a[96:99], v[56:59], v[96:99], a[96:99]
    v_mfma_f32_16x16x32_bf16 a[96:99], v[60:63], v[100:103], a[96:99]
    s_xor_b32 s63, s63, 128
    v_mfma_f32_16x16x32_bf16 a[100:103], v[56:59], v[104:107], a[100:103]
    buffer_store_dwordx4 v[32:35], v1, s[36:39], s72 offen sc1
    v_mfma_f32_16x16x32_bf16 a[100:103], v[60:63], v[108:111], a[100:103]
    v_mfma_f32_16x16x32_bf16 a[104:107], v[56:59], v[112:115], a[104:107]
    v_mfma_f32_16x16x32_bf16 a[104:107], v[60:63], v[116:119], a[104:107]
    s_waitcnt vmcnt(10) lgkmcnt(0)
    s_barrier
    ds_read_b64_tr_b16 v[48:49], v14 offset:0
    v_mfma_f32_16x16x32_bf16 a[108:111], v[56:59], v[120:123], a[108:111]
    s_add_u32 m0, s69, 65536
    ds_read_b64_tr_b16 v[50:51], v14 offset:1024
    ds_read_b64_tr_b16 v[52:53], v14 offset:8192
    v_mfma_f32_16x16x32_bf16 a[108:111], v[60:63], v[124:127], a[108:111]
    buffer_load_dwordx4 v2, s[24:27], s60 offen lds
    v_mfma_f32_16x16x32_bf16 a[112:115], v[40:43], v[96:99], a[112:115]
    ds_read_b64_tr_b16 v[54:55], v14 offset:9216
    ds_read_b64_tr_b16 v[56:57], v15 offset:0
    v_mfma_f32_16x16x32_bf16 a[112:115], v[44:47], v[100:103], a[112:115]
    ds_read_b64_tr_b16 v[58:59], v15 offset:1024
    ds_read_b64_tr_b16 v[60:61], v15 offset:8192
    v_mfma_f32_16x16x32_bf16 a[116:119], v[40:43], v[104:107], a[116:119]
    ds_read_b64_tr_b16 v[62:63], v15 offset:9216
    ds_read_b128 a[136:139], v22 offset:0
    v_mfma_f32_16x16x32_bf16 a[116:119], v[44:47], v[108:111], a[116:119]
    ds_read_b128 a[140:143], v23 offset:0
    v_add_u32 v14, 0xfffe0000, v14
    v_mfma_f32_16x16x32_bf16 a[120:123], v[40:43], v[112:115], a[120:123]
    v_add_u32 v15, 0xfffe0000, v15
    v_add_u32 v22, 0x10000, v22
    v_mfma_f32_16x16x32_bf16 a[120:123], v[44:47], v[116:119], a[120:123]
    buffer_load_dwordx4 v3, s[24:27], s60 offen offset:1024 lds
    v_mfma_f32_16x16x32_bf16 a[124:127], v[40:43], v[120:123], a[124:127]
    ds_read_b64_tr_b16 v[40:41], v16 offset:0
    ds_read_b64_tr_b16 v[42:43], v16 offset:1024
    v_mfma_f32_16x16x32_bf16 a[124:127], v[44:47], v[124:127], a[124:127]
    s_waitcnt lgkmcnt(3)
    ds_read_b64_tr_b16 v[44:45], v16 offset:8192
    ds_read_b64_tr_b16 v[46:47], v16 offset:9216
    v_mfma_f32_16x16x32_bf16 v[128:131], v[48:51], v[64:67], v[128:131]
    v_add_u32 v16, 0xfffe0000, v16
    v_add_u32 v23, 0x10000, v23
    v_mfma_f32_16x16x32_bf16 v[128:131], v[52:55], v[68:71], v[128:131]
    v_add_u32 v24, 0x10000, v24
    v_accvgpr_read_b32 v32, a240
    v_mfma_f32_16x16x32_bf16 v[132:135], v[48:51], v[72:75], v[132:135]
    ds_read_b128 v[96:99], v24 offset:16384
    v_accvgpr_read_b32 v31, a241
    v_mfma_f32_16x16x32_bf16 v[132:135], v[52:55], v[76:79], v[132:135]
    v_cvt_pk_bf16_f32 v32, v32, v31
    v_accvgpr_read_b32 v33, a242
    v_mfma_f32_16x16x32_bf16 v[136:139], v[48:51], v[80:83], v[136:139]
    v_accvgpr_read_b32 v31, a243
    v_cvt_pk_bf16_f32 v33, v33, v31
    v_mfma_f32_16x16x32_bf16 v[136:139], v[52:55], v[84:87], v[136:139]
    s_add_u32 s72, s71, 38912
    buffer_load_dwordx4 v4, s[24:27], s60 offen offset:2048 lds
    v_mfma_f32_16x16x32_bf16 v[140:143], v[48:51], v[88:91], v[140:143]
    ds_read_b64_tr_b16 v[48:49], v17 offset:0
    ds_read_b64_tr_b16 v[50:51], v17 offset:1024
    v_mfma_f32_16x16x32_bf16 v[140:143], v[52:55], v[92:95], v[140:143]
    ds_read_b64_tr_b16 v[52:53], v17 offset:8192
    ds_read_b64_tr_b16 v[54:55], v17 offset:9216
    v_mfma_f32_16x16x32_bf16 v[144:147], v[56:59], v[64:67], v[144:147]
    v_add_u32 v17, 0xfffe0000, v17
    v_accvgpr_read_b32 v34, a244
    v_mfma_f32_16x16x32_bf16 v[144:147], v[60:63], v[68:71], v[144:147]
    v_accvgpr_read_b32 v31, a245
    v_cvt_pk_bf16_f32 v34, v34, v31
    v_mfma_f32_16x16x32_bf16 v[148:151], v[56:59], v[72:75], v[148:151]
    v_accvgpr_read_b32 v35, a246
    v_accvgpr_read_b32 v31, a247
    v_mfma_f32_16x16x32_bf16 v[148:151], v[60:63], v[76:79], v[148:151]
    v_cvt_pk_bf16_f32 v35, v35, v31
    v_mov_b32 v2, v1
    v_mfma_f32_16x16x32_bf16 v[152:155], v[56:59], v[80:83], v[152:155]
    buffer_load_dwordx4 v5, s[24:27], s60 offen offset:3072 lds
    v_mfma_f32_16x16x32_bf16 v[152:155], v[60:63], v[84:87], v[152:155]
    v_add_u32 v25, 0x10000, v25
    ds_read_b128 v[100:103], v25 offset:16384
    v_mfma_f32_16x16x32_bf16 v[156:159], v[56:59], v[88:91], v[156:159]
    ds_read_b64_tr_b16 v[56:57], v18 offset:0
    ds_read_b64_tr_b16 v[58:59], v18 offset:1024
    v_mfma_f32_16x16x32_bf16 v[156:159], v[60:63], v[92:95], v[156:159]
    s_waitcnt lgkmcnt(3)
    ds_read_b64_tr_b16 v[60:61], v18 offset:8192
    ds_read_b64_tr_b16 v[62:63], v18 offset:9216
    v_mfma_f32_16x16x32_bf16 v[160:163], v[40:43], v[64:67], v[160:163]
    buffer_store_dwordx4 v[32:35], v1, s[36:39], s72 offen sc1
    v_mfma_f32_16x16x32_bf16 v[160:163], v[44:47], v[68:71], v[160:163]
    v_add_u32 v18, 0xfffe0000, v18
    v_mfma_f32_16x16x32_bf16 v[164:167], v[40:43], v[72:75], v[164:167]
    v_mfma_f32_16x16x32_bf16 v[164:167], v[44:47], v[76:79], v[164:167]
    s_add_u32 m0, s69, 81920
    v_accvgpr_read_b32 v32, a248
    v_accvgpr_read_b32 v31, a249
    v_mfma_f32_16x16x32_bf16 v[168:171], v[40:43], v[80:83], v[168:171]
    s_xor_b32 s60, s60, 524288
    buffer_load_dwordx4 v10, s[20:23], s64 offen lds
    v_mfma_f32_16x16x32_bf16 v[168:171], v[44:47], v[84:87], v[168:171]
    s_mov_b32 s60, 131072
    v_cvt_pk_bf16_f32 v32, v32, v31
    v_accvgpr_read_b32 v33, a250
    v_mfma_f32_16x16x32_bf16 v[172:175], v[40:43], v[88:91], v[172:175]
    ds_read_b64_tr_b16 v[40:41], v19 offset:0
    ds_read_b64_tr_b16 v[42:43], v19 offset:1024
    v_mfma_f32_16x16x32_bf16 v[172:175], v[44:47], v[92:95], v[172:175]
    ds_read_b64_tr_b16 v[44:45], v19 offset:8192
    ds_read_b64_tr_b16 v[46:47], v19 offset:9216
    v_mfma_f32_16x16x32_bf16 v[176:179], v[48:51], v[64:67], v[176:179]
    ds_read_b128 v[104:107], v24 offset:24576
    v_add_u32 v19, 0xfffe0000, v19
    v_mfma_f32_16x16x32_bf16 v[176:179], v[52:55], v[68:71], v[176:179]
    v_accvgpr_read_b32 v31, a251
    v_cvt_pk_bf16_f32 v33, v33, v31
    v_mfma_f32_16x16x32_bf16 v[180:183], v[48:51], v[72:75], v[180:183]
    v_accvgpr_read_b32 v34, a252
    v_accvgpr_read_b32 v31, a253
    v_mfma_f32_16x16x32_bf16 v[180:183], v[52:55], v[76:79], v[180:183]
    buffer_load_dwordx4 v11, s[20:23], s64 offen offset:1024 lds
    v_mfma_f32_16x16x32_bf16 v[184:187], v[48:51], v[80:83], v[184:187]
    v_cvt_pk_bf16_f32 v34, v34, v31
    v_accvgpr_read_b32 v35, a254
    v_mfma_f32_16x16x32_bf16 v[184:187], v[52:55], v[84:87], v[184:187]
    v_accvgpr_read_b32 v31, a255
    v_cvt_pk_bf16_f32 v35, v35, v31
    v_mfma_f32_16x16x32_bf16 v[188:191], v[48:51], v[88:91], v[188:191]
    s_add_u32 s72, s71, 39936
    ds_read_b64_tr_b16 v[48:49], v20 offset:0
    ds_read_b64_tr_b16 v[50:51], v20 offset:1024
    v_mfma_f32_16x16x32_bf16 v[188:191], v[52:55], v[92:95], v[188:191]
    s_waitcnt lgkmcnt(2)
    ds_read_b64_tr_b16 v[52:53], v20 offset:8192
    ds_read_b64_tr_b16 v[54:55], v20 offset:9216
    v_mfma_f32_16x16x32_bf16 v[192:195], v[56:59], v[64:67], v[192:195]
    v_mov_b32 v31, 1
    v_add_u32 v20, 0xfffe0000, v20
    v_mfma_f32_16x16x32_bf16 v[192:195], v[60:63], v[68:71], v[192:195]
    buffer_store_dwordx4 v[32:35], v1, s[36:39], s72 offen sc1
    v_mfma_f32_16x16x32_bf16 v[196:199], v[56:59], v[72:75], v[196:199]
    v_add_u32 v11, s99, v39
    v_mfma_f32_16x16x32_bf16 v[196:199], v[60:63], v[76:79], v[196:199]
    s_mul_i32 s99, s98, 6
    buffer_load_dwordx4 v12, s[20:23], s64 offen offset:2048 lds
    v_mfma_f32_16x16x32_bf16 v[200:203], v[56:59], v[80:83], v[200:203]
    s_sub_u32 s99, s8, s99
    ds_read_b128 v[108:111], v25 offset:24576
    v_mfma_f32_16x16x32_bf16 v[200:203], v[60:63], v[84:87], v[200:203]
    s_mul_i32 s99, s99, 6
    v_mfma_f32_16x16x32_bf16 v[204:207], v[56:59], v[88:91], v[204:207]
    s_lshr_b32 s8, s5, 3
    ds_read_b64_tr_b16 v[56:57], v21 offset:0
    ds_read_b64_tr_b16 v[58:59], v21 offset:1024
    v_mfma_f32_16x16x32_bf16 v[204:207], v[60:63], v[92:95], v[204:207]
    s_lshl1_add_u32 s99, s4, s99
    ds_read_b64_tr_b16 v[60:61], v21 offset:8192
    ds_read_b64_tr_b16 v[62:63], v21 offset:9216
    v_mfma_f32_16x16x32_bf16 v[208:211], v[40:43], v[64:67], v[208:211]
    s_mul_i32 s8, s8, 6
    v_add_u32 v21, 0xfffe0000, v21
    v_mfma_f32_16x16x32_bf16 v[208:211], v[44:47], v[68:71], v[208:211]
    s_cmp_lt_u32 s98, 6
    s_cselect_b32 s98, s98, 40
    v_mfma_f32_16x16x32_bf16 v[212:215], v[40:43], v[72:75], v[212:215]
    s_sub_u32 s99, s99, 2
    buffer_load_dwordx4 v13, s[20:23], s64 offen offset:3072 lds
    v_mfma_f32_16x16x32_bf16 v[212:215], v[44:47], v[76:79], v[212:215]
    s_add_u32 s98, s98, s8
    v_mfma_f32_16x16x32_bf16 v[216:219], v[40:43], v[80:83], v[216:219]
    s_lshl_b32 s8, s99, 5
    v_lshl_add_u32 v10, v38, 4, s8
    v_lshrrev_b32 v38, 2, v37
    v_mfma_f32_16x16x32_bf16 v[216:219], v[44:47], v[84:87], v[216:219]
    s_lshr_b32 s99, s99, 1
    v_lshl_add_u32 v38, s98, 2, v38
    v_mul_u32_u24 v39, 171, v38
    v_mfma_f32_16x16x32_bf16 v[220:223], v[40:43], v[88:91], v[220:223]
    s_add_u32 s98, s98, 128
    ds_read_b64_tr_b16 v[40:41], v26 offset:0
    ds_read_b64_tr_b16 v[42:43], v26 offset:512
    v_mfma_f32_16x16x32_bf16 v[220:223], v[44:47], v[92:95], v[220:223]
    s_add_u32 s8, s100, 16
    ds_read_b64_tr_b16 v[44:45], v26 offset:4096
    ds_read_b64_tr_b16 v[46:47], v26 offset:4608
    s_waitcnt lgkmcnt(4)
    v_mfma_f32_16x16x32_bf16 v[224:227], v[48:51], v[64:67], v[224:227]
    v_add_u32 v26, 0x10000, v26
    v_and_b32 v37, 3, v37
    v_mfma_f32_16x16x32_bf16 v[224:227], v[52:55], v[68:71], v[224:227]
    s_xor_b32 s64, s64, 128
    v_lshrrev_b32 v39, 9, v39
    v_lshl_add_u32 v37, v38, 3, v37
    v_mfma_f32_16x16x32_bf16 v[228:231], v[48:51], v[72:75], v[228:231]
    v_mul_u32_u24 v38, 24, v39
    v_sub_u32 v37, v37, v38
    v_mfma_f32_16x16x32_bf16 v[228:231], v[52:55], v[76:79], v[228:231]
    v_mad_u32_u24 v39, v39, 18, v37
    v_mul_u32_u24 v39, 1152, v39
    v_mfma_f32_16x16x32_bf16 v[232:235], v[48:51], v[80:83], v[232:235]
    v_add_u32 v39, v39, v10
    v_add_u32 v12, 0, v39
    v_mfma_f32_16x16x32_bf16 v[232:235], v[52:55], v[84:87], v[232:235]
    s_add_u32 m0, s67, 98304
    v_mov_b32 v38, 1073741824
    v_cmp_gt_u32 vcc, 18, v37
    v_mfma_f32_16x16x32_bf16 v[236:239], v[48:51], v[88:91], v[236:239]
    buffer_load_dwordx4 v1, s[28:31], s65 offen sc1 lds
    v_mfma_f32_16x16x32_bf16 v[236:239], v[52:55], v[92:95], v[236:239]
    ds_read_b64_tr_b16 v[48:49], v27 offset:0
    ds_read_b64_tr_b16 v[50:51], v27 offset:512
    v_mfma_f32_16x16x32_bf16 v[240:243], v[56:59], v[64:67], v[240:243]
    ds_read_b64_tr_b16 v[52:53], v27 offset:4096
    ds_read_b64_tr_b16 v[54:55], v27 offset:4608
    v_mfma_f32_16x16x32_bf16 v[240:243], v[60:63], v[68:71], v[240:243]
    v_add_u32 v27, 0x10000, v27
    v_cndmask_b32 v12, v38, v12, vcc
    v_mfma_f32_16x16x32_bf16 v[244:247], v[56:59], v[72:75], v[244:247]
    v_add_u32 v38, 1024, v36
    v_add_u32 v13, 4608, v39
    v_mfma_f32_16x16x32_bf16 v[244:247], v[60:63], v[76:79], v[244:247]
    s_cmp_eq_u32 s4, 0
    s_cselect_b64 vcc, -1, 0
    v_cndmask_b32 v12, v12, v38, vcc
    v_mfma_f32_16x16x32_bf16 v[248:251], v[56:59], v[80:83], v[248:251]
    v_mov_b32 v38, 1073741824
    v_cmp_gt_u32 vcc, 14, v37
    v_mfma_f32_16x16x32_bf16 v[248:251], v[60:63], v[84:87], v[248:251]
    v_lshrrev_b32 v37, 8, v1
    v_cndmask_b32 v13, v38, v13, vcc
    v_mfma_f32_16x16x32_bf16 v[252:255], v[56:59], v[88:91], v[252:255]
    ds_read_b64_tr_b16 v[56:57], v28 offset:0
    ds_read_b64_tr_b16 v[58:59], v28 offset:512
    v_mfma_f32_16x16x32_bf16 v[252:255], v[60:63], v[92:95], v[252:255]
    s_waitcnt lgkmcnt(2)
    ds_read_b64_tr_b16 v[60:61], v28 offset:4096
    ds_read_b64_tr_b16 v[62:63], v28 offset:4608
    v_mfma_f32_16x16x32_bf16 a[64:67], v[40:43], v[64:67], a[64:67]
    buffer_load_dwordx4 v1, s[28:31], s65 offen offset:1024 sc1 lds
    v_mfma_f32_16x16x32_bf16 a[64:67], v[44:47], v[68:71], a[64:67]
    v_add_u32 v24, 0xfffe0000, v24
    v_add_u32 v28, 0x10000, v28
    v_mfma_f32_16x16x32_bf16 a[68:71], v[40:43], v[72:75], a[68:71]
    ds_read_b128 v[112:115], v24 offset:16384
    v_add_u32 v38, 19456, v36
    v_mfma_f32_16x16x32_bf16 a[68:71], v[44:47], v[76:79], a[68:71]
    s_cmp_eq_u32 s4, 0
    s_cselect_b64 vcc, -1, 0
    v_cndmask_b32 v13, v13, v38, vcc
    v_mfma_f32_16x16x32_bf16 a[72:75], v[40:43], v[80:83], a[72:75]
    s_cmp_eq_u32 s4, 0
    s_cselect_b32 s98, s7, s98
    s_cselect_b32 s99, s8, s99
    v_mfma_f32_16x16x32_bf16 a[72:75], v[44:47], v[84:87], a[72:75]
    s_lshr_b32 s9, s99, 2
    v_add_u32 v25, 0xfffe0000, v25
    v_bfe_u32 v36, v1, 4, 4
    v_mfma_f32_16x16x32_bf16 a[76:79], v[40:43], v[88:91], a[76:79]
    s_lshr_b32 s92, s2, 3
    ds_read_b128 v[116:119], v25 offset:16384
    v_lshrrev_b32 v9, 4, v1
    v_mfma_f32_16x16x32_bf16 a[76:79], v[44:47], v[92:95], a[76:79]
    s_lshl2_add_u32 s92, s92, s4
    v_min_u32 v9, 0, v9
    v_lshlrev_b32 v37, 2, v37
    v_mfma_f32_16x16x32_bf16 a[128:131], v[40:43], a[136:139], a[128:131]
    s_mul_i32 s92, s92, 1
    ds_read_b64_tr_b16 v[40:41], v29 offset:0
    ds_read_b64_tr_b16 v[42:43], v29 offset:512
    v_mfma_f32_16x16x32_bf16 a[128:131], v[44:47], a[140:143], a[128:131]
    s_add_u32 s92, s92, 32
    v_add_lshl_u32 v9, v9, s92, 7
    ds_read_b64_tr_b16 v[44:45], v29 offset:4096
    v_mfma_f32_16x16x32_bf16 a[80:83], v[48:51], v[64:67], a[80:83]
    s_add_u32 m0, s68, 106496
    ds_read_b128 v[120:123], v24 offset:24576
    ds_read_b64_tr_b16 v[46:47], v29 offset:4608
    v_mfma_f32_16x16x32_bf16 a[80:83], v[52:55], v[68:71], a[80:83]
    s_getpc_b64 s[92:93]
    global_load_dword v9, v9, s[92:93]
    v_mfma_f32_16x16x32_bf16 a[84:87], v[48:51], v[72:75], a[84:87]
    s_sub_u32 s9, s9, s10
    buffer_load_dwordx4 v6, s[20:23], s66 offen lds
    v_mfma_f32_16x16x32_bf16 a[84:87], v[52:55], v[76:79], a[84:87]
    s_sub_u32 s9, s9, 1
    v_add_u32 v29, 0x10000, v29
    v_sub_u32 v36, v36, v37
    v_mfma_f32_16x16x32_bf16 a[88:91], v[48:51], v[80:83], a[88:91]
    s_and_b32 s9, s9, 3
    ds_read_b128 v[124:127], v25 offset:24576
    v_mov_b32 v37, 0xf149f2ca
    v_mfma_f32_16x16x32_bf16 a[88:91], v[52:55], v[84:87], a[88:91]
    s_lshl_b32 s9, s9, 1
    v_bfe_u32 v38, v1, 4, 2
    v_and_b32 v39, 0x40, v1
    v_mfma_f32_16x16x32_bf16 a[92:95], v[48:51], v[88:91], a[92:95]
    s_and_b32 s10, s99, 3
    v_mfma_f32_16x16x32_bf16 a[92:95], v[52:55], v[92:95], a[92:95]
    s_cmp_eq_u32 s9, 6
    s_cselect_b32 s9, 7, s9
    v_mfma_f32_16x16x32_bf16 a[132:135], v[48:51], a[136:139], a[132:135]
    s_mul_i32 s10, s10, 9
    v_mfma_f32_16x16x32_bf16 a[132:135], v[52:55], a[140:143], a[132:135]
    s_add_u32 s9, s9, s10
    s_waitcnt lgkmcnt(0)
    v_mfma_f32_16x16x32_bf16 a[96:99], v[56:59], v[64:67], a[96:99]
    s_lshl_b32 s64, s9, 10
    v_mfma_f32_16x16x32_bf16 a[96:99], v[60:63], v[68:71], a[96:99]
    s_xor_b32 s65, s65, 122880
    v_mfma_f32_16x16x32_bf16 a[100:103], v[56:59], v[72:75], a[100:103]
    s_xor_b32 s66, s66, 1920
    v_mfma_f32_16x16x32_bf16 a[100:103], v[60:63], v[76:79], a[100:103]
    s_andn2_b32 s65, s65, 57344
    v_mfma_f32_16x16x32_bf16 a[104:107], v[56:59], v[80:83], a[104:107]
    s_andn2_b32 s66, s66, 896
    v_mfma_f32_16x16x32_bf16 a[104:107], v[60:63], v[84:87], a[104:107]
    s_waitcnt vmcnt(4) lgkmcnt(0)
    s_barrier
    ds_read_b64_tr_b16 v[48:49], v14 offset:32768
    v_mfma_f32_16x16x32_bf16 a[108:111], v[56:59], v[88:91], a[108:111]
    s_add_u32 m0, s67, 131072
    buffer_store_dword v31, v30, s[32:35], s101 offen sc1
    v_mfma_f32_16x16x32_bf16 a[108:111], v[60:63], v[92:95], a[108:111]
    s_sub_u32 s9, s99, 16
    buffer_load_dwordx4 v1, s[28:31], s65 offen sc1 lds
    v_mfma_f32_16x16x32_bf16 a[112:115], v[40:43], v[64:67], a[112:115]
    s_mul_i32 s9, s9, 18432
    ds_read_b64_tr_b16 v[50:51], v14 offset:33792
    ds_read_b64_tr_b16 v[52:53], v14 offset:40960
    v_mfma_f32_16x16x32_bf16 a[112:115], v[44:47], v[68:71], a[112:115]
    s_add_u32 s9, s9, 6144
    ds_read_b64_tr_b16 v[54:55], v14 offset:41984
    ds_read_b64_tr_b16 v[56:57], v15 offset:32768
    v_mfma_f32_16x16x32_bf16 a[116:119], v[40:43], v[72:75], a[116:119]
    s_mov_b32 s10, 1024
    ds_read_b64_tr_b16 v[58:59], v15 offset:33792
    ds_read_b64_tr_b16 v[60:61], v15 offset:40960
    v_mfma_f32_16x16x32_bf16 a[116:119], v[44:47], v[76:79], a[116:119]
    s_mul_i32 s98, s98, 36864
    ds_read_b64_tr_b16 v[62:63], v15 offset:41984
    v_add_u32 v14, 0x10000, v14
    v_mfma_f32_16x16x32_bf16 a[120:123], v[40:43], v[80:83], a[120:123]
    s_mul_i32 s7, s7, 36864
    v_add_u32 v15, 0x10000, v15
    v_mfma_f32_16x16x32_bf16 a[120:123], v[44:47], v[84:87], a[120:123]
    s_cmp_lt_u32 s99, 16
    s_cselect_b32 s64, s64, s9
    s_cselect_b32 s10, s10, 9216
    v_mfma_f32_16x16x32_bf16 a[124:127], v[40:43], v[88:91], a[124:127]
    s_lshl2_add_u32 s99, s100, s4
    ds_read_b64_tr_b16 v[40:41], v16 offset:32768
    ds_read_b64_tr_b16 v[42:43], v16 offset:33792
    v_mfma_f32_16x16x32_bf16 a[124:127], v[44:47], v[92:95], a[124:127]
    s_add_u32 s64, s64, s98
    ds_read_b64_tr_b16 v[44:45], v16 offset:40960
    ds_read_b64_tr_b16 v[46:47], v16 offset:41984
    s_waitcnt lgkmcnt(5)
    v_mfma_f32_16x16x32_bf16 v[128:131], v[48:51], v[96:99], v[128:131]
    s_lshl_b32 s99, s99, 1
    v_add_u32 v16, 0x10000, v16
    v_mfma_f32_16x16x32_bf16 v[128:131], v[52:55], v[100:103], v[128:131]
    s_add_u32 s62, s64, s10
    v_mfma_f32_16x16x32_bf16 v[132:135], v[48:51], v[104:107], v[132:135]
    s_lshr_b32 s9, s99, 2
    ds_read_b128 v[64:67], v24 offset:49152
    v_mfma_f32_16x16x32_bf16 v[132:135], v[52:55], v[108:111], v[132:135]
    s_lshr_b32 s10, s5, 3
    v_mfma_f32_16x16x32_bf16 v[136:139], v[48:51], v[112:115], v[136:139]
    s_sub_u32 s9, s9, s10
    v_mfma_f32_16x16x32_bf16 v[136:139], v[52:55], v[116:119], v[136:139]
    s_sub_u32 s9, s9, 1
    v_mfma_f32_16x16x32_bf16 v[140:143], v[48:51], v[120:123], v[140:143]
    s_and_b32 s9, s9, 3
    ds_read_b64_tr_b16 v[48:49], v17 offset:32768
    ds_read_b64_tr_b16 v[50:51], v17 offset:33792
    v_mfma_f32_16x16x32_bf16 v[140:143], v[52:55], v[124:127], v[140:143]
    s_lshl_b32 s9, s9, 1
    ds_read_b64_tr_b16 v[52:53], v17 offset:40960
    ds_read_b64_tr_b16 v[54:55], v17 offset:41984
    v_mfma_f32_16x16x32_bf16 v[144:147], v[56:59], v[96:99], v[144:147]
    s_and_b32 s10, s99, 3
    ds_read_b128 v[68:71], v25 offset:49152
    v_add_u32 v17, 0x10000, v17
    s_waitcnt lgkmcnt(5)
    v_mfma_f32_16x16x32_bf16 v[144:147], v[60:63], v[100:103], v[144:147]
    s_cmp_eq_u32 s9, 6
    s_cselect_b32 s9, 7, s9
    v_mfma_f32_16x16x32_bf16 v[148:151], v[56:59], v[104:107], v[148:151]
    s_mul_i32 s10, s10, 9
    buffer_load_dwordx4 v1, s[28:31], s65 offen offset:1024 sc1 lds
    v_mfma_f32_16x16x32_bf16 v[148:151], v[60:63], v[108:111], v[148:151]
    s_add_u32 s9, s9, s10
    v_mfma_f32_16x16x32_bf16 v[152:155], v[56:59], v[112:115], v[152:155]
    s_lshl_b32 s63, s9, 10
    v_mfma_f32_16x16x32_bf16 v[152:155], v[60:63], v[116:119], v[152:155]
    s_cmp_eq_u32 s4, 0
    s_cselect_b32 s8, 1.0, 0
    v_mfma_f32_16x16x32_bf16 v[156:159], v[56:59], v[120:123], v[156:159]
    s_add_u32 s63, s63, s7
    ds_read_b128 v[72:75], v24 offset:57344
    ds_read_b64_tr_b16 v[56:57], v18 offset:32768
    v_mfma_f32_16x16x32_bf16 v[156:159], v[60:63], v[124:127], v[156:159]
    ds_read_b64_tr_b16 v[58:59], v18 offset:33792
    ds_read_b64_tr_b16 v[60:61], v18 offset:40960
    v_mfma_f32_16x16x32_bf16 v[160:163], v[40:43], v[96:99], v[160:163]
    ds_read_b64_tr_b16 v[62:63], v18 offset:41984
    v_add_u32 v18, 0x10000, v18
    v_mfma_f32_16x16x32_bf16 v[160:163], v[44:47], v[100:103], v[160:163]
    s_cmp_eq_u32 s4, 1
    s_cselect_b32 s9, 1.0, 0
    v_mfma_f32_16x16x32_bf16 v[164:167], v[40:43], v[104:107], v[164:167]
    s_cmp_eq_u32 s6, 0
    s_cselect_b32 s16, s8, 0
    s_cselect_b32 s17, s9, 0
    v_mfma_f32_16x16x32_bf16 v[164:167], v[44:47], v[108:111], v[164:167]
    s_cmp_eq_u32 s4, 2
    s_cselect_b32 s10, 1.0, 0
    v_mfma_f32_16x16x32_bf16 v[168:171], v[40:43], v[112:115], v[168:171]
    ds_read_b128 v[76:79], v25 offset:57344
    v_mfma_f32_16x16x32_bf16 v[168:171], v[44:47], v[116:119], v[168:171]
    s_cmp_eq_u32 s6, 0
    s_cselect_b32 s18, s10, 0
    s_cselect_b32 s19, s11, 0
    v_mfma_f32_16x16x32_bf16 v[172:175], v[40:43], v[120:123], v[172:175]
    ds_read_b64_tr_b16 v[40:41], v19 offset:32768
    ds_read_b64_tr_b16 v[42:43], v19 offset:33792
    v_mfma_f32_16x16x32_bf16 v[172:175], v[44:47], v[124:127], v[172:175]
    s_waitcnt lgkmcnt(3)
    ds_read_b64_tr_b16 v[44:45], v19 offset:40960
    ds_read_b64_tr_b16 v[46:47], v19 offset:41984
    v_mfma_f32_16x16x32_bf16 v[176:179], v[48:51], v[96:99], v[176:179]
    v_add_u32 v19, 0x10000, v19
    v_mfma_f32_16x16x32_bf16 v[176:179], v[52:55], v[100:103], v[176:179]
    v_mfma_f32_16x16x32_bf16 v[180:183], v[48:51], v[104:107], v[180:183]
    v_mfma_f32_16x16x32_bf16 v[180:183], v[52:55], v[108:111], v[180:183]
    v_add_u32 v24, 0x10000, v24
    v_mfma_f32_16x16x32_bf16 v[184:187], v[48:51], v[112:115], v[184:187]
    ds_read_b128 v[80:83], v24 offset:16384
    v_mfma_f32_16x16x32_bf16 v[184:187], v[52:55], v[116:119], v[184:187]
    s_add_u32 m0, s68, 139264
    v_mfma_f32_16x16x32_bf16 v[188:191], v[48:51], v[120:123], v[188:191]
    buffer_load_dwordx4 v6, s[20:23], s66 offen lds
    v_mfma_f32_16x16x32_bf16 v[188:191], v[52:55], v[124:127], v[188:191]
    ds_read_b64_tr_b16 v[48:49], v20 offset:32768
    ds_read_b64_tr_b16 v[50:51], v20 offset:33792
    v_mfma_f32_16x16x32_bf16 v[192:195], v[56:59], v[96:99], v[192:195]
    ds_read_b64_tr_b16 v[52:53], v20 offset:40960
    ds_read_b64_tr_b16 v[54:55], v20 offset:41984
    v_mfma_f32_16x16x32_bf16 v[192:195], v[60:63], v[100:103], v[192:195]
    v_add_u32 v25, 0x10000, v25
    v_add_u32 v20, 0x10000, v20
    v_mfma_f32_16x16x32_bf16 v[196:199], v[56:59], v[104:107], v[196:199]
    ds_read_b128 v[84:87], v25 offset:16384
    v_mfma_f32_16x16x32_bf16 v[196:199], v[60:63], v[108:111], v[196:199]
    s_cmp_eq_u32 s6, 0
    s_cselect_b32 s20, s12, 0
    s_cselect_b32 s21, s13, 0
    v_mfma_f32_16x16x32_bf16 v[200:203], v[56:59], v[112:115], v[200:203]
    s_cmp_eq_u32 s6, 0
    s_cselect_b32 s22, s14, 0
    s_cselect_b32 s23, s15, 0
    v_mfma_f32_16x16x32_bf16 v[200:203], v[60:63], v[116:119], v[200:203]
    v_mfma_f32_16x16x32_bf16 v[204:207], v[56:59], v[120:123], v[204:207]
    ds_read_b64_tr_b16 v[56:57], v21 offset:32768
    ds_read_b64_tr_b16 v[58:59], v21 offset:33792
    v_mfma_f32_16x16x32_bf16 v[204:207], v[60:63], v[124:127], v[204:207]
    s_waitcnt lgkmcnt(2)
    ds_read_b64_tr_b16 v[60:61], v21 offset:40960
    ds_read_b64_tr_b16 v[62:63], v21 offset:41984
    v_mfma_f32_16x16x32_bf16 v[208:211], v[40:43], v[96:99], v[208:211]
    ds_read_b128 v[88:91], v24 offset:24576
    v_add_u32 v21, 0x10000, v21
    v_mfma_f32_16x16x32_bf16 v[208:211], v[44:47], v[100:103], v[208:211]
    v_mfma_f32_16x16x32_bf16 v[212:215], v[40:43], v[104:107], v[212:215]
    v_mfma_f32_16x16x32_bf16 v[212:215], v[44:47], v[108:111], v[212:215]
    v_mfma_f32_16x16x32_bf16 v[216:219], v[40:43], v[112:115], v[216:219]
    v_mfma_f32_16x16x32_bf16 v[216:219], v[44:47], v[116:119], v[216:219]
    v_mfma_f32_16x16x32_bf16 v[220:223], v[40:43], v[120:123], v[220:223]
    ds_read_b128 v[92:95], v25 offset:24576
    ds_read_b64_tr_b16 v[40:41], v14 offset:0
    v_mfma_f32_16x16x32_bf16 v[220:223], v[44:47], v[124:127], v[220:223]
    ds_read_b64_tr_b16 v[42:43], v14 offset:1024
    ds_read_b64_tr_b16 v[44:45], v14 offset:8192
    v_mfma_f32_16x16x32_bf16 v[224:227], v[48:51], v[96:99], v[224:227]
    ds_read_b64_tr_b16 v[46:47], v14 offset:9216
    v_mfma_f32_16x16x32_bf16 v[224:227], v[52:55], v[100:103], v[224:227]
    s_xor_b32 s65, s65, 8192
    v_mfma_f32_16x16x32_bf16 v[228:231], v[48:51], v[104:107], v[228:231]
    s_xor_b32 s66, s66, 128
    v_mfma_f32_16x16x32_bf16 v[228:231], v[52:55], v[108:111], v[228:231]
    v_mfma_f32_16x16x32_bf16 v[232:235], v[48:51], v[112:115], v[232:235]
    v_mfma_f32_16x16x32_bf16 v[232:235], v[52:55], v[116:119], v[232:235]
    v_mfma_f32_16x16x32_bf16 v[236:239], v[48:51], v[120:123], v[236:239]
    ds_read_b64_tr_b16 v[48:49], v15 offset:0
    ds_read_b64_tr_b16 v[50:51], v15 offset:1024
    v_mfma_f32_16x16x32_bf16 v[236:239], v[52:55], v[124:127], v[236:239]
    s_waitcnt lgkmcnt(2)
    ds_read_b64_tr_b16 v[52:53], v15 offset:8192
    ds_read_b64_tr_b16 v[54:55], v15 offset:9216
    v_mfma_f32_16x16x32_bf16 v[240:243], v[56:59], v[96:99], v[240:243]
    v_mfma_f32_16x16x32_bf16 v[240:243], v[60:63], v[100:103], v[240:243]
    v_mfma_f32_16x16x32_bf16 v[244:247], v[56:59], v[104:107], v[244:247]
    v_mfma_f32_16x16x32_bf16 v[244:247], v[60:63], v[108:111], v[244:247]
    v_mfma_f32_16x16x32_bf16 v[248:251], v[56:59], v[112:115], v[248:251]
    v_mfma_f32_16x16x32_bf16 v[248:251], v[60:63], v[116:119], v[248:251]
    v_mfma_f32_16x16x32_bf16 v[252:255], v[56:59], v[120:123], v[252:255]
    ds_read_b64_tr_b16 v[56:57], v16 offset:0
    ds_read_b64_tr_b16 v[58:59], v16 offset:1024
    v_mfma_f32_16x16x32_bf16 v[252:255], v[60:63], v[124:127], v[252:255]
    buffer_load_dword v7, v8, s[32:35], s61 offen sc1
    v_mfma_f32_16x16x32_bf16 v[128:131], v[40:43], v[64:67], v[128:131]
    ds_read_b64_tr_b16 v[60:61], v16 offset:8192
    ds_read_b64_tr_b16 v[62:63], v16 offset:9216
    v_mfma_f32_16x16x32_bf16 v[128:131], v[44:47], v[68:71], v[128:131]
    v_mfma_f32_16x16x32_bf16 v[132:135], v[40:43], v[72:75], v[132:135]
    v_mfma_f32_16x16x32_bf16 v[132:135], v[44:47], v[76:79], v[132:135]
    v_mfma_f32_16x16x32_bf16 v[136:139], v[40:43], v[80:83], v[136:139]
    v_mfma_f32_16x16x32_bf16 v[136:139], v[44:47], v[84:87], v[136:139]
    v_mfma_f32_16x16x32_bf16 v[140:143], v[40:43], v[88:91], v[140:143]
    ds_read_b64_tr_b16 v[40:41], v17 offset:0
    ds_read_b64_tr_b16 v[42:43], v17 offset:1024
    v_mfma_f32_16x16x32_bf16 v[140:143], v[44:47], v[92:95], v[140:143]
    s_waitcnt lgkmcnt(2)
    ds_read_b64_tr_b16 v[44:45], v17 offset:8192
    ds_read_b64_tr_b16 v[46:47], v17 offset:9216
    v_mfma_f32_16x16x32_bf16 v[144:147], v[48:51], v[64:67], v[144:147]
    v_cvt_pk_bf16_f32 v128, v128, v129
    v_cvt_pk_bf16_f32 v129, v130, v131
    v_mfma_f32_16x16x32_bf16 v[144:147], v[52:55], v[68:71], v[144:147]
    v_cvt_pk_bf16_f32 v132, v132, v133
    v_cvt_pk_bf16_f32 v133, v134, v135
    v_mfma_f32_16x16x32_bf16 v[148:151], v[48:51], v[72:75], v[148:151]
    v_cvt_pk_bf16_f32 v136, v136, v137
    v_cvt_pk_bf16_f32 v137, v138, v139
    v_mfma_f32_16x16x32_bf16 v[148:151], v[52:55], v[76:79], v[148:151]
    v_cvt_pk_bf16_f32 v140, v140, v141
    v_cvt_pk_bf16_f32 v141, v142, v143
    v_mfma_f32_16x16x32_bf16 v[152:155], v[48:51], v[80:83], v[152:155]
    v_cvt_pk_bf16_f32 v130, v144, v145
    v_cvt_pk_bf16_f32 v131, v146, v147
    v_mfma_f32_16x16x32_bf16 v[152:155], v[52:55], v[84:87], v[152:155]
    v_mfma_f32_16x16x32_bf16 v[156:159], v[48:51], v[88:91], v[156:159]
    ds_read_b64_tr_b16 v[48:49], v18 offset:0
    ds_read_b64_tr_b16 v[50:51], v18 offset:1024
    v_mfma_f32_16x16x32_bf16 v[156:159], v[52:55], v[92:95], v[156:159]
    ds_read_b64_tr_b16 v[52:53], v18 offset:8192
    ds_read_b64_tr_b16 v[54:55], v18 offset:9216
    v_mfma_f32_16x16x32_bf16 v[160:163], v[56:59], v[64:67], v[160:163]
    v_cvt_pk_bf16_f32 v134, v148, v149
    v_cvt_pk_bf16_f32 v135, v150, v151
    v_mfma_f32_16x16x32_bf16 v[160:163], v[60:63], v[68:71], v[160:163]
    v_cvt_pk_bf16_f32 v138, v152, v153
    v_cvt_pk_bf16_f32 v139, v154, v155
    v_mfma_f32_16x16x32_bf16 v[164:167], v[56:59], v[72:75], v[164:167]
    v_cvt_pk_bf16_f32 v142, v156, v157
    v_cvt_pk_bf16_f32 v143, v158, v159
    v_mfma_f32_16x16x32_bf16 v[164:167], v[60:63], v[76:79], v[164:167]
    v_mfma_f32_16x16x32_bf16 v[168:171], v[56:59], v[80:83], v[168:171]
    v_mfma_f32_16x16x32_bf16 v[168:171], v[60:63], v[84:87], v[168:171]
    v_cvt_pk_bf16_f32 v160, v160, v161
    v_cvt_pk_bf16_f32 v161, v162, v163
    v_mfma_f32_16x16x32_bf16 v[172:175], v[56:59], v[88:91], v[172:175]
    ds_read_b64_tr_b16 v[56:57], v19 offset:0
    ds_read_b64_tr_b16 v[58:59], v19 offset:1024
    v_mfma_f32_16x16x32_bf16 v[172:175], v[60:63], v[92:95], v[172:175]
    s_waitcnt lgkmcnt(2)
    ds_read_b64_tr_b16 v[60:61], v19 offset:8192
    ds_read_b64_tr_b16 v[62:63], v19 offset:9216
    v_mfma_f32_16x16x32_bf16 v[176:179], v[40:43], v[64:67], v[176:179]
    v_cvt_pk_bf16_f32 v164, v164, v165
    v_cvt_pk_bf16_f32 v165, v166, v167
    v_mfma_f32_16x16x32_bf16 v[176:179], v[44:47], v[68:71], v[176:179]
    v_cvt_pk_bf16_f32 v168, v168, v169
    v_cvt_pk_bf16_f32 v169, v170, v171
    v_mfma_f32_16x16x32_bf16 v[180:183], v[40:43], v[72:75], v[180:183]
    v_cvt_pk_bf16_f32 v172, v172, v173
    v_cvt_pk_bf16_f32 v173, v174, v175
    v_mfma_f32_16x16x32_bf16 v[180:183], v[44:47], v[76:79], v[180:183]
    v_mfma_f32_16x16x32_bf16 v[184:187], v[40:43], v[80:83], v[184:187]
    v_mfma_f32_16x16x32_bf16 v[184:187], v[44:47], v[84:87], v[184:187]
    v_cvt_pk_bf16_f32 v162, v176, v177
    v_cvt_pk_bf16_f32 v163, v178, v179
    v_mfma_f32_16x16x32_bf16 v[188:191], v[40:43], v[88:91], v[188:191]
    ds_read_b64_tr_b16 v[40:41], v20 offset:0
    ds_read_b64_tr_b16 v[42:43], v20 offset:1024
    v_mfma_f32_16x16x32_bf16 v[188:191], v[44:47], v[92:95], v[188:191]
    ds_read_b64_tr_b16 v[44:45], v20 offset:8192
    ds_read_b64_tr_b16 v[46:47], v20 offset:9216
    v_mfma_f32_16x16x32_bf16 v[192:195], v[48:51], v[64:67], v[192:195]
    v_cvt_pk_bf16_f32 v166, v180, v181
    v_cvt_pk_bf16_f32 v167, v182, v183
    v_mfma_f32_16x16x32_bf16 v[192:195], v[52:55], v[68:71], v[192:195]
    v_cvt_pk_bf16_f32 v170, v184, v185
    v_cvt_pk_bf16_f32 v171, v186, v187
    s_waitcnt vmcnt(0)
    v_cmp_gt_u32 vcc, 1, v7
    s_nop 1
    s_and_b64 vcc, vcc, exec
    s_cbranch_scc1 SPIN_KV
BACK_KV:
    v_mfma_f32_16x16x32_bf16 v[196:199], v[48:51], v[72:75], v[196:199]
    s_mov_b32 s77, s75
    buffer_load_dwordx4 a[224:227], v1, s[36:39], 0 offen offset:0 sc1
    v_mfma_f32_16x16x32_bf16 v[196:199], v[52:55], v[76:79], v[196:199]
    buffer_load_dwordx4 a[228:231], v1, s[36:39], 0 offen offset:1024 sc1
    v_mfma_f32_16x16x32_bf16 v[200:203], v[48:51], v[80:83], v[200:203]
    v_cmp_le_i32 vcc, 0, v36
    v_cvt_pk_bf16_f32 v192, v192, v193
    v_mfma_f32_16x16x32_bf16 v[200:203], v[52:55], v[84:87], v[200:203]
    v_cvt_pk_bf16_f32 v193, v194, v195
    v_cvt_pk_bf16_f32 v174, v188, v189
    v_mfma_f32_16x16x32_bf16 v[204:207], v[48:51], v[88:91], v[204:207]
    buffer_load_dwordx4 a[232:235], v1, s[36:39], 0 offen offset:2048 sc1
    v_mfma_f32_16x16x32_bf16 v[204:207], v[52:55], v[92:95], v[204:207]
    s_waitcnt lgkmcnt(0)
    ds_read_b64_tr_b16 v[48:49], v21 offset:0
    ds_read_b64_tr_b16 v[50:51], v21 offset:1024
    v_mfma_f32_16x16x32_bf16 v[208:211], v[56:59], v[64:67], v[208:211]
    ds_read_b64_tr_b16 v[52:53], v21 offset:8192
    ds_read_b64_tr_b16 v[54:55], v21 offset:9216
    v_mfma_f32_16x16x32_bf16 v[208:211], v[60:63], v[68:71], v[208:211]
    v_cvt_pk_bf16_f32 v196, v196, v197
    v_cvt_pk_bf16_f32 v197, v198, v199
    v_mfma_f32_16x16x32_bf16 v[212:215], v[56:59], v[72:75], v[212:215]
    buffer_load_dwordx4 a[236:239], v1, s[36:39], 0 offen offset:3072 sc1
    v_mfma_f32_16x16x32_bf16 v[212:215], v[60:63], v[76:79], v[212:215]
    v_cvt_pk_bf16_f32 v200, v200, v201
    v_cvt_pk_bf16_f32 v201, v202, v203
    v_mfma_f32_16x16x32_bf16 v[216:219], v[56:59], v[80:83], v[216:219]
    v_cvt_pk_bf16_f32 v194, v208, v209
    v_cndmask_b32_e64 v208, v37, 0, vcc
    v_mfma_f32_16x16x32_bf16 v[216:219], v[60:63], v[84:87], v[216:219]
    v_mul_f32 v176, s16, v208
    v_cmp_le_i32 vcc, 1, v36
    v_mfma_f32_16x16x32_bf16 v[220:223], v[56:59], v[88:91], v[220:223]
    v_cvt_pk_bf16_f32 v195, v210, v211
    v_cndmask_b32_e64 v209, v37, 0, vcc
    v_mfma_f32_16x16x32_bf16 v[220:223], v[60:63], v[92:95], v[220:223]
    v_mul_f32 v177, s16, v209
    v_cmp_le_i32 vcc, 2, v36
    v_mfma_f32_16x16x32_bf16 v[224:227], v[40:43], v[64:67], v[224:227]
    s_mov_b32 s38, 16384
    v_cndmask_b32_e64 v210, v37, 0, vcc
    v_mul_f32 v178, s16, v210
    v_mfma_f32_16x16x32_bf16 v[224:227], v[44:47], v[68:71], v[224:227]
    s_add_u32 m0, s76, s75
    v_cmp_le_i32 vcc, 3, v36
    v_cvt_pk_bf16_f32 v198, v212, v213
    v_mfma_f32_16x16x32_bf16 v[228:231], v[40:43], v[72:75], v[228:231]
    buffer_load_dwordx4 v1, s[36:39], s77 offen sc1 lds
    v_mfma_f32_16x16x32_bf16 v[228:231], v[44:47], v[76:79], v[228:231]
    v_cndmask_b32_e64 v211, v37, 0, vcc
    v_mul_f32 v179, s16, v211
    v_mfma_f32_16x16x32_bf16 v[232:235], v[40:43], v[80:83], v[232:235]
    v_cvt_pk_bf16_f32 v224, v224, v225
    v_cvt_pk_bf16_f32 v225, v226, v227
    v_mfma_f32_16x16x32_bf16 v[232:235], v[44:47], v[84:87], v[232:235]
    s_waitcnt vmcnt(6) lgkmcnt(0)
    s_barrier
    ds_read_b64_tr_b16 v[56:57], v26 offset:32768
    v_mfma_f32_16x16x32_bf16 v[236:239], v[40:43], v[88:91], v[236:239]
    buffer_load_dwordx4 v1, s[36:39], s77 offen offset:1024 sc1 lds
    v_mfma_f32_16x16x32_bf16 v[236:239], v[44:47], v[92:95], v[236:239]
    ds_read_b64_tr_b16 v[58:59], v26 offset:33280
    ds_read_b64_tr_b16 v[60:61], v26 offset:36864
    v_mfma_f32_16x16x32_bf16 v[240:243], v[48:51], v[64:67], v[240:243]
    ds_read_b64_tr_b16 v[62:63], v26 offset:37376
    ds_read_b128 a[136:139], v22 offset:32768
    v_mfma_f32_16x16x32_bf16 v[240:243], v[52:55], v[68:71], v[240:243]
    ds_read_b128 a[140:143], v23 offset:32768
    v_add_u32 v26, 0x10000, v26
    v_mfma_f32_16x16x32_bf16 v[244:247], v[48:51], v[72:75], v[244:247]
    buffer_load_dwordx4 v1, s[36:39], s77 offen offset:2048 sc1 lds
    v_mfma_f32_16x16x32_bf16 v[244:247], v[52:55], v[76:79], v[244:247]
    ds_read_b64_tr_b16 v[40:41], v27 offset:32768
    ds_read_b64_tr_b16 v[42:43], v27 offset:33280
    v_mfma_f32_16x16x32_bf16 v[248:251], v[48:51], v[80:83], v[248:251]
    ds_read_b64_tr_b16 v[44:45], v27 offset:36864
    ds_read_b64_tr_b16 v[46:47], v27 offset:37376
    v_mfma_f32_16x16x32_bf16 v[248:251], v[52:55], v[84:87], v[248:251]
    v_add_u32 v22, 0x10000, v22
    v_add_u32 v23, 0x10000, v23
    v_mfma_f32_16x16x32_bf16 v[252:255], v[48:51], v[88:91], v[252:255]
    buffer_load_dwordx4 v1, s[36:39], s77 offen offset:3072 sc1 lds
    v_mfma_f32_16x16x32_bf16 v[252:255], v[52:55], v[92:95], v[252:255]
    s_waitcnt lgkmcnt(4)
    ds_read_b64_tr_b16 v[48:49], v28 offset:32768
    ds_read_b64_tr_b16 v[50:51], v28 offset:33280
    v_mfma_f32_16x16x32_bf16 a[64:67], v[56:59], v[96:99], a[64:67]
    s_add_u32 s100, s77, 4096
    ds_read_b64_tr_b16 v[52:53], v28 offset:36864
    ds_read_b64_tr_b16 v[54:55], v28 offset:37376
    v_mfma_f32_16x16x32_bf16 a[64:67], v[60:63], v[100:103], a[64:67]
    s_add_u32 m0, m0, 4096
    v_add_u32 v27, 0x10000, v27
    v_add_u32 v28, 0x10000, v28
    v_mfma_f32_16x16x32_bf16 a[68:71], v[56:59], v[104:107], a[68:71]
    buffer_load_dwordx4 v1, s[36:39], s100 offen sc1 lds
    v_mfma_f32_16x16x32_bf16 a[68:71], v[60:63], v[108:111], a[68:71]
    v_cvt_pk_bf16_f32 v226, v240, v241
    v_cvt_pk_bf16_f32 v227, v242, v243
    v_mfma_f32_16x16x32_bf16 a[72:75], v[56:59], v[112:115], a[72:75]
    v_cvt_pk_bf16_f32 v228, v228, v229
    v_cvt_pk_bf16_f32 v229, v230, v231
    v_mfma_f32_16x16x32_bf16 a[72:75], v[60:63], v[116:119], a[72:75]
    v_cvt_pk_bf16_f32 v230, v244, v245
    v_cvt_pk_bf16_f32 v231, v246, v247
    v_mfma_f32_16x16x32_bf16 a[76:79], v[56:59], v[120:123], a[76:79]
    buffer_load_dwordx4 v1, s[36:39], s100 offen offset:1024 sc1 lds
    v_mfma_f32_16x16x32_bf16 a[76:79], v[60:63], v[124:127], a[76:79]
    v_cvt_pk_bf16_f32 v199, v214, v215
    v_cvt_pk_bf16_f32 v232, v232, v233
    v_mfma_f32_16x16x32_bf16 a[128:131], v[56:59], a[136:139], a[128:131]
    ds_read_b64_tr_b16 v[56:57], v29 offset:32768
    ds_read_b64_tr_b16 v[58:59], v29 offset:33280
    v_mfma_f32_16x16x32_bf16 a[128:131], v[60:63], a[140:143], a[128:131]
    s_waitcnt lgkmcnt(2)
    ds_read_b64_tr_b16 v[60:61], v29 offset:36864
    ds_read_b64_tr_b16 v[62:63], v29 offset:37376
    v_mfma_f32_16x16x32_bf16 a[80:83], v[40:43], v[96:99], a[80:83]
    buffer_load_dwordx4 v1, s[36:39], s100 offen offset:2048 sc1 lds
    v_mfma_f32_16x16x32_bf16 a[80:83], v[44:47], v[100:103], a[80:83]
    v_add_u32 v29, 0x10000, v29
    v_cvt_pk_bf16_f32 v233, v234, v235
    v_mfma_f32_16x16x32_bf16 a[84:87], v[40:43], v[104:107], a[84:87]
    v_cvt_pk_bf16_f32 v234, v248, v249
    v_cvt_pk_bf16_f32 v235, v250, v251
    v_mfma_f32_16x16x32_bf16 a[84:87], v[44:47], v[108:111], a[84:87]
    v_cvt_pk_bf16_f32 v202, v216, v217
    v_cvt_pk_bf16_f32 v203, v218, v219
    v_mfma_f32_16x16x32_bf16 a[88:91], v[40:43], v[112:115], a[88:91]
    buffer_load_dwordx4 v1, s[36:39], s100 offen offset:3072 sc1 lds
    v_mfma_f32_16x16x32_bf16 a[88:91], v[44:47], v[116:119], a[88:91]
    v_cvt_pk_bf16_f32 v175, v190, v191
    v_cvt_pk_bf16_f32 v236, v236, v237
    v_mfma_f32_16x16x32_bf16 a[92:95], v[40:43], v[120:123], a[92:95]
    s_lshr_b32 s82, s4, 1
    s_add_u32 s82, s82, 32
    v_cvt_pk_bf16_f32 v237, v238, v239
    v_mfma_f32_16x16x32_bf16 a[92:95], v[44:47], v[124:127], a[92:95]
    s_sub_u32 s82, s82, s6
    v_cvt_pk_bf16_f32 v238, v252, v253
    v_cvt_pk_bf16_f32 v239, v254, v255
    v_mfma_f32_16x16x32_bf16 a[132:135], v[40:43], a[136:139], a[132:135]
    s_add_u32 s76, s76, 32768
    s_sub_u32 s82, s82, s6
    ds_read_b64_tr_b16 v[40:41], v26 offset:0
    v_mfma_f32_16x16x32_bf16 a[132:135], v[44:47], a[140:143], a[132:135]
    s_add_u32 s77, s77, 32768
    s_lshl_b32 s38, s82, 15
    s_add_u32 m0, s76, s75
    v_mfma_f32_16x16x32_bf16 a[96:99], v[48:51], v[96:99], a[96:99]
    s_mov_b32 s82, 0
    buffer_load_dwordx4 v1, s[36:39], s77 offen sc1 lds
    v_mfma_f32_16x16x32_bf16 a[96:99], v[52:55], v[100:103], a[96:99]
    ds_read_b64_tr_b16 v[42:43], v26 offset:512
    ds_read_b64_tr_b16 v[44:45], v26 offset:4096
    v_mfma_f32_16x16x32_bf16 a[100:103], v[48:51], v[104:107], a[100:103]
    buffer_load_dwordx4 v1, s[36:39], s77 offen offset:1024 sc1 lds
    v_mfma_f32_16x16x32_bf16 a[100:103], v[52:55], v[108:111], a[100:103]
    ds_read_b64_tr_b16 v[46:47], v26 offset:4608
    ds_read_b128 a[136:139], v22 offset:0
    v_mfma_f32_16x16x32_bf16 a[104:107], v[48:51], v[112:115], a[104:107]
    ds_read_b128 a[140:143], v23 offset:0
    v_cvt_pk_bf16_f32 v204, v204, v205
    v_mfma_f32_16x16x32_bf16 a[104:107], v[52:55], v[116:119], a[104:107]
    v_cvt_pk_bf16_f32 v205, v206, v207
    v_cvt_pk_bf16_f32 v206, v220, v221
    v_mfma_f32_16x16x32_bf16 a[108:111], v[48:51], v[120:123], a[108:111]
    buffer_load_dwordx4 v1, s[36:39], s77 offen offset:2048 sc1 lds
    v_mfma_f32_16x16x32_bf16 a[108:111], v[52:55], v[124:127], a[108:111]
    s_waitcnt lgkmcnt(3)
    ds_read_b64_tr_b16 v[48:49], v27 offset:0
    ds_read_b64_tr_b16 v[50:51], v27 offset:512
    v_mfma_f32_16x16x32_bf16 a[112:115], v[56:59], v[96:99], a[112:115]
    ds_read_b64_tr_b16 v[52:53], v27 offset:4096
    ds_read_b64_tr_b16 v[54:55], v27 offset:4608
    v_mfma_f32_16x16x32_bf16 a[112:115], v[60:63], v[100:103], a[112:115]
    v_cvt_pk_bf16_f32 v207, v222, v223
    v_cmp_eq_u32 vcc, 0, v38
    v_mfma_f32_16x16x32_bf16 a[116:119], v[56:59], v[104:107], a[116:119]
    buffer_load_dwordx4 v1, s[36:39], s77 offen offset:3072 sc1 lds
    v_mfma_f32_16x16x32_bf16 a[116:119], v[60:63], v[108:111], a[116:119]
    v_mov_b32 v38, 0x3f803f80
    v_cndmask_b32 v38, 0, v38, vcc
    v_mfma_f32_16x16x32_bf16 a[120:123], v[56:59], v[112:115], a[120:123]
    s_add_u32 s100, s77, 4096
    v_mfma_f32_16x16x32_bf16 a[120:123], v[60:63], v[116:119], a[120:123]
    s_add_u32 m0, m0, 4096
    v_mfma_f32_16x16x32_bf16 a[124:127], v[56:59], v[120:123], a[124:127]
    buffer_load_dwordx4 v1, s[36:39], s100 offen sc1 lds
    v_mfma_f32_16x16x32_bf16 a[124:127], v[60:63], v[124:127], a[124:127]
    s_waitcnt vmcnt(13)
    ds_read_b64_tr_b16 v[56:57], v28 offset:0
    ds_read_b64_tr_b16 v[58:59], v28 offset:512
    v_mfma_f32_16x16x32_bf16 v[240:243], a[224:227], v[128:131], v[176:179]
    ds_read_b64_tr_b16 v[60:61], v28 offset:4096
    ds_read_b64_tr_b16 v[62:63], v28 offset:4608
    v_mfma_f32_16x16x32_bf16 v[240:243], a[228:231], v[160:163], v[240:243]
    v_mfma_f32_16x16x32_bf16 v[240:243], a[232:235], v[192:195], v[240:243]
    buffer_load_dwordx4 v1, s[36:39], s100 offen offset:1024 sc1 lds
    v_mfma_f32_16x16x32_bf16 v[240:243], a[236:239], v[224:227], v[240:243]
    v_mfma_f32_16x16x32_bf16 v[244:247], a[224:227], v[132:135], 0
    v_mfma_f32_16x16x32_bf16 v[244:247], a[228:231], v[164:167], v[244:247]
    v_mfma_f32_16x16x32_bf16 v[244:247], a[232:235], v[196:199], v[244:247]
    buffer_load_dwordx4 v1, s[36:39], s100 offen offset:2048 sc1 lds
    v_mfma_f32_16x16x32_bf16 v[244:247], a[236:239], v[228:231], v[244:247]
    v_mfma_f32_16x16x32_bf16 v[248:251], a[224:227], v[136:139], 0
    v_mfma_f32_16x16x32_bf16 v[248:251], a[228:231], v[168:171], v[248:251]
    v_mfma_f32_16x16x32_bf16 v[248:251], a[232:235], v[200:203], v[248:251]
    buffer_load_dwordx4 v1, s[36:39], s100 offen offset:3072 sc1 lds
    v_mfma_f32_16x16x32_bf16 v[248:251], a[236:239], v[232:235], v[248:251]
    v_max3_f32 v240, v240, v241, v242
    v_max_f32 v240, v240, v243
    v_mfma_f32_16x16x32_bf16 v[252:255], a[224:227], v[140:143], 0
    s_add_u32 s76, s76, 32768
    v_max3_f32 v244, v244, v245, v246
    v_max_f32 v244, v244, v247
    v_mfma_f32_16x16x32_bf16 v[252:255], a[228:231], v[172:175], v[252:255]
    s_add_u32 s77, s77, 32768
    v_max3_f32 v248, v248, v249, v250
    v_max_f32 v248, v248, v251
    v_mfma_f32_16x16x32_bf16 v[252:255], a[232:235], v[204:207], v[252:255]
    s_add_u32 m0, s76, s75
    v_mov_b32 v241, v240
    v_mov_b32 v245, v244
    v_mfma_f32_16x16x32_bf16 v[252:255], a[236:239], v[236:239], v[252:255]
    buffer_load_dwordx4 v1, s[36:39], s77 offen sc1 lds
    v_mfma_f32_16x16x32_bf16 a[64:67], v[40:43], v[64:67], a[64:67]
    s_waitcnt lgkmcnt(0)
    v_mov_b32 v249, v248
    v_permlane32_swap_b32 v240, v241
    v_mfma_f32_16x16x32_bf16 a[64:67], v[44:47], v[68:71], a[64:67]
    v_permlane32_swap_b32 v244, v245
    v_permlane32_swap_b32 v248, v249
    v_mfma_f32_16x16x32_bf16 a[68:71], v[40:43], v[72:75], a[68:71]
    buffer_load_dwordx4 v1, s[36:39], s77 offen offset:1024 sc1 lds
    v_mfma_f32_16x16x32_bf16 a[68:71], v[44:47], v[76:79], a[68:71]
    v_max3_f32 v252, v252, v253, v254
    v_max_f32 v252, v252, v255
    v_mfma_f32_16x16x32_bf16 a[72:75], v[40:43], v[80:83], a[72:75]
    v_mov_b32 v253, v252
    v_max_f32 v240, v240, v241
    v_mfma_f32_16x16x32_bf16 a[72:75], v[44:47], v[84:87], a[72:75]
    v_permlane32_swap_b32 v252, v253
    v_max_f32 v244, v244, v245
    v_mfma_f32_16x16x32_bf16 a[76:79], v[40:43], v[88:91], a[76:79]
    buffer_load_dwordx4 v1, s[36:39], s77 offen offset:2048 sc1 lds
    v_mfma_f32_16x16x32_bf16 a[76:79], v[44:47], v[92:95], a[76:79]
    v_max_f32 v248, v248, v249
    v_max_f32 v252, v252, v253
    v_mfma_f32_16x16x32_bf16 a[128:131], v[40:43], a[136:139], a[128:131]
    ds_read_b64_tr_b16 v[40:41], v29 offset:0
    ds_read_b64_tr_b16 v[42:43], v29 offset:512
    v_mfma_f32_16x16x32_bf16 a[128:131], v[44:47], a[140:143], a[128:131]
    ds_read_b64_tr_b16 v[44:45], v29 offset:4096
    ds_read_b64_tr_b16 v[46:47], v29 offset:4608
    v_mfma_f32_16x16x32_bf16 a[80:83], v[48:51], v[64:67], a[80:83]
    buffer_load_dwordx4 v1, s[36:39], s77 offen offset:3072 sc1 lds
    v_mfma_f32_16x16x32_bf16 a[80:83], v[52:55], v[68:71], a[80:83]
    v_mov_b32 v241, v240
    v_mov_b32 v245, v244
    v_mfma_f32_16x16x32_bf16 a[84:87], v[48:51], v[72:75], a[84:87]
    s_add_u32 s100, s77, 4096
    v_mov_b32 v249, v248
    v_mov_b32 v253, v252
    v_mfma_f32_16x16x32_bf16 a[84:87], v[52:55], v[76:79], a[84:87]
    s_add_u32 m0, m0, 4096
    v_permlane16_swap_b32 v240, v241
    v_permlane16_swap_b32 v244, v245
    v_mfma_f32_16x16x32_bf16 a[88:91], v[48:51], v[80:83], a[88:91]
    buffer_load_dwordx4 v1, s[36:39], s100 offen sc1 lds
    v_mfma_f32_16x16x32_bf16 a[88:91], v[52:55], v[84:87], a[88:91]
    v_permlane16_swap_b32 v248, v249
    v_permlane16_swap_b32 v252, v253
    v_mfma_f32_16x16x32_bf16 a[92:95], v[48:51], v[88:91], a[92:95]
    v_max_f32 v240, v240, v241
    v_max_f32 v244, v244, v245
    v_mfma_f32_16x16x32_bf16 a[92:95], v[52:55], v[92:95], a[92:95]
    v_max_f32 v248, v248, v249
    v_max_f32 v252, v252, v253
    v_mfma_f32_16x16x32_bf16 a[132:135], v[48:51], a[136:139], a[132:135]
    buffer_load_dwordx4 v1, s[36:39], s100 offen offset:1024 sc1 lds
    v_mfma_f32_16x16x32_bf16 a[132:135], v[52:55], a[140:143], a[132:135]
    v_sub_f32 v144, 0, v240
    v_sub_f32 v145, 0, v240
    v_mfma_f32_16x16x32_bf16 a[96:99], v[56:59], v[64:67], a[96:99]
    v_sub_f32 v146, 0, v240
    v_sub_f32 v147, 0, v240
    v_mfma_f32_16x16x32_bf16 a[96:99], v[60:63], v[68:71], a[96:99]
    v_sub_f32 v148, 0, v244
    v_sub_f32 v149, 0, v244
    v_mfma_f32_16x16x32_bf16 a[100:103], v[56:59], v[72:75], a[100:103]
    buffer_load_dwordx4 v1, s[36:39], s100 offen offset:2048 sc1 lds
    v_mfma_f32_16x16x32_bf16 a[100:103], v[60:63], v[76:79], a[100:103]
    v_sub_f32 v150, 0, v244
    v_sub_f32 v151, 0, v244
    v_mfma_f32_16x16x32_bf16 a[104:107], v[56:59], v[80:83], a[104:107]
    v_sub_f32 v152, 0, v248
    v_sub_f32 v153, 0, v248
    v_mfma_f32_16x16x32_bf16 a[104:107], v[60:63], v[84:87], a[104:107]
    v_sub_f32 v154, 0, v248
    v_sub_f32 v155, 0, v248
    v_mfma_f32_16x16x32_bf16 a[108:111], v[56:59], v[88:91], a[108:111]
    buffer_load_dwordx4 v1, s[36:39], s100 offen offset:3072 sc1 lds
    v_mfma_f32_16x16x32_bf16 a[108:111], v[60:63], v[92:95], a[108:111]
    s_waitcnt lgkmcnt(0)
    v_sub_f32 v156, 0, v252
    v_sub_f32 v157, 0, v252
    v_mfma_f32_16x16x32_bf16 a[112:115], v[40:43], v[64:67], a[112:115]
    s_add_u32 s77, s77, 32768
    v_sub_f32 v158, 0, v252
    v_sub_f32 v159, 0, v252
    v_mfma_f32_16x16x32_bf16 a[112:115], v[44:47], v[68:71], a[112:115]
    s_add_u32 s76, s76, 32768
    v_and_b32 v29, 0x380, v1
    v_lshl_add_u32 v29, v29, 4, v39
    v_mfma_f32_16x16x32_bf16 a[116:119], v[40:43], v[72:75], a[116:119]
    v_bfe_u32 v39, v1, 2, 4
    v_accvgpr_write_b32 a136, v38
    v_mfma_f32_16x16x32_bf16 a[116:119], v[44:47], v[76:79], a[116:119]
    v_accvgpr_write_b32 a137, v38
    v_accvgpr_write_b32 a138, v38
    v_mfma_f32_16x16x32_bf16 a[120:123], v[40:43], v[80:83], a[120:123]
    v_accvgpr_write_b32 a139, v38
    v_lshl_add_u32 v29, v29, 1, v39
    v_mfma_f32_16x16x32_bf16 a[120:123], v[44:47], v[84:87], a[120:123]
    s_waitcnt vmcnt(16) lgkmcnt(0)
    s_barrier
    v_mfma_f32_16x16x32_bf16 a[124:127], v[40:43], v[88:91], a[124:127]
    v_mfma_f32_16x16x32_bf16 a[124:127], v[44:47], v[92:95], a[124:127]
K1_ATT:
    v_add_f32 v212, s20, v144
    v_fma_f32 v176, v208, s16, v212
    v_fma_f32 v177, v209, s16, v212
    v_fma_f32 v178, v210, s16, v212
    v_fma_f32 v179, v211, s16, v212
    s_nop 1
    s_waitcnt lgkmcnt(0)
    v_mfma_f32_16x16x32_bf16 v[240:243], a[224:227], v[128:131], v[176:179]
    s_add_u32 m0, s76, s75
    ds_read_b128 a[240:243], v2 offset:4096
    ds_read_b128 a[244:247], v2 offset:5120
    v_mfma_f32_16x16x32_bf16 v[240:243], a[228:231], v[160:163], v[240:243]
    s_mov_b32 s76, s60
    buffer_load_dwordx4 v1, s[36:39], s77 offen sc1 lds
    v_mfma_f32_16x16x32_bf16 v[240:243], a[232:235], v[192:195], v[240:243]
    s_mov_b32 s60, s82
    ds_read_b128 a[248:251], v2 offset:6144
    ds_read_b128 a[252:255], v2 offset:7168
    v_mfma_f32_16x16x32_bf16 v[240:243], a[236:239], v[224:227], v[240:243]
    s_add_u32 s82, s82, 32768
    v_add_f32 v213, s21, v144
    v_fma_f32 v180, v208, s17, v213
    v_mfma_f32_16x16x32_bf16 v[244:247], a[224:227], v[132:135], v[148:151]
    s_sub_u32 s7, 15, s6
    v_fma_f32 v181, v209, s17, v213
    v_fma_f32 v182, v210, s17, v213
    v_mfma_f32_16x16x32_bf16 v[244:247], a[228:231], v[164:167], v[244:247]
    s_lshl3_add_u32 s80, s6, s4
    v_exp_f32 v240, v240
    v_mfma_f32_16x16x32_bf16 v[244:247], a[232:235], v[196:199], v[244:247]
    s_lshl3_add_u32 s81, s7, s4
    buffer_load_dwordx4 v1, s[36:39], s77 offen offset:1024 sc1 lds
    v_mfma_f32_16x16x32_bf16 v[244:247], a[236:239], v[228:231], v[244:247]
    s_mul_i32 s80, s80, 155648
    v_exp_f32 v241, v241
    v_mfma_f32_16x16x32_bf16 v[248:251], a[224:227], v[136:139], v[152:155]
    s_mul_i32 s81, s81, 155648
    v_exp_f32 v242, v242
    v_mfma_f32_16x16x32_bf16 v[248:251], a[228:231], v[168:171], v[248:251]
    s_lshl_b32 s7, s5, 12
    v_exp_f32 v243, v243
    v_mfma_f32_16x16x32_bf16 v[248:251], a[232:235], v[200:203], v[248:251]
    s_add_u32 s80, s80, s7
    v_fma_f32 v183, v211, s17, v213
    v_cvt_pk_bf16_f32 v32, v240, v241
    v_mfma_f32_16x16x32_bf16 v[248:251], a[236:239], v[232:235], v[248:251]
    s_add_u32 s81, s81, s7
    buffer_load_dwordx4 v1, s[36:39], s77 offen offset:2048 sc1 lds
    v_mfma_f32_16x16x32_bf16 v[252:255], a[224:227], v[140:143], v[156:159]
    s_lshr_b32 s7, s5, 3
    v_cvt_pk_bf16_f32 v33, v242, v243
    ds_read_b128 a[224:227], v2 offset:8192
    v_mfma_f32_16x16x32_bf16 v[252:255], a[228:231], v[172:175], v[252:255]
    s_lshl2_add_u32 s7, s7, s4
    v_exp_f32 v244, v244
    v_mfma_f32_16x16x32_bf16 v[252:255], a[232:235], v[204:207], v[252:255]
    s_lshl_b32 s7, s7, 8
    v_exp_f32 v245, v245
    v_mfma_f32_16x16x32_bf16 v[252:255], a[236:239], v[236:239], v[252:255]
    s_mov_b32 s42, 19922944
    v_exp_f32 v246, v246
    s_waitcnt lgkmcnt(1)
    v_mfma_f32_16x16x32_bf16 v[240:243], a[240:243], v[128:131], v[180:183]
    s_mov_b32 s43, 0x20000
    v_exp_f32 v247, v247
    v_mfma_f32_16x16x32_bf16 v[240:243], a[244:247], v[160:163], v[240:243]
    s_add_u32 s92, s7, 163840
    buffer_load_dwordx4 v1, s[36:39], s77 offen offset:3072 sc1 lds
    v_mfma_f32_16x16x32_bf16 v[240:243], a[248:251], v[192:195], v[240:243]
    s_mov_b64 s[24:25], s[0:1]
    v_cvt_pk_bf16_f32 v40, v244, v245
    v_cvt_pk_bf16_f32 v41, v246, v247
    v_mfma_f32_16x16x32_bf16 v[240:243], a[252:255], v[224:227], v[240:243]
    s_mov_b32 s78, s6
    v_exp_f32 v248, v248
    v_mfma_f32_16x16x32_bf16 v[244:247], a[240:243], v[132:135], v[148:151]
    s_mov_b32 s26, 2359296
    v_exp_f32 v249, v249
    v_mfma_f32_16x16x32_bf16 v[244:247], a[244:247], v[164:167], v[244:247]
    s_add_u32 s100, s77, 4096
    v_exp_f32 v250, v250
    v_mfma_f32_16x16x32_bf16 v[244:247], a[248:251], v[196:199], v[244:247]
    s_add_u32 m0, m0, 4096
    v_exp_f32 v251, v251
    v_mfma_f32_16x16x32_bf16 v[244:247], a[252:255], v[228:231], v[244:247]
    s_mov_b32 s27, 0x20000
    v_cvt_pk_bf16_f32 v48, v248, v249
    v_cvt_pk_bf16_f32 v49, v250, v251
    v_mfma_f32_16x16x32_bf16 v[248:251], a[240:243], v[136:139], v[152:155]
    buffer_load_dwordx4 v1, s[36:39], s100 offen sc1 lds
    v_mfma_f32_16x16x32_bf16 v[248:251], a[244:247], v[168:171], v[248:251]
    ds_read_b128 a[228:231], v2 offset:9216
    ds_read_b128 a[232:235], v2 offset:10240
    v_mfma_f32_16x16x32_bf16 v[248:251], a[248:251], v[200:203], v[248:251]
    v_exp_f32 v252, v252
    v_mfma_f32_16x16x32_bf16 v[248:251], a[252:255], v[232:235], v[248:251]
    v_exp_f32 v253, v253
    v_exp_f32 v254, v254
    v_exp_f32 v255, v255
    v_cvt_pk_bf16_f32 v56, v252, v253
    v_cvt_pk_bf16_f32 v57, v254, v255
    v_mfma_f32_16x16x32_bf16 v[252:255], a[240:243], v[140:143], v[156:159]
    ds_read_b128 a[236:239], v2 offset:11264
    v_add_f32 v214, s22, v144
    v_mfma_f32_16x16x32_bf16 v[252:255], a[244:247], v[172:175], v[252:255]
    buffer_load_dwordx4 v1, s[36:39], s100 offen offset:1024 sc1 lds
    v_mfma_f32_16x16x32_bf16 v[252:255], a[248:251], v[204:207], v[252:255]
    v_exp_f32 v240, v240
    v_mfma_f32_16x16x32_bf16 v[252:255], a[252:255], v[236:239], v[252:255]
    s_waitcnt lgkmcnt(1)
    v_exp_f32 v241, v241
    v_exp_f32 v242, v242
    v_exp_f32 v243, v243
    v_fma_f32 v184, v208, s18, v214
    v_fma_f32 v185, v209, s18, v214
    v_fma_f32 v186, v210, s18, v214
    v_fma_f32 v187, v211, s18, v214
    v_cvt_pk_bf16_f32 v34, v240, v241
    v_cvt_pk_bf16_f32 v35, v242, v243
    v_mfma_f32_16x16x32_bf16 v[240:243], a[224:227], v[128:131], v[184:187]
    v_exp_f32 v244, v244
    v_mfma_f32_16x16x32_bf16 v[240:243], a[228:231], v[160:163], v[240:243]
    v_exp_f32 v245, v245
    v_mfma_f32_16x16x32_bf16 v[240:243], a[232:235], v[192:195], v[240:243]
    s_waitcnt lgkmcnt(0)
    v_exp_f32 v246, v246
    v_mfma_f32_16x16x32_bf16 v[240:243], a[236:239], v[224:227], v[240:243]
    v_exp_f32 v247, v247
    v_cvt_pk_bf16_f32 v42, v244, v245
    v_cvt_pk_bf16_f32 v43, v246, v247
    v_mfma_f32_16x16x32_bf16 v[244:247], a[224:227], v[132:135], v[148:151]
    buffer_load_dwordx4 v1, s[36:39], s100 offen offset:2048 sc1 lds
    v_mfma_f32_16x16x32_bf16 v[244:247], a[228:231], v[164:167], v[244:247]
    v_exp_f32 v248, v248
    v_mfma_f32_16x16x32_bf16 v[244:247], a[232:235], v[196:199], v[244:247]
    v_exp_f32 v249, v249
    v_mfma_f32_16x16x32_bf16 v[244:247], a[236:239], v[228:231], v[244:247]
    v_exp_f32 v250, v250
    v_exp_f32 v251, v251
    v_cvt_pk_bf16_f32 v50, v248, v249
    v_cvt_pk_bf16_f32 v51, v250, v251
    v_mfma_f32_16x16x32_bf16 v[248:251], a[224:227], v[136:139], v[152:155]
    buffer_load_dwordx4 v1, s[36:39], s100 offen offset:3072 sc1 lds
    v_mfma_f32_16x16x32_bf16 v[248:251], a[228:231], v[168:171], v[248:251]
    ds_read_b128 a[240:243], v2 offset:12288
    ds_read_b128 a[244:247], v2 offset:13312
    v_mfma_f32_16x16x32_bf16 v[248:251], a[232:235], v[200:203], v[248:251]
    s_add_u32 s77, s77, 32768
    v_exp_f32 v252, v252
    v_mfma_f32_16x16x32_bf16 v[248:251], a[236:239], v[232:235], v[248:251]
    v_exp_f32 v253, v253
    v_exp_f32 v254, v254
    v_exp_f32 v255, v255
    v_cvt_pk_bf16_f32 v58, v252, v253
    v_cvt_pk_bf16_f32 v59, v254, v255
    v_mfma_f32_16x16x32_bf16 v[252:255], a[224:227], v[140:143], v[156:159]
    ds_read_b128 a[248:251], v2 offset:14336
    ds_read_b128 a[252:255], v2 offset:15360
    v_mfma_f32_16x16x32_bf16 v[252:255], a[228:231], v[172:175], v[252:255]
    v_add_f32 v215, s23, v144
    v_fma_f32 v188, v208, s19, v215
    v_mfma_f32_16x16x32_bf16 v[252:255], a[232:235], v[204:207], v[252:255]
    v_exp_f32 v240, v240
    v_mfma_f32_16x16x32_bf16 v[252:255], a[236:239], v[236:239], v[252:255]
    s_waitcnt lgkmcnt(2)
    v_exp_f32 v241, v241
    v_exp_f32 v242, v242
    v_exp_f32 v243, v243
    v_fma_f32 v189, v209, s19, v215
    v_fma_f32 v190, v210, s19, v215
    v_fma_f32 v191, v211, s19, v215
    v_cvt_pk_bf16_f32 v36, v240, v241
    v_cvt_pk_bf16_f32 v37, v242, v243
    v_mfma_f32_16x16x32_bf16 v[240:243], a[240:243], v[128:131], v[188:191]
    v_exp_f32 v244, v244
    v_mfma_f32_16x16x32_bf16 v[240:243], a[244:247], v[160:163], v[240:243]
    s_cmp_eq_u32 s82, 163840
    s_cselect_b32 s82, 0, s82
    v_add_u32 v2, s82, v1
    s_waitcnt lgkmcnt(0)
    v_mfma_f32_16x16x32_bf16 v[240:243], a[248:251], v[192:195], v[240:243]
    v_exp_f32 v245, v245
    v_mfma_f32_16x16x32_bf16 v[240:243], a[252:255], v[224:227], v[240:243]
    s_waitcnt vmcnt(8) lgkmcnt(0)
    s_barrier
    v_cvt_pk_bf16_f32 v44, v244, v245
    v_exp_f32 v246, v246
    v_exp_f32 v247, v247
    s_nop 0
    v_cvt_pk_bf16_f32 v45, v246, v247
    v_mfma_f32_16x16x32_bf16 v[244:247], a[240:243], v[132:135], v[148:151]
    ds_read_b128 a[224:227], v2 offset:0
    ds_read_b128 a[228:231], v2 offset:1024
    v_mfma_f32_16x16x32_bf16 v[244:247], a[244:247], v[164:167], v[244:247]
    v_exp_f32 v248, v248
    v_mfma_f32_16x16x32_bf16 v[244:247], a[248:251], v[196:199], v[244:247]
    v_exp_f32 v249, v249
    v_mfma_f32_16x16x32_bf16 v[244:247], a[252:255], v[228:231], v[244:247]
    v_exp_f32 v250, v250
    v_exp_f32 v251, v251
    v_cvt_pk_bf16_f32 v52, v248, v249
    v_cvt_pk_bf16_f32 v53, v250, v251
    v_mfma_f32_16x16x32_bf16 v[248:251], a[240:243], v[136:139], v[152:155]
    ds_read_b128 a[232:235], v2 offset:2048
    ds_read_b128 a[236:239], v2 offset:3072
    v_mfma_f32_16x16x32_bf16 v[248:251], a[244:247], v[168:171], v[248:251]
    ds_read_b128 v[96:99], v2 offset:16384
    v_mfma_f32_16x16x32_bf16 v[248:251], a[248:251], v[200:203], v[248:251]
    v_exp_f32 v252, v252
    v_mfma_f32_16x16x32_bf16 v[248:251], a[252:255], v[232:235], v[248:251]
    v_exp_f32 v253, v253
    v_exp_f32 v254, v254
    v_exp_f32 v255, v255
    v_cvt_pk_bf16_f32 v60, v252, v253
    v_cvt_pk_bf16_f32 v61, v254, v255
    v_mfma_f32_16x16x32_bf16 v[252:255], a[240:243], v[140:143], v[156:159]
    ds_read_b128 v[100:103], v2 offset:17408
    v_mfma_f32_16x16x32_bf16 v[252:255], a[244:247], v[172:175], v[252:255]
    v_exp_f32 v240, v240
    v_mfma_f32_16x16x32_bf16 v[252:255], a[248:251], v[204:207], v[252:255]
    s_sub_u32 s40, s56, 20971520
    s_subb_u32 s41, s57, 0
    v_mfma_f32_16x16x32_bf16 v[252:255], a[252:255], v[236:239], v[252:255]
    v_exp_f32 v241, v241
    v_exp_f32 v242, v242
    v_exp_f32 v243, v243
    v_exp_f32 v244, v244
    v_exp_f32 v245, v245
    v_exp_f32 v246, v246
    v_exp_f32 v247, v247
    v_exp_f32 v248, v248
    v_exp_f32 v249, v249
    v_exp_f32 v250, v250
    v_exp_f32 v251, v251
    v_exp_f32 v252, v252
    v_exp_f32 v253, v253
    v_cvt_pk_bf16_f32 v38, v240, v241
    v_cvt_pk_bf16_f32 v39, v242, v243
    v_cvt_pk_bf16_f32 v46, v244, v245
    v_cvt_pk_bf16_f32 v47, v246, v247
    v_cvt_pk_bf16_f32 v54, v248, v249
    v_cvt_pk_bf16_f32 v55, v250, v251
    v_cvt_pk_bf16_f32 v62, v252, v253
    s_cmp_eq_u32 s78, 0
    s_cbranch_scc1 K1_LB_END
.p2align 3
K1_LB:
    s_waitcnt lgkmcnt(0)
    v_mfma_f32_16x16x32_bf16 v[240:243], a[224:227], v[128:131], v[176:179]
    s_add_u32 m0, s76, s75
    v_exp_f32 v254, v254
    v_mfma_f32_16x16x32_bf16 v[240:243], a[228:231], v[160:163], v[240:243]
    s_mov_b32 s76, s60
    buffer_load_dwordx4 v1, s[36:39], s77 offen sc1 lds
    v_mfma_f32_16x16x32_bf16 v[240:243], a[232:235], v[192:195], v[240:243]
    s_mov_b32 s60, s82
    v_exp_f32 v255, v255
    v_mfma_f32_16x16x32_bf16 v[240:243], a[236:239], v[224:227], v[240:243]
    s_add_u32 s82, s82, 32768
    ds_read_b128 v[104:107], v2 offset:18432
    v_cvt_pk_bf16_f32 v63, v254, v255
    v_mfma_f32_16x16x32_bf16 a[0:3], v[96:99], v[32:35], a[0:3]
    ds_read_b128 v[108:111], v2 offset:19456
    ds_read_b128 a[240:243], v2 offset:4096
    v_mfma_f32_16x16x32_bf16 a[0:3], v[100:103], v[36:39], a[0:3]
    ds_read_b128 a[244:247], v2 offset:5120
    v_mfma_f32_16x16x32_bf16 a[4:7], v[96:99], v[40:43], a[4:7]
    v_exp_f32 v240, v240
    v_mfma_f32_16x16x32_bf16 a[4:7], v[100:103], v[44:47], a[4:7]
    ds_read_b128 a[248:251], v2 offset:6144
    ds_read_b128 a[252:255], v2 offset:7168
    v_mfma_f32_16x16x32_bf16 v[244:247], a[224:227], v[132:135], v[148:151]
    v_exp_f32 v241, v241
    v_mfma_f32_16x16x32_bf16 v[244:247], a[228:231], v[164:167], v[244:247]
    ds_read_b128 v[112:115], v2 offset:20480
    ds_read_b128 v[116:119], v2 offset:21504
    v_mfma_f32_16x16x32_bf16 v[244:247], a[232:235], v[196:199], v[244:247]
    v_exp_f32 v242, v242
    v_mfma_f32_16x16x32_bf16 v[244:247], a[236:239], v[228:231], v[244:247]
    v_exp_f32 v243, v243
    v_mfma_f32_16x16x32_bf16 a[8:11], v[96:99], v[48:51], a[8:11]
    v_cvt_pk_bf16_f32 v64, v240, v241
    v_cvt_pk_bf16_f32 v65, v242, v243
    v_mfma_f32_16x16x32_bf16 a[8:11], v[100:103], v[52:55], a[8:11]
    ds_read_b128 v[120:123], v2 offset:22528
    ds_read_b128 v[124:127], v2 offset:23552
    v_mfma_f32_16x16x32_bf16 a[12:15], v[96:99], v[56:59], a[12:15]
    v_exp_f32 v244, v244
    v_mfma_f32_16x16x32_bf16 a[12:15], v[100:103], v[60:63], a[12:15]
    buffer_load_dwordx4 v1, s[36:39], s77 offen offset:1024 sc1 lds
    v_mfma_f32_16x16x32_bf16 v[248:251], a[224:227], v[136:139], v[152:155]
    v_exp_f32 v245, v245
    v_mfma_f32_16x16x32_bf16 v[248:251], a[228:231], v[168:171], v[248:251]
    v_exp_f32 v246, v246
    v_mfma_f32_16x16x32_bf16 v[248:251], a[232:235], v[200:203], v[248:251]
    v_exp_f32 v247, v247
    v_mfma_f32_16x16x32_bf16 v[248:251], a[236:239], v[232:235], v[248:251]
    s_waitcnt lgkmcnt(0)
    v_cvt_pk_bf16_f32 v72, v244, v245
    v_cvt_pk_bf16_f32 v73, v246, v247
    v_mfma_f32_16x16x32_bf16 a[16:19], v[104:107], v[32:35], a[16:19]
    ds_read_b128 v[96:99], v2 offset:24576
    ds_read_b128 v[100:103], v2 offset:25600
    v_mfma_f32_16x16x32_bf16 a[16:19], v[108:111], v[36:39], a[16:19]
    v_mfma_f32_16x16x32_bf16 a[20:23], v[104:107], v[40:43], a[20:23]
    v_mfma_f32_16x16x32_bf16 a[20:23], v[108:111], v[44:47], a[20:23]
    v_exp_f32 v248, v248
    v_mfma_f32_16x16x32_bf16 v[252:255], a[224:227], v[140:143], v[156:159]
    v_exp_f32 v249, v249
    v_mfma_f32_16x16x32_bf16 v[252:255], a[228:231], v[172:175], v[252:255]
    v_exp_f32 v250, v250
    v_mfma_f32_16x16x32_bf16 v[252:255], a[232:235], v[204:207], v[252:255]
    v_exp_f32 v251, v251
    v_mfma_f32_16x16x32_bf16 v[252:255], a[236:239], v[236:239], v[252:255]
    v_cvt_pk_bf16_f32 v80, v248, v249
    v_cvt_pk_bf16_f32 v81, v250, v251
    v_mfma_f32_16x16x32_bf16 a[24:27], v[104:107], v[48:51], a[24:27]
    ds_read_b128 a[224:227], v2 offset:8192
    ds_read_b128 a[228:231], v2 offset:9216
    v_mfma_f32_16x16x32_bf16 a[24:27], v[108:111], v[52:55], a[24:27]
    buffer_load_dwordx4 v1, s[36:39], s77 offen offset:2048 sc1 lds
    v_mfma_f32_16x16x32_bf16 a[28:31], v[104:107], v[56:59], a[28:31]
    v_exp_f32 v252, v252
    v_mfma_f32_16x16x32_bf16 a[28:31], v[108:111], v[60:63], a[28:31]
    v_exp_f32 v253, v253
    v_mfma_f32_16x16x32_bf16 v[240:243], a[240:243], v[128:131], v[180:183]
    v_exp_f32 v254, v254
    v_mfma_f32_16x16x32_bf16 v[240:243], a[244:247], v[160:163], v[240:243]
    v_exp_f32 v255, v255
    v_mfma_f32_16x16x32_bf16 v[240:243], a[248:251], v[192:195], v[240:243]
    v_cvt_pk_bf16_f32 v88, v252, v253
    v_cvt_pk_bf16_f32 v89, v254, v255
    v_mfma_f32_16x16x32_bf16 v[240:243], a[252:255], v[224:227], v[240:243]
    ds_read_b128 a[232:235], v2 offset:10240
    ds_read_b128 a[236:239], v2 offset:11264
    v_mfma_f32_16x16x32_bf16 a[32:35], v[112:115], v[32:35], a[32:35]
    ds_read_b128 v[104:107], v2 offset:26624
    v_mfma_f32_16x16x32_bf16 a[32:35], v[116:119], v[36:39], a[32:35]
    ds_read_b128 v[108:111], v2 offset:27648
    v_mfma_f32_16x16x32_bf16 a[36:39], v[112:115], v[40:43], a[36:39]
    v_mfma_f32_16x16x32_bf16 a[36:39], v[116:119], v[44:47], a[36:39]
    v_exp_f32 v240, v240
    v_mfma_f32_16x16x32_bf16 v[244:247], a[240:243], v[132:135], v[148:151]
    v_exp_f32 v241, v241
    v_mfma_f32_16x16x32_bf16 v[244:247], a[244:247], v[164:167], v[244:247]
    v_exp_f32 v242, v242
    v_mfma_f32_16x16x32_bf16 v[244:247], a[248:251], v[196:199], v[244:247]
    v_exp_f32 v243, v243
    v_mfma_f32_16x16x32_bf16 v[244:247], a[252:255], v[228:231], v[244:247]
    buffer_load_dwordx4 v1, s[36:39], s77 offen offset:3072 sc1 lds
    v_mfma_f32_16x16x32_bf16 a[40:43], v[112:115], v[48:51], a[40:43]
    v_cvt_pk_bf16_f32 v66, v240, v241
    v_cvt_pk_bf16_f32 v67, v242, v243
    v_mfma_f32_16x16x32_bf16 a[40:43], v[116:119], v[52:55], a[40:43]
    v_mfma_f32_16x16x32_bf16 a[44:47], v[112:115], v[56:59], a[44:47]
    ds_read_b128 v[112:115], v2 offset:28672
    v_mfma_f32_16x16x32_bf16 a[44:47], v[116:119], v[60:63], a[44:47]
    v_exp_f32 v244, v244
    v_mfma_f32_16x16x32_bf16 v[248:251], a[240:243], v[136:139], v[152:155]
    v_exp_f32 v245, v245
    v_mfma_f32_16x16x32_bf16 v[248:251], a[244:247], v[168:171], v[248:251]
    v_exp_f32 v246, v246
    v_mfma_f32_16x16x32_bf16 v[248:251], a[248:251], v[200:203], v[248:251]
    v_exp_f32 v247, v247
    v_mfma_f32_16x16x32_bf16 v[248:251], a[252:255], v[232:235], v[248:251]
    v_cvt_pk_bf16_f32 v74, v244, v245
    v_cvt_pk_bf16_f32 v75, v246, v247
    v_mfma_f32_16x16x32_bf16 a[48:51], v[120:123], v[32:35], a[48:51]
    ds_read_b128 v[116:119], v2 offset:29696
    v_mfma_f32_16x16x32_bf16 a[48:51], v[124:127], v[36:39], a[48:51]
    v_mfma_f32_16x16x32_bf16 a[52:55], v[120:123], v[40:43], a[52:55]
    v_mfma_f32_16x16x32_bf16 a[52:55], v[124:127], v[44:47], a[52:55]
    v_mfma_f32_16x16x32_bf16 v[252:255], a[240:243], v[140:143], v[156:159]
    v_exp_f32 v248, v248
    v_mfma_f32_16x16x32_bf16 v[252:255], a[244:247], v[172:175], v[252:255]
    s_add_u32 s100, s77, 4096
    v_exp_f32 v249, v249
    v_mfma_f32_16x16x32_bf16 v[252:255], a[248:251], v[204:207], v[252:255]
    s_add_u32 m0, m0, 4096
    v_exp_f32 v250, v250
    v_mfma_f32_16x16x32_bf16 v[252:255], a[252:255], v[236:239], v[252:255]
    buffer_load_dwordx4 v1, s[36:39], s100 offen sc1 lds
    v_mfma_f32_16x16x32_bf16 a[56:59], v[120:123], v[48:51], a[56:59]
    v_exp_f32 v251, v251
    v_mfma_f32_16x16x32_bf16 a[56:59], v[124:127], v[52:55], a[56:59]
    v_cvt_pk_bf16_f32 v82, v248, v249
    v_cvt_pk_bf16_f32 v83, v250, v251
    v_mfma_f32_16x16x32_bf16 a[60:63], v[120:123], v[56:59], a[60:63]
    ds_read_b128 a[240:243], v2 offset:12288
    ds_read_b128 a[244:247], v2 offset:13312
    v_mfma_f32_16x16x32_bf16 a[60:63], v[124:127], v[60:63], a[60:63]
    s_waitcnt lgkmcnt(2)
    v_exp_f32 v252, v252
    v_mfma_f32_16x16x32_bf16 v[240:243], a[224:227], v[128:131], v[184:187]
    v_exp_f32 v253, v253
    v_mfma_f32_16x16x32_bf16 v[240:243], a[228:231], v[160:163], v[240:243]
    v_exp_f32 v254, v254
    v_mfma_f32_16x16x32_bf16 v[240:243], a[232:235], v[192:195], v[240:243]
    v_exp_f32 v255, v255
    v_mfma_f32_16x16x32_bf16 v[240:243], a[236:239], v[224:227], v[240:243]
    v_cvt_pk_bf16_f32 v90, v252, v253
    v_cvt_pk_bf16_f32 v91, v254, v255
    v_mfma_f32_16x16x32_bf16 a[144:147], v[96:99], v[32:35], a[144:147]
    ds_read_b128 a[248:251], v2 offset:14336
    ds_read_b128 a[252:255], v2 offset:15360
    v_mfma_f32_16x16x32_bf16 a[144:147], v[100:103], v[36:39], a[144:147]
    ds_read_b128 v[120:123], v2 offset:30720
    v_mfma_f32_16x16x32_bf16 a[148:151], v[96:99], v[40:43], a[148:151]
    v_exp_f32 v240, v240
    v_mfma_f32_16x16x32_bf16 a[148:151], v[100:103], v[44:47], a[148:151]
    v_exp_f32 v241, v241
    v_mfma_f32_16x16x32_bf16 v[244:247], a[224:227], v[132:135], v[148:151]
    buffer_load_dwordx4 v1, s[36:39], s100 offen offset:1024 sc1 lds
    v_mfma_f32_16x16x32_bf16 v[244:247], a[228:231], v[164:167], v[244:247]
    v_exp_f32 v242, v242
    v_mfma_f32_16x16x32_bf16 v[244:247], a[232:235], v[196:199], v[244:247]
    v_exp_f32 v243, v243
    v_mfma_f32_16x16x32_bf16 v[244:247], a[236:239], v[228:231], v[244:247]
    v_cvt_pk_bf16_f32 v68, v240, v241
    v_cvt_pk_bf16_f32 v69, v242, v243
    v_mfma_f32_16x16x32_bf16 a[152:155], v[96:99], v[48:51], a[152:155]
    ds_read_b128 v[124:127], v2 offset:31744
    v_mfma_f32_16x16x32_bf16 a[152:155], v[100:103], v[52:55], a[152:155]
    v_mfma_f32_16x16x32_bf16 a[156:159], v[96:99], v[56:59], a[156:159]
    v_mfma_f32_16x16x32_bf16 a[156:159], v[100:103], v[60:63], a[156:159]
    v_mfma_f32_16x16x32_bf16 v[248:251], a[224:227], v[136:139], v[152:155]
    v_exp_f32 v244, v244
    v_mfma_f32_16x16x32_bf16 v[248:251], a[228:231], v[168:171], v[248:251]
    v_exp_f32 v245, v245
    v_mfma_f32_16x16x32_bf16 v[248:251], a[232:235], v[200:203], v[248:251]
    v_exp_f32 v246, v246
    v_mfma_f32_16x16x32_bf16 v[248:251], a[236:239], v[232:235], v[248:251]
    v_exp_f32 v247, v247
    v_mfma_f32_16x16x32_bf16 a[160:163], v[104:107], v[32:35], a[160:163]
    v_cvt_pk_bf16_f32 v76, v244, v245
    v_cvt_pk_bf16_f32 v77, v246, v247
    v_mfma_f32_16x16x32_bf16 a[160:163], v[108:111], v[36:39], a[160:163]
    v_mfma_f32_16x16x32_bf16 a[164:167], v[104:107], v[40:43], a[164:167]
    buffer_load_dwordx4 v1, s[36:39], s100 offen offset:2048 sc1 lds
    v_mfma_f32_16x16x32_bf16 a[164:167], v[108:111], v[44:47], a[164:167]
    v_exp_f32 v248, v248
    v_mfma_f32_16x16x32_bf16 v[252:255], a[224:227], v[140:143], v[156:159]
    v_exp_f32 v249, v249
    v_mfma_f32_16x16x32_bf16 v[252:255], a[228:231], v[172:175], v[252:255]
    v_exp_f32 v250, v250
    v_mfma_f32_16x16x32_bf16 v[252:255], a[232:235], v[204:207], v[252:255]
    v_exp_f32 v251, v251
    v_mfma_f32_16x16x32_bf16 v[252:255], a[236:239], v[236:239], v[252:255]
    v_cvt_pk_bf16_f32 v84, v248, v249
    v_cvt_pk_bf16_f32 v85, v250, v251
    v_mfma_f32_16x16x32_bf16 a[168:171], v[104:107], v[48:51], a[168:171]
    v_mfma_f32_16x16x32_bf16 a[168:171], v[108:111], v[52:55], a[168:171]
    v_mfma_f32_16x16x32_bf16 a[172:175], v[104:107], v[56:59], a[172:175]
    v_mfma_f32_16x16x32_bf16 a[172:175], v[108:111], v[60:63], a[172:175]
    s_waitcnt lgkmcnt(0)
    v_mfma_f32_16x16x32_bf16 v[240:243], a[240:243], v[128:131], v[188:191]
    v_mfma_f32_16x16x32_bf16 v[240:243], a[244:247], v[160:163], v[240:243]
    v_exp_f32 v252, v252
    v_mfma_f32_16x16x32_bf16 v[240:243], a[248:251], v[192:195], v[240:243]
    v_exp_f32 v253, v253
    v_mfma_f32_16x16x32_bf16 v[240:243], a[252:255], v[224:227], v[240:243]
    v_exp_f32 v254, v254
    v_mfma_f32_16x16x32_bf16 a[176:179], v[112:115], v[32:35], a[176:179]
    buffer_load_dwordx4 v1, s[36:39], s100 offen offset:3072 sc1 lds
    v_mfma_f32_16x16x32_bf16 a[176:179], v[116:119], v[36:39], a[176:179]
    v_exp_f32 v255, v255
    v_mfma_f32_16x16x32_bf16 a[180:183], v[112:115], v[40:43], a[180:183]
    v_cvt_pk_bf16_f32 v92, v252, v253
    v_cvt_pk_bf16_f32 v93, v254, v255
    v_mfma_f32_16x16x32_bf16 a[180:183], v[116:119], v[44:47], a[180:183]
    s_cmp_eq_u32 s82, 163840
    s_cselect_b32 s82, 0, s82
    v_add_u32 v2, s82, v1
    v_mfma_f32_16x16x32_bf16 v[244:247], a[240:243], v[132:135], v[148:151]
    ds_read_b128 a[224:227], v2 offset:0
    ds_read_b128 a[228:231], v2 offset:1024
    v_mfma_f32_16x16x32_bf16 v[244:247], a[244:247], v[164:167], v[244:247]
    v_exp_f32 v240, v240
    v_mfma_f32_16x16x32_bf16 v[244:247], a[248:251], v[196:199], v[244:247]
    ds_read_b128 a[232:235], v2 offset:2048
    ds_read_b128 a[236:239], v2 offset:3072
    v_mfma_f32_16x16x32_bf16 v[244:247], a[252:255], v[228:231], v[244:247]
    v_exp_f32 v241, v241
    v_mfma_f32_16x16x32_bf16 a[184:187], v[112:115], v[48:51], a[184:187]
    ds_read_b128 v[96:99], v2 offset:16384
    ds_read_b128 v[100:103], v2 offset:17408
    v_mfma_f32_16x16x32_bf16 a[184:187], v[116:119], v[52:55], a[184:187]
    v_exp_f32 v242, v242
    v_mfma_f32_16x16x32_bf16 a[188:191], v[112:115], v[56:59], a[188:191]
    v_exp_f32 v243, v243
    v_mfma_f32_16x16x32_bf16 a[188:191], v[116:119], v[60:63], a[188:191]
    v_exp_f32 v244, v244
    v_mfma_f32_16x16x32_bf16 v[248:251], a[240:243], v[136:139], v[152:155]
    v_exp_f32 v245, v245
    v_mfma_f32_16x16x32_bf16 v[248:251], a[244:247], v[168:171], v[248:251]
    v_exp_f32 v246, v246
    v_mfma_f32_16x16x32_bf16 v[248:251], a[248:251], v[200:203], v[248:251]
    s_add_u32 s77, s77, 32768
    v_exp_f32 v247, v247
    v_mfma_f32_16x16x32_bf16 v[248:251], a[252:255], v[232:235], v[248:251]
    v_cvt_pk_bf16_f32 v70, v240, v241
    v_cvt_pk_bf16_f32 v71, v242, v243
    v_mfma_f32_16x16x32_bf16 a[192:195], v[120:123], v[32:35], a[192:195]
    v_cvt_pk_bf16_f32 v78, v244, v245
    v_cvt_pk_bf16_f32 v79, v246, v247
    v_mfma_f32_16x16x32_bf16 a[192:195], v[124:127], v[36:39], a[192:195]
    v_mfma_f32_16x16x32_bf16 a[196:199], v[120:123], v[40:43], a[196:199]
    v_mfma_f32_16x16x32_bf16 a[196:199], v[124:127], v[44:47], a[196:199]
    v_exp_f32 v248, v248
    v_mfma_f32_16x16x32_bf16 v[252:255], a[240:243], v[140:143], v[156:159]
    v_exp_f32 v249, v249
    v_mfma_f32_16x16x32_bf16 v[252:255], a[244:247], v[172:175], v[252:255]
    v_exp_f32 v250, v250
    v_mfma_f32_16x16x32_bf16 v[252:255], a[248:251], v[204:207], v[252:255]
    v_exp_f32 v251, v251
    v_mfma_f32_16x16x32_bf16 v[252:255], a[252:255], v[236:239], v[252:255]
    v_cvt_pk_bf16_f32 v86, v248, v249
    v_cvt_pk_bf16_f32 v87, v250, v251
    v_mfma_f32_16x16x32_bf16 a[200:203], v[120:123], v[48:51], a[200:203]
    v_mfma_f32_16x16x32_bf16 a[200:203], v[124:127], v[52:55], a[200:203]
    v_mfma_f32_16x16x32_bf16 a[204:207], v[120:123], v[56:59], a[204:207]
    v_mfma_f32_16x16x32_bf16 a[204:207], v[124:127], v[60:63], a[204:207]
    v_mfma_f32_16x16x32_bf16 a[208:211], a[136:139], v[32:35], a[208:211]
    v_mfma_f32_16x16x32_bf16 a[208:211], a[136:139], v[36:39], a[208:211]
    v_exp_f32 v252, v252
    v_mfma_f32_16x16x32_bf16 a[212:215], a[136:139], v[40:43], a[212:215]
    v_exp_f32 v253, v253
    v_mfma_f32_16x16x32_bf16 a[212:215], a[136:139], v[44:47], a[212:215]
    v_cvt_pk_bf16_f32 v94, v252, v253
    v_mfma_f32_16x16x32_bf16 a[216:219], a[136:139], v[48:51], a[216:219]
    v_mfma_f32_16x16x32_bf16 a[216:219], a[136:139], v[52:55], a[216:219]
    v_mfma_f32_16x16x32_bf16 a[220:223], a[136:139], v[56:59], a[220:223]
    v_mfma_f32_16x16x32_bf16 a[220:223], a[136:139], v[60:63], a[220:223]
    s_cmp_le_u32 s78, 1
    s_cbranch_scc1 K1_LB_MASK
K1_LB_BACK:
    s_waitcnt lgkmcnt(0)
    v_mfma_f32_16x16x32_bf16 v[240:243], a[224:227], v[128:131], v[176:179]
    s_add_u32 m0, s76, s75
    v_exp_f32 v254, v254
    v_mfma_f32_16x16x32_bf16 v[240:243], a[228:231], v[160:163], v[240:243]
    s_mov_b32 s76, s60
    buffer_load_dwordx4 v1, s[36:39], s77 offen sc1 lds
    v_mfma_f32_16x16x32_bf16 v[240:243], a[232:235], v[192:195], v[240:243]
    s_mov_b32 s60, s82
    v_exp_f32 v255, v255
    v_mfma_f32_16x16x32_bf16 v[240:243], a[236:239], v[224:227], v[240:243]
    s_add_u32 s82, s82, 32768
    ds_read_b128 v[104:107], v2 offset:18432
    v_cvt_pk_bf16_f32 v95, v254, v255
    v_mfma_f32_16x16x32_bf16 a[0:3], v[96:99], v[64:67], a[0:3]
    ds_read_b128 v[108:111], v2 offset:19456
    ds_read_b128 a[240:243], v2 offset:4096
    v_mfma_f32_16x16x32_bf16 a[0:3], v[100:103], v[68:71], a[0:3]
    ds_read_b128 a[244:247], v2 offset:5120
    v_mfma_f32_16x16x32_bf16 a[4:7], v[96:99], v[72:75], a[4:7]
    v_exp_f32 v240, v240
    v_mfma_f32_16x16x32_bf16 a[4:7], v[100:103], v[76:79], a[4:7]
    ds_read_b128 a[248:251], v2 offset:6144
    ds_read_b128 a[252:255], v2 offset:7168
    v_mfma_f32_16x16x32_bf16 v[244:247], a[224:227], v[132:135], v[148:151]
    v_exp_f32 v241, v241
    v_mfma_f32_16x16x32_bf16 v[244:247], a[228:231], v[164:167], v[244:247]
    ds_read_b128 v[112:115], v2 offset:20480
    ds_read_b128 v[116:119], v2 offset:21504
    v_mfma_f32_16x16x32_bf16 v[244:247], a[232:235], v[196:199], v[244:247]
    v_exp_f32 v242, v242
    v_mfma_f32_16x16x32_bf16 v[244:247], a[236:239], v[228:231], v[244:247]
    v_exp_f32 v243, v243
    v_mfma_f32_16x16x32_bf16 a[8:11], v[96:99], v[80:83], a[8:11]
    v_cvt_pk_bf16_f32 v32, v240, v241
    v_cvt_pk_bf16_f32 v33, v242, v243
    v_mfma_f32_16x16x32_bf16 a[8:11], v[100:103], v[84:87], a[8:11]
    ds_read_b128 v[120:123], v2 offset:22528
    ds_read_b128 v[124:127], v2 offset:23552
    v_mfma_f32_16x16x32_bf16 a[12:15], v[96:99], v[88:91], a[12:15]
    v_exp_f32 v244, v244
    v_mfma_f32_16x16x32_bf16 a[12:15], v[100:103], v[92:95], a[12:15]
    buffer_load_dwordx4 v1, s[36:39], s77 offen offset:1024 sc1 lds
    v_mfma_f32_16x16x32_bf16 v[248:251], a[224:227], v[136:139], v[152:155]
    v_exp_f32 v245, v245
    v_mfma_f32_16x16x32_bf16 v[248:251], a[228:231], v[168:171], v[248:251]
    v_exp_f32 v246, v246
    v_mfma_f32_16x16x32_bf16 v[248:251], a[232:235], v[200:203], v[248:251]
    v_exp_f32 v247, v247
    v_mfma_f32_16x16x32_bf16 v[248:251], a[236:239], v[232:235], v[248:251]
    s_waitcnt lgkmcnt(0)
    v_cvt_pk_bf16_f32 v40, v244, v245
    v_cvt_pk_bf16_f32 v41, v246, v247
    v_mfma_f32_16x16x32_bf16 a[16:19], v[104:107], v[64:67], a[16:19]
    ds_read_b128 v[96:99], v2 offset:24576
    ds_read_b128 v[100:103], v2 offset:25600
    v_mfma_f32_16x16x32_bf16 a[16:19], v[108:111], v[68:71], a[16:19]
    v_mfma_f32_16x16x32_bf16 a[20:23], v[104:107], v[72:75], a[20:23]
    v_mfma_f32_16x16x32_bf16 a[20:23], v[108:111], v[76:79], a[20:23]
    v_exp_f32 v248, v248
    v_mfma_f32_16x16x32_bf16 v[252:255], a[224:227], v[140:143], v[156:159]
    v_exp_f32 v249, v249
    v_mfma_f32_16x16x32_bf16 v[252:255], a[228:231], v[172:175], v[252:255]
    v_exp_f32 v250, v250
    v_mfma_f32_16x16x32_bf16 v[252:255], a[232:235], v[204:207], v[252:255]
    v_exp_f32 v251, v251
    v_mfma_f32_16x16x32_bf16 v[252:255], a[236:239], v[236:239], v[252:255]
    v_cvt_pk_bf16_f32 v48, v248, v249
    v_cvt_pk_bf16_f32 v49, v250, v251
    v_mfma_f32_16x16x32_bf16 a[24:27], v[104:107], v[80:83], a[24:27]
    ds_read_b128 a[224:227], v2 offset:8192
    ds_read_b128 a[228:231], v2 offset:9216
    v_mfma_f32_16x16x32_bf16 a[24:27], v[108:111], v[84:87], a[24:27]
    buffer_load_dwordx4 v1, s[36:39], s77 offen offset:2048 sc1 lds
    v_mfma_f32_16x16x32_bf16 a[28:31], v[104:107], v[88:91], a[28:31]
    v_exp_f32 v252, v252
    v_mfma_f32_16x16x32_bf16 a[28:31], v[108:111], v[92:95], a[28:31]
    v_exp_f32 v253, v253
    v_mfma_f32_16x16x32_bf16 v[240:243], a[240:243], v[128:131], v[180:183]
    v_exp_f32 v254, v254
    v_mfma_f32_16x16x32_bf16 v[240:243], a[244:247], v[160:163], v[240:243]
    v_exp_f32 v255, v255
    v_mfma_f32_16x16x32_bf16 v[240:243], a[248:251], v[192:195], v[240:243]
    v_cvt_pk_bf16_f32 v56, v252, v253
    v_cvt_pk_bf16_f32 v57, v254, v255
    v_mfma_f32_16x16x32_bf16 v[240:243], a[252:255], v[224:227], v[240:243]
    ds_read_b128 a[232:235], v2 offset:10240
    ds_read_b128 a[236:239], v2 offset:11264
    v_mfma_f32_16x16x32_bf16 a[32:35], v[112:115], v[64:67], a[32:35]
    ds_read_b128 v[104:107], v2 offset:26624
    v_mfma_f32_16x16x32_bf16 a[32:35], v[116:119], v[68:71], a[32:35]
    ds_read_b128 v[108:111], v2 offset:27648
    v_mfma_f32_16x16x32_bf16 a[36:39], v[112:115], v[72:75], a[36:39]
    v_mfma_f32_16x16x32_bf16 a[36:39], v[116:119], v[76:79], a[36:39]
    v_exp_f32 v240, v240
    v_mfma_f32_16x16x32_bf16 v[244:247], a[240:243], v[132:135], v[148:151]
    v_exp_f32 v241, v241
    v_mfma_f32_16x16x32_bf16 v[244:247], a[244:247], v[164:167], v[244:247]
    v_exp_f32 v242, v242
    v_mfma_f32_16x16x32_bf16 v[244:247], a[248:251], v[196:199], v[244:247]
    v_exp_f32 v243, v243
    v_mfma_f32_16x16x32_bf16 v[244:247], a[252:255], v[228:231], v[244:247]
    buffer_load_dwordx4 v1, s[36:39], s77 offen offset:3072 sc1 lds
    v_mfma_f32_16x16x32_bf16 a[40:43], v[112:115], v[80:83], a[40:43]
    v_cvt_pk_bf16_f32 v34, v240, v241
    v_cvt_pk_bf16_f32 v35, v242, v243
    v_mfma_f32_16x16x32_bf16 a[40:43], v[116:119], v[84:87], a[40:43]
    v_mfma_f32_16x16x32_bf16 a[44:47], v[112:115], v[88:91], a[44:47]
    ds_read_b128 v[112:115], v2 offset:28672
    v_mfma_f32_16x16x32_bf16 a[44:47], v[116:119], v[92:95], a[44:47]
    v_exp_f32 v244, v244
    v_mfma_f32_16x16x32_bf16 v[248:251], a[240:243], v[136:139], v[152:155]
    v_exp_f32 v245, v245
    v_mfma_f32_16x16x32_bf16 v[248:251], a[244:247], v[168:171], v[248:251]
    v_exp_f32 v246, v246
    v_mfma_f32_16x16x32_bf16 v[248:251], a[248:251], v[200:203], v[248:251]
    v_exp_f32 v247, v247
    v_mfma_f32_16x16x32_bf16 v[248:251], a[252:255], v[232:235], v[248:251]
    v_cvt_pk_bf16_f32 v42, v244, v245
    v_cvt_pk_bf16_f32 v43, v246, v247
    v_mfma_f32_16x16x32_bf16 a[48:51], v[120:123], v[64:67], a[48:51]
    ds_read_b128 v[116:119], v2 offset:29696
    v_mfma_f32_16x16x32_bf16 a[48:51], v[124:127], v[68:71], a[48:51]
    v_mfma_f32_16x16x32_bf16 a[52:55], v[120:123], v[72:75], a[52:55]
    v_mfma_f32_16x16x32_bf16 a[52:55], v[124:127], v[76:79], a[52:55]
    v_mfma_f32_16x16x32_bf16 v[252:255], a[240:243], v[140:143], v[156:159]
    v_exp_f32 v248, v248
    v_mfma_f32_16x16x32_bf16 v[252:255], a[244:247], v[172:175], v[252:255]
    s_add_u32 s100, s77, 4096
    v_exp_f32 v249, v249
    v_mfma_f32_16x16x32_bf16 v[252:255], a[248:251], v[204:207], v[252:255]
    s_add_u32 m0, m0, 4096
    v_exp_f32 v250, v250
    v_mfma_f32_16x16x32_bf16 v[252:255], a[252:255], v[236:239], v[252:255]
    buffer_load_dwordx4 v1, s[36:39], s100 offen sc1 lds
    v_mfma_f32_16x16x32_bf16 a[56:59], v[120:123], v[80:83], a[56:59]
    v_exp_f32 v251, v251
    v_mfma_f32_16x16x32_bf16 a[56:59], v[124:127], v[84:87], a[56:59]
    v_cvt_pk_bf16_f32 v50, v248, v249
    v_cvt_pk_bf16_f32 v51, v250, v251
    v_mfma_f32_16x16x32_bf16 a[60:63], v[120:123], v[88:91], a[60:63]
    ds_read_b128 a[240:243], v2 offset:12288
    ds_read_b128 a[244:247], v2 offset:13312
    v_mfma_f32_16x16x32_bf16 a[60:63], v[124:127], v[92:95], a[60:63]
    s_waitcnt lgkmcnt(2)
    v_exp_f32 v252, v252
    v_mfma_f32_16x16x32_bf16 v[240:243], a[224:227], v[128:131], v[184:187]
    v_exp_f32 v253, v253
    v_mfma_f32_16x16x32_bf16 v[240:243], a[228:231], v[160:163], v[240:243]
    v_exp_f32 v254, v254
    v_mfma_f32_16x16x32_bf16 v[240:243], a[232:235], v[192:195], v[240:243]
    v_exp_f32 v255, v255
    v_mfma_f32_16x16x32_bf16 v[240:243], a[236:239], v[224:227], v[240:243]
    v_cvt_pk_bf16_f32 v58, v252, v253
    v_cvt_pk_bf16_f32 v59, v254, v255
    v_mfma_f32_16x16x32_bf16 a[144:147], v[96:99], v[64:67], a[144:147]
    ds_read_b128 a[248:251], v2 offset:14336
    ds_read_b128 a[252:255], v2 offset:15360
    v_mfma_f32_16x16x32_bf16 a[144:147], v[100:103], v[68:71], a[144:147]
    ds_read_b128 v[120:123], v2 offset:30720
    v_mfma_f32_16x16x32_bf16 a[148:151], v[96:99], v[72:75], a[148:151]
    v_exp_f32 v240, v240
    v_mfma_f32_16x16x32_bf16 a[148:151], v[100:103], v[76:79], a[148:151]
    v_exp_f32 v241, v241
    v_mfma_f32_16x16x32_bf16 v[244:247], a[224:227], v[132:135], v[148:151]
    buffer_load_dwordx4 v1, s[36:39], s100 offen offset:1024 sc1 lds
    v_mfma_f32_16x16x32_bf16 v[244:247], a[228:231], v[164:167], v[244:247]
    v_exp_f32 v242, v242
    v_mfma_f32_16x16x32_bf16 v[244:247], a[232:235], v[196:199], v[244:247]
    v_exp_f32 v243, v243
    v_mfma_f32_16x16x32_bf16 v[244:247], a[236:239], v[228:231], v[244:247]
    v_cvt_pk_bf16_f32 v36, v240, v241
    v_cvt_pk_bf16_f32 v37, v242, v243
    v_mfma_f32_16x16x32_bf16 a[152:155], v[96:99], v[80:83], a[152:155]
    ds_read_b128 v[124:127], v2 offset:31744
    v_mfma_f32_16x16x32_bf16 a[152:155], v[100:103], v[84:87], a[152:155]
    v_mfma_f32_16x16x32_bf16 a[156:159], v[96:99], v[88:91], a[156:159]
    v_mfma_f32_16x16x32_bf16 a[156:159], v[100:103], v[92:95], a[156:159]
    v_mfma_f32_16x16x32_bf16 v[248:251], a[224:227], v[136:139], v[152:155]
    v_exp_f32 v244, v244
    v_mfma_f32_16x16x32_bf16 v[248:251], a[228:231], v[168:171], v[248:251]
    v_exp_f32 v245, v245
    v_mfma_f32_16x16x32_bf16 v[248:251], a[232:235], v[200:203], v[248:251]
    v_exp_f32 v246, v246
    v_mfma_f32_16x16x32_bf16 v[248:251], a[236:239], v[232:235], v[248:251]
    v_exp_f32 v247, v247
    v_mfma_f32_16x16x32_bf16 a[160:163], v[104:107], v[64:67], a[160:163]
    v_cvt_pk_bf16_f32 v44, v244, v245
    v_cvt_pk_bf16_f32 v45, v246, v247
    v_mfma_f32_16x16x32_bf16 a[160:163], v[108:111], v[68:71], a[160:163]
    v_mfma_f32_16x16x32_bf16 a[164:167], v[104:107], v[72:75], a[164:167]
    buffer_load_dwordx4 v1, s[36:39], s100 offen offset:2048 sc1 lds
    v_mfma_f32_16x16x32_bf16 a[164:167], v[108:111], v[76:79], a[164:167]
    v_exp_f32 v248, v248
    v_mfma_f32_16x16x32_bf16 v[252:255], a[224:227], v[140:143], v[156:159]
    v_exp_f32 v249, v249
    v_mfma_f32_16x16x32_bf16 v[252:255], a[228:231], v[172:175], v[252:255]
    v_exp_f32 v250, v250
    v_mfma_f32_16x16x32_bf16 v[252:255], a[232:235], v[204:207], v[252:255]
    v_exp_f32 v251, v251
    v_mfma_f32_16x16x32_bf16 v[252:255], a[236:239], v[236:239], v[252:255]
    v_cvt_pk_bf16_f32 v52, v248, v249
    v_cvt_pk_bf16_f32 v53, v250, v251
    v_mfma_f32_16x16x32_bf16 a[168:171], v[104:107], v[80:83], a[168:171]
    v_mfma_f32_16x16x32_bf16 a[168:171], v[108:111], v[84:87], a[168:171]
    v_mfma_f32_16x16x32_bf16 a[172:175], v[104:107], v[88:91], a[172:175]
    v_mfma_f32_16x16x32_bf16 a[172:175], v[108:111], v[92:95], a[172:175]
    s_waitcnt lgkmcnt(0)
    v_mfma_f32_16x16x32_bf16 v[240:243], a[240:243], v[128:131], v[188:191]
    v_mfma_f32_16x16x32_bf16 v[240:243], a[244:247], v[160:163], v[240:243]
    v_exp_f32 v252, v252
    v_mfma_f32_16x16x32_bf16 v[240:243], a[248:251], v[192:195], v[240:243]
    v_exp_f32 v253, v253
    v_mfma_f32_16x16x32_bf16 v[240:243], a[252:255], v[224:227], v[240:243]
    v_exp_f32 v254, v254
    v_mfma_f32_16x16x32_bf16 a[176:179], v[112:115], v[64:67], a[176:179]
    buffer_load_dwordx4 v1, s[36:39], s100 offen offset:3072 sc1 lds
    v_mfma_f32_16x16x32_bf16 a[176:179], v[116:119], v[68:71], a[176:179]
    v_exp_f32 v255, v255
    v_mfma_f32_16x16x32_bf16 a[180:183], v[112:115], v[72:75], a[180:183]
    v_cvt_pk_bf16_f32 v60, v252, v253
    v_cvt_pk_bf16_f32 v61, v254, v255
    v_mfma_f32_16x16x32_bf16 a[180:183], v[116:119], v[76:79], a[180:183]
    s_cmp_eq_u32 s82, 163840
    s_cselect_b32 s82, 0, s82
    v_add_u32 v2, s82, v1
    v_mfma_f32_16x16x32_bf16 v[244:247], a[240:243], v[132:135], v[148:151]
    v_exp_f32 v240, v240
    v_mfma_f32_16x16x32_bf16 v[244:247], a[244:247], v[164:167], v[244:247]
    v_exp_f32 v241, v241
    v_mfma_f32_16x16x32_bf16 v[244:247], a[248:251], v[196:199], v[244:247]
    v_exp_f32 v242, v242
    v_mfma_f32_16x16x32_bf16 v[244:247], a[252:255], v[228:231], v[244:247]
    v_exp_f32 v243, v243
    v_mfma_f32_16x16x32_bf16 a[184:187], v[112:115], v[80:83], a[184:187]
    v_cvt_pk_bf16_f32 v38, v240, v241
    v_cvt_pk_bf16_f32 v39, v242, v243
    v_mfma_f32_16x16x32_bf16 a[184:187], v[116:119], v[84:87], a[184:187]
    v_mfma_f32_16x16x32_bf16 a[188:191], v[112:115], v[88:91], a[188:191]
    v_mfma_f32_16x16x32_bf16 a[188:191], v[116:119], v[92:95], a[188:191]
    v_mfma_f32_16x16x32_bf16 v[248:251], a[240:243], v[136:139], v[152:155]
    v_exp_f32 v244, v244
    v_mfma_f32_16x16x32_bf16 v[248:251], a[244:247], v[168:171], v[248:251]
    v_exp_f32 v245, v245
    v_mfma_f32_16x16x32_bf16 v[248:251], a[248:251], v[200:203], v[248:251]
    s_add_u32 s77, s77, 32768
    v_exp_f32 v246, v246
    v_mfma_f32_16x16x32_bf16 v[248:251], a[252:255], v[232:235], v[248:251]
    v_exp_f32 v247, v247
    v_mfma_f32_16x16x32_bf16 a[192:195], v[120:123], v[64:67], a[192:195]
    v_cvt_pk_bf16_f32 v46, v244, v245
    v_cvt_pk_bf16_f32 v47, v246, v247
    v_mfma_f32_16x16x32_bf16 a[192:195], v[124:127], v[68:71], a[192:195]
    v_mfma_f32_16x16x32_bf16 a[196:199], v[120:123], v[72:75], a[196:199]
    v_mfma_f32_16x16x32_bf16 a[196:199], v[124:127], v[76:79], a[196:199]
    v_mfma_f32_16x16x32_bf16 v[252:255], a[240:243], v[140:143], v[156:159]
    v_exp_f32 v248, v248
    v_mfma_f32_16x16x32_bf16 v[252:255], a[244:247], v[172:175], v[252:255]
    v_exp_f32 v249, v249
    v_mfma_f32_16x16x32_bf16 v[252:255], a[248:251], v[204:207], v[252:255]
    v_exp_f32 v250, v250
    v_mfma_f32_16x16x32_bf16 v[252:255], a[252:255], v[236:239], v[252:255]
    s_waitcnt vmcnt(8) lgkmcnt(0)
    s_barrier
    ds_read_b128 a[224:227], v2 offset:0
    v_mfma_f32_16x16x32_bf16 a[200:203], v[120:123], v[80:83], a[200:203]
    ds_read_b128 a[228:231], v2 offset:1024
    ds_read_b128 a[232:235], v2 offset:2048
    v_mfma_f32_16x16x32_bf16 a[200:203], v[124:127], v[84:87], a[200:203]
    ds_read_b128 a[236:239], v2 offset:3072
    v_cvt_pk_bf16_f32 v54, v248, v249
    v_mfma_f32_16x16x32_bf16 a[204:207], v[120:123], v[88:91], a[204:207]
    v_exp_f32 v251, v251
    v_mfma_f32_16x16x32_bf16 a[204:207], v[124:127], v[92:95], a[204:207]
    ds_read_b128 v[96:99], v2 offset:16384
    ds_read_b128 v[100:103], v2 offset:17408
    v_mfma_f32_16x16x32_bf16 a[208:211], a[136:139], v[64:67], a[208:211]
    v_exp_f32 v252, v252
    v_mfma_f32_16x16x32_bf16 a[208:211], a[136:139], v[68:71], a[208:211]
    v_exp_f32 v253, v253
    v_mfma_f32_16x16x32_bf16 a[212:215], a[136:139], v[72:75], a[212:215]
    v_cvt_pk_bf16_f32 v55, v250, v251
    v_cvt_pk_bf16_f32 v62, v252, v253
    v_mfma_f32_16x16x32_bf16 a[212:215], a[136:139], v[76:79], a[212:215]
    v_mfma_f32_16x16x32_bf16 a[216:219], a[136:139], v[80:83], a[216:219]
    v_mfma_f32_16x16x32_bf16 a[216:219], a[136:139], v[84:87], a[216:219]
    v_mfma_f32_16x16x32_bf16 a[220:223], a[136:139], v[88:91], a[220:223]
    v_mfma_f32_16x16x32_bf16 a[220:223], a[136:139], v[92:95], a[220:223]
    s_sub_u32 s78, s78, 1
    s_cmp_lg_u32 s78, 0
    s_cbranch_scc1 K1_LB
K1_LB_END:
    v_add_f32 v212, s12, v148
    v_fma_f32 v176, v208, s8, v212
    v_fma_f32 v177, v209, s8, v212
    v_fma_f32 v178, v210, s8, v212
    v_fma_f32 v179, v211, s8, v212
    s_nop 1
    s_waitcnt lgkmcnt(0)
    v_mfma_f32_16x16x32_bf16 v[240:243], a[224:227], v[132:135], v[176:179]
    s_mov_b32 s7, 0
    ds_read_b128 v[104:107], v2 offset:18432
    ds_read_b128 v[108:111], v2 offset:19456
    v_mfma_f32_16x16x32_bf16 v[240:243], a[228:231], v[164:167], v[240:243]
    s_lshl_b32 s29, s6, 2
    buffer_load_dwordx4 v[64:67], v11, s[48:51], s7 offen nt
    v_mfma_f32_16x16x32_bf16 v[240:243], a[232:235], v[196:199], v[240:243]
    s_mov_b32 s7, 18432
    v_exp_f32 v254, v254
    v_mfma_f32_16x16x32_bf16 v[240:243], a[236:239], v[228:231], v[240:243]
    s_lshr_b32 s29, 0x41302413, s29
    v_exp_f32 v255, v255
    v_mfma_f32_16x16x32_bf16 a[0:3], v[96:99], v[32:35], a[0:3]
    s_and_b32 s29, s29, 7
    v_cvt_pk_bf16_f32 v63, v254, v255
    ds_read_b128 a[240:243], v2 offset:4096
    v_mfma_f32_16x16x32_bf16 a[0:3], v[100:103], v[36:39], a[0:3]
    s_lshl_b32 s29, s29, 15
    buffer_load_dwordx4 v[68:71], v11, s[48:51], s7 offen nt
    v_mfma_f32_16x16x32_bf16 a[4:7], v[96:99], v[40:43], a[4:7]
    s_mov_b32 s7, 9216
    ds_read_b128 a[244:247], v2 offset:5120
    ds_read_b128 a[248:251], v2 offset:6144
    v_mfma_f32_16x16x32_bf16 a[4:7], v[100:103], v[44:47], a[4:7]
    s_add_u32 s44, s29, s75
    ds_read_b128 a[252:255], v2 offset:7168
    v_add_f32 v213, s13, v148
    v_mfma_f32_16x16x32_bf16 v[244:247], a[224:227], v[136:139], v[152:155]
    s_lshl_b32 s29, s6, 2
    ds_read_b128 v[112:115], v2 offset:20480
    v_fma_f32 v180, v208, s9, v213
    v_mfma_f32_16x16x32_bf16 v[244:247], a[228:231], v[168:171], v[244:247]
    s_lshr_b32 s29, 0x2413024, s29
    buffer_load_dwordx4 v[20:23], v11, s[48:51], s7 offen nt
    v_mfma_f32_16x16x32_bf16 v[244:247], a[232:235], v[200:203], v[244:247]
    s_mov_b32 s7, 27648
    ds_read_b128 v[116:119], v2 offset:21504
    v_fma_f32 v181, v209, s9, v213
    v_mfma_f32_16x16x32_bf16 v[244:247], a[236:239], v[232:235], v[244:247]
    s_and_b32 s29, s29, 7
    v_fma_f32 v182, v210, s9, v213
    v_fma_f32 v183, v211, s9, v213
    v_mfma_f32_16x16x32_bf16 a[8:11], v[96:99], v[48:51], a[8:11]
    s_lshl_b32 s29, s29, 15
    v_exp_f32 v240, v240
    v_mfma_f32_16x16x32_bf16 a[8:11], v[100:103], v[52:55], a[8:11]
    s_add_u32 s45, s29, s75
    buffer_load_dwordx4 v[24:27], v11, s[48:51], s7 offen nt
    v_mfma_f32_16x16x32_bf16 a[12:15], v[96:99], v[56:59], a[12:15]
    s_lshl_b32 s29, s6, 2
    v_exp_f32 v241, v241
    v_mfma_f32_16x16x32_bf16 a[12:15], v[100:103], v[60:63], a[12:15]
    s_lshr_b32 s29, 0x13024130, s29
    v_exp_f32 v242, v242
    s_waitcnt lgkmcnt(0)
    v_mfma_f32_16x16x32_bf16 a[16:19], v[104:107], v[32:35], a[16:19]
    s_and_b32 s29, s29, 7
    v_exp_f32 v243, v243
    v_mfma_f32_16x16x32_bf16 a[16:19], v[108:111], v[36:39], a[16:19]
    s_lshl_b32 s29, s29, 15
    buffer_load_dwordx4 v[144:147], v12, s[52:55], 0 offen nt
    v_mfma_f32_16x16x32_bf16 v[248:251], a[224:227], v[140:143], v[156:159]
    s_add_u32 s46, s29, s75
    v_cvt_pk_bf16_f32 v72, v240, v241
    v_cvt_pk_bf16_f32 v73, v242, v243
    v_mfma_f32_16x16x32_bf16 v[248:251], a[228:231], v[172:175], v[248:251]
    s_lshl_b32 s29, s6, 2
    ds_read_b128 v[120:123], v2 offset:22528
    ds_read_b128 v[124:127], v2 offset:23552
    v_mfma_f32_16x16x32_bf16 v[248:251], a[232:235], v[204:207], v[248:251]
    s_lshr_b32 s29, 0x24130241, s29
    v_exp_f32 v244, v244
    v_mfma_f32_16x16x32_bf16 v[248:251], a[236:239], v[236:239], v[248:251]
    s_and_b32 s29, s29, 7
    buffer_load_dwordx4 a[140:143], v13, s[52:55], 0 offen nt
    v_mfma_f32_16x16x32_bf16 a[20:23], v[104:107], v[40:43], a[20:23]
    s_lshl_b32 s29, s29, 15
    v_exp_f32 v245, v245
    v_mfma_f32_16x16x32_bf16 a[20:23], v[108:111], v[44:47], a[20:23]
    s_mov_b32 s98, 0x3fb8aa3b
    v_exp_f32 v246, v246
    v_mfma_f32_16x16x32_bf16 a[24:27], v[104:107], v[48:51], a[24:27]
    s_add_u32 s47, s29, s75
    v_exp_f32 v247, v247
    v_mfma_f32_16x16x32_bf16 a[24:27], v[108:111], v[52:55], a[24:27]
    s_lshl_b32 s29, s6, 2
    v_cvt_pk_bf16_f32 v80, v244, v245
    v_cvt_pk_bf16_f32 v81, v246, v247
    v_mfma_f32_16x16x32_bf16 a[28:31], v[104:107], v[56:59], a[28:31]
    s_lshr_b32 s29, 0x30241302, s29
    ds_read_b128 a[224:227], v2 offset:8192
    ds_read_b128 a[228:231], v2 offset:9216
    v_mfma_f32_16x16x32_bf16 a[28:31], v[108:111], v[60:63], a[28:31]
    s_lshr_b32 s61, s5, 3
    ds_read_b128 a[232:235], v2 offset:10240
    v_add_f32 v214, s14, v148
    v_mfma_f32_16x16x32_bf16 v[252:255], a[240:243], v[132:135], v[180:183]
    s_add_u32 s3, s5, s6
    ds_read_b128 a[236:239], v2 offset:11264
    v_fma_f32 v184, v208, s10, v214
    v_mfma_f32_16x16x32_bf16 v[252:255], a[244:247], v[164:167], v[252:255]
    s_and_b32 s29, s29, 7
    ds_read_b128 v[96:99], v2 offset:24576
    v_fma_f32 v185, v209, s10, v214
    v_mfma_f32_16x16x32_bf16 v[252:255], a[248:251], v[196:199], v[252:255]
    s_and_b32 s28, s5, 3
    ds_read_b128 v[100:103], v2 offset:25600
    v_fma_f32 v186, v210, s10, v214
    v_mfma_f32_16x16x32_bf16 v[252:255], a[252:255], v[228:231], v[252:255]
    s_and_b32 s3, s3, 3
    v_exp_f32 v248, v248
    v_mfma_f32_16x16x32_bf16 a[32:35], v[112:115], v[32:35], a[32:35]
    s_lshl_b32 s29, s29, 15
    v_exp_f32 v249, v249
    v_mfma_f32_16x16x32_bf16 a[32:35], v[116:119], v[36:39], a[32:35]
    s_lshl2_add_u32 s66, s6, s61
    v_exp_f32 v250, v250
    v_mfma_f32_16x16x32_bf16 a[36:39], v[112:115], v[40:43], a[36:39]
    s_mul_i32 s71, s5, 768
    v_exp_f32 v251, v251
    v_mfma_f32_16x16x32_bf16 a[36:39], v[116:119], v[44:47], a[36:39]
    s_mul_i32 s28, s28, 9216
    v_fma_f32 v187, v211, s10, v214
    v_cvt_pk_bf16_f32 v88, v248, v249
    v_mfma_f32_16x16x32_bf16 v[240:243], a[240:243], v[136:139], v[152:155]
    s_lshl3_add_u32 s3, s61, s3
    v_cvt_pk_bf16_f32 v89, v250, v251
    ds_read_b128 v[104:107], v2 offset:26624
    v_mfma_f32_16x16x32_bf16 v[240:243], a[244:247], v[168:171], v[240:243]
    s_add_u32 s79, s29, s75
    v_exp_f32 v252, v252
    v_mfma_f32_16x16x32_bf16 v[240:243], a[248:251], v[200:203], v[240:243]
    s_lshl_b32 s66, s66, 10
    v_exp_f32 v253, v253
    v_mfma_f32_16x16x32_bf16 v[240:243], a[252:255], v[232:235], v[240:243]
    s_add_u32 s71, s71, 131072
    v_exp_f32 v254, v254
    v_mfma_f32_16x16x32_bf16 a[40:43], v[112:115], v[48:51], a[40:43]
    v_exp_f32 v255, v255
    v_mfma_f32_16x16x32_bf16 a[40:43], v[116:119], v[52:55], a[40:43]
    v_cvt_pk_bf16_f32 v74, v252, v253
    v_cvt_pk_bf16_f32 v75, v254, v255
    v_mfma_f32_16x16x32_bf16 a[44:47], v[112:115], v[56:59], a[44:47]
    ds_read_b128 v[108:111], v2 offset:27648
    ds_read_b128 v[112:115], v2 offset:28672
    v_mfma_f32_16x16x32_bf16 a[44:47], v[116:119], v[60:63], a[44:47]
    s_waitcnt lgkmcnt(2)
    v_exp_f32 v240, v240
    v_mfma_f32_16x16x32_bf16 a[48:51], v[120:123], v[32:35], a[48:51]
    v_exp_f32 v241, v241
    v_mfma_f32_16x16x32_bf16 a[48:51], v[124:127], v[36:39], a[48:51]
    v_exp_f32 v242, v242
    v_mfma_f32_16x16x32_bf16 v[244:247], a[240:243], v[140:143], v[156:159]
    v_exp_f32 v243, v243
    v_mfma_f32_16x16x32_bf16 v[244:247], a[244:247], v[172:175], v[244:247]
    v_cvt_pk_bf16_f32 v82, v240, v241
    v_cvt_pk_bf16_f32 v83, v242, v243
    v_mfma_f32_16x16x32_bf16 v[244:247], a[248:251], v[204:207], v[244:247]
    ds_read_b128 a[240:243], v2 offset:12288
    ds_read_b128 a[244:247], v2 offset:13312
    v_mfma_f32_16x16x32_bf16 v[244:247], a[252:255], v[236:239], v[244:247]
    ds_read_b128 a[248:251], v2 offset:14336
    v_add_f32 v215, s15, v148
    v_mfma_f32_16x16x32_bf16 a[52:55], v[120:123], v[40:43], a[52:55]
    ds_read_b128 a[252:255], v2 offset:15360
    v_fma_f32 v188, v208, s11, v215
    v_mfma_f32_16x16x32_bf16 a[52:55], v[124:127], v[44:47], a[52:55]
    ds_read_b128 v[116:119], v2 offset:29696
    v_fma_f32 v189, v209, s11, v215
    v_mfma_f32_16x16x32_bf16 a[56:59], v[120:123], v[48:51], a[56:59]
    v_exp_f32 v244, v244
    v_mfma_f32_16x16x32_bf16 a[56:59], v[124:127], v[52:55], a[56:59]
    v_exp_f32 v245, v245
    v_mfma_f32_16x16x32_bf16 a[60:63], v[120:123], v[56:59], a[60:63]
    v_exp_f32 v246, v246
    v_mfma_f32_16x16x32_bf16 a[60:63], v[124:127], v[60:63], a[60:63]
    v_exp_f32 v247, v247
    v_mfma_f32_16x16x32_bf16 v[248:251], a[224:227], v[132:135], v[184:187]
    v_fma_f32 v190, v210, s11, v215
    v_fma_f32 v191, v211, s11, v215
    v_mfma_f32_16x16x32_bf16 v[248:251], a[228:231], v[164:167], v[248:251]
    v_cvt_pk_bf16_f32 v90, v244, v245
    v_cvt_pk_bf16_f32 v91, v246, v247
    v_mfma_f32_16x16x32_bf16 v[248:251], a[232:235], v[196:199], v[248:251]
    ds_read_b128 v[120:123], v2 offset:30720
    ds_read_b128 v[124:127], v2 offset:31744
    v_mfma_f32_16x16x32_bf16 v[248:251], a[236:239], v[228:231], v[248:251]
    s_add_u32 m0, s76, s75
    v_bfe_u32 v8, v1, 2, 6
    v_accvgpr_read_b32 v4, a112
    v_mfma_f32_16x16x32_bf16 a[144:147], v[96:99], v[32:35], a[144:147]
    s_mov_b32 s76, s60
    buffer_load_dwordx4 v1, s[36:39], s77 offen sc1 lds
    v_mfma_f32_16x16x32_bf16 a[144:147], v[100:103], v[36:39], a[144:147]
    s_mov_b32 s60, s82
    v_exp_f32 v248, v248
    v_mfma_f32_16x16x32_bf16 a[148:151], v[96:99], v[40:43], a[148:151]
    s_add_u32 s82, s82, 32768
    v_exp_f32 v249, v249
    v_mfma_f32_16x16x32_bf16 a[148:151], v[100:103], v[44:47], a[148:151]
    v_exp_f32 v250, v250
    v_mfma_f32_16x16x32_bf16 v[252:255], a[224:227], v[136:139], v[152:155]
    v_exp_f32 v251, v251
    v_mfma_f32_16x16x32_bf16 v[252:255], a[228:231], v[168:171], v[252:255]
    v_cvt_pk_bf16_f32 v76, v248, v249
    v_cvt_pk_bf16_f32 v77, v250, v251
    v_mfma_f32_16x16x32_bf16 v[252:255], a[232:235], v[200:203], v[252:255]
    s_cmp_eq_u32 s82, 163840
    s_cselect_b32 s82, 0, s82
    v_add_u32 v2, s82, v1
    v_mfma_f32_16x16x32_bf16 v[252:255], a[236:239], v[232:235], v[252:255]
    buffer_load_dwordx4 v1, s[36:39], s77 offen offset:1024 sc1 lds
    v_mfma_f32_16x16x32_bf16 a[152:155], v[96:99], v[48:51], a[152:155]
    v_accvgpr_read_b32 v5, a116
    v_add_u32 v8, 192, v8
    v_mfma_f32_16x16x32_bf16 a[152:155], v[100:103], v[52:55], a[152:155]
    v_cvt_pk_bf16_f32 v4, 0, v4
    v_cvt_pk_bf16_f32 v5, 0, v5
    v_mfma_f32_16x16x32_bf16 a[156:159], v[96:99], v[56:59], a[156:159]
    v_exp_f32 v252, v252
    v_mfma_f32_16x16x32_bf16 a[156:159], v[100:103], v[60:63], a[156:159]
    v_exp_f32 v253, v253
    v_mfma_f32_16x16x32_bf16 a[160:163], v[104:107], v[32:35], a[160:163]
    s_waitcnt lgkmcnt(0)
    v_exp_f32 v254, v254
    v_mfma_f32_16x16x32_bf16 a[160:163], v[108:111], v[36:39], a[160:163]
    v_exp_f32 v255, v255
    v_mfma_f32_16x16x32_bf16 v[240:243], a[224:227], v[140:143], v[156:159]
    v_cvt_pk_bf16_f32 v84, v252, v253
    v_cvt_pk_bf16_f32 v85, v254, v255
    v_mfma_f32_16x16x32_bf16 v[240:243], a[228:231], v[172:175], v[240:243]
    buffer_load_dwordx4 v1, s[36:39], s77 offen offset:2048 sc1 lds
    v_mfma_f32_16x16x32_bf16 v[240:243], a[232:235], v[204:207], v[240:243]
    v_lshrrev_b32 v15, 8, v1
    ds_bpermute_b32 v4, v8, v4
    v_mfma_f32_16x16x32_bf16 v[240:243], a[236:239], v[236:239], v[240:243]
    ds_bpermute_b32 v5, v8, v5
    ds_read_b128 a[224:227], v2 offset:0
    v_mfma_f32_16x16x32_bf16 a[164:167], v[104:107], v[40:43], a[164:167]
    ds_read_b128 a[228:231], v2 offset:1024
    v_bfe_u32 v14, v1, 4, 4
    v_mfma_f32_16x16x32_bf16 a[164:167], v[108:111], v[44:47], a[164:167]
    ds_read_b128 a[232:235], v2 offset:2048
    v_lshlrev_b32 v15, 3, v15
    v_mfma_f32_16x16x32_bf16 a[168:171], v[104:107], v[48:51], a[168:171]
    ds_read_b128 a[236:239], v2 offset:3072
    v_sub_u32 v14, v14, v15
    v_mfma_f32_16x16x32_bf16 a[168:171], v[108:111], v[52:55], a[168:171]
    ds_read_b128 v[96:99], v2 offset:16384
    v_and_b32 v15, 16, v1
    v_mfma_f32_16x16x32_bf16 a[172:175], v[104:107], v[56:59], a[172:175]
    buffer_load_dwordx4 v1, s[36:39], s77 offen offset:3072 sc1 lds
    v_mfma_f32_16x16x32_bf16 a[172:175], v[108:111], v[60:63], a[172:175]
    ds_read_b128 v[100:103], v2 offset:17408
    v_mov_b32 v31, 0x3f80
    v_mfma_f32_16x16x32_bf16 v[244:247], a[240:243], v[132:135], v[188:191]
    v_exp_f32 v240, v240
    v_mfma_f32_16x16x32_bf16 v[244:247], a[244:247], v[164:167], v[244:247]
    v_exp_f32 v241, v241
    v_mfma_f32_16x16x32_bf16 v[244:247], a[248:251], v[196:199], v[244:247]
    v_exp_f32 v242, v242
    v_mfma_f32_16x16x32_bf16 v[244:247], a[252:255], v[228:231], v[244:247]
    v_exp_f32 v243, v243
    v_mfma_f32_16x16x32_bf16 a[176:179], v[112:115], v[32:35], a[176:179]
    v_cvt_pk_bf16_f32 v92, v240, v241
    v_cvt_pk_bf16_f32 v93, v242, v243
    v_mfma_f32_16x16x32_bf16 a[176:179], v[116:119], v[36:39], a[176:179]
    s_add_u32 s100, s77, 4096
    v_ashrrev_i32 v14, 1, v14
    v_lshlrev_b32 v15, v15, v31
    v_mfma_f32_16x16x32_bf16 a[180:183], v[112:115], v[40:43], a[180:183]
    s_add_u32 m0, m0, 4096
    v_exp_f32 v244, v244
    v_mfma_f32_16x16x32_bf16 a[180:183], v[116:119], v[44:47], a[180:183]
    buffer_load_dwordx4 v1, s[36:39], s100 offen sc1 lds
    v_mfma_f32_16x16x32_bf16 v[248:251], a[240:243], v[136:139], v[152:155]
    v_exp_f32 v245, v245
    v_mfma_f32_16x16x32_bf16 v[248:251], a[244:247], v[168:171], v[248:251]
    v_exp_f32 v246, v246
    v_mfma_f32_16x16x32_bf16 v[248:251], a[248:251], v[200:203], v[248:251]
    v_exp_f32 v247, v247
    v_mfma_f32_16x16x32_bf16 v[248:251], a[252:255], v[232:235], v[248:251]
    v_cvt_pk_bf16_f32 v78, v244, v245
    v_cvt_pk_bf16_f32 v79, v246, v247
    v_mfma_f32_16x16x32_bf16 a[184:187], v[112:115], v[48:51], a[184:187]
    s_waitcnt lgkmcnt(0)
    v_cmp_eq_i32 vcc, 0, v14
    v_mul_f32 v4, s98, v4
    v_mfma_f32_16x16x32_bf16 a[184:187], v[116:119], v[52:55], a[184:187]
    buffer_load_dwordx4 v1, s[36:39], s100 offen offset:1024 sc1 lds
    v_mfma_f32_16x16x32_bf16 a[188:191], v[112:115], v[56:59], a[188:191]
    v_exp_f32 v248, v248
    v_mfma_f32_16x16x32_bf16 a[188:191], v[116:119], v[60:63], a[188:191]
    v_exp_f32 v249, v249
    v_mfma_f32_16x16x32_bf16 a[192:195], v[120:123], v[32:35], a[192:195]
    v_exp_f32 v250, v250
    v_mfma_f32_16x16x32_bf16 a[192:195], v[124:127], v[36:39], a[192:195]
    v_exp_f32 v251, v251
    v_mfma_f32_16x16x32_bf16 v[252:255], a[240:243], v[140:143], v[156:159]
    v_cvt_pk_bf16_f32 v86, v248, v249
    v_cvt_pk_bf16_f32 v87, v250, v251
    v_mfma_f32_16x16x32_bf16 v[252:255], a[244:247], v[172:175], v[252:255]
    v_cndmask_b32 v216, 0, v15, vcc
    v_cmp_eq_i32 vcc, 1, v14
    v_mfma_f32_16x16x32_bf16 v[252:255], a[248:251], v[204:207], v[252:255]
    v_mul_f32 v5, s98, v5
    v_cndmask_b32 v217, 0, v15, vcc
    v_mfma_f32_16x16x32_bf16 v[252:255], a[252:255], v[236:239], v[252:255]
    buffer_load_dwordx4 v1, s[36:39], s100 offen offset:2048 sc1 lds
    v_mfma_f32_16x16x32_bf16 a[196:199], v[120:123], v[40:43], a[196:199]
    v_cmp_eq_i32 vcc, 2, v14
    v_and_b32 v31, 512, v1
    v_mfma_f32_16x16x32_bf16 a[196:199], v[124:127], v[44:47], a[196:199]
    v_cndmask_b32 v218, 0, v15, vcc
    v_cmp_eq_i32 vcc, 3, v14
    v_mfma_f32_16x16x32_bf16 a[200:203], v[120:123], v[48:51], a[200:203]
    v_exp_f32 v252, v252
    v_mfma_f32_16x16x32_bf16 a[200:203], v[124:127], v[52:55], a[200:203]
    v_exp_f32 v253, v253
    v_mfma_f32_16x16x32_bf16 a[204:207], v[120:123], v[56:59], a[204:207]
    v_cvt_pk_bf16_f32 v94, v252, v253
    v_cndmask_b32 v219, 0, v15, vcc
    v_mfma_f32_16x16x32_bf16 a[204:207], v[124:127], v[60:63], a[204:207]
    v_cmp_eq_i32 vcc, -8, v14
    v_mad_u32_u24 v31, v31, 17, v1
    v_mfma_f32_16x16x32_bf16 a[208:211], a[136:139], v[32:35], a[208:211]
    buffer_load_dwordx4 v1, s[36:39], s100 offen offset:3072 sc1 lds
    v_mfma_f32_16x16x32_bf16 a[208:211], a[136:139], v[36:39], a[208:211]
    v_cndmask_b32 v220, 0, v15, vcc
    v_cmp_eq_i32 vcc, -7, v14
    v_mfma_f32_16x16x32_bf16 a[212:215], a[136:139], v[40:43], a[212:215]
    v_exp_f32 v4, v4
    v_mfma_f32_16x16x32_bf16 a[212:215], a[136:139], v[44:47], a[212:215]
    v_exp_f32 v5, v5
    v_mfma_f32_16x16x32_bf16 a[216:219], a[136:139], v[48:51], a[216:219]
    v_cndmask_b32 v221, 0, v15, vcc
    v_cmp_eq_i32 vcc, -6, v14
    v_mfma_f32_16x16x32_bf16 a[216:219], a[136:139], v[52:55], a[216:219]
    v_add_f32 v4, 1.0, v4
    v_add_f32 v5, 1.0, v5
    v_mfma_f32_16x16x32_bf16 a[220:223], a[136:139], v[56:59], a[220:223]
    v_cndmask_b32 v222, 0, v15, vcc
    v_cmp_eq_i32 vcc, -5, v14
    v_mfma_f32_16x16x32_bf16 a[220:223], a[136:139], v[60:63], a[220:223]
    s_add_u32 s77, s77, 32768
    v_rcp_f32 v4, v4
    v_rcp_f32 v5, v5
    v_cndmask_b32 v223, 0, v15, vcc
    s_cmp_eq_u32 s6, 7
    s_cselect_b32 s16, s8, 0
    s_cselect_b32 s17, s9, 0
    s_cselect_b32 s18, s10, 0
    s_cselect_b32 s19, s11, 0
    s_cselect_b32 s20, s12, 0
    s_cselect_b32 s21, s13, 0
    s_cselect_b32 s22, s14, 0
    s_cselect_b32 s23, s15, 0
    s_cbranch_scc1 K1_J7
K1_J7_BACK:
    v_add_f32 v212, s20, v152
    v_fma_f32 v176, v208, s16, v212
    v_fma_f32 v177, v209, s16, v212
    v_fma_f32 v178, v210, s16, v212
    v_fma_f32 v179, v211, s16, v212
    s_nop 1
    s_waitcnt lgkmcnt(0)
    v_mfma_f32_16x16x32_bf16 v[240:243], a[224:227], v[136:139], v[176:179]
    s_add_u32 m0, s76, s75
    v_exp_f32 v254, v254
    v_mfma_f32_16x16x32_bf16 v[240:243], a[228:231], v[168:171], v[240:243]
    s_mov_b32 s76, s60
    buffer_load_dwordx4 v1, s[36:39], s77 offen sc1 lds
    v_mfma_f32_16x16x32_bf16 v[240:243], a[232:235], v[200:203], v[240:243]
    s_mov_b32 s60, s82
    v_exp_f32 v255, v255
    v_mfma_f32_16x16x32_bf16 v[240:243], a[236:239], v[232:235], v[240:243]
    s_add_u32 s82, s82, 32768
    ds_read_b128 v[104:107], v2 offset:18432
    v_cvt_pk_bf16_f32 v95, v254, v255
    v_mfma_f32_16x16x32_bf16 a[4:7], v[96:99], v[72:75], a[4:7]
    ds_read_b128 v[108:111], v2 offset:19456
    ds_read_b128 a[240:243], v2 offset:4096
    v_mfma_f32_16x16x32_bf16 a[4:7], v[100:103], v[76:79], a[4:7]
    ds_read_b128 a[244:247], v2 offset:5120
    v_add_f32 v213, s21, v152
    v_mfma_f32_16x16x32_bf16 a[8:11], v[96:99], v[80:83], a[8:11]
    ds_read_b128 a[248:251], v2 offset:6144
    v_fma_f32 v180, v208, s17, v213
    v_mfma_f32_16x16x32_bf16 a[8:11], v[100:103], v[84:87], a[8:11]
    ds_read_b128 a[252:255], v2 offset:7168
    v_fma_f32 v181, v209, s17, v213
    v_mfma_f32_16x16x32_bf16 a[12:15], v[96:99], v[88:91], a[12:15]
    ds_read_b128 v[112:115], v2 offset:20480
    v_fma_f32 v182, v210, s17, v213
    v_mfma_f32_16x16x32_bf16 a[12:15], v[100:103], v[92:95], a[12:15]
    ds_read_b128 v[116:119], v2 offset:21504
    v_fma_f32 v183, v211, s17, v213
    v_mfma_f32_16x16x32_bf16 v[244:247], a[224:227], v[140:143], v[156:159]
    buffer_load_dwordx4 v1, s[36:39], s77 offen offset:1024 sc1 lds
    v_mfma_f32_16x16x32_bf16 v[244:247], a[228:231], v[172:175], v[244:247]
    ds_read_b128 v[120:123], v2 offset:22528
    ds_read_b128 v[124:127], v2 offset:23552
    v_mfma_f32_16x16x32_bf16 v[244:247], a[232:235], v[204:207], v[244:247]
    ds_read_b128 a[224:227], v2 offset:8192
    v_add_f32 v214, s22, v152
    v_mfma_f32_16x16x32_bf16 v[244:247], a[236:239], v[236:239], v[244:247]
    s_waitcnt lgkmcnt(4)
    ds_read_b128 a[228:231], v2 offset:9216
    v_fma_f32 v184, v208, s18, v214
    v_mfma_f32_16x16x32_bf16 a[20:23], v[104:107], v[72:75], a[20:23]
    ds_read_b128 a[232:235], v2 offset:10240
    v_fma_f32 v185, v209, s18, v214
    v_mfma_f32_16x16x32_bf16 a[20:23], v[108:111], v[76:79], a[20:23]
    ds_read_b128 a[236:239], v2 offset:11264
    v_fma_f32 v186, v210, s18, v214
    v_mfma_f32_16x16x32_bf16 a[24:27], v[104:107], v[80:83], a[24:27]
    ds_read_b128 v[96:99], v2 offset:24576
    v_fma_f32 v187, v211, s18, v214
    v_mfma_f32_16x16x32_bf16 a[24:27], v[108:111], v[84:87], a[24:27]
    ds_read_b128 v[100:103], v2 offset:25600
    v_add_f32 v215, s23, v152
    v_mfma_f32_16x16x32_bf16 a[28:31], v[104:107], v[88:91], a[28:31]
    v_exp_f32 v240, v240
    v_mfma_f32_16x16x32_bf16 a[28:31], v[108:111], v[92:95], a[28:31]
    v_exp_f32 v241, v241
    v_mfma_f32_16x16x32_bf16 v[248:251], a[240:243], v[136:139], v[180:183]
    buffer_load_dwordx4 v1, s[36:39], s77 offen offset:2048 sc1 lds
    v_mfma_f32_16x16x32_bf16 v[248:251], a[244:247], v[168:171], v[248:251]
    v_exp_f32 v242, v242
    v_mfma_f32_16x16x32_bf16 v[248:251], a[248:251], v[200:203], v[248:251]
    v_exp_f32 v243, v243
    v_mfma_f32_16x16x32_bf16 v[248:251], a[252:255], v[232:235], v[248:251]
    v_cvt_pk_bf16_f32 v48, v240, v241
    v_cvt_pk_bf16_f32 v49, v242, v243
    v_mfma_f32_16x16x32_bf16 a[36:39], v[112:115], v[72:75], a[36:39]
    s_waitcnt lgkmcnt(0)
    ds_read_b128 v[104:107], v2 offset:26624
    ds_read_b128 v[108:111], v2 offset:27648
    v_mfma_f32_16x16x32_bf16 a[36:39], v[116:119], v[76:79], a[36:39]
    v_exp_f32 v244, v244
    v_mfma_f32_16x16x32_bf16 a[40:43], v[112:115], v[80:83], a[40:43]
    v_exp_f32 v245, v245
    v_mfma_f32_16x16x32_bf16 a[40:43], v[116:119], v[84:87], a[40:43]
    v_exp_f32 v246, v246
    v_mfma_f32_16x16x32_bf16 a[44:47], v[112:115], v[88:91], a[44:47]
    v_exp_f32 v247, v247
    v_mfma_f32_16x16x32_bf16 a[44:47], v[116:119], v[92:95], a[44:47]
    s_waitcnt vmcnt(11)
    buffer_load_dwordx4 v1, s[36:39], s77 offen offset:3072 sc1 lds
    v_mfma_f32_16x16x32_bf16 v[12:15], v[64:67], v[216:219], 0
    v_cvt_pk_bf16_f32 v56, v244, v245
    v_cvt_pk_bf16_f32 v57, v246, v247
    v_mfma_f32_16x16x32_bf16 v[16:19], v[68:71], v[216:219], 0
    ds_read_b128 v[112:115], v2 offset:28672
    ds_read_b128 v[116:119], v2 offset:29696
    v_mfma_f32_16x16x32_bf16 v[252:255], a[240:243], v[140:143], v[156:159]
    ds_read_b128 a[240:243], v2 offset:12288
    v_fma_f32 v188, v208, s19, v215
    v_mfma_f32_16x16x32_bf16 v[252:255], a[244:247], v[172:175], v[252:255]
    v_cvt_pk_bf16_f32 v12, v12, v13
    v_cvt_pk_bf16_f32 v13, v14, v15
    v_mfma_f32_16x16x32_bf16 v[252:255], a[248:251], v[204:207], v[252:255]
    v_cvt_pk_bf16_f32 v14, v16, v17
    v_cvt_pk_bf16_f32 v15, v18, v19
    v_mfma_f32_16x16x32_bf16 v[252:255], a[252:255], v[236:239], v[252:255]
    buffer_store_dwordx4 v[12:15], v31, s[56:59], s63 offen offset:0 sc1
    v_mfma_f32_16x16x32_bf16 a[52:55], v[120:123], v[72:75], a[52:55]
    ds_read_b128 a[244:247], v2 offset:13312
    ds_read_b128 a[248:251], v2 offset:14336
    v_mfma_f32_16x16x32_bf16 a[52:55], v[124:127], v[76:79], a[52:55]
    ds_read_b128 a[252:255], v2 offset:15360
    v_fma_f32 v189, v209, s19, v215
    v_mfma_f32_16x16x32_bf16 a[56:59], v[120:123], v[80:83], a[56:59]
    s_add_u32 s100, s77, 4096
    v_exp_f32 v248, v248
    v_mfma_f32_16x16x32_bf16 a[56:59], v[124:127], v[84:87], a[56:59]
    s_add_u32 m0, m0, 4096
    v_exp_f32 v249, v249
    v_mfma_f32_16x16x32_bf16 a[60:63], v[120:123], v[88:91], a[60:63]
    buffer_load_dwordx4 v1, s[36:39], s100 offen sc1 lds
    v_mfma_f32_16x16x32_bf16 a[60:63], v[124:127], v[92:95], a[60:63]
    v_exp_f32 v250, v250
    v_mfma_f32_16x16x32_bf16 v[12:15], v[64:67], v[220:223], 0
    v_exp_f32 v251, v251
    v_mfma_f32_16x16x32_bf16 v[16:19], v[68:71], v[220:223], 0
    v_fma_f32 v190, v210, s19, v215
    v_fma_f32 v191, v211, s19, v215
    v_mfma_f32_16x16x32_bf16 v[240:243], a[224:227], v[136:139], v[184:187]
    v_cvt_pk_bf16_f32 v50, v248, v249
    v_cvt_pk_bf16_f32 v51, v250, v251
    v_mfma_f32_16x16x32_bf16 v[240:243], a[228:231], v[168:171], v[240:243]
    v_cvt_pk_bf16_f32 v12, v12, v13
    v_cvt_pk_bf16_f32 v13, v14, v15
    v_mfma_f32_16x16x32_bf16 v[240:243], a[232:235], v[200:203], v[240:243]
    v_cvt_pk_bf16_f32 v14, v16, v17
    v_cvt_pk_bf16_f32 v15, v18, v19
    v_mfma_f32_16x16x32_bf16 v[240:243], a[236:239], v[232:235], v[240:243]
    buffer_store_dwordx4 v[12:15], v31, s[56:59], s63 offen offset:1024 sc1
    v_mfma_f32_16x16x32_bf16 a[148:151], v[96:99], v[72:75], a[148:151]
    buffer_load_dwordx4 v1, s[36:39], s100 offen offset:1024 sc1 lds
    v_mfma_f32_16x16x32_bf16 a[148:151], v[100:103], v[76:79], a[148:151]
    ds_read_b128 v[120:123], v2 offset:30720
    ds_read_b128 v[124:127], v2 offset:31744
    v_mfma_f32_16x16x32_bf16 a[152:155], v[96:99], v[80:83], a[152:155]
    v_exp_f32 v252, v252
    v_mfma_f32_16x16x32_bf16 a[152:155], v[100:103], v[84:87], a[152:155]
    v_exp_f32 v253, v253
    v_mfma_f32_16x16x32_bf16 a[156:159], v[96:99], v[88:91], a[156:159]
    v_exp_f32 v254, v254
    v_mfma_f32_16x16x32_bf16 a[156:159], v[100:103], v[92:95], a[156:159]
    v_exp_f32 v255, v255
    v_mfma_f32_16x16x32_bf16 v[12:15], v[20:23], v[216:219], 0
    v_cvt_pk_bf16_f32 v58, v252, v253
    v_cvt_pk_bf16_f32 v59, v254, v255
    v_mfma_f32_16x16x32_bf16 v[16:19], v[24:27], v[216:219], 0
    v_exp_f32 v240, v240
    v_mfma_f32_16x16x32_bf16 v[244:247], a[224:227], v[140:143], v[156:159]
    v_exp_f32 v241, v241
    v_mfma_f32_16x16x32_bf16 v[244:247], a[228:231], v[172:175], v[244:247]
    v_exp_f32 v242, v242
    v_mfma_f32_16x16x32_bf16 v[244:247], a[232:235], v[204:207], v[244:247]
    buffer_load_dwordx4 v1, s[36:39], s100 offen offset:2048 sc1 lds
    v_mfma_f32_16x16x32_bf16 v[244:247], a[236:239], v[236:239], v[244:247]
    s_waitcnt lgkmcnt(0)
    v_cvt_pk_bf16_f32 v12, v12, v13
    v_cvt_pk_bf16_f32 v13, v14, v15
    v_mfma_f32_16x16x32_bf16 a[164:167], v[104:107], v[72:75], a[164:167]
    v_cvt_pk_bf16_f32 v14, v16, v17
    v_cvt_pk_bf16_f32 v15, v18, v19
    v_mfma_f32_16x16x32_bf16 a[164:167], v[108:111], v[76:79], a[164:167]
    buffer_store_dwordx4 v[12:15], v31, s[56:59], s63 offen offset:512 sc1
    v_mfma_f32_16x16x32_bf16 a[168:171], v[104:107], v[80:83], a[168:171]
    s_cmp_eq_u32 s82, 163840
    s_cselect_b32 s82, 0, s82
    v_add_u32 v2, s82, v1
    v_mfma_f32_16x16x32_bf16 a[168:171], v[108:111], v[84:87], a[168:171]
    v_exp_f32 v243, v243
    v_mfma_f32_16x16x32_bf16 a[172:175], v[104:107], v[88:91], a[172:175]
    v_exp_f32 v244, v244
    v_mfma_f32_16x16x32_bf16 a[172:175], v[108:111], v[92:95], a[172:175]
    v_exp_f32 v245, v245
    v_mfma_f32_16x16x32_bf16 v[12:15], v[20:23], v[220:223], 0
    v_exp_f32 v246, v246
    v_mfma_f32_16x16x32_bf16 v[16:19], v[24:27], v[220:223], 0
    buffer_load_dwordx4 v1, s[36:39], s100 offen offset:3072 sc1 lds
    v_mfma_f32_16x16x32_bf16 v[248:251], a[240:243], v[136:139], v[188:191]
    v_exp_f32 v247, v247
    v_mfma_f32_16x16x32_bf16 v[248:251], a[244:247], v[168:171], v[248:251]
    v_cvt_pk_bf16_f32 v52, v240, v241
    v_cvt_pk_bf16_f32 v53, v242, v243
    v_mfma_f32_16x16x32_bf16 v[248:251], a[248:251], v[200:203], v[248:251]
    v_cvt_pk_bf16_f32 v12, v12, v13
    v_cvt_pk_bf16_f32 v13, v14, v15
    v_mfma_f32_16x16x32_bf16 v[248:251], a[252:255], v[232:235], v[248:251]
    v_cvt_pk_bf16_f32 v14, v16, v17
    v_cvt_pk_bf16_f32 v15, v18, v19
    v_mfma_f32_16x16x32_bf16 a[180:183], v[112:115], v[72:75], a[180:183]
    buffer_store_dwordx4 v[12:15], v31, s[56:59], s63 offen offset:1536 sc1
    v_mfma_f32_16x16x32_bf16 a[180:183], v[116:119], v[76:79], a[180:183]
    v_cvt_pk_bf16_f32 v60, v244, v245
    v_cvt_pk_bf16_f32 v61, v246, v247
    v_mfma_f32_16x16x32_bf16 a[184:187], v[112:115], v[80:83], a[184:187]
    v_exp_f32 v248, v248
    v_mfma_f32_16x16x32_bf16 a[184:187], v[116:119], v[84:87], a[184:187]
    v_exp_f32 v249, v249
    v_mfma_f32_16x16x32_bf16 a[188:191], v[112:115], v[88:91], a[188:191]
    s_add_u32 s77, s77, 32768
    v_exp_f32 v250, v250
    v_mfma_f32_16x16x32_bf16 a[188:191], v[116:119], v[92:95], a[188:191]
    v_exp_f32 v251, v251
    v_mfma_f32_16x16x32_bf16 v[12:15], v[144:147], v[216:219], 0
    v_cvt_pk_bf16_f32 v54, v248, v249
    v_cvt_pk_bf16_f32 v55, v250, v251
    v_mfma_f32_16x16x32_bf16 v[16:19], a[140:143], v[216:219], 0
    v_accvgpr_read_b32 v6, a120
    v_accvgpr_read_b32 v7, a124
    v_mfma_f32_16x16x32_bf16 v[252:255], a[240:243], v[140:143], v[156:159]
    v_cvt_pk_bf16_f32 v6, 0, v6
    v_cvt_pk_bf16_f32 v7, 0, v7
    v_mfma_f32_16x16x32_bf16 v[252:255], a[244:247], v[172:175], v[252:255]
    v_cvt_pk_bf16_f32 v12, v12, v13
    v_cvt_pk_bf16_f32 v13, v14, v15
    v_mfma_f32_16x16x32_bf16 v[252:255], a[248:251], v[204:207], v[252:255]
    v_cvt_pk_bf16_f32 v14, v16, v17
    v_cvt_pk_bf16_f32 v15, v18, v19
    v_mfma_f32_16x16x32_bf16 v[252:255], a[252:255], v[236:239], v[252:255]
    buffer_store_dwordx4 v[12:15], v1, s[56:59], s64 offen offset:0 sc1
    v_mfma_f32_16x16x32_bf16 a[196:199], v[120:123], v[72:75], a[196:199]
    ds_bpermute_b32 v6, v8, v6
    ds_bpermute_b32 v7, v8, v7
    v_mfma_f32_16x16x32_bf16 a[196:199], v[124:127], v[76:79], a[196:199]
    s_waitcnt vmcnt(8) lgkmcnt(0)
    s_barrier
    ds_read_b128 a[224:227], v2 offset:0
    v_mfma_f32_16x16x32_bf16 a[200:203], v[120:123], v[80:83], a[200:203]
    ds_read_b128 a[228:231], v2 offset:1024
    ds_read_b128 a[232:235], v2 offset:2048
    v_mfma_f32_16x16x32_bf16 a[200:203], v[124:127], v[84:87], a[200:203]
    ds_read_b128 a[236:239], v2 offset:3072
    v_mul_f32 v6, s98, v6
    v_mfma_f32_16x16x32_bf16 a[204:207], v[120:123], v[88:91], a[204:207]
    ds_read_b128 v[96:99], v2 offset:16384
    v_mul_f32 v7, s98, v7
    v_mfma_f32_16x16x32_bf16 a[204:207], v[124:127], v[92:95], a[204:207]
    v_exp_f32 v252, v252
    v_mfma_f32_16x16x32_bf16 v[12:15], v[144:147], v[220:223], 0
    v_exp_f32 v253, v253
    v_mfma_f32_16x16x32_bf16 v[16:19], a[140:143], v[220:223], 0
    ds_read_b128 v[100:103], v2 offset:17408
    v_cvt_pk_bf16_f32 v62, v252, v253
    v_mfma_f32_16x16x32_bf16 a[212:215], a[136:139], v[72:75], a[212:215]
    v_exp_f32 v6, v6
    v_mfma_f32_16x16x32_bf16 a[212:215], a[136:139], v[76:79], a[212:215]
    v_exp_f32 v7, v7
    v_mfma_f32_16x16x32_bf16 a[216:219], a[136:139], v[80:83], a[216:219]
    v_cvt_pk_bf16_f32 v12, v12, v13
    v_cvt_pk_bf16_f32 v13, v14, v15
    v_mfma_f32_16x16x32_bf16 a[216:219], a[136:139], v[84:87], a[216:219]
    v_cvt_pk_bf16_f32 v14, v16, v17
    v_cvt_pk_bf16_f32 v15, v18, v19
    v_mfma_f32_16x16x32_bf16 a[220:223], a[136:139], v[88:91], a[220:223]
    buffer_store_dwordx4 v[12:15], v1, s[56:59], s62 offen offset:0 sc1
    v_mfma_f32_16x16x32_bf16 a[220:223], a[136:139], v[92:95], a[220:223]
    v_add_f32 v6, 1.0, v6
    v_add_f32 v7, 1.0, v7
    v_rcp_f32 v6, v6
    v_rcp_f32 v7, v7
    s_nop 1
    v_accvgpr_read_b32 v9, a208
    v_cmp_nge_f32 vcc, 0x71800000, v9
    v_rcp_f32 v10, v9
    s_nop 0
    s_or_b64 s[84:85], s[84:85], vcc
    v_mul_f32 v10, v10, v4
    v_accvgpr_read_b32 v12, a0
    v_accvgpr_read_b32 v13, a1
    v_accvgpr_read_b32 v14, a2
    v_accvgpr_read_b32 v15, a3
    v_accvgpr_read_b32 v16, a16
    v_accvgpr_read_b32 v17, a17
    v_accvgpr_read_b32 v18, a18
    v_accvgpr_read_b32 v19, a19
    v_pk_mul_f32 v[12:13], v[12:13], v[10:11] op_sel_hi:[1,0]
    v_pk_mul_f32 v[14:15], v[14:15], v[10:11] op_sel_hi:[1,0]
    v_pk_mul_f32 v[16:17], v[16:17], v[10:11] op_sel_hi:[1,0]
    v_pk_mul_f32 v[18:19], v[18:19], v[10:11] op_sel_hi:[1,0]
    v_cvt_pk_bf16_f32 v12, v12, v13
    v_cvt_pk_bf16_f32 v13, v14, v15
    v_cvt_pk_bf16_f32 v14, v16, v17
    v_cvt_pk_bf16_f32 v15, v18, v19
    buffer_store_dwordx4 v[12:15], v1, s[40:43], s80 offen offset:0 sc1
    v_accvgpr_read_b32 v20, a32
    v_accvgpr_read_b32 v21, a33
    v_accvgpr_read_b32 v22, a34
    v_accvgpr_read_b32 v23, a35
    v_accvgpr_read_b32 v24, a48
    v_accvgpr_read_b32 v25, a49
    v_accvgpr_read_b32 v26, a50
    v_accvgpr_read_b32 v27, a51
    v_pk_mul_f32 v[20:21], v[20:21], v[10:11] op_sel_hi:[1,0]
    v_pk_mul_f32 v[22:23], v[22:23], v[10:11] op_sel_hi:[1,0]
    v_pk_mul_f32 v[24:25], v[24:25], v[10:11] op_sel_hi:[1,0]
    v_pk_mul_f32 v[26:27], v[26:27], v[10:11] op_sel_hi:[1,0]
    v_cvt_pk_bf16_f32 v20, v20, v21
    v_cvt_pk_bf16_f32 v21, v22, v23
    v_cvt_pk_bf16_f32 v22, v24, v25
    v_cvt_pk_bf16_f32 v23, v26, v27
    buffer_store_dwordx4 v[20:23], v1, s[40:43], s80 offen offset:1024 sc1
    v_accvgpr_read_b32 v12, a144
    v_accvgpr_read_b32 v13, a145
    v_accvgpr_read_b32 v14, a146
    v_accvgpr_read_b32 v15, a147
    v_accvgpr_read_b32 v16, a160
    v_accvgpr_read_b32 v17, a161
    v_accvgpr_read_b32 v18, a162
    v_accvgpr_read_b32 v19, a163
    v_pk_mul_f32 v[12:13], v[12:13], v[10:11] op_sel_hi:[1,0]
    v_pk_mul_f32 v[14:15], v[14:15], v[10:11] op_sel_hi:[1,0]
    v_pk_mul_f32 v[16:17], v[16:17], v[10:11] op_sel_hi:[1,0]
    v_pk_mul_f32 v[18:19], v[18:19], v[10:11] op_sel_hi:[1,0]
    v_cvt_pk_bf16_f32 v12, v12, v13
    v_cvt_pk_bf16_f32 v13, v14, v15
    v_cvt_pk_bf16_f32 v14, v16, v17
    v_cvt_pk_bf16_f32 v15, v18, v19
    buffer_store_dwordx4 v[12:15], v1, s[40:43], s80 offen offset:2048 sc1
    v_accvgpr_read_b32 v20, a176
    v_accvgpr_read_b32 v21, a177
    v_accvgpr_read_b32 v22, a178
    v_accvgpr_read_b32 v23, a179
    v_accvgpr_read_b32 v24, a192
    v_accvgpr_read_b32 v25, a193
    v_accvgpr_read_b32 v26, a194
    v_accvgpr_read_b32 v27, a195
    v_pk_mul_f32 v[20:21], v[20:21], v[10:11] op_sel_hi:[1,0]
    v_pk_mul_f32 v[22:23], v[22:23], v[10:11] op_sel_hi:[1,0]
    v_pk_mul_f32 v[24:25], v[24:25], v[10:11] op_sel_hi:[1,0]
    v_pk_mul_f32 v[26:27], v[26:27], v[10:11] op_sel_hi:[1,0]
    v_cvt_pk_bf16_f32 v20, v20, v21
    v_cvt_pk_bf16_f32 v21, v22, v23
    v_cvt_pk_bf16_f32 v22, v24, v25
    v_cvt_pk_bf16_f32 v23, v26, v27
    buffer_store_dwordx4 v[20:23], v1, s[40:43], s80 offen offset:3072 sc1
    v_accvgpr_read_b32 v9, a212
    v_cmp_nge_f32 vcc, 0x71800000, v9
    v_rcp_f32 v10, v9
    s_nop 0
    s_or_b64 s[84:85], s[84:85], vcc
    v_mul_f32 v10, v10, v5
    s_add_u32 s72, s80, 622592
    v_accvgpr_read_b32 v12, a4
    v_accvgpr_read_b32 v13, a5
    v_accvgpr_read_b32 v14, a6
    v_accvgpr_read_b32 v15, a7
    v_accvgpr_read_b32 v16, a20
    v_accvgpr_read_b32 v17, a21
    v_accvgpr_read_b32 v18, a22
    v_accvgpr_read_b32 v19, a23
    v_pk_mul_f32 v[12:13], v[12:13], v[10:11] op_sel_hi:[1,0]
    v_pk_mul_f32 v[14:15], v[14:15], v[10:11] op_sel_hi:[1,0]
    v_pk_mul_f32 v[16:17], v[16:17], v[10:11] op_sel_hi:[1,0]
    v_pk_mul_f32 v[18:19], v[18:19], v[10:11] op_sel_hi:[1,0]
    v_cvt_pk_bf16_f32 v12, v12, v13
    v_cvt_pk_bf16_f32 v13, v14, v15
    v_cvt_pk_bf16_f32 v14, v16, v17
    v_cvt_pk_bf16_f32 v15, v18, v19
    buffer_store_dwordx4 v[12:15], v1, s[40:43], s72 offen offset:0 sc1
    v_accvgpr_read_b32 v20, a36
    v_accvgpr_read_b32 v21, a37
    v_accvgpr_read_b32 v22, a38
    v_accvgpr_read_b32 v23, a39
    v_accvgpr_read_b32 v24, a52
    v_accvgpr_read_b32 v25, a53
    v_accvgpr_read_b32 v26, a54
    v_accvgpr_read_b32 v27, a55
    v_pk_mul_f32 v[20:21], v[20:21], v[10:11] op_sel_hi:[1,0]
    v_pk_mul_f32 v[22:23], v[22:23], v[10:11] op_sel_hi:[1,0]
    v_pk_mul_f32 v[24:25], v[24:25], v[10:11] op_sel_hi:[1,0]
    v_pk_mul_f32 v[26:27], v[26:27], v[10:11] op_sel_hi:[1,0]
    v_cvt_pk_bf16_f32 v20, v20, v21
    v_cvt_pk_bf16_f32 v21, v22, v23
    v_cvt_pk_bf16_f32 v22, v24, v25
    v_cvt_pk_bf16_f32 v23, v26, v27
    buffer_store_dwordx4 v[20:23], v1, s[40:43], s72 offen offset:1024 sc1
    v_accvgpr_read_b32 v12, a148
    v_accvgpr_read_b32 v13, a149
    v_accvgpr_read_b32 v14, a150
    v_accvgpr_read_b32 v15, a151
    v_accvgpr_read_b32 v16, a164
    v_accvgpr_read_b32 v17, a165
    v_accvgpr_read_b32 v18, a166
    v_accvgpr_read_b32 v19, a167
    v_pk_mul_f32 v[12:13], v[12:13], v[10:11] op_sel_hi:[1,0]
    v_pk_mul_f32 v[14:15], v[14:15], v[10:11] op_sel_hi:[1,0]
    v_pk_mul_f32 v[16:17], v[16:17], v[10:11] op_sel_hi:[1,0]
    v_pk_mul_f32 v[18:19], v[18:19], v[10:11] op_sel_hi:[1,0]
    v_cvt_pk_bf16_f32 v12, v12, v13
    v_cvt_pk_bf16_f32 v13, v14, v15
    v_cvt_pk_bf16_f32 v14, v16, v17
    v_cvt_pk_bf16_f32 v15, v18, v19
    buffer_store_dwordx4 v[12:15], v1, s[40:43], s72 offen offset:2048 sc1
    v_accvgpr_read_b32 v20, a180
    v_accvgpr_read_b32 v21, a181
    v_accvgpr_read_b32 v22, a182
    v_accvgpr_read_b32 v23, a183
    v_accvgpr_read_b32 v24, a196
    v_accvgpr_read_b32 v25, a197
    v_accvgpr_read_b32 v26, a198
    v_accvgpr_read_b32 v27, a199
    v_pk_mul_f32 v[20:21], v[20:21], v[10:11] op_sel_hi:[1,0]
    v_pk_mul_f32 v[22:23], v[22:23], v[10:11] op_sel_hi:[1,0]
    v_pk_mul_f32 v[24:25], v[24:25], v[10:11] op_sel_hi:[1,0]
    v_pk_mul_f32 v[26:27], v[26:27], v[10:11] op_sel_hi:[1,0]
    v_cvt_pk_bf16_f32 v20, v20, v21
    v_cvt_pk_bf16_f32 v21, v22, v23
    v_cvt_pk_bf16_f32 v22, v24, v25
    v_cvt_pk_bf16_f32 v23, v26, v27
    buffer_store_dwordx4 v[20:23], v1, s[40:43], s72 offen offset:3072 sc1
    v_mov_b32 v9, 1
    v_lshlrev_b32 v8, 20, v1
    s_lshl2_add_u32 s7, s4, s101
    s_add_u32 s7, s7, 163840
    s_waitcnt vmcnt(8)
    buffer_store_dword v9, v8, s[32:35], s7 offen sc1
    s_sub_u32 s78, 14, s6
    s_sub_u32 s78, s78, s6
    s_cmp_eq_u32 s78, 0
    s_cbranch_scc1 K1_LS_END
.p2align 3
K1_LS:
    s_waitcnt lgkmcnt(0)
    v_mfma_f32_16x16x32_bf16 v[240:243], a[224:227], v[136:139], v[176:179]
    s_add_u32 m0, s76, s75
    v_exp_f32 v254, v254
    v_mfma_f32_16x16x32_bf16 v[240:243], a[228:231], v[168:171], v[240:243]
    s_mov_b32 s76, s60
    v_exp_f32 v255, v255
    v_mfma_f32_16x16x32_bf16 v[240:243], a[232:235], v[200:203], v[240:243]
    s_mov_b32 s60, s82
    buffer_load_dwordx4 v1, s[36:39], s77 offen sc1 lds
    v_mfma_f32_16x16x32_bf16 v[240:243], a[236:239], v[232:235], v[240:243]
    s_add_u32 s82, s82, 32768
    ds_read_b128 v[104:107], v2 offset:18432
    v_cvt_pk_bf16_f32 v63, v254, v255
    v_mfma_f32_16x16x32_bf16 a[8:11], v[96:99], v[48:51], a[8:11]
    ds_read_b128 v[108:111], v2 offset:19456
    ds_read_b128 a[240:243], v2 offset:4096
    v_mfma_f32_16x16x32_bf16 a[8:11], v[100:103], v[52:55], a[8:11]
    ds_read_b128 a[244:247], v2 offset:5120
    v_mfma_f32_16x16x32_bf16 a[12:15], v[96:99], v[56:59], a[12:15]
    buffer_load_dwordx4 v1, s[36:39], s77 offen offset:1024 sc1 lds
    v_mfma_f32_16x16x32_bf16 a[12:15], v[100:103], v[60:63], a[12:15]
    ds_read_b128 a[248:251], v2 offset:6144
    ds_read_b128 a[252:255], v2 offset:7168
    v_mfma_f32_16x16x32_bf16 v[244:247], a[224:227], v[140:143], v[156:159]
    v_exp_f32 v240, v240
    v_mfma_f32_16x16x32_bf16 v[244:247], a[228:231], v[172:175], v[244:247]
    ds_read_b128 v[112:115], v2 offset:20480
    ds_read_b128 v[116:119], v2 offset:21504
    v_mfma_f32_16x16x32_bf16 v[244:247], a[232:235], v[204:207], v[244:247]
    v_exp_f32 v241, v241
    v_mfma_f32_16x16x32_bf16 v[244:247], a[236:239], v[236:239], v[244:247]
    s_waitcnt lgkmcnt(4)
    ds_read_b128 v[120:123], v2 offset:22528
    ds_read_b128 v[124:127], v2 offset:23552
    v_mfma_f32_16x16x32_bf16 a[24:27], v[104:107], v[48:51], a[24:27]
    buffer_load_dwordx4 v1, s[36:39], s77 offen offset:2048 sc1 lds
    v_mfma_f32_16x16x32_bf16 a[24:27], v[108:111], v[52:55], a[24:27]
    ds_read_b128 a[224:227], v2 offset:8192
    ds_read_b128 a[228:231], v2 offset:9216
    v_mfma_f32_16x16x32_bf16 a[28:31], v[104:107], v[56:59], a[28:31]
    ds_read_b128 a[232:235], v2 offset:10240
    v_cvt_pk_bf16_f32 v80, v240, v241
    v_mfma_f32_16x16x32_bf16 a[28:31], v[108:111], v[60:63], a[28:31]
    v_exp_f32 v242, v242
    v_mfma_f32_16x16x32_bf16 v[248:251], a[240:243], v[136:139], v[180:183]
    ds_read_b128 a[236:239], v2 offset:11264
    ds_read_b128 v[96:99], v2 offset:24576
    v_mfma_f32_16x16x32_bf16 v[248:251], a[244:247], v[168:171], v[248:251]
    s_waitcnt lgkmcnt(5)
    v_exp_f32 v243, v243
    v_mfma_f32_16x16x32_bf16 v[248:251], a[248:251], v[200:203], v[248:251]
    buffer_load_dwordx4 v1, s[36:39], s77 offen offset:3072 sc1 lds
    v_mfma_f32_16x16x32_bf16 v[248:251], a[252:255], v[232:235], v[248:251]
    ds_read_b128 v[100:103], v2 offset:25600
    v_cvt_pk_bf16_f32 v81, v242, v243
    v_mfma_f32_16x16x32_bf16 a[40:43], v[112:115], v[48:51], a[40:43]
    ds_read_b128 v[104:107], v2 offset:26624
    ds_read_b128 v[108:111], v2 offset:27648
    v_mfma_f32_16x16x32_bf16 a[40:43], v[116:119], v[52:55], a[40:43]
    v_exp_f32 v244, v244
    v_mfma_f32_16x16x32_bf16 a[44:47], v[112:115], v[56:59], a[44:47]
    v_exp_f32 v245, v245
    v_mfma_f32_16x16x32_bf16 a[44:47], v[116:119], v[60:63], a[44:47]
    s_add_u32 s100, s77, 4096
    v_exp_f32 v246, v246
    v_mfma_f32_16x16x32_bf16 v[252:255], a[240:243], v[140:143], v[156:159]
    s_add_u32 m0, m0, 4096
    v_exp_f32 v247, v247
    v_mfma_f32_16x16x32_bf16 v[252:255], a[244:247], v[172:175], v[252:255]
    buffer_load_dwordx4 v1, s[36:39], s100 offen sc1 lds
    v_mfma_f32_16x16x32_bf16 v[252:255], a[248:251], v[204:207], v[252:255]
    v_cvt_pk_bf16_f32 v88, v244, v245
    v_cvt_pk_bf16_f32 v89, v246, v247
    v_mfma_f32_16x16x32_bf16 v[252:255], a[252:255], v[236:239], v[252:255]
    ds_read_b128 a[240:243], v2 offset:12288
    ds_read_b128 a[244:247], v2 offset:13312
    v_mfma_f32_16x16x32_bf16 a[56:59], v[120:123], v[48:51], a[56:59]
    v_exp_f32 v248, v248
    v_mfma_f32_16x16x32_bf16 a[56:59], v[124:127], v[52:55], a[56:59]
    buffer_load_dwordx4 v1, s[36:39], s100 offen offset:1024 sc1 lds
    v_mfma_f32_16x16x32_bf16 a[60:63], v[120:123], v[56:59], a[60:63]
    ds_read_b128 a[248:251], v2 offset:14336
    ds_read_b128 a[252:255], v2 offset:15360
    v_mfma_f32_16x16x32_bf16 a[60:63], v[124:127], v[60:63], a[60:63]
    s_waitcnt lgkmcnt(4)
    v_exp_f32 v249, v249
    v_mfma_f32_16x16x32_bf16 v[240:243], a[224:227], v[136:139], v[184:187]
    ds_read_b128 v[112:115], v2 offset:28672
    ds_read_b128 v[116:119], v2 offset:29696
    v_mfma_f32_16x16x32_bf16 v[240:243], a[228:231], v[168:171], v[240:243]
    v_exp_f32 v250, v250
    v_mfma_f32_16x16x32_bf16 v[240:243], a[232:235], v[200:203], v[240:243]
    v_exp_f32 v251, v251
    v_mfma_f32_16x16x32_bf16 v[240:243], a[236:239], v[232:235], v[240:243]
    buffer_load_dwordx4 v1, s[36:39], s100 offen offset:2048 sc1 lds
    v_mfma_f32_16x16x32_bf16 a[152:155], v[96:99], v[48:51], a[152:155]
    v_cvt_pk_bf16_f32 v82, v248, v249
    v_cvt_pk_bf16_f32 v83, v250, v251
    v_mfma_f32_16x16x32_bf16 a[152:155], v[100:103], v[52:55], a[152:155]
    ds_read_b128 v[120:123], v2 offset:30720
    ds_read_b128 v[124:127], v2 offset:31744
    v_mfma_f32_16x16x32_bf16 a[156:159], v[96:99], v[56:59], a[156:159]
    v_exp_f32 v252, v252
    v_mfma_f32_16x16x32_bf16 a[156:159], v[100:103], v[60:63], a[156:159]
    v_exp_f32 v253, v253
    v_mfma_f32_16x16x32_bf16 v[244:247], a[224:227], v[140:143], v[156:159]
    v_exp_f32 v254, v254
    v_mfma_f32_16x16x32_bf16 v[244:247], a[228:231], v[172:175], v[244:247]
    buffer_load_dwordx4 v1, s[36:39], s100 offen offset:3072 sc1 lds
    v_mfma_f32_16x16x32_bf16 v[244:247], a[232:235], v[204:207], v[244:247]
    v_exp_f32 v255, v255
    v_mfma_f32_16x16x32_bf16 v[244:247], a[236:239], v[236:239], v[244:247]
    s_cmp_eq_u32 s82, 163840
    s_cselect_b32 s82, 0, s82
    v_cvt_pk_bf16_f32 v90, v252, v253
    v_mfma_f32_16x16x32_bf16 a[168:171], v[104:107], v[48:51], a[168:171]
    v_cvt_pk_bf16_f32 v91, v254, v255
    v_add_u32 v2, s82, v1
    v_mfma_f32_16x16x32_bf16 a[168:171], v[108:111], v[52:55], a[168:171]
    ds_read_b128 a[224:227], v2 offset:0
    ds_read_b128 a[228:231], v2 offset:1024
    v_mfma_f32_16x16x32_bf16 a[172:175], v[104:107], v[56:59], a[172:175]
    s_add_u32 s77, s77, 32768
    v_exp_f32 v240, v240
    v_mfma_f32_16x16x32_bf16 a[172:175], v[108:111], v[60:63], a[172:175]
    s_waitcnt lgkmcnt(2)
    ds_read_b128 a[232:235], v2 offset:2048
    ds_read_b128 a[236:239], v2 offset:3072
    v_mfma_f32_16x16x32_bf16 v[248:251], a[240:243], v[136:139], v[188:191]
    v_exp_f32 v241, v241
    v_mfma_f32_16x16x32_bf16 v[248:251], a[244:247], v[168:171], v[248:251]
    ds_read_b128 v[96:99], v2 offset:16384
    ds_read_b128 v[100:103], v2 offset:17408
    v_mfma_f32_16x16x32_bf16 v[248:251], a[248:251], v[200:203], v[248:251]
    v_exp_f32 v242, v242
    v_mfma_f32_16x16x32_bf16 v[248:251], a[252:255], v[232:235], v[248:251]
    v_exp_f32 v243, v243
    v_mfma_f32_16x16x32_bf16 a[184:187], v[112:115], v[48:51], a[184:187]
    v_exp_f32 v244, v244
    v_mfma_f32_16x16x32_bf16 a[184:187], v[116:119], v[52:55], a[184:187]
    v_exp_f32 v245, v245
    v_mfma_f32_16x16x32_bf16 a[188:191], v[112:115], v[56:59], a[188:191]
    v_exp_f32 v246, v246
    v_mfma_f32_16x16x32_bf16 a[188:191], v[116:119], v[60:63], a[188:191]
    v_exp_f32 v247, v247
    v_mfma_f32_16x16x32_bf16 v[252:255], a[240:243], v[140:143], v[156:159]
    v_exp_f32 v248, v248
    v_mfma_f32_16x16x32_bf16 v[252:255], a[244:247], v[172:175], v[252:255]
    v_exp_f32 v249, v249
    v_mfma_f32_16x16x32_bf16 v[252:255], a[248:251], v[204:207], v[252:255]
    v_exp_f32 v250, v250
    v_mfma_f32_16x16x32_bf16 v[252:255], a[252:255], v[236:239], v[252:255]
    v_exp_f32 v251, v251
    v_mfma_f32_16x16x32_bf16 a[200:203], v[120:123], v[48:51], a[200:203]
    v_cvt_pk_bf16_f32 v84, v240, v241
    v_cvt_pk_bf16_f32 v85, v242, v243
    v_mfma_f32_16x16x32_bf16 a[200:203], v[124:127], v[52:55], a[200:203]
    v_cvt_pk_bf16_f32 v92, v244, v245
    v_cvt_pk_bf16_f32 v93, v246, v247
    v_mfma_f32_16x16x32_bf16 a[204:207], v[120:123], v[56:59], a[204:207]
    v_exp_f32 v252, v252
    v_mfma_f32_16x16x32_bf16 a[204:207], v[124:127], v[60:63], a[204:207]
    v_exp_f32 v253, v253
    v_mfma_f32_16x16x32_bf16 a[216:219], a[136:139], v[48:51], a[216:219]
    v_cvt_pk_bf16_f32 v86, v248, v249
    v_cvt_pk_bf16_f32 v87, v250, v251
    v_mfma_f32_16x16x32_bf16 a[216:219], a[136:139], v[52:55], a[216:219]
    v_cvt_pk_bf16_f32 v94, v252, v253
    v_mfma_f32_16x16x32_bf16 a[220:223], a[136:139], v[56:59], a[220:223]
    v_mfma_f32_16x16x32_bf16 a[220:223], a[136:139], v[60:63], a[220:223]
    s_cmp_le_u32 s78, 2
    s_cbranch_scc1 K1_LS_MASK
K1_LS_BACK:
    s_waitcnt lgkmcnt(0)
    v_mfma_f32_16x16x32_bf16 v[240:243], a[224:227], v[136:139], v[176:179]
    s_add_u32 m0, s76, s75
    v_exp_f32 v254, v254
    v_mfma_f32_16x16x32_bf16 v[240:243], a[228:231], v[168:171], v[240:243]
    s_mov_b32 s76, s60
    v_exp_f32 v255, v255
    v_mfma_f32_16x16x32_bf16 v[240:243], a[232:235], v[200:203], v[240:243]
    s_mov_b32 s60, s82
    buffer_load_dwordx4 v1, s[36:39], s77 offen sc1 lds
    v_mfma_f32_16x16x32_bf16 v[240:243], a[236:239], v[232:235], v[240:243]
    s_add_u32 s82, s82, 32768
    ds_read_b128 v[104:107], v2 offset:18432
    v_cvt_pk_bf16_f32 v95, v254, v255
    v_mfma_f32_16x16x32_bf16 a[8:11], v[96:99], v[80:83], a[8:11]
    ds_read_b128 v[108:111], v2 offset:19456
    ds_read_b128 a[240:243], v2 offset:4096
    v_mfma_f32_16x16x32_bf16 a[8:11], v[100:103], v[84:87], a[8:11]
    ds_read_b128 a[244:247], v2 offset:5120
    v_mfma_f32_16x16x32_bf16 a[12:15], v[96:99], v[88:91], a[12:15]
    buffer_load_dwordx4 v1, s[36:39], s77 offen offset:1024 sc1 lds
    v_mfma_f32_16x16x32_bf16 a[12:15], v[100:103], v[92:95], a[12:15]
    ds_read_b128 a[248:251], v2 offset:6144
    ds_read_b128 a[252:255], v2 offset:7168
    v_mfma_f32_16x16x32_bf16 v[244:247], a[224:227], v[140:143], v[156:159]
    v_exp_f32 v240, v240
    v_mfma_f32_16x16x32_bf16 v[244:247], a[228:231], v[172:175], v[244:247]
    ds_read_b128 v[112:115], v2 offset:20480
    ds_read_b128 v[116:119], v2 offset:21504
    v_mfma_f32_16x16x32_bf16 v[244:247], a[232:235], v[204:207], v[244:247]
    v_exp_f32 v241, v241
    v_mfma_f32_16x16x32_bf16 v[244:247], a[236:239], v[236:239], v[244:247]
    s_waitcnt lgkmcnt(4)
    ds_read_b128 v[120:123], v2 offset:22528
    ds_read_b128 v[124:127], v2 offset:23552
    v_mfma_f32_16x16x32_bf16 a[24:27], v[104:107], v[80:83], a[24:27]
    buffer_load_dwordx4 v1, s[36:39], s77 offen offset:2048 sc1 lds
    v_mfma_f32_16x16x32_bf16 a[24:27], v[108:111], v[84:87], a[24:27]
    ds_read_b128 a[224:227], v2 offset:8192
    ds_read_b128 a[228:231], v2 offset:9216
    v_mfma_f32_16x16x32_bf16 a[28:31], v[104:107], v[88:91], a[28:31]
    ds_read_b128 a[232:235], v2 offset:10240
    v_cvt_pk_bf16_f32 v48, v240, v241
    v_mfma_f32_16x16x32_bf16 a[28:31], v[108:111], v[92:95], a[28:31]
    v_exp_f32 v242, v242
    v_mfma_f32_16x16x32_bf16 v[248:251], a[240:243], v[136:139], v[180:183]
    ds_read_b128 a[236:239], v2 offset:11264
    ds_read_b128 v[96:99], v2 offset:24576
    v_mfma_f32_16x16x32_bf16 v[248:251], a[244:247], v[168:171], v[248:251]
    s_waitcnt lgkmcnt(5)
    v_exp_f32 v243, v243
    v_mfma_f32_16x16x32_bf16 v[248:251], a[248:251], v[200:203], v[248:251]
    buffer_load_dwordx4 v1, s[36:39], s77 offen offset:3072 sc1 lds
    v_mfma_f32_16x16x32_bf16 v[248:251], a[252:255], v[232:235], v[248:251]
    ds_read_b128 v[100:103], v2 offset:25600
    v_cvt_pk_bf16_f32 v49, v242, v243
    v_mfma_f32_16x16x32_bf16 a[40:43], v[112:115], v[80:83], a[40:43]
    ds_read_b128 v[104:107], v2 offset:26624
    ds_read_b128 v[108:111], v2 offset:27648
    v_mfma_f32_16x16x32_bf16 a[40:43], v[116:119], v[84:87], a[40:43]
    v_exp_f32 v244, v244
    v_mfma_f32_16x16x32_bf16 a[44:47], v[112:115], v[88:91], a[44:47]
    v_exp_f32 v245, v245
    v_mfma_f32_16x16x32_bf16 a[44:47], v[116:119], v[92:95], a[44:47]
    s_add_u32 s100, s77, 4096
    v_exp_f32 v246, v246
    v_mfma_f32_16x16x32_bf16 v[252:255], a[240:243], v[140:143], v[156:159]
    s_add_u32 m0, m0, 4096
    v_exp_f32 v247, v247
    v_mfma_f32_16x16x32_bf16 v[252:255], a[244:247], v[172:175], v[252:255]
    buffer_load_dwordx4 v1, s[36:39], s100 offen sc1 lds
    v_mfma_f32_16x16x32_bf16 v[252:255], a[248:251], v[204:207], v[252:255]
    v_cvt_pk_bf16_f32 v56, v244, v245
    v_cvt_pk_bf16_f32 v57, v246, v247
    v_mfma_f32_16x16x32_bf16 v[252:255], a[252:255], v[236:239], v[252:255]
    ds_read_b128 a[240:243], v2 offset:12288
    ds_read_b128 a[244:247], v2 offset:13312
    v_mfma_f32_16x16x32_bf16 a[56:59], v[120:123], v[80:83], a[56:59]
    v_exp_f32 v248, v248
    v_mfma_f32_16x16x32_bf16 a[56:59], v[124:127], v[84:87], a[56:59]
    buffer_load_dwordx4 v1, s[36:39], s100 offen offset:1024 sc1 lds
    v_mfma_f32_16x16x32_bf16 a[60:63], v[120:123], v[88:91], a[60:63]
    ds_read_b128 a[248:251], v2 offset:14336
    ds_read_b128 a[252:255], v2 offset:15360
    v_mfma_f32_16x16x32_bf16 a[60:63], v[124:127], v[92:95], a[60:63]
    s_waitcnt lgkmcnt(4)
    v_exp_f32 v249, v249
    v_mfma_f32_16x16x32_bf16 v[240:243], a[224:227], v[136:139], v[184:187]
    ds_read_b128 v[112:115], v2 offset:28672
    ds_read_b128 v[116:119], v2 offset:29696
    v_mfma_f32_16x16x32_bf16 v[240:243], a[228:231], v[168:171], v[240:243]
    v_exp_f32 v250, v250
    v_mfma_f32_16x16x32_bf16 v[240:243], a[232:235], v[200:203], v[240:243]
    v_exp_f32 v251, v251
    v_mfma_f32_16x16x32_bf16 v[240:243], a[236:239], v[232:235], v[240:243]
    buffer_load_dwordx4 v1, s[36:39], s100 offen offset:2048 sc1 lds
    v_mfma_f32_16x16x32_bf16 a[152:155], v[96:99], v[80:83], a[152:155]
    v_cvt_pk_bf16_f32 v50, v248, v249
    v_cvt_pk_bf16_f32 v51, v250, v251
    v_mfma_f32_16x16x32_bf16 a[152:155], v[100:103], v[84:87], a[152:155]
    ds_read_b128 v[120:123], v2 offset:30720
    ds_read_b128 v[124:127], v2 offset:31744
    v_mfma_f32_16x16x32_bf16 a[156:159], v[96:99], v[88:91], a[156:159]
    v_exp_f32 v252, v252
    v_mfma_f32_16x16x32_bf16 a[156:159], v[100:103], v[92:95], a[156:159]
    v_exp_f32 v253, v253
    v_mfma_f32_16x16x32_bf16 v[244:247], a[224:227], v[140:143], v[156:159]
    v_exp_f32 v254, v254
    v_mfma_f32_16x16x32_bf16 v[244:247], a[228:231], v[172:175], v[244:247]
    buffer_load_dwordx4 v1, s[36:39], s100 offen offset:3072 sc1 lds
    v_mfma_f32_16x16x32_bf16 v[244:247], a[232:235], v[204:207], v[244:247]
    v_exp_f32 v255, v255
    v_mfma_f32_16x16x32_bf16 v[244:247], a[236:239], v[236:239], v[244:247]
    s_cmp_eq_u32 s82, 163840
    s_cselect_b32 s82, 0, s82
    v_cvt_pk_bf16_f32 v58, v252, v253
    v_mfma_f32_16x16x32_bf16 a[168:171], v[104:107], v[80:83], a[168:171]
    v_cvt_pk_bf16_f32 v59, v254, v255
    v_add_u32 v2, s82, v1
    v_mfma_f32_16x16x32_bf16 a[168:171], v[108:111], v[84:87], a[168:171]
    v_exp_f32 v240, v240
    v_mfma_f32_16x16x32_bf16 a[172:175], v[104:107], v[88:91], a[172:175]
    s_add_u32 s77, s77, 32768
    v_exp_f32 v241, v241
    v_mfma_f32_16x16x32_bf16 a[172:175], v[108:111], v[92:95], a[172:175]
    s_waitcnt lgkmcnt(0)
    v_exp_f32 v242, v242
    v_mfma_f32_16x16x32_bf16 v[248:251], a[240:243], v[136:139], v[188:191]
    v_exp_f32 v243, v243
    v_mfma_f32_16x16x32_bf16 v[248:251], a[244:247], v[168:171], v[248:251]
    v_exp_f32 v244, v244
    v_mfma_f32_16x16x32_bf16 v[248:251], a[248:251], v[200:203], v[248:251]
    v_exp_f32 v245, v245
    v_mfma_f32_16x16x32_bf16 v[248:251], a[252:255], v[232:235], v[248:251]
    v_exp_f32 v246, v246
    v_mfma_f32_16x16x32_bf16 a[184:187], v[112:115], v[80:83], a[184:187]
    v_exp_f32 v247, v247
    v_mfma_f32_16x16x32_bf16 a[184:187], v[116:119], v[84:87], a[184:187]
    v_cvt_pk_bf16_f32 v52, v240, v241
    v_cvt_pk_bf16_f32 v53, v242, v243
    v_mfma_f32_16x16x32_bf16 a[188:191], v[112:115], v[88:91], a[188:191]
    v_cvt_pk_bf16_f32 v60, v244, v245
    v_cvt_pk_bf16_f32 v61, v246, v247
    v_mfma_f32_16x16x32_bf16 a[188:191], v[116:119], v[92:95], a[188:191]
    s_waitcnt vmcnt(8) lgkmcnt(0)
    s_barrier
    ds_read_b128 a[224:227], v2 offset:0
    v_mfma_f32_16x16x32_bf16 v[252:255], a[240:243], v[140:143], v[156:159]
    ds_read_b128 a[228:231], v2 offset:1024
    ds_read_b128 a[232:235], v2 offset:2048
    v_mfma_f32_16x16x32_bf16 v[252:255], a[244:247], v[172:175], v[252:255]
    v_exp_f32 v248, v248
    v_mfma_f32_16x16x32_bf16 v[252:255], a[248:251], v[204:207], v[252:255]
    ds_read_b128 a[236:239], v2 offset:3072
    ds_read_b128 v[96:99], v2 offset:16384
    v_mfma_f32_16x16x32_bf16 v[252:255], a[252:255], v[236:239], v[252:255]
    v_exp_f32 v249, v249
    v_mfma_f32_16x16x32_bf16 a[200:203], v[120:123], v[80:83], a[200:203]
    ds_read_b128 v[100:103], v2 offset:17408
    v_cvt_pk_bf16_f32 v54, v248, v249
    v_mfma_f32_16x16x32_bf16 a[200:203], v[124:127], v[84:87], a[200:203]
    v_exp_f32 v250, v250
    v_mfma_f32_16x16x32_bf16 a[204:207], v[120:123], v[88:91], a[204:207]
    v_exp_f32 v251, v251
    v_mfma_f32_16x16x32_bf16 a[204:207], v[124:127], v[92:95], a[204:207]
    v_exp_f32 v252, v252
    v_mfma_f32_16x16x32_bf16 a[216:219], a[136:139], v[80:83], a[216:219]
    v_exp_f32 v253, v253
    v_mfma_f32_16x16x32_bf16 a[216:219], a[136:139], v[84:87], a[216:219]
    v_cvt_pk_bf16_f32 v55, v250, v251
    v_cvt_pk_bf16_f32 v62, v252, v253
    v_mfma_f32_16x16x32_bf16 a[220:223], a[136:139], v[88:91], a[220:223]
    v_mfma_f32_16x16x32_bf16 a[220:223], a[136:139], v[92:95], a[220:223]
    s_sub_u32 s78, s78, 1
    s_cmp_lg_u32 s78, 0
    s_cbranch_scc1 K1_LS
K1_LS_END:
    v_add_f32 v212, s12, v156
    v_fma_f32 v176, v208, s8, v212
    v_fma_f32 v177, v209, s8, v212
    v_fma_f32 v178, v210, s8, v212
    v_fma_f32 v179, v211, s8, v212
    s_nop 1
    s_waitcnt lgkmcnt(0)
    v_mfma_f32_16x16x32_bf16 v[240:243], a[224:227], v[140:143], v[176:179]
    s_xor_b32 s21, s3, 1
    s_lshl2_add_u32 s21, s21, s4
    ds_read_b128 v[104:107], v2 offset:18432
    v_mfma_f32_16x16x32_bf16 v[240:243], a[228:231], v[172:175], v[240:243]
    s_mul_i32 s21, s21, 36864
    ds_read_b128 v[108:111], v2 offset:19456
    ds_read_b128 a[240:243], v2 offset:4096
    v_mfma_f32_16x16x32_bf16 v[240:243], a[232:235], v[204:207], v[240:243]
    s_add_u32 s21, s21, s28
    s_mov_b32 m0, s45
    ds_read_b128 a[244:247], v2 offset:5120
    v_mfma_f32_16x16x32_bf16 v[240:243], a[236:239], v[236:239], v[240:243]
    s_mul_i32 s86, s4, 34
    buffer_load_dwordx4 v1, s[56:59], s21 offen sc1 lds
    v_mfma_f32_16x16x32_bf16 a[8:11], v[96:99], v[48:51], a[8:11]
    s_add_u32 s86, s86, 8
    v_exp_f32 v254, v254
    v_mfma_f32_16x16x32_bf16 a[8:11], v[100:103], v[52:55], a[8:11]
    s_mov_b32 s76, s60
    v_exp_f32 v255, v255
    v_mfma_f32_16x16x32_bf16 a[12:15], v[96:99], v[56:59], a[12:15]
    s_mov_b32 s60, s82
    v_cvt_pk_bf16_f32 v63, v254, v255
    ds_read_b128 a[248:251], v2 offset:6144
    s_nop 0
    v_mfma_f32_16x16x32_bf16 a[12:15], v[100:103], v[60:63], a[12:15]
    s_add_u32 s82, s82, 32768
    buffer_load_dwordx4 v1, s[56:59], s21 offen offset:1024 sc1 lds
    s_waitcnt lgkmcnt(1)
    v_mfma_f32_16x16x32_bf16 a[24:27], v[104:107], v[48:51], a[24:27]
    s_sub_u32 s62, 15, s6
    v_lshrrev_b32 v28, 4, v1
    ds_read_b128 a[252:255], v2 offset:7168
    v_mfma_f32_16x16x32_bf16 a[24:27], v[108:111], v[52:55], a[24:27]
    s_lshl_b32 s63, s3, 12
    v_min_u32 v28, 33, v28
    ds_read_b128 v[112:115], v2 offset:20480
    v_mfma_f32_16x16x32_bf16 a[28:31], v[104:107], v[56:59], a[28:31]
    s_mov_b32 s50, 9437184
    buffer_load_dwordx4 v1, s[56:59], s21 offen offset:2048 sc1 lds
    v_mfma_f32_16x16x32_bf16 a[28:31], v[108:111], v[60:63], a[28:31]
    v_add_lshl_u32 v28, v28, s86, 7
    v_add_f32 v213, s13, v156
    v_fma_f32 v180, v208, s9, v213
    v_fma_f32 v181, v209, s9, v213
    v_fma_f32 v182, v210, s9, v213
    v_fma_f32 v183, v211, s9, v213
    s_nop 1
    v_mfma_f32_16x16x32_bf16 v[244:247], a[240:243], v[140:143], v[180:183]
    s_getpc_b64 s[86:87]
    global_load_dword v28, v28, s[86:87]
    v_mfma_f32_16x16x32_bf16 v[244:247], a[244:247], v[172:175], v[244:247]
    s_waitcnt lgkmcnt(1)
    ds_read_b128 v[116:119], v2 offset:21504
    ds_read_b128 v[120:123], v2 offset:22528
    v_mfma_f32_16x16x32_bf16 v[244:247], a[248:251], v[204:207], v[244:247]
    buffer_load_dwordx4 v1, s[56:59], s21 offen offset:3072 sc1 lds
    v_mfma_f32_16x16x32_bf16 v[244:247], a[252:255], v[236:239], v[244:247]
    s_add_u32 s21, s21, 4096
    ds_read_b128 v[124:127], v2 offset:23552
    s_add_u32 m0, s45, 4096
    s_waitcnt lgkmcnt(3)
    v_mfma_f32_16x16x32_bf16 a[40:43], v[112:115], v[48:51], a[40:43]
    s_waitcnt lgkmcnt(2)
    buffer_load_dwordx4 v1, s[56:59], s21 offen sc1 lds
    v_mfma_f32_16x16x32_bf16 a[40:43], v[116:119], v[52:55], a[40:43]
    ds_read_b128 a[224:227], v2 offset:8192
    ds_read_b128 a[228:231], v2 offset:9216
    v_mfma_f32_16x16x32_bf16 a[44:47], v[112:115], v[56:59], a[44:47]
    ds_read_b128 a[232:235], v2 offset:10240
    v_add_f32 v214, s14, v156
    v_mfma_f32_16x16x32_bf16 a[44:47], v[116:119], v[60:63], a[44:47]
    s_waitcnt lgkmcnt(4)
    ds_read_b128 a[236:239], v2 offset:11264
    v_fma_f32 v184, v208, s10, v214
    v_mfma_f32_16x16x32_bf16 a[56:59], v[120:123], v[48:51], a[56:59]
    s_waitcnt lgkmcnt(4)
    buffer_load_dwordx4 v1, s[56:59], s21 offen offset:1024 sc1 lds
    v_mfma_f32_16x16x32_bf16 a[56:59], v[124:127], v[52:55], a[56:59]
    ds_read_b128 v[96:99], v2 offset:24576
    ds_read_b128 v[100:103], v2 offset:25600
    v_mfma_f32_16x16x32_bf16 a[60:63], v[120:123], v[56:59], a[60:63]
    buffer_load_dwordx4 v1, s[56:59], s21 offen offset:2048 sc1 lds
    v_mfma_f32_16x16x32_bf16 a[60:63], v[124:127], v[60:63], a[60:63]
    s_xor_b32 s21, s3, 2
    v_fma_f32 v185, v209, s10, v214
    v_fma_f32 v186, v210, s10, v214
    v_fma_f32 v187, v211, s10, v214
    s_nop 1
    s_waitcnt lgkmcnt(3)
    v_mfma_f32_16x16x32_bf16 v[248:251], a[224:227], v[140:143], v[184:187]
    s_lshl2_add_u32 s21, s21, s4
    s_mul_i32 s21, s21, 36864
    ds_read_b128 v[104:107], v2 offset:26624
    v_mfma_f32_16x16x32_bf16 v[248:251], a[228:231], v[172:175], v[248:251]
    s_add_u32 s21, s21, s28
    s_mov_b32 m0, s46
    ds_read_b128 v[108:111], v2 offset:27648
    v_mfma_f32_16x16x32_bf16 v[248:251], a[232:235], v[204:207], v[248:251]
    s_waitcnt lgkmcnt(2)
    buffer_load_dwordx4 v1, s[56:59], s21 offen sc1 lds
    v_mfma_f32_16x16x32_bf16 v[248:251], a[236:239], v[236:239], v[248:251]
    ds_read_b128 a[240:243], v2 offset:12288
    ds_read_b128 a[244:247], v2 offset:13312
    v_mfma_f32_16x16x32_bf16 a[152:155], v[96:99], v[48:51], a[152:155]
    ds_read_b128 a[248:251], v2 offset:14336
    v_add_f32 v215, s15, v156
    v_mfma_f32_16x16x32_bf16 a[152:155], v[100:103], v[52:55], a[152:155]
    buffer_load_dwordx4 v1, s[56:59], s21 offen offset:1024 sc1 lds
    v_mfma_f32_16x16x32_bf16 a[156:159], v[96:99], v[56:59], a[156:159]
    ds_read_b128 a[252:255], v2 offset:15360
    ds_read_b128 v[112:115], v2 offset:28672
    v_mfma_f32_16x16x32_bf16 a[156:159], v[100:103], v[60:63], a[156:159]
    s_waitcnt lgkmcnt(5)
    ds_read_b128 v[116:119], v2 offset:29696
    v_fma_f32 v188, v208, s11, v215
    v_mfma_f32_16x16x32_bf16 a[168:171], v[104:107], v[48:51], a[168:171]
    buffer_load_dwordx4 v1, s[56:59], s21 offen offset:2048 sc1 lds
    v_mfma_f32_16x16x32_bf16 a[168:171], v[108:111], v[52:55], a[168:171]
    v_fma_f32 v189, v209, s11, v215
    v_fma_f32 v190, v210, s11, v215
    v_mfma_f32_16x16x32_bf16 a[172:175], v[104:107], v[56:59], a[172:175]
    v_fma_f32 v191, v211, s11, v215
    ds_read_b128 v[120:123], v2 offset:30720
    v_mfma_f32_16x16x32_bf16 a[172:175], v[108:111], v[60:63], a[172:175]
    s_waitcnt lgkmcnt(2)
    v_exp_f32 v240, v240
    v_mfma_f32_16x16x32_bf16 v[252:255], a[240:243], v[140:143], v[188:191]
    buffer_load_dwordx4 v1, s[56:59], s21 offen offset:3072 sc1 lds
    v_mfma_f32_16x16x32_bf16 v[252:255], a[244:247], v[172:175], v[252:255]
    s_cmp_eq_u32 s82, 163840
    s_cselect_b32 s82, 0, s82
    ds_read_b128 v[124:127], v2 offset:31744
    v_mfma_f32_16x16x32_bf16 v[252:255], a[248:251], v[204:207], v[252:255]
    s_add_u32 s21, s21, 4096
    v_exp_f32 v241, v241
    v_mfma_f32_16x16x32_bf16 v[252:255], a[252:255], v[236:239], v[252:255]
    s_add_u32 m0, s46, 4096
    v_add_u32 v2, s82, v1
    ds_read_b128 a[224:227], v2 offset:0
    v_mfma_f32_16x16x32_bf16 a[184:187], v[112:115], v[48:51], a[184:187]
    s_waitcnt lgkmcnt(2)
    buffer_load_dwordx4 v1, s[56:59], s21 offen sc1 lds
    v_mfma_f32_16x16x32_bf16 a[184:187], v[116:119], v[52:55], a[184:187]
    ds_read_b128 a[228:231], v2 offset:1024
    ds_read_b128 a[232:235], v2 offset:2048
    v_mfma_f32_16x16x32_bf16 a[188:191], v[112:115], v[56:59], a[188:191]
    buffer_load_dwordx4 v1, s[56:59], s21 offen offset:1024 sc1 lds
    v_mfma_f32_16x16x32_bf16 a[188:191], v[116:119], v[60:63], a[188:191]
    ds_read_b128 a[236:239], v2 offset:3072
    ds_read_b128 v[96:99], v2 offset:16384
    v_mfma_f32_16x16x32_bf16 a[200:203], v[120:123], v[48:51], a[200:203]
    s_waitcnt lgkmcnt(4)
    ds_read_b128 v[100:103], v2 offset:17408
    v_cvt_pk_bf16_f32 v88, v240, v241
    v_mfma_f32_16x16x32_bf16 a[200:203], v[124:127], v[52:55], a[200:203]
    v_exp_f32 v242, v242
    v_mfma_f32_16x16x32_bf16 a[204:207], v[120:123], v[56:59], a[204:207]
    buffer_load_dwordx4 v1, s[56:59], s21 offen offset:2048 sc1 lds
    v_mfma_f32_16x16x32_bf16 a[204:207], v[124:127], v[60:63], a[204:207]
    v_exp_f32 v243, v243
    v_mfma_f32_16x16x32_bf16 a[216:219], a[136:139], v[48:51], a[216:219]
    v_exp_f32 v244, v244
    v_mfma_f32_16x16x32_bf16 a[216:219], a[136:139], v[52:55], a[216:219]
    v_exp_f32 v245, v245
    v_mfma_f32_16x16x32_bf16 a[220:223], a[136:139], v[56:59], a[220:223]
    s_bitcmp1_b32 s5, 2
    s_cselect_b32 s62, s62, s6
    v_cvt_pk_bf16_f32 v89, v242, v243
    v_mfma_f32_16x16x32_bf16 a[220:223], a[136:139], v[60:63], a[220:223]
    s_add_u32 s48, s32, 1048576
    s_addc_u32 s49, s33, 0
    v_cvt_pk_bf16_f32 v90, v244, v245
    v_exp_f32 v246, v246
    v_exp_f32 v247, v247
    v_exp_f32 v248, v248
    v_exp_f32 v249, v249
    v_exp_f32 v250, v250
    v_exp_f32 v251, v251
    v_exp_f32 v252, v252
    v_exp_f32 v253, v253
    v_cvt_pk_bf16_f32 v91, v246, v247
    v_cvt_pk_bf16_f32 v92, v248, v249
    v_cvt_pk_bf16_f32 v93, v250, v251
    v_cvt_pk_bf16_f32 v94, v252, v253
    ds_read_b128 v[104:107], v2 offset:18432
    ds_read_b128 v[108:111], v2 offset:19456
    ds_read_b128 v[112:115], v2 offset:20480
    ds_read_b128 v[116:119], v2 offset:21504
    ds_read_b128 v[120:123], v2 offset:22528
    ds_read_b128 v[124:127], v2 offset:23552
    s_waitcnt lgkmcnt(6)
    v_mfma_f32_16x16x32_bf16 a[12:15], v[96:99], v[88:91], a[12:15]
    v_exp_f32 v254, v254
    v_exp_f32 v255, v255
    s_nop 0
    v_cvt_pk_bf16_f32 v95, v254, v255
    s_nop 1
    v_mfma_f32_16x16x32_bf16 a[12:15], v[100:103], v[92:95], a[12:15]
    s_waitcnt lgkmcnt(5)
    ds_read_b128 v[96:99], v2 offset:24576
    ds_read_b128 v[100:103], v2 offset:25600
    v_accvgpr_read_b32 v9, a216
    v_rcp_f32 v10, v9
    v_mfma_f32_16x16x32_bf16 a[28:31], v[104:107], v[88:91], a[28:31]
    s_waitcnt lgkmcnt(6)
    ds_read_b128 v[104:107], v2 offset:26624
    v_mul_f32 v10, v10, v6
    v_accvgpr_read_b32 v12, a8
    v_accvgpr_read_b32 v13, a9
    v_accvgpr_read_b32 v14, a10
    v_mfma_f32_16x16x32_bf16 a[28:31], v[108:111], v[92:95], a[28:31]
    s_waitcnt lgkmcnt(6)
    ds_read_b128 v[108:111], v2 offset:27648
    v_accvgpr_read_b32 v15, a11
    v_accvgpr_read_b32 v16, a24
    v_accvgpr_read_b32 v17, a25
    v_accvgpr_read_b32 v18, a26
    v_mfma_f32_16x16x32_bf16 a[44:47], v[112:115], v[88:91], a[44:47]
    s_waitcnt lgkmcnt(4)
    ds_read_b128 v[112:115], v2 offset:28672
    v_accvgpr_read_b32 v19, a27
    v_accvgpr_read_b32 v20, a40
    v_accvgpr_read_b32 v21, a41
    v_accvgpr_read_b32 v22, a42
    v_mfma_f32_16x16x32_bf16 a[44:47], v[116:119], v[92:95], a[44:47]
    ds_read_b128 v[116:119], v2 offset:29696
    v_accvgpr_read_b32 v23, a43
    v_accvgpr_read_b32 v24, a56
    v_accvgpr_read_b32 v25, a57
    v_accvgpr_read_b32 v26, a58
    v_mfma_f32_16x16x32_bf16 a[60:63], v[120:123], v[88:91], a[60:63]
    ds_read_b128 v[120:123], v2 offset:30720
    v_accvgpr_read_b32 v27, a59
    v_mul_f32 v12, v10, v12
    v_mul_f32 v13, v10, v13
    v_mul_f32 v14, v10, v14
    v_mfma_f32_16x16x32_bf16 a[60:63], v[124:127], v[92:95], a[60:63]
    s_waitcnt lgkmcnt(4)
    ds_read_b128 v[124:127], v2 offset:31744
    v_mul_f32 v15, v10, v15
    v_mul_f32 v16, v10, v16
    v_mul_f32 v17, v10, v17
    v_mul_f32 v18, v10, v18
    v_mfma_f32_16x16x32_bf16 a[156:159], v[96:99], v[88:91], a[156:159]
    v_mul_f32 v19, v10, v19
    v_mul_f32 v20, v10, v20
    v_mul_f32 v21, v10, v21
    v_mul_f32 v22, v10, v22
    v_mul_f32 v23, v10, v23
    v_mfma_f32_16x16x32_bf16 a[156:159], v[100:103], v[92:95], a[156:159]
    v_mul_f32 v24, v10, v24
    v_mul_f32 v25, v10, v25
    v_mul_f32 v26, v10, v26
    v_mul_f32 v27, v10, v27
    v_cvt_pk_bf16_f32 v12, v12, v13
    v_mfma_f32_16x16x32_bf16 a[172:175], v[104:107], v[88:91], a[172:175]
    s_waitcnt lgkmcnt(2)
    v_cvt_pk_bf16_f32 v13, v14, v15
    v_cvt_pk_bf16_f32 v14, v16, v17
    v_cvt_pk_bf16_f32 v15, v18, v19
    v_cvt_pk_bf16_f32 v20, v20, v21
    v_cvt_pk_bf16_f32 v21, v22, v23
    v_mfma_f32_16x16x32_bf16 a[172:175], v[108:111], v[92:95], a[172:175]
    v_cvt_pk_bf16_f32 v22, v24, v25
    v_cvt_pk_bf16_f32 v23, v26, v27
    buffer_store_dwordx4 v[12:15], v1, s[40:43], s81 offen offset:0 sc1
    v_accvgpr_read_b32 v16, a168
    v_mfma_f32_16x16x32_bf16 a[188:191], v[112:115], v[88:91], a[188:191]
    buffer_store_dwordx4 v[20:23], v1, s[40:43], s81 offen offset:1024 sc1
    v_accvgpr_read_b32 v12, a152
    v_accvgpr_read_b32 v13, a153
    v_accvgpr_read_b32 v14, a154
    v_mfma_f32_16x16x32_bf16 a[188:191], v[116:119], v[92:95], a[188:191]
    s_waitcnt lgkmcnt(0)
    v_accvgpr_read_b32 v15, a155
    v_accvgpr_read_b32 v17, a169
    v_accvgpr_read_b32 v18, a170
    v_accvgpr_read_b32 v19, a171
    v_accvgpr_read_b32 v20, a184
    v_mfma_f32_16x16x32_bf16 a[204:207], v[120:123], v[88:91], a[204:207]
    v_accvgpr_read_b32 v21, a185
    v_accvgpr_read_b32 v22, a186
    v_accvgpr_read_b32 v23, a187
    v_accvgpr_read_b32 v24, a200
    v_accvgpr_read_b32 v25, a201
    v_mfma_f32_16x16x32_bf16 a[204:207], v[124:127], v[92:95], a[204:207]
    v_accvgpr_read_b32 v26, a202
    v_accvgpr_read_b32 v27, a203
    v_mul_f32 v12, v10, v12
    v_mul_f32 v13, v10, v13
    v_mul_f32 v14, v10, v14
    v_mfma_f32_16x16x32_bf16 a[220:223], a[136:139], v[88:91], a[220:223]
    v_mul_f32 v15, v10, v15
    v_mul_f32 v16, v10, v16
    v_mul_f32 v17, v10, v17
    v_mul_f32 v18, v10, v18
    v_mul_f32 v19, v10, v19
    v_mfma_f32_16x16x32_bf16 a[220:223], a[136:139], v[92:95], a[220:223]
    v_mul_f32 v20, v10, v20
    v_mul_f32 v21, v10, v21
    v_mul_f32 v22, v10, v22
    v_mul_f32 v23, v10, v23
    v_mul_f32 v24, v10, v24
    v_mul_f32 v25, v10, v25
    v_mul_f32 v26, v10, v26
    v_mul_f32 v27, v10, v27
    v_cmp_nge_f32 vcc, 0x71800000, v9
    v_cvt_pk_bf16_f32 v12, v12, v13
    v_cvt_pk_bf16_f32 v13, v14, v15
    v_cvt_pk_bf16_f32 v14, v16, v17
    v_cvt_pk_bf16_f32 v15, v18, v19
    v_cvt_pk_bf16_f32 v20, v20, v21
    v_cvt_pk_bf16_f32 v21, v22, v23
    v_cvt_pk_bf16_f32 v22, v24, v25
    v_cvt_pk_bf16_f32 v23, v26, v27
    s_or_b64 s[84:85], s[84:85], vcc
    buffer_store_dwordx4 v[12:15], v1, s[40:43], s81 offen offset:2048 sc1
    buffer_store_dwordx4 v[20:23], v1, s[40:43], s81 offen offset:3072 sc1
    s_nop 3
    v_accvgpr_read_b32 v9, a220
    v_cmp_nge_f32 vcc, 0x71800000, v9
    v_rcp_f32 v10, v9
    s_nop 0
    s_or_b64 s[84:85], s[84:85], vcc
    v_mul_f32 v10, v10, v7
    s_add_u32 s72, s81, 622592
    v_accvgpr_read_b32 v12, a12
    v_accvgpr_read_b32 v13, a13
    v_accvgpr_read_b32 v14, a14
    v_accvgpr_read_b32 v15, a15
    v_accvgpr_read_b32 v16, a28
    v_accvgpr_read_b32 v17, a29
    v_accvgpr_read_b32 v18, a30
    v_accvgpr_read_b32 v19, a31
    v_pk_mul_f32 v[12:13], v[12:13], v[10:11] op_sel_hi:[1,0]
    v_pk_mul_f32 v[14:15], v[14:15], v[10:11] op_sel_hi:[1,0]
    v_pk_mul_f32 v[16:17], v[16:17], v[10:11] op_sel_hi:[1,0]
    v_pk_mul_f32 v[18:19], v[18:19], v[10:11] op_sel_hi:[1,0]
    v_cvt_pk_bf16_f32 v12, v12, v13
    v_cvt_pk_bf16_f32 v13, v14, v15
    v_cvt_pk_bf16_f32 v14, v16, v17
    v_cvt_pk_bf16_f32 v15, v18, v19
    buffer_store_dwordx4 v[12:15], v1, s[40:43], s72 offen offset:0 sc1
    v_accvgpr_read_b32 v20, a44
    v_accvgpr_read_b32 v21, a45
    v_accvgpr_read_b32 v22, a46
    v_accvgpr_read_b32 v23, a47
    v_accvgpr_read_b32 v24, a60
    v_accvgpr_read_b32 v25, a61
    v_accvgpr_read_b32 v26, a62
    v_accvgpr_read_b32 v27, a63
    v_pk_mul_f32 v[20:21], v[20:21], v[10:11] op_sel_hi:[1,0]
    v_pk_mul_f32 v[22:23], v[22:23], v[10:11] op_sel_hi:[1,0]
    v_pk_mul_f32 v[24:25], v[24:25], v[10:11] op_sel_hi:[1,0]
    v_pk_mul_f32 v[26:27], v[26:27], v[10:11] op_sel_hi:[1,0]
    v_cvt_pk_bf16_f32 v20, v20, v21
    v_cvt_pk_bf16_f32 v21, v22, v23
    v_cvt_pk_bf16_f32 v22, v24, v25
    v_cvt_pk_bf16_f32 v23, v26, v27
    buffer_store_dwordx4 v[20:23], v1, s[40:43], s72 offen offset:1024 sc1
    v_accvgpr_read_b32 v12, a156
    v_accvgpr_read_b32 v13, a157
    v_accvgpr_read_b32 v14, a158
    v_accvgpr_read_b32 v15, a159
    v_accvgpr_read_b32 v16, a172
    v_accvgpr_read_b32 v17, a173
    v_accvgpr_read_b32 v18, a174
    v_accvgpr_read_b32 v19, a175
    v_pk_mul_f32 v[12:13], v[12:13], v[10:11] op_sel_hi:[1,0]
    v_pk_mul_f32 v[14:15], v[14:15], v[10:11] op_sel_hi:[1,0]
    v_pk_mul_f32 v[16:17], v[16:17], v[10:11] op_sel_hi:[1,0]
    v_pk_mul_f32 v[18:19], v[18:19], v[10:11] op_sel_hi:[1,0]
    v_cvt_pk_bf16_f32 v12, v12, v13
    v_cvt_pk_bf16_f32 v13, v14, v15
    v_cvt_pk_bf16_f32 v14, v16, v17
    v_cvt_pk_bf16_f32 v15, v18, v19
    buffer_store_dwordx4 v[12:15], v1, s[40:43], s72 offen offset:2048 sc1
    v_accvgpr_read_b32 v20, a188
    v_accvgpr_read_b32 v21, a189
    v_accvgpr_read_b32 v22, a190
    v_accvgpr_read_b32 v23, a191
    v_accvgpr_read_b32 v24, a204
    v_accvgpr_read_b32 v25, a205
    v_accvgpr_read_b32 v26, a206
    v_accvgpr_read_b32 v27, a207
    v_pk_mul_f32 v[20:21], v[20:21], v[10:11] op_sel_hi:[1,0]
    v_pk_mul_f32 v[22:23], v[22:23], v[10:11] op_sel_hi:[1,0]
    v_pk_mul_f32 v[24:25], v[24:25], v[10:11] op_sel_hi:[1,0]
    v_pk_mul_f32 v[26:27], v[26:27], v[10:11] op_sel_hi:[1,0]
    v_cvt_pk_bf16_f32 v20, v20, v21
    v_cvt_pk_bf16_f32 v21, v22, v23
    v_cvt_pk_bf16_f32 v22, v24, v25
    v_cvt_pk_bf16_f32 v23, v26, v27
    buffer_store_dwordx4 v[20:23], v1, s[40:43], s72 offen offset:3072 sc1
    s_waitcnt lgkmcnt(0)
    s_barrier
    s_sub_u32 s30, s47, s75
    s_sub_u32 s31, s79, s75
    v_bfe_u32 v20, v1, 4, 4
    v_lshrrev_b32 v21, 8, v1
    s_lshl_b32 s98, s4, 4
    s_add_u32 s98, s98, 16
    v_add_u32 v22, s98, v20
    v_mul_u32_u24 v22, 144, v22
    v_add_u32 v22, s30, v22
    v_lshl_add_u32 v9, v21, 3, v22
    s_lshr_b32 s98, s73, 1
    v_add_u32 v8, s98, v9
    v_subrev_u32 v10, s98, v9
    s_sub_u32 s99, s31, s30
    v_add_u32 v24, s99, v8
    v_add_u32 v25, s99, v9
    v_add_u32 v26, s99, v10
    s_bitcmp1_b32 s4, 0
    s_cselect_b32 s99, s31, s30
    v_mul_u32_u24 v23, 144, v20
    v_lshl_add_u32 v23, v21, 3, v23
    v_add_u32 v13, s99, v23
    v_add_u32 v12, s98, v13
    v_accvgpr_read_b32 v32, a64
    v_accvgpr_read_b32 v33, a65
    v_accvgpr_read_b32 v34, a66
    v_accvgpr_read_b32 v35, a67
    v_cvt_pk_bf16_f32 v32, v32, v33
    v_cvt_pk_bf16_f32 v33, v34, v35
    ds_write_b64 v8, v[32:33] offset:0
    v_accvgpr_read_b32 v36, a68
    v_accvgpr_read_b32 v37, a69
    v_accvgpr_read_b32 v38, a70
    v_accvgpr_read_b32 v39, a71
    v_cvt_pk_bf16_f32 v36, v36, v37
    v_cvt_pk_bf16_f32 v37, v38, v39
    ds_write_b64 v8, v[36:37] offset:9216
    v_accvgpr_read_b32 v40, a72
    v_accvgpr_read_b32 v41, a73
    v_accvgpr_read_b32 v42, a74
    v_accvgpr_read_b32 v43, a75
    v_cvt_pk_bf16_f32 v40, v40, v41
    v_cvt_pk_bf16_f32 v41, v42, v43
    ds_write_b64 v24, v[40:41] offset:0
    v_accvgpr_read_b32 v44, a76
    v_accvgpr_read_b32 v45, a77
    v_accvgpr_read_b32 v46, a78
    v_accvgpr_read_b32 v47, a79
    v_cvt_pk_bf16_f32 v44, v44, v45
    v_cvt_pk_bf16_f32 v45, v46, v47
    ds_write_b64 v24, v[44:45] offset:9216
    v_accvgpr_read_b32 v32, a80
    v_accvgpr_read_b32 v33, a81
    v_accvgpr_read_b32 v34, a82
    v_accvgpr_read_b32 v35, a83
    v_cvt_pk_bf16_f32 v32, v32, v33
    v_cvt_pk_bf16_f32 v33, v34, v35
    ds_write_b64 v9, v[32:33] offset:32
    v_accvgpr_read_b32 v36, a84
    v_accvgpr_read_b32 v37, a85
    v_accvgpr_read_b32 v38, a86
    v_accvgpr_read_b32 v39, a87
    v_cvt_pk_bf16_f32 v36, v36, v37
    v_cvt_pk_bf16_f32 v37, v38, v39
    ds_write_b64 v9, v[36:37] offset:9248
    v_accvgpr_read_b32 v40, a88
    v_accvgpr_read_b32 v41, a89
    v_accvgpr_read_b32 v42, a90
    v_accvgpr_read_b32 v43, a91
    v_cvt_pk_bf16_f32 v40, v40, v41
    v_cvt_pk_bf16_f32 v41, v42, v43
    ds_write_b64 v25, v[40:41] offset:32
    v_accvgpr_read_b32 v44, a92
    v_accvgpr_read_b32 v45, a93
    v_accvgpr_read_b32 v46, a94
    v_accvgpr_read_b32 v47, a95
    v_cvt_pk_bf16_f32 v44, v44, v45
    v_cvt_pk_bf16_f32 v45, v46, v47
    ds_write_b64 v25, v[44:45] offset:9248
    v_accvgpr_read_b32 v32, a96
    v_accvgpr_read_b32 v33, a97
    v_accvgpr_read_b32 v34, a98
    v_accvgpr_read_b32 v35, a99
    v_cvt_pk_bf16_f32 v32, v32, v33
    v_cvt_pk_bf16_f32 v33, v34, v35
    ds_write_b64 v10, v[32:33] offset:64
    v_accvgpr_read_b32 v36, a100
    v_accvgpr_read_b32 v37, a101
    v_accvgpr_read_b32 v38, a102
    v_accvgpr_read_b32 v39, a103
    v_cvt_pk_bf16_f32 v36, v36, v37
    v_cvt_pk_bf16_f32 v37, v38, v39
    ds_write_b64 v10, v[36:37] offset:9280
    v_accvgpr_read_b32 v40, a104
    v_accvgpr_read_b32 v41, a105
    v_accvgpr_read_b32 v42, a106
    v_accvgpr_read_b32 v43, a107
    v_cvt_pk_bf16_f32 v40, v40, v41
    v_cvt_pk_bf16_f32 v41, v42, v43
    ds_write_b64 v26, v[40:41] offset:64
    v_accvgpr_read_b32 v44, a108
    v_accvgpr_read_b32 v45, a109
    v_accvgpr_read_b32 v46, a110
    v_accvgpr_read_b32 v47, a111
    v_cvt_pk_bf16_f32 v44, v44, v45
    v_cvt_pk_bf16_f32 v45, v46, v47
    ds_write_b64 v26, v[44:45] offset:9280
    v_accvgpr_read_b32 v32, a112
    v_accvgpr_read_b32 v33, a113
    v_accvgpr_read_b32 v34, a114
    v_accvgpr_read_b32 v35, a115
    v_cvt_pk_bf16_f32 v32, v32, v33
    v_cvt_pk_bf16_f32 v33, v34, v35
    ds_write_b64 v9, v[32:33] offset:96
    v_accvgpr_read_b32 v36, a116
    v_accvgpr_read_b32 v37, a117
    v_accvgpr_read_b32 v38, a118
    v_accvgpr_read_b32 v39, a119
    v_cvt_pk_bf16_f32 v36, v36, v37
    v_cvt_pk_bf16_f32 v37, v38, v39
    ds_write_b64 v9, v[36:37] offset:9312
    v_accvgpr_read_b32 v40, a120
    v_accvgpr_read_b32 v41, a121
    v_accvgpr_read_b32 v42, a122
    v_accvgpr_read_b32 v43, a123
    v_cvt_pk_bf16_f32 v40, v40, v41
    v_cvt_pk_bf16_f32 v41, v42, v43
    ds_write_b64 v25, v[40:41] offset:96
    v_accvgpr_read_b32 v44, a124
    v_accvgpr_read_b32 v45, a125
    v_accvgpr_read_b32 v46, a126
    v_accvgpr_read_b32 v47, a127
    v_cvt_pk_bf16_f32 v44, v44, v45
    v_cvt_pk_bf16_f32 v45, v46, v47
    s_waitcnt lgkmcnt(14)
    ds_write_b64 v25, v[44:45] offset:9312
    v_accvgpr_read_b32 v32, a128
    v_accvgpr_read_b32 v33, a129
    v_accvgpr_read_b32 v34, a130
    v_accvgpr_read_b32 v35, a131
    v_cvt_pk_bf16_f32 v32, v32, v33
    v_cvt_pk_bf16_f32 v33, v34, v35
    s_waitcnt lgkmcnt(14)
    ds_write_b64 v12, v[32:33] offset:0
    v_accvgpr_read_b32 v36, a132
    v_accvgpr_read_b32 v37, a133
    v_accvgpr_read_b32 v38, a134
    v_accvgpr_read_b32 v39, a135
    v_cvt_pk_bf16_f32 v36, v36, v37
    v_cvt_pk_bf16_f32 v37, v38, v39
    s_cmp_eq_u32 s73, 0
    s_cselect_b64 exec, -1, 0
    s_waitcnt lgkmcnt(14)
    ds_write_b64 v13, v[36:37] offset:32
    s_mov_b64 exec, -1
    s_cmp_lg_u64 s[84:85], 0
    s_cselect_b32 s7, 1, 0
    v_mov_b32 v20, s7
    s_lshl2_add_u32 s98, s4, s30
    v_mov_b32 v21, s98
    s_waitcnt lgkmcnt(14)
    ds_write_b32 v21, v20 offset:20736
    v_mov_b32 v21, s30
    s_and_b32 s98, s4, 1
    s_lshl_b32 s98, s98, 6
    v_lshrrev_b32 v14, 4, v1
    v_add_u32 v14, s98, v14
    s_sub_u32 s7, 15, s6
    s_cmp_lt_u32 s4, 2
    s_cselect_b32 s7, s6, s7
    s_cselect_b32 s99, s30, s31
    s_lshl_b32 s7, s7, 7
    v_add_u32 v2, 2, v14
    v_mul_u32_u24 v2, 144, v2
    v_add_u32 v2, s99, v2
    v_add_u32 v14, s7, v14
    v_lshrrev_b32 v15, 4, v14
    s_mov_b32 s98, 155648
    v_mul_lo_u32 v15, v15, s98
    v_and_b32 v23, 0xf0, v1
    v_add_u32 v15, v15, v23
    s_lshl2_add_u32 s98, s62, s4
    s_mul_i32 s98, s98, 311296
    v_add_u32 v4, s98, v1
    v_add_u32 v5, 155648, v4
    v_bfe_u32 v19, v1, 4, 3
    v_lshlrev_b32 v19, 7, v19
    v_subrev_u32 v23, s75, v1
    v_add_u32 v11, s44, v23
    v_add_u32 v12, s45, v23
    v_add_u32 v13, s46, v23
    v_add_u32 v6, s47, v23
    v_add_u32 v7, s79, v23
    s_mov_b32 s98, 0xbfb8aa3b
    s_mov_b32 s99, 0x3eae1a93
    s_waitcnt vmcnt(0) lgkmcnt(0)
    s_barrier
    ds_read_b128 v[24:27], v21 offset:20736
    ds_read_b128 v[32:35], v2 offset:2016
    ds_read_b128 v[36:39], v2 offset:2032
    ds_read_b128 v[40:43], v2 offset:2048
    ds_read_b128 v[44:47], v2 offset:1728
    ds_read_b128 v[48:51], v2 offset:1744
    ds_read_b128 v[52:55], v2 offset:1760
    s_waitcnt lgkmcnt(6)
    v_or3_b32 v24, v24, v25, v26
    v_or_b32 v24, v24, v27
    s_nop 0
    v_readfirstlane_b32 s7, v24
    s_nop 1
    s_andn2_b32 s7, s7, s83
    s_cbranch_scc1 K1_REDO
    v_mov_b32 v31, 2
    buffer_store_dword v31, v30, s[32:35], s101 offen sc1
    buffer_load_dword v28, v29, s[32:35], s92 offen sc1
    ds_read_b128 v[128:131], v2 offset:2096
    ds_read_b128 v[132:135], v2 offset:2112
    ds_read_b128 v[136:139], v2 offset:2128
    ds_read_b128 v[56:59], v2 offset:1440
    ds_read_b128 v[60:63], v2 offset:1456
    ds_read_b128 v[64:67], v2 offset:1472
    ds_read_b128 v[68:71], v2 offset:1152
    ds_read_b128 v[72:75], v2 offset:1168
    ds_read_b128 v[76:79], v2 offset:1184
    s_waitcnt lgkmcnt(8)
    v_dot2_f32_bf16 v140, v128, v32, 0
    v_dot2_f32_bf16 v141, v128, v44, 0
    ds_read_b128 v[80:83], v2 offset:864
    s_waitcnt lgkmcnt(6)
    v_dot2_f32_bf16 v142, v128, v56, 0
    s_waitcnt lgkmcnt(3)
    v_dot2_f32_bf16 v143, v128, v68, 0
    ds_read_b128 v[84:87], v2 offset:880
    v_dot2c_f32_bf16 v140, v129, v33
    v_dot2c_f32_bf16 v141, v129, v45
    ds_read_b128 v[88:91], v2 offset:896
    v_dot2c_f32_bf16 v142, v129, v57
    v_dot2c_f32_bf16 v143, v129, v69
    ds_read_b128 v[92:95], v2 offset:576
    v_dot2c_f32_bf16 v140, v130, v34
    v_dot2c_f32_bf16 v141, v130, v46
    ds_read_b128 v[96:99], v2 offset:592
    v_dot2c_f32_bf16 v142, v130, v58
    v_dot2c_f32_bf16 v143, v130, v70
    ds_read_b128 v[100:103], v2 offset:608
    v_dot2c_f32_bf16 v140, v131, v35
    v_dot2c_f32_bf16 v141, v131, v47
    ds_read_b128 v[104:107], v2 offset:288
    v_dot2c_f32_bf16 v142, v131, v59
    v_dot2c_f32_bf16 v143, v131, v71
    ds_read_b128 v[108:111], v2 offset:304
    v_dot2c_f32_bf16 v140, v132, v36
    v_dot2c_f32_bf16 v141, v132, v48
    ds_read_b128 v[112:115], v2 offset:320
    v_dot2c_f32_bf16 v142, v132, v60
    s_waitcnt lgkmcnt(10)
    v_dot2c_f32_bf16 v143, v132, v72
    ds_read_b128 v[116:119], v2 offset:0
    v_dot2c_f32_bf16 v140, v133, v37
    v_dot2c_f32_bf16 v141, v133, v49
    ds_read_b128 v[120:123], v2 offset:16
    v_dot2c_f32_bf16 v142, v133, v61
    v_dot2c_f32_bf16 v143, v133, v73
    ds_read_b128 v[124:127], v2 offset:32
    v_dot2c_f32_bf16 v140, v134, v38
    v_dot2c_f32_bf16 v141, v134, v50
    v_dot2c_f32_bf16 v142, v134, v62
    v_dot2c_f32_bf16 v143, v134, v74
    v_dot2c_f32_bf16 v140, v135, v39
    v_dot2c_f32_bf16 v141, v135, v51
    v_dot2c_f32_bf16 v142, v135, v63
    v_dot2c_f32_bf16 v143, v135, v75
    v_dot2c_f32_bf16 v140, v136, v40
    v_dot2c_f32_bf16 v141, v136, v52
    v_dot2c_f32_bf16 v142, v136, v64
    s_waitcnt lgkmcnt(12)
    v_dot2c_f32_bf16 v143, v136, v76
    s_waitcnt lgkmcnt(11)
    v_dot2_f32_bf16 v144, v128, v80, 0
    s_waitcnt lgkmcnt(8)
    v_dot2_f32_bf16 v145, v128, v92, 0
    ds_read_b128 v[32:35], v2 offset:2064
    s_waitcnt lgkmcnt(6)
    v_dot2_f32_bf16 v146, v128, v104, 0
    s_waitcnt lgkmcnt(3)
    v_dot2_f32_bf16 v147, v128, v116, 0
    ds_read_b128 v[36:39], v2 offset:2080
    v_dot2c_f32_bf16 v144, v129, v81
    v_dot2c_f32_bf16 v145, v129, v93
    ds_read_b128 v[44:47], v2 offset:1776
    v_dot2c_f32_bf16 v146, v129, v105
    v_dot2c_f32_bf16 v147, v129, v117
    ds_read_b128 v[48:51], v2 offset:1792
    v_dot2c_f32_bf16 v144, v130, v82
    v_dot2c_f32_bf16 v145, v130, v94
    ds_read_b128 v[56:59], v2 offset:1488
    v_dot2c_f32_bf16 v146, v130, v106
    v_dot2c_f32_bf16 v147, v130, v118
    ds_read_b128 v[60:63], v2 offset:1504
    v_dot2c_f32_bf16 v144, v131, v83
    v_dot2c_f32_bf16 v145, v131, v95
    ds_read_b128 v[68:71], v2 offset:1200
    v_dot2c_f32_bf16 v146, v131, v107
    v_dot2c_f32_bf16 v147, v131, v119
    ds_read_b128 v[72:75], v2 offset:1216
    v_dot2c_f32_bf16 v144, v132, v84
    v_dot2c_f32_bf16 v145, v132, v96
    v_dot2c_f32_bf16 v146, v132, v108
    s_waitcnt lgkmcnt(9)
    v_dot2c_f32_bf16 v147, v132, v120
    v_dot2c_f32_bf16 v144, v133, v85
    v_dot2c_f32_bf16 v145, v133, v97
    v_dot2c_f32_bf16 v146, v133, v109
    v_dot2c_f32_bf16 v147, v133, v121
    v_dot2c_f32_bf16 v144, v134, v86
    v_dot2c_f32_bf16 v145, v134, v98
    v_dot2c_f32_bf16 v146, v134, v110
    v_dot2c_f32_bf16 v147, v134, v122
    v_dot2c_f32_bf16 v144, v135, v87
    v_dot2c_f32_bf16 v145, v135, v99
    v_dot2c_f32_bf16 v146, v135, v111
    v_dot2c_f32_bf16 v147, v135, v123
    v_dot2c_f32_bf16 v144, v136, v88
    v_dot2c_f32_bf16 v145, v136, v100
    v_dot2c_f32_bf16 v146, v136, v112
    s_waitcnt lgkmcnt(8)
    v_dot2c_f32_bf16 v147, v136, v124
    v_lshlrev_b32 v8, 16, v138
    v_mul_f32 v8, s98, v8
    v_exp_f32 v8, v8
    v_mov_b32 v9, 0xf149f2ca
    ds_read_b128 v[80:83], v2 offset:912
    v_cmp_le_u32 vcc, 2, v14
    ds_read_b128 v[84:87], v2 offset:928
    s_nop 0
    v_cndmask_b32 v141, v9, v141, vcc
    v_cmp_le_u32 vcc, 4, v14
    ds_read_b128 v[92:95], v2 offset:624
    s_nop 0
    v_cndmask_b32 v142, v9, v142, vcc
    v_cmp_le_u32 vcc, 6, v14
    ds_read_b128 v[96:99], v2 offset:640
    s_nop 0
    v_cndmask_b32 v143, v9, v143, vcc
    v_cmp_le_u32 vcc, 8, v14
    ds_read_b128 v[104:107], v2 offset:336
    s_nop 0
    v_cndmask_b32 v144, v9, v144, vcc
    v_cmp_le_u32 vcc, 10, v14
    ds_read_b128 v[108:111], v2 offset:352
    s_nop 0
    v_cndmask_b32 v145, v9, v145, vcc
    v_cmp_le_u32 vcc, 12, v14
    ds_read_b128 v[116:119], v2 offset:48
    s_nop 0
    v_cndmask_b32 v146, v9, v146, vcc
    v_cmp_le_u32 vcc, 14, v14
    s_waitcnt lgkmcnt(14)
    ds_read_b128 v[120:123], v2 offset:64
    s_nop 0
    v_cndmask_b32 v147, v9, v147, vcc
    v_max3_f32 v9, v140, v141, v142
    v_max3_f32 v10, v143, v144, v145
    v_max3_f32 v9, v9, v146, v147
    v_max_f32 v9, v9, v10
    v_mul_f32 v9, s99, v9
    v_add_f32 v8, 1.0, v8
    v_fma_f32 v140, v140, s99, -v9
    v_fma_f32 v141, v141, s99, -v9
    v_fma_f32 v142, v142, s99, -v9
    v_fma_f32 v143, v143, s99, -v9
    v_fma_f32 v144, v144, s99, -v9
    v_fma_f32 v145, v145, s99, -v9
    v_fma_f32 v146, v146, s99, -v9
    v_fma_f32 v147, v147, s99, -v9
    buffer_load_dword v3, v19, s[32:35], s66 offen sc1
    v_exp_f32 v140, v140
    v_exp_f32 v141, v141
    v_exp_f32 v142, v142
    v_exp_f32 v143, v143
    v_exp_f32 v144, v144
    v_exp_f32 v145, v145
    v_exp_f32 v146, v146
    v_exp_f32 v147, v147
    v_add_f32 v10, v140, v141
    v_add_f32 v10, v10, v142
    v_add_f32 v10, v10, v143
    v_add_f32 v10, v10, v144
    v_add_f32 v10, v10, v145
    v_add_f32 v10, v10, v146
    v_add_f32 v10, v10, v147
    v_mul_f32 v10, v10, v8
    v_rcp_f32 v10, v10
    s_nop 0
    v_mul_f32 v140, v140, v10
    v_mul_f32 v141, v141, v10
    v_mul_f32 v142, v142, v10
    v_mul_f32 v143, v143, v10
    v_mul_f32 v144, v144, v10
    v_mul_f32 v145, v145, v10
    v_mul_f32 v146, v146, v10
    v_mul_f32 v147, v147, v10
    v_cvt_pk_bf16_f32 v148, 0, v140
    v_cvt_pk_bf16_f32 v149, 0, v141
    v_cvt_pk_bf16_f32 v150, 0, v142
    v_cvt_pk_bf16_f32 v151, 0, v143
    v_cvt_pk_bf16_f32 v152, 0, v144
    v_cvt_pk_bf16_f32 v153, 0, v145
    v_cvt_pk_bf16_f32 v154, 0, v146
    v_cvt_pk_bf16_f32 v155, 0, v147
    v_lshrrev_b32 v140, 16, v148
    v_lshrrev_b32 v141, 16, v149
    v_lshrrev_b32 v142, 16, v150
    v_lshrrev_b32 v143, 16, v151
    v_lshrrev_b32 v144, 16, v152
    v_lshrrev_b32 v145, 16, v153
    v_lshrrev_b32 v146, 16, v154
    v_lshrrev_b32 v147, 16, v155
    v_dot2_f32_bf16 v128, v42, v140, 0
    v_dot2_f32_bf16 v129, v42, v148, 0
    v_dot2_f32_bf16 v130, v43, v140, 0
    v_dot2_f32_bf16 v131, v43, v148, 0
    v_dot2_f32_bf16 v132, v32, v140, 0
    v_dot2_f32_bf16 v133, v32, v148, 0
    v_dot2_f32_bf16 v134, v33, v140, 0
    v_dot2_f32_bf16 v135, v33, v148, 0
    v_dot2_f32_bf16 v136, v34, v140, 0
    v_dot2_f32_bf16 v137, v34, v148, 0
    v_dot2_f32_bf16 v138, v35, v140, 0
    v_dot2_f32_bf16 v139, v35, v148, 0
    s_waitcnt lgkmcnt(14)
    v_dot2_f32_bf16 v156, v36, v140, 0
    v_dot2_f32_bf16 v157, v36, v148, 0
    v_dot2_f32_bf16 v158, v37, v140, 0
    v_dot2_f32_bf16 v159, v37, v148, 0
    v_dot2_f32_bf16 v17, v38, v140, 0
    v_dot2_f32_bf16 v18, v38, v148, 0
    s_waitcnt vmcnt(0)
    v_cmp_gt_u32 vcc, 2, v3
    s_nop 1
    s_and_b64 vcc, vcc, exec
    s_cbranch_scc1 SPIN_CTX
BACK_CTX:
    buffer_load_dwordx4 a[0:3], v4, s[40:43], s63 offen offset:0 sc1
    v_dot2c_f32_bf16 v128, v54, v141
    v_dot2c_f32_bf16 v129, v54, v149
    v_dot2c_f32_bf16 v130, v55, v141
    v_dot2c_f32_bf16 v131, v55, v149
    s_waitcnt lgkmcnt(13)
    v_dot2c_f32_bf16 v132, v44, v141
    v_dot2c_f32_bf16 v133, v44, v149
    v_dot2c_f32_bf16 v134, v45, v141
    v_dot2c_f32_bf16 v135, v45, v149
    buffer_load_dwordx4 a[4:7], v5, s[40:43], s63 offen offset:0 sc1
    v_dot2c_f32_bf16 v136, v46, v141
    v_dot2c_f32_bf16 v137, v46, v149
    v_dot2c_f32_bf16 v138, v47, v141
    v_dot2c_f32_bf16 v139, v47, v149
    s_waitcnt lgkmcnt(12)
    v_dot2c_f32_bf16 v156, v48, v141
    v_dot2c_f32_bf16 v157, v48, v149
    v_dot2c_f32_bf16 v158, v49, v141
    v_dot2c_f32_bf16 v159, v49, v149
    v_dot2c_f32_bf16 v17, v50, v141
    buffer_load_dwordx4 a[8:11], v4, s[40:43], s63 offen offset:1024 sc1
    v_dot2c_f32_bf16 v18, v50, v149
    v_dot2c_f32_bf16 v128, v66, v142
    v_dot2c_f32_bf16 v129, v66, v150
    v_dot2c_f32_bf16 v130, v67, v142
    v_dot2c_f32_bf16 v131, v67, v150
    s_waitcnt lgkmcnt(11)
    v_dot2c_f32_bf16 v132, v56, v142
    v_dot2c_f32_bf16 v133, v56, v150
    v_dot2c_f32_bf16 v134, v57, v142
    buffer_load_dwordx4 a[12:15], v5, s[40:43], s63 offen offset:1024 sc1
    v_dot2c_f32_bf16 v135, v57, v150
    v_dot2c_f32_bf16 v136, v58, v142
    v_dot2c_f32_bf16 v137, v58, v150
    v_dot2c_f32_bf16 v138, v59, v142
    v_dot2c_f32_bf16 v139, v59, v150
    s_waitcnt lgkmcnt(10)
    v_dot2c_f32_bf16 v156, v60, v142
    v_dot2c_f32_bf16 v157, v60, v150
    v_dot2c_f32_bf16 v158, v61, v142
    v_dot2c_f32_bf16 v159, v61, v150
    buffer_load_dwordx4 a[16:19], v4, s[40:43], s63 offen offset:2048 sc1
    v_dot2c_f32_bf16 v17, v62, v142
    v_dot2c_f32_bf16 v18, v62, v150
    v_dot2c_f32_bf16 v128, v78, v143
    v_dot2c_f32_bf16 v129, v78, v151
    v_dot2c_f32_bf16 v130, v79, v143
    v_dot2c_f32_bf16 v131, v79, v151
    s_waitcnt lgkmcnt(9)
    v_dot2c_f32_bf16 v132, v68, v143
    v_dot2c_f32_bf16 v133, v68, v151
    v_dot2c_f32_bf16 v134, v69, v143
    buffer_load_dwordx4 a[20:23], v5, s[40:43], s63 offen offset:2048 sc1
    v_dot2c_f32_bf16 v135, v69, v151
    v_dot2c_f32_bf16 v136, v70, v143
    v_dot2c_f32_bf16 v137, v70, v151
    v_dot2c_f32_bf16 v138, v71, v143
    v_dot2c_f32_bf16 v139, v71, v151
    s_waitcnt lgkmcnt(8)
    v_dot2c_f32_bf16 v156, v72, v143
    v_dot2c_f32_bf16 v157, v72, v151
    v_dot2c_f32_bf16 v158, v73, v143
    buffer_load_dwordx4 a[24:27], v4, s[40:43], s63 offen offset:3072 sc1
    v_dot2c_f32_bf16 v159, v73, v151
    v_dot2c_f32_bf16 v17, v74, v143
    v_dot2c_f32_bf16 v18, v74, v151
    v_dot2c_f32_bf16 v128, v90, v144
    v_dot2c_f32_bf16 v129, v90, v152
    v_dot2c_f32_bf16 v130, v91, v144
    v_dot2c_f32_bf16 v131, v91, v152
    s_waitcnt lgkmcnt(7)
    v_dot2c_f32_bf16 v132, v80, v144
    v_dot2c_f32_bf16 v133, v80, v152
    buffer_load_dwordx4 a[28:31], v5, s[40:43], s63 offen offset:3072 sc1
    v_dot2c_f32_bf16 v134, v81, v144
    v_dot2c_f32_bf16 v135, v81, v152
    v_dot2c_f32_bf16 v136, v82, v144
    v_dot2c_f32_bf16 v137, v82, v152
    v_dot2c_f32_bf16 v138, v83, v144
    v_dot2c_f32_bf16 v139, v83, v152
    s_waitcnt lgkmcnt(6)
    v_dot2c_f32_bf16 v156, v84, v144
    v_dot2c_f32_bf16 v157, v84, v152
    v_dot2c_f32_bf16 v158, v85, v144
    s_xor_b32 s63, s63, 4096
    buffer_load_dwordx4 a[32:35], v4, s[40:43], s63 offen offset:0 sc1
    v_dot2c_f32_bf16 v159, v85, v152
    v_dot2c_f32_bf16 v17, v86, v144
    v_dot2c_f32_bf16 v18, v86, v152
    v_dot2c_f32_bf16 v128, v102, v145
    v_dot2c_f32_bf16 v129, v102, v153
    v_dot2c_f32_bf16 v130, v103, v145
    v_dot2c_f32_bf16 v131, v103, v153
    s_waitcnt lgkmcnt(5)
    v_dot2c_f32_bf16 v132, v92, v145
    buffer_load_dwordx4 a[36:39], v5, s[40:43], s63 offen offset:0 sc1
    v_dot2c_f32_bf16 v133, v92, v153
    v_dot2c_f32_bf16 v134, v93, v145
    v_dot2c_f32_bf16 v135, v93, v153
    v_dot2c_f32_bf16 v136, v94, v145
    v_dot2c_f32_bf16 v137, v94, v153
    v_dot2c_f32_bf16 v138, v95, v145
    v_dot2c_f32_bf16 v139, v95, v153
    s_waitcnt lgkmcnt(4)
    v_dot2c_f32_bf16 v156, v96, v145
    v_dot2c_f32_bf16 v157, v96, v153
    buffer_load_dwordx4 a[40:43], v4, s[40:43], s63 offen offset:1024 sc1
    v_dot2c_f32_bf16 v158, v97, v145
    v_dot2c_f32_bf16 v159, v97, v153
    v_dot2c_f32_bf16 v17, v98, v145
    v_dot2c_f32_bf16 v18, v98, v153
    v_dot2c_f32_bf16 v128, v114, v146
    v_dot2c_f32_bf16 v129, v114, v154
    v_dot2c_f32_bf16 v130, v115, v146
    v_dot2c_f32_bf16 v131, v115, v154
    buffer_load_dwordx4 a[44:47], v5, s[40:43], s63 offen offset:1024 sc1
    s_waitcnt lgkmcnt(3)
    v_dot2c_f32_bf16 v132, v104, v146
    v_dot2c_f32_bf16 v133, v104, v154
    v_dot2c_f32_bf16 v134, v105, v146
    v_dot2c_f32_bf16 v135, v105, v154
    v_dot2c_f32_bf16 v136, v106, v146
    v_dot2c_f32_bf16 v137, v106, v154
    v_dot2c_f32_bf16 v138, v107, v146
    v_dot2c_f32_bf16 v139, v107, v154
    s_waitcnt lgkmcnt(2)
    v_dot2c_f32_bf16 v156, v108, v146
    buffer_load_dwordx4 a[48:51], v4, s[40:43], s63 offen offset:2048 sc1
    v_dot2c_f32_bf16 v157, v108, v154
    v_dot2c_f32_bf16 v158, v109, v146
    v_dot2c_f32_bf16 v159, v109, v154
    v_dot2c_f32_bf16 v17, v110, v146
    v_dot2c_f32_bf16 v18, v110, v154
    v_dot2c_f32_bf16 v128, v126, v147
    v_dot2c_f32_bf16 v129, v126, v155
    v_dot2c_f32_bf16 v130, v127, v147
    v_dot2c_f32_bf16 v131, v127, v155
    buffer_load_dwordx4 a[52:55], v5, s[40:43], s63 offen offset:2048 sc1
    s_waitcnt lgkmcnt(1)
    v_dot2c_f32_bf16 v132, v116, v147
    v_dot2c_f32_bf16 v133, v116, v155
    v_dot2c_f32_bf16 v134, v117, v147
    v_dot2c_f32_bf16 v135, v117, v155
    v_dot2c_f32_bf16 v136, v118, v147
    v_dot2c_f32_bf16 v137, v118, v155
    v_dot2c_f32_bf16 v138, v119, v147
    v_dot2c_f32_bf16 v139, v119, v155
    buffer_load_dwordx4 a[56:59], v4, s[40:43], s63 offen offset:3072 sc1
    s_waitcnt lgkmcnt(0)
    v_dot2c_f32_bf16 v156, v120, v147
    v_dot2c_f32_bf16 v157, v120, v155
    v_dot2c_f32_bf16 v158, v121, v147
    v_dot2c_f32_bf16 v159, v121, v155
    v_dot2c_f32_bf16 v17, v122, v147
    v_dot2c_f32_bf16 v18, v122, v155
    v_mov_b32 v89, 0
    v_mov_b32 v90, 0
    v_mov_b32 v91, 0
    buffer_load_dwordx4 a[60:63], v5, s[40:43], s63 offen offset:3072 sc1
    s_xor_b32 s63, s63, 12288
    v_cvt_pk_bf16_f32 v80, v128, v129
    v_cvt_pk_bf16_f32 v81, v130, v131
    v_cvt_pk_bf16_f32 v82, v132, v133
    v_cvt_pk_bf16_f32 v83, v134, v135
    v_cvt_pk_bf16_f32 v84, v136, v137
    v_cvt_pk_bf16_f32 v85, v138, v139
    v_cvt_pk_bf16_f32 v86, v156, v157
    v_cvt_pk_bf16_f32 v87, v158, v159
    v_cvt_pk_bf16_f32 v88, v17, v18
    v_cmp_gt_u32 vcc, 1, v28
    s_nop 1
    s_and_b64 vcc, vcc, exec
    s_cbranch_scc1 SPIN_ALL
BACK_ALL:
    s_waitcnt vmcnt(8)
    s_barrier
    ds_read_b128 v[104:107], v11 offset:0
    ds_read_b128 v[108:111], v11 offset:8192
    ds_read_b128 v[112:115], v11 offset:1024
    ds_read_b128 v[116:119], v11 offset:9216
    s_waitcnt lgkmcnt(3)
    v_mfma_f32_16x16x32_bf16 v[176:179], v[104:107], a[0:3], 0
    s_lshl3_add_u32 s98, 1, s5
    ds_read_b128 v[120:123], v11 offset:2048
    ds_read_b128 v[124:127], v11 offset:10240
    s_waitcnt lgkmcnt(4)
    v_mfma_f32_16x16x32_bf16 v[176:179], v[108:111], a[8:11], v[176:179]
    s_and_b32 s98, s98, 31
    buffer_load_dwordx4 a[64:67], v4, s[40:43], s63 offen offset:0 sc1
    v_mfma_f32_16x16x32_bf16 v[180:183], v[104:107], a[4:7], 0
    s_lshl_b32 s8, s6, 5
    ds_read_b128 v[128:131], v11 offset:3072
    ds_read_b128 v[132:135], v11 offset:11264
    v_mfma_f32_16x16x32_bf16 v[180:183], v[108:111], a[12:15], v[180:183]
    s_add_u32 s98, s98, s8
    buffer_load_dwordx4 a[68:71], v5, s[40:43], s63 offen offset:0 sc1
    s_waitcnt lgkmcnt(5)
    v_mfma_f32_16x16x32_bf16 v[184:187], v[112:115], a[0:3], 0
    s_mul_i32 s98, s98, 3
    ds_read_b128 v[136:139], v11 offset:4096
    ds_read_b128 v[140:143], v11 offset:12288
    s_waitcnt lgkmcnt(6)
    v_mfma_f32_16x16x32_bf16 v[184:187], v[116:119], a[8:11], v[184:187]
    s_sub_u32 s98, s98, 1
    ds_read_b128 v[144:147], v11 offset:5120
    v_mfma_f32_16x16x32_bf16 v[188:191], v[112:115], a[4:7], 0
    s_add_u32 s98, s98, 3
    ds_read_b128 v[148:151], v11 offset:13312
    v_mfma_f32_16x16x32_bf16 v[188:191], v[116:119], a[12:15], v[188:191]
    s_lshl2_add_u32 s98, s98, s4
    buffer_load_dwordx4 a[72:75], v4, s[40:43], s63 offen offset:1024 sc1
    s_waitcnt lgkmcnt(4)
    v_mfma_f32_16x16x32_bf16 v[192:195], v[120:123], a[0:3], 0
    s_mul_i32 s8, s98, 3072
    ds_read_b128 v[104:107], v11 offset:6144
    ds_read_b128 v[108:111], v11 offset:14336
    v_mfma_f32_16x16x32_bf16 v[192:195], v[124:127], a[8:11], v[192:195]
    s_lshl3_add_u32 s98, 2, s5
    ds_read_b128 v[112:115], v11 offset:16384
    v_mfma_f32_16x16x32_bf16 v[196:199], v[120:123], a[4:7], 0
    s_and_b32 s98, s98, 31
    ds_read_b128 v[116:119], v11 offset:24576
    v_mfma_f32_16x16x32_bf16 v[196:199], v[124:127], a[12:15], v[196:199]
    s_lshl_b32 s9, s6, 5
    buffer_load_dwordx4 a[76:79], v5, s[40:43], s63 offen offset:1024 sc1
    v_mfma_f32_16x16x32_bf16 v[200:203], v[128:131], a[0:3], 0
    s_add_u32 s98, s98, s9
    ds_read_b128 v[120:123], v11 offset:17408
    ds_read_b128 v[124:127], v11 offset:25600
    v_mfma_f32_16x16x32_bf16 v[200:203], v[132:135], a[8:11], v[200:203]
    s_mul_i32 s98, s98, 3
    v_mfma_f32_16x16x32_bf16 v[204:207], v[128:131], a[4:7], 0
    s_sub_u32 s98, s98, 2
    ds_read_b128 v[128:131], v11 offset:18432
    v_mfma_f32_16x16x32_bf16 v[204:207], v[132:135], a[12:15], v[204:207]
    s_add_u32 s98, s98, 3
    buffer_load_dwordx4 a[80:83], v4, s[40:43], s63 offen offset:2048 sc1
    s_waitcnt lgkmcnt(3)
    v_mfma_f32_16x16x32_bf16 v[208:211], v[136:139], a[0:3], 0
    s_lshl2_add_u32 s98, s98, s4
    ds_read_b128 v[132:135], v11 offset:26624
    v_mfma_f32_16x16x32_bf16 v[208:211], v[140:143], a[8:11], v[208:211]
    s_mul_i32 s9, s98, 3072
    v_mfma_f32_16x16x32_bf16 v[212:215], v[136:139], a[4:7], 0
    s_lshl3_add_u32 s98, 3, s5
    ds_read_b128 v[136:139], v11 offset:19456
    v_mfma_f32_16x16x32_bf16 v[212:215], v[140:143], a[12:15], v[212:215]
    s_and_b32 s98, s98, 31
    buffer_load_dwordx4 a[84:87], v5, s[40:43], s63 offen offset:2048 sc1
    v_mfma_f32_16x16x32_bf16 v[216:219], v[144:147], a[0:3], 0
    s_lshl_b32 s10, s6, 5
    ds_read_b128 v[140:143], v11 offset:27648
    v_mfma_f32_16x16x32_bf16 v[216:219], v[148:151], a[8:11], v[216:219]
    s_add_u32 s98, s98, s10
    v_mfma_f32_16x16x32_bf16 v[220:223], v[144:147], a[4:7], 0
    s_mul_i32 s98, s98, 3
    ds_read_b128 v[144:147], v11 offset:20480
    v_mfma_f32_16x16x32_bf16 v[220:223], v[148:151], a[12:15], v[220:223]
    s_sub_u32 s98, s98, 3
    buffer_load_dwordx4 a[88:91], v4, s[40:43], s63 offen offset:3072 sc1
    v_mfma_f32_16x16x32_bf16 v[224:227], v[104:107], a[0:3], 0
    s_add_u32 s98, s98, 3
    ds_read_b128 v[148:151], v11 offset:28672
    v_mfma_f32_16x16x32_bf16 v[224:227], v[108:111], a[8:11], v[224:227]
    s_lshl2_add_u32 s98, s98, s4
    v_mfma_f32_16x16x32_bf16 v[228:231], v[104:107], a[4:7], 0
    s_mul_i32 s10, s98, 3072
    ds_read_b128 v[104:107], v11 offset:21504
    v_mfma_f32_16x16x32_bf16 v[228:231], v[108:111], a[12:15], v[228:231]
    s_sub_u32 s99, s4, s61
    buffer_load_dwordx4 a[92:95], v5, s[40:43], s63 offen offset:3072 sc1
    v_mfma_f32_16x16x32_bf16 v[176:179], v[112:115], a[16:19], v[176:179]
    s_xor_b32 s63, s63, 4096
    ds_read_b128 v[108:111], v11 offset:29696
    v_mfma_f32_16x16x32_bf16 v[176:179], v[116:119], a[24:27], v[176:179]
    s_and_b32 s99, s99, 3
    v_mfma_f32_16x16x32_bf16 v[180:183], v[112:115], a[20:23], v[180:183]
    s_lshl3_add_u32 s98, s99, s5
    buffer_store_dwordx4 v[80:83], v15, s[40:43], s71 offen offset:0 sc1
    v_mfma_f32_16x16x32_bf16 v[180:183], v[116:119], a[28:31], v[180:183]
    s_and_b32 s98, s98, 31
    ds_read_b128 v[112:115], v11 offset:22528
    ds_read_b128 v[116:119], v11 offset:30720
    s_waitcnt lgkmcnt(3)
    v_mfma_f32_16x16x32_bf16 v[184:187], v[120:123], a[16:19], v[184:187]
    s_lshl_b32 s11, s6, 5
    v_mfma_f32_16x16x32_bf16 v[184:187], v[124:127], a[24:27], v[184:187]
    s_add_u32 s98, s98, s11
    v_mfma_f32_16x16x32_bf16 v[188:191], v[120:123], a[20:23], v[188:191]
    s_mul_i32 s98, s98, 3
    buffer_store_dwordx4 v[84:87], v15, s[40:43], s71 offen offset:256 sc1
    v_mfma_f32_16x16x32_bf16 v[188:191], v[124:127], a[28:31], v[188:191]
    s_sub_u32 s98, s98, s99
    ds_read_b128 v[120:123], v12 offset:0
    ds_read_b128 v[124:127], v12 offset:8192
    v_mfma_f32_16x16x32_bf16 v[192:195], v[128:131], a[16:19], v[192:195]
    s_add_u32 s98, s98, 3
    v_mfma_f32_16x16x32_bf16 v[192:195], v[132:135], a[24:27], v[192:195]
    s_lshl2_add_u32 s98, s98, s4
    v_mfma_f32_16x16x32_bf16 v[196:199], v[128:131], a[20:23], v[196:199]
    s_mul_i32 s11, s98, 3072
    buffer_store_dwordx4 v[88:91], v15, s[40:43], s71 offen offset:512 sc1
    v_mfma_f32_16x16x32_bf16 v[196:199], v[132:135], a[28:31], v[196:199]
    s_xor_b32 s21, s3, 3
    ds_read_b128 v[128:131], v12 offset:1024
    ds_read_b128 v[132:135], v12 offset:9216
    v_mfma_f32_16x16x32_bf16 v[200:203], v[136:139], a[16:19], v[200:203]
    s_lshl2_add_u32 s21, s21, s4
    v_mfma_f32_16x16x32_bf16 v[200:203], v[140:143], a[24:27], v[200:203]
    s_mul_i32 s21, s21, 36864
    v_mfma_f32_16x16x32_bf16 v[204:207], v[136:139], a[20:23], v[204:207]
    s_add_u32 s21, s21, s28
    s_mov_b32 m0, s47
    ds_read_b128 v[136:139], v12 offset:2048
    v_mfma_f32_16x16x32_bf16 v[204:207], v[140:143], a[28:31], v[204:207]
    s_waitcnt vmcnt(11)
    buffer_load_dwordx4 v1, s[56:59], s21 offen sc1 lds
    v_mfma_f32_16x16x32_bf16 v[208:211], v[144:147], a[16:19], v[208:211]
    ds_read_b128 v[140:143], v12 offset:10240
    v_mfma_f32_16x16x32_bf16 v[208:211], v[148:151], a[24:27], v[208:211]
    s_cmp_eq_u32 s99, 0
    s_cselect_b32 s11, 1073741824, s11
    v_mfma_f32_16x16x32_bf16 v[212:215], v[144:147], a[20:23], v[212:215]
    buffer_load_dwordx4 v1, s[56:59], s21 offen offset:1024 sc1 lds
    v_mfma_f32_16x16x32_bf16 v[212:215], v[148:151], a[28:31], v[212:215]
    ds_read_b128 v[144:147], v12 offset:3072
    ds_read_b128 v[148:151], v12 offset:11264
    v_mfma_f32_16x16x32_bf16 v[216:219], v[104:107], a[16:19], v[216:219]
    s_waitcnt lgkmcnt(3)
    v_mfma_f32_16x16x32_bf16 v[216:219], v[108:111], a[24:27], v[216:219]
    v_mfma_f32_16x16x32_bf16 v[220:223], v[104:107], a[20:23], v[220:223]
    buffer_load_dwordx4 v1, s[56:59], s21 offen offset:2048 sc1 lds
    v_mfma_f32_16x16x32_bf16 v[220:223], v[108:111], a[28:31], v[220:223]
    ds_read_b128 v[104:107], v12 offset:4096
    ds_read_b128 v[108:111], v12 offset:12288
    v_mfma_f32_16x16x32_bf16 v[224:227], v[112:115], a[16:19], v[224:227]
    v_mfma_f32_16x16x32_bf16 v[224:227], v[116:119], a[24:27], v[224:227]
    v_mfma_f32_16x16x32_bf16 v[228:231], v[112:115], a[20:23], v[228:231]
    buffer_load_dwordx4 v1, s[56:59], s21 offen offset:3072 sc1 lds
    v_mfma_f32_16x16x32_bf16 v[228:231], v[116:119], a[28:31], v[228:231]
    s_add_u32 s21, s21, 4096
    ds_read_b128 v[112:115], v12 offset:5120
    ds_read_b128 v[116:119], v12 offset:13312
    v_mfma_f32_16x16x32_bf16 v[176:179], v[120:123], a[32:35], v[176:179]
    s_add_u32 m0, s47, 4096
    v_mfma_f32_16x16x32_bf16 v[176:179], v[124:127], a[40:43], v[176:179]
    buffer_load_dwordx4 v1, s[56:59], s21 offen sc1 lds
    v_mfma_f32_16x16x32_bf16 v[180:183], v[120:123], a[36:39], v[180:183]
    ds_read_b128 v[120:123], v12 offset:6144
    v_mfma_f32_16x16x32_bf16 v[180:183], v[124:127], a[44:47], v[180:183]
    ds_read_b128 v[124:127], v12 offset:14336
    v_mfma_f32_16x16x32_bf16 v[184:187], v[128:131], a[32:35], v[184:187]
    v_mfma_f32_16x16x32_bf16 v[184:187], v[132:135], a[40:43], v[184:187]
    buffer_load_dwordx4 v1, s[56:59], s21 offen offset:1024 sc1 lds
    v_mfma_f32_16x16x32_bf16 v[188:191], v[128:131], a[36:39], v[188:191]
    ds_read_b128 v[128:131], v12 offset:16384
    v_mfma_f32_16x16x32_bf16 v[188:191], v[132:135], a[44:47], v[188:191]
    ds_read_b128 v[132:135], v12 offset:24576
    v_mfma_f32_16x16x32_bf16 v[192:195], v[136:139], a[32:35], v[192:195]
    s_waitcnt lgkmcnt(2)
    v_mfma_f32_16x16x32_bf16 v[192:195], v[140:143], a[40:43], v[192:195]
    buffer_load_dwordx4 v1, s[56:59], s21 offen offset:2048 sc1 lds
    v_mfma_f32_16x16x32_bf16 v[196:199], v[136:139], a[36:39], v[196:199]
    ds_read_b128 v[136:139], v12 offset:17408
    v_mfma_f32_16x16x32_bf16 v[196:199], v[140:143], a[44:47], v[196:199]
    ds_read_b128 v[140:143], v12 offset:25600
    v_mfma_f32_16x16x32_bf16 v[200:203], v[144:147], a[32:35], v[200:203]
    v_mfma_f32_16x16x32_bf16 v[200:203], v[148:151], a[40:43], v[200:203]
    buffer_load_dwordx4 a[96:99], v4, s[40:43], s63 offen offset:0 sc1
    v_mfma_f32_16x16x32_bf16 v[204:207], v[144:147], a[36:39], v[204:207]
    ds_read_b128 v[144:147], v12 offset:18432
    v_mfma_f32_16x16x32_bf16 v[204:207], v[148:151], a[44:47], v[204:207]
    ds_read_b128 v[148:151], v12 offset:26624
    v_mfma_f32_16x16x32_bf16 v[208:211], v[104:107], a[32:35], v[208:211]
    v_mfma_f32_16x16x32_bf16 v[208:211], v[108:111], a[40:43], v[208:211]
    buffer_load_dwordx4 a[100:103], v5, s[40:43], s63 offen offset:0 sc1
    v_mfma_f32_16x16x32_bf16 v[212:215], v[104:107], a[36:39], v[212:215]
    ds_read_b128 v[104:107], v12 offset:19456
    v_mfma_f32_16x16x32_bf16 v[212:215], v[108:111], a[44:47], v[212:215]
    ds_read_b128 v[108:111], v12 offset:27648
    v_mfma_f32_16x16x32_bf16 v[216:219], v[112:115], a[32:35], v[216:219]
    v_mfma_f32_16x16x32_bf16 v[216:219], v[116:119], a[40:43], v[216:219]
    buffer_load_dwordx4 a[104:107], v4, s[40:43], s63 offen offset:1024 sc1
    v_mfma_f32_16x16x32_bf16 v[220:223], v[112:115], a[36:39], v[220:223]
    ds_read_b128 v[112:115], v12 offset:20480
    v_mfma_f32_16x16x32_bf16 v[220:223], v[116:119], a[44:47], v[220:223]
    ds_read_b128 v[116:119], v12 offset:28672
    v_mfma_f32_16x16x32_bf16 v[224:227], v[120:123], a[32:35], v[224:227]
    v_mfma_f32_16x16x32_bf16 v[224:227], v[124:127], a[40:43], v[224:227]
    buffer_load_dwordx4 a[108:111], v5, s[40:43], s63 offen offset:1024 sc1
    v_mfma_f32_16x16x32_bf16 v[228:231], v[120:123], a[36:39], v[228:231]
    ds_read_b128 v[120:123], v12 offset:21504
    v_mfma_f32_16x16x32_bf16 v[228:231], v[124:127], a[44:47], v[228:231]
    s_waitcnt lgkmcnt(2)
    ds_read_b128 v[124:127], v12 offset:29696
    v_mfma_f32_16x16x32_bf16 v[176:179], v[128:131], a[48:51], v[176:179]
    v_mfma_f32_16x16x32_bf16 v[176:179], v[132:135], a[56:59], v[176:179]
    buffer_load_dwordx4 a[112:115], v4, s[40:43], s63 offen offset:2048 sc1
    v_mfma_f32_16x16x32_bf16 v[180:183], v[128:131], a[52:55], v[180:183]
    ds_read_b128 v[128:131], v12 offset:22528
    v_mfma_f32_16x16x32_bf16 v[180:183], v[132:135], a[60:63], v[180:183]
    ds_read_b128 v[132:135], v12 offset:30720
    v_mfma_f32_16x16x32_bf16 v[184:187], v[136:139], a[48:51], v[184:187]
    buffer_load_dwordx4 a[116:119], v5, s[40:43], s63 offen offset:2048 sc1
    v_mfma_f32_16x16x32_bf16 v[184:187], v[140:143], a[56:59], v[184:187]
    v_mfma_f32_16x16x32_bf16 v[188:191], v[136:139], a[52:55], v[188:191]
    ds_read_b128 v[136:139], v13 offset:0
    v_mfma_f32_16x16x32_bf16 v[188:191], v[140:143], a[60:63], v[188:191]
    ds_read_b128 v[140:143], v13 offset:8192
    v_mfma_f32_16x16x32_bf16 v[192:195], v[144:147], a[48:51], v[192:195]
    buffer_load_dwordx4 a[120:123], v4, s[40:43], s63 offen offset:3072 sc1
    v_mfma_f32_16x16x32_bf16 v[192:195], v[148:151], a[56:59], v[192:195]
    v_mfma_f32_16x16x32_bf16 v[196:199], v[144:147], a[52:55], v[196:199]
    ds_read_b128 v[144:147], v13 offset:1024
    v_mfma_f32_16x16x32_bf16 v[196:199], v[148:151], a[60:63], v[196:199]
    ds_read_b128 v[148:151], v13 offset:9216
    v_mfma_f32_16x16x32_bf16 v[200:203], v[104:107], a[48:51], v[200:203]
    buffer_load_dwordx4 a[124:127], v5, s[40:43], s63 offen offset:3072 sc1
    v_mfma_f32_16x16x32_bf16 v[200:203], v[108:111], a[56:59], v[200:203]
    s_xor_b32 s21, s3, 4
    v_mfma_f32_16x16x32_bf16 v[204:207], v[104:107], a[52:55], v[204:207]
    s_lshl2_add_u32 s21, s21, s4
    ds_read_b128 v[104:107], v13 offset:2048
    v_mfma_f32_16x16x32_bf16 v[204:207], v[108:111], a[60:63], v[204:207]
    s_mul_i32 s21, s21, 36864
    s_waitcnt vmcnt(18)
    s_barrier
    v_mfma_f32_16x16x32_bf16 v[208:211], v[112:115], a[48:51], v[208:211]
    s_add_u32 s21, s21, s28
    s_mov_b32 m0, s79
    ds_read_b128 v[108:111], v13 offset:10240
    s_waitcnt lgkmcnt(2)
    v_mfma_f32_16x16x32_bf16 v[208:211], v[116:119], a[56:59], v[208:211]
    s_xor_b32 s63, s63, 28672
    buffer_load_dwordx4 v1, s[56:59], s21 offen sc1 lds
    v_mfma_f32_16x16x32_bf16 v[212:215], v[112:115], a[52:55], v[212:215]
    ds_read_b128 v[112:115], v13 offset:3072
    v_mfma_f32_16x16x32_bf16 v[212:215], v[116:119], a[60:63], v[212:215]
    ds_read_b128 v[116:119], v13 offset:11264
    v_mfma_f32_16x16x32_bf16 v[216:219], v[120:123], a[48:51], v[216:219]
    buffer_load_dwordx4 v1, s[56:59], s21 offen offset:1024 sc1 lds
    v_mfma_f32_16x16x32_bf16 v[216:219], v[124:127], a[56:59], v[216:219]
    v_mfma_f32_16x16x32_bf16 v[220:223], v[120:123], a[52:55], v[220:223]
    ds_read_b128 v[120:123], v13 offset:4096
    v_mfma_f32_16x16x32_bf16 v[220:223], v[124:127], a[60:63], v[220:223]
    ds_read_b128 v[124:127], v13 offset:12288
    v_mfma_f32_16x16x32_bf16 v[224:227], v[128:131], a[48:51], v[224:227]
    buffer_load_dwordx4 v1, s[56:59], s21 offen offset:2048 sc1 lds
    v_mfma_f32_16x16x32_bf16 v[224:227], v[132:135], a[56:59], v[224:227]
    v_mfma_f32_16x16x32_bf16 v[228:231], v[128:131], a[52:55], v[228:231]
    ds_read_b128 v[128:131], v13 offset:5120
    v_mfma_f32_16x16x32_bf16 v[228:231], v[132:135], a[60:63], v[228:231]
    ds_read_b128 v[132:135], v13 offset:13312
    v_mfma_f32_16x16x32_bf16 v[176:179], v[136:139], a[64:67], v[176:179]
    buffer_load_dwordx4 v1, s[56:59], s21 offen offset:3072 sc1 lds
    v_mfma_f32_16x16x32_bf16 v[176:179], v[140:143], a[72:75], v[176:179]
    s_add_u32 s21, s21, 4096
    v_mfma_f32_16x16x32_bf16 v[180:183], v[136:139], a[68:71], v[180:183]
    s_add_u32 m0, s79, 4096
    ds_read_b128 v[136:139], v13 offset:6144
    v_mfma_f32_16x16x32_bf16 v[180:183], v[140:143], a[76:79], v[180:183]
    buffer_load_dwordx4 v1, s[56:59], s21 offen sc1 lds
    v_mfma_f32_16x16x32_bf16 v[184:187], v[144:147], a[64:67], v[184:187]
    ds_read_b128 v[140:143], v13 offset:14336
    v_mfma_f32_16x16x32_bf16 v[184:187], v[148:151], a[72:75], v[184:187]
    v_mfma_f32_16x16x32_bf16 v[188:191], v[144:147], a[68:71], v[188:191]
    ds_read_b128 v[144:147], v13 offset:16384
    v_mfma_f32_16x16x32_bf16 v[188:191], v[148:151], a[76:79], v[188:191]
    s_waitcnt lgkmcnt(2)
    buffer_load_dwordx4 v1, s[56:59], s21 offen offset:1024 sc1 lds
    v_mfma_f32_16x16x32_bf16 v[192:195], v[104:107], a[64:67], v[192:195]
    ds_read_b128 v[148:151], v13 offset:24576
    v_mfma_f32_16x16x32_bf16 v[192:195], v[108:111], a[72:75], v[192:195]
    v_mfma_f32_16x16x32_bf16 v[196:199], v[104:107], a[68:71], v[196:199]
    ds_read_b128 v[104:107], v13 offset:17408
    v_mfma_f32_16x16x32_bf16 v[196:199], v[108:111], a[76:79], v[196:199]
    buffer_load_dwordx4 v1, s[56:59], s21 offen offset:2048 sc1 lds
    v_mfma_f32_16x16x32_bf16 v[200:203], v[112:115], a[64:67], v[200:203]
    ds_read_b128 v[108:111], v13 offset:25600
    v_mfma_f32_16x16x32_bf16 v[200:203], v[116:119], a[72:75], v[200:203]
    v_mfma_f32_16x16x32_bf16 v[204:207], v[112:115], a[68:71], v[204:207]
    ds_read_b128 v[112:115], v13 offset:18432
    v_mfma_f32_16x16x32_bf16 v[204:207], v[116:119], a[76:79], v[204:207]
    buffer_load_dwordx4 a[128:131], v4, s[40:43], s63 offen offset:0 sc1
    v_mfma_f32_16x16x32_bf16 v[208:211], v[120:123], a[64:67], v[208:211]
    ds_read_b128 v[116:119], v13 offset:26624
    v_mfma_f32_16x16x32_bf16 v[208:211], v[124:127], a[72:75], v[208:211]
    v_mfma_f32_16x16x32_bf16 v[212:215], v[120:123], a[68:71], v[212:215]
    ds_read_b128 v[120:123], v13 offset:19456
    v_mfma_f32_16x16x32_bf16 v[212:215], v[124:127], a[76:79], v[212:215]
    buffer_load_dwordx4 a[132:135], v5, s[40:43], s63 offen offset:0 sc1
    v_mfma_f32_16x16x32_bf16 v[216:219], v[128:131], a[64:67], v[216:219]
    ds_read_b128 v[124:127], v13 offset:27648
    v_mfma_f32_16x16x32_bf16 v[216:219], v[132:135], a[72:75], v[216:219]
    v_mfma_f32_16x16x32_bf16 v[220:223], v[128:131], a[68:71], v[220:223]
    ds_read_b128 v[128:131], v13 offset:20480
    v_mfma_f32_16x16x32_bf16 v[220:223], v[132:135], a[76:79], v[220:223]
    buffer_load_dwordx4 a[136:139], v4, s[40:43], s63 offen offset:1024 sc1
    v_mfma_f32_16x16x32_bf16 v[224:227], v[136:139], a[64:67], v[224:227]
    s_waitcnt lgkmcnt(2)
    ds_read_b128 v[132:135], v13 offset:28672
    v_mfma_f32_16x16x32_bf16 v[224:227], v[140:143], a[72:75], v[224:227]
    v_mfma_f32_16x16x32_bf16 v[228:231], v[136:139], a[68:71], v[228:231]
    ds_read_b128 v[136:139], v13 offset:21504
    v_mfma_f32_16x16x32_bf16 v[228:231], v[140:143], a[76:79], v[228:231]
    buffer_load_dwordx4 a[140:143], v5, s[40:43], s63 offen offset:1024 sc1
    v_mfma_f32_16x16x32_bf16 v[176:179], v[144:147], a[80:83], v[176:179]
    ds_read_b128 v[140:143], v13 offset:29696
    v_mfma_f32_16x16x32_bf16 v[176:179], v[148:151], a[88:91], v[176:179]
    v_mfma_f32_16x16x32_bf16 v[180:183], v[144:147], a[84:87], v[180:183]
    buffer_load_dwordx4 a[144:147], v4, s[40:43], s63 offen offset:2048 sc1
    v_mfma_f32_16x16x32_bf16 v[180:183], v[148:151], a[92:95], v[180:183]
    ds_read_b128 v[144:147], v13 offset:22528
    ds_read_b128 v[148:151], v13 offset:30720
    v_mfma_f32_16x16x32_bf16 v[184:187], v[104:107], a[80:83], v[184:187]
    v_mfma_f32_16x16x32_bf16 v[184:187], v[108:111], a[88:91], v[184:187]
    v_mfma_f32_16x16x32_bf16 v[188:191], v[104:107], a[84:87], v[188:191]
    buffer_load_dwordx4 a[148:151], v5, s[40:43], s63 offen offset:2048 sc1
    v_mfma_f32_16x16x32_bf16 v[188:191], v[108:111], a[92:95], v[188:191]
    v_mfma_f32_16x16x32_bf16 v[192:195], v[112:115], a[80:83], v[192:195]
    v_mfma_f32_16x16x32_bf16 v[192:195], v[116:119], a[88:91], v[192:195]
    v_mfma_f32_16x16x32_bf16 v[196:199], v[112:115], a[84:87], v[196:199]
    buffer_load_dwordx4 a[152:155], v4, s[40:43], s63 offen offset:3072 sc1
    v_mfma_f32_16x16x32_bf16 v[196:199], v[116:119], a[92:95], v[196:199]
    v_mfma_f32_16x16x32_bf16 v[200:203], v[120:123], a[80:83], v[200:203]
    s_waitcnt lgkmcnt(0)
    v_mfma_f32_16x16x32_bf16 v[200:203], v[124:127], a[88:91], v[200:203]
    v_mfma_f32_16x16x32_bf16 v[204:207], v[120:123], a[84:87], v[204:207]
    buffer_load_dwordx4 a[156:159], v5, s[40:43], s63 offen offset:3072 sc1
    v_mfma_f32_16x16x32_bf16 v[204:207], v[124:127], a[92:95], v[204:207]
    s_xor_b32 s21, s3, 5
    s_waitcnt vmcnt(15)
    s_barrier
    v_mfma_f32_16x16x32_bf16 v[208:211], v[128:131], a[80:83], v[208:211]
    s_lshl2_add_u32 s21, s21, s4
    v_mov_b32 v31, 3
    ds_read_b128 v[104:107], v6 offset:0
    v_mfma_f32_16x16x32_bf16 v[208:211], v[132:135], a[88:91], v[208:211]
    s_mul_i32 s21, s21, 36864
    buffer_store_dword v31, v30, s[32:35], s101 offen sc1
    v_mfma_f32_16x16x32_bf16 v[212:215], v[128:131], a[84:87], v[212:215]
    s_add_u32 s21, s21, s28
    s_mov_b32 m0, s44
    ds_read_b128 v[108:111], v6 offset:8192
    v_mfma_f32_16x16x32_bf16 v[212:215], v[132:135], a[92:95], v[212:215]
    s_xor_b32 s63, s63, 4096
    buffer_load_dwordx4 v1, s[56:59], s21 offen sc1 lds
    v_mfma_f32_16x16x32_bf16 v[216:219], v[136:139], a[80:83], v[216:219]
    ds_read_b128 v[112:115], v6 offset:1024
    ds_read_b128 v[116:119], v6 offset:9216
    v_mfma_f32_16x16x32_bf16 v[216:219], v[140:143], a[88:91], v[216:219]
    ds_read_b128 v[120:123], v6 offset:2048
    v_mfma_f32_16x16x32_bf16 v[220:223], v[136:139], a[84:87], v[220:223]
    buffer_load_dwordx4 v1, s[56:59], s21 offen offset:1024 sc1 lds
    v_mfma_f32_16x16x32_bf16 v[220:223], v[140:143], a[92:95], v[220:223]
    ds_read_b128 v[124:127], v6 offset:10240
    ds_read_b128 v[128:131], v6 offset:3072
    v_mfma_f32_16x16x32_bf16 v[224:227], v[144:147], a[80:83], v[224:227]
    ds_read_b128 v[132:135], v6 offset:11264
    v_mfma_f32_16x16x32_bf16 v[224:227], v[148:151], a[88:91], v[224:227]
    ds_read_b128 v[136:139], v6 offset:4096
    v_mfma_f32_16x16x32_bf16 v[228:231], v[144:147], a[84:87], v[228:231]
    buffer_load_dwordx4 v1, s[56:59], s21 offen offset:2048 sc1 lds
    v_mfma_f32_16x16x32_bf16 v[228:231], v[148:151], a[92:95], v[228:231]
    s_waitcnt lgkmcnt(4)
    ds_read_b128 v[140:143], v6 offset:12288
    ds_read_b128 v[144:147], v6 offset:5120
    v_mfma_f32_16x16x32_bf16 v[176:179], v[104:107], a[96:99], v[176:179]
    ds_read_b128 v[148:151], v6 offset:13312
    v_mfma_f32_16x16x32_bf16 v[176:179], v[108:111], a[104:107], v[176:179]
    v_mfma_f32_16x16x32_bf16 v[180:183], v[104:107], a[100:103], v[180:183]
    buffer_load_dwordx4 v1, s[56:59], s21 offen offset:3072 sc1 lds
    v_mfma_f32_16x16x32_bf16 v[180:183], v[108:111], a[108:111], v[180:183]
    s_add_u32 s21, s21, 4096
    ds_read_b128 v[104:107], v6 offset:6144
    ds_read_b128 v[108:111], v6 offset:14336
    v_mfma_f32_16x16x32_bf16 v[184:187], v[112:115], a[96:99], v[184:187]
    s_add_u32 m0, s44, 4096
    v_mfma_f32_16x16x32_bf16 v[184:187], v[116:119], a[104:107], v[184:187]
    buffer_load_dwordx4 v1, s[56:59], s21 offen sc1 lds
    v_mfma_f32_16x16x32_bf16 v[188:191], v[112:115], a[100:103], v[188:191]
    ds_read_b128 v[112:115], v6 offset:16384
    v_mfma_f32_16x16x32_bf16 v[188:191], v[116:119], a[108:111], v[188:191]
    ds_read_b128 v[116:119], v6 offset:24576
    v_mfma_f32_16x16x32_bf16 v[192:195], v[120:123], a[96:99], v[192:195]
    s_waitcnt lgkmcnt(2)
    v_mfma_f32_16x16x32_bf16 v[192:195], v[124:127], a[104:107], v[192:195]
    buffer_load_dwordx4 v1, s[56:59], s21 offen offset:1024 sc1 lds
    v_mfma_f32_16x16x32_bf16 v[196:199], v[120:123], a[100:103], v[196:199]
    ds_read_b128 v[120:123], v6 offset:17408
    v_mfma_f32_16x16x32_bf16 v[196:199], v[124:127], a[108:111], v[196:199]
    ds_read_b128 v[124:127], v6 offset:25600
    v_mfma_f32_16x16x32_bf16 v[200:203], v[128:131], a[96:99], v[200:203]
    v_mfma_f32_16x16x32_bf16 v[200:203], v[132:135], a[104:107], v[200:203]
    buffer_load_dwordx4 v1, s[56:59], s21 offen offset:2048 sc1 lds
    v_mfma_f32_16x16x32_bf16 v[204:207], v[128:131], a[100:103], v[204:207]
    ds_read_b128 v[128:131], v6 offset:18432
    v_mfma_f32_16x16x32_bf16 v[204:207], v[132:135], a[108:111], v[204:207]
    ds_read_b128 v[132:135], v6 offset:26624
    v_mfma_f32_16x16x32_bf16 v[208:211], v[136:139], a[96:99], v[208:211]
    v_mfma_f32_16x16x32_bf16 v[208:211], v[140:143], a[104:107], v[208:211]
    buffer_load_dwordx4 a[160:163], v4, s[40:43], s63 offen offset:0 sc1
    v_mfma_f32_16x16x32_bf16 v[212:215], v[136:139], a[100:103], v[212:215]
    ds_read_b128 v[136:139], v6 offset:19456
    v_mfma_f32_16x16x32_bf16 v[212:215], v[140:143], a[108:111], v[212:215]
    ds_read_b128 v[140:143], v6 offset:27648
    v_mfma_f32_16x16x32_bf16 v[216:219], v[144:147], a[96:99], v[216:219]
    v_mfma_f32_16x16x32_bf16 v[216:219], v[148:151], a[104:107], v[216:219]
    buffer_load_dwordx4 a[164:167], v5, s[40:43], s63 offen offset:0 sc1
    v_mfma_f32_16x16x32_bf16 v[220:223], v[144:147], a[100:103], v[220:223]
    ds_read_b128 v[144:147], v6 offset:20480
    v_mfma_f32_16x16x32_bf16 v[220:223], v[148:151], a[108:111], v[220:223]
    ds_read_b128 v[148:151], v6 offset:28672
    v_mfma_f32_16x16x32_bf16 v[224:227], v[104:107], a[96:99], v[224:227]
    v_mfma_f32_16x16x32_bf16 v[224:227], v[108:111], a[104:107], v[224:227]
    buffer_load_dwordx4 a[168:171], v4, s[40:43], s63 offen offset:1024 sc1
    v_mfma_f32_16x16x32_bf16 v[228:231], v[104:107], a[100:103], v[228:231]
    ds_read_b128 v[104:107], v6 offset:21504
    v_mfma_f32_16x16x32_bf16 v[228:231], v[108:111], a[108:111], v[228:231]
    s_waitcnt lgkmcnt(2)
    ds_read_b128 v[108:111], v6 offset:29696
    v_mfma_f32_16x16x32_bf16 v[176:179], v[112:115], a[112:115], v[176:179]
    v_mfma_f32_16x16x32_bf16 v[176:179], v[116:119], a[120:123], v[176:179]
    buffer_load_dwordx4 a[172:175], v5, s[40:43], s63 offen offset:1024 sc1
    v_mfma_f32_16x16x32_bf16 v[180:183], v[112:115], a[116:119], v[180:183]
    ds_read_b128 v[112:115], v6 offset:22528
    v_mfma_f32_16x16x32_bf16 v[180:183], v[116:119], a[124:127], v[180:183]
    ds_read_b128 v[116:119], v6 offset:30720
    v_mfma_f32_16x16x32_bf16 v[184:187], v[120:123], a[112:115], v[184:187]
    buffer_load_dwordx4 a[176:179], v4, s[40:43], s63 offen offset:2048 sc1
    v_mfma_f32_16x16x32_bf16 v[184:187], v[124:127], a[120:123], v[184:187]
    v_mfma_f32_16x16x32_bf16 v[188:191], v[120:123], a[116:119], v[188:191]
    v_mfma_f32_16x16x32_bf16 v[188:191], v[124:127], a[124:127], v[188:191]
    v_mfma_f32_16x16x32_bf16 v[192:195], v[128:131], a[112:115], v[192:195]
    buffer_load_dwordx4 a[180:183], v5, s[40:43], s63 offen offset:2048 sc1
    v_mfma_f32_16x16x32_bf16 v[192:195], v[132:135], a[120:123], v[192:195]
    v_mfma_f32_16x16x32_bf16 v[196:199], v[128:131], a[116:119], v[196:199]
    v_mfma_f32_16x16x32_bf16 v[196:199], v[132:135], a[124:127], v[196:199]
    v_mfma_f32_16x16x32_bf16 v[200:203], v[136:139], a[112:115], v[200:203]
    buffer_load_dwordx4 a[184:187], v4, s[40:43], s63 offen offset:3072 sc1
    v_mfma_f32_16x16x32_bf16 v[200:203], v[140:143], a[120:123], v[200:203]
    v_mfma_f32_16x16x32_bf16 v[204:207], v[136:139], a[116:119], v[204:207]
    v_mfma_f32_16x16x32_bf16 v[204:207], v[140:143], a[124:127], v[204:207]
    s_waitcnt vmcnt(15)
    s_barrier
    ds_read_b128 v[120:123], v7 offset:0
    v_mfma_f32_16x16x32_bf16 v[208:211], v[144:147], a[112:115], v[208:211]
    s_waitcnt lgkmcnt(1)
    buffer_load_dwordx4 a[188:191], v5, s[40:43], s63 offen offset:3072 sc1
    v_mfma_f32_16x16x32_bf16 v[208:211], v[148:151], a[120:123], v[208:211]
    s_xor_b32 s21, s3, 6
    ds_read_b128 v[124:127], v7 offset:8192
    ds_read_b128 v[128:131], v7 offset:1024
    v_mfma_f32_16x16x32_bf16 v[212:215], v[144:147], a[116:119], v[212:215]
    s_lshl2_add_u32 s21, s21, s4
    ds_read_b128 v[132:135], v7 offset:9216
    v_mfma_f32_16x16x32_bf16 v[212:215], v[148:151], a[124:127], v[212:215]
    s_mul_i32 s21, s21, 36864
    ds_read_b128 v[136:139], v7 offset:2048
    v_mfma_f32_16x16x32_bf16 v[216:219], v[104:107], a[112:115], v[216:219]
    s_add_u32 s21, s21, s28
    s_mov_b32 m0, s45
    ds_read_b128 v[140:143], v7 offset:10240
    v_mfma_f32_16x16x32_bf16 v[216:219], v[108:111], a[120:123], v[216:219]
    s_xor_b32 s63, s63, 12288
    buffer_load_dwordx4 v1, s[56:59], s21 offen sc1 lds
    v_mfma_f32_16x16x32_bf16 v[220:223], v[104:107], a[116:119], v[220:223]
    ds_read_b128 v[144:147], v7 offset:3072
    ds_read_b128 v[148:151], v7 offset:11264
    v_mfma_f32_16x16x32_bf16 v[220:223], v[108:111], a[124:127], v[220:223]
    ds_read_b128 v[104:107], v7 offset:4096
    v_mfma_f32_16x16x32_bf16 v[224:227], v[112:115], a[112:115], v[224:227]
    buffer_load_dwordx4 v1, s[56:59], s21 offen offset:1024 sc1 lds
    v_mfma_f32_16x16x32_bf16 v[224:227], v[116:119], a[120:123], v[224:227]
    ds_read_b128 v[108:111], v7 offset:12288
    v_mfma_f32_16x16x32_bf16 v[228:231], v[112:115], a[116:119], v[228:231]
    ds_read_b128 v[112:115], v7 offset:5120
    v_mfma_f32_16x16x32_bf16 v[228:231], v[116:119], a[124:127], v[228:231]
    s_waitcnt lgkmcnt(3)
    ds_read_b128 v[116:119], v7 offset:13312
    v_mfma_f32_16x16x32_bf16 v[176:179], v[120:123], a[128:131], v[176:179]
    buffer_load_dwordx4 v1, s[56:59], s21 offen offset:2048 sc1 lds
    v_mfma_f32_16x16x32_bf16 v[176:179], v[124:127], a[136:139], v[176:179]
    v_mfma_f32_16x16x32_bf16 v[180:183], v[120:123], a[132:135], v[180:183]
    ds_read_b128 v[120:123], v7 offset:6144
    v_mfma_f32_16x16x32_bf16 v[180:183], v[124:127], a[140:143], v[180:183]
    buffer_load_dwordx4 v1, s[56:59], s21 offen offset:3072 sc1 lds
    v_mfma_f32_16x16x32_bf16 v[184:187], v[128:131], a[128:131], v[184:187]
    s_add_u32 s21, s21, 4096
    ds_read_b128 v[124:127], v7 offset:14336
    v_mfma_f32_16x16x32_bf16 v[184:187], v[132:135], a[136:139], v[184:187]
    s_add_u32 m0, s45, 4096
    v_mfma_f32_16x16x32_bf16 v[188:191], v[128:131], a[132:135], v[188:191]
    ds_read_b128 v[128:131], v7 offset:16384
    v_mfma_f32_16x16x32_bf16 v[188:191], v[132:135], a[140:143], v[188:191]
    buffer_load_dwordx4 v1, s[56:59], s21 offen sc1 lds
    v_mfma_f32_16x16x32_bf16 v[192:195], v[136:139], a[128:131], v[192:195]
    ds_read_b128 v[132:135], v7 offset:24576
    v_mfma_f32_16x16x32_bf16 v[192:195], v[140:143], a[136:139], v[192:195]
    v_mfma_f32_16x16x32_bf16 v[196:199], v[136:139], a[132:135], v[196:199]
    ds_read_b128 v[136:139], v7 offset:17408
    v_mfma_f32_16x16x32_bf16 v[196:199], v[140:143], a[140:143], v[196:199]
    buffer_load_dwordx4 v1, s[56:59], s21 offen offset:1024 sc1 lds
    v_mfma_f32_16x16x32_bf16 v[200:203], v[144:147], a[128:131], v[200:203]
    ds_read_b128 v[140:143], v7 offset:25600
    v_mfma_f32_16x16x32_bf16 v[200:203], v[148:151], a[136:139], v[200:203]
    v_mfma_f32_16x16x32_bf16 v[204:207], v[144:147], a[132:135], v[204:207]
    ds_read_b128 v[144:147], v7 offset:18432
    v_mfma_f32_16x16x32_bf16 v[204:207], v[148:151], a[140:143], v[204:207]
    s_waitcnt lgkmcnt(2)
    buffer_load_dwordx4 v1, s[56:59], s21 offen offset:2048 sc1 lds
    v_mfma_f32_16x16x32_bf16 v[208:211], v[104:107], a[128:131], v[208:211]
    ds_read_b128 v[148:151], v7 offset:26624
    v_mfma_f32_16x16x32_bf16 v[208:211], v[108:111], a[136:139], v[208:211]
    v_mfma_f32_16x16x32_bf16 v[212:215], v[104:107], a[132:135], v[212:215]
    ds_read_b128 v[104:107], v7 offset:19456
    v_mfma_f32_16x16x32_bf16 v[212:215], v[108:111], a[140:143], v[212:215]
    buffer_load_dwordx4 a[192:195], v4, s[40:43], s63 offen offset:0 sc1
    v_mfma_f32_16x16x32_bf16 v[216:219], v[112:115], a[128:131], v[216:219]
    ds_read_b128 v[108:111], v7 offset:27648
    v_mfma_f32_16x16x32_bf16 v[216:219], v[116:119], a[136:139], v[216:219]
    v_mfma_f32_16x16x32_bf16 v[220:223], v[112:115], a[132:135], v[220:223]
    ds_read_b128 v[112:115], v7 offset:20480
    v_mfma_f32_16x16x32_bf16 v[220:223], v[116:119], a[140:143], v[220:223]
    buffer_load_dwordx4 a[196:199], v5, s[40:43], s63 offen offset:0 sc1
    v_mfma_f32_16x16x32_bf16 v[224:227], v[120:123], a[128:131], v[224:227]
    ds_read_b128 v[116:119], v7 offset:28672
    v_mfma_f32_16x16x32_bf16 v[224:227], v[124:127], a[136:139], v[224:227]
    v_mfma_f32_16x16x32_bf16 v[228:231], v[120:123], a[132:135], v[228:231]
    ds_read_b128 v[120:123], v7 offset:21504
    v_mfma_f32_16x16x32_bf16 v[228:231], v[124:127], a[140:143], v[228:231]
    buffer_load_dwordx4 a[200:203], v4, s[40:43], s63 offen offset:1024 sc1
    v_mfma_f32_16x16x32_bf16 v[176:179], v[128:131], a[144:147], v[176:179]
    ds_read_b128 v[124:127], v7 offset:29696
    v_mfma_f32_16x16x32_bf16 v[176:179], v[132:135], a[152:155], v[176:179]
    v_mfma_f32_16x16x32_bf16 v[180:183], v[128:131], a[148:151], v[180:183]
    ds_read_b128 v[128:131], v7 offset:22528
    v_mfma_f32_16x16x32_bf16 v[180:183], v[132:135], a[156:159], v[180:183]
    buffer_load_dwordx4 a[204:207], v5, s[40:43], s63 offen offset:1024 sc1
    v_mfma_f32_16x16x32_bf16 v[184:187], v[136:139], a[144:147], v[184:187]
    s_waitcnt lgkmcnt(2)
    ds_read_b128 v[132:135], v7 offset:30720
    v_mfma_f32_16x16x32_bf16 v[184:187], v[140:143], a[152:155], v[184:187]
    v_mfma_f32_16x16x32_bf16 v[188:191], v[136:139], a[148:151], v[188:191]
    buffer_load_dwordx4 a[208:211], v4, s[40:43], s63 offen offset:2048 sc1
    v_mfma_f32_16x16x32_bf16 v[188:191], v[140:143], a[156:159], v[188:191]
    v_mfma_f32_16x16x32_bf16 v[192:195], v[144:147], a[144:147], v[192:195]
    v_mfma_f32_16x16x32_bf16 v[192:195], v[148:151], a[152:155], v[192:195]
    v_mfma_f32_16x16x32_bf16 v[196:199], v[144:147], a[148:151], v[196:199]
    buffer_load_dwordx4 a[212:215], v5, s[40:43], s63 offen offset:2048 sc1
    v_mfma_f32_16x16x32_bf16 v[196:199], v[148:151], a[156:159], v[196:199]
    v_mfma_f32_16x16x32_bf16 v[200:203], v[104:107], a[144:147], v[200:203]
    v_mfma_f32_16x16x32_bf16 v[200:203], v[108:111], a[152:155], v[200:203]
    v_mfma_f32_16x16x32_bf16 v[204:207], v[104:107], a[148:151], v[204:207]
    buffer_load_dwordx4 a[216:219], v4, s[40:43], s63 offen offset:3072 sc1
    v_mfma_f32_16x16x32_bf16 v[204:207], v[108:111], a[156:159], v[204:207]
    s_waitcnt vmcnt(14)
    s_barrier
    ds_read_b128 v[136:139], v11 offset:0
    v_mfma_f32_16x16x32_bf16 v[208:211], v[112:115], a[144:147], v[208:211]
    ds_read_b128 v[140:143], v11 offset:8192
    ds_read_b128 v[144:147], v11 offset:1024
    v_mfma_f32_16x16x32_bf16 v[208:211], v[116:119], a[152:155], v[208:211]
    ds_read_b128 v[148:151], v11 offset:9216
    v_mfma_f32_16x16x32_bf16 v[212:215], v[112:115], a[148:151], v[212:215]
    buffer_load_dwordx4 a[220:223], v5, s[40:43], s63 offen offset:3072 sc1
    v_mfma_f32_16x16x32_bf16 v[212:215], v[116:119], a[156:159], v[212:215]
    s_xor_b32 s63, s63, 4096
    ds_read_b128 v[104:107], v11 offset:2048
    ds_read_b128 v[108:111], v11 offset:10240
    v_mfma_f32_16x16x32_bf16 v[216:219], v[120:123], a[144:147], v[216:219]
    s_waitcnt lgkmcnt(5)
    ds_read_b128 v[112:115], v11 offset:3072
    v_mfma_f32_16x16x32_bf16 v[216:219], v[124:127], a[152:155], v[216:219]
    ds_read_b128 v[116:119], v11 offset:11264
    v_mfma_f32_16x16x32_bf16 v[220:223], v[120:123], a[148:151], v[220:223]
    buffer_load_dword v3, v19, s[32:35], s66 offen sc1
    v_mfma_f32_16x16x32_bf16 v[220:223], v[124:127], a[156:159], v[220:223]
    s_xor_b32 s21, s3, 7
    ds_read_b128 v[120:123], v11 offset:4096
    ds_read_b128 v[124:127], v11 offset:12288
    v_mfma_f32_16x16x32_bf16 v[224:227], v[128:131], a[144:147], v[224:227]
    s_lshl2_add_u32 s21, s21, s4
    v_mfma_f32_16x16x32_bf16 v[224:227], v[132:135], a[152:155], v[224:227]
    s_mul_i32 s21, s21, 36864
    v_mfma_f32_16x16x32_bf16 v[228:231], v[128:131], a[148:151], v[228:231]
    s_add_u32 s21, s21, s28
    s_mov_b32 m0, s46
    ds_read_b128 v[128:131], v11 offset:5120
    v_mfma_f32_16x16x32_bf16 v[228:231], v[132:135], a[156:159], v[228:231]
    buffer_load_dwordx4 v1, s[56:59], s21 offen sc1 lds
    v_mfma_f32_16x16x32_bf16 v[176:179], v[136:139], a[160:163], v[176:179]
    s_waitcnt lgkmcnt(1)
    ds_read_b128 v[132:135], v11 offset:13312
    v_mfma_f32_16x16x32_bf16 v[176:179], v[140:143], a[168:171], v[176:179]
    v_mfma_f32_16x16x32_bf16 v[180:183], v[136:139], a[164:167], v[180:183]
    buffer_load_dwordx4 v1, s[56:59], s21 offen offset:1024 sc1 lds
    v_mfma_f32_16x16x32_bf16 v[180:183], v[140:143], a[172:175], v[180:183]
    ds_read_b128 v[136:139], v11 offset:6144
    ds_read_b128 v[140:143], v11 offset:14336
    v_mfma_f32_16x16x32_bf16 v[184:187], v[144:147], a[160:163], v[184:187]
    v_mfma_f32_16x16x32_bf16 v[184:187], v[148:151], a[168:171], v[184:187]
    buffer_load_dwordx4 v1, s[56:59], s21 offen offset:2048 sc1 lds
    v_mfma_f32_16x16x32_bf16 v[188:191], v[144:147], a[164:167], v[188:191]
    ds_read_b128 v[144:147], v11 offset:16384
    v_mfma_f32_16x16x32_bf16 v[188:191], v[148:151], a[172:175], v[188:191]
    ds_read_b128 v[148:151], v11 offset:24576
    v_mfma_f32_16x16x32_bf16 v[192:195], v[104:107], a[160:163], v[192:195]
    v_mfma_f32_16x16x32_bf16 v[192:195], v[108:111], a[168:171], v[192:195]
    buffer_load_dwordx4 v1, s[56:59], s21 offen offset:3072 sc1 lds
    v_mfma_f32_16x16x32_bf16 v[196:199], v[104:107], a[164:167], v[196:199]
    s_add_u32 s21, s21, 4096
    ds_read_b128 v[104:107], v11 offset:17408
    v_mfma_f32_16x16x32_bf16 v[196:199], v[108:111], a[172:175], v[196:199]
    s_add_u32 m0, s46, 4096
    ds_read_b128 v[108:111], v11 offset:25600
    v_mfma_f32_16x16x32_bf16 v[200:203], v[112:115], a[160:163], v[200:203]
    v_mfma_f32_16x16x32_bf16 v[200:203], v[116:119], a[168:171], v[200:203]
    buffer_load_dwordx4 v1, s[56:59], s21 offen sc1 lds
    v_mfma_f32_16x16x32_bf16 v[204:207], v[112:115], a[164:167], v[204:207]
    ds_read_b128 v[112:115], v11 offset:18432
    v_mfma_f32_16x16x32_bf16 v[204:207], v[116:119], a[172:175], v[204:207]
    ds_read_b128 v[116:119], v11 offset:26624
    v_mfma_f32_16x16x32_bf16 v[208:211], v[120:123], a[160:163], v[208:211]
    v_mfma_f32_16x16x32_bf16 v[208:211], v[124:127], a[168:171], v[208:211]
    buffer_load_dwordx4 v1, s[56:59], s21 offen offset:1024 sc1 lds
    v_mfma_f32_16x16x32_bf16 v[212:215], v[120:123], a[164:167], v[212:215]
    ds_read_b128 v[120:123], v11 offset:19456
    v_mfma_f32_16x16x32_bf16 v[212:215], v[124:127], a[172:175], v[212:215]
    s_waitcnt lgkmcnt(2)
    ds_read_b128 v[124:127], v11 offset:27648
    v_mfma_f32_16x16x32_bf16 v[216:219], v[128:131], a[160:163], v[216:219]
    v_mfma_f32_16x16x32_bf16 v[216:219], v[132:135], a[168:171], v[216:219]
    buffer_load_dwordx4 v1, s[56:59], s21 offen offset:2048 sc1 lds
    v_mfma_f32_16x16x32_bf16 v[220:223], v[128:131], a[164:167], v[220:223]
    ds_read_b128 v[128:131], v11 offset:20480
    v_mfma_f32_16x16x32_bf16 v[220:223], v[132:135], a[172:175], v[220:223]
    ds_read_b128 v[132:135], v11 offset:28672
    v_mfma_f32_16x16x32_bf16 v[224:227], v[136:139], a[160:163], v[224:227]
    v_mfma_f32_16x16x32_bf16 v[224:227], v[140:143], a[168:171], v[224:227]
    buffer_load_dwordx4 a[224:227], v4, s[40:43], s63 offen offset:0 sc1
    v_mfma_f32_16x16x32_bf16 v[228:231], v[136:139], a[164:167], v[228:231]
    ds_read_b128 v[136:139], v11 offset:21504
    v_mfma_f32_16x16x32_bf16 v[228:231], v[140:143], a[172:175], v[228:231]
    ds_read_b128 v[140:143], v11 offset:29696
    v_mfma_f32_16x16x32_bf16 v[176:179], v[144:147], a[176:179], v[176:179]
    v_mfma_f32_16x16x32_bf16 v[176:179], v[148:151], a[184:187], v[176:179]
    buffer_load_dwordx4 a[228:231], v5, s[40:43], s63 offen offset:0 sc1
    v_mfma_f32_16x16x32_bf16 v[180:183], v[144:147], a[180:183], v[180:183]
    ds_read_b128 v[144:147], v11 offset:22528
    v_mfma_f32_16x16x32_bf16 v[180:183], v[148:151], a[188:191], v[180:183]
    ds_read_b128 v[148:151], v11 offset:30720
    v_mfma_f32_16x16x32_bf16 v[184:187], v[104:107], a[176:179], v[184:187]
    buffer_load_dwordx4 a[232:235], v4, s[40:43], s63 offen offset:1024 sc1
    v_mfma_f32_16x16x32_bf16 v[184:187], v[108:111], a[184:187], v[184:187]
    v_mfma_f32_16x16x32_bf16 v[188:191], v[104:107], a[180:183], v[188:191]
    v_mfma_f32_16x16x32_bf16 v[188:191], v[108:111], a[188:191], v[188:191]
    v_mfma_f32_16x16x32_bf16 v[192:195], v[112:115], a[176:179], v[192:195]
    s_waitcnt lgkmcnt(0)
    buffer_load_dwordx4 a[236:239], v5, s[40:43], s63 offen offset:1024 sc1
    v_mfma_f32_16x16x32_bf16 v[192:195], v[116:119], a[184:187], v[192:195]
    v_mfma_f32_16x16x32_bf16 v[196:199], v[112:115], a[180:183], v[196:199]
    v_mfma_f32_16x16x32_bf16 v[196:199], v[116:119], a[188:191], v[196:199]
    v_mfma_f32_16x16x32_bf16 v[200:203], v[120:123], a[176:179], v[200:203]
    buffer_load_dwordx4 a[240:243], v4, s[40:43], s63 offen offset:2048 sc1
    v_mfma_f32_16x16x32_bf16 v[200:203], v[124:127], a[184:187], v[200:203]
    v_mfma_f32_16x16x32_bf16 v[204:207], v[120:123], a[180:183], v[204:207]
    v_mfma_f32_16x16x32_bf16 v[204:207], v[124:127], a[188:191], v[204:207]
    s_waitcnt vmcnt(12)
    v_cmp_gt_u32 vcc, 3, v3
    s_nop 1
    s_and_b64 vcc, vcc, exec
    s_cbranch_scc1 SPIN_OA
BACK_OA:
    s_barrier
    v_mfma_f32_16x16x32_bf16 v[208:211], v[128:131], a[176:179], v[208:211]
    buffer_load_dwordx4 a[244:247], v5, s[40:43], s63 offen offset:2048 sc1
    v_mfma_f32_16x16x32_bf16 v[208:211], v[132:135], a[184:187], v[208:211]
    ds_read_b128 v[104:107], v12 offset:0
    ds_read_b128 v[108:111], v12 offset:8192
    v_mfma_f32_16x16x32_bf16 v[212:215], v[128:131], a[180:183], v[212:215]
    ds_read_b128 v[112:115], v12 offset:1024
    v_mfma_f32_16x16x32_bf16 v[212:215], v[132:135], a[188:191], v[212:215]
    ds_read_b128 v[116:119], v12 offset:9216
    v_mfma_f32_16x16x32_bf16 v[216:219], v[136:139], a[176:179], v[216:219]
    buffer_load_dwordx4 a[248:251], v4, s[40:43], s63 offen offset:3072 sc1
    v_mfma_f32_16x16x32_bf16 v[216:219], v[140:143], a[184:187], v[216:219]
    ds_read_b128 v[120:123], v12 offset:2048
    ds_read_b128 v[124:127], v12 offset:10240
    v_mfma_f32_16x16x32_bf16 v[220:223], v[136:139], a[180:183], v[220:223]
    ds_read_b128 v[128:131], v12 offset:3072
    v_mfma_f32_16x16x32_bf16 v[220:223], v[140:143], a[188:191], v[220:223]
    ds_read_b128 v[132:135], v12 offset:11264
    v_mfma_f32_16x16x32_bf16 v[224:227], v[144:147], a[176:179], v[224:227]
    buffer_load_dwordx4 a[252:255], v5, s[40:43], s63 offen offset:3072 sc1
    v_mfma_f32_16x16x32_bf16 v[224:227], v[148:151], a[184:187], v[224:227]
    s_mul_i32 s21, s61, 6
    s_add_u32 s21, s4, s21
    ds_read_b128 v[136:139], v12 offset:4096
    v_mfma_f32_16x16x32_bf16 v[228:231], v[144:147], a[180:183], v[228:231]
    s_add_u32 s21, s21, 128
    ds_read_b128 v[140:143], v12 offset:12288
    ds_read_b128 v[144:147], v12 offset:5120
    v_mfma_f32_16x16x32_bf16 v[228:231], v[148:151], a[188:191], v[228:231]
    s_mul_i32 s21, s21, 36864
    ds_read_b128 v[148:151], v12 offset:13312
    s_waitcnt lgkmcnt(5)
    v_mfma_f32_16x16x32_bf16 v[176:179], v[104:107], a[192:195], v[176:179]
    s_add_u32 s21, s21, s28
    s_mov_b32 m0, s47
    v_mfma_f32_16x16x32_bf16 v[176:179], v[108:111], a[200:203], v[176:179]
    s_add_u32 s63, s63, 4096
    buffer_load_dwordx4 v1, s[56:59], s21 offen sc1 lds
    v_mfma_f32_16x16x32_bf16 v[180:183], v[104:107], a[196:199], v[180:183]
    ds_read_b128 v[104:107], v12 offset:6144
    v_mfma_f32_16x16x32_bf16 v[180:183], v[108:111], a[204:207], v[180:183]
    ds_read_b128 v[108:111], v12 offset:14336
    v_mfma_f32_16x16x32_bf16 v[184:187], v[112:115], a[192:195], v[184:187]
    buffer_load_dwordx4 v1, s[56:59], s21 offen offset:1024 sc1 lds
    v_mfma_f32_16x16x32_bf16 v[184:187], v[116:119], a[200:203], v[184:187]
    v_mfma_f32_16x16x32_bf16 v[188:191], v[112:115], a[196:199], v[188:191]
    ds_read_b128 v[112:115], v12 offset:16384
    v_mfma_f32_16x16x32_bf16 v[188:191], v[116:119], a[204:207], v[188:191]
    buffer_load_dwordx4 v1, s[56:59], s21 offen offset:2048 sc1 lds
    v_mfma_f32_16x16x32_bf16 v[192:195], v[120:123], a[192:195], v[192:195]
    ds_read_b128 v[116:119], v12 offset:24576
    v_mfma_f32_16x16x32_bf16 v[192:195], v[124:127], a[200:203], v[192:195]
    v_mfma_f32_16x16x32_bf16 v[196:199], v[120:123], a[196:199], v[196:199]
    ds_read_b128 v[120:123], v12 offset:17408
    v_mfma_f32_16x16x32_bf16 v[196:199], v[124:127], a[204:207], v[196:199]
    buffer_load_dwordx4 v1, s[56:59], s21 offen offset:3072 sc1 lds
    v_mfma_f32_16x16x32_bf16 v[200:203], v[128:131], a[192:195], v[200:203]
    s_add_u32 s21, s21, 4096
    ds_read_b128 v[124:127], v12 offset:25600
    s_waitcnt lgkmcnt(3)
    v_mfma_f32_16x16x32_bf16 v[200:203], v[132:135], a[200:203], v[200:203]
    s_add_u32 m0, s47, 4096
    v_mfma_f32_16x16x32_bf16 v[204:207], v[128:131], a[196:199], v[204:207]
    ds_read_b128 v[128:131], v12 offset:18432
    v_mfma_f32_16x16x32_bf16 v[204:207], v[132:135], a[204:207], v[204:207]
    buffer_load_dwordx4 v1, s[56:59], s21 offen sc1 lds
    v_mfma_f32_16x16x32_bf16 v[208:211], v[136:139], a[192:195], v[208:211]
    ds_read_b128 v[132:135], v12 offset:26624
    v_mfma_f32_16x16x32_bf16 v[208:211], v[140:143], a[200:203], v[208:211]
    v_mfma_f32_16x16x32_bf16 v[212:215], v[136:139], a[196:199], v[212:215]
    ds_read_b128 v[136:139], v12 offset:19456
    v_mfma_f32_16x16x32_bf16 v[212:215], v[140:143], a[204:207], v[212:215]
    buffer_load_dwordx4 v1, s[56:59], s21 offen offset:1024 sc1 lds
    v_mfma_f32_16x16x32_bf16 v[216:219], v[144:147], a[192:195], v[216:219]
    ds_read_b128 v[140:143], v12 offset:27648
    v_mfma_f32_16x16x32_bf16 v[216:219], v[148:151], a[200:203], v[216:219]
    v_mfma_f32_16x16x32_bf16 v[220:223], v[144:147], a[196:199], v[220:223]
    ds_read_b128 v[144:147], v12 offset:20480
    v_mfma_f32_16x16x32_bf16 v[220:223], v[148:151], a[204:207], v[220:223]
    buffer_load_dwordx4 v1, s[56:59], s21 offen offset:2048 sc1 lds
    v_mfma_f32_16x16x32_bf16 v[224:227], v[104:107], a[192:195], v[224:227]
    s_mul_i32 s63, s61, 6144
    ds_read_b128 v[148:151], v12 offset:28672
    v_mfma_f32_16x16x32_bf16 v[224:227], v[108:111], a[200:203], v[224:227]
    s_add_u32 s63, s63, 131072
    v_mfma_f32_16x16x32_bf16 v[228:231], v[104:107], a[196:199], v[228:231]
    ds_read_b128 v[104:107], v12 offset:21504
    v_mfma_f32_16x16x32_bf16 v[228:231], v[108:111], a[204:207], v[228:231]
    buffer_load_dwordx4 v[32:35], v4, s[40:43], s63 offen offset:0 sc1
    v_mfma_f32_16x16x32_bf16 v[176:179], v[112:115], a[208:211], v[176:179]
    s_waitcnt lgkmcnt(2)
    ds_read_b128 v[108:111], v12 offset:29696
    v_mfma_f32_16x16x32_bf16 v[176:179], v[116:119], a[216:219], v[176:179]
    v_mfma_f32_16x16x32_bf16 v[180:183], v[112:115], a[212:215], v[180:183]
    ds_read_b128 v[112:115], v12 offset:22528
    v_mfma_f32_16x16x32_bf16 v[180:183], v[116:119], a[220:223], v[180:183]
    buffer_load_dwordx4 v[36:39], v5, s[40:43], s63 offen offset:0 sc1
    v_mfma_f32_16x16x32_bf16 v[184:187], v[120:123], a[208:211], v[184:187]
    ds_read_b128 v[116:119], v12 offset:30720
    v_mfma_f32_16x16x32_bf16 v[184:187], v[124:127], a[216:219], v[184:187]
    v_mfma_f32_16x16x32_bf16 v[188:191], v[120:123], a[212:215], v[188:191]
    buffer_load_dwordx4 v[40:43], v4, s[40:43], s63 offen offset:1024 sc1
    v_mfma_f32_16x16x32_bf16 v[188:191], v[124:127], a[220:223], v[188:191]
    v_mfma_f32_16x16x32_bf16 v[192:195], v[128:131], a[208:211], v[192:195]
    v_mfma_f32_16x16x32_bf16 v[192:195], v[132:135], a[216:219], v[192:195]
    v_mfma_f32_16x16x32_bf16 v[196:199], v[128:131], a[212:215], v[196:199]
    buffer_load_dwordx4 v[44:47], v5, s[40:43], s63 offen offset:1024 sc1
    v_mfma_f32_16x16x32_bf16 v[196:199], v[132:135], a[220:223], v[196:199]
    v_mfma_f32_16x16x32_bf16 v[200:203], v[136:139], a[208:211], v[200:203]
    v_mfma_f32_16x16x32_bf16 v[200:203], v[140:143], a[216:219], v[200:203]
    v_mfma_f32_16x16x32_bf16 v[204:207], v[136:139], a[212:215], v[204:207]
    buffer_load_dwordx4 v[48:51], v4, s[40:43], s63 offen offset:2048 sc1
    v_mfma_f32_16x16x32_bf16 v[204:207], v[140:143], a[220:223], v[204:207]
    s_waitcnt vmcnt(12)
    s_barrier
    ds_read_b128 v[120:123], v13 offset:0
    v_mfma_f32_16x16x32_bf16 v[208:211], v[144:147], a[208:211], v[208:211]
    s_waitcnt lgkmcnt(1)
    ds_read_b128 v[124:127], v13 offset:8192
    ds_read_b128 v[128:131], v13 offset:1024
    v_mfma_f32_16x16x32_bf16 v[208:211], v[148:151], a[216:219], v[208:211]
    ds_read_b128 v[132:135], v13 offset:9216
    v_mfma_f32_16x16x32_bf16 v[212:215], v[144:147], a[212:215], v[212:215]
    buffer_load_dwordx4 v[52:55], v5, s[40:43], s63 offen offset:2048 sc1
    v_mfma_f32_16x16x32_bf16 v[212:215], v[148:151], a[220:223], v[212:215]
    ds_read_b128 v[136:139], v13 offset:2048
    ds_read_b128 v[140:143], v13 offset:10240
    v_mfma_f32_16x16x32_bf16 v[216:219], v[104:107], a[208:211], v[216:219]
    ds_read_b128 v[144:147], v13 offset:3072
    v_mfma_f32_16x16x32_bf16 v[216:219], v[108:111], a[216:219], v[216:219]
    ds_read_b128 v[148:151], v13 offset:11264
    v_mfma_f32_16x16x32_bf16 v[220:223], v[104:107], a[212:215], v[220:223]
    buffer_load_dwordx4 v[56:59], v4, s[40:43], s63 offen offset:3072 sc1
    v_mfma_f32_16x16x32_bf16 v[220:223], v[108:111], a[220:223], v[220:223]
    ds_read_b128 v[104:107], v13 offset:4096
    ds_read_b128 v[108:111], v13 offset:12288
    v_mfma_f32_16x16x32_bf16 v[224:227], v[112:115], a[208:211], v[224:227]
    v_mfma_f32_16x16x32_bf16 v[224:227], v[116:119], a[216:219], v[224:227]
    v_mfma_f32_16x16x32_bf16 v[228:231], v[112:115], a[212:215], v[228:231]
    buffer_load_dwordx4 v[60:63], v5, s[40:43], s63 offen offset:3072 sc1
    v_mfma_f32_16x16x32_bf16 v[228:231], v[116:119], a[220:223], v[228:231]
    s_mul_i32 s21, s61, 6
    s_lshr_b32 s64, s4, 1
    s_add_u32 s21, s21, s64
    s_waitcnt lgkmcnt(2)
    v_mfma_f32_16x16x32_bf16 v[176:179], v[120:123], a[224:227], v[176:179]
    s_add_u32 s21, s21, 132
    s_mul_i32 s21, s21, 36864
    ds_read_b128 v[112:115], v13 offset:5120
    v_mfma_f32_16x16x32_bf16 v[176:179], v[124:127], a[232:235], v[176:179]
    s_add_u32 s21, s21, s28
    s_and_b32 s64, s69, 4096
    ds_read_b128 v[116:119], v13 offset:13312
    v_mfma_f32_16x16x32_bf16 v[180:183], v[120:123], a[228:231], v[180:183]
    s_add_u32 s21, s21, s64
    s_mov_b32 m0, s79
    ds_read_b128 v[120:123], v13 offset:6144
    v_mfma_f32_16x16x32_bf16 v[180:183], v[124:127], a[236:239], v[180:183]
    s_add_u32 s63, s63, 4096
    buffer_load_dwordx4 v1, s[56:59], s21 offen sc1 lds
    v_mfma_f32_16x16x32_bf16 v[184:187], v[128:131], a[224:227], v[184:187]
    s_add_u32 s23, s5, 8
    ds_read_b128 v[124:127], v13 offset:14336
    v_lshrrev_b32 v19, 4, v1
    v_mfma_f32_16x16x32_bf16 v[184:187], v[132:135], a[232:235], v[184:187]
    s_and_b32 s65, s5, 3
    buffer_load_dwordx4 v1, s[56:59], s21 offen offset:1024 sc1 lds
    v_mfma_f32_16x16x32_bf16 v[188:191], v[128:131], a[228:231], v[188:191]
    s_add_u32 s22, s4, 1
    ds_read_b128 v[128:131], v13 offset:16384
    v_min_u32 v19, 2, v19
    v_mfma_f32_16x16x32_bf16 v[188:191], v[132:135], a[236:239], v[188:191]
    s_mul_i32 s70, s4, 3072
    ds_read_b128 v[132:135], v13 offset:24576
    v_lshl_add_u32 v19, v19, 3, s23
    v_mfma_f32_16x16x32_bf16 v[192:195], v[136:139], a[224:227], v[192:195]
    s_lshl2_add_u32 s23, s62, s4
    v_bfe_u32 v20, v1, 4, 4
    v_lshrrev_b32 v21, 8, v1
    v_mfma_f32_16x16x32_bf16 v[192:195], v[140:143], a[232:235], v[192:195]
    s_lshl_b32 s23, s23, 5
    buffer_load_dwordx4 v1, s[56:59], s21 offen offset:2048 sc1 lds
    v_mfma_f32_16x16x32_bf16 v[196:199], v[136:139], a[228:231], v[196:199]
    s_lshl_b32 s22, s22, 15
    ds_read_b128 v[136:139], v13 offset:17408
    v_add_u32 v20, s23, v20
    v_mfma_f32_16x16x32_bf16 v[196:199], v[140:143], a[236:239], v[196:199]
    s_mul_i32 s23, s101, 288
    ds_read_b128 v[140:143], v13 offset:25600
    v_mul_u32_u24 v20, 1152, v20
    v_mfma_f32_16x16x32_bf16 v[200:203], v[144:147], a[224:227], v[200:203]
    s_lshl_b32 s66, s6, 12
    v_and_b32 v19, 31, v19
    v_lshl_add_u32 v20, v21, 3, v20
    v_mfma_f32_16x16x32_bf16 v[200:203], v[148:151], a[232:235], v[200:203]
    s_add_u32 s23, s23, s70
    buffer_load_dwordx4 v1, s[56:59], s21 offen offset:3072 sc1 lds
    v_mfma_f32_16x16x32_bf16 v[204:207], v[144:147], a[228:231], v[204:207]
    s_add_u32 s66, s66, s22
    ds_read_b128 v[144:147], v13 offset:18432
    v_mov_b32 v31, 2
    v_mfma_f32_16x16x32_bf16 v[204:207], v[148:151], a[236:239], v[204:207]
    s_add_u32 s22, s22, s101
    ds_read_b128 v[148:151], v13 offset:26624
    v_lshlrev_b32 v23, 20, v1
    s_waitcnt lgkmcnt(3)
    v_mfma_f32_16x16x32_bf16 v[208:211], v[104:107], a[224:227], v[208:211]
    v_lshlrev_b32 v19, 7, v19
    v_add_u32 v21, 18432, v20
    v_mfma_f32_16x16x32_bf16 v[208:211], v[108:111], a[232:235], v[208:211]
    buffer_load_dwordx4 v[64:67], v4, s[40:43], s63 offen offset:0 sc1
    v_mfma_f32_16x16x32_bf16 v[212:215], v[104:107], a[228:231], v[212:215]
    ds_read_b128 v[104:107], v13 offset:19456
    v_mfma_f32_16x16x32_bf16 v[212:215], v[108:111], a[236:239], v[212:215]
    ds_read_b128 v[108:111], v13 offset:27648
    v_mfma_f32_16x16x32_bf16 v[216:219], v[112:115], a[224:227], v[216:219]
    v_mfma_f32_16x16x32_bf16 v[216:219], v[116:119], a[232:235], v[216:219]
    buffer_load_dwordx4 v[68:71], v5, s[40:43], s63 offen offset:0 sc1
    v_mfma_f32_16x16x32_bf16 v[220:223], v[112:115], a[228:231], v[220:223]
    ds_read_b128 v[112:115], v13 offset:20480
    v_mfma_f32_16x16x32_bf16 v[220:223], v[116:119], a[236:239], v[220:223]
    ds_read_b128 v[116:119], v13 offset:28672
    v_mfma_f32_16x16x32_bf16 v[224:227], v[120:123], a[224:227], v[224:227]
    v_mfma_f32_16x16x32_bf16 v[224:227], v[124:127], a[232:235], v[224:227]
    buffer_load_dwordx4 v[72:75], v4, s[40:43], s63 offen offset:1024 sc1
    v_mfma_f32_16x16x32_bf16 v[228:231], v[120:123], a[228:231], v[228:231]
    ds_read_b128 v[120:123], v13 offset:21504
    v_mfma_f32_16x16x32_bf16 v[228:231], v[124:127], a[236:239], v[228:231]
    ds_read_b128 v[124:127], v13 offset:29696
    v_mfma_f32_16x16x32_bf16 v[176:179], v[128:131], a[240:243], v[176:179]
    v_mfma_f32_16x16x32_bf16 v[176:179], v[132:135], a[248:251], v[176:179]
    buffer_load_dwordx4 v[76:79], v5, s[40:43], s63 offen offset:1024 sc1
    v_mfma_f32_16x16x32_bf16 v[180:183], v[128:131], a[244:247], v[180:183]
    s_add_u32 s21, s4, 0
    s_xor_b32 s21, s21, s3
    s_lshl_b32 s21, s21, 2
    v_mfma_f32_16x16x32_bf16 v[180:183], v[132:135], a[252:255], v[180:183]
    s_mul_i32 s21, s21, 36864
    ds_read_b128 v[128:131], v13 offset:22528
    ds_read_b128 v[132:135], v13 offset:30720
    v_mfma_f32_16x16x32_bf16 v[184:187], v[136:139], a[240:243], v[184:187]
    s_add_u32 s21, s21, s28
    s_waitcnt lgkmcnt(2)
    v_mfma_f32_16x16x32_bf16 v[184:187], v[140:143], a[248:251], v[184:187]
    s_add_u32 s21, s21, 7168
    s_add_u32 m0, s44, 0
    v_mfma_f32_16x16x32_bf16 v[188:191], v[136:139], a[244:247], v[188:191]
    s_add_u32 s63, s63, 4096
    buffer_load_dwordx4 v1, s[56:59], s21 offen sc1 lds
    v_mfma_f32_16x16x32_bf16 v[188:191], v[140:143], a[252:255], v[188:191]
    v_mfma_f32_16x16x32_bf16 v[192:195], v[144:147], a[240:243], v[192:195]
    buffer_load_dwordx4 v1, s[56:59], s21 offen offset:1024 sc1 lds
    v_mfma_f32_16x16x32_bf16 v[192:195], v[148:151], a[248:251], v[192:195]
    s_add_u32 s21, s21, 36864
    v_mfma_f32_16x16x32_bf16 v[196:199], v[144:147], a[244:247], v[196:199]
    s_add_u32 m0, s44, 2048
    v_mfma_f32_16x16x32_bf16 v[196:199], v[148:151], a[252:255], v[196:199]
    v_mfma_f32_16x16x32_bf16 v[200:203], v[104:107], a[240:243], v[200:203]
    buffer_load_dwordx4 v1, s[56:59], s21 offen sc1 lds
    v_mfma_f32_16x16x32_bf16 v[200:203], v[108:111], a[248:251], v[200:203]
    v_mfma_f32_16x16x32_bf16 v[204:207], v[104:107], a[244:247], v[204:207]
    v_mfma_f32_16x16x32_bf16 v[204:207], v[108:111], a[252:255], v[204:207]
    s_waitcnt vmcnt(11)
    s_barrier
    ds_read_b128 v[136:139], v6 offset:0
    v_mfma_f32_16x16x32_bf16 v[208:211], v[112:115], a[240:243], v[208:211]
    buffer_load_dwordx4 v1, s[56:59], s21 offen offset:1024 sc1 lds
    v_mfma_f32_16x16x32_bf16 v[208:211], v[116:119], a[248:251], v[208:211]
    s_add_u32 s21, s21, 36864
    ds_read_b128 v[140:143], v6 offset:8192
    ds_read_b128 v[144:147], v6 offset:1024
    v_mfma_f32_16x16x32_bf16 v[212:215], v[112:115], a[244:247], v[212:215]
    s_add_u32 m0, s44, 4096
    ds_read_b128 v[148:151], v6 offset:9216
    v_mfma_f32_16x16x32_bf16 v[212:215], v[116:119], a[252:255], v[212:215]
    ds_read_b128 v[104:107], v6 offset:2048
    v_mfma_f32_16x16x32_bf16 v[216:219], v[120:123], a[240:243], v[216:219]
    buffer_load_dwordx4 v1, s[56:59], s21 offen sc1 lds
    v_mfma_f32_16x16x32_bf16 v[216:219], v[124:127], a[248:251], v[216:219]
    ds_read_b128 v[108:111], v6 offset:10240
    ds_read_b128 v[112:115], v6 offset:3072
    v_mfma_f32_16x16x32_bf16 v[220:223], v[120:123], a[244:247], v[220:223]
    ds_read_b128 v[116:119], v6 offset:11264
    v_mfma_f32_16x16x32_bf16 v[220:223], v[124:127], a[252:255], v[220:223]
    s_waitcnt lgkmcnt(4)
    ds_read_b128 v[120:123], v6 offset:4096
    v_mfma_f32_16x16x32_bf16 v[224:227], v[128:131], a[240:243], v[224:227]
    buffer_load_dwordx4 v1, s[56:59], s21 offen offset:1024 sc1 lds
    v_mfma_f32_16x16x32_bf16 v[224:227], v[132:135], a[248:251], v[224:227]
    s_add_u32 s21, s21, 36864
    ds_read_b128 v[124:127], v6 offset:12288
    v_mfma_f32_16x16x32_bf16 v[228:231], v[128:131], a[244:247], v[228:231]
    s_add_u32 m0, s44, 6144
    ds_read_b128 v[128:131], v6 offset:5120
    v_mfma_f32_16x16x32_bf16 v[228:231], v[132:135], a[252:255], v[228:231]
    ds_read_b128 v[132:135], v6 offset:13312
    v_mfma_f32_16x16x32_bf16 v[176:179], v[136:139], v[32:35], v[176:179]
    buffer_load_dwordx4 v1, s[56:59], s21 offen sc1 lds
    v_mfma_f32_16x16x32_bf16 v[176:179], v[140:143], v[40:43], v[176:179]
    v_mfma_f32_16x16x32_bf16 v[180:183], v[136:139], v[36:39], v[180:183]
    ds_read_b128 v[136:139], v6 offset:6144
    v_mfma_f32_16x16x32_bf16 v[180:183], v[140:143], v[44:47], v[180:183]
    ds_read_b128 v[140:143], v6 offset:14336
    v_mfma_f32_16x16x32_bf16 v[184:187], v[144:147], v[32:35], v[184:187]
    buffer_load_dwordx4 v1, s[56:59], s21 offen offset:1024 sc1 lds
    v_mfma_f32_16x16x32_bf16 v[184:187], v[148:151], v[40:43], v[184:187]
    s_add_u32 s21, s21, 36864
    s_add_u32 s21, s4, 4
    s_xor_b32 s21, s21, s3
    v_mfma_f32_16x16x32_bf16 v[188:191], v[144:147], v[36:39], v[188:191]
    s_lshl_b32 s21, s21, 2
    s_mul_i32 s21, s21, 36864
    s_add_u32 s21, s21, s28
    v_mfma_f32_16x16x32_bf16 v[188:191], v[148:151], v[44:47], v[188:191]
    s_add_u32 s21, s21, 7168
    s_add_u32 m0, s45, 0
    ds_read_b128 v[144:147], v6 offset:16384
    s_waitcnt lgkmcnt(2)
    v_mfma_f32_16x16x32_bf16 v[192:195], v[104:107], v[32:35], v[192:195]
    buffer_load_dwordx4 v1, s[56:59], s21 offen sc1 lds
    v_mfma_f32_16x16x32_bf16 v[192:195], v[108:111], v[40:43], v[192:195]
    ds_read_b128 v[148:151], v6 offset:24576
    v_mfma_f32_16x16x32_bf16 v[196:199], v[104:107], v[36:39], v[196:199]
    v_mfma_f32_16x16x32_bf16 v[196:199], v[108:111], v[44:47], v[196:199]
    buffer_load_dwordx4 v1, s[56:59], s21 offen offset:1024 sc1 lds
    v_mfma_f32_16x16x32_bf16 v[200:203], v[112:115], v[32:35], v[200:203]
    s_add_u32 s21, s21, 36864
    v_mfma_f32_16x16x32_bf16 v[200:203], v[116:119], v[40:43], v[200:203]
    s_add_u32 m0, s45, 2048
    v_mfma_f32_16x16x32_bf16 v[204:207], v[112:115], v[36:39], v[204:207]
    ds_read_b128 v[112:115], v6 offset:17408
    v_mfma_f32_16x16x32_bf16 v[204:207], v[116:119], v[44:47], v[204:207]
    s_waitcnt vmcnt(10)
    s_barrier
    ds_read_b128 v[104:107], v7 offset:0
    v_mfma_f32_16x16x32_bf16 v[208:211], v[120:123], v[32:35], v[208:211]
    buffer_load_dwordx4 v1, s[56:59], s21 offen sc1 lds
    v_mfma_f32_16x16x32_bf16 v[208:211], v[124:127], v[40:43], v[208:211]
    ds_read_b128 v[108:111], v7 offset:16384
    ds_read_b128 v[116:119], v6 offset:25600
    v_mfma_f32_16x16x32_bf16 v[212:215], v[120:123], v[36:39], v[212:215]
    ds_read_b128 v[120:123], v7 offset:1024
    v_mfma_f32_16x16x32_bf16 v[212:215], v[124:127], v[44:47], v[212:215]
    buffer_load_dwordx4 v1, s[56:59], s21 offen offset:1024 sc1 lds
    v_mfma_f32_16x16x32_bf16 v[216:219], v[128:131], v[32:35], v[216:219]
    s_add_u32 s21, s21, 36864
    ds_read_b128 v[124:127], v7 offset:17408
    v_mfma_f32_16x16x32_bf16 v[216:219], v[132:135], v[40:43], v[216:219]
    s_add_u32 m0, s45, 4096
    v_mfma_f32_16x16x32_bf16 v[220:223], v[128:131], v[36:39], v[220:223]
    ds_read_b128 v[128:131], v6 offset:18432
    v_mfma_f32_16x16x32_bf16 v[220:223], v[132:135], v[44:47], v[220:223]
    buffer_load_dwordx4 v1, s[56:59], s21 offen sc1 lds
    v_mfma_f32_16x16x32_bf16 v[224:227], v[136:139], v[32:35], v[224:227]
    s_waitcnt lgkmcnt(2)
    ds_read_b128 v[132:135], v6 offset:26624
    v_mfma_f32_16x16x32_bf16 v[224:227], v[140:143], v[40:43], v[224:227]
    v_mfma_f32_16x16x32_bf16 v[228:231], v[136:139], v[36:39], v[228:231]
    ds_read_b128 v[136:139], v7 offset:2048
    v_mfma_f32_16x16x32_bf16 v[228:231], v[140:143], v[44:47], v[228:231]
    buffer_load_dwordx4 v1, s[56:59], s21 offen offset:1024 sc1 lds
    v_mfma_f32_16x16x32_bf16 v[176:179], v[144:147], v[48:51], v[176:179]
    s_add_u32 s21, s21, 36864
    ds_read_b128 v[140:143], v7 offset:18432
    v_mfma_f32_16x16x32_bf16 v[176:179], v[148:151], v[56:59], v[176:179]
    s_add_u32 m0, s45, 6144
    v_mfma_f32_16x16x32_bf16 v[176:179], v[104:107], v[64:67], v[176:179]
    v_mfma_f32_16x16x32_bf16 v[176:179], v[108:111], v[72:75], v[176:179]
    buffer_load_dwordx4 v1, s[56:59], s21 offen sc1 lds
    v_mfma_f32_16x16x32_bf16 v[180:183], v[144:147], v[52:55], v[180:183]
    ds_read_b128 v[144:147], v6 offset:19456
    v_mfma_f32_16x16x32_bf16 v[180:183], v[148:151], v[60:63], v[180:183]
    ds_read_b128 v[148:151], v6 offset:27648
    v_mfma_f32_16x16x32_bf16 v[180:183], v[104:107], v[68:71], v[180:183]
    buffer_load_dwordx4 v1, s[56:59], s21 offen offset:1024 sc1 lds
    v_mfma_f32_16x16x32_bf16 v[180:183], v[108:111], v[76:79], v[180:183]
    s_lshr_b32 s64, s4, 1
    s_add_u32 s21, s21, 36864
    s_lshl1_add_u32 s21, s61, s64
    v_mfma_f32_16x16x32_bf16 v[184:187], v[112:115], v[48:51], v[184:187]
    s_mul_i32 s21, s21, 3
    s_add_u32 s21, s21, 128
    s_mul_i32 s21, s21, 36864
    v_mfma_f32_16x16x32_bf16 v[184:187], v[116:119], v[56:59], v[184:187]
    s_add_u32 s21, s21, s28
    s_add_u32 s21, s21, 7168
    s_and_b32 s64, s68, 1024
    v_mfma_f32_16x16x32_bf16 v[184:187], v[120:123], v[64:67], v[184:187]
    s_add_u32 s21, s21, s64
    s_add_u32 m0, s46, 0
    v_cvt_pk_bf16_f32 v232, v176, v177
    s_waitcnt lgkmcnt(0)
    v_mfma_f32_16x16x32_bf16 v[184:187], v[124:127], v[72:75], v[184:187]
    s_lshl2_add_u32 s64, s61, s65
    buffer_load_dwordx4 v1, s[56:59], s21 offen sc1 lds
    v_mfma_f32_16x16x32_bf16 v[188:191], v[112:115], v[52:55], v[188:191]
    s_add_u32 s21, s21, 36864
    v_cvt_pk_bf16_f32 v233, v178, v179
    v_cvt_pk_bf16_f32 v234, v180, v181
    v_mfma_f32_16x16x32_bf16 v[188:191], v[116:119], v[60:63], v[188:191]
    s_add_u32 m0, s46, 1024
    v_cvt_pk_bf16_f32 v235, v182, v183
    ds_read_b128 v[104:107], v7 offset:3072
    v_mfma_f32_16x16x32_bf16 v[188:191], v[120:123], v[68:71], v[188:191]
    s_lshl_b32 s65, s65, 5
    buffer_store_dwordx4 v[232:235], v1, s[48:51], s8 offen offset:0 sc1
    v_mfma_f32_16x16x32_bf16 v[188:191], v[124:127], v[76:79], v[188:191]
    s_add_u32 s65, s65, 1024
    buffer_load_dwordx4 v1, s[56:59], s21 offen sc1 lds
    v_mfma_f32_16x16x32_bf16 v[192:195], v[128:131], v[48:51], v[192:195]
    s_add_u32 s21, s21, 36864
    ds_read_b128 v[108:111], v7 offset:19456
    v_cvt_pk_bf16_f32 v236, v184, v185
    v_mfma_f32_16x16x32_bf16 v[192:195], v[132:135], v[56:59], v[192:195]
    s_add_u32 m0, s46, 2048
    v_cvt_pk_bf16_f32 v237, v186, v187
    v_cvt_pk_bf16_f32 v238, v188, v189
    v_mfma_f32_16x16x32_bf16 v[192:195], v[136:139], v[64:67], v[192:195]
    s_lshl_b32 s64, s64, 6
    v_cvt_pk_bf16_f32 v239, v190, v191
    ds_read_b128 v[112:115], v6 offset:20480
    v_mfma_f32_16x16x32_bf16 v[192:195], v[140:143], v[72:75], v[192:195]
    buffer_load_dwordx4 v1, s[56:59], s21 offen sc1 lds
    v_mfma_f32_16x16x32_bf16 v[196:199], v[128:131], v[52:55], v[196:199]
    s_add_u32 s21, s21, 36864
    ds_read_b128 v[116:119], v6 offset:28672
    ds_read_b128 v[120:123], v7 offset:8192
    v_mfma_f32_16x16x32_bf16 v[196:199], v[132:135], v[60:63], v[196:199]
    ds_read_b128 v[124:127], v7 offset:24576
    v_mfma_f32_16x16x32_bf16 v[196:199], v[136:139], v[68:71], v[196:199]
    buffer_store_dwordx4 v[236:239], v1, s[48:51], s8 offen offset:1024 sc1
    v_mfma_f32_16x16x32_bf16 v[196:199], v[140:143], v[76:79], v[196:199]
    v_cvt_pk_bf16_f32 v240, v192, v193
    v_cvt_pk_bf16_f32 v241, v194, v195
    v_mfma_f32_16x16x32_bf16 v[200:203], v[144:147], v[48:51], v[200:203]
    ds_read_b128 v[128:131], v6 offset:21504
    ds_read_b128 v[132:135], v6 offset:29696
    v_mfma_f32_16x16x32_bf16 v[200:203], v[148:151], v[56:59], v[200:203]
    s_waitcnt lgkmcnt(3)
    ds_read_b128 v[136:139], v7 offset:9216
    v_mfma_f32_16x16x32_bf16 v[200:203], v[104:107], v[64:67], v[200:203]
    v_cvt_pk_bf16_f32 v242, v196, v197
    v_cvt_pk_bf16_f32 v243, v198, v199
    v_mfma_f32_16x16x32_bf16 v[200:203], v[108:111], v[72:75], v[200:203]
    buffer_store_dwordx4 v[240:243], v1, s[48:51], s9 offen offset:0 sc1
    v_mfma_f32_16x16x32_bf16 v[204:207], v[144:147], v[52:55], v[204:207]
    ds_read_b128 v[140:143], v7 offset:25600
    ds_read_b128 v[144:147], v6 offset:22528
    v_mfma_f32_16x16x32_bf16 v[204:207], v[148:151], v[60:63], v[204:207]
    ds_read_b128 v[148:151], v6 offset:30720
    v_mfma_f32_16x16x32_bf16 v[204:207], v[104:107], v[68:71], v[204:207]
    ds_read_b128 v[104:107], v7 offset:10240
    v_cvt_pk_bf16_f32 v244, v200, v201
    v_mfma_f32_16x16x32_bf16 v[204:207], v[108:111], v[76:79], v[204:207]
    v_cvt_pk_bf16_f32 v245, v202, v203
    ds_read_b128 v[108:111], v7 offset:26624
    v_mfma_f32_16x16x32_bf16 v[208:211], v[112:115], v[48:51], v[208:211]
    v_mfma_f32_16x16x32_bf16 v[208:211], v[116:119], v[56:59], v[208:211]
    v_mfma_f32_16x16x32_bf16 v[208:211], v[120:123], v[64:67], v[208:211]
    s_waitcnt lgkmcnt(2)
    v_mfma_f32_16x16x32_bf16 v[208:211], v[124:127], v[72:75], v[208:211]
    v_mfma_f32_16x16x32_bf16 v[212:215], v[112:115], v[52:55], v[212:215]
    v_mfma_f32_16x16x32_bf16 v[212:215], v[116:119], v[60:63], v[212:215]
    v_cvt_pk_bf16_f32 v246, v204, v205
    v_cvt_pk_bf16_f32 v247, v206, v207
    v_mfma_f32_16x16x32_bf16 v[212:215], v[120:123], v[68:71], v[212:215]
    buffer_store_dwordx4 v[244:247], v1, s[48:51], s9 offen offset:1024 sc1
    v_mfma_f32_16x16x32_bf16 v[212:215], v[124:127], v[76:79], v[212:215]
    v_mfma_f32_16x16x32_bf16 v[216:219], v[128:131], v[48:51], v[216:219]
    v_cvt_pk_bf16_f32 v232, v208, v209
    v_cvt_pk_bf16_f32 v233, v210, v211
    v_mfma_f32_16x16x32_bf16 v[216:219], v[132:135], v[56:59], v[216:219]
    v_mfma_f32_16x16x32_bf16 v[216:219], v[136:139], v[64:67], v[216:219]
    v_mfma_f32_16x16x32_bf16 v[216:219], v[140:143], v[72:75], v[216:219]
    s_waitcnt vmcnt(15)
    s_barrier
    v_cvt_pk_bf16_f32 v234, v212, v213
    v_mfma_f32_16x16x32_bf16 v[220:223], v[128:131], v[52:55], v[220:223]
    v_cvt_pk_bf16_f32 v235, v214, v215
    ds_read_b128 v[112:115], v11 offset:0
    v_mfma_f32_16x16x32_bf16 v[220:223], v[132:135], v[60:63], v[220:223]
    buffer_store_dwordx4 v[232:235], v1, s[48:51], s10 offen offset:0 sc1
    v_mfma_f32_16x16x32_bf16 v[220:223], v[136:139], v[68:71], v[220:223]
    ds_read_b128 v[116:119], v11 offset:2048
    ds_read_b128 v[120:123], v11 offset:4096
    v_mfma_f32_16x16x32_bf16 v[220:223], v[140:143], v[76:79], v[220:223]
    ds_read_b128 v[124:127], v11 offset:6144
    v_cvt_pk_bf16_f32 v236, v216, v217
    v_mfma_f32_16x16x32_bf16 v[224:227], v[144:147], v[48:51], v[224:227]
    v_cvt_pk_bf16_f32 v237, v218, v219
    ds_read_b128 v[128:131], v11 offset:1024
    v_mfma_f32_16x16x32_bf16 v[224:227], v[148:151], v[56:59], v[224:227]
    s_waitcnt lgkmcnt(4)
    ds_read_b128 v[132:135], v11 offset:3072
    v_mfma_f32_16x16x32_bf16 v[224:227], v[104:107], v[64:67], v[224:227]
    v_cvt_pk_bf16_f32 v238, v220, v221
    v_cvt_pk_bf16_f32 v239, v222, v223
    v_mfma_f32_16x16x32_bf16 v[224:227], v[108:111], v[72:75], v[224:227]
    buffer_store_dwordx4 v[236:239], v1, s[48:51], s10 offen offset:1024 sc1
    v_mfma_f32_16x16x32_bf16 v[228:231], v[144:147], v[52:55], v[228:231]
    ds_read_b128 v[136:139], v11 offset:5120
    ds_read_b128 v[140:143], v11 offset:7168
    v_mfma_f32_16x16x32_bf16 v[228:231], v[148:151], v[60:63], v[228:231]
    ds_read_b128 v[144:147], v11 offset:8192
    v_mfma_f32_16x16x32_bf16 v[228:231], v[104:107], v[68:71], v[228:231]
    ds_read_b128 v[148:151], v11 offset:10240
    v_cvt_pk_bf16_f32 v240, v224, v225
    v_mfma_f32_16x16x32_bf16 v[228:231], v[108:111], v[76:79], v[228:231]
    v_cvt_pk_bf16_f32 v241, v226, v227
    ds_read_b128 v[104:107], v11 offset:12288
    v_mfma_f32_16x16x32_bf16 v[160:163], v[112:115], a[0:3], 0
    s_waitcnt lgkmcnt(5)
    ds_read_b128 v[108:111], v11 offset:14336
    v_mfma_f32_16x16x32_bf16 v[160:163], v[116:119], a[8:11], v[160:163]
    v_mfma_f32_16x16x32_bf16 v[160:163], v[120:123], a[16:19], v[160:163]
    v_mfma_f32_16x16x32_bf16 v[160:163], v[124:127], a[24:27], v[160:163]
    v_mfma_f32_16x16x32_bf16 v[164:167], v[112:115], a[4:7], 0
    v_cvt_pk_bf16_f32 v242, v228, v229
    v_cvt_pk_bf16_f32 v243, v230, v231
    v_mfma_f32_16x16x32_bf16 v[164:167], v[116:119], a[12:15], v[164:167]
    buffer_store_dwordx4 v[240:243], v1, s[48:51], s11 offen offset:2048 sc1
    v_mfma_f32_16x16x32_bf16 v[164:167], v[120:123], a[20:23], v[164:167]
    ds_read_b128 v[112:115], v11 offset:9216
    ds_read_b128 v[116:119], v11 offset:11264
    v_mfma_f32_16x16x32_bf16 v[164:167], v[124:127], a[28:31], v[164:167]
    ds_read_b128 v[120:123], v11 offset:13312
    v_mfma_f32_16x16x32_bf16 v[168:171], v[128:131], a[0:3], 0
    ds_read_b128 v[124:127], v11 offset:15360
    v_mfma_f32_16x16x32_bf16 v[168:171], v[132:135], a[8:11], v[168:171]
    s_cmp_eq_u32 s4, s61
    s_cselect_b32 s65, s65, 1073741824
    s_cselect_b32 s70, s23, 1073741824
    s_waitcnt lgkmcnt(4)
    v_mfma_f32_16x16x32_bf16 v[168:171], v[136:139], a[16:19], v[168:171]
    s_add_u32 s98, s70, 0
    v_mfma_f32_16x16x32_bf16 v[168:171], v[140:143], a[24:27], v[168:171]
    v_mfma_f32_16x16x32_bf16 v[172:175], v[128:131], a[4:7], 0
    ds_read_b128 v[128:131], v11 offset:16384
    v_mfma_f32_16x16x32_bf16 v[172:175], v[132:135], a[12:15], v[172:175]
    ds_read_b128 v[132:135], v11 offset:18432
    v_mfma_f32_16x16x32_bf16 v[172:175], v[136:139], a[20:23], v[172:175]
    ds_read_b128 v[136:139], v11 offset:20480
    v_mfma_f32_16x16x32_bf16 v[172:175], v[140:143], a[28:31], v[172:175]
    ds_read_b128 v[140:143], v11 offset:22528
    v_mfma_f32_16x16x32_bf16 v[160:163], v[144:147], a[32:35], v[160:163]
    v_mfma_f32_16x16x32_bf16 v[160:163], v[148:151], a[40:43], v[160:163]
    v_mfma_f32_16x16x32_bf16 v[160:163], v[104:107], a[48:51], v[160:163]
    v_mfma_f32_16x16x32_bf16 v[160:163], v[108:111], a[56:59], v[160:163]
    v_mfma_f32_16x16x32_bf16 v[164:167], v[144:147], a[36:39], v[164:167]
    ds_read_b128 v[144:147], v11 offset:17408
    v_mfma_f32_16x16x32_bf16 v[164:167], v[148:151], a[44:47], v[164:167]
    ds_read_b128 v[148:151], v11 offset:19456
    v_mfma_f32_16x16x32_bf16 v[164:167], v[104:107], a[52:55], v[164:167]
    ds_read_b128 v[104:107], v11 offset:21504
    v_mfma_f32_16x16x32_bf16 v[164:167], v[108:111], a[60:63], v[164:167]
    s_waitcnt lgkmcnt(3)
    ds_read_b128 v[108:111], v11 offset:23552
    v_mfma_f32_16x16x32_bf16 v[168:171], v[112:115], a[32:35], v[168:171]
    v_mfma_f32_16x16x32_bf16 v[168:171], v[116:119], a[40:43], v[168:171]
    v_mfma_f32_16x16x32_bf16 v[168:171], v[120:123], a[48:51], v[168:171]
    v_mfma_f32_16x16x32_bf16 v[168:171], v[124:127], a[56:59], v[168:171]
    v_mfma_f32_16x16x32_bf16 v[172:175], v[112:115], a[36:39], v[172:175]
    ds_read_b128 v[112:115], v11 offset:24576
    v_mfma_f32_16x16x32_bf16 v[172:175], v[116:119], a[44:47], v[172:175]
    ds_read_b128 v[116:119], v11 offset:26624
    v_mfma_f32_16x16x32_bf16 v[172:175], v[120:123], a[52:55], v[172:175]
    ds_read_b128 v[120:123], v11 offset:28672
    v_mfma_f32_16x16x32_bf16 v[172:175], v[124:127], a[60:63], v[172:175]
    ds_read_b128 v[124:127], v11 offset:30720
    v_mfma_f32_16x16x32_bf16 v[160:163], v[128:131], a[64:67], v[160:163]
    v_mfma_f32_16x16x32_bf16 v[160:163], v[132:135], a[72:75], v[160:163]
    v_mfma_f32_16x16x32_bf16 v[160:163], v[136:139], a[80:83], v[160:163]
    v_mfma_f32_16x16x32_bf16 v[160:163], v[140:143], a[88:91], v[160:163]
    v_mfma_f32_16x16x32_bf16 v[164:167], v[128:131], a[68:71], v[164:167]
    ds_read_b128 v[128:131], v11 offset:25600
    v_mfma_f32_16x16x32_bf16 v[164:167], v[132:135], a[76:79], v[164:167]
    ds_read_b128 v[132:135], v11 offset:27648
    v_mfma_f32_16x16x32_bf16 v[164:167], v[136:139], a[84:87], v[164:167]
    ds_read_b128 v[136:139], v11 offset:29696
    v_mfma_f32_16x16x32_bf16 v[164:167], v[140:143], a[92:95], v[164:167]
    s_waitcnt lgkmcnt(3)
    ds_read_b128 v[140:143], v11 offset:31744
    v_mfma_f32_16x16x32_bf16 v[168:171], v[144:147], a[64:67], v[168:171]
    v_mfma_f32_16x16x32_bf16 v[168:171], v[148:151], a[72:75], v[168:171]
    v_mfma_f32_16x16x32_bf16 v[168:171], v[104:107], a[80:83], v[168:171]
    v_mfma_f32_16x16x32_bf16 v[168:171], v[108:111], a[88:91], v[168:171]
    v_mfma_f32_16x16x32_bf16 v[172:175], v[144:147], a[68:71], v[172:175]
    v_mfma_f32_16x16x32_bf16 v[172:175], v[148:151], a[76:79], v[172:175]
    v_mfma_f32_16x16x32_bf16 v[172:175], v[104:107], a[84:87], v[172:175]
    v_mfma_f32_16x16x32_bf16 v[172:175], v[108:111], a[92:95], v[172:175]
    v_mfma_f32_16x16x32_bf16 v[160:163], v[112:115], a[96:99], v[160:163]
    v_mfma_f32_16x16x32_bf16 v[160:163], v[116:119], a[104:107], v[160:163]
    v_mfma_f32_16x16x32_bf16 v[160:163], v[120:123], a[112:115], v[160:163]
    s_waitcnt vmcnt(0)
    buffer_store_dword v31, v23, s[32:35], s22 offen sc1
    v_mfma_f32_16x16x32_bf16 v[160:163], v[124:127], a[120:123], v[160:163]
    s_waitcnt vmcnt(7)
    s_barrier
    ds_read_b128 v[144:147], v12 offset:0
    v_mfma_f32_16x16x32_bf16 v[164:167], v[112:115], a[100:103], v[164:167]
    ds_read_b128 v[148:151], v12 offset:2048
    ds_read_b128 v[104:107], v12 offset:4096
    v_mfma_f32_16x16x32_bf16 v[164:167], v[116:119], a[108:111], v[164:167]
    ds_read_b128 v[108:111], v12 offset:6144
    v_mfma_f32_16x16x32_bf16 v[164:167], v[120:123], a[116:119], v[164:167]
    ds_read_b128 v[112:115], v12 offset:1024
    v_mfma_f32_16x16x32_bf16 v[164:167], v[124:127], a[124:127], v[164:167]
    s_waitcnt lgkmcnt(5)
    ds_read_b128 v[116:119], v12 offset:3072
    v_mfma_f32_16x16x32_bf16 v[168:171], v[128:131], a[96:99], v[168:171]
    ds_read_b128 v[120:123], v12 offset:5120
    v_mfma_f32_16x16x32_bf16 v[168:171], v[132:135], a[104:107], v[168:171]
    ds_read_b128 v[124:127], v12 offset:7168
    v_mfma_f32_16x16x32_bf16 v[168:171], v[136:139], a[112:115], v[168:171]
    v_mfma_f32_16x16x32_bf16 v[168:171], v[140:143], a[120:123], v[168:171]
    v_mfma_f32_16x16x32_bf16 v[172:175], v[128:131], a[100:103], v[172:175]
    ds_read_b128 v[128:131], v12 offset:8192
    v_mfma_f32_16x16x32_bf16 v[172:175], v[132:135], a[108:111], v[172:175]
    ds_read_b128 v[132:135], v12 offset:10240
    v_mfma_f32_16x16x32_bf16 v[172:175], v[136:139], a[116:119], v[172:175]
    ds_read_b128 v[136:139], v12 offset:12288
    v_mfma_f32_16x16x32_bf16 v[172:175], v[140:143], a[124:127], v[172:175]
    s_waitcnt lgkmcnt(3)
    ds_read_b128 v[140:143], v12 offset:14336
    v_mfma_f32_16x16x32_bf16 v[160:163], v[144:147], a[128:131], v[160:163]
    v_mfma_f32_16x16x32_bf16 v[160:163], v[148:151], a[136:139], v[160:163]
    v_mfma_f32_16x16x32_bf16 v[160:163], v[104:107], a[144:147], v[160:163]
    v_mfma_f32_16x16x32_bf16 v[160:163], v[108:111], a[152:155], v[160:163]
    v_mfma_f32_16x16x32_bf16 v[164:167], v[144:147], a[132:135], v[164:167]
    ds_read_b128 v[144:147], v12 offset:9216
    v_mfma_f32_16x16x32_bf16 v[164:167], v[148:151], a[140:143], v[164:167]
    ds_read_b128 v[148:151], v12 offset:11264
    v_mfma_f32_16x16x32_bf16 v[164:167], v[104:107], a[148:151], v[164:167]
    ds_read_b128 v[104:107], v12 offset:13312
    v_mfma_f32_16x16x32_bf16 v[164:167], v[108:111], a[156:159], v[164:167]
    ds_read_b128 v[108:111], v12 offset:15360
    v_mfma_f32_16x16x32_bf16 v[168:171], v[112:115], a[128:131], v[168:171]
    v_mfma_f32_16x16x32_bf16 v[168:171], v[116:119], a[136:139], v[168:171]
    v_mfma_f32_16x16x32_bf16 v[168:171], v[120:123], a[144:147], v[168:171]
    v_mfma_f32_16x16x32_bf16 v[168:171], v[124:127], a[152:155], v[168:171]
    v_mfma_f32_16x16x32_bf16 v[172:175], v[112:115], a[132:135], v[172:175]
    ds_read_b128 v[112:115], v12 offset:16384
    v_mfma_f32_16x16x32_bf16 v[172:175], v[116:119], a[140:143], v[172:175]
    ds_read_b128 v[116:119], v12 offset:18432
    v_mfma_f32_16x16x32_bf16 v[172:175], v[120:123], a[148:151], v[172:175]
    ds_read_b128 v[120:123], v12 offset:20480
    v_mfma_f32_16x16x32_bf16 v[172:175], v[124:127], a[156:159], v[172:175]
    s_waitcnt lgkmcnt(3)
    ds_read_b128 v[124:127], v12 offset:22528
    v_mfma_f32_16x16x32_bf16 v[160:163], v[128:131], a[160:163], v[160:163]
    v_mfma_f32_16x16x32_bf16 v[160:163], v[132:135], a[168:171], v[160:163]
    v_mfma_f32_16x16x32_bf16 v[160:163], v[136:139], a[176:179], v[160:163]
    v_mfma_f32_16x16x32_bf16 v[160:163], v[140:143], a[184:187], v[160:163]
    v_mfma_f32_16x16x32_bf16 v[164:167], v[128:131], a[164:167], v[164:167]
    ds_read_b128 v[128:131], v12 offset:17408
    v_mfma_f32_16x16x32_bf16 v[164:167], v[132:135], a[172:175], v[164:167]
    buffer_load_dword v3, v19, s[32:35], s66 offen sc1
    v_mfma_f32_16x16x32_bf16 v[164:167], v[136:139], a[180:183], v[164:167]
    ds_read_b128 v[132:135], v12 offset:19456
    ds_read_b128 v[136:139], v12 offset:21504
    v_mfma_f32_16x16x32_bf16 v[164:167], v[140:143], a[188:191], v[164:167]
    ds_read_b128 v[140:143], v12 offset:23552
    v_mfma_f32_16x16x32_bf16 v[168:171], v[144:147], a[160:163], v[168:171]
    v_mfma_f32_16x16x32_bf16 v[168:171], v[148:151], a[168:171], v[168:171]
    v_mfma_f32_16x16x32_bf16 v[168:171], v[104:107], a[176:179], v[168:171]
    v_mfma_f32_16x16x32_bf16 v[168:171], v[108:111], a[184:187], v[168:171]
    v_mfma_f32_16x16x32_bf16 v[172:175], v[144:147], a[164:167], v[172:175]
    ds_read_b128 v[144:147], v12 offset:24576
    v_mfma_f32_16x16x32_bf16 v[172:175], v[148:151], a[172:175], v[172:175]
    ds_read_b128 v[148:151], v12 offset:26624
    v_mfma_f32_16x16x32_bf16 v[172:175], v[104:107], a[180:183], v[172:175]
    ds_read_b128 v[104:107], v12 offset:28672
    v_mfma_f32_16x16x32_bf16 v[172:175], v[108:111], a[188:191], v[172:175]
    s_waitcnt lgkmcnt(3)
    ds_read_b128 v[108:111], v12 offset:30720
    v_mfma_f32_16x16x32_bf16 v[160:163], v[112:115], a[192:195], v[160:163]
    v_mfma_f32_16x16x32_bf16 v[160:163], v[116:119], a[200:203], v[160:163]
    v_mfma_f32_16x16x32_bf16 v[160:163], v[120:123], a[208:211], v[160:163]
    v_mfma_f32_16x16x32_bf16 v[160:163], v[124:127], a[216:219], v[160:163]
    v_mfma_f32_16x16x32_bf16 v[164:167], v[112:115], a[196:199], v[164:167]
    ds_read_b128 v[112:115], v12 offset:25600
    v_mfma_f32_16x16x32_bf16 v[164:167], v[116:119], a[204:207], v[164:167]
    ds_read_b128 v[116:119], v12 offset:27648
    v_mfma_f32_16x16x32_bf16 v[164:167], v[120:123], a[212:215], v[164:167]
    ds_read_b128 v[120:123], v12 offset:29696
    v_mfma_f32_16x16x32_bf16 v[164:167], v[124:127], a[220:223], v[164:167]
    ds_read_b128 v[124:127], v12 offset:31744
    v_mfma_f32_16x16x32_bf16 v[168:171], v[128:131], a[192:195], v[168:171]
    v_mfma_f32_16x16x32_bf16 v[168:171], v[132:135], a[200:203], v[168:171]
    v_mfma_f32_16x16x32_bf16 v[168:171], v[136:139], a[208:211], v[168:171]
    v_mfma_f32_16x16x32_bf16 v[168:171], v[140:143], a[216:219], v[168:171]
    v_mfma_f32_16x16x32_bf16 v[172:175], v[128:131], a[196:199], v[172:175]
    ds_read_b128 v[128:131], v13 offset:0
    v_mfma_f32_16x16x32_bf16 v[172:175], v[132:135], a[204:207], v[172:175]
    ds_read_b128 v[132:135], v13 offset:1024
    v_mfma_f32_16x16x32_bf16 v[172:175], v[136:139], a[212:215], v[172:175]
    ds_read_b128 v[136:139], v13 offset:2048
    v_mfma_f32_16x16x32_bf16 v[172:175], v[140:143], a[220:223], v[172:175]
    s_waitcnt lgkmcnt(3)
    ds_read_b128 v[140:143], v13 offset:8192
    v_mfma_f32_16x16x32_bf16 v[160:163], v[144:147], a[224:227], v[160:163]
    s_waitcnt vmcnt(0)
    v_cmp_gt_u32 vcc, 2, v3
    s_nop 1
    s_and_b64 vcc, vcc, exec
    s_cbranch_scc1 SPIN_X
BACK_X:
    v_mfma_f32_16x16x32_bf16 v[160:163], v[148:151], a[232:235], v[160:163]
    buffer_load_dwordx4 v[200:203], v1, s[48:51], s98 offen offset:2048 sc1
    v_mfma_f32_16x16x32_bf16 v[160:163], v[104:107], a[240:243], v[160:163]
    s_add_u32 s98, s70, 12288
    buffer_load_dwordx4 v[204:207], v1, s[48:51], s98 offen offset:2048 sc1
    v_mfma_f32_16x16x32_bf16 v[160:163], v[108:111], a[248:251], v[160:163]
    s_add_u32 s98, s70, 24576
    v_mfma_f32_16x16x32_bf16 v[164:167], v[144:147], a[228:231], v[164:167]
    ds_read_b128 v[144:147], v13 offset:9216
    v_mfma_f32_16x16x32_bf16 v[164:167], v[148:151], a[236:239], v[164:167]
    buffer_load_dwordx4 v[208:211], v1, s[48:51], s98 offen offset:2048 sc1
    v_mfma_f32_16x16x32_bf16 v[164:167], v[104:107], a[244:247], v[164:167]
    s_add_u32 s98, s23, 0
    ds_read_b128 v[148:151], v13 offset:10240
    ds_read_b128 v[104:107], v13 offset:16384
    v_mfma_f32_16x16x32_bf16 v[164:167], v[108:111], a[252:255], v[164:167]
    ds_read_b128 v[108:111], v13 offset:17408
    v_mfma_f32_16x16x32_bf16 v[168:171], v[112:115], a[224:227], v[168:171]
    v_mfma_f32_16x16x32_bf16 v[168:171], v[116:119], a[232:235], v[168:171]
    buffer_load_dwordx4 v[176:179], v1, s[48:51], s98 offen offset:0 sc1
    v_mfma_f32_16x16x32_bf16 v[168:171], v[120:123], a[240:243], v[168:171]
    s_add_u32 s98, s23, 12288
    v_mfma_f32_16x16x32_bf16 v[168:171], v[124:127], a[248:251], v[168:171]
    v_mfma_f32_16x16x32_bf16 v[172:175], v[112:115], a[228:231], v[172:175]
    buffer_load_dwordx4 v[180:183], v1, s[48:51], s98 offen offset:0 sc1
    v_mfma_f32_16x16x32_bf16 v[172:175], v[116:119], a[236:239], v[172:175]
    s_add_u32 s98, s23, 24576
    ds_read_b128 v[112:115], v13 offset:18432
    ds_read_b128 v[116:119], v13 offset:24576
    v_mfma_f32_16x16x32_bf16 v[172:175], v[120:123], a[244:247], v[172:175]
    ds_read_b128 v[120:123], v13 offset:25600
    v_mfma_f32_16x16x32_bf16 v[172:175], v[124:127], a[252:255], v[172:175]
    s_waitcnt lgkmcnt(3)
    ds_read_b128 v[124:127], v13 offset:26624
    v_mfma_f32_16x16x32_bf16 v[160:163], v[128:131], v[32:35], v[160:163]
    buffer_load_dwordx4 v[184:187], v1, s[48:51], s98 offen offset:0 sc1
    v_mfma_f32_16x16x32_bf16 v[160:163], v[132:135], v[40:43], v[160:163]
    s_add_u32 s98, s23, 0
    v_mfma_f32_16x16x32_bf16 v[160:163], v[136:139], v[48:51], v[160:163]
    v_mfma_f32_16x16x32_bf16 v[164:167], v[128:131], v[36:39], v[164:167]
    v_mfma_f32_16x16x32_bf16 v[164:167], v[132:135], v[44:47], v[164:167]
    buffer_load_dwordx4 v[188:191], v1, s[48:51], s98 offen offset:1024 sc1
    v_mfma_f32_16x16x32_bf16 v[164:167], v[136:139], v[52:55], v[164:167]
    s_add_u32 s98, s23, 12288
    v_mfma_f32_16x16x32_bf16 v[168:171], v[140:143], v[32:35], v[168:171]
    v_mfma_f32_16x16x32_bf16 v[168:171], v[144:147], v[40:43], v[168:171]
    buffer_load_dwordx4 v[192:195], v1, s[48:51], s98 offen offset:1024 sc1
    v_mfma_f32_16x16x32_bf16 v[168:171], v[148:151], v[48:51], v[168:171]
    s_add_u32 s98, s23, 24576
    v_mfma_f32_16x16x32_bf16 v[172:175], v[140:143], v[36:39], v[172:175]
    v_mfma_f32_16x16x32_bf16 v[172:175], v[144:147], v[44:47], v[172:175]
    v_mfma_f32_16x16x32_bf16 v[172:175], v[148:151], v[52:55], v[172:175]
    buffer_load_dwordx4 v[196:199], v1, s[48:51], s98 offen offset:1024 sc1
    v_mfma_f32_16x16x32_bf16 v[160:163], v[104:107], v[56:59], v[160:163]
    v_mfma_f32_16x16x32_bf16 v[160:163], v[108:111], v[64:67], v[160:163]
    s_waitcnt lgkmcnt(0)
    v_mfma_f32_16x16x32_bf16 v[160:163], v[112:115], v[72:75], v[160:163]
    v_mfma_f32_16x16x32_bf16 v[164:167], v[104:107], v[60:63], v[164:167]
    v_mfma_f32_16x16x32_bf16 v[164:167], v[108:111], v[68:71], v[164:167]
    v_mfma_f32_16x16x32_bf16 v[164:167], v[112:115], v[76:79], v[164:167]
    v_mfma_f32_16x16x32_bf16 v[168:171], v[116:119], v[56:59], v[168:171]
    v_mfma_f32_16x16x32_bf16 v[168:171], v[120:123], v[64:67], v[168:171]
    v_mfma_f32_16x16x32_bf16 v[168:171], v[124:127], v[72:75], v[168:171]
    v_mfma_f32_16x16x32_bf16 v[172:175], v[116:119], v[60:63], v[172:175]
    v_mfma_f32_16x16x32_bf16 v[172:175], v[120:123], v[68:71], v[172:175]
    v_mfma_f32_16x16x32_bf16 v[172:175], v[124:127], v[76:79], v[172:175]
    s_cmp_lg_u32 s4, s61
    s_cbranch_scc1 K1_X2
    s_waitcnt vmcnt(6)
    v_lshlrev_b32 v80, 16, v200
    v_and_b32 v81, 0xffff0000, v200
    v_lshlrev_b32 v82, 16, v204
    v_and_b32 v83, 0xffff0000, v204
    v_lshlrev_b32 v84, 16, v208
    v_and_b32 v85, 0xffff0000, v208
    v_pk_add_f32 v[80:81], v[80:81], v[82:83]
    v_pk_add_f32 v[224:225], v[224:225], v[84:85]
    v_pk_add_f32 v[224:225], v[224:225], v[80:81]
    v_cvt_pk_bf16_f32 v200, v224, v225
    v_lshlrev_b32 v86, 16, v201
    v_and_b32 v87, 0xffff0000, v201
    v_lshlrev_b32 v88, 16, v205
    v_and_b32 v89, 0xffff0000, v205
    v_lshlrev_b32 v90, 16, v209
    v_and_b32 v91, 0xffff0000, v209
    v_pk_add_f32 v[86:87], v[86:87], v[88:89]
    v_pk_add_f32 v[226:227], v[226:227], v[90:91]
    v_pk_add_f32 v[226:227], v[226:227], v[86:87]
    v_cvt_pk_bf16_f32 v201, v226, v227
    buffer_store_dwordx2 v[200:201], v20, s[24:27], s65 offen
    v_lshlrev_b32 v92, 16, v202
    v_and_b32 v93, 0xffff0000, v202
    v_lshlrev_b32 v94, 16, v206
    v_and_b32 v95, 0xffff0000, v206
    v_lshlrev_b32 v96, 16, v210
    v_and_b32 v97, 0xffff0000, v210
    v_pk_add_f32 v[92:93], v[92:93], v[94:95]
    v_pk_add_f32 v[228:229], v[228:229], v[96:97]
    v_pk_add_f32 v[228:229], v[228:229], v[92:93]
    v_cvt_pk_bf16_f32 v202, v228, v229
    v_lshlrev_b32 v98, 16, v203
    v_and_b32 v99, 0xffff0000, v203
    v_lshlrev_b32 v100, 16, v207
    v_and_b32 v101, 0xffff0000, v207
    v_lshlrev_b32 v102, 16, v211
    v_and_b32 v103, 0xffff0000, v211
    v_pk_add_f32 v[98:99], v[98:99], v[100:101]
    v_pk_add_f32 v[230:231], v[230:231], v[102:103]
    v_pk_add_f32 v[230:231], v[230:231], v[98:99]
    v_cvt_pk_bf16_f32 v203, v230, v231
    buffer_store_dwordx2 v[202:203], v21, s[24:27], s65 offen
    s_waitcnt vmcnt(2)
K1_X2:
    s_waitcnt vmcnt(3)
    v_lshlrev_b32 v80, 16, v176
    v_and_b32 v81, 0xffff0000, v176
    v_lshlrev_b32 v82, 16, v180
    v_and_b32 v83, 0xffff0000, v180
    v_lshlrev_b32 v84, 16, v184
    v_and_b32 v85, 0xffff0000, v184
    v_pk_add_f32 v[80:81], v[80:81], v[82:83]
    v_pk_add_f32 v[160:161], v[160:161], v[84:85]
    v_pk_add_f32 v[160:161], v[160:161], v[80:81]
    v_cvt_pk_bf16_f32 v176, v160, v161
    v_lshlrev_b32 v86, 16, v177
    v_and_b32 v87, 0xffff0000, v177
    v_lshlrev_b32 v88, 16, v181
    v_and_b32 v89, 0xffff0000, v181
    v_lshlrev_b32 v90, 16, v185
    v_and_b32 v91, 0xffff0000, v185
    v_pk_add_f32 v[86:87], v[86:87], v[88:89]
    v_pk_add_f32 v[162:163], v[162:163], v[90:91]
    v_pk_add_f32 v[162:163], v[162:163], v[86:87]
    v_cvt_pk_bf16_f32 v177, v162, v163
    buffer_store_dwordx2 v[176:177], v20, s[24:27], s64 offen
    v_lshlrev_b32 v92, 16, v178
    v_and_b32 v93, 0xffff0000, v178
    v_lshlrev_b32 v94, 16, v182
    v_and_b32 v95, 0xffff0000, v182
    v_lshlrev_b32 v96, 16, v186
    v_and_b32 v97, 0xffff0000, v186
    v_pk_add_f32 v[92:93], v[92:93], v[94:95]
    v_pk_add_f32 v[164:165], v[164:165], v[96:97]
    v_pk_add_f32 v[164:165], v[164:165], v[92:93]
    v_cvt_pk_bf16_f32 v178, v164, v165
    v_lshlrev_b32 v98, 16, v179
    v_and_b32 v99, 0xffff0000, v179
    v_lshlrev_b32 v100, 16, v183
    v_and_b32 v101, 0xffff0000, v183
    v_lshlrev_b32 v102, 16, v187
    v_and_b32 v103, 0xffff0000, v187
    v_pk_add_f32 v[98:99], v[98:99], v[100:101]
    v_pk_add_f32 v[166:167], v[166:167], v[102:103]
    v_pk_add_f32 v[166:167], v[166:167], v[98:99]
    v_cvt_pk_bf16_f32 v179, v166, v167
    buffer_store_dwordx2 v[178:179], v21, s[24:27], s64 offen
    s_waitcnt vmcnt(2)
    v_lshlrev_b32 v80, 16, v188
    v_and_b32 v81, 0xffff0000, v188
    v_lshlrev_b32 v82, 16, v192
    v_and_b32 v83, 0xffff0000, v192
    v_lshlrev_b32 v84, 16, v196
    v_and_b32 v85, 0xffff0000, v196
    v_pk_add_f32 v[80:81], v[80:81], v[82:83]
    v_pk_add_f32 v[168:169], v[168:169], v[84:85]
    v_pk_add_f32 v[168:169], v[168:169], v[80:81]
    v_cvt_pk_bf16_f32 v188, v168, v169
    v_lshlrev_b32 v86, 16, v189
    v_and_b32 v87, 0xffff0000, v189
    v_lshlrev_b32 v88, 16, v193
    v_and_b32 v89, 0xffff0000, v193
    v_lshlrev_b32 v90, 16, v197
    v_and_b32 v91, 0xffff0000, v197
    v_pk_add_f32 v[86:87], v[86:87], v[88:89]
    v_pk_add_f32 v[170:171], v[170:171], v[90:91]
    v_pk_add_f32 v[170:171], v[170:171], v[86:87]
    v_cvt_pk_bf16_f32 v189, v170, v171
    buffer_store_dwordx2 v[188:189], v20, s[24:27], s64 offen offset:32
    v_lshlrev_b32 v92, 16, v190
    v_and_b32 v93, 0xffff0000, v190
    v_lshlrev_b32 v94, 16, v194
    v_and_b32 v95, 0xffff0000, v194
    v_lshlrev_b32 v96, 16, v198
    v_and_b32 v97, 0xffff0000, v198
    v_pk_add_f32 v[92:93], v[92:93], v[94:95]
    v_pk_add_f32 v[172:173], v[172:173], v[96:97]
    v_pk_add_f32 v[172:173], v[172:173], v[92:93]
    v_cvt_pk_bf16_f32 v190, v172, v173
    v_lshlrev_b32 v98, 16, v191
    v_and_b32 v99, 0xffff0000, v191
    v_lshlrev_b32 v100, 16, v195
    v_and_b32 v101, 0xffff0000, v195
    v_lshlrev_b32 v102, 16, v199
    v_and_b32 v103, 0xffff0000, v199
    v_pk_add_f32 v[98:99], v[98:99], v[100:101]
    v_pk_add_f32 v[174:175], v[174:175], v[102:103]
    v_pk_add_f32 v[174:175], v[174:175], v[98:99]
    v_cvt_pk_bf16_f32 v191, v174, v175
    buffer_store_dwordx2 v[190:191], v21, s[24:27], s64 offen offset:32
K1_END:
    s_endpgm
K1_LB_MASK:
    buffer_load_dword v3, v29, s[32:35], s92 offen sc1
    s_nop 1
    v_add_f32 v212, s12, v144
    v_fma_f32 v176, v208, s8, v212
    v_fma_f32 v177, v209, s8, v212
    v_fma_f32 v178, v210, s8, v212
    v_fma_f32 v179, v211, s8, v212
    v_add_f32 v213, s13, v144
    v_fma_f32 v180, v208, s9, v213
    v_fma_f32 v181, v209, s9, v213
    v_fma_f32 v182, v210, s9, v213
    v_fma_f32 v183, v211, s9, v213
    v_add_f32 v214, s14, v144
    v_fma_f32 v184, v208, s10, v214
    v_fma_f32 v185, v209, s10, v214
    v_fma_f32 v186, v210, s10, v214
    v_fma_f32 v187, v211, s10, v214
    v_add_f32 v215, s15, v144
    v_fma_f32 v188, v208, s11, v215
    v_fma_f32 v189, v209, s11, v215
    v_fma_f32 v190, v210, s11, v215
    v_fma_f32 v191, v211, s11, v215
    s_nop 1
    s_branch K1_LB_BACK
K1_LS_MASK:
    s_cmp_eq_u32 s78, 1
    s_cbranch_scc1 K1_LS_LAST
    buffer_load_dword v3, v29, s[32:35], s92 offen sc1
    s_branch K1_LS_BACK
K1_LS_LAST:
    v_cmp_gt_u32 vcc, 1, v3
    s_nop 1
    s_cmp_lg_u32 vcc_lo, 0
    s_cbranch_scc1 SPIN_W0
BACK_W0:
    s_mov_b64 s[36:37], s[56:57]
    s_mov_b32 s38, 5603328
    s_xor_b32 s77, s3, 0
    s_lshl2_add_u32 s77, s77, s4
    s_mul_i32 s77, s77, 36864
    s_add_u32 s77, s77, s28
    s_nop 1
    v_add_f32 v212, s12, v152
    v_fma_f32 v176, v208, s8, v212
    v_fma_f32 v177, v209, s8, v212
    v_fma_f32 v178, v210, s8, v212
    v_fma_f32 v179, v211, s8, v212
    v_add_f32 v213, s13, v152
    v_fma_f32 v180, v208, s9, v213
    v_fma_f32 v181, v209, s9, v213
    v_fma_f32 v182, v210, s9, v213
    v_fma_f32 v183, v211, s9, v213
    v_add_f32 v214, s14, v152
    v_fma_f32 v184, v208, s10, v214
    v_fma_f32 v185, v209, s10, v214
    v_fma_f32 v186, v210, s10, v214
    v_fma_f32 v187, v211, s10, v214
    v_add_f32 v215, s15, v152
    v_fma_f32 v188, v208, s11, v215
    v_fma_f32 v189, v209, s11, v215
    v_fma_f32 v190, v210, s11, v215
    v_fma_f32 v191, v211, s11, v215
    s_nop 1
    s_branch K1_LS_BACK
K1_J7:
    v_cmp_gt_u32 vcc, 1, v3
    s_nop 1
    s_cmp_lg_u32 vcc_lo, 0
    s_cbranch_scc1 SPIN_W7
BACK_W7:
    s_mov_b64 s[36:37], s[56:57]
    s_mov_b32 s38, 5603328
    s_xor_b32 s77, s3, 0
    s_lshl2_add_u32 s77, s77, s4
    s_mul_i32 s77, s77, 36864
    s_add_u32 s77, s77, s28
    s_branch K1_J7_BACK
K1_REDO:
    s_mov_b32 s83, 1
    s_mov_b32 s63, 1073741824
    s_mov_b32 s64, 1073741824
    s_mov_b32 s62, 1073741824
    s_mul_i32 s7, s5, 1081344
    s_sub_u32 s7, 56623104, s7
    s_sub_u32 s36, s56, s7
    s_subb_u32 s37, s57, 0
    s_mov_b32 s38, 1081344
    s_mov_b32 s50, 0
    s_mov_b32 s54, 0
    s_waitcnt vmcnt(0) lgkmcnt(0)
    s_barrier
    v_lshrrev_b32 v92, 4, v1
    v_and_b32 v64, 15, v92
    v_lshrrev_b32 v92, 4, v92
    v_lshlrev_b32 v92, 2, v92
    v_sub_u32 v92, v64, v92
    s_lshl_b32 s98, s4, 4
    v_add_u32 v92, s98, v92
    s_lshl_b32 s98, s6, 7
    s_sub_u32 s99, 1920, s98
    v_add_u32 v64, s98, v92
    v_add_u32 v65, 64, v64
    v_add_u32 v66, s99, v92
    v_add_u32 v67, 64, v66
    v_mov_b32 v93, 0xf149f2ca
    v_mov_b32 v68, v93
    v_mov_b32 v69, v93
    v_mov_b32 v70, v93
    v_mov_b32 v71, v93
    s_mov_b32 s78, 0
    s_add_u32 s99, s99, 128
K1_REDO_L:
    s_lshr_b32 s7, s78, 6
    s_lshl_b32 s7, s7, 15
    s_bfe_u32 s98, s78, 0x20004
    s_lshl_b32 s98, s98, 12
    s_add_u32 s7, s7, s98
    buffer_load_dwordx4 v[72:75], v1, s[36:39], s7 offen offset:0 sc1
    buffer_load_dwordx4 v[76:79], v1, s[36:39], s7 offen offset:1024 sc1
    buffer_load_dwordx4 v[80:83], v1, s[36:39], s7 offen offset:2048 sc1
    buffer_load_dwordx4 v[84:87], v1, s[36:39], s7 offen offset:3072 sc1
    s_waitcnt vmcnt(0)
    v_mfma_f32_16x16x32_bf16 v[88:91], v[72:75], v[128:131], 0
    v_mfma_f32_16x16x32_bf16 v[88:91], v[76:79], v[160:163], v[88:91]
    v_mfma_f32_16x16x32_bf16 v[88:91], v[80:83], v[192:195], v[88:91]
    v_mfma_f32_16x16x32_bf16 v[88:91], v[84:87], v[224:227], v[88:91]
    v_subrev_u32 v92, s78, v64
    v_cmp_le_i32 vcc, 0, v92
    s_nop 5
    v_cndmask_b32 v88, v93, v88, vcc
    v_max_f32 v68, v68, v88
    v_cmp_le_i32 vcc, 1, v92
    s_nop 1
    v_cndmask_b32 v89, v93, v89, vcc
    v_max_f32 v68, v68, v89
    v_cmp_le_i32 vcc, 2, v92
    s_nop 1
    v_cndmask_b32 v90, v93, v90, vcc
    v_max_f32 v68, v68, v90
    v_cmp_le_i32 vcc, 3, v92
    s_nop 1
    v_cndmask_b32 v91, v93, v91, vcc
    v_max_f32 v68, v68, v91
    v_mfma_f32_16x16x32_bf16 v[88:91], v[72:75], v[132:135], 0
    v_mfma_f32_16x16x32_bf16 v[88:91], v[76:79], v[164:167], v[88:91]
    v_mfma_f32_16x16x32_bf16 v[88:91], v[80:83], v[196:199], v[88:91]
    v_mfma_f32_16x16x32_bf16 v[88:91], v[84:87], v[228:231], v[88:91]
    v_subrev_u32 v92, s78, v65
    v_cmp_le_i32 vcc, 0, v92
    s_nop 5
    v_cndmask_b32 v88, v93, v88, vcc
    v_max_f32 v69, v69, v88
    v_cmp_le_i32 vcc, 1, v92
    s_nop 1
    v_cndmask_b32 v89, v93, v89, vcc
    v_max_f32 v69, v69, v89
    v_cmp_le_i32 vcc, 2, v92
    s_nop 1
    v_cndmask_b32 v90, v93, v90, vcc
    v_max_f32 v69, v69, v90
    v_cmp_le_i32 vcc, 3, v92
    s_nop 1
    v_cndmask_b32 v91, v93, v91, vcc
    v_max_f32 v69, v69, v91
    v_mfma_f32_16x16x32_bf16 v[88:91], v[72:75], v[136:139], 0
    v_mfma_f32_16x16x32_bf16 v[88:91], v[76:79], v[168:171], v[88:91]
    v_mfma_f32_16x16x32_bf16 v[88:91], v[80:83], v[200:203], v[88:91]
    v_mfma_f32_16x16x32_bf16 v[88:91], v[84:87], v[232:235], v[88:91]
    v_subrev_u32 v92, s78, v66
    v_cmp_le_i32 vcc, 0, v92
    s_nop 5
    v_cndmask_b32 v88, v93, v88, vcc
    v_max_f32 v70, v70, v88
    v_cmp_le_i32 vcc, 1, v92
    s_nop 1
    v_cndmask_b32 v89, v93, v89, vcc
    v_max_f32 v70, v70, v89
    v_cmp_le_i32 vcc, 2, v92
    s_nop 1
    v_cndmask_b32 v90, v93, v90, vcc
    v_max_f32 v70, v70, v90
    v_cmp_le_i32 vcc, 3, v92
    s_nop 1
    v_cndmask_b32 v91, v93, v91, vcc
    v_max_f32 v70, v70, v91
    v_mfma_f32_16x16x32_bf16 v[88:91], v[72:75], v[140:143], 0
    v_mfma_f32_16x16x32_bf16 v[88:91], v[76:79], v[172:175], v[88:91]
    v_mfma_f32_16x16x32_bf16 v[88:91], v[80:83], v[204:207], v[88:91]
    v_mfma_f32_16x16x32_bf16 v[88:91], v[84:87], v[236:239], v[88:91]
    v_subrev_u32 v92, s78, v67
    v_cmp_le_i32 vcc, 0, v92
    s_nop 5
    v_cndmask_b32 v88, v93, v88, vcc
    v_max_f32 v71, v71, v88
    v_cmp_le_i32 vcc, 1, v92
    s_nop 1
    v_cndmask_b32 v89, v93, v89, vcc
    v_max_f32 v71, v71, v89
    v_cmp_le_i32 vcc, 2, v92
    s_nop 1
    v_cndmask_b32 v90, v93, v90, vcc
    v_max_f32 v71, v71, v90
    v_cmp_le_i32 vcc, 3, v92
    s_nop 1
    v_cndmask_b32 v91, v93, v91, vcc
    v_max_f32 v71, v71, v91
    s_add_u32 s78, s78, 16
    s_cmp_lt_u32 s78, s99
    s_cbranch_scc1 K1_REDO_L
    v_mov_b32 v92, v68
    s_nop 1
    v_permlane32_swap_b32 v68, v92
    v_max_f32 v68, v68, v92
    v_mov_b32 v92, v68
    s_nop 1
    v_permlane16_swap_b32 v68, v92
    v_max_f32 v68, v68, v92
    v_sub_f32 v144, 0, v68
    v_sub_f32 v145, 0, v68
    v_sub_f32 v146, 0, v68
    v_sub_f32 v147, 0, v68
    v_mov_b32 v92, v69
    s_nop 1
    v_permlane32_swap_b32 v69, v92
    v_max_f32 v69, v69, v92
    v_mov_b32 v92, v69
    s_nop 1
    v_permlane16_swap_b32 v69, v92
    v_max_f32 v69, v69, v92
    v_sub_f32 v148, 0, v69
    v_sub_f32 v149, 0, v69
    v_sub_f32 v150, 0, v69
    v_sub_f32 v151, 0, v69
    v_mov_b32 v92, v70
    s_nop 1
    v_permlane32_swap_b32 v70, v92
    v_max_f32 v70, v70, v92
    v_mov_b32 v92, v70
    s_nop 1
    v_permlane16_swap_b32 v70, v92
    v_max_f32 v70, v70, v92
    v_sub_f32 v152, 0, v70
    v_sub_f32 v153, 0, v70
    v_sub_f32 v154, 0, v70
    v_sub_f32 v155, 0, v70
    v_mov_b32 v92, v71
    s_nop 1
    v_permlane32_swap_b32 v71, v92
    v_max_f32 v71, v71, v92
    v_mov_b32 v92, v71
    s_nop 1
    v_permlane16_swap_b32 v71, v92
    v_max_f32 v71, v71, v92
    v_sub_f32 v156, 0, v71
    v_sub_f32 v157, 0, v71
    v_sub_f32 v158, 0, v71
    v_sub_f32 v159, 0, v71
    v_accvgpr_write_b32 a0, 0
    v_accvgpr_write_b32 a1, 0
    v_accvgpr_write_b32 a2, 0
    v_accvgpr_write_b32 a3, 0
    v_accvgpr_write_b32 a4, 0
    v_accvgpr_write_b32 a5, 0
    v_accvgpr_write_b32 a6, 0
    v_accvgpr_write_b32 a7, 0
    v_accvgpr_write_b32 a8, 0
    v_accvgpr_write_b32 a9, 0
    v_accvgpr_write_b32 a10, 0
    v_accvgpr_write_b32 a11, 0
    v_accvgpr_write_b32 a12, 0
    v_accvgpr_write_b32 a13, 0
    v_accvgpr_write_b32 a14, 0
    v_accvgpr_write_b32 a15, 0
    v_accvgpr_write_b32 a16, 0
    v_accvgpr_write_b32 a17, 0
    v_accvgpr_write_b32 a18, 0
    v_accvgpr_write_b32 a19, 0
    v_accvgpr_write_b32 a20, 0
    v_accvgpr_write_b32 a21, 0
    v_accvgpr_write_b32 a22, 0
    v_accvgpr_write_b32 a23, 0
    v_accvgpr_write_b32 a24, 0
    v_accvgpr_write_b32 a25, 0
    v_accvgpr_write_b32 a26, 0
    v_accvgpr_write_b32 a27, 0
    v_accvgpr_write_b32 a28, 0
    v_accvgpr_write_b32 a29, 0
    v_accvgpr_write_b32 a30, 0
    v_accvgpr_write_b32 a31, 0
    v_accvgpr_write_b32 a32, 0
    v_accvgpr_write_b32 a33, 0
    v_accvgpr_write_b32 a34, 0
    v_accvgpr_write_b32 a35, 0
    v_accvgpr_write_b32 a36, 0
    v_accvgpr_write_b32 a37, 0
    v_accvgpr_write_b32 a38, 0
    v_accvgpr_write_b32 a39, 0
    v_accvgpr_write_b32 a40, 0
    v_accvgpr_write_b32 a41, 0
    v_accvgpr_write_b32 a42, 0
    v_accvgpr_write_b32 a43, 0
    v_accvgpr_write_b32 a44, 0
    v_accvgpr_write_b32 a45, 0
    v_accvgpr_write_b32 a46, 0
    v_accvgpr_write_b32 a47, 0
    v_accvgpr_write_b32 a48, 0
    v_accvgpr_write_b32 a49, 0
    v_accvgpr_write_b32 a50, 0
    v_accvgpr_write_b32 a51, 0
    v_accvgpr_write_b32 a52, 0
    v_accvgpr_write_b32 a53, 0
    v_accvgpr_write_b32 a54, 0
    v_accvgpr_write_b32 a55, 0
    v_accvgpr_write_b32 a56, 0
    v_accvgpr_write_b32 a57, 0
    v_accvgpr_write_b32 a58, 0
    v_accvgpr_write_b32 a59, 0
    v_accvgpr_write_b32 a60, 0
    v_accvgpr_write_b32 a61, 0
    v_accvgpr_write_b32 a62, 0
    v_accvgpr_write_b32 a63, 0
    v_accvgpr_write_b32 a144, 0
    v_accvgpr_write_b32 a145, 0
    v_accvgpr_write_b32 a146, 0
    v_accvgpr_write_b32 a147, 0
    v_accvgpr_write_b32 a148, 0
    v_accvgpr_write_b32 a149, 0
    v_accvgpr_write_b32 a150, 0
    v_accvgpr_write_b32 a151, 0
    v_accvgpr_write_b32 a152, 0
    v_accvgpr_write_b32 a153, 0
    v_accvgpr_write_b32 a154, 0
    v_accvgpr_write_b32 a155, 0
    v_accvgpr_write_b32 a156, 0
    v_accvgpr_write_b32 a157, 0
    v_accvgpr_write_b32 a158, 0
    v_accvgpr_write_b32 a159, 0
    v_accvgpr_write_b32 a160, 0
    v_accvgpr_write_b32 a161, 0
    v_accvgpr_write_b32 a162, 0
    v_accvgpr_write_b32 a163, 0
    v_accvgpr_write_b32 a164, 0
    v_accvgpr_write_b32 a165, 0
    v_accvgpr_write_b32 a166, 0
    v_accvgpr_write_b32 a167, 0
    v_accvgpr_write_b32 a168, 0
    v_accvgpr_write_b32 a169, 0
    v_accvgpr_write_b32 a170, 0
    v_accvgpr_write_b32 a171, 0
    v_accvgpr_write_b32 a172, 0
    v_accvgpr_write_b32 a173, 0
    v_accvgpr_write_b32 a174, 0
    v_accvgpr_write_b32 a175, 0
    v_accvgpr_write_b32 a176, 0
    v_accvgpr_write_b32 a177, 0
    v_accvgpr_write_b32 a178, 0
    v_accvgpr_write_b32 a179, 0
    v_accvgpr_write_b32 a180, 0
    v_accvgpr_write_b32 a181, 0
    v_accvgpr_write_b32 a182, 0
    v_accvgpr_write_b32 a183, 0
    v_accvgpr_write_b32 a184, 0
    v_accvgpr_write_b32 a185, 0
    v_accvgpr_write_b32 a186, 0
    v_accvgpr_write_b32 a187, 0
    v_accvgpr_write_b32 a188, 0
    v_accvgpr_write_b32 a189, 0
    v_accvgpr_write_b32 a190, 0
    v_accvgpr_write_b32 a191, 0
    v_accvgpr_write_b32 a192, 0
    v_accvgpr_write_b32 a193, 0
    v_accvgpr_write_b32 a194, 0
    v_accvgpr_write_b32 a195, 0
    v_accvgpr_write_b32 a196, 0
    v_accvgpr_write_b32 a197, 0
    v_accvgpr_write_b32 a198, 0
    v_accvgpr_write_b32 a199, 0
    v_accvgpr_write_b32 a200, 0
    v_accvgpr_write_b32 a201, 0
    v_accvgpr_write_b32 a202, 0
    v_accvgpr_write_b32 a203, 0
    v_accvgpr_write_b32 a204, 0
    v_accvgpr_write_b32 a205, 0
    v_accvgpr_write_b32 a206, 0
    v_accvgpr_write_b32 a207, 0
    v_accvgpr_write_b32 a208, 0
    v_accvgpr_write_b32 a209, 0
    v_accvgpr_write_b32 a210, 0
    v_accvgpr_write_b32 a211, 0
    v_accvgpr_write_b32 a212, 0
    v_accvgpr_write_b32 a213, 0
    v_accvgpr_write_b32 a214, 0
    v_accvgpr_write_b32 a215, 0
    v_accvgpr_write_b32 a216, 0
    v_accvgpr_write_b32 a217, 0
    v_accvgpr_write_b32 a218, 0
    v_accvgpr_write_b32 a219, 0
    v_accvgpr_write_b32 a220, 0
    v_accvgpr_write_b32 a221, 0
    v_accvgpr_write_b32 a222, 0
    v_accvgpr_write_b32 a223, 0
    v_bfe_u32 v92, v1, 4, 2
    v_cmp_eq_u32 vcc, 0, v92
    v_mov_b32 v92, 0x3f803f80
    s_nop 0
    v_cndmask_b32 v92, 0, v92, vcc
    v_accvgpr_write_b32 a136, v92
    v_accvgpr_write_b32 a137, v92
    v_accvgpr_write_b32 a138, v92
    v_accvgpr_write_b32 a139, v92
    s_mov_b32 s77, s75
    s_mov_b32 s76, 0
    s_mov_b32 s38, 16384
    s_add_u32 m0, s76, s75
    s_nop 0
    buffer_load_dwordx4 v1, s[36:39], s77 offen sc1 lds
    buffer_load_dwordx4 v1, s[36:39], s77 offen offset:1024 sc1 lds
    buffer_load_dwordx4 v1, s[36:39], s77 offen offset:2048 sc1 lds
    buffer_load_dwordx4 v1, s[36:39], s77 offen offset:3072 sc1 lds
    s_add_u32 s100, s77, 4096
    s_add_u32 m0, m0, 4096
    s_nop 0
    buffer_load_dwordx4 v1, s[36:39], s100 offen sc1 lds
    buffer_load_dwordx4 v1, s[36:39], s100 offen offset:1024 sc1 lds
    buffer_load_dwordx4 v1, s[36:39], s100 offen offset:2048 sc1 lds
    buffer_load_dwordx4 v1, s[36:39], s100 offen offset:3072 sc1 lds
    s_add_u32 s77, s77, 32768
    s_add_u32 s76, s76, 32768
    s_lshr_b32 s82, s4, 1
    s_add_u32 s82, s82, 32
    s_sub_u32 s82, s82, s6
    s_sub_u32 s82, s82, s6
    s_lshl_b32 s38, s82, 15
    s_add_u32 m0, s76, s75
    s_nop 0
    buffer_load_dwordx4 v1, s[36:39], s77 offen sc1 lds
    buffer_load_dwordx4 v1, s[36:39], s77 offen offset:1024 sc1 lds
    buffer_load_dwordx4 v1, s[36:39], s77 offen offset:2048 sc1 lds
    buffer_load_dwordx4 v1, s[36:39], s77 offen offset:3072 sc1 lds
    s_add_u32 s100, s77, 4096
    s_add_u32 m0, m0, 4096
    s_nop 0
    buffer_load_dwordx4 v1, s[36:39], s100 offen sc1 lds
    buffer_load_dwordx4 v1, s[36:39], s100 offen offset:1024 sc1 lds
    buffer_load_dwordx4 v1, s[36:39], s100 offen offset:2048 sc1 lds
    buffer_load_dwordx4 v1, s[36:39], s100 offen offset:3072 sc1 lds
    s_add_u32 s77, s77, 32768
    s_add_u32 s76, s76, 32768
    s_add_u32 m0, s76, s75
    s_nop 0
    buffer_load_dwordx4 v1, s[36:39], s77 offen sc1 lds
    buffer_load_dwordx4 v1, s[36:39], s77 offen offset:1024 sc1 lds
    buffer_load_dwordx4 v1, s[36:39], s77 offen offset:2048 sc1 lds
    buffer_load_dwordx4 v1, s[36:39], s77 offen offset:3072 sc1 lds
    s_add_u32 s100, s77, 4096
    s_add_u32 m0, m0, 4096
    s_nop 0
    buffer_load_dwordx4 v1, s[36:39], s100 offen sc1 lds
    buffer_load_dwordx4 v1, s[36:39], s100 offen offset:1024 sc1 lds
    buffer_load_dwordx4 v1, s[36:39], s100 offen offset:2048 sc1 lds
    buffer_load_dwordx4 v1, s[36:39], s100 offen offset:3072 sc1 lds
    s_add_u32 s77, s77, 32768
    s_add_u32 s76, s76, 32768
    s_mov_b32 s82, 0
    s_mov_b32 s60, 131072
    v_mov_b32 v2, v1
    s_cmp_eq_u32 s6, 0
    s_cselect_b32 s16, s8, 0
    s_cselect_b32 s17, s9, 0
    s_cmp_eq_u32 s6, 0
    s_cselect_b32 s18, s10, 0
    s_cselect_b32 s19, s11, 0
    s_cmp_eq_u32 s6, 0
    s_cselect_b32 s20, s12, 0
    s_cselect_b32 s21, s13, 0
    s_cmp_eq_u32 s6, 0
    s_cselect_b32 s22, s14, 0
    s_cselect_b32 s23, s15, 0
    s_waitcnt vmcnt(16)
    s_barrier
    ds_read_b128 a[224:227], v2 offset:0
    ds_read_b128 a[228:231], v2 offset:1024
    ds_read_b128 a[232:235], v2 offset:2048
    ds_read_b128 a[236:239], v2 offset:3072
    s_waitcnt lgkmcnt(0)
    s_branch K1_ATT
SPIN_WA:
    s_mov_b32 s94, 0
SPIN_WA_L:
    s_sleep 2
    buffer_load_dword v7, v9, s[44:47], s69 offen sc1
    s_add_u32 s94, s94, 1
    s_cmp_ge_u32 s94, 0x40000
    s_waitcnt vmcnt(0)
    s_cbranch_scc1 BACK_WA
    v_cmp_gt_u32 vcc, 8, v7
    s_nop 1
    s_and_b64 vcc, vcc, s[86:87]
    s_cbranch_scc1 SPIN_WA_L
    s_branch BACK_WA
SPIN_KV:
    s_mov_b32 s94, 0
SPIN_KV_L:
    s_sleep 2
    buffer_load_dword v7, v8, s[32:35], s61 offen sc1
    s_add_u32 s94, s94, 1
    s_cmp_ge_u32 s94, 0x40000
    s_waitcnt vmcnt(0)
    s_cbranch_scc1 BACK_KV
    v_cmp_gt_u32 vcc, 1, v7
    s_nop 1
    s_and_b64 vcc, vcc, exec
    s_cbranch_scc1 SPIN_KV_L
    s_branch BACK_KV
SPIN_CTX:
    s_mov_b32 s94, 0
SPIN_CTX_L:
    s_sleep 2
    buffer_load_dword v3, v19, s[32:35], s66 offen sc1
    s_add_u32 s94, s94, 1
    s_cmp_ge_u32 s94, 0x40000
    s_waitcnt vmcnt(0)
    s_cbranch_scc1 BACK_CTX
    v_cmp_gt_u32 vcc, 2, v3
    s_nop 1
    s_and_b64 vcc, vcc, exec
    s_cbranch_scc1 SPIN_CTX_L
    s_branch BACK_CTX
SPIN_ALL:
    s_mov_b32 s94, 0
SPIN_ALL_L:
    s_sleep 2
    buffer_load_dword v28, v29, s[32:35], s92 offen sc1
    s_add_u32 s94, s94, 1
    s_cmp_ge_u32 s94, 0x40000
    s_waitcnt vmcnt(0)
    s_cbranch_scc1 BACK_ALL
    v_cmp_gt_u32 vcc, 1, v28
    s_nop 1
    s_and_b64 vcc, vcc, exec
    s_cbranch_scc1 SPIN_ALL_L
    s_branch BACK_ALL
SPIN_OA:
    s_mov_b32 s94, 0
SPIN_OA_L:
    s_sleep 2
    buffer_load_dword v3, v19, s[32:35], s66 offen sc1
    s_add_u32 s94, s94, 1
    s_cmp_ge_u32 s94, 0x40000
    s_waitcnt vmcnt(0)
    s_cbranch_scc1 BACK_OA
    v_cmp_gt_u32 vcc, 3, v3
    s_nop 1
    s_and_b64 vcc, vcc, exec
    s_cbranch_scc1 SPIN_OA_L
    s_branch BACK_OA
SPIN_X:
    s_mov_b32 s94, 0
SPIN_X_L:
    s_sleep 2
    buffer_load_dword v3, v19, s[32:35], s66 offen sc1
    s_add_u32 s94, s94, 1
    s_cmp_ge_u32 s94, 0x40000
    s_waitcnt vmcnt(0)
    s_cbranch_scc1 BACK_X
    v_cmp_gt_u32 vcc, 2, v3
    s_nop 1
    s_and_b64 vcc, vcc, exec
    s_cbranch_scc1 SPIN_X_L
    s_branch BACK_X
SPIN_W0:
    s_mov_b32 s94, 0
SPIN_W0_L:
    s_sleep 2
    buffer_load_dword v3, v29, s[32:35], s92 offen sc1
    s_add_u32 s94, s94, 1
    s_cmp_ge_u32 s94, 0x40000
    s_waitcnt vmcnt(0)
    s_cbranch_scc1 BACK_W0
    v_cmp_gt_u32 vcc, 1, v3
    s_nop 1
    s_cmp_lg_u32 vcc_lo, 0
    s_cbranch_scc1 SPIN_W0_L
    s_branch BACK_W0
SPIN_W7:
    s_mov_b32 s94, 0
SPIN_W7_L:
    s_sleep 2
    buffer_load_dword v3, v29, s[32:35], s92 offen sc1
    s_add_u32 s94, s94, 1
    s_cmp_ge_u32 s94, 0x40000
    s_waitcnt vmcnt(0)
    s_cbranch_scc1 BACK_W7
    v_cmp_gt_u32 vcc, 1, v3
    s_nop 1
    s_cmp_lg_u32 vcc_lo, 0
    s_cbranch_scc1 SPIN_W7_L
    s_branch BACK_W7
.section .rodata,"a"
.p2align 6
.amdhsa_kernel gated_mix__sliding_local_dilated__compressed_kv_cla__prompt_kernel
.amdhsa_next_free_vgpr 512
.amdhsa_next_free_sgpr 102
.amdhsa_accum_offset 256
.amdhsa_group_segment_fixed_size 0
.amdhsa_kernarg_size 104
.amdhsa_user_sgpr_count 2
.amdhsa_user_sgpr_kernarg_segment_ptr 1
.amdhsa_system_sgpr_workgroup_id_x 1
.amdhsa_ieee_mode 0
.amdhsa_dx10_clamp 0
.end_amdhsa_kernel
```

```asm
; @launch grid=(256,1,1) block=(256,1,1) lds=163840
.amdgcn_target "amdgcn-amd-amdhsa--gfx950"
.text
.globl gated_mix__sliding_local_dilated__compressed_kv_cla__prompt_kernel
.p2align 8
.type gated_mix__sliding_local_dilated__compressed_kv_cla__prompt_kernel,@function
gated_mix__sliding_local_dilated__compressed_kv_cla__prompt_kernel:
    s_cmp_ge_u32 s2, 256
    s_cbranch_scc1 K1_END
    s_getpc_b64 s[94:95]
    s_load_dwordx8 s[36:43], s[0:1], 32
    v_min_u32 v74, 16, v0
    s_lshr_b32 s7, s2, 3
    s_mul_i32 s7, s7, 17
    v_add_lshl_u32 v74, v74, s7, 7
    global_load_dword v76, v74, s[94:95]
    v_lshrrev_b32 v64, 6, v0
    v_and_b32 v31, 63, v0
    v_readfirstlane_b32 s4, v64
    s_and_b32 s5, s2, 7
    s_lshl_b32 s5, s5, 2
    s_bfe_u32 s7, s2, 0x20003
    s_add_u32 s5, s5, s7
    s_lshr_b32 s6, s2, 5
    s_lshl_b32 s69, s4, 12
    s_mov_b32 s10, 2097152
    s_mov_b32 s11, 0x20000
    s_mov_b32 s14, 4194304
    s_mov_b32 s15, 0x20000
    s_mov_b32 s18, 4194304
    s_mov_b32 s19, 0x20000
    v_lshrrev_b32 v65, 3, v31
    v_and_b32 v66, 7, v31
    v_lshrrev_b32 v67, 1, v65
    v_xor_b32 v66, v66, v67
    v_lshlrev_b32 v66, 4, v66
    v_xor_b32 v67, 64, v66
    s_lshr_b32 s7, s4, 1
    s_lshl_b32 s73, s7, 7
    s_and_b32 s100, s4, 1
    s_lshl_b32 s98, s100, 5
    s_add_u32 s98, s98, s73
    v_add_lshl_u32 v68, v65, s98, 10
    v_add_u32 v6, v68, v66
    v_add_u32 v7, v68, v67
    v_add_u32 v7, 7168, v7
    v_add_u32 v8, v68, v66
    v_add_u32 v8, 14336, v8
    v_add_u32 v9, v68, v67
    v_add_u32 v9, 21504, v9
    v_lshrrev_b32 v69, 4, v31
    v_and_b32 v70, 15, v31
    v_lshlrev_b32 v71, 1, v69
    v_xor_b32 v71, v71, v70
    v_lshlrev_b32 v71, 4, v71
    v_xor_b32 v72, 128, v71
    s_lshl_b32 s98, s4, 4
    v_add_lshl_u32 v73, v69, s98, 13
    v_add_u32 v2, v73, v71
    v_add_u32 v3, v73, v71
    v_add_u32 v3, 31744, v3
    v_add_u32 v4, v73, v72
    v_add_u32 v4, 63488, v4
    v_add_u32 v5, v73, v72
    v_add_u32 v5, 95232, v5
    s_and_b32 s3, s2, 0
    s_lshl_b32 s66, s3, 7
    s_lshl_b32 s60, s3, 11
    s_add_u32 s60, s60, s5
    s_lshl_b32 s60, s60, 8
    s_lshl_b32 s61, s6, 18
    s_add_u32 s61, s61, s66
    s_add_u32 s62, s61, 65536
    s_waitcnt lgkmcnt(0)
    s_mov_b64 s[8:9], s[36:37]
    s_mov_b64 s[24:25], s[38:39]
    s_mov_b64 s[12:13], s[40:41]
    s_mov_b64 s[16:17], s[42:43]
    s_load_dwordx2 s[20:21], s[0:1], 0
    s_load_dwordx2 s[28:29], s[0:1], 8
    s_load_dwordx2 s[32:33], s[0:1], 72
    s_load_dwordx2 s[48:49], s[0:1], 64
    s_load_dwordx2 s[92:93], s[0:1], 16
    s_load_dwordx2 s[44:45], s[0:1], 88
    s_load_dwordx2 s[56:57], s[0:1], 96
    s_load_dwordx2 s[0:1], s[0:1], 80
    s_add_u32 m0, s69, 0
    s_nop 0
    buffer_load_dwordx4 v6, s[8:11], s61 offen lds
    buffer_load_dwordx4 v7, s[8:11], s61 offen offset:1024 lds
    buffer_load_dwordx4 v8, s[8:11], s61 offen offset:2048 lds
    buffer_load_dwordx4 v9, s[8:11], s61 offen offset:3072 lds
    s_xor_b32 s61, s61, 128
    s_add_u32 m0, s69, 16384
    s_nop 0
    buffer_load_dwordx4 v6, s[8:11], s62 offen lds
    buffer_load_dwordx4 v7, s[8:11], s62 offen offset:1024 lds
    buffer_load_dwordx4 v8, s[8:11], s62 offen offset:2048 lds
    buffer_load_dwordx4 v9, s[8:11], s62 offen offset:3072 lds
    s_xor_b32 s62, s62, 128
    s_add_u32 m0, s69, 32768
    s_nop 0
    buffer_load_dwordx4 v2, s[12:15], s60 offen nt lds
    buffer_load_dwordx4 v3, s[12:15], s60 offen offset:1024 nt lds
    buffer_load_dwordx4 v4, s[12:15], s60 offen offset:2048 nt lds
    buffer_load_dwordx4 v5, s[12:15], s60 offen offset:3072 nt lds
    s_add_u32 m0, s69, 49152
    s_nop 0
    buffer_load_dwordx4 v6, s[8:11], s61 offen lds
    buffer_load_dwordx4 v7, s[8:11], s61 offen offset:1024 lds
    buffer_load_dwordx4 v8, s[8:11], s61 offen offset:2048 lds
    buffer_load_dwordx4 v9, s[8:11], s61 offen offset:3072 lds
    s_xor_b32 s61, s61, 384
    v_min_u32 v74, 15, v31
    s_lshl2_add_u32 s98, s2, s4
    s_lshl_b32 s98, s98, 11
    v_lshlrev_b32 v74, 7, v74
    buffer_load_dword v117, v74, s[8:11], s98 offen
    s_waitcnt lgkmcnt(0)
    s_mov_b32 s22, 2359296
    s_mov_b32 s23, 0x20000
    s_mov_b32 s26, 4718592
    s_mov_b32 s27, 0x20000
    s_mov_b32 s50, 4718592
    s_mov_b32 s51, 0x20000
    s_mov_b32 s46, 256
    s_mov_b32 s47, 0x20000
    s_mov_b32 s30, 1990656
    s_mov_b32 s31, 0x20000
    s_mov_b32 s34, 1152
    s_mov_b32 s35, 0x20000
    s_mul_i32 s7, s5, 1081344
    s_add_u32 s36, s56, s7
    s_addc_u32 s37, s57, 0
    s_mov_b32 s38, 1081344
    s_mov_b32 s39, 0x20000
    s_cmp_eq_u32 s4, 0
    s_cselect_b32 s86, 0x55555555, 0
    s_cselect_b32 s87, 0x55555555, 0
    s_cselect_b32 s52, s48, s92
    s_cselect_b32 s53, s49, s93
    s_cselect_b32 s54, s50, 663552
    s_mov_b32 s55, 0x20000
    s_mul_i32 s63, s6, 147456
    s_sub_u32 s64, 2211840, s63
    s_add_u32 s63, s63, s66
    s_add_u32 s64, s64, s66
    s_lshl_b32 s67, s4, 11
    s_lshl_b32 s68, s4, 10
    s_lshl_b32 s75, s4, 13
    s_lshl_b32 s65, s3, 13
    s_add_u32 s65, s65, s67
    s_lshl_b32 s70, s6, 2
    s_lshl1_add_u32 s70, s100, s70
    s_lshl_b32 s70, s70, 15
    s_lshl_b32 s98, s73, 6
    s_add_u32 s71, s70, s98
    s_add_u32 s71, s71, 49152
    s_lshl_b32 s98, s73, 4
    s_add_u32 s70, s70, s98
    v_lshlrev_b32 v1, 4, v31
    v_mov_b32 v77, 1073741824
    v_cmp_eq_u32 vcc, 0, v0
    s_nop 1
    v_cndmask_b32_e64 v30, v77, 0, vcc
    v_lshlrev_b32 v103, 7, v31
    v_cmp_gt_u32 vcc, 9, v31
    s_nop 1
    v_cndmask_b32 v103, v77, v103, vcc
    s_lshl_b32 s98, s4, 5
    v_add_u32 v68, s98, v65
    v_mul_u32_u24 v68, 1152, v68
    v_add_u32 v10, v68, v66
    v_add_u32 v11, v68, v67
    v_add_u32 v11, 8192, v11
    v_add_u32 v12, v68, v66
    v_add_u32 v12, 16384, v12
    v_add_u32 v13, v68, v67
    v_add_u32 v13, 24576, v13
    s_sub_u32 s98, 15, s6
    s_cmp_eq_u32 s73, 0
    s_cselect_b32 s98, s6, s98
    s_lshl_b32 s98, s98, 7
    s_sub_u32 s98, s98, 16
    s_max_i32 s98, s98, 0
    s_lshl3_add_u32 s98, s100, s98
    v_add_u32 v68, s98, v65
    v_mul_u32_u24 v68, 1152, v68
    s_lshl_b32 s98, s100, 6
    v_xor_b32 v73, s98, v66
    v_add_u32 v96, v68, v73
    s_add_u32 m0, s69, 65536
    s_nop 0
    buffer_load_dwordx4 v2, s[16:19], s60 offen nt lds
    v_lshrrev_b32 v71, 1, v70
    v_xor_b32 v71, v71, v69
    v_lshlrev_b32 v71, 4, v71
    v_lshl_add_u32 v71, v70, 7, v71
    v_xor_b32 v72, 64, v71
    s_lshl_b32 s98, s100, 13
    v_add_u32 v22, s98, v71
    v_add_u32 v23, s98, v72
    v_add_u32 v24, s67, v71
    v_add_u32 v25, s67, v72
    s_lshl_b32 s98, s100, 11
    s_add_u32 s98, s98, 8192
    v_add_u32 v100, s98, v71
    v_add_u32 v101, s98, v72
    v_bfe_u32 v73, v31, 2, 2
    v_and_b32 v74, 3, v31
    v_lshl_add_u32 v75, v69, 3, v73
    v_and_b32 v78, 1, v69
    buffer_load_dwordx4 v3, s[16:19], s60 offen offset:1024 nt lds
    v_lshl_add_u32 v77, v78, 2, v73
    v_lshlrev_b32 v77, 5, v77
    v_lshl_add_u32 v77, v74, 3, v77
    v_lshl_add_u32 v77, v75, 8, v77
    v_xor_b32 v14, 0, v77
    v_xor_b32 v14, s73, v14
    v_xor_b32 v15, 32, v77
    v_xor_b32 v15, s73, v15
    v_xor_b32 v16, 64, v77
    v_xor_b32 v16, s73, v16
    v_xor_b32 v17, 96, v77
    v_xor_b32 v17, s73, v17
    v_xor_b32 v18, 128, v77
    v_xor_b32 v19, 160, v77
    v_xor_b32 v20, 192, v77
    v_xor_b32 v21, 224, v77
    v_lshrrev_b32 v77, 1, v73
    v_lshl_add_u32 v77, v78, 1, v77
    buffer_load_dwordx4 v4, s[16:19], s60 offen offset:2048 nt lds
    v_lshlrev_b32 v77, 5, v77
    v_lshl_add_u32 v77, v74, 3, v77
    v_lshl_add_u32 v77, v75, 7, v77
    s_lshr_b32 s98, s73, 1
    v_xor_b32 v26, 0, v77
    v_xor_b32 v26, s98, v26
    v_xor_b32 v27, 32, v77
    v_xor_b32 v28, 64, v77
    v_xor_b32 v28, s98, v28
    v_xor_b32 v29, 96, v77
    v_and_b32 v73, 7, v0
    v_lshrrev_b32 v74, 3, v0
    v_lshl_add_u32 v75, v73, 1, 0
    v_mul_u32_u24 v78, 52, v75
    v_lshrrev_b32 v78, 8, v78
    v_mul_u32_u24 v79, 5, v78
    v_sub_u32 v75, v75, v79
    v_add_u32 v78, 1, v78
    buffer_load_dwordx4 v5, s[16:19], s60 offen offset:3072 nt lds
    s_xor_b32 s60, s60, 524288
    v_cmp_le_u32 vcc, 3, v78
    s_nop 1
    v_cndmask_b32_e64 v78, v78, 0, vcc
    v_mul_u32_u24 v78, 1152, v78
    v_lshl_add_u32 v75, v75, 3, v78
    v_mad_u32_u24 v75, v74, 36, v75
    v_lshl_add_u32 v77, v73, 1, 1
    v_mul_u32_u24 v78, 52, v77
    v_lshrrev_b32 v78, 8, v78
    v_mul_u32_u24 v79, 5, v78
    v_sub_u32 v77, v77, v79
    v_add_u32 v78, 1, v78
    v_cmp_le_u32 vcc, 3, v78
    s_nop 1
    v_cndmask_b32_e64 v78, v78, 0, vcc
    v_mul_u32_u24 v78, 1152, v78
    v_lshl_add_u32 v77, v77, 3, v78
    v_mad_u32_u24 v77, v74, 36, v77
    s_mul_i32 s98, s2, 10368
    s_mul_i32 s99, s2, 6
    s_mov_b32 s7, 73728
    v_mul_lo_u32 v95, v74, s7
    v_lshl_add_u32 v95, v73, 4, v95
    v_cmp_eq_u32 s[92:93], 7, v73
    s_add_u32 s56, s56, 56623104
    s_addc_u32 s57, s57, 0
    s_mov_b32 s58, 5603328
    s_mov_b32 s59, 0x20000
    s_lshl_b32 s101, s6, 5
    s_add_u32 s101, s101, s5
    s_lshl_b32 s101, s101, 7
    v_mov_b32 v65, 0
    v_lshrrev_b32 v64, 2, v0
    v_lshlrev_b32 v64, 15, v64
    v_and_b32 v79, 3, v0
    v_lshl_add_u32 v64, v79, 2, v64
    s_mov_b32 s74, 0x3e0293ee
    s_lshl_b32 s95, s5, 3
    s_waitcnt vmcnt(5)
    s_barrier
    ds_read_b128 a[0:3], v22 offset:0
    ds_read_b64_tr_b16 v[40:41], v14 offset:32768
    ds_read_b64_tr_b16 v[42:43], v14 offset:33792
    ds_read_b128 a[4:7], v23 offset:0
    ds_read_b64_tr_b16 v[44:45], v14 offset:40960
    ds_read_b64_tr_b16 v[46:47], v14 offset:41984
    ds_read_b128 a[8:11], v22 offset:2048
    ds_read_b128 a[12:15], v23 offset:2048
    ds_read_b128 a[16:19], v22 offset:4096
    ds_read_b128 a[20:23], v23 offset:4096
    ds_read_b128 a[24:27], v22 offset:6144
    ds_read_b128 a[28:31], v23 offset:6144
    ds_read_b128 a[32:35], v22 offset:16384
    ds_read_b128 a[36:39], v23 offset:16384
    ds_read_b128 a[40:43], v22 offset:18432
    s_waitcnt lgkmcnt(14)
    ds_read_b128 a[44:47], v23 offset:18432
    s_waitcnt lgkmcnt(14)
    ds_read_b128 a[48:51], v22 offset:20480
    s_waitcnt lgkmcnt(14)
    ds_read_b128 a[52:55], v23 offset:20480
    s_waitcnt lgkmcnt(14)
    ds_read_b128 a[56:59], v22 offset:22528
    s_waitcnt lgkmcnt(14)
    ds_read_b128 a[60:63], v23 offset:22528
    v_mfma_f32_16x16x32_bf16 v[128:131], v[40:43], a[0:3], 0
    s_add_u32 m0, s69, 81920
    s_waitcnt lgkmcnt(14)
    ds_read_b64_tr_b16 v[48:49], v15 offset:32768
    s_waitcnt lgkmcnt(14)
    ds_read_b64_tr_b16 v[50:51], v15 offset:33792
    v_mfma_f32_16x16x32_bf16 v[128:131], v[44:47], a[4:7], v[128:131]
    s_mul_i32 s77, s2, 9216
    buffer_load_dwordx4 v6, s[8:11], s62 offen lds
    v_mfma_f32_16x16x32_bf16 v[132:135], v[40:43], a[8:11], 0
    s_mul_i32 s76, s4, 1152
    s_waitcnt lgkmcnt(14)
    ds_read_b128 a[64:67], v22 offset:49152
    s_waitcnt lgkmcnt(14)
    ds_read_b64_tr_b16 v[52:53], v15 offset:40960
    v_mfma_f32_16x16x32_bf16 v[132:135], v[44:47], a[12:15], v[132:135]
    s_add_u32 s77, s77, s76
    s_waitcnt lgkmcnt(14)
    ds_read_b64_tr_b16 v[54:55], v15 offset:41984
    s_waitcnt lgkmcnt(14)
    ds_read_b64_tr_b16 v[56:57], v16 offset:32768
    v_mfma_f32_16x16x32_bf16 v[136:139], v[40:43], a[16:19], 0
    s_mul_i32 s76, s4, 1152
    buffer_load_dwordx4 v7, s[8:11], s62 offen offset:1024 lds
    v_mfma_f32_16x16x32_bf16 v[136:139], v[44:47], a[20:23], v[136:139]
    s_mul_i32 s72, s2, 3
    s_waitcnt lgkmcnt(4)
    ds_read_b64_tr_b16 v[58:59], v16 offset:33792
    ds_read_b64_tr_b16 v[60:61], v16 offset:40960
    v_mfma_f32_16x16x32_bf16 v[140:143], v[40:43], a[24:27], 0
    s_add_u32 s72, s72, 0
    ds_read_b64_tr_b16 v[62:63], v16 offset:41984
    v_add_u32 v14, 0x10000, v14
    v_mfma_f32_16x16x32_bf16 v[140:143], v[44:47], a[28:31], v[140:143]
    s_mul_i32 s7, s5, 73728
    ds_read_b128 a[68:71], v23 offset:49152
    v_add_u32 v15, 0x10000, v15
    v_mfma_f32_16x16x32_bf16 v[144:147], v[40:43], a[32:35], 0
    s_and_b32 s100, s5, 1
    buffer_load_dwordx4 v8, s[8:11], s62 offen offset:2048 lds
    v_mfma_f32_16x16x32_bf16 v[144:147], v[44:47], a[36:39], v[144:147]
    s_mov_b64 s[84:85], 0
    v_add_u32 v16, 0x10000, v16
    v_mov_b32 v31, 1
    v_mfma_f32_16x16x32_bf16 v[148:151], v[40:43], a[40:43], 0
    s_mov_b32 s83, 0
    v_add_u32 v18, 0x10000, v18
    v_add_u32 v19, 0x10000, v19
    v_mfma_f32_16x16x32_bf16 v[148:151], v[44:47], a[44:47], v[148:151]
    v_add_u32 v20, 0x10000, v20
    v_add_u32 v21, 0x10000, v21
    v_mfma_f32_16x16x32_bf16 v[152:155], v[40:43], a[48:51], 0
    buffer_load_dwordx4 v9, s[8:11], s62 offen offset:3072 lds
    v_mfma_f32_16x16x32_bf16 v[152:155], v[44:47], a[52:55], v[152:155]
    ds_read_b128 a[72:75], v22 offset:51200
    v_add_u32 v26, 0x10000, v26
    v_mfma_f32_16x16x32_bf16 v[156:159], v[40:43], a[56:59], 0
    s_add_u32 m0, s69, 98304
    ds_read_b64_tr_b16 v[40:41], v17 offset:32768
    ds_read_b64_tr_b16 v[42:43], v17 offset:33792
    v_mfma_f32_16x16x32_bf16 v[156:159], v[44:47], a[60:63], v[156:159]
    s_xor_b32 s62, s62, 384
    ds_read_b64_tr_b16 v[44:45], v17 offset:40960
    ds_read_b64_tr_b16 v[46:47], v17 offset:41984
    v_mfma_f32_16x16x32_bf16 v[160:163], v[48:51], a[0:3], 0
    s_waitcnt lgkmcnt(5)
    buffer_load_dwordx4 v2, s[12:15], s60 offen nt lds
    v_mfma_f32_16x16x32_bf16 v[160:163], v[52:55], a[4:7], v[160:163]
    v_add_u32 v17, 0x10000, v17
    v_add_u32 v27, 0x10000, v27
    v_mfma_f32_16x16x32_bf16 v[164:167], v[48:51], a[8:11], 0
    ds_read_b128 a[76:79], v23 offset:51200
    v_add_u32 v28, 0x10000, v28
    v_mfma_f32_16x16x32_bf16 v[164:167], v[52:55], a[12:15], v[164:167]
    v_add_u32 v29, 0x10000, v29
    v_bfe_u32 v37, v1, 4, 4
    v_mfma_f32_16x16x32_bf16 v[168:171], v[48:51], a[16:19], 0
    buffer_load_dwordx4 v3, s[12:15], s60 offen offset:1024 nt lds
    v_mfma_f32_16x16x32_bf16 v[168:171], v[52:55], a[20:23], v[168:171]
    v_mul_u32_u24 v36, 1152, v37
    v_lshrrev_b32 v38, 8, v1
    v_mfma_f32_16x16x32_bf16 v[172:175], v[48:51], a[24:27], 0
    v_lshl_add_u32 v36, v38, 4, v36
    v_lshrrev_b32 v39, 3, v37
    v_mfma_f32_16x16x32_bf16 v[172:175], v[52:55], a[28:31], v[172:175]
    v_mul_u32_u24 v39, 9152, v39
    v_mfma_f32_16x16x32_bf16 v[176:179], v[48:51], a[32:35], 0
    buffer_load_dwordx4 v4, s[12:15], s60 offen offset:2048 nt lds
    v_mfma_f32_16x16x32_bf16 v[176:179], v[52:55], a[36:39], v[176:179]
    ds_read_b128 a[80:83], v22 offset:53248
    v_mfma_f32_16x16x32_bf16 v[180:183], v[48:51], a[40:43], 0
    v_mfma_f32_16x16x32_bf16 v[180:183], v[52:55], a[44:47], v[180:183]
    v_mfma_f32_16x16x32_bf16 v[184:187], v[48:51], a[48:51], 0
    buffer_load_dwordx4 v5, s[12:15], s60 offen offset:3072 nt lds
    v_mfma_f32_16x16x32_bf16 v[184:187], v[52:55], a[52:55], v[184:187]
    ds_read_b128 a[84:87], v23 offset:53248
    v_mfma_f32_16x16x32_bf16 v[188:191], v[48:51], a[56:59], 0
    s_add_u32 m0, s69, 114688
    v_mfma_f32_16x16x32_bf16 v[188:191], v[52:55], a[60:63], v[188:191]
    v_mfma_f32_16x16x32_bf16 v[192:195], v[56:59], a[0:3], 0
    buffer_load_dwordx4 v6, s[8:11], s61 offen lds
    v_mfma_f32_16x16x32_bf16 v[192:195], v[60:63], a[4:7], v[192:195]
    v_mfma_f32_16x16x32_bf16 v[196:199], v[56:59], a[8:11], 0
    v_mfma_f32_16x16x32_bf16 v[196:199], v[60:63], a[12:15], v[196:199]
    ds_read_b128 a[88:91], v22 offset:55296
    v_mfma_f32_16x16x32_bf16 v[200:203], v[56:59], a[16:19], 0
    buffer_load_dwordx4 v7, s[8:11], s61 offen offset:1024 lds
    v_mfma_f32_16x16x32_bf16 v[200:203], v[60:63], a[20:23], v[200:203]
    v_mfma_f32_16x16x32_bf16 v[204:207], v[56:59], a[24:27], 0
    v_mfma_f32_16x16x32_bf16 v[204:207], v[60:63], a[28:31], v[204:207]
    v_mfma_f32_16x16x32_bf16 v[208:211], v[56:59], a[32:35], 0
    buffer_load_dwordx4 v8, s[8:11], s61 offen offset:2048 lds
    v_mfma_f32_16x16x32_bf16 v[208:211], v[60:63], a[36:39], v[208:211]
    ds_read_b128 a[92:95], v23 offset:55296
    v_mfma_f32_16x16x32_bf16 v[212:215], v[56:59], a[40:43], 0
    v_mfma_f32_16x16x32_bf16 v[212:215], v[60:63], a[44:47], v[212:215]
    v_mfma_f32_16x16x32_bf16 v[216:219], v[56:59], a[48:51], 0
    buffer_load_dwordx4 v9, s[8:11], s61 offen offset:3072 lds
    v_mfma_f32_16x16x32_bf16 v[216:219], v[60:63], a[52:55], v[216:219]
    v_mfma_f32_16x16x32_bf16 v[220:223], v[56:59], a[56:59], 0
    s_xor_b32 s61, s61, 128
    v_mfma_f32_16x16x32_bf16 v[220:223], v[60:63], a[60:63], v[220:223]
    s_add_u32 m0, s69, 131072
    s_waitcnt lgkmcnt(0)
    v_mfma_f32_16x16x32_bf16 v[224:227], v[40:43], a[0:3], 0
    buffer_load_dwordx4 v2, s[16:19], s60 offen nt lds
    v_mfma_f32_16x16x32_bf16 v[224:227], v[44:47], a[4:7], v[224:227]
    v_mfma_f32_16x16x32_bf16 v[228:231], v[40:43], a[8:11], 0
    buffer_load_dword v104, v103, s[20:23], s77 offen
    v_mfma_f32_16x16x32_bf16 v[228:231], v[44:47], a[12:15], v[228:231]
    s_add_u32 s77, s77, 4608
    v_mfma_f32_16x16x32_bf16 v[232:235], v[40:43], a[16:19], 0
    v_mfma_f32_16x16x32_bf16 v[232:235], v[44:47], a[20:23], v[232:235]
    s_waitcnt vmcnt(10)
    s_barrier
    ds_read_b64_tr_b16 v[48:49], v14 offset:0
    v_mfma_f32_16x16x32_bf16 v[236:239], v[40:43], a[24:27], 0
    buffer_load_dwordx4 v3, s[16:19], s60 offen offset:1024 nt lds
    v_mfma_f32_16x16x32_bf16 v[236:239], v[44:47], a[28:31], v[236:239]
    ds_read_b64_tr_b16 v[50:51], v14 offset:1024
    ds_read_b64_tr_b16 v[52:53], v14 offset:8192
    v_mfma_f32_16x16x32_bf16 v[240:243], v[40:43], a[32:35], 0
    ds_read_b64_tr_b16 v[54:55], v14 offset:9216
    ds_read_b64_tr_b16 v[56:57], v15 offset:0
    v_mfma_f32_16x16x32_bf16 v[240:243], v[44:47], a[36:39], v[240:243]
    buffer_load_dwordx4 v4, s[16:19], s60 offen offset:2048 nt lds
    v_mfma_f32_16x16x32_bf16 v[244:247], v[40:43], a[40:43], 0
    ds_read_b64_tr_b16 v[58:59], v15 offset:1024
    ds_read_b64_tr_b16 v[60:61], v15 offset:8192
    v_mfma_f32_16x16x32_bf16 v[244:247], v[44:47], a[44:47], v[244:247]
    ds_read_b64_tr_b16 v[62:63], v15 offset:9216
    v_mfma_f32_16x16x32_bf16 v[248:251], v[40:43], a[48:51], 0
    v_mfma_f32_16x16x32_bf16 v[248:251], v[44:47], a[52:55], v[248:251]
    buffer_load_dwordx4 v5, s[16:19], s60 offen offset:3072 nt lds
    v_mfma_f32_16x16x32_bf16 v[252:255], v[40:43], a[56:59], 0
    ds_read_b64_tr_b16 v[40:41], v16 offset:0
    ds_read_b64_tr_b16 v[42:43], v16 offset:1024
    v_mfma_f32_16x16x32_bf16 v[252:255], v[44:47], a[60:63], v[252:255]
    s_waitcnt lgkmcnt(3)
    ds_read_b64_tr_b16 v[44:45], v16 offset:8192
    ds_read_b64_tr_b16 v[46:47], v16 offset:9216
    v_mfma_f32_16x16x32_bf16 a[128:131], a[0:3], v[48:51], 0
    v_mfma_f32_16x16x32_bf16 a[128:131], a[4:7], v[52:55], a[128:131]
    s_add_u32 m0, s69, 147456
    v_add_u32 v22, 0x10000, v22
    v_mfma_f32_16x16x32_bf16 a[132:135], a[8:11], v[48:51], 0
    s_xor_b32 s60, s60, 1572864
    buffer_load_dwordx4 v6, s[8:11], s62 offen lds
    v_mfma_f32_16x16x32_bf16 a[132:135], a[12:15], v[52:55], a[132:135]
    ds_read_b128 a[96:99], v22 offset:16384
    v_mfma_f32_16x16x32_bf16 a[136:139], a[16:19], v[48:51], 0
    v_mfma_f32_16x16x32_bf16 a[136:139], a[20:23], v[52:55], a[136:139]
    v_mfma_f32_16x16x32_bf16 a[140:143], a[24:27], v[48:51], 0
    buffer_load_dwordx4 v7, s[8:11], s62 offen offset:1024 lds
    v_mfma_f32_16x16x32_bf16 a[140:143], a[28:31], v[52:55], a[140:143]
    v_add_u32 v23, 0x10000, v23
    ds_read_b128 a[100:103], v23 offset:16384
    v_mfma_f32_16x16x32_bf16 a[144:147], a[32:35], v[48:51], 0
    v_mfma_f32_16x16x32_bf16 a[144:147], a[36:39], v[52:55], a[144:147]
    v_mfma_f32_16x16x32_bf16 a[148:151], a[40:43], v[48:51], 0
    v_mfma_f32_16x16x32_bf16 a[148:151], a[44:47], v[52:55], a[148:151]
    buffer_load_dwordx4 v8, s[8:11], s62 offen offset:2048 lds
    v_mfma_f32_16x16x32_bf16 a[152:155], a[48:51], v[48:51], 0
    v_mfma_f32_16x16x32_bf16 a[152:155], a[52:55], v[52:55], a[152:155]
    ds_read_b128 a[104:107], v22 offset:18432
    v_mfma_f32_16x16x32_bf16 a[156:159], a[56:59], v[48:51], 0
    ds_read_b64_tr_b16 v[48:49], v17 offset:0
    ds_read_b64_tr_b16 v[50:51], v17 offset:1024
    v_mfma_f32_16x16x32_bf16 a[156:159], a[60:63], v[52:55], a[156:159]
    buffer_load_dwordx4 v9, s[8:11], s62 offen offset:3072 lds
    v_mfma_f32_16x16x32_bf16 a[160:163], a[0:3], v[56:59], 0
    s_waitcnt lgkmcnt(3)
    ds_read_b64_tr_b16 v[52:53], v17 offset:8192
    ds_read_b64_tr_b16 v[54:55], v17 offset:9216
    v_mfma_f32_16x16x32_bf16 a[160:163], a[4:7], v[60:63], a[160:163]
    v_mfma_f32_16x16x32_bf16 a[164:167], a[8:11], v[56:59], 0
    ds_read_b128 a[108:111], v23 offset:18432
    v_mfma_f32_16x16x32_bf16 a[164:167], a[12:15], v[60:63], a[164:167]
    s_add_u32 m0, s69, 0
    v_mfma_f32_16x16x32_bf16 a[168:171], a[16:19], v[56:59], 0
    s_xor_b32 s62, s62, 128
    buffer_load_dwordx4 v2, s[12:15], s60 offen nt lds
    v_mfma_f32_16x16x32_bf16 a[168:171], a[20:23], v[60:63], a[168:171]
    v_mfma_f32_16x16x32_bf16 a[172:175], a[24:27], v[56:59], 0
    v_mfma_f32_16x16x32_bf16 a[172:175], a[28:31], v[60:63], a[172:175]
    v_mfma_f32_16x16x32_bf16 a[176:179], a[32:35], v[56:59], 0
    buffer_load_dwordx4 v3, s[12:15], s60 offen offset:1024 nt lds
    v_mfma_f32_16x16x32_bf16 a[176:179], a[36:39], v[60:63], a[176:179]
    ds_read_b128 a[112:115], v22 offset:20480
    v_mfma_f32_16x16x32_bf16 a[180:183], a[40:43], v[56:59], 0
    v_mfma_f32_16x16x32_bf16 a[180:183], a[44:47], v[60:63], a[180:183]
    v_mfma_f32_16x16x32_bf16 a[184:187], a[48:51], v[56:59], 0
    v_mfma_f32_16x16x32_bf16 a[184:187], a[52:55], v[60:63], a[184:187]
    buffer_load_dwordx4 v4, s[12:15], s60 offen offset:2048 nt lds
    v_mfma_f32_16x16x32_bf16 a[188:191], a[56:59], v[56:59], 0
    ds_read_b128 a[116:119], v23 offset:20480
    v_mfma_f32_16x16x32_bf16 a[188:191], a[60:63], v[60:63], a[188:191]
    v_mfma_f32_16x16x32_bf16 a[192:195], a[0:3], v[40:43], 0
    v_mfma_f32_16x16x32_bf16 a[192:195], a[4:7], v[44:47], a[192:195]
    buffer_load_dwordx4 v5, s[12:15], s60 offen offset:3072 nt lds
    v_mfma_f32_16x16x32_bf16 a[196:199], a[8:11], v[40:43], 0
    v_mfma_f32_16x16x32_bf16 a[196:199], a[12:15], v[44:47], a[196:199]
    ds_read_b128 a[120:123], v22 offset:22528
    v_mfma_f32_16x16x32_bf16 a[200:203], a[16:19], v[40:43], 0
    v_mfma_f32_16x16x32_bf16 a[200:203], a[20:23], v[44:47], a[200:203]
    s_add_u32 m0, s69, 16384
    v_mfma_f32_16x16x32_bf16 a[204:207], a[24:27], v[40:43], 0
    buffer_load_dwordx4 v6, s[8:11], s61 offen lds
    v_mfma_f32_16x16x32_bf16 a[204:207], a[28:31], v[44:47], a[204:207]
    v_mfma_f32_16x16x32_bf16 a[208:211], a[32:35], v[40:43], 0
    ds_read_b128 a[124:127], v23 offset:22528
    v_mfma_f32_16x16x32_bf16 a[208:211], a[36:39], v[44:47], a[208:211]
    v_mfma_f32_16x16x32_bf16 a[212:215], a[40:43], v[40:43], 0
    buffer_load_dwordx4 v7, s[8:11], s61 offen offset:1024 lds
    v_mfma_f32_16x16x32_bf16 a[212:215], a[44:47], v[44:47], a[212:215]
    v_mfma_f32_16x16x32_bf16 a[216:219], a[48:51], v[40:43], 0
    v_mfma_f32_16x16x32_bf16 a[216:219], a[52:55], v[44:47], a[216:219]
    v_mfma_f32_16x16x32_bf16 a[220:223], a[56:59], v[40:43], 0
    v_mfma_f32_16x16x32_bf16 a[220:223], a[60:63], v[44:47], a[220:223]
    s_waitcnt lgkmcnt(0)
    buffer_load_dwordx4 v8, s[8:11], s61 offen offset:2048 lds
    v_mfma_f32_16x16x32_bf16 a[224:227], a[0:3], v[48:51], 0
    v_mfma_f32_16x16x32_bf16 a[224:227], a[4:7], v[52:55], a[224:227]
    v_mfma_f32_16x16x32_bf16 a[228:231], a[8:11], v[48:51], 0
    v_mfma_f32_16x16x32_bf16 a[228:231], a[12:15], v[52:55], a[228:231]
    buffer_load_dwordx4 v9, s[8:11], s61 offen offset:3072 lds
    v_mfma_f32_16x16x32_bf16 a[232:235], a[16:19], v[48:51], 0
    v_mfma_f32_16x16x32_bf16 a[232:235], a[20:23], v[52:55], a[232:235]
    s_waitcnt vmcnt(8) lgkmcnt(0)
    s_barrier
    ds_read_b64_tr_b16 v[56:57], v14 offset:32768
    v_mfma_f32_16x16x32_bf16 a[236:239], a[24:27], v[48:51], 0
    s_add_u32 m0, s69, 32768
    ds_read_b64_tr_b16 v[58:59], v14 offset:33792
    ds_read_b64_tr_b16 v[60:61], v14 offset:40960
    v_mfma_f32_16x16x32_bf16 a[236:239], a[28:31], v[52:55], a[236:239]
    s_xor_b32 s61, s61, 896
    buffer_load_dwordx4 v2, s[16:19], s60 offen nt lds
    v_mfma_f32_16x16x32_bf16 a[240:243], a[32:35], v[48:51], 0
    ds_read_b64_tr_b16 v[62:63], v14 offset:41984
    ds_read_b64_tr_b16 v[40:41], v15 offset:32768
    v_mfma_f32_16x16x32_bf16 a[240:243], a[36:39], v[52:55], a[240:243]
    ds_read_b64_tr_b16 v[42:43], v15 offset:33792
    ds_read_b64_tr_b16 v[44:45], v15 offset:40960
    v_mfma_f32_16x16x32_bf16 a[244:247], a[40:43], v[48:51], 0
    ds_read_b64_tr_b16 v[46:47], v15 offset:41984
    v_add_u32 v14, 0x10000, v14
    v_mfma_f32_16x16x32_bf16 a[244:247], a[44:47], v[52:55], a[244:247]
    v_add_u32 v15, 0x10000, v15
    v_mfma_f32_16x16x32_bf16 a[248:251], a[48:51], v[48:51], 0
    v_mfma_f32_16x16x32_bf16 a[248:251], a[52:55], v[52:55], a[248:251]
    buffer_load_dwordx4 v3, s[16:19], s60 offen offset:1024 nt lds
    v_mfma_f32_16x16x32_bf16 a[252:255], a[56:59], v[48:51], 0
    ds_read_b64_tr_b16 v[48:49], v16 offset:32768
    ds_read_b64_tr_b16 v[50:51], v16 offset:33792
    v_mfma_f32_16x16x32_bf16 a[252:255], a[60:63], v[52:55], a[252:255]
    s_waitcnt lgkmcnt(2)
    ds_read_b64_tr_b16 v[52:53], v16 offset:40960
    ds_read_b64_tr_b16 v[54:55], v16 offset:41984
    v_mfma_f32_16x16x32_bf16 v[128:131], v[56:59], a[64:67], v[128:131]
    v_add_u32 v16, 0x10000, v16
    v_mfma_f32_16x16x32_bf16 v[128:131], v[60:63], a[68:71], v[128:131]
    v_mfma_f32_16x16x32_bf16 v[132:135], v[56:59], a[72:75], v[132:135]
    ds_read_b128 a[0:3], v22 offset:49152
    v_mfma_f32_16x16x32_bf16 v[132:135], v[60:63], a[76:79], v[132:135]
    v_mfma_f32_16x16x32_bf16 v[136:139], v[56:59], a[80:83], v[136:139]
    v_mfma_f32_16x16x32_bf16 v[136:139], v[60:63], a[84:87], v[136:139]
    buffer_load_dwordx4 v4, s[16:19], s60 offen offset:2048 nt lds
    v_mfma_f32_16x16x32_bf16 v[140:143], v[56:59], a[88:91], v[140:143]
    v_mfma_f32_16x16x32_bf16 v[140:143], v[60:63], a[92:95], v[140:143]
    ds_read_b128 a[4:7], v23 offset:49152
    v_mfma_f32_16x16x32_bf16 v[144:147], v[56:59], a[96:99], v[144:147]
    v_mfma_f32_16x16x32_bf16 v[144:147], v[60:63], a[100:103], v[144:147]
    v_mfma_f32_16x16x32_bf16 v[148:151], v[56:59], a[104:107], v[148:151]
    v_mfma_f32_16x16x32_bf16 v[148:151], v[60:63], a[108:111], v[148:151]
    v_mfma_f32_16x16x32_bf16 v[152:155], v[56:59], a[112:115], v[152:155]
    buffer_load_dwordx4 v5, s[16:19], s60 offen offset:3072 nt lds
    v_mfma_f32_16x16x32_bf16 v[152:155], v[60:63], a[116:119], v[152:155]
    ds_read_b128 a[8:11], v22 offset:51200
    v_mfma_f32_16x16x32_bf16 v[156:159], v[56:59], a[120:123], v[156:159]
    ds_read_b64_tr_b16 v[56:57], v17 offset:32768
    ds_read_b64_tr_b16 v[58:59], v17 offset:33792
    v_mfma_f32_16x16x32_bf16 v[156:159], v[60:63], a[124:127], v[156:159]
    ds_read_b64_tr_b16 v[60:61], v17 offset:40960
    ds_read_b64_tr_b16 v[62:63], v17 offset:41984
    v_mfma_f32_16x16x32_bf16 v[160:163], v[40:43], a[64:67], v[160:163]
    v_add_u32 v17, 0x10000, v17
    v_mfma_f32_16x16x32_bf16 v[160:163], v[44:47], a[68:71], v[160:163]
    v_mfma_f32_16x16x32_bf16 v[164:167], v[40:43], a[72:75], v[164:167]
    ds_read_b128 a[12:15], v23 offset:51200
    v_mfma_f32_16x16x32_bf16 v[164:167], v[44:47], a[76:79], v[164:167]
    s_add_u32 m0, s69, 49152
    v_mfma_f32_16x16x32_bf16 v[168:171], v[40:43], a[80:83], v[168:171]
    s_xor_b32 s60, s60, 524288
    buffer_load_dwordx4 v6, s[8:11], s62 offen lds
    v_mfma_f32_16x16x32_bf16 v[168:171], v[44:47], a[84:87], v[168:171]
    v_mfma_f32_16x16x32_bf16 v[172:175], v[40:43], a[88:91], v[172:175]
    v_mfma_f32_16x16x32_bf16 v[172:175], v[44:47], a[92:95], v[172:175]
    v_mfma_f32_16x16x32_bf16 v[176:179], v[40:43], a[96:99], v[176:179]
    ds_read_b128 a[16:19], v22 offset:53248
    v_mfma_f32_16x16x32_bf16 v[176:179], v[44:47], a[100:103], v[176:179]
    v_mfma_f32_16x16x32_bf16 v[180:183], v[40:43], a[104:107], v[180:183]
    v_mfma_f32_16x16x32_bf16 v[180:183], v[44:47], a[108:111], v[180:183]
    buffer_load_dwordx4 v7, s[8:11], s62 offen offset:1024 lds
    v_mfma_f32_16x16x32_bf16 v[184:187], v[40:43], a[112:115], v[184:187]
    v_mfma_f32_16x16x32_bf16 v[184:187], v[44:47], a[116:119], v[184:187]
    ds_read_b128 a[20:23], v23 offset:53248
    v_mfma_f32_16x16x32_bf16 v[188:191], v[40:43], a[120:123], v[188:191]
    s_waitcnt lgkmcnt(1)
    ds_read_b64_tr_b16 v[40:41], v14 offset:0
    ds_read_b64_tr_b16 v[42:43], v14 offset:1024
    v_mfma_f32_16x16x32_bf16 v[188:191], v[44:47], a[124:127], v[188:191]
    ds_read_b64_tr_b16 v[44:45], v14 offset:8192
    ds_read_b64_tr_b16 v[46:47], v14 offset:9216
    v_mfma_f32_16x16x32_bf16 v[192:195], v[48:51], a[64:67], v[192:195]
    v_add_u32 v14, 0xfffe0000, v14
    v_mfma_f32_16x16x32_bf16 v[192:195], v[52:55], a[68:71], v[192:195]
    v_mfma_f32_16x16x32_bf16 v[196:199], v[48:51], a[72:75], v[196:199]
    v_mfma_f32_16x16x32_bf16 v[196:199], v[52:55], a[76:79], v[196:199]
    buffer_load_dwordx4 v8, s[8:11], s62 offen offset:2048 lds
    v_mfma_f32_16x16x32_bf16 v[200:203], v[48:51], a[80:83], v[200:203]
    ds_read_b128 a[24:27], v22 offset:55296
    v_mfma_f32_16x16x32_bf16 v[200:203], v[52:55], a[84:87], v[200:203]
    v_mfma_f32_16x16x32_bf16 v[204:207], v[48:51], a[88:91], v[204:207]
    v_mfma_f32_16x16x32_bf16 v[204:207], v[52:55], a[92:95], v[204:207]
    v_mfma_f32_16x16x32_bf16 v[208:211], v[48:51], a[96:99], v[208:211]
    ds_read_b128 a[28:31], v23 offset:55296
    v_mfma_f32_16x16x32_bf16 v[208:211], v[52:55], a[100:103], v[208:211]
    v_mfma_f32_16x16x32_bf16 v[212:215], v[48:51], a[104:107], v[212:215]
    buffer_load_dwordx4 v9, s[8:11], s62 offen offset:3072 lds
    v_mfma_f32_16x16x32_bf16 v[212:215], v[52:55], a[108:111], v[212:215]
    v_mfma_f32_16x16x32_bf16 v[216:219], v[48:51], a[112:115], v[216:219]
    v_mfma_f32_16x16x32_bf16 v[216:219], v[52:55], a[116:119], v[216:219]
    v_mfma_f32_16x16x32_bf16 v[220:223], v[48:51], a[120:123], v[220:223]
    ds_read_b64_tr_b16 v[48:49], v15 offset:0
    ds_read_b64_tr_b16 v[50:51], v15 offset:1024
    v_mfma_f32_16x16x32_bf16 v[220:223], v[52:55], a[124:127], v[220:223]
    ds_read_b64_tr_b16 v[52:53], v15 offset:8192
    ds_read_b64_tr_b16 v[54:55], v15 offset:9216
    v_mfma_f32_16x16x32_bf16 v[224:227], v[56:59], a[64:67], v[224:227]
    buffer_load_dwordx2 v[80:81], v75, s[28:31], s98 offen nt
    v_mfma_f32_16x16x32_bf16 v[224:227], v[60:63], a[68:71], v[224:227]
    s_xor_b32 s62, s62, 896
    v_add_u32 v15, 0xfffe0000, v15
    v_mfma_f32_16x16x32_bf16 v[228:231], v[56:59], a[72:75], v[228:231]
    buffer_load_dword v105, v103, s[20:23], s77 offen
    v_mfma_f32_16x16x32_bf16 v[228:231], v[60:63], a[76:79], v[228:231]
    s_mul_i32 s77, s2, 18432
    v_mfma_f32_16x16x32_bf16 v[232:235], v[56:59], a[80:83], v[232:235]
    s_add_u32 s77, s77, s76
    buffer_load_dwordx2 v[82:83], v77, s[28:31], s98 offen nt
    v_mfma_f32_16x16x32_bf16 v[232:235], v[60:63], a[84:87], v[232:235]
    s_add_u32 s98, s98, 3456
    v_mfma_f32_16x16x32_bf16 v[236:239], v[56:59], a[88:91], v[236:239]
    s_add_u32 m0, s69, 65536
    v_mfma_f32_16x16x32_bf16 v[236:239], v[60:63], a[92:95], v[236:239]
    s_mov_b32 s76, 0
    v_mfma_f32_16x16x32_bf16 v[240:243], v[56:59], a[96:99], v[240:243]
    buffer_load_ushort v92, v65, s[32:35], s99 offen offset:0
    v_mfma_f32_16x16x32_bf16 v[240:243], v[60:63], a[100:103], v[240:243]
    v_mfma_f32_16x16x32_bf16 v[244:247], v[56:59], a[104:107], v[244:247]
    v_mfma_f32_16x16x32_bf16 v[244:247], v[60:63], a[108:111], v[244:247]
    v_mfma_f32_16x16x32_bf16 v[248:251], v[56:59], a[112:115], v[248:251]
    buffer_load_dwordx2 v[84:85], v75, s[28:31], s98 offen nt
    v_mfma_f32_16x16x32_bf16 v[248:251], v[60:63], a[116:119], v[248:251]
    v_mfma_f32_16x16x32_bf16 v[252:255], v[56:59], a[120:123], v[252:255]
    ds_read_b64_tr_b16 v[56:57], v16 offset:0
    ds_read_b64_tr_b16 v[58:59], v16 offset:1024
    v_mfma_f32_16x16x32_bf16 v[252:255], v[60:63], a[124:127], v[252:255]
    s_waitcnt lgkmcnt(2)
    ds_read_b64_tr_b16 v[60:61], v16 offset:8192
    ds_read_b64_tr_b16 v[62:63], v16 offset:9216
    v_mfma_f32_16x16x32_bf16 a[128:131], a[64:67], v[40:43], a[128:131]
    buffer_load_dwordx4 v2, s[12:15], s60 offen nt lds
    v_mfma_f32_16x16x32_bf16 a[128:131], a[68:71], v[44:47], a[128:131]
    v_add_u32 v22, 0x10000, v22
    v_add_u32 v16, 0xfffe0000, v16
    v_mfma_f32_16x16x32_bf16 a[132:135], a[72:75], v[40:43], a[132:135]
    ds_read_b128 a[32:35], v22 offset:16384
    v_mfma_f32_16x16x32_bf16 a[132:135], a[76:79], v[44:47], a[132:135]
    v_mfma_f32_16x16x32_bf16 a[136:139], a[80:83], v[40:43], a[136:139]
    buffer_load_dwordx2 v[86:87], v77, s[28:31], s98 offen nt
    v_mfma_f32_16x16x32_bf16 a[136:139], a[84:87], v[44:47], a[136:139]
    s_add_u32 s98, s98, 3456
    v_mfma_f32_16x16x32_bf16 a[140:143], a[88:91], v[40:43], a[140:143]
    v_add_u32 v23, 0x10000, v23
    v_mfma_f32_16x16x32_bf16 a[140:143], a[92:95], v[44:47], a[140:143]
    ds_read_b128 a[36:39], v23 offset:16384
    v_mfma_f32_16x16x32_bf16 a[144:147], a[96:99], v[40:43], a[144:147]
    buffer_load_ushort v93, v65, s[32:35], s99 offen offset:2
    v_mfma_f32_16x16x32_bf16 a[144:147], a[100:103], v[44:47], a[144:147]
    v_mfma_f32_16x16x32_bf16 a[148:151], a[104:107], v[40:43], a[148:151]
    v_mfma_f32_16x16x32_bf16 a[148:151], a[108:111], v[44:47], a[148:151]
    v_mfma_f32_16x16x32_bf16 a[152:155], a[112:115], v[40:43], a[152:155]
    buffer_load_dwordx2 v[88:89], v75, s[28:31], s98 offen nt
    v_mfma_f32_16x16x32_bf16 a[152:155], a[116:119], v[44:47], a[152:155]
    ds_read_b128 a[40:43], v22 offset:18432
    v_mfma_f32_16x16x32_bf16 a[156:159], a[120:123], v[40:43], a[156:159]
    ds_read_b64_tr_b16 v[40:41], v17 offset:0
    ds_read_b64_tr_b16 v[42:43], v17 offset:1024
    v_mfma_f32_16x16x32_bf16 a[156:159], a[124:127], v[44:47], a[156:159]
    ds_read_b64_tr_b16 v[44:45], v17 offset:8192
    ds_read_b64_tr_b16 v[46:47], v17 offset:9216
    v_mfma_f32_16x16x32_bf16 a[160:163], a[64:67], v[48:51], a[160:163]
    buffer_load_dwordx4 v3, s[12:15], s60 offen offset:1024 nt lds
    v_mfma_f32_16x16x32_bf16 a[160:163], a[68:71], v[52:55], a[160:163]
    v_add_u32 v17, 0xfffe0000, v17
    v_mfma_f32_16x16x32_bf16 a[164:167], a[72:75], v[48:51], a[164:167]
    ds_read_b128 a[44:47], v23 offset:18432
    v_mfma_f32_16x16x32_bf16 a[164:167], a[76:79], v[52:55], a[164:167]
    v_mfma_f32_16x16x32_bf16 a[168:171], a[80:83], v[48:51], a[168:171]
    buffer_load_dwordx2 v[90:91], v77, s[28:31], s98 offen nt
    v_mfma_f32_16x16x32_bf16 a[168:171], a[84:87], v[52:55], a[168:171]
    s_add_u32 s98, s98, 3456
    s_add_u32 s28, s56, 6291456
    s_addc_u32 s29, s57, 0
    v_mfma_f32_16x16x32_bf16 a[172:175], a[88:91], v[48:51], a[172:175]
    s_mov_b32 s30, 2359296
    v_mfma_f32_16x16x32_bf16 a[172:175], a[92:95], v[52:55], a[172:175]
    s_bfe_u32 s98, s72, 0x10001
    v_mfma_f32_16x16x32_bf16 a[176:179], a[96:99], v[48:51], a[176:179]
    buffer_load_ushort v94, v65, s[32:35], s99 offen offset:4
    v_mfma_f32_16x16x32_bf16 a[176:179], a[100:103], v[52:55], a[176:179]
    s_add_u32 s32, s56, 9437184
    s_addc_u32 s33, s57, 0
    s_mov_b32 s34, 196608
    v_mfma_f32_16x16x32_bf16 a[180:183], a[104:107], v[48:51], a[180:183]
    s_bfe_u32 s99, s72, 0x10003
    ds_read_b128 a[48:51], v22 offset:20480
    v_mfma_f32_16x16x32_bf16 a[180:183], a[108:111], v[52:55], a[180:183]
    s_lshl1_add_u32 s98, s99, s98
    v_mfma_f32_16x16x32_bf16 a[184:187], a[112:115], v[48:51], a[184:187]
    s_lshl_b32 s98, s98, 5
    buffer_store_dword v65, v64, s[32:35], s101 offen sc1
    v_mfma_f32_16x16x32_bf16 a[184:187], a[116:119], v[52:55], a[184:187]
    s_lshl_b32 s72, s72, 7
    ds_read_b128 a[52:55], v23 offset:20480
    v_mfma_f32_16x16x32_bf16 a[188:191], a[120:123], v[48:51], a[188:191]
    v_mfma_f32_16x16x32_bf16 a[188:191], a[124:127], v[52:55], a[188:191]
    s_waitcnt lgkmcnt(1)
    v_mfma_f32_16x16x32_bf16 a[192:195], a[64:67], v[56:59], a[192:195]
    buffer_load_dwordx4 v4, s[12:15], s60 offen offset:2048 nt lds
    v_mfma_f32_16x16x32_bf16 a[192:195], a[68:71], v[60:63], a[192:195]
    v_mfma_f32_16x16x32_bf16 a[196:199], a[72:75], v[56:59], a[196:199]
    v_mfma_f32_16x16x32_bf16 a[196:199], a[76:79], v[60:63], a[196:199]
    ds_read_b128 a[56:59], v22 offset:22528
    v_mfma_f32_16x16x32_bf16 a[200:203], a[80:83], v[56:59], a[200:203]
    buffer_load_dwordx4 v5, s[12:15], s60 offen offset:3072 nt lds
    v_mfma_f32_16x16x32_bf16 a[200:203], a[84:87], v[60:63], a[200:203]
    s_add_u32 m0, s69, 81920
    v_mfma_f32_16x16x32_bf16 a[204:207], a[88:91], v[56:59], a[204:207]
    v_mfma_f32_16x16x32_bf16 a[204:207], a[92:95], v[60:63], a[204:207]
    v_mfma_f32_16x16x32_bf16 a[208:211], a[96:99], v[56:59], a[208:211]
    buffer_load_dwordx4 v6, s[8:11], s61 offen lds
    v_mfma_f32_16x16x32_bf16 a[208:211], a[100:103], v[60:63], a[208:211]
    ds_read_b128 a[60:63], v23 offset:22528
    v_mfma_f32_16x16x32_bf16 a[212:215], a[104:107], v[56:59], a[212:215]
    v_mfma_f32_16x16x32_bf16 a[212:215], a[108:111], v[60:63], a[212:215]
    v_mfma_f32_16x16x32_bf16 a[216:219], a[112:115], v[56:59], a[216:219]
    buffer_load_dwordx4 v7, s[8:11], s61 offen offset:1024 lds
    v_mfma_f32_16x16x32_bf16 a[216:219], a[116:119], v[60:63], a[216:219]
    v_mfma_f32_16x16x32_bf16 a[220:223], a[120:123], v[56:59], a[220:223]
    v_mfma_f32_16x16x32_bf16 a[220:223], a[124:127], v[60:63], a[220:223]
    v_mfma_f32_16x16x32_bf16 a[224:227], a[64:67], v[40:43], a[224:227]
    buffer_load_dwordx4 v8, s[8:11], s61 offen offset:2048 lds
    v_mfma_f32_16x16x32_bf16 a[224:227], a[68:71], v[44:47], a[224:227]
    v_mfma_f32_16x16x32_bf16 a[228:231], a[72:75], v[40:43], a[228:231]
    v_mfma_f32_16x16x32_bf16 a[228:231], a[76:79], v[44:47], a[228:231]
    v_mfma_f32_16x16x32_bf16 a[232:235], a[80:83], v[40:43], a[232:235]
    buffer_load_dwordx4 v9, s[8:11], s61 offen offset:3072 lds
    v_mfma_f32_16x16x32_bf16 a[232:235], a[84:87], v[44:47], a[232:235]
    s_xor_b32 s61, s61, 128
    s_waitcnt vmcnt(19) lgkmcnt(0)
    s_barrier
    v_mfma_f32_16x16x32_bf16 a[236:239], a[88:91], v[40:43], a[236:239]
    s_add_u32 m0, s69, 98304
    ds_read_b64_tr_b16 v[48:49], v14 offset:0
    ds_read_b64_tr_b16 v[50:51], v14 offset:1024
    v_mfma_f32_16x16x32_bf16 a[236:239], a[92:95], v[44:47], a[236:239]
    ds_read_b64_tr_b16 v[52:53], v14 offset:8192
    ds_read_b64_tr_b16 v[54:55], v14 offset:9216
    v_mfma_f32_16x16x32_bf16 a[240:243], a[96:99], v[40:43], a[240:243]
    buffer_load_dwordx4 v2, s[16:19], s60 offen nt lds
    v_mfma_f32_16x16x32_bf16 a[240:243], a[100:103], v[44:47], a[240:243]
    ds_read_b64_tr_b16 v[56:57], v15 offset:0
    ds_read_b64_tr_b16 v[58:59], v15 offset:1024
    v_mfma_f32_16x16x32_bf16 a[244:247], a[104:107], v[40:43], a[244:247]
    ds_read_b64_tr_b16 v[60:61], v15 offset:8192
    ds_read_b64_tr_b16 v[62:63], v15 offset:9216
    v_mfma_f32_16x16x32_bf16 a[244:247], a[108:111], v[44:47], a[244:247]
    s_cmp_lt_u32 s2, 192
    s_cselect_b32 s72, s72, 1073741824
    v_mfma_f32_16x16x32_bf16 a[248:251], a[112:115], v[40:43], a[248:251]
    v_mfma_f32_16x16x32_bf16 a[248:251], a[116:119], v[44:47], a[248:251]
    buffer_load_dwordx4 v3, s[16:19], s60 offen offset:1024 nt lds
    v_mfma_f32_16x16x32_bf16 a[252:255], a[120:123], v[40:43], a[252:255]
    ds_read_b64_tr_b16 v[40:41], v16 offset:0
    ds_read_b64_tr_b16 v[42:43], v16 offset:1024
    v_mfma_f32_16x16x32_bf16 a[252:255], a[124:127], v[44:47], a[252:255]
    s_waitcnt lgkmcnt(2)
    ds_read_b64_tr_b16 v[44:45], v16 offset:8192
    ds_read_b64_tr_b16 v[46:47], v16 offset:9216
    v_mfma_f32_16x16x32_bf16 v[128:131], v[48:51], a[0:3], v[128:131]
    v_mfma_f32_16x16x32_bf16 v[128:131], v[52:55], a[4:7], v[128:131]
    v_add_u32 v22, 0xfffe0000, v22
    v_mfma_f32_16x16x32_bf16 v[132:135], v[48:51], a[8:11], v[132:135]
    ds_read_b128 a[64:67], v22 offset:16384
    v_mfma_f32_16x16x32_bf16 v[132:135], v[52:55], a[12:15], v[132:135]
    v_mfma_f32_16x16x32_bf16 v[136:139], v[48:51], a[16:19], v[136:139]
    v_mfma_f32_16x16x32_bf16 v[136:139], v[52:55], a[20:23], v[136:139]
    buffer_load_dwordx4 v4, s[16:19], s60 offen offset:2048 nt lds
    v_mfma_f32_16x16x32_bf16 v[140:143], v[48:51], a[24:27], v[140:143]
    v_add_u32 v23, 0xfffe0000, v23
    v_mfma_f32_16x16x32_bf16 v[140:143], v[52:55], a[28:31], v[140:143]
    ds_read_b128 a[68:71], v23 offset:16384
    v_mfma_f32_16x16x32_bf16 v[144:147], v[48:51], a[32:35], v[144:147]
    v_mfma_f32_16x16x32_bf16 v[144:147], v[52:55], a[36:39], v[144:147]
    v_mfma_f32_16x16x32_bf16 v[148:151], v[48:51], a[40:43], v[148:151]
    v_mfma_f32_16x16x32_bf16 v[148:151], v[52:55], a[44:47], v[148:151]
    v_mfma_f32_16x16x32_bf16 v[152:155], v[48:51], a[48:51], v[152:155]
    buffer_load_dwordx4 v5, s[16:19], s60 offen offset:3072 nt lds
    v_mfma_f32_16x16x32_bf16 v[152:155], v[52:55], a[52:55], v[152:155]
    ds_read_b128 a[72:75], v22 offset:18432
    v_mfma_f32_16x16x32_bf16 v[156:159], v[48:51], a[56:59], v[156:159]
    ds_read_b64_tr_b16 v[48:49], v17 offset:0
    ds_read_b64_tr_b16 v[50:51], v17 offset:1024
    v_mfma_f32_16x16x32_bf16 v[156:159], v[52:55], a[60:63], v[156:159]
    ds_read_b64_tr_b16 v[52:53], v17 offset:8192
    ds_read_b64_tr_b16 v[54:55], v17 offset:9216
    v_mfma_f32_16x16x32_bf16 v[160:163], v[56:59], a[0:3], v[160:163]
    v_mfma_f32_16x16x32_bf16 v[160:163], v[60:63], a[4:7], v[160:163]
    v_mfma_f32_16x16x32_bf16 v[164:167], v[56:59], a[8:11], v[164:167]
    ds_read_b128 a[76:79], v23 offset:18432
    v_mfma_f32_16x16x32_bf16 v[164:167], v[60:63], a[12:15], v[164:167]
    s_add_u32 m0, s69, 114688
    v_mfma_f32_16x16x32_bf16 v[168:171], v[56:59], a[16:19], v[168:171]
    s_xor_b32 s60, s60, 3670016
    buffer_load_dwordx4 v6, s[8:11], s62 offen lds
    v_mfma_f32_16x16x32_bf16 v[168:171], v[60:63], a[20:23], v[168:171]
    v_mfma_f32_16x16x32_bf16 v[172:175], v[56:59], a[24:27], v[172:175]
    v_mfma_f32_16x16x32_bf16 v[172:175], v[60:63], a[28:31], v[172:175]
    v_mfma_f32_16x16x32_bf16 v[176:179], v[56:59], a[32:35], v[176:179]
    ds_read_b128 a[80:83], v22 offset:20480
    v_mfma_f32_16x16x32_bf16 v[176:179], v[60:63], a[36:39], v[176:179]
    v_mfma_f32_16x16x32_bf16 v[180:183], v[56:59], a[40:43], v[180:183]
    v_mfma_f32_16x16x32_bf16 v[180:183], v[60:63], a[44:47], v[180:183]
    buffer_load_dwordx4 v7, s[8:11], s62 offen offset:1024 lds
    v_mfma_f32_16x16x32_bf16 v[184:187], v[56:59], a[48:51], v[184:187]
    v_mfma_f32_16x16x32_bf16 v[184:187], v[60:63], a[52:55], v[184:187]
    ds_read_b128 a[84:87], v23 offset:20480
    v_mfma_f32_16x16x32_bf16 v[188:191], v[56:59], a[56:59], v[188:191]
    s_waitcnt lgkmcnt(1)
    ds_read_b64_tr_b16 v[56:57], v14 offset:32768
    ds_read_b64_tr_b16 v[58:59], v14 offset:33792
    v_mfma_f32_16x16x32_bf16 v[188:191], v[60:63], a[60:63], v[188:191]
    ds_read_b64_tr_b16 v[60:61], v14 offset:40960
    ds_read_b64_tr_b16 v[62:63], v14 offset:41984
    v_mfma_f32_16x16x32_bf16 v[192:195], v[40:43], a[0:3], v[192:195]
    v_add_u32 v14, 0x10000, v14
    v_mfma_f32_16x16x32_bf16 v[192:195], v[44:47], a[4:7], v[192:195]
    v_mfma_f32_16x16x32_bf16 v[196:199], v[40:43], a[8:11], v[196:199]
    v_mfma_f32_16x16x32_bf16 v[196:199], v[44:47], a[12:15], v[196:199]
    buffer_load_dwordx4 v8, s[8:11], s62 offen offset:2048 lds
    v_mfma_f32_16x16x32_bf16 v[200:203], v[40:43], a[16:19], v[200:203]
    ds_read_b128 a[88:91], v22 offset:22528
    v_mfma_f32_16x16x32_bf16 v[200:203], v[44:47], a[20:23], v[200:203]
    v_mfma_f32_16x16x32_bf16 v[204:207], v[40:43], a[24:27], v[204:207]
    v_mfma_f32_16x16x32_bf16 v[204:207], v[44:47], a[28:31], v[204:207]
    v_mfma_f32_16x16x32_bf16 v[208:211], v[40:43], a[32:35], v[208:211]
    ds_read_b128 a[92:95], v23 offset:22528
    v_mfma_f32_16x16x32_bf16 v[208:211], v[44:47], a[36:39], v[208:211]
    v_mfma_f32_16x16x32_bf16 v[212:215], v[40:43], a[40:43], v[212:215]
    buffer_load_dwordx4 v9, s[8:11], s62 offen offset:3072 lds
    v_mfma_f32_16x16x32_bf16 v[212:215], v[44:47], a[44:47], v[212:215]
    v_mfma_f32_16x16x32_bf16 v[216:219], v[40:43], a[48:51], v[216:219]
    v_mfma_f32_16x16x32_bf16 v[216:219], v[44:47], a[52:55], v[216:219]
    v_mfma_f32_16x16x32_bf16 v[220:223], v[40:43], a[56:59], v[220:223]
    ds_read_b64_tr_b16 v[40:41], v15 offset:32768
    ds_read_b64_tr_b16 v[42:43], v15 offset:33792
    v_mfma_f32_16x16x32_bf16 v[220:223], v[44:47], a[60:63], v[220:223]
    ds_read_b64_tr_b16 v[44:45], v15 offset:40960
    ds_read_b64_tr_b16 v[46:47], v15 offset:41984
    v_mfma_f32_16x16x32_bf16 v[224:227], v[48:51], a[0:3], v[224:227]
    v_add_u32 v15, 0x10000, v15
    v_mfma_f32_16x16x32_bf16 v[224:227], v[52:55], a[4:7], v[224:227]
    s_xor_b32 s62, s62, 128
    v_mfma_f32_16x16x32_bf16 v[228:231], v[48:51], a[8:11], v[228:231]
    buffer_load_dword v106, v103, s[24:27], s77 offen
    v_mfma_f32_16x16x32_bf16 v[228:231], v[52:55], a[12:15], v[228:231]
    s_add_u32 s77, s77, 4608
    v_mfma_f32_16x16x32_bf16 v[232:235], v[48:51], a[16:19], v[232:235]
    v_mfma_f32_16x16x32_bf16 v[232:235], v[52:55], a[20:23], v[232:235]
    s_add_u32 m0, s69, 131072
    v_mfma_f32_16x16x32_bf16 v[236:239], v[48:51], a[24:27], v[236:239]
    buffer_load_dwordx4 v2, s[12:15], s60 offen nt lds
    v_mfma_f32_16x16x32_bf16 v[236:239], v[52:55], a[28:31], v[236:239]
    v_mfma_f32_16x16x32_bf16 v[240:243], v[48:51], a[32:35], v[240:243]
    v_mfma_f32_16x16x32_bf16 v[240:243], v[52:55], a[36:39], v[240:243]
    v_mfma_f32_16x16x32_bf16 v[244:247], v[48:51], a[40:43], v[244:247]
    v_mfma_f32_16x16x32_bf16 v[244:247], v[52:55], a[44:47], v[244:247]
    v_mfma_f32_16x16x32_bf16 v[248:251], v[48:51], a[48:51], v[248:251]
    v_mfma_f32_16x16x32_bf16 v[248:251], v[52:55], a[52:55], v[248:251]
    buffer_load_dwordx4 v3, s[12:15], s60 offen offset:1024 nt lds
    v_mfma_f32_16x16x32_bf16 v[252:255], v[48:51], a[56:59], v[252:255]
    ds_read_b64_tr_b16 v[48:49], v16 offset:32768
    ds_read_b64_tr_b16 v[50:51], v16 offset:33792
    v_mfma_f32_16x16x32_bf16 v[252:255], v[52:55], a[60:63], v[252:255]
    s_waitcnt lgkmcnt(2)
    ds_read_b64_tr_b16 v[52:53], v16 offset:40960
    ds_read_b64_tr_b16 v[54:55], v16 offset:41984
    v_mfma_f32_16x16x32_bf16 a[128:131], a[0:3], v[56:59], a[128:131]
    v_add_u32 v16, 0x10000, v16
    v_mfma_f32_16x16x32_bf16 a[128:131], a[4:7], v[60:63], a[128:131]
    v_mfma_f32_16x16x32_bf16 a[132:135], a[8:11], v[56:59], a[132:135]
    ds_read_b128 a[96:99], v22 offset:49152
    v_mfma_f32_16x16x32_bf16 a[132:135], a[12:15], v[60:63], a[132:135]
    v_mfma_f32_16x16x32_bf16 a[136:139], a[16:19], v[56:59], a[136:139]
    v_mfma_f32_16x16x32_bf16 a[136:139], a[20:23], v[60:63], a[136:139]
    buffer_load_dwordx4 v4, s[12:15], s60 offen offset:2048 nt lds
    v_mfma_f32_16x16x32_bf16 a[140:143], a[24:27], v[56:59], a[140:143]
    v_mfma_f32_16x16x32_bf16 a[140:143], a[28:31], v[60:63], a[140:143]
    ds_read_b128 a[100:103], v23 offset:49152
    v_mfma_f32_16x16x32_bf16 a[144:147], a[32:35], v[56:59], a[144:147]
    v_mfma_f32_16x16x32_bf16 a[144:147], a[36:39], v[60:63], a[144:147]
    v_mfma_f32_16x16x32_bf16 a[148:151], a[40:43], v[56:59], a[148:151]
    v_mfma_f32_16x16x32_bf16 a[148:151], a[44:47], v[60:63], a[148:151]
    v_mfma_f32_16x16x32_bf16 a[152:155], a[48:51], v[56:59], a[152:155]
    buffer_load_dwordx4 v5, s[12:15], s60 offen offset:3072 nt lds
    v_mfma_f32_16x16x32_bf16 a[152:155], a[52:55], v[60:63], a[152:155]
    ds_read_b128 a[104:107], v22 offset:51200
    v_mfma_f32_16x16x32_bf16 a[156:159], a[56:59], v[56:59], a[156:159]
    ds_read_b64_tr_b16 v[56:57], v17 offset:32768
    ds_read_b64_tr_b16 v[58:59], v17 offset:33792
    v_mfma_f32_16x16x32_bf16 a[156:159], a[60:63], v[60:63], a[156:159]
    ds_read_b64_tr_b16 v[60:61], v17 offset:40960
    ds_read_b64_tr_b16 v[62:63], v17 offset:41984
    v_mfma_f32_16x16x32_bf16 a[160:163], a[0:3], v[40:43], a[160:163]
    v_add_u32 v17, 0x10000, v17
    v_mfma_f32_16x16x32_bf16 a[160:163], a[4:7], v[44:47], a[160:163]
    v_mfma_f32_16x16x32_bf16 a[164:167], a[8:11], v[40:43], a[164:167]
    ds_read_b128 a[108:111], v23 offset:51200
    v_mfma_f32_16x16x32_bf16 a[164:167], a[12:15], v[44:47], a[164:167]
    s_add_u32 m0, s69, 147456
    v_mfma_f32_16x16x32_bf16 a[168:171], a[16:19], v[40:43], a[168:171]
    buffer_load_dwordx4 v6, s[8:11], s61 offen lds
    v_mfma_f32_16x16x32_bf16 a[168:171], a[20:23], v[44:47], a[168:171]
    v_mfma_f32_16x16x32_bf16 a[172:175], a[24:27], v[40:43], a[172:175]
    v_mfma_f32_16x16x32_bf16 a[172:175], a[28:31], v[44:47], a[172:175]
    v_mfma_f32_16x16x32_bf16 a[176:179], a[32:35], v[40:43], a[176:179]
    ds_read_b128 a[112:115], v22 offset:53248
    v_mfma_f32_16x16x32_bf16 a[176:179], a[36:39], v[44:47], a[176:179]
    v_mfma_f32_16x16x32_bf16 a[180:183], a[40:43], v[40:43], a[180:183]
    v_mfma_f32_16x16x32_bf16 a[180:183], a[44:47], v[44:47], a[180:183]
    buffer_load_dwordx4 v7, s[8:11], s61 offen offset:1024 lds
    v_mfma_f32_16x16x32_bf16 a[184:187], a[48:51], v[40:43], a[184:187]
    v_mfma_f32_16x16x32_bf16 a[184:187], a[52:55], v[44:47], a[184:187]
    ds_read_b128 a[116:119], v23 offset:53248
    v_mfma_f32_16x16x32_bf16 a[188:191], a[56:59], v[40:43], a[188:191]
    v_mfma_f32_16x16x32_bf16 a[188:191], a[60:63], v[44:47], a[188:191]
    s_waitcnt lgkmcnt(1)
    v_mfma_f32_16x16x32_bf16 a[192:195], a[0:3], v[48:51], a[192:195]
    v_mfma_f32_16x16x32_bf16 a[192:195], a[4:7], v[52:55], a[192:195]
    v_mfma_f32_16x16x32_bf16 a[196:199], a[8:11], v[48:51], a[196:199]
    v_mfma_f32_16x16x32_bf16 a[196:199], a[12:15], v[52:55], a[196:199]
    buffer_load_dwordx4 v8, s[8:11], s61 offen offset:2048 lds
    v_mfma_f32_16x16x32_bf16 a[200:203], a[16:19], v[48:51], a[200:203]
    ds_read_b128 a[120:123], v22 offset:55296
    v_mfma_f32_16x16x32_bf16 a[200:203], a[20:23], v[52:55], a[200:203]
    v_mfma_f32_16x16x32_bf16 a[204:207], a[24:27], v[48:51], a[204:207]
    v_mfma_f32_16x16x32_bf16 a[204:207], a[28:31], v[52:55], a[204:207]
    v_mfma_f32_16x16x32_bf16 a[208:211], a[32:35], v[48:51], a[208:211]
    ds_read_b128 a[124:127], v23 offset:55296
    v_mfma_f32_16x16x32_bf16 a[208:211], a[36:39], v[52:55], a[208:211]
    v_mfma_f32_16x16x32_bf16 a[212:215], a[40:43], v[48:51], a[212:215]
    buffer_load_dwordx4 v9, s[8:11], s61 offen offset:3072 lds
    v_mfma_f32_16x16x32_bf16 a[212:215], a[44:47], v[52:55], a[212:215]
    v_mfma_f32_16x16x32_bf16 a[216:219], a[48:51], v[48:51], a[216:219]
    v_mfma_f32_16x16x32_bf16 a[216:219], a[52:55], v[52:55], a[216:219]
    v_mfma_f32_16x16x32_bf16 a[220:223], a[56:59], v[48:51], a[220:223]
    v_mfma_f32_16x16x32_bf16 a[220:223], a[60:63], v[52:55], a[220:223]
    v_mfma_f32_16x16x32_bf16 a[224:227], a[0:3], v[56:59], a[224:227]
    v_mfma_f32_16x16x32_bf16 a[224:227], a[4:7], v[60:63], a[224:227]
    s_xor_b32 s61, s61, 384
    v_mfma_f32_16x16x32_bf16 a[228:231], a[8:11], v[56:59], a[228:231]
    v_mfma_f32_16x16x32_bf16 a[228:231], a[12:15], v[60:63], a[228:231]
    v_mfma_f32_16x16x32_bf16 a[232:235], a[16:19], v[56:59], a[232:235]
    v_mfma_f32_16x16x32_bf16 a[232:235], a[20:23], v[60:63], a[232:235]
    s_waitcnt vmcnt(9) lgkmcnt(0)
    s_barrier
    ds_read_b64_tr_b16 v[40:41], v14 offset:0
    v_mfma_f32_16x16x32_bf16 a[236:239], a[24:27], v[56:59], a[236:239]
    s_add_u32 m0, s69, 0
    ds_read_b64_tr_b16 v[42:43], v14 offset:1024
    ds_read_b64_tr_b16 v[44:45], v14 offset:8192
    v_mfma_f32_16x16x32_bf16 a[236:239], a[28:31], v[60:63], a[236:239]
    buffer_load_dwordx4 v2, s[16:19], s60 offen nt lds
    v_mfma_f32_16x16x32_bf16 a[240:243], a[32:35], v[56:59], a[240:243]
    ds_read_b64_tr_b16 v[46:47], v14 offset:9216
    v_cndmask_b32 v82, v82, v92, s[92:93]
    v_mfma_f32_16x16x32_bf16 a[240:243], a[36:39], v[60:63], a[240:243]
    v_cndmask_b32_e64 v83, v83, 0, s[92:93]
    v_xor_b32 v92, s98, v95
    v_mfma_f32_16x16x32_bf16 a[244:247], a[40:43], v[56:59], a[244:247]
    buffer_store_dwordx4 v[80:83], v92, s[28:31], s72 offen sc1
    v_mfma_f32_16x16x32_bf16 a[244:247], a[44:47], v[60:63], a[244:247]
    s_mul_i32 s72, s2, 3
    ds_read_b64_tr_b16 v[48:49], v15 offset:0
    ds_read_b64_tr_b16 v[50:51], v15 offset:1024
    v_mfma_f32_16x16x32_bf16 a[248:251], a[48:51], v[56:59], a[248:251]
    s_add_u32 s72, s72, 1
    ds_read_b64_tr_b16 v[52:53], v15 offset:8192
    ds_read_b64_tr_b16 v[54:55], v15 offset:9216
    v_mfma_f32_16x16x32_bf16 a[248:251], a[52:55], v[60:63], a[248:251]
    s_bfe_u32 s98, s72, 0x10001
    buffer_load_dwordx4 v3, s[16:19], s60 offen offset:1024 nt lds
    v_mfma_f32_16x16x32_bf16 a[252:255], a[56:59], v[56:59], a[252:255]
    s_bfe_u32 s99, s72, 0x10003
    v_cndmask_b32 v86, v86, v93, s[92:93]
    v_cndmask_b32_e64 v87, v87, 0, s[92:93]
    v_mfma_f32_16x16x32_bf16 a[252:255], a[60:63], v[60:63], a[252:255]
    s_lshl1_add_u32 s98, s99, s98
    v_cndmask_b32 v90, v90, v94, s[92:93]
    v_cndmask_b32_e64 v91, v91, 0, s[92:93]
    s_waitcnt lgkmcnt(4)
    v_mfma_f32_16x16x32_bf16 v[128:131], v[40:43], a[64:67], v[128:131]
    s_lshl_b32 s98, s98, 5
    v_xor_b32 v93, s98, v95
    ds_read_b64_tr_b16 v[56:57], v16 offset:0
    v_mfma_f32_16x16x32_bf16 v[128:131], v[44:47], a[68:71], v[128:131]
    s_lshl_b32 s72, s72, 7
    v_add_u32 v22, 0x10000, v22
    ds_read_b64_tr_b16 v[58:59], v16 offset:1024
    v_mfma_f32_16x16x32_bf16 v[132:135], v[40:43], a[72:75], v[132:135]
    ds_read_b128 a[0:3], v22 offset:16384
    ds_read_b64_tr_b16 v[60:61], v16 offset:8192
    v_mfma_f32_16x16x32_bf16 v[132:135], v[44:47], a[76:79], v[132:135]
    s_cmp_lt_u32 s2, 192
    s_cselect_b32 s72, s72, 1073741824
    ds_read_b64_tr_b16 v[62:63], v16 offset:9216
    v_mfma_f32_16x16x32_bf16 v[136:139], v[40:43], a[80:83], v[136:139]
    buffer_store_dwordx4 v[84:87], v93, s[28:31], s72 offen sc1
    v_mfma_f32_16x16x32_bf16 v[136:139], v[44:47], a[84:87], v[136:139]
    s_mul_i32 s72, s2, 3
    buffer_load_dwordx4 v4, s[16:19], s60 offen offset:2048 nt lds
    v_mfma_f32_16x16x32_bf16 v[140:143], v[40:43], a[88:91], v[140:143]
    s_add_u32 s72, s72, 2
    v_add_u32 v23, 0x10000, v23
    v_mfma_f32_16x16x32_bf16 v[140:143], v[44:47], a[92:95], v[140:143]
    s_bfe_u32 s98, s72, 0x10001
    ds_read_b128 a[4:7], v23 offset:16384
    v_mfma_f32_16x16x32_bf16 v[144:147], v[40:43], a[96:99], v[144:147]
    s_bfe_u32 s99, s72, 0x10003
    v_mfma_f32_16x16x32_bf16 v[144:147], v[44:47], a[100:103], v[144:147]
    s_lshl1_add_u32 s98, s99, s98
    v_mfma_f32_16x16x32_bf16 v[148:151], v[40:43], a[104:107], v[148:151]
    s_lshl_b32 s98, s98, 5
    v_xor_b32 v94, s98, v95
    v_mfma_f32_16x16x32_bf16 v[148:151], v[44:47], a[108:111], v[148:151]
    s_lshl_b32 s72, s72, 7
    v_mfma_f32_16x16x32_bf16 v[152:155], v[40:43], a[112:115], v[152:155]
    s_bfe_u32 s98, s5, 0x20001
    buffer_load_dwordx4 v5, s[16:19], s60 offen offset:3072 nt lds
    v_mfma_f32_16x16x32_bf16 v[152:155], v[44:47], a[116:119], v[152:155]
    s_lshl2_add_u32 s99, s100, s4
    ds_read_b128 a[8:11], v22 offset:18432
    v_mfma_f32_16x16x32_bf16 v[156:159], v[40:43], a[120:123], v[156:159]
    s_cmp_lt_u32 s2, 192
    s_cselect_b32 s72, s72, 1073741824
    ds_read_b64_tr_b16 v[40:41], v17 offset:0
    v_mfma_f32_16x16x32_bf16 v[156:159], v[44:47], a[124:127], v[156:159]
    s_lshl_b32 s99, s99, 7
    buffer_store_dwordx4 v[88:91], v94, s[28:31], s72 offen sc1
    s_waitcnt lgkmcnt(2)
    v_mfma_f32_16x16x32_bf16 v[160:163], v[48:51], a[64:67], v[160:163]
    s_mov_b32 s30, 73728
    ds_read_b64_tr_b16 v[42:43], v17 offset:1024
    ds_read_b64_tr_b16 v[44:45], v17 offset:8192
    v_mfma_f32_16x16x32_bf16 v[160:163], v[52:55], a[68:71], v[160:163]
    ds_read_b64_tr_b16 v[46:47], v17 offset:9216
    v_mfma_f32_16x16x32_bf16 v[164:167], v[48:51], a[72:75], v[164:167]
    ds_read_b128 a[12:15], v23 offset:18432
    v_mfma_f32_16x16x32_bf16 v[164:167], v[52:55], a[76:79], v[164:167]
    s_add_u32 m0, s69, 16384
    v_mfma_f32_16x16x32_bf16 v[168:171], v[48:51], a[80:83], v[168:171]
    s_xor_b32 s60, s60, 524288
    buffer_load_dwordx4 v6, s[8:11], s62 offen lds
    v_mfma_f32_16x16x32_bf16 v[168:171], v[52:55], a[84:87], v[168:171]
    s_add_u32 s28, s28, s7
    s_addc_u32 s29, s29, 0
    v_mfma_f32_16x16x32_bf16 v[172:175], v[48:51], a[88:91], v[172:175]
    s_and_b32 s7, s5, 24
    v_mfma_f32_16x16x32_bf16 v[172:175], v[52:55], a[92:95], v[172:175]
    s_add_u32 s7, s7, s6
    v_mfma_f32_16x16x32_bf16 v[176:179], v[48:51], a[96:99], v[176:179]
    s_lshl2_add_u32 s7, s7, s98
    ds_read_b128 a[16:19], v22 offset:20480
    v_mfma_f32_16x16x32_bf16 v[176:179], v[52:55], a[100:103], v[176:179]
    s_mul_i32 s98, s7, 36864
    v_add_u32 v36, s98, v36
    v_sub_u32 v39, v36, v39
    v_mfma_f32_16x16x32_bf16 v[180:183], v[48:51], a[104:107], v[180:183]
    v_lshl_add_u32 v36, s100, 6, v36
    v_mfma_f32_16x16x32_bf16 v[180:183], v[52:55], a[108:111], v[180:183]
    buffer_load_dwordx4 v7, s[8:11], s62 offen offset:1024 lds
    v_mfma_f32_16x16x32_bf16 v[184:187], v[48:51], a[112:115], v[184:187]
    v_mfma_f32_16x16x32_bf16 v[184:187], v[52:55], a[116:119], v[184:187]
    ds_read_b128 a[20:23], v23 offset:20480
    v_mfma_f32_16x16x32_bf16 v[188:191], v[48:51], a[120:123], v[188:191]
    ds_read_b64_tr_b16 v[48:49], v14 offset:32768
    ds_read_b64_tr_b16 v[50:51], v14 offset:33792
    v_mfma_f32_16x16x32_bf16 v[188:191], v[52:55], a[124:127], v[188:191]
    ds_read_b64_tr_b16 v[52:53], v14 offset:40960
    ds_read_b64_tr_b16 v[54:55], v14 offset:41984
    v_mfma_f32_16x16x32_bf16 v[192:195], v[56:59], a[64:67], v[192:195]
    v_add_u32 v14, 0x10000, v14
    v_mfma_f32_16x16x32_bf16 v[192:195], v[60:63], a[68:71], v[192:195]
    v_mfma_f32_16x16x32_bf16 v[196:199], v[56:59], a[72:75], v[196:199]
    v_mfma_f32_16x16x32_bf16 v[196:199], v[60:63], a[76:79], v[196:199]
    buffer_load_dwordx4 v8, s[8:11], s62 offen offset:2048 lds
    v_mfma_f32_16x16x32_bf16 v[200:203], v[56:59], a[80:83], v[200:203]
    ds_read_b128 a[24:27], v22 offset:22528
    v_mfma_f32_16x16x32_bf16 v[200:203], v[60:63], a[84:87], v[200:203]
    v_mfma_f32_16x16x32_bf16 v[204:207], v[56:59], a[88:91], v[204:207]
    v_mfma_f32_16x16x32_bf16 v[204:207], v[60:63], a[92:95], v[204:207]
    v_mfma_f32_16x16x32_bf16 v[208:211], v[56:59], a[96:99], v[208:211]
    ds_read_b128 a[28:31], v23 offset:22528
    v_mfma_f32_16x16x32_bf16 v[208:211], v[60:63], a[100:103], v[208:211]
    v_mfma_f32_16x16x32_bf16 v[212:215], v[56:59], a[104:107], v[212:215]
    buffer_load_dwordx4 v9, s[8:11], s62 offen offset:3072 lds
    v_mfma_f32_16x16x32_bf16 v[212:215], v[60:63], a[108:111], v[212:215]
    v_mfma_f32_16x16x32_bf16 v[216:219], v[56:59], a[112:115], v[216:219]
    v_mfma_f32_16x16x32_bf16 v[216:219], v[60:63], a[116:119], v[216:219]
    v_mfma_f32_16x16x32_bf16 v[220:223], v[56:59], a[120:123], v[220:223]
    s_waitcnt lgkmcnt(0)
    ds_read_b64_tr_b16 v[56:57], v15 offset:32768
    ds_read_b64_tr_b16 v[58:59], v15 offset:33792
    v_mfma_f32_16x16x32_bf16 v[220:223], v[60:63], a[124:127], v[220:223]
    ds_read_b64_tr_b16 v[60:61], v15 offset:40960
    ds_read_b64_tr_b16 v[62:63], v15 offset:41984
    v_mfma_f32_16x16x32_bf16 v[224:227], v[40:43], a[64:67], v[224:227]
    v_add_u32 v15, 0x10000, v15
    v_mfma_f32_16x16x32_bf16 v[224:227], v[44:47], a[68:71], v[224:227]
    s_xor_b32 s62, s62, 384
    v_mfma_f32_16x16x32_bf16 v[228:231], v[40:43], a[72:75], v[228:231]
    buffer_load_dword v107, v103, s[24:27], s77 offen
    v_mfma_f32_16x16x32_bf16 v[228:231], v[44:47], a[76:79], v[228:231]
    s_add_u32 s77, s77, 4608
    v_mfma_f32_16x16x32_bf16 v[232:235], v[40:43], a[80:83], v[232:235]
    v_mfma_f32_16x16x32_bf16 v[232:235], v[44:47], a[84:87], v[232:235]
    s_add_u32 m0, s69, 32768
    v_mfma_f32_16x16x32_bf16 v[236:239], v[40:43], a[88:91], v[236:239]
    buffer_load_dwordx4 v2, s[12:15], s60 offen nt lds
    v_mfma_f32_16x16x32_bf16 v[236:239], v[44:47], a[92:95], v[236:239]
    v_mfma_f32_16x16x32_bf16 v[240:243], v[40:43], a[96:99], v[240:243]
    v_mfma_f32_16x16x32_bf16 v[240:243], v[44:47], a[100:103], v[240:243]
    v_mfma_f32_16x16x32_bf16 v[244:247], v[40:43], a[104:107], v[244:247]
    v_mfma_f32_16x16x32_bf16 v[244:247], v[44:47], a[108:111], v[244:247]
    v_mfma_f32_16x16x32_bf16 v[248:251], v[40:43], a[112:115], v[248:251]
    v_mfma_f32_16x16x32_bf16 v[248:251], v[44:47], a[116:119], v[248:251]
    buffer_load_dwordx4 v3, s[12:15], s60 offen offset:1024 nt lds
    v_mfma_f32_16x16x32_bf16 v[252:255], v[40:43], a[120:123], v[252:255]
    ds_read_b64_tr_b16 v[40:41], v16 offset:32768
    ds_read_b64_tr_b16 v[42:43], v16 offset:33792
    v_mfma_f32_16x16x32_bf16 v[252:255], v[44:47], a[124:127], v[252:255]
    ds_read_b64_tr_b16 v[44:45], v16 offset:40960
    ds_read_b64_tr_b16 v[46:47], v16 offset:41984
    v_mfma_f32_16x16x32_bf16 a[128:131], a[64:67], v[48:51], a[128:131]
    v_add_u32 v16, 0x10000, v16
    v_mfma_f32_16x16x32_bf16 a[128:131], a[68:71], v[52:55], a[128:131]
    v_mfma_f32_16x16x32_bf16 a[132:135], a[72:75], v[48:51], a[132:135]
    ds_read_b128 a[32:35], v22 offset:49152
    v_mfma_f32_16x16x32_bf16 a[132:135], a[76:79], v[52:55], a[132:135]
    v_mfma_f32_16x16x32_bf16 a[136:139], a[80:83], v[48:51], a[136:139]
    v_mfma_f32_16x16x32_bf16 a[136:139], a[84:87], v[52:55], a[136:139]
    buffer_load_dwordx4 v4, s[12:15], s60 offen offset:2048 nt lds
    v_mfma_f32_16x16x32_bf16 a[140:143], a[88:91], v[48:51], a[140:143]
    v_mfma_f32_16x16x32_bf16 a[140:143], a[92:95], v[52:55], a[140:143]
    ds_read_b128 a[36:39], v23 offset:49152
    v_mfma_f32_16x16x32_bf16 a[144:147], a[96:99], v[48:51], a[144:147]
    v_mfma_f32_16x16x32_bf16 a[144:147], a[100:103], v[52:55], a[144:147]
    v_mfma_f32_16x16x32_bf16 a[148:151], a[104:107], v[48:51], a[148:151]
    v_mfma_f32_16x16x32_bf16 a[148:151], a[108:111], v[52:55], a[148:151]
    v_mfma_f32_16x16x32_bf16 a[152:155], a[112:115], v[48:51], a[152:155]
    buffer_load_dwordx4 v5, s[12:15], s60 offen offset:3072 nt lds
    v_mfma_f32_16x16x32_bf16 a[152:155], a[116:119], v[52:55], a[152:155]
    ds_read_b128 a[40:43], v22 offset:51200
    v_mfma_f32_16x16x32_bf16 a[156:159], a[120:123], v[48:51], a[156:159]
    ds_read_b64_tr_b16 v[48:49], v17 offset:32768
    ds_read_b64_tr_b16 v[50:51], v17 offset:33792
    v_mfma_f32_16x16x32_bf16 a[156:159], a[124:127], v[52:55], a[156:159]
    s_waitcnt lgkmcnt(3)
    ds_read_b64_tr_b16 v[52:53], v17 offset:40960
    ds_read_b64_tr_b16 v[54:55], v17 offset:41984
    v_mfma_f32_16x16x32_bf16 a[160:163], a[64:67], v[56:59], a[160:163]
    v_add_u32 v17, 0x10000, v17
    v_mfma_f32_16x16x32_bf16 a[160:163], a[68:71], v[60:63], a[160:163]
    v_mfma_f32_16x16x32_bf16 a[164:167], a[72:75], v[56:59], a[164:167]
    ds_read_b128 a[44:47], v23 offset:51200
    v_mfma_f32_16x16x32_bf16 a[164:167], a[76:79], v[60:63], a[164:167]
    s_add_u32 m0, s69, 49152
    v_mfma_f32_16x16x32_bf16 a[168:171], a[80:83], v[56:59], a[168:171]
    buffer_load_dwordx4 v6, s[8:11], s61 offen lds
    v_mfma_f32_16x16x32_bf16 a[168:171], a[84:87], v[60:63], a[168:171]
    v_mfma_f32_16x16x32_bf16 a[172:175], a[88:91], v[56:59], a[172:175]
    v_mfma_f32_16x16x32_bf16 a[172:175], a[92:95], v[60:63], a[172:175]
    v_mfma_f32_16x16x32_bf16 a[176:179], a[96:99], v[56:59], a[176:179]
    ds_read_b128 a[48:51], v22 offset:53248
    v_mfma_f32_16x16x32_bf16 a[176:179], a[100:103], v[60:63], a[176:179]
    v_mfma_f32_16x16x32_bf16 a[180:183], a[104:107], v[56:59], a[180:183]
    v_mfma_f32_16x16x32_bf16 a[180:183], a[108:111], v[60:63], a[180:183]
    buffer_load_dwordx4 v7, s[8:11], s61 offen offset:1024 lds
    v_mfma_f32_16x16x32_bf16 a[184:187], a[112:115], v[56:59], a[184:187]
    v_mfma_f32_16x16x32_bf16 a[184:187], a[116:119], v[60:63], a[184:187]
    ds_read_b128 a[52:55], v23 offset:53248
    v_mfma_f32_16x16x32_bf16 a[188:191], a[120:123], v[56:59], a[188:191]
    v_mfma_f32_16x16x32_bf16 a[188:191], a[124:127], v[60:63], a[188:191]
    v_mfma_f32_16x16x32_bf16 a[192:195], a[64:67], v[40:43], a[192:195]
    v_mfma_f32_16x16x32_bf16 a[192:195], a[68:71], v[44:47], a[192:195]
    v_mfma_f32_16x16x32_bf16 a[196:199], a[72:75], v[40:43], a[196:199]
    v_mfma_f32_16x16x32_bf16 a[196:199], a[76:79], v[44:47], a[196:199]
    buffer_load_dwordx4 v8, s[8:11], s61 offen offset:2048 lds
    v_mfma_f32_16x16x32_bf16 a[200:203], a[80:83], v[40:43], a[200:203]
    ds_read_b128 a[56:59], v22 offset:55296
    v_mfma_f32_16x16x32_bf16 a[200:203], a[84:87], v[44:47], a[200:203]
    v_mfma_f32_16x16x32_bf16 a[204:207], a[88:91], v[40:43], a[204:207]
    v_mfma_f32_16x16x32_bf16 a[204:207], a[92:95], v[44:47], a[204:207]
    v_mfma_f32_16x16x32_bf16 a[208:211], a[96:99], v[40:43], a[208:211]
    ds_read_b128 a[60:63], v23 offset:55296
    v_mfma_f32_16x16x32_bf16 a[208:211], a[100:103], v[44:47], a[208:211]
    v_mfma_f32_16x16x32_bf16 a[212:215], a[104:107], v[40:43], a[212:215]
    buffer_load_dwordx4 v9, s[8:11], s61 offen offset:3072 lds
    v_mfma_f32_16x16x32_bf16 a[212:215], a[108:111], v[44:47], a[212:215]
    v_mfma_f32_16x16x32_bf16 a[216:219], a[112:115], v[40:43], a[216:219]
    v_mfma_f32_16x16x32_bf16 a[216:219], a[116:119], v[44:47], a[216:219]
    v_mfma_f32_16x16x32_bf16 a[220:223], a[120:123], v[40:43], a[220:223]
    v_mfma_f32_16x16x32_bf16 a[220:223], a[124:127], v[44:47], a[220:223]
    s_waitcnt lgkmcnt(0)
    v_mfma_f32_16x16x32_bf16 a[224:227], a[64:67], v[48:51], a[224:227]
    v_mfma_f32_16x16x32_bf16 a[224:227], a[68:71], v[52:55], a[224:227]
    s_xor_b32 s61, s61, 128
    v_mfma_f32_16x16x32_bf16 a[228:231], a[72:75], v[48:51], a[228:231]
    v_mfma_f32_16x16x32_bf16 a[228:231], a[76:79], v[52:55], a[228:231]
    v_mfma_f32_16x16x32_bf16 a[232:235], a[80:83], v[48:51], a[232:235]
    v_mfma_f32_16x16x32_bf16 a[232:235], a[84:87], v[52:55], a[232:235]
    s_waitcnt vmcnt(9) lgkmcnt(0)
    s_barrier
    ds_read_b64_tr_b16 v[56:57], v14 offset:0
    v_mfma_f32_16x16x32_bf16 a[236:239], a[88:91], v[48:51], a[236:239]
    s_add_u32 m0, s69, 65536
    ds_read_b64_tr_b16 v[58:59], v14 offset:1024
    ds_read_b64_tr_b16 v[60:61], v14 offset:8192
    v_mfma_f32_16x16x32_bf16 a[236:239], a[92:95], v[52:55], a[236:239]
    buffer_load_dwordx4 v2, s[16:19], s60 offen nt lds
    v_mfma_f32_16x16x32_bf16 a[240:243], a[96:99], v[48:51], a[240:243]
    ds_read_b64_tr_b16 v[62:63], v14 offset:9216
    ds_read_b64_tr_b16 v[40:41], v15 offset:0
    v_mfma_f32_16x16x32_bf16 a[240:243], a[100:103], v[52:55], a[240:243]
    buffer_atomic_add v31, v30, s[44:47], s95 offen sc1
    v_mfma_f32_16x16x32_bf16 a[244:247], a[104:107], v[48:51], a[244:247]
    ds_read_b64_tr_b16 v[42:43], v15 offset:1024
    ds_read_b64_tr_b16 v[44:45], v15 offset:8192
    v_mfma_f32_16x16x32_bf16 a[244:247], a[108:111], v[52:55], a[244:247]
    ds_read_b64_tr_b16 v[46:47], v15 offset:9216
    v_add_u32 v14, 0xfffe0000, v14
    v_mfma_f32_16x16x32_bf16 a[248:251], a[112:115], v[48:51], a[248:251]
    v_add_u32 v15, 0xfffe0000, v15
    v_mfma_f32_16x16x32_bf16 a[248:251], a[116:119], v[52:55], a[248:251]
    buffer_load_dwordx4 v3, s[16:19], s60 offen offset:1024 nt lds
    v_mfma_f32_16x16x32_bf16 a[252:255], a[120:123], v[48:51], a[252:255]
    ds_read_b64_tr_b16 v[48:49], v16 offset:0
    ds_read_b64_tr_b16 v[50:51], v16 offset:1024
    v_mfma_f32_16x16x32_bf16 a[252:255], a[124:127], v[52:55], a[252:255]
    s_waitcnt lgkmcnt(3)
    ds_read_b64_tr_b16 v[52:53], v16 offset:8192
    ds_read_b64_tr_b16 v[54:55], v16 offset:9216
    v_mfma_f32_16x16x32_bf16 v[128:131], v[56:59], a[0:3], v[128:131]
    v_add_u32 v16, 0xfffe0000, v16
    v_mfma_f32_16x16x32_bf16 v[128:131], v[60:63], a[4:7], v[128:131]
    v_add_u32 v22, 0x10000, v22
    v_mfma_f32_16x16x32_bf16 v[132:135], v[56:59], a[8:11], v[132:135]
    ds_read_b128 a[64:67], v22 offset:16384
    v_mfma_f32_16x16x32_bf16 v[132:135], v[60:63], a[12:15], v[132:135]
    v_mfma_f32_16x16x32_bf16 v[136:139], v[56:59], a[16:19], v[136:139]
    v_mfma_f32_16x16x32_bf16 v[136:139], v[60:63], a[20:23], v[136:139]
    buffer_load_dwordx4 v4, s[16:19], s60 offen offset:2048 nt lds
    v_mfma_f32_16x16x32_bf16 v[140:143], v[56:59], a[24:27], v[140:143]
    v_add_u32 v23, 0x10000, v23
    v_mfma_f32_16x16x32_bf16 v[140:143], v[60:63], a[28:31], v[140:143]
    ds_read_b128 a[68:71], v23 offset:16384
    v_mfma_f32_16x16x32_bf16 v[144:147], v[56:59], a[32:35], v[144:147]
    v_mfma_f32_16x16x32_bf16 v[144:147], v[60:63], a[36:39], v[144:147]
    v_mfma_f32_16x16x32_bf16 v[148:151], v[56:59], a[40:43], v[148:151]
    v_mfma_f32_16x16x32_bf16 v[148:151], v[60:63], a[44:47], v[148:151]
    v_mfma_f32_16x16x32_bf16 v[152:155], v[56:59], a[48:51], v[152:155]
    buffer_load_dwordx4 v5, s[16:19], s60 offen offset:3072 nt lds
    v_mfma_f32_16x16x32_bf16 v[152:155], v[60:63], a[52:55], v[152:155]
    ds_read_b128 a[72:75], v22 offset:18432
    v_mfma_f32_16x16x32_bf16 v[156:159], v[56:59], a[56:59], v[156:159]
    ds_read_b64_tr_b16 v[56:57], v17 offset:0
    ds_read_b64_tr_b16 v[58:59], v17 offset:1024
    v_mfma_f32_16x16x32_bf16 v[156:159], v[60:63], a[60:63], v[156:159]
    ds_read_b64_tr_b16 v[60:61], v17 offset:8192
    ds_read_b64_tr_b16 v[62:63], v17 offset:9216
    v_mfma_f32_16x16x32_bf16 v[160:163], v[40:43], a[0:3], v[160:163]
    s_waitcnt lgkmcnt(5)
    v_add_u32 v17, 0xfffe0000, v17
    v_mfma_f32_16x16x32_bf16 v[160:163], v[44:47], a[4:7], v[160:163]
    v_mfma_f32_16x16x32_bf16 v[164:167], v[40:43], a[8:11], v[164:167]
    ds_read_b128 a[76:79], v23 offset:18432
    v_mfma_f32_16x16x32_bf16 v[164:167], v[44:47], a[12:15], v[164:167]
    s_add_u32 m0, s69, 81920
    v_mfma_f32_16x16x32_bf16 v[168:171], v[40:43], a[16:19], v[168:171]
    s_xor_b32 s60, s60, 1572864
    buffer_load_dwordx4 v6, s[8:11], s62 offen lds
    v_mfma_f32_16x16x32_bf16 v[168:171], v[44:47], a[20:23], v[168:171]
    v_mfma_f32_16x16x32_bf16 v[172:175], v[40:43], a[24:27], v[172:175]
    v_mfma_f32_16x16x32_bf16 v[172:175], v[44:47], a[28:31], v[172:175]
    v_mfma_f32_16x16x32_bf16 v[176:179], v[40:43], a[32:35], v[176:179]
    ds_read_b128 a[80:83], v22 offset:20480
    v_mfma_f32_16x16x32_bf16 v[176:179], v[44:47], a[36:39], v[176:179]
    v_mfma_f32_16x16x32_bf16 v[180:183], v[40:43], a[40:43], v[180:183]
    v_mfma_f32_16x16x32_bf16 v[180:183], v[44:47], a[44:47], v[180:183]
    buffer_load_dwordx4 v7, s[8:11], s62 offen offset:1024 lds
    v_mfma_f32_16x16x32_bf16 v[184:187], v[40:43], a[48:51], v[184:187]
    v_mfma_f32_16x16x32_bf16 v[184:187], v[44:47], a[52:55], v[184:187]
    ds_read_b128 a[84:87], v23 offset:20480
    v_mfma_f32_16x16x32_bf16 v[188:191], v[40:43], a[56:59], v[188:191]
    ds_read_b64_tr_b16 v[40:41], v14 offset:0
    ds_read_b64_tr_b16 v[42:43], v14 offset:1024
    v_mfma_f32_16x16x32_bf16 v[188:191], v[44:47], a[60:63], v[188:191]
    ds_read_b64_tr_b16 v[44:45], v14 offset:8192
    ds_read_b64_tr_b16 v[46:47], v14 offset:9216
    v_mfma_f32_16x16x32_bf16 v[192:195], v[48:51], a[0:3], v[192:195]
    v_mfma_f32_16x16x32_bf16 v[192:195], v[52:55], a[4:7], v[192:195]
    v_mfma_f32_16x16x32_bf16 v[196:199], v[48:51], a[8:11], v[196:199]
    v_mfma_f32_16x16x32_bf16 v[196:199], v[52:55], a[12:15], v[196:199]
    buffer_load_dwordx4 v8, s[8:11], s62 offen offset:2048 lds
    v_mfma_f32_16x16x32_bf16 v[200:203], v[48:51], a[16:19], v[200:203]
    ds_read_b128 a[88:91], v22 offset:22528
    v_mfma_f32_16x16x32_bf16 v[200:203], v[52:55], a[20:23], v[200:203]
    v_mfma_f32_16x16x32_bf16 v[204:207], v[48:51], a[24:27], v[204:207]
    v_mfma_f32_16x16x32_bf16 v[204:207], v[52:55], a[28:31], v[204:207]
    v_mfma_f32_16x16x32_bf16 v[208:211], v[48:51], a[32:35], v[208:211]
    ds_read_b128 a[92:95], v23 offset:22528
    v_mfma_f32_16x16x32_bf16 v[208:211], v[52:55], a[36:39], v[208:211]
    v_mfma_f32_16x16x32_bf16 v[212:215], v[48:51], a[40:43], v[212:215]
    buffer_load_dwordx4 v9, s[8:11], s62 offen offset:3072 lds
    v_mfma_f32_16x16x32_bf16 v[212:215], v[52:55], a[44:47], v[212:215]
    v_mfma_f32_16x16x32_bf16 v[216:219], v[48:51], a[48:51], v[216:219]
    v_mfma_f32_16x16x32_bf16 v[216:219], v[52:55], a[52:55], v[216:219]
    v_mfma_f32_16x16x32_bf16 v[220:223], v[48:51], a[56:59], v[220:223]
    s_waitcnt lgkmcnt(0)
    ds_read_b64_tr_b16 v[48:49], v15 offset:0
    ds_read_b64_tr_b16 v[50:51], v15 offset:1024
    v_mfma_f32_16x16x32_bf16 v[220:223], v[52:55], a[60:63], v[220:223]
    ds_read_b64_tr_b16 v[52:53], v15 offset:8192
    ds_read_b64_tr_b16 v[54:55], v15 offset:9216
    v_mfma_f32_16x16x32_bf16 v[224:227], v[56:59], a[0:3], v[224:227]
    v_mfma_f32_16x16x32_bf16 v[224:227], v[60:63], a[4:7], v[224:227]
    s_xor_b32 s62, s62, 128
    v_mfma_f32_16x16x32_bf16 v[228:231], v[56:59], a[8:11], v[228:231]
    buffer_load_dword v108, v103, s[24:27], s77 offen
    v_mfma_f32_16x16x32_bf16 v[228:231], v[60:63], a[12:15], v[228:231]
    s_add_u32 s77, s77, 4608
    v_mfma_f32_16x16x32_bf16 v[232:235], v[56:59], a[16:19], v[232:235]
    v_mfma_f32_16x16x32_bf16 v[232:235], v[60:63], a[20:23], v[232:235]
    s_add_u32 m0, s69, 98304
    v_mfma_f32_16x16x32_bf16 v[236:239], v[56:59], a[24:27], v[236:239]
    buffer_load_dwordx4 v2, s[12:15], s60 offen nt lds
    v_mfma_f32_16x16x32_bf16 v[236:239], v[60:63], a[28:31], v[236:239]
    v_mfma_f32_16x16x32_bf16 v[240:243], v[56:59], a[32:35], v[240:243]
    v_mfma_f32_16x16x32_bf16 v[240:243], v[60:63], a[36:39], v[240:243]
    v_mfma_f32_16x16x32_bf16 v[244:247], v[56:59], a[40:43], v[244:247]
    v_mfma_f32_16x16x32_bf16 v[244:247], v[60:63], a[44:47], v[244:247]
    v_mfma_f32_16x16x32_bf16 v[248:251], v[56:59], a[48:51], v[248:251]
    v_mfma_f32_16x16x32_bf16 v[248:251], v[60:63], a[52:55], v[248:251]
    buffer_load_dwordx4 v3, s[12:15], s60 offen offset:1024 nt lds
    v_mfma_f32_16x16x32_bf16 v[252:255], v[56:59], a[56:59], v[252:255]
    ds_read_b64_tr_b16 v[56:57], v16 offset:0
    ds_read_b64_tr_b16 v[58:59], v16 offset:1024
    v_mfma_f32_16x16x32_bf16 v[252:255], v[60:63], a[60:63], v[252:255]
    ds_read_b64_tr_b16 v[60:61], v16 offset:8192
    ds_read_b64_tr_b16 v[62:63], v16 offset:9216
    v_mfma_f32_16x16x32_bf16 a[128:131], a[0:3], v[40:43], a[128:131]
    v_mfma_f32_16x16x32_bf16 a[128:131], a[4:7], v[44:47], a[128:131]
    v_add_u32 v22, 0xfffe0000, v22
    v_mfma_f32_16x16x32_bf16 a[132:135], a[8:11], v[40:43], a[132:135]
    ds_read_b128 a[96:99], v22 offset:16384
    v_mfma_f32_16x16x32_bf16 a[132:135], a[12:15], v[44:47], a[132:135]
    v_mfma_f32_16x16x32_bf16 a[136:139], a[16:19], v[40:43], a[136:139]
    v_mfma_f32_16x16x32_bf16 a[136:139], a[20:23], v[44:47], a[136:139]
    buffer_load_dwordx4 v4, s[12:15], s60 offen offset:2048 nt lds
    v_mfma_f32_16x16x32_bf16 a[140:143], a[24:27], v[40:43], a[140:143]
    v_add_u32 v23, 0xfffe0000, v23
    v_mfma_f32_16x16x32_bf16 a[140:143], a[28:31], v[44:47], a[140:143]
    ds_read_b128 a[100:103], v23 offset:16384
    v_mfma_f32_16x16x32_bf16 a[144:147], a[32:35], v[40:43], a[144:147]
    v_mfma_f32_16x16x32_bf16 a[144:147], a[36:39], v[44:47], a[144:147]
    v_mfma_f32_16x16x32_bf16 a[148:151], a[40:43], v[40:43], a[148:151]
    v_mfma_f32_16x16x32_bf16 a[148:151], a[44:47], v[44:47], a[148:151]
    v_mfma_f32_16x16x32_bf16 a[152:155], a[48:51], v[40:43], a[152:155]
    buffer_load_dwordx4 v5, s[12:15], s60 offen offset:3072 nt lds
    v_mfma_f32_16x16x32_bf16 a[152:155], a[52:55], v[44:47], a[152:155]
    ds_read_b128 a[104:107], v22 offset:18432
    v_mfma_f32_16x16x32_bf16 a[156:159], a[56:59], v[40:43], a[156:159]
    ds_read_b64_tr_b16 v[40:41], v17 offset:0
    ds_read_b64_tr_b16 v[42:43], v17 offset:1024
    v_mfma_f32_16x16x32_bf16 a[156:159], a[60:63], v[44:47], a[156:159]
    s_waitcnt lgkmcnt(3)
    ds_read_b64_tr_b16 v[44:45], v17 offset:8192
    ds_read_b64_tr_b16 v[46:47], v17 offset:9216
    v_mfma_f32_16x16x32_bf16 a[160:163], a[0:3], v[48:51], a[160:163]
    v_mfma_f32_16x16x32_bf16 a[160:163], a[4:7], v[52:55], a[160:163]
    v_mfma_f32_16x16x32_bf16 a[164:167], a[8:11], v[48:51], a[164:167]
    ds_read_b128 a[108:111], v23 offset:18432
    v_mfma_f32_16x16x32_bf16 a[164:167], a[12:15], v[52:55], a[164:167]
    s_add_u32 m0, s69, 114688
    v_mfma_f32_16x16x32_bf16 a[168:171], a[16:19], v[48:51], a[168:171]
    s_xor_b32 s60, s60, 524288
    buffer_load_dwordx4 v6, s[8:11], s61 offen lds
    v_mfma_f32_16x16x32_bf16 a[168:171], a[20:23], v[52:55], a[168:171]
    v_mfma_f32_16x16x32_bf16 a[172:175], a[24:27], v[48:51], a[172:175]
    v_mfma_f32_16x16x32_bf16 a[172:175], a[28:31], v[52:55], a[172:175]
    v_mfma_f32_16x16x32_bf16 a[176:179], a[32:35], v[48:51], a[176:179]
    ds_read_b128 a[112:115], v22 offset:20480
    v_mfma_f32_16x16x32_bf16 a[176:179], a[36:39], v[52:55], a[176:179]
    v_mfma_f32_16x16x32_bf16 a[180:183], a[40:43], v[48:51], a[180:183]
    v_mfma_f32_16x16x32_bf16 a[180:183], a[44:47], v[52:55], a[180:183]
    buffer_load_dwordx4 v7, s[8:11], s61 offen offset:1024 lds
    v_mfma_f32_16x16x32_bf16 a[184:187], a[48:51], v[48:51], a[184:187]
    v_mfma_f32_16x16x32_bf16 a[184:187], a[52:55], v[52:55], a[184:187]
    ds_read_b128 a[116:119], v23 offset:20480
    v_mfma_f32_16x16x32_bf16 a[188:191], a[56:59], v[48:51], a[188:191]
    v_mfma_f32_16x16x32_bf16 a[188:191], a[60:63], v[52:55], a[188:191]
    v_mfma_f32_16x16x32_bf16 a[192:195], a[0:3], v[56:59], a[192:195]
    v_mfma_f32_16x16x32_bf16 a[192:195], a[4:7], v[60:63], a[192:195]
    v_mfma_f32_16x16x32_bf16 a[196:199], a[8:11], v[56:59], a[196:199]
    v_mfma_f32_16x16x32_bf16 a[196:199], a[12:15], v[60:63], a[196:199]
    buffer_load_dwordx4 v8, s[8:11], s61 offen offset:2048 lds
    v_mfma_f32_16x16x32_bf16 a[200:203], a[16:19], v[56:59], a[200:203]
    ds_read_b128 a[120:123], v22 offset:22528
    v_mfma_f32_16x16x32_bf16 a[200:203], a[20:23], v[60:63], a[200:203]
    v_mfma_f32_16x16x32_bf16 a[204:207], a[24:27], v[56:59], a[204:207]
    v_mfma_f32_16x16x32_bf16 a[204:207], a[28:31], v[60:63], a[204:207]
    v_mfma_f32_16x16x32_bf16 a[208:211], a[32:35], v[56:59], a[208:211]
    ds_read_b128 a[124:127], v23 offset:22528
    v_mfma_f32_16x16x32_bf16 a[208:211], a[36:39], v[60:63], a[208:211]
    v_mfma_f32_16x16x32_bf16 a[212:215], a[40:43], v[56:59], a[212:215]
    buffer_load_dwordx4 v9, s[8:11], s61 offen offset:3072 lds
    v_mfma_f32_16x16x32_bf16 a[212:215], a[44:47], v[60:63], a[212:215]
    v_mfma_f32_16x16x32_bf16 a[216:219], a[48:51], v[56:59], a[216:219]
    v_mfma_f32_16x16x32_bf16 a[216:219], a[52:55], v[60:63], a[216:219]
    v_mfma_f32_16x16x32_bf16 a[220:223], a[56:59], v[56:59], a[220:223]
    v_mfma_f32_16x16x32_bf16 a[220:223], a[60:63], v[60:63], a[220:223]
    s_waitcnt lgkmcnt(0)
    v_mfma_f32_16x16x32_bf16 a[224:227], a[0:3], v[40:43], a[224:227]
    v_mfma_f32_16x16x32_bf16 a[224:227], a[4:7], v[44:47], a[224:227]
    s_xor_b32 s61, s61, 1920
    v_mfma_f32_16x16x32_bf16 a[228:231], a[8:11], v[40:43], a[228:231]
    s_andn2_b32 s61, s61, 896
    v_mfma_f32_16x16x32_bf16 a[228:231], a[12:15], v[44:47], a[228:231]
    s_lshl_b32 s61, s5, 7
    v_mfma_f32_16x16x32_bf16 a[232:235], a[16:19], v[40:43], a[232:235]
    v_mfma_f32_16x16x32_bf16 a[232:235], a[20:23], v[44:47], a[232:235]
    s_waitcnt vmcnt(9) lgkmcnt(0)
    s_barrier
    ds_read_b64_tr_b16 v[48:49], v14 offset:32768
    v_mfma_f32_16x16x32_bf16 a[236:239], a[24:27], v[40:43], a[236:239]
    s_add_u32 m0, s69, 131072
    ds_read_b64_tr_b16 v[50:51], v14 offset:33792
    ds_read_b64_tr_b16 v[52:53], v14 offset:40960
    v_mfma_f32_16x16x32_bf16 a[236:239], a[28:31], v[44:47], a[236:239]
    buffer_load_dwordx4 v2, s[12:15], s60 offen nt lds
    v_mfma_f32_16x16x32_bf16 a[240:243], a[32:35], v[40:43], a[240:243]
    ds_read_b64_tr_b16 v[54:55], v14 offset:41984
    ds_read_b64_tr_b16 v[56:57], v15 offset:32768
    v_mfma_f32_16x16x32_bf16 a[240:243], a[36:39], v[44:47], a[240:243]
    ds_read_b64_tr_b16 v[58:59], v15 offset:33792
    ds_read_b64_tr_b16 v[60:61], v15 offset:40960
    v_mfma_f32_16x16x32_bf16 a[244:247], a[40:43], v[40:43], a[244:247]
    ds_read_b64_tr_b16 v[62:63], v15 offset:41984
    v_add_u32 v14, 0x10000, v14
    v_mfma_f32_16x16x32_bf16 a[244:247], a[44:47], v[44:47], a[244:247]
    v_add_u32 v15, 0x10000, v15
    v_mfma_f32_16x16x32_bf16 a[248:251], a[48:51], v[40:43], a[248:251]
    v_mfma_f32_16x16x32_bf16 a[248:251], a[52:55], v[44:47], a[248:251]
    buffer_load_dwordx4 v3, s[12:15], s60 offen offset:1024 nt lds
    v_mfma_f32_16x16x32_bf16 a[252:255], a[56:59], v[40:43], a[252:255]
    ds_read_b64_tr_b16 v[40:41], v16 offset:32768
    ds_read_b64_tr_b16 v[42:43], v16 offset:33792
    v_mfma_f32_16x16x32_bf16 a[252:255], a[60:63], v[44:47], a[252:255]
    s_waitcnt lgkmcnt(2)
    ds_read_b64_tr_b16 v[44:45], v16 offset:40960
    ds_read_b64_tr_b16 v[46:47], v16 offset:41984
    v_mfma_f32_16x16x32_bf16 v[128:131], v[48:51], a[64:67], v[128:131]
    v_add_u32 v16, 0x10000, v16
    v_mfma_f32_16x16x32_bf16 v[128:131], v[52:55], a[68:71], v[128:131]
    v_mfma_f32_16x16x32_bf16 v[132:135], v[48:51], a[72:75], v[132:135]
    ds_read_b128 a[0:3], v22 offset:49152
    v_mfma_f32_16x16x32_bf16 v[132:135], v[52:55], a[76:79], v[132:135]
    v_mfma_f32_16x16x32_bf16 v[136:139], v[48:51], a[80:83], v[136:139]
    v_mfma_f32_16x16x32_bf16 v[136:139], v[52:55], a[84:87], v[136:139]
    buffer_load_dwordx4 v4, s[12:15], s60 offen offset:2048 nt lds
    v_mfma_f32_16x16x32_bf16 v[140:143], v[48:51], a[88:91], v[140:143]
    v_mfma_f32_16x16x32_bf16 v[140:143], v[52:55], a[92:95], v[140:143]
    ds_read_b128 a[4:7], v23 offset:49152
    v_mfma_f32_16x16x32_bf16 v[144:147], v[48:51], a[96:99], v[144:147]
    v_mfma_f32_16x16x32_bf16 v[144:147], v[52:55], a[100:103], v[144:147]
    v_mfma_f32_16x16x32_bf16 v[148:151], v[48:51], a[104:107], v[148:151]
    v_mfma_f32_16x16x32_bf16 v[148:151], v[52:55], a[108:111], v[148:151]
    v_mfma_f32_16x16x32_bf16 v[152:155], v[48:51], a[112:115], v[152:155]
    buffer_load_dwordx4 v5, s[12:15], s60 offen offset:3072 nt lds
    v_mfma_f32_16x16x32_bf16 v[152:155], v[52:55], a[116:119], v[152:155]
    ds_read_b128 a[8:11], v22 offset:51200
    v_mfma_f32_16x16x32_bf16 v[156:159], v[48:51], a[120:123], v[156:159]
    ds_read_b64_tr_b16 v[48:49], v17 offset:32768
    ds_read_b64_tr_b16 v[50:51], v17 offset:33792
    v_mfma_f32_16x16x32_bf16 v[156:159], v[52:55], a[124:127], v[156:159]
    ds_read_b64_tr_b16 v[52:53], v17 offset:40960
    ds_read_b64_tr_b16 v[54:55], v17 offset:41984
    v_mfma_f32_16x16x32_bf16 v[160:163], v[56:59], a[64:67], v[160:163]
    v_add_u32 v17, 0x10000, v17
    v_mfma_f32_16x16x32_bf16 v[160:163], v[60:63], a[68:71], v[160:163]
    s_cmp_lt_u32 s4, 0
    s_cselect_b32 s12, 0xf149f2ca, 0
    v_mfma_f32_16x16x32_bf16 v[164:167], v[56:59], a[72:75], v[164:167]
    ds_read_b128 a[12:15], v23 offset:51200
    v_mfma_f32_16x16x32_bf16 v[164:167], v[60:63], a[76:79], v[164:167]
    s_add_u32 m0, s69, 147456
    v_mfma_f32_16x16x32_bf16 v[168:171], v[56:59], a[80:83], v[168:171]
    s_xor_b32 s60, s60, 524288
    buffer_load_dwordx4 v6, s[8:11], s62 offen lds
    v_mfma_f32_16x16x32_bf16 v[168:171], v[60:63], a[84:87], v[168:171]
    v_mov_b32 v6, v96
    v_mfma_f32_16x16x32_bf16 v[172:175], v[56:59], a[88:91], v[172:175]
    s_cmp_lt_u32 s4, 1
    s_cselect_b32 s13, 0xf149f2ca, 0
    v_mfma_f32_16x16x32_bf16 v[172:175], v[60:63], a[92:95], v[172:175]
    s_cmp_lt_u32 s4, 2
    s_cselect_b32 s14, 0xf149f2ca, 0
    v_mfma_f32_16x16x32_bf16 v[176:179], v[56:59], a[96:99], v[176:179]
    ds_read_b128 a[16:19], v22 offset:53248
    v_mfma_f32_16x16x32_bf16 v[176:179], v[60:63], a[100:103], v[176:179]
    s_cmp_lt_u32 s4, 3
    s_cselect_b32 s15, 0xf149f2ca, 0
    v_mfma_f32_16x16x32_bf16 v[180:183], v[56:59], a[104:107], v[180:183]
    v_mfma_f32_16x16x32_bf16 v[180:183], v[60:63], a[108:111], v[180:183]
    buffer_load_dwordx4 v7, s[8:11], s62 offen offset:1024 lds
    v_mfma_f32_16x16x32_bf16 v[184:187], v[56:59], a[112:115], v[184:187]
    v_mfma_f32_16x16x32_bf16 v[184:187], v[60:63], a[116:119], v[184:187]
    ds_read_b128 a[20:23], v23 offset:53248
    v_mfma_f32_16x16x32_bf16 v[188:191], v[56:59], a[120:123], v[188:191]
    s_waitcnt lgkmcnt(1)
    ds_read_b64_tr_b16 v[56:57], v14 offset:0
    ds_read_b64_tr_b16 v[58:59], v14 offset:1024
    v_mfma_f32_16x16x32_bf16 v[188:191], v[60:63], a[124:127], v[188:191]
    ds_read_b64_tr_b16 v[60:61], v14 offset:8192
    ds_read_b64_tr_b16 v[62:63], v14 offset:9216
    v_mfma_f32_16x16x32_bf16 v[192:195], v[40:43], a[64:67], v[192:195]
    v_mfma_f32_16x16x32_bf16 v[192:195], v[44:47], a[68:71], v[192:195]
    v_mfma_f32_16x16x32_bf16 v[196:199], v[40:43], a[72:75], v[196:199]
    v_mfma_f32_16x16x32_bf16 v[196:199], v[44:47], a[76:79], v[196:199]
    buffer_load_dwordx4 v8, s[8:11], s62 offen offset:2048 lds
    v_mfma_f32_16x16x32_bf16 v[200:203], v[40:43], a[80:83], v[200:203]
    ds_read_b128 a[24:27], v22 offset:55296
    v_bfe_u32 v8, v1, 4, 3
    v_mfma_f32_16x16x32_bf16 v[200:203], v[44:47], a[84:87], v[200:203]
    v_lshlrev_b32 v8, 12, v8
    v_mfma_f32_16x16x32_bf16 v[204:207], v[40:43], a[88:91], v[204:207]
    v_mfma_f32_16x16x32_bf16 v[204:207], v[44:47], a[92:95], v[204:207]
    v_mfma_f32_16x16x32_bf16 v[208:211], v[40:43], a[96:99], v[208:211]
    ds_read_b128 a[28:31], v23 offset:55296
    v_mfma_f32_16x16x32_bf16 v[208:211], v[44:47], a[100:103], v[208:211]
    v_mfma_f32_16x16x32_bf16 v[212:215], v[40:43], a[104:107], v[212:215]
    buffer_load_dwordx4 v9, s[8:11], s62 offen offset:3072 lds
    v_mfma_f32_16x16x32_bf16 v[212:215], v[44:47], a[108:111], v[212:215]
    s_and_b32 s8, s5, 7
    v_lshrrev_b32 v9, 2, v1
    v_mfma_f32_16x16x32_bf16 v[216:219], v[40:43], a[112:115], v[216:219]
    s_lshl3_add_u32 s8, s6, s8
    v_mfma_f32_16x16x32_bf16 v[216:219], v[44:47], a[116:119], v[216:219]
    s_mul_hi_u32 s98, s8, 715827883
    v_mfma_f32_16x16x32_bf16 v[220:223], v[40:43], a[120:123], v[220:223]
    s_lshr_b32 s10, s5, 3
    ds_read_b64_tr_b16 v[40:41], v15 offset:0
    ds_read_b64_tr_b16 v[42:43], v15 offset:1024
    v_mfma_f32_16x16x32_bf16 v[220:223], v[44:47], a[124:127], v[220:223]
    ds_read_b64_tr_b16 v[44:45], v15 offset:8192
    ds_read_b64_tr_b16 v[46:47], v15 offset:9216
    v_mfma_f32_16x16x32_bf16 v[224:227], v[48:51], a[64:67], v[224:227]
    s_cmp_eq_u32 s4, 3
    s_cselect_b32 s11, 1.0, 0
    v_mfma_f32_16x16x32_bf16 v[224:227], v[52:55], a[68:71], v[224:227]
    s_xor_b32 s62, s62, 1920
    v_mfma_f32_16x16x32_bf16 v[228:231], v[48:51], a[72:75], v[228:231]
    s_andn2_b32 s62, s62, 896
    buffer_load_dword v109, v103, s[24:27], s77 offen
    v_mfma_f32_16x16x32_bf16 v[228:231], v[52:55], a[76:79], v[228:231]
    v_mfma_f32_16x16x32_bf16 v[232:235], v[48:51], a[80:83], v[232:235]
    v_mfma_f32_16x16x32_bf16 v[232:235], v[52:55], a[84:87], v[232:235]
    s_add_u32 m0, s69, 0
    v_mfma_f32_16x16x32_bf16 v[236:239], v[48:51], a[88:91], v[236:239]
    buffer_load_dwordx4 v2, s[16:19], s60 offen nt lds
    v_mfma_f32_16x16x32_bf16 v[236:239], v[52:55], a[92:95], v[236:239]
    v_mfma_f32_16x16x32_bf16 v[240:243], v[48:51], a[96:99], v[240:243]
    v_mfma_f32_16x16x32_bf16 v[240:243], v[52:55], a[100:103], v[240:243]
    v_mfma_f32_16x16x32_bf16 v[244:247], v[48:51], a[104:107], v[244:247]
    v_mfma_f32_16x16x32_bf16 v[244:247], v[52:55], a[108:111], v[244:247]
    v_mfma_f32_16x16x32_bf16 v[248:251], v[48:51], a[112:115], v[248:251]
    v_mfma_f32_16x16x32_bf16 v[248:251], v[52:55], a[116:119], v[248:251]
    buffer_load_dwordx4 v3, s[16:19], s60 offen offset:1024 nt lds
    v_mfma_f32_16x16x32_bf16 v[252:255], v[48:51], a[120:123], v[252:255]
    ds_read_b64_tr_b16 v[48:49], v16 offset:0
    ds_read_b64_tr_b16 v[50:51], v16 offset:1024
    v_mfma_f32_16x16x32_bf16 v[252:255], v[52:55], a[124:127], v[252:255]
    s_waitcnt lgkmcnt(2)
    ds_read_b64_tr_b16 v[52:53], v16 offset:8192
    ds_read_b64_tr_b16 v[54:55], v16 offset:9216
    v_mfma_f32_16x16x32_bf16 a[128:131], a[64:67], v[56:59], a[128:131]
    v_mfma_f32_16x16x32_bf16 a[128:131], a[68:71], v[60:63], a[128:131]
    v_add_u32 v22, 0x10000, v22
    v_mfma_f32_16x16x32_bf16 a[132:135], a[72:75], v[56:59], a[132:135]
    ds_read_b128 a[32:35], v22 offset:16384
    v_mfma_f32_16x16x32_bf16 a[132:135], a[76:79], v[60:63], a[132:135]
    v_mfma_f32_16x16x32_bf16 a[136:139], a[80:83], v[56:59], a[136:139]
    v_mfma_f32_16x16x32_bf16 a[136:139], a[84:87], v[60:63], a[136:139]
    buffer_load_dwordx4 v4, s[16:19], s60 offen offset:2048 nt lds
    v_mfma_f32_16x16x32_bf16 a[140:143], a[88:91], v[56:59], a[140:143]
    v_add_u32 v23, 0x10000, v23
    v_mfma_f32_16x16x32_bf16 a[140:143], a[92:95], v[60:63], a[140:143]
    ds_read_b128 a[36:39], v23 offset:16384
    v_mfma_f32_16x16x32_bf16 a[144:147], a[96:99], v[56:59], a[144:147]
    v_mfma_f32_16x16x32_bf16 a[144:147], a[100:103], v[60:63], a[144:147]
    v_mfma_f32_16x16x32_bf16 a[148:151], a[104:107], v[56:59], a[148:151]
    v_mfma_f32_16x16x32_bf16 a[148:151], a[108:111], v[60:63], a[148:151]
    v_mfma_f32_16x16x32_bf16 a[152:155], a[112:115], v[56:59], a[152:155]
    buffer_load_dwordx4 v5, s[16:19], s60 offen offset:3072 nt lds
    v_mfma_f32_16x16x32_bf16 a[152:155], a[116:119], v[60:63], a[152:155]
    ds_read_b128 a[40:43], v22 offset:18432
    v_mfma_f32_16x16x32_bf16 a[156:159], a[120:123], v[56:59], a[156:159]
    ds_read_b64_tr_b16 v[56:57], v17 offset:0
    ds_read_b64_tr_b16 v[58:59], v17 offset:1024
    v_mfma_f32_16x16x32_bf16 a[156:159], a[124:127], v[60:63], a[156:159]
    ds_read_b64_tr_b16 v[60:61], v17 offset:8192
    ds_read_b64_tr_b16 v[62:63], v17 offset:9216
    v_mfma_f32_16x16x32_bf16 a[160:163], a[64:67], v[40:43], a[160:163]
    v_mfma_f32_16x16x32_bf16 a[160:163], a[68:71], v[44:47], a[160:163]
    v_mfma_f32_16x16x32_bf16 a[164:167], a[72:75], v[40:43], a[164:167]
    ds_read_b128 a[44:47], v23 offset:18432
    v_mfma_f32_16x16x32_bf16 a[164:167], a[76:79], v[44:47], a[164:167]
    s_add_u32 m0, s69, 16384
    v_mfma_f32_16x16x32_bf16 a[168:171], a[80:83], v[40:43], a[168:171]
    s_xor_b32 s60, s60, 524288
    buffer_load_dwordx4 v10, s[20:23], s63 offen lds
    v_mfma_f32_16x16x32_bf16 a[168:171], a[84:87], v[44:47], a[168:171]
    v_mfma_f32_16x16x32_bf16 a[172:175], a[88:91], v[40:43], a[172:175]
    v_mfma_f32_16x16x32_bf16 a[172:175], a[92:95], v[44:47], a[172:175]
    v_mfma_f32_16x16x32_bf16 a[176:179], a[96:99], v[40:43], a[176:179]
    ds_read_b128 a[48:51], v22 offset:20480
    v_mfma_f32_16x16x32_bf16 a[176:179], a[100:103], v[44:47], a[176:179]
    v_mfma_f32_16x16x32_bf16 a[180:183], a[104:107], v[40:43], a[180:183]
    v_mfma_f32_16x16x32_bf16 a[180:183], a[108:111], v[44:47], a[180:183]
    buffer_load_dwordx4 v11, s[20:23], s63 offen offset:1024 lds
    v_mfma_f32_16x16x32_bf16 a[184:187], a[112:115], v[40:43], a[184:187]
    v_mfma_f32_16x16x32_bf16 a[184:187], a[116:119], v[44:47], a[184:187]
    ds_read_b128 a[52:55], v23 offset:20480
    v_mfma_f32_16x16x32_bf16 a[188:191], a[120:123], v[40:43], a[188:191]
    v_mfma_f32_16x16x32_bf16 a[188:191], a[124:127], v[44:47], a[188:191]
    s_waitcnt lgkmcnt(1)
    v_mfma_f32_16x16x32_bf16 a[192:195], a[64:67], v[48:51], a[192:195]
    v_mfma_f32_16x16x32_bf16 a[192:195], a[68:71], v[52:55], a[192:195]
    v_mfma_f32_16x16x32_bf16 a[196:199], a[72:75], v[48:51], a[196:199]
    v_mfma_f32_16x16x32_bf16 a[196:199], a[76:79], v[52:55], a[196:199]
    buffer_load_dwordx4 v12, s[20:23], s63 offen offset:2048 lds
    v_mfma_f32_16x16x32_bf16 a[200:203], a[80:83], v[48:51], a[200:203]
    ds_read_b128 a[56:59], v22 offset:22528
    v_mfma_f32_16x16x32_bf16 a[200:203], a[84:87], v[52:55], a[200:203]
    v_mfma_f32_16x16x32_bf16 a[204:207], a[88:91], v[48:51], a[204:207]
    v_mfma_f32_16x16x32_bf16 a[204:207], a[92:95], v[52:55], a[204:207]
    v_mfma_f32_16x16x32_bf16 a[208:211], a[96:99], v[48:51], a[208:211]
    ds_read_b128 a[60:63], v23 offset:22528
    v_mfma_f32_16x16x32_bf16 a[208:211], a[100:103], v[52:55], a[208:211]
    v_mfma_f32_16x16x32_bf16 a[212:215], a[104:107], v[48:51], a[212:215]
    buffer_load_dwordx4 v13, s[20:23], s63 offen offset:3072 lds
    v_mfma_f32_16x16x32_bf16 a[212:215], a[108:111], v[52:55], a[212:215]
    v_mfma_f32_16x16x32_bf16 a[216:219], a[112:115], v[48:51], a[216:219]
    v_mfma_f32_16x16x32_bf16 a[216:219], a[116:119], v[52:55], a[216:219]
    v_mfma_f32_16x16x32_bf16 a[220:223], a[120:123], v[48:51], a[220:223]
    v_mfma_f32_16x16x32_bf16 a[220:223], a[124:127], v[52:55], a[220:223]
    v_mfma_f32_16x16x32_bf16 a[224:227], a[64:67], v[56:59], a[224:227]
    v_mfma_f32_16x16x32_bf16 a[224:227], a[68:71], v[60:63], a[224:227]
    s_xor_b32 s63, s63, 128
    v_mfma_f32_16x16x32_bf16 a[228:231], a[72:75], v[56:59], a[228:231]
    v_mfma_f32_16x16x32_bf16 a[228:231], a[76:79], v[60:63], a[228:231]
    v_mfma_f32_16x16x32_bf16 a[232:235], a[80:83], v[56:59], a[232:235]
    v_mfma_f32_16x16x32_bf16 a[232:235], a[84:87], v[60:63], a[232:235]
    s_waitcnt vmcnt(9) lgkmcnt(0)
    s_barrier
    ds_read_b64_tr_b16 v[40:41], v14 offset:32768
    v_mfma_f32_16x16x32_bf16 a[236:239], a[88:91], v[56:59], a[236:239]
    s_add_u32 m0, s69, 32768
    ds_read_b64_tr_b16 v[42:43], v14 offset:33792
    ds_read_b64_tr_b16 v[44:45], v14 offset:40960
    v_mfma_f32_16x16x32_bf16 a[236:239], a[92:95], v[60:63], a[236:239]
    buffer_load_dwordx4 v2, s[16:19], s60 offen nt lds
    v_mfma_f32_16x16x32_bf16 a[240:243], a[96:99], v[56:59], a[240:243]
    ds_read_b64_tr_b16 v[46:47], v14 offset:41984
    ds_read_b64_tr_b16 v[48:49], v15 offset:32768
    v_mfma_f32_16x16x32_bf16 a[240:243], a[100:103], v[60:63], a[240:243]
    ds_read_b64_tr_b16 v[50:51], v15 offset:33792
    ds_read_b64_tr_b16 v[52:53], v15 offset:40960
    v_mfma_f32_16x16x32_bf16 a[244:247], a[104:107], v[56:59], a[244:247]
    ds_read_b64_tr_b16 v[54:55], v15 offset:41984
    v_add_u32 v14, 0x10000, v14
    v_mfma_f32_16x16x32_bf16 a[244:247], a[108:111], v[60:63], a[244:247]
    v_add_u32 v15, 0x10000, v15
    v_mfma_f32_16x16x32_bf16 a[248:251], a[112:115], v[56:59], a[248:251]
    v_mfma_f32_16x16x32_bf16 a[248:251], a[116:119], v[60:63], a[248:251]
    buffer_load_dwordx4 v3, s[16:19], s60 offen offset:1024 nt lds
    v_mfma_f32_16x16x32_bf16 a[252:255], a[120:123], v[56:59], a[252:255]
    ds_read_b64_tr_b16 v[56:57], v16 offset:32768
    ds_read_b64_tr_b16 v[58:59], v16 offset:33792
    v_mfma_f32_16x16x32_bf16 a[252:255], a[124:127], v[60:63], a[252:255]
    s_waitcnt lgkmcnt(2)
    ds_read_b64_tr_b16 v[60:61], v16 offset:40960
    ds_read_b64_tr_b16 v[62:63], v16 offset:41984
    v_mfma_f32_16x16x32_bf16 v[128:131], v[40:43], a[0:3], v[128:131]
    v_add_u32 v16, 0x10000, v16
    v_mfma_f32_16x16x32_bf16 v[128:131], v[44:47], a[4:7], v[128:131]
    ds_read_b128 a[64:67], v22 offset:49152
    v_mfma_f32_16x16x32_bf16 v[132:135], v[40:43], a[8:11], v[132:135]
    v_mfma_f32_16x16x32_bf16 v[132:135], v[44:47], a[12:15], v[132:135]
    v_mfma_f32_16x16x32_bf16 v[136:139], v[40:43], a[16:19], v[136:139]
    ds_read_b128 a[68:71], v23 offset:49152
    v_mfma_f32_16x16x32_bf16 v[136:139], v[44:47], a[20:23], v[136:139]
    buffer_load_dwordx4 v4, s[16:19], s60 offen offset:2048 nt lds
    v_mfma_f32_16x16x32_bf16 v[140:143], v[40:43], a[24:27], v[140:143]
    v_mfma_f32_16x16x32_bf16 v[140:143], v[44:47], a[28:31], v[140:143]
    ds_read_b128 a[72:75], v22 offset:51200
    v_mfma_f32_16x16x32_bf16 v[144:147], v[40:43], a[32:35], v[144:147]
    v_mfma_f32_16x16x32_bf16 v[144:147], v[44:47], a[36:39], v[144:147]
    v_mfma_f32_16x16x32_bf16 v[148:151], v[40:43], a[40:43], v[148:151]
    ds_read_b128 a[76:79], v23 offset:51200
    v_mfma_f32_16x16x32_bf16 v[148:151], v[44:47], a[44:47], v[148:151]
    v_mfma_f32_16x16x32_bf16 v[152:155], v[40:43], a[48:51], v[152:155]
    buffer_load_dwordx4 v5, s[16:19], s60 offen offset:3072 nt lds
    v_mfma_f32_16x16x32_bf16 v[152:155], v[44:47], a[52:55], v[152:155]
    v_mfma_f32_16x16x32_bf16 v[156:159], v[40:43], a[56:59], v[156:159]
    ds_read_b128 a[80:83], v22 offset:53248
    ds_read_b64_tr_b16 v[40:41], v17 offset:32768
    v_mfma_f32_16x16x32_bf16 v[156:159], v[44:47], a[60:63], v[156:159]
    ds_read_b64_tr_b16 v[42:43], v17 offset:33792
    ds_read_b64_tr_b16 v[44:45], v17 offset:40960
    v_mfma_f32_16x16x32_bf16 v[160:163], v[48:51], a[0:3], v[160:163]
    ds_read_b64_tr_b16 v[46:47], v17 offset:41984
    v_add_u32 v17, 0x10000, v17
    v_mfma_f32_16x16x32_bf16 v[160:163], v[52:55], a[4:7], v[160:163]
    ds_read_b128 a[84:87], v23 offset:53248
    v_mfma_f32_16x16x32_bf16 v[164:167], v[48:51], a[8:11], v[164:167]
    v_mfma_f32_16x16x32_bf16 v[164:167], v[52:55], a[12:15], v[164:167]
    s_add_u32 m0, s69, 49152
    buffer_load_dword v7, v9, s[44:47], s69 offen sc1
    v_mfma_f32_16x16x32_bf16 v[168:171], v[48:51], a[16:19], v[168:171]
    s_xor_b32 s60, s60, 3670016
    buffer_load_dwordx4 v10, s[20:23], s64 offen lds
    v_mfma_f32_16x16x32_bf16 v[168:171], v[52:55], a[20:23], v[168:171]
    ds_read_b128 a[88:91], v22 offset:55296
    v_mfma_f32_16x16x32_bf16 v[172:175], v[48:51], a[24:27], v[172:175]
    v_mfma_f32_16x16x32_bf16 v[172:175], v[52:55], a[28:31], v[172:175]
    s_waitcnt lgkmcnt(1)
    ds_read_b128 a[92:95], v23 offset:55296
    v_mfma_f32_16x16x32_bf16 v[176:179], v[48:51], a[32:35], v[176:179]
    v_mfma_f32_16x16x32_bf16 v[176:179], v[52:55], a[36:39], v[176:179]
    v_mfma_f32_16x16x32_bf16 v[180:183], v[48:51], a[40:43], v[180:183]
    v_mfma_f32_16x16x32_bf16 v[180:183], v[52:55], a[44:47], v[180:183]
    buffer_load_dwordx4 v11, s[20:23], s64 offen offset:1024 lds
    v_mfma_f32_16x16x32_bf16 v[184:187], v[48:51], a[48:51], v[184:187]
    v_add_u32 v22, 0x10000, v22
    ds_read_b128 a[96:99], v22 offset:16384
    v_mfma_f32_16x16x32_bf16 v[184:187], v[52:55], a[52:55], v[184:187]
    v_mfma_f32_16x16x32_bf16 v[188:191], v[48:51], a[56:59], v[188:191]
    v_add_u32 v23, 0x10000, v23
    ds_read_b64_tr_b16 v[48:49], v14 offset:0
    v_mfma_f32_16x16x32_bf16 v[188:191], v[52:55], a[60:63], v[188:191]
    ds_read_b128 a[100:103], v23 offset:16384
    ds_read_b64_tr_b16 v[50:51], v14 offset:1024
    v_mfma_f32_16x16x32_bf16 v[192:195], v[56:59], a[0:3], v[192:195]
    ds_read_b64_tr_b16 v[52:53], v14 offset:8192
    ds_read_b64_tr_b16 v[54:55], v14 offset:9216
    v_mfma_f32_16x16x32_bf16 v[192:195], v[60:63], a[4:7], v[192:195]
    v_add_u32 v14, 0xfffe0000, v14
    v_mfma_f32_16x16x32_bf16 v[196:199], v[56:59], a[8:11], v[196:199]
    ds_read_b128 a[104:107], v22 offset:18432
    v_mfma_f32_16x16x32_bf16 v[196:199], v[60:63], a[12:15], v[196:199]
    buffer_load_dwordx4 v12, s[20:23], s64 offen offset:2048 lds
    v_mfma_f32_16x16x32_bf16 v[200:203], v[56:59], a[16:19], v[200:203]
    v_mfma_f32_16x16x32_bf16 v[200:203], v[60:63], a[20:23], v[200:203]
    ds_read_b128 a[108:111], v23 offset:18432
    v_mfma_f32_16x16x32_bf16 v[204:207], v[56:59], a[24:27], v[204:207]
    v_mfma_f32_16x16x32_bf16 v[204:207], v[60:63], a[28:31], v[204:207]
    v_mfma_f32_16x16x32_bf16 v[208:211], v[56:59], a[32:35], v[208:211]
    v_mfma_f32_16x16x32_bf16 v[208:211], v[60:63], a[36:39], v[208:211]
    ds_read_b128 a[112:115], v22 offset:20480
    v_mfma_f32_16x16x32_bf16 v[212:215], v[56:59], a[40:43], v[212:215]
    buffer_load_dwordx4 v13, s[20:23], s64 offen offset:3072 lds
    v_mfma_f32_16x16x32_bf16 v[212:215], v[60:63], a[44:47], v[212:215]
    v_mfma_f32_16x16x32_bf16 v[216:219], v[56:59], a[48:51], v[216:219]
    ds_read_b128 a[116:119], v23 offset:20480
    v_mfma_f32_16x16x32_bf16 v[216:219], v[60:63], a[52:55], v[216:219]
    v_mfma_f32_16x16x32_bf16 v[220:223], v[56:59], a[56:59], v[220:223]
    ds_read_b64_tr_b16 v[56:57], v15 offset:0
    ds_read_b64_tr_b16 v[58:59], v15 offset:1024
    v_mfma_f32_16x16x32_bf16 v[220:223], v[60:63], a[60:63], v[220:223]
    s_waitcnt lgkmcnt(3)
    ds_read_b128 a[120:123], v22 offset:22528
    ds_read_b64_tr_b16 v[60:61], v15 offset:8192
    v_mfma_f32_16x16x32_bf16 v[224:227], v[40:43], a[0:3], v[224:227]
    ds_read_b64_tr_b16 v[62:63], v15 offset:9216
    v_add_u32 v15, 0xfffe0000, v15
    v_mfma_f32_16x16x32_bf16 v[224:227], v[44:47], a[4:7], v[224:227]
    s_xor_b32 s64, s64, 128
    v_mov_b32 v22, v100
    v_add_u32 v22, 0x10000, v22
    v_mfma_f32_16x16x32_bf16 v[228:231], v[40:43], a[8:11], v[228:231]
    ds_read_b128 a[124:127], v23 offset:22528
    v_mov_b32 v23, v101
    v_mfma_f32_16x16x32_bf16 v[228:231], v[44:47], a[12:15], v[228:231]
    v_add_u32 v23, 0x10000, v23
    v_mfma_f32_16x16x32_bf16 v[232:235], v[40:43], a[16:19], v[232:235]
    v_mfma_f32_16x16x32_bf16 v[232:235], v[44:47], a[20:23], v[232:235]
    s_add_u32 m0, s69, 65536
    v_mfma_f32_16x16x32_bf16 v[236:239], v[40:43], a[24:27], v[236:239]
    buffer_load_dwordx4 v2, s[24:27], s60 offen lds
    v_mfma_f32_16x16x32_bf16 v[236:239], v[44:47], a[28:31], v[236:239]
    v_mfma_f32_16x16x32_bf16 v[240:243], v[40:43], a[32:35], v[240:243]
    v_mfma_f32_16x16x32_bf16 v[240:243], v[44:47], a[36:39], v[240:243]
    v_mfma_f32_16x16x32_bf16 v[244:247], v[40:43], a[40:43], v[244:247]
    v_mfma_f32_16x16x32_bf16 v[244:247], v[44:47], a[44:47], v[244:247]
    v_mfma_f32_16x16x32_bf16 v[248:251], v[40:43], a[48:51], v[248:251]
    v_mfma_f32_16x16x32_bf16 v[248:251], v[44:47], a[52:55], v[248:251]
    buffer_load_dwordx4 v3, s[24:27], s60 offen offset:1024 lds
    v_mfma_f32_16x16x32_bf16 v[252:255], v[40:43], a[56:59], v[252:255]
    ds_read_b64_tr_b16 v[40:41], v16 offset:0
    ds_read_b64_tr_b16 v[42:43], v16 offset:1024
    v_mfma_f32_16x16x32_bf16 v[252:255], v[44:47], a[60:63], v[252:255]
    ds_read_b64_tr_b16 v[44:45], v16 offset:8192
    ds_read_b64_tr_b16 v[46:47], v16 offset:9216
    v_mfma_f32_16x16x32_bf16 v[128:131], v[48:51], a[64:67], v[128:131]
    v_add_u32 v16, 0xfffe0000, v16
    v_mfma_f32_16x16x32_bf16 v[128:131], v[52:55], a[68:71], v[128:131]
    v_mfma_f32_16x16x32_bf16 v[132:135], v[48:51], a[72:75], v[132:135]
    v_mfma_f32_16x16x32_bf16 v[132:135], v[52:55], a[76:79], v[132:135]
    v_mfma_f32_16x16x32_bf16 v[136:139], v[48:51], a[80:83], v[136:139]
    v_mfma_f32_16x16x32_bf16 v[136:139], v[52:55], a[84:87], v[136:139]
    buffer_load_dwordx4 v4, s[24:27], s60 offen offset:2048 lds
    v_mfma_f32_16x16x32_bf16 v[140:143], v[48:51], a[88:91], v[140:143]
    v_mfma_f32_16x16x32_bf16 v[140:143], v[52:55], a[92:95], v[140:143]
    v_mfma_f32_16x16x32_bf16 v[144:147], v[48:51], a[96:99], v[144:147]
    v_mul_f32 v128, s74, v128
    v_mul_f32 v129, s74, v129
    v_mfma_f32_16x16x32_bf16 v[144:147], v[52:55], a[100:103], v[144:147]
    v_mul_f32 v130, s74, v130
    v_mul_f32 v131, s74, v131
    v_mfma_f32_16x16x32_bf16 v[148:151], v[48:51], a[104:107], v[148:151]
    v_cvt_pk_bf16_f32 v128, v128, v129
    v_cvt_pk_bf16_f32 v129, v130, v131
    v_mfma_f32_16x16x32_bf16 v[148:151], v[52:55], a[108:111], v[148:151]
    v_mul_f32 v132, s74, v132
    v_mul_f32 v133, s74, v133
    v_mfma_f32_16x16x32_bf16 v[152:155], v[48:51], a[112:115], v[152:155]
    s_waitcnt lgkmcnt(0)
    buffer_load_dwordx4 v5, s[24:27], s60 offen offset:3072 lds
    v_mfma_f32_16x16x32_bf16 v[152:155], v[52:55], a[116:119], v[152:155]
    v_mul_f32 v134, s74, v134
    v_mul_f32 v135, s74, v135
    v_mfma_f32_16x16x32_bf16 v[156:159], v[48:51], a[120:123], v[156:159]
    ds_read_b64_tr_b16 v[48:49], v17 offset:0
    ds_read_b64_tr_b16 v[50:51], v17 offset:1024
    v_mfma_f32_16x16x32_bf16 v[156:159], v[52:55], a[124:127], v[156:159]
    ds_read_b64_tr_b16 v[52:53], v17 offset:8192
    ds_read_b64_tr_b16 v[54:55], v17 offset:9216
    v_mfma_f32_16x16x32_bf16 v[160:163], v[56:59], a[64:67], v[160:163]
    v_add_u32 v17, 0xfffe0000, v17
    v_cvt_pk_bf16_f32 v132, v132, v133
    v_mfma_f32_16x16x32_bf16 v[160:163], v[60:63], a[68:71], v[160:163]
    v_cvt_pk_bf16_f32 v133, v134, v135
    v_mul_f32 v136, s74, v136
    v_mfma_f32_16x16x32_bf16 v[164:167], v[56:59], a[72:75], v[164:167]
    v_mul_f32 v137, s74, v137
    v_mul_f32 v138, s74, v138
    v_mfma_f32_16x16x32_bf16 v[164:167], v[60:63], a[76:79], v[164:167]
    s_add_u32 m0, s69, 81920
    v_mul_f32 v139, s74, v139
    v_mul_f32 v160, s74, v160
    v_mfma_f32_16x16x32_bf16 v[168:171], v[56:59], a[80:83], v[168:171]
    s_xor_b32 s60, s60, 524288
    buffer_load_dwordx4 v10, s[20:23], s63 offen lds
    v_mfma_f32_16x16x32_bf16 v[168:171], v[60:63], a[84:87], v[168:171]
    v_mul_f32 v161, s74, v161
    v_mul_f32 v162, s74, v162
    v_mfma_f32_16x16x32_bf16 v[172:175], v[56:59], a[88:91], v[172:175]
    v_mul_f32 v163, s74, v163
    v_cvt_pk_bf16_f32 v130, v160, v161
    v_mfma_f32_16x16x32_bf16 v[172:175], v[60:63], a[92:95], v[172:175]
    v_cvt_pk_bf16_f32 v131, v162, v163
    v_mul_f32 v164, s74, v164
    v_mfma_f32_16x16x32_bf16 v[176:179], v[56:59], a[96:99], v[176:179]
    v_mul_f32 v165, s74, v165
    v_mul_f32 v166, s74, v166
    v_mfma_f32_16x16x32_bf16 v[176:179], v[60:63], a[100:103], v[176:179]
    v_mul_f32 v167, s74, v167
    v_cvt_pk_bf16_f32 v134, v164, v165
    v_mfma_f32_16x16x32_bf16 v[180:183], v[56:59], a[104:107], v[180:183]
    v_cvt_pk_bf16_f32 v135, v166, v167
    v_mul_f32 v168, s74, v168
    v_mfma_f32_16x16x32_bf16 v[180:183], v[60:63], a[108:111], v[180:183]
    buffer_load_dwordx4 v11, s[20:23], s63 offen offset:1024 lds
    v_mfma_f32_16x16x32_bf16 v[184:187], v[56:59], a[112:115], v[184:187]
    v_mul_f32 v169, s74, v169
    v_mul_f32 v170, s74, v170
    v_mfma_f32_16x16x32_bf16 v[184:187], v[60:63], a[116:119], v[184:187]
    v_mul_f32 v171, s74, v171
    v_cvt_pk_bf16_f32 v136, v136, v137
    v_mfma_f32_16x16x32_bf16 v[188:191], v[56:59], a[120:123], v[188:191]
    v_cvt_pk_bf16_f32 v137, v138, v139
    v_cvt_pk_bf16_f32 v138, v168, v169
    v_mfma_f32_16x16x32_bf16 v[188:191], v[60:63], a[124:127], v[188:191]
    v_cvt_pk_bf16_f32 v139, v170, v171
    v_mul_f32 v140, s74, v140
    v_mfma_f32_16x16x32_bf16 v[192:195], v[40:43], a[64:67], v[192:195]
    v_mul_f32 v141, s74, v141
    v_mul_f32 v142, s74, v142
    v_mfma_f32_16x16x32_bf16 v[192:195], v[44:47], a[68:71], v[192:195]
    v_mul_f32 v143, s74, v143
    v_mul_f32 v172, s74, v172
    v_mfma_f32_16x16x32_bf16 v[196:199], v[40:43], a[72:75], v[196:199]
    v_mul_f32 v173, s74, v173
    v_mul_f32 v174, s74, v174
    v_mfma_f32_16x16x32_bf16 v[196:199], v[44:47], a[76:79], v[196:199]
    buffer_load_dwordx4 v12, s[20:23], s63 offen offset:2048 lds
    v_mfma_f32_16x16x32_bf16 v[200:203], v[40:43], a[80:83], v[200:203]
    v_mul_f32 v175, s74, v175
    v_cvt_pk_bf16_f32 v140, v140, v141
    v_mfma_f32_16x16x32_bf16 v[200:203], v[44:47], a[84:87], v[200:203]
    v_cvt_pk_bf16_f32 v141, v142, v143
    v_cvt_pk_bf16_f32 v142, v172, v173
    v_mfma_f32_16x16x32_bf16 v[204:207], v[40:43], a[88:91], v[204:207]
    v_cvt_pk_bf16_f32 v143, v174, v175
    v_mul_f32 v144, s74, v144
    v_mfma_f32_16x16x32_bf16 v[204:207], v[44:47], a[92:95], v[204:207]
    v_mul_f32 v145, s74, v145
    v_mul_f32 v146, s74, v146
    v_mfma_f32_16x16x32_bf16 v[208:211], v[40:43], a[96:99], v[208:211]
    v_mul_f32 v147, s74, v147
    v_mul_f32 v176, s74, v176
    v_mfma_f32_16x16x32_bf16 v[208:211], v[44:47], a[100:103], v[208:211]
    v_mul_f32 v177, s74, v177
    v_mul_f32 v178, s74, v178
    v_mfma_f32_16x16x32_bf16 v[212:215], v[40:43], a[104:107], v[212:215]
    buffer_load_dwordx4 v13, s[20:23], s63 offen offset:3072 lds
    v_mfma_f32_16x16x32_bf16 v[212:215], v[44:47], a[108:111], v[212:215]
    v_mul_f32 v179, s74, v179
    v_cvt_pk_bf16_f32 v144, v144, v145
    v_mfma_f32_16x16x32_bf16 v[216:219], v[40:43], a[112:115], v[216:219]
    v_cvt_pk_bf16_f32 v145, v146, v147
    v_cvt_pk_bf16_f32 v146, v176, v177
    v_mfma_f32_16x16x32_bf16 v[216:219], v[44:47], a[116:119], v[216:219]
    v_cvt_pk_bf16_f32 v147, v178, v179
    v_mul_f32 v148, s74, v148
    v_mfma_f32_16x16x32_bf16 v[220:223], v[40:43], a[120:123], v[220:223]
    v_mul_f32 v149, s74, v149
    v_mul_f32 v150, s74, v150
    v_mfma_f32_16x16x32_bf16 v[220:223], v[44:47], a[124:127], v[220:223]
    s_add_u32 s72, s70, 0
    v_mul_f32 v151, s74, v151
    v_mul_f32 v180, s74, v180
    s_waitcnt lgkmcnt(0)
    v_mfma_f32_16x16x32_bf16 v[224:227], v[48:51], a[64:67], v[224:227]
    buffer_store_dwordx4 v[128:131], v1, s[36:39], s72 offen sc1
    v_mfma_f32_16x16x32_bf16 v[224:227], v[52:55], a[68:71], v[224:227]
    s_xor_b32 s63, s63, 384
    v_mul_f32 v181, s74, v181
    v_mul_f32 v182, s74, v182
    v_mfma_f32_16x16x32_bf16 v[228:231], v[48:51], a[72:75], v[228:231]
    v_mul_f32 v183, s74, v183
    v_cvt_pk_bf16_f32 v148, v148, v149
    v_mfma_f32_16x16x32_bf16 v[228:231], v[52:55], a[76:79], v[228:231]
    v_cvt_pk_bf16_f32 v149, v150, v151
    v_cvt_pk_bf16_f32 v150, v180, v181
    v_mfma_f32_16x16x32_bf16 v[232:235], v[48:51], a[80:83], v[232:235]
    v_cvt_pk_bf16_f32 v151, v182, v183
    v_mul_f32 v152, s74, v152
    v_mfma_f32_16x16x32_bf16 v[232:235], v[52:55], a[84:87], v[232:235]
    s_add_u32 m0, s67, 98304
    v_mul_f32 v153, s74, v153
    v_mul_f32 v154, s74, v154
    s_waitcnt vmcnt(9) lgkmcnt(0)
    v_cmp_gt_u32 vcc, 8, v7
    s_nop 1
    s_and_b64 vcc, vcc, s[86:87]
    s_cbranch_scc1 SPIN_WA
BACK_WA:
    s_barrier
    v_mfma_f32_16x16x32_bf16 v[236:239], v[48:51], a[88:91], v[236:239]
    buffer_load_dwordx4 v1, s[28:31], s65 offen sc1 lds
    v_mfma_f32_16x16x32_bf16 v[236:239], v[52:55], a[92:95], v[236:239]
    ds_read_b64_tr_b16 v[56:57], v14 offset:0
    ds_read_b64_tr_b16 v[58:59], v14 offset:1024
    v_mfma_f32_16x16x32_bf16 v[240:243], v[48:51], a[96:99], v[240:243]
    ds_read_b64_tr_b16 v[60:61], v14 offset:8192
    ds_read_b64_tr_b16 v[62:63], v14 offset:9216
    v_mfma_f32_16x16x32_bf16 v[240:243], v[52:55], a[100:103], v[240:243]
    ds_read_b64_tr_b16 v[40:41], v15 offset:0
    ds_read_b64_tr_b16 v[42:43], v15 offset:1024
    v_mfma_f32_16x16x32_bf16 v[244:247], v[48:51], a[104:107], v[244:247]
    ds_read_b64_tr_b16 v[44:45], v15 offset:8192
    ds_read_b64_tr_b16 v[46:47], v15 offset:9216
    v_mfma_f32_16x16x32_bf16 v[244:247], v[52:55], a[108:111], v[244:247]
    v_mul_f32 v155, s74, v155
    v_mul_f32 v184, s74, v184
    v_mfma_f32_16x16x32_bf16 v[248:251], v[48:51], a[112:115], v[248:251]
    v_mul_f32 v185, s74, v185
    v_mul_f32 v186, s74, v186
    v_mfma_f32_16x16x32_bf16 v[248:251], v[52:55], a[116:119], v[248:251]
    v_mul_f32 v187, s74, v187
    v_cvt_pk_bf16_f32 v152, v152, v153
    v_mfma_f32_16x16x32_bf16 v[252:255], v[48:51], a[120:123], v[252:255]
    s_lshr_b32 s92, s2, 3
    buffer_load_dwordx4 v1, s[28:31], s65 offen offset:1024 sc1 lds
    v_mfma_f32_16x16x32_bf16 v[252:255], v[52:55], a[124:127], v[252:255]
    s_lshl2_add_u32 s92, s92, s4
    v_lshrrev_b32 v9, 4, v1
    v_min_u32 v9, 0, v9
    s_waitcnt lgkmcnt(0)
    v_mfma_f32_16x16x32_bf16 a[128:131], a[0:3], v[56:59], a[128:131]
    s_mul_i32 s92, s92, 1
    ds_read_b64_tr_b16 v[48:49], v16 offset:0
    ds_read_b64_tr_b16 v[50:51], v16 offset:1024
    v_mfma_f32_16x16x32_bf16 a[128:131], a[4:7], v[60:63], a[128:131]
    s_add_u32 s92, s92, 32
    v_add_lshl_u32 v9, v9, s92, 7
    ds_read_b64_tr_b16 v[52:53], v16 offset:8192
    v_mfma_f32_16x16x32_bf16 a[132:135], a[8:11], v[56:59], a[132:135]
    s_getpc_b64 s[92:93]
    global_load_dword v9, v9, s[92:93]
    v_mfma_f32_16x16x32_bf16 a[132:135], a[12:15], v[60:63], a[132:135]
    ds_read_b128 v[64:67], v24 offset:16384
    ds_read_b64_tr_b16 v[54:55], v16 offset:9216
    v_mfma_f32_16x16x32_bf16 a[136:139], a[16:19], v[56:59], a[136:139]
    v_cvt_pk_bf16_f32 v153, v154, v155
    v_cvt_pk_bf16_f32 v154, v184, v185
    v_mfma_f32_16x16x32_bf16 a[136:139], a[20:23], v[60:63], a[136:139]
    v_cvt_pk_bf16_f32 v155, v186, v187
    v_mul_f32 v156, s74, v156
    v_mfma_f32_16x16x32_bf16 a[140:143], a[24:27], v[56:59], a[140:143]
    s_add_u32 m0, s68, 106496
    v_mul_f32 v157, s74, v157
    v_mul_f32 v158, s74, v158
    v_mfma_f32_16x16x32_bf16 a[140:143], a[28:31], v[60:63], a[140:143]
    buffer_load_dwordx4 v6, s[20:23], s66 offen lds
    v_mfma_f32_16x16x32_bf16 a[144:147], a[32:35], v[56:59], a[144:147]
    s_add_u32 s72, s70, 4096
    v_mul_f32 v159, s74, v159
    v_mul_f32 v188, s74, v188
    v_mfma_f32_16x16x32_bf16 a[144:147], a[36:39], v[60:63], a[144:147]
    buffer_store_dwordx4 v[132:135], v1, s[36:39], s72 offen sc1
    v_mfma_f32_16x16x32_bf16 a[148:151], a[40:43], v[56:59], a[148:151]
    v_mul_f32 v189, s74, v189
    v_mul_f32 v190, s74, v190
    v_mfma_f32_16x16x32_bf16 a[148:151], a[44:47], v[60:63], a[148:151]
    v_mul_f32 v191, s74, v191
    v_cvt_pk_bf16_f32 v156, v156, v157
    v_mfma_f32_16x16x32_bf16 a[152:155], a[48:51], v[56:59], a[152:155]
    v_cvt_pk_bf16_f32 v157, v158, v159
    v_cvt_pk_bf16_f32 v158, v188, v189
    v_mfma_f32_16x16x32_bf16 a[152:155], a[52:55], v[60:63], a[152:155]
    ds_read_b128 v[68:71], v25 offset:16384
    v_cvt_pk_bf16_f32 v159, v190, v191
    v_mfma_f32_16x16x32_bf16 a[156:159], a[56:59], v[56:59], a[156:159]
    s_add_u32 m0, s69, 114688
    ds_read_b64_tr_b16 v[56:57], v17 offset:0
    ds_read_b64_tr_b16 v[58:59], v17 offset:1024
    v_mfma_f32_16x16x32_bf16 a[156:159], a[60:63], v[60:63], a[156:159]
    s_xor_b32 s65, s65, 8192
    buffer_load_dwordx4 v10, s[20:23], s64 offen lds
    v_mfma_f32_16x16x32_bf16 a[160:163], a[0:3], v[40:43], a[160:163]
    s_xor_b32 s66, s66, 128
    ds_read_b64_tr_b16 v[60:61], v17 offset:8192
    ds_read_b64_tr_b16 v[62:63], v17 offset:9216
    v_mfma_f32_16x16x32_bf16 a[160:163], a[4:7], v[44:47], a[160:163]
    v_mul_f32 v192, s74, v192
    v_mul_f32 v193, s74, v193
    v_mfma_f32_16x16x32_bf16 a[164:167], a[8:11], v[40:43], a[164:167]
    v_mul_f32 v194, s74, v194
    v_mul_f32 v195, s74, v195
    v_mfma_f32_16x16x32_bf16 a[164:167], a[12:15], v[44:47], a[164:167]
    v_mul_f32 v224, s74, v224
    v_mul_f32 v225, s74, v225
    v_mfma_f32_16x16x32_bf16 a[168:171], a[16:19], v[40:43], a[168:171]
    v_mul_f32 v226, s74, v226
    v_mul_f32 v227, s74, v227
    v_mfma_f32_16x16x32_bf16 a[168:171], a[20:23], v[44:47], a[168:171]
    v_cvt_pk_bf16_f32 v192, v192, v193
    v_cvt_pk_bf16_f32 v193, v194, v195
    v_mfma_f32_16x16x32_bf16 a[172:175], a[24:27], v[40:43], a[172:175]
    v_cvt_pk_bf16_f32 v194, v224, v225
    v_cvt_pk_bf16_f32 v195, v226, v227
    v_mfma_f32_16x16x32_bf16 a[172:175], a[28:31], v[44:47], a[172:175]
    v_mul_f32 v196, s74, v196
    v_mul_f32 v197, s74, v197
    v_mfma_f32_16x16x32_bf16 a[176:179], a[32:35], v[40:43], a[176:179]
    buffer_load_dwordx4 v11, s[20:23], s64 offen offset:1024 lds
    v_mfma_f32_16x16x32_bf16 a[176:179], a[36:39], v[44:47], a[176:179]
    ds_read_b128 v[72:75], v24 offset:24576
    v_mul_f32 v198, s74, v198
    v_mfma_f32_16x16x32_bf16 a[180:183], a[40:43], v[40:43], a[180:183]
    v_mul_f32 v199, s74, v199
    v_mul_f32 v228, s74, v228
    v_mfma_f32_16x16x32_bf16 a[180:183], a[44:47], v[44:47], a[180:183]
    v_mul_f32 v229, s74, v229
    v_mul_f32 v230, s74, v230
    v_mfma_f32_16x16x32_bf16 a[184:187], a[48:51], v[40:43], a[184:187]
    v_mul_f32 v231, s74, v231
    v_cvt_pk_bf16_f32 v196, v196, v197
    v_mfma_f32_16x16x32_bf16 a[184:187], a[52:55], v[44:47], a[184:187]
    v_cvt_pk_bf16_f32 v197, v198, v199
    v_cvt_pk_bf16_f32 v198, v228, v229
    v_mfma_f32_16x16x32_bf16 a[188:191], a[56:59], v[40:43], a[188:191]
    ds_read_b64_tr_b16 v[40:41], v14 offset:32768
    ds_read_b64_tr_b16 v[42:43], v14 offset:33792
    v_mfma_f32_16x16x32_bf16 a[188:191], a[60:63], v[44:47], a[188:191]
    s_waitcnt lgkmcnt(2)
    ds_read_b64_tr_b16 v[44:45], v14 offset:40960
    ds_read_b64_tr_b16 v[46:47], v14 offset:41984
    v_mfma_f32_16x16x32_bf16 a[192:195], a[0:3], v[48:51], a[192:195]
    buffer_load_dwordx4 v12, s[20:23], s64 offen offset:2048 lds
    v_mfma_f32_16x16x32_bf16 a[192:195], a[4:7], v[52:55], a[192:195]
    s_add_u32 s72, s70, 8192
    v_xor_b32 v14, s73, v14
    v_add_u32 v14, 0x10000, v14
    v_mfma_f32_16x16x32_bf16 a[196:199], a[8:11], v[48:51], a[196:199]
    buffer_store_dwordx4 v[136:139], v1, s[36:39], s72 offen sc1
    v_mfma_f32_16x16x32_bf16 a[196:199], a[12:15], v[52:55], a[196:199]
    ds_read_b128 v[76:79], v25 offset:24576
    v_cvt_pk_bf16_f32 v199, v230, v231
    v_mfma_f32_16x16x32_bf16 a[200:203], a[16:19], v[48:51], a[200:203]
    v_mul_f32 v200, s74, v200
    v_mul_f32 v201, s74, v201
    v_mfma_f32_16x16x32_bf16 a[200:203], a[20:23], v[52:55], a[200:203]
    v_mul_f32 v202, s74, v202
    v_mul_f32 v203, s74, v203
    v_mfma_f32_16x16x32_bf16 a[204:207], a[24:27], v[48:51], a[204:207]
    v_mul_f32 v232, s74, v232
    v_mul_f32 v233, s74, v233
    v_mfma_f32_16x16x32_bf16 a[204:207], a[28:31], v[52:55], a[204:207]
    v_mul_f32 v234, s74, v234
    v_mul_f32 v235, s74, v235
    v_mfma_f32_16x16x32_bf16 a[208:211], a[32:35], v[48:51], a[208:211]
    v_cvt_pk_bf16_f32 v200, v200, v201
    v_cvt_pk_bf16_f32 v201, v202, v203
    v_mfma_f32_16x16x32_bf16 a[208:211], a[36:39], v[52:55], a[208:211]
    buffer_load_dwordx4 v13, s[20:23], s64 offen offset:3072 lds
    v_mfma_f32_16x16x32_bf16 a[212:215], a[40:43], v[48:51], a[212:215]
    v_cvt_pk_bf16_f32 v202, v232, v233
    v_cvt_pk_bf16_f32 v203, v234, v235
    v_mfma_f32_16x16x32_bf16 a[212:215], a[44:47], v[52:55], a[212:215]
    v_mul_f32 v204, s74, v204
    v_mul_f32 v205, s74, v205
    v_mfma_f32_16x16x32_bf16 a[216:219], a[48:51], v[48:51], a[216:219]
    v_mul_f32 v206, s74, v206
    v_mul_f32 v207, s74, v207
    v_mfma_f32_16x16x32_bf16 a[216:219], a[52:55], v[52:55], a[216:219]
    v_mul_f32 v236, s74, v236
    v_mul_f32 v237, s74, v237
    v_mfma_f32_16x16x32_bf16 a[220:223], a[56:59], v[48:51], a[220:223]
    ds_read_b64_tr_b16 v[48:49], v15 offset:32768
    ds_read_b64_tr_b16 v[50:51], v15 offset:33792
    v_mfma_f32_16x16x32_bf16 a[220:223], a[60:63], v[52:55], a[220:223]
    ds_read_b64_tr_b16 v[52:53], v15 offset:40960
    ds_read_b64_tr_b16 v[54:55], v15 offset:41984
    v_mfma_f32_16x16x32_bf16 a[224:227], a[0:3], v[56:59], a[224:227]
    v_xor_b32 v15, s73, v15
    v_add_u32 v15, 0x10000, v15
    v_mfma_f32_16x16x32_bf16 a[224:227], a[4:7], v[60:63], a[224:227]
    s_xor_b32 s64, s64, 384
    v_accvgpr_write_b32 a4, v192
    v_accvgpr_write_b32 a5, v193
    v_mfma_f32_16x16x32_bf16 a[228:231], a[8:11], v[56:59], a[228:231]
    v_accvgpr_write_b32 a6, v194
    v_accvgpr_write_b32 a7, v195
    v_mfma_f32_16x16x32_bf16 a[228:231], a[12:15], v[60:63], a[228:231]
    v_accvgpr_write_b32 a12, v196
    v_accvgpr_write_b32 a13, v197
    v_mfma_f32_16x16x32_bf16 a[232:235], a[16:19], v[56:59], a[232:235]
    v_accvgpr_write_b32 a14, v198
    v_accvgpr_write_b32 a15, v199
    v_mfma_f32_16x16x32_bf16 a[232:235], a[20:23], v[60:63], a[232:235]
    s_add_u32 m0, s69, 131072
    v_mul_f32 v238, s74, v238
    v_mul_f32 v239, s74, v239
    v_mfma_f32_16x16x32_bf16 a[236:239], a[24:27], v[56:59], a[236:239]
    buffer_load_dwordx4 v2, s[24:27], s60 offen lds
    v_mfma_f32_16x16x32_bf16 a[236:239], a[28:31], v[60:63], a[236:239]
    v_accvgpr_write_b32 a20, v200
    v_accvgpr_write_b32 a21, v201
    v_mfma_f32_16x16x32_bf16 a[240:243], a[32:35], v[56:59], a[240:243]
    v_accvgpr_write_b32 a22, v202
    v_accvgpr_write_b32 a23, v203
    v_mfma_f32_16x16x32_bf16 a[240:243], a[36:39], v[60:63], a[240:243]
    v_cvt_pk_bf16_f32 v204, v204, v205
    v_cvt_pk_bf16_f32 v205, v206, v207
    v_mfma_f32_16x16x32_bf16 a[244:247], a[40:43], v[56:59], a[244:247]
    s_add_u32 s72, s70, 12288
    v_accvgpr_write_b32 a40, v148
    v_accvgpr_write_b32 a41, v149
    v_mfma_f32_16x16x32_bf16 a[244:247], a[44:47], v[60:63], a[244:247]
    buffer_store_dwordx4 v[140:143], v1, s[36:39], s72 offen sc1
    v_mfma_f32_16x16x32_bf16 a[248:251], a[48:51], v[56:59], a[248:251]
    v_accvgpr_write_b32 a42, v150
    v_accvgpr_write_b32 a43, v151
    v_mfma_f32_16x16x32_bf16 a[248:251], a[52:55], v[60:63], a[248:251]
    buffer_load_dwordx4 v3, s[24:27], s60 offen offset:1024 lds
    v_mfma_f32_16x16x32_bf16 a[252:255], a[56:59], v[56:59], a[252:255]
    ds_read_b64_tr_b16 v[56:57], v16 offset:32768
    ds_read_b64_tr_b16 v[58:59], v16 offset:33792
    v_mfma_f32_16x16x32_bf16 a[252:255], a[60:63], v[60:63], a[252:255]
    s_waitcnt lgkmcnt(2)
    ds_read_b64_tr_b16 v[60:61], v16 offset:40960
    ds_read_b64_tr_b16 v[62:63], v16 offset:41984
    v_mfma_f32_16x16x32_bf16 a[128:131], a[64:67], v[40:43], a[128:131]
    v_xor_b32 v16, s73, v16
    v_add_u32 v16, 0x10000, v16
    v_mfma_f32_16x16x32_bf16 a[128:131], a[68:71], v[44:47], a[128:131]
    v_accvgpr_write_b32 a48, v152
    v_accvgpr_write_b32 a49, v153
    v_mfma_f32_16x16x32_bf16 a[132:135], a[72:75], v[40:43], a[132:135]
    ds_read_b128 v[80:83], v24 offset:49152
    v_accvgpr_write_b32 a50, v154
    v_mfma_f32_16x16x32_bf16 a[132:135], a[76:79], v[44:47], a[132:135]
    v_accvgpr_write_b32 a51, v155
    v_accvgpr_write_b32 a56, v156
    v_mfma_f32_16x16x32_bf16 a[136:139], a[80:83], v[40:43], a[136:139]
    v_accvgpr_write_b32 a57, v157
    v_accvgpr_write_b32 a58, v158
    v_mfma_f32_16x16x32_bf16 a[136:139], a[84:87], v[44:47], a[136:139]
    buffer_load_dwordx4 v4, s[24:27], s60 offen offset:2048 lds
    v_mfma_f32_16x16x32_bf16 a[140:143], a[88:91], v[40:43], a[140:143]
    v_accvgpr_write_b32 a59, v159
    v_cvt_pk_bf16_f32 v206, v236, v237
    v_mfma_f32_16x16x32_bf16 a[140:143], a[92:95], v[44:47], a[140:143]
    v_cvt_pk_bf16_f32 v207, v238, v239
    v_mul_f32 v208, s74, v208
    v_mfma_f32_16x16x32_bf16 a[144:147], a[96:99], v[40:43], a[144:147]
    v_mul_f32 v209, s74, v209
    v_mul_f32 v210, s74, v210
    v_mfma_f32_16x16x32_bf16 a[144:147], a[100:103], v[44:47], a[144:147]
    v_mul_f32 v211, s74, v211
    v_mul_f32 v240, s74, v240
    v_mfma_f32_16x16x32_bf16 a[148:151], a[104:107], v[40:43], a[148:151]
    v_mul_f32 v241, s74, v241
    v_mul_f32 v242, s74, v242
    v_mfma_f32_16x16x32_bf16 a[148:151], a[108:111], v[44:47], a[148:151]
    v_mul_f32 v243, s74, v243
    v_accvgpr_write_b32 a28, v204
    v_mfma_f32_16x16x32_bf16 a[152:155], a[112:115], v[40:43], a[152:155]
    buffer_load_dwordx4 v5, s[24:27], s60 offen offset:3072 lds
    v_mfma_f32_16x16x32_bf16 a[152:155], a[116:119], v[44:47], a[152:155]
    ds_read_b128 v[84:87], v25 offset:49152
    v_accvgpr_write_b32 a29, v205
    v_mfma_f32_16x16x32_bf16 a[156:159], a[120:123], v[40:43], a[156:159]
    ds_read_b64_tr_b16 v[40:41], v17 offset:32768
    ds_read_b64_tr_b16 v[42:43], v17 offset:33792
    v_mfma_f32_16x16x32_bf16 a[156:159], a[124:127], v[44:47], a[156:159]
    ds_read_b64_tr_b16 v[44:45], v17 offset:40960
    ds_read_b64_tr_b16 v[46:47], v17 offset:41984
    v_mfma_f32_16x16x32_bf16 a[160:163], a[64:67], v[48:51], a[160:163]
    v_xor_b32 v17, s73, v17
    v_add_u32 v17, 0x10000, v17
    v_mfma_f32_16x16x32_bf16 a[160:163], a[68:71], v[52:55], a[160:163]
    v_accvgpr_write_b32 a30, v206
    v_accvgpr_write_b32 a31, v207
    v_mfma_f32_16x16x32_bf16 a[164:167], a[72:75], v[48:51], a[164:167]
    v_cvt_pk_bf16_f32 v208, v208, v209
    v_cvt_pk_bf16_f32 v209, v210, v211
    v_mfma_f32_16x16x32_bf16 a[164:167], a[76:79], v[52:55], a[164:167]
    s_add_u32 m0, s69, 147456
    v_cvt_pk_bf16_f32 v210, v240, v241
    v_cvt_pk_bf16_f32 v211, v242, v243
    v_mfma_f32_16x16x32_bf16 a[168:171], a[80:83], v[48:51], a[168:171]
    s_xor_b32 s60, s60, 1572864
    buffer_load_dwordx4 v10, s[20:23], s63 offen lds
    v_mfma_f32_16x16x32_bf16 a[168:171], a[84:87], v[52:55], a[168:171]
    s_add_u32 s72, s70, 32768
    buffer_store_dwordx4 v[144:147], v1, s[36:39], s72 offen sc1
    v_mfma_f32_16x16x32_bf16 a[172:175], a[88:91], v[48:51], a[172:175]
    v_mul_f32 v212, s74, v212
    v_mul_f32 v213, s74, v213
    v_mfma_f32_16x16x32_bf16 a[172:175], a[92:95], v[52:55], a[172:175]
    v_mul_f32 v214, s74, v214
    v_mul_f32 v215, s74, v215
    v_mfma_f32_16x16x32_bf16 a[176:179], a[96:99], v[48:51], a[176:179]
    ds_read_b128 v[88:91], v24 offset:57344
    v_mul_f32 v244, s74, v244
    v_mfma_f32_16x16x32_bf16 a[176:179], a[100:103], v[52:55], a[176:179]
    v_mul_f32 v245, s74, v245
    v_mul_f32 v246, s74, v246
    v_mfma_f32_16x16x32_bf16 a[180:183], a[104:107], v[48:51], a[180:183]
    v_mul_f32 v247, s74, v247
    v_accvgpr_write_b32 a36, v208
    v_mfma_f32_16x16x32_bf16 a[180:183], a[108:111], v[52:55], a[180:183]
    buffer_load_dwordx4 v11, s[20:23], s63 offen offset:1024 lds
    v_mfma_f32_16x16x32_bf16 a[184:187], a[112:115], v[48:51], a[184:187]
    v_accvgpr_write_b32 a37, v209
    v_accvgpr_write_b32 a38, v210
    v_mfma_f32_16x16x32_bf16 a[184:187], a[116:119], v[52:55], a[184:187]
    v_accvgpr_write_b32 a39, v211
    v_cvt_pk_bf16_f32 v212, v212, v213
    v_mfma_f32_16x16x32_bf16 a[188:191], a[120:123], v[48:51], a[188:191]
    v_cvt_pk_bf16_f32 v213, v214, v215
    v_cvt_pk_bf16_f32 v214, v244, v245
    v_mfma_f32_16x16x32_bf16 a[188:191], a[124:127], v[52:55], a[188:191]
    s_waitcnt lgkmcnt(0)
    v_cvt_pk_bf16_f32 v215, v246, v247
    v_mul_f32 v216, s74, v216
    v_mfma_f32_16x16x32_bf16 a[192:195], a[64:67], v[56:59], a[192:195]
    v_mul_f32 v217, s74, v217
    v_mul_f32 v218, s74, v218
    v_mfma_f32_16x16x32_bf16 a[192:195], a[68:71], v[60:63], a[192:195]
    v_accvgpr_read_b32 v32, a128
    v_accvgpr_read_b32 v31, a129
    v_mfma_f32_16x16x32_bf16 a[196:199], a[72:75], v[56:59], a[196:199]
    v_cvt_pk_bf16_f32 v32, v32, v31
    v_accvgpr_read_b32 v33, a130
    v_mfma_f32_16x16x32_bf16 a[196:199], a[76:79], v[60:63], a[196:199]
    buffer_load_dwordx4 v12, s[20:23], s63 offen offset:2048 lds
    v_mfma_f32_16x16x32_bf16 a[200:203], a[80:83], v[56:59], a[200:203]
    ds_read_b128 v[92:95], v25 offset:57344
    v_accvgpr_read_b32 v31, a131
    v_mfma_f32_16x16x32_bf16 a[200:203], a[84:87], v[60:63], a[200:203]
    v_cvt_pk_bf16_f32 v33, v33, v31
    v_accvgpr_read_b32 v34, a132
    v_mfma_f32_16x16x32_bf16 a[204:207], a[88:91], v[56:59], a[204:207]
    v_accvgpr_read_b32 v31, a133
    v_cvt_pk_bf16_f32 v34, v34, v31
    v_mfma_f32_16x16x32_bf16 a[204:207], a[92:95], v[60:63], a[204:207]
    v_accvgpr_read_b32 v35, a134
    v_accvgpr_read_b32 v31, a135
    v_mfma_f32_16x16x32_bf16 a[208:211], a[96:99], v[56:59], a[208:211]
    v_cvt_pk_bf16_f32 v35, v35, v31
    v_mul_f32 v219, s74, v219
    v_mfma_f32_16x16x32_bf16 a[208:211], a[100:103], v[60:63], a[208:211]
    v_mul_f32 v248, s74, v248
    v_mul_f32 v249, s74, v249
    v_mfma_f32_16x16x32_bf16 a[212:215], a[104:107], v[56:59], a[212:215]
    buffer_load_dwordx4 v13, s[20:23], s63 offen offset:3072 lds
    v_mfma_f32_16x16x32_bf16 a[212:215], a[108:111], v[60:63], a[212:215]
    v_mul_f32 v250, s74, v250
    v_mul_f32 v251, s74, v251
    v_mfma_f32_16x16x32_bf16 a[216:219], a[112:115], v[56:59], a[216:219]
    s_add_u32 s72, s71, 0
    v_accvgpr_write_b32 a44, v212
    v_accvgpr_write_b32 a45, v213
    v_mfma_f32_16x16x32_bf16 a[216:219], a[116:119], v[60:63], a[216:219]
    buffer_store_dwordx4 v[32:35], v1, s[36:39], s72 offen sc1
    v_mfma_f32_16x16x32_bf16 a[220:223], a[120:123], v[56:59], a[220:223]
    v_accvgpr_write_b32 a46, v214
    v_accvgpr_write_b32 a47, v215
    v_mfma_f32_16x16x32_bf16 a[220:223], a[124:127], v[60:63], a[220:223]
    v_cvt_pk_bf16_f32 v216, v216, v217
    v_cvt_pk_bf16_f32 v217, v218, v219
    v_mfma_f32_16x16x32_bf16 a[224:227], a[64:67], v[40:43], a[224:227]
    v_cvt_pk_bf16_f32 v218, v248, v249
    v_cvt_pk_bf16_f32 v219, v250, v251
    v_mfma_f32_16x16x32_bf16 a[224:227], a[68:71], v[44:47], a[224:227]
    s_xor_b32 s63, s63, 128
    v_mul_f32 v220, s74, v220
    v_mul_f32 v221, s74, v221
    v_mfma_f32_16x16x32_bf16 a[228:231], a[72:75], v[40:43], a[228:231]
    v_mul_f32 v222, s74, v222
    v_mul_f32 v223, s74, v223
    v_mfma_f32_16x16x32_bf16 a[228:231], a[76:79], v[44:47], a[228:231]
    v_mul_f32 v252, s74, v252
    v_mul_f32 v253, s74, v253
    v_mfma_f32_16x16x32_bf16 a[232:235], a[80:83], v[40:43], a[232:235]
    v_mul_f32 v254, s74, v254
    v_mul_f32 v255, s74, v255
    v_mfma_f32_16x16x32_bf16 a[232:235], a[84:87], v[44:47], a[232:235]
    s_waitcnt vmcnt(11) lgkmcnt(0)
    s_barrier
    ds_read_b64_tr_b16 v[48:49], v14 offset:0
    v_mfma_f32_16x16x32_bf16 a[236:239], a[88:91], v[40:43], a[236:239]
    s_add_u32 m0, s67, 0
    ds_read_b64_tr_b16 v[50:51], v14 offset:1024
    ds_read_b64_tr_b16 v[52:53], v14 offset:8192
    v_mfma_f32_16x16x32_bf16 a[236:239], a[92:95], v[44:47], a[236:239]
    buffer_load_dwordx4 v1, s[28:31], s65 offen sc1 lds
    v_mfma_f32_16x16x32_bf16 a[240:243], a[96:99], v[40:43], a[240:243]
    ds_read_b64_tr_b16 v[54:55], v14 offset:9216
    ds_read_b64_tr_b16 v[56:57], v15 offset:0
    v_mfma_f32_16x16x32_bf16 a[240:243], a[100:103], v[44:47], a[240:243]
    ds_read_b64_tr_b16 v[58:59], v15 offset:1024
    ds_read_b64_tr_b16 v[60:61], v15 offset:8192
    v_mfma_f32_16x16x32_bf16 a[244:247], a[104:107], v[40:43], a[244:247]
    ds_read_b64_tr_b16 v[62:63], v15 offset:9216
    v_add_u32 v14, 0x10000, v14
    v_mfma_f32_16x16x32_bf16 a[244:247], a[108:111], v[44:47], a[244:247]
    v_add_u32 v15, 0x10000, v15
    v_accvgpr_read_b32 v32, a136
    v_mfma_f32_16x16x32_bf16 a[248:251], a[112:115], v[40:43], a[248:251]
    v_accvgpr_read_b32 v31, a137
    v_cvt_pk_bf16_f32 v32, v32, v31
    v_mfma_f32_16x16x32_bf16 a[248:251], a[116:119], v[44:47], a[248:251]
    v_accvgpr_read_b32 v33, a138
    v_accvgpr_read_b32 v31, a139
    v_mfma_f32_16x16x32_bf16 a[252:255], a[120:123], v[40:43], a[252:255]
    buffer_load_dwordx4 v1, s[28:31], s65 offen offset:1024 sc1 lds
    v_mfma_f32_16x16x32_bf16 a[252:255], a[124:127], v[44:47], a[252:255]
    s_waitcnt lgkmcnt(0)
    ds_read_b64_tr_b16 v[40:41], v16 offset:0
    ds_read_b64_tr_b16 v[42:43], v16 offset:1024
    v_mfma_f32_16x16x32_bf16 v[128:131], v[48:51], v[64:67], 0
    ds_read_b64_tr_b16 v[44:45], v16 offset:8192
    ds_read_b64_tr_b16 v[46:47], v16 offset:9216
    v_mfma_f32_16x16x32_bf16 v[128:131], v[52:55], v[68:71], v[128:131]
    v_add_u32 v24, 0x10000, v24
    ds_read_b128 a[136:139], v22 offset:32768
    v_mfma_f32_16x16x32_bf16 v[132:135], v[48:51], v[72:75], 0
    ds_read_b128 v[96:99], v24 offset:16384
    v_add_u32 v16, 0x10000, v16
    v_mfma_f32_16x16x32_bf16 v[132:135], v[52:55], v[76:79], v[132:135]
    v_add_u32 v22, 0xffff0000, v22
    v_cvt_pk_bf16_f32 v33, v33, v31
    v_mfma_f32_16x16x32_bf16 v[136:139], v[48:51], v[80:83], 0
    v_accvgpr_read_b32 v34, a140
    v_accvgpr_read_b32 v31, a141
    v_mfma_f32_16x16x32_bf16 v[136:139], v[52:55], v[84:87], v[136:139]
    s_add_u32 s72, s71, 1024
    v_cvt_pk_bf16_f32 v34, v34, v31
    v_accvgpr_read_b32 v35, a142
    v_mfma_f32_16x16x32_bf16 v[140:143], v[48:51], v[88:91], 0
    s_add_u32 m0, s68, 8192
    ds_read_b64_tr_b16 v[48:49], v17 offset:0
    ds_read_b64_tr_b16 v[50:51], v17 offset:1024
    v_mfma_f32_16x16x32_bf16 v[140:143], v[52:55], v[92:95], v[140:143]
    buffer_load_dwordx4 v6, s[20:23], s66 offen lds
    v_mfma_f32_16x16x32_bf16 v[144:147], v[56:59], v[64:67], 0
    ds_read_b64_tr_b16 v[52:53], v17 offset:8192
    ds_read_b64_tr_b16 v[54:55], v17 offset:9216
    v_mfma_f32_16x16x32_bf16 v[144:147], v[60:63], v[68:71], v[144:147]
    v_add_u32 v17, 0x10000, v17
    v_accvgpr_read_b32 v31, a143
    v_mfma_f32_16x16x32_bf16 v[148:151], v[56:59], v[72:75], 0
    ds_read_b128 a[140:143], v23 offset:32768
    v_add_u32 v23, 0xffff0000, v23
    v_mfma_f32_16x16x32_bf16 v[148:151], v[60:63], v[76:79], v[148:151]
    v_cvt_pk_bf16_f32 v35, v35, v31
    v_accvgpr_write_b32 a52, v216
    v_mfma_f32_16x16x32_bf16 v[152:155], v[56:59], v[80:83], 0
    v_add_u32 v25, 0x10000, v25
    v_accvgpr_write_b32 a53, v217
    v_mfma_f32_16x16x32_bf16 v[152:155], v[60:63], v[84:87], v[152:155]
    ds_read_b128 v[100:103], v25 offset:16384
    v_accvgpr_write_b32 a54, v218
    v_mfma_f32_16x16x32_bf16 v[156:159], v[56:59], v[88:91], 0
    s_add_u32 m0, s69, 16384
    ds_read_b64_tr_b16 v[56:57], v18 offset:0
    ds_read_b64_tr_b16 v[58:59], v18 offset:1024
    v_mfma_f32_16x16x32_bf16 v[156:159], v[60:63], v[92:95], v[156:159]
    s_xor_b32 s65, s65, 24576
    buffer_load_dwordx4 v10, s[20:23], s64 offen lds
    s_waitcnt lgkmcnt(3)
    v_mfma_f32_16x16x32_bf16 v[160:163], v[40:43], v[64:67], 0
    s_xor_b32 s66, s66, 384
    ds_read_b64_tr_b16 v[60:61], v18 offset:8192
    ds_read_b64_tr_b16 v[62:63], v18 offset:9216
    v_mfma_f32_16x16x32_bf16 v[160:163], v[44:47], v[68:71], v[160:163]
    v_add_u32 v18, 0x10000, v18
    v_accvgpr_write_b32 a55, v219
    v_mfma_f32_16x16x32_bf16 v[164:167], v[40:43], v[72:75], 0
    buffer_store_dwordx4 v[32:35], v1, s[36:39], s72 offen sc1
    v_mfma_f32_16x16x32_bf16 v[164:167], v[44:47], v[76:79], v[164:167]
    v_cvt_pk_bf16_f32 v220, v220, v221
    v_cvt_pk_bf16_f32 v221, v222, v223
    v_mfma_f32_16x16x32_bf16 v[168:171], v[40:43], v[80:83], 0
    v_cvt_pk_bf16_f32 v222, v252, v253
    v_cvt_pk_bf16_f32 v223, v254, v255
    v_mfma_f32_16x16x32_bf16 v[168:171], v[44:47], v[84:87], v[168:171]
    v_accvgpr_write_b32 a60, v220
    v_accvgpr_write_b32 a61, v221
    v_mfma_f32_16x16x32_bf16 v[172:175], v[40:43], v[88:91], 0
    ds_read_b64_tr_b16 v[40:41], v19 offset:0
    ds_read_b64_tr_b16 v[42:43], v19 offset:1024
    v_mfma_f32_16x16x32_bf16 v[172:175], v[44:47], v[92:95], v[172:175]
    ds_read_b64_tr_b16 v[44:45], v19 offset:8192
    ds_read_b64_tr_b16 v[46:47], v19 offset:9216
    v_mfma_f32_16x16x32_bf16 v[176:179], v[48:51], v[64:67], 0
    buffer_load_dwordx4 v11, s[20:23], s64 offen offset:1024 lds
    v_mfma_f32_16x16x32_bf16 v[176:179], v[52:55], v[68:71], v[176:179]
    ds_read_b128 v[104:107], v24 offset:24576
    v_add_u32 v19, 0x10000, v19
    v_mfma_f32_16x16x32_bf16 v[180:183], v[48:51], v[72:75], 0
    v_accvgpr_write_b32 a62, v222
    v_accvgpr_write_b32 a63, v223
    v_mfma_f32_16x16x32_bf16 v[180:183], v[52:55], v[76:79], v[180:183]
    v_accvgpr_write_b32 a0, 0
    v_accvgpr_write_b32 a1, 0
    v_mfma_f32_16x16x32_bf16 v[184:187], v[48:51], v[80:83], 0
    v_accvgpr_write_b32 a2, 0
    v_accvgpr_write_b32 a3, 0
    v_mfma_f32_16x16x32_bf16 v[184:187], v[52:55], v[84:87], v[184:187]
    v_accvgpr_write_b32 a8, 0
    v_accvgpr_write_b32 a9, 0
    v_mfma_f32_16x16x32_bf16 v[188:191], v[48:51], v[88:91], 0
    s_add_u32 s72, s70, 36864
    ds_read_b64_tr_b16 v[48:49], v20 offset:0
    ds_read_b64_tr_b16 v[50:51], v20 offset:1024
    v_mfma_f32_16x16x32_bf16 v[188:191], v[52:55], v[92:95], v[188:191]
    s_waitcnt lgkmcnt(2)
    ds_read_b64_tr_b16 v[52:53], v20 offset:8192
    ds_read_b64_tr_b16 v[54:55], v20 offset:9216
    v_mfma_f32_16x16x32_bf16 v[192:195], v[56:59], v[64:67], 0
    buffer_load_dwordx4 v12, s[20:23], s64 offen offset:2048 lds
    v_mfma_f32_16x16x32_bf16 v[192:195], v[60:63], v[68:71], v[192:195]
    v_add_u32 v20, 0x10000, v20
    v_accvgpr_write_b32 a10, 0
    v_mfma_f32_16x16x32_bf16 v[196:199], v[56:59], v[72:75], 0
    buffer_store_dwordx4 a[40:43], v1, s[36:39], s72 offen sc1
    v_mfma_f32_16x16x32_bf16 v[196:199], v[60:63], v[76:79], v[196:199]
    ds_read_b128 v[108:111], v25 offset:24576
    v_accvgpr_write_b32 a11, 0
    v_mfma_f32_16x16x32_bf16 v[200:203], v[56:59], v[80:83], 0
    v_accvgpr_write_b32 a16, 0
    v_accvgpr_write_b32 a17, 0
    v_mfma_f32_16x16x32_bf16 v[200:203], v[60:63], v[84:87], v[200:203]
    v_accvgpr_write_b32 a18, 0
    v_accvgpr_write_b32 a19, 0
    v_mfma_f32_16x16x32_bf16 v[204:207], v[56:59], v[88:91], 0
    ds_read_b64_tr_b16 v[56:57], v21 offset:0
    ds_read_b64_tr_b16 v[58:59], v21 offset:1024
    v_mfma_f32_16x16x32_bf16 v[204:207], v[60:63], v[92:95], v[204:207]
    ds_read_b64_tr_b16 v[60:61], v21 offset:8192
    ds_read_b64_tr_b16 v[62:63], v21 offset:9216
    v_mfma_f32_16x16x32_bf16 v[208:211], v[40:43], v[64:67], 0
    v_add_u32 v21, 0x10000, v21
    v_accvgpr_write_b32 a24, 0
    v_mfma_f32_16x16x32_bf16 v[208:211], v[44:47], v[68:71], v[208:211]
    buffer_load_dwordx4 v13, s[20:23], s64 offen offset:3072 lds
    v_mfma_f32_16x16x32_bf16 v[212:215], v[40:43], v[72:75], 0
    v_accvgpr_write_b32 a25, 0
    v_accvgpr_write_b32 a26, 0
    v_mfma_f32_16x16x32_bf16 v[212:215], v[44:47], v[76:79], v[212:215]
    v_accvgpr_write_b32 a27, 0
    v_accvgpr_write_b32 a32, 0
    v_mfma_f32_16x16x32_bf16 v[216:219], v[40:43], v[80:83], 0
    v_accvgpr_write_b32 a33, 0
    v_accvgpr_write_b32 a34, 0
    v_mfma_f32_16x16x32_bf16 v[216:219], v[44:47], v[84:87], v[216:219]
    v_accvgpr_write_b32 a35, 0
    v_accvgpr_write_b32 a40, 0
    v_mfma_f32_16x16x32_bf16 v[220:223], v[40:43], v[88:91], 0
    ds_read_b64_tr_b16 v[40:41], v26 offset:32768
    ds_read_b64_tr_b16 v[42:43], v26 offset:33280
    v_mfma_f32_16x16x32_bf16 v[220:223], v[44:47], v[92:95], v[220:223]
    s_waitcnt lgkmcnt(2)
    ds_read_b64_tr_b16 v[44:45], v26 offset:36864
    ds_read_b64_tr_b16 v[46:47], v26 offset:37376
    v_mfma_f32_16x16x32_bf16 v[224:227], v[48:51], v[64:67], 0
    v_add_u32 v26, 0xffff0000, v26
    v_accvgpr_write_b32 a41, 0
    v_mfma_f32_16x16x32_bf16 v[224:227], v[52:55], v[68:71], v[224:227]
    s_xor_b32 s64, s64, 128
    v_accvgpr_write_b32 a42, 0
    v_accvgpr_write_b32 a43, 0
    v_mfma_f32_16x16x32_bf16 v[228:231], v[48:51], v[72:75], 0
    v_mfma_f32_16x16x32_bf16 v[228:231], v[52:55], v[76:79], v[228:231]
    v_mfma_f32_16x16x32_bf16 v[232:235], v[48:51], v[80:83], 0
    v_mfma_f32_16x16x32_bf16 v[232:235], v[52:55], v[84:87], v[232:235]
    s_add_u32 m0, s69, 32768
    v_mfma_f32_16x16x32_bf16 v[236:239], v[48:51], v[88:91], 0
    buffer_load_dwordx4 v2, s[24:27], s60 offen lds
    v_mfma_f32_16x16x32_bf16 v[236:239], v[52:55], v[92:95], v[236:239]
    s_add_u32 s72, s70, 40960
    ds_read_b64_tr_b16 v[48:49], v27 offset:32768
    ds_read_b64_tr_b16 v[50:51], v27 offset:33280
    v_mfma_f32_16x16x32_bf16 v[240:243], v[56:59], v[64:67], 0
    ds_read_b64_tr_b16 v[52:53], v27 offset:36864
    ds_read_b64_tr_b16 v[54:55], v27 offset:37376
    v_mfma_f32_16x16x32_bf16 v[240:243], v[60:63], v[68:71], v[240:243]
    buffer_store_dwordx4 a[48:51], v1, s[36:39], s72 offen sc1
    v_mfma_f32_16x16x32_bf16 v[244:247], v[56:59], v[72:75], 0
    buffer_load_dwordx4 v3, s[24:27], s60 offen offset:1024 lds
    v_mfma_f32_16x16x32_bf16 v[244:247], v[60:63], v[76:79], v[244:247]
    v_add_u32 v27, 0xffff0000, v27
    v_accvgpr_write_b32 a48, 0
    v_mfma_f32_16x16x32_bf16 v[248:251], v[56:59], v[80:83], 0
    v_accvgpr_write_b32 a49, 0
    v_accvgpr_write_b32 a50, 0
    v_mfma_f32_16x16x32_bf16 v[248:251], v[60:63], v[84:87], v[248:251]
    v_accvgpr_write_b32 a51, 0
    v_mfma_f32_16x16x32_bf16 v[252:255], v[56:59], v[88:91], 0
    buffer_load_dwordx4 v4, s[24:27], s60 offen offset:2048 lds
    v_mfma_f32_16x16x32_bf16 v[252:255], v[60:63], v[92:95], v[252:255]
    s_waitcnt lgkmcnt(0)
    ds_read_b64_tr_b16 v[56:57], v28 offset:32768
    ds_read_b64_tr_b16 v[58:59], v28 offset:33280
    v_mfma_f32_16x16x32_bf16 a[64:67], v[40:43], v[64:67], 0
    ds_read_b64_tr_b16 v[60:61], v28 offset:36864
    ds_read_b64_tr_b16 v[62:63], v28 offset:37376
    v_mfma_f32_16x16x32_bf16 a[64:67], v[44:47], v[68:71], a[64:67]
    v_add_u32 v28, 0xffff0000, v28
    v_mfma_f32_16x16x32_bf16 a[68:71], v[40:43], v[72:75], 0
    buffer_load_dwordx4 v5, s[24:27], s60 offen offset:3072 lds
    v_mfma_f32_16x16x32_bf16 a[68:71], v[44:47], v[76:79], a[68:71]
    ds_read_b128 v[112:115], v24 offset:49152
    v_mfma_f32_16x16x32_bf16 a[72:75], v[40:43], v[80:83], 0
    v_mfma_f32_16x16x32_bf16 a[72:75], v[44:47], v[84:87], a[72:75]
    s_add_u32 m0, s69, 49152
    v_mfma_f32_16x16x32_bf16 a[76:79], v[40:43], v[88:91], 0
    s_xor_b32 s60, s60, 524288
    buffer_load_dwordx4 v10, s[20:23], s63 offen lds
    v_mfma_f32_16x16x32_bf16 a[76:79], v[44:47], v[92:95], a[76:79]
    ds_read_b128 v[116:119], v25 offset:49152
    v_mfma_f32_16x16x32_bf16 a[128:131], v[40:43], a[136:139], 0
    ds_read_b64_tr_b16 v[40:41], v29 offset:32768
    ds_read_b64_tr_b16 v[42:43], v29 offset:33280
    v_mfma_f32_16x16x32_bf16 a[128:131], v[44:47], a[140:143], a[128:131]
    ds_read_b64_tr_b16 v[44:45], v29 offset:36864
    ds_read_b64_tr_b16 v[46:47], v29 offset:37376
    v_mfma_f32_16x16x32_bf16 a[80:83], v[48:51], v[64:67], 0
    buffer_load_dwordx4 v11, s[20:23], s63 offen offset:1024 lds
    v_mfma_f32_16x16x32_bf16 a[80:83], v[52:55], v[68:71], a[80:83]
    ds_read_b128 v[120:123], v24 offset:57344
    v_add_u32 v29, 0xffff0000, v29
    v_mfma_f32_16x16x32_bf16 a[84:87], v[48:51], v[72:75], 0
    v_mfma_f32_16x16x32_bf16 a[84:87], v[52:55], v[76:79], a[84:87]
    v_mfma_f32_16x16x32_bf16 a[88:91], v[48:51], v[80:83], 0
    buffer_load_dwordx4 v12, s[20:23], s63 offen offset:2048 lds
    v_mfma_f32_16x16x32_bf16 a[88:91], v[52:55], v[84:87], a[88:91]
    ds_read_b128 v[124:127], v25 offset:57344
    v_mfma_f32_16x16x32_bf16 a[92:95], v[48:51], v[88:91], 0
    s_add_u32 s72, s70, 45056
    v_mfma_f32_16x16x32_bf16 a[92:95], v[52:55], v[92:95], a[92:95]
    v_mfma_f32_16x16x32_bf16 a[132:135], v[48:51], a[136:139], 0
    buffer_load_dwordx4 v13, s[20:23], s63 offen offset:3072 lds
    v_mfma_f32_16x16x32_bf16 a[132:135], v[52:55], a[140:143], a[132:135]
    s_waitcnt lgkmcnt(1)
    v_mfma_f32_16x16x32_bf16 a[96:99], v[56:59], v[64:67], 0
    v_mfma_f32_16x16x32_bf16 a[96:99], v[60:63], v[68:71], a[96:99]
    s_xor_b32 s63, s63, 896
    v_mfma_f32_16x16x32_bf16 a[100:103], v[56:59], v[72:75], 0
    buffer_store_dwordx4 a[56:59], v1, s[36:39], s72 offen sc1
    v_mfma_f32_16x16x32_bf16 a[100:103], v[60:63], v[76:79], a[100:103]
    v_mfma_f32_16x16x32_bf16 a[104:107], v[56:59], v[80:83], 0
    v_accvgpr_write_b32 a56, 0
    v_accvgpr_write_b32 a57, 0
    v_mfma_f32_16x16x32_bf16 a[104:107], v[60:63], v[84:87], a[104:107]
    s_waitcnt vmcnt(10) lgkmcnt(0)
    s_barrier
    ds_read_b64_tr_b16 v[48:49], v14 offset:0
    v_mfma_f32_16x16x32_bf16 a[108:111], v[56:59], v[88:91], 0
    s_add_u32 m0, s67, 65536
    ds_read_b64_tr_b16 v[50:51], v14 offset:1024
    ds_read_b64_tr_b16 v[52:53], v14 offset:8192
    v_mfma_f32_16x16x32_bf16 a[108:111], v[60:63], v[92:95], a[108:111]
    buffer_load_dwordx4 v1, s[28:31], s65 offen sc1 lds
    v_mfma_f32_16x16x32_bf16 a[112:115], v[40:43], v[64:67], 0
    ds_read_b64_tr_b16 v[54:55], v14 offset:9216
    ds_read_b64_tr_b16 v[56:57], v15 offset:0
    v_mfma_f32_16x16x32_bf16 a[112:115], v[44:47], v[68:71], a[112:115]
    ds_read_b64_tr_b16 v[58:59], v15 offset:1024
    ds_read_b64_tr_b16 v[60:61], v15 offset:8192
    v_mfma_f32_16x16x32_bf16 a[116:119], v[40:43], v[72:75], 0
    ds_read_b64_tr_b16 v[62:63], v15 offset:9216
    ds_read_b128 a[136:139], v22 offset:0
    v_mfma_f32_16x16x32_bf16 a[116:119], v[44:47], v[76:79], a[116:119]
    ds_read_b128 a[140:143], v23 offset:0
    v_add_u32 v14, 0xfffe0000, v14
    v_mfma_f32_16x16x32_bf16 a[120:123], v[40:43], v[80:83], 0
    v_add_u32 v15, 0xfffe0000, v15
    v_add_u32 v22, 0x10000, v22
    v_mfma_f32_16x16x32_bf16 a[120:123], v[44:47], v[84:87], a[120:123]
    v_add_u32 v23, 0x10000, v23
    v_accvgpr_write_b32 a58, 0
    v_mfma_f32_16x16x32_bf16 a[124:127], v[40:43], v[88:91], 0
    buffer_load_dwordx4 v1, s[28:31], s65 offen offset:1024 sc1 lds
    v_mfma_f32_16x16x32_bf16 a[124:127], v[44:47], v[92:95], a[124:127]
    s_waitcnt lgkmcnt(1)
    ds_read_b64_tr_b16 v[40:41], v16 offset:0
    ds_read_b64_tr_b16 v[42:43], v16 offset:1024
    v_mfma_f32_16x16x32_bf16 v[128:131], v[48:51], v[96:99], v[128:131]
    ds_read_b64_tr_b16 v[44:45], v16 offset:8192
    ds_read_b64_tr_b16 v[46:47], v16 offset:9216
    v_mfma_f32_16x16x32_bf16 v[128:131], v[52:55], v[100:103], v[128:131]
    v_add_u32 v24, 0x10000, v24
    v_add_u32 v16, 0xfffe0000, v16
    v_mfma_f32_16x16x32_bf16 v[132:135], v[48:51], v[104:107], v[132:135]
    ds_read_b128 v[64:67], v24 offset:16384
    v_accvgpr_write_b32 a59, 0
    v_mfma_f32_16x16x32_bf16 v[132:135], v[52:55], v[108:111], v[132:135]
    v_mfma_f32_16x16x32_bf16 v[136:139], v[48:51], v[112:115], v[136:139]
    v_mfma_f32_16x16x32_bf16 v[136:139], v[52:55], v[116:119], v[136:139]
    s_add_u32 s72, s70, 1024
    v_mfma_f32_16x16x32_bf16 v[140:143], v[48:51], v[120:123], v[140:143]
    s_add_u32 m0, s68, 73728
    ds_read_b64_tr_b16 v[48:49], v17 offset:0
    ds_read_b64_tr_b16 v[50:51], v17 offset:1024
    v_mfma_f32_16x16x32_bf16 v[140:143], v[52:55], v[124:127], v[140:143]
    buffer_load_dwordx4 v6, s[20:23], s66 offen lds
    v_mfma_f32_16x16x32_bf16 v[144:147], v[56:59], v[96:99], v[144:147]
    ds_read_b64_tr_b16 v[52:53], v17 offset:8192
    ds_read_b64_tr_b16 v[54:55], v17 offset:9216
    v_mfma_f32_16x16x32_bf16 v[144:147], v[60:63], v[100:103], v[144:147]
    buffer_store_dwordx4 a[4:7], v1, s[36:39], s72 offen sc1
    v_mfma_f32_16x16x32_bf16 v[148:151], v[56:59], v[104:107], v[148:151]
    v_add_u32 v17, 0xfffe0000, v17
    v_accvgpr_write_b32 a4, 0
    v_mfma_f32_16x16x32_bf16 v[148:151], v[60:63], v[108:111], v[148:151]
    v_accvgpr_write_b32 a5, 0
    v_accvgpr_write_b32 a6, 0
    v_mfma_f32_16x16x32_bf16 v[152:155], v[56:59], v[112:115], v[152:155]
    v_add_u32 v25, 0x10000, v25
    v_accvgpr_write_b32 a7, 0
    v_mfma_f32_16x16x32_bf16 v[152:155], v[60:63], v[116:119], v[152:155]
    ds_read_b128 v[68:71], v25 offset:16384
    v_mfma_f32_16x16x32_bf16 v[156:159], v[56:59], v[120:123], v[156:159]
    s_add_u32 m0, s69, 81920
    ds_read_b64_tr_b16 v[56:57], v18 offset:0
    ds_read_b64_tr_b16 v[58:59], v18 offset:1024
    v_mfma_f32_16x16x32_bf16 v[156:159], v[60:63], v[124:127], v[156:159]
    s_xor_b32 s65, s65, 8192
    buffer_load_dwordx4 v10, s[20:23], s64 offen lds
    s_waitcnt lgkmcnt(3)
    v_mfma_f32_16x16x32_bf16 v[160:163], v[40:43], v[96:99], v[160:163]
    s_xor_b32 s66, s66, 128
    ds_read_b64_tr_b16 v[60:61], v18 offset:8192
    ds_read_b64_tr_b16 v[62:63], v18 offset:9216
    v_mfma_f32_16x16x32_bf16 v[160:163], v[44:47], v[100:103], v[160:163]
    v_add_u32 v18, 0xfffe0000, v18
    v_mfma_f32_16x16x32_bf16 v[164:167], v[40:43], v[104:107], v[164:167]
    v_mfma_f32_16x16x32_bf16 v[164:167], v[44:47], v[108:111], v[164:167]
    v_mfma_f32_16x16x32_bf16 v[168:171], v[40:43], v[112:115], v[168:171]
    v_mfma_f32_16x16x32_bf16 v[168:171], v[44:47], v[116:119], v[168:171]
    v_mfma_f32_16x16x32_bf16 v[172:175], v[40:43], v[120:123], v[172:175]
    ds_read_b64_tr_b16 v[40:41], v19 offset:0
    ds_read_b64_tr_b16 v[42:43], v19 offset:1024
    v_mfma_f32_16x16x32_bf16 v[172:175], v[44:47], v[124:127], v[172:175]
    ds_read_b64_tr_b16 v[44:45], v19 offset:8192
    ds_read_b64_tr_b16 v[46:47], v19 offset:9216
    v_mfma_f32_16x16x32_bf16 v[176:179], v[48:51], v[96:99], v[176:179]
    buffer_load_dwordx4 v11, s[20:23], s64 offen offset:1024 lds
    v_mfma_f32_16x16x32_bf16 v[176:179], v[52:55], v[100:103], v[176:179]
    ds_read_b128 v[72:75], v24 offset:24576
    v_add_u32 v19, 0xfffe0000, v19
    v_mfma_f32_16x16x32_bf16 v[180:183], v[48:51], v[104:107], v[180:183]
    v_mfma_f32_16x16x32_bf16 v[180:183], v[52:55], v[108:111], v[180:183]
    v_mfma_f32_16x16x32_bf16 v[184:187], v[48:51], v[112:115], v[184:187]
    v_mfma_f32_16x16x32_bf16 v[184:187], v[52:55], v[116:119], v[184:187]
    v_mfma_f32_16x16x32_bf16 v[188:191], v[48:51], v[120:123], v[188:191]
    s_add_u32 s72, s70, 5120
    ds_read_b64_tr_b16 v[48:49], v20 offset:0
    ds_read_b64_tr_b16 v[50:51], v20 offset:1024
    v_mfma_f32_16x16x32_bf16 v[188:191], v[52:55], v[124:127], v[188:191]
    s_waitcnt lgkmcnt(2)
    ds_read_b64_tr_b16 v[52:53], v20 offset:8192
    ds_read_b64_tr_b16 v[54:55], v20 offset:9216
    v_mfma_f32_16x16x32_bf16 v[192:195], v[56:59], v[96:99], v[192:195]
    buffer_load_dwordx4 v12, s[20:23], s64 offen offset:2048 lds
    v_mfma_f32_16x16x32_bf16 v[192:195], v[60:63], v[100:103], v[192:195]
    buffer_store_dwordx4 a[12:15], v1, s[36:39], s72 offen sc1
    v_mfma_f32_16x16x32_bf16 v[196:199], v[56:59], v[104:107], v[196:199]
    v_add_u32 v20, 0xfffe0000, v20
    v_accvgpr_write_b32 a12, 0
    v_mfma_f32_16x16x32_bf16 v[196:199], v[60:63], v[108:111], v[196:199]
    ds_read_b128 v[76:79], v25 offset:24576
    v_accvgpr_write_b32 a13, 0
    v_mfma_f32_16x16x32_bf16 v[200:203], v[56:59], v[112:115], v[200:203]
    v_accvgpr_write_b32 a14, 0
    v_accvgpr_write_b32 a15, 0
    v_mfma_f32_16x16x32_bf16 v[200:203], v[60:63], v[116:119], v[200:203]
    v_mfma_f32_16x16x32_bf16 v[204:207], v[56:59], v[120:123], v[204:207]
    ds_read_b64_tr_b16 v[56:57], v21 offset:0
    ds_read_b64_tr_b16 v[58:59], v21 offset:1024
    v_mfma_f32_16x16x32_bf16 v[204:207], v[60:63], v[124:127], v[204:207]
    ds_read_b64_tr_b16 v[60:61], v21 offset:8192
    ds_read_b64_tr_b16 v[62:63], v21 offset:9216
    v_mfma_f32_16x16x32_bf16 v[208:211], v[40:43], v[96:99], v[208:211]
    v_add_u32 v21, 0xfffe0000, v21
    v_mfma_f32_16x16x32_bf16 v[208:211], v[44:47], v[100:103], v[208:211]
    buffer_load_dwordx4 v13, s[20:23], s64 offen offset:3072 lds
    v_mfma_f32_16x16x32_bf16 v[212:215], v[40:43], v[104:107], v[212:215]
    v_mfma_f32_16x16x32_bf16 v[212:215], v[44:47], v[108:111], v[212:215]
    v_mfma_f32_16x16x32_bf16 v[216:219], v[40:43], v[112:115], v[216:219]
    v_mfma_f32_16x16x32_bf16 v[216:219], v[44:47], v[116:119], v[216:219]
    v_mfma_f32_16x16x32_bf16 v[220:223], v[40:43], v[120:123], v[220:223]
    ds_read_b64_tr_b16 v[40:41], v26 offset:0
    ds_read_b64_tr_b16 v[42:43], v26 offset:512
    v_mfma_f32_16x16x32_bf16 v[220:223], v[44:47], v[124:127], v[220:223]
    s_waitcnt lgkmcnt(2)
    ds_read_b64_tr_b16 v[44:45], v26 offset:4096
    ds_read_b64_tr_b16 v[46:47], v26 offset:4608
    v_mfma_f32_16x16x32_bf16 v[224:227], v[48:51], v[96:99], v[224:227]
    v_add_u32 v26, 0x10000, v26
    v_mfma_f32_16x16x32_bf16 v[224:227], v[52:55], v[100:103], v[224:227]
    s_xor_b32 s64, s64, 896
    v_mfma_f32_16x16x32_bf16 v[228:231], v[48:51], v[104:107], v[228:231]
    v_mfma_f32_16x16x32_bf16 v[228:231], v[52:55], v[108:111], v[228:231]
    v_mfma_f32_16x16x32_bf16 v[232:235], v[48:51], v[112:115], v[232:235]
    v_mfma_f32_16x16x32_bf16 v[232:235], v[52:55], v[116:119], v[232:235]
    s_add_u32 m0, s69, 98304
    v_mfma_f32_16x16x32_bf16 v[236:239], v[48:51], v[120:123], v[236:239]
    buffer_load_dwordx4 v2, s[24:27], s60 offen lds
    v_mfma_f32_16x16x32_bf16 v[236:239], v[52:55], v[124:127], v[236:239]
    s_add_u32 s72, s70, 9216
    ds_read_b64_tr_b16 v[48:49], v27 offset:0
    ds_read_b64_tr_b16 v[50:51], v27 offset:512
    v_mfma_f32_16x16x32_bf16 v[240:243], v[56:59], v[96:99], v[240:243]
    ds_read_b64_tr_b16 v[52:53], v27 offset:4096
    ds_read_b64_tr_b16 v[54:55], v27 offset:4608
    v_mfma_f32_16x16x32_bf16 v[240:243], v[60:63], v[100:103], v[240:243]
    buffer_store_dwordx4 a[20:23], v1, s[36:39], s72 offen sc1
    v_mfma_f32_16x16x32_bf16 v[244:247], v[56:59], v[104:107], v[244:247]
    buffer_load_dwordx4 v3, s[24:27], s60 offen offset:1024 lds
    v_mfma_f32_16x16x32_bf16 v[244:247], v[60:63], v[108:111], v[244:247]
    v_add_u32 v27, 0x10000, v27
    v_accvgpr_write_b32 a20, 0
    v_mfma_f32_16x16x32_bf16 v[248:251], v[56:59], v[112:115], v[248:251]
    v_accvgpr_write_b32 a21, 0
    v_accvgpr_write_b32 a22, 0
    v_mfma_f32_16x16x32_bf16 v[248:251], v[60:63], v[116:119], v[248:251]
    v_accvgpr_write_b32 a23, 0
    v_mfma_f32_16x16x32_bf16 v[252:255], v[56:59], v[120:123], v[252:255]
    buffer_load_dwordx4 v4, s[24:27], s60 offen offset:2048 lds
    v_mfma_f32_16x16x32_bf16 v[252:255], v[60:63], v[124:127], v[252:255]
    s_waitcnt lgkmcnt(0)
    ds_read_b64_tr_b16 v[56:57], v28 offset:0
    ds_read_b64_tr_b16 v[58:59], v28 offset:512
    v_mfma_f32_16x16x32_bf16 a[64:67], v[40:43], v[96:99], a[64:67]
    ds_read_b64_tr_b16 v[60:61], v28 offset:4096
    ds_read_b64_tr_b16 v[62:63], v28 offset:4608
    v_mfma_f32_16x16x32_bf16 a[64:67], v[44:47], v[100:103], a[64:67]
    v_add_u32 v24, 0xfffe0000, v24
    v_add_u32 v28, 0x10000, v28
    v_mfma_f32_16x16x32_bf16 a[68:71], v[40:43], v[104:107], a[68:71]
    buffer_load_dwordx4 v5, s[24:27], s60 offen offset:3072 lds
    v_mfma_f32_16x16x32_bf16 a[68:71], v[44:47], v[108:111], a[68:71]
    ds_read_b128 v[80:83], v24 offset:16384
    v_mfma_f32_16x16x32_bf16 a[72:75], v[40:43], v[112:115], a[72:75]
    v_mfma_f32_16x16x32_bf16 a[72:75], v[44:47], v[116:119], a[72:75]
    s_add_u32 m0, s69, 114688
    v_add_u32 v25, 0xfffe0000, v25
    v_mfma_f32_16x16x32_bf16 a[76:79], v[40:43], v[120:123], a[76:79]
    s_xor_b32 s60, s60, 3670016
    buffer_load_dwordx4 v10, s[20:23], s63 offen lds
    v_mfma_f32_16x16x32_bf16 a[76:79], v[44:47], v[124:127], a[76:79]
    ds_read_b128 v[84:87], v25 offset:16384
    v_mfma_f32_16x16x32_bf16 a[128:131], v[40:43], a[136:139], a[128:131]
    ds_read_b64_tr_b16 v[40:41], v29 offset:0
    ds_read_b64_tr_b16 v[42:43], v29 offset:512
    v_mfma_f32_16x16x32_bf16 a[128:131], v[44:47], a[140:143], a[128:131]
    ds_read_b64_tr_b16 v[44:45], v29 offset:4096
    ds_read_b64_tr_b16 v[46:47], v29 offset:4608
    v_mfma_f32_16x16x32_bf16 a[80:83], v[48:51], v[96:99], a[80:83]
    buffer_load_dwordx4 v11, s[20:23], s63 offen offset:1024 lds
    v_mfma_f32_16x16x32_bf16 a[80:83], v[52:55], v[100:103], a[80:83]
    ds_read_b128 v[88:91], v24 offset:24576
    v_add_u32 v29, 0x10000, v29
    v_mfma_f32_16x16x32_bf16 a[84:87], v[48:51], v[104:107], a[84:87]
    v_mfma_f32_16x16x32_bf16 a[84:87], v[52:55], v[108:111], a[84:87]
    v_mfma_f32_16x16x32_bf16 a[88:91], v[48:51], v[112:115], a[88:91]
    buffer_load_dwordx4 v12, s[20:23], s63 offen offset:2048 lds
    v_mfma_f32_16x16x32_bf16 a[88:91], v[52:55], v[116:119], a[88:91]
    ds_read_b128 v[92:95], v25 offset:24576
    v_mfma_f32_16x16x32_bf16 a[92:95], v[48:51], v[120:123], a[92:95]
    s_add_u32 s72, s70, 13312
    v_mfma_f32_16x16x32_bf16 a[92:95], v[52:55], v[124:127], a[92:95]
    v_mfma_f32_16x16x32_bf16 a[132:135], v[48:51], a[136:139], a[132:135]
    buffer_load_dwordx4 v13, s[20:23], s63 offen offset:3072 lds
    v_mfma_f32_16x16x32_bf16 a[132:135], v[52:55], a[140:143], a[132:135]
    s_waitcnt lgkmcnt(1)
    v_mfma_f32_16x16x32_bf16 a[96:99], v[56:59], v[96:99], a[96:99]
    v_mfma_f32_16x16x32_bf16 a[96:99], v[60:63], v[100:103], a[96:99]
    s_xor_b32 s63, s63, 128
    v_mfma_f32_16x16x32_bf16 a[100:103], v[56:59], v[104:107], a[100:103]
    buffer_store_dwordx4 a[28:31], v1, s[36:39], s72 offen sc1
    v_mfma_f32_16x16x32_bf16 a[100:103], v[60:63], v[108:111], a[100:103]
    v_mfma_f32_16x16x32_bf16 a[104:107], v[56:59], v[112:115], a[104:107]
    v_accvgpr_write_b32 a28, 0
    v_accvgpr_write_b32 a29, 0
    v_mfma_f32_16x16x32_bf16 a[104:107], v[60:63], v[116:119], a[104:107]
    s_waitcnt vmcnt(10) lgkmcnt(0)
    s_barrier
    ds_read_b64_tr_b16 v[48:49], v14 offset:32768
    v_mfma_f32_16x16x32_bf16 a[108:111], v[56:59], v[120:123], a[108:111]
    s_add_u32 m0, s67, 131072
    ds_read_b64_tr_b16 v[50:51], v14 offset:33792
    ds_read_b64_tr_b16 v[52:53], v14 offset:40960
    v_mfma_f32_16x16x32_bf16 a[108:111], v[60:63], v[124:127], a[108:111]
    buffer_load_dwordx4 v1, s[28:31], s65 offen sc1 lds
    v_mfma_f32_16x16x32_bf16 a[112:115], v[40:43], v[96:99], a[112:115]
    ds_read_b64_tr_b16 v[54:55], v14 offset:41984
    ds_read_b64_tr_b16 v[56:57], v15 offset:32768
    v_mfma_f32_16x16x32_bf16 a[112:115], v[44:47], v[100:103], a[112:115]
    ds_read_b64_tr_b16 v[58:59], v15 offset:33792
    ds_read_b64_tr_b16 v[60:61], v15 offset:40960
    v_mfma_f32_16x16x32_bf16 a[116:119], v[40:43], v[104:107], a[116:119]
    ds_read_b64_tr_b16 v[62:63], v15 offset:41984
    ds_read_b128 a[136:139], v22 offset:0
    v_mfma_f32_16x16x32_bf16 a[116:119], v[44:47], v[108:111], a[116:119]
    ds_read_b128 a[140:143], v23 offset:0
    v_add_u32 v14, 0x10000, v14
    v_mfma_f32_16x16x32_bf16 a[120:123], v[40:43], v[112:115], a[120:123]
    v_add_u32 v15, 0x10000, v15
    v_add_u32 v22, 0x10000, v22
    v_mfma_f32_16x16x32_bf16 a[120:123], v[44:47], v[116:119], a[120:123]
    v_add_u32 v23, 0x10000, v23
    v_accvgpr_write_b32 a30, 0
    v_mfma_f32_16x16x32_bf16 a[124:127], v[40:43], v[120:123], a[124:127]
    buffer_load_dwordx4 v1, s[28:31], s65 offen offset:1024 sc1 lds
    v_mfma_f32_16x16x32_bf16 a[124:127], v[44:47], v[124:127], a[124:127]
    s_waitcnt lgkmcnt(1)
    ds_read_b64_tr_b16 v[40:41], v16 offset:32768
    ds_read_b64_tr_b16 v[42:43], v16 offset:33792
    v_mfma_f32_16x16x32_bf16 v[128:131], v[48:51], v[64:67], v[128:131]
    ds_read_b64_tr_b16 v[44:45], v16 offset:40960
    ds_read_b64_tr_b16 v[46:47], v16 offset:41984
    v_mfma_f32_16x16x32_bf16 v[128:131], v[52:55], v[68:71], v[128:131]
    v_add_u32 v16, 0x10000, v16
    v_accvgpr_write_b32 a31, 0
    v_mfma_f32_16x16x32_bf16 v[132:135], v[48:51], v[72:75], v[132:135]
    ds_read_b128 v[96:99], v24 offset:49152
    v_mfma_f32_16x16x32_bf16 v[132:135], v[52:55], v[76:79], v[132:135]
    v_mfma_f32_16x16x32_bf16 v[136:139], v[48:51], v[80:83], v[136:139]
    v_mfma_f32_16x16x32_bf16 v[136:139], v[52:55], v[84:87], v[136:139]
    s_add_u32 s72, s70, 33792
    v_mfma_f32_16x16x32_bf16 v[140:143], v[48:51], v[88:91], v[140:143]
    s_add_u32 m0, s68, 139264
    ds_read_b64_tr_b16 v[48:49], v17 offset:32768
    ds_read_b64_tr_b16 v[50:51], v17 offset:33792
    v_mfma_f32_16x16x32_bf16 v[140:143], v[52:55], v[92:95], v[140:143]
    buffer_load_dwordx4 v6, s[20:23], s66 offen lds
    v_mfma_f32_16x16x32_bf16 v[144:147], v[56:59], v[64:67], v[144:147]
    ds_read_b64_tr_b16 v[52:53], v17 offset:40960
    ds_read_b64_tr_b16 v[54:55], v17 offset:41984
    v_mfma_f32_16x16x32_bf16 v[144:147], v[60:63], v[68:71], v[144:147]
    buffer_store_dwordx4 a[36:39], v1, s[36:39], s72 offen sc1
    v_mfma_f32_16x16x32_bf16 v[148:151], v[56:59], v[72:75], v[148:151]
    v_add_u32 v17, 0x10000, v17
    v_accvgpr_write_b32 a36, 0
    v_mfma_f32_16x16x32_bf16 v[148:151], v[60:63], v[76:79], v[148:151]
    v_accvgpr_write_b32 a37, 0
    v_accvgpr_write_b32 a38, 0
    v_mfma_f32_16x16x32_bf16 v[152:155], v[56:59], v[80:83], v[152:155]
    v_accvgpr_write_b32 a39, 0
    v_mfma_f32_16x16x32_bf16 v[152:155], v[60:63], v[84:87], v[152:155]
    ds_read_b128 v[100:103], v25 offset:49152
    v_mfma_f32_16x16x32_bf16 v[156:159], v[56:59], v[88:91], v[156:159]
    s_add_u32 m0, s69, 147456
    ds_read_b64_tr_b16 v[56:57], v18 offset:32768
    ds_read_b64_tr_b16 v[58:59], v18 offset:33792
    v_mfma_f32_16x16x32_bf16 v[156:159], v[60:63], v[92:95], v[156:159]
    s_xor_b32 s65, s65, 57344
    buffer_load_dwordx4 v10, s[20:23], s64 offen lds
    s_waitcnt lgkmcnt(3)
    v_mfma_f32_16x16x32_bf16 v[160:163], v[40:43], v[64:67], v[160:163]
    s_xor_b32 s66, s66, 896
    ds_read_b64_tr_b16 v[60:61], v18 offset:40960
    ds_read_b64_tr_b16 v[62:63], v18 offset:41984
    v_mfma_f32_16x16x32_bf16 v[160:163], v[44:47], v[68:71], v[160:163]
    v_add_u32 v18, 0x10000, v18
    v_mfma_f32_16x16x32_bf16 v[164:167], v[40:43], v[72:75], v[164:167]
    v_mfma_f32_16x16x32_bf16 v[164:167], v[44:47], v[76:79], v[164:167]
    v_mfma_f32_16x16x32_bf16 v[168:171], v[40:43], v[80:83], v[168:171]
    v_mfma_f32_16x16x32_bf16 v[168:171], v[44:47], v[84:87], v[168:171]
    v_mfma_f32_16x16x32_bf16 v[172:175], v[40:43], v[88:91], v[172:175]
    ds_read_b64_tr_b16 v[40:41], v19 offset:32768
    ds_read_b64_tr_b16 v[42:43], v19 offset:33792
    v_mfma_f32_16x16x32_bf16 v[172:175], v[44:47], v[92:95], v[172:175]
    ds_read_b64_tr_b16 v[44:45], v19 offset:40960
    ds_read_b64_tr_b16 v[46:47], v19 offset:41984
    v_mfma_f32_16x16x32_bf16 v[176:179], v[48:51], v[64:67], v[176:179]
    buffer_load_dwordx4 v11, s[20:23], s64 offen offset:1024 lds
    v_mfma_f32_16x16x32_bf16 v[176:179], v[52:55], v[68:71], v[176:179]
    ds_read_b128 v[104:107], v24 offset:57344
    v_add_u32 v19, 0x10000, v19
    v_mfma_f32_16x16x32_bf16 v[180:183], v[48:51], v[72:75], v[180:183]
    v_mfma_f32_16x16x32_bf16 v[180:183], v[52:55], v[76:79], v[180:183]
    v_mfma_f32_16x16x32_bf16 v[184:187], v[48:51], v[80:83], v[184:187]
    v_mfma_f32_16x16x32_bf16 v[184:187], v[52:55], v[84:87], v[184:187]
    v_mfma_f32_16x16x32_bf16 v[188:191], v[48:51], v[88:91], v[188:191]
    s_add_u32 s72, s70, 37888
    ds_read_b64_tr_b16 v[48:49], v20 offset:32768
    ds_read_b64_tr_b16 v[50:51], v20 offset:33792
    v_mfma_f32_16x16x32_bf16 v[188:191], v[52:55], v[92:95], v[188:191]
    s_waitcnt lgkmcnt(2)
    ds_read_b64_tr_b16 v[52:53], v20 offset:40960
    ds_read_b64_tr_b16 v[54:55], v20 offset:41984
    v_mfma_f32_16x16x32_bf16 v[192:195], v[56:59], v[64:67], v[192:195]
    buffer_load_dwordx4 v12, s[20:23], s64 offen offset:2048 lds
    v_mfma_f32_16x16x32_bf16 v[192:195], v[60:63], v[68:71], v[192:195]
    buffer_store_dwordx4 a[44:47], v1, s[36:39], s72 offen sc1
    v_mfma_f32_16x16x32_bf16 v[196:199], v[56:59], v[72:75], v[196:199]
    v_add_u32 v20, 0x10000, v20
    v_accvgpr_write_b32 a44, 0
    v_mfma_f32_16x16x32_bf16 v[196:199], v[60:63], v[76:79], v[196:199]
    ds_read_b128 v[108:111], v25 offset:57344
    v_accvgpr_write_b32 a45, 0
    v_mfma_f32_16x16x32_bf16 v[200:203], v[56:59], v[80:83], v[200:203]
    v_accvgpr_write_b32 a46, 0
    v_accvgpr_write_b32 a47, 0
    v_mfma_f32_16x16x32_bf16 v[200:203], v[60:63], v[84:87], v[200:203]
    v_mfma_f32_16x16x32_bf16 v[204:207], v[56:59], v[88:91], v[204:207]
    ds_read_b64_tr_b16 v[56:57], v21 offset:32768
    ds_read_b64_tr_b16 v[58:59], v21 offset:33792
    v_mfma_f32_16x16x32_bf16 v[204:207], v[60:63], v[92:95], v[204:207]
    ds_read_b64_tr_b16 v[60:61], v21 offset:40960
    ds_read_b64_tr_b16 v[62:63], v21 offset:41984
    v_mfma_f32_16x16x32_bf16 v[208:211], v[40:43], v[64:67], v[208:211]
    v_add_u32 v21, 0x10000, v21
    v_mfma_f32_16x16x32_bf16 v[208:211], v[44:47], v[68:71], v[208:211]
    buffer_load_dwordx4 v13, s[20:23], s64 offen offset:3072 lds
    v_mfma_f32_16x16x32_bf16 v[212:215], v[40:43], v[72:75], v[212:215]
    v_mfma_f32_16x16x32_bf16 v[212:215], v[44:47], v[76:79], v[212:215]
    v_mfma_f32_16x16x32_bf16 v[216:219], v[40:43], v[80:83], v[216:219]
    v_mfma_f32_16x16x32_bf16 v[216:219], v[44:47], v[84:87], v[216:219]
    v_mfma_f32_16x16x32_bf16 v[220:223], v[40:43], v[88:91], v[220:223]
    ds_read_b64_tr_b16 v[40:41], v26 offset:0
    ds_read_b64_tr_b16 v[42:43], v26 offset:512
    v_mfma_f32_16x16x32_bf16 v[220:223], v[44:47], v[92:95], v[220:223]
    s_waitcnt lgkmcnt(2)
    ds_read_b64_tr_b16 v[44:45], v26 offset:4096
    ds_read_b64_tr_b16 v[46:47], v26 offset:4608
    v_mfma_f32_16x16x32_bf16 v[224:227], v[48:51], v[64:67], v[224:227]
    v_add_u32 v26, 0x10000, v26
    v_mfma_f32_16x16x32_bf16 v[224:227], v[52:55], v[68:71], v[224:227]
    s_xor_b32 s64, s64, 128
    v_mfma_f32_16x16x32_bf16 v[228:231], v[48:51], v[72:75], v[228:231]
    v_mfma_f32_16x16x32_bf16 v[228:231], v[52:55], v[76:79], v[228:231]
    v_mfma_f32_16x16x32_bf16 v[232:235], v[48:51], v[80:83], v[232:235]
    v_mfma_f32_16x16x32_bf16 v[232:235], v[52:55], v[84:87], v[232:235]
    s_add_u32 m0, s69, 0
    v_mfma_f32_16x16x32_bf16 v[236:239], v[48:51], v[88:91], v[236:239]
    buffer_load_dwordx4 v2, s[24:27], s60 offen lds
    v_mfma_f32_16x16x32_bf16 v[236:239], v[52:55], v[92:95], v[236:239]
    s_add_u32 s72, s70, 41984
    ds_read_b64_tr_b16 v[48:49], v27 offset:0
    ds_read_b64_tr_b16 v[50:51], v27 offset:512
    v_mfma_f32_16x16x32_bf16 v[240:243], v[56:59], v[64:67], v[240:243]
    ds_read_b64_tr_b16 v[52:53], v27 offset:4096
    ds_read_b64_tr_b16 v[54:55], v27 offset:4608
    v_mfma_f32_16x16x32_bf16 v[240:243], v[60:63], v[68:71], v[240:243]
    buffer_store_dwordx4 a[52:55], v1, s[36:39], s72 offen sc1
    v_mfma_f32_16x16x32_bf16 v[244:247], v[56:59], v[72:75], v[244:247]
    buffer_load_dwordx4 v3, s[24:27], s60 offen offset:1024 lds
    v_mfma_f32_16x16x32_bf16 v[244:247], v[60:63], v[76:79], v[244:247]
    v_add_u32 v27, 0x10000, v27
    v_accvgpr_write_b32 a52, 0
    v_mfma_f32_16x16x32_bf16 v[248:251], v[56:59], v[80:83], v[248:251]
    v_accvgpr_write_b32 a53, 0
    v_accvgpr_write_b32 a54, 0
    v_mfma_f32_16x16x32_bf16 v[248:251], v[60:63], v[84:87], v[248:251]
    v_accvgpr_write_b32 a55, 0
    v_mfma_f32_16x16x32_bf16 v[252:255], v[56:59], v[88:91], v[252:255]
    buffer_load_dwordx4 v4, s[24:27], s60 offen offset:2048 lds
    v_mfma_f32_16x16x32_bf16 v[252:255], v[60:63], v[92:95], v[252:255]
    s_waitcnt lgkmcnt(0)
    ds_read_b64_tr_b16 v[56:57], v28 offset:0
    ds_read_b64_tr_b16 v[58:59], v28 offset:512
    v_mfma_f32_16x16x32_bf16 a[64:67], v[40:43], v[64:67], a[64:67]
    ds_read_b64_tr_b16 v[60:61], v28 offset:4096
    ds_read_b64_tr_b16 v[62:63], v28 offset:4608
    v_mfma_f32_16x16x32_bf16 a[64:67], v[44:47], v[68:71], a[64:67]
    v_add_u32 v24, 0x10000, v24
    v_add_u32 v28, 0x10000, v28
    v_mfma_f32_16x16x32_bf16 a[68:71], v[40:43], v[72:75], a[68:71]
    buffer_load_dwordx4 v5, s[24:27], s60 offen offset:3072 lds
    v_mfma_f32_16x16x32_bf16 a[68:71], v[44:47], v[76:79], a[68:71]
    ds_read_b128 v[112:115], v24 offset:16384
    v_mfma_f32_16x16x32_bf16 a[72:75], v[40:43], v[80:83], a[72:75]
    v_mfma_f32_16x16x32_bf16 a[72:75], v[44:47], v[84:87], a[72:75]
    s_add_u32 m0, s69, 16384
    v_add_u32 v25, 0x10000, v25
    v_mfma_f32_16x16x32_bf16 a[76:79], v[40:43], v[88:91], a[76:79]
    s_xor_b32 s60, s60, 524288
    buffer_load_dwordx4 v10, s[20:23], s63 offen lds
    v_mfma_f32_16x16x32_bf16 a[76:79], v[44:47], v[92:95], a[76:79]
    ds_read_b128 v[116:119], v25 offset:16384
    v_mfma_f32_16x16x32_bf16 a[128:131], v[40:43], a[136:139], a[128:131]
    ds_read_b64_tr_b16 v[40:41], v29 offset:0
    ds_read_b64_tr_b16 v[42:43], v29 offset:512
    v_mfma_f32_16x16x32_bf16 a[128:131], v[44:47], a[140:143], a[128:131]
    ds_read_b64_tr_b16 v[44:45], v29 offset:4096
    ds_read_b64_tr_b16 v[46:47], v29 offset:4608
    v_mfma_f32_16x16x32_bf16 a[80:83], v[48:51], v[64:67], a[80:83]
    buffer_load_dwordx4 v11, s[20:23], s63 offen offset:1024 lds
    v_mfma_f32_16x16x32_bf16 a[80:83], v[52:55], v[68:71], a[80:83]
    ds_read_b128 v[120:123], v24 offset:24576
    v_add_u32 v29, 0x10000, v29
    v_mfma_f32_16x16x32_bf16 a[84:87], v[48:51], v[72:75], a[84:87]
    v_mfma_f32_16x16x32_bf16 a[84:87], v[52:55], v[76:79], a[84:87]
    v_mfma_f32_16x16x32_bf16 a[88:91], v[48:51], v[80:83], a[88:91]
    buffer_load_dwordx4 v12, s[20:23], s63 offen offset:2048 lds
    v_mfma_f32_16x16x32_bf16 a[88:91], v[52:55], v[84:87], a[88:91]
    ds_read_b128 v[124:127], v25 offset:24576
    v_mfma_f32_16x16x32_bf16 a[92:95], v[48:51], v[88:91], a[92:95]
    s_add_u32 s72, s70, 46080
    v_mfma_f32_16x16x32_bf16 a[92:95], v[52:55], v[92:95], a[92:95]
    v_mfma_f32_16x16x32_bf16 a[132:135], v[48:51], a[136:139], a[132:135]
    buffer_load_dwordx4 v13, s[20:23], s63 offen offset:3072 lds
    v_mfma_f32_16x16x32_bf16 a[132:135], v[52:55], a[140:143], a[132:135]
    s_waitcnt lgkmcnt(1)
    v_mfma_f32_16x16x32_bf16 a[96:99], v[56:59], v[64:67], a[96:99]
    v_mfma_f32_16x16x32_bf16 a[96:99], v[60:63], v[68:71], a[96:99]
    s_xor_b32 s63, s63, 384
    v_mfma_f32_16x16x32_bf16 a[100:103], v[56:59], v[72:75], a[100:103]
    buffer_store_dwordx4 a[60:63], v1, s[36:39], s72 offen sc1
    v_mfma_f32_16x16x32_bf16 a[100:103], v[60:63], v[76:79], a[100:103]
    v_mfma_f32_16x16x32_bf16 a[104:107], v[56:59], v[80:83], a[104:107]
    v_accvgpr_write_b32 a60, 0
    v_accvgpr_write_b32 a61, 0
    v_mfma_f32_16x16x32_bf16 a[104:107], v[60:63], v[84:87], a[104:107]
    s_waitcnt vmcnt(10) lgkmcnt(0)
    s_barrier
    ds_read_b64_tr_b16 v[48:49], v14 offset:32768
    v_mfma_f32_16x16x32_bf16 a[108:111], v[56:59], v[88:91], a[108:111]
    s_add_u32 m0, s67, 32768
    ds_read_b64_tr_b16 v[50:51], v14 offset:33792
    ds_read_b64_tr_b16 v[52:53], v14 offset:40960
    v_mfma_f32_16x16x32_bf16 a[108:111], v[60:63], v[92:95], a[108:111]
    buffer_load_dwordx4 v1, s[28:31], s65 offen sc1 lds
    v_mfma_f32_16x16x32_bf16 a[112:115], v[40:43], v[64:67], a[112:115]
    ds_read_b64_tr_b16 v[54:55], v14 offset:41984
    ds_read_b64_tr_b16 v[56:57], v15 offset:32768
    v_mfma_f32_16x16x32_bf16 a[112:115], v[44:47], v[68:71], a[112:115]
    ds_read_b64_tr_b16 v[58:59], v15 offset:33792
    ds_read_b64_tr_b16 v[60:61], v15 offset:40960
    v_mfma_f32_16x16x32_bf16 a[116:119], v[40:43], v[72:75], a[116:119]
    ds_read_b64_tr_b16 v[62:63], v15 offset:41984
    ds_read_b128 a[136:139], v22 offset:0
    v_mfma_f32_16x16x32_bf16 a[116:119], v[44:47], v[76:79], a[116:119]
    ds_read_b128 a[140:143], v23 offset:0
    v_add_u32 v14, 0xffff0000, v14
    v_mfma_f32_16x16x32_bf16 a[120:123], v[40:43], v[80:83], a[120:123]
    v_add_u32 v15, 0xffff0000, v15
    v_add_u32 v22, 0xfffe0000, v22
    v_mfma_f32_16x16x32_bf16 a[120:123], v[44:47], v[84:87], a[120:123]
    v_add_u32 v23, 0xfffe0000, v23
    v_accvgpr_read_b32 v32, a144
    v_mfma_f32_16x16x32_bf16 a[124:127], v[40:43], v[88:91], a[124:127]
    buffer_load_dwordx4 v1, s[28:31], s65 offen offset:1024 sc1 lds
    v_mfma_f32_16x16x32_bf16 a[124:127], v[44:47], v[92:95], a[124:127]
    s_waitcnt lgkmcnt(1)
    ds_read_b64_tr_b16 v[40:41], v16 offset:32768
    ds_read_b64_tr_b16 v[42:43], v16 offset:33792
    v_mfma_f32_16x16x32_bf16 v[128:131], v[48:51], v[96:99], v[128:131]
    ds_read_b64_tr_b16 v[44:45], v16 offset:40960
    ds_read_b64_tr_b16 v[46:47], v16 offset:41984
    v_mfma_f32_16x16x32_bf16 v[128:131], v[52:55], v[100:103], v[128:131]
    v_add_u32 v16, 0xffff0000, v16
    v_accvgpr_read_b32 v31, a145
    v_mfma_f32_16x16x32_bf16 v[132:135], v[48:51], v[104:107], v[132:135]
    ds_read_b128 v[64:67], v24 offset:49152
    v_cvt_pk_bf16_f32 v32, v32, v31
    v_mfma_f32_16x16x32_bf16 v[132:135], v[52:55], v[108:111], v[132:135]
    v_accvgpr_read_b32 v33, a146
    v_accvgpr_read_b32 v31, a147
    v_mfma_f32_16x16x32_bf16 v[136:139], v[48:51], v[112:115], v[136:139]
    v_cvt_pk_bf16_f32 v33, v33, v31
    v_accvgpr_read_b32 v34, a148
    v_mfma_f32_16x16x32_bf16 v[136:139], v[52:55], v[116:119], v[136:139]
    s_add_u32 s72, s71, 32768
    v_accvgpr_read_b32 v31, a149
    v_cvt_pk_bf16_f32 v34, v34, v31
    v_mfma_f32_16x16x32_bf16 v[140:143], v[48:51], v[120:123], v[140:143]
    s_add_u32 m0, s68, 40960
    ds_read_b64_tr_b16 v[48:49], v17 offset:32768
    ds_read_b64_tr_b16 v[50:51], v17 offset:33792
    v_mfma_f32_16x16x32_bf16 v[140:143], v[52:55], v[124:127], v[140:143]
    buffer_load_dwordx4 v6, s[20:23], s66 offen lds
    v_mfma_f32_16x16x32_bf16 v[144:147], v[56:59], v[96:99], v[144:147]
    ds_read_b64_tr_b16 v[52:53], v17 offset:40960
    ds_read_b64_tr_b16 v[54:55], v17 offset:41984
    v_mfma_f32_16x16x32_bf16 v[144:147], v[60:63], v[100:103], v[144:147]
    v_add_u32 v17, 0xffff0000, v17
    v_accvgpr_read_b32 v35, a150
    v_mfma_f32_16x16x32_bf16 v[148:151], v[56:59], v[104:107], v[148:151]
    v_accvgpr_read_b32 v31, a151
    v_cvt_pk_bf16_f32 v35, v35, v31
    v_mfma_f32_16x16x32_bf16 v[148:151], v[60:63], v[108:111], v[148:151]
    buffer_store_dwordx4 v[32:35], v1, s[36:39], s72 offen sc1
    v_mfma_f32_16x16x32_bf16 v[152:155], v[56:59], v[112:115], v[152:155]
    v_accvgpr_write_b32 a62, 0
    v_accvgpr_write_b32 a63, 0
    v_mfma_f32_16x16x32_bf16 v[152:155], v[60:63], v[116:119], v[152:155]
    ds_read_b128 v[68:71], v25 offset:49152
    v_accvgpr_write_b32 a144, 0
    v_mfma_f32_16x16x32_bf16 v[156:159], v[56:59], v[120:123], v[156:159]
    s_add_u32 m0, s69, 49152
    ds_read_b64_tr_b16 v[56:57], v18 offset:32768
    ds_read_b64_tr_b16 v[58:59], v18 offset:33792
    v_mfma_f32_16x16x32_bf16 v[156:159], v[60:63], v[124:127], v[156:159]
    s_xor_b32 s65, s65, 8192
    buffer_load_dwordx4 v10, s[20:23], s64 offen lds
    s_waitcnt lgkmcnt(3)
    v_mfma_f32_16x16x32_bf16 v[160:163], v[40:43], v[96:99], v[160:163]
    s_xor_b32 s66, s66, 128
    ds_read_b64_tr_b16 v[60:61], v18 offset:40960
    ds_read_b64_tr_b16 v[62:63], v18 offset:41984
    v_mfma_f32_16x16x32_bf16 v[160:163], v[44:47], v[100:103], v[160:163]
    v_add_u32 v18, 0xffff0000, v18
    v_accvgpr_write_b32 a145, 0
    v_mfma_f32_16x16x32_bf16 v[164:167], v[40:43], v[104:107], v[164:167]
    v_accvgpr_write_b32 a146, 0
    v_accvgpr_write_b32 a147, 0
    v_mfma_f32_16x16x32_bf16 v[164:167], v[44:47], v[108:111], v[164:167]
    v_accvgpr_read_b32 v32, a152
    v_accvgpr_read_b32 v31, a153
    v_mfma_f32_16x16x32_bf16 v[168:171], v[40:43], v[112:115], v[168:171]
    v_cvt_pk_bf16_f32 v32, v32, v31
    v_accvgpr_read_b32 v33, a154
    v_mfma_f32_16x16x32_bf16 v[168:171], v[44:47], v[116:119], v[168:171]
    v_accvgpr_read_b32 v31, a155
    v_cvt_pk_bf16_f32 v33, v33, v31
    v_mfma_f32_16x16x32_bf16 v[172:175], v[40:43], v[120:123], v[172:175]
    ds_read_b64_tr_b16 v[40:41], v19 offset:32768
    ds_read_b64_tr_b16 v[42:43], v19 offset:33792
    v_mfma_f32_16x16x32_bf16 v[172:175], v[44:47], v[124:127], v[172:175]
    ds_read_b64_tr_b16 v[44:45], v19 offset:40960
    ds_read_b64_tr_b16 v[46:47], v19 offset:41984
    v_mfma_f32_16x16x32_bf16 v[176:179], v[48:51], v[96:99], v[176:179]
    buffer_load_dwordx4 v11, s[20:23], s64 offen offset:1024 lds
    v_mfma_f32_16x16x32_bf16 v[176:179], v[52:55], v[100:103], v[176:179]
    ds_read_b128 v[72:75], v24 offset:57344
    v_add_u32 v19, 0xffff0000, v19
    v_mfma_f32_16x16x32_bf16 v[180:183], v[48:51], v[104:107], v[180:183]
    v_accvgpr_read_b32 v34, a156
    v_accvgpr_read_b32 v31, a157
    v_mfma_f32_16x16x32_bf16 v[180:183], v[52:55], v[108:111], v[180:183]
    v_cvt_pk_bf16_f32 v34, v34, v31
    v_accvgpr_read_b32 v35, a158
    v_mfma_f32_16x16x32_bf16 v[184:187], v[48:51], v[112:115], v[184:187]
    v_accvgpr_read_b32 v31, a159
    v_cvt_pk_bf16_f32 v35, v35, v31
    v_mfma_f32_16x16x32_bf16 v[184:187], v[52:55], v[116:119], v[184:187]
    v_accvgpr_write_b32 a148, 0
    v_accvgpr_write_b32 a149, 0
    v_mfma_f32_16x16x32_bf16 v[188:191], v[48:51], v[120:123], v[188:191]
    s_add_u32 s72, s71, 33792
    ds_read_b64_tr_b16 v[48:49], v20 offset:32768
    ds_read_b64_tr_b16 v[50:51], v20 offset:33792
    v_mfma_f32_16x16x32_bf16 v[188:191], v[52:55], v[124:127], v[188:191]
    s_waitcnt lgkmcnt(2)
    ds_read_b64_tr_b16 v[52:53], v20 offset:40960
    ds_read_b64_tr_b16 v[54:55], v20 offset:41984
    v_mfma_f32_16x16x32_bf16 v[192:195], v[56:59], v[96:99], v[192:195]
    buffer_load_dwordx4 v12, s[20:23], s64 offen offset:2048 lds
    v_mfma_f32_16x16x32_bf16 v[192:195], v[60:63], v[100:103], v[192:195]
    v_add_u32 v20, 0xffff0000, v20
    v_accvgpr_write_b32 a150, 0
    v_mfma_f32_16x16x32_bf16 v[196:199], v[56:59], v[104:107], v[196:199]
    buffer_store_dwordx4 v[32:35], v1, s[36:39], s72 offen sc1
    v_mfma_f32_16x16x32_bf16 v[196:199], v[60:63], v[108:111], v[196:199]
    ds_read_b128 v[76:79], v25 offset:57344
    v_accvgpr_write_b32 a151, 0
    v_mfma_f32_16x16x32_bf16 v[200:203], v[56:59], v[112:115], v[200:203]
    v_accvgpr_write_b32 a152, 0
    v_accvgpr_write_b32 a153, 0
    v_mfma_f32_16x16x32_bf16 v[200:203], v[60:63], v[116:119], v[200:203]
    v_accvgpr_write_b32 a154, 0
    v_accvgpr_write_b32 a155, 0
    v_mfma_f32_16x16x32_bf16 v[204:207], v[56:59], v[120:123], v[204:207]
    ds_read_b64_tr_b16 v[56:57], v21 offset:32768
    ds_read_b64_tr_b16 v[58:59], v21 offset:33792
    v_mfma_f32_16x16x32_bf16 v[204:207], v[60:63], v[124:127], v[204:207]
    ds_read_b64_tr_b16 v[60:61], v21 offset:40960
    ds_read_b64_tr_b16 v[62:63], v21 offset:41984
    v_mfma_f32_16x16x32_bf16 v[208:211], v[40:43], v[96:99], v[208:211]
    v_add_u32 v21, 0xffff0000, v21
    v_accvgpr_write_b32 a156, 0
    v_mfma_f32_16x16x32_bf16 v[208:211], v[44:47], v[100:103], v[208:211]
    buffer_load_dwordx4 v13, s[20:23], s64 offen offset:3072 lds
    v_mfma_f32_16x16x32_bf16 v[212:215], v[40:43], v[104:107], v[212:215]
    v_accvgpr_write_b32 a157, 0
    v_accvgpr_write_b32 a158, 0
    v_mfma_f32_16x16x32_bf16 v[212:215], v[44:47], v[108:111], v[212:215]
    v_accvgpr_write_b32 a159, 0
    v_mfma_f32_16x16x32_bf16 v[216:219], v[40:43], v[112:115], v[216:219]
    v_accvgpr_read_b32 v32, a160
    v_accvgpr_read_b32 v31, a161
    v_mfma_f32_16x16x32_bf16 v[216:219], v[44:47], v[116:119], v[216:219]
    v_cvt_pk_bf16_f32 v32, v32, v31
    v_accvgpr_read_b32 v33, a162
    v_mfma_f32_16x16x32_bf16 v[220:223], v[40:43], v[120:123], v[220:223]
    ds_read_b64_tr_b16 v[40:41], v26 offset:0
    ds_read_b64_tr_b16 v[42:43], v26 offset:512
    v_mfma_f32_16x16x32_bf16 v[220:223], v[44:47], v[124:127], v[220:223]
    s_waitcnt lgkmcnt(2)
    ds_read_b64_tr_b16 v[44:45], v26 offset:4096
    ds_read_b64_tr_b16 v[46:47], v26 offset:4608
    v_mfma_f32_16x16x32_bf16 v[224:227], v[48:51], v[96:99], v[224:227]
    v_add_u32 v26, 0xfffe0000, v26
    v_accvgpr_read_b32 v31, a163
    v_mfma_f32_16x16x32_bf16 v[224:227], v[52:55], v[100:103], v[224:227]
    s_xor_b32 s64, s64, 384
    v_cvt_pk_bf16_f32 v33, v33, v31
    v_accvgpr_read_b32 v34, a164
    v_mfma_f32_16x16x32_bf16 v[228:231], v[48:51], v[104:107], v[228:231]
    v_accvgpr_read_b32 v31, a165
    v_cvt_pk_bf16_f32 v34, v34, v31
    v_mfma_f32_16x16x32_bf16 v[228:231], v[52:55], v[108:111], v[228:231]
    v_accvgpr_read_b32 v35, a166
    v_accvgpr_read_b32 v31, a167
    v_mfma_f32_16x16x32_bf16 v[232:235], v[48:51], v[112:115], v[232:235]
    v_cvt_pk_bf16_f32 v35, v35, v31
    v_accvgpr_write_b32 a160, 0
    v_mfma_f32_16x16x32_bf16 v[232:235], v[52:55], v[116:119], v[232:235]
    s_add_u32 m0, s69, 65536
    v_accvgpr_write_b32 a161, 0
    v_accvgpr_write_b32 a162, 0
    v_mfma_f32_16x16x32_bf16 v[236:239], v[48:51], v[120:123], v[236:239]
    buffer_load_dwordx4 v2, s[24:27], s60 offen lds
    v_mfma_f32_16x16x32_bf16 v[236:239], v[52:55], v[124:127], v[236:239]
    s_add_u32 s72, s71, 2048
    ds_read_b64_tr_b16 v[48:49], v27 offset:0
    ds_read_b64_tr_b16 v[50:51], v27 offset:512
    v_mfma_f32_16x16x32_bf16 v[240:243], v[56:59], v[96:99], v[240:243]
    ds_read_b64_tr_b16 v[52:53], v27 offset:4096
    ds_read_b64_tr_b16 v[54:55], v27 offset:4608
    v_mfma_f32_16x16x32_bf16 v[240:243], v[60:63], v[100:103], v[240:243]
    v_add_u32 v27, 0xfffe0000, v27
    v_accvgpr_write_b32 a163, 0
    v_mfma_f32_16x16x32_bf16 v[244:247], v[56:59], v[104:107], v[244:247]
    buffer_load_dwordx4 v3, s[24:27], s60 offen offset:1024 lds
    v_mfma_f32_16x16x32_bf16 v[244:247], v[60:63], v[108:111], v[244:247]
    buffer_store_dwordx4 v[32:35], v1, s[36:39], s72 offen sc1
    v_mfma_f32_16x16x32_bf16 v[248:251], v[56:59], v[112:115], v[248:251]
    v_accvgpr_write_b32 a164, 0
    v_accvgpr_write_b32 a165, 0
    v_mfma_f32_16x16x32_bf16 v[248:251], v[60:63], v[116:119], v[248:251]
    v_accvgpr_write_b32 a166, 0
    v_accvgpr_write_b32 a167, 0
    v_mfma_f32_16x16x32_bf16 v[252:255], v[56:59], v[120:123], v[252:255]
    buffer_load_dwordx4 v4, s[24:27], s60 offen offset:2048 lds
    v_mfma_f32_16x16x32_bf16 v[252:255], v[60:63], v[124:127], v[252:255]
    s_waitcnt lgkmcnt(0)
    ds_read_b64_tr_b16 v[56:57], v28 offset:0
    ds_read_b64_tr_b16 v[58:59], v28 offset:512
    v_mfma_f32_16x16x32_bf16 a[64:67], v[40:43], v[96:99], a[64:67]
    ds_read_b64_tr_b16 v[60:61], v28 offset:4096
    ds_read_b64_tr_b16 v[62:63], v28 offset:4608
    v_mfma_f32_16x16x32_bf16 a[64:67], v[44:47], v[100:103], a[64:67]
    v_add_u32 v24, 0x10000, v24
    v_add_u32 v28, 0xfffe0000, v28
    v_mfma_f32_16x16x32_bf16 a[68:71], v[40:43], v[104:107], a[68:71]
    buffer_load_dwordx4 v5, s[24:27], s60 offen offset:3072 lds
    v_mfma_f32_16x16x32_bf16 a[68:71], v[44:47], v[108:111], a[68:71]
    ds_read_b128 v[80:83], v24 offset:16384
    v_mfma_f32_16x16x32_bf16 a[72:75], v[40:43], v[112:115], a[72:75]
    v_mfma_f32_16x16x32_bf16 a[72:75], v[44:47], v[116:119], a[72:75]
    s_add_u32 m0, s69, 81920
    v_add_u32 v25, 0x10000, v25
    v_accvgpr_read_b32 v32, a168
    v_mfma_f32_16x16x32_bf16 a[76:79], v[40:43], v[120:123], a[76:79]
    s_xor_b32 s60, s60, 1572864
    buffer_load_dwordx4 v10, s[20:23], s63 offen lds
    v_mfma_f32_16x16x32_bf16 a[76:79], v[44:47], v[124:127], a[76:79]
    ds_read_b128 v[84:87], v25 offset:16384
    v_accvgpr_read_b32 v31, a169
    v_mfma_f32_16x16x32_bf16 a[128:131], v[40:43], a[136:139], a[128:131]
    ds_read_b64_tr_b16 v[40:41], v29 offset:0
    ds_read_b64_tr_b16 v[42:43], v29 offset:512
    v_mfma_f32_16x16x32_bf16 a[128:131], v[44:47], a[140:143], a[128:131]
    ds_read_b64_tr_b16 v[44:45], v29 offset:4096
    ds_read_b64_tr_b16 v[46:47], v29 offset:4608
    v_mfma_f32_16x16x32_bf16 a[80:83], v[48:51], v[96:99], a[80:83]
    buffer_load_dwordx4 v11, s[20:23], s63 offen offset:1024 lds
    v_mfma_f32_16x16x32_bf16 a[80:83], v[52:55], v[100:103], a[80:83]
    ds_read_b128 v[88:91], v24 offset:24576
    v_add_u32 v29, 0xfffe0000, v29
    v_mfma_f32_16x16x32_bf16 a[84:87], v[48:51], v[104:107], a[84:87]
    v_cvt_pk_bf16_f32 v32, v32, v31
    v_accvgpr_read_b32 v33, a170
    v_mfma_f32_16x16x32_bf16 a[84:87], v[52:55], v[108:111], a[84:87]
    v_accvgpr_read_b32 v31, a171
    v_cvt_pk_bf16_f32 v33, v33, v31
    v_mfma_f32_16x16x32_bf16 a[88:91], v[48:51], v[112:115], a[88:91]
    buffer_load_dwordx4 v12, s[20:23], s63 offen offset:2048 lds
    v_mfma_f32_16x16x32_bf16 a[88:91], v[52:55], v[116:119], a[88:91]
    ds_read_b128 v[92:95], v25 offset:24576
    v_accvgpr_read_b32 v34, a172
    v_mfma_f32_16x16x32_bf16 a[92:95], v[48:51], v[120:123], a[92:95]
    s_add_u32 s72, s71, 3072
    v_accvgpr_read_b32 v31, a173
    v_cvt_pk_bf16_f32 v34, v34, v31
    v_mfma_f32_16x16x32_bf16 a[92:95], v[52:55], v[124:127], a[92:95]
    v_accvgpr_read_b32 v35, a174
    v_accvgpr_read_b32 v31, a175
    v_mfma_f32_16x16x32_bf16 a[132:135], v[48:51], a[136:139], a[132:135]
    buffer_load_dwordx4 v13, s[20:23], s63 offen offset:3072 lds
    v_mfma_f32_16x16x32_bf16 a[132:135], v[52:55], a[140:143], a[132:135]
    s_waitcnt lgkmcnt(1)
    v_cvt_pk_bf16_f32 v35, v35, v31
    v_accvgpr_write_b32 a168, 0
    v_mfma_f32_16x16x32_bf16 a[96:99], v[56:59], v[96:99], a[96:99]
    v_accvgpr_write_b32 a169, 0
    v_accvgpr_write_b32 a170, 0
    v_mfma_f32_16x16x32_bf16 a[96:99], v[60:63], v[100:103], a[96:99]
    s_xor_b32 s63, s63, 128
    v_accvgpr_write_b32 a171, 0
    v_accvgpr_write_b32 a172, 0
    v_mfma_f32_16x16x32_bf16 a[100:103], v[56:59], v[104:107], a[100:103]
    buffer_store_dwordx4 v[32:35], v1, s[36:39], s72 offen sc1
    v_mfma_f32_16x16x32_bf16 a[100:103], v[60:63], v[108:111], a[100:103]
    v_accvgpr_write_b32 a173, 0
    v_accvgpr_write_b32 a174, 0
    v_mfma_f32_16x16x32_bf16 a[104:107], v[56:59], v[112:115], a[104:107]
    v_accvgpr_write_b32 a175, 0
    v_mfma_f32_16x16x32_bf16 a[104:107], v[60:63], v[116:119], a[104:107]
    s_waitcnt vmcnt(10) lgkmcnt(0)
    s_barrier
    ds_read_b64_tr_b16 v[48:49], v14 offset:0
    v_mfma_f32_16x16x32_bf16 a[108:111], v[56:59], v[120:123], a[108:111]
    s_add_u32 m0, s67, 98304
    ds_read_b64_tr_b16 v[50:51], v14 offset:1024
    ds_read_b64_tr_b16 v[52:53], v14 offset:8192
    v_mfma_f32_16x16x32_bf16 a[108:111], v[60:63], v[124:127], a[108:111]
    buffer_load_dwordx4 v1, s[28:31], s65 offen sc1 lds
    v_mfma_f32_16x16x32_bf16 a[112:115], v[40:43], v[96:99], a[112:115]
    ds_read_b64_tr_b16 v[54:55], v14 offset:9216
    ds_read_b64_tr_b16 v[56:57], v15 offset:0
    v_mfma_f32_16x16x32_bf16 a[112:115], v[44:47], v[100:103], a[112:115]
    ds_read_b64_tr_b16 v[58:59], v15 offset:1024
    ds_read_b64_tr_b16 v[60:61], v15 offset:8192
    v_mfma_f32_16x16x32_bf16 a[116:119], v[40:43], v[104:107], a[116:119]
    ds_read_b64_tr_b16 v[62:63], v15 offset:9216
    ds_read_b128 a[136:139], v22 offset:32768
    v_mfma_f32_16x16x32_bf16 a[116:119], v[44:47], v[108:111], a[116:119]
    ds_read_b128 a[140:143], v23 offset:32768
    v_add_u32 v14, 0x10000, v14
    v_mfma_f32_16x16x32_bf16 a[120:123], v[40:43], v[112:115], a[120:123]
    v_add_u32 v15, 0x10000, v15
    v_add_u32 v22, 0x10000, v22
    v_mfma_f32_16x16x32_bf16 a[120:123], v[44:47], v[116:119], a[120:123]
    v_add_u32 v23, 0x10000, v23
    v_accvgpr_read_b32 v32, a176
    v_mfma_f32_16x16x32_bf16 a[124:127], v[40:43], v[120:123], a[124:127]
    buffer_load_dwordx4 v1, s[28:31], s65 offen offset:1024 sc1 lds
    v_mfma_f32_16x16x32_bf16 a[124:127], v[44:47], v[124:127], a[124:127]
    s_waitcnt lgkmcnt(1)
    ds_read_b64_tr_b16 v[40:41], v16 offset:0
    ds_read_b64_tr_b16 v[42:43], v16 offset:1024
    v_mfma_f32_16x16x32_bf16 v[128:131], v[48:51], v[64:67], v[128:131]
    ds_read_b64_tr_b16 v[44:45], v16 offset:8192
    ds_read_b64_tr_b16 v[46:47], v16 offset:9216
    v_mfma_f32_16x16x32_bf16 v[128:131], v[52:55], v[68:71], v[128:131]
    v_add_u32 v24, 0xfffe0000, v24
    v_add_u32 v16, 0x10000, v16
    v_mfma_f32_16x16x32_bf16 v[132:135], v[48:51], v[72:75], v[132:135]
    ds_read_b128 v[96:99], v24 offset:16384
    v_accvgpr_read_b32 v31, a177
    v_mfma_f32_16x16x32_bf16 v[132:135], v[52:55], v[76:79], v[132:135]
    v_cvt_pk_bf16_f32 v32, v32, v31
    v_accvgpr_read_b32 v33, a178
    v_mfma_f32_16x16x32_bf16 v[136:139], v[48:51], v[80:83], v[136:139]
    v_accvgpr_read_b32 v31, a179
    v_cvt_pk_bf16_f32 v33, v33, v31
    v_mfma_f32_16x16x32_bf16 v[136:139], v[52:55], v[84:87], v[136:139]
    s_add_u32 s72, s71, 34816
    v_accvgpr_read_b32 v34, a180
    v_accvgpr_read_b32 v31, a181
    v_mfma_f32_16x16x32_bf16 v[140:143], v[48:51], v[88:91], v[140:143]
    s_add_u32 m0, s68, 106496
    ds_read_b64_tr_b16 v[48:49], v17 offset:0
    ds_read_b64_tr_b16 v[50:51], v17 offset:1024
    v_mfma_f32_16x16x32_bf16 v[140:143], v[52:55], v[92:95], v[140:143]
    buffer_load_dwordx4 v6, s[20:23], s66 offen lds
    v_mfma_f32_16x16x32_bf16 v[144:147], v[56:59], v[64:67], v[144:147]
    ds_read_b64_tr_b16 v[52:53], v17 offset:8192
    ds_read_b64_tr_b16 v[54:55], v17 offset:9216
    v_mfma_f32_16x16x32_bf16 v[144:147], v[60:63], v[68:71], v[144:147]
    v_add_u32 v17, 0x10000, v17
    v_cvt_pk_bf16_f32 v34, v34, v31
    v_mfma_f32_16x16x32_bf16 v[148:151], v[56:59], v[72:75], v[148:151]
    v_accvgpr_read_b32 v35, a182
    v_accvgpr_read_b32 v31, a183
    v_mfma_f32_16x16x32_bf16 v[148:151], v[60:63], v[76:79], v[148:151]
    v_cvt_pk_bf16_f32 v35, v35, v31
    v_accvgpr_write_b32 a176, 0
    v_mfma_f32_16x16x32_bf16 v[152:155], v[56:59], v[80:83], v[152:155]
    v_add_u32 v25, 0xfffe0000, v25
    v_accvgpr_write_b32 a177, 0
    v_mfma_f32_16x16x32_bf16 v[152:155], v[60:63], v[84:87], v[152:155]
    ds_read_b128 v[100:103], v25 offset:16384
    v_accvgpr_write_b32 a178, 0
    v_mfma_f32_16x16x32_bf16 v[156:159], v[56:59], v[88:91], v[156:159]
    s_add_u32 m0, s69, 114688
    ds_read_b64_tr_b16 v[56:57], v18 offset:0
    ds_read_b64_tr_b16 v[58:59], v18 offset:1024
    v_mfma_f32_16x16x32_bf16 v[156:159], v[60:63], v[92:95], v[156:159]
    s_xor_b32 s65, s65, 24576
    buffer_load_dwordx4 v10, s[20:23], s64 offen lds
    s_waitcnt lgkmcnt(3)
    v_mfma_f32_16x16x32_bf16 v[160:163], v[40:43], v[64:67], v[160:163]
    s_xor_b32 s66, s66, 384
    ds_read_b64_tr_b16 v[60:61], v18 offset:8192
    ds_read_b64_tr_b16 v[62:63], v18 offset:9216
    v_mfma_f32_16x16x32_bf16 v[160:163], v[44:47], v[68:71], v[160:163]
    v_add_u32 v18, 0x10000, v18
    v_accvgpr_write_b32 a179, 0
    v_mfma_f32_16x16x32_bf16 v[164:167], v[40:43], v[72:75], v[164:167]
    buffer_store_dwordx4 v[32:35], v1, s[36:39], s72 offen sc1
    v_mfma_f32_16x16x32_bf16 v[164:167], v[44:47], v[76:79], v[164:167]
    v_accvgpr_read_b32 v31, a185
    v_accvgpr_read_b32 v32, a184
    v_mfma_f32_16x16x32_bf16 v[168:171], v[40:43], v[80:83], v[168:171]
    v_cvt_pk_bf16_f32 v32, v32, v31
    v_accvgpr_read_b32 v33, a186
    v_mfma_f32_16x16x32_bf16 v[168:171], v[44:47], v[84:87], v[168:171]
    v_accvgpr_read_b32 v31, a187
    v_cvt_pk_bf16_f32 v33, v33, v31
    v_mfma_f32_16x16x32_bf16 v[172:175], v[40:43], v[88:91], v[172:175]
    ds_read_b64_tr_b16 v[40:41], v19 offset:0
    ds_read_b64_tr_b16 v[42:43], v19 offset:1024
    v_mfma_f32_16x16x32_bf16 v[172:175], v[44:47], v[92:95], v[172:175]
    ds_read_b64_tr_b16 v[44:45], v19 offset:8192
    ds_read_b64_tr_b16 v[46:47], v19 offset:9216
    v_mfma_f32_16x16x32_bf16 v[176:179], v[48:51], v[64:67], v[176:179]
    buffer_load_dwordx4 v11, s[20:23], s64 offen offset:1024 lds
    v_mfma_f32_16x16x32_bf16 v[176:179], v[52:55], v[68:71], v[176:179]
    ds_read_b128 v[104:107], v24 offset:24576
    v_add_u32 v19, 0x10000, v19
    v_mfma_f32_16x16x32_bf16 v[180:183], v[48:51], v[72:75], v[180:183]
    v_accvgpr_read_b32 v34, a188
    v_accvgpr_read_b32 v31, a189
    v_mfma_f32_16x16x32_bf16 v[180:183], v[52:55], v[76:79], v[180:183]
    v_cvt_pk_bf16_f32 v34, v34, v31
    v_accvgpr_read_b32 v35, a190
    v_mfma_f32_16x16x32_bf16 v[184:187], v[48:51], v[80:83], v[184:187]
    v_accvgpr_read_b32 v31, a191
    v_cvt_pk_bf16_f32 v35, v35, v31
    v_mfma_f32_16x16x32_bf16 v[184:187], v[52:55], v[84:87], v[184:187]
    v_accvgpr_write_b32 a180, 0
    v_accvgpr_write_b32 a181, 0
    v_mfma_f32_16x16x32_bf16 v[188:191], v[48:51], v[88:91], v[188:191]
    s_add_u32 s72, s71, 35840
    ds_read_b64_tr_b16 v[48:49], v20 offset:0
    ds_read_b64_tr_b16 v[50:51], v20 offset:1024
    v_mfma_f32_16x16x32_bf16 v[188:191], v[52:55], v[92:95], v[188:191]
    s_waitcnt lgkmcnt(2)
    ds_read_b64_tr_b16 v[52:53], v20 offset:8192
    ds_read_b64_tr_b16 v[54:55], v20 offset:9216
    v_mfma_f32_16x16x32_bf16 v[192:195], v[56:59], v[64:67], v[192:195]
    buffer_load_dwordx4 v12, s[20:23], s64 offen offset:2048 lds
    v_mfma_f32_16x16x32_bf16 v[192:195], v[60:63], v[68:71], v[192:195]
    v_add_u32 v20, 0x10000, v20
    v_accvgpr_write_b32 a182, 0
    v_mfma_f32_16x16x32_bf16 v[196:199], v[56:59], v[72:75], v[196:199]
    buffer_store_dwordx4 v[32:35], v1, s[36:39], s72 offen sc1
    v_mfma_f32_16x16x32_bf16 v[196:199], v[60:63], v[76:79], v[196:199]
    ds_read_b128 v[108:111], v25 offset:24576
    v_accvgpr_write_b32 a183, 0
    v_mfma_f32_16x16x32_bf16 v[200:203], v[56:59], v[80:83], v[200:203]
    v_accvgpr_write_b32 a184, 0
    v_accvgpr_write_b32 a185, 0
    v_mfma_f32_16x16x32_bf16 v[200:203], v[60:63], v[84:87], v[200:203]
    v_accvgpr_write_b32 a186, 0
    v_accvgpr_write_b32 a187, 0
    v_mfma_f32_16x16x32_bf16 v[204:207], v[56:59], v[88:91], v[204:207]
    ds_read_b64_tr_b16 v[56:57], v21 offset:0
    ds_read_b64_tr_b16 v[58:59], v21 offset:1024
    v_mfma_f32_16x16x32_bf16 v[204:207], v[60:63], v[92:95], v[204:207]
    ds_read_b64_tr_b16 v[60:61], v21 offset:8192
    ds_read_b64_tr_b16 v[62:63], v21 offset:9216
    v_mfma_f32_16x16x32_bf16 v[208:211], v[40:43], v[64:67], v[208:211]
    v_add_u32 v21, 0x10000, v21
    v_accvgpr_write_b32 a188, 0
    v_mfma_f32_16x16x32_bf16 v[208:211], v[44:47], v[68:71], v[208:211]
    buffer_load_dwordx4 v13, s[20:23], s64 offen offset:3072 lds
    v_mfma_f32_16x16x32_bf16 v[212:215], v[40:43], v[72:75], v[212:215]
    v_accvgpr_write_b32 a189, 0
    v_accvgpr_write_b32 a190, 0
    v_mfma_f32_16x16x32_bf16 v[212:215], v[44:47], v[76:79], v[212:215]
    v_accvgpr_write_b32 a191, 0
    v_mfma_f32_16x16x32_bf16 v[216:219], v[40:43], v[80:83], v[216:219]
    v_accvgpr_read_b32 v32, a192
    v_accvgpr_read_b32 v31, a193
    v_mfma_f32_16x16x32_bf16 v[216:219], v[44:47], v[84:87], v[216:219]
    v_cvt_pk_bf16_f32 v32, v32, v31
    v_accvgpr_read_b32 v33, a194
    v_mfma_f32_16x16x32_bf16 v[220:223], v[40:43], v[88:91], v[220:223]
    ds_read_b64_tr_b16 v[40:41], v26 offset:32768
    ds_read_b64_tr_b16 v[42:43], v26 offset:33280
    v_mfma_f32_16x16x32_bf16 v[220:223], v[44:47], v[92:95], v[220:223]
    s_waitcnt lgkmcnt(2)
    ds_read_b64_tr_b16 v[44:45], v26 offset:36864
    ds_read_b64_tr_b16 v[46:47], v26 offset:37376
    v_mfma_f32_16x16x32_bf16 v[224:227], v[48:51], v[64:67], v[224:227]
    v_add_u32 v26, 0x10000, v26
    v_accvgpr_read_b32 v31, a195
    v_mfma_f32_16x16x32_bf16 v[224:227], v[52:55], v[68:71], v[224:227]
    s_xor_b32 s64, s64, 128
    v_cvt_pk_bf16_f32 v33, v33, v31
    v_accvgpr_read_b32 v34, a196
    v_mfma_f32_16x16x32_bf16 v[228:231], v[48:51], v[72:75], v[228:231]
    v_accvgpr_read_b32 v31, a197
    v_cvt_pk_bf16_f32 v34, v34, v31
    v_mfma_f32_16x16x32_bf16 v[228:231], v[52:55], v[76:79], v[228:231]
    v_accvgpr_read_b32 v35, a198
    v_accvgpr_read_b32 v31, a199
    v_mfma_f32_16x16x32_bf16 v[232:235], v[48:51], v[80:83], v[232:235]
    v_cvt_pk_bf16_f32 v35, v35, v31
    v_accvgpr_write_b32 a192, 0
    v_mfma_f32_16x16x32_bf16 v[232:235], v[52:55], v[84:87], v[232:235]
    s_add_u32 m0, s69, 131072
    v_accvgpr_write_b32 a193, 0
    v_accvgpr_write_b32 a194, 0
    v_mfma_f32_16x16x32_bf16 v[236:239], v[48:51], v[88:91], v[236:239]
    buffer_load_dwordx4 v2, s[24:27], s60 offen lds
    v_mfma_f32_16x16x32_bf16 v[236:239], v[52:55], v[92:95], v[236:239]
    s_add_u32 s72, s71, 4096
    ds_read_b64_tr_b16 v[48:49], v27 offset:32768
    ds_read_b64_tr_b16 v[50:51], v27 offset:33280
    v_mfma_f32_16x16x32_bf16 v[240:243], v[56:59], v[64:67], v[240:243]
    ds_read_b64_tr_b16 v[52:53], v27 offset:36864
    ds_read_b64_tr_b16 v[54:55], v27 offset:37376
    v_mfma_f32_16x16x32_bf16 v[240:243], v[60:63], v[68:71], v[240:243]
    v_add_u32 v27, 0x10000, v27
    v_accvgpr_write_b32 a195, 0
    v_mfma_f32_16x16x32_bf16 v[244:247], v[56:59], v[72:75], v[244:247]
    buffer_load_dwordx4 v3, s[24:27], s60 offen offset:1024 lds
    v_mfma_f32_16x16x32_bf16 v[244:247], v[60:63], v[76:79], v[244:247]
    buffer_store_dwordx4 v[32:35], v1, s[36:39], s72 offen sc1
    v_mfma_f32_16x16x32_bf16 v[248:251], v[56:59], v[80:83], v[248:251]
    v_accvgpr_write_b32 a196, 0
    v_accvgpr_write_b32 a197, 0
    v_mfma_f32_16x16x32_bf16 v[248:251], v[60:63], v[84:87], v[248:251]
    v_accvgpr_write_b32 a198, 0
    v_accvgpr_write_b32 a199, 0
    v_mfma_f32_16x16x32_bf16 v[252:255], v[56:59], v[88:91], v[252:255]
    buffer_load_dwordx4 v4, s[24:27], s60 offen offset:2048 lds
    v_mfma_f32_16x16x32_bf16 v[252:255], v[60:63], v[92:95], v[252:255]
    s_waitcnt lgkmcnt(0)
    ds_read_b64_tr_b16 v[56:57], v28 offset:32768
    ds_read_b64_tr_b16 v[58:59], v28 offset:33280
    v_mfma_f32_16x16x32_bf16 a[64:67], v[40:43], v[64:67], a[64:67]
    ds_read_b64_tr_b16 v[60:61], v28 offset:36864
    ds_read_b64_tr_b16 v[62:63], v28 offset:37376
    v_mfma_f32_16x16x32_bf16 a[64:67], v[44:47], v[68:71], a[64:67]
    v_add_u32 v28, 0x10000, v28
    v_mfma_f32_16x16x32_bf16 a[68:71], v[40:43], v[72:75], a[68:71]
    buffer_load_dwordx4 v5, s[24:27], s60 offen offset:3072 lds
    v_mfma_f32_16x16x32_bf16 a[68:71], v[44:47], v[76:79], a[68:71]
    ds_read_b128 v[112:115], v24 offset:49152
    v_mfma_f32_16x16x32_bf16 a[72:75], v[40:43], v[80:83], a[72:75]
    v_mfma_f32_16x16x32_bf16 a[72:75], v[44:47], v[84:87], a[72:75]
    s_add_u32 m0, s69, 147456
    v_accvgpr_read_b32 v32, a200
    v_accvgpr_read_b32 v31, a201
    v_mfma_f32_16x16x32_bf16 a[76:79], v[40:43], v[88:91], a[76:79]
    s_xor_b32 s60, s60, 524288
    buffer_load_dwordx4 v10, s[20:23], s63 offen lds
    v_mfma_f32_16x16x32_bf16 a[76:79], v[44:47], v[92:95], a[76:79]
    ds_read_b128 v[116:119], v25 offset:49152
    v_cvt_pk_bf16_f32 v32, v32, v31
    v_mfma_f32_16x16x32_bf16 a[128:131], v[40:43], a[136:139], a[128:131]
    ds_read_b64_tr_b16 v[40:41], v29 offset:32768
    ds_read_b64_tr_b16 v[42:43], v29 offset:33280
    v_mfma_f32_16x16x32_bf16 a[128:131], v[44:47], a[140:143], a[128:131]
    ds_read_b64_tr_b16 v[44:45], v29 offset:36864
    ds_read_b64_tr_b16 v[46:47], v29 offset:37376
    v_mfma_f32_16x16x32_bf16 a[80:83], v[48:51], v[64:67], a[80:83]
    buffer_load_dwordx4 v11, s[20:23], s63 offen offset:1024 lds
    v_mfma_f32_16x16x32_bf16 a[80:83], v[52:55], v[68:71], a[80:83]
    ds_read_b128 v[120:123], v24 offset:57344
    v_add_u32 v29, 0x10000, v29
    v_mfma_f32_16x16x32_bf16 a[84:87], v[48:51], v[72:75], a[84:87]
    v_accvgpr_read_b32 v33, a202
    v_accvgpr_read_b32 v31, a203
    v_mfma_f32_16x16x32_bf16 a[84:87], v[52:55], v[76:79], a[84:87]
    v_cvt_pk_bf16_f32 v33, v33, v31
    v_accvgpr_read_b32 v34, a204
    v_mfma_f32_16x16x32_bf16 a[88:91], v[48:51], v[80:83], a[88:91]
    buffer_load_dwordx4 v12, s[20:23], s63 offen offset:2048 lds
    v_mfma_f32_16x16x32_bf16 a[88:91], v[52:55], v[84:87], a[88:91]
    ds_read_b128 v[124:127], v25 offset:57344
    v_accvgpr_read_b32 v31, a205
    v_mfma_f32_16x16x32_bf16 a[92:95], v[48:51], v[88:91], a[92:95]
    s_add_u32 s72, s71, 5120
    v_cvt_pk_bf16_f32 v34, v34, v31
    v_accvgpr_read_b32 v35, a206
    v_mfma_f32_16x16x32_bf16 a[92:95], v[52:55], v[92:95], a[92:95]
    v_accvgpr_read_b32 v31, a207
    v_cvt_pk_bf16_f32 v35, v35, v31
    v_mfma_f32_16x16x32_bf16 a[132:135], v[48:51], a[136:139], a[132:135]
    buffer_load_dwordx4 v13, s[20:23], s63 offen offset:3072 lds
    v_mfma_f32_16x16x32_bf16 a[132:135], v[52:55], a[140:143], a[132:135]
    s_waitcnt lgkmcnt(1)
    v_accvgpr_write_b32 a200, 0
    v_accvgpr_write_b32 a201, 0
    v_mfma_f32_16x16x32_bf16 a[96:99], v[56:59], v[64:67], a[96:99]
    v_accvgpr_write_b32 a202, 0
    v_accvgpr_write_b32 a203, 0
    v_mfma_f32_16x16x32_bf16 a[96:99], v[60:63], v[68:71], a[96:99]
    s_xor_b32 s63, s63, 1920
    v_accvgpr_write_b32 a204, 0
    v_accvgpr_write_b32 a205, 0
    v_mfma_f32_16x16x32_bf16 a[100:103], v[56:59], v[72:75], a[100:103]
    s_andn2_b32 s63, s63, 896
    buffer_store_dwordx4 v[32:35], v1, s[36:39], s72 offen sc1
    v_mfma_f32_16x16x32_bf16 a[100:103], v[60:63], v[76:79], a[100:103]
    v_accvgpr_write_b32 a206, 0
    v_accvgpr_write_b32 a207, 0
    v_mfma_f32_16x16x32_bf16 a[104:107], v[56:59], v[80:83], a[104:107]
    v_mfma_f32_16x16x32_bf16 a[104:107], v[60:63], v[84:87], a[104:107]
    s_waitcnt vmcnt(10) lgkmcnt(0)
    s_barrier
    ds_read_b64_tr_b16 v[48:49], v14 offset:0
    v_mfma_f32_16x16x32_bf16 a[108:111], v[56:59], v[88:91], a[108:111]
    s_add_u32 m0, s67, 0
    ds_read_b64_tr_b16 v[50:51], v14 offset:1024
    ds_read_b64_tr_b16 v[52:53], v14 offset:8192
    v_mfma_f32_16x16x32_bf16 a[108:111], v[60:63], v[92:95], a[108:111]
    buffer_load_dwordx4 v1, s[28:31], s65 offen sc1 lds
    v_mfma_f32_16x16x32_bf16 a[112:115], v[40:43], v[64:67], a[112:115]
    ds_read_b64_tr_b16 v[54:55], v14 offset:9216
    ds_read_b64_tr_b16 v[56:57], v15 offset:0
    v_mfma_f32_16x16x32_bf16 a[112:115], v[44:47], v[68:71], a[112:115]
    ds_read_b64_tr_b16 v[58:59], v15 offset:1024
    ds_read_b64_tr_b16 v[60:61], v15 offset:8192
    v_mfma_f32_16x16x32_bf16 a[116:119], v[40:43], v[72:75], a[116:119]
    ds_read_b64_tr_b16 v[62:63], v15 offset:9216
    ds_read_b128 a[136:139], v22 offset:32768
    v_mfma_f32_16x16x32_bf16 a[116:119], v[44:47], v[76:79], a[116:119]
    ds_read_b128 a[140:143], v23 offset:32768
    v_add_u32 v14, 0x10000, v14
    v_mfma_f32_16x16x32_bf16 a[120:123], v[40:43], v[80:83], a[120:123]
    v_add_u32 v15, 0x10000, v15
    v_add_u32 v22, 0xffff0000, v22
    v_mfma_f32_16x16x32_bf16 a[120:123], v[44:47], v[84:87], a[120:123]
    v_add_u32 v23, 0xffff0000, v23
    v_accvgpr_read_b32 v32, a208
    v_mfma_f32_16x16x32_bf16 a[124:127], v[40:43], v[88:91], a[124:127]
    buffer_load_dwordx4 v1, s[28:31], s65 offen offset:1024 sc1 lds
    v_mfma_f32_16x16x32_bf16 a[124:127], v[44:47], v[92:95], a[124:127]
    s_waitcnt lgkmcnt(1)
    ds_read_b64_tr_b16 v[40:41], v16 offset:0
    ds_read_b64_tr_b16 v[42:43], v16 offset:1024
    v_mfma_f32_16x16x32_bf16 v[128:131], v[48:51], v[96:99], v[128:131]
    ds_read_b64_tr_b16 v[44:45], v16 offset:8192
    ds_read_b64_tr_b16 v[46:47], v16 offset:9216
    v_mfma_f32_16x16x32_bf16 v[128:131], v[52:55], v[100:103], v[128:131]
    v_add_u32 v24, 0x10000, v24
    v_add_u32 v16, 0x10000, v16
    v_mfma_f32_16x16x32_bf16 v[132:135], v[48:51], v[104:107], v[132:135]
    ds_read_b128 v[64:67], v24 offset:16384
    v_accvgpr_read_b32 v31, a209
    v_mfma_f32_16x16x32_bf16 v[132:135], v[52:55], v[108:111], v[132:135]
    v_cvt_pk_bf16_f32 v32, v32, v31
    v_accvgpr_read_b32 v33, a210
    v_mfma_f32_16x16x32_bf16 v[136:139], v[48:51], v[112:115], v[136:139]
    v_accvgpr_read_b32 v31, a211
    v_cvt_pk_bf16_f32 v33, v33, v31
    v_mfma_f32_16x16x32_bf16 v[136:139], v[52:55], v[116:119], v[136:139]
    s_add_u32 s72, s71, 36864
    v_accvgpr_read_b32 v34, a212
    v_accvgpr_read_b32 v31, a213
    v_mfma_f32_16x16x32_bf16 v[140:143], v[48:51], v[120:123], v[140:143]
    s_add_u32 m0, s68, 8192
    ds_read_b64_tr_b16 v[48:49], v17 offset:0
    ds_read_b64_tr_b16 v[50:51], v17 offset:1024
    v_mfma_f32_16x16x32_bf16 v[140:143], v[52:55], v[124:127], v[140:143]
    buffer_load_dwordx4 v6, s[20:23], s66 offen lds
    v_mfma_f32_16x16x32_bf16 v[144:147], v[56:59], v[96:99], v[144:147]
    ds_read_b64_tr_b16 v[52:53], v17 offset:8192
    ds_read_b64_tr_b16 v[54:55], v17 offset:9216
    v_mfma_f32_16x16x32_bf16 v[144:147], v[60:63], v[100:103], v[144:147]
    v_add_u32 v17, 0x10000, v17
    v_cvt_pk_bf16_f32 v34, v34, v31
    v_mfma_f32_16x16x32_bf16 v[148:151], v[56:59], v[104:107], v[148:151]
    v_accvgpr_read_b32 v35, a214
    v_accvgpr_read_b32 v31, a215
    v_mfma_f32_16x16x32_bf16 v[148:151], v[60:63], v[108:111], v[148:151]
    v_cvt_pk_bf16_f32 v35, v35, v31
    v_accvgpr_write_b32 a208, 0
    v_mfma_f32_16x16x32_bf16 v[152:155], v[56:59], v[112:115], v[152:155]
    v_add_u32 v25, 0x10000, v25
    v_accvgpr_write_b32 a209, 0
    v_mfma_f32_16x16x32_bf16 v[152:155], v[60:63], v[116:119], v[152:155]
    ds_read_b128 v[68:71], v25 offset:16384
    v_accvgpr_write_b32 a210, 0
    v_mfma_f32_16x16x32_bf16 v[156:159], v[56:59], v[120:123], v[156:159]
    s_add_u32 m0, s69, 16384
    ds_read_b64_tr_b16 v[56:57], v18 offset:0
    ds_read_b64_tr_b16 v[58:59], v18 offset:1024
    v_mfma_f32_16x16x32_bf16 v[156:159], v[60:63], v[124:127], v[156:159]
    s_xor_b32 s65, s65, 8192
    buffer_load_dwordx4 v10, s[20:23], s64 offen lds
    s_waitcnt lgkmcnt(3)
    v_mfma_f32_16x16x32_bf16 v[160:163], v[40:43], v[96:99], v[160:163]
    s_xor_b32 s66, s66, 128
    ds_read_b64_tr_b16 v[60:61], v18 offset:8192
    ds_read_b64_tr_b16 v[62:63], v18 offset:9216
    v_mfma_f32_16x16x32_bf16 v[160:163], v[44:47], v[100:103], v[160:163]
    v_add_u32 v18, 0x10000, v18
    v_accvgpr_write_b32 a211, 0
    v_mfma_f32_16x16x32_bf16 v[164:167], v[40:43], v[104:107], v[164:167]
    buffer_store_dwordx4 v[32:35], v1, s[36:39], s72 offen sc1
    v_mfma_f32_16x16x32_bf16 v[164:167], v[44:47], v[108:111], v[164:167]
    v_accvgpr_read_b32 v31, a217
    v_accvgpr_read_b32 v32, a216
    v_mfma_f32_16x16x32_bf16 v[168:171], v[40:43], v[112:115], v[168:171]
    v_cvt_pk_bf16_f32 v32, v32, v31
    v_accvgpr_read_b32 v33, a218
    v_mfma_f32_16x16x32_bf16 v[168:171], v[44:47], v[116:119], v[168:171]
    v_accvgpr_read_b32 v31, a219
    v_cvt_pk_bf16_f32 v33, v33, v31
    v_mfma_f32_16x16x32_bf16 v[172:175], v[40:43], v[120:123], v[172:175]
    ds_read_b64_tr_b16 v[40:41], v19 offset:0
    ds_read_b64_tr_b16 v[42:43], v19 offset:1024
    v_mfma_f32_16x16x32_bf16 v[172:175], v[44:47], v[124:127], v[172:175]
    ds_read_b64_tr_b16 v[44:45], v19 offset:8192
    ds_read_b64_tr_b16 v[46:47], v19 offset:9216
    v_mfma_f32_16x16x32_bf16 v[176:179], v[48:51], v[96:99], v[176:179]
    buffer_load_dwordx4 v11, s[20:23], s64 offen offset:1024 lds
    v_mfma_f32_16x16x32_bf16 v[176:179], v[52:55], v[100:103], v[176:179]
    ds_read_b128 v[72:75], v24 offset:24576
    v_add_u32 v19, 0x10000, v19
    v_mfma_f32_16x16x32_bf16 v[180:183], v[48:51], v[104:107], v[180:183]
    v_accvgpr_read_b32 v34, a220
    v_accvgpr_read_b32 v31, a221
    v_mfma_f32_16x16x32_bf16 v[180:183], v[52:55], v[108:111], v[180:183]
    v_cvt_pk_bf16_f32 v34, v34, v31
    v_accvgpr_read_b32 v35, a222
    v_mfma_f32_16x16x32_bf16 v[184:187], v[48:51], v[112:115], v[184:187]
    v_accvgpr_read_b32 v31, a223
    v_cvt_pk_bf16_f32 v35, v35, v31
    v_mfma_f32_16x16x32_bf16 v[184:187], v[52:55], v[116:119], v[184:187]
    v_accvgpr_write_b32 a212, 0
    v_accvgpr_write_b32 a213, 0
    v_mfma_f32_16x16x32_bf16 v[188:191], v[48:51], v[120:123], v[188:191]
    s_add_u32 s72, s71, 37888
    ds_read_b64_tr_b16 v[48:49], v20 offset:0
    ds_read_b64_tr_b16 v[50:51], v20 offset:1024
    v_mfma_f32_16x16x32_bf16 v[188:191], v[52:55], v[124:127], v[188:191]
    s_waitcnt lgkmcnt(2)
    ds_read_b64_tr_b16 v[52:53], v20 offset:8192
    ds_read_b64_tr_b16 v[54:55], v20 offset:9216
    v_mfma_f32_16x16x32_bf16 v[192:195], v[56:59], v[96:99], v[192:195]
    buffer_load_dwordx4 v12, s[20:23], s64 offen offset:2048 lds
    v_mfma_f32_16x16x32_bf16 v[192:195], v[60:63], v[100:103], v[192:195]
    v_add_u32 v20, 0x10000, v20
    v_accvgpr_write_b32 a214, 0
    v_mfma_f32_16x16x32_bf16 v[196:199], v[56:59], v[104:107], v[196:199]
    buffer_store_dwordx4 v[32:35], v1, s[36:39], s72 offen sc1
    v_mfma_f32_16x16x32_bf16 v[196:199], v[60:63], v[108:111], v[196:199]
    ds_read_b128 v[76:79], v25 offset:24576
    v_accvgpr_write_b32 a215, 0
    v_mfma_f32_16x16x32_bf16 v[200:203], v[56:59], v[112:115], v[200:203]
    v_accvgpr_write_b32 a216, 0
    v_accvgpr_write_b32 a217, 0
    v_mfma_f32_16x16x32_bf16 v[200:203], v[60:63], v[116:119], v[200:203]
    v_accvgpr_write_b32 a218, 0
    v_accvgpr_write_b32 a219, 0
    v_mfma_f32_16x16x32_bf16 v[204:207], v[56:59], v[120:123], v[204:207]
    ds_read_b64_tr_b16 v[56:57], v21 offset:0
    ds_read_b64_tr_b16 v[58:59], v21 offset:1024
    v_mfma_f32_16x16x32_bf16 v[204:207], v[60:63], v[124:127], v[204:207]
    ds_read_b64_tr_b16 v[60:61], v21 offset:8192
    ds_read_b64_tr_b16 v[62:63], v21 offset:9216
    v_mfma_f32_16x16x32_bf16 v[208:211], v[40:43], v[96:99], v[208:211]
    v_add_u32 v21, 0x10000, v21
    v_accvgpr_write_b32 a220, 0
    v_mfma_f32_16x16x32_bf16 v[208:211], v[44:47], v[100:103], v[208:211]
    buffer_load_dwordx4 v13, s[20:23], s64 offen offset:3072 lds
    v_mfma_f32_16x16x32_bf16 v[212:215], v[40:43], v[104:107], v[212:215]
    v_accvgpr_write_b32 a221, 0
    v_accvgpr_write_b32 a222, 0
    v_mfma_f32_16x16x32_bf16 v[212:215], v[44:47], v[108:111], v[212:215]
    v_accvgpr_write_b32 a223, 0
    v_mfma_f32_16x16x32_bf16 v[216:219], v[40:43], v[112:115], v[216:219]
    v_accvgpr_read_b32 v32, a224
    v_accvgpr_read_b32 v31, a225
    v_mfma_f32_16x16x32_bf16 v[216:219], v[44:47], v[116:119], v[216:219]
    v_cvt_pk_bf16_f32 v32, v32, v31
    v_accvgpr_read_b32 v33, a226
    v_mfma_f32_16x16x32_bf16 v[220:223], v[40:43], v[120:123], v[220:223]
    ds_read_b64_tr_b16 v[40:41], v26 offset:32768
    ds_read_b64_tr_b16 v[42:43], v26 offset:33280
    v_mfma_f32_16x16x32_bf16 v[220:223], v[44:47], v[124:127], v[220:223]
    s_waitcnt lgkmcnt(2)
    ds_read_b64_tr_b16 v[44:45], v26 offset:36864
    ds_read_b64_tr_b16 v[46:47], v26 offset:37376
    v_mfma_f32_16x16x32_bf16 v[224:227], v[48:51], v[96:99], v[224:227]
    v_add_u32 v26, 0xffff0000, v26
    v_accvgpr_read_b32 v31, a227
    v_mfma_f32_16x16x32_bf16 v[224:227], v[52:55], v[100:103], v[224:227]
    s_xor_b32 s64, s64, 1920
    v_cvt_pk_bf16_f32 v33, v33, v31
    v_accvgpr_read_b32 v34, a228
    v_mfma_f32_16x16x32_bf16 v[228:231], v[48:51], v[104:107], v[228:231]
    s_andn2_b32 s64, s64, 896
    v_accvgpr_read_b32 v31, a229
    v_cvt_pk_bf16_f32 v34, v34, v31
    v_mfma_f32_16x16x32_bf16 v[228:231], v[52:55], v[108:111], v[228:231]
    v_accvgpr_read_b32 v35, a230
    v_accvgpr_read_b32 v31, a231
    v_mfma_f32_16x16x32_bf16 v[232:235], v[48:51], v[112:115], v[232:235]
    v_cvt_pk_bf16_f32 v35, v35, v31
    v_mfma_f32_16x16x32_bf16 v[232:235], v[52:55], v[116:119], v[232:235]
    s_add_u32 m0, s69, 32768
    v_mfma_f32_16x16x32_bf16 v[236:239], v[48:51], v[120:123], v[236:239]
    buffer_load_dwordx4 v2, s[24:27], s60 offen lds
    v_mfma_f32_16x16x32_bf16 v[236:239], v[52:55], v[124:127], v[236:239]
    s_add_u32 s72, s71, 6144
    ds_read_b64_tr_b16 v[48:49], v27 offset:32768
    ds_read_b64_tr_b16 v[50:51], v27 offset:33280
    v_mfma_f32_16x16x32_bf16 v[240:243], v[56:59], v[96:99], v[240:243]
    ds_read_b64_tr_b16 v[52:53], v27 offset:36864
    ds_read_b64_tr_b16 v[54:55], v27 offset:37376
    v_mfma_f32_16x16x32_bf16 v[240:243], v[60:63], v[100:103], v[240:243]
    buffer_store_dwordx4 v[32:35], v1, s[36:39], s72 offen sc1
    v_mfma_f32_16x16x32_bf16 v[244:247], v[56:59], v[104:107], v[244:247]
    buffer_load_dwordx4 v3, s[24:27], s60 offen offset:1024 lds
    v_mfma_f32_16x16x32_bf16 v[244:247], v[60:63], v[108:111], v[244:247]
    v_add_u32 v27, 0xffff0000, v27
    v_mfma_f32_16x16x32_bf16 v[248:251], v[56:59], v[112:115], v[248:251]
    v_mfma_f32_16x16x32_bf16 v[248:251], v[60:63], v[116:119], v[248:251]
    v_mfma_f32_16x16x32_bf16 v[252:255], v[56:59], v[120:123], v[252:255]
    buffer_load_dwordx4 v4, s[24:27], s60 offen offset:2048 lds
    v_mfma_f32_16x16x32_bf16 v[252:255], v[60:63], v[124:127], v[252:255]
    s_waitcnt lgkmcnt(0)
    ds_read_b64_tr_b16 v[56:57], v28 offset:32768
    ds_read_b64_tr_b16 v[58:59], v28 offset:33280
    v_mfma_f32_16x16x32_bf16 a[64:67], v[40:43], v[96:99], a[64:67]
    ds_read_b64_tr_b16 v[60:61], v28 offset:36864
    ds_read_b64_tr_b16 v[62:63], v28 offset:37376
    v_mfma_f32_16x16x32_bf16 a[64:67], v[44:47], v[100:103], a[64:67]
    v_add_u32 v28, 0xffff0000, v28
    v_mfma_f32_16x16x32_bf16 a[68:71], v[40:43], v[104:107], a[68:71]
    buffer_load_dwordx4 v5, s[24:27], s60 offen offset:3072 lds
    v_mfma_f32_16x16x32_bf16 a[68:71], v[44:47], v[108:111], a[68:71]
    ds_read_b128 v[80:83], v24 offset:49152
    v_mfma_f32_16x16x32_bf16 a[72:75], v[40:43], v[112:115], a[72:75]
    v_mfma_f32_16x16x32_bf16 a[72:75], v[44:47], v[116:119], a[72:75]
    s_xor_b32 s60, s60, 7864320
    v_accvgpr_read_b32 v32, a232
    v_accvgpr_read_b32 v31, a233
    v_mfma_f32_16x16x32_bf16 a[76:79], v[40:43], v[120:123], a[76:79]
    s_add_u32 m0, s69, 49152
    ds_read_b128 v[84:87], v25 offset:49152
    v_cvt_pk_bf16_f32 v32, v32, v31
    v_mfma_f32_16x16x32_bf16 a[76:79], v[44:47], v[124:127], a[76:79]
    s_andn2_b32 s60, s60, 3670016
    buffer_load_dwordx4 v10, s[20:23], s63 offen lds
    v_mfma_f32_16x16x32_bf16 a[128:131], v[40:43], a[136:139], a[128:131]
    ds_read_b64_tr_b16 v[40:41], v29 offset:32768
    ds_read_b64_tr_b16 v[42:43], v29 offset:33280
    v_mfma_f32_16x16x32_bf16 a[128:131], v[44:47], a[140:143], a[128:131]
    ds_read_b64_tr_b16 v[44:45], v29 offset:36864
    ds_read_b64_tr_b16 v[46:47], v29 offset:37376
    v_mfma_f32_16x16x32_bf16 a[80:83], v[48:51], v[96:99], a[80:83]
    buffer_load_dwordx4 v11, s[20:23], s63 offen offset:1024 lds
    v_mfma_f32_16x16x32_bf16 a[80:83], v[52:55], v[100:103], a[80:83]
    ds_read_b128 v[88:91], v24 offset:57344
    v_add_u32 v29, 0xffff0000, v29
    v_mfma_f32_16x16x32_bf16 a[84:87], v[48:51], v[104:107], a[84:87]
    v_accvgpr_read_b32 v33, a234
    v_accvgpr_read_b32 v31, a235
    v_mfma_f32_16x16x32_bf16 a[84:87], v[52:55], v[108:111], a[84:87]
    v_cvt_pk_bf16_f32 v33, v33, v31
    v_accvgpr_read_b32 v34, a236
    v_mfma_f32_16x16x32_bf16 a[88:91], v[48:51], v[112:115], a[88:91]
    buffer_load_dwordx4 v12, s[20:23], s63 offen offset:2048 lds
    v_mfma_f32_16x16x32_bf16 a[88:91], v[52:55], v[116:119], a[88:91]
    ds_read_b128 v[92:95], v25 offset:57344
    v_accvgpr_read_b32 v31, a237
    v_mfma_f32_16x16x32_bf16 a[92:95], v[48:51], v[120:123], a[92:95]
    s_add_u32 s72, s71, 7168
    v_cvt_pk_bf16_f32 v34, v34, v31
    v_accvgpr_read_b32 v35, a238
    v_mfma_f32_16x16x32_bf16 a[92:95], v[52:55], v[124:127], a[92:95]
    v_accvgpr_read_b32 v31, a239
    v_cvt_pk_bf16_f32 v35, v35, v31
    v_mfma_f32_16x16x32_bf16 a[132:135], v[48:51], a[136:139], a[132:135]
    buffer_load_dwordx4 v13, s[20:23], s63 offen offset:3072 lds
    v_mfma_f32_16x16x32_bf16 a[132:135], v[52:55], a[140:143], a[132:135]
    s_waitcnt lgkmcnt(1)
    v_mfma_f32_16x16x32_bf16 a[96:99], v[56:59], v[96:99], a[96:99]
    v_mfma_f32_16x16x32_bf16 a[96:99], v[60:63], v[100:103], a[96:99]
    s_xor_b32 s63, s63, 128
    v_mfma_f32_16x16x32_bf16 a[100:103], v[56:59], v[104:107], a[100:103]
    buffer_store_dwordx4 v[32:35], v1, s[36:39], s72 offen sc1
    v_mfma_f32_16x16x32_bf16 a[100:103], v[60:63], v[108:111], a[100:103]
    v_mfma_f32_16x16x32_bf16 a[104:107], v[56:59], v[112:115], a[104:107]
    v_mfma_f32_16x16x32_bf16 a[104:107], v[60:63], v[116:119], a[104:107]
    s_waitcnt vmcnt(10) lgkmcnt(0)
    s_barrier
    ds_read_b64_tr_b16 v[48:49], v14 offset:0
    v_mfma_f32_16x16x32_bf16 a[108:111], v[56:59], v[120:123], a[108:111]
    s_add_u32 m0, s69, 65536
    ds_read_b64_tr_b16 v[50:51], v14 offset:1024
    ds_read_b64_tr_b16 v[52:53], v14 offset:8192
    v_mfma_f32_16x16x32_bf16 a[108:111], v[60:63], v[124:127], a[108:111]
    buffer_load_dwordx4 v2, s[24:27], s60 offen lds
    v_mfma_f32_16x16x32_bf16 a[112:115], v[40:43], v[96:99], a[112:115]
    ds_read_b64_tr_b16 v[54:55], v14 offset:9216
    ds_read_b64_tr_b16 v[56:57], v15 offset:0
    v_mfma_f32_16x16x32_bf16 a[112:115], v[44:47], v[100:103], a[112:115]
    ds_read_b64_tr_b16 v[58:59], v15 offset:1024
    ds_read_b64_tr_b16 v[60:61], v15 offset:8192
    v_mfma_f32_16x16x32_bf16 a[116:119], v[40:43], v[104:107], a[116:119]
    ds_read_b64_tr_b16 v[62:63], v15 offset:9216
    ds_read_b128 a[136:139], v22 offset:0
    v_mfma_f32_16x16x32_bf16 a[116:119], v[44:47], v[108:111], a[116:119]
    ds_read_b128 a[140:143], v23 offset:0
    v_add_u32 v14, 0xfffe0000, v14
    v_mfma_f32_16x16x32_bf16 a[120:123], v[40:43], v[112:115], a[120:123]
    v_add_u32 v15, 0xfffe0000, v15
    v_add_u32 v22, 0x10000, v22
    v_mfma_f32_16x16x32_bf16 a[120:123], v[44:47], v[116:119], a[120:123]
    buffer_load_dwordx4 v3, s[24:27], s60 offen offset:1024 lds
    v_mfma_f32_16x16x32_bf16 a[124:127], v[40:43], v[120:123], a[124:127]
    ds_read_b64_tr_b16 v[40:41], v16 offset:0
    ds_read_b64_tr_b16 v[42:43], v16 offset:1024
    v_mfma_f32_16x16x32_bf16 a[124:127], v[44:47], v[124:127], a[124:127]
    s_waitcnt lgkmcnt(3)
    ds_read_b64_tr_b16 v[44:45], v16 offset:8192
    ds_read_b64_tr_b16 v[46:47], v16 offset:9216
    v_mfma_f32_16x16x32_bf16 v[128:131], v[48:51], v[64:67], v[128:131]
    v_add_u32 v16, 0xfffe0000, v16
    v_add_u32 v23, 0x10000, v23
    v_mfma_f32_16x16x32_bf16 v[128:131], v[52:55], v[68:71], v[128:131]
    v_add_u32 v24, 0x10000, v24
    v_accvgpr_read_b32 v32, a240
    v_mfma_f32_16x16x32_bf16 v[132:135], v[48:51], v[72:75], v[132:135]
    ds_read_b128 v[96:99], v24 offset:16384
    v_accvgpr_read_b32 v31, a241
    v_mfma_f32_16x16x32_bf16 v[132:135], v[52:55], v[76:79], v[132:135]
    v_cvt_pk_bf16_f32 v32, v32, v31
    v_accvgpr_read_b32 v33, a242
    v_mfma_f32_16x16x32_bf16 v[136:139], v[48:51], v[80:83], v[136:139]
    v_accvgpr_read_b32 v31, a243
    v_cvt_pk_bf16_f32 v33, v33, v31
    v_mfma_f32_16x16x32_bf16 v[136:139], v[52:55], v[84:87], v[136:139]
    s_add_u32 s72, s71, 38912
    buffer_load_dwordx4 v4, s[24:27], s60 offen offset:2048 lds
    v_mfma_f32_16x16x32_bf16 v[140:143], v[48:51], v[88:91], v[140:143]
    ds_read_b64_tr_b16 v[48:49], v17 offset:0
    ds_read_b64_tr_b16 v[50:51], v17 offset:1024
    v_mfma_f32_16x16x32_bf16 v[140:143], v[52:55], v[92:95], v[140:143]
    ds_read_b64_tr_b16 v[52:53], v17 offset:8192
    ds_read_b64_tr_b16 v[54:55], v17 offset:9216
    v_mfma_f32_16x16x32_bf16 v[144:147], v[56:59], v[64:67], v[144:147]
    v_add_u32 v17, 0xfffe0000, v17
    v_accvgpr_read_b32 v34, a244
    v_mfma_f32_16x16x32_bf16 v[144:147], v[60:63], v[68:71], v[144:147]
    v_accvgpr_read_b32 v31, a245
    v_cvt_pk_bf16_f32 v34, v34, v31
    v_mfma_f32_16x16x32_bf16 v[148:151], v[56:59], v[72:75], v[148:151]
    v_accvgpr_read_b32 v35, a246
    v_accvgpr_read_b32 v31, a247
    v_mfma_f32_16x16x32_bf16 v[148:151], v[60:63], v[76:79], v[148:151]
    v_cvt_pk_bf16_f32 v35, v35, v31
    v_mov_b32 v2, v1
    v_mfma_f32_16x16x32_bf16 v[152:155], v[56:59], v[80:83], v[152:155]
    buffer_load_dwordx4 v5, s[24:27], s60 offen offset:3072 lds
    v_mfma_f32_16x16x32_bf16 v[152:155], v[60:63], v[84:87], v[152:155]
    v_add_u32 v25, 0x10000, v25
    ds_read_b128 v[100:103], v25 offset:16384
    v_mfma_f32_16x16x32_bf16 v[156:159], v[56:59], v[88:91], v[156:159]
    ds_read_b64_tr_b16 v[56:57], v18 offset:0
    ds_read_b64_tr_b16 v[58:59], v18 offset:1024
    v_mfma_f32_16x16x32_bf16 v[156:159], v[60:63], v[92:95], v[156:159]
    s_waitcnt lgkmcnt(3)
    ds_read_b64_tr_b16 v[60:61], v18 offset:8192
    ds_read_b64_tr_b16 v[62:63], v18 offset:9216
    v_mfma_f32_16x16x32_bf16 v[160:163], v[40:43], v[64:67], v[160:163]
    buffer_store_dwordx4 v[32:35], v1, s[36:39], s72 offen sc1
    v_mfma_f32_16x16x32_bf16 v[160:163], v[44:47], v[68:71], v[160:163]
    v_add_u32 v18, 0xfffe0000, v18
    v_mfma_f32_16x16x32_bf16 v[164:167], v[40:43], v[72:75], v[164:167]
    v_mfma_f32_16x16x32_bf16 v[164:167], v[44:47], v[76:79], v[164:167]
    s_add_u32 m0, s69, 81920
    v_accvgpr_read_b32 v32, a248
    v_accvgpr_read_b32 v31, a249
    v_mfma_f32_16x16x32_bf16 v[168:171], v[40:43], v[80:83], v[168:171]
    s_xor_b32 s60, s60, 524288
    buffer_load_dwordx4 v10, s[20:23], s64 offen lds
    v_mfma_f32_16x16x32_bf16 v[168:171], v[44:47], v[84:87], v[168:171]
    s_mov_b32 s60, 131072
    v_cvt_pk_bf16_f32 v32, v32, v31
    v_accvgpr_read_b32 v33, a250
    v_mfma_f32_16x16x32_bf16 v[172:175], v[40:43], v[88:91], v[172:175]
    ds_read_b64_tr_b16 v[40:41], v19 offset:0
    ds_read_b64_tr_b16 v[42:43], v19 offset:1024
    v_mfma_f32_16x16x32_bf16 v[172:175], v[44:47], v[92:95], v[172:175]
    ds_read_b64_tr_b16 v[44:45], v19 offset:8192
    ds_read_b64_tr_b16 v[46:47], v19 offset:9216
    v_mfma_f32_16x16x32_bf16 v[176:179], v[48:51], v[64:67], v[176:179]
    ds_read_b128 v[104:107], v24 offset:24576
    v_add_u32 v19, 0xfffe0000, v19
    v_mfma_f32_16x16x32_bf16 v[176:179], v[52:55], v[68:71], v[176:179]
    v_accvgpr_read_b32 v31, a251
    v_cvt_pk_bf16_f32 v33, v33, v31
    v_mfma_f32_16x16x32_bf16 v[180:183], v[48:51], v[72:75], v[180:183]
    v_accvgpr_read_b32 v34, a252
    v_accvgpr_read_b32 v31, a253
    v_mfma_f32_16x16x32_bf16 v[180:183], v[52:55], v[76:79], v[180:183]
    buffer_load_dwordx4 v11, s[20:23], s64 offen offset:1024 lds
    v_mfma_f32_16x16x32_bf16 v[184:187], v[48:51], v[80:83], v[184:187]
    v_cvt_pk_bf16_f32 v34, v34, v31
    v_accvgpr_read_b32 v35, a254
    v_mfma_f32_16x16x32_bf16 v[184:187], v[52:55], v[84:87], v[184:187]
    v_accvgpr_read_b32 v31, a255
    v_cvt_pk_bf16_f32 v35, v35, v31
    v_mfma_f32_16x16x32_bf16 v[188:191], v[48:51], v[88:91], v[188:191]
    s_add_u32 s72, s71, 39936
    ds_read_b64_tr_b16 v[48:49], v20 offset:0
    ds_read_b64_tr_b16 v[50:51], v20 offset:1024
    v_mfma_f32_16x16x32_bf16 v[188:191], v[52:55], v[92:95], v[188:191]
    s_waitcnt lgkmcnt(2)
    ds_read_b64_tr_b16 v[52:53], v20 offset:8192
    ds_read_b64_tr_b16 v[54:55], v20 offset:9216
    v_mfma_f32_16x16x32_bf16 v[192:195], v[56:59], v[64:67], v[192:195]
    v_mov_b32 v31, 1
    v_add_u32 v20, 0xfffe0000, v20
    v_mfma_f32_16x16x32_bf16 v[192:195], v[60:63], v[68:71], v[192:195]
    buffer_store_dwordx4 v[32:35], v1, s[36:39], s72 offen sc1
    v_mfma_f32_16x16x32_bf16 v[196:199], v[56:59], v[72:75], v[196:199]
    v_add_u32 v11, s99, v39
    v_mfma_f32_16x16x32_bf16 v[196:199], v[60:63], v[76:79], v[196:199]
    s_mul_i32 s99, s98, 6
    buffer_load_dwordx4 v12, s[20:23], s64 offen offset:2048 lds
    v_mfma_f32_16x16x32_bf16 v[200:203], v[56:59], v[80:83], v[200:203]
    s_sub_u32 s99, s8, s99
    ds_read_b128 v[108:111], v25 offset:24576
    v_mfma_f32_16x16x32_bf16 v[200:203], v[60:63], v[84:87], v[200:203]
    s_mul_i32 s99, s99, 6
    v_mfma_f32_16x16x32_bf16 v[204:207], v[56:59], v[88:91], v[204:207]
    s_lshr_b32 s8, s5, 3
    ds_read_b64_tr_b16 v[56:57], v21 offset:0
    ds_read_b64_tr_b16 v[58:59], v21 offset:1024
    v_mfma_f32_16x16x32_bf16 v[204:207], v[60:63], v[92:95], v[204:207]
    s_lshl1_add_u32 s99, s4, s99
    ds_read_b64_tr_b16 v[60:61], v21 offset:8192
    ds_read_b64_tr_b16 v[62:63], v21 offset:9216
    v_mfma_f32_16x16x32_bf16 v[208:211], v[40:43], v[64:67], v[208:211]
    s_mul_i32 s8, s8, 6
    v_add_u32 v21, 0xfffe0000, v21
    v_mfma_f32_16x16x32_bf16 v[208:211], v[44:47], v[68:71], v[208:211]
    s_cmp_lt_u32 s98, 6
    s_cselect_b32 s98, s98, 40
    v_mfma_f32_16x16x32_bf16 v[212:215], v[40:43], v[72:75], v[212:215]
    s_sub_u32 s99, s99, 2
    buffer_load_dwordx4 v13, s[20:23], s64 offen offset:3072 lds
    v_mfma_f32_16x16x32_bf16 v[212:215], v[44:47], v[76:79], v[212:215]
    s_add_u32 s98, s98, s8
    v_mfma_f32_16x16x32_bf16 v[216:219], v[40:43], v[80:83], v[216:219]
    s_lshl_b32 s8, s99, 5
    v_lshl_add_u32 v10, v38, 4, s8
    v_lshrrev_b32 v38, 2, v37
    v_mfma_f32_16x16x32_bf16 v[216:219], v[44:47], v[84:87], v[216:219]
    s_lshr_b32 s99, s99, 1
    v_lshl_add_u32 v38, s98, 2, v38
    v_mul_u32_u24 v39, 171, v38
    v_mfma_f32_16x16x32_bf16 v[220:223], v[40:43], v[88:91], v[220:223]
    s_add_u32 s98, s98, 128
    ds_read_b64_tr_b16 v[40:41], v26 offset:0
    ds_read_b64_tr_b16 v[42:43], v26 offset:512
    v_mfma_f32_16x16x32_bf16 v[220:223], v[44:47], v[92:95], v[220:223]
    s_add_u32 s8, s100, 16
    ds_read_b64_tr_b16 v[44:45], v26 offset:4096
    ds_read_b64_tr_b16 v[46:47], v26 offset:4608
    s_waitcnt lgkmcnt(4)
    v_mfma_f32_16x16x32_bf16 v[224:227], v[48:51], v[64:67], v[224:227]
    v_add_u32 v26, 0x10000, v26
    v_and_b32 v37, 3, v37
    v_mfma_f32_16x16x32_bf16 v[224:227], v[52:55], v[68:71], v[224:227]
    s_xor_b32 s64, s64, 128
    v_lshrrev_b32 v39, 9, v39
    v_lshl_add_u32 v37, v38, 3, v37
    v_mfma_f32_16x16x32_bf16 v[228:231], v[48:51], v[72:75], v[228:231]
    v_mul_u32_u24 v38, 24, v39
    v_sub_u32 v37, v37, v38
    v_mfma_f32_16x16x32_bf16 v[228:231], v[52:55], v[76:79], v[228:231]
    v_mad_u32_u24 v39, v39, 18, v37
    v_mul_u32_u24 v39, 1152, v39
    v_mfma_f32_16x16x32_bf16 v[232:235], v[48:51], v[80:83], v[232:235]
    v_add_u32 v39, v39, v10
    v_add_u32 v12, 0, v39
    v_mfma_f32_16x16x32_bf16 v[232:235], v[52:55], v[84:87], v[232:235]
    s_add_u32 m0, s67, 98304
    v_mov_b32 v38, 1073741824
    v_cmp_gt_u32 vcc, 18, v37
    v_mfma_f32_16x16x32_bf16 v[236:239], v[48:51], v[88:91], v[236:239]
    buffer_load_dwordx4 v1, s[28:31], s65 offen sc1 lds
    v_mfma_f32_16x16x32_bf16 v[236:239], v[52:55], v[92:95], v[236:239]
    ds_read_b64_tr_b16 v[48:49], v27 offset:0
    ds_read_b64_tr_b16 v[50:51], v27 offset:512
    v_mfma_f32_16x16x32_bf16 v[240:243], v[56:59], v[64:67], v[240:243]
    ds_read_b64_tr_b16 v[52:53], v27 offset:4096
    ds_read_b64_tr_b16 v[54:55], v27 offset:4608
    v_mfma_f32_16x16x32_bf16 v[240:243], v[60:63], v[68:71], v[240:243]
    v_add_u32 v27, 0x10000, v27
    v_cndmask_b32 v12, v38, v12, vcc
    v_mfma_f32_16x16x32_bf16 v[244:247], v[56:59], v[72:75], v[244:247]
    v_add_u32 v38, 1024, v36
    v_add_u32 v13, 4608, v39
    v_mfma_f32_16x16x32_bf16 v[244:247], v[60:63], v[76:79], v[244:247]
    s_cmp_eq_u32 s4, 0
    s_cselect_b64 vcc, -1, 0
    v_cndmask_b32 v12, v12, v38, vcc
    v_mfma_f32_16x16x32_bf16 v[248:251], v[56:59], v[80:83], v[248:251]
    v_mov_b32 v38, 1073741824
    v_cmp_gt_u32 vcc, 14, v37
    v_mfma_f32_16x16x32_bf16 v[248:251], v[60:63], v[84:87], v[248:251]
    v_lshrrev_b32 v37, 8, v1
    v_cndmask_b32 v13, v38, v13, vcc
    v_mfma_f32_16x16x32_bf16 v[252:255], v[56:59], v[88:91], v[252:255]
    ds_read_b64_tr_b16 v[56:57], v28 offset:0
    ds_read_b64_tr_b16 v[58:59], v28 offset:512
    v_mfma_f32_16x16x32_bf16 v[252:255], v[60:63], v[92:95], v[252:255]
    s_waitcnt lgkmcnt(2)
    ds_read_b64_tr_b16 v[60:61], v28 offset:4096
    ds_read_b64_tr_b16 v[62:63], v28 offset:4608
    v_mfma_f32_16x16x32_bf16 a[64:67], v[40:43], v[64:67], a[64:67]
    buffer_load_dwordx4 v1, s[28:31], s65 offen offset:1024 sc1 lds
    v_mfma_f32_16x16x32_bf16 a[64:67], v[44:47], v[68:71], a[64:67]
    v_add_u32 v24, 0xfffe0000, v24
    v_add_u32 v28, 0x10000, v28
    v_mfma_f32_16x16x32_bf16 a[68:71], v[40:43], v[72:75], a[68:71]
    ds_read_b128 v[112:115], v24 offset:16384
    v_add_u32 v38, 19456, v36
    v_mfma_f32_16x16x32_bf16 a[68:71], v[44:47], v[76:79], a[68:71]
    s_cmp_eq_u32 s4, 0
    s_cselect_b64 vcc, -1, 0
    v_cndmask_b32 v13, v13, v38, vcc
    v_mfma_f32_16x16x32_bf16 a[72:75], v[40:43], v[80:83], a[72:75]
    s_cmp_eq_u32 s4, 0
    s_cselect_b32 s98, s7, s98
    s_cselect_b32 s99, s8, s99
    v_mfma_f32_16x16x32_bf16 a[72:75], v[44:47], v[84:87], a[72:75]
    s_lshr_b32 s9, s99, 2
    v_add_u32 v25, 0xfffe0000, v25
    v_bfe_u32 v36, v1, 4, 4
    v_mfma_f32_16x16x32_bf16 a[76:79], v[40:43], v[88:91], a[76:79]
    s_lshr_b32 s92, s2, 3
    ds_read_b128 v[116:119], v25 offset:16384
    v_lshrrev_b32 v9, 4, v1
    v_mfma_f32_16x16x32_bf16 a[76:79], v[44:47], v[92:95], a[76:79]
    s_lshl2_add_u32 s92, s92, s4
    v_min_u32 v9, 0, v9
    v_lshlrev_b32 v37, 2, v37
    v_mfma_f32_16x16x32_bf16 a[128:131], v[40:43], a[136:139], a[128:131]
    s_mul_i32 s92, s92, 1
    ds_read_b64_tr_b16 v[40:41], v29 offset:0
    ds_read_b64_tr_b16 v[42:43], v29 offset:512
    v_mfma_f32_16x16x32_bf16 a[128:131], v[44:47], a[140:143], a[128:131]
    s_add_u32 s92, s92, 32
    v_add_lshl_u32 v9, v9, s92, 7
    ds_read_b64_tr_b16 v[44:45], v29 offset:4096
    v_mfma_f32_16x16x32_bf16 a[80:83], v[48:51], v[64:67], a[80:83]
    s_add_u32 m0, s68, 106496
    ds_read_b128 v[120:123], v24 offset:24576
    ds_read_b64_tr_b16 v[46:47], v29 offset:4608
    v_mfma_f32_16x16x32_bf16 a[80:83], v[52:55], v[68:71], a[80:83]
    s_getpc_b64 s[92:93]
    global_load_dword v9, v9, s[92:93]
    v_mfma_f32_16x16x32_bf16 a[84:87], v[48:51], v[72:75], a[84:87]
    s_sub_u32 s9, s9, s10
    buffer_load_dwordx4 v6, s[20:23], s66 offen lds
    v_mfma_f32_16x16x32_bf16 a[84:87], v[52:55], v[76:79], a[84:87]
    s_sub_u32 s9, s9, 1
    v_add_u32 v29, 0x10000, v29
    v_sub_u32 v36, v36, v37
    v_mfma_f32_16x16x32_bf16 a[88:91], v[48:51], v[80:83], a[88:91]
    s_and_b32 s9, s9, 3
    ds_read_b128 v[124:127], v25 offset:24576
    v_mov_b32 v37, 0xf149f2ca
    v_mfma_f32_16x16x32_bf16 a[88:91], v[52:55], v[84:87], a[88:91]
    s_lshl_b32 s9, s9, 1
    v_bfe_u32 v38, v1, 4, 2
    v_and_b32 v39, 0x40, v1
    v_mfma_f32_16x16x32_bf16 a[92:95], v[48:51], v[88:91], a[92:95]
    s_and_b32 s10, s99, 3
    v_mfma_f32_16x16x32_bf16 a[92:95], v[52:55], v[92:95], a[92:95]
    s_cmp_eq_u32 s9, 6
    s_cselect_b32 s9, 7, s9
    v_mfma_f32_16x16x32_bf16 a[132:135], v[48:51], a[136:139], a[132:135]
    s_mul_i32 s10, s10, 9
    v_mfma_f32_16x16x32_bf16 a[132:135], v[52:55], a[140:143], a[132:135]
    s_add_u32 s9, s9, s10
    s_waitcnt lgkmcnt(0)
    v_mfma_f32_16x16x32_bf16 a[96:99], v[56:59], v[64:67], a[96:99]
    s_lshl_b32 s64, s9, 10
    v_mfma_f32_16x16x32_bf16 a[96:99], v[60:63], v[68:71], a[96:99]
    s_xor_b32 s65, s65, 122880
    v_mfma_f32_16x16x32_bf16 a[100:103], v[56:59], v[72:75], a[100:103]
    s_xor_b32 s66, s66, 1920
    v_mfma_f32_16x16x32_bf16 a[100:103], v[60:63], v[76:79], a[100:103]
    s_andn2_b32 s65, s65, 57344
    v_mfma_f32_16x16x32_bf16 a[104:107], v[56:59], v[80:83], a[104:107]
    s_andn2_b32 s66, s66, 896
    v_mfma_f32_16x16x32_bf16 a[104:107], v[60:63], v[84:87], a[104:107]
    s_waitcnt vmcnt(4) lgkmcnt(0)
    s_barrier
    ds_read_b64_tr_b16 v[48:49], v14 offset:32768
    v_mfma_f32_16x16x32_bf16 a[108:111], v[56:59], v[88:91], a[108:111]
    s_add_u32 m0, s67, 131072
    buffer_store_dword v31, v30, s[32:35], s101 offen sc1
    v_mfma_f32_16x16x32_bf16 a[108:111], v[60:63], v[92:95], a[108:111]
    s_sub_u32 s9, s99, 16
    buffer_load_dwordx4 v1, s[28:31], s65 offen sc1 lds
    v_mfma_f32_16x16x32_bf16 a[112:115], v[40:43], v[64:67], a[112:115]
    s_mul_i32 s9, s9, 18432
    ds_read_b64_tr_b16 v[50:51], v14 offset:33792
    ds_read_b64_tr_b16 v[52:53], v14 offset:40960
    v_mfma_f32_16x16x32_bf16 a[112:115], v[44:47], v[68:71], a[112:115]
    s_add_u32 s9, s9, 6144
    ds_read_b64_tr_b16 v[54:55], v14 offset:41984
    ds_read_b64_tr_b16 v[56:57], v15 offset:32768
    v_mfma_f32_16x16x32_bf16 a[116:119], v[40:43], v[72:75], a[116:119]
    s_mov_b32 s10, 1024
    ds_read_b64_tr_b16 v[58:59], v15 offset:33792
    ds_read_b64_tr_b16 v[60:61], v15 offset:40960
    v_mfma_f32_16x16x32_bf16 a[116:119], v[44:47], v[76:79], a[116:119]
    s_mul_i32 s98, s98, 36864
    ds_read_b64_tr_b16 v[62:63], v15 offset:41984
    v_add_u32 v14, 0x10000, v14
    v_mfma_f32_16x16x32_bf16 a[120:123], v[40:43], v[80:83], a[120:123]
    s_mul_i32 s7, s7, 36864
    v_add_u32 v15, 0x10000, v15
    v_mfma_f32_16x16x32_bf16 a[120:123], v[44:47], v[84:87], a[120:123]
    s_cmp_lt_u32 s99, 16
    s_cselect_b32 s64, s64, s9
    s_cselect_b32 s10, s10, 9216
    v_mfma_f32_16x16x32_bf16 a[124:127], v[40:43], v[88:91], a[124:127]
    s_lshl2_add_u32 s99, s100, s4
    ds_read_b64_tr_b16 v[40:41], v16 offset:32768
    ds_read_b64_tr_b16 v[42:43], v16 offset:33792
    v_mfma_f32_16x16x32_bf16 a[124:127], v[44:47], v[92:95], a[124:127]
    s_add_u32 s64, s64, s98
    ds_read_b64_tr_b16 v[44:45], v16 offset:40960
    ds_read_b64_tr_b16 v[46:47], v16 offset:41984
    s_waitcnt lgkmcnt(5)
    v_mfma_f32_16x16x32_bf16 v[128:131], v[48:51], v[96:99], v[128:131]
    s_lshl_b32 s99, s99, 1
    v_add_u32 v16, 0x10000, v16
    v_mfma_f32_16x16x32_bf16 v[128:131], v[52:55], v[100:103], v[128:131]
    s_add_u32 s62, s64, s10
    v_mfma_f32_16x16x32_bf16 v[132:135], v[48:51], v[104:107], v[132:135]
    s_lshr_b32 s9, s99, 2
    ds_read_b128 v[64:67], v24 offset:49152
    v_mfma_f32_16x16x32_bf16 v[132:135], v[52:55], v[108:111], v[132:135]
    s_lshr_b32 s10, s5, 3
    v_mfma_f32_16x16x32_bf16 v[136:139], v[48:51], v[112:115], v[136:139]
    s_sub_u32 s9, s9, s10
    v_mfma_f32_16x16x32_bf16 v[136:139], v[52:55], v[116:119], v[136:139]
    s_sub_u32 s9, s9, 1
    v_mfma_f32_16x16x32_bf16 v[140:143], v[48:51], v[120:123], v[140:143]
    s_and_b32 s9, s9, 3
    ds_read_b64_tr_b16 v[48:49], v17 offset:32768
    ds_read_b64_tr_b16 v[50:51], v17 offset:33792
    v_mfma_f32_16x16x32_bf16 v[140:143], v[52:55], v[124:127], v[140:143]
    s_lshl_b32 s9, s9, 1
    ds_read_b64_tr_b16 v[52:53], v17 offset:40960
    ds_read_b64_tr_b16 v[54:55], v17 offset:41984
    v_mfma_f32_16x16x32_bf16 v[144:147], v[56:59], v[96:99], v[144:147]
    s_and_b32 s10, s99, 3
    ds_read_b128 v[68:71], v25 offset:49152
    v_add_u32 v17, 0x10000, v17
    s_waitcnt lgkmcnt(5)
    v_mfma_f32_16x16x32_bf16 v[144:147], v[60:63], v[100:103], v[144:147]
    s_cmp_eq_u32 s9, 6
    s_cselect_b32 s9, 7, s9
    v_mfma_f32_16x16x32_bf16 v[148:151], v[56:59], v[104:107], v[148:151]
    s_mul_i32 s10, s10, 9
    buffer_load_dwordx4 v1, s[28:31], s65 offen offset:1024 sc1 lds
    v_mfma_f32_16x16x32_bf16 v[148:151], v[60:63], v[108:111], v[148:151]
    s_add_u32 s9, s9, s10
    v_mfma_f32_16x16x32_bf16 v[152:155], v[56:59], v[112:115], v[152:155]
    s_lshl_b32 s63, s9, 10
    v_mfma_f32_16x16x32_bf16 v[152:155], v[60:63], v[116:119], v[152:155]
    s_cmp_eq_u32 s4, 0
    s_cselect_b32 s8, 1.0, 0
    v_mfma_f32_16x16x32_bf16 v[156:159], v[56:59], v[120:123], v[156:159]
    s_add_u32 s63, s63, s7
    ds_read_b128 v[72:75], v24 offset:57344
    ds_read_b64_tr_b16 v[56:57], v18 offset:32768
    v_mfma_f32_16x16x32_bf16 v[156:159], v[60:63], v[124:127], v[156:159]
    ds_read_b64_tr_b16 v[58:59], v18 offset:33792
    ds_read_b64_tr_b16 v[60:61], v18 offset:40960
    v_mfma_f32_16x16x32_bf16 v[160:163], v[40:43], v[96:99], v[160:163]
    ds_read_b64_tr_b16 v[62:63], v18 offset:41984
    v_add_u32 v18, 0x10000, v18
    v_mfma_f32_16x16x32_bf16 v[160:163], v[44:47], v[100:103], v[160:163]
    s_cmp_eq_u32 s4, 1
    s_cselect_b32 s9, 1.0, 0
    v_mfma_f32_16x16x32_bf16 v[164:167], v[40:43], v[104:107], v[164:167]
    s_cmp_eq_u32 s6, 0
    s_cselect_b32 s16, s8, 0
    s_cselect_b32 s17, s9, 0
    v_mfma_f32_16x16x32_bf16 v[164:167], v[44:47], v[108:111], v[164:167]
    s_cmp_eq_u32 s4, 2
    s_cselect_b32 s10, 1.0, 0
    v_mfma_f32_16x16x32_bf16 v[168:171], v[40:43], v[112:115], v[168:171]
    ds_read_b128 v[76:79], v25 offset:57344
    v_mfma_f32_16x16x32_bf16 v[168:171], v[44:47], v[116:119], v[168:171]
    s_cmp_eq_u32 s6, 0
    s_cselect_b32 s18, s10, 0
    s_cselect_b32 s19, s11, 0
    v_mfma_f32_16x16x32_bf16 v[172:175], v[40:43], v[120:123], v[172:175]
    ds_read_b64_tr_b16 v[40:41], v19 offset:32768
    ds_read_b64_tr_b16 v[42:43], v19 offset:33792
    v_mfma_f32_16x16x32_bf16 v[172:175], v[44:47], v[124:127], v[172:175]
    s_waitcnt lgkmcnt(3)
    ds_read_b64_tr_b16 v[44:45], v19 offset:40960
    ds_read_b64_tr_b16 v[46:47], v19 offset:41984
    v_mfma_f32_16x16x32_bf16 v[176:179], v[48:51], v[96:99], v[176:179]
    v_add_u32 v19, 0x10000, v19
    v_mfma_f32_16x16x32_bf16 v[176:179], v[52:55], v[100:103], v[176:179]
    v_mfma_f32_16x16x32_bf16 v[180:183], v[48:51], v[104:107], v[180:183]
    v_mfma_f32_16x16x32_bf16 v[180:183], v[52:55], v[108:111], v[180:183]
    v_add_u32 v24, 0x10000, v24
    v_mfma_f32_16x16x32_bf16 v[184:187], v[48:51], v[112:115], v[184:187]
    ds_read_b128 v[80:83], v24 offset:16384
    v_mfma_f32_16x16x32_bf16 v[184:187], v[52:55], v[116:119], v[184:187]
    s_add_u32 m0, s68, 139264
    v_mfma_f32_16x16x32_bf16 v[188:191], v[48:51], v[120:123], v[188:191]
    buffer_load_dwordx4 v6, s[20:23], s66 offen lds
    v_mfma_f32_16x16x32_bf16 v[188:191], v[52:55], v[124:127], v[188:191]
    ds_read_b64_tr_b16 v[48:49], v20 offset:32768
    ds_read_b64_tr_b16 v[50:51], v20 offset:33792
    v_mfma_f32_16x16x32_bf16 v[192:195], v[56:59], v[96:99], v[192:195]
    ds_read_b64_tr_b16 v[52:53], v20 offset:40960
    ds_read_b64_tr_b16 v[54:55], v20 offset:41984
    v_mfma_f32_16x16x32_bf16 v[192:195], v[60:63], v[100:103], v[192:195]
    v_add_u32 v25, 0x10000, v25
    v_add_u32 v20, 0x10000, v20
    v_mfma_f32_16x16x32_bf16 v[196:199], v[56:59], v[104:107], v[196:199]
    ds_read_b128 v[84:87], v25 offset:16384
    v_mfma_f32_16x16x32_bf16 v[196:199], v[60:63], v[108:111], v[196:199]
    s_cmp_eq_u32 s6, 0
    s_cselect_b32 s20, s12, 0
    s_cselect_b32 s21, s13, 0
    v_mfma_f32_16x16x32_bf16 v[200:203], v[56:59], v[112:115], v[200:203]
    s_cmp_eq_u32 s6, 0
    s_cselect_b32 s22, s14, 0
    s_cselect_b32 s23, s15, 0
    v_mfma_f32_16x16x32_bf16 v[200:203], v[60:63], v[116:119], v[200:203]
    v_mfma_f32_16x16x32_bf16 v[204:207], v[56:59], v[120:123], v[204:207]
    ds_read_b64_tr_b16 v[56:57], v21 offset:32768
    ds_read_b64_tr_b16 v[58:59], v21 offset:33792
    v_mfma_f32_16x16x32_bf16 v[204:207], v[60:63], v[124:127], v[204:207]
    s_waitcnt lgkmcnt(2)
    ds_read_b64_tr_b16 v[60:61], v21 offset:40960
    ds_read_b64_tr_b16 v[62:63], v21 offset:41984
    v_mfma_f32_16x16x32_bf16 v[208:211], v[40:43], v[96:99], v[208:211]
    ds_read_b128 v[88:91], v24 offset:24576
    v_add_u32 v21, 0x10000, v21
    v_mfma_f32_16x16x32_bf16 v[208:211], v[44:47], v[100:103], v[208:211]
    v_mfma_f32_16x16x32_bf16 v[212:215], v[40:43], v[104:107], v[212:215]
    v_mfma_f32_16x16x32_bf16 v[212:215], v[44:47], v[108:111], v[212:215]
    v_mfma_f32_16x16x32_bf16 v[216:219], v[40:43], v[112:115], v[216:219]
    v_mfma_f32_16x16x32_bf16 v[216:219], v[44:47], v[116:119], v[216:219]
    v_mfma_f32_16x16x32_bf16 v[220:223], v[40:43], v[120:123], v[220:223]
    ds_read_b128 v[92:95], v25 offset:24576
    ds_read_b64_tr_b16 v[40:41], v14 offset:0
    v_mfma_f32_16x16x32_bf16 v[220:223], v[44:47], v[124:127], v[220:223]
    ds_read_b64_tr_b16 v[42:43], v14 offset:1024
    ds_read_b64_tr_b16 v[44:45], v14 offset:8192
    v_mfma_f32_16x16x32_bf16 v[224:227], v[48:51], v[96:99], v[224:227]
    ds_read_b64_tr_b16 v[46:47], v14 offset:9216
    v_mfma_f32_16x16x32_bf16 v[224:227], v[52:55], v[100:103], v[224:227]
    s_xor_b32 s65, s65, 8192
    v_mfma_f32_16x16x32_bf16 v[228:231], v[48:51], v[104:107], v[228:231]
    s_xor_b32 s66, s66, 128
    v_mfma_f32_16x16x32_bf16 v[228:231], v[52:55], v[108:111], v[228:231]
    v_mfma_f32_16x16x32_bf16 v[232:235], v[48:51], v[112:115], v[232:235]
    v_mfma_f32_16x16x32_bf16 v[232:235], v[52:55], v[116:119], v[232:235]
    v_mfma_f32_16x16x32_bf16 v[236:239], v[48:51], v[120:123], v[236:239]
    ds_read_b64_tr_b16 v[48:49], v15 offset:0
    ds_read_b64_tr_b16 v[50:51], v15 offset:1024
    v_mfma_f32_16x16x32_bf16 v[236:239], v[52:55], v[124:127], v[236:239]
    s_waitcnt lgkmcnt(2)
    ds_read_b64_tr_b16 v[52:53], v15 offset:8192
    ds_read_b64_tr_b16 v[54:55], v15 offset:9216
    v_mfma_f32_16x16x32_bf16 v[240:243], v[56:59], v[96:99], v[240:243]
    v_mfma_f32_16x16x32_bf16 v[240:243], v[60:63], v[100:103], v[240:243]
    v_mfma_f32_16x16x32_bf16 v[244:247], v[56:59], v[104:107], v[244:247]
    v_mfma_f32_16x16x32_bf16 v[244:247], v[60:63], v[108:111], v[244:247]
    v_mfma_f32_16x16x32_bf16 v[248:251], v[56:59], v[112:115], v[248:251]
    v_mfma_f32_16x16x32_bf16 v[248:251], v[60:63], v[116:119], v[248:251]
    v_mfma_f32_16x16x32_bf16 v[252:255], v[56:59], v[120:123], v[252:255]
    ds_read_b64_tr_b16 v[56:57], v16 offset:0
    ds_read_b64_tr_b16 v[58:59], v16 offset:1024
    v_mfma_f32_16x16x32_bf16 v[252:255], v[60:63], v[124:127], v[252:255]
    buffer_load_dword v7, v8, s[32:35], s61 offen sc1
    v_mfma_f32_16x16x32_bf16 v[128:131], v[40:43], v[64:67], v[128:131]
    ds_read_b64_tr_b16 v[60:61], v16 offset:8192
    ds_read_b64_tr_b16 v[62:63], v16 offset:9216
    v_mfma_f32_16x16x32_bf16 v[128:131], v[44:47], v[68:71], v[128:131]
    v_mfma_f32_16x16x32_bf16 v[132:135], v[40:43], v[72:75], v[132:135]
    v_mfma_f32_16x16x32_bf16 v[132:135], v[44:47], v[76:79], v[132:135]
    v_mfma_f32_16x16x32_bf16 v[136:139], v[40:43], v[80:83], v[136:139]
    v_mfma_f32_16x16x32_bf16 v[136:139], v[44:47], v[84:87], v[136:139]
    v_mfma_f32_16x16x32_bf16 v[140:143], v[40:43], v[88:91], v[140:143]
    ds_read_b64_tr_b16 v[40:41], v17 offset:0
    ds_read_b64_tr_b16 v[42:43], v17 offset:1024
    v_mfma_f32_16x16x32_bf16 v[140:143], v[44:47], v[92:95], v[140:143]
    s_waitcnt lgkmcnt(2)
    ds_read_b64_tr_b16 v[44:45], v17 offset:8192
    ds_read_b64_tr_b16 v[46:47], v17 offset:9216
    v_mfma_f32_16x16x32_bf16 v[144:147], v[48:51], v[64:67], v[144:147]
    v_cvt_pk_bf16_f32 v128, v128, v129
    v_cvt_pk_bf16_f32 v129, v130, v131
    v_mfma_f32_16x16x32_bf16 v[144:147], v[52:55], v[68:71], v[144:147]
    v_cvt_pk_bf16_f32 v132, v132, v133
    v_cvt_pk_bf16_f32 v133, v134, v135
    v_mfma_f32_16x16x32_bf16 v[148:151], v[48:51], v[72:75], v[148:151]
    v_cvt_pk_bf16_f32 v136, v136, v137
    v_cvt_pk_bf16_f32 v137, v138, v139
    v_mfma_f32_16x16x32_bf16 v[148:151], v[52:55], v[76:79], v[148:151]
    v_cvt_pk_bf16_f32 v140, v140, v141
    v_cvt_pk_bf16_f32 v141, v142, v143
    v_mfma_f32_16x16x32_bf16 v[152:155], v[48:51], v[80:83], v[152:155]
    v_cvt_pk_bf16_f32 v130, v144, v145
    v_cvt_pk_bf16_f32 v131, v146, v147
    v_mfma_f32_16x16x32_bf16 v[152:155], v[52:55], v[84:87], v[152:155]
    v_mfma_f32_16x16x32_bf16 v[156:159], v[48:51], v[88:91], v[156:159]
    ds_read_b64_tr_b16 v[48:49], v18 offset:0
    ds_read_b64_tr_b16 v[50:51], v18 offset:1024
    v_mfma_f32_16x16x32_bf16 v[156:159], v[52:55], v[92:95], v[156:159]
    ds_read_b64_tr_b16 v[52:53], v18 offset:8192
    ds_read_b64_tr_b16 v[54:55], v18 offset:9216
    v_mfma_f32_16x16x32_bf16 v[160:163], v[56:59], v[64:67], v[160:163]
    v_cvt_pk_bf16_f32 v134, v148, v149
    v_cvt_pk_bf16_f32 v135, v150, v151
    v_mfma_f32_16x16x32_bf16 v[160:163], v[60:63], v[68:71], v[160:163]
    v_cvt_pk_bf16_f32 v138, v152, v153
    v_cvt_pk_bf16_f32 v139, v154, v155
    v_mfma_f32_16x16x32_bf16 v[164:167], v[56:59], v[72:75], v[164:167]
    v_cvt_pk_bf16_f32 v142, v156, v157
    v_cvt_pk_bf16_f32 v143, v158, v159
    v_mfma_f32_16x16x32_bf16 v[164:167], v[60:63], v[76:79], v[164:167]
    v_mfma_f32_16x16x32_bf16 v[168:171], v[56:59], v[80:83], v[168:171]
    v_mfma_f32_16x16x32_bf16 v[168:171], v[60:63], v[84:87], v[168:171]
    v_cvt_pk_bf16_f32 v160, v160, v161
    v_cvt_pk_bf16_f32 v161, v162, v163
    v_mfma_f32_16x16x32_bf16 v[172:175], v[56:59], v[88:91], v[172:175]
    ds_read_b64_tr_b16 v[56:57], v19 offset:0
    ds_read_b64_tr_b16 v[58:59], v19 offset:1024
    v_mfma_f32_16x16x32_bf16 v[172:175], v[60:63], v[92:95], v[172:175]
    s_waitcnt lgkmcnt(2)
    ds_read_b64_tr_b16 v[60:61], v19 offset:8192
    ds_read_b64_tr_b16 v[62:63], v19 offset:9216
    v_mfma_f32_16x16x32_bf16 v[176:179], v[40:43], v[64:67], v[176:179]
    v_cvt_pk_bf16_f32 v164, v164, v165
    v_cvt_pk_bf16_f32 v165, v166, v167
    v_mfma_f32_16x16x32_bf16 v[176:179], v[44:47], v[68:71], v[176:179]
    v_cvt_pk_bf16_f32 v168, v168, v169
    v_cvt_pk_bf16_f32 v169, v170, v171
    v_mfma_f32_16x16x32_bf16 v[180:183], v[40:43], v[72:75], v[180:183]
    v_cvt_pk_bf16_f32 v172, v172, v173
    v_cvt_pk_bf16_f32 v173, v174, v175
    v_mfma_f32_16x16x32_bf16 v[180:183], v[44:47], v[76:79], v[180:183]
    v_mfma_f32_16x16x32_bf16 v[184:187], v[40:43], v[80:83], v[184:187]
    v_mfma_f32_16x16x32_bf16 v[184:187], v[44:47], v[84:87], v[184:187]
    v_cvt_pk_bf16_f32 v162, v176, v177
    v_cvt_pk_bf16_f32 v163, v178, v179
    v_mfma_f32_16x16x32_bf16 v[188:191], v[40:43], v[88:91], v[188:191]
    ds_read_b64_tr_b16 v[40:41], v20 offset:0
    ds_read_b64_tr_b16 v[42:43], v20 offset:1024
    v_mfma_f32_16x16x32_bf16 v[188:191], v[44:47], v[92:95], v[188:191]
    ds_read_b64_tr_b16 v[44:45], v20 offset:8192
    ds_read_b64_tr_b16 v[46:47], v20 offset:9216
    v_mfma_f32_16x16x32_bf16 v[192:195], v[48:51], v[64:67], v[192:195]
    v_cvt_pk_bf16_f32 v166, v180, v181
    v_cvt_pk_bf16_f32 v167, v182, v183
    v_mfma_f32_16x16x32_bf16 v[192:195], v[52:55], v[68:71], v[192:195]
    v_cvt_pk_bf16_f32 v170, v184, v185
    v_cvt_pk_bf16_f32 v171, v186, v187
    s_waitcnt vmcnt(0)
    v_cmp_gt_u32 vcc, 1, v7
    s_nop 1
    s_and_b64 vcc, vcc, exec
    s_cbranch_scc1 SPIN_KV
BACK_KV:
    v_mfma_f32_16x16x32_bf16 v[196:199], v[48:51], v[72:75], v[196:199]
    s_mov_b32 s77, s75
    buffer_load_dwordx4 a[224:227], v1, s[36:39], 0 offen offset:0 sc1
    v_mfma_f32_16x16x32_bf16 v[196:199], v[52:55], v[76:79], v[196:199]
    buffer_load_dwordx4 a[228:231], v1, s[36:39], 0 offen offset:1024 sc1
    v_mfma_f32_16x16x32_bf16 v[200:203], v[48:51], v[80:83], v[200:203]
    v_cmp_le_i32 vcc, 0, v36
    v_cvt_pk_bf16_f32 v192, v192, v193
    v_mfma_f32_16x16x32_bf16 v[200:203], v[52:55], v[84:87], v[200:203]
    v_cvt_pk_bf16_f32 v193, v194, v195
    v_cvt_pk_bf16_f32 v174, v188, v189
    v_mfma_f32_16x16x32_bf16 v[204:207], v[48:51], v[88:91], v[204:207]
    buffer_load_dwordx4 a[232:235], v1, s[36:39], 0 offen offset:2048 sc1
    v_mfma_f32_16x16x32_bf16 v[204:207], v[52:55], v[92:95], v[204:207]
    s_waitcnt lgkmcnt(0)
    ds_read_b64_tr_b16 v[48:49], v21 offset:0
    ds_read_b64_tr_b16 v[50:51], v21 offset:1024
    v_mfma_f32_16x16x32_bf16 v[208:211], v[56:59], v[64:67], v[208:211]
    ds_read_b64_tr_b16 v[52:53], v21 offset:8192
    ds_read_b64_tr_b16 v[54:55], v21 offset:9216
    v_mfma_f32_16x16x32_bf16 v[208:211], v[60:63], v[68:71], v[208:211]
    v_cvt_pk_bf16_f32 v196, v196, v197
    v_cvt_pk_bf16_f32 v197, v198, v199
    v_mfma_f32_16x16x32_bf16 v[212:215], v[56:59], v[72:75], v[212:215]
    buffer_load_dwordx4 a[236:239], v1, s[36:39], 0 offen offset:3072 sc1
    v_mfma_f32_16x16x32_bf16 v[212:215], v[60:63], v[76:79], v[212:215]
    v_cvt_pk_bf16_f32 v200, v200, v201
    v_cvt_pk_bf16_f32 v201, v202, v203
    v_mfma_f32_16x16x32_bf16 v[216:219], v[56:59], v[80:83], v[216:219]
    v_cvt_pk_bf16_f32 v194, v208, v209
    v_cndmask_b32_e64 v208, v37, 0, vcc
    v_mfma_f32_16x16x32_bf16 v[216:219], v[60:63], v[84:87], v[216:219]
    v_mul_f32 v176, s16, v208
    v_cmp_le_i32 vcc, 1, v36
    v_mfma_f32_16x16x32_bf16 v[220:223], v[56:59], v[88:91], v[220:223]
    v_cvt_pk_bf16_f32 v195, v210, v211
    v_cndmask_b32_e64 v209, v37, 0, vcc
    v_mfma_f32_16x16x32_bf16 v[220:223], v[60:63], v[92:95], v[220:223]
    v_mul_f32 v177, s16, v209
    v_cmp_le_i32 vcc, 2, v36
    v_mfma_f32_16x16x32_bf16 v[224:227], v[40:43], v[64:67], v[224:227]
    s_mov_b32 s38, 16384
    v_cndmask_b32_e64 v210, v37, 0, vcc
    v_mul_f32 v178, s16, v210
    v_mfma_f32_16x16x32_bf16 v[224:227], v[44:47], v[68:71], v[224:227]
    s_add_u32 m0, s76, s75
    v_cmp_le_i32 vcc, 3, v36
    v_cvt_pk_bf16_f32 v198, v212, v213
    v_mfma_f32_16x16x32_bf16 v[228:231], v[40:43], v[72:75], v[228:231]
    buffer_load_dwordx4 v1, s[36:39], s77 offen sc1 lds
    v_mfma_f32_16x16x32_bf16 v[228:231], v[44:47], v[76:79], v[228:231]
    v_cndmask_b32_e64 v211, v37, 0, vcc
    v_mul_f32 v179, s16, v211
    v_mfma_f32_16x16x32_bf16 v[232:235], v[40:43], v[80:83], v[232:235]
    v_cvt_pk_bf16_f32 v224, v224, v225
    v_cvt_pk_bf16_f32 v225, v226, v227
    v_mfma_f32_16x16x32_bf16 v[232:235], v[44:47], v[84:87], v[232:235]
    s_waitcnt vmcnt(6) lgkmcnt(0)
    s_barrier
    ds_read_b64_tr_b16 v[56:57], v26 offset:32768
    v_mfma_f32_16x16x32_bf16 v[236:239], v[40:43], v[88:91], v[236:239]
    buffer_load_dwordx4 v1, s[36:39], s77 offen offset:1024 sc1 lds
    v_mfma_f32_16x16x32_bf16 v[236:239], v[44:47], v[92:95], v[236:239]
    ds_read_b64_tr_b16 v[58:59], v26 offset:33280
    ds_read_b64_tr_b16 v[60:61], v26 offset:36864
    v_mfma_f32_16x16x32_bf16 v[240:243], v[48:51], v[64:67], v[240:243]
    ds_read_b64_tr_b16 v[62:63], v26 offset:37376
    ds_read_b128 a[136:139], v22 offset:32768
    v_mfma_f32_16x16x32_bf16 v[240:243], v[52:55], v[68:71], v[240:243]
    ds_read_b128 a[140:143], v23 offset:32768
    v_add_u32 v26, 0x10000, v26
    v_mfma_f32_16x16x32_bf16 v[244:247], v[48:51], v[72:75], v[244:247]
    buffer_load_dwordx4 v1, s[36:39], s77 offen offset:2048 sc1 lds
    v_mfma_f32_16x16x32_bf16 v[244:247], v[52:55], v[76:79], v[244:247]
    ds_read_b64_tr_b16 v[40:41], v27 offset:32768
    ds_read_b64_tr_b16 v[42:43], v27 offset:33280
    v_mfma_f32_16x16x32_bf16 v[248:251], v[48:51], v[80:83], v[248:251]
    ds_read_b64_tr_b16 v[44:45], v27 offset:36864
    ds_read_b64_tr_b16 v[46:47], v27 offset:37376
    v_mfma_f32_16x16x32_bf16 v[248:251], v[52:55], v[84:87], v[248:251]
    v_add_u32 v22, 0x10000, v22
    v_add_u32 v23, 0x10000, v23
    v_mfma_f32_16x16x32_bf16 v[252:255], v[48:51], v[88:91], v[252:255]
    buffer_load_dwordx4 v1, s[36:39], s77 offen offset:3072 sc1 lds
    v_mfma_f32_16x16x32_bf16 v[252:255], v[52:55], v[92:95], v[252:255]
    s_waitcnt lgkmcnt(4)
    ds_read_b64_tr_b16 v[48:49], v28 offset:32768
    ds_read_b64_tr_b16 v[50:51], v28 offset:33280
    v_mfma_f32_16x16x32_bf16 a[64:67], v[56:59], v[96:99], a[64:67]
    s_add_u32 s100, s77, 4096
    ds_read_b64_tr_b16 v[52:53], v28 offset:36864
    ds_read_b64_tr_b16 v[54:55], v28 offset:37376
    v_mfma_f32_16x16x32_bf16 a[64:67], v[60:63], v[100:103], a[64:67]
    s_add_u32 m0, m0, 4096
    v_add_u32 v27, 0x10000, v27
    v_add_u32 v28, 0x10000, v28
    v_mfma_f32_16x16x32_bf16 a[68:71], v[56:59], v[104:107], a[68:71]
    buffer_load_dwordx4 v1, s[36:39], s100 offen sc1 lds
    v_mfma_f32_16x16x32_bf16 a[68:71], v[60:63], v[108:111], a[68:71]
    v_cvt_pk_bf16_f32 v226, v240, v241
    v_cvt_pk_bf16_f32 v227, v242, v243
    v_mfma_f32_16x16x32_bf16 a[72:75], v[56:59], v[112:115], a[72:75]
    v_cvt_pk_bf16_f32 v228, v228, v229
    v_cvt_pk_bf16_f32 v229, v230, v231
    v_mfma_f32_16x16x32_bf16 a[72:75], v[60:63], v[116:119], a[72:75]
    v_cvt_pk_bf16_f32 v230, v244, v245
    v_cvt_pk_bf16_f32 v231, v246, v247
    v_mfma_f32_16x16x32_bf16 a[76:79], v[56:59], v[120:123], a[76:79]
    buffer_load_dwordx4 v1, s[36:39], s100 offen offset:1024 sc1 lds
    v_mfma_f32_16x16x32_bf16 a[76:79], v[60:63], v[124:127], a[76:79]
    v_cvt_pk_bf16_f32 v199, v214, v215
    v_cvt_pk_bf16_f32 v232, v232, v233
    v_mfma_f32_16x16x32_bf16 a[128:131], v[56:59], a[136:139], a[128:131]
    ds_read_b64_tr_b16 v[56:57], v29 offset:32768
    ds_read_b64_tr_b16 v[58:59], v29 offset:33280
    v_mfma_f32_16x16x32_bf16 a[128:131], v[60:63], a[140:143], a[128:131]
    s_waitcnt lgkmcnt(2)
    ds_read_b64_tr_b16 v[60:61], v29 offset:36864
    ds_read_b64_tr_b16 v[62:63], v29 offset:37376
    v_mfma_f32_16x16x32_bf16 a[80:83], v[40:43], v[96:99], a[80:83]
    buffer_load_dwordx4 v1, s[36:39], s100 offen offset:2048 sc1 lds
    v_mfma_f32_16x16x32_bf16 a[80:83], v[44:47], v[100:103], a[80:83]
    v_add_u32 v29, 0x10000, v29
    v_cvt_pk_bf16_f32 v233, v234, v235
    v_mfma_f32_16x16x32_bf16 a[84:87], v[40:43], v[104:107], a[84:87]
    v_cvt_pk_bf16_f32 v234, v248, v249
    v_cvt_pk_bf16_f32 v235, v250, v251
    v_mfma_f32_16x16x32_bf16 a[84:87], v[44:47], v[108:111], a[84:87]
    v_cvt_pk_bf16_f32 v202, v216, v217
    v_cvt_pk_bf16_f32 v203, v218, v219
    v_mfma_f32_16x16x32_bf16 a[88:91], v[40:43], v[112:115], a[88:91]
    buffer_load_dwordx4 v1, s[36:39], s100 offen offset:3072 sc1 lds
    v_mfma_f32_16x16x32_bf16 a[88:91], v[44:47], v[116:119], a[88:91]
    v_cvt_pk_bf16_f32 v175, v190, v191
    v_cvt_pk_bf16_f32 v236, v236, v237
    v_mfma_f32_16x16x32_bf16 a[92:95], v[40:43], v[120:123], a[92:95]
    s_lshr_b32 s82, s4, 1
    s_add_u32 s82, s82, 32
    v_cvt_pk_bf16_f32 v237, v238, v239
    v_mfma_f32_16x16x32_bf16 a[92:95], v[44:47], v[124:127], a[92:95]
    s_sub_u32 s82, s82, s6
    v_cvt_pk_bf16_f32 v238, v252, v253
    v_cvt_pk_bf16_f32 v239, v254, v255
    v_mfma_f32_16x16x32_bf16 a[132:135], v[40:43], a[136:139], a[132:135]
    s_add_u32 s76, s76, 32768
    s_sub_u32 s82, s82, s6
    ds_read_b64_tr_b16 v[40:41], v26 offset:0
    v_mfma_f32_16x16x32_bf16 a[132:135], v[44:47], a[140:143], a[132:135]
    s_add_u32 s77, s77, 32768
    s_lshl_b32 s38, s82, 15
    s_add_u32 m0, s76, s75
    v_mfma_f32_16x16x32_bf16 a[96:99], v[48:51], v[96:99], a[96:99]
    s_mov_b32 s82, 0
    buffer_load_dwordx4 v1, s[36:39], s77 offen sc1 lds
    v_mfma_f32_16x16x32_bf16 a[96:99], v[52:55], v[100:103], a[96:99]
    ds_read_b64_tr_b16 v[42:43], v26 offset:512
    ds_read_b64_tr_b16 v[44:45], v26 offset:4096
    v_mfma_f32_16x16x32_bf16 a[100:103], v[48:51], v[104:107], a[100:103]
    buffer_load_dwordx4 v1, s[36:39], s77 offen offset:1024 sc1 lds
    v_mfma_f32_16x16x32_bf16 a[100:103], v[52:55], v[108:111], a[100:103]
    ds_read_b64_tr_b16 v[46:47], v26 offset:4608
    ds_read_b128 a[136:139], v22 offset:0
    v_mfma_f32_16x16x32_bf16 a[104:107], v[48:51], v[112:115], a[104:107]
    ds_read_b128 a[140:143], v23 offset:0
    v_cvt_pk_bf16_f32 v204, v204, v205
    v_mfma_f32_16x16x32_bf16 a[104:107], v[52:55], v[116:119], a[104:107]
    v_cvt_pk_bf16_f32 v205, v206, v207
    v_cvt_pk_bf16_f32 v206, v220, v221
    v_mfma_f32_16x16x32_bf16 a[108:111], v[48:51], v[120:123], a[108:111]
    buffer_load_dwordx4 v1, s[36:39], s77 offen offset:2048 sc1 lds
    v_mfma_f32_16x16x32_bf16 a[108:111], v[52:55], v[124:127], a[108:111]
    s_waitcnt lgkmcnt(3)
    ds_read_b64_tr_b16 v[48:49], v27 offset:0
    ds_read_b64_tr_b16 v[50:51], v27 offset:512
    v_mfma_f32_16x16x32_bf16 a[112:115], v[56:59], v[96:99], a[112:115]
    ds_read_b64_tr_b16 v[52:53], v27 offset:4096
    ds_read_b64_tr_b16 v[54:55], v27 offset:4608
    v_mfma_f32_16x16x32_bf16 a[112:115], v[60:63], v[100:103], a[112:115]
    v_cvt_pk_bf16_f32 v207, v222, v223
    v_cmp_eq_u32 vcc, 0, v38
    v_mfma_f32_16x16x32_bf16 a[116:119], v[56:59], v[104:107], a[116:119]
    buffer_load_dwordx4 v1, s[36:39], s77 offen offset:3072 sc1 lds
    v_mfma_f32_16x16x32_bf16 a[116:119], v[60:63], v[108:111], a[116:119]
    v_mov_b32 v38, 0x3f803f80
    v_cndmask_b32 v38, 0, v38, vcc
    v_mfma_f32_16x16x32_bf16 a[120:123], v[56:59], v[112:115], a[120:123]
    s_add_u32 s100, s77, 4096
    v_mfma_f32_16x16x32_bf16 a[120:123], v[60:63], v[116:119], a[120:123]
    s_add_u32 m0, m0, 4096
    v_mfma_f32_16x16x32_bf16 a[124:127], v[56:59], v[120:123], a[124:127]
    buffer_load_dwordx4 v1, s[36:39], s100 offen sc1 lds
    v_mfma_f32_16x16x32_bf16 a[124:127], v[60:63], v[124:127], a[124:127]
    s_waitcnt vmcnt(13)
    ds_read_b64_tr_b16 v[56:57], v28 offset:0
    ds_read_b64_tr_b16 v[58:59], v28 offset:512
    v_mfma_f32_16x16x32_bf16 v[240:243], a[224:227], v[128:131], v[176:179]
    ds_read_b64_tr_b16 v[60:61], v28 offset:4096
    ds_read_b64_tr_b16 v[62:63], v28 offset:4608
    v_mfma_f32_16x16x32_bf16 v[240:243], a[228:231], v[160:163], v[240:243]
    v_mfma_f32_16x16x32_bf16 v[240:243], a[232:235], v[192:195], v[240:243]
    buffer_load_dwordx4 v1, s[36:39], s100 offen offset:1024 sc1 lds
    v_mfma_f32_16x16x32_bf16 v[240:243], a[236:239], v[224:227], v[240:243]
    v_mfma_f32_16x16x32_bf16 v[244:247], a[224:227], v[132:135], 0
    v_mfma_f32_16x16x32_bf16 v[244:247], a[228:231], v[164:167], v[244:247]
    v_mfma_f32_16x16x32_bf16 v[244:247], a[232:235], v[196:199], v[244:247]
    buffer_load_dwordx4 v1, s[36:39], s100 offen offset:2048 sc1 lds
    v_mfma_f32_16x16x32_bf16 v[244:247], a[236:239], v[228:231], v[244:247]
    v_mfma_f32_16x16x32_bf16 v[248:251], a[224:227], v[136:139], 0
    v_mfma_f32_16x16x32_bf16 v[248:251], a[228:231], v[168:171], v[248:251]
    v_mfma_f32_16x16x32_bf16 v[248:251], a[232:235], v[200:203], v[248:251]
    buffer_load_dwordx4 v1, s[36:39], s100 offen offset:3072 sc1 lds
    v_mfma_f32_16x16x32_bf16 v[248:251], a[236:239], v[232:235], v[248:251]
    v_max3_f32 v240, v240, v241, v242
    v_max_f32 v240, v240, v243
    v_mfma_f32_16x16x32_bf16 v[252:255], a[224:227], v[140:143], 0
    s_add_u32 s76, s76, 32768
    v_max3_f32 v244, v244, v245, v246
    v_max_f32 v244, v244, v247
    v_mfma_f32_16x16x32_bf16 v[252:255], a[228:231], v[172:175], v[252:255]
    s_add_u32 s77, s77, 32768
    v_max3_f32 v248, v248, v249, v250
    v_max_f32 v248, v248, v251
    v_mfma_f32_16x16x32_bf16 v[252:255], a[232:235], v[204:207], v[252:255]
    s_add_u32 m0, s76, s75
    v_mov_b32 v241, v240
    v_mov_b32 v245, v244
    v_mfma_f32_16x16x32_bf16 v[252:255], a[236:239], v[236:239], v[252:255]
    buffer_load_dwordx4 v1, s[36:39], s77 offen sc1 lds
    v_mfma_f32_16x16x32_bf16 a[64:67], v[40:43], v[64:67], a[64:67]
    s_waitcnt lgkmcnt(0)
    v_mov_b32 v249, v248
    v_permlane32_swap_b32 v240, v241
    v_mfma_f32_16x16x32_bf16 a[64:67], v[44:47], v[68:71], a[64:67]
    v_permlane32_swap_b32 v244, v245
    v_permlane32_swap_b32 v248, v249
    v_mfma_f32_16x16x32_bf16 a[68:71], v[40:43], v[72:75], a[68:71]
    buffer_load_dwordx4 v1, s[36:39], s77 offen offset:1024 sc1 lds
    v_mfma_f32_16x16x32_bf16 a[68:71], v[44:47], v[76:79], a[68:71]
    v_max3_f32 v252, v252, v253, v254
    v_max_f32 v252, v252, v255
    v_mfma_f32_16x16x32_bf16 a[72:75], v[40:43], v[80:83], a[72:75]
    v_mov_b32 v253, v252
    v_max_f32 v240, v240, v241
    v_mfma_f32_16x16x32_bf16 a[72:75], v[44:47], v[84:87], a[72:75]
    v_permlane32_swap_b32 v252, v253
    v_max_f32 v244, v244, v245
    v_mfma_f32_16x16x32_bf16 a[76:79], v[40:43], v[88:91], a[76:79]
    buffer_load_dwordx4 v1, s[36:39], s77 offen offset:2048 sc1 lds
    v_mfma_f32_16x16x32_bf16 a[76:79], v[44:47], v[92:95], a[76:79]
    v_max_f32 v248, v248, v249
    v_max_f32 v252, v252, v253
    v_mfma_f32_16x16x32_bf16 a[128:131], v[40:43], a[136:139], a[128:131]
    ds_read_b64_tr_b16 v[40:41], v29 offset:0
    ds_read_b64_tr_b16 v[42:43], v29 offset:512
    v_mfma_f32_16x16x32_bf16 a[128:131], v[44:47], a[140:143], a[128:131]
    ds_read_b64_tr_b16 v[44:45], v29 offset:4096
    ds_read_b64_tr_b16 v[46:47], v29 offset:4608
    v_mfma_f32_16x16x32_bf16 a[80:83], v[48:51], v[64:67], a[80:83]
    buffer_load_dwordx4 v1, s[36:39], s77 offen offset:3072 sc1 lds
    v_mfma_f32_16x16x32_bf16 a[80:83], v[52:55], v[68:71], a[80:83]
    v_mov_b32 v241, v240
    v_mov_b32 v245, v244
    v_mfma_f32_16x16x32_bf16 a[84:87], v[48:51], v[72:75], a[84:87]
    s_add_u32 s100, s77, 4096
    v_mov_b32 v249, v248
    v_mov_b32 v253, v252
    v_mfma_f32_16x16x32_bf16 a[84:87], v[52:55], v[76:79], a[84:87]
    s_add_u32 m0, m0, 4096
    v_permlane16_swap_b32 v240, v241
    v_permlane16_swap_b32 v244, v245
    v_mfma_f32_16x16x32_bf16 a[88:91], v[48:51], v[80:83], a[88:91]
    buffer_load_dwordx4 v1, s[36:39], s100 offen sc1 lds
    v_mfma_f32_16x16x32_bf16 a[88:91], v[52:55], v[84:87], a[88:91]
    v_permlane16_swap_b32 v248, v249
    v_permlane16_swap_b32 v252, v253
    v_mfma_f32_16x16x32_bf16 a[92:95], v[48:51], v[88:91], a[92:95]
    v_max_f32 v240, v240, v241
    v_max_f32 v244, v244, v245
    v_mfma_f32_16x16x32_bf16 a[92:95], v[52:55], v[92:95], a[92:95]
    v_max_f32 v248, v248, v249
    v_max_f32 v252, v252, v253
    v_mfma_f32_16x16x32_bf16 a[132:135], v[48:51], a[136:139], a[132:135]
    buffer_load_dwordx4 v1, s[36:39], s100 offen offset:1024 sc1 lds
    v_mfma_f32_16x16x32_bf16 a[132:135], v[52:55], a[140:143], a[132:135]
    v_sub_f32 v144, 0, v240
    v_sub_f32 v145, 0, v240
    v_mfma_f32_16x16x32_bf16 a[96:99], v[56:59], v[64:67], a[96:99]
    v_sub_f32 v146, 0, v240
    v_sub_f32 v147, 0, v240
    v_mfma_f32_16x16x32_bf16 a[96:99], v[60:63], v[68:71], a[96:99]
    v_sub_f32 v148, 0, v244
    v_sub_f32 v149, 0, v244
    v_mfma_f32_16x16x32_bf16 a[100:103], v[56:59], v[72:75], a[100:103]
    buffer_load_dwordx4 v1, s[36:39], s100 offen offset:2048 sc1 lds
    v_mfma_f32_16x16x32_bf16 a[100:103], v[60:63], v[76:79], a[100:103]
    v_sub_f32 v150, 0, v244
    v_sub_f32 v151, 0, v244
    v_mfma_f32_16x16x32_bf16 a[104:107], v[56:59], v[80:83], a[104:107]
    v_sub_f32 v152, 0, v248
    v_sub_f32 v153, 0, v248
    v_mfma_f32_16x16x32_bf16 a[104:107], v[60:63], v[84:87], a[104:107]
    v_sub_f32 v154, 0, v248
    v_sub_f32 v155, 0, v248
    v_mfma_f32_16x16x32_bf16 a[108:111], v[56:59], v[88:91], a[108:111]
    buffer_load_dwordx4 v1, s[36:39], s100 offen offset:3072 sc1 lds
    v_mfma_f32_16x16x32_bf16 a[108:111], v[60:63], v[92:95], a[108:111]
    s_waitcnt lgkmcnt(0)
    v_sub_f32 v156, 0, v252
    v_sub_f32 v157, 0, v252
    v_mfma_f32_16x16x32_bf16 a[112:115], v[40:43], v[64:67], a[112:115]
    s_add_u32 s77, s77, 32768
    v_sub_f32 v158, 0, v252
    v_sub_f32 v159, 0, v252
    v_mfma_f32_16x16x32_bf16 a[112:115], v[44:47], v[68:71], a[112:115]
    s_add_u32 s76, s76, 32768
    v_and_b32 v29, 0x380, v1
    v_lshl_add_u32 v29, v29, 4, v39
    v_mfma_f32_16x16x32_bf16 a[116:119], v[40:43], v[72:75], a[116:119]
    v_bfe_u32 v39, v1, 2, 4
    v_accvgpr_write_b32 a136, v38
    v_mfma_f32_16x16x32_bf16 a[116:119], v[44:47], v[76:79], a[116:119]
    v_accvgpr_write_b32 a137, v38
    v_accvgpr_write_b32 a138, v38
    v_mfma_f32_16x16x32_bf16 a[120:123], v[40:43], v[80:83], a[120:123]
    v_accvgpr_write_b32 a139, v38
    v_lshl_add_u32 v29, v29, 1, v39
    v_mfma_f32_16x16x32_bf16 a[120:123], v[44:47], v[84:87], a[120:123]
    s_waitcnt vmcnt(16) lgkmcnt(0)
    s_barrier
    v_mfma_f32_16x16x32_bf16 a[124:127], v[40:43], v[88:91], a[124:127]
    v_mfma_f32_16x16x32_bf16 a[124:127], v[44:47], v[92:95], a[124:127]
K1_ATT:
    v_add_f32 v212, s20, v144
    v_fma_f32 v176, v208, s16, v212
    v_fma_f32 v177, v209, s16, v212
    v_fma_f32 v178, v210, s16, v212
    v_fma_f32 v179, v211, s16, v212
    s_nop 1
    s_waitcnt lgkmcnt(0)
    v_mfma_f32_16x16x32_bf16 v[240:243], a[224:227], v[128:131], v[176:179]
    s_add_u32 m0, s76, s75
    ds_read_b128 a[240:243], v2 offset:4096
    ds_read_b128 a[244:247], v2 offset:5120
    v_mfma_f32_16x16x32_bf16 v[240:243], a[228:231], v[160:163], v[240:243]
    s_mov_b32 s76, s60
    buffer_load_dwordx4 v1, s[36:39], s77 offen sc1 lds
    v_mfma_f32_16x16x32_bf16 v[240:243], a[232:235], v[192:195], v[240:243]
    s_mov_b32 s60, s82
    ds_read_b128 a[248:251], v2 offset:6144
    ds_read_b128 a[252:255], v2 offset:7168
    v_mfma_f32_16x16x32_bf16 v[240:243], a[236:239], v[224:227], v[240:243]
    s_add_u32 s82, s82, 32768
    v_add_f32 v213, s21, v144
    v_fma_f32 v180, v208, s17, v213
    v_mfma_f32_16x16x32_bf16 v[244:247], a[224:227], v[132:135], v[148:151]
    s_sub_u32 s7, 15, s6
    v_fma_f32 v181, v209, s17, v213
    v_fma_f32 v182, v210, s17, v213
    v_mfma_f32_16x16x32_bf16 v[244:247], a[228:231], v[164:167], v[244:247]
    s_lshl3_add_u32 s80, s6, s4
    v_exp_f32 v240, v240
    v_mfma_f32_16x16x32_bf16 v[244:247], a[232:235], v[196:199], v[244:247]
    s_lshl3_add_u32 s81, s7, s4
    buffer_load_dwordx4 v1, s[36:39], s77 offen offset:1024 sc1 lds
    v_mfma_f32_16x16x32_bf16 v[244:247], a[236:239], v[228:231], v[244:247]
    s_mul_i32 s80, s80, 155648
    v_exp_f32 v241, v241
    v_mfma_f32_16x16x32_bf16 v[248:251], a[224:227], v[136:139], v[152:155]
    s_mul_i32 s81, s81, 155648
    v_exp_f32 v242, v242
    v_mfma_f32_16x16x32_bf16 v[248:251], a[228:231], v[168:171], v[248:251]
    s_lshl_b32 s7, s5, 12
    v_exp_f32 v243, v243
    v_mfma_f32_16x16x32_bf16 v[248:251], a[232:235], v[200:203], v[248:251]
    s_add_u32 s80, s80, s7
    v_fma_f32 v183, v211, s17, v213
    v_cvt_pk_bf16_f32 v32, v240, v241
    v_mfma_f32_16x16x32_bf16 v[248:251], a[236:239], v[232:235], v[248:251]
    s_add_u32 s81, s81, s7
    buffer_load_dwordx4 v1, s[36:39], s77 offen offset:2048 sc1 lds
    v_mfma_f32_16x16x32_bf16 v[252:255], a[224:227], v[140:143], v[156:159]
    s_lshr_b32 s7, s5, 3
    v_cvt_pk_bf16_f32 v33, v242, v243
    ds_read_b128 a[224:227], v2 offset:8192
    v_mfma_f32_16x16x32_bf16 v[252:255], a[228:231], v[172:175], v[252:255]
    s_lshl2_add_u32 s7, s7, s4
    v_exp_f32 v244, v244
    v_mfma_f32_16x16x32_bf16 v[252:255], a[232:235], v[204:207], v[252:255]
    s_lshl_b32 s7, s7, 8
    v_exp_f32 v245, v245
    v_mfma_f32_16x16x32_bf16 v[252:255], a[236:239], v[236:239], v[252:255]
    s_mov_b32 s42, 19922944
    v_exp_f32 v246, v246
    s_waitcnt lgkmcnt(1)
    v_mfma_f32_16x16x32_bf16 v[240:243], a[240:243], v[128:131], v[180:183]
    s_mov_b32 s43, 0x20000
    v_exp_f32 v247, v247
    v_mfma_f32_16x16x32_bf16 v[240:243], a[244:247], v[160:163], v[240:243]
    s_add_u32 s92, s7, 163840
    buffer_load_dwordx4 v1, s[36:39], s77 offen offset:3072 sc1 lds
    v_mfma_f32_16x16x32_bf16 v[240:243], a[248:251], v[192:195], v[240:243]
    s_mov_b64 s[24:25], s[0:1]
    v_cvt_pk_bf16_f32 v40, v244, v245
    v_cvt_pk_bf16_f32 v41, v246, v247
    v_mfma_f32_16x16x32_bf16 v[240:243], a[252:255], v[224:227], v[240:243]
    s_mov_b32 s78, s6
    v_exp_f32 v248, v248
    v_mfma_f32_16x16x32_bf16 v[244:247], a[240:243], v[132:135], v[148:151]
    s_mov_b32 s26, 2359296
    v_exp_f32 v249, v249
    v_mfma_f32_16x16x32_bf16 v[244:247], a[244:247], v[164:167], v[244:247]
    s_add_u32 s100, s77, 4096
    v_exp_f32 v250, v250
    v_mfma_f32_16x16x32_bf16 v[244:247], a[248:251], v[196:199], v[244:247]
    s_add_u32 m0, m0, 4096
    v_exp_f32 v251, v251
    v_mfma_f32_16x16x32_bf16 v[244:247], a[252:255], v[228:231], v[244:247]
    s_mov_b32 s27, 0x20000
    v_cvt_pk_bf16_f32 v48, v248, v249
    v_cvt_pk_bf16_f32 v49, v250, v251
    v_mfma_f32_16x16x32_bf16 v[248:251], a[240:243], v[136:139], v[152:155]
    buffer_load_dwordx4 v1, s[36:39], s100 offen sc1 lds
    v_mfma_f32_16x16x32_bf16 v[248:251], a[244:247], v[168:171], v[248:251]
    ds_read_b128 a[228:231], v2 offset:9216
    ds_read_b128 a[232:235], v2 offset:10240
    v_mfma_f32_16x16x32_bf16 v[248:251], a[248:251], v[200:203], v[248:251]
    v_exp_f32 v252, v252
    v_mfma_f32_16x16x32_bf16 v[248:251], a[252:255], v[232:235], v[248:251]
    v_exp_f32 v253, v253
    v_exp_f32 v254, v254
    v_exp_f32 v255, v255
    v_cvt_pk_bf16_f32 v56, v252, v253
    v_cvt_pk_bf16_f32 v57, v254, v255
    v_mfma_f32_16x16x32_bf16 v[252:255], a[240:243], v[140:143], v[156:159]
    ds_read_b128 a[236:239], v2 offset:11264
    v_add_f32 v214, s22, v144
    v_mfma_f32_16x16x32_bf16 v[252:255], a[244:247], v[172:175], v[252:255]
    buffer_load_dwordx4 v1, s[36:39], s100 offen offset:1024 sc1 lds
    v_mfma_f32_16x16x32_bf16 v[252:255], a[248:251], v[204:207], v[252:255]
    v_exp_f32 v240, v240
    v_mfma_f32_16x16x32_bf16 v[252:255], a[252:255], v[236:239], v[252:255]
    s_waitcnt lgkmcnt(1)
    v_exp_f32 v241, v241
    v_exp_f32 v242, v242
    v_exp_f32 v243, v243
    v_fma_f32 v184, v208, s18, v214
    v_fma_f32 v185, v209, s18, v214
    v_fma_f32 v186, v210, s18, v214
    v_fma_f32 v187, v211, s18, v214
    v_cvt_pk_bf16_f32 v34, v240, v241
    v_cvt_pk_bf16_f32 v35, v242, v243
    v_mfma_f32_16x16x32_bf16 v[240:243], a[224:227], v[128:131], v[184:187]
    v_exp_f32 v244, v244
    v_mfma_f32_16x16x32_bf16 v[240:243], a[228:231], v[160:163], v[240:243]
    v_exp_f32 v245, v245
    v_mfma_f32_16x16x32_bf16 v[240:243], a[232:235], v[192:195], v[240:243]
    s_waitcnt lgkmcnt(0)
    v_exp_f32 v246, v246
    v_mfma_f32_16x16x32_bf16 v[240:243], a[236:239], v[224:227], v[240:243]
    v_exp_f32 v247, v247
    v_cvt_pk_bf16_f32 v42, v244, v245
    v_cvt_pk_bf16_f32 v43, v246, v247
    v_mfma_f32_16x16x32_bf16 v[244:247], a[224:227], v[132:135], v[148:151]
    buffer_load_dwordx4 v1, s[36:39], s100 offen offset:2048 sc1 lds
    v_mfma_f32_16x16x32_bf16 v[244:247], a[228:231], v[164:167], v[244:247]
    v_exp_f32 v248, v248
    v_mfma_f32_16x16x32_bf16 v[244:247], a[232:235], v[196:199], v[244:247]
    v_exp_f32 v249, v249
    v_mfma_f32_16x16x32_bf16 v[244:247], a[236:239], v[228:231], v[244:247]
    v_exp_f32 v250, v250
    v_exp_f32 v251, v251
    v_cvt_pk_bf16_f32 v50, v248, v249
    v_cvt_pk_bf16_f32 v51, v250, v251
    v_mfma_f32_16x16x32_bf16 v[248:251], a[224:227], v[136:139], v[152:155]
    buffer_load_dwordx4 v1, s[36:39], s100 offen offset:3072 sc1 lds
    v_mfma_f32_16x16x32_bf16 v[248:251], a[228:231], v[168:171], v[248:251]
    ds_read_b128 a[240:243], v2 offset:12288
    ds_read_b128 a[244:247], v2 offset:13312
    v_mfma_f32_16x16x32_bf16 v[248:251], a[232:235], v[200:203], v[248:251]
    s_add_u32 s77, s77, 32768
    v_exp_f32 v252, v252
    v_mfma_f32_16x16x32_bf16 v[248:251], a[236:239], v[232:235], v[248:251]
    v_exp_f32 v253, v253
    v_exp_f32 v254, v254
    v_exp_f32 v255, v255
    v_cvt_pk_bf16_f32 v58, v252, v253
    v_cvt_pk_bf16_f32 v59, v254, v255
    v_mfma_f32_16x16x32_bf16 v[252:255], a[224:227], v[140:143], v[156:159]
    ds_read_b128 a[248:251], v2 offset:14336
    ds_read_b128 a[252:255], v2 offset:15360
    v_mfma_f32_16x16x32_bf16 v[252:255], a[228:231], v[172:175], v[252:255]
    v_add_f32 v215, s23, v144
    v_fma_f32 v188, v208, s19, v215
    v_mfma_f32_16x16x32_bf16 v[252:255], a[232:235], v[204:207], v[252:255]
    v_exp_f32 v240, v240
    v_mfma_f32_16x16x32_bf16 v[252:255], a[236:239], v[236:239], v[252:255]
    s_waitcnt lgkmcnt(2)
    v_exp_f32 v241, v241
    v_exp_f32 v242, v242
    v_exp_f32 v243, v243
    v_fma_f32 v189, v209, s19, v215
    v_fma_f32 v190, v210, s19, v215
    v_fma_f32 v191, v211, s19, v215
    v_cvt_pk_bf16_f32 v36, v240, v241
    v_cvt_pk_bf16_f32 v37, v242, v243
    v_mfma_f32_16x16x32_bf16 v[240:243], a[240:243], v[128:131], v[188:191]
    v_exp_f32 v244, v244
    v_mfma_f32_16x16x32_bf16 v[240:243], a[244:247], v[160:163], v[240:243]
    s_cmp_eq_u32 s82, 163840
    s_cselect_b32 s82, 0, s82
    v_add_u32 v2, s82, v1
    s_waitcnt lgkmcnt(0)
    v_mfma_f32_16x16x32_bf16 v[240:243], a[248:251], v[192:195], v[240:243]
    v_exp_f32 v245, v245
    v_mfma_f32_16x16x32_bf16 v[240:243], a[252:255], v[224:227], v[240:243]
    s_waitcnt vmcnt(8) lgkmcnt(0)
    s_barrier
    v_cvt_pk_bf16_f32 v44, v244, v245
    v_exp_f32 v246, v246
    v_exp_f32 v247, v247
    s_nop 0
    v_cvt_pk_bf16_f32 v45, v246, v247
    v_mfma_f32_16x16x32_bf16 v[244:247], a[240:243], v[132:135], v[148:151]
    ds_read_b128 a[224:227], v2 offset:0
    ds_read_b128 a[228:231], v2 offset:1024
    v_mfma_f32_16x16x32_bf16 v[244:247], a[244:247], v[164:167], v[244:247]
    v_exp_f32 v248, v248
    v_mfma_f32_16x16x32_bf16 v[244:247], a[248:251], v[196:199], v[244:247]
    v_exp_f32 v249, v249
    v_mfma_f32_16x16x32_bf16 v[244:247], a[252:255], v[228:231], v[244:247]
    v_exp_f32 v250, v250
    v_exp_f32 v251, v251
    v_cvt_pk_bf16_f32 v52, v248, v249
    v_cvt_pk_bf16_f32 v53, v250, v251
    v_mfma_f32_16x16x32_bf16 v[248:251], a[240:243], v[136:139], v[152:155]
    ds_read_b128 a[232:235], v2 offset:2048
    ds_read_b128 a[236:239], v2 offset:3072
    v_mfma_f32_16x16x32_bf16 v[248:251], a[244:247], v[168:171], v[248:251]
    ds_read_b128 v[96:99], v2 offset:16384
    v_mfma_f32_16x16x32_bf16 v[248:251], a[248:251], v[200:203], v[248:251]
    v_exp_f32 v252, v252
    v_mfma_f32_16x16x32_bf16 v[248:251], a[252:255], v[232:235], v[248:251]
    v_exp_f32 v253, v253
    v_exp_f32 v254, v254
    v_exp_f32 v255, v255
    v_cvt_pk_bf16_f32 v60, v252, v253
    v_cvt_pk_bf16_f32 v61, v254, v255
    v_mfma_f32_16x16x32_bf16 v[252:255], a[240:243], v[140:143], v[156:159]
    ds_read_b128 v[100:103], v2 offset:17408
    v_mfma_f32_16x16x32_bf16 v[252:255], a[244:247], v[172:175], v[252:255]
    v_exp_f32 v240, v240
    v_mfma_f32_16x16x32_bf16 v[252:255], a[248:251], v[204:207], v[252:255]
    s_sub_u32 s40, s56, 20971520
    s_subb_u32 s41, s57, 0
    v_mfma_f32_16x16x32_bf16 v[252:255], a[252:255], v[236:239], v[252:255]
    v_exp_f32 v241, v241
    v_exp_f32 v242, v242
    v_exp_f32 v243, v243
    v_exp_f32 v244, v244
    v_exp_f32 v245, v245
    v_exp_f32 v246, v246
    v_exp_f32 v247, v247
    v_exp_f32 v248, v248
    v_exp_f32 v249, v249
    v_exp_f32 v250, v250
    v_exp_f32 v251, v251
    v_exp_f32 v252, v252
    v_exp_f32 v253, v253
    v_cvt_pk_bf16_f32 v38, v240, v241
    v_cvt_pk_bf16_f32 v39, v242, v243
    v_cvt_pk_bf16_f32 v46, v244, v245
    v_cvt_pk_bf16_f32 v47, v246, v247
    v_cvt_pk_bf16_f32 v54, v248, v249
    v_cvt_pk_bf16_f32 v55, v250, v251
    v_cvt_pk_bf16_f32 v62, v252, v253
    s_cmp_eq_u32 s78, 0
    s_cbranch_scc1 K1_LB_END
.p2align 3
K1_LB:
    s_waitcnt lgkmcnt(0)
    v_mfma_f32_16x16x32_bf16 v[240:243], a[224:227], v[128:131], v[176:179]
    s_add_u32 m0, s76, s75
    v_exp_f32 v254, v254
    v_mfma_f32_16x16x32_bf16 v[240:243], a[228:231], v[160:163], v[240:243]
    s_mov_b32 s76, s60
    buffer_load_dwordx4 v1, s[36:39], s77 offen sc1 lds
    v_mfma_f32_16x16x32_bf16 v[240:243], a[232:235], v[192:195], v[240:243]
    s_mov_b32 s60, s82
    v_exp_f32 v255, v255
    v_mfma_f32_16x16x32_bf16 v[240:243], a[236:239], v[224:227], v[240:243]
    s_add_u32 s82, s82, 32768
    ds_read_b128 v[104:107], v2 offset:18432
    v_cvt_pk_bf16_f32 v63, v254, v255
    v_mfma_f32_16x16x32_bf16 a[0:3], v[96:99], v[32:35], a[0:3]
    ds_read_b128 v[108:111], v2 offset:19456
    ds_read_b128 a[240:243], v2 offset:4096
    v_mfma_f32_16x16x32_bf16 a[0:3], v[100:103], v[36:39], a[0:3]
    ds_read_b128 a[244:247], v2 offset:5120
    v_mfma_f32_16x16x32_bf16 a[4:7], v[96:99], v[40:43], a[4:7]
    v_exp_f32 v240, v240
    v_mfma_f32_16x16x32_bf16 a[4:7], v[100:103], v[44:47], a[4:7]
    ds_read_b128 a[248:251], v2 offset:6144
    ds_read_b128 a[252:255], v2 offset:7168
    v_mfma_f32_16x16x32_bf16 v[244:247], a[224:227], v[132:135], v[148:151]
    v_exp_f32 v241, v241
    v_mfma_f32_16x16x32_bf16 v[244:247], a[228:231], v[164:167], v[244:247]
    ds_read_b128 v[112:115], v2 offset:20480
    ds_read_b128 v[116:119], v2 offset:21504
    v_mfma_f32_16x16x32_bf16 v[244:247], a[232:235], v[196:199], v[244:247]
    v_exp_f32 v242, v242
    v_mfma_f32_16x16x32_bf16 v[244:247], a[236:239], v[228:231], v[244:247]
    v_exp_f32 v243, v243
    v_mfma_f32_16x16x32_bf16 a[8:11], v[96:99], v[48:51], a[8:11]
    v_cvt_pk_bf16_f32 v64, v240, v241
    v_cvt_pk_bf16_f32 v65, v242, v243
    v_mfma_f32_16x16x32_bf16 a[8:11], v[100:103], v[52:55], a[8:11]
    ds_read_b128 v[120:123], v2 offset:22528
    ds_read_b128 v[124:127], v2 offset:23552
    v_mfma_f32_16x16x32_bf16 a[12:15], v[96:99], v[56:59], a[12:15]
    v_exp_f32 v244, v244
    v_mfma_f32_16x16x32_bf16 a[12:15], v[100:103], v[60:63], a[12:15]
    buffer_load_dwordx4 v1, s[36:39], s77 offen offset:1024 sc1 lds
    v_mfma_f32_16x16x32_bf16 v[248:251], a[224:227], v[136:139], v[152:155]
    v_exp_f32 v245, v245
    v_mfma_f32_16x16x32_bf16 v[248:251], a[228:231], v[168:171], v[248:251]
    v_exp_f32 v246, v246
    v_mfma_f32_16x16x32_bf16 v[248:251], a[232:235], v[200:203], v[248:251]
    v_exp_f32 v247, v247
    v_mfma_f32_16x16x32_bf16 v[248:251], a[236:239], v[232:235], v[248:251]
    s_waitcnt lgkmcnt(0)
    v_cvt_pk_bf16_f32 v72, v244, v245
    v_cvt_pk_bf16_f32 v73, v246, v247
    v_mfma_f32_16x16x32_bf16 a[16:19], v[104:107], v[32:35], a[16:19]
    ds_read_b128 v[96:99], v2 offset:24576
    ds_read_b128 v[100:103], v2 offset:25600
    v_mfma_f32_16x16x32_bf16 a[16:19], v[108:111], v[36:39], a[16:19]
    v_mfma_f32_16x16x32_bf16 a[20:23], v[104:107], v[40:43], a[20:23]
    v_mfma_f32_16x16x32_bf16 a[20:23], v[108:111], v[44:47], a[20:23]
    v_exp_f32 v248, v248
    v_mfma_f32_16x16x32_bf16 v[252:255], a[224:227], v[140:143], v[156:159]
    v_exp_f32 v249, v249
    v_mfma_f32_16x16x32_bf16 v[252:255], a[228:231], v[172:175], v[252:255]
    v_exp_f32 v250, v250
    v_mfma_f32_16x16x32_bf16 v[252:255], a[232:235], v[204:207], v[252:255]
    v_exp_f32 v251, v251
    v_mfma_f32_16x16x32_bf16 v[252:255], a[236:239], v[236:239], v[252:255]
    v_cvt_pk_bf16_f32 v80, v248, v249
    v_cvt_pk_bf16_f32 v81, v250, v251
    v_mfma_f32_16x16x32_bf16 a[24:27], v[104:107], v[48:51], a[24:27]
    ds_read_b128 a[224:227], v2 offset:8192
    ds_read_b128 a[228:231], v2 offset:9216
    v_mfma_f32_16x16x32_bf16 a[24:27], v[108:111], v[52:55], a[24:27]
    buffer_load_dwordx4 v1, s[36:39], s77 offen offset:2048 sc1 lds
    v_mfma_f32_16x16x32_bf16 a[28:31], v[104:107], v[56:59], a[28:31]
    v_exp_f32 v252, v252
    v_mfma_f32_16x16x32_bf16 a[28:31], v[108:111], v[60:63], a[28:31]
    v_exp_f32 v253, v253
    v_mfma_f32_16x16x32_bf16 v[240:243], a[240:243], v[128:131], v[180:183]
    v_exp_f32 v254, v254
    v_mfma_f32_16x16x32_bf16 v[240:243], a[244:247], v[160:163], v[240:243]
    v_exp_f32 v255, v255
    v_mfma_f32_16x16x32_bf16 v[240:243], a[248:251], v[192:195], v[240:243]
    v_cvt_pk_bf16_f32 v88, v252, v253
    v_cvt_pk_bf16_f32 v89, v254, v255
    v_mfma_f32_16x16x32_bf16 v[240:243], a[252:255], v[224:227], v[240:243]
    ds_read_b128 a[232:235], v2 offset:10240
    ds_read_b128 a[236:239], v2 offset:11264
    v_mfma_f32_16x16x32_bf16 a[32:35], v[112:115], v[32:35], a[32:35]
    ds_read_b128 v[104:107], v2 offset:26624
    v_mfma_f32_16x16x32_bf16 a[32:35], v[116:119], v[36:39], a[32:35]
    ds_read_b128 v[108:111], v2 offset:27648
    v_mfma_f32_16x16x32_bf16 a[36:39], v[112:115], v[40:43], a[36:39]
    v_mfma_f32_16x16x32_bf16 a[36:39], v[116:119], v[44:47], a[36:39]
    v_exp_f32 v240, v240
    v_mfma_f32_16x16x32_bf16 v[244:247], a[240:243], v[132:135], v[148:151]
    v_exp_f32 v241, v241
    v_mfma_f32_16x16x32_bf16 v[244:247], a[244:247], v[164:167], v[244:247]
    v_exp_f32 v242, v242
    v_mfma_f32_16x16x32_bf16 v[244:247], a[248:251], v[196:199], v[244:247]
    v_exp_f32 v243, v243
    v_mfma_f32_16x16x32_bf16 v[244:247], a[252:255], v[228:231], v[244:247]
    buffer_load_dwordx4 v1, s[36:39], s77 offen offset:3072 sc1 lds
    v_mfma_f32_16x16x32_bf16 a[40:43], v[112:115], v[48:51], a[40:43]
    v_cvt_pk_bf16_f32 v66, v240, v241
    v_cvt_pk_bf16_f32 v67, v242, v243
    v_mfma_f32_16x16x32_bf16 a[40:43], v[116:119], v[52:55], a[40:43]
    v_mfma_f32_16x16x32_bf16 a[44:47], v[112:115], v[56:59], a[44:47]
    ds_read_b128 v[112:115], v2 offset:28672
    v_mfma_f32_16x16x32_bf16 a[44:47], v[116:119], v[60:63], a[44:47]
    v_exp_f32 v244, v244
    v_mfma_f32_16x16x32_bf16 v[248:251], a[240:243], v[136:139], v[152:155]
    v_exp_f32 v245, v245
    v_mfma_f32_16x16x32_bf16 v[248:251], a[244:247], v[168:171], v[248:251]
    v_exp_f32 v246, v246
    v_mfma_f32_16x16x32_bf16 v[248:251], a[248:251], v[200:203], v[248:251]
    v_exp_f32 v247, v247
    v_mfma_f32_16x16x32_bf16 v[248:251], a[252:255], v[232:235], v[248:251]
    v_cvt_pk_bf16_f32 v74, v244, v245
    v_cvt_pk_bf16_f32 v75, v246, v247
    v_mfma_f32_16x16x32_bf16 a[48:51], v[120:123], v[32:35], a[48:51]
    ds_read_b128 v[116:119], v2 offset:29696
    v_mfma_f32_16x16x32_bf16 a[48:51], v[124:127], v[36:39], a[48:51]
    v_mfma_f32_16x16x32_bf16 a[52:55], v[120:123], v[40:43], a[52:55]
    v_mfma_f32_16x16x32_bf16 a[52:55], v[124:127], v[44:47], a[52:55]
    v_mfma_f32_16x16x32_bf16 v[252:255], a[240:243], v[140:143], v[156:159]
    v_exp_f32 v248, v248
    v_mfma_f32_16x16x32_bf16 v[252:255], a[244:247], v[172:175], v[252:255]
    s_add_u32 s100, s77, 4096
    v_exp_f32 v249, v249
    v_mfma_f32_16x16x32_bf16 v[252:255], a[248:251], v[204:207], v[252:255]
    s_add_u32 m0, m0, 4096
    v_exp_f32 v250, v250
    v_mfma_f32_16x16x32_bf16 v[252:255], a[252:255], v[236:239], v[252:255]
    buffer_load_dwordx4 v1, s[36:39], s100 offen sc1 lds
    v_mfma_f32_16x16x32_bf16 a[56:59], v[120:123], v[48:51], a[56:59]
    v_exp_f32 v251, v251
    v_mfma_f32_16x16x32_bf16 a[56:59], v[124:127], v[52:55], a[56:59]
    v_cvt_pk_bf16_f32 v82, v248, v249
    v_cvt_pk_bf16_f32 v83, v250, v251
    v_mfma_f32_16x16x32_bf16 a[60:63], v[120:123], v[56:59], a[60:63]
    ds_read_b128 a[240:243], v2 offset:12288
    ds_read_b128 a[244:247], v2 offset:13312
    v_mfma_f32_16x16x32_bf16 a[60:63], v[124:127], v[60:63], a[60:63]
    s_waitcnt lgkmcnt(2)
    v_exp_f32 v252, v252
    v_mfma_f32_16x16x32_bf16 v[240:243], a[224:227], v[128:131], v[184:187]
    v_exp_f32 v253, v253
    v_mfma_f32_16x16x32_bf16 v[240:243], a[228:231], v[160:163], v[240:243]
    v_exp_f32 v254, v254
    v_mfma_f32_16x16x32_bf16 v[240:243], a[232:235], v[192:195], v[240:243]
    v_exp_f32 v255, v255
    v_mfma_f32_16x16x32_bf16 v[240:243], a[236:239], v[224:227], v[240:243]
    v_cvt_pk_bf16_f32 v90, v252, v253
    v_cvt_pk_bf16_f32 v91, v254, v255
    v_mfma_f32_16x16x32_bf16 a[144:147], v[96:99], v[32:35], a[144:147]
    ds_read_b128 a[248:251], v2 offset:14336
    ds_read_b128 a[252:255], v2 offset:15360
    v_mfma_f32_16x16x32_bf16 a[144:147], v[100:103], v[36:39], a[144:147]
    ds_read_b128 v[120:123], v2 offset:30720
    v_mfma_f32_16x16x32_bf16 a[148:151], v[96:99], v[40:43], a[148:151]
    v_exp_f32 v240, v240
    v_mfma_f32_16x16x32_bf16 a[148:151], v[100:103], v[44:47], a[148:151]
    v_exp_f32 v241, v241
    v_mfma_f32_16x16x32_bf16 v[244:247], a[224:227], v[132:135], v[148:151]
    buffer_load_dwordx4 v1, s[36:39], s100 offen offset:1024 sc1 lds
    v_mfma_f32_16x16x32_bf16 v[244:247], a[228:231], v[164:167], v[244:247]
    v_exp_f32 v242, v242
    v_mfma_f32_16x16x32_bf16 v[244:247], a[232:235], v[196:199], v[244:247]
    v_exp_f32 v243, v243
    v_mfma_f32_16x16x32_bf16 v[244:247], a[236:239], v[228:231], v[244:247]
    v_cvt_pk_bf16_f32 v68, v240, v241
    v_cvt_pk_bf16_f32 v69, v242, v243
    v_mfma_f32_16x16x32_bf16 a[152:155], v[96:99], v[48:51], a[152:155]
    ds_read_b128 v[124:127], v2 offset:31744
    v_mfma_f32_16x16x32_bf16 a[152:155], v[100:103], v[52:55], a[152:155]
    v_mfma_f32_16x16x32_bf16 a[156:159], v[96:99], v[56:59], a[156:159]
    v_mfma_f32_16x16x32_bf16 a[156:159], v[100:103], v[60:63], a[156:159]
    v_mfma_f32_16x16x32_bf16 v[248:251], a[224:227], v[136:139], v[152:155]
    v_exp_f32 v244, v244
    v_mfma_f32_16x16x32_bf16 v[248:251], a[228:231], v[168:171], v[248:251]
    v_exp_f32 v245, v245
    v_mfma_f32_16x16x32_bf16 v[248:251], a[232:235], v[200:203], v[248:251]
    v_exp_f32 v246, v246
    v_mfma_f32_16x16x32_bf16 v[248:251], a[236:239], v[232:235], v[248:251]
    v_exp_f32 v247, v247
    v_mfma_f32_16x16x32_bf16 a[160:163], v[104:107], v[32:35], a[160:163]
    v_cvt_pk_bf16_f32 v76, v244, v245
    v_cvt_pk_bf16_f32 v77, v246, v247
    v_mfma_f32_16x16x32_bf16 a[160:163], v[108:111], v[36:39], a[160:163]
    v_mfma_f32_16x16x32_bf16 a[164:167], v[104:107], v[40:43], a[164:167]
    buffer_load_dwordx4 v1, s[36:39], s100 offen offset:2048 sc1 lds
    v_mfma_f32_16x16x32_bf16 a[164:167], v[108:111], v[44:47], a[164:167]
    v_exp_f32 v248, v248
    v_mfma_f32_16x16x32_bf16 v[252:255], a[224:227], v[140:143], v[156:159]
    v_exp_f32 v249, v249
    v_mfma_f32_16x16x32_bf16 v[252:255], a[228:231], v[172:175], v[252:255]
    v_exp_f32 v250, v250
    v_mfma_f32_16x16x32_bf16 v[252:255], a[232:235], v[204:207], v[252:255]
    v_exp_f32 v251, v251
    v_mfma_f32_16x16x32_bf16 v[252:255], a[236:239], v[236:239], v[252:255]
    v_cvt_pk_bf16_f32 v84, v248, v249
    v_cvt_pk_bf16_f32 v85, v250, v251
    v_mfma_f32_16x16x32_bf16 a[168:171], v[104:107], v[48:51], a[168:171]
    v_mfma_f32_16x16x32_bf16 a[168:171], v[108:111], v[52:55], a[168:171]
    v_mfma_f32_16x16x32_bf16 a[172:175], v[104:107], v[56:59], a[172:175]
    v_mfma_f32_16x16x32_bf16 a[172:175], v[108:111], v[60:63], a[172:175]
    s_waitcnt lgkmcnt(0)
    v_mfma_f32_16x16x32_bf16 v[240:243], a[240:243], v[128:131], v[188:191]
    v_mfma_f32_16x16x32_bf16 v[240:243], a[244:247], v[160:163], v[240:243]
    v_exp_f32 v252, v252
    v_mfma_f32_16x16x32_bf16 v[240:243], a[248:251], v[192:195], v[240:243]
    v_exp_f32 v253, v253
    v_mfma_f32_16x16x32_bf16 v[240:243], a[252:255], v[224:227], v[240:243]
    v_exp_f32 v254, v254
    v_mfma_f32_16x16x32_bf16 a[176:179], v[112:115], v[32:35], a[176:179]
    buffer_load_dwordx4 v1, s[36:39], s100 offen offset:3072 sc1 lds
    v_mfma_f32_16x16x32_bf16 a[176:179], v[116:119], v[36:39], a[176:179]
    v_exp_f32 v255, v255
    v_mfma_f32_16x16x32_bf16 a[180:183], v[112:115], v[40:43], a[180:183]
    v_cvt_pk_bf16_f32 v92, v252, v253
    v_cvt_pk_bf16_f32 v93, v254, v255
    v_mfma_f32_16x16x32_bf16 a[180:183], v[116:119], v[44:47], a[180:183]
    s_cmp_eq_u32 s82, 163840
    s_cselect_b32 s82, 0, s82
    v_add_u32 v2, s82, v1
    v_mfma_f32_16x16x32_bf16 v[244:247], a[240:243], v[132:135], v[148:151]
    ds_read_b128 a[224:227], v2 offset:0
    ds_read_b128 a[228:231], v2 offset:1024
    v_mfma_f32_16x16x32_bf16 v[244:247], a[244:247], v[164:167], v[244:247]
    v_exp_f32 v240, v240
    v_mfma_f32_16x16x32_bf16 v[244:247], a[248:251], v[196:199], v[244:247]
    ds_read_b128 a[232:235], v2 offset:2048
    ds_read_b128 a[236:239], v2 offset:3072
    v_mfma_f32_16x16x32_bf16 v[244:247], a[252:255], v[228:231], v[244:247]
    v_exp_f32 v241, v241
    v_mfma_f32_16x16x32_bf16 a[184:187], v[112:115], v[48:51], a[184:187]
    ds_read_b128 v[96:99], v2 offset:16384
    ds_read_b128 v[100:103], v2 offset:17408
    v_mfma_f32_16x16x32_bf16 a[184:187], v[116:119], v[52:55], a[184:187]
    v_exp_f32 v242, v242
    v_mfma_f32_16x16x32_bf16 a[188:191], v[112:115], v[56:59], a[188:191]
    v_exp_f32 v243, v243
    v_mfma_f32_16x16x32_bf16 a[188:191], v[116:119], v[60:63], a[188:191]
    v_exp_f32 v244, v244
    v_mfma_f32_16x16x32_bf16 v[248:251], a[240:243], v[136:139], v[152:155]
    v_exp_f32 v245, v245
    v_mfma_f32_16x16x32_bf16 v[248:251], a[244:247], v[168:171], v[248:251]
    v_exp_f32 v246, v246
    v_mfma_f32_16x16x32_bf16 v[248:251], a[248:251], v[200:203], v[248:251]
    s_add_u32 s77, s77, 32768
    v_exp_f32 v247, v247
    v_mfma_f32_16x16x32_bf16 v[248:251], a[252:255], v[232:235], v[248:251]
    v_cvt_pk_bf16_f32 v70, v240, v241
    v_cvt_pk_bf16_f32 v71, v242, v243
    v_mfma_f32_16x16x32_bf16 a[192:195], v[120:123], v[32:35], a[192:195]
    v_cvt_pk_bf16_f32 v78, v244, v245
    v_cvt_pk_bf16_f32 v79, v246, v247
    v_mfma_f32_16x16x32_bf16 a[192:195], v[124:127], v[36:39], a[192:195]
    v_mfma_f32_16x16x32_bf16 a[196:199], v[120:123], v[40:43], a[196:199]
    v_mfma_f32_16x16x32_bf16 a[196:199], v[124:127], v[44:47], a[196:199]
    v_exp_f32 v248, v248
    v_mfma_f32_16x16x32_bf16 v[252:255], a[240:243], v[140:143], v[156:159]
    v_exp_f32 v249, v249
    v_mfma_f32_16x16x32_bf16 v[252:255], a[244:247], v[172:175], v[252:255]
    v_exp_f32 v250, v250
    v_mfma_f32_16x16x32_bf16 v[252:255], a[248:251], v[204:207], v[252:255]
    v_exp_f32 v251, v251
    v_mfma_f32_16x16x32_bf16 v[252:255], a[252:255], v[236:239], v[252:255]
    v_cvt_pk_bf16_f32 v86, v248, v249
    v_cvt_pk_bf16_f32 v87, v250, v251
    v_mfma_f32_16x16x32_bf16 a[200:203], v[120:123], v[48:51], a[200:203]
    v_mfma_f32_16x16x32_bf16 a[200:203], v[124:127], v[52:55], a[200:203]
    v_mfma_f32_16x16x32_bf16 a[204:207], v[120:123], v[56:59], a[204:207]
    v_mfma_f32_16x16x32_bf16 a[204:207], v[124:127], v[60:63], a[204:207]
    v_mfma_f32_16x16x32_bf16 a[208:211], a[136:139], v[32:35], a[208:211]
    v_mfma_f32_16x16x32_bf16 a[208:211], a[136:139], v[36:39], a[208:211]
    v_exp_f32 v252, v252
    v_mfma_f32_16x16x32_bf16 a[212:215], a[136:139], v[40:43], a[212:215]
    v_exp_f32 v253, v253
    v_mfma_f32_16x16x32_bf16 a[212:215], a[136:139], v[44:47], a[212:215]
    v_cvt_pk_bf16_f32 v94, v252, v253
    v_mfma_f32_16x16x32_bf16 a[216:219], a[136:139], v[48:51], a[216:219]
    v_mfma_f32_16x16x32_bf16 a[216:219], a[136:139], v[52:55], a[216:219]
    v_mfma_f32_16x16x32_bf16 a[220:223], a[136:139], v[56:59], a[220:223]
    v_mfma_f32_16x16x32_bf16 a[220:223], a[136:139], v[60:63], a[220:223]
    s_cmp_le_u32 s78, 1
    s_cbranch_scc1 K1_LB_MASK
K1_LB_BACK:
    s_waitcnt lgkmcnt(0)
    v_mfma_f32_16x16x32_bf16 v[240:243], a[224:227], v[128:131], v[176:179]
    s_add_u32 m0, s76, s75
    v_exp_f32 v254, v254
    v_mfma_f32_16x16x32_bf16 v[240:243], a[228:231], v[160:163], v[240:243]
    s_mov_b32 s76, s60
    buffer_load_dwordx4 v1, s[36:39], s77 offen sc1 lds
    v_mfma_f32_16x16x32_bf16 v[240:243], a[232:235], v[192:195], v[240:243]
    s_mov_b32 s60, s82
    v_exp_f32 v255, v255
    v_mfma_f32_16x16x32_bf16 v[240:243], a[236:239], v[224:227], v[240:243]
    s_add_u32 s82, s82, 32768
    ds_read_b128 v[104:107], v2 offset:18432
    v_cvt_pk_bf16_f32 v95, v254, v255
    v_mfma_f32_16x16x32_bf16 a[0:3], v[96:99], v[64:67], a[0:3]
    ds_read_b128 v[108:111], v2 offset:19456
    ds_read_b128 a[240:243], v2 offset:4096
    v_mfma_f32_16x16x32_bf16 a[0:3], v[100:103], v[68:71], a[0:3]
    ds_read_b128 a[244:247], v2 offset:5120
    v_mfma_f32_16x16x32_bf16 a[4:7], v[96:99], v[72:75], a[4:7]
    v_exp_f32 v240, v240
    v_mfma_f32_16x16x32_bf16 a[4:7], v[100:103], v[76:79], a[4:7]
    ds_read_b128 a[248:251], v2 offset:6144
    ds_read_b128 a[252:255], v2 offset:7168
    v_mfma_f32_16x16x32_bf16 v[244:247], a[224:227], v[132:135], v[148:151]
    v_exp_f32 v241, v241
    v_mfma_f32_16x16x32_bf16 v[244:247], a[228:231], v[164:167], v[244:247]
    ds_read_b128 v[112:115], v2 offset:20480
    ds_read_b128 v[116:119], v2 offset:21504
    v_mfma_f32_16x16x32_bf16 v[244:247], a[232:235], v[196:199], v[244:247]
    v_exp_f32 v242, v242
    v_mfma_f32_16x16x32_bf16 v[244:247], a[236:239], v[228:231], v[244:247]
    v_exp_f32 v243, v243
    v_mfma_f32_16x16x32_bf16 a[8:11], v[96:99], v[80:83], a[8:11]
    v_cvt_pk_bf16_f32 v32, v240, v241
    v_cvt_pk_bf16_f32 v33, v242, v243
    v_mfma_f32_16x16x32_bf16 a[8:11], v[100:103], v[84:87], a[8:11]
    ds_read_b128 v[120:123], v2 offset:22528
    ds_read_b128 v[124:127], v2 offset:23552
    v_mfma_f32_16x16x32_bf16 a[12:15], v[96:99], v[88:91], a[12:15]
    v_exp_f32 v244, v244
    v_mfma_f32_16x16x32_bf16 a[12:15], v[100:103], v[92:95], a[12:15]
    buffer_load_dwordx4 v1, s[36:39], s77 offen offset:1024 sc1 lds
    v_mfma_f32_16x16x32_bf16 v[248:251], a[224:227], v[136:139], v[152:155]
    v_exp_f32 v245, v245
    v_mfma_f32_16x16x32_bf16 v[248:251], a[228:231], v[168:171], v[248:251]
    v_exp_f32 v246, v246
    v_mfma_f32_16x16x32_bf16 v[248:251], a[232:235], v[200:203], v[248:251]
    v_exp_f32 v247, v247
    v_mfma_f32_16x16x32_bf16 v[248:251], a[236:239], v[232:235], v[248:251]
    s_waitcnt lgkmcnt(0)
    v_cvt_pk_bf16_f32 v40, v244, v245
    v_cvt_pk_bf16_f32 v41, v246, v247
    v_mfma_f32_16x16x32_bf16 a[16:19], v[104:107], v[64:67], a[16:19]
    ds_read_b128 v[96:99], v2 offset:24576
    ds_read_b128 v[100:103], v2 offset:25600
    v_mfma_f32_16x16x32_bf16 a[16:19], v[108:111], v[68:71], a[16:19]
    v_mfma_f32_16x16x32_bf16 a[20:23], v[104:107], v[72:75], a[20:23]
    v_mfma_f32_16x16x32_bf16 a[20:23], v[108:111], v[76:79], a[20:23]
    v_exp_f32 v248, v248
    v_mfma_f32_16x16x32_bf16 v[252:255], a[224:227], v[140:143], v[156:159]
    v_exp_f32 v249, v249
    v_mfma_f32_16x16x32_bf16 v[252:255], a[228:231], v[172:175], v[252:255]
    v_exp_f32 v250, v250
    v_mfma_f32_16x16x32_bf16 v[252:255], a[232:235], v[204:207], v[252:255]
    v_exp_f32 v251, v251
    v_mfma_f32_16x16x32_bf16 v[252:255], a[236:239], v[236:239], v[252:255]
    v_cvt_pk_bf16_f32 v48, v248, v249
    v_cvt_pk_bf16_f32 v49, v250, v251
    v_mfma_f32_16x16x32_bf16 a[24:27], v[104:107], v[80:83], a[24:27]
    ds_read_b128 a[224:227], v2 offset:8192
    ds_read_b128 a[228:231], v2 offset:9216
    v_mfma_f32_16x16x32_bf16 a[24:27], v[108:111], v[84:87], a[24:27]
    buffer_load_dwordx4 v1, s[36:39], s77 offen offset:2048 sc1 lds
    v_mfma_f32_16x16x32_bf16 a[28:31], v[104:107], v[88:91], a[28:31]
    v_exp_f32 v252, v252
    v_mfma_f32_16x16x32_bf16 a[28:31], v[108:111], v[92:95], a[28:31]
    v_exp_f32 v253, v253
    v_mfma_f32_16x16x32_bf16 v[240:243], a[240:243], v[128:131], v[180:183]
    v_exp_f32 v254, v254
    v_mfma_f32_16x16x32_bf16 v[240:243], a[244:247], v[160:163], v[240:243]
    v_exp_f32 v255, v255
    v_mfma_f32_16x16x32_bf16 v[240:243], a[248:251], v[192:195], v[240:243]
    v_cvt_pk_bf16_f32 v56, v252, v253
    v_cvt_pk_bf16_f32 v57, v254, v255
    v_mfma_f32_16x16x32_bf16 v[240:243], a[252:255], v[224:227], v[240:243]
    ds_read_b128 a[232:235], v2 offset:10240
    ds_read_b128 a[236:239], v2 offset:11264
    v_mfma_f32_16x16x32_bf16 a[32:35], v[112:115], v[64:67], a[32:35]
    ds_read_b128 v[104:107], v2 offset:26624
    v_mfma_f32_16x16x32_bf16 a[32:35], v[116:119], v[68:71], a[32:35]
    ds_read_b128 v[108:111], v2 offset:27648
    v_mfma_f32_16x16x32_bf16 a[36:39], v[112:115], v[72:75], a[36:39]
    v_mfma_f32_16x16x32_bf16 a[36:39], v[116:119], v[76:79], a[36:39]
    v_exp_f32 v240, v240
    v_mfma_f32_16x16x32_bf16 v[244:247], a[240:243], v[132:135], v[148:151]
    v_exp_f32 v241, v241
    v_mfma_f32_16x16x32_bf16 v[244:247], a[244:247], v[164:167], v[244:247]
    v_exp_f32 v242, v242
    v_mfma_f32_16x16x32_bf16 v[244:247], a[248:251], v[196:199], v[244:247]
    v_exp_f32 v243, v243
    v_mfma_f32_16x16x32_bf16 v[244:247], a[252:255], v[228:231], v[244:247]
    buffer_load_dwordx4 v1, s[36:39], s77 offen offset:3072 sc1 lds
    v_mfma_f32_16x16x32_bf16 a[40:43], v[112:115], v[80:83], a[40:43]
    v_cvt_pk_bf16_f32 v34, v240, v241
    v_cvt_pk_bf16_f32 v35, v242, v243
    v_mfma_f32_16x16x32_bf16 a[40:43], v[116:119], v[84:87], a[40:43]
    v_mfma_f32_16x16x32_bf16 a[44:47], v[112:115], v[88:91], a[44:47]
    ds_read_b128 v[112:115], v2 offset:28672
    v_mfma_f32_16x16x32_bf16 a[44:47], v[116:119], v[92:95], a[44:47]
    v_exp_f32 v244, v244
    v_mfma_f32_16x16x32_bf16 v[248:251], a[240:243], v[136:139], v[152:155]
    v_exp_f32 v245, v245
    v_mfma_f32_16x16x32_bf16 v[248:251], a[244:247], v[168:171], v[248:251]
    v_exp_f32 v246, v246
    v_mfma_f32_16x16x32_bf16 v[248:251], a[248:251], v[200:203], v[248:251]
    v_exp_f32 v247, v247
    v_mfma_f32_16x16x32_bf16 v[248:251], a[252:255], v[232:235], v[248:251]
    v_cvt_pk_bf16_f32 v42, v244, v245
    v_cvt_pk_bf16_f32 v43, v246, v247
    v_mfma_f32_16x16x32_bf16 a[48:51], v[120:123], v[64:67], a[48:51]
    ds_read_b128 v[116:119], v2 offset:29696
    v_mfma_f32_16x16x32_bf16 a[48:51], v[124:127], v[68:71], a[48:51]
    v_mfma_f32_16x16x32_bf16 a[52:55], v[120:123], v[72:75], a[52:55]
    v_mfma_f32_16x16x32_bf16 a[52:55], v[124:127], v[76:79], a[52:55]
    v_mfma_f32_16x16x32_bf16 v[252:255], a[240:243], v[140:143], v[156:159]
    v_exp_f32 v248, v248
    v_mfma_f32_16x16x32_bf16 v[252:255], a[244:247], v[172:175], v[252:255]
    s_add_u32 s100, s77, 4096
    v_exp_f32 v249, v249
    v_mfma_f32_16x16x32_bf16 v[252:255], a[248:251], v[204:207], v[252:255]
    s_add_u32 m0, m0, 4096
    v_exp_f32 v250, v250
    v_mfma_f32_16x16x32_bf16 v[252:255], a[252:255], v[236:239], v[252:255]
    buffer_load_dwordx4 v1, s[36:39], s100 offen sc1 lds
    v_mfma_f32_16x16x32_bf16 a[56:59], v[120:123], v[80:83], a[56:59]
    v_exp_f32 v251, v251
    v_mfma_f32_16x16x32_bf16 a[56:59], v[124:127], v[84:87], a[56:59]
    v_cvt_pk_bf16_f32 v50, v248, v249
    v_cvt_pk_bf16_f32 v51, v250, v251
    v_mfma_f32_16x16x32_bf16 a[60:63], v[120:123], v[88:91], a[60:63]
    ds_read_b128 a[240:243], v2 offset:12288
    ds_read_b128 a[244:247], v2 offset:13312
    v_mfma_f32_16x16x32_bf16 a[60:63], v[124:127], v[92:95], a[60:63]
    s_waitcnt lgkmcnt(2)
    v_exp_f32 v252, v252
    v_mfma_f32_16x16x32_bf16 v[240:243], a[224:227], v[128:131], v[184:187]
    v_exp_f32 v253, v253
    v_mfma_f32_16x16x32_bf16 v[240:243], a[228:231], v[160:163], v[240:243]
    v_exp_f32 v254, v254
    v_mfma_f32_16x16x32_bf16 v[240:243], a[232:235], v[192:195], v[240:243]
    v_exp_f32 v255, v255
    v_mfma_f32_16x16x32_bf16 v[240:243], a[236:239], v[224:227], v[240:243]
    v_cvt_pk_bf16_f32 v58, v252, v253
    v_cvt_pk_bf16_f32 v59, v254, v255
    v_mfma_f32_16x16x32_bf16 a[144:147], v[96:99], v[64:67], a[144:147]
    ds_read_b128 a[248:251], v2 offset:14336
    ds_read_b128 a[252:255], v2 offset:15360
    v_mfma_f32_16x16x32_bf16 a[144:147], v[100:103], v[68:71], a[144:147]
    ds_read_b128 v[120:123], v2 offset:30720
    v_mfma_f32_16x16x32_bf16 a[148:151], v[96:99], v[72:75], a[148:151]
    v_exp_f32 v240, v240
    v_mfma_f32_16x16x32_bf16 a[148:151], v[100:103], v[76:79], a[148:151]
    v_exp_f32 v241, v241
    v_mfma_f32_16x16x32_bf16 v[244:247], a[224:227], v[132:135], v[148:151]
    buffer_load_dwordx4 v1, s[36:39], s100 offen offset:1024 sc1 lds
    v_mfma_f32_16x16x32_bf16 v[244:247], a[228:231], v[164:167], v[244:247]
    v_exp_f32 v242, v242
    v_mfma_f32_16x16x32_bf16 v[244:247], a[232:235], v[196:199], v[244:247]
    v_exp_f32 v243, v243
    v_mfma_f32_16x16x32_bf16 v[244:247], a[236:239], v[228:231], v[244:247]
    v_cvt_pk_bf16_f32 v36, v240, v241
    v_cvt_pk_bf16_f32 v37, v242, v243
    v_mfma_f32_16x16x32_bf16 a[152:155], v[96:99], v[80:83], a[152:155]
    ds_read_b128 v[124:127], v2 offset:31744
    v_mfma_f32_16x16x32_bf16 a[152:155], v[100:103], v[84:87], a[152:155]
    v_mfma_f32_16x16x32_bf16 a[156:159], v[96:99], v[88:91], a[156:159]
    v_mfma_f32_16x16x32_bf16 a[156:159], v[100:103], v[92:95], a[156:159]
    v_mfma_f32_16x16x32_bf16 v[248:251], a[224:227], v[136:139], v[152:155]
    v_exp_f32 v244, v244
    v_mfma_f32_16x16x32_bf16 v[248:251], a[228:231], v[168:171], v[248:251]
    v_exp_f32 v245, v245
    v_mfma_f32_16x16x32_bf16 v[248:251], a[232:235], v[200:203], v[248:251]
    v_exp_f32 v246, v246
    v_mfma_f32_16x16x32_bf16 v[248:251], a[236:239], v[232:235], v[248:251]
    v_exp_f32 v247, v247
    v_mfma_f32_16x16x32_bf16 a[160:163], v[104:107], v[64:67], a[160:163]
    v_cvt_pk_bf16_f32 v44, v244, v245
    v_cvt_pk_bf16_f32 v45, v246, v247
    v_mfma_f32_16x16x32_bf16 a[160:163], v[108:111], v[68:71], a[160:163]
    v_mfma_f32_16x16x32_bf16 a[164:167], v[104:107], v[72:75], a[164:167]
    buffer_load_dwordx4 v1, s[36:39], s100 offen offset:2048 sc1 lds
    v_mfma_f32_16x16x32_bf16 a[164:167], v[108:111], v[76:79], a[164:167]
    v_exp_f32 v248, v248
    v_mfma_f32_16x16x32_bf16 v[252:255], a[224:227], v[140:143], v[156:159]
    v_exp_f32 v249, v249
    v_mfma_f32_16x16x32_bf16 v[252:255], a[228:231], v[172:175], v[252:255]
    v_exp_f32 v250, v250
    v_mfma_f32_16x16x32_bf16 v[252:255], a[232:235], v[204:207], v[252:255]
    v_exp_f32 v251, v251
    v_mfma_f32_16x16x32_bf16 v[252:255], a[236:239], v[236:239], v[252:255]
    v_cvt_pk_bf16_f32 v52, v248, v249
    v_cvt_pk_bf16_f32 v53, v250, v251
    v_mfma_f32_16x16x32_bf16 a[168:171], v[104:107], v[80:83], a[168:171]
    v_mfma_f32_16x16x32_bf16 a[168:171], v[108:111], v[84:87], a[168:171]
    v_mfma_f32_16x16x32_bf16 a[172:175], v[104:107], v[88:91], a[172:175]
    v_mfma_f32_16x16x32_bf16 a[172:175], v[108:111], v[92:95], a[172:175]
    s_waitcnt lgkmcnt(0)
    v_mfma_f32_16x16x32_bf16 v[240:243], a[240:243], v[128:131], v[188:191]
    v_mfma_f32_16x16x32_bf16 v[240:243], a[244:247], v[160:163], v[240:243]
    v_exp_f32 v252, v252
    v_mfma_f32_16x16x32_bf16 v[240:243], a[248:251], v[192:195], v[240:243]
    v_exp_f32 v253, v253
    v_mfma_f32_16x16x32_bf16 v[240:243], a[252:255], v[224:227], v[240:243]
    v_exp_f32 v254, v254
    v_mfma_f32_16x16x32_bf16 a[176:179], v[112:115], v[64:67], a[176:179]
    buffer_load_dwordx4 v1, s[36:39], s100 offen offset:3072 sc1 lds
    v_mfma_f32_16x16x32_bf16 a[176:179], v[116:119], v[68:71], a[176:179]
    v_exp_f32 v255, v255
    v_mfma_f32_16x16x32_bf16 a[180:183], v[112:115], v[72:75], a[180:183]
    v_cvt_pk_bf16_f32 v60, v252, v253
    v_cvt_pk_bf16_f32 v61, v254, v255
    v_mfma_f32_16x16x32_bf16 a[180:183], v[116:119], v[76:79], a[180:183]
    s_cmp_eq_u32 s82, 163840
    s_cselect_b32 s82, 0, s82
    v_add_u32 v2, s82, v1
    v_mfma_f32_16x16x32_bf16 v[244:247], a[240:243], v[132:135], v[148:151]
    v_exp_f32 v240, v240
    v_mfma_f32_16x16x32_bf16 v[244:247], a[244:247], v[164:167], v[244:247]
    v_exp_f32 v241, v241
    v_mfma_f32_16x16x32_bf16 v[244:247], a[248:251], v[196:199], v[244:247]
    v_exp_f32 v242, v242
    v_mfma_f32_16x16x32_bf16 v[244:247], a[252:255], v[228:231], v[244:247]
    v_exp_f32 v243, v243
    v_mfma_f32_16x16x32_bf16 a[184:187], v[112:115], v[80:83], a[184:187]
    v_cvt_pk_bf16_f32 v38, v240, v241
    v_cvt_pk_bf16_f32 v39, v242, v243
    v_mfma_f32_16x16x32_bf16 a[184:187], v[116:119], v[84:87], a[184:187]
    v_mfma_f32_16x16x32_bf16 a[188:191], v[112:115], v[88:91], a[188:191]
    v_mfma_f32_16x16x32_bf16 a[188:191], v[116:119], v[92:95], a[188:191]
    v_mfma_f32_16x16x32_bf16 v[248:251], a[240:243], v[136:139], v[152:155]
    v_exp_f32 v244, v244
    v_mfma_f32_16x16x32_bf16 v[248:251], a[244:247], v[168:171], v[248:251]
    v_exp_f32 v245, v245
    v_mfma_f32_16x16x32_bf16 v[248:251], a[248:251], v[200:203], v[248:251]
    s_add_u32 s77, s77, 32768
    v_exp_f32 v246, v246
    v_mfma_f32_16x16x32_bf16 v[248:251], a[252:255], v[232:235], v[248:251]
    v_exp_f32 v247, v247
    v_mfma_f32_16x16x32_bf16 a[192:195], v[120:123], v[64:67], a[192:195]
    v_cvt_pk_bf16_f32 v46, v244, v245
    v_cvt_pk_bf16_f32 v47, v246, v247
    v_mfma_f32_16x16x32_bf16 a[192:195], v[124:127], v[68:71], a[192:195]
    v_mfma_f32_16x16x32_bf16 a[196:199], v[120:123], v[72:75], a[196:199]
    v_mfma_f32_16x16x32_bf16 a[196:199], v[124:127], v[76:79], a[196:199]
    v_mfma_f32_16x16x32_bf16 v[252:255], a[240:243], v[140:143], v[156:159]
    v_exp_f32 v248, v248
    v_mfma_f32_16x16x32_bf16 v[252:255], a[244:247], v[172:175], v[252:255]
    v_exp_f32 v249, v249
    v_mfma_f32_16x16x32_bf16 v[252:255], a[248:251], v[204:207], v[252:255]
    v_exp_f32 v250, v250
    v_mfma_f32_16x16x32_bf16 v[252:255], a[252:255], v[236:239], v[252:255]
    s_waitcnt vmcnt(8) lgkmcnt(0)
    s_barrier
    ds_read_b128 a[224:227], v2 offset:0
    v_mfma_f32_16x16x32_bf16 a[200:203], v[120:123], v[80:83], a[200:203]
    ds_read_b128 a[228:231], v2 offset:1024
    ds_read_b128 a[232:235], v2 offset:2048
    v_mfma_f32_16x16x32_bf16 a[200:203], v[124:127], v[84:87], a[200:203]
    ds_read_b128 a[236:239], v2 offset:3072
    v_cvt_pk_bf16_f32 v54, v248, v249
    v_mfma_f32_16x16x32_bf16 a[204:207], v[120:123], v[88:91], a[204:207]
    v_exp_f32 v251, v251
    v_mfma_f32_16x16x32_bf16 a[204:207], v[124:127], v[92:95], a[204:207]
    ds_read_b128 v[96:99], v2 offset:16384
    ds_read_b128 v[100:103], v2 offset:17408
    v_mfma_f32_16x16x32_bf16 a[208:211], a[136:139], v[64:67], a[208:211]
    v_exp_f32 v252, v252
    v_mfma_f32_16x16x32_bf16 a[208:211], a[136:139], v[68:71], a[208:211]
    v_exp_f32 v253, v253
    v_mfma_f32_16x16x32_bf16 a[212:215], a[136:139], v[72:75], a[212:215]
    v_cvt_pk_bf16_f32 v55, v250, v251
    v_cvt_pk_bf16_f32 v62, v252, v253
    v_mfma_f32_16x16x32_bf16 a[212:215], a[136:139], v[76:79], a[212:215]
    v_mfma_f32_16x16x32_bf16 a[216:219], a[136:139], v[80:83], a[216:219]
    v_mfma_f32_16x16x32_bf16 a[216:219], a[136:139], v[84:87], a[216:219]
    v_mfma_f32_16x16x32_bf16 a[220:223], a[136:139], v[88:91], a[220:223]
    v_mfma_f32_16x16x32_bf16 a[220:223], a[136:139], v[92:95], a[220:223]
    s_sub_u32 s78, s78, 1
    s_cmp_lg_u32 s78, 0
    s_cbranch_scc1 K1_LB
K1_LB_END:
    v_add_f32 v212, s12, v148
    v_fma_f32 v176, v208, s8, v212
    v_fma_f32 v177, v209, s8, v212
    v_fma_f32 v178, v210, s8, v212
    v_fma_f32 v179, v211, s8, v212
    s_nop 1
    s_waitcnt lgkmcnt(0)
    v_mfma_f32_16x16x32_bf16 v[240:243], a[224:227], v[132:135], v[176:179]
    s_mov_b32 s7, 0
    ds_read_b128 v[104:107], v2 offset:18432
    ds_read_b128 v[108:111], v2 offset:19456
    v_mfma_f32_16x16x32_bf16 v[240:243], a[228:231], v[164:167], v[240:243]
    s_lshl_b32 s29, s6, 2
    buffer_load_dwordx4 v[64:67], v11, s[48:51], s7 offen nt
    v_mfma_f32_16x16x32_bf16 v[240:243], a[232:235], v[196:199], v[240:243]
    s_mov_b32 s7, 18432
    v_exp_f32 v254, v254
    v_mfma_f32_16x16x32_bf16 v[240:243], a[236:239], v[228:231], v[240:243]
    s_lshr_b32 s29, 0x41302413, s29
    v_exp_f32 v255, v255
    v_mfma_f32_16x16x32_bf16 a[0:3], v[96:99], v[32:35], a[0:3]
    s_and_b32 s29, s29, 7
    v_cvt_pk_bf16_f32 v63, v254, v255
    ds_read_b128 a[240:243], v2 offset:4096
    v_mfma_f32_16x16x32_bf16 a[0:3], v[100:103], v[36:39], a[0:3]
    s_lshl_b32 s29, s29, 15
    buffer_load_dwordx4 v[68:71], v11, s[48:51], s7 offen nt
    v_mfma_f32_16x16x32_bf16 a[4:7], v[96:99], v[40:43], a[4:7]
    s_mov_b32 s7, 9216
    ds_read_b128 a[244:247], v2 offset:5120
    ds_read_b128 a[248:251], v2 offset:6144
    v_mfma_f32_16x16x32_bf16 a[4:7], v[100:103], v[44:47], a[4:7]
    s_add_u32 s44, s29, s75
    ds_read_b128 a[252:255], v2 offset:7168
    v_add_f32 v213, s13, v148
    v_mfma_f32_16x16x32_bf16 v[244:247], a[224:227], v[136:139], v[152:155]
    s_lshl_b32 s29, s6, 2
    ds_read_b128 v[112:115], v2 offset:20480
    v_fma_f32 v180, v208, s9, v213
    v_mfma_f32_16x16x32_bf16 v[244:247], a[228:231], v[168:171], v[244:247]
    s_lshr_b32 s29, 0x2413024, s29
    buffer_load_dwordx4 v[20:23], v11, s[48:51], s7 offen nt
    v_mfma_f32_16x16x32_bf16 v[244:247], a[232:235], v[200:203], v[244:247]
    s_mov_b32 s7, 27648
    ds_read_b128 v[116:119], v2 offset:21504
    v_fma_f32 v181, v209, s9, v213
    v_mfma_f32_16x16x32_bf16 v[244:247], a[236:239], v[232:235], v[244:247]
    s_and_b32 s29, s29, 7
    v_fma_f32 v182, v210, s9, v213
    v_fma_f32 v183, v211, s9, v213
    v_mfma_f32_16x16x32_bf16 a[8:11], v[96:99], v[48:51], a[8:11]
    s_lshl_b32 s29, s29, 15
    v_exp_f32 v240, v240
    v_mfma_f32_16x16x32_bf16 a[8:11], v[100:103], v[52:55], a[8:11]
    s_add_u32 s45, s29, s75
    buffer_load_dwordx4 v[24:27], v11, s[48:51], s7 offen nt
    v_mfma_f32_16x16x32_bf16 a[12:15], v[96:99], v[56:59], a[12:15]
    s_lshl_b32 s29, s6, 2
    v_exp_f32 v241, v241
    v_mfma_f32_16x16x32_bf16 a[12:15], v[100:103], v[60:63], a[12:15]
    s_lshr_b32 s29, 0x13024130, s29
    v_exp_f32 v242, v242
    s_waitcnt lgkmcnt(0)
    v_mfma_f32_16x16x32_bf16 a[16:19], v[104:107], v[32:35], a[16:19]
    s_and_b32 s29, s29, 7
    v_exp_f32 v243, v243
    v_mfma_f32_16x16x32_bf16 a[16:19], v[108:111], v[36:39], a[16:19]
    s_lshl_b32 s29, s29, 15
    buffer_load_dwordx4 v[144:147], v12, s[52:55], 0 offen nt
    v_mfma_f32_16x16x32_bf16 v[248:251], a[224:227], v[140:143], v[156:159]
    s_add_u32 s46, s29, s75
    v_cvt_pk_bf16_f32 v72, v240, v241
    v_cvt_pk_bf16_f32 v73, v242, v243
    v_mfma_f32_16x16x32_bf16 v[248:251], a[228:231], v[172:175], v[248:251]
    s_lshl_b32 s29, s6, 2
    ds_read_b128 v[120:123], v2 offset:22528
    ds_read_b128 v[124:127], v2 offset:23552
    v_mfma_f32_16x16x32_bf16 v[248:251], a[232:235], v[204:207], v[248:251]
    s_lshr_b32 s29, 0x24130241, s29
    v_exp_f32 v244, v244
    v_mfma_f32_16x16x32_bf16 v[248:251], a[236:239], v[236:239], v[248:251]
    s_and_b32 s29, s29, 7
    buffer_load_dwordx4 a[140:143], v13, s[52:55], 0 offen nt
    v_mfma_f32_16x16x32_bf16 a[20:23], v[104:107], v[40:43], a[20:23]
    s_lshl_b32 s29, s29, 15
    v_exp_f32 v245, v245
    v_mfma_f32_16x16x32_bf16 a[20:23], v[108:111], v[44:47], a[20:23]
    s_mov_b32 s98, 0x3fb8aa3b
    v_exp_f32 v246, v246
    v_mfma_f32_16x16x32_bf16 a[24:27], v[104:107], v[48:51], a[24:27]
    s_add_u32 s47, s29, s75
    v_exp_f32 v247, v247
    v_mfma_f32_16x16x32_bf16 a[24:27], v[108:111], v[52:55], a[24:27]
    s_lshl_b32 s29, s6, 2
    v_cvt_pk_bf16_f32 v80, v244, v245
    v_cvt_pk_bf16_f32 v81, v246, v247
    v_mfma_f32_16x16x32_bf16 a[28:31], v[104:107], v[56:59], a[28:31]
    s_lshr_b32 s29, 0x30241302, s29
    ds_read_b128 a[224:227], v2 offset:8192
    ds_read_b128 a[228:231], v2 offset:9216
    v_mfma_f32_16x16x32_bf16 a[28:31], v[108:111], v[60:63], a[28:31]
    s_lshr_b32 s61, s5, 3
    ds_read_b128 a[232:235], v2 offset:10240
    v_add_f32 v214, s14, v148
    v_mfma_f32_16x16x32_bf16 v[252:255], a[240:243], v[132:135], v[180:183]
    s_add_u32 s3, s5, s6
    ds_read_b128 a[236:239], v2 offset:11264
    v_fma_f32 v184, v208, s10, v214
    v_mfma_f32_16x16x32_bf16 v[252:255], a[244:247], v[164:167], v[252:255]
    s_and_b32 s29, s29, 7
    ds_read_b128 v[96:99], v2 offset:24576
    v_fma_f32 v185, v209, s10, v214
    v_mfma_f32_16x16x32_bf16 v[252:255], a[248:251], v[196:199], v[252:255]
    s_add_u32 s74, s4, 1
    ds_read_b128 v[100:103], v2 offset:25600
    v_fma_f32 v186, v210, s10, v214
    v_mfma_f32_16x16x32_bf16 v[252:255], a[252:255], v[228:231], v[252:255]
    s_and_b32 s28, s5, 3
    v_exp_f32 v248, v248
    v_mfma_f32_16x16x32_bf16 a[32:35], v[112:115], v[32:35], a[32:35]
    s_and_b32 s3, s3, 1
    v_exp_f32 v249, v249
    v_mfma_f32_16x16x32_bf16 a[32:35], v[116:119], v[36:39], a[32:35]
    s_lshl_b32 s29, s29, 15
    v_exp_f32 v250, v250
    v_mfma_f32_16x16x32_bf16 a[36:39], v[112:115], v[40:43], a[36:39]
    s_lshl2_add_u32 s66, s6, s61
    v_exp_f32 v251, v251
    v_mfma_f32_16x16x32_bf16 a[36:39], v[116:119], v[44:47], a[36:39]
    s_mul_i32 s71, s5, 768
    v_fma_f32 v187, v211, s10, v214
    v_cvt_pk_bf16_f32 v88, v248, v249
    v_mfma_f32_16x16x32_bf16 v[240:243], a[240:243], v[136:139], v[152:155]
    s_lshl_b32 s74, s74, 15
    v_cvt_pk_bf16_f32 v89, v250, v251
    ds_read_b128 v[104:107], v2 offset:26624
    v_mfma_f32_16x16x32_bf16 v[240:243], a[244:247], v[168:171], v[240:243]
    s_mul_i32 s28, s28, 9216
    v_exp_f32 v252, v252
    v_mfma_f32_16x16x32_bf16 v[240:243], a[248:251], v[200:203], v[240:243]
    s_lshl3_add_u32 s3, s61, s3
    v_exp_f32 v253, v253
    v_mfma_f32_16x16x32_bf16 v[240:243], a[252:255], v[232:235], v[240:243]
    s_add_u32 s79, s29, s75
    v_exp_f32 v254, v254
    v_mfma_f32_16x16x32_bf16 a[40:43], v[112:115], v[48:51], a[40:43]
    s_lshl_b32 s66, s66, 10
    v_exp_f32 v255, v255
    v_mfma_f32_16x16x32_bf16 a[40:43], v[116:119], v[52:55], a[40:43]
    s_add_u32 s71, s71, 131072
    v_cvt_pk_bf16_f32 v74, v252, v253
    v_cvt_pk_bf16_f32 v75, v254, v255
    v_mfma_f32_16x16x32_bf16 a[44:47], v[112:115], v[56:59], a[44:47]
    s_add_u32 s74, s74, s101
    ds_read_b128 v[108:111], v2 offset:27648
    ds_read_b128 v[112:115], v2 offset:28672
    v_mfma_f32_16x16x32_bf16 a[44:47], v[116:119], v[60:63], a[44:47]
    s_waitcnt lgkmcnt(2)
    v_exp_f32 v240, v240
    v_mfma_f32_16x16x32_bf16 a[48:51], v[120:123], v[32:35], a[48:51]
    v_exp_f32 v241, v241
    v_mfma_f32_16x16x32_bf16 a[48:51], v[124:127], v[36:39], a[48:51]
    v_exp_f32 v242, v242
    v_mfma_f32_16x16x32_bf16 v[244:247], a[240:243], v[140:143], v[156:159]
    v_exp_f32 v243, v243
    v_mfma_f32_16x16x32_bf16 v[244:247], a[244:247], v[172:175], v[244:247]
    v_cvt_pk_bf16_f32 v82, v240, v241
    v_cvt_pk_bf16_f32 v83, v242, v243
    v_mfma_f32_16x16x32_bf16 v[244:247], a[248:251], v[204:207], v[244:247]
    ds_read_b128 a[240:243], v2 offset:12288
    ds_read_b128 a[244:247], v2 offset:13312
    v_mfma_f32_16x16x32_bf16 v[244:247], a[252:255], v[236:239], v[244:247]
    ds_read_b128 a[248:251], v2 offset:14336
    v_add_f32 v215, s15, v148
    v_mfma_f32_16x16x32_bf16 a[52:55], v[120:123], v[40:43], a[52:55]
    ds_read_b128 a[252:255], v2 offset:15360
    v_fma_f32 v188, v208, s11, v215
    v_mfma_f32_16x16x32_bf16 a[52:55], v[124:127], v[44:47], a[52:55]
    ds_read_b128 v[116:119], v2 offset:29696
    v_fma_f32 v189, v209, s11, v215
    v_mfma_f32_16x16x32_bf16 a[56:59], v[120:123], v[48:51], a[56:59]
    v_exp_f32 v244, v244
    v_mfma_f32_16x16x32_bf16 a[56:59], v[124:127], v[52:55], a[56:59]
    v_exp_f32 v245, v245
    v_mfma_f32_16x16x32_bf16 a[60:63], v[120:123], v[56:59], a[60:63]
    v_exp_f32 v246, v246
    v_mfma_f32_16x16x32_bf16 a[60:63], v[124:127], v[60:63], a[60:63]
    v_exp_f32 v247, v247
    v_mfma_f32_16x16x32_bf16 v[248:251], a[224:227], v[132:135], v[184:187]
    v_fma_f32 v190, v210, s11, v215
    v_fma_f32 v191, v211, s11, v215
    v_mfma_f32_16x16x32_bf16 v[248:251], a[228:231], v[164:167], v[248:251]
    v_cvt_pk_bf16_f32 v90, v244, v245
    v_cvt_pk_bf16_f32 v91, v246, v247
    v_mfma_f32_16x16x32_bf16 v[248:251], a[232:235], v[196:199], v[248:251]
    ds_read_b128 v[120:123], v2 offset:30720
    ds_read_b128 v[124:127], v2 offset:31744
    v_mfma_f32_16x16x32_bf16 v[248:251], a[236:239], v[228:231], v[248:251]
    s_add_u32 m0, s76, s75
    v_bfe_u32 v8, v1, 2, 6
    v_accvgpr_read_b32 v4, a112
    v_mfma_f32_16x16x32_bf16 a[144:147], v[96:99], v[32:35], a[144:147]
    s_mov_b32 s76, s60
    buffer_load_dwordx4 v1, s[36:39], s77 offen sc1 lds
    v_mfma_f32_16x16x32_bf16 a[144:147], v[100:103], v[36:39], a[144:147]
    s_mov_b32 s60, s82
    v_exp_f32 v248, v248
    v_mfma_f32_16x16x32_bf16 a[148:151], v[96:99], v[40:43], a[148:151]
    s_add_u32 s82, s82, 32768
    v_exp_f32 v249, v249
    v_mfma_f32_16x16x32_bf16 a[148:151], v[100:103], v[44:47], a[148:151]
    v_exp_f32 v250, v250
    v_mfma_f32_16x16x32_bf16 v[252:255], a[224:227], v[136:139], v[152:155]
    v_exp_f32 v251, v251
    v_mfma_f32_16x16x32_bf16 v[252:255], a[228:231], v[168:171], v[252:255]
    v_cvt_pk_bf16_f32 v76, v248, v249
    v_cvt_pk_bf16_f32 v77, v250, v251
    v_mfma_f32_16x16x32_bf16 v[252:255], a[232:235], v[200:203], v[252:255]
    s_cmp_eq_u32 s82, 163840
    s_cselect_b32 s82, 0, s82
    v_add_u32 v2, s82, v1
    v_mfma_f32_16x16x32_bf16 v[252:255], a[236:239], v[232:235], v[252:255]
    buffer_load_dwordx4 v1, s[36:39], s77 offen offset:1024 sc1 lds
    v_mfma_f32_16x16x32_bf16 a[152:155], v[96:99], v[48:51], a[152:155]
    v_accvgpr_read_b32 v5, a116
    v_add_u32 v8, 192, v8
    v_mfma_f32_16x16x32_bf16 a[152:155], v[100:103], v[52:55], a[152:155]
    v_cvt_pk_bf16_f32 v4, 0, v4
    v_cvt_pk_bf16_f32 v5, 0, v5
    v_mfma_f32_16x16x32_bf16 a[156:159], v[96:99], v[56:59], a[156:159]
    v_exp_f32 v252, v252
    v_mfma_f32_16x16x32_bf16 a[156:159], v[100:103], v[60:63], a[156:159]
    v_exp_f32 v253, v253
    v_mfma_f32_16x16x32_bf16 a[160:163], v[104:107], v[32:35], a[160:163]
    s_waitcnt lgkmcnt(0)
    v_exp_f32 v254, v254
    v_mfma_f32_16x16x32_bf16 a[160:163], v[108:111], v[36:39], a[160:163]
    v_exp_f32 v255, v255
    v_mfma_f32_16x16x32_bf16 v[240:243], a[224:227], v[140:143], v[156:159]
    v_cvt_pk_bf16_f32 v84, v252, v253
    v_cvt_pk_bf16_f32 v85, v254, v255
    v_mfma_f32_16x16x32_bf16 v[240:243], a[228:231], v[172:175], v[240:243]
    buffer_load_dwordx4 v1, s[36:39], s77 offen offset:2048 sc1 lds
    v_mfma_f32_16x16x32_bf16 v[240:243], a[232:235], v[204:207], v[240:243]
    v_lshrrev_b32 v15, 8, v1
    ds_bpermute_b32 v4, v8, v4
    v_mfma_f32_16x16x32_bf16 v[240:243], a[236:239], v[236:239], v[240:243]
    ds_bpermute_b32 v5, v8, v5
    ds_read_b128 a[224:227], v2 offset:0
    v_mfma_f32_16x16x32_bf16 a[164:167], v[104:107], v[40:43], a[164:167]
    ds_read_b128 a[228:231], v2 offset:1024
    v_bfe_u32 v14, v1, 4, 4
    v_mfma_f32_16x16x32_bf16 a[164:167], v[108:111], v[44:47], a[164:167]
    ds_read_b128 a[232:235], v2 offset:2048
    v_lshlrev_b32 v15, 3, v15
    v_mfma_f32_16x16x32_bf16 a[168:171], v[104:107], v[48:51], a[168:171]
    ds_read_b128 a[236:239], v2 offset:3072
    v_sub_u32 v14, v14, v15
    v_mfma_f32_16x16x32_bf16 a[168:171], v[108:111], v[52:55], a[168:171]
    ds_read_b128 v[96:99], v2 offset:16384
    v_and_b32 v15, 16, v1
    v_mfma_f32_16x16x32_bf16 a[172:175], v[104:107], v[56:59], a[172:175]
    buffer_load_dwordx4 v1, s[36:39], s77 offen offset:3072 sc1 lds
    v_mfma_f32_16x16x32_bf16 a[172:175], v[108:111], v[60:63], a[172:175]
    ds_read_b128 v[100:103], v2 offset:17408
    v_mov_b32 v31, 0x3f80
    v_mfma_f32_16x16x32_bf16 v[244:247], a[240:243], v[132:135], v[188:191]
    v_exp_f32 v240, v240
    v_mfma_f32_16x16x32_bf16 v[244:247], a[244:247], v[164:167], v[244:247]
    v_exp_f32 v241, v241
    v_mfma_f32_16x16x32_bf16 v[244:247], a[248:251], v[196:199], v[244:247]
    v_exp_f32 v242, v242
    v_mfma_f32_16x16x32_bf16 v[244:247], a[252:255], v[228:231], v[244:247]
    v_exp_f32 v243, v243
    v_mfma_f32_16x16x32_bf16 a[176:179], v[112:115], v[32:35], a[176:179]
    v_cvt_pk_bf16_f32 v92, v240, v241
    v_cvt_pk_bf16_f32 v93, v242, v243
    v_mfma_f32_16x16x32_bf16 a[176:179], v[116:119], v[36:39], a[176:179]
    s_add_u32 s100, s77, 4096
    v_ashrrev_i32 v14, 1, v14
    v_lshlrev_b32 v15, v15, v31
    v_mfma_f32_16x16x32_bf16 a[180:183], v[112:115], v[40:43], a[180:183]
    s_add_u32 m0, m0, 4096
    v_exp_f32 v244, v244
    v_mfma_f32_16x16x32_bf16 a[180:183], v[116:119], v[44:47], a[180:183]
    buffer_load_dwordx4 v1, s[36:39], s100 offen sc1 lds
    v_mfma_f32_16x16x32_bf16 v[248:251], a[240:243], v[136:139], v[152:155]
    v_exp_f32 v245, v245
    v_mfma_f32_16x16x32_bf16 v[248:251], a[244:247], v[168:171], v[248:251]
    v_exp_f32 v246, v246
    v_mfma_f32_16x16x32_bf16 v[248:251], a[248:251], v[200:203], v[248:251]
    v_exp_f32 v247, v247
    v_mfma_f32_16x16x32_bf16 v[248:251], a[252:255], v[232:235], v[248:251]
    v_cvt_pk_bf16_f32 v78, v244, v245
    v_cvt_pk_bf16_f32 v79, v246, v247
    v_mfma_f32_16x16x32_bf16 a[184:187], v[112:115], v[48:51], a[184:187]
    s_waitcnt lgkmcnt(0)
    v_cmp_eq_i32 vcc, 0, v14
    v_mul_f32 v4, s98, v4
    v_mfma_f32_16x16x32_bf16 a[184:187], v[116:119], v[52:55], a[184:187]
    buffer_load_dwordx4 v1, s[36:39], s100 offen offset:1024 sc1 lds
    v_mfma_f32_16x16x32_bf16 a[188:191], v[112:115], v[56:59], a[188:191]
    v_exp_f32 v248, v248
    v_mfma_f32_16x16x32_bf16 a[188:191], v[116:119], v[60:63], a[188:191]
    v_exp_f32 v249, v249
    v_mfma_f32_16x16x32_bf16 a[192:195], v[120:123], v[32:35], a[192:195]
    v_exp_f32 v250, v250
    v_mfma_f32_16x16x32_bf16 a[192:195], v[124:127], v[36:39], a[192:195]
    v_exp_f32 v251, v251
    v_mfma_f32_16x16x32_bf16 v[252:255], a[240:243], v[140:143], v[156:159]
    v_cvt_pk_bf16_f32 v86, v248, v249
    v_cvt_pk_bf16_f32 v87, v250, v251
    v_mfma_f32_16x16x32_bf16 v[252:255], a[244:247], v[172:175], v[252:255]
    v_cndmask_b32 v216, 0, v15, vcc
    v_cmp_eq_i32 vcc, 1, v14
    v_mfma_f32_16x16x32_bf16 v[252:255], a[248:251], v[204:207], v[252:255]
    v_mul_f32 v5, s98, v5
    v_cndmask_b32 v217, 0, v15, vcc
    v_mfma_f32_16x16x32_bf16 v[252:255], a[252:255], v[236:239], v[252:255]
    buffer_load_dwordx4 v1, s[36:39], s100 offen offset:2048 sc1 lds
    v_mfma_f32_16x16x32_bf16 a[196:199], v[120:123], v[40:43], a[196:199]
    v_cmp_eq_i32 vcc, 2, v14
    v_and_b32 v31, 512, v1
    v_mfma_f32_16x16x32_bf16 a[196:199], v[124:127], v[44:47], a[196:199]
    v_cndmask_b32 v218, 0, v15, vcc
    v_cmp_eq_i32 vcc, 3, v14
    v_mfma_f32_16x16x32_bf16 a[200:203], v[120:123], v[48:51], a[200:203]
    v_exp_f32 v252, v252
    v_mfma_f32_16x16x32_bf16 a[200:203], v[124:127], v[52:55], a[200:203]
    v_exp_f32 v253, v253
    v_mfma_f32_16x16x32_bf16 a[204:207], v[120:123], v[56:59], a[204:207]
    v_cvt_pk_bf16_f32 v94, v252, v253
    v_cndmask_b32 v219, 0, v15, vcc
    v_mfma_f32_16x16x32_bf16 a[204:207], v[124:127], v[60:63], a[204:207]
    v_cmp_eq_i32 vcc, -8, v14
    v_mad_u32_u24 v31, v31, 17, v1
    v_mfma_f32_16x16x32_bf16 a[208:211], a[136:139], v[32:35], a[208:211]
    buffer_load_dwordx4 v1, s[36:39], s100 offen offset:3072 sc1 lds
    v_mfma_f32_16x16x32_bf16 a[208:211], a[136:139], v[36:39], a[208:211]
    v_cndmask_b32 v220, 0, v15, vcc
    v_cmp_eq_i32 vcc, -7, v14
    v_mfma_f32_16x16x32_bf16 a[212:215], a[136:139], v[40:43], a[212:215]
    v_exp_f32 v4, v4
    v_mfma_f32_16x16x32_bf16 a[212:215], a[136:139], v[44:47], a[212:215]
    v_exp_f32 v5, v5
    v_mfma_f32_16x16x32_bf16 a[216:219], a[136:139], v[48:51], a[216:219]
    v_cndmask_b32 v221, 0, v15, vcc
    v_cmp_eq_i32 vcc, -6, v14
    v_mfma_f32_16x16x32_bf16 a[216:219], a[136:139], v[52:55], a[216:219]
    v_add_f32 v4, 1.0, v4
    v_add_f32 v5, 1.0, v5
    v_mfma_f32_16x16x32_bf16 a[220:223], a[136:139], v[56:59], a[220:223]
    v_cndmask_b32 v222, 0, v15, vcc
    v_cmp_eq_i32 vcc, -5, v14
    v_mfma_f32_16x16x32_bf16 a[220:223], a[136:139], v[60:63], a[220:223]
    s_add_u32 s77, s77, 32768
    v_rcp_f32 v4, v4
    v_rcp_f32 v5, v5
    v_cndmask_b32 v223, 0, v15, vcc
    s_cmp_eq_u32 s6, 7
    s_cselect_b32 s16, s8, 0
    s_cselect_b32 s17, s9, 0
    s_cselect_b32 s18, s10, 0
    s_cselect_b32 s19, s11, 0
    s_cselect_b32 s20, s12, 0
    s_cselect_b32 s21, s13, 0
    s_cselect_b32 s22, s14, 0
    s_cselect_b32 s23, s15, 0
    s_cbranch_scc1 K1_J7
K1_J7_BACK:
    v_add_f32 v212, s20, v152
    v_fma_f32 v176, v208, s16, v212
    v_fma_f32 v177, v209, s16, v212
    v_fma_f32 v178, v210, s16, v212
    v_fma_f32 v179, v211, s16, v212
    s_nop 1
    s_waitcnt lgkmcnt(0)
    v_mfma_f32_16x16x32_bf16 v[240:243], a[224:227], v[136:139], v[176:179]
    s_add_u32 m0, s76, s75
    v_exp_f32 v254, v254
    v_mfma_f32_16x16x32_bf16 v[240:243], a[228:231], v[168:171], v[240:243]
    s_mov_b32 s76, s60
    buffer_load_dwordx4 v1, s[36:39], s77 offen sc1 lds
    v_mfma_f32_16x16x32_bf16 v[240:243], a[232:235], v[200:203], v[240:243]
    s_mov_b32 s60, s82
    v_exp_f32 v255, v255
    v_mfma_f32_16x16x32_bf16 v[240:243], a[236:239], v[232:235], v[240:243]
    s_add_u32 s82, s82, 32768
    ds_read_b128 v[104:107], v2 offset:18432
    v_cvt_pk_bf16_f32 v95, v254, v255
    v_mfma_f32_16x16x32_bf16 a[4:7], v[96:99], v[72:75], a[4:7]
    ds_read_b128 v[108:111], v2 offset:19456
    ds_read_b128 a[240:243], v2 offset:4096
    v_mfma_f32_16x16x32_bf16 a[4:7], v[100:103], v[76:79], a[4:7]
    ds_read_b128 a[244:247], v2 offset:5120
    v_add_f32 v213, s21, v152
    v_mfma_f32_16x16x32_bf16 a[8:11], v[96:99], v[80:83], a[8:11]
    ds_read_b128 a[248:251], v2 offset:6144
    v_fma_f32 v180, v208, s17, v213
    v_mfma_f32_16x16x32_bf16 a[8:11], v[100:103], v[84:87], a[8:11]
    ds_read_b128 a[252:255], v2 offset:7168
    v_fma_f32 v181, v209, s17, v213
    v_mfma_f32_16x16x32_bf16 a[12:15], v[96:99], v[88:91], a[12:15]
    ds_read_b128 v[112:115], v2 offset:20480
    v_fma_f32 v182, v210, s17, v213
    v_mfma_f32_16x16x32_bf16 a[12:15], v[100:103], v[92:95], a[12:15]
    ds_read_b128 v[116:119], v2 offset:21504
    v_fma_f32 v183, v211, s17, v213
    v_mfma_f32_16x16x32_bf16 v[244:247], a[224:227], v[140:143], v[156:159]
    buffer_load_dwordx4 v1, s[36:39], s77 offen offset:1024 sc1 lds
    v_mfma_f32_16x16x32_bf16 v[244:247], a[228:231], v[172:175], v[244:247]
    ds_read_b128 v[120:123], v2 offset:22528
    ds_read_b128 v[124:127], v2 offset:23552
    v_mfma_f32_16x16x32_bf16 v[244:247], a[232:235], v[204:207], v[244:247]
    ds_read_b128 a[224:227], v2 offset:8192
    v_add_f32 v214, s22, v152
    v_mfma_f32_16x16x32_bf16 v[244:247], a[236:239], v[236:239], v[244:247]
    s_waitcnt lgkmcnt(4)
    ds_read_b128 a[228:231], v2 offset:9216
    v_fma_f32 v184, v208, s18, v214
    v_mfma_f32_16x16x32_bf16 a[20:23], v[104:107], v[72:75], a[20:23]
    ds_read_b128 a[232:235], v2 offset:10240
    v_fma_f32 v185, v209, s18, v214
    v_mfma_f32_16x16x32_bf16 a[20:23], v[108:111], v[76:79], a[20:23]
    ds_read_b128 a[236:239], v2 offset:11264
    v_fma_f32 v186, v210, s18, v214
    v_mfma_f32_16x16x32_bf16 a[24:27], v[104:107], v[80:83], a[24:27]
    ds_read_b128 v[96:99], v2 offset:24576
    v_fma_f32 v187, v211, s18, v214
    v_mfma_f32_16x16x32_bf16 a[24:27], v[108:111], v[84:87], a[24:27]
    ds_read_b128 v[100:103], v2 offset:25600
    v_add_f32 v215, s23, v152
    v_mfma_f32_16x16x32_bf16 a[28:31], v[104:107], v[88:91], a[28:31]
    v_exp_f32 v240, v240
    v_mfma_f32_16x16x32_bf16 a[28:31], v[108:111], v[92:95], a[28:31]
    v_exp_f32 v241, v241
    v_mfma_f32_16x16x32_bf16 v[248:251], a[240:243], v[136:139], v[180:183]
    buffer_load_dwordx4 v1, s[36:39], s77 offen offset:2048 sc1 lds
    v_mfma_f32_16x16x32_bf16 v[248:251], a[244:247], v[168:171], v[248:251]
    v_exp_f32 v242, v242
    v_mfma_f32_16x16x32_bf16 v[248:251], a[248:251], v[200:203], v[248:251]
    v_exp_f32 v243, v243
    v_mfma_f32_16x16x32_bf16 v[248:251], a[252:255], v[232:235], v[248:251]
    v_cvt_pk_bf16_f32 v48, v240, v241
    v_cvt_pk_bf16_f32 v49, v242, v243
    v_mfma_f32_16x16x32_bf16 a[36:39], v[112:115], v[72:75], a[36:39]
    s_waitcnt lgkmcnt(0)
    ds_read_b128 v[104:107], v2 offset:26624
    ds_read_b128 v[108:111], v2 offset:27648
    v_mfma_f32_16x16x32_bf16 a[36:39], v[116:119], v[76:79], a[36:39]
    v_exp_f32 v244, v244
    v_mfma_f32_16x16x32_bf16 a[40:43], v[112:115], v[80:83], a[40:43]
    v_exp_f32 v245, v245
    v_mfma_f32_16x16x32_bf16 a[40:43], v[116:119], v[84:87], a[40:43]
    v_exp_f32 v246, v246
    v_mfma_f32_16x16x32_bf16 a[44:47], v[112:115], v[88:91], a[44:47]
    v_exp_f32 v247, v247
    v_mfma_f32_16x16x32_bf16 a[44:47], v[116:119], v[92:95], a[44:47]
    s_waitcnt vmcnt(11)
    buffer_load_dwordx4 v1, s[36:39], s77 offen offset:3072 sc1 lds
    v_mfma_f32_16x16x32_bf16 v[12:15], v[64:67], v[216:219], 0
    v_cvt_pk_bf16_f32 v56, v244, v245
    v_cvt_pk_bf16_f32 v57, v246, v247
    v_mfma_f32_16x16x32_bf16 v[16:19], v[68:71], v[216:219], 0
    ds_read_b128 v[112:115], v2 offset:28672
    ds_read_b128 v[116:119], v2 offset:29696
    v_mfma_f32_16x16x32_bf16 v[252:255], a[240:243], v[140:143], v[156:159]
    ds_read_b128 a[240:243], v2 offset:12288
    v_fma_f32 v188, v208, s19, v215
    v_mfma_f32_16x16x32_bf16 v[252:255], a[244:247], v[172:175], v[252:255]
    v_cvt_pk_bf16_f32 v12, v12, v13
    v_cvt_pk_bf16_f32 v13, v14, v15
    v_mfma_f32_16x16x32_bf16 v[252:255], a[248:251], v[204:207], v[252:255]
    v_cvt_pk_bf16_f32 v14, v16, v17
    v_cvt_pk_bf16_f32 v15, v18, v19
    v_mfma_f32_16x16x32_bf16 v[252:255], a[252:255], v[236:239], v[252:255]
    buffer_store_dwordx4 v[12:15], v31, s[56:59], s63 offen offset:0 sc1
    v_mfma_f32_16x16x32_bf16 a[52:55], v[120:123], v[72:75], a[52:55]
    ds_read_b128 a[244:247], v2 offset:13312
    ds_read_b128 a[248:251], v2 offset:14336
    v_mfma_f32_16x16x32_bf16 a[52:55], v[124:127], v[76:79], a[52:55]
    ds_read_b128 a[252:255], v2 offset:15360
    v_fma_f32 v189, v209, s19, v215
    v_mfma_f32_16x16x32_bf16 a[56:59], v[120:123], v[80:83], a[56:59]
    s_add_u32 s100, s77, 4096
    v_exp_f32 v248, v248
    v_mfma_f32_16x16x32_bf16 a[56:59], v[124:127], v[84:87], a[56:59]
    s_add_u32 m0, m0, 4096
    v_exp_f32 v249, v249
    v_mfma_f32_16x16x32_bf16 a[60:63], v[120:123], v[88:91], a[60:63]
    buffer_load_dwordx4 v1, s[36:39], s100 offen sc1 lds
    v_mfma_f32_16x16x32_bf16 a[60:63], v[124:127], v[92:95], a[60:63]
    v_exp_f32 v250, v250
    v_mfma_f32_16x16x32_bf16 v[12:15], v[64:67], v[220:223], 0
    v_exp_f32 v251, v251
    v_mfma_f32_16x16x32_bf16 v[16:19], v[68:71], v[220:223], 0
    v_fma_f32 v190, v210, s19, v215
    v_fma_f32 v191, v211, s19, v215
    v_mfma_f32_16x16x32_bf16 v[240:243], a[224:227], v[136:139], v[184:187]
    v_cvt_pk_bf16_f32 v50, v248, v249
    v_cvt_pk_bf16_f32 v51, v250, v251
    v_mfma_f32_16x16x32_bf16 v[240:243], a[228:231], v[168:171], v[240:243]
    v_cvt_pk_bf16_f32 v12, v12, v13
    v_cvt_pk_bf16_f32 v13, v14, v15
    v_mfma_f32_16x16x32_bf16 v[240:243], a[232:235], v[200:203], v[240:243]
    v_cvt_pk_bf16_f32 v14, v16, v17
    v_cvt_pk_bf16_f32 v15, v18, v19
    v_mfma_f32_16x16x32_bf16 v[240:243], a[236:239], v[232:235], v[240:243]
    buffer_store_dwordx4 v[12:15], v31, s[56:59], s63 offen offset:1024 sc1
    v_mfma_f32_16x16x32_bf16 a[148:151], v[96:99], v[72:75], a[148:151]
    buffer_load_dwordx4 v1, s[36:39], s100 offen offset:1024 sc1 lds
    v_mfma_f32_16x16x32_bf16 a[148:151], v[100:103], v[76:79], a[148:151]
    ds_read_b128 v[120:123], v2 offset:30720
    ds_read_b128 v[124:127], v2 offset:31744
    v_mfma_f32_16x16x32_bf16 a[152:155], v[96:99], v[80:83], a[152:155]
    v_exp_f32 v252, v252
    v_mfma_f32_16x16x32_bf16 a[152:155], v[100:103], v[84:87], a[152:155]
    v_exp_f32 v253, v253
    v_mfma_f32_16x16x32_bf16 a[156:159], v[96:99], v[88:91], a[156:159]
    v_exp_f32 v254, v254
    v_mfma_f32_16x16x32_bf16 a[156:159], v[100:103], v[92:95], a[156:159]
    v_exp_f32 v255, v255
    v_mfma_f32_16x16x32_bf16 v[12:15], v[20:23], v[216:219], 0
    v_cvt_pk_bf16_f32 v58, v252, v253
    v_cvt_pk_bf16_f32 v59, v254, v255
    v_mfma_f32_16x16x32_bf16 v[16:19], v[24:27], v[216:219], 0
    v_exp_f32 v240, v240
    v_mfma_f32_16x16x32_bf16 v[244:247], a[224:227], v[140:143], v[156:159]
    v_exp_f32 v241, v241
    v_mfma_f32_16x16x32_bf16 v[244:247], a[228:231], v[172:175], v[244:247]
    v_exp_f32 v242, v242
    v_mfma_f32_16x16x32_bf16 v[244:247], a[232:235], v[204:207], v[244:247]
    buffer_load_dwordx4 v1, s[36:39], s100 offen offset:2048 sc1 lds
    v_mfma_f32_16x16x32_bf16 v[244:247], a[236:239], v[236:239], v[244:247]
    s_waitcnt lgkmcnt(0)
    v_cvt_pk_bf16_f32 v12, v12, v13
    v_cvt_pk_bf16_f32 v13, v14, v15
    v_mfma_f32_16x16x32_bf16 a[164:167], v[104:107], v[72:75], a[164:167]
    v_cvt_pk_bf16_f32 v14, v16, v17
    v_cvt_pk_bf16_f32 v15, v18, v19
    v_mfma_f32_16x16x32_bf16 a[164:167], v[108:111], v[76:79], a[164:167]
    buffer_store_dwordx4 v[12:15], v31, s[56:59], s63 offen offset:512 sc1
    v_mfma_f32_16x16x32_bf16 a[168:171], v[104:107], v[80:83], a[168:171]
    s_cmp_eq_u32 s82, 163840
    s_cselect_b32 s82, 0, s82
    v_add_u32 v2, s82, v1
    v_mfma_f32_16x16x32_bf16 a[168:171], v[108:111], v[84:87], a[168:171]
    v_exp_f32 v243, v243
    v_mfma_f32_16x16x32_bf16 a[172:175], v[104:107], v[88:91], a[172:175]
    v_exp_f32 v244, v244
    v_mfma_f32_16x16x32_bf16 a[172:175], v[108:111], v[92:95], a[172:175]
    v_exp_f32 v245, v245
    v_mfma_f32_16x16x32_bf16 v[12:15], v[20:23], v[220:223], 0
    v_exp_f32 v246, v246
    v_mfma_f32_16x16x32_bf16 v[16:19], v[24:27], v[220:223], 0
    buffer_load_dwordx4 v1, s[36:39], s100 offen offset:3072 sc1 lds
    v_mfma_f32_16x16x32_bf16 v[248:251], a[240:243], v[136:139], v[188:191]
    v_exp_f32 v247, v247
    v_mfma_f32_16x16x32_bf16 v[248:251], a[244:247], v[168:171], v[248:251]
    v_cvt_pk_bf16_f32 v52, v240, v241
    v_cvt_pk_bf16_f32 v53, v242, v243
    v_mfma_f32_16x16x32_bf16 v[248:251], a[248:251], v[200:203], v[248:251]
    v_cvt_pk_bf16_f32 v12, v12, v13
    v_cvt_pk_bf16_f32 v13, v14, v15
    v_mfma_f32_16x16x32_bf16 v[248:251], a[252:255], v[232:235], v[248:251]
    v_cvt_pk_bf16_f32 v14, v16, v17
    v_cvt_pk_bf16_f32 v15, v18, v19
    v_mfma_f32_16x16x32_bf16 a[180:183], v[112:115], v[72:75], a[180:183]
    buffer_store_dwordx4 v[12:15], v31, s[56:59], s63 offen offset:1536 sc1
    v_mfma_f32_16x16x32_bf16 a[180:183], v[116:119], v[76:79], a[180:183]
    v_cvt_pk_bf16_f32 v60, v244, v245
    v_cvt_pk_bf16_f32 v61, v246, v247
    v_mfma_f32_16x16x32_bf16 a[184:187], v[112:115], v[80:83], a[184:187]
    v_exp_f32 v248, v248
    v_mfma_f32_16x16x32_bf16 a[184:187], v[116:119], v[84:87], a[184:187]
    v_exp_f32 v249, v249
    v_mfma_f32_16x16x32_bf16 a[188:191], v[112:115], v[88:91], a[188:191]
    s_add_u32 s77, s77, 32768
    v_exp_f32 v250, v250
    v_mfma_f32_16x16x32_bf16 a[188:191], v[116:119], v[92:95], a[188:191]
    v_exp_f32 v251, v251
    v_mfma_f32_16x16x32_bf16 v[12:15], v[144:147], v[216:219], 0
    v_cvt_pk_bf16_f32 v54, v248, v249
    v_cvt_pk_bf16_f32 v55, v250, v251
    v_mfma_f32_16x16x32_bf16 v[16:19], a[140:143], v[216:219], 0
    v_accvgpr_read_b32 v6, a120
    v_accvgpr_read_b32 v7, a124
    v_mfma_f32_16x16x32_bf16 v[252:255], a[240:243], v[140:143], v[156:159]
    v_cvt_pk_bf16_f32 v6, 0, v6
    v_cvt_pk_bf16_f32 v7, 0, v7
    v_mfma_f32_16x16x32_bf16 v[252:255], a[244:247], v[172:175], v[252:255]
    v_cvt_pk_bf16_f32 v12, v12, v13
    v_cvt_pk_bf16_f32 v13, v14, v15
    v_mfma_f32_16x16x32_bf16 v[252:255], a[248:251], v[204:207], v[252:255]
    v_cvt_pk_bf16_f32 v14, v16, v17
    v_cvt_pk_bf16_f32 v15, v18, v19
    v_mfma_f32_16x16x32_bf16 v[252:255], a[252:255], v[236:239], v[252:255]
    buffer_store_dwordx4 v[12:15], v1, s[56:59], s64 offen offset:0 sc1
    v_mfma_f32_16x16x32_bf16 a[196:199], v[120:123], v[72:75], a[196:199]
    ds_bpermute_b32 v6, v8, v6
    ds_bpermute_b32 v7, v8, v7
    v_mfma_f32_16x16x32_bf16 a[196:199], v[124:127], v[76:79], a[196:199]
    s_waitcnt vmcnt(8) lgkmcnt(0)
    s_barrier
    ds_read_b128 a[224:227], v2 offset:0
    v_mfma_f32_16x16x32_bf16 a[200:203], v[120:123], v[80:83], a[200:203]
    ds_read_b128 a[228:231], v2 offset:1024
    ds_read_b128 a[232:235], v2 offset:2048
    v_mfma_f32_16x16x32_bf16 a[200:203], v[124:127], v[84:87], a[200:203]
    ds_read_b128 a[236:239], v2 offset:3072
    v_mul_f32 v6, s98, v6
    v_mfma_f32_16x16x32_bf16 a[204:207], v[120:123], v[88:91], a[204:207]
    ds_read_b128 v[96:99], v2 offset:16384
    v_mul_f32 v7, s98, v7
    v_mfma_f32_16x16x32_bf16 a[204:207], v[124:127], v[92:95], a[204:207]
    v_exp_f32 v252, v252
    v_mfma_f32_16x16x32_bf16 v[12:15], v[144:147], v[220:223], 0
    v_exp_f32 v253, v253
    v_mfma_f32_16x16x32_bf16 v[16:19], a[140:143], v[220:223], 0
    ds_read_b128 v[100:103], v2 offset:17408
    v_cvt_pk_bf16_f32 v62, v252, v253
    v_mfma_f32_16x16x32_bf16 a[212:215], a[136:139], v[72:75], a[212:215]
    v_exp_f32 v6, v6
    v_mfma_f32_16x16x32_bf16 a[212:215], a[136:139], v[76:79], a[212:215]
    v_exp_f32 v7, v7
    v_mfma_f32_16x16x32_bf16 a[216:219], a[136:139], v[80:83], a[216:219]
    v_cvt_pk_bf16_f32 v12, v12, v13
    v_cvt_pk_bf16_f32 v13, v14, v15
    v_mfma_f32_16x16x32_bf16 a[216:219], a[136:139], v[84:87], a[216:219]
    v_cvt_pk_bf16_f32 v14, v16, v17
    v_cvt_pk_bf16_f32 v15, v18, v19
    v_mfma_f32_16x16x32_bf16 a[220:223], a[136:139], v[88:91], a[220:223]
    buffer_store_dwordx4 v[12:15], v1, s[56:59], s62 offen offset:0 sc1
    v_mfma_f32_16x16x32_bf16 a[220:223], a[136:139], v[92:95], a[220:223]
    v_add_f32 v6, 1.0, v6
    v_add_f32 v7, 1.0, v7
    v_rcp_f32 v6, v6
    v_rcp_f32 v7, v7
    s_nop 1
    v_accvgpr_read_b32 v9, a208
    v_cmp_nge_f32 vcc, 0x71800000, v9
    v_rcp_f32 v10, v9
    s_nop 0
    s_or_b64 s[84:85], s[84:85], vcc
    v_mul_f32 v10, v10, v4
    v_accvgpr_read_b32 v12, a0
    v_accvgpr_read_b32 v13, a1
    v_accvgpr_read_b32 v14, a2
    v_accvgpr_read_b32 v15, a3
    v_accvgpr_read_b32 v16, a16
    v_accvgpr_read_b32 v17, a17
    v_accvgpr_read_b32 v18, a18
    v_accvgpr_read_b32 v19, a19
    v_pk_mul_f32 v[12:13], v[12:13], v[10:11] op_sel_hi:[1,0]
    v_pk_mul_f32 v[14:15], v[14:15], v[10:11] op_sel_hi:[1,0]
    v_pk_mul_f32 v[16:17], v[16:17], v[10:11] op_sel_hi:[1,0]
    v_pk_mul_f32 v[18:19], v[18:19], v[10:11] op_sel_hi:[1,0]
    v_cvt_pk_bf16_f32 v12, v12, v13
    v_cvt_pk_bf16_f32 v13, v14, v15
    v_cvt_pk_bf16_f32 v14, v16, v17
    v_cvt_pk_bf16_f32 v15, v18, v19
    buffer_store_dwordx4 v[12:15], v1, s[40:43], s80 offen offset:0 sc1
    v_accvgpr_read_b32 v20, a32
    v_accvgpr_read_b32 v21, a33
    v_accvgpr_read_b32 v22, a34
    v_accvgpr_read_b32 v23, a35
    v_accvgpr_read_b32 v24, a48
    v_accvgpr_read_b32 v25, a49
    v_accvgpr_read_b32 v26, a50
    v_accvgpr_read_b32 v27, a51
    v_pk_mul_f32 v[20:21], v[20:21], v[10:11] op_sel_hi:[1,0]
    v_pk_mul_f32 v[22:23], v[22:23], v[10:11] op_sel_hi:[1,0]
    v_pk_mul_f32 v[24:25], v[24:25], v[10:11] op_sel_hi:[1,0]
    v_pk_mul_f32 v[26:27], v[26:27], v[10:11] op_sel_hi:[1,0]
    v_cvt_pk_bf16_f32 v20, v20, v21
    v_cvt_pk_bf16_f32 v21, v22, v23
    v_cvt_pk_bf16_f32 v22, v24, v25
    v_cvt_pk_bf16_f32 v23, v26, v27
    buffer_store_dwordx4 v[20:23], v1, s[40:43], s80 offen offset:1024 sc1
    v_accvgpr_read_b32 v12, a144
    v_accvgpr_read_b32 v13, a145
    v_accvgpr_read_b32 v14, a146
    v_accvgpr_read_b32 v15, a147
    v_accvgpr_read_b32 v16, a160
    v_accvgpr_read_b32 v17, a161
    v_accvgpr_read_b32 v18, a162
    v_accvgpr_read_b32 v19, a163
    v_pk_mul_f32 v[12:13], v[12:13], v[10:11] op_sel_hi:[1,0]
    v_pk_mul_f32 v[14:15], v[14:15], v[10:11] op_sel_hi:[1,0]
    v_pk_mul_f32 v[16:17], v[16:17], v[10:11] op_sel_hi:[1,0]
    v_pk_mul_f32 v[18:19], v[18:19], v[10:11] op_sel_hi:[1,0]
    v_cvt_pk_bf16_f32 v12, v12, v13
    v_cvt_pk_bf16_f32 v13, v14, v15
    v_cvt_pk_bf16_f32 v14, v16, v17
    v_cvt_pk_bf16_f32 v15, v18, v19
    buffer_store_dwordx4 v[12:15], v1, s[40:43], s80 offen offset:2048 sc1
    v_accvgpr_read_b32 v20, a176
    v_accvgpr_read_b32 v21, a177
    v_accvgpr_read_b32 v22, a178
    v_accvgpr_read_b32 v23, a179
    v_accvgpr_read_b32 v24, a192
    v_accvgpr_read_b32 v25, a193
    v_accvgpr_read_b32 v26, a194
    v_accvgpr_read_b32 v27, a195
    v_pk_mul_f32 v[20:21], v[20:21], v[10:11] op_sel_hi:[1,0]
    v_pk_mul_f32 v[22:23], v[22:23], v[10:11] op_sel_hi:[1,0]
    v_pk_mul_f32 v[24:25], v[24:25], v[10:11] op_sel_hi:[1,0]
    v_pk_mul_f32 v[26:27], v[26:27], v[10:11] op_sel_hi:[1,0]
    v_cvt_pk_bf16_f32 v20, v20, v21
    v_cvt_pk_bf16_f32 v21, v22, v23
    v_cvt_pk_bf16_f32 v22, v24, v25
    v_cvt_pk_bf16_f32 v23, v26, v27
    buffer_store_dwordx4 v[20:23], v1, s[40:43], s80 offen offset:3072 sc1
    v_accvgpr_read_b32 v9, a212
    v_cmp_nge_f32 vcc, 0x71800000, v9
    v_rcp_f32 v10, v9
    s_nop 0
    s_or_b64 s[84:85], s[84:85], vcc
    v_mul_f32 v10, v10, v5
    s_add_u32 s72, s80, 622592
    v_accvgpr_read_b32 v12, a4
    v_accvgpr_read_b32 v13, a5
    v_accvgpr_read_b32 v14, a6
    v_accvgpr_read_b32 v15, a7
    v_accvgpr_read_b32 v16, a20
    v_accvgpr_read_b32 v17, a21
    v_accvgpr_read_b32 v18, a22
    v_accvgpr_read_b32 v19, a23
    v_pk_mul_f32 v[12:13], v[12:13], v[10:11] op_sel_hi:[1,0]
    v_pk_mul_f32 v[14:15], v[14:15], v[10:11] op_sel_hi:[1,0]
    v_pk_mul_f32 v[16:17], v[16:17], v[10:11] op_sel_hi:[1,0]
    v_pk_mul_f32 v[18:19], v[18:19], v[10:11] op_sel_hi:[1,0]
    v_cvt_pk_bf16_f32 v12, v12, v13
    v_cvt_pk_bf16_f32 v13, v14, v15
    v_cvt_pk_bf16_f32 v14, v16, v17
    v_cvt_pk_bf16_f32 v15, v18, v19
    buffer_store_dwordx4 v[12:15], v1, s[40:43], s72 offen offset:0 sc1
    v_accvgpr_read_b32 v20, a36
    v_accvgpr_read_b32 v21, a37
    v_accvgpr_read_b32 v22, a38
    v_accvgpr_read_b32 v23, a39
    v_accvgpr_read_b32 v24, a52
    v_accvgpr_read_b32 v25, a53
    v_accvgpr_read_b32 v26, a54
    v_accvgpr_read_b32 v27, a55
    v_pk_mul_f32 v[20:21], v[20:21], v[10:11] op_sel_hi:[1,0]
    v_pk_mul_f32 v[22:23], v[22:23], v[10:11] op_sel_hi:[1,0]
    v_pk_mul_f32 v[24:25], v[24:25], v[10:11] op_sel_hi:[1,0]
    v_pk_mul_f32 v[26:27], v[26:27], v[10:11] op_sel_hi:[1,0]
    v_cvt_pk_bf16_f32 v20, v20, v21
    v_cvt_pk_bf16_f32 v21, v22, v23
    v_cvt_pk_bf16_f32 v22, v24, v25
    v_cvt_pk_bf16_f32 v23, v26, v27
    buffer_store_dwordx4 v[20:23], v1, s[40:43], s72 offen offset:1024 sc1
    v_accvgpr_read_b32 v12, a148
    v_accvgpr_read_b32 v13, a149
    v_accvgpr_read_b32 v14, a150
    v_accvgpr_read_b32 v15, a151
    v_accvgpr_read_b32 v16, a164
    v_accvgpr_read_b32 v17, a165
    v_accvgpr_read_b32 v18, a166
    v_accvgpr_read_b32 v19, a167
    v_pk_mul_f32 v[12:13], v[12:13], v[10:11] op_sel_hi:[1,0]
    v_pk_mul_f32 v[14:15], v[14:15], v[10:11] op_sel_hi:[1,0]
    v_pk_mul_f32 v[16:17], v[16:17], v[10:11] op_sel_hi:[1,0]
    v_pk_mul_f32 v[18:19], v[18:19], v[10:11] op_sel_hi:[1,0]
    v_cvt_pk_bf16_f32 v12, v12, v13
    v_cvt_pk_bf16_f32 v13, v14, v15
    v_cvt_pk_bf16_f32 v14, v16, v17
    v_cvt_pk_bf16_f32 v15, v18, v19
    buffer_store_dwordx4 v[12:15], v1, s[40:43], s72 offen offset:2048 sc1
    v_accvgpr_read_b32 v20, a180
    v_accvgpr_read_b32 v21, a181
    v_accvgpr_read_b32 v22, a182
    v_accvgpr_read_b32 v23, a183
    v_accvgpr_read_b32 v24, a196
    v_accvgpr_read_b32 v25, a197
    v_accvgpr_read_b32 v26, a198
    v_accvgpr_read_b32 v27, a199
    v_pk_mul_f32 v[20:21], v[20:21], v[10:11] op_sel_hi:[1,0]
    v_pk_mul_f32 v[22:23], v[22:23], v[10:11] op_sel_hi:[1,0]
    v_pk_mul_f32 v[24:25], v[24:25], v[10:11] op_sel_hi:[1,0]
    v_pk_mul_f32 v[26:27], v[26:27], v[10:11] op_sel_hi:[1,0]
    v_cvt_pk_bf16_f32 v20, v20, v21
    v_cvt_pk_bf16_f32 v21, v22, v23
    v_cvt_pk_bf16_f32 v22, v24, v25
    v_cvt_pk_bf16_f32 v23, v26, v27
    buffer_store_dwordx4 v[20:23], v1, s[40:43], s72 offen offset:3072 sc1
    v_mov_b32 v9, 1
    v_lshlrev_b32 v216, 20, v1
    s_lshl2_add_u32 s7, s4, s101
    s_add_u32 s7, s7, 163840
    s_waitcnt vmcnt(8)
    buffer_store_dword v9, v216, s[32:35], s7 offen sc1
    s_sub_u32 s78, 14, s6
    s_sub_u32 s78, s78, s6
    s_cmp_eq_u32 s78, 0
    s_cbranch_scc1 K1_LS_END
.p2align 3
K1_LS:
    s_waitcnt lgkmcnt(0)
    v_mfma_f32_16x16x32_bf16 v[240:243], a[224:227], v[136:139], v[176:179]
    s_add_u32 m0, s76, s75
    v_exp_f32 v254, v254
    v_mfma_f32_16x16x32_bf16 v[240:243], a[228:231], v[168:171], v[240:243]
    s_mov_b32 s76, s60
    v_exp_f32 v255, v255
    v_mfma_f32_16x16x32_bf16 v[240:243], a[232:235], v[200:203], v[240:243]
    s_mov_b32 s60, s82
    buffer_load_dwordx4 v1, s[36:39], s77 offen sc1 lds
    v_mfma_f32_16x16x32_bf16 v[240:243], a[236:239], v[232:235], v[240:243]
    s_add_u32 s82, s82, 32768
    ds_read_b128 v[104:107], v2 offset:18432
    v_cvt_pk_bf16_f32 v63, v254, v255
    v_mfma_f32_16x16x32_bf16 a[8:11], v[96:99], v[48:51], a[8:11]
    ds_read_b128 v[108:111], v2 offset:19456
    ds_read_b128 a[240:243], v2 offset:4096
    v_mfma_f32_16x16x32_bf16 a[8:11], v[100:103], v[52:55], a[8:11]
    ds_read_b128 a[244:247], v2 offset:5120
    v_mfma_f32_16x16x32_bf16 a[12:15], v[96:99], v[56:59], a[12:15]
    buffer_load_dwordx4 v1, s[36:39], s77 offen offset:1024 sc1 lds
    v_mfma_f32_16x16x32_bf16 a[12:15], v[100:103], v[60:63], a[12:15]
    ds_read_b128 a[248:251], v2 offset:6144
    ds_read_b128 a[252:255], v2 offset:7168
    v_mfma_f32_16x16x32_bf16 v[244:247], a[224:227], v[140:143], v[156:159]
    v_exp_f32 v240, v240
    v_mfma_f32_16x16x32_bf16 v[244:247], a[228:231], v[172:175], v[244:247]
    ds_read_b128 v[112:115], v2 offset:20480
    ds_read_b128 v[116:119], v2 offset:21504
    v_mfma_f32_16x16x32_bf16 v[244:247], a[232:235], v[204:207], v[244:247]
    v_exp_f32 v241, v241
    v_mfma_f32_16x16x32_bf16 v[244:247], a[236:239], v[236:239], v[244:247]
    s_waitcnt lgkmcnt(4)
    ds_read_b128 v[120:123], v2 offset:22528
    ds_read_b128 v[124:127], v2 offset:23552
    v_mfma_f32_16x16x32_bf16 a[24:27], v[104:107], v[48:51], a[24:27]
    buffer_load_dwordx4 v1, s[36:39], s77 offen offset:2048 sc1 lds
    v_mfma_f32_16x16x32_bf16 a[24:27], v[108:111], v[52:55], a[24:27]
    ds_read_b128 a[224:227], v2 offset:8192
    ds_read_b128 a[228:231], v2 offset:9216
    v_mfma_f32_16x16x32_bf16 a[28:31], v[104:107], v[56:59], a[28:31]
    ds_read_b128 a[232:235], v2 offset:10240
    v_cvt_pk_bf16_f32 v80, v240, v241
    v_mfma_f32_16x16x32_bf16 a[28:31], v[108:111], v[60:63], a[28:31]
    v_exp_f32 v242, v242
    v_mfma_f32_16x16x32_bf16 v[248:251], a[240:243], v[136:139], v[180:183]
    ds_read_b128 a[236:239], v2 offset:11264
    ds_read_b128 v[96:99], v2 offset:24576
    v_mfma_f32_16x16x32_bf16 v[248:251], a[244:247], v[168:171], v[248:251]
    s_waitcnt lgkmcnt(5)
    v_exp_f32 v243, v243
    v_mfma_f32_16x16x32_bf16 v[248:251], a[248:251], v[200:203], v[248:251]
    buffer_load_dwordx4 v1, s[36:39], s77 offen offset:3072 sc1 lds
    v_mfma_f32_16x16x32_bf16 v[248:251], a[252:255], v[232:235], v[248:251]
    ds_read_b128 v[100:103], v2 offset:25600
    v_cvt_pk_bf16_f32 v81, v242, v243
    v_mfma_f32_16x16x32_bf16 a[40:43], v[112:115], v[48:51], a[40:43]
    ds_read_b128 v[104:107], v2 offset:26624
    ds_read_b128 v[108:111], v2 offset:27648
    v_mfma_f32_16x16x32_bf16 a[40:43], v[116:119], v[52:55], a[40:43]
    v_exp_f32 v244, v244
    v_mfma_f32_16x16x32_bf16 a[44:47], v[112:115], v[56:59], a[44:47]
    v_exp_f32 v245, v245
    v_mfma_f32_16x16x32_bf16 a[44:47], v[116:119], v[60:63], a[44:47]
    s_add_u32 s100, s77, 4096
    v_exp_f32 v246, v246
    v_mfma_f32_16x16x32_bf16 v[252:255], a[240:243], v[140:143], v[156:159]
    s_add_u32 m0, m0, 4096
    v_exp_f32 v247, v247
    v_mfma_f32_16x16x32_bf16 v[252:255], a[244:247], v[172:175], v[252:255]
    buffer_load_dwordx4 v1, s[36:39], s100 offen sc1 lds
    v_mfma_f32_16x16x32_bf16 v[252:255], a[248:251], v[204:207], v[252:255]
    v_cvt_pk_bf16_f32 v88, v244, v245
    v_cvt_pk_bf16_f32 v89, v246, v247
    v_mfma_f32_16x16x32_bf16 v[252:255], a[252:255], v[236:239], v[252:255]
    ds_read_b128 a[240:243], v2 offset:12288
    ds_read_b128 a[244:247], v2 offset:13312
    v_mfma_f32_16x16x32_bf16 a[56:59], v[120:123], v[48:51], a[56:59]
    v_exp_f32 v248, v248
    v_mfma_f32_16x16x32_bf16 a[56:59], v[124:127], v[52:55], a[56:59]
    buffer_load_dwordx4 v1, s[36:39], s100 offen offset:1024 sc1 lds
    v_mfma_f32_16x16x32_bf16 a[60:63], v[120:123], v[56:59], a[60:63]
    ds_read_b128 a[248:251], v2 offset:14336
    ds_read_b128 a[252:255], v2 offset:15360
    v_mfma_f32_16x16x32_bf16 a[60:63], v[124:127], v[60:63], a[60:63]
    s_waitcnt lgkmcnt(4)
    v_exp_f32 v249, v249
    v_mfma_f32_16x16x32_bf16 v[240:243], a[224:227], v[136:139], v[184:187]
    ds_read_b128 v[112:115], v2 offset:28672
    ds_read_b128 v[116:119], v2 offset:29696
    v_mfma_f32_16x16x32_bf16 v[240:243], a[228:231], v[168:171], v[240:243]
    v_exp_f32 v250, v250
    v_mfma_f32_16x16x32_bf16 v[240:243], a[232:235], v[200:203], v[240:243]
    v_exp_f32 v251, v251
    v_mfma_f32_16x16x32_bf16 v[240:243], a[236:239], v[232:235], v[240:243]
    buffer_load_dwordx4 v1, s[36:39], s100 offen offset:2048 sc1 lds
    v_mfma_f32_16x16x32_bf16 a[152:155], v[96:99], v[48:51], a[152:155]
    v_cvt_pk_bf16_f32 v82, v248, v249
    v_cvt_pk_bf16_f32 v83, v250, v251
    v_mfma_f32_16x16x32_bf16 a[152:155], v[100:103], v[52:55], a[152:155]
    ds_read_b128 v[120:123], v2 offset:30720
    ds_read_b128 v[124:127], v2 offset:31744
    v_mfma_f32_16x16x32_bf16 a[156:159], v[96:99], v[56:59], a[156:159]
    v_exp_f32 v252, v252
    v_mfma_f32_16x16x32_bf16 a[156:159], v[100:103], v[60:63], a[156:159]
    v_exp_f32 v253, v253
    v_mfma_f32_16x16x32_bf16 v[244:247], a[224:227], v[140:143], v[156:159]
    v_exp_f32 v254, v254
    v_mfma_f32_16x16x32_bf16 v[244:247], a[228:231], v[172:175], v[244:247]
    buffer_load_dwordx4 v1, s[36:39], s100 offen offset:3072 sc1 lds
    v_mfma_f32_16x16x32_bf16 v[244:247], a[232:235], v[204:207], v[244:247]
    v_exp_f32 v255, v255
    v_mfma_f32_16x16x32_bf16 v[244:247], a[236:239], v[236:239], v[244:247]
    s_cmp_eq_u32 s82, 163840
    s_cselect_b32 s82, 0, s82
    v_cvt_pk_bf16_f32 v90, v252, v253
    v_mfma_f32_16x16x32_bf16 a[168:171], v[104:107], v[48:51], a[168:171]
    v_cvt_pk_bf16_f32 v91, v254, v255
    v_add_u32 v2, s82, v1
    v_mfma_f32_16x16x32_bf16 a[168:171], v[108:111], v[52:55], a[168:171]
    ds_read_b128 a[224:227], v2 offset:0
    ds_read_b128 a[228:231], v2 offset:1024
    v_mfma_f32_16x16x32_bf16 a[172:175], v[104:107], v[56:59], a[172:175]
    s_add_u32 s77, s77, 32768
    v_exp_f32 v240, v240
    v_mfma_f32_16x16x32_bf16 a[172:175], v[108:111], v[60:63], a[172:175]
    s_waitcnt lgkmcnt(2)
    ds_read_b128 a[232:235], v2 offset:2048
    ds_read_b128 a[236:239], v2 offset:3072
    v_mfma_f32_16x16x32_bf16 v[248:251], a[240:243], v[136:139], v[188:191]
    v_exp_f32 v241, v241
    v_mfma_f32_16x16x32_bf16 v[248:251], a[244:247], v[168:171], v[248:251]
    ds_read_b128 v[96:99], v2 offset:16384
    ds_read_b128 v[100:103], v2 offset:17408
    v_mfma_f32_16x16x32_bf16 v[248:251], a[248:251], v[200:203], v[248:251]
    v_exp_f32 v242, v242
    v_mfma_f32_16x16x32_bf16 v[248:251], a[252:255], v[232:235], v[248:251]
    v_exp_f32 v243, v243
    v_mfma_f32_16x16x32_bf16 a[184:187], v[112:115], v[48:51], a[184:187]
    v_exp_f32 v244, v244
    v_mfma_f32_16x16x32_bf16 a[184:187], v[116:119], v[52:55], a[184:187]
    v_exp_f32 v245, v245
    v_mfma_f32_16x16x32_bf16 a[188:191], v[112:115], v[56:59], a[188:191]
    v_exp_f32 v246, v246
    v_mfma_f32_16x16x32_bf16 a[188:191], v[116:119], v[60:63], a[188:191]
    v_exp_f32 v247, v247
    v_mfma_f32_16x16x32_bf16 v[252:255], a[240:243], v[140:143], v[156:159]
    v_exp_f32 v248, v248
    v_mfma_f32_16x16x32_bf16 v[252:255], a[244:247], v[172:175], v[252:255]
    v_exp_f32 v249, v249
    v_mfma_f32_16x16x32_bf16 v[252:255], a[248:251], v[204:207], v[252:255]
    v_exp_f32 v250, v250
    v_mfma_f32_16x16x32_bf16 v[252:255], a[252:255], v[236:239], v[252:255]
    v_exp_f32 v251, v251
    v_mfma_f32_16x16x32_bf16 a[200:203], v[120:123], v[48:51], a[200:203]
    v_cvt_pk_bf16_f32 v84, v240, v241
    v_cvt_pk_bf16_f32 v85, v242, v243
    v_mfma_f32_16x16x32_bf16 a[200:203], v[124:127], v[52:55], a[200:203]
    v_cvt_pk_bf16_f32 v92, v244, v245
    v_cvt_pk_bf16_f32 v93, v246, v247
    v_mfma_f32_16x16x32_bf16 a[204:207], v[120:123], v[56:59], a[204:207]
    v_exp_f32 v252, v252
    v_mfma_f32_16x16x32_bf16 a[204:207], v[124:127], v[60:63], a[204:207]
    v_exp_f32 v253, v253
    v_mfma_f32_16x16x32_bf16 a[216:219], a[136:139], v[48:51], a[216:219]
    v_cvt_pk_bf16_f32 v86, v248, v249
    v_cvt_pk_bf16_f32 v87, v250, v251
    v_mfma_f32_16x16x32_bf16 a[216:219], a[136:139], v[52:55], a[216:219]
    v_cvt_pk_bf16_f32 v94, v252, v253
    v_mfma_f32_16x16x32_bf16 a[220:223], a[136:139], v[56:59], a[220:223]
    v_mfma_f32_16x16x32_bf16 a[220:223], a[136:139], v[60:63], a[220:223]
    s_cmp_le_u32 s78, 2
    s_cbranch_scc1 K1_LS_MASK
K1_LS_BACK:
    s_waitcnt lgkmcnt(0)
    v_mfma_f32_16x16x32_bf16 v[240:243], a[224:227], v[136:139], v[176:179]
    s_add_u32 m0, s76, s75
    v_exp_f32 v254, v254
    v_mfma_f32_16x16x32_bf16 v[240:243], a[228:231], v[168:171], v[240:243]
    s_mov_b32 s76, s60
    v_exp_f32 v255, v255
    v_mfma_f32_16x16x32_bf16 v[240:243], a[232:235], v[200:203], v[240:243]
    s_mov_b32 s60, s82
    buffer_load_dwordx4 v1, s[36:39], s77 offen sc1 lds
    v_mfma_f32_16x16x32_bf16 v[240:243], a[236:239], v[232:235], v[240:243]
    s_add_u32 s82, s82, 32768
    ds_read_b128 v[104:107], v2 offset:18432
    v_cvt_pk_bf16_f32 v95, v254, v255
    v_mfma_f32_16x16x32_bf16 a[8:11], v[96:99], v[80:83], a[8:11]
    ds_read_b128 v[108:111], v2 offset:19456
    ds_read_b128 a[240:243], v2 offset:4096
    v_mfma_f32_16x16x32_bf16 a[8:11], v[100:103], v[84:87], a[8:11]
    ds_read_b128 a[244:247], v2 offset:5120
    v_mfma_f32_16x16x32_bf16 a[12:15], v[96:99], v[88:91], a[12:15]
    buffer_load_dwordx4 v1, s[36:39], s77 offen offset:1024 sc1 lds
    v_mfma_f32_16x16x32_bf16 a[12:15], v[100:103], v[92:95], a[12:15]
    ds_read_b128 a[248:251], v2 offset:6144
    ds_read_b128 a[252:255], v2 offset:7168
    v_mfma_f32_16x16x32_bf16 v[244:247], a[224:227], v[140:143], v[156:159]
    v_exp_f32 v240, v240
    v_mfma_f32_16x16x32_bf16 v[244:247], a[228:231], v[172:175], v[244:247]
    ds_read_b128 v[112:115], v2 offset:20480
    ds_read_b128 v[116:119], v2 offset:21504
    v_mfma_f32_16x16x32_bf16 v[244:247], a[232:235], v[204:207], v[244:247]
    v_exp_f32 v241, v241
    v_mfma_f32_16x16x32_bf16 v[244:247], a[236:239], v[236:239], v[244:247]
    s_waitcnt lgkmcnt(4)
    ds_read_b128 v[120:123], v2 offset:22528
    ds_read_b128 v[124:127], v2 offset:23552
    v_mfma_f32_16x16x32_bf16 a[24:27], v[104:107], v[80:83], a[24:27]
    buffer_load_dwordx4 v1, s[36:39], s77 offen offset:2048 sc1 lds
    v_mfma_f32_16x16x32_bf16 a[24:27], v[108:111], v[84:87], a[24:27]
    ds_read_b128 a[224:227], v2 offset:8192
    ds_read_b128 a[228:231], v2 offset:9216
    v_mfma_f32_16x16x32_bf16 a[28:31], v[104:107], v[88:91], a[28:31]
    ds_read_b128 a[232:235], v2 offset:10240
    v_cvt_pk_bf16_f32 v48, v240, v241
    v_mfma_f32_16x16x32_bf16 a[28:31], v[108:111], v[92:95], a[28:31]
    v_exp_f32 v242, v242
    v_mfma_f32_16x16x32_bf16 v[248:251], a[240:243], v[136:139], v[180:183]
    ds_read_b128 a[236:239], v2 offset:11264
    ds_read_b128 v[96:99], v2 offset:24576
    v_mfma_f32_16x16x32_bf16 v[248:251], a[244:247], v[168:171], v[248:251]
    s_waitcnt lgkmcnt(5)
    v_exp_f32 v243, v243
    v_mfma_f32_16x16x32_bf16 v[248:251], a[248:251], v[200:203], v[248:251]
    buffer_load_dwordx4 v1, s[36:39], s77 offen offset:3072 sc1 lds
    v_mfma_f32_16x16x32_bf16 v[248:251], a[252:255], v[232:235], v[248:251]
    ds_read_b128 v[100:103], v2 offset:25600
    v_cvt_pk_bf16_f32 v49, v242, v243
    v_mfma_f32_16x16x32_bf16 a[40:43], v[112:115], v[80:83], a[40:43]
    ds_read_b128 v[104:107], v2 offset:26624
    ds_read_b128 v[108:111], v2 offset:27648
    v_mfma_f32_16x16x32_bf16 a[40:43], v[116:119], v[84:87], a[40:43]
    v_exp_f32 v244, v244
    v_mfma_f32_16x16x32_bf16 a[44:47], v[112:115], v[88:91], a[44:47]
    v_exp_f32 v245, v245
    v_mfma_f32_16x16x32_bf16 a[44:47], v[116:119], v[92:95], a[44:47]
    s_add_u32 s100, s77, 4096
    v_exp_f32 v246, v246
    v_mfma_f32_16x16x32_bf16 v[252:255], a[240:243], v[140:143], v[156:159]
    s_add_u32 m0, m0, 4096
    v_exp_f32 v247, v247
    v_mfma_f32_16x16x32_bf16 v[252:255], a[244:247], v[172:175], v[252:255]
    buffer_load_dwordx4 v1, s[36:39], s100 offen sc1 lds
    v_mfma_f32_16x16x32_bf16 v[252:255], a[248:251], v[204:207], v[252:255]
    v_cvt_pk_bf16_f32 v56, v244, v245
    v_cvt_pk_bf16_f32 v57, v246, v247
    v_mfma_f32_16x16x32_bf16 v[252:255], a[252:255], v[236:239], v[252:255]
    ds_read_b128 a[240:243], v2 offset:12288
    ds_read_b128 a[244:247], v2 offset:13312
    v_mfma_f32_16x16x32_bf16 a[56:59], v[120:123], v[80:83], a[56:59]
    v_exp_f32 v248, v248
    v_mfma_f32_16x16x32_bf16 a[56:59], v[124:127], v[84:87], a[56:59]
    buffer_load_dwordx4 v1, s[36:39], s100 offen offset:1024 sc1 lds
    v_mfma_f32_16x16x32_bf16 a[60:63], v[120:123], v[88:91], a[60:63]
    ds_read_b128 a[248:251], v2 offset:14336
    ds_read_b128 a[252:255], v2 offset:15360
    v_mfma_f32_16x16x32_bf16 a[60:63], v[124:127], v[92:95], a[60:63]
    s_waitcnt lgkmcnt(4)
    v_exp_f32 v249, v249
    v_mfma_f32_16x16x32_bf16 v[240:243], a[224:227], v[136:139], v[184:187]
    ds_read_b128 v[112:115], v2 offset:28672
    ds_read_b128 v[116:119], v2 offset:29696
    v_mfma_f32_16x16x32_bf16 v[240:243], a[228:231], v[168:171], v[240:243]
    v_exp_f32 v250, v250
    v_mfma_f32_16x16x32_bf16 v[240:243], a[232:235], v[200:203], v[240:243]
    v_exp_f32 v251, v251
    v_mfma_f32_16x16x32_bf16 v[240:243], a[236:239], v[232:235], v[240:243]
    buffer_load_dwordx4 v1, s[36:39], s100 offen offset:2048 sc1 lds
    v_mfma_f32_16x16x32_bf16 a[152:155], v[96:99], v[80:83], a[152:155]
    v_cvt_pk_bf16_f32 v50, v248, v249
    v_cvt_pk_bf16_f32 v51, v250, v251
    v_mfma_f32_16x16x32_bf16 a[152:155], v[100:103], v[84:87], a[152:155]
    ds_read_b128 v[120:123], v2 offset:30720
    ds_read_b128 v[124:127], v2 offset:31744
    v_mfma_f32_16x16x32_bf16 a[156:159], v[96:99], v[88:91], a[156:159]
    v_exp_f32 v252, v252
    v_mfma_f32_16x16x32_bf16 a[156:159], v[100:103], v[92:95], a[156:159]
    v_exp_f32 v253, v253
    v_mfma_f32_16x16x32_bf16 v[244:247], a[224:227], v[140:143], v[156:159]
    v_exp_f32 v254, v254
    v_mfma_f32_16x16x32_bf16 v[244:247], a[228:231], v[172:175], v[244:247]
    buffer_load_dwordx4 v1, s[36:39], s100 offen offset:3072 sc1 lds
    v_mfma_f32_16x16x32_bf16 v[244:247], a[232:235], v[204:207], v[244:247]
    v_exp_f32 v255, v255
    v_mfma_f32_16x16x32_bf16 v[244:247], a[236:239], v[236:239], v[244:247]
    s_cmp_eq_u32 s82, 163840
    s_cselect_b32 s82, 0, s82
    v_cvt_pk_bf16_f32 v58, v252, v253
    v_mfma_f32_16x16x32_bf16 a[168:171], v[104:107], v[80:83], a[168:171]
    v_cvt_pk_bf16_f32 v59, v254, v255
    v_add_u32 v2, s82, v1
    v_mfma_f32_16x16x32_bf16 a[168:171], v[108:111], v[84:87], a[168:171]
    v_exp_f32 v240, v240
    v_mfma_f32_16x16x32_bf16 a[172:175], v[104:107], v[88:91], a[172:175]
    s_add_u32 s77, s77, 32768
    v_exp_f32 v241, v241
    v_mfma_f32_16x16x32_bf16 a[172:175], v[108:111], v[92:95], a[172:175]
    s_waitcnt lgkmcnt(0)
    v_exp_f32 v242, v242
    v_mfma_f32_16x16x32_bf16 v[248:251], a[240:243], v[136:139], v[188:191]
    v_exp_f32 v243, v243
    v_mfma_f32_16x16x32_bf16 v[248:251], a[244:247], v[168:171], v[248:251]
    v_exp_f32 v244, v244
    v_mfma_f32_16x16x32_bf16 v[248:251], a[248:251], v[200:203], v[248:251]
    v_exp_f32 v245, v245
    v_mfma_f32_16x16x32_bf16 v[248:251], a[252:255], v[232:235], v[248:251]
    v_exp_f32 v246, v246
    v_mfma_f32_16x16x32_bf16 a[184:187], v[112:115], v[80:83], a[184:187]
    v_exp_f32 v247, v247
    v_mfma_f32_16x16x32_bf16 a[184:187], v[116:119], v[84:87], a[184:187]
    v_cvt_pk_bf16_f32 v52, v240, v241
    v_cvt_pk_bf16_f32 v53, v242, v243
    v_mfma_f32_16x16x32_bf16 a[188:191], v[112:115], v[88:91], a[188:191]
    v_cvt_pk_bf16_f32 v60, v244, v245
    v_cvt_pk_bf16_f32 v61, v246, v247
    v_mfma_f32_16x16x32_bf16 a[188:191], v[116:119], v[92:95], a[188:191]
    s_waitcnt vmcnt(8) lgkmcnt(0)
    s_barrier
    ds_read_b128 a[224:227], v2 offset:0
    v_mfma_f32_16x16x32_bf16 v[252:255], a[240:243], v[140:143], v[156:159]
    ds_read_b128 a[228:231], v2 offset:1024
    ds_read_b128 a[232:235], v2 offset:2048
    v_mfma_f32_16x16x32_bf16 v[252:255], a[244:247], v[172:175], v[252:255]
    v_exp_f32 v248, v248
    v_mfma_f32_16x16x32_bf16 v[252:255], a[248:251], v[204:207], v[252:255]
    ds_read_b128 a[236:239], v2 offset:3072
    ds_read_b128 v[96:99], v2 offset:16384
    v_mfma_f32_16x16x32_bf16 v[252:255], a[252:255], v[236:239], v[252:255]
    v_exp_f32 v249, v249
    v_mfma_f32_16x16x32_bf16 a[200:203], v[120:123], v[80:83], a[200:203]
    ds_read_b128 v[100:103], v2 offset:17408
    v_cvt_pk_bf16_f32 v54, v248, v249
    v_mfma_f32_16x16x32_bf16 a[200:203], v[124:127], v[84:87], a[200:203]
    v_exp_f32 v250, v250
    v_mfma_f32_16x16x32_bf16 a[204:207], v[120:123], v[88:91], a[204:207]
    v_exp_f32 v251, v251
    v_mfma_f32_16x16x32_bf16 a[204:207], v[124:127], v[92:95], a[204:207]
    v_exp_f32 v252, v252
    v_mfma_f32_16x16x32_bf16 a[216:219], a[136:139], v[80:83], a[216:219]
    v_exp_f32 v253, v253
    v_mfma_f32_16x16x32_bf16 a[216:219], a[136:139], v[84:87], a[216:219]
    v_cvt_pk_bf16_f32 v55, v250, v251
    v_cvt_pk_bf16_f32 v62, v252, v253
    v_mfma_f32_16x16x32_bf16 a[220:223], a[136:139], v[88:91], a[220:223]
    v_mfma_f32_16x16x32_bf16 a[220:223], a[136:139], v[92:95], a[220:223]
    s_sub_u32 s78, s78, 1
    s_cmp_lg_u32 s78, 0
    s_cbranch_scc1 K1_LS
K1_LS_END:
    v_add_f32 v212, s12, v156
    v_fma_f32 v176, v208, s8, v212
    v_fma_f32 v177, v209, s8, v212
    v_fma_f32 v178, v210, s8, v212
    v_fma_f32 v179, v211, s8, v212
    s_nop 1
    s_waitcnt lgkmcnt(0)
    v_mfma_f32_16x16x32_bf16 v[240:243], a[224:227], v[140:143], v[176:179]
    s_xor_b32 s21, s3, 1
    s_lshl2_add_u32 s21, s21, s4
    ds_read_b128 v[104:107], v2 offset:18432
    v_mfma_f32_16x16x32_bf16 v[240:243], a[228:231], v[172:175], v[240:243]
    s_mul_i32 s21, s21, 36864
    ds_read_b128 v[108:111], v2 offset:19456
    ds_read_b128 a[240:243], v2 offset:4096
    v_mfma_f32_16x16x32_bf16 v[240:243], a[232:235], v[204:207], v[240:243]
    s_add_u32 s21, s21, s28
    s_mov_b32 m0, s45
    ds_read_b128 a[244:247], v2 offset:5120
    v_mfma_f32_16x16x32_bf16 v[240:243], a[236:239], v[236:239], v[240:243]
    s_mul_i32 s86, s4, 34
    buffer_load_dwordx4 v1, s[56:59], s21 offen sc1 lds
    v_mfma_f32_16x16x32_bf16 a[8:11], v[96:99], v[48:51], a[8:11]
    s_add_u32 s86, s86, 8
    v_exp_f32 v254, v254
    v_mfma_f32_16x16x32_bf16 a[8:11], v[100:103], v[52:55], a[8:11]
    s_mov_b32 s76, s60
    v_exp_f32 v255, v255
    v_mfma_f32_16x16x32_bf16 a[12:15], v[96:99], v[56:59], a[12:15]
    s_mov_b32 s60, s82
    v_cvt_pk_bf16_f32 v63, v254, v255
    ds_read_b128 a[248:251], v2 offset:6144
    s_nop 0
    v_mfma_f32_16x16x32_bf16 a[12:15], v[100:103], v[60:63], a[12:15]
    s_add_u32 s82, s82, 32768
    v_lshrrev_b32 v28, 4, v1
    ds_read_b128 a[252:255], v2 offset:7168
    s_waitcnt lgkmcnt(2)
    v_mfma_f32_16x16x32_bf16 a[24:27], v[104:107], v[48:51], a[24:27]
    s_and_b32 s62, s5, 4
    v_min_u32 v28, 33, v28
    ds_read_b128 v[112:115], v2 offset:20480
    v_mfma_f32_16x16x32_bf16 a[24:27], v[108:111], v[52:55], a[24:27]
    s_lshl_b32 s63, s3, 12
    buffer_load_dwordx4 v1, s[56:59], s21 offen offset:1024 sc1 lds
    v_mfma_f32_16x16x32_bf16 a[28:31], v[104:107], v[56:59], a[28:31]
    s_sub_u32 s19, s74, s101
    v_add_lshl_u32 v28, v28, s86, 7
    v_add_f32 v213, s13, v156
    v_mfma_f32_16x16x32_bf16 a[28:31], v[108:111], v[60:63], a[28:31]
    s_getpc_b64 s[86:87]
    global_load_dword v28, v28, s[86:87]
    v_fma_f32 v180, v208, s9, v213
    v_fma_f32 v181, v209, s9, v213
    v_fma_f32 v182, v210, s9, v213
    v_fma_f32 v183, v211, s9, v213
    s_nop 1
    v_mfma_f32_16x16x32_bf16 v[244:247], a[240:243], v[140:143], v[180:183]
    s_add_u32 s62, s62, s4
    ds_read_b128 v[116:119], v2 offset:21504
    ds_read_b128 v[120:123], v2 offset:22528
    v_mfma_f32_16x16x32_bf16 v[244:247], a[244:247], v[172:175], v[244:247]
    s_mov_b32 s20, s63
    ds_read_b128 v[124:127], v2 offset:23552
    v_add_f32 v214, s14, v156
    s_waitcnt lgkmcnt(3)
    v_mfma_f32_16x16x32_bf16 v[244:247], a[248:251], v[204:207], v[244:247]
    s_add_u32 s19, s66, s19
    buffer_load_dwordx4 v1, s[56:59], s21 offen offset:2048 sc1 lds
    v_mfma_f32_16x16x32_bf16 v[244:247], a[252:255], v[236:239], v[244:247]
    s_mov_b32 s50, 9437184
    ds_read_b128 a[224:227], v2 offset:8192
    ds_read_b128 a[228:231], v2 offset:9216
    v_mfma_f32_16x16x32_bf16 a[40:43], v[112:115], v[48:51], a[40:43]
    s_waitcnt lgkmcnt(4)
    ds_read_b128 a[232:235], v2 offset:10240
    v_fma_f32 v184, v208, s10, v214
    v_mfma_f32_16x16x32_bf16 a[40:43], v[116:119], v[52:55], a[40:43]
    ds_read_b128 a[236:239], v2 offset:11264
    v_fma_f32 v185, v209, s10, v214
    v_mfma_f32_16x16x32_bf16 a[44:47], v[112:115], v[56:59], a[44:47]
    ds_read_b128 v[96:99], v2 offset:24576
    v_fma_f32 v186, v210, s10, v214
    v_mfma_f32_16x16x32_bf16 a[44:47], v[116:119], v[60:63], a[44:47]
    s_waitcnt lgkmcnt(5)
    ds_read_b128 v[100:103], v2 offset:25600
    v_fma_f32 v187, v211, s10, v214
    v_mfma_f32_16x16x32_bf16 a[56:59], v[120:123], v[48:51], a[56:59]
    buffer_load_dwordx4 v1, s[56:59], s21 offen offset:3072 sc1 lds
    v_mfma_f32_16x16x32_bf16 a[56:59], v[124:127], v[52:55], a[56:59]
    s_add_u32 s21, s21, 4096
    ds_read_b128 v[104:107], v2 offset:26624
    ds_read_b128 v[108:111], v2 offset:27648
    v_mfma_f32_16x16x32_bf16 a[60:63], v[120:123], v[56:59], a[60:63]
    s_add_u32 m0, s45, 4096
    ds_read_b128 a[240:243], v2 offset:12288
    v_add_f32 v215, s15, v156
    v_mfma_f32_16x16x32_bf16 a[60:63], v[124:127], v[60:63], a[60:63]
    s_waitcnt lgkmcnt(4)
    ds_read_b128 a[244:247], v2 offset:13312
    v_fma_f32 v188, v208, s11, v215
    v_mfma_f32_16x16x32_bf16 v[248:251], a[224:227], v[140:143], v[184:187]
    ds_read_b128 a[248:251], v2 offset:14336
    v_fma_f32 v189, v209, s11, v215
    v_mfma_f32_16x16x32_bf16 v[248:251], a[228:231], v[172:175], v[248:251]
    ds_read_b128 a[252:255], v2 offset:15360
    v_fma_f32 v190, v210, s11, v215
    v_mfma_f32_16x16x32_bf16 v[248:251], a[232:235], v[204:207], v[248:251]
    buffer_load_dwordx4 v1, s[56:59], s21 offen sc1 lds
    v_mfma_f32_16x16x32_bf16 v[248:251], a[236:239], v[236:239], v[248:251]
    ds_read_b128 v[112:115], v2 offset:28672
    ds_read_b128 v[116:119], v2 offset:29696
    v_mfma_f32_16x16x32_bf16 a[152:155], v[96:99], v[48:51], a[152:155]
    s_waitcnt lgkmcnt(4)
    v_fma_f32 v191, v211, s11, v215
    ds_read_b128 v[120:123], v2 offset:30720
    v_mfma_f32_16x16x32_bf16 a[152:155], v[100:103], v[52:55], a[152:155]
    ds_read_b128 v[124:127], v2 offset:31744
    v_bfe_u32 v217, v1, 4, 3
    v_mfma_f32_16x16x32_bf16 a[156:159], v[96:99], v[56:59], a[156:159]
    s_cmp_eq_u32 s82, 163840
    s_cselect_b32 s82, 0, s82
    v_add_u32 v2, s82, v1
    v_mfma_f32_16x16x32_bf16 a[156:159], v[100:103], v[60:63], a[156:159]
    ds_read_b128 a[224:227], v2 offset:0
    ds_read_b128 a[228:231], v2 offset:1024
    v_mfma_f32_16x16x32_bf16 a[168:171], v[104:107], v[48:51], a[168:171]
    buffer_load_dwordx4 v1, s[56:59], s21 offen offset:1024 sc1 lds
    v_mfma_f32_16x16x32_bf16 a[168:171], v[108:111], v[52:55], a[168:171]
    ds_read_b128 a[232:235], v2 offset:2048
    ds_read_b128 a[236:239], v2 offset:3072
    v_mfma_f32_16x16x32_bf16 a[172:175], v[104:107], v[56:59], a[172:175]
    ds_read_b128 v[96:99], v2 offset:16384
    v_lshlrev_b32 v217, 7, v217
    v_mfma_f32_16x16x32_bf16 a[172:175], v[108:111], v[60:63], a[172:175]
    v_exp_f32 v240, v240
    v_mfma_f32_16x16x32_bf16 v[252:255], a[240:243], v[140:143], v[188:191]
    v_exp_f32 v241, v241
    v_mfma_f32_16x16x32_bf16 v[252:255], a[244:247], v[172:175], v[252:255]
    s_waitcnt lgkmcnt(3)
    ds_read_b128 v[100:103], v2 offset:17408
    v_cvt_pk_bf16_f32 v88, v240, v241
    v_mfma_f32_16x16x32_bf16 v[252:255], a[248:251], v[204:207], v[252:255]
    buffer_load_dwordx4 v1, s[56:59], s21 offen offset:2048 sc1 lds
    v_mfma_f32_16x16x32_bf16 v[252:255], a[252:255], v[236:239], v[252:255]
    v_exp_f32 v242, v242
    v_mfma_f32_16x16x32_bf16 a[184:187], v[112:115], v[48:51], a[184:187]
    v_exp_f32 v243, v243
    v_mfma_f32_16x16x32_bf16 a[184:187], v[116:119], v[52:55], a[184:187]
    v_exp_f32 v244, v244
    v_mfma_f32_16x16x32_bf16 a[188:191], v[112:115], v[56:59], a[188:191]
    v_exp_f32 v245, v245
    v_mfma_f32_16x16x32_bf16 a[188:191], v[116:119], v[60:63], a[188:191]
    v_exp_f32 v246, v246
    v_mfma_f32_16x16x32_bf16 a[200:203], v[120:123], v[48:51], a[200:203]
    v_exp_f32 v247, v247
    v_mfma_f32_16x16x32_bf16 a[200:203], v[124:127], v[52:55], a[200:203]
    v_exp_f32 v248, v248
    v_mfma_f32_16x16x32_bf16 a[204:207], v[120:123], v[56:59], a[204:207]
    v_exp_f32 v249, v249
    v_mfma_f32_16x16x32_bf16 a[204:207], v[124:127], v[60:63], a[204:207]
    v_exp_f32 v250, v250
    v_mfma_f32_16x16x32_bf16 a[216:219], a[136:139], v[48:51], a[216:219]
    v_exp_f32 v251, v251
    v_mfma_f32_16x16x32_bf16 a[216:219], a[136:139], v[52:55], a[216:219]
    v_exp_f32 v252, v252
    v_mfma_f32_16x16x32_bf16 a[220:223], a[136:139], v[56:59], a[220:223]
    s_add_u32 s48, s32, 1048576
    s_addc_u32 s49, s33, 0
    v_cvt_pk_bf16_f32 v89, v242, v243
    v_mfma_f32_16x16x32_bf16 a[220:223], a[136:139], v[60:63], a[220:223]
    v_exp_f32 v253, v253
    v_cvt_pk_bf16_f32 v90, v244, v245
    v_cvt_pk_bf16_f32 v91, v246, v247
    v_cvt_pk_bf16_f32 v92, v248, v249
    v_cvt_pk_bf16_f32 v93, v250, v251
    v_cvt_pk_bf16_f32 v94, v252, v253
    s_cmp_eq_u32 s6, 7
    s_cbranch_scc1 K1_S7
K1_S7_BACK:
    ds_read_b128 v[104:107], v2 offset:18432
    ds_read_b128 v[108:111], v2 offset:19456
    ds_read_b128 v[112:115], v2 offset:20480
    ds_read_b128 v[116:119], v2 offset:21504
    ds_read_b128 v[120:123], v2 offset:22528
    ds_read_b128 v[124:127], v2 offset:23552
    s_waitcnt lgkmcnt(6)
    v_mfma_f32_16x16x32_bf16 a[12:15], v[96:99], v[88:91], a[12:15]
    v_exp_f32 v254, v254
    v_exp_f32 v255, v255
    s_nop 0
    v_cvt_pk_bf16_f32 v95, v254, v255
    s_nop 1
    v_mfma_f32_16x16x32_bf16 a[12:15], v[100:103], v[92:95], a[12:15]
    s_waitcnt lgkmcnt(5)
    ds_read_b128 v[96:99], v2 offset:24576
    ds_read_b128 v[100:103], v2 offset:25600
    v_accvgpr_read_b32 v9, a216
    v_rcp_f32 v10, v9
    v_mfma_f32_16x16x32_bf16 a[28:31], v[104:107], v[88:91], a[28:31]
    s_waitcnt lgkmcnt(6)
    ds_read_b128 v[104:107], v2 offset:26624
    v_mul_f32 v10, v10, v6
    v_accvgpr_read_b32 v12, a8
    v_accvgpr_read_b32 v13, a9
    v_accvgpr_read_b32 v14, a10
    v_mfma_f32_16x16x32_bf16 a[28:31], v[108:111], v[92:95], a[28:31]
    s_waitcnt lgkmcnt(6)
    ds_read_b128 v[108:111], v2 offset:27648
    v_accvgpr_read_b32 v15, a11
    v_accvgpr_read_b32 v16, a24
    v_accvgpr_read_b32 v17, a25
    v_accvgpr_read_b32 v18, a26
    v_mfma_f32_16x16x32_bf16 a[44:47], v[112:115], v[88:91], a[44:47]
    s_waitcnt lgkmcnt(4)
    ds_read_b128 v[112:115], v2 offset:28672
    v_accvgpr_read_b32 v19, a27
    v_accvgpr_read_b32 v20, a40
    v_accvgpr_read_b32 v21, a41
    v_accvgpr_read_b32 v22, a42
    v_mfma_f32_16x16x32_bf16 a[44:47], v[116:119], v[92:95], a[44:47]
    ds_read_b128 v[116:119], v2 offset:29696
    v_accvgpr_read_b32 v23, a43
    v_accvgpr_read_b32 v24, a56
    v_accvgpr_read_b32 v25, a57
    v_accvgpr_read_b32 v26, a58
    v_mfma_f32_16x16x32_bf16 a[60:63], v[120:123], v[88:91], a[60:63]
    ds_read_b128 v[120:123], v2 offset:30720
    v_accvgpr_read_b32 v27, a59
    v_mul_f32 v12, v10, v12
    v_mul_f32 v13, v10, v13
    v_mul_f32 v14, v10, v14
    v_mfma_f32_16x16x32_bf16 a[60:63], v[124:127], v[92:95], a[60:63]
    s_waitcnt lgkmcnt(4)
    ds_read_b128 v[124:127], v2 offset:31744
    v_mul_f32 v15, v10, v15
    v_mul_f32 v16, v10, v16
    v_mul_f32 v17, v10, v17
    v_mul_f32 v18, v10, v18
    v_mfma_f32_16x16x32_bf16 a[156:159], v[96:99], v[88:91], a[156:159]
    v_mul_f32 v19, v10, v19
    v_mul_f32 v20, v10, v20
    v_mul_f32 v21, v10, v21
    v_mul_f32 v22, v10, v22
    v_mul_f32 v23, v10, v23
    v_mfma_f32_16x16x32_bf16 a[156:159], v[100:103], v[92:95], a[156:159]
    v_mul_f32 v24, v10, v24
    v_mul_f32 v25, v10, v25
    v_mul_f32 v26, v10, v26
    v_mul_f32 v27, v10, v27
    v_cvt_pk_bf16_f32 v12, v12, v13
    v_mfma_f32_16x16x32_bf16 a[172:175], v[104:107], v[88:91], a[172:175]
    s_waitcnt lgkmcnt(2)
    v_cvt_pk_bf16_f32 v13, v14, v15
    v_cvt_pk_bf16_f32 v14, v16, v17
    v_cvt_pk_bf16_f32 v15, v18, v19
    v_cvt_pk_bf16_f32 v20, v20, v21
    v_cvt_pk_bf16_f32 v21, v22, v23
    v_mfma_f32_16x16x32_bf16 a[172:175], v[108:111], v[92:95], a[172:175]
    v_cvt_pk_bf16_f32 v22, v24, v25
    v_cvt_pk_bf16_f32 v23, v26, v27
    buffer_store_dwordx4 v[12:15], v1, s[40:43], s81 offen offset:0 sc1
    v_accvgpr_read_b32 v16, a168
    v_mfma_f32_16x16x32_bf16 a[188:191], v[112:115], v[88:91], a[188:191]
    buffer_store_dwordx4 v[20:23], v1, s[40:43], s81 offen offset:1024 sc1
    v_accvgpr_read_b32 v12, a152
    v_accvgpr_read_b32 v13, a153
    v_accvgpr_read_b32 v14, a154
    v_mfma_f32_16x16x32_bf16 a[188:191], v[116:119], v[92:95], a[188:191]
    s_waitcnt lgkmcnt(0)
    v_accvgpr_read_b32 v15, a155
    v_accvgpr_read_b32 v17, a169
    v_accvgpr_read_b32 v18, a170
    v_accvgpr_read_b32 v19, a171
    v_accvgpr_read_b32 v20, a184
    v_mfma_f32_16x16x32_bf16 a[204:207], v[120:123], v[88:91], a[204:207]
    v_accvgpr_read_b32 v21, a185
    v_accvgpr_read_b32 v22, a186
    v_accvgpr_read_b32 v23, a187
    v_accvgpr_read_b32 v24, a200
    v_accvgpr_read_b32 v25, a201
    v_mfma_f32_16x16x32_bf16 a[204:207], v[124:127], v[92:95], a[204:207]
    v_accvgpr_read_b32 v26, a202
    v_accvgpr_read_b32 v27, a203
    v_mul_f32 v12, v10, v12
    v_mul_f32 v13, v10, v13
    v_mul_f32 v14, v10, v14
    v_mfma_f32_16x16x32_bf16 a[220:223], a[136:139], v[88:91], a[220:223]
    v_mul_f32 v15, v10, v15
    v_mul_f32 v16, v10, v16
    v_mul_f32 v17, v10, v17
    v_mul_f32 v18, v10, v18
    v_mul_f32 v19, v10, v19
    v_mfma_f32_16x16x32_bf16 a[220:223], a[136:139], v[92:95], a[220:223]
    v_mul_f32 v20, v10, v20
    v_mul_f32 v21, v10, v21
    v_mul_f32 v22, v10, v22
    v_mul_f32 v23, v10, v23
    v_mul_f32 v24, v10, v24
    v_mul_f32 v25, v10, v25
    v_mul_f32 v26, v10, v26
    v_mul_f32 v27, v10, v27
    v_cmp_nge_f32 vcc, 0x71800000, v9
    v_cvt_pk_bf16_f32 v12, v12, v13
    v_cvt_pk_bf16_f32 v13, v14, v15
    v_cvt_pk_bf16_f32 v14, v16, v17
    v_cvt_pk_bf16_f32 v15, v18, v19
    v_cvt_pk_bf16_f32 v20, v20, v21
    v_cvt_pk_bf16_f32 v21, v22, v23
    v_cvt_pk_bf16_f32 v22, v24, v25
    v_cvt_pk_bf16_f32 v23, v26, v27
    s_or_b64 s[84:85], s[84:85], vcc
    buffer_store_dwordx4 v[12:15], v1, s[40:43], s81 offen offset:2048 sc1
    buffer_store_dwordx4 v[20:23], v1, s[40:43], s81 offen offset:3072 sc1
    s_nop 3
    v_accvgpr_read_b32 v9, a220
    v_cmp_nge_f32 vcc, 0x71800000, v9
    v_rcp_f32 v10, v9
    s_nop 0
    s_or_b64 s[84:85], s[84:85], vcc
    v_mul_f32 v10, v10, v7
    s_add_u32 s72, s81, 622592
    v_accvgpr_read_b32 v12, a12
    v_accvgpr_read_b32 v13, a13
    v_accvgpr_read_b32 v14, a14
    v_accvgpr_read_b32 v15, a15
    v_accvgpr_read_b32 v16, a28
    v_accvgpr_read_b32 v17, a29
    v_accvgpr_read_b32 v18, a30
    v_accvgpr_read_b32 v19, a31
    v_pk_mul_f32 v[12:13], v[12:13], v[10:11] op_sel_hi:[1,0]
    v_pk_mul_f32 v[14:15], v[14:15], v[10:11] op_sel_hi:[1,0]
    v_pk_mul_f32 v[16:17], v[16:17], v[10:11] op_sel_hi:[1,0]
    v_pk_mul_f32 v[18:19], v[18:19], v[10:11] op_sel_hi:[1,0]
    v_cvt_pk_bf16_f32 v12, v12, v13
    v_cvt_pk_bf16_f32 v13, v14, v15
    v_cvt_pk_bf16_f32 v14, v16, v17
    v_cvt_pk_bf16_f32 v15, v18, v19
    buffer_store_dwordx4 v[12:15], v1, s[40:43], s72 offen offset:0 sc1
    v_accvgpr_read_b32 v20, a44
    v_accvgpr_read_b32 v21, a45
    v_accvgpr_read_b32 v22, a46
    v_accvgpr_read_b32 v23, a47
    v_accvgpr_read_b32 v24, a60
    v_accvgpr_read_b32 v25, a61
    v_accvgpr_read_b32 v26, a62
    v_accvgpr_read_b32 v27, a63
    v_pk_mul_f32 v[20:21], v[20:21], v[10:11] op_sel_hi:[1,0]
    v_pk_mul_f32 v[22:23], v[22:23], v[10:11] op_sel_hi:[1,0]
    v_pk_mul_f32 v[24:25], v[24:25], v[10:11] op_sel_hi:[1,0]
    v_pk_mul_f32 v[26:27], v[26:27], v[10:11] op_sel_hi:[1,0]
    v_cvt_pk_bf16_f32 v20, v20, v21
    v_cvt_pk_bf16_f32 v21, v22, v23
    v_cvt_pk_bf16_f32 v22, v24, v25
    v_cvt_pk_bf16_f32 v23, v26, v27
    buffer_store_dwordx4 v[20:23], v1, s[40:43], s72 offen offset:1024 sc1
    v_accvgpr_read_b32 v12, a156
    v_accvgpr_read_b32 v13, a157
    v_accvgpr_read_b32 v14, a158
    v_accvgpr_read_b32 v15, a159
    v_accvgpr_read_b32 v16, a172
    v_accvgpr_read_b32 v17, a173
    v_accvgpr_read_b32 v18, a174
    v_accvgpr_read_b32 v19, a175
    v_pk_mul_f32 v[12:13], v[12:13], v[10:11] op_sel_hi:[1,0]
    v_pk_mul_f32 v[14:15], v[14:15], v[10:11] op_sel_hi:[1,0]
    v_pk_mul_f32 v[16:17], v[16:17], v[10:11] op_sel_hi:[1,0]
    v_pk_mul_f32 v[18:19], v[18:19], v[10:11] op_sel_hi:[1,0]
    v_cvt_pk_bf16_f32 v12, v12, v13
    v_cvt_pk_bf16_f32 v13, v14, v15
    v_cvt_pk_bf16_f32 v14, v16, v17
    v_cvt_pk_bf16_f32 v15, v18, v19
    buffer_store_dwordx4 v[12:15], v1, s[40:43], s72 offen offset:2048 sc1
    v_accvgpr_read_b32 v20, a188
    v_accvgpr_read_b32 v21, a189
    v_accvgpr_read_b32 v22, a190
    v_accvgpr_read_b32 v23, a191
    v_accvgpr_read_b32 v24, a204
    v_accvgpr_read_b32 v25, a205
    v_accvgpr_read_b32 v26, a206
    v_accvgpr_read_b32 v27, a207
    v_pk_mul_f32 v[20:21], v[20:21], v[10:11] op_sel_hi:[1,0]
    v_pk_mul_f32 v[22:23], v[22:23], v[10:11] op_sel_hi:[1,0]
    v_pk_mul_f32 v[24:25], v[24:25], v[10:11] op_sel_hi:[1,0]
    v_pk_mul_f32 v[26:27], v[26:27], v[10:11] op_sel_hi:[1,0]
    v_cvt_pk_bf16_f32 v20, v20, v21
    v_cvt_pk_bf16_f32 v21, v22, v23
    v_cvt_pk_bf16_f32 v22, v24, v25
    v_cvt_pk_bf16_f32 v23, v26, v27
    buffer_store_dwordx4 v[20:23], v1, s[40:43], s72 offen offset:3072 sc1
    buffer_load_dword v3, v217, s[32:35], s19 offen sc1
    s_waitcnt lgkmcnt(0)
    s_barrier
    s_sub_u32 s30, s47, s75
    s_sub_u32 s31, s79, s75
    v_bfe_u32 v20, v1, 4, 4
    v_lshrrev_b32 v21, 8, v1
    s_lshl_b32 s98, s4, 4
    s_add_u32 s98, s98, 16
    v_add_u32 v22, s98, v20
    v_mul_u32_u24 v22, 144, v22
    v_add_u32 v22, s30, v22
    v_lshl_add_u32 v9, v21, 3, v22
    s_lshr_b32 s98, s73, 1
    v_add_u32 v8, s98, v9
    v_subrev_u32 v10, s98, v9
    s_sub_u32 s99, s31, s30
    v_add_u32 v24, s99, v8
    v_add_u32 v25, s99, v9
    v_add_u32 v26, s99, v10
    s_bitcmp1_b32 s4, 0
    s_cselect_b32 s99, s31, s30
    v_mul_u32_u24 v23, 144, v20
    v_lshl_add_u32 v23, v21, 3, v23
    v_add_u32 v13, s99, v23
    v_add_u32 v12, s98, v13
    v_accvgpr_read_b32 v32, a64
    v_accvgpr_read_b32 v33, a65
    v_accvgpr_read_b32 v34, a66
    v_accvgpr_read_b32 v35, a67
    v_cvt_pk_bf16_f32 v32, v32, v33
    v_cvt_pk_bf16_f32 v33, v34, v35
    ds_write_b64 v8, v[32:33] offset:0
    v_accvgpr_read_b32 v36, a68
    v_accvgpr_read_b32 v37, a69
    v_accvgpr_read_b32 v38, a70
    v_accvgpr_read_b32 v39, a71
    v_cvt_pk_bf16_f32 v36, v36, v37
    v_cvt_pk_bf16_f32 v37, v38, v39
    ds_write_b64 v8, v[36:37] offset:9216
    v_accvgpr_read_b32 v40, a72
    v_accvgpr_read_b32 v41, a73
    v_accvgpr_read_b32 v42, a74
    v_accvgpr_read_b32 v43, a75
    v_cvt_pk_bf16_f32 v40, v40, v41
    v_cvt_pk_bf16_f32 v41, v42, v43
    ds_write_b64 v24, v[40:41] offset:0
    v_accvgpr_read_b32 v44, a76
    v_accvgpr_read_b32 v45, a77
    v_accvgpr_read_b32 v46, a78
    v_accvgpr_read_b32 v47, a79
    v_cvt_pk_bf16_f32 v44, v44, v45
    v_cvt_pk_bf16_f32 v45, v46, v47
    ds_write_b64 v24, v[44:45] offset:9216
    v_accvgpr_read_b32 v32, a80
    v_accvgpr_read_b32 v33, a81
    v_accvgpr_read_b32 v34, a82
    v_accvgpr_read_b32 v35, a83
    v_cvt_pk_bf16_f32 v32, v32, v33
    v_cvt_pk_bf16_f32 v33, v34, v35
    ds_write_b64 v9, v[32:33] offset:32
    v_accvgpr_read_b32 v36, a84
    v_accvgpr_read_b32 v37, a85
    v_accvgpr_read_b32 v38, a86
    v_accvgpr_read_b32 v39, a87
    v_cvt_pk_bf16_f32 v36, v36, v37
    v_cvt_pk_bf16_f32 v37, v38, v39
    ds_write_b64 v9, v[36:37] offset:9248
    v_accvgpr_read_b32 v40, a88
    v_accvgpr_read_b32 v41, a89
    v_accvgpr_read_b32 v42, a90
    v_accvgpr_read_b32 v43, a91
    v_cvt_pk_bf16_f32 v40, v40, v41
    v_cvt_pk_bf16_f32 v41, v42, v43
    ds_write_b64 v25, v[40:41] offset:32
    v_accvgpr_read_b32 v44, a92
    v_accvgpr_read_b32 v45, a93
    v_accvgpr_read_b32 v46, a94
    v_accvgpr_read_b32 v47, a95
    v_cvt_pk_bf16_f32 v44, v44, v45
    v_cvt_pk_bf16_f32 v45, v46, v47
    ds_write_b64 v25, v[44:45] offset:9248
    v_accvgpr_read_b32 v32, a96
    v_accvgpr_read_b32 v33, a97
    v_accvgpr_read_b32 v34, a98
    v_accvgpr_read_b32 v35, a99
    v_cvt_pk_bf16_f32 v32, v32, v33
    v_cvt_pk_bf16_f32 v33, v34, v35
    ds_write_b64 v10, v[32:33] offset:64
    v_accvgpr_read_b32 v36, a100
    v_accvgpr_read_b32 v37, a101
    v_accvgpr_read_b32 v38, a102
    v_accvgpr_read_b32 v39, a103
    v_cvt_pk_bf16_f32 v36, v36, v37
    v_cvt_pk_bf16_f32 v37, v38, v39
    ds_write_b64 v10, v[36:37] offset:9280
    v_accvgpr_read_b32 v40, a104
    v_accvgpr_read_b32 v41, a105
    v_accvgpr_read_b32 v42, a106
    v_accvgpr_read_b32 v43, a107
    v_cvt_pk_bf16_f32 v40, v40, v41
    v_cvt_pk_bf16_f32 v41, v42, v43
    ds_write_b64 v26, v[40:41] offset:64
    v_accvgpr_read_b32 v44, a108
    v_accvgpr_read_b32 v45, a109
    v_accvgpr_read_b32 v46, a110
    v_accvgpr_read_b32 v47, a111
    v_cvt_pk_bf16_f32 v44, v44, v45
    v_cvt_pk_bf16_f32 v45, v46, v47
    ds_write_b64 v26, v[44:45] offset:9280
    v_mov_b32 v218, 2
    s_cmp_eq_u64 s[84:85], 0
    s_cselect_b32 s7, s74, 1073741824
    s_cmp_lg_u32 s83, 0
    s_cselect_b32 s7, s74, s7
    s_waitcnt vmcnt(1)
    buffer_store_dword v218, v216, s[32:35], s7 offen sc1
    s_xor_b32 s21, s3, 2
    s_lshl2_add_u32 s21, s21, s4
    s_mul_i32 s21, s21, 36864
    s_add_u32 s21, s21, s28
    s_mov_b32 m0, s46
    s_nop 0
    buffer_load_dwordx4 v1, s[56:59], s21 offen sc1 lds
    v_accvgpr_read_b32 v32, a112
    v_accvgpr_read_b32 v33, a113
    v_accvgpr_read_b32 v34, a114
    v_accvgpr_read_b32 v35, a115
    v_cvt_pk_bf16_f32 v32, v32, v33
    v_cvt_pk_bf16_f32 v33, v34, v35
    ds_write_b64 v9, v[32:33] offset:96
    v_accvgpr_read_b32 v36, a116
    v_accvgpr_read_b32 v37, a117
    v_accvgpr_read_b32 v38, a118
    v_accvgpr_read_b32 v39, a119
    v_cvt_pk_bf16_f32 v36, v36, v37
    buffer_load_dwordx4 v1, s[56:59], s21 offen offset:1024 sc1 lds
    v_cvt_pk_bf16_f32 v37, v38, v39
    ds_write_b64 v9, v[36:37] offset:9312
    v_accvgpr_read_b32 v40, a120
    v_accvgpr_read_b32 v41, a121
    v_accvgpr_read_b32 v42, a122
    v_accvgpr_read_b32 v43, a123
    v_cvt_pk_bf16_f32 v40, v40, v41
    v_cvt_pk_bf16_f32 v41, v42, v43
    ds_write_b64 v25, v[40:41] offset:96
    v_accvgpr_read_b32 v44, a124
    v_accvgpr_read_b32 v45, a125
    v_accvgpr_read_b32 v46, a126
    buffer_load_dwordx4 v1, s[56:59], s21 offen offset:2048 sc1 lds
    v_accvgpr_read_b32 v47, a127
    v_cvt_pk_bf16_f32 v44, v44, v45
    v_cvt_pk_bf16_f32 v45, v46, v47
    s_waitcnt lgkmcnt(14)
    ds_write_b64 v25, v[44:45] offset:9312
    v_accvgpr_read_b32 v32, a128
    v_accvgpr_read_b32 v33, a129
    v_accvgpr_read_b32 v34, a130
    v_accvgpr_read_b32 v35, a131
    v_cvt_pk_bf16_f32 v32, v32, v33
    v_cvt_pk_bf16_f32 v33, v34, v35
    s_waitcnt lgkmcnt(14)
    ds_write_b64 v12, v[32:33] offset:0
    v_accvgpr_read_b32 v36, a132
    buffer_load_dwordx4 v1, s[56:59], s21 offen offset:3072 sc1 lds
    v_accvgpr_read_b32 v37, a133
    v_accvgpr_read_b32 v38, a134
    v_accvgpr_read_b32 v39, a135
    v_cvt_pk_bf16_f32 v36, v36, v37
    v_cvt_pk_bf16_f32 v37, v38, v39
    s_cmp_eq_u32 s73, 0
    s_cselect_b64 exec, -1, 0
    s_waitcnt lgkmcnt(14)
    ds_write_b64 v13, v[36:37] offset:32
    s_mov_b64 exec, -1
    s_cmp_lg_u64 s[84:85], 0
    s_cselect_b32 s7, 1, 0
    v_mov_b32 v20, s7
    s_lshl2_add_u32 s98, s4, s30
    s_add_u32 s21, s21, 4096
    s_add_u32 m0, s46, 4096
    s_nop 0
    buffer_load_dwordx4 v1, s[56:59], s21 offen sc1 lds
    v_mov_b32 v21, s98
    s_waitcnt lgkmcnt(14)
    ds_write_b32 v21, v20 offset:20736
    v_mov_b32 v21, s30
    s_and_b32 s98, s4, 1
    s_lshl_b32 s98, s98, 6
    v_lshrrev_b32 v14, 4, v1
    v_add_u32 v14, s98, v14
    s_sub_u32 s7, 15, s6
    s_cmp_lt_u32 s4, 2
    s_cselect_b32 s7, s6, s7
    s_cselect_b32 s99, s30, s31
    s_lshl_b32 s7, s7, 7
    buffer_load_dwordx4 v1, s[56:59], s21 offen offset:1024 sc1 lds
    v_add_u32 v2, 2, v14
    v_mul_u32_u24 v2, 144, v2
    v_add_u32 v2, s99, v2
    v_add_u32 v14, s7, v14
    v_lshrrev_b32 v15, 4, v14
    s_mov_b32 s98, 155648
    v_mul_lo_u32 v15, v15, s98
    v_and_b32 v23, 0xf0, v1
    v_add_u32 v15, v15, v23
    s_lshl3_add_u32 s98, s6, s62
    s_mul_i32 s98, s98, 155648
    v_add_u32 v4, s98, v1
    buffer_load_dwordx4 v1, s[56:59], s21 offen offset:2048 sc1 lds
    s_sub_u32 s98, 15, s6
    s_lshl3_add_u32 s98, s98, s62
    s_mul_i32 s98, s98, 155648
    v_add_u32 v5, s98, v1
    v_mov_b32 v19, v217
    v_subrev_u32 v23, s75, v1
    v_add_u32 v11, s44, v23
    v_add_u32 v12, s45, v23
    v_add_u32 v13, s46, v23
    v_add_u32 v6, s47, v23
    v_add_u32 v7, s79, v23
    s_mov_b32 s98, 0xbfb8aa3b
    s_mov_b32 s99, 0x3eae1a93
    s_waitcnt vmcnt(8) lgkmcnt(0)
    s_barrier
    ds_read_b128 v[24:27], v21 offset:20736
    ds_read_b128 v[32:35], v2 offset:2016
    ds_read_b128 v[36:39], v2 offset:2032
    ds_read_b128 v[40:43], v2 offset:2048
    ds_read_b128 v[44:47], v2 offset:1728
    ds_read_b128 v[48:51], v2 offset:1744
    ds_read_b128 v[52:55], v2 offset:1760
    s_waitcnt lgkmcnt(6)
    v_or3_b32 v24, v24, v25, v26
    v_or_b32 v24, v24, v27
    s_nop 0
    v_readfirstlane_b32 s7, v24
    s_nop 1
    s_andn2_b32 s7, s7, s83
    s_cbranch_scc1 K1_REDO
    buffer_load_dword v28, v29, s[32:35], s92 offen sc1
    v_cmp_gt_u32 vcc, 1, v3
    s_nop 1
    s_and_b64 vcc, vcc, exec
    s_cbranch_scc1 SPIN_SHORT
BACK_SHORT:
    buffer_load_dwordx4 a[0:3], v4, s[40:43], s63 offen offset:0 sc1
    ds_read_b128 v[128:131], v2 offset:2096
    ds_read_b128 v[132:135], v2 offset:2112
    ds_read_b128 v[136:139], v2 offset:2128
    ds_read_b128 v[56:59], v2 offset:1440
    ds_read_b128 v[60:63], v2 offset:1456
    ds_read_b128 v[64:67], v2 offset:1472
    ds_read_b128 v[68:71], v2 offset:1152
    ds_read_b128 v[72:75], v2 offset:1168
    ds_read_b128 v[76:79], v2 offset:1184
    s_waitcnt lgkmcnt(8)
    v_dot2_f32_bf16 v140, v128, v32, 0
    v_dot2_f32_bf16 v141, v128, v44, 0
    buffer_load_dwordx4 a[8:11], v4, s[40:43], s63 offen offset:1024 sc1
    ds_read_b128 v[80:83], v2 offset:864
    s_waitcnt lgkmcnt(6)
    v_dot2_f32_bf16 v142, v128, v56, 0
    s_waitcnt lgkmcnt(3)
    v_dot2_f32_bf16 v143, v128, v68, 0
    ds_read_b128 v[84:87], v2 offset:880
    v_dot2c_f32_bf16 v140, v129, v33
    v_dot2c_f32_bf16 v141, v129, v45
    ds_read_b128 v[88:91], v2 offset:896
    v_dot2c_f32_bf16 v142, v129, v57
    v_dot2c_f32_bf16 v143, v129, v69
    ds_read_b128 v[92:95], v2 offset:576
    v_dot2c_f32_bf16 v140, v130, v34
    v_dot2c_f32_bf16 v141, v130, v46
    buffer_load_dwordx4 a[16:19], v4, s[40:43], s63 offen offset:2048 sc1
    ds_read_b128 v[96:99], v2 offset:592
    v_dot2c_f32_bf16 v142, v130, v58
    v_dot2c_f32_bf16 v143, v130, v70
    ds_read_b128 v[100:103], v2 offset:608
    v_dot2c_f32_bf16 v140, v131, v35
    v_dot2c_f32_bf16 v141, v131, v47
    ds_read_b128 v[104:107], v2 offset:288
    v_dot2c_f32_bf16 v142, v131, v59
    v_dot2c_f32_bf16 v143, v131, v71
    ds_read_b128 v[108:111], v2 offset:304
    v_dot2c_f32_bf16 v140, v132, v36
    v_dot2c_f32_bf16 v141, v132, v48
    buffer_load_dwordx4 a[24:27], v4, s[40:43], s63 offen offset:3072 sc1
    ds_read_b128 v[112:115], v2 offset:320
    v_dot2c_f32_bf16 v142, v132, v60
    s_waitcnt lgkmcnt(10)
    v_dot2c_f32_bf16 v143, v132, v72
    ds_read_b128 v[116:119], v2 offset:0
    v_dot2c_f32_bf16 v140, v133, v37
    v_dot2c_f32_bf16 v141, v133, v49
    ds_read_b128 v[120:123], v2 offset:16
    v_dot2c_f32_bf16 v142, v133, v61
    v_dot2c_f32_bf16 v143, v133, v73
    ds_read_b128 v[124:127], v2 offset:32
    v_dot2c_f32_bf16 v140, v134, v38
    v_dot2c_f32_bf16 v141, v134, v50
    s_xor_b32 s63, s63, 4096
    buffer_load_dwordx4 a[32:35], v4, s[40:43], s63 offen offset:0 sc1
    v_dot2c_f32_bf16 v142, v134, v62
    v_dot2c_f32_bf16 v143, v134, v74
    v_dot2c_f32_bf16 v140, v135, v39
    v_dot2c_f32_bf16 v141, v135, v51
    v_dot2c_f32_bf16 v142, v135, v63
    v_dot2c_f32_bf16 v143, v135, v75
    v_dot2c_f32_bf16 v140, v136, v40
    v_dot2c_f32_bf16 v141, v136, v52
    v_dot2c_f32_bf16 v142, v136, v64
    s_waitcnt lgkmcnt(12)
    v_dot2c_f32_bf16 v143, v136, v76
    s_waitcnt lgkmcnt(11)
    v_dot2_f32_bf16 v144, v128, v80, 0
    buffer_load_dwordx4 a[40:43], v4, s[40:43], s63 offen offset:1024 sc1
    s_waitcnt lgkmcnt(8)
    v_dot2_f32_bf16 v145, v128, v92, 0
    ds_read_b128 v[32:35], v2 offset:2064
    s_waitcnt lgkmcnt(6)
    v_dot2_f32_bf16 v146, v128, v104, 0
    s_waitcnt lgkmcnt(3)
    v_dot2_f32_bf16 v147, v128, v116, 0
    ds_read_b128 v[36:39], v2 offset:2080
    v_dot2c_f32_bf16 v144, v129, v81
    v_dot2c_f32_bf16 v145, v129, v93
    ds_read_b128 v[44:47], v2 offset:1776
    v_dot2c_f32_bf16 v146, v129, v105
    v_dot2c_f32_bf16 v147, v129, v117
    ds_read_b128 v[48:51], v2 offset:1792
    v_dot2c_f32_bf16 v144, v130, v82
    buffer_load_dwordx4 a[48:51], v4, s[40:43], s63 offen offset:2048 sc1
    v_dot2c_f32_bf16 v145, v130, v94
    ds_read_b128 v[56:59], v2 offset:1488
    v_dot2c_f32_bf16 v146, v130, v106
    v_dot2c_f32_bf16 v147, v130, v118
    ds_read_b128 v[60:63], v2 offset:1504
    v_dot2c_f32_bf16 v144, v131, v83
    v_dot2c_f32_bf16 v145, v131, v95
    ds_read_b128 v[68:71], v2 offset:1200
    v_dot2c_f32_bf16 v146, v131, v107
    v_dot2c_f32_bf16 v147, v131, v119
    ds_read_b128 v[72:75], v2 offset:1216
    v_dot2c_f32_bf16 v144, v132, v84
    buffer_load_dwordx4 a[56:59], v4, s[40:43], s63 offen offset:3072 sc1
    v_dot2c_f32_bf16 v145, v132, v96
    v_dot2c_f32_bf16 v146, v132, v108
    s_waitcnt lgkmcnt(9)
    v_dot2c_f32_bf16 v147, v132, v120
    v_dot2c_f32_bf16 v144, v133, v85
    v_dot2c_f32_bf16 v145, v133, v97
    v_dot2c_f32_bf16 v146, v133, v109
    v_dot2c_f32_bf16 v147, v133, v121
    v_dot2c_f32_bf16 v144, v134, v86
    v_dot2c_f32_bf16 v145, v134, v98
    v_dot2c_f32_bf16 v146, v134, v110
    v_dot2c_f32_bf16 v147, v134, v122
    v_dot2c_f32_bf16 v144, v135, v87
    s_xor_b32 s63, s63, 12288
    buffer_load_dwordx4 a[64:67], v4, s[40:43], s63 offen offset:0 sc1
    v_dot2c_f32_bf16 v145, v135, v99
    v_dot2c_f32_bf16 v146, v135, v111
    v_dot2c_f32_bf16 v147, v135, v123
    v_dot2c_f32_bf16 v144, v136, v88
    v_dot2c_f32_bf16 v145, v136, v100
    v_dot2c_f32_bf16 v146, v136, v112
    s_waitcnt lgkmcnt(8)
    v_dot2c_f32_bf16 v147, v136, v124
    v_lshlrev_b32 v8, 16, v138
    v_mul_f32 v8, s98, v8
    v_exp_f32 v8, v8
    v_mov_b32 v9, 0xf149f2ca
    buffer_load_dwordx4 a[72:75], v4, s[40:43], s63 offen offset:1024 sc1
    ds_read_b128 v[80:83], v2 offset:912
    v_cmp_le_u32 vcc, 2, v14
    ds_read_b128 v[84:87], v2 offset:928
    s_nop 0
    v_cndmask_b32 v141, v9, v141, vcc
    v_cmp_le_u32 vcc, 4, v14
    ds_read_b128 v[92:95], v2 offset:624
    s_nop 0
    v_cndmask_b32 v142, v9, v142, vcc
    v_cmp_le_u32 vcc, 6, v14
    ds_read_b128 v[96:99], v2 offset:640
    s_nop 0
    v_cndmask_b32 v143, v9, v143, vcc
    v_cmp_le_u32 vcc, 8, v14
    ds_read_b128 v[104:107], v2 offset:336
    buffer_load_dwordx4 a[80:83], v4, s[40:43], s63 offen offset:2048 sc1
    v_cndmask_b32 v144, v9, v144, vcc
    v_cmp_le_u32 vcc, 10, v14
    ds_read_b128 v[108:111], v2 offset:352
    s_nop 0
    v_cndmask_b32 v145, v9, v145, vcc
    v_cmp_le_u32 vcc, 12, v14
    ds_read_b128 v[116:119], v2 offset:48
    s_nop 0
    v_cndmask_b32 v146, v9, v146, vcc
    v_cmp_le_u32 vcc, 14, v14
    s_waitcnt lgkmcnt(14)
    ds_read_b128 v[120:123], v2 offset:64
    s_nop 0
    v_cndmask_b32 v147, v9, v147, vcc
    v_max3_f32 v9, v140, v141, v142
    v_max3_f32 v10, v143, v144, v145
    buffer_load_dwordx4 a[88:91], v4, s[40:43], s63 offen offset:3072 sc1
    s_xor_b32 s63, s63, 4096
    v_max3_f32 v9, v9, v146, v147
    v_max_f32 v9, v9, v10
    v_mul_f32 v9, s99, v9
    v_add_f32 v8, 1.0, v8
    v_fma_f32 v140, v140, s99, -v9
    v_fma_f32 v141, v141, s99, -v9
    v_fma_f32 v142, v142, s99, -v9
    v_fma_f32 v143, v143, s99, -v9
    v_fma_f32 v144, v144, s99, -v9
    v_fma_f32 v145, v145, s99, -v9
    v_fma_f32 v146, v146, s99, -v9
    v_fma_f32 v147, v147, s99, -v9
    buffer_load_dword v3, v217, s[32:35], s19 offen sc1
    buffer_load_dwordx4 a[96:99], v4, s[40:43], s63 offen offset:0 sc1
    v_exp_f32 v140, v140
    v_exp_f32 v141, v141
    v_exp_f32 v142, v142
    v_exp_f32 v143, v143
    v_exp_f32 v144, v144
    v_exp_f32 v145, v145
    v_exp_f32 v146, v146
    v_exp_f32 v147, v147
    v_add_f32 v10, v140, v141
    v_add_f32 v10, v10, v142
    v_add_f32 v10, v10, v143
    v_add_f32 v10, v10, v144
    v_add_f32 v10, v10, v145
    v_add_f32 v10, v10, v146
    buffer_load_dwordx4 a[104:107], v4, s[40:43], s63 offen offset:1024 sc1
    v_add_f32 v10, v10, v147
    v_mul_f32 v10, v10, v8
    v_rcp_f32 v10, v10
    s_nop 0
    v_mul_f32 v140, v140, v10
    v_mul_f32 v141, v141, v10
    v_mul_f32 v142, v142, v10
    v_mul_f32 v143, v143, v10
    v_mul_f32 v144, v144, v10
    v_mul_f32 v145, v145, v10
    v_mul_f32 v146, v146, v10
    v_mul_f32 v147, v147, v10
    v_cvt_pk_bf16_f32 v148, 0, v140
    v_cvt_pk_bf16_f32 v149, 0, v141
    v_cvt_pk_bf16_f32 v150, 0, v142
    v_cvt_pk_bf16_f32 v151, 0, v143
    buffer_load_dwordx4 a[112:115], v4, s[40:43], s63 offen offset:2048 sc1
    v_cvt_pk_bf16_f32 v152, 0, v144
    v_cvt_pk_bf16_f32 v153, 0, v145
    v_cvt_pk_bf16_f32 v154, 0, v146
    v_cvt_pk_bf16_f32 v155, 0, v147
    v_lshrrev_b32 v140, 16, v148
    v_lshrrev_b32 v141, 16, v149
    v_lshrrev_b32 v142, 16, v150
    v_lshrrev_b32 v143, 16, v151
    v_lshrrev_b32 v144, 16, v152
    v_lshrrev_b32 v145, 16, v153
    v_lshrrev_b32 v146, 16, v154
    v_lshrrev_b32 v147, 16, v155
    v_dot2_f32_bf16 v128, v42, v140, 0
    v_dot2_f32_bf16 v129, v42, v148, 0
    v_dot2_f32_bf16 v130, v43, v140, 0
    buffer_load_dwordx4 a[120:123], v4, s[40:43], s63 offen offset:3072 sc1
    s_xor_b32 s63, s63, 28672
    v_dot2_f32_bf16 v131, v43, v148, 0
    v_dot2_f32_bf16 v132, v32, v140, 0
    v_dot2_f32_bf16 v133, v32, v148, 0
    v_dot2_f32_bf16 v134, v33, v140, 0
    v_dot2_f32_bf16 v135, v33, v148, 0
    v_dot2_f32_bf16 v136, v34, v140, 0
    v_dot2_f32_bf16 v137, v34, v148, 0
    v_dot2_f32_bf16 v138, v35, v140, 0
    v_dot2_f32_bf16 v139, v35, v148, 0
    s_waitcnt lgkmcnt(14)
    v_dot2_f32_bf16 v156, v36, v140, 0
    v_dot2_f32_bf16 v157, v36, v148, 0
    v_dot2_f32_bf16 v158, v37, v140, 0
    v_dot2_f32_bf16 v159, v37, v148, 0
    v_dot2_f32_bf16 v17, v38, v140, 0
    v_dot2_f32_bf16 v18, v38, v148, 0
    s_waitcnt vmcnt(4)
    v_cmp_gt_u32 vcc, 2, v3
    s_nop 1
    s_and_b64 vcc, vcc, exec
    s_cbranch_scc1 SPIN_CTX
BACK_CTX:
    buffer_load_dwordx4 a[4:7], v5, s[40:43], s20 offen offset:0 sc1
    v_dot2c_f32_bf16 v128, v54, v141
    v_dot2c_f32_bf16 v129, v54, v149
    v_dot2c_f32_bf16 v130, v55, v141
    v_dot2c_f32_bf16 v131, v55, v149
    s_waitcnt lgkmcnt(13)
    v_dot2c_f32_bf16 v132, v44, v141
    v_dot2c_f32_bf16 v133, v44, v149
    v_dot2c_f32_bf16 v134, v45, v141
    v_dot2c_f32_bf16 v135, v45, v149
    v_dot2c_f32_bf16 v136, v46, v141
    v_dot2c_f32_bf16 v137, v46, v149
    v_dot2c_f32_bf16 v138, v47, v141
    v_dot2c_f32_bf16 v139, v47, v149
    s_waitcnt lgkmcnt(12)
    v_dot2c_f32_bf16 v156, v48, v141
    buffer_load_dwordx4 a[12:15], v5, s[40:43], s20 offen offset:1024 sc1
    v_dot2c_f32_bf16 v157, v48, v149
    v_dot2c_f32_bf16 v158, v49, v141
    v_dot2c_f32_bf16 v159, v49, v149
    v_dot2c_f32_bf16 v17, v50, v141
    v_dot2c_f32_bf16 v18, v50, v149
    v_dot2c_f32_bf16 v128, v66, v142
    v_dot2c_f32_bf16 v129, v66, v150
    v_dot2c_f32_bf16 v130, v67, v142
    v_dot2c_f32_bf16 v131, v67, v150
    s_waitcnt lgkmcnt(11)
    v_dot2c_f32_bf16 v132, v56, v142
    v_dot2c_f32_bf16 v133, v56, v150
    v_dot2c_f32_bf16 v134, v57, v142
    v_dot2c_f32_bf16 v135, v57, v150
    v_dot2c_f32_bf16 v136, v58, v142
    buffer_load_dwordx4 a[20:23], v5, s[40:43], s20 offen offset:2048 sc1
    v_dot2c_f32_bf16 v137, v58, v150
    v_dot2c_f32_bf16 v138, v59, v142
    v_dot2c_f32_bf16 v139, v59, v150
    s_waitcnt lgkmcnt(10)
    v_dot2c_f32_bf16 v156, v60, v142
    v_dot2c_f32_bf16 v157, v60, v150
    v_dot2c_f32_bf16 v158, v61, v142
    v_dot2c_f32_bf16 v159, v61, v150
    v_dot2c_f32_bf16 v17, v62, v142
    v_dot2c_f32_bf16 v18, v62, v150
    v_dot2c_f32_bf16 v128, v78, v143
    v_dot2c_f32_bf16 v129, v78, v151
    v_dot2c_f32_bf16 v130, v79, v143
    v_dot2c_f32_bf16 v131, v79, v151
    s_waitcnt lgkmcnt(9)
    v_dot2c_f32_bf16 v132, v68, v143
    buffer_load_dwordx4 a[28:31], v5, s[40:43], s20 offen offset:3072 sc1
    v_dot2c_f32_bf16 v133, v68, v151
    v_dot2c_f32_bf16 v134, v69, v143
    v_dot2c_f32_bf16 v135, v69, v151
    v_dot2c_f32_bf16 v136, v70, v143
    v_dot2c_f32_bf16 v137, v70, v151
    v_dot2c_f32_bf16 v138, v71, v143
    v_dot2c_f32_bf16 v139, v71, v151
    s_waitcnt lgkmcnt(8)
    v_dot2c_f32_bf16 v156, v72, v143
    v_dot2c_f32_bf16 v157, v72, v151
    v_dot2c_f32_bf16 v158, v73, v143
    v_dot2c_f32_bf16 v159, v73, v151
    v_dot2c_f32_bf16 v17, v74, v143
    v_dot2c_f32_bf16 v18, v74, v151
    v_dot2c_f32_bf16 v128, v90, v144
    s_xor_b32 s20, s20, 4096
    buffer_load_dwordx4 a[36:39], v5, s[40:43], s20 offen offset:0 sc1
    v_dot2c_f32_bf16 v129, v90, v152
    v_dot2c_f32_bf16 v130, v91, v144
    v_dot2c_f32_bf16 v131, v91, v152
    s_waitcnt lgkmcnt(7)
    v_dot2c_f32_bf16 v132, v80, v144
    v_dot2c_f32_bf16 v133, v80, v152
    v_dot2c_f32_bf16 v134, v81, v144
    v_dot2c_f32_bf16 v135, v81, v152
    v_dot2c_f32_bf16 v136, v82, v144
    v_dot2c_f32_bf16 v137, v82, v152
    v_dot2c_f32_bf16 v138, v83, v144
    v_dot2c_f32_bf16 v139, v83, v152
    s_waitcnt lgkmcnt(6)
    v_dot2c_f32_bf16 v156, v84, v144
    v_dot2c_f32_bf16 v157, v84, v152
    buffer_load_dwordx4 a[44:47], v5, s[40:43], s20 offen offset:1024 sc1
    v_dot2c_f32_bf16 v158, v85, v144
    v_dot2c_f32_bf16 v159, v85, v152
    v_dot2c_f32_bf16 v17, v86, v144
    v_dot2c_f32_bf16 v18, v86, v152
    v_dot2c_f32_bf16 v128, v102, v145
    v_dot2c_f32_bf16 v129, v102, v153
    v_dot2c_f32_bf16 v130, v103, v145
    v_dot2c_f32_bf16 v131, v103, v153
    s_waitcnt lgkmcnt(5)
    v_dot2c_f32_bf16 v132, v92, v145
    v_dot2c_f32_bf16 v133, v92, v153
    v_dot2c_f32_bf16 v134, v93, v145
    v_dot2c_f32_bf16 v135, v93, v153
    v_dot2c_f32_bf16 v136, v94, v145
    v_dot2c_f32_bf16 v137, v94, v153
    buffer_load_dwordx4 a[52:55], v5, s[40:43], s20 offen offset:2048 sc1
    v_dot2c_f32_bf16 v138, v95, v145
    v_dot2c_f32_bf16 v139, v95, v153
    s_waitcnt lgkmcnt(4)
    v_dot2c_f32_bf16 v156, v96, v145
    v_dot2c_f32_bf16 v157, v96, v153
    v_dot2c_f32_bf16 v158, v97, v145
    v_dot2c_f32_bf16 v159, v97, v153
    v_dot2c_f32_bf16 v17, v98, v145
    v_dot2c_f32_bf16 v18, v98, v153
    v_dot2c_f32_bf16 v128, v114, v146
    v_dot2c_f32_bf16 v129, v114, v154
    v_dot2c_f32_bf16 v130, v115, v146
    v_dot2c_f32_bf16 v131, v115, v154
    s_waitcnt lgkmcnt(3)
    v_dot2c_f32_bf16 v132, v104, v146
    v_dot2c_f32_bf16 v133, v104, v154
    buffer_load_dwordx4 a[60:63], v5, s[40:43], s20 offen offset:3072 sc1
    s_xor_b32 s20, s20, 12288
    v_dot2c_f32_bf16 v134, v105, v146
    v_dot2c_f32_bf16 v135, v105, v154
    v_dot2c_f32_bf16 v136, v106, v146
    v_dot2c_f32_bf16 v137, v106, v154
    v_dot2c_f32_bf16 v138, v107, v146
    v_dot2c_f32_bf16 v139, v107, v154
    s_waitcnt lgkmcnt(2)
    v_dot2c_f32_bf16 v156, v108, v146
    v_dot2c_f32_bf16 v157, v108, v154
    v_dot2c_f32_bf16 v158, v109, v146
    v_dot2c_f32_bf16 v159, v109, v154
    v_dot2c_f32_bf16 v17, v110, v146
    v_dot2c_f32_bf16 v18, v110, v154
    v_dot2c_f32_bf16 v128, v126, v147
    v_dot2c_f32_bf16 v129, v126, v155
    v_dot2c_f32_bf16 v130, v127, v147
    v_dot2c_f32_bf16 v131, v127, v155
    s_waitcnt lgkmcnt(1)
    v_dot2c_f32_bf16 v132, v116, v147
    v_dot2c_f32_bf16 v133, v116, v155
    v_dot2c_f32_bf16 v134, v117, v147
    v_dot2c_f32_bf16 v135, v117, v155
    v_dot2c_f32_bf16 v136, v118, v147
    v_dot2c_f32_bf16 v137, v118, v155
    v_dot2c_f32_bf16 v138, v119, v147
    v_dot2c_f32_bf16 v139, v119, v155
    s_waitcnt lgkmcnt(0)
    v_dot2c_f32_bf16 v156, v120, v147
    v_dot2c_f32_bf16 v157, v120, v155
    v_dot2c_f32_bf16 v158, v121, v147
    v_dot2c_f32_bf16 v159, v121, v155
    v_dot2c_f32_bf16 v17, v122, v147
    v_dot2c_f32_bf16 v18, v122, v155
    v_mov_b32 v89, 0
    v_mov_b32 v90, 0
    v_mov_b32 v91, 0
    v_cvt_pk_bf16_f32 v80, v128, v129
    v_cvt_pk_bf16_f32 v81, v130, v131
    v_cvt_pk_bf16_f32 v82, v132, v133
    v_cvt_pk_bf16_f32 v83, v134, v135
    v_cvt_pk_bf16_f32 v84, v136, v137
    v_cvt_pk_bf16_f32 v85, v138, v139
    v_cvt_pk_bf16_f32 v86, v156, v157
    v_cvt_pk_bf16_f32 v87, v158, v159
    v_cvt_pk_bf16_f32 v88, v17, v18
    v_cmp_gt_u32 vcc, 1, v28
    s_nop 1
    s_and_b64 vcc, vcc, exec
    s_cbranch_scc1 SPIN_ALL
BACK_ALL:
    s_waitcnt vmcnt(4)
    s_barrier
    ds_read_b128 v[104:107], v11 offset:0
    ds_read_b128 v[108:111], v11 offset:8192
    ds_read_b128 v[112:115], v11 offset:1024
    ds_read_b128 v[116:119], v11 offset:9216
    s_waitcnt lgkmcnt(3)
    v_mfma_f32_16x16x32_bf16 v[176:179], v[104:107], a[0:3], 0
    s_lshl3_add_u32 s98, 1, s5
    ds_read_b128 v[120:123], v11 offset:2048
    ds_read_b128 v[124:127], v11 offset:10240
    s_waitcnt lgkmcnt(4)
    v_mfma_f32_16x16x32_bf16 v[176:179], v[108:111], a[8:11], v[176:179]
    s_and_b32 s98, s98, 31
    buffer_load_dwordx4 a[68:71], v5, s[40:43], s20 offen offset:0 sc1
    v_mfma_f32_16x16x32_bf16 v[180:183], v[104:107], a[4:7], 0
    s_lshl_b32 s8, s6, 5
    ds_read_b128 v[128:131], v11 offset:3072
    ds_read_b128 v[132:135], v11 offset:11264
    v_mfma_f32_16x16x32_bf16 v[180:183], v[108:111], a[12:15], v[180:183]
    s_add_u32 s98, s98, s8
    ds_read_b128 v[136:139], v11 offset:4096
    s_waitcnt lgkmcnt(6)
    v_mfma_f32_16x16x32_bf16 v[184:187], v[112:115], a[0:3], 0
    s_mul_i32 s98, s98, 3
    buffer_load_dwordx4 a[76:79], v5, s[40:43], s20 offen offset:1024 sc1
    s_waitcnt lgkmcnt(5)
    v_mfma_f32_16x16x32_bf16 v[184:187], v[116:119], a[8:11], v[184:187]
    s_sub_u32 s98, s98, 1
    ds_read_b128 v[140:143], v11 offset:12288
    ds_read_b128 v[144:147], v11 offset:5120
    v_mfma_f32_16x16x32_bf16 v[188:191], v[112:115], a[4:7], 0
    s_add_u32 s98, s98, 3
    ds_read_b128 v[148:151], v11 offset:13312
    v_mfma_f32_16x16x32_bf16 v[188:191], v[116:119], a[12:15], v[188:191]
    s_lshl2_add_u32 s98, s98, s4
    ds_read_b128 v[104:107], v11 offset:6144
    s_waitcnt lgkmcnt(5)
    v_mfma_f32_16x16x32_bf16 v[192:195], v[120:123], a[0:3], 0
    s_mul_i32 s8, s98, 3072
    buffer_load_dwordx4 a[84:87], v5, s[40:43], s20 offen offset:2048 sc1
    v_mfma_f32_16x16x32_bf16 v[192:195], v[124:127], a[8:11], v[192:195]
    s_lshl3_add_u32 s98, 2, s5
    ds_read_b128 v[108:111], v11 offset:14336
    ds_read_b128 v[112:115], v11 offset:16384
    v_mfma_f32_16x16x32_bf16 v[196:199], v[120:123], a[4:7], 0
    s_and_b32 s98, s98, 31
    ds_read_b128 v[116:119], v11 offset:24576
    v_mfma_f32_16x16x32_bf16 v[196:199], v[124:127], a[12:15], v[196:199]
    s_lshl_b32 s9, s6, 5
    ds_read_b128 v[120:123], v11 offset:17408
    v_mfma_f32_16x16x32_bf16 v[200:203], v[128:131], a[0:3], 0
    s_add_u32 s98, s98, s9
    buffer_load_dwordx4 a[92:95], v5, s[40:43], s20 offen offset:3072 sc1
    v_mfma_f32_16x16x32_bf16 v[200:203], v[132:135], a[8:11], v[200:203]
    s_xor_b32 s20, s20, 4096
    ds_read_b128 v[124:127], v11 offset:25600
    v_mfma_f32_16x16x32_bf16 v[204:207], v[128:131], a[4:7], 0
    s_mul_i32 s98, s98, 3
    ds_read_b128 v[128:131], v11 offset:18432
    v_mfma_f32_16x16x32_bf16 v[204:207], v[132:135], a[12:15], v[204:207]
    s_sub_u32 s98, s98, 2
    ds_read_b128 v[132:135], v11 offset:26624
    s_waitcnt lgkmcnt(4)
    v_mfma_f32_16x16x32_bf16 v[208:211], v[136:139], a[0:3], 0
    s_add_u32 s98, s98, 3
    buffer_store_dwordx4 v[80:83], v15, s[40:43], s71 offen offset:0 sc1
    v_mfma_f32_16x16x32_bf16 v[208:211], v[140:143], a[8:11], v[208:211]
    s_lshl2_add_u32 s98, s98, s4
    v_mfma_f32_16x16x32_bf16 v[212:215], v[136:139], a[4:7], 0
    s_mul_i32 s9, s98, 3072
    ds_read_b128 v[136:139], v11 offset:19456
    v_mfma_f32_16x16x32_bf16 v[212:215], v[140:143], a[12:15], v[212:215]
    s_lshl3_add_u32 s98, 3, s5
    ds_read_b128 v[140:143], v11 offset:27648
    v_mfma_f32_16x16x32_bf16 v[216:219], v[144:147], a[0:3], 0
    s_and_b32 s98, s98, 31
    buffer_store_dwordx4 v[84:87], v15, s[40:43], s71 offen offset:256 sc1
    v_mfma_f32_16x16x32_bf16 v[216:219], v[148:151], a[8:11], v[216:219]
    s_lshl_b32 s10, s6, 5
    v_mfma_f32_16x16x32_bf16 v[220:223], v[144:147], a[4:7], 0
    s_add_u32 s98, s98, s10
    ds_read_b128 v[144:147], v11 offset:20480
    v_mfma_f32_16x16x32_bf16 v[220:223], v[148:151], a[12:15], v[220:223]
    s_mul_i32 s98, s98, 3
    ds_read_b128 v[148:151], v11 offset:28672
    v_mfma_f32_16x16x32_bf16 v[224:227], v[104:107], a[0:3], 0
    s_sub_u32 s98, s98, 3
    v_mfma_f32_16x16x32_bf16 v[224:227], v[108:111], a[8:11], v[224:227]
    s_add_u32 s98, s98, 3
    buffer_store_dwordx4 v[88:91], v15, s[40:43], s71 offen offset:512 sc1
    v_mfma_f32_16x16x32_bf16 v[228:231], v[104:107], a[4:7], 0
    s_xor_b32 s21, s3, 3
    ds_read_b128 v[104:107], v11 offset:21504
    v_mfma_f32_16x16x32_bf16 v[228:231], v[108:111], a[12:15], v[228:231]
    s_lshl2_add_u32 s21, s21, s4
    ds_read_b128 v[108:111], v11 offset:29696
    v_mfma_f32_16x16x32_bf16 v[176:179], v[112:115], a[16:19], v[176:179]
    s_mul_i32 s21, s21, 36864
    v_mfma_f32_16x16x32_bf16 v[176:179], v[116:119], a[24:27], v[176:179]
    s_add_u32 s21, s21, s28
    s_mov_b32 m0, s47
    v_mfma_f32_16x16x32_bf16 v[180:183], v[112:115], a[20:23], v[180:183]
    s_lshl2_add_u32 s98, s98, s4
    buffer_load_dwordx4 v1, s[56:59], s21 offen sc1 lds
    v_mfma_f32_16x16x32_bf16 v[180:183], v[116:119], a[28:31], v[180:183]
    s_mul_i32 s10, s98, 3072
    ds_read_b128 v[112:115], v11 offset:22528
    ds_read_b128 v[116:119], v11 offset:30720
    s_waitcnt lgkmcnt(3)
    v_mfma_f32_16x16x32_bf16 v[184:187], v[120:123], a[16:19], v[184:187]
    s_sub_u32 s99, s4, s61
    v_mfma_f32_16x16x32_bf16 v[184:187], v[124:127], a[24:27], v[184:187]
    s_and_b32 s99, s99, 3
    buffer_load_dwordx4 v1, s[56:59], s21 offen offset:1024 sc1 lds
    v_mfma_f32_16x16x32_bf16 v[188:191], v[120:123], a[20:23], v[188:191]
    s_lshl3_add_u32 s98, s99, s5
    ds_read_b128 v[120:123], v12 offset:0
    v_mfma_f32_16x16x32_bf16 v[188:191], v[124:127], a[28:31], v[188:191]
    s_and_b32 s98, s98, 31
    ds_read_b128 v[124:127], v12 offset:8192
    v_mfma_f32_16x16x32_bf16 v[192:195], v[128:131], a[16:19], v[192:195]
    s_lshl_b32 s11, s6, 5
    v_mfma_f32_16x16x32_bf16 v[192:195], v[132:135], a[24:27], v[192:195]
    s_add_u32 s98, s98, s11
    buffer_load_dwordx4 v1, s[56:59], s21 offen offset:2048 sc1 lds
    v_mfma_f32_16x16x32_bf16 v[196:199], v[128:131], a[20:23], v[196:199]
    s_mul_i32 s98, s98, 3
    ds_read_b128 v[128:131], v12 offset:1024
    v_mfma_f32_16x16x32_bf16 v[196:199], v[132:135], a[28:31], v[196:199]
    s_sub_u32 s98, s98, s99
    ds_read_b128 v[132:135], v12 offset:9216
    v_mfma_f32_16x16x32_bf16 v[200:203], v[136:139], a[16:19], v[200:203]
    s_add_u32 s98, s98, 3
    v_mfma_f32_16x16x32_bf16 v[200:203], v[140:143], a[24:27], v[200:203]
    s_lshl2_add_u32 s98, s98, s4
    buffer_load_dwordx4 v1, s[56:59], s21 offen offset:3072 sc1 lds
    v_mfma_f32_16x16x32_bf16 v[204:207], v[136:139], a[20:23], v[204:207]
    s_add_u32 s21, s21, 4096
    ds_read_b128 v[136:139], v12 offset:2048
    v_mfma_f32_16x16x32_bf16 v[204:207], v[140:143], a[28:31], v[204:207]
    s_waitcnt vmcnt(11)
    ds_read_b128 v[140:143], v12 offset:10240
    v_mfma_f32_16x16x32_bf16 v[208:211], v[144:147], a[16:19], v[208:211]
    s_add_u32 m0, s47, 4096
    v_mfma_f32_16x16x32_bf16 v[208:211], v[148:151], a[24:27], v[208:211]
    s_mul_i32 s11, s98, 3072
    buffer_load_dwordx4 v1, s[56:59], s21 offen sc1 lds
    v_mfma_f32_16x16x32_bf16 v[212:215], v[144:147], a[20:23], v[212:215]
    ds_read_b128 v[144:147], v12 offset:3072
    v_mfma_f32_16x16x32_bf16 v[212:215], v[148:151], a[28:31], v[212:215]
    ds_read_b128 v[148:151], v12 offset:11264
    v_mfma_f32_16x16x32_bf16 v[216:219], v[104:107], a[16:19], v[216:219]
    s_cmp_eq_u32 s99, 0
    s_cselect_b32 s11, 1073741824, s11
    s_waitcnt lgkmcnt(2)
    v_mfma_f32_16x16x32_bf16 v[216:219], v[108:111], a[24:27], v[216:219]
    buffer_load_dwordx4 v1, s[56:59], s21 offen offset:1024 sc1 lds
    v_mfma_f32_16x16x32_bf16 v[220:223], v[104:107], a[20:23], v[220:223]
    ds_read_b128 v[104:107], v12 offset:4096
    v_mfma_f32_16x16x32_bf16 v[220:223], v[108:111], a[28:31], v[220:223]
    ds_read_b128 v[108:111], v12 offset:12288
    v_mfma_f32_16x16x32_bf16 v[224:227], v[112:115], a[16:19], v[224:227]
    v_mfma_f32_16x16x32_bf16 v[224:227], v[116:119], a[24:27], v[224:227]
    v_mfma_f32_16x16x32_bf16 v[228:231], v[112:115], a[20:23], v[228:231]
    buffer_load_dwordx4 v1, s[56:59], s21 offen offset:2048 sc1 lds
    v_mfma_f32_16x16x32_bf16 v[228:231], v[116:119], a[28:31], v[228:231]
    ds_read_b128 v[112:115], v12 offset:5120
    ds_read_b128 v[116:119], v12 offset:13312
    v_mfma_f32_16x16x32_bf16 v[176:179], v[120:123], a[32:35], v[176:179]
    v_mfma_f32_16x16x32_bf16 v[176:179], v[124:127], a[40:43], v[176:179]
    v_mfma_f32_16x16x32_bf16 v[180:183], v[120:123], a[36:39], v[180:183]
    buffer_load_dwordx4 a[100:103], v5, s[40:43], s20 offen offset:0 sc1
    v_mfma_f32_16x16x32_bf16 v[180:183], v[124:127], a[44:47], v[180:183]
    ds_read_b128 v[120:123], v12 offset:6144
    ds_read_b128 v[124:127], v12 offset:14336
    v_mfma_f32_16x16x32_bf16 v[184:187], v[128:131], a[32:35], v[184:187]
    v_mfma_f32_16x16x32_bf16 v[184:187], v[132:135], a[40:43], v[184:187]
    v_mfma_f32_16x16x32_bf16 v[188:191], v[128:131], a[36:39], v[188:191]
    buffer_load_dwordx4 a[108:111], v5, s[40:43], s20 offen offset:1024 sc1
    v_mfma_f32_16x16x32_bf16 v[188:191], v[132:135], a[44:47], v[188:191]
    ds_read_b128 v[128:131], v12 offset:16384
    ds_read_b128 v[132:135], v12 offset:24576
    v_mfma_f32_16x16x32_bf16 v[192:195], v[136:139], a[32:35], v[192:195]
    v_mfma_f32_16x16x32_bf16 v[192:195], v[140:143], a[40:43], v[192:195]
    v_mfma_f32_16x16x32_bf16 v[196:199], v[136:139], a[36:39], v[196:199]
    buffer_load_dwordx4 a[116:119], v5, s[40:43], s20 offen offset:2048 sc1
    v_mfma_f32_16x16x32_bf16 v[196:199], v[140:143], a[44:47], v[196:199]
    s_waitcnt lgkmcnt(2)
    ds_read_b128 v[136:139], v12 offset:17408
    ds_read_b128 v[140:143], v12 offset:25600
    v_mfma_f32_16x16x32_bf16 v[200:203], v[144:147], a[32:35], v[200:203]
    v_mfma_f32_16x16x32_bf16 v[200:203], v[148:151], a[40:43], v[200:203]
    v_mfma_f32_16x16x32_bf16 v[204:207], v[144:147], a[36:39], v[204:207]
    buffer_load_dwordx4 a[124:127], v5, s[40:43], s20 offen offset:3072 sc1
    v_mfma_f32_16x16x32_bf16 v[204:207], v[148:151], a[44:47], v[204:207]
    ds_read_b128 v[144:147], v12 offset:18432
    ds_read_b128 v[148:151], v12 offset:26624
    v_mfma_f32_16x16x32_bf16 v[208:211], v[104:107], a[32:35], v[208:211]
    s_xor_b32 s21, s3, 4
    v_mfma_f32_16x16x32_bf16 v[208:211], v[108:111], a[40:43], v[208:211]
    s_lshl2_add_u32 s21, s21, s4
    v_mfma_f32_16x16x32_bf16 v[212:215], v[104:107], a[36:39], v[212:215]
    s_mul_i32 s21, s21, 36864
    ds_read_b128 v[104:107], v12 offset:19456
    v_mfma_f32_16x16x32_bf16 v[212:215], v[108:111], a[44:47], v[212:215]
    s_add_u32 s21, s21, s28
    s_mov_b32 m0, s79
    ds_read_b128 v[108:111], v12 offset:27648
    v_mfma_f32_16x16x32_bf16 v[216:219], v[112:115], a[32:35], v[216:219]
    s_xor_b32 s20, s20, 28672
    buffer_load_dwordx4 v1, s[56:59], s21 offen sc1 lds
    v_mfma_f32_16x16x32_bf16 v[216:219], v[116:119], a[40:43], v[216:219]
    v_mfma_f32_16x16x32_bf16 v[220:223], v[112:115], a[36:39], v[220:223]
    ds_read_b128 v[112:115], v12 offset:20480
    v_mfma_f32_16x16x32_bf16 v[220:223], v[116:119], a[44:47], v[220:223]
    buffer_load_dwordx4 v1, s[56:59], s21 offen offset:1024 sc1 lds
    v_mfma_f32_16x16x32_bf16 v[224:227], v[120:123], a[32:35], v[224:227]
    ds_read_b128 v[116:119], v12 offset:28672
    v_mfma_f32_16x16x32_bf16 v[224:227], v[124:127], a[40:43], v[224:227]
    v_mfma_f32_16x16x32_bf16 v[228:231], v[120:123], a[36:39], v[228:231]
    ds_read_b128 v[120:123], v12 offset:21504
    v_mfma_f32_16x16x32_bf16 v[228:231], v[124:127], a[44:47], v[228:231]
    s_waitcnt lgkmcnt(2)
    buffer_load_dwordx4 v1, s[56:59], s21 offen offset:2048 sc1 lds
    v_mfma_f32_16x16x32_bf16 v[176:179], v[128:131], a[48:51], v[176:179]
    ds_read_b128 v[124:127], v12 offset:29696
    v_mfma_f32_16x16x32_bf16 v[176:179], v[132:135], a[56:59], v[176:179]
    v_mfma_f32_16x16x32_bf16 v[180:183], v[128:131], a[52:55], v[180:183]
    ds_read_b128 v[128:131], v12 offset:22528
    v_mfma_f32_16x16x32_bf16 v[180:183], v[132:135], a[60:63], v[180:183]
    buffer_load_dwordx4 v1, s[56:59], s21 offen offset:3072 sc1 lds
    v_mfma_f32_16x16x32_bf16 v[184:187], v[136:139], a[48:51], v[184:187]
    s_add_u32 s21, s21, 4096
    ds_read_b128 v[132:135], v12 offset:30720
    v_mfma_f32_16x16x32_bf16 v[184:187], v[140:143], a[56:59], v[184:187]
    s_add_u32 m0, s79, 4096
    v_mfma_f32_16x16x32_bf16 v[188:191], v[136:139], a[52:55], v[188:191]
    ds_read_b128 v[136:139], v13 offset:0
    v_mfma_f32_16x16x32_bf16 v[188:191], v[140:143], a[60:63], v[188:191]
    buffer_load_dwordx4 v1, s[56:59], s21 offen sc1 lds
    v_mfma_f32_16x16x32_bf16 v[192:195], v[144:147], a[48:51], v[192:195]
    ds_read_b128 v[140:143], v13 offset:8192
    v_mfma_f32_16x16x32_bf16 v[192:195], v[148:151], a[56:59], v[192:195]
    v_mfma_f32_16x16x32_bf16 v[196:199], v[144:147], a[52:55], v[196:199]
    ds_read_b128 v[144:147], v13 offset:1024
    v_mfma_f32_16x16x32_bf16 v[196:199], v[148:151], a[60:63], v[196:199]
    buffer_load_dwordx4 v1, s[56:59], s21 offen offset:1024 sc1 lds
    v_mfma_f32_16x16x32_bf16 v[200:203], v[104:107], a[48:51], v[200:203]
    ds_read_b128 v[148:151], v13 offset:9216
    v_mfma_f32_16x16x32_bf16 v[200:203], v[108:111], a[56:59], v[200:203]
    v_mfma_f32_16x16x32_bf16 v[204:207], v[104:107], a[52:55], v[204:207]
    ds_read_b128 v[104:107], v13 offset:2048
    v_mfma_f32_16x16x32_bf16 v[204:207], v[108:111], a[60:63], v[204:207]
    s_waitcnt vmcnt(20)
    s_barrier
    ds_read_b128 v[108:111], v13 offset:10240
    v_mfma_f32_16x16x32_bf16 v[208:211], v[112:115], a[48:51], v[208:211]
    s_waitcnt lgkmcnt(3)
    buffer_load_dwordx4 v1, s[56:59], s21 offen offset:2048 sc1 lds
    v_mfma_f32_16x16x32_bf16 v[208:211], v[116:119], a[56:59], v[208:211]
    v_mfma_f32_16x16x32_bf16 v[212:215], v[112:115], a[52:55], v[212:215]
    ds_read_b128 v[112:115], v13 offset:3072
    v_mfma_f32_16x16x32_bf16 v[212:215], v[116:119], a[60:63], v[212:215]
    ds_read_b128 v[116:119], v13 offset:11264
    v_mfma_f32_16x16x32_bf16 v[216:219], v[120:123], a[48:51], v[216:219]
    buffer_load_dwordx4 a[128:131], v4, s[40:43], s63 offen offset:0 sc1
    v_mfma_f32_16x16x32_bf16 v[216:219], v[124:127], a[56:59], v[216:219]
    v_mfma_f32_16x16x32_bf16 v[220:223], v[120:123], a[52:55], v[220:223]
    ds_read_b128 v[120:123], v13 offset:4096
    v_mfma_f32_16x16x32_bf16 v[220:223], v[124:127], a[60:63], v[220:223]
    ds_read_b128 v[124:127], v13 offset:12288
    v_mfma_f32_16x16x32_bf16 v[224:227], v[128:131], a[48:51], v[224:227]
    buffer_load_dwordx4 a[136:139], v4, s[40:43], s63 offen offset:1024 sc1
    v_mfma_f32_16x16x32_bf16 v[224:227], v[132:135], a[56:59], v[224:227]
    v_mfma_f32_16x16x32_bf16 v[228:231], v[128:131], a[52:55], v[228:231]
    ds_read_b128 v[128:131], v13 offset:5120
    v_mfma_f32_16x16x32_bf16 v[228:231], v[132:135], a[60:63], v[228:231]
    ds_read_b128 v[132:135], v13 offset:13312
    v_mfma_f32_16x16x32_bf16 v[176:179], v[136:139], a[64:67], v[176:179]
    buffer_load_dwordx4 a[144:147], v4, s[40:43], s63 offen offset:2048 sc1
    v_mfma_f32_16x16x32_bf16 v[176:179], v[140:143], a[72:75], v[176:179]
    v_mfma_f32_16x16x32_bf16 v[180:183], v[136:139], a[68:71], v[180:183]
    ds_read_b128 v[136:139], v13 offset:6144
    v_mfma_f32_16x16x32_bf16 v[180:183], v[140:143], a[76:79], v[180:183]
    ds_read_b128 v[140:143], v13 offset:14336
    v_mfma_f32_16x16x32_bf16 v[184:187], v[144:147], a[64:67], v[184:187]
    s_waitcnt lgkmcnt(2)
    buffer_load_dwordx4 a[152:155], v4, s[40:43], s63 offen offset:3072 sc1
    v_mfma_f32_16x16x32_bf16 v[184:187], v[148:151], a[72:75], v[184:187]
    s_xor_b32 s63, s63, 4096
    v_mfma_f32_16x16x32_bf16 v[188:191], v[144:147], a[68:71], v[188:191]
    ds_read_b128 v[144:147], v13 offset:16384
    v_mfma_f32_16x16x32_bf16 v[188:191], v[148:151], a[76:79], v[188:191]
    ds_read_b128 v[148:151], v13 offset:24576
    v_mfma_f32_16x16x32_bf16 v[192:195], v[104:107], a[64:67], v[192:195]
    buffer_load_dwordx4 a[132:135], v5, s[40:43], s20 offen offset:0 sc1
    v_mfma_f32_16x16x32_bf16 v[192:195], v[108:111], a[72:75], v[192:195]
    v_mfma_f32_16x16x32_bf16 v[196:199], v[104:107], a[68:71], v[196:199]
    ds_read_b128 v[104:107], v13 offset:17408
    v_mfma_f32_16x16x32_bf16 v[196:199], v[108:111], a[76:79], v[196:199]
    ds_read_b128 v[108:111], v13 offset:25600
    v_mfma_f32_16x16x32_bf16 v[200:203], v[112:115], a[64:67], v[200:203]
    v_mfma_f32_16x16x32_bf16 v[200:203], v[116:119], a[72:75], v[200:203]
    buffer_load_dwordx4 a[140:143], v5, s[40:43], s20 offen offset:1024 sc1
    v_mfma_f32_16x16x32_bf16 v[204:207], v[112:115], a[68:71], v[204:207]
    ds_read_b128 v[112:115], v13 offset:18432
    v_mfma_f32_16x16x32_bf16 v[204:207], v[116:119], a[76:79], v[204:207]
    ds_read_b128 v[116:119], v13 offset:26624
    v_mfma_f32_16x16x32_bf16 v[208:211], v[120:123], a[64:67], v[208:211]
    v_mfma_f32_16x16x32_bf16 v[208:211], v[124:127], a[72:75], v[208:211]
    buffer_load_dwordx4 a[148:151], v5, s[40:43], s20 offen offset:2048 sc1
    v_mfma_f32_16x16x32_bf16 v[212:215], v[120:123], a[68:71], v[212:215]
    ds_read_b128 v[120:123], v13 offset:19456
    v_mfma_f32_16x16x32_bf16 v[212:215], v[124:127], a[76:79], v[212:215]
    ds_read_b128 v[124:127], v13 offset:27648
    v_mfma_f32_16x16x32_bf16 v[216:219], v[128:131], a[64:67], v[216:219]
    v_mfma_f32_16x16x32_bf16 v[216:219], v[132:135], a[72:75], v[216:219]
    buffer_load_dwordx4 a[156:159], v5, s[40:43], s20 offen offset:3072 sc1
    v_mfma_f32_16x16x32_bf16 v[220:223], v[128:131], a[68:71], v[220:223]
    s_xor_b32 s21, s3, 5
    ds_read_b128 v[128:131], v13 offset:20480
    v_mfma_f32_16x16x32_bf16 v[220:223], v[132:135], a[76:79], v[220:223]
    s_lshl2_add_u32 s21, s21, s4
    ds_read_b128 v[132:135], v13 offset:28672
    s_waitcnt lgkmcnt(3)
    v_mfma_f32_16x16x32_bf16 v[224:227], v[136:139], a[64:67], v[224:227]
    s_mul_i32 s21, s21, 36864
    v_mfma_f32_16x16x32_bf16 v[224:227], v[140:143], a[72:75], v[224:227]
    s_add_u32 s21, s21, s28
    s_mov_b32 m0, s44
    v_mfma_f32_16x16x32_bf16 v[228:231], v[136:139], a[68:71], v[228:231]
    s_xor_b32 s20, s20, 4096
    buffer_load_dwordx4 v1, s[56:59], s21 offen sc1 lds
    v_mfma_f32_16x16x32_bf16 v[228:231], v[140:143], a[76:79], v[228:231]
    ds_read_b128 v[136:139], v13 offset:21504
    ds_read_b128 v[140:143], v13 offset:29696
    v_mfma_f32_16x16x32_bf16 v[176:179], v[144:147], a[80:83], v[176:179]
    v_mfma_f32_16x16x32_bf16 v[176:179], v[148:151], a[88:91], v[176:179]
    buffer_load_dwordx4 v1, s[56:59], s21 offen offset:1024 sc1 lds
    v_mfma_f32_16x16x32_bf16 v[180:183], v[144:147], a[84:87], v[180:183]
    ds_read_b128 v[144:147], v13 offset:22528
    v_mfma_f32_16x16x32_bf16 v[180:183], v[148:151], a[92:95], v[180:183]
    ds_read_b128 v[148:151], v13 offset:30720
    v_mfma_f32_16x16x32_bf16 v[184:187], v[104:107], a[80:83], v[184:187]
    v_mfma_f32_16x16x32_bf16 v[184:187], v[108:111], a[88:91], v[184:187]
    buffer_load_dwordx4 v1, s[56:59], s21 offen offset:2048 sc1 lds
    v_mfma_f32_16x16x32_bf16 v[188:191], v[104:107], a[84:87], v[188:191]
    v_mfma_f32_16x16x32_bf16 v[188:191], v[108:111], a[92:95], v[188:191]
    v_mfma_f32_16x16x32_bf16 v[192:195], v[112:115], a[80:83], v[192:195]
    v_mfma_f32_16x16x32_bf16 v[192:195], v[116:119], a[88:91], v[192:195]
    v_mfma_f32_16x16x32_bf16 v[196:199], v[112:115], a[84:87], v[196:199]
    buffer_load_dwordx4 v1, s[56:59], s21 offen offset:3072 sc1 lds
    v_mfma_f32_16x16x32_bf16 v[196:199], v[116:119], a[92:95], v[196:199]
    s_add_u32 s21, s21, 4096
    v_mfma_f32_16x16x32_bf16 v[200:203], v[120:123], a[80:83], v[200:203]
    s_add_u32 m0, s44, 4096
    s_waitcnt lgkmcnt(0)
    v_mfma_f32_16x16x32_bf16 v[200:203], v[124:127], a[88:91], v[200:203]
    v_mfma_f32_16x16x32_bf16 v[204:207], v[120:123], a[84:87], v[204:207]
    buffer_load_dwordx4 v1, s[56:59], s21 offen sc1 lds
    v_mfma_f32_16x16x32_bf16 v[204:207], v[124:127], a[92:95], v[204:207]
    s_waitcnt vmcnt(20)
    s_barrier
    v_mov_b32 v31, 3
    v_mfma_f32_16x16x32_bf16 v[208:211], v[128:131], a[80:83], v[208:211]
    buffer_store_dword v31, v30, s[32:35], s101 offen sc1
    v_mfma_f32_16x16x32_bf16 v[208:211], v[132:135], a[88:91], v[208:211]
    ds_read_b128 v[104:107], v6 offset:0
    ds_read_b128 v[108:111], v6 offset:8192
    v_mfma_f32_16x16x32_bf16 v[212:215], v[128:131], a[84:87], v[212:215]
    buffer_load_dwordx4 v1, s[56:59], s21 offen offset:1024 sc1 lds
    v_mfma_f32_16x16x32_bf16 v[212:215], v[132:135], a[92:95], v[212:215]
    ds_read_b128 v[112:115], v6 offset:1024
    ds_read_b128 v[116:119], v6 offset:9216
    v_mfma_f32_16x16x32_bf16 v[216:219], v[136:139], a[80:83], v[216:219]
    ds_read_b128 v[120:123], v6 offset:2048
    v_mfma_f32_16x16x32_bf16 v[216:219], v[140:143], a[88:91], v[216:219]
    ds_read_b128 v[124:127], v6 offset:10240
    v_mfma_f32_16x16x32_bf16 v[220:223], v[136:139], a[84:87], v[220:223]
    buffer_load_dwordx4 v1, s[56:59], s21 offen offset:2048 sc1 lds
    v_mfma_f32_16x16x32_bf16 v[220:223], v[140:143], a[92:95], v[220:223]
    ds_read_b128 v[128:131], v6 offset:3072
    ds_read_b128 v[132:135], v6 offset:11264
    v_mfma_f32_16x16x32_bf16 v[224:227], v[144:147], a[80:83], v[224:227]
    ds_read_b128 v[136:139], v6 offset:4096
    v_mfma_f32_16x16x32_bf16 v[224:227], v[148:151], a[88:91], v[224:227]
    ds_read_b128 v[140:143], v6 offset:12288
    v_mfma_f32_16x16x32_bf16 v[228:231], v[144:147], a[84:87], v[228:231]
    buffer_load_dwordx4 a[160:163], v4, s[40:43], s63 offen offset:0 sc1
    v_mfma_f32_16x16x32_bf16 v[228:231], v[148:151], a[92:95], v[228:231]
    s_waitcnt lgkmcnt(4)
    ds_read_b128 v[144:147], v6 offset:5120
    ds_read_b128 v[148:151], v6 offset:13312
    v_mfma_f32_16x16x32_bf16 v[176:179], v[104:107], a[96:99], v[176:179]
    v_mfma_f32_16x16x32_bf16 v[176:179], v[108:111], a[104:107], v[176:179]
    v_mfma_f32_16x16x32_bf16 v[180:183], v[104:107], a[100:103], v[180:183]
    buffer_load_dwordx4 a[168:171], v4, s[40:43], s63 offen offset:1024 sc1
    v_mfma_f32_16x16x32_bf16 v[180:183], v[108:111], a[108:111], v[180:183]
    ds_read_b128 v[104:107], v6 offset:6144
    ds_read_b128 v[108:111], v6 offset:14336
    v_mfma_f32_16x16x32_bf16 v[184:187], v[112:115], a[96:99], v[184:187]
    v_mfma_f32_16x16x32_bf16 v[184:187], v[116:119], a[104:107], v[184:187]
    v_mfma_f32_16x16x32_bf16 v[188:191], v[112:115], a[100:103], v[188:191]
    buffer_load_dwordx4 a[176:179], v4, s[40:43], s63 offen offset:2048 sc1
    v_mfma_f32_16x16x32_bf16 v[188:191], v[116:119], a[108:111], v[188:191]
    ds_read_b128 v[112:115], v6 offset:16384
    ds_read_b128 v[116:119], v6 offset:24576
    v_mfma_f32_16x16x32_bf16 v[192:195], v[120:123], a[96:99], v[192:195]
    v_mfma_f32_16x16x32_bf16 v[192:195], v[124:127], a[104:107], v[192:195]
    v_mfma_f32_16x16x32_bf16 v[196:199], v[120:123], a[100:103], v[196:199]
    ds_read_b128 v[120:123], v6 offset:17408
    v_mfma_f32_16x16x32_bf16 v[196:199], v[124:127], a[108:111], v[196:199]
    s_waitcnt lgkmcnt(3)
    buffer_load_dwordx4 a[184:187], v4, s[40:43], s63 offen offset:3072 sc1
    v_mfma_f32_16x16x32_bf16 v[200:203], v[128:131], a[96:99], v[200:203]
    s_xor_b32 s63, s63, 12288
    ds_read_b128 v[124:127], v6 offset:25600
    v_mfma_f32_16x16x32_bf16 v[200:203], v[132:135], a[104:107], v[200:203]
    v_mfma_f32_16x16x32_bf16 v[204:207], v[128:131], a[100:103], v[204:207]
    ds_read_b128 v[128:131], v6 offset:18432
    v_mfma_f32_16x16x32_bf16 v[204:207], v[132:135], a[108:111], v[204:207]
    buffer_load_dwordx4 a[164:167], v5, s[40:43], s20 offen offset:0 sc1
    v_mfma_f32_16x16x32_bf16 v[208:211], v[136:139], a[96:99], v[208:211]
    ds_read_b128 v[132:135], v6 offset:26624
    v_mfma_f32_16x16x32_bf16 v[208:211], v[140:143], a[104:107], v[208:211]
    v_mfma_f32_16x16x32_bf16 v[212:215], v[136:139], a[100:103], v[212:215]
    ds_read_b128 v[136:139], v6 offset:19456
    v_mfma_f32_16x16x32_bf16 v[212:215], v[140:143], a[108:111], v[212:215]
    buffer_load_dwordx4 a[172:175], v5, s[40:43], s20 offen offset:1024 sc1
    v_mfma_f32_16x16x32_bf16 v[216:219], v[144:147], a[96:99], v[216:219]
    ds_read_b128 v[140:143], v6 offset:27648
    v_mfma_f32_16x16x32_bf16 v[216:219], v[148:151], a[104:107], v[216:219]
    v_mfma_f32_16x16x32_bf16 v[220:223], v[144:147], a[100:103], v[220:223]
    ds_read_b128 v[144:147], v6 offset:20480
    v_mfma_f32_16x16x32_bf16 v[220:223], v[148:151], a[108:111], v[220:223]
    buffer_load_dwordx4 a[180:183], v5, s[40:43], s20 offen offset:2048 sc1
    v_mfma_f32_16x16x32_bf16 v[224:227], v[104:107], a[96:99], v[224:227]
    ds_read_b128 v[148:151], v6 offset:28672
    v_mfma_f32_16x16x32_bf16 v[224:227], v[108:111], a[104:107], v[224:227]
    v_mfma_f32_16x16x32_bf16 v[228:231], v[104:107], a[100:103], v[228:231]
    ds_read_b128 v[104:107], v6 offset:21504
    v_mfma_f32_16x16x32_bf16 v[228:231], v[108:111], a[108:111], v[228:231]
    s_waitcnt lgkmcnt(2)
    buffer_load_dwordx4 a[188:191], v5, s[40:43], s20 offen offset:3072 sc1
    v_mfma_f32_16x16x32_bf16 v[176:179], v[112:115], a[112:115], v[176:179]
    s_xor_b32 s21, s3, 6
    ds_read_b128 v[108:111], v6 offset:29696
    v_mfma_f32_16x16x32_bf16 v[176:179], v[116:119], a[120:123], v[176:179]
    s_lshl2_add_u32 s21, s21, s4
    v_mfma_f32_16x16x32_bf16 v[180:183], v[112:115], a[116:119], v[180:183]
    s_mul_i32 s21, s21, 36864
    ds_read_b128 v[112:115], v6 offset:22528
    v_mfma_f32_16x16x32_bf16 v[180:183], v[116:119], a[124:127], v[180:183]
    s_add_u32 s21, s21, s28
    s_mov_b32 m0, s45
    ds_read_b128 v[116:119], v6 offset:30720
    v_mfma_f32_16x16x32_bf16 v[184:187], v[120:123], a[112:115], v[184:187]
    s_xor_b32 s20, s20, 12288
    buffer_load_dwordx4 v1, s[56:59], s21 offen sc1 lds
    v_mfma_f32_16x16x32_bf16 v[184:187], v[124:127], a[120:123], v[184:187]
    v_mfma_f32_16x16x32_bf16 v[188:191], v[120:123], a[116:119], v[188:191]
    v_mfma_f32_16x16x32_bf16 v[188:191], v[124:127], a[124:127], v[188:191]
    v_mfma_f32_16x16x32_bf16 v[192:195], v[128:131], a[112:115], v[192:195]
    buffer_load_dwordx4 v1, s[56:59], s21 offen offset:1024 sc1 lds
    v_mfma_f32_16x16x32_bf16 v[192:195], v[132:135], a[120:123], v[192:195]
    v_mfma_f32_16x16x32_bf16 v[196:199], v[128:131], a[116:119], v[196:199]
    v_mfma_f32_16x16x32_bf16 v[196:199], v[132:135], a[124:127], v[196:199]
    v_mfma_f32_16x16x32_bf16 v[200:203], v[136:139], a[112:115], v[200:203]
    buffer_load_dwordx4 v1, s[56:59], s21 offen offset:2048 sc1 lds
    v_mfma_f32_16x16x32_bf16 v[200:203], v[140:143], a[120:123], v[200:203]
    v_mfma_f32_16x16x32_bf16 v[204:207], v[136:139], a[116:119], v[204:207]
    v_mfma_f32_16x16x32_bf16 v[204:207], v[140:143], a[124:127], v[204:207]
    s_waitcnt vmcnt(19)
    s_barrier
    ds_read_b128 v[120:123], v7 offset:0
    v_mfma_f32_16x16x32_bf16 v[208:211], v[144:147], a[112:115], v[208:211]
    s_waitcnt lgkmcnt(1)
    buffer_load_dwordx4 v1, s[56:59], s21 offen offset:3072 sc1 lds
    v_mfma_f32_16x16x32_bf16 v[208:211], v[148:151], a[120:123], v[208:211]
    s_add_u32 s21, s21, 4096
    ds_read_b128 v[124:127], v7 offset:8192
    ds_read_b128 v[128:131], v7 offset:1024
    v_mfma_f32_16x16x32_bf16 v[212:215], v[144:147], a[116:119], v[212:215]
    s_add_u32 m0, s45, 4096
    ds_read_b128 v[132:135], v7 offset:9216
    v_mfma_f32_16x16x32_bf16 v[212:215], v[148:151], a[124:127], v[212:215]
    ds_read_b128 v[136:139], v7 offset:2048
    v_mfma_f32_16x16x32_bf16 v[216:219], v[104:107], a[112:115], v[216:219]
    buffer_load_dwordx4 v1, s[56:59], s21 offen sc1 lds
    v_mfma_f32_16x16x32_bf16 v[216:219], v[108:111], a[120:123], v[216:219]
    ds_read_b128 v[140:143], v7 offset:10240
    ds_read_b128 v[144:147], v7 offset:3072
    v_mfma_f32_16x16x32_bf16 v[220:223], v[104:107], a[116:119], v[220:223]
    ds_read_b128 v[148:151], v7 offset:11264
    v_mfma_f32_16x16x32_bf16 v[220:223], v[108:111], a[124:127], v[220:223]
    ds_read_b128 v[104:107], v7 offset:4096
    v_mfma_f32_16x16x32_bf16 v[224:227], v[112:115], a[112:115], v[224:227]
    buffer_load_dwordx4 v1, s[56:59], s21 offen offset:1024 sc1 lds
    v_mfma_f32_16x16x32_bf16 v[224:227], v[116:119], a[120:123], v[224:227]
    ds_read_b128 v[108:111], v7 offset:12288
    v_mfma_f32_16x16x32_bf16 v[228:231], v[112:115], a[116:119], v[228:231]
    ds_read_b128 v[112:115], v7 offset:5120
    v_mfma_f32_16x16x32_bf16 v[228:231], v[116:119], a[124:127], v[228:231]
    s_waitcnt lgkmcnt(3)
    ds_read_b128 v[116:119], v7 offset:13312
    v_mfma_f32_16x16x32_bf16 v[176:179], v[120:123], a[128:131], v[176:179]
    buffer_load_dwordx4 v1, s[56:59], s21 offen offset:2048 sc1 lds
    v_mfma_f32_16x16x32_bf16 v[176:179], v[124:127], a[136:139], v[176:179]
    v_mfma_f32_16x16x32_bf16 v[180:183], v[120:123], a[132:135], v[180:183]
    ds_read_b128 v[120:123], v7 offset:6144
    v_mfma_f32_16x16x32_bf16 v[180:183], v[124:127], a[140:143], v[180:183]
    ds_read_b128 v[124:127], v7 offset:14336
    v_mfma_f32_16x16x32_bf16 v[184:187], v[128:131], a[128:131], v[184:187]
    v_mfma_f32_16x16x32_bf16 v[184:187], v[132:135], a[136:139], v[184:187]
    buffer_load_dwordx4 a[192:195], v4, s[40:43], s63 offen offset:0 sc1
    v_mfma_f32_16x16x32_bf16 v[188:191], v[128:131], a[132:135], v[188:191]
    ds_read_b128 v[128:131], v7 offset:16384
    v_mfma_f32_16x16x32_bf16 v[188:191], v[132:135], a[140:143], v[188:191]
    ds_read_b128 v[132:135], v7 offset:24576
    v_mfma_f32_16x16x32_bf16 v[192:195], v[136:139], a[128:131], v[192:195]
    v_mfma_f32_16x16x32_bf16 v[192:195], v[140:143], a[136:139], v[192:195]
    buffer_load_dwordx4 a[200:203], v4, s[40:43], s63 offen offset:1024 sc1
    v_mfma_f32_16x16x32_bf16 v[196:199], v[136:139], a[132:135], v[196:199]
    ds_read_b128 v[136:139], v7 offset:17408
    v_mfma_f32_16x16x32_bf16 v[196:199], v[140:143], a[140:143], v[196:199]
    ds_read_b128 v[140:143], v7 offset:25600
    v_mfma_f32_16x16x32_bf16 v[200:203], v[144:147], a[128:131], v[200:203]
    v_mfma_f32_16x16x32_bf16 v[200:203], v[148:151], a[136:139], v[200:203]
    buffer_load_dwordx4 a[208:211], v4, s[40:43], s63 offen offset:2048 sc1
    v_mfma_f32_16x16x32_bf16 v[204:207], v[144:147], a[132:135], v[204:207]
    ds_read_b128 v[144:147], v7 offset:18432
    v_mfma_f32_16x16x32_bf16 v[204:207], v[148:151], a[140:143], v[204:207]
    s_waitcnt lgkmcnt(2)
    ds_read_b128 v[148:151], v7 offset:26624
    v_mfma_f32_16x16x32_bf16 v[208:211], v[104:107], a[128:131], v[208:211]
    v_mfma_f32_16x16x32_bf16 v[208:211], v[108:111], a[136:139], v[208:211]
    buffer_load_dwordx4 a[216:219], v4, s[40:43], s63 offen offset:3072 sc1
    v_mfma_f32_16x16x32_bf16 v[212:215], v[104:107], a[132:135], v[212:215]
    s_xor_b32 s63, s63, 4096
    ds_read_b128 v[104:107], v7 offset:19456
    v_mfma_f32_16x16x32_bf16 v[212:215], v[108:111], a[140:143], v[212:215]
    ds_read_b128 v[108:111], v7 offset:27648
    v_mfma_f32_16x16x32_bf16 v[216:219], v[112:115], a[128:131], v[216:219]
    v_mfma_f32_16x16x32_bf16 v[216:219], v[116:119], a[136:139], v[216:219]
    buffer_load_dwordx4 a[196:199], v5, s[40:43], s20 offen offset:0 sc1
    v_mfma_f32_16x16x32_bf16 v[220:223], v[112:115], a[132:135], v[220:223]
    ds_read_b128 v[112:115], v7 offset:20480
    v_mfma_f32_16x16x32_bf16 v[220:223], v[116:119], a[140:143], v[220:223]
    ds_read_b128 v[116:119], v7 offset:28672
    v_mfma_f32_16x16x32_bf16 v[224:227], v[120:123], a[128:131], v[224:227]
    v_mfma_f32_16x16x32_bf16 v[224:227], v[124:127], a[136:139], v[224:227]
    buffer_load_dwordx4 a[204:207], v5, s[40:43], s20 offen offset:1024 sc1
    v_mfma_f32_16x16x32_bf16 v[228:231], v[120:123], a[132:135], v[228:231]
    ds_read_b128 v[120:123], v7 offset:21504
    v_mfma_f32_16x16x32_bf16 v[228:231], v[124:127], a[140:143], v[228:231]
    ds_read_b128 v[124:127], v7 offset:29696
    v_mfma_f32_16x16x32_bf16 v[176:179], v[128:131], a[144:147], v[176:179]
    v_mfma_f32_16x16x32_bf16 v[176:179], v[132:135], a[152:155], v[176:179]
    v_mfma_f32_16x16x32_bf16 v[180:183], v[128:131], a[148:151], v[180:183]
    buffer_load_dwordx4 a[212:215], v5, s[40:43], s20 offen offset:2048 sc1
    v_mfma_f32_16x16x32_bf16 v[180:183], v[132:135], a[156:159], v[180:183]
    buffer_load_dword v3, v19, s[32:35], s66 offen sc1
    v_mfma_f32_16x16x32_bf16 v[184:187], v[136:139], a[144:147], v[184:187]
    s_waitcnt lgkmcnt(0)
    ds_read_b128 v[128:131], v7 offset:22528
    ds_read_b128 v[132:135], v7 offset:30720
    v_mfma_f32_16x16x32_bf16 v[184:187], v[140:143], a[152:155], v[184:187]
    v_mfma_f32_16x16x32_bf16 v[188:191], v[136:139], a[148:151], v[188:191]
    buffer_load_dwordx4 a[220:223], v5, s[40:43], s20 offen offset:3072 sc1
    v_mfma_f32_16x16x32_bf16 v[188:191], v[140:143], a[156:159], v[188:191]
    s_xor_b32 s21, s3, 7
    v_mfma_f32_16x16x32_bf16 v[192:195], v[144:147], a[144:147], v[192:195]
    s_lshl2_add_u32 s21, s21, s4
    v_mfma_f32_16x16x32_bf16 v[192:195], v[148:151], a[152:155], v[192:195]
    s_mul_i32 s21, s21, 36864
    v_mfma_f32_16x16x32_bf16 v[196:199], v[144:147], a[148:151], v[196:199]
    s_add_u32 s21, s21, s28
    s_mov_b32 m0, s46
    v_mfma_f32_16x16x32_bf16 v[196:199], v[148:151], a[156:159], v[196:199]
    s_xor_b32 s20, s20, 4096
    buffer_load_dwordx4 v1, s[56:59], s21 offen sc1 lds
    v_mfma_f32_16x16x32_bf16 v[200:203], v[104:107], a[144:147], v[200:203]
    v_mfma_f32_16x16x32_bf16 v[200:203], v[108:111], a[152:155], v[200:203]
    v_mfma_f32_16x16x32_bf16 v[204:207], v[104:107], a[148:151], v[204:207]
    buffer_load_dwordx4 v1, s[56:59], s21 offen offset:1024 sc1 lds
    v_mfma_f32_16x16x32_bf16 v[204:207], v[108:111], a[156:159], v[204:207]
    s_waitcnt vmcnt(18)
    s_barrier
    ds_read_b128 v[136:139], v11 offset:0
    v_mfma_f32_16x16x32_bf16 v[208:211], v[112:115], a[144:147], v[208:211]
    ds_read_b128 v[140:143], v11 offset:8192
    ds_read_b128 v[144:147], v11 offset:1024
    v_mfma_f32_16x16x32_bf16 v[208:211], v[116:119], a[152:155], v[208:211]
    ds_read_b128 v[148:151], v11 offset:9216
    v_mfma_f32_16x16x32_bf16 v[212:215], v[112:115], a[148:151], v[212:215]
    buffer_load_dwordx4 v1, s[56:59], s21 offen offset:2048 sc1 lds
    v_mfma_f32_16x16x32_bf16 v[212:215], v[116:119], a[156:159], v[212:215]
    ds_read_b128 v[104:107], v11 offset:2048
    ds_read_b128 v[108:111], v11 offset:10240
    v_mfma_f32_16x16x32_bf16 v[216:219], v[120:123], a[144:147], v[216:219]
    ds_read_b128 v[112:115], v11 offset:3072
    v_mfma_f32_16x16x32_bf16 v[216:219], v[124:127], a[152:155], v[216:219]
    ds_read_b128 v[116:119], v11 offset:11264
    v_mfma_f32_16x16x32_bf16 v[220:223], v[120:123], a[148:151], v[220:223]
    buffer_load_dwordx4 v1, s[56:59], s21 offen offset:3072 sc1 lds
    v_mfma_f32_16x16x32_bf16 v[220:223], v[124:127], a[156:159], v[220:223]
    s_waitcnt lgkmcnt(4)
    ds_read_b128 v[120:123], v11 offset:4096
    ds_read_b128 v[124:127], v11 offset:12288
    v_mfma_f32_16x16x32_bf16 v[224:227], v[128:131], a[144:147], v[224:227]
    s_add_u32 s21, s21, 4096
    v_mfma_f32_16x16x32_bf16 v[224:227], v[132:135], a[152:155], v[224:227]
    s_add_u32 m0, s46, 4096
    v_mfma_f32_16x16x32_bf16 v[228:231], v[128:131], a[148:151], v[228:231]
    ds_read_b128 v[128:131], v11 offset:5120
    v_mfma_f32_16x16x32_bf16 v[228:231], v[132:135], a[156:159], v[228:231]
    buffer_load_dwordx4 v1, s[56:59], s21 offen sc1 lds
    v_mfma_f32_16x16x32_bf16 v[176:179], v[136:139], a[160:163], v[176:179]
    ds_read_b128 v[132:135], v11 offset:13312
    v_mfma_f32_16x16x32_bf16 v[176:179], v[140:143], a[168:171], v[176:179]
    v_mfma_f32_16x16x32_bf16 v[180:183], v[136:139], a[164:167], v[180:183]
    ds_read_b128 v[136:139], v11 offset:6144
    v_mfma_f32_16x16x32_bf16 v[180:183], v[140:143], a[172:175], v[180:183]
    buffer_load_dwordx4 v1, s[56:59], s21 offen offset:1024 sc1 lds
    v_mfma_f32_16x16x32_bf16 v[184:187], v[144:147], a[160:163], v[184:187]
    ds_read_b128 v[140:143], v11 offset:14336
    v_mfma_f32_16x16x32_bf16 v[184:187], v[148:151], a[168:171], v[184:187]
    v_mfma_f32_16x16x32_bf16 v[188:191], v[144:147], a[164:167], v[188:191]
    ds_read_b128 v[144:147], v11 offset:16384
    v_mfma_f32_16x16x32_bf16 v[188:191], v[148:151], a[172:175], v[188:191]
    s_waitcnt lgkmcnt(2)
    buffer_load_dwordx4 v1, s[56:59], s21 offen offset:2048 sc1 lds
    v_mfma_f32_16x16x32_bf16 v[192:195], v[104:107], a[160:163], v[192:195]
    ds_read_b128 v[148:151], v11 offset:24576
    v_mfma_f32_16x16x32_bf16 v[192:195], v[108:111], a[168:171], v[192:195]
    v_mfma_f32_16x16x32_bf16 v[196:199], v[104:107], a[164:167], v[196:199]
    ds_read_b128 v[104:107], v11 offset:17408
    v_mfma_f32_16x16x32_bf16 v[196:199], v[108:111], a[172:175], v[196:199]
    buffer_load_dwordx4 a[224:227], v4, s[40:43], s63 offen offset:0 sc1
    v_mfma_f32_16x16x32_bf16 v[200:203], v[112:115], a[160:163], v[200:203]
    ds_read_b128 v[108:111], v11 offset:25600
    v_mfma_f32_16x16x32_bf16 v[200:203], v[116:119], a[168:171], v[200:203]
    v_mfma_f32_16x16x32_bf16 v[204:207], v[112:115], a[164:167], v[204:207]
    ds_read_b128 v[112:115], v11 offset:18432
    v_mfma_f32_16x16x32_bf16 v[204:207], v[116:119], a[172:175], v[204:207]
    buffer_load_dwordx4 a[232:235], v4, s[40:43], s63 offen offset:1024 sc1
    v_mfma_f32_16x16x32_bf16 v[208:211], v[120:123], a[160:163], v[208:211]
    ds_read_b128 v[116:119], v11 offset:26624
    v_mfma_f32_16x16x32_bf16 v[208:211], v[124:127], a[168:171], v[208:211]
    v_mfma_f32_16x16x32_bf16 v[212:215], v[120:123], a[164:167], v[212:215]
    ds_read_b128 v[120:123], v11 offset:19456
    v_mfma_f32_16x16x32_bf16 v[212:215], v[124:127], a[172:175], v[212:215]
    buffer_load_dwordx4 a[240:243], v4, s[40:43], s63 offen offset:2048 sc1
    v_mfma_f32_16x16x32_bf16 v[216:219], v[128:131], a[160:163], v[216:219]
    ds_read_b128 v[124:127], v11 offset:27648
    v_mfma_f32_16x16x32_bf16 v[216:219], v[132:135], a[168:171], v[216:219]
    v_mfma_f32_16x16x32_bf16 v[220:223], v[128:131], a[164:167], v[220:223]
    ds_read_b128 v[128:131], v11 offset:20480
    v_mfma_f32_16x16x32_bf16 v[220:223], v[132:135], a[172:175], v[220:223]
    ds_read_b128 v[132:135], v11 offset:28672
    v_mfma_f32_16x16x32_bf16 v[224:227], v[136:139], a[160:163], v[224:227]
    s_waitcnt lgkmcnt(3)
    buffer_load_dwordx4 a[248:251], v4, s[40:43], s63 offen offset:3072 sc1
    v_mfma_f32_16x16x32_bf16 v[224:227], v[140:143], a[168:171], v[224:227]
    s_add_u32 s63, s63, 4096
    v_mfma_f32_16x16x32_bf16 v[228:231], v[136:139], a[164:167], v[228:231]
    ds_read_b128 v[136:139], v11 offset:21504
    v_mfma_f32_16x16x32_bf16 v[228:231], v[140:143], a[172:175], v[228:231]
    ds_read_b128 v[140:143], v11 offset:29696
    v_mfma_f32_16x16x32_bf16 v[176:179], v[144:147], a[176:179], v[176:179]
    buffer_load_dwordx4 a[228:231], v5, s[40:43], s20 offen offset:0 sc1
    v_mfma_f32_16x16x32_bf16 v[176:179], v[148:151], a[184:187], v[176:179]
    v_mfma_f32_16x16x32_bf16 v[180:183], v[144:147], a[180:183], v[180:183]
    ds_read_b128 v[144:147], v11 offset:22528
    v_mfma_f32_16x16x32_bf16 v[180:183], v[148:151], a[188:191], v[180:183]
    ds_read_b128 v[148:151], v11 offset:30720
    v_mfma_f32_16x16x32_bf16 v[184:187], v[104:107], a[176:179], v[184:187]
    buffer_load_dwordx4 a[236:239], v5, s[40:43], s20 offen offset:1024 sc1
    v_mfma_f32_16x16x32_bf16 v[184:187], v[108:111], a[184:187], v[184:187]
    v_mfma_f32_16x16x32_bf16 v[188:191], v[104:107], a[180:183], v[188:191]
    v_mfma_f32_16x16x32_bf16 v[188:191], v[108:111], a[188:191], v[188:191]
    v_mfma_f32_16x16x32_bf16 v[192:195], v[112:115], a[176:179], v[192:195]
    buffer_load_dwordx4 a[244:247], v5, s[40:43], s20 offen offset:2048 sc1
    v_mfma_f32_16x16x32_bf16 v[192:195], v[116:119], a[184:187], v[192:195]
    v_mfma_f32_16x16x32_bf16 v[196:199], v[112:115], a[180:183], v[196:199]
    v_mfma_f32_16x16x32_bf16 v[196:199], v[116:119], a[188:191], v[196:199]
    v_mfma_f32_16x16x32_bf16 v[200:203], v[120:123], a[176:179], v[200:203]
    s_waitcnt lgkmcnt(0)
    buffer_load_dwordx4 a[252:255], v5, s[40:43], s20 offen offset:3072 sc1
    v_mfma_f32_16x16x32_bf16 v[200:203], v[124:127], a[184:187], v[200:203]
    v_mfma_f32_16x16x32_bf16 v[204:207], v[120:123], a[180:183], v[204:207]
    s_mul_i32 s21, s61, 6
    s_add_u32 s21, s4, s21
    v_mfma_f32_16x16x32_bf16 v[204:207], v[124:127], a[188:191], v[204:207]
    s_add_u32 s21, s21, 128
    s_waitcnt vmcnt(15)
    v_cmp_gt_u32 vcc, 3, v3
    s_nop 1
    s_and_b64 vcc, vcc, exec
    s_cbranch_scc1 SPIN_OA
BACK_OA:
    s_barrier
    v_mfma_f32_16x16x32_bf16 v[208:211], v[128:131], a[176:179], v[208:211]
    s_mul_i32 s21, s21, 36864
    ds_read_b128 v[104:107], v12 offset:0
    ds_read_b128 v[108:111], v12 offset:8192
    v_mfma_f32_16x16x32_bf16 v[208:211], v[132:135], a[184:187], v[208:211]
    s_add_u32 s21, s21, s28
    s_mov_b32 m0, s47
    ds_read_b128 v[112:115], v12 offset:1024
    v_mfma_f32_16x16x32_bf16 v[212:215], v[128:131], a[180:183], v[212:215]
    s_add_u32 s20, s20, 4096
    buffer_load_dwordx4 v1, s[56:59], s21 offen sc1 lds
    v_mfma_f32_16x16x32_bf16 v[212:215], v[132:135], a[188:191], v[212:215]
    ds_read_b128 v[116:119], v12 offset:9216
    ds_read_b128 v[120:123], v12 offset:2048
    v_mfma_f32_16x16x32_bf16 v[216:219], v[136:139], a[176:179], v[216:219]
    ds_read_b128 v[124:127], v12 offset:10240
    v_mfma_f32_16x16x32_bf16 v[216:219], v[140:143], a[184:187], v[216:219]
    buffer_load_dwordx4 v1, s[56:59], s21 offen offset:1024 sc1 lds
    v_mfma_f32_16x16x32_bf16 v[220:223], v[136:139], a[180:183], v[220:223]
    ds_read_b128 v[128:131], v12 offset:3072
    ds_read_b128 v[132:135], v12 offset:11264
    v_mfma_f32_16x16x32_bf16 v[220:223], v[140:143], a[188:191], v[220:223]
    ds_read_b128 v[136:139], v12 offset:4096
    v_mfma_f32_16x16x32_bf16 v[224:227], v[144:147], a[176:179], v[224:227]
    ds_read_b128 v[140:143], v12 offset:12288
    v_mfma_f32_16x16x32_bf16 v[224:227], v[148:151], a[184:187], v[224:227]
    buffer_load_dwordx4 v1, s[56:59], s21 offen offset:2048 sc1 lds
    v_mfma_f32_16x16x32_bf16 v[228:231], v[144:147], a[180:183], v[228:231]
    ds_read_b128 v[144:147], v12 offset:5120
    v_mfma_f32_16x16x32_bf16 v[228:231], v[148:151], a[188:191], v[228:231]
    s_waitcnt lgkmcnt(3)
    ds_read_b128 v[148:151], v12 offset:13312
    v_mfma_f32_16x16x32_bf16 v[176:179], v[104:107], a[192:195], v[176:179]
    v_mfma_f32_16x16x32_bf16 v[176:179], v[108:111], a[200:203], v[176:179]
    buffer_load_dwordx4 v1, s[56:59], s21 offen offset:3072 sc1 lds
    v_mfma_f32_16x16x32_bf16 v[180:183], v[104:107], a[196:199], v[180:183]
    s_add_u32 s21, s21, 4096
    ds_read_b128 v[104:107], v12 offset:6144
    v_mfma_f32_16x16x32_bf16 v[180:183], v[108:111], a[204:207], v[180:183]
    s_add_u32 m0, s47, 4096
    ds_read_b128 v[108:111], v12 offset:14336
    v_mfma_f32_16x16x32_bf16 v[184:187], v[112:115], a[192:195], v[184:187]
    v_mfma_f32_16x16x32_bf16 v[184:187], v[116:119], a[200:203], v[184:187]
    buffer_load_dwordx4 v1, s[56:59], s21 offen sc1 lds
    v_mfma_f32_16x16x32_bf16 v[188:191], v[112:115], a[196:199], v[188:191]
    ds_read_b128 v[112:115], v12 offset:16384
    v_mfma_f32_16x16x32_bf16 v[188:191], v[116:119], a[204:207], v[188:191]
    ds_read_b128 v[116:119], v12 offset:24576
    v_mfma_f32_16x16x32_bf16 v[192:195], v[120:123], a[192:195], v[192:195]
    v_mfma_f32_16x16x32_bf16 v[192:195], v[124:127], a[200:203], v[192:195]
    buffer_load_dwordx4 v1, s[56:59], s21 offen offset:1024 sc1 lds
    v_mfma_f32_16x16x32_bf16 v[196:199], v[120:123], a[196:199], v[196:199]
    ds_read_b128 v[120:123], v12 offset:17408
    v_mfma_f32_16x16x32_bf16 v[196:199], v[124:127], a[204:207], v[196:199]
    ds_read_b128 v[124:127], v12 offset:25600
    v_mfma_f32_16x16x32_bf16 v[200:203], v[128:131], a[192:195], v[200:203]
    v_mfma_f32_16x16x32_bf16 v[200:203], v[132:135], a[200:203], v[200:203]
    v_mfma_f32_16x16x32_bf16 v[204:207], v[128:131], a[196:199], v[204:207]
    buffer_load_dwordx4 v1, s[56:59], s21 offen offset:2048 sc1 lds
    v_mfma_f32_16x16x32_bf16 v[204:207], v[132:135], a[204:207], v[204:207]
    s_mul_i32 s63, s61, 6144
    ds_read_b128 v[128:131], v12 offset:18432
    ds_read_b128 v[132:135], v12 offset:26624
    s_waitcnt lgkmcnt(3)
    v_mfma_f32_16x16x32_bf16 v[208:211], v[136:139], a[192:195], v[208:211]
    s_add_u32 s63, s63, 131072
    v_mfma_f32_16x16x32_bf16 v[208:211], v[140:143], a[200:203], v[208:211]
    v_mfma_f32_16x16x32_bf16 v[212:215], v[136:139], a[196:199], v[212:215]
    buffer_load_dwordx4 v[32:35], v4, s[40:43], s63 offen offset:0 sc1
    v_mfma_f32_16x16x32_bf16 v[212:215], v[140:143], a[204:207], v[212:215]
    ds_read_b128 v[136:139], v12 offset:19456
    ds_read_b128 v[140:143], v12 offset:27648
    v_mfma_f32_16x16x32_bf16 v[216:219], v[144:147], a[192:195], v[216:219]
    v_mfma_f32_16x16x32_bf16 v[216:219], v[148:151], a[200:203], v[216:219]
    v_mfma_f32_16x16x32_bf16 v[220:223], v[144:147], a[196:199], v[220:223]
    buffer_load_dwordx4 v[40:43], v4, s[40:43], s63 offen offset:1024 sc1
    v_mfma_f32_16x16x32_bf16 v[220:223], v[148:151], a[204:207], v[220:223]
    ds_read_b128 v[144:147], v12 offset:20480
    ds_read_b128 v[148:151], v12 offset:28672
    v_mfma_f32_16x16x32_bf16 v[224:227], v[104:107], a[192:195], v[224:227]
    v_mfma_f32_16x16x32_bf16 v[224:227], v[108:111], a[200:203], v[224:227]
    v_mfma_f32_16x16x32_bf16 v[228:231], v[104:107], a[196:199], v[228:231]
    buffer_load_dwordx4 v[48:51], v4, s[40:43], s63 offen offset:2048 sc1
    v_mfma_f32_16x16x32_bf16 v[228:231], v[108:111], a[204:207], v[228:231]
    ds_read_b128 v[104:107], v12 offset:21504
    ds_read_b128 v[108:111], v12 offset:29696
    v_mfma_f32_16x16x32_bf16 v[176:179], v[112:115], a[208:211], v[176:179]
    v_mfma_f32_16x16x32_bf16 v[176:179], v[116:119], a[216:219], v[176:179]
    v_mfma_f32_16x16x32_bf16 v[180:183], v[112:115], a[212:215], v[180:183]
    buffer_load_dwordx4 v[56:59], v4, s[40:43], s63 offen offset:3072 sc1
    v_mfma_f32_16x16x32_bf16 v[180:183], v[116:119], a[220:223], v[180:183]
    s_mul_i32 s20, s61, 6144
    ds_read_b128 v[112:115], v12 offset:22528
    ds_read_b128 v[116:119], v12 offset:30720
    v_mfma_f32_16x16x32_bf16 v[184:187], v[120:123], a[208:211], v[184:187]
    s_add_u32 s20, s20, 131072
    s_waitcnt lgkmcnt(2)
    v_mfma_f32_16x16x32_bf16 v[184:187], v[124:127], a[216:219], v[184:187]
    s_add_u32 s63, s63, 4096
    v_mfma_f32_16x16x32_bf16 v[188:191], v[120:123], a[212:215], v[188:191]
    buffer_load_dwordx4 v[36:39], v5, s[40:43], s20 offen offset:0 sc1
    v_mfma_f32_16x16x32_bf16 v[188:191], v[124:127], a[220:223], v[188:191]
    v_mfma_f32_16x16x32_bf16 v[192:195], v[128:131], a[208:211], v[192:195]
    v_mfma_f32_16x16x32_bf16 v[192:195], v[132:135], a[216:219], v[192:195]
    v_mfma_f32_16x16x32_bf16 v[196:199], v[128:131], a[212:215], v[196:199]
    v_mfma_f32_16x16x32_bf16 v[196:199], v[132:135], a[220:223], v[196:199]
    buffer_load_dwordx4 v[44:47], v5, s[40:43], s20 offen offset:1024 sc1
    v_mfma_f32_16x16x32_bf16 v[200:203], v[136:139], a[208:211], v[200:203]
    v_mfma_f32_16x16x32_bf16 v[200:203], v[140:143], a[216:219], v[200:203]
    v_mfma_f32_16x16x32_bf16 v[204:207], v[136:139], a[212:215], v[204:207]
    v_mfma_f32_16x16x32_bf16 v[204:207], v[140:143], a[220:223], v[204:207]
    s_waitcnt vmcnt(13)
    s_barrier
    ds_read_b128 v[120:123], v13 offset:0
    v_mfma_f32_16x16x32_bf16 v[208:211], v[144:147], a[208:211], v[208:211]
    buffer_load_dwordx4 v[52:55], v5, s[40:43], s20 offen offset:2048 sc1
    v_mfma_f32_16x16x32_bf16 v[208:211], v[148:151], a[216:219], v[208:211]
    ds_read_b128 v[124:127], v13 offset:8192
    ds_read_b128 v[128:131], v13 offset:1024
    v_mfma_f32_16x16x32_bf16 v[212:215], v[144:147], a[212:215], v[212:215]
    ds_read_b128 v[132:135], v13 offset:9216
    v_mfma_f32_16x16x32_bf16 v[212:215], v[148:151], a[220:223], v[212:215]
    buffer_load_dwordx4 v[60:63], v5, s[40:43], s20 offen offset:3072 sc1
    v_mfma_f32_16x16x32_bf16 v[216:219], v[104:107], a[208:211], v[216:219]
    s_mul_i32 s21, s61, 6
    s_lshr_b32 s64, s4, 1
    s_add_u32 s21, s21, s64
    v_mfma_f32_16x16x32_bf16 v[216:219], v[108:111], a[216:219], v[216:219]
    s_add_u32 s21, s21, 132
    s_mul_i32 s21, s21, 36864
    ds_read_b128 v[136:139], v13 offset:2048
    v_mfma_f32_16x16x32_bf16 v[220:223], v[104:107], a[212:215], v[220:223]
    s_add_u32 s21, s21, s28
    s_and_b32 s64, s69, 4096
    ds_read_b128 v[140:143], v13 offset:10240
    v_mfma_f32_16x16x32_bf16 v[220:223], v[108:111], a[220:223], v[220:223]
    s_add_u32 s21, s21, s64
    s_mov_b32 m0, s79
    ds_read_b128 v[144:147], v13 offset:3072
    s_waitcnt lgkmcnt(3)
    v_mfma_f32_16x16x32_bf16 v[224:227], v[112:115], a[208:211], v[224:227]
    s_add_u32 s20, s20, 4096
    buffer_load_dwordx4 v1, s[56:59], s21 offen sc1 lds
    v_mfma_f32_16x16x32_bf16 v[224:227], v[116:119], a[216:219], v[224:227]
    ds_read_b128 v[148:151], v13 offset:11264
    ds_read_b128 v[104:107], v13 offset:4096
    v_mfma_f32_16x16x32_bf16 v[228:231], v[112:115], a[212:215], v[228:231]
    ds_read_b128 v[108:111], v13 offset:12288
    v_mfma_f32_16x16x32_bf16 v[228:231], v[116:119], a[220:223], v[228:231]
    buffer_load_dwordx4 v1, s[56:59], s21 offen offset:1024 sc1 lds
    v_mfma_f32_16x16x32_bf16 v[176:179], v[120:123], a[224:227], v[176:179]
    s_add_u32 s23, s5, 8
    ds_read_b128 v[112:115], v13 offset:5120
    ds_read_b128 v[116:119], v13 offset:13312
    v_mfma_f32_16x16x32_bf16 v[176:179], v[124:127], a[232:235], v[176:179]
    s_and_b32 s65, s5, 3
    v_lshrrev_b32 v19, 4, v1
    v_min_u32 v19, 2, v19
    v_mfma_f32_16x16x32_bf16 v[180:183], v[120:123], a[228:231], v[180:183]
    s_mul_i32 s70, s4, 3072
    ds_read_b128 v[120:123], v13 offset:6144
    v_lshl_add_u32 v19, v19, 3, s23
    v_mfma_f32_16x16x32_bf16 v[180:183], v[124:127], a[236:239], v[180:183]
    s_lshl3_add_u32 s23, s6, s62
    buffer_load_dwordx4 v1, s[56:59], s21 offen offset:2048 sc1 lds
    v_mfma_f32_16x16x32_bf16 v[184:187], v[128:131], a[224:227], v[184:187]
    s_lshl_b32 s23, s23, 4
    ds_read_b128 v[124:127], v13 offset:14336
    v_bfe_u32 v20, v1, 4, 4
    v_mfma_f32_16x16x32_bf16 v[184:187], v[132:135], a[232:235], v[184:187]
    s_andn2_b32 s66, s74, 0xfff
    v_add_u32 v20, s23, v20
    v_mul_u32_u24 v20, 1152, v20
    v_mfma_f32_16x16x32_bf16 v[188:191], v[128:131], a[228:231], v[188:191]
    s_mul_i32 s23, s6, 294912
    ds_read_b128 v[128:131], v13 offset:16384
    v_lshrrev_b32 v21, 8, v1
    v_mfma_f32_16x16x32_bf16 v[188:191], v[132:135], a[236:239], v[188:191]
    s_sub_u32 s23, 2211840, s23
    ds_read_b128 v[132:135], v13 offset:24576
    v_lshl_add_u32 v20, v21, 3, v20
    s_waitcnt lgkmcnt(3)
    v_mfma_f32_16x16x32_bf16 v[192:195], v[136:139], a[224:227], v[192:195]
    buffer_load_dwordx4 v1, s[56:59], s21 offen offset:3072 sc1 lds
    v_mfma_f32_16x16x32_bf16 v[192:195], v[140:143], a[232:235], v[192:195]
    v_add_u32 v21, s23, v20
    v_and_b32 v19, 31, v19
    v_mfma_f32_16x16x32_bf16 v[196:199], v[136:139], a[228:231], v[196:199]
    s_mul_i32 s23, s101, 288
    ds_read_b128 v[136:139], v13 offset:17408
    v_mov_b32 v31, 3
    v_mfma_f32_16x16x32_bf16 v[196:199], v[140:143], a[236:239], v[196:199]
    s_add_u32 s23, s23, s70
    ds_read_b128 v[140:143], v13 offset:25600
    v_lshlrev_b32 v23, 20, v1
    v_mfma_f32_16x16x32_bf16 v[200:203], v[144:147], a[224:227], v[200:203]
    buffer_load_dwordx4 v[64:67], v4, s[40:43], s63 offen offset:0 sc1
    v_mfma_f32_16x16x32_bf16 v[200:203], v[148:151], a[232:235], v[200:203]
    v_lshlrev_b32 v19, 7, v19
    v_mfma_f32_16x16x32_bf16 v[204:207], v[144:147], a[228:231], v[204:207]
    ds_read_b128 v[144:147], v13 offset:18432
    v_mfma_f32_16x16x32_bf16 v[204:207], v[148:151], a[236:239], v[204:207]
    ds_read_b128 v[148:151], v13 offset:26624
    v_mfma_f32_16x16x32_bf16 v[208:211], v[104:107], a[224:227], v[208:211]
    buffer_load_dwordx4 v[72:75], v4, s[40:43], s63 offen offset:1024 sc1
    v_mfma_f32_16x16x32_bf16 v[208:211], v[108:111], a[232:235], v[208:211]
    s_add_u32 s63, s63, 4096
    v_mfma_f32_16x16x32_bf16 v[212:215], v[104:107], a[228:231], v[212:215]
    ds_read_b128 v[104:107], v13 offset:19456
    v_mfma_f32_16x16x32_bf16 v[212:215], v[108:111], a[236:239], v[212:215]
    ds_read_b128 v[108:111], v13 offset:27648
    v_mfma_f32_16x16x32_bf16 v[216:219], v[112:115], a[224:227], v[216:219]
    buffer_load_dwordx4 v[68:71], v5, s[40:43], s20 offen offset:0 sc1
    v_mfma_f32_16x16x32_bf16 v[216:219], v[116:119], a[232:235], v[216:219]
    v_mfma_f32_16x16x32_bf16 v[220:223], v[112:115], a[228:231], v[220:223]
    ds_read_b128 v[112:115], v13 offset:20480
    v_mfma_f32_16x16x32_bf16 v[220:223], v[116:119], a[236:239], v[220:223]
    ds_read_b128 v[116:119], v13 offset:28672
    v_mfma_f32_16x16x32_bf16 v[224:227], v[120:123], a[224:227], v[224:227]
    s_waitcnt lgkmcnt(2)
    buffer_load_dwordx4 v[76:79], v5, s[40:43], s20 offen offset:1024 sc1
    v_mfma_f32_16x16x32_bf16 v[224:227], v[124:127], a[232:235], v[224:227]
    s_add_u32 s21, s4, 0
    s_xor_b32 s21, s21, s3
    s_lshl_b32 s21, s21, 2
    v_mfma_f32_16x16x32_bf16 v[228:231], v[120:123], a[228:231], v[228:231]
    s_mul_i32 s21, s21, 36864
    ds_read_b128 v[120:123], v13 offset:21504
    v_mfma_f32_16x16x32_bf16 v[228:231], v[124:127], a[236:239], v[228:231]
    s_add_u32 s21, s21, s28
    ds_read_b128 v[124:127], v13 offset:29696
    v_mfma_f32_16x16x32_bf16 v[176:179], v[128:131], a[240:243], v[176:179]
    s_add_u32 s21, s21, 7168
    s_add_u32 m0, s44, 0
    v_mfma_f32_16x16x32_bf16 v[176:179], v[132:135], a[248:251], v[176:179]
    s_add_u32 s20, s20, 4096
    buffer_load_dwordx4 v1, s[56:59], s21 offen sc1 lds
    v_mfma_f32_16x16x32_bf16 v[180:183], v[128:131], a[244:247], v[180:183]
    ds_read_b128 v[128:131], v13 offset:22528
    v_mfma_f32_16x16x32_bf16 v[180:183], v[132:135], a[252:255], v[180:183]
    ds_read_b128 v[132:135], v13 offset:30720
    v_mfma_f32_16x16x32_bf16 v[184:187], v[136:139], a[240:243], v[184:187]
    v_mfma_f32_16x16x32_bf16 v[184:187], v[140:143], a[248:251], v[184:187]
    buffer_load_dwordx4 v1, s[56:59], s21 offen offset:1024 sc1 lds
    v_mfma_f32_16x16x32_bf16 v[188:191], v[136:139], a[244:247], v[188:191]
    s_add_u32 s21, s21, 36864
    v_mfma_f32_16x16x32_bf16 v[188:191], v[140:143], a[252:255], v[188:191]
    s_add_u32 m0, s44, 2048
    v_mfma_f32_16x16x32_bf16 v[192:195], v[144:147], a[240:243], v[192:195]
    v_mfma_f32_16x16x32_bf16 v[192:195], v[148:151], a[248:251], v[192:195]
    buffer_load_dwordx4 v1, s[56:59], s21 offen sc1 lds
    v_mfma_f32_16x16x32_bf16 v[196:199], v[144:147], a[244:247], v[196:199]
    v_mfma_f32_16x16x32_bf16 v[196:199], v[148:151], a[252:255], v[196:199]
    v_mfma_f32_16x16x32_bf16 v[200:203], v[104:107], a[240:243], v[200:203]
    v_mfma_f32_16x16x32_bf16 v[200:203], v[108:111], a[248:251], v[200:203]
    buffer_load_dwordx4 v1, s[56:59], s21 offen offset:1024 sc1 lds
    v_mfma_f32_16x16x32_bf16 v[204:207], v[104:107], a[244:247], v[204:207]
    s_add_u32 s21, s21, 36864
    v_mfma_f32_16x16x32_bf16 v[204:207], v[108:111], a[252:255], v[204:207]
    s_waitcnt vmcnt(12)
    s_barrier
    ds_read_b128 v[136:139], v6 offset:0
    s_waitcnt lgkmcnt(1)
    v_mfma_f32_16x16x32_bf16 v[208:211], v[112:115], a[240:243], v[208:211]
    s_add_u32 m0, s44, 4096
    ds_read_b128 v[140:143], v6 offset:8192
    ds_read_b128 v[144:147], v6 offset:1024
    v_mfma_f32_16x16x32_bf16 v[208:211], v[116:119], a[248:251], v[208:211]
    buffer_load_dwordx4 v1, s[56:59], s21 offen sc1 lds
    v_mfma_f32_16x16x32_bf16 v[212:215], v[112:115], a[244:247], v[212:215]
    ds_read_b128 v[148:151], v6 offset:9216
    ds_read_b128 v[104:107], v6 offset:2048
    v_mfma_f32_16x16x32_bf16 v[212:215], v[116:119], a[252:255], v[212:215]
    ds_read_b128 v[108:111], v6 offset:10240
    v_mfma_f32_16x16x32_bf16 v[216:219], v[120:123], a[240:243], v[216:219]
    ds_read_b128 v[112:115], v6 offset:3072
    v_mfma_f32_16x16x32_bf16 v[216:219], v[124:127], a[248:251], v[216:219]
    buffer_load_dwordx4 v1, s[56:59], s21 offen offset:1024 sc1 lds
    v_mfma_f32_16x16x32_bf16 v[220:223], v[120:123], a[244:247], v[220:223]
    s_add_u32 s21, s21, 36864
    ds_read_b128 v[116:119], v6 offset:11264
    ds_read_b128 v[120:123], v6 offset:4096
    v_mfma_f32_16x16x32_bf16 v[220:223], v[124:127], a[252:255], v[220:223]
    s_add_u32 m0, s44, 6144
    ds_read_b128 v[124:127], v6 offset:12288
    v_mfma_f32_16x16x32_bf16 v[224:227], v[128:131], a[240:243], v[224:227]
    v_mfma_f32_16x16x32_bf16 v[224:227], v[132:135], a[248:251], v[224:227]
    buffer_load_dwordx4 v1, s[56:59], s21 offen sc1 lds
    v_mfma_f32_16x16x32_bf16 v[228:231], v[128:131], a[244:247], v[228:231]
    ds_read_b128 v[128:131], v6 offset:5120
    v_mfma_f32_16x16x32_bf16 v[228:231], v[132:135], a[252:255], v[228:231]
    s_waitcnt lgkmcnt(2)
    ds_read_b128 v[132:135], v6 offset:13312
    v_mfma_f32_16x16x32_bf16 v[176:179], v[136:139], v[32:35], v[176:179]
    v_mfma_f32_16x16x32_bf16 v[176:179], v[140:143], v[40:43], v[176:179]
    v_mfma_f32_16x16x32_bf16 v[180:183], v[136:139], v[36:39], v[180:183]
    buffer_load_dwordx4 v1, s[56:59], s21 offen offset:1024 sc1 lds
    v_mfma_f32_16x16x32_bf16 v[180:183], v[140:143], v[44:47], v[180:183]
    s_add_u32 s21, s21, 36864
    s_add_u32 s21, s4, 4
    s_xor_b32 s21, s21, s3
    v_mfma_f32_16x16x32_bf16 v[184:187], v[144:147], v[32:35], v[184:187]
    s_lshl_b32 s21, s21, 2
    s_mul_i32 s21, s21, 36864
    ds_read_b128 v[136:139], v6 offset:6144
    v_mfma_f32_16x16x32_bf16 v[184:187], v[148:151], v[40:43], v[184:187]
    s_add_u32 s21, s21, s28
    ds_read_b128 v[140:143], v6 offset:14336
    v_mfma_f32_16x16x32_bf16 v[188:191], v[144:147], v[36:39], v[188:191]
    s_add_u32 s21, s21, 7168
    s_add_u32 m0, s45, 0
    ds_read_b128 v[144:147], v6 offset:16384
    v_mfma_f32_16x16x32_bf16 v[188:191], v[148:151], v[44:47], v[188:191]
    buffer_load_dwordx4 v1, s[56:59], s21 offen sc1 lds
    v_mfma_f32_16x16x32_bf16 v[192:195], v[104:107], v[32:35], v[192:195]
    ds_read_b128 v[148:151], v6 offset:24576
    v_mfma_f32_16x16x32_bf16 v[192:195], v[108:111], v[40:43], v[192:195]
    v_mfma_f32_16x16x32_bf16 v[196:199], v[104:107], v[36:39], v[196:199]
    buffer_load_dwordx4 v1, s[56:59], s21 offen offset:1024 sc1 lds
    v_mfma_f32_16x16x32_bf16 v[196:199], v[108:111], v[44:47], v[196:199]
    s_add_u32 s21, s21, 36864
    v_mfma_f32_16x16x32_bf16 v[200:203], v[112:115], v[32:35], v[200:203]
    s_add_u32 m0, s45, 2048
    v_mfma_f32_16x16x32_bf16 v[200:203], v[116:119], v[40:43], v[200:203]
    v_mfma_f32_16x16x32_bf16 v[204:207], v[112:115], v[36:39], v[204:207]
    buffer_load_dwordx4 v1, s[56:59], s21 offen sc1 lds
    v_mfma_f32_16x16x32_bf16 v[204:207], v[116:119], v[44:47], v[204:207]
    s_waitcnt vmcnt(11)
    s_barrier
    ds_read_b128 v[104:107], v7 offset:0
    v_mfma_f32_16x16x32_bf16 v[208:211], v[120:123], v[32:35], v[208:211]
    s_waitcnt lgkmcnt(1)
    ds_read_b128 v[108:111], v7 offset:16384
    ds_read_b128 v[112:115], v6 offset:17408
    v_mfma_f32_16x16x32_bf16 v[208:211], v[124:127], v[40:43], v[208:211]
    ds_read_b128 v[116:119], v6 offset:25600
    v_mfma_f32_16x16x32_bf16 v[212:215], v[120:123], v[36:39], v[212:215]
    buffer_load_dwordx4 v1, s[56:59], s21 offen offset:1024 sc1 lds
    v_mfma_f32_16x16x32_bf16 v[212:215], v[124:127], v[44:47], v[212:215]
    s_add_u32 s21, s21, 36864
    ds_read_b128 v[120:123], v7 offset:1024
    ds_read_b128 v[124:127], v7 offset:17408
    v_mfma_f32_16x16x32_bf16 v[216:219], v[128:131], v[32:35], v[216:219]
    s_add_u32 m0, s45, 4096
    v_mfma_f32_16x16x32_bf16 v[216:219], v[132:135], v[40:43], v[216:219]
    v_mfma_f32_16x16x32_bf16 v[220:223], v[128:131], v[36:39], v[220:223]
    buffer_load_dwordx4 v1, s[56:59], s21 offen sc1 lds
    v_mfma_f32_16x16x32_bf16 v[220:223], v[132:135], v[44:47], v[220:223]
    ds_read_b128 v[128:131], v6 offset:18432
    ds_read_b128 v[132:135], v6 offset:26624
    v_mfma_f32_16x16x32_bf16 v[224:227], v[136:139], v[32:35], v[224:227]
    v_mfma_f32_16x16x32_bf16 v[224:227], v[140:143], v[40:43], v[224:227]
    v_mfma_f32_16x16x32_bf16 v[228:231], v[136:139], v[36:39], v[228:231]
    ds_read_b128 v[136:139], v7 offset:2048
    v_mfma_f32_16x16x32_bf16 v[228:231], v[140:143], v[44:47], v[228:231]
    buffer_load_dwordx4 v1, s[56:59], s21 offen offset:1024 sc1 lds
    v_mfma_f32_16x16x32_bf16 v[176:179], v[144:147], v[48:51], v[176:179]
    s_add_u32 s21, s21, 36864
    ds_read_b128 v[140:143], v7 offset:18432
    v_mfma_f32_16x16x32_bf16 v[176:179], v[148:151], v[56:59], v[176:179]
    s_add_u32 m0, s45, 6144
    s_waitcnt lgkmcnt(2)
    v_mfma_f32_16x16x32_bf16 v[176:179], v[104:107], v[64:67], v[176:179]
    v_mfma_f32_16x16x32_bf16 v[176:179], v[108:111], v[72:75], v[176:179]
    buffer_load_dwordx4 v1, s[56:59], s21 offen sc1 lds
    v_mfma_f32_16x16x32_bf16 v[180:183], v[144:147], v[52:55], v[180:183]
    ds_read_b128 v[144:147], v6 offset:19456
    v_mfma_f32_16x16x32_bf16 v[180:183], v[148:151], v[60:63], v[180:183]
    ds_read_b128 v[148:151], v6 offset:27648
    v_mfma_f32_16x16x32_bf16 v[180:183], v[104:107], v[68:71], v[180:183]
    ds_read_b128 v[104:107], v7 offset:3072
    v_mfma_f32_16x16x32_bf16 v[180:183], v[108:111], v[76:79], v[180:183]
    buffer_load_dwordx4 v1, s[56:59], s21 offen offset:1024 sc1 lds
    v_mfma_f32_16x16x32_bf16 v[184:187], v[112:115], v[48:51], v[184:187]
    s_add_u32 s21, s21, 36864
    v_cvt_pk_bf16_f32 v232, v176, v177
    v_cvt_pk_bf16_f32 v233, v178, v179
    v_mfma_f32_16x16x32_bf16 v[184:187], v[116:119], v[56:59], v[184:187]
    ds_read_b128 v[108:111], v7 offset:19456
    v_mfma_f32_16x16x32_bf16 v[184:187], v[120:123], v[64:67], v[184:187]
    v_cvt_pk_bf16_f32 v234, v180, v181
    v_cvt_pk_bf16_f32 v235, v182, v183
    v_mfma_f32_16x16x32_bf16 v[184:187], v[124:127], v[72:75], v[184:187]
    buffer_store_dwordx4 v[232:235], v1, s[48:51], s8 offen offset:0 sc1
    v_mfma_f32_16x16x32_bf16 v[188:191], v[112:115], v[52:55], v[188:191]
    ds_read_b128 v[112:115], v6 offset:20480
    v_mfma_f32_16x16x32_bf16 v[188:191], v[116:119], v[60:63], v[188:191]
    ds_read_b128 v[116:119], v6 offset:28672
    v_mfma_f32_16x16x32_bf16 v[188:191], v[120:123], v[68:71], v[188:191]
    ds_read_b128 v[120:123], v7 offset:8192
    v_mfma_f32_16x16x32_bf16 v[188:191], v[124:127], v[76:79], v[188:191]
    v_cvt_pk_bf16_f32 v236, v184, v185
    v_cvt_pk_bf16_f32 v237, v186, v187
    v_mfma_f32_16x16x32_bf16 v[192:195], v[128:131], v[48:51], v[192:195]
    ds_read_b128 v[124:127], v7 offset:24576
    v_mfma_f32_16x16x32_bf16 v[192:195], v[132:135], v[56:59], v[192:195]
    s_waitcnt lgkmcnt(3)
    v_mfma_f32_16x16x32_bf16 v[192:195], v[136:139], v[64:67], v[192:195]
    v_mfma_f32_16x16x32_bf16 v[192:195], v[140:143], v[72:75], v[192:195]
    v_mfma_f32_16x16x32_bf16 v[196:199], v[128:131], v[52:55], v[196:199]
    v_cvt_pk_bf16_f32 v238, v188, v189
    v_cvt_pk_bf16_f32 v239, v190, v191
    v_mfma_f32_16x16x32_bf16 v[196:199], v[132:135], v[60:63], v[196:199]
    buffer_store_dwordx4 v[236:239], v1, s[48:51], s8 offen offset:1024 sc1
    v_mfma_f32_16x16x32_bf16 v[196:199], v[136:139], v[68:71], v[196:199]
    ds_read_b128 v[128:131], v6 offset:21504
    ds_read_b128 v[132:135], v6 offset:29696
    v_mfma_f32_16x16x32_bf16 v[196:199], v[140:143], v[76:79], v[196:199]
    v_cvt_pk_bf16_f32 v240, v192, v193
    v_cvt_pk_bf16_f32 v241, v194, v195
    v_mfma_f32_16x16x32_bf16 v[200:203], v[144:147], v[48:51], v[200:203]
    ds_read_b128 v[136:139], v7 offset:9216
    ds_read_b128 v[140:143], v7 offset:25600
    v_mfma_f32_16x16x32_bf16 v[200:203], v[148:151], v[56:59], v[200:203]
    v_mfma_f32_16x16x32_bf16 v[200:203], v[104:107], v[64:67], v[200:203]
    v_mfma_f32_16x16x32_bf16 v[200:203], v[108:111], v[72:75], v[200:203]
    v_cvt_pk_bf16_f32 v242, v196, v197
    v_cvt_pk_bf16_f32 v243, v198, v199
    v_mfma_f32_16x16x32_bf16 v[204:207], v[144:147], v[52:55], v[204:207]
    buffer_store_dwordx4 v[240:243], v1, s[48:51], s9 offen offset:0 sc1
    v_mfma_f32_16x16x32_bf16 v[204:207], v[148:151], v[60:63], v[204:207]
    ds_read_b128 v[144:147], v6 offset:22528
    ds_read_b128 v[148:151], v6 offset:30720
    v_mfma_f32_16x16x32_bf16 v[204:207], v[104:107], v[68:71], v[204:207]
    v_cvt_pk_bf16_f32 v244, v200, v201
    v_cvt_pk_bf16_f32 v245, v202, v203
    v_mfma_f32_16x16x32_bf16 v[204:207], v[108:111], v[76:79], v[204:207]
    ds_read_b128 v[104:107], v7 offset:10240
    ds_read_b128 v[108:111], v7 offset:26624
    v_mfma_f32_16x16x32_bf16 v[208:211], v[112:115], v[48:51], v[208:211]
    s_waitcnt lgkmcnt(4)
    v_mfma_f32_16x16x32_bf16 v[208:211], v[116:119], v[56:59], v[208:211]
    v_mfma_f32_16x16x32_bf16 v[208:211], v[120:123], v[64:67], v[208:211]
    v_mfma_f32_16x16x32_bf16 v[208:211], v[124:127], v[72:75], v[208:211]
    v_mfma_f32_16x16x32_bf16 v[212:215], v[112:115], v[52:55], v[212:215]
    v_mfma_f32_16x16x32_bf16 v[212:215], v[116:119], v[60:63], v[212:215]
    v_cvt_pk_bf16_f32 v246, v204, v205
    v_cvt_pk_bf16_f32 v247, v206, v207
    v_mfma_f32_16x16x32_bf16 v[212:215], v[120:123], v[68:71], v[212:215]
    buffer_store_dwordx4 v[244:247], v1, s[48:51], s9 offen offset:1024 sc1
    v_mfma_f32_16x16x32_bf16 v[212:215], v[124:127], v[76:79], v[212:215]
    v_mfma_f32_16x16x32_bf16 v[216:219], v[128:131], v[48:51], v[216:219]
    v_cvt_pk_bf16_f32 v232, v208, v209
    v_cvt_pk_bf16_f32 v233, v210, v211
    v_mfma_f32_16x16x32_bf16 v[216:219], v[132:135], v[56:59], v[216:219]
    v_mfma_f32_16x16x32_bf16 v[216:219], v[136:139], v[64:67], v[216:219]
    v_mfma_f32_16x16x32_bf16 v[216:219], v[140:143], v[72:75], v[216:219]
    s_waitcnt vmcnt(12)
    s_barrier
    v_cvt_pk_bf16_f32 v234, v212, v213
    v_mfma_f32_16x16x32_bf16 v[220:223], v[128:131], v[52:55], v[220:223]
    v_cvt_pk_bf16_f32 v235, v214, v215
    ds_read_b128 v[112:115], v11 offset:0
    v_mfma_f32_16x16x32_bf16 v[220:223], v[132:135], v[60:63], v[220:223]
    buffer_store_dwordx4 v[232:235], v1, s[48:51], s10 offen offset:0 sc1
    v_mfma_f32_16x16x32_bf16 v[220:223], v[136:139], v[68:71], v[220:223]
    ds_read_b128 v[116:119], v11 offset:2048
    ds_read_b128 v[120:123], v11 offset:4096
    v_mfma_f32_16x16x32_bf16 v[220:223], v[140:143], v[76:79], v[220:223]
    s_waitcnt lgkmcnt(3)
    ds_read_b128 v[124:127], v11 offset:6144
    v_cvt_pk_bf16_f32 v236, v216, v217
    v_mfma_f32_16x16x32_bf16 v[224:227], v[144:147], v[48:51], v[224:227]
    v_cvt_pk_bf16_f32 v237, v218, v219
    ds_read_b128 v[128:131], v11 offset:1024
    v_mfma_f32_16x16x32_bf16 v[224:227], v[148:151], v[56:59], v[224:227]
    ds_read_b128 v[132:135], v11 offset:3072
    v_mfma_f32_16x16x32_bf16 v[224:227], v[104:107], v[64:67], v[224:227]
    v_cvt_pk_bf16_f32 v238, v220, v221
    v_cvt_pk_bf16_f32 v239, v222, v223
    v_mfma_f32_16x16x32_bf16 v[224:227], v[108:111], v[72:75], v[224:227]
    buffer_store_dwordx4 v[236:239], v1, s[48:51], s10 offen offset:1024 sc1
    v_mfma_f32_16x16x32_bf16 v[228:231], v[144:147], v[52:55], v[228:231]
    ds_read_b128 v[136:139], v11 offset:5120
    ds_read_b128 v[140:143], v11 offset:7168
    v_mfma_f32_16x16x32_bf16 v[228:231], v[148:151], v[60:63], v[228:231]
    ds_read_b128 v[144:147], v11 offset:8192
    v_mfma_f32_16x16x32_bf16 v[228:231], v[104:107], v[68:71], v[228:231]
    ds_read_b128 v[148:151], v11 offset:10240
    v_cvt_pk_bf16_f32 v240, v224, v225
    v_mfma_f32_16x16x32_bf16 v[228:231], v[108:111], v[76:79], v[228:231]
    s_waitcnt lgkmcnt(4)
    v_cvt_pk_bf16_f32 v241, v226, v227
    ds_read_b128 v[104:107], v11 offset:12288
    v_mfma_f32_16x16x32_bf16 v[160:163], v[112:115], a[0:3], 0
    ds_read_b128 v[108:111], v11 offset:14336
    v_mfma_f32_16x16x32_bf16 v[160:163], v[116:119], a[8:11], v[160:163]
    v_mfma_f32_16x16x32_bf16 v[160:163], v[120:123], a[16:19], v[160:163]
    v_mfma_f32_16x16x32_bf16 v[160:163], v[124:127], a[24:27], v[160:163]
    v_mfma_f32_16x16x32_bf16 v[164:167], v[112:115], a[4:7], 0
    v_cvt_pk_bf16_f32 v242, v228, v229
    v_cvt_pk_bf16_f32 v243, v230, v231
    v_mfma_f32_16x16x32_bf16 v[164:167], v[116:119], a[12:15], v[164:167]
    buffer_store_dwordx4 v[240:243], v1, s[48:51], s11 offen offset:2048 sc1
    v_mfma_f32_16x16x32_bf16 v[164:167], v[120:123], a[20:23], v[164:167]
    ds_read_b128 v[112:115], v11 offset:9216
    ds_read_b128 v[116:119], v11 offset:11264
    v_mfma_f32_16x16x32_bf16 v[164:167], v[124:127], a[28:31], v[164:167]
    ds_read_b128 v[120:123], v11 offset:13312
    v_mfma_f32_16x16x32_bf16 v[168:171], v[128:131], a[0:3], 0
    ds_read_b128 v[124:127], v11 offset:15360
    v_mfma_f32_16x16x32_bf16 v[168:171], v[132:135], a[8:11], v[168:171]
    s_waitcnt lgkmcnt(4)
    v_mfma_f32_16x16x32_bf16 v[168:171], v[136:139], a[16:19], v[168:171]
    v_mfma_f32_16x16x32_bf16 v[168:171], v[140:143], a[24:27], v[168:171]
    v_mfma_f32_16x16x32_bf16 v[172:175], v[128:131], a[4:7], 0
    ds_read_b128 v[128:131], v11 offset:16384
    v_mfma_f32_16x16x32_bf16 v[172:175], v[132:135], a[12:15], v[172:175]
    ds_read_b128 v[132:135], v11 offset:18432
    v_mfma_f32_16x16x32_bf16 v[172:175], v[136:139], a[20:23], v[172:175]
    ds_read_b128 v[136:139], v11 offset:20480
    v_mfma_f32_16x16x32_bf16 v[172:175], v[140:143], a[28:31], v[172:175]
    ds_read_b128 v[140:143], v11 offset:22528
    v_mfma_f32_16x16x32_bf16 v[160:163], v[144:147], a[32:35], v[160:163]
    v_mfma_f32_16x16x32_bf16 v[160:163], v[148:151], a[40:43], v[160:163]
    v_mfma_f32_16x16x32_bf16 v[160:163], v[104:107], a[48:51], v[160:163]
    v_mfma_f32_16x16x32_bf16 v[160:163], v[108:111], a[56:59], v[160:163]
    v_mfma_f32_16x16x32_bf16 v[164:167], v[144:147], a[36:39], v[164:167]
    ds_read_b128 v[144:147], v11 offset:17408
    v_mfma_f32_16x16x32_bf16 v[164:167], v[148:151], a[44:47], v[164:167]
    ds_read_b128 v[148:151], v11 offset:19456
    v_mfma_f32_16x16x32_bf16 v[164:167], v[104:107], a[52:55], v[164:167]
    ds_read_b128 v[104:107], v11 offset:21504
    v_mfma_f32_16x16x32_bf16 v[164:167], v[108:111], a[60:63], v[164:167]
    s_waitcnt lgkmcnt(3)
    ds_read_b128 v[108:111], v11 offset:23552
    v_mfma_f32_16x16x32_bf16 v[168:171], v[112:115], a[32:35], v[168:171]
    v_mfma_f32_16x16x32_bf16 v[168:171], v[116:119], a[40:43], v[168:171]
    v_mfma_f32_16x16x32_bf16 v[168:171], v[120:123], a[48:51], v[168:171]
    v_mfma_f32_16x16x32_bf16 v[168:171], v[124:127], a[56:59], v[168:171]
    v_mfma_f32_16x16x32_bf16 v[172:175], v[112:115], a[36:39], v[172:175]
    ds_read_b128 v[112:115], v11 offset:24576
    v_mfma_f32_16x16x32_bf16 v[172:175], v[116:119], a[44:47], v[172:175]
    ds_read_b128 v[116:119], v11 offset:26624
    v_mfma_f32_16x16x32_bf16 v[172:175], v[120:123], a[52:55], v[172:175]
    ds_read_b128 v[120:123], v11 offset:28672
    v_mfma_f32_16x16x32_bf16 v[172:175], v[124:127], a[60:63], v[172:175]
    ds_read_b128 v[124:127], v11 offset:30720
    v_mfma_f32_16x16x32_bf16 v[160:163], v[128:131], a[64:67], v[160:163]
    v_mfma_f32_16x16x32_bf16 v[160:163], v[132:135], a[72:75], v[160:163]
    v_mfma_f32_16x16x32_bf16 v[160:163], v[136:139], a[80:83], v[160:163]
    v_mfma_f32_16x16x32_bf16 v[160:163], v[140:143], a[88:91], v[160:163]
    v_mfma_f32_16x16x32_bf16 v[164:167], v[128:131], a[68:71], v[164:167]
    ds_read_b128 v[128:131], v11 offset:25600
    v_mfma_f32_16x16x32_bf16 v[164:167], v[132:135], a[76:79], v[164:167]
    ds_read_b128 v[132:135], v11 offset:27648
    v_mfma_f32_16x16x32_bf16 v[164:167], v[136:139], a[84:87], v[164:167]
    ds_read_b128 v[136:139], v11 offset:29696
    v_mfma_f32_16x16x32_bf16 v[164:167], v[140:143], a[92:95], v[164:167]
    s_waitcnt lgkmcnt(3)
    ds_read_b128 v[140:143], v11 offset:31744
    v_mfma_f32_16x16x32_bf16 v[168:171], v[144:147], a[64:67], v[168:171]
    v_mfma_f32_16x16x32_bf16 v[168:171], v[148:151], a[72:75], v[168:171]
    v_mfma_f32_16x16x32_bf16 v[168:171], v[104:107], a[80:83], v[168:171]
    v_mfma_f32_16x16x32_bf16 v[168:171], v[108:111], a[88:91], v[168:171]
    v_mfma_f32_16x16x32_bf16 v[172:175], v[144:147], a[68:71], v[172:175]
    v_mfma_f32_16x16x32_bf16 v[172:175], v[148:151], a[76:79], v[172:175]
    v_mfma_f32_16x16x32_bf16 v[172:175], v[104:107], a[84:87], v[172:175]
    v_mfma_f32_16x16x32_bf16 v[172:175], v[108:111], a[92:95], v[172:175]
    v_mfma_f32_16x16x32_bf16 v[160:163], v[112:115], a[96:99], v[160:163]
    v_mfma_f32_16x16x32_bf16 v[160:163], v[116:119], a[104:107], v[160:163]
    v_mfma_f32_16x16x32_bf16 v[160:163], v[120:123], a[112:115], v[160:163]
    s_waitcnt vmcnt(0)
    buffer_store_dword v31, v23, s[32:35], s74 offen sc1
    v_mfma_f32_16x16x32_bf16 v[160:163], v[124:127], a[120:123], v[160:163]
    s_waitcnt vmcnt(8)
    s_barrier
    ds_read_b128 v[144:147], v12 offset:0
    v_mfma_f32_16x16x32_bf16 v[164:167], v[112:115], a[100:103], v[164:167]
    ds_read_b128 v[148:151], v12 offset:2048
    ds_read_b128 v[104:107], v12 offset:4096
    v_mfma_f32_16x16x32_bf16 v[164:167], v[116:119], a[108:111], v[164:167]
    ds_read_b128 v[108:111], v12 offset:6144
    v_mfma_f32_16x16x32_bf16 v[164:167], v[120:123], a[116:119], v[164:167]
    ds_read_b128 v[112:115], v12 offset:1024
    v_mfma_f32_16x16x32_bf16 v[164:167], v[124:127], a[124:127], v[164:167]
    s_lshr_b32 s64, s4, 1
    s_lshl1_add_u32 s21, s61, s64
    s_mul_i32 s21, s21, 3
    s_waitcnt lgkmcnt(5)
    v_mfma_f32_16x16x32_bf16 v[168:171], v[128:131], a[96:99], v[168:171]
    s_add_u32 s21, s21, 128
    s_mul_i32 s21, s21, 36864
    s_add_u32 s21, s21, s28
    v_mfma_f32_16x16x32_bf16 v[168:171], v[132:135], a[104:107], v[168:171]
    s_add_u32 s21, s21, 7168
    s_and_b32 s64, s68, 1024
    s_add_u32 s21, s21, s64
    v_mfma_f32_16x16x32_bf16 v[168:171], v[136:139], a[112:115], v[168:171]
    s_add_u32 m0, s46, 0
    ds_read_b128 v[116:119], v12 offset:3072
    ds_read_b128 v[120:123], v12 offset:5120
    v_mfma_f32_16x16x32_bf16 v[168:171], v[140:143], a[120:123], v[168:171]
    s_lshl2_add_u32 s64, s61, s65
    buffer_load_dwordx4 v1, s[56:59], s21 offen sc1 lds
    v_mfma_f32_16x16x32_bf16 v[172:175], v[128:131], a[100:103], v[172:175]
    s_add_u32 s21, s21, 36864
    ds_read_b128 v[124:127], v12 offset:7168
    ds_read_b128 v[128:131], v12 offset:8192
    v_mfma_f32_16x16x32_bf16 v[172:175], v[132:135], a[108:111], v[172:175]
    s_add_u32 m0, s46, 1024
    ds_read_b128 v[132:135], v12 offset:10240
    s_lshl_b32 s65, s65, 5
    v_mfma_f32_16x16x32_bf16 v[172:175], v[136:139], a[116:119], v[172:175]
    s_add_u32 s65, s65, 1024
    buffer_load_dwordx4 v1, s[56:59], s21 offen sc1 lds
    v_mfma_f32_16x16x32_bf16 v[172:175], v[140:143], a[124:127], v[172:175]
    s_add_u32 s21, s21, 36864
    ds_read_b128 v[136:139], v12 offset:12288
    ds_read_b128 v[140:143], v12 offset:14336
    s_waitcnt lgkmcnt(5)
    v_mfma_f32_16x16x32_bf16 v[160:163], v[144:147], a[128:131], v[160:163]
    s_add_u32 m0, s46, 2048
    s_lshl_b32 s64, s64, 6
    v_mfma_f32_16x16x32_bf16 v[160:163], v[148:151], a[136:139], v[160:163]
    s_cmp_eq_u32 s4, s61
    s_cselect_b32 s65, s65, 1073741824
    s_cselect_b32 s70, s23, 1073741824
    v_mfma_f32_16x16x32_bf16 v[160:163], v[104:107], a[144:147], v[160:163]
    s_add_u32 s98, s70, 0
    buffer_load_dwordx4 v1, s[56:59], s21 offen sc1 lds
    v_mfma_f32_16x16x32_bf16 v[160:163], v[108:111], a[152:155], v[160:163]
    s_add_u32 s21, s21, 36864
    v_mfma_f32_16x16x32_bf16 v[164:167], v[144:147], a[132:135], v[164:167]
    ds_read_b128 v[144:147], v12 offset:9216
    v_mfma_f32_16x16x32_bf16 v[164:167], v[148:151], a[140:143], v[164:167]
    ds_read_b128 v[148:151], v12 offset:11264
    v_mfma_f32_16x16x32_bf16 v[164:167], v[104:107], a[148:151], v[164:167]
    ds_read_b128 v[104:107], v12 offset:13312
    v_mfma_f32_16x16x32_bf16 v[164:167], v[108:111], a[156:159], v[164:167]
    ds_read_b128 v[108:111], v12 offset:15360
    v_mfma_f32_16x16x32_bf16 v[168:171], v[112:115], a[128:131], v[168:171]
    v_mfma_f32_16x16x32_bf16 v[168:171], v[116:119], a[136:139], v[168:171]
    v_mfma_f32_16x16x32_bf16 v[168:171], v[120:123], a[144:147], v[168:171]
    s_waitcnt lgkmcnt(2)
    v_mfma_f32_16x16x32_bf16 v[168:171], v[124:127], a[152:155], v[168:171]
    v_mfma_f32_16x16x32_bf16 v[172:175], v[112:115], a[132:135], v[172:175]
    ds_read_b128 v[112:115], v12 offset:16384
    v_mfma_f32_16x16x32_bf16 v[172:175], v[116:119], a[140:143], v[172:175]
    ds_read_b128 v[116:119], v12 offset:18432
    v_mfma_f32_16x16x32_bf16 v[172:175], v[120:123], a[148:151], v[172:175]
    ds_read_b128 v[120:123], v12 offset:20480
    v_mfma_f32_16x16x32_bf16 v[172:175], v[124:127], a[156:159], v[172:175]
    ds_read_b128 v[124:127], v12 offset:22528
    v_mfma_f32_16x16x32_bf16 v[160:163], v[128:131], a[160:163], v[160:163]
    v_mfma_f32_16x16x32_bf16 v[160:163], v[132:135], a[168:171], v[160:163]
    v_mfma_f32_16x16x32_bf16 v[160:163], v[136:139], a[176:179], v[160:163]
    v_mfma_f32_16x16x32_bf16 v[160:163], v[140:143], a[184:187], v[160:163]
    v_mfma_f32_16x16x32_bf16 v[164:167], v[128:131], a[164:167], v[164:167]
    ds_read_b128 v[128:131], v12 offset:17408
    v_mfma_f32_16x16x32_bf16 v[164:167], v[132:135], a[172:175], v[164:167]
    buffer_load_dword v3, v19, s[32:35], s66 offen sc1
    v_mfma_f32_16x16x32_bf16 v[164:167], v[136:139], a[180:183], v[164:167]
    ds_read_b128 v[132:135], v12 offset:19456
    ds_read_b128 v[136:139], v12 offset:21504
    v_mfma_f32_16x16x32_bf16 v[164:167], v[140:143], a[188:191], v[164:167]
    ds_read_b128 v[140:143], v12 offset:23552
    v_mfma_f32_16x16x32_bf16 v[168:171], v[144:147], a[160:163], v[168:171]
    v_mfma_f32_16x16x32_bf16 v[168:171], v[148:151], a[168:171], v[168:171]
    s_waitcnt lgkmcnt(3)
    v_mfma_f32_16x16x32_bf16 v[168:171], v[104:107], a[176:179], v[168:171]
    v_mfma_f32_16x16x32_bf16 v[168:171], v[108:111], a[184:187], v[168:171]
    v_mfma_f32_16x16x32_bf16 v[172:175], v[144:147], a[164:167], v[172:175]
    ds_read_b128 v[144:147], v12 offset:24576
    v_mfma_f32_16x16x32_bf16 v[172:175], v[148:151], a[172:175], v[172:175]
    ds_read_b128 v[148:151], v12 offset:26624
    v_mfma_f32_16x16x32_bf16 v[172:175], v[104:107], a[180:183], v[172:175]
    ds_read_b128 v[104:107], v12 offset:28672
    v_mfma_f32_16x16x32_bf16 v[172:175], v[108:111], a[188:191], v[172:175]
    ds_read_b128 v[108:111], v12 offset:30720
    v_mfma_f32_16x16x32_bf16 v[160:163], v[112:115], a[192:195], v[160:163]
    v_mfma_f32_16x16x32_bf16 v[160:163], v[116:119], a[200:203], v[160:163]
    v_mfma_f32_16x16x32_bf16 v[160:163], v[120:123], a[208:211], v[160:163]
    v_mfma_f32_16x16x32_bf16 v[160:163], v[124:127], a[216:219], v[160:163]
    v_mfma_f32_16x16x32_bf16 v[164:167], v[112:115], a[196:199], v[164:167]
    ds_read_b128 v[112:115], v12 offset:25600
    v_mfma_f32_16x16x32_bf16 v[164:167], v[116:119], a[204:207], v[164:167]
    ds_read_b128 v[116:119], v12 offset:27648
    v_mfma_f32_16x16x32_bf16 v[164:167], v[120:123], a[212:215], v[164:167]
    ds_read_b128 v[120:123], v12 offset:29696
    v_mfma_f32_16x16x32_bf16 v[164:167], v[124:127], a[220:223], v[164:167]
    ds_read_b128 v[124:127], v12 offset:31744
    v_mfma_f32_16x16x32_bf16 v[168:171], v[128:131], a[192:195], v[168:171]
    s_waitcnt lgkmcnt(4)
    v_mfma_f32_16x16x32_bf16 v[168:171], v[132:135], a[200:203], v[168:171]
    v_mfma_f32_16x16x32_bf16 v[168:171], v[136:139], a[208:211], v[168:171]
    v_mfma_f32_16x16x32_bf16 v[168:171], v[140:143], a[216:219], v[168:171]
    v_mfma_f32_16x16x32_bf16 v[172:175], v[128:131], a[196:199], v[172:175]
    v_mfma_f32_16x16x32_bf16 v[172:175], v[132:135], a[204:207], v[172:175]
    v_mfma_f32_16x16x32_bf16 v[172:175], v[136:139], a[212:215], v[172:175]
    v_mfma_f32_16x16x32_bf16 v[172:175], v[140:143], a[220:223], v[172:175]
    v_mfma_f32_16x16x32_bf16 v[160:163], v[144:147], a[224:227], v[160:163]
    s_waitcnt vmcnt(0)
    v_cmp_gt_u32 vcc, 3, v3
    s_nop 1
    s_and_b64 vcc, vcc, exec
    s_cbranch_scc1 SPIN_X
BACK_X:
    v_mfma_f32_16x16x32_bf16 v[160:163], v[148:151], a[232:235], v[160:163]
    buffer_load_dwordx4 v[200:203], v1, s[48:51], s98 offen offset:2048 sc1
    v_mfma_f32_16x16x32_bf16 v[160:163], v[104:107], a[240:243], v[160:163]
    s_add_u32 s98, s70, 12288
    buffer_load_dwordx4 v[204:207], v1, s[48:51], s98 offen offset:2048 sc1
    v_mfma_f32_16x16x32_bf16 v[160:163], v[108:111], a[248:251], v[160:163]
    s_waitcnt vmcnt(3)
    s_barrier
    ds_read_b128 v[128:131], v13 offset:0
    v_mfma_f32_16x16x32_bf16 v[164:167], v[144:147], a[228:231], v[164:167]
    s_add_u32 s98, s70, 24576
    ds_read_b128 v[132:135], v13 offset:1024
    ds_read_b128 v[136:139], v13 offset:2048
    v_mfma_f32_16x16x32_bf16 v[164:167], v[148:151], a[236:239], v[164:167]
    buffer_load_dwordx4 v[208:211], v1, s[48:51], s98 offen offset:2048 sc1
    v_mfma_f32_16x16x32_bf16 v[164:167], v[104:107], a[244:247], v[164:167]
    s_add_u32 s98, s23, 0
    ds_read_b128 v[140:143], v13 offset:8192
    ds_read_b128 v[144:147], v13 offset:9216
    v_mfma_f32_16x16x32_bf16 v[164:167], v[108:111], a[252:255], v[164:167]
    s_waitcnt lgkmcnt(5)
    ds_read_b128 v[148:151], v13 offset:10240
    v_mfma_f32_16x16x32_bf16 v[168:171], v[112:115], a[224:227], v[168:171]
    ds_read_b128 v[104:107], v13 offset:16384
    v_mfma_f32_16x16x32_bf16 v[168:171], v[116:119], a[232:235], v[168:171]
    buffer_load_dwordx4 v[176:179], v1, s[48:51], s98 offen offset:0 sc1
    v_mfma_f32_16x16x32_bf16 v[168:171], v[120:123], a[240:243], v[168:171]
    s_add_u32 s98, s23, 12288
    ds_read_b128 v[108:111], v13 offset:17408
    v_mfma_f32_16x16x32_bf16 v[168:171], v[124:127], a[248:251], v[168:171]
    v_mfma_f32_16x16x32_bf16 v[172:175], v[112:115], a[228:231], v[172:175]
    ds_read_b128 v[112:115], v13 offset:18432
    v_mfma_f32_16x16x32_bf16 v[172:175], v[116:119], a[236:239], v[172:175]
    buffer_load_dwordx4 v[180:183], v1, s[48:51], s98 offen offset:0 sc1
    v_mfma_f32_16x16x32_bf16 v[172:175], v[120:123], a[244:247], v[172:175]
    s_add_u32 s98, s23, 24576
    ds_read_b128 v[116:119], v13 offset:24576
    ds_read_b128 v[120:123], v13 offset:25600
    v_mfma_f32_16x16x32_bf16 v[172:175], v[124:127], a[252:255], v[172:175]
    s_waitcnt lgkmcnt(3)
    ds_read_b128 v[124:127], v13 offset:26624
    v_mfma_f32_16x16x32_bf16 v[160:163], v[128:131], v[32:35], v[160:163]
    v_mfma_f32_16x16x32_bf16 v[160:163], v[132:135], v[40:43], v[160:163]
    buffer_load_dwordx4 v[184:187], v1, s[48:51], s98 offen offset:0 sc1
    v_mfma_f32_16x16x32_bf16 v[160:163], v[136:139], v[48:51], v[160:163]
    s_add_u32 s98, s23, 0
    v_mfma_f32_16x16x32_bf16 v[164:167], v[128:131], v[36:39], v[164:167]
    v_mfma_f32_16x16x32_bf16 v[164:167], v[132:135], v[44:47], v[164:167]
    v_mfma_f32_16x16x32_bf16 v[164:167], v[136:139], v[52:55], v[164:167]
    buffer_load_dwordx4 v[188:191], v1, s[48:51], s98 offen offset:1024 sc1
    v_mfma_f32_16x16x32_bf16 v[168:171], v[140:143], v[32:35], v[168:171]
    s_add_u32 s98, s23, 12288
    v_mfma_f32_16x16x32_bf16 v[168:171], v[144:147], v[40:43], v[168:171]
    v_mfma_f32_16x16x32_bf16 v[168:171], v[148:151], v[48:51], v[168:171]
    v_mfma_f32_16x16x32_bf16 v[172:175], v[140:143], v[36:39], v[172:175]
    buffer_load_dwordx4 v[192:195], v1, s[48:51], s98 offen offset:1024 sc1
    v_mfma_f32_16x16x32_bf16 v[172:175], v[144:147], v[44:47], v[172:175]
    s_add_u32 s98, s23, 24576
    v_mfma_f32_16x16x32_bf16 v[172:175], v[148:151], v[52:55], v[172:175]
    v_mfma_f32_16x16x32_bf16 v[160:163], v[104:107], v[56:59], v[160:163]
    v_mfma_f32_16x16x32_bf16 v[160:163], v[108:111], v[64:67], v[160:163]
    s_waitcnt lgkmcnt(0)
    buffer_load_dwordx4 v[196:199], v1, s[48:51], s98 offen offset:1024 sc1
    v_mfma_f32_16x16x32_bf16 v[160:163], v[112:115], v[72:75], v[160:163]
    v_mfma_f32_16x16x32_bf16 v[164:167], v[104:107], v[60:63], v[164:167]
    v_mfma_f32_16x16x32_bf16 v[164:167], v[108:111], v[68:71], v[164:167]
    v_mfma_f32_16x16x32_bf16 v[164:167], v[112:115], v[76:79], v[164:167]
    v_mfma_f32_16x16x32_bf16 v[168:171], v[116:119], v[56:59], v[168:171]
    v_mfma_f32_16x16x32_bf16 v[168:171], v[120:123], v[64:67], v[168:171]
    v_mfma_f32_16x16x32_bf16 v[168:171], v[124:127], v[72:75], v[168:171]
    v_mfma_f32_16x16x32_bf16 v[172:175], v[116:119], v[60:63], v[172:175]
    v_mfma_f32_16x16x32_bf16 v[172:175], v[120:123], v[68:71], v[172:175]
    v_mfma_f32_16x16x32_bf16 v[172:175], v[124:127], v[76:79], v[172:175]
    s_cmp_lg_u32 s4, s61
    s_cbranch_scc1 K1_X2
    s_waitcnt vmcnt(6)
    v_lshlrev_b32 v80, 16, v200
    v_and_b32 v81, 0xffff0000, v200
    v_lshlrev_b32 v82, 16, v204
    v_and_b32 v83, 0xffff0000, v204
    v_lshlrev_b32 v84, 16, v208
    v_and_b32 v85, 0xffff0000, v208
    v_pk_add_f32 v[80:81], v[80:81], v[82:83]
    v_pk_add_f32 v[224:225], v[224:225], v[84:85]
    v_pk_add_f32 v[224:225], v[224:225], v[80:81]
    v_cvt_pk_bf16_f32 v200, v224, v225
    v_lshlrev_b32 v86, 16, v201
    v_and_b32 v87, 0xffff0000, v201
    v_lshlrev_b32 v88, 16, v205
    v_and_b32 v89, 0xffff0000, v205
    v_lshlrev_b32 v90, 16, v209
    v_and_b32 v91, 0xffff0000, v209
    v_pk_add_f32 v[86:87], v[86:87], v[88:89]
    v_pk_add_f32 v[226:227], v[226:227], v[90:91]
    v_pk_add_f32 v[226:227], v[226:227], v[86:87]
    v_cvt_pk_bf16_f32 v201, v226, v227
    buffer_store_dwordx2 v[200:201], v20, s[24:27], s65 offen
    v_lshlrev_b32 v92, 16, v202
    v_and_b32 v93, 0xffff0000, v202
    v_lshlrev_b32 v94, 16, v206
    v_and_b32 v95, 0xffff0000, v206
    v_lshlrev_b32 v96, 16, v210
    v_and_b32 v97, 0xffff0000, v210
    v_pk_add_f32 v[92:93], v[92:93], v[94:95]
    v_pk_add_f32 v[228:229], v[228:229], v[96:97]
    v_pk_add_f32 v[228:229], v[228:229], v[92:93]
    v_cvt_pk_bf16_f32 v202, v228, v229
    v_lshlrev_b32 v98, 16, v203
    v_and_b32 v99, 0xffff0000, v203
    v_lshlrev_b32 v100, 16, v207
    v_and_b32 v101, 0xffff0000, v207
    v_lshlrev_b32 v102, 16, v211
    v_and_b32 v103, 0xffff0000, v211
    v_pk_add_f32 v[98:99], v[98:99], v[100:101]
    v_pk_add_f32 v[230:231], v[230:231], v[102:103]
    v_pk_add_f32 v[230:231], v[230:231], v[98:99]
    v_cvt_pk_bf16_f32 v203, v230, v231
    buffer_store_dwordx2 v[202:203], v21, s[24:27], s65 offen
    s_waitcnt vmcnt(2)
K1_X2:
    s_waitcnt vmcnt(3)
    v_lshlrev_b32 v80, 16, v176
    v_and_b32 v81, 0xffff0000, v176
    v_lshlrev_b32 v82, 16, v180
    v_and_b32 v83, 0xffff0000, v180
    v_lshlrev_b32 v84, 16, v184
    v_and_b32 v85, 0xffff0000, v184
    v_pk_add_f32 v[80:81], v[80:81], v[82:83]
    v_pk_add_f32 v[160:161], v[160:161], v[84:85]
    v_pk_add_f32 v[160:161], v[160:161], v[80:81]
    v_cvt_pk_bf16_f32 v176, v160, v161
    v_lshlrev_b32 v86, 16, v177
    v_and_b32 v87, 0xffff0000, v177
    v_lshlrev_b32 v88, 16, v181
    v_and_b32 v89, 0xffff0000, v181
    v_lshlrev_b32 v90, 16, v185
    v_and_b32 v91, 0xffff0000, v185
    v_pk_add_f32 v[86:87], v[86:87], v[88:89]
    v_pk_add_f32 v[162:163], v[162:163], v[90:91]
    v_pk_add_f32 v[162:163], v[162:163], v[86:87]
    v_cvt_pk_bf16_f32 v177, v162, v163
    buffer_store_dwordx2 v[176:177], v20, s[24:27], s64 offen
    v_lshlrev_b32 v92, 16, v178
    v_and_b32 v93, 0xffff0000, v178
    v_lshlrev_b32 v94, 16, v182
    v_and_b32 v95, 0xffff0000, v182
    v_lshlrev_b32 v96, 16, v186
    v_and_b32 v97, 0xffff0000, v186
    v_pk_add_f32 v[92:93], v[92:93], v[94:95]
    v_pk_add_f32 v[164:165], v[164:165], v[96:97]
    v_pk_add_f32 v[164:165], v[164:165], v[92:93]
    v_cvt_pk_bf16_f32 v178, v164, v165
    v_lshlrev_b32 v98, 16, v179
    v_and_b32 v99, 0xffff0000, v179
    v_lshlrev_b32 v100, 16, v183
    v_and_b32 v101, 0xffff0000, v183
    v_lshlrev_b32 v102, 16, v187
    v_and_b32 v103, 0xffff0000, v187
    v_pk_add_f32 v[98:99], v[98:99], v[100:101]
    v_pk_add_f32 v[166:167], v[166:167], v[102:103]
    v_pk_add_f32 v[166:167], v[166:167], v[98:99]
    v_cvt_pk_bf16_f32 v179, v166, v167
    buffer_store_dwordx2 v[178:179], v21, s[24:27], s64 offen
    s_waitcnt vmcnt(2)
    v_lshlrev_b32 v80, 16, v188
    v_and_b32 v81, 0xffff0000, v188
    v_lshlrev_b32 v82, 16, v192
    v_and_b32 v83, 0xffff0000, v192
    v_lshlrev_b32 v84, 16, v196
    v_and_b32 v85, 0xffff0000, v196
    v_pk_add_f32 v[80:81], v[80:81], v[82:83]
    v_pk_add_f32 v[168:169], v[168:169], v[84:85]
    v_pk_add_f32 v[168:169], v[168:169], v[80:81]
    v_cvt_pk_bf16_f32 v188, v168, v169
    v_lshlrev_b32 v86, 16, v189
    v_and_b32 v87, 0xffff0000, v189
    v_lshlrev_b32 v88, 16, v193
    v_and_b32 v89, 0xffff0000, v193
    v_lshlrev_b32 v90, 16, v197
    v_and_b32 v91, 0xffff0000, v197
    v_pk_add_f32 v[86:87], v[86:87], v[88:89]
    v_pk_add_f32 v[170:171], v[170:171], v[90:91]
    v_pk_add_f32 v[170:171], v[170:171], v[86:87]
    v_cvt_pk_bf16_f32 v189, v170, v171
    buffer_store_dwordx2 v[188:189], v20, s[24:27], s64 offen offset:32
    v_lshlrev_b32 v92, 16, v190
    v_and_b32 v93, 0xffff0000, v190
    v_lshlrev_b32 v94, 16, v194
    v_and_b32 v95, 0xffff0000, v194
    v_lshlrev_b32 v96, 16, v198
    v_and_b32 v97, 0xffff0000, v198
    v_pk_add_f32 v[92:93], v[92:93], v[94:95]
    v_pk_add_f32 v[172:173], v[172:173], v[96:97]
    v_pk_add_f32 v[172:173], v[172:173], v[92:93]
    v_cvt_pk_bf16_f32 v190, v172, v173
    v_lshlrev_b32 v98, 16, v191
    v_and_b32 v99, 0xffff0000, v191
    v_lshlrev_b32 v100, 16, v195
    v_and_b32 v101, 0xffff0000, v195
    v_lshlrev_b32 v102, 16, v199
    v_and_b32 v103, 0xffff0000, v199
    v_pk_add_f32 v[98:99], v[98:99], v[100:101]
    v_pk_add_f32 v[174:175], v[174:175], v[102:103]
    v_pk_add_f32 v[174:175], v[174:175], v[98:99]
    v_cvt_pk_bf16_f32 v191, v174, v175
    buffer_store_dwordx2 v[190:191], v21, s[24:27], s64 offen offset:32
K1_END:
    s_endpgm
K1_LB_MASK:
    buffer_load_dword v3, v29, s[32:35], s92 offen sc1
    s_nop 1
    v_add_f32 v212, s12, v144
    v_fma_f32 v176, v208, s8, v212
    v_fma_f32 v177, v209, s8, v212
    v_fma_f32 v178, v210, s8, v212
    v_fma_f32 v179, v211, s8, v212
    v_add_f32 v213, s13, v144
    v_fma_f32 v180, v208, s9, v213
    v_fma_f32 v181, v209, s9, v213
    v_fma_f32 v182, v210, s9, v213
    v_fma_f32 v183, v211, s9, v213
    v_add_f32 v214, s14, v144
    v_fma_f32 v184, v208, s10, v214
    v_fma_f32 v185, v209, s10, v214
    v_fma_f32 v186, v210, s10, v214
    v_fma_f32 v187, v211, s10, v214
    v_add_f32 v215, s15, v144
    v_fma_f32 v188, v208, s11, v215
    v_fma_f32 v189, v209, s11, v215
    v_fma_f32 v190, v210, s11, v215
    v_fma_f32 v191, v211, s11, v215
    s_nop 1
    s_branch K1_LB_BACK
K1_LS_MASK:
    s_cmp_eq_u32 s78, 1
    s_cbranch_scc1 K1_LS_LAST
    buffer_load_dword v3, v29, s[32:35], s92 offen sc1
    v_mov_b32 v218, 1
    s_cmp_eq_u64 s[84:85], 0
    s_cselect_b32 s7, s74, 1073741824
    s_cmp_lg_u32 s83, 0
    s_cselect_b32 s7, s74, s7
    s_waitcnt vmcnt(9)
    buffer_store_dword v218, v216, s[32:35], s7 offen sc1
    s_branch K1_LS_BACK
K1_LS_LAST:
    v_cmp_gt_u32 vcc, 1, v3
    s_nop 1
    s_cmp_lg_u32 vcc_lo, 0
    s_cbranch_scc1 SPIN_W0
BACK_W0:
    s_mov_b64 s[36:37], s[56:57]
    s_mov_b32 s38, 5603328
    s_xor_b32 s77, s3, 0
    s_lshl2_add_u32 s77, s77, s4
    s_mul_i32 s77, s77, 36864
    s_add_u32 s77, s77, s28
    s_nop 1
    v_add_f32 v212, s12, v152
    v_fma_f32 v176, v208, s8, v212
    v_fma_f32 v177, v209, s8, v212
    v_fma_f32 v178, v210, s8, v212
    v_fma_f32 v179, v211, s8, v212
    v_add_f32 v213, s13, v152
    v_fma_f32 v180, v208, s9, v213
    v_fma_f32 v181, v209, s9, v213
    v_fma_f32 v182, v210, s9, v213
    v_fma_f32 v183, v211, s9, v213
    v_add_f32 v214, s14, v152
    v_fma_f32 v184, v208, s10, v214
    v_fma_f32 v185, v209, s10, v214
    v_fma_f32 v186, v210, s10, v214
    v_fma_f32 v187, v211, s10, v214
    v_add_f32 v215, s15, v152
    v_fma_f32 v188, v208, s11, v215
    v_fma_f32 v189, v209, s11, v215
    v_fma_f32 v190, v210, s11, v215
    v_fma_f32 v191, v211, s11, v215
    s_nop 1
    s_branch K1_LS_BACK
K1_S7:
    v_mov_b32 v218, 1
    s_cmp_eq_u64 s[84:85], 0
    s_cselect_b32 s7, s74, 1073741824
    s_cmp_lg_u32 s83, 0
    s_cselect_b32 s7, s74, s7
    s_waitcnt vmcnt(8)
    buffer_store_dword v218, v216, s[32:35], s7 offen sc1
    s_branch K1_S7_BACK
K1_J7:
    v_cmp_gt_u32 vcc, 1, v3
    s_nop 1
    s_cmp_lg_u32 vcc_lo, 0
    s_cbranch_scc1 SPIN_W7
BACK_W7:
    s_mov_b64 s[36:37], s[56:57]
    s_mov_b32 s38, 5603328
    s_xor_b32 s77, s3, 0
    s_lshl2_add_u32 s77, s77, s4
    s_mul_i32 s77, s77, 36864
    s_add_u32 s77, s77, s28
    s_branch K1_J7_BACK
K1_REDO:
    s_mov_b32 s83, 1
    s_mov_b32 s63, 1073741824
    s_mov_b32 s64, 1073741824
    s_mov_b32 s62, 1073741824
    s_mul_i32 s7, s5, 1081344
    s_sub_u32 s7, 56623104, s7
    s_sub_u32 s36, s56, s7
    s_subb_u32 s37, s57, 0
    s_mov_b32 s38, 1081344
    s_mov_b32 s50, 0
    s_mov_b32 s54, 0
    s_waitcnt vmcnt(0) lgkmcnt(0)
    s_barrier
    v_lshrrev_b32 v92, 4, v1
    v_and_b32 v64, 15, v92
    v_lshrrev_b32 v92, 4, v92
    v_lshlrev_b32 v92, 2, v92
    v_sub_u32 v92, v64, v92
    s_lshl_b32 s98, s4, 4
    v_add_u32 v92, s98, v92
    s_lshl_b32 s98, s6, 7
    s_sub_u32 s99, 1920, s98
    v_add_u32 v64, s98, v92
    v_add_u32 v65, 64, v64
    v_add_u32 v66, s99, v92
    v_add_u32 v67, 64, v66
    v_mov_b32 v93, 0xf149f2ca
    v_mov_b32 v68, v93
    v_mov_b32 v69, v93
    v_mov_b32 v70, v93
    v_mov_b32 v71, v93
    s_mov_b32 s78, 0
    s_add_u32 s99, s99, 128
K1_REDO_L:
    s_lshr_b32 s7, s78, 6
    s_lshl_b32 s7, s7, 15
    s_bfe_u32 s98, s78, 0x20004
    s_lshl_b32 s98, s98, 12
    s_add_u32 s7, s7, s98
    buffer_load_dwordx4 v[72:75], v1, s[36:39], s7 offen offset:0 sc1
    buffer_load_dwordx4 v[76:79], v1, s[36:39], s7 offen offset:1024 sc1
    buffer_load_dwordx4 v[80:83], v1, s[36:39], s7 offen offset:2048 sc1
    buffer_load_dwordx4 v[84:87], v1, s[36:39], s7 offen offset:3072 sc1
    s_waitcnt vmcnt(0)
    v_mfma_f32_16x16x32_bf16 v[88:91], v[72:75], v[128:131], 0
    v_mfma_f32_16x16x32_bf16 v[88:91], v[76:79], v[160:163], v[88:91]
    v_mfma_f32_16x16x32_bf16 v[88:91], v[80:83], v[192:195], v[88:91]
    v_mfma_f32_16x16x32_bf16 v[88:91], v[84:87], v[224:227], v[88:91]
    v_subrev_u32 v92, s78, v64
    v_cmp_le_i32 vcc, 0, v92
    s_nop 5
    v_cndmask_b32 v88, v93, v88, vcc
    v_max_f32 v68, v68, v88
    v_cmp_le_i32 vcc, 1, v92
    s_nop 1
    v_cndmask_b32 v89, v93, v89, vcc
    v_max_f32 v68, v68, v89
    v_cmp_le_i32 vcc, 2, v92
    s_nop 1
    v_cndmask_b32 v90, v93, v90, vcc
    v_max_f32 v68, v68, v90
    v_cmp_le_i32 vcc, 3, v92
    s_nop 1
    v_cndmask_b32 v91, v93, v91, vcc
    v_max_f32 v68, v68, v91
    v_mfma_f32_16x16x32_bf16 v[88:91], v[72:75], v[132:135], 0
    v_mfma_f32_16x16x32_bf16 v[88:91], v[76:79], v[164:167], v[88:91]
    v_mfma_f32_16x16x32_bf16 v[88:91], v[80:83], v[196:199], v[88:91]
    v_mfma_f32_16x16x32_bf16 v[88:91], v[84:87], v[228:231], v[88:91]
    v_subrev_u32 v92, s78, v65
    v_cmp_le_i32 vcc, 0, v92
    s_nop 5
    v_cndmask_b32 v88, v93, v88, vcc
    v_max_f32 v69, v69, v88
    v_cmp_le_i32 vcc, 1, v92
    s_nop 1
    v_cndmask_b32 v89, v93, v89, vcc
    v_max_f32 v69, v69, v89
    v_cmp_le_i32 vcc, 2, v92
    s_nop 1
    v_cndmask_b32 v90, v93, v90, vcc
    v_max_f32 v69, v69, v90
    v_cmp_le_i32 vcc, 3, v92
    s_nop 1
    v_cndmask_b32 v91, v93, v91, vcc
    v_max_f32 v69, v69, v91
    v_mfma_f32_16x16x32_bf16 v[88:91], v[72:75], v[136:139], 0
    v_mfma_f32_16x16x32_bf16 v[88:91], v[76:79], v[168:171], v[88:91]
    v_mfma_f32_16x16x32_bf16 v[88:91], v[80:83], v[200:203], v[88:91]
    v_mfma_f32_16x16x32_bf16 v[88:91], v[84:87], v[232:235], v[88:91]
    v_subrev_u32 v92, s78, v66
    v_cmp_le_i32 vcc, 0, v92
    s_nop 5
    v_cndmask_b32 v88, v93, v88, vcc
    v_max_f32 v70, v70, v88
    v_cmp_le_i32 vcc, 1, v92
    s_nop 1
    v_cndmask_b32 v89, v93, v89, vcc
    v_max_f32 v70, v70, v89
    v_cmp_le_i32 vcc, 2, v92
    s_nop 1
    v_cndmask_b32 v90, v93, v90, vcc
    v_max_f32 v70, v70, v90
    v_cmp_le_i32 vcc, 3, v92
    s_nop 1
    v_cndmask_b32 v91, v93, v91, vcc
    v_max_f32 v70, v70, v91
    v_mfma_f32_16x16x32_bf16 v[88:91], v[72:75], v[140:143], 0
    v_mfma_f32_16x16x32_bf16 v[88:91], v[76:79], v[172:175], v[88:91]
    v_mfma_f32_16x16x32_bf16 v[88:91], v[80:83], v[204:207], v[88:91]
    v_mfma_f32_16x16x32_bf16 v[88:91], v[84:87], v[236:239], v[88:91]
    v_subrev_u32 v92, s78, v67
    v_cmp_le_i32 vcc, 0, v92
    s_nop 5
    v_cndmask_b32 v88, v93, v88, vcc
    v_max_f32 v71, v71, v88
    v_cmp_le_i32 vcc, 1, v92
    s_nop 1
    v_cndmask_b32 v89, v93, v89, vcc
    v_max_f32 v71, v71, v89
    v_cmp_le_i32 vcc, 2, v92
    s_nop 1
    v_cndmask_b32 v90, v93, v90, vcc
    v_max_f32 v71, v71, v90
    v_cmp_le_i32 vcc, 3, v92
    s_nop 1
    v_cndmask_b32 v91, v93, v91, vcc
    v_max_f32 v71, v71, v91
    s_add_u32 s78, s78, 16
    s_cmp_lt_u32 s78, s99
    s_cbranch_scc1 K1_REDO_L
    v_mov_b32 v92, v68
    s_nop 1
    v_permlane32_swap_b32 v68, v92
    v_max_f32 v68, v68, v92
    v_mov_b32 v92, v68
    s_nop 1
    v_permlane16_swap_b32 v68, v92
    v_max_f32 v68, v68, v92
    v_sub_f32 v144, 0, v68
    v_sub_f32 v145, 0, v68
    v_sub_f32 v146, 0, v68
    v_sub_f32 v147, 0, v68
    v_mov_b32 v92, v69
    s_nop 1
    v_permlane32_swap_b32 v69, v92
    v_max_f32 v69, v69, v92
    v_mov_b32 v92, v69
    s_nop 1
    v_permlane16_swap_b32 v69, v92
    v_max_f32 v69, v69, v92
    v_sub_f32 v148, 0, v69
    v_sub_f32 v149, 0, v69
    v_sub_f32 v150, 0, v69
    v_sub_f32 v151, 0, v69
    v_mov_b32 v92, v70
    s_nop 1
    v_permlane32_swap_b32 v70, v92
    v_max_f32 v70, v70, v92
    v_mov_b32 v92, v70
    s_nop 1
    v_permlane16_swap_b32 v70, v92
    v_max_f32 v70, v70, v92
    v_sub_f32 v152, 0, v70
    v_sub_f32 v153, 0, v70
    v_sub_f32 v154, 0, v70
    v_sub_f32 v155, 0, v70
    v_mov_b32 v92, v71
    s_nop 1
    v_permlane32_swap_b32 v71, v92
    v_max_f32 v71, v71, v92
    v_mov_b32 v92, v71
    s_nop 1
    v_permlane16_swap_b32 v71, v92
    v_max_f32 v71, v71, v92
    v_sub_f32 v156, 0, v71
    v_sub_f32 v157, 0, v71
    v_sub_f32 v158, 0, v71
    v_sub_f32 v159, 0, v71
    v_accvgpr_write_b32 a0, 0
    v_accvgpr_write_b32 a1, 0
    v_accvgpr_write_b32 a2, 0
    v_accvgpr_write_b32 a3, 0
    v_accvgpr_write_b32 a4, 0
    v_accvgpr_write_b32 a5, 0
    v_accvgpr_write_b32 a6, 0
    v_accvgpr_write_b32 a7, 0
    v_accvgpr_write_b32 a8, 0
    v_accvgpr_write_b32 a9, 0
    v_accvgpr_write_b32 a10, 0
    v_accvgpr_write_b32 a11, 0
    v_accvgpr_write_b32 a12, 0
    v_accvgpr_write_b32 a13, 0
    v_accvgpr_write_b32 a14, 0
    v_accvgpr_write_b32 a15, 0
    v_accvgpr_write_b32 a16, 0
    v_accvgpr_write_b32 a17, 0
    v_accvgpr_write_b32 a18, 0
    v_accvgpr_write_b32 a19, 0
    v_accvgpr_write_b32 a20, 0
    v_accvgpr_write_b32 a21, 0
    v_accvgpr_write_b32 a22, 0
    v_accvgpr_write_b32 a23, 0
    v_accvgpr_write_b32 a24, 0
    v_accvgpr_write_b32 a25, 0
    v_accvgpr_write_b32 a26, 0
    v_accvgpr_write_b32 a27, 0
    v_accvgpr_write_b32 a28, 0
    v_accvgpr_write_b32 a29, 0
    v_accvgpr_write_b32 a30, 0
    v_accvgpr_write_b32 a31, 0
    v_accvgpr_write_b32 a32, 0
    v_accvgpr_write_b32 a33, 0
    v_accvgpr_write_b32 a34, 0
    v_accvgpr_write_b32 a35, 0
    v_accvgpr_write_b32 a36, 0
    v_accvgpr_write_b32 a37, 0
    v_accvgpr_write_b32 a38, 0
    v_accvgpr_write_b32 a39, 0
    v_accvgpr_write_b32 a40, 0
    v_accvgpr_write_b32 a41, 0
    v_accvgpr_write_b32 a42, 0
    v_accvgpr_write_b32 a43, 0
    v_accvgpr_write_b32 a44, 0
    v_accvgpr_write_b32 a45, 0
    v_accvgpr_write_b32 a46, 0
    v_accvgpr_write_b32 a47, 0
    v_accvgpr_write_b32 a48, 0
    v_accvgpr_write_b32 a49, 0
    v_accvgpr_write_b32 a50, 0
    v_accvgpr_write_b32 a51, 0
    v_accvgpr_write_b32 a52, 0
    v_accvgpr_write_b32 a53, 0
    v_accvgpr_write_b32 a54, 0
    v_accvgpr_write_b32 a55, 0
    v_accvgpr_write_b32 a56, 0
    v_accvgpr_write_b32 a57, 0
    v_accvgpr_write_b32 a58, 0
    v_accvgpr_write_b32 a59, 0
    v_accvgpr_write_b32 a60, 0
    v_accvgpr_write_b32 a61, 0
    v_accvgpr_write_b32 a62, 0
    v_accvgpr_write_b32 a63, 0
    v_accvgpr_write_b32 a144, 0
    v_accvgpr_write_b32 a145, 0
    v_accvgpr_write_b32 a146, 0
    v_accvgpr_write_b32 a147, 0
    v_accvgpr_write_b32 a148, 0
    v_accvgpr_write_b32 a149, 0
    v_accvgpr_write_b32 a150, 0
    v_accvgpr_write_b32 a151, 0
    v_accvgpr_write_b32 a152, 0
    v_accvgpr_write_b32 a153, 0
    v_accvgpr_write_b32 a154, 0
    v_accvgpr_write_b32 a155, 0
    v_accvgpr_write_b32 a156, 0
    v_accvgpr_write_b32 a157, 0
    v_accvgpr_write_b32 a158, 0
    v_accvgpr_write_b32 a159, 0
    v_accvgpr_write_b32 a160, 0
    v_accvgpr_write_b32 a161, 0
    v_accvgpr_write_b32 a162, 0
    v_accvgpr_write_b32 a163, 0
    v_accvgpr_write_b32 a164, 0
    v_accvgpr_write_b32 a165, 0
    v_accvgpr_write_b32 a166, 0
    v_accvgpr_write_b32 a167, 0
    v_accvgpr_write_b32 a168, 0
    v_accvgpr_write_b32 a169, 0
    v_accvgpr_write_b32 a170, 0
    v_accvgpr_write_b32 a171, 0
    v_accvgpr_write_b32 a172, 0
    v_accvgpr_write_b32 a173, 0
    v_accvgpr_write_b32 a174, 0
    v_accvgpr_write_b32 a175, 0
    v_accvgpr_write_b32 a176, 0
    v_accvgpr_write_b32 a177, 0
    v_accvgpr_write_b32 a178, 0
    v_accvgpr_write_b32 a179, 0
    v_accvgpr_write_b32 a180, 0
    v_accvgpr_write_b32 a181, 0
    v_accvgpr_write_b32 a182, 0
    v_accvgpr_write_b32 a183, 0
    v_accvgpr_write_b32 a184, 0
    v_accvgpr_write_b32 a185, 0
    v_accvgpr_write_b32 a186, 0
    v_accvgpr_write_b32 a187, 0
    v_accvgpr_write_b32 a188, 0
    v_accvgpr_write_b32 a189, 0
    v_accvgpr_write_b32 a190, 0
    v_accvgpr_write_b32 a191, 0
    v_accvgpr_write_b32 a192, 0
    v_accvgpr_write_b32 a193, 0
    v_accvgpr_write_b32 a194, 0
    v_accvgpr_write_b32 a195, 0
    v_accvgpr_write_b32 a196, 0
    v_accvgpr_write_b32 a197, 0
    v_accvgpr_write_b32 a198, 0
    v_accvgpr_write_b32 a199, 0
    v_accvgpr_write_b32 a200, 0
    v_accvgpr_write_b32 a201, 0
    v_accvgpr_write_b32 a202, 0
    v_accvgpr_write_b32 a203, 0
    v_accvgpr_write_b32 a204, 0
    v_accvgpr_write_b32 a205, 0
    v_accvgpr_write_b32 a206, 0
    v_accvgpr_write_b32 a207, 0
    v_accvgpr_write_b32 a208, 0
    v_accvgpr_write_b32 a209, 0
    v_accvgpr_write_b32 a210, 0
    v_accvgpr_write_b32 a211, 0
    v_accvgpr_write_b32 a212, 0
    v_accvgpr_write_b32 a213, 0
    v_accvgpr_write_b32 a214, 0
    v_accvgpr_write_b32 a215, 0
    v_accvgpr_write_b32 a216, 0
    v_accvgpr_write_b32 a217, 0
    v_accvgpr_write_b32 a218, 0
    v_accvgpr_write_b32 a219, 0
    v_accvgpr_write_b32 a220, 0
    v_accvgpr_write_b32 a221, 0
    v_accvgpr_write_b32 a222, 0
    v_accvgpr_write_b32 a223, 0
    v_bfe_u32 v92, v1, 4, 2
    v_cmp_eq_u32 vcc, 0, v92
    v_mov_b32 v92, 0x3f803f80
    s_nop 0
    v_cndmask_b32 v92, 0, v92, vcc
    v_accvgpr_write_b32 a136, v92
    v_accvgpr_write_b32 a137, v92
    v_accvgpr_write_b32 a138, v92
    v_accvgpr_write_b32 a139, v92
    s_mov_b32 s77, s75
    s_mov_b32 s76, 0
    s_mov_b32 s38, 16384
    s_add_u32 m0, s76, s75
    s_nop 0
    buffer_load_dwordx4 v1, s[36:39], s77 offen sc1 lds
    buffer_load_dwordx4 v1, s[36:39], s77 offen offset:1024 sc1 lds
    buffer_load_dwordx4 v1, s[36:39], s77 offen offset:2048 sc1 lds
    buffer_load_dwordx4 v1, s[36:39], s77 offen offset:3072 sc1 lds
    s_add_u32 s100, s77, 4096
    s_add_u32 m0, m0, 4096
    s_nop 0
    buffer_load_dwordx4 v1, s[36:39], s100 offen sc1 lds
    buffer_load_dwordx4 v1, s[36:39], s100 offen offset:1024 sc1 lds
    buffer_load_dwordx4 v1, s[36:39], s100 offen offset:2048 sc1 lds
    buffer_load_dwordx4 v1, s[36:39], s100 offen offset:3072 sc1 lds
    s_add_u32 s77, s77, 32768
    s_add_u32 s76, s76, 32768
    s_lshr_b32 s82, s4, 1
    s_add_u32 s82, s82, 32
    s_sub_u32 s82, s82, s6
    s_sub_u32 s82, s82, s6
    s_lshl_b32 s38, s82, 15
    s_add_u32 m0, s76, s75
    s_nop 0
    buffer_load_dwordx4 v1, s[36:39], s77 offen sc1 lds
    buffer_load_dwordx4 v1, s[36:39], s77 offen offset:1024 sc1 lds
    buffer_load_dwordx4 v1, s[36:39], s77 offen offset:2048 sc1 lds
    buffer_load_dwordx4 v1, s[36:39], s77 offen offset:3072 sc1 lds
    s_add_u32 s100, s77, 4096
    s_add_u32 m0, m0, 4096
    s_nop 0
    buffer_load_dwordx4 v1, s[36:39], s100 offen sc1 lds
    buffer_load_dwordx4 v1, s[36:39], s100 offen offset:1024 sc1 lds
    buffer_load_dwordx4 v1, s[36:39], s100 offen offset:2048 sc1 lds
    buffer_load_dwordx4 v1, s[36:39], s100 offen offset:3072 sc1 lds
    s_add_u32 s77, s77, 32768
    s_add_u32 s76, s76, 32768
    s_add_u32 m0, s76, s75
    s_nop 0
    buffer_load_dwordx4 v1, s[36:39], s77 offen sc1 lds
    buffer_load_dwordx4 v1, s[36:39], s77 offen offset:1024 sc1 lds
    buffer_load_dwordx4 v1, s[36:39], s77 offen offset:2048 sc1 lds
    buffer_load_dwordx4 v1, s[36:39], s77 offen offset:3072 sc1 lds
    s_add_u32 s100, s77, 4096
    s_add_u32 m0, m0, 4096
    s_nop 0
    buffer_load_dwordx4 v1, s[36:39], s100 offen sc1 lds
    buffer_load_dwordx4 v1, s[36:39], s100 offen offset:1024 sc1 lds
    buffer_load_dwordx4 v1, s[36:39], s100 offen offset:2048 sc1 lds
    buffer_load_dwordx4 v1, s[36:39], s100 offen offset:3072 sc1 lds
    s_add_u32 s77, s77, 32768
    s_add_u32 s76, s76, 32768
    s_mov_b32 s82, 0
    s_mov_b32 s60, 131072
    v_mov_b32 v2, v1
    s_cmp_eq_u32 s6, 0
    s_cselect_b32 s16, s8, 0
    s_cselect_b32 s17, s9, 0
    s_cmp_eq_u32 s6, 0
    s_cselect_b32 s18, s10, 0
    s_cselect_b32 s19, s11, 0
    s_cmp_eq_u32 s6, 0
    s_cselect_b32 s20, s12, 0
    s_cselect_b32 s21, s13, 0
    s_cmp_eq_u32 s6, 0
    s_cselect_b32 s22, s14, 0
    s_cselect_b32 s23, s15, 0
    s_waitcnt vmcnt(16)
    s_barrier
    ds_read_b128 a[224:227], v2 offset:0
    ds_read_b128 a[228:231], v2 offset:1024
    ds_read_b128 a[232:235], v2 offset:2048
    ds_read_b128 a[236:239], v2 offset:3072
    s_waitcnt lgkmcnt(0)
    s_branch K1_ATT
SPIN_WA:
    s_mov_b32 s94, 0
SPIN_WA_L:
    s_sleep 2
    buffer_load_dword v7, v9, s[44:47], s69 offen sc1
    s_add_u32 s94, s94, 1
    s_cmp_ge_u32 s94, 0x40000
    s_waitcnt vmcnt(0)
    s_cbranch_scc1 BACK_WA
    v_cmp_gt_u32 vcc, 8, v7
    s_nop 1
    s_and_b64 vcc, vcc, s[86:87]
    s_cbranch_scc1 SPIN_WA_L
    s_branch BACK_WA
SPIN_KV:
    s_mov_b32 s94, 0
SPIN_KV_L:
    s_sleep 2
    buffer_load_dword v7, v8, s[32:35], s61 offen sc1
    s_add_u32 s94, s94, 1
    s_cmp_ge_u32 s94, 0x40000
    s_waitcnt vmcnt(0)
    s_cbranch_scc1 BACK_KV
    v_cmp_gt_u32 vcc, 1, v7
    s_nop 1
    s_and_b64 vcc, vcc, exec
    s_cbranch_scc1 SPIN_KV_L
    s_branch BACK_KV
SPIN_SHORT:
    s_mov_b32 s94, 0
SPIN_SHORT_L:
    s_sleep 2
    buffer_load_dword v3, v217, s[32:35], s19 offen sc1
    s_add_u32 s94, s94, 1
    s_cmp_ge_u32 s94, 0x40000
    s_waitcnt vmcnt(0)
    s_cbranch_scc1 BACK_SHORT
    v_cmp_gt_u32 vcc, 1, v3
    s_nop 1
    s_and_b64 vcc, vcc, exec
    s_cbranch_scc1 SPIN_SHORT_L
    s_branch BACK_SHORT
SPIN_CTX:
    s_mov_b32 s94, 0
SPIN_CTX_L:
    s_sleep 2
    buffer_load_dword v3, v217, s[32:35], s19 offen sc1
    s_add_u32 s94, s94, 1
    s_cmp_ge_u32 s94, 0x40000
    s_waitcnt vmcnt(0)
    s_cbranch_scc1 BACK_CTX
    v_cmp_gt_u32 vcc, 2, v3
    s_nop 1
    s_and_b64 vcc, vcc, exec
    s_cbranch_scc1 SPIN_CTX_L
    s_branch BACK_CTX
SPIN_ALL:
    s_mov_b32 s94, 0
SPIN_ALL_L:
    s_sleep 2
    buffer_load_dword v28, v29, s[32:35], s92 offen sc1
    s_add_u32 s94, s94, 1
    s_cmp_ge_u32 s94, 0x40000
    s_waitcnt vmcnt(0)
    s_cbranch_scc1 BACK_ALL
    v_cmp_gt_u32 vcc, 1, v28
    s_nop 1
    s_and_b64 vcc, vcc, exec
    s_cbranch_scc1 SPIN_ALL_L
    s_branch BACK_ALL
SPIN_OA:
    s_mov_b32 s94, 0
SPIN_OA_L:
    s_sleep 2
    buffer_load_dword v3, v19, s[32:35], s66 offen sc1
    s_add_u32 s94, s94, 1
    s_cmp_ge_u32 s94, 0x40000
    s_waitcnt vmcnt(0)
    s_cbranch_scc1 BACK_OA
    v_cmp_gt_u32 vcc, 3, v3
    s_nop 1
    s_and_b64 vcc, vcc, exec
    s_cbranch_scc1 SPIN_OA_L
    s_branch BACK_OA
SPIN_X:
    s_mov_b32 s94, 0
SPIN_X_L:
    s_sleep 2
    buffer_load_dword v3, v19, s[32:35], s66 offen sc1
    s_add_u32 s94, s94, 1
    s_cmp_ge_u32 s94, 0x40000
    s_waitcnt vmcnt(0)
    s_cbranch_scc1 BACK_X
    v_cmp_gt_u32 vcc, 3, v3
    s_nop 1
    s_and_b64 vcc, vcc, exec
    s_cbranch_scc1 SPIN_X_L
    s_branch BACK_X
SPIN_W0:
    s_mov_b32 s94, 0
SPIN_W0_L:
    s_sleep 2
    buffer_load_dword v3, v29, s[32:35], s92 offen sc1
    s_add_u32 s94, s94, 1
    s_cmp_ge_u32 s94, 0x40000
    s_waitcnt vmcnt(0)
    s_cbranch_scc1 BACK_W0
    v_cmp_gt_u32 vcc, 1, v3
    s_nop 1
    s_cmp_lg_u32 vcc_lo, 0
    s_cbranch_scc1 SPIN_W0_L
    s_branch BACK_W0
SPIN_W7:
    s_mov_b32 s94, 0
SPIN_W7_L:
    s_sleep 2
    buffer_load_dword v3, v29, s[32:35], s92 offen sc1
    s_add_u32 s94, s94, 1
    s_cmp_ge_u32 s94, 0x40000
    s_waitcnt vmcnt(0)
    s_cbranch_scc1 BACK_W7
    v_cmp_gt_u32 vcc, 1, v3
    s_nop 1
    s_cmp_lg_u32 vcc_lo, 0
    s_cbranch_scc1 SPIN_W7_L
    s_branch BACK_W7
.section .rodata,"a"
.p2align 6
.amdhsa_kernel gated_mix__sliding_local_dilated__compressed_kv_cla__prompt_kernel
.amdhsa_next_free_vgpr 512
.amdhsa_next_free_sgpr 102
.amdhsa_accum_offset 256
.amdhsa_group_segment_fixed_size 0
.amdhsa_kernarg_size 104
.amdhsa_user_sgpr_count 2
.amdhsa_user_sgpr_kernarg_segment_ptr 1
.amdhsa_system_sgpr_workgroup_id_x 1
.amdhsa_ieee_mode 0
.amdhsa_dx10_clamp 0
.end_amdhsa_kernel
```

```asm
; @launch grid=(256,1,1) block=(256,1,1) lds=163840
.amdgcn_target "amdgcn-amd-amdhsa--gfx950"
.text
.globl gated_mix__sliding_local_dilated__compressed_kv_cla__prompt_kernel
.p2align 8
.type gated_mix__sliding_local_dilated__compressed_kv_cla__prompt_kernel,@function
gated_mix__sliding_local_dilated__compressed_kv_cla__prompt_kernel:
    s_cmp_ge_u32 s2, 256
    s_cbranch_scc1 K1_END
    s_getpc_b64 s[94:95]
    s_load_dwordx8 s[36:43], s[0:1], 32
    v_min_u32 v74, 16, v0
    s_lshr_b32 s7, s2, 3
    s_mul_i32 s7, s7, 17
    v_add_lshl_u32 v74, v74, s7, 7
    global_load_dword v76, v74, s[94:95]
    v_lshrrev_b32 v64, 6, v0
    v_and_b32 v31, 63, v0
    v_readfirstlane_b32 s4, v64
    s_and_b32 s5, s2, 7
    s_lshl_b32 s5, s5, 2
    s_bfe_u32 s7, s2, 0x20003
    s_add_u32 s5, s5, s7
    s_lshr_b32 s6, s2, 5
    s_lshl_b32 s69, s4, 12
    s_mov_b32 s10, 2097152
    s_mov_b32 s11, 0x20000
    s_mov_b32 s14, 4194304
    s_mov_b32 s15, 0x20000
    s_mov_b32 s18, 4194304
    s_mov_b32 s19, 0x20000
    v_lshrrev_b32 v65, 3, v31
    v_and_b32 v66, 7, v31
    v_lshrrev_b32 v67, 1, v65
    v_xor_b32 v66, v66, v67
    v_lshlrev_b32 v66, 4, v66
    v_xor_b32 v67, 64, v66
    s_lshr_b32 s7, s4, 1
    s_lshl_b32 s73, s7, 7
    s_and_b32 s100, s4, 1
    s_lshl_b32 s98, s100, 5
    s_add_u32 s98, s98, s73
    v_add_lshl_u32 v68, v65, s98, 10
    v_add_u32 v6, v68, v66
    v_add_u32 v7, v68, v67
    v_add_u32 v7, 7168, v7
    v_add_u32 v8, v68, v66
    v_add_u32 v8, 14336, v8
    v_add_u32 v9, v68, v67
    v_add_u32 v9, 21504, v9
    v_lshrrev_b32 v69, 4, v31
    v_and_b32 v70, 15, v31
    v_lshlrev_b32 v71, 1, v69
    v_xor_b32 v71, v71, v70
    v_lshlrev_b32 v71, 4, v71
    v_xor_b32 v72, 128, v71
    s_lshl_b32 s98, s4, 4
    v_add_lshl_u32 v73, v69, s98, 13
    v_add_u32 v2, v73, v71
    v_add_u32 v3, v73, v71
    v_add_u32 v3, 31744, v3
    v_add_u32 v4, v73, v72
    v_add_u32 v4, 63488, v4
    v_add_u32 v5, v73, v72
    v_add_u32 v5, 95232, v5
    s_and_b32 s3, s2, 0
    s_lshl_b32 s66, s3, 7
    s_lshl_b32 s60, s3, 11
    s_add_u32 s60, s60, s5
    s_lshl_b32 s60, s60, 8
    s_lshl_b32 s61, s6, 18
    s_add_u32 s61, s61, s66
    s_add_u32 s62, s61, 65536
    s_waitcnt lgkmcnt(0)
    s_mov_b64 s[8:9], s[36:37]
    s_mov_b64 s[24:25], s[38:39]
    s_mov_b64 s[12:13], s[40:41]
    s_mov_b64 s[16:17], s[42:43]
    s_load_dwordx2 s[20:21], s[0:1], 0
    s_load_dwordx2 s[28:29], s[0:1], 8
    s_load_dwordx2 s[32:33], s[0:1], 72
    s_load_dwordx2 s[48:49], s[0:1], 64
    s_load_dwordx2 s[92:93], s[0:1], 16
    s_load_dwordx2 s[44:45], s[0:1], 88
    s_load_dwordx2 s[56:57], s[0:1], 96
    s_load_dwordx2 s[0:1], s[0:1], 80
    s_add_u32 m0, s69, 0
    s_nop 0
    buffer_load_dwordx4 v6, s[8:11], s61 offen lds
    buffer_load_dwordx4 v7, s[8:11], s61 offen offset:1024 lds
    buffer_load_dwordx4 v8, s[8:11], s61 offen offset:2048 lds
    buffer_load_dwordx4 v9, s[8:11], s61 offen offset:3072 lds
    s_xor_b32 s61, s61, 128
    s_add_u32 m0, s69, 16384
    s_nop 0
    buffer_load_dwordx4 v6, s[8:11], s62 offen lds
    buffer_load_dwordx4 v7, s[8:11], s62 offen offset:1024 lds
    buffer_load_dwordx4 v8, s[8:11], s62 offen offset:2048 lds
    buffer_load_dwordx4 v9, s[8:11], s62 offen offset:3072 lds
    s_xor_b32 s62, s62, 128
    s_add_u32 m0, s69, 32768
    s_nop 0
    buffer_load_dwordx4 v2, s[12:15], s60 offen nt lds
    buffer_load_dwordx4 v3, s[12:15], s60 offen offset:1024 nt lds
    buffer_load_dwordx4 v4, s[12:15], s60 offen offset:2048 nt lds
    buffer_load_dwordx4 v5, s[12:15], s60 offen offset:3072 nt lds
    s_add_u32 m0, s69, 49152
    s_nop 0
    buffer_load_dwordx4 v6, s[8:11], s61 offen lds
    buffer_load_dwordx4 v7, s[8:11], s61 offen offset:1024 lds
    buffer_load_dwordx4 v8, s[8:11], s61 offen offset:2048 lds
    buffer_load_dwordx4 v9, s[8:11], s61 offen offset:3072 lds
    s_xor_b32 s61, s61, 384
    v_min_u32 v74, 15, v31
    s_lshl2_add_u32 s98, s2, s4
    s_lshl_b32 s98, s98, 11
    v_lshlrev_b32 v74, 7, v74
    buffer_load_dword v117, v74, s[8:11], s98 offen
    s_waitcnt lgkmcnt(0)
    s_mov_b32 s22, 2359296
    s_mov_b32 s23, 0x20000
    s_mov_b32 s26, 4718592
    s_mov_b32 s27, 0x20000
    s_mov_b32 s50, 4718592
    s_mov_b32 s51, 0x20000
    s_mov_b32 s46, 256
    s_mov_b32 s47, 0x20000
    s_mov_b32 s30, 1990656
    s_mov_b32 s31, 0x20000
    s_mov_b32 s34, 1152
    s_mov_b32 s35, 0x20000
    s_mul_i32 s7, s5, 1081344
    s_add_u32 s36, s56, s7
    s_addc_u32 s37, s57, 0
    s_mov_b32 s38, 1081344
    s_mov_b32 s39, 0x20000
    s_cmp_eq_u32 s4, 0
    s_cselect_b32 s86, 0x55555555, 0
    s_cselect_b32 s87, 0x55555555, 0
    s_cselect_b32 s52, s48, s92
    s_cselect_b32 s53, s49, s93
    s_cselect_b32 s54, s50, 663552
    s_mov_b32 s55, 0x20000
    s_mul_i32 s63, s6, 147456
    s_sub_u32 s64, 2211840, s63
    s_add_u32 s63, s63, s66
    s_add_u32 s64, s64, s66
    s_lshl_b32 s67, s4, 11
    s_lshl_b32 s68, s4, 10
    s_lshl_b32 s75, s4, 13
    s_lshl_b32 s65, s3, 13
    s_add_u32 s65, s65, s67
    s_lshl_b32 s70, s6, 2
    s_lshl1_add_u32 s70, s100, s70
    s_lshl_b32 s70, s70, 15
    s_lshl_b32 s98, s73, 6
    s_add_u32 s71, s70, s98
    s_add_u32 s71, s71, 49152
    s_lshl_b32 s98, s73, 4
    s_add_u32 s70, s70, s98
    v_lshlrev_b32 v1, 4, v31
    v_mov_b32 v77, 1073741824
    v_cmp_eq_u32 vcc, 0, v0
    s_nop 1
    v_cndmask_b32_e64 v30, v77, 0, vcc
    v_lshlrev_b32 v103, 7, v31
    v_cmp_gt_u32 vcc, 9, v31
    s_nop 1
    v_cndmask_b32 v103, v77, v103, vcc
    s_lshl_b32 s98, s4, 5
    v_add_u32 v68, s98, v65
    v_mul_u32_u24 v68, 1152, v68
    v_add_u32 v10, v68, v66
    v_add_u32 v11, v68, v67
    v_add_u32 v11, 8192, v11
    v_add_u32 v12, v68, v66
    v_add_u32 v12, 16384, v12
    v_add_u32 v13, v68, v67
    v_add_u32 v13, 24576, v13
    s_sub_u32 s98, 15, s6
    s_cmp_eq_u32 s73, 0
    s_cselect_b32 s98, s6, s98
    s_lshl_b32 s98, s98, 7
    s_sub_u32 s98, s98, 16
    s_max_i32 s98, s98, 0
    s_lshl3_add_u32 s98, s100, s98
    v_add_u32 v68, s98, v65
    v_mul_u32_u24 v68, 1152, v68
    s_lshl_b32 s98, s100, 6
    v_xor_b32 v73, s98, v66
    v_add_u32 v96, v68, v73
    s_add_u32 m0, s69, 65536
    s_nop 0
    buffer_load_dwordx4 v2, s[16:19], s60 offen nt lds
    v_lshrrev_b32 v71, 1, v70
    v_xor_b32 v71, v71, v69
    v_lshlrev_b32 v71, 4, v71
    v_lshl_add_u32 v71, v70, 7, v71
    v_xor_b32 v72, 64, v71
    s_lshl_b32 s98, s100, 13
    v_add_u32 v22, s98, v71
    v_add_u32 v23, s98, v72
    v_add_u32 v24, s67, v71
    v_add_u32 v25, s67, v72
    s_lshl_b32 s98, s100, 11
    s_add_u32 s98, s98, 8192
    v_add_u32 v100, s98, v71
    v_add_u32 v101, s98, v72
    v_bfe_u32 v73, v31, 2, 2
    v_and_b32 v74, 3, v31
    v_lshl_add_u32 v75, v69, 3, v73
    v_and_b32 v78, 1, v69
    buffer_load_dwordx4 v3, s[16:19], s60 offen offset:1024 nt lds
    v_lshl_add_u32 v77, v78, 2, v73
    v_lshlrev_b32 v77, 5, v77
    v_lshl_add_u32 v77, v74, 3, v77
    v_lshl_add_u32 v77, v75, 8, v77
    v_xor_b32 v14, 0, v77
    v_xor_b32 v14, s73, v14
    v_xor_b32 v15, 32, v77
    v_xor_b32 v15, s73, v15
    v_xor_b32 v16, 64, v77
    v_xor_b32 v16, s73, v16
    v_xor_b32 v17, 96, v77
    v_xor_b32 v17, s73, v17
    v_xor_b32 v18, 128, v77
    v_xor_b32 v19, 160, v77
    v_xor_b32 v20, 192, v77
    v_xor_b32 v21, 224, v77
    v_lshrrev_b32 v77, 1, v73
    v_lshl_add_u32 v77, v78, 1, v77
    buffer_load_dwordx4 v4, s[16:19], s60 offen offset:2048 nt lds
    v_lshlrev_b32 v77, 5, v77
    v_lshl_add_u32 v77, v74, 3, v77
    v_lshl_add_u32 v77, v75, 7, v77
    s_lshr_b32 s98, s73, 1
    v_xor_b32 v26, 0, v77
    v_xor_b32 v26, s98, v26
    v_xor_b32 v27, 32, v77
    v_xor_b32 v28, 64, v77
    v_xor_b32 v28, s98, v28
    v_xor_b32 v29, 96, v77
    v_and_b32 v73, 7, v0
    v_lshrrev_b32 v74, 3, v0
    v_lshl_add_u32 v75, v73, 1, 0
    v_mul_u32_u24 v78, 52, v75
    v_lshrrev_b32 v78, 8, v78
    v_mul_u32_u24 v79, 5, v78
    v_sub_u32 v75, v75, v79
    v_add_u32 v78, 1, v78
    buffer_load_dwordx4 v5, s[16:19], s60 offen offset:3072 nt lds
    s_xor_b32 s60, s60, 524288
    v_cmp_le_u32 vcc, 3, v78
    s_nop 1
    v_cndmask_b32_e64 v78, v78, 0, vcc
    v_mul_u32_u24 v78, 1152, v78
    v_lshl_add_u32 v75, v75, 3, v78
    v_mad_u32_u24 v75, v74, 36, v75
    v_lshl_add_u32 v77, v73, 1, 1
    v_mul_u32_u24 v78, 52, v77
    v_lshrrev_b32 v78, 8, v78
    v_mul_u32_u24 v79, 5, v78
    v_sub_u32 v77, v77, v79
    v_add_u32 v78, 1, v78
    v_cmp_le_u32 vcc, 3, v78
    s_nop 1
    v_cndmask_b32_e64 v78, v78, 0, vcc
    v_mul_u32_u24 v78, 1152, v78
    v_lshl_add_u32 v77, v77, 3, v78
    v_mad_u32_u24 v77, v74, 36, v77
    s_mul_i32 s98, s2, 10368
    s_mul_i32 s99, s2, 6
    s_mov_b32 s7, 73728
    v_mul_lo_u32 v95, v74, s7
    v_lshl_add_u32 v95, v73, 4, v95
    v_cmp_eq_u32 s[92:93], 7, v73
    s_add_u32 s56, s56, 56623104
    s_addc_u32 s57, s57, 0
    s_mov_b32 s58, 5603328
    s_mov_b32 s59, 0x20000
    s_lshl_b32 s101, s6, 5
    s_add_u32 s101, s101, s5
    s_lshl_b32 s101, s101, 7
    v_mov_b32 v65, 0
    v_lshrrev_b32 v64, 2, v0
    v_lshlrev_b32 v64, 15, v64
    v_and_b32 v79, 3, v0
    v_lshl_add_u32 v64, v79, 2, v64
    s_mov_b32 s74, 0x3e0293ee
    s_lshl_b32 s95, s5, 3
    s_waitcnt vmcnt(5)
    s_barrier
    ds_read_b128 a[0:3], v22 offset:0
    ds_read_b64_tr_b16 v[40:41], v14 offset:32768
    ds_read_b64_tr_b16 v[42:43], v14 offset:33792
    ds_read_b128 a[4:7], v23 offset:0
    ds_read_b64_tr_b16 v[44:45], v14 offset:40960
    ds_read_b64_tr_b16 v[46:47], v14 offset:41984
    ds_read_b128 a[8:11], v22 offset:2048
    ds_read_b128 a[12:15], v23 offset:2048
    ds_read_b128 a[16:19], v22 offset:4096
    ds_read_b128 a[20:23], v23 offset:4096
    ds_read_b128 a[24:27], v22 offset:6144
    ds_read_b128 a[28:31], v23 offset:6144
    ds_read_b128 a[32:35], v22 offset:16384
    ds_read_b128 a[36:39], v23 offset:16384
    ds_read_b128 a[40:43], v22 offset:18432
    s_waitcnt lgkmcnt(14)
    ds_read_b128 a[44:47], v23 offset:18432
    s_waitcnt lgkmcnt(14)
    ds_read_b128 a[48:51], v22 offset:20480
    s_waitcnt lgkmcnt(14)
    ds_read_b128 a[52:55], v23 offset:20480
    s_waitcnt lgkmcnt(14)
    ds_read_b128 a[56:59], v22 offset:22528
    s_waitcnt lgkmcnt(14)
    ds_read_b128 a[60:63], v23 offset:22528
    v_mfma_f32_16x16x32_bf16 v[128:131], v[40:43], a[0:3], 0
    s_add_u32 m0, s69, 81920
    s_waitcnt lgkmcnt(14)
    ds_read_b64_tr_b16 v[48:49], v15 offset:32768
    s_waitcnt lgkmcnt(14)
    ds_read_b64_tr_b16 v[50:51], v15 offset:33792
    v_mfma_f32_16x16x32_bf16 v[128:131], v[44:47], a[4:7], v[128:131]
    s_mul_i32 s77, s2, 9216
    buffer_load_dwordx4 v6, s[8:11], s62 offen lds
    v_mfma_f32_16x16x32_bf16 v[132:135], v[40:43], a[8:11], 0
    s_mul_i32 s76, s4, 1152
    s_waitcnt lgkmcnt(14)
    ds_read_b128 a[64:67], v22 offset:49152
    s_waitcnt lgkmcnt(14)
    ds_read_b64_tr_b16 v[52:53], v15 offset:40960
    v_mfma_f32_16x16x32_bf16 v[132:135], v[44:47], a[12:15], v[132:135]
    s_add_u32 s77, s77, s76
    s_waitcnt lgkmcnt(14)
    ds_read_b64_tr_b16 v[54:55], v15 offset:41984
    s_waitcnt lgkmcnt(14)
    ds_read_b64_tr_b16 v[56:57], v16 offset:32768
    v_mfma_f32_16x16x32_bf16 v[136:139], v[40:43], a[16:19], 0
    s_mul_i32 s76, s4, 1152
    buffer_load_dwordx4 v7, s[8:11], s62 offen offset:1024 lds
    v_mfma_f32_16x16x32_bf16 v[136:139], v[44:47], a[20:23], v[136:139]
    s_mul_i32 s72, s2, 3
    s_waitcnt lgkmcnt(4)
    ds_read_b64_tr_b16 v[58:59], v16 offset:33792
    ds_read_b64_tr_b16 v[60:61], v16 offset:40960
    v_mfma_f32_16x16x32_bf16 v[140:143], v[40:43], a[24:27], 0
    s_add_u32 s72, s72, 0
    ds_read_b64_tr_b16 v[62:63], v16 offset:41984
    v_add_u32 v14, 0x10000, v14
    v_mfma_f32_16x16x32_bf16 v[140:143], v[44:47], a[28:31], v[140:143]
    s_mul_i32 s7, s5, 73728
    ds_read_b128 a[68:71], v23 offset:49152
    v_add_u32 v15, 0x10000, v15
    v_mfma_f32_16x16x32_bf16 v[144:147], v[40:43], a[32:35], 0
    s_and_b32 s100, s5, 1
    buffer_load_dwordx4 v8, s[8:11], s62 offen offset:2048 lds
    v_mfma_f32_16x16x32_bf16 v[144:147], v[44:47], a[36:39], v[144:147]
    s_mov_b64 s[84:85], 0
    v_add_u32 v16, 0x10000, v16
    v_mov_b32 v31, 1
    v_mfma_f32_16x16x32_bf16 v[148:151], v[40:43], a[40:43], 0
    s_mov_b32 s83, 0
    v_add_u32 v18, 0x10000, v18
    v_add_u32 v19, 0x10000, v19
    v_mfma_f32_16x16x32_bf16 v[148:151], v[44:47], a[44:47], v[148:151]
    v_add_u32 v20, 0x10000, v20
    v_add_u32 v21, 0x10000, v21
    v_mfma_f32_16x16x32_bf16 v[152:155], v[40:43], a[48:51], 0
    buffer_load_dwordx4 v9, s[8:11], s62 offen offset:3072 lds
    v_mfma_f32_16x16x32_bf16 v[152:155], v[44:47], a[52:55], v[152:155]
    ds_read_b128 a[72:75], v22 offset:51200
    v_add_u32 v26, 0x10000, v26
    v_mfma_f32_16x16x32_bf16 v[156:159], v[40:43], a[56:59], 0
    s_add_u32 m0, s69, 98304
    ds_read_b64_tr_b16 v[40:41], v17 offset:32768
    ds_read_b64_tr_b16 v[42:43], v17 offset:33792
    v_mfma_f32_16x16x32_bf16 v[156:159], v[44:47], a[60:63], v[156:159]
    s_xor_b32 s62, s62, 384
    ds_read_b64_tr_b16 v[44:45], v17 offset:40960
    ds_read_b64_tr_b16 v[46:47], v17 offset:41984
    v_mfma_f32_16x16x32_bf16 v[160:163], v[48:51], a[0:3], 0
    s_waitcnt lgkmcnt(5)
    buffer_load_dwordx4 v2, s[12:15], s60 offen nt lds
    v_mfma_f32_16x16x32_bf16 v[160:163], v[52:55], a[4:7], v[160:163]
    v_add_u32 v17, 0x10000, v17
    v_add_u32 v27, 0x10000, v27
    v_mfma_f32_16x16x32_bf16 v[164:167], v[48:51], a[8:11], 0
    ds_read_b128 a[76:79], v23 offset:51200
    v_add_u32 v28, 0x10000, v28
    v_mfma_f32_16x16x32_bf16 v[164:167], v[52:55], a[12:15], v[164:167]
    v_add_u32 v29, 0x10000, v29
    v_bfe_u32 v37, v1, 4, 4
    v_mfma_f32_16x16x32_bf16 v[168:171], v[48:51], a[16:19], 0
    buffer_load_dwordx4 v3, s[12:15], s60 offen offset:1024 nt lds
    v_mfma_f32_16x16x32_bf16 v[168:171], v[52:55], a[20:23], v[168:171]
    v_mul_u32_u24 v36, 1152, v37
    v_lshrrev_b32 v38, 8, v1
    v_mfma_f32_16x16x32_bf16 v[172:175], v[48:51], a[24:27], 0
    v_lshl_add_u32 v36, v38, 4, v36
    v_lshrrev_b32 v39, 3, v37
    v_mfma_f32_16x16x32_bf16 v[172:175], v[52:55], a[28:31], v[172:175]
    v_mul_u32_u24 v39, 9152, v39
    v_mfma_f32_16x16x32_bf16 v[176:179], v[48:51], a[32:35], 0
    buffer_load_dwordx4 v4, s[12:15], s60 offen offset:2048 nt lds
    v_mfma_f32_16x16x32_bf16 v[176:179], v[52:55], a[36:39], v[176:179]
    ds_read_b128 a[80:83], v22 offset:53248
    v_mfma_f32_16x16x32_bf16 v[180:183], v[48:51], a[40:43], 0
    v_mfma_f32_16x16x32_bf16 v[180:183], v[52:55], a[44:47], v[180:183]
    v_mfma_f32_16x16x32_bf16 v[184:187], v[48:51], a[48:51], 0
    buffer_load_dwordx4 v5, s[12:15], s60 offen offset:3072 nt lds
    v_mfma_f32_16x16x32_bf16 v[184:187], v[52:55], a[52:55], v[184:187]
    ds_read_b128 a[84:87], v23 offset:53248
    v_mfma_f32_16x16x32_bf16 v[188:191], v[48:51], a[56:59], 0
    s_add_u32 m0, s69, 114688
    v_mfma_f32_16x16x32_bf16 v[188:191], v[52:55], a[60:63], v[188:191]
    v_mfma_f32_16x16x32_bf16 v[192:195], v[56:59], a[0:3], 0
    buffer_load_dwordx4 v6, s[8:11], s61 offen lds
    v_mfma_f32_16x16x32_bf16 v[192:195], v[60:63], a[4:7], v[192:195]
    v_mfma_f32_16x16x32_bf16 v[196:199], v[56:59], a[8:11], 0
    v_mfma_f32_16x16x32_bf16 v[196:199], v[60:63], a[12:15], v[196:199]
    ds_read_b128 a[88:91], v22 offset:55296
    v_mfma_f32_16x16x32_bf16 v[200:203], v[56:59], a[16:19], 0
    buffer_load_dwordx4 v7, s[8:11], s61 offen offset:1024 lds
    v_mfma_f32_16x16x32_bf16 v[200:203], v[60:63], a[20:23], v[200:203]
    v_mfma_f32_16x16x32_bf16 v[204:207], v[56:59], a[24:27], 0
    v_mfma_f32_16x16x32_bf16 v[204:207], v[60:63], a[28:31], v[204:207]
    v_mfma_f32_16x16x32_bf16 v[208:211], v[56:59], a[32:35], 0
    buffer_load_dwordx4 v8, s[8:11], s61 offen offset:2048 lds
    v_mfma_f32_16x16x32_bf16 v[208:211], v[60:63], a[36:39], v[208:211]
    ds_read_b128 a[92:95], v23 offset:55296
    v_mfma_f32_16x16x32_bf16 v[212:215], v[56:59], a[40:43], 0
    v_mfma_f32_16x16x32_bf16 v[212:215], v[60:63], a[44:47], v[212:215]
    v_mfma_f32_16x16x32_bf16 v[216:219], v[56:59], a[48:51], 0
    buffer_load_dwordx4 v9, s[8:11], s61 offen offset:3072 lds
    v_mfma_f32_16x16x32_bf16 v[216:219], v[60:63], a[52:55], v[216:219]
    v_mfma_f32_16x16x32_bf16 v[220:223], v[56:59], a[56:59], 0
    s_xor_b32 s61, s61, 128
    v_mfma_f32_16x16x32_bf16 v[220:223], v[60:63], a[60:63], v[220:223]
    s_add_u32 m0, s69, 131072
    s_waitcnt lgkmcnt(0)
    v_mfma_f32_16x16x32_bf16 v[224:227], v[40:43], a[0:3], 0
    buffer_load_dwordx4 v2, s[16:19], s60 offen nt lds
    v_mfma_f32_16x16x32_bf16 v[224:227], v[44:47], a[4:7], v[224:227]
    v_mfma_f32_16x16x32_bf16 v[228:231], v[40:43], a[8:11], 0
    buffer_load_dword v104, v103, s[20:23], s77 offen
    v_mfma_f32_16x16x32_bf16 v[228:231], v[44:47], a[12:15], v[228:231]
    s_add_u32 s77, s77, 4608
    v_mfma_f32_16x16x32_bf16 v[232:235], v[40:43], a[16:19], 0
    v_mfma_f32_16x16x32_bf16 v[232:235], v[44:47], a[20:23], v[232:235]
    s_waitcnt vmcnt(10)
    s_barrier
    ds_read_b64_tr_b16 v[48:49], v14 offset:0
    v_mfma_f32_16x16x32_bf16 v[236:239], v[40:43], a[24:27], 0
    buffer_load_dwordx4 v3, s[16:19], s60 offen offset:1024 nt lds
    v_mfma_f32_16x16x32_bf16 v[236:239], v[44:47], a[28:31], v[236:239]
    ds_read_b64_tr_b16 v[50:51], v14 offset:1024
    ds_read_b64_tr_b16 v[52:53], v14 offset:8192
    v_mfma_f32_16x16x32_bf16 v[240:243], v[40:43], a[32:35], 0
    ds_read_b64_tr_b16 v[54:55], v14 offset:9216
    ds_read_b64_tr_b16 v[56:57], v15 offset:0
    v_mfma_f32_16x16x32_bf16 v[240:243], v[44:47], a[36:39], v[240:243]
    buffer_load_dwordx4 v4, s[16:19], s60 offen offset:2048 nt lds
    v_mfma_f32_16x16x32_bf16 v[244:247], v[40:43], a[40:43], 0
    ds_read_b64_tr_b16 v[58:59], v15 offset:1024
    ds_read_b64_tr_b16 v[60:61], v15 offset:8192
    v_mfma_f32_16x16x32_bf16 v[244:247], v[44:47], a[44:47], v[244:247]
    ds_read_b64_tr_b16 v[62:63], v15 offset:9216
    v_mfma_f32_16x16x32_bf16 v[248:251], v[40:43], a[48:51], 0
    v_mfma_f32_16x16x32_bf16 v[248:251], v[44:47], a[52:55], v[248:251]
    buffer_load_dwordx4 v5, s[16:19], s60 offen offset:3072 nt lds
    v_mfma_f32_16x16x32_bf16 v[252:255], v[40:43], a[56:59], 0
    ds_read_b64_tr_b16 v[40:41], v16 offset:0
    ds_read_b64_tr_b16 v[42:43], v16 offset:1024
    v_mfma_f32_16x16x32_bf16 v[252:255], v[44:47], a[60:63], v[252:255]
    s_waitcnt lgkmcnt(3)
    ds_read_b64_tr_b16 v[44:45], v16 offset:8192
    ds_read_b64_tr_b16 v[46:47], v16 offset:9216
    v_mfma_f32_16x16x32_bf16 a[128:131], a[0:3], v[48:51], 0
    v_mfma_f32_16x16x32_bf16 a[128:131], a[4:7], v[52:55], a[128:131]
    s_add_u32 m0, s69, 147456
    v_add_u32 v22, 0x10000, v22
    v_mfma_f32_16x16x32_bf16 a[132:135], a[8:11], v[48:51], 0
    s_xor_b32 s60, s60, 1572864
    buffer_load_dwordx4 v6, s[8:11], s62 offen lds
    v_mfma_f32_16x16x32_bf16 a[132:135], a[12:15], v[52:55], a[132:135]
    ds_read_b128 a[96:99], v22 offset:16384
    v_mfma_f32_16x16x32_bf16 a[136:139], a[16:19], v[48:51], 0
    v_mfma_f32_16x16x32_bf16 a[136:139], a[20:23], v[52:55], a[136:139]
    v_mfma_f32_16x16x32_bf16 a[140:143], a[24:27], v[48:51], 0
    buffer_load_dwordx4 v7, s[8:11], s62 offen offset:1024 lds
    v_mfma_f32_16x16x32_bf16 a[140:143], a[28:31], v[52:55], a[140:143]
    v_add_u32 v23, 0x10000, v23
    ds_read_b128 a[100:103], v23 offset:16384
    v_mfma_f32_16x16x32_bf16 a[144:147], a[32:35], v[48:51], 0
    v_mfma_f32_16x16x32_bf16 a[144:147], a[36:39], v[52:55], a[144:147]
    v_mfma_f32_16x16x32_bf16 a[148:151], a[40:43], v[48:51], 0
    v_mfma_f32_16x16x32_bf16 a[148:151], a[44:47], v[52:55], a[148:151]
    buffer_load_dwordx4 v8, s[8:11], s62 offen offset:2048 lds
    v_mfma_f32_16x16x32_bf16 a[152:155], a[48:51], v[48:51], 0
    v_mfma_f32_16x16x32_bf16 a[152:155], a[52:55], v[52:55], a[152:155]
    ds_read_b128 a[104:107], v22 offset:18432
    v_mfma_f32_16x16x32_bf16 a[156:159], a[56:59], v[48:51], 0
    ds_read_b64_tr_b16 v[48:49], v17 offset:0
    ds_read_b64_tr_b16 v[50:51], v17 offset:1024
    v_mfma_f32_16x16x32_bf16 a[156:159], a[60:63], v[52:55], a[156:159]
    buffer_load_dwordx4 v9, s[8:11], s62 offen offset:3072 lds
    v_mfma_f32_16x16x32_bf16 a[160:163], a[0:3], v[56:59], 0
    s_waitcnt lgkmcnt(3)
    ds_read_b64_tr_b16 v[52:53], v17 offset:8192
    ds_read_b64_tr_b16 v[54:55], v17 offset:9216
    v_mfma_f32_16x16x32_bf16 a[160:163], a[4:7], v[60:63], a[160:163]
    v_mfma_f32_16x16x32_bf16 a[164:167], a[8:11], v[56:59], 0
    ds_read_b128 a[108:111], v23 offset:18432
    v_mfma_f32_16x16x32_bf16 a[164:167], a[12:15], v[60:63], a[164:167]
    s_add_u32 m0, s69, 0
    v_mfma_f32_16x16x32_bf16 a[168:171], a[16:19], v[56:59], 0
    s_xor_b32 s62, s62, 128
    buffer_load_dwordx4 v2, s[12:15], s60 offen nt lds
    v_mfma_f32_16x16x32_bf16 a[168:171], a[20:23], v[60:63], a[168:171]
    v_mfma_f32_16x16x32_bf16 a[172:175], a[24:27], v[56:59], 0
    v_mfma_f32_16x16x32_bf16 a[172:175], a[28:31], v[60:63], a[172:175]
    v_mfma_f32_16x16x32_bf16 a[176:179], a[32:35], v[56:59], 0
    buffer_load_dwordx4 v3, s[12:15], s60 offen offset:1024 nt lds
    v_mfma_f32_16x16x32_bf16 a[176:179], a[36:39], v[60:63], a[176:179]
    ds_read_b128 a[112:115], v22 offset:20480
    v_mfma_f32_16x16x32_bf16 a[180:183], a[40:43], v[56:59], 0
    v_mfma_f32_16x16x32_bf16 a[180:183], a[44:47], v[60:63], a[180:183]
    v_mfma_f32_16x16x32_bf16 a[184:187], a[48:51], v[56:59], 0
    v_mfma_f32_16x16x32_bf16 a[184:187], a[52:55], v[60:63], a[184:187]
    buffer_load_dwordx4 v4, s[12:15], s60 offen offset:2048 nt lds
    v_mfma_f32_16x16x32_bf16 a[188:191], a[56:59], v[56:59], 0
    ds_read_b128 a[116:119], v23 offset:20480
    v_mfma_f32_16x16x32_bf16 a[188:191], a[60:63], v[60:63], a[188:191]
    v_mfma_f32_16x16x32_bf16 a[192:195], a[0:3], v[40:43], 0
    v_mfma_f32_16x16x32_bf16 a[192:195], a[4:7], v[44:47], a[192:195]
    buffer_load_dwordx4 v5, s[12:15], s60 offen offset:3072 nt lds
    v_mfma_f32_16x16x32_bf16 a[196:199], a[8:11], v[40:43], 0
    v_mfma_f32_16x16x32_bf16 a[196:199], a[12:15], v[44:47], a[196:199]
    ds_read_b128 a[120:123], v22 offset:22528
    v_mfma_f32_16x16x32_bf16 a[200:203], a[16:19], v[40:43], 0
    v_mfma_f32_16x16x32_bf16 a[200:203], a[20:23], v[44:47], a[200:203]
    s_add_u32 m0, s69, 16384
    v_mfma_f32_16x16x32_bf16 a[204:207], a[24:27], v[40:43], 0
    buffer_load_dwordx4 v6, s[8:11], s61 offen lds
    v_mfma_f32_16x16x32_bf16 a[204:207], a[28:31], v[44:47], a[204:207]
    v_mfma_f32_16x16x32_bf16 a[208:211], a[32:35], v[40:43], 0
    ds_read_b128 a[124:127], v23 offset:22528
    v_mfma_f32_16x16x32_bf16 a[208:211], a[36:39], v[44:47], a[208:211]
    v_mfma_f32_16x16x32_bf16 a[212:215], a[40:43], v[40:43], 0
    buffer_load_dwordx4 v7, s[8:11], s61 offen offset:1024 lds
    v_mfma_f32_16x16x32_bf16 a[212:215], a[44:47], v[44:47], a[212:215]
    v_mfma_f32_16x16x32_bf16 a[216:219], a[48:51], v[40:43], 0
    v_mfma_f32_16x16x32_bf16 a[216:219], a[52:55], v[44:47], a[216:219]
    v_mfma_f32_16x16x32_bf16 a[220:223], a[56:59], v[40:43], 0
    v_mfma_f32_16x16x32_bf16 a[220:223], a[60:63], v[44:47], a[220:223]
    s_waitcnt lgkmcnt(0)
    buffer_load_dwordx4 v8, s[8:11], s61 offen offset:2048 lds
    v_mfma_f32_16x16x32_bf16 a[224:227], a[0:3], v[48:51], 0
    v_mfma_f32_16x16x32_bf16 a[224:227], a[4:7], v[52:55], a[224:227]
    v_mfma_f32_16x16x32_bf16 a[228:231], a[8:11], v[48:51], 0
    v_mfma_f32_16x16x32_bf16 a[228:231], a[12:15], v[52:55], a[228:231]
    buffer_load_dwordx4 v9, s[8:11], s61 offen offset:3072 lds
    v_mfma_f32_16x16x32_bf16 a[232:235], a[16:19], v[48:51], 0
    v_mfma_f32_16x16x32_bf16 a[232:235], a[20:23], v[52:55], a[232:235]
    s_waitcnt vmcnt(8) lgkmcnt(0)
    s_barrier
    ds_read_b64_tr_b16 v[56:57], v14 offset:32768
    v_mfma_f32_16x16x32_bf16 a[236:239], a[24:27], v[48:51], 0
    s_add_u32 m0, s69, 32768
    ds_read_b64_tr_b16 v[58:59], v14 offset:33792
    ds_read_b64_tr_b16 v[60:61], v14 offset:40960
    v_mfma_f32_16x16x32_bf16 a[236:239], a[28:31], v[52:55], a[236:239]
    s_xor_b32 s61, s61, 896
    buffer_load_dwordx4 v2, s[16:19], s60 offen nt lds
    v_mfma_f32_16x16x32_bf16 a[240:243], a[32:35], v[48:51], 0
    ds_read_b64_tr_b16 v[62:63], v14 offset:41984
    ds_read_b64_tr_b16 v[40:41], v15 offset:32768
    v_mfma_f32_16x16x32_bf16 a[240:243], a[36:39], v[52:55], a[240:243]
    ds_read_b64_tr_b16 v[42:43], v15 offset:33792
    ds_read_b64_tr_b16 v[44:45], v15 offset:40960
    v_mfma_f32_16x16x32_bf16 a[244:247], a[40:43], v[48:51], 0
    ds_read_b64_tr_b16 v[46:47], v15 offset:41984
    v_add_u32 v14, 0x10000, v14
    v_mfma_f32_16x16x32_bf16 a[244:247], a[44:47], v[52:55], a[244:247]
    v_add_u32 v15, 0x10000, v15
    v_mfma_f32_16x16x32_bf16 a[248:251], a[48:51], v[48:51], 0
    v_mfma_f32_16x16x32_bf16 a[248:251], a[52:55], v[52:55], a[248:251]
    buffer_load_dwordx4 v3, s[16:19], s60 offen offset:1024 nt lds
    v_mfma_f32_16x16x32_bf16 a[252:255], a[56:59], v[48:51], 0
    ds_read_b64_tr_b16 v[48:49], v16 offset:32768
    ds_read_b64_tr_b16 v[50:51], v16 offset:33792
    v_mfma_f32_16x16x32_bf16 a[252:255], a[60:63], v[52:55], a[252:255]
    s_waitcnt lgkmcnt(2)
    ds_read_b64_tr_b16 v[52:53], v16 offset:40960
    ds_read_b64_tr_b16 v[54:55], v16 offset:41984
    v_mfma_f32_16x16x32_bf16 v[128:131], v[56:59], a[64:67], v[128:131]
    v_add_u32 v16, 0x10000, v16
    v_mfma_f32_16x16x32_bf16 v[128:131], v[60:63], a[68:71], v[128:131]
    v_mfma_f32_16x16x32_bf16 v[132:135], v[56:59], a[72:75], v[132:135]
    ds_read_b128 a[0:3], v22 offset:49152
    v_mfma_f32_16x16x32_bf16 v[132:135], v[60:63], a[76:79], v[132:135]
    v_mfma_f32_16x16x32_bf16 v[136:139], v[56:59], a[80:83], v[136:139]
    v_mfma_f32_16x16x32_bf16 v[136:139], v[60:63], a[84:87], v[136:139]
    buffer_load_dwordx4 v4, s[16:19], s60 offen offset:2048 nt lds
    v_mfma_f32_16x16x32_bf16 v[140:143], v[56:59], a[88:91], v[140:143]
    v_mfma_f32_16x16x32_bf16 v[140:143], v[60:63], a[92:95], v[140:143]
    ds_read_b128 a[4:7], v23 offset:49152
    v_mfma_f32_16x16x32_bf16 v[144:147], v[56:59], a[96:99], v[144:147]
    v_mfma_f32_16x16x32_bf16 v[144:147], v[60:63], a[100:103], v[144:147]
    v_mfma_f32_16x16x32_bf16 v[148:151], v[56:59], a[104:107], v[148:151]
    v_mfma_f32_16x16x32_bf16 v[148:151], v[60:63], a[108:111], v[148:151]
    v_mfma_f32_16x16x32_bf16 v[152:155], v[56:59], a[112:115], v[152:155]
    buffer_load_dwordx4 v5, s[16:19], s60 offen offset:3072 nt lds
    v_mfma_f32_16x16x32_bf16 v[152:155], v[60:63], a[116:119], v[152:155]
    ds_read_b128 a[8:11], v22 offset:51200
    v_mfma_f32_16x16x32_bf16 v[156:159], v[56:59], a[120:123], v[156:159]
    ds_read_b64_tr_b16 v[56:57], v17 offset:32768
    ds_read_b64_tr_b16 v[58:59], v17 offset:33792
    v_mfma_f32_16x16x32_bf16 v[156:159], v[60:63], a[124:127], v[156:159]
    ds_read_b64_tr_b16 v[60:61], v17 offset:40960
    ds_read_b64_tr_b16 v[62:63], v17 offset:41984
    v_mfma_f32_16x16x32_bf16 v[160:163], v[40:43], a[64:67], v[160:163]
    v_add_u32 v17, 0x10000, v17
    v_mfma_f32_16x16x32_bf16 v[160:163], v[44:47], a[68:71], v[160:163]
    v_mfma_f32_16x16x32_bf16 v[164:167], v[40:43], a[72:75], v[164:167]
    ds_read_b128 a[12:15], v23 offset:51200
    v_mfma_f32_16x16x32_bf16 v[164:167], v[44:47], a[76:79], v[164:167]
    s_add_u32 m0, s69, 49152
    v_mfma_f32_16x16x32_bf16 v[168:171], v[40:43], a[80:83], v[168:171]
    s_xor_b32 s60, s60, 524288
    buffer_load_dwordx4 v6, s[8:11], s62 offen lds
    v_mfma_f32_16x16x32_bf16 v[168:171], v[44:47], a[84:87], v[168:171]
    v_mfma_f32_16x16x32_bf16 v[172:175], v[40:43], a[88:91], v[172:175]
    v_mfma_f32_16x16x32_bf16 v[172:175], v[44:47], a[92:95], v[172:175]
    v_mfma_f32_16x16x32_bf16 v[176:179], v[40:43], a[96:99], v[176:179]
    ds_read_b128 a[16:19], v22 offset:53248
    v_mfma_f32_16x16x32_bf16 v[176:179], v[44:47], a[100:103], v[176:179]
    v_mfma_f32_16x16x32_bf16 v[180:183], v[40:43], a[104:107], v[180:183]
    v_mfma_f32_16x16x32_bf16 v[180:183], v[44:47], a[108:111], v[180:183]
    buffer_load_dwordx4 v7, s[8:11], s62 offen offset:1024 lds
    v_mfma_f32_16x16x32_bf16 v[184:187], v[40:43], a[112:115], v[184:187]
    v_mfma_f32_16x16x32_bf16 v[184:187], v[44:47], a[116:119], v[184:187]
    ds_read_b128 a[20:23], v23 offset:53248
    v_mfma_f32_16x16x32_bf16 v[188:191], v[40:43], a[120:123], v[188:191]
    s_waitcnt lgkmcnt(1)
    ds_read_b64_tr_b16 v[40:41], v14 offset:0
    ds_read_b64_tr_b16 v[42:43], v14 offset:1024
    v_mfma_f32_16x16x32_bf16 v[188:191], v[44:47], a[124:127], v[188:191]
    ds_read_b64_tr_b16 v[44:45], v14 offset:8192
    ds_read_b64_tr_b16 v[46:47], v14 offset:9216
    v_mfma_f32_16x16x32_bf16 v[192:195], v[48:51], a[64:67], v[192:195]
    v_add_u32 v14, 0xfffe0000, v14
    v_mfma_f32_16x16x32_bf16 v[192:195], v[52:55], a[68:71], v[192:195]
    v_mfma_f32_16x16x32_bf16 v[196:199], v[48:51], a[72:75], v[196:199]
    v_mfma_f32_16x16x32_bf16 v[196:199], v[52:55], a[76:79], v[196:199]
    buffer_load_dwordx4 v8, s[8:11], s62 offen offset:2048 lds
    v_mfma_f32_16x16x32_bf16 v[200:203], v[48:51], a[80:83], v[200:203]
    ds_read_b128 a[24:27], v22 offset:55296
    v_mfma_f32_16x16x32_bf16 v[200:203], v[52:55], a[84:87], v[200:203]
    v_mfma_f32_16x16x32_bf16 v[204:207], v[48:51], a[88:91], v[204:207]
    v_mfma_f32_16x16x32_bf16 v[204:207], v[52:55], a[92:95], v[204:207]
    v_mfma_f32_16x16x32_bf16 v[208:211], v[48:51], a[96:99], v[208:211]
    ds_read_b128 a[28:31], v23 offset:55296
    v_mfma_f32_16x16x32_bf16 v[208:211], v[52:55], a[100:103], v[208:211]
    v_mfma_f32_16x16x32_bf16 v[212:215], v[48:51], a[104:107], v[212:215]
    buffer_load_dwordx4 v9, s[8:11], s62 offen offset:3072 lds
    v_mfma_f32_16x16x32_bf16 v[212:215], v[52:55], a[108:111], v[212:215]
    v_mfma_f32_16x16x32_bf16 v[216:219], v[48:51], a[112:115], v[216:219]
    v_mfma_f32_16x16x32_bf16 v[216:219], v[52:55], a[116:119], v[216:219]
    v_mfma_f32_16x16x32_bf16 v[220:223], v[48:51], a[120:123], v[220:223]
    ds_read_b64_tr_b16 v[48:49], v15 offset:0
    ds_read_b64_tr_b16 v[50:51], v15 offset:1024
    v_mfma_f32_16x16x32_bf16 v[220:223], v[52:55], a[124:127], v[220:223]
    ds_read_b64_tr_b16 v[52:53], v15 offset:8192
    ds_read_b64_tr_b16 v[54:55], v15 offset:9216
    v_mfma_f32_16x16x32_bf16 v[224:227], v[56:59], a[64:67], v[224:227]
    buffer_load_dwordx2 v[80:81], v75, s[28:31], s98 offen nt
    v_mfma_f32_16x16x32_bf16 v[224:227], v[60:63], a[68:71], v[224:227]
    s_xor_b32 s62, s62, 896
    v_add_u32 v15, 0xfffe0000, v15
    v_mfma_f32_16x16x32_bf16 v[228:231], v[56:59], a[72:75], v[228:231]
    buffer_load_dword v105, v103, s[20:23], s77 offen
    v_mfma_f32_16x16x32_bf16 v[228:231], v[60:63], a[76:79], v[228:231]
    s_mul_i32 s77, s2, 18432
    v_mfma_f32_16x16x32_bf16 v[232:235], v[56:59], a[80:83], v[232:235]
    s_add_u32 s77, s77, s76
    buffer_load_dwordx2 v[82:83], v77, s[28:31], s98 offen nt
    v_mfma_f32_16x16x32_bf16 v[232:235], v[60:63], a[84:87], v[232:235]
    s_add_u32 s98, s98, 3456
    v_mfma_f32_16x16x32_bf16 v[236:239], v[56:59], a[88:91], v[236:239]
    s_add_u32 m0, s69, 65536
    v_mfma_f32_16x16x32_bf16 v[236:239], v[60:63], a[92:95], v[236:239]
    s_mov_b32 s76, 0
    v_mfma_f32_16x16x32_bf16 v[240:243], v[56:59], a[96:99], v[240:243]
    buffer_load_ushort v92, v65, s[32:35], s99 offen offset:0
    v_mfma_f32_16x16x32_bf16 v[240:243], v[60:63], a[100:103], v[240:243]
    v_mfma_f32_16x16x32_bf16 v[244:247], v[56:59], a[104:107], v[244:247]
    v_mfma_f32_16x16x32_bf16 v[244:247], v[60:63], a[108:111], v[244:247]
    v_mfma_f32_16x16x32_bf16 v[248:251], v[56:59], a[112:115], v[248:251]
    buffer_load_dwordx2 v[84:85], v75, s[28:31], s98 offen nt
    v_mfma_f32_16x16x32_bf16 v[248:251], v[60:63], a[116:119], v[248:251]
    v_mfma_f32_16x16x32_bf16 v[252:255], v[56:59], a[120:123], v[252:255]
    ds_read_b64_tr_b16 v[56:57], v16 offset:0
    ds_read_b64_tr_b16 v[58:59], v16 offset:1024
    v_mfma_f32_16x16x32_bf16 v[252:255], v[60:63], a[124:127], v[252:255]
    s_waitcnt lgkmcnt(2)
    ds_read_b64_tr_b16 v[60:61], v16 offset:8192
    ds_read_b64_tr_b16 v[62:63], v16 offset:9216
    v_mfma_f32_16x16x32_bf16 a[128:131], a[64:67], v[40:43], a[128:131]
    buffer_load_dwordx4 v2, s[12:15], s60 offen nt lds
    v_mfma_f32_16x16x32_bf16 a[128:131], a[68:71], v[44:47], a[128:131]
    v_add_u32 v22, 0x10000, v22
    v_add_u32 v16, 0xfffe0000, v16
    v_mfma_f32_16x16x32_bf16 a[132:135], a[72:75], v[40:43], a[132:135]
    ds_read_b128 a[32:35], v22 offset:16384
    v_mfma_f32_16x16x32_bf16 a[132:135], a[76:79], v[44:47], a[132:135]
    v_mfma_f32_16x16x32_bf16 a[136:139], a[80:83], v[40:43], a[136:139]
    buffer_load_dwordx2 v[86:87], v77, s[28:31], s98 offen nt
    v_mfma_f32_16x16x32_bf16 a[136:139], a[84:87], v[44:47], a[136:139]
    s_add_u32 s98, s98, 3456
    v_mfma_f32_16x16x32_bf16 a[140:143], a[88:91], v[40:43], a[140:143]
    v_add_u32 v23, 0x10000, v23
    v_mfma_f32_16x16x32_bf16 a[140:143], a[92:95], v[44:47], a[140:143]
    ds_read_b128 a[36:39], v23 offset:16384
    v_mfma_f32_16x16x32_bf16 a[144:147], a[96:99], v[40:43], a[144:147]
    buffer_load_ushort v93, v65, s[32:35], s99 offen offset:2
    v_mfma_f32_16x16x32_bf16 a[144:147], a[100:103], v[44:47], a[144:147]
    v_mfma_f32_16x16x32_bf16 a[148:151], a[104:107], v[40:43], a[148:151]
    v_mfma_f32_16x16x32_bf16 a[148:151], a[108:111], v[44:47], a[148:151]
    v_mfma_f32_16x16x32_bf16 a[152:155], a[112:115], v[40:43], a[152:155]
    buffer_load_dwordx2 v[88:89], v75, s[28:31], s98 offen nt
    v_mfma_f32_16x16x32_bf16 a[152:155], a[116:119], v[44:47], a[152:155]
    ds_read_b128 a[40:43], v22 offset:18432
    v_mfma_f32_16x16x32_bf16 a[156:159], a[120:123], v[40:43], a[156:159]
    ds_read_b64_tr_b16 v[40:41], v17 offset:0
    ds_read_b64_tr_b16 v[42:43], v17 offset:1024
    v_mfma_f32_16x16x32_bf16 a[156:159], a[124:127], v[44:47], a[156:159]
    ds_read_b64_tr_b16 v[44:45], v17 offset:8192
    ds_read_b64_tr_b16 v[46:47], v17 offset:9216
    v_mfma_f32_16x16x32_bf16 a[160:163], a[64:67], v[48:51], a[160:163]
    buffer_load_dwordx4 v3, s[12:15], s60 offen offset:1024 nt lds
    v_mfma_f32_16x16x32_bf16 a[160:163], a[68:71], v[52:55], a[160:163]
    v_add_u32 v17, 0xfffe0000, v17
    v_mfma_f32_16x16x32_bf16 a[164:167], a[72:75], v[48:51], a[164:167]
    ds_read_b128 a[44:47], v23 offset:18432
    v_mfma_f32_16x16x32_bf16 a[164:167], a[76:79], v[52:55], a[164:167]
    v_mfma_f32_16x16x32_bf16 a[168:171], a[80:83], v[48:51], a[168:171]
    buffer_load_dwordx2 v[90:91], v77, s[28:31], s98 offen nt
    v_mfma_f32_16x16x32_bf16 a[168:171], a[84:87], v[52:55], a[168:171]
    s_add_u32 s98, s98, 3456
    s_add_u32 s28, s56, 6291456
    s_addc_u32 s29, s57, 0
    v_mfma_f32_16x16x32_bf16 a[172:175], a[88:91], v[48:51], a[172:175]
    s_mov_b32 s30, 2359296
    v_mfma_f32_16x16x32_bf16 a[172:175], a[92:95], v[52:55], a[172:175]
    s_bfe_u32 s98, s72, 0x10001
    v_mfma_f32_16x16x32_bf16 a[176:179], a[96:99], v[48:51], a[176:179]
    buffer_load_ushort v94, v65, s[32:35], s99 offen offset:4
    v_mfma_f32_16x16x32_bf16 a[176:179], a[100:103], v[52:55], a[176:179]
    s_add_u32 s32, s56, 9437184
    s_addc_u32 s33, s57, 0
    s_mov_b32 s34, 196608
    v_mfma_f32_16x16x32_bf16 a[180:183], a[104:107], v[48:51], a[180:183]
    s_bfe_u32 s99, s72, 0x10003
    ds_read_b128 a[48:51], v22 offset:20480
    v_mfma_f32_16x16x32_bf16 a[180:183], a[108:111], v[52:55], a[180:183]
    s_lshl1_add_u32 s98, s99, s98
    v_mfma_f32_16x16x32_bf16 a[184:187], a[112:115], v[48:51], a[184:187]
    s_lshl_b32 s98, s98, 5
    buffer_store_dword v65, v64, s[32:35], s101 offen sc1
    v_mfma_f32_16x16x32_bf16 a[184:187], a[116:119], v[52:55], a[184:187]
    s_lshl_b32 s72, s72, 7
    ds_read_b128 a[52:55], v23 offset:20480
    v_mfma_f32_16x16x32_bf16 a[188:191], a[120:123], v[48:51], a[188:191]
    v_mfma_f32_16x16x32_bf16 a[188:191], a[124:127], v[52:55], a[188:191]
    s_waitcnt lgkmcnt(1)
    v_mfma_f32_16x16x32_bf16 a[192:195], a[64:67], v[56:59], a[192:195]
    buffer_load_dwordx4 v4, s[12:15], s60 offen offset:2048 nt lds
    v_mfma_f32_16x16x32_bf16 a[192:195], a[68:71], v[60:63], a[192:195]
    v_mfma_f32_16x16x32_bf16 a[196:199], a[72:75], v[56:59], a[196:199]
    v_mfma_f32_16x16x32_bf16 a[196:199], a[76:79], v[60:63], a[196:199]
    ds_read_b128 a[56:59], v22 offset:22528
    v_mfma_f32_16x16x32_bf16 a[200:203], a[80:83], v[56:59], a[200:203]
    buffer_load_dwordx4 v5, s[12:15], s60 offen offset:3072 nt lds
    v_mfma_f32_16x16x32_bf16 a[200:203], a[84:87], v[60:63], a[200:203]
    s_add_u32 m0, s69, 81920
    v_mfma_f32_16x16x32_bf16 a[204:207], a[88:91], v[56:59], a[204:207]
    v_mfma_f32_16x16x32_bf16 a[204:207], a[92:95], v[60:63], a[204:207]
    v_mfma_f32_16x16x32_bf16 a[208:211], a[96:99], v[56:59], a[208:211]
    buffer_load_dwordx4 v6, s[8:11], s61 offen lds
    v_mfma_f32_16x16x32_bf16 a[208:211], a[100:103], v[60:63], a[208:211]
    ds_read_b128 a[60:63], v23 offset:22528
    v_mfma_f32_16x16x32_bf16 a[212:215], a[104:107], v[56:59], a[212:215]
    v_mfma_f32_16x16x32_bf16 a[212:215], a[108:111], v[60:63], a[212:215]
    v_mfma_f32_16x16x32_bf16 a[216:219], a[112:115], v[56:59], a[216:219]
    buffer_load_dwordx4 v7, s[8:11], s61 offen offset:1024 lds
    v_mfma_f32_16x16x32_bf16 a[216:219], a[116:119], v[60:63], a[216:219]
    v_mfma_f32_16x16x32_bf16 a[220:223], a[120:123], v[56:59], a[220:223]
    v_mfma_f32_16x16x32_bf16 a[220:223], a[124:127], v[60:63], a[220:223]
    v_mfma_f32_16x16x32_bf16 a[224:227], a[64:67], v[40:43], a[224:227]
    buffer_load_dwordx4 v8, s[8:11], s61 offen offset:2048 lds
    v_mfma_f32_16x16x32_bf16 a[224:227], a[68:71], v[44:47], a[224:227]
    v_mfma_f32_16x16x32_bf16 a[228:231], a[72:75], v[40:43], a[228:231]
    v_mfma_f32_16x16x32_bf16 a[228:231], a[76:79], v[44:47], a[228:231]
    v_mfma_f32_16x16x32_bf16 a[232:235], a[80:83], v[40:43], a[232:235]
    buffer_load_dwordx4 v9, s[8:11], s61 offen offset:3072 lds
    v_mfma_f32_16x16x32_bf16 a[232:235], a[84:87], v[44:47], a[232:235]
    s_xor_b32 s61, s61, 128
    s_waitcnt vmcnt(19) lgkmcnt(0)
    s_barrier
    v_mfma_f32_16x16x32_bf16 a[236:239], a[88:91], v[40:43], a[236:239]
    s_add_u32 m0, s69, 98304
    ds_read_b64_tr_b16 v[48:49], v14 offset:0
    ds_read_b64_tr_b16 v[50:51], v14 offset:1024
    v_mfma_f32_16x16x32_bf16 a[236:239], a[92:95], v[44:47], a[236:239]
    ds_read_b64_tr_b16 v[52:53], v14 offset:8192
    ds_read_b64_tr_b16 v[54:55], v14 offset:9216
    v_mfma_f32_16x16x32_bf16 a[240:243], a[96:99], v[40:43], a[240:243]
    buffer_load_dwordx4 v2, s[16:19], s60 offen nt lds
    v_mfma_f32_16x16x32_bf16 a[240:243], a[100:103], v[44:47], a[240:243]
    ds_read_b64_tr_b16 v[56:57], v15 offset:0
    ds_read_b64_tr_b16 v[58:59], v15 offset:1024
    v_mfma_f32_16x16x32_bf16 a[244:247], a[104:107], v[40:43], a[244:247]
    ds_read_b64_tr_b16 v[60:61], v15 offset:8192
    ds_read_b64_tr_b16 v[62:63], v15 offset:9216
    v_mfma_f32_16x16x32_bf16 a[244:247], a[108:111], v[44:47], a[244:247]
    s_cmp_lt_u32 s2, 192
    s_cselect_b32 s72, s72, 1073741824
    v_mfma_f32_16x16x32_bf16 a[248:251], a[112:115], v[40:43], a[248:251]
    v_mfma_f32_16x16x32_bf16 a[248:251], a[116:119], v[44:47], a[248:251]
    buffer_load_dwordx4 v3, s[16:19], s60 offen offset:1024 nt lds
    v_mfma_f32_16x16x32_bf16 a[252:255], a[120:123], v[40:43], a[252:255]
    ds_read_b64_tr_b16 v[40:41], v16 offset:0
    ds_read_b64_tr_b16 v[42:43], v16 offset:1024
    v_mfma_f32_16x16x32_bf16 a[252:255], a[124:127], v[44:47], a[252:255]
    s_waitcnt lgkmcnt(2)
    ds_read_b64_tr_b16 v[44:45], v16 offset:8192
    ds_read_b64_tr_b16 v[46:47], v16 offset:9216
    v_mfma_f32_16x16x32_bf16 v[128:131], v[48:51], a[0:3], v[128:131]
    v_mfma_f32_16x16x32_bf16 v[128:131], v[52:55], a[4:7], v[128:131]
    v_add_u32 v22, 0xfffe0000, v22
    v_mfma_f32_16x16x32_bf16 v[132:135], v[48:51], a[8:11], v[132:135]
    ds_read_b128 a[64:67], v22 offset:16384
    v_mfma_f32_16x16x32_bf16 v[132:135], v[52:55], a[12:15], v[132:135]
    v_mfma_f32_16x16x32_bf16 v[136:139], v[48:51], a[16:19], v[136:139]
    v_mfma_f32_16x16x32_bf16 v[136:139], v[52:55], a[20:23], v[136:139]
    buffer_load_dwordx4 v4, s[16:19], s60 offen offset:2048 nt lds
    v_mfma_f32_16x16x32_bf16 v[140:143], v[48:51], a[24:27], v[140:143]
    v_add_u32 v23, 0xfffe0000, v23
    v_mfma_f32_16x16x32_bf16 v[140:143], v[52:55], a[28:31], v[140:143]
    ds_read_b128 a[68:71], v23 offset:16384
    v_mfma_f32_16x16x32_bf16 v[144:147], v[48:51], a[32:35], v[144:147]
    v_mfma_f32_16x16x32_bf16 v[144:147], v[52:55], a[36:39], v[144:147]
    v_mfma_f32_16x16x32_bf16 v[148:151], v[48:51], a[40:43], v[148:151]
    v_mfma_f32_16x16x32_bf16 v[148:151], v[52:55], a[44:47], v[148:151]
    v_mfma_f32_16x16x32_bf16 v[152:155], v[48:51], a[48:51], v[152:155]
    buffer_load_dwordx4 v5, s[16:19], s60 offen offset:3072 nt lds
    v_mfma_f32_16x16x32_bf16 v[152:155], v[52:55], a[52:55], v[152:155]
    ds_read_b128 a[72:75], v22 offset:18432
    v_mfma_f32_16x16x32_bf16 v[156:159], v[48:51], a[56:59], v[156:159]
    ds_read_b64_tr_b16 v[48:49], v17 offset:0
    ds_read_b64_tr_b16 v[50:51], v17 offset:1024
    v_mfma_f32_16x16x32_bf16 v[156:159], v[52:55], a[60:63], v[156:159]
    ds_read_b64_tr_b16 v[52:53], v17 offset:8192
    ds_read_b64_tr_b16 v[54:55], v17 offset:9216
    v_mfma_f32_16x16x32_bf16 v[160:163], v[56:59], a[0:3], v[160:163]
    v_mfma_f32_16x16x32_bf16 v[160:163], v[60:63], a[4:7], v[160:163]
    v_mfma_f32_16x16x32_bf16 v[164:167], v[56:59], a[8:11], v[164:167]
    ds_read_b128 a[76:79], v23 offset:18432
    v_mfma_f32_16x16x32_bf16 v[164:167], v[60:63], a[12:15], v[164:167]
    s_add_u32 m0, s69, 114688
    v_mfma_f32_16x16x32_bf16 v[168:171], v[56:59], a[16:19], v[168:171]
    s_xor_b32 s60, s60, 3670016
    buffer_load_dwordx4 v6, s[8:11], s62 offen lds
    v_mfma_f32_16x16x32_bf16 v[168:171], v[60:63], a[20:23], v[168:171]
    v_mfma_f32_16x16x32_bf16 v[172:175], v[56:59], a[24:27], v[172:175]
    v_mfma_f32_16x16x32_bf16 v[172:175], v[60:63], a[28:31], v[172:175]
    v_mfma_f32_16x16x32_bf16 v[176:179], v[56:59], a[32:35], v[176:179]
    ds_read_b128 a[80:83], v22 offset:20480
    v_mfma_f32_16x16x32_bf16 v[176:179], v[60:63], a[36:39], v[176:179]
    v_mfma_f32_16x16x32_bf16 v[180:183], v[56:59], a[40:43], v[180:183]
    v_mfma_f32_16x16x32_bf16 v[180:183], v[60:63], a[44:47], v[180:183]
    buffer_load_dwordx4 v7, s[8:11], s62 offen offset:1024 lds
    v_mfma_f32_16x16x32_bf16 v[184:187], v[56:59], a[48:51], v[184:187]
    v_mfma_f32_16x16x32_bf16 v[184:187], v[60:63], a[52:55], v[184:187]
    ds_read_b128 a[84:87], v23 offset:20480
    v_mfma_f32_16x16x32_bf16 v[188:191], v[56:59], a[56:59], v[188:191]
    s_waitcnt lgkmcnt(1)
    ds_read_b64_tr_b16 v[56:57], v14 offset:32768
    ds_read_b64_tr_b16 v[58:59], v14 offset:33792
    v_mfma_f32_16x16x32_bf16 v[188:191], v[60:63], a[60:63], v[188:191]
    ds_read_b64_tr_b16 v[60:61], v14 offset:40960
    ds_read_b64_tr_b16 v[62:63], v14 offset:41984
    v_mfma_f32_16x16x32_bf16 v[192:195], v[40:43], a[0:3], v[192:195]
    v_add_u32 v14, 0x10000, v14
    v_mfma_f32_16x16x32_bf16 v[192:195], v[44:47], a[4:7], v[192:195]
    v_mfma_f32_16x16x32_bf16 v[196:199], v[40:43], a[8:11], v[196:199]
    v_mfma_f32_16x16x32_bf16 v[196:199], v[44:47], a[12:15], v[196:199]
    buffer_load_dwordx4 v8, s[8:11], s62 offen offset:2048 lds
    v_mfma_f32_16x16x32_bf16 v[200:203], v[40:43], a[16:19], v[200:203]
    ds_read_b128 a[88:91], v22 offset:22528
    v_mfma_f32_16x16x32_bf16 v[200:203], v[44:47], a[20:23], v[200:203]
    v_mfma_f32_16x16x32_bf16 v[204:207], v[40:43], a[24:27], v[204:207]
    v_mfma_f32_16x16x32_bf16 v[204:207], v[44:47], a[28:31], v[204:207]
    v_mfma_f32_16x16x32_bf16 v[208:211], v[40:43], a[32:35], v[208:211]
    ds_read_b128 a[92:95], v23 offset:22528
    v_mfma_f32_16x16x32_bf16 v[208:211], v[44:47], a[36:39], v[208:211]
    v_mfma_f32_16x16x32_bf16 v[212:215], v[40:43], a[40:43], v[212:215]
    buffer_load_dwordx4 v9, s[8:11], s62 offen offset:3072 lds
    v_mfma_f32_16x16x32_bf16 v[212:215], v[44:47], a[44:47], v[212:215]
    v_mfma_f32_16x16x32_bf16 v[216:219], v[40:43], a[48:51], v[216:219]
    v_mfma_f32_16x16x32_bf16 v[216:219], v[44:47], a[52:55], v[216:219]
    v_mfma_f32_16x16x32_bf16 v[220:223], v[40:43], a[56:59], v[220:223]
    ds_read_b64_tr_b16 v[40:41], v15 offset:32768
    ds_read_b64_tr_b16 v[42:43], v15 offset:33792
    v_mfma_f32_16x16x32_bf16 v[220:223], v[44:47], a[60:63], v[220:223]
    ds_read_b64_tr_b16 v[44:45], v15 offset:40960
    ds_read_b64_tr_b16 v[46:47], v15 offset:41984
    v_mfma_f32_16x16x32_bf16 v[224:227], v[48:51], a[0:3], v[224:227]
    v_add_u32 v15, 0x10000, v15
    v_mfma_f32_16x16x32_bf16 v[224:227], v[52:55], a[4:7], v[224:227]
    s_xor_b32 s62, s62, 128
    v_mfma_f32_16x16x32_bf16 v[228:231], v[48:51], a[8:11], v[228:231]
    buffer_load_dword v106, v103, s[24:27], s77 offen
    v_mfma_f32_16x16x32_bf16 v[228:231], v[52:55], a[12:15], v[228:231]
    s_add_u32 s77, s77, 4608
    v_mfma_f32_16x16x32_bf16 v[232:235], v[48:51], a[16:19], v[232:235]
    v_mfma_f32_16x16x32_bf16 v[232:235], v[52:55], a[20:23], v[232:235]
    s_add_u32 m0, s69, 131072
    v_mfma_f32_16x16x32_bf16 v[236:239], v[48:51], a[24:27], v[236:239]
    buffer_load_dwordx4 v2, s[12:15], s60 offen nt lds
    v_mfma_f32_16x16x32_bf16 v[236:239], v[52:55], a[28:31], v[236:239]
    v_mfma_f32_16x16x32_bf16 v[240:243], v[48:51], a[32:35], v[240:243]
    v_mfma_f32_16x16x32_bf16 v[240:243], v[52:55], a[36:39], v[240:243]
    v_mfma_f32_16x16x32_bf16 v[244:247], v[48:51], a[40:43], v[244:247]
    v_mfma_f32_16x16x32_bf16 v[244:247], v[52:55], a[44:47], v[244:247]
    v_mfma_f32_16x16x32_bf16 v[248:251], v[48:51], a[48:51], v[248:251]
    v_mfma_f32_16x16x32_bf16 v[248:251], v[52:55], a[52:55], v[248:251]
    buffer_load_dwordx4 v3, s[12:15], s60 offen offset:1024 nt lds
    v_mfma_f32_16x16x32_bf16 v[252:255], v[48:51], a[56:59], v[252:255]
    ds_read_b64_tr_b16 v[48:49], v16 offset:32768
    ds_read_b64_tr_b16 v[50:51], v16 offset:33792
    v_mfma_f32_16x16x32_bf16 v[252:255], v[52:55], a[60:63], v[252:255]
    s_waitcnt lgkmcnt(2)
    ds_read_b64_tr_b16 v[52:53], v16 offset:40960
    ds_read_b64_tr_b16 v[54:55], v16 offset:41984
    v_mfma_f32_16x16x32_bf16 a[128:131], a[0:3], v[56:59], a[128:131]
    v_add_u32 v16, 0x10000, v16
    v_mfma_f32_16x16x32_bf16 a[128:131], a[4:7], v[60:63], a[128:131]
    v_mfma_f32_16x16x32_bf16 a[132:135], a[8:11], v[56:59], a[132:135]
    ds_read_b128 a[96:99], v22 offset:49152
    v_mfma_f32_16x16x32_bf16 a[132:135], a[12:15], v[60:63], a[132:135]
    v_mfma_f32_16x16x32_bf16 a[136:139], a[16:19], v[56:59], a[136:139]
    v_mfma_f32_16x16x32_bf16 a[136:139], a[20:23], v[60:63], a[136:139]
    buffer_load_dwordx4 v4, s[12:15], s60 offen offset:2048 nt lds
    v_mfma_f32_16x16x32_bf16 a[140:143], a[24:27], v[56:59], a[140:143]
    v_mfma_f32_16x16x32_bf16 a[140:143], a[28:31], v[60:63], a[140:143]
    ds_read_b128 a[100:103], v23 offset:49152
    v_mfma_f32_16x16x32_bf16 a[144:147], a[32:35], v[56:59], a[144:147]
    v_mfma_f32_16x16x32_bf16 a[144:147], a[36:39], v[60:63], a[144:147]
    v_mfma_f32_16x16x32_bf16 a[148:151], a[40:43], v[56:59], a[148:151]
    v_mfma_f32_16x16x32_bf16 a[148:151], a[44:47], v[60:63], a[148:151]
    v_mfma_f32_16x16x32_bf16 a[152:155], a[48:51], v[56:59], a[152:155]
    buffer_load_dwordx4 v5, s[12:15], s60 offen offset:3072 nt lds
    v_mfma_f32_16x16x32_bf16 a[152:155], a[52:55], v[60:63], a[152:155]
    ds_read_b128 a[104:107], v22 offset:51200
    v_mfma_f32_16x16x32_bf16 a[156:159], a[56:59], v[56:59], a[156:159]
    ds_read_b64_tr_b16 v[56:57], v17 offset:32768
    ds_read_b64_tr_b16 v[58:59], v17 offset:33792
    v_mfma_f32_16x16x32_bf16 a[156:159], a[60:63], v[60:63], a[156:159]
    ds_read_b64_tr_b16 v[60:61], v17 offset:40960
    ds_read_b64_tr_b16 v[62:63], v17 offset:41984
    v_mfma_f32_16x16x32_bf16 a[160:163], a[0:3], v[40:43], a[160:163]
    v_add_u32 v17, 0x10000, v17
    v_mfma_f32_16x16x32_bf16 a[160:163], a[4:7], v[44:47], a[160:163]
    v_mfma_f32_16x16x32_bf16 a[164:167], a[8:11], v[40:43], a[164:167]
    ds_read_b128 a[108:111], v23 offset:51200
    v_mfma_f32_16x16x32_bf16 a[164:167], a[12:15], v[44:47], a[164:167]
    s_add_u32 m0, s69, 147456
    v_mfma_f32_16x16x32_bf16 a[168:171], a[16:19], v[40:43], a[168:171]
    buffer_load_dwordx4 v6, s[8:11], s61 offen lds
    v_mfma_f32_16x16x32_bf16 a[168:171], a[20:23], v[44:47], a[168:171]
    v_mfma_f32_16x16x32_bf16 a[172:175], a[24:27], v[40:43], a[172:175]
    v_mfma_f32_16x16x32_bf16 a[172:175], a[28:31], v[44:47], a[172:175]
    v_mfma_f32_16x16x32_bf16 a[176:179], a[32:35], v[40:43], a[176:179]
    ds_read_b128 a[112:115], v22 offset:53248
    v_mfma_f32_16x16x32_bf16 a[176:179], a[36:39], v[44:47], a[176:179]
    v_mfma_f32_16x16x32_bf16 a[180:183], a[40:43], v[40:43], a[180:183]
    v_mfma_f32_16x16x32_bf16 a[180:183], a[44:47], v[44:47], a[180:183]
    buffer_load_dwordx4 v7, s[8:11], s61 offen offset:1024 lds
    v_mfma_f32_16x16x32_bf16 a[184:187], a[48:51], v[40:43], a[184:187]
    v_mfma_f32_16x16x32_bf16 a[184:187], a[52:55], v[44:47], a[184:187]
    ds_read_b128 a[116:119], v23 offset:53248
    v_mfma_f32_16x16x32_bf16 a[188:191], a[56:59], v[40:43], a[188:191]
    v_mfma_f32_16x16x32_bf16 a[188:191], a[60:63], v[44:47], a[188:191]
    s_waitcnt lgkmcnt(1)
    v_mfma_f32_16x16x32_bf16 a[192:195], a[0:3], v[48:51], a[192:195]
    v_mfma_f32_16x16x32_bf16 a[192:195], a[4:7], v[52:55], a[192:195]
    v_mfma_f32_16x16x32_bf16 a[196:199], a[8:11], v[48:51], a[196:199]
    v_mfma_f32_16x16x32_bf16 a[196:199], a[12:15], v[52:55], a[196:199]
    buffer_load_dwordx4 v8, s[8:11], s61 offen offset:2048 lds
    v_mfma_f32_16x16x32_bf16 a[200:203], a[16:19], v[48:51], a[200:203]
    ds_read_b128 a[120:123], v22 offset:55296
    v_mfma_f32_16x16x32_bf16 a[200:203], a[20:23], v[52:55], a[200:203]
    v_mfma_f32_16x16x32_bf16 a[204:207], a[24:27], v[48:51], a[204:207]
    v_mfma_f32_16x16x32_bf16 a[204:207], a[28:31], v[52:55], a[204:207]
    v_mfma_f32_16x16x32_bf16 a[208:211], a[32:35], v[48:51], a[208:211]
    ds_read_b128 a[124:127], v23 offset:55296
    v_mfma_f32_16x16x32_bf16 a[208:211], a[36:39], v[52:55], a[208:211]
    v_mfma_f32_16x16x32_bf16 a[212:215], a[40:43], v[48:51], a[212:215]
    buffer_load_dwordx4 v9, s[8:11], s61 offen offset:3072 lds
    v_mfma_f32_16x16x32_bf16 a[212:215], a[44:47], v[52:55], a[212:215]
    v_mfma_f32_16x16x32_bf16 a[216:219], a[48:51], v[48:51], a[216:219]
    v_mfma_f32_16x16x32_bf16 a[216:219], a[52:55], v[52:55], a[216:219]
    v_mfma_f32_16x16x32_bf16 a[220:223], a[56:59], v[48:51], a[220:223]
    v_mfma_f32_16x16x32_bf16 a[220:223], a[60:63], v[52:55], a[220:223]
    v_mfma_f32_16x16x32_bf16 a[224:227], a[0:3], v[56:59], a[224:227]
    v_mfma_f32_16x16x32_bf16 a[224:227], a[4:7], v[60:63], a[224:227]
    s_xor_b32 s61, s61, 384
    v_mfma_f32_16x16x32_bf16 a[228:231], a[8:11], v[56:59], a[228:231]
    v_mfma_f32_16x16x32_bf16 a[228:231], a[12:15], v[60:63], a[228:231]
    v_mfma_f32_16x16x32_bf16 a[232:235], a[16:19], v[56:59], a[232:235]
    v_mfma_f32_16x16x32_bf16 a[232:235], a[20:23], v[60:63], a[232:235]
    s_waitcnt vmcnt(9) lgkmcnt(0)
    s_barrier
    ds_read_b64_tr_b16 v[40:41], v14 offset:0
    v_mfma_f32_16x16x32_bf16 a[236:239], a[24:27], v[56:59], a[236:239]
    s_add_u32 m0, s69, 0
    ds_read_b64_tr_b16 v[42:43], v14 offset:1024
    ds_read_b64_tr_b16 v[44:45], v14 offset:8192
    v_mfma_f32_16x16x32_bf16 a[236:239], a[28:31], v[60:63], a[236:239]
    buffer_load_dwordx4 v2, s[16:19], s60 offen nt lds
    v_mfma_f32_16x16x32_bf16 a[240:243], a[32:35], v[56:59], a[240:243]
    ds_read_b64_tr_b16 v[46:47], v14 offset:9216
    v_cndmask_b32 v82, v82, v92, s[92:93]
    v_mfma_f32_16x16x32_bf16 a[240:243], a[36:39], v[60:63], a[240:243]
    v_cndmask_b32_e64 v83, v83, 0, s[92:93]
    v_xor_b32 v92, s98, v95
    v_mfma_f32_16x16x32_bf16 a[244:247], a[40:43], v[56:59], a[244:247]
    buffer_store_dwordx4 v[80:83], v92, s[28:31], s72 offen sc1
    v_mfma_f32_16x16x32_bf16 a[244:247], a[44:47], v[60:63], a[244:247]
    s_mul_i32 s72, s2, 3
    ds_read_b64_tr_b16 v[48:49], v15 offset:0
    ds_read_b64_tr_b16 v[50:51], v15 offset:1024
    v_mfma_f32_16x16x32_bf16 a[248:251], a[48:51], v[56:59], a[248:251]
    s_add_u32 s72, s72, 1
    ds_read_b64_tr_b16 v[52:53], v15 offset:8192
    ds_read_b64_tr_b16 v[54:55], v15 offset:9216
    v_mfma_f32_16x16x32_bf16 a[248:251], a[52:55], v[60:63], a[248:251]
    s_bfe_u32 s98, s72, 0x10001
    buffer_load_dwordx4 v3, s[16:19], s60 offen offset:1024 nt lds
    v_mfma_f32_16x16x32_bf16 a[252:255], a[56:59], v[56:59], a[252:255]
    s_bfe_u32 s99, s72, 0x10003
    v_cndmask_b32 v86, v86, v93, s[92:93]
    v_cndmask_b32_e64 v87, v87, 0, s[92:93]
    v_mfma_f32_16x16x32_bf16 a[252:255], a[60:63], v[60:63], a[252:255]
    s_lshl1_add_u32 s98, s99, s98
    v_cndmask_b32 v90, v90, v94, s[92:93]
    v_cndmask_b32_e64 v91, v91, 0, s[92:93]
    s_waitcnt lgkmcnt(4)
    v_mfma_f32_16x16x32_bf16 v[128:131], v[40:43], a[64:67], v[128:131]
    s_lshl_b32 s98, s98, 5
    v_xor_b32 v93, s98, v95
    ds_read_b64_tr_b16 v[56:57], v16 offset:0
    v_mfma_f32_16x16x32_bf16 v[128:131], v[44:47], a[68:71], v[128:131]
    s_lshl_b32 s72, s72, 7
    v_add_u32 v22, 0x10000, v22
    ds_read_b64_tr_b16 v[58:59], v16 offset:1024
    v_mfma_f32_16x16x32_bf16 v[132:135], v[40:43], a[72:75], v[132:135]
    ds_read_b128 a[0:3], v22 offset:16384
    ds_read_b64_tr_b16 v[60:61], v16 offset:8192
    v_mfma_f32_16x16x32_bf16 v[132:135], v[44:47], a[76:79], v[132:135]
    s_cmp_lt_u32 s2, 192
    s_cselect_b32 s72, s72, 1073741824
    ds_read_b64_tr_b16 v[62:63], v16 offset:9216
    v_mfma_f32_16x16x32_bf16 v[136:139], v[40:43], a[80:83], v[136:139]
    buffer_store_dwordx4 v[84:87], v93, s[28:31], s72 offen sc1
    v_mfma_f32_16x16x32_bf16 v[136:139], v[44:47], a[84:87], v[136:139]
    s_mul_i32 s72, s2, 3
    buffer_load_dwordx4 v4, s[16:19], s60 offen offset:2048 nt lds
    v_mfma_f32_16x16x32_bf16 v[140:143], v[40:43], a[88:91], v[140:143]
    s_add_u32 s72, s72, 2
    v_add_u32 v23, 0x10000, v23
    v_mfma_f32_16x16x32_bf16 v[140:143], v[44:47], a[92:95], v[140:143]
    s_bfe_u32 s98, s72, 0x10001
    ds_read_b128 a[4:7], v23 offset:16384
    v_mfma_f32_16x16x32_bf16 v[144:147], v[40:43], a[96:99], v[144:147]
    s_bfe_u32 s99, s72, 0x10003
    v_mfma_f32_16x16x32_bf16 v[144:147], v[44:47], a[100:103], v[144:147]
    s_lshl1_add_u32 s98, s99, s98
    v_mfma_f32_16x16x32_bf16 v[148:151], v[40:43], a[104:107], v[148:151]
    s_lshl_b32 s98, s98, 5
    v_xor_b32 v94, s98, v95
    v_mfma_f32_16x16x32_bf16 v[148:151], v[44:47], a[108:111], v[148:151]
    s_lshl_b32 s72, s72, 7
    v_mfma_f32_16x16x32_bf16 v[152:155], v[40:43], a[112:115], v[152:155]
    s_bfe_u32 s98, s5, 0x20001
    buffer_load_dwordx4 v5, s[16:19], s60 offen offset:3072 nt lds
    v_mfma_f32_16x16x32_bf16 v[152:155], v[44:47], a[116:119], v[152:155]
    s_lshl2_add_u32 s99, s100, s4
    ds_read_b128 a[8:11], v22 offset:18432
    v_mfma_f32_16x16x32_bf16 v[156:159], v[40:43], a[120:123], v[156:159]
    s_cmp_lt_u32 s2, 192
    s_cselect_b32 s72, s72, 1073741824
    ds_read_b64_tr_b16 v[40:41], v17 offset:0
    v_mfma_f32_16x16x32_bf16 v[156:159], v[44:47], a[124:127], v[156:159]
    s_lshl_b32 s99, s99, 7
    buffer_store_dwordx4 v[88:91], v94, s[28:31], s72 offen sc1
    s_waitcnt lgkmcnt(2)
    v_mfma_f32_16x16x32_bf16 v[160:163], v[48:51], a[64:67], v[160:163]
    s_mov_b32 s30, 73728
    ds_read_b64_tr_b16 v[42:43], v17 offset:1024
    ds_read_b64_tr_b16 v[44:45], v17 offset:8192
    v_mfma_f32_16x16x32_bf16 v[160:163], v[52:55], a[68:71], v[160:163]
    ds_read_b64_tr_b16 v[46:47], v17 offset:9216
    v_mfma_f32_16x16x32_bf16 v[164:167], v[48:51], a[72:75], v[164:167]
    ds_read_b128 a[12:15], v23 offset:18432
    v_mfma_f32_16x16x32_bf16 v[164:167], v[52:55], a[76:79], v[164:167]
    s_add_u32 m0, s69, 16384
    v_mfma_f32_16x16x32_bf16 v[168:171], v[48:51], a[80:83], v[168:171]
    s_xor_b32 s60, s60, 524288
    buffer_load_dwordx4 v6, s[8:11], s62 offen lds
    v_mfma_f32_16x16x32_bf16 v[168:171], v[52:55], a[84:87], v[168:171]
    s_add_u32 s28, s28, s7
    s_addc_u32 s29, s29, 0
    v_mfma_f32_16x16x32_bf16 v[172:175], v[48:51], a[88:91], v[172:175]
    s_and_b32 s7, s5, 24
    v_mfma_f32_16x16x32_bf16 v[172:175], v[52:55], a[92:95], v[172:175]
    s_add_u32 s7, s7, s6
    v_mfma_f32_16x16x32_bf16 v[176:179], v[48:51], a[96:99], v[176:179]
    s_lshl2_add_u32 s7, s7, s98
    ds_read_b128 a[16:19], v22 offset:20480
    v_mfma_f32_16x16x32_bf16 v[176:179], v[52:55], a[100:103], v[176:179]
    s_mul_i32 s98, s7, 36864
    v_add_u32 v36, s98, v36
    v_sub_u32 v39, v36, v39
    v_mfma_f32_16x16x32_bf16 v[180:183], v[48:51], a[104:107], v[180:183]
    v_lshl_add_u32 v36, s100, 6, v36
    v_mfma_f32_16x16x32_bf16 v[180:183], v[52:55], a[108:111], v[180:183]
    buffer_load_dwordx4 v7, s[8:11], s62 offen offset:1024 lds
    v_mfma_f32_16x16x32_bf16 v[184:187], v[48:51], a[112:115], v[184:187]
    v_mfma_f32_16x16x32_bf16 v[184:187], v[52:55], a[116:119], v[184:187]
    ds_read_b128 a[20:23], v23 offset:20480
    v_mfma_f32_16x16x32_bf16 v[188:191], v[48:51], a[120:123], v[188:191]
    ds_read_b64_tr_b16 v[48:49], v14 offset:32768
    ds_read_b64_tr_b16 v[50:51], v14 offset:33792
    v_mfma_f32_16x16x32_bf16 v[188:191], v[52:55], a[124:127], v[188:191]
    ds_read_b64_tr_b16 v[52:53], v14 offset:40960
    ds_read_b64_tr_b16 v[54:55], v14 offset:41984
    v_mfma_f32_16x16x32_bf16 v[192:195], v[56:59], a[64:67], v[192:195]
    v_add_u32 v14, 0x10000, v14
    v_mfma_f32_16x16x32_bf16 v[192:195], v[60:63], a[68:71], v[192:195]
    v_mfma_f32_16x16x32_bf16 v[196:199], v[56:59], a[72:75], v[196:199]
    v_mfma_f32_16x16x32_bf16 v[196:199], v[60:63], a[76:79], v[196:199]
    buffer_load_dwordx4 v8, s[8:11], s62 offen offset:2048 lds
    v_mfma_f32_16x16x32_bf16 v[200:203], v[56:59], a[80:83], v[200:203]
    ds_read_b128 a[24:27], v22 offset:22528
    v_mfma_f32_16x16x32_bf16 v[200:203], v[60:63], a[84:87], v[200:203]
    v_mfma_f32_16x16x32_bf16 v[204:207], v[56:59], a[88:91], v[204:207]
    v_mfma_f32_16x16x32_bf16 v[204:207], v[60:63], a[92:95], v[204:207]
    v_mfma_f32_16x16x32_bf16 v[208:211], v[56:59], a[96:99], v[208:211]
    ds_read_b128 a[28:31], v23 offset:22528
    v_mfma_f32_16x16x32_bf16 v[208:211], v[60:63], a[100:103], v[208:211]
    v_mfma_f32_16x16x32_bf16 v[212:215], v[56:59], a[104:107], v[212:215]
    buffer_load_dwordx4 v9, s[8:11], s62 offen offset:3072 lds
    v_mfma_f32_16x16x32_bf16 v[212:215], v[60:63], a[108:111], v[212:215]
    v_mfma_f32_16x16x32_bf16 v[216:219], v[56:59], a[112:115], v[216:219]
    v_mfma_f32_16x16x32_bf16 v[216:219], v[60:63], a[116:119], v[216:219]
    v_mfma_f32_16x16x32_bf16 v[220:223], v[56:59], a[120:123], v[220:223]
    s_waitcnt lgkmcnt(0)
    ds_read_b64_tr_b16 v[56:57], v15 offset:32768
    ds_read_b64_tr_b16 v[58:59], v15 offset:33792
    v_mfma_f32_16x16x32_bf16 v[220:223], v[60:63], a[124:127], v[220:223]
    ds_read_b64_tr_b16 v[60:61], v15 offset:40960
    ds_read_b64_tr_b16 v[62:63], v15 offset:41984
    v_mfma_f32_16x16x32_bf16 v[224:227], v[40:43], a[64:67], v[224:227]
    v_add_u32 v15, 0x10000, v15
    v_mfma_f32_16x16x32_bf16 v[224:227], v[44:47], a[68:71], v[224:227]
    s_xor_b32 s62, s62, 384
    v_mfma_f32_16x16x32_bf16 v[228:231], v[40:43], a[72:75], v[228:231]
    buffer_load_dword v107, v103, s[24:27], s77 offen
    v_mfma_f32_16x16x32_bf16 v[228:231], v[44:47], a[76:79], v[228:231]
    s_add_u32 s77, s77, 4608
    v_mfma_f32_16x16x32_bf16 v[232:235], v[40:43], a[80:83], v[232:235]
    v_mfma_f32_16x16x32_bf16 v[232:235], v[44:47], a[84:87], v[232:235]
    s_add_u32 m0, s69, 32768
    v_mfma_f32_16x16x32_bf16 v[236:239], v[40:43], a[88:91], v[236:239]
    buffer_load_dwordx4 v2, s[12:15], s60 offen nt lds
    v_mfma_f32_16x16x32_bf16 v[236:239], v[44:47], a[92:95], v[236:239]
    v_mfma_f32_16x16x32_bf16 v[240:243], v[40:43], a[96:99], v[240:243]
    v_mfma_f32_16x16x32_bf16 v[240:243], v[44:47], a[100:103], v[240:243]
    v_mfma_f32_16x16x32_bf16 v[244:247], v[40:43], a[104:107], v[244:247]
    v_mfma_f32_16x16x32_bf16 v[244:247], v[44:47], a[108:111], v[244:247]
    v_mfma_f32_16x16x32_bf16 v[248:251], v[40:43], a[112:115], v[248:251]
    v_mfma_f32_16x16x32_bf16 v[248:251], v[44:47], a[116:119], v[248:251]
    buffer_load_dwordx4 v3, s[12:15], s60 offen offset:1024 nt lds
    v_mfma_f32_16x16x32_bf16 v[252:255], v[40:43], a[120:123], v[252:255]
    ds_read_b64_tr_b16 v[40:41], v16 offset:32768
    ds_read_b64_tr_b16 v[42:43], v16 offset:33792
    v_mfma_f32_16x16x32_bf16 v[252:255], v[44:47], a[124:127], v[252:255]
    ds_read_b64_tr_b16 v[44:45], v16 offset:40960
    ds_read_b64_tr_b16 v[46:47], v16 offset:41984
    v_mfma_f32_16x16x32_bf16 a[128:131], a[64:67], v[48:51], a[128:131]
    v_add_u32 v16, 0x10000, v16
    v_mfma_f32_16x16x32_bf16 a[128:131], a[68:71], v[52:55], a[128:131]
    v_mfma_f32_16x16x32_bf16 a[132:135], a[72:75], v[48:51], a[132:135]
    ds_read_b128 a[32:35], v22 offset:49152
    v_mfma_f32_16x16x32_bf16 a[132:135], a[76:79], v[52:55], a[132:135]
    v_mfma_f32_16x16x32_bf16 a[136:139], a[80:83], v[48:51], a[136:139]
    v_mfma_f32_16x16x32_bf16 a[136:139], a[84:87], v[52:55], a[136:139]
    buffer_load_dwordx4 v4, s[12:15], s60 offen offset:2048 nt lds
    v_mfma_f32_16x16x32_bf16 a[140:143], a[88:91], v[48:51], a[140:143]
    v_mfma_f32_16x16x32_bf16 a[140:143], a[92:95], v[52:55], a[140:143]
    ds_read_b128 a[36:39], v23 offset:49152
    v_mfma_f32_16x16x32_bf16 a[144:147], a[96:99], v[48:51], a[144:147]
    v_mfma_f32_16x16x32_bf16 a[144:147], a[100:103], v[52:55], a[144:147]
    v_mfma_f32_16x16x32_bf16 a[148:151], a[104:107], v[48:51], a[148:151]
    v_mfma_f32_16x16x32_bf16 a[148:151], a[108:111], v[52:55], a[148:151]
    v_mfma_f32_16x16x32_bf16 a[152:155], a[112:115], v[48:51], a[152:155]
    buffer_load_dwordx4 v5, s[12:15], s60 offen offset:3072 nt lds
    v_mfma_f32_16x16x32_bf16 a[152:155], a[116:119], v[52:55], a[152:155]
    ds_read_b128 a[40:43], v22 offset:51200
    v_mfma_f32_16x16x32_bf16 a[156:159], a[120:123], v[48:51], a[156:159]
    ds_read_b64_tr_b16 v[48:49], v17 offset:32768
    ds_read_b64_tr_b16 v[50:51], v17 offset:33792
    v_mfma_f32_16x16x32_bf16 a[156:159], a[124:127], v[52:55], a[156:159]
    s_waitcnt lgkmcnt(3)
    ds_read_b64_tr_b16 v[52:53], v17 offset:40960
    ds_read_b64_tr_b16 v[54:55], v17 offset:41984
    v_mfma_f32_16x16x32_bf16 a[160:163], a[64:67], v[56:59], a[160:163]
    v_add_u32 v17, 0x10000, v17
    v_mfma_f32_16x16x32_bf16 a[160:163], a[68:71], v[60:63], a[160:163]
    v_mfma_f32_16x16x32_bf16 a[164:167], a[72:75], v[56:59], a[164:167]
    ds_read_b128 a[44:47], v23 offset:51200
    v_mfma_f32_16x16x32_bf16 a[164:167], a[76:79], v[60:63], a[164:167]
    s_add_u32 m0, s69, 49152
    v_mfma_f32_16x16x32_bf16 a[168:171], a[80:83], v[56:59], a[168:171]
    buffer_load_dwordx4 v6, s[8:11], s61 offen lds
    v_mfma_f32_16x16x32_bf16 a[168:171], a[84:87], v[60:63], a[168:171]
    v_mfma_f32_16x16x32_bf16 a[172:175], a[88:91], v[56:59], a[172:175]
    v_mfma_f32_16x16x32_bf16 a[172:175], a[92:95], v[60:63], a[172:175]
    v_mfma_f32_16x16x32_bf16 a[176:179], a[96:99], v[56:59], a[176:179]
    ds_read_b128 a[48:51], v22 offset:53248
    v_mfma_f32_16x16x32_bf16 a[176:179], a[100:103], v[60:63], a[176:179]
    v_mfma_f32_16x16x32_bf16 a[180:183], a[104:107], v[56:59], a[180:183]
    v_mfma_f32_16x16x32_bf16 a[180:183], a[108:111], v[60:63], a[180:183]
    buffer_load_dwordx4 v7, s[8:11], s61 offen offset:1024 lds
    v_mfma_f32_16x16x32_bf16 a[184:187], a[112:115], v[56:59], a[184:187]
    v_mfma_f32_16x16x32_bf16 a[184:187], a[116:119], v[60:63], a[184:187]
    ds_read_b128 a[52:55], v23 offset:53248
    v_mfma_f32_16x16x32_bf16 a[188:191], a[120:123], v[56:59], a[188:191]
    v_mfma_f32_16x16x32_bf16 a[188:191], a[124:127], v[60:63], a[188:191]
    v_mfma_f32_16x16x32_bf16 a[192:195], a[64:67], v[40:43], a[192:195]
    v_mfma_f32_16x16x32_bf16 a[192:195], a[68:71], v[44:47], a[192:195]
    v_mfma_f32_16x16x32_bf16 a[196:199], a[72:75], v[40:43], a[196:199]
    v_mfma_f32_16x16x32_bf16 a[196:199], a[76:79], v[44:47], a[196:199]
    buffer_load_dwordx4 v8, s[8:11], s61 offen offset:2048 lds
    v_mfma_f32_16x16x32_bf16 a[200:203], a[80:83], v[40:43], a[200:203]
    ds_read_b128 a[56:59], v22 offset:55296
    v_mfma_f32_16x16x32_bf16 a[200:203], a[84:87], v[44:47], a[200:203]
    v_mfma_f32_16x16x32_bf16 a[204:207], a[88:91], v[40:43], a[204:207]
    v_mfma_f32_16x16x32_bf16 a[204:207], a[92:95], v[44:47], a[204:207]
    v_mfma_f32_16x16x32_bf16 a[208:211], a[96:99], v[40:43], a[208:211]
    ds_read_b128 a[60:63], v23 offset:55296
    v_mfma_f32_16x16x32_bf16 a[208:211], a[100:103], v[44:47], a[208:211]
    v_mfma_f32_16x16x32_bf16 a[212:215], a[104:107], v[40:43], a[212:215]
    buffer_load_dwordx4 v9, s[8:11], s61 offen offset:3072 lds
    v_mfma_f32_16x16x32_bf16 a[212:215], a[108:111], v[44:47], a[212:215]
    v_mfma_f32_16x16x32_bf16 a[216:219], a[112:115], v[40:43], a[216:219]
    v_mfma_f32_16x16x32_bf16 a[216:219], a[116:119], v[44:47], a[216:219]
    v_mfma_f32_16x16x32_bf16 a[220:223], a[120:123], v[40:43], a[220:223]
    v_mfma_f32_16x16x32_bf16 a[220:223], a[124:127], v[44:47], a[220:223]
    s_waitcnt lgkmcnt(0)
    v_mfma_f32_16x16x32_bf16 a[224:227], a[64:67], v[48:51], a[224:227]
    v_mfma_f32_16x16x32_bf16 a[224:227], a[68:71], v[52:55], a[224:227]
    s_xor_b32 s61, s61, 128
    v_mfma_f32_16x16x32_bf16 a[228:231], a[72:75], v[48:51], a[228:231]
    v_mfma_f32_16x16x32_bf16 a[228:231], a[76:79], v[52:55], a[228:231]
    v_mfma_f32_16x16x32_bf16 a[232:235], a[80:83], v[48:51], a[232:235]
    v_mfma_f32_16x16x32_bf16 a[232:235], a[84:87], v[52:55], a[232:235]
    s_waitcnt vmcnt(9) lgkmcnt(0)
    s_barrier
    ds_read_b64_tr_b16 v[56:57], v14 offset:0
    v_mfma_f32_16x16x32_bf16 a[236:239], a[88:91], v[48:51], a[236:239]
    s_add_u32 m0, s69, 65536
    ds_read_b64_tr_b16 v[58:59], v14 offset:1024
    ds_read_b64_tr_b16 v[60:61], v14 offset:8192
    v_mfma_f32_16x16x32_bf16 a[236:239], a[92:95], v[52:55], a[236:239]
    buffer_load_dwordx4 v2, s[16:19], s60 offen nt lds
    v_mfma_f32_16x16x32_bf16 a[240:243], a[96:99], v[48:51], a[240:243]
    ds_read_b64_tr_b16 v[62:63], v14 offset:9216
    ds_read_b64_tr_b16 v[40:41], v15 offset:0
    v_mfma_f32_16x16x32_bf16 a[240:243], a[100:103], v[52:55], a[240:243]
    buffer_atomic_add v31, v30, s[44:47], s95 offen sc1
    v_mfma_f32_16x16x32_bf16 a[244:247], a[104:107], v[48:51], a[244:247]
    ds_read_b64_tr_b16 v[42:43], v15 offset:1024
    ds_read_b64_tr_b16 v[44:45], v15 offset:8192
    v_mfma_f32_16x16x32_bf16 a[244:247], a[108:111], v[52:55], a[244:247]
    ds_read_b64_tr_b16 v[46:47], v15 offset:9216
    v_add_u32 v14, 0xfffe0000, v14
    v_mfma_f32_16x16x32_bf16 a[248:251], a[112:115], v[48:51], a[248:251]
    v_add_u32 v15, 0xfffe0000, v15
    v_mfma_f32_16x16x32_bf16 a[248:251], a[116:119], v[52:55], a[248:251]
    buffer_load_dwordx4 v3, s[16:19], s60 offen offset:1024 nt lds
    v_mfma_f32_16x16x32_bf16 a[252:255], a[120:123], v[48:51], a[252:255]
    ds_read_b64_tr_b16 v[48:49], v16 offset:0
    ds_read_b64_tr_b16 v[50:51], v16 offset:1024
    v_mfma_f32_16x16x32_bf16 a[252:255], a[124:127], v[52:55], a[252:255]
    s_waitcnt lgkmcnt(3)
    ds_read_b64_tr_b16 v[52:53], v16 offset:8192
    ds_read_b64_tr_b16 v[54:55], v16 offset:9216
    v_mfma_f32_16x16x32_bf16 v[128:131], v[56:59], a[0:3], v[128:131]
    v_add_u32 v16, 0xfffe0000, v16
    v_mfma_f32_16x16x32_bf16 v[128:131], v[60:63], a[4:7], v[128:131]
    v_add_u32 v22, 0x10000, v22
    v_mfma_f32_16x16x32_bf16 v[132:135], v[56:59], a[8:11], v[132:135]
    ds_read_b128 a[64:67], v22 offset:16384
    v_mfma_f32_16x16x32_bf16 v[132:135], v[60:63], a[12:15], v[132:135]
    v_mfma_f32_16x16x32_bf16 v[136:139], v[56:59], a[16:19], v[136:139]
    v_mfma_f32_16x16x32_bf16 v[136:139], v[60:63], a[20:23], v[136:139]
    buffer_load_dwordx4 v4, s[16:19], s60 offen offset:2048 nt lds
    v_mfma_f32_16x16x32_bf16 v[140:143], v[56:59], a[24:27], v[140:143]
    v_add_u32 v23, 0x10000, v23
    v_mfma_f32_16x16x32_bf16 v[140:143], v[60:63], a[28:31], v[140:143]
    ds_read_b128 a[68:71], v23 offset:16384
    v_mfma_f32_16x16x32_bf16 v[144:147], v[56:59], a[32:35], v[144:147]
    v_mfma_f32_16x16x32_bf16 v[144:147], v[60:63], a[36:39], v[144:147]
    v_mfma_f32_16x16x32_bf16 v[148:151], v[56:59], a[40:43], v[148:151]
    v_mfma_f32_16x16x32_bf16 v[148:151], v[60:63], a[44:47], v[148:151]
    v_mfma_f32_16x16x32_bf16 v[152:155], v[56:59], a[48:51], v[152:155]
    buffer_load_dwordx4 v5, s[16:19], s60 offen offset:3072 nt lds
    v_mfma_f32_16x16x32_bf16 v[152:155], v[60:63], a[52:55], v[152:155]
    ds_read_b128 a[72:75], v22 offset:18432
    v_mfma_f32_16x16x32_bf16 v[156:159], v[56:59], a[56:59], v[156:159]
    ds_read_b64_tr_b16 v[56:57], v17 offset:0
    ds_read_b64_tr_b16 v[58:59], v17 offset:1024
    v_mfma_f32_16x16x32_bf16 v[156:159], v[60:63], a[60:63], v[156:159]
    ds_read_b64_tr_b16 v[60:61], v17 offset:8192
    ds_read_b64_tr_b16 v[62:63], v17 offset:9216
    v_mfma_f32_16x16x32_bf16 v[160:163], v[40:43], a[0:3], v[160:163]
    s_waitcnt lgkmcnt(5)
    v_add_u32 v17, 0xfffe0000, v17
    v_mfma_f32_16x16x32_bf16 v[160:163], v[44:47], a[4:7], v[160:163]
    v_mfma_f32_16x16x32_bf16 v[164:167], v[40:43], a[8:11], v[164:167]
    ds_read_b128 a[76:79], v23 offset:18432
    v_mfma_f32_16x16x32_bf16 v[164:167], v[44:47], a[12:15], v[164:167]
    s_add_u32 m0, s69, 81920
    v_mfma_f32_16x16x32_bf16 v[168:171], v[40:43], a[16:19], v[168:171]
    s_xor_b32 s60, s60, 1572864
    buffer_load_dwordx4 v6, s[8:11], s62 offen lds
    v_mfma_f32_16x16x32_bf16 v[168:171], v[44:47], a[20:23], v[168:171]
    v_mfma_f32_16x16x32_bf16 v[172:175], v[40:43], a[24:27], v[172:175]
    v_mfma_f32_16x16x32_bf16 v[172:175], v[44:47], a[28:31], v[172:175]
    v_mfma_f32_16x16x32_bf16 v[176:179], v[40:43], a[32:35], v[176:179]
    ds_read_b128 a[80:83], v22 offset:20480
    v_mfma_f32_16x16x32_bf16 v[176:179], v[44:47], a[36:39], v[176:179]
    v_mfma_f32_16x16x32_bf16 v[180:183], v[40:43], a[40:43], v[180:183]
    v_mfma_f32_16x16x32_bf16 v[180:183], v[44:47], a[44:47], v[180:183]
    buffer_load_dwordx4 v7, s[8:11], s62 offen offset:1024 lds
    v_mfma_f32_16x16x32_bf16 v[184:187], v[40:43], a[48:51], v[184:187]
    v_mfma_f32_16x16x32_bf16 v[184:187], v[44:47], a[52:55], v[184:187]
    ds_read_b128 a[84:87], v23 offset:20480
    v_mfma_f32_16x16x32_bf16 v[188:191], v[40:43], a[56:59], v[188:191]
    ds_read_b64_tr_b16 v[40:41], v14 offset:0
    ds_read_b64_tr_b16 v[42:43], v14 offset:1024
    v_mfma_f32_16x16x32_bf16 v[188:191], v[44:47], a[60:63], v[188:191]
    ds_read_b64_tr_b16 v[44:45], v14 offset:8192
    ds_read_b64_tr_b16 v[46:47], v14 offset:9216
    v_mfma_f32_16x16x32_bf16 v[192:195], v[48:51], a[0:3], v[192:195]
    v_mfma_f32_16x16x32_bf16 v[192:195], v[52:55], a[4:7], v[192:195]
    v_mfma_f32_16x16x32_bf16 v[196:199], v[48:51], a[8:11], v[196:199]
    v_mfma_f32_16x16x32_bf16 v[196:199], v[52:55], a[12:15], v[196:199]
    buffer_load_dwordx4 v8, s[8:11], s62 offen offset:2048 lds
    v_mfma_f32_16x16x32_bf16 v[200:203], v[48:51], a[16:19], v[200:203]
    ds_read_b128 a[88:91], v22 offset:22528
    v_mfma_f32_16x16x32_bf16 v[200:203], v[52:55], a[20:23], v[200:203]
    v_mfma_f32_16x16x32_bf16 v[204:207], v[48:51], a[24:27], v[204:207]
    v_mfma_f32_16x16x32_bf16 v[204:207], v[52:55], a[28:31], v[204:207]
    v_mfma_f32_16x16x32_bf16 v[208:211], v[48:51], a[32:35], v[208:211]
    ds_read_b128 a[92:95], v23 offset:22528
    v_mfma_f32_16x16x32_bf16 v[208:211], v[52:55], a[36:39], v[208:211]
    v_mfma_f32_16x16x32_bf16 v[212:215], v[48:51], a[40:43], v[212:215]
    buffer_load_dwordx4 v9, s[8:11], s62 offen offset:3072 lds
    v_mfma_f32_16x16x32_bf16 v[212:215], v[52:55], a[44:47], v[212:215]
    v_mfma_f32_16x16x32_bf16 v[216:219], v[48:51], a[48:51], v[216:219]
    v_mfma_f32_16x16x32_bf16 v[216:219], v[52:55], a[52:55], v[216:219]
    v_mfma_f32_16x16x32_bf16 v[220:223], v[48:51], a[56:59], v[220:223]
    s_waitcnt lgkmcnt(0)
    ds_read_b64_tr_b16 v[48:49], v15 offset:0
    ds_read_b64_tr_b16 v[50:51], v15 offset:1024
    v_mfma_f32_16x16x32_bf16 v[220:223], v[52:55], a[60:63], v[220:223]
    ds_read_b64_tr_b16 v[52:53], v15 offset:8192
    ds_read_b64_tr_b16 v[54:55], v15 offset:9216
    v_mfma_f32_16x16x32_bf16 v[224:227], v[56:59], a[0:3], v[224:227]
    v_mfma_f32_16x16x32_bf16 v[224:227], v[60:63], a[4:7], v[224:227]
    s_xor_b32 s62, s62, 128
    v_mfma_f32_16x16x32_bf16 v[228:231], v[56:59], a[8:11], v[228:231]
    buffer_load_dword v108, v103, s[24:27], s77 offen
    v_mfma_f32_16x16x32_bf16 v[228:231], v[60:63], a[12:15], v[228:231]
    s_add_u32 s77, s77, 4608
    v_mfma_f32_16x16x32_bf16 v[232:235], v[56:59], a[16:19], v[232:235]
    v_mfma_f32_16x16x32_bf16 v[232:235], v[60:63], a[20:23], v[232:235]
    s_add_u32 m0, s69, 98304
    v_mfma_f32_16x16x32_bf16 v[236:239], v[56:59], a[24:27], v[236:239]
    buffer_load_dwordx4 v2, s[12:15], s60 offen nt lds
    v_mfma_f32_16x16x32_bf16 v[236:239], v[60:63], a[28:31], v[236:239]
    v_mfma_f32_16x16x32_bf16 v[240:243], v[56:59], a[32:35], v[240:243]
    v_mfma_f32_16x16x32_bf16 v[240:243], v[60:63], a[36:39], v[240:243]
    v_mfma_f32_16x16x32_bf16 v[244:247], v[56:59], a[40:43], v[244:247]
    v_mfma_f32_16x16x32_bf16 v[244:247], v[60:63], a[44:47], v[244:247]
    v_mfma_f32_16x16x32_bf16 v[248:251], v[56:59], a[48:51], v[248:251]
    v_mfma_f32_16x16x32_bf16 v[248:251], v[60:63], a[52:55], v[248:251]
    buffer_load_dwordx4 v3, s[12:15], s60 offen offset:1024 nt lds
    v_mfma_f32_16x16x32_bf16 v[252:255], v[56:59], a[56:59], v[252:255]
    ds_read_b64_tr_b16 v[56:57], v16 offset:0
    ds_read_b64_tr_b16 v[58:59], v16 offset:1024
    v_mfma_f32_16x16x32_bf16 v[252:255], v[60:63], a[60:63], v[252:255]
    ds_read_b64_tr_b16 v[60:61], v16 offset:8192
    ds_read_b64_tr_b16 v[62:63], v16 offset:9216
    v_mfma_f32_16x16x32_bf16 a[128:131], a[0:3], v[40:43], a[128:131]
    v_mfma_f32_16x16x32_bf16 a[128:131], a[4:7], v[44:47], a[128:131]
    v_add_u32 v22, 0xfffe0000, v22
    v_mfma_f32_16x16x32_bf16 a[132:135], a[8:11], v[40:43], a[132:135]
    ds_read_b128 a[96:99], v22 offset:16384
    v_mfma_f32_16x16x32_bf16 a[132:135], a[12:15], v[44:47], a[132:135]
    v_mfma_f32_16x16x32_bf16 a[136:139], a[16:19], v[40:43], a[136:139]
    v_mfma_f32_16x16x32_bf16 a[136:139], a[20:23], v[44:47], a[136:139]
    buffer_load_dwordx4 v4, s[12:15], s60 offen offset:2048 nt lds
    v_mfma_f32_16x16x32_bf16 a[140:143], a[24:27], v[40:43], a[140:143]
    v_add_u32 v23, 0xfffe0000, v23
    v_mfma_f32_16x16x32_bf16 a[140:143], a[28:31], v[44:47], a[140:143]
    ds_read_b128 a[100:103], v23 offset:16384
    v_mfma_f32_16x16x32_bf16 a[144:147], a[32:35], v[40:43], a[144:147]
    v_mfma_f32_16x16x32_bf16 a[144:147], a[36:39], v[44:47], a[144:147]
    v_mfma_f32_16x16x32_bf16 a[148:151], a[40:43], v[40:43], a[148:151]
    v_mfma_f32_16x16x32_bf16 a[148:151], a[44:47], v[44:47], a[148:151]
    v_mfma_f32_16x16x32_bf16 a[152:155], a[48:51], v[40:43], a[152:155]
    buffer_load_dwordx4 v5, s[12:15], s60 offen offset:3072 nt lds
    v_mfma_f32_16x16x32_bf16 a[152:155], a[52:55], v[44:47], a[152:155]
    ds_read_b128 a[104:107], v22 offset:18432
    v_mfma_f32_16x16x32_bf16 a[156:159], a[56:59], v[40:43], a[156:159]
    ds_read_b64_tr_b16 v[40:41], v17 offset:0
    ds_read_b64_tr_b16 v[42:43], v17 offset:1024
    v_mfma_f32_16x16x32_bf16 a[156:159], a[60:63], v[44:47], a[156:159]
    s_waitcnt lgkmcnt(3)
    ds_read_b64_tr_b16 v[44:45], v17 offset:8192
    ds_read_b64_tr_b16 v[46:47], v17 offset:9216
    v_mfma_f32_16x16x32_bf16 a[160:163], a[0:3], v[48:51], a[160:163]
    v_mfma_f32_16x16x32_bf16 a[160:163], a[4:7], v[52:55], a[160:163]
    v_mfma_f32_16x16x32_bf16 a[164:167], a[8:11], v[48:51], a[164:167]
    ds_read_b128 a[108:111], v23 offset:18432
    v_mfma_f32_16x16x32_bf16 a[164:167], a[12:15], v[52:55], a[164:167]
    s_add_u32 m0, s69, 114688
    v_mfma_f32_16x16x32_bf16 a[168:171], a[16:19], v[48:51], a[168:171]
    s_xor_b32 s60, s60, 524288
    buffer_load_dwordx4 v6, s[8:11], s61 offen lds
    v_mfma_f32_16x16x32_bf16 a[168:171], a[20:23], v[52:55], a[168:171]
    v_mfma_f32_16x16x32_bf16 a[172:175], a[24:27], v[48:51], a[172:175]
    v_mfma_f32_16x16x32_bf16 a[172:175], a[28:31], v[52:55], a[172:175]
    v_mfma_f32_16x16x32_bf16 a[176:179], a[32:35], v[48:51], a[176:179]
    ds_read_b128 a[112:115], v22 offset:20480
    v_mfma_f32_16x16x32_bf16 a[176:179], a[36:39], v[52:55], a[176:179]
    v_mfma_f32_16x16x32_bf16 a[180:183], a[40:43], v[48:51], a[180:183]
    v_mfma_f32_16x16x32_bf16 a[180:183], a[44:47], v[52:55], a[180:183]
    buffer_load_dwordx4 v7, s[8:11], s61 offen offset:1024 lds
    v_mfma_f32_16x16x32_bf16 a[184:187], a[48:51], v[48:51], a[184:187]
    v_mfma_f32_16x16x32_bf16 a[184:187], a[52:55], v[52:55], a[184:187]
    ds_read_b128 a[116:119], v23 offset:20480
    v_mfma_f32_16x16x32_bf16 a[188:191], a[56:59], v[48:51], a[188:191]
    v_mfma_f32_16x16x32_bf16 a[188:191], a[60:63], v[52:55], a[188:191]
    v_mfma_f32_16x16x32_bf16 a[192:195], a[0:3], v[56:59], a[192:195]
    v_mfma_f32_16x16x32_bf16 a[192:195], a[4:7], v[60:63], a[192:195]
    v_mfma_f32_16x16x32_bf16 a[196:199], a[8:11], v[56:59], a[196:199]
    v_mfma_f32_16x16x32_bf16 a[196:199], a[12:15], v[60:63], a[196:199]
    buffer_load_dwordx4 v8, s[8:11], s61 offen offset:2048 lds
    v_mfma_f32_16x16x32_bf16 a[200:203], a[16:19], v[56:59], a[200:203]
    ds_read_b128 a[120:123], v22 offset:22528
    v_mfma_f32_16x16x32_bf16 a[200:203], a[20:23], v[60:63], a[200:203]
    v_mfma_f32_16x16x32_bf16 a[204:207], a[24:27], v[56:59], a[204:207]
    v_mfma_f32_16x16x32_bf16 a[204:207], a[28:31], v[60:63], a[204:207]
    v_mfma_f32_16x16x32_bf16 a[208:211], a[32:35], v[56:59], a[208:211]
    ds_read_b128 a[124:127], v23 offset:22528
    v_mfma_f32_16x16x32_bf16 a[208:211], a[36:39], v[60:63], a[208:211]
    v_mfma_f32_16x16x32_bf16 a[212:215], a[40:43], v[56:59], a[212:215]
    buffer_load_dwordx4 v9, s[8:11], s61 offen offset:3072 lds
    v_mfma_f32_16x16x32_bf16 a[212:215], a[44:47], v[60:63], a[212:215]
    v_mfma_f32_16x16x32_bf16 a[216:219], a[48:51], v[56:59], a[216:219]
    v_mfma_f32_16x16x32_bf16 a[216:219], a[52:55], v[60:63], a[216:219]
    v_mfma_f32_16x16x32_bf16 a[220:223], a[56:59], v[56:59], a[220:223]
    v_mfma_f32_16x16x32_bf16 a[220:223], a[60:63], v[60:63], a[220:223]
    s_waitcnt lgkmcnt(0)
    v_mfma_f32_16x16x32_bf16 a[224:227], a[0:3], v[40:43], a[224:227]
    v_mfma_f32_16x16x32_bf16 a[224:227], a[4:7], v[44:47], a[224:227]
    s_xor_b32 s61, s61, 1920
    v_mfma_f32_16x16x32_bf16 a[228:231], a[8:11], v[40:43], a[228:231]
    s_andn2_b32 s61, s61, 896
    v_mfma_f32_16x16x32_bf16 a[228:231], a[12:15], v[44:47], a[228:231]
    s_lshl_b32 s61, s5, 7
    v_mfma_f32_16x16x32_bf16 a[232:235], a[16:19], v[40:43], a[232:235]
    v_mfma_f32_16x16x32_bf16 a[232:235], a[20:23], v[44:47], a[232:235]
    s_waitcnt vmcnt(9) lgkmcnt(0)
    s_barrier
    ds_read_b64_tr_b16 v[48:49], v14 offset:32768
    v_mfma_f32_16x16x32_bf16 a[236:239], a[24:27], v[40:43], a[236:239]
    s_add_u32 m0, s69, 131072
    ds_read_b64_tr_b16 v[50:51], v14 offset:33792
    ds_read_b64_tr_b16 v[52:53], v14 offset:40960
    v_mfma_f32_16x16x32_bf16 a[236:239], a[28:31], v[44:47], a[236:239]
    buffer_load_dwordx4 v2, s[12:15], s60 offen nt lds
    v_mfma_f32_16x16x32_bf16 a[240:243], a[32:35], v[40:43], a[240:243]
    ds_read_b64_tr_b16 v[54:55], v14 offset:41984
    ds_read_b64_tr_b16 v[56:57], v15 offset:32768
    v_mfma_f32_16x16x32_bf16 a[240:243], a[36:39], v[44:47], a[240:243]
    ds_read_b64_tr_b16 v[58:59], v15 offset:33792
    ds_read_b64_tr_b16 v[60:61], v15 offset:40960
    v_mfma_f32_16x16x32_bf16 a[244:247], a[40:43], v[40:43], a[244:247]
    ds_read_b64_tr_b16 v[62:63], v15 offset:41984
    v_add_u32 v14, 0x10000, v14
    v_mfma_f32_16x16x32_bf16 a[244:247], a[44:47], v[44:47], a[244:247]
    v_add_u32 v15, 0x10000, v15
    v_mfma_f32_16x16x32_bf16 a[248:251], a[48:51], v[40:43], a[248:251]
    v_mfma_f32_16x16x32_bf16 a[248:251], a[52:55], v[44:47], a[248:251]
    buffer_load_dwordx4 v3, s[12:15], s60 offen offset:1024 nt lds
    v_mfma_f32_16x16x32_bf16 a[252:255], a[56:59], v[40:43], a[252:255]
    ds_read_b64_tr_b16 v[40:41], v16 offset:32768
    ds_read_b64_tr_b16 v[42:43], v16 offset:33792
    v_mfma_f32_16x16x32_bf16 a[252:255], a[60:63], v[44:47], a[252:255]
    s_waitcnt lgkmcnt(2)
    ds_read_b64_tr_b16 v[44:45], v16 offset:40960
    ds_read_b64_tr_b16 v[46:47], v16 offset:41984
    v_mfma_f32_16x16x32_bf16 v[128:131], v[48:51], a[64:67], v[128:131]
    v_add_u32 v16, 0x10000, v16
    v_mfma_f32_16x16x32_bf16 v[128:131], v[52:55], a[68:71], v[128:131]
    v_mfma_f32_16x16x32_bf16 v[132:135], v[48:51], a[72:75], v[132:135]
    ds_read_b128 a[0:3], v22 offset:49152
    v_mfma_f32_16x16x32_bf16 v[132:135], v[52:55], a[76:79], v[132:135]
    v_mfma_f32_16x16x32_bf16 v[136:139], v[48:51], a[80:83], v[136:139]
    v_mfma_f32_16x16x32_bf16 v[136:139], v[52:55], a[84:87], v[136:139]
    buffer_load_dwordx4 v4, s[12:15], s60 offen offset:2048 nt lds
    v_mfma_f32_16x16x32_bf16 v[140:143], v[48:51], a[88:91], v[140:143]
    v_mfma_f32_16x16x32_bf16 v[140:143], v[52:55], a[92:95], v[140:143]
    ds_read_b128 a[4:7], v23 offset:49152
    v_mfma_f32_16x16x32_bf16 v[144:147], v[48:51], a[96:99], v[144:147]
    v_mfma_f32_16x16x32_bf16 v[144:147], v[52:55], a[100:103], v[144:147]
    v_mfma_f32_16x16x32_bf16 v[148:151], v[48:51], a[104:107], v[148:151]
    v_mfma_f32_16x16x32_bf16 v[148:151], v[52:55], a[108:111], v[148:151]
    v_mfma_f32_16x16x32_bf16 v[152:155], v[48:51], a[112:115], v[152:155]
    buffer_load_dwordx4 v5, s[12:15], s60 offen offset:3072 nt lds
    v_mfma_f32_16x16x32_bf16 v[152:155], v[52:55], a[116:119], v[152:155]
    ds_read_b128 a[8:11], v22 offset:51200
    v_mfma_f32_16x16x32_bf16 v[156:159], v[48:51], a[120:123], v[156:159]
    ds_read_b64_tr_b16 v[48:49], v17 offset:32768
    ds_read_b64_tr_b16 v[50:51], v17 offset:33792
    v_mfma_f32_16x16x32_bf16 v[156:159], v[52:55], a[124:127], v[156:159]
    ds_read_b64_tr_b16 v[52:53], v17 offset:40960
    ds_read_b64_tr_b16 v[54:55], v17 offset:41984
    v_mfma_f32_16x16x32_bf16 v[160:163], v[56:59], a[64:67], v[160:163]
    v_add_u32 v17, 0x10000, v17
    v_mfma_f32_16x16x32_bf16 v[160:163], v[60:63], a[68:71], v[160:163]
    s_cmp_lt_u32 s4, 0
    s_cselect_b32 s12, 0xf149f2ca, 0
    v_mfma_f32_16x16x32_bf16 v[164:167], v[56:59], a[72:75], v[164:167]
    ds_read_b128 a[12:15], v23 offset:51200
    v_mfma_f32_16x16x32_bf16 v[164:167], v[60:63], a[76:79], v[164:167]
    s_add_u32 m0, s69, 147456
    v_mfma_f32_16x16x32_bf16 v[168:171], v[56:59], a[80:83], v[168:171]
    s_xor_b32 s60, s60, 524288
    buffer_load_dwordx4 v6, s[8:11], s62 offen lds
    v_mfma_f32_16x16x32_bf16 v[168:171], v[60:63], a[84:87], v[168:171]
    v_mov_b32 v6, v96
    v_mfma_f32_16x16x32_bf16 v[172:175], v[56:59], a[88:91], v[172:175]
    s_cmp_lt_u32 s4, 1
    s_cselect_b32 s13, 0xf149f2ca, 0
    v_mfma_f32_16x16x32_bf16 v[172:175], v[60:63], a[92:95], v[172:175]
    s_cmp_lt_u32 s4, 2
    s_cselect_b32 s14, 0xf149f2ca, 0
    v_mfma_f32_16x16x32_bf16 v[176:179], v[56:59], a[96:99], v[176:179]
    ds_read_b128 a[16:19], v22 offset:53248
    v_mfma_f32_16x16x32_bf16 v[176:179], v[60:63], a[100:103], v[176:179]
    s_cmp_lt_u32 s4, 3
    s_cselect_b32 s15, 0xf149f2ca, 0
    v_mfma_f32_16x16x32_bf16 v[180:183], v[56:59], a[104:107], v[180:183]
    v_mfma_f32_16x16x32_bf16 v[180:183], v[60:63], a[108:111], v[180:183]
    buffer_load_dwordx4 v7, s[8:11], s62 offen offset:1024 lds
    v_mfma_f32_16x16x32_bf16 v[184:187], v[56:59], a[112:115], v[184:187]
    v_mfma_f32_16x16x32_bf16 v[184:187], v[60:63], a[116:119], v[184:187]
    ds_read_b128 a[20:23], v23 offset:53248
    v_mfma_f32_16x16x32_bf16 v[188:191], v[56:59], a[120:123], v[188:191]
    s_waitcnt lgkmcnt(1)
    ds_read_b64_tr_b16 v[56:57], v14 offset:0
    ds_read_b64_tr_b16 v[58:59], v14 offset:1024
    v_mfma_f32_16x16x32_bf16 v[188:191], v[60:63], a[124:127], v[188:191]
    ds_read_b64_tr_b16 v[60:61], v14 offset:8192
    ds_read_b64_tr_b16 v[62:63], v14 offset:9216
    v_mfma_f32_16x16x32_bf16 v[192:195], v[40:43], a[64:67], v[192:195]
    v_mfma_f32_16x16x32_bf16 v[192:195], v[44:47], a[68:71], v[192:195]
    v_mfma_f32_16x16x32_bf16 v[196:199], v[40:43], a[72:75], v[196:199]
    v_mfma_f32_16x16x32_bf16 v[196:199], v[44:47], a[76:79], v[196:199]
    buffer_load_dwordx4 v8, s[8:11], s62 offen offset:2048 lds
    v_mfma_f32_16x16x32_bf16 v[200:203], v[40:43], a[80:83], v[200:203]
    ds_read_b128 a[24:27], v22 offset:55296
    v_bfe_u32 v8, v1, 4, 3
    v_mfma_f32_16x16x32_bf16 v[200:203], v[44:47], a[84:87], v[200:203]
    v_lshlrev_b32 v8, 12, v8
    v_mfma_f32_16x16x32_bf16 v[204:207], v[40:43], a[88:91], v[204:207]
    v_mfma_f32_16x16x32_bf16 v[204:207], v[44:47], a[92:95], v[204:207]
    v_mfma_f32_16x16x32_bf16 v[208:211], v[40:43], a[96:99], v[208:211]
    ds_read_b128 a[28:31], v23 offset:55296
    v_mfma_f32_16x16x32_bf16 v[208:211], v[44:47], a[100:103], v[208:211]
    v_mfma_f32_16x16x32_bf16 v[212:215], v[40:43], a[104:107], v[212:215]
    buffer_load_dwordx4 v9, s[8:11], s62 offen offset:3072 lds
    v_mfma_f32_16x16x32_bf16 v[212:215], v[44:47], a[108:111], v[212:215]
    s_and_b32 s8, s5, 7
    v_lshrrev_b32 v9, 2, v1
    v_mfma_f32_16x16x32_bf16 v[216:219], v[40:43], a[112:115], v[216:219]
    s_lshl3_add_u32 s8, s6, s8
    v_mfma_f32_16x16x32_bf16 v[216:219], v[44:47], a[116:119], v[216:219]
    s_mul_hi_u32 s98, s8, 715827883
    v_mfma_f32_16x16x32_bf16 v[220:223], v[40:43], a[120:123], v[220:223]
    s_lshr_b32 s10, s5, 3
    ds_read_b64_tr_b16 v[40:41], v15 offset:0
    ds_read_b64_tr_b16 v[42:43], v15 offset:1024
    v_mfma_f32_16x16x32_bf16 v[220:223], v[44:47], a[124:127], v[220:223]
    ds_read_b64_tr_b16 v[44:45], v15 offset:8192
    ds_read_b64_tr_b16 v[46:47], v15 offset:9216
    v_mfma_f32_16x16x32_bf16 v[224:227], v[48:51], a[64:67], v[224:227]
    s_cmp_eq_u32 s4, 3
    s_cselect_b32 s11, 1.0, 0
    v_mfma_f32_16x16x32_bf16 v[224:227], v[52:55], a[68:71], v[224:227]
    s_xor_b32 s62, s62, 1920
    v_mfma_f32_16x16x32_bf16 v[228:231], v[48:51], a[72:75], v[228:231]
    s_andn2_b32 s62, s62, 896
    buffer_load_dword v109, v103, s[24:27], s77 offen
    v_mfma_f32_16x16x32_bf16 v[228:231], v[52:55], a[76:79], v[228:231]
    v_mfma_f32_16x16x32_bf16 v[232:235], v[48:51], a[80:83], v[232:235]
    v_mfma_f32_16x16x32_bf16 v[232:235], v[52:55], a[84:87], v[232:235]
    s_add_u32 m0, s69, 0
    v_mfma_f32_16x16x32_bf16 v[236:239], v[48:51], a[88:91], v[236:239]
    buffer_load_dwordx4 v2, s[16:19], s60 offen nt lds
    v_mfma_f32_16x16x32_bf16 v[236:239], v[52:55], a[92:95], v[236:239]
    v_mfma_f32_16x16x32_bf16 v[240:243], v[48:51], a[96:99], v[240:243]
    v_mfma_f32_16x16x32_bf16 v[240:243], v[52:55], a[100:103], v[240:243]
    v_mfma_f32_16x16x32_bf16 v[244:247], v[48:51], a[104:107], v[244:247]
    v_mfma_f32_16x16x32_bf16 v[244:247], v[52:55], a[108:111], v[244:247]
    v_mfma_f32_16x16x32_bf16 v[248:251], v[48:51], a[112:115], v[248:251]
    v_mfma_f32_16x16x32_bf16 v[248:251], v[52:55], a[116:119], v[248:251]
    buffer_load_dwordx4 v3, s[16:19], s60 offen offset:1024 nt lds
    v_mfma_f32_16x16x32_bf16 v[252:255], v[48:51], a[120:123], v[252:255]
    ds_read_b64_tr_b16 v[48:49], v16 offset:0
    ds_read_b64_tr_b16 v[50:51], v16 offset:1024
    v_mfma_f32_16x16x32_bf16 v[252:255], v[52:55], a[124:127], v[252:255]
    s_waitcnt lgkmcnt(2)
    ds_read_b64_tr_b16 v[52:53], v16 offset:8192
    ds_read_b64_tr_b16 v[54:55], v16 offset:9216
    v_mfma_f32_16x16x32_bf16 a[128:131], a[64:67], v[56:59], a[128:131]
    v_mfma_f32_16x16x32_bf16 a[128:131], a[68:71], v[60:63], a[128:131]
    v_add_u32 v22, 0x10000, v22
    v_mfma_f32_16x16x32_bf16 a[132:135], a[72:75], v[56:59], a[132:135]
    ds_read_b128 a[32:35], v22 offset:16384
    v_mfma_f32_16x16x32_bf16 a[132:135], a[76:79], v[60:63], a[132:135]
    v_mfma_f32_16x16x32_bf16 a[136:139], a[80:83], v[56:59], a[136:139]
    v_mfma_f32_16x16x32_bf16 a[136:139], a[84:87], v[60:63], a[136:139]
    buffer_load_dwordx4 v4, s[16:19], s60 offen offset:2048 nt lds
    v_mfma_f32_16x16x32_bf16 a[140:143], a[88:91], v[56:59], a[140:143]
    v_add_u32 v23, 0x10000, v23
    v_mfma_f32_16x16x32_bf16 a[140:143], a[92:95], v[60:63], a[140:143]
    ds_read_b128 a[36:39], v23 offset:16384
    v_mfma_f32_16x16x32_bf16 a[144:147], a[96:99], v[56:59], a[144:147]
    v_mfma_f32_16x16x32_bf16 a[144:147], a[100:103], v[60:63], a[144:147]
    v_mfma_f32_16x16x32_bf16 a[148:151], a[104:107], v[56:59], a[148:151]
    v_mfma_f32_16x16x32_bf16 a[148:151], a[108:111], v[60:63], a[148:151]
    v_mfma_f32_16x16x32_bf16 a[152:155], a[112:115], v[56:59], a[152:155]
    buffer_load_dwordx4 v5, s[16:19], s60 offen offset:3072 nt lds
    v_mfma_f32_16x16x32_bf16 a[152:155], a[116:119], v[60:63], a[152:155]
    ds_read_b128 a[40:43], v22 offset:18432
    v_mfma_f32_16x16x32_bf16 a[156:159], a[120:123], v[56:59], a[156:159]
    ds_read_b64_tr_b16 v[56:57], v17 offset:0
    ds_read_b64_tr_b16 v[58:59], v17 offset:1024
    v_mfma_f32_16x16x32_bf16 a[156:159], a[124:127], v[60:63], a[156:159]
    ds_read_b64_tr_b16 v[60:61], v17 offset:8192
    ds_read_b64_tr_b16 v[62:63], v17 offset:9216
    v_mfma_f32_16x16x32_bf16 a[160:163], a[64:67], v[40:43], a[160:163]
    v_mfma_f32_16x16x32_bf16 a[160:163], a[68:71], v[44:47], a[160:163]
    v_mfma_f32_16x16x32_bf16 a[164:167], a[72:75], v[40:43], a[164:167]
    ds_read_b128 a[44:47], v23 offset:18432
    v_mfma_f32_16x16x32_bf16 a[164:167], a[76:79], v[44:47], a[164:167]
    s_add_u32 m0, s69, 16384
    v_mfma_f32_16x16x32_bf16 a[168:171], a[80:83], v[40:43], a[168:171]
    s_xor_b32 s60, s60, 524288
    buffer_load_dwordx4 v10, s[20:23], s63 offen lds
    v_mfma_f32_16x16x32_bf16 a[168:171], a[84:87], v[44:47], a[168:171]
    v_mfma_f32_16x16x32_bf16 a[172:175], a[88:91], v[40:43], a[172:175]
    v_mfma_f32_16x16x32_bf16 a[172:175], a[92:95], v[44:47], a[172:175]
    v_mfma_f32_16x16x32_bf16 a[176:179], a[96:99], v[40:43], a[176:179]
    ds_read_b128 a[48:51], v22 offset:20480
    v_mfma_f32_16x16x32_bf16 a[176:179], a[100:103], v[44:47], a[176:179]
    v_mfma_f32_16x16x32_bf16 a[180:183], a[104:107], v[40:43], a[180:183]
    v_mfma_f32_16x16x32_bf16 a[180:183], a[108:111], v[44:47], a[180:183]
    buffer_load_dwordx4 v11, s[20:23], s63 offen offset:1024 lds
    v_mfma_f32_16x16x32_bf16 a[184:187], a[112:115], v[40:43], a[184:187]
    v_mfma_f32_16x16x32_bf16 a[184:187], a[116:119], v[44:47], a[184:187]
    ds_read_b128 a[52:55], v23 offset:20480
    v_mfma_f32_16x16x32_bf16 a[188:191], a[120:123], v[40:43], a[188:191]
    v_mfma_f32_16x16x32_bf16 a[188:191], a[124:127], v[44:47], a[188:191]
    s_waitcnt lgkmcnt(1)
    v_mfma_f32_16x16x32_bf16 a[192:195], a[64:67], v[48:51], a[192:195]
    v_mfma_f32_16x16x32_bf16 a[192:195], a[68:71], v[52:55], a[192:195]
    v_mfma_f32_16x16x32_bf16 a[196:199], a[72:75], v[48:51], a[196:199]
    v_mfma_f32_16x16x32_bf16 a[196:199], a[76:79], v[52:55], a[196:199]
    buffer_load_dwordx4 v12, s[20:23], s63 offen offset:2048 lds
    v_mfma_f32_16x16x32_bf16 a[200:203], a[80:83], v[48:51], a[200:203]
    ds_read_b128 a[56:59], v22 offset:22528
    v_mfma_f32_16x16x32_bf16 a[200:203], a[84:87], v[52:55], a[200:203]
    v_mfma_f32_16x16x32_bf16 a[204:207], a[88:91], v[48:51], a[204:207]
    v_mfma_f32_16x16x32_bf16 a[204:207], a[92:95], v[52:55], a[204:207]
    v_mfma_f32_16x16x32_bf16 a[208:211], a[96:99], v[48:51], a[208:211]
    ds_read_b128 a[60:63], v23 offset:22528
    v_mfma_f32_16x16x32_bf16 a[208:211], a[100:103], v[52:55], a[208:211]
    v_mfma_f32_16x16x32_bf16 a[212:215], a[104:107], v[48:51], a[212:215]
    buffer_load_dwordx4 v13, s[20:23], s63 offen offset:3072 lds
    v_mfma_f32_16x16x32_bf16 a[212:215], a[108:111], v[52:55], a[212:215]
    v_mfma_f32_16x16x32_bf16 a[216:219], a[112:115], v[48:51], a[216:219]
    v_mfma_f32_16x16x32_bf16 a[216:219], a[116:119], v[52:55], a[216:219]
    v_mfma_f32_16x16x32_bf16 a[220:223], a[120:123], v[48:51], a[220:223]
    v_mfma_f32_16x16x32_bf16 a[220:223], a[124:127], v[52:55], a[220:223]
    v_mfma_f32_16x16x32_bf16 a[224:227], a[64:67], v[56:59], a[224:227]
    v_mfma_f32_16x16x32_bf16 a[224:227], a[68:71], v[60:63], a[224:227]
    s_xor_b32 s63, s63, 128
    v_mfma_f32_16x16x32_bf16 a[228:231], a[72:75], v[56:59], a[228:231]
    v_mfma_f32_16x16x32_bf16 a[228:231], a[76:79], v[60:63], a[228:231]
    v_mfma_f32_16x16x32_bf16 a[232:235], a[80:83], v[56:59], a[232:235]
    v_mfma_f32_16x16x32_bf16 a[232:235], a[84:87], v[60:63], a[232:235]
    s_waitcnt vmcnt(9) lgkmcnt(0)
    s_barrier
    ds_read_b64_tr_b16 v[40:41], v14 offset:32768
    v_mfma_f32_16x16x32_bf16 a[236:239], a[88:91], v[56:59], a[236:239]
    s_add_u32 m0, s69, 32768
    ds_read_b64_tr_b16 v[42:43], v14 offset:33792
    ds_read_b64_tr_b16 v[44:45], v14 offset:40960
    v_mfma_f32_16x16x32_bf16 a[236:239], a[92:95], v[60:63], a[236:239]
    buffer_load_dwordx4 v2, s[16:19], s60 offen nt lds
    v_mfma_f32_16x16x32_bf16 a[240:243], a[96:99], v[56:59], a[240:243]
    ds_read_b64_tr_b16 v[46:47], v14 offset:41984
    ds_read_b64_tr_b16 v[48:49], v15 offset:32768
    v_mfma_f32_16x16x32_bf16 a[240:243], a[100:103], v[60:63], a[240:243]
    ds_read_b64_tr_b16 v[50:51], v15 offset:33792
    ds_read_b64_tr_b16 v[52:53], v15 offset:40960
    v_mfma_f32_16x16x32_bf16 a[244:247], a[104:107], v[56:59], a[244:247]
    ds_read_b64_tr_b16 v[54:55], v15 offset:41984
    v_add_u32 v14, 0x10000, v14
    v_mfma_f32_16x16x32_bf16 a[244:247], a[108:111], v[60:63], a[244:247]
    v_add_u32 v15, 0x10000, v15
    v_mfma_f32_16x16x32_bf16 a[248:251], a[112:115], v[56:59], a[248:251]
    v_mfma_f32_16x16x32_bf16 a[248:251], a[116:119], v[60:63], a[248:251]
    buffer_load_dwordx4 v3, s[16:19], s60 offen offset:1024 nt lds
    v_mfma_f32_16x16x32_bf16 a[252:255], a[120:123], v[56:59], a[252:255]
    ds_read_b64_tr_b16 v[56:57], v16 offset:32768
    ds_read_b64_tr_b16 v[58:59], v16 offset:33792
    v_mfma_f32_16x16x32_bf16 a[252:255], a[124:127], v[60:63], a[252:255]
    s_waitcnt lgkmcnt(2)
    ds_read_b64_tr_b16 v[60:61], v16 offset:40960
    ds_read_b64_tr_b16 v[62:63], v16 offset:41984
    v_mfma_f32_16x16x32_bf16 v[128:131], v[40:43], a[0:3], v[128:131]
    v_add_u32 v16, 0x10000, v16
    v_mfma_f32_16x16x32_bf16 v[128:131], v[44:47], a[4:7], v[128:131]
    ds_read_b128 a[64:67], v22 offset:49152
    v_mfma_f32_16x16x32_bf16 v[132:135], v[40:43], a[8:11], v[132:135]
    v_mfma_f32_16x16x32_bf16 v[132:135], v[44:47], a[12:15], v[132:135]
    v_mfma_f32_16x16x32_bf16 v[136:139], v[40:43], a[16:19], v[136:139]
    ds_read_b128 a[68:71], v23 offset:49152
    v_mfma_f32_16x16x32_bf16 v[136:139], v[44:47], a[20:23], v[136:139]
    buffer_load_dwordx4 v4, s[16:19], s60 offen offset:2048 nt lds
    v_mfma_f32_16x16x32_bf16 v[140:143], v[40:43], a[24:27], v[140:143]
    v_mfma_f32_16x16x32_bf16 v[140:143], v[44:47], a[28:31], v[140:143]
    ds_read_b128 a[72:75], v22 offset:51200
    v_mfma_f32_16x16x32_bf16 v[144:147], v[40:43], a[32:35], v[144:147]
    v_mfma_f32_16x16x32_bf16 v[144:147], v[44:47], a[36:39], v[144:147]
    v_mfma_f32_16x16x32_bf16 v[148:151], v[40:43], a[40:43], v[148:151]
    ds_read_b128 a[76:79], v23 offset:51200
    v_mfma_f32_16x16x32_bf16 v[148:151], v[44:47], a[44:47], v[148:151]
    v_mfma_f32_16x16x32_bf16 v[152:155], v[40:43], a[48:51], v[152:155]
    buffer_load_dwordx4 v5, s[16:19], s60 offen offset:3072 nt lds
    v_mfma_f32_16x16x32_bf16 v[152:155], v[44:47], a[52:55], v[152:155]
    v_mfma_f32_16x16x32_bf16 v[156:159], v[40:43], a[56:59], v[156:159]
    ds_read_b128 a[80:83], v22 offset:53248
    ds_read_b64_tr_b16 v[40:41], v17 offset:32768
    v_mfma_f32_16x16x32_bf16 v[156:159], v[44:47], a[60:63], v[156:159]
    ds_read_b64_tr_b16 v[42:43], v17 offset:33792
    ds_read_b64_tr_b16 v[44:45], v17 offset:40960
    v_mfma_f32_16x16x32_bf16 v[160:163], v[48:51], a[0:3], v[160:163]
    ds_read_b64_tr_b16 v[46:47], v17 offset:41984
    v_add_u32 v17, 0x10000, v17
    v_mfma_f32_16x16x32_bf16 v[160:163], v[52:55], a[4:7], v[160:163]
    ds_read_b128 a[84:87], v23 offset:53248
    v_mfma_f32_16x16x32_bf16 v[164:167], v[48:51], a[8:11], v[164:167]
    v_mfma_f32_16x16x32_bf16 v[164:167], v[52:55], a[12:15], v[164:167]
    s_add_u32 m0, s69, 49152
    buffer_load_dword v7, v9, s[44:47], s69 offen sc1
    v_mfma_f32_16x16x32_bf16 v[168:171], v[48:51], a[16:19], v[168:171]
    s_xor_b32 s60, s60, 3670016
    buffer_load_dwordx4 v10, s[20:23], s64 offen lds
    v_mfma_f32_16x16x32_bf16 v[168:171], v[52:55], a[20:23], v[168:171]
    ds_read_b128 a[88:91], v22 offset:55296
    v_mfma_f32_16x16x32_bf16 v[172:175], v[48:51], a[24:27], v[172:175]
    v_mfma_f32_16x16x32_bf16 v[172:175], v[52:55], a[28:31], v[172:175]
    s_waitcnt lgkmcnt(1)
    ds_read_b128 a[92:95], v23 offset:55296
    v_mfma_f32_16x16x32_bf16 v[176:179], v[48:51], a[32:35], v[176:179]
    v_mfma_f32_16x16x32_bf16 v[176:179], v[52:55], a[36:39], v[176:179]
    v_mfma_f32_16x16x32_bf16 v[180:183], v[48:51], a[40:43], v[180:183]
    v_mfma_f32_16x16x32_bf16 v[180:183], v[52:55], a[44:47], v[180:183]
    buffer_load_dwordx4 v11, s[20:23], s64 offen offset:1024 lds
    v_mfma_f32_16x16x32_bf16 v[184:187], v[48:51], a[48:51], v[184:187]
    v_add_u32 v22, 0x10000, v22
    ds_read_b128 a[96:99], v22 offset:16384
    v_mfma_f32_16x16x32_bf16 v[184:187], v[52:55], a[52:55], v[184:187]
    v_mfma_f32_16x16x32_bf16 v[188:191], v[48:51], a[56:59], v[188:191]
    v_add_u32 v23, 0x10000, v23
    ds_read_b64_tr_b16 v[48:49], v14 offset:0
    v_mfma_f32_16x16x32_bf16 v[188:191], v[52:55], a[60:63], v[188:191]
    ds_read_b128 a[100:103], v23 offset:16384
    ds_read_b64_tr_b16 v[50:51], v14 offset:1024
    v_mfma_f32_16x16x32_bf16 v[192:195], v[56:59], a[0:3], v[192:195]
    ds_read_b64_tr_b16 v[52:53], v14 offset:8192
    ds_read_b64_tr_b16 v[54:55], v14 offset:9216
    v_mfma_f32_16x16x32_bf16 v[192:195], v[60:63], a[4:7], v[192:195]
    v_add_u32 v14, 0xfffe0000, v14
    v_mfma_f32_16x16x32_bf16 v[196:199], v[56:59], a[8:11], v[196:199]
    ds_read_b128 a[104:107], v22 offset:18432
    v_mfma_f32_16x16x32_bf16 v[196:199], v[60:63], a[12:15], v[196:199]
    buffer_load_dwordx4 v12, s[20:23], s64 offen offset:2048 lds
    v_mfma_f32_16x16x32_bf16 v[200:203], v[56:59], a[16:19], v[200:203]
    v_mfma_f32_16x16x32_bf16 v[200:203], v[60:63], a[20:23], v[200:203]
    ds_read_b128 a[108:111], v23 offset:18432
    v_mfma_f32_16x16x32_bf16 v[204:207], v[56:59], a[24:27], v[204:207]
    v_mfma_f32_16x16x32_bf16 v[204:207], v[60:63], a[28:31], v[204:207]
    v_mfma_f32_16x16x32_bf16 v[208:211], v[56:59], a[32:35], v[208:211]
    v_mfma_f32_16x16x32_bf16 v[208:211], v[60:63], a[36:39], v[208:211]
    ds_read_b128 a[112:115], v22 offset:20480
    v_mfma_f32_16x16x32_bf16 v[212:215], v[56:59], a[40:43], v[212:215]
    buffer_load_dwordx4 v13, s[20:23], s64 offen offset:3072 lds
    v_mfma_f32_16x16x32_bf16 v[212:215], v[60:63], a[44:47], v[212:215]
    v_mfma_f32_16x16x32_bf16 v[216:219], v[56:59], a[48:51], v[216:219]
    ds_read_b128 a[116:119], v23 offset:20480
    v_mfma_f32_16x16x32_bf16 v[216:219], v[60:63], a[52:55], v[216:219]
    v_mfma_f32_16x16x32_bf16 v[220:223], v[56:59], a[56:59], v[220:223]
    ds_read_b64_tr_b16 v[56:57], v15 offset:0
    ds_read_b64_tr_b16 v[58:59], v15 offset:1024
    v_mfma_f32_16x16x32_bf16 v[220:223], v[60:63], a[60:63], v[220:223]
    s_waitcnt lgkmcnt(3)
    ds_read_b128 a[120:123], v22 offset:22528
    ds_read_b64_tr_b16 v[60:61], v15 offset:8192
    v_mfma_f32_16x16x32_bf16 v[224:227], v[40:43], a[0:3], v[224:227]
    ds_read_b64_tr_b16 v[62:63], v15 offset:9216
    v_add_u32 v15, 0xfffe0000, v15
    v_mfma_f32_16x16x32_bf16 v[224:227], v[44:47], a[4:7], v[224:227]
    s_xor_b32 s64, s64, 128
    v_mov_b32 v22, v100
    v_add_u32 v22, 0x10000, v22
    v_mfma_f32_16x16x32_bf16 v[228:231], v[40:43], a[8:11], v[228:231]
    ds_read_b128 a[124:127], v23 offset:22528
    v_mov_b32 v23, v101
    v_mfma_f32_16x16x32_bf16 v[228:231], v[44:47], a[12:15], v[228:231]
    v_add_u32 v23, 0x10000, v23
    v_mfma_f32_16x16x32_bf16 v[232:235], v[40:43], a[16:19], v[232:235]
    v_mfma_f32_16x16x32_bf16 v[232:235], v[44:47], a[20:23], v[232:235]
    s_add_u32 m0, s69, 65536
    v_mfma_f32_16x16x32_bf16 v[236:239], v[40:43], a[24:27], v[236:239]
    buffer_load_dwordx4 v2, s[24:27], s60 offen lds
    v_mfma_f32_16x16x32_bf16 v[236:239], v[44:47], a[28:31], v[236:239]
    v_mfma_f32_16x16x32_bf16 v[240:243], v[40:43], a[32:35], v[240:243]
    v_mfma_f32_16x16x32_bf16 v[240:243], v[44:47], a[36:39], v[240:243]
    v_mfma_f32_16x16x32_bf16 v[244:247], v[40:43], a[40:43], v[244:247]
    v_mfma_f32_16x16x32_bf16 v[244:247], v[44:47], a[44:47], v[244:247]
    v_mfma_f32_16x16x32_bf16 v[248:251], v[40:43], a[48:51], v[248:251]
    v_mfma_f32_16x16x32_bf16 v[248:251], v[44:47], a[52:55], v[248:251]
    buffer_load_dwordx4 v3, s[24:27], s60 offen offset:1024 lds
    v_mfma_f32_16x16x32_bf16 v[252:255], v[40:43], a[56:59], v[252:255]
    ds_read_b64_tr_b16 v[40:41], v16 offset:0
    ds_read_b64_tr_b16 v[42:43], v16 offset:1024
    v_mfma_f32_16x16x32_bf16 v[252:255], v[44:47], a[60:63], v[252:255]
    ds_read_b64_tr_b16 v[44:45], v16 offset:8192
    ds_read_b64_tr_b16 v[46:47], v16 offset:9216
    v_mfma_f32_16x16x32_bf16 v[128:131], v[48:51], a[64:67], v[128:131]
    v_add_u32 v16, 0xfffe0000, v16
    v_mfma_f32_16x16x32_bf16 v[128:131], v[52:55], a[68:71], v[128:131]
    v_mfma_f32_16x16x32_bf16 v[132:135], v[48:51], a[72:75], v[132:135]
    v_mfma_f32_16x16x32_bf16 v[132:135], v[52:55], a[76:79], v[132:135]
    v_mfma_f32_16x16x32_bf16 v[136:139], v[48:51], a[80:83], v[136:139]
    v_mfma_f32_16x16x32_bf16 v[136:139], v[52:55], a[84:87], v[136:139]
    buffer_load_dwordx4 v4, s[24:27], s60 offen offset:2048 lds
    v_mfma_f32_16x16x32_bf16 v[140:143], v[48:51], a[88:91], v[140:143]
    v_mfma_f32_16x16x32_bf16 v[140:143], v[52:55], a[92:95], v[140:143]
    v_mfma_f32_16x16x32_bf16 v[144:147], v[48:51], a[96:99], v[144:147]
    v_mul_f32 v128, s74, v128
    v_mul_f32 v129, s74, v129
    v_mfma_f32_16x16x32_bf16 v[144:147], v[52:55], a[100:103], v[144:147]
    v_mul_f32 v130, s74, v130
    v_mul_f32 v131, s74, v131
    v_mfma_f32_16x16x32_bf16 v[148:151], v[48:51], a[104:107], v[148:151]
    v_cvt_pk_bf16_f32 v128, v128, v129
    v_cvt_pk_bf16_f32 v129, v130, v131
    v_mfma_f32_16x16x32_bf16 v[148:151], v[52:55], a[108:111], v[148:151]
    v_mul_f32 v132, s74, v132
    v_mul_f32 v133, s74, v133
    v_mfma_f32_16x16x32_bf16 v[152:155], v[48:51], a[112:115], v[152:155]
    s_waitcnt lgkmcnt(0)
    buffer_load_dwordx4 v5, s[24:27], s60 offen offset:3072 lds
    v_mfma_f32_16x16x32_bf16 v[152:155], v[52:55], a[116:119], v[152:155]
    v_mul_f32 v134, s74, v134
    v_mul_f32 v135, s74, v135
    v_mfma_f32_16x16x32_bf16 v[156:159], v[48:51], a[120:123], v[156:159]
    ds_read_b64_tr_b16 v[48:49], v17 offset:0
    ds_read_b64_tr_b16 v[50:51], v17 offset:1024
    v_mfma_f32_16x16x32_bf16 v[156:159], v[52:55], a[124:127], v[156:159]
    ds_read_b64_tr_b16 v[52:53], v17 offset:8192
    ds_read_b64_tr_b16 v[54:55], v17 offset:9216
    v_mfma_f32_16x16x32_bf16 v[160:163], v[56:59], a[64:67], v[160:163]
    v_add_u32 v17, 0xfffe0000, v17
    v_cvt_pk_bf16_f32 v132, v132, v133
    v_mfma_f32_16x16x32_bf16 v[160:163], v[60:63], a[68:71], v[160:163]
    v_cvt_pk_bf16_f32 v133, v134, v135
    v_mul_f32 v136, s74, v136
    v_mfma_f32_16x16x32_bf16 v[164:167], v[56:59], a[72:75], v[164:167]
    v_mul_f32 v137, s74, v137
    v_mul_f32 v138, s74, v138
    v_mfma_f32_16x16x32_bf16 v[164:167], v[60:63], a[76:79], v[164:167]
    s_add_u32 m0, s69, 81920
    v_mul_f32 v139, s74, v139
    v_mul_f32 v160, s74, v160
    v_mfma_f32_16x16x32_bf16 v[168:171], v[56:59], a[80:83], v[168:171]
    s_xor_b32 s60, s60, 524288
    buffer_load_dwordx4 v10, s[20:23], s63 offen lds
    v_mfma_f32_16x16x32_bf16 v[168:171], v[60:63], a[84:87], v[168:171]
    v_mul_f32 v161, s74, v161
    v_mul_f32 v162, s74, v162
    v_mfma_f32_16x16x32_bf16 v[172:175], v[56:59], a[88:91], v[172:175]
    v_mul_f32 v163, s74, v163
    v_cvt_pk_bf16_f32 v130, v160, v161
    v_mfma_f32_16x16x32_bf16 v[172:175], v[60:63], a[92:95], v[172:175]
    v_cvt_pk_bf16_f32 v131, v162, v163
    v_mul_f32 v164, s74, v164
    v_mfma_f32_16x16x32_bf16 v[176:179], v[56:59], a[96:99], v[176:179]
    v_mul_f32 v165, s74, v165
    v_mul_f32 v166, s74, v166
    v_mfma_f32_16x16x32_bf16 v[176:179], v[60:63], a[100:103], v[176:179]
    v_mul_f32 v167, s74, v167
    v_cvt_pk_bf16_f32 v134, v164, v165
    v_mfma_f32_16x16x32_bf16 v[180:183], v[56:59], a[104:107], v[180:183]
    v_cvt_pk_bf16_f32 v135, v166, v167
    v_mul_f32 v168, s74, v168
    v_mfma_f32_16x16x32_bf16 v[180:183], v[60:63], a[108:111], v[180:183]
    buffer_load_dwordx4 v11, s[20:23], s63 offen offset:1024 lds
    v_mfma_f32_16x16x32_bf16 v[184:187], v[56:59], a[112:115], v[184:187]
    v_mul_f32 v169, s74, v169
    v_mul_f32 v170, s74, v170
    v_mfma_f32_16x16x32_bf16 v[184:187], v[60:63], a[116:119], v[184:187]
    v_mul_f32 v171, s74, v171
    v_cvt_pk_bf16_f32 v136, v136, v137
    v_mfma_f32_16x16x32_bf16 v[188:191], v[56:59], a[120:123], v[188:191]
    v_cvt_pk_bf16_f32 v137, v138, v139
    v_cvt_pk_bf16_f32 v138, v168, v169
    v_mfma_f32_16x16x32_bf16 v[188:191], v[60:63], a[124:127], v[188:191]
    v_cvt_pk_bf16_f32 v139, v170, v171
    v_mul_f32 v140, s74, v140
    v_mfma_f32_16x16x32_bf16 v[192:195], v[40:43], a[64:67], v[192:195]
    v_mul_f32 v141, s74, v141
    v_mul_f32 v142, s74, v142
    v_mfma_f32_16x16x32_bf16 v[192:195], v[44:47], a[68:71], v[192:195]
    v_mul_f32 v143, s74, v143
    v_mul_f32 v172, s74, v172
    v_mfma_f32_16x16x32_bf16 v[196:199], v[40:43], a[72:75], v[196:199]
    v_mul_f32 v173, s74, v173
    v_mul_f32 v174, s74, v174
    v_mfma_f32_16x16x32_bf16 v[196:199], v[44:47], a[76:79], v[196:199]
    buffer_load_dwordx4 v12, s[20:23], s63 offen offset:2048 lds
    v_mfma_f32_16x16x32_bf16 v[200:203], v[40:43], a[80:83], v[200:203]
    v_mul_f32 v175, s74, v175
    v_cvt_pk_bf16_f32 v140, v140, v141
    v_mfma_f32_16x16x32_bf16 v[200:203], v[44:47], a[84:87], v[200:203]
    v_cvt_pk_bf16_f32 v141, v142, v143
    v_cvt_pk_bf16_f32 v142, v172, v173
    v_mfma_f32_16x16x32_bf16 v[204:207], v[40:43], a[88:91], v[204:207]
    v_cvt_pk_bf16_f32 v143, v174, v175
    v_mul_f32 v144, s74, v144
    v_mfma_f32_16x16x32_bf16 v[204:207], v[44:47], a[92:95], v[204:207]
    v_mul_f32 v145, s74, v145
    v_mul_f32 v146, s74, v146
    v_mfma_f32_16x16x32_bf16 v[208:211], v[40:43], a[96:99], v[208:211]
    v_mul_f32 v147, s74, v147
    v_mul_f32 v176, s74, v176
    v_mfma_f32_16x16x32_bf16 v[208:211], v[44:47], a[100:103], v[208:211]
    v_mul_f32 v177, s74, v177
    v_mul_f32 v178, s74, v178
    v_mfma_f32_16x16x32_bf16 v[212:215], v[40:43], a[104:107], v[212:215]
    buffer_load_dwordx4 v13, s[20:23], s63 offen offset:3072 lds
    v_mfma_f32_16x16x32_bf16 v[212:215], v[44:47], a[108:111], v[212:215]
    v_mul_f32 v179, s74, v179
    v_cvt_pk_bf16_f32 v144, v144, v145
    v_mfma_f32_16x16x32_bf16 v[216:219], v[40:43], a[112:115], v[216:219]
    v_cvt_pk_bf16_f32 v145, v146, v147
    v_cvt_pk_bf16_f32 v146, v176, v177
    v_mfma_f32_16x16x32_bf16 v[216:219], v[44:47], a[116:119], v[216:219]
    v_cvt_pk_bf16_f32 v147, v178, v179
    v_mul_f32 v148, s74, v148
    v_mfma_f32_16x16x32_bf16 v[220:223], v[40:43], a[120:123], v[220:223]
    v_mul_f32 v149, s74, v149
    v_mul_f32 v150, s74, v150
    v_mfma_f32_16x16x32_bf16 v[220:223], v[44:47], a[124:127], v[220:223]
    s_add_u32 s72, s70, 0
    v_mul_f32 v151, s74, v151
    v_mul_f32 v180, s74, v180
    s_waitcnt lgkmcnt(0)
    v_mfma_f32_16x16x32_bf16 v[224:227], v[48:51], a[64:67], v[224:227]
    buffer_store_dwordx4 v[128:131], v1, s[36:39], s72 offen sc1
    v_mfma_f32_16x16x32_bf16 v[224:227], v[52:55], a[68:71], v[224:227]
    s_xor_b32 s63, s63, 384
    v_mul_f32 v181, s74, v181
    v_mul_f32 v182, s74, v182
    v_mfma_f32_16x16x32_bf16 v[228:231], v[48:51], a[72:75], v[228:231]
    v_mul_f32 v183, s74, v183
    v_cvt_pk_bf16_f32 v148, v148, v149
    v_mfma_f32_16x16x32_bf16 v[228:231], v[52:55], a[76:79], v[228:231]
    v_cvt_pk_bf16_f32 v149, v150, v151
    v_cvt_pk_bf16_f32 v150, v180, v181
    v_mfma_f32_16x16x32_bf16 v[232:235], v[48:51], a[80:83], v[232:235]
    v_cvt_pk_bf16_f32 v151, v182, v183
    v_mul_f32 v152, s74, v152
    v_mfma_f32_16x16x32_bf16 v[232:235], v[52:55], a[84:87], v[232:235]
    s_add_u32 m0, s67, 98304
    v_mul_f32 v153, s74, v153
    v_mul_f32 v154, s74, v154
    s_waitcnt vmcnt(9) lgkmcnt(0)
    v_cmp_gt_u32 vcc, 8, v7
    s_nop 1
    s_and_b64 vcc, vcc, s[86:87]
    s_cbranch_scc1 SPIN_WA
BACK_WA:
    s_barrier
    v_mfma_f32_16x16x32_bf16 v[236:239], v[48:51], a[88:91], v[236:239]
    buffer_load_dwordx4 v1, s[28:31], s65 offen sc1 lds
    v_mfma_f32_16x16x32_bf16 v[236:239], v[52:55], a[92:95], v[236:239]
    ds_read_b64_tr_b16 v[56:57], v14 offset:0
    ds_read_b64_tr_b16 v[58:59], v14 offset:1024
    v_mfma_f32_16x16x32_bf16 v[240:243], v[48:51], a[96:99], v[240:243]
    ds_read_b64_tr_b16 v[60:61], v14 offset:8192
    ds_read_b64_tr_b16 v[62:63], v14 offset:9216
    v_mfma_f32_16x16x32_bf16 v[240:243], v[52:55], a[100:103], v[240:243]
    ds_read_b64_tr_b16 v[40:41], v15 offset:0
    ds_read_b64_tr_b16 v[42:43], v15 offset:1024
    v_mfma_f32_16x16x32_bf16 v[244:247], v[48:51], a[104:107], v[244:247]
    ds_read_b64_tr_b16 v[44:45], v15 offset:8192
    ds_read_b64_tr_b16 v[46:47], v15 offset:9216
    v_mfma_f32_16x16x32_bf16 v[244:247], v[52:55], a[108:111], v[244:247]
    v_mul_f32 v155, s74, v155
    v_mul_f32 v184, s74, v184
    v_mfma_f32_16x16x32_bf16 v[248:251], v[48:51], a[112:115], v[248:251]
    v_mul_f32 v185, s74, v185
    v_mul_f32 v186, s74, v186
    v_mfma_f32_16x16x32_bf16 v[248:251], v[52:55], a[116:119], v[248:251]
    v_mul_f32 v187, s74, v187
    v_cvt_pk_bf16_f32 v152, v152, v153
    v_mfma_f32_16x16x32_bf16 v[252:255], v[48:51], a[120:123], v[252:255]
    s_lshr_b32 s92, s2, 3
    buffer_load_dwordx4 v1, s[28:31], s65 offen offset:1024 sc1 lds
    v_mfma_f32_16x16x32_bf16 v[252:255], v[52:55], a[124:127], v[252:255]
    s_lshl2_add_u32 s92, s92, s4
    v_lshrrev_b32 v9, 4, v1
    v_min_u32 v9, 0, v9
    s_waitcnt lgkmcnt(0)
    v_mfma_f32_16x16x32_bf16 a[128:131], a[0:3], v[56:59], a[128:131]
    s_mul_i32 s92, s92, 1
    ds_read_b64_tr_b16 v[48:49], v16 offset:0
    ds_read_b64_tr_b16 v[50:51], v16 offset:1024
    v_mfma_f32_16x16x32_bf16 a[128:131], a[4:7], v[60:63], a[128:131]
    s_add_u32 s92, s92, 32
    v_add_lshl_u32 v9, v9, s92, 7
    ds_read_b64_tr_b16 v[52:53], v16 offset:8192
    v_mfma_f32_16x16x32_bf16 a[132:135], a[8:11], v[56:59], a[132:135]
    s_getpc_b64 s[92:93]
    global_load_dword v9, v9, s[92:93]
    v_mfma_f32_16x16x32_bf16 a[132:135], a[12:15], v[60:63], a[132:135]
    ds_read_b128 v[64:67], v24 offset:16384
    ds_read_b64_tr_b16 v[54:55], v16 offset:9216
    v_mfma_f32_16x16x32_bf16 a[136:139], a[16:19], v[56:59], a[136:139]
    v_cvt_pk_bf16_f32 v153, v154, v155
    v_cvt_pk_bf16_f32 v154, v184, v185
    v_mfma_f32_16x16x32_bf16 a[136:139], a[20:23], v[60:63], a[136:139]
    v_cvt_pk_bf16_f32 v155, v186, v187
    v_mul_f32 v156, s74, v156
    v_mfma_f32_16x16x32_bf16 a[140:143], a[24:27], v[56:59], a[140:143]
    s_add_u32 m0, s68, 106496
    v_mul_f32 v157, s74, v157
    v_mul_f32 v158, s74, v158
    v_mfma_f32_16x16x32_bf16 a[140:143], a[28:31], v[60:63], a[140:143]
    buffer_load_dwordx4 v6, s[20:23], s66 offen lds
    v_mfma_f32_16x16x32_bf16 a[144:147], a[32:35], v[56:59], a[144:147]
    s_add_u32 s72, s70, 4096
    v_mul_f32 v159, s74, v159
    v_mul_f32 v188, s74, v188
    v_mfma_f32_16x16x32_bf16 a[144:147], a[36:39], v[60:63], a[144:147]
    buffer_store_dwordx4 v[132:135], v1, s[36:39], s72 offen sc1
    v_mfma_f32_16x16x32_bf16 a[148:151], a[40:43], v[56:59], a[148:151]
    v_mul_f32 v189, s74, v189
    v_mul_f32 v190, s74, v190
    v_mfma_f32_16x16x32_bf16 a[148:151], a[44:47], v[60:63], a[148:151]
    v_mul_f32 v191, s74, v191
    v_cvt_pk_bf16_f32 v156, v156, v157
    v_mfma_f32_16x16x32_bf16 a[152:155], a[48:51], v[56:59], a[152:155]
    v_cvt_pk_bf16_f32 v157, v158, v159
    v_cvt_pk_bf16_f32 v158, v188, v189
    v_mfma_f32_16x16x32_bf16 a[152:155], a[52:55], v[60:63], a[152:155]
    ds_read_b128 v[68:71], v25 offset:16384
    v_cvt_pk_bf16_f32 v159, v190, v191
    v_mfma_f32_16x16x32_bf16 a[156:159], a[56:59], v[56:59], a[156:159]
    s_add_u32 m0, s69, 114688
    ds_read_b64_tr_b16 v[56:57], v17 offset:0
    ds_read_b64_tr_b16 v[58:59], v17 offset:1024
    v_mfma_f32_16x16x32_bf16 a[156:159], a[60:63], v[60:63], a[156:159]
    s_xor_b32 s65, s65, 8192
    buffer_load_dwordx4 v10, s[20:23], s64 offen lds
    v_mfma_f32_16x16x32_bf16 a[160:163], a[0:3], v[40:43], a[160:163]
    s_xor_b32 s66, s66, 128
    ds_read_b64_tr_b16 v[60:61], v17 offset:8192
    ds_read_b64_tr_b16 v[62:63], v17 offset:9216
    v_mfma_f32_16x16x32_bf16 a[160:163], a[4:7], v[44:47], a[160:163]
    v_mul_f32 v192, s74, v192
    v_mul_f32 v193, s74, v193
    v_mfma_f32_16x16x32_bf16 a[164:167], a[8:11], v[40:43], a[164:167]
    v_mul_f32 v194, s74, v194
    v_mul_f32 v195, s74, v195
    v_mfma_f32_16x16x32_bf16 a[164:167], a[12:15], v[44:47], a[164:167]
    v_mul_f32 v224, s74, v224
    v_mul_f32 v225, s74, v225
    v_mfma_f32_16x16x32_bf16 a[168:171], a[16:19], v[40:43], a[168:171]
    v_mul_f32 v226, s74, v226
    v_mul_f32 v227, s74, v227
    v_mfma_f32_16x16x32_bf16 a[168:171], a[20:23], v[44:47], a[168:171]
    v_cvt_pk_bf16_f32 v192, v192, v193
    v_cvt_pk_bf16_f32 v193, v194, v195
    v_mfma_f32_16x16x32_bf16 a[172:175], a[24:27], v[40:43], a[172:175]
    v_cvt_pk_bf16_f32 v194, v224, v225
    v_cvt_pk_bf16_f32 v195, v226, v227
    v_mfma_f32_16x16x32_bf16 a[172:175], a[28:31], v[44:47], a[172:175]
    v_mul_f32 v196, s74, v196
    v_mul_f32 v197, s74, v197
    v_mfma_f32_16x16x32_bf16 a[176:179], a[32:35], v[40:43], a[176:179]
    buffer_load_dwordx4 v11, s[20:23], s64 offen offset:1024 lds
    v_mfma_f32_16x16x32_bf16 a[176:179], a[36:39], v[44:47], a[176:179]
    ds_read_b128 v[72:75], v24 offset:24576
    v_mul_f32 v198, s74, v198
    v_mfma_f32_16x16x32_bf16 a[180:183], a[40:43], v[40:43], a[180:183]
    v_mul_f32 v199, s74, v199
    v_mul_f32 v228, s74, v228
    v_mfma_f32_16x16x32_bf16 a[180:183], a[44:47], v[44:47], a[180:183]
    v_mul_f32 v229, s74, v229
    v_mul_f32 v230, s74, v230
    v_mfma_f32_16x16x32_bf16 a[184:187], a[48:51], v[40:43], a[184:187]
    v_mul_f32 v231, s74, v231
    v_cvt_pk_bf16_f32 v196, v196, v197
    v_mfma_f32_16x16x32_bf16 a[184:187], a[52:55], v[44:47], a[184:187]
    v_cvt_pk_bf16_f32 v197, v198, v199
    v_cvt_pk_bf16_f32 v198, v228, v229
    v_mfma_f32_16x16x32_bf16 a[188:191], a[56:59], v[40:43], a[188:191]
    ds_read_b64_tr_b16 v[40:41], v14 offset:32768
    ds_read_b64_tr_b16 v[42:43], v14 offset:33792
    v_mfma_f32_16x16x32_bf16 a[188:191], a[60:63], v[44:47], a[188:191]
    s_waitcnt lgkmcnt(2)
    ds_read_b64_tr_b16 v[44:45], v14 offset:40960
    ds_read_b64_tr_b16 v[46:47], v14 offset:41984
    v_mfma_f32_16x16x32_bf16 a[192:195], a[0:3], v[48:51], a[192:195]
    buffer_load_dwordx4 v12, s[20:23], s64 offen offset:2048 lds
    v_mfma_f32_16x16x32_bf16 a[192:195], a[4:7], v[52:55], a[192:195]
    s_add_u32 s72, s70, 8192
    v_xor_b32 v14, s73, v14
    v_add_u32 v14, 0x10000, v14
    v_mfma_f32_16x16x32_bf16 a[196:199], a[8:11], v[48:51], a[196:199]
    buffer_store_dwordx4 v[136:139], v1, s[36:39], s72 offen sc1
    v_mfma_f32_16x16x32_bf16 a[196:199], a[12:15], v[52:55], a[196:199]
    ds_read_b128 v[76:79], v25 offset:24576
    v_cvt_pk_bf16_f32 v199, v230, v231
    v_mfma_f32_16x16x32_bf16 a[200:203], a[16:19], v[48:51], a[200:203]
    v_mul_f32 v200, s74, v200
    v_mul_f32 v201, s74, v201
    v_mfma_f32_16x16x32_bf16 a[200:203], a[20:23], v[52:55], a[200:203]
    v_mul_f32 v202, s74, v202
    v_mul_f32 v203, s74, v203
    v_mfma_f32_16x16x32_bf16 a[204:207], a[24:27], v[48:51], a[204:207]
    v_mul_f32 v232, s74, v232
    v_mul_f32 v233, s74, v233
    v_mfma_f32_16x16x32_bf16 a[204:207], a[28:31], v[52:55], a[204:207]
    v_mul_f32 v234, s74, v234
    v_mul_f32 v235, s74, v235
    v_mfma_f32_16x16x32_bf16 a[208:211], a[32:35], v[48:51], a[208:211]
    v_cvt_pk_bf16_f32 v200, v200, v201
    v_cvt_pk_bf16_f32 v201, v202, v203
    v_mfma_f32_16x16x32_bf16 a[208:211], a[36:39], v[52:55], a[208:211]
    buffer_load_dwordx4 v13, s[20:23], s64 offen offset:3072 lds
    v_mfma_f32_16x16x32_bf16 a[212:215], a[40:43], v[48:51], a[212:215]
    v_cvt_pk_bf16_f32 v202, v232, v233
    v_cvt_pk_bf16_f32 v203, v234, v235
    v_mfma_f32_16x16x32_bf16 a[212:215], a[44:47], v[52:55], a[212:215]
    v_mul_f32 v204, s74, v204
    v_mul_f32 v205, s74, v205
    v_mfma_f32_16x16x32_bf16 a[216:219], a[48:51], v[48:51], a[216:219]
    v_mul_f32 v206, s74, v206
    v_mul_f32 v207, s74, v207
    v_mfma_f32_16x16x32_bf16 a[216:219], a[52:55], v[52:55], a[216:219]
    v_mul_f32 v236, s74, v236
    v_mul_f32 v237, s74, v237
    v_mfma_f32_16x16x32_bf16 a[220:223], a[56:59], v[48:51], a[220:223]
    ds_read_b64_tr_b16 v[48:49], v15 offset:32768
    ds_read_b64_tr_b16 v[50:51], v15 offset:33792
    v_mfma_f32_16x16x32_bf16 a[220:223], a[60:63], v[52:55], a[220:223]
    ds_read_b64_tr_b16 v[52:53], v15 offset:40960
    ds_read_b64_tr_b16 v[54:55], v15 offset:41984
    v_mfma_f32_16x16x32_bf16 a[224:227], a[0:3], v[56:59], a[224:227]
    v_xor_b32 v15, s73, v15
    v_add_u32 v15, 0x10000, v15
    v_mfma_f32_16x16x32_bf16 a[224:227], a[4:7], v[60:63], a[224:227]
    s_xor_b32 s64, s64, 384
    v_accvgpr_write_b32 a4, v192
    v_accvgpr_write_b32 a5, v193
    v_mfma_f32_16x16x32_bf16 a[228:231], a[8:11], v[56:59], a[228:231]
    v_accvgpr_write_b32 a6, v194
    v_accvgpr_write_b32 a7, v195
    v_mfma_f32_16x16x32_bf16 a[228:231], a[12:15], v[60:63], a[228:231]
    v_accvgpr_write_b32 a12, v196
    v_accvgpr_write_b32 a13, v197
    v_mfma_f32_16x16x32_bf16 a[232:235], a[16:19], v[56:59], a[232:235]
    v_accvgpr_write_b32 a14, v198
    v_accvgpr_write_b32 a15, v199
    v_mfma_f32_16x16x32_bf16 a[232:235], a[20:23], v[60:63], a[232:235]
    s_add_u32 m0, s69, 131072
    v_mul_f32 v238, s74, v238
    v_mul_f32 v239, s74, v239
    v_mfma_f32_16x16x32_bf16 a[236:239], a[24:27], v[56:59], a[236:239]
    buffer_load_dwordx4 v2, s[24:27], s60 offen lds
    v_mfma_f32_16x16x32_bf16 a[236:239], a[28:31], v[60:63], a[236:239]
    v_accvgpr_write_b32 a20, v200
    v_accvgpr_write_b32 a21, v201
    v_mfma_f32_16x16x32_bf16 a[240:243], a[32:35], v[56:59], a[240:243]
    v_accvgpr_write_b32 a22, v202
    v_accvgpr_write_b32 a23, v203
    v_mfma_f32_16x16x32_bf16 a[240:243], a[36:39], v[60:63], a[240:243]
    v_cvt_pk_bf16_f32 v204, v204, v205
    v_cvt_pk_bf16_f32 v205, v206, v207
    v_mfma_f32_16x16x32_bf16 a[244:247], a[40:43], v[56:59], a[244:247]
    s_add_u32 s72, s70, 12288
    v_accvgpr_write_b32 a40, v148
    v_accvgpr_write_b32 a41, v149
    v_mfma_f32_16x16x32_bf16 a[244:247], a[44:47], v[60:63], a[244:247]
    buffer_store_dwordx4 v[140:143], v1, s[36:39], s72 offen sc1
    v_mfma_f32_16x16x32_bf16 a[248:251], a[48:51], v[56:59], a[248:251]
    v_accvgpr_write_b32 a42, v150
    v_accvgpr_write_b32 a43, v151
    v_mfma_f32_16x16x32_bf16 a[248:251], a[52:55], v[60:63], a[248:251]
    buffer_load_dwordx4 v3, s[24:27], s60 offen offset:1024 lds
    v_mfma_f32_16x16x32_bf16 a[252:255], a[56:59], v[56:59], a[252:255]
    ds_read_b64_tr_b16 v[56:57], v16 offset:32768
    ds_read_b64_tr_b16 v[58:59], v16 offset:33792
    v_mfma_f32_16x16x32_bf16 a[252:255], a[60:63], v[60:63], a[252:255]
    s_waitcnt lgkmcnt(2)
    ds_read_b64_tr_b16 v[60:61], v16 offset:40960
    ds_read_b64_tr_b16 v[62:63], v16 offset:41984
    v_mfma_f32_16x16x32_bf16 a[128:131], a[64:67], v[40:43], a[128:131]
    v_xor_b32 v16, s73, v16
    v_add_u32 v16, 0x10000, v16
    v_mfma_f32_16x16x32_bf16 a[128:131], a[68:71], v[44:47], a[128:131]
    v_accvgpr_write_b32 a48, v152
    v_accvgpr_write_b32 a49, v153
    v_mfma_f32_16x16x32_bf16 a[132:135], a[72:75], v[40:43], a[132:135]
    ds_read_b128 v[80:83], v24 offset:49152
    v_accvgpr_write_b32 a50, v154
    v_mfma_f32_16x16x32_bf16 a[132:135], a[76:79], v[44:47], a[132:135]
    v_accvgpr_write_b32 a51, v155
    v_accvgpr_write_b32 a56, v156
    v_mfma_f32_16x16x32_bf16 a[136:139], a[80:83], v[40:43], a[136:139]
    v_accvgpr_write_b32 a57, v157
    v_accvgpr_write_b32 a58, v158
    v_mfma_f32_16x16x32_bf16 a[136:139], a[84:87], v[44:47], a[136:139]
    buffer_load_dwordx4 v4, s[24:27], s60 offen offset:2048 lds
    v_mfma_f32_16x16x32_bf16 a[140:143], a[88:91], v[40:43], a[140:143]
    v_accvgpr_write_b32 a59, v159
    v_cvt_pk_bf16_f32 v206, v236, v237
    v_mfma_f32_16x16x32_bf16 a[140:143], a[92:95], v[44:47], a[140:143]
    v_cvt_pk_bf16_f32 v207, v238, v239
    v_mul_f32 v208, s74, v208
    v_mfma_f32_16x16x32_bf16 a[144:147], a[96:99], v[40:43], a[144:147]
    v_mul_f32 v209, s74, v209
    v_mul_f32 v210, s74, v210
    v_mfma_f32_16x16x32_bf16 a[144:147], a[100:103], v[44:47], a[144:147]
    v_mul_f32 v211, s74, v211
    v_mul_f32 v240, s74, v240
    v_mfma_f32_16x16x32_bf16 a[148:151], a[104:107], v[40:43], a[148:151]
    v_mul_f32 v241, s74, v241
    v_mul_f32 v242, s74, v242
    v_mfma_f32_16x16x32_bf16 a[148:151], a[108:111], v[44:47], a[148:151]
    v_mul_f32 v243, s74, v243
    v_accvgpr_write_b32 a28, v204
    v_mfma_f32_16x16x32_bf16 a[152:155], a[112:115], v[40:43], a[152:155]
    buffer_load_dwordx4 v5, s[24:27], s60 offen offset:3072 lds
    v_mfma_f32_16x16x32_bf16 a[152:155], a[116:119], v[44:47], a[152:155]
    ds_read_b128 v[84:87], v25 offset:49152
    v_accvgpr_write_b32 a29, v205
    v_mfma_f32_16x16x32_bf16 a[156:159], a[120:123], v[40:43], a[156:159]
    ds_read_b64_tr_b16 v[40:41], v17 offset:32768
    ds_read_b64_tr_b16 v[42:43], v17 offset:33792
    v_mfma_f32_16x16x32_bf16 a[156:159], a[124:127], v[44:47], a[156:159]
    ds_read_b64_tr_b16 v[44:45], v17 offset:40960
    ds_read_b64_tr_b16 v[46:47], v17 offset:41984
    v_mfma_f32_16x16x32_bf16 a[160:163], a[64:67], v[48:51], a[160:163]
    v_xor_b32 v17, s73, v17
    v_add_u32 v17, 0x10000, v17
    v_mfma_f32_16x16x32_bf16 a[160:163], a[68:71], v[52:55], a[160:163]
    v_accvgpr_write_b32 a30, v206
    v_accvgpr_write_b32 a31, v207
    v_mfma_f32_16x16x32_bf16 a[164:167], a[72:75], v[48:51], a[164:167]
    v_cvt_pk_bf16_f32 v208, v208, v209
    v_cvt_pk_bf16_f32 v209, v210, v211
    v_mfma_f32_16x16x32_bf16 a[164:167], a[76:79], v[52:55], a[164:167]
    s_add_u32 m0, s69, 147456
    v_cvt_pk_bf16_f32 v210, v240, v241
    v_cvt_pk_bf16_f32 v211, v242, v243
    v_mfma_f32_16x16x32_bf16 a[168:171], a[80:83], v[48:51], a[168:171]
    s_xor_b32 s60, s60, 1572864
    buffer_load_dwordx4 v10, s[20:23], s63 offen lds
    v_mfma_f32_16x16x32_bf16 a[168:171], a[84:87], v[52:55], a[168:171]
    s_add_u32 s72, s70, 32768
    buffer_store_dwordx4 v[144:147], v1, s[36:39], s72 offen sc1
    v_mfma_f32_16x16x32_bf16 a[172:175], a[88:91], v[48:51], a[172:175]
    v_mul_f32 v212, s74, v212
    v_mul_f32 v213, s74, v213
    v_mfma_f32_16x16x32_bf16 a[172:175], a[92:95], v[52:55], a[172:175]
    v_mul_f32 v214, s74, v214
    v_mul_f32 v215, s74, v215
    v_mfma_f32_16x16x32_bf16 a[176:179], a[96:99], v[48:51], a[176:179]
    ds_read_b128 v[88:91], v24 offset:57344
    v_mul_f32 v244, s74, v244
    v_mfma_f32_16x16x32_bf16 a[176:179], a[100:103], v[52:55], a[176:179]
    v_mul_f32 v245, s74, v245
    v_mul_f32 v246, s74, v246
    v_mfma_f32_16x16x32_bf16 a[180:183], a[104:107], v[48:51], a[180:183]
    v_mul_f32 v247, s74, v247
    v_accvgpr_write_b32 a36, v208
    v_mfma_f32_16x16x32_bf16 a[180:183], a[108:111], v[52:55], a[180:183]
    buffer_load_dwordx4 v11, s[20:23], s63 offen offset:1024 lds
    v_mfma_f32_16x16x32_bf16 a[184:187], a[112:115], v[48:51], a[184:187]
    v_accvgpr_write_b32 a37, v209
    v_accvgpr_write_b32 a38, v210
    v_mfma_f32_16x16x32_bf16 a[184:187], a[116:119], v[52:55], a[184:187]
    v_accvgpr_write_b32 a39, v211
    v_cvt_pk_bf16_f32 v212, v212, v213
    v_mfma_f32_16x16x32_bf16 a[188:191], a[120:123], v[48:51], a[188:191]
    v_cvt_pk_bf16_f32 v213, v214, v215
    v_cvt_pk_bf16_f32 v214, v244, v245
    v_mfma_f32_16x16x32_bf16 a[188:191], a[124:127], v[52:55], a[188:191]
    s_waitcnt lgkmcnt(0)
    v_cvt_pk_bf16_f32 v215, v246, v247
    v_mul_f32 v216, s74, v216
    v_mfma_f32_16x16x32_bf16 a[192:195], a[64:67], v[56:59], a[192:195]
    v_mul_f32 v217, s74, v217
    v_mul_f32 v218, s74, v218
    v_mfma_f32_16x16x32_bf16 a[192:195], a[68:71], v[60:63], a[192:195]
    v_accvgpr_read_b32 v32, a128
    v_accvgpr_read_b32 v31, a129
    v_mfma_f32_16x16x32_bf16 a[196:199], a[72:75], v[56:59], a[196:199]
    v_cvt_pk_bf16_f32 v32, v32, v31
    v_accvgpr_read_b32 v33, a130
    v_mfma_f32_16x16x32_bf16 a[196:199], a[76:79], v[60:63], a[196:199]
    buffer_load_dwordx4 v12, s[20:23], s63 offen offset:2048 lds
    v_mfma_f32_16x16x32_bf16 a[200:203], a[80:83], v[56:59], a[200:203]
    ds_read_b128 v[92:95], v25 offset:57344
    v_accvgpr_read_b32 v31, a131
    v_mfma_f32_16x16x32_bf16 a[200:203], a[84:87], v[60:63], a[200:203]
    v_cvt_pk_bf16_f32 v33, v33, v31
    v_accvgpr_read_b32 v34, a132
    v_mfma_f32_16x16x32_bf16 a[204:207], a[88:91], v[56:59], a[204:207]
    v_accvgpr_read_b32 v31, a133
    v_cvt_pk_bf16_f32 v34, v34, v31
    v_mfma_f32_16x16x32_bf16 a[204:207], a[92:95], v[60:63], a[204:207]
    v_accvgpr_read_b32 v35, a134
    v_accvgpr_read_b32 v31, a135
    v_mfma_f32_16x16x32_bf16 a[208:211], a[96:99], v[56:59], a[208:211]
    v_cvt_pk_bf16_f32 v35, v35, v31
    v_mul_f32 v219, s74, v219
    v_mfma_f32_16x16x32_bf16 a[208:211], a[100:103], v[60:63], a[208:211]
    v_mul_f32 v248, s74, v248
    v_mul_f32 v249, s74, v249
    v_mfma_f32_16x16x32_bf16 a[212:215], a[104:107], v[56:59], a[212:215]
    buffer_load_dwordx4 v13, s[20:23], s63 offen offset:3072 lds
    v_mfma_f32_16x16x32_bf16 a[212:215], a[108:111], v[60:63], a[212:215]
    v_mul_f32 v250, s74, v250
    v_mul_f32 v251, s74, v251
    v_mfma_f32_16x16x32_bf16 a[216:219], a[112:115], v[56:59], a[216:219]
    s_add_u32 s72, s71, 0
    v_accvgpr_write_b32 a44, v212
    v_accvgpr_write_b32 a45, v213
    v_mfma_f32_16x16x32_bf16 a[216:219], a[116:119], v[60:63], a[216:219]
    buffer_store_dwordx4 v[32:35], v1, s[36:39], s72 offen sc1
    v_mfma_f32_16x16x32_bf16 a[220:223], a[120:123], v[56:59], a[220:223]
    v_accvgpr_write_b32 a46, v214
    v_accvgpr_write_b32 a47, v215
    v_mfma_f32_16x16x32_bf16 a[220:223], a[124:127], v[60:63], a[220:223]
    v_cvt_pk_bf16_f32 v216, v216, v217
    v_cvt_pk_bf16_f32 v217, v218, v219
    v_mfma_f32_16x16x32_bf16 a[224:227], a[64:67], v[40:43], a[224:227]
    v_cvt_pk_bf16_f32 v218, v248, v249
    v_cvt_pk_bf16_f32 v219, v250, v251
    v_mfma_f32_16x16x32_bf16 a[224:227], a[68:71], v[44:47], a[224:227]
    s_xor_b32 s63, s63, 128
    v_mul_f32 v220, s74, v220
    v_mul_f32 v221, s74, v221
    v_mfma_f32_16x16x32_bf16 a[228:231], a[72:75], v[40:43], a[228:231]
    v_mul_f32 v222, s74, v222
    v_mul_f32 v223, s74, v223
    v_mfma_f32_16x16x32_bf16 a[228:231], a[76:79], v[44:47], a[228:231]
    v_mul_f32 v252, s74, v252
    v_mul_f32 v253, s74, v253
    v_mfma_f32_16x16x32_bf16 a[232:235], a[80:83], v[40:43], a[232:235]
    v_mul_f32 v254, s74, v254
    v_mul_f32 v255, s74, v255
    v_mfma_f32_16x16x32_bf16 a[232:235], a[84:87], v[44:47], a[232:235]
    s_waitcnt vmcnt(11) lgkmcnt(0)
    s_barrier
    ds_read_b64_tr_b16 v[48:49], v14 offset:0
    v_mfma_f32_16x16x32_bf16 a[236:239], a[88:91], v[40:43], a[236:239]
    s_add_u32 m0, s67, 0
    ds_read_b64_tr_b16 v[50:51], v14 offset:1024
    ds_read_b64_tr_b16 v[52:53], v14 offset:8192
    v_mfma_f32_16x16x32_bf16 a[236:239], a[92:95], v[44:47], a[236:239]
    buffer_load_dwordx4 v1, s[28:31], s65 offen sc1 lds
    v_mfma_f32_16x16x32_bf16 a[240:243], a[96:99], v[40:43], a[240:243]
    ds_read_b64_tr_b16 v[54:55], v14 offset:9216
    ds_read_b64_tr_b16 v[56:57], v15 offset:0
    v_mfma_f32_16x16x32_bf16 a[240:243], a[100:103], v[44:47], a[240:243]
    ds_read_b64_tr_b16 v[58:59], v15 offset:1024
    ds_read_b64_tr_b16 v[60:61], v15 offset:8192
    v_mfma_f32_16x16x32_bf16 a[244:247], a[104:107], v[40:43], a[244:247]
    ds_read_b64_tr_b16 v[62:63], v15 offset:9216
    v_add_u32 v14, 0x10000, v14
    v_mfma_f32_16x16x32_bf16 a[244:247], a[108:111], v[44:47], a[244:247]
    v_add_u32 v15, 0x10000, v15
    v_accvgpr_read_b32 v32, a136
    v_mfma_f32_16x16x32_bf16 a[248:251], a[112:115], v[40:43], a[248:251]
    v_accvgpr_read_b32 v31, a137
    v_cvt_pk_bf16_f32 v32, v32, v31
    v_mfma_f32_16x16x32_bf16 a[248:251], a[116:119], v[44:47], a[248:251]
    v_accvgpr_read_b32 v33, a138
    v_accvgpr_read_b32 v31, a139
    v_mfma_f32_16x16x32_bf16 a[252:255], a[120:123], v[40:43], a[252:255]
    buffer_load_dwordx4 v1, s[28:31], s65 offen offset:1024 sc1 lds
    v_mfma_f32_16x16x32_bf16 a[252:255], a[124:127], v[44:47], a[252:255]
    s_waitcnt lgkmcnt(0)
    ds_read_b64_tr_b16 v[40:41], v16 offset:0
    ds_read_b64_tr_b16 v[42:43], v16 offset:1024
    v_mfma_f32_16x16x32_bf16 v[128:131], v[48:51], v[64:67], 0
    ds_read_b64_tr_b16 v[44:45], v16 offset:8192
    ds_read_b64_tr_b16 v[46:47], v16 offset:9216
    v_mfma_f32_16x16x32_bf16 v[128:131], v[52:55], v[68:71], v[128:131]
    v_add_u32 v24, 0x10000, v24
    ds_read_b128 a[136:139], v22 offset:32768
    v_mfma_f32_16x16x32_bf16 v[132:135], v[48:51], v[72:75], 0
    ds_read_b128 v[96:99], v24 offset:16384
    v_add_u32 v16, 0x10000, v16
    v_mfma_f32_16x16x32_bf16 v[132:135], v[52:55], v[76:79], v[132:135]
    v_add_u32 v22, 0xffff0000, v22
    v_cvt_pk_bf16_f32 v33, v33, v31
    v_mfma_f32_16x16x32_bf16 v[136:139], v[48:51], v[80:83], 0
    v_accvgpr_read_b32 v34, a140
    v_accvgpr_read_b32 v31, a141
    v_mfma_f32_16x16x32_bf16 v[136:139], v[52:55], v[84:87], v[136:139]
    s_add_u32 s72, s71, 1024
    v_cvt_pk_bf16_f32 v34, v34, v31
    v_accvgpr_read_b32 v35, a142
    v_mfma_f32_16x16x32_bf16 v[140:143], v[48:51], v[88:91], 0
    s_add_u32 m0, s68, 8192
    ds_read_b64_tr_b16 v[48:49], v17 offset:0
    ds_read_b64_tr_b16 v[50:51], v17 offset:1024
    v_mfma_f32_16x16x32_bf16 v[140:143], v[52:55], v[92:95], v[140:143]
    buffer_load_dwordx4 v6, s[20:23], s66 offen lds
    v_mfma_f32_16x16x32_bf16 v[144:147], v[56:59], v[64:67], 0
    ds_read_b64_tr_b16 v[52:53], v17 offset:8192
    ds_read_b64_tr_b16 v[54:55], v17 offset:9216
    v_mfma_f32_16x16x32_bf16 v[144:147], v[60:63], v[68:71], v[144:147]
    v_add_u32 v17, 0x10000, v17
    v_accvgpr_read_b32 v31, a143
    v_mfma_f32_16x16x32_bf16 v[148:151], v[56:59], v[72:75], 0
    ds_read_b128 a[140:143], v23 offset:32768
    v_add_u32 v23, 0xffff0000, v23
    v_mfma_f32_16x16x32_bf16 v[148:151], v[60:63], v[76:79], v[148:151]
    v_cvt_pk_bf16_f32 v35, v35, v31
    v_accvgpr_write_b32 a52, v216
    v_mfma_f32_16x16x32_bf16 v[152:155], v[56:59], v[80:83], 0
    v_add_u32 v25, 0x10000, v25
    v_accvgpr_write_b32 a53, v217
    v_mfma_f32_16x16x32_bf16 v[152:155], v[60:63], v[84:87], v[152:155]
    ds_read_b128 v[100:103], v25 offset:16384
    v_accvgpr_write_b32 a54, v218
    v_mfma_f32_16x16x32_bf16 v[156:159], v[56:59], v[88:91], 0
    s_add_u32 m0, s69, 16384
    ds_read_b64_tr_b16 v[56:57], v18 offset:0
    ds_read_b64_tr_b16 v[58:59], v18 offset:1024
    v_mfma_f32_16x16x32_bf16 v[156:159], v[60:63], v[92:95], v[156:159]
    s_xor_b32 s65, s65, 24576
    buffer_load_dwordx4 v10, s[20:23], s64 offen lds
    s_waitcnt lgkmcnt(3)
    v_mfma_f32_16x16x32_bf16 v[160:163], v[40:43], v[64:67], 0
    s_xor_b32 s66, s66, 384
    ds_read_b64_tr_b16 v[60:61], v18 offset:8192
    ds_read_b64_tr_b16 v[62:63], v18 offset:9216
    v_mfma_f32_16x16x32_bf16 v[160:163], v[44:47], v[68:71], v[160:163]
    v_add_u32 v18, 0x10000, v18
    v_accvgpr_write_b32 a55, v219
    v_mfma_f32_16x16x32_bf16 v[164:167], v[40:43], v[72:75], 0
    buffer_store_dwordx4 v[32:35], v1, s[36:39], s72 offen sc1
    v_mfma_f32_16x16x32_bf16 v[164:167], v[44:47], v[76:79], v[164:167]
    v_cvt_pk_bf16_f32 v220, v220, v221
    v_cvt_pk_bf16_f32 v221, v222, v223
    v_mfma_f32_16x16x32_bf16 v[168:171], v[40:43], v[80:83], 0
    v_cvt_pk_bf16_f32 v222, v252, v253
    v_cvt_pk_bf16_f32 v223, v254, v255
    v_mfma_f32_16x16x32_bf16 v[168:171], v[44:47], v[84:87], v[168:171]
    v_accvgpr_write_b32 a60, v220
    v_accvgpr_write_b32 a61, v221
    v_mfma_f32_16x16x32_bf16 v[172:175], v[40:43], v[88:91], 0
    ds_read_b64_tr_b16 v[40:41], v19 offset:0
    ds_read_b64_tr_b16 v[42:43], v19 offset:1024
    v_mfma_f32_16x16x32_bf16 v[172:175], v[44:47], v[92:95], v[172:175]
    ds_read_b64_tr_b16 v[44:45], v19 offset:8192
    ds_read_b64_tr_b16 v[46:47], v19 offset:9216
    v_mfma_f32_16x16x32_bf16 v[176:179], v[48:51], v[64:67], 0
    buffer_load_dwordx4 v11, s[20:23], s64 offen offset:1024 lds
    v_mfma_f32_16x16x32_bf16 v[176:179], v[52:55], v[68:71], v[176:179]
    ds_read_b128 v[104:107], v24 offset:24576
    v_add_u32 v19, 0x10000, v19
    v_mfma_f32_16x16x32_bf16 v[180:183], v[48:51], v[72:75], 0
    v_accvgpr_write_b32 a62, v222
    v_accvgpr_write_b32 a63, v223
    v_mfma_f32_16x16x32_bf16 v[180:183], v[52:55], v[76:79], v[180:183]
    v_accvgpr_write_b32 a0, 0
    v_accvgpr_write_b32 a1, 0
    v_mfma_f32_16x16x32_bf16 v[184:187], v[48:51], v[80:83], 0
    v_accvgpr_write_b32 a2, 0
    v_accvgpr_write_b32 a3, 0
    v_mfma_f32_16x16x32_bf16 v[184:187], v[52:55], v[84:87], v[184:187]
    v_accvgpr_write_b32 a8, 0
    v_accvgpr_write_b32 a9, 0
    v_mfma_f32_16x16x32_bf16 v[188:191], v[48:51], v[88:91], 0
    s_add_u32 s72, s70, 36864
    ds_read_b64_tr_b16 v[48:49], v20 offset:0
    ds_read_b64_tr_b16 v[50:51], v20 offset:1024
    v_mfma_f32_16x16x32_bf16 v[188:191], v[52:55], v[92:95], v[188:191]
    s_waitcnt lgkmcnt(2)
    ds_read_b64_tr_b16 v[52:53], v20 offset:8192
    ds_read_b64_tr_b16 v[54:55], v20 offset:9216
    v_mfma_f32_16x16x32_bf16 v[192:195], v[56:59], v[64:67], 0
    buffer_load_dwordx4 v12, s[20:23], s64 offen offset:2048 lds
    v_mfma_f32_16x16x32_bf16 v[192:195], v[60:63], v[68:71], v[192:195]
    v_add_u32 v20, 0x10000, v20
    v_accvgpr_write_b32 a10, 0
    v_mfma_f32_16x16x32_bf16 v[196:199], v[56:59], v[72:75], 0
    buffer_store_dwordx4 a[40:43], v1, s[36:39], s72 offen sc1
    v_mfma_f32_16x16x32_bf16 v[196:199], v[60:63], v[76:79], v[196:199]
    ds_read_b128 v[108:111], v25 offset:24576
    v_accvgpr_write_b32 a11, 0
    v_mfma_f32_16x16x32_bf16 v[200:203], v[56:59], v[80:83], 0
    v_accvgpr_write_b32 a16, 0
    v_accvgpr_write_b32 a17, 0
    v_mfma_f32_16x16x32_bf16 v[200:203], v[60:63], v[84:87], v[200:203]
    v_accvgpr_write_b32 a18, 0
    v_accvgpr_write_b32 a19, 0
    v_mfma_f32_16x16x32_bf16 v[204:207], v[56:59], v[88:91], 0
    ds_read_b64_tr_b16 v[56:57], v21 offset:0
    ds_read_b64_tr_b16 v[58:59], v21 offset:1024
    v_mfma_f32_16x16x32_bf16 v[204:207], v[60:63], v[92:95], v[204:207]
    ds_read_b64_tr_b16 v[60:61], v21 offset:8192
    ds_read_b64_tr_b16 v[62:63], v21 offset:9216
    v_mfma_f32_16x16x32_bf16 v[208:211], v[40:43], v[64:67], 0
    v_add_u32 v21, 0x10000, v21
    v_accvgpr_write_b32 a24, 0
    v_mfma_f32_16x16x32_bf16 v[208:211], v[44:47], v[68:71], v[208:211]
    buffer_load_dwordx4 v13, s[20:23], s64 offen offset:3072 lds
    v_mfma_f32_16x16x32_bf16 v[212:215], v[40:43], v[72:75], 0
    v_accvgpr_write_b32 a25, 0
    v_accvgpr_write_b32 a26, 0
    v_mfma_f32_16x16x32_bf16 v[212:215], v[44:47], v[76:79], v[212:215]
    v_accvgpr_write_b32 a27, 0
    v_accvgpr_write_b32 a32, 0
    v_mfma_f32_16x16x32_bf16 v[216:219], v[40:43], v[80:83], 0
    v_accvgpr_write_b32 a33, 0
    v_accvgpr_write_b32 a34, 0
    v_mfma_f32_16x16x32_bf16 v[216:219], v[44:47], v[84:87], v[216:219]
    v_accvgpr_write_b32 a35, 0
    v_accvgpr_write_b32 a40, 0
    v_mfma_f32_16x16x32_bf16 v[220:223], v[40:43], v[88:91], 0
    ds_read_b64_tr_b16 v[40:41], v26 offset:32768
    ds_read_b64_tr_b16 v[42:43], v26 offset:33280
    v_mfma_f32_16x16x32_bf16 v[220:223], v[44:47], v[92:95], v[220:223]
    s_waitcnt lgkmcnt(2)
    ds_read_b64_tr_b16 v[44:45], v26 offset:36864
    ds_read_b64_tr_b16 v[46:47], v26 offset:37376
    v_mfma_f32_16x16x32_bf16 v[224:227], v[48:51], v[64:67], 0
    v_add_u32 v26, 0xffff0000, v26
    v_accvgpr_write_b32 a41, 0
    v_mfma_f32_16x16x32_bf16 v[224:227], v[52:55], v[68:71], v[224:227]
    s_xor_b32 s64, s64, 128
    v_accvgpr_write_b32 a42, 0
    v_accvgpr_write_b32 a43, 0
    v_mfma_f32_16x16x32_bf16 v[228:231], v[48:51], v[72:75], 0
    v_mfma_f32_16x16x32_bf16 v[228:231], v[52:55], v[76:79], v[228:231]
    v_mfma_f32_16x16x32_bf16 v[232:235], v[48:51], v[80:83], 0
    v_mfma_f32_16x16x32_bf16 v[232:235], v[52:55], v[84:87], v[232:235]
    s_add_u32 m0, s69, 32768
    v_mfma_f32_16x16x32_bf16 v[236:239], v[48:51], v[88:91], 0
    buffer_load_dwordx4 v2, s[24:27], s60 offen lds
    v_mfma_f32_16x16x32_bf16 v[236:239], v[52:55], v[92:95], v[236:239]
    s_add_u32 s72, s70, 40960
    ds_read_b64_tr_b16 v[48:49], v27 offset:32768
    ds_read_b64_tr_b16 v[50:51], v27 offset:33280
    v_mfma_f32_16x16x32_bf16 v[240:243], v[56:59], v[64:67], 0
    ds_read_b64_tr_b16 v[52:53], v27 offset:36864
    ds_read_b64_tr_b16 v[54:55], v27 offset:37376
    v_mfma_f32_16x16x32_bf16 v[240:243], v[60:63], v[68:71], v[240:243]
    buffer_store_dwordx4 a[48:51], v1, s[36:39], s72 offen sc1
    v_mfma_f32_16x16x32_bf16 v[244:247], v[56:59], v[72:75], 0
    buffer_load_dwordx4 v3, s[24:27], s60 offen offset:1024 lds
    v_mfma_f32_16x16x32_bf16 v[244:247], v[60:63], v[76:79], v[244:247]
    v_add_u32 v27, 0xffff0000, v27
    v_accvgpr_write_b32 a48, 0
    v_mfma_f32_16x16x32_bf16 v[248:251], v[56:59], v[80:83], 0
    v_accvgpr_write_b32 a49, 0
    v_accvgpr_write_b32 a50, 0
    v_mfma_f32_16x16x32_bf16 v[248:251], v[60:63], v[84:87], v[248:251]
    v_accvgpr_write_b32 a51, 0
    v_mfma_f32_16x16x32_bf16 v[252:255], v[56:59], v[88:91], 0
    buffer_load_dwordx4 v4, s[24:27], s60 offen offset:2048 lds
    v_mfma_f32_16x16x32_bf16 v[252:255], v[60:63], v[92:95], v[252:255]
    s_waitcnt lgkmcnt(0)
    ds_read_b64_tr_b16 v[56:57], v28 offset:32768
    ds_read_b64_tr_b16 v[58:59], v28 offset:33280
    v_mfma_f32_16x16x32_bf16 a[64:67], v[40:43], v[64:67], 0
    ds_read_b64_tr_b16 v[60:61], v28 offset:36864
    ds_read_b64_tr_b16 v[62:63], v28 offset:37376
    v_mfma_f32_16x16x32_bf16 a[64:67], v[44:47], v[68:71], a[64:67]
    v_add_u32 v28, 0xffff0000, v28
    v_mfma_f32_16x16x32_bf16 a[68:71], v[40:43], v[72:75], 0
    buffer_load_dwordx4 v5, s[24:27], s60 offen offset:3072 lds
    v_mfma_f32_16x16x32_bf16 a[68:71], v[44:47], v[76:79], a[68:71]
    ds_read_b128 v[112:115], v24 offset:49152
    v_mfma_f32_16x16x32_bf16 a[72:75], v[40:43], v[80:83], 0
    v_mfma_f32_16x16x32_bf16 a[72:75], v[44:47], v[84:87], a[72:75]
    s_add_u32 m0, s69, 49152
    v_mfma_f32_16x16x32_bf16 a[76:79], v[40:43], v[88:91], 0
    s_xor_b32 s60, s60, 524288
    buffer_load_dwordx4 v10, s[20:23], s63 offen lds
    v_mfma_f32_16x16x32_bf16 a[76:79], v[44:47], v[92:95], a[76:79]
    ds_read_b128 v[116:119], v25 offset:49152
    v_mfma_f32_16x16x32_bf16 a[128:131], v[40:43], a[136:139], 0
    ds_read_b64_tr_b16 v[40:41], v29 offset:32768
    ds_read_b64_tr_b16 v[42:43], v29 offset:33280
    v_mfma_f32_16x16x32_bf16 a[128:131], v[44:47], a[140:143], a[128:131]
    ds_read_b64_tr_b16 v[44:45], v29 offset:36864
    ds_read_b64_tr_b16 v[46:47], v29 offset:37376
    v_mfma_f32_16x16x32_bf16 a[80:83], v[48:51], v[64:67], 0
    buffer_load_dwordx4 v11, s[20:23], s63 offen offset:1024 lds
    v_mfma_f32_16x16x32_bf16 a[80:83], v[52:55], v[68:71], a[80:83]
    ds_read_b128 v[120:123], v24 offset:57344
    v_add_u32 v29, 0xffff0000, v29
    v_mfma_f32_16x16x32_bf16 a[84:87], v[48:51], v[72:75], 0
    v_mfma_f32_16x16x32_bf16 a[84:87], v[52:55], v[76:79], a[84:87]
    v_mfma_f32_16x16x32_bf16 a[88:91], v[48:51], v[80:83], 0
    buffer_load_dwordx4 v12, s[20:23], s63 offen offset:2048 lds
    v_mfma_f32_16x16x32_bf16 a[88:91], v[52:55], v[84:87], a[88:91]
    ds_read_b128 v[124:127], v25 offset:57344
    v_mfma_f32_16x16x32_bf16 a[92:95], v[48:51], v[88:91], 0
    s_add_u32 s72, s70, 45056
    v_mfma_f32_16x16x32_bf16 a[92:95], v[52:55], v[92:95], a[92:95]
    v_mfma_f32_16x16x32_bf16 a[132:135], v[48:51], a[136:139], 0
    buffer_load_dwordx4 v13, s[20:23], s63 offen offset:3072 lds
    v_mfma_f32_16x16x32_bf16 a[132:135], v[52:55], a[140:143], a[132:135]
    s_waitcnt lgkmcnt(1)
    v_mfma_f32_16x16x32_bf16 a[96:99], v[56:59], v[64:67], 0
    v_mfma_f32_16x16x32_bf16 a[96:99], v[60:63], v[68:71], a[96:99]
    s_xor_b32 s63, s63, 896
    v_mfma_f32_16x16x32_bf16 a[100:103], v[56:59], v[72:75], 0
    buffer_store_dwordx4 a[56:59], v1, s[36:39], s72 offen sc1
    v_mfma_f32_16x16x32_bf16 a[100:103], v[60:63], v[76:79], a[100:103]
    v_mfma_f32_16x16x32_bf16 a[104:107], v[56:59], v[80:83], 0
    v_accvgpr_write_b32 a56, 0
    v_accvgpr_write_b32 a57, 0
    v_mfma_f32_16x16x32_bf16 a[104:107], v[60:63], v[84:87], a[104:107]
    s_waitcnt vmcnt(10) lgkmcnt(0)
    s_barrier
    ds_read_b64_tr_b16 v[48:49], v14 offset:0
    v_mfma_f32_16x16x32_bf16 a[108:111], v[56:59], v[88:91], 0
    s_add_u32 m0, s67, 65536
    ds_read_b64_tr_b16 v[50:51], v14 offset:1024
    ds_read_b64_tr_b16 v[52:53], v14 offset:8192
    v_mfma_f32_16x16x32_bf16 a[108:111], v[60:63], v[92:95], a[108:111]
    buffer_load_dwordx4 v1, s[28:31], s65 offen sc1 lds
    v_mfma_f32_16x16x32_bf16 a[112:115], v[40:43], v[64:67], 0
    ds_read_b64_tr_b16 v[54:55], v14 offset:9216
    ds_read_b64_tr_b16 v[56:57], v15 offset:0
    v_mfma_f32_16x16x32_bf16 a[112:115], v[44:47], v[68:71], a[112:115]
    ds_read_b64_tr_b16 v[58:59], v15 offset:1024
    ds_read_b64_tr_b16 v[60:61], v15 offset:8192
    v_mfma_f32_16x16x32_bf16 a[116:119], v[40:43], v[72:75], 0
    ds_read_b64_tr_b16 v[62:63], v15 offset:9216
    ds_read_b128 a[136:139], v22 offset:0
    v_mfma_f32_16x16x32_bf16 a[116:119], v[44:47], v[76:79], a[116:119]
    ds_read_b128 a[140:143], v23 offset:0
    v_add_u32 v14, 0xfffe0000, v14
    v_mfma_f32_16x16x32_bf16 a[120:123], v[40:43], v[80:83], 0
    v_add_u32 v15, 0xfffe0000, v15
    v_add_u32 v22, 0x10000, v22
    v_mfma_f32_16x16x32_bf16 a[120:123], v[44:47], v[84:87], a[120:123]
    v_add_u32 v23, 0x10000, v23
    v_accvgpr_write_b32 a58, 0
    v_mfma_f32_16x16x32_bf16 a[124:127], v[40:43], v[88:91], 0
    buffer_load_dwordx4 v1, s[28:31], s65 offen offset:1024 sc1 lds
    v_mfma_f32_16x16x32_bf16 a[124:127], v[44:47], v[92:95], a[124:127]
    s_waitcnt lgkmcnt(1)
    ds_read_b64_tr_b16 v[40:41], v16 offset:0
    ds_read_b64_tr_b16 v[42:43], v16 offset:1024
    v_mfma_f32_16x16x32_bf16 v[128:131], v[48:51], v[96:99], v[128:131]
    ds_read_b64_tr_b16 v[44:45], v16 offset:8192
    ds_read_b64_tr_b16 v[46:47], v16 offset:9216
    v_mfma_f32_16x16x32_bf16 v[128:131], v[52:55], v[100:103], v[128:131]
    v_add_u32 v24, 0x10000, v24
    v_add_u32 v16, 0xfffe0000, v16
    v_mfma_f32_16x16x32_bf16 v[132:135], v[48:51], v[104:107], v[132:135]
    ds_read_b128 v[64:67], v24 offset:16384
    v_accvgpr_write_b32 a59, 0
    v_mfma_f32_16x16x32_bf16 v[132:135], v[52:55], v[108:111], v[132:135]
    v_mfma_f32_16x16x32_bf16 v[136:139], v[48:51], v[112:115], v[136:139]
    v_mfma_f32_16x16x32_bf16 v[136:139], v[52:55], v[116:119], v[136:139]
    s_add_u32 s72, s70, 1024
    v_mfma_f32_16x16x32_bf16 v[140:143], v[48:51], v[120:123], v[140:143]
    s_add_u32 m0, s68, 73728
    ds_read_b64_tr_b16 v[48:49], v17 offset:0
    ds_read_b64_tr_b16 v[50:51], v17 offset:1024
    v_mfma_f32_16x16x32_bf16 v[140:143], v[52:55], v[124:127], v[140:143]
    buffer_load_dwordx4 v6, s[20:23], s66 offen lds
    v_mfma_f32_16x16x32_bf16 v[144:147], v[56:59], v[96:99], v[144:147]
    ds_read_b64_tr_b16 v[52:53], v17 offset:8192
    ds_read_b64_tr_b16 v[54:55], v17 offset:9216
    v_mfma_f32_16x16x32_bf16 v[144:147], v[60:63], v[100:103], v[144:147]
    buffer_store_dwordx4 a[4:7], v1, s[36:39], s72 offen sc1
    v_mfma_f32_16x16x32_bf16 v[148:151], v[56:59], v[104:107], v[148:151]
    v_add_u32 v17, 0xfffe0000, v17
    v_accvgpr_write_b32 a4, 0
    v_mfma_f32_16x16x32_bf16 v[148:151], v[60:63], v[108:111], v[148:151]
    v_accvgpr_write_b32 a5, 0
    v_accvgpr_write_b32 a6, 0
    v_mfma_f32_16x16x32_bf16 v[152:155], v[56:59], v[112:115], v[152:155]
    v_add_u32 v25, 0x10000, v25
    v_accvgpr_write_b32 a7, 0
    v_mfma_f32_16x16x32_bf16 v[152:155], v[60:63], v[116:119], v[152:155]
    ds_read_b128 v[68:71], v25 offset:16384
    v_mfma_f32_16x16x32_bf16 v[156:159], v[56:59], v[120:123], v[156:159]
    s_add_u32 m0, s69, 81920
    ds_read_b64_tr_b16 v[56:57], v18 offset:0
    ds_read_b64_tr_b16 v[58:59], v18 offset:1024
    v_mfma_f32_16x16x32_bf16 v[156:159], v[60:63], v[124:127], v[156:159]
    s_xor_b32 s65, s65, 8192
    buffer_load_dwordx4 v10, s[20:23], s64 offen lds
    s_waitcnt lgkmcnt(3)
    v_mfma_f32_16x16x32_bf16 v[160:163], v[40:43], v[96:99], v[160:163]
    s_xor_b32 s66, s66, 128
    ds_read_b64_tr_b16 v[60:61], v18 offset:8192
    ds_read_b64_tr_b16 v[62:63], v18 offset:9216
    v_mfma_f32_16x16x32_bf16 v[160:163], v[44:47], v[100:103], v[160:163]
    v_add_u32 v18, 0xfffe0000, v18
    v_mfma_f32_16x16x32_bf16 v[164:167], v[40:43], v[104:107], v[164:167]
    v_mfma_f32_16x16x32_bf16 v[164:167], v[44:47], v[108:111], v[164:167]
    v_mfma_f32_16x16x32_bf16 v[168:171], v[40:43], v[112:115], v[168:171]
    v_mfma_f32_16x16x32_bf16 v[168:171], v[44:47], v[116:119], v[168:171]
    v_mfma_f32_16x16x32_bf16 v[172:175], v[40:43], v[120:123], v[172:175]
    ds_read_b64_tr_b16 v[40:41], v19 offset:0
    ds_read_b64_tr_b16 v[42:43], v19 offset:1024
    v_mfma_f32_16x16x32_bf16 v[172:175], v[44:47], v[124:127], v[172:175]
    ds_read_b64_tr_b16 v[44:45], v19 offset:8192
    ds_read_b64_tr_b16 v[46:47], v19 offset:9216
    v_mfma_f32_16x16x32_bf16 v[176:179], v[48:51], v[96:99], v[176:179]
    buffer_load_dwordx4 v11, s[20:23], s64 offen offset:1024 lds
    v_mfma_f32_16x16x32_bf16 v[176:179], v[52:55], v[100:103], v[176:179]
    ds_read_b128 v[72:75], v24 offset:24576
    v_add_u32 v19, 0xfffe0000, v19
    v_mfma_f32_16x16x32_bf16 v[180:183], v[48:51], v[104:107], v[180:183]
    v_mfma_f32_16x16x32_bf16 v[180:183], v[52:55], v[108:111], v[180:183]
    v_mfma_f32_16x16x32_bf16 v[184:187], v[48:51], v[112:115], v[184:187]
    v_mfma_f32_16x16x32_bf16 v[184:187], v[52:55], v[116:119], v[184:187]
    v_mfma_f32_16x16x32_bf16 v[188:191], v[48:51], v[120:123], v[188:191]
    s_add_u32 s72, s70, 5120
    ds_read_b64_tr_b16 v[48:49], v20 offset:0
    ds_read_b64_tr_b16 v[50:51], v20 offset:1024
    v_mfma_f32_16x16x32_bf16 v[188:191], v[52:55], v[124:127], v[188:191]
    s_waitcnt lgkmcnt(2)
    ds_read_b64_tr_b16 v[52:53], v20 offset:8192
    ds_read_b64_tr_b16 v[54:55], v20 offset:9216
    v_mfma_f32_16x16x32_bf16 v[192:195], v[56:59], v[96:99], v[192:195]
    buffer_load_dwordx4 v12, s[20:23], s64 offen offset:2048 lds
    v_mfma_f32_16x16x32_bf16 v[192:195], v[60:63], v[100:103], v[192:195]
    buffer_store_dwordx4 a[12:15], v1, s[36:39], s72 offen sc1
    v_mfma_f32_16x16x32_bf16 v[196:199], v[56:59], v[104:107], v[196:199]
    v_add_u32 v20, 0xfffe0000, v20
    v_accvgpr_write_b32 a12, 0
    v_mfma_f32_16x16x32_bf16 v[196:199], v[60:63], v[108:111], v[196:199]
    ds_read_b128 v[76:79], v25 offset:24576
    v_accvgpr_write_b32 a13, 0
    v_mfma_f32_16x16x32_bf16 v[200:203], v[56:59], v[112:115], v[200:203]
    v_accvgpr_write_b32 a14, 0
    v_accvgpr_write_b32 a15, 0
    v_mfma_f32_16x16x32_bf16 v[200:203], v[60:63], v[116:119], v[200:203]
    v_mfma_f32_16x16x32_bf16 v[204:207], v[56:59], v[120:123], v[204:207]
    ds_read_b64_tr_b16 v[56:57], v21 offset:0
    ds_read_b64_tr_b16 v[58:59], v21 offset:1024
    v_mfma_f32_16x16x32_bf16 v[204:207], v[60:63], v[124:127], v[204:207]
    ds_read_b64_tr_b16 v[60:61], v21 offset:8192
    ds_read_b64_tr_b16 v[62:63], v21 offset:9216
    v_mfma_f32_16x16x32_bf16 v[208:211], v[40:43], v[96:99], v[208:211]
    v_add_u32 v21, 0xfffe0000, v21
    v_mfma_f32_16x16x32_bf16 v[208:211], v[44:47], v[100:103], v[208:211]
    buffer_load_dwordx4 v13, s[20:23], s64 offen offset:3072 lds
    v_mfma_f32_16x16x32_bf16 v[212:215], v[40:43], v[104:107], v[212:215]
    v_mfma_f32_16x16x32_bf16 v[212:215], v[44:47], v[108:111], v[212:215]
    v_mfma_f32_16x16x32_bf16 v[216:219], v[40:43], v[112:115], v[216:219]
    v_mfma_f32_16x16x32_bf16 v[216:219], v[44:47], v[116:119], v[216:219]
    v_mfma_f32_16x16x32_bf16 v[220:223], v[40:43], v[120:123], v[220:223]
    ds_read_b64_tr_b16 v[40:41], v26 offset:0
    ds_read_b64_tr_b16 v[42:43], v26 offset:512
    v_mfma_f32_16x16x32_bf16 v[220:223], v[44:47], v[124:127], v[220:223]
    s_waitcnt lgkmcnt(2)
    ds_read_b64_tr_b16 v[44:45], v26 offset:4096
    ds_read_b64_tr_b16 v[46:47], v26 offset:4608
    v_mfma_f32_16x16x32_bf16 v[224:227], v[48:51], v[96:99], v[224:227]
    v_add_u32 v26, 0x10000, v26
    v_mfma_f32_16x16x32_bf16 v[224:227], v[52:55], v[100:103], v[224:227]
    s_xor_b32 s64, s64, 896
    v_mfma_f32_16x16x32_bf16 v[228:231], v[48:51], v[104:107], v[228:231]
    v_mfma_f32_16x16x32_bf16 v[228:231], v[52:55], v[108:111], v[228:231]
    v_mfma_f32_16x16x32_bf16 v[232:235], v[48:51], v[112:115], v[232:235]
    v_mfma_f32_16x16x32_bf16 v[232:235], v[52:55], v[116:119], v[232:235]
    s_add_u32 m0, s69, 98304
    v_mfma_f32_16x16x32_bf16 v[236:239], v[48:51], v[120:123], v[236:239]
    buffer_load_dwordx4 v2, s[24:27], s60 offen lds
    v_mfma_f32_16x16x32_bf16 v[236:239], v[52:55], v[124:127], v[236:239]
    s_add_u32 s72, s70, 9216
    ds_read_b64_tr_b16 v[48:49], v27 offset:0
    ds_read_b64_tr_b16 v[50:51], v27 offset:512
    v_mfma_f32_16x16x32_bf16 v[240:243], v[56:59], v[96:99], v[240:243]
    ds_read_b64_tr_b16 v[52:53], v27 offset:4096
    ds_read_b64_tr_b16 v[54:55], v27 offset:4608
    v_mfma_f32_16x16x32_bf16 v[240:243], v[60:63], v[100:103], v[240:243]
    buffer_store_dwordx4 a[20:23], v1, s[36:39], s72 offen sc1
    v_mfma_f32_16x16x32_bf16 v[244:247], v[56:59], v[104:107], v[244:247]
    buffer_load_dwordx4 v3, s[24:27], s60 offen offset:1024 lds
    v_mfma_f32_16x16x32_bf16 v[244:247], v[60:63], v[108:111], v[244:247]
    v_add_u32 v27, 0x10000, v27
    v_accvgpr_write_b32 a20, 0
    v_mfma_f32_16x16x32_bf16 v[248:251], v[56:59], v[112:115], v[248:251]
    v_accvgpr_write_b32 a21, 0
    v_accvgpr_write_b32 a22, 0
    v_mfma_f32_16x16x32_bf16 v[248:251], v[60:63], v[116:119], v[248:251]
    v_accvgpr_write_b32 a23, 0
    v_mfma_f32_16x16x32_bf16 v[252:255], v[56:59], v[120:123], v[252:255]
    buffer_load_dwordx4 v4, s[24:27], s60 offen offset:2048 lds
    v_mfma_f32_16x16x32_bf16 v[252:255], v[60:63], v[124:127], v[252:255]
    s_waitcnt lgkmcnt(0)
    ds_read_b64_tr_b16 v[56:57], v28 offset:0
    ds_read_b64_tr_b16 v[58:59], v28 offset:512
    v_mfma_f32_16x16x32_bf16 a[64:67], v[40:43], v[96:99], a[64:67]
    ds_read_b64_tr_b16 v[60:61], v28 offset:4096
    ds_read_b64_tr_b16 v[62:63], v28 offset:4608
    v_mfma_f32_16x16x32_bf16 a[64:67], v[44:47], v[100:103], a[64:67]
    v_add_u32 v24, 0xfffe0000, v24
    v_add_u32 v28, 0x10000, v28
    v_mfma_f32_16x16x32_bf16 a[68:71], v[40:43], v[104:107], a[68:71]
    buffer_load_dwordx4 v5, s[24:27], s60 offen offset:3072 lds
    v_mfma_f32_16x16x32_bf16 a[68:71], v[44:47], v[108:111], a[68:71]
    ds_read_b128 v[80:83], v24 offset:16384
    v_mfma_f32_16x16x32_bf16 a[72:75], v[40:43], v[112:115], a[72:75]
    v_mfma_f32_16x16x32_bf16 a[72:75], v[44:47], v[116:119], a[72:75]
    s_add_u32 m0, s69, 114688
    v_add_u32 v25, 0xfffe0000, v25
    v_mfma_f32_16x16x32_bf16 a[76:79], v[40:43], v[120:123], a[76:79]
    s_xor_b32 s60, s60, 3670016
    buffer_load_dwordx4 v10, s[20:23], s63 offen lds
    v_mfma_f32_16x16x32_bf16 a[76:79], v[44:47], v[124:127], a[76:79]
    ds_read_b128 v[84:87], v25 offset:16384
    v_mfma_f32_16x16x32_bf16 a[128:131], v[40:43], a[136:139], a[128:131]
    ds_read_b64_tr_b16 v[40:41], v29 offset:0
    ds_read_b64_tr_b16 v[42:43], v29 offset:512
    v_mfma_f32_16x16x32_bf16 a[128:131], v[44:47], a[140:143], a[128:131]
    ds_read_b64_tr_b16 v[44:45], v29 offset:4096
    ds_read_b64_tr_b16 v[46:47], v29 offset:4608
    v_mfma_f32_16x16x32_bf16 a[80:83], v[48:51], v[96:99], a[80:83]
    buffer_load_dwordx4 v11, s[20:23], s63 offen offset:1024 lds
    v_mfma_f32_16x16x32_bf16 a[80:83], v[52:55], v[100:103], a[80:83]
    ds_read_b128 v[88:91], v24 offset:24576
    v_add_u32 v29, 0x10000, v29
    v_mfma_f32_16x16x32_bf16 a[84:87], v[48:51], v[104:107], a[84:87]
    v_mfma_f32_16x16x32_bf16 a[84:87], v[52:55], v[108:111], a[84:87]
    v_mfma_f32_16x16x32_bf16 a[88:91], v[48:51], v[112:115], a[88:91]
    buffer_load_dwordx4 v12, s[20:23], s63 offen offset:2048 lds
    v_mfma_f32_16x16x32_bf16 a[88:91], v[52:55], v[116:119], a[88:91]
    ds_read_b128 v[92:95], v25 offset:24576
    v_mfma_f32_16x16x32_bf16 a[92:95], v[48:51], v[120:123], a[92:95]
    s_add_u32 s72, s70, 13312
    v_mfma_f32_16x16x32_bf16 a[92:95], v[52:55], v[124:127], a[92:95]
    v_mfma_f32_16x16x32_bf16 a[132:135], v[48:51], a[136:139], a[132:135]
    buffer_load_dwordx4 v13, s[20:23], s63 offen offset:3072 lds
    v_mfma_f32_16x16x32_bf16 a[132:135], v[52:55], a[140:143], a[132:135]
    s_waitcnt lgkmcnt(1)
    v_mfma_f32_16x16x32_bf16 a[96:99], v[56:59], v[96:99], a[96:99]
    v_mfma_f32_16x16x32_bf16 a[96:99], v[60:63], v[100:103], a[96:99]
    s_xor_b32 s63, s63, 128
    v_mfma_f32_16x16x32_bf16 a[100:103], v[56:59], v[104:107], a[100:103]
    buffer_store_dwordx4 a[28:31], v1, s[36:39], s72 offen sc1
    v_mfma_f32_16x16x32_bf16 a[100:103], v[60:63], v[108:111], a[100:103]
    v_mfma_f32_16x16x32_bf16 a[104:107], v[56:59], v[112:115], a[104:107]
    v_accvgpr_write_b32 a28, 0
    v_accvgpr_write_b32 a29, 0
    v_mfma_f32_16x16x32_bf16 a[104:107], v[60:63], v[116:119], a[104:107]
    s_waitcnt vmcnt(10) lgkmcnt(0)
    s_barrier
    ds_read_b64_tr_b16 v[48:49], v14 offset:32768
    v_mfma_f32_16x16x32_bf16 a[108:111], v[56:59], v[120:123], a[108:111]
    s_add_u32 m0, s67, 131072
    ds_read_b64_tr_b16 v[50:51], v14 offset:33792
    ds_read_b64_tr_b16 v[52:53], v14 offset:40960
    v_mfma_f32_16x16x32_bf16 a[108:111], v[60:63], v[124:127], a[108:111]
    buffer_load_dwordx4 v1, s[28:31], s65 offen sc1 lds
    v_mfma_f32_16x16x32_bf16 a[112:115], v[40:43], v[96:99], a[112:115]
    ds_read_b64_tr_b16 v[54:55], v14 offset:41984
    ds_read_b64_tr_b16 v[56:57], v15 offset:32768
    v_mfma_f32_16x16x32_bf16 a[112:115], v[44:47], v[100:103], a[112:115]
    ds_read_b64_tr_b16 v[58:59], v15 offset:33792
    ds_read_b64_tr_b16 v[60:61], v15 offset:40960
    v_mfma_f32_16x16x32_bf16 a[116:119], v[40:43], v[104:107], a[116:119]
    ds_read_b64_tr_b16 v[62:63], v15 offset:41984
    ds_read_b128 a[136:139], v22 offset:0
    v_mfma_f32_16x16x32_bf16 a[116:119], v[44:47], v[108:111], a[116:119]
    ds_read_b128 a[140:143], v23 offset:0
    v_add_u32 v14, 0x10000, v14
    v_mfma_f32_16x16x32_bf16 a[120:123], v[40:43], v[112:115], a[120:123]
    v_add_u32 v15, 0x10000, v15
    v_add_u32 v22, 0x10000, v22
    v_mfma_f32_16x16x32_bf16 a[120:123], v[44:47], v[116:119], a[120:123]
    v_add_u32 v23, 0x10000, v23
    v_accvgpr_write_b32 a30, 0
    v_mfma_f32_16x16x32_bf16 a[124:127], v[40:43], v[120:123], a[124:127]
    buffer_load_dwordx4 v1, s[28:31], s65 offen offset:1024 sc1 lds
    v_mfma_f32_16x16x32_bf16 a[124:127], v[44:47], v[124:127], a[124:127]
    s_waitcnt lgkmcnt(1)
    ds_read_b64_tr_b16 v[40:41], v16 offset:32768
    ds_read_b64_tr_b16 v[42:43], v16 offset:33792
    v_mfma_f32_16x16x32_bf16 v[128:131], v[48:51], v[64:67], v[128:131]
    ds_read_b64_tr_b16 v[44:45], v16 offset:40960
    ds_read_b64_tr_b16 v[46:47], v16 offset:41984
    v_mfma_f32_16x16x32_bf16 v[128:131], v[52:55], v[68:71], v[128:131]
    v_add_u32 v16, 0x10000, v16
    v_accvgpr_write_b32 a31, 0
    v_mfma_f32_16x16x32_bf16 v[132:135], v[48:51], v[72:75], v[132:135]
    ds_read_b128 v[96:99], v24 offset:49152
    v_mfma_f32_16x16x32_bf16 v[132:135], v[52:55], v[76:79], v[132:135]
    v_mfma_f32_16x16x32_bf16 v[136:139], v[48:51], v[80:83], v[136:139]
    v_mfma_f32_16x16x32_bf16 v[136:139], v[52:55], v[84:87], v[136:139]
    s_add_u32 s72, s70, 33792
    v_mfma_f32_16x16x32_bf16 v[140:143], v[48:51], v[88:91], v[140:143]
    s_add_u32 m0, s68, 139264
    ds_read_b64_tr_b16 v[48:49], v17 offset:32768
    ds_read_b64_tr_b16 v[50:51], v17 offset:33792
    v_mfma_f32_16x16x32_bf16 v[140:143], v[52:55], v[92:95], v[140:143]
    buffer_load_dwordx4 v6, s[20:23], s66 offen lds
    v_mfma_f32_16x16x32_bf16 v[144:147], v[56:59], v[64:67], v[144:147]
    ds_read_b64_tr_b16 v[52:53], v17 offset:40960
    ds_read_b64_tr_b16 v[54:55], v17 offset:41984
    v_mfma_f32_16x16x32_bf16 v[144:147], v[60:63], v[68:71], v[144:147]
    buffer_store_dwordx4 a[36:39], v1, s[36:39], s72 offen sc1
    v_mfma_f32_16x16x32_bf16 v[148:151], v[56:59], v[72:75], v[148:151]
    v_add_u32 v17, 0x10000, v17
    v_accvgpr_write_b32 a36, 0
    v_mfma_f32_16x16x32_bf16 v[148:151], v[60:63], v[76:79], v[148:151]
    v_accvgpr_write_b32 a37, 0
    v_accvgpr_write_b32 a38, 0
    v_mfma_f32_16x16x32_bf16 v[152:155], v[56:59], v[80:83], v[152:155]
    v_accvgpr_write_b32 a39, 0
    v_mfma_f32_16x16x32_bf16 v[152:155], v[60:63], v[84:87], v[152:155]
    ds_read_b128 v[100:103], v25 offset:49152
    v_mfma_f32_16x16x32_bf16 v[156:159], v[56:59], v[88:91], v[156:159]
    s_add_u32 m0, s69, 147456
    ds_read_b64_tr_b16 v[56:57], v18 offset:32768
    ds_read_b64_tr_b16 v[58:59], v18 offset:33792
    v_mfma_f32_16x16x32_bf16 v[156:159], v[60:63], v[92:95], v[156:159]
    s_xor_b32 s65, s65, 57344
    buffer_load_dwordx4 v10, s[20:23], s64 offen lds
    s_waitcnt lgkmcnt(3)
    v_mfma_f32_16x16x32_bf16 v[160:163], v[40:43], v[64:67], v[160:163]
    s_xor_b32 s66, s66, 896
    ds_read_b64_tr_b16 v[60:61], v18 offset:40960
    ds_read_b64_tr_b16 v[62:63], v18 offset:41984
    v_mfma_f32_16x16x32_bf16 v[160:163], v[44:47], v[68:71], v[160:163]
    v_add_u32 v18, 0x10000, v18
    v_mfma_f32_16x16x32_bf16 v[164:167], v[40:43], v[72:75], v[164:167]
    v_mfma_f32_16x16x32_bf16 v[164:167], v[44:47], v[76:79], v[164:167]
    v_mfma_f32_16x16x32_bf16 v[168:171], v[40:43], v[80:83], v[168:171]
    v_mfma_f32_16x16x32_bf16 v[168:171], v[44:47], v[84:87], v[168:171]
    v_mfma_f32_16x16x32_bf16 v[172:175], v[40:43], v[88:91], v[172:175]
    ds_read_b64_tr_b16 v[40:41], v19 offset:32768
    ds_read_b64_tr_b16 v[42:43], v19 offset:33792
    v_mfma_f32_16x16x32_bf16 v[172:175], v[44:47], v[92:95], v[172:175]
    ds_read_b64_tr_b16 v[44:45], v19 offset:40960
    ds_read_b64_tr_b16 v[46:47], v19 offset:41984
    v_mfma_f32_16x16x32_bf16 v[176:179], v[48:51], v[64:67], v[176:179]
    buffer_load_dwordx4 v11, s[20:23], s64 offen offset:1024 lds
    v_mfma_f32_16x16x32_bf16 v[176:179], v[52:55], v[68:71], v[176:179]
    ds_read_b128 v[104:107], v24 offset:57344
    v_add_u32 v19, 0x10000, v19
    v_mfma_f32_16x16x32_bf16 v[180:183], v[48:51], v[72:75], v[180:183]
    v_mfma_f32_16x16x32_bf16 v[180:183], v[52:55], v[76:79], v[180:183]
    v_mfma_f32_16x16x32_bf16 v[184:187], v[48:51], v[80:83], v[184:187]
    v_mfma_f32_16x16x32_bf16 v[184:187], v[52:55], v[84:87], v[184:187]
    v_mfma_f32_16x16x32_bf16 v[188:191], v[48:51], v[88:91], v[188:191]
    s_add_u32 s72, s70, 37888
    ds_read_b64_tr_b16 v[48:49], v20 offset:32768
    ds_read_b64_tr_b16 v[50:51], v20 offset:33792
    v_mfma_f32_16x16x32_bf16 v[188:191], v[52:55], v[92:95], v[188:191]
    s_waitcnt lgkmcnt(2)
    ds_read_b64_tr_b16 v[52:53], v20 offset:40960
    ds_read_b64_tr_b16 v[54:55], v20 offset:41984
    v_mfma_f32_16x16x32_bf16 v[192:195], v[56:59], v[64:67], v[192:195]
    buffer_load_dwordx4 v12, s[20:23], s64 offen offset:2048 lds
    v_mfma_f32_16x16x32_bf16 v[192:195], v[60:63], v[68:71], v[192:195]
    buffer_store_dwordx4 a[44:47], v1, s[36:39], s72 offen sc1
    v_mfma_f32_16x16x32_bf16 v[196:199], v[56:59], v[72:75], v[196:199]
    v_add_u32 v20, 0x10000, v20
    v_accvgpr_write_b32 a44, 0
    v_mfma_f32_16x16x32_bf16 v[196:199], v[60:63], v[76:79], v[196:199]
    ds_read_b128 v[108:111], v25 offset:57344
    v_accvgpr_write_b32 a45, 0
    v_mfma_f32_16x16x32_bf16 v[200:203], v[56:59], v[80:83], v[200:203]
    v_accvgpr_write_b32 a46, 0
    v_accvgpr_write_b32 a47, 0
    v_mfma_f32_16x16x32_bf16 v[200:203], v[60:63], v[84:87], v[200:203]
    v_mfma_f32_16x16x32_bf16 v[204:207], v[56:59], v[88:91], v[204:207]
    ds_read_b64_tr_b16 v[56:57], v21 offset:32768
    ds_read_b64_tr_b16 v[58:59], v21 offset:33792
    v_mfma_f32_16x16x32_bf16 v[204:207], v[60:63], v[92:95], v[204:207]
    ds_read_b64_tr_b16 v[60:61], v21 offset:40960
    ds_read_b64_tr_b16 v[62:63], v21 offset:41984
    v_mfma_f32_16x16x32_bf16 v[208:211], v[40:43], v[64:67], v[208:211]
    v_add_u32 v21, 0x10000, v21
    v_mfma_f32_16x16x32_bf16 v[208:211], v[44:47], v[68:71], v[208:211]
    buffer_load_dwordx4 v13, s[20:23], s64 offen offset:3072 lds
    v_mfma_f32_16x16x32_bf16 v[212:215], v[40:43], v[72:75], v[212:215]
    v_mfma_f32_16x16x32_bf16 v[212:215], v[44:47], v[76:79], v[212:215]
    v_mfma_f32_16x16x32_bf16 v[216:219], v[40:43], v[80:83], v[216:219]
    v_mfma_f32_16x16x32_bf16 v[216:219], v[44:47], v[84:87], v[216:219]
    v_mfma_f32_16x16x32_bf16 v[220:223], v[40:43], v[88:91], v[220:223]
    ds_read_b64_tr_b16 v[40:41], v26 offset:0
    ds_read_b64_tr_b16 v[42:43], v26 offset:512
    v_mfma_f32_16x16x32_bf16 v[220:223], v[44:47], v[92:95], v[220:223]
    s_waitcnt lgkmcnt(2)
    ds_read_b64_tr_b16 v[44:45], v26 offset:4096
    ds_read_b64_tr_b16 v[46:47], v26 offset:4608
    v_mfma_f32_16x16x32_bf16 v[224:227], v[48:51], v[64:67], v[224:227]
    v_add_u32 v26, 0x10000, v26
    v_mfma_f32_16x16x32_bf16 v[224:227], v[52:55], v[68:71], v[224:227]
    s_xor_b32 s64, s64, 128
    v_mfma_f32_16x16x32_bf16 v[228:231], v[48:51], v[72:75], v[228:231]
    v_mfma_f32_16x16x32_bf16 v[228:231], v[52:55], v[76:79], v[228:231]
    v_mfma_f32_16x16x32_bf16 v[232:235], v[48:51], v[80:83], v[232:235]
    v_mfma_f32_16x16x32_bf16 v[232:235], v[52:55], v[84:87], v[232:235]
    s_add_u32 m0, s69, 0
    v_mfma_f32_16x16x32_bf16 v[236:239], v[48:51], v[88:91], v[236:239]
    buffer_load_dwordx4 v2, s[24:27], s60 offen lds
    v_mfma_f32_16x16x32_bf16 v[236:239], v[52:55], v[92:95], v[236:239]
    s_add_u32 s72, s70, 41984
    ds_read_b64_tr_b16 v[48:49], v27 offset:0
    ds_read_b64_tr_b16 v[50:51], v27 offset:512
    v_mfma_f32_16x16x32_bf16 v[240:243], v[56:59], v[64:67], v[240:243]
    ds_read_b64_tr_b16 v[52:53], v27 offset:4096
    ds_read_b64_tr_b16 v[54:55], v27 offset:4608
    v_mfma_f32_16x16x32_bf16 v[240:243], v[60:63], v[68:71], v[240:243]
    buffer_store_dwordx4 a[52:55], v1, s[36:39], s72 offen sc1
    v_mfma_f32_16x16x32_bf16 v[244:247], v[56:59], v[72:75], v[244:247]
    buffer_load_dwordx4 v3, s[24:27], s60 offen offset:1024 lds
    v_mfma_f32_16x16x32_bf16 v[244:247], v[60:63], v[76:79], v[244:247]
    v_add_u32 v27, 0x10000, v27
    v_accvgpr_write_b32 a52, 0
    v_mfma_f32_16x16x32_bf16 v[248:251], v[56:59], v[80:83], v[248:251]
    v_accvgpr_write_b32 a53, 0
    v_accvgpr_write_b32 a54, 0
    v_mfma_f32_16x16x32_bf16 v[248:251], v[60:63], v[84:87], v[248:251]
    v_accvgpr_write_b32 a55, 0
    v_mfma_f32_16x16x32_bf16 v[252:255], v[56:59], v[88:91], v[252:255]
    buffer_load_dwordx4 v4, s[24:27], s60 offen offset:2048 lds
    v_mfma_f32_16x16x32_bf16 v[252:255], v[60:63], v[92:95], v[252:255]
    s_waitcnt lgkmcnt(0)
    ds_read_b64_tr_b16 v[56:57], v28 offset:0
    ds_read_b64_tr_b16 v[58:59], v28 offset:512
    v_mfma_f32_16x16x32_bf16 a[64:67], v[40:43], v[64:67], a[64:67]
    ds_read_b64_tr_b16 v[60:61], v28 offset:4096
    ds_read_b64_tr_b16 v[62:63], v28 offset:4608
    v_mfma_f32_16x16x32_bf16 a[64:67], v[44:47], v[68:71], a[64:67]
    v_add_u32 v24, 0x10000, v24
    v_add_u32 v28, 0x10000, v28
    v_mfma_f32_16x16x32_bf16 a[68:71], v[40:43], v[72:75], a[68:71]
    buffer_load_dwordx4 v5, s[24:27], s60 offen offset:3072 lds
    v_mfma_f32_16x16x32_bf16 a[68:71], v[44:47], v[76:79], a[68:71]
    ds_read_b128 v[112:115], v24 offset:16384
    v_mfma_f32_16x16x32_bf16 a[72:75], v[40:43], v[80:83], a[72:75]
    v_mfma_f32_16x16x32_bf16 a[72:75], v[44:47], v[84:87], a[72:75]
    s_add_u32 m0, s69, 16384
    v_add_u32 v25, 0x10000, v25
    v_mfma_f32_16x16x32_bf16 a[76:79], v[40:43], v[88:91], a[76:79]
    s_xor_b32 s60, s60, 524288
    buffer_load_dwordx4 v10, s[20:23], s63 offen lds
    v_mfma_f32_16x16x32_bf16 a[76:79], v[44:47], v[92:95], a[76:79]
    ds_read_b128 v[116:119], v25 offset:16384
    v_mfma_f32_16x16x32_bf16 a[128:131], v[40:43], a[136:139], a[128:131]
    ds_read_b64_tr_b16 v[40:41], v29 offset:0
    ds_read_b64_tr_b16 v[42:43], v29 offset:512
    v_mfma_f32_16x16x32_bf16 a[128:131], v[44:47], a[140:143], a[128:131]
    ds_read_b64_tr_b16 v[44:45], v29 offset:4096
    ds_read_b64_tr_b16 v[46:47], v29 offset:4608
    v_mfma_f32_16x16x32_bf16 a[80:83], v[48:51], v[64:67], a[80:83]
    buffer_load_dwordx4 v11, s[20:23], s63 offen offset:1024 lds
    v_mfma_f32_16x16x32_bf16 a[80:83], v[52:55], v[68:71], a[80:83]
    ds_read_b128 v[120:123], v24 offset:24576
    v_add_u32 v29, 0x10000, v29
    v_mfma_f32_16x16x32_bf16 a[84:87], v[48:51], v[72:75], a[84:87]
    v_mfma_f32_16x16x32_bf16 a[84:87], v[52:55], v[76:79], a[84:87]
    v_mfma_f32_16x16x32_bf16 a[88:91], v[48:51], v[80:83], a[88:91]
    buffer_load_dwordx4 v12, s[20:23], s63 offen offset:2048 lds
    v_mfma_f32_16x16x32_bf16 a[88:91], v[52:55], v[84:87], a[88:91]
    ds_read_b128 v[124:127], v25 offset:24576
    v_mfma_f32_16x16x32_bf16 a[92:95], v[48:51], v[88:91], a[92:95]
    s_add_u32 s72, s70, 46080
    v_mfma_f32_16x16x32_bf16 a[92:95], v[52:55], v[92:95], a[92:95]
    v_mfma_f32_16x16x32_bf16 a[132:135], v[48:51], a[136:139], a[132:135]
    buffer_load_dwordx4 v13, s[20:23], s63 offen offset:3072 lds
    v_mfma_f32_16x16x32_bf16 a[132:135], v[52:55], a[140:143], a[132:135]
    s_waitcnt lgkmcnt(1)
    v_mfma_f32_16x16x32_bf16 a[96:99], v[56:59], v[64:67], a[96:99]
    v_mfma_f32_16x16x32_bf16 a[96:99], v[60:63], v[68:71], a[96:99]
    s_xor_b32 s63, s63, 384
    v_mfma_f32_16x16x32_bf16 a[100:103], v[56:59], v[72:75], a[100:103]
    buffer_store_dwordx4 a[60:63], v1, s[36:39], s72 offen sc1
    v_mfma_f32_16x16x32_bf16 a[100:103], v[60:63], v[76:79], a[100:103]
    v_mfma_f32_16x16x32_bf16 a[104:107], v[56:59], v[80:83], a[104:107]
    v_accvgpr_write_b32 a60, 0
    v_accvgpr_write_b32 a61, 0
    v_mfma_f32_16x16x32_bf16 a[104:107], v[60:63], v[84:87], a[104:107]
    s_waitcnt vmcnt(10) lgkmcnt(0)
    s_barrier
    ds_read_b64_tr_b16 v[48:49], v14 offset:32768
    v_mfma_f32_16x16x32_bf16 a[108:111], v[56:59], v[88:91], a[108:111]
    s_add_u32 m0, s67, 32768
    ds_read_b64_tr_b16 v[50:51], v14 offset:33792
    ds_read_b64_tr_b16 v[52:53], v14 offset:40960
    v_mfma_f32_16x16x32_bf16 a[108:111], v[60:63], v[92:95], a[108:111]
    buffer_load_dwordx4 v1, s[28:31], s65 offen sc1 lds
    v_mfma_f32_16x16x32_bf16 a[112:115], v[40:43], v[64:67], a[112:115]
    ds_read_b64_tr_b16 v[54:55], v14 offset:41984
    ds_read_b64_tr_b16 v[56:57], v15 offset:32768
    v_mfma_f32_16x16x32_bf16 a[112:115], v[44:47], v[68:71], a[112:115]
    ds_read_b64_tr_b16 v[58:59], v15 offset:33792
    ds_read_b64_tr_b16 v[60:61], v15 offset:40960
    v_mfma_f32_16x16x32_bf16 a[116:119], v[40:43], v[72:75], a[116:119]
    ds_read_b64_tr_b16 v[62:63], v15 offset:41984
    ds_read_b128 a[136:139], v22 offset:0
    v_mfma_f32_16x16x32_bf16 a[116:119], v[44:47], v[76:79], a[116:119]
    ds_read_b128 a[140:143], v23 offset:0
    v_add_u32 v14, 0xffff0000, v14
    v_mfma_f32_16x16x32_bf16 a[120:123], v[40:43], v[80:83], a[120:123]
    v_add_u32 v15, 0xffff0000, v15
    v_add_u32 v22, 0xfffe0000, v22
    v_mfma_f32_16x16x32_bf16 a[120:123], v[44:47], v[84:87], a[120:123]
    v_add_u32 v23, 0xfffe0000, v23
    v_accvgpr_read_b32 v32, a144
    v_mfma_f32_16x16x32_bf16 a[124:127], v[40:43], v[88:91], a[124:127]
    buffer_load_dwordx4 v1, s[28:31], s65 offen offset:1024 sc1 lds
    v_mfma_f32_16x16x32_bf16 a[124:127], v[44:47], v[92:95], a[124:127]
    s_waitcnt lgkmcnt(1)
    ds_read_b64_tr_b16 v[40:41], v16 offset:32768
    ds_read_b64_tr_b16 v[42:43], v16 offset:33792
    v_mfma_f32_16x16x32_bf16 v[128:131], v[48:51], v[96:99], v[128:131]
    ds_read_b64_tr_b16 v[44:45], v16 offset:40960
    ds_read_b64_tr_b16 v[46:47], v16 offset:41984
    v_mfma_f32_16x16x32_bf16 v[128:131], v[52:55], v[100:103], v[128:131]
    v_add_u32 v16, 0xffff0000, v16
    v_accvgpr_read_b32 v31, a145
    v_mfma_f32_16x16x32_bf16 v[132:135], v[48:51], v[104:107], v[132:135]
    ds_read_b128 v[64:67], v24 offset:49152
    v_cvt_pk_bf16_f32 v32, v32, v31
    v_mfma_f32_16x16x32_bf16 v[132:135], v[52:55], v[108:111], v[132:135]
    v_accvgpr_read_b32 v33, a146
    v_accvgpr_read_b32 v31, a147
    v_mfma_f32_16x16x32_bf16 v[136:139], v[48:51], v[112:115], v[136:139]
    v_cvt_pk_bf16_f32 v33, v33, v31
    v_accvgpr_read_b32 v34, a148
    v_mfma_f32_16x16x32_bf16 v[136:139], v[52:55], v[116:119], v[136:139]
    s_add_u32 s72, s71, 32768
    v_accvgpr_read_b32 v31, a149
    v_cvt_pk_bf16_f32 v34, v34, v31
    v_mfma_f32_16x16x32_bf16 v[140:143], v[48:51], v[120:123], v[140:143]
    s_add_u32 m0, s68, 40960
    ds_read_b64_tr_b16 v[48:49], v17 offset:32768
    ds_read_b64_tr_b16 v[50:51], v17 offset:33792
    v_mfma_f32_16x16x32_bf16 v[140:143], v[52:55], v[124:127], v[140:143]
    buffer_load_dwordx4 v6, s[20:23], s66 offen lds
    v_mfma_f32_16x16x32_bf16 v[144:147], v[56:59], v[96:99], v[144:147]
    ds_read_b64_tr_b16 v[52:53], v17 offset:40960
    ds_read_b64_tr_b16 v[54:55], v17 offset:41984
    v_mfma_f32_16x16x32_bf16 v[144:147], v[60:63], v[100:103], v[144:147]
    v_add_u32 v17, 0xffff0000, v17
    v_accvgpr_read_b32 v35, a150
    v_mfma_f32_16x16x32_bf16 v[148:151], v[56:59], v[104:107], v[148:151]
    v_accvgpr_read_b32 v31, a151
    v_cvt_pk_bf16_f32 v35, v35, v31
    v_mfma_f32_16x16x32_bf16 v[148:151], v[60:63], v[108:111], v[148:151]
    buffer_store_dwordx4 v[32:35], v1, s[36:39], s72 offen sc1
    v_mfma_f32_16x16x32_bf16 v[152:155], v[56:59], v[112:115], v[152:155]
    v_accvgpr_write_b32 a62, 0
    v_accvgpr_write_b32 a63, 0
    v_mfma_f32_16x16x32_bf16 v[152:155], v[60:63], v[116:119], v[152:155]
    ds_read_b128 v[68:71], v25 offset:49152
    v_accvgpr_write_b32 a144, 0
    v_mfma_f32_16x16x32_bf16 v[156:159], v[56:59], v[120:123], v[156:159]
    s_add_u32 m0, s69, 49152
    ds_read_b64_tr_b16 v[56:57], v18 offset:32768
    ds_read_b64_tr_b16 v[58:59], v18 offset:33792
    v_mfma_f32_16x16x32_bf16 v[156:159], v[60:63], v[124:127], v[156:159]
    s_xor_b32 s65, s65, 8192
    buffer_load_dwordx4 v10, s[20:23], s64 offen lds
    s_waitcnt lgkmcnt(3)
    v_mfma_f32_16x16x32_bf16 v[160:163], v[40:43], v[96:99], v[160:163]
    s_xor_b32 s66, s66, 128
    ds_read_b64_tr_b16 v[60:61], v18 offset:40960
    ds_read_b64_tr_b16 v[62:63], v18 offset:41984
    v_mfma_f32_16x16x32_bf16 v[160:163], v[44:47], v[100:103], v[160:163]
    v_add_u32 v18, 0xffff0000, v18
    v_accvgpr_write_b32 a145, 0
    v_mfma_f32_16x16x32_bf16 v[164:167], v[40:43], v[104:107], v[164:167]
    v_accvgpr_write_b32 a146, 0
    v_accvgpr_write_b32 a147, 0
    v_mfma_f32_16x16x32_bf16 v[164:167], v[44:47], v[108:111], v[164:167]
    v_accvgpr_read_b32 v32, a152
    v_accvgpr_read_b32 v31, a153
    v_mfma_f32_16x16x32_bf16 v[168:171], v[40:43], v[112:115], v[168:171]
    v_cvt_pk_bf16_f32 v32, v32, v31
    v_accvgpr_read_b32 v33, a154
    v_mfma_f32_16x16x32_bf16 v[168:171], v[44:47], v[116:119], v[168:171]
    v_accvgpr_read_b32 v31, a155
    v_cvt_pk_bf16_f32 v33, v33, v31
    v_mfma_f32_16x16x32_bf16 v[172:175], v[40:43], v[120:123], v[172:175]
    ds_read_b64_tr_b16 v[40:41], v19 offset:32768
    ds_read_b64_tr_b16 v[42:43], v19 offset:33792
    v_mfma_f32_16x16x32_bf16 v[172:175], v[44:47], v[124:127], v[172:175]
    ds_read_b64_tr_b16 v[44:45], v19 offset:40960
    ds_read_b64_tr_b16 v[46:47], v19 offset:41984
    v_mfma_f32_16x16x32_bf16 v[176:179], v[48:51], v[96:99], v[176:179]
    buffer_load_dwordx4 v11, s[20:23], s64 offen offset:1024 lds
    v_mfma_f32_16x16x32_bf16 v[176:179], v[52:55], v[100:103], v[176:179]
    ds_read_b128 v[72:75], v24 offset:57344
    v_add_u32 v19, 0xffff0000, v19
    v_mfma_f32_16x16x32_bf16 v[180:183], v[48:51], v[104:107], v[180:183]
    v_accvgpr_read_b32 v34, a156
    v_accvgpr_read_b32 v31, a157
    v_mfma_f32_16x16x32_bf16 v[180:183], v[52:55], v[108:111], v[180:183]
    v_cvt_pk_bf16_f32 v34, v34, v31
    v_accvgpr_read_b32 v35, a158
    v_mfma_f32_16x16x32_bf16 v[184:187], v[48:51], v[112:115], v[184:187]
    v_accvgpr_read_b32 v31, a159
    v_cvt_pk_bf16_f32 v35, v35, v31
    v_mfma_f32_16x16x32_bf16 v[184:187], v[52:55], v[116:119], v[184:187]
    v_accvgpr_write_b32 a148, 0
    v_accvgpr_write_b32 a149, 0
    v_mfma_f32_16x16x32_bf16 v[188:191], v[48:51], v[120:123], v[188:191]
    s_add_u32 s72, s71, 33792
    ds_read_b64_tr_b16 v[48:49], v20 offset:32768
    ds_read_b64_tr_b16 v[50:51], v20 offset:33792
    v_mfma_f32_16x16x32_bf16 v[188:191], v[52:55], v[124:127], v[188:191]
    s_waitcnt lgkmcnt(2)
    ds_read_b64_tr_b16 v[52:53], v20 offset:40960
    ds_read_b64_tr_b16 v[54:55], v20 offset:41984
    v_mfma_f32_16x16x32_bf16 v[192:195], v[56:59], v[96:99], v[192:195]
    buffer_load_dwordx4 v12, s[20:23], s64 offen offset:2048 lds
    v_mfma_f32_16x16x32_bf16 v[192:195], v[60:63], v[100:103], v[192:195]
    v_add_u32 v20, 0xffff0000, v20
    v_accvgpr_write_b32 a150, 0
    v_mfma_f32_16x16x32_bf16 v[196:199], v[56:59], v[104:107], v[196:199]
    buffer_store_dwordx4 v[32:35], v1, s[36:39], s72 offen sc1
    v_mfma_f32_16x16x32_bf16 v[196:199], v[60:63], v[108:111], v[196:199]
    ds_read_b128 v[76:79], v25 offset:57344
    v_accvgpr_write_b32 a151, 0
    v_mfma_f32_16x16x32_bf16 v[200:203], v[56:59], v[112:115], v[200:203]
    v_accvgpr_write_b32 a152, 0
    v_accvgpr_write_b32 a153, 0
    v_mfma_f32_16x16x32_bf16 v[200:203], v[60:63], v[116:119], v[200:203]
    v_accvgpr_write_b32 a154, 0
    v_accvgpr_write_b32 a155, 0
    v_mfma_f32_16x16x32_bf16 v[204:207], v[56:59], v[120:123], v[204:207]
    ds_read_b64_tr_b16 v[56:57], v21 offset:32768
    ds_read_b64_tr_b16 v[58:59], v21 offset:33792
    v_mfma_f32_16x16x32_bf16 v[204:207], v[60:63], v[124:127], v[204:207]
    ds_read_b64_tr_b16 v[60:61], v21 offset:40960
    ds_read_b64_tr_b16 v[62:63], v21 offset:41984
    v_mfma_f32_16x16x32_bf16 v[208:211], v[40:43], v[96:99], v[208:211]
    v_add_u32 v21, 0xffff0000, v21
    v_accvgpr_write_b32 a156, 0
    v_mfma_f32_16x16x32_bf16 v[208:211], v[44:47], v[100:103], v[208:211]
    buffer_load_dwordx4 v13, s[20:23], s64 offen offset:3072 lds
    v_mfma_f32_16x16x32_bf16 v[212:215], v[40:43], v[104:107], v[212:215]
    v_accvgpr_write_b32 a157, 0
    v_accvgpr_write_b32 a158, 0
    v_mfma_f32_16x16x32_bf16 v[212:215], v[44:47], v[108:111], v[212:215]
    v_accvgpr_write_b32 a159, 0
    v_mfma_f32_16x16x32_bf16 v[216:219], v[40:43], v[112:115], v[216:219]
    v_accvgpr_read_b32 v32, a160
    v_accvgpr_read_b32 v31, a161
    v_mfma_f32_16x16x32_bf16 v[216:219], v[44:47], v[116:119], v[216:219]
    v_cvt_pk_bf16_f32 v32, v32, v31
    v_accvgpr_read_b32 v33, a162
    v_mfma_f32_16x16x32_bf16 v[220:223], v[40:43], v[120:123], v[220:223]
    ds_read_b64_tr_b16 v[40:41], v26 offset:0
    ds_read_b64_tr_b16 v[42:43], v26 offset:512
    v_mfma_f32_16x16x32_bf16 v[220:223], v[44:47], v[124:127], v[220:223]
    s_waitcnt lgkmcnt(2)
    ds_read_b64_tr_b16 v[44:45], v26 offset:4096
    ds_read_b64_tr_b16 v[46:47], v26 offset:4608
    v_mfma_f32_16x16x32_bf16 v[224:227], v[48:51], v[96:99], v[224:227]
    v_add_u32 v26, 0xfffe0000, v26
    v_accvgpr_read_b32 v31, a163
    v_mfma_f32_16x16x32_bf16 v[224:227], v[52:55], v[100:103], v[224:227]
    s_xor_b32 s64, s64, 384
    v_cvt_pk_bf16_f32 v33, v33, v31
    v_accvgpr_read_b32 v34, a164
    v_mfma_f32_16x16x32_bf16 v[228:231], v[48:51], v[104:107], v[228:231]
    v_accvgpr_read_b32 v31, a165
    v_cvt_pk_bf16_f32 v34, v34, v31
    v_mfma_f32_16x16x32_bf16 v[228:231], v[52:55], v[108:111], v[228:231]
    v_accvgpr_read_b32 v35, a166
    v_accvgpr_read_b32 v31, a167
    v_mfma_f32_16x16x32_bf16 v[232:235], v[48:51], v[112:115], v[232:235]
    v_cvt_pk_bf16_f32 v35, v35, v31
    v_accvgpr_write_b32 a160, 0
    v_mfma_f32_16x16x32_bf16 v[232:235], v[52:55], v[116:119], v[232:235]
    s_add_u32 m0, s69, 65536
    v_accvgpr_write_b32 a161, 0
    v_accvgpr_write_b32 a162, 0
    v_mfma_f32_16x16x32_bf16 v[236:239], v[48:51], v[120:123], v[236:239]
    buffer_load_dwordx4 v2, s[24:27], s60 offen lds
    v_mfma_f32_16x16x32_bf16 v[236:239], v[52:55], v[124:127], v[236:239]
    s_add_u32 s72, s71, 2048
    ds_read_b64_tr_b16 v[48:49], v27 offset:0
    ds_read_b64_tr_b16 v[50:51], v27 offset:512
    v_mfma_f32_16x16x32_bf16 v[240:243], v[56:59], v[96:99], v[240:243]
    ds_read_b64_tr_b16 v[52:53], v27 offset:4096
    ds_read_b64_tr_b16 v[54:55], v27 offset:4608
    v_mfma_f32_16x16x32_bf16 v[240:243], v[60:63], v[100:103], v[240:243]
    v_add_u32 v27, 0xfffe0000, v27
    v_accvgpr_write_b32 a163, 0
    v_mfma_f32_16x16x32_bf16 v[244:247], v[56:59], v[104:107], v[244:247]
    buffer_load_dwordx4 v3, s[24:27], s60 offen offset:1024 lds
    v_mfma_f32_16x16x32_bf16 v[244:247], v[60:63], v[108:111], v[244:247]
    buffer_store_dwordx4 v[32:35], v1, s[36:39], s72 offen sc1
    v_mfma_f32_16x16x32_bf16 v[248:251], v[56:59], v[112:115], v[248:251]
    v_accvgpr_write_b32 a164, 0
    v_accvgpr_write_b32 a165, 0
    v_mfma_f32_16x16x32_bf16 v[248:251], v[60:63], v[116:119], v[248:251]
    v_accvgpr_write_b32 a166, 0
    v_accvgpr_write_b32 a167, 0
    v_mfma_f32_16x16x32_bf16 v[252:255], v[56:59], v[120:123], v[252:255]
    buffer_load_dwordx4 v4, s[24:27], s60 offen offset:2048 lds
    v_mfma_f32_16x16x32_bf16 v[252:255], v[60:63], v[124:127], v[252:255]
    s_waitcnt lgkmcnt(0)
    ds_read_b64_tr_b16 v[56:57], v28 offset:0
    ds_read_b64_tr_b16 v[58:59], v28 offset:512
    v_mfma_f32_16x16x32_bf16 a[64:67], v[40:43], v[96:99], a[64:67]
    ds_read_b64_tr_b16 v[60:61], v28 offset:4096
    ds_read_b64_tr_b16 v[62:63], v28 offset:4608
    v_mfma_f32_16x16x32_bf16 a[64:67], v[44:47], v[100:103], a[64:67]
    v_add_u32 v24, 0x10000, v24
    v_add_u32 v28, 0xfffe0000, v28
    v_mfma_f32_16x16x32_bf16 a[68:71], v[40:43], v[104:107], a[68:71]
    buffer_load_dwordx4 v5, s[24:27], s60 offen offset:3072 lds
    v_mfma_f32_16x16x32_bf16 a[68:71], v[44:47], v[108:111], a[68:71]
    ds_read_b128 v[80:83], v24 offset:16384
    v_mfma_f32_16x16x32_bf16 a[72:75], v[40:43], v[112:115], a[72:75]
    v_mfma_f32_16x16x32_bf16 a[72:75], v[44:47], v[116:119], a[72:75]
    s_add_u32 m0, s69, 81920
    v_add_u32 v25, 0x10000, v25
    v_accvgpr_read_b32 v32, a168
    v_mfma_f32_16x16x32_bf16 a[76:79], v[40:43], v[120:123], a[76:79]
    s_xor_b32 s60, s60, 1572864
    buffer_load_dwordx4 v10, s[20:23], s63 offen lds
    v_mfma_f32_16x16x32_bf16 a[76:79], v[44:47], v[124:127], a[76:79]
    ds_read_b128 v[84:87], v25 offset:16384
    v_accvgpr_read_b32 v31, a169
    v_mfma_f32_16x16x32_bf16 a[128:131], v[40:43], a[136:139], a[128:131]
    ds_read_b64_tr_b16 v[40:41], v29 offset:0
    ds_read_b64_tr_b16 v[42:43], v29 offset:512
    v_mfma_f32_16x16x32_bf16 a[128:131], v[44:47], a[140:143], a[128:131]
    ds_read_b64_tr_b16 v[44:45], v29 offset:4096
    ds_read_b64_tr_b16 v[46:47], v29 offset:4608
    v_mfma_f32_16x16x32_bf16 a[80:83], v[48:51], v[96:99], a[80:83]
    buffer_load_dwordx4 v11, s[20:23], s63 offen offset:1024 lds
    v_mfma_f32_16x16x32_bf16 a[80:83], v[52:55], v[100:103], a[80:83]
    ds_read_b128 v[88:91], v24 offset:24576
    v_add_u32 v29, 0xfffe0000, v29
    v_mfma_f32_16x16x32_bf16 a[84:87], v[48:51], v[104:107], a[84:87]
    v_cvt_pk_bf16_f32 v32, v32, v31
    v_accvgpr_read_b32 v33, a170
    v_mfma_f32_16x16x32_bf16 a[84:87], v[52:55], v[108:111], a[84:87]
    v_accvgpr_read_b32 v31, a171
    v_cvt_pk_bf16_f32 v33, v33, v31
    v_mfma_f32_16x16x32_bf16 a[88:91], v[48:51], v[112:115], a[88:91]
    buffer_load_dwordx4 v12, s[20:23], s63 offen offset:2048 lds
    v_mfma_f32_16x16x32_bf16 a[88:91], v[52:55], v[116:119], a[88:91]
    ds_read_b128 v[92:95], v25 offset:24576
    v_accvgpr_read_b32 v34, a172
    v_mfma_f32_16x16x32_bf16 a[92:95], v[48:51], v[120:123], a[92:95]
    s_add_u32 s72, s71, 3072
    v_accvgpr_read_b32 v31, a173
    v_cvt_pk_bf16_f32 v34, v34, v31
    v_mfma_f32_16x16x32_bf16 a[92:95], v[52:55], v[124:127], a[92:95]
    v_accvgpr_read_b32 v35, a174
    v_accvgpr_read_b32 v31, a175
    v_mfma_f32_16x16x32_bf16 a[132:135], v[48:51], a[136:139], a[132:135]
    buffer_load_dwordx4 v13, s[20:23], s63 offen offset:3072 lds
    v_mfma_f32_16x16x32_bf16 a[132:135], v[52:55], a[140:143], a[132:135]
    s_waitcnt lgkmcnt(1)
    v_cvt_pk_bf16_f32 v35, v35, v31
    v_accvgpr_write_b32 a168, 0
    v_mfma_f32_16x16x32_bf16 a[96:99], v[56:59], v[96:99], a[96:99]
    v_accvgpr_write_b32 a169, 0
    v_accvgpr_write_b32 a170, 0
    v_mfma_f32_16x16x32_bf16 a[96:99], v[60:63], v[100:103], a[96:99]
    s_xor_b32 s63, s63, 128
    v_accvgpr_write_b32 a171, 0
    v_accvgpr_write_b32 a172, 0
    v_mfma_f32_16x16x32_bf16 a[100:103], v[56:59], v[104:107], a[100:103]
    buffer_store_dwordx4 v[32:35], v1, s[36:39], s72 offen sc1
    v_mfma_f32_16x16x32_bf16 a[100:103], v[60:63], v[108:111], a[100:103]
    v_accvgpr_write_b32 a173, 0
    v_accvgpr_write_b32 a174, 0
    v_mfma_f32_16x16x32_bf16 a[104:107], v[56:59], v[112:115], a[104:107]
    v_accvgpr_write_b32 a175, 0
    v_mfma_f32_16x16x32_bf16 a[104:107], v[60:63], v[116:119], a[104:107]
    s_waitcnt vmcnt(10) lgkmcnt(0)
    s_barrier
    ds_read_b64_tr_b16 v[48:49], v14 offset:0
    v_mfma_f32_16x16x32_bf16 a[108:111], v[56:59], v[120:123], a[108:111]
    s_add_u32 m0, s67, 98304
    ds_read_b64_tr_b16 v[50:51], v14 offset:1024
    ds_read_b64_tr_b16 v[52:53], v14 offset:8192
    v_mfma_f32_16x16x32_bf16 a[108:111], v[60:63], v[124:127], a[108:111]
    buffer_load_dwordx4 v1, s[28:31], s65 offen sc1 lds
    v_mfma_f32_16x16x32_bf16 a[112:115], v[40:43], v[96:99], a[112:115]
    ds_read_b64_tr_b16 v[54:55], v14 offset:9216
    ds_read_b64_tr_b16 v[56:57], v15 offset:0
    v_mfma_f32_16x16x32_bf16 a[112:115], v[44:47], v[100:103], a[112:115]
    ds_read_b64_tr_b16 v[58:59], v15 offset:1024
    ds_read_b64_tr_b16 v[60:61], v15 offset:8192
    v_mfma_f32_16x16x32_bf16 a[116:119], v[40:43], v[104:107], a[116:119]
    ds_read_b64_tr_b16 v[62:63], v15 offset:9216
    ds_read_b128 a[136:139], v22 offset:32768
    v_mfma_f32_16x16x32_bf16 a[116:119], v[44:47], v[108:111], a[116:119]
    ds_read_b128 a[140:143], v23 offset:32768
    v_add_u32 v14, 0x10000, v14
    v_mfma_f32_16x16x32_bf16 a[120:123], v[40:43], v[112:115], a[120:123]
    v_add_u32 v15, 0x10000, v15
    v_add_u32 v22, 0x10000, v22
    v_mfma_f32_16x16x32_bf16 a[120:123], v[44:47], v[116:119], a[120:123]
    v_add_u32 v23, 0x10000, v23
    v_accvgpr_read_b32 v32, a176
    v_mfma_f32_16x16x32_bf16 a[124:127], v[40:43], v[120:123], a[124:127]
    buffer_load_dwordx4 v1, s[28:31], s65 offen offset:1024 sc1 lds
    v_mfma_f32_16x16x32_bf16 a[124:127], v[44:47], v[124:127], a[124:127]
    s_waitcnt lgkmcnt(1)
    ds_read_b64_tr_b16 v[40:41], v16 offset:0
    ds_read_b64_tr_b16 v[42:43], v16 offset:1024
    v_mfma_f32_16x16x32_bf16 v[128:131], v[48:51], v[64:67], v[128:131]
    ds_read_b64_tr_b16 v[44:45], v16 offset:8192
    ds_read_b64_tr_b16 v[46:47], v16 offset:9216
    v_mfma_f32_16x16x32_bf16 v[128:131], v[52:55], v[68:71], v[128:131]
    v_add_u32 v24, 0xfffe0000, v24
    v_add_u32 v16, 0x10000, v16
    v_mfma_f32_16x16x32_bf16 v[132:135], v[48:51], v[72:75], v[132:135]
    ds_read_b128 v[96:99], v24 offset:16384
    v_accvgpr_read_b32 v31, a177
    v_mfma_f32_16x16x32_bf16 v[132:135], v[52:55], v[76:79], v[132:135]
    v_cvt_pk_bf16_f32 v32, v32, v31
    v_accvgpr_read_b32 v33, a178
    v_mfma_f32_16x16x32_bf16 v[136:139], v[48:51], v[80:83], v[136:139]
    v_accvgpr_read_b32 v31, a179
    v_cvt_pk_bf16_f32 v33, v33, v31
    v_mfma_f32_16x16x32_bf16 v[136:139], v[52:55], v[84:87], v[136:139]
    s_add_u32 s72, s71, 34816
    v_accvgpr_read_b32 v34, a180
    v_accvgpr_read_b32 v31, a181
    v_mfma_f32_16x16x32_bf16 v[140:143], v[48:51], v[88:91], v[140:143]
    s_add_u32 m0, s68, 106496
    ds_read_b64_tr_b16 v[48:49], v17 offset:0
    ds_read_b64_tr_b16 v[50:51], v17 offset:1024
    v_mfma_f32_16x16x32_bf16 v[140:143], v[52:55], v[92:95], v[140:143]
    buffer_load_dwordx4 v6, s[20:23], s66 offen lds
    v_mfma_f32_16x16x32_bf16 v[144:147], v[56:59], v[64:67], v[144:147]
    ds_read_b64_tr_b16 v[52:53], v17 offset:8192
    ds_read_b64_tr_b16 v[54:55], v17 offset:9216
    v_mfma_f32_16x16x32_bf16 v[144:147], v[60:63], v[68:71], v[144:147]
    v_add_u32 v17, 0x10000, v17
    v_cvt_pk_bf16_f32 v34, v34, v31
    v_mfma_f32_16x16x32_bf16 v[148:151], v[56:59], v[72:75], v[148:151]
    v_accvgpr_read_b32 v35, a182
    v_accvgpr_read_b32 v31, a183
    v_mfma_f32_16x16x32_bf16 v[148:151], v[60:63], v[76:79], v[148:151]
    v_cvt_pk_bf16_f32 v35, v35, v31
    v_accvgpr_write_b32 a176, 0
    v_mfma_f32_16x16x32_bf16 v[152:155], v[56:59], v[80:83], v[152:155]
    v_add_u32 v25, 0xfffe0000, v25
    v_accvgpr_write_b32 a177, 0
    v_mfma_f32_16x16x32_bf16 v[152:155], v[60:63], v[84:87], v[152:155]
    ds_read_b128 v[100:103], v25 offset:16384
    v_accvgpr_write_b32 a178, 0
    v_mfma_f32_16x16x32_bf16 v[156:159], v[56:59], v[88:91], v[156:159]
    s_add_u32 m0, s69, 114688
    ds_read_b64_tr_b16 v[56:57], v18 offset:0
    ds_read_b64_tr_b16 v[58:59], v18 offset:1024
    v_mfma_f32_16x16x32_bf16 v[156:159], v[60:63], v[92:95], v[156:159]
    s_xor_b32 s65, s65, 24576
    buffer_load_dwordx4 v10, s[20:23], s64 offen lds
    s_waitcnt lgkmcnt(3)
    v_mfma_f32_16x16x32_bf16 v[160:163], v[40:43], v[64:67], v[160:163]
    s_xor_b32 s66, s66, 384
    ds_read_b64_tr_b16 v[60:61], v18 offset:8192
    ds_read_b64_tr_b16 v[62:63], v18 offset:9216
    v_mfma_f32_16x16x32_bf16 v[160:163], v[44:47], v[68:71], v[160:163]
    v_add_u32 v18, 0x10000, v18
    v_accvgpr_write_b32 a179, 0
    v_mfma_f32_16x16x32_bf16 v[164:167], v[40:43], v[72:75], v[164:167]
    buffer_store_dwordx4 v[32:35], v1, s[36:39], s72 offen sc1
    v_mfma_f32_16x16x32_bf16 v[164:167], v[44:47], v[76:79], v[164:167]
    v_accvgpr_read_b32 v31, a185
    v_accvgpr_read_b32 v32, a184
    v_mfma_f32_16x16x32_bf16 v[168:171], v[40:43], v[80:83], v[168:171]
    v_cvt_pk_bf16_f32 v32, v32, v31
    v_accvgpr_read_b32 v33, a186
    v_mfma_f32_16x16x32_bf16 v[168:171], v[44:47], v[84:87], v[168:171]
    v_accvgpr_read_b32 v31, a187
    v_cvt_pk_bf16_f32 v33, v33, v31
    v_mfma_f32_16x16x32_bf16 v[172:175], v[40:43], v[88:91], v[172:175]
    ds_read_b64_tr_b16 v[40:41], v19 offset:0
    ds_read_b64_tr_b16 v[42:43], v19 offset:1024
    v_mfma_f32_16x16x32_bf16 v[172:175], v[44:47], v[92:95], v[172:175]
    ds_read_b64_tr_b16 v[44:45], v19 offset:8192
    ds_read_b64_tr_b16 v[46:47], v19 offset:9216
    v_mfma_f32_16x16x32_bf16 v[176:179], v[48:51], v[64:67], v[176:179]
    buffer_load_dwordx4 v11, s[20:23], s64 offen offset:1024 lds
    v_mfma_f32_16x16x32_bf16 v[176:179], v[52:55], v[68:71], v[176:179]
    ds_read_b128 v[104:107], v24 offset:24576
    v_add_u32 v19, 0x10000, v19
    v_mfma_f32_16x16x32_bf16 v[180:183], v[48:51], v[72:75], v[180:183]
    v_accvgpr_read_b32 v34, a188
    v_accvgpr_read_b32 v31, a189
    v_mfma_f32_16x16x32_bf16 v[180:183], v[52:55], v[76:79], v[180:183]
    v_cvt_pk_bf16_f32 v34, v34, v31
    v_accvgpr_read_b32 v35, a190
    v_mfma_f32_16x16x32_bf16 v[184:187], v[48:51], v[80:83], v[184:187]
    v_accvgpr_read_b32 v31, a191
    v_cvt_pk_bf16_f32 v35, v35, v31
    v_mfma_f32_16x16x32_bf16 v[184:187], v[52:55], v[84:87], v[184:187]
    v_accvgpr_write_b32 a180, 0
    v_accvgpr_write_b32 a181, 0
    v_mfma_f32_16x16x32_bf16 v[188:191], v[48:51], v[88:91], v[188:191]
    s_add_u32 s72, s71, 35840
    ds_read_b64_tr_b16 v[48:49], v20 offset:0
    ds_read_b64_tr_b16 v[50:51], v20 offset:1024
    v_mfma_f32_16x16x32_bf16 v[188:191], v[52:55], v[92:95], v[188:191]
    s_waitcnt lgkmcnt(2)
    ds_read_b64_tr_b16 v[52:53], v20 offset:8192
    ds_read_b64_tr_b16 v[54:55], v20 offset:9216
    v_mfma_f32_16x16x32_bf16 v[192:195], v[56:59], v[64:67], v[192:195]
    buffer_load_dwordx4 v12, s[20:23], s64 offen offset:2048 lds
    v_mfma_f32_16x16x32_bf16 v[192:195], v[60:63], v[68:71], v[192:195]
    v_add_u32 v20, 0x10000, v20
    v_accvgpr_write_b32 a182, 0
    v_mfma_f32_16x16x32_bf16 v[196:199], v[56:59], v[72:75], v[196:199]
    buffer_store_dwordx4 v[32:35], v1, s[36:39], s72 offen sc1
    v_mfma_f32_16x16x32_bf16 v[196:199], v[60:63], v[76:79], v[196:199]
    ds_read_b128 v[108:111], v25 offset:24576
    v_accvgpr_write_b32 a183, 0
    v_mfma_f32_16x16x32_bf16 v[200:203], v[56:59], v[80:83], v[200:203]
    v_accvgpr_write_b32 a184, 0
    v_accvgpr_write_b32 a185, 0
    v_mfma_f32_16x16x32_bf16 v[200:203], v[60:63], v[84:87], v[200:203]
    v_accvgpr_write_b32 a186, 0
    v_accvgpr_write_b32 a187, 0
    v_mfma_f32_16x16x32_bf16 v[204:207], v[56:59], v[88:91], v[204:207]
    ds_read_b64_tr_b16 v[56:57], v21 offset:0
    ds_read_b64_tr_b16 v[58:59], v21 offset:1024
    v_mfma_f32_16x16x32_bf16 v[204:207], v[60:63], v[92:95], v[204:207]
    ds_read_b64_tr_b16 v[60:61], v21 offset:8192
    ds_read_b64_tr_b16 v[62:63], v21 offset:9216
    v_mfma_f32_16x16x32_bf16 v[208:211], v[40:43], v[64:67], v[208:211]
    v_add_u32 v21, 0x10000, v21
    v_accvgpr_write_b32 a188, 0
    v_mfma_f32_16x16x32_bf16 v[208:211], v[44:47], v[68:71], v[208:211]
    buffer_load_dwordx4 v13, s[20:23], s64 offen offset:3072 lds
    v_mfma_f32_16x16x32_bf16 v[212:215], v[40:43], v[72:75], v[212:215]
    v_accvgpr_write_b32 a189, 0
    v_accvgpr_write_b32 a190, 0
    v_mfma_f32_16x16x32_bf16 v[212:215], v[44:47], v[76:79], v[212:215]
    v_accvgpr_write_b32 a191, 0
    v_mfma_f32_16x16x32_bf16 v[216:219], v[40:43], v[80:83], v[216:219]
    v_accvgpr_read_b32 v32, a192
    v_accvgpr_read_b32 v31, a193
    v_mfma_f32_16x16x32_bf16 v[216:219], v[44:47], v[84:87], v[216:219]
    v_cvt_pk_bf16_f32 v32, v32, v31
    v_accvgpr_read_b32 v33, a194
    v_mfma_f32_16x16x32_bf16 v[220:223], v[40:43], v[88:91], v[220:223]
    ds_read_b64_tr_b16 v[40:41], v26 offset:32768
    ds_read_b64_tr_b16 v[42:43], v26 offset:33280
    v_mfma_f32_16x16x32_bf16 v[220:223], v[44:47], v[92:95], v[220:223]
    s_waitcnt lgkmcnt(2)
    ds_read_b64_tr_b16 v[44:45], v26 offset:36864
    ds_read_b64_tr_b16 v[46:47], v26 offset:37376
    v_mfma_f32_16x16x32_bf16 v[224:227], v[48:51], v[64:67], v[224:227]
    v_add_u32 v26, 0x10000, v26
    v_accvgpr_read_b32 v31, a195
    v_mfma_f32_16x16x32_bf16 v[224:227], v[52:55], v[68:71], v[224:227]
    s_xor_b32 s64, s64, 128
    v_cvt_pk_bf16_f32 v33, v33, v31
    v_accvgpr_read_b32 v34, a196
    v_mfma_f32_16x16x32_bf16 v[228:231], v[48:51], v[72:75], v[228:231]
    v_accvgpr_read_b32 v31, a197
    v_cvt_pk_bf16_f32 v34, v34, v31
    v_mfma_f32_16x16x32_bf16 v[228:231], v[52:55], v[76:79], v[228:231]
    v_accvgpr_read_b32 v35, a198
    v_accvgpr_read_b32 v31, a199
    v_mfma_f32_16x16x32_bf16 v[232:235], v[48:51], v[80:83], v[232:235]
    v_cvt_pk_bf16_f32 v35, v35, v31
    v_accvgpr_write_b32 a192, 0
    v_mfma_f32_16x16x32_bf16 v[232:235], v[52:55], v[84:87], v[232:235]
    s_add_u32 m0, s69, 131072
    v_accvgpr_write_b32 a193, 0
    v_accvgpr_write_b32 a194, 0
    v_mfma_f32_16x16x32_bf16 v[236:239], v[48:51], v[88:91], v[236:239]
    buffer_load_dwordx4 v2, s[24:27], s60 offen lds
    v_mfma_f32_16x16x32_bf16 v[236:239], v[52:55], v[92:95], v[236:239]
    s_add_u32 s72, s71, 4096
    ds_read_b64_tr_b16 v[48:49], v27 offset:32768
    ds_read_b64_tr_b16 v[50:51], v27 offset:33280
    v_mfma_f32_16x16x32_bf16 v[240:243], v[56:59], v[64:67], v[240:243]
    ds_read_b64_tr_b16 v[52:53], v27 offset:36864
    ds_read_b64_tr_b16 v[54:55], v27 offset:37376
    v_mfma_f32_16x16x32_bf16 v[240:243], v[60:63], v[68:71], v[240:243]
    v_add_u32 v27, 0x10000, v27
    v_accvgpr_write_b32 a195, 0
    v_mfma_f32_16x16x32_bf16 v[244:247], v[56:59], v[72:75], v[244:247]
    buffer_load_dwordx4 v3, s[24:27], s60 offen offset:1024 lds
    v_mfma_f32_16x16x32_bf16 v[244:247], v[60:63], v[76:79], v[244:247]
    buffer_store_dwordx4 v[32:35], v1, s[36:39], s72 offen sc1
    v_mfma_f32_16x16x32_bf16 v[248:251], v[56:59], v[80:83], v[248:251]
    v_accvgpr_write_b32 a196, 0
    v_accvgpr_write_b32 a197, 0
    v_mfma_f32_16x16x32_bf16 v[248:251], v[60:63], v[84:87], v[248:251]
    v_accvgpr_write_b32 a198, 0
    v_accvgpr_write_b32 a199, 0
    v_mfma_f32_16x16x32_bf16 v[252:255], v[56:59], v[88:91], v[252:255]
    buffer_load_dwordx4 v4, s[24:27], s60 offen offset:2048 lds
    v_mfma_f32_16x16x32_bf16 v[252:255], v[60:63], v[92:95], v[252:255]
    s_waitcnt lgkmcnt(0)
    ds_read_b64_tr_b16 v[56:57], v28 offset:32768
    ds_read_b64_tr_b16 v[58:59], v28 offset:33280
    v_mfma_f32_16x16x32_bf16 a[64:67], v[40:43], v[64:67], a[64:67]
    ds_read_b64_tr_b16 v[60:61], v28 offset:36864
    ds_read_b64_tr_b16 v[62:63], v28 offset:37376
    v_mfma_f32_16x16x32_bf16 a[64:67], v[44:47], v[68:71], a[64:67]
    v_add_u32 v28, 0x10000, v28
    v_mfma_f32_16x16x32_bf16 a[68:71], v[40:43], v[72:75], a[68:71]
    buffer_load_dwordx4 v5, s[24:27], s60 offen offset:3072 lds
    v_mfma_f32_16x16x32_bf16 a[68:71], v[44:47], v[76:79], a[68:71]
    ds_read_b128 v[112:115], v24 offset:49152
    v_mfma_f32_16x16x32_bf16 a[72:75], v[40:43], v[80:83], a[72:75]
    v_mfma_f32_16x16x32_bf16 a[72:75], v[44:47], v[84:87], a[72:75]
    s_add_u32 m0, s69, 147456
    v_accvgpr_read_b32 v32, a200
    v_accvgpr_read_b32 v31, a201
    v_mfma_f32_16x16x32_bf16 a[76:79], v[40:43], v[88:91], a[76:79]
    s_xor_b32 s60, s60, 524288
    buffer_load_dwordx4 v10, s[20:23], s63 offen lds
    v_mfma_f32_16x16x32_bf16 a[76:79], v[44:47], v[92:95], a[76:79]
    ds_read_b128 v[116:119], v25 offset:49152
    v_cvt_pk_bf16_f32 v32, v32, v31
    v_mfma_f32_16x16x32_bf16 a[128:131], v[40:43], a[136:139], a[128:131]
    ds_read_b64_tr_b16 v[40:41], v29 offset:32768
    ds_read_b64_tr_b16 v[42:43], v29 offset:33280
    v_mfma_f32_16x16x32_bf16 a[128:131], v[44:47], a[140:143], a[128:131]
    ds_read_b64_tr_b16 v[44:45], v29 offset:36864
    ds_read_b64_tr_b16 v[46:47], v29 offset:37376
    v_mfma_f32_16x16x32_bf16 a[80:83], v[48:51], v[64:67], a[80:83]
    buffer_load_dwordx4 v11, s[20:23], s63 offen offset:1024 lds
    v_mfma_f32_16x16x32_bf16 a[80:83], v[52:55], v[68:71], a[80:83]
    ds_read_b128 v[120:123], v24 offset:57344
    v_add_u32 v29, 0x10000, v29
    v_mfma_f32_16x16x32_bf16 a[84:87], v[48:51], v[72:75], a[84:87]
    v_accvgpr_read_b32 v33, a202
    v_accvgpr_read_b32 v31, a203
    v_mfma_f32_16x16x32_bf16 a[84:87], v[52:55], v[76:79], a[84:87]
    v_cvt_pk_bf16_f32 v33, v33, v31
    v_accvgpr_read_b32 v34, a204
    v_mfma_f32_16x16x32_bf16 a[88:91], v[48:51], v[80:83], a[88:91]
    buffer_load_dwordx4 v12, s[20:23], s63 offen offset:2048 lds
    v_mfma_f32_16x16x32_bf16 a[88:91], v[52:55], v[84:87], a[88:91]
    ds_read_b128 v[124:127], v25 offset:57344
    v_accvgpr_read_b32 v31, a205
    v_mfma_f32_16x16x32_bf16 a[92:95], v[48:51], v[88:91], a[92:95]
    s_add_u32 s72, s71, 5120
    v_cvt_pk_bf16_f32 v34, v34, v31
    v_accvgpr_read_b32 v35, a206
    v_mfma_f32_16x16x32_bf16 a[92:95], v[52:55], v[92:95], a[92:95]
    v_accvgpr_read_b32 v31, a207
    v_cvt_pk_bf16_f32 v35, v35, v31
    v_mfma_f32_16x16x32_bf16 a[132:135], v[48:51], a[136:139], a[132:135]
    buffer_load_dwordx4 v13, s[20:23], s63 offen offset:3072 lds
    v_mfma_f32_16x16x32_bf16 a[132:135], v[52:55], a[140:143], a[132:135]
    s_waitcnt lgkmcnt(1)
    v_accvgpr_write_b32 a200, 0
    v_accvgpr_write_b32 a201, 0
    v_mfma_f32_16x16x32_bf16 a[96:99], v[56:59], v[64:67], a[96:99]
    v_accvgpr_write_b32 a202, 0
    v_accvgpr_write_b32 a203, 0
    v_mfma_f32_16x16x32_bf16 a[96:99], v[60:63], v[68:71], a[96:99]
    s_xor_b32 s63, s63, 1920
    v_accvgpr_write_b32 a204, 0
    v_accvgpr_write_b32 a205, 0
    v_mfma_f32_16x16x32_bf16 a[100:103], v[56:59], v[72:75], a[100:103]
    s_andn2_b32 s63, s63, 896
    buffer_store_dwordx4 v[32:35], v1, s[36:39], s72 offen sc1
    v_mfma_f32_16x16x32_bf16 a[100:103], v[60:63], v[76:79], a[100:103]
    v_accvgpr_write_b32 a206, 0
    v_accvgpr_write_b32 a207, 0
    v_mfma_f32_16x16x32_bf16 a[104:107], v[56:59], v[80:83], a[104:107]
    v_mfma_f32_16x16x32_bf16 a[104:107], v[60:63], v[84:87], a[104:107]
    s_waitcnt vmcnt(10) lgkmcnt(0)
    s_barrier
    ds_read_b64_tr_b16 v[48:49], v14 offset:0
    v_mfma_f32_16x16x32_bf16 a[108:111], v[56:59], v[88:91], a[108:111]
    s_add_u32 m0, s67, 0
    ds_read_b64_tr_b16 v[50:51], v14 offset:1024
    ds_read_b64_tr_b16 v[52:53], v14 offset:8192
    v_mfma_f32_16x16x32_bf16 a[108:111], v[60:63], v[92:95], a[108:111]
    buffer_load_dwordx4 v1, s[28:31], s65 offen sc1 lds
    v_mfma_f32_16x16x32_bf16 a[112:115], v[40:43], v[64:67], a[112:115]
    ds_read_b64_tr_b16 v[54:55], v14 offset:9216
    ds_read_b64_tr_b16 v[56:57], v15 offset:0
    v_mfma_f32_16x16x32_bf16 a[112:115], v[44:47], v[68:71], a[112:115]
    ds_read_b64_tr_b16 v[58:59], v15 offset:1024
    ds_read_b64_tr_b16 v[60:61], v15 offset:8192
    v_mfma_f32_16x16x32_bf16 a[116:119], v[40:43], v[72:75], a[116:119]
    ds_read_b64_tr_b16 v[62:63], v15 offset:9216
    ds_read_b128 a[136:139], v22 offset:32768
    v_mfma_f32_16x16x32_bf16 a[116:119], v[44:47], v[76:79], a[116:119]
    ds_read_b128 a[140:143], v23 offset:32768
    v_add_u32 v14, 0x10000, v14
    v_mfma_f32_16x16x32_bf16 a[120:123], v[40:43], v[80:83], a[120:123]
    v_add_u32 v15, 0x10000, v15
    v_add_u32 v22, 0xffff0000, v22
    v_mfma_f32_16x16x32_bf16 a[120:123], v[44:47], v[84:87], a[120:123]
    v_add_u32 v23, 0xffff0000, v23
    v_accvgpr_read_b32 v32, a208
    v_mfma_f32_16x16x32_bf16 a[124:127], v[40:43], v[88:91], a[124:127]
    buffer_load_dwordx4 v1, s[28:31], s65 offen offset:1024 sc1 lds
    v_mfma_f32_16x16x32_bf16 a[124:127], v[44:47], v[92:95], a[124:127]
    s_waitcnt lgkmcnt(1)
    ds_read_b64_tr_b16 v[40:41], v16 offset:0
    ds_read_b64_tr_b16 v[42:43], v16 offset:1024
    v_mfma_f32_16x16x32_bf16 v[128:131], v[48:51], v[96:99], v[128:131]
    ds_read_b64_tr_b16 v[44:45], v16 offset:8192
    ds_read_b64_tr_b16 v[46:47], v16 offset:9216
    v_mfma_f32_16x16x32_bf16 v[128:131], v[52:55], v[100:103], v[128:131]
    v_add_u32 v24, 0x10000, v24
    v_add_u32 v16, 0x10000, v16
    v_mfma_f32_16x16x32_bf16 v[132:135], v[48:51], v[104:107], v[132:135]
    ds_read_b128 v[64:67], v24 offset:16384
    v_accvgpr_read_b32 v31, a209
    v_mfma_f32_16x16x32_bf16 v[132:135], v[52:55], v[108:111], v[132:135]
    v_cvt_pk_bf16_f32 v32, v32, v31
    v_accvgpr_read_b32 v33, a210
    v_mfma_f32_16x16x32_bf16 v[136:139], v[48:51], v[112:115], v[136:139]
    v_accvgpr_read_b32 v31, a211
    v_cvt_pk_bf16_f32 v33, v33, v31
    v_mfma_f32_16x16x32_bf16 v[136:139], v[52:55], v[116:119], v[136:139]
    s_add_u32 s72, s71, 36864
    v_accvgpr_read_b32 v34, a212
    v_accvgpr_read_b32 v31, a213
    v_mfma_f32_16x16x32_bf16 v[140:143], v[48:51], v[120:123], v[140:143]
    s_add_u32 m0, s68, 8192
    ds_read_b64_tr_b16 v[48:49], v17 offset:0
    ds_read_b64_tr_b16 v[50:51], v17 offset:1024
    v_mfma_f32_16x16x32_bf16 v[140:143], v[52:55], v[124:127], v[140:143]
    buffer_load_dwordx4 v6, s[20:23], s66 offen lds
    v_mfma_f32_16x16x32_bf16 v[144:147], v[56:59], v[96:99], v[144:147]
    ds_read_b64_tr_b16 v[52:53], v17 offset:8192
    ds_read_b64_tr_b16 v[54:55], v17 offset:9216
    v_mfma_f32_16x16x32_bf16 v[144:147], v[60:63], v[100:103], v[144:147]
    v_add_u32 v17, 0x10000, v17
    v_cvt_pk_bf16_f32 v34, v34, v31
    v_mfma_f32_16x16x32_bf16 v[148:151], v[56:59], v[104:107], v[148:151]
    v_accvgpr_read_b32 v35, a214
    v_accvgpr_read_b32 v31, a215
    v_mfma_f32_16x16x32_bf16 v[148:151], v[60:63], v[108:111], v[148:151]
    v_cvt_pk_bf16_f32 v35, v35, v31
    v_accvgpr_write_b32 a208, 0
    v_mfma_f32_16x16x32_bf16 v[152:155], v[56:59], v[112:115], v[152:155]
    v_add_u32 v25, 0x10000, v25
    v_accvgpr_write_b32 a209, 0
    v_mfma_f32_16x16x32_bf16 v[152:155], v[60:63], v[116:119], v[152:155]
    ds_read_b128 v[68:71], v25 offset:16384
    v_accvgpr_write_b32 a210, 0
    v_mfma_f32_16x16x32_bf16 v[156:159], v[56:59], v[120:123], v[156:159]
    s_add_u32 m0, s69, 16384
    ds_read_b64_tr_b16 v[56:57], v18 offset:0
    ds_read_b64_tr_b16 v[58:59], v18 offset:1024
    v_mfma_f32_16x16x32_bf16 v[156:159], v[60:63], v[124:127], v[156:159]
    s_xor_b32 s65, s65, 8192
    buffer_load_dwordx4 v10, s[20:23], s64 offen lds
    s_waitcnt lgkmcnt(3)
    v_mfma_f32_16x16x32_bf16 v[160:163], v[40:43], v[96:99], v[160:163]
    s_xor_b32 s66, s66, 128
    ds_read_b64_tr_b16 v[60:61], v18 offset:8192
    ds_read_b64_tr_b16 v[62:63], v18 offset:9216
    v_mfma_f32_16x16x32_bf16 v[160:163], v[44:47], v[100:103], v[160:163]
    v_add_u32 v18, 0x10000, v18
    v_accvgpr_write_b32 a211, 0
    v_mfma_f32_16x16x32_bf16 v[164:167], v[40:43], v[104:107], v[164:167]
    buffer_store_dwordx4 v[32:35], v1, s[36:39], s72 offen sc1
    v_mfma_f32_16x16x32_bf16 v[164:167], v[44:47], v[108:111], v[164:167]
    v_accvgpr_read_b32 v31, a217
    v_accvgpr_read_b32 v32, a216
    v_mfma_f32_16x16x32_bf16 v[168:171], v[40:43], v[112:115], v[168:171]
    v_cvt_pk_bf16_f32 v32, v32, v31
    v_accvgpr_read_b32 v33, a218
    v_mfma_f32_16x16x32_bf16 v[168:171], v[44:47], v[116:119], v[168:171]
    v_accvgpr_read_b32 v31, a219
    v_cvt_pk_bf16_f32 v33, v33, v31
    v_mfma_f32_16x16x32_bf16 v[172:175], v[40:43], v[120:123], v[172:175]
    ds_read_b64_tr_b16 v[40:41], v19 offset:0
    ds_read_b64_tr_b16 v[42:43], v19 offset:1024
    v_mfma_f32_16x16x32_bf16 v[172:175], v[44:47], v[124:127], v[172:175]
    ds_read_b64_tr_b16 v[44:45], v19 offset:8192
    ds_read_b64_tr_b16 v[46:47], v19 offset:9216
    v_mfma_f32_16x16x32_bf16 v[176:179], v[48:51], v[96:99], v[176:179]
    buffer_load_dwordx4 v11, s[20:23], s64 offen offset:1024 lds
    v_mfma_f32_16x16x32_bf16 v[176:179], v[52:55], v[100:103], v[176:179]
    ds_read_b128 v[72:75], v24 offset:24576
    v_add_u32 v19, 0x10000, v19
    v_mfma_f32_16x16x32_bf16 v[180:183], v[48:51], v[104:107], v[180:183]
    v_accvgpr_read_b32 v34, a220
    v_accvgpr_read_b32 v31, a221
    v_mfma_f32_16x16x32_bf16 v[180:183], v[52:55], v[108:111], v[180:183]
    v_cvt_pk_bf16_f32 v34, v34, v31
    v_accvgpr_read_b32 v35, a222
    v_mfma_f32_16x16x32_bf16 v[184:187], v[48:51], v[112:115], v[184:187]
    v_accvgpr_read_b32 v31, a223
    v_cvt_pk_bf16_f32 v35, v35, v31
    v_mfma_f32_16x16x32_bf16 v[184:187], v[52:55], v[116:119], v[184:187]
    v_accvgpr_write_b32 a212, 0
    v_accvgpr_write_b32 a213, 0
    v_mfma_f32_16x16x32_bf16 v[188:191], v[48:51], v[120:123], v[188:191]
    s_add_u32 s72, s71, 37888
    ds_read_b64_tr_b16 v[48:49], v20 offset:0
    ds_read_b64_tr_b16 v[50:51], v20 offset:1024
    v_mfma_f32_16x16x32_bf16 v[188:191], v[52:55], v[124:127], v[188:191]
    s_waitcnt lgkmcnt(2)
    ds_read_b64_tr_b16 v[52:53], v20 offset:8192
    ds_read_b64_tr_b16 v[54:55], v20 offset:9216
    v_mfma_f32_16x16x32_bf16 v[192:195], v[56:59], v[96:99], v[192:195]
    buffer_load_dwordx4 v12, s[20:23], s64 offen offset:2048 lds
    v_mfma_f32_16x16x32_bf16 v[192:195], v[60:63], v[100:103], v[192:195]
    v_add_u32 v20, 0x10000, v20
    v_accvgpr_write_b32 a214, 0
    v_mfma_f32_16x16x32_bf16 v[196:199], v[56:59], v[104:107], v[196:199]
    buffer_store_dwordx4 v[32:35], v1, s[36:39], s72 offen sc1
    v_mfma_f32_16x16x32_bf16 v[196:199], v[60:63], v[108:111], v[196:199]
    ds_read_b128 v[76:79], v25 offset:24576
    v_accvgpr_write_b32 a215, 0
    v_mfma_f32_16x16x32_bf16 v[200:203], v[56:59], v[112:115], v[200:203]
    v_accvgpr_write_b32 a216, 0
    v_accvgpr_write_b32 a217, 0
    v_mfma_f32_16x16x32_bf16 v[200:203], v[60:63], v[116:119], v[200:203]
    v_accvgpr_write_b32 a218, 0
    v_accvgpr_write_b32 a219, 0
    v_mfma_f32_16x16x32_bf16 v[204:207], v[56:59], v[120:123], v[204:207]
    ds_read_b64_tr_b16 v[56:57], v21 offset:0
    ds_read_b64_tr_b16 v[58:59], v21 offset:1024
    v_mfma_f32_16x16x32_bf16 v[204:207], v[60:63], v[124:127], v[204:207]
    ds_read_b64_tr_b16 v[60:61], v21 offset:8192
    ds_read_b64_tr_b16 v[62:63], v21 offset:9216
    v_mfma_f32_16x16x32_bf16 v[208:211], v[40:43], v[96:99], v[208:211]
    v_add_u32 v21, 0x10000, v21
    v_accvgpr_write_b32 a220, 0
    v_mfma_f32_16x16x32_bf16 v[208:211], v[44:47], v[100:103], v[208:211]
    buffer_load_dwordx4 v13, s[20:23], s64 offen offset:3072 lds
    v_mfma_f32_16x16x32_bf16 v[212:215], v[40:43], v[104:107], v[212:215]
    v_accvgpr_write_b32 a221, 0
    v_accvgpr_write_b32 a222, 0
    v_mfma_f32_16x16x32_bf16 v[212:215], v[44:47], v[108:111], v[212:215]
    v_accvgpr_write_b32 a223, 0
    v_mfma_f32_16x16x32_bf16 v[216:219], v[40:43], v[112:115], v[216:219]
    v_accvgpr_read_b32 v32, a224
    v_accvgpr_read_b32 v31, a225
    v_mfma_f32_16x16x32_bf16 v[216:219], v[44:47], v[116:119], v[216:219]
    v_cvt_pk_bf16_f32 v32, v32, v31
    v_accvgpr_read_b32 v33, a226
    v_mfma_f32_16x16x32_bf16 v[220:223], v[40:43], v[120:123], v[220:223]
    ds_read_b64_tr_b16 v[40:41], v26 offset:32768
    ds_read_b64_tr_b16 v[42:43], v26 offset:33280
    v_mfma_f32_16x16x32_bf16 v[220:223], v[44:47], v[124:127], v[220:223]
    s_waitcnt lgkmcnt(2)
    ds_read_b64_tr_b16 v[44:45], v26 offset:36864
    ds_read_b64_tr_b16 v[46:47], v26 offset:37376
    v_mfma_f32_16x16x32_bf16 v[224:227], v[48:51], v[96:99], v[224:227]
    v_add_u32 v26, 0xffff0000, v26
    v_accvgpr_read_b32 v31, a227
    v_mfma_f32_16x16x32_bf16 v[224:227], v[52:55], v[100:103], v[224:227]
    s_xor_b32 s64, s64, 1920
    v_cvt_pk_bf16_f32 v33, v33, v31
    v_accvgpr_read_b32 v34, a228
    v_mfma_f32_16x16x32_bf16 v[228:231], v[48:51], v[104:107], v[228:231]
    s_andn2_b32 s64, s64, 896
    v_accvgpr_read_b32 v31, a229
    v_cvt_pk_bf16_f32 v34, v34, v31
    v_mfma_f32_16x16x32_bf16 v[228:231], v[52:55], v[108:111], v[228:231]
    v_accvgpr_read_b32 v35, a230
    v_accvgpr_read_b32 v31, a231
    v_mfma_f32_16x16x32_bf16 v[232:235], v[48:51], v[112:115], v[232:235]
    v_cvt_pk_bf16_f32 v35, v35, v31
    v_mfma_f32_16x16x32_bf16 v[232:235], v[52:55], v[116:119], v[232:235]
    s_add_u32 m0, s69, 32768
    v_mfma_f32_16x16x32_bf16 v[236:239], v[48:51], v[120:123], v[236:239]
    buffer_load_dwordx4 v2, s[24:27], s60 offen lds
    v_mfma_f32_16x16x32_bf16 v[236:239], v[52:55], v[124:127], v[236:239]
    s_add_u32 s72, s71, 6144
    ds_read_b64_tr_b16 v[48:49], v27 offset:32768
    ds_read_b64_tr_b16 v[50:51], v27 offset:33280
    v_mfma_f32_16x16x32_bf16 v[240:243], v[56:59], v[96:99], v[240:243]
    ds_read_b64_tr_b16 v[52:53], v27 offset:36864
    ds_read_b64_tr_b16 v[54:55], v27 offset:37376
    v_mfma_f32_16x16x32_bf16 v[240:243], v[60:63], v[100:103], v[240:243]
    buffer_store_dwordx4 v[32:35], v1, s[36:39], s72 offen sc1
    v_mfma_f32_16x16x32_bf16 v[244:247], v[56:59], v[104:107], v[244:247]
    buffer_load_dwordx4 v3, s[24:27], s60 offen offset:1024 lds
    v_mfma_f32_16x16x32_bf16 v[244:247], v[60:63], v[108:111], v[244:247]
    v_add_u32 v27, 0xffff0000, v27
    v_mfma_f32_16x16x32_bf16 v[248:251], v[56:59], v[112:115], v[248:251]
    v_mfma_f32_16x16x32_bf16 v[248:251], v[60:63], v[116:119], v[248:251]
    v_mfma_f32_16x16x32_bf16 v[252:255], v[56:59], v[120:123], v[252:255]
    buffer_load_dwordx4 v4, s[24:27], s60 offen offset:2048 lds
    v_mfma_f32_16x16x32_bf16 v[252:255], v[60:63], v[124:127], v[252:255]
    s_waitcnt lgkmcnt(0)
    ds_read_b64_tr_b16 v[56:57], v28 offset:32768
    ds_read_b64_tr_b16 v[58:59], v28 offset:33280
    v_mfma_f32_16x16x32_bf16 a[64:67], v[40:43], v[96:99], a[64:67]
    ds_read_b64_tr_b16 v[60:61], v28 offset:36864
    ds_read_b64_tr_b16 v[62:63], v28 offset:37376
    v_mfma_f32_16x16x32_bf16 a[64:67], v[44:47], v[100:103], a[64:67]
    v_add_u32 v28, 0xffff0000, v28
    v_mfma_f32_16x16x32_bf16 a[68:71], v[40:43], v[104:107], a[68:71]
    buffer_load_dwordx4 v5, s[24:27], s60 offen offset:3072 lds
    v_mfma_f32_16x16x32_bf16 a[68:71], v[44:47], v[108:111], a[68:71]
    ds_read_b128 v[80:83], v24 offset:49152
    v_mfma_f32_16x16x32_bf16 a[72:75], v[40:43], v[112:115], a[72:75]
    v_mfma_f32_16x16x32_bf16 a[72:75], v[44:47], v[116:119], a[72:75]
    s_xor_b32 s60, s60, 7864320
    v_accvgpr_read_b32 v32, a232
    v_accvgpr_read_b32 v31, a233
    v_mfma_f32_16x16x32_bf16 a[76:79], v[40:43], v[120:123], a[76:79]
    s_add_u32 m0, s69, 49152
    ds_read_b128 v[84:87], v25 offset:49152
    v_cvt_pk_bf16_f32 v32, v32, v31
    v_mfma_f32_16x16x32_bf16 a[76:79], v[44:47], v[124:127], a[76:79]
    s_andn2_b32 s60, s60, 3670016
    buffer_load_dwordx4 v10, s[20:23], s63 offen lds
    v_mfma_f32_16x16x32_bf16 a[128:131], v[40:43], a[136:139], a[128:131]
    ds_read_b64_tr_b16 v[40:41], v29 offset:32768
    ds_read_b64_tr_b16 v[42:43], v29 offset:33280
    v_mfma_f32_16x16x32_bf16 a[128:131], v[44:47], a[140:143], a[128:131]
    ds_read_b64_tr_b16 v[44:45], v29 offset:36864
    ds_read_b64_tr_b16 v[46:47], v29 offset:37376
    v_mfma_f32_16x16x32_bf16 a[80:83], v[48:51], v[96:99], a[80:83]
    buffer_load_dwordx4 v11, s[20:23], s63 offen offset:1024 lds
    v_mfma_f32_16x16x32_bf16 a[80:83], v[52:55], v[100:103], a[80:83]
    ds_read_b128 v[88:91], v24 offset:57344
    v_add_u32 v29, 0xffff0000, v29
    v_mfma_f32_16x16x32_bf16 a[84:87], v[48:51], v[104:107], a[84:87]
    v_accvgpr_read_b32 v33, a234
    v_accvgpr_read_b32 v31, a235
    v_mfma_f32_16x16x32_bf16 a[84:87], v[52:55], v[108:111], a[84:87]
    v_cvt_pk_bf16_f32 v33, v33, v31
    v_accvgpr_read_b32 v34, a236
    v_mfma_f32_16x16x32_bf16 a[88:91], v[48:51], v[112:115], a[88:91]
    buffer_load_dwordx4 v12, s[20:23], s63 offen offset:2048 lds
    v_mfma_f32_16x16x32_bf16 a[88:91], v[52:55], v[116:119], a[88:91]
    ds_read_b128 v[92:95], v25 offset:57344
    v_accvgpr_read_b32 v31, a237
    v_mfma_f32_16x16x32_bf16 a[92:95], v[48:51], v[120:123], a[92:95]
    s_add_u32 s72, s71, 7168
    v_cvt_pk_bf16_f32 v34, v34, v31
    v_accvgpr_read_b32 v35, a238
    v_mfma_f32_16x16x32_bf16 a[92:95], v[52:55], v[124:127], a[92:95]
    v_accvgpr_read_b32 v31, a239
    v_cvt_pk_bf16_f32 v35, v35, v31
    v_mfma_f32_16x16x32_bf16 a[132:135], v[48:51], a[136:139], a[132:135]
    buffer_load_dwordx4 v13, s[20:23], s63 offen offset:3072 lds
    v_mfma_f32_16x16x32_bf16 a[132:135], v[52:55], a[140:143], a[132:135]
    s_waitcnt lgkmcnt(1)
    v_mfma_f32_16x16x32_bf16 a[96:99], v[56:59], v[96:99], a[96:99]
    v_mfma_f32_16x16x32_bf16 a[96:99], v[60:63], v[100:103], a[96:99]
    s_xor_b32 s63, s63, 128
    v_mfma_f32_16x16x32_bf16 a[100:103], v[56:59], v[104:107], a[100:103]
    buffer_store_dwordx4 v[32:35], v1, s[36:39], s72 offen sc1
    v_mfma_f32_16x16x32_bf16 a[100:103], v[60:63], v[108:111], a[100:103]
    v_mfma_f32_16x16x32_bf16 a[104:107], v[56:59], v[112:115], a[104:107]
    v_mfma_f32_16x16x32_bf16 a[104:107], v[60:63], v[116:119], a[104:107]
    s_waitcnt vmcnt(10) lgkmcnt(0)
    s_barrier
    ds_read_b64_tr_b16 v[48:49], v14 offset:0
    v_mfma_f32_16x16x32_bf16 a[108:111], v[56:59], v[120:123], a[108:111]
    s_add_u32 m0, s69, 65536
    ds_read_b64_tr_b16 v[50:51], v14 offset:1024
    ds_read_b64_tr_b16 v[52:53], v14 offset:8192
    v_mfma_f32_16x16x32_bf16 a[108:111], v[60:63], v[124:127], a[108:111]
    buffer_load_dwordx4 v2, s[24:27], s60 offen lds
    v_mfma_f32_16x16x32_bf16 a[112:115], v[40:43], v[96:99], a[112:115]
    ds_read_b64_tr_b16 v[54:55], v14 offset:9216
    ds_read_b64_tr_b16 v[56:57], v15 offset:0
    v_mfma_f32_16x16x32_bf16 a[112:115], v[44:47], v[100:103], a[112:115]
    ds_read_b64_tr_b16 v[58:59], v15 offset:1024
    ds_read_b64_tr_b16 v[60:61], v15 offset:8192
    v_mfma_f32_16x16x32_bf16 a[116:119], v[40:43], v[104:107], a[116:119]
    ds_read_b64_tr_b16 v[62:63], v15 offset:9216
    ds_read_b128 a[136:139], v22 offset:0
    v_mfma_f32_16x16x32_bf16 a[116:119], v[44:47], v[108:111], a[116:119]
    ds_read_b128 a[140:143], v23 offset:0
    v_add_u32 v14, 0xfffe0000, v14
    v_mfma_f32_16x16x32_bf16 a[120:123], v[40:43], v[112:115], a[120:123]
    v_add_u32 v15, 0xfffe0000, v15
    v_add_u32 v22, 0x10000, v22
    v_mfma_f32_16x16x32_bf16 a[120:123], v[44:47], v[116:119], a[120:123]
    buffer_load_dwordx4 v3, s[24:27], s60 offen offset:1024 lds
    v_mfma_f32_16x16x32_bf16 a[124:127], v[40:43], v[120:123], a[124:127]
    ds_read_b64_tr_b16 v[40:41], v16 offset:0
    ds_read_b64_tr_b16 v[42:43], v16 offset:1024
    v_mfma_f32_16x16x32_bf16 a[124:127], v[44:47], v[124:127], a[124:127]
    s_waitcnt lgkmcnt(3)
    ds_read_b64_tr_b16 v[44:45], v16 offset:8192
    ds_read_b64_tr_b16 v[46:47], v16 offset:9216
    v_mfma_f32_16x16x32_bf16 v[128:131], v[48:51], v[64:67], v[128:131]
    v_add_u32 v16, 0xfffe0000, v16
    v_add_u32 v23, 0x10000, v23
    v_mfma_f32_16x16x32_bf16 v[128:131], v[52:55], v[68:71], v[128:131]
    v_add_u32 v24, 0x10000, v24
    v_accvgpr_read_b32 v32, a240
    v_mfma_f32_16x16x32_bf16 v[132:135], v[48:51], v[72:75], v[132:135]
    ds_read_b128 v[96:99], v24 offset:16384
    v_accvgpr_read_b32 v31, a241
    v_mfma_f32_16x16x32_bf16 v[132:135], v[52:55], v[76:79], v[132:135]
    v_cvt_pk_bf16_f32 v32, v32, v31
    v_accvgpr_read_b32 v33, a242
    v_mfma_f32_16x16x32_bf16 v[136:139], v[48:51], v[80:83], v[136:139]
    v_accvgpr_read_b32 v31, a243
    v_cvt_pk_bf16_f32 v33, v33, v31
    v_mfma_f32_16x16x32_bf16 v[136:139], v[52:55], v[84:87], v[136:139]
    s_add_u32 s72, s71, 38912
    buffer_load_dwordx4 v4, s[24:27], s60 offen offset:2048 lds
    v_mfma_f32_16x16x32_bf16 v[140:143], v[48:51], v[88:91], v[140:143]
    ds_read_b64_tr_b16 v[48:49], v17 offset:0
    ds_read_b64_tr_b16 v[50:51], v17 offset:1024
    v_mfma_f32_16x16x32_bf16 v[140:143], v[52:55], v[92:95], v[140:143]
    ds_read_b64_tr_b16 v[52:53], v17 offset:8192
    ds_read_b64_tr_b16 v[54:55], v17 offset:9216
    v_mfma_f32_16x16x32_bf16 v[144:147], v[56:59], v[64:67], v[144:147]
    v_add_u32 v17, 0xfffe0000, v17
    v_accvgpr_read_b32 v34, a244
    v_mfma_f32_16x16x32_bf16 v[144:147], v[60:63], v[68:71], v[144:147]
    v_accvgpr_read_b32 v31, a245
    v_cvt_pk_bf16_f32 v34, v34, v31
    v_mfma_f32_16x16x32_bf16 v[148:151], v[56:59], v[72:75], v[148:151]
    v_accvgpr_read_b32 v35, a246
    v_accvgpr_read_b32 v31, a247
    v_mfma_f32_16x16x32_bf16 v[148:151], v[60:63], v[76:79], v[148:151]
    v_cvt_pk_bf16_f32 v35, v35, v31
    v_mov_b32 v2, v1
    v_mfma_f32_16x16x32_bf16 v[152:155], v[56:59], v[80:83], v[152:155]
    buffer_load_dwordx4 v5, s[24:27], s60 offen offset:3072 lds
    v_mfma_f32_16x16x32_bf16 v[152:155], v[60:63], v[84:87], v[152:155]
    v_add_u32 v25, 0x10000, v25
    ds_read_b128 v[100:103], v25 offset:16384
    v_mfma_f32_16x16x32_bf16 v[156:159], v[56:59], v[88:91], v[156:159]
    ds_read_b64_tr_b16 v[56:57], v18 offset:0
    ds_read_b64_tr_b16 v[58:59], v18 offset:1024
    v_mfma_f32_16x16x32_bf16 v[156:159], v[60:63], v[92:95], v[156:159]
    s_waitcnt lgkmcnt(3)
    ds_read_b64_tr_b16 v[60:61], v18 offset:8192
    ds_read_b64_tr_b16 v[62:63], v18 offset:9216
    v_mfma_f32_16x16x32_bf16 v[160:163], v[40:43], v[64:67], v[160:163]
    buffer_store_dwordx4 v[32:35], v1, s[36:39], s72 offen sc1
    v_mfma_f32_16x16x32_bf16 v[160:163], v[44:47], v[68:71], v[160:163]
    v_add_u32 v18, 0xfffe0000, v18
    v_mfma_f32_16x16x32_bf16 v[164:167], v[40:43], v[72:75], v[164:167]
    v_mfma_f32_16x16x32_bf16 v[164:167], v[44:47], v[76:79], v[164:167]
    s_add_u32 m0, s69, 81920
    v_accvgpr_read_b32 v32, a248
    v_accvgpr_read_b32 v31, a249
    v_mfma_f32_16x16x32_bf16 v[168:171], v[40:43], v[80:83], v[168:171]
    s_xor_b32 s60, s60, 524288
    buffer_load_dwordx4 v10, s[20:23], s64 offen lds
    v_mfma_f32_16x16x32_bf16 v[168:171], v[44:47], v[84:87], v[168:171]
    s_mov_b32 s60, 131072
    v_cvt_pk_bf16_f32 v32, v32, v31
    v_accvgpr_read_b32 v33, a250
    v_mfma_f32_16x16x32_bf16 v[172:175], v[40:43], v[88:91], v[172:175]
    ds_read_b64_tr_b16 v[40:41], v19 offset:0
    ds_read_b64_tr_b16 v[42:43], v19 offset:1024
    v_mfma_f32_16x16x32_bf16 v[172:175], v[44:47], v[92:95], v[172:175]
    ds_read_b64_tr_b16 v[44:45], v19 offset:8192
    ds_read_b64_tr_b16 v[46:47], v19 offset:9216
    v_mfma_f32_16x16x32_bf16 v[176:179], v[48:51], v[64:67], v[176:179]
    ds_read_b128 v[104:107], v24 offset:24576
    v_add_u32 v19, 0xfffe0000, v19
    v_mfma_f32_16x16x32_bf16 v[176:179], v[52:55], v[68:71], v[176:179]
    v_accvgpr_read_b32 v31, a251
    v_cvt_pk_bf16_f32 v33, v33, v31
    v_mfma_f32_16x16x32_bf16 v[180:183], v[48:51], v[72:75], v[180:183]
    v_accvgpr_read_b32 v34, a252
    v_accvgpr_read_b32 v31, a253
    v_mfma_f32_16x16x32_bf16 v[180:183], v[52:55], v[76:79], v[180:183]
    buffer_load_dwordx4 v11, s[20:23], s64 offen offset:1024 lds
    v_mfma_f32_16x16x32_bf16 v[184:187], v[48:51], v[80:83], v[184:187]
    v_cvt_pk_bf16_f32 v34, v34, v31
    v_accvgpr_read_b32 v35, a254
    v_mfma_f32_16x16x32_bf16 v[184:187], v[52:55], v[84:87], v[184:187]
    v_accvgpr_read_b32 v31, a255
    v_cvt_pk_bf16_f32 v35, v35, v31
    v_mfma_f32_16x16x32_bf16 v[188:191], v[48:51], v[88:91], v[188:191]
    s_add_u32 s72, s71, 39936
    ds_read_b64_tr_b16 v[48:49], v20 offset:0
    ds_read_b64_tr_b16 v[50:51], v20 offset:1024
    v_mfma_f32_16x16x32_bf16 v[188:191], v[52:55], v[92:95], v[188:191]
    s_waitcnt lgkmcnt(2)
    ds_read_b64_tr_b16 v[52:53], v20 offset:8192
    ds_read_b64_tr_b16 v[54:55], v20 offset:9216
    v_mfma_f32_16x16x32_bf16 v[192:195], v[56:59], v[64:67], v[192:195]
    v_mov_b32 v31, 1
    v_add_u32 v20, 0xfffe0000, v20
    v_mfma_f32_16x16x32_bf16 v[192:195], v[60:63], v[68:71], v[192:195]
    buffer_store_dwordx4 v[32:35], v1, s[36:39], s72 offen sc1
    v_mfma_f32_16x16x32_bf16 v[196:199], v[56:59], v[72:75], v[196:199]
    v_add_u32 v11, s99, v39
    v_mfma_f32_16x16x32_bf16 v[196:199], v[60:63], v[76:79], v[196:199]
    s_mul_i32 s99, s98, 6
    buffer_load_dwordx4 v12, s[20:23], s64 offen offset:2048 lds
    v_mfma_f32_16x16x32_bf16 v[200:203], v[56:59], v[80:83], v[200:203]
    s_sub_u32 s99, s8, s99
    ds_read_b128 v[108:111], v25 offset:24576
    v_mfma_f32_16x16x32_bf16 v[200:203], v[60:63], v[84:87], v[200:203]
    s_mul_i32 s99, s99, 6
    v_mfma_f32_16x16x32_bf16 v[204:207], v[56:59], v[88:91], v[204:207]
    s_lshr_b32 s8, s5, 3
    ds_read_b64_tr_b16 v[56:57], v21 offset:0
    ds_read_b64_tr_b16 v[58:59], v21 offset:1024
    v_mfma_f32_16x16x32_bf16 v[204:207], v[60:63], v[92:95], v[204:207]
    s_lshl1_add_u32 s99, s4, s99
    ds_read_b64_tr_b16 v[60:61], v21 offset:8192
    ds_read_b64_tr_b16 v[62:63], v21 offset:9216
    v_mfma_f32_16x16x32_bf16 v[208:211], v[40:43], v[64:67], v[208:211]
    s_mul_i32 s8, s8, 6
    v_add_u32 v21, 0xfffe0000, v21
    v_mfma_f32_16x16x32_bf16 v[208:211], v[44:47], v[68:71], v[208:211]
    s_cmp_lt_u32 s98, 6
    s_cselect_b32 s98, s98, 40
    v_mfma_f32_16x16x32_bf16 v[212:215], v[40:43], v[72:75], v[212:215]
    s_sub_u32 s99, s99, 2
    buffer_load_dwordx4 v13, s[20:23], s64 offen offset:3072 lds
    v_mfma_f32_16x16x32_bf16 v[212:215], v[44:47], v[76:79], v[212:215]
    s_add_u32 s98, s98, s8
    v_mfma_f32_16x16x32_bf16 v[216:219], v[40:43], v[80:83], v[216:219]
    s_lshl_b32 s8, s99, 5
    v_lshl_add_u32 v10, v38, 4, s8
    v_lshrrev_b32 v38, 2, v37
    v_mfma_f32_16x16x32_bf16 v[216:219], v[44:47], v[84:87], v[216:219]
    s_lshr_b32 s99, s99, 1
    v_lshl_add_u32 v38, s98, 2, v38
    v_mul_u32_u24 v39, 171, v38
    v_mfma_f32_16x16x32_bf16 v[220:223], v[40:43], v[88:91], v[220:223]
    s_add_u32 s98, s98, 128
    ds_read_b64_tr_b16 v[40:41], v26 offset:0
    ds_read_b64_tr_b16 v[42:43], v26 offset:512
    v_mfma_f32_16x16x32_bf16 v[220:223], v[44:47], v[92:95], v[220:223]
    s_add_u32 s8, s100, 16
    ds_read_b64_tr_b16 v[44:45], v26 offset:4096
    ds_read_b64_tr_b16 v[46:47], v26 offset:4608
    s_waitcnt lgkmcnt(4)
    v_mfma_f32_16x16x32_bf16 v[224:227], v[48:51], v[64:67], v[224:227]
    v_add_u32 v26, 0x10000, v26
    v_and_b32 v37, 3, v37
    v_mfma_f32_16x16x32_bf16 v[224:227], v[52:55], v[68:71], v[224:227]
    s_xor_b32 s64, s64, 128
    v_lshrrev_b32 v39, 9, v39
    v_lshl_add_u32 v37, v38, 3, v37
    v_mfma_f32_16x16x32_bf16 v[228:231], v[48:51], v[72:75], v[228:231]
    v_mul_u32_u24 v38, 24, v39
    v_sub_u32 v37, v37, v38
    v_mfma_f32_16x16x32_bf16 v[228:231], v[52:55], v[76:79], v[228:231]
    v_mad_u32_u24 v39, v39, 18, v37
    v_mul_u32_u24 v39, 1152, v39
    v_mfma_f32_16x16x32_bf16 v[232:235], v[48:51], v[80:83], v[232:235]
    v_add_u32 v39, v39, v10
    v_add_u32 v12, 0, v39
    v_mfma_f32_16x16x32_bf16 v[232:235], v[52:55], v[84:87], v[232:235]
    s_add_u32 m0, s67, 98304
    v_mov_b32 v38, 1073741824
    v_cmp_gt_u32 vcc, 18, v37
    v_mfma_f32_16x16x32_bf16 v[236:239], v[48:51], v[88:91], v[236:239]
    buffer_load_dwordx4 v1, s[28:31], s65 offen sc1 lds
    v_mfma_f32_16x16x32_bf16 v[236:239], v[52:55], v[92:95], v[236:239]
    ds_read_b64_tr_b16 v[48:49], v27 offset:0
    ds_read_b64_tr_b16 v[50:51], v27 offset:512
    v_mfma_f32_16x16x32_bf16 v[240:243], v[56:59], v[64:67], v[240:243]
    ds_read_b64_tr_b16 v[52:53], v27 offset:4096
    ds_read_b64_tr_b16 v[54:55], v27 offset:4608
    v_mfma_f32_16x16x32_bf16 v[240:243], v[60:63], v[68:71], v[240:243]
    v_add_u32 v27, 0x10000, v27
    v_cndmask_b32 v12, v38, v12, vcc
    v_mfma_f32_16x16x32_bf16 v[244:247], v[56:59], v[72:75], v[244:247]
    v_add_u32 v38, 1024, v36
    v_add_u32 v13, 4608, v39
    v_mfma_f32_16x16x32_bf16 v[244:247], v[60:63], v[76:79], v[244:247]
    s_cmp_eq_u32 s4, 0
    s_cselect_b64 vcc, -1, 0
    v_cndmask_b32 v12, v12, v38, vcc
    v_mfma_f32_16x16x32_bf16 v[248:251], v[56:59], v[80:83], v[248:251]
    v_mov_b32 v38, 1073741824
    v_cmp_gt_u32 vcc, 14, v37
    v_mfma_f32_16x16x32_bf16 v[248:251], v[60:63], v[84:87], v[248:251]
    v_lshrrev_b32 v37, 8, v1
    v_cndmask_b32 v13, v38, v13, vcc
    v_mfma_f32_16x16x32_bf16 v[252:255], v[56:59], v[88:91], v[252:255]
    ds_read_b64_tr_b16 v[56:57], v28 offset:0
    ds_read_b64_tr_b16 v[58:59], v28 offset:512
    v_mfma_f32_16x16x32_bf16 v[252:255], v[60:63], v[92:95], v[252:255]
    s_waitcnt lgkmcnt(2)
    ds_read_b64_tr_b16 v[60:61], v28 offset:4096
    ds_read_b64_tr_b16 v[62:63], v28 offset:4608
    v_mfma_f32_16x16x32_bf16 a[64:67], v[40:43], v[64:67], a[64:67]
    buffer_load_dwordx4 v1, s[28:31], s65 offen offset:1024 sc1 lds
    v_mfma_f32_16x16x32_bf16 a[64:67], v[44:47], v[68:71], a[64:67]
    v_add_u32 v24, 0xfffe0000, v24
    v_add_u32 v28, 0x10000, v28
    v_mfma_f32_16x16x32_bf16 a[68:71], v[40:43], v[72:75], a[68:71]
    ds_read_b128 v[112:115], v24 offset:16384
    v_add_u32 v38, 19456, v36
    v_mfma_f32_16x16x32_bf16 a[68:71], v[44:47], v[76:79], a[68:71]
    s_cmp_eq_u32 s4, 0
    s_cselect_b64 vcc, -1, 0
    v_cndmask_b32 v13, v13, v38, vcc
    v_mfma_f32_16x16x32_bf16 a[72:75], v[40:43], v[80:83], a[72:75]
    s_cmp_eq_u32 s4, 0
    s_cselect_b32 s98, s7, s98
    s_cselect_b32 s99, s8, s99
    v_mfma_f32_16x16x32_bf16 a[72:75], v[44:47], v[84:87], a[72:75]
    s_lshr_b32 s9, s99, 2
    v_add_u32 v25, 0xfffe0000, v25
    v_bfe_u32 v36, v1, 4, 4
    v_mfma_f32_16x16x32_bf16 a[76:79], v[40:43], v[88:91], a[76:79]
    s_lshr_b32 s92, s2, 3
    ds_read_b128 v[116:119], v25 offset:16384
    v_lshrrev_b32 v9, 4, v1
    v_mfma_f32_16x16x32_bf16 a[76:79], v[44:47], v[92:95], a[76:79]
    s_lshl2_add_u32 s92, s92, s4
    v_min_u32 v9, 0, v9
    v_lshlrev_b32 v37, 2, v37
    v_mfma_f32_16x16x32_bf16 a[128:131], v[40:43], a[136:139], a[128:131]
    s_mul_i32 s92, s92, 1
    ds_read_b64_tr_b16 v[40:41], v29 offset:0
    ds_read_b64_tr_b16 v[42:43], v29 offset:512
    v_mfma_f32_16x16x32_bf16 a[128:131], v[44:47], a[140:143], a[128:131]
    s_add_u32 s92, s92, 32
    v_add_lshl_u32 v9, v9, s92, 7
    ds_read_b64_tr_b16 v[44:45], v29 offset:4096
    v_mfma_f32_16x16x32_bf16 a[80:83], v[48:51], v[64:67], a[80:83]
    s_add_u32 m0, s68, 106496
    ds_read_b128 v[120:123], v24 offset:24576
    ds_read_b64_tr_b16 v[46:47], v29 offset:4608
    v_mfma_f32_16x16x32_bf16 a[80:83], v[52:55], v[68:71], a[80:83]
    s_getpc_b64 s[92:93]
    global_load_dword v9, v9, s[92:93]
    v_mfma_f32_16x16x32_bf16 a[84:87], v[48:51], v[72:75], a[84:87]
    s_sub_u32 s9, s9, s10
    buffer_load_dwordx4 v6, s[20:23], s66 offen lds
    v_mfma_f32_16x16x32_bf16 a[84:87], v[52:55], v[76:79], a[84:87]
    s_sub_u32 s9, s9, 1
    v_add_u32 v29, 0x10000, v29
    v_sub_u32 v36, v36, v37
    v_mfma_f32_16x16x32_bf16 a[88:91], v[48:51], v[80:83], a[88:91]
    s_and_b32 s9, s9, 3
    ds_read_b128 v[124:127], v25 offset:24576
    v_mov_b32 v37, 0xf149f2ca
    v_mfma_f32_16x16x32_bf16 a[88:91], v[52:55], v[84:87], a[88:91]
    s_lshl_b32 s9, s9, 1
    v_bfe_u32 v38, v1, 4, 2
    v_and_b32 v39, 0x40, v1
    v_mfma_f32_16x16x32_bf16 a[92:95], v[48:51], v[88:91], a[92:95]
    s_and_b32 s10, s99, 3
    v_mfma_f32_16x16x32_bf16 a[92:95], v[52:55], v[92:95], a[92:95]
    s_cmp_eq_u32 s9, 6
    s_cselect_b32 s9, 7, s9
    v_mfma_f32_16x16x32_bf16 a[132:135], v[48:51], a[136:139], a[132:135]
    s_mul_i32 s10, s10, 9
    v_mfma_f32_16x16x32_bf16 a[132:135], v[52:55], a[140:143], a[132:135]
    s_add_u32 s9, s9, s10
    s_waitcnt lgkmcnt(0)
    v_mfma_f32_16x16x32_bf16 a[96:99], v[56:59], v[64:67], a[96:99]
    s_lshl_b32 s64, s9, 10
    v_mfma_f32_16x16x32_bf16 a[96:99], v[60:63], v[68:71], a[96:99]
    s_xor_b32 s65, s65, 122880
    v_mfma_f32_16x16x32_bf16 a[100:103], v[56:59], v[72:75], a[100:103]
    s_xor_b32 s66, s66, 1920
    v_mfma_f32_16x16x32_bf16 a[100:103], v[60:63], v[76:79], a[100:103]
    s_andn2_b32 s65, s65, 57344
    v_mfma_f32_16x16x32_bf16 a[104:107], v[56:59], v[80:83], a[104:107]
    s_andn2_b32 s66, s66, 896
    v_mfma_f32_16x16x32_bf16 a[104:107], v[60:63], v[84:87], a[104:107]
    s_waitcnt vmcnt(4) lgkmcnt(0)
    s_barrier
    ds_read_b64_tr_b16 v[48:49], v14 offset:32768
    v_mfma_f32_16x16x32_bf16 a[108:111], v[56:59], v[88:91], a[108:111]
    s_add_u32 m0, s67, 131072
    buffer_store_dword v31, v30, s[32:35], s101 offen sc1
    v_mfma_f32_16x16x32_bf16 a[108:111], v[60:63], v[92:95], a[108:111]
    s_sub_u32 s9, s99, 16
    buffer_load_dwordx4 v1, s[28:31], s65 offen sc1 lds
    v_mfma_f32_16x16x32_bf16 a[112:115], v[40:43], v[64:67], a[112:115]
    s_mul_i32 s9, s9, 18432
    ds_read_b64_tr_b16 v[50:51], v14 offset:33792
    ds_read_b64_tr_b16 v[52:53], v14 offset:40960
    v_mfma_f32_16x16x32_bf16 a[112:115], v[44:47], v[68:71], a[112:115]
    s_add_u32 s9, s9, 6144
    ds_read_b64_tr_b16 v[54:55], v14 offset:41984
    ds_read_b64_tr_b16 v[56:57], v15 offset:32768
    v_mfma_f32_16x16x32_bf16 a[116:119], v[40:43], v[72:75], a[116:119]
    s_mov_b32 s10, 1024
    ds_read_b64_tr_b16 v[58:59], v15 offset:33792
    ds_read_b64_tr_b16 v[60:61], v15 offset:40960
    v_mfma_f32_16x16x32_bf16 a[116:119], v[44:47], v[76:79], a[116:119]
    s_mul_i32 s98, s98, 36864
    ds_read_b64_tr_b16 v[62:63], v15 offset:41984
    v_add_u32 v14, 0x10000, v14
    v_mfma_f32_16x16x32_bf16 a[120:123], v[40:43], v[80:83], a[120:123]
    s_mul_i32 s7, s7, 36864
    v_add_u32 v15, 0x10000, v15
    v_mfma_f32_16x16x32_bf16 a[120:123], v[44:47], v[84:87], a[120:123]
    s_cmp_lt_u32 s99, 16
    s_cselect_b32 s64, s64, s9
    s_cselect_b32 s10, s10, 9216
    v_mfma_f32_16x16x32_bf16 a[124:127], v[40:43], v[88:91], a[124:127]
    s_lshl2_add_u32 s99, s100, s4
    ds_read_b64_tr_b16 v[40:41], v16 offset:32768
    ds_read_b64_tr_b16 v[42:43], v16 offset:33792
    v_mfma_f32_16x16x32_bf16 a[124:127], v[44:47], v[92:95], a[124:127]
    s_add_u32 s64, s64, s98
    ds_read_b64_tr_b16 v[44:45], v16 offset:40960
    ds_read_b64_tr_b16 v[46:47], v16 offset:41984
    s_waitcnt lgkmcnt(5)
    v_mfma_f32_16x16x32_bf16 v[128:131], v[48:51], v[96:99], v[128:131]
    s_lshl_b32 s99, s99, 1
    v_add_u32 v16, 0x10000, v16
    v_mfma_f32_16x16x32_bf16 v[128:131], v[52:55], v[100:103], v[128:131]
    s_add_u32 s62, s64, s10
    v_mfma_f32_16x16x32_bf16 v[132:135], v[48:51], v[104:107], v[132:135]
    s_lshr_b32 s9, s99, 2
    ds_read_b128 v[64:67], v24 offset:49152
    v_mfma_f32_16x16x32_bf16 v[132:135], v[52:55], v[108:111], v[132:135]
    s_lshr_b32 s10, s5, 3
    v_mfma_f32_16x16x32_bf16 v[136:139], v[48:51], v[112:115], v[136:139]
    s_sub_u32 s9, s9, s10
    v_mfma_f32_16x16x32_bf16 v[136:139], v[52:55], v[116:119], v[136:139]
    s_sub_u32 s9, s9, 1
    v_mfma_f32_16x16x32_bf16 v[140:143], v[48:51], v[120:123], v[140:143]
    s_and_b32 s9, s9, 3
    ds_read_b64_tr_b16 v[48:49], v17 offset:32768
    ds_read_b64_tr_b16 v[50:51], v17 offset:33792
    v_mfma_f32_16x16x32_bf16 v[140:143], v[52:55], v[124:127], v[140:143]
    s_lshl_b32 s9, s9, 1
    ds_read_b64_tr_b16 v[52:53], v17 offset:40960
    ds_read_b64_tr_b16 v[54:55], v17 offset:41984
    v_mfma_f32_16x16x32_bf16 v[144:147], v[56:59], v[96:99], v[144:147]
    s_and_b32 s10, s99, 3
    ds_read_b128 v[68:71], v25 offset:49152
    v_add_u32 v17, 0x10000, v17
    s_waitcnt lgkmcnt(5)
    v_mfma_f32_16x16x32_bf16 v[144:147], v[60:63], v[100:103], v[144:147]
    s_cmp_eq_u32 s9, 6
    s_cselect_b32 s9, 7, s9
    v_mfma_f32_16x16x32_bf16 v[148:151], v[56:59], v[104:107], v[148:151]
    s_mul_i32 s10, s10, 9
    buffer_load_dwordx4 v1, s[28:31], s65 offen offset:1024 sc1 lds
    v_mfma_f32_16x16x32_bf16 v[148:151], v[60:63], v[108:111], v[148:151]
    s_add_u32 s9, s9, s10
    v_mfma_f32_16x16x32_bf16 v[152:155], v[56:59], v[112:115], v[152:155]
    s_lshl_b32 s63, s9, 10
    v_mfma_f32_16x16x32_bf16 v[152:155], v[60:63], v[116:119], v[152:155]
    s_cmp_eq_u32 s4, 0
    s_cselect_b32 s8, 1.0, 0
    v_mfma_f32_16x16x32_bf16 v[156:159], v[56:59], v[120:123], v[156:159]
    s_add_u32 s63, s63, s7
    ds_read_b128 v[72:75], v24 offset:57344
    ds_read_b64_tr_b16 v[56:57], v18 offset:32768
    v_mfma_f32_16x16x32_bf16 v[156:159], v[60:63], v[124:127], v[156:159]
    ds_read_b64_tr_b16 v[58:59], v18 offset:33792
    ds_read_b64_tr_b16 v[60:61], v18 offset:40960
    v_mfma_f32_16x16x32_bf16 v[160:163], v[40:43], v[96:99], v[160:163]
    ds_read_b64_tr_b16 v[62:63], v18 offset:41984
    v_add_u32 v18, 0x10000, v18
    v_mfma_f32_16x16x32_bf16 v[160:163], v[44:47], v[100:103], v[160:163]
    s_cmp_eq_u32 s4, 1
    s_cselect_b32 s9, 1.0, 0
    v_mfma_f32_16x16x32_bf16 v[164:167], v[40:43], v[104:107], v[164:167]
    s_cmp_eq_u32 s6, 0
    s_cselect_b32 s16, s8, 0
    s_cselect_b32 s17, s9, 0
    v_mfma_f32_16x16x32_bf16 v[164:167], v[44:47], v[108:111], v[164:167]
    s_cmp_eq_u32 s4, 2
    s_cselect_b32 s10, 1.0, 0
    v_mfma_f32_16x16x32_bf16 v[168:171], v[40:43], v[112:115], v[168:171]
    ds_read_b128 v[76:79], v25 offset:57344
    v_mfma_f32_16x16x32_bf16 v[168:171], v[44:47], v[116:119], v[168:171]
    s_cmp_eq_u32 s6, 0
    s_cselect_b32 s18, s10, 0
    s_cselect_b32 s19, s11, 0
    v_mfma_f32_16x16x32_bf16 v[172:175], v[40:43], v[120:123], v[172:175]
    ds_read_b64_tr_b16 v[40:41], v19 offset:32768
    ds_read_b64_tr_b16 v[42:43], v19 offset:33792
    v_mfma_f32_16x16x32_bf16 v[172:175], v[44:47], v[124:127], v[172:175]
    s_waitcnt lgkmcnt(3)
    ds_read_b64_tr_b16 v[44:45], v19 offset:40960
    ds_read_b64_tr_b16 v[46:47], v19 offset:41984
    v_mfma_f32_16x16x32_bf16 v[176:179], v[48:51], v[96:99], v[176:179]
    v_add_u32 v19, 0x10000, v19
    v_mfma_f32_16x16x32_bf16 v[176:179], v[52:55], v[100:103], v[176:179]
    v_mfma_f32_16x16x32_bf16 v[180:183], v[48:51], v[104:107], v[180:183]
    v_mfma_f32_16x16x32_bf16 v[180:183], v[52:55], v[108:111], v[180:183]
    v_add_u32 v24, 0x10000, v24
    v_mfma_f32_16x16x32_bf16 v[184:187], v[48:51], v[112:115], v[184:187]
    ds_read_b128 v[80:83], v24 offset:16384
    v_mfma_f32_16x16x32_bf16 v[184:187], v[52:55], v[116:119], v[184:187]
    s_add_u32 m0, s68, 139264
    v_mfma_f32_16x16x32_bf16 v[188:191], v[48:51], v[120:123], v[188:191]
    buffer_load_dwordx4 v6, s[20:23], s66 offen lds
    v_mfma_f32_16x16x32_bf16 v[188:191], v[52:55], v[124:127], v[188:191]
    ds_read_b64_tr_b16 v[48:49], v20 offset:32768
    ds_read_b64_tr_b16 v[50:51], v20 offset:33792
    v_mfma_f32_16x16x32_bf16 v[192:195], v[56:59], v[96:99], v[192:195]
    ds_read_b64_tr_b16 v[52:53], v20 offset:40960
    ds_read_b64_tr_b16 v[54:55], v20 offset:41984
    v_mfma_f32_16x16x32_bf16 v[192:195], v[60:63], v[100:103], v[192:195]
    v_add_u32 v25, 0x10000, v25
    v_add_u32 v20, 0x10000, v20
    v_mfma_f32_16x16x32_bf16 v[196:199], v[56:59], v[104:107], v[196:199]
    ds_read_b128 v[84:87], v25 offset:16384
    v_mfma_f32_16x16x32_bf16 v[196:199], v[60:63], v[108:111], v[196:199]
    s_cmp_eq_u32 s6, 0
    s_cselect_b32 s20, s12, 0
    s_cselect_b32 s21, s13, 0
    v_mfma_f32_16x16x32_bf16 v[200:203], v[56:59], v[112:115], v[200:203]
    s_cmp_eq_u32 s6, 0
    s_cselect_b32 s22, s14, 0
    s_cselect_b32 s23, s15, 0
    v_mfma_f32_16x16x32_bf16 v[200:203], v[60:63], v[116:119], v[200:203]
    v_mfma_f32_16x16x32_bf16 v[204:207], v[56:59], v[120:123], v[204:207]
    ds_read_b64_tr_b16 v[56:57], v21 offset:32768
    ds_read_b64_tr_b16 v[58:59], v21 offset:33792
    v_mfma_f32_16x16x32_bf16 v[204:207], v[60:63], v[124:127], v[204:207]
    s_waitcnt lgkmcnt(2)
    ds_read_b64_tr_b16 v[60:61], v21 offset:40960
    ds_read_b64_tr_b16 v[62:63], v21 offset:41984
    v_mfma_f32_16x16x32_bf16 v[208:211], v[40:43], v[96:99], v[208:211]
    ds_read_b128 v[88:91], v24 offset:24576
    v_add_u32 v21, 0x10000, v21
    v_mfma_f32_16x16x32_bf16 v[208:211], v[44:47], v[100:103], v[208:211]
    v_mfma_f32_16x16x32_bf16 v[212:215], v[40:43], v[104:107], v[212:215]
    v_mfma_f32_16x16x32_bf16 v[212:215], v[44:47], v[108:111], v[212:215]
    v_mfma_f32_16x16x32_bf16 v[216:219], v[40:43], v[112:115], v[216:219]
    v_mfma_f32_16x16x32_bf16 v[216:219], v[44:47], v[116:119], v[216:219]
    v_mfma_f32_16x16x32_bf16 v[220:223], v[40:43], v[120:123], v[220:223]
    ds_read_b128 v[92:95], v25 offset:24576
    ds_read_b64_tr_b16 v[40:41], v14 offset:0
    v_mfma_f32_16x16x32_bf16 v[220:223], v[44:47], v[124:127], v[220:223]
    ds_read_b64_tr_b16 v[42:43], v14 offset:1024
    ds_read_b64_tr_b16 v[44:45], v14 offset:8192
    v_mfma_f32_16x16x32_bf16 v[224:227], v[48:51], v[96:99], v[224:227]
    ds_read_b64_tr_b16 v[46:47], v14 offset:9216
    v_mfma_f32_16x16x32_bf16 v[224:227], v[52:55], v[100:103], v[224:227]
    s_xor_b32 s65, s65, 8192
    v_mfma_f32_16x16x32_bf16 v[228:231], v[48:51], v[104:107], v[228:231]
    s_xor_b32 s66, s66, 128
    v_mfma_f32_16x16x32_bf16 v[228:231], v[52:55], v[108:111], v[228:231]
    v_mfma_f32_16x16x32_bf16 v[232:235], v[48:51], v[112:115], v[232:235]
    v_mfma_f32_16x16x32_bf16 v[232:235], v[52:55], v[116:119], v[232:235]
    v_mfma_f32_16x16x32_bf16 v[236:239], v[48:51], v[120:123], v[236:239]
    ds_read_b64_tr_b16 v[48:49], v15 offset:0
    ds_read_b64_tr_b16 v[50:51], v15 offset:1024
    v_mfma_f32_16x16x32_bf16 v[236:239], v[52:55], v[124:127], v[236:239]
    s_waitcnt lgkmcnt(2)
    ds_read_b64_tr_b16 v[52:53], v15 offset:8192
    ds_read_b64_tr_b16 v[54:55], v15 offset:9216
    v_mfma_f32_16x16x32_bf16 v[240:243], v[56:59], v[96:99], v[240:243]
    v_mfma_f32_16x16x32_bf16 v[240:243], v[60:63], v[100:103], v[240:243]
    v_mfma_f32_16x16x32_bf16 v[244:247], v[56:59], v[104:107], v[244:247]
    v_mfma_f32_16x16x32_bf16 v[244:247], v[60:63], v[108:111], v[244:247]
    v_mfma_f32_16x16x32_bf16 v[248:251], v[56:59], v[112:115], v[248:251]
    v_mfma_f32_16x16x32_bf16 v[248:251], v[60:63], v[116:119], v[248:251]
    v_mfma_f32_16x16x32_bf16 v[252:255], v[56:59], v[120:123], v[252:255]
    ds_read_b64_tr_b16 v[56:57], v16 offset:0
    ds_read_b64_tr_b16 v[58:59], v16 offset:1024
    v_mfma_f32_16x16x32_bf16 v[252:255], v[60:63], v[124:127], v[252:255]
    buffer_load_dword v7, v8, s[32:35], s61 offen sc1
    v_mfma_f32_16x16x32_bf16 v[128:131], v[40:43], v[64:67], v[128:131]
    ds_read_b64_tr_b16 v[60:61], v16 offset:8192
    ds_read_b64_tr_b16 v[62:63], v16 offset:9216
    v_mfma_f32_16x16x32_bf16 v[128:131], v[44:47], v[68:71], v[128:131]
    v_mfma_f32_16x16x32_bf16 v[132:135], v[40:43], v[72:75], v[132:135]
    v_mfma_f32_16x16x32_bf16 v[132:135], v[44:47], v[76:79], v[132:135]
    v_mfma_f32_16x16x32_bf16 v[136:139], v[40:43], v[80:83], v[136:139]
    v_mfma_f32_16x16x32_bf16 v[136:139], v[44:47], v[84:87], v[136:139]
    v_mfma_f32_16x16x32_bf16 v[140:143], v[40:43], v[88:91], v[140:143]
    ds_read_b64_tr_b16 v[40:41], v17 offset:0
    ds_read_b64_tr_b16 v[42:43], v17 offset:1024
    v_mfma_f32_16x16x32_bf16 v[140:143], v[44:47], v[92:95], v[140:143]
    s_waitcnt lgkmcnt(2)
    ds_read_b64_tr_b16 v[44:45], v17 offset:8192
    ds_read_b64_tr_b16 v[46:47], v17 offset:9216
    v_mfma_f32_16x16x32_bf16 v[144:147], v[48:51], v[64:67], v[144:147]
    v_cvt_pk_bf16_f32 v128, v128, v129
    v_cvt_pk_bf16_f32 v129, v130, v131
    v_mfma_f32_16x16x32_bf16 v[144:147], v[52:55], v[68:71], v[144:147]
    v_cvt_pk_bf16_f32 v132, v132, v133
    v_cvt_pk_bf16_f32 v133, v134, v135
    v_mfma_f32_16x16x32_bf16 v[148:151], v[48:51], v[72:75], v[148:151]
    v_cvt_pk_bf16_f32 v136, v136, v137
    v_cvt_pk_bf16_f32 v137, v138, v139
    v_mfma_f32_16x16x32_bf16 v[148:151], v[52:55], v[76:79], v[148:151]
    v_cvt_pk_bf16_f32 v140, v140, v141
    v_cvt_pk_bf16_f32 v141, v142, v143
    v_mfma_f32_16x16x32_bf16 v[152:155], v[48:51], v[80:83], v[152:155]
    v_cvt_pk_bf16_f32 v130, v144, v145
    v_cvt_pk_bf16_f32 v131, v146, v147
    v_mfma_f32_16x16x32_bf16 v[152:155], v[52:55], v[84:87], v[152:155]
    v_mfma_f32_16x16x32_bf16 v[156:159], v[48:51], v[88:91], v[156:159]
    ds_read_b64_tr_b16 v[48:49], v18 offset:0
    ds_read_b64_tr_b16 v[50:51], v18 offset:1024
    v_mfma_f32_16x16x32_bf16 v[156:159], v[52:55], v[92:95], v[156:159]
    ds_read_b64_tr_b16 v[52:53], v18 offset:8192
    ds_read_b64_tr_b16 v[54:55], v18 offset:9216
    v_mfma_f32_16x16x32_bf16 v[160:163], v[56:59], v[64:67], v[160:163]
    v_cvt_pk_bf16_f32 v134, v148, v149
    v_cvt_pk_bf16_f32 v135, v150, v151
    v_mfma_f32_16x16x32_bf16 v[160:163], v[60:63], v[68:71], v[160:163]
    v_cvt_pk_bf16_f32 v138, v152, v153
    v_cvt_pk_bf16_f32 v139, v154, v155
    v_mfma_f32_16x16x32_bf16 v[164:167], v[56:59], v[72:75], v[164:167]
    v_cvt_pk_bf16_f32 v142, v156, v157
    v_cvt_pk_bf16_f32 v143, v158, v159
    v_mfma_f32_16x16x32_bf16 v[164:167], v[60:63], v[76:79], v[164:167]
    v_mfma_f32_16x16x32_bf16 v[168:171], v[56:59], v[80:83], v[168:171]
    v_mfma_f32_16x16x32_bf16 v[168:171], v[60:63], v[84:87], v[168:171]
    v_cvt_pk_bf16_f32 v160, v160, v161
    v_cvt_pk_bf16_f32 v161, v162, v163
    v_mfma_f32_16x16x32_bf16 v[172:175], v[56:59], v[88:91], v[172:175]
    ds_read_b64_tr_b16 v[56:57], v19 offset:0
    ds_read_b64_tr_b16 v[58:59], v19 offset:1024
    v_mfma_f32_16x16x32_bf16 v[172:175], v[60:63], v[92:95], v[172:175]
    s_waitcnt lgkmcnt(2)
    ds_read_b64_tr_b16 v[60:61], v19 offset:8192
    ds_read_b64_tr_b16 v[62:63], v19 offset:9216
    v_mfma_f32_16x16x32_bf16 v[176:179], v[40:43], v[64:67], v[176:179]
    v_cvt_pk_bf16_f32 v164, v164, v165
    v_cvt_pk_bf16_f32 v165, v166, v167
    v_mfma_f32_16x16x32_bf16 v[176:179], v[44:47], v[68:71], v[176:179]
    v_cvt_pk_bf16_f32 v168, v168, v169
    v_cvt_pk_bf16_f32 v169, v170, v171
    v_mfma_f32_16x16x32_bf16 v[180:183], v[40:43], v[72:75], v[180:183]
    v_cvt_pk_bf16_f32 v172, v172, v173
    v_cvt_pk_bf16_f32 v173, v174, v175
    v_mfma_f32_16x16x32_bf16 v[180:183], v[44:47], v[76:79], v[180:183]
    v_mfma_f32_16x16x32_bf16 v[184:187], v[40:43], v[80:83], v[184:187]
    v_mfma_f32_16x16x32_bf16 v[184:187], v[44:47], v[84:87], v[184:187]
    v_cvt_pk_bf16_f32 v162, v176, v177
    v_cvt_pk_bf16_f32 v163, v178, v179
    v_mfma_f32_16x16x32_bf16 v[188:191], v[40:43], v[88:91], v[188:191]
    ds_read_b64_tr_b16 v[40:41], v20 offset:0
    ds_read_b64_tr_b16 v[42:43], v20 offset:1024
    v_mfma_f32_16x16x32_bf16 v[188:191], v[44:47], v[92:95], v[188:191]
    ds_read_b64_tr_b16 v[44:45], v20 offset:8192
    ds_read_b64_tr_b16 v[46:47], v20 offset:9216
    v_mfma_f32_16x16x32_bf16 v[192:195], v[48:51], v[64:67], v[192:195]
    v_cvt_pk_bf16_f32 v166, v180, v181
    v_cvt_pk_bf16_f32 v167, v182, v183
    v_mfma_f32_16x16x32_bf16 v[192:195], v[52:55], v[68:71], v[192:195]
    v_cvt_pk_bf16_f32 v170, v184, v185
    v_cvt_pk_bf16_f32 v171, v186, v187
    s_waitcnt vmcnt(0)
    v_cmp_gt_u32 vcc, 1, v7
    s_nop 1
    s_and_b64 vcc, vcc, exec
    s_cbranch_scc1 SPIN_KV
BACK_KV:
    v_mfma_f32_16x16x32_bf16 v[196:199], v[48:51], v[72:75], v[196:199]
    s_mov_b32 s77, s75
    buffer_load_dwordx4 a[224:227], v1, s[36:39], 0 offen offset:0 sc1
    v_mfma_f32_16x16x32_bf16 v[196:199], v[52:55], v[76:79], v[196:199]
    buffer_load_dwordx4 a[228:231], v1, s[36:39], 0 offen offset:1024 sc1
    v_mfma_f32_16x16x32_bf16 v[200:203], v[48:51], v[80:83], v[200:203]
    v_cmp_le_i32 vcc, 0, v36
    v_cvt_pk_bf16_f32 v192, v192, v193
    v_mfma_f32_16x16x32_bf16 v[200:203], v[52:55], v[84:87], v[200:203]
    v_cvt_pk_bf16_f32 v193, v194, v195
    v_cvt_pk_bf16_f32 v174, v188, v189
    v_mfma_f32_16x16x32_bf16 v[204:207], v[48:51], v[88:91], v[204:207]
    buffer_load_dwordx4 a[232:235], v1, s[36:39], 0 offen offset:2048 sc1
    v_mfma_f32_16x16x32_bf16 v[204:207], v[52:55], v[92:95], v[204:207]
    s_waitcnt lgkmcnt(0)
    ds_read_b64_tr_b16 v[48:49], v21 offset:0
    ds_read_b64_tr_b16 v[50:51], v21 offset:1024
    v_mfma_f32_16x16x32_bf16 v[208:211], v[56:59], v[64:67], v[208:211]
    ds_read_b64_tr_b16 v[52:53], v21 offset:8192
    ds_read_b64_tr_b16 v[54:55], v21 offset:9216
    v_mfma_f32_16x16x32_bf16 v[208:211], v[60:63], v[68:71], v[208:211]
    v_cvt_pk_bf16_f32 v196, v196, v197
    v_cvt_pk_bf16_f32 v197, v198, v199
    v_mfma_f32_16x16x32_bf16 v[212:215], v[56:59], v[72:75], v[212:215]
    buffer_load_dwordx4 a[236:239], v1, s[36:39], 0 offen offset:3072 sc1
    v_mfma_f32_16x16x32_bf16 v[212:215], v[60:63], v[76:79], v[212:215]
    v_cvt_pk_bf16_f32 v200, v200, v201
    v_cvt_pk_bf16_f32 v201, v202, v203
    v_mfma_f32_16x16x32_bf16 v[216:219], v[56:59], v[80:83], v[216:219]
    v_cvt_pk_bf16_f32 v194, v208, v209
    v_cndmask_b32_e64 v208, v37, 0, vcc
    v_mfma_f32_16x16x32_bf16 v[216:219], v[60:63], v[84:87], v[216:219]
    v_mul_f32 v176, s16, v208
    v_cmp_le_i32 vcc, 1, v36
    v_mfma_f32_16x16x32_bf16 v[220:223], v[56:59], v[88:91], v[220:223]
    v_cvt_pk_bf16_f32 v195, v210, v211
    v_cndmask_b32_e64 v209, v37, 0, vcc
    v_mfma_f32_16x16x32_bf16 v[220:223], v[60:63], v[92:95], v[220:223]
    v_mul_f32 v177, s16, v209
    v_cmp_le_i32 vcc, 2, v36
    v_mfma_f32_16x16x32_bf16 v[224:227], v[40:43], v[64:67], v[224:227]
    s_mov_b32 s38, 16384
    v_cndmask_b32_e64 v210, v37, 0, vcc
    v_mul_f32 v178, s16, v210
    v_mfma_f32_16x16x32_bf16 v[224:227], v[44:47], v[68:71], v[224:227]
    s_add_u32 m0, s76, s75
    v_cmp_le_i32 vcc, 3, v36
    v_cvt_pk_bf16_f32 v198, v212, v213
    v_mfma_f32_16x16x32_bf16 v[228:231], v[40:43], v[72:75], v[228:231]
    buffer_load_dwordx4 v1, s[36:39], s77 offen sc1 lds
    v_mfma_f32_16x16x32_bf16 v[228:231], v[44:47], v[76:79], v[228:231]
    v_cndmask_b32_e64 v211, v37, 0, vcc
    v_mul_f32 v179, s16, v211
    v_mfma_f32_16x16x32_bf16 v[232:235], v[40:43], v[80:83], v[232:235]
    v_cvt_pk_bf16_f32 v224, v224, v225
    v_cvt_pk_bf16_f32 v225, v226, v227
    v_mfma_f32_16x16x32_bf16 v[232:235], v[44:47], v[84:87], v[232:235]
    s_waitcnt vmcnt(6) lgkmcnt(0)
    s_barrier
    ds_read_b64_tr_b16 v[56:57], v26 offset:32768
    v_mfma_f32_16x16x32_bf16 v[236:239], v[40:43], v[88:91], v[236:239]
    buffer_load_dwordx4 v1, s[36:39], s77 offen offset:1024 sc1 lds
    v_mfma_f32_16x16x32_bf16 v[236:239], v[44:47], v[92:95], v[236:239]
    ds_read_b64_tr_b16 v[58:59], v26 offset:33280
    ds_read_b64_tr_b16 v[60:61], v26 offset:36864
    v_mfma_f32_16x16x32_bf16 v[240:243], v[48:51], v[64:67], v[240:243]
    ds_read_b64_tr_b16 v[62:63], v26 offset:37376
    ds_read_b128 a[136:139], v22 offset:32768
    v_mfma_f32_16x16x32_bf16 v[240:243], v[52:55], v[68:71], v[240:243]
    ds_read_b128 a[140:143], v23 offset:32768
    v_add_u32 v26, 0x10000, v26
    v_mfma_f32_16x16x32_bf16 v[244:247], v[48:51], v[72:75], v[244:247]
    buffer_load_dwordx4 v1, s[36:39], s77 offen offset:2048 sc1 lds
    v_mfma_f32_16x16x32_bf16 v[244:247], v[52:55], v[76:79], v[244:247]
    ds_read_b64_tr_b16 v[40:41], v27 offset:32768
    ds_read_b64_tr_b16 v[42:43], v27 offset:33280
    v_mfma_f32_16x16x32_bf16 v[248:251], v[48:51], v[80:83], v[248:251]
    ds_read_b64_tr_b16 v[44:45], v27 offset:36864
    ds_read_b64_tr_b16 v[46:47], v27 offset:37376
    v_mfma_f32_16x16x32_bf16 v[248:251], v[52:55], v[84:87], v[248:251]
    v_add_u32 v22, 0x10000, v22
    v_add_u32 v23, 0x10000, v23
    v_mfma_f32_16x16x32_bf16 v[252:255], v[48:51], v[88:91], v[252:255]
    buffer_load_dwordx4 v1, s[36:39], s77 offen offset:3072 sc1 lds
    v_mfma_f32_16x16x32_bf16 v[252:255], v[52:55], v[92:95], v[252:255]
    s_waitcnt lgkmcnt(4)
    ds_read_b64_tr_b16 v[48:49], v28 offset:32768
    ds_read_b64_tr_b16 v[50:51], v28 offset:33280
    v_mfma_f32_16x16x32_bf16 a[64:67], v[56:59], v[96:99], a[64:67]
    s_add_u32 s100, s77, 4096
    ds_read_b64_tr_b16 v[52:53], v28 offset:36864
    ds_read_b64_tr_b16 v[54:55], v28 offset:37376
    v_mfma_f32_16x16x32_bf16 a[64:67], v[60:63], v[100:103], a[64:67]
    s_add_u32 m0, m0, 4096
    v_add_u32 v27, 0x10000, v27
    v_add_u32 v28, 0x10000, v28
    v_mfma_f32_16x16x32_bf16 a[68:71], v[56:59], v[104:107], a[68:71]
    buffer_load_dwordx4 v1, s[36:39], s100 offen sc1 lds
    v_mfma_f32_16x16x32_bf16 a[68:71], v[60:63], v[108:111], a[68:71]
    v_cvt_pk_bf16_f32 v226, v240, v241
    v_cvt_pk_bf16_f32 v227, v242, v243
    v_mfma_f32_16x16x32_bf16 a[72:75], v[56:59], v[112:115], a[72:75]
    v_cvt_pk_bf16_f32 v228, v228, v229
    v_cvt_pk_bf16_f32 v229, v230, v231
    v_mfma_f32_16x16x32_bf16 a[72:75], v[60:63], v[116:119], a[72:75]
    v_cvt_pk_bf16_f32 v230, v244, v245
    v_cvt_pk_bf16_f32 v231, v246, v247
    v_mfma_f32_16x16x32_bf16 a[76:79], v[56:59], v[120:123], a[76:79]
    buffer_load_dwordx4 v1, s[36:39], s100 offen offset:1024 sc1 lds
    v_mfma_f32_16x16x32_bf16 a[76:79], v[60:63], v[124:127], a[76:79]
    v_cvt_pk_bf16_f32 v199, v214, v215
    v_cvt_pk_bf16_f32 v232, v232, v233
    v_mfma_f32_16x16x32_bf16 a[128:131], v[56:59], a[136:139], a[128:131]
    ds_read_b64_tr_b16 v[56:57], v29 offset:32768
    ds_read_b64_tr_b16 v[58:59], v29 offset:33280
    v_mfma_f32_16x16x32_bf16 a[128:131], v[60:63], a[140:143], a[128:131]
    s_waitcnt lgkmcnt(2)
    ds_read_b64_tr_b16 v[60:61], v29 offset:36864
    ds_read_b64_tr_b16 v[62:63], v29 offset:37376
    v_mfma_f32_16x16x32_bf16 a[80:83], v[40:43], v[96:99], a[80:83]
    buffer_load_dwordx4 v1, s[36:39], s100 offen offset:2048 sc1 lds
    v_mfma_f32_16x16x32_bf16 a[80:83], v[44:47], v[100:103], a[80:83]
    v_add_u32 v29, 0x10000, v29
    v_cvt_pk_bf16_f32 v233, v234, v235
    v_mfma_f32_16x16x32_bf16 a[84:87], v[40:43], v[104:107], a[84:87]
    v_cvt_pk_bf16_f32 v234, v248, v249
    v_cvt_pk_bf16_f32 v235, v250, v251
    v_mfma_f32_16x16x32_bf16 a[84:87], v[44:47], v[108:111], a[84:87]
    v_cvt_pk_bf16_f32 v202, v216, v217
    v_cvt_pk_bf16_f32 v203, v218, v219
    v_mfma_f32_16x16x32_bf16 a[88:91], v[40:43], v[112:115], a[88:91]
    buffer_load_dwordx4 v1, s[36:39], s100 offen offset:3072 sc1 lds
    v_mfma_f32_16x16x32_bf16 a[88:91], v[44:47], v[116:119], a[88:91]
    v_cvt_pk_bf16_f32 v175, v190, v191
    v_cvt_pk_bf16_f32 v236, v236, v237
    v_mfma_f32_16x16x32_bf16 a[92:95], v[40:43], v[120:123], a[92:95]
    s_lshr_b32 s82, s4, 1
    s_add_u32 s82, s82, 32
    v_cvt_pk_bf16_f32 v237, v238, v239
    v_mfma_f32_16x16x32_bf16 a[92:95], v[44:47], v[124:127], a[92:95]
    s_sub_u32 s82, s82, s6
    v_cvt_pk_bf16_f32 v238, v252, v253
    v_cvt_pk_bf16_f32 v239, v254, v255
    v_mfma_f32_16x16x32_bf16 a[132:135], v[40:43], a[136:139], a[132:135]
    s_add_u32 s76, s76, 32768
    s_sub_u32 s82, s82, s6
    ds_read_b64_tr_b16 v[40:41], v26 offset:0
    v_mfma_f32_16x16x32_bf16 a[132:135], v[44:47], a[140:143], a[132:135]
    s_add_u32 s77, s77, 32768
    s_lshl_b32 s38, s82, 15
    s_add_u32 m0, s76, s75
    v_mfma_f32_16x16x32_bf16 a[96:99], v[48:51], v[96:99], a[96:99]
    s_mov_b32 s82, 0
    buffer_load_dwordx4 v1, s[36:39], s77 offen sc1 lds
    v_mfma_f32_16x16x32_bf16 a[96:99], v[52:55], v[100:103], a[96:99]
    ds_read_b64_tr_b16 v[42:43], v26 offset:512
    ds_read_b64_tr_b16 v[44:45], v26 offset:4096
    v_mfma_f32_16x16x32_bf16 a[100:103], v[48:51], v[104:107], a[100:103]
    buffer_load_dwordx4 v1, s[36:39], s77 offen offset:1024 sc1 lds
    v_mfma_f32_16x16x32_bf16 a[100:103], v[52:55], v[108:111], a[100:103]
    ds_read_b64_tr_b16 v[46:47], v26 offset:4608
    ds_read_b128 a[136:139], v22 offset:0
    v_mfma_f32_16x16x32_bf16 a[104:107], v[48:51], v[112:115], a[104:107]
    ds_read_b128 a[140:143], v23 offset:0
    v_cvt_pk_bf16_f32 v204, v204, v205
    v_mfma_f32_16x16x32_bf16 a[104:107], v[52:55], v[116:119], a[104:107]
    v_cvt_pk_bf16_f32 v205, v206, v207
    v_cvt_pk_bf16_f32 v206, v220, v221
    v_mfma_f32_16x16x32_bf16 a[108:111], v[48:51], v[120:123], a[108:111]
    buffer_load_dwordx4 v1, s[36:39], s77 offen offset:2048 sc1 lds
    v_mfma_f32_16x16x32_bf16 a[108:111], v[52:55], v[124:127], a[108:111]
    s_waitcnt lgkmcnt(3)
    ds_read_b64_tr_b16 v[48:49], v27 offset:0
    ds_read_b64_tr_b16 v[50:51], v27 offset:512
    v_mfma_f32_16x16x32_bf16 a[112:115], v[56:59], v[96:99], a[112:115]
    ds_read_b64_tr_b16 v[52:53], v27 offset:4096
    ds_read_b64_tr_b16 v[54:55], v27 offset:4608
    v_mfma_f32_16x16x32_bf16 a[112:115], v[60:63], v[100:103], a[112:115]
    v_cvt_pk_bf16_f32 v207, v222, v223
    v_cmp_eq_u32 vcc, 0, v38
    v_mfma_f32_16x16x32_bf16 a[116:119], v[56:59], v[104:107], a[116:119]
    buffer_load_dwordx4 v1, s[36:39], s77 offen offset:3072 sc1 lds
    v_mfma_f32_16x16x32_bf16 a[116:119], v[60:63], v[108:111], a[116:119]
    v_mov_b32 v38, 0x3f803f80
    v_cndmask_b32 v38, 0, v38, vcc
    v_mfma_f32_16x16x32_bf16 a[120:123], v[56:59], v[112:115], a[120:123]
    s_add_u32 s100, s77, 4096
    v_mfma_f32_16x16x32_bf16 a[120:123], v[60:63], v[116:119], a[120:123]
    s_add_u32 m0, m0, 4096
    v_mfma_f32_16x16x32_bf16 a[124:127], v[56:59], v[120:123], a[124:127]
    buffer_load_dwordx4 v1, s[36:39], s100 offen sc1 lds
    v_mfma_f32_16x16x32_bf16 a[124:127], v[60:63], v[124:127], a[124:127]
    s_waitcnt vmcnt(13)
    ds_read_b64_tr_b16 v[56:57], v28 offset:0
    ds_read_b64_tr_b16 v[58:59], v28 offset:512
    v_mfma_f32_16x16x32_bf16 v[240:243], a[224:227], v[128:131], v[176:179]
    ds_read_b64_tr_b16 v[60:61], v28 offset:4096
    ds_read_b64_tr_b16 v[62:63], v28 offset:4608
    v_mfma_f32_16x16x32_bf16 v[240:243], a[228:231], v[160:163], v[240:243]
    v_mfma_f32_16x16x32_bf16 v[240:243], a[232:235], v[192:195], v[240:243]
    buffer_load_dwordx4 v1, s[36:39], s100 offen offset:1024 sc1 lds
    v_mfma_f32_16x16x32_bf16 v[240:243], a[236:239], v[224:227], v[240:243]
    v_mfma_f32_16x16x32_bf16 v[244:247], a[224:227], v[132:135], 0
    v_mfma_f32_16x16x32_bf16 v[244:247], a[228:231], v[164:167], v[244:247]
    v_mfma_f32_16x16x32_bf16 v[244:247], a[232:235], v[196:199], v[244:247]
    buffer_load_dwordx4 v1, s[36:39], s100 offen offset:2048 sc1 lds
    v_mfma_f32_16x16x32_bf16 v[244:247], a[236:239], v[228:231], v[244:247]
    v_mfma_f32_16x16x32_bf16 v[248:251], a[224:227], v[136:139], 0
    v_mfma_f32_16x16x32_bf16 v[248:251], a[228:231], v[168:171], v[248:251]
    v_mfma_f32_16x16x32_bf16 v[248:251], a[232:235], v[200:203], v[248:251]
    buffer_load_dwordx4 v1, s[36:39], s100 offen offset:3072 sc1 lds
    v_mfma_f32_16x16x32_bf16 v[248:251], a[236:239], v[232:235], v[248:251]
    v_max3_f32 v240, v240, v241, v242
    v_max_f32 v240, v240, v243
    v_mfma_f32_16x16x32_bf16 v[252:255], a[224:227], v[140:143], 0
    s_add_u32 s76, s76, 32768
    v_max3_f32 v244, v244, v245, v246
    v_max_f32 v244, v244, v247
    v_mfma_f32_16x16x32_bf16 v[252:255], a[228:231], v[172:175], v[252:255]
    s_add_u32 s77, s77, 32768
    v_max3_f32 v248, v248, v249, v250
    v_max_f32 v248, v248, v251
    v_mfma_f32_16x16x32_bf16 v[252:255], a[232:235], v[204:207], v[252:255]
    s_add_u32 m0, s76, s75
    v_mov_b32 v241, v240
    v_mov_b32 v245, v244
    v_mfma_f32_16x16x32_bf16 v[252:255], a[236:239], v[236:239], v[252:255]
    buffer_load_dwordx4 v1, s[36:39], s77 offen sc1 lds
    v_mfma_f32_16x16x32_bf16 a[64:67], v[40:43], v[64:67], a[64:67]
    s_waitcnt lgkmcnt(0)
    v_mov_b32 v249, v248
    v_permlane32_swap_b32 v240, v241
    v_mfma_f32_16x16x32_bf16 a[64:67], v[44:47], v[68:71], a[64:67]
    v_permlane32_swap_b32 v244, v245
    v_permlane32_swap_b32 v248, v249
    v_mfma_f32_16x16x32_bf16 a[68:71], v[40:43], v[72:75], a[68:71]
    buffer_load_dwordx4 v1, s[36:39], s77 offen offset:1024 sc1 lds
    v_mfma_f32_16x16x32_bf16 a[68:71], v[44:47], v[76:79], a[68:71]
    v_max3_f32 v252, v252, v253, v254
    v_max_f32 v252, v252, v255
    v_mfma_f32_16x16x32_bf16 a[72:75], v[40:43], v[80:83], a[72:75]
    v_mov_b32 v253, v252
    v_max_f32 v240, v240, v241
    v_mfma_f32_16x16x32_bf16 a[72:75], v[44:47], v[84:87], a[72:75]
    v_permlane32_swap_b32 v252, v253
    v_max_f32 v244, v244, v245
    v_mfma_f32_16x16x32_bf16 a[76:79], v[40:43], v[88:91], a[76:79]
    buffer_load_dwordx4 v1, s[36:39], s77 offen offset:2048 sc1 lds
    v_mfma_f32_16x16x32_bf16 a[76:79], v[44:47], v[92:95], a[76:79]
    v_max_f32 v248, v248, v249
    v_max_f32 v252, v252, v253
    v_mfma_f32_16x16x32_bf16 a[128:131], v[40:43], a[136:139], a[128:131]
    ds_read_b64_tr_b16 v[40:41], v29 offset:0
    ds_read_b64_tr_b16 v[42:43], v29 offset:512
    v_mfma_f32_16x16x32_bf16 a[128:131], v[44:47], a[140:143], a[128:131]
    ds_read_b64_tr_b16 v[44:45], v29 offset:4096
    ds_read_b64_tr_b16 v[46:47], v29 offset:4608
    v_mfma_f32_16x16x32_bf16 a[80:83], v[48:51], v[64:67], a[80:83]
    buffer_load_dwordx4 v1, s[36:39], s77 offen offset:3072 sc1 lds
    v_mfma_f32_16x16x32_bf16 a[80:83], v[52:55], v[68:71], a[80:83]
    v_mov_b32 v241, v240
    v_mov_b32 v245, v244
    v_mfma_f32_16x16x32_bf16 a[84:87], v[48:51], v[72:75], a[84:87]
    s_add_u32 s100, s77, 4096
    v_mov_b32 v249, v248
    v_mov_b32 v253, v252
    v_mfma_f32_16x16x32_bf16 a[84:87], v[52:55], v[76:79], a[84:87]
    s_add_u32 m0, m0, 4096
    v_permlane16_swap_b32 v240, v241
    v_permlane16_swap_b32 v244, v245
    v_mfma_f32_16x16x32_bf16 a[88:91], v[48:51], v[80:83], a[88:91]
    buffer_load_dwordx4 v1, s[36:39], s100 offen sc1 lds
    v_mfma_f32_16x16x32_bf16 a[88:91], v[52:55], v[84:87], a[88:91]
    v_permlane16_swap_b32 v248, v249
    v_permlane16_swap_b32 v252, v253
    v_mfma_f32_16x16x32_bf16 a[92:95], v[48:51], v[88:91], a[92:95]
    v_max_f32 v240, v240, v241
    v_max_f32 v244, v244, v245
    v_mfma_f32_16x16x32_bf16 a[92:95], v[52:55], v[92:95], a[92:95]
    v_max_f32 v248, v248, v249
    v_max_f32 v252, v252, v253
    v_mfma_f32_16x16x32_bf16 a[132:135], v[48:51], a[136:139], a[132:135]
    buffer_load_dwordx4 v1, s[36:39], s100 offen offset:1024 sc1 lds
    v_mfma_f32_16x16x32_bf16 a[132:135], v[52:55], a[140:143], a[132:135]
    v_sub_f32 v144, 0, v240
    v_sub_f32 v145, 0, v240
    v_mfma_f32_16x16x32_bf16 a[96:99], v[56:59], v[64:67], a[96:99]
    v_sub_f32 v146, 0, v240
    v_sub_f32 v147, 0, v240
    v_mfma_f32_16x16x32_bf16 a[96:99], v[60:63], v[68:71], a[96:99]
    v_sub_f32 v148, 0, v244
    v_sub_f32 v149, 0, v244
    v_mfma_f32_16x16x32_bf16 a[100:103], v[56:59], v[72:75], a[100:103]
    buffer_load_dwordx4 v1, s[36:39], s100 offen offset:2048 sc1 lds
    v_mfma_f32_16x16x32_bf16 a[100:103], v[60:63], v[76:79], a[100:103]
    v_sub_f32 v150, 0, v244
    v_sub_f32 v151, 0, v244
    v_mfma_f32_16x16x32_bf16 a[104:107], v[56:59], v[80:83], a[104:107]
    v_sub_f32 v152, 0, v248
    v_sub_f32 v153, 0, v248
    v_mfma_f32_16x16x32_bf16 a[104:107], v[60:63], v[84:87], a[104:107]
    v_sub_f32 v154, 0, v248
    v_sub_f32 v155, 0, v248
    v_mfma_f32_16x16x32_bf16 a[108:111], v[56:59], v[88:91], a[108:111]
    buffer_load_dwordx4 v1, s[36:39], s100 offen offset:3072 sc1 lds
    v_mfma_f32_16x16x32_bf16 a[108:111], v[60:63], v[92:95], a[108:111]
    s_waitcnt lgkmcnt(0)
    v_sub_f32 v156, 0, v252
    v_sub_f32 v157, 0, v252
    v_mfma_f32_16x16x32_bf16 a[112:115], v[40:43], v[64:67], a[112:115]
    s_add_u32 s77, s77, 32768
    v_sub_f32 v158, 0, v252
    v_sub_f32 v159, 0, v252
    v_mfma_f32_16x16x32_bf16 a[112:115], v[44:47], v[68:71], a[112:115]
    s_add_u32 s76, s76, 32768
    v_and_b32 v29, 0x380, v1
    v_lshl_add_u32 v29, v29, 4, v39
    v_mfma_f32_16x16x32_bf16 a[116:119], v[40:43], v[72:75], a[116:119]
    v_bfe_u32 v39, v1, 2, 4
    v_accvgpr_write_b32 a136, v38
    v_mfma_f32_16x16x32_bf16 a[116:119], v[44:47], v[76:79], a[116:119]
    v_accvgpr_write_b32 a137, v38
    v_accvgpr_write_b32 a138, v38
    v_mfma_f32_16x16x32_bf16 a[120:123], v[40:43], v[80:83], a[120:123]
    v_accvgpr_write_b32 a139, v38
    v_lshl_add_u32 v29, v29, 1, v39
    v_mfma_f32_16x16x32_bf16 a[120:123], v[44:47], v[84:87], a[120:123]
    s_waitcnt vmcnt(16) lgkmcnt(0)
    s_barrier
    v_mfma_f32_16x16x32_bf16 a[124:127], v[40:43], v[88:91], a[124:127]
    v_mfma_f32_16x16x32_bf16 a[124:127], v[44:47], v[92:95], a[124:127]
K1_ATT:
    v_add_f32 v212, s20, v144
    v_fma_f32 v176, v208, s16, v212
    v_fma_f32 v177, v209, s16, v212
    v_fma_f32 v178, v210, s16, v212
    v_fma_f32 v179, v211, s16, v212
    s_nop 1
    s_waitcnt lgkmcnt(0)
    v_mfma_f32_16x16x32_bf16 v[240:243], a[224:227], v[128:131], v[176:179]
    s_add_u32 m0, s76, s75
    ds_read_b128 a[240:243], v2 offset:4096
    ds_read_b128 a[244:247], v2 offset:5120
    v_mfma_f32_16x16x32_bf16 v[240:243], a[228:231], v[160:163], v[240:243]
    s_mov_b32 s76, s60
    buffer_load_dwordx4 v1, s[36:39], s77 offen sc1 lds
    v_mfma_f32_16x16x32_bf16 v[240:243], a[232:235], v[192:195], v[240:243]
    s_mov_b32 s60, s82
    ds_read_b128 a[248:251], v2 offset:6144
    ds_read_b128 a[252:255], v2 offset:7168
    v_mfma_f32_16x16x32_bf16 v[240:243], a[236:239], v[224:227], v[240:243]
    s_add_u32 s82, s82, 32768
    v_add_f32 v213, s21, v144
    v_fma_f32 v180, v208, s17, v213
    v_mfma_f32_16x16x32_bf16 v[244:247], a[224:227], v[132:135], v[148:151]
    s_sub_u32 s7, 15, s6
    v_fma_f32 v181, v209, s17, v213
    v_fma_f32 v182, v210, s17, v213
    v_mfma_f32_16x16x32_bf16 v[244:247], a[228:231], v[164:167], v[244:247]
    s_lshl3_add_u32 s80, s6, s4
    v_exp_f32 v240, v240
    v_mfma_f32_16x16x32_bf16 v[244:247], a[232:235], v[196:199], v[244:247]
    s_lshl3_add_u32 s81, s7, s4
    buffer_load_dwordx4 v1, s[36:39], s77 offen offset:1024 sc1 lds
    v_mfma_f32_16x16x32_bf16 v[244:247], a[236:239], v[228:231], v[244:247]
    s_mul_i32 s80, s80, 155648
    v_exp_f32 v241, v241
    v_mfma_f32_16x16x32_bf16 v[248:251], a[224:227], v[136:139], v[152:155]
    s_mul_i32 s81, s81, 155648
    v_exp_f32 v242, v242
    v_mfma_f32_16x16x32_bf16 v[248:251], a[228:231], v[168:171], v[248:251]
    s_lshl_b32 s7, s5, 12
    v_exp_f32 v243, v243
    v_mfma_f32_16x16x32_bf16 v[248:251], a[232:235], v[200:203], v[248:251]
    s_add_u32 s80, s80, s7
    v_fma_f32 v183, v211, s17, v213
    v_cvt_pk_bf16_f32 v32, v240, v241
    v_mfma_f32_16x16x32_bf16 v[248:251], a[236:239], v[232:235], v[248:251]
    s_add_u32 s81, s81, s7
    buffer_load_dwordx4 v1, s[36:39], s77 offen offset:2048 sc1 lds
    v_mfma_f32_16x16x32_bf16 v[252:255], a[224:227], v[140:143], v[156:159]
    s_lshr_b32 s7, s5, 3
    v_cvt_pk_bf16_f32 v33, v242, v243
    ds_read_b128 a[224:227], v2 offset:8192
    v_mfma_f32_16x16x32_bf16 v[252:255], a[228:231], v[172:175], v[252:255]
    s_lshl2_add_u32 s7, s7, s4
    v_exp_f32 v244, v244
    v_mfma_f32_16x16x32_bf16 v[252:255], a[232:235], v[204:207], v[252:255]
    s_lshl_b32 s7, s7, 8
    v_exp_f32 v245, v245
    v_mfma_f32_16x16x32_bf16 v[252:255], a[236:239], v[236:239], v[252:255]
    s_mov_b32 s42, 19922944
    v_exp_f32 v246, v246
    s_waitcnt lgkmcnt(1)
    v_mfma_f32_16x16x32_bf16 v[240:243], a[240:243], v[128:131], v[180:183]
    s_mov_b32 s43, 0x20000
    v_exp_f32 v247, v247
    v_mfma_f32_16x16x32_bf16 v[240:243], a[244:247], v[160:163], v[240:243]
    s_add_u32 s92, s7, 163840
    buffer_load_dwordx4 v1, s[36:39], s77 offen offset:3072 sc1 lds
    v_mfma_f32_16x16x32_bf16 v[240:243], a[248:251], v[192:195], v[240:243]
    s_mov_b64 s[24:25], s[0:1]
    v_cvt_pk_bf16_f32 v40, v244, v245
    v_cvt_pk_bf16_f32 v41, v246, v247
    v_mfma_f32_16x16x32_bf16 v[240:243], a[252:255], v[224:227], v[240:243]
    s_mov_b32 s78, s6
    v_exp_f32 v248, v248
    v_mfma_f32_16x16x32_bf16 v[244:247], a[240:243], v[132:135], v[148:151]
    s_mov_b32 s26, 2359296
    v_exp_f32 v249, v249
    v_mfma_f32_16x16x32_bf16 v[244:247], a[244:247], v[164:167], v[244:247]
    s_add_u32 s100, s77, 4096
    v_exp_f32 v250, v250
    v_mfma_f32_16x16x32_bf16 v[244:247], a[248:251], v[196:199], v[244:247]
    s_add_u32 m0, m0, 4096
    v_exp_f32 v251, v251
    v_mfma_f32_16x16x32_bf16 v[244:247], a[252:255], v[228:231], v[244:247]
    s_mov_b32 s27, 0x20000
    v_cvt_pk_bf16_f32 v48, v248, v249
    v_cvt_pk_bf16_f32 v49, v250, v251
    v_mfma_f32_16x16x32_bf16 v[248:251], a[240:243], v[136:139], v[152:155]
    buffer_load_dwordx4 v1, s[36:39], s100 offen sc1 lds
    v_mfma_f32_16x16x32_bf16 v[248:251], a[244:247], v[168:171], v[248:251]
    ds_read_b128 a[228:231], v2 offset:9216
    ds_read_b128 a[232:235], v2 offset:10240
    v_mfma_f32_16x16x32_bf16 v[248:251], a[248:251], v[200:203], v[248:251]
    v_exp_f32 v252, v252
    v_mfma_f32_16x16x32_bf16 v[248:251], a[252:255], v[232:235], v[248:251]
    v_exp_f32 v253, v253
    v_exp_f32 v254, v254
    v_exp_f32 v255, v255
    v_cvt_pk_bf16_f32 v56, v252, v253
    v_cvt_pk_bf16_f32 v57, v254, v255
    v_mfma_f32_16x16x32_bf16 v[252:255], a[240:243], v[140:143], v[156:159]
    ds_read_b128 a[236:239], v2 offset:11264
    v_add_f32 v214, s22, v144
    v_mfma_f32_16x16x32_bf16 v[252:255], a[244:247], v[172:175], v[252:255]
    buffer_load_dwordx4 v1, s[36:39], s100 offen offset:1024 sc1 lds
    v_mfma_f32_16x16x32_bf16 v[252:255], a[248:251], v[204:207], v[252:255]
    v_exp_f32 v240, v240
    v_mfma_f32_16x16x32_bf16 v[252:255], a[252:255], v[236:239], v[252:255]
    s_waitcnt lgkmcnt(1)
    v_exp_f32 v241, v241
    v_exp_f32 v242, v242
    v_exp_f32 v243, v243
    v_fma_f32 v184, v208, s18, v214
    v_fma_f32 v185, v209, s18, v214
    v_fma_f32 v186, v210, s18, v214
    v_fma_f32 v187, v211, s18, v214
    v_cvt_pk_bf16_f32 v34, v240, v241
    v_cvt_pk_bf16_f32 v35, v242, v243
    v_mfma_f32_16x16x32_bf16 v[240:243], a[224:227], v[128:131], v[184:187]
    v_exp_f32 v244, v244
    v_mfma_f32_16x16x32_bf16 v[240:243], a[228:231], v[160:163], v[240:243]
    v_exp_f32 v245, v245
    v_mfma_f32_16x16x32_bf16 v[240:243], a[232:235], v[192:195], v[240:243]
    s_waitcnt lgkmcnt(0)
    v_exp_f32 v246, v246
    v_mfma_f32_16x16x32_bf16 v[240:243], a[236:239], v[224:227], v[240:243]
    v_exp_f32 v247, v247
    v_cvt_pk_bf16_f32 v42, v244, v245
    v_cvt_pk_bf16_f32 v43, v246, v247
    v_mfma_f32_16x16x32_bf16 v[244:247], a[224:227], v[132:135], v[148:151]
    buffer_load_dwordx4 v1, s[36:39], s100 offen offset:2048 sc1 lds
    v_mfma_f32_16x16x32_bf16 v[244:247], a[228:231], v[164:167], v[244:247]
    v_exp_f32 v248, v248
    v_mfma_f32_16x16x32_bf16 v[244:247], a[232:235], v[196:199], v[244:247]
    v_exp_f32 v249, v249
    v_mfma_f32_16x16x32_bf16 v[244:247], a[236:239], v[228:231], v[244:247]
    v_exp_f32 v250, v250
    v_exp_f32 v251, v251
    v_cvt_pk_bf16_f32 v50, v248, v249
    v_cvt_pk_bf16_f32 v51, v250, v251
    v_mfma_f32_16x16x32_bf16 v[248:251], a[224:227], v[136:139], v[152:155]
    buffer_load_dwordx4 v1, s[36:39], s100 offen offset:3072 sc1 lds
    v_mfma_f32_16x16x32_bf16 v[248:251], a[228:231], v[168:171], v[248:251]
    ds_read_b128 a[240:243], v2 offset:12288
    ds_read_b128 a[244:247], v2 offset:13312
    v_mfma_f32_16x16x32_bf16 v[248:251], a[232:235], v[200:203], v[248:251]
    s_add_u32 s77, s77, 32768
    v_exp_f32 v252, v252
    v_mfma_f32_16x16x32_bf16 v[248:251], a[236:239], v[232:235], v[248:251]
    v_exp_f32 v253, v253
    v_exp_f32 v254, v254
    v_exp_f32 v255, v255
    v_cvt_pk_bf16_f32 v58, v252, v253
    v_cvt_pk_bf16_f32 v59, v254, v255
    v_mfma_f32_16x16x32_bf16 v[252:255], a[224:227], v[140:143], v[156:159]
    ds_read_b128 a[248:251], v2 offset:14336
    ds_read_b128 a[252:255], v2 offset:15360
    v_mfma_f32_16x16x32_bf16 v[252:255], a[228:231], v[172:175], v[252:255]
    v_add_f32 v215, s23, v144
    v_fma_f32 v188, v208, s19, v215
    v_mfma_f32_16x16x32_bf16 v[252:255], a[232:235], v[204:207], v[252:255]
    v_exp_f32 v240, v240
    v_mfma_f32_16x16x32_bf16 v[252:255], a[236:239], v[236:239], v[252:255]
    s_waitcnt lgkmcnt(2)
    v_exp_f32 v241, v241
    v_exp_f32 v242, v242
    v_exp_f32 v243, v243
    v_fma_f32 v189, v209, s19, v215
    v_fma_f32 v190, v210, s19, v215
    v_fma_f32 v191, v211, s19, v215
    v_cvt_pk_bf16_f32 v36, v240, v241
    v_cvt_pk_bf16_f32 v37, v242, v243
    v_mfma_f32_16x16x32_bf16 v[240:243], a[240:243], v[128:131], v[188:191]
    v_exp_f32 v244, v244
    v_mfma_f32_16x16x32_bf16 v[240:243], a[244:247], v[160:163], v[240:243]
    s_cmp_eq_u32 s82, 163840
    s_cselect_b32 s82, 0, s82
    v_add_u32 v2, s82, v1
    s_waitcnt lgkmcnt(0)
    v_mfma_f32_16x16x32_bf16 v[240:243], a[248:251], v[192:195], v[240:243]
    v_exp_f32 v245, v245
    v_mfma_f32_16x16x32_bf16 v[240:243], a[252:255], v[224:227], v[240:243]
    s_waitcnt vmcnt(8) lgkmcnt(0)
    s_barrier
    v_cvt_pk_bf16_f32 v44, v244, v245
    v_exp_f32 v246, v246
    v_exp_f32 v247, v247
    s_nop 0
    v_cvt_pk_bf16_f32 v45, v246, v247
    v_mfma_f32_16x16x32_bf16 v[244:247], a[240:243], v[132:135], v[148:151]
    ds_read_b128 a[224:227], v2 offset:0
    ds_read_b128 a[228:231], v2 offset:1024
    v_mfma_f32_16x16x32_bf16 v[244:247], a[244:247], v[164:167], v[244:247]
    v_exp_f32 v248, v248
    v_mfma_f32_16x16x32_bf16 v[244:247], a[248:251], v[196:199], v[244:247]
    v_exp_f32 v249, v249
    v_mfma_f32_16x16x32_bf16 v[244:247], a[252:255], v[228:231], v[244:247]
    v_exp_f32 v250, v250
    v_exp_f32 v251, v251
    v_cvt_pk_bf16_f32 v52, v248, v249
    v_cvt_pk_bf16_f32 v53, v250, v251
    v_mfma_f32_16x16x32_bf16 v[248:251], a[240:243], v[136:139], v[152:155]
    ds_read_b128 a[232:235], v2 offset:2048
    ds_read_b128 a[236:239], v2 offset:3072
    v_mfma_f32_16x16x32_bf16 v[248:251], a[244:247], v[168:171], v[248:251]
    ds_read_b128 v[96:99], v2 offset:16384
    v_mfma_f32_16x16x32_bf16 v[248:251], a[248:251], v[200:203], v[248:251]
    v_exp_f32 v252, v252
    v_mfma_f32_16x16x32_bf16 v[248:251], a[252:255], v[232:235], v[248:251]
    v_exp_f32 v253, v253
    v_exp_f32 v254, v254
    v_exp_f32 v255, v255
    v_cvt_pk_bf16_f32 v60, v252, v253
    v_cvt_pk_bf16_f32 v61, v254, v255
    v_mfma_f32_16x16x32_bf16 v[252:255], a[240:243], v[140:143], v[156:159]
    ds_read_b128 v[100:103], v2 offset:17408
    v_mfma_f32_16x16x32_bf16 v[252:255], a[244:247], v[172:175], v[252:255]
    v_exp_f32 v240, v240
    v_mfma_f32_16x16x32_bf16 v[252:255], a[248:251], v[204:207], v[252:255]
    s_sub_u32 s40, s56, 20971520
    s_subb_u32 s41, s57, 0
    v_mfma_f32_16x16x32_bf16 v[252:255], a[252:255], v[236:239], v[252:255]
    v_exp_f32 v241, v241
    v_exp_f32 v242, v242
    v_exp_f32 v243, v243
    v_exp_f32 v244, v244
    v_exp_f32 v245, v245
    v_exp_f32 v246, v246
    v_exp_f32 v247, v247
    v_exp_f32 v248, v248
    v_exp_f32 v249, v249
    v_exp_f32 v250, v250
    v_exp_f32 v251, v251
    v_exp_f32 v252, v252
    v_exp_f32 v253, v253
    v_cvt_pk_bf16_f32 v38, v240, v241
    v_cvt_pk_bf16_f32 v39, v242, v243
    v_cvt_pk_bf16_f32 v46, v244, v245
    v_cvt_pk_bf16_f32 v47, v246, v247
    v_cvt_pk_bf16_f32 v54, v248, v249
    v_cvt_pk_bf16_f32 v55, v250, v251
    v_cvt_pk_bf16_f32 v62, v252, v253
    s_cmp_eq_u32 s78, 0
    s_cbranch_scc1 K1_LB_END
.p2align 3
K1_LB:
    s_waitcnt lgkmcnt(0)
    v_mfma_f32_16x16x32_bf16 v[240:243], a[224:227], v[128:131], v[176:179]
    s_add_u32 m0, s76, s75
    v_exp_f32 v254, v254
    v_mfma_f32_16x16x32_bf16 v[240:243], a[228:231], v[160:163], v[240:243]
    s_mov_b32 s76, s60
    buffer_load_dwordx4 v1, s[36:39], s77 offen sc1 lds
    v_mfma_f32_16x16x32_bf16 v[240:243], a[232:235], v[192:195], v[240:243]
    s_mov_b32 s60, s82
    v_exp_f32 v255, v255
    v_mfma_f32_16x16x32_bf16 v[240:243], a[236:239], v[224:227], v[240:243]
    s_add_u32 s82, s82, 32768
    ds_read_b128 v[104:107], v2 offset:18432
    v_cvt_pk_bf16_f32 v63, v254, v255
    v_mfma_f32_16x16x32_bf16 a[0:3], v[96:99], v[32:35], a[0:3]
    ds_read_b128 v[108:111], v2 offset:19456
    ds_read_b128 a[240:243], v2 offset:4096
    v_mfma_f32_16x16x32_bf16 a[0:3], v[100:103], v[36:39], a[0:3]
    ds_read_b128 a[244:247], v2 offset:5120
    v_mfma_f32_16x16x32_bf16 a[4:7], v[96:99], v[40:43], a[4:7]
    v_exp_f32 v240, v240
    v_mfma_f32_16x16x32_bf16 a[4:7], v[100:103], v[44:47], a[4:7]
    ds_read_b128 a[248:251], v2 offset:6144
    ds_read_b128 a[252:255], v2 offset:7168
    v_mfma_f32_16x16x32_bf16 v[244:247], a[224:227], v[132:135], v[148:151]
    v_exp_f32 v241, v241
    v_mfma_f32_16x16x32_bf16 v[244:247], a[228:231], v[164:167], v[244:247]
    ds_read_b128 v[112:115], v2 offset:20480
    ds_read_b128 v[116:119], v2 offset:21504
    v_mfma_f32_16x16x32_bf16 v[244:247], a[232:235], v[196:199], v[244:247]
    v_exp_f32 v242, v242
    v_mfma_f32_16x16x32_bf16 v[244:247], a[236:239], v[228:231], v[244:247]
    v_exp_f32 v243, v243
    v_mfma_f32_16x16x32_bf16 a[8:11], v[96:99], v[48:51], a[8:11]
    v_cvt_pk_bf16_f32 v64, v240, v241
    v_cvt_pk_bf16_f32 v65, v242, v243
    v_mfma_f32_16x16x32_bf16 a[8:11], v[100:103], v[52:55], a[8:11]
    ds_read_b128 v[120:123], v2 offset:22528
    ds_read_b128 v[124:127], v2 offset:23552
    v_mfma_f32_16x16x32_bf16 a[12:15], v[96:99], v[56:59], a[12:15]
    v_exp_f32 v244, v244
    v_mfma_f32_16x16x32_bf16 a[12:15], v[100:103], v[60:63], a[12:15]
    buffer_load_dwordx4 v1, s[36:39], s77 offen offset:1024 sc1 lds
    v_mfma_f32_16x16x32_bf16 v[248:251], a[224:227], v[136:139], v[152:155]
    v_exp_f32 v245, v245
    v_mfma_f32_16x16x32_bf16 v[248:251], a[228:231], v[168:171], v[248:251]
    v_exp_f32 v246, v246
    v_mfma_f32_16x16x32_bf16 v[248:251], a[232:235], v[200:203], v[248:251]
    v_exp_f32 v247, v247
    v_mfma_f32_16x16x32_bf16 v[248:251], a[236:239], v[232:235], v[248:251]
    s_waitcnt lgkmcnt(0)
    v_cvt_pk_bf16_f32 v72, v244, v245
    v_cvt_pk_bf16_f32 v73, v246, v247
    v_mfma_f32_16x16x32_bf16 a[16:19], v[104:107], v[32:35], a[16:19]
    ds_read_b128 v[96:99], v2 offset:24576
    ds_read_b128 v[100:103], v2 offset:25600
    v_mfma_f32_16x16x32_bf16 a[16:19], v[108:111], v[36:39], a[16:19]
    v_mfma_f32_16x16x32_bf16 a[20:23], v[104:107], v[40:43], a[20:23]
    v_mfma_f32_16x16x32_bf16 a[20:23], v[108:111], v[44:47], a[20:23]
    v_exp_f32 v248, v248
    v_mfma_f32_16x16x32_bf16 v[252:255], a[224:227], v[140:143], v[156:159]
    v_exp_f32 v249, v249
    v_mfma_f32_16x16x32_bf16 v[252:255], a[228:231], v[172:175], v[252:255]
    v_exp_f32 v250, v250
    v_mfma_f32_16x16x32_bf16 v[252:255], a[232:235], v[204:207], v[252:255]
    v_exp_f32 v251, v251
    v_mfma_f32_16x16x32_bf16 v[252:255], a[236:239], v[236:239], v[252:255]
    v_cvt_pk_bf16_f32 v80, v248, v249
    v_cvt_pk_bf16_f32 v81, v250, v251
    v_mfma_f32_16x16x32_bf16 a[24:27], v[104:107], v[48:51], a[24:27]
    ds_read_b128 a[224:227], v2 offset:8192
    ds_read_b128 a[228:231], v2 offset:9216
    v_mfma_f32_16x16x32_bf16 a[24:27], v[108:111], v[52:55], a[24:27]
    buffer_load_dwordx4 v1, s[36:39], s77 offen offset:2048 sc1 lds
    v_mfma_f32_16x16x32_bf16 a[28:31], v[104:107], v[56:59], a[28:31]
    v_exp_f32 v252, v252
    v_mfma_f32_16x16x32_bf16 a[28:31], v[108:111], v[60:63], a[28:31]
    v_exp_f32 v253, v253
    v_mfma_f32_16x16x32_bf16 v[240:243], a[240:243], v[128:131], v[180:183]
    v_exp_f32 v254, v254
    v_mfma_f32_16x16x32_bf16 v[240:243], a[244:247], v[160:163], v[240:243]
    v_exp_f32 v255, v255
    v_mfma_f32_16x16x32_bf16 v[240:243], a[248:251], v[192:195], v[240:243]
    v_cvt_pk_bf16_f32 v88, v252, v253
    v_cvt_pk_bf16_f32 v89, v254, v255
    v_mfma_f32_16x16x32_bf16 v[240:243], a[252:255], v[224:227], v[240:243]
    ds_read_b128 a[232:235], v2 offset:10240
    ds_read_b128 a[236:239], v2 offset:11264
    v_mfma_f32_16x16x32_bf16 a[32:35], v[112:115], v[32:35], a[32:35]
    ds_read_b128 v[104:107], v2 offset:26624
    v_mfma_f32_16x16x32_bf16 a[32:35], v[116:119], v[36:39], a[32:35]
    ds_read_b128 v[108:111], v2 offset:27648
    v_mfma_f32_16x16x32_bf16 a[36:39], v[112:115], v[40:43], a[36:39]
    v_mfma_f32_16x16x32_bf16 a[36:39], v[116:119], v[44:47], a[36:39]
    v_exp_f32 v240, v240
    v_mfma_f32_16x16x32_bf16 v[244:247], a[240:243], v[132:135], v[148:151]
    v_exp_f32 v241, v241
    v_mfma_f32_16x16x32_bf16 v[244:247], a[244:247], v[164:167], v[244:247]
    v_exp_f32 v242, v242
    v_mfma_f32_16x16x32_bf16 v[244:247], a[248:251], v[196:199], v[244:247]
    v_exp_f32 v243, v243
    v_mfma_f32_16x16x32_bf16 v[244:247], a[252:255], v[228:231], v[244:247]
    buffer_load_dwordx4 v1, s[36:39], s77 offen offset:3072 sc1 lds
    v_mfma_f32_16x16x32_bf16 a[40:43], v[112:115], v[48:51], a[40:43]
    v_cvt_pk_bf16_f32 v66, v240, v241
    v_cvt_pk_bf16_f32 v67, v242, v243
    v_mfma_f32_16x16x32_bf16 a[40:43], v[116:119], v[52:55], a[40:43]
    v_mfma_f32_16x16x32_bf16 a[44:47], v[112:115], v[56:59], a[44:47]
    ds_read_b128 v[112:115], v2 offset:28672
    v_mfma_f32_16x16x32_bf16 a[44:47], v[116:119], v[60:63], a[44:47]
    v_exp_f32 v244, v244
    v_mfma_f32_16x16x32_bf16 v[248:251], a[240:243], v[136:139], v[152:155]
    v_exp_f32 v245, v245
    v_mfma_f32_16x16x32_bf16 v[248:251], a[244:247], v[168:171], v[248:251]
    v_exp_f32 v246, v246
    v_mfma_f32_16x16x32_bf16 v[248:251], a[248:251], v[200:203], v[248:251]
    v_exp_f32 v247, v247
    v_mfma_f32_16x16x32_bf16 v[248:251], a[252:255], v[232:235], v[248:251]
    v_cvt_pk_bf16_f32 v74, v244, v245
    v_cvt_pk_bf16_f32 v75, v246, v247
    v_mfma_f32_16x16x32_bf16 a[48:51], v[120:123], v[32:35], a[48:51]
    ds_read_b128 v[116:119], v2 offset:29696
    v_mfma_f32_16x16x32_bf16 a[48:51], v[124:127], v[36:39], a[48:51]
    v_mfma_f32_16x16x32_bf16 a[52:55], v[120:123], v[40:43], a[52:55]
    v_mfma_f32_16x16x32_bf16 a[52:55], v[124:127], v[44:47], a[52:55]
    v_mfma_f32_16x16x32_bf16 v[252:255], a[240:243], v[140:143], v[156:159]
    v_exp_f32 v248, v248
    v_mfma_f32_16x16x32_bf16 v[252:255], a[244:247], v[172:175], v[252:255]
    s_add_u32 s100, s77, 4096
    v_exp_f32 v249, v249
    v_mfma_f32_16x16x32_bf16 v[252:255], a[248:251], v[204:207], v[252:255]
    s_add_u32 m0, m0, 4096
    v_exp_f32 v250, v250
    v_mfma_f32_16x16x32_bf16 v[252:255], a[252:255], v[236:239], v[252:255]
    buffer_load_dwordx4 v1, s[36:39], s100 offen sc1 lds
    v_mfma_f32_16x16x32_bf16 a[56:59], v[120:123], v[48:51], a[56:59]
    v_exp_f32 v251, v251
    v_mfma_f32_16x16x32_bf16 a[56:59], v[124:127], v[52:55], a[56:59]
    v_cvt_pk_bf16_f32 v82, v248, v249
    v_cvt_pk_bf16_f32 v83, v250, v251
    v_mfma_f32_16x16x32_bf16 a[60:63], v[120:123], v[56:59], a[60:63]
    ds_read_b128 a[240:243], v2 offset:12288
    ds_read_b128 a[244:247], v2 offset:13312
    v_mfma_f32_16x16x32_bf16 a[60:63], v[124:127], v[60:63], a[60:63]
    s_waitcnt lgkmcnt(2)
    v_exp_f32 v252, v252
    v_mfma_f32_16x16x32_bf16 v[240:243], a[224:227], v[128:131], v[184:187]
    v_exp_f32 v253, v253
    v_mfma_f32_16x16x32_bf16 v[240:243], a[228:231], v[160:163], v[240:243]
    v_exp_f32 v254, v254
    v_mfma_f32_16x16x32_bf16 v[240:243], a[232:235], v[192:195], v[240:243]
    v_exp_f32 v255, v255
    v_mfma_f32_16x16x32_bf16 v[240:243], a[236:239], v[224:227], v[240:243]
    v_cvt_pk_bf16_f32 v90, v252, v253
    v_cvt_pk_bf16_f32 v91, v254, v255
    v_mfma_f32_16x16x32_bf16 a[144:147], v[96:99], v[32:35], a[144:147]
    ds_read_b128 a[248:251], v2 offset:14336
    ds_read_b128 a[252:255], v2 offset:15360
    v_mfma_f32_16x16x32_bf16 a[144:147], v[100:103], v[36:39], a[144:147]
    ds_read_b128 v[120:123], v2 offset:30720
    v_mfma_f32_16x16x32_bf16 a[148:151], v[96:99], v[40:43], a[148:151]
    v_exp_f32 v240, v240
    v_mfma_f32_16x16x32_bf16 a[148:151], v[100:103], v[44:47], a[148:151]
    v_exp_f32 v241, v241
    v_mfma_f32_16x16x32_bf16 v[244:247], a[224:227], v[132:135], v[148:151]
    buffer_load_dwordx4 v1, s[36:39], s100 offen offset:1024 sc1 lds
    v_mfma_f32_16x16x32_bf16 v[244:247], a[228:231], v[164:167], v[244:247]
    v_exp_f32 v242, v242
    v_mfma_f32_16x16x32_bf16 v[244:247], a[232:235], v[196:199], v[244:247]
    v_exp_f32 v243, v243
    v_mfma_f32_16x16x32_bf16 v[244:247], a[236:239], v[228:231], v[244:247]
    v_cvt_pk_bf16_f32 v68, v240, v241
    v_cvt_pk_bf16_f32 v69, v242, v243
    v_mfma_f32_16x16x32_bf16 a[152:155], v[96:99], v[48:51], a[152:155]
    ds_read_b128 v[124:127], v2 offset:31744
    v_mfma_f32_16x16x32_bf16 a[152:155], v[100:103], v[52:55], a[152:155]
    v_mfma_f32_16x16x32_bf16 a[156:159], v[96:99], v[56:59], a[156:159]
    v_mfma_f32_16x16x32_bf16 a[156:159], v[100:103], v[60:63], a[156:159]
    v_mfma_f32_16x16x32_bf16 v[248:251], a[224:227], v[136:139], v[152:155]
    v_exp_f32 v244, v244
    v_mfma_f32_16x16x32_bf16 v[248:251], a[228:231], v[168:171], v[248:251]
    v_exp_f32 v245, v245
    v_mfma_f32_16x16x32_bf16 v[248:251], a[232:235], v[200:203], v[248:251]
    v_exp_f32 v246, v246
    v_mfma_f32_16x16x32_bf16 v[248:251], a[236:239], v[232:235], v[248:251]
    v_exp_f32 v247, v247
    v_mfma_f32_16x16x32_bf16 a[160:163], v[104:107], v[32:35], a[160:163]
    v_cvt_pk_bf16_f32 v76, v244, v245
    v_cvt_pk_bf16_f32 v77, v246, v247
    v_mfma_f32_16x16x32_bf16 a[160:163], v[108:111], v[36:39], a[160:163]
    v_mfma_f32_16x16x32_bf16 a[164:167], v[104:107], v[40:43], a[164:167]
    buffer_load_dwordx4 v1, s[36:39], s100 offen offset:2048 sc1 lds
    v_mfma_f32_16x16x32_bf16 a[164:167], v[108:111], v[44:47], a[164:167]
    v_exp_f32 v248, v248
    v_mfma_f32_16x16x32_bf16 v[252:255], a[224:227], v[140:143], v[156:159]
    v_exp_f32 v249, v249
    v_mfma_f32_16x16x32_bf16 v[252:255], a[228:231], v[172:175], v[252:255]
    v_exp_f32 v250, v250
    v_mfma_f32_16x16x32_bf16 v[252:255], a[232:235], v[204:207], v[252:255]
    v_exp_f32 v251, v251
    v_mfma_f32_16x16x32_bf16 v[252:255], a[236:239], v[236:239], v[252:255]
    v_cvt_pk_bf16_f32 v84, v248, v249
    v_cvt_pk_bf16_f32 v85, v250, v251
    v_mfma_f32_16x16x32_bf16 a[168:171], v[104:107], v[48:51], a[168:171]
    v_mfma_f32_16x16x32_bf16 a[168:171], v[108:111], v[52:55], a[168:171]
    v_mfma_f32_16x16x32_bf16 a[172:175], v[104:107], v[56:59], a[172:175]
    v_mfma_f32_16x16x32_bf16 a[172:175], v[108:111], v[60:63], a[172:175]
    s_waitcnt lgkmcnt(0)
    v_mfma_f32_16x16x32_bf16 v[240:243], a[240:243], v[128:131], v[188:191]
    v_mfma_f32_16x16x32_bf16 v[240:243], a[244:247], v[160:163], v[240:243]
    v_exp_f32 v252, v252
    v_mfma_f32_16x16x32_bf16 v[240:243], a[248:251], v[192:195], v[240:243]
    v_exp_f32 v253, v253
    v_mfma_f32_16x16x32_bf16 v[240:243], a[252:255], v[224:227], v[240:243]
    v_exp_f32 v254, v254
    v_mfma_f32_16x16x32_bf16 a[176:179], v[112:115], v[32:35], a[176:179]
    buffer_load_dwordx4 v1, s[36:39], s100 offen offset:3072 sc1 lds
    v_mfma_f32_16x16x32_bf16 a[176:179], v[116:119], v[36:39], a[176:179]
    v_exp_f32 v255, v255
    v_mfma_f32_16x16x32_bf16 a[180:183], v[112:115], v[40:43], a[180:183]
    v_cvt_pk_bf16_f32 v92, v252, v253
    v_cvt_pk_bf16_f32 v93, v254, v255
    v_mfma_f32_16x16x32_bf16 a[180:183], v[116:119], v[44:47], a[180:183]
    s_cmp_eq_u32 s82, 163840
    s_cselect_b32 s82, 0, s82
    v_add_u32 v2, s82, v1
    v_mfma_f32_16x16x32_bf16 v[244:247], a[240:243], v[132:135], v[148:151]
    ds_read_b128 a[224:227], v2 offset:0
    ds_read_b128 a[228:231], v2 offset:1024
    v_mfma_f32_16x16x32_bf16 v[244:247], a[244:247], v[164:167], v[244:247]
    v_exp_f32 v240, v240
    v_mfma_f32_16x16x32_bf16 v[244:247], a[248:251], v[196:199], v[244:247]
    ds_read_b128 a[232:235], v2 offset:2048
    ds_read_b128 a[236:239], v2 offset:3072
    v_mfma_f32_16x16x32_bf16 v[244:247], a[252:255], v[228:231], v[244:247]
    v_exp_f32 v241, v241
    v_mfma_f32_16x16x32_bf16 a[184:187], v[112:115], v[48:51], a[184:187]
    ds_read_b128 v[96:99], v2 offset:16384
    ds_read_b128 v[100:103], v2 offset:17408
    v_mfma_f32_16x16x32_bf16 a[184:187], v[116:119], v[52:55], a[184:187]
    v_exp_f32 v242, v242
    v_mfma_f32_16x16x32_bf16 a[188:191], v[112:115], v[56:59], a[188:191]
    v_exp_f32 v243, v243
    v_mfma_f32_16x16x32_bf16 a[188:191], v[116:119], v[60:63], a[188:191]
    v_exp_f32 v244, v244
    v_mfma_f32_16x16x32_bf16 v[248:251], a[240:243], v[136:139], v[152:155]
    v_exp_f32 v245, v245
    v_mfma_f32_16x16x32_bf16 v[248:251], a[244:247], v[168:171], v[248:251]
    v_exp_f32 v246, v246
    v_mfma_f32_16x16x32_bf16 v[248:251], a[248:251], v[200:203], v[248:251]
    s_add_u32 s77, s77, 32768
    v_exp_f32 v247, v247
    v_mfma_f32_16x16x32_bf16 v[248:251], a[252:255], v[232:235], v[248:251]
    v_cvt_pk_bf16_f32 v70, v240, v241
    v_cvt_pk_bf16_f32 v71, v242, v243
    v_mfma_f32_16x16x32_bf16 a[192:195], v[120:123], v[32:35], a[192:195]
    v_cvt_pk_bf16_f32 v78, v244, v245
    v_cvt_pk_bf16_f32 v79, v246, v247
    v_mfma_f32_16x16x32_bf16 a[192:195], v[124:127], v[36:39], a[192:195]
    v_mfma_f32_16x16x32_bf16 a[196:199], v[120:123], v[40:43], a[196:199]
    v_mfma_f32_16x16x32_bf16 a[196:199], v[124:127], v[44:47], a[196:199]
    v_exp_f32 v248, v248
    v_mfma_f32_16x16x32_bf16 v[252:255], a[240:243], v[140:143], v[156:159]
    v_exp_f32 v249, v249
    v_mfma_f32_16x16x32_bf16 v[252:255], a[244:247], v[172:175], v[252:255]
    v_exp_f32 v250, v250
    v_mfma_f32_16x16x32_bf16 v[252:255], a[248:251], v[204:207], v[252:255]
    v_exp_f32 v251, v251
    v_mfma_f32_16x16x32_bf16 v[252:255], a[252:255], v[236:239], v[252:255]
    v_cvt_pk_bf16_f32 v86, v248, v249
    v_cvt_pk_bf16_f32 v87, v250, v251
    v_mfma_f32_16x16x32_bf16 a[200:203], v[120:123], v[48:51], a[200:203]
    v_mfma_f32_16x16x32_bf16 a[200:203], v[124:127], v[52:55], a[200:203]
    v_mfma_f32_16x16x32_bf16 a[204:207], v[120:123], v[56:59], a[204:207]
    v_mfma_f32_16x16x32_bf16 a[204:207], v[124:127], v[60:63], a[204:207]
    v_mfma_f32_16x16x32_bf16 a[208:211], a[136:139], v[32:35], a[208:211]
    v_mfma_f32_16x16x32_bf16 a[208:211], a[136:139], v[36:39], a[208:211]
    v_exp_f32 v252, v252
    v_mfma_f32_16x16x32_bf16 a[212:215], a[136:139], v[40:43], a[212:215]
    v_exp_f32 v253, v253
    v_mfma_f32_16x16x32_bf16 a[212:215], a[136:139], v[44:47], a[212:215]
    v_cvt_pk_bf16_f32 v94, v252, v253
    v_mfma_f32_16x16x32_bf16 a[216:219], a[136:139], v[48:51], a[216:219]
    v_mfma_f32_16x16x32_bf16 a[216:219], a[136:139], v[52:55], a[216:219]
    v_mfma_f32_16x16x32_bf16 a[220:223], a[136:139], v[56:59], a[220:223]
    v_mfma_f32_16x16x32_bf16 a[220:223], a[136:139], v[60:63], a[220:223]
    s_cmp_le_u32 s78, 1
    s_cbranch_scc1 K1_LB_MASK
K1_LB_BACK:
    s_waitcnt lgkmcnt(0)
    v_mfma_f32_16x16x32_bf16 v[240:243], a[224:227], v[128:131], v[176:179]
    s_add_u32 m0, s76, s75
    v_exp_f32 v254, v254
    v_mfma_f32_16x16x32_bf16 v[240:243], a[228:231], v[160:163], v[240:243]
    s_mov_b32 s76, s60
    buffer_load_dwordx4 v1, s[36:39], s77 offen sc1 lds
    v_mfma_f32_16x16x32_bf16 v[240:243], a[232:235], v[192:195], v[240:243]
    s_mov_b32 s60, s82
    v_exp_f32 v255, v255
    v_mfma_f32_16x16x32_bf16 v[240:243], a[236:239], v[224:227], v[240:243]
    s_add_u32 s82, s82, 32768
    ds_read_b128 v[104:107], v2 offset:18432
    v_cvt_pk_bf16_f32 v95, v254, v255
    v_mfma_f32_16x16x32_bf16 a[0:3], v[96:99], v[64:67], a[0:3]
    ds_read_b128 v[108:111], v2 offset:19456
    ds_read_b128 a[240:243], v2 offset:4096
    v_mfma_f32_16x16x32_bf16 a[0:3], v[100:103], v[68:71], a[0:3]
    ds_read_b128 a[244:247], v2 offset:5120
    v_mfma_f32_16x16x32_bf16 a[4:7], v[96:99], v[72:75], a[4:7]
    v_exp_f32 v240, v240
    v_mfma_f32_16x16x32_bf16 a[4:7], v[100:103], v[76:79], a[4:7]
    ds_read_b128 a[248:251], v2 offset:6144
    ds_read_b128 a[252:255], v2 offset:7168
    v_mfma_f32_16x16x32_bf16 v[244:247], a[224:227], v[132:135], v[148:151]
    v_exp_f32 v241, v241
    v_mfma_f32_16x16x32_bf16 v[244:247], a[228:231], v[164:167], v[244:247]
    ds_read_b128 v[112:115], v2 offset:20480
    ds_read_b128 v[116:119], v2 offset:21504
    v_mfma_f32_16x16x32_bf16 v[244:247], a[232:235], v[196:199], v[244:247]
    v_exp_f32 v242, v242
    v_mfma_f32_16x16x32_bf16 v[244:247], a[236:239], v[228:231], v[244:247]
    v_exp_f32 v243, v243
    v_mfma_f32_16x16x32_bf16 a[8:11], v[96:99], v[80:83], a[8:11]
    v_cvt_pk_bf16_f32 v32, v240, v241
    v_cvt_pk_bf16_f32 v33, v242, v243
    v_mfma_f32_16x16x32_bf16 a[8:11], v[100:103], v[84:87], a[8:11]
    ds_read_b128 v[120:123], v2 offset:22528
    ds_read_b128 v[124:127], v2 offset:23552
    v_mfma_f32_16x16x32_bf16 a[12:15], v[96:99], v[88:91], a[12:15]
    v_exp_f32 v244, v244
    v_mfma_f32_16x16x32_bf16 a[12:15], v[100:103], v[92:95], a[12:15]
    buffer_load_dwordx4 v1, s[36:39], s77 offen offset:1024 sc1 lds
    v_mfma_f32_16x16x32_bf16 v[248:251], a[224:227], v[136:139], v[152:155]
    v_exp_f32 v245, v245
    v_mfma_f32_16x16x32_bf16 v[248:251], a[228:231], v[168:171], v[248:251]
    v_exp_f32 v246, v246
    v_mfma_f32_16x16x32_bf16 v[248:251], a[232:235], v[200:203], v[248:251]
    v_exp_f32 v247, v247
    v_mfma_f32_16x16x32_bf16 v[248:251], a[236:239], v[232:235], v[248:251]
    s_waitcnt lgkmcnt(0)
    v_cvt_pk_bf16_f32 v40, v244, v245
    v_cvt_pk_bf16_f32 v41, v246, v247
    v_mfma_f32_16x16x32_bf16 a[16:19], v[104:107], v[64:67], a[16:19]
    ds_read_b128 v[96:99], v2 offset:24576
    ds_read_b128 v[100:103], v2 offset:25600
    v_mfma_f32_16x16x32_bf16 a[16:19], v[108:111], v[68:71], a[16:19]
    v_mfma_f32_16x16x32_bf16 a[20:23], v[104:107], v[72:75], a[20:23]
    v_mfma_f32_16x16x32_bf16 a[20:23], v[108:111], v[76:79], a[20:23]
    v_exp_f32 v248, v248
    v_mfma_f32_16x16x32_bf16 v[252:255], a[224:227], v[140:143], v[156:159]
    v_exp_f32 v249, v249
    v_mfma_f32_16x16x32_bf16 v[252:255], a[228:231], v[172:175], v[252:255]
    v_exp_f32 v250, v250
    v_mfma_f32_16x16x32_bf16 v[252:255], a[232:235], v[204:207], v[252:255]
    v_exp_f32 v251, v251
    v_mfma_f32_16x16x32_bf16 v[252:255], a[236:239], v[236:239], v[252:255]
    v_cvt_pk_bf16_f32 v48, v248, v249
    v_cvt_pk_bf16_f32 v49, v250, v251
    v_mfma_f32_16x16x32_bf16 a[24:27], v[104:107], v[80:83], a[24:27]
    ds_read_b128 a[224:227], v2 offset:8192
    ds_read_b128 a[228:231], v2 offset:9216
    v_mfma_f32_16x16x32_bf16 a[24:27], v[108:111], v[84:87], a[24:27]
    buffer_load_dwordx4 v1, s[36:39], s77 offen offset:2048 sc1 lds
    v_mfma_f32_16x16x32_bf16 a[28:31], v[104:107], v[88:91], a[28:31]
    v_exp_f32 v252, v252
    v_mfma_f32_16x16x32_bf16 a[28:31], v[108:111], v[92:95], a[28:31]
    v_exp_f32 v253, v253
    v_mfma_f32_16x16x32_bf16 v[240:243], a[240:243], v[128:131], v[180:183]
    v_exp_f32 v254, v254
    v_mfma_f32_16x16x32_bf16 v[240:243], a[244:247], v[160:163], v[240:243]
    v_exp_f32 v255, v255
    v_mfma_f32_16x16x32_bf16 v[240:243], a[248:251], v[192:195], v[240:243]
    v_cvt_pk_bf16_f32 v56, v252, v253
    v_cvt_pk_bf16_f32 v57, v254, v255
    v_mfma_f32_16x16x32_bf16 v[240:243], a[252:255], v[224:227], v[240:243]
    ds_read_b128 a[232:235], v2 offset:10240
    ds_read_b128 a[236:239], v2 offset:11264
    v_mfma_f32_16x16x32_bf16 a[32:35], v[112:115], v[64:67], a[32:35]
    ds_read_b128 v[104:107], v2 offset:26624
    v_mfma_f32_16x16x32_bf16 a[32:35], v[116:119], v[68:71], a[32:35]
    ds_read_b128 v[108:111], v2 offset:27648
    v_mfma_f32_16x16x32_bf16 a[36:39], v[112:115], v[72:75], a[36:39]
    v_mfma_f32_16x16x32_bf16 a[36:39], v[116:119], v[76:79], a[36:39]
    v_exp_f32 v240, v240
    v_mfma_f32_16x16x32_bf16 v[244:247], a[240:243], v[132:135], v[148:151]
    v_exp_f32 v241, v241
    v_mfma_f32_16x16x32_bf16 v[244:247], a[244:247], v[164:167], v[244:247]
    v_exp_f32 v242, v242
    v_mfma_f32_16x16x32_bf16 v[244:247], a[248:251], v[196:199], v[244:247]
    v_exp_f32 v243, v243
    v_mfma_f32_16x16x32_bf16 v[244:247], a[252:255], v[228:231], v[244:247]
    buffer_load_dwordx4 v1, s[36:39], s77 offen offset:3072 sc1 lds
    v_mfma_f32_16x16x32_bf16 a[40:43], v[112:115], v[80:83], a[40:43]
    v_cvt_pk_bf16_f32 v34, v240, v241
    v_cvt_pk_bf16_f32 v35, v242, v243
    v_mfma_f32_16x16x32_bf16 a[40:43], v[116:119], v[84:87], a[40:43]
    v_mfma_f32_16x16x32_bf16 a[44:47], v[112:115], v[88:91], a[44:47]
    ds_read_b128 v[112:115], v2 offset:28672
    v_mfma_f32_16x16x32_bf16 a[44:47], v[116:119], v[92:95], a[44:47]
    v_exp_f32 v244, v244
    v_mfma_f32_16x16x32_bf16 v[248:251], a[240:243], v[136:139], v[152:155]
    v_exp_f32 v245, v245
    v_mfma_f32_16x16x32_bf16 v[248:251], a[244:247], v[168:171], v[248:251]
    v_exp_f32 v246, v246
    v_mfma_f32_16x16x32_bf16 v[248:251], a[248:251], v[200:203], v[248:251]
    v_exp_f32 v247, v247
    v_mfma_f32_16x16x32_bf16 v[248:251], a[252:255], v[232:235], v[248:251]
    v_cvt_pk_bf16_f32 v42, v244, v245
    v_cvt_pk_bf16_f32 v43, v246, v247
    v_mfma_f32_16x16x32_bf16 a[48:51], v[120:123], v[64:67], a[48:51]
    ds_read_b128 v[116:119], v2 offset:29696
    v_mfma_f32_16x16x32_bf16 a[48:51], v[124:127], v[68:71], a[48:51]
    v_mfma_f32_16x16x32_bf16 a[52:55], v[120:123], v[72:75], a[52:55]
    v_mfma_f32_16x16x32_bf16 a[52:55], v[124:127], v[76:79], a[52:55]
    v_mfma_f32_16x16x32_bf16 v[252:255], a[240:243], v[140:143], v[156:159]
    v_exp_f32 v248, v248
    v_mfma_f32_16x16x32_bf16 v[252:255], a[244:247], v[172:175], v[252:255]
    s_add_u32 s100, s77, 4096
    v_exp_f32 v249, v249
    v_mfma_f32_16x16x32_bf16 v[252:255], a[248:251], v[204:207], v[252:255]
    s_add_u32 m0, m0, 4096
    v_exp_f32 v250, v250
    v_mfma_f32_16x16x32_bf16 v[252:255], a[252:255], v[236:239], v[252:255]
    buffer_load_dwordx4 v1, s[36:39], s100 offen sc1 lds
    v_mfma_f32_16x16x32_bf16 a[56:59], v[120:123], v[80:83], a[56:59]
    v_exp_f32 v251, v251
    v_mfma_f32_16x16x32_bf16 a[56:59], v[124:127], v[84:87], a[56:59]
    v_cvt_pk_bf16_f32 v50, v248, v249
    v_cvt_pk_bf16_f32 v51, v250, v251
    v_mfma_f32_16x16x32_bf16 a[60:63], v[120:123], v[88:91], a[60:63]
    ds_read_b128 a[240:243], v2 offset:12288
    ds_read_b128 a[244:247], v2 offset:13312
    v_mfma_f32_16x16x32_bf16 a[60:63], v[124:127], v[92:95], a[60:63]
    s_waitcnt lgkmcnt(2)
    v_exp_f32 v252, v252
    v_mfma_f32_16x16x32_bf16 v[240:243], a[224:227], v[128:131], v[184:187]
    v_exp_f32 v253, v253
    v_mfma_f32_16x16x32_bf16 v[240:243], a[228:231], v[160:163], v[240:243]
    v_exp_f32 v254, v254
    v_mfma_f32_16x16x32_bf16 v[240:243], a[232:235], v[192:195], v[240:243]
    v_exp_f32 v255, v255
    v_mfma_f32_16x16x32_bf16 v[240:243], a[236:239], v[224:227], v[240:243]
    v_cvt_pk_bf16_f32 v58, v252, v253
    v_cvt_pk_bf16_f32 v59, v254, v255
    v_mfma_f32_16x16x32_bf16 a[144:147], v[96:99], v[64:67], a[144:147]
    ds_read_b128 a[248:251], v2 offset:14336
    ds_read_b128 a[252:255], v2 offset:15360
    v_mfma_f32_16x16x32_bf16 a[144:147], v[100:103], v[68:71], a[144:147]
    ds_read_b128 v[120:123], v2 offset:30720
    v_mfma_f32_16x16x32_bf16 a[148:151], v[96:99], v[72:75], a[148:151]
    v_exp_f32 v240, v240
    v_mfma_f32_16x16x32_bf16 a[148:151], v[100:103], v[76:79], a[148:151]
    v_exp_f32 v241, v241
    v_mfma_f32_16x16x32_bf16 v[244:247], a[224:227], v[132:135], v[148:151]
    buffer_load_dwordx4 v1, s[36:39], s100 offen offset:1024 sc1 lds
    v_mfma_f32_16x16x32_bf16 v[244:247], a[228:231], v[164:167], v[244:247]
    v_exp_f32 v242, v242
    v_mfma_f32_16x16x32_bf16 v[244:247], a[232:235], v[196:199], v[244:247]
    v_exp_f32 v243, v243
    v_mfma_f32_16x16x32_bf16 v[244:247], a[236:239], v[228:231], v[244:247]
    v_cvt_pk_bf16_f32 v36, v240, v241
    v_cvt_pk_bf16_f32 v37, v242, v243
    v_mfma_f32_16x16x32_bf16 a[152:155], v[96:99], v[80:83], a[152:155]
    ds_read_b128 v[124:127], v2 offset:31744
    v_mfma_f32_16x16x32_bf16 a[152:155], v[100:103], v[84:87], a[152:155]
    v_mfma_f32_16x16x32_bf16 a[156:159], v[96:99], v[88:91], a[156:159]
    v_mfma_f32_16x16x32_bf16 a[156:159], v[100:103], v[92:95], a[156:159]
    v_mfma_f32_16x16x32_bf16 v[248:251], a[224:227], v[136:139], v[152:155]
    v_exp_f32 v244, v244
    v_mfma_f32_16x16x32_bf16 v[248:251], a[228:231], v[168:171], v[248:251]
    v_exp_f32 v245, v245
    v_mfma_f32_16x16x32_bf16 v[248:251], a[232:235], v[200:203], v[248:251]
    v_exp_f32 v246, v246
    v_mfma_f32_16x16x32_bf16 v[248:251], a[236:239], v[232:235], v[248:251]
    v_exp_f32 v247, v247
    v_mfma_f32_16x16x32_bf16 a[160:163], v[104:107], v[64:67], a[160:163]
    v_cvt_pk_bf16_f32 v44, v244, v245
    v_cvt_pk_bf16_f32 v45, v246, v247
    v_mfma_f32_16x16x32_bf16 a[160:163], v[108:111], v[68:71], a[160:163]
    v_mfma_f32_16x16x32_bf16 a[164:167], v[104:107], v[72:75], a[164:167]
    buffer_load_dwordx4 v1, s[36:39], s100 offen offset:2048 sc1 lds
    v_mfma_f32_16x16x32_bf16 a[164:167], v[108:111], v[76:79], a[164:167]
    v_exp_f32 v248, v248
    v_mfma_f32_16x16x32_bf16 v[252:255], a[224:227], v[140:143], v[156:159]
    v_exp_f32 v249, v249
    v_mfma_f32_16x16x32_bf16 v[252:255], a[228:231], v[172:175], v[252:255]
    v_exp_f32 v250, v250
    v_mfma_f32_16x16x32_bf16 v[252:255], a[232:235], v[204:207], v[252:255]
    v_exp_f32 v251, v251
    v_mfma_f32_16x16x32_bf16 v[252:255], a[236:239], v[236:239], v[252:255]
    v_cvt_pk_bf16_f32 v52, v248, v249
    v_cvt_pk_bf16_f32 v53, v250, v251
    v_mfma_f32_16x16x32_bf16 a[168:171], v[104:107], v[80:83], a[168:171]
    v_mfma_f32_16x16x32_bf16 a[168:171], v[108:111], v[84:87], a[168:171]
    v_mfma_f32_16x16x32_bf16 a[172:175], v[104:107], v[88:91], a[172:175]
    v_mfma_f32_16x16x32_bf16 a[172:175], v[108:111], v[92:95], a[172:175]
    s_waitcnt lgkmcnt(0)
    v_mfma_f32_16x16x32_bf16 v[240:243], a[240:243], v[128:131], v[188:191]
    v_mfma_f32_16x16x32_bf16 v[240:243], a[244:247], v[160:163], v[240:243]
    v_exp_f32 v252, v252
    v_mfma_f32_16x16x32_bf16 v[240:243], a[248:251], v[192:195], v[240:243]
    v_exp_f32 v253, v253
    v_mfma_f32_16x16x32_bf16 v[240:243], a[252:255], v[224:227], v[240:243]
    v_exp_f32 v254, v254
    v_mfma_f32_16x16x32_bf16 a[176:179], v[112:115], v[64:67], a[176:179]
    buffer_load_dwordx4 v1, s[36:39], s100 offen offset:3072 sc1 lds
    v_mfma_f32_16x16x32_bf16 a[176:179], v[116:119], v[68:71], a[176:179]
    v_exp_f32 v255, v255
    v_mfma_f32_16x16x32_bf16 a[180:183], v[112:115], v[72:75], a[180:183]
    v_cvt_pk_bf16_f32 v60, v252, v253
    v_cvt_pk_bf16_f32 v61, v254, v255
    v_mfma_f32_16x16x32_bf16 a[180:183], v[116:119], v[76:79], a[180:183]
    s_cmp_eq_u32 s82, 163840
    s_cselect_b32 s82, 0, s82
    v_add_u32 v2, s82, v1
    v_mfma_f32_16x16x32_bf16 v[244:247], a[240:243], v[132:135], v[148:151]
    v_exp_f32 v240, v240
    v_mfma_f32_16x16x32_bf16 v[244:247], a[244:247], v[164:167], v[244:247]
    v_exp_f32 v241, v241
    v_mfma_f32_16x16x32_bf16 v[244:247], a[248:251], v[196:199], v[244:247]
    v_exp_f32 v242, v242
    v_mfma_f32_16x16x32_bf16 v[244:247], a[252:255], v[228:231], v[244:247]
    v_exp_f32 v243, v243
    v_mfma_f32_16x16x32_bf16 a[184:187], v[112:115], v[80:83], a[184:187]
    v_cvt_pk_bf16_f32 v38, v240, v241
    v_cvt_pk_bf16_f32 v39, v242, v243
    v_mfma_f32_16x16x32_bf16 a[184:187], v[116:119], v[84:87], a[184:187]
    v_mfma_f32_16x16x32_bf16 a[188:191], v[112:115], v[88:91], a[188:191]
    v_mfma_f32_16x16x32_bf16 a[188:191], v[116:119], v[92:95], a[188:191]
    v_mfma_f32_16x16x32_bf16 v[248:251], a[240:243], v[136:139], v[152:155]
    v_exp_f32 v244, v244
    v_mfma_f32_16x16x32_bf16 v[248:251], a[244:247], v[168:171], v[248:251]
    v_exp_f32 v245, v245
    v_mfma_f32_16x16x32_bf16 v[248:251], a[248:251], v[200:203], v[248:251]
    s_add_u32 s77, s77, 32768
    v_exp_f32 v246, v246
    v_mfma_f32_16x16x32_bf16 v[248:251], a[252:255], v[232:235], v[248:251]
    v_exp_f32 v247, v247
    v_mfma_f32_16x16x32_bf16 a[192:195], v[120:123], v[64:67], a[192:195]
    v_cvt_pk_bf16_f32 v46, v244, v245
    v_cvt_pk_bf16_f32 v47, v246, v247
    v_mfma_f32_16x16x32_bf16 a[192:195], v[124:127], v[68:71], a[192:195]
    v_mfma_f32_16x16x32_bf16 a[196:199], v[120:123], v[72:75], a[196:199]
    v_mfma_f32_16x16x32_bf16 a[196:199], v[124:127], v[76:79], a[196:199]
    v_mfma_f32_16x16x32_bf16 v[252:255], a[240:243], v[140:143], v[156:159]
    v_exp_f32 v248, v248
    v_mfma_f32_16x16x32_bf16 v[252:255], a[244:247], v[172:175], v[252:255]
    v_exp_f32 v249, v249
    v_mfma_f32_16x16x32_bf16 v[252:255], a[248:251], v[204:207], v[252:255]
    v_exp_f32 v250, v250
    v_mfma_f32_16x16x32_bf16 v[252:255], a[252:255], v[236:239], v[252:255]
    s_waitcnt vmcnt(8) lgkmcnt(0)
    s_barrier
    ds_read_b128 a[224:227], v2 offset:0
    v_mfma_f32_16x16x32_bf16 a[200:203], v[120:123], v[80:83], a[200:203]
    ds_read_b128 a[228:231], v2 offset:1024
    ds_read_b128 a[232:235], v2 offset:2048
    v_mfma_f32_16x16x32_bf16 a[200:203], v[124:127], v[84:87], a[200:203]
    ds_read_b128 a[236:239], v2 offset:3072
    v_cvt_pk_bf16_f32 v54, v248, v249
    v_mfma_f32_16x16x32_bf16 a[204:207], v[120:123], v[88:91], a[204:207]
    v_exp_f32 v251, v251
    v_mfma_f32_16x16x32_bf16 a[204:207], v[124:127], v[92:95], a[204:207]
    ds_read_b128 v[96:99], v2 offset:16384
    ds_read_b128 v[100:103], v2 offset:17408
    v_mfma_f32_16x16x32_bf16 a[208:211], a[136:139], v[64:67], a[208:211]
    v_exp_f32 v252, v252
    v_mfma_f32_16x16x32_bf16 a[208:211], a[136:139], v[68:71], a[208:211]
    v_exp_f32 v253, v253
    v_mfma_f32_16x16x32_bf16 a[212:215], a[136:139], v[72:75], a[212:215]
    v_cvt_pk_bf16_f32 v55, v250, v251
    v_cvt_pk_bf16_f32 v62, v252, v253
    v_mfma_f32_16x16x32_bf16 a[212:215], a[136:139], v[76:79], a[212:215]
    v_mfma_f32_16x16x32_bf16 a[216:219], a[136:139], v[80:83], a[216:219]
    v_mfma_f32_16x16x32_bf16 a[216:219], a[136:139], v[84:87], a[216:219]
    v_mfma_f32_16x16x32_bf16 a[220:223], a[136:139], v[88:91], a[220:223]
    v_mfma_f32_16x16x32_bf16 a[220:223], a[136:139], v[92:95], a[220:223]
    s_sub_u32 s78, s78, 1
    s_cmp_lg_u32 s78, 0
    s_cbranch_scc1 K1_LB
K1_LB_END:
    v_add_f32 v212, s12, v148
    v_fma_f32 v176, v208, s8, v212
    v_fma_f32 v177, v209, s8, v212
    v_fma_f32 v178, v210, s8, v212
    v_fma_f32 v179, v211, s8, v212
    s_nop 1
    s_waitcnt lgkmcnt(0)
    v_mfma_f32_16x16x32_bf16 v[240:243], a[224:227], v[132:135], v[176:179]
    s_mov_b32 s7, 0
    ds_read_b128 v[104:107], v2 offset:18432
    ds_read_b128 v[108:111], v2 offset:19456
    v_mfma_f32_16x16x32_bf16 v[240:243], a[228:231], v[164:167], v[240:243]
    s_lshl_b32 s29, s6, 2
    buffer_load_dwordx4 v[64:67], v11, s[48:51], s7 offen nt
    v_mfma_f32_16x16x32_bf16 v[240:243], a[232:235], v[196:199], v[240:243]
    s_mov_b32 s7, 18432
    v_exp_f32 v254, v254
    v_mfma_f32_16x16x32_bf16 v[240:243], a[236:239], v[228:231], v[240:243]
    s_lshr_b32 s29, 0x41302413, s29
    v_exp_f32 v255, v255
    v_mfma_f32_16x16x32_bf16 a[0:3], v[96:99], v[32:35], a[0:3]
    s_and_b32 s29, s29, 7
    v_cvt_pk_bf16_f32 v63, v254, v255
    ds_read_b128 a[240:243], v2 offset:4096
    v_mfma_f32_16x16x32_bf16 a[0:3], v[100:103], v[36:39], a[0:3]
    s_lshl_b32 s29, s29, 15
    buffer_load_dwordx4 v[68:71], v11, s[48:51], s7 offen nt
    v_mfma_f32_16x16x32_bf16 a[4:7], v[96:99], v[40:43], a[4:7]
    s_mov_b32 s7, 9216
    ds_read_b128 a[244:247], v2 offset:5120
    ds_read_b128 a[248:251], v2 offset:6144
    v_mfma_f32_16x16x32_bf16 a[4:7], v[100:103], v[44:47], a[4:7]
    s_add_u32 s44, s29, s75
    ds_read_b128 a[252:255], v2 offset:7168
    v_add_f32 v213, s13, v148
    v_mfma_f32_16x16x32_bf16 v[244:247], a[224:227], v[136:139], v[152:155]
    s_lshl_b32 s29, s6, 2
    ds_read_b128 v[112:115], v2 offset:20480
    v_fma_f32 v180, v208, s9, v213
    v_mfma_f32_16x16x32_bf16 v[244:247], a[228:231], v[168:171], v[244:247]
    s_lshr_b32 s29, 0x2413024, s29
    buffer_load_dwordx4 v[20:23], v11, s[48:51], s7 offen nt
    v_mfma_f32_16x16x32_bf16 v[244:247], a[232:235], v[200:203], v[244:247]
    s_mov_b32 s7, 27648
    ds_read_b128 v[116:119], v2 offset:21504
    v_fma_f32 v181, v209, s9, v213
    v_mfma_f32_16x16x32_bf16 v[244:247], a[236:239], v[232:235], v[244:247]
    s_and_b32 s29, s29, 7
    v_fma_f32 v182, v210, s9, v213
    v_fma_f32 v183, v211, s9, v213
    v_mfma_f32_16x16x32_bf16 a[8:11], v[96:99], v[48:51], a[8:11]
    s_lshl_b32 s29, s29, 15
    v_exp_f32 v240, v240
    v_mfma_f32_16x16x32_bf16 a[8:11], v[100:103], v[52:55], a[8:11]
    s_add_u32 s45, s29, s75
    buffer_load_dwordx4 v[24:27], v11, s[48:51], s7 offen nt
    v_mfma_f32_16x16x32_bf16 a[12:15], v[96:99], v[56:59], a[12:15]
    s_lshl_b32 s29, s6, 2
    v_exp_f32 v241, v241
    v_mfma_f32_16x16x32_bf16 a[12:15], v[100:103], v[60:63], a[12:15]
    s_lshr_b32 s29, 0x13024130, s29
    v_exp_f32 v242, v242
    s_waitcnt lgkmcnt(0)
    v_mfma_f32_16x16x32_bf16 a[16:19], v[104:107], v[32:35], a[16:19]
    s_and_b32 s29, s29, 7
    v_exp_f32 v243, v243
    v_mfma_f32_16x16x32_bf16 a[16:19], v[108:111], v[36:39], a[16:19]
    s_lshl_b32 s29, s29, 15
    buffer_load_dwordx4 v[144:147], v12, s[52:55], 0 offen nt
    v_mfma_f32_16x16x32_bf16 v[248:251], a[224:227], v[140:143], v[156:159]
    s_add_u32 s46, s29, s75
    v_cvt_pk_bf16_f32 v72, v240, v241
    v_cvt_pk_bf16_f32 v73, v242, v243
    v_mfma_f32_16x16x32_bf16 v[248:251], a[228:231], v[172:175], v[248:251]
    s_lshl_b32 s29, s6, 2
    ds_read_b128 v[120:123], v2 offset:22528
    ds_read_b128 v[124:127], v2 offset:23552
    v_mfma_f32_16x16x32_bf16 v[248:251], a[232:235], v[204:207], v[248:251]
    s_lshr_b32 s29, 0x24130241, s29
    v_exp_f32 v244, v244
    v_mfma_f32_16x16x32_bf16 v[248:251], a[236:239], v[236:239], v[248:251]
    s_and_b32 s29, s29, 7
    buffer_load_dwordx4 a[140:143], v13, s[52:55], 0 offen nt
    v_mfma_f32_16x16x32_bf16 a[20:23], v[104:107], v[40:43], a[20:23]
    s_lshl_b32 s29, s29, 15
    v_exp_f32 v245, v245
    v_mfma_f32_16x16x32_bf16 a[20:23], v[108:111], v[44:47], a[20:23]
    s_mov_b32 s98, 0x3fb8aa3b
    v_exp_f32 v246, v246
    v_mfma_f32_16x16x32_bf16 a[24:27], v[104:107], v[48:51], a[24:27]
    s_add_u32 s47, s29, s75
    v_exp_f32 v247, v247
    v_mfma_f32_16x16x32_bf16 a[24:27], v[108:111], v[52:55], a[24:27]
    s_lshl_b32 s29, s6, 2
    v_cvt_pk_bf16_f32 v80, v244, v245
    v_cvt_pk_bf16_f32 v81, v246, v247
    v_mfma_f32_16x16x32_bf16 a[28:31], v[104:107], v[56:59], a[28:31]
    s_lshr_b32 s29, 0x30241302, s29
    ds_read_b128 a[224:227], v2 offset:8192
    ds_read_b128 a[228:231], v2 offset:9216
    v_mfma_f32_16x16x32_bf16 a[28:31], v[108:111], v[60:63], a[28:31]
    s_lshr_b32 s61, s5, 3
    ds_read_b128 a[232:235], v2 offset:10240
    v_add_f32 v214, s14, v148
    v_mfma_f32_16x16x32_bf16 v[252:255], a[240:243], v[132:135], v[180:183]
    s_add_u32 s3, s5, s6
    ds_read_b128 a[236:239], v2 offset:11264
    v_fma_f32 v184, v208, s10, v214
    v_mfma_f32_16x16x32_bf16 v[252:255], a[244:247], v[164:167], v[252:255]
    s_and_b32 s29, s29, 7
    ds_read_b128 v[96:99], v2 offset:24576
    v_fma_f32 v185, v209, s10, v214
    v_mfma_f32_16x16x32_bf16 v[252:255], a[248:251], v[196:199], v[252:255]
    s_add_u32 s74, s4, 1
    ds_read_b128 v[100:103], v2 offset:25600
    v_fma_f32 v186, v210, s10, v214
    v_mfma_f32_16x16x32_bf16 v[252:255], a[252:255], v[228:231], v[252:255]
    s_and_b32 s28, s5, 3
    v_exp_f32 v248, v248
    v_mfma_f32_16x16x32_bf16 a[32:35], v[112:115], v[32:35], a[32:35]
    s_and_b32 s3, s3, 1
    v_exp_f32 v249, v249
    v_mfma_f32_16x16x32_bf16 a[32:35], v[116:119], v[36:39], a[32:35]
    s_lshl_b32 s29, s29, 15
    v_exp_f32 v250, v250
    v_mfma_f32_16x16x32_bf16 a[36:39], v[112:115], v[40:43], a[36:39]
    s_lshl2_add_u32 s66, s6, s61
    v_exp_f32 v251, v251
    v_mfma_f32_16x16x32_bf16 a[36:39], v[116:119], v[44:47], a[36:39]
    s_mul_i32 s71, s5, 768
    v_fma_f32 v187, v211, s10, v214
    v_cvt_pk_bf16_f32 v88, v248, v249
    v_mfma_f32_16x16x32_bf16 v[240:243], a[240:243], v[136:139], v[152:155]
    s_lshl_b32 s74, s74, 15
    v_cvt_pk_bf16_f32 v89, v250, v251
    ds_read_b128 v[104:107], v2 offset:26624
    v_mfma_f32_16x16x32_bf16 v[240:243], a[244:247], v[168:171], v[240:243]
    s_mul_i32 s28, s28, 9216
    v_exp_f32 v252, v252
    v_mfma_f32_16x16x32_bf16 v[240:243], a[248:251], v[200:203], v[240:243]
    s_lshl3_add_u32 s3, s61, s3
    v_exp_f32 v253, v253
    v_mfma_f32_16x16x32_bf16 v[240:243], a[252:255], v[232:235], v[240:243]
    s_add_u32 s79, s29, s75
    v_exp_f32 v254, v254
    v_mfma_f32_16x16x32_bf16 a[40:43], v[112:115], v[48:51], a[40:43]
    s_lshl_b32 s66, s66, 10
    v_exp_f32 v255, v255
    v_mfma_f32_16x16x32_bf16 a[40:43], v[116:119], v[52:55], a[40:43]
    s_add_u32 s71, s71, 131072
    v_cvt_pk_bf16_f32 v74, v252, v253
    v_cvt_pk_bf16_f32 v75, v254, v255
    v_mfma_f32_16x16x32_bf16 a[44:47], v[112:115], v[56:59], a[44:47]
    s_add_u32 s74, s74, s101
    ds_read_b128 v[108:111], v2 offset:27648
    ds_read_b128 v[112:115], v2 offset:28672
    v_mfma_f32_16x16x32_bf16 a[44:47], v[116:119], v[60:63], a[44:47]
    s_waitcnt lgkmcnt(2)
    v_exp_f32 v240, v240
    v_mfma_f32_16x16x32_bf16 a[48:51], v[120:123], v[32:35], a[48:51]
    v_exp_f32 v241, v241
    v_mfma_f32_16x16x32_bf16 a[48:51], v[124:127], v[36:39], a[48:51]
    v_exp_f32 v242, v242
    v_mfma_f32_16x16x32_bf16 v[244:247], a[240:243], v[140:143], v[156:159]
    v_exp_f32 v243, v243
    v_mfma_f32_16x16x32_bf16 v[244:247], a[244:247], v[172:175], v[244:247]
    v_cvt_pk_bf16_f32 v82, v240, v241
    v_cvt_pk_bf16_f32 v83, v242, v243
    v_mfma_f32_16x16x32_bf16 v[244:247], a[248:251], v[204:207], v[244:247]
    ds_read_b128 a[240:243], v2 offset:12288
    ds_read_b128 a[244:247], v2 offset:13312
    v_mfma_f32_16x16x32_bf16 v[244:247], a[252:255], v[236:239], v[244:247]
    ds_read_b128 a[248:251], v2 offset:14336
    v_add_f32 v215, s15, v148
    v_mfma_f32_16x16x32_bf16 a[52:55], v[120:123], v[40:43], a[52:55]
    ds_read_b128 a[252:255], v2 offset:15360
    v_fma_f32 v188, v208, s11, v215
    v_mfma_f32_16x16x32_bf16 a[52:55], v[124:127], v[44:47], a[52:55]
    ds_read_b128 v[116:119], v2 offset:29696
    v_fma_f32 v189, v209, s11, v215
    v_mfma_f32_16x16x32_bf16 a[56:59], v[120:123], v[48:51], a[56:59]
    v_exp_f32 v244, v244
    v_mfma_f32_16x16x32_bf16 a[56:59], v[124:127], v[52:55], a[56:59]
    v_exp_f32 v245, v245
    v_mfma_f32_16x16x32_bf16 a[60:63], v[120:123], v[56:59], a[60:63]
    v_exp_f32 v246, v246
    v_mfma_f32_16x16x32_bf16 a[60:63], v[124:127], v[60:63], a[60:63]
    v_exp_f32 v247, v247
    v_mfma_f32_16x16x32_bf16 v[248:251], a[224:227], v[132:135], v[184:187]
    v_fma_f32 v190, v210, s11, v215
    v_fma_f32 v191, v211, s11, v215
    v_mfma_f32_16x16x32_bf16 v[248:251], a[228:231], v[164:167], v[248:251]
    v_cvt_pk_bf16_f32 v90, v244, v245
    v_cvt_pk_bf16_f32 v91, v246, v247
    v_mfma_f32_16x16x32_bf16 v[248:251], a[232:235], v[196:199], v[248:251]
    ds_read_b128 v[120:123], v2 offset:30720
    ds_read_b128 v[124:127], v2 offset:31744
    v_mfma_f32_16x16x32_bf16 v[248:251], a[236:239], v[228:231], v[248:251]
    s_add_u32 m0, s76, s75
    v_bfe_u32 v8, v1, 2, 6
    v_accvgpr_read_b32 v4, a112
    v_mfma_f32_16x16x32_bf16 a[144:147], v[96:99], v[32:35], a[144:147]
    s_mov_b32 s76, s60
    buffer_load_dwordx4 v1, s[36:39], s77 offen sc1 lds
    v_mfma_f32_16x16x32_bf16 a[144:147], v[100:103], v[36:39], a[144:147]
    s_mov_b32 s60, s82
    v_exp_f32 v248, v248
    v_mfma_f32_16x16x32_bf16 a[148:151], v[96:99], v[40:43], a[148:151]
    s_add_u32 s82, s82, 32768
    v_exp_f32 v249, v249
    v_mfma_f32_16x16x32_bf16 a[148:151], v[100:103], v[44:47], a[148:151]
    v_exp_f32 v250, v250
    v_mfma_f32_16x16x32_bf16 v[252:255], a[224:227], v[136:139], v[152:155]
    v_exp_f32 v251, v251
    v_mfma_f32_16x16x32_bf16 v[252:255], a[228:231], v[168:171], v[252:255]
    v_cvt_pk_bf16_f32 v76, v248, v249
    v_cvt_pk_bf16_f32 v77, v250, v251
    v_mfma_f32_16x16x32_bf16 v[252:255], a[232:235], v[200:203], v[252:255]
    s_cmp_eq_u32 s82, 163840
    s_cselect_b32 s82, 0, s82
    v_add_u32 v2, s82, v1
    v_mfma_f32_16x16x32_bf16 v[252:255], a[236:239], v[232:235], v[252:255]
    buffer_load_dwordx4 v1, s[36:39], s77 offen offset:1024 sc1 lds
    v_mfma_f32_16x16x32_bf16 a[152:155], v[96:99], v[48:51], a[152:155]
    v_accvgpr_read_b32 v5, a116
    v_add_u32 v8, 192, v8
    v_mfma_f32_16x16x32_bf16 a[152:155], v[100:103], v[52:55], a[152:155]
    v_cvt_pk_bf16_f32 v4, 0, v4
    v_cvt_pk_bf16_f32 v5, 0, v5
    v_mfma_f32_16x16x32_bf16 a[156:159], v[96:99], v[56:59], a[156:159]
    v_exp_f32 v252, v252
    v_mfma_f32_16x16x32_bf16 a[156:159], v[100:103], v[60:63], a[156:159]
    v_exp_f32 v253, v253
    v_mfma_f32_16x16x32_bf16 a[160:163], v[104:107], v[32:35], a[160:163]
    s_waitcnt lgkmcnt(0)
    v_exp_f32 v254, v254
    v_mfma_f32_16x16x32_bf16 a[160:163], v[108:111], v[36:39], a[160:163]
    v_exp_f32 v255, v255
    v_mfma_f32_16x16x32_bf16 v[240:243], a[224:227], v[140:143], v[156:159]
    v_cvt_pk_bf16_f32 v84, v252, v253
    v_cvt_pk_bf16_f32 v85, v254, v255
    v_mfma_f32_16x16x32_bf16 v[240:243], a[228:231], v[172:175], v[240:243]
    buffer_load_dwordx4 v1, s[36:39], s77 offen offset:2048 sc1 lds
    v_mfma_f32_16x16x32_bf16 v[240:243], a[232:235], v[204:207], v[240:243]
    v_lshrrev_b32 v15, 8, v1
    ds_bpermute_b32 v4, v8, v4
    v_mfma_f32_16x16x32_bf16 v[240:243], a[236:239], v[236:239], v[240:243]
    ds_bpermute_b32 v5, v8, v5
    ds_read_b128 a[224:227], v2 offset:0
    v_mfma_f32_16x16x32_bf16 a[164:167], v[104:107], v[40:43], a[164:167]
    ds_read_b128 a[228:231], v2 offset:1024
    v_bfe_u32 v14, v1, 4, 4
    v_mfma_f32_16x16x32_bf16 a[164:167], v[108:111], v[44:47], a[164:167]
    ds_read_b128 a[232:235], v2 offset:2048
    v_lshlrev_b32 v15, 3, v15
    v_mfma_f32_16x16x32_bf16 a[168:171], v[104:107], v[48:51], a[168:171]
    ds_read_b128 a[236:239], v2 offset:3072
    v_sub_u32 v14, v14, v15
    v_mfma_f32_16x16x32_bf16 a[168:171], v[108:111], v[52:55], a[168:171]
    ds_read_b128 v[96:99], v2 offset:16384
    v_and_b32 v15, 16, v1
    v_mfma_f32_16x16x32_bf16 a[172:175], v[104:107], v[56:59], a[172:175]
    buffer_load_dwordx4 v1, s[36:39], s77 offen offset:3072 sc1 lds
    v_mfma_f32_16x16x32_bf16 a[172:175], v[108:111], v[60:63], a[172:175]
    ds_read_b128 v[100:103], v2 offset:17408
    v_mov_b32 v31, 0x3f80
    v_mfma_f32_16x16x32_bf16 v[244:247], a[240:243], v[132:135], v[188:191]
    v_exp_f32 v240, v240
    v_mfma_f32_16x16x32_bf16 v[244:247], a[244:247], v[164:167], v[244:247]
    v_exp_f32 v241, v241
    v_mfma_f32_16x16x32_bf16 v[244:247], a[248:251], v[196:199], v[244:247]
    v_exp_f32 v242, v242
    v_mfma_f32_16x16x32_bf16 v[244:247], a[252:255], v[228:231], v[244:247]
    v_exp_f32 v243, v243
    v_mfma_f32_16x16x32_bf16 a[176:179], v[112:115], v[32:35], a[176:179]
    v_cvt_pk_bf16_f32 v92, v240, v241
    v_cvt_pk_bf16_f32 v93, v242, v243
    v_mfma_f32_16x16x32_bf16 a[176:179], v[116:119], v[36:39], a[176:179]
    s_add_u32 s100, s77, 4096
    v_ashrrev_i32 v14, 1, v14
    v_lshlrev_b32 v15, v15, v31
    v_mfma_f32_16x16x32_bf16 a[180:183], v[112:115], v[40:43], a[180:183]
    s_add_u32 m0, m0, 4096
    v_exp_f32 v244, v244
    v_mfma_f32_16x16x32_bf16 a[180:183], v[116:119], v[44:47], a[180:183]
    buffer_load_dwordx4 v1, s[36:39], s100 offen sc1 lds
    v_mfma_f32_16x16x32_bf16 v[248:251], a[240:243], v[136:139], v[152:155]
    v_exp_f32 v245, v245
    v_mfma_f32_16x16x32_bf16 v[248:251], a[244:247], v[168:171], v[248:251]
    v_exp_f32 v246, v246
    v_mfma_f32_16x16x32_bf16 v[248:251], a[248:251], v[200:203], v[248:251]
    v_exp_f32 v247, v247
    v_mfma_f32_16x16x32_bf16 v[248:251], a[252:255], v[232:235], v[248:251]
    v_cvt_pk_bf16_f32 v78, v244, v245
    v_cvt_pk_bf16_f32 v79, v246, v247
    v_mfma_f32_16x16x32_bf16 a[184:187], v[112:115], v[48:51], a[184:187]
    s_waitcnt lgkmcnt(0)
    v_cmp_eq_i32 vcc, 0, v14
    v_mul_f32 v4, s98, v4
    v_mfma_f32_16x16x32_bf16 a[184:187], v[116:119], v[52:55], a[184:187]
    buffer_load_dwordx4 v1, s[36:39], s100 offen offset:1024 sc1 lds
    v_mfma_f32_16x16x32_bf16 a[188:191], v[112:115], v[56:59], a[188:191]
    v_exp_f32 v248, v248
    v_mfma_f32_16x16x32_bf16 a[188:191], v[116:119], v[60:63], a[188:191]
    v_exp_f32 v249, v249
    v_mfma_f32_16x16x32_bf16 a[192:195], v[120:123], v[32:35], a[192:195]
    v_exp_f32 v250, v250
    v_mfma_f32_16x16x32_bf16 a[192:195], v[124:127], v[36:39], a[192:195]
    v_exp_f32 v251, v251
    v_mfma_f32_16x16x32_bf16 v[252:255], a[240:243], v[140:143], v[156:159]
    v_cvt_pk_bf16_f32 v86, v248, v249
    v_cvt_pk_bf16_f32 v87, v250, v251
    v_mfma_f32_16x16x32_bf16 v[252:255], a[244:247], v[172:175], v[252:255]
    v_cndmask_b32 v216, 0, v15, vcc
    v_cmp_eq_i32 vcc, 1, v14
    v_mfma_f32_16x16x32_bf16 v[252:255], a[248:251], v[204:207], v[252:255]
    v_mul_f32 v5, s98, v5
    v_cndmask_b32 v217, 0, v15, vcc
    v_mfma_f32_16x16x32_bf16 v[252:255], a[252:255], v[236:239], v[252:255]
    buffer_load_dwordx4 v1, s[36:39], s100 offen offset:2048 sc1 lds
    v_mfma_f32_16x16x32_bf16 a[196:199], v[120:123], v[40:43], a[196:199]
    v_cmp_eq_i32 vcc, 2, v14
    v_and_b32 v31, 512, v1
    v_mfma_f32_16x16x32_bf16 a[196:199], v[124:127], v[44:47], a[196:199]
    v_cndmask_b32 v218, 0, v15, vcc
    v_cmp_eq_i32 vcc, 3, v14
    v_mfma_f32_16x16x32_bf16 a[200:203], v[120:123], v[48:51], a[200:203]
    v_exp_f32 v252, v252
    v_mfma_f32_16x16x32_bf16 a[200:203], v[124:127], v[52:55], a[200:203]
    v_exp_f32 v253, v253
    v_mfma_f32_16x16x32_bf16 a[204:207], v[120:123], v[56:59], a[204:207]
    v_cvt_pk_bf16_f32 v94, v252, v253
    v_cndmask_b32 v219, 0, v15, vcc
    v_mfma_f32_16x16x32_bf16 a[204:207], v[124:127], v[60:63], a[204:207]
    v_cmp_eq_i32 vcc, -8, v14
    v_mad_u32_u24 v31, v31, 17, v1
    v_mfma_f32_16x16x32_bf16 a[208:211], a[136:139], v[32:35], a[208:211]
    buffer_load_dwordx4 v1, s[36:39], s100 offen offset:3072 sc1 lds
    v_mfma_f32_16x16x32_bf16 a[208:211], a[136:139], v[36:39], a[208:211]
    v_cndmask_b32 v220, 0, v15, vcc
    v_cmp_eq_i32 vcc, -7, v14
    v_mfma_f32_16x16x32_bf16 a[212:215], a[136:139], v[40:43], a[212:215]
    v_exp_f32 v4, v4
    v_mfma_f32_16x16x32_bf16 a[212:215], a[136:139], v[44:47], a[212:215]
    v_exp_f32 v5, v5
    v_mfma_f32_16x16x32_bf16 a[216:219], a[136:139], v[48:51], a[216:219]
    v_cndmask_b32 v221, 0, v15, vcc
    v_cmp_eq_i32 vcc, -6, v14
    v_mfma_f32_16x16x32_bf16 a[216:219], a[136:139], v[52:55], a[216:219]
    v_add_f32 v4, 1.0, v4
    v_add_f32 v5, 1.0, v5
    v_mfma_f32_16x16x32_bf16 a[220:223], a[136:139], v[56:59], a[220:223]
    v_cndmask_b32 v222, 0, v15, vcc
    v_cmp_eq_i32 vcc, -5, v14
    v_mfma_f32_16x16x32_bf16 a[220:223], a[136:139], v[60:63], a[220:223]
    s_add_u32 s77, s77, 32768
    v_rcp_f32 v4, v4
    v_rcp_f32 v5, v5
    v_cndmask_b32 v223, 0, v15, vcc
    s_cmp_eq_u32 s6, 7
    s_cselect_b32 s16, s8, 0
    s_cselect_b32 s17, s9, 0
    s_cselect_b32 s18, s10, 0
    s_cselect_b32 s19, s11, 0
    s_cselect_b32 s20, s12, 0
    s_cselect_b32 s21, s13, 0
    s_cselect_b32 s22, s14, 0
    s_cselect_b32 s23, s15, 0
    s_cbranch_scc1 K1_J7
K1_J7_BACK:
    v_add_f32 v212, s20, v152
    v_fma_f32 v176, v208, s16, v212
    v_fma_f32 v177, v209, s16, v212
    v_fma_f32 v178, v210, s16, v212
    v_fma_f32 v179, v211, s16, v212
    s_nop 1
    s_waitcnt lgkmcnt(0)
    v_mfma_f32_16x16x32_bf16 v[240:243], a[224:227], v[136:139], v[176:179]
    s_add_u32 m0, s76, s75
    v_exp_f32 v254, v254
    v_mfma_f32_16x16x32_bf16 v[240:243], a[228:231], v[168:171], v[240:243]
    s_mov_b32 s76, s60
    buffer_load_dwordx4 v1, s[36:39], s77 offen sc1 lds
    v_mfma_f32_16x16x32_bf16 v[240:243], a[232:235], v[200:203], v[240:243]
    s_mov_b32 s60, s82
    v_exp_f32 v255, v255
    v_mfma_f32_16x16x32_bf16 v[240:243], a[236:239], v[232:235], v[240:243]
    s_add_u32 s82, s82, 32768
    ds_read_b128 v[104:107], v2 offset:18432
    v_cvt_pk_bf16_f32 v95, v254, v255
    v_mfma_f32_16x16x32_bf16 a[4:7], v[96:99], v[72:75], a[4:7]
    ds_read_b128 v[108:111], v2 offset:19456
    ds_read_b128 a[240:243], v2 offset:4096
    v_mfma_f32_16x16x32_bf16 a[4:7], v[100:103], v[76:79], a[4:7]
    ds_read_b128 a[244:247], v2 offset:5120
    v_add_f32 v213, s21, v152
    v_mfma_f32_16x16x32_bf16 a[8:11], v[96:99], v[80:83], a[8:11]
    ds_read_b128 a[248:251], v2 offset:6144
    v_fma_f32 v180, v208, s17, v213
    v_mfma_f32_16x16x32_bf16 a[8:11], v[100:103], v[84:87], a[8:11]
    ds_read_b128 a[252:255], v2 offset:7168
    v_fma_f32 v181, v209, s17, v213
    v_mfma_f32_16x16x32_bf16 a[12:15], v[96:99], v[88:91], a[12:15]
    ds_read_b128 v[112:115], v2 offset:20480
    v_fma_f32 v182, v210, s17, v213
    v_mfma_f32_16x16x32_bf16 a[12:15], v[100:103], v[92:95], a[12:15]
    ds_read_b128 v[116:119], v2 offset:21504
    v_fma_f32 v183, v211, s17, v213
    v_mfma_f32_16x16x32_bf16 v[244:247], a[224:227], v[140:143], v[156:159]
    buffer_load_dwordx4 v1, s[36:39], s77 offen offset:1024 sc1 lds
    v_mfma_f32_16x16x32_bf16 v[244:247], a[228:231], v[172:175], v[244:247]
    ds_read_b128 v[120:123], v2 offset:22528
    ds_read_b128 v[124:127], v2 offset:23552
    v_mfma_f32_16x16x32_bf16 v[244:247], a[232:235], v[204:207], v[244:247]
    ds_read_b128 a[224:227], v2 offset:8192
    v_add_f32 v214, s22, v152
    v_mfma_f32_16x16x32_bf16 v[244:247], a[236:239], v[236:239], v[244:247]
    s_waitcnt lgkmcnt(4)
    ds_read_b128 a[228:231], v2 offset:9216
    v_fma_f32 v184, v208, s18, v214
    v_mfma_f32_16x16x32_bf16 a[20:23], v[104:107], v[72:75], a[20:23]
    ds_read_b128 a[232:235], v2 offset:10240
    v_fma_f32 v185, v209, s18, v214
    v_mfma_f32_16x16x32_bf16 a[20:23], v[108:111], v[76:79], a[20:23]
    ds_read_b128 a[236:239], v2 offset:11264
    v_fma_f32 v186, v210, s18, v214
    v_mfma_f32_16x16x32_bf16 a[24:27], v[104:107], v[80:83], a[24:27]
    ds_read_b128 v[96:99], v2 offset:24576
    v_fma_f32 v187, v211, s18, v214
    v_mfma_f32_16x16x32_bf16 a[24:27], v[108:111], v[84:87], a[24:27]
    ds_read_b128 v[100:103], v2 offset:25600
    v_add_f32 v215, s23, v152
    v_mfma_f32_16x16x32_bf16 a[28:31], v[104:107], v[88:91], a[28:31]
    v_exp_f32 v240, v240
    v_mfma_f32_16x16x32_bf16 a[28:31], v[108:111], v[92:95], a[28:31]
    v_exp_f32 v241, v241
    v_mfma_f32_16x16x32_bf16 v[248:251], a[240:243], v[136:139], v[180:183]
    buffer_load_dwordx4 v1, s[36:39], s77 offen offset:2048 sc1 lds
    v_mfma_f32_16x16x32_bf16 v[248:251], a[244:247], v[168:171], v[248:251]
    v_exp_f32 v242, v242
    v_mfma_f32_16x16x32_bf16 v[248:251], a[248:251], v[200:203], v[248:251]
    v_exp_f32 v243, v243
    v_mfma_f32_16x16x32_bf16 v[248:251], a[252:255], v[232:235], v[248:251]
    v_cvt_pk_bf16_f32 v48, v240, v241
    v_cvt_pk_bf16_f32 v49, v242, v243
    v_mfma_f32_16x16x32_bf16 a[36:39], v[112:115], v[72:75], a[36:39]
    s_waitcnt lgkmcnt(0)
    ds_read_b128 v[104:107], v2 offset:26624
    ds_read_b128 v[108:111], v2 offset:27648
    v_mfma_f32_16x16x32_bf16 a[36:39], v[116:119], v[76:79], a[36:39]
    v_exp_f32 v244, v244
    v_mfma_f32_16x16x32_bf16 a[40:43], v[112:115], v[80:83], a[40:43]
    v_exp_f32 v245, v245
    v_mfma_f32_16x16x32_bf16 a[40:43], v[116:119], v[84:87], a[40:43]
    v_exp_f32 v246, v246
    v_mfma_f32_16x16x32_bf16 a[44:47], v[112:115], v[88:91], a[44:47]
    v_exp_f32 v247, v247
    v_mfma_f32_16x16x32_bf16 a[44:47], v[116:119], v[92:95], a[44:47]
    s_waitcnt vmcnt(11)
    buffer_load_dwordx4 v1, s[36:39], s77 offen offset:3072 sc1 lds
    v_mfma_f32_16x16x32_bf16 v[12:15], v[64:67], v[216:219], 0
    v_cvt_pk_bf16_f32 v56, v244, v245
    v_cvt_pk_bf16_f32 v57, v246, v247
    v_mfma_f32_16x16x32_bf16 v[16:19], v[68:71], v[216:219], 0
    ds_read_b128 v[112:115], v2 offset:28672
    ds_read_b128 v[116:119], v2 offset:29696
    v_mfma_f32_16x16x32_bf16 v[252:255], a[240:243], v[140:143], v[156:159]
    ds_read_b128 a[240:243], v2 offset:12288
    v_fma_f32 v188, v208, s19, v215
    v_mfma_f32_16x16x32_bf16 v[252:255], a[244:247], v[172:175], v[252:255]
    v_cvt_pk_bf16_f32 v12, v12, v13
    v_cvt_pk_bf16_f32 v13, v14, v15
    v_mfma_f32_16x16x32_bf16 v[252:255], a[248:251], v[204:207], v[252:255]
    v_cvt_pk_bf16_f32 v14, v16, v17
    v_cvt_pk_bf16_f32 v15, v18, v19
    v_mfma_f32_16x16x32_bf16 v[252:255], a[252:255], v[236:239], v[252:255]
    buffer_store_dwordx4 v[12:15], v31, s[56:59], s63 offen offset:0 sc1
    v_mfma_f32_16x16x32_bf16 a[52:55], v[120:123], v[72:75], a[52:55]
    ds_read_b128 a[244:247], v2 offset:13312
    ds_read_b128 a[248:251], v2 offset:14336
    v_mfma_f32_16x16x32_bf16 a[52:55], v[124:127], v[76:79], a[52:55]
    ds_read_b128 a[252:255], v2 offset:15360
    v_fma_f32 v189, v209, s19, v215
    v_mfma_f32_16x16x32_bf16 a[56:59], v[120:123], v[80:83], a[56:59]
    s_add_u32 s100, s77, 4096
    v_exp_f32 v248, v248
    v_mfma_f32_16x16x32_bf16 a[56:59], v[124:127], v[84:87], a[56:59]
    s_add_u32 m0, m0, 4096
    v_exp_f32 v249, v249
    v_mfma_f32_16x16x32_bf16 a[60:63], v[120:123], v[88:91], a[60:63]
    buffer_load_dwordx4 v1, s[36:39], s100 offen sc1 lds
    v_mfma_f32_16x16x32_bf16 a[60:63], v[124:127], v[92:95], a[60:63]
    v_exp_f32 v250, v250
    v_mfma_f32_16x16x32_bf16 v[12:15], v[64:67], v[220:223], 0
    v_exp_f32 v251, v251
    v_mfma_f32_16x16x32_bf16 v[16:19], v[68:71], v[220:223], 0
    v_fma_f32 v190, v210, s19, v215
    v_fma_f32 v191, v211, s19, v215
    v_mfma_f32_16x16x32_bf16 v[240:243], a[224:227], v[136:139], v[184:187]
    v_cvt_pk_bf16_f32 v50, v248, v249
    v_cvt_pk_bf16_f32 v51, v250, v251
    v_mfma_f32_16x16x32_bf16 v[240:243], a[228:231], v[168:171], v[240:243]
    v_cvt_pk_bf16_f32 v12, v12, v13
    v_cvt_pk_bf16_f32 v13, v14, v15
    v_mfma_f32_16x16x32_bf16 v[240:243], a[232:235], v[200:203], v[240:243]
    v_cvt_pk_bf16_f32 v14, v16, v17
    v_cvt_pk_bf16_f32 v15, v18, v19
    v_mfma_f32_16x16x32_bf16 v[240:243], a[236:239], v[232:235], v[240:243]
    buffer_store_dwordx4 v[12:15], v31, s[56:59], s63 offen offset:1024 sc1
    v_mfma_f32_16x16x32_bf16 a[148:151], v[96:99], v[72:75], a[148:151]
    buffer_load_dwordx4 v1, s[36:39], s100 offen offset:1024 sc1 lds
    v_mfma_f32_16x16x32_bf16 a[148:151], v[100:103], v[76:79], a[148:151]
    ds_read_b128 v[120:123], v2 offset:30720
    ds_read_b128 v[124:127], v2 offset:31744
    v_mfma_f32_16x16x32_bf16 a[152:155], v[96:99], v[80:83], a[152:155]
    v_exp_f32 v252, v252
    v_mfma_f32_16x16x32_bf16 a[152:155], v[100:103], v[84:87], a[152:155]
    v_exp_f32 v253, v253
    v_mfma_f32_16x16x32_bf16 a[156:159], v[96:99], v[88:91], a[156:159]
    v_exp_f32 v254, v254
    v_mfma_f32_16x16x32_bf16 a[156:159], v[100:103], v[92:95], a[156:159]
    v_exp_f32 v255, v255
    v_mfma_f32_16x16x32_bf16 v[12:15], v[20:23], v[216:219], 0
    v_cvt_pk_bf16_f32 v58, v252, v253
    v_cvt_pk_bf16_f32 v59, v254, v255
    v_mfma_f32_16x16x32_bf16 v[16:19], v[24:27], v[216:219], 0
    v_exp_f32 v240, v240
    v_mfma_f32_16x16x32_bf16 v[244:247], a[224:227], v[140:143], v[156:159]
    v_exp_f32 v241, v241
    v_mfma_f32_16x16x32_bf16 v[244:247], a[228:231], v[172:175], v[244:247]
    v_exp_f32 v242, v242
    v_mfma_f32_16x16x32_bf16 v[244:247], a[232:235], v[204:207], v[244:247]
    buffer_load_dwordx4 v1, s[36:39], s100 offen offset:2048 sc1 lds
    v_mfma_f32_16x16x32_bf16 v[244:247], a[236:239], v[236:239], v[244:247]
    s_waitcnt lgkmcnt(0)
    v_cvt_pk_bf16_f32 v12, v12, v13
    v_cvt_pk_bf16_f32 v13, v14, v15
    v_mfma_f32_16x16x32_bf16 a[164:167], v[104:107], v[72:75], a[164:167]
    v_cvt_pk_bf16_f32 v14, v16, v17
    v_cvt_pk_bf16_f32 v15, v18, v19
    v_mfma_f32_16x16x32_bf16 a[164:167], v[108:111], v[76:79], a[164:167]
    buffer_store_dwordx4 v[12:15], v31, s[56:59], s63 offen offset:512 sc1
    v_mfma_f32_16x16x32_bf16 a[168:171], v[104:107], v[80:83], a[168:171]
    s_cmp_eq_u32 s82, 163840
    s_cselect_b32 s82, 0, s82
    v_add_u32 v2, s82, v1
    v_mfma_f32_16x16x32_bf16 a[168:171], v[108:111], v[84:87], a[168:171]
    v_exp_f32 v243, v243
    v_mfma_f32_16x16x32_bf16 a[172:175], v[104:107], v[88:91], a[172:175]
    v_exp_f32 v244, v244
    v_mfma_f32_16x16x32_bf16 a[172:175], v[108:111], v[92:95], a[172:175]
    v_exp_f32 v245, v245
    v_mfma_f32_16x16x32_bf16 v[12:15], v[20:23], v[220:223], 0
    v_exp_f32 v246, v246
    v_mfma_f32_16x16x32_bf16 v[16:19], v[24:27], v[220:223], 0
    buffer_load_dwordx4 v1, s[36:39], s100 offen offset:3072 sc1 lds
    v_mfma_f32_16x16x32_bf16 v[248:251], a[240:243], v[136:139], v[188:191]
    v_exp_f32 v247, v247
    v_mfma_f32_16x16x32_bf16 v[248:251], a[244:247], v[168:171], v[248:251]
    v_cvt_pk_bf16_f32 v52, v240, v241
    v_cvt_pk_bf16_f32 v53, v242, v243
    v_mfma_f32_16x16x32_bf16 v[248:251], a[248:251], v[200:203], v[248:251]
    v_cvt_pk_bf16_f32 v12, v12, v13
    v_cvt_pk_bf16_f32 v13, v14, v15
    v_mfma_f32_16x16x32_bf16 v[248:251], a[252:255], v[232:235], v[248:251]
    v_cvt_pk_bf16_f32 v14, v16, v17
    v_cvt_pk_bf16_f32 v15, v18, v19
    v_mfma_f32_16x16x32_bf16 a[180:183], v[112:115], v[72:75], a[180:183]
    buffer_store_dwordx4 v[12:15], v31, s[56:59], s63 offen offset:1536 sc1
    v_mfma_f32_16x16x32_bf16 a[180:183], v[116:119], v[76:79], a[180:183]
    v_cvt_pk_bf16_f32 v60, v244, v245
    v_cvt_pk_bf16_f32 v61, v246, v247
    v_mfma_f32_16x16x32_bf16 a[184:187], v[112:115], v[80:83], a[184:187]
    v_exp_f32 v248, v248
    v_mfma_f32_16x16x32_bf16 a[184:187], v[116:119], v[84:87], a[184:187]
    v_exp_f32 v249, v249
    v_mfma_f32_16x16x32_bf16 a[188:191], v[112:115], v[88:91], a[188:191]
    s_add_u32 s77, s77, 32768
    v_exp_f32 v250, v250
    v_mfma_f32_16x16x32_bf16 a[188:191], v[116:119], v[92:95], a[188:191]
    v_exp_f32 v251, v251
    v_mfma_f32_16x16x32_bf16 v[12:15], v[144:147], v[216:219], 0
    v_cvt_pk_bf16_f32 v54, v248, v249
    v_cvt_pk_bf16_f32 v55, v250, v251
    v_mfma_f32_16x16x32_bf16 v[16:19], a[140:143], v[216:219], 0
    v_accvgpr_read_b32 v6, a120
    v_accvgpr_read_b32 v7, a124
    v_mfma_f32_16x16x32_bf16 v[252:255], a[240:243], v[140:143], v[156:159]
    v_cvt_pk_bf16_f32 v6, 0, v6
    v_cvt_pk_bf16_f32 v7, 0, v7
    v_mfma_f32_16x16x32_bf16 v[252:255], a[244:247], v[172:175], v[252:255]
    v_cvt_pk_bf16_f32 v12, v12, v13
    v_cvt_pk_bf16_f32 v13, v14, v15
    v_mfma_f32_16x16x32_bf16 v[252:255], a[248:251], v[204:207], v[252:255]
    v_cvt_pk_bf16_f32 v14, v16, v17
    v_cvt_pk_bf16_f32 v15, v18, v19
    v_mfma_f32_16x16x32_bf16 v[252:255], a[252:255], v[236:239], v[252:255]
    buffer_store_dwordx4 v[12:15], v1, s[56:59], s64 offen offset:0 sc1
    v_mfma_f32_16x16x32_bf16 a[196:199], v[120:123], v[72:75], a[196:199]
    ds_bpermute_b32 v6, v8, v6
    ds_bpermute_b32 v7, v8, v7
    v_mfma_f32_16x16x32_bf16 a[196:199], v[124:127], v[76:79], a[196:199]
    s_waitcnt vmcnt(8) lgkmcnt(0)
    s_barrier
    ds_read_b128 a[224:227], v2 offset:0
    v_mfma_f32_16x16x32_bf16 a[200:203], v[120:123], v[80:83], a[200:203]
    ds_read_b128 a[228:231], v2 offset:1024
    ds_read_b128 a[232:235], v2 offset:2048
    v_mfma_f32_16x16x32_bf16 a[200:203], v[124:127], v[84:87], a[200:203]
    ds_read_b128 a[236:239], v2 offset:3072
    v_mul_f32 v6, s98, v6
    v_mfma_f32_16x16x32_bf16 a[204:207], v[120:123], v[88:91], a[204:207]
    ds_read_b128 v[96:99], v2 offset:16384
    v_mul_f32 v7, s98, v7
    v_mfma_f32_16x16x32_bf16 a[204:207], v[124:127], v[92:95], a[204:207]
    v_exp_f32 v252, v252
    v_mfma_f32_16x16x32_bf16 v[12:15], v[144:147], v[220:223], 0
    v_exp_f32 v253, v253
    v_mfma_f32_16x16x32_bf16 v[16:19], a[140:143], v[220:223], 0
    ds_read_b128 v[100:103], v2 offset:17408
    v_cvt_pk_bf16_f32 v62, v252, v253
    v_mfma_f32_16x16x32_bf16 a[212:215], a[136:139], v[72:75], a[212:215]
    v_exp_f32 v6, v6
    v_mfma_f32_16x16x32_bf16 a[212:215], a[136:139], v[76:79], a[212:215]
    v_exp_f32 v7, v7
    v_mfma_f32_16x16x32_bf16 a[216:219], a[136:139], v[80:83], a[216:219]
    v_cvt_pk_bf16_f32 v12, v12, v13
    v_cvt_pk_bf16_f32 v13, v14, v15
    v_mfma_f32_16x16x32_bf16 a[216:219], a[136:139], v[84:87], a[216:219]
    v_cvt_pk_bf16_f32 v14, v16, v17
    v_cvt_pk_bf16_f32 v15, v18, v19
    v_mfma_f32_16x16x32_bf16 a[220:223], a[136:139], v[88:91], a[220:223]
    buffer_store_dwordx4 v[12:15], v1, s[56:59], s62 offen offset:0 sc1
    v_mfma_f32_16x16x32_bf16 a[220:223], a[136:139], v[92:95], a[220:223]
    v_add_f32 v6, 1.0, v6
    v_add_f32 v7, 1.0, v7
    v_rcp_f32 v6, v6
    v_rcp_f32 v7, v7
    s_nop 1
    v_accvgpr_read_b32 v9, a208
    v_cmp_nge_f32 vcc, 0x71800000, v9
    v_rcp_f32 v10, v9
    s_nop 0
    s_or_b64 s[84:85], s[84:85], vcc
    v_mul_f32 v10, v10, v4
    v_accvgpr_read_b32 v12, a0
    v_accvgpr_read_b32 v13, a1
    v_accvgpr_read_b32 v14, a2
    v_accvgpr_read_b32 v15, a3
    v_accvgpr_read_b32 v16, a16
    v_accvgpr_read_b32 v17, a17
    v_accvgpr_read_b32 v18, a18
    v_accvgpr_read_b32 v19, a19
    v_pk_mul_f32 v[12:13], v[12:13], v[10:11] op_sel_hi:[1,0]
    v_pk_mul_f32 v[14:15], v[14:15], v[10:11] op_sel_hi:[1,0]
    v_pk_mul_f32 v[16:17], v[16:17], v[10:11] op_sel_hi:[1,0]
    v_pk_mul_f32 v[18:19], v[18:19], v[10:11] op_sel_hi:[1,0]
    v_cvt_pk_bf16_f32 v12, v12, v13
    v_cvt_pk_bf16_f32 v13, v14, v15
    v_cvt_pk_bf16_f32 v14, v16, v17
    v_cvt_pk_bf16_f32 v15, v18, v19
    buffer_store_dwordx4 v[12:15], v1, s[40:43], s80 offen offset:0 sc1
    v_accvgpr_read_b32 v20, a32
    v_accvgpr_read_b32 v21, a33
    v_accvgpr_read_b32 v22, a34
    v_accvgpr_read_b32 v23, a35
    v_accvgpr_read_b32 v24, a48
    v_accvgpr_read_b32 v25, a49
    v_accvgpr_read_b32 v26, a50
    v_accvgpr_read_b32 v27, a51
    v_pk_mul_f32 v[20:21], v[20:21], v[10:11] op_sel_hi:[1,0]
    v_pk_mul_f32 v[22:23], v[22:23], v[10:11] op_sel_hi:[1,0]
    v_pk_mul_f32 v[24:25], v[24:25], v[10:11] op_sel_hi:[1,0]
    v_pk_mul_f32 v[26:27], v[26:27], v[10:11] op_sel_hi:[1,0]
    v_cvt_pk_bf16_f32 v20, v20, v21
    v_cvt_pk_bf16_f32 v21, v22, v23
    v_cvt_pk_bf16_f32 v22, v24, v25
    v_cvt_pk_bf16_f32 v23, v26, v27
    buffer_store_dwordx4 v[20:23], v1, s[40:43], s80 offen offset:1024 sc1
    v_accvgpr_read_b32 v12, a144
    v_accvgpr_read_b32 v13, a145
    v_accvgpr_read_b32 v14, a146
    v_accvgpr_read_b32 v15, a147
    v_accvgpr_read_b32 v16, a160
    v_accvgpr_read_b32 v17, a161
    v_accvgpr_read_b32 v18, a162
    v_accvgpr_read_b32 v19, a163
    v_pk_mul_f32 v[12:13], v[12:13], v[10:11] op_sel_hi:[1,0]
    v_pk_mul_f32 v[14:15], v[14:15], v[10:11] op_sel_hi:[1,0]
    v_pk_mul_f32 v[16:17], v[16:17], v[10:11] op_sel_hi:[1,0]
    v_pk_mul_f32 v[18:19], v[18:19], v[10:11] op_sel_hi:[1,0]
    v_cvt_pk_bf16_f32 v12, v12, v13
    v_cvt_pk_bf16_f32 v13, v14, v15
    v_cvt_pk_bf16_f32 v14, v16, v17
    v_cvt_pk_bf16_f32 v15, v18, v19
    buffer_store_dwordx4 v[12:15], v1, s[40:43], s80 offen offset:2048 sc1
    v_accvgpr_read_b32 v20, a176
    v_accvgpr_read_b32 v21, a177
    v_accvgpr_read_b32 v22, a178
    v_accvgpr_read_b32 v23, a179
    v_accvgpr_read_b32 v24, a192
    v_accvgpr_read_b32 v25, a193
    v_accvgpr_read_b32 v26, a194
    v_accvgpr_read_b32 v27, a195
    v_pk_mul_f32 v[20:21], v[20:21], v[10:11] op_sel_hi:[1,0]
    v_pk_mul_f32 v[22:23], v[22:23], v[10:11] op_sel_hi:[1,0]
    v_pk_mul_f32 v[24:25], v[24:25], v[10:11] op_sel_hi:[1,0]
    v_pk_mul_f32 v[26:27], v[26:27], v[10:11] op_sel_hi:[1,0]
    v_cvt_pk_bf16_f32 v20, v20, v21
    v_cvt_pk_bf16_f32 v21, v22, v23
    v_cvt_pk_bf16_f32 v22, v24, v25
    v_cvt_pk_bf16_f32 v23, v26, v27
    buffer_store_dwordx4 v[20:23], v1, s[40:43], s80 offen offset:3072 sc1
    v_accvgpr_read_b32 v9, a212
    v_cmp_nge_f32 vcc, 0x71800000, v9
    v_rcp_f32 v10, v9
    s_nop 0
    s_or_b64 s[84:85], s[84:85], vcc
    v_mul_f32 v10, v10, v5
    s_add_u32 s72, s80, 622592
    v_accvgpr_read_b32 v12, a4
    v_accvgpr_read_b32 v13, a5
    v_accvgpr_read_b32 v14, a6
    v_accvgpr_read_b32 v15, a7
    v_accvgpr_read_b32 v16, a20
    v_accvgpr_read_b32 v17, a21
    v_accvgpr_read_b32 v18, a22
    v_accvgpr_read_b32 v19, a23
    v_pk_mul_f32 v[12:13], v[12:13], v[10:11] op_sel_hi:[1,0]
    v_pk_mul_f32 v[14:15], v[14:15], v[10:11] op_sel_hi:[1,0]
    v_pk_mul_f32 v[16:17], v[16:17], v[10:11] op_sel_hi:[1,0]
    v_pk_mul_f32 v[18:19], v[18:19], v[10:11] op_sel_hi:[1,0]
    v_cvt_pk_bf16_f32 v12, v12, v13
    v_cvt_pk_bf16_f32 v13, v14, v15
    v_cvt_pk_bf16_f32 v14, v16, v17
    v_cvt_pk_bf16_f32 v15, v18, v19
    buffer_store_dwordx4 v[12:15], v1, s[40:43], s72 offen offset:0 sc1
    v_accvgpr_read_b32 v20, a36
    v_accvgpr_read_b32 v21, a37
    v_accvgpr_read_b32 v22, a38
    v_accvgpr_read_b32 v23, a39
    v_accvgpr_read_b32 v24, a52
    v_accvgpr_read_b32 v25, a53
    v_accvgpr_read_b32 v26, a54
    v_accvgpr_read_b32 v27, a55
    v_pk_mul_f32 v[20:21], v[20:21], v[10:11] op_sel_hi:[1,0]
    v_pk_mul_f32 v[22:23], v[22:23], v[10:11] op_sel_hi:[1,0]
    v_pk_mul_f32 v[24:25], v[24:25], v[10:11] op_sel_hi:[1,0]
    v_pk_mul_f32 v[26:27], v[26:27], v[10:11] op_sel_hi:[1,0]
    v_cvt_pk_bf16_f32 v20, v20, v21
    v_cvt_pk_bf16_f32 v21, v22, v23
    v_cvt_pk_bf16_f32 v22, v24, v25
    v_cvt_pk_bf16_f32 v23, v26, v27
    buffer_store_dwordx4 v[20:23], v1, s[40:43], s72 offen offset:1024 sc1
    v_accvgpr_read_b32 v12, a148
    v_accvgpr_read_b32 v13, a149
    v_accvgpr_read_b32 v14, a150
    v_accvgpr_read_b32 v15, a151
    v_accvgpr_read_b32 v16, a164
    v_accvgpr_read_b32 v17, a165
    v_accvgpr_read_b32 v18, a166
    v_accvgpr_read_b32 v19, a167
    v_pk_mul_f32 v[12:13], v[12:13], v[10:11] op_sel_hi:[1,0]
    v_pk_mul_f32 v[14:15], v[14:15], v[10:11] op_sel_hi:[1,0]
    v_pk_mul_f32 v[16:17], v[16:17], v[10:11] op_sel_hi:[1,0]
    v_pk_mul_f32 v[18:19], v[18:19], v[10:11] op_sel_hi:[1,0]
    v_cvt_pk_bf16_f32 v12, v12, v13
    v_cvt_pk_bf16_f32 v13, v14, v15
    v_cvt_pk_bf16_f32 v14, v16, v17
    v_cvt_pk_bf16_f32 v15, v18, v19
    buffer_store_dwordx4 v[12:15], v1, s[40:43], s72 offen offset:2048 sc1
    v_accvgpr_read_b32 v20, a180
    v_accvgpr_read_b32 v21, a181
    v_accvgpr_read_b32 v22, a182
    v_accvgpr_read_b32 v23, a183
    v_accvgpr_read_b32 v24, a196
    v_accvgpr_read_b32 v25, a197
    v_accvgpr_read_b32 v26, a198
    v_accvgpr_read_b32 v27, a199
    v_pk_mul_f32 v[20:21], v[20:21], v[10:11] op_sel_hi:[1,0]
    v_pk_mul_f32 v[22:23], v[22:23], v[10:11] op_sel_hi:[1,0]
    v_pk_mul_f32 v[24:25], v[24:25], v[10:11] op_sel_hi:[1,0]
    v_pk_mul_f32 v[26:27], v[26:27], v[10:11] op_sel_hi:[1,0]
    v_cvt_pk_bf16_f32 v20, v20, v21
    v_cvt_pk_bf16_f32 v21, v22, v23
    v_cvt_pk_bf16_f32 v22, v24, v25
    v_cvt_pk_bf16_f32 v23, v26, v27
    buffer_store_dwordx4 v[20:23], v1, s[40:43], s72 offen offset:3072 sc1
    v_mov_b32 v9, 1
    v_lshlrev_b32 v216, 20, v1
    s_lshl2_add_u32 s7, s4, s101
    s_add_u32 s7, s7, 163840
    s_waitcnt vmcnt(8)
    buffer_store_dword v9, v216, s[32:35], s7 offen sc1
    s_sub_u32 s78, 14, s6
    s_sub_u32 s78, s78, s6
    s_cmp_eq_u32 s78, 0
    s_cbranch_scc1 K1_LS_END
.p2align 3
K1_LS:
    s_waitcnt lgkmcnt(0)
    v_mfma_f32_16x16x32_bf16 v[240:243], a[224:227], v[136:139], v[176:179]
    s_add_u32 m0, s76, s75
    v_exp_f32 v254, v254
    v_mfma_f32_16x16x32_bf16 v[240:243], a[228:231], v[168:171], v[240:243]
    s_mov_b32 s76, s60
    v_exp_f32 v255, v255
    v_mfma_f32_16x16x32_bf16 v[240:243], a[232:235], v[200:203], v[240:243]
    s_mov_b32 s60, s82
    buffer_load_dwordx4 v1, s[36:39], s77 offen sc1 lds
    v_mfma_f32_16x16x32_bf16 v[240:243], a[236:239], v[232:235], v[240:243]
    s_add_u32 s82, s82, 32768
    ds_read_b128 v[104:107], v2 offset:18432
    v_cvt_pk_bf16_f32 v63, v254, v255
    v_mfma_f32_16x16x32_bf16 a[8:11], v[96:99], v[48:51], a[8:11]
    ds_read_b128 v[108:111], v2 offset:19456
    ds_read_b128 a[240:243], v2 offset:4096
    v_mfma_f32_16x16x32_bf16 a[8:11], v[100:103], v[52:55], a[8:11]
    ds_read_b128 a[244:247], v2 offset:5120
    v_mfma_f32_16x16x32_bf16 a[12:15], v[96:99], v[56:59], a[12:15]
    buffer_load_dwordx4 v1, s[36:39], s77 offen offset:1024 sc1 lds
    v_mfma_f32_16x16x32_bf16 a[12:15], v[100:103], v[60:63], a[12:15]
    ds_read_b128 a[248:251], v2 offset:6144
    ds_read_b128 a[252:255], v2 offset:7168
    v_mfma_f32_16x16x32_bf16 v[244:247], a[224:227], v[140:143], v[156:159]
    v_exp_f32 v240, v240
    v_mfma_f32_16x16x32_bf16 v[244:247], a[228:231], v[172:175], v[244:247]
    ds_read_b128 v[112:115], v2 offset:20480
    ds_read_b128 v[116:119], v2 offset:21504
    v_mfma_f32_16x16x32_bf16 v[244:247], a[232:235], v[204:207], v[244:247]
    v_exp_f32 v241, v241
    v_mfma_f32_16x16x32_bf16 v[244:247], a[236:239], v[236:239], v[244:247]
    s_waitcnt lgkmcnt(4)
    ds_read_b128 v[120:123], v2 offset:22528
    ds_read_b128 v[124:127], v2 offset:23552
    v_mfma_f32_16x16x32_bf16 a[24:27], v[104:107], v[48:51], a[24:27]
    buffer_load_dwordx4 v1, s[36:39], s77 offen offset:2048 sc1 lds
    v_mfma_f32_16x16x32_bf16 a[24:27], v[108:111], v[52:55], a[24:27]
    ds_read_b128 a[224:227], v2 offset:8192
    ds_read_b128 a[228:231], v2 offset:9216
    v_mfma_f32_16x16x32_bf16 a[28:31], v[104:107], v[56:59], a[28:31]
    ds_read_b128 a[232:235], v2 offset:10240
    v_cvt_pk_bf16_f32 v80, v240, v241
    v_mfma_f32_16x16x32_bf16 a[28:31], v[108:111], v[60:63], a[28:31]
    v_exp_f32 v242, v242
    v_mfma_f32_16x16x32_bf16 v[248:251], a[240:243], v[136:139], v[180:183]
    ds_read_b128 a[236:239], v2 offset:11264
    ds_read_b128 v[96:99], v2 offset:24576
    v_mfma_f32_16x16x32_bf16 v[248:251], a[244:247], v[168:171], v[248:251]
    s_waitcnt lgkmcnt(5)
    v_exp_f32 v243, v243
    v_mfma_f32_16x16x32_bf16 v[248:251], a[248:251], v[200:203], v[248:251]
    buffer_load_dwordx4 v1, s[36:39], s77 offen offset:3072 sc1 lds
    v_mfma_f32_16x16x32_bf16 v[248:251], a[252:255], v[232:235], v[248:251]
    ds_read_b128 v[100:103], v2 offset:25600
    v_cvt_pk_bf16_f32 v81, v242, v243
    v_mfma_f32_16x16x32_bf16 a[40:43], v[112:115], v[48:51], a[40:43]
    ds_read_b128 v[104:107], v2 offset:26624
    ds_read_b128 v[108:111], v2 offset:27648
    v_mfma_f32_16x16x32_bf16 a[40:43], v[116:119], v[52:55], a[40:43]
    v_exp_f32 v244, v244
    v_mfma_f32_16x16x32_bf16 a[44:47], v[112:115], v[56:59], a[44:47]
    v_exp_f32 v245, v245
    v_mfma_f32_16x16x32_bf16 a[44:47], v[116:119], v[60:63], a[44:47]
    s_add_u32 s100, s77, 4096
    v_exp_f32 v246, v246
    v_mfma_f32_16x16x32_bf16 v[252:255], a[240:243], v[140:143], v[156:159]
    s_add_u32 m0, m0, 4096
    v_exp_f32 v247, v247
    v_mfma_f32_16x16x32_bf16 v[252:255], a[244:247], v[172:175], v[252:255]
    buffer_load_dwordx4 v1, s[36:39], s100 offen sc1 lds
    v_mfma_f32_16x16x32_bf16 v[252:255], a[248:251], v[204:207], v[252:255]
    v_cvt_pk_bf16_f32 v88, v244, v245
    v_cvt_pk_bf16_f32 v89, v246, v247
    v_mfma_f32_16x16x32_bf16 v[252:255], a[252:255], v[236:239], v[252:255]
    ds_read_b128 a[240:243], v2 offset:12288
    ds_read_b128 a[244:247], v2 offset:13312
    v_mfma_f32_16x16x32_bf16 a[56:59], v[120:123], v[48:51], a[56:59]
    v_exp_f32 v248, v248
    v_mfma_f32_16x16x32_bf16 a[56:59], v[124:127], v[52:55], a[56:59]
    buffer_load_dwordx4 v1, s[36:39], s100 offen offset:1024 sc1 lds
    v_mfma_f32_16x16x32_bf16 a[60:63], v[120:123], v[56:59], a[60:63]
    ds_read_b128 a[248:251], v2 offset:14336
    ds_read_b128 a[252:255], v2 offset:15360
    v_mfma_f32_16x16x32_bf16 a[60:63], v[124:127], v[60:63], a[60:63]
    s_waitcnt lgkmcnt(4)
    v_exp_f32 v249, v249
    v_mfma_f32_16x16x32_bf16 v[240:243], a[224:227], v[136:139], v[184:187]
    ds_read_b128 v[112:115], v2 offset:28672
    ds_read_b128 v[116:119], v2 offset:29696
    v_mfma_f32_16x16x32_bf16 v[240:243], a[228:231], v[168:171], v[240:243]
    v_exp_f32 v250, v250
    v_mfma_f32_16x16x32_bf16 v[240:243], a[232:235], v[200:203], v[240:243]
    v_exp_f32 v251, v251
    v_mfma_f32_16x16x32_bf16 v[240:243], a[236:239], v[232:235], v[240:243]
    buffer_load_dwordx4 v1, s[36:39], s100 offen offset:2048 sc1 lds
    v_mfma_f32_16x16x32_bf16 a[152:155], v[96:99], v[48:51], a[152:155]
    v_cvt_pk_bf16_f32 v82, v248, v249
    v_cvt_pk_bf16_f32 v83, v250, v251
    v_mfma_f32_16x16x32_bf16 a[152:155], v[100:103], v[52:55], a[152:155]
    ds_read_b128 v[120:123], v2 offset:30720
    ds_read_b128 v[124:127], v2 offset:31744
    v_mfma_f32_16x16x32_bf16 a[156:159], v[96:99], v[56:59], a[156:159]
    v_exp_f32 v252, v252
    v_mfma_f32_16x16x32_bf16 a[156:159], v[100:103], v[60:63], a[156:159]
    v_exp_f32 v253, v253
    v_mfma_f32_16x16x32_bf16 v[244:247], a[224:227], v[140:143], v[156:159]
    v_exp_f32 v254, v254
    v_mfma_f32_16x16x32_bf16 v[244:247], a[228:231], v[172:175], v[244:247]
    buffer_load_dwordx4 v1, s[36:39], s100 offen offset:3072 sc1 lds
    v_mfma_f32_16x16x32_bf16 v[244:247], a[232:235], v[204:207], v[244:247]
    v_exp_f32 v255, v255
    v_mfma_f32_16x16x32_bf16 v[244:247], a[236:239], v[236:239], v[244:247]
    s_cmp_eq_u32 s82, 163840
    s_cselect_b32 s82, 0, s82
    v_cvt_pk_bf16_f32 v90, v252, v253
    v_mfma_f32_16x16x32_bf16 a[168:171], v[104:107], v[48:51], a[168:171]
    v_cvt_pk_bf16_f32 v91, v254, v255
    v_add_u32 v2, s82, v1
    v_mfma_f32_16x16x32_bf16 a[168:171], v[108:111], v[52:55], a[168:171]
    ds_read_b128 a[224:227], v2 offset:0
    ds_read_b128 a[228:231], v2 offset:1024
    v_mfma_f32_16x16x32_bf16 a[172:175], v[104:107], v[56:59], a[172:175]
    s_add_u32 s77, s77, 32768
    v_exp_f32 v240, v240
    v_mfma_f32_16x16x32_bf16 a[172:175], v[108:111], v[60:63], a[172:175]
    s_waitcnt lgkmcnt(2)
    ds_read_b128 a[232:235], v2 offset:2048
    ds_read_b128 a[236:239], v2 offset:3072
    v_mfma_f32_16x16x32_bf16 v[248:251], a[240:243], v[136:139], v[188:191]
    v_exp_f32 v241, v241
    v_mfma_f32_16x16x32_bf16 v[248:251], a[244:247], v[168:171], v[248:251]
    ds_read_b128 v[96:99], v2 offset:16384
    ds_read_b128 v[100:103], v2 offset:17408
    v_mfma_f32_16x16x32_bf16 v[248:251], a[248:251], v[200:203], v[248:251]
    v_exp_f32 v242, v242
    v_mfma_f32_16x16x32_bf16 v[248:251], a[252:255], v[232:235], v[248:251]
    v_exp_f32 v243, v243
    v_mfma_f32_16x16x32_bf16 a[184:187], v[112:115], v[48:51], a[184:187]
    v_exp_f32 v244, v244
    v_mfma_f32_16x16x32_bf16 a[184:187], v[116:119], v[52:55], a[184:187]
    v_exp_f32 v245, v245
    v_mfma_f32_16x16x32_bf16 a[188:191], v[112:115], v[56:59], a[188:191]
    v_exp_f32 v246, v246
    v_mfma_f32_16x16x32_bf16 a[188:191], v[116:119], v[60:63], a[188:191]
    v_exp_f32 v247, v247
    v_mfma_f32_16x16x32_bf16 v[252:255], a[240:243], v[140:143], v[156:159]
    v_exp_f32 v248, v248
    v_mfma_f32_16x16x32_bf16 v[252:255], a[244:247], v[172:175], v[252:255]
    v_exp_f32 v249, v249
    v_mfma_f32_16x16x32_bf16 v[252:255], a[248:251], v[204:207], v[252:255]
    v_exp_f32 v250, v250
    v_mfma_f32_16x16x32_bf16 v[252:255], a[252:255], v[236:239], v[252:255]
    v_exp_f32 v251, v251
    v_mfma_f32_16x16x32_bf16 a[200:203], v[120:123], v[48:51], a[200:203]
    v_cvt_pk_bf16_f32 v84, v240, v241
    v_cvt_pk_bf16_f32 v85, v242, v243
    v_mfma_f32_16x16x32_bf16 a[200:203], v[124:127], v[52:55], a[200:203]
    v_cvt_pk_bf16_f32 v92, v244, v245
    v_cvt_pk_bf16_f32 v93, v246, v247
    v_mfma_f32_16x16x32_bf16 a[204:207], v[120:123], v[56:59], a[204:207]
    v_exp_f32 v252, v252
    v_mfma_f32_16x16x32_bf16 a[204:207], v[124:127], v[60:63], a[204:207]
    v_exp_f32 v253, v253
    v_mfma_f32_16x16x32_bf16 a[216:219], a[136:139], v[48:51], a[216:219]
    v_cvt_pk_bf16_f32 v86, v248, v249
    v_cvt_pk_bf16_f32 v87, v250, v251
    v_mfma_f32_16x16x32_bf16 a[216:219], a[136:139], v[52:55], a[216:219]
    v_cvt_pk_bf16_f32 v94, v252, v253
    v_mfma_f32_16x16x32_bf16 a[220:223], a[136:139], v[56:59], a[220:223]
    v_mfma_f32_16x16x32_bf16 a[220:223], a[136:139], v[60:63], a[220:223]
    s_cmp_le_u32 s78, 2
    s_cbranch_scc1 K1_LS_MASK
K1_LS_BACK:
    s_waitcnt lgkmcnt(0)
    v_mfma_f32_16x16x32_bf16 v[240:243], a[224:227], v[136:139], v[176:179]
    s_add_u32 m0, s76, s75
    v_exp_f32 v254, v254
    v_mfma_f32_16x16x32_bf16 v[240:243], a[228:231], v[168:171], v[240:243]
    s_mov_b32 s76, s60
    v_exp_f32 v255, v255
    v_mfma_f32_16x16x32_bf16 v[240:243], a[232:235], v[200:203], v[240:243]
    s_mov_b32 s60, s82
    buffer_load_dwordx4 v1, s[36:39], s77 offen sc1 lds
    v_mfma_f32_16x16x32_bf16 v[240:243], a[236:239], v[232:235], v[240:243]
    s_add_u32 s82, s82, 32768
    ds_read_b128 v[104:107], v2 offset:18432
    v_cvt_pk_bf16_f32 v95, v254, v255
    v_mfma_f32_16x16x32_bf16 a[8:11], v[96:99], v[80:83], a[8:11]
    ds_read_b128 v[108:111], v2 offset:19456
    ds_read_b128 a[240:243], v2 offset:4096
    v_mfma_f32_16x16x32_bf16 a[8:11], v[100:103], v[84:87], a[8:11]
    ds_read_b128 a[244:247], v2 offset:5120
    v_mfma_f32_16x16x32_bf16 a[12:15], v[96:99], v[88:91], a[12:15]
    buffer_load_dwordx4 v1, s[36:39], s77 offen offset:1024 sc1 lds
    v_mfma_f32_16x16x32_bf16 a[12:15], v[100:103], v[92:95], a[12:15]
    ds_read_b128 a[248:251], v2 offset:6144
    ds_read_b128 a[252:255], v2 offset:7168
    v_mfma_f32_16x16x32_bf16 v[244:247], a[224:227], v[140:143], v[156:159]
    v_exp_f32 v240, v240
    v_mfma_f32_16x16x32_bf16 v[244:247], a[228:231], v[172:175], v[244:247]
    ds_read_b128 v[112:115], v2 offset:20480
    ds_read_b128 v[116:119], v2 offset:21504
    v_mfma_f32_16x16x32_bf16 v[244:247], a[232:235], v[204:207], v[244:247]
    v_exp_f32 v241, v241
    v_mfma_f32_16x16x32_bf16 v[244:247], a[236:239], v[236:239], v[244:247]
    s_waitcnt lgkmcnt(4)
    ds_read_b128 v[120:123], v2 offset:22528
    ds_read_b128 v[124:127], v2 offset:23552
    v_mfma_f32_16x16x32_bf16 a[24:27], v[104:107], v[80:83], a[24:27]
    buffer_load_dwordx4 v1, s[36:39], s77 offen offset:2048 sc1 lds
    v_mfma_f32_16x16x32_bf16 a[24:27], v[108:111], v[84:87], a[24:27]
    ds_read_b128 a[224:227], v2 offset:8192
    ds_read_b128 a[228:231], v2 offset:9216
    v_mfma_f32_16x16x32_bf16 a[28:31], v[104:107], v[88:91], a[28:31]
    ds_read_b128 a[232:235], v2 offset:10240
    v_cvt_pk_bf16_f32 v48, v240, v241
    v_mfma_f32_16x16x32_bf16 a[28:31], v[108:111], v[92:95], a[28:31]
    v_exp_f32 v242, v242
    v_mfma_f32_16x16x32_bf16 v[248:251], a[240:243], v[136:139], v[180:183]
    ds_read_b128 a[236:239], v2 offset:11264
    ds_read_b128 v[96:99], v2 offset:24576
    v_mfma_f32_16x16x32_bf16 v[248:251], a[244:247], v[168:171], v[248:251]
    s_waitcnt lgkmcnt(5)
    v_exp_f32 v243, v243
    v_mfma_f32_16x16x32_bf16 v[248:251], a[248:251], v[200:203], v[248:251]
    buffer_load_dwordx4 v1, s[36:39], s77 offen offset:3072 sc1 lds
    v_mfma_f32_16x16x32_bf16 v[248:251], a[252:255], v[232:235], v[248:251]
    ds_read_b128 v[100:103], v2 offset:25600
    v_cvt_pk_bf16_f32 v49, v242, v243
    v_mfma_f32_16x16x32_bf16 a[40:43], v[112:115], v[80:83], a[40:43]
    ds_read_b128 v[104:107], v2 offset:26624
    ds_read_b128 v[108:111], v2 offset:27648
    v_mfma_f32_16x16x32_bf16 a[40:43], v[116:119], v[84:87], a[40:43]
    v_exp_f32 v244, v244
    v_mfma_f32_16x16x32_bf16 a[44:47], v[112:115], v[88:91], a[44:47]
    v_exp_f32 v245, v245
    v_mfma_f32_16x16x32_bf16 a[44:47], v[116:119], v[92:95], a[44:47]
    s_add_u32 s100, s77, 4096
    v_exp_f32 v246, v246
    v_mfma_f32_16x16x32_bf16 v[252:255], a[240:243], v[140:143], v[156:159]
    s_add_u32 m0, m0, 4096
    v_exp_f32 v247, v247
    v_mfma_f32_16x16x32_bf16 v[252:255], a[244:247], v[172:175], v[252:255]
    buffer_load_dwordx4 v1, s[36:39], s100 offen sc1 lds
    v_mfma_f32_16x16x32_bf16 v[252:255], a[248:251], v[204:207], v[252:255]
    v_cvt_pk_bf16_f32 v56, v244, v245
    v_cvt_pk_bf16_f32 v57, v246, v247
    v_mfma_f32_16x16x32_bf16 v[252:255], a[252:255], v[236:239], v[252:255]
    ds_read_b128 a[240:243], v2 offset:12288
    ds_read_b128 a[244:247], v2 offset:13312
    v_mfma_f32_16x16x32_bf16 a[56:59], v[120:123], v[80:83], a[56:59]
    v_exp_f32 v248, v248
    v_mfma_f32_16x16x32_bf16 a[56:59], v[124:127], v[84:87], a[56:59]
    buffer_load_dwordx4 v1, s[36:39], s100 offen offset:1024 sc1 lds
    v_mfma_f32_16x16x32_bf16 a[60:63], v[120:123], v[88:91], a[60:63]
    ds_read_b128 a[248:251], v2 offset:14336
    ds_read_b128 a[252:255], v2 offset:15360
    v_mfma_f32_16x16x32_bf16 a[60:63], v[124:127], v[92:95], a[60:63]
    s_waitcnt lgkmcnt(4)
    v_exp_f32 v249, v249
    v_mfma_f32_16x16x32_bf16 v[240:243], a[224:227], v[136:139], v[184:187]
    ds_read_b128 v[112:115], v2 offset:28672
    ds_read_b128 v[116:119], v2 offset:29696
    v_mfma_f32_16x16x32_bf16 v[240:243], a[228:231], v[168:171], v[240:243]
    v_exp_f32 v250, v250
    v_mfma_f32_16x16x32_bf16 v[240:243], a[232:235], v[200:203], v[240:243]
    v_exp_f32 v251, v251
    v_mfma_f32_16x16x32_bf16 v[240:243], a[236:239], v[232:235], v[240:243]
    buffer_load_dwordx4 v1, s[36:39], s100 offen offset:2048 sc1 lds
    v_mfma_f32_16x16x32_bf16 a[152:155], v[96:99], v[80:83], a[152:155]
    v_cvt_pk_bf16_f32 v50, v248, v249
    v_cvt_pk_bf16_f32 v51, v250, v251
    v_mfma_f32_16x16x32_bf16 a[152:155], v[100:103], v[84:87], a[152:155]
    ds_read_b128 v[120:123], v2 offset:30720
    ds_read_b128 v[124:127], v2 offset:31744
    v_mfma_f32_16x16x32_bf16 a[156:159], v[96:99], v[88:91], a[156:159]
    v_exp_f32 v252, v252
    v_mfma_f32_16x16x32_bf16 a[156:159], v[100:103], v[92:95], a[156:159]
    v_exp_f32 v253, v253
    v_mfma_f32_16x16x32_bf16 v[244:247], a[224:227], v[140:143], v[156:159]
    v_exp_f32 v254, v254
    v_mfma_f32_16x16x32_bf16 v[244:247], a[228:231], v[172:175], v[244:247]
    buffer_load_dwordx4 v1, s[36:39], s100 offen offset:3072 sc1 lds
    v_mfma_f32_16x16x32_bf16 v[244:247], a[232:235], v[204:207], v[244:247]
    v_exp_f32 v255, v255
    v_mfma_f32_16x16x32_bf16 v[244:247], a[236:239], v[236:239], v[244:247]
    s_cmp_eq_u32 s82, 163840
    s_cselect_b32 s82, 0, s82
    v_cvt_pk_bf16_f32 v58, v252, v253
    v_mfma_f32_16x16x32_bf16 a[168:171], v[104:107], v[80:83], a[168:171]
    v_cvt_pk_bf16_f32 v59, v254, v255
    v_add_u32 v2, s82, v1
    v_mfma_f32_16x16x32_bf16 a[168:171], v[108:111], v[84:87], a[168:171]
    v_exp_f32 v240, v240
    v_mfma_f32_16x16x32_bf16 a[172:175], v[104:107], v[88:91], a[172:175]
    s_add_u32 s77, s77, 32768
    v_exp_f32 v241, v241
    v_mfma_f32_16x16x32_bf16 a[172:175], v[108:111], v[92:95], a[172:175]
    s_waitcnt lgkmcnt(0)
    v_exp_f32 v242, v242
    v_mfma_f32_16x16x32_bf16 v[248:251], a[240:243], v[136:139], v[188:191]
    v_exp_f32 v243, v243
    v_mfma_f32_16x16x32_bf16 v[248:251], a[244:247], v[168:171], v[248:251]
    v_exp_f32 v244, v244
    v_mfma_f32_16x16x32_bf16 v[248:251], a[248:251], v[200:203], v[248:251]
    v_exp_f32 v245, v245
    v_mfma_f32_16x16x32_bf16 v[248:251], a[252:255], v[232:235], v[248:251]
    v_exp_f32 v246, v246
    v_mfma_f32_16x16x32_bf16 a[184:187], v[112:115], v[80:83], a[184:187]
    v_exp_f32 v247, v247
    v_mfma_f32_16x16x32_bf16 a[184:187], v[116:119], v[84:87], a[184:187]
    v_cvt_pk_bf16_f32 v52, v240, v241
    v_cvt_pk_bf16_f32 v53, v242, v243
    v_mfma_f32_16x16x32_bf16 a[188:191], v[112:115], v[88:91], a[188:191]
    v_cvt_pk_bf16_f32 v60, v244, v245
    v_cvt_pk_bf16_f32 v61, v246, v247
    v_mfma_f32_16x16x32_bf16 a[188:191], v[116:119], v[92:95], a[188:191]
    s_waitcnt vmcnt(8) lgkmcnt(0)
    s_barrier
    ds_read_b128 a[224:227], v2 offset:0
    v_mfma_f32_16x16x32_bf16 v[252:255], a[240:243], v[140:143], v[156:159]
    ds_read_b128 a[228:231], v2 offset:1024
    ds_read_b128 a[232:235], v2 offset:2048
    v_mfma_f32_16x16x32_bf16 v[252:255], a[244:247], v[172:175], v[252:255]
    v_exp_f32 v248, v248
    v_mfma_f32_16x16x32_bf16 v[252:255], a[248:251], v[204:207], v[252:255]
    ds_read_b128 a[236:239], v2 offset:3072
    ds_read_b128 v[96:99], v2 offset:16384
    v_mfma_f32_16x16x32_bf16 v[252:255], a[252:255], v[236:239], v[252:255]
    v_exp_f32 v249, v249
    v_mfma_f32_16x16x32_bf16 a[200:203], v[120:123], v[80:83], a[200:203]
    ds_read_b128 v[100:103], v2 offset:17408
    v_cvt_pk_bf16_f32 v54, v248, v249
    v_mfma_f32_16x16x32_bf16 a[200:203], v[124:127], v[84:87], a[200:203]
    v_exp_f32 v250, v250
    v_mfma_f32_16x16x32_bf16 a[204:207], v[120:123], v[88:91], a[204:207]
    v_exp_f32 v251, v251
    v_mfma_f32_16x16x32_bf16 a[204:207], v[124:127], v[92:95], a[204:207]
    v_exp_f32 v252, v252
    v_mfma_f32_16x16x32_bf16 a[216:219], a[136:139], v[80:83], a[216:219]
    v_exp_f32 v253, v253
    v_mfma_f32_16x16x32_bf16 a[216:219], a[136:139], v[84:87], a[216:219]
    v_cvt_pk_bf16_f32 v55, v250, v251
    v_cvt_pk_bf16_f32 v62, v252, v253
    v_mfma_f32_16x16x32_bf16 a[220:223], a[136:139], v[88:91], a[220:223]
    v_mfma_f32_16x16x32_bf16 a[220:223], a[136:139], v[92:95], a[220:223]
    s_sub_u32 s78, s78, 1
    s_cmp_lg_u32 s78, 0
    s_cbranch_scc1 K1_LS
K1_LS_END:
    v_add_f32 v212, s12, v156
    v_fma_f32 v176, v208, s8, v212
    v_fma_f32 v177, v209, s8, v212
    v_fma_f32 v178, v210, s8, v212
    v_fma_f32 v179, v211, s8, v212
    s_nop 1
    s_waitcnt lgkmcnt(0)
    v_mfma_f32_16x16x32_bf16 v[240:243], a[224:227], v[140:143], v[176:179]
    s_xor_b32 s21, s3, 1
    s_lshl2_add_u32 s21, s21, s4
    ds_read_b128 v[104:107], v2 offset:18432
    v_mfma_f32_16x16x32_bf16 v[240:243], a[228:231], v[172:175], v[240:243]
    s_mul_i32 s21, s21, 36864
    ds_read_b128 v[108:111], v2 offset:19456
    ds_read_b128 a[240:243], v2 offset:4096
    v_mfma_f32_16x16x32_bf16 v[240:243], a[232:235], v[204:207], v[240:243]
    s_add_u32 s21, s21, s28
    s_mov_b32 m0, s45
    ds_read_b128 a[244:247], v2 offset:5120
    v_mfma_f32_16x16x32_bf16 v[240:243], a[236:239], v[236:239], v[240:243]
    s_mul_i32 s86, s4, 34
    buffer_load_dwordx4 v1, s[56:59], s21 offen sc1 lds
    v_mfma_f32_16x16x32_bf16 a[8:11], v[96:99], v[48:51], a[8:11]
    s_add_u32 s86, s86, 8
    v_exp_f32 v254, v254
    v_mfma_f32_16x16x32_bf16 a[8:11], v[100:103], v[52:55], a[8:11]
    s_mov_b32 s76, s60
    v_exp_f32 v255, v255
    v_mfma_f32_16x16x32_bf16 a[12:15], v[96:99], v[56:59], a[12:15]
    s_mov_b32 s60, s82
    v_cvt_pk_bf16_f32 v63, v254, v255
    ds_read_b128 a[248:251], v2 offset:6144
    s_nop 0
    v_mfma_f32_16x16x32_bf16 a[12:15], v[100:103], v[60:63], a[12:15]
    s_add_u32 s82, s82, 32768
    v_lshrrev_b32 v28, 4, v1
    ds_read_b128 a[252:255], v2 offset:7168
    s_waitcnt lgkmcnt(2)
    v_mfma_f32_16x16x32_bf16 a[24:27], v[104:107], v[48:51], a[24:27]
    s_and_b32 s62, s5, 4
    v_min_u32 v28, 33, v28
    ds_read_b128 v[112:115], v2 offset:20480
    v_mfma_f32_16x16x32_bf16 a[24:27], v[108:111], v[52:55], a[24:27]
    s_lshl_b32 s63, s3, 12
    buffer_load_dwordx4 v1, s[56:59], s21 offen offset:1024 sc1 lds
    v_mfma_f32_16x16x32_bf16 a[28:31], v[104:107], v[56:59], a[28:31]
    s_sub_u32 s19, s74, s101
    v_add_lshl_u32 v28, v28, s86, 7
    v_add_f32 v213, s13, v156
    v_mfma_f32_16x16x32_bf16 a[28:31], v[108:111], v[60:63], a[28:31]
    s_getpc_b64 s[86:87]
    global_load_dword v28, v28, s[86:87]
    v_fma_f32 v180, v208, s9, v213
    v_fma_f32 v181, v209, s9, v213
    v_fma_f32 v182, v210, s9, v213
    v_fma_f32 v183, v211, s9, v213
    s_nop 1
    v_mfma_f32_16x16x32_bf16 v[244:247], a[240:243], v[140:143], v[180:183]
    s_add_u32 s62, s62, s4
    ds_read_b128 v[116:119], v2 offset:21504
    ds_read_b128 v[120:123], v2 offset:22528
    v_mfma_f32_16x16x32_bf16 v[244:247], a[244:247], v[172:175], v[244:247]
    s_mov_b32 s20, s63
    ds_read_b128 v[124:127], v2 offset:23552
    v_add_f32 v214, s14, v156
    s_waitcnt lgkmcnt(3)
    v_mfma_f32_16x16x32_bf16 v[244:247], a[248:251], v[204:207], v[244:247]
    s_add_u32 s19, s66, s19
    buffer_load_dwordx4 v1, s[56:59], s21 offen offset:2048 sc1 lds
    v_mfma_f32_16x16x32_bf16 v[244:247], a[252:255], v[236:239], v[244:247]
    s_mov_b32 s50, 9437184
    ds_read_b128 a[224:227], v2 offset:8192
    ds_read_b128 a[228:231], v2 offset:9216
    v_mfma_f32_16x16x32_bf16 a[40:43], v[112:115], v[48:51], a[40:43]
    s_waitcnt lgkmcnt(4)
    ds_read_b128 a[232:235], v2 offset:10240
    v_fma_f32 v184, v208, s10, v214
    v_mfma_f32_16x16x32_bf16 a[40:43], v[116:119], v[52:55], a[40:43]
    ds_read_b128 a[236:239], v2 offset:11264
    v_fma_f32 v185, v209, s10, v214
    v_mfma_f32_16x16x32_bf16 a[44:47], v[112:115], v[56:59], a[44:47]
    ds_read_b128 v[96:99], v2 offset:24576
    v_fma_f32 v186, v210, s10, v214
    v_mfma_f32_16x16x32_bf16 a[44:47], v[116:119], v[60:63], a[44:47]
    s_waitcnt lgkmcnt(5)
    ds_read_b128 v[100:103], v2 offset:25600
    v_fma_f32 v187, v211, s10, v214
    v_mfma_f32_16x16x32_bf16 a[56:59], v[120:123], v[48:51], a[56:59]
    buffer_load_dwordx4 v1, s[56:59], s21 offen offset:3072 sc1 lds
    v_mfma_f32_16x16x32_bf16 a[56:59], v[124:127], v[52:55], a[56:59]
    s_add_u32 s21, s21, 4096
    ds_read_b128 v[104:107], v2 offset:26624
    ds_read_b128 v[108:111], v2 offset:27648
    v_mfma_f32_16x16x32_bf16 a[60:63], v[120:123], v[56:59], a[60:63]
    s_add_u32 m0, s45, 4096
    ds_read_b128 a[240:243], v2 offset:12288
    v_add_f32 v215, s15, v156
    v_mfma_f32_16x16x32_bf16 a[60:63], v[124:127], v[60:63], a[60:63]
    s_waitcnt lgkmcnt(4)
    ds_read_b128 a[244:247], v2 offset:13312
    v_fma_f32 v188, v208, s11, v215
    v_mfma_f32_16x16x32_bf16 v[248:251], a[224:227], v[140:143], v[184:187]
    ds_read_b128 a[248:251], v2 offset:14336
    v_fma_f32 v189, v209, s11, v215
    v_mfma_f32_16x16x32_bf16 v[248:251], a[228:231], v[172:175], v[248:251]
    ds_read_b128 a[252:255], v2 offset:15360
    v_fma_f32 v190, v210, s11, v215
    v_mfma_f32_16x16x32_bf16 v[248:251], a[232:235], v[204:207], v[248:251]
    buffer_load_dwordx4 v1, s[56:59], s21 offen sc1 lds
    v_mfma_f32_16x16x32_bf16 v[248:251], a[236:239], v[236:239], v[248:251]
    ds_read_b128 v[112:115], v2 offset:28672
    ds_read_b128 v[116:119], v2 offset:29696
    v_mfma_f32_16x16x32_bf16 a[152:155], v[96:99], v[48:51], a[152:155]
    s_waitcnt lgkmcnt(4)
    v_fma_f32 v191, v211, s11, v215
    ds_read_b128 v[120:123], v2 offset:30720
    v_mfma_f32_16x16x32_bf16 a[152:155], v[100:103], v[52:55], a[152:155]
    ds_read_b128 v[124:127], v2 offset:31744
    v_bfe_u32 v217, v1, 4, 3
    v_mfma_f32_16x16x32_bf16 a[156:159], v[96:99], v[56:59], a[156:159]
    s_cmp_eq_u32 s82, 163840
    s_cselect_b32 s82, 0, s82
    v_add_u32 v2, s82, v1
    v_mfma_f32_16x16x32_bf16 a[156:159], v[100:103], v[60:63], a[156:159]
    ds_read_b128 a[224:227], v2 offset:0
    ds_read_b128 a[228:231], v2 offset:1024
    v_mfma_f32_16x16x32_bf16 a[168:171], v[104:107], v[48:51], a[168:171]
    buffer_load_dwordx4 v1, s[56:59], s21 offen offset:1024 sc1 lds
    v_mfma_f32_16x16x32_bf16 a[168:171], v[108:111], v[52:55], a[168:171]
    ds_read_b128 a[232:235], v2 offset:2048
    ds_read_b128 a[236:239], v2 offset:3072
    v_mfma_f32_16x16x32_bf16 a[172:175], v[104:107], v[56:59], a[172:175]
    ds_read_b128 v[96:99], v2 offset:16384
    v_lshlrev_b32 v217, 7, v217
    v_mfma_f32_16x16x32_bf16 a[172:175], v[108:111], v[60:63], a[172:175]
    v_exp_f32 v240, v240
    v_mfma_f32_16x16x32_bf16 v[252:255], a[240:243], v[140:143], v[188:191]
    v_exp_f32 v241, v241
    v_mfma_f32_16x16x32_bf16 v[252:255], a[244:247], v[172:175], v[252:255]
    s_waitcnt lgkmcnt(3)
    ds_read_b128 v[100:103], v2 offset:17408
    v_cvt_pk_bf16_f32 v88, v240, v241
    v_mfma_f32_16x16x32_bf16 v[252:255], a[248:251], v[204:207], v[252:255]
    buffer_load_dwordx4 v1, s[56:59], s21 offen offset:2048 sc1 lds
    v_mfma_f32_16x16x32_bf16 v[252:255], a[252:255], v[236:239], v[252:255]
    v_exp_f32 v242, v242
    v_mfma_f32_16x16x32_bf16 a[184:187], v[112:115], v[48:51], a[184:187]
    v_exp_f32 v243, v243
    v_mfma_f32_16x16x32_bf16 a[184:187], v[116:119], v[52:55], a[184:187]
    v_exp_f32 v244, v244
    v_mfma_f32_16x16x32_bf16 a[188:191], v[112:115], v[56:59], a[188:191]
    v_exp_f32 v245, v245
    v_mfma_f32_16x16x32_bf16 a[188:191], v[116:119], v[60:63], a[188:191]
    v_exp_f32 v246, v246
    v_mfma_f32_16x16x32_bf16 a[200:203], v[120:123], v[48:51], a[200:203]
    v_exp_f32 v247, v247
    v_mfma_f32_16x16x32_bf16 a[200:203], v[124:127], v[52:55], a[200:203]
    v_exp_f32 v248, v248
    v_mfma_f32_16x16x32_bf16 a[204:207], v[120:123], v[56:59], a[204:207]
    v_exp_f32 v249, v249
    v_mfma_f32_16x16x32_bf16 a[204:207], v[124:127], v[60:63], a[204:207]
    v_exp_f32 v250, v250
    v_mfma_f32_16x16x32_bf16 a[216:219], a[136:139], v[48:51], a[216:219]
    v_exp_f32 v251, v251
    v_mfma_f32_16x16x32_bf16 a[216:219], a[136:139], v[52:55], a[216:219]
    v_exp_f32 v252, v252
    v_mfma_f32_16x16x32_bf16 a[220:223], a[136:139], v[56:59], a[220:223]
    s_add_u32 s48, s32, 1048576
    s_addc_u32 s49, s33, 0
    v_cvt_pk_bf16_f32 v89, v242, v243
    v_mfma_f32_16x16x32_bf16 a[220:223], a[136:139], v[60:63], a[220:223]
    v_exp_f32 v253, v253
    v_cvt_pk_bf16_f32 v90, v244, v245
    v_cvt_pk_bf16_f32 v91, v246, v247
    v_cvt_pk_bf16_f32 v92, v248, v249
    v_cvt_pk_bf16_f32 v93, v250, v251
    v_cvt_pk_bf16_f32 v94, v252, v253
    s_cmp_eq_u32 s6, 7
    s_cbranch_scc1 K1_S7
K1_S7_BACK:
    ds_read_b128 v[104:107], v2 offset:18432
    ds_read_b128 v[108:111], v2 offset:19456
    ds_read_b128 v[112:115], v2 offset:20480
    ds_read_b128 v[116:119], v2 offset:21504
    ds_read_b128 v[120:123], v2 offset:22528
    ds_read_b128 v[124:127], v2 offset:23552
    s_waitcnt lgkmcnt(6)
    v_mfma_f32_16x16x32_bf16 a[12:15], v[96:99], v[88:91], a[12:15]
    v_exp_f32 v254, v254
    v_exp_f32 v255, v255
    s_nop 0
    v_cvt_pk_bf16_f32 v95, v254, v255
    s_nop 1
    v_mfma_f32_16x16x32_bf16 a[12:15], v[100:103], v[92:95], a[12:15]
    s_waitcnt lgkmcnt(5)
    ds_read_b128 v[96:99], v2 offset:24576
    ds_read_b128 v[100:103], v2 offset:25600
    v_accvgpr_read_b32 v9, a216
    v_rcp_f32 v10, v9
    v_mfma_f32_16x16x32_bf16 a[28:31], v[104:107], v[88:91], a[28:31]
    s_waitcnt lgkmcnt(6)
    ds_read_b128 v[104:107], v2 offset:26624
    v_mul_f32 v10, v10, v6
    v_accvgpr_read_b32 v12, a8
    v_accvgpr_read_b32 v13, a9
    v_accvgpr_read_b32 v14, a10
    v_mfma_f32_16x16x32_bf16 a[28:31], v[108:111], v[92:95], a[28:31]
    s_waitcnt lgkmcnt(6)
    ds_read_b128 v[108:111], v2 offset:27648
    v_accvgpr_read_b32 v15, a11
    v_accvgpr_read_b32 v16, a24
    v_accvgpr_read_b32 v17, a25
    v_accvgpr_read_b32 v18, a26
    v_mfma_f32_16x16x32_bf16 a[44:47], v[112:115], v[88:91], a[44:47]
    s_waitcnt lgkmcnt(4)
    ds_read_b128 v[112:115], v2 offset:28672
    v_accvgpr_read_b32 v19, a27
    v_accvgpr_read_b32 v20, a40
    v_accvgpr_read_b32 v21, a41
    v_accvgpr_read_b32 v22, a42
    v_mfma_f32_16x16x32_bf16 a[44:47], v[116:119], v[92:95], a[44:47]
    ds_read_b128 v[116:119], v2 offset:29696
    v_accvgpr_read_b32 v23, a43
    v_accvgpr_read_b32 v24, a56
    v_accvgpr_read_b32 v25, a57
    v_accvgpr_read_b32 v26, a58
    v_mfma_f32_16x16x32_bf16 a[60:63], v[120:123], v[88:91], a[60:63]
    ds_read_b128 v[120:123], v2 offset:30720
    v_accvgpr_read_b32 v27, a59
    v_mul_f32 v12, v10, v12
    v_mul_f32 v13, v10, v13
    v_mul_f32 v14, v10, v14
    v_mfma_f32_16x16x32_bf16 a[60:63], v[124:127], v[92:95], a[60:63]
    s_waitcnt lgkmcnt(4)
    ds_read_b128 v[124:127], v2 offset:31744
    v_mul_f32 v15, v10, v15
    v_mul_f32 v16, v10, v16
    v_mul_f32 v17, v10, v17
    v_mul_f32 v18, v10, v18
    v_mfma_f32_16x16x32_bf16 a[156:159], v[96:99], v[88:91], a[156:159]
    v_mul_f32 v19, v10, v19
    v_mul_f32 v20, v10, v20
    v_mul_f32 v21, v10, v21
    v_mul_f32 v22, v10, v22
    v_mul_f32 v23, v10, v23
    v_mfma_f32_16x16x32_bf16 a[156:159], v[100:103], v[92:95], a[156:159]
    v_mul_f32 v24, v10, v24
    v_mul_f32 v25, v10, v25
    v_mul_f32 v26, v10, v26
    v_mul_f32 v27, v10, v27
    v_cvt_pk_bf16_f32 v12, v12, v13
    v_mfma_f32_16x16x32_bf16 a[172:175], v[104:107], v[88:91], a[172:175]
    s_waitcnt lgkmcnt(2)
    v_cvt_pk_bf16_f32 v13, v14, v15
    v_cvt_pk_bf16_f32 v14, v16, v17
    v_cvt_pk_bf16_f32 v15, v18, v19
    v_cvt_pk_bf16_f32 v20, v20, v21
    v_cvt_pk_bf16_f32 v21, v22, v23
    v_mfma_f32_16x16x32_bf16 a[172:175], v[108:111], v[92:95], a[172:175]
    v_cvt_pk_bf16_f32 v22, v24, v25
    v_cvt_pk_bf16_f32 v23, v26, v27
    buffer_store_dwordx4 v[12:15], v1, s[40:43], s81 offen offset:0 sc1
    v_accvgpr_read_b32 v16, a168
    v_mfma_f32_16x16x32_bf16 a[188:191], v[112:115], v[88:91], a[188:191]
    buffer_store_dwordx4 v[20:23], v1, s[40:43], s81 offen offset:1024 sc1
    v_accvgpr_read_b32 v12, a152
    v_accvgpr_read_b32 v13, a153
    v_accvgpr_read_b32 v14, a154
    v_mfma_f32_16x16x32_bf16 a[188:191], v[116:119], v[92:95], a[188:191]
    s_waitcnt lgkmcnt(0)
    v_accvgpr_read_b32 v15, a155
    v_accvgpr_read_b32 v17, a169
    v_accvgpr_read_b32 v18, a170
    v_accvgpr_read_b32 v19, a171
    v_accvgpr_read_b32 v20, a184
    v_mfma_f32_16x16x32_bf16 a[204:207], v[120:123], v[88:91], a[204:207]
    v_accvgpr_read_b32 v21, a185
    v_accvgpr_read_b32 v22, a186
    v_accvgpr_read_b32 v23, a187
    v_accvgpr_read_b32 v24, a200
    v_accvgpr_read_b32 v25, a201
    v_mfma_f32_16x16x32_bf16 a[204:207], v[124:127], v[92:95], a[204:207]
    v_accvgpr_read_b32 v26, a202
    v_accvgpr_read_b32 v27, a203
    v_mul_f32 v12, v10, v12
    v_mul_f32 v13, v10, v13
    v_mul_f32 v14, v10, v14
    v_mfma_f32_16x16x32_bf16 a[220:223], a[136:139], v[88:91], a[220:223]
    v_mul_f32 v15, v10, v15
    v_mul_f32 v16, v10, v16
    v_mul_f32 v17, v10, v17
    v_mul_f32 v18, v10, v18
    v_mul_f32 v19, v10, v19
    v_mfma_f32_16x16x32_bf16 a[220:223], a[136:139], v[92:95], a[220:223]
    v_mul_f32 v20, v10, v20
    v_mul_f32 v21, v10, v21
    v_mul_f32 v22, v10, v22
    v_mul_f32 v23, v10, v23
    v_mul_f32 v24, v10, v24
    v_mul_f32 v25, v10, v25
    v_mul_f32 v26, v10, v26
    v_mul_f32 v27, v10, v27
    v_cmp_nge_f32 vcc, 0x71800000, v9
    v_cvt_pk_bf16_f32 v12, v12, v13
    v_cvt_pk_bf16_f32 v13, v14, v15
    v_cvt_pk_bf16_f32 v14, v16, v17
    v_cvt_pk_bf16_f32 v15, v18, v19
    v_cvt_pk_bf16_f32 v20, v20, v21
    v_cvt_pk_bf16_f32 v21, v22, v23
    v_cvt_pk_bf16_f32 v22, v24, v25
    v_cvt_pk_bf16_f32 v23, v26, v27
    s_or_b64 s[84:85], s[84:85], vcc
    buffer_store_dwordx4 v[12:15], v1, s[40:43], s81 offen offset:2048 sc1
    buffer_store_dwordx4 v[20:23], v1, s[40:43], s81 offen offset:3072 sc1
    s_nop 3
    v_accvgpr_read_b32 v9, a220
    v_cmp_nge_f32 vcc, 0x71800000, v9
    v_rcp_f32 v10, v9
    s_nop 0
    s_or_b64 s[84:85], s[84:85], vcc
    v_mul_f32 v10, v10, v7
    s_add_u32 s72, s81, 622592
    v_accvgpr_read_b32 v12, a12
    v_accvgpr_read_b32 v13, a13
    v_accvgpr_read_b32 v14, a14
    v_accvgpr_read_b32 v15, a15
    v_accvgpr_read_b32 v16, a28
    v_accvgpr_read_b32 v17, a29
    v_accvgpr_read_b32 v18, a30
    v_accvgpr_read_b32 v19, a31
    v_pk_mul_f32 v[12:13], v[12:13], v[10:11] op_sel_hi:[1,0]
    v_pk_mul_f32 v[14:15], v[14:15], v[10:11] op_sel_hi:[1,0]
    v_pk_mul_f32 v[16:17], v[16:17], v[10:11] op_sel_hi:[1,0]
    v_pk_mul_f32 v[18:19], v[18:19], v[10:11] op_sel_hi:[1,0]
    v_cvt_pk_bf16_f32 v12, v12, v13
    v_cvt_pk_bf16_f32 v13, v14, v15
    v_cvt_pk_bf16_f32 v14, v16, v17
    v_cvt_pk_bf16_f32 v15, v18, v19
    buffer_store_dwordx4 v[12:15], v1, s[40:43], s72 offen offset:0 sc1
    v_accvgpr_read_b32 v20, a44
    v_accvgpr_read_b32 v21, a45
    v_accvgpr_read_b32 v22, a46
    v_accvgpr_read_b32 v23, a47
    v_accvgpr_read_b32 v24, a60
    v_accvgpr_read_b32 v25, a61
    v_accvgpr_read_b32 v26, a62
    v_accvgpr_read_b32 v27, a63
    v_pk_mul_f32 v[20:21], v[20:21], v[10:11] op_sel_hi:[1,0]
    v_pk_mul_f32 v[22:23], v[22:23], v[10:11] op_sel_hi:[1,0]
    v_pk_mul_f32 v[24:25], v[24:25], v[10:11] op_sel_hi:[1,0]
    v_pk_mul_f32 v[26:27], v[26:27], v[10:11] op_sel_hi:[1,0]
    v_cvt_pk_bf16_f32 v20, v20, v21
    v_cvt_pk_bf16_f32 v21, v22, v23
    v_cvt_pk_bf16_f32 v22, v24, v25
    v_cvt_pk_bf16_f32 v23, v26, v27
    buffer_store_dwordx4 v[20:23], v1, s[40:43], s72 offen offset:1024 sc1
    v_accvgpr_read_b32 v12, a156
    v_accvgpr_read_b32 v13, a157
    v_accvgpr_read_b32 v14, a158
    v_accvgpr_read_b32 v15, a159
    v_accvgpr_read_b32 v16, a172
    v_accvgpr_read_b32 v17, a173
    v_accvgpr_read_b32 v18, a174
    v_accvgpr_read_b32 v19, a175
    v_pk_mul_f32 v[12:13], v[12:13], v[10:11] op_sel_hi:[1,0]
    v_pk_mul_f32 v[14:15], v[14:15], v[10:11] op_sel_hi:[1,0]
    v_pk_mul_f32 v[16:17], v[16:17], v[10:11] op_sel_hi:[1,0]
    v_pk_mul_f32 v[18:19], v[18:19], v[10:11] op_sel_hi:[1,0]
    v_cvt_pk_bf16_f32 v12, v12, v13
    v_cvt_pk_bf16_f32 v13, v14, v15
    v_cvt_pk_bf16_f32 v14, v16, v17
    v_cvt_pk_bf16_f32 v15, v18, v19
    buffer_store_dwordx4 v[12:15], v1, s[40:43], s72 offen offset:2048 sc1
    v_accvgpr_read_b32 v20, a188
    v_accvgpr_read_b32 v21, a189
    v_accvgpr_read_b32 v22, a190
    v_accvgpr_read_b32 v23, a191
    v_accvgpr_read_b32 v24, a204
    v_accvgpr_read_b32 v25, a205
    v_accvgpr_read_b32 v26, a206
    v_accvgpr_read_b32 v27, a207
    v_pk_mul_f32 v[20:21], v[20:21], v[10:11] op_sel_hi:[1,0]
    v_pk_mul_f32 v[22:23], v[22:23], v[10:11] op_sel_hi:[1,0]
    v_pk_mul_f32 v[24:25], v[24:25], v[10:11] op_sel_hi:[1,0]
    v_pk_mul_f32 v[26:27], v[26:27], v[10:11] op_sel_hi:[1,0]
    v_cvt_pk_bf16_f32 v20, v20, v21
    v_cvt_pk_bf16_f32 v21, v22, v23
    v_cvt_pk_bf16_f32 v22, v24, v25
    v_cvt_pk_bf16_f32 v23, v26, v27
    buffer_store_dwordx4 v[20:23], v1, s[40:43], s72 offen offset:3072 sc1
    buffer_load_dword v3, v217, s[32:35], s19 offen sc1
    s_waitcnt lgkmcnt(0)
    s_barrier
    s_sub_u32 s30, s47, s75
    s_sub_u32 s31, s79, s75
    v_bfe_u32 v20, v1, 4, 4
    v_lshrrev_b32 v21, 8, v1
    s_lshl_b32 s98, s4, 4
    s_add_u32 s98, s98, 16
    v_add_u32 v22, s98, v20
    v_mul_u32_u24 v22, 144, v22
    v_add_u32 v22, s30, v22
    v_lshl_add_u32 v9, v21, 3, v22
    s_lshr_b32 s98, s73, 1
    v_add_u32 v8, s98, v9
    v_subrev_u32 v10, s98, v9
    s_sub_u32 s99, s31, s30
    v_add_u32 v24, s99, v8
    v_add_u32 v25, s99, v9
    v_add_u32 v26, s99, v10
    s_bitcmp1_b32 s4, 0
    s_cselect_b32 s99, s31, s30
    v_mul_u32_u24 v23, 144, v20
    v_lshl_add_u32 v23, v21, 3, v23
    v_add_u32 v13, s99, v23
    v_add_u32 v12, s98, v13
    v_accvgpr_read_b32 v32, a64
    v_accvgpr_read_b32 v33, a65
    v_accvgpr_read_b32 v34, a66
    v_accvgpr_read_b32 v35, a67
    v_cvt_pk_bf16_f32 v32, v32, v33
    v_cvt_pk_bf16_f32 v33, v34, v35
    ds_write_b64 v8, v[32:33] offset:0
    v_accvgpr_read_b32 v36, a68
    v_accvgpr_read_b32 v37, a69
    v_accvgpr_read_b32 v38, a70
    v_accvgpr_read_b32 v39, a71
    v_cvt_pk_bf16_f32 v36, v36, v37
    v_cvt_pk_bf16_f32 v37, v38, v39
    ds_write_b64 v8, v[36:37] offset:9216
    v_accvgpr_read_b32 v40, a72
    v_accvgpr_read_b32 v41, a73
    v_accvgpr_read_b32 v42, a74
    v_accvgpr_read_b32 v43, a75
    v_cvt_pk_bf16_f32 v40, v40, v41
    v_cvt_pk_bf16_f32 v41, v42, v43
    ds_write_b64 v24, v[40:41] offset:0
    v_accvgpr_read_b32 v44, a76
    v_accvgpr_read_b32 v45, a77
    v_accvgpr_read_b32 v46, a78
    v_accvgpr_read_b32 v47, a79
    v_cvt_pk_bf16_f32 v44, v44, v45
    v_cvt_pk_bf16_f32 v45, v46, v47
    ds_write_b64 v24, v[44:45] offset:9216
    v_accvgpr_read_b32 v32, a80
    v_accvgpr_read_b32 v33, a81
    v_accvgpr_read_b32 v34, a82
    v_accvgpr_read_b32 v35, a83
    v_cvt_pk_bf16_f32 v32, v32, v33
    v_cvt_pk_bf16_f32 v33, v34, v35
    ds_write_b64 v9, v[32:33] offset:32
    v_accvgpr_read_b32 v36, a84
    v_accvgpr_read_b32 v37, a85
    v_accvgpr_read_b32 v38, a86
    v_accvgpr_read_b32 v39, a87
    v_cvt_pk_bf16_f32 v36, v36, v37
    v_cvt_pk_bf16_f32 v37, v38, v39
    ds_write_b64 v9, v[36:37] offset:9248
    v_accvgpr_read_b32 v40, a88
    v_accvgpr_read_b32 v41, a89
    v_accvgpr_read_b32 v42, a90
    v_accvgpr_read_b32 v43, a91
    v_cvt_pk_bf16_f32 v40, v40, v41
    v_cvt_pk_bf16_f32 v41, v42, v43
    ds_write_b64 v25, v[40:41] offset:32
    v_accvgpr_read_b32 v44, a92
    v_accvgpr_read_b32 v45, a93
    v_accvgpr_read_b32 v46, a94
    v_accvgpr_read_b32 v47, a95
    v_cvt_pk_bf16_f32 v44, v44, v45
    v_cvt_pk_bf16_f32 v45, v46, v47
    ds_write_b64 v25, v[44:45] offset:9248
    v_accvgpr_read_b32 v32, a96
    v_accvgpr_read_b32 v33, a97
    v_accvgpr_read_b32 v34, a98
    v_accvgpr_read_b32 v35, a99
    v_cvt_pk_bf16_f32 v32, v32, v33
    v_cvt_pk_bf16_f32 v33, v34, v35
    ds_write_b64 v10, v[32:33] offset:64
    v_accvgpr_read_b32 v36, a100
    v_accvgpr_read_b32 v37, a101
    v_accvgpr_read_b32 v38, a102
    v_accvgpr_read_b32 v39, a103
    v_cvt_pk_bf16_f32 v36, v36, v37
    v_cvt_pk_bf16_f32 v37, v38, v39
    ds_write_b64 v10, v[36:37] offset:9280
    v_accvgpr_read_b32 v40, a104
    v_accvgpr_read_b32 v41, a105
    v_accvgpr_read_b32 v42, a106
    v_accvgpr_read_b32 v43, a107
    v_cvt_pk_bf16_f32 v40, v40, v41
    v_cvt_pk_bf16_f32 v41, v42, v43
    ds_write_b64 v26, v[40:41] offset:64
    v_accvgpr_read_b32 v44, a108
    v_accvgpr_read_b32 v45, a109
    v_accvgpr_read_b32 v46, a110
    v_accvgpr_read_b32 v47, a111
    v_cvt_pk_bf16_f32 v44, v44, v45
    v_cvt_pk_bf16_f32 v45, v46, v47
    ds_write_b64 v26, v[44:45] offset:9280
    v_mov_b32 v218, 2
    s_cmp_eq_u64 s[84:85], 0
    s_cselect_b32 s7, s74, 1073741824
    s_cmp_lg_u32 s83, 0
    s_cselect_b32 s7, s74, s7
    s_waitcnt vmcnt(1)
    buffer_store_dword v218, v216, s[32:35], s7 offen sc1
    s_xor_b32 s21, s3, 2
    s_lshl2_add_u32 s21, s21, s4
    s_mul_i32 s21, s21, 36864
    s_add_u32 s21, s21, s28
    s_mov_b32 m0, s46
    s_nop 0
    buffer_load_dwordx4 v1, s[56:59], s21 offen sc1 lds
    v_accvgpr_read_b32 v32, a112
    v_accvgpr_read_b32 v33, a113
    v_accvgpr_read_b32 v34, a114
    v_accvgpr_read_b32 v35, a115
    v_cvt_pk_bf16_f32 v32, v32, v33
    v_cvt_pk_bf16_f32 v33, v34, v35
    ds_write_b64 v9, v[32:33] offset:96
    v_accvgpr_read_b32 v36, a116
    v_accvgpr_read_b32 v37, a117
    v_accvgpr_read_b32 v38, a118
    v_accvgpr_read_b32 v39, a119
    v_cvt_pk_bf16_f32 v36, v36, v37
    buffer_load_dwordx4 v1, s[56:59], s21 offen offset:1024 sc1 lds
    v_cvt_pk_bf16_f32 v37, v38, v39
    ds_write_b64 v9, v[36:37] offset:9312
    v_accvgpr_read_b32 v40, a120
    v_accvgpr_read_b32 v41, a121
    v_accvgpr_read_b32 v42, a122
    v_accvgpr_read_b32 v43, a123
    v_cvt_pk_bf16_f32 v40, v40, v41
    v_cvt_pk_bf16_f32 v41, v42, v43
    ds_write_b64 v25, v[40:41] offset:96
    v_accvgpr_read_b32 v44, a124
    v_accvgpr_read_b32 v45, a125
    v_accvgpr_read_b32 v46, a126
    buffer_load_dwordx4 v1, s[56:59], s21 offen offset:2048 sc1 lds
    v_accvgpr_read_b32 v47, a127
    v_cvt_pk_bf16_f32 v44, v44, v45
    v_cvt_pk_bf16_f32 v45, v46, v47
    s_waitcnt lgkmcnt(14)
    ds_write_b64 v25, v[44:45] offset:9312
    v_accvgpr_read_b32 v32, a128
    v_accvgpr_read_b32 v33, a129
    v_accvgpr_read_b32 v34, a130
    v_accvgpr_read_b32 v35, a131
    v_cvt_pk_bf16_f32 v32, v32, v33
    v_cvt_pk_bf16_f32 v33, v34, v35
    s_waitcnt lgkmcnt(14)
    ds_write_b64 v12, v[32:33] offset:0
    v_accvgpr_read_b32 v36, a132
    buffer_load_dwordx4 v1, s[56:59], s21 offen offset:3072 sc1 lds
    v_accvgpr_read_b32 v37, a133
    v_accvgpr_read_b32 v38, a134
    v_accvgpr_read_b32 v39, a135
    v_cvt_pk_bf16_f32 v36, v36, v37
    v_cvt_pk_bf16_f32 v37, v38, v39
    s_cmp_eq_u32 s73, 0
    s_cselect_b64 exec, -1, 0
    s_waitcnt lgkmcnt(14)
    ds_write_b64 v13, v[36:37] offset:32
    s_mov_b64 exec, -1
    s_cmp_lg_u64 s[84:85], 0
    s_cselect_b32 s7, 1, 0
    v_mov_b32 v20, s7
    s_lshl2_add_u32 s98, s4, s30
    s_add_u32 s21, s21, 4096
    s_add_u32 m0, s46, 4096
    s_nop 0
    buffer_load_dwordx4 v1, s[56:59], s21 offen sc1 lds
    v_mov_b32 v21, s98
    s_waitcnt lgkmcnt(14)
    ds_write_b32 v21, v20 offset:20736
    v_mov_b32 v21, s30
    s_and_b32 s98, s4, 1
    s_lshl_b32 s98, s98, 6
    v_lshrrev_b32 v14, 4, v1
    v_add_u32 v14, s98, v14
    s_sub_u32 s7, 15, s6
    s_cmp_lt_u32 s4, 2
    s_cselect_b32 s7, s6, s7
    s_cselect_b32 s99, s30, s31
    s_lshl_b32 s7, s7, 7
    buffer_load_dwordx4 v1, s[56:59], s21 offen offset:1024 sc1 lds
    v_add_u32 v2, 2, v14
    v_mul_u32_u24 v2, 144, v2
    v_add_u32 v2, s99, v2
    v_add_u32 v14, s7, v14
    v_lshrrev_b32 v15, 4, v14
    s_mov_b32 s98, 155648
    v_mul_lo_u32 v15, v15, s98
    v_and_b32 v23, 0xf0, v1
    v_add_u32 v15, v15, v23
    s_lshl3_add_u32 s98, s6, s62
    s_mul_i32 s98, s98, 155648
    v_add_u32 v4, s98, v1
    buffer_load_dwordx4 v1, s[56:59], s21 offen offset:2048 sc1 lds
    s_sub_u32 s98, 15, s6
    s_lshl3_add_u32 s98, s98, s62
    s_mul_i32 s98, s98, 155648
    v_add_u32 v5, s98, v1
    v_mov_b32 v19, v217
    v_subrev_u32 v23, s75, v1
    v_add_u32 v11, s44, v23
    v_add_u32 v12, s45, v23
    v_add_u32 v13, s46, v23
    v_add_u32 v6, s47, v23
    v_add_u32 v7, s79, v23
    s_mov_b32 s98, 0xbfb8aa3b
    s_mov_b32 s99, 0x3eae1a93
    s_waitcnt vmcnt(8) lgkmcnt(0)
    s_barrier
    ds_read_b128 v[24:27], v21 offset:20736
    ds_read_b128 v[32:35], v2 offset:2016
    ds_read_b128 v[36:39], v2 offset:2032
    ds_read_b128 v[40:43], v2 offset:2048
    ds_read_b128 v[44:47], v2 offset:1728
    ds_read_b128 v[48:51], v2 offset:1744
    ds_read_b128 v[52:55], v2 offset:1760
    s_waitcnt lgkmcnt(6)
    v_or3_b32 v24, v24, v25, v26
    v_or_b32 v24, v24, v27
    s_nop 0
    v_readfirstlane_b32 s7, v24
    s_nop 1
    s_andn2_b32 s7, s7, s83
    s_cbranch_scc1 K1_REDO
    buffer_load_dword v28, v29, s[32:35], s92 offen sc1
    v_cmp_gt_u32 vcc, 1, v3
    s_nop 1
    s_and_b64 vcc, vcc, exec
    s_cbranch_scc1 SPIN_SHORT
BACK_SHORT:
    buffer_load_dwordx4 a[0:3], v4, s[40:43], s63 offen offset:0 sc1
    ds_read_b128 v[128:131], v2 offset:2096
    ds_read_b128 v[132:135], v2 offset:2112
    ds_read_b128 v[136:139], v2 offset:2128
    ds_read_b128 v[56:59], v2 offset:1440
    ds_read_b128 v[60:63], v2 offset:1456
    ds_read_b128 v[64:67], v2 offset:1472
    ds_read_b128 v[68:71], v2 offset:1152
    ds_read_b128 v[72:75], v2 offset:1168
    ds_read_b128 v[76:79], v2 offset:1184
    s_waitcnt lgkmcnt(8)
    v_dot2_f32_bf16 v140, v128, v32, 0
    v_dot2_f32_bf16 v141, v128, v44, 0
    buffer_load_dwordx4 a[8:11], v4, s[40:43], s63 offen offset:1024 sc1
    ds_read_b128 v[80:83], v2 offset:864
    s_waitcnt lgkmcnt(6)
    v_dot2_f32_bf16 v142, v128, v56, 0
    s_waitcnt lgkmcnt(3)
    v_dot2_f32_bf16 v143, v128, v68, 0
    ds_read_b128 v[84:87], v2 offset:880
    v_dot2c_f32_bf16 v140, v129, v33
    v_dot2c_f32_bf16 v141, v129, v45
    ds_read_b128 v[88:91], v2 offset:896
    v_dot2c_f32_bf16 v142, v129, v57
    v_dot2c_f32_bf16 v143, v129, v69
    ds_read_b128 v[92:95], v2 offset:576
    v_dot2c_f32_bf16 v140, v130, v34
    v_dot2c_f32_bf16 v141, v130, v46
    buffer_load_dwordx4 a[16:19], v4, s[40:43], s63 offen offset:2048 sc1
    ds_read_b128 v[96:99], v2 offset:592
    v_dot2c_f32_bf16 v142, v130, v58
    v_dot2c_f32_bf16 v143, v130, v70
    ds_read_b128 v[100:103], v2 offset:608
    v_dot2c_f32_bf16 v140, v131, v35
    v_dot2c_f32_bf16 v141, v131, v47
    ds_read_b128 v[104:107], v2 offset:288
    v_dot2c_f32_bf16 v142, v131, v59
    v_dot2c_f32_bf16 v143, v131, v71
    ds_read_b128 v[108:111], v2 offset:304
    v_dot2c_f32_bf16 v140, v132, v36
    v_dot2c_f32_bf16 v141, v132, v48
    buffer_load_dwordx4 a[24:27], v4, s[40:43], s63 offen offset:3072 sc1
    ds_read_b128 v[112:115], v2 offset:320
    v_dot2c_f32_bf16 v142, v132, v60
    s_waitcnt lgkmcnt(10)
    v_dot2c_f32_bf16 v143, v132, v72
    ds_read_b128 v[116:119], v2 offset:0
    v_dot2c_f32_bf16 v140, v133, v37
    v_dot2c_f32_bf16 v141, v133, v49
    ds_read_b128 v[120:123], v2 offset:16
    v_dot2c_f32_bf16 v142, v133, v61
    v_dot2c_f32_bf16 v143, v133, v73
    ds_read_b128 v[124:127], v2 offset:32
    v_dot2c_f32_bf16 v140, v134, v38
    v_dot2c_f32_bf16 v141, v134, v50
    s_xor_b32 s63, s63, 4096
    buffer_load_dwordx4 a[32:35], v4, s[40:43], s63 offen offset:0 sc1
    v_dot2c_f32_bf16 v142, v134, v62
    v_dot2c_f32_bf16 v143, v134, v74
    v_dot2c_f32_bf16 v140, v135, v39
    v_dot2c_f32_bf16 v141, v135, v51
    v_dot2c_f32_bf16 v142, v135, v63
    v_dot2c_f32_bf16 v143, v135, v75
    v_dot2c_f32_bf16 v140, v136, v40
    v_dot2c_f32_bf16 v141, v136, v52
    v_dot2c_f32_bf16 v142, v136, v64
    s_waitcnt lgkmcnt(12)
    v_dot2c_f32_bf16 v143, v136, v76
    s_waitcnt lgkmcnt(11)
    v_dot2_f32_bf16 v144, v128, v80, 0
    buffer_load_dwordx4 a[40:43], v4, s[40:43], s63 offen offset:1024 sc1
    s_waitcnt lgkmcnt(8)
    v_dot2_f32_bf16 v145, v128, v92, 0
    ds_read_b128 v[32:35], v2 offset:2064
    s_waitcnt lgkmcnt(6)
    v_dot2_f32_bf16 v146, v128, v104, 0
    s_waitcnt lgkmcnt(3)
    v_dot2_f32_bf16 v147, v128, v116, 0
    ds_read_b128 v[36:39], v2 offset:2080
    v_dot2c_f32_bf16 v144, v129, v81
    v_dot2c_f32_bf16 v145, v129, v93
    ds_read_b128 v[44:47], v2 offset:1776
    v_dot2c_f32_bf16 v146, v129, v105
    v_dot2c_f32_bf16 v147, v129, v117
    ds_read_b128 v[48:51], v2 offset:1792
    v_dot2c_f32_bf16 v144, v130, v82
    buffer_load_dwordx4 a[48:51], v4, s[40:43], s63 offen offset:2048 sc1
    v_dot2c_f32_bf16 v145, v130, v94
    ds_read_b128 v[56:59], v2 offset:1488
    v_dot2c_f32_bf16 v146, v130, v106
    v_dot2c_f32_bf16 v147, v130, v118
    ds_read_b128 v[60:63], v2 offset:1504
    v_dot2c_f32_bf16 v144, v131, v83
    v_dot2c_f32_bf16 v145, v131, v95
    ds_read_b128 v[68:71], v2 offset:1200
    v_dot2c_f32_bf16 v146, v131, v107
    v_dot2c_f32_bf16 v147, v131, v119
    ds_read_b128 v[72:75], v2 offset:1216
    v_dot2c_f32_bf16 v144, v132, v84
    buffer_load_dwordx4 a[56:59], v4, s[40:43], s63 offen offset:3072 sc1
    v_dot2c_f32_bf16 v145, v132, v96
    v_dot2c_f32_bf16 v146, v132, v108
    s_waitcnt lgkmcnt(9)
    v_dot2c_f32_bf16 v147, v132, v120
    v_dot2c_f32_bf16 v144, v133, v85
    v_dot2c_f32_bf16 v145, v133, v97
    v_dot2c_f32_bf16 v146, v133, v109
    v_dot2c_f32_bf16 v147, v133, v121
    v_dot2c_f32_bf16 v144, v134, v86
    v_dot2c_f32_bf16 v145, v134, v98
    v_dot2c_f32_bf16 v146, v134, v110
    v_dot2c_f32_bf16 v147, v134, v122
    v_dot2c_f32_bf16 v144, v135, v87
    s_xor_b32 s63, s63, 12288
    buffer_load_dwordx4 a[64:67], v4, s[40:43], s63 offen offset:0 sc1
    v_dot2c_f32_bf16 v145, v135, v99
    v_dot2c_f32_bf16 v146, v135, v111
    v_dot2c_f32_bf16 v147, v135, v123
    v_dot2c_f32_bf16 v144, v136, v88
    v_dot2c_f32_bf16 v145, v136, v100
    v_dot2c_f32_bf16 v146, v136, v112
    s_waitcnt lgkmcnt(8)
    v_dot2c_f32_bf16 v147, v136, v124
    v_lshlrev_b32 v8, 16, v138
    v_mul_f32 v8, s98, v8
    v_exp_f32 v8, v8
    v_mov_b32 v9, 0xf149f2ca
    buffer_load_dwordx4 a[72:75], v4, s[40:43], s63 offen offset:1024 sc1
    ds_read_b128 v[80:83], v2 offset:912
    v_cmp_le_u32 vcc, 2, v14
    ds_read_b128 v[84:87], v2 offset:928
    s_nop 0
    v_cndmask_b32 v141, v9, v141, vcc
    v_cmp_le_u32 vcc, 4, v14
    ds_read_b128 v[92:95], v2 offset:624
    s_nop 0
    v_cndmask_b32 v142, v9, v142, vcc
    v_cmp_le_u32 vcc, 6, v14
    ds_read_b128 v[96:99], v2 offset:640
    s_nop 0
    v_cndmask_b32 v143, v9, v143, vcc
    v_cmp_le_u32 vcc, 8, v14
    ds_read_b128 v[104:107], v2 offset:336
    buffer_load_dwordx4 a[80:83], v4, s[40:43], s63 offen offset:2048 sc1
    v_cndmask_b32 v144, v9, v144, vcc
    v_cmp_le_u32 vcc, 10, v14
    ds_read_b128 v[108:111], v2 offset:352
    s_nop 0
    v_cndmask_b32 v145, v9, v145, vcc
    v_cmp_le_u32 vcc, 12, v14
    ds_read_b128 v[116:119], v2 offset:48
    s_nop 0
    v_cndmask_b32 v146, v9, v146, vcc
    v_cmp_le_u32 vcc, 14, v14
    s_waitcnt lgkmcnt(14)
    ds_read_b128 v[120:123], v2 offset:64
    s_nop 0
    v_cndmask_b32 v147, v9, v147, vcc
    v_max3_f32 v9, v140, v141, v142
    v_max3_f32 v10, v143, v144, v145
    buffer_load_dwordx4 a[88:91], v4, s[40:43], s63 offen offset:3072 sc1
    s_xor_b32 s63, s63, 4096
    v_max3_f32 v9, v9, v146, v147
    v_max_f32 v9, v9, v10
    v_mul_f32 v9, s99, v9
    v_add_f32 v8, 1.0, v8
    v_fma_f32 v140, v140, s99, -v9
    v_fma_f32 v141, v141, s99, -v9
    v_fma_f32 v142, v142, s99, -v9
    v_fma_f32 v143, v143, s99, -v9
    v_fma_f32 v144, v144, s99, -v9
    v_fma_f32 v145, v145, s99, -v9
    v_fma_f32 v146, v146, s99, -v9
    v_fma_f32 v147, v147, s99, -v9
    buffer_load_dword v3, v217, s[32:35], s19 offen sc1
    buffer_load_dwordx4 a[96:99], v4, s[40:43], s63 offen offset:0 sc1
    v_exp_f32 v140, v140
    v_exp_f32 v141, v141
    v_exp_f32 v142, v142
    v_exp_f32 v143, v143
    v_exp_f32 v144, v144
    v_exp_f32 v145, v145
    v_exp_f32 v146, v146
    buffer_load_dwordx4 a[104:107], v4, s[40:43], s63 offen offset:1024 sc1
    v_exp_f32 v147, v147
    v_add_f32 v10, v140, v141
    v_add_f32 v10, v10, v142
    v_add_f32 v10, v10, v143
    v_add_f32 v10, v10, v144
    v_add_f32 v10, v10, v145
    v_add_f32 v10, v10, v146
    buffer_load_dwordx4 a[112:115], v4, s[40:43], s63 offen offset:2048 sc1
    v_add_f32 v10, v10, v147
    v_mul_f32 v10, v10, v8
    v_rcp_f32 v10, v10
    s_nop 0
    v_mul_f32 v140, v140, v10
    v_mul_f32 v141, v141, v10
    v_mul_f32 v142, v142, v10
    v_mul_f32 v143, v143, v10
    v_mul_f32 v144, v144, v10
    buffer_load_dwordx4 a[120:123], v4, s[40:43], s63 offen offset:3072 sc1
    v_mul_f32 v145, v145, v10
    v_mul_f32 v146, v146, v10
    v_mul_f32 v147, v147, v10
    v_cvt_pk_bf16_f32 v148, 0, v140
    v_cvt_pk_bf16_f32 v149, 0, v141
    v_cvt_pk_bf16_f32 v150, 0, v142
    v_cvt_pk_bf16_f32 v151, 0, v143
    s_xor_b32 s63, s63, 28672
    buffer_load_dwordx4 a[128:131], v4, s[40:43], s63 offen offset:0 sc1
    v_cvt_pk_bf16_f32 v152, 0, v144
    v_cvt_pk_bf16_f32 v153, 0, v145
    v_cvt_pk_bf16_f32 v154, 0, v146
    v_cvt_pk_bf16_f32 v155, 0, v147
    v_lshrrev_b32 v140, 16, v148
    v_lshrrev_b32 v141, 16, v149
    v_lshrrev_b32 v142, 16, v150
    buffer_load_dwordx4 a[136:139], v4, s[40:43], s63 offen offset:1024 sc1
    v_lshrrev_b32 v143, 16, v151
    v_lshrrev_b32 v144, 16, v152
    v_lshrrev_b32 v145, 16, v153
    v_lshrrev_b32 v146, 16, v154
    v_lshrrev_b32 v147, 16, v155
    v_dot2_f32_bf16 v128, v42, v140, 0
    v_dot2_f32_bf16 v129, v42, v148, 0
    v_dot2_f32_bf16 v130, v43, v140, 0
    buffer_load_dwordx4 a[144:147], v4, s[40:43], s63 offen offset:2048 sc1
    v_dot2_f32_bf16 v131, v43, v148, 0
    v_dot2_f32_bf16 v132, v32, v140, 0
    v_dot2_f32_bf16 v133, v32, v148, 0
    v_dot2_f32_bf16 v134, v33, v140, 0
    v_dot2_f32_bf16 v135, v33, v148, 0
    v_dot2_f32_bf16 v136, v34, v140, 0
    v_dot2_f32_bf16 v137, v34, v148, 0
    buffer_load_dwordx4 a[152:155], v4, s[40:43], s63 offen offset:3072 sc1
    s_xor_b32 s63, s63, 4096
    v_dot2_f32_bf16 v138, v35, v140, 0
    v_dot2_f32_bf16 v139, v35, v148, 0
    s_waitcnt lgkmcnt(14)
    v_dot2_f32_bf16 v156, v36, v140, 0
    v_dot2_f32_bf16 v157, v36, v148, 0
    v_dot2_f32_bf16 v158, v37, v140, 0
    v_dot2_f32_bf16 v159, v37, v148, 0
    v_dot2_f32_bf16 v17, v38, v140, 0
    v_dot2_f32_bf16 v18, v38, v148, 0
    s_waitcnt vmcnt(8)
    v_cmp_gt_u32 vcc, 2, v3
    s_nop 1
    s_and_b64 vcc, vcc, exec
    s_cbranch_scc1 SPIN_CTX
BACK_CTX:
    buffer_load_dwordx4 a[4:7], v5, s[40:43], s20 offen offset:0 sc1
    v_dot2c_f32_bf16 v128, v54, v141
    v_dot2c_f32_bf16 v129, v54, v149
    v_dot2c_f32_bf16 v130, v55, v141
    v_dot2c_f32_bf16 v131, v55, v149
    s_waitcnt lgkmcnt(13)
    v_dot2c_f32_bf16 v132, v44, v141
    v_dot2c_f32_bf16 v133, v44, v149
    v_dot2c_f32_bf16 v134, v45, v141
    v_dot2c_f32_bf16 v135, v45, v149
    v_dot2c_f32_bf16 v136, v46, v141
    v_dot2c_f32_bf16 v137, v46, v149
    v_dot2c_f32_bf16 v138, v47, v141
    v_dot2c_f32_bf16 v139, v47, v149
    s_waitcnt lgkmcnt(12)
    v_dot2c_f32_bf16 v156, v48, v141
    buffer_load_dwordx4 a[12:15], v5, s[40:43], s20 offen offset:1024 sc1
    v_dot2c_f32_bf16 v157, v48, v149
    v_dot2c_f32_bf16 v158, v49, v141
    v_dot2c_f32_bf16 v159, v49, v149
    v_dot2c_f32_bf16 v17, v50, v141
    v_dot2c_f32_bf16 v18, v50, v149
    v_dot2c_f32_bf16 v128, v66, v142
    v_dot2c_f32_bf16 v129, v66, v150
    v_dot2c_f32_bf16 v130, v67, v142
    v_dot2c_f32_bf16 v131, v67, v150
    s_waitcnt lgkmcnt(11)
    v_dot2c_f32_bf16 v132, v56, v142
    v_dot2c_f32_bf16 v133, v56, v150
    v_dot2c_f32_bf16 v134, v57, v142
    v_dot2c_f32_bf16 v135, v57, v150
    v_dot2c_f32_bf16 v136, v58, v142
    buffer_load_dwordx4 a[20:23], v5, s[40:43], s20 offen offset:2048 sc1
    v_dot2c_f32_bf16 v137, v58, v150
    v_dot2c_f32_bf16 v138, v59, v142
    v_dot2c_f32_bf16 v139, v59, v150
    s_waitcnt lgkmcnt(10)
    v_dot2c_f32_bf16 v156, v60, v142
    v_dot2c_f32_bf16 v157, v60, v150
    v_dot2c_f32_bf16 v158, v61, v142
    v_dot2c_f32_bf16 v159, v61, v150
    v_dot2c_f32_bf16 v17, v62, v142
    v_dot2c_f32_bf16 v18, v62, v150
    v_dot2c_f32_bf16 v128, v78, v143
    v_dot2c_f32_bf16 v129, v78, v151
    v_dot2c_f32_bf16 v130, v79, v143
    v_dot2c_f32_bf16 v131, v79, v151
    s_waitcnt lgkmcnt(9)
    v_dot2c_f32_bf16 v132, v68, v143
    buffer_load_dwordx4 a[28:31], v5, s[40:43], s20 offen offset:3072 sc1
    v_dot2c_f32_bf16 v133, v68, v151
    v_dot2c_f32_bf16 v134, v69, v143
    v_dot2c_f32_bf16 v135, v69, v151
    v_dot2c_f32_bf16 v136, v70, v143
    v_dot2c_f32_bf16 v137, v70, v151
    v_dot2c_f32_bf16 v138, v71, v143
    v_dot2c_f32_bf16 v139, v71, v151
    s_waitcnt lgkmcnt(8)
    v_dot2c_f32_bf16 v156, v72, v143
    v_dot2c_f32_bf16 v157, v72, v151
    v_dot2c_f32_bf16 v158, v73, v143
    v_dot2c_f32_bf16 v159, v73, v151
    v_dot2c_f32_bf16 v17, v74, v143
    v_dot2c_f32_bf16 v18, v74, v151
    v_dot2c_f32_bf16 v128, v90, v144
    s_xor_b32 s20, s20, 4096
    buffer_load_dwordx4 a[36:39], v5, s[40:43], s20 offen offset:0 sc1
    v_dot2c_f32_bf16 v129, v90, v152
    v_dot2c_f32_bf16 v130, v91, v144
    v_dot2c_f32_bf16 v131, v91, v152
    s_waitcnt lgkmcnt(7)
    v_dot2c_f32_bf16 v132, v80, v144
    v_dot2c_f32_bf16 v133, v80, v152
    v_dot2c_f32_bf16 v134, v81, v144
    v_dot2c_f32_bf16 v135, v81, v152
    v_dot2c_f32_bf16 v136, v82, v144
    v_dot2c_f32_bf16 v137, v82, v152
    v_dot2c_f32_bf16 v138, v83, v144
    v_dot2c_f32_bf16 v139, v83, v152
    s_waitcnt lgkmcnt(6)
    v_dot2c_f32_bf16 v156, v84, v144
    v_dot2c_f32_bf16 v157, v84, v152
    buffer_load_dwordx4 a[44:47], v5, s[40:43], s20 offen offset:1024 sc1
    v_dot2c_f32_bf16 v158, v85, v144
    v_dot2c_f32_bf16 v159, v85, v152
    v_dot2c_f32_bf16 v17, v86, v144
    v_dot2c_f32_bf16 v18, v86, v152
    v_dot2c_f32_bf16 v128, v102, v145
    v_dot2c_f32_bf16 v129, v102, v153
    v_dot2c_f32_bf16 v130, v103, v145
    v_dot2c_f32_bf16 v131, v103, v153
    s_waitcnt lgkmcnt(5)
    v_dot2c_f32_bf16 v132, v92, v145
    v_dot2c_f32_bf16 v133, v92, v153
    v_dot2c_f32_bf16 v134, v93, v145
    v_dot2c_f32_bf16 v135, v93, v153
    v_dot2c_f32_bf16 v136, v94, v145
    v_dot2c_f32_bf16 v137, v94, v153
    buffer_load_dwordx4 a[52:55], v5, s[40:43], s20 offen offset:2048 sc1
    v_dot2c_f32_bf16 v138, v95, v145
    v_dot2c_f32_bf16 v139, v95, v153
    s_waitcnt lgkmcnt(4)
    v_dot2c_f32_bf16 v156, v96, v145
    v_dot2c_f32_bf16 v157, v96, v153
    v_dot2c_f32_bf16 v158, v97, v145
    v_dot2c_f32_bf16 v159, v97, v153
    v_dot2c_f32_bf16 v17, v98, v145
    v_dot2c_f32_bf16 v18, v98, v153
    v_dot2c_f32_bf16 v128, v114, v146
    v_dot2c_f32_bf16 v129, v114, v154
    v_dot2c_f32_bf16 v130, v115, v146
    v_dot2c_f32_bf16 v131, v115, v154
    s_waitcnt lgkmcnt(3)
    v_dot2c_f32_bf16 v132, v104, v146
    v_dot2c_f32_bf16 v133, v104, v154
    buffer_load_dwordx4 a[60:63], v5, s[40:43], s20 offen offset:3072 sc1
    s_xor_b32 s20, s20, 12288
    v_dot2c_f32_bf16 v134, v105, v146
    v_dot2c_f32_bf16 v135, v105, v154
    v_dot2c_f32_bf16 v136, v106, v146
    v_dot2c_f32_bf16 v137, v106, v154
    v_dot2c_f32_bf16 v138, v107, v146
    v_dot2c_f32_bf16 v139, v107, v154
    s_waitcnt lgkmcnt(2)
    v_dot2c_f32_bf16 v156, v108, v146
    v_dot2c_f32_bf16 v157, v108, v154
    v_dot2c_f32_bf16 v158, v109, v146
    v_dot2c_f32_bf16 v159, v109, v154
    v_dot2c_f32_bf16 v17, v110, v146
    v_dot2c_f32_bf16 v18, v110, v154
    v_dot2c_f32_bf16 v128, v126, v147
    v_dot2c_f32_bf16 v129, v126, v155
    v_dot2c_f32_bf16 v130, v127, v147
    v_dot2c_f32_bf16 v131, v127, v155
    s_waitcnt lgkmcnt(1)
    v_dot2c_f32_bf16 v132, v116, v147
    v_dot2c_f32_bf16 v133, v116, v155
    v_dot2c_f32_bf16 v134, v117, v147
    v_dot2c_f32_bf16 v135, v117, v155
    v_dot2c_f32_bf16 v136, v118, v147
    v_dot2c_f32_bf16 v137, v118, v155
    v_dot2c_f32_bf16 v138, v119, v147
    v_dot2c_f32_bf16 v139, v119, v155
    s_waitcnt lgkmcnt(0)
    v_dot2c_f32_bf16 v156, v120, v147
    v_dot2c_f32_bf16 v157, v120, v155
    v_dot2c_f32_bf16 v158, v121, v147
    v_dot2c_f32_bf16 v159, v121, v155
    v_dot2c_f32_bf16 v17, v122, v147
    v_dot2c_f32_bf16 v18, v122, v155
    v_mov_b32 v89, 0
    v_mov_b32 v90, 0
    v_mov_b32 v91, 0
    v_cvt_pk_bf16_f32 v80, v128, v129
    v_cvt_pk_bf16_f32 v81, v130, v131
    v_cvt_pk_bf16_f32 v82, v132, v133
    v_cvt_pk_bf16_f32 v83, v134, v135
    v_cvt_pk_bf16_f32 v84, v136, v137
    v_cvt_pk_bf16_f32 v85, v138, v139
    v_cvt_pk_bf16_f32 v86, v156, v157
    v_cvt_pk_bf16_f32 v87, v158, v159
    v_cvt_pk_bf16_f32 v88, v17, v18
    v_cmp_gt_u32 vcc, 1, v28
    s_nop 1
    s_and_b64 vcc, vcc, exec
    s_cbranch_scc1 SPIN_ALL
BACK_ALL:
    s_waitcnt vmcnt(4)
    s_barrier
    ds_read_b128 v[104:107], v11 offset:0
    ds_read_b128 v[108:111], v11 offset:8192
    ds_read_b128 v[112:115], v11 offset:1024
    ds_read_b128 v[116:119], v11 offset:9216
    s_waitcnt lgkmcnt(3)
    v_mfma_f32_16x16x32_bf16 v[176:179], v[104:107], a[0:3], 0
    s_lshl3_add_u32 s98, 1, s5
    ds_read_b128 v[120:123], v11 offset:2048
    ds_read_b128 v[124:127], v11 offset:10240
    s_waitcnt lgkmcnt(4)
    v_mfma_f32_16x16x32_bf16 v[176:179], v[108:111], a[8:11], v[176:179]
    s_and_b32 s98, s98, 31
    buffer_load_dwordx4 a[68:71], v5, s[40:43], s20 offen offset:0 sc1
    v_mfma_f32_16x16x32_bf16 v[180:183], v[104:107], a[4:7], 0
    s_lshl_b32 s8, s6, 5
    ds_read_b128 v[128:131], v11 offset:3072
    ds_read_b128 v[132:135], v11 offset:11264
    v_mfma_f32_16x16x32_bf16 v[180:183], v[108:111], a[12:15], v[180:183]
    s_add_u32 s98, s98, s8
    ds_read_b128 v[136:139], v11 offset:4096
    s_waitcnt lgkmcnt(6)
    v_mfma_f32_16x16x32_bf16 v[184:187], v[112:115], a[0:3], 0
    s_mul_i32 s98, s98, 3
    buffer_load_dwordx4 a[76:79], v5, s[40:43], s20 offen offset:1024 sc1
    s_waitcnt lgkmcnt(5)
    v_mfma_f32_16x16x32_bf16 v[184:187], v[116:119], a[8:11], v[184:187]
    s_sub_u32 s98, s98, 1
    ds_read_b128 v[140:143], v11 offset:12288
    ds_read_b128 v[144:147], v11 offset:5120
    v_mfma_f32_16x16x32_bf16 v[188:191], v[112:115], a[4:7], 0
    s_add_u32 s98, s98, 3
    ds_read_b128 v[148:151], v11 offset:13312
    v_mfma_f32_16x16x32_bf16 v[188:191], v[116:119], a[12:15], v[188:191]
    s_lshl2_add_u32 s98, s98, s4
    ds_read_b128 v[104:107], v11 offset:6144
    s_waitcnt lgkmcnt(5)
    v_mfma_f32_16x16x32_bf16 v[192:195], v[120:123], a[0:3], 0
    s_mul_i32 s8, s98, 3072
    buffer_load_dwordx4 a[84:87], v5, s[40:43], s20 offen offset:2048 sc1
    v_mfma_f32_16x16x32_bf16 v[192:195], v[124:127], a[8:11], v[192:195]
    s_lshl3_add_u32 s98, 2, s5
    ds_read_b128 v[108:111], v11 offset:14336
    ds_read_b128 v[112:115], v11 offset:16384
    v_mfma_f32_16x16x32_bf16 v[196:199], v[120:123], a[4:7], 0
    s_and_b32 s98, s98, 31
    ds_read_b128 v[116:119], v11 offset:24576
    v_mfma_f32_16x16x32_bf16 v[196:199], v[124:127], a[12:15], v[196:199]
    s_lshl_b32 s9, s6, 5
    ds_read_b128 v[120:123], v11 offset:17408
    v_mfma_f32_16x16x32_bf16 v[200:203], v[128:131], a[0:3], 0
    s_add_u32 s98, s98, s9
    buffer_load_dwordx4 a[92:95], v5, s[40:43], s20 offen offset:3072 sc1
    v_mfma_f32_16x16x32_bf16 v[200:203], v[132:135], a[8:11], v[200:203]
    s_xor_b32 s20, s20, 4096
    ds_read_b128 v[124:127], v11 offset:25600
    v_mfma_f32_16x16x32_bf16 v[204:207], v[128:131], a[4:7], 0
    s_mul_i32 s98, s98, 3
    ds_read_b128 v[128:131], v11 offset:18432
    v_mfma_f32_16x16x32_bf16 v[204:207], v[132:135], a[12:15], v[204:207]
    s_sub_u32 s98, s98, 2
    ds_read_b128 v[132:135], v11 offset:26624
    s_waitcnt lgkmcnt(4)
    v_mfma_f32_16x16x32_bf16 v[208:211], v[136:139], a[0:3], 0
    s_add_u32 s98, s98, 3
    buffer_store_dwordx4 v[80:83], v15, s[40:43], s71 offen offset:0 sc1
    v_mfma_f32_16x16x32_bf16 v[208:211], v[140:143], a[8:11], v[208:211]
    s_lshl2_add_u32 s98, s98, s4
    v_mfma_f32_16x16x32_bf16 v[212:215], v[136:139], a[4:7], 0
    s_mul_i32 s9, s98, 3072
    ds_read_b128 v[136:139], v11 offset:19456
    v_mfma_f32_16x16x32_bf16 v[212:215], v[140:143], a[12:15], v[212:215]
    s_lshl3_add_u32 s98, 3, s5
    ds_read_b128 v[140:143], v11 offset:27648
    v_mfma_f32_16x16x32_bf16 v[216:219], v[144:147], a[0:3], 0
    s_and_b32 s98, s98, 31
    v_mfma_f32_16x16x32_bf16 v[216:219], v[148:151], a[8:11], v[216:219]
    s_lshl_b32 s10, s6, 5
    buffer_store_dwordx4 v[84:87], v15, s[40:43], s71 offen offset:256 sc1
    v_mfma_f32_16x16x32_bf16 v[220:223], v[144:147], a[4:7], 0
    s_add_u32 s98, s98, s10
    ds_read_b128 v[144:147], v11 offset:20480
    v_mfma_f32_16x16x32_bf16 v[220:223], v[148:151], a[12:15], v[220:223]
    s_mul_i32 s98, s98, 3
    ds_read_b128 v[148:151], v11 offset:28672
    v_mfma_f32_16x16x32_bf16 v[224:227], v[104:107], a[0:3], 0
    s_sub_u32 s98, s98, 3
    v_mfma_f32_16x16x32_bf16 v[224:227], v[108:111], a[8:11], v[224:227]
    s_add_u32 s98, s98, 3
    buffer_store_dwordx4 v[88:91], v15, s[40:43], s71 offen offset:512 sc1
    v_mfma_f32_16x16x32_bf16 v[228:231], v[104:107], a[4:7], 0
    s_xor_b32 s21, s3, 3
    ds_read_b128 v[104:107], v11 offset:21504
    v_mfma_f32_16x16x32_bf16 v[228:231], v[108:111], a[12:15], v[228:231]
    s_lshl2_add_u32 s21, s21, s4
    ds_read_b128 v[108:111], v11 offset:29696
    v_mfma_f32_16x16x32_bf16 v[176:179], v[112:115], a[16:19], v[176:179]
    s_mul_i32 s21, s21, 36864
    v_mfma_f32_16x16x32_bf16 v[176:179], v[116:119], a[24:27], v[176:179]
    s_add_u32 s21, s21, s28
    s_mov_b32 m0, s47
    v_mfma_f32_16x16x32_bf16 v[180:183], v[112:115], a[20:23], v[180:183]
    s_lshl2_add_u32 s98, s98, s4
    buffer_load_dwordx4 v1, s[56:59], s21 offen sc1 lds
    v_mfma_f32_16x16x32_bf16 v[180:183], v[116:119], a[28:31], v[180:183]
    s_mul_i32 s10, s98, 3072
    ds_read_b128 v[112:115], v11 offset:22528
    ds_read_b128 v[116:119], v11 offset:30720
    s_waitcnt lgkmcnt(3)
    v_mfma_f32_16x16x32_bf16 v[184:187], v[120:123], a[16:19], v[184:187]
    s_sub_u32 s99, s4, s61
    v_mfma_f32_16x16x32_bf16 v[184:187], v[124:127], a[24:27], v[184:187]
    s_and_b32 s99, s99, 3
    buffer_load_dwordx4 v1, s[56:59], s21 offen offset:1024 sc1 lds
    v_mfma_f32_16x16x32_bf16 v[188:191], v[120:123], a[20:23], v[188:191]
    s_lshl3_add_u32 s98, s99, s5
    ds_read_b128 v[120:123], v12 offset:0
    v_mfma_f32_16x16x32_bf16 v[188:191], v[124:127], a[28:31], v[188:191]
    s_and_b32 s98, s98, 31
    ds_read_b128 v[124:127], v12 offset:8192
    v_mfma_f32_16x16x32_bf16 v[192:195], v[128:131], a[16:19], v[192:195]
    s_lshl_b32 s11, s6, 5
    v_mfma_f32_16x16x32_bf16 v[192:195], v[132:135], a[24:27], v[192:195]
    s_add_u32 s98, s98, s11
    buffer_load_dwordx4 v1, s[56:59], s21 offen offset:2048 sc1 lds
    v_mfma_f32_16x16x32_bf16 v[196:199], v[128:131], a[20:23], v[196:199]
    s_mul_i32 s98, s98, 3
    ds_read_b128 v[128:131], v12 offset:1024
    v_mfma_f32_16x16x32_bf16 v[196:199], v[132:135], a[28:31], v[196:199]
    s_sub_u32 s98, s98, s99
    ds_read_b128 v[132:135], v12 offset:9216
    v_mfma_f32_16x16x32_bf16 v[200:203], v[136:139], a[16:19], v[200:203]
    s_add_u32 s98, s98, 3
    v_mfma_f32_16x16x32_bf16 v[200:203], v[140:143], a[24:27], v[200:203]
    s_lshl2_add_u32 s98, s98, s4
    v_mfma_f32_16x16x32_bf16 v[204:207], v[136:139], a[20:23], v[204:207]
    s_mul_i32 s11, s98, 3072
    buffer_load_dwordx4 v1, s[56:59], s21 offen offset:3072 sc1 lds
    v_mfma_f32_16x16x32_bf16 v[204:207], v[140:143], a[28:31], v[204:207]
    s_waitcnt vmcnt(11)
    ds_read_b128 v[136:139], v12 offset:2048
    ds_read_b128 v[140:143], v12 offset:10240
    v_mfma_f32_16x16x32_bf16 v[208:211], v[144:147], a[16:19], v[208:211]
    s_add_u32 s21, s21, 4096
    v_mfma_f32_16x16x32_bf16 v[208:211], v[148:151], a[24:27], v[208:211]
    s_add_u32 m0, s47, 4096
    v_mfma_f32_16x16x32_bf16 v[212:215], v[144:147], a[20:23], v[212:215]
    buffer_load_dwordx4 v1, s[56:59], s21 offen sc1 lds
    v_mfma_f32_16x16x32_bf16 v[212:215], v[148:151], a[28:31], v[212:215]
    ds_read_b128 v[144:147], v12 offset:3072
    ds_read_b128 v[148:151], v12 offset:11264
    v_mfma_f32_16x16x32_bf16 v[216:219], v[104:107], a[16:19], v[216:219]
    s_cmp_eq_u32 s99, 0
    s_cselect_b32 s11, 1073741824, s11
    s_waitcnt lgkmcnt(2)
    v_mfma_f32_16x16x32_bf16 v[216:219], v[108:111], a[24:27], v[216:219]
    v_mfma_f32_16x16x32_bf16 v[220:223], v[104:107], a[20:23], v[220:223]
    buffer_load_dwordx4 v1, s[56:59], s21 offen offset:1024 sc1 lds
    v_mfma_f32_16x16x32_bf16 v[220:223], v[108:111], a[28:31], v[220:223]
    ds_read_b128 v[104:107], v12 offset:4096
    ds_read_b128 v[108:111], v12 offset:12288
    v_mfma_f32_16x16x32_bf16 v[224:227], v[112:115], a[16:19], v[224:227]
    v_mfma_f32_16x16x32_bf16 v[224:227], v[116:119], a[24:27], v[224:227]
    v_mfma_f32_16x16x32_bf16 v[228:231], v[112:115], a[20:23], v[228:231]
    buffer_load_dwordx4 v1, s[56:59], s21 offen offset:2048 sc1 lds
    v_mfma_f32_16x16x32_bf16 v[228:231], v[116:119], a[28:31], v[228:231]
    ds_read_b128 v[112:115], v12 offset:5120
    ds_read_b128 v[116:119], v12 offset:13312
    v_mfma_f32_16x16x32_bf16 v[176:179], v[120:123], a[32:35], v[176:179]
    v_mfma_f32_16x16x32_bf16 v[176:179], v[124:127], a[40:43], v[176:179]
    v_mfma_f32_16x16x32_bf16 v[180:183], v[120:123], a[36:39], v[180:183]
    buffer_load_dwordx4 a[100:103], v5, s[40:43], s20 offen offset:0 sc1
    v_mfma_f32_16x16x32_bf16 v[180:183], v[124:127], a[44:47], v[180:183]
    ds_read_b128 v[120:123], v12 offset:6144
    ds_read_b128 v[124:127], v12 offset:14336
    v_mfma_f32_16x16x32_bf16 v[184:187], v[128:131], a[32:35], v[184:187]
    v_mfma_f32_16x16x32_bf16 v[184:187], v[132:135], a[40:43], v[184:187]
    v_mfma_f32_16x16x32_bf16 v[188:191], v[128:131], a[36:39], v[188:191]
    ds_read_b128 v[128:131], v12 offset:16384
    v_mfma_f32_16x16x32_bf16 v[188:191], v[132:135], a[44:47], v[188:191]
    buffer_load_dwordx4 a[108:111], v5, s[40:43], s20 offen offset:1024 sc1
    v_mfma_f32_16x16x32_bf16 v[192:195], v[136:139], a[32:35], v[192:195]
    ds_read_b128 v[132:135], v12 offset:24576
    v_mfma_f32_16x16x32_bf16 v[192:195], v[140:143], a[40:43], v[192:195]
    v_mfma_f32_16x16x32_bf16 v[196:199], v[136:139], a[36:39], v[196:199]
    ds_read_b128 v[136:139], v12 offset:17408
    v_mfma_f32_16x16x32_bf16 v[196:199], v[140:143], a[44:47], v[196:199]
    s_waitcnt lgkmcnt(2)
    buffer_load_dwordx4 a[116:119], v5, s[40:43], s20 offen offset:2048 sc1
    v_mfma_f32_16x16x32_bf16 v[200:203], v[144:147], a[32:35], v[200:203]
    ds_read_b128 v[140:143], v12 offset:25600
    v_mfma_f32_16x16x32_bf16 v[200:203], v[148:151], a[40:43], v[200:203]
    v_mfma_f32_16x16x32_bf16 v[204:207], v[144:147], a[36:39], v[204:207]
    ds_read_b128 v[144:147], v12 offset:18432
    v_mfma_f32_16x16x32_bf16 v[204:207], v[148:151], a[44:47], v[204:207]
    buffer_load_dwordx4 a[124:127], v5, s[40:43], s20 offen offset:3072 sc1
    v_mfma_f32_16x16x32_bf16 v[208:211], v[104:107], a[32:35], v[208:211]
    s_xor_b32 s21, s3, 4
    ds_read_b128 v[148:151], v12 offset:26624
    v_mfma_f32_16x16x32_bf16 v[208:211], v[108:111], a[40:43], v[208:211]
    s_lshl2_add_u32 s21, s21, s4
    v_mfma_f32_16x16x32_bf16 v[212:215], v[104:107], a[36:39], v[212:215]
    s_mul_i32 s21, s21, 36864
    ds_read_b128 v[104:107], v12 offset:19456
    v_mfma_f32_16x16x32_bf16 v[212:215], v[108:111], a[44:47], v[212:215]
    s_add_u32 s21, s21, s28
    s_mov_b32 m0, s79
    ds_read_b128 v[108:111], v12 offset:27648
    v_mfma_f32_16x16x32_bf16 v[216:219], v[112:115], a[32:35], v[216:219]
    s_xor_b32 s20, s20, 28672
    buffer_load_dwordx4 v1, s[56:59], s21 offen sc1 lds
    v_mfma_f32_16x16x32_bf16 v[216:219], v[116:119], a[40:43], v[216:219]
    v_mfma_f32_16x16x32_bf16 v[220:223], v[112:115], a[36:39], v[220:223]
    ds_read_b128 v[112:115], v12 offset:20480
    v_mfma_f32_16x16x32_bf16 v[220:223], v[116:119], a[44:47], v[220:223]
    buffer_load_dwordx4 v1, s[56:59], s21 offen offset:1024 sc1 lds
    v_mfma_f32_16x16x32_bf16 v[224:227], v[120:123], a[32:35], v[224:227]
    ds_read_b128 v[116:119], v12 offset:28672
    v_mfma_f32_16x16x32_bf16 v[224:227], v[124:127], a[40:43], v[224:227]
    v_mfma_f32_16x16x32_bf16 v[228:231], v[120:123], a[36:39], v[228:231]
    ds_read_b128 v[120:123], v12 offset:21504
    v_mfma_f32_16x16x32_bf16 v[228:231], v[124:127], a[44:47], v[228:231]
    ds_read_b128 v[124:127], v12 offset:29696
    v_mfma_f32_16x16x32_bf16 v[176:179], v[128:131], a[48:51], v[176:179]
    s_waitcnt lgkmcnt(3)
    buffer_load_dwordx4 v1, s[56:59], s21 offen offset:2048 sc1 lds
    v_mfma_f32_16x16x32_bf16 v[176:179], v[132:135], a[56:59], v[176:179]
    v_mfma_f32_16x16x32_bf16 v[180:183], v[128:131], a[52:55], v[180:183]
    ds_read_b128 v[128:131], v12 offset:22528
    v_mfma_f32_16x16x32_bf16 v[180:183], v[132:135], a[60:63], v[180:183]
    ds_read_b128 v[132:135], v12 offset:30720
    v_mfma_f32_16x16x32_bf16 v[184:187], v[136:139], a[48:51], v[184:187]
    buffer_load_dwordx4 v1, s[56:59], s21 offen offset:3072 sc1 lds
    v_mfma_f32_16x16x32_bf16 v[184:187], v[140:143], a[56:59], v[184:187]
    s_add_u32 s21, s21, 4096
    v_mfma_f32_16x16x32_bf16 v[188:191], v[136:139], a[52:55], v[188:191]
    s_add_u32 m0, s79, 4096
    ds_read_b128 v[136:139], v13 offset:0
    v_mfma_f32_16x16x32_bf16 v[188:191], v[140:143], a[60:63], v[188:191]
    ds_read_b128 v[140:143], v13 offset:8192
    v_mfma_f32_16x16x32_bf16 v[192:195], v[144:147], a[48:51], v[192:195]
    buffer_load_dwordx4 v1, s[56:59], s21 offen sc1 lds
    v_mfma_f32_16x16x32_bf16 v[192:195], v[148:151], a[56:59], v[192:195]
    v_mfma_f32_16x16x32_bf16 v[196:199], v[144:147], a[52:55], v[196:199]
    ds_read_b128 v[144:147], v13 offset:1024
    v_mfma_f32_16x16x32_bf16 v[196:199], v[148:151], a[60:63], v[196:199]
    ds_read_b128 v[148:151], v13 offset:9216
    v_mfma_f32_16x16x32_bf16 v[200:203], v[104:107], a[48:51], v[200:203]
    buffer_load_dwordx4 v1, s[56:59], s21 offen offset:1024 sc1 lds
    v_mfma_f32_16x16x32_bf16 v[200:203], v[108:111], a[56:59], v[200:203]
    v_mfma_f32_16x16x32_bf16 v[204:207], v[104:107], a[52:55], v[204:207]
    ds_read_b128 v[104:107], v13 offset:2048
    v_mfma_f32_16x16x32_bf16 v[204:207], v[108:111], a[60:63], v[204:207]
    s_waitcnt vmcnt(20)
    s_barrier
    ds_read_b128 v[108:111], v13 offset:10240
    v_mfma_f32_16x16x32_bf16 v[208:211], v[112:115], a[48:51], v[208:211]
    s_waitcnt lgkmcnt(2)
    buffer_load_dwordx4 v1, s[56:59], s21 offen offset:2048 sc1 lds
    v_mfma_f32_16x16x32_bf16 v[208:211], v[116:119], a[56:59], v[208:211]
    v_mfma_f32_16x16x32_bf16 v[212:215], v[112:115], a[52:55], v[212:215]
    ds_read_b128 v[112:115], v13 offset:3072
    v_mfma_f32_16x16x32_bf16 v[212:215], v[116:119], a[60:63], v[212:215]
    ds_read_b128 v[116:119], v13 offset:11264
    v_mfma_f32_16x16x32_bf16 v[216:219], v[120:123], a[48:51], v[216:219]
    v_mfma_f32_16x16x32_bf16 v[216:219], v[124:127], a[56:59], v[216:219]
    buffer_load_dwordx4 a[132:135], v5, s[40:43], s20 offen offset:0 sc1
    v_mfma_f32_16x16x32_bf16 v[220:223], v[120:123], a[52:55], v[220:223]
    ds_read_b128 v[120:123], v13 offset:4096
    v_mfma_f32_16x16x32_bf16 v[220:223], v[124:127], a[60:63], v[220:223]
    ds_read_b128 v[124:127], v13 offset:12288
    v_mfma_f32_16x16x32_bf16 v[224:227], v[128:131], a[48:51], v[224:227]
    v_mfma_f32_16x16x32_bf16 v[224:227], v[132:135], a[56:59], v[224:227]
    buffer_load_dwordx4 a[140:143], v5, s[40:43], s20 offen offset:1024 sc1
    v_mfma_f32_16x16x32_bf16 v[228:231], v[128:131], a[52:55], v[228:231]
    ds_read_b128 v[128:131], v13 offset:5120
    v_mfma_f32_16x16x32_bf16 v[228:231], v[132:135], a[60:63], v[228:231]
    ds_read_b128 v[132:135], v13 offset:13312
    v_mfma_f32_16x16x32_bf16 v[176:179], v[136:139], a[64:67], v[176:179]
    v_mfma_f32_16x16x32_bf16 v[176:179], v[140:143], a[72:75], v[176:179]
    buffer_load_dwordx4 a[148:151], v5, s[40:43], s20 offen offset:2048 sc1
    v_mfma_f32_16x16x32_bf16 v[180:183], v[136:139], a[68:71], v[180:183]
    ds_read_b128 v[136:139], v13 offset:6144
    v_mfma_f32_16x16x32_bf16 v[180:183], v[140:143], a[76:79], v[180:183]
    ds_read_b128 v[140:143], v13 offset:14336
    v_mfma_f32_16x16x32_bf16 v[184:187], v[144:147], a[64:67], v[184:187]
    v_mfma_f32_16x16x32_bf16 v[184:187], v[148:151], a[72:75], v[184:187]
    buffer_load_dwordx4 a[156:159], v5, s[40:43], s20 offen offset:3072 sc1
    v_mfma_f32_16x16x32_bf16 v[188:191], v[144:147], a[68:71], v[188:191]
    s_xor_b32 s21, s3, 5
    ds_read_b128 v[144:147], v13 offset:16384
    v_mfma_f32_16x16x32_bf16 v[188:191], v[148:151], a[76:79], v[188:191]
    s_lshl2_add_u32 s21, s21, s4
    ds_read_b128 v[148:151], v13 offset:24576
    s_waitcnt lgkmcnt(3)
    v_mfma_f32_16x16x32_bf16 v[192:195], v[104:107], a[64:67], v[192:195]
    s_mul_i32 s21, s21, 36864
    v_mfma_f32_16x16x32_bf16 v[192:195], v[108:111], a[72:75], v[192:195]
    s_add_u32 s21, s21, s28
    s_mov_b32 m0, s44
    v_mfma_f32_16x16x32_bf16 v[196:199], v[104:107], a[68:71], v[196:199]
    s_xor_b32 s20, s20, 4096
    buffer_load_dwordx4 v1, s[56:59], s21 offen sc1 lds
    v_mfma_f32_16x16x32_bf16 v[196:199], v[108:111], a[76:79], v[196:199]
    ds_read_b128 v[104:107], v13 offset:17408
    ds_read_b128 v[108:111], v13 offset:25600
    v_mfma_f32_16x16x32_bf16 v[200:203], v[112:115], a[64:67], v[200:203]
    v_mfma_f32_16x16x32_bf16 v[200:203], v[116:119], a[72:75], v[200:203]
    v_mfma_f32_16x16x32_bf16 v[204:207], v[112:115], a[68:71], v[204:207]
    buffer_load_dwordx4 v1, s[56:59], s21 offen offset:1024 sc1 lds
    v_mfma_f32_16x16x32_bf16 v[204:207], v[116:119], a[76:79], v[204:207]
    ds_read_b128 v[112:115], v13 offset:18432
    ds_read_b128 v[116:119], v13 offset:26624
    v_mfma_f32_16x16x32_bf16 v[208:211], v[120:123], a[64:67], v[208:211]
    v_mfma_f32_16x16x32_bf16 v[208:211], v[124:127], a[72:75], v[208:211]
    v_mfma_f32_16x16x32_bf16 v[212:215], v[120:123], a[68:71], v[212:215]
    buffer_load_dwordx4 v1, s[56:59], s21 offen offset:2048 sc1 lds
    v_mfma_f32_16x16x32_bf16 v[212:215], v[124:127], a[76:79], v[212:215]
    ds_read_b128 v[120:123], v13 offset:19456
    ds_read_b128 v[124:127], v13 offset:27648
    v_mfma_f32_16x16x32_bf16 v[216:219], v[128:131], a[64:67], v[216:219]
    v_mfma_f32_16x16x32_bf16 v[216:219], v[132:135], a[72:75], v[216:219]
    v_mfma_f32_16x16x32_bf16 v[220:223], v[128:131], a[68:71], v[220:223]
    buffer_load_dwordx4 v1, s[56:59], s21 offen offset:3072 sc1 lds
    v_mfma_f32_16x16x32_bf16 v[220:223], v[132:135], a[76:79], v[220:223]
    s_add_u32 s21, s21, 4096
    ds_read_b128 v[128:131], v13 offset:20480
    ds_read_b128 v[132:135], v13 offset:28672
    v_mfma_f32_16x16x32_bf16 v[224:227], v[136:139], a[64:67], v[224:227]
    s_add_u32 m0, s44, 4096
    s_waitcnt lgkmcnt(2)
    v_mfma_f32_16x16x32_bf16 v[224:227], v[140:143], a[72:75], v[224:227]
    v_mfma_f32_16x16x32_bf16 v[228:231], v[136:139], a[68:71], v[228:231]
    buffer_load_dwordx4 v1, s[56:59], s21 offen sc1 lds
    v_mfma_f32_16x16x32_bf16 v[228:231], v[140:143], a[76:79], v[228:231]
    ds_read_b128 v[136:139], v13 offset:21504
    ds_read_b128 v[140:143], v13 offset:29696
    v_mfma_f32_16x16x32_bf16 v[176:179], v[144:147], a[80:83], v[176:179]
    v_mfma_f32_16x16x32_bf16 v[176:179], v[148:151], a[88:91], v[176:179]
    v_mfma_f32_16x16x32_bf16 v[180:183], v[144:147], a[84:87], v[180:183]
    buffer_load_dwordx4 v1, s[56:59], s21 offen offset:1024 sc1 lds
    v_mfma_f32_16x16x32_bf16 v[180:183], v[148:151], a[92:95], v[180:183]
    ds_read_b128 v[144:147], v13 offset:22528
    ds_read_b128 v[148:151], v13 offset:30720
    v_mfma_f32_16x16x32_bf16 v[184:187], v[104:107], a[80:83], v[184:187]
    v_mfma_f32_16x16x32_bf16 v[184:187], v[108:111], a[88:91], v[184:187]
    v_mfma_f32_16x16x32_bf16 v[188:191], v[104:107], a[84:87], v[188:191]
    v_mfma_f32_16x16x32_bf16 v[188:191], v[108:111], a[92:95], v[188:191]
    buffer_load_dwordx4 v1, s[56:59], s21 offen offset:2048 sc1 lds
    v_mfma_f32_16x16x32_bf16 v[192:195], v[112:115], a[80:83], v[192:195]
    v_mfma_f32_16x16x32_bf16 v[192:195], v[116:119], a[88:91], v[192:195]
    v_mfma_f32_16x16x32_bf16 v[196:199], v[112:115], a[84:87], v[196:199]
    v_mfma_f32_16x16x32_bf16 v[196:199], v[116:119], a[92:95], v[196:199]
    buffer_load_dwordx4 a[160:163], v4, s[40:43], s63 offen offset:0 sc1
    v_mfma_f32_16x16x32_bf16 v[200:203], v[120:123], a[80:83], v[200:203]
    v_mfma_f32_16x16x32_bf16 v[200:203], v[124:127], a[88:91], v[200:203]
    v_mfma_f32_16x16x32_bf16 v[204:207], v[120:123], a[84:87], v[204:207]
    v_mfma_f32_16x16x32_bf16 v[204:207], v[124:127], a[92:95], v[204:207]
    s_waitcnt vmcnt(19)
    s_barrier
    v_mov_b32 v31, 3
    s_waitcnt lgkmcnt(0)
    v_mfma_f32_16x16x32_bf16 v[208:211], v[128:131], a[80:83], v[208:211]
    buffer_load_dwordx4 a[168:171], v4, s[40:43], s63 offen offset:1024 sc1
    v_mfma_f32_16x16x32_bf16 v[208:211], v[132:135], a[88:91], v[208:211]
    buffer_store_dword v31, v30, s[32:35], s101 offen sc1
    v_mfma_f32_16x16x32_bf16 v[212:215], v[128:131], a[84:87], v[212:215]
    ds_read_b128 v[104:107], v6 offset:0
    ds_read_b128 v[108:111], v6 offset:8192
    v_mfma_f32_16x16x32_bf16 v[212:215], v[132:135], a[92:95], v[212:215]
    ds_read_b128 v[112:115], v6 offset:1024
    v_mfma_f32_16x16x32_bf16 v[216:219], v[136:139], a[80:83], v[216:219]
    buffer_load_dwordx4 a[176:179], v4, s[40:43], s63 offen offset:2048 sc1
    v_mfma_f32_16x16x32_bf16 v[216:219], v[140:143], a[88:91], v[216:219]
    ds_read_b128 v[116:119], v6 offset:9216
    ds_read_b128 v[120:123], v6 offset:2048
    v_mfma_f32_16x16x32_bf16 v[220:223], v[136:139], a[84:87], v[220:223]
    ds_read_b128 v[124:127], v6 offset:10240
    v_mfma_f32_16x16x32_bf16 v[220:223], v[140:143], a[92:95], v[220:223]
    ds_read_b128 v[128:131], v6 offset:3072
    v_mfma_f32_16x16x32_bf16 v[224:227], v[144:147], a[80:83], v[224:227]
    buffer_load_dwordx4 a[184:187], v4, s[40:43], s63 offen offset:3072 sc1
    v_mfma_f32_16x16x32_bf16 v[224:227], v[148:151], a[88:91], v[224:227]
    s_xor_b32 s63, s63, 12288
    ds_read_b128 v[132:135], v6 offset:11264
    ds_read_b128 v[136:139], v6 offset:4096
    v_mfma_f32_16x16x32_bf16 v[228:231], v[144:147], a[84:87], v[228:231]
    ds_read_b128 v[140:143], v6 offset:12288
    v_mfma_f32_16x16x32_bf16 v[228:231], v[148:151], a[92:95], v[228:231]
    s_waitcnt lgkmcnt(4)
    ds_read_b128 v[144:147], v6 offset:5120
    v_mfma_f32_16x16x32_bf16 v[176:179], v[104:107], a[96:99], v[176:179]
    buffer_load_dwordx4 a[164:167], v5, s[40:43], s20 offen offset:0 sc1
    v_mfma_f32_16x16x32_bf16 v[176:179], v[108:111], a[104:107], v[176:179]
    ds_read_b128 v[148:151], v6 offset:13312
    v_mfma_f32_16x16x32_bf16 v[180:183], v[104:107], a[100:103], v[180:183]
    ds_read_b128 v[104:107], v6 offset:6144
    v_mfma_f32_16x16x32_bf16 v[180:183], v[108:111], a[108:111], v[180:183]
    ds_read_b128 v[108:111], v6 offset:14336
    v_mfma_f32_16x16x32_bf16 v[184:187], v[112:115], a[96:99], v[184:187]
    buffer_load_dwordx4 a[172:175], v5, s[40:43], s20 offen offset:1024 sc1
    v_mfma_f32_16x16x32_bf16 v[184:187], v[116:119], a[104:107], v[184:187]
    v_mfma_f32_16x16x32_bf16 v[188:191], v[112:115], a[100:103], v[188:191]
    ds_read_b128 v[112:115], v6 offset:16384
    v_mfma_f32_16x16x32_bf16 v[188:191], v[116:119], a[108:111], v[188:191]
    ds_read_b128 v[116:119], v6 offset:24576
    v_mfma_f32_16x16x32_bf16 v[192:195], v[120:123], a[96:99], v[192:195]
    buffer_load_dwordx4 a[180:183], v5, s[40:43], s20 offen offset:2048 sc1
    v_mfma_f32_16x16x32_bf16 v[192:195], v[124:127], a[104:107], v[192:195]
    v_mfma_f32_16x16x32_bf16 v[196:199], v[120:123], a[100:103], v[196:199]
    ds_read_b128 v[120:123], v6 offset:17408
    v_mfma_f32_16x16x32_bf16 v[196:199], v[124:127], a[108:111], v[196:199]
    s_waitcnt lgkmcnt(2)
    ds_read_b128 v[124:127], v6 offset:25600
    v_mfma_f32_16x16x32_bf16 v[200:203], v[128:131], a[96:99], v[200:203]
    buffer_load_dwordx4 a[188:191], v5, s[40:43], s20 offen offset:3072 sc1
    v_mfma_f32_16x16x32_bf16 v[200:203], v[132:135], a[104:107], v[200:203]
    s_xor_b32 s21, s3, 6
    v_mfma_f32_16x16x32_bf16 v[204:207], v[128:131], a[100:103], v[204:207]
    s_lshl2_add_u32 s21, s21, s4
    ds_read_b128 v[128:131], v6 offset:18432
    v_mfma_f32_16x16x32_bf16 v[204:207], v[132:135], a[108:111], v[204:207]
    s_mul_i32 s21, s21, 36864
    ds_read_b128 v[132:135], v6 offset:26624
    v_mfma_f32_16x16x32_bf16 v[208:211], v[136:139], a[96:99], v[208:211]
    s_add_u32 s21, s21, s28
    s_mov_b32 m0, s45
    v_mfma_f32_16x16x32_bf16 v[208:211], v[140:143], a[104:107], v[208:211]
    s_xor_b32 s20, s20, 12288
    buffer_load_dwordx4 v1, s[56:59], s21 offen sc1 lds
    v_mfma_f32_16x16x32_bf16 v[212:215], v[136:139], a[100:103], v[212:215]
    ds_read_b128 v[136:139], v6 offset:19456
    v_mfma_f32_16x16x32_bf16 v[212:215], v[140:143], a[108:111], v[212:215]
    ds_read_b128 v[140:143], v6 offset:27648
    v_mfma_f32_16x16x32_bf16 v[216:219], v[144:147], a[96:99], v[216:219]
    buffer_load_dwordx4 v1, s[56:59], s21 offen offset:1024 sc1 lds
    v_mfma_f32_16x16x32_bf16 v[216:219], v[148:151], a[104:107], v[216:219]
    v_mfma_f32_16x16x32_bf16 v[220:223], v[144:147], a[100:103], v[220:223]
    ds_read_b128 v[144:147], v6 offset:20480
    v_mfma_f32_16x16x32_bf16 v[220:223], v[148:151], a[108:111], v[220:223]
    ds_read_b128 v[148:151], v6 offset:28672
    v_mfma_f32_16x16x32_bf16 v[224:227], v[104:107], a[96:99], v[224:227]
    v_mfma_f32_16x16x32_bf16 v[224:227], v[108:111], a[104:107], v[224:227]
    buffer_load_dwordx4 v1, s[56:59], s21 offen offset:2048 sc1 lds
    v_mfma_f32_16x16x32_bf16 v[228:231], v[104:107], a[100:103], v[228:231]
    ds_read_b128 v[104:107], v6 offset:21504
    v_mfma_f32_16x16x32_bf16 v[228:231], v[108:111], a[108:111], v[228:231]
    ds_read_b128 v[108:111], v6 offset:29696
    v_mfma_f32_16x16x32_bf16 v[176:179], v[112:115], a[112:115], v[176:179]
    s_waitcnt lgkmcnt(2)
    v_mfma_f32_16x16x32_bf16 v[176:179], v[116:119], a[120:123], v[176:179]
    buffer_load_dwordx4 v1, s[56:59], s21 offen offset:3072 sc1 lds
    v_mfma_f32_16x16x32_bf16 v[180:183], v[112:115], a[116:119], v[180:183]
    s_add_u32 s21, s21, 4096
    ds_read_b128 v[112:115], v6 offset:22528
    v_mfma_f32_16x16x32_bf16 v[180:183], v[116:119], a[124:127], v[180:183]
    s_add_u32 m0, s45, 4096
    ds_read_b128 v[116:119], v6 offset:30720
    v_mfma_f32_16x16x32_bf16 v[184:187], v[120:123], a[112:115], v[184:187]
    v_mfma_f32_16x16x32_bf16 v[184:187], v[124:127], a[120:123], v[184:187]
    buffer_load_dwordx4 v1, s[56:59], s21 offen sc1 lds
    v_mfma_f32_16x16x32_bf16 v[188:191], v[120:123], a[116:119], v[188:191]
    v_mfma_f32_16x16x32_bf16 v[188:191], v[124:127], a[124:127], v[188:191]
    v_mfma_f32_16x16x32_bf16 v[192:195], v[128:131], a[112:115], v[192:195]
    v_mfma_f32_16x16x32_bf16 v[192:195], v[132:135], a[120:123], v[192:195]
    buffer_load_dwordx4 v1, s[56:59], s21 offen offset:1024 sc1 lds
    v_mfma_f32_16x16x32_bf16 v[196:199], v[128:131], a[116:119], v[196:199]
    v_mfma_f32_16x16x32_bf16 v[196:199], v[132:135], a[124:127], v[196:199]
    v_mfma_f32_16x16x32_bf16 v[200:203], v[136:139], a[112:115], v[200:203]
    v_mfma_f32_16x16x32_bf16 v[200:203], v[140:143], a[120:123], v[200:203]
    buffer_load_dwordx4 v1, s[56:59], s21 offen offset:2048 sc1 lds
    v_mfma_f32_16x16x32_bf16 v[204:207], v[136:139], a[116:119], v[204:207]
    v_mfma_f32_16x16x32_bf16 v[204:207], v[140:143], a[124:127], v[204:207]
    s_waitcnt vmcnt(23)
    s_barrier
    ds_read_b128 v[120:123], v7 offset:0
    v_mfma_f32_16x16x32_bf16 v[208:211], v[144:147], a[112:115], v[208:211]
    ds_read_b128 v[124:127], v7 offset:8192
    ds_read_b128 v[128:131], v7 offset:1024
    v_mfma_f32_16x16x32_bf16 v[208:211], v[148:151], a[120:123], v[208:211]
    ds_read_b128 v[132:135], v7 offset:9216
    v_mfma_f32_16x16x32_bf16 v[212:215], v[144:147], a[116:119], v[212:215]
    buffer_load_dwordx4 a[192:195], v4, s[40:43], s63 offen offset:0 sc1
    v_mfma_f32_16x16x32_bf16 v[212:215], v[148:151], a[124:127], v[212:215]
    s_waitcnt lgkmcnt(4)
    ds_read_b128 v[136:139], v7 offset:2048
    ds_read_b128 v[140:143], v7 offset:10240
    v_mfma_f32_16x16x32_bf16 v[216:219], v[104:107], a[112:115], v[216:219]
    ds_read_b128 v[144:147], v7 offset:3072
    v_mfma_f32_16x16x32_bf16 v[216:219], v[108:111], a[120:123], v[216:219]
    ds_read_b128 v[148:151], v7 offset:11264
    v_mfma_f32_16x16x32_bf16 v[220:223], v[104:107], a[116:119], v[220:223]
    buffer_load_dwordx4 a[200:203], v4, s[40:43], s63 offen offset:1024 sc1
    v_mfma_f32_16x16x32_bf16 v[220:223], v[108:111], a[124:127], v[220:223]
    ds_read_b128 v[104:107], v7 offset:4096
    ds_read_b128 v[108:111], v7 offset:12288
    v_mfma_f32_16x16x32_bf16 v[224:227], v[112:115], a[112:115], v[224:227]
    v_mfma_f32_16x16x32_bf16 v[224:227], v[116:119], a[120:123], v[224:227]
    v_mfma_f32_16x16x32_bf16 v[228:231], v[112:115], a[116:119], v[228:231]
    buffer_load_dwordx4 a[208:211], v4, s[40:43], s63 offen offset:2048 sc1
    v_mfma_f32_16x16x32_bf16 v[228:231], v[116:119], a[124:127], v[228:231]
    s_waitcnt lgkmcnt(2)
    ds_read_b128 v[112:115], v7 offset:5120
    ds_read_b128 v[116:119], v7 offset:13312
    v_mfma_f32_16x16x32_bf16 v[176:179], v[120:123], a[128:131], v[176:179]
    v_mfma_f32_16x16x32_bf16 v[176:179], v[124:127], a[136:139], v[176:179]
    v_mfma_f32_16x16x32_bf16 v[180:183], v[120:123], a[132:135], v[180:183]
    buffer_load_dwordx4 a[216:219], v4, s[40:43], s63 offen offset:3072 sc1
    v_mfma_f32_16x16x32_bf16 v[180:183], v[124:127], a[140:143], v[180:183]
    s_xor_b32 s63, s63, 4096
    ds_read_b128 v[120:123], v7 offset:6144
    ds_read_b128 v[124:127], v7 offset:14336
    v_mfma_f32_16x16x32_bf16 v[184:187], v[128:131], a[128:131], v[184:187]
    v_mfma_f32_16x16x32_bf16 v[184:187], v[132:135], a[136:139], v[184:187]
    v_mfma_f32_16x16x32_bf16 v[188:191], v[128:131], a[132:135], v[188:191]
    buffer_load_dwordx4 a[196:199], v5, s[40:43], s20 offen offset:0 sc1
    v_mfma_f32_16x16x32_bf16 v[188:191], v[132:135], a[140:143], v[188:191]
    ds_read_b128 v[128:131], v7 offset:16384
    ds_read_b128 v[132:135], v7 offset:24576
    v_mfma_f32_16x16x32_bf16 v[192:195], v[136:139], a[128:131], v[192:195]
    v_mfma_f32_16x16x32_bf16 v[192:195], v[140:143], a[136:139], v[192:195]
    v_mfma_f32_16x16x32_bf16 v[196:199], v[136:139], a[132:135], v[196:199]
    ds_read_b128 v[136:139], v7 offset:17408
    v_mfma_f32_16x16x32_bf16 v[196:199], v[140:143], a[140:143], v[196:199]
    buffer_load_dwordx4 a[204:207], v5, s[40:43], s20 offen offset:1024 sc1
    v_mfma_f32_16x16x32_bf16 v[200:203], v[144:147], a[128:131], v[200:203]
    ds_read_b128 v[140:143], v7 offset:25600
    v_mfma_f32_16x16x32_bf16 v[200:203], v[148:151], a[136:139], v[200:203]
    v_mfma_f32_16x16x32_bf16 v[204:207], v[144:147], a[132:135], v[204:207]
    ds_read_b128 v[144:147], v7 offset:18432
    v_mfma_f32_16x16x32_bf16 v[204:207], v[148:151], a[140:143], v[204:207]
    s_waitcnt lgkmcnt(2)
    buffer_load_dwordx4 a[212:215], v5, s[40:43], s20 offen offset:2048 sc1
    v_mfma_f32_16x16x32_bf16 v[208:211], v[104:107], a[128:131], v[208:211]
    ds_read_b128 v[148:151], v7 offset:26624
    v_mfma_f32_16x16x32_bf16 v[208:211], v[108:111], a[136:139], v[208:211]
    v_mfma_f32_16x16x32_bf16 v[212:215], v[104:107], a[132:135], v[212:215]
    ds_read_b128 v[104:107], v7 offset:19456
    v_mfma_f32_16x16x32_bf16 v[212:215], v[108:111], a[140:143], v[212:215]
    buffer_load_dwordx4 a[220:223], v5, s[40:43], s20 offen offset:3072 sc1
    v_mfma_f32_16x16x32_bf16 v[216:219], v[112:115], a[128:131], v[216:219]
    s_xor_b32 s21, s3, 7
    ds_read_b128 v[108:111], v7 offset:27648
    v_mfma_f32_16x16x32_bf16 v[216:219], v[116:119], a[136:139], v[216:219]
    s_lshl2_add_u32 s21, s21, s4
    v_mfma_f32_16x16x32_bf16 v[220:223], v[112:115], a[132:135], v[220:223]
    s_mul_i32 s21, s21, 36864
    ds_read_b128 v[112:115], v7 offset:20480
    v_mfma_f32_16x16x32_bf16 v[220:223], v[116:119], a[140:143], v[220:223]
    s_add_u32 s21, s21, s28
    s_mov_b32 m0, s46
    ds_read_b128 v[116:119], v7 offset:28672
    v_mfma_f32_16x16x32_bf16 v[224:227], v[120:123], a[128:131], v[224:227]
    s_xor_b32 s20, s20, 4096
    buffer_load_dwordx4 v1, s[56:59], s21 offen sc1 lds
    v_mfma_f32_16x16x32_bf16 v[224:227], v[124:127], a[136:139], v[224:227]
    v_mfma_f32_16x16x32_bf16 v[228:231], v[120:123], a[132:135], v[228:231]
    ds_read_b128 v[120:123], v7 offset:21504
    v_mfma_f32_16x16x32_bf16 v[228:231], v[124:127], a[140:143], v[228:231]
    buffer_load_dwordx4 v1, s[56:59], s21 offen offset:1024 sc1 lds
    v_mfma_f32_16x16x32_bf16 v[176:179], v[128:131], a[144:147], v[176:179]
    ds_read_b128 v[124:127], v7 offset:29696
    v_mfma_f32_16x16x32_bf16 v[176:179], v[132:135], a[152:155], v[176:179]
    v_mfma_f32_16x16x32_bf16 v[180:183], v[128:131], a[148:151], v[180:183]
    buffer_load_dword v3, v19, s[32:35], s66 offen sc1
    v_mfma_f32_16x16x32_bf16 v[180:183], v[132:135], a[156:159], v[180:183]
    ds_read_b128 v[128:131], v7 offset:22528
    ds_read_b128 v[132:135], v7 offset:30720
    v_mfma_f32_16x16x32_bf16 v[184:187], v[136:139], a[144:147], v[184:187]
    s_waitcnt lgkmcnt(3)
    buffer_load_dwordx4 v1, s[56:59], s21 offen offset:2048 sc1 lds
    v_mfma_f32_16x16x32_bf16 v[184:187], v[140:143], a[152:155], v[184:187]
    v_mfma_f32_16x16x32_bf16 v[188:191], v[136:139], a[148:151], v[188:191]
    v_mfma_f32_16x16x32_bf16 v[188:191], v[140:143], a[156:159], v[188:191]
    v_mfma_f32_16x16x32_bf16 v[192:195], v[144:147], a[144:147], v[192:195]
    buffer_load_dwordx4 v1, s[56:59], s21 offen offset:3072 sc1 lds
    v_mfma_f32_16x16x32_bf16 v[192:195], v[148:151], a[152:155], v[192:195]
    s_add_u32 s21, s21, 4096
    v_mfma_f32_16x16x32_bf16 v[196:199], v[144:147], a[148:151], v[196:199]
    s_add_u32 m0, s46, 4096
    v_mfma_f32_16x16x32_bf16 v[196:199], v[148:151], a[156:159], v[196:199]
    v_mfma_f32_16x16x32_bf16 v[200:203], v[104:107], a[144:147], v[200:203]
    buffer_load_dwordx4 v1, s[56:59], s21 offen sc1 lds
    v_mfma_f32_16x16x32_bf16 v[200:203], v[108:111], a[152:155], v[200:203]
    v_mfma_f32_16x16x32_bf16 v[204:207], v[104:107], a[148:151], v[204:207]
    v_mfma_f32_16x16x32_bf16 v[204:207], v[108:111], a[156:159], v[204:207]
    s_waitcnt vmcnt(21)
    s_barrier
    ds_read_b128 v[136:139], v11 offset:0
    v_mfma_f32_16x16x32_bf16 v[208:211], v[112:115], a[144:147], v[208:211]
    buffer_load_dwordx4 v1, s[56:59], s21 offen offset:1024 sc1 lds
    v_mfma_f32_16x16x32_bf16 v[208:211], v[116:119], a[152:155], v[208:211]
    ds_read_b128 v[140:143], v11 offset:8192
    ds_read_b128 v[144:147], v11 offset:1024
    v_mfma_f32_16x16x32_bf16 v[212:215], v[112:115], a[148:151], v[212:215]
    ds_read_b128 v[148:151], v11 offset:9216
    v_mfma_f32_16x16x32_bf16 v[212:215], v[116:119], a[156:159], v[212:215]
    ds_read_b128 v[104:107], v11 offset:2048
    v_mfma_f32_16x16x32_bf16 v[216:219], v[120:123], a[144:147], v[216:219]
    s_waitcnt lgkmcnt(4)
    buffer_load_dwordx4 v1, s[56:59], s21 offen offset:2048 sc1 lds
    v_mfma_f32_16x16x32_bf16 v[216:219], v[124:127], a[152:155], v[216:219]
    ds_read_b128 v[108:111], v11 offset:10240
    ds_read_b128 v[112:115], v11 offset:3072
    v_mfma_f32_16x16x32_bf16 v[220:223], v[120:123], a[148:151], v[220:223]
    ds_read_b128 v[116:119], v11 offset:11264
    v_mfma_f32_16x16x32_bf16 v[220:223], v[124:127], a[156:159], v[220:223]
    ds_read_b128 v[120:123], v11 offset:4096
    v_mfma_f32_16x16x32_bf16 v[224:227], v[128:131], a[144:147], v[224:227]
    ds_read_b128 v[124:127], v11 offset:12288
    v_mfma_f32_16x16x32_bf16 v[224:227], v[132:135], a[152:155], v[224:227]
    buffer_load_dwordx4 a[224:227], v4, s[40:43], s63 offen offset:0 sc1
    v_mfma_f32_16x16x32_bf16 v[228:231], v[128:131], a[148:151], v[228:231]
    ds_read_b128 v[128:131], v11 offset:5120
    v_mfma_f32_16x16x32_bf16 v[228:231], v[132:135], a[156:159], v[228:231]
    ds_read_b128 v[132:135], v11 offset:13312
    v_mfma_f32_16x16x32_bf16 v[176:179], v[136:139], a[160:163], v[176:179]
    s_waitcnt lgkmcnt(3)
    v_mfma_f32_16x16x32_bf16 v[176:179], v[140:143], a[168:171], v[176:179]
    buffer_load_dwordx4 a[232:235], v4, s[40:43], s63 offen offset:1024 sc1
    v_mfma_f32_16x16x32_bf16 v[180:183], v[136:139], a[164:167], v[180:183]
    ds_read_b128 v[136:139], v11 offset:6144
    v_mfma_f32_16x16x32_bf16 v[180:183], v[140:143], a[172:175], v[180:183]
    ds_read_b128 v[140:143], v11 offset:14336
    v_mfma_f32_16x16x32_bf16 v[184:187], v[144:147], a[160:163], v[184:187]
    v_mfma_f32_16x16x32_bf16 v[184:187], v[148:151], a[168:171], v[184:187]
    buffer_load_dwordx4 a[240:243], v4, s[40:43], s63 offen offset:2048 sc1
    v_mfma_f32_16x16x32_bf16 v[188:191], v[144:147], a[164:167], v[188:191]
    ds_read_b128 v[144:147], v11 offset:16384
    v_mfma_f32_16x16x32_bf16 v[188:191], v[148:151], a[172:175], v[188:191]
    ds_read_b128 v[148:151], v11 offset:24576
    v_mfma_f32_16x16x32_bf16 v[192:195], v[104:107], a[160:163], v[192:195]
    v_mfma_f32_16x16x32_bf16 v[192:195], v[108:111], a[168:171], v[192:195]
    buffer_load_dwordx4 a[248:251], v4, s[40:43], s63 offen offset:3072 sc1
    v_mfma_f32_16x16x32_bf16 v[196:199], v[104:107], a[164:167], v[196:199]
    s_add_u32 s63, s63, 4096
    ds_read_b128 v[104:107], v11 offset:17408
    v_mfma_f32_16x16x32_bf16 v[196:199], v[108:111], a[172:175], v[196:199]
    ds_read_b128 v[108:111], v11 offset:25600
    v_mfma_f32_16x16x32_bf16 v[200:203], v[112:115], a[160:163], v[200:203]
    v_mfma_f32_16x16x32_bf16 v[200:203], v[116:119], a[168:171], v[200:203]
    buffer_load_dwordx4 a[228:231], v5, s[40:43], s20 offen offset:0 sc1
    v_mfma_f32_16x16x32_bf16 v[204:207], v[112:115], a[164:167], v[204:207]
    ds_read_b128 v[112:115], v11 offset:18432
    v_mfma_f32_16x16x32_bf16 v[204:207], v[116:119], a[172:175], v[204:207]
    ds_read_b128 v[116:119], v11 offset:26624
    v_mfma_f32_16x16x32_bf16 v[208:211], v[120:123], a[160:163], v[208:211]
    s_waitcnt lgkmcnt(2)
    v_mfma_f32_16x16x32_bf16 v[208:211], v[124:127], a[168:171], v[208:211]
    v_mfma_f32_16x16x32_bf16 v[212:215], v[120:123], a[164:167], v[212:215]
    buffer_load_dwordx4 a[236:239], v5, s[40:43], s20 offen offset:1024 sc1
    v_mfma_f32_16x16x32_bf16 v[212:215], v[124:127], a[172:175], v[212:215]
    ds_read_b128 v[120:123], v11 offset:19456
    ds_read_b128 v[124:127], v11 offset:27648
    v_mfma_f32_16x16x32_bf16 v[216:219], v[128:131], a[160:163], v[216:219]
    v_mfma_f32_16x16x32_bf16 v[216:219], v[132:135], a[168:171], v[216:219]
    v_mfma_f32_16x16x32_bf16 v[220:223], v[128:131], a[164:167], v[220:223]
    buffer_load_dwordx4 a[244:247], v5, s[40:43], s20 offen offset:2048 sc1
    v_mfma_f32_16x16x32_bf16 v[220:223], v[132:135], a[172:175], v[220:223]
    ds_read_b128 v[128:131], v11 offset:20480
    ds_read_b128 v[132:135], v11 offset:28672
    v_mfma_f32_16x16x32_bf16 v[224:227], v[136:139], a[160:163], v[224:227]
    v_mfma_f32_16x16x32_bf16 v[224:227], v[140:143], a[168:171], v[224:227]
    v_mfma_f32_16x16x32_bf16 v[228:231], v[136:139], a[164:167], v[228:231]
    buffer_load_dwordx4 a[252:255], v5, s[40:43], s20 offen offset:3072 sc1
    v_mfma_f32_16x16x32_bf16 v[228:231], v[140:143], a[172:175], v[228:231]
    s_mul_i32 s21, s61, 6
    s_add_u32 s21, s4, s21
    ds_read_b128 v[136:139], v11 offset:21504
    v_mfma_f32_16x16x32_bf16 v[176:179], v[144:147], a[176:179], v[176:179]
    s_add_u32 s21, s21, 128
    ds_read_b128 v[140:143], v11 offset:29696
    v_mfma_f32_16x16x32_bf16 v[176:179], v[148:151], a[184:187], v[176:179]
    s_mul_i32 s21, s21, 36864
    v_mfma_f32_16x16x32_bf16 v[180:183], v[144:147], a[180:183], v[180:183]
    s_add_u32 s21, s21, s28
    s_mov_b32 m0, s47
    ds_read_b128 v[144:147], v11 offset:22528
    v_mfma_f32_16x16x32_bf16 v[180:183], v[148:151], a[188:191], v[180:183]
    s_add_u32 s20, s20, 4096
    buffer_load_dwordx4 v1, s[56:59], s21 offen sc1 lds
    v_mfma_f32_16x16x32_bf16 v[184:187], v[104:107], a[176:179], v[184:187]
    ds_read_b128 v[148:151], v11 offset:30720
    v_mfma_f32_16x16x32_bf16 v[184:187], v[108:111], a[184:187], v[184:187]
    v_mfma_f32_16x16x32_bf16 v[188:191], v[104:107], a[180:183], v[188:191]
    buffer_load_dwordx4 v1, s[56:59], s21 offen offset:1024 sc1 lds
    v_mfma_f32_16x16x32_bf16 v[188:191], v[108:111], a[188:191], v[188:191]
    s_waitcnt lgkmcnt(1)
    v_mfma_f32_16x16x32_bf16 v[192:195], v[112:115], a[176:179], v[192:195]
    v_mfma_f32_16x16x32_bf16 v[192:195], v[116:119], a[184:187], v[192:195]
    v_mfma_f32_16x16x32_bf16 v[196:199], v[112:115], a[180:183], v[196:199]
    v_mfma_f32_16x16x32_bf16 v[196:199], v[116:119], a[188:191], v[196:199]
    buffer_load_dwordx4 v1, s[56:59], s21 offen offset:2048 sc1 lds
    v_mfma_f32_16x16x32_bf16 v[200:203], v[120:123], a[176:179], v[200:203]
    v_mfma_f32_16x16x32_bf16 v[200:203], v[124:127], a[184:187], v[200:203]
    v_mfma_f32_16x16x32_bf16 v[204:207], v[120:123], a[180:183], v[204:207]
    v_mfma_f32_16x16x32_bf16 v[204:207], v[124:127], a[188:191], v[204:207]
    buffer_load_dwordx4 v1, s[56:59], s21 offen offset:3072 sc1 lds
    s_waitcnt vmcnt(17)
    v_cmp_gt_u32 vcc, 3, v3
    s_nop 1
    s_and_b64 vcc, vcc, exec
    s_cbranch_scc1 SPIN_OA
BACK_OA:
    s_barrier
    v_mfma_f32_16x16x32_bf16 v[208:211], v[128:131], a[176:179], v[208:211]
    s_add_u32 s21, s21, 4096
    ds_read_b128 v[104:107], v12 offset:0
    ds_read_b128 v[108:111], v12 offset:8192
    v_mfma_f32_16x16x32_bf16 v[208:211], v[132:135], a[184:187], v[208:211]
    s_add_u32 m0, s47, 4096
    ds_read_b128 v[112:115], v12 offset:1024
    v_mfma_f32_16x16x32_bf16 v[212:215], v[128:131], a[180:183], v[212:215]
    ds_read_b128 v[116:119], v12 offset:9216
    v_mfma_f32_16x16x32_bf16 v[212:215], v[132:135], a[188:191], v[212:215]
    buffer_load_dwordx4 v1, s[56:59], s21 offen sc1 lds
    v_mfma_f32_16x16x32_bf16 v[216:219], v[136:139], a[176:179], v[216:219]
    ds_read_b128 v[120:123], v12 offset:2048
    ds_read_b128 v[124:127], v12 offset:10240
    v_mfma_f32_16x16x32_bf16 v[216:219], v[140:143], a[184:187], v[216:219]
    ds_read_b128 v[128:131], v12 offset:3072
    v_mfma_f32_16x16x32_bf16 v[220:223], v[136:139], a[180:183], v[220:223]
    ds_read_b128 v[132:135], v12 offset:11264
    v_mfma_f32_16x16x32_bf16 v[220:223], v[140:143], a[188:191], v[220:223]
    buffer_load_dwordx4 v1, s[56:59], s21 offen offset:1024 sc1 lds
    v_mfma_f32_16x16x32_bf16 v[224:227], v[144:147], a[176:179], v[224:227]
    s_waitcnt lgkmcnt(4)
    ds_read_b128 v[136:139], v12 offset:4096
    ds_read_b128 v[140:143], v12 offset:12288
    v_mfma_f32_16x16x32_bf16 v[224:227], v[148:151], a[184:187], v[224:227]
    v_mfma_f32_16x16x32_bf16 v[228:231], v[144:147], a[180:183], v[228:231]
    ds_read_b128 v[144:147], v12 offset:5120
    v_mfma_f32_16x16x32_bf16 v[228:231], v[148:151], a[188:191], v[228:231]
    buffer_load_dwordx4 v1, s[56:59], s21 offen offset:2048 sc1 lds
    v_mfma_f32_16x16x32_bf16 v[176:179], v[104:107], a[192:195], v[176:179]
    ds_read_b128 v[148:151], v12 offset:13312
    v_mfma_f32_16x16x32_bf16 v[176:179], v[108:111], a[200:203], v[176:179]
    s_mul_i32 s63, s61, 6144
    v_mfma_f32_16x16x32_bf16 v[180:183], v[104:107], a[196:199], v[180:183]
    s_add_u32 s63, s63, 131072
    ds_read_b128 v[104:107], v12 offset:6144
    v_mfma_f32_16x16x32_bf16 v[180:183], v[108:111], a[204:207], v[180:183]
    ds_read_b128 v[108:111], v12 offset:14336
    v_mfma_f32_16x16x32_bf16 v[184:187], v[112:115], a[192:195], v[184:187]
    buffer_load_dwordx4 v[32:35], v4, s[40:43], s63 offen offset:0 sc1
    v_mfma_f32_16x16x32_bf16 v[184:187], v[116:119], a[200:203], v[184:187]
    v_mfma_f32_16x16x32_bf16 v[188:191], v[112:115], a[196:199], v[188:191]
    ds_read_b128 v[112:115], v12 offset:16384
    v_mfma_f32_16x16x32_bf16 v[188:191], v[116:119], a[204:207], v[188:191]
    s_waitcnt lgkmcnt(2)
    ds_read_b128 v[116:119], v12 offset:24576
    v_mfma_f32_16x16x32_bf16 v[192:195], v[120:123], a[192:195], v[192:195]
    buffer_load_dwordx4 v[40:43], v4, s[40:43], s63 offen offset:1024 sc1
    v_mfma_f32_16x16x32_bf16 v[192:195], v[124:127], a[200:203], v[192:195]
    v_mfma_f32_16x16x32_bf16 v[196:199], v[120:123], a[196:199], v[196:199]
    ds_read_b128 v[120:123], v12 offset:17408
    v_mfma_f32_16x16x32_bf16 v[196:199], v[124:127], a[204:207], v[196:199]
    ds_read_b128 v[124:127], v12 offset:25600
    v_mfma_f32_16x16x32_bf16 v[200:203], v[128:131], a[192:195], v[200:203]
    buffer_load_dwordx4 v[48:51], v4, s[40:43], s63 offen offset:2048 sc1
    v_mfma_f32_16x16x32_bf16 v[200:203], v[132:135], a[200:203], v[200:203]
    v_mfma_f32_16x16x32_bf16 v[204:207], v[128:131], a[196:199], v[204:207]
    ds_read_b128 v[128:131], v12 offset:18432
    v_mfma_f32_16x16x32_bf16 v[204:207], v[132:135], a[204:207], v[204:207]
    ds_read_b128 v[132:135], v12 offset:26624
    v_mfma_f32_16x16x32_bf16 v[208:211], v[136:139], a[192:195], v[208:211]
    buffer_load_dwordx4 v[56:59], v4, s[40:43], s63 offen offset:3072 sc1
    v_mfma_f32_16x16x32_bf16 v[208:211], v[140:143], a[200:203], v[208:211]
    s_mul_i32 s20, s61, 6144
    v_mfma_f32_16x16x32_bf16 v[212:215], v[136:139], a[196:199], v[212:215]
    s_add_u32 s20, s20, 131072
    ds_read_b128 v[136:139], v12 offset:19456
    v_mfma_f32_16x16x32_bf16 v[212:215], v[140:143], a[204:207], v[212:215]
    s_add_u32 s63, s63, 4096
    ds_read_b128 v[140:143], v12 offset:27648
    v_mfma_f32_16x16x32_bf16 v[216:219], v[144:147], a[192:195], v[216:219]
    buffer_load_dwordx4 v[36:39], v5, s[40:43], s20 offen offset:0 sc1
    v_mfma_f32_16x16x32_bf16 v[216:219], v[148:151], a[200:203], v[216:219]
    v_mfma_f32_16x16x32_bf16 v[220:223], v[144:147], a[196:199], v[220:223]
    ds_read_b128 v[144:147], v12 offset:20480
    v_mfma_f32_16x16x32_bf16 v[220:223], v[148:151], a[204:207], v[220:223]
    ds_read_b128 v[148:151], v12 offset:28672
    v_mfma_f32_16x16x32_bf16 v[224:227], v[104:107], a[192:195], v[224:227]
    s_waitcnt lgkmcnt(2)
    v_mfma_f32_16x16x32_bf16 v[224:227], v[108:111], a[200:203], v[224:227]
    buffer_load_dwordx4 v[44:47], v5, s[40:43], s20 offen offset:1024 sc1
    v_mfma_f32_16x16x32_bf16 v[228:231], v[104:107], a[196:199], v[228:231]
    ds_read_b128 v[104:107], v12 offset:21504
    v_mfma_f32_16x16x32_bf16 v[228:231], v[108:111], a[204:207], v[228:231]
    ds_read_b128 v[108:111], v12 offset:29696
    v_mfma_f32_16x16x32_bf16 v[176:179], v[112:115], a[208:211], v[176:179]
    v_mfma_f32_16x16x32_bf16 v[176:179], v[116:119], a[216:219], v[176:179]
    buffer_load_dwordx4 v[52:55], v5, s[40:43], s20 offen offset:2048 sc1
    v_mfma_f32_16x16x32_bf16 v[180:183], v[112:115], a[212:215], v[180:183]
    ds_read_b128 v[112:115], v12 offset:22528
    v_mfma_f32_16x16x32_bf16 v[180:183], v[116:119], a[220:223], v[180:183]
    ds_read_b128 v[116:119], v12 offset:30720
    v_mfma_f32_16x16x32_bf16 v[184:187], v[120:123], a[208:211], v[184:187]
    v_mfma_f32_16x16x32_bf16 v[184:187], v[124:127], a[216:219], v[184:187]
    buffer_load_dwordx4 v[60:63], v5, s[40:43], s20 offen offset:3072 sc1
    v_mfma_f32_16x16x32_bf16 v[188:191], v[120:123], a[212:215], v[188:191]
    s_mul_i32 s21, s61, 6
    s_lshr_b32 s64, s4, 1
    s_add_u32 s21, s21, s64
    v_mfma_f32_16x16x32_bf16 v[188:191], v[124:127], a[220:223], v[188:191]
    s_add_u32 s21, s21, 132
    s_mul_i32 s21, s21, 36864
    v_mfma_f32_16x16x32_bf16 v[192:195], v[128:131], a[208:211], v[192:195]
    s_add_u32 s21, s21, s28
    s_and_b32 s64, s69, 4096
    v_mfma_f32_16x16x32_bf16 v[192:195], v[132:135], a[216:219], v[192:195]
    s_add_u32 s21, s21, s64
    s_mov_b32 m0, s79
    v_mfma_f32_16x16x32_bf16 v[196:199], v[128:131], a[212:215], v[196:199]
    s_add_u32 s20, s20, 4096
    buffer_load_dwordx4 v1, s[56:59], s21 offen sc1 lds
    v_mfma_f32_16x16x32_bf16 v[196:199], v[132:135], a[220:223], v[196:199]
    v_mfma_f32_16x16x32_bf16 v[200:203], v[136:139], a[208:211], v[200:203]
    v_mfma_f32_16x16x32_bf16 v[200:203], v[140:143], a[216:219], v[200:203]
    buffer_load_dwordx4 v1, s[56:59], s21 offen offset:1024 sc1 lds
    v_mfma_f32_16x16x32_bf16 v[204:207], v[136:139], a[212:215], v[204:207]
    v_mfma_f32_16x16x32_bf16 v[204:207], v[140:143], a[220:223], v[204:207]
    s_waitcnt vmcnt(17)
    s_barrier
    ds_read_b128 v[120:123], v13 offset:0
    s_waitcnt lgkmcnt(1)
    v_mfma_f32_16x16x32_bf16 v[208:211], v[144:147], a[208:211], v[208:211]
    ds_read_b128 v[124:127], v13 offset:8192
    ds_read_b128 v[128:131], v13 offset:1024
    v_mfma_f32_16x16x32_bf16 v[208:211], v[148:151], a[216:219], v[208:211]
    ds_read_b128 v[132:135], v13 offset:9216
    v_mfma_f32_16x16x32_bf16 v[212:215], v[144:147], a[212:215], v[212:215]
    buffer_load_dwordx4 v1, s[56:59], s21 offen offset:2048 sc1 lds
    v_mfma_f32_16x16x32_bf16 v[212:215], v[148:151], a[220:223], v[212:215]
    ds_read_b128 v[136:139], v13 offset:2048
    ds_read_b128 v[140:143], v13 offset:10240
    v_mfma_f32_16x16x32_bf16 v[216:219], v[104:107], a[208:211], v[216:219]
    ds_read_b128 v[144:147], v13 offset:3072
    v_mfma_f32_16x16x32_bf16 v[216:219], v[108:111], a[216:219], v[216:219]
    ds_read_b128 v[148:151], v13 offset:11264
    v_mfma_f32_16x16x32_bf16 v[220:223], v[104:107], a[212:215], v[220:223]
    buffer_load_dwordx4 v1, s[56:59], s21 offen offset:3072 sc1 lds
    v_mfma_f32_16x16x32_bf16 v[220:223], v[108:111], a[220:223], v[220:223]
    ds_read_b128 v[104:107], v13 offset:4096
    ds_read_b128 v[108:111], v13 offset:12288
    v_mfma_f32_16x16x32_bf16 v[224:227], v[112:115], a[208:211], v[224:227]
    v_mfma_f32_16x16x32_bf16 v[224:227], v[116:119], a[216:219], v[224:227]
    v_mfma_f32_16x16x32_bf16 v[228:231], v[112:115], a[212:215], v[228:231]
    buffer_load_dwordx4 v[64:67], v4, s[40:43], s63 offen offset:0 sc1
    v_mfma_f32_16x16x32_bf16 v[228:231], v[116:119], a[220:223], v[228:231]
    s_waitcnt lgkmcnt(2)
    ds_read_b128 v[112:115], v13 offset:5120
    ds_read_b128 v[116:119], v13 offset:13312
    v_mfma_f32_16x16x32_bf16 v[176:179], v[120:123], a[224:227], v[176:179]
    s_add_u32 s23, s5, 8
    v_lshrrev_b32 v19, 4, v1
    v_min_u32 v19, 2, v19
    v_mfma_f32_16x16x32_bf16 v[176:179], v[124:127], a[232:235], v[176:179]
    s_and_b32 s65, s5, 3
    v_lshl_add_u32 v19, v19, 3, s23
    v_bfe_u32 v20, v1, 4, 4
    v_mfma_f32_16x16x32_bf16 v[180:183], v[120:123], a[228:231], v[180:183]
    s_lshl3_add_u32 s23, s6, s62
    buffer_load_dwordx4 v[72:75], v4, s[40:43], s63 offen offset:1024 sc1
    v_mfma_f32_16x16x32_bf16 v[180:183], v[124:127], a[236:239], v[180:183]
    s_add_u32 s63, s63, 4096
    ds_read_b128 v[120:123], v13 offset:6144
    ds_read_b128 v[124:127], v13 offset:14336
    v_mfma_f32_16x16x32_bf16 v[184:187], v[128:131], a[224:227], v[184:187]
    s_lshl_b32 s23, s23, 4
    v_add_u32 v20, s23, v20
    v_mul_u32_u24 v20, 1152, v20
    v_mfma_f32_16x16x32_bf16 v[184:187], v[132:135], a[232:235], v[184:187]
    s_mul_i32 s23, s6, 294912
    v_lshrrev_b32 v21, 8, v1
    v_lshl_add_u32 v20, v21, 3, v20
    v_mfma_f32_16x16x32_bf16 v[188:191], v[128:131], a[228:231], v[188:191]
    s_sub_u32 s23, 2211840, s23
    buffer_load_dwordx4 v[68:71], v5, s[40:43], s20 offen offset:0 sc1
    v_mfma_f32_16x16x32_bf16 v[188:191], v[132:135], a[236:239], v[188:191]
    s_mul_i32 s70, s4, 3072
    ds_read_b128 v[128:131], v13 offset:16384
    ds_read_b128 v[132:135], v13 offset:24576
    v_mfma_f32_16x16x32_bf16 v[192:195], v[136:139], a[224:227], v[192:195]
    s_andn2_b32 s66, s74, 0xfff
    v_add_u32 v21, s23, v20
    v_and_b32 v19, 31, v19
    v_mfma_f32_16x16x32_bf16 v[192:195], v[140:143], a[232:235], v[192:195]
    s_mul_i32 s23, s101, 288
    v_mov_b32 v31, 3
    v_lshlrev_b32 v23, 20, v1
    v_mfma_f32_16x16x32_bf16 v[196:199], v[136:139], a[228:231], v[196:199]
    s_add_u32 s23, s23, s70
    ds_read_b128 v[136:139], v13 offset:17408
    v_lshlrev_b32 v19, 7, v19
    v_mfma_f32_16x16x32_bf16 v[196:199], v[140:143], a[236:239], v[196:199]
    buffer_load_dwordx4 v[76:79], v5, s[40:43], s20 offen offset:1024 sc1
    v_mfma_f32_16x16x32_bf16 v[200:203], v[144:147], a[224:227], v[200:203]
    s_add_u32 s21, s4, 0
    s_xor_b32 s21, s21, s3
    s_lshl_b32 s21, s21, 2
    v_mfma_f32_16x16x32_bf16 v[200:203], v[148:151], a[232:235], v[200:203]
    s_mul_i32 s21, s21, 36864
    ds_read_b128 v[140:143], v13 offset:25600
    v_mfma_f32_16x16x32_bf16 v[204:207], v[144:147], a[228:231], v[204:207]
    s_add_u32 s21, s21, s28
    ds_read_b128 v[144:147], v13 offset:18432
    v_mfma_f32_16x16x32_bf16 v[204:207], v[148:151], a[236:239], v[204:207]
    s_add_u32 s21, s21, 7168
    s_add_u32 m0, s44, 0
    ds_read_b128 v[148:151], v13 offset:26624
    s_waitcnt lgkmcnt(3)
    v_mfma_f32_16x16x32_bf16 v[208:211], v[104:107], a[224:227], v[208:211]
    s_add_u32 s20, s20, 4096
    buffer_load_dwordx4 v1, s[56:59], s21 offen sc1 lds
    v_mfma_f32_16x16x32_bf16 v[208:211], v[108:111], a[232:235], v[208:211]
    v_mfma_f32_16x16x32_bf16 v[212:215], v[104:107], a[228:231], v[212:215]
    ds_read_b128 v[104:107], v13 offset:19456
    v_mfma_f32_16x16x32_bf16 v[212:215], v[108:111], a[236:239], v[212:215]
    buffer_load_dwordx4 v1, s[56:59], s21 offen offset:1024 sc1 lds
    v_mfma_f32_16x16x32_bf16 v[216:219], v[112:115], a[224:227], v[216:219]
    s_add_u32 s21, s21, 36864
    ds_read_b128 v[108:111], v13 offset:27648
    v_mfma_f32_16x16x32_bf16 v[216:219], v[116:119], a[232:235], v[216:219]
    s_add_u32 m0, s44, 2048
    v_mfma_f32_16x16x32_bf16 v[220:223], v[112:115], a[228:231], v[220:223]
    ds_read_b128 v[112:115], v13 offset:20480
    v_mfma_f32_16x16x32_bf16 v[220:223], v[116:119], a[236:239], v[220:223]
    buffer_load_dwordx4 v1, s[56:59], s21 offen sc1 lds
    v_mfma_f32_16x16x32_bf16 v[224:227], v[120:123], a[224:227], v[224:227]
    ds_read_b128 v[116:119], v13 offset:28672
    v_mfma_f32_16x16x32_bf16 v[224:227], v[124:127], a[232:235], v[224:227]
    v_mfma_f32_16x16x32_bf16 v[228:231], v[120:123], a[228:231], v[228:231]
    ds_read_b128 v[120:123], v13 offset:21504
    v_mfma_f32_16x16x32_bf16 v[228:231], v[124:127], a[236:239], v[228:231]
    buffer_load_dwordx4 v1, s[56:59], s21 offen offset:1024 sc1 lds
    v_mfma_f32_16x16x32_bf16 v[176:179], v[128:131], a[240:243], v[176:179]
    ds_read_b128 v[124:127], v13 offset:29696
    v_mfma_f32_16x16x32_bf16 v[176:179], v[132:135], a[248:251], v[176:179]
    s_add_u32 s21, s21, 36864
    v_mfma_f32_16x16x32_bf16 v[180:183], v[128:131], a[244:247], v[180:183]
    s_add_u32 m0, s44, 4096
    ds_read_b128 v[128:131], v13 offset:22528
    v_mfma_f32_16x16x32_bf16 v[180:183], v[132:135], a[252:255], v[180:183]
    ds_read_b128 v[132:135], v13 offset:30720
    v_mfma_f32_16x16x32_bf16 v[184:187], v[136:139], a[240:243], v[184:187]
    s_waitcnt lgkmcnt(3)
    buffer_load_dwordx4 v1, s[56:59], s21 offen sc1 lds
    v_mfma_f32_16x16x32_bf16 v[184:187], v[140:143], a[248:251], v[184:187]
    v_mfma_f32_16x16x32_bf16 v[188:191], v[136:139], a[244:247], v[188:191]
    v_mfma_f32_16x16x32_bf16 v[188:191], v[140:143], a[252:255], v[188:191]
    v_mfma_f32_16x16x32_bf16 v[192:195], v[144:147], a[240:243], v[192:195]
    buffer_load_dwordx4 v1, s[56:59], s21 offen offset:1024 sc1 lds
    v_mfma_f32_16x16x32_bf16 v[192:195], v[148:151], a[248:251], v[192:195]
    s_add_u32 s21, s21, 36864
    v_mfma_f32_16x16x32_bf16 v[196:199], v[144:147], a[244:247], v[196:199]
    s_add_u32 m0, s44, 6144
    v_mfma_f32_16x16x32_bf16 v[196:199], v[148:151], a[252:255], v[196:199]
    v_mfma_f32_16x16x32_bf16 v[200:203], v[104:107], a[240:243], v[200:203]
    buffer_load_dwordx4 v1, s[56:59], s21 offen sc1 lds
    v_mfma_f32_16x16x32_bf16 v[200:203], v[108:111], a[248:251], v[200:203]
    v_mfma_f32_16x16x32_bf16 v[204:207], v[104:107], a[244:247], v[204:207]
    v_mfma_f32_16x16x32_bf16 v[204:207], v[108:111], a[252:255], v[204:207]
    s_waitcnt vmcnt(15)
    s_barrier
    ds_read_b128 v[136:139], v6 offset:0
    v_mfma_f32_16x16x32_bf16 v[208:211], v[112:115], a[240:243], v[208:211]
    buffer_load_dwordx4 v1, s[56:59], s21 offen offset:1024 sc1 lds
    v_mfma_f32_16x16x32_bf16 v[208:211], v[116:119], a[248:251], v[208:211]
    s_add_u32 s21, s21, 36864
    s_add_u32 s21, s4, 4
    s_xor_b32 s21, s21, s3
    v_mfma_f32_16x16x32_bf16 v[212:215], v[112:115], a[244:247], v[212:215]
    s_lshl_b32 s21, s21, 2
    s_mul_i32 s21, s21, 36864
    ds_read_b128 v[140:143], v6 offset:8192
    v_mfma_f32_16x16x32_bf16 v[212:215], v[116:119], a[252:255], v[212:215]
    s_add_u32 s21, s21, s28
    ds_read_b128 v[144:147], v6 offset:1024
    ds_read_b128 v[148:151], v6 offset:9216
    v_mfma_f32_16x16x32_bf16 v[216:219], v[120:123], a[240:243], v[216:219]
    s_add_u32 s21, s21, 7168
    s_add_u32 m0, s45, 0
    ds_read_b128 v[104:107], v6 offset:2048
    s_waitcnt lgkmcnt(4)
    v_mfma_f32_16x16x32_bf16 v[216:219], v[124:127], a[248:251], v[216:219]
    buffer_load_dwordx4 v1, s[56:59], s21 offen sc1 lds
    v_mfma_f32_16x16x32_bf16 v[220:223], v[120:123], a[244:247], v[220:223]
    ds_read_b128 v[108:111], v6 offset:10240
    ds_read_b128 v[112:115], v6 offset:3072
    v_mfma_f32_16x16x32_bf16 v[220:223], v[124:127], a[252:255], v[220:223]
    ds_read_b128 v[116:119], v6 offset:11264
    v_mfma_f32_16x16x32_bf16 v[224:227], v[128:131], a[240:243], v[224:227]
    ds_read_b128 v[120:123], v6 offset:4096
    v_mfma_f32_16x16x32_bf16 v[224:227], v[132:135], a[248:251], v[224:227]
    buffer_load_dwordx4 v1, s[56:59], s21 offen offset:1024 sc1 lds
    v_mfma_f32_16x16x32_bf16 v[228:231], v[128:131], a[244:247], v[228:231]
    s_add_u32 s21, s21, 36864
    ds_read_b128 v[124:127], v6 offset:12288
    ds_read_b128 v[128:131], v6 offset:5120
    v_mfma_f32_16x16x32_bf16 v[228:231], v[132:135], a[252:255], v[228:231]
    s_add_u32 m0, s45, 2048
    ds_read_b128 v[132:135], v6 offset:13312
    v_mfma_f32_16x16x32_bf16 v[176:179], v[136:139], v[32:35], v[176:179]
    s_waitcnt lgkmcnt(4)
    v_mfma_f32_16x16x32_bf16 v[176:179], v[140:143], v[40:43], v[176:179]
    buffer_load_dwordx4 v1, s[56:59], s21 offen sc1 lds
    v_mfma_f32_16x16x32_bf16 v[180:183], v[136:139], v[36:39], v[180:183]
    ds_read_b128 v[136:139], v6 offset:6144
    v_mfma_f32_16x16x32_bf16 v[180:183], v[140:143], v[44:47], v[180:183]
    ds_read_b128 v[140:143], v6 offset:14336
    v_mfma_f32_16x16x32_bf16 v[184:187], v[144:147], v[32:35], v[184:187]
    v_mfma_f32_16x16x32_bf16 v[184:187], v[148:151], v[40:43], v[184:187]
    buffer_load_dwordx4 v1, s[56:59], s21 offen offset:1024 sc1 lds
    v_mfma_f32_16x16x32_bf16 v[188:191], v[144:147], v[36:39], v[188:191]
    s_add_u32 s21, s21, 36864
    ds_read_b128 v[144:147], v6 offset:16384
    v_mfma_f32_16x16x32_bf16 v[188:191], v[148:151], v[44:47], v[188:191]
    s_add_u32 m0, s45, 4096
    ds_read_b128 v[148:151], v6 offset:24576
    v_mfma_f32_16x16x32_bf16 v[192:195], v[104:107], v[32:35], v[192:195]
    v_mfma_f32_16x16x32_bf16 v[192:195], v[108:111], v[40:43], v[192:195]
    buffer_load_dwordx4 v1, s[56:59], s21 offen sc1 lds
    v_mfma_f32_16x16x32_bf16 v[196:199], v[104:107], v[36:39], v[196:199]
    v_mfma_f32_16x16x32_bf16 v[196:199], v[108:111], v[44:47], v[196:199]
    v_mfma_f32_16x16x32_bf16 v[200:203], v[112:115], v[32:35], v[200:203]
    v_mfma_f32_16x16x32_bf16 v[200:203], v[116:119], v[40:43], v[200:203]
    buffer_load_dwordx4 v1, s[56:59], s21 offen offset:1024 sc1 lds
    v_mfma_f32_16x16x32_bf16 v[204:207], v[112:115], v[36:39], v[204:207]
    ds_read_b128 v[112:115], v6 offset:17408
    v_mfma_f32_16x16x32_bf16 v[204:207], v[116:119], v[44:47], v[204:207]
    s_waitcnt vmcnt(14)
    s_barrier
    ds_read_b128 v[104:107], v7 offset:0
    s_waitcnt lgkmcnt(2)
    v_mfma_f32_16x16x32_bf16 v[208:211], v[120:123], v[32:35], v[208:211]
    s_add_u32 s21, s21, 36864
    ds_read_b128 v[108:111], v7 offset:16384
    ds_read_b128 v[116:119], v6 offset:25600
    v_mfma_f32_16x16x32_bf16 v[208:211], v[124:127], v[40:43], v[208:211]
    s_add_u32 m0, s45, 6144
    v_mfma_f32_16x16x32_bf16 v[212:215], v[120:123], v[36:39], v[212:215]
    buffer_load_dwordx4 v1, s[56:59], s21 offen sc1 lds
    v_mfma_f32_16x16x32_bf16 v[212:215], v[124:127], v[44:47], v[212:215]
    ds_read_b128 v[120:123], v7 offset:1024
    ds_read_b128 v[124:127], v7 offset:17408
    v_mfma_f32_16x16x32_bf16 v[216:219], v[128:131], v[32:35], v[216:219]
    v_mfma_f32_16x16x32_bf16 v[216:219], v[132:135], v[40:43], v[216:219]
    v_mfma_f32_16x16x32_bf16 v[220:223], v[128:131], v[36:39], v[220:223]
    buffer_load_dwordx4 v1, s[56:59], s21 offen offset:1024 sc1 lds
    v_mfma_f32_16x16x32_bf16 v[220:223], v[132:135], v[44:47], v[220:223]
    s_add_u32 s21, s21, 36864
    ds_read_b128 v[128:131], v6 offset:18432
    ds_read_b128 v[132:135], v6 offset:26624
    v_mfma_f32_16x16x32_bf16 v[224:227], v[136:139], v[32:35], v[224:227]
    v_mfma_f32_16x16x32_bf16 v[224:227], v[140:143], v[40:43], v[224:227]
    v_mfma_f32_16x16x32_bf16 v[228:231], v[136:139], v[36:39], v[228:231]
    ds_read_b128 v[136:139], v7 offset:2048
    v_mfma_f32_16x16x32_bf16 v[228:231], v[140:143], v[44:47], v[228:231]
    ds_read_b128 v[140:143], v7 offset:18432
    v_mfma_f32_16x16x32_bf16 v[176:179], v[144:147], v[48:51], v[176:179]
    v_mfma_f32_16x16x32_bf16 v[176:179], v[148:151], v[56:59], v[176:179]
    s_waitcnt lgkmcnt(2)
    v_mfma_f32_16x16x32_bf16 v[176:179], v[104:107], v[64:67], v[176:179]
    v_mfma_f32_16x16x32_bf16 v[176:179], v[108:111], v[72:75], v[176:179]
    v_mfma_f32_16x16x32_bf16 v[180:183], v[144:147], v[52:55], v[180:183]
    ds_read_b128 v[144:147], v6 offset:19456
    v_mfma_f32_16x16x32_bf16 v[180:183], v[148:151], v[60:63], v[180:183]
    ds_read_b128 v[148:151], v6 offset:27648
    v_mfma_f32_16x16x32_bf16 v[180:183], v[104:107], v[68:71], v[180:183]
    ds_read_b128 v[104:107], v7 offset:3072
    v_mfma_f32_16x16x32_bf16 v[180:183], v[108:111], v[76:79], v[180:183]
    ds_read_b128 v[108:111], v7 offset:19456
    v_cvt_pk_bf16_f32 v232, v176, v177
    v_mfma_f32_16x16x32_bf16 v[184:187], v[112:115], v[48:51], v[184:187]
    v_cvt_pk_bf16_f32 v233, v178, v179
    v_mfma_f32_16x16x32_bf16 v[184:187], v[116:119], v[56:59], v[184:187]
    v_mfma_f32_16x16x32_bf16 v[184:187], v[120:123], v[64:67], v[184:187]
    v_mfma_f32_16x16x32_bf16 v[184:187], v[124:127], v[72:75], v[184:187]
    v_mfma_f32_16x16x32_bf16 v[188:191], v[112:115], v[52:55], v[188:191]
    v_cvt_pk_bf16_f32 v234, v180, v181
    v_cvt_pk_bf16_f32 v235, v182, v183
    v_mfma_f32_16x16x32_bf16 v[188:191], v[116:119], v[60:63], v[188:191]
    buffer_store_dwordx4 v[232:235], v1, s[48:51], s8 offen offset:0 sc1
    v_mfma_f32_16x16x32_bf16 v[188:191], v[120:123], v[68:71], v[188:191]
    ds_read_b128 v[112:115], v6 offset:20480
    ds_read_b128 v[116:119], v6 offset:28672
    v_mfma_f32_16x16x32_bf16 v[188:191], v[124:127], v[76:79], v[188:191]
    v_cvt_pk_bf16_f32 v236, v184, v185
    v_cvt_pk_bf16_f32 v237, v186, v187
    v_mfma_f32_16x16x32_bf16 v[192:195], v[128:131], v[48:51], v[192:195]
    ds_read_b128 v[120:123], v7 offset:8192
    ds_read_b128 v[124:127], v7 offset:24576
    v_mfma_f32_16x16x32_bf16 v[192:195], v[132:135], v[56:59], v[192:195]
    s_waitcnt lgkmcnt(4)
    v_mfma_f32_16x16x32_bf16 v[192:195], v[136:139], v[64:67], v[192:195]
    v_mfma_f32_16x16x32_bf16 v[192:195], v[140:143], v[72:75], v[192:195]
    v_cvt_pk_bf16_f32 v238, v188, v189
    v_cvt_pk_bf16_f32 v239, v190, v191
    v_mfma_f32_16x16x32_bf16 v[196:199], v[128:131], v[52:55], v[196:199]
    buffer_store_dwordx4 v[236:239], v1, s[48:51], s8 offen offset:1024 sc1
    v_mfma_f32_16x16x32_bf16 v[196:199], v[132:135], v[60:63], v[196:199]
    ds_read_b128 v[128:131], v6 offset:21504
    ds_read_b128 v[132:135], v6 offset:29696
    v_mfma_f32_16x16x32_bf16 v[196:199], v[136:139], v[68:71], v[196:199]
    v_cvt_pk_bf16_f32 v240, v192, v193
    v_cvt_pk_bf16_f32 v241, v194, v195
    v_mfma_f32_16x16x32_bf16 v[196:199], v[140:143], v[76:79], v[196:199]
    ds_read_b128 v[136:139], v7 offset:9216
    ds_read_b128 v[140:143], v7 offset:25600
    v_mfma_f32_16x16x32_bf16 v[200:203], v[144:147], v[48:51], v[200:203]
    v_mfma_f32_16x16x32_bf16 v[200:203], v[148:151], v[56:59], v[200:203]
    v_mfma_f32_16x16x32_bf16 v[200:203], v[104:107], v[64:67], v[200:203]
    v_mfma_f32_16x16x32_bf16 v[200:203], v[108:111], v[72:75], v[200:203]
    v_mfma_f32_16x16x32_bf16 v[204:207], v[144:147], v[52:55], v[204:207]
    ds_read_b128 v[144:147], v6 offset:22528
    v_cvt_pk_bf16_f32 v242, v196, v197
    v_mfma_f32_16x16x32_bf16 v[204:207], v[148:151], v[60:63], v[204:207]
    v_cvt_pk_bf16_f32 v243, v198, v199
    ds_read_b128 v[148:151], v6 offset:30720
    v_mfma_f32_16x16x32_bf16 v[204:207], v[104:107], v[68:71], v[204:207]
    buffer_store_dwordx4 v[240:243], v1, s[48:51], s9 offen offset:0 sc1
    v_mfma_f32_16x16x32_bf16 v[204:207], v[108:111], v[76:79], v[204:207]
    s_waitcnt lgkmcnt(2)
    v_cvt_pk_bf16_f32 v244, v200, v201
    v_cvt_pk_bf16_f32 v245, v202, v203
    v_mfma_f32_16x16x32_bf16 v[208:211], v[112:115], v[48:51], v[208:211]
    ds_read_b128 v[104:107], v7 offset:10240
    ds_read_b128 v[108:111], v7 offset:26624
    v_mfma_f32_16x16x32_bf16 v[208:211], v[116:119], v[56:59], v[208:211]
    v_mfma_f32_16x16x32_bf16 v[208:211], v[120:123], v[64:67], v[208:211]
    v_mfma_f32_16x16x32_bf16 v[208:211], v[124:127], v[72:75], v[208:211]
    v_cvt_pk_bf16_f32 v246, v204, v205
    v_cvt_pk_bf16_f32 v247, v206, v207
    v_mfma_f32_16x16x32_bf16 v[212:215], v[112:115], v[52:55], v[212:215]
    buffer_store_dwordx4 v[244:247], v1, s[48:51], s9 offen offset:1024 sc1
    v_mfma_f32_16x16x32_bf16 v[212:215], v[116:119], v[60:63], v[212:215]
    v_mfma_f32_16x16x32_bf16 v[212:215], v[120:123], v[68:71], v[212:215]
    v_mfma_f32_16x16x32_bf16 v[212:215], v[124:127], v[76:79], v[212:215]
    v_mfma_f32_16x16x32_bf16 v[216:219], v[128:131], v[48:51], v[216:219]
    v_cvt_pk_bf16_f32 v232, v208, v209
    v_cvt_pk_bf16_f32 v233, v210, v211
    v_mfma_f32_16x16x32_bf16 v[216:219], v[132:135], v[56:59], v[216:219]
    v_mfma_f32_16x16x32_bf16 v[216:219], v[136:139], v[64:67], v[216:219]
    v_mfma_f32_16x16x32_bf16 v[216:219], v[140:143], v[72:75], v[216:219]
    s_waitcnt vmcnt(12)
    s_barrier
    v_cvt_pk_bf16_f32 v234, v212, v213
    v_mfma_f32_16x16x32_bf16 v[220:223], v[128:131], v[52:55], v[220:223]
    v_cvt_pk_bf16_f32 v235, v214, v215
    ds_read_b128 v[112:115], v11 offset:0
    v_mfma_f32_16x16x32_bf16 v[220:223], v[132:135], v[60:63], v[220:223]
    buffer_store_dwordx4 v[232:235], v1, s[48:51], s10 offen offset:0 sc1
    v_mfma_f32_16x16x32_bf16 v[220:223], v[136:139], v[68:71], v[220:223]
    ds_read_b128 v[116:119], v11 offset:2048
    ds_read_b128 v[120:123], v11 offset:4096
    v_mfma_f32_16x16x32_bf16 v[220:223], v[140:143], v[76:79], v[220:223]
    s_waitcnt lgkmcnt(3)
    ds_read_b128 v[124:127], v11 offset:6144
    v_cvt_pk_bf16_f32 v236, v216, v217
    v_mfma_f32_16x16x32_bf16 v[224:227], v[144:147], v[48:51], v[224:227]
    v_cvt_pk_bf16_f32 v237, v218, v219
    ds_read_b128 v[128:131], v11 offset:1024
    v_mfma_f32_16x16x32_bf16 v[224:227], v[148:151], v[56:59], v[224:227]
    ds_read_b128 v[132:135], v11 offset:3072
    v_mfma_f32_16x16x32_bf16 v[224:227], v[104:107], v[64:67], v[224:227]
    v_cvt_pk_bf16_f32 v238, v220, v221
    v_cvt_pk_bf16_f32 v239, v222, v223
    v_mfma_f32_16x16x32_bf16 v[224:227], v[108:111], v[72:75], v[224:227]
    buffer_store_dwordx4 v[236:239], v1, s[48:51], s10 offen offset:1024 sc1
    v_mfma_f32_16x16x32_bf16 v[228:231], v[144:147], v[52:55], v[228:231]
    ds_read_b128 v[136:139], v11 offset:5120
    ds_read_b128 v[140:143], v11 offset:7168
    v_mfma_f32_16x16x32_bf16 v[228:231], v[148:151], v[60:63], v[228:231]
    ds_read_b128 v[144:147], v11 offset:8192
    v_mfma_f32_16x16x32_bf16 v[228:231], v[104:107], v[68:71], v[228:231]
    ds_read_b128 v[148:151], v11 offset:10240
    v_cvt_pk_bf16_f32 v240, v224, v225
    v_mfma_f32_16x16x32_bf16 v[228:231], v[108:111], v[76:79], v[228:231]
    s_waitcnt lgkmcnt(4)
    v_cvt_pk_bf16_f32 v241, v226, v227
    ds_read_b128 v[104:107], v11 offset:12288
    v_mfma_f32_16x16x32_bf16 v[160:163], v[112:115], a[0:3], 0
    ds_read_b128 v[108:111], v11 offset:14336
    v_mfma_f32_16x16x32_bf16 v[160:163], v[116:119], a[8:11], v[160:163]
    v_mfma_f32_16x16x32_bf16 v[160:163], v[120:123], a[16:19], v[160:163]
    v_mfma_f32_16x16x32_bf16 v[160:163], v[124:127], a[24:27], v[160:163]
    v_mfma_f32_16x16x32_bf16 v[164:167], v[112:115], a[4:7], 0
    v_cvt_pk_bf16_f32 v242, v228, v229
    v_cvt_pk_bf16_f32 v243, v230, v231
    v_mfma_f32_16x16x32_bf16 v[164:167], v[116:119], a[12:15], v[164:167]
    buffer_store_dwordx4 v[240:243], v1, s[48:51], s11 offen offset:2048 sc1
    v_mfma_f32_16x16x32_bf16 v[164:167], v[120:123], a[20:23], v[164:167]
    ds_read_b128 v[112:115], v11 offset:9216
    ds_read_b128 v[116:119], v11 offset:11264
    v_mfma_f32_16x16x32_bf16 v[164:167], v[124:127], a[28:31], v[164:167]
    ds_read_b128 v[120:123], v11 offset:13312
    v_mfma_f32_16x16x32_bf16 v[168:171], v[128:131], a[0:3], 0
    ds_read_b128 v[124:127], v11 offset:15360
    v_mfma_f32_16x16x32_bf16 v[168:171], v[132:135], a[8:11], v[168:171]
    s_waitcnt lgkmcnt(4)
    v_mfma_f32_16x16x32_bf16 v[168:171], v[136:139], a[16:19], v[168:171]
    v_mfma_f32_16x16x32_bf16 v[168:171], v[140:143], a[24:27], v[168:171]
    v_mfma_f32_16x16x32_bf16 v[172:175], v[128:131], a[4:7], 0
    ds_read_b128 v[128:131], v11 offset:16384
    v_mfma_f32_16x16x32_bf16 v[172:175], v[132:135], a[12:15], v[172:175]
    ds_read_b128 v[132:135], v11 offset:18432
    v_mfma_f32_16x16x32_bf16 v[172:175], v[136:139], a[20:23], v[172:175]
    ds_read_b128 v[136:139], v11 offset:20480
    v_mfma_f32_16x16x32_bf16 v[172:175], v[140:143], a[28:31], v[172:175]
    ds_read_b128 v[140:143], v11 offset:22528
    v_mfma_f32_16x16x32_bf16 v[160:163], v[144:147], a[32:35], v[160:163]
    v_mfma_f32_16x16x32_bf16 v[160:163], v[148:151], a[40:43], v[160:163]
    v_mfma_f32_16x16x32_bf16 v[160:163], v[104:107], a[48:51], v[160:163]
    v_mfma_f32_16x16x32_bf16 v[160:163], v[108:111], a[56:59], v[160:163]
    v_mfma_f32_16x16x32_bf16 v[164:167], v[144:147], a[36:39], v[164:167]
    ds_read_b128 v[144:147], v11 offset:17408
    v_mfma_f32_16x16x32_bf16 v[164:167], v[148:151], a[44:47], v[164:167]
    ds_read_b128 v[148:151], v11 offset:19456
    v_mfma_f32_16x16x32_bf16 v[164:167], v[104:107], a[52:55], v[164:167]
    ds_read_b128 v[104:107], v11 offset:21504
    v_mfma_f32_16x16x32_bf16 v[164:167], v[108:111], a[60:63], v[164:167]
    s_waitcnt lgkmcnt(3)
    ds_read_b128 v[108:111], v11 offset:23552
    v_mfma_f32_16x16x32_bf16 v[168:171], v[112:115], a[32:35], v[168:171]
    v_mfma_f32_16x16x32_bf16 v[168:171], v[116:119], a[40:43], v[168:171]
    v_mfma_f32_16x16x32_bf16 v[168:171], v[120:123], a[48:51], v[168:171]
    v_mfma_f32_16x16x32_bf16 v[168:171], v[124:127], a[56:59], v[168:171]
    v_mfma_f32_16x16x32_bf16 v[172:175], v[112:115], a[36:39], v[172:175]
    ds_read_b128 v[112:115], v11 offset:24576
    v_mfma_f32_16x16x32_bf16 v[172:175], v[116:119], a[44:47], v[172:175]
    ds_read_b128 v[116:119], v11 offset:26624
    v_mfma_f32_16x16x32_bf16 v[172:175], v[120:123], a[52:55], v[172:175]
    ds_read_b128 v[120:123], v11 offset:28672
    v_mfma_f32_16x16x32_bf16 v[172:175], v[124:127], a[60:63], v[172:175]
    ds_read_b128 v[124:127], v11 offset:30720
    v_mfma_f32_16x16x32_bf16 v[160:163], v[128:131], a[64:67], v[160:163]
    v_mfma_f32_16x16x32_bf16 v[160:163], v[132:135], a[72:75], v[160:163]
    v_mfma_f32_16x16x32_bf16 v[160:163], v[136:139], a[80:83], v[160:163]
    v_mfma_f32_16x16x32_bf16 v[160:163], v[140:143], a[88:91], v[160:163]
    v_mfma_f32_16x16x32_bf16 v[164:167], v[128:131], a[68:71], v[164:167]
    ds_read_b128 v[128:131], v11 offset:25600
    v_mfma_f32_16x16x32_bf16 v[164:167], v[132:135], a[76:79], v[164:167]
    ds_read_b128 v[132:135], v11 offset:27648
    v_mfma_f32_16x16x32_bf16 v[164:167], v[136:139], a[84:87], v[164:167]
    ds_read_b128 v[136:139], v11 offset:29696
    v_mfma_f32_16x16x32_bf16 v[164:167], v[140:143], a[92:95], v[164:167]
    s_waitcnt lgkmcnt(3)
    ds_read_b128 v[140:143], v11 offset:31744
    v_mfma_f32_16x16x32_bf16 v[168:171], v[144:147], a[64:67], v[168:171]
    v_mfma_f32_16x16x32_bf16 v[168:171], v[148:151], a[72:75], v[168:171]
    v_mfma_f32_16x16x32_bf16 v[168:171], v[104:107], a[80:83], v[168:171]
    v_mfma_f32_16x16x32_bf16 v[168:171], v[108:111], a[88:91], v[168:171]
    v_mfma_f32_16x16x32_bf16 v[172:175], v[144:147], a[68:71], v[172:175]
    v_mfma_f32_16x16x32_bf16 v[172:175], v[148:151], a[76:79], v[172:175]
    v_mfma_f32_16x16x32_bf16 v[172:175], v[104:107], a[84:87], v[172:175]
    v_mfma_f32_16x16x32_bf16 v[172:175], v[108:111], a[92:95], v[172:175]
    v_mfma_f32_16x16x32_bf16 v[160:163], v[112:115], a[96:99], v[160:163]
    v_mfma_f32_16x16x32_bf16 v[160:163], v[116:119], a[104:107], v[160:163]
    v_mfma_f32_16x16x32_bf16 v[160:163], v[120:123], a[112:115], v[160:163]
    s_waitcnt vmcnt(0)
    buffer_store_dword v31, v23, s[32:35], s74 offen sc1
    v_mfma_f32_16x16x32_bf16 v[160:163], v[124:127], a[120:123], v[160:163]
    s_waitcnt vmcnt(8)
    s_barrier
    ds_read_b128 v[144:147], v12 offset:0
    v_mfma_f32_16x16x32_bf16 v[164:167], v[112:115], a[100:103], v[164:167]
    ds_read_b128 v[148:151], v12 offset:2048
    ds_read_b128 v[104:107], v12 offset:4096
    v_mfma_f32_16x16x32_bf16 v[164:167], v[116:119], a[108:111], v[164:167]
    ds_read_b128 v[108:111], v12 offset:6144
    v_mfma_f32_16x16x32_bf16 v[164:167], v[120:123], a[116:119], v[164:167]
    ds_read_b128 v[112:115], v12 offset:1024
    v_mfma_f32_16x16x32_bf16 v[164:167], v[124:127], a[124:127], v[164:167]
    s_lshr_b32 s64, s4, 1
    s_lshl1_add_u32 s21, s61, s64
    s_mul_i32 s21, s21, 3
    s_waitcnt lgkmcnt(5)
    v_mfma_f32_16x16x32_bf16 v[168:171], v[128:131], a[96:99], v[168:171]
    s_add_u32 s21, s21, 128
    s_mul_i32 s21, s21, 36864
    s_add_u32 s21, s21, s28
    v_mfma_f32_16x16x32_bf16 v[168:171], v[132:135], a[104:107], v[168:171]
    s_add_u32 s21, s21, 7168
    s_and_b32 s64, s68, 1024
    s_add_u32 s21, s21, s64
    v_mfma_f32_16x16x32_bf16 v[168:171], v[136:139], a[112:115], v[168:171]
    s_add_u32 m0, s46, 0
    ds_read_b128 v[116:119], v12 offset:3072
    ds_read_b128 v[120:123], v12 offset:5120
    v_mfma_f32_16x16x32_bf16 v[168:171], v[140:143], a[120:123], v[168:171]
    s_lshl2_add_u32 s64, s61, s65
    buffer_load_dwordx4 v1, s[56:59], s21 offen sc1 lds
    v_mfma_f32_16x16x32_bf16 v[172:175], v[128:131], a[100:103], v[172:175]
    s_add_u32 s21, s21, 36864
    ds_read_b128 v[124:127], v12 offset:7168
    ds_read_b128 v[128:131], v12 offset:8192
    v_mfma_f32_16x16x32_bf16 v[172:175], v[132:135], a[108:111], v[172:175]
    s_add_u32 m0, s46, 1024
    ds_read_b128 v[132:135], v12 offset:10240
    s_lshl_b32 s65, s65, 5
    v_mfma_f32_16x16x32_bf16 v[172:175], v[136:139], a[116:119], v[172:175]
    s_add_u32 s65, s65, 1024
    buffer_load_dwordx4 v1, s[56:59], s21 offen sc1 lds
    v_mfma_f32_16x16x32_bf16 v[172:175], v[140:143], a[124:127], v[172:175]
    s_add_u32 s21, s21, 36864
    ds_read_b128 v[136:139], v12 offset:12288
    ds_read_b128 v[140:143], v12 offset:14336
    s_waitcnt lgkmcnt(5)
    v_mfma_f32_16x16x32_bf16 v[160:163], v[144:147], a[128:131], v[160:163]
    s_add_u32 m0, s46, 2048
    s_lshl_b32 s64, s64, 6
    v_mfma_f32_16x16x32_bf16 v[160:163], v[148:151], a[136:139], v[160:163]
    s_cmp_eq_u32 s4, s61
    s_cselect_b32 s65, s65, 1073741824
    s_cselect_b32 s70, s23, 1073741824
    v_mfma_f32_16x16x32_bf16 v[160:163], v[104:107], a[144:147], v[160:163]
    s_add_u32 s98, s70, 0
    buffer_load_dwordx4 v1, s[56:59], s21 offen sc1 lds
    v_mfma_f32_16x16x32_bf16 v[160:163], v[108:111], a[152:155], v[160:163]
    s_add_u32 s21, s21, 36864
    v_mfma_f32_16x16x32_bf16 v[164:167], v[144:147], a[132:135], v[164:167]
    ds_read_b128 v[144:147], v12 offset:9216
    v_mfma_f32_16x16x32_bf16 v[164:167], v[148:151], a[140:143], v[164:167]
    ds_read_b128 v[148:151], v12 offset:11264
    v_mfma_f32_16x16x32_bf16 v[164:167], v[104:107], a[148:151], v[164:167]
    ds_read_b128 v[104:107], v12 offset:13312
    v_mfma_f32_16x16x32_bf16 v[164:167], v[108:111], a[156:159], v[164:167]
    ds_read_b128 v[108:111], v12 offset:15360
    v_mfma_f32_16x16x32_bf16 v[168:171], v[112:115], a[128:131], v[168:171]
    v_mfma_f32_16x16x32_bf16 v[168:171], v[116:119], a[136:139], v[168:171]
    v_mfma_f32_16x16x32_bf16 v[168:171], v[120:123], a[144:147], v[168:171]
    s_waitcnt lgkmcnt(2)
    v_mfma_f32_16x16x32_bf16 v[168:171], v[124:127], a[152:155], v[168:171]
    v_mfma_f32_16x16x32_bf16 v[172:175], v[112:115], a[132:135], v[172:175]
    ds_read_b128 v[112:115], v12 offset:16384
    v_mfma_f32_16x16x32_bf16 v[172:175], v[116:119], a[140:143], v[172:175]
    ds_read_b128 v[116:119], v12 offset:18432
    v_mfma_f32_16x16x32_bf16 v[172:175], v[120:123], a[148:151], v[172:175]
    ds_read_b128 v[120:123], v12 offset:20480
    v_mfma_f32_16x16x32_bf16 v[172:175], v[124:127], a[156:159], v[172:175]
    ds_read_b128 v[124:127], v12 offset:22528
    v_mfma_f32_16x16x32_bf16 v[160:163], v[128:131], a[160:163], v[160:163]
    v_mfma_f32_16x16x32_bf16 v[160:163], v[132:135], a[168:171], v[160:163]
    v_mfma_f32_16x16x32_bf16 v[160:163], v[136:139], a[176:179], v[160:163]
    v_mfma_f32_16x16x32_bf16 v[160:163], v[140:143], a[184:187], v[160:163]
    v_mfma_f32_16x16x32_bf16 v[164:167], v[128:131], a[164:167], v[164:167]
    ds_read_b128 v[128:131], v12 offset:17408
    v_mfma_f32_16x16x32_bf16 v[164:167], v[132:135], a[172:175], v[164:167]
    buffer_load_dword v3, v19, s[32:35], s66 offen sc1
    v_mfma_f32_16x16x32_bf16 v[164:167], v[136:139], a[180:183], v[164:167]
    ds_read_b128 v[132:135], v12 offset:19456
    ds_read_b128 v[136:139], v12 offset:21504
    v_mfma_f32_16x16x32_bf16 v[164:167], v[140:143], a[188:191], v[164:167]
    ds_read_b128 v[140:143], v12 offset:23552
    v_mfma_f32_16x16x32_bf16 v[168:171], v[144:147], a[160:163], v[168:171]
    v_mfma_f32_16x16x32_bf16 v[168:171], v[148:151], a[168:171], v[168:171]
    s_waitcnt lgkmcnt(3)
    v_mfma_f32_16x16x32_bf16 v[168:171], v[104:107], a[176:179], v[168:171]
    v_mfma_f32_16x16x32_bf16 v[168:171], v[108:111], a[184:187], v[168:171]
    v_mfma_f32_16x16x32_bf16 v[172:175], v[144:147], a[164:167], v[172:175]
    ds_read_b128 v[144:147], v12 offset:24576
    v_mfma_f32_16x16x32_bf16 v[172:175], v[148:151], a[172:175], v[172:175]
    ds_read_b128 v[148:151], v12 offset:26624
    v_mfma_f32_16x16x32_bf16 v[172:175], v[104:107], a[180:183], v[172:175]
    ds_read_b128 v[104:107], v12 offset:28672
    v_mfma_f32_16x16x32_bf16 v[172:175], v[108:111], a[188:191], v[172:175]
    ds_read_b128 v[108:111], v12 offset:30720
    v_mfma_f32_16x16x32_bf16 v[160:163], v[112:115], a[192:195], v[160:163]
    v_mfma_f32_16x16x32_bf16 v[160:163], v[116:119], a[200:203], v[160:163]
    v_mfma_f32_16x16x32_bf16 v[160:163], v[120:123], a[208:211], v[160:163]
    v_mfma_f32_16x16x32_bf16 v[160:163], v[124:127], a[216:219], v[160:163]
    v_mfma_f32_16x16x32_bf16 v[164:167], v[112:115], a[196:199], v[164:167]
    ds_read_b128 v[112:115], v12 offset:25600
    v_mfma_f32_16x16x32_bf16 v[164:167], v[116:119], a[204:207], v[164:167]
    ds_read_b128 v[116:119], v12 offset:27648
    v_mfma_f32_16x16x32_bf16 v[164:167], v[120:123], a[212:215], v[164:167]
    ds_read_b128 v[120:123], v12 offset:29696
    v_mfma_f32_16x16x32_bf16 v[164:167], v[124:127], a[220:223], v[164:167]
    ds_read_b128 v[124:127], v12 offset:31744
    v_mfma_f32_16x16x32_bf16 v[168:171], v[128:131], a[192:195], v[168:171]
    s_waitcnt lgkmcnt(4)
    v_mfma_f32_16x16x32_bf16 v[168:171], v[132:135], a[200:203], v[168:171]
    v_mfma_f32_16x16x32_bf16 v[168:171], v[136:139], a[208:211], v[168:171]
    v_mfma_f32_16x16x32_bf16 v[168:171], v[140:143], a[216:219], v[168:171]
    v_mfma_f32_16x16x32_bf16 v[172:175], v[128:131], a[196:199], v[172:175]
    v_mfma_f32_16x16x32_bf16 v[172:175], v[132:135], a[204:207], v[172:175]
    v_mfma_f32_16x16x32_bf16 v[172:175], v[136:139], a[212:215], v[172:175]
    v_mfma_f32_16x16x32_bf16 v[172:175], v[140:143], a[220:223], v[172:175]
    v_mfma_f32_16x16x32_bf16 v[160:163], v[144:147], a[224:227], v[160:163]
    s_waitcnt vmcnt(0)
    v_cmp_gt_u32 vcc, 3, v3
    s_nop 1
    s_and_b64 vcc, vcc, exec
    s_cbranch_scc1 SPIN_X
BACK_X:
    v_mfma_f32_16x16x32_bf16 v[160:163], v[148:151], a[232:235], v[160:163]
    buffer_load_dwordx4 v[200:203], v1, s[48:51], s98 offen offset:2048 sc1
    v_mfma_f32_16x16x32_bf16 v[160:163], v[104:107], a[240:243], v[160:163]
    s_add_u32 s98, s70, 12288
    buffer_load_dwordx4 v[204:207], v1, s[48:51], s98 offen offset:2048 sc1
    v_mfma_f32_16x16x32_bf16 v[160:163], v[108:111], a[248:251], v[160:163]
    s_waitcnt vmcnt(3)
    s_barrier
    ds_read_b128 v[128:131], v13 offset:0
    v_mfma_f32_16x16x32_bf16 v[164:167], v[144:147], a[228:231], v[164:167]
    s_add_u32 s98, s70, 24576
    ds_read_b128 v[132:135], v13 offset:1024
    ds_read_b128 v[136:139], v13 offset:2048
    v_mfma_f32_16x16x32_bf16 v[164:167], v[148:151], a[236:239], v[164:167]
    buffer_load_dwordx4 v[208:211], v1, s[48:51], s98 offen offset:2048 sc1
    v_mfma_f32_16x16x32_bf16 v[164:167], v[104:107], a[244:247], v[164:167]
    s_add_u32 s98, s23, 0
    ds_read_b128 v[140:143], v13 offset:8192
    ds_read_b128 v[144:147], v13 offset:9216
    v_mfma_f32_16x16x32_bf16 v[164:167], v[108:111], a[252:255], v[164:167]
    s_waitcnt lgkmcnt(5)
    ds_read_b128 v[148:151], v13 offset:10240
    v_mfma_f32_16x16x32_bf16 v[168:171], v[112:115], a[224:227], v[168:171]
    ds_read_b128 v[104:107], v13 offset:16384
    v_mfma_f32_16x16x32_bf16 v[168:171], v[116:119], a[232:235], v[168:171]
    buffer_load_dwordx4 v[176:179], v1, s[48:51], s98 offen offset:0 sc1
    v_mfma_f32_16x16x32_bf16 v[168:171], v[120:123], a[240:243], v[168:171]
    s_add_u32 s98, s23, 12288
    ds_read_b128 v[108:111], v13 offset:17408
    v_mfma_f32_16x16x32_bf16 v[168:171], v[124:127], a[248:251], v[168:171]
    v_mfma_f32_16x16x32_bf16 v[172:175], v[112:115], a[228:231], v[172:175]
    ds_read_b128 v[112:115], v13 offset:18432
    v_mfma_f32_16x16x32_bf16 v[172:175], v[116:119], a[236:239], v[172:175]
    buffer_load_dwordx4 v[180:183], v1, s[48:51], s98 offen offset:0 sc1
    v_mfma_f32_16x16x32_bf16 v[172:175], v[120:123], a[244:247], v[172:175]
    s_add_u32 s98, s23, 24576
    ds_read_b128 v[116:119], v13 offset:24576
    ds_read_b128 v[120:123], v13 offset:25600
    v_mfma_f32_16x16x32_bf16 v[172:175], v[124:127], a[252:255], v[172:175]
    s_waitcnt lgkmcnt(3)
    ds_read_b128 v[124:127], v13 offset:26624
    v_mfma_f32_16x16x32_bf16 v[160:163], v[128:131], v[32:35], v[160:163]
    v_mfma_f32_16x16x32_bf16 v[160:163], v[132:135], v[40:43], v[160:163]
    buffer_load_dwordx4 v[184:187], v1, s[48:51], s98 offen offset:0 sc1
    v_mfma_f32_16x16x32_bf16 v[160:163], v[136:139], v[48:51], v[160:163]
    s_add_u32 s98, s23, 0
    v_mfma_f32_16x16x32_bf16 v[164:167], v[128:131], v[36:39], v[164:167]
    v_mfma_f32_16x16x32_bf16 v[164:167], v[132:135], v[44:47], v[164:167]
    v_mfma_f32_16x16x32_bf16 v[164:167], v[136:139], v[52:55], v[164:167]
    buffer_load_dwordx4 v[188:191], v1, s[48:51], s98 offen offset:1024 sc1
    v_mfma_f32_16x16x32_bf16 v[168:171], v[140:143], v[32:35], v[168:171]
    s_add_u32 s98, s23, 12288
    v_mfma_f32_16x16x32_bf16 v[168:171], v[144:147], v[40:43], v[168:171]
    v_mfma_f32_16x16x32_bf16 v[168:171], v[148:151], v[48:51], v[168:171]
    v_mfma_f32_16x16x32_bf16 v[172:175], v[140:143], v[36:39], v[172:175]
    buffer_load_dwordx4 v[192:195], v1, s[48:51], s98 offen offset:1024 sc1
    v_mfma_f32_16x16x32_bf16 v[172:175], v[144:147], v[44:47], v[172:175]
    s_add_u32 s98, s23, 24576
    v_mfma_f32_16x16x32_bf16 v[172:175], v[148:151], v[52:55], v[172:175]
    v_mfma_f32_16x16x32_bf16 v[160:163], v[104:107], v[56:59], v[160:163]
    v_mfma_f32_16x16x32_bf16 v[160:163], v[108:111], v[64:67], v[160:163]
    s_waitcnt lgkmcnt(0)
    buffer_load_dwordx4 v[196:199], v1, s[48:51], s98 offen offset:1024 sc1
    v_mfma_f32_16x16x32_bf16 v[160:163], v[112:115], v[72:75], v[160:163]
    v_mfma_f32_16x16x32_bf16 v[164:167], v[104:107], v[60:63], v[164:167]
    v_mfma_f32_16x16x32_bf16 v[164:167], v[108:111], v[68:71], v[164:167]
    v_mfma_f32_16x16x32_bf16 v[164:167], v[112:115], v[76:79], v[164:167]
    v_mfma_f32_16x16x32_bf16 v[168:171], v[116:119], v[56:59], v[168:171]
    v_mfma_f32_16x16x32_bf16 v[168:171], v[120:123], v[64:67], v[168:171]
    v_mfma_f32_16x16x32_bf16 v[168:171], v[124:127], v[72:75], v[168:171]
    v_mfma_f32_16x16x32_bf16 v[172:175], v[116:119], v[60:63], v[172:175]
    v_mfma_f32_16x16x32_bf16 v[172:175], v[120:123], v[68:71], v[172:175]
    v_mfma_f32_16x16x32_bf16 v[172:175], v[124:127], v[76:79], v[172:175]
    s_cmp_lg_u32 s4, s61
    s_cbranch_scc1 K1_X2
    s_waitcnt vmcnt(6)
    v_lshlrev_b32 v80, 16, v200
    v_and_b32 v81, 0xffff0000, v200
    v_lshlrev_b32 v82, 16, v204
    v_and_b32 v83, 0xffff0000, v204
    v_lshlrev_b32 v84, 16, v208
    v_and_b32 v85, 0xffff0000, v208
    v_pk_add_f32 v[80:81], v[80:81], v[82:83]
    v_pk_add_f32 v[224:225], v[224:225], v[84:85]
    v_pk_add_f32 v[224:225], v[224:225], v[80:81]
    v_cvt_pk_bf16_f32 v200, v224, v225
    v_lshlrev_b32 v86, 16, v201
    v_and_b32 v87, 0xffff0000, v201
    v_lshlrev_b32 v88, 16, v205
    v_and_b32 v89, 0xffff0000, v205
    v_lshlrev_b32 v90, 16, v209
    v_and_b32 v91, 0xffff0000, v209
    v_pk_add_f32 v[86:87], v[86:87], v[88:89]
    v_pk_add_f32 v[226:227], v[226:227], v[90:91]
    v_pk_add_f32 v[226:227], v[226:227], v[86:87]
    v_cvt_pk_bf16_f32 v201, v226, v227
    buffer_store_dwordx2 v[200:201], v20, s[24:27], s65 offen
    v_lshlrev_b32 v92, 16, v202
    v_and_b32 v93, 0xffff0000, v202
    v_lshlrev_b32 v94, 16, v206
    v_and_b32 v95, 0xffff0000, v206
    v_lshlrev_b32 v96, 16, v210
    v_and_b32 v97, 0xffff0000, v210
    v_pk_add_f32 v[92:93], v[92:93], v[94:95]
    v_pk_add_f32 v[228:229], v[228:229], v[96:97]
    v_pk_add_f32 v[228:229], v[228:229], v[92:93]
    v_cvt_pk_bf16_f32 v202, v228, v229
    v_lshlrev_b32 v98, 16, v203
    v_and_b32 v99, 0xffff0000, v203
    v_lshlrev_b32 v100, 16, v207
    v_and_b32 v101, 0xffff0000, v207
    v_lshlrev_b32 v102, 16, v211
    v_and_b32 v103, 0xffff0000, v211
    v_pk_add_f32 v[98:99], v[98:99], v[100:101]
    v_pk_add_f32 v[230:231], v[230:231], v[102:103]
    v_pk_add_f32 v[230:231], v[230:231], v[98:99]
    v_cvt_pk_bf16_f32 v203, v230, v231
    buffer_store_dwordx2 v[202:203], v21, s[24:27], s65 offen
    s_waitcnt vmcnt(2)
K1_X2:
    s_waitcnt vmcnt(3)
    v_lshlrev_b32 v80, 16, v176
    v_and_b32 v81, 0xffff0000, v176
    v_lshlrev_b32 v82, 16, v180
    v_and_b32 v83, 0xffff0000, v180
    v_lshlrev_b32 v84, 16, v184
    v_and_b32 v85, 0xffff0000, v184
    v_pk_add_f32 v[80:81], v[80:81], v[82:83]
    v_pk_add_f32 v[160:161], v[160:161], v[84:85]
    v_pk_add_f32 v[160:161], v[160:161], v[80:81]
    v_cvt_pk_bf16_f32 v176, v160, v161
    v_lshlrev_b32 v86, 16, v177
    v_and_b32 v87, 0xffff0000, v177
    v_lshlrev_b32 v88, 16, v181
    v_and_b32 v89, 0xffff0000, v181
    v_lshlrev_b32 v90, 16, v185
    v_and_b32 v91, 0xffff0000, v185
    v_pk_add_f32 v[86:87], v[86:87], v[88:89]
    v_pk_add_f32 v[162:163], v[162:163], v[90:91]
    v_pk_add_f32 v[162:163], v[162:163], v[86:87]
    v_cvt_pk_bf16_f32 v177, v162, v163
    buffer_store_dwordx2 v[176:177], v20, s[24:27], s64 offen
    v_lshlrev_b32 v92, 16, v178
    v_and_b32 v93, 0xffff0000, v178
    v_lshlrev_b32 v94, 16, v182
    v_and_b32 v95, 0xffff0000, v182
    v_lshlrev_b32 v96, 16, v186
    v_and_b32 v97, 0xffff0000, v186
    v_pk_add_f32 v[92:93], v[92:93], v[94:95]
    v_pk_add_f32 v[164:165], v[164:165], v[96:97]
    v_pk_add_f32 v[164:165], v[164:165], v[92:93]
    v_cvt_pk_bf16_f32 v178, v164, v165
    v_lshlrev_b32 v98, 16, v179
    v_and_b32 v99, 0xffff0000, v179
    v_lshlrev_b32 v100, 16, v183
    v_and_b32 v101, 0xffff0000, v183
    v_lshlrev_b32 v102, 16, v187
    v_and_b32 v103, 0xffff0000, v187
    v_pk_add_f32 v[98:99], v[98:99], v[100:101]
    v_pk_add_f32 v[166:167], v[166:167], v[102:103]
    v_pk_add_f32 v[166:167], v[166:167], v[98:99]
    v_cvt_pk_bf16_f32 v179, v166, v167
    buffer_store_dwordx2 v[178:179], v21, s[24:27], s64 offen
    s_waitcnt vmcnt(2)
    v_lshlrev_b32 v80, 16, v188
    v_and_b32 v81, 0xffff0000, v188
    v_lshlrev_b32 v82, 16, v192
    v_and_b32 v83, 0xffff0000, v192
    v_lshlrev_b32 v84, 16, v196
    v_and_b32 v85, 0xffff0000, v196
    v_pk_add_f32 v[80:81], v[80:81], v[82:83]
    v_pk_add_f32 v[168:169], v[168:169], v[84:85]
    v_pk_add_f32 v[168:169], v[168:169], v[80:81]
    v_cvt_pk_bf16_f32 v188, v168, v169
    v_lshlrev_b32 v86, 16, v189
    v_and_b32 v87, 0xffff0000, v189
    v_lshlrev_b32 v88, 16, v193
    v_and_b32 v89, 0xffff0000, v193
    v_lshlrev_b32 v90, 16, v197
    v_and_b32 v91, 0xffff0000, v197
    v_pk_add_f32 v[86:87], v[86:87], v[88:89]
    v_pk_add_f32 v[170:171], v[170:171], v[90:91]
    v_pk_add_f32 v[170:171], v[170:171], v[86:87]
    v_cvt_pk_bf16_f32 v189, v170, v171
    buffer_store_dwordx2 v[188:189], v20, s[24:27], s64 offen offset:32
    v_lshlrev_b32 v92, 16, v190
    v_and_b32 v93, 0xffff0000, v190
    v_lshlrev_b32 v94, 16, v194
    v_and_b32 v95, 0xffff0000, v194
    v_lshlrev_b32 v96, 16, v198
    v_and_b32 v97, 0xffff0000, v198
    v_pk_add_f32 v[92:93], v[92:93], v[94:95]
    v_pk_add_f32 v[172:173], v[172:173], v[96:97]
    v_pk_add_f32 v[172:173], v[172:173], v[92:93]
    v_cvt_pk_bf16_f32 v190, v172, v173
    v_lshlrev_b32 v98, 16, v191
    v_and_b32 v99, 0xffff0000, v191
    v_lshlrev_b32 v100, 16, v195
    v_and_b32 v101, 0xffff0000, v195
    v_lshlrev_b32 v102, 16, v199
    v_and_b32 v103, 0xffff0000, v199
    v_pk_add_f32 v[98:99], v[98:99], v[100:101]
    v_pk_add_f32 v[174:175], v[174:175], v[102:103]
    v_pk_add_f32 v[174:175], v[174:175], v[98:99]
    v_cvt_pk_bf16_f32 v191, v174, v175
    buffer_store_dwordx2 v[190:191], v21, s[24:27], s64 offen offset:32
K1_END:
    s_endpgm
K1_LB_MASK:
    buffer_load_dword v3, v29, s[32:35], s92 offen sc1
    s_nop 1
    v_add_f32 v212, s12, v144
    v_fma_f32 v176, v208, s8, v212
    v_fma_f32 v177, v209, s8, v212
    v_fma_f32 v178, v210, s8, v212
    v_fma_f32 v179, v211, s8, v212
    v_add_f32 v213, s13, v144
    v_fma_f32 v180, v208, s9, v213
    v_fma_f32 v181, v209, s9, v213
    v_fma_f32 v182, v210, s9, v213
    v_fma_f32 v183, v211, s9, v213
    v_add_f32 v214, s14, v144
    v_fma_f32 v184, v208, s10, v214
    v_fma_f32 v185, v209, s10, v214
    v_fma_f32 v186, v210, s10, v214
    v_fma_f32 v187, v211, s10, v214
    v_add_f32 v215, s15, v144
    v_fma_f32 v188, v208, s11, v215
    v_fma_f32 v189, v209, s11, v215
    v_fma_f32 v190, v210, s11, v215
    v_fma_f32 v191, v211, s11, v215
    s_nop 1
    s_branch K1_LB_BACK
K1_LS_MASK:
    s_cmp_eq_u32 s78, 1
    s_cbranch_scc1 K1_LS_LAST
    buffer_load_dword v3, v29, s[32:35], s92 offen sc1
    v_mov_b32 v218, 1
    s_cmp_eq_u64 s[84:85], 0
    s_cselect_b32 s7, s74, 1073741824
    s_cmp_lg_u32 s83, 0
    s_cselect_b32 s7, s74, s7
    s_waitcnt vmcnt(9)
    buffer_store_dword v218, v216, s[32:35], s7 offen sc1
    s_branch K1_LS_BACK
K1_LS_LAST:
    v_cmp_gt_u32 vcc, 1, v3
    s_nop 1
    s_cmp_lg_u32 vcc_lo, 0
    s_cbranch_scc1 SPIN_W0
BACK_W0:
    s_mov_b64 s[36:37], s[56:57]
    s_mov_b32 s38, 5603328
    s_xor_b32 s77, s3, 0
    s_lshl2_add_u32 s77, s77, s4
    s_mul_i32 s77, s77, 36864
    s_add_u32 s77, s77, s28
    s_nop 1
    v_add_f32 v212, s12, v152
    v_fma_f32 v176, v208, s8, v212
    v_fma_f32 v177, v209, s8, v212
    v_fma_f32 v178, v210, s8, v212
    v_fma_f32 v179, v211, s8, v212
    v_add_f32 v213, s13, v152
    v_fma_f32 v180, v208, s9, v213
    v_fma_f32 v181, v209, s9, v213
    v_fma_f32 v182, v210, s9, v213
    v_fma_f32 v183, v211, s9, v213
    v_add_f32 v214, s14, v152
    v_fma_f32 v184, v208, s10, v214
    v_fma_f32 v185, v209, s10, v214
    v_fma_f32 v186, v210, s10, v214
    v_fma_f32 v187, v211, s10, v214
    v_add_f32 v215, s15, v152
    v_fma_f32 v188, v208, s11, v215
    v_fma_f32 v189, v209, s11, v215
    v_fma_f32 v190, v210, s11, v215
    v_fma_f32 v191, v211, s11, v215
    s_nop 1
    s_branch K1_LS_BACK
K1_S7:
    v_mov_b32 v218, 1
    s_cmp_eq_u64 s[84:85], 0
    s_cselect_b32 s7, s74, 1073741824
    s_cmp_lg_u32 s83, 0
    s_cselect_b32 s7, s74, s7
    s_waitcnt vmcnt(8)
    buffer_store_dword v218, v216, s[32:35], s7 offen sc1
    s_branch K1_S7_BACK
K1_J7:
    v_cmp_gt_u32 vcc, 1, v3
    s_nop 1
    s_cmp_lg_u32 vcc_lo, 0
    s_cbranch_scc1 SPIN_W7
BACK_W7:
    s_mov_b64 s[36:37], s[56:57]
    s_mov_b32 s38, 5603328
    s_xor_b32 s77, s3, 0
    s_lshl2_add_u32 s77, s77, s4
    s_mul_i32 s77, s77, 36864
    s_add_u32 s77, s77, s28
    s_branch K1_J7_BACK
K1_REDO:
    s_mov_b32 s83, 1
    s_mov_b32 s63, 1073741824
    s_mov_b32 s64, 1073741824
    s_mov_b32 s62, 1073741824
    s_mul_i32 s7, s5, 1081344
    s_sub_u32 s7, 56623104, s7
    s_sub_u32 s36, s56, s7
    s_subb_u32 s37, s57, 0
    s_mov_b32 s38, 1081344
    s_mov_b32 s50, 0
    s_mov_b32 s54, 0
    s_waitcnt vmcnt(0) lgkmcnt(0)
    s_barrier
    v_lshrrev_b32 v92, 4, v1
    v_and_b32 v64, 15, v92
    v_lshrrev_b32 v92, 4, v92
    v_lshlrev_b32 v92, 2, v92
    v_sub_u32 v92, v64, v92
    s_lshl_b32 s98, s4, 4
    v_add_u32 v92, s98, v92
    s_lshl_b32 s98, s6, 7
    s_sub_u32 s99, 1920, s98
    v_add_u32 v64, s98, v92
    v_add_u32 v65, 64, v64
    v_add_u32 v66, s99, v92
    v_add_u32 v67, 64, v66
    v_mov_b32 v93, 0xf149f2ca
    v_mov_b32 v68, v93
    v_mov_b32 v69, v93
    v_mov_b32 v70, v93
    v_mov_b32 v71, v93
    s_mov_b32 s78, 0
    s_add_u32 s99, s99, 128
K1_REDO_L:
    s_lshr_b32 s7, s78, 6
    s_lshl_b32 s7, s7, 15
    s_bfe_u32 s98, s78, 0x20004
    s_lshl_b32 s98, s98, 12
    s_add_u32 s7, s7, s98
    buffer_load_dwordx4 v[72:75], v1, s[36:39], s7 offen offset:0 sc1
    buffer_load_dwordx4 v[76:79], v1, s[36:39], s7 offen offset:1024 sc1
    buffer_load_dwordx4 v[80:83], v1, s[36:39], s7 offen offset:2048 sc1
    buffer_load_dwordx4 v[84:87], v1, s[36:39], s7 offen offset:3072 sc1
    s_waitcnt vmcnt(0)
    v_mfma_f32_16x16x32_bf16 v[88:91], v[72:75], v[128:131], 0
    v_mfma_f32_16x16x32_bf16 v[88:91], v[76:79], v[160:163], v[88:91]
    v_mfma_f32_16x16x32_bf16 v[88:91], v[80:83], v[192:195], v[88:91]
    v_mfma_f32_16x16x32_bf16 v[88:91], v[84:87], v[224:227], v[88:91]
    v_subrev_u32 v92, s78, v64
    v_cmp_le_i32 vcc, 0, v92
    s_nop 5
    v_cndmask_b32 v88, v93, v88, vcc
    v_max_f32 v68, v68, v88
    v_cmp_le_i32 vcc, 1, v92
    s_nop 1
    v_cndmask_b32 v89, v93, v89, vcc
    v_max_f32 v68, v68, v89
    v_cmp_le_i32 vcc, 2, v92
    s_nop 1
    v_cndmask_b32 v90, v93, v90, vcc
    v_max_f32 v68, v68, v90
    v_cmp_le_i32 vcc, 3, v92
    s_nop 1
    v_cndmask_b32 v91, v93, v91, vcc
    v_max_f32 v68, v68, v91
    v_mfma_f32_16x16x32_bf16 v[88:91], v[72:75], v[132:135], 0
    v_mfma_f32_16x16x32_bf16 v[88:91], v[76:79], v[164:167], v[88:91]
    v_mfma_f32_16x16x32_bf16 v[88:91], v[80:83], v[196:199], v[88:91]
    v_mfma_f32_16x16x32_bf16 v[88:91], v[84:87], v[228:231], v[88:91]
    v_subrev_u32 v92, s78, v65
    v_cmp_le_i32 vcc, 0, v92
    s_nop 5
    v_cndmask_b32 v88, v93, v88, vcc
    v_max_f32 v69, v69, v88
    v_cmp_le_i32 vcc, 1, v92
    s_nop 1
    v_cndmask_b32 v89, v93, v89, vcc
    v_max_f32 v69, v69, v89
    v_cmp_le_i32 vcc, 2, v92
    s_nop 1
    v_cndmask_b32 v90, v93, v90, vcc
    v_max_f32 v69, v69, v90
    v_cmp_le_i32 vcc, 3, v92
    s_nop 1
    v_cndmask_b32 v91, v93, v91, vcc
    v_max_f32 v69, v69, v91
    v_mfma_f32_16x16x32_bf16 v[88:91], v[72:75], v[136:139], 0
    v_mfma_f32_16x16x32_bf16 v[88:91], v[76:79], v[168:171], v[88:91]
    v_mfma_f32_16x16x32_bf16 v[88:91], v[80:83], v[200:203], v[88:91]
    v_mfma_f32_16x16x32_bf16 v[88:91], v[84:87], v[232:235], v[88:91]
    v_subrev_u32 v92, s78, v66
    v_cmp_le_i32 vcc, 0, v92
    s_nop 5
    v_cndmask_b32 v88, v93, v88, vcc
    v_max_f32 v70, v70, v88
    v_cmp_le_i32 vcc, 1, v92
    s_nop 1
    v_cndmask_b32 v89, v93, v89, vcc
    v_max_f32 v70, v70, v89
    v_cmp_le_i32 vcc, 2, v92
    s_nop 1
    v_cndmask_b32 v90, v93, v90, vcc
    v_max_f32 v70, v70, v90
    v_cmp_le_i32 vcc, 3, v92
    s_nop 1
    v_cndmask_b32 v91, v93, v91, vcc
    v_max_f32 v70, v70, v91
    v_mfma_f32_16x16x32_bf16 v[88:91], v[72:75], v[140:143], 0
    v_mfma_f32_16x16x32_bf16 v[88:91], v[76:79], v[172:175], v[88:91]
    v_mfma_f32_16x16x32_bf16 v[88:91], v[80:83], v[204:207], v[88:91]
    v_mfma_f32_16x16x32_bf16 v[88:91], v[84:87], v[236:239], v[88:91]
    v_subrev_u32 v92, s78, v67
    v_cmp_le_i32 vcc, 0, v92
    s_nop 5
    v_cndmask_b32 v88, v93, v88, vcc
    v_max_f32 v71, v71, v88
    v_cmp_le_i32 vcc, 1, v92
    s_nop 1
    v_cndmask_b32 v89, v93, v89, vcc
    v_max_f32 v71, v71, v89
    v_cmp_le_i32 vcc, 2, v92
    s_nop 1
    v_cndmask_b32 v90, v93, v90, vcc
    v_max_f32 v71, v71, v90
    v_cmp_le_i32 vcc, 3, v92
    s_nop 1
    v_cndmask_b32 v91, v93, v91, vcc
    v_max_f32 v71, v71, v91
    s_add_u32 s78, s78, 16
    s_cmp_lt_u32 s78, s99
    s_cbranch_scc1 K1_REDO_L
    v_mov_b32 v92, v68
    s_nop 1
    v_permlane32_swap_b32 v68, v92
    v_max_f32 v68, v68, v92
    v_mov_b32 v92, v68
    s_nop 1
    v_permlane16_swap_b32 v68, v92
    v_max_f32 v68, v68, v92
    v_sub_f32 v144, 0, v68
    v_sub_f32 v145, 0, v68
    v_sub_f32 v146, 0, v68
    v_sub_f32 v147, 0, v68
    v_mov_b32 v92, v69
    s_nop 1
    v_permlane32_swap_b32 v69, v92
    v_max_f32 v69, v69, v92
    v_mov_b32 v92, v69
    s_nop 1
    v_permlane16_swap_b32 v69, v92
    v_max_f32 v69, v69, v92
    v_sub_f32 v148, 0, v69
    v_sub_f32 v149, 0, v69
    v_sub_f32 v150, 0, v69
    v_sub_f32 v151, 0, v69
    v_mov_b32 v92, v70
    s_nop 1
    v_permlane32_swap_b32 v70, v92
    v_max_f32 v70, v70, v92
    v_mov_b32 v92, v70
    s_nop 1
    v_permlane16_swap_b32 v70, v92
    v_max_f32 v70, v70, v92
    v_sub_f32 v152, 0, v70
    v_sub_f32 v153, 0, v70
    v_sub_f32 v154, 0, v70
    v_sub_f32 v155, 0, v70
    v_mov_b32 v92, v71
    s_nop 1
    v_permlane32_swap_b32 v71, v92
    v_max_f32 v71, v71, v92
    v_mov_b32 v92, v71
    s_nop 1
    v_permlane16_swap_b32 v71, v92
    v_max_f32 v71, v71, v92
    v_sub_f32 v156, 0, v71
    v_sub_f32 v157, 0, v71
    v_sub_f32 v158, 0, v71
    v_sub_f32 v159, 0, v71
    v_accvgpr_write_b32 a0, 0
    v_accvgpr_write_b32 a1, 0
    v_accvgpr_write_b32 a2, 0
    v_accvgpr_write_b32 a3, 0
    v_accvgpr_write_b32 a4, 0
    v_accvgpr_write_b32 a5, 0
    v_accvgpr_write_b32 a6, 0
    v_accvgpr_write_b32 a7, 0
    v_accvgpr_write_b32 a8, 0
    v_accvgpr_write_b32 a9, 0
    v_accvgpr_write_b32 a10, 0
    v_accvgpr_write_b32 a11, 0
    v_accvgpr_write_b32 a12, 0
    v_accvgpr_write_b32 a13, 0
    v_accvgpr_write_b32 a14, 0
    v_accvgpr_write_b32 a15, 0
    v_accvgpr_write_b32 a16, 0
    v_accvgpr_write_b32 a17, 0
    v_accvgpr_write_b32 a18, 0
    v_accvgpr_write_b32 a19, 0
    v_accvgpr_write_b32 a20, 0
    v_accvgpr_write_b32 a21, 0
    v_accvgpr_write_b32 a22, 0
    v_accvgpr_write_b32 a23, 0
    v_accvgpr_write_b32 a24, 0
    v_accvgpr_write_b32 a25, 0
    v_accvgpr_write_b32 a26, 0
    v_accvgpr_write_b32 a27, 0
    v_accvgpr_write_b32 a28, 0
    v_accvgpr_write_b32 a29, 0
    v_accvgpr_write_b32 a30, 0
    v_accvgpr_write_b32 a31, 0
    v_accvgpr_write_b32 a32, 0
    v_accvgpr_write_b32 a33, 0
    v_accvgpr_write_b32 a34, 0
    v_accvgpr_write_b32 a35, 0
    v_accvgpr_write_b32 a36, 0
    v_accvgpr_write_b32 a37, 0
    v_accvgpr_write_b32 a38, 0
    v_accvgpr_write_b32 a39, 0
    v_accvgpr_write_b32 a40, 0
    v_accvgpr_write_b32 a41, 0
    v_accvgpr_write_b32 a42, 0
    v_accvgpr_write_b32 a43, 0
    v_accvgpr_write_b32 a44, 0
    v_accvgpr_write_b32 a45, 0
    v_accvgpr_write_b32 a46, 0
    v_accvgpr_write_b32 a47, 0
    v_accvgpr_write_b32 a48, 0
    v_accvgpr_write_b32 a49, 0
    v_accvgpr_write_b32 a50, 0
    v_accvgpr_write_b32 a51, 0
    v_accvgpr_write_b32 a52, 0
    v_accvgpr_write_b32 a53, 0
    v_accvgpr_write_b32 a54, 0
    v_accvgpr_write_b32 a55, 0
    v_accvgpr_write_b32 a56, 0
    v_accvgpr_write_b32 a57, 0
    v_accvgpr_write_b32 a58, 0
    v_accvgpr_write_b32 a59, 0
    v_accvgpr_write_b32 a60, 0
    v_accvgpr_write_b32 a61, 0
    v_accvgpr_write_b32 a62, 0
    v_accvgpr_write_b32 a63, 0
    v_accvgpr_write_b32 a144, 0
    v_accvgpr_write_b32 a145, 0
    v_accvgpr_write_b32 a146, 0
    v_accvgpr_write_b32 a147, 0
    v_accvgpr_write_b32 a148, 0
    v_accvgpr_write_b32 a149, 0
    v_accvgpr_write_b32 a150, 0
    v_accvgpr_write_b32 a151, 0
    v_accvgpr_write_b32 a152, 0
    v_accvgpr_write_b32 a153, 0
    v_accvgpr_write_b32 a154, 0
    v_accvgpr_write_b32 a155, 0
    v_accvgpr_write_b32 a156, 0
    v_accvgpr_write_b32 a157, 0
    v_accvgpr_write_b32 a158, 0
    v_accvgpr_write_b32 a159, 0
    v_accvgpr_write_b32 a160, 0
    v_accvgpr_write_b32 a161, 0
    v_accvgpr_write_b32 a162, 0
    v_accvgpr_write_b32 a163, 0
    v_accvgpr_write_b32 a164, 0
    v_accvgpr_write_b32 a165, 0
    v_accvgpr_write_b32 a166, 0
    v_accvgpr_write_b32 a167, 0
    v_accvgpr_write_b32 a168, 0
    v_accvgpr_write_b32 a169, 0
    v_accvgpr_write_b32 a170, 0
    v_accvgpr_write_b32 a171, 0
    v_accvgpr_write_b32 a172, 0
    v_accvgpr_write_b32 a173, 0
    v_accvgpr_write_b32 a174, 0
    v_accvgpr_write_b32 a175, 0
    v_accvgpr_write_b32 a176, 0
    v_accvgpr_write_b32 a177, 0
    v_accvgpr_write_b32 a178, 0
    v_accvgpr_write_b32 a179, 0
    v_accvgpr_write_b32 a180, 0
    v_accvgpr_write_b32 a181, 0
    v_accvgpr_write_b32 a182, 0
    v_accvgpr_write_b32 a183, 0
    v_accvgpr_write_b32 a184, 0
    v_accvgpr_write_b32 a185, 0
    v_accvgpr_write_b32 a186, 0
    v_accvgpr_write_b32 a187, 0
    v_accvgpr_write_b32 a188, 0
    v_accvgpr_write_b32 a189, 0
    v_accvgpr_write_b32 a190, 0
    v_accvgpr_write_b32 a191, 0
    v_accvgpr_write_b32 a192, 0
    v_accvgpr_write_b32 a193, 0
    v_accvgpr_write_b32 a194, 0
    v_accvgpr_write_b32 a195, 0
    v_accvgpr_write_b32 a196, 0
    v_accvgpr_write_b32 a197, 0
    v_accvgpr_write_b32 a198, 0
    v_accvgpr_write_b32 a199, 0
    v_accvgpr_write_b32 a200, 0
    v_accvgpr_write_b32 a201, 0
    v_accvgpr_write_b32 a202, 0
    v_accvgpr_write_b32 a203, 0
    v_accvgpr_write_b32 a204, 0
    v_accvgpr_write_b32 a205, 0
    v_accvgpr_write_b32 a206, 0
    v_accvgpr_write_b32 a207, 0
    v_accvgpr_write_b32 a208, 0
    v_accvgpr_write_b32 a209, 0
    v_accvgpr_write_b32 a210, 0
    v_accvgpr_write_b32 a211, 0
    v_accvgpr_write_b32 a212, 0
    v_accvgpr_write_b32 a213, 0
    v_accvgpr_write_b32 a214, 0
    v_accvgpr_write_b32 a215, 0
    v_accvgpr_write_b32 a216, 0
    v_accvgpr_write_b32 a217, 0
    v_accvgpr_write_b32 a218, 0
    v_accvgpr_write_b32 a219, 0
    v_accvgpr_write_b32 a220, 0
    v_accvgpr_write_b32 a221, 0
    v_accvgpr_write_b32 a222, 0
    v_accvgpr_write_b32 a223, 0
    v_bfe_u32 v92, v1, 4, 2
    v_cmp_eq_u32 vcc, 0, v92
    v_mov_b32 v92, 0x3f803f80
    s_nop 0
    v_cndmask_b32 v92, 0, v92, vcc
    v_accvgpr_write_b32 a136, v92
    v_accvgpr_write_b32 a137, v92
    v_accvgpr_write_b32 a138, v92
    v_accvgpr_write_b32 a139, v92
    s_mov_b32 s77, s75
    s_mov_b32 s76, 0
    s_mov_b32 s38, 16384
    s_add_u32 m0, s76, s75
    s_nop 0
    buffer_load_dwordx4 v1, s[36:39], s77 offen sc1 lds
    buffer_load_dwordx4 v1, s[36:39], s77 offen offset:1024 sc1 lds
    buffer_load_dwordx4 v1, s[36:39], s77 offen offset:2048 sc1 lds
    buffer_load_dwordx4 v1, s[36:39], s77 offen offset:3072 sc1 lds
    s_add_u32 s100, s77, 4096
    s_add_u32 m0, m0, 4096
    s_nop 0
    buffer_load_dwordx4 v1, s[36:39], s100 offen sc1 lds
    buffer_load_dwordx4 v1, s[36:39], s100 offen offset:1024 sc1 lds
    buffer_load_dwordx4 v1, s[36:39], s100 offen offset:2048 sc1 lds
    buffer_load_dwordx4 v1, s[36:39], s100 offen offset:3072 sc1 lds
    s_add_u32 s77, s77, 32768
    s_add_u32 s76, s76, 32768
    s_lshr_b32 s82, s4, 1
    s_add_u32 s82, s82, 32
    s_sub_u32 s82, s82, s6
    s_sub_u32 s82, s82, s6
    s_lshl_b32 s38, s82, 15
    s_add_u32 m0, s76, s75
    s_nop 0
    buffer_load_dwordx4 v1, s[36:39], s77 offen sc1 lds
    buffer_load_dwordx4 v1, s[36:39], s77 offen offset:1024 sc1 lds
    buffer_load_dwordx4 v1, s[36:39], s77 offen offset:2048 sc1 lds
    buffer_load_dwordx4 v1, s[36:39], s77 offen offset:3072 sc1 lds
    s_add_u32 s100, s77, 4096
    s_add_u32 m0, m0, 4096
    s_nop 0
    buffer_load_dwordx4 v1, s[36:39], s100 offen sc1 lds
    buffer_load_dwordx4 v1, s[36:39], s100 offen offset:1024 sc1 lds
    buffer_load_dwordx4 v1, s[36:39], s100 offen offset:2048 sc1 lds
    buffer_load_dwordx4 v1, s[36:39], s100 offen offset:3072 sc1 lds
    s_add_u32 s77, s77, 32768
    s_add_u32 s76, s76, 32768
    s_add_u32 m0, s76, s75
    s_nop 0
    buffer_load_dwordx4 v1, s[36:39], s77 offen sc1 lds
    buffer_load_dwordx4 v1, s[36:39], s77 offen offset:1024 sc1 lds
    buffer_load_dwordx4 v1, s[36:39], s77 offen offset:2048 sc1 lds
    buffer_load_dwordx4 v1, s[36:39], s77 offen offset:3072 sc1 lds
    s_add_u32 s100, s77, 4096
    s_add_u32 m0, m0, 4096
    s_nop 0
    buffer_load_dwordx4 v1, s[36:39], s100 offen sc1 lds
    buffer_load_dwordx4 v1, s[36:39], s100 offen offset:1024 sc1 lds
    buffer_load_dwordx4 v1, s[36:39], s100 offen offset:2048 sc1 lds
    buffer_load_dwordx4 v1, s[36:39], s100 offen offset:3072 sc1 lds
    s_add_u32 s77, s77, 32768
    s_add_u32 s76, s76, 32768
    s_mov_b32 s82, 0
    s_mov_b32 s60, 131072
    v_mov_b32 v2, v1
    s_cmp_eq_u32 s6, 0
    s_cselect_b32 s16, s8, 0
    s_cselect_b32 s17, s9, 0
    s_cmp_eq_u32 s6, 0
    s_cselect_b32 s18, s10, 0
    s_cselect_b32 s19, s11, 0
    s_cmp_eq_u32 s6, 0
    s_cselect_b32 s20, s12, 0
    s_cselect_b32 s21, s13, 0
    s_cmp_eq_u32 s6, 0
    s_cselect_b32 s22, s14, 0
    s_cselect_b32 s23, s15, 0
    s_waitcnt vmcnt(16)
    s_barrier
    ds_read_b128 a[224:227], v2 offset:0
    ds_read_b128 a[228:231], v2 offset:1024
    ds_read_b128 a[232:235], v2 offset:2048
    ds_read_b128 a[236:239], v2 offset:3072
    s_waitcnt lgkmcnt(0)
    s_branch K1_ATT
SPIN_WA:
    s_mov_b32 s94, 0
SPIN_WA_L:
    s_sleep 2
    buffer_load_dword v7, v9, s[44:47], s69 offen sc1
    s_add_u32 s94, s94, 1
    s_cmp_ge_u32 s94, 0x40000
    s_waitcnt vmcnt(0)
    s_cbranch_scc1 BACK_WA
    v_cmp_gt_u32 vcc, 8, v7
    s_nop 1
    s_and_b64 vcc, vcc, s[86:87]
    s_cbranch_scc1 SPIN_WA_L
    s_branch BACK_WA
SPIN_KV:
    s_mov_b32 s94, 0
SPIN_KV_L:
    s_sleep 2
    buffer_load_dword v7, v8, s[32:35], s61 offen sc1
    s_add_u32 s94, s94, 1
    s_cmp_ge_u32 s94, 0x40000
    s_waitcnt vmcnt(0)
    s_cbranch_scc1 BACK_KV
    v_cmp_gt_u32 vcc, 1, v7
    s_nop 1
    s_and_b64 vcc, vcc, exec
    s_cbranch_scc1 SPIN_KV_L
    s_branch BACK_KV
SPIN_SHORT:
    s_mov_b32 s94, 0
SPIN_SHORT_L:
    s_sleep 2
    buffer_load_dword v3, v217, s[32:35], s19 offen sc1
    s_add_u32 s94, s94, 1
    s_cmp_ge_u32 s94, 0x40000
    s_waitcnt vmcnt(0)
    s_cbranch_scc1 BACK_SHORT
    v_cmp_gt_u32 vcc, 1, v3
    s_nop 1
    s_and_b64 vcc, vcc, exec
    s_cbranch_scc1 SPIN_SHORT_L
    s_branch BACK_SHORT
SPIN_CTX:
    s_mov_b32 s94, 0
SPIN_CTX_L:
    s_sleep 2
    buffer_load_dword v3, v217, s[32:35], s19 offen sc1
    s_add_u32 s94, s94, 1
    s_cmp_ge_u32 s94, 0x40000
    s_waitcnt vmcnt(0)
    s_cbranch_scc1 BACK_CTX
    v_cmp_gt_u32 vcc, 2, v3
    s_nop 1
    s_and_b64 vcc, vcc, exec
    s_cbranch_scc1 SPIN_CTX_L
    s_branch BACK_CTX
SPIN_ALL:
    s_mov_b32 s94, 0
SPIN_ALL_L:
    s_sleep 2
    buffer_load_dword v28, v29, s[32:35], s92 offen sc1
    s_add_u32 s94, s94, 1
    s_cmp_ge_u32 s94, 0x40000
    s_waitcnt vmcnt(0)
    s_cbranch_scc1 BACK_ALL
    v_cmp_gt_u32 vcc, 1, v28
    s_nop 1
    s_and_b64 vcc, vcc, exec
    s_cbranch_scc1 SPIN_ALL_L
    s_branch BACK_ALL
SPIN_OA:
    s_mov_b32 s94, 0
SPIN_OA_L:
    s_sleep 2
    buffer_load_dword v3, v19, s[32:35], s66 offen sc1
    s_add_u32 s94, s94, 1
    s_cmp_ge_u32 s94, 0x40000
    s_waitcnt vmcnt(0)
    s_cbranch_scc1 BACK_OA
    v_cmp_gt_u32 vcc, 3, v3
    s_nop 1
    s_and_b64 vcc, vcc, exec
    s_cbranch_scc1 SPIN_OA_L
    s_branch BACK_OA
SPIN_X:
    s_mov_b32 s94, 0
SPIN_X_L:
    s_sleep 2
    buffer_load_dword v3, v19, s[32:35], s66 offen sc1
    s_add_u32 s94, s94, 1
    s_cmp_ge_u32 s94, 0x40000
    s_waitcnt vmcnt(0)
    s_cbranch_scc1 BACK_X
    v_cmp_gt_u32 vcc, 3, v3
    s_nop 1
    s_and_b64 vcc, vcc, exec
    s_cbranch_scc1 SPIN_X_L
    s_branch BACK_X
SPIN_W0:
    s_mov_b32 s94, 0
SPIN_W0_L:
    s_sleep 2
    buffer_load_dword v3, v29, s[32:35], s92 offen sc1
    s_add_u32 s94, s94, 1
    s_cmp_ge_u32 s94, 0x40000
    s_waitcnt vmcnt(0)
    s_cbranch_scc1 BACK_W0
    v_cmp_gt_u32 vcc, 1, v3
    s_nop 1
    s_cmp_lg_u32 vcc_lo, 0
    s_cbranch_scc1 SPIN_W0_L
    s_branch BACK_W0
SPIN_W7:
    s_mov_b32 s94, 0
SPIN_W7_L:
    s_sleep 2
    buffer_load_dword v3, v29, s[32:35], s92 offen sc1
    s_add_u32 s94, s94, 1
    s_cmp_ge_u32 s94, 0x40000
    s_waitcnt vmcnt(0)
    s_cbranch_scc1 BACK_W7
    v_cmp_gt_u32 vcc, 1, v3
    s_nop 1
    s_cmp_lg_u32 vcc_lo, 0
    s_cbranch_scc1 SPIN_W7_L
    s_branch BACK_W7
.section .rodata,"a"
.p2align 6
.amdhsa_kernel gated_mix__sliding_local_dilated__compressed_kv_cla__prompt_kernel
.amdhsa_next_free_vgpr 512
.amdhsa_next_free_sgpr 102
.amdhsa_accum_offset 256
.amdhsa_group_segment_fixed_size 0
.amdhsa_kernarg_size 104
.amdhsa_user_sgpr_count 2
.amdhsa_user_sgpr_kernarg_segment_ptr 1
.amdhsa_system_sgpr_workgroup_id_x 1
.amdhsa_ieee_mode 0
.amdhsa_dx10_clamp 0
.end_amdhsa_kernel
```

```asm
; @launch grid=(256,1,1) block=(256,1,1) lds=163840
.amdgcn_target "amdgcn-amd-amdhsa--gfx950"
.text
.globl gated_mix__sliding_local_dilated__compressed_kv_cla__prompt_kernel
.p2align 8
.type gated_mix__sliding_local_dilated__compressed_kv_cla__prompt_kernel,@function
gated_mix__sliding_local_dilated__compressed_kv_cla__prompt_kernel:
    s_cmp_ge_u32 s2, 256
    s_cbranch_scc1 K1_END
    s_getpc_b64 s[94:95]
    s_load_dwordx8 s[36:43], s[0:1], 32
    v_min_u32 v74, 16, v0
    s_lshr_b32 s7, s2, 3
    s_mul_i32 s7, s7, 17
    v_add_lshl_u32 v74, v74, s7, 7
    global_load_dword v76, v74, s[94:95]
    v_lshrrev_b32 v64, 6, v0
    v_and_b32 v31, 63, v0
    v_readfirstlane_b32 s4, v64
    s_and_b32 s5, s2, 7
    s_lshl_b32 s5, s5, 2
    s_bfe_u32 s7, s2, 0x20003
    s_add_u32 s5, s5, s7
    s_lshr_b32 s6, s2, 5
    s_lshl_b32 s69, s4, 12
    s_mov_b32 s10, 2097152
    s_mov_b32 s11, 0x20000
    s_mov_b32 s14, 4194304
    s_mov_b32 s15, 0x20000
    s_mov_b32 s18, 4194304
    s_mov_b32 s19, 0x20000
    v_lshrrev_b32 v65, 3, v31
    v_and_b32 v66, 7, v31
    v_lshrrev_b32 v67, 1, v65
    v_xor_b32 v66, v66, v67
    v_lshlrev_b32 v66, 4, v66
    v_xor_b32 v67, 64, v66
    s_lshr_b32 s7, s4, 1
    s_lshl_b32 s73, s7, 7
    s_and_b32 s100, s4, 1
    s_lshl_b32 s98, s100, 5
    s_add_u32 s98, s98, s73
    v_add_lshl_u32 v68, v65, s98, 10
    v_add_u32 v6, v68, v66
    v_add_u32 v7, v68, v67
    v_add_u32 v7, 7168, v7
    v_add_u32 v8, v68, v66
    v_add_u32 v8, 14336, v8
    v_add_u32 v9, v68, v67
    v_add_u32 v9, 21504, v9
    v_lshrrev_b32 v69, 4, v31
    v_and_b32 v70, 15, v31
    v_lshlrev_b32 v71, 1, v69
    v_xor_b32 v71, v71, v70
    v_lshlrev_b32 v71, 4, v71
    v_xor_b32 v72, 128, v71
    s_lshl_b32 s98, s4, 4
    v_add_lshl_u32 v73, v69, s98, 13
    v_add_u32 v2, v73, v71
    v_add_u32 v3, v73, v71
    v_add_u32 v3, 31744, v3
    v_add_u32 v4, v73, v72
    v_add_u32 v4, 63488, v4
    v_add_u32 v5, v73, v72
    v_add_u32 v5, 95232, v5
    s_and_b32 s3, s2, 0
    s_lshl_b32 s66, s3, 7
    s_lshl_b32 s60, s3, 11
    s_add_u32 s60, s60, s5
    s_lshl_b32 s60, s60, 8
    s_lshl_b32 s61, s6, 18
    s_add_u32 s61, s61, s66
    s_add_u32 s62, s61, 65536
    s_waitcnt lgkmcnt(0)
    s_mov_b64 s[8:9], s[36:37]
    s_mov_b64 s[24:25], s[38:39]
    s_mov_b64 s[12:13], s[40:41]
    s_mov_b64 s[16:17], s[42:43]
    s_load_dwordx2 s[20:21], s[0:1], 0
    s_load_dwordx2 s[28:29], s[0:1], 8
    s_load_dwordx2 s[32:33], s[0:1], 72
    s_load_dwordx2 s[48:49], s[0:1], 64
    s_load_dwordx2 s[92:93], s[0:1], 16
    s_load_dwordx2 s[44:45], s[0:1], 88
    s_load_dwordx2 s[56:57], s[0:1], 96
    s_load_dwordx2 s[0:1], s[0:1], 80
    s_add_u32 m0, s69, 0
    s_nop 0
    buffer_load_dwordx4 v6, s[8:11], s61 offen lds
    buffer_load_dwordx4 v7, s[8:11], s61 offen offset:1024 lds
    buffer_load_dwordx4 v8, s[8:11], s61 offen offset:2048 lds
    buffer_load_dwordx4 v9, s[8:11], s61 offen offset:3072 lds
    s_xor_b32 s61, s61, 128
    s_add_u32 m0, s69, 16384
    s_nop 0
    buffer_load_dwordx4 v6, s[8:11], s62 offen lds
    buffer_load_dwordx4 v7, s[8:11], s62 offen offset:1024 lds
    buffer_load_dwordx4 v8, s[8:11], s62 offen offset:2048 lds
    buffer_load_dwordx4 v9, s[8:11], s62 offen offset:3072 lds
    s_xor_b32 s62, s62, 128
    s_add_u32 m0, s69, 32768
    s_nop 0
    buffer_load_dwordx4 v2, s[12:15], s60 offen nt lds
    buffer_load_dwordx4 v3, s[12:15], s60 offen offset:1024 nt lds
    buffer_load_dwordx4 v4, s[12:15], s60 offen offset:2048 nt lds
    buffer_load_dwordx4 v5, s[12:15], s60 offen offset:3072 nt lds
    s_add_u32 m0, s69, 49152
    s_nop 0
    buffer_load_dwordx4 v6, s[8:11], s61 offen lds
    buffer_load_dwordx4 v7, s[8:11], s61 offen offset:1024 lds
    buffer_load_dwordx4 v8, s[8:11], s61 offen offset:2048 lds
    buffer_load_dwordx4 v9, s[8:11], s61 offen offset:3072 lds
    s_xor_b32 s61, s61, 384
    v_min_u32 v74, 15, v31
    s_lshl2_add_u32 s98, s2, s4
    s_lshl_b32 s98, s98, 11
    v_lshlrev_b32 v74, 7, v74
    buffer_load_dword v117, v74, s[8:11], s98 offen
    s_waitcnt lgkmcnt(0)
    s_mov_b32 s22, 2359296
    s_mov_b32 s23, 0x20000
    s_mov_b32 s26, 4718592
    s_mov_b32 s27, 0x20000
    s_mov_b32 s50, 4718592
    s_mov_b32 s51, 0x20000
    s_mov_b32 s46, 256
    s_mov_b32 s47, 0x20000
    s_mov_b32 s30, 1990656
    s_mov_b32 s31, 0x20000
    s_mov_b32 s34, 1152
    s_mov_b32 s35, 0x20000
    s_mul_i32 s7, s5, 1081344
    s_add_u32 s36, s56, s7
    s_addc_u32 s37, s57, 0
    s_mov_b32 s38, 1081344
    s_mov_b32 s39, 0x20000
    s_cmp_eq_u32 s4, 0
    s_cselect_b32 s86, 0x55555555, 0
    s_cselect_b32 s87, 0x55555555, 0
    s_cselect_b32 s52, s48, s92
    s_cselect_b32 s53, s49, s93
    s_cselect_b32 s54, s50, 663552
    s_mov_b32 s55, 0x20000
    s_mul_i32 s63, s6, 147456
    s_sub_u32 s64, 2211840, s63
    s_add_u32 s63, s63, s66
    s_add_u32 s64, s64, s66
    s_lshl_b32 s67, s4, 11
    s_lshl_b32 s68, s4, 10
    s_lshl_b32 s75, s4, 13
    s_lshl_b32 s65, s3, 13
    s_add_u32 s65, s65, s67
    s_lshl_b32 s70, s6, 2
    s_lshl1_add_u32 s70, s100, s70
    s_lshl_b32 s70, s70, 15
    s_lshl_b32 s98, s73, 6
    s_add_u32 s71, s70, s98
    s_add_u32 s71, s71, 49152
    s_lshl_b32 s98, s73, 4
    s_add_u32 s70, s70, s98
    v_lshlrev_b32 v1, 4, v31
    v_mov_b32 v77, 1073741824
    v_cmp_eq_u32 vcc, 0, v0
    s_nop 1
    v_cndmask_b32_e64 v30, v77, 0, vcc
    v_lshlrev_b32 v103, 7, v31
    v_cmp_gt_u32 vcc, 9, v31
    s_nop 1
    v_cndmask_b32 v103, v77, v103, vcc
    s_lshl_b32 s98, s4, 5
    v_add_u32 v68, s98, v65
    v_mul_u32_u24 v68, 1152, v68
    v_add_u32 v10, v68, v66
    v_add_u32 v11, v68, v67
    v_add_u32 v11, 8192, v11
    v_add_u32 v12, v68, v66
    v_add_u32 v12, 16384, v12
    v_add_u32 v13, v68, v67
    v_add_u32 v13, 24576, v13
    s_sub_u32 s98, 15, s6
    s_cmp_eq_u32 s73, 0
    s_cselect_b32 s98, s6, s98
    s_lshl_b32 s98, s98, 7
    s_sub_u32 s98, s98, 16
    s_max_i32 s98, s98, 0
    s_lshl3_add_u32 s98, s100, s98
    v_add_u32 v68, s98, v65
    v_mul_u32_u24 v68, 1152, v68
    s_lshl_b32 s98, s100, 6
    v_xor_b32 v73, s98, v66
    v_add_u32 v96, v68, v73
    s_add_u32 m0, s69, 65536
    s_nop 0
    buffer_load_dwordx4 v2, s[16:19], s60 offen nt lds
    v_lshrrev_b32 v71, 1, v70
    v_xor_b32 v71, v71, v69
    v_lshlrev_b32 v71, 4, v71
    v_lshl_add_u32 v71, v70, 7, v71
    v_xor_b32 v72, 64, v71
    s_lshl_b32 s98, s100, 13
    v_add_u32 v22, s98, v71
    v_add_u32 v23, s98, v72
    v_add_u32 v24, s67, v71
    v_add_u32 v25, s67, v72
    s_lshl_b32 s98, s100, 11
    s_add_u32 s98, s98, 8192
    v_add_u32 v100, s98, v71
    v_add_u32 v101, s98, v72
    v_bfe_u32 v73, v31, 2, 2
    v_and_b32 v74, 3, v31
    v_lshl_add_u32 v75, v69, 3, v73
    v_and_b32 v78, 1, v69
    buffer_load_dwordx4 v3, s[16:19], s60 offen offset:1024 nt lds
    v_lshl_add_u32 v77, v78, 2, v73
    v_lshlrev_b32 v77, 5, v77
    v_lshl_add_u32 v77, v74, 3, v77
    v_lshl_add_u32 v77, v75, 8, v77
    v_xor_b32 v14, 0, v77
    v_xor_b32 v14, s73, v14
    v_xor_b32 v15, 32, v77
    v_xor_b32 v15, s73, v15
    v_xor_b32 v16, 64, v77
    v_xor_b32 v16, s73, v16
    v_xor_b32 v17, 96, v77
    v_xor_b32 v17, s73, v17
    v_xor_b32 v18, 128, v77
    v_xor_b32 v19, 160, v77
    v_xor_b32 v20, 192, v77
    v_xor_b32 v21, 224, v77
    v_lshrrev_b32 v77, 1, v73
    v_lshl_add_u32 v77, v78, 1, v77
    buffer_load_dwordx4 v4, s[16:19], s60 offen offset:2048 nt lds
    v_lshlrev_b32 v77, 5, v77
    v_lshl_add_u32 v77, v74, 3, v77
    v_lshl_add_u32 v77, v75, 7, v77
    s_lshr_b32 s98, s73, 1
    v_xor_b32 v26, 0, v77
    v_xor_b32 v26, s98, v26
    v_xor_b32 v27, 32, v77
    v_xor_b32 v28, 64, v77
    v_xor_b32 v28, s98, v28
    v_xor_b32 v29, 96, v77
    v_and_b32 v73, 7, v0
    v_lshrrev_b32 v74, 3, v0
    v_lshl_add_u32 v75, v73, 1, 0
    v_mul_u32_u24 v78, 52, v75
    v_lshrrev_b32 v78, 8, v78
    v_mul_u32_u24 v79, 5, v78
    v_sub_u32 v75, v75, v79
    v_add_u32 v78, 1, v78
    buffer_load_dwordx4 v5, s[16:19], s60 offen offset:3072 nt lds
    s_xor_b32 s60, s60, 524288
    v_cmp_le_u32 vcc, 3, v78
    s_nop 1
    v_cndmask_b32_e64 v78, v78, 0, vcc
    v_mul_u32_u24 v78, 1152, v78
    v_lshl_add_u32 v75, v75, 3, v78
    v_mad_u32_u24 v75, v74, 36, v75
    v_lshl_add_u32 v77, v73, 1, 1
    v_mul_u32_u24 v78, 52, v77
    v_lshrrev_b32 v78, 8, v78
    v_mul_u32_u24 v79, 5, v78
    v_sub_u32 v77, v77, v79
    v_add_u32 v78, 1, v78
    v_cmp_le_u32 vcc, 3, v78
    s_nop 1
    v_cndmask_b32_e64 v78, v78, 0, vcc
    v_mul_u32_u24 v78, 1152, v78
    v_lshl_add_u32 v77, v77, 3, v78
    v_mad_u32_u24 v77, v74, 36, v77
    s_mul_i32 s98, s2, 10368
    s_mul_i32 s99, s2, 6
    s_mov_b32 s7, 73728
    v_mul_lo_u32 v95, v74, s7
    v_lshl_add_u32 v95, v73, 4, v95
    v_cmp_eq_u32 s[92:93], 7, v73
    s_add_u32 s56, s56, 56623104
    s_addc_u32 s57, s57, 0
    s_mov_b32 s58, 5603328
    s_mov_b32 s59, 0x20000
    s_lshl_b32 s101, s6, 5
    s_add_u32 s101, s101, s5
    s_lshl_b32 s101, s101, 7
    v_mov_b32 v65, 0
    v_lshrrev_b32 v64, 2, v0
    v_lshlrev_b32 v64, 15, v64
    v_and_b32 v79, 3, v0
    v_lshl_add_u32 v64, v79, 2, v64
    s_mov_b32 s74, 0x3e0293ee
    s_lshl_b32 s95, s5, 3
    s_waitcnt vmcnt(5)
    s_barrier
    ds_read_b128 a[0:3], v22 offset:0
    ds_read_b64_tr_b16 v[40:41], v14 offset:32768
    ds_read_b64_tr_b16 v[42:43], v14 offset:33792
    ds_read_b128 a[4:7], v23 offset:0
    ds_read_b64_tr_b16 v[44:45], v14 offset:40960
    ds_read_b64_tr_b16 v[46:47], v14 offset:41984
    ds_read_b128 a[8:11], v22 offset:2048
    ds_read_b128 a[12:15], v23 offset:2048
    ds_read_b128 a[16:19], v22 offset:4096
    ds_read_b128 a[20:23], v23 offset:4096
    ds_read_b128 a[24:27], v22 offset:6144
    ds_read_b128 a[28:31], v23 offset:6144
    ds_read_b128 a[32:35], v22 offset:16384
    ds_read_b128 a[36:39], v23 offset:16384
    ds_read_b128 a[40:43], v22 offset:18432
    s_waitcnt lgkmcnt(14)
    ds_read_b128 a[44:47], v23 offset:18432
    s_waitcnt lgkmcnt(14)
    ds_read_b128 a[48:51], v22 offset:20480
    s_waitcnt lgkmcnt(14)
    ds_read_b128 a[52:55], v23 offset:20480
    s_waitcnt lgkmcnt(14)
    ds_read_b128 a[56:59], v22 offset:22528
    s_waitcnt lgkmcnt(14)
    ds_read_b128 a[60:63], v23 offset:22528
    v_mfma_f32_16x16x32_bf16 v[128:131], v[40:43], a[0:3], 0
    s_add_u32 m0, s69, 81920
    s_waitcnt lgkmcnt(14)
    ds_read_b64_tr_b16 v[48:49], v15 offset:32768
    s_waitcnt lgkmcnt(14)
    ds_read_b64_tr_b16 v[50:51], v15 offset:33792
    v_mfma_f32_16x16x32_bf16 v[128:131], v[44:47], a[4:7], v[128:131]
    s_mul_i32 s77, s2, 9216
    buffer_load_dwordx4 v6, s[8:11], s62 offen lds
    v_mfma_f32_16x16x32_bf16 v[132:135], v[40:43], a[8:11], 0
    s_mul_i32 s76, s4, 1152
    s_waitcnt lgkmcnt(14)
    ds_read_b128 a[64:67], v22 offset:49152
    s_waitcnt lgkmcnt(14)
    ds_read_b64_tr_b16 v[52:53], v15 offset:40960
    v_mfma_f32_16x16x32_bf16 v[132:135], v[44:47], a[12:15], v[132:135]
    s_add_u32 s77, s77, s76
    s_waitcnt lgkmcnt(14)
    ds_read_b64_tr_b16 v[54:55], v15 offset:41984
    s_waitcnt lgkmcnt(14)
    ds_read_b64_tr_b16 v[56:57], v16 offset:32768
    v_mfma_f32_16x16x32_bf16 v[136:139], v[40:43], a[16:19], 0
    s_mul_i32 s76, s4, 1152
    buffer_load_dwordx4 v7, s[8:11], s62 offen offset:1024 lds
    v_mfma_f32_16x16x32_bf16 v[136:139], v[44:47], a[20:23], v[136:139]
    s_mul_i32 s72, s2, 3
    s_waitcnt lgkmcnt(4)
    ds_read_b64_tr_b16 v[58:59], v16 offset:33792
    ds_read_b64_tr_b16 v[60:61], v16 offset:40960
    v_mfma_f32_16x16x32_bf16 v[140:143], v[40:43], a[24:27], 0
    s_add_u32 s72, s72, 0
    ds_read_b64_tr_b16 v[62:63], v16 offset:41984
    v_add_u32 v14, 0x10000, v14
    v_mfma_f32_16x16x32_bf16 v[140:143], v[44:47], a[28:31], v[140:143]
    s_mul_i32 s7, s5, 73728
    ds_read_b128 a[68:71], v23 offset:49152
    v_add_u32 v15, 0x10000, v15
    v_mfma_f32_16x16x32_bf16 v[144:147], v[40:43], a[32:35], 0
    s_and_b32 s100, s5, 1
    buffer_load_dwordx4 v8, s[8:11], s62 offen offset:2048 lds
    v_mfma_f32_16x16x32_bf16 v[144:147], v[44:47], a[36:39], v[144:147]
    s_mov_b64 s[84:85], 0
    v_add_u32 v16, 0x10000, v16
    v_mov_b32 v31, 1
    v_mfma_f32_16x16x32_bf16 v[148:151], v[40:43], a[40:43], 0
    s_mov_b32 vcc_lo, 0x84848484
    s_mov_b32 vcc_hi, 0x84848484
    v_add_u32 v18, 0x10000, v18
    v_mfma_f32_16x16x32_bf16 v[148:151], v[44:47], a[44:47], v[148:151]
    s_mov_b32 s83, 0
    v_add_u32 v19, 0x10000, v19
    v_add_u32 v20, 0x10000, v20
    v_mfma_f32_16x16x32_bf16 v[152:155], v[40:43], a[48:51], 0
    buffer_load_dwordx4 v9, s[8:11], s62 offen offset:3072 lds
    v_mfma_f32_16x16x32_bf16 v[152:155], v[44:47], a[52:55], v[152:155]
    ds_read_b128 a[72:75], v22 offset:51200
    v_add_u32 v21, 0x10000, v21
    v_mfma_f32_16x16x32_bf16 v[156:159], v[40:43], a[56:59], 0
    s_add_u32 m0, s69, 98304
    ds_read_b64_tr_b16 v[40:41], v17 offset:32768
    ds_read_b64_tr_b16 v[42:43], v17 offset:33792
    v_mfma_f32_16x16x32_bf16 v[156:159], v[44:47], a[60:63], v[156:159]
    s_xor_b32 s62, s62, 384
    ds_read_b64_tr_b16 v[44:45], v17 offset:40960
    ds_read_b64_tr_b16 v[46:47], v17 offset:41984
    v_mfma_f32_16x16x32_bf16 v[160:163], v[48:51], a[0:3], 0
    s_waitcnt lgkmcnt(5)
    buffer_load_dwordx4 v2, s[12:15], s60 offen nt lds
    v_mfma_f32_16x16x32_bf16 v[160:163], v[52:55], a[4:7], v[160:163]
    v_add_u32 v17, 0x10000, v17
    v_add_u32 v26, 0x10000, v26
    v_mfma_f32_16x16x32_bf16 v[164:167], v[48:51], a[8:11], 0
    ds_read_b128 a[76:79], v23 offset:51200
    v_add_u32 v27, 0x10000, v27
    v_mfma_f32_16x16x32_bf16 v[164:167], v[52:55], a[12:15], v[164:167]
    v_add_u32 v28, 0x10000, v28
    v_add_u32 v29, 0x10000, v29
    v_mfma_f32_16x16x32_bf16 v[168:171], v[48:51], a[16:19], 0
    buffer_load_dwordx4 v3, s[12:15], s60 offen offset:1024 nt lds
    v_mfma_f32_16x16x32_bf16 v[168:171], v[52:55], a[20:23], v[168:171]
    v_bfe_u32 v37, v1, 4, 4
    v_mul_u32_u24 v36, 1152, v37
    v_mfma_f32_16x16x32_bf16 v[172:175], v[48:51], a[24:27], 0
    v_lshrrev_b32 v38, 8, v1
    v_lshl_add_u32 v36, v38, 4, v36
    v_mfma_f32_16x16x32_bf16 v[172:175], v[52:55], a[28:31], v[172:175]
    v_lshrrev_b32 v39, 3, v37
    v_mul_u32_u24 v39, 9152, v39
    v_mfma_f32_16x16x32_bf16 v[176:179], v[48:51], a[32:35], 0
    buffer_load_dwordx4 v4, s[12:15], s60 offen offset:2048 nt lds
    v_mfma_f32_16x16x32_bf16 v[176:179], v[52:55], a[36:39], v[176:179]
    ds_read_b128 a[80:83], v22 offset:53248
    v_mfma_f32_16x16x32_bf16 v[180:183], v[48:51], a[40:43], 0
    v_mfma_f32_16x16x32_bf16 v[180:183], v[52:55], a[44:47], v[180:183]
    v_mfma_f32_16x16x32_bf16 v[184:187], v[48:51], a[48:51], 0
    buffer_load_dwordx4 v5, s[12:15], s60 offen offset:3072 nt lds
    v_mfma_f32_16x16x32_bf16 v[184:187], v[52:55], a[52:55], v[184:187]
    ds_read_b128 a[84:87], v23 offset:53248
    v_mfma_f32_16x16x32_bf16 v[188:191], v[48:51], a[56:59], 0
    s_add_u32 m0, s69, 114688
    v_mfma_f32_16x16x32_bf16 v[188:191], v[52:55], a[60:63], v[188:191]
    v_mfma_f32_16x16x32_bf16 v[192:195], v[56:59], a[0:3], 0
    buffer_load_dwordx4 v6, s[8:11], s61 offen lds
    v_mfma_f32_16x16x32_bf16 v[192:195], v[60:63], a[4:7], v[192:195]
    v_mfma_f32_16x16x32_bf16 v[196:199], v[56:59], a[8:11], 0
    v_mfma_f32_16x16x32_bf16 v[196:199], v[60:63], a[12:15], v[196:199]
    ds_read_b128 a[88:91], v22 offset:55296
    v_mfma_f32_16x16x32_bf16 v[200:203], v[56:59], a[16:19], 0
    buffer_load_dwordx4 v7, s[8:11], s61 offen offset:1024 lds
    v_mfma_f32_16x16x32_bf16 v[200:203], v[60:63], a[20:23], v[200:203]
    v_mfma_f32_16x16x32_bf16 v[204:207], v[56:59], a[24:27], 0
    v_mfma_f32_16x16x32_bf16 v[204:207], v[60:63], a[28:31], v[204:207]
    v_mfma_f32_16x16x32_bf16 v[208:211], v[56:59], a[32:35], 0
    buffer_load_dwordx4 v8, s[8:11], s61 offen offset:2048 lds
    v_mfma_f32_16x16x32_bf16 v[208:211], v[60:63], a[36:39], v[208:211]
    ds_read_b128 a[92:95], v23 offset:55296
    v_mfma_f32_16x16x32_bf16 v[212:215], v[56:59], a[40:43], 0
    v_mfma_f32_16x16x32_bf16 v[212:215], v[60:63], a[44:47], v[212:215]
    v_mfma_f32_16x16x32_bf16 v[216:219], v[56:59], a[48:51], 0
    buffer_load_dwordx4 v9, s[8:11], s61 offen offset:3072 lds
    v_mfma_f32_16x16x32_bf16 v[216:219], v[60:63], a[52:55], v[216:219]
    v_mfma_f32_16x16x32_bf16 v[220:223], v[56:59], a[56:59], 0
    s_xor_b32 s61, s61, 128
    v_mfma_f32_16x16x32_bf16 v[220:223], v[60:63], a[60:63], v[220:223]
    s_add_u32 m0, s69, 131072
    s_waitcnt lgkmcnt(0)
    v_mfma_f32_16x16x32_bf16 v[224:227], v[40:43], a[0:3], 0
    buffer_load_dwordx4 v2, s[16:19], s60 offen nt lds
    v_mfma_f32_16x16x32_bf16 v[224:227], v[44:47], a[4:7], v[224:227]
    v_mfma_f32_16x16x32_bf16 v[228:231], v[40:43], a[8:11], 0
    buffer_load_dword v104, v103, s[20:23], s77 offen
    v_mfma_f32_16x16x32_bf16 v[228:231], v[44:47], a[12:15], v[228:231]
    s_add_u32 s77, s77, 4608
    v_mfma_f32_16x16x32_bf16 v[232:235], v[40:43], a[16:19], 0
    v_mfma_f32_16x16x32_bf16 v[232:235], v[44:47], a[20:23], v[232:235]
    s_waitcnt vmcnt(10)
    s_barrier
    ds_read_b64_tr_b16 v[48:49], v14 offset:0
    v_mfma_f32_16x16x32_bf16 v[236:239], v[40:43], a[24:27], 0
    buffer_load_dwordx4 v3, s[16:19], s60 offen offset:1024 nt lds
    v_mfma_f32_16x16x32_bf16 v[236:239], v[44:47], a[28:31], v[236:239]
    ds_read_b64_tr_b16 v[50:51], v14 offset:1024
    ds_read_b64_tr_b16 v[52:53], v14 offset:8192
    v_mfma_f32_16x16x32_bf16 v[240:243], v[40:43], a[32:35], 0
    ds_read_b64_tr_b16 v[54:55], v14 offset:9216
    ds_read_b64_tr_b16 v[56:57], v15 offset:0
    v_mfma_f32_16x16x32_bf16 v[240:243], v[44:47], a[36:39], v[240:243]
    buffer_load_dwordx4 v4, s[16:19], s60 offen offset:2048 nt lds
    v_mfma_f32_16x16x32_bf16 v[244:247], v[40:43], a[40:43], 0
    ds_read_b64_tr_b16 v[58:59], v15 offset:1024
    ds_read_b64_tr_b16 v[60:61], v15 offset:8192
    v_mfma_f32_16x16x32_bf16 v[244:247], v[44:47], a[44:47], v[244:247]
    ds_read_b64_tr_b16 v[62:63], v15 offset:9216
    v_mfma_f32_16x16x32_bf16 v[248:251], v[40:43], a[48:51], 0
    v_mfma_f32_16x16x32_bf16 v[248:251], v[44:47], a[52:55], v[248:251]
    buffer_load_dwordx4 v5, s[16:19], s60 offen offset:3072 nt lds
    v_mfma_f32_16x16x32_bf16 v[252:255], v[40:43], a[56:59], 0
    ds_read_b64_tr_b16 v[40:41], v16 offset:0
    ds_read_b64_tr_b16 v[42:43], v16 offset:1024
    v_mfma_f32_16x16x32_bf16 v[252:255], v[44:47], a[60:63], v[252:255]
    s_waitcnt lgkmcnt(3)
    ds_read_b64_tr_b16 v[44:45], v16 offset:8192
    ds_read_b64_tr_b16 v[46:47], v16 offset:9216
    v_mfma_f32_16x16x32_bf16 a[128:131], a[0:3], v[48:51], 0
    v_mfma_f32_16x16x32_bf16 a[128:131], a[4:7], v[52:55], a[128:131]
    s_add_u32 m0, s69, 147456
    v_add_u32 v22, 0x10000, v22
    v_mfma_f32_16x16x32_bf16 a[132:135], a[8:11], v[48:51], 0
    s_xor_b32 s60, s60, 1572864
    buffer_load_dwordx4 v6, s[8:11], s62 offen lds
    v_mfma_f32_16x16x32_bf16 a[132:135], a[12:15], v[52:55], a[132:135]
    ds_read_b128 a[96:99], v22 offset:16384
    v_mfma_f32_16x16x32_bf16 a[136:139], a[16:19], v[48:51], 0
    v_mfma_f32_16x16x32_bf16 a[136:139], a[20:23], v[52:55], a[136:139]
    v_mfma_f32_16x16x32_bf16 a[140:143], a[24:27], v[48:51], 0
    buffer_load_dwordx4 v7, s[8:11], s62 offen offset:1024 lds
    v_mfma_f32_16x16x32_bf16 a[140:143], a[28:31], v[52:55], a[140:143]
    v_add_u32 v23, 0x10000, v23
    ds_read_b128 a[100:103], v23 offset:16384
    v_mfma_f32_16x16x32_bf16 a[144:147], a[32:35], v[48:51], 0
    v_mfma_f32_16x16x32_bf16 a[144:147], a[36:39], v[52:55], a[144:147]
    v_mfma_f32_16x16x32_bf16 a[148:151], a[40:43], v[48:51], 0
    v_mfma_f32_16x16x32_bf16 a[148:151], a[44:47], v[52:55], a[148:151]
    buffer_load_dwordx4 v8, s[8:11], s62 offen offset:2048 lds
    v_mfma_f32_16x16x32_bf16 a[152:155], a[48:51], v[48:51], 0
    v_mfma_f32_16x16x32_bf16 a[152:155], a[52:55], v[52:55], a[152:155]
    ds_read_b128 a[104:107], v22 offset:18432
    v_mfma_f32_16x16x32_bf16 a[156:159], a[56:59], v[48:51], 0
    ds_read_b64_tr_b16 v[48:49], v17 offset:0
    ds_read_b64_tr_b16 v[50:51], v17 offset:1024
    v_mfma_f32_16x16x32_bf16 a[156:159], a[60:63], v[52:55], a[156:159]
    buffer_load_dwordx4 v9, s[8:11], s62 offen offset:3072 lds
    v_mfma_f32_16x16x32_bf16 a[160:163], a[0:3], v[56:59], 0
    s_waitcnt lgkmcnt(3)
    ds_read_b64_tr_b16 v[52:53], v17 offset:8192
    ds_read_b64_tr_b16 v[54:55], v17 offset:9216
    v_mfma_f32_16x16x32_bf16 a[160:163], a[4:7], v[60:63], a[160:163]
    v_mfma_f32_16x16x32_bf16 a[164:167], a[8:11], v[56:59], 0
    ds_read_b128 a[108:111], v23 offset:18432
    v_mfma_f32_16x16x32_bf16 a[164:167], a[12:15], v[60:63], a[164:167]
    s_add_u32 m0, s69, 0
    v_mfma_f32_16x16x32_bf16 a[168:171], a[16:19], v[56:59], 0
    s_xor_b32 s62, s62, 128
    buffer_load_dwordx4 v2, s[12:15], s60 offen nt lds
    v_mfma_f32_16x16x32_bf16 a[168:171], a[20:23], v[60:63], a[168:171]
    v_mfma_f32_16x16x32_bf16 a[172:175], a[24:27], v[56:59], 0
    v_mfma_f32_16x16x32_bf16 a[172:175], a[28:31], v[60:63], a[172:175]
    v_mfma_f32_16x16x32_bf16 a[176:179], a[32:35], v[56:59], 0
    buffer_load_dwordx4 v3, s[12:15], s60 offen offset:1024 nt lds
    v_mfma_f32_16x16x32_bf16 a[176:179], a[36:39], v[60:63], a[176:179]
    ds_read_b128 a[112:115], v22 offset:20480
    v_mfma_f32_16x16x32_bf16 a[180:183], a[40:43], v[56:59], 0
    v_mfma_f32_16x16x32_bf16 a[180:183], a[44:47], v[60:63], a[180:183]
    v_mfma_f32_16x16x32_bf16 a[184:187], a[48:51], v[56:59], 0
    v_mfma_f32_16x16x32_bf16 a[184:187], a[52:55], v[60:63], a[184:187]
    buffer_load_dwordx4 v4, s[12:15], s60 offen offset:2048 nt lds
    v_mfma_f32_16x16x32_bf16 a[188:191], a[56:59], v[56:59], 0
    ds_read_b128 a[116:119], v23 offset:20480
    v_mfma_f32_16x16x32_bf16 a[188:191], a[60:63], v[60:63], a[188:191]
    v_mfma_f32_16x16x32_bf16 a[192:195], a[0:3], v[40:43], 0
    v_mfma_f32_16x16x32_bf16 a[192:195], a[4:7], v[44:47], a[192:195]
    buffer_load_dwordx4 v5, s[12:15], s60 offen offset:3072 nt lds
    v_mfma_f32_16x16x32_bf16 a[196:199], a[8:11], v[40:43], 0
    v_mfma_f32_16x16x32_bf16 a[196:199], a[12:15], v[44:47], a[196:199]
    ds_read_b128 a[120:123], v22 offset:22528
    v_mfma_f32_16x16x32_bf16 a[200:203], a[16:19], v[40:43], 0
    v_mfma_f32_16x16x32_bf16 a[200:203], a[20:23], v[44:47], a[200:203]
    s_add_u32 m0, s69, 16384
    v_mfma_f32_16x16x32_bf16 a[204:207], a[24:27], v[40:43], 0
    buffer_load_dwordx4 v6, s[8:11], s61 offen lds
    v_mfma_f32_16x16x32_bf16 a[204:207], a[28:31], v[44:47], a[204:207]
    v_mfma_f32_16x16x32_bf16 a[208:211], a[32:35], v[40:43], 0
    ds_read_b128 a[124:127], v23 offset:22528
    v_mfma_f32_16x16x32_bf16 a[208:211], a[36:39], v[44:47], a[208:211]
    v_mfma_f32_16x16x32_bf16 a[212:215], a[40:43], v[40:43], 0
    buffer_load_dwordx4 v7, s[8:11], s61 offen offset:1024 lds
    v_mfma_f32_16x16x32_bf16 a[212:215], a[44:47], v[44:47], a[212:215]
    v_mfma_f32_16x16x32_bf16 a[216:219], a[48:51], v[40:43], 0
    v_mfma_f32_16x16x32_bf16 a[216:219], a[52:55], v[44:47], a[216:219]
    v_mfma_f32_16x16x32_bf16 a[220:223], a[56:59], v[40:43], 0
    v_mfma_f32_16x16x32_bf16 a[220:223], a[60:63], v[44:47], a[220:223]
    s_waitcnt lgkmcnt(0)
    buffer_load_dwordx4 v8, s[8:11], s61 offen offset:2048 lds
    v_mfma_f32_16x16x32_bf16 a[224:227], a[0:3], v[48:51], 0
    v_mfma_f32_16x16x32_bf16 a[224:227], a[4:7], v[52:55], a[224:227]
    v_mfma_f32_16x16x32_bf16 a[228:231], a[8:11], v[48:51], 0
    v_mfma_f32_16x16x32_bf16 a[228:231], a[12:15], v[52:55], a[228:231]
    buffer_load_dwordx4 v9, s[8:11], s61 offen offset:3072 lds
    v_mfma_f32_16x16x32_bf16 a[232:235], a[16:19], v[48:51], 0
    v_mfma_f32_16x16x32_bf16 a[232:235], a[20:23], v[52:55], a[232:235]
    s_waitcnt vmcnt(8) lgkmcnt(0)
    s_barrier
    ds_read_b64_tr_b16 v[56:57], v14 offset:32768
    v_mfma_f32_16x16x32_bf16 a[236:239], a[24:27], v[48:51], 0
    s_add_u32 m0, s69, 32768
    ds_read_b64_tr_b16 v[58:59], v14 offset:33792
    ds_read_b64_tr_b16 v[60:61], v14 offset:40960
    v_mfma_f32_16x16x32_bf16 a[236:239], a[28:31], v[52:55], a[236:239]
    s_xor_b32 s61, s61, 896
    buffer_load_dwordx4 v2, s[16:19], s60 offen nt lds
    v_mfma_f32_16x16x32_bf16 a[240:243], a[32:35], v[48:51], 0
    ds_read_b64_tr_b16 v[62:63], v14 offset:41984
    ds_read_b64_tr_b16 v[40:41], v15 offset:32768
    v_mfma_f32_16x16x32_bf16 a[240:243], a[36:39], v[52:55], a[240:243]
    ds_read_b64_tr_b16 v[42:43], v15 offset:33792
    ds_read_b64_tr_b16 v[44:45], v15 offset:40960
    v_mfma_f32_16x16x32_bf16 a[244:247], a[40:43], v[48:51], 0
    ds_read_b64_tr_b16 v[46:47], v15 offset:41984
    v_add_u32 v14, 0x10000, v14
    v_mfma_f32_16x16x32_bf16 a[244:247], a[44:47], v[52:55], a[244:247]
    v_add_u32 v15, 0x10000, v15
    v_mfma_f32_16x16x32_bf16 a[248:251], a[48:51], v[48:51], 0
    v_mfma_f32_16x16x32_bf16 a[248:251], a[52:55], v[52:55], a[248:251]
    buffer_load_dwordx4 v3, s[16:19], s60 offen offset:1024 nt lds
    v_mfma_f32_16x16x32_bf16 a[252:255], a[56:59], v[48:51], 0
    ds_read_b64_tr_b16 v[48:49], v16 offset:32768
    ds_read_b64_tr_b16 v[50:51], v16 offset:33792
    v_mfma_f32_16x16x32_bf16 a[252:255], a[60:63], v[52:55], a[252:255]
    s_waitcnt lgkmcnt(2)
    ds_read_b64_tr_b16 v[52:53], v16 offset:40960
    ds_read_b64_tr_b16 v[54:55], v16 offset:41984
    v_mfma_f32_16x16x32_bf16 v[128:131], v[56:59], a[64:67], v[128:131]
    v_add_u32 v16, 0x10000, v16
    v_mfma_f32_16x16x32_bf16 v[128:131], v[60:63], a[68:71], v[128:131]
    v_mfma_f32_16x16x32_bf16 v[132:135], v[56:59], a[72:75], v[132:135]
    ds_read_b128 a[0:3], v22 offset:49152
    v_mfma_f32_16x16x32_bf16 v[132:135], v[60:63], a[76:79], v[132:135]
    v_mfma_f32_16x16x32_bf16 v[136:139], v[56:59], a[80:83], v[136:139]
    v_mfma_f32_16x16x32_bf16 v[136:139], v[60:63], a[84:87], v[136:139]
    buffer_load_dwordx4 v4, s[16:19], s60 offen offset:2048 nt lds
    v_mfma_f32_16x16x32_bf16 v[140:143], v[56:59], a[88:91], v[140:143]
    v_mfma_f32_16x16x32_bf16 v[140:143], v[60:63], a[92:95], v[140:143]
    ds_read_b128 a[4:7], v23 offset:49152
    v_mfma_f32_16x16x32_bf16 v[144:147], v[56:59], a[96:99], v[144:147]
    v_mfma_f32_16x16x32_bf16 v[144:147], v[60:63], a[100:103], v[144:147]
    v_mfma_f32_16x16x32_bf16 v[148:151], v[56:59], a[104:107], v[148:151]
    v_mfma_f32_16x16x32_bf16 v[148:151], v[60:63], a[108:111], v[148:151]
    v_mfma_f32_16x16x32_bf16 v[152:155], v[56:59], a[112:115], v[152:155]
    buffer_load_dwordx4 v5, s[16:19], s60 offen offset:3072 nt lds
    v_mfma_f32_16x16x32_bf16 v[152:155], v[60:63], a[116:119], v[152:155]
    ds_read_b128 a[8:11], v22 offset:51200
    v_mfma_f32_16x16x32_bf16 v[156:159], v[56:59], a[120:123], v[156:159]
    ds_read_b64_tr_b16 v[56:57], v17 offset:32768
    ds_read_b64_tr_b16 v[58:59], v17 offset:33792
    v_mfma_f32_16x16x32_bf16 v[156:159], v[60:63], a[124:127], v[156:159]
    ds_read_b64_tr_b16 v[60:61], v17 offset:40960
    ds_read_b64_tr_b16 v[62:63], v17 offset:41984
    v_mfma_f32_16x16x32_bf16 v[160:163], v[40:43], a[64:67], v[160:163]
    v_add_u32 v17, 0x10000, v17
    v_mfma_f32_16x16x32_bf16 v[160:163], v[44:47], a[68:71], v[160:163]
    v_mfma_f32_16x16x32_bf16 v[164:167], v[40:43], a[72:75], v[164:167]
    ds_read_b128 a[12:15], v23 offset:51200
    v_mfma_f32_16x16x32_bf16 v[164:167], v[44:47], a[76:79], v[164:167]
    s_add_u32 m0, s69, 49152
    v_mfma_f32_16x16x32_bf16 v[168:171], v[40:43], a[80:83], v[168:171]
    s_xor_b32 s60, s60, 524288
    buffer_load_dwordx4 v6, s[8:11], s62 offen lds
    v_mfma_f32_16x16x32_bf16 v[168:171], v[44:47], a[84:87], v[168:171]
    v_mfma_f32_16x16x32_bf16 v[172:175], v[40:43], a[88:91], v[172:175]
    v_mfma_f32_16x16x32_bf16 v[172:175], v[44:47], a[92:95], v[172:175]
    v_mfma_f32_16x16x32_bf16 v[176:179], v[40:43], a[96:99], v[176:179]
    ds_read_b128 a[16:19], v22 offset:53248
    v_mfma_f32_16x16x32_bf16 v[176:179], v[44:47], a[100:103], v[176:179]
    v_mfma_f32_16x16x32_bf16 v[180:183], v[40:43], a[104:107], v[180:183]
    v_mfma_f32_16x16x32_bf16 v[180:183], v[44:47], a[108:111], v[180:183]
    buffer_load_dwordx4 v7, s[8:11], s62 offen offset:1024 lds
    v_mfma_f32_16x16x32_bf16 v[184:187], v[40:43], a[112:115], v[184:187]
    v_mfma_f32_16x16x32_bf16 v[184:187], v[44:47], a[116:119], v[184:187]
    ds_read_b128 a[20:23], v23 offset:53248
    v_mfma_f32_16x16x32_bf16 v[188:191], v[40:43], a[120:123], v[188:191]
    s_waitcnt lgkmcnt(1)
    ds_read_b64_tr_b16 v[40:41], v14 offset:0
    ds_read_b64_tr_b16 v[42:43], v14 offset:1024
    v_mfma_f32_16x16x32_bf16 v[188:191], v[44:47], a[124:127], v[188:191]
    ds_read_b64_tr_b16 v[44:45], v14 offset:8192
    ds_read_b64_tr_b16 v[46:47], v14 offset:9216
    v_mfma_f32_16x16x32_bf16 v[192:195], v[48:51], a[64:67], v[192:195]
    v_add_u32 v14, 0xfffe0000, v14
    v_mfma_f32_16x16x32_bf16 v[192:195], v[52:55], a[68:71], v[192:195]
    v_mfma_f32_16x16x32_bf16 v[196:199], v[48:51], a[72:75], v[196:199]
    v_mfma_f32_16x16x32_bf16 v[196:199], v[52:55], a[76:79], v[196:199]
    buffer_load_dwordx4 v8, s[8:11], s62 offen offset:2048 lds
    v_mfma_f32_16x16x32_bf16 v[200:203], v[48:51], a[80:83], v[200:203]
    ds_read_b128 a[24:27], v22 offset:55296
    v_mfma_f32_16x16x32_bf16 v[200:203], v[52:55], a[84:87], v[200:203]
    v_mfma_f32_16x16x32_bf16 v[204:207], v[48:51], a[88:91], v[204:207]
    v_mfma_f32_16x16x32_bf16 v[204:207], v[52:55], a[92:95], v[204:207]
    v_mfma_f32_16x16x32_bf16 v[208:211], v[48:51], a[96:99], v[208:211]
    ds_read_b128 a[28:31], v23 offset:55296
    v_mfma_f32_16x16x32_bf16 v[208:211], v[52:55], a[100:103], v[208:211]
    v_mfma_f32_16x16x32_bf16 v[212:215], v[48:51], a[104:107], v[212:215]
    buffer_load_dwordx4 v9, s[8:11], s62 offen offset:3072 lds
    v_mfma_f32_16x16x32_bf16 v[212:215], v[52:55], a[108:111], v[212:215]
    v_mfma_f32_16x16x32_bf16 v[216:219], v[48:51], a[112:115], v[216:219]
    v_mfma_f32_16x16x32_bf16 v[216:219], v[52:55], a[116:119], v[216:219]
    v_mfma_f32_16x16x32_bf16 v[220:223], v[48:51], a[120:123], v[220:223]
    ds_read_b64_tr_b16 v[48:49], v15 offset:0
    ds_read_b64_tr_b16 v[50:51], v15 offset:1024
    v_mfma_f32_16x16x32_bf16 v[220:223], v[52:55], a[124:127], v[220:223]
    ds_read_b64_tr_b16 v[52:53], v15 offset:8192
    ds_read_b64_tr_b16 v[54:55], v15 offset:9216
    v_mfma_f32_16x16x32_bf16 v[224:227], v[56:59], a[64:67], v[224:227]
    buffer_load_dwordx2 v[80:81], v75, s[28:31], s98 offen nt
    v_mfma_f32_16x16x32_bf16 v[224:227], v[60:63], a[68:71], v[224:227]
    s_xor_b32 s62, s62, 896
    v_add_u32 v15, 0xfffe0000, v15
    v_mfma_f32_16x16x32_bf16 v[228:231], v[56:59], a[72:75], v[228:231]
    buffer_load_dword v105, v103, s[20:23], s77 offen
    v_mfma_f32_16x16x32_bf16 v[228:231], v[60:63], a[76:79], v[228:231]
    s_mul_i32 s77, s2, 18432
    v_mfma_f32_16x16x32_bf16 v[232:235], v[56:59], a[80:83], v[232:235]
    s_add_u32 s77, s77, s76
    buffer_load_dwordx2 v[82:83], v77, s[28:31], s98 offen nt
    v_mfma_f32_16x16x32_bf16 v[232:235], v[60:63], a[84:87], v[232:235]
    s_add_u32 s98, s98, 3456
    v_mfma_f32_16x16x32_bf16 v[236:239], v[56:59], a[88:91], v[236:239]
    s_add_u32 m0, s69, 65536
    v_mfma_f32_16x16x32_bf16 v[236:239], v[60:63], a[92:95], v[236:239]
    s_mov_b32 s76, 0
    v_mfma_f32_16x16x32_bf16 v[240:243], v[56:59], a[96:99], v[240:243]
    buffer_load_ushort v92, v65, s[32:35], s99 offen offset:0
    v_mfma_f32_16x16x32_bf16 v[240:243], v[60:63], a[100:103], v[240:243]
    v_mfma_f32_16x16x32_bf16 v[244:247], v[56:59], a[104:107], v[244:247]
    v_mfma_f32_16x16x32_bf16 v[244:247], v[60:63], a[108:111], v[244:247]
    v_mfma_f32_16x16x32_bf16 v[248:251], v[56:59], a[112:115], v[248:251]
    buffer_load_dwordx2 v[84:85], v75, s[28:31], s98 offen nt
    v_mfma_f32_16x16x32_bf16 v[248:251], v[60:63], a[116:119], v[248:251]
    v_mfma_f32_16x16x32_bf16 v[252:255], v[56:59], a[120:123], v[252:255]
    ds_read_b64_tr_b16 v[56:57], v16 offset:0
    ds_read_b64_tr_b16 v[58:59], v16 offset:1024
    v_mfma_f32_16x16x32_bf16 v[252:255], v[60:63], a[124:127], v[252:255]
    s_waitcnt lgkmcnt(2)
    ds_read_b64_tr_b16 v[60:61], v16 offset:8192
    ds_read_b64_tr_b16 v[62:63], v16 offset:9216
    v_mfma_f32_16x16x32_bf16 a[128:131], a[64:67], v[40:43], a[128:131]
    buffer_load_dwordx4 v2, s[12:15], s60 offen nt lds
    v_mfma_f32_16x16x32_bf16 a[128:131], a[68:71], v[44:47], a[128:131]
    v_add_u32 v22, 0x10000, v22
    v_add_u32 v16, 0xfffe0000, v16
    v_mfma_f32_16x16x32_bf16 a[132:135], a[72:75], v[40:43], a[132:135]
    ds_read_b128 a[32:35], v22 offset:16384
    v_mfma_f32_16x16x32_bf16 a[132:135], a[76:79], v[44:47], a[132:135]
    v_mfma_f32_16x16x32_bf16 a[136:139], a[80:83], v[40:43], a[136:139]
    buffer_load_dwordx2 v[86:87], v77, s[28:31], s98 offen nt
    v_mfma_f32_16x16x32_bf16 a[136:139], a[84:87], v[44:47], a[136:139]
    s_add_u32 s98, s98, 3456
    v_mfma_f32_16x16x32_bf16 a[140:143], a[88:91], v[40:43], a[140:143]
    v_add_u32 v23, 0x10000, v23
    v_mfma_f32_16x16x32_bf16 a[140:143], a[92:95], v[44:47], a[140:143]
    ds_read_b128 a[36:39], v23 offset:16384
    v_mfma_f32_16x16x32_bf16 a[144:147], a[96:99], v[40:43], a[144:147]
    buffer_load_ushort v93, v65, s[32:35], s99 offen offset:2
    v_mfma_f32_16x16x32_bf16 a[144:147], a[100:103], v[44:47], a[144:147]
    v_mfma_f32_16x16x32_bf16 a[148:151], a[104:107], v[40:43], a[148:151]
    v_mfma_f32_16x16x32_bf16 a[148:151], a[108:111], v[44:47], a[148:151]
    v_mfma_f32_16x16x32_bf16 a[152:155], a[112:115], v[40:43], a[152:155]
    buffer_load_dwordx2 v[88:89], v75, s[28:31], s98 offen nt
    v_mfma_f32_16x16x32_bf16 a[152:155], a[116:119], v[44:47], a[152:155]
    ds_read_b128 a[40:43], v22 offset:18432
    v_mfma_f32_16x16x32_bf16 a[156:159], a[120:123], v[40:43], a[156:159]
    ds_read_b64_tr_b16 v[40:41], v17 offset:0
    ds_read_b64_tr_b16 v[42:43], v17 offset:1024
    v_mfma_f32_16x16x32_bf16 a[156:159], a[124:127], v[44:47], a[156:159]
    ds_read_b64_tr_b16 v[44:45], v17 offset:8192
    ds_read_b64_tr_b16 v[46:47], v17 offset:9216
    v_mfma_f32_16x16x32_bf16 a[160:163], a[64:67], v[48:51], a[160:163]
    buffer_load_dwordx4 v3, s[12:15], s60 offen offset:1024 nt lds
    v_mfma_f32_16x16x32_bf16 a[160:163], a[68:71], v[52:55], a[160:163]
    v_add_u32 v17, 0xfffe0000, v17
    v_mfma_f32_16x16x32_bf16 a[164:167], a[72:75], v[48:51], a[164:167]
    ds_read_b128 a[44:47], v23 offset:18432
    v_mfma_f32_16x16x32_bf16 a[164:167], a[76:79], v[52:55], a[164:167]
    v_mfma_f32_16x16x32_bf16 a[168:171], a[80:83], v[48:51], a[168:171]
    buffer_load_dwordx2 v[90:91], v77, s[28:31], s98 offen nt
    v_mfma_f32_16x16x32_bf16 a[168:171], a[84:87], v[52:55], a[168:171]
    s_add_u32 s98, s98, 3456
    s_add_u32 s28, s56, 6291456
    s_addc_u32 s29, s57, 0
    v_mfma_f32_16x16x32_bf16 a[172:175], a[88:91], v[48:51], a[172:175]
    s_mov_b32 s30, 2359296
    v_mfma_f32_16x16x32_bf16 a[172:175], a[92:95], v[52:55], a[172:175]
    s_bfe_u32 s98, s72, 0x10001
    v_mfma_f32_16x16x32_bf16 a[176:179], a[96:99], v[48:51], a[176:179]
    buffer_load_ushort v94, v65, s[32:35], s99 offen offset:4
    v_mfma_f32_16x16x32_bf16 a[176:179], a[100:103], v[52:55], a[176:179]
    s_add_u32 s32, s56, 9437184
    s_addc_u32 s33, s57, 0
    s_mov_b32 s34, 196608
    v_mfma_f32_16x16x32_bf16 a[180:183], a[104:107], v[48:51], a[180:183]
    s_bfe_u32 s99, s72, 0x10003
    ds_read_b128 a[48:51], v22 offset:20480
    v_mfma_f32_16x16x32_bf16 a[180:183], a[108:111], v[52:55], a[180:183]
    s_lshl1_add_u32 s98, s99, s98
    v_mfma_f32_16x16x32_bf16 a[184:187], a[112:115], v[48:51], a[184:187]
    s_lshl_b32 s98, s98, 5
    buffer_store_dword v65, v64, s[32:35], s101 offen sc1
    v_mfma_f32_16x16x32_bf16 a[184:187], a[116:119], v[52:55], a[184:187]
    s_lshl_b32 s72, s72, 7
    ds_read_b128 a[52:55], v23 offset:20480
    v_mfma_f32_16x16x32_bf16 a[188:191], a[120:123], v[48:51], a[188:191]
    v_mfma_f32_16x16x32_bf16 a[188:191], a[124:127], v[52:55], a[188:191]
    s_waitcnt lgkmcnt(1)
    v_mfma_f32_16x16x32_bf16 a[192:195], a[64:67], v[56:59], a[192:195]
    buffer_load_dwordx4 v4, s[12:15], s60 offen offset:2048 nt lds
    v_mfma_f32_16x16x32_bf16 a[192:195], a[68:71], v[60:63], a[192:195]
    v_mfma_f32_16x16x32_bf16 a[196:199], a[72:75], v[56:59], a[196:199]
    v_mfma_f32_16x16x32_bf16 a[196:199], a[76:79], v[60:63], a[196:199]
    ds_read_b128 a[56:59], v22 offset:22528
    v_mfma_f32_16x16x32_bf16 a[200:203], a[80:83], v[56:59], a[200:203]
    buffer_load_dwordx4 v5, s[12:15], s60 offen offset:3072 nt lds
    v_mfma_f32_16x16x32_bf16 a[200:203], a[84:87], v[60:63], a[200:203]
    s_add_u32 m0, s69, 81920
    v_mfma_f32_16x16x32_bf16 a[204:207], a[88:91], v[56:59], a[204:207]
    v_mfma_f32_16x16x32_bf16 a[204:207], a[92:95], v[60:63], a[204:207]
    v_mfma_f32_16x16x32_bf16 a[208:211], a[96:99], v[56:59], a[208:211]
    buffer_load_dwordx4 v6, s[8:11], s61 offen lds
    v_mfma_f32_16x16x32_bf16 a[208:211], a[100:103], v[60:63], a[208:211]
    ds_read_b128 a[60:63], v23 offset:22528
    v_mfma_f32_16x16x32_bf16 a[212:215], a[104:107], v[56:59], a[212:215]
    v_mfma_f32_16x16x32_bf16 a[212:215], a[108:111], v[60:63], a[212:215]
    v_mfma_f32_16x16x32_bf16 a[216:219], a[112:115], v[56:59], a[216:219]
    buffer_load_dwordx4 v7, s[8:11], s61 offen offset:1024 lds
    v_mfma_f32_16x16x32_bf16 a[216:219], a[116:119], v[60:63], a[216:219]
    v_mfma_f32_16x16x32_bf16 a[220:223], a[120:123], v[56:59], a[220:223]
    v_mfma_f32_16x16x32_bf16 a[220:223], a[124:127], v[60:63], a[220:223]
    v_mfma_f32_16x16x32_bf16 a[224:227], a[64:67], v[40:43], a[224:227]
    buffer_load_dwordx4 v8, s[8:11], s61 offen offset:2048 lds
    v_mfma_f32_16x16x32_bf16 a[224:227], a[68:71], v[44:47], a[224:227]
    v_mfma_f32_16x16x32_bf16 a[228:231], a[72:75], v[40:43], a[228:231]
    v_mfma_f32_16x16x32_bf16 a[228:231], a[76:79], v[44:47], a[228:231]
    v_mfma_f32_16x16x32_bf16 a[232:235], a[80:83], v[40:43], a[232:235]
    buffer_load_dwordx4 v9, s[8:11], s61 offen offset:3072 lds
    v_mfma_f32_16x16x32_bf16 a[232:235], a[84:87], v[44:47], a[232:235]
    s_xor_b32 s61, s61, 128
    s_waitcnt vmcnt(19) lgkmcnt(0)
    s_barrier
    v_mfma_f32_16x16x32_bf16 a[236:239], a[88:91], v[40:43], a[236:239]
    s_add_u32 m0, s69, 98304
    ds_read_b64_tr_b16 v[48:49], v14 offset:0
    ds_read_b64_tr_b16 v[50:51], v14 offset:1024
    v_mfma_f32_16x16x32_bf16 a[236:239], a[92:95], v[44:47], a[236:239]
    ds_read_b64_tr_b16 v[52:53], v14 offset:8192
    ds_read_b64_tr_b16 v[54:55], v14 offset:9216
    v_mfma_f32_16x16x32_bf16 a[240:243], a[96:99], v[40:43], a[240:243]
    buffer_load_dwordx4 v2, s[16:19], s60 offen nt lds
    v_mfma_f32_16x16x32_bf16 a[240:243], a[100:103], v[44:47], a[240:243]
    ds_read_b64_tr_b16 v[56:57], v15 offset:0
    ds_read_b64_tr_b16 v[58:59], v15 offset:1024
    v_mfma_f32_16x16x32_bf16 a[244:247], a[104:107], v[40:43], a[244:247]
    ds_read_b64_tr_b16 v[60:61], v15 offset:8192
    ds_read_b64_tr_b16 v[62:63], v15 offset:9216
    v_mfma_f32_16x16x32_bf16 a[244:247], a[108:111], v[44:47], a[244:247]
    s_cmp_lt_u32 s2, 192
    s_cselect_b32 s72, s72, 1073741824
    v_mfma_f32_16x16x32_bf16 a[248:251], a[112:115], v[40:43], a[248:251]
    v_mfma_f32_16x16x32_bf16 a[248:251], a[116:119], v[44:47], a[248:251]
    buffer_load_dwordx4 v3, s[16:19], s60 offen offset:1024 nt lds
    v_mfma_f32_16x16x32_bf16 a[252:255], a[120:123], v[40:43], a[252:255]
    ds_read_b64_tr_b16 v[40:41], v16 offset:0
    ds_read_b64_tr_b16 v[42:43], v16 offset:1024
    v_mfma_f32_16x16x32_bf16 a[252:255], a[124:127], v[44:47], a[252:255]
    s_waitcnt lgkmcnt(2)
    ds_read_b64_tr_b16 v[44:45], v16 offset:8192
    ds_read_b64_tr_b16 v[46:47], v16 offset:9216
    v_mfma_f32_16x16x32_bf16 v[128:131], v[48:51], a[0:3], v[128:131]
    v_mfma_f32_16x16x32_bf16 v[128:131], v[52:55], a[4:7], v[128:131]
    v_add_u32 v22, 0xfffe0000, v22
    v_mfma_f32_16x16x32_bf16 v[132:135], v[48:51], a[8:11], v[132:135]
    ds_read_b128 a[64:67], v22 offset:16384
    v_mfma_f32_16x16x32_bf16 v[132:135], v[52:55], a[12:15], v[132:135]
    v_mfma_f32_16x16x32_bf16 v[136:139], v[48:51], a[16:19], v[136:139]
    v_mfma_f32_16x16x32_bf16 v[136:139], v[52:55], a[20:23], v[136:139]
    buffer_load_dwordx4 v4, s[16:19], s60 offen offset:2048 nt lds
    v_mfma_f32_16x16x32_bf16 v[140:143], v[48:51], a[24:27], v[140:143]
    v_add_u32 v23, 0xfffe0000, v23
    v_mfma_f32_16x16x32_bf16 v[140:143], v[52:55], a[28:31], v[140:143]
    ds_read_b128 a[68:71], v23 offset:16384
    v_mfma_f32_16x16x32_bf16 v[144:147], v[48:51], a[32:35], v[144:147]
    v_mfma_f32_16x16x32_bf16 v[144:147], v[52:55], a[36:39], v[144:147]
    v_mfma_f32_16x16x32_bf16 v[148:151], v[48:51], a[40:43], v[148:151]
    v_mfma_f32_16x16x32_bf16 v[148:151], v[52:55], a[44:47], v[148:151]
    v_mfma_f32_16x16x32_bf16 v[152:155], v[48:51], a[48:51], v[152:155]
    buffer_load_dwordx4 v5, s[16:19], s60 offen offset:3072 nt lds
    v_mfma_f32_16x16x32_bf16 v[152:155], v[52:55], a[52:55], v[152:155]
    ds_read_b128 a[72:75], v22 offset:18432
    v_mfma_f32_16x16x32_bf16 v[156:159], v[48:51], a[56:59], v[156:159]
    ds_read_b64_tr_b16 v[48:49], v17 offset:0
    ds_read_b64_tr_b16 v[50:51], v17 offset:1024
    v_mfma_f32_16x16x32_bf16 v[156:159], v[52:55], a[60:63], v[156:159]
    ds_read_b64_tr_b16 v[52:53], v17 offset:8192
    ds_read_b64_tr_b16 v[54:55], v17 offset:9216
    v_mfma_f32_16x16x32_bf16 v[160:163], v[56:59], a[0:3], v[160:163]
    v_mfma_f32_16x16x32_bf16 v[160:163], v[60:63], a[4:7], v[160:163]
    v_mfma_f32_16x16x32_bf16 v[164:167], v[56:59], a[8:11], v[164:167]
    ds_read_b128 a[76:79], v23 offset:18432
    v_mfma_f32_16x16x32_bf16 v[164:167], v[60:63], a[12:15], v[164:167]
    s_add_u32 m0, s69, 114688
    v_mfma_f32_16x16x32_bf16 v[168:171], v[56:59], a[16:19], v[168:171]
    s_xor_b32 s60, s60, 3670016
    buffer_load_dwordx4 v6, s[8:11], s62 offen lds
    v_mfma_f32_16x16x32_bf16 v[168:171], v[60:63], a[20:23], v[168:171]
    v_mfma_f32_16x16x32_bf16 v[172:175], v[56:59], a[24:27], v[172:175]
    v_mfma_f32_16x16x32_bf16 v[172:175], v[60:63], a[28:31], v[172:175]
    v_mfma_f32_16x16x32_bf16 v[176:179], v[56:59], a[32:35], v[176:179]
    ds_read_b128 a[80:83], v22 offset:20480
    v_mfma_f32_16x16x32_bf16 v[176:179], v[60:63], a[36:39], v[176:179]
    v_mfma_f32_16x16x32_bf16 v[180:183], v[56:59], a[40:43], v[180:183]
    v_mfma_f32_16x16x32_bf16 v[180:183], v[60:63], a[44:47], v[180:183]
    buffer_load_dwordx4 v7, s[8:11], s62 offen offset:1024 lds
    v_mfma_f32_16x16x32_bf16 v[184:187], v[56:59], a[48:51], v[184:187]
    v_mfma_f32_16x16x32_bf16 v[184:187], v[60:63], a[52:55], v[184:187]
    ds_read_b128 a[84:87], v23 offset:20480
    v_mfma_f32_16x16x32_bf16 v[188:191], v[56:59], a[56:59], v[188:191]
    s_waitcnt lgkmcnt(1)
    ds_read_b64_tr_b16 v[56:57], v14 offset:32768
    ds_read_b64_tr_b16 v[58:59], v14 offset:33792
    v_mfma_f32_16x16x32_bf16 v[188:191], v[60:63], a[60:63], v[188:191]
    ds_read_b64_tr_b16 v[60:61], v14 offset:40960
    ds_read_b64_tr_b16 v[62:63], v14 offset:41984
    v_mfma_f32_16x16x32_bf16 v[192:195], v[40:43], a[0:3], v[192:195]
    v_add_u32 v14, 0x10000, v14
    v_mfma_f32_16x16x32_bf16 v[192:195], v[44:47], a[4:7], v[192:195]
    v_mfma_f32_16x16x32_bf16 v[196:199], v[40:43], a[8:11], v[196:199]
    v_mfma_f32_16x16x32_bf16 v[196:199], v[44:47], a[12:15], v[196:199]
    buffer_load_dwordx4 v8, s[8:11], s62 offen offset:2048 lds
    v_mfma_f32_16x16x32_bf16 v[200:203], v[40:43], a[16:19], v[200:203]
    ds_read_b128 a[88:91], v22 offset:22528
    v_mfma_f32_16x16x32_bf16 v[200:203], v[44:47], a[20:23], v[200:203]
    v_mfma_f32_16x16x32_bf16 v[204:207], v[40:43], a[24:27], v[204:207]
    v_mfma_f32_16x16x32_bf16 v[204:207], v[44:47], a[28:31], v[204:207]
    v_mfma_f32_16x16x32_bf16 v[208:211], v[40:43], a[32:35], v[208:211]
    ds_read_b128 a[92:95], v23 offset:22528
    v_mfma_f32_16x16x32_bf16 v[208:211], v[44:47], a[36:39], v[208:211]
    v_mfma_f32_16x16x32_bf16 v[212:215], v[40:43], a[40:43], v[212:215]
    buffer_load_dwordx4 v9, s[8:11], s62 offen offset:3072 lds
    v_mfma_f32_16x16x32_bf16 v[212:215], v[44:47], a[44:47], v[212:215]
    v_mfma_f32_16x16x32_bf16 v[216:219], v[40:43], a[48:51], v[216:219]
    v_mfma_f32_16x16x32_bf16 v[216:219], v[44:47], a[52:55], v[216:219]
    v_mfma_f32_16x16x32_bf16 v[220:223], v[40:43], a[56:59], v[220:223]
    ds_read_b64_tr_b16 v[40:41], v15 offset:32768
    ds_read_b64_tr_b16 v[42:43], v15 offset:33792
    v_mfma_f32_16x16x32_bf16 v[220:223], v[44:47], a[60:63], v[220:223]
    ds_read_b64_tr_b16 v[44:45], v15 offset:40960
    ds_read_b64_tr_b16 v[46:47], v15 offset:41984
    v_mfma_f32_16x16x32_bf16 v[224:227], v[48:51], a[0:3], v[224:227]
    v_add_u32 v15, 0x10000, v15
    v_mfma_f32_16x16x32_bf16 v[224:227], v[52:55], a[4:7], v[224:227]
    s_xor_b32 s62, s62, 128
    v_mfma_f32_16x16x32_bf16 v[228:231], v[48:51], a[8:11], v[228:231]
    buffer_load_dword v106, v103, s[24:27], s77 offen
    v_mfma_f32_16x16x32_bf16 v[228:231], v[52:55], a[12:15], v[228:231]
    s_add_u32 s77, s77, 4608
    v_mfma_f32_16x16x32_bf16 v[232:235], v[48:51], a[16:19], v[232:235]
    v_mfma_f32_16x16x32_bf16 v[232:235], v[52:55], a[20:23], v[232:235]
    s_add_u32 m0, s69, 131072
    v_mfma_f32_16x16x32_bf16 v[236:239], v[48:51], a[24:27], v[236:239]
    buffer_load_dwordx4 v2, s[12:15], s60 offen nt lds
    v_mfma_f32_16x16x32_bf16 v[236:239], v[52:55], a[28:31], v[236:239]
    v_mfma_f32_16x16x32_bf16 v[240:243], v[48:51], a[32:35], v[240:243]
    v_mfma_f32_16x16x32_bf16 v[240:243], v[52:55], a[36:39], v[240:243]
    v_mfma_f32_16x16x32_bf16 v[244:247], v[48:51], a[40:43], v[244:247]
    v_mfma_f32_16x16x32_bf16 v[244:247], v[52:55], a[44:47], v[244:247]
    v_mfma_f32_16x16x32_bf16 v[248:251], v[48:51], a[48:51], v[248:251]
    v_mfma_f32_16x16x32_bf16 v[248:251], v[52:55], a[52:55], v[248:251]
    buffer_load_dwordx4 v3, s[12:15], s60 offen offset:1024 nt lds
    v_mfma_f32_16x16x32_bf16 v[252:255], v[48:51], a[56:59], v[252:255]
    ds_read_b64_tr_b16 v[48:49], v16 offset:32768
    ds_read_b64_tr_b16 v[50:51], v16 offset:33792
    v_mfma_f32_16x16x32_bf16 v[252:255], v[52:55], a[60:63], v[252:255]
    s_waitcnt lgkmcnt(2)
    ds_read_b64_tr_b16 v[52:53], v16 offset:40960
    ds_read_b64_tr_b16 v[54:55], v16 offset:41984
    v_mfma_f32_16x16x32_bf16 a[128:131], a[0:3], v[56:59], a[128:131]
    v_add_u32 v16, 0x10000, v16
    v_mfma_f32_16x16x32_bf16 a[128:131], a[4:7], v[60:63], a[128:131]
    v_mfma_f32_16x16x32_bf16 a[132:135], a[8:11], v[56:59], a[132:135]
    ds_read_b128 a[96:99], v22 offset:49152
    v_mfma_f32_16x16x32_bf16 a[132:135], a[12:15], v[60:63], a[132:135]
    v_mfma_f32_16x16x32_bf16 a[136:139], a[16:19], v[56:59], a[136:139]
    v_mfma_f32_16x16x32_bf16 a[136:139], a[20:23], v[60:63], a[136:139]
    buffer_load_dwordx4 v4, s[12:15], s60 offen offset:2048 nt lds
    v_mfma_f32_16x16x32_bf16 a[140:143], a[24:27], v[56:59], a[140:143]
    v_mfma_f32_16x16x32_bf16 a[140:143], a[28:31], v[60:63], a[140:143]
    ds_read_b128 a[100:103], v23 offset:49152
    v_mfma_f32_16x16x32_bf16 a[144:147], a[32:35], v[56:59], a[144:147]
    v_mfma_f32_16x16x32_bf16 a[144:147], a[36:39], v[60:63], a[144:147]
    v_mfma_f32_16x16x32_bf16 a[148:151], a[40:43], v[56:59], a[148:151]
    v_mfma_f32_16x16x32_bf16 a[148:151], a[44:47], v[60:63], a[148:151]
    v_mfma_f32_16x16x32_bf16 a[152:155], a[48:51], v[56:59], a[152:155]
    buffer_load_dwordx4 v5, s[12:15], s60 offen offset:3072 nt lds
    v_mfma_f32_16x16x32_bf16 a[152:155], a[52:55], v[60:63], a[152:155]
    ds_read_b128 a[104:107], v22 offset:51200
    v_mfma_f32_16x16x32_bf16 a[156:159], a[56:59], v[56:59], a[156:159]
    ds_read_b64_tr_b16 v[56:57], v17 offset:32768
    ds_read_b64_tr_b16 v[58:59], v17 offset:33792
    v_mfma_f32_16x16x32_bf16 a[156:159], a[60:63], v[60:63], a[156:159]
    ds_read_b64_tr_b16 v[60:61], v17 offset:40960
    ds_read_b64_tr_b16 v[62:63], v17 offset:41984
    v_mfma_f32_16x16x32_bf16 a[160:163], a[0:3], v[40:43], a[160:163]
    v_add_u32 v17, 0x10000, v17
    v_mfma_f32_16x16x32_bf16 a[160:163], a[4:7], v[44:47], a[160:163]
    v_mfma_f32_16x16x32_bf16 a[164:167], a[8:11], v[40:43], a[164:167]
    ds_read_b128 a[108:111], v23 offset:51200
    v_mfma_f32_16x16x32_bf16 a[164:167], a[12:15], v[44:47], a[164:167]
    s_add_u32 m0, s69, 147456
    v_mfma_f32_16x16x32_bf16 a[168:171], a[16:19], v[40:43], a[168:171]
    buffer_load_dwordx4 v6, s[8:11], s61 offen lds
    v_mfma_f32_16x16x32_bf16 a[168:171], a[20:23], v[44:47], a[168:171]
    v_mfma_f32_16x16x32_bf16 a[172:175], a[24:27], v[40:43], a[172:175]
    v_mfma_f32_16x16x32_bf16 a[172:175], a[28:31], v[44:47], a[172:175]
    v_mfma_f32_16x16x32_bf16 a[176:179], a[32:35], v[40:43], a[176:179]
    ds_read_b128 a[112:115], v22 offset:53248
    v_mfma_f32_16x16x32_bf16 a[176:179], a[36:39], v[44:47], a[176:179]
    v_mfma_f32_16x16x32_bf16 a[180:183], a[40:43], v[40:43], a[180:183]
    v_mfma_f32_16x16x32_bf16 a[180:183], a[44:47], v[44:47], a[180:183]
    buffer_load_dwordx4 v7, s[8:11], s61 offen offset:1024 lds
    v_mfma_f32_16x16x32_bf16 a[184:187], a[48:51], v[40:43], a[184:187]
    v_mfma_f32_16x16x32_bf16 a[184:187], a[52:55], v[44:47], a[184:187]
    ds_read_b128 a[116:119], v23 offset:53248
    v_mfma_f32_16x16x32_bf16 a[188:191], a[56:59], v[40:43], a[188:191]
    v_mfma_f32_16x16x32_bf16 a[188:191], a[60:63], v[44:47], a[188:191]
    s_waitcnt lgkmcnt(1)
    v_mfma_f32_16x16x32_bf16 a[192:195], a[0:3], v[48:51], a[192:195]
    v_mfma_f32_16x16x32_bf16 a[192:195], a[4:7], v[52:55], a[192:195]
    v_mfma_f32_16x16x32_bf16 a[196:199], a[8:11], v[48:51], a[196:199]
    v_mfma_f32_16x16x32_bf16 a[196:199], a[12:15], v[52:55], a[196:199]
    buffer_load_dwordx4 v8, s[8:11], s61 offen offset:2048 lds
    v_mfma_f32_16x16x32_bf16 a[200:203], a[16:19], v[48:51], a[200:203]
    ds_read_b128 a[120:123], v22 offset:55296
    v_mfma_f32_16x16x32_bf16 a[200:203], a[20:23], v[52:55], a[200:203]
    v_mfma_f32_16x16x32_bf16 a[204:207], a[24:27], v[48:51], a[204:207]
    v_mfma_f32_16x16x32_bf16 a[204:207], a[28:31], v[52:55], a[204:207]
    v_mfma_f32_16x16x32_bf16 a[208:211], a[32:35], v[48:51], a[208:211]
    ds_read_b128 a[124:127], v23 offset:55296
    v_mfma_f32_16x16x32_bf16 a[208:211], a[36:39], v[52:55], a[208:211]
    v_mfma_f32_16x16x32_bf16 a[212:215], a[40:43], v[48:51], a[212:215]
    buffer_load_dwordx4 v9, s[8:11], s61 offen offset:3072 lds
    v_mfma_f32_16x16x32_bf16 a[212:215], a[44:47], v[52:55], a[212:215]
    v_mfma_f32_16x16x32_bf16 a[216:219], a[48:51], v[48:51], a[216:219]
    v_mfma_f32_16x16x32_bf16 a[216:219], a[52:55], v[52:55], a[216:219]
    v_mfma_f32_16x16x32_bf16 a[220:223], a[56:59], v[48:51], a[220:223]
    v_mfma_f32_16x16x32_bf16 a[220:223], a[60:63], v[52:55], a[220:223]
    v_mfma_f32_16x16x32_bf16 a[224:227], a[0:3], v[56:59], a[224:227]
    v_mfma_f32_16x16x32_bf16 a[224:227], a[4:7], v[60:63], a[224:227]
    s_xor_b32 s61, s61, 384
    v_mfma_f32_16x16x32_bf16 a[228:231], a[8:11], v[56:59], a[228:231]
    v_mfma_f32_16x16x32_bf16 a[228:231], a[12:15], v[60:63], a[228:231]
    v_mfma_f32_16x16x32_bf16 a[232:235], a[16:19], v[56:59], a[232:235]
    v_mfma_f32_16x16x32_bf16 a[232:235], a[20:23], v[60:63], a[232:235]
    s_waitcnt vmcnt(9) lgkmcnt(0)
    s_barrier
    ds_read_b64_tr_b16 v[40:41], v14 offset:0
    v_mfma_f32_16x16x32_bf16 a[236:239], a[24:27], v[56:59], a[236:239]
    s_add_u32 m0, s69, 0
    ds_read_b64_tr_b16 v[42:43], v14 offset:1024
    ds_read_b64_tr_b16 v[44:45], v14 offset:8192
    v_mfma_f32_16x16x32_bf16 a[236:239], a[28:31], v[60:63], a[236:239]
    buffer_load_dwordx4 v2, s[16:19], s60 offen nt lds
    v_mfma_f32_16x16x32_bf16 a[240:243], a[32:35], v[56:59], a[240:243]
    ds_read_b64_tr_b16 v[46:47], v14 offset:9216
    v_cndmask_b32_e64 v83, v83, 0, s[92:93]
    v_mfma_f32_16x16x32_bf16 a[240:243], a[36:39], v[60:63], a[240:243]
    v_cndmask_b32_e64 v81, v81, 0, vcc
    v_cndmask_b32 v82, v82, v92, s[92:93]
    v_mfma_f32_16x16x32_bf16 a[244:247], a[40:43], v[56:59], a[244:247]
    s_mov_b32 vcc_lo, 0x10101010
    s_mov_b32 vcc_hi, 0x10101010
    v_cndmask_b32_e64 v83, v83, 0, vcc
    v_mfma_f32_16x16x32_bf16 a[244:247], a[44:47], v[60:63], a[244:247]
    v_xor_b32 v92, s98, v95
    ds_read_b64_tr_b16 v[48:49], v15 offset:0
    v_mfma_f32_16x16x32_bf16 a[248:251], a[48:51], v[56:59], a[248:251]
    buffer_store_dwordx4 v[80:83], v92, s[28:31], s72 offen sc1
    v_mfma_f32_16x16x32_bf16 a[248:251], a[52:55], v[60:63], a[248:251]
    s_mul_i32 s72, s2, 3
    buffer_load_dwordx4 v3, s[16:19], s60 offen offset:1024 nt lds
    v_mfma_f32_16x16x32_bf16 a[252:255], a[56:59], v[56:59], a[252:255]
    s_add_u32 s72, s72, 1
    ds_read_b64_tr_b16 v[50:51], v15 offset:1024
    ds_read_b64_tr_b16 v[52:53], v15 offset:8192
    v_mfma_f32_16x16x32_bf16 a[252:255], a[60:63], v[60:63], a[252:255]
    s_bfe_u32 s98, s72, 0x10001
    ds_read_b64_tr_b16 v[54:55], v15 offset:9216
    v_cndmask_b32_e64 v87, v87, 0, s[92:93]
    s_waitcnt lgkmcnt(4)
    v_mfma_f32_16x16x32_bf16 v[128:131], v[40:43], a[64:67], v[128:131]
    s_bfe_u32 s99, s72, 0x10003
    v_cndmask_b32 v86, v86, v93, s[92:93]
    v_cndmask_b32_e64 v91, v91, 0, s[92:93]
    v_mfma_f32_16x16x32_bf16 v[128:131], v[44:47], a[68:71], v[128:131]
    s_lshl1_add_u32 s98, s99, s98
    v_add_u32 v22, 0x10000, v22
    v_cndmask_b32 v90, v90, v94, s[92:93]
    v_mfma_f32_16x16x32_bf16 v[132:135], v[40:43], a[72:75], v[132:135]
    s_lshl_b32 s98, s98, 5
    ds_read_b128 a[0:3], v22 offset:16384
    v_xor_b32 v93, s98, v95
    v_mfma_f32_16x16x32_bf16 v[132:135], v[44:47], a[76:79], v[132:135]
    s_mov_b32 vcc_lo, 0x84848484
    s_mov_b32 vcc_hi, 0x84848484
    v_cndmask_b32_e64 v85, v85, 0, vcc
    v_mfma_f32_16x16x32_bf16 v[136:139], v[40:43], a[80:83], v[136:139]
    s_mov_b32 vcc_lo, 0x10101010
    s_mov_b32 vcc_hi, 0x10101010
    v_cndmask_b32_e64 v87, v87, 0, vcc
    v_mfma_f32_16x16x32_bf16 v[136:139], v[44:47], a[84:87], v[136:139]
    s_lshl_b32 s72, s72, 7
    buffer_load_dwordx4 v4, s[16:19], s60 offen offset:2048 nt lds
    v_mfma_f32_16x16x32_bf16 v[140:143], v[40:43], a[88:91], v[140:143]
    v_add_u32 v23, 0x10000, v23
    ds_read_b64_tr_b16 v[56:57], v16 offset:0
    v_mfma_f32_16x16x32_bf16 v[140:143], v[44:47], a[92:95], v[140:143]
    ds_read_b128 a[4:7], v23 offset:16384
    ds_read_b64_tr_b16 v[58:59], v16 offset:1024
    v_mfma_f32_16x16x32_bf16 v[144:147], v[40:43], a[96:99], v[144:147]
    s_cmp_lt_u32 s2, 192
    s_cselect_b32 s72, s72, 1073741824
    ds_read_b64_tr_b16 v[60:61], v16 offset:8192
    v_mfma_f32_16x16x32_bf16 v[144:147], v[44:47], a[100:103], v[144:147]
    buffer_store_dwordx4 v[84:87], v93, s[28:31], s72 offen sc1
    v_mfma_f32_16x16x32_bf16 v[148:151], v[40:43], a[104:107], v[148:151]
    s_mul_i32 s72, s2, 3
    ds_read_b64_tr_b16 v[62:63], v16 offset:9216
    v_mfma_f32_16x16x32_bf16 v[148:151], v[44:47], a[108:111], v[148:151]
    s_add_u32 s72, s72, 2
    v_mfma_f32_16x16x32_bf16 v[152:155], v[40:43], a[112:115], v[152:155]
    s_bfe_u32 s98, s72, 0x10001
    buffer_load_dwordx4 v5, s[16:19], s60 offen offset:3072 nt lds
    v_mfma_f32_16x16x32_bf16 v[152:155], v[44:47], a[116:119], v[152:155]
    s_bfe_u32 s99, s72, 0x10003
    ds_read_b128 a[8:11], v22 offset:18432
    v_mfma_f32_16x16x32_bf16 v[156:159], v[40:43], a[120:123], v[156:159]
    s_mov_b32 vcc_lo, 0x84848484
    s_mov_b32 vcc_hi, 0x84848484
    v_cndmask_b32_e64 v89, v89, 0, vcc
    v_mfma_f32_16x16x32_bf16 v[156:159], v[44:47], a[124:127], v[156:159]
    s_lshl1_add_u32 s98, s99, s98
    ds_read_b64_tr_b16 v[40:41], v17 offset:0
    ds_read_b64_tr_b16 v[42:43], v17 offset:1024
    s_waitcnt lgkmcnt(3)
    v_mfma_f32_16x16x32_bf16 v[160:163], v[48:51], a[64:67], v[160:163]
    s_mov_b32 vcc_lo, 0x10101010
    s_mov_b32 vcc_hi, 0x10101010
    v_cndmask_b32_e64 v91, v91, 0, vcc
    v_mfma_f32_16x16x32_bf16 v[160:163], v[52:55], a[68:71], v[160:163]
    s_lshl_b32 s98, s98, 5
    v_xor_b32 v94, s98, v95
    ds_read_b64_tr_b16 v[44:45], v17 offset:8192
    v_mfma_f32_16x16x32_bf16 v[164:167], v[48:51], a[72:75], v[164:167]
    s_lshl_b32 s72, s72, 7
    ds_read_b128 a[12:15], v23 offset:18432
    ds_read_b64_tr_b16 v[46:47], v17 offset:9216
    v_mfma_f32_16x16x32_bf16 v[164:167], v[52:55], a[76:79], v[164:167]
    s_add_u32 m0, s69, 16384
    v_mfma_f32_16x16x32_bf16 v[168:171], v[48:51], a[80:83], v[168:171]
    s_xor_b32 s60, s60, 524288
    buffer_load_dwordx4 v6, s[8:11], s62 offen lds
    v_mfma_f32_16x16x32_bf16 v[168:171], v[52:55], a[84:87], v[168:171]
    s_cmp_lt_u32 s2, 192
    s_cselect_b32 s72, s72, 1073741824
    v_mfma_f32_16x16x32_bf16 v[172:175], v[48:51], a[88:91], v[172:175]
    s_bfe_u32 s98, s5, 0x20001
    buffer_store_dwordx4 v[88:91], v94, s[28:31], s72 offen sc1
    v_mfma_f32_16x16x32_bf16 v[172:175], v[52:55], a[92:95], v[172:175]
    s_add_u32 s28, s28, s7
    s_addc_u32 s29, s29, 0
    v_mfma_f32_16x16x32_bf16 v[176:179], v[48:51], a[96:99], v[176:179]
    s_mov_b32 s30, 73728
    ds_read_b128 a[16:19], v22 offset:20480
    v_mfma_f32_16x16x32_bf16 v[176:179], v[52:55], a[100:103], v[176:179]
    s_and_b32 s7, s5, 24
    v_mfma_f32_16x16x32_bf16 v[180:183], v[48:51], a[104:107], v[180:183]
    s_add_u32 s7, s7, s6
    v_mfma_f32_16x16x32_bf16 v[180:183], v[52:55], a[108:111], v[180:183]
    s_lshl2_add_u32 s7, s7, s98
    buffer_load_dwordx4 v7, s[8:11], s62 offen offset:1024 lds
    v_mfma_f32_16x16x32_bf16 v[184:187], v[48:51], a[112:115], v[184:187]
    s_mul_i32 s98, s7, 36864
    v_add_u32 v36, s98, v36
    v_sub_u32 v39, v36, v39
    v_mfma_f32_16x16x32_bf16 v[184:187], v[52:55], a[116:119], v[184:187]
    s_lshl2_add_u32 s99, s100, s4
    ds_read_b128 a[20:23], v23 offset:20480
    v_lshl_add_u32 v36, s100, 6, v36
    v_mfma_f32_16x16x32_bf16 v[188:191], v[48:51], a[120:123], v[188:191]
    s_lshl_b32 s99, s99, 7
    ds_read_b64_tr_b16 v[48:49], v14 offset:32768
    ds_read_b64_tr_b16 v[50:51], v14 offset:33792
    v_mfma_f32_16x16x32_bf16 v[188:191], v[52:55], a[124:127], v[188:191]
    ds_read_b64_tr_b16 v[52:53], v14 offset:40960
    ds_read_b64_tr_b16 v[54:55], v14 offset:41984
    v_mfma_f32_16x16x32_bf16 v[192:195], v[56:59], a[64:67], v[192:195]
    v_add_u32 v14, 0x10000, v14
    v_mfma_f32_16x16x32_bf16 v[192:195], v[60:63], a[68:71], v[192:195]
    v_mfma_f32_16x16x32_bf16 v[196:199], v[56:59], a[72:75], v[196:199]
    v_mfma_f32_16x16x32_bf16 v[196:199], v[60:63], a[76:79], v[196:199]
    buffer_load_dwordx4 v8, s[8:11], s62 offen offset:2048 lds
    v_mfma_f32_16x16x32_bf16 v[200:203], v[56:59], a[80:83], v[200:203]
    ds_read_b128 a[24:27], v22 offset:22528
    v_mfma_f32_16x16x32_bf16 v[200:203], v[60:63], a[84:87], v[200:203]
    v_mfma_f32_16x16x32_bf16 v[204:207], v[56:59], a[88:91], v[204:207]
    v_mfma_f32_16x16x32_bf16 v[204:207], v[60:63], a[92:95], v[204:207]
    v_mfma_f32_16x16x32_bf16 v[208:211], v[56:59], a[96:99], v[208:211]
    ds_read_b128 a[28:31], v23 offset:22528
    v_mfma_f32_16x16x32_bf16 v[208:211], v[60:63], a[100:103], v[208:211]
    v_mfma_f32_16x16x32_bf16 v[212:215], v[56:59], a[104:107], v[212:215]
    buffer_load_dwordx4 v9, s[8:11], s62 offen offset:3072 lds
    v_mfma_f32_16x16x32_bf16 v[212:215], v[60:63], a[108:111], v[212:215]
    v_mfma_f32_16x16x32_bf16 v[216:219], v[56:59], a[112:115], v[216:219]
    v_mfma_f32_16x16x32_bf16 v[216:219], v[60:63], a[116:119], v[216:219]
    v_mfma_f32_16x16x32_bf16 v[220:223], v[56:59], a[120:123], v[220:223]
    s_waitcnt lgkmcnt(0)
    ds_read_b64_tr_b16 v[56:57], v15 offset:32768
    ds_read_b64_tr_b16 v[58:59], v15 offset:33792
    v_mfma_f32_16x16x32_bf16 v[220:223], v[60:63], a[124:127], v[220:223]
    ds_read_b64_tr_b16 v[60:61], v15 offset:40960
    ds_read_b64_tr_b16 v[62:63], v15 offset:41984
    v_mfma_f32_16x16x32_bf16 v[224:227], v[40:43], a[64:67], v[224:227]
    v_add_u32 v15, 0x10000, v15
    v_mfma_f32_16x16x32_bf16 v[224:227], v[44:47], a[68:71], v[224:227]
    s_xor_b32 s62, s62, 384
    v_mfma_f32_16x16x32_bf16 v[228:231], v[40:43], a[72:75], v[228:231]
    buffer_load_dword v107, v103, s[24:27], s77 offen
    v_mfma_f32_16x16x32_bf16 v[228:231], v[44:47], a[76:79], v[228:231]
    s_add_u32 s77, s77, 4608
    v_mfma_f32_16x16x32_bf16 v[232:235], v[40:43], a[80:83], v[232:235]
    v_mfma_f32_16x16x32_bf16 v[232:235], v[44:47], a[84:87], v[232:235]
    s_add_u32 m0, s69, 32768
    v_mfma_f32_16x16x32_bf16 v[236:239], v[40:43], a[88:91], v[236:239]
    buffer_load_dwordx4 v2, s[12:15], s60 offen nt lds
    v_mfma_f32_16x16x32_bf16 v[236:239], v[44:47], a[92:95], v[236:239]
    v_mfma_f32_16x16x32_bf16 v[240:243], v[40:43], a[96:99], v[240:243]
    v_mfma_f32_16x16x32_bf16 v[240:243], v[44:47], a[100:103], v[240:243]
    v_mfma_f32_16x16x32_bf16 v[244:247], v[40:43], a[104:107], v[244:247]
    v_mfma_f32_16x16x32_bf16 v[244:247], v[44:47], a[108:111], v[244:247]
    v_mfma_f32_16x16x32_bf16 v[248:251], v[40:43], a[112:115], v[248:251]
    v_mfma_f32_16x16x32_bf16 v[248:251], v[44:47], a[116:119], v[248:251]
    buffer_load_dwordx4 v3, s[12:15], s60 offen offset:1024 nt lds
    v_mfma_f32_16x16x32_bf16 v[252:255], v[40:43], a[120:123], v[252:255]
    ds_read_b64_tr_b16 v[40:41], v16 offset:32768
    ds_read_b64_tr_b16 v[42:43], v16 offset:33792
    v_mfma_f32_16x16x32_bf16 v[252:255], v[44:47], a[124:127], v[252:255]
    ds_read_b64_tr_b16 v[44:45], v16 offset:40960
    ds_read_b64_tr_b16 v[46:47], v16 offset:41984
    v_mfma_f32_16x16x32_bf16 a[128:131], a[64:67], v[48:51], a[128:131]
    v_add_u32 v16, 0x10000, v16
    v_mfma_f32_16x16x32_bf16 a[128:131], a[68:71], v[52:55], a[128:131]
    v_mfma_f32_16x16x32_bf16 a[132:135], a[72:75], v[48:51], a[132:135]
    ds_read_b128 a[32:35], v22 offset:49152
    v_mfma_f32_16x16x32_bf16 a[132:135], a[76:79], v[52:55], a[132:135]
    v_mfma_f32_16x16x32_bf16 a[136:139], a[80:83], v[48:51], a[136:139]
    v_mfma_f32_16x16x32_bf16 a[136:139], a[84:87], v[52:55], a[136:139]
    buffer_load_dwordx4 v4, s[12:15], s60 offen offset:2048 nt lds
    v_mfma_f32_16x16x32_bf16 a[140:143], a[88:91], v[48:51], a[140:143]
    v_mfma_f32_16x16x32_bf16 a[140:143], a[92:95], v[52:55], a[140:143]
    ds_read_b128 a[36:39], v23 offset:49152
    v_mfma_f32_16x16x32_bf16 a[144:147], a[96:99], v[48:51], a[144:147]
    v_mfma_f32_16x16x32_bf16 a[144:147], a[100:103], v[52:55], a[144:147]
    v_mfma_f32_16x16x32_bf16 a[148:151], a[104:107], v[48:51], a[148:151]
    v_mfma_f32_16x16x32_bf16 a[148:151], a[108:111], v[52:55], a[148:151]
    v_mfma_f32_16x16x32_bf16 a[152:155], a[112:115], v[48:51], a[152:155]
    buffer_load_dwordx4 v5, s[12:15], s60 offen offset:3072 nt lds
    v_mfma_f32_16x16x32_bf16 a[152:155], a[116:119], v[52:55], a[152:155]
    ds_read_b128 a[40:43], v22 offset:51200
    v_mfma_f32_16x16x32_bf16 a[156:159], a[120:123], v[48:51], a[156:159]
    ds_read_b64_tr_b16 v[48:49], v17 offset:32768
    ds_read_b64_tr_b16 v[50:51], v17 offset:33792
    v_mfma_f32_16x16x32_bf16 a[156:159], a[124:127], v[52:55], a[156:159]
    s_waitcnt lgkmcnt(3)
    ds_read_b64_tr_b16 v[52:53], v17 offset:40960
    ds_read_b64_tr_b16 v[54:55], v17 offset:41984
    v_mfma_f32_16x16x32_bf16 a[160:163], a[64:67], v[56:59], a[160:163]
    v_add_u32 v17, 0x10000, v17
    v_mfma_f32_16x16x32_bf16 a[160:163], a[68:71], v[60:63], a[160:163]
    v_mfma_f32_16x16x32_bf16 a[164:167], a[72:75], v[56:59], a[164:167]
    ds_read_b128 a[44:47], v23 offset:51200
    v_mfma_f32_16x16x32_bf16 a[164:167], a[76:79], v[60:63], a[164:167]
    s_add_u32 m0, s69, 49152
    v_mfma_f32_16x16x32_bf16 a[168:171], a[80:83], v[56:59], a[168:171]
    buffer_load_dwordx4 v6, s[8:11], s61 offen lds
    v_mfma_f32_16x16x32_bf16 a[168:171], a[84:87], v[60:63], a[168:171]
    v_mfma_f32_16x16x32_bf16 a[172:175], a[88:91], v[56:59], a[172:175]
    v_mfma_f32_16x16x32_bf16 a[172:175], a[92:95], v[60:63], a[172:175]
    v_mfma_f32_16x16x32_bf16 a[176:179], a[96:99], v[56:59], a[176:179]
    ds_read_b128 a[48:51], v22 offset:53248
    v_mfma_f32_16x16x32_bf16 a[176:179], a[100:103], v[60:63], a[176:179]
    v_mfma_f32_16x16x32_bf16 a[180:183], a[104:107], v[56:59], a[180:183]
    v_mfma_f32_16x16x32_bf16 a[180:183], a[108:111], v[60:63], a[180:183]
    buffer_load_dwordx4 v7, s[8:11], s61 offen offset:1024 lds
    v_mfma_f32_16x16x32_bf16 a[184:187], a[112:115], v[56:59], a[184:187]
    v_mfma_f32_16x16x32_bf16 a[184:187], a[116:119], v[60:63], a[184:187]
    ds_read_b128 a[52:55], v23 offset:53248
    v_mfma_f32_16x16x32_bf16 a[188:191], a[120:123], v[56:59], a[188:191]
    v_mfma_f32_16x16x32_bf16 a[188:191], a[124:127], v[60:63], a[188:191]
    v_mfma_f32_16x16x32_bf16 a[192:195], a[64:67], v[40:43], a[192:195]
    v_mfma_f32_16x16x32_bf16 a[192:195], a[68:71], v[44:47], a[192:195]
    v_mfma_f32_16x16x32_bf16 a[196:199], a[72:75], v[40:43], a[196:199]
    v_mfma_f32_16x16x32_bf16 a[196:199], a[76:79], v[44:47], a[196:199]
    buffer_load_dwordx4 v8, s[8:11], s61 offen offset:2048 lds
    v_mfma_f32_16x16x32_bf16 a[200:203], a[80:83], v[40:43], a[200:203]
    ds_read_b128 a[56:59], v22 offset:55296
    v_mfma_f32_16x16x32_bf16 a[200:203], a[84:87], v[44:47], a[200:203]
    v_mfma_f32_16x16x32_bf16 a[204:207], a[88:91], v[40:43], a[204:207]
    v_mfma_f32_16x16x32_bf16 a[204:207], a[92:95], v[44:47], a[204:207]
    v_mfma_f32_16x16x32_bf16 a[208:211], a[96:99], v[40:43], a[208:211]
    ds_read_b128 a[60:63], v23 offset:55296
    v_mfma_f32_16x16x32_bf16 a[208:211], a[100:103], v[44:47], a[208:211]
    v_mfma_f32_16x16x32_bf16 a[212:215], a[104:107], v[40:43], a[212:215]
    buffer_load_dwordx4 v9, s[8:11], s61 offen offset:3072 lds
    v_mfma_f32_16x16x32_bf16 a[212:215], a[108:111], v[44:47], a[212:215]
    v_mfma_f32_16x16x32_bf16 a[216:219], a[112:115], v[40:43], a[216:219]
    v_mfma_f32_16x16x32_bf16 a[216:219], a[116:119], v[44:47], a[216:219]
    v_mfma_f32_16x16x32_bf16 a[220:223], a[120:123], v[40:43], a[220:223]
    v_mfma_f32_16x16x32_bf16 a[220:223], a[124:127], v[44:47], a[220:223]
    s_waitcnt lgkmcnt(0)
    v_mfma_f32_16x16x32_bf16 a[224:227], a[64:67], v[48:51], a[224:227]
    v_mfma_f32_16x16x32_bf16 a[224:227], a[68:71], v[52:55], a[224:227]
    s_xor_b32 s61, s61, 128
    v_mfma_f32_16x16x32_bf16 a[228:231], a[72:75], v[48:51], a[228:231]
    v_mfma_f32_16x16x32_bf16 a[228:231], a[76:79], v[52:55], a[228:231]
    v_mfma_f32_16x16x32_bf16 a[232:235], a[80:83], v[48:51], a[232:235]
    v_mfma_f32_16x16x32_bf16 a[232:235], a[84:87], v[52:55], a[232:235]
    s_waitcnt vmcnt(9) lgkmcnt(0)
    s_barrier
    ds_read_b64_tr_b16 v[56:57], v14 offset:0
    v_mfma_f32_16x16x32_bf16 a[236:239], a[88:91], v[48:51], a[236:239]
    s_add_u32 m0, s69, 65536
    ds_read_b64_tr_b16 v[58:59], v14 offset:1024
    ds_read_b64_tr_b16 v[60:61], v14 offset:8192
    v_mfma_f32_16x16x32_bf16 a[236:239], a[92:95], v[52:55], a[236:239]
    buffer_load_dwordx4 v2, s[16:19], s60 offen nt lds
    v_mfma_f32_16x16x32_bf16 a[240:243], a[96:99], v[48:51], a[240:243]
    ds_read_b64_tr_b16 v[62:63], v14 offset:9216
    ds_read_b64_tr_b16 v[40:41], v15 offset:0
    v_mfma_f32_16x16x32_bf16 a[240:243], a[100:103], v[52:55], a[240:243]
    buffer_atomic_add v31, v30, s[44:47], s95 offen sc1
    v_mfma_f32_16x16x32_bf16 a[244:247], a[104:107], v[48:51], a[244:247]
    ds_read_b64_tr_b16 v[42:43], v15 offset:1024
    ds_read_b64_tr_b16 v[44:45], v15 offset:8192
    v_mfma_f32_16x16x32_bf16 a[244:247], a[108:111], v[52:55], a[244:247]
    ds_read_b64_tr_b16 v[46:47], v15 offset:9216
    v_add_u32 v14, 0xfffe0000, v14
    v_mfma_f32_16x16x32_bf16 a[248:251], a[112:115], v[48:51], a[248:251]
    v_add_u32 v15, 0xfffe0000, v15
    v_mfma_f32_16x16x32_bf16 a[248:251], a[116:119], v[52:55], a[248:251]
    buffer_load_dwordx4 v3, s[16:19], s60 offen offset:1024 nt lds
    v_mfma_f32_16x16x32_bf16 a[252:255], a[120:123], v[48:51], a[252:255]
    ds_read_b64_tr_b16 v[48:49], v16 offset:0
    ds_read_b64_tr_b16 v[50:51], v16 offset:1024
    v_mfma_f32_16x16x32_bf16 a[252:255], a[124:127], v[52:55], a[252:255]
    s_waitcnt lgkmcnt(3)
    ds_read_b64_tr_b16 v[52:53], v16 offset:8192
    ds_read_b64_tr_b16 v[54:55], v16 offset:9216
    v_mfma_f32_16x16x32_bf16 v[128:131], v[56:59], a[0:3], v[128:131]
    v_add_u32 v16, 0xfffe0000, v16
    v_mfma_f32_16x16x32_bf16 v[128:131], v[60:63], a[4:7], v[128:131]
    v_add_u32 v22, 0x10000, v22
    v_mfma_f32_16x16x32_bf16 v[132:135], v[56:59], a[8:11], v[132:135]
    ds_read_b128 a[64:67], v22 offset:16384
    v_mfma_f32_16x16x32_bf16 v[132:135], v[60:63], a[12:15], v[132:135]
    v_mfma_f32_16x16x32_bf16 v[136:139], v[56:59], a[16:19], v[136:139]
    v_mfma_f32_16x16x32_bf16 v[136:139], v[60:63], a[20:23], v[136:139]
    buffer_load_dwordx4 v4, s[16:19], s60 offen offset:2048 nt lds
    v_mfma_f32_16x16x32_bf16 v[140:143], v[56:59], a[24:27], v[140:143]
    v_add_u32 v23, 0x10000, v23
    v_mfma_f32_16x16x32_bf16 v[140:143], v[60:63], a[28:31], v[140:143]
    ds_read_b128 a[68:71], v23 offset:16384
    v_mfma_f32_16x16x32_bf16 v[144:147], v[56:59], a[32:35], v[144:147]
    v_mfma_f32_16x16x32_bf16 v[144:147], v[60:63], a[36:39], v[144:147]
    v_mfma_f32_16x16x32_bf16 v[148:151], v[56:59], a[40:43], v[148:151]
    v_mfma_f32_16x16x32_bf16 v[148:151], v[60:63], a[44:47], v[148:151]
    v_mfma_f32_16x16x32_bf16 v[152:155], v[56:59], a[48:51], v[152:155]
    buffer_load_dwordx4 v5, s[16:19], s60 offen offset:3072 nt lds
    v_mfma_f32_16x16x32_bf16 v[152:155], v[60:63], a[52:55], v[152:155]
    ds_read_b128 a[72:75], v22 offset:18432
    v_mfma_f32_16x16x32_bf16 v[156:159], v[56:59], a[56:59], v[156:159]
    ds_read_b64_tr_b16 v[56:57], v17 offset:0
    ds_read_b64_tr_b16 v[58:59], v17 offset:1024
    v_mfma_f32_16x16x32_bf16 v[156:159], v[60:63], a[60:63], v[156:159]
    ds_read_b64_tr_b16 v[60:61], v17 offset:8192
    ds_read_b64_tr_b16 v[62:63], v17 offset:9216
    v_mfma_f32_16x16x32_bf16 v[160:163], v[40:43], a[0:3], v[160:163]
    s_waitcnt lgkmcnt(5)
    v_add_u32 v17, 0xfffe0000, v17
    v_mfma_f32_16x16x32_bf16 v[160:163], v[44:47], a[4:7], v[160:163]
    v_mfma_f32_16x16x32_bf16 v[164:167], v[40:43], a[8:11], v[164:167]
    ds_read_b128 a[76:79], v23 offset:18432
    v_mfma_f32_16x16x32_bf16 v[164:167], v[44:47], a[12:15], v[164:167]
    s_add_u32 m0, s69, 81920
    v_mfma_f32_16x16x32_bf16 v[168:171], v[40:43], a[16:19], v[168:171]
    s_xor_b32 s60, s60, 1572864
    buffer_load_dwordx4 v6, s[8:11], s62 offen lds
    v_mfma_f32_16x16x32_bf16 v[168:171], v[44:47], a[20:23], v[168:171]
    v_mfma_f32_16x16x32_bf16 v[172:175], v[40:43], a[24:27], v[172:175]
    v_mfma_f32_16x16x32_bf16 v[172:175], v[44:47], a[28:31], v[172:175]
    v_mfma_f32_16x16x32_bf16 v[176:179], v[40:43], a[32:35], v[176:179]
    ds_read_b128 a[80:83], v22 offset:20480
    v_mfma_f32_16x16x32_bf16 v[176:179], v[44:47], a[36:39], v[176:179]
    v_mfma_f32_16x16x32_bf16 v[180:183], v[40:43], a[40:43], v[180:183]
    v_mfma_f32_16x16x32_bf16 v[180:183], v[44:47], a[44:47], v[180:183]
    buffer_load_dwordx4 v7, s[8:11], s62 offen offset:1024 lds
    v_mfma_f32_16x16x32_bf16 v[184:187], v[40:43], a[48:51], v[184:187]
    v_mfma_f32_16x16x32_bf16 v[184:187], v[44:47], a[52:55], v[184:187]
    ds_read_b128 a[84:87], v23 offset:20480
    v_mfma_f32_16x16x32_bf16 v[188:191], v[40:43], a[56:59], v[188:191]
    ds_read_b64_tr_b16 v[40:41], v14 offset:0
    ds_read_b64_tr_b16 v[42:43], v14 offset:1024
    v_mfma_f32_16x16x32_bf16 v[188:191], v[44:47], a[60:63], v[188:191]
    ds_read_b64_tr_b16 v[44:45], v14 offset:8192
    ds_read_b64_tr_b16 v[46:47], v14 offset:9216
    v_mfma_f32_16x16x32_bf16 v[192:195], v[48:51], a[0:3], v[192:195]
    v_mfma_f32_16x16x32_bf16 v[192:195], v[52:55], a[4:7], v[192:195]
    v_mfma_f32_16x16x32_bf16 v[196:199], v[48:51], a[8:11], v[196:199]
    v_mfma_f32_16x16x32_bf16 v[196:199], v[52:55], a[12:15], v[196:199]
    buffer_load_dwordx4 v8, s[8:11], s62 offen offset:2048 lds
    v_mfma_f32_16x16x32_bf16 v[200:203], v[48:51], a[16:19], v[200:203]
    ds_read_b128 a[88:91], v22 offset:22528
    v_mfma_f32_16x16x32_bf16 v[200:203], v[52:55], a[20:23], v[200:203]
    v_mfma_f32_16x16x32_bf16 v[204:207], v[48:51], a[24:27], v[204:207]
    v_mfma_f32_16x16x32_bf16 v[204:207], v[52:55], a[28:31], v[204:207]
    v_mfma_f32_16x16x32_bf16 v[208:211], v[48:51], a[32:35], v[208:211]
    ds_read_b128 a[92:95], v23 offset:22528
    v_mfma_f32_16x16x32_bf16 v[208:211], v[52:55], a[36:39], v[208:211]
    v_mfma_f32_16x16x32_bf16 v[212:215], v[48:51], a[40:43], v[212:215]
    buffer_load_dwordx4 v9, s[8:11], s62 offen offset:3072 lds
    v_mfma_f32_16x16x32_bf16 v[212:215], v[52:55], a[44:47], v[212:215]
    v_mfma_f32_16x16x32_bf16 v[216:219], v[48:51], a[48:51], v[216:219]
    v_mfma_f32_16x16x32_bf16 v[216:219], v[52:55], a[52:55], v[216:219]
    v_mfma_f32_16x16x32_bf16 v[220:223], v[48:51], a[56:59], v[220:223]
    s_waitcnt lgkmcnt(0)
    ds_read_b64_tr_b16 v[48:49], v15 offset:0
    ds_read_b64_tr_b16 v[50:51], v15 offset:1024
    v_mfma_f32_16x16x32_bf16 v[220:223], v[52:55], a[60:63], v[220:223]
    ds_read_b64_tr_b16 v[52:53], v15 offset:8192
    ds_read_b64_tr_b16 v[54:55], v15 offset:9216
    v_mfma_f32_16x16x32_bf16 v[224:227], v[56:59], a[0:3], v[224:227]
    v_mfma_f32_16x16x32_bf16 v[224:227], v[60:63], a[4:7], v[224:227]
    s_xor_b32 s62, s62, 128
    v_mfma_f32_16x16x32_bf16 v[228:231], v[56:59], a[8:11], v[228:231]
    buffer_load_dword v108, v103, s[24:27], s77 offen
    v_mfma_f32_16x16x32_bf16 v[228:231], v[60:63], a[12:15], v[228:231]
    s_add_u32 s77, s77, 4608
    v_mfma_f32_16x16x32_bf16 v[232:235], v[56:59], a[16:19], v[232:235]
    v_mfma_f32_16x16x32_bf16 v[232:235], v[60:63], a[20:23], v[232:235]
    s_add_u32 m0, s69, 98304
    v_mfma_f32_16x16x32_bf16 v[236:239], v[56:59], a[24:27], v[236:239]
    buffer_load_dwordx4 v2, s[12:15], s60 offen nt lds
    v_mfma_f32_16x16x32_bf16 v[236:239], v[60:63], a[28:31], v[236:239]
    v_mfma_f32_16x16x32_bf16 v[240:243], v[56:59], a[32:35], v[240:243]
    v_mfma_f32_16x16x32_bf16 v[240:243], v[60:63], a[36:39], v[240:243]
    v_mfma_f32_16x16x32_bf16 v[244:247], v[56:59], a[40:43], v[244:247]
    v_mfma_f32_16x16x32_bf16 v[244:247], v[60:63], a[44:47], v[244:247]
    v_mfma_f32_16x16x32_bf16 v[248:251], v[56:59], a[48:51], v[248:251]
    v_mfma_f32_16x16x32_bf16 v[248:251], v[60:63], a[52:55], v[248:251]
    buffer_load_dwordx4 v3, s[12:15], s60 offen offset:1024 nt lds
    v_mfma_f32_16x16x32_bf16 v[252:255], v[56:59], a[56:59], v[252:255]
    ds_read_b64_tr_b16 v[56:57], v16 offset:0
    ds_read_b64_tr_b16 v[58:59], v16 offset:1024
    v_mfma_f32_16x16x32_bf16 v[252:255], v[60:63], a[60:63], v[252:255]
    ds_read_b64_tr_b16 v[60:61], v16 offset:8192
    ds_read_b64_tr_b16 v[62:63], v16 offset:9216
    v_mfma_f32_16x16x32_bf16 a[128:131], a[0:3], v[40:43], a[128:131]
    v_mfma_f32_16x16x32_bf16 a[128:131], a[4:7], v[44:47], a[128:131]
    v_add_u32 v22, 0xfffe0000, v22
    v_mfma_f32_16x16x32_bf16 a[132:135], a[8:11], v[40:43], a[132:135]
    ds_read_b128 a[96:99], v22 offset:16384
    v_mfma_f32_16x16x32_bf16 a[132:135], a[12:15], v[44:47], a[132:135]
    v_mfma_f32_16x16x32_bf16 a[136:139], a[16:19], v[40:43], a[136:139]
    v_mfma_f32_16x16x32_bf16 a[136:139], a[20:23], v[44:47], a[136:139]
    buffer_load_dwordx4 v4, s[12:15], s60 offen offset:2048 nt lds
    v_mfma_f32_16x16x32_bf16 a[140:143], a[24:27], v[40:43], a[140:143]
    v_add_u32 v23, 0xfffe0000, v23
    v_mfma_f32_16x16x32_bf16 a[140:143], a[28:31], v[44:47], a[140:143]
    ds_read_b128 a[100:103], v23 offset:16384
    v_mfma_f32_16x16x32_bf16 a[144:147], a[32:35], v[40:43], a[144:147]
    v_mfma_f32_16x16x32_bf16 a[144:147], a[36:39], v[44:47], a[144:147]
    v_mfma_f32_16x16x32_bf16 a[148:151], a[40:43], v[40:43], a[148:151]
    v_mfma_f32_16x16x32_bf16 a[148:151], a[44:47], v[44:47], a[148:151]
    v_mfma_f32_16x16x32_bf16 a[152:155], a[48:51], v[40:43], a[152:155]
    buffer_load_dwordx4 v5, s[12:15], s60 offen offset:3072 nt lds
    v_mfma_f32_16x16x32_bf16 a[152:155], a[52:55], v[44:47], a[152:155]
    ds_read_b128 a[104:107], v22 offset:18432
    v_mfma_f32_16x16x32_bf16 a[156:159], a[56:59], v[40:43], a[156:159]
    ds_read_b64_tr_b16 v[40:41], v17 offset:0
    ds_read_b64_tr_b16 v[42:43], v17 offset:1024
    v_mfma_f32_16x16x32_bf16 a[156:159], a[60:63], v[44:47], a[156:159]
    s_waitcnt lgkmcnt(3)
    ds_read_b64_tr_b16 v[44:45], v17 offset:8192
    ds_read_b64_tr_b16 v[46:47], v17 offset:9216
    v_mfma_f32_16x16x32_bf16 a[160:163], a[0:3], v[48:51], a[160:163]
    v_mfma_f32_16x16x32_bf16 a[160:163], a[4:7], v[52:55], a[160:163]
    v_mfma_f32_16x16x32_bf16 a[164:167], a[8:11], v[48:51], a[164:167]
    ds_read_b128 a[108:111], v23 offset:18432
    v_mfma_f32_16x16x32_bf16 a[164:167], a[12:15], v[52:55], a[164:167]
    s_add_u32 m0, s69, 114688
    v_mfma_f32_16x16x32_bf16 a[168:171], a[16:19], v[48:51], a[168:171]
    s_xor_b32 s60, s60, 524288
    buffer_load_dwordx4 v6, s[8:11], s61 offen lds
    v_mfma_f32_16x16x32_bf16 a[168:171], a[20:23], v[52:55], a[168:171]
    v_mfma_f32_16x16x32_bf16 a[172:175], a[24:27], v[48:51], a[172:175]
    v_mfma_f32_16x16x32_bf16 a[172:175], a[28:31], v[52:55], a[172:175]
    v_mfma_f32_16x16x32_bf16 a[176:179], a[32:35], v[48:51], a[176:179]
    ds_read_b128 a[112:115], v22 offset:20480
    v_mfma_f32_16x16x32_bf16 a[176:179], a[36:39], v[52:55], a[176:179]
    v_mfma_f32_16x16x32_bf16 a[180:183], a[40:43], v[48:51], a[180:183]
    v_mfma_f32_16x16x32_bf16 a[180:183], a[44:47], v[52:55], a[180:183]
    buffer_load_dwordx4 v7, s[8:11], s61 offen offset:1024 lds
    v_mfma_f32_16x16x32_bf16 a[184:187], a[48:51], v[48:51], a[184:187]
    v_mfma_f32_16x16x32_bf16 a[184:187], a[52:55], v[52:55], a[184:187]
    ds_read_b128 a[116:119], v23 offset:20480
    v_mfma_f32_16x16x32_bf16 a[188:191], a[56:59], v[48:51], a[188:191]
    v_mfma_f32_16x16x32_bf16 a[188:191], a[60:63], v[52:55], a[188:191]
    v_mfma_f32_16x16x32_bf16 a[192:195], a[0:3], v[56:59], a[192:195]
    v_mfma_f32_16x16x32_bf16 a[192:195], a[4:7], v[60:63], a[192:195]
    v_mfma_f32_16x16x32_bf16 a[196:199], a[8:11], v[56:59], a[196:199]
    v_mfma_f32_16x16x32_bf16 a[196:199], a[12:15], v[60:63], a[196:199]
    buffer_load_dwordx4 v8, s[8:11], s61 offen offset:2048 lds
    v_mfma_f32_16x16x32_bf16 a[200:203], a[16:19], v[56:59], a[200:203]
    ds_read_b128 a[120:123], v22 offset:22528
    v_mfma_f32_16x16x32_bf16 a[200:203], a[20:23], v[60:63], a[200:203]
    v_mfma_f32_16x16x32_bf16 a[204:207], a[24:27], v[56:59], a[204:207]
    v_mfma_f32_16x16x32_bf16 a[204:207], a[28:31], v[60:63], a[204:207]
    v_mfma_f32_16x16x32_bf16 a[208:211], a[32:35], v[56:59], a[208:211]
    ds_read_b128 a[124:127], v23 offset:22528
    v_mfma_f32_16x16x32_bf16 a[208:211], a[36:39], v[60:63], a[208:211]
    v_mfma_f32_16x16x32_bf16 a[212:215], a[40:43], v[56:59], a[212:215]
    buffer_load_dwordx4 v9, s[8:11], s61 offen offset:3072 lds
    v_mfma_f32_16x16x32_bf16 a[212:215], a[44:47], v[60:63], a[212:215]
    v_mfma_f32_16x16x32_bf16 a[216:219], a[48:51], v[56:59], a[216:219]
    v_mfma_f32_16x16x32_bf16 a[216:219], a[52:55], v[60:63], a[216:219]
    v_mfma_f32_16x16x32_bf16 a[220:223], a[56:59], v[56:59], a[220:223]
    v_mfma_f32_16x16x32_bf16 a[220:223], a[60:63], v[60:63], a[220:223]
    s_waitcnt lgkmcnt(0)
    v_mfma_f32_16x16x32_bf16 a[224:227], a[0:3], v[40:43], a[224:227]
    v_mfma_f32_16x16x32_bf16 a[224:227], a[4:7], v[44:47], a[224:227]
    s_xor_b32 s61, s61, 1920
    v_mfma_f32_16x16x32_bf16 a[228:231], a[8:11], v[40:43], a[228:231]
    s_andn2_b32 s61, s61, 896
    v_mfma_f32_16x16x32_bf16 a[228:231], a[12:15], v[44:47], a[228:231]
    s_lshl_b32 s61, s5, 7
    v_mfma_f32_16x16x32_bf16 a[232:235], a[16:19], v[40:43], a[232:235]
    v_mfma_f32_16x16x32_bf16 a[232:235], a[20:23], v[44:47], a[232:235]
    s_waitcnt vmcnt(9) lgkmcnt(0)
    s_barrier
    ds_read_b64_tr_b16 v[48:49], v14 offset:32768
    v_mfma_f32_16x16x32_bf16 a[236:239], a[24:27], v[40:43], a[236:239]
    s_add_u32 m0, s69, 131072
    ds_read_b64_tr_b16 v[50:51], v14 offset:33792
    ds_read_b64_tr_b16 v[52:53], v14 offset:40960
    v_mfma_f32_16x16x32_bf16 a[236:239], a[28:31], v[44:47], a[236:239]
    buffer_load_dwordx4 v2, s[12:15], s60 offen nt lds
    v_mfma_f32_16x16x32_bf16 a[240:243], a[32:35], v[40:43], a[240:243]
    ds_read_b64_tr_b16 v[54:55], v14 offset:41984
    ds_read_b64_tr_b16 v[56:57], v15 offset:32768
    v_mfma_f32_16x16x32_bf16 a[240:243], a[36:39], v[44:47], a[240:243]
    ds_read_b64_tr_b16 v[58:59], v15 offset:33792
    ds_read_b64_tr_b16 v[60:61], v15 offset:40960
    v_mfma_f32_16x16x32_bf16 a[244:247], a[40:43], v[40:43], a[244:247]
    ds_read_b64_tr_b16 v[62:63], v15 offset:41984
    v_add_u32 v14, 0x10000, v14
    v_mfma_f32_16x16x32_bf16 a[244:247], a[44:47], v[44:47], a[244:247]
    v_add_u32 v15, 0x10000, v15
    v_mfma_f32_16x16x32_bf16 a[248:251], a[48:51], v[40:43], a[248:251]
    v_mfma_f32_16x16x32_bf16 a[248:251], a[52:55], v[44:47], a[248:251]
    buffer_load_dwordx4 v3, s[12:15], s60 offen offset:1024 nt lds
    v_mfma_f32_16x16x32_bf16 a[252:255], a[56:59], v[40:43], a[252:255]
    ds_read_b64_tr_b16 v[40:41], v16 offset:32768
    ds_read_b64_tr_b16 v[42:43], v16 offset:33792
    v_mfma_f32_16x16x32_bf16 a[252:255], a[60:63], v[44:47], a[252:255]
    s_waitcnt lgkmcnt(2)
    ds_read_b64_tr_b16 v[44:45], v16 offset:40960
    ds_read_b64_tr_b16 v[46:47], v16 offset:41984
    v_mfma_f32_16x16x32_bf16 v[128:131], v[48:51], a[64:67], v[128:131]
    v_add_u32 v16, 0x10000, v16
    v_mfma_f32_16x16x32_bf16 v[128:131], v[52:55], a[68:71], v[128:131]
    v_mfma_f32_16x16x32_bf16 v[132:135], v[48:51], a[72:75], v[132:135]
    ds_read_b128 a[0:3], v22 offset:49152
    v_mfma_f32_16x16x32_bf16 v[132:135], v[52:55], a[76:79], v[132:135]
    v_mfma_f32_16x16x32_bf16 v[136:139], v[48:51], a[80:83], v[136:139]
    v_mfma_f32_16x16x32_bf16 v[136:139], v[52:55], a[84:87], v[136:139]
    buffer_load_dwordx4 v4, s[12:15], s60 offen offset:2048 nt lds
    v_mfma_f32_16x16x32_bf16 v[140:143], v[48:51], a[88:91], v[140:143]
    v_mfma_f32_16x16x32_bf16 v[140:143], v[52:55], a[92:95], v[140:143]
    ds_read_b128 a[4:7], v23 offset:49152
    v_mfma_f32_16x16x32_bf16 v[144:147], v[48:51], a[96:99], v[144:147]
    v_mfma_f32_16x16x32_bf16 v[144:147], v[52:55], a[100:103], v[144:147]
    v_mfma_f32_16x16x32_bf16 v[148:151], v[48:51], a[104:107], v[148:151]
    v_mfma_f32_16x16x32_bf16 v[148:151], v[52:55], a[108:111], v[148:151]
    v_mfma_f32_16x16x32_bf16 v[152:155], v[48:51], a[112:115], v[152:155]
    buffer_load_dwordx4 v5, s[12:15], s60 offen offset:3072 nt lds
    v_mfma_f32_16x16x32_bf16 v[152:155], v[52:55], a[116:119], v[152:155]
    ds_read_b128 a[8:11], v22 offset:51200
    v_mfma_f32_16x16x32_bf16 v[156:159], v[48:51], a[120:123], v[156:159]
    ds_read_b64_tr_b16 v[48:49], v17 offset:32768
    ds_read_b64_tr_b16 v[50:51], v17 offset:33792
    v_mfma_f32_16x16x32_bf16 v[156:159], v[52:55], a[124:127], v[156:159]
    ds_read_b64_tr_b16 v[52:53], v17 offset:40960
    ds_read_b64_tr_b16 v[54:55], v17 offset:41984
    v_mfma_f32_16x16x32_bf16 v[160:163], v[56:59], a[64:67], v[160:163]
    v_add_u32 v17, 0x10000, v17
    v_mfma_f32_16x16x32_bf16 v[160:163], v[60:63], a[68:71], v[160:163]
    s_cmp_lt_u32 s4, 0
    s_cselect_b32 s12, 0xf149f2ca, 0
    v_mfma_f32_16x16x32_bf16 v[164:167], v[56:59], a[72:75], v[164:167]
    ds_read_b128 a[12:15], v23 offset:51200
    v_mfma_f32_16x16x32_bf16 v[164:167], v[60:63], a[76:79], v[164:167]
    s_add_u32 m0, s69, 147456
    v_mfma_f32_16x16x32_bf16 v[168:171], v[56:59], a[80:83], v[168:171]
    s_xor_b32 s60, s60, 524288
    buffer_load_dwordx4 v6, s[8:11], s62 offen lds
    v_mfma_f32_16x16x32_bf16 v[168:171], v[60:63], a[84:87], v[168:171]
    v_mov_b32 v6, v96
    v_mfma_f32_16x16x32_bf16 v[172:175], v[56:59], a[88:91], v[172:175]
    s_cmp_lt_u32 s4, 1
    s_cselect_b32 s13, 0xf149f2ca, 0
    v_mfma_f32_16x16x32_bf16 v[172:175], v[60:63], a[92:95], v[172:175]
    s_cmp_lt_u32 s4, 2
    s_cselect_b32 s14, 0xf149f2ca, 0
    v_mfma_f32_16x16x32_bf16 v[176:179], v[56:59], a[96:99], v[176:179]
    ds_read_b128 a[16:19], v22 offset:53248
    v_mfma_f32_16x16x32_bf16 v[176:179], v[60:63], a[100:103], v[176:179]
    s_cmp_lt_u32 s4, 3
    s_cselect_b32 s15, 0xf149f2ca, 0
    v_mfma_f32_16x16x32_bf16 v[180:183], v[56:59], a[104:107], v[180:183]
    v_mfma_f32_16x16x32_bf16 v[180:183], v[60:63], a[108:111], v[180:183]
    buffer_load_dwordx4 v7, s[8:11], s62 offen offset:1024 lds
    v_mfma_f32_16x16x32_bf16 v[184:187], v[56:59], a[112:115], v[184:187]
    v_mfma_f32_16x16x32_bf16 v[184:187], v[60:63], a[116:119], v[184:187]
    ds_read_b128 a[20:23], v23 offset:53248
    v_mfma_f32_16x16x32_bf16 v[188:191], v[56:59], a[120:123], v[188:191]
    s_waitcnt lgkmcnt(1)
    ds_read_b64_tr_b16 v[56:57], v14 offset:0
    ds_read_b64_tr_b16 v[58:59], v14 offset:1024
    v_mfma_f32_16x16x32_bf16 v[188:191], v[60:63], a[124:127], v[188:191]
    ds_read_b64_tr_b16 v[60:61], v14 offset:8192
    ds_read_b64_tr_b16 v[62:63], v14 offset:9216
    v_mfma_f32_16x16x32_bf16 v[192:195], v[40:43], a[64:67], v[192:195]
    v_mfma_f32_16x16x32_bf16 v[192:195], v[44:47], a[68:71], v[192:195]
    v_mfma_f32_16x16x32_bf16 v[196:199], v[40:43], a[72:75], v[196:199]
    v_mfma_f32_16x16x32_bf16 v[196:199], v[44:47], a[76:79], v[196:199]
    buffer_load_dwordx4 v8, s[8:11], s62 offen offset:2048 lds
    v_mfma_f32_16x16x32_bf16 v[200:203], v[40:43], a[80:83], v[200:203]
    ds_read_b128 a[24:27], v22 offset:55296
    v_bfe_u32 v8, v1, 4, 3
    v_mfma_f32_16x16x32_bf16 v[200:203], v[44:47], a[84:87], v[200:203]
    v_lshlrev_b32 v8, 12, v8
    v_mfma_f32_16x16x32_bf16 v[204:207], v[40:43], a[88:91], v[204:207]
    v_mfma_f32_16x16x32_bf16 v[204:207], v[44:47], a[92:95], v[204:207]
    v_mfma_f32_16x16x32_bf16 v[208:211], v[40:43], a[96:99], v[208:211]
    ds_read_b128 a[28:31], v23 offset:55296
    v_mfma_f32_16x16x32_bf16 v[208:211], v[44:47], a[100:103], v[208:211]
    v_mfma_f32_16x16x32_bf16 v[212:215], v[40:43], a[104:107], v[212:215]
    buffer_load_dwordx4 v9, s[8:11], s62 offen offset:3072 lds
    v_mfma_f32_16x16x32_bf16 v[212:215], v[44:47], a[108:111], v[212:215]
    s_and_b32 s8, s5, 7
    v_lshrrev_b32 v9, 2, v1
    v_mfma_f32_16x16x32_bf16 v[216:219], v[40:43], a[112:115], v[216:219]
    s_lshl3_add_u32 s8, s6, s8
    v_mfma_f32_16x16x32_bf16 v[216:219], v[44:47], a[116:119], v[216:219]
    s_mul_hi_u32 s98, s8, 715827883
    v_mfma_f32_16x16x32_bf16 v[220:223], v[40:43], a[120:123], v[220:223]
    s_lshr_b32 s10, s5, 3
    ds_read_b64_tr_b16 v[40:41], v15 offset:0
    ds_read_b64_tr_b16 v[42:43], v15 offset:1024
    v_mfma_f32_16x16x32_bf16 v[220:223], v[44:47], a[124:127], v[220:223]
    ds_read_b64_tr_b16 v[44:45], v15 offset:8192
    ds_read_b64_tr_b16 v[46:47], v15 offset:9216
    v_mfma_f32_16x16x32_bf16 v[224:227], v[48:51], a[64:67], v[224:227]
    s_cmp_eq_u32 s4, 3
    s_cselect_b32 s11, 1.0, 0
    v_mfma_f32_16x16x32_bf16 v[224:227], v[52:55], a[68:71], v[224:227]
    s_xor_b32 s62, s62, 1920
    v_mfma_f32_16x16x32_bf16 v[228:231], v[48:51], a[72:75], v[228:231]
    s_andn2_b32 s62, s62, 896
    buffer_load_dword v109, v103, s[24:27], s77 offen
    v_mfma_f32_16x16x32_bf16 v[228:231], v[52:55], a[76:79], v[228:231]
    v_mfma_f32_16x16x32_bf16 v[232:235], v[48:51], a[80:83], v[232:235]
    v_mfma_f32_16x16x32_bf16 v[232:235], v[52:55], a[84:87], v[232:235]
    s_add_u32 m0, s69, 0
    v_mfma_f32_16x16x32_bf16 v[236:239], v[48:51], a[88:91], v[236:239]
    buffer_load_dwordx4 v2, s[16:19], s60 offen nt lds
    v_mfma_f32_16x16x32_bf16 v[236:239], v[52:55], a[92:95], v[236:239]
    v_mfma_f32_16x16x32_bf16 v[240:243], v[48:51], a[96:99], v[240:243]
    v_mfma_f32_16x16x32_bf16 v[240:243], v[52:55], a[100:103], v[240:243]
    v_mfma_f32_16x16x32_bf16 v[244:247], v[48:51], a[104:107], v[244:247]
    v_mfma_f32_16x16x32_bf16 v[244:247], v[52:55], a[108:111], v[244:247]
    v_mfma_f32_16x16x32_bf16 v[248:251], v[48:51], a[112:115], v[248:251]
    v_mfma_f32_16x16x32_bf16 v[248:251], v[52:55], a[116:119], v[248:251]
    buffer_load_dwordx4 v3, s[16:19], s60 offen offset:1024 nt lds
    v_mfma_f32_16x16x32_bf16 v[252:255], v[48:51], a[120:123], v[252:255]
    ds_read_b64_tr_b16 v[48:49], v16 offset:0
    ds_read_b64_tr_b16 v[50:51], v16 offset:1024
    v_mfma_f32_16x16x32_bf16 v[252:255], v[52:55], a[124:127], v[252:255]
    s_waitcnt lgkmcnt(2)
    ds_read_b64_tr_b16 v[52:53], v16 offset:8192
    ds_read_b64_tr_b16 v[54:55], v16 offset:9216
    v_mfma_f32_16x16x32_bf16 a[128:131], a[64:67], v[56:59], a[128:131]
    v_mfma_f32_16x16x32_bf16 a[128:131], a[68:71], v[60:63], a[128:131]
    v_add_u32 v22, 0x10000, v22
    v_mfma_f32_16x16x32_bf16 a[132:135], a[72:75], v[56:59], a[132:135]
    ds_read_b128 a[32:35], v22 offset:16384
    v_mfma_f32_16x16x32_bf16 a[132:135], a[76:79], v[60:63], a[132:135]
    v_mfma_f32_16x16x32_bf16 a[136:139], a[80:83], v[56:59], a[136:139]
    v_mfma_f32_16x16x32_bf16 a[136:139], a[84:87], v[60:63], a[136:139]
    buffer_load_dwordx4 v4, s[16:19], s60 offen offset:2048 nt lds
    v_mfma_f32_16x16x32_bf16 a[140:143], a[88:91], v[56:59], a[140:143]
    v_add_u32 v23, 0x10000, v23
    v_mfma_f32_16x16x32_bf16 a[140:143], a[92:95], v[60:63], a[140:143]
    ds_read_b128 a[36:39], v23 offset:16384
    v_mfma_f32_16x16x32_bf16 a[144:147], a[96:99], v[56:59], a[144:147]
    v_mfma_f32_16x16x32_bf16 a[144:147], a[100:103], v[60:63], a[144:147]
    v_mfma_f32_16x16x32_bf16 a[148:151], a[104:107], v[56:59], a[148:151]
    v_mfma_f32_16x16x32_bf16 a[148:151], a[108:111], v[60:63], a[148:151]
    v_mfma_f32_16x16x32_bf16 a[152:155], a[112:115], v[56:59], a[152:155]
    buffer_load_dwordx4 v5, s[16:19], s60 offen offset:3072 nt lds
    v_mfma_f32_16x16x32_bf16 a[152:155], a[116:119], v[60:63], a[152:155]
    ds_read_b128 a[40:43], v22 offset:18432
    v_mfma_f32_16x16x32_bf16 a[156:159], a[120:123], v[56:59], a[156:159]
    ds_read_b64_tr_b16 v[56:57], v17 offset:0
    ds_read_b64_tr_b16 v[58:59], v17 offset:1024
    v_mfma_f32_16x16x32_bf16 a[156:159], a[124:127], v[60:63], a[156:159]
    ds_read_b64_tr_b16 v[60:61], v17 offset:8192
    ds_read_b64_tr_b16 v[62:63], v17 offset:9216
    v_mfma_f32_16x16x32_bf16 a[160:163], a[64:67], v[40:43], a[160:163]
    v_mfma_f32_16x16x32_bf16 a[160:163], a[68:71], v[44:47], a[160:163]
    v_mfma_f32_16x16x32_bf16 a[164:167], a[72:75], v[40:43], a[164:167]
    ds_read_b128 a[44:47], v23 offset:18432
    v_mfma_f32_16x16x32_bf16 a[164:167], a[76:79], v[44:47], a[164:167]
    s_add_u32 m0, s69, 16384
    v_mfma_f32_16x16x32_bf16 a[168:171], a[80:83], v[40:43], a[168:171]
    s_xor_b32 s60, s60, 524288
    buffer_load_dwordx4 v10, s[20:23], s63 offen lds
    v_mfma_f32_16x16x32_bf16 a[168:171], a[84:87], v[44:47], a[168:171]
    v_mfma_f32_16x16x32_bf16 a[172:175], a[88:91], v[40:43], a[172:175]
    v_mfma_f32_16x16x32_bf16 a[172:175], a[92:95], v[44:47], a[172:175]
    v_mfma_f32_16x16x32_bf16 a[176:179], a[96:99], v[40:43], a[176:179]
    ds_read_b128 a[48:51], v22 offset:20480
    v_mfma_f32_16x16x32_bf16 a[176:179], a[100:103], v[44:47], a[176:179]
    v_mfma_f32_16x16x32_bf16 a[180:183], a[104:107], v[40:43], a[180:183]
    v_mfma_f32_16x16x32_bf16 a[180:183], a[108:111], v[44:47], a[180:183]
    buffer_load_dwordx4 v11, s[20:23], s63 offen offset:1024 lds
    v_mfma_f32_16x16x32_bf16 a[184:187], a[112:115], v[40:43], a[184:187]
    v_mfma_f32_16x16x32_bf16 a[184:187], a[116:119], v[44:47], a[184:187]
    ds_read_b128 a[52:55], v23 offset:20480
    v_mfma_f32_16x16x32_bf16 a[188:191], a[120:123], v[40:43], a[188:191]
    v_mfma_f32_16x16x32_bf16 a[188:191], a[124:127], v[44:47], a[188:191]
    s_waitcnt lgkmcnt(1)
    v_mfma_f32_16x16x32_bf16 a[192:195], a[64:67], v[48:51], a[192:195]
    v_mfma_f32_16x16x32_bf16 a[192:195], a[68:71], v[52:55], a[192:195]
    v_mfma_f32_16x16x32_bf16 a[196:199], a[72:75], v[48:51], a[196:199]
    v_mfma_f32_16x16x32_bf16 a[196:199], a[76:79], v[52:55], a[196:199]
    buffer_load_dwordx4 v12, s[20:23], s63 offen offset:2048 lds
    v_mfma_f32_16x16x32_bf16 a[200:203], a[80:83], v[48:51], a[200:203]
    ds_read_b128 a[56:59], v22 offset:22528
    v_mfma_f32_16x16x32_bf16 a[200:203], a[84:87], v[52:55], a[200:203]
    v_mfma_f32_16x16x32_bf16 a[204:207], a[88:91], v[48:51], a[204:207]
    v_mfma_f32_16x16x32_bf16 a[204:207], a[92:95], v[52:55], a[204:207]
    v_mfma_f32_16x16x32_bf16 a[208:211], a[96:99], v[48:51], a[208:211]
    ds_read_b128 a[60:63], v23 offset:22528
    v_mfma_f32_16x16x32_bf16 a[208:211], a[100:103], v[52:55], a[208:211]
    v_mfma_f32_16x16x32_bf16 a[212:215], a[104:107], v[48:51], a[212:215]
    buffer_load_dwordx4 v13, s[20:23], s63 offen offset:3072 lds
    v_mfma_f32_16x16x32_bf16 a[212:215], a[108:111], v[52:55], a[212:215]
    v_mfma_f32_16x16x32_bf16 a[216:219], a[112:115], v[48:51], a[216:219]
    v_mfma_f32_16x16x32_bf16 a[216:219], a[116:119], v[52:55], a[216:219]
    v_mfma_f32_16x16x32_bf16 a[220:223], a[120:123], v[48:51], a[220:223]
    v_mfma_f32_16x16x32_bf16 a[220:223], a[124:127], v[52:55], a[220:223]
    v_mfma_f32_16x16x32_bf16 a[224:227], a[64:67], v[56:59], a[224:227]
    v_mfma_f32_16x16x32_bf16 a[224:227], a[68:71], v[60:63], a[224:227]
    s_xor_b32 s63, s63, 128
    v_mfma_f32_16x16x32_bf16 a[228:231], a[72:75], v[56:59], a[228:231]
    v_mfma_f32_16x16x32_bf16 a[228:231], a[76:79], v[60:63], a[228:231]
    v_mfma_f32_16x16x32_bf16 a[232:235], a[80:83], v[56:59], a[232:235]
    v_mfma_f32_16x16x32_bf16 a[232:235], a[84:87], v[60:63], a[232:235]
    s_waitcnt vmcnt(9) lgkmcnt(0)
    s_barrier
    ds_read_b64_tr_b16 v[40:41], v14 offset:32768
    v_mfma_f32_16x16x32_bf16 a[236:239], a[88:91], v[56:59], a[236:239]
    s_add_u32 m0, s69, 32768
    ds_read_b64_tr_b16 v[42:43], v14 offset:33792
    ds_read_b64_tr_b16 v[44:45], v14 offset:40960
    v_mfma_f32_16x16x32_bf16 a[236:239], a[92:95], v[60:63], a[236:239]
    buffer_load_dwordx4 v2, s[16:19], s60 offen nt lds
    v_mfma_f32_16x16x32_bf16 a[240:243], a[96:99], v[56:59], a[240:243]
    ds_read_b64_tr_b16 v[46:47], v14 offset:41984
    ds_read_b64_tr_b16 v[48:49], v15 offset:32768
    v_mfma_f32_16x16x32_bf16 a[240:243], a[100:103], v[60:63], a[240:243]
    ds_read_b64_tr_b16 v[50:51], v15 offset:33792
    ds_read_b64_tr_b16 v[52:53], v15 offset:40960
    v_mfma_f32_16x16x32_bf16 a[244:247], a[104:107], v[56:59], a[244:247]
    ds_read_b64_tr_b16 v[54:55], v15 offset:41984
    v_add_u32 v14, 0x10000, v14
    v_mfma_f32_16x16x32_bf16 a[244:247], a[108:111], v[60:63], a[244:247]
    v_add_u32 v15, 0x10000, v15
    v_mfma_f32_16x16x32_bf16 a[248:251], a[112:115], v[56:59], a[248:251]
    v_mfma_f32_16x16x32_bf16 a[248:251], a[116:119], v[60:63], a[248:251]
    buffer_load_dwordx4 v3, s[16:19], s60 offen offset:1024 nt lds
    v_mfma_f32_16x16x32_bf16 a[252:255], a[120:123], v[56:59], a[252:255]
    ds_read_b64_tr_b16 v[56:57], v16 offset:32768
    ds_read_b64_tr_b16 v[58:59], v16 offset:33792
    v_mfma_f32_16x16x32_bf16 a[252:255], a[124:127], v[60:63], a[252:255]
    s_waitcnt lgkmcnt(2)
    ds_read_b64_tr_b16 v[60:61], v16 offset:40960
    ds_read_b64_tr_b16 v[62:63], v16 offset:41984
    v_mfma_f32_16x16x32_bf16 v[128:131], v[40:43], a[0:3], v[128:131]
    v_add_u32 v16, 0x10000, v16
    v_mfma_f32_16x16x32_bf16 v[128:131], v[44:47], a[4:7], v[128:131]
    ds_read_b128 a[64:67], v22 offset:49152
    v_mfma_f32_16x16x32_bf16 v[132:135], v[40:43], a[8:11], v[132:135]
    v_mfma_f32_16x16x32_bf16 v[132:135], v[44:47], a[12:15], v[132:135]
    v_mfma_f32_16x16x32_bf16 v[136:139], v[40:43], a[16:19], v[136:139]
    ds_read_b128 a[68:71], v23 offset:49152
    v_mfma_f32_16x16x32_bf16 v[136:139], v[44:47], a[20:23], v[136:139]
    buffer_load_dwordx4 v4, s[16:19], s60 offen offset:2048 nt lds
    v_mfma_f32_16x16x32_bf16 v[140:143], v[40:43], a[24:27], v[140:143]
    v_mfma_f32_16x16x32_bf16 v[140:143], v[44:47], a[28:31], v[140:143]
    ds_read_b128 a[72:75], v22 offset:51200
    v_mfma_f32_16x16x32_bf16 v[144:147], v[40:43], a[32:35], v[144:147]
    v_mfma_f32_16x16x32_bf16 v[144:147], v[44:47], a[36:39], v[144:147]
    v_mfma_f32_16x16x32_bf16 v[148:151], v[40:43], a[40:43], v[148:151]
    ds_read_b128 a[76:79], v23 offset:51200
    v_mfma_f32_16x16x32_bf16 v[148:151], v[44:47], a[44:47], v[148:151]
    v_mfma_f32_16x16x32_bf16 v[152:155], v[40:43], a[48:51], v[152:155]
    buffer_load_dwordx4 v5, s[16:19], s60 offen offset:3072 nt lds
    v_mfma_f32_16x16x32_bf16 v[152:155], v[44:47], a[52:55], v[152:155]
    v_mfma_f32_16x16x32_bf16 v[156:159], v[40:43], a[56:59], v[156:159]
    ds_read_b128 a[80:83], v22 offset:53248
    ds_read_b64_tr_b16 v[40:41], v17 offset:32768
    v_mfma_f32_16x16x32_bf16 v[156:159], v[44:47], a[60:63], v[156:159]
    ds_read_b64_tr_b16 v[42:43], v17 offset:33792
    ds_read_b64_tr_b16 v[44:45], v17 offset:40960
    v_mfma_f32_16x16x32_bf16 v[160:163], v[48:51], a[0:3], v[160:163]
    ds_read_b64_tr_b16 v[46:47], v17 offset:41984
    v_add_u32 v17, 0x10000, v17
    v_mfma_f32_16x16x32_bf16 v[160:163], v[52:55], a[4:7], v[160:163]
    ds_read_b128 a[84:87], v23 offset:53248
    v_mfma_f32_16x16x32_bf16 v[164:167], v[48:51], a[8:11], v[164:167]
    v_mfma_f32_16x16x32_bf16 v[164:167], v[52:55], a[12:15], v[164:167]
    s_add_u32 m0, s69, 49152
    buffer_load_dword v7, v9, s[44:47], s69 offen sc1
    v_mfma_f32_16x16x32_bf16 v[168:171], v[48:51], a[16:19], v[168:171]
    s_xor_b32 s60, s60, 3670016
    buffer_load_dwordx4 v10, s[20:23], s64 offen lds
    v_mfma_f32_16x16x32_bf16 v[168:171], v[52:55], a[20:23], v[168:171]
    ds_read_b128 a[88:91], v22 offset:55296
    v_mfma_f32_16x16x32_bf16 v[172:175], v[48:51], a[24:27], v[172:175]
    v_mfma_f32_16x16x32_bf16 v[172:175], v[52:55], a[28:31], v[172:175]
    s_waitcnt lgkmcnt(1)
    ds_read_b128 a[92:95], v23 offset:55296
    v_mfma_f32_16x16x32_bf16 v[176:179], v[48:51], a[32:35], v[176:179]
    v_mfma_f32_16x16x32_bf16 v[176:179], v[52:55], a[36:39], v[176:179]
    v_mfma_f32_16x16x32_bf16 v[180:183], v[48:51], a[40:43], v[180:183]
    v_mfma_f32_16x16x32_bf16 v[180:183], v[52:55], a[44:47], v[180:183]
    buffer_load_dwordx4 v11, s[20:23], s64 offen offset:1024 lds
    v_mfma_f32_16x16x32_bf16 v[184:187], v[48:51], a[48:51], v[184:187]
    v_add_u32 v22, 0x10000, v22
    ds_read_b128 a[96:99], v22 offset:16384
    v_mfma_f32_16x16x32_bf16 v[184:187], v[52:55], a[52:55], v[184:187]
    v_mfma_f32_16x16x32_bf16 v[188:191], v[48:51], a[56:59], v[188:191]
    v_add_u32 v23, 0x10000, v23
    ds_read_b64_tr_b16 v[48:49], v14 offset:0
    v_mfma_f32_16x16x32_bf16 v[188:191], v[52:55], a[60:63], v[188:191]
    ds_read_b128 a[100:103], v23 offset:16384
    ds_read_b64_tr_b16 v[50:51], v14 offset:1024
    v_mfma_f32_16x16x32_bf16 v[192:195], v[56:59], a[0:3], v[192:195]
    ds_read_b64_tr_b16 v[52:53], v14 offset:8192
    ds_read_b64_tr_b16 v[54:55], v14 offset:9216
    v_mfma_f32_16x16x32_bf16 v[192:195], v[60:63], a[4:7], v[192:195]
    v_add_u32 v14, 0xfffe0000, v14
    v_mfma_f32_16x16x32_bf16 v[196:199], v[56:59], a[8:11], v[196:199]
    ds_read_b128 a[104:107], v22 offset:18432
    v_mfma_f32_16x16x32_bf16 v[196:199], v[60:63], a[12:15], v[196:199]
    buffer_load_dwordx4 v12, s[20:23], s64 offen offset:2048 lds
    v_mfma_f32_16x16x32_bf16 v[200:203], v[56:59], a[16:19], v[200:203]
    v_mfma_f32_16x16x32_bf16 v[200:203], v[60:63], a[20:23], v[200:203]
    ds_read_b128 a[108:111], v23 offset:18432
    v_mfma_f32_16x16x32_bf16 v[204:207], v[56:59], a[24:27], v[204:207]
    v_mfma_f32_16x16x32_bf16 v[204:207], v[60:63], a[28:31], v[204:207]
    v_mfma_f32_16x16x32_bf16 v[208:211], v[56:59], a[32:35], v[208:211]
    v_mfma_f32_16x16x32_bf16 v[208:211], v[60:63], a[36:39], v[208:211]
    ds_read_b128 a[112:115], v22 offset:20480
    v_mfma_f32_16x16x32_bf16 v[212:215], v[56:59], a[40:43], v[212:215]
    buffer_load_dwordx4 v13, s[20:23], s64 offen offset:3072 lds
    v_mfma_f32_16x16x32_bf16 v[212:215], v[60:63], a[44:47], v[212:215]
    v_mfma_f32_16x16x32_bf16 v[216:219], v[56:59], a[48:51], v[216:219]
    ds_read_b128 a[116:119], v23 offset:20480
    v_mfma_f32_16x16x32_bf16 v[216:219], v[60:63], a[52:55], v[216:219]
    v_mfma_f32_16x16x32_bf16 v[220:223], v[56:59], a[56:59], v[220:223]
    ds_read_b64_tr_b16 v[56:57], v15 offset:0
    ds_read_b64_tr_b16 v[58:59], v15 offset:1024
    v_mfma_f32_16x16x32_bf16 v[220:223], v[60:63], a[60:63], v[220:223]
    s_waitcnt lgkmcnt(3)
    ds_read_b128 a[120:123], v22 offset:22528
    ds_read_b64_tr_b16 v[60:61], v15 offset:8192
    v_mfma_f32_16x16x32_bf16 v[224:227], v[40:43], a[0:3], v[224:227]
    ds_read_b64_tr_b16 v[62:63], v15 offset:9216
    v_add_u32 v15, 0xfffe0000, v15
    v_mfma_f32_16x16x32_bf16 v[224:227], v[44:47], a[4:7], v[224:227]
    s_xor_b32 s64, s64, 128
    v_mov_b32 v22, v100
    v_add_u32 v22, 0x10000, v22
    v_mfma_f32_16x16x32_bf16 v[228:231], v[40:43], a[8:11], v[228:231]
    ds_read_b128 a[124:127], v23 offset:22528
    v_mov_b32 v23, v101
    v_mfma_f32_16x16x32_bf16 v[228:231], v[44:47], a[12:15], v[228:231]
    v_add_u32 v23, 0x10000, v23
    v_mfma_f32_16x16x32_bf16 v[232:235], v[40:43], a[16:19], v[232:235]
    v_mfma_f32_16x16x32_bf16 v[232:235], v[44:47], a[20:23], v[232:235]
    s_add_u32 m0, s69, 65536
    v_mfma_f32_16x16x32_bf16 v[236:239], v[40:43], a[24:27], v[236:239]
    buffer_load_dwordx4 v2, s[24:27], s60 offen lds
    v_mfma_f32_16x16x32_bf16 v[236:239], v[44:47], a[28:31], v[236:239]
    v_mfma_f32_16x16x32_bf16 v[240:243], v[40:43], a[32:35], v[240:243]
    v_mfma_f32_16x16x32_bf16 v[240:243], v[44:47], a[36:39], v[240:243]
    v_mfma_f32_16x16x32_bf16 v[244:247], v[40:43], a[40:43], v[244:247]
    v_mfma_f32_16x16x32_bf16 v[244:247], v[44:47], a[44:47], v[244:247]
    v_mfma_f32_16x16x32_bf16 v[248:251], v[40:43], a[48:51], v[248:251]
    v_mfma_f32_16x16x32_bf16 v[248:251], v[44:47], a[52:55], v[248:251]
    buffer_load_dwordx4 v3, s[24:27], s60 offen offset:1024 lds
    v_mfma_f32_16x16x32_bf16 v[252:255], v[40:43], a[56:59], v[252:255]
    ds_read_b64_tr_b16 v[40:41], v16 offset:0
    ds_read_b64_tr_b16 v[42:43], v16 offset:1024
    v_mfma_f32_16x16x32_bf16 v[252:255], v[44:47], a[60:63], v[252:255]
    ds_read_b64_tr_b16 v[44:45], v16 offset:8192
    ds_read_b64_tr_b16 v[46:47], v16 offset:9216
    v_mfma_f32_16x16x32_bf16 v[128:131], v[48:51], a[64:67], v[128:131]
    v_add_u32 v16, 0xfffe0000, v16
    v_mfma_f32_16x16x32_bf16 v[128:131], v[52:55], a[68:71], v[128:131]
    v_mfma_f32_16x16x32_bf16 v[132:135], v[48:51], a[72:75], v[132:135]
    v_mfma_f32_16x16x32_bf16 v[132:135], v[52:55], a[76:79], v[132:135]
    v_mfma_f32_16x16x32_bf16 v[136:139], v[48:51], a[80:83], v[136:139]
    v_mfma_f32_16x16x32_bf16 v[136:139], v[52:55], a[84:87], v[136:139]
    buffer_load_dwordx4 v4, s[24:27], s60 offen offset:2048 lds
    v_mfma_f32_16x16x32_bf16 v[140:143], v[48:51], a[88:91], v[140:143]
    v_mfma_f32_16x16x32_bf16 v[140:143], v[52:55], a[92:95], v[140:143]
    v_mfma_f32_16x16x32_bf16 v[144:147], v[48:51], a[96:99], v[144:147]
    v_mul_f32 v128, s74, v128
    v_mul_f32 v129, s74, v129
    v_mfma_f32_16x16x32_bf16 v[144:147], v[52:55], a[100:103], v[144:147]
    v_mul_f32 v130, s74, v130
    v_mul_f32 v131, s74, v131
    v_mfma_f32_16x16x32_bf16 v[148:151], v[48:51], a[104:107], v[148:151]
    v_cvt_pk_bf16_f32 v128, v128, v129
    v_cvt_pk_bf16_f32 v129, v130, v131
    v_mfma_f32_16x16x32_bf16 v[148:151], v[52:55], a[108:111], v[148:151]
    v_mul_f32 v132, s74, v132
    v_mul_f32 v133, s74, v133
    v_mfma_f32_16x16x32_bf16 v[152:155], v[48:51], a[112:115], v[152:155]
    s_waitcnt lgkmcnt(0)
    buffer_load_dwordx4 v5, s[24:27], s60 offen offset:3072 lds
    v_mfma_f32_16x16x32_bf16 v[152:155], v[52:55], a[116:119], v[152:155]
    v_mul_f32 v134, s74, v134
    v_mul_f32 v135, s74, v135
    v_mfma_f32_16x16x32_bf16 v[156:159], v[48:51], a[120:123], v[156:159]
    ds_read_b64_tr_b16 v[48:49], v17 offset:0
    ds_read_b64_tr_b16 v[50:51], v17 offset:1024
    v_mfma_f32_16x16x32_bf16 v[156:159], v[52:55], a[124:127], v[156:159]
    ds_read_b64_tr_b16 v[52:53], v17 offset:8192
    ds_read_b64_tr_b16 v[54:55], v17 offset:9216
    v_mfma_f32_16x16x32_bf16 v[160:163], v[56:59], a[64:67], v[160:163]
    v_add_u32 v17, 0xfffe0000, v17
    v_cvt_pk_bf16_f32 v132, v132, v133
    v_mfma_f32_16x16x32_bf16 v[160:163], v[60:63], a[68:71], v[160:163]
    v_cvt_pk_bf16_f32 v133, v134, v135
    v_mul_f32 v136, s74, v136
    v_mfma_f32_16x16x32_bf16 v[164:167], v[56:59], a[72:75], v[164:167]
    v_mul_f32 v137, s74, v137
    v_mul_f32 v138, s74, v138
    v_mfma_f32_16x16x32_bf16 v[164:167], v[60:63], a[76:79], v[164:167]
    s_add_u32 m0, s69, 81920
    v_mul_f32 v139, s74, v139
    v_mul_f32 v160, s74, v160
    v_mfma_f32_16x16x32_bf16 v[168:171], v[56:59], a[80:83], v[168:171]
    s_xor_b32 s60, s60, 524288
    buffer_load_dwordx4 v10, s[20:23], s63 offen lds
    v_mfma_f32_16x16x32_bf16 v[168:171], v[60:63], a[84:87], v[168:171]
    v_mul_f32 v161, s74, v161
    v_mul_f32 v162, s74, v162
    v_mfma_f32_16x16x32_bf16 v[172:175], v[56:59], a[88:91], v[172:175]
    v_mul_f32 v163, s74, v163
    v_cvt_pk_bf16_f32 v130, v160, v161
    v_mfma_f32_16x16x32_bf16 v[172:175], v[60:63], a[92:95], v[172:175]
    v_cvt_pk_bf16_f32 v131, v162, v163
    v_mul_f32 v164, s74, v164
    v_mfma_f32_16x16x32_bf16 v[176:179], v[56:59], a[96:99], v[176:179]
    v_mul_f32 v165, s74, v165
    v_mul_f32 v166, s74, v166
    v_mfma_f32_16x16x32_bf16 v[176:179], v[60:63], a[100:103], v[176:179]
    v_mul_f32 v167, s74, v167
    v_cvt_pk_bf16_f32 v134, v164, v165
    v_mfma_f32_16x16x32_bf16 v[180:183], v[56:59], a[104:107], v[180:183]
    v_cvt_pk_bf16_f32 v135, v166, v167
    v_mul_f32 v168, s74, v168
    v_mfma_f32_16x16x32_bf16 v[180:183], v[60:63], a[108:111], v[180:183]
    buffer_load_dwordx4 v11, s[20:23], s63 offen offset:1024 lds
    v_mfma_f32_16x16x32_bf16 v[184:187], v[56:59], a[112:115], v[184:187]
    v_mul_f32 v169, s74, v169
    v_mul_f32 v170, s74, v170
    v_mfma_f32_16x16x32_bf16 v[184:187], v[60:63], a[116:119], v[184:187]
    v_mul_f32 v171, s74, v171
    v_cvt_pk_bf16_f32 v136, v136, v137
    v_mfma_f32_16x16x32_bf16 v[188:191], v[56:59], a[120:123], v[188:191]
    v_cvt_pk_bf16_f32 v137, v138, v139
    v_cvt_pk_bf16_f32 v138, v168, v169
    v_mfma_f32_16x16x32_bf16 v[188:191], v[60:63], a[124:127], v[188:191]
    v_cvt_pk_bf16_f32 v139, v170, v171
    v_mul_f32 v140, s74, v140
    v_mfma_f32_16x16x32_bf16 v[192:195], v[40:43], a[64:67], v[192:195]
    v_mul_f32 v141, s74, v141
    v_mul_f32 v142, s74, v142
    v_mfma_f32_16x16x32_bf16 v[192:195], v[44:47], a[68:71], v[192:195]
    v_mul_f32 v143, s74, v143
    v_mul_f32 v172, s74, v172
    v_mfma_f32_16x16x32_bf16 v[196:199], v[40:43], a[72:75], v[196:199]
    v_mul_f32 v173, s74, v173
    v_mul_f32 v174, s74, v174
    v_mfma_f32_16x16x32_bf16 v[196:199], v[44:47], a[76:79], v[196:199]
    buffer_load_dwordx4 v12, s[20:23], s63 offen offset:2048 lds
    v_mfma_f32_16x16x32_bf16 v[200:203], v[40:43], a[80:83], v[200:203]
    v_mul_f32 v175, s74, v175
    v_cvt_pk_bf16_f32 v140, v140, v141
    v_mfma_f32_16x16x32_bf16 v[200:203], v[44:47], a[84:87], v[200:203]
    v_cvt_pk_bf16_f32 v141, v142, v143
    v_cvt_pk_bf16_f32 v142, v172, v173
    v_mfma_f32_16x16x32_bf16 v[204:207], v[40:43], a[88:91], v[204:207]
    v_cvt_pk_bf16_f32 v143, v174, v175
    v_mul_f32 v144, s74, v144
    v_mfma_f32_16x16x32_bf16 v[204:207], v[44:47], a[92:95], v[204:207]
    v_mul_f32 v145, s74, v145
    v_mul_f32 v146, s74, v146
    v_mfma_f32_16x16x32_bf16 v[208:211], v[40:43], a[96:99], v[208:211]
    v_mul_f32 v147, s74, v147
    v_mul_f32 v176, s74, v176
    v_mfma_f32_16x16x32_bf16 v[208:211], v[44:47], a[100:103], v[208:211]
    v_mul_f32 v177, s74, v177
    v_mul_f32 v178, s74, v178
    v_mfma_f32_16x16x32_bf16 v[212:215], v[40:43], a[104:107], v[212:215]
    buffer_load_dwordx4 v13, s[20:23], s63 offen offset:3072 lds
    v_mfma_f32_16x16x32_bf16 v[212:215], v[44:47], a[108:111], v[212:215]
    v_mul_f32 v179, s74, v179
    v_cvt_pk_bf16_f32 v144, v144, v145
    v_mfma_f32_16x16x32_bf16 v[216:219], v[40:43], a[112:115], v[216:219]
    v_cvt_pk_bf16_f32 v145, v146, v147
    v_cvt_pk_bf16_f32 v146, v176, v177
    v_mfma_f32_16x16x32_bf16 v[216:219], v[44:47], a[116:119], v[216:219]
    v_cvt_pk_bf16_f32 v147, v178, v179
    v_mul_f32 v148, s74, v148
    v_mfma_f32_16x16x32_bf16 v[220:223], v[40:43], a[120:123], v[220:223]
    v_mul_f32 v149, s74, v149
    v_mul_f32 v150, s74, v150
    v_mfma_f32_16x16x32_bf16 v[220:223], v[44:47], a[124:127], v[220:223]
    s_add_u32 s72, s70, 0
    v_mul_f32 v151, s74, v151
    v_mul_f32 v180, s74, v180
    s_waitcnt lgkmcnt(0)
    v_mfma_f32_16x16x32_bf16 v[224:227], v[48:51], a[64:67], v[224:227]
    buffer_store_dwordx4 v[128:131], v1, s[36:39], s72 offen sc1
    v_mfma_f32_16x16x32_bf16 v[224:227], v[52:55], a[68:71], v[224:227]
    s_xor_b32 s63, s63, 384
    v_mul_f32 v181, s74, v181
    v_mul_f32 v182, s74, v182
    v_mfma_f32_16x16x32_bf16 v[228:231], v[48:51], a[72:75], v[228:231]
    v_mul_f32 v183, s74, v183
    v_cvt_pk_bf16_f32 v148, v148, v149
    v_mfma_f32_16x16x32_bf16 v[228:231], v[52:55], a[76:79], v[228:231]
    v_cvt_pk_bf16_f32 v149, v150, v151
    v_cvt_pk_bf16_f32 v150, v180, v181
    v_mfma_f32_16x16x32_bf16 v[232:235], v[48:51], a[80:83], v[232:235]
    v_cvt_pk_bf16_f32 v151, v182, v183
    v_mul_f32 v152, s74, v152
    v_mfma_f32_16x16x32_bf16 v[232:235], v[52:55], a[84:87], v[232:235]
    s_add_u32 m0, s67, 98304
    v_mul_f32 v153, s74, v153
    v_mul_f32 v154, s74, v154
    s_waitcnt vmcnt(9) lgkmcnt(0)
    v_cmp_gt_u32 vcc, 8, v7
    s_nop 1
    s_and_b64 vcc, vcc, s[86:87]
    s_cbranch_scc1 SPIN_WA
BACK_WA:
    s_barrier
    v_mfma_f32_16x16x32_bf16 v[236:239], v[48:51], a[88:91], v[236:239]
    buffer_load_dwordx4 v1, s[28:31], s65 offen sc1 lds
    v_mfma_f32_16x16x32_bf16 v[236:239], v[52:55], a[92:95], v[236:239]
    ds_read_b64_tr_b16 v[56:57], v14 offset:0
    ds_read_b64_tr_b16 v[58:59], v14 offset:1024
    v_mfma_f32_16x16x32_bf16 v[240:243], v[48:51], a[96:99], v[240:243]
    ds_read_b64_tr_b16 v[60:61], v14 offset:8192
    ds_read_b64_tr_b16 v[62:63], v14 offset:9216
    v_mfma_f32_16x16x32_bf16 v[240:243], v[52:55], a[100:103], v[240:243]
    ds_read_b64_tr_b16 v[40:41], v15 offset:0
    ds_read_b64_tr_b16 v[42:43], v15 offset:1024
    v_mfma_f32_16x16x32_bf16 v[244:247], v[48:51], a[104:107], v[244:247]
    ds_read_b64_tr_b16 v[44:45], v15 offset:8192
    ds_read_b64_tr_b16 v[46:47], v15 offset:9216
    v_mfma_f32_16x16x32_bf16 v[244:247], v[52:55], a[108:111], v[244:247]
    v_mul_f32 v155, s74, v155
    v_mul_f32 v184, s74, v184
    v_mfma_f32_16x16x32_bf16 v[248:251], v[48:51], a[112:115], v[248:251]
    v_mul_f32 v185, s74, v185
    v_mul_f32 v186, s74, v186
    v_mfma_f32_16x16x32_bf16 v[248:251], v[52:55], a[116:119], v[248:251]
    v_mul_f32 v187, s74, v187
    v_cvt_pk_bf16_f32 v152, v152, v153
    v_mfma_f32_16x16x32_bf16 v[252:255], v[48:51], a[120:123], v[252:255]
    s_lshr_b32 s92, s2, 3
    buffer_load_dwordx4 v1, s[28:31], s65 offen offset:1024 sc1 lds
    v_mfma_f32_16x16x32_bf16 v[252:255], v[52:55], a[124:127], v[252:255]
    s_lshl2_add_u32 s92, s92, s4
    v_lshrrev_b32 v9, 4, v1
    v_min_u32 v9, 0, v9
    s_waitcnt lgkmcnt(0)
    v_mfma_f32_16x16x32_bf16 a[128:131], a[0:3], v[56:59], a[128:131]
    s_mul_i32 s92, s92, 1
    ds_read_b64_tr_b16 v[48:49], v16 offset:0
    ds_read_b64_tr_b16 v[50:51], v16 offset:1024
    v_mfma_f32_16x16x32_bf16 a[128:131], a[4:7], v[60:63], a[128:131]
    s_add_u32 s92, s92, 32
    v_add_lshl_u32 v9, v9, s92, 7
    ds_read_b64_tr_b16 v[52:53], v16 offset:8192
    v_mfma_f32_16x16x32_bf16 a[132:135], a[8:11], v[56:59], a[132:135]
    s_getpc_b64 s[92:93]
    global_load_dword v9, v9, s[92:93]
    v_mfma_f32_16x16x32_bf16 a[132:135], a[12:15], v[60:63], a[132:135]
    ds_read_b128 v[64:67], v24 offset:16384
    ds_read_b64_tr_b16 v[54:55], v16 offset:9216
    v_mfma_f32_16x16x32_bf16 a[136:139], a[16:19], v[56:59], a[136:139]
    v_cvt_pk_bf16_f32 v153, v154, v155
    v_cvt_pk_bf16_f32 v154, v184, v185
    v_mfma_f32_16x16x32_bf16 a[136:139], a[20:23], v[60:63], a[136:139]
    v_cvt_pk_bf16_f32 v155, v186, v187
    v_mul_f32 v156, s74, v156
    v_mfma_f32_16x16x32_bf16 a[140:143], a[24:27], v[56:59], a[140:143]
    s_add_u32 m0, s68, 106496
    v_mul_f32 v157, s74, v157
    v_mul_f32 v158, s74, v158
    v_mfma_f32_16x16x32_bf16 a[140:143], a[28:31], v[60:63], a[140:143]
    buffer_load_dwordx4 v6, s[20:23], s66 offen lds
    v_mfma_f32_16x16x32_bf16 a[144:147], a[32:35], v[56:59], a[144:147]
    s_add_u32 s72, s70, 4096
    v_mul_f32 v159, s74, v159
    v_mul_f32 v188, s74, v188
    v_mfma_f32_16x16x32_bf16 a[144:147], a[36:39], v[60:63], a[144:147]
    buffer_store_dwordx4 v[132:135], v1, s[36:39], s72 offen sc1
    v_mfma_f32_16x16x32_bf16 a[148:151], a[40:43], v[56:59], a[148:151]
    v_mul_f32 v189, s74, v189
    v_mul_f32 v190, s74, v190
    v_mfma_f32_16x16x32_bf16 a[148:151], a[44:47], v[60:63], a[148:151]
    v_mul_f32 v191, s74, v191
    v_cvt_pk_bf16_f32 v156, v156, v157
    v_mfma_f32_16x16x32_bf16 a[152:155], a[48:51], v[56:59], a[152:155]
    v_cvt_pk_bf16_f32 v157, v158, v159
    v_cvt_pk_bf16_f32 v158, v188, v189
    v_mfma_f32_16x16x32_bf16 a[152:155], a[52:55], v[60:63], a[152:155]
    ds_read_b128 v[68:71], v25 offset:16384
    v_cvt_pk_bf16_f32 v159, v190, v191
    v_mfma_f32_16x16x32_bf16 a[156:159], a[56:59], v[56:59], a[156:159]
    s_add_u32 m0, s69, 114688
    ds_read_b64_tr_b16 v[56:57], v17 offset:0
    ds_read_b64_tr_b16 v[58:59], v17 offset:1024
    v_mfma_f32_16x16x32_bf16 a[156:159], a[60:63], v[60:63], a[156:159]
    s_xor_b32 s65, s65, 8192
    buffer_load_dwordx4 v10, s[20:23], s64 offen lds
    v_mfma_f32_16x16x32_bf16 a[160:163], a[0:3], v[40:43], a[160:163]
    s_xor_b32 s66, s66, 128
    ds_read_b64_tr_b16 v[60:61], v17 offset:8192
    ds_read_b64_tr_b16 v[62:63], v17 offset:9216
    v_mfma_f32_16x16x32_bf16 a[160:163], a[4:7], v[44:47], a[160:163]
    v_mul_f32 v192, s74, v192
    v_mul_f32 v193, s74, v193
    v_mfma_f32_16x16x32_bf16 a[164:167], a[8:11], v[40:43], a[164:167]
    v_mul_f32 v194, s74, v194
    v_mul_f32 v195, s74, v195
    v_mfma_f32_16x16x32_bf16 a[164:167], a[12:15], v[44:47], a[164:167]
    v_mul_f32 v224, s74, v224
    v_mul_f32 v225, s74, v225
    v_mfma_f32_16x16x32_bf16 a[168:171], a[16:19], v[40:43], a[168:171]
    v_mul_f32 v226, s74, v226
    v_mul_f32 v227, s74, v227
    v_mfma_f32_16x16x32_bf16 a[168:171], a[20:23], v[44:47], a[168:171]
    v_cvt_pk_bf16_f32 v192, v192, v193
    v_cvt_pk_bf16_f32 v193, v194, v195
    v_mfma_f32_16x16x32_bf16 a[172:175], a[24:27], v[40:43], a[172:175]
    v_cvt_pk_bf16_f32 v194, v224, v225
    v_cvt_pk_bf16_f32 v195, v226, v227
    v_mfma_f32_16x16x32_bf16 a[172:175], a[28:31], v[44:47], a[172:175]
    v_mul_f32 v196, s74, v196
    v_mul_f32 v197, s74, v197
    v_mfma_f32_16x16x32_bf16 a[176:179], a[32:35], v[40:43], a[176:179]
    buffer_load_dwordx4 v11, s[20:23], s64 offen offset:1024 lds
    v_mfma_f32_16x16x32_bf16 a[176:179], a[36:39], v[44:47], a[176:179]
    ds_read_b128 v[72:75], v24 offset:24576
    v_mul_f32 v198, s74, v198
    v_mfma_f32_16x16x32_bf16 a[180:183], a[40:43], v[40:43], a[180:183]
    v_mul_f32 v199, s74, v199
    v_mul_f32 v228, s74, v228
    v_mfma_f32_16x16x32_bf16 a[180:183], a[44:47], v[44:47], a[180:183]
    v_mul_f32 v229, s74, v229
    v_mul_f32 v230, s74, v230
    v_mfma_f32_16x16x32_bf16 a[184:187], a[48:51], v[40:43], a[184:187]
    v_mul_f32 v231, s74, v231
    v_cvt_pk_bf16_f32 v196, v196, v197
    v_mfma_f32_16x16x32_bf16 a[184:187], a[52:55], v[44:47], a[184:187]
    v_cvt_pk_bf16_f32 v197, v198, v199
    v_cvt_pk_bf16_f32 v198, v228, v229
    v_mfma_f32_16x16x32_bf16 a[188:191], a[56:59], v[40:43], a[188:191]
    ds_read_b64_tr_b16 v[40:41], v14 offset:32768
    ds_read_b64_tr_b16 v[42:43], v14 offset:33792
    v_mfma_f32_16x16x32_bf16 a[188:191], a[60:63], v[44:47], a[188:191]
    s_waitcnt lgkmcnt(2)
    ds_read_b64_tr_b16 v[44:45], v14 offset:40960
    ds_read_b64_tr_b16 v[46:47], v14 offset:41984
    v_mfma_f32_16x16x32_bf16 a[192:195], a[0:3], v[48:51], a[192:195]
    buffer_load_dwordx4 v12, s[20:23], s64 offen offset:2048 lds
    v_mfma_f32_16x16x32_bf16 a[192:195], a[4:7], v[52:55], a[192:195]
    s_add_u32 s72, s70, 8192
    v_xor_b32 v14, s73, v14
    v_add_u32 v14, 0x10000, v14
    v_mfma_f32_16x16x32_bf16 a[196:199], a[8:11], v[48:51], a[196:199]
    buffer_store_dwordx4 v[136:139], v1, s[36:39], s72 offen sc1
    v_mfma_f32_16x16x32_bf16 a[196:199], a[12:15], v[52:55], a[196:199]
    ds_read_b128 v[76:79], v25 offset:24576
    v_cvt_pk_bf16_f32 v199, v230, v231
    v_mfma_f32_16x16x32_bf16 a[200:203], a[16:19], v[48:51], a[200:203]
    v_mul_f32 v200, s74, v200
    v_mul_f32 v201, s74, v201
    v_mfma_f32_16x16x32_bf16 a[200:203], a[20:23], v[52:55], a[200:203]
    v_mul_f32 v202, s74, v202
    v_mul_f32 v203, s74, v203
    v_mfma_f32_16x16x32_bf16 a[204:207], a[24:27], v[48:51], a[204:207]
    v_mul_f32 v232, s74, v232
    v_mul_f32 v233, s74, v233
    v_mfma_f32_16x16x32_bf16 a[204:207], a[28:31], v[52:55], a[204:207]
    v_mul_f32 v234, s74, v234
    v_mul_f32 v235, s74, v235
    v_mfma_f32_16x16x32_bf16 a[208:211], a[32:35], v[48:51], a[208:211]
    v_cvt_pk_bf16_f32 v200, v200, v201
    v_cvt_pk_bf16_f32 v201, v202, v203
    v_mfma_f32_16x16x32_bf16 a[208:211], a[36:39], v[52:55], a[208:211]
    buffer_load_dwordx4 v13, s[20:23], s64 offen offset:3072 lds
    v_mfma_f32_16x16x32_bf16 a[212:215], a[40:43], v[48:51], a[212:215]
    v_cvt_pk_bf16_f32 v202, v232, v233
    v_cvt_pk_bf16_f32 v203, v234, v235
    v_mfma_f32_16x16x32_bf16 a[212:215], a[44:47], v[52:55], a[212:215]
    v_mul_f32 v204, s74, v204
    v_mul_f32 v205, s74, v205
    v_mfma_f32_16x16x32_bf16 a[216:219], a[48:51], v[48:51], a[216:219]
    v_mul_f32 v206, s74, v206
    v_mul_f32 v207, s74, v207
    v_mfma_f32_16x16x32_bf16 a[216:219], a[52:55], v[52:55], a[216:219]
    v_mul_f32 v236, s74, v236
    v_mul_f32 v237, s74, v237
    v_mfma_f32_16x16x32_bf16 a[220:223], a[56:59], v[48:51], a[220:223]
    ds_read_b64_tr_b16 v[48:49], v15 offset:32768
    ds_read_b64_tr_b16 v[50:51], v15 offset:33792
    v_mfma_f32_16x16x32_bf16 a[220:223], a[60:63], v[52:55], a[220:223]
    ds_read_b64_tr_b16 v[52:53], v15 offset:40960
    ds_read_b64_tr_b16 v[54:55], v15 offset:41984
    v_mfma_f32_16x16x32_bf16 a[224:227], a[0:3], v[56:59], a[224:227]
    v_xor_b32 v15, s73, v15
    v_add_u32 v15, 0x10000, v15
    v_mfma_f32_16x16x32_bf16 a[224:227], a[4:7], v[60:63], a[224:227]
    s_xor_b32 s64, s64, 384
    v_accvgpr_write_b32 a4, v192
    v_accvgpr_write_b32 a5, v193
    v_mfma_f32_16x16x32_bf16 a[228:231], a[8:11], v[56:59], a[228:231]
    v_accvgpr_write_b32 a6, v194
    v_accvgpr_write_b32 a7, v195
    v_mfma_f32_16x16x32_bf16 a[228:231], a[12:15], v[60:63], a[228:231]
    v_accvgpr_write_b32 a12, v196
    v_accvgpr_write_b32 a13, v197
    v_mfma_f32_16x16x32_bf16 a[232:235], a[16:19], v[56:59], a[232:235]
    v_accvgpr_write_b32 a14, v198
    v_accvgpr_write_b32 a15, v199
    v_mfma_f32_16x16x32_bf16 a[232:235], a[20:23], v[60:63], a[232:235]
    s_add_u32 m0, s69, 131072
    v_mul_f32 v238, s74, v238
    v_mul_f32 v239, s74, v239
    v_mfma_f32_16x16x32_bf16 a[236:239], a[24:27], v[56:59], a[236:239]
    buffer_load_dwordx4 v2, s[24:27], s60 offen lds
    v_mfma_f32_16x16x32_bf16 a[236:239], a[28:31], v[60:63], a[236:239]
    v_accvgpr_write_b32 a20, v200
    v_accvgpr_write_b32 a21, v201
    v_mfma_f32_16x16x32_bf16 a[240:243], a[32:35], v[56:59], a[240:243]
    v_accvgpr_write_b32 a22, v202
    v_accvgpr_write_b32 a23, v203
    v_mfma_f32_16x16x32_bf16 a[240:243], a[36:39], v[60:63], a[240:243]
    v_cvt_pk_bf16_f32 v204, v204, v205
    v_cvt_pk_bf16_f32 v205, v206, v207
    v_mfma_f32_16x16x32_bf16 a[244:247], a[40:43], v[56:59], a[244:247]
    s_add_u32 s72, s70, 12288
    v_accvgpr_write_b32 a40, v148
    v_accvgpr_write_b32 a41, v149
    v_mfma_f32_16x16x32_bf16 a[244:247], a[44:47], v[60:63], a[244:247]
    buffer_store_dwordx4 v[140:143], v1, s[36:39], s72 offen sc1
    v_mfma_f32_16x16x32_bf16 a[248:251], a[48:51], v[56:59], a[248:251]
    v_accvgpr_write_b32 a42, v150
    v_accvgpr_write_b32 a43, v151
    v_mfma_f32_16x16x32_bf16 a[248:251], a[52:55], v[60:63], a[248:251]
    buffer_load_dwordx4 v3, s[24:27], s60 offen offset:1024 lds
    v_mfma_f32_16x16x32_bf16 a[252:255], a[56:59], v[56:59], a[252:255]
    ds_read_b64_tr_b16 v[56:57], v16 offset:32768
    ds_read_b64_tr_b16 v[58:59], v16 offset:33792
    v_mfma_f32_16x16x32_bf16 a[252:255], a[60:63], v[60:63], a[252:255]
    s_waitcnt lgkmcnt(2)
    ds_read_b64_tr_b16 v[60:61], v16 offset:40960
    ds_read_b64_tr_b16 v[62:63], v16 offset:41984
    v_mfma_f32_16x16x32_bf16 a[128:131], a[64:67], v[40:43], a[128:131]
    v_xor_b32 v16, s73, v16
    v_add_u32 v16, 0x10000, v16
    v_mfma_f32_16x16x32_bf16 a[128:131], a[68:71], v[44:47], a[128:131]
    v_accvgpr_write_b32 a48, v152
    v_accvgpr_write_b32 a49, v153
    v_mfma_f32_16x16x32_bf16 a[132:135], a[72:75], v[40:43], a[132:135]
    ds_read_b128 v[80:83], v24 offset:49152
    v_accvgpr_write_b32 a50, v154
    v_mfma_f32_16x16x32_bf16 a[132:135], a[76:79], v[44:47], a[132:135]
    v_accvgpr_write_b32 a51, v155
    v_accvgpr_write_b32 a56, v156
    v_mfma_f32_16x16x32_bf16 a[136:139], a[80:83], v[40:43], a[136:139]
    v_accvgpr_write_b32 a57, v157
    v_accvgpr_write_b32 a58, v158
    v_mfma_f32_16x16x32_bf16 a[136:139], a[84:87], v[44:47], a[136:139]
    buffer_load_dwordx4 v4, s[24:27], s60 offen offset:2048 lds
    v_mfma_f32_16x16x32_bf16 a[140:143], a[88:91], v[40:43], a[140:143]
    v_accvgpr_write_b32 a59, v159
    v_cvt_pk_bf16_f32 v206, v236, v237
    v_mfma_f32_16x16x32_bf16 a[140:143], a[92:95], v[44:47], a[140:143]
    v_cvt_pk_bf16_f32 v207, v238, v239
    v_mul_f32 v208, s74, v208
    v_mfma_f32_16x16x32_bf16 a[144:147], a[96:99], v[40:43], a[144:147]
    v_mul_f32 v209, s74, v209
    v_mul_f32 v210, s74, v210
    v_mfma_f32_16x16x32_bf16 a[144:147], a[100:103], v[44:47], a[144:147]
    v_mul_f32 v211, s74, v211
    v_mul_f32 v240, s74, v240
    v_mfma_f32_16x16x32_bf16 a[148:151], a[104:107], v[40:43], a[148:151]
    v_mul_f32 v241, s74, v241
    v_mul_f32 v242, s74, v242
    v_mfma_f32_16x16x32_bf16 a[148:151], a[108:111], v[44:47], a[148:151]
    v_mul_f32 v243, s74, v243
    v_accvgpr_write_b32 a28, v204
    v_mfma_f32_16x16x32_bf16 a[152:155], a[112:115], v[40:43], a[152:155]
    buffer_load_dwordx4 v5, s[24:27], s60 offen offset:3072 lds
    v_mfma_f32_16x16x32_bf16 a[152:155], a[116:119], v[44:47], a[152:155]
    ds_read_b128 v[84:87], v25 offset:49152
    v_accvgpr_write_b32 a29, v205
    v_mfma_f32_16x16x32_bf16 a[156:159], a[120:123], v[40:43], a[156:159]
    ds_read_b64_tr_b16 v[40:41], v17 offset:32768
    ds_read_b64_tr_b16 v[42:43], v17 offset:33792
    v_mfma_f32_16x16x32_bf16 a[156:159], a[124:127], v[44:47], a[156:159]
    ds_read_b64_tr_b16 v[44:45], v17 offset:40960
    ds_read_b64_tr_b16 v[46:47], v17 offset:41984
    v_mfma_f32_16x16x32_bf16 a[160:163], a[64:67], v[48:51], a[160:163]
    v_xor_b32 v17, s73, v17
    v_add_u32 v17, 0x10000, v17
    v_mfma_f32_16x16x32_bf16 a[160:163], a[68:71], v[52:55], a[160:163]
    v_accvgpr_write_b32 a30, v206
    v_accvgpr_write_b32 a31, v207
    v_mfma_f32_16x16x32_bf16 a[164:167], a[72:75], v[48:51], a[164:167]
    v_cvt_pk_bf16_f32 v208, v208, v209
    v_cvt_pk_bf16_f32 v209, v210, v211
    v_mfma_f32_16x16x32_bf16 a[164:167], a[76:79], v[52:55], a[164:167]
    s_add_u32 m0, s69, 147456
    v_cvt_pk_bf16_f32 v210, v240, v241
    v_cvt_pk_bf16_f32 v211, v242, v243
    v_mfma_f32_16x16x32_bf16 a[168:171], a[80:83], v[48:51], a[168:171]
    s_xor_b32 s60, s60, 1572864
    buffer_load_dwordx4 v10, s[20:23], s63 offen lds
    v_mfma_f32_16x16x32_bf16 a[168:171], a[84:87], v[52:55], a[168:171]
    s_add_u32 s72, s70, 32768
    buffer_store_dwordx4 v[144:147], v1, s[36:39], s72 offen sc1
    v_mfma_f32_16x16x32_bf16 a[172:175], a[88:91], v[48:51], a[172:175]
    v_mul_f32 v212, s74, v212
    v_mul_f32 v213, s74, v213
    v_mfma_f32_16x16x32_bf16 a[172:175], a[92:95], v[52:55], a[172:175]
    v_mul_f32 v214, s74, v214
    v_mul_f32 v215, s74, v215
    v_mfma_f32_16x16x32_bf16 a[176:179], a[96:99], v[48:51], a[176:179]
    ds_read_b128 v[88:91], v24 offset:57344
    v_mul_f32 v244, s74, v244
    v_mfma_f32_16x16x32_bf16 a[176:179], a[100:103], v[52:55], a[176:179]
    v_mul_f32 v245, s74, v245
    v_mul_f32 v246, s74, v246
    v_mfma_f32_16x16x32_bf16 a[180:183], a[104:107], v[48:51], a[180:183]
    v_mul_f32 v247, s74, v247
    v_accvgpr_write_b32 a36, v208
    v_mfma_f32_16x16x32_bf16 a[180:183], a[108:111], v[52:55], a[180:183]
    buffer_load_dwordx4 v11, s[20:23], s63 offen offset:1024 lds
    v_mfma_f32_16x16x32_bf16 a[184:187], a[112:115], v[48:51], a[184:187]
    v_accvgpr_write_b32 a37, v209
    v_accvgpr_write_b32 a38, v210
    v_mfma_f32_16x16x32_bf16 a[184:187], a[116:119], v[52:55], a[184:187]
    v_accvgpr_write_b32 a39, v211
    v_cvt_pk_bf16_f32 v212, v212, v213
    v_mfma_f32_16x16x32_bf16 a[188:191], a[120:123], v[48:51], a[188:191]
    v_cvt_pk_bf16_f32 v213, v214, v215
    v_cvt_pk_bf16_f32 v214, v244, v245
    v_mfma_f32_16x16x32_bf16 a[188:191], a[124:127], v[52:55], a[188:191]
    s_waitcnt lgkmcnt(0)
    v_cvt_pk_bf16_f32 v215, v246, v247
    v_mul_f32 v216, s74, v216
    v_mfma_f32_16x16x32_bf16 a[192:195], a[64:67], v[56:59], a[192:195]
    v_mul_f32 v217, s74, v217
    v_mul_f32 v218, s74, v218
    v_mfma_f32_16x16x32_bf16 a[192:195], a[68:71], v[60:63], a[192:195]
    v_accvgpr_read_b32 v32, a128
    v_accvgpr_read_b32 v31, a129
    v_mfma_f32_16x16x32_bf16 a[196:199], a[72:75], v[56:59], a[196:199]
    v_cvt_pk_bf16_f32 v32, v32, v31
    v_accvgpr_read_b32 v33, a130
    v_mfma_f32_16x16x32_bf16 a[196:199], a[76:79], v[60:63], a[196:199]
    buffer_load_dwordx4 v12, s[20:23], s63 offen offset:2048 lds
    v_mfma_f32_16x16x32_bf16 a[200:203], a[80:83], v[56:59], a[200:203]
    ds_read_b128 v[92:95], v25 offset:57344
    v_accvgpr_read_b32 v31, a131
    v_mfma_f32_16x16x32_bf16 a[200:203], a[84:87], v[60:63], a[200:203]
    v_cvt_pk_bf16_f32 v33, v33, v31
    v_accvgpr_read_b32 v34, a132
    v_mfma_f32_16x16x32_bf16 a[204:207], a[88:91], v[56:59], a[204:207]
    v_accvgpr_read_b32 v31, a133
    v_cvt_pk_bf16_f32 v34, v34, v31
    v_mfma_f32_16x16x32_bf16 a[204:207], a[92:95], v[60:63], a[204:207]
    v_accvgpr_read_b32 v35, a134
    v_accvgpr_read_b32 v31, a135
    v_mfma_f32_16x16x32_bf16 a[208:211], a[96:99], v[56:59], a[208:211]
    v_cvt_pk_bf16_f32 v35, v35, v31
    v_mul_f32 v219, s74, v219
    v_mfma_f32_16x16x32_bf16 a[208:211], a[100:103], v[60:63], a[208:211]
    v_mul_f32 v248, s74, v248
    v_mul_f32 v249, s74, v249
    v_mfma_f32_16x16x32_bf16 a[212:215], a[104:107], v[56:59], a[212:215]
    buffer_load_dwordx4 v13, s[20:23], s63 offen offset:3072 lds
    v_mfma_f32_16x16x32_bf16 a[212:215], a[108:111], v[60:63], a[212:215]
    v_mul_f32 v250, s74, v250
    v_mul_f32 v251, s74, v251
    v_mfma_f32_16x16x32_bf16 a[216:219], a[112:115], v[56:59], a[216:219]
    s_add_u32 s72, s71, 0
    v_accvgpr_write_b32 a44, v212
    v_accvgpr_write_b32 a45, v213
    v_mfma_f32_16x16x32_bf16 a[216:219], a[116:119], v[60:63], a[216:219]
    buffer_store_dwordx4 v[32:35], v1, s[36:39], s72 offen sc1
    v_mfma_f32_16x16x32_bf16 a[220:223], a[120:123], v[56:59], a[220:223]
    v_accvgpr_write_b32 a46, v214
    v_accvgpr_write_b32 a47, v215
    v_mfma_f32_16x16x32_bf16 a[220:223], a[124:127], v[60:63], a[220:223]
    v_cvt_pk_bf16_f32 v216, v216, v217
    v_cvt_pk_bf16_f32 v217, v218, v219
    v_mfma_f32_16x16x32_bf16 a[224:227], a[64:67], v[40:43], a[224:227]
    v_cvt_pk_bf16_f32 v218, v248, v249
    v_cvt_pk_bf16_f32 v219, v250, v251
    v_mfma_f32_16x16x32_bf16 a[224:227], a[68:71], v[44:47], a[224:227]
    s_xor_b32 s63, s63, 128
    v_mul_f32 v220, s74, v220
    v_mul_f32 v221, s74, v221
    v_mfma_f32_16x16x32_bf16 a[228:231], a[72:75], v[40:43], a[228:231]
    v_mul_f32 v222, s74, v222
    v_mul_f32 v223, s74, v223
    v_mfma_f32_16x16x32_bf16 a[228:231], a[76:79], v[44:47], a[228:231]
    v_mul_f32 v252, s74, v252
    v_mul_f32 v253, s74, v253
    v_mfma_f32_16x16x32_bf16 a[232:235], a[80:83], v[40:43], a[232:235]
    v_mul_f32 v254, s74, v254
    v_mul_f32 v255, s74, v255
    v_mfma_f32_16x16x32_bf16 a[232:235], a[84:87], v[44:47], a[232:235]
    s_waitcnt vmcnt(11) lgkmcnt(0)
    s_barrier
    ds_read_b64_tr_b16 v[48:49], v14 offset:0
    v_mfma_f32_16x16x32_bf16 a[236:239], a[88:91], v[40:43], a[236:239]
    s_add_u32 m0, s67, 0
    ds_read_b64_tr_b16 v[50:51], v14 offset:1024
    ds_read_b64_tr_b16 v[52:53], v14 offset:8192
    v_mfma_f32_16x16x32_bf16 a[236:239], a[92:95], v[44:47], a[236:239]
    buffer_load_dwordx4 v1, s[28:31], s65 offen sc1 lds
    v_mfma_f32_16x16x32_bf16 a[240:243], a[96:99], v[40:43], a[240:243]
    ds_read_b64_tr_b16 v[54:55], v14 offset:9216
    ds_read_b64_tr_b16 v[56:57], v15 offset:0
    v_mfma_f32_16x16x32_bf16 a[240:243], a[100:103], v[44:47], a[240:243]
    ds_read_b64_tr_b16 v[58:59], v15 offset:1024
    ds_read_b64_tr_b16 v[60:61], v15 offset:8192
    v_mfma_f32_16x16x32_bf16 a[244:247], a[104:107], v[40:43], a[244:247]
    ds_read_b64_tr_b16 v[62:63], v15 offset:9216
    v_add_u32 v14, 0x10000, v14
    v_mfma_f32_16x16x32_bf16 a[244:247], a[108:111], v[44:47], a[244:247]
    v_add_u32 v15, 0x10000, v15
    v_accvgpr_read_b32 v32, a136
    v_mfma_f32_16x16x32_bf16 a[248:251], a[112:115], v[40:43], a[248:251]
    v_accvgpr_read_b32 v31, a137
    v_cvt_pk_bf16_f32 v32, v32, v31
    v_mfma_f32_16x16x32_bf16 a[248:251], a[116:119], v[44:47], a[248:251]
    v_accvgpr_read_b32 v33, a138
    v_accvgpr_read_b32 v31, a139
    v_mfma_f32_16x16x32_bf16 a[252:255], a[120:123], v[40:43], a[252:255]
    buffer_load_dwordx4 v1, s[28:31], s65 offen offset:1024 sc1 lds
    v_mfma_f32_16x16x32_bf16 a[252:255], a[124:127], v[44:47], a[252:255]
    s_waitcnt lgkmcnt(0)
    ds_read_b64_tr_b16 v[40:41], v16 offset:0
    ds_read_b64_tr_b16 v[42:43], v16 offset:1024
    v_mfma_f32_16x16x32_bf16 v[128:131], v[48:51], v[64:67], 0
    ds_read_b64_tr_b16 v[44:45], v16 offset:8192
    ds_read_b64_tr_b16 v[46:47], v16 offset:9216
    v_mfma_f32_16x16x32_bf16 v[128:131], v[52:55], v[68:71], v[128:131]
    v_add_u32 v24, 0x10000, v24
    ds_read_b128 a[136:139], v22 offset:32768
    v_mfma_f32_16x16x32_bf16 v[132:135], v[48:51], v[72:75], 0
    ds_read_b128 v[96:99], v24 offset:16384
    v_add_u32 v16, 0x10000, v16
    v_mfma_f32_16x16x32_bf16 v[132:135], v[52:55], v[76:79], v[132:135]
    v_add_u32 v22, 0xffff0000, v22
    v_cvt_pk_bf16_f32 v33, v33, v31
    v_mfma_f32_16x16x32_bf16 v[136:139], v[48:51], v[80:83], 0
    v_accvgpr_read_b32 v34, a140
    v_accvgpr_read_b32 v31, a141
    v_mfma_f32_16x16x32_bf16 v[136:139], v[52:55], v[84:87], v[136:139]
    s_add_u32 s72, s71, 1024
    v_cvt_pk_bf16_f32 v34, v34, v31
    v_accvgpr_read_b32 v35, a142
    v_mfma_f32_16x16x32_bf16 v[140:143], v[48:51], v[88:91], 0
    s_add_u32 m0, s68, 8192
    ds_read_b64_tr_b16 v[48:49], v17 offset:0
    ds_read_b64_tr_b16 v[50:51], v17 offset:1024
    v_mfma_f32_16x16x32_bf16 v[140:143], v[52:55], v[92:95], v[140:143]
    buffer_load_dwordx4 v6, s[20:23], s66 offen lds
    v_mfma_f32_16x16x32_bf16 v[144:147], v[56:59], v[64:67], 0
    ds_read_b64_tr_b16 v[52:53], v17 offset:8192
    ds_read_b64_tr_b16 v[54:55], v17 offset:9216
    v_mfma_f32_16x16x32_bf16 v[144:147], v[60:63], v[68:71], v[144:147]
    v_add_u32 v17, 0x10000, v17
    v_accvgpr_read_b32 v31, a143
    v_mfma_f32_16x16x32_bf16 v[148:151], v[56:59], v[72:75], 0
    ds_read_b128 a[140:143], v23 offset:32768
    v_add_u32 v23, 0xffff0000, v23
    v_mfma_f32_16x16x32_bf16 v[148:151], v[60:63], v[76:79], v[148:151]
    v_cvt_pk_bf16_f32 v35, v35, v31
    v_accvgpr_write_b32 a52, v216
    v_mfma_f32_16x16x32_bf16 v[152:155], v[56:59], v[80:83], 0
    v_add_u32 v25, 0x10000, v25
    v_accvgpr_write_b32 a53, v217
    v_mfma_f32_16x16x32_bf16 v[152:155], v[60:63], v[84:87], v[152:155]
    ds_read_b128 v[100:103], v25 offset:16384
    v_accvgpr_write_b32 a54, v218
    v_mfma_f32_16x16x32_bf16 v[156:159], v[56:59], v[88:91], 0
    s_add_u32 m0, s69, 16384
    ds_read_b64_tr_b16 v[56:57], v18 offset:0
    ds_read_b64_tr_b16 v[58:59], v18 offset:1024
    v_mfma_f32_16x16x32_bf16 v[156:159], v[60:63], v[92:95], v[156:159]
    s_xor_b32 s65, s65, 24576
    buffer_load_dwordx4 v10, s[20:23], s64 offen lds
    s_waitcnt lgkmcnt(3)
    v_mfma_f32_16x16x32_bf16 v[160:163], v[40:43], v[64:67], 0
    s_xor_b32 s66, s66, 384
    ds_read_b64_tr_b16 v[60:61], v18 offset:8192
    ds_read_b64_tr_b16 v[62:63], v18 offset:9216
    v_mfma_f32_16x16x32_bf16 v[160:163], v[44:47], v[68:71], v[160:163]
    v_add_u32 v18, 0x10000, v18
    v_accvgpr_write_b32 a55, v219
    v_mfma_f32_16x16x32_bf16 v[164:167], v[40:43], v[72:75], 0
    buffer_store_dwordx4 v[32:35], v1, s[36:39], s72 offen sc1
    v_mfma_f32_16x16x32_bf16 v[164:167], v[44:47], v[76:79], v[164:167]
    v_cvt_pk_bf16_f32 v220, v220, v221
    v_cvt_pk_bf16_f32 v221, v222, v223
    v_mfma_f32_16x16x32_bf16 v[168:171], v[40:43], v[80:83], 0
    v_cvt_pk_bf16_f32 v222, v252, v253
    v_cvt_pk_bf16_f32 v223, v254, v255
    v_mfma_f32_16x16x32_bf16 v[168:171], v[44:47], v[84:87], v[168:171]
    v_accvgpr_write_b32 a60, v220
    v_accvgpr_write_b32 a61, v221
    v_mfma_f32_16x16x32_bf16 v[172:175], v[40:43], v[88:91], 0
    ds_read_b64_tr_b16 v[40:41], v19 offset:0
    ds_read_b64_tr_b16 v[42:43], v19 offset:1024
    v_mfma_f32_16x16x32_bf16 v[172:175], v[44:47], v[92:95], v[172:175]
    ds_read_b64_tr_b16 v[44:45], v19 offset:8192
    ds_read_b64_tr_b16 v[46:47], v19 offset:9216
    v_mfma_f32_16x16x32_bf16 v[176:179], v[48:51], v[64:67], 0
    buffer_load_dwordx4 v11, s[20:23], s64 offen offset:1024 lds
    v_mfma_f32_16x16x32_bf16 v[176:179], v[52:55], v[68:71], v[176:179]
    ds_read_b128 v[104:107], v24 offset:24576
    v_add_u32 v19, 0x10000, v19
    v_mfma_f32_16x16x32_bf16 v[180:183], v[48:51], v[72:75], 0
    v_accvgpr_write_b32 a62, v222
    v_accvgpr_write_b32 a63, v223
    v_mfma_f32_16x16x32_bf16 v[180:183], v[52:55], v[76:79], v[180:183]
    v_accvgpr_write_b32 a0, 0
    v_accvgpr_write_b32 a1, 0
    v_mfma_f32_16x16x32_bf16 v[184:187], v[48:51], v[80:83], 0
    v_accvgpr_write_b32 a2, 0
    v_accvgpr_write_b32 a3, 0
    v_mfma_f32_16x16x32_bf16 v[184:187], v[52:55], v[84:87], v[184:187]
    v_accvgpr_write_b32 a8, 0
    v_accvgpr_write_b32 a9, 0
    v_mfma_f32_16x16x32_bf16 v[188:191], v[48:51], v[88:91], 0
    s_add_u32 s72, s70, 36864
    ds_read_b64_tr_b16 v[48:49], v20 offset:0
    ds_read_b64_tr_b16 v[50:51], v20 offset:1024
    v_mfma_f32_16x16x32_bf16 v[188:191], v[52:55], v[92:95], v[188:191]
    s_waitcnt lgkmcnt(2)
    ds_read_b64_tr_b16 v[52:53], v20 offset:8192
    ds_read_b64_tr_b16 v[54:55], v20 offset:9216
    v_mfma_f32_16x16x32_bf16 v[192:195], v[56:59], v[64:67], 0
    buffer_load_dwordx4 v12, s[20:23], s64 offen offset:2048 lds
    v_mfma_f32_16x16x32_bf16 v[192:195], v[60:63], v[68:71], v[192:195]
    v_add_u32 v20, 0x10000, v20
    v_accvgpr_write_b32 a10, 0
    v_mfma_f32_16x16x32_bf16 v[196:199], v[56:59], v[72:75], 0
    buffer_store_dwordx4 a[40:43], v1, s[36:39], s72 offen sc1
    v_mfma_f32_16x16x32_bf16 v[196:199], v[60:63], v[76:79], v[196:199]
    ds_read_b128 v[108:111], v25 offset:24576
    v_accvgpr_write_b32 a11, 0
    v_mfma_f32_16x16x32_bf16 v[200:203], v[56:59], v[80:83], 0
    v_accvgpr_write_b32 a16, 0
    v_accvgpr_write_b32 a17, 0
    v_mfma_f32_16x16x32_bf16 v[200:203], v[60:63], v[84:87], v[200:203]
    v_accvgpr_write_b32 a18, 0
    v_accvgpr_write_b32 a19, 0
    v_mfma_f32_16x16x32_bf16 v[204:207], v[56:59], v[88:91], 0
    ds_read_b64_tr_b16 v[56:57], v21 offset:0
    ds_read_b64_tr_b16 v[58:59], v21 offset:1024
    v_mfma_f32_16x16x32_bf16 v[204:207], v[60:63], v[92:95], v[204:207]
    ds_read_b64_tr_b16 v[60:61], v21 offset:8192
    ds_read_b64_tr_b16 v[62:63], v21 offset:9216
    v_mfma_f32_16x16x32_bf16 v[208:211], v[40:43], v[64:67], 0
    v_add_u32 v21, 0x10000, v21
    v_accvgpr_write_b32 a24, 0
    v_mfma_f32_16x16x32_bf16 v[208:211], v[44:47], v[68:71], v[208:211]
    buffer_load_dwordx4 v13, s[20:23], s64 offen offset:3072 lds
    v_mfma_f32_16x16x32_bf16 v[212:215], v[40:43], v[72:75], 0
    v_accvgpr_write_b32 a25, 0
    v_accvgpr_write_b32 a26, 0
    v_mfma_f32_16x16x32_bf16 v[212:215], v[44:47], v[76:79], v[212:215]
    v_accvgpr_write_b32 a27, 0
    v_accvgpr_write_b32 a32, 0
    v_mfma_f32_16x16x32_bf16 v[216:219], v[40:43], v[80:83], 0
    v_accvgpr_write_b32 a33, 0
    v_accvgpr_write_b32 a34, 0
    v_mfma_f32_16x16x32_bf16 v[216:219], v[44:47], v[84:87], v[216:219]
    v_accvgpr_write_b32 a35, 0
    v_accvgpr_write_b32 a40, 0
    v_mfma_f32_16x16x32_bf16 v[220:223], v[40:43], v[88:91], 0
    ds_read_b64_tr_b16 v[40:41], v26 offset:32768
    ds_read_b64_tr_b16 v[42:43], v26 offset:33280
    v_mfma_f32_16x16x32_bf16 v[220:223], v[44:47], v[92:95], v[220:223]
    s_waitcnt lgkmcnt(2)
    ds_read_b64_tr_b16 v[44:45], v26 offset:36864
    ds_read_b64_tr_b16 v[46:47], v26 offset:37376
    v_mfma_f32_16x16x32_bf16 v[224:227], v[48:51], v[64:67], 0
    v_add_u32 v26, 0xffff0000, v26
    v_accvgpr_write_b32 a41, 0
    v_mfma_f32_16x16x32_bf16 v[224:227], v[52:55], v[68:71], v[224:227]
    s_xor_b32 s64, s64, 128
    v_accvgpr_write_b32 a42, 0
    v_accvgpr_write_b32 a43, 0
    v_mfma_f32_16x16x32_bf16 v[228:231], v[48:51], v[72:75], 0
    v_mfma_f32_16x16x32_bf16 v[228:231], v[52:55], v[76:79], v[228:231]
    v_mfma_f32_16x16x32_bf16 v[232:235], v[48:51], v[80:83], 0
    v_mfma_f32_16x16x32_bf16 v[232:235], v[52:55], v[84:87], v[232:235]
    s_add_u32 m0, s69, 32768
    v_mfma_f32_16x16x32_bf16 v[236:239], v[48:51], v[88:91], 0
    buffer_load_dwordx4 v2, s[24:27], s60 offen lds
    v_mfma_f32_16x16x32_bf16 v[236:239], v[52:55], v[92:95], v[236:239]
    s_add_u32 s72, s70, 40960
    ds_read_b64_tr_b16 v[48:49], v27 offset:32768
    ds_read_b64_tr_b16 v[50:51], v27 offset:33280
    v_mfma_f32_16x16x32_bf16 v[240:243], v[56:59], v[64:67], 0
    ds_read_b64_tr_b16 v[52:53], v27 offset:36864
    ds_read_b64_tr_b16 v[54:55], v27 offset:37376
    v_mfma_f32_16x16x32_bf16 v[240:243], v[60:63], v[68:71], v[240:243]
    buffer_store_dwordx4 a[48:51], v1, s[36:39], s72 offen sc1
    v_mfma_f32_16x16x32_bf16 v[244:247], v[56:59], v[72:75], 0
    buffer_load_dwordx4 v3, s[24:27], s60 offen offset:1024 lds
    v_mfma_f32_16x16x32_bf16 v[244:247], v[60:63], v[76:79], v[244:247]
    v_add_u32 v27, 0xffff0000, v27
    v_accvgpr_write_b32 a48, 0
    v_mfma_f32_16x16x32_bf16 v[248:251], v[56:59], v[80:83], 0
    v_accvgpr_write_b32 a49, 0
    v_accvgpr_write_b32 a50, 0
    v_mfma_f32_16x16x32_bf16 v[248:251], v[60:63], v[84:87], v[248:251]
    v_accvgpr_write_b32 a51, 0
    v_mfma_f32_16x16x32_bf16 v[252:255], v[56:59], v[88:91], 0
    buffer_load_dwordx4 v4, s[24:27], s60 offen offset:2048 lds
    v_mfma_f32_16x16x32_bf16 v[252:255], v[60:63], v[92:95], v[252:255]
    s_waitcnt lgkmcnt(0)
    ds_read_b64_tr_b16 v[56:57], v28 offset:32768
    ds_read_b64_tr_b16 v[58:59], v28 offset:33280
    v_mfma_f32_16x16x32_bf16 a[64:67], v[40:43], v[64:67], 0
    ds_read_b64_tr_b16 v[60:61], v28 offset:36864
    ds_read_b64_tr_b16 v[62:63], v28 offset:37376
    v_mfma_f32_16x16x32_bf16 a[64:67], v[44:47], v[68:71], a[64:67]
    v_add_u32 v28, 0xffff0000, v28
    v_mfma_f32_16x16x32_bf16 a[68:71], v[40:43], v[72:75], 0
    buffer_load_dwordx4 v5, s[24:27], s60 offen offset:3072 lds
    v_mfma_f32_16x16x32_bf16 a[68:71], v[44:47], v[76:79], a[68:71]
    ds_read_b128 v[112:115], v24 offset:49152
    v_mfma_f32_16x16x32_bf16 a[72:75], v[40:43], v[80:83], 0
    v_mfma_f32_16x16x32_bf16 a[72:75], v[44:47], v[84:87], a[72:75]
    s_add_u32 m0, s69, 49152
    v_mfma_f32_16x16x32_bf16 a[76:79], v[40:43], v[88:91], 0
    s_xor_b32 s60, s60, 524288
    buffer_load_dwordx4 v10, s[20:23], s63 offen lds
    v_mfma_f32_16x16x32_bf16 a[76:79], v[44:47], v[92:95], a[76:79]
    ds_read_b128 v[116:119], v25 offset:49152
    v_mfma_f32_16x16x32_bf16 a[128:131], v[40:43], a[136:139], 0
    ds_read_b64_tr_b16 v[40:41], v29 offset:32768
    ds_read_b64_tr_b16 v[42:43], v29 offset:33280
    v_mfma_f32_16x16x32_bf16 a[128:131], v[44:47], a[140:143], a[128:131]
    ds_read_b64_tr_b16 v[44:45], v29 offset:36864
    ds_read_b64_tr_b16 v[46:47], v29 offset:37376
    v_mfma_f32_16x16x32_bf16 a[80:83], v[48:51], v[64:67], 0
    buffer_load_dwordx4 v11, s[20:23], s63 offen offset:1024 lds
    v_mfma_f32_16x16x32_bf16 a[80:83], v[52:55], v[68:71], a[80:83]
    ds_read_b128 v[120:123], v24 offset:57344
    v_add_u32 v29, 0xffff0000, v29
    v_mfma_f32_16x16x32_bf16 a[84:87], v[48:51], v[72:75], 0
    v_mfma_f32_16x16x32_bf16 a[84:87], v[52:55], v[76:79], a[84:87]
    v_mfma_f32_16x16x32_bf16 a[88:91], v[48:51], v[80:83], 0
    buffer_load_dwordx4 v12, s[20:23], s63 offen offset:2048 lds
    v_mfma_f32_16x16x32_bf16 a[88:91], v[52:55], v[84:87], a[88:91]
    ds_read_b128 v[124:127], v25 offset:57344
    v_mfma_f32_16x16x32_bf16 a[92:95], v[48:51], v[88:91], 0
    s_add_u32 s72, s70, 45056
    v_mfma_f32_16x16x32_bf16 a[92:95], v[52:55], v[92:95], a[92:95]
    v_mfma_f32_16x16x32_bf16 a[132:135], v[48:51], a[136:139], 0
    buffer_load_dwordx4 v13, s[20:23], s63 offen offset:3072 lds
    v_mfma_f32_16x16x32_bf16 a[132:135], v[52:55], a[140:143], a[132:135]
    s_waitcnt lgkmcnt(1)
    v_mfma_f32_16x16x32_bf16 a[96:99], v[56:59], v[64:67], 0
    v_mfma_f32_16x16x32_bf16 a[96:99], v[60:63], v[68:71], a[96:99]
    s_xor_b32 s63, s63, 896
    v_mfma_f32_16x16x32_bf16 a[100:103], v[56:59], v[72:75], 0
    buffer_store_dwordx4 a[56:59], v1, s[36:39], s72 offen sc1
    v_mfma_f32_16x16x32_bf16 a[100:103], v[60:63], v[76:79], a[100:103]
    v_mfma_f32_16x16x32_bf16 a[104:107], v[56:59], v[80:83], 0
    v_accvgpr_write_b32 a56, 0
    v_accvgpr_write_b32 a57, 0
    v_mfma_f32_16x16x32_bf16 a[104:107], v[60:63], v[84:87], a[104:107]
    s_waitcnt vmcnt(10) lgkmcnt(0)
    s_barrier
    ds_read_b64_tr_b16 v[48:49], v14 offset:0
    v_mfma_f32_16x16x32_bf16 a[108:111], v[56:59], v[88:91], 0
    s_add_u32 m0, s67, 65536
    ds_read_b64_tr_b16 v[50:51], v14 offset:1024
    ds_read_b64_tr_b16 v[52:53], v14 offset:8192
    v_mfma_f32_16x16x32_bf16 a[108:111], v[60:63], v[92:95], a[108:111]
    buffer_load_dwordx4 v1, s[28:31], s65 offen sc1 lds
    v_mfma_f32_16x16x32_bf16 a[112:115], v[40:43], v[64:67], 0
    ds_read_b64_tr_b16 v[54:55], v14 offset:9216
    ds_read_b64_tr_b16 v[56:57], v15 offset:0
    v_mfma_f32_16x16x32_bf16 a[112:115], v[44:47], v[68:71], a[112:115]
    ds_read_b64_tr_b16 v[58:59], v15 offset:1024
    ds_read_b64_tr_b16 v[60:61], v15 offset:8192
    v_mfma_f32_16x16x32_bf16 a[116:119], v[40:43], v[72:75], 0
    ds_read_b64_tr_b16 v[62:63], v15 offset:9216
    ds_read_b128 a[136:139], v22 offset:0
    v_mfma_f32_16x16x32_bf16 a[116:119], v[44:47], v[76:79], a[116:119]
    ds_read_b128 a[140:143], v23 offset:0
    v_add_u32 v14, 0xfffe0000, v14
    v_mfma_f32_16x16x32_bf16 a[120:123], v[40:43], v[80:83], 0
    v_add_u32 v15, 0xfffe0000, v15
    v_add_u32 v22, 0x10000, v22
    v_mfma_f32_16x16x32_bf16 a[120:123], v[44:47], v[84:87], a[120:123]
    v_add_u32 v23, 0x10000, v23
    v_accvgpr_write_b32 a58, 0
    v_mfma_f32_16x16x32_bf16 a[124:127], v[40:43], v[88:91], 0
    buffer_load_dwordx4 v1, s[28:31], s65 offen offset:1024 sc1 lds
    v_mfma_f32_16x16x32_bf16 a[124:127], v[44:47], v[92:95], a[124:127]
    s_waitcnt lgkmcnt(1)
    ds_read_b64_tr_b16 v[40:41], v16 offset:0
    ds_read_b64_tr_b16 v[42:43], v16 offset:1024
    v_mfma_f32_16x16x32_bf16 v[128:131], v[48:51], v[96:99], v[128:131]
    ds_read_b64_tr_b16 v[44:45], v16 offset:8192
    ds_read_b64_tr_b16 v[46:47], v16 offset:9216
    v_mfma_f32_16x16x32_bf16 v[128:131], v[52:55], v[100:103], v[128:131]
    v_add_u32 v24, 0x10000, v24
    v_add_u32 v16, 0xfffe0000, v16
    v_mfma_f32_16x16x32_bf16 v[132:135], v[48:51], v[104:107], v[132:135]
    ds_read_b128 v[64:67], v24 offset:16384
    v_accvgpr_write_b32 a59, 0
    v_mfma_f32_16x16x32_bf16 v[132:135], v[52:55], v[108:111], v[132:135]
    v_mfma_f32_16x16x32_bf16 v[136:139], v[48:51], v[112:115], v[136:139]
    v_mfma_f32_16x16x32_bf16 v[136:139], v[52:55], v[116:119], v[136:139]
    s_add_u32 s72, s70, 1024
    v_mfma_f32_16x16x32_bf16 v[140:143], v[48:51], v[120:123], v[140:143]
    s_add_u32 m0, s68, 73728
    ds_read_b64_tr_b16 v[48:49], v17 offset:0
    ds_read_b64_tr_b16 v[50:51], v17 offset:1024
    v_mfma_f32_16x16x32_bf16 v[140:143], v[52:55], v[124:127], v[140:143]
    buffer_load_dwordx4 v6, s[20:23], s66 offen lds
    v_mfma_f32_16x16x32_bf16 v[144:147], v[56:59], v[96:99], v[144:147]
    ds_read_b64_tr_b16 v[52:53], v17 offset:8192
    ds_read_b64_tr_b16 v[54:55], v17 offset:9216
    v_mfma_f32_16x16x32_bf16 v[144:147], v[60:63], v[100:103], v[144:147]
    buffer_store_dwordx4 a[4:7], v1, s[36:39], s72 offen sc1
    v_mfma_f32_16x16x32_bf16 v[148:151], v[56:59], v[104:107], v[148:151]
    v_add_u32 v17, 0xfffe0000, v17
    v_accvgpr_write_b32 a4, 0
    v_mfma_f32_16x16x32_bf16 v[148:151], v[60:63], v[108:111], v[148:151]
    v_accvgpr_write_b32 a5, 0
    v_accvgpr_write_b32 a6, 0
    v_mfma_f32_16x16x32_bf16 v[152:155], v[56:59], v[112:115], v[152:155]
    v_add_u32 v25, 0x10000, v25
    v_accvgpr_write_b32 a7, 0
    v_mfma_f32_16x16x32_bf16 v[152:155], v[60:63], v[116:119], v[152:155]
    ds_read_b128 v[68:71], v25 offset:16384
    v_mfma_f32_16x16x32_bf16 v[156:159], v[56:59], v[120:123], v[156:159]
    s_add_u32 m0, s69, 81920
    ds_read_b64_tr_b16 v[56:57], v18 offset:0
    ds_read_b64_tr_b16 v[58:59], v18 offset:1024
    v_mfma_f32_16x16x32_bf16 v[156:159], v[60:63], v[124:127], v[156:159]
    s_xor_b32 s65, s65, 8192
    buffer_load_dwordx4 v10, s[20:23], s64 offen lds
    s_waitcnt lgkmcnt(3)
    v_mfma_f32_16x16x32_bf16 v[160:163], v[40:43], v[96:99], v[160:163]
    s_xor_b32 s66, s66, 128
    ds_read_b64_tr_b16 v[60:61], v18 offset:8192
    ds_read_b64_tr_b16 v[62:63], v18 offset:9216
    v_mfma_f32_16x16x32_bf16 v[160:163], v[44:47], v[100:103], v[160:163]
    v_add_u32 v18, 0xfffe0000, v18
    v_mfma_f32_16x16x32_bf16 v[164:167], v[40:43], v[104:107], v[164:167]
    v_mfma_f32_16x16x32_bf16 v[164:167], v[44:47], v[108:111], v[164:167]
    v_mfma_f32_16x16x32_bf16 v[168:171], v[40:43], v[112:115], v[168:171]
    v_mfma_f32_16x16x32_bf16 v[168:171], v[44:47], v[116:119], v[168:171]
    v_mfma_f32_16x16x32_bf16 v[172:175], v[40:43], v[120:123], v[172:175]
    ds_read_b64_tr_b16 v[40:41], v19 offset:0
    ds_read_b64_tr_b16 v[42:43], v19 offset:1024
    v_mfma_f32_16x16x32_bf16 v[172:175], v[44:47], v[124:127], v[172:175]
    ds_read_b64_tr_b16 v[44:45], v19 offset:8192
    ds_read_b64_tr_b16 v[46:47], v19 offset:9216
    v_mfma_f32_16x16x32_bf16 v[176:179], v[48:51], v[96:99], v[176:179]
    buffer_load_dwordx4 v11, s[20:23], s64 offen offset:1024 lds
    v_mfma_f32_16x16x32_bf16 v[176:179], v[52:55], v[100:103], v[176:179]
    ds_read_b128 v[72:75], v24 offset:24576
    v_add_u32 v19, 0xfffe0000, v19
    v_mfma_f32_16x16x32_bf16 v[180:183], v[48:51], v[104:107], v[180:183]
    v_mfma_f32_16x16x32_bf16 v[180:183], v[52:55], v[108:111], v[180:183]
    v_mfma_f32_16x16x32_bf16 v[184:187], v[48:51], v[112:115], v[184:187]
    v_mfma_f32_16x16x32_bf16 v[184:187], v[52:55], v[116:119], v[184:187]
    v_mfma_f32_16x16x32_bf16 v[188:191], v[48:51], v[120:123], v[188:191]
    s_add_u32 s72, s70, 5120
    ds_read_b64_tr_b16 v[48:49], v20 offset:0
    ds_read_b64_tr_b16 v[50:51], v20 offset:1024
    v_mfma_f32_16x16x32_bf16 v[188:191], v[52:55], v[124:127], v[188:191]
    s_waitcnt lgkmcnt(2)
    ds_read_b64_tr_b16 v[52:53], v20 offset:8192
    ds_read_b64_tr_b16 v[54:55], v20 offset:9216
    v_mfma_f32_16x16x32_bf16 v[192:195], v[56:59], v[96:99], v[192:195]
    buffer_load_dwordx4 v12, s[20:23], s64 offen offset:2048 lds
    v_mfma_f32_16x16x32_bf16 v[192:195], v[60:63], v[100:103], v[192:195]
    buffer_store_dwordx4 a[12:15], v1, s[36:39], s72 offen sc1
    v_mfma_f32_16x16x32_bf16 v[196:199], v[56:59], v[104:107], v[196:199]
    v_add_u32 v20, 0xfffe0000, v20
    v_accvgpr_write_b32 a12, 0
    v_mfma_f32_16x16x32_bf16 v[196:199], v[60:63], v[108:111], v[196:199]
    ds_read_b128 v[76:79], v25 offset:24576
    v_accvgpr_write_b32 a13, 0
    v_mfma_f32_16x16x32_bf16 v[200:203], v[56:59], v[112:115], v[200:203]
    v_accvgpr_write_b32 a14, 0
    v_accvgpr_write_b32 a15, 0
    v_mfma_f32_16x16x32_bf16 v[200:203], v[60:63], v[116:119], v[200:203]
    v_mfma_f32_16x16x32_bf16 v[204:207], v[56:59], v[120:123], v[204:207]
    ds_read_b64_tr_b16 v[56:57], v21 offset:0
    ds_read_b64_tr_b16 v[58:59], v21 offset:1024
    v_mfma_f32_16x16x32_bf16 v[204:207], v[60:63], v[124:127], v[204:207]
    ds_read_b64_tr_b16 v[60:61], v21 offset:8192
    ds_read_b64_tr_b16 v[62:63], v21 offset:9216
    v_mfma_f32_16x16x32_bf16 v[208:211], v[40:43], v[96:99], v[208:211]
    v_add_u32 v21, 0xfffe0000, v21
    v_mfma_f32_16x16x32_bf16 v[208:211], v[44:47], v[100:103], v[208:211]
    buffer_load_dwordx4 v13, s[20:23], s64 offen offset:3072 lds
    v_mfma_f32_16x16x32_bf16 v[212:215], v[40:43], v[104:107], v[212:215]
    v_mfma_f32_16x16x32_bf16 v[212:215], v[44:47], v[108:111], v[212:215]
    v_mfma_f32_16x16x32_bf16 v[216:219], v[40:43], v[112:115], v[216:219]
    v_mfma_f32_16x16x32_bf16 v[216:219], v[44:47], v[116:119], v[216:219]
    v_mfma_f32_16x16x32_bf16 v[220:223], v[40:43], v[120:123], v[220:223]
    ds_read_b64_tr_b16 v[40:41], v26 offset:0
    ds_read_b64_tr_b16 v[42:43], v26 offset:512
    v_mfma_f32_16x16x32_bf16 v[220:223], v[44:47], v[124:127], v[220:223]
    s_waitcnt lgkmcnt(2)
    ds_read_b64_tr_b16 v[44:45], v26 offset:4096
    ds_read_b64_tr_b16 v[46:47], v26 offset:4608
    v_mfma_f32_16x16x32_bf16 v[224:227], v[48:51], v[96:99], v[224:227]
    v_add_u32 v26, 0x10000, v26
    v_mfma_f32_16x16x32_bf16 v[224:227], v[52:55], v[100:103], v[224:227]
    s_xor_b32 s64, s64, 896
    v_mfma_f32_16x16x32_bf16 v[228:231], v[48:51], v[104:107], v[228:231]
    v_mfma_f32_16x16x32_bf16 v[228:231], v[52:55], v[108:111], v[228:231]
    v_mfma_f32_16x16x32_bf16 v[232:235], v[48:51], v[112:115], v[232:235]
    v_mfma_f32_16x16x32_bf16 v[232:235], v[52:55], v[116:119], v[232:235]
    s_add_u32 m0, s69, 98304
    v_mfma_f32_16x16x32_bf16 v[236:239], v[48:51], v[120:123], v[236:239]
    buffer_load_dwordx4 v2, s[24:27], s60 offen lds
    v_mfma_f32_16x16x32_bf16 v[236:239], v[52:55], v[124:127], v[236:239]
    s_add_u32 s72, s70, 9216
    ds_read_b64_tr_b16 v[48:49], v27 offset:0
    ds_read_b64_tr_b16 v[50:51], v27 offset:512
    v_mfma_f32_16x16x32_bf16 v[240:243], v[56:59], v[96:99], v[240:243]
    ds_read_b64_tr_b16 v[52:53], v27 offset:4096
    ds_read_b64_tr_b16 v[54:55], v27 offset:4608
    v_mfma_f32_16x16x32_bf16 v[240:243], v[60:63], v[100:103], v[240:243]
    buffer_store_dwordx4 a[20:23], v1, s[36:39], s72 offen sc1
    v_mfma_f32_16x16x32_bf16 v[244:247], v[56:59], v[104:107], v[244:247]
    buffer_load_dwordx4 v3, s[24:27], s60 offen offset:1024 lds
    v_mfma_f32_16x16x32_bf16 v[244:247], v[60:63], v[108:111], v[244:247]
    v_add_u32 v27, 0x10000, v27
    v_accvgpr_write_b32 a20, 0
    v_mfma_f32_16x16x32_bf16 v[248:251], v[56:59], v[112:115], v[248:251]
    v_accvgpr_write_b32 a21, 0
    v_accvgpr_write_b32 a22, 0
    v_mfma_f32_16x16x32_bf16 v[248:251], v[60:63], v[116:119], v[248:251]
    v_accvgpr_write_b32 a23, 0
    v_mfma_f32_16x16x32_bf16 v[252:255], v[56:59], v[120:123], v[252:255]
    buffer_load_dwordx4 v4, s[24:27], s60 offen offset:2048 lds
    v_mfma_f32_16x16x32_bf16 v[252:255], v[60:63], v[124:127], v[252:255]
    s_waitcnt lgkmcnt(0)
    ds_read_b64_tr_b16 v[56:57], v28 offset:0
    ds_read_b64_tr_b16 v[58:59], v28 offset:512
    v_mfma_f32_16x16x32_bf16 a[64:67], v[40:43], v[96:99], a[64:67]
    ds_read_b64_tr_b16 v[60:61], v28 offset:4096
    ds_read_b64_tr_b16 v[62:63], v28 offset:4608
    v_mfma_f32_16x16x32_bf16 a[64:67], v[44:47], v[100:103], a[64:67]
    v_add_u32 v24, 0xfffe0000, v24
    v_add_u32 v28, 0x10000, v28
    v_mfma_f32_16x16x32_bf16 a[68:71], v[40:43], v[104:107], a[68:71]
    buffer_load_dwordx4 v5, s[24:27], s60 offen offset:3072 lds
    v_mfma_f32_16x16x32_bf16 a[68:71], v[44:47], v[108:111], a[68:71]
    ds_read_b128 v[80:83], v24 offset:16384
    v_mfma_f32_16x16x32_bf16 a[72:75], v[40:43], v[112:115], a[72:75]
    v_mfma_f32_16x16x32_bf16 a[72:75], v[44:47], v[116:119], a[72:75]
    s_add_u32 m0, s69, 114688
    v_add_u32 v25, 0xfffe0000, v25
    v_mfma_f32_16x16x32_bf16 a[76:79], v[40:43], v[120:123], a[76:79]
    s_xor_b32 s60, s60, 3670016
    buffer_load_dwordx4 v10, s[20:23], s63 offen lds
    v_mfma_f32_16x16x32_bf16 a[76:79], v[44:47], v[124:127], a[76:79]
    ds_read_b128 v[84:87], v25 offset:16384
    v_mfma_f32_16x16x32_bf16 a[128:131], v[40:43], a[136:139], a[128:131]
    ds_read_b64_tr_b16 v[40:41], v29 offset:0
    ds_read_b64_tr_b16 v[42:43], v29 offset:512
    v_mfma_f32_16x16x32_bf16 a[128:131], v[44:47], a[140:143], a[128:131]
    ds_read_b64_tr_b16 v[44:45], v29 offset:4096
    ds_read_b64_tr_b16 v[46:47], v29 offset:4608
    v_mfma_f32_16x16x32_bf16 a[80:83], v[48:51], v[96:99], a[80:83]
    buffer_load_dwordx4 v11, s[20:23], s63 offen offset:1024 lds
    v_mfma_f32_16x16x32_bf16 a[80:83], v[52:55], v[100:103], a[80:83]
    ds_read_b128 v[88:91], v24 offset:24576
    v_add_u32 v29, 0x10000, v29
    v_mfma_f32_16x16x32_bf16 a[84:87], v[48:51], v[104:107], a[84:87]
    v_mfma_f32_16x16x32_bf16 a[84:87], v[52:55], v[108:111], a[84:87]
    v_mfma_f32_16x16x32_bf16 a[88:91], v[48:51], v[112:115], a[88:91]
    buffer_load_dwordx4 v12, s[20:23], s63 offen offset:2048 lds
    v_mfma_f32_16x16x32_bf16 a[88:91], v[52:55], v[116:119], a[88:91]
    ds_read_b128 v[92:95], v25 offset:24576
    v_mfma_f32_16x16x32_bf16 a[92:95], v[48:51], v[120:123], a[92:95]
    s_add_u32 s72, s70, 13312
    v_mfma_f32_16x16x32_bf16 a[92:95], v[52:55], v[124:127], a[92:95]
    v_mfma_f32_16x16x32_bf16 a[132:135], v[48:51], a[136:139], a[132:135]
    buffer_load_dwordx4 v13, s[20:23], s63 offen offset:3072 lds
    v_mfma_f32_16x16x32_bf16 a[132:135], v[52:55], a[140:143], a[132:135]
    s_waitcnt lgkmcnt(1)
    v_mfma_f32_16x16x32_bf16 a[96:99], v[56:59], v[96:99], a[96:99]
    v_mfma_f32_16x16x32_bf16 a[96:99], v[60:63], v[100:103], a[96:99]
    s_xor_b32 s63, s63, 128
    v_mfma_f32_16x16x32_bf16 a[100:103], v[56:59], v[104:107], a[100:103]
    buffer_store_dwordx4 a[28:31], v1, s[36:39], s72 offen sc1
    v_mfma_f32_16x16x32_bf16 a[100:103], v[60:63], v[108:111], a[100:103]
    v_mfma_f32_16x16x32_bf16 a[104:107], v[56:59], v[112:115], a[104:107]
    v_accvgpr_write_b32 a28, 0
    v_accvgpr_write_b32 a29, 0
    v_mfma_f32_16x16x32_bf16 a[104:107], v[60:63], v[116:119], a[104:107]
    s_waitcnt vmcnt(10) lgkmcnt(0)
    s_barrier
    ds_read_b64_tr_b16 v[48:49], v14 offset:32768
    v_mfma_f32_16x16x32_bf16 a[108:111], v[56:59], v[120:123], a[108:111]
    s_add_u32 m0, s67, 131072
    ds_read_b64_tr_b16 v[50:51], v14 offset:33792
    ds_read_b64_tr_b16 v[52:53], v14 offset:40960
    v_mfma_f32_16x16x32_bf16 a[108:111], v[60:63], v[124:127], a[108:111]
    buffer_load_dwordx4 v1, s[28:31], s65 offen sc1 lds
    v_mfma_f32_16x16x32_bf16 a[112:115], v[40:43], v[96:99], a[112:115]
    ds_read_b64_tr_b16 v[54:55], v14 offset:41984
    ds_read_b64_tr_b16 v[56:57], v15 offset:32768
    v_mfma_f32_16x16x32_bf16 a[112:115], v[44:47], v[100:103], a[112:115]
    ds_read_b64_tr_b16 v[58:59], v15 offset:33792
    ds_read_b64_tr_b16 v[60:61], v15 offset:40960
    v_mfma_f32_16x16x32_bf16 a[116:119], v[40:43], v[104:107], a[116:119]
    ds_read_b64_tr_b16 v[62:63], v15 offset:41984
    ds_read_b128 a[136:139], v22 offset:0
    v_mfma_f32_16x16x32_bf16 a[116:119], v[44:47], v[108:111], a[116:119]
    ds_read_b128 a[140:143], v23 offset:0
    v_add_u32 v14, 0x10000, v14
    v_mfma_f32_16x16x32_bf16 a[120:123], v[40:43], v[112:115], a[120:123]
    v_add_u32 v15, 0x10000, v15
    v_add_u32 v22, 0x10000, v22
    v_mfma_f32_16x16x32_bf16 a[120:123], v[44:47], v[116:119], a[120:123]
    v_add_u32 v23, 0x10000, v23
    v_accvgpr_write_b32 a30, 0
    v_mfma_f32_16x16x32_bf16 a[124:127], v[40:43], v[120:123], a[124:127]
    buffer_load_dwordx4 v1, s[28:31], s65 offen offset:1024 sc1 lds
    v_mfma_f32_16x16x32_bf16 a[124:127], v[44:47], v[124:127], a[124:127]
    s_waitcnt lgkmcnt(1)
    ds_read_b64_tr_b16 v[40:41], v16 offset:32768
    ds_read_b64_tr_b16 v[42:43], v16 offset:33792
    v_mfma_f32_16x16x32_bf16 v[128:131], v[48:51], v[64:67], v[128:131]
    ds_read_b64_tr_b16 v[44:45], v16 offset:40960
    ds_read_b64_tr_b16 v[46:47], v16 offset:41984
    v_mfma_f32_16x16x32_bf16 v[128:131], v[52:55], v[68:71], v[128:131]
    v_add_u32 v16, 0x10000, v16
    v_accvgpr_write_b32 a31, 0
    v_mfma_f32_16x16x32_bf16 v[132:135], v[48:51], v[72:75], v[132:135]
    ds_read_b128 v[96:99], v24 offset:49152
    v_mfma_f32_16x16x32_bf16 v[132:135], v[52:55], v[76:79], v[132:135]
    v_mfma_f32_16x16x32_bf16 v[136:139], v[48:51], v[80:83], v[136:139]
    v_mfma_f32_16x16x32_bf16 v[136:139], v[52:55], v[84:87], v[136:139]
    s_add_u32 s72, s70, 33792
    v_mfma_f32_16x16x32_bf16 v[140:143], v[48:51], v[88:91], v[140:143]
    s_add_u32 m0, s68, 139264
    ds_read_b64_tr_b16 v[48:49], v17 offset:32768
    ds_read_b64_tr_b16 v[50:51], v17 offset:33792
    v_mfma_f32_16x16x32_bf16 v[140:143], v[52:55], v[92:95], v[140:143]
    buffer_load_dwordx4 v6, s[20:23], s66 offen lds
    v_mfma_f32_16x16x32_bf16 v[144:147], v[56:59], v[64:67], v[144:147]
    ds_read_b64_tr_b16 v[52:53], v17 offset:40960
    ds_read_b64_tr_b16 v[54:55], v17 offset:41984
    v_mfma_f32_16x16x32_bf16 v[144:147], v[60:63], v[68:71], v[144:147]
    buffer_store_dwordx4 a[36:39], v1, s[36:39], s72 offen sc1
    v_mfma_f32_16x16x32_bf16 v[148:151], v[56:59], v[72:75], v[148:151]
    v_add_u32 v17, 0x10000, v17
    v_accvgpr_write_b32 a36, 0
    v_mfma_f32_16x16x32_bf16 v[148:151], v[60:63], v[76:79], v[148:151]
    v_accvgpr_write_b32 a37, 0
    v_accvgpr_write_b32 a38, 0
    v_mfma_f32_16x16x32_bf16 v[152:155], v[56:59], v[80:83], v[152:155]
    v_accvgpr_write_b32 a39, 0
    v_mfma_f32_16x16x32_bf16 v[152:155], v[60:63], v[84:87], v[152:155]
    ds_read_b128 v[100:103], v25 offset:49152
    v_mfma_f32_16x16x32_bf16 v[156:159], v[56:59], v[88:91], v[156:159]
    s_add_u32 m0, s69, 147456
    ds_read_b64_tr_b16 v[56:57], v18 offset:32768
    ds_read_b64_tr_b16 v[58:59], v18 offset:33792
    v_mfma_f32_16x16x32_bf16 v[156:159], v[60:63], v[92:95], v[156:159]
    s_xor_b32 s65, s65, 57344
    buffer_load_dwordx4 v10, s[20:23], s64 offen lds
    s_waitcnt lgkmcnt(3)
    v_mfma_f32_16x16x32_bf16 v[160:163], v[40:43], v[64:67], v[160:163]
    s_xor_b32 s66, s66, 896
    ds_read_b64_tr_b16 v[60:61], v18 offset:40960
    ds_read_b64_tr_b16 v[62:63], v18 offset:41984
    v_mfma_f32_16x16x32_bf16 v[160:163], v[44:47], v[68:71], v[160:163]
    v_add_u32 v18, 0x10000, v18
    v_mfma_f32_16x16x32_bf16 v[164:167], v[40:43], v[72:75], v[164:167]
    v_mfma_f32_16x16x32_bf16 v[164:167], v[44:47], v[76:79], v[164:167]
    v_mfma_f32_16x16x32_bf16 v[168:171], v[40:43], v[80:83], v[168:171]
    v_mfma_f32_16x16x32_bf16 v[168:171], v[44:47], v[84:87], v[168:171]
    v_mfma_f32_16x16x32_bf16 v[172:175], v[40:43], v[88:91], v[172:175]
    ds_read_b64_tr_b16 v[40:41], v19 offset:32768
    ds_read_b64_tr_b16 v[42:43], v19 offset:33792
    v_mfma_f32_16x16x32_bf16 v[172:175], v[44:47], v[92:95], v[172:175]
    ds_read_b64_tr_b16 v[44:45], v19 offset:40960
    ds_read_b64_tr_b16 v[46:47], v19 offset:41984
    v_mfma_f32_16x16x32_bf16 v[176:179], v[48:51], v[64:67], v[176:179]
    buffer_load_dwordx4 v11, s[20:23], s64 offen offset:1024 lds
    v_mfma_f32_16x16x32_bf16 v[176:179], v[52:55], v[68:71], v[176:179]
    ds_read_b128 v[104:107], v24 offset:57344
    v_add_u32 v19, 0x10000, v19
    v_mfma_f32_16x16x32_bf16 v[180:183], v[48:51], v[72:75], v[180:183]
    v_mfma_f32_16x16x32_bf16 v[180:183], v[52:55], v[76:79], v[180:183]
    v_mfma_f32_16x16x32_bf16 v[184:187], v[48:51], v[80:83], v[184:187]
    v_mfma_f32_16x16x32_bf16 v[184:187], v[52:55], v[84:87], v[184:187]
    v_mfma_f32_16x16x32_bf16 v[188:191], v[48:51], v[88:91], v[188:191]
    s_add_u32 s72, s70, 37888
    ds_read_b64_tr_b16 v[48:49], v20 offset:32768
    ds_read_b64_tr_b16 v[50:51], v20 offset:33792
    v_mfma_f32_16x16x32_bf16 v[188:191], v[52:55], v[92:95], v[188:191]
    s_waitcnt lgkmcnt(2)
    ds_read_b64_tr_b16 v[52:53], v20 offset:40960
    ds_read_b64_tr_b16 v[54:55], v20 offset:41984
    v_mfma_f32_16x16x32_bf16 v[192:195], v[56:59], v[64:67], v[192:195]
    buffer_load_dwordx4 v12, s[20:23], s64 offen offset:2048 lds
    v_mfma_f32_16x16x32_bf16 v[192:195], v[60:63], v[68:71], v[192:195]
    buffer_store_dwordx4 a[44:47], v1, s[36:39], s72 offen sc1
    v_mfma_f32_16x16x32_bf16 v[196:199], v[56:59], v[72:75], v[196:199]
    v_add_u32 v20, 0x10000, v20
    v_accvgpr_write_b32 a44, 0
    v_mfma_f32_16x16x32_bf16 v[196:199], v[60:63], v[76:79], v[196:199]
    ds_read_b128 v[108:111], v25 offset:57344
    v_accvgpr_write_b32 a45, 0
    v_mfma_f32_16x16x32_bf16 v[200:203], v[56:59], v[80:83], v[200:203]
    v_accvgpr_write_b32 a46, 0
    v_accvgpr_write_b32 a47, 0
    v_mfma_f32_16x16x32_bf16 v[200:203], v[60:63], v[84:87], v[200:203]
    v_mfma_f32_16x16x32_bf16 v[204:207], v[56:59], v[88:91], v[204:207]
    ds_read_b64_tr_b16 v[56:57], v21 offset:32768
    ds_read_b64_tr_b16 v[58:59], v21 offset:33792
    v_mfma_f32_16x16x32_bf16 v[204:207], v[60:63], v[92:95], v[204:207]
    ds_read_b64_tr_b16 v[60:61], v21 offset:40960
    ds_read_b64_tr_b16 v[62:63], v21 offset:41984
    v_mfma_f32_16x16x32_bf16 v[208:211], v[40:43], v[64:67], v[208:211]
    v_add_u32 v21, 0x10000, v21
    v_mfma_f32_16x16x32_bf16 v[208:211], v[44:47], v[68:71], v[208:211]
    buffer_load_dwordx4 v13, s[20:23], s64 offen offset:3072 lds
    v_mfma_f32_16x16x32_bf16 v[212:215], v[40:43], v[72:75], v[212:215]
    v_mfma_f32_16x16x32_bf16 v[212:215], v[44:47], v[76:79], v[212:215]
    v_mfma_f32_16x16x32_bf16 v[216:219], v[40:43], v[80:83], v[216:219]
    v_mfma_f32_16x16x32_bf16 v[216:219], v[44:47], v[84:87], v[216:219]
    v_mfma_f32_16x16x32_bf16 v[220:223], v[40:43], v[88:91], v[220:223]
    ds_read_b64_tr_b16 v[40:41], v26 offset:0
    ds_read_b64_tr_b16 v[42:43], v26 offset:512
    v_mfma_f32_16x16x32_bf16 v[220:223], v[44:47], v[92:95], v[220:223]
    s_waitcnt lgkmcnt(2)
    ds_read_b64_tr_b16 v[44:45], v26 offset:4096
    ds_read_b64_tr_b16 v[46:47], v26 offset:4608
    v_mfma_f32_16x16x32_bf16 v[224:227], v[48:51], v[64:67], v[224:227]
    v_add_u32 v26, 0x10000, v26
    v_mfma_f32_16x16x32_bf16 v[224:227], v[52:55], v[68:71], v[224:227]
    s_xor_b32 s64, s64, 128
    v_mfma_f32_16x16x32_bf16 v[228:231], v[48:51], v[72:75], v[228:231]
    v_mfma_f32_16x16x32_bf16 v[228:231], v[52:55], v[76:79], v[228:231]
    v_mfma_f32_16x16x32_bf16 v[232:235], v[48:51], v[80:83], v[232:235]
    v_mfma_f32_16x16x32_bf16 v[232:235], v[52:55], v[84:87], v[232:235]
    s_add_u32 m0, s69, 0
    v_mfma_f32_16x16x32_bf16 v[236:239], v[48:51], v[88:91], v[236:239]
    buffer_load_dwordx4 v2, s[24:27], s60 offen lds
    v_mfma_f32_16x16x32_bf16 v[236:239], v[52:55], v[92:95], v[236:239]
    s_add_u32 s72, s70, 41984
    ds_read_b64_tr_b16 v[48:49], v27 offset:0
    ds_read_b64_tr_b16 v[50:51], v27 offset:512
    v_mfma_f32_16x16x32_bf16 v[240:243], v[56:59], v[64:67], v[240:243]
    ds_read_b64_tr_b16 v[52:53], v27 offset:4096
    ds_read_b64_tr_b16 v[54:55], v27 offset:4608
    v_mfma_f32_16x16x32_bf16 v[240:243], v[60:63], v[68:71], v[240:243]
    buffer_store_dwordx4 a[52:55], v1, s[36:39], s72 offen sc1
    v_mfma_f32_16x16x32_bf16 v[244:247], v[56:59], v[72:75], v[244:247]
    buffer_load_dwordx4 v3, s[24:27], s60 offen offset:1024 lds
    v_mfma_f32_16x16x32_bf16 v[244:247], v[60:63], v[76:79], v[244:247]
    v_add_u32 v27, 0x10000, v27
    v_accvgpr_write_b32 a52, 0
    v_mfma_f32_16x16x32_bf16 v[248:251], v[56:59], v[80:83], v[248:251]
    v_accvgpr_write_b32 a53, 0
    v_accvgpr_write_b32 a54, 0
    v_mfma_f32_16x16x32_bf16 v[248:251], v[60:63], v[84:87], v[248:251]
    v_accvgpr_write_b32 a55, 0
    v_mfma_f32_16x16x32_bf16 v[252:255], v[56:59], v[88:91], v[252:255]
    buffer_load_dwordx4 v4, s[24:27], s60 offen offset:2048 lds
    v_mfma_f32_16x16x32_bf16 v[252:255], v[60:63], v[92:95], v[252:255]
    s_waitcnt lgkmcnt(0)
    ds_read_b64_tr_b16 v[56:57], v28 offset:0
    ds_read_b64_tr_b16 v[58:59], v28 offset:512
    v_mfma_f32_16x16x32_bf16 a[64:67], v[40:43], v[64:67], a[64:67]
    ds_read_b64_tr_b16 v[60:61], v28 offset:4096
    ds_read_b64_tr_b16 v[62:63], v28 offset:4608
    v_mfma_f32_16x16x32_bf16 a[64:67], v[44:47], v[68:71], a[64:67]
    v_add_u32 v24, 0x10000, v24
    v_add_u32 v28, 0x10000, v28
    v_mfma_f32_16x16x32_bf16 a[68:71], v[40:43], v[72:75], a[68:71]
    buffer_load_dwordx4 v5, s[24:27], s60 offen offset:3072 lds
    v_mfma_f32_16x16x32_bf16 a[68:71], v[44:47], v[76:79], a[68:71]
    ds_read_b128 v[112:115], v24 offset:16384
    v_mfma_f32_16x16x32_bf16 a[72:75], v[40:43], v[80:83], a[72:75]
    v_mfma_f32_16x16x32_bf16 a[72:75], v[44:47], v[84:87], a[72:75]
    s_add_u32 m0, s69, 16384
    v_add_u32 v25, 0x10000, v25
    v_mfma_f32_16x16x32_bf16 a[76:79], v[40:43], v[88:91], a[76:79]
    s_xor_b32 s60, s60, 524288
    buffer_load_dwordx4 v10, s[20:23], s63 offen lds
    v_mfma_f32_16x16x32_bf16 a[76:79], v[44:47], v[92:95], a[76:79]
    ds_read_b128 v[116:119], v25 offset:16384
    v_mfma_f32_16x16x32_bf16 a[128:131], v[40:43], a[136:139], a[128:131]
    ds_read_b64_tr_b16 v[40:41], v29 offset:0
    ds_read_b64_tr_b16 v[42:43], v29 offset:512
    v_mfma_f32_16x16x32_bf16 a[128:131], v[44:47], a[140:143], a[128:131]
    ds_read_b64_tr_b16 v[44:45], v29 offset:4096
    ds_read_b64_tr_b16 v[46:47], v29 offset:4608
    v_mfma_f32_16x16x32_bf16 a[80:83], v[48:51], v[64:67], a[80:83]
    buffer_load_dwordx4 v11, s[20:23], s63 offen offset:1024 lds
    v_mfma_f32_16x16x32_bf16 a[80:83], v[52:55], v[68:71], a[80:83]
    ds_read_b128 v[120:123], v24 offset:24576
    v_add_u32 v29, 0x10000, v29
    v_mfma_f32_16x16x32_bf16 a[84:87], v[48:51], v[72:75], a[84:87]
    v_mfma_f32_16x16x32_bf16 a[84:87], v[52:55], v[76:79], a[84:87]
    v_mfma_f32_16x16x32_bf16 a[88:91], v[48:51], v[80:83], a[88:91]
    buffer_load_dwordx4 v12, s[20:23], s63 offen offset:2048 lds
    v_mfma_f32_16x16x32_bf16 a[88:91], v[52:55], v[84:87], a[88:91]
    ds_read_b128 v[124:127], v25 offset:24576
    v_mfma_f32_16x16x32_bf16 a[92:95], v[48:51], v[88:91], a[92:95]
    s_add_u32 s72, s70, 46080
    v_mfma_f32_16x16x32_bf16 a[92:95], v[52:55], v[92:95], a[92:95]
    v_mfma_f32_16x16x32_bf16 a[132:135], v[48:51], a[136:139], a[132:135]
    buffer_load_dwordx4 v13, s[20:23], s63 offen offset:3072 lds
    v_mfma_f32_16x16x32_bf16 a[132:135], v[52:55], a[140:143], a[132:135]
    s_waitcnt lgkmcnt(1)
    v_mfma_f32_16x16x32_bf16 a[96:99], v[56:59], v[64:67], a[96:99]
    v_mfma_f32_16x16x32_bf16 a[96:99], v[60:63], v[68:71], a[96:99]
    s_xor_b32 s63, s63, 384
    v_mfma_f32_16x16x32_bf16 a[100:103], v[56:59], v[72:75], a[100:103]
    buffer_store_dwordx4 a[60:63], v1, s[36:39], s72 offen sc1
    v_mfma_f32_16x16x32_bf16 a[100:103], v[60:63], v[76:79], a[100:103]
    v_mfma_f32_16x16x32_bf16 a[104:107], v[56:59], v[80:83], a[104:107]
    v_accvgpr_write_b32 a60, 0
    v_accvgpr_write_b32 a61, 0
    v_mfma_f32_16x16x32_bf16 a[104:107], v[60:63], v[84:87], a[104:107]
    s_waitcnt vmcnt(10) lgkmcnt(0)
    s_barrier
    ds_read_b64_tr_b16 v[48:49], v14 offset:32768
    v_mfma_f32_16x16x32_bf16 a[108:111], v[56:59], v[88:91], a[108:111]
    s_add_u32 m0, s67, 32768
    ds_read_b64_tr_b16 v[50:51], v14 offset:33792
    ds_read_b64_tr_b16 v[52:53], v14 offset:40960
    v_mfma_f32_16x16x32_bf16 a[108:111], v[60:63], v[92:95], a[108:111]
    buffer_load_dwordx4 v1, s[28:31], s65 offen sc1 lds
    v_mfma_f32_16x16x32_bf16 a[112:115], v[40:43], v[64:67], a[112:115]
    ds_read_b64_tr_b16 v[54:55], v14 offset:41984
    ds_read_b64_tr_b16 v[56:57], v15 offset:32768
    v_mfma_f32_16x16x32_bf16 a[112:115], v[44:47], v[68:71], a[112:115]
    ds_read_b64_tr_b16 v[58:59], v15 offset:33792
    ds_read_b64_tr_b16 v[60:61], v15 offset:40960
    v_mfma_f32_16x16x32_bf16 a[116:119], v[40:43], v[72:75], a[116:119]
    ds_read_b64_tr_b16 v[62:63], v15 offset:41984
    ds_read_b128 a[136:139], v22 offset:0
    v_mfma_f32_16x16x32_bf16 a[116:119], v[44:47], v[76:79], a[116:119]
    ds_read_b128 a[140:143], v23 offset:0
    v_add_u32 v14, 0xffff0000, v14
    v_mfma_f32_16x16x32_bf16 a[120:123], v[40:43], v[80:83], a[120:123]
    v_add_u32 v15, 0xffff0000, v15
    v_add_u32 v22, 0xfffe0000, v22
    v_mfma_f32_16x16x32_bf16 a[120:123], v[44:47], v[84:87], a[120:123]
    v_add_u32 v23, 0xfffe0000, v23
    v_accvgpr_read_b32 v32, a144
    v_mfma_f32_16x16x32_bf16 a[124:127], v[40:43], v[88:91], a[124:127]
    buffer_load_dwordx4 v1, s[28:31], s65 offen offset:1024 sc1 lds
    v_mfma_f32_16x16x32_bf16 a[124:127], v[44:47], v[92:95], a[124:127]
    s_waitcnt lgkmcnt(1)
    ds_read_b64_tr_b16 v[40:41], v16 offset:32768
    ds_read_b64_tr_b16 v[42:43], v16 offset:33792
    v_mfma_f32_16x16x32_bf16 v[128:131], v[48:51], v[96:99], v[128:131]
    ds_read_b64_tr_b16 v[44:45], v16 offset:40960
    ds_read_b64_tr_b16 v[46:47], v16 offset:41984
    v_mfma_f32_16x16x32_bf16 v[128:131], v[52:55], v[100:103], v[128:131]
    v_add_u32 v16, 0xffff0000, v16
    v_accvgpr_read_b32 v31, a145
    v_mfma_f32_16x16x32_bf16 v[132:135], v[48:51], v[104:107], v[132:135]
    ds_read_b128 v[64:67], v24 offset:49152
    v_cvt_pk_bf16_f32 v32, v32, v31
    v_mfma_f32_16x16x32_bf16 v[132:135], v[52:55], v[108:111], v[132:135]
    v_accvgpr_read_b32 v33, a146
    v_accvgpr_read_b32 v31, a147
    v_mfma_f32_16x16x32_bf16 v[136:139], v[48:51], v[112:115], v[136:139]
    v_cvt_pk_bf16_f32 v33, v33, v31
    v_accvgpr_read_b32 v34, a148
    v_mfma_f32_16x16x32_bf16 v[136:139], v[52:55], v[116:119], v[136:139]
    s_add_u32 s72, s71, 32768
    v_accvgpr_read_b32 v31, a149
    v_cvt_pk_bf16_f32 v34, v34, v31
    v_mfma_f32_16x16x32_bf16 v[140:143], v[48:51], v[120:123], v[140:143]
    s_add_u32 m0, s68, 40960
    ds_read_b64_tr_b16 v[48:49], v17 offset:32768
    ds_read_b64_tr_b16 v[50:51], v17 offset:33792
    v_mfma_f32_16x16x32_bf16 v[140:143], v[52:55], v[124:127], v[140:143]
    buffer_load_dwordx4 v6, s[20:23], s66 offen lds
    v_mfma_f32_16x16x32_bf16 v[144:147], v[56:59], v[96:99], v[144:147]
    ds_read_b64_tr_b16 v[52:53], v17 offset:40960
    ds_read_b64_tr_b16 v[54:55], v17 offset:41984
    v_mfma_f32_16x16x32_bf16 v[144:147], v[60:63], v[100:103], v[144:147]
    v_add_u32 v17, 0xffff0000, v17
    v_accvgpr_read_b32 v35, a150
    v_mfma_f32_16x16x32_bf16 v[148:151], v[56:59], v[104:107], v[148:151]
    v_accvgpr_read_b32 v31, a151
    v_cvt_pk_bf16_f32 v35, v35, v31
    v_mfma_f32_16x16x32_bf16 v[148:151], v[60:63], v[108:111], v[148:151]
    buffer_store_dwordx4 v[32:35], v1, s[36:39], s72 offen sc1
    v_mfma_f32_16x16x32_bf16 v[152:155], v[56:59], v[112:115], v[152:155]
    v_accvgpr_write_b32 a62, 0
    v_accvgpr_write_b32 a63, 0
    v_mfma_f32_16x16x32_bf16 v[152:155], v[60:63], v[116:119], v[152:155]
    ds_read_b128 v[68:71], v25 offset:49152
    v_accvgpr_write_b32 a144, 0
    v_mfma_f32_16x16x32_bf16 v[156:159], v[56:59], v[120:123], v[156:159]
    s_add_u32 m0, s69, 49152
    ds_read_b64_tr_b16 v[56:57], v18 offset:32768
    ds_read_b64_tr_b16 v[58:59], v18 offset:33792
    v_mfma_f32_16x16x32_bf16 v[156:159], v[60:63], v[124:127], v[156:159]
    s_xor_b32 s65, s65, 8192
    buffer_load_dwordx4 v10, s[20:23], s64 offen lds
    s_waitcnt lgkmcnt(3)
    v_mfma_f32_16x16x32_bf16 v[160:163], v[40:43], v[96:99], v[160:163]
    s_xor_b32 s66, s66, 128
    ds_read_b64_tr_b16 v[60:61], v18 offset:40960
    ds_read_b64_tr_b16 v[62:63], v18 offset:41984
    v_mfma_f32_16x16x32_bf16 v[160:163], v[44:47], v[100:103], v[160:163]
    v_add_u32 v18, 0xffff0000, v18
    v_accvgpr_write_b32 a145, 0
    v_mfma_f32_16x16x32_bf16 v[164:167], v[40:43], v[104:107], v[164:167]
    v_accvgpr_write_b32 a146, 0
    v_accvgpr_write_b32 a147, 0
    v_mfma_f32_16x16x32_bf16 v[164:167], v[44:47], v[108:111], v[164:167]
    v_accvgpr_read_b32 v32, a152
    v_accvgpr_read_b32 v31, a153
    v_mfma_f32_16x16x32_bf16 v[168:171], v[40:43], v[112:115], v[168:171]
    v_cvt_pk_bf16_f32 v32, v32, v31
    v_accvgpr_read_b32 v33, a154
    v_mfma_f32_16x16x32_bf16 v[168:171], v[44:47], v[116:119], v[168:171]
    v_accvgpr_read_b32 v31, a155
    v_cvt_pk_bf16_f32 v33, v33, v31
    v_mfma_f32_16x16x32_bf16 v[172:175], v[40:43], v[120:123], v[172:175]
    ds_read_b64_tr_b16 v[40:41], v19 offset:32768
    ds_read_b64_tr_b16 v[42:43], v19 offset:33792
    v_mfma_f32_16x16x32_bf16 v[172:175], v[44:47], v[124:127], v[172:175]
    ds_read_b64_tr_b16 v[44:45], v19 offset:40960
    ds_read_b64_tr_b16 v[46:47], v19 offset:41984
    v_mfma_f32_16x16x32_bf16 v[176:179], v[48:51], v[96:99], v[176:179]
    buffer_load_dwordx4 v11, s[20:23], s64 offen offset:1024 lds
    v_mfma_f32_16x16x32_bf16 v[176:179], v[52:55], v[100:103], v[176:179]
    ds_read_b128 v[72:75], v24 offset:57344
    v_add_u32 v19, 0xffff0000, v19
    v_mfma_f32_16x16x32_bf16 v[180:183], v[48:51], v[104:107], v[180:183]
    v_accvgpr_read_b32 v34, a156
    v_accvgpr_read_b32 v31, a157
    v_mfma_f32_16x16x32_bf16 v[180:183], v[52:55], v[108:111], v[180:183]
    v_cvt_pk_bf16_f32 v34, v34, v31
    v_accvgpr_read_b32 v35, a158
    v_mfma_f32_16x16x32_bf16 v[184:187], v[48:51], v[112:115], v[184:187]
    v_accvgpr_read_b32 v31, a159
    v_cvt_pk_bf16_f32 v35, v35, v31
    v_mfma_f32_16x16x32_bf16 v[184:187], v[52:55], v[116:119], v[184:187]
    v_accvgpr_write_b32 a148, 0
    v_accvgpr_write_b32 a149, 0
    v_mfma_f32_16x16x32_bf16 v[188:191], v[48:51], v[120:123], v[188:191]
    s_add_u32 s72, s71, 33792
    ds_read_b64_tr_b16 v[48:49], v20 offset:32768
    ds_read_b64_tr_b16 v[50:51], v20 offset:33792
    v_mfma_f32_16x16x32_bf16 v[188:191], v[52:55], v[124:127], v[188:191]
    s_waitcnt lgkmcnt(2)
    ds_read_b64_tr_b16 v[52:53], v20 offset:40960
    ds_read_b64_tr_b16 v[54:55], v20 offset:41984
    v_mfma_f32_16x16x32_bf16 v[192:195], v[56:59], v[96:99], v[192:195]
    buffer_load_dwordx4 v12, s[20:23], s64 offen offset:2048 lds
    v_mfma_f32_16x16x32_bf16 v[192:195], v[60:63], v[100:103], v[192:195]
    v_add_u32 v20, 0xffff0000, v20
    v_accvgpr_write_b32 a150, 0
    v_mfma_f32_16x16x32_bf16 v[196:199], v[56:59], v[104:107], v[196:199]
    buffer_store_dwordx4 v[32:35], v1, s[36:39], s72 offen sc1
    v_mfma_f32_16x16x32_bf16 v[196:199], v[60:63], v[108:111], v[196:199]
    ds_read_b128 v[76:79], v25 offset:57344
    v_accvgpr_write_b32 a151, 0
    v_mfma_f32_16x16x32_bf16 v[200:203], v[56:59], v[112:115], v[200:203]
    v_accvgpr_write_b32 a152, 0
    v_accvgpr_write_b32 a153, 0
    v_mfma_f32_16x16x32_bf16 v[200:203], v[60:63], v[116:119], v[200:203]
    v_accvgpr_write_b32 a154, 0
    v_accvgpr_write_b32 a155, 0
    v_mfma_f32_16x16x32_bf16 v[204:207], v[56:59], v[120:123], v[204:207]
    ds_read_b64_tr_b16 v[56:57], v21 offset:32768
    ds_read_b64_tr_b16 v[58:59], v21 offset:33792
    v_mfma_f32_16x16x32_bf16 v[204:207], v[60:63], v[124:127], v[204:207]
    ds_read_b64_tr_b16 v[60:61], v21 offset:40960
    ds_read_b64_tr_b16 v[62:63], v21 offset:41984
    v_mfma_f32_16x16x32_bf16 v[208:211], v[40:43], v[96:99], v[208:211]
    v_add_u32 v21, 0xffff0000, v21
    v_accvgpr_write_b32 a156, 0
    v_mfma_f32_16x16x32_bf16 v[208:211], v[44:47], v[100:103], v[208:211]
    buffer_load_dwordx4 v13, s[20:23], s64 offen offset:3072 lds
    v_mfma_f32_16x16x32_bf16 v[212:215], v[40:43], v[104:107], v[212:215]
    v_accvgpr_write_b32 a157, 0
    v_accvgpr_write_b32 a158, 0
    v_mfma_f32_16x16x32_bf16 v[212:215], v[44:47], v[108:111], v[212:215]
    v_accvgpr_write_b32 a159, 0
    v_mfma_f32_16x16x32_bf16 v[216:219], v[40:43], v[112:115], v[216:219]
    v_accvgpr_read_b32 v32, a160
    v_accvgpr_read_b32 v31, a161
    v_mfma_f32_16x16x32_bf16 v[216:219], v[44:47], v[116:119], v[216:219]
    v_cvt_pk_bf16_f32 v32, v32, v31
    v_accvgpr_read_b32 v33, a162
    v_mfma_f32_16x16x32_bf16 v[220:223], v[40:43], v[120:123], v[220:223]
    ds_read_b64_tr_b16 v[40:41], v26 offset:0
    ds_read_b64_tr_b16 v[42:43], v26 offset:512
    v_mfma_f32_16x16x32_bf16 v[220:223], v[44:47], v[124:127], v[220:223]
    s_waitcnt lgkmcnt(2)
    ds_read_b64_tr_b16 v[44:45], v26 offset:4096
    ds_read_b64_tr_b16 v[46:47], v26 offset:4608
    v_mfma_f32_16x16x32_bf16 v[224:227], v[48:51], v[96:99], v[224:227]
    v_add_u32 v26, 0xfffe0000, v26
    v_accvgpr_read_b32 v31, a163
    v_mfma_f32_16x16x32_bf16 v[224:227], v[52:55], v[100:103], v[224:227]
    s_xor_b32 s64, s64, 384
    v_cvt_pk_bf16_f32 v33, v33, v31
    v_accvgpr_read_b32 v34, a164
    v_mfma_f32_16x16x32_bf16 v[228:231], v[48:51], v[104:107], v[228:231]
    v_accvgpr_read_b32 v31, a165
    v_cvt_pk_bf16_f32 v34, v34, v31
    v_mfma_f32_16x16x32_bf16 v[228:231], v[52:55], v[108:111], v[228:231]
    v_accvgpr_read_b32 v35, a166
    v_accvgpr_read_b32 v31, a167
    v_mfma_f32_16x16x32_bf16 v[232:235], v[48:51], v[112:115], v[232:235]
    v_cvt_pk_bf16_f32 v35, v35, v31
    v_accvgpr_write_b32 a160, 0
    v_mfma_f32_16x16x32_bf16 v[232:235], v[52:55], v[116:119], v[232:235]
    s_add_u32 m0, s69, 65536
    v_accvgpr_write_b32 a161, 0
    v_accvgpr_write_b32 a162, 0
    v_mfma_f32_16x16x32_bf16 v[236:239], v[48:51], v[120:123], v[236:239]
    buffer_load_dwordx4 v2, s[24:27], s60 offen lds
    v_mfma_f32_16x16x32_bf16 v[236:239], v[52:55], v[124:127], v[236:239]
    s_add_u32 s72, s71, 2048
    ds_read_b64_tr_b16 v[48:49], v27 offset:0
    ds_read_b64_tr_b16 v[50:51], v27 offset:512
    v_mfma_f32_16x16x32_bf16 v[240:243], v[56:59], v[96:99], v[240:243]
    ds_read_b64_tr_b16 v[52:53], v27 offset:4096
    ds_read_b64_tr_b16 v[54:55], v27 offset:4608
    v_mfma_f32_16x16x32_bf16 v[240:243], v[60:63], v[100:103], v[240:243]
    v_add_u32 v27, 0xfffe0000, v27
    v_accvgpr_write_b32 a163, 0
    v_mfma_f32_16x16x32_bf16 v[244:247], v[56:59], v[104:107], v[244:247]
    buffer_load_dwordx4 v3, s[24:27], s60 offen offset:1024 lds
    v_mfma_f32_16x16x32_bf16 v[244:247], v[60:63], v[108:111], v[244:247]
    buffer_store_dwordx4 v[32:35], v1, s[36:39], s72 offen sc1
    v_mfma_f32_16x16x32_bf16 v[248:251], v[56:59], v[112:115], v[248:251]
    v_accvgpr_write_b32 a164, 0
    v_accvgpr_write_b32 a165, 0
    v_mfma_f32_16x16x32_bf16 v[248:251], v[60:63], v[116:119], v[248:251]
    v_accvgpr_write_b32 a166, 0
    v_accvgpr_write_b32 a167, 0
    v_mfma_f32_16x16x32_bf16 v[252:255], v[56:59], v[120:123], v[252:255]
    buffer_load_dwordx4 v4, s[24:27], s60 offen offset:2048 lds
    v_mfma_f32_16x16x32_bf16 v[252:255], v[60:63], v[124:127], v[252:255]
    s_waitcnt lgkmcnt(0)
    ds_read_b64_tr_b16 v[56:57], v28 offset:0
    ds_read_b64_tr_b16 v[58:59], v28 offset:512
    v_mfma_f32_16x16x32_bf16 a[64:67], v[40:43], v[96:99], a[64:67]
    ds_read_b64_tr_b16 v[60:61], v28 offset:4096
    ds_read_b64_tr_b16 v[62:63], v28 offset:4608
    v_mfma_f32_16x16x32_bf16 a[64:67], v[44:47], v[100:103], a[64:67]
    v_add_u32 v24, 0x10000, v24
    v_add_u32 v28, 0xfffe0000, v28
    v_mfma_f32_16x16x32_bf16 a[68:71], v[40:43], v[104:107], a[68:71]
    buffer_load_dwordx4 v5, s[24:27], s60 offen offset:3072 lds
    v_mfma_f32_16x16x32_bf16 a[68:71], v[44:47], v[108:111], a[68:71]
    ds_read_b128 v[80:83], v24 offset:16384
    v_mfma_f32_16x16x32_bf16 a[72:75], v[40:43], v[112:115], a[72:75]
    v_mfma_f32_16x16x32_bf16 a[72:75], v[44:47], v[116:119], a[72:75]
    s_add_u32 m0, s69, 81920
    v_add_u32 v25, 0x10000, v25
    v_accvgpr_read_b32 v32, a168
    v_mfma_f32_16x16x32_bf16 a[76:79], v[40:43], v[120:123], a[76:79]
    s_xor_b32 s60, s60, 1572864
    buffer_load_dwordx4 v10, s[20:23], s63 offen lds
    v_mfma_f32_16x16x32_bf16 a[76:79], v[44:47], v[124:127], a[76:79]
    ds_read_b128 v[84:87], v25 offset:16384
    v_accvgpr_read_b32 v31, a169
    v_mfma_f32_16x16x32_bf16 a[128:131], v[40:43], a[136:139], a[128:131]
    ds_read_b64_tr_b16 v[40:41], v29 offset:0
    ds_read_b64_tr_b16 v[42:43], v29 offset:512
    v_mfma_f32_16x16x32_bf16 a[128:131], v[44:47], a[140:143], a[128:131]
    ds_read_b64_tr_b16 v[44:45], v29 offset:4096
    ds_read_b64_tr_b16 v[46:47], v29 offset:4608
    v_mfma_f32_16x16x32_bf16 a[80:83], v[48:51], v[96:99], a[80:83]
    buffer_load_dwordx4 v11, s[20:23], s63 offen offset:1024 lds
    v_mfma_f32_16x16x32_bf16 a[80:83], v[52:55], v[100:103], a[80:83]
    ds_read_b128 v[88:91], v24 offset:24576
    v_add_u32 v29, 0xfffe0000, v29
    v_mfma_f32_16x16x32_bf16 a[84:87], v[48:51], v[104:107], a[84:87]
    v_cvt_pk_bf16_f32 v32, v32, v31
    v_accvgpr_read_b32 v33, a170
    v_mfma_f32_16x16x32_bf16 a[84:87], v[52:55], v[108:111], a[84:87]
    v_accvgpr_read_b32 v31, a171
    v_cvt_pk_bf16_f32 v33, v33, v31
    v_mfma_f32_16x16x32_bf16 a[88:91], v[48:51], v[112:115], a[88:91]
    buffer_load_dwordx4 v12, s[20:23], s63 offen offset:2048 lds
    v_mfma_f32_16x16x32_bf16 a[88:91], v[52:55], v[116:119], a[88:91]
    ds_read_b128 v[92:95], v25 offset:24576
    v_accvgpr_read_b32 v34, a172
    v_mfma_f32_16x16x32_bf16 a[92:95], v[48:51], v[120:123], a[92:95]
    s_add_u32 s72, s71, 3072
    v_accvgpr_read_b32 v31, a173
    v_cvt_pk_bf16_f32 v34, v34, v31
    v_mfma_f32_16x16x32_bf16 a[92:95], v[52:55], v[124:127], a[92:95]
    v_accvgpr_read_b32 v35, a174
    v_accvgpr_read_b32 v31, a175
    v_mfma_f32_16x16x32_bf16 a[132:135], v[48:51], a[136:139], a[132:135]
    buffer_load_dwordx4 v13, s[20:23], s63 offen offset:3072 lds
    v_mfma_f32_16x16x32_bf16 a[132:135], v[52:55], a[140:143], a[132:135]
    s_waitcnt lgkmcnt(1)
    v_cvt_pk_bf16_f32 v35, v35, v31
    v_accvgpr_write_b32 a168, 0
    v_mfma_f32_16x16x32_bf16 a[96:99], v[56:59], v[96:99], a[96:99]
    v_accvgpr_write_b32 a169, 0
    v_accvgpr_write_b32 a170, 0
    v_mfma_f32_16x16x32_bf16 a[96:99], v[60:63], v[100:103], a[96:99]
    s_xor_b32 s63, s63, 128
    v_accvgpr_write_b32 a171, 0
    v_accvgpr_write_b32 a172, 0
    v_mfma_f32_16x16x32_bf16 a[100:103], v[56:59], v[104:107], a[100:103]
    buffer_store_dwordx4 v[32:35], v1, s[36:39], s72 offen sc1
    v_mfma_f32_16x16x32_bf16 a[100:103], v[60:63], v[108:111], a[100:103]
    v_accvgpr_write_b32 a173, 0
    v_accvgpr_write_b32 a174, 0
    v_mfma_f32_16x16x32_bf16 a[104:107], v[56:59], v[112:115], a[104:107]
    v_accvgpr_write_b32 a175, 0
    v_mfma_f32_16x16x32_bf16 a[104:107], v[60:63], v[116:119], a[104:107]
    s_waitcnt vmcnt(10) lgkmcnt(0)
    s_barrier
    ds_read_b64_tr_b16 v[48:49], v14 offset:0
    v_mfma_f32_16x16x32_bf16 a[108:111], v[56:59], v[120:123], a[108:111]
    s_add_u32 m0, s67, 98304
    ds_read_b64_tr_b16 v[50:51], v14 offset:1024
    ds_read_b64_tr_b16 v[52:53], v14 offset:8192
    v_mfma_f32_16x16x32_bf16 a[108:111], v[60:63], v[124:127], a[108:111]
    buffer_load_dwordx4 v1, s[28:31], s65 offen sc1 lds
    v_mfma_f32_16x16x32_bf16 a[112:115], v[40:43], v[96:99], a[112:115]
    ds_read_b64_tr_b16 v[54:55], v14 offset:9216
    ds_read_b64_tr_b16 v[56:57], v15 offset:0
    v_mfma_f32_16x16x32_bf16 a[112:115], v[44:47], v[100:103], a[112:115]
    ds_read_b64_tr_b16 v[58:59], v15 offset:1024
    ds_read_b64_tr_b16 v[60:61], v15 offset:8192
    v_mfma_f32_16x16x32_bf16 a[116:119], v[40:43], v[104:107], a[116:119]
    ds_read_b64_tr_b16 v[62:63], v15 offset:9216
    ds_read_b128 a[136:139], v22 offset:32768
    v_mfma_f32_16x16x32_bf16 a[116:119], v[44:47], v[108:111], a[116:119]
    ds_read_b128 a[140:143], v23 offset:32768
    v_add_u32 v14, 0x10000, v14
    v_mfma_f32_16x16x32_bf16 a[120:123], v[40:43], v[112:115], a[120:123]
    v_add_u32 v15, 0x10000, v15
    v_add_u32 v22, 0x10000, v22
    v_mfma_f32_16x16x32_bf16 a[120:123], v[44:47], v[116:119], a[120:123]
    v_add_u32 v23, 0x10000, v23
    v_accvgpr_read_b32 v32, a176
    v_mfma_f32_16x16x32_bf16 a[124:127], v[40:43], v[120:123], a[124:127]
    buffer_load_dwordx4 v1, s[28:31], s65 offen offset:1024 sc1 lds
    v_mfma_f32_16x16x32_bf16 a[124:127], v[44:47], v[124:127], a[124:127]
    s_waitcnt lgkmcnt(1)
    ds_read_b64_tr_b16 v[40:41], v16 offset:0
    ds_read_b64_tr_b16 v[42:43], v16 offset:1024
    v_mfma_f32_16x16x32_bf16 v[128:131], v[48:51], v[64:67], v[128:131]
    ds_read_b64_tr_b16 v[44:45], v16 offset:8192
    ds_read_b64_tr_b16 v[46:47], v16 offset:9216
    v_mfma_f32_16x16x32_bf16 v[128:131], v[52:55], v[68:71], v[128:131]
    v_add_u32 v24, 0xfffe0000, v24
    v_add_u32 v16, 0x10000, v16
    v_mfma_f32_16x16x32_bf16 v[132:135], v[48:51], v[72:75], v[132:135]
    ds_read_b128 v[96:99], v24 offset:16384
    v_accvgpr_read_b32 v31, a177
    v_mfma_f32_16x16x32_bf16 v[132:135], v[52:55], v[76:79], v[132:135]
    v_cvt_pk_bf16_f32 v32, v32, v31
    v_accvgpr_read_b32 v33, a178
    v_mfma_f32_16x16x32_bf16 v[136:139], v[48:51], v[80:83], v[136:139]
    v_accvgpr_read_b32 v31, a179
    v_cvt_pk_bf16_f32 v33, v33, v31
    v_mfma_f32_16x16x32_bf16 v[136:139], v[52:55], v[84:87], v[136:139]
    s_add_u32 s72, s71, 34816
    v_accvgpr_read_b32 v34, a180
    v_accvgpr_read_b32 v31, a181
    v_mfma_f32_16x16x32_bf16 v[140:143], v[48:51], v[88:91], v[140:143]
    s_add_u32 m0, s68, 106496
    ds_read_b64_tr_b16 v[48:49], v17 offset:0
    ds_read_b64_tr_b16 v[50:51], v17 offset:1024
    v_mfma_f32_16x16x32_bf16 v[140:143], v[52:55], v[92:95], v[140:143]
    buffer_load_dwordx4 v6, s[20:23], s66 offen lds
    v_mfma_f32_16x16x32_bf16 v[144:147], v[56:59], v[64:67], v[144:147]
    ds_read_b64_tr_b16 v[52:53], v17 offset:8192
    ds_read_b64_tr_b16 v[54:55], v17 offset:9216
    v_mfma_f32_16x16x32_bf16 v[144:147], v[60:63], v[68:71], v[144:147]
    v_add_u32 v17, 0x10000, v17
    v_cvt_pk_bf16_f32 v34, v34, v31
    v_mfma_f32_16x16x32_bf16 v[148:151], v[56:59], v[72:75], v[148:151]
    v_accvgpr_read_b32 v35, a182
    v_accvgpr_read_b32 v31, a183
    v_mfma_f32_16x16x32_bf16 v[148:151], v[60:63], v[76:79], v[148:151]
    v_cvt_pk_bf16_f32 v35, v35, v31
    v_accvgpr_write_b32 a176, 0
    v_mfma_f32_16x16x32_bf16 v[152:155], v[56:59], v[80:83], v[152:155]
    v_add_u32 v25, 0xfffe0000, v25
    v_accvgpr_write_b32 a177, 0
    v_mfma_f32_16x16x32_bf16 v[152:155], v[60:63], v[84:87], v[152:155]
    ds_read_b128 v[100:103], v25 offset:16384
    v_accvgpr_write_b32 a178, 0
    v_mfma_f32_16x16x32_bf16 v[156:159], v[56:59], v[88:91], v[156:159]
    s_add_u32 m0, s69, 114688
    ds_read_b64_tr_b16 v[56:57], v18 offset:0
    ds_read_b64_tr_b16 v[58:59], v18 offset:1024
    v_mfma_f32_16x16x32_bf16 v[156:159], v[60:63], v[92:95], v[156:159]
    s_xor_b32 s65, s65, 24576
    buffer_load_dwordx4 v10, s[20:23], s64 offen lds
    s_waitcnt lgkmcnt(3)
    v_mfma_f32_16x16x32_bf16 v[160:163], v[40:43], v[64:67], v[160:163]
    s_xor_b32 s66, s66, 384
    ds_read_b64_tr_b16 v[60:61], v18 offset:8192
    ds_read_b64_tr_b16 v[62:63], v18 offset:9216
    v_mfma_f32_16x16x32_bf16 v[160:163], v[44:47], v[68:71], v[160:163]
    v_add_u32 v18, 0x10000, v18
    v_accvgpr_write_b32 a179, 0
    v_mfma_f32_16x16x32_bf16 v[164:167], v[40:43], v[72:75], v[164:167]
    buffer_store_dwordx4 v[32:35], v1, s[36:39], s72 offen sc1
    v_mfma_f32_16x16x32_bf16 v[164:167], v[44:47], v[76:79], v[164:167]
    v_accvgpr_read_b32 v31, a185
    v_accvgpr_read_b32 v32, a184
    v_mfma_f32_16x16x32_bf16 v[168:171], v[40:43], v[80:83], v[168:171]
    v_cvt_pk_bf16_f32 v32, v32, v31
    v_accvgpr_read_b32 v33, a186
    v_mfma_f32_16x16x32_bf16 v[168:171], v[44:47], v[84:87], v[168:171]
    v_accvgpr_read_b32 v31, a187
    v_cvt_pk_bf16_f32 v33, v33, v31
    v_mfma_f32_16x16x32_bf16 v[172:175], v[40:43], v[88:91], v[172:175]
    ds_read_b64_tr_b16 v[40:41], v19 offset:0
    ds_read_b64_tr_b16 v[42:43], v19 offset:1024
    v_mfma_f32_16x16x32_bf16 v[172:175], v[44:47], v[92:95], v[172:175]
    ds_read_b64_tr_b16 v[44:45], v19 offset:8192
    ds_read_b64_tr_b16 v[46:47], v19 offset:9216
    v_mfma_f32_16x16x32_bf16 v[176:179], v[48:51], v[64:67], v[176:179]
    buffer_load_dwordx4 v11, s[20:23], s64 offen offset:1024 lds
    v_mfma_f32_16x16x32_bf16 v[176:179], v[52:55], v[68:71], v[176:179]
    ds_read_b128 v[104:107], v24 offset:24576
    v_add_u32 v19, 0x10000, v19
    v_mfma_f32_16x16x32_bf16 v[180:183], v[48:51], v[72:75], v[180:183]
    v_accvgpr_read_b32 v34, a188
    v_accvgpr_read_b32 v31, a189
    v_mfma_f32_16x16x32_bf16 v[180:183], v[52:55], v[76:79], v[180:183]
    v_cvt_pk_bf16_f32 v34, v34, v31
    v_accvgpr_read_b32 v35, a190
    v_mfma_f32_16x16x32_bf16 v[184:187], v[48:51], v[80:83], v[184:187]
    v_accvgpr_read_b32 v31, a191
    v_cvt_pk_bf16_f32 v35, v35, v31
    v_mfma_f32_16x16x32_bf16 v[184:187], v[52:55], v[84:87], v[184:187]
    v_accvgpr_write_b32 a180, 0
    v_accvgpr_write_b32 a181, 0
    v_mfma_f32_16x16x32_bf16 v[188:191], v[48:51], v[88:91], v[188:191]
    s_add_u32 s72, s71, 35840
    ds_read_b64_tr_b16 v[48:49], v20 offset:0
    ds_read_b64_tr_b16 v[50:51], v20 offset:1024
    v_mfma_f32_16x16x32_bf16 v[188:191], v[52:55], v[92:95], v[188:191]
    s_waitcnt lgkmcnt(2)
    ds_read_b64_tr_b16 v[52:53], v20 offset:8192
    ds_read_b64_tr_b16 v[54:55], v20 offset:9216
    v_mfma_f32_16x16x32_bf16 v[192:195], v[56:59], v[64:67], v[192:195]
    buffer_load_dwordx4 v12, s[20:23], s64 offen offset:2048 lds
    v_mfma_f32_16x16x32_bf16 v[192:195], v[60:63], v[68:71], v[192:195]
    v_add_u32 v20, 0x10000, v20
    v_accvgpr_write_b32 a182, 0
    v_mfma_f32_16x16x32_bf16 v[196:199], v[56:59], v[72:75], v[196:199]
    buffer_store_dwordx4 v[32:35], v1, s[36:39], s72 offen sc1
    v_mfma_f32_16x16x32_bf16 v[196:199], v[60:63], v[76:79], v[196:199]
    ds_read_b128 v[108:111], v25 offset:24576
    v_accvgpr_write_b32 a183, 0
    v_mfma_f32_16x16x32_bf16 v[200:203], v[56:59], v[80:83], v[200:203]
    v_accvgpr_write_b32 a184, 0
    v_accvgpr_write_b32 a185, 0
    v_mfma_f32_16x16x32_bf16 v[200:203], v[60:63], v[84:87], v[200:203]
    v_accvgpr_write_b32 a186, 0
    v_accvgpr_write_b32 a187, 0
    v_mfma_f32_16x16x32_bf16 v[204:207], v[56:59], v[88:91], v[204:207]
    ds_read_b64_tr_b16 v[56:57], v21 offset:0
    ds_read_b64_tr_b16 v[58:59], v21 offset:1024
    v_mfma_f32_16x16x32_bf16 v[204:207], v[60:63], v[92:95], v[204:207]
    ds_read_b64_tr_b16 v[60:61], v21 offset:8192
    ds_read_b64_tr_b16 v[62:63], v21 offset:9216
    v_mfma_f32_16x16x32_bf16 v[208:211], v[40:43], v[64:67], v[208:211]
    v_add_u32 v21, 0x10000, v21
    v_accvgpr_write_b32 a188, 0
    v_mfma_f32_16x16x32_bf16 v[208:211], v[44:47], v[68:71], v[208:211]
    buffer_load_dwordx4 v13, s[20:23], s64 offen offset:3072 lds
    v_mfma_f32_16x16x32_bf16 v[212:215], v[40:43], v[72:75], v[212:215]
    v_accvgpr_write_b32 a189, 0
    v_accvgpr_write_b32 a190, 0
    v_mfma_f32_16x16x32_bf16 v[212:215], v[44:47], v[76:79], v[212:215]
    v_accvgpr_write_b32 a191, 0
    v_mfma_f32_16x16x32_bf16 v[216:219], v[40:43], v[80:83], v[216:219]
    v_accvgpr_read_b32 v32, a192
    v_accvgpr_read_b32 v31, a193
    v_mfma_f32_16x16x32_bf16 v[216:219], v[44:47], v[84:87], v[216:219]
    v_cvt_pk_bf16_f32 v32, v32, v31
    v_accvgpr_read_b32 v33, a194
    v_mfma_f32_16x16x32_bf16 v[220:223], v[40:43], v[88:91], v[220:223]
    ds_read_b64_tr_b16 v[40:41], v26 offset:32768
    ds_read_b64_tr_b16 v[42:43], v26 offset:33280
    v_mfma_f32_16x16x32_bf16 v[220:223], v[44:47], v[92:95], v[220:223]
    s_waitcnt lgkmcnt(2)
    ds_read_b64_tr_b16 v[44:45], v26 offset:36864
    ds_read_b64_tr_b16 v[46:47], v26 offset:37376
    v_mfma_f32_16x16x32_bf16 v[224:227], v[48:51], v[64:67], v[224:227]
    v_add_u32 v26, 0x10000, v26
    v_accvgpr_read_b32 v31, a195
    v_mfma_f32_16x16x32_bf16 v[224:227], v[52:55], v[68:71], v[224:227]
    s_xor_b32 s64, s64, 128
    v_cvt_pk_bf16_f32 v33, v33, v31
    v_accvgpr_read_b32 v34, a196
    v_mfma_f32_16x16x32_bf16 v[228:231], v[48:51], v[72:75], v[228:231]
    v_accvgpr_read_b32 v31, a197
    v_cvt_pk_bf16_f32 v34, v34, v31
    v_mfma_f32_16x16x32_bf16 v[228:231], v[52:55], v[76:79], v[228:231]
    v_accvgpr_read_b32 v35, a198
    v_accvgpr_read_b32 v31, a199
    v_mfma_f32_16x16x32_bf16 v[232:235], v[48:51], v[80:83], v[232:235]
    v_cvt_pk_bf16_f32 v35, v35, v31
    v_accvgpr_write_b32 a192, 0
    v_mfma_f32_16x16x32_bf16 v[232:235], v[52:55], v[84:87], v[232:235]
    s_add_u32 m0, s69, 131072
    v_accvgpr_write_b32 a193, 0
    v_accvgpr_write_b32 a194, 0
    v_mfma_f32_16x16x32_bf16 v[236:239], v[48:51], v[88:91], v[236:239]
    buffer_load_dwordx4 v2, s[24:27], s60 offen lds
    v_mfma_f32_16x16x32_bf16 v[236:239], v[52:55], v[92:95], v[236:239]
    s_add_u32 s72, s71, 4096
    ds_read_b64_tr_b16 v[48:49], v27 offset:32768
    ds_read_b64_tr_b16 v[50:51], v27 offset:33280
    v_mfma_f32_16x16x32_bf16 v[240:243], v[56:59], v[64:67], v[240:243]
    ds_read_b64_tr_b16 v[52:53], v27 offset:36864
    ds_read_b64_tr_b16 v[54:55], v27 offset:37376
    v_mfma_f32_16x16x32_bf16 v[240:243], v[60:63], v[68:71], v[240:243]
    v_add_u32 v27, 0x10000, v27
    v_accvgpr_write_b32 a195, 0
    v_mfma_f32_16x16x32_bf16 v[244:247], v[56:59], v[72:75], v[244:247]
    buffer_load_dwordx4 v3, s[24:27], s60 offen offset:1024 lds
    v_mfma_f32_16x16x32_bf16 v[244:247], v[60:63], v[76:79], v[244:247]
    buffer_store_dwordx4 v[32:35], v1, s[36:39], s72 offen sc1
    v_mfma_f32_16x16x32_bf16 v[248:251], v[56:59], v[80:83], v[248:251]
    v_accvgpr_write_b32 a196, 0
    v_accvgpr_write_b32 a197, 0
    v_mfma_f32_16x16x32_bf16 v[248:251], v[60:63], v[84:87], v[248:251]
    v_accvgpr_write_b32 a198, 0
    v_accvgpr_write_b32 a199, 0
    v_mfma_f32_16x16x32_bf16 v[252:255], v[56:59], v[88:91], v[252:255]
    buffer_load_dwordx4 v4, s[24:27], s60 offen offset:2048 lds
    v_mfma_f32_16x16x32_bf16 v[252:255], v[60:63], v[92:95], v[252:255]
    s_waitcnt lgkmcnt(0)
    ds_read_b64_tr_b16 v[56:57], v28 offset:32768
    ds_read_b64_tr_b16 v[58:59], v28 offset:33280
    v_mfma_f32_16x16x32_bf16 a[64:67], v[40:43], v[64:67], a[64:67]
    ds_read_b64_tr_b16 v[60:61], v28 offset:36864
    ds_read_b64_tr_b16 v[62:63], v28 offset:37376
    v_mfma_f32_16x16x32_bf16 a[64:67], v[44:47], v[68:71], a[64:67]
    v_add_u32 v28, 0x10000, v28
    v_mfma_f32_16x16x32_bf16 a[68:71], v[40:43], v[72:75], a[68:71]
    buffer_load_dwordx4 v5, s[24:27], s60 offen offset:3072 lds
    v_mfma_f32_16x16x32_bf16 a[68:71], v[44:47], v[76:79], a[68:71]
    ds_read_b128 v[112:115], v24 offset:49152
    v_mfma_f32_16x16x32_bf16 a[72:75], v[40:43], v[80:83], a[72:75]
    v_mfma_f32_16x16x32_bf16 a[72:75], v[44:47], v[84:87], a[72:75]
    s_add_u32 m0, s69, 147456
    v_accvgpr_read_b32 v32, a200
    v_accvgpr_read_b32 v31, a201
    v_mfma_f32_16x16x32_bf16 a[76:79], v[40:43], v[88:91], a[76:79]
    s_xor_b32 s60, s60, 524288
    buffer_load_dwordx4 v10, s[20:23], s63 offen lds
    v_mfma_f32_16x16x32_bf16 a[76:79], v[44:47], v[92:95], a[76:79]
    ds_read_b128 v[116:119], v25 offset:49152
    v_cvt_pk_bf16_f32 v32, v32, v31
    v_mfma_f32_16x16x32_bf16 a[128:131], v[40:43], a[136:139], a[128:131]
    ds_read_b64_tr_b16 v[40:41], v29 offset:32768
    ds_read_b64_tr_b16 v[42:43], v29 offset:33280
    v_mfma_f32_16x16x32_bf16 a[128:131], v[44:47], a[140:143], a[128:131]
    ds_read_b64_tr_b16 v[44:45], v29 offset:36864
    ds_read_b64_tr_b16 v[46:47], v29 offset:37376
    v_mfma_f32_16x16x32_bf16 a[80:83], v[48:51], v[64:67], a[80:83]
    buffer_load_dwordx4 v11, s[20:23], s63 offen offset:1024 lds
    v_mfma_f32_16x16x32_bf16 a[80:83], v[52:55], v[68:71], a[80:83]
    ds_read_b128 v[120:123], v24 offset:57344
    v_add_u32 v29, 0x10000, v29
    v_mfma_f32_16x16x32_bf16 a[84:87], v[48:51], v[72:75], a[84:87]
    v_accvgpr_read_b32 v33, a202
    v_accvgpr_read_b32 v31, a203
    v_mfma_f32_16x16x32_bf16 a[84:87], v[52:55], v[76:79], a[84:87]
    v_cvt_pk_bf16_f32 v33, v33, v31
    v_accvgpr_read_b32 v34, a204
    v_mfma_f32_16x16x32_bf16 a[88:91], v[48:51], v[80:83], a[88:91]
    buffer_load_dwordx4 v12, s[20:23], s63 offen offset:2048 lds
    v_mfma_f32_16x16x32_bf16 a[88:91], v[52:55], v[84:87], a[88:91]
    ds_read_b128 v[124:127], v25 offset:57344
    v_accvgpr_read_b32 v31, a205
    v_mfma_f32_16x16x32_bf16 a[92:95], v[48:51], v[88:91], a[92:95]
    s_add_u32 s72, s71, 5120
    v_cvt_pk_bf16_f32 v34, v34, v31
    v_accvgpr_read_b32 v35, a206
    v_mfma_f32_16x16x32_bf16 a[92:95], v[52:55], v[92:95], a[92:95]
    v_accvgpr_read_b32 v31, a207
    v_cvt_pk_bf16_f32 v35, v35, v31
    v_mfma_f32_16x16x32_bf16 a[132:135], v[48:51], a[136:139], a[132:135]
    buffer_load_dwordx4 v13, s[20:23], s63 offen offset:3072 lds
    v_mfma_f32_16x16x32_bf16 a[132:135], v[52:55], a[140:143], a[132:135]
    s_waitcnt lgkmcnt(1)
    v_accvgpr_write_b32 a200, 0
    v_accvgpr_write_b32 a201, 0
    v_mfma_f32_16x16x32_bf16 a[96:99], v[56:59], v[64:67], a[96:99]
    v_accvgpr_write_b32 a202, 0
    v_accvgpr_write_b32 a203, 0
    v_mfma_f32_16x16x32_bf16 a[96:99], v[60:63], v[68:71], a[96:99]
    s_xor_b32 s63, s63, 1920
    v_accvgpr_write_b32 a204, 0
    v_accvgpr_write_b32 a205, 0
    v_mfma_f32_16x16x32_bf16 a[100:103], v[56:59], v[72:75], a[100:103]
    s_andn2_b32 s63, s63, 896
    buffer_store_dwordx4 v[32:35], v1, s[36:39], s72 offen sc1
    v_mfma_f32_16x16x32_bf16 a[100:103], v[60:63], v[76:79], a[100:103]
    v_accvgpr_write_b32 a206, 0
    v_accvgpr_write_b32 a207, 0
    v_mfma_f32_16x16x32_bf16 a[104:107], v[56:59], v[80:83], a[104:107]
    v_mfma_f32_16x16x32_bf16 a[104:107], v[60:63], v[84:87], a[104:107]
    s_waitcnt vmcnt(10) lgkmcnt(0)
    s_barrier
    ds_read_b64_tr_b16 v[48:49], v14 offset:0
    v_mfma_f32_16x16x32_bf16 a[108:111], v[56:59], v[88:91], a[108:111]
    s_add_u32 m0, s67, 0
    ds_read_b64_tr_b16 v[50:51], v14 offset:1024
    ds_read_b64_tr_b16 v[52:53], v14 offset:8192
    v_mfma_f32_16x16x32_bf16 a[108:111], v[60:63], v[92:95], a[108:111]
    buffer_load_dwordx4 v1, s[28:31], s65 offen sc1 lds
    v_mfma_f32_16x16x32_bf16 a[112:115], v[40:43], v[64:67], a[112:115]
    ds_read_b64_tr_b16 v[54:55], v14 offset:9216
    ds_read_b64_tr_b16 v[56:57], v15 offset:0
    v_mfma_f32_16x16x32_bf16 a[112:115], v[44:47], v[68:71], a[112:115]
    ds_read_b64_tr_b16 v[58:59], v15 offset:1024
    ds_read_b64_tr_b16 v[60:61], v15 offset:8192
    v_mfma_f32_16x16x32_bf16 a[116:119], v[40:43], v[72:75], a[116:119]
    ds_read_b64_tr_b16 v[62:63], v15 offset:9216
    ds_read_b128 a[136:139], v22 offset:32768
    v_mfma_f32_16x16x32_bf16 a[116:119], v[44:47], v[76:79], a[116:119]
    ds_read_b128 a[140:143], v23 offset:32768
    v_add_u32 v14, 0x10000, v14
    v_mfma_f32_16x16x32_bf16 a[120:123], v[40:43], v[80:83], a[120:123]
    v_add_u32 v15, 0x10000, v15
    v_add_u32 v22, 0xffff0000, v22
    v_mfma_f32_16x16x32_bf16 a[120:123], v[44:47], v[84:87], a[120:123]
    v_add_u32 v23, 0xffff0000, v23
    v_accvgpr_read_b32 v32, a208
    v_mfma_f32_16x16x32_bf16 a[124:127], v[40:43], v[88:91], a[124:127]
    buffer_load_dwordx4 v1, s[28:31], s65 offen offset:1024 sc1 lds
    v_mfma_f32_16x16x32_bf16 a[124:127], v[44:47], v[92:95], a[124:127]
    s_waitcnt lgkmcnt(1)
    ds_read_b64_tr_b16 v[40:41], v16 offset:0
    ds_read_b64_tr_b16 v[42:43], v16 offset:1024
    v_mfma_f32_16x16x32_bf16 v[128:131], v[48:51], v[96:99], v[128:131]
    ds_read_b64_tr_b16 v[44:45], v16 offset:8192
    ds_read_b64_tr_b16 v[46:47], v16 offset:9216
    v_mfma_f32_16x16x32_bf16 v[128:131], v[52:55], v[100:103], v[128:131]
    v_add_u32 v24, 0x10000, v24
    v_add_u32 v16, 0x10000, v16
    v_mfma_f32_16x16x32_bf16 v[132:135], v[48:51], v[104:107], v[132:135]
    ds_read_b128 v[64:67], v24 offset:16384
    v_accvgpr_read_b32 v31, a209
    v_mfma_f32_16x16x32_bf16 v[132:135], v[52:55], v[108:111], v[132:135]
    v_cvt_pk_bf16_f32 v32, v32, v31
    v_accvgpr_read_b32 v33, a210
    v_mfma_f32_16x16x32_bf16 v[136:139], v[48:51], v[112:115], v[136:139]
    v_accvgpr_read_b32 v31, a211
    v_cvt_pk_bf16_f32 v33, v33, v31
    v_mfma_f32_16x16x32_bf16 v[136:139], v[52:55], v[116:119], v[136:139]
    s_add_u32 s72, s71, 36864
    v_accvgpr_read_b32 v34, a212
    v_accvgpr_read_b32 v31, a213
    v_mfma_f32_16x16x32_bf16 v[140:143], v[48:51], v[120:123], v[140:143]
    s_add_u32 m0, s68, 8192
    ds_read_b64_tr_b16 v[48:49], v17 offset:0
    ds_read_b64_tr_b16 v[50:51], v17 offset:1024
    v_mfma_f32_16x16x32_bf16 v[140:143], v[52:55], v[124:127], v[140:143]
    buffer_load_dwordx4 v6, s[20:23], s66 offen lds
    v_mfma_f32_16x16x32_bf16 v[144:147], v[56:59], v[96:99], v[144:147]
    ds_read_b64_tr_b16 v[52:53], v17 offset:8192
    ds_read_b64_tr_b16 v[54:55], v17 offset:9216
    v_mfma_f32_16x16x32_bf16 v[144:147], v[60:63], v[100:103], v[144:147]
    v_add_u32 v17, 0x10000, v17
    v_cvt_pk_bf16_f32 v34, v34, v31
    v_mfma_f32_16x16x32_bf16 v[148:151], v[56:59], v[104:107], v[148:151]
    v_accvgpr_read_b32 v35, a214
    v_accvgpr_read_b32 v31, a215
    v_mfma_f32_16x16x32_bf16 v[148:151], v[60:63], v[108:111], v[148:151]
    v_cvt_pk_bf16_f32 v35, v35, v31
    v_accvgpr_write_b32 a208, 0
    v_mfma_f32_16x16x32_bf16 v[152:155], v[56:59], v[112:115], v[152:155]
    v_add_u32 v25, 0x10000, v25
    v_accvgpr_write_b32 a209, 0
    v_mfma_f32_16x16x32_bf16 v[152:155], v[60:63], v[116:119], v[152:155]
    ds_read_b128 v[68:71], v25 offset:16384
    v_accvgpr_write_b32 a210, 0
    v_mfma_f32_16x16x32_bf16 v[156:159], v[56:59], v[120:123], v[156:159]
    s_add_u32 m0, s69, 16384
    ds_read_b64_tr_b16 v[56:57], v18 offset:0
    ds_read_b64_tr_b16 v[58:59], v18 offset:1024
    v_mfma_f32_16x16x32_bf16 v[156:159], v[60:63], v[124:127], v[156:159]
    s_xor_b32 s65, s65, 8192
    buffer_load_dwordx4 v10, s[20:23], s64 offen lds
    s_waitcnt lgkmcnt(3)
    v_mfma_f32_16x16x32_bf16 v[160:163], v[40:43], v[96:99], v[160:163]
    s_xor_b32 s66, s66, 128
    ds_read_b64_tr_b16 v[60:61], v18 offset:8192
    ds_read_b64_tr_b16 v[62:63], v18 offset:9216
    v_mfma_f32_16x16x32_bf16 v[160:163], v[44:47], v[100:103], v[160:163]
    v_add_u32 v18, 0x10000, v18
    v_accvgpr_write_b32 a211, 0
    v_mfma_f32_16x16x32_bf16 v[164:167], v[40:43], v[104:107], v[164:167]
    buffer_store_dwordx4 v[32:35], v1, s[36:39], s72 offen sc1
    v_mfma_f32_16x16x32_bf16 v[164:167], v[44:47], v[108:111], v[164:167]
    v_accvgpr_read_b32 v31, a217
    v_accvgpr_read_b32 v32, a216
    v_mfma_f32_16x16x32_bf16 v[168:171], v[40:43], v[112:115], v[168:171]
    v_cvt_pk_bf16_f32 v32, v32, v31
    v_accvgpr_read_b32 v33, a218
    v_mfma_f32_16x16x32_bf16 v[168:171], v[44:47], v[116:119], v[168:171]
    v_accvgpr_read_b32 v31, a219
    v_cvt_pk_bf16_f32 v33, v33, v31
    v_mfma_f32_16x16x32_bf16 v[172:175], v[40:43], v[120:123], v[172:175]
    ds_read_b64_tr_b16 v[40:41], v19 offset:0
    ds_read_b64_tr_b16 v[42:43], v19 offset:1024
    v_mfma_f32_16x16x32_bf16 v[172:175], v[44:47], v[124:127], v[172:175]
    ds_read_b64_tr_b16 v[44:45], v19 offset:8192
    ds_read_b64_tr_b16 v[46:47], v19 offset:9216
    v_mfma_f32_16x16x32_bf16 v[176:179], v[48:51], v[96:99], v[176:179]
    buffer_load_dwordx4 v11, s[20:23], s64 offen offset:1024 lds
    v_mfma_f32_16x16x32_bf16 v[176:179], v[52:55], v[100:103], v[176:179]
    ds_read_b128 v[72:75], v24 offset:24576
    v_add_u32 v19, 0x10000, v19
    v_mfma_f32_16x16x32_bf16 v[180:183], v[48:51], v[104:107], v[180:183]
    v_accvgpr_read_b32 v34, a220
    v_accvgpr_read_b32 v31, a221
    v_mfma_f32_16x16x32_bf16 v[180:183], v[52:55], v[108:111], v[180:183]
    v_cvt_pk_bf16_f32 v34, v34, v31
    v_accvgpr_read_b32 v35, a222
    v_mfma_f32_16x16x32_bf16 v[184:187], v[48:51], v[112:115], v[184:187]
    v_accvgpr_read_b32 v31, a223
    v_cvt_pk_bf16_f32 v35, v35, v31
    v_mfma_f32_16x16x32_bf16 v[184:187], v[52:55], v[116:119], v[184:187]
    v_accvgpr_write_b32 a212, 0
    v_accvgpr_write_b32 a213, 0
    v_mfma_f32_16x16x32_bf16 v[188:191], v[48:51], v[120:123], v[188:191]
    s_add_u32 s72, s71, 37888
    ds_read_b64_tr_b16 v[48:49], v20 offset:0
    ds_read_b64_tr_b16 v[50:51], v20 offset:1024
    v_mfma_f32_16x16x32_bf16 v[188:191], v[52:55], v[124:127], v[188:191]
    s_waitcnt lgkmcnt(2)
    ds_read_b64_tr_b16 v[52:53], v20 offset:8192
    ds_read_b64_tr_b16 v[54:55], v20 offset:9216
    v_mfma_f32_16x16x32_bf16 v[192:195], v[56:59], v[96:99], v[192:195]
    buffer_load_dwordx4 v12, s[20:23], s64 offen offset:2048 lds
    v_mfma_f32_16x16x32_bf16 v[192:195], v[60:63], v[100:103], v[192:195]
    v_add_u32 v20, 0x10000, v20
    v_accvgpr_write_b32 a214, 0
    v_mfma_f32_16x16x32_bf16 v[196:199], v[56:59], v[104:107], v[196:199]
    buffer_store_dwordx4 v[32:35], v1, s[36:39], s72 offen sc1
    v_mfma_f32_16x16x32_bf16 v[196:199], v[60:63], v[108:111], v[196:199]
    ds_read_b128 v[76:79], v25 offset:24576
    v_accvgpr_write_b32 a215, 0
    v_mfma_f32_16x16x32_bf16 v[200:203], v[56:59], v[112:115], v[200:203]
    v_accvgpr_write_b32 a216, 0
    v_accvgpr_write_b32 a217, 0
    v_mfma_f32_16x16x32_bf16 v[200:203], v[60:63], v[116:119], v[200:203]
    v_accvgpr_write_b32 a218, 0
    v_accvgpr_write_b32 a219, 0
    v_mfma_f32_16x16x32_bf16 v[204:207], v[56:59], v[120:123], v[204:207]
    ds_read_b64_tr_b16 v[56:57], v21 offset:0
    ds_read_b64_tr_b16 v[58:59], v21 offset:1024
    v_mfma_f32_16x16x32_bf16 v[204:207], v[60:63], v[124:127], v[204:207]
    ds_read_b64_tr_b16 v[60:61], v21 offset:8192
    ds_read_b64_tr_b16 v[62:63], v21 offset:9216
    v_mfma_f32_16x16x32_bf16 v[208:211], v[40:43], v[96:99], v[208:211]
    v_add_u32 v21, 0x10000, v21
    v_accvgpr_write_b32 a220, 0
    v_mfma_f32_16x16x32_bf16 v[208:211], v[44:47], v[100:103], v[208:211]
    buffer_load_dwordx4 v13, s[20:23], s64 offen offset:3072 lds
    v_mfma_f32_16x16x32_bf16 v[212:215], v[40:43], v[104:107], v[212:215]
    v_accvgpr_write_b32 a221, 0
    v_accvgpr_write_b32 a222, 0
    v_mfma_f32_16x16x32_bf16 v[212:215], v[44:47], v[108:111], v[212:215]
    v_accvgpr_write_b32 a223, 0
    v_mfma_f32_16x16x32_bf16 v[216:219], v[40:43], v[112:115], v[216:219]
    v_accvgpr_read_b32 v32, a224
    v_accvgpr_read_b32 v31, a225
    v_mfma_f32_16x16x32_bf16 v[216:219], v[44:47], v[116:119], v[216:219]
    v_cvt_pk_bf16_f32 v32, v32, v31
    v_accvgpr_read_b32 v33, a226
    v_mfma_f32_16x16x32_bf16 v[220:223], v[40:43], v[120:123], v[220:223]
    ds_read_b64_tr_b16 v[40:41], v26 offset:32768
    ds_read_b64_tr_b16 v[42:43], v26 offset:33280
    v_mfma_f32_16x16x32_bf16 v[220:223], v[44:47], v[124:127], v[220:223]
    s_waitcnt lgkmcnt(2)
    ds_read_b64_tr_b16 v[44:45], v26 offset:36864
    ds_read_b64_tr_b16 v[46:47], v26 offset:37376
    v_mfma_f32_16x16x32_bf16 v[224:227], v[48:51], v[96:99], v[224:227]
    v_add_u32 v26, 0xffff0000, v26
    v_accvgpr_read_b32 v31, a227
    v_mfma_f32_16x16x32_bf16 v[224:227], v[52:55], v[100:103], v[224:227]
    s_xor_b32 s64, s64, 1920
    v_cvt_pk_bf16_f32 v33, v33, v31
    v_accvgpr_read_b32 v34, a228
    v_mfma_f32_16x16x32_bf16 v[228:231], v[48:51], v[104:107], v[228:231]
    s_andn2_b32 s64, s64, 896
    v_accvgpr_read_b32 v31, a229
    v_cvt_pk_bf16_f32 v34, v34, v31
    v_mfma_f32_16x16x32_bf16 v[228:231], v[52:55], v[108:111], v[228:231]
    v_accvgpr_read_b32 v35, a230
    v_accvgpr_read_b32 v31, a231
    v_mfma_f32_16x16x32_bf16 v[232:235], v[48:51], v[112:115], v[232:235]
    v_cvt_pk_bf16_f32 v35, v35, v31
    v_mfma_f32_16x16x32_bf16 v[232:235], v[52:55], v[116:119], v[232:235]
    s_add_u32 m0, s69, 32768
    v_mfma_f32_16x16x32_bf16 v[236:239], v[48:51], v[120:123], v[236:239]
    buffer_load_dwordx4 v2, s[24:27], s60 offen lds
    v_mfma_f32_16x16x32_bf16 v[236:239], v[52:55], v[124:127], v[236:239]
    s_add_u32 s72, s71, 6144
    ds_read_b64_tr_b16 v[48:49], v27 offset:32768
    ds_read_b64_tr_b16 v[50:51], v27 offset:33280
    v_mfma_f32_16x16x32_bf16 v[240:243], v[56:59], v[96:99], v[240:243]
    ds_read_b64_tr_b16 v[52:53], v27 offset:36864
    ds_read_b64_tr_b16 v[54:55], v27 offset:37376
    v_mfma_f32_16x16x32_bf16 v[240:243], v[60:63], v[100:103], v[240:243]
    buffer_store_dwordx4 v[32:35], v1, s[36:39], s72 offen sc1
    v_mfma_f32_16x16x32_bf16 v[244:247], v[56:59], v[104:107], v[244:247]
    buffer_load_dwordx4 v3, s[24:27], s60 offen offset:1024 lds
    v_mfma_f32_16x16x32_bf16 v[244:247], v[60:63], v[108:111], v[244:247]
    v_add_u32 v27, 0xffff0000, v27
    v_mfma_f32_16x16x32_bf16 v[248:251], v[56:59], v[112:115], v[248:251]
    v_mfma_f32_16x16x32_bf16 v[248:251], v[60:63], v[116:119], v[248:251]
    v_mfma_f32_16x16x32_bf16 v[252:255], v[56:59], v[120:123], v[252:255]
    buffer_load_dwordx4 v4, s[24:27], s60 offen offset:2048 lds
    v_mfma_f32_16x16x32_bf16 v[252:255], v[60:63], v[124:127], v[252:255]
    s_waitcnt lgkmcnt(0)
    ds_read_b64_tr_b16 v[56:57], v28 offset:32768
    ds_read_b64_tr_b16 v[58:59], v28 offset:33280
    v_mfma_f32_16x16x32_bf16 a[64:67], v[40:43], v[96:99], a[64:67]
    ds_read_b64_tr_b16 v[60:61], v28 offset:36864
    ds_read_b64_tr_b16 v[62:63], v28 offset:37376
    v_mfma_f32_16x16x32_bf16 a[64:67], v[44:47], v[100:103], a[64:67]
    v_add_u32 v28, 0xffff0000, v28
    v_mfma_f32_16x16x32_bf16 a[68:71], v[40:43], v[104:107], a[68:71]
    buffer_load_dwordx4 v5, s[24:27], s60 offen offset:3072 lds
    v_mfma_f32_16x16x32_bf16 a[68:71], v[44:47], v[108:111], a[68:71]
    ds_read_b128 v[80:83], v24 offset:49152
    v_mfma_f32_16x16x32_bf16 a[72:75], v[40:43], v[112:115], a[72:75]
    v_mfma_f32_16x16x32_bf16 a[72:75], v[44:47], v[116:119], a[72:75]
    s_xor_b32 s60, s60, 7864320
    v_accvgpr_read_b32 v32, a232
    v_accvgpr_read_b32 v31, a233
    v_mfma_f32_16x16x32_bf16 a[76:79], v[40:43], v[120:123], a[76:79]
    s_add_u32 m0, s69, 49152
    ds_read_b128 v[84:87], v25 offset:49152
    v_cvt_pk_bf16_f32 v32, v32, v31
    v_mfma_f32_16x16x32_bf16 a[76:79], v[44:47], v[124:127], a[76:79]
    s_andn2_b32 s60, s60, 3670016
    buffer_load_dwordx4 v10, s[20:23], s63 offen lds
    v_mfma_f32_16x16x32_bf16 a[128:131], v[40:43], a[136:139], a[128:131]
    ds_read_b64_tr_b16 v[40:41], v29 offset:32768
    ds_read_b64_tr_b16 v[42:43], v29 offset:33280
    v_mfma_f32_16x16x32_bf16 a[128:131], v[44:47], a[140:143], a[128:131]
    ds_read_b64_tr_b16 v[44:45], v29 offset:36864
    ds_read_b64_tr_b16 v[46:47], v29 offset:37376
    v_mfma_f32_16x16x32_bf16 a[80:83], v[48:51], v[96:99], a[80:83]
    buffer_load_dwordx4 v11, s[20:23], s63 offen offset:1024 lds
    v_mfma_f32_16x16x32_bf16 a[80:83], v[52:55], v[100:103], a[80:83]
    ds_read_b128 v[88:91], v24 offset:57344
    v_add_u32 v29, 0xffff0000, v29
    v_mfma_f32_16x16x32_bf16 a[84:87], v[48:51], v[104:107], a[84:87]
    v_accvgpr_read_b32 v33, a234
    v_accvgpr_read_b32 v31, a235
    v_mfma_f32_16x16x32_bf16 a[84:87], v[52:55], v[108:111], a[84:87]
    v_cvt_pk_bf16_f32 v33, v33, v31
    v_accvgpr_read_b32 v34, a236
    v_mfma_f32_16x16x32_bf16 a[88:91], v[48:51], v[112:115], a[88:91]
    buffer_load_dwordx4 v12, s[20:23], s63 offen offset:2048 lds
    v_mfma_f32_16x16x32_bf16 a[88:91], v[52:55], v[116:119], a[88:91]
    ds_read_b128 v[92:95], v25 offset:57344
    v_accvgpr_read_b32 v31, a237
    v_mfma_f32_16x16x32_bf16 a[92:95], v[48:51], v[120:123], a[92:95]
    s_add_u32 s72, s71, 7168
    v_cvt_pk_bf16_f32 v34, v34, v31
    v_accvgpr_read_b32 v35, a238
    v_mfma_f32_16x16x32_bf16 a[92:95], v[52:55], v[124:127], a[92:95]
    v_accvgpr_read_b32 v31, a239
    v_cvt_pk_bf16_f32 v35, v35, v31
    v_mfma_f32_16x16x32_bf16 a[132:135], v[48:51], a[136:139], a[132:135]
    buffer_load_dwordx4 v13, s[20:23], s63 offen offset:3072 lds
    v_mfma_f32_16x16x32_bf16 a[132:135], v[52:55], a[140:143], a[132:135]
    s_waitcnt lgkmcnt(1)
    v_mfma_f32_16x16x32_bf16 a[96:99], v[56:59], v[96:99], a[96:99]
    v_mfma_f32_16x16x32_bf16 a[96:99], v[60:63], v[100:103], a[96:99]
    s_xor_b32 s63, s63, 128
    v_mfma_f32_16x16x32_bf16 a[100:103], v[56:59], v[104:107], a[100:103]
    buffer_store_dwordx4 v[32:35], v1, s[36:39], s72 offen sc1
    v_mfma_f32_16x16x32_bf16 a[100:103], v[60:63], v[108:111], a[100:103]
    v_mfma_f32_16x16x32_bf16 a[104:107], v[56:59], v[112:115], a[104:107]
    v_mfma_f32_16x16x32_bf16 a[104:107], v[60:63], v[116:119], a[104:107]
    s_waitcnt vmcnt(10) lgkmcnt(0)
    s_barrier
    ds_read_b64_tr_b16 v[48:49], v14 offset:0
    v_mfma_f32_16x16x32_bf16 a[108:111], v[56:59], v[120:123], a[108:111]
    s_add_u32 m0, s69, 65536
    ds_read_b64_tr_b16 v[50:51], v14 offset:1024
    ds_read_b64_tr_b16 v[52:53], v14 offset:8192
    v_mfma_f32_16x16x32_bf16 a[108:111], v[60:63], v[124:127], a[108:111]
    buffer_load_dwordx4 v2, s[24:27], s60 offen lds
    v_mfma_f32_16x16x32_bf16 a[112:115], v[40:43], v[96:99], a[112:115]
    ds_read_b64_tr_b16 v[54:55], v14 offset:9216
    ds_read_b64_tr_b16 v[56:57], v15 offset:0
    v_mfma_f32_16x16x32_bf16 a[112:115], v[44:47], v[100:103], a[112:115]
    ds_read_b64_tr_b16 v[58:59], v15 offset:1024
    ds_read_b64_tr_b16 v[60:61], v15 offset:8192
    v_mfma_f32_16x16x32_bf16 a[116:119], v[40:43], v[104:107], a[116:119]
    ds_read_b64_tr_b16 v[62:63], v15 offset:9216
    ds_read_b128 a[136:139], v22 offset:0
    v_mfma_f32_16x16x32_bf16 a[116:119], v[44:47], v[108:111], a[116:119]
    ds_read_b128 a[140:143], v23 offset:0
    v_add_u32 v14, 0xfffe0000, v14
    v_mfma_f32_16x16x32_bf16 a[120:123], v[40:43], v[112:115], a[120:123]
    v_add_u32 v15, 0xfffe0000, v15
    v_add_u32 v22, 0x10000, v22
    v_mfma_f32_16x16x32_bf16 a[120:123], v[44:47], v[116:119], a[120:123]
    buffer_load_dwordx4 v3, s[24:27], s60 offen offset:1024 lds
    v_mfma_f32_16x16x32_bf16 a[124:127], v[40:43], v[120:123], a[124:127]
    ds_read_b64_tr_b16 v[40:41], v16 offset:0
    ds_read_b64_tr_b16 v[42:43], v16 offset:1024
    v_mfma_f32_16x16x32_bf16 a[124:127], v[44:47], v[124:127], a[124:127]
    s_waitcnt lgkmcnt(3)
    ds_read_b64_tr_b16 v[44:45], v16 offset:8192
    ds_read_b64_tr_b16 v[46:47], v16 offset:9216
    v_mfma_f32_16x16x32_bf16 v[128:131], v[48:51], v[64:67], v[128:131]
    v_add_u32 v16, 0xfffe0000, v16
    v_add_u32 v23, 0x10000, v23
    v_mfma_f32_16x16x32_bf16 v[128:131], v[52:55], v[68:71], v[128:131]
    v_add_u32 v24, 0x10000, v24
    v_accvgpr_read_b32 v32, a240
    v_mfma_f32_16x16x32_bf16 v[132:135], v[48:51], v[72:75], v[132:135]
    ds_read_b128 v[96:99], v24 offset:16384
    v_accvgpr_read_b32 v31, a241
    v_mfma_f32_16x16x32_bf16 v[132:135], v[52:55], v[76:79], v[132:135]
    v_cvt_pk_bf16_f32 v32, v32, v31
    v_accvgpr_read_b32 v33, a242
    v_mfma_f32_16x16x32_bf16 v[136:139], v[48:51], v[80:83], v[136:139]
    v_accvgpr_read_b32 v31, a243
    v_cvt_pk_bf16_f32 v33, v33, v31
    v_mfma_f32_16x16x32_bf16 v[136:139], v[52:55], v[84:87], v[136:139]
    s_add_u32 s72, s71, 38912
    buffer_load_dwordx4 v4, s[24:27], s60 offen offset:2048 lds
    v_mfma_f32_16x16x32_bf16 v[140:143], v[48:51], v[88:91], v[140:143]
    ds_read_b64_tr_b16 v[48:49], v17 offset:0
    ds_read_b64_tr_b16 v[50:51], v17 offset:1024
    v_mfma_f32_16x16x32_bf16 v[140:143], v[52:55], v[92:95], v[140:143]
    ds_read_b64_tr_b16 v[52:53], v17 offset:8192
    ds_read_b64_tr_b16 v[54:55], v17 offset:9216
    v_mfma_f32_16x16x32_bf16 v[144:147], v[56:59], v[64:67], v[144:147]
    v_add_u32 v17, 0xfffe0000, v17
    v_accvgpr_read_b32 v34, a244
    v_mfma_f32_16x16x32_bf16 v[144:147], v[60:63], v[68:71], v[144:147]
    v_accvgpr_read_b32 v31, a245
    v_cvt_pk_bf16_f32 v34, v34, v31
    v_mfma_f32_16x16x32_bf16 v[148:151], v[56:59], v[72:75], v[148:151]
    v_accvgpr_read_b32 v35, a246
    v_accvgpr_read_b32 v31, a247
    v_mfma_f32_16x16x32_bf16 v[148:151], v[60:63], v[76:79], v[148:151]
    v_cvt_pk_bf16_f32 v35, v35, v31
    v_mov_b32 v2, v1
    v_mfma_f32_16x16x32_bf16 v[152:155], v[56:59], v[80:83], v[152:155]
    buffer_load_dwordx4 v5, s[24:27], s60 offen offset:3072 lds
    v_mfma_f32_16x16x32_bf16 v[152:155], v[60:63], v[84:87], v[152:155]
    v_add_u32 v25, 0x10000, v25
    ds_read_b128 v[100:103], v25 offset:16384
    v_mfma_f32_16x16x32_bf16 v[156:159], v[56:59], v[88:91], v[156:159]
    ds_read_b64_tr_b16 v[56:57], v18 offset:0
    ds_read_b64_tr_b16 v[58:59], v18 offset:1024
    v_mfma_f32_16x16x32_bf16 v[156:159], v[60:63], v[92:95], v[156:159]
    s_waitcnt lgkmcnt(3)
    ds_read_b64_tr_b16 v[60:61], v18 offset:8192
    ds_read_b64_tr_b16 v[62:63], v18 offset:9216
    v_mfma_f32_16x16x32_bf16 v[160:163], v[40:43], v[64:67], v[160:163]
    buffer_store_dwordx4 v[32:35], v1, s[36:39], s72 offen sc1
    v_mfma_f32_16x16x32_bf16 v[160:163], v[44:47], v[68:71], v[160:163]
    v_add_u32 v18, 0xfffe0000, v18
    v_mfma_f32_16x16x32_bf16 v[164:167], v[40:43], v[72:75], v[164:167]
    v_mfma_f32_16x16x32_bf16 v[164:167], v[44:47], v[76:79], v[164:167]
    s_add_u32 m0, s69, 81920
    v_accvgpr_read_b32 v32, a248
    v_accvgpr_read_b32 v31, a249
    v_mfma_f32_16x16x32_bf16 v[168:171], v[40:43], v[80:83], v[168:171]
    s_xor_b32 s60, s60, 524288
    buffer_load_dwordx4 v10, s[20:23], s64 offen lds
    v_mfma_f32_16x16x32_bf16 v[168:171], v[44:47], v[84:87], v[168:171]
    s_mov_b32 s60, 131072
    v_cvt_pk_bf16_f32 v32, v32, v31
    v_accvgpr_read_b32 v33, a250
    v_mfma_f32_16x16x32_bf16 v[172:175], v[40:43], v[88:91], v[172:175]
    ds_read_b64_tr_b16 v[40:41], v19 offset:0
    ds_read_b64_tr_b16 v[42:43], v19 offset:1024
    v_mfma_f32_16x16x32_bf16 v[172:175], v[44:47], v[92:95], v[172:175]
    ds_read_b64_tr_b16 v[44:45], v19 offset:8192
    ds_read_b64_tr_b16 v[46:47], v19 offset:9216
    v_mfma_f32_16x16x32_bf16 v[176:179], v[48:51], v[64:67], v[176:179]
    ds_read_b128 v[104:107], v24 offset:24576
    v_add_u32 v19, 0xfffe0000, v19
    v_mfma_f32_16x16x32_bf16 v[176:179], v[52:55], v[68:71], v[176:179]
    v_accvgpr_read_b32 v31, a251
    v_cvt_pk_bf16_f32 v33, v33, v31
    v_mfma_f32_16x16x32_bf16 v[180:183], v[48:51], v[72:75], v[180:183]
    v_accvgpr_read_b32 v34, a252
    v_accvgpr_read_b32 v31, a253
    v_mfma_f32_16x16x32_bf16 v[180:183], v[52:55], v[76:79], v[180:183]
    buffer_load_dwordx4 v11, s[20:23], s64 offen offset:1024 lds
    v_mfma_f32_16x16x32_bf16 v[184:187], v[48:51], v[80:83], v[184:187]
    v_cvt_pk_bf16_f32 v34, v34, v31
    v_accvgpr_read_b32 v35, a254
    v_mfma_f32_16x16x32_bf16 v[184:187], v[52:55], v[84:87], v[184:187]
    v_accvgpr_read_b32 v31, a255
    v_cvt_pk_bf16_f32 v35, v35, v31
    v_mfma_f32_16x16x32_bf16 v[188:191], v[48:51], v[88:91], v[188:191]
    s_add_u32 s72, s71, 39936
    ds_read_b64_tr_b16 v[48:49], v20 offset:0
    ds_read_b64_tr_b16 v[50:51], v20 offset:1024
    v_mfma_f32_16x16x32_bf16 v[188:191], v[52:55], v[92:95], v[188:191]
    s_waitcnt lgkmcnt(2)
    ds_read_b64_tr_b16 v[52:53], v20 offset:8192
    ds_read_b64_tr_b16 v[54:55], v20 offset:9216
    v_mfma_f32_16x16x32_bf16 v[192:195], v[56:59], v[64:67], v[192:195]
    v_mov_b32 v31, 1
    v_add_u32 v20, 0xfffe0000, v20
    v_mfma_f32_16x16x32_bf16 v[192:195], v[60:63], v[68:71], v[192:195]
    buffer_store_dwordx4 v[32:35], v1, s[36:39], s72 offen sc1
    v_mfma_f32_16x16x32_bf16 v[196:199], v[56:59], v[72:75], v[196:199]
    v_add_u32 v11, s99, v39
    v_mfma_f32_16x16x32_bf16 v[196:199], v[60:63], v[76:79], v[196:199]
    s_mul_i32 s99, s98, 6
    buffer_load_dwordx4 v12, s[20:23], s64 offen offset:2048 lds
    v_mfma_f32_16x16x32_bf16 v[200:203], v[56:59], v[80:83], v[200:203]
    s_sub_u32 s99, s8, s99
    ds_read_b128 v[108:111], v25 offset:24576
    v_mfma_f32_16x16x32_bf16 v[200:203], v[60:63], v[84:87], v[200:203]
    s_mul_i32 s99, s99, 6
    v_mfma_f32_16x16x32_bf16 v[204:207], v[56:59], v[88:91], v[204:207]
    s_lshr_b32 s8, s5, 3
    ds_read_b64_tr_b16 v[56:57], v21 offset:0
    ds_read_b64_tr_b16 v[58:59], v21 offset:1024
    v_mfma_f32_16x16x32_bf16 v[204:207], v[60:63], v[92:95], v[204:207]
    s_lshl1_add_u32 s99, s4, s99
    ds_read_b64_tr_b16 v[60:61], v21 offset:8192
    ds_read_b64_tr_b16 v[62:63], v21 offset:9216
    v_mfma_f32_16x16x32_bf16 v[208:211], v[40:43], v[64:67], v[208:211]
    s_mul_i32 s8, s8, 6
    v_add_u32 v21, 0xfffe0000, v21
    v_mfma_f32_16x16x32_bf16 v[208:211], v[44:47], v[68:71], v[208:211]
    s_cmp_lt_u32 s98, 6
    s_cselect_b32 s98, s98, 40
    v_mfma_f32_16x16x32_bf16 v[212:215], v[40:43], v[72:75], v[212:215]
    s_sub_u32 s99, s99, 2
    buffer_load_dwordx4 v13, s[20:23], s64 offen offset:3072 lds
    v_mfma_f32_16x16x32_bf16 v[212:215], v[44:47], v[76:79], v[212:215]
    s_add_u32 s98, s98, s8
    v_mfma_f32_16x16x32_bf16 v[216:219], v[40:43], v[80:83], v[216:219]
    s_lshl_b32 s8, s99, 5
    v_lshl_add_u32 v10, v38, 4, s8
    v_lshrrev_b32 v38, 2, v37
    v_mfma_f32_16x16x32_bf16 v[216:219], v[44:47], v[84:87], v[216:219]
    s_lshr_b32 s99, s99, 1
    v_lshl_add_u32 v38, s98, 2, v38
    v_mul_u32_u24 v39, 171, v38
    v_mfma_f32_16x16x32_bf16 v[220:223], v[40:43], v[88:91], v[220:223]
    s_add_u32 s98, s98, 128
    ds_read_b64_tr_b16 v[40:41], v26 offset:0
    ds_read_b64_tr_b16 v[42:43], v26 offset:512
    v_mfma_f32_16x16x32_bf16 v[220:223], v[44:47], v[92:95], v[220:223]
    s_add_u32 s8, s100, 16
    ds_read_b64_tr_b16 v[44:45], v26 offset:4096
    ds_read_b64_tr_b16 v[46:47], v26 offset:4608
    s_waitcnt lgkmcnt(4)
    v_mfma_f32_16x16x32_bf16 v[224:227], v[48:51], v[64:67], v[224:227]
    v_add_u32 v26, 0x10000, v26
    v_and_b32 v37, 3, v37
    v_mfma_f32_16x16x32_bf16 v[224:227], v[52:55], v[68:71], v[224:227]
    s_xor_b32 s64, s64, 128
    v_lshrrev_b32 v39, 9, v39
    v_lshl_add_u32 v37, v38, 3, v37
    v_mfma_f32_16x16x32_bf16 v[228:231], v[48:51], v[72:75], v[228:231]
    v_mul_u32_u24 v38, 24, v39
    v_sub_u32 v37, v37, v38
    v_mfma_f32_16x16x32_bf16 v[228:231], v[52:55], v[76:79], v[228:231]
    v_mad_u32_u24 v39, v39, 18, v37
    v_mul_u32_u24 v39, 1152, v39
    v_mfma_f32_16x16x32_bf16 v[232:235], v[48:51], v[80:83], v[232:235]
    v_add_u32 v39, v39, v10
    v_add_u32 v12, 0, v39
    v_mfma_f32_16x16x32_bf16 v[232:235], v[52:55], v[84:87], v[232:235]
    s_add_u32 m0, s67, 98304
    v_mov_b32 v38, 1073741824
    v_cmp_gt_u32 vcc, 18, v37
    v_mfma_f32_16x16x32_bf16 v[236:239], v[48:51], v[88:91], v[236:239]
    buffer_load_dwordx4 v1, s[28:31], s65 offen sc1 lds
    v_mfma_f32_16x16x32_bf16 v[236:239], v[52:55], v[92:95], v[236:239]
    ds_read_b64_tr_b16 v[48:49], v27 offset:0
    ds_read_b64_tr_b16 v[50:51], v27 offset:512
    v_mfma_f32_16x16x32_bf16 v[240:243], v[56:59], v[64:67], v[240:243]
    ds_read_b64_tr_b16 v[52:53], v27 offset:4096
    ds_read_b64_tr_b16 v[54:55], v27 offset:4608
    v_mfma_f32_16x16x32_bf16 v[240:243], v[60:63], v[68:71], v[240:243]
    v_add_u32 v27, 0x10000, v27
    v_cndmask_b32 v12, v38, v12, vcc
    v_mfma_f32_16x16x32_bf16 v[244:247], v[56:59], v[72:75], v[244:247]
    v_add_u32 v38, 1024, v36
    v_add_u32 v13, 4608, v39
    v_mfma_f32_16x16x32_bf16 v[244:247], v[60:63], v[76:79], v[244:247]
    s_cmp_eq_u32 s4, 0
    s_cselect_b64 vcc, -1, 0
    v_cndmask_b32 v12, v12, v38, vcc
    v_mfma_f32_16x16x32_bf16 v[248:251], v[56:59], v[80:83], v[248:251]
    v_mov_b32 v38, 1073741824
    v_cmp_gt_u32 vcc, 14, v37
    v_mfma_f32_16x16x32_bf16 v[248:251], v[60:63], v[84:87], v[248:251]
    v_lshrrev_b32 v37, 8, v1
    v_cndmask_b32 v13, v38, v13, vcc
    v_mfma_f32_16x16x32_bf16 v[252:255], v[56:59], v[88:91], v[252:255]
    ds_read_b64_tr_b16 v[56:57], v28 offset:0
    ds_read_b64_tr_b16 v[58:59], v28 offset:512
    v_mfma_f32_16x16x32_bf16 v[252:255], v[60:63], v[92:95], v[252:255]
    s_waitcnt lgkmcnt(2)
    ds_read_b64_tr_b16 v[60:61], v28 offset:4096
    ds_read_b64_tr_b16 v[62:63], v28 offset:4608
    v_mfma_f32_16x16x32_bf16 a[64:67], v[40:43], v[64:67], a[64:67]
    buffer_load_dwordx4 v1, s[28:31], s65 offen offset:1024 sc1 lds
    v_mfma_f32_16x16x32_bf16 a[64:67], v[44:47], v[68:71], a[64:67]
    v_add_u32 v24, 0xfffe0000, v24
    v_add_u32 v28, 0x10000, v28
    v_mfma_f32_16x16x32_bf16 a[68:71], v[40:43], v[72:75], a[68:71]
    ds_read_b128 v[112:115], v24 offset:16384
    v_add_u32 v38, 19456, v36
    v_mfma_f32_16x16x32_bf16 a[68:71], v[44:47], v[76:79], a[68:71]
    s_cmp_eq_u32 s4, 0
    s_cselect_b64 vcc, -1, 0
    v_cndmask_b32 v13, v13, v38, vcc
    v_mfma_f32_16x16x32_bf16 a[72:75], v[40:43], v[80:83], a[72:75]
    s_cmp_eq_u32 s4, 0
    s_cselect_b32 s98, s7, s98
    s_cselect_b32 s99, s8, s99
    v_mfma_f32_16x16x32_bf16 a[72:75], v[44:47], v[84:87], a[72:75]
    s_lshr_b32 s9, s99, 2
    v_add_u32 v25, 0xfffe0000, v25
    v_bfe_u32 v36, v1, 4, 4
    v_mfma_f32_16x16x32_bf16 a[76:79], v[40:43], v[88:91], a[76:79]
    s_lshr_b32 s92, s2, 3
    ds_read_b128 v[116:119], v25 offset:16384
    v_lshrrev_b32 v9, 4, v1
    v_mfma_f32_16x16x32_bf16 a[76:79], v[44:47], v[92:95], a[76:79]
    s_lshl2_add_u32 s92, s92, s4
    v_min_u32 v9, 0, v9
    v_lshlrev_b32 v37, 2, v37
    v_mfma_f32_16x16x32_bf16 a[128:131], v[40:43], a[136:139], a[128:131]
    s_mul_i32 s92, s92, 1
    ds_read_b64_tr_b16 v[40:41], v29 offset:0
    ds_read_b64_tr_b16 v[42:43], v29 offset:512
    v_mfma_f32_16x16x32_bf16 a[128:131], v[44:47], a[140:143], a[128:131]
    s_add_u32 s92, s92, 32
    v_add_lshl_u32 v9, v9, s92, 7
    ds_read_b64_tr_b16 v[44:45], v29 offset:4096
    v_mfma_f32_16x16x32_bf16 a[80:83], v[48:51], v[64:67], a[80:83]
    s_add_u32 m0, s68, 106496
    ds_read_b128 v[120:123], v24 offset:24576
    ds_read_b64_tr_b16 v[46:47], v29 offset:4608
    v_mfma_f32_16x16x32_bf16 a[80:83], v[52:55], v[68:71], a[80:83]
    s_getpc_b64 s[92:93]
    global_load_dword v9, v9, s[92:93]
    v_mfma_f32_16x16x32_bf16 a[84:87], v[48:51], v[72:75], a[84:87]
    s_sub_u32 s9, s9, s10
    buffer_load_dwordx4 v6, s[20:23], s66 offen lds
    v_mfma_f32_16x16x32_bf16 a[84:87], v[52:55], v[76:79], a[84:87]
    s_sub_u32 s9, s9, 1
    v_add_u32 v29, 0x10000, v29
    v_sub_u32 v36, v36, v37
    v_mfma_f32_16x16x32_bf16 a[88:91], v[48:51], v[80:83], a[88:91]
    s_and_b32 s9, s9, 3
    ds_read_b128 v[124:127], v25 offset:24576
    v_mov_b32 v37, 0xf149f2ca
    v_mfma_f32_16x16x32_bf16 a[88:91], v[52:55], v[84:87], a[88:91]
    s_lshl_b32 s9, s9, 1
    v_bfe_u32 v38, v1, 4, 2
    v_and_b32 v39, 0x40, v1
    v_mfma_f32_16x16x32_bf16 a[92:95], v[48:51], v[88:91], a[92:95]
    s_and_b32 s10, s99, 3
    v_mfma_f32_16x16x32_bf16 a[92:95], v[52:55], v[92:95], a[92:95]
    s_cmp_eq_u32 s9, 6
    s_cselect_b32 s9, 7, s9
    v_mfma_f32_16x16x32_bf16 a[132:135], v[48:51], a[136:139], a[132:135]
    s_mul_i32 s10, s10, 9
    v_mfma_f32_16x16x32_bf16 a[132:135], v[52:55], a[140:143], a[132:135]
    s_add_u32 s9, s9, s10
    s_waitcnt lgkmcnt(0)
    v_mfma_f32_16x16x32_bf16 a[96:99], v[56:59], v[64:67], a[96:99]
    s_lshl_b32 s64, s9, 10
    v_mfma_f32_16x16x32_bf16 a[96:99], v[60:63], v[68:71], a[96:99]
    s_xor_b32 s65, s65, 122880
    v_mfma_f32_16x16x32_bf16 a[100:103], v[56:59], v[72:75], a[100:103]
    s_xor_b32 s66, s66, 1920
    v_mfma_f32_16x16x32_bf16 a[100:103], v[60:63], v[76:79], a[100:103]
    s_andn2_b32 s65, s65, 57344
    v_mfma_f32_16x16x32_bf16 a[104:107], v[56:59], v[80:83], a[104:107]
    s_andn2_b32 s66, s66, 896
    v_mfma_f32_16x16x32_bf16 a[104:107], v[60:63], v[84:87], a[104:107]
    s_waitcnt vmcnt(4) lgkmcnt(0)
    s_barrier
    ds_read_b64_tr_b16 v[48:49], v14 offset:32768
    v_mfma_f32_16x16x32_bf16 a[108:111], v[56:59], v[88:91], a[108:111]
    s_add_u32 m0, s67, 131072
    buffer_store_dword v31, v30, s[32:35], s101 offen sc1
    v_mfma_f32_16x16x32_bf16 a[108:111], v[60:63], v[92:95], a[108:111]
    s_sub_u32 s9, s99, 16
    buffer_load_dwordx4 v1, s[28:31], s65 offen sc1 lds
    v_mfma_f32_16x16x32_bf16 a[112:115], v[40:43], v[64:67], a[112:115]
    s_mul_i32 s9, s9, 18432
    ds_read_b64_tr_b16 v[50:51], v14 offset:33792
    ds_read_b64_tr_b16 v[52:53], v14 offset:40960
    v_mfma_f32_16x16x32_bf16 a[112:115], v[44:47], v[68:71], a[112:115]
    s_add_u32 s9, s9, 6144
    ds_read_b64_tr_b16 v[54:55], v14 offset:41984
    ds_read_b64_tr_b16 v[56:57], v15 offset:32768
    v_mfma_f32_16x16x32_bf16 a[116:119], v[40:43], v[72:75], a[116:119]
    s_mov_b32 s10, 1024
    ds_read_b64_tr_b16 v[58:59], v15 offset:33792
    ds_read_b64_tr_b16 v[60:61], v15 offset:40960
    v_mfma_f32_16x16x32_bf16 a[116:119], v[44:47], v[76:79], a[116:119]
    s_mul_i32 s98, s98, 36864
    ds_read_b64_tr_b16 v[62:63], v15 offset:41984
    v_add_u32 v14, 0x10000, v14
    v_mfma_f32_16x16x32_bf16 a[120:123], v[40:43], v[80:83], a[120:123]
    s_mul_i32 s7, s7, 36864
    v_add_u32 v15, 0x10000, v15
    v_mfma_f32_16x16x32_bf16 a[120:123], v[44:47], v[84:87], a[120:123]
    s_cmp_lt_u32 s99, 16
    s_cselect_b32 s64, s64, s9
    s_cselect_b32 s10, s10, 9216
    v_mfma_f32_16x16x32_bf16 a[124:127], v[40:43], v[88:91], a[124:127]
    s_lshl2_add_u32 s99, s100, s4
    ds_read_b64_tr_b16 v[40:41], v16 offset:32768
    ds_read_b64_tr_b16 v[42:43], v16 offset:33792
    v_mfma_f32_16x16x32_bf16 a[124:127], v[44:47], v[92:95], a[124:127]
    s_add_u32 s64, s64, s98
    ds_read_b64_tr_b16 v[44:45], v16 offset:40960
    ds_read_b64_tr_b16 v[46:47], v16 offset:41984
    s_waitcnt lgkmcnt(5)
    v_mfma_f32_16x16x32_bf16 v[128:131], v[48:51], v[96:99], v[128:131]
    s_lshl_b32 s99, s99, 1
    v_add_u32 v16, 0x10000, v16
    v_mfma_f32_16x16x32_bf16 v[128:131], v[52:55], v[100:103], v[128:131]
    s_add_u32 s62, s64, s10
    v_mfma_f32_16x16x32_bf16 v[132:135], v[48:51], v[104:107], v[132:135]
    s_lshr_b32 s9, s99, 2
    ds_read_b128 v[64:67], v24 offset:49152
    v_mfma_f32_16x16x32_bf16 v[132:135], v[52:55], v[108:111], v[132:135]
    s_lshr_b32 s10, s5, 3
    v_mfma_f32_16x16x32_bf16 v[136:139], v[48:51], v[112:115], v[136:139]
    s_sub_u32 s9, s9, s10
    v_mfma_f32_16x16x32_bf16 v[136:139], v[52:55], v[116:119], v[136:139]
    s_sub_u32 s9, s9, 1
    v_mfma_f32_16x16x32_bf16 v[140:143], v[48:51], v[120:123], v[140:143]
    s_and_b32 s9, s9, 3
    ds_read_b64_tr_b16 v[48:49], v17 offset:32768
    ds_read_b64_tr_b16 v[50:51], v17 offset:33792
    v_mfma_f32_16x16x32_bf16 v[140:143], v[52:55], v[124:127], v[140:143]
    s_lshl_b32 s9, s9, 1
    ds_read_b64_tr_b16 v[52:53], v17 offset:40960
    ds_read_b64_tr_b16 v[54:55], v17 offset:41984
    v_mfma_f32_16x16x32_bf16 v[144:147], v[56:59], v[96:99], v[144:147]
    s_and_b32 s10, s99, 3
    ds_read_b128 v[68:71], v25 offset:49152
    v_add_u32 v17, 0x10000, v17
    s_waitcnt lgkmcnt(5)
    v_mfma_f32_16x16x32_bf16 v[144:147], v[60:63], v[100:103], v[144:147]
    s_cmp_eq_u32 s9, 6
    s_cselect_b32 s9, 7, s9
    v_mfma_f32_16x16x32_bf16 v[148:151], v[56:59], v[104:107], v[148:151]
    s_mul_i32 s10, s10, 9
    buffer_load_dwordx4 v1, s[28:31], s65 offen offset:1024 sc1 lds
    v_mfma_f32_16x16x32_bf16 v[148:151], v[60:63], v[108:111], v[148:151]
    s_add_u32 s9, s9, s10
    v_mfma_f32_16x16x32_bf16 v[152:155], v[56:59], v[112:115], v[152:155]
    s_lshl_b32 s63, s9, 10
    v_mfma_f32_16x16x32_bf16 v[152:155], v[60:63], v[116:119], v[152:155]
    s_cmp_eq_u32 s4, 0
    s_cselect_b32 s8, 1.0, 0
    v_mfma_f32_16x16x32_bf16 v[156:159], v[56:59], v[120:123], v[156:159]
    s_add_u32 s63, s63, s7
    ds_read_b128 v[72:75], v24 offset:57344
    ds_read_b64_tr_b16 v[56:57], v18 offset:32768
    v_mfma_f32_16x16x32_bf16 v[156:159], v[60:63], v[124:127], v[156:159]
    ds_read_b64_tr_b16 v[58:59], v18 offset:33792
    ds_read_b64_tr_b16 v[60:61], v18 offset:40960
    v_mfma_f32_16x16x32_bf16 v[160:163], v[40:43], v[96:99], v[160:163]
    ds_read_b64_tr_b16 v[62:63], v18 offset:41984
    v_add_u32 v18, 0x10000, v18
    v_mfma_f32_16x16x32_bf16 v[160:163], v[44:47], v[100:103], v[160:163]
    s_cmp_eq_u32 s4, 1
    s_cselect_b32 s9, 1.0, 0
    v_mfma_f32_16x16x32_bf16 v[164:167], v[40:43], v[104:107], v[164:167]
    s_cmp_eq_u32 s6, 0
    s_cselect_b32 s16, s8, 0
    s_cselect_b32 s17, s9, 0
    v_mfma_f32_16x16x32_bf16 v[164:167], v[44:47], v[108:111], v[164:167]
    s_cmp_eq_u32 s4, 2
    s_cselect_b32 s10, 1.0, 0
    v_mfma_f32_16x16x32_bf16 v[168:171], v[40:43], v[112:115], v[168:171]
    ds_read_b128 v[76:79], v25 offset:57344
    v_mfma_f32_16x16x32_bf16 v[168:171], v[44:47], v[116:119], v[168:171]
    s_cmp_eq_u32 s6, 0
    s_cselect_b32 s18, s10, 0
    s_cselect_b32 s19, s11, 0
    v_mfma_f32_16x16x32_bf16 v[172:175], v[40:43], v[120:123], v[172:175]
    ds_read_b64_tr_b16 v[40:41], v19 offset:32768
    ds_read_b64_tr_b16 v[42:43], v19 offset:33792
    v_mfma_f32_16x16x32_bf16 v[172:175], v[44:47], v[124:127], v[172:175]
    s_waitcnt lgkmcnt(3)
    ds_read_b64_tr_b16 v[44:45], v19 offset:40960
    ds_read_b64_tr_b16 v[46:47], v19 offset:41984
    v_mfma_f32_16x16x32_bf16 v[176:179], v[48:51], v[96:99], v[176:179]
    v_add_u32 v19, 0x10000, v19
    v_mfma_f32_16x16x32_bf16 v[176:179], v[52:55], v[100:103], v[176:179]
    v_mfma_f32_16x16x32_bf16 v[180:183], v[48:51], v[104:107], v[180:183]
    v_mfma_f32_16x16x32_bf16 v[180:183], v[52:55], v[108:111], v[180:183]
    v_add_u32 v24, 0x10000, v24
    v_mfma_f32_16x16x32_bf16 v[184:187], v[48:51], v[112:115], v[184:187]
    ds_read_b128 v[80:83], v24 offset:16384
    v_mfma_f32_16x16x32_bf16 v[184:187], v[52:55], v[116:119], v[184:187]
    s_add_u32 m0, s68, 139264
    v_mfma_f32_16x16x32_bf16 v[188:191], v[48:51], v[120:123], v[188:191]
    buffer_load_dwordx4 v6, s[20:23], s66 offen lds
    v_mfma_f32_16x16x32_bf16 v[188:191], v[52:55], v[124:127], v[188:191]
    ds_read_b64_tr_b16 v[48:49], v20 offset:32768
    ds_read_b64_tr_b16 v[50:51], v20 offset:33792
    v_mfma_f32_16x16x32_bf16 v[192:195], v[56:59], v[96:99], v[192:195]
    ds_read_b64_tr_b16 v[52:53], v20 offset:40960
    ds_read_b64_tr_b16 v[54:55], v20 offset:41984
    v_mfma_f32_16x16x32_bf16 v[192:195], v[60:63], v[100:103], v[192:195]
    v_add_u32 v25, 0x10000, v25
    v_add_u32 v20, 0x10000, v20
    v_mfma_f32_16x16x32_bf16 v[196:199], v[56:59], v[104:107], v[196:199]
    ds_read_b128 v[84:87], v25 offset:16384
    v_mfma_f32_16x16x32_bf16 v[196:199], v[60:63], v[108:111], v[196:199]
    s_cmp_eq_u32 s6, 0
    s_cselect_b32 s20, s12, 0
    s_cselect_b32 s21, s13, 0
    v_mfma_f32_16x16x32_bf16 v[200:203], v[56:59], v[112:115], v[200:203]
    s_cmp_eq_u32 s6, 0
    s_cselect_b32 s22, s14, 0
    s_cselect_b32 s23, s15, 0
    v_mfma_f32_16x16x32_bf16 v[200:203], v[60:63], v[116:119], v[200:203]
    v_mfma_f32_16x16x32_bf16 v[204:207], v[56:59], v[120:123], v[204:207]
    ds_read_b64_tr_b16 v[56:57], v21 offset:32768
    ds_read_b64_tr_b16 v[58:59], v21 offset:33792
    v_mfma_f32_16x16x32_bf16 v[204:207], v[60:63], v[124:127], v[204:207]
    s_waitcnt lgkmcnt(2)
    ds_read_b64_tr_b16 v[60:61], v21 offset:40960
    ds_read_b64_tr_b16 v[62:63], v21 offset:41984
    v_mfma_f32_16x16x32_bf16 v[208:211], v[40:43], v[96:99], v[208:211]
    ds_read_b128 v[88:91], v24 offset:24576
    v_add_u32 v21, 0x10000, v21
    v_mfma_f32_16x16x32_bf16 v[208:211], v[44:47], v[100:103], v[208:211]
    v_mfma_f32_16x16x32_bf16 v[212:215], v[40:43], v[104:107], v[212:215]
    v_mfma_f32_16x16x32_bf16 v[212:215], v[44:47], v[108:111], v[212:215]
    v_mfma_f32_16x16x32_bf16 v[216:219], v[40:43], v[112:115], v[216:219]
    v_mfma_f32_16x16x32_bf16 v[216:219], v[44:47], v[116:119], v[216:219]
    v_mfma_f32_16x16x32_bf16 v[220:223], v[40:43], v[120:123], v[220:223]
    ds_read_b128 v[92:95], v25 offset:24576
    ds_read_b64_tr_b16 v[40:41], v14 offset:0
    v_mfma_f32_16x16x32_bf16 v[220:223], v[44:47], v[124:127], v[220:223]
    ds_read_b64_tr_b16 v[42:43], v14 offset:1024
    ds_read_b64_tr_b16 v[44:45], v14 offset:8192
    v_mfma_f32_16x16x32_bf16 v[224:227], v[48:51], v[96:99], v[224:227]
    ds_read_b64_tr_b16 v[46:47], v14 offset:9216
    v_mfma_f32_16x16x32_bf16 v[224:227], v[52:55], v[100:103], v[224:227]
    s_xor_b32 s65, s65, 8192
    v_mfma_f32_16x16x32_bf16 v[228:231], v[48:51], v[104:107], v[228:231]
    s_xor_b32 s66, s66, 128
    v_mfma_f32_16x16x32_bf16 v[228:231], v[52:55], v[108:111], v[228:231]
    v_mfma_f32_16x16x32_bf16 v[232:235], v[48:51], v[112:115], v[232:235]
    v_mfma_f32_16x16x32_bf16 v[232:235], v[52:55], v[116:119], v[232:235]
    v_mfma_f32_16x16x32_bf16 v[236:239], v[48:51], v[120:123], v[236:239]
    ds_read_b64_tr_b16 v[48:49], v15 offset:0
    ds_read_b64_tr_b16 v[50:51], v15 offset:1024
    v_mfma_f32_16x16x32_bf16 v[236:239], v[52:55], v[124:127], v[236:239]
    s_waitcnt lgkmcnt(2)
    ds_read_b64_tr_b16 v[52:53], v15 offset:8192
    ds_read_b64_tr_b16 v[54:55], v15 offset:9216
    v_mfma_f32_16x16x32_bf16 v[240:243], v[56:59], v[96:99], v[240:243]
    v_mfma_f32_16x16x32_bf16 v[240:243], v[60:63], v[100:103], v[240:243]
    v_mfma_f32_16x16x32_bf16 v[244:247], v[56:59], v[104:107], v[244:247]
    v_mfma_f32_16x16x32_bf16 v[244:247], v[60:63], v[108:111], v[244:247]
    v_mfma_f32_16x16x32_bf16 v[248:251], v[56:59], v[112:115], v[248:251]
    v_mfma_f32_16x16x32_bf16 v[248:251], v[60:63], v[116:119], v[248:251]
    v_mfma_f32_16x16x32_bf16 v[252:255], v[56:59], v[120:123], v[252:255]
    ds_read_b64_tr_b16 v[56:57], v16 offset:0
    ds_read_b64_tr_b16 v[58:59], v16 offset:1024
    v_mfma_f32_16x16x32_bf16 v[252:255], v[60:63], v[124:127], v[252:255]
    buffer_load_dword v7, v8, s[32:35], s61 offen sc1
    v_mfma_f32_16x16x32_bf16 v[128:131], v[40:43], v[64:67], v[128:131]
    ds_read_b64_tr_b16 v[60:61], v16 offset:8192
    ds_read_b64_tr_b16 v[62:63], v16 offset:9216
    v_mfma_f32_16x16x32_bf16 v[128:131], v[44:47], v[68:71], v[128:131]
    v_mfma_f32_16x16x32_bf16 v[132:135], v[40:43], v[72:75], v[132:135]
    v_mfma_f32_16x16x32_bf16 v[132:135], v[44:47], v[76:79], v[132:135]
    v_mfma_f32_16x16x32_bf16 v[136:139], v[40:43], v[80:83], v[136:139]
    v_mfma_f32_16x16x32_bf16 v[136:139], v[44:47], v[84:87], v[136:139]
    v_mfma_f32_16x16x32_bf16 v[140:143], v[40:43], v[88:91], v[140:143]
    ds_read_b64_tr_b16 v[40:41], v17 offset:0
    ds_read_b64_tr_b16 v[42:43], v17 offset:1024
    v_mfma_f32_16x16x32_bf16 v[140:143], v[44:47], v[92:95], v[140:143]
    s_waitcnt lgkmcnt(2)
    ds_read_b64_tr_b16 v[44:45], v17 offset:8192
    ds_read_b64_tr_b16 v[46:47], v17 offset:9216
    v_mfma_f32_16x16x32_bf16 v[144:147], v[48:51], v[64:67], v[144:147]
    v_cvt_pk_bf16_f32 v128, v128, v129
    v_cvt_pk_bf16_f32 v129, v130, v131
    v_mfma_f32_16x16x32_bf16 v[144:147], v[52:55], v[68:71], v[144:147]
    v_cvt_pk_bf16_f32 v132, v132, v133
    v_cvt_pk_bf16_f32 v133, v134, v135
    v_mfma_f32_16x16x32_bf16 v[148:151], v[48:51], v[72:75], v[148:151]
    v_cvt_pk_bf16_f32 v136, v136, v137
    v_cvt_pk_bf16_f32 v137, v138, v139
    v_mfma_f32_16x16x32_bf16 v[148:151], v[52:55], v[76:79], v[148:151]
    v_cvt_pk_bf16_f32 v140, v140, v141
    v_cvt_pk_bf16_f32 v141, v142, v143
    v_mfma_f32_16x16x32_bf16 v[152:155], v[48:51], v[80:83], v[152:155]
    v_cvt_pk_bf16_f32 v130, v144, v145
    v_cvt_pk_bf16_f32 v131, v146, v147
    v_mfma_f32_16x16x32_bf16 v[152:155], v[52:55], v[84:87], v[152:155]
    v_mfma_f32_16x16x32_bf16 v[156:159], v[48:51], v[88:91], v[156:159]
    ds_read_b64_tr_b16 v[48:49], v18 offset:0
    ds_read_b64_tr_b16 v[50:51], v18 offset:1024
    v_mfma_f32_16x16x32_bf16 v[156:159], v[52:55], v[92:95], v[156:159]
    ds_read_b64_tr_b16 v[52:53], v18 offset:8192
    ds_read_b64_tr_b16 v[54:55], v18 offset:9216
    v_mfma_f32_16x16x32_bf16 v[160:163], v[56:59], v[64:67], v[160:163]
    v_cvt_pk_bf16_f32 v134, v148, v149
    v_cvt_pk_bf16_f32 v135, v150, v151
    v_mfma_f32_16x16x32_bf16 v[160:163], v[60:63], v[68:71], v[160:163]
    v_cvt_pk_bf16_f32 v138, v152, v153
    v_cvt_pk_bf16_f32 v139, v154, v155
    v_mfma_f32_16x16x32_bf16 v[164:167], v[56:59], v[72:75], v[164:167]
    v_cvt_pk_bf16_f32 v142, v156, v157
    v_cvt_pk_bf16_f32 v143, v158, v159
    v_mfma_f32_16x16x32_bf16 v[164:167], v[60:63], v[76:79], v[164:167]
    v_mfma_f32_16x16x32_bf16 v[168:171], v[56:59], v[80:83], v[168:171]
    v_mfma_f32_16x16x32_bf16 v[168:171], v[60:63], v[84:87], v[168:171]
    v_cvt_pk_bf16_f32 v160, v160, v161
    v_cvt_pk_bf16_f32 v161, v162, v163
    v_mfma_f32_16x16x32_bf16 v[172:175], v[56:59], v[88:91], v[172:175]
    ds_read_b64_tr_b16 v[56:57], v19 offset:0
    ds_read_b64_tr_b16 v[58:59], v19 offset:1024
    v_mfma_f32_16x16x32_bf16 v[172:175], v[60:63], v[92:95], v[172:175]
    s_waitcnt lgkmcnt(2)
    ds_read_b64_tr_b16 v[60:61], v19 offset:8192
    ds_read_b64_tr_b16 v[62:63], v19 offset:9216
    v_mfma_f32_16x16x32_bf16 v[176:179], v[40:43], v[64:67], v[176:179]
    v_cvt_pk_bf16_f32 v164, v164, v165
    v_cvt_pk_bf16_f32 v165, v166, v167
    v_mfma_f32_16x16x32_bf16 v[176:179], v[44:47], v[68:71], v[176:179]
    v_cvt_pk_bf16_f32 v168, v168, v169
    v_cvt_pk_bf16_f32 v169, v170, v171
    v_mfma_f32_16x16x32_bf16 v[180:183], v[40:43], v[72:75], v[180:183]
    v_cvt_pk_bf16_f32 v172, v172, v173
    v_cvt_pk_bf16_f32 v173, v174, v175
    v_mfma_f32_16x16x32_bf16 v[180:183], v[44:47], v[76:79], v[180:183]
    v_mfma_f32_16x16x32_bf16 v[184:187], v[40:43], v[80:83], v[184:187]
    v_mfma_f32_16x16x32_bf16 v[184:187], v[44:47], v[84:87], v[184:187]
    v_cvt_pk_bf16_f32 v162, v176, v177
    v_cvt_pk_bf16_f32 v163, v178, v179
    v_mfma_f32_16x16x32_bf16 v[188:191], v[40:43], v[88:91], v[188:191]
    ds_read_b64_tr_b16 v[40:41], v20 offset:0
    ds_read_b64_tr_b16 v[42:43], v20 offset:1024
    v_mfma_f32_16x16x32_bf16 v[188:191], v[44:47], v[92:95], v[188:191]
    ds_read_b64_tr_b16 v[44:45], v20 offset:8192
    ds_read_b64_tr_b16 v[46:47], v20 offset:9216
    v_mfma_f32_16x16x32_bf16 v[192:195], v[48:51], v[64:67], v[192:195]
    v_cvt_pk_bf16_f32 v166, v180, v181
    v_cvt_pk_bf16_f32 v167, v182, v183
    v_mfma_f32_16x16x32_bf16 v[192:195], v[52:55], v[68:71], v[192:195]
    v_cvt_pk_bf16_f32 v170, v184, v185
    v_cvt_pk_bf16_f32 v171, v186, v187
    s_waitcnt vmcnt(0)
    v_cmp_gt_u32 vcc, 1, v7
    s_nop 1
    s_and_b64 vcc, vcc, exec
    s_cbranch_scc1 SPIN_KV
BACK_KV:
    v_mfma_f32_16x16x32_bf16 v[196:199], v[48:51], v[72:75], v[196:199]
    s_mov_b32 s77, s75
    buffer_load_dwordx4 a[224:227], v1, s[36:39], 0 offen offset:0 sc1
    v_mfma_f32_16x16x32_bf16 v[196:199], v[52:55], v[76:79], v[196:199]
    buffer_load_dwordx4 a[228:231], v1, s[36:39], 0 offen offset:1024 sc1
    v_mfma_f32_16x16x32_bf16 v[200:203], v[48:51], v[80:83], v[200:203]
    v_cmp_le_i32 vcc, 0, v36
    v_cvt_pk_bf16_f32 v192, v192, v193
    v_mfma_f32_16x16x32_bf16 v[200:203], v[52:55], v[84:87], v[200:203]
    v_cvt_pk_bf16_f32 v193, v194, v195
    v_cvt_pk_bf16_f32 v174, v188, v189
    v_mfma_f32_16x16x32_bf16 v[204:207], v[48:51], v[88:91], v[204:207]
    buffer_load_dwordx4 a[232:235], v1, s[36:39], 0 offen offset:2048 sc1
    v_mfma_f32_16x16x32_bf16 v[204:207], v[52:55], v[92:95], v[204:207]
    s_waitcnt lgkmcnt(0)
    ds_read_b64_tr_b16 v[48:49], v21 offset:0
    ds_read_b64_tr_b16 v[50:51], v21 offset:1024
    v_mfma_f32_16x16x32_bf16 v[208:211], v[56:59], v[64:67], v[208:211]
    ds_read_b64_tr_b16 v[52:53], v21 offset:8192
    ds_read_b64_tr_b16 v[54:55], v21 offset:9216
    v_mfma_f32_16x16x32_bf16 v[208:211], v[60:63], v[68:71], v[208:211]
    v_cvt_pk_bf16_f32 v196, v196, v197
    v_cvt_pk_bf16_f32 v197, v198, v199
    v_mfma_f32_16x16x32_bf16 v[212:215], v[56:59], v[72:75], v[212:215]
    buffer_load_dwordx4 a[236:239], v1, s[36:39], 0 offen offset:3072 sc1
    v_mfma_f32_16x16x32_bf16 v[212:215], v[60:63], v[76:79], v[212:215]
    v_cvt_pk_bf16_f32 v200, v200, v201
    v_cvt_pk_bf16_f32 v201, v202, v203
    v_mfma_f32_16x16x32_bf16 v[216:219], v[56:59], v[80:83], v[216:219]
    v_cvt_pk_bf16_f32 v194, v208, v209
    v_cndmask_b32_e64 v208, v37, 0, vcc
    v_mfma_f32_16x16x32_bf16 v[216:219], v[60:63], v[84:87], v[216:219]
    v_mul_f32 v176, s16, v208
    v_cmp_le_i32 vcc, 1, v36
    v_mfma_f32_16x16x32_bf16 v[220:223], v[56:59], v[88:91], v[220:223]
    v_cvt_pk_bf16_f32 v195, v210, v211
    v_cndmask_b32_e64 v209, v37, 0, vcc
    v_mfma_f32_16x16x32_bf16 v[220:223], v[60:63], v[92:95], v[220:223]
    v_mul_f32 v177, s16, v209
    v_cmp_le_i32 vcc, 2, v36
    v_mfma_f32_16x16x32_bf16 v[224:227], v[40:43], v[64:67], v[224:227]
    s_mov_b32 s38, 16384
    v_cndmask_b32_e64 v210, v37, 0, vcc
    v_mul_f32 v178, s16, v210
    v_mfma_f32_16x16x32_bf16 v[224:227], v[44:47], v[68:71], v[224:227]
    s_add_u32 m0, s76, s75
    v_cmp_le_i32 vcc, 3, v36
    v_cvt_pk_bf16_f32 v198, v212, v213
    v_mfma_f32_16x16x32_bf16 v[228:231], v[40:43], v[72:75], v[228:231]
    buffer_load_dwordx4 v1, s[36:39], s77 offen sc1 lds
    v_mfma_f32_16x16x32_bf16 v[228:231], v[44:47], v[76:79], v[228:231]
    v_cndmask_b32_e64 v211, v37, 0, vcc
    v_mul_f32 v179, s16, v211
    v_mfma_f32_16x16x32_bf16 v[232:235], v[40:43], v[80:83], v[232:235]
    v_cvt_pk_bf16_f32 v224, v224, v225
    v_cvt_pk_bf16_f32 v225, v226, v227
    v_mfma_f32_16x16x32_bf16 v[232:235], v[44:47], v[84:87], v[232:235]
    s_waitcnt vmcnt(6) lgkmcnt(0)
    s_barrier
    ds_read_b64_tr_b16 v[56:57], v26 offset:32768
    v_mfma_f32_16x16x32_bf16 v[236:239], v[40:43], v[88:91], v[236:239]
    buffer_load_dwordx4 v1, s[36:39], s77 offen offset:1024 sc1 lds
    v_mfma_f32_16x16x32_bf16 v[236:239], v[44:47], v[92:95], v[236:239]
    ds_read_b64_tr_b16 v[58:59], v26 offset:33280
    ds_read_b64_tr_b16 v[60:61], v26 offset:36864
    v_mfma_f32_16x16x32_bf16 v[240:243], v[48:51], v[64:67], v[240:243]
    ds_read_b64_tr_b16 v[62:63], v26 offset:37376
    ds_read_b128 a[136:139], v22 offset:32768
    v_mfma_f32_16x16x32_bf16 v[240:243], v[52:55], v[68:71], v[240:243]
    ds_read_b128 a[140:143], v23 offset:32768
    v_add_u32 v26, 0x10000, v26
    v_mfma_f32_16x16x32_bf16 v[244:247], v[48:51], v[72:75], v[244:247]
    buffer_load_dwordx4 v1, s[36:39], s77 offen offset:2048 sc1 lds
    v_mfma_f32_16x16x32_bf16 v[244:247], v[52:55], v[76:79], v[244:247]
    ds_read_b64_tr_b16 v[40:41], v27 offset:32768
    ds_read_b64_tr_b16 v[42:43], v27 offset:33280
    v_mfma_f32_16x16x32_bf16 v[248:251], v[48:51], v[80:83], v[248:251]
    ds_read_b64_tr_b16 v[44:45], v27 offset:36864
    ds_read_b64_tr_b16 v[46:47], v27 offset:37376
    v_mfma_f32_16x16x32_bf16 v[248:251], v[52:55], v[84:87], v[248:251]
    v_add_u32 v22, 0x10000, v22
    v_add_u32 v23, 0x10000, v23
    v_mfma_f32_16x16x32_bf16 v[252:255], v[48:51], v[88:91], v[252:255]
    buffer_load_dwordx4 v1, s[36:39], s77 offen offset:3072 sc1 lds
    v_mfma_f32_16x16x32_bf16 v[252:255], v[52:55], v[92:95], v[252:255]
    s_waitcnt lgkmcnt(4)
    ds_read_b64_tr_b16 v[48:49], v28 offset:32768
    ds_read_b64_tr_b16 v[50:51], v28 offset:33280
    v_mfma_f32_16x16x32_bf16 a[64:67], v[56:59], v[96:99], a[64:67]
    s_add_u32 s100, s77, 4096
    ds_read_b64_tr_b16 v[52:53], v28 offset:36864
    ds_read_b64_tr_b16 v[54:55], v28 offset:37376
    v_mfma_f32_16x16x32_bf16 a[64:67], v[60:63], v[100:103], a[64:67]
    s_add_u32 m0, m0, 4096
    v_add_u32 v27, 0x10000, v27
    v_add_u32 v28, 0x10000, v28
    v_mfma_f32_16x16x32_bf16 a[68:71], v[56:59], v[104:107], a[68:71]
    buffer_load_dwordx4 v1, s[36:39], s100 offen sc1 lds
    v_mfma_f32_16x16x32_bf16 a[68:71], v[60:63], v[108:111], a[68:71]
    v_cvt_pk_bf16_f32 v226, v240, v241
    v_cvt_pk_bf16_f32 v227, v242, v243
    v_mfma_f32_16x16x32_bf16 a[72:75], v[56:59], v[112:115], a[72:75]
    v_cvt_pk_bf16_f32 v228, v228, v229
    v_cvt_pk_bf16_f32 v229, v230, v231
    v_mfma_f32_16x16x32_bf16 a[72:75], v[60:63], v[116:119], a[72:75]
    v_cvt_pk_bf16_f32 v230, v244, v245
    v_cvt_pk_bf16_f32 v231, v246, v247
    v_mfma_f32_16x16x32_bf16 a[76:79], v[56:59], v[120:123], a[76:79]
    buffer_load_dwordx4 v1, s[36:39], s100 offen offset:1024 sc1 lds
    v_mfma_f32_16x16x32_bf16 a[76:79], v[60:63], v[124:127], a[76:79]
    v_cvt_pk_bf16_f32 v199, v214, v215
    v_cvt_pk_bf16_f32 v232, v232, v233
    v_mfma_f32_16x16x32_bf16 a[128:131], v[56:59], a[136:139], a[128:131]
    ds_read_b64_tr_b16 v[56:57], v29 offset:32768
    ds_read_b64_tr_b16 v[58:59], v29 offset:33280
    v_mfma_f32_16x16x32_bf16 a[128:131], v[60:63], a[140:143], a[128:131]
    s_waitcnt lgkmcnt(2)
    ds_read_b64_tr_b16 v[60:61], v29 offset:36864
    ds_read_b64_tr_b16 v[62:63], v29 offset:37376
    v_mfma_f32_16x16x32_bf16 a[80:83], v[40:43], v[96:99], a[80:83]
    buffer_load_dwordx4 v1, s[36:39], s100 offen offset:2048 sc1 lds
    v_mfma_f32_16x16x32_bf16 a[80:83], v[44:47], v[100:103], a[80:83]
    v_add_u32 v29, 0x10000, v29
    v_cvt_pk_bf16_f32 v233, v234, v235
    v_mfma_f32_16x16x32_bf16 a[84:87], v[40:43], v[104:107], a[84:87]
    v_cvt_pk_bf16_f32 v234, v248, v249
    v_cvt_pk_bf16_f32 v235, v250, v251
    v_mfma_f32_16x16x32_bf16 a[84:87], v[44:47], v[108:111], a[84:87]
    v_cvt_pk_bf16_f32 v202, v216, v217
    v_cvt_pk_bf16_f32 v203, v218, v219
    v_mfma_f32_16x16x32_bf16 a[88:91], v[40:43], v[112:115], a[88:91]
    buffer_load_dwordx4 v1, s[36:39], s100 offen offset:3072 sc1 lds
    v_mfma_f32_16x16x32_bf16 a[88:91], v[44:47], v[116:119], a[88:91]
    v_cvt_pk_bf16_f32 v175, v190, v191
    v_cvt_pk_bf16_f32 v236, v236, v237
    v_mfma_f32_16x16x32_bf16 a[92:95], v[40:43], v[120:123], a[92:95]
    s_lshr_b32 s82, s4, 1
    s_add_u32 s82, s82, 32
    v_cvt_pk_bf16_f32 v237, v238, v239
    v_mfma_f32_16x16x32_bf16 a[92:95], v[44:47], v[124:127], a[92:95]
    s_sub_u32 s82, s82, s6
    v_cvt_pk_bf16_f32 v238, v252, v253
    v_cvt_pk_bf16_f32 v239, v254, v255
    v_mfma_f32_16x16x32_bf16 a[132:135], v[40:43], a[136:139], a[132:135]
    s_add_u32 s76, s76, 32768
    s_sub_u32 s82, s82, s6
    ds_read_b64_tr_b16 v[40:41], v26 offset:0
    v_mfma_f32_16x16x32_bf16 a[132:135], v[44:47], a[140:143], a[132:135]
    s_waitcnt vmcnt(8)
    s_add_u32 s77, s77, 32768
    s_lshl_b32 s38, s82, 15
    v_mfma_f32_16x16x32_bf16 v[240:243], a[224:227], v[128:131], v[176:179]
    s_add_u32 m0, s76, s75
    ds_read_b64_tr_b16 v[42:43], v26 offset:512
    ds_read_b64_tr_b16 v[44:45], v26 offset:4096
    v_mfma_f32_16x16x32_bf16 v[240:243], a[228:231], v[160:163], v[240:243]
    s_mov_b32 s82, 0
    buffer_load_dwordx4 v1, s[36:39], s77 offen sc1 lds
    v_mfma_f32_16x16x32_bf16 v[240:243], a[232:235], v[192:195], v[240:243]
    buffer_load_dwordx4 v1, s[36:39], s77 offen offset:1024 sc1 lds
    v_mfma_f32_16x16x32_bf16 v[240:243], a[236:239], v[224:227], v[240:243]
    ds_read_b64_tr_b16 v[46:47], v26 offset:4608
    ds_read_b128 a[136:139], v22 offset:0
    v_mfma_f32_16x16x32_bf16 v[244:247], a[224:227], v[132:135], 0
    ds_read_b128 a[140:143], v23 offset:0
    v_cvt_pk_bf16_f32 v204, v204, v205
    v_mfma_f32_16x16x32_bf16 v[244:247], a[228:231], v[164:167], v[244:247]
    v_cvt_pk_bf16_f32 v205, v206, v207
    v_cvt_pk_bf16_f32 v206, v220, v221
    v_mfma_f32_16x16x32_bf16 v[244:247], a[232:235], v[196:199], v[244:247]
    buffer_load_dwordx4 v1, s[36:39], s77 offen offset:2048 sc1 lds
    v_mfma_f32_16x16x32_bf16 v[244:247], a[236:239], v[228:231], v[244:247]
    v_max3_f32 v147, v240, v241, v242
    v_max_f32 v147, v147, v243
    v_mfma_f32_16x16x32_bf16 v[248:251], a[224:227], v[136:139], 0
    v_mov_b32 v146, v147
    v_cvt_pk_bf16_f32 v207, v222, v223
    v_mfma_f32_16x16x32_bf16 v[248:251], a[228:231], v[168:171], v[248:251]
    v_permlane32_swap_b32 v147, v146
    v_max_f32 v147, v147, v146
    v_mfma_f32_16x16x32_bf16 v[248:251], a[232:235], v[200:203], v[248:251]
    buffer_load_dwordx4 v1, s[36:39], s77 offen offset:3072 sc1 lds
    v_mfma_f32_16x16x32_bf16 v[248:251], a[236:239], v[232:235], v[248:251]
    v_max3_f32 v151, v244, v245, v246
    v_max_f32 v151, v151, v247
    v_mfma_f32_16x16x32_bf16 v[252:255], a[224:227], v[140:143], 0
    s_add_u32 s100, s77, 4096
    v_mov_b32 v150, v151
    v_mov_b32 v146, v147
    v_mfma_f32_16x16x32_bf16 v[252:255], a[228:231], v[172:175], v[252:255]
    s_add_u32 m0, m0, 4096
    v_max3_f32 v155, v248, v249, v250
    v_max_f32 v155, v155, v251
    v_mfma_f32_16x16x32_bf16 v[252:255], a[232:235], v[204:207], v[252:255]
    buffer_load_dwordx4 v1, s[36:39], s100 offen sc1 lds
    v_mfma_f32_16x16x32_bf16 v[252:255], a[236:239], v[236:239], v[252:255]
    v_mov_b32 v154, v155
    v_permlane32_swap_b32 v151, v150
    v_mfma_f32_16x16x32_bf16 a[96:99], v[48:51], v[96:99], a[96:99]
    v_permlane32_swap_b32 v155, v154
    v_max_f32 v151, v151, v150
    v_mfma_f32_16x16x32_bf16 a[96:99], v[52:55], v[100:103], a[96:99]
    v_max_f32 v155, v155, v154
    v_mov_b32 v150, v151
    v_mfma_f32_16x16x32_bf16 a[100:103], v[48:51], v[104:107], a[100:103]
    buffer_load_dwordx4 v1, s[36:39], s100 offen offset:1024 sc1 lds
    v_mfma_f32_16x16x32_bf16 a[100:103], v[52:55], v[108:111], a[100:103]
    v_max3_f32 v159, v252, v253, v254
    v_max_f32 v159, v159, v255
    v_mfma_f32_16x16x32_bf16 a[104:107], v[48:51], v[112:115], a[104:107]
    v_mov_b32 v158, v159
    v_mov_b32 v154, v155
    v_mfma_f32_16x16x32_bf16 a[104:107], v[52:55], v[116:119], a[104:107]
    v_permlane32_swap_b32 v159, v158
    v_max_f32 v159, v159, v158
    v_mfma_f32_16x16x32_bf16 a[108:111], v[48:51], v[120:123], a[108:111]
    buffer_load_dwordx4 v1, s[36:39], s100 offen offset:2048 sc1 lds
    v_mfma_f32_16x16x32_bf16 a[108:111], v[52:55], v[124:127], a[108:111]
    s_waitcnt lgkmcnt(0)
    ds_read_b64_tr_b16 v[48:49], v27 offset:0
    ds_read_b64_tr_b16 v[50:51], v27 offset:512
    v_mfma_f32_16x16x32_bf16 a[112:115], v[56:59], v[96:99], a[112:115]
    ds_read_b64_tr_b16 v[52:53], v27 offset:4096
    ds_read_b64_tr_b16 v[54:55], v27 offset:4608
    v_mfma_f32_16x16x32_bf16 a[112:115], v[60:63], v[100:103], a[112:115]
    v_mov_b32 v158, v159
    v_permlane16_swap_b32 v147, v146
    v_mfma_f32_16x16x32_bf16 a[116:119], v[56:59], v[104:107], a[116:119]
    buffer_load_dwordx4 v1, s[36:39], s100 offen offset:3072 sc1 lds
    v_mfma_f32_16x16x32_bf16 a[116:119], v[60:63], v[108:111], a[116:119]
    v_permlane16_swap_b32 v151, v150
    v_permlane16_swap_b32 v155, v154
    v_mfma_f32_16x16x32_bf16 a[120:123], v[56:59], v[112:115], a[120:123]
    s_add_u32 s76, s76, 32768
    v_permlane16_swap_b32 v159, v158
    v_max_f32 v147, v147, v146
    v_mfma_f32_16x16x32_bf16 a[120:123], v[60:63], v[116:119], a[120:123]
    s_add_u32 s77, s77, 32768
    v_max_f32 v151, v151, v150
    v_max_f32 v155, v155, v154
    v_mfma_f32_16x16x32_bf16 a[124:127], v[56:59], v[120:123], a[124:127]
    s_add_u32 m0, s76, s75
    ds_read_b64_tr_b16 v[56:57], v28 offset:0
    ds_read_b64_tr_b16 v[58:59], v28 offset:512
    v_mfma_f32_16x16x32_bf16 a[124:127], v[60:63], v[124:127], a[124:127]
    buffer_load_dwordx4 v1, s[36:39], s77 offen sc1 lds
    v_mfma_f32_16x16x32_bf16 a[64:67], v[40:43], v[64:67], a[64:67]
    ds_read_b64_tr_b16 v[60:61], v28 offset:4096
    ds_read_b64_tr_b16 v[62:63], v28 offset:4608
    v_mfma_f32_16x16x32_bf16 a[64:67], v[44:47], v[68:71], a[64:67]
    v_max_f32 v159, v159, v158
    v_sub_f32 v144, 0, v147
    v_mfma_f32_16x16x32_bf16 a[68:71], v[40:43], v[72:75], a[68:71]
    buffer_load_dwordx4 v1, s[36:39], s77 offen offset:1024 sc1 lds
    v_mfma_f32_16x16x32_bf16 a[68:71], v[44:47], v[76:79], a[68:71]
    v_sub_f32 v148, 0, v151
    v_sub_f32 v152, 0, v155
    v_mfma_f32_16x16x32_bf16 a[72:75], v[40:43], v[80:83], a[72:75]
    v_sub_f32 v156, 0, v159
    v_sub_f32 v145, 0, v147
    v_mfma_f32_16x16x32_bf16 a[72:75], v[44:47], v[84:87], a[72:75]
    v_sub_f32 v146, 0, v147
    v_sub_f32 v147, 0, v147
    v_mfma_f32_16x16x32_bf16 a[76:79], v[40:43], v[88:91], a[76:79]
    buffer_load_dwordx4 v1, s[36:39], s77 offen offset:2048 sc1 lds
    v_mfma_f32_16x16x32_bf16 a[76:79], v[44:47], v[92:95], a[76:79]
    v_sub_f32 v149, 0, v151
    v_sub_f32 v150, 0, v151
    v_mfma_f32_16x16x32_bf16 a[128:131], v[40:43], a[136:139], a[128:131]
    ds_read_b64_tr_b16 v[40:41], v29 offset:0
    ds_read_b64_tr_b16 v[42:43], v29 offset:512
    v_mfma_f32_16x16x32_bf16 a[128:131], v[44:47], a[140:143], a[128:131]
    s_waitcnt lgkmcnt(2)
    ds_read_b64_tr_b16 v[44:45], v29 offset:4096
    ds_read_b64_tr_b16 v[46:47], v29 offset:4608
    v_mfma_f32_16x16x32_bf16 a[80:83], v[48:51], v[64:67], a[80:83]
    buffer_load_dwordx4 v1, s[36:39], s77 offen offset:3072 sc1 lds
    v_mfma_f32_16x16x32_bf16 a[80:83], v[52:55], v[68:71], a[80:83]
    v_sub_f32 v151, 0, v151
    v_sub_f32 v153, 0, v155
    v_mfma_f32_16x16x32_bf16 a[84:87], v[48:51], v[72:75], a[84:87]
    s_add_u32 s100, s77, 4096
    v_sub_f32 v154, 0, v155
    v_sub_f32 v155, 0, v155
    v_mfma_f32_16x16x32_bf16 a[84:87], v[52:55], v[76:79], a[84:87]
    s_add_u32 m0, m0, 4096
    v_sub_f32 v157, 0, v159
    v_sub_f32 v158, 0, v159
    v_mfma_f32_16x16x32_bf16 a[88:91], v[48:51], v[80:83], a[88:91]
    buffer_load_dwordx4 v1, s[36:39], s100 offen sc1 lds
    v_mfma_f32_16x16x32_bf16 a[88:91], v[52:55], v[84:87], a[88:91]
    v_sub_f32 v159, 0, v159
    v_cmp_eq_u32 vcc, 0, v38
    v_mfma_f32_16x16x32_bf16 a[92:95], v[48:51], v[88:91], a[92:95]
    v_mov_b32 v38, 0x3f803f80
    v_and_b32 v29, 0x380, v1
    v_mfma_f32_16x16x32_bf16 a[92:95], v[52:55], v[92:95], a[92:95]
    v_add_f32 v240, v240, v144
    v_add_f32 v241, v241, v144
    v_mfma_f32_16x16x32_bf16 a[132:135], v[48:51], a[136:139], a[132:135]
    buffer_load_dwordx4 v1, s[36:39], s100 offen offset:1024 sc1 lds
    v_mfma_f32_16x16x32_bf16 a[132:135], v[52:55], a[140:143], a[132:135]
    v_add_f32 v242, v242, v144
    v_add_f32 v243, v243, v144
    v_mfma_f32_16x16x32_bf16 a[96:99], v[56:59], v[64:67], a[96:99]
    v_add_f32 v244, v244, v148
    v_add_f32 v245, v245, v148
    v_mfma_f32_16x16x32_bf16 a[96:99], v[60:63], v[68:71], a[96:99]
    v_add_f32 v246, v246, v148
    v_add_f32 v247, v247, v148
    v_mfma_f32_16x16x32_bf16 a[100:103], v[56:59], v[72:75], a[100:103]
    buffer_load_dwordx4 v1, s[36:39], s100 offen offset:2048 sc1 lds
    v_mfma_f32_16x16x32_bf16 a[100:103], v[60:63], v[76:79], a[100:103]
    v_add_f32 v248, v248, v152
    v_add_f32 v249, v249, v152
    v_mfma_f32_16x16x32_bf16 a[104:107], v[56:59], v[80:83], a[104:107]
    v_add_f32 v250, v250, v152
    v_add_f32 v251, v251, v152
    v_mfma_f32_16x16x32_bf16 a[104:107], v[60:63], v[84:87], a[104:107]
    s_waitcnt vmcnt(15) lgkmcnt(0)
    s_barrier
    ds_read_b128 a[240:243], v2 offset:4096
    v_mfma_f32_16x16x32_bf16 a[108:111], v[56:59], v[88:91], a[108:111]
    ds_read_b128 a[244:247], v2 offset:5120
    ds_read_b128 a[248:251], v2 offset:6144
    v_mfma_f32_16x16x32_bf16 a[108:111], v[60:63], v[92:95], a[108:111]
    buffer_load_dwordx4 v1, s[36:39], s100 offen offset:3072 sc1 lds
    v_mfma_f32_16x16x32_bf16 a[112:115], v[40:43], v[64:67], a[112:115]
    s_add_u32 s77, s77, 32768
    ds_read_b128 a[252:255], v2 offset:7168
    v_add_f32 v252, v252, v156
    v_mfma_f32_16x16x32_bf16 a[112:115], v[44:47], v[68:71], a[112:115]
    s_add_u32 s76, s76, 32768
    v_add_f32 v253, v253, v156
    v_add_f32 v254, v254, v156
    v_mfma_f32_16x16x32_bf16 a[116:119], v[40:43], v[72:75], a[116:119]
    v_add_f32 v255, v255, v156
    v_cndmask_b32 v38, 0, v38, vcc
    v_mfma_f32_16x16x32_bf16 a[116:119], v[44:47], v[76:79], a[116:119]
    v_lshl_add_u32 v29, v29, 4, v39
    v_bfe_u32 v39, v1, 2, 4
    v_mfma_f32_16x16x32_bf16 a[120:123], v[40:43], v[80:83], a[120:123]
    v_exp_f32 v240, v240
    v_mfma_f32_16x16x32_bf16 a[120:123], v[44:47], v[84:87], a[120:123]
    v_exp_f32 v241, v241
    v_mfma_f32_16x16x32_bf16 a[124:127], v[40:43], v[88:91], a[124:127]
    v_exp_f32 v242, v242
    v_mfma_f32_16x16x32_bf16 a[124:127], v[44:47], v[92:95], a[124:127]
    v_exp_f32 v243, v243
    v_exp_f32 v244, v244
    v_exp_f32 v245, v245
    v_exp_f32 v246, v246
    v_exp_f32 v247, v247
    v_exp_f32 v248, v248
    v_exp_f32 v249, v249
    v_exp_f32 v250, v250
    v_exp_f32 v251, v251
    v_exp_f32 v252, v252
    v_exp_f32 v253, v253
    v_exp_f32 v254, v254
    v_exp_f32 v255, v255
    v_accvgpr_write_b32 a136, v38
    v_accvgpr_write_b32 a137, v38
    v_accvgpr_write_b32 a138, v38
    v_accvgpr_write_b32 a139, v38
    v_lshl_add_u32 v29, v29, 1, v39
K1_ATT:
    v_cvt_pk_bf16_f32 v32, v240, v241
    v_cvt_pk_bf16_f32 v33, v242, v243
    v_add_f32 v213, s21, v144
    v_fma_f32 v180, v208, s17, v213
    v_fma_f32 v181, v209, s17, v213
    v_fma_f32 v182, v210, s17, v213
    v_fma_f32 v183, v211, s17, v213
    s_nop 1
    s_waitcnt lgkmcnt(0)
    v_mfma_f32_16x16x32_bf16 v[240:243], a[240:243], v[128:131], v[180:183]
    s_add_u32 m0, s76, s75
    v_cvt_pk_bf16_f32 v40, v244, v245
    v_cvt_pk_bf16_f32 v41, v246, v247
    v_mfma_f32_16x16x32_bf16 v[240:243], a[244:247], v[160:163], v[240:243]
    s_mov_b32 s76, s60
    buffer_load_dwordx4 v1, s[36:39], s77 offen sc1 lds
    v_mfma_f32_16x16x32_bf16 v[240:243], a[248:251], v[192:195], v[240:243]
    s_mov_b32 s60, s82
    v_cvt_pk_bf16_f32 v48, v248, v249
    v_cvt_pk_bf16_f32 v49, v250, v251
    v_mfma_f32_16x16x32_bf16 v[240:243], a[252:255], v[224:227], v[240:243]
    s_add_u32 s82, s82, 32768
    ds_read_b128 a[224:227], v2 offset:8192
    ds_read_b128 a[228:231], v2 offset:9216
    v_mfma_f32_16x16x32_bf16 v[244:247], a[240:243], v[132:135], v[148:151]
    s_sub_u32 s7, 15, s6
    buffer_load_dwordx4 v1, s[36:39], s77 offen offset:1024 sc1 lds
    v_mfma_f32_16x16x32_bf16 v[244:247], a[244:247], v[164:167], v[244:247]
    s_lshl3_add_u32 s80, s6, s4
    ds_read_b128 a[232:235], v2 offset:10240
    v_cvt_pk_bf16_f32 v56, v252, v253
    v_mfma_f32_16x16x32_bf16 v[244:247], a[248:251], v[196:199], v[244:247]
    s_lshl3_add_u32 s81, s7, s4
    v_cvt_pk_bf16_f32 v57, v254, v255
    ds_read_b128 a[236:239], v2 offset:11264
    v_mfma_f32_16x16x32_bf16 v[244:247], a[252:255], v[228:231], v[244:247]
    s_mul_i32 s80, s80, 155648
    buffer_load_dwordx4 v1, s[36:39], s77 offen offset:2048 sc1 lds
    v_mfma_f32_16x16x32_bf16 v[248:251], a[240:243], v[136:139], v[152:155]
    s_mul_i32 s81, s81, 155648
    v_add_f32 v214, s22, v144
    v_fma_f32 v184, v208, s18, v214
    v_mfma_f32_16x16x32_bf16 v[248:251], a[244:247], v[168:171], v[248:251]
    s_lshl_b32 s7, s5, 12
    v_exp_f32 v240, v240
    v_mfma_f32_16x16x32_bf16 v[248:251], a[248:251], v[200:203], v[248:251]
    s_add_u32 s80, s80, s7
    buffer_load_dwordx4 v1, s[36:39], s77 offen offset:3072 sc1 lds
    v_mfma_f32_16x16x32_bf16 v[248:251], a[252:255], v[232:235], v[248:251]
    s_add_u32 s81, s81, s7
    v_exp_f32 v241, v241
    v_mfma_f32_16x16x32_bf16 v[252:255], a[240:243], v[140:143], v[156:159]
    s_lshr_b32 s7, s5, 3
    v_exp_f32 v242, v242
    v_mfma_f32_16x16x32_bf16 v[252:255], a[244:247], v[172:175], v[252:255]
    s_add_u32 s100, s77, 4096
    v_exp_f32 v243, v243
    v_mfma_f32_16x16x32_bf16 v[252:255], a[248:251], v[204:207], v[252:255]
    s_add_u32 m0, m0, 4096
    v_fma_f32 v185, v209, s18, v214
    v_fma_f32 v186, v210, s18, v214
    v_mfma_f32_16x16x32_bf16 v[252:255], a[252:255], v[236:239], v[252:255]
    s_lshl2_add_u32 s7, s7, s4
    v_fma_f32 v187, v211, s18, v214
    v_cvt_pk_bf16_f32 v34, v240, v241
    v_cvt_pk_bf16_f32 v35, v242, v243
    s_waitcnt lgkmcnt(0)
    v_mfma_f32_16x16x32_bf16 v[240:243], a[224:227], v[128:131], v[184:187]
    s_lshl_b32 s7, s7, 8
    buffer_load_dwordx4 v1, s[36:39], s100 offen sc1 lds
    v_mfma_f32_16x16x32_bf16 v[240:243], a[228:231], v[160:163], v[240:243]
    s_mov_b32 s42, 19922944
    v_exp_f32 v244, v244
    v_mfma_f32_16x16x32_bf16 v[240:243], a[232:235], v[192:195], v[240:243]
    s_mov_b32 s43, 0x20000
    v_exp_f32 v245, v245
    v_mfma_f32_16x16x32_bf16 v[240:243], a[236:239], v[224:227], v[240:243]
    s_add_u32 s92, s7, 163840
    v_exp_f32 v246, v246
    v_exp_f32 v247, v247
    v_cvt_pk_bf16_f32 v42, v244, v245
    v_cvt_pk_bf16_f32 v43, v246, v247
    v_mfma_f32_16x16x32_bf16 v[244:247], a[224:227], v[132:135], v[148:151]
    s_mov_b64 s[24:25], s[0:1]
    buffer_load_dwordx4 v1, s[36:39], s100 offen offset:1024 sc1 lds
    v_mfma_f32_16x16x32_bf16 v[244:247], a[228:231], v[164:167], v[244:247]
    s_mov_b32 s78, s6
    v_exp_f32 v248, v248
    v_mfma_f32_16x16x32_bf16 v[244:247], a[232:235], v[196:199], v[244:247]
    s_mov_b32 s26, 2359296
    v_exp_f32 v249, v249
    v_mfma_f32_16x16x32_bf16 v[244:247], a[236:239], v[228:231], v[244:247]
    s_mov_b32 s27, 0x20000
    v_exp_f32 v250, v250
    v_exp_f32 v251, v251
    v_cvt_pk_bf16_f32 v50, v248, v249
    v_cvt_pk_bf16_f32 v51, v250, v251
    v_mfma_f32_16x16x32_bf16 v[248:251], a[224:227], v[136:139], v[152:155]
    buffer_load_dwordx4 v1, s[36:39], s100 offen offset:2048 sc1 lds
    v_mfma_f32_16x16x32_bf16 v[248:251], a[228:231], v[168:171], v[248:251]
    ds_read_b128 a[240:243], v2 offset:12288
    ds_read_b128 a[244:247], v2 offset:13312
    v_mfma_f32_16x16x32_bf16 v[248:251], a[232:235], v[200:203], v[248:251]
    s_add_u32 s77, s77, 32768
    buffer_load_dwordx4 v1, s[36:39], s100 offen offset:3072 sc1 lds
    v_mfma_f32_16x16x32_bf16 v[248:251], a[236:239], v[232:235], v[248:251]
    v_exp_f32 v252, v252
    v_exp_f32 v253, v253
    v_exp_f32 v254, v254
    v_exp_f32 v255, v255
    v_cvt_pk_bf16_f32 v58, v252, v253
    v_cvt_pk_bf16_f32 v59, v254, v255
    v_mfma_f32_16x16x32_bf16 v[252:255], a[224:227], v[140:143], v[156:159]
    ds_read_b128 a[248:251], v2 offset:14336
    ds_read_b128 a[252:255], v2 offset:15360
    v_mfma_f32_16x16x32_bf16 v[252:255], a[228:231], v[172:175], v[252:255]
    v_add_f32 v215, s23, v144
    v_fma_f32 v188, v208, s19, v215
    v_mfma_f32_16x16x32_bf16 v[252:255], a[232:235], v[204:207], v[252:255]
    v_exp_f32 v240, v240
    v_mfma_f32_16x16x32_bf16 v[252:255], a[236:239], v[236:239], v[252:255]
    s_waitcnt lgkmcnt(2)
    v_exp_f32 v241, v241
    v_exp_f32 v242, v242
    v_exp_f32 v243, v243
    v_fma_f32 v189, v209, s19, v215
    v_fma_f32 v190, v210, s19, v215
    v_fma_f32 v191, v211, s19, v215
    v_cvt_pk_bf16_f32 v36, v240, v241
    v_cvt_pk_bf16_f32 v37, v242, v243
    v_mfma_f32_16x16x32_bf16 v[240:243], a[240:243], v[128:131], v[188:191]
    v_exp_f32 v244, v244
    v_mfma_f32_16x16x32_bf16 v[240:243], a[244:247], v[160:163], v[240:243]
    s_cmp_eq_u32 s82, 163840
    s_cselect_b32 s82, 0, s82
    v_add_u32 v2, s82, v1
    s_waitcnt lgkmcnt(0)
    v_mfma_f32_16x16x32_bf16 v[240:243], a[248:251], v[192:195], v[240:243]
    v_exp_f32 v245, v245
    v_mfma_f32_16x16x32_bf16 v[240:243], a[252:255], v[224:227], v[240:243]
    s_waitcnt vmcnt(8) lgkmcnt(0)
    s_barrier
    v_cvt_pk_bf16_f32 v44, v244, v245
    v_exp_f32 v246, v246
    v_exp_f32 v247, v247
    s_nop 0
    v_cvt_pk_bf16_f32 v45, v246, v247
    v_mfma_f32_16x16x32_bf16 v[244:247], a[240:243], v[132:135], v[148:151]
    ds_read_b128 a[224:227], v2 offset:0
    ds_read_b128 a[228:231], v2 offset:1024
    v_mfma_f32_16x16x32_bf16 v[244:247], a[244:247], v[164:167], v[244:247]
    v_exp_f32 v248, v248
    v_mfma_f32_16x16x32_bf16 v[244:247], a[248:251], v[196:199], v[244:247]
    v_exp_f32 v249, v249
    v_mfma_f32_16x16x32_bf16 v[244:247], a[252:255], v[228:231], v[244:247]
    v_exp_f32 v250, v250
    v_exp_f32 v251, v251
    v_cvt_pk_bf16_f32 v52, v248, v249
    v_cvt_pk_bf16_f32 v53, v250, v251
    v_mfma_f32_16x16x32_bf16 v[248:251], a[240:243], v[136:139], v[152:155]
    ds_read_b128 a[232:235], v2 offset:2048
    ds_read_b128 a[236:239], v2 offset:3072
    v_mfma_f32_16x16x32_bf16 v[248:251], a[244:247], v[168:171], v[248:251]
    ds_read_b128 v[96:99], v2 offset:16384
    v_add_f32 v212, s20, v144
    v_mfma_f32_16x16x32_bf16 v[248:251], a[248:251], v[200:203], v[248:251]
    v_exp_f32 v252, v252
    v_mfma_f32_16x16x32_bf16 v[248:251], a[252:255], v[232:235], v[248:251]
    v_exp_f32 v253, v253
    v_exp_f32 v254, v254
    v_exp_f32 v255, v255
    v_cvt_pk_bf16_f32 v60, v252, v253
    v_cvt_pk_bf16_f32 v61, v254, v255
    v_mfma_f32_16x16x32_bf16 v[252:255], a[240:243], v[140:143], v[156:159]
    ds_read_b128 v[100:103], v2 offset:17408
    v_fma_f32 v176, v208, s16, v212
    v_mfma_f32_16x16x32_bf16 v[252:255], a[244:247], v[172:175], v[252:255]
    v_exp_f32 v240, v240
    v_mfma_f32_16x16x32_bf16 v[252:255], a[248:251], v[204:207], v[252:255]
    s_sub_u32 s40, s56, 20971520
    s_subb_u32 s41, s57, 0
    v_fma_f32 v177, v209, s16, v212
    v_mfma_f32_16x16x32_bf16 v[252:255], a[252:255], v[236:239], v[252:255]
    v_exp_f32 v241, v241
    v_exp_f32 v242, v242
    v_exp_f32 v243, v243
    v_exp_f32 v244, v244
    v_exp_f32 v245, v245
    v_exp_f32 v246, v246
    v_exp_f32 v247, v247
    v_exp_f32 v248, v248
    v_exp_f32 v249, v249
    v_exp_f32 v250, v250
    v_exp_f32 v251, v251
    v_exp_f32 v252, v252
    v_exp_f32 v253, v253
    v_fma_f32 v178, v210, s16, v212
    v_fma_f32 v179, v211, s16, v212
    v_cvt_pk_bf16_f32 v38, v240, v241
    v_cvt_pk_bf16_f32 v39, v242, v243
    v_cvt_pk_bf16_f32 v46, v244, v245
    v_cvt_pk_bf16_f32 v47, v246, v247
    v_cvt_pk_bf16_f32 v54, v248, v249
    v_cvt_pk_bf16_f32 v55, v250, v251
    v_cvt_pk_bf16_f32 v62, v252, v253
    s_cmp_eq_u32 s78, 0
    s_cbranch_scc1 K1_LB_END
.p2align 3
K1_LB:
    s_waitcnt lgkmcnt(0)
    v_mfma_f32_16x16x32_bf16 v[240:243], a[224:227], v[128:131], v[176:179]
    s_add_u32 m0, s76, s75
    v_exp_f32 v254, v254
    v_mfma_f32_16x16x32_bf16 v[240:243], a[228:231], v[160:163], v[240:243]
    s_mov_b32 s76, s60
    buffer_load_dwordx4 v1, s[36:39], s77 offen sc1 lds
    v_mfma_f32_16x16x32_bf16 v[240:243], a[232:235], v[192:195], v[240:243]
    s_mov_b32 s60, s82
    v_exp_f32 v255, v255
    v_mfma_f32_16x16x32_bf16 v[240:243], a[236:239], v[224:227], v[240:243]
    s_add_u32 s82, s82, 32768
    ds_read_b128 v[104:107], v2 offset:18432
    v_cvt_pk_bf16_f32 v63, v254, v255
    v_mfma_f32_16x16x32_bf16 a[0:3], v[96:99], v[32:35], a[0:3]
    ds_read_b128 v[108:111], v2 offset:19456
    ds_read_b128 a[240:243], v2 offset:4096
    v_mfma_f32_16x16x32_bf16 a[0:3], v[100:103], v[36:39], a[0:3]
    ds_read_b128 a[244:247], v2 offset:5120
    v_mfma_f32_16x16x32_bf16 a[4:7], v[96:99], v[40:43], a[4:7]
    v_exp_f32 v240, v240
    v_mfma_f32_16x16x32_bf16 a[4:7], v[100:103], v[44:47], a[4:7]
    ds_read_b128 a[248:251], v2 offset:6144
    ds_read_b128 a[252:255], v2 offset:7168
    v_mfma_f32_16x16x32_bf16 v[244:247], a[224:227], v[132:135], v[148:151]
    v_exp_f32 v241, v241
    v_mfma_f32_16x16x32_bf16 v[244:247], a[228:231], v[164:167], v[244:247]
    ds_read_b128 v[112:115], v2 offset:20480
    ds_read_b128 v[116:119], v2 offset:21504
    v_mfma_f32_16x16x32_bf16 v[244:247], a[232:235], v[196:199], v[244:247]
    v_exp_f32 v242, v242
    v_mfma_f32_16x16x32_bf16 v[244:247], a[236:239], v[228:231], v[244:247]
    v_exp_f32 v243, v243
    v_mfma_f32_16x16x32_bf16 a[8:11], v[96:99], v[48:51], a[8:11]
    v_cvt_pk_bf16_f32 v64, v240, v241
    v_cvt_pk_bf16_f32 v65, v242, v243
    v_mfma_f32_16x16x32_bf16 a[8:11], v[100:103], v[52:55], a[8:11]
    ds_read_b128 v[120:123], v2 offset:22528
    ds_read_b128 v[124:127], v2 offset:23552
    v_mfma_f32_16x16x32_bf16 a[12:15], v[96:99], v[56:59], a[12:15]
    v_exp_f32 v244, v244
    v_mfma_f32_16x16x32_bf16 a[12:15], v[100:103], v[60:63], a[12:15]
    buffer_load_dwordx4 v1, s[36:39], s77 offen offset:1024 sc1 lds
    v_mfma_f32_16x16x32_bf16 v[248:251], a[224:227], v[136:139], v[152:155]
    v_exp_f32 v245, v245
    v_mfma_f32_16x16x32_bf16 v[248:251], a[228:231], v[168:171], v[248:251]
    v_exp_f32 v246, v246
    v_mfma_f32_16x16x32_bf16 v[248:251], a[232:235], v[200:203], v[248:251]
    v_exp_f32 v247, v247
    v_mfma_f32_16x16x32_bf16 v[248:251], a[236:239], v[232:235], v[248:251]
    s_waitcnt lgkmcnt(0)
    v_cvt_pk_bf16_f32 v72, v244, v245
    v_cvt_pk_bf16_f32 v73, v246, v247
    v_mfma_f32_16x16x32_bf16 a[16:19], v[104:107], v[32:35], a[16:19]
    ds_read_b128 v[96:99], v2 offset:24576
    ds_read_b128 v[100:103], v2 offset:25600
    v_mfma_f32_16x16x32_bf16 a[16:19], v[108:111], v[36:39], a[16:19]
    v_mfma_f32_16x16x32_bf16 a[20:23], v[104:107], v[40:43], a[20:23]
    v_mfma_f32_16x16x32_bf16 a[20:23], v[108:111], v[44:47], a[20:23]
    v_exp_f32 v248, v248
    v_mfma_f32_16x16x32_bf16 v[252:255], a[224:227], v[140:143], v[156:159]
    v_exp_f32 v249, v249
    v_mfma_f32_16x16x32_bf16 v[252:255], a[228:231], v[172:175], v[252:255]
    v_exp_f32 v250, v250
    v_mfma_f32_16x16x32_bf16 v[252:255], a[232:235], v[204:207], v[252:255]
    v_exp_f32 v251, v251
    v_mfma_f32_16x16x32_bf16 v[252:255], a[236:239], v[236:239], v[252:255]
    v_cvt_pk_bf16_f32 v80, v248, v249
    v_cvt_pk_bf16_f32 v81, v250, v251
    v_mfma_f32_16x16x32_bf16 a[24:27], v[104:107], v[48:51], a[24:27]
    ds_read_b128 a[224:227], v2 offset:8192
    ds_read_b128 a[228:231], v2 offset:9216
    v_mfma_f32_16x16x32_bf16 a[24:27], v[108:111], v[52:55], a[24:27]
    buffer_load_dwordx4 v1, s[36:39], s77 offen offset:2048 sc1 lds
    v_mfma_f32_16x16x32_bf16 a[28:31], v[104:107], v[56:59], a[28:31]
    v_exp_f32 v252, v252
    v_mfma_f32_16x16x32_bf16 a[28:31], v[108:111], v[60:63], a[28:31]
    v_exp_f32 v253, v253
    v_mfma_f32_16x16x32_bf16 v[240:243], a[240:243], v[128:131], v[180:183]
    v_exp_f32 v254, v254
    v_mfma_f32_16x16x32_bf16 v[240:243], a[244:247], v[160:163], v[240:243]
    v_exp_f32 v255, v255
    v_mfma_f32_16x16x32_bf16 v[240:243], a[248:251], v[192:195], v[240:243]
    v_cvt_pk_bf16_f32 v88, v252, v253
    v_cvt_pk_bf16_f32 v89, v254, v255
    v_mfma_f32_16x16x32_bf16 v[240:243], a[252:255], v[224:227], v[240:243]
    ds_read_b128 a[232:235], v2 offset:10240
    ds_read_b128 a[236:239], v2 offset:11264
    v_mfma_f32_16x16x32_bf16 a[32:35], v[112:115], v[32:35], a[32:35]
    ds_read_b128 v[104:107], v2 offset:26624
    v_mfma_f32_16x16x32_bf16 a[32:35], v[116:119], v[36:39], a[32:35]
    ds_read_b128 v[108:111], v2 offset:27648
    v_mfma_f32_16x16x32_bf16 a[36:39], v[112:115], v[40:43], a[36:39]
    v_mfma_f32_16x16x32_bf16 a[36:39], v[116:119], v[44:47], a[36:39]
    v_exp_f32 v240, v240
    v_mfma_f32_16x16x32_bf16 v[244:247], a[240:243], v[132:135], v[148:151]
    v_exp_f32 v241, v241
    v_mfma_f32_16x16x32_bf16 v[244:247], a[244:247], v[164:167], v[244:247]
    v_exp_f32 v242, v242
    v_mfma_f32_16x16x32_bf16 v[244:247], a[248:251], v[196:199], v[244:247]
    v_exp_f32 v243, v243
    v_mfma_f32_16x16x32_bf16 v[244:247], a[252:255], v[228:231], v[244:247]
    buffer_load_dwordx4 v1, s[36:39], s77 offen offset:3072 sc1 lds
    v_mfma_f32_16x16x32_bf16 a[40:43], v[112:115], v[48:51], a[40:43]
    v_cvt_pk_bf16_f32 v66, v240, v241
    v_cvt_pk_bf16_f32 v67, v242, v243
    v_mfma_f32_16x16x32_bf16 a[40:43], v[116:119], v[52:55], a[40:43]
    v_mfma_f32_16x16x32_bf16 a[44:47], v[112:115], v[56:59], a[44:47]
    ds_read_b128 v[112:115], v2 offset:28672
    v_mfma_f32_16x16x32_bf16 a[44:47], v[116:119], v[60:63], a[44:47]
    v_exp_f32 v244, v244
    v_mfma_f32_16x16x32_bf16 v[248:251], a[240:243], v[136:139], v[152:155]
    v_exp_f32 v245, v245
    v_mfma_f32_16x16x32_bf16 v[248:251], a[244:247], v[168:171], v[248:251]
    v_exp_f32 v246, v246
    v_mfma_f32_16x16x32_bf16 v[248:251], a[248:251], v[200:203], v[248:251]
    v_exp_f32 v247, v247
    v_mfma_f32_16x16x32_bf16 v[248:251], a[252:255], v[232:235], v[248:251]
    v_cvt_pk_bf16_f32 v74, v244, v245
    v_cvt_pk_bf16_f32 v75, v246, v247
    v_mfma_f32_16x16x32_bf16 a[48:51], v[120:123], v[32:35], a[48:51]
    ds_read_b128 v[116:119], v2 offset:29696
    v_mfma_f32_16x16x32_bf16 a[48:51], v[124:127], v[36:39], a[48:51]
    v_mfma_f32_16x16x32_bf16 a[52:55], v[120:123], v[40:43], a[52:55]
    v_mfma_f32_16x16x32_bf16 a[52:55], v[124:127], v[44:47], a[52:55]
    v_mfma_f32_16x16x32_bf16 v[252:255], a[240:243], v[140:143], v[156:159]
    v_exp_f32 v248, v248
    v_mfma_f32_16x16x32_bf16 v[252:255], a[244:247], v[172:175], v[252:255]
    s_add_u32 s100, s77, 4096
    v_exp_f32 v249, v249
    v_mfma_f32_16x16x32_bf16 v[252:255], a[248:251], v[204:207], v[252:255]
    s_add_u32 m0, m0, 4096
    v_exp_f32 v250, v250
    v_mfma_f32_16x16x32_bf16 v[252:255], a[252:255], v[236:239], v[252:255]
    buffer_load_dwordx4 v1, s[36:39], s100 offen sc1 lds
    v_mfma_f32_16x16x32_bf16 a[56:59], v[120:123], v[48:51], a[56:59]
    v_exp_f32 v251, v251
    v_mfma_f32_16x16x32_bf16 a[56:59], v[124:127], v[52:55], a[56:59]
    v_cvt_pk_bf16_f32 v82, v248, v249
    v_cvt_pk_bf16_f32 v83, v250, v251
    v_mfma_f32_16x16x32_bf16 a[60:63], v[120:123], v[56:59], a[60:63]
    ds_read_b128 a[240:243], v2 offset:12288
    ds_read_b128 a[244:247], v2 offset:13312
    v_mfma_f32_16x16x32_bf16 a[60:63], v[124:127], v[60:63], a[60:63]
    s_waitcnt lgkmcnt(2)
    v_exp_f32 v252, v252
    v_mfma_f32_16x16x32_bf16 v[240:243], a[224:227], v[128:131], v[184:187]
    v_exp_f32 v253, v253
    v_mfma_f32_16x16x32_bf16 v[240:243], a[228:231], v[160:163], v[240:243]
    v_exp_f32 v254, v254
    v_mfma_f32_16x16x32_bf16 v[240:243], a[232:235], v[192:195], v[240:243]
    v_exp_f32 v255, v255
    v_mfma_f32_16x16x32_bf16 v[240:243], a[236:239], v[224:227], v[240:243]
    v_cvt_pk_bf16_f32 v90, v252, v253
    v_cvt_pk_bf16_f32 v91, v254, v255
    v_mfma_f32_16x16x32_bf16 a[144:147], v[96:99], v[32:35], a[144:147]
    ds_read_b128 a[248:251], v2 offset:14336
    ds_read_b128 a[252:255], v2 offset:15360
    v_mfma_f32_16x16x32_bf16 a[144:147], v[100:103], v[36:39], a[144:147]
    ds_read_b128 v[120:123], v2 offset:30720
    v_mfma_f32_16x16x32_bf16 a[148:151], v[96:99], v[40:43], a[148:151]
    v_exp_f32 v240, v240
    v_mfma_f32_16x16x32_bf16 a[148:151], v[100:103], v[44:47], a[148:151]
    v_exp_f32 v241, v241
    v_mfma_f32_16x16x32_bf16 v[244:247], a[224:227], v[132:135], v[148:151]
    buffer_load_dwordx4 v1, s[36:39], s100 offen offset:1024 sc1 lds
    v_mfma_f32_16x16x32_bf16 v[244:247], a[228:231], v[164:167], v[244:247]
    v_exp_f32 v242, v242
    v_mfma_f32_16x16x32_bf16 v[244:247], a[232:235], v[196:199], v[244:247]
    v_exp_f32 v243, v243
    v_mfma_f32_16x16x32_bf16 v[244:247], a[236:239], v[228:231], v[244:247]
    v_cvt_pk_bf16_f32 v68, v240, v241
    v_cvt_pk_bf16_f32 v69, v242, v243
    v_mfma_f32_16x16x32_bf16 a[152:155], v[96:99], v[48:51], a[152:155]
    ds_read_b128 v[124:127], v2 offset:31744
    v_mfma_f32_16x16x32_bf16 a[152:155], v[100:103], v[52:55], a[152:155]
    v_mfma_f32_16x16x32_bf16 a[156:159], v[96:99], v[56:59], a[156:159]
    v_mfma_f32_16x16x32_bf16 a[156:159], v[100:103], v[60:63], a[156:159]
    v_mfma_f32_16x16x32_bf16 v[248:251], a[224:227], v[136:139], v[152:155]
    v_exp_f32 v244, v244
    v_mfma_f32_16x16x32_bf16 v[248:251], a[228:231], v[168:171], v[248:251]
    v_exp_f32 v245, v245
    v_mfma_f32_16x16x32_bf16 v[248:251], a[232:235], v[200:203], v[248:251]
    v_exp_f32 v246, v246
    v_mfma_f32_16x16x32_bf16 v[248:251], a[236:239], v[232:235], v[248:251]
    v_exp_f32 v247, v247
    v_mfma_f32_16x16x32_bf16 a[160:163], v[104:107], v[32:35], a[160:163]
    v_cvt_pk_bf16_f32 v76, v244, v245
    v_cvt_pk_bf16_f32 v77, v246, v247
    v_mfma_f32_16x16x32_bf16 a[160:163], v[108:111], v[36:39], a[160:163]
    v_mfma_f32_16x16x32_bf16 a[164:167], v[104:107], v[40:43], a[164:167]
    buffer_load_dwordx4 v1, s[36:39], s100 offen offset:2048 sc1 lds
    v_mfma_f32_16x16x32_bf16 a[164:167], v[108:111], v[44:47], a[164:167]
    v_exp_f32 v248, v248
    v_mfma_f32_16x16x32_bf16 v[252:255], a[224:227], v[140:143], v[156:159]
    v_exp_f32 v249, v249
    v_mfma_f32_16x16x32_bf16 v[252:255], a[228:231], v[172:175], v[252:255]
    v_exp_f32 v250, v250
    v_mfma_f32_16x16x32_bf16 v[252:255], a[232:235], v[204:207], v[252:255]
    v_exp_f32 v251, v251
    v_mfma_f32_16x16x32_bf16 v[252:255], a[236:239], v[236:239], v[252:255]
    v_cvt_pk_bf16_f32 v84, v248, v249
    v_cvt_pk_bf16_f32 v85, v250, v251
    v_mfma_f32_16x16x32_bf16 a[168:171], v[104:107], v[48:51], a[168:171]
    v_mfma_f32_16x16x32_bf16 a[168:171], v[108:111], v[52:55], a[168:171]
    v_mfma_f32_16x16x32_bf16 a[172:175], v[104:107], v[56:59], a[172:175]
    v_mfma_f32_16x16x32_bf16 a[172:175], v[108:111], v[60:63], a[172:175]
    s_waitcnt lgkmcnt(0)
    v_mfma_f32_16x16x32_bf16 v[240:243], a[240:243], v[128:131], v[188:191]
    v_mfma_f32_16x16x32_bf16 v[240:243], a[244:247], v[160:163], v[240:243]
    v_exp_f32 v252, v252
    v_mfma_f32_16x16x32_bf16 v[240:243], a[248:251], v[192:195], v[240:243]
    v_exp_f32 v253, v253
    v_mfma_f32_16x16x32_bf16 v[240:243], a[252:255], v[224:227], v[240:243]
    v_exp_f32 v254, v254
    v_mfma_f32_16x16x32_bf16 a[176:179], v[112:115], v[32:35], a[176:179]
    buffer_load_dwordx4 v1, s[36:39], s100 offen offset:3072 sc1 lds
    v_mfma_f32_16x16x32_bf16 a[176:179], v[116:119], v[36:39], a[176:179]
    v_exp_f32 v255, v255
    v_mfma_f32_16x16x32_bf16 a[180:183], v[112:115], v[40:43], a[180:183]
    v_cvt_pk_bf16_f32 v92, v252, v253
    v_cvt_pk_bf16_f32 v93, v254, v255
    v_mfma_f32_16x16x32_bf16 a[180:183], v[116:119], v[44:47], a[180:183]
    s_cmp_eq_u32 s82, 163840
    s_cselect_b32 s82, 0, s82
    v_add_u32 v2, s82, v1
    v_mfma_f32_16x16x32_bf16 v[244:247], a[240:243], v[132:135], v[148:151]
    ds_read_b128 a[224:227], v2 offset:0
    ds_read_b128 a[228:231], v2 offset:1024
    v_mfma_f32_16x16x32_bf16 v[244:247], a[244:247], v[164:167], v[244:247]
    v_exp_f32 v240, v240
    v_mfma_f32_16x16x32_bf16 v[244:247], a[248:251], v[196:199], v[244:247]
    ds_read_b128 a[232:235], v2 offset:2048
    ds_read_b128 a[236:239], v2 offset:3072
    v_mfma_f32_16x16x32_bf16 v[244:247], a[252:255], v[228:231], v[244:247]
    v_exp_f32 v241, v241
    v_mfma_f32_16x16x32_bf16 a[184:187], v[112:115], v[48:51], a[184:187]
    ds_read_b128 v[96:99], v2 offset:16384
    ds_read_b128 v[100:103], v2 offset:17408
    v_mfma_f32_16x16x32_bf16 a[184:187], v[116:119], v[52:55], a[184:187]
    v_exp_f32 v242, v242
    v_mfma_f32_16x16x32_bf16 a[188:191], v[112:115], v[56:59], a[188:191]
    v_exp_f32 v243, v243
    v_mfma_f32_16x16x32_bf16 a[188:191], v[116:119], v[60:63], a[188:191]
    v_exp_f32 v244, v244
    v_mfma_f32_16x16x32_bf16 v[248:251], a[240:243], v[136:139], v[152:155]
    v_exp_f32 v245, v245
    v_mfma_f32_16x16x32_bf16 v[248:251], a[244:247], v[168:171], v[248:251]
    v_exp_f32 v246, v246
    v_mfma_f32_16x16x32_bf16 v[248:251], a[248:251], v[200:203], v[248:251]
    s_add_u32 s77, s77, 32768
    v_exp_f32 v247, v247
    v_mfma_f32_16x16x32_bf16 v[248:251], a[252:255], v[232:235], v[248:251]
    v_cvt_pk_bf16_f32 v70, v240, v241
    v_cvt_pk_bf16_f32 v71, v242, v243
    v_mfma_f32_16x16x32_bf16 a[192:195], v[120:123], v[32:35], a[192:195]
    v_cvt_pk_bf16_f32 v78, v244, v245
    v_cvt_pk_bf16_f32 v79, v246, v247
    v_mfma_f32_16x16x32_bf16 a[192:195], v[124:127], v[36:39], a[192:195]
    v_mfma_f32_16x16x32_bf16 a[196:199], v[120:123], v[40:43], a[196:199]
    v_mfma_f32_16x16x32_bf16 a[196:199], v[124:127], v[44:47], a[196:199]
    v_exp_f32 v248, v248
    v_mfma_f32_16x16x32_bf16 v[252:255], a[240:243], v[140:143], v[156:159]
    v_exp_f32 v249, v249
    v_mfma_f32_16x16x32_bf16 v[252:255], a[244:247], v[172:175], v[252:255]
    v_exp_f32 v250, v250
    v_mfma_f32_16x16x32_bf16 v[252:255], a[248:251], v[204:207], v[252:255]
    v_exp_f32 v251, v251
    v_mfma_f32_16x16x32_bf16 v[252:255], a[252:255], v[236:239], v[252:255]
    v_cvt_pk_bf16_f32 v86, v248, v249
    v_cvt_pk_bf16_f32 v87, v250, v251
    v_mfma_f32_16x16x32_bf16 a[200:203], v[120:123], v[48:51], a[200:203]
    v_mfma_f32_16x16x32_bf16 a[200:203], v[124:127], v[52:55], a[200:203]
    v_mfma_f32_16x16x32_bf16 a[204:207], v[120:123], v[56:59], a[204:207]
    v_mfma_f32_16x16x32_bf16 a[204:207], v[124:127], v[60:63], a[204:207]
    v_mfma_f32_16x16x32_bf16 a[208:211], a[136:139], v[32:35], a[208:211]
    v_mfma_f32_16x16x32_bf16 a[208:211], a[136:139], v[36:39], a[208:211]
    v_exp_f32 v252, v252
    v_mfma_f32_16x16x32_bf16 a[212:215], a[136:139], v[40:43], a[212:215]
    v_exp_f32 v253, v253
    v_mfma_f32_16x16x32_bf16 a[212:215], a[136:139], v[44:47], a[212:215]
    v_cvt_pk_bf16_f32 v94, v252, v253
    v_mfma_f32_16x16x32_bf16 a[216:219], a[136:139], v[48:51], a[216:219]
    v_mfma_f32_16x16x32_bf16 a[216:219], a[136:139], v[52:55], a[216:219]
    v_mfma_f32_16x16x32_bf16 a[220:223], a[136:139], v[56:59], a[220:223]
    v_mfma_f32_16x16x32_bf16 a[220:223], a[136:139], v[60:63], a[220:223]
    s_cmp_le_u32 s78, 1
    s_cbranch_scc1 K1_LB_MASK
K1_LB_BACK:
    s_waitcnt lgkmcnt(0)
    v_mfma_f32_16x16x32_bf16 v[240:243], a[224:227], v[128:131], v[176:179]
    s_add_u32 m0, s76, s75
    v_exp_f32 v254, v254
    v_mfma_f32_16x16x32_bf16 v[240:243], a[228:231], v[160:163], v[240:243]
    s_mov_b32 s76, s60
    buffer_load_dwordx4 v1, s[36:39], s77 offen sc1 lds
    v_mfma_f32_16x16x32_bf16 v[240:243], a[232:235], v[192:195], v[240:243]
    s_mov_b32 s60, s82
    v_exp_f32 v255, v255
    v_mfma_f32_16x16x32_bf16 v[240:243], a[236:239], v[224:227], v[240:243]
    s_add_u32 s82, s82, 32768
    ds_read_b128 v[104:107], v2 offset:18432
    v_cvt_pk_bf16_f32 v95, v254, v255
    v_mfma_f32_16x16x32_bf16 a[0:3], v[96:99], v[64:67], a[0:3]
    ds_read_b128 v[108:111], v2 offset:19456
    ds_read_b128 a[240:243], v2 offset:4096
    v_mfma_f32_16x16x32_bf16 a[0:3], v[100:103], v[68:71], a[0:3]
    ds_read_b128 a[244:247], v2 offset:5120
    v_mfma_f32_16x16x32_bf16 a[4:7], v[96:99], v[72:75], a[4:7]
    v_exp_f32 v240, v240
    v_mfma_f32_16x16x32_bf16 a[4:7], v[100:103], v[76:79], a[4:7]
    ds_read_b128 a[248:251], v2 offset:6144
    ds_read_b128 a[252:255], v2 offset:7168
    v_mfma_f32_16x16x32_bf16 v[244:247], a[224:227], v[132:135], v[148:151]
    v_exp_f32 v241, v241
    v_mfma_f32_16x16x32_bf16 v[244:247], a[228:231], v[164:167], v[244:247]
    ds_read_b128 v[112:115], v2 offset:20480
    ds_read_b128 v[116:119], v2 offset:21504
    v_mfma_f32_16x16x32_bf16 v[244:247], a[232:235], v[196:199], v[244:247]
    v_exp_f32 v242, v242
    v_mfma_f32_16x16x32_bf16 v[244:247], a[236:239], v[228:231], v[244:247]
    v_exp_f32 v243, v243
    v_mfma_f32_16x16x32_bf16 a[8:11], v[96:99], v[80:83], a[8:11]
    v_cvt_pk_bf16_f32 v32, v240, v241
    v_cvt_pk_bf16_f32 v33, v242, v243
    v_mfma_f32_16x16x32_bf16 a[8:11], v[100:103], v[84:87], a[8:11]
    ds_read_b128 v[120:123], v2 offset:22528
    ds_read_b128 v[124:127], v2 offset:23552
    v_mfma_f32_16x16x32_bf16 a[12:15], v[96:99], v[88:91], a[12:15]
    v_exp_f32 v244, v244
    v_mfma_f32_16x16x32_bf16 a[12:15], v[100:103], v[92:95], a[12:15]
    buffer_load_dwordx4 v1, s[36:39], s77 offen offset:1024 sc1 lds
    v_mfma_f32_16x16x32_bf16 v[248:251], a[224:227], v[136:139], v[152:155]
    v_exp_f32 v245, v245
    v_mfma_f32_16x16x32_bf16 v[248:251], a[228:231], v[168:171], v[248:251]
    v_exp_f32 v246, v246
    v_mfma_f32_16x16x32_bf16 v[248:251], a[232:235], v[200:203], v[248:251]
    v_exp_f32 v247, v247
    v_mfma_f32_16x16x32_bf16 v[248:251], a[236:239], v[232:235], v[248:251]
    s_waitcnt lgkmcnt(0)
    v_cvt_pk_bf16_f32 v40, v244, v245
    v_cvt_pk_bf16_f32 v41, v246, v247
    v_mfma_f32_16x16x32_bf16 a[16:19], v[104:107], v[64:67], a[16:19]
    ds_read_b128 v[96:99], v2 offset:24576
    ds_read_b128 v[100:103], v2 offset:25600
    v_mfma_f32_16x16x32_bf16 a[16:19], v[108:111], v[68:71], a[16:19]
    v_mfma_f32_16x16x32_bf16 a[20:23], v[104:107], v[72:75], a[20:23]
    v_mfma_f32_16x16x32_bf16 a[20:23], v[108:111], v[76:79], a[20:23]
    v_exp_f32 v248, v248
    v_mfma_f32_16x16x32_bf16 v[252:255], a[224:227], v[140:143], v[156:159]
    v_exp_f32 v249, v249
    v_mfma_f32_16x16x32_bf16 v[252:255], a[228:231], v[172:175], v[252:255]
    v_exp_f32 v250, v250
    v_mfma_f32_16x16x32_bf16 v[252:255], a[232:235], v[204:207], v[252:255]
    v_exp_f32 v251, v251
    v_mfma_f32_16x16x32_bf16 v[252:255], a[236:239], v[236:239], v[252:255]
    v_cvt_pk_bf16_f32 v48, v248, v249
    v_cvt_pk_bf16_f32 v49, v250, v251
    v_mfma_f32_16x16x32_bf16 a[24:27], v[104:107], v[80:83], a[24:27]
    ds_read_b128 a[224:227], v2 offset:8192
    ds_read_b128 a[228:231], v2 offset:9216
    v_mfma_f32_16x16x32_bf16 a[24:27], v[108:111], v[84:87], a[24:27]
    buffer_load_dwordx4 v1, s[36:39], s77 offen offset:2048 sc1 lds
    v_mfma_f32_16x16x32_bf16 a[28:31], v[104:107], v[88:91], a[28:31]
    v_exp_f32 v252, v252
    v_mfma_f32_16x16x32_bf16 a[28:31], v[108:111], v[92:95], a[28:31]
    v_exp_f32 v253, v253
    v_mfma_f32_16x16x32_bf16 v[240:243], a[240:243], v[128:131], v[180:183]
    v_exp_f32 v254, v254
    v_mfma_f32_16x16x32_bf16 v[240:243], a[244:247], v[160:163], v[240:243]
    v_exp_f32 v255, v255
    v_mfma_f32_16x16x32_bf16 v[240:243], a[248:251], v[192:195], v[240:243]
    v_cvt_pk_bf16_f32 v56, v252, v253
    v_cvt_pk_bf16_f32 v57, v254, v255
    v_mfma_f32_16x16x32_bf16 v[240:243], a[252:255], v[224:227], v[240:243]
    ds_read_b128 a[232:235], v2 offset:10240
    ds_read_b128 a[236:239], v2 offset:11264
    v_mfma_f32_16x16x32_bf16 a[32:35], v[112:115], v[64:67], a[32:35]
    ds_read_b128 v[104:107], v2 offset:26624
    v_mfma_f32_16x16x32_bf16 a[32:35], v[116:119], v[68:71], a[32:35]
    ds_read_b128 v[108:111], v2 offset:27648
    v_mfma_f32_16x16x32_bf16 a[36:39], v[112:115], v[72:75], a[36:39]
    v_mfma_f32_16x16x32_bf16 a[36:39], v[116:119], v[76:79], a[36:39]
    v_exp_f32 v240, v240
    v_mfma_f32_16x16x32_bf16 v[244:247], a[240:243], v[132:135], v[148:151]
    v_exp_f32 v241, v241
    v_mfma_f32_16x16x32_bf16 v[244:247], a[244:247], v[164:167], v[244:247]
    v_exp_f32 v242, v242
    v_mfma_f32_16x16x32_bf16 v[244:247], a[248:251], v[196:199], v[244:247]
    v_exp_f32 v243, v243
    v_mfma_f32_16x16x32_bf16 v[244:247], a[252:255], v[228:231], v[244:247]
    buffer_load_dwordx4 v1, s[36:39], s77 offen offset:3072 sc1 lds
    v_mfma_f32_16x16x32_bf16 a[40:43], v[112:115], v[80:83], a[40:43]
    v_cvt_pk_bf16_f32 v34, v240, v241
    v_cvt_pk_bf16_f32 v35, v242, v243
    v_mfma_f32_16x16x32_bf16 a[40:43], v[116:119], v[84:87], a[40:43]
    v_mfma_f32_16x16x32_bf16 a[44:47], v[112:115], v[88:91], a[44:47]
    ds_read_b128 v[112:115], v2 offset:28672
    v_mfma_f32_16x16x32_bf16 a[44:47], v[116:119], v[92:95], a[44:47]
    v_exp_f32 v244, v244
    v_mfma_f32_16x16x32_bf16 v[248:251], a[240:243], v[136:139], v[152:155]
    v_exp_f32 v245, v245
    v_mfma_f32_16x16x32_bf16 v[248:251], a[244:247], v[168:171], v[248:251]
    v_exp_f32 v246, v246
    v_mfma_f32_16x16x32_bf16 v[248:251], a[248:251], v[200:203], v[248:251]
    v_exp_f32 v247, v247
    v_mfma_f32_16x16x32_bf16 v[248:251], a[252:255], v[232:235], v[248:251]
    v_cvt_pk_bf16_f32 v42, v244, v245
    v_cvt_pk_bf16_f32 v43, v246, v247
    v_mfma_f32_16x16x32_bf16 a[48:51], v[120:123], v[64:67], a[48:51]
    ds_read_b128 v[116:119], v2 offset:29696
    v_mfma_f32_16x16x32_bf16 a[48:51], v[124:127], v[68:71], a[48:51]
    v_mfma_f32_16x16x32_bf16 a[52:55], v[120:123], v[72:75], a[52:55]
    v_mfma_f32_16x16x32_bf16 a[52:55], v[124:127], v[76:79], a[52:55]
    v_mfma_f32_16x16x32_bf16 v[252:255], a[240:243], v[140:143], v[156:159]
    v_exp_f32 v248, v248
    v_mfma_f32_16x16x32_bf16 v[252:255], a[244:247], v[172:175], v[252:255]
    s_add_u32 s100, s77, 4096
    v_exp_f32 v249, v249
    v_mfma_f32_16x16x32_bf16 v[252:255], a[248:251], v[204:207], v[252:255]
    s_add_u32 m0, m0, 4096
    v_exp_f32 v250, v250
    v_mfma_f32_16x16x32_bf16 v[252:255], a[252:255], v[236:239], v[252:255]
    buffer_load_dwordx4 v1, s[36:39], s100 offen sc1 lds
    v_mfma_f32_16x16x32_bf16 a[56:59], v[120:123], v[80:83], a[56:59]
    v_exp_f32 v251, v251
    v_mfma_f32_16x16x32_bf16 a[56:59], v[124:127], v[84:87], a[56:59]
    v_cvt_pk_bf16_f32 v50, v248, v249
    v_cvt_pk_bf16_f32 v51, v250, v251
    v_mfma_f32_16x16x32_bf16 a[60:63], v[120:123], v[88:91], a[60:63]
    ds_read_b128 a[240:243], v2 offset:12288
    ds_read_b128 a[244:247], v2 offset:13312
    v_mfma_f32_16x16x32_bf16 a[60:63], v[124:127], v[92:95], a[60:63]
    s_waitcnt lgkmcnt(2)
    v_exp_f32 v252, v252
    v_mfma_f32_16x16x32_bf16 v[240:243], a[224:227], v[128:131], v[184:187]
    v_exp_f32 v253, v253
    v_mfma_f32_16x16x32_bf16 v[240:243], a[228:231], v[160:163], v[240:243]
    v_exp_f32 v254, v254
    v_mfma_f32_16x16x32_bf16 v[240:243], a[232:235], v[192:195], v[240:243]
    v_exp_f32 v255, v255
    v_mfma_f32_16x16x32_bf16 v[240:243], a[236:239], v[224:227], v[240:243]
    v_cvt_pk_bf16_f32 v58, v252, v253
    v_cvt_pk_bf16_f32 v59, v254, v255
    v_mfma_f32_16x16x32_bf16 a[144:147], v[96:99], v[64:67], a[144:147]
    ds_read_b128 a[248:251], v2 offset:14336
    ds_read_b128 a[252:255], v2 offset:15360
    v_mfma_f32_16x16x32_bf16 a[144:147], v[100:103], v[68:71], a[144:147]
    ds_read_b128 v[120:123], v2 offset:30720
    v_mfma_f32_16x16x32_bf16 a[148:151], v[96:99], v[72:75], a[148:151]
    v_exp_f32 v240, v240
    v_mfma_f32_16x16x32_bf16 a[148:151], v[100:103], v[76:79], a[148:151]
    v_exp_f32 v241, v241
    v_mfma_f32_16x16x32_bf16 v[244:247], a[224:227], v[132:135], v[148:151]
    buffer_load_dwordx4 v1, s[36:39], s100 offen offset:1024 sc1 lds
    v_mfma_f32_16x16x32_bf16 v[244:247], a[228:231], v[164:167], v[244:247]
    v_exp_f32 v242, v242
    v_mfma_f32_16x16x32_bf16 v[244:247], a[232:235], v[196:199], v[244:247]
    v_exp_f32 v243, v243
    v_mfma_f32_16x16x32_bf16 v[244:247], a[236:239], v[228:231], v[244:247]
    v_cvt_pk_bf16_f32 v36, v240, v241
    v_cvt_pk_bf16_f32 v37, v242, v243
    v_mfma_f32_16x16x32_bf16 a[152:155], v[96:99], v[80:83], a[152:155]
    ds_read_b128 v[124:127], v2 offset:31744
    v_mfma_f32_16x16x32_bf16 a[152:155], v[100:103], v[84:87], a[152:155]
    v_mfma_f32_16x16x32_bf16 a[156:159], v[96:99], v[88:91], a[156:159]
    v_mfma_f32_16x16x32_bf16 a[156:159], v[100:103], v[92:95], a[156:159]
    v_mfma_f32_16x16x32_bf16 v[248:251], a[224:227], v[136:139], v[152:155]
    v_exp_f32 v244, v244
    v_mfma_f32_16x16x32_bf16 v[248:251], a[228:231], v[168:171], v[248:251]
    v_exp_f32 v245, v245
    v_mfma_f32_16x16x32_bf16 v[248:251], a[232:235], v[200:203], v[248:251]
    v_exp_f32 v246, v246
    v_mfma_f32_16x16x32_bf16 v[248:251], a[236:239], v[232:235], v[248:251]
    v_exp_f32 v247, v247
    v_mfma_f32_16x16x32_bf16 a[160:163], v[104:107], v[64:67], a[160:163]
    v_cvt_pk_bf16_f32 v44, v244, v245
    v_cvt_pk_bf16_f32 v45, v246, v247
    v_mfma_f32_16x16x32_bf16 a[160:163], v[108:111], v[68:71], a[160:163]
    v_mfma_f32_16x16x32_bf16 a[164:167], v[104:107], v[72:75], a[164:167]
    buffer_load_dwordx4 v1, s[36:39], s100 offen offset:2048 sc1 lds
    v_mfma_f32_16x16x32_bf16 a[164:167], v[108:111], v[76:79], a[164:167]
    v_exp_f32 v248, v248
    v_mfma_f32_16x16x32_bf16 v[252:255], a[224:227], v[140:143], v[156:159]
    v_exp_f32 v249, v249
    v_mfma_f32_16x16x32_bf16 v[252:255], a[228:231], v[172:175], v[252:255]
    v_exp_f32 v250, v250
    v_mfma_f32_16x16x32_bf16 v[252:255], a[232:235], v[204:207], v[252:255]
    v_exp_f32 v251, v251
    v_mfma_f32_16x16x32_bf16 v[252:255], a[236:239], v[236:239], v[252:255]
    v_cvt_pk_bf16_f32 v52, v248, v249
    v_cvt_pk_bf16_f32 v53, v250, v251
    v_mfma_f32_16x16x32_bf16 a[168:171], v[104:107], v[80:83], a[168:171]
    v_mfma_f32_16x16x32_bf16 a[168:171], v[108:111], v[84:87], a[168:171]
    v_mfma_f32_16x16x32_bf16 a[172:175], v[104:107], v[88:91], a[172:175]
    v_mfma_f32_16x16x32_bf16 a[172:175], v[108:111], v[92:95], a[172:175]
    s_waitcnt lgkmcnt(0)
    v_mfma_f32_16x16x32_bf16 v[240:243], a[240:243], v[128:131], v[188:191]
    v_mfma_f32_16x16x32_bf16 v[240:243], a[244:247], v[160:163], v[240:243]
    v_exp_f32 v252, v252
    v_mfma_f32_16x16x32_bf16 v[240:243], a[248:251], v[192:195], v[240:243]
    v_exp_f32 v253, v253
    v_mfma_f32_16x16x32_bf16 v[240:243], a[252:255], v[224:227], v[240:243]
    v_exp_f32 v254, v254
    v_mfma_f32_16x16x32_bf16 a[176:179], v[112:115], v[64:67], a[176:179]
    buffer_load_dwordx4 v1, s[36:39], s100 offen offset:3072 sc1 lds
    v_mfma_f32_16x16x32_bf16 a[176:179], v[116:119], v[68:71], a[176:179]
    v_exp_f32 v255, v255
    v_mfma_f32_16x16x32_bf16 a[180:183], v[112:115], v[72:75], a[180:183]
    v_cvt_pk_bf16_f32 v60, v252, v253
    v_cvt_pk_bf16_f32 v61, v254, v255
    v_mfma_f32_16x16x32_bf16 a[180:183], v[116:119], v[76:79], a[180:183]
    s_cmp_eq_u32 s82, 163840
    s_cselect_b32 s82, 0, s82
    v_add_u32 v2, s82, v1
    v_mfma_f32_16x16x32_bf16 v[244:247], a[240:243], v[132:135], v[148:151]
    v_exp_f32 v240, v240
    v_mfma_f32_16x16x32_bf16 v[244:247], a[244:247], v[164:167], v[244:247]
    v_exp_f32 v241, v241
    v_mfma_f32_16x16x32_bf16 v[244:247], a[248:251], v[196:199], v[244:247]
    v_exp_f32 v242, v242
    v_mfma_f32_16x16x32_bf16 v[244:247], a[252:255], v[228:231], v[244:247]
    v_exp_f32 v243, v243
    v_mfma_f32_16x16x32_bf16 a[184:187], v[112:115], v[80:83], a[184:187]
    v_cvt_pk_bf16_f32 v38, v240, v241
    v_cvt_pk_bf16_f32 v39, v242, v243
    v_mfma_f32_16x16x32_bf16 a[184:187], v[116:119], v[84:87], a[184:187]
    v_mfma_f32_16x16x32_bf16 a[188:191], v[112:115], v[88:91], a[188:191]
    v_mfma_f32_16x16x32_bf16 a[188:191], v[116:119], v[92:95], a[188:191]
    v_mfma_f32_16x16x32_bf16 v[248:251], a[240:243], v[136:139], v[152:155]
    v_exp_f32 v244, v244
    v_mfma_f32_16x16x32_bf16 v[248:251], a[244:247], v[168:171], v[248:251]
    v_exp_f32 v245, v245
    v_mfma_f32_16x16x32_bf16 v[248:251], a[248:251], v[200:203], v[248:251]
    s_add_u32 s77, s77, 32768
    v_exp_f32 v246, v246
    v_mfma_f32_16x16x32_bf16 v[248:251], a[252:255], v[232:235], v[248:251]
    v_exp_f32 v247, v247
    v_mfma_f32_16x16x32_bf16 a[192:195], v[120:123], v[64:67], a[192:195]
    v_cvt_pk_bf16_f32 v46, v244, v245
    v_cvt_pk_bf16_f32 v47, v246, v247
    v_mfma_f32_16x16x32_bf16 a[192:195], v[124:127], v[68:71], a[192:195]
    v_mfma_f32_16x16x32_bf16 a[196:199], v[120:123], v[72:75], a[196:199]
    v_mfma_f32_16x16x32_bf16 a[196:199], v[124:127], v[76:79], a[196:199]
    v_mfma_f32_16x16x32_bf16 v[252:255], a[240:243], v[140:143], v[156:159]
    v_exp_f32 v248, v248
    v_mfma_f32_16x16x32_bf16 v[252:255], a[244:247], v[172:175], v[252:255]
    v_exp_f32 v249, v249
    v_mfma_f32_16x16x32_bf16 v[252:255], a[248:251], v[204:207], v[252:255]
    v_exp_f32 v250, v250
    v_mfma_f32_16x16x32_bf16 v[252:255], a[252:255], v[236:239], v[252:255]
    s_waitcnt vmcnt(8) lgkmcnt(0)
    s_barrier
    ds_read_b128 a[224:227], v2 offset:0
    v_mfma_f32_16x16x32_bf16 a[200:203], v[120:123], v[80:83], a[200:203]
    ds_read_b128 a[228:231], v2 offset:1024
    ds_read_b128 a[232:235], v2 offset:2048
    v_mfma_f32_16x16x32_bf16 a[200:203], v[124:127], v[84:87], a[200:203]
    ds_read_b128 a[236:239], v2 offset:3072
    v_cvt_pk_bf16_f32 v54, v248, v249
    v_mfma_f32_16x16x32_bf16 a[204:207], v[120:123], v[88:91], a[204:207]
    v_exp_f32 v251, v251
    v_mfma_f32_16x16x32_bf16 a[204:207], v[124:127], v[92:95], a[204:207]
    ds_read_b128 v[96:99], v2 offset:16384
    ds_read_b128 v[100:103], v2 offset:17408
    v_mfma_f32_16x16x32_bf16 a[208:211], a[136:139], v[64:67], a[208:211]
    v_exp_f32 v252, v252
    v_mfma_f32_16x16x32_bf16 a[208:211], a[136:139], v[68:71], a[208:211]
    v_exp_f32 v253, v253
    v_mfma_f32_16x16x32_bf16 a[212:215], a[136:139], v[72:75], a[212:215]
    v_cvt_pk_bf16_f32 v55, v250, v251
    v_cvt_pk_bf16_f32 v62, v252, v253
    v_mfma_f32_16x16x32_bf16 a[212:215], a[136:139], v[76:79], a[212:215]
    v_mfma_f32_16x16x32_bf16 a[216:219], a[136:139], v[80:83], a[216:219]
    v_mfma_f32_16x16x32_bf16 a[216:219], a[136:139], v[84:87], a[216:219]
    v_mfma_f32_16x16x32_bf16 a[220:223], a[136:139], v[88:91], a[220:223]
    v_mfma_f32_16x16x32_bf16 a[220:223], a[136:139], v[92:95], a[220:223]
    s_sub_u32 s78, s78, 1
    s_cmp_lg_u32 s78, 0
    s_cbranch_scc1 K1_LB
K1_LB_END:
    v_add_f32 v212, s12, v148
    v_fma_f32 v176, v208, s8, v212
    v_fma_f32 v177, v209, s8, v212
    v_fma_f32 v178, v210, s8, v212
    v_fma_f32 v179, v211, s8, v212
    s_nop 1
    s_waitcnt lgkmcnt(0)
    v_mfma_f32_16x16x32_bf16 v[240:243], a[224:227], v[132:135], v[176:179]
    s_mov_b32 s7, 0
    ds_read_b128 v[104:107], v2 offset:18432
    ds_read_b128 v[108:111], v2 offset:19456
    v_mfma_f32_16x16x32_bf16 v[240:243], a[228:231], v[164:167], v[240:243]
    s_lshl_b32 s29, s6, 2
    buffer_load_dwordx4 v[64:67], v11, s[48:51], s7 offen nt
    v_mfma_f32_16x16x32_bf16 v[240:243], a[232:235], v[196:199], v[240:243]
    s_mov_b32 s7, 18432
    v_exp_f32 v254, v254
    v_mfma_f32_16x16x32_bf16 v[240:243], a[236:239], v[228:231], v[240:243]
    s_lshr_b32 s29, 0x41302413, s29
    v_exp_f32 v255, v255
    v_mfma_f32_16x16x32_bf16 a[0:3], v[96:99], v[32:35], a[0:3]
    s_and_b32 s29, s29, 7
    v_cvt_pk_bf16_f32 v63, v254, v255
    ds_read_b128 a[240:243], v2 offset:4096
    v_mfma_f32_16x16x32_bf16 a[0:3], v[100:103], v[36:39], a[0:3]
    s_lshl_b32 s29, s29, 15
    buffer_load_dwordx4 v[68:71], v11, s[48:51], s7 offen nt
    v_mfma_f32_16x16x32_bf16 a[4:7], v[96:99], v[40:43], a[4:7]
    s_mov_b32 s7, 9216
    ds_read_b128 a[244:247], v2 offset:5120
    ds_read_b128 a[248:251], v2 offset:6144
    v_mfma_f32_16x16x32_bf16 a[4:7], v[100:103], v[44:47], a[4:7]
    s_add_u32 s44, s29, s75
    ds_read_b128 a[252:255], v2 offset:7168
    v_add_f32 v213, s13, v148
    v_mfma_f32_16x16x32_bf16 v[244:247], a[224:227], v[136:139], v[152:155]
    s_lshl_b32 s29, s6, 2
    ds_read_b128 v[112:115], v2 offset:20480
    v_fma_f32 v180, v208, s9, v213
    v_mfma_f32_16x16x32_bf16 v[244:247], a[228:231], v[168:171], v[244:247]
    s_lshr_b32 s29, 0x2413024, s29
    buffer_load_dwordx4 v[20:23], v11, s[48:51], s7 offen nt
    v_mfma_f32_16x16x32_bf16 v[244:247], a[232:235], v[200:203], v[244:247]
    s_mov_b32 s7, 27648
    ds_read_b128 v[116:119], v2 offset:21504
    v_fma_f32 v181, v209, s9, v213
    v_mfma_f32_16x16x32_bf16 v[244:247], a[236:239], v[232:235], v[244:247]
    s_and_b32 s29, s29, 7
    v_fma_f32 v182, v210, s9, v213
    v_fma_f32 v183, v211, s9, v213
    v_mfma_f32_16x16x32_bf16 a[8:11], v[96:99], v[48:51], a[8:11]
    s_lshl_b32 s29, s29, 15
    v_exp_f32 v240, v240
    v_mfma_f32_16x16x32_bf16 a[8:11], v[100:103], v[52:55], a[8:11]
    s_add_u32 s45, s29, s75
    buffer_load_dwordx4 v[24:27], v11, s[48:51], s7 offen nt
    v_mfma_f32_16x16x32_bf16 a[12:15], v[96:99], v[56:59], a[12:15]
    s_lshl_b32 s29, s6, 2
    v_exp_f32 v241, v241
    v_mfma_f32_16x16x32_bf16 a[12:15], v[100:103], v[60:63], a[12:15]
    s_lshr_b32 s29, 0x13024130, s29
    v_exp_f32 v242, v242
    s_waitcnt lgkmcnt(0)
    v_mfma_f32_16x16x32_bf16 a[16:19], v[104:107], v[32:35], a[16:19]
    s_and_b32 s29, s29, 7
    v_exp_f32 v243, v243
    v_mfma_f32_16x16x32_bf16 a[16:19], v[108:111], v[36:39], a[16:19]
    s_lshl_b32 s29, s29, 15
    buffer_load_dwordx4 v[144:147], v12, s[52:55], 0 offen nt
    v_mfma_f32_16x16x32_bf16 v[248:251], a[224:227], v[140:143], v[156:159]
    s_add_u32 s46, s29, s75
    v_cvt_pk_bf16_f32 v72, v240, v241
    v_cvt_pk_bf16_f32 v73, v242, v243
    v_mfma_f32_16x16x32_bf16 v[248:251], a[228:231], v[172:175], v[248:251]
    s_lshl_b32 s29, s6, 2
    ds_read_b128 v[120:123], v2 offset:22528
    ds_read_b128 v[124:127], v2 offset:23552
    v_mfma_f32_16x16x32_bf16 v[248:251], a[232:235], v[204:207], v[248:251]
    s_lshr_b32 s29, 0x24130241, s29
    v_exp_f32 v244, v244
    v_mfma_f32_16x16x32_bf16 v[248:251], a[236:239], v[236:239], v[248:251]
    s_and_b32 s29, s29, 7
    buffer_load_dwordx4 a[140:143], v13, s[52:55], 0 offen nt
    v_mfma_f32_16x16x32_bf16 a[20:23], v[104:107], v[40:43], a[20:23]
    s_lshl_b32 s29, s29, 15
    v_exp_f32 v245, v245
    v_mfma_f32_16x16x32_bf16 a[20:23], v[108:111], v[44:47], a[20:23]
    s_mov_b32 s98, 0x3fb8aa3b
    v_exp_f32 v246, v246
    v_mfma_f32_16x16x32_bf16 a[24:27], v[104:107], v[48:51], a[24:27]
    s_add_u32 s47, s29, s75
    v_exp_f32 v247, v247
    v_mfma_f32_16x16x32_bf16 a[24:27], v[108:111], v[52:55], a[24:27]
    s_lshl_b32 s29, s6, 2
    v_cvt_pk_bf16_f32 v80, v244, v245
    v_cvt_pk_bf16_f32 v81, v246, v247
    v_mfma_f32_16x16x32_bf16 a[28:31], v[104:107], v[56:59], a[28:31]
    s_lshr_b32 s29, 0x30241302, s29
    ds_read_b128 a[224:227], v2 offset:8192
    ds_read_b128 a[228:231], v2 offset:9216
    v_mfma_f32_16x16x32_bf16 a[28:31], v[108:111], v[60:63], a[28:31]
    s_lshr_b32 s61, s5, 3
    ds_read_b128 a[232:235], v2 offset:10240
    v_add_f32 v214, s14, v148
    v_mfma_f32_16x16x32_bf16 v[252:255], a[240:243], v[132:135], v[180:183]
    s_add_u32 s3, s5, s6
    ds_read_b128 a[236:239], v2 offset:11264
    v_fma_f32 v184, v208, s10, v214
    v_mfma_f32_16x16x32_bf16 v[252:255], a[244:247], v[164:167], v[252:255]
    s_and_b32 s29, s29, 7
    ds_read_b128 v[96:99], v2 offset:24576
    v_fma_f32 v185, v209, s10, v214
    v_mfma_f32_16x16x32_bf16 v[252:255], a[248:251], v[196:199], v[252:255]
    s_add_u32 s74, s4, 1
    ds_read_b128 v[100:103], v2 offset:25600
    v_fma_f32 v186, v210, s10, v214
    v_mfma_f32_16x16x32_bf16 v[252:255], a[252:255], v[228:231], v[252:255]
    s_and_b32 s28, s5, 3
    v_exp_f32 v248, v248
    v_mfma_f32_16x16x32_bf16 a[32:35], v[112:115], v[32:35], a[32:35]
    s_and_b32 s3, s3, 1
    v_exp_f32 v249, v249
    v_mfma_f32_16x16x32_bf16 a[32:35], v[116:119], v[36:39], a[32:35]
    s_lshl_b32 s29, s29, 15
    v_exp_f32 v250, v250
    v_mfma_f32_16x16x32_bf16 a[36:39], v[112:115], v[40:43], a[36:39]
    s_lshl2_add_u32 s66, s6, s61
    v_exp_f32 v251, v251
    v_mfma_f32_16x16x32_bf16 a[36:39], v[116:119], v[44:47], a[36:39]
    s_mul_i32 s71, s5, 768
    v_fma_f32 v187, v211, s10, v214
    v_cvt_pk_bf16_f32 v88, v248, v249
    v_mfma_f32_16x16x32_bf16 v[240:243], a[240:243], v[136:139], v[152:155]
    s_lshl_b32 s74, s74, 15
    v_cvt_pk_bf16_f32 v89, v250, v251
    ds_read_b128 v[104:107], v2 offset:26624
    v_mfma_f32_16x16x32_bf16 v[240:243], a[244:247], v[168:171], v[240:243]
    s_mul_i32 s28, s28, 9216
    v_exp_f32 v252, v252
    v_mfma_f32_16x16x32_bf16 v[240:243], a[248:251], v[200:203], v[240:243]
    s_lshl3_add_u32 s3, s61, s3
    v_exp_f32 v253, v253
    v_mfma_f32_16x16x32_bf16 v[240:243], a[252:255], v[232:235], v[240:243]
    s_add_u32 s79, s29, s75
    v_exp_f32 v254, v254
    v_mfma_f32_16x16x32_bf16 a[40:43], v[112:115], v[48:51], a[40:43]
    s_lshl_b32 s66, s66, 10
    v_exp_f32 v255, v255
    v_mfma_f32_16x16x32_bf16 a[40:43], v[116:119], v[52:55], a[40:43]
    s_add_u32 s71, s71, 131072
    v_cvt_pk_bf16_f32 v74, v252, v253
    v_cvt_pk_bf16_f32 v75, v254, v255
    v_mfma_f32_16x16x32_bf16 a[44:47], v[112:115], v[56:59], a[44:47]
    s_add_u32 s74, s74, s101
    ds_read_b128 v[108:111], v2 offset:27648
    ds_read_b128 v[112:115], v2 offset:28672
    v_mfma_f32_16x16x32_bf16 a[44:47], v[116:119], v[60:63], a[44:47]
    s_waitcnt lgkmcnt(2)
    v_exp_f32 v240, v240
    v_mfma_f32_16x16x32_bf16 a[48:51], v[120:123], v[32:35], a[48:51]
    v_exp_f32 v241, v241
    v_mfma_f32_16x16x32_bf16 a[48:51], v[124:127], v[36:39], a[48:51]
    v_exp_f32 v242, v242
    v_mfma_f32_16x16x32_bf16 v[244:247], a[240:243], v[140:143], v[156:159]
    v_exp_f32 v243, v243
    v_mfma_f32_16x16x32_bf16 v[244:247], a[244:247], v[172:175], v[244:247]
    v_cvt_pk_bf16_f32 v82, v240, v241
    v_cvt_pk_bf16_f32 v83, v242, v243
    v_mfma_f32_16x16x32_bf16 v[244:247], a[248:251], v[204:207], v[244:247]
    ds_read_b128 a[240:243], v2 offset:12288
    ds_read_b128 a[244:247], v2 offset:13312
    v_mfma_f32_16x16x32_bf16 v[244:247], a[252:255], v[236:239], v[244:247]
    ds_read_b128 a[248:251], v2 offset:14336
    v_add_f32 v215, s15, v148
    v_mfma_f32_16x16x32_bf16 a[52:55], v[120:123], v[40:43], a[52:55]
    ds_read_b128 a[252:255], v2 offset:15360
    v_fma_f32 v188, v208, s11, v215
    v_mfma_f32_16x16x32_bf16 a[52:55], v[124:127], v[44:47], a[52:55]
    ds_read_b128 v[116:119], v2 offset:29696
    v_fma_f32 v189, v209, s11, v215
    v_mfma_f32_16x16x32_bf16 a[56:59], v[120:123], v[48:51], a[56:59]
    v_exp_f32 v244, v244
    v_mfma_f32_16x16x32_bf16 a[56:59], v[124:127], v[52:55], a[56:59]
    v_exp_f32 v245, v245
    v_mfma_f32_16x16x32_bf16 a[60:63], v[120:123], v[56:59], a[60:63]
    v_exp_f32 v246, v246
    v_mfma_f32_16x16x32_bf16 a[60:63], v[124:127], v[60:63], a[60:63]
    v_exp_f32 v247, v247
    v_mfma_f32_16x16x32_bf16 v[248:251], a[224:227], v[132:135], v[184:187]
    v_fma_f32 v190, v210, s11, v215
    v_fma_f32 v191, v211, s11, v215
    v_mfma_f32_16x16x32_bf16 v[248:251], a[228:231], v[164:167], v[248:251]
    v_cvt_pk_bf16_f32 v90, v244, v245
    v_cvt_pk_bf16_f32 v91, v246, v247
    v_mfma_f32_16x16x32_bf16 v[248:251], a[232:235], v[196:199], v[248:251]
    ds_read_b128 v[120:123], v2 offset:30720
    ds_read_b128 v[124:127], v2 offset:31744
    v_mfma_f32_16x16x32_bf16 v[248:251], a[236:239], v[228:231], v[248:251]
    s_add_u32 m0, s76, s75
    v_bfe_u32 v8, v1, 2, 6
    v_accvgpr_read_b32 v4, a112
    v_mfma_f32_16x16x32_bf16 a[144:147], v[96:99], v[32:35], a[144:147]
    s_mov_b32 s76, s60
    buffer_load_dwordx4 v1, s[36:39], s77 offen sc1 lds
    v_mfma_f32_16x16x32_bf16 a[144:147], v[100:103], v[36:39], a[144:147]
    s_mov_b32 s60, s82
    v_exp_f32 v248, v248
    v_mfma_f32_16x16x32_bf16 a[148:151], v[96:99], v[40:43], a[148:151]
    s_add_u32 s82, s82, 32768
    v_exp_f32 v249, v249
    v_mfma_f32_16x16x32_bf16 a[148:151], v[100:103], v[44:47], a[148:151]
    v_exp_f32 v250, v250
    v_mfma_f32_16x16x32_bf16 v[252:255], a[224:227], v[136:139], v[152:155]
    v_exp_f32 v251, v251
    v_mfma_f32_16x16x32_bf16 v[252:255], a[228:231], v[168:171], v[252:255]
    v_cvt_pk_bf16_f32 v76, v248, v249
    v_cvt_pk_bf16_f32 v77, v250, v251
    v_mfma_f32_16x16x32_bf16 v[252:255], a[232:235], v[200:203], v[252:255]
    s_cmp_eq_u32 s82, 163840
    s_cselect_b32 s82, 0, s82
    v_add_u32 v2, s82, v1
    v_mfma_f32_16x16x32_bf16 v[252:255], a[236:239], v[232:235], v[252:255]
    buffer_load_dwordx4 v1, s[36:39], s77 offen offset:1024 sc1 lds
    v_mfma_f32_16x16x32_bf16 a[152:155], v[96:99], v[48:51], a[152:155]
    v_accvgpr_read_b32 v5, a116
    v_add_u32 v8, 192, v8
    v_mfma_f32_16x16x32_bf16 a[152:155], v[100:103], v[52:55], a[152:155]
    v_cvt_pk_bf16_f32 v4, 0, v4
    v_cvt_pk_bf16_f32 v5, 0, v5
    v_mfma_f32_16x16x32_bf16 a[156:159], v[96:99], v[56:59], a[156:159]
    v_exp_f32 v252, v252
    v_mfma_f32_16x16x32_bf16 a[156:159], v[100:103], v[60:63], a[156:159]
    v_exp_f32 v253, v253
    v_mfma_f32_16x16x32_bf16 a[160:163], v[104:107], v[32:35], a[160:163]
    s_waitcnt lgkmcnt(0)
    v_exp_f32 v254, v254
    v_mfma_f32_16x16x32_bf16 a[160:163], v[108:111], v[36:39], a[160:163]
    v_exp_f32 v255, v255
    v_mfma_f32_16x16x32_bf16 v[240:243], a[224:227], v[140:143], v[156:159]
    v_cvt_pk_bf16_f32 v84, v252, v253
    v_cvt_pk_bf16_f32 v85, v254, v255
    v_mfma_f32_16x16x32_bf16 v[240:243], a[228:231], v[172:175], v[240:243]
    buffer_load_dwordx4 v1, s[36:39], s77 offen offset:2048 sc1 lds
    v_mfma_f32_16x16x32_bf16 v[240:243], a[232:235], v[204:207], v[240:243]
    v_lshrrev_b32 v15, 8, v1
    ds_bpermute_b32 v4, v8, v4
    v_mfma_f32_16x16x32_bf16 v[240:243], a[236:239], v[236:239], v[240:243]
    ds_bpermute_b32 v5, v8, v5
    ds_read_b128 a[224:227], v2 offset:0
    v_mfma_f32_16x16x32_bf16 a[164:167], v[104:107], v[40:43], a[164:167]
    ds_read_b128 a[228:231], v2 offset:1024
    v_bfe_u32 v14, v1, 4, 4
    v_mfma_f32_16x16x32_bf16 a[164:167], v[108:111], v[44:47], a[164:167]
    ds_read_b128 a[232:235], v2 offset:2048
    v_lshlrev_b32 v15, 3, v15
    v_mfma_f32_16x16x32_bf16 a[168:171], v[104:107], v[48:51], a[168:171]
    ds_read_b128 a[236:239], v2 offset:3072
    v_sub_u32 v14, v14, v15
    v_mfma_f32_16x16x32_bf16 a[168:171], v[108:111], v[52:55], a[168:171]
    ds_read_b128 v[96:99], v2 offset:16384
    v_and_b32 v15, 16, v1
    v_mfma_f32_16x16x32_bf16 a[172:175], v[104:107], v[56:59], a[172:175]
    buffer_load_dwordx4 v1, s[36:39], s77 offen offset:3072 sc1 lds
    v_mfma_f32_16x16x32_bf16 a[172:175], v[108:111], v[60:63], a[172:175]
    ds_read_b128 v[100:103], v2 offset:17408
    v_mov_b32 v31, 0x3f80
    v_mfma_f32_16x16x32_bf16 v[244:247], a[240:243], v[132:135], v[188:191]
    v_exp_f32 v240, v240
    v_mfma_f32_16x16x32_bf16 v[244:247], a[244:247], v[164:167], v[244:247]
    v_exp_f32 v241, v241
    v_mfma_f32_16x16x32_bf16 v[244:247], a[248:251], v[196:199], v[244:247]
    v_exp_f32 v242, v242
    v_mfma_f32_16x16x32_bf16 v[244:247], a[252:255], v[228:231], v[244:247]
    v_exp_f32 v243, v243
    v_mfma_f32_16x16x32_bf16 a[176:179], v[112:115], v[32:35], a[176:179]
    v_cvt_pk_bf16_f32 v92, v240, v241
    v_cvt_pk_bf16_f32 v93, v242, v243
    v_mfma_f32_16x16x32_bf16 a[176:179], v[116:119], v[36:39], a[176:179]
    s_add_u32 s100, s77, 4096
    v_ashrrev_i32 v14, 1, v14
    v_lshlrev_b32 v15, v15, v31
    v_mfma_f32_16x16x32_bf16 a[180:183], v[112:115], v[40:43], a[180:183]
    s_add_u32 m0, m0, 4096
    v_exp_f32 v244, v244
    v_mfma_f32_16x16x32_bf16 a[180:183], v[116:119], v[44:47], a[180:183]
    buffer_load_dwordx4 v1, s[36:39], s100 offen sc1 lds
    v_mfma_f32_16x16x32_bf16 v[248:251], a[240:243], v[136:139], v[152:155]
    v_exp_f32 v245, v245
    v_mfma_f32_16x16x32_bf16 v[248:251], a[244:247], v[168:171], v[248:251]
    v_exp_f32 v246, v246
    v_mfma_f32_16x16x32_bf16 v[248:251], a[248:251], v[200:203], v[248:251]
    v_exp_f32 v247, v247
    v_mfma_f32_16x16x32_bf16 v[248:251], a[252:255], v[232:235], v[248:251]
    v_cvt_pk_bf16_f32 v78, v244, v245
    v_cvt_pk_bf16_f32 v79, v246, v247
    v_mfma_f32_16x16x32_bf16 a[184:187], v[112:115], v[48:51], a[184:187]
    s_waitcnt lgkmcnt(0)
    v_cmp_eq_i32 vcc, 0, v14
    v_mul_f32 v4, s98, v4
    v_mfma_f32_16x16x32_bf16 a[184:187], v[116:119], v[52:55], a[184:187]
    buffer_load_dwordx4 v1, s[36:39], s100 offen offset:1024 sc1 lds
    v_mfma_f32_16x16x32_bf16 a[188:191], v[112:115], v[56:59], a[188:191]
    v_exp_f32 v248, v248
    v_mfma_f32_16x16x32_bf16 a[188:191], v[116:119], v[60:63], a[188:191]
    v_exp_f32 v249, v249
    v_mfma_f32_16x16x32_bf16 a[192:195], v[120:123], v[32:35], a[192:195]
    v_exp_f32 v250, v250
    v_mfma_f32_16x16x32_bf16 a[192:195], v[124:127], v[36:39], a[192:195]
    v_exp_f32 v251, v251
    v_mfma_f32_16x16x32_bf16 v[252:255], a[240:243], v[140:143], v[156:159]
    v_cvt_pk_bf16_f32 v86, v248, v249
    v_cvt_pk_bf16_f32 v87, v250, v251
    v_mfma_f32_16x16x32_bf16 v[252:255], a[244:247], v[172:175], v[252:255]
    v_cndmask_b32 v216, 0, v15, vcc
    v_cmp_eq_i32 vcc, 1, v14
    v_mfma_f32_16x16x32_bf16 v[252:255], a[248:251], v[204:207], v[252:255]
    v_mul_f32 v5, s98, v5
    v_cndmask_b32 v217, 0, v15, vcc
    v_mfma_f32_16x16x32_bf16 v[252:255], a[252:255], v[236:239], v[252:255]
    buffer_load_dwordx4 v1, s[36:39], s100 offen offset:2048 sc1 lds
    v_mfma_f32_16x16x32_bf16 a[196:199], v[120:123], v[40:43], a[196:199]
    v_cmp_eq_i32 vcc, 2, v14
    v_and_b32 v31, 512, v1
    v_mfma_f32_16x16x32_bf16 a[196:199], v[124:127], v[44:47], a[196:199]
    v_cndmask_b32 v218, 0, v15, vcc
    v_cmp_eq_i32 vcc, 3, v14
    v_mfma_f32_16x16x32_bf16 a[200:203], v[120:123], v[48:51], a[200:203]
    v_exp_f32 v252, v252
    v_mfma_f32_16x16x32_bf16 a[200:203], v[124:127], v[52:55], a[200:203]
    v_exp_f32 v253, v253
    v_mfma_f32_16x16x32_bf16 a[204:207], v[120:123], v[56:59], a[204:207]
    v_cvt_pk_bf16_f32 v94, v252, v253
    v_cndmask_b32 v219, 0, v15, vcc
    v_mfma_f32_16x16x32_bf16 a[204:207], v[124:127], v[60:63], a[204:207]
    v_cmp_eq_i32 vcc, -8, v14
    v_mad_u32_u24 v31, v31, 17, v1
    v_mfma_f32_16x16x32_bf16 a[208:211], a[136:139], v[32:35], a[208:211]
    buffer_load_dwordx4 v1, s[36:39], s100 offen offset:3072 sc1 lds
    v_mfma_f32_16x16x32_bf16 a[208:211], a[136:139], v[36:39], a[208:211]
    v_cndmask_b32 v220, 0, v15, vcc
    v_cmp_eq_i32 vcc, -7, v14
    v_mfma_f32_16x16x32_bf16 a[212:215], a[136:139], v[40:43], a[212:215]
    v_exp_f32 v4, v4
    v_mfma_f32_16x16x32_bf16 a[212:215], a[136:139], v[44:47], a[212:215]
    v_exp_f32 v5, v5
    v_mfma_f32_16x16x32_bf16 a[216:219], a[136:139], v[48:51], a[216:219]
    v_cndmask_b32 v221, 0, v15, vcc
    v_cmp_eq_i32 vcc, -6, v14
    v_mfma_f32_16x16x32_bf16 a[216:219], a[136:139], v[52:55], a[216:219]
    v_add_f32 v4, 1.0, v4
    v_add_f32 v5, 1.0, v5
    v_mfma_f32_16x16x32_bf16 a[220:223], a[136:139], v[56:59], a[220:223]
    v_cndmask_b32 v222, 0, v15, vcc
    v_cmp_eq_i32 vcc, -5, v14
    v_mfma_f32_16x16x32_bf16 a[220:223], a[136:139], v[60:63], a[220:223]
    s_add_u32 s77, s77, 32768
    v_rcp_f32 v4, v4
    v_rcp_f32 v5, v5
    v_cndmask_b32 v223, 0, v15, vcc
    s_cmp_eq_u32 s6, 7
    s_cselect_b32 s16, s8, 0
    s_cselect_b32 s17, s9, 0
    s_cselect_b32 s18, s10, 0
    s_cselect_b32 s19, s11, 0
    s_cselect_b32 s20, s12, 0
    s_cselect_b32 s21, s13, 0
    s_cselect_b32 s22, s14, 0
    s_cselect_b32 s23, s15, 0
    s_cbranch_scc1 K1_J7
K1_J7_BACK:
    v_add_f32 v212, s20, v152
    v_fma_f32 v176, v208, s16, v212
    v_fma_f32 v177, v209, s16, v212
    v_fma_f32 v178, v210, s16, v212
    v_fma_f32 v179, v211, s16, v212
    s_nop 1
    s_waitcnt lgkmcnt(0)
    v_mfma_f32_16x16x32_bf16 v[240:243], a[224:227], v[136:139], v[176:179]
    s_add_u32 m0, s76, s75
    v_exp_f32 v254, v254
    v_mfma_f32_16x16x32_bf16 v[240:243], a[228:231], v[168:171], v[240:243]
    s_mov_b32 s76, s60
    buffer_load_dwordx4 v1, s[36:39], s77 offen sc1 lds
    v_mfma_f32_16x16x32_bf16 v[240:243], a[232:235], v[200:203], v[240:243]
    s_mov_b32 s60, s82
    v_exp_f32 v255, v255
    v_mfma_f32_16x16x32_bf16 v[240:243], a[236:239], v[232:235], v[240:243]
    s_add_u32 s82, s82, 32768
    ds_read_b128 v[104:107], v2 offset:18432
    v_cvt_pk_bf16_f32 v95, v254, v255
    v_mfma_f32_16x16x32_bf16 a[4:7], v[96:99], v[72:75], a[4:7]
    ds_read_b128 v[108:111], v2 offset:19456
    ds_read_b128 a[240:243], v2 offset:4096
    v_mfma_f32_16x16x32_bf16 a[4:7], v[100:103], v[76:79], a[4:7]
    ds_read_b128 a[244:247], v2 offset:5120
    v_add_f32 v213, s21, v152
    v_mfma_f32_16x16x32_bf16 a[8:11], v[96:99], v[80:83], a[8:11]
    ds_read_b128 a[248:251], v2 offset:6144
    v_fma_f32 v180, v208, s17, v213
    v_mfma_f32_16x16x32_bf16 a[8:11], v[100:103], v[84:87], a[8:11]
    ds_read_b128 a[252:255], v2 offset:7168
    v_fma_f32 v181, v209, s17, v213
    v_mfma_f32_16x16x32_bf16 a[12:15], v[96:99], v[88:91], a[12:15]
    ds_read_b128 v[112:115], v2 offset:20480
    v_fma_f32 v182, v210, s17, v213
    v_mfma_f32_16x16x32_bf16 a[12:15], v[100:103], v[92:95], a[12:15]
    ds_read_b128 v[116:119], v2 offset:21504
    v_fma_f32 v183, v211, s17, v213
    v_mfma_f32_16x16x32_bf16 v[244:247], a[224:227], v[140:143], v[156:159]
    buffer_load_dwordx4 v1, s[36:39], s77 offen offset:1024 sc1 lds
    v_mfma_f32_16x16x32_bf16 v[244:247], a[228:231], v[172:175], v[244:247]
    ds_read_b128 v[120:123], v2 offset:22528
    ds_read_b128 v[124:127], v2 offset:23552
    v_mfma_f32_16x16x32_bf16 v[244:247], a[232:235], v[204:207], v[244:247]
    ds_read_b128 a[224:227], v2 offset:8192
    v_add_f32 v214, s22, v152
    v_mfma_f32_16x16x32_bf16 v[244:247], a[236:239], v[236:239], v[244:247]
    s_waitcnt lgkmcnt(4)
    ds_read_b128 a[228:231], v2 offset:9216
    v_fma_f32 v184, v208, s18, v214
    v_mfma_f32_16x16x32_bf16 a[20:23], v[104:107], v[72:75], a[20:23]
    ds_read_b128 a[232:235], v2 offset:10240
    v_fma_f32 v185, v209, s18, v214
    v_mfma_f32_16x16x32_bf16 a[20:23], v[108:111], v[76:79], a[20:23]
    ds_read_b128 a[236:239], v2 offset:11264
    v_fma_f32 v186, v210, s18, v214
    v_mfma_f32_16x16x32_bf16 a[24:27], v[104:107], v[80:83], a[24:27]
    ds_read_b128 v[96:99], v2 offset:24576
    v_fma_f32 v187, v211, s18, v214
    v_mfma_f32_16x16x32_bf16 a[24:27], v[108:111], v[84:87], a[24:27]
    ds_read_b128 v[100:103], v2 offset:25600
    v_add_f32 v215, s23, v152
    v_mfma_f32_16x16x32_bf16 a[28:31], v[104:107], v[88:91], a[28:31]
    v_exp_f32 v240, v240
    v_mfma_f32_16x16x32_bf16 a[28:31], v[108:111], v[92:95], a[28:31]
    v_exp_f32 v241, v241
    v_mfma_f32_16x16x32_bf16 v[248:251], a[240:243], v[136:139], v[180:183]
    buffer_load_dwordx4 v1, s[36:39], s77 offen offset:2048 sc1 lds
    v_mfma_f32_16x16x32_bf16 v[248:251], a[244:247], v[168:171], v[248:251]
    v_exp_f32 v242, v242
    v_mfma_f32_16x16x32_bf16 v[248:251], a[248:251], v[200:203], v[248:251]
    v_exp_f32 v243, v243
    v_mfma_f32_16x16x32_bf16 v[248:251], a[252:255], v[232:235], v[248:251]
    v_cvt_pk_bf16_f32 v48, v240, v241
    v_cvt_pk_bf16_f32 v49, v242, v243
    v_mfma_f32_16x16x32_bf16 a[36:39], v[112:115], v[72:75], a[36:39]
    s_waitcnt lgkmcnt(0)
    ds_read_b128 v[104:107], v2 offset:26624
    ds_read_b128 v[108:111], v2 offset:27648
    v_mfma_f32_16x16x32_bf16 a[36:39], v[116:119], v[76:79], a[36:39]
    v_exp_f32 v244, v244
    v_mfma_f32_16x16x32_bf16 a[40:43], v[112:115], v[80:83], a[40:43]
    v_exp_f32 v245, v245
    v_mfma_f32_16x16x32_bf16 a[40:43], v[116:119], v[84:87], a[40:43]
    v_exp_f32 v246, v246
    v_mfma_f32_16x16x32_bf16 a[44:47], v[112:115], v[88:91], a[44:47]
    v_exp_f32 v247, v247
    v_mfma_f32_16x16x32_bf16 a[44:47], v[116:119], v[92:95], a[44:47]
    s_waitcnt vmcnt(11)
    buffer_load_dwordx4 v1, s[36:39], s77 offen offset:3072 sc1 lds
    v_mfma_f32_16x16x32_bf16 v[12:15], v[64:67], v[216:219], 0
    v_cvt_pk_bf16_f32 v56, v244, v245
    v_cvt_pk_bf16_f32 v57, v246, v247
    v_mfma_f32_16x16x32_bf16 v[16:19], v[68:71], v[216:219], 0
    ds_read_b128 v[112:115], v2 offset:28672
    ds_read_b128 v[116:119], v2 offset:29696
    v_mfma_f32_16x16x32_bf16 v[252:255], a[240:243], v[140:143], v[156:159]
    ds_read_b128 a[240:243], v2 offset:12288
    v_fma_f32 v188, v208, s19, v215
    v_mfma_f32_16x16x32_bf16 v[252:255], a[244:247], v[172:175], v[252:255]
    v_cvt_pk_bf16_f32 v12, v12, v13
    v_cvt_pk_bf16_f32 v13, v14, v15
    v_mfma_f32_16x16x32_bf16 v[252:255], a[248:251], v[204:207], v[252:255]
    v_cvt_pk_bf16_f32 v14, v16, v17
    v_cvt_pk_bf16_f32 v15, v18, v19
    v_mfma_f32_16x16x32_bf16 v[252:255], a[252:255], v[236:239], v[252:255]
    buffer_store_dwordx4 v[12:15], v31, s[56:59], s63 offen offset:0 sc1
    v_mfma_f32_16x16x32_bf16 a[52:55], v[120:123], v[72:75], a[52:55]
    ds_read_b128 a[244:247], v2 offset:13312
    ds_read_b128 a[248:251], v2 offset:14336
    v_mfma_f32_16x16x32_bf16 a[52:55], v[124:127], v[76:79], a[52:55]
    ds_read_b128 a[252:255], v2 offset:15360
    v_fma_f32 v189, v209, s19, v215
    v_mfma_f32_16x16x32_bf16 a[56:59], v[120:123], v[80:83], a[56:59]
    s_add_u32 s100, s77, 4096
    v_exp_f32 v248, v248
    v_mfma_f32_16x16x32_bf16 a[56:59], v[124:127], v[84:87], a[56:59]
    s_add_u32 m0, m0, 4096
    v_exp_f32 v249, v249
    v_mfma_f32_16x16x32_bf16 a[60:63], v[120:123], v[88:91], a[60:63]
    buffer_load_dwordx4 v1, s[36:39], s100 offen sc1 lds
    v_mfma_f32_16x16x32_bf16 a[60:63], v[124:127], v[92:95], a[60:63]
    v_exp_f32 v250, v250
    v_mfma_f32_16x16x32_bf16 v[12:15], v[64:67], v[220:223], 0
    v_exp_f32 v251, v251
    v_mfma_f32_16x16x32_bf16 v[16:19], v[68:71], v[220:223], 0
    v_fma_f32 v190, v210, s19, v215
    v_fma_f32 v191, v211, s19, v215
    v_mfma_f32_16x16x32_bf16 v[240:243], a[224:227], v[136:139], v[184:187]
    v_cvt_pk_bf16_f32 v50, v248, v249
    v_cvt_pk_bf16_f32 v51, v250, v251
    v_mfma_f32_16x16x32_bf16 v[240:243], a[228:231], v[168:171], v[240:243]
    v_cvt_pk_bf16_f32 v12, v12, v13
    v_cvt_pk_bf16_f32 v13, v14, v15
    v_mfma_f32_16x16x32_bf16 v[240:243], a[232:235], v[200:203], v[240:243]
    v_cvt_pk_bf16_f32 v14, v16, v17
    v_cvt_pk_bf16_f32 v15, v18, v19
    v_mfma_f32_16x16x32_bf16 v[240:243], a[236:239], v[232:235], v[240:243]
    buffer_store_dwordx4 v[12:15], v31, s[56:59], s63 offen offset:1024 sc1
    v_mfma_f32_16x16x32_bf16 a[148:151], v[96:99], v[72:75], a[148:151]
    buffer_load_dwordx4 v1, s[36:39], s100 offen offset:1024 sc1 lds
    v_mfma_f32_16x16x32_bf16 a[148:151], v[100:103], v[76:79], a[148:151]
    ds_read_b128 v[120:123], v2 offset:30720
    ds_read_b128 v[124:127], v2 offset:31744
    v_mfma_f32_16x16x32_bf16 a[152:155], v[96:99], v[80:83], a[152:155]
    v_exp_f32 v252, v252
    v_mfma_f32_16x16x32_bf16 a[152:155], v[100:103], v[84:87], a[152:155]
    v_exp_f32 v253, v253
    v_mfma_f32_16x16x32_bf16 a[156:159], v[96:99], v[88:91], a[156:159]
    v_exp_f32 v254, v254
    v_mfma_f32_16x16x32_bf16 a[156:159], v[100:103], v[92:95], a[156:159]
    v_exp_f32 v255, v255
    v_mfma_f32_16x16x32_bf16 v[12:15], v[20:23], v[216:219], 0
    v_cvt_pk_bf16_f32 v58, v252, v253
    v_cvt_pk_bf16_f32 v59, v254, v255
    v_mfma_f32_16x16x32_bf16 v[16:19], v[24:27], v[216:219], 0
    v_exp_f32 v240, v240
    v_mfma_f32_16x16x32_bf16 v[244:247], a[224:227], v[140:143], v[156:159]
    v_exp_f32 v241, v241
    v_mfma_f32_16x16x32_bf16 v[244:247], a[228:231], v[172:175], v[244:247]
    v_exp_f32 v242, v242
    v_mfma_f32_16x16x32_bf16 v[244:247], a[232:235], v[204:207], v[244:247]
    buffer_load_dwordx4 v1, s[36:39], s100 offen offset:2048 sc1 lds
    v_mfma_f32_16x16x32_bf16 v[244:247], a[236:239], v[236:239], v[244:247]
    s_waitcnt lgkmcnt(0)
    v_cvt_pk_bf16_f32 v12, v12, v13
    v_cvt_pk_bf16_f32 v13, v14, v15
    v_mfma_f32_16x16x32_bf16 a[164:167], v[104:107], v[72:75], a[164:167]
    v_cvt_pk_bf16_f32 v14, v16, v17
    v_cvt_pk_bf16_f32 v15, v18, v19
    v_mfma_f32_16x16x32_bf16 a[164:167], v[108:111], v[76:79], a[164:167]
    buffer_store_dwordx4 v[12:15], v31, s[56:59], s63 offen offset:512 sc1
    v_mfma_f32_16x16x32_bf16 a[168:171], v[104:107], v[80:83], a[168:171]
    s_cmp_eq_u32 s82, 163840
    s_cselect_b32 s82, 0, s82
    v_add_u32 v2, s82, v1
    v_mfma_f32_16x16x32_bf16 a[168:171], v[108:111], v[84:87], a[168:171]
    v_exp_f32 v243, v243
    v_mfma_f32_16x16x32_bf16 a[172:175], v[104:107], v[88:91], a[172:175]
    v_exp_f32 v244, v244
    v_mfma_f32_16x16x32_bf16 a[172:175], v[108:111], v[92:95], a[172:175]
    v_exp_f32 v245, v245
    v_mfma_f32_16x16x32_bf16 v[12:15], v[20:23], v[220:223], 0
    v_exp_f32 v246, v246
    v_mfma_f32_16x16x32_bf16 v[16:19], v[24:27], v[220:223], 0
    buffer_load_dwordx4 v1, s[36:39], s100 offen offset:3072 sc1 lds
    v_mfma_f32_16x16x32_bf16 v[248:251], a[240:243], v[136:139], v[188:191]
    v_exp_f32 v247, v247
    v_mfma_f32_16x16x32_bf16 v[248:251], a[244:247], v[168:171], v[248:251]
    v_cvt_pk_bf16_f32 v52, v240, v241
    v_cvt_pk_bf16_f32 v53, v242, v243
    v_mfma_f32_16x16x32_bf16 v[248:251], a[248:251], v[200:203], v[248:251]
    v_cvt_pk_bf16_f32 v12, v12, v13
    v_cvt_pk_bf16_f32 v13, v14, v15
    v_mfma_f32_16x16x32_bf16 v[248:251], a[252:255], v[232:235], v[248:251]
    v_cvt_pk_bf16_f32 v14, v16, v17
    v_cvt_pk_bf16_f32 v15, v18, v19
    v_mfma_f32_16x16x32_bf16 a[180:183], v[112:115], v[72:75], a[180:183]
    buffer_store_dwordx4 v[12:15], v31, s[56:59], s63 offen offset:1536 sc1
    v_mfma_f32_16x16x32_bf16 a[180:183], v[116:119], v[76:79], a[180:183]
    v_cvt_pk_bf16_f32 v60, v244, v245
    v_cvt_pk_bf16_f32 v61, v246, v247
    v_mfma_f32_16x16x32_bf16 a[184:187], v[112:115], v[80:83], a[184:187]
    v_exp_f32 v248, v248
    v_mfma_f32_16x16x32_bf16 a[184:187], v[116:119], v[84:87], a[184:187]
    v_exp_f32 v249, v249
    v_mfma_f32_16x16x32_bf16 a[188:191], v[112:115], v[88:91], a[188:191]
    s_add_u32 s77, s77, 32768
    v_exp_f32 v250, v250
    v_mfma_f32_16x16x32_bf16 a[188:191], v[116:119], v[92:95], a[188:191]
    v_exp_f32 v251, v251
    v_mfma_f32_16x16x32_bf16 v[12:15], v[144:147], v[216:219], 0
    v_cvt_pk_bf16_f32 v54, v248, v249
    v_cvt_pk_bf16_f32 v55, v250, v251
    v_mfma_f32_16x16x32_bf16 v[16:19], a[140:143], v[216:219], 0
    v_accvgpr_read_b32 v6, a120
    v_accvgpr_read_b32 v7, a124
    v_mfma_f32_16x16x32_bf16 v[252:255], a[240:243], v[140:143], v[156:159]
    v_cvt_pk_bf16_f32 v6, 0, v6
    v_cvt_pk_bf16_f32 v7, 0, v7
    v_mfma_f32_16x16x32_bf16 v[252:255], a[244:247], v[172:175], v[252:255]
    v_cvt_pk_bf16_f32 v12, v12, v13
    v_cvt_pk_bf16_f32 v13, v14, v15
    v_mfma_f32_16x16x32_bf16 v[252:255], a[248:251], v[204:207], v[252:255]
    v_cvt_pk_bf16_f32 v14, v16, v17
    v_cvt_pk_bf16_f32 v15, v18, v19
    v_mfma_f32_16x16x32_bf16 v[252:255], a[252:255], v[236:239], v[252:255]
    buffer_store_dwordx4 v[12:15], v1, s[56:59], s64 offen offset:0 sc1
    v_mfma_f32_16x16x32_bf16 a[196:199], v[120:123], v[72:75], a[196:199]
    ds_bpermute_b32 v6, v8, v6
    ds_bpermute_b32 v7, v8, v7
    v_mfma_f32_16x16x32_bf16 a[196:199], v[124:127], v[76:79], a[196:199]
    s_waitcnt vmcnt(8) lgkmcnt(0)
    s_barrier
    ds_read_b128 a[224:227], v2 offset:0
    v_mfma_f32_16x16x32_bf16 a[200:203], v[120:123], v[80:83], a[200:203]
    ds_read_b128 a[228:231], v2 offset:1024
    ds_read_b128 a[232:235], v2 offset:2048
    v_mfma_f32_16x16x32_bf16 a[200:203], v[124:127], v[84:87], a[200:203]
    ds_read_b128 a[236:239], v2 offset:3072
    v_mul_f32 v6, s98, v6
    v_mfma_f32_16x16x32_bf16 a[204:207], v[120:123], v[88:91], a[204:207]
    ds_read_b128 v[96:99], v2 offset:16384
    v_mul_f32 v7, s98, v7
    v_mfma_f32_16x16x32_bf16 a[204:207], v[124:127], v[92:95], a[204:207]
    v_exp_f32 v252, v252
    v_mfma_f32_16x16x32_bf16 v[12:15], v[144:147], v[220:223], 0
    v_exp_f32 v253, v253
    v_mfma_f32_16x16x32_bf16 v[16:19], a[140:143], v[220:223], 0
    ds_read_b128 v[100:103], v2 offset:17408
    v_cvt_pk_bf16_f32 v62, v252, v253
    v_mfma_f32_16x16x32_bf16 a[212:215], a[136:139], v[72:75], a[212:215]
    v_exp_f32 v6, v6
    v_mfma_f32_16x16x32_bf16 a[212:215], a[136:139], v[76:79], a[212:215]
    v_exp_f32 v7, v7
    v_mfma_f32_16x16x32_bf16 a[216:219], a[136:139], v[80:83], a[216:219]
    v_cvt_pk_bf16_f32 v12, v12, v13
    v_cvt_pk_bf16_f32 v13, v14, v15
    v_mfma_f32_16x16x32_bf16 a[216:219], a[136:139], v[84:87], a[216:219]
    v_cvt_pk_bf16_f32 v14, v16, v17
    v_cvt_pk_bf16_f32 v15, v18, v19
    v_mfma_f32_16x16x32_bf16 a[220:223], a[136:139], v[88:91], a[220:223]
    buffer_store_dwordx4 v[12:15], v1, s[56:59], s62 offen offset:0 sc1
    v_mfma_f32_16x16x32_bf16 a[220:223], a[136:139], v[92:95], a[220:223]
    v_add_f32 v6, 1.0, v6
    v_add_f32 v7, 1.0, v7
    v_rcp_f32 v6, v6
    v_rcp_f32 v7, v7
    s_nop 1
    v_accvgpr_read_b32 v9, a208
    v_cmp_nge_f32 vcc, 0x71800000, v9
    v_rcp_f32 v10, v9
    s_nop 0
    s_or_b64 s[84:85], s[84:85], vcc
    v_mul_f32 v10, v10, v4
    v_accvgpr_read_b32 v12, a0
    v_accvgpr_read_b32 v13, a1
    v_accvgpr_read_b32 v14, a2
    v_accvgpr_read_b32 v15, a3
    v_accvgpr_read_b32 v16, a16
    v_accvgpr_read_b32 v17, a17
    v_accvgpr_read_b32 v18, a18
    v_accvgpr_read_b32 v19, a19
    v_pk_mul_f32 v[12:13], v[12:13], v[10:11] op_sel_hi:[1,0]
    v_pk_mul_f32 v[14:15], v[14:15], v[10:11] op_sel_hi:[1,0]
    v_pk_mul_f32 v[16:17], v[16:17], v[10:11] op_sel_hi:[1,0]
    v_pk_mul_f32 v[18:19], v[18:19], v[10:11] op_sel_hi:[1,0]
    v_cvt_pk_bf16_f32 v12, v12, v13
    v_cvt_pk_bf16_f32 v13, v14, v15
    v_cvt_pk_bf16_f32 v14, v16, v17
    v_cvt_pk_bf16_f32 v15, v18, v19
    buffer_store_dwordx4 v[12:15], v1, s[40:43], s80 offen offset:0 sc1
    v_accvgpr_read_b32 v20, a32
    v_accvgpr_read_b32 v21, a33
    v_accvgpr_read_b32 v22, a34
    v_accvgpr_read_b32 v23, a35
    v_accvgpr_read_b32 v24, a48
    v_accvgpr_read_b32 v25, a49
    v_accvgpr_read_b32 v26, a50
    v_accvgpr_read_b32 v27, a51
    v_pk_mul_f32 v[20:21], v[20:21], v[10:11] op_sel_hi:[1,0]
    v_pk_mul_f32 v[22:23], v[22:23], v[10:11] op_sel_hi:[1,0]
    v_pk_mul_f32 v[24:25], v[24:25], v[10:11] op_sel_hi:[1,0]
    v_pk_mul_f32 v[26:27], v[26:27], v[10:11] op_sel_hi:[1,0]
    v_cvt_pk_bf16_f32 v20, v20, v21
    v_cvt_pk_bf16_f32 v21, v22, v23
    v_cvt_pk_bf16_f32 v22, v24, v25
    v_cvt_pk_bf16_f32 v23, v26, v27
    buffer_store_dwordx4 v[20:23], v1, s[40:43], s80 offen offset:1024 sc1
    v_accvgpr_read_b32 v12, a144
    v_accvgpr_read_b32 v13, a145
    v_accvgpr_read_b32 v14, a146
    v_accvgpr_read_b32 v15, a147
    v_accvgpr_read_b32 v16, a160
    v_accvgpr_read_b32 v17, a161
    v_accvgpr_read_b32 v18, a162
    v_accvgpr_read_b32 v19, a163
    v_pk_mul_f32 v[12:13], v[12:13], v[10:11] op_sel_hi:[1,0]
    v_pk_mul_f32 v[14:15], v[14:15], v[10:11] op_sel_hi:[1,0]
    v_pk_mul_f32 v[16:17], v[16:17], v[10:11] op_sel_hi:[1,0]
    v_pk_mul_f32 v[18:19], v[18:19], v[10:11] op_sel_hi:[1,0]
    v_cvt_pk_bf16_f32 v12, v12, v13
    v_cvt_pk_bf16_f32 v13, v14, v15
    v_cvt_pk_bf16_f32 v14, v16, v17
    v_cvt_pk_bf16_f32 v15, v18, v19
    buffer_store_dwordx4 v[12:15], v1, s[40:43], s80 offen offset:2048 sc1
    v_accvgpr_read_b32 v20, a176
    v_accvgpr_read_b32 v21, a177
    v_accvgpr_read_b32 v22, a178
    v_accvgpr_read_b32 v23, a179
    v_accvgpr_read_b32 v24, a192
    v_accvgpr_read_b32 v25, a193
    v_accvgpr_read_b32 v26, a194
    v_accvgpr_read_b32 v27, a195
    v_pk_mul_f32 v[20:21], v[20:21], v[10:11] op_sel_hi:[1,0]
    v_pk_mul_f32 v[22:23], v[22:23], v[10:11] op_sel_hi:[1,0]
    v_pk_mul_f32 v[24:25], v[24:25], v[10:11] op_sel_hi:[1,0]
    v_pk_mul_f32 v[26:27], v[26:27], v[10:11] op_sel_hi:[1,0]
    v_cvt_pk_bf16_f32 v20, v20, v21
    v_cvt_pk_bf16_f32 v21, v22, v23
    v_cvt_pk_bf16_f32 v22, v24, v25
    v_cvt_pk_bf16_f32 v23, v26, v27
    buffer_store_dwordx4 v[20:23], v1, s[40:43], s80 offen offset:3072 sc1
    v_accvgpr_read_b32 v9, a212
    v_cmp_nge_f32 vcc, 0x71800000, v9
    v_rcp_f32 v10, v9
    s_nop 0
    s_or_b64 s[84:85], s[84:85], vcc
    v_mul_f32 v10, v10, v5
    s_add_u32 s72, s80, 622592
    v_accvgpr_read_b32 v12, a4
    v_accvgpr_read_b32 v13, a5
    v_accvgpr_read_b32 v14, a6
    v_accvgpr_read_b32 v15, a7
    v_accvgpr_read_b32 v16, a20
    v_accvgpr_read_b32 v17, a21
    v_accvgpr_read_b32 v18, a22
    v_accvgpr_read_b32 v19, a23
    v_pk_mul_f32 v[12:13], v[12:13], v[10:11] op_sel_hi:[1,0]
    v_pk_mul_f32 v[14:15], v[14:15], v[10:11] op_sel_hi:[1,0]
    v_pk_mul_f32 v[16:17], v[16:17], v[10:11] op_sel_hi:[1,0]
    v_pk_mul_f32 v[18:19], v[18:19], v[10:11] op_sel_hi:[1,0]
    v_cvt_pk_bf16_f32 v12, v12, v13
    v_cvt_pk_bf16_f32 v13, v14, v15
    v_cvt_pk_bf16_f32 v14, v16, v17
    v_cvt_pk_bf16_f32 v15, v18, v19
    buffer_store_dwordx4 v[12:15], v1, s[40:43], s72 offen offset:0 sc1
    v_accvgpr_read_b32 v20, a36
    v_accvgpr_read_b32 v21, a37
    v_accvgpr_read_b32 v22, a38
    v_accvgpr_read_b32 v23, a39
    v_accvgpr_read_b32 v24, a52
    v_accvgpr_read_b32 v25, a53
    v_accvgpr_read_b32 v26, a54
    v_accvgpr_read_b32 v27, a55
    v_pk_mul_f32 v[20:21], v[20:21], v[10:11] op_sel_hi:[1,0]
    v_pk_mul_f32 v[22:23], v[22:23], v[10:11] op_sel_hi:[1,0]
    v_pk_mul_f32 v[24:25], v[24:25], v[10:11] op_sel_hi:[1,0]
    v_pk_mul_f32 v[26:27], v[26:27], v[10:11] op_sel_hi:[1,0]
    v_cvt_pk_bf16_f32 v20, v20, v21
    v_cvt_pk_bf16_f32 v21, v22, v23
    v_cvt_pk_bf16_f32 v22, v24, v25
    v_cvt_pk_bf16_f32 v23, v26, v27
    buffer_store_dwordx4 v[20:23], v1, s[40:43], s72 offen offset:1024 sc1
    v_accvgpr_read_b32 v12, a148
    v_accvgpr_read_b32 v13, a149
    v_accvgpr_read_b32 v14, a150
    v_accvgpr_read_b32 v15, a151
    v_accvgpr_read_b32 v16, a164
    v_accvgpr_read_b32 v17, a165
    v_accvgpr_read_b32 v18, a166
    v_accvgpr_read_b32 v19, a167
    v_pk_mul_f32 v[12:13], v[12:13], v[10:11] op_sel_hi:[1,0]
    v_pk_mul_f32 v[14:15], v[14:15], v[10:11] op_sel_hi:[1,0]
    v_pk_mul_f32 v[16:17], v[16:17], v[10:11] op_sel_hi:[1,0]
    v_pk_mul_f32 v[18:19], v[18:19], v[10:11] op_sel_hi:[1,0]
    v_cvt_pk_bf16_f32 v12, v12, v13
    v_cvt_pk_bf16_f32 v13, v14, v15
    v_cvt_pk_bf16_f32 v14, v16, v17
    v_cvt_pk_bf16_f32 v15, v18, v19
    buffer_store_dwordx4 v[12:15], v1, s[40:43], s72 offen offset:2048 sc1
    v_accvgpr_read_b32 v20, a180
    v_accvgpr_read_b32 v21, a181
    v_accvgpr_read_b32 v22, a182
    v_accvgpr_read_b32 v23, a183
    v_accvgpr_read_b32 v24, a196
    v_accvgpr_read_b32 v25, a197
    v_accvgpr_read_b32 v26, a198
    v_accvgpr_read_b32 v27, a199
    v_pk_mul_f32 v[20:21], v[20:21], v[10:11] op_sel_hi:[1,0]
    v_pk_mul_f32 v[22:23], v[22:23], v[10:11] op_sel_hi:[1,0]
    v_pk_mul_f32 v[24:25], v[24:25], v[10:11] op_sel_hi:[1,0]
    v_pk_mul_f32 v[26:27], v[26:27], v[10:11] op_sel_hi:[1,0]
    v_cvt_pk_bf16_f32 v20, v20, v21
    v_cvt_pk_bf16_f32 v21, v22, v23
    v_cvt_pk_bf16_f32 v22, v24, v25
    v_cvt_pk_bf16_f32 v23, v26, v27
    buffer_store_dwordx4 v[20:23], v1, s[40:43], s72 offen offset:3072 sc1
    v_mov_b32 v9, 1
    v_lshlrev_b32 v216, 20, v1
    s_lshl2_add_u32 s7, s4, s101
    s_add_u32 s7, s7, 163840
    s_waitcnt vmcnt(8)
    buffer_store_dword v9, v216, s[32:35], s7 offen sc1
    s_sub_u32 s78, 14, s6
    s_sub_u32 s78, s78, s6
    s_cmp_eq_u32 s78, 0
    s_cbranch_scc1 K1_LS_END
.p2align 3
K1_LS:
    s_waitcnt lgkmcnt(0)
    v_mfma_f32_16x16x32_bf16 v[240:243], a[224:227], v[136:139], v[176:179]
    s_add_u32 m0, s76, s75
    v_exp_f32 v254, v254
    v_mfma_f32_16x16x32_bf16 v[240:243], a[228:231], v[168:171], v[240:243]
    s_mov_b32 s76, s60
    v_exp_f32 v255, v255
    v_mfma_f32_16x16x32_bf16 v[240:243], a[232:235], v[200:203], v[240:243]
    s_mov_b32 s60, s82
    buffer_load_dwordx4 v1, s[36:39], s77 offen sc1 lds
    v_mfma_f32_16x16x32_bf16 v[240:243], a[236:239], v[232:235], v[240:243]
    s_add_u32 s82, s82, 32768
    ds_read_b128 v[104:107], v2 offset:18432
    v_cvt_pk_bf16_f32 v63, v254, v255
    v_mfma_f32_16x16x32_bf16 a[8:11], v[96:99], v[48:51], a[8:11]
    ds_read_b128 v[108:111], v2 offset:19456
    ds_read_b128 a[240:243], v2 offset:4096
    v_mfma_f32_16x16x32_bf16 a[8:11], v[100:103], v[52:55], a[8:11]
    ds_read_b128 a[244:247], v2 offset:5120
    v_mfma_f32_16x16x32_bf16 a[12:15], v[96:99], v[56:59], a[12:15]
    buffer_load_dwordx4 v1, s[36:39], s77 offen offset:1024 sc1 lds
    v_mfma_f32_16x16x32_bf16 a[12:15], v[100:103], v[60:63], a[12:15]
    ds_read_b128 a[248:251], v2 offset:6144
    ds_read_b128 a[252:255], v2 offset:7168
    v_mfma_f32_16x16x32_bf16 v[244:247], a[224:227], v[140:143], v[156:159]
    v_exp_f32 v240, v240
    v_mfma_f32_16x16x32_bf16 v[244:247], a[228:231], v[172:175], v[244:247]
    ds_read_b128 v[112:115], v2 offset:20480
    ds_read_b128 v[116:119], v2 offset:21504
    v_mfma_f32_16x16x32_bf16 v[244:247], a[232:235], v[204:207], v[244:247]
    v_exp_f32 v241, v241
    v_mfma_f32_16x16x32_bf16 v[244:247], a[236:239], v[236:239], v[244:247]
    s_waitcnt lgkmcnt(4)
    ds_read_b128 v[120:123], v2 offset:22528
    ds_read_b128 v[124:127], v2 offset:23552
    v_mfma_f32_16x16x32_bf16 a[24:27], v[104:107], v[48:51], a[24:27]
    buffer_load_dwordx4 v1, s[36:39], s77 offen offset:2048 sc1 lds
    v_mfma_f32_16x16x32_bf16 a[24:27], v[108:111], v[52:55], a[24:27]
    ds_read_b128 a[224:227], v2 offset:8192
    ds_read_b128 a[228:231], v2 offset:9216
    v_mfma_f32_16x16x32_bf16 a[28:31], v[104:107], v[56:59], a[28:31]
    ds_read_b128 a[232:235], v2 offset:10240
    v_cvt_pk_bf16_f32 v80, v240, v241
    v_mfma_f32_16x16x32_bf16 a[28:31], v[108:111], v[60:63], a[28:31]
    v_exp_f32 v242, v242
    v_mfma_f32_16x16x32_bf16 v[248:251], a[240:243], v[136:139], v[180:183]
    ds_read_b128 a[236:239], v2 offset:11264
    ds_read_b128 v[96:99], v2 offset:24576
    v_mfma_f32_16x16x32_bf16 v[248:251], a[244:247], v[168:171], v[248:251]
    s_waitcnt lgkmcnt(5)
    v_exp_f32 v243, v243
    v_mfma_f32_16x16x32_bf16 v[248:251], a[248:251], v[200:203], v[248:251]
    buffer_load_dwordx4 v1, s[36:39], s77 offen offset:3072 sc1 lds
    v_mfma_f32_16x16x32_bf16 v[248:251], a[252:255], v[232:235], v[248:251]
    ds_read_b128 v[100:103], v2 offset:25600
    v_cvt_pk_bf16_f32 v81, v242, v243
    v_mfma_f32_16x16x32_bf16 a[40:43], v[112:115], v[48:51], a[40:43]
    ds_read_b128 v[104:107], v2 offset:26624
    ds_read_b128 v[108:111], v2 offset:27648
    v_mfma_f32_16x16x32_bf16 a[40:43], v[116:119], v[52:55], a[40:43]
    v_exp_f32 v244, v244
    v_mfma_f32_16x16x32_bf16 a[44:47], v[112:115], v[56:59], a[44:47]
    v_exp_f32 v245, v245
    v_mfma_f32_16x16x32_bf16 a[44:47], v[116:119], v[60:63], a[44:47]
    s_add_u32 s100, s77, 4096
    v_exp_f32 v246, v246
    v_mfma_f32_16x16x32_bf16 v[252:255], a[240:243], v[140:143], v[156:159]
    s_add_u32 m0, m0, 4096
    v_exp_f32 v247, v247
    v_mfma_f32_16x16x32_bf16 v[252:255], a[244:247], v[172:175], v[252:255]
    buffer_load_dwordx4 v1, s[36:39], s100 offen sc1 lds
    v_mfma_f32_16x16x32_bf16 v[252:255], a[248:251], v[204:207], v[252:255]
    v_cvt_pk_bf16_f32 v88, v244, v245
    v_cvt_pk_bf16_f32 v89, v246, v247
    v_mfma_f32_16x16x32_bf16 v[252:255], a[252:255], v[236:239], v[252:255]
    ds_read_b128 a[240:243], v2 offset:12288
    ds_read_b128 a[244:247], v2 offset:13312
    v_mfma_f32_16x16x32_bf16 a[56:59], v[120:123], v[48:51], a[56:59]
    v_exp_f32 v248, v248
    v_mfma_f32_16x16x32_bf16 a[56:59], v[124:127], v[52:55], a[56:59]
    buffer_load_dwordx4 v1, s[36:39], s100 offen offset:1024 sc1 lds
    v_mfma_f32_16x16x32_bf16 a[60:63], v[120:123], v[56:59], a[60:63]
    ds_read_b128 a[248:251], v2 offset:14336
    ds_read_b128 a[252:255], v2 offset:15360
    v_mfma_f32_16x16x32_bf16 a[60:63], v[124:127], v[60:63], a[60:63]
    s_waitcnt lgkmcnt(4)
    v_exp_f32 v249, v249
    v_mfma_f32_16x16x32_bf16 v[240:243], a[224:227], v[136:139], v[184:187]
    ds_read_b128 v[112:115], v2 offset:28672
    ds_read_b128 v[116:119], v2 offset:29696
    v_mfma_f32_16x16x32_bf16 v[240:243], a[228:231], v[168:171], v[240:243]
    v_exp_f32 v250, v250
    v_mfma_f32_16x16x32_bf16 v[240:243], a[232:235], v[200:203], v[240:243]
    v_exp_f32 v251, v251
    v_mfma_f32_16x16x32_bf16 v[240:243], a[236:239], v[232:235], v[240:243]
    buffer_load_dwordx4 v1, s[36:39], s100 offen offset:2048 sc1 lds
    v_mfma_f32_16x16x32_bf16 a[152:155], v[96:99], v[48:51], a[152:155]
    v_cvt_pk_bf16_f32 v82, v248, v249
    v_cvt_pk_bf16_f32 v83, v250, v251
    v_mfma_f32_16x16x32_bf16 a[152:155], v[100:103], v[52:55], a[152:155]
    ds_read_b128 v[120:123], v2 offset:30720
    ds_read_b128 v[124:127], v2 offset:31744
    v_mfma_f32_16x16x32_bf16 a[156:159], v[96:99], v[56:59], a[156:159]
    v_exp_f32 v252, v252
    v_mfma_f32_16x16x32_bf16 a[156:159], v[100:103], v[60:63], a[156:159]
    v_exp_f32 v253, v253
    v_mfma_f32_16x16x32_bf16 v[244:247], a[224:227], v[140:143], v[156:159]
    v_exp_f32 v254, v254
    v_mfma_f32_16x16x32_bf16 v[244:247], a[228:231], v[172:175], v[244:247]
    buffer_load_dwordx4 v1, s[36:39], s100 offen offset:3072 sc1 lds
    v_mfma_f32_16x16x32_bf16 v[244:247], a[232:235], v[204:207], v[244:247]
    v_exp_f32 v255, v255
    v_mfma_f32_16x16x32_bf16 v[244:247], a[236:239], v[236:239], v[244:247]
    s_cmp_eq_u32 s82, 163840
    s_cselect_b32 s82, 0, s82
    v_cvt_pk_bf16_f32 v90, v252, v253
    v_mfma_f32_16x16x32_bf16 a[168:171], v[104:107], v[48:51], a[168:171]
    v_cvt_pk_bf16_f32 v91, v254, v255
    v_add_u32 v2, s82, v1
    v_mfma_f32_16x16x32_bf16 a[168:171], v[108:111], v[52:55], a[168:171]
    ds_read_b128 a[224:227], v2 offset:0
    ds_read_b128 a[228:231], v2 offset:1024
    v_mfma_f32_16x16x32_bf16 a[172:175], v[104:107], v[56:59], a[172:175]
    s_add_u32 s77, s77, 32768
    v_exp_f32 v240, v240
    v_mfma_f32_16x16x32_bf16 a[172:175], v[108:111], v[60:63], a[172:175]
    s_waitcnt lgkmcnt(2)
    ds_read_b128 a[232:235], v2 offset:2048
    ds_read_b128 a[236:239], v2 offset:3072
    v_mfma_f32_16x16x32_bf16 v[248:251], a[240:243], v[136:139], v[188:191]
    v_exp_f32 v241, v241
    v_mfma_f32_16x16x32_bf16 v[248:251], a[244:247], v[168:171], v[248:251]
    ds_read_b128 v[96:99], v2 offset:16384
    ds_read_b128 v[100:103], v2 offset:17408
    v_mfma_f32_16x16x32_bf16 v[248:251], a[248:251], v[200:203], v[248:251]
    v_exp_f32 v242, v242
    v_mfma_f32_16x16x32_bf16 v[248:251], a[252:255], v[232:235], v[248:251]
    v_exp_f32 v243, v243
    v_mfma_f32_16x16x32_bf16 a[184:187], v[112:115], v[48:51], a[184:187]
    v_exp_f32 v244, v244
    v_mfma_f32_16x16x32_bf16 a[184:187], v[116:119], v[52:55], a[184:187]
    v_exp_f32 v245, v245
    v_mfma_f32_16x16x32_bf16 a[188:191], v[112:115], v[56:59], a[188:191]
    v_exp_f32 v246, v246
    v_mfma_f32_16x16x32_bf16 a[188:191], v[116:119], v[60:63], a[188:191]
    v_exp_f32 v247, v247
    v_mfma_f32_16x16x32_bf16 v[252:255], a[240:243], v[140:143], v[156:159]
    v_exp_f32 v248, v248
    v_mfma_f32_16x16x32_bf16 v[252:255], a[244:247], v[172:175], v[252:255]
    v_exp_f32 v249, v249
    v_mfma_f32_16x16x32_bf16 v[252:255], a[248:251], v[204:207], v[252:255]
    v_exp_f32 v250, v250
    v_mfma_f32_16x16x32_bf16 v[252:255], a[252:255], v[236:239], v[252:255]
    v_exp_f32 v251, v251
    v_mfma_f32_16x16x32_bf16 a[200:203], v[120:123], v[48:51], a[200:203]
    v_cvt_pk_bf16_f32 v84, v240, v241
    v_cvt_pk_bf16_f32 v85, v242, v243
    v_mfma_f32_16x16x32_bf16 a[200:203], v[124:127], v[52:55], a[200:203]
    v_cvt_pk_bf16_f32 v92, v244, v245
    v_cvt_pk_bf16_f32 v93, v246, v247
    v_mfma_f32_16x16x32_bf16 a[204:207], v[120:123], v[56:59], a[204:207]
    v_exp_f32 v252, v252
    v_mfma_f32_16x16x32_bf16 a[204:207], v[124:127], v[60:63], a[204:207]
    v_exp_f32 v253, v253
    v_mfma_f32_16x16x32_bf16 a[216:219], a[136:139], v[48:51], a[216:219]
    v_cvt_pk_bf16_f32 v86, v248, v249
    v_cvt_pk_bf16_f32 v87, v250, v251
    v_mfma_f32_16x16x32_bf16 a[216:219], a[136:139], v[52:55], a[216:219]
    v_cvt_pk_bf16_f32 v94, v252, v253
    v_mfma_f32_16x16x32_bf16 a[220:223], a[136:139], v[56:59], a[220:223]
    v_mfma_f32_16x16x32_bf16 a[220:223], a[136:139], v[60:63], a[220:223]
    s_cmp_le_u32 s78, 2
    s_cbranch_scc1 K1_LS_MASK
K1_LS_BACK:
    s_waitcnt lgkmcnt(0)
    v_mfma_f32_16x16x32_bf16 v[240:243], a[224:227], v[136:139], v[176:179]
    s_add_u32 m0, s76, s75
    v_exp_f32 v254, v254
    v_mfma_f32_16x16x32_bf16 v[240:243], a[228:231], v[168:171], v[240:243]
    s_mov_b32 s76, s60
    v_exp_f32 v255, v255
    v_mfma_f32_16x16x32_bf16 v[240:243], a[232:235], v[200:203], v[240:243]
    s_mov_b32 s60, s82
    buffer_load_dwordx4 v1, s[36:39], s77 offen sc1 lds
    v_mfma_f32_16x16x32_bf16 v[240:243], a[236:239], v[232:235], v[240:243]
    s_add_u32 s82, s82, 32768
    ds_read_b128 v[104:107], v2 offset:18432
    v_cvt_pk_bf16_f32 v95, v254, v255
    v_mfma_f32_16x16x32_bf16 a[8:11], v[96:99], v[80:83], a[8:11]
    ds_read_b128 v[108:111], v2 offset:19456
    ds_read_b128 a[240:243], v2 offset:4096
    v_mfma_f32_16x16x32_bf16 a[8:11], v[100:103], v[84:87], a[8:11]
    ds_read_b128 a[244:247], v2 offset:5120
    v_mfma_f32_16x16x32_bf16 a[12:15], v[96:99], v[88:91], a[12:15]
    buffer_load_dwordx4 v1, s[36:39], s77 offen offset:1024 sc1 lds
    v_mfma_f32_16x16x32_bf16 a[12:15], v[100:103], v[92:95], a[12:15]
    ds_read_b128 a[248:251], v2 offset:6144
    ds_read_b128 a[252:255], v2 offset:7168
    v_mfma_f32_16x16x32_bf16 v[244:247], a[224:227], v[140:143], v[156:159]
    v_exp_f32 v240, v240
    v_mfma_f32_16x16x32_bf16 v[244:247], a[228:231], v[172:175], v[244:247]
    ds_read_b128 v[112:115], v2 offset:20480
    ds_read_b128 v[116:119], v2 offset:21504
    v_mfma_f32_16x16x32_bf16 v[244:247], a[232:235], v[204:207], v[244:247]
    v_exp_f32 v241, v241
    v_mfma_f32_16x16x32_bf16 v[244:247], a[236:239], v[236:239], v[244:247]
    s_waitcnt lgkmcnt(4)
    ds_read_b128 v[120:123], v2 offset:22528
    ds_read_b128 v[124:127], v2 offset:23552
    v_mfma_f32_16x16x32_bf16 a[24:27], v[104:107], v[80:83], a[24:27]
    buffer_load_dwordx4 v1, s[36:39], s77 offen offset:2048 sc1 lds
    v_mfma_f32_16x16x32_bf16 a[24:27], v[108:111], v[84:87], a[24:27]
    ds_read_b128 a[224:227], v2 offset:8192
    ds_read_b128 a[228:231], v2 offset:9216
    v_mfma_f32_16x16x32_bf16 a[28:31], v[104:107], v[88:91], a[28:31]
    ds_read_b128 a[232:235], v2 offset:10240
    v_cvt_pk_bf16_f32 v48, v240, v241
    v_mfma_f32_16x16x32_bf16 a[28:31], v[108:111], v[92:95], a[28:31]
    v_exp_f32 v242, v242
    v_mfma_f32_16x16x32_bf16 v[248:251], a[240:243], v[136:139], v[180:183]
    ds_read_b128 a[236:239], v2 offset:11264
    ds_read_b128 v[96:99], v2 offset:24576
    v_mfma_f32_16x16x32_bf16 v[248:251], a[244:247], v[168:171], v[248:251]
    s_waitcnt lgkmcnt(5)
    v_exp_f32 v243, v243
    v_mfma_f32_16x16x32_bf16 v[248:251], a[248:251], v[200:203], v[248:251]
    buffer_load_dwordx4 v1, s[36:39], s77 offen offset:3072 sc1 lds
    v_mfma_f32_16x16x32_bf16 v[248:251], a[252:255], v[232:235], v[248:251]
    ds_read_b128 v[100:103], v2 offset:25600
    v_cvt_pk_bf16_f32 v49, v242, v243
    v_mfma_f32_16x16x32_bf16 a[40:43], v[112:115], v[80:83], a[40:43]
    ds_read_b128 v[104:107], v2 offset:26624
    ds_read_b128 v[108:111], v2 offset:27648
    v_mfma_f32_16x16x32_bf16 a[40:43], v[116:119], v[84:87], a[40:43]
    v_exp_f32 v244, v244
    v_mfma_f32_16x16x32_bf16 a[44:47], v[112:115], v[88:91], a[44:47]
    v_exp_f32 v245, v245
    v_mfma_f32_16x16x32_bf16 a[44:47], v[116:119], v[92:95], a[44:47]
    s_add_u32 s100, s77, 4096
    v_exp_f32 v246, v246
    v_mfma_f32_16x16x32_bf16 v[252:255], a[240:243], v[140:143], v[156:159]
    s_add_u32 m0, m0, 4096
    v_exp_f32 v247, v247
    v_mfma_f32_16x16x32_bf16 v[252:255], a[244:247], v[172:175], v[252:255]
    buffer_load_dwordx4 v1, s[36:39], s100 offen sc1 lds
    v_mfma_f32_16x16x32_bf16 v[252:255], a[248:251], v[204:207], v[252:255]
    v_cvt_pk_bf16_f32 v56, v244, v245
    v_cvt_pk_bf16_f32 v57, v246, v247
    v_mfma_f32_16x16x32_bf16 v[252:255], a[252:255], v[236:239], v[252:255]
    ds_read_b128 a[240:243], v2 offset:12288
    ds_read_b128 a[244:247], v2 offset:13312
    v_mfma_f32_16x16x32_bf16 a[56:59], v[120:123], v[80:83], a[56:59]
    v_exp_f32 v248, v248
    v_mfma_f32_16x16x32_bf16 a[56:59], v[124:127], v[84:87], a[56:59]
    buffer_load_dwordx4 v1, s[36:39], s100 offen offset:1024 sc1 lds
    v_mfma_f32_16x16x32_bf16 a[60:63], v[120:123], v[88:91], a[60:63]
    ds_read_b128 a[248:251], v2 offset:14336
    ds_read_b128 a[252:255], v2 offset:15360
    v_mfma_f32_16x16x32_bf16 a[60:63], v[124:127], v[92:95], a[60:63]
    s_waitcnt lgkmcnt(4)
    v_exp_f32 v249, v249
    v_mfma_f32_16x16x32_bf16 v[240:243], a[224:227], v[136:139], v[184:187]
    ds_read_b128 v[112:115], v2 offset:28672
    ds_read_b128 v[116:119], v2 offset:29696
    v_mfma_f32_16x16x32_bf16 v[240:243], a[228:231], v[168:171], v[240:243]
    v_exp_f32 v250, v250
    v_mfma_f32_16x16x32_bf16 v[240:243], a[232:235], v[200:203], v[240:243]
    v_exp_f32 v251, v251
    v_mfma_f32_16x16x32_bf16 v[240:243], a[236:239], v[232:235], v[240:243]
    buffer_load_dwordx4 v1, s[36:39], s100 offen offset:2048 sc1 lds
    v_mfma_f32_16x16x32_bf16 a[152:155], v[96:99], v[80:83], a[152:155]
    v_cvt_pk_bf16_f32 v50, v248, v249
    v_cvt_pk_bf16_f32 v51, v250, v251
    v_mfma_f32_16x16x32_bf16 a[152:155], v[100:103], v[84:87], a[152:155]
    ds_read_b128 v[120:123], v2 offset:30720
    ds_read_b128 v[124:127], v2 offset:31744
    v_mfma_f32_16x16x32_bf16 a[156:159], v[96:99], v[88:91], a[156:159]
    v_exp_f32 v252, v252
    v_mfma_f32_16x16x32_bf16 a[156:159], v[100:103], v[92:95], a[156:159]
    v_exp_f32 v253, v253
    v_mfma_f32_16x16x32_bf16 v[244:247], a[224:227], v[140:143], v[156:159]
    v_exp_f32 v254, v254
    v_mfma_f32_16x16x32_bf16 v[244:247], a[228:231], v[172:175], v[244:247]
    buffer_load_dwordx4 v1, s[36:39], s100 offen offset:3072 sc1 lds
    v_mfma_f32_16x16x32_bf16 v[244:247], a[232:235], v[204:207], v[244:247]
    v_exp_f32 v255, v255
    v_mfma_f32_16x16x32_bf16 v[244:247], a[236:239], v[236:239], v[244:247]
    s_cmp_eq_u32 s82, 163840
    s_cselect_b32 s82, 0, s82
    v_cvt_pk_bf16_f32 v58, v252, v253
    v_mfma_f32_16x16x32_bf16 a[168:171], v[104:107], v[80:83], a[168:171]
    v_cvt_pk_bf16_f32 v59, v254, v255
    v_add_u32 v2, s82, v1
    v_mfma_f32_16x16x32_bf16 a[168:171], v[108:111], v[84:87], a[168:171]
    v_exp_f32 v240, v240
    v_mfma_f32_16x16x32_bf16 a[172:175], v[104:107], v[88:91], a[172:175]
    s_add_u32 s77, s77, 32768
    v_exp_f32 v241, v241
    v_mfma_f32_16x16x32_bf16 a[172:175], v[108:111], v[92:95], a[172:175]
    s_waitcnt lgkmcnt(0)
    v_exp_f32 v242, v242
    v_mfma_f32_16x16x32_bf16 v[248:251], a[240:243], v[136:139], v[188:191]
    v_exp_f32 v243, v243
    v_mfma_f32_16x16x32_bf16 v[248:251], a[244:247], v[168:171], v[248:251]
    v_exp_f32 v244, v244
    v_mfma_f32_16x16x32_bf16 v[248:251], a[248:251], v[200:203], v[248:251]
    v_exp_f32 v245, v245
    v_mfma_f32_16x16x32_bf16 v[248:251], a[252:255], v[232:235], v[248:251]
    v_exp_f32 v246, v246
    v_mfma_f32_16x16x32_bf16 a[184:187], v[112:115], v[80:83], a[184:187]
    v_exp_f32 v247, v247
    v_mfma_f32_16x16x32_bf16 a[184:187], v[116:119], v[84:87], a[184:187]
    v_cvt_pk_bf16_f32 v52, v240, v241
    v_cvt_pk_bf16_f32 v53, v242, v243
    v_mfma_f32_16x16x32_bf16 a[188:191], v[112:115], v[88:91], a[188:191]
    v_cvt_pk_bf16_f32 v60, v244, v245
    v_cvt_pk_bf16_f32 v61, v246, v247
    v_mfma_f32_16x16x32_bf16 a[188:191], v[116:119], v[92:95], a[188:191]
    s_waitcnt vmcnt(8) lgkmcnt(0)
    s_barrier
    ds_read_b128 a[224:227], v2 offset:0
    v_mfma_f32_16x16x32_bf16 v[252:255], a[240:243], v[140:143], v[156:159]
    ds_read_b128 a[228:231], v2 offset:1024
    ds_read_b128 a[232:235], v2 offset:2048
    v_mfma_f32_16x16x32_bf16 v[252:255], a[244:247], v[172:175], v[252:255]
    v_exp_f32 v248, v248
    v_mfma_f32_16x16x32_bf16 v[252:255], a[248:251], v[204:207], v[252:255]
    ds_read_b128 a[236:239], v2 offset:3072
    ds_read_b128 v[96:99], v2 offset:16384
    v_mfma_f32_16x16x32_bf16 v[252:255], a[252:255], v[236:239], v[252:255]
    v_exp_f32 v249, v249
    v_mfma_f32_16x16x32_bf16 a[200:203], v[120:123], v[80:83], a[200:203]
    ds_read_b128 v[100:103], v2 offset:17408
    v_cvt_pk_bf16_f32 v54, v248, v249
    v_mfma_f32_16x16x32_bf16 a[200:203], v[124:127], v[84:87], a[200:203]
    v_exp_f32 v250, v250
    v_mfma_f32_16x16x32_bf16 a[204:207], v[120:123], v[88:91], a[204:207]
    v_exp_f32 v251, v251
    v_mfma_f32_16x16x32_bf16 a[204:207], v[124:127], v[92:95], a[204:207]
    v_exp_f32 v252, v252
    v_mfma_f32_16x16x32_bf16 a[216:219], a[136:139], v[80:83], a[216:219]
    v_exp_f32 v253, v253
    v_mfma_f32_16x16x32_bf16 a[216:219], a[136:139], v[84:87], a[216:219]
    v_cvt_pk_bf16_f32 v55, v250, v251
    v_cvt_pk_bf16_f32 v62, v252, v253
    v_mfma_f32_16x16x32_bf16 a[220:223], a[136:139], v[88:91], a[220:223]
    v_mfma_f32_16x16x32_bf16 a[220:223], a[136:139], v[92:95], a[220:223]
    s_sub_u32 s78, s78, 1
    s_cmp_lg_u32 s78, 0
    s_cbranch_scc1 K1_LS
K1_LS_END:
    v_add_f32 v212, s12, v156
    v_fma_f32 v176, v208, s8, v212
    v_fma_f32 v177, v209, s8, v212
    v_fma_f32 v178, v210, s8, v212
    v_fma_f32 v179, v211, s8, v212
    s_nop 1
    s_waitcnt lgkmcnt(0)
    v_mfma_f32_16x16x32_bf16 v[240:243], a[224:227], v[140:143], v[176:179]
    s_xor_b32 s21, s3, 1
    s_lshl2_add_u32 s21, s21, s4
    ds_read_b128 v[104:107], v2 offset:18432
    v_mfma_f32_16x16x32_bf16 v[240:243], a[228:231], v[172:175], v[240:243]
    s_mul_i32 s21, s21, 36864
    ds_read_b128 v[108:111], v2 offset:19456
    ds_read_b128 a[240:243], v2 offset:4096
    v_mfma_f32_16x16x32_bf16 v[240:243], a[232:235], v[204:207], v[240:243]
    s_add_u32 s21, s21, s28
    s_mov_b32 m0, s45
    ds_read_b128 a[244:247], v2 offset:5120
    v_mfma_f32_16x16x32_bf16 v[240:243], a[236:239], v[236:239], v[240:243]
    s_mul_i32 s86, s4, 34
    buffer_load_dwordx4 v1, s[56:59], s21 offen sc1 lds
    v_mfma_f32_16x16x32_bf16 a[8:11], v[96:99], v[48:51], a[8:11]
    s_add_u32 s86, s86, 8
    v_exp_f32 v254, v254
    v_mfma_f32_16x16x32_bf16 a[8:11], v[100:103], v[52:55], a[8:11]
    s_mov_b32 s76, s60
    v_exp_f32 v255, v255
    v_mfma_f32_16x16x32_bf16 a[12:15], v[96:99], v[56:59], a[12:15]
    s_mov_b32 s60, s82
    v_cvt_pk_bf16_f32 v63, v254, v255
    ds_read_b128 a[248:251], v2 offset:6144
    s_nop 0
    v_mfma_f32_16x16x32_bf16 a[12:15], v[100:103], v[60:63], a[12:15]
    s_add_u32 s82, s82, 32768
    v_lshrrev_b32 v28, 4, v1
    ds_read_b128 a[252:255], v2 offset:7168
    s_waitcnt lgkmcnt(2)
    v_mfma_f32_16x16x32_bf16 a[24:27], v[104:107], v[48:51], a[24:27]
    s_and_b32 s62, s5, 4
    v_min_u32 v28, 33, v28
    ds_read_b128 v[112:115], v2 offset:20480
    v_mfma_f32_16x16x32_bf16 a[24:27], v[108:111], v[52:55], a[24:27]
    s_lshl_b32 s63, s3, 12
    buffer_load_dwordx4 v1, s[56:59], s21 offen offset:1024 sc1 lds
    v_mfma_f32_16x16x32_bf16 a[28:31], v[104:107], v[56:59], a[28:31]
    s_sub_u32 s19, s74, s101
    v_add_lshl_u32 v28, v28, s86, 7
    v_add_f32 v213, s13, v156
    v_mfma_f32_16x16x32_bf16 a[28:31], v[108:111], v[60:63], a[28:31]
    s_getpc_b64 s[86:87]
    global_load_dword v28, v28, s[86:87]
    v_fma_f32 v180, v208, s9, v213
    v_fma_f32 v181, v209, s9, v213
    v_fma_f32 v182, v210, s9, v213
    v_fma_f32 v183, v211, s9, v213
    s_nop 1
    v_mfma_f32_16x16x32_bf16 v[244:247], a[240:243], v[140:143], v[180:183]
    s_add_u32 s62, s62, s4
    ds_read_b128 v[116:119], v2 offset:21504
    ds_read_b128 v[120:123], v2 offset:22528
    v_mfma_f32_16x16x32_bf16 v[244:247], a[244:247], v[172:175], v[244:247]
    s_mov_b32 s20, s63
    ds_read_b128 v[124:127], v2 offset:23552
    v_add_f32 v214, s14, v156
    s_waitcnt lgkmcnt(3)
    v_mfma_f32_16x16x32_bf16 v[244:247], a[248:251], v[204:207], v[244:247]
    s_add_u32 s19, s66, s19
    buffer_load_dwordx4 v1, s[56:59], s21 offen offset:2048 sc1 lds
    v_mfma_f32_16x16x32_bf16 v[244:247], a[252:255], v[236:239], v[244:247]
    s_mov_b32 s50, 9437184
    ds_read_b128 a[224:227], v2 offset:8192
    ds_read_b128 a[228:231], v2 offset:9216
    v_mfma_f32_16x16x32_bf16 a[40:43], v[112:115], v[48:51], a[40:43]
    s_waitcnt lgkmcnt(4)
    ds_read_b128 a[232:235], v2 offset:10240
    v_fma_f32 v184, v208, s10, v214
    v_mfma_f32_16x16x32_bf16 a[40:43], v[116:119], v[52:55], a[40:43]
    ds_read_b128 a[236:239], v2 offset:11264
    v_fma_f32 v185, v209, s10, v214
    v_mfma_f32_16x16x32_bf16 a[44:47], v[112:115], v[56:59], a[44:47]
    ds_read_b128 v[96:99], v2 offset:24576
    v_fma_f32 v186, v210, s10, v214
    v_mfma_f32_16x16x32_bf16 a[44:47], v[116:119], v[60:63], a[44:47]
    s_waitcnt lgkmcnt(5)
    ds_read_b128 v[100:103], v2 offset:25600
    v_fma_f32 v187, v211, s10, v214
    v_mfma_f32_16x16x32_bf16 a[56:59], v[120:123], v[48:51], a[56:59]
    buffer_load_dwordx4 v1, s[56:59], s21 offen offset:3072 sc1 lds
    v_mfma_f32_16x16x32_bf16 a[56:59], v[124:127], v[52:55], a[56:59]
    s_add_u32 s21, s21, 4096
    ds_read_b128 v[104:107], v2 offset:26624
    ds_read_b128 v[108:111], v2 offset:27648
    v_mfma_f32_16x16x32_bf16 a[60:63], v[120:123], v[56:59], a[60:63]
    s_add_u32 m0, s45, 4096
    ds_read_b128 a[240:243], v2 offset:12288
    v_add_f32 v215, s15, v156
    v_mfma_f32_16x16x32_bf16 a[60:63], v[124:127], v[60:63], a[60:63]
    s_waitcnt lgkmcnt(4)
    ds_read_b128 a[244:247], v2 offset:13312
    v_fma_f32 v188, v208, s11, v215
    v_mfma_f32_16x16x32_bf16 v[248:251], a[224:227], v[140:143], v[184:187]
    ds_read_b128 a[248:251], v2 offset:14336
    v_fma_f32 v189, v209, s11, v215
    v_mfma_f32_16x16x32_bf16 v[248:251], a[228:231], v[172:175], v[248:251]
    ds_read_b128 a[252:255], v2 offset:15360
    v_fma_f32 v190, v210, s11, v215
    v_mfma_f32_16x16x32_bf16 v[248:251], a[232:235], v[204:207], v[248:251]
    buffer_load_dwordx4 v1, s[56:59], s21 offen sc1 lds
    v_mfma_f32_16x16x32_bf16 v[248:251], a[236:239], v[236:239], v[248:251]
    ds_read_b128 v[112:115], v2 offset:28672
    ds_read_b128 v[116:119], v2 offset:29696
    v_mfma_f32_16x16x32_bf16 a[152:155], v[96:99], v[48:51], a[152:155]
    s_waitcnt lgkmcnt(4)
    v_fma_f32 v191, v211, s11, v215
    ds_read_b128 v[120:123], v2 offset:30720
    v_mfma_f32_16x16x32_bf16 a[152:155], v[100:103], v[52:55], a[152:155]
    ds_read_b128 v[124:127], v2 offset:31744
    v_bfe_u32 v217, v1, 4, 3
    v_mfma_f32_16x16x32_bf16 a[156:159], v[96:99], v[56:59], a[156:159]
    s_cmp_eq_u32 s82, 163840
    s_cselect_b32 s82, 0, s82
    v_add_u32 v2, s82, v1
    v_mfma_f32_16x16x32_bf16 a[156:159], v[100:103], v[60:63], a[156:159]
    ds_read_b128 a[224:227], v2 offset:0
    ds_read_b128 a[228:231], v2 offset:1024
    v_mfma_f32_16x16x32_bf16 a[168:171], v[104:107], v[48:51], a[168:171]
    buffer_load_dwordx4 v1, s[56:59], s21 offen offset:1024 sc1 lds
    v_mfma_f32_16x16x32_bf16 a[168:171], v[108:111], v[52:55], a[168:171]
    ds_read_b128 a[232:235], v2 offset:2048
    ds_read_b128 a[236:239], v2 offset:3072
    v_mfma_f32_16x16x32_bf16 a[172:175], v[104:107], v[56:59], a[172:175]
    ds_read_b128 v[96:99], v2 offset:16384
    v_lshlrev_b32 v217, 7, v217
    v_mfma_f32_16x16x32_bf16 a[172:175], v[108:111], v[60:63], a[172:175]
    v_exp_f32 v240, v240
    v_mfma_f32_16x16x32_bf16 v[252:255], a[240:243], v[140:143], v[188:191]
    v_exp_f32 v241, v241
    v_mfma_f32_16x16x32_bf16 v[252:255], a[244:247], v[172:175], v[252:255]
    s_waitcnt lgkmcnt(3)
    ds_read_b128 v[100:103], v2 offset:17408
    v_cvt_pk_bf16_f32 v88, v240, v241
    v_mfma_f32_16x16x32_bf16 v[252:255], a[248:251], v[204:207], v[252:255]
    buffer_load_dwordx4 v1, s[56:59], s21 offen offset:2048 sc1 lds
    v_mfma_f32_16x16x32_bf16 v[252:255], a[252:255], v[236:239], v[252:255]
    v_exp_f32 v242, v242
    v_mfma_f32_16x16x32_bf16 a[184:187], v[112:115], v[48:51], a[184:187]
    v_exp_f32 v243, v243
    v_mfma_f32_16x16x32_bf16 a[184:187], v[116:119], v[52:55], a[184:187]
    v_exp_f32 v244, v244
    v_mfma_f32_16x16x32_bf16 a[188:191], v[112:115], v[56:59], a[188:191]
    v_exp_f32 v245, v245
    v_mfma_f32_16x16x32_bf16 a[188:191], v[116:119], v[60:63], a[188:191]
    v_exp_f32 v246, v246
    v_mfma_f32_16x16x32_bf16 a[200:203], v[120:123], v[48:51], a[200:203]
    v_exp_f32 v247, v247
    v_mfma_f32_16x16x32_bf16 a[200:203], v[124:127], v[52:55], a[200:203]
    v_exp_f32 v248, v248
    v_mfma_f32_16x16x32_bf16 a[204:207], v[120:123], v[56:59], a[204:207]
    v_exp_f32 v249, v249
    v_mfma_f32_16x16x32_bf16 a[204:207], v[124:127], v[60:63], a[204:207]
    v_exp_f32 v250, v250
    v_mfma_f32_16x16x32_bf16 a[216:219], a[136:139], v[48:51], a[216:219]
    v_exp_f32 v251, v251
    v_mfma_f32_16x16x32_bf16 a[216:219], a[136:139], v[52:55], a[216:219]
    v_exp_f32 v252, v252
    v_mfma_f32_16x16x32_bf16 a[220:223], a[136:139], v[56:59], a[220:223]
    s_add_u32 s48, s32, 1048576
    s_addc_u32 s49, s33, 0
    v_cvt_pk_bf16_f32 v89, v242, v243
    v_mfma_f32_16x16x32_bf16 a[220:223], a[136:139], v[60:63], a[220:223]
    v_exp_f32 v253, v253
    v_cvt_pk_bf16_f32 v90, v244, v245
    v_cvt_pk_bf16_f32 v91, v246, v247
    v_cvt_pk_bf16_f32 v92, v248, v249
    v_cvt_pk_bf16_f32 v93, v250, v251
    v_cvt_pk_bf16_f32 v94, v252, v253
    s_cmp_eq_u32 s6, 7
    s_cbranch_scc1 K1_S7
K1_S7_BACK:
    ds_read_b128 v[104:107], v2 offset:18432
    ds_read_b128 v[108:111], v2 offset:19456
    ds_read_b128 v[112:115], v2 offset:20480
    ds_read_b128 v[116:119], v2 offset:21504
    ds_read_b128 v[120:123], v2 offset:22528
    ds_read_b128 v[124:127], v2 offset:23552
    s_waitcnt lgkmcnt(6)
    v_mfma_f32_16x16x32_bf16 a[12:15], v[96:99], v[88:91], a[12:15]
    v_exp_f32 v254, v254
    v_exp_f32 v255, v255
    s_nop 0
    v_cvt_pk_bf16_f32 v95, v254, v255
    s_nop 1
    v_mfma_f32_16x16x32_bf16 a[12:15], v[100:103], v[92:95], a[12:15]
    s_waitcnt lgkmcnt(5)
    ds_read_b128 v[96:99], v2 offset:24576
    ds_read_b128 v[100:103], v2 offset:25600
    v_accvgpr_read_b32 v9, a216
    v_rcp_f32 v10, v9
    v_mfma_f32_16x16x32_bf16 a[28:31], v[104:107], v[88:91], a[28:31]
    s_waitcnt lgkmcnt(6)
    ds_read_b128 v[104:107], v2 offset:26624
    v_mul_f32 v10, v10, v6
    v_accvgpr_read_b32 v12, a8
    v_accvgpr_read_b32 v13, a9
    v_accvgpr_read_b32 v14, a10
    v_mfma_f32_16x16x32_bf16 a[28:31], v[108:111], v[92:95], a[28:31]
    s_waitcnt lgkmcnt(6)
    ds_read_b128 v[108:111], v2 offset:27648
    v_accvgpr_read_b32 v15, a11
    v_accvgpr_read_b32 v16, a24
    v_accvgpr_read_b32 v17, a25
    v_accvgpr_read_b32 v18, a26
    v_mfma_f32_16x16x32_bf16 a[44:47], v[112:115], v[88:91], a[44:47]
    s_waitcnt lgkmcnt(4)
    ds_read_b128 v[112:115], v2 offset:28672
    v_accvgpr_read_b32 v19, a27
    v_accvgpr_read_b32 v20, a40
    v_accvgpr_read_b32 v21, a41
    v_accvgpr_read_b32 v22, a42
    v_mfma_f32_16x16x32_bf16 a[44:47], v[116:119], v[92:95], a[44:47]
    ds_read_b128 v[116:119], v2 offset:29696
    v_accvgpr_read_b32 v23, a43
    v_accvgpr_read_b32 v24, a56
    v_accvgpr_read_b32 v25, a57
    v_accvgpr_read_b32 v26, a58
    v_mfma_f32_16x16x32_bf16 a[60:63], v[120:123], v[88:91], a[60:63]
    ds_read_b128 v[120:123], v2 offset:30720
    v_accvgpr_read_b32 v27, a59
    v_mul_f32 v12, v10, v12
    v_mul_f32 v13, v10, v13
    v_mul_f32 v14, v10, v14
    v_mfma_f32_16x16x32_bf16 a[60:63], v[124:127], v[92:95], a[60:63]
    s_waitcnt lgkmcnt(4)
    ds_read_b128 v[124:127], v2 offset:31744
    v_mul_f32 v15, v10, v15
    v_mul_f32 v16, v10, v16
    v_mul_f32 v17, v10, v17
    v_mul_f32 v18, v10, v18
    v_mfma_f32_16x16x32_bf16 a[156:159], v[96:99], v[88:91], a[156:159]
    v_mul_f32 v19, v10, v19
    v_mul_f32 v20, v10, v20
    v_mul_f32 v21, v10, v21
    v_mul_f32 v22, v10, v22
    v_mul_f32 v23, v10, v23
    v_mfma_f32_16x16x32_bf16 a[156:159], v[100:103], v[92:95], a[156:159]
    v_mul_f32 v24, v10, v24
    v_mul_f32 v25, v10, v25
    v_mul_f32 v26, v10, v26
    v_mul_f32 v27, v10, v27
    v_cvt_pk_bf16_f32 v12, v12, v13
    v_mfma_f32_16x16x32_bf16 a[172:175], v[104:107], v[88:91], a[172:175]
    s_waitcnt lgkmcnt(2)
    v_cvt_pk_bf16_f32 v13, v14, v15
    v_cvt_pk_bf16_f32 v14, v16, v17
    v_cvt_pk_bf16_f32 v15, v18, v19
    v_cvt_pk_bf16_f32 v20, v20, v21
    v_cvt_pk_bf16_f32 v21, v22, v23
    v_mfma_f32_16x16x32_bf16 a[172:175], v[108:111], v[92:95], a[172:175]
    v_cvt_pk_bf16_f32 v22, v24, v25
    v_cvt_pk_bf16_f32 v23, v26, v27
    buffer_store_dwordx4 v[12:15], v1, s[40:43], s81 offen offset:0 sc1
    v_accvgpr_read_b32 v16, a168
    v_mfma_f32_16x16x32_bf16 a[188:191], v[112:115], v[88:91], a[188:191]
    buffer_store_dwordx4 v[20:23], v1, s[40:43], s81 offen offset:1024 sc1
    v_accvgpr_read_b32 v12, a152
    v_accvgpr_read_b32 v13, a153
    v_accvgpr_read_b32 v14, a154
    v_mfma_f32_16x16x32_bf16 a[188:191], v[116:119], v[92:95], a[188:191]
    s_waitcnt lgkmcnt(0)
    v_accvgpr_read_b32 v15, a155
    v_accvgpr_read_b32 v17, a169
    v_accvgpr_read_b32 v18, a170
    v_accvgpr_read_b32 v19, a171
    v_accvgpr_read_b32 v20, a184
    v_mfma_f32_16x16x32_bf16 a[204:207], v[120:123], v[88:91], a[204:207]
    v_accvgpr_read_b32 v21, a185
    v_accvgpr_read_b32 v22, a186
    v_accvgpr_read_b32 v23, a187
    v_accvgpr_read_b32 v24, a200
    v_accvgpr_read_b32 v25, a201
    v_mfma_f32_16x16x32_bf16 a[204:207], v[124:127], v[92:95], a[204:207]
    v_accvgpr_read_b32 v26, a202
    v_accvgpr_read_b32 v27, a203
    v_mul_f32 v12, v10, v12
    v_mul_f32 v13, v10, v13
    v_mul_f32 v14, v10, v14
    v_mfma_f32_16x16x32_bf16 a[220:223], a[136:139], v[88:91], a[220:223]
    v_mul_f32 v15, v10, v15
    v_mul_f32 v16, v10, v16
    v_mul_f32 v17, v10, v17
    v_mul_f32 v18, v10, v18
    v_mul_f32 v19, v10, v19
    v_mfma_f32_16x16x32_bf16 a[220:223], a[136:139], v[92:95], a[220:223]
    v_mul_f32 v20, v10, v20
    v_mul_f32 v21, v10, v21
    v_mul_f32 v22, v10, v22
    v_mul_f32 v23, v10, v23
    v_mul_f32 v24, v10, v24
    v_mul_f32 v25, v10, v25
    v_mul_f32 v26, v10, v26
    v_mul_f32 v27, v10, v27
    v_cmp_nge_f32 vcc, 0x71800000, v9
    v_cvt_pk_bf16_f32 v12, v12, v13
    v_cvt_pk_bf16_f32 v13, v14, v15
    v_cvt_pk_bf16_f32 v14, v16, v17
    v_cvt_pk_bf16_f32 v15, v18, v19
    v_cvt_pk_bf16_f32 v20, v20, v21
    v_cvt_pk_bf16_f32 v21, v22, v23
    v_cvt_pk_bf16_f32 v22, v24, v25
    v_cvt_pk_bf16_f32 v23, v26, v27
    s_or_b64 s[84:85], s[84:85], vcc
    buffer_store_dwordx4 v[12:15], v1, s[40:43], s81 offen offset:2048 sc1
    buffer_store_dwordx4 v[20:23], v1, s[40:43], s81 offen offset:3072 sc1
    s_nop 3
    v_accvgpr_read_b32 v9, a220
    v_cmp_nge_f32 vcc, 0x71800000, v9
    v_rcp_f32 v10, v9
    s_nop 0
    s_or_b64 s[84:85], s[84:85], vcc
    v_mul_f32 v10, v10, v7
    s_add_u32 s72, s81, 622592
    v_accvgpr_read_b32 v12, a12
    v_accvgpr_read_b32 v13, a13
    v_accvgpr_read_b32 v14, a14
    v_accvgpr_read_b32 v15, a15
    v_accvgpr_read_b32 v16, a28
    v_accvgpr_read_b32 v17, a29
    v_accvgpr_read_b32 v18, a30
    v_accvgpr_read_b32 v19, a31
    v_pk_mul_f32 v[12:13], v[12:13], v[10:11] op_sel_hi:[1,0]
    v_pk_mul_f32 v[14:15], v[14:15], v[10:11] op_sel_hi:[1,0]
    v_pk_mul_f32 v[16:17], v[16:17], v[10:11] op_sel_hi:[1,0]
    v_pk_mul_f32 v[18:19], v[18:19], v[10:11] op_sel_hi:[1,0]
    v_cvt_pk_bf16_f32 v12, v12, v13
    v_cvt_pk_bf16_f32 v13, v14, v15
    v_cvt_pk_bf16_f32 v14, v16, v17
    v_cvt_pk_bf16_f32 v15, v18, v19
    buffer_store_dwordx4 v[12:15], v1, s[40:43], s72 offen offset:0 sc1
    v_accvgpr_read_b32 v20, a44
    v_accvgpr_read_b32 v21, a45
    v_accvgpr_read_b32 v22, a46
    v_accvgpr_read_b32 v23, a47
    v_accvgpr_read_b32 v24, a60
    v_accvgpr_read_b32 v25, a61
    v_accvgpr_read_b32 v26, a62
    v_accvgpr_read_b32 v27, a63
    v_pk_mul_f32 v[20:21], v[20:21], v[10:11] op_sel_hi:[1,0]
    v_pk_mul_f32 v[22:23], v[22:23], v[10:11] op_sel_hi:[1,0]
    v_pk_mul_f32 v[24:25], v[24:25], v[10:11] op_sel_hi:[1,0]
    v_pk_mul_f32 v[26:27], v[26:27], v[10:11] op_sel_hi:[1,0]
    v_cvt_pk_bf16_f32 v20, v20, v21
    v_cvt_pk_bf16_f32 v21, v22, v23
    v_cvt_pk_bf16_f32 v22, v24, v25
    v_cvt_pk_bf16_f32 v23, v26, v27
    buffer_store_dwordx4 v[20:23], v1, s[40:43], s72 offen offset:1024 sc1
    v_accvgpr_read_b32 v12, a156
    v_accvgpr_read_b32 v13, a157
    v_accvgpr_read_b32 v14, a158
    v_accvgpr_read_b32 v15, a159
    v_accvgpr_read_b32 v16, a172
    v_accvgpr_read_b32 v17, a173
    v_accvgpr_read_b32 v18, a174
    v_accvgpr_read_b32 v19, a175
    v_pk_mul_f32 v[12:13], v[12:13], v[10:11] op_sel_hi:[1,0]
    v_pk_mul_f32 v[14:15], v[14:15], v[10:11] op_sel_hi:[1,0]
    v_pk_mul_f32 v[16:17], v[16:17], v[10:11] op_sel_hi:[1,0]
    v_pk_mul_f32 v[18:19], v[18:19], v[10:11] op_sel_hi:[1,0]
    v_cvt_pk_bf16_f32 v12, v12, v13
    v_cvt_pk_bf16_f32 v13, v14, v15
    v_cvt_pk_bf16_f32 v14, v16, v17
    v_cvt_pk_bf16_f32 v15, v18, v19
    buffer_store_dwordx4 v[12:15], v1, s[40:43], s72 offen offset:2048 sc1
    v_accvgpr_read_b32 v20, a188
    v_accvgpr_read_b32 v21, a189
    v_accvgpr_read_b32 v22, a190
    v_accvgpr_read_b32 v23, a191
    v_accvgpr_read_b32 v24, a204
    v_accvgpr_read_b32 v25, a205
    v_accvgpr_read_b32 v26, a206
    v_accvgpr_read_b32 v27, a207
    v_pk_mul_f32 v[20:21], v[20:21], v[10:11] op_sel_hi:[1,0]
    v_pk_mul_f32 v[22:23], v[22:23], v[10:11] op_sel_hi:[1,0]
    v_pk_mul_f32 v[24:25], v[24:25], v[10:11] op_sel_hi:[1,0]
    v_pk_mul_f32 v[26:27], v[26:27], v[10:11] op_sel_hi:[1,0]
    v_cvt_pk_bf16_f32 v20, v20, v21
    v_cvt_pk_bf16_f32 v21, v22, v23
    v_cvt_pk_bf16_f32 v22, v24, v25
    v_cvt_pk_bf16_f32 v23, v26, v27
    buffer_store_dwordx4 v[20:23], v1, s[40:43], s72 offen offset:3072 sc1
    buffer_load_dword v3, v217, s[32:35], s19 offen sc1
    s_waitcnt lgkmcnt(0)
    s_barrier
    s_sub_u32 s30, s47, s75
    s_sub_u32 s31, s79, s75
    v_bfe_u32 v20, v1, 4, 4
    v_lshrrev_b32 v21, 8, v1
    s_lshl_b32 s98, s4, 4
    s_add_u32 s98, s98, 16
    v_add_u32 v22, s98, v20
    v_mul_u32_u24 v22, 144, v22
    v_add_u32 v22, s30, v22
    v_lshl_add_u32 v9, v21, 3, v22
    s_lshr_b32 s98, s73, 1
    v_add_u32 v8, s98, v9
    v_subrev_u32 v10, s98, v9
    s_sub_u32 s99, s31, s30
    v_add_u32 v24, s99, v8
    v_add_u32 v25, s99, v9
    v_add_u32 v26, s99, v10
    s_bitcmp1_b32 s4, 0
    s_cselect_b32 s99, s31, s30
    v_mul_u32_u24 v23, 144, v20
    v_lshl_add_u32 v23, v21, 3, v23
    v_add_u32 v13, s99, v23
    v_add_u32 v12, s98, v13
    v_accvgpr_read_b32 v32, a64
    v_accvgpr_read_b32 v33, a65
    v_accvgpr_read_b32 v34, a66
    v_accvgpr_read_b32 v35, a67
    v_cvt_pk_bf16_f32 v32, v32, v33
    v_cvt_pk_bf16_f32 v33, v34, v35
    ds_write_b64 v8, v[32:33] offset:0
    v_accvgpr_read_b32 v36, a68
    v_accvgpr_read_b32 v37, a69
    v_accvgpr_read_b32 v38, a70
    v_accvgpr_read_b32 v39, a71
    v_cvt_pk_bf16_f32 v36, v36, v37
    v_cvt_pk_bf16_f32 v37, v38, v39
    ds_write_b64 v8, v[36:37] offset:9216
    v_accvgpr_read_b32 v40, a72
    v_accvgpr_read_b32 v41, a73
    v_accvgpr_read_b32 v42, a74
    v_accvgpr_read_b32 v43, a75
    v_cvt_pk_bf16_f32 v40, v40, v41
    v_cvt_pk_bf16_f32 v41, v42, v43
    ds_write_b64 v24, v[40:41] offset:0
    v_accvgpr_read_b32 v44, a76
    v_accvgpr_read_b32 v45, a77
    v_accvgpr_read_b32 v46, a78
    v_accvgpr_read_b32 v47, a79
    v_cvt_pk_bf16_f32 v44, v44, v45
    v_cvt_pk_bf16_f32 v45, v46, v47
    ds_write_b64 v24, v[44:45] offset:9216
    v_accvgpr_read_b32 v32, a80
    v_accvgpr_read_b32 v33, a81
    v_accvgpr_read_b32 v34, a82
    v_accvgpr_read_b32 v35, a83
    v_cvt_pk_bf16_f32 v32, v32, v33
    v_cvt_pk_bf16_f32 v33, v34, v35
    ds_write_b64 v9, v[32:33] offset:32
    v_accvgpr_read_b32 v36, a84
    v_accvgpr_read_b32 v37, a85
    v_accvgpr_read_b32 v38, a86
    v_accvgpr_read_b32 v39, a87
    v_cvt_pk_bf16_f32 v36, v36, v37
    v_cvt_pk_bf16_f32 v37, v38, v39
    ds_write_b64 v9, v[36:37] offset:9248
    v_accvgpr_read_b32 v40, a88
    v_accvgpr_read_b32 v41, a89
    v_accvgpr_read_b32 v42, a90
    v_accvgpr_read_b32 v43, a91
    v_cvt_pk_bf16_f32 v40, v40, v41
    v_cvt_pk_bf16_f32 v41, v42, v43
    ds_write_b64 v25, v[40:41] offset:32
    v_accvgpr_read_b32 v44, a92
    v_accvgpr_read_b32 v45, a93
    v_accvgpr_read_b32 v46, a94
    v_accvgpr_read_b32 v47, a95
    v_cvt_pk_bf16_f32 v44, v44, v45
    v_cvt_pk_bf16_f32 v45, v46, v47
    ds_write_b64 v25, v[44:45] offset:9248
    v_accvgpr_read_b32 v32, a96
    v_accvgpr_read_b32 v33, a97
    v_accvgpr_read_b32 v34, a98
    v_accvgpr_read_b32 v35, a99
    v_cvt_pk_bf16_f32 v32, v32, v33
    v_cvt_pk_bf16_f32 v33, v34, v35
    ds_write_b64 v10, v[32:33] offset:64
    v_accvgpr_read_b32 v36, a100
    v_accvgpr_read_b32 v37, a101
    v_accvgpr_read_b32 v38, a102
    v_accvgpr_read_b32 v39, a103
    v_cvt_pk_bf16_f32 v36, v36, v37
    v_cvt_pk_bf16_f32 v37, v38, v39
    ds_write_b64 v10, v[36:37] offset:9280
    v_accvgpr_read_b32 v40, a104
    v_accvgpr_read_b32 v41, a105
    v_accvgpr_read_b32 v42, a106
    v_accvgpr_read_b32 v43, a107
    v_cvt_pk_bf16_f32 v40, v40, v41
    v_cvt_pk_bf16_f32 v41, v42, v43
    ds_write_b64 v26, v[40:41] offset:64
    v_accvgpr_read_b32 v44, a108
    v_accvgpr_read_b32 v45, a109
    v_accvgpr_read_b32 v46, a110
    v_accvgpr_read_b32 v47, a111
    v_cvt_pk_bf16_f32 v44, v44, v45
    v_cvt_pk_bf16_f32 v45, v46, v47
    ds_write_b64 v26, v[44:45] offset:9280
    v_mov_b32 v218, 2
    s_cmp_eq_u64 s[84:85], 0
    s_cselect_b32 s7, s74, 1073741824
    s_cmp_lg_u32 s83, 0
    s_cselect_b32 s7, s74, s7
    s_waitcnt vmcnt(1)
    buffer_store_dword v218, v216, s[32:35], s7 offen sc1
    s_xor_b32 s21, s3, 2
    s_lshl2_add_u32 s21, s21, s4
    s_mul_i32 s21, s21, 36864
    s_add_u32 s21, s21, s28
    s_mov_b32 m0, s46
    s_nop 0
    buffer_load_dwordx4 v1, s[56:59], s21 offen sc1 lds
    v_accvgpr_read_b32 v32, a112
    v_accvgpr_read_b32 v33, a113
    v_accvgpr_read_b32 v34, a114
    v_accvgpr_read_b32 v35, a115
    v_cvt_pk_bf16_f32 v32, v32, v33
    v_cvt_pk_bf16_f32 v33, v34, v35
    ds_write_b64 v9, v[32:33] offset:96
    v_accvgpr_read_b32 v36, a116
    v_accvgpr_read_b32 v37, a117
    v_accvgpr_read_b32 v38, a118
    v_accvgpr_read_b32 v39, a119
    v_cvt_pk_bf16_f32 v36, v36, v37
    buffer_load_dwordx4 v1, s[56:59], s21 offen offset:1024 sc1 lds
    v_cvt_pk_bf16_f32 v37, v38, v39
    ds_write_b64 v9, v[36:37] offset:9312
    v_accvgpr_read_b32 v40, a120
    v_accvgpr_read_b32 v41, a121
    v_accvgpr_read_b32 v42, a122
    v_accvgpr_read_b32 v43, a123
    v_cvt_pk_bf16_f32 v40, v40, v41
    v_cvt_pk_bf16_f32 v41, v42, v43
    ds_write_b64 v25, v[40:41] offset:96
    v_accvgpr_read_b32 v44, a124
    v_accvgpr_read_b32 v45, a125
    v_accvgpr_read_b32 v46, a126
    buffer_load_dwordx4 v1, s[56:59], s21 offen offset:2048 sc1 lds
    v_accvgpr_read_b32 v47, a127
    v_cvt_pk_bf16_f32 v44, v44, v45
    v_cvt_pk_bf16_f32 v45, v46, v47
    s_waitcnt lgkmcnt(14)
    ds_write_b64 v25, v[44:45] offset:9312
    v_accvgpr_read_b32 v32, a128
    v_accvgpr_read_b32 v33, a129
    v_accvgpr_read_b32 v34, a130
    v_accvgpr_read_b32 v35, a131
    v_cvt_pk_bf16_f32 v32, v32, v33
    v_cvt_pk_bf16_f32 v33, v34, v35
    s_waitcnt lgkmcnt(14)
    ds_write_b64 v12, v[32:33] offset:0
    v_accvgpr_read_b32 v36, a132
    buffer_load_dwordx4 v1, s[56:59], s21 offen offset:3072 sc1 lds
    v_accvgpr_read_b32 v37, a133
    v_accvgpr_read_b32 v38, a134
    v_accvgpr_read_b32 v39, a135
    v_cvt_pk_bf16_f32 v36, v36, v37
    v_cvt_pk_bf16_f32 v37, v38, v39
    s_cmp_eq_u32 s73, 0
    s_cselect_b64 exec, -1, 0
    s_waitcnt lgkmcnt(14)
    ds_write_b64 v13, v[36:37] offset:32
    s_mov_b64 exec, -1
    s_cmp_lg_u64 s[84:85], 0
    s_cselect_b32 s7, 1, 0
    v_mov_b32 v20, s7
    s_lshl2_add_u32 s98, s4, s30
    s_add_u32 s21, s21, 4096
    s_add_u32 m0, s46, 4096
    s_nop 0
    buffer_load_dwordx4 v1, s[56:59], s21 offen sc1 lds
    v_mov_b32 v21, s98
    s_waitcnt lgkmcnt(14)
    ds_write_b32 v21, v20 offset:20736
    v_mov_b32 v21, s30
    s_and_b32 s98, s4, 1
    s_lshl_b32 s98, s98, 6
    v_lshrrev_b32 v14, 4, v1
    v_add_u32 v14, s98, v14
    s_sub_u32 s7, 15, s6
    s_cmp_lt_u32 s4, 2
    s_cselect_b32 s7, s6, s7
    s_cselect_b32 s99, s30, s31
    s_lshl_b32 s7, s7, 7
    buffer_load_dwordx4 v1, s[56:59], s21 offen offset:1024 sc1 lds
    v_add_u32 v2, 2, v14
    v_mul_u32_u24 v2, 144, v2
    v_add_u32 v2, s99, v2
    v_add_u32 v14, s7, v14
    v_lshrrev_b32 v15, 4, v14
    s_mov_b32 s98, 155648
    v_mul_lo_u32 v15, v15, s98
    v_and_b32 v23, 0xf0, v1
    v_add_u32 v15, v15, v23
    s_lshl3_add_u32 s98, s6, s62
    s_mul_i32 s98, s98, 155648
    v_add_u32 v4, s98, v1
    buffer_load_dwordx4 v1, s[56:59], s21 offen offset:2048 sc1 lds
    s_sub_u32 s98, 15, s6
    s_lshl3_add_u32 s98, s98, s62
    s_mul_i32 s98, s98, 155648
    v_add_u32 v5, s98, v1
    v_mov_b32 v19, v217
    v_subrev_u32 v23, s75, v1
    v_add_u32 v11, s44, v23
    v_add_u32 v12, s45, v23
    v_add_u32 v13, s46, v23
    v_add_u32 v6, s47, v23
    v_add_u32 v7, s79, v23
    s_mov_b32 s98, 0xbfb8aa3b
    s_mov_b32 s99, 0x3eae1a93
    s_waitcnt vmcnt(8) lgkmcnt(0)
    s_barrier
    ds_read_b128 v[24:27], v21 offset:20736
    ds_read_b128 v[32:35], v2 offset:2016
    ds_read_b128 v[36:39], v2 offset:2032
    ds_read_b128 v[40:43], v2 offset:2048
    ds_read_b128 v[44:47], v2 offset:1728
    ds_read_b128 v[48:51], v2 offset:1744
    ds_read_b128 v[52:55], v2 offset:1760
    s_waitcnt lgkmcnt(6)
    v_or3_b32 v24, v24, v25, v26
    v_or_b32 v24, v24, v27
    s_nop 0
    v_readfirstlane_b32 s7, v24
    s_nop 1
    s_andn2_b32 s7, s7, s83
    s_cbranch_scc1 K1_REDO
    buffer_load_dword v28, v29, s[32:35], s92 offen sc1
    v_cmp_gt_u32 vcc, 1, v3
    s_nop 1
    s_and_b64 vcc, vcc, exec
    s_cbranch_scc1 SPIN_SHORT
BACK_SHORT:
    buffer_load_dwordx4 a[0:3], v4, s[40:43], s63 offen offset:0 sc1
    ds_read_b128 v[128:131], v2 offset:2096
    ds_read_b128 v[132:135], v2 offset:2112
    ds_read_b128 v[136:139], v2 offset:2128
    ds_read_b128 v[56:59], v2 offset:1440
    ds_read_b128 v[60:63], v2 offset:1456
    ds_read_b128 v[64:67], v2 offset:1472
    ds_read_b128 v[68:71], v2 offset:1152
    ds_read_b128 v[72:75], v2 offset:1168
    ds_read_b128 v[76:79], v2 offset:1184
    s_waitcnt lgkmcnt(8)
    v_dot2_f32_bf16 v140, v128, v32, 0
    v_dot2_f32_bf16 v141, v128, v44, 0
    buffer_load_dwordx4 a[8:11], v4, s[40:43], s63 offen offset:1024 sc1
    ds_read_b128 v[80:83], v2 offset:864
    s_waitcnt lgkmcnt(6)
    v_dot2_f32_bf16 v142, v128, v56, 0
    s_waitcnt lgkmcnt(3)
    v_dot2_f32_bf16 v143, v128, v68, 0
    ds_read_b128 v[84:87], v2 offset:880
    v_dot2c_f32_bf16 v140, v129, v33
    v_dot2c_f32_bf16 v141, v129, v45
    ds_read_b128 v[88:91], v2 offset:896
    v_dot2c_f32_bf16 v142, v129, v57
    v_dot2c_f32_bf16 v143, v129, v69
    ds_read_b128 v[92:95], v2 offset:576
    v_dot2c_f32_bf16 v140, v130, v34
    v_dot2c_f32_bf16 v141, v130, v46
    buffer_load_dwordx4 a[16:19], v4, s[40:43], s63 offen offset:2048 sc1
    ds_read_b128 v[96:99], v2 offset:592
    v_dot2c_f32_bf16 v142, v130, v58
    v_dot2c_f32_bf16 v143, v130, v70
    ds_read_b128 v[100:103], v2 offset:608
    v_dot2c_f32_bf16 v140, v131, v35
    v_dot2c_f32_bf16 v141, v131, v47
    ds_read_b128 v[104:107], v2 offset:288
    v_dot2c_f32_bf16 v142, v131, v59
    v_dot2c_f32_bf16 v143, v131, v71
    ds_read_b128 v[108:111], v2 offset:304
    v_dot2c_f32_bf16 v140, v132, v36
    v_dot2c_f32_bf16 v141, v132, v48
    buffer_load_dwordx4 a[24:27], v4, s[40:43], s63 offen offset:3072 sc1
    ds_read_b128 v[112:115], v2 offset:320
    v_dot2c_f32_bf16 v142, v132, v60
    s_waitcnt lgkmcnt(10)
    v_dot2c_f32_bf16 v143, v132, v72
    ds_read_b128 v[116:119], v2 offset:0
    v_dot2c_f32_bf16 v140, v133, v37
    v_dot2c_f32_bf16 v141, v133, v49
    ds_read_b128 v[120:123], v2 offset:16
    v_dot2c_f32_bf16 v142, v133, v61
    v_dot2c_f32_bf16 v143, v133, v73
    ds_read_b128 v[124:127], v2 offset:32
    v_dot2c_f32_bf16 v140, v134, v38
    v_dot2c_f32_bf16 v141, v134, v50
    s_xor_b32 s63, s63, 4096
    buffer_load_dwordx4 a[32:35], v4, s[40:43], s63 offen offset:0 sc1
    v_dot2c_f32_bf16 v142, v134, v62
    v_dot2c_f32_bf16 v143, v134, v74
    v_dot2c_f32_bf16 v140, v135, v39
    v_dot2c_f32_bf16 v141, v135, v51
    v_dot2c_f32_bf16 v142, v135, v63
    v_dot2c_f32_bf16 v143, v135, v75
    v_dot2c_f32_bf16 v140, v136, v40
    v_dot2c_f32_bf16 v141, v136, v52
    v_dot2c_f32_bf16 v142, v136, v64
    s_waitcnt lgkmcnt(12)
    v_dot2c_f32_bf16 v143, v136, v76
    s_waitcnt lgkmcnt(11)
    v_dot2_f32_bf16 v144, v128, v80, 0
    buffer_load_dwordx4 a[40:43], v4, s[40:43], s63 offen offset:1024 sc1
    s_waitcnt lgkmcnt(8)
    v_dot2_f32_bf16 v145, v128, v92, 0
    ds_read_b128 v[32:35], v2 offset:2064
    s_waitcnt lgkmcnt(6)
    v_dot2_f32_bf16 v146, v128, v104, 0
    s_waitcnt lgkmcnt(3)
    v_dot2_f32_bf16 v147, v128, v116, 0
    ds_read_b128 v[36:39], v2 offset:2080
    v_dot2c_f32_bf16 v144, v129, v81
    v_dot2c_f32_bf16 v145, v129, v93
    ds_read_b128 v[44:47], v2 offset:1776
    v_dot2c_f32_bf16 v146, v129, v105
    v_dot2c_f32_bf16 v147, v129, v117
    ds_read_b128 v[48:51], v2 offset:1792
    v_dot2c_f32_bf16 v144, v130, v82
    buffer_load_dwordx4 a[48:51], v4, s[40:43], s63 offen offset:2048 sc1
    v_dot2c_f32_bf16 v145, v130, v94
    ds_read_b128 v[56:59], v2 offset:1488
    v_dot2c_f32_bf16 v146, v130, v106
    v_dot2c_f32_bf16 v147, v130, v118
    ds_read_b128 v[60:63], v2 offset:1504
    v_dot2c_f32_bf16 v144, v131, v83
    v_dot2c_f32_bf16 v145, v131, v95
    ds_read_b128 v[68:71], v2 offset:1200
    v_dot2c_f32_bf16 v146, v131, v107
    v_dot2c_f32_bf16 v147, v131, v119
    ds_read_b128 v[72:75], v2 offset:1216
    v_dot2c_f32_bf16 v144, v132, v84
    buffer_load_dwordx4 a[56:59], v4, s[40:43], s63 offen offset:3072 sc1
    v_dot2c_f32_bf16 v145, v132, v96
    v_dot2c_f32_bf16 v146, v132, v108
    s_waitcnt lgkmcnt(9)
    v_dot2c_f32_bf16 v147, v132, v120
    v_dot2c_f32_bf16 v144, v133, v85
    v_dot2c_f32_bf16 v145, v133, v97
    v_dot2c_f32_bf16 v146, v133, v109
    v_dot2c_f32_bf16 v147, v133, v121
    v_dot2c_f32_bf16 v144, v134, v86
    v_dot2c_f32_bf16 v145, v134, v98
    v_dot2c_f32_bf16 v146, v134, v110
    v_dot2c_f32_bf16 v147, v134, v122
    v_dot2c_f32_bf16 v144, v135, v87
    s_xor_b32 s63, s63, 12288
    buffer_load_dwordx4 a[64:67], v4, s[40:43], s63 offen offset:0 sc1
    v_dot2c_f32_bf16 v145, v135, v99
    v_dot2c_f32_bf16 v146, v135, v111
    v_dot2c_f32_bf16 v147, v135, v123
    v_dot2c_f32_bf16 v144, v136, v88
    v_dot2c_f32_bf16 v145, v136, v100
    v_dot2c_f32_bf16 v146, v136, v112
    s_waitcnt lgkmcnt(8)
    v_dot2c_f32_bf16 v147, v136, v124
    v_lshlrev_b32 v8, 16, v138
    v_mul_f32 v8, s98, v8
    v_exp_f32 v8, v8
    v_mov_b32 v9, 0xf149f2ca
    buffer_load_dwordx4 a[72:75], v4, s[40:43], s63 offen offset:1024 sc1
    ds_read_b128 v[80:83], v2 offset:912
    v_cmp_le_u32 vcc, 2, v14
    ds_read_b128 v[84:87], v2 offset:928
    s_nop 0
    v_cndmask_b32 v141, v9, v141, vcc
    v_cmp_le_u32 vcc, 4, v14
    ds_read_b128 v[92:95], v2 offset:624
    s_nop 0
    v_cndmask_b32 v142, v9, v142, vcc
    v_cmp_le_u32 vcc, 6, v14
    ds_read_b128 v[96:99], v2 offset:640
    s_nop 0
    v_cndmask_b32 v143, v9, v143, vcc
    v_cmp_le_u32 vcc, 8, v14
    ds_read_b128 v[104:107], v2 offset:336
    buffer_load_dwordx4 a[80:83], v4, s[40:43], s63 offen offset:2048 sc1
    v_cndmask_b32 v144, v9, v144, vcc
    v_cmp_le_u32 vcc, 10, v14
    ds_read_b128 v[108:111], v2 offset:352
    s_nop 0
    v_cndmask_b32 v145, v9, v145, vcc
    v_cmp_le_u32 vcc, 12, v14
    ds_read_b128 v[116:119], v2 offset:48
    s_nop 0
    v_cndmask_b32 v146, v9, v146, vcc
    v_cmp_le_u32 vcc, 14, v14
    s_waitcnt lgkmcnt(14)
    ds_read_b128 v[120:123], v2 offset:64
    s_nop 0
    v_cndmask_b32 v147, v9, v147, vcc
    v_max3_f32 v9, v140, v141, v142
    v_max3_f32 v10, v143, v144, v145
    buffer_load_dwordx4 a[88:91], v4, s[40:43], s63 offen offset:3072 sc1
    s_xor_b32 s63, s63, 4096
    v_max3_f32 v9, v9, v146, v147
    v_max_f32 v9, v9, v10
    v_mul_f32 v9, s99, v9
    v_add_f32 v8, 1.0, v8
    v_fma_f32 v140, v140, s99, -v9
    v_fma_f32 v141, v141, s99, -v9
    v_fma_f32 v142, v142, s99, -v9
    v_fma_f32 v143, v143, s99, -v9
    v_fma_f32 v144, v144, s99, -v9
    v_fma_f32 v145, v145, s99, -v9
    v_fma_f32 v146, v146, s99, -v9
    v_fma_f32 v147, v147, s99, -v9
    buffer_load_dword v3, v217, s[32:35], s19 offen sc1
    buffer_load_dwordx4 a[96:99], v4, s[40:43], s63 offen offset:0 sc1
    v_exp_f32 v140, v140
    v_exp_f32 v141, v141
    v_exp_f32 v142, v142
    v_exp_f32 v143, v143
    v_exp_f32 v144, v144
    v_exp_f32 v145, v145
    v_exp_f32 v146, v146
    buffer_load_dwordx4 a[104:107], v4, s[40:43], s63 offen offset:1024 sc1
    v_exp_f32 v147, v147
    v_add_f32 v10, v140, v141
    v_add_f32 v10, v10, v142
    v_add_f32 v10, v10, v143
    v_add_f32 v10, v10, v144
    v_add_f32 v10, v10, v145
    v_add_f32 v10, v10, v146
    buffer_load_dwordx4 a[112:115], v4, s[40:43], s63 offen offset:2048 sc1
    v_add_f32 v10, v10, v147
    v_mul_f32 v10, v10, v8
    v_rcp_f32 v10, v10
    s_nop 0
    v_mul_f32 v140, v140, v10
    v_mul_f32 v141, v141, v10
    v_mul_f32 v142, v142, v10
    v_mul_f32 v143, v143, v10
    v_mul_f32 v144, v144, v10
    buffer_load_dwordx4 a[120:123], v4, s[40:43], s63 offen offset:3072 sc1
    v_mul_f32 v145, v145, v10
    v_mul_f32 v146, v146, v10
    v_mul_f32 v147, v147, v10
    v_cvt_pk_bf16_f32 v148, 0, v140
    v_cvt_pk_bf16_f32 v149, 0, v141
    v_cvt_pk_bf16_f32 v150, 0, v142
    v_cvt_pk_bf16_f32 v151, 0, v143
    s_xor_b32 s63, s63, 28672
    buffer_load_dwordx4 a[128:131], v4, s[40:43], s63 offen offset:0 sc1
    v_cvt_pk_bf16_f32 v152, 0, v144
    v_cvt_pk_bf16_f32 v153, 0, v145
    v_cvt_pk_bf16_f32 v154, 0, v146
    v_cvt_pk_bf16_f32 v155, 0, v147
    v_lshrrev_b32 v140, 16, v148
    v_lshrrev_b32 v141, 16, v149
    v_lshrrev_b32 v142, 16, v150
    buffer_load_dwordx4 a[136:139], v4, s[40:43], s63 offen offset:1024 sc1
    v_lshrrev_b32 v143, 16, v151
    v_lshrrev_b32 v144, 16, v152
    v_lshrrev_b32 v145, 16, v153
    v_lshrrev_b32 v146, 16, v154
    v_lshrrev_b32 v147, 16, v155
    v_dot2_f32_bf16 v128, v42, v140, 0
    v_dot2_f32_bf16 v129, v42, v148, 0
    v_dot2_f32_bf16 v130, v43, v140, 0
    buffer_load_dwordx4 a[144:147], v4, s[40:43], s63 offen offset:2048 sc1
    v_dot2_f32_bf16 v131, v43, v148, 0
    v_dot2_f32_bf16 v132, v32, v140, 0
    v_dot2_f32_bf16 v133, v32, v148, 0
    v_dot2_f32_bf16 v134, v33, v140, 0
    v_dot2_f32_bf16 v135, v33, v148, 0
    v_dot2_f32_bf16 v136, v34, v140, 0
    v_dot2_f32_bf16 v137, v34, v148, 0
    buffer_load_dwordx4 a[152:155], v4, s[40:43], s63 offen offset:3072 sc1
    s_xor_b32 s63, s63, 4096
    v_dot2_f32_bf16 v138, v35, v140, 0
    v_dot2_f32_bf16 v139, v35, v148, 0
    s_waitcnt lgkmcnt(14)
    v_dot2_f32_bf16 v156, v36, v140, 0
    v_dot2_f32_bf16 v157, v36, v148, 0
    v_dot2_f32_bf16 v158, v37, v140, 0
    v_dot2_f32_bf16 v159, v37, v148, 0
    v_dot2_f32_bf16 v17, v38, v140, 0
    v_dot2_f32_bf16 v18, v38, v148, 0
    s_waitcnt vmcnt(8)
    v_cmp_gt_u32 vcc, 2, v3
    s_nop 1
    s_and_b64 vcc, vcc, exec
    s_cbranch_scc1 SPIN_CTX
BACK_CTX:
    buffer_load_dwordx4 a[4:7], v5, s[40:43], s20 offen offset:0 sc1
    v_dot2c_f32_bf16 v128, v54, v141
    v_dot2c_f32_bf16 v129, v54, v149
    v_dot2c_f32_bf16 v130, v55, v141
    v_dot2c_f32_bf16 v131, v55, v149
    s_waitcnt lgkmcnt(13)
    v_dot2c_f32_bf16 v132, v44, v141
    v_dot2c_f32_bf16 v133, v44, v149
    v_dot2c_f32_bf16 v134, v45, v141
    v_dot2c_f32_bf16 v135, v45, v149
    v_dot2c_f32_bf16 v136, v46, v141
    v_dot2c_f32_bf16 v137, v46, v149
    v_dot2c_f32_bf16 v138, v47, v141
    v_dot2c_f32_bf16 v139, v47, v149
    s_waitcnt lgkmcnt(12)
    v_dot2c_f32_bf16 v156, v48, v141
    buffer_load_dwordx4 a[12:15], v5, s[40:43], s20 offen offset:1024 sc1
    v_dot2c_f32_bf16 v157, v48, v149
    v_dot2c_f32_bf16 v158, v49, v141
    v_dot2c_f32_bf16 v159, v49, v149
    v_dot2c_f32_bf16 v17, v50, v141
    v_dot2c_f32_bf16 v18, v50, v149
    v_dot2c_f32_bf16 v128, v66, v142
    v_dot2c_f32_bf16 v129, v66, v150
    v_dot2c_f32_bf16 v130, v67, v142
    v_dot2c_f32_bf16 v131, v67, v150
    s_waitcnt lgkmcnt(11)
    v_dot2c_f32_bf16 v132, v56, v142
    v_dot2c_f32_bf16 v133, v56, v150
    v_dot2c_f32_bf16 v134, v57, v142
    v_dot2c_f32_bf16 v135, v57, v150
    v_dot2c_f32_bf16 v136, v58, v142
    buffer_load_dwordx4 a[20:23], v5, s[40:43], s20 offen offset:2048 sc1
    v_dot2c_f32_bf16 v137, v58, v150
    v_dot2c_f32_bf16 v138, v59, v142
    v_dot2c_f32_bf16 v139, v59, v150
    s_waitcnt lgkmcnt(10)
    v_dot2c_f32_bf16 v156, v60, v142
    v_dot2c_f32_bf16 v157, v60, v150
    v_dot2c_f32_bf16 v158, v61, v142
    v_dot2c_f32_bf16 v159, v61, v150
    v_dot2c_f32_bf16 v17, v62, v142
    v_dot2c_f32_bf16 v18, v62, v150
    v_dot2c_f32_bf16 v128, v78, v143
    v_dot2c_f32_bf16 v129, v78, v151
    v_dot2c_f32_bf16 v130, v79, v143
    v_dot2c_f32_bf16 v131, v79, v151
    s_waitcnt lgkmcnt(9)
    v_dot2c_f32_bf16 v132, v68, v143
    buffer_load_dwordx4 a[28:31], v5, s[40:43], s20 offen offset:3072 sc1
    v_dot2c_f32_bf16 v133, v68, v151
    v_dot2c_f32_bf16 v134, v69, v143
    v_dot2c_f32_bf16 v135, v69, v151
    v_dot2c_f32_bf16 v136, v70, v143
    v_dot2c_f32_bf16 v137, v70, v151
    v_dot2c_f32_bf16 v138, v71, v143
    v_dot2c_f32_bf16 v139, v71, v151
    s_waitcnt lgkmcnt(8)
    v_dot2c_f32_bf16 v156, v72, v143
    v_dot2c_f32_bf16 v157, v72, v151
    v_dot2c_f32_bf16 v158, v73, v143
    v_dot2c_f32_bf16 v159, v73, v151
    v_dot2c_f32_bf16 v17, v74, v143
    v_dot2c_f32_bf16 v18, v74, v151
    v_dot2c_f32_bf16 v128, v90, v144
    s_xor_b32 s20, s20, 4096
    buffer_load_dwordx4 a[36:39], v5, s[40:43], s20 offen offset:0 sc1
    v_dot2c_f32_bf16 v129, v90, v152
    v_dot2c_f32_bf16 v130, v91, v144
    v_dot2c_f32_bf16 v131, v91, v152
    s_waitcnt lgkmcnt(7)
    v_dot2c_f32_bf16 v132, v80, v144
    v_dot2c_f32_bf16 v133, v80, v152
    v_dot2c_f32_bf16 v134, v81, v144
    v_dot2c_f32_bf16 v135, v81, v152
    v_dot2c_f32_bf16 v136, v82, v144
    v_dot2c_f32_bf16 v137, v82, v152
    v_dot2c_f32_bf16 v138, v83, v144
    v_dot2c_f32_bf16 v139, v83, v152
    s_waitcnt lgkmcnt(6)
    v_dot2c_f32_bf16 v156, v84, v144
    v_dot2c_f32_bf16 v157, v84, v152
    buffer_load_dwordx4 a[44:47], v5, s[40:43], s20 offen offset:1024 sc1
    v_dot2c_f32_bf16 v158, v85, v144
    v_dot2c_f32_bf16 v159, v85, v152
    v_dot2c_f32_bf16 v17, v86, v144
    v_dot2c_f32_bf16 v18, v86, v152
    v_dot2c_f32_bf16 v128, v102, v145
    v_dot2c_f32_bf16 v129, v102, v153
    v_dot2c_f32_bf16 v130, v103, v145
    v_dot2c_f32_bf16 v131, v103, v153
    s_waitcnt lgkmcnt(5)
    v_dot2c_f32_bf16 v132, v92, v145
    v_dot2c_f32_bf16 v133, v92, v153
    v_dot2c_f32_bf16 v134, v93, v145
    v_dot2c_f32_bf16 v135, v93, v153
    v_dot2c_f32_bf16 v136, v94, v145
    v_dot2c_f32_bf16 v137, v94, v153
    buffer_load_dwordx4 a[52:55], v5, s[40:43], s20 offen offset:2048 sc1
    v_dot2c_f32_bf16 v138, v95, v145
    v_dot2c_f32_bf16 v139, v95, v153
    s_waitcnt lgkmcnt(4)
    v_dot2c_f32_bf16 v156, v96, v145
    v_dot2c_f32_bf16 v157, v96, v153
    v_dot2c_f32_bf16 v158, v97, v145
    v_dot2c_f32_bf16 v159, v97, v153
    v_dot2c_f32_bf16 v17, v98, v145
    v_dot2c_f32_bf16 v18, v98, v153
    v_dot2c_f32_bf16 v128, v114, v146
    v_dot2c_f32_bf16 v129, v114, v154
    v_dot2c_f32_bf16 v130, v115, v146
    v_dot2c_f32_bf16 v131, v115, v154
    s_waitcnt lgkmcnt(3)
    v_dot2c_f32_bf16 v132, v104, v146
    v_dot2c_f32_bf16 v133, v104, v154
    buffer_load_dwordx4 a[60:63], v5, s[40:43], s20 offen offset:3072 sc1
    s_xor_b32 s20, s20, 12288
    v_dot2c_f32_bf16 v134, v105, v146
    v_dot2c_f32_bf16 v135, v105, v154
    v_dot2c_f32_bf16 v136, v106, v146
    v_dot2c_f32_bf16 v137, v106, v154
    v_dot2c_f32_bf16 v138, v107, v146
    v_dot2c_f32_bf16 v139, v107, v154
    s_waitcnt lgkmcnt(2)
    v_dot2c_f32_bf16 v156, v108, v146
    v_dot2c_f32_bf16 v157, v108, v154
    v_dot2c_f32_bf16 v158, v109, v146
    v_dot2c_f32_bf16 v159, v109, v154
    v_dot2c_f32_bf16 v17, v110, v146
    v_dot2c_f32_bf16 v18, v110, v154
    v_dot2c_f32_bf16 v128, v126, v147
    v_dot2c_f32_bf16 v129, v126, v155
    v_dot2c_f32_bf16 v130, v127, v147
    v_dot2c_f32_bf16 v131, v127, v155
    s_waitcnt lgkmcnt(1)
    v_dot2c_f32_bf16 v132, v116, v147
    v_dot2c_f32_bf16 v133, v116, v155
    v_dot2c_f32_bf16 v134, v117, v147
    v_dot2c_f32_bf16 v135, v117, v155
    v_dot2c_f32_bf16 v136, v118, v147
    v_dot2c_f32_bf16 v137, v118, v155
    v_dot2c_f32_bf16 v138, v119, v147
    v_dot2c_f32_bf16 v139, v119, v155
    s_waitcnt lgkmcnt(0)
    v_dot2c_f32_bf16 v156, v120, v147
    v_dot2c_f32_bf16 v157, v120, v155
    v_dot2c_f32_bf16 v158, v121, v147
    v_dot2c_f32_bf16 v159, v121, v155
    v_dot2c_f32_bf16 v17, v122, v147
    v_dot2c_f32_bf16 v18, v122, v155
    v_mov_b32 v89, 0
    v_mov_b32 v90, 0
    v_mov_b32 v91, 0
    v_cvt_pk_bf16_f32 v80, v128, v129
    v_cvt_pk_bf16_f32 v81, v130, v131
    v_cvt_pk_bf16_f32 v82, v132, v133
    v_cvt_pk_bf16_f32 v83, v134, v135
    v_cvt_pk_bf16_f32 v84, v136, v137
    v_cvt_pk_bf16_f32 v85, v138, v139
    v_cvt_pk_bf16_f32 v86, v156, v157
    v_cvt_pk_bf16_f32 v87, v158, v159
    v_cvt_pk_bf16_f32 v88, v17, v18
    v_cmp_gt_u32 vcc, 1, v28
    s_nop 1
    s_and_b64 vcc, vcc, exec
    s_cbranch_scc1 SPIN_ALL
BACK_ALL:
    s_waitcnt vmcnt(4)
    s_barrier
    ds_read_b128 v[104:107], v11 offset:0
    ds_read_b128 v[108:111], v11 offset:8192
    ds_read_b128 v[112:115], v11 offset:16384
    ds_read_b128 v[116:119], v11 offset:24576
    s_waitcnt lgkmcnt(3)
    v_mfma_f32_16x16x32_bf16 v[176:179], v[104:107], a[0:3], 0
    s_lshl3_add_u32 s98, 1, s5
    ds_read_b128 v[120:123], v11 offset:1024
    ds_read_b128 v[124:127], v11 offset:9216
    s_waitcnt lgkmcnt(4)
    v_mfma_f32_16x16x32_bf16 v[176:179], v[108:111], a[8:11], v[176:179]
    s_and_b32 s98, s98, 31
    buffer_load_dwordx4 a[68:71], v5, s[40:43], s20 offen offset:0 sc1
    s_waitcnt lgkmcnt(3)
    v_mfma_f32_16x16x32_bf16 v[176:179], v[112:115], a[16:19], v[176:179]
    s_lshl_b32 s8, s6, 5
    ds_read_b128 v[128:131], v11 offset:17408
    ds_read_b128 v[132:135], v11 offset:25600
    s_waitcnt lgkmcnt(4)
    v_mfma_f32_16x16x32_bf16 v[176:179], v[116:119], a[24:27], v[176:179]
    s_add_u32 s98, s98, s8
    ds_read_b128 v[136:139], v11 offset:2048
    v_mfma_f32_16x16x32_bf16 v[180:183], v[104:107], a[4:7], 0
    s_mul_i32 s98, s98, 3
    buffer_load_dwordx4 a[76:79], v5, s[40:43], s20 offen offset:1024 sc1
    v_mfma_f32_16x16x32_bf16 v[180:183], v[108:111], a[12:15], v[180:183]
    s_sub_u32 s98, s98, 1
    ds_read_b128 v[140:143], v11 offset:10240
    ds_read_b128 v[144:147], v11 offset:18432
    v_mfma_f32_16x16x32_bf16 v[180:183], v[112:115], a[20:23], v[180:183]
    s_add_u32 s98, s98, 3
    ds_read_b128 v[148:151], v11 offset:26624
    v_mfma_f32_16x16x32_bf16 v[180:183], v[116:119], a[28:31], v[180:183]
    s_lshl2_add_u32 s98, s98, s4
    ds_read_b128 v[104:107], v11 offset:3072
    s_waitcnt lgkmcnt(5)
    v_mfma_f32_16x16x32_bf16 v[184:187], v[120:123], a[0:3], 0
    s_mul_i32 s8, s98, 3072
    buffer_load_dwordx4 a[84:87], v5, s[40:43], s20 offen offset:2048 sc1
    v_mfma_f32_16x16x32_bf16 v[184:187], v[124:127], a[8:11], v[184:187]
    s_lshl3_add_u32 s98, 2, s5
    ds_read_b128 v[108:111], v11 offset:11264
    ds_read_b128 v[112:115], v11 offset:19456
    v_mfma_f32_16x16x32_bf16 v[184:187], v[128:131], a[16:19], v[184:187]
    s_and_b32 s98, s98, 31
    ds_read_b128 v[116:119], v11 offset:27648
    v_mfma_f32_16x16x32_bf16 v[184:187], v[132:135], a[24:27], v[184:187]
    s_lshl_b32 s9, s6, 5
    v_mfma_f32_16x16x32_bf16 v[188:191], v[120:123], a[4:7], 0
    s_add_u32 s98, s98, s9
    buffer_load_dwordx4 a[92:95], v5, s[40:43], s20 offen offset:3072 sc1
    v_mfma_f32_16x16x32_bf16 v[188:191], v[124:127], a[12:15], v[188:191]
    s_xor_b32 s20, s20, 4096
    ds_read_b128 v[120:123], v11 offset:4096
    ds_read_b128 v[124:127], v11 offset:12288
    v_mfma_f32_16x16x32_bf16 v[188:191], v[128:131], a[20:23], v[188:191]
    s_mul_i32 s98, s98, 3
    ds_read_b128 v[128:131], v11 offset:20480
    v_mfma_f32_16x16x32_bf16 v[188:191], v[132:135], a[28:31], v[188:191]
    s_sub_u32 s98, s98, 2
    ds_read_b128 v[132:135], v11 offset:28672
    s_waitcnt lgkmcnt(4)
    v_mfma_f32_16x16x32_bf16 v[192:195], v[136:139], a[0:3], 0
    s_add_u32 s98, s98, 3
    buffer_store_dwordx4 v[80:83], v15, s[40:43], s71 offen offset:0 sc1
    v_mfma_f32_16x16x32_bf16 v[192:195], v[140:143], a[8:11], v[192:195]
    s_lshl2_add_u32 s98, s98, s4
    v_mfma_f32_16x16x32_bf16 v[192:195], v[144:147], a[16:19], v[192:195]
    s_mul_i32 s9, s98, 3072
    v_mfma_f32_16x16x32_bf16 v[192:195], v[148:151], a[24:27], v[192:195]
    s_lshl3_add_u32 s98, 3, s5
    v_mfma_f32_16x16x32_bf16 v[196:199], v[136:139], a[4:7], 0
    s_and_b32 s98, s98, 31
    ds_read_b128 v[136:139], v11 offset:5120
    v_mfma_f32_16x16x32_bf16 v[196:199], v[140:143], a[12:15], v[196:199]
    s_lshl_b32 s10, s6, 5
    buffer_store_dwordx4 v[84:87], v15, s[40:43], s71 offen offset:256 sc1
    v_mfma_f32_16x16x32_bf16 v[196:199], v[144:147], a[20:23], v[196:199]
    s_add_u32 s98, s98, s10
    ds_read_b128 v[140:143], v11 offset:13312
    ds_read_b128 v[144:147], v11 offset:21504
    v_mfma_f32_16x16x32_bf16 v[196:199], v[148:151], a[28:31], v[196:199]
    s_mul_i32 s98, s98, 3
    ds_read_b128 v[148:151], v11 offset:29696
    v_mfma_f32_16x16x32_bf16 v[200:203], v[104:107], a[0:3], 0
    s_sub_u32 s98, s98, 3
    v_mfma_f32_16x16x32_bf16 v[200:203], v[108:111], a[8:11], v[200:203]
    s_add_u32 s98, s98, 3
    buffer_store_dwordx4 v[88:91], v15, s[40:43], s71 offen offset:512 sc1
    v_mfma_f32_16x16x32_bf16 v[200:203], v[112:115], a[16:19], v[200:203]
    s_xor_b32 s21, s3, 3
    v_mfma_f32_16x16x32_bf16 v[200:203], v[116:119], a[24:27], v[200:203]
    s_lshl2_add_u32 s21, s21, s4
    v_mfma_f32_16x16x32_bf16 v[204:207], v[104:107], a[4:7], 0
    s_mul_i32 s21, s21, 36864
    ds_read_b128 v[104:107], v11 offset:6144
    v_mfma_f32_16x16x32_bf16 v[204:207], v[108:111], a[12:15], v[204:207]
    s_add_u32 s21, s21, s28
    s_mov_b32 m0, s47
    ds_read_b128 v[108:111], v11 offset:14336
    v_mfma_f32_16x16x32_bf16 v[204:207], v[112:115], a[20:23], v[204:207]
    s_lshl2_add_u32 s98, s98, s4
    buffer_load_dwordx4 v1, s[56:59], s21 offen sc1 lds
    v_mfma_f32_16x16x32_bf16 v[204:207], v[116:119], a[28:31], v[204:207]
    s_mul_i32 s10, s98, 3072
    ds_read_b128 v[112:115], v11 offset:22528
    ds_read_b128 v[116:119], v11 offset:30720
    s_waitcnt lgkmcnt(4)
    v_mfma_f32_16x16x32_bf16 v[208:211], v[120:123], a[0:3], 0
    s_sub_u32 s99, s4, s61
    v_mfma_f32_16x16x32_bf16 v[208:211], v[124:127], a[8:11], v[208:211]
    s_and_b32 s99, s99, 3
    buffer_load_dwordx4 v1, s[56:59], s21 offen offset:1024 sc1 lds
    v_mfma_f32_16x16x32_bf16 v[208:211], v[128:131], a[16:19], v[208:211]
    s_lshl3_add_u32 s98, s99, s5
    v_mfma_f32_16x16x32_bf16 v[208:211], v[132:135], a[24:27], v[208:211]
    s_and_b32 s98, s98, 31
    v_mfma_f32_16x16x32_bf16 v[212:215], v[120:123], a[4:7], 0
    s_lshl_b32 s11, s6, 5
    ds_read_b128 v[120:123], v12 offset:0
    v_mfma_f32_16x16x32_bf16 v[212:215], v[124:127], a[12:15], v[212:215]
    s_add_u32 s98, s98, s11
    buffer_load_dwordx4 v1, s[56:59], s21 offen offset:2048 sc1 lds
    v_mfma_f32_16x16x32_bf16 v[212:215], v[128:131], a[20:23], v[212:215]
    s_mul_i32 s98, s98, 3
    ds_read_b128 v[124:127], v12 offset:8192
    ds_read_b128 v[128:131], v12 offset:16384
    v_mfma_f32_16x16x32_bf16 v[212:215], v[132:135], a[28:31], v[212:215]
    s_sub_u32 s98, s98, s99
    ds_read_b128 v[132:135], v12 offset:24576
    v_mfma_f32_16x16x32_bf16 v[216:219], v[136:139], a[0:3], 0
    s_add_u32 s98, s98, 3
    v_mfma_f32_16x16x32_bf16 v[216:219], v[140:143], a[8:11], v[216:219]
    s_lshl2_add_u32 s98, s98, s4
    v_mfma_f32_16x16x32_bf16 v[216:219], v[144:147], a[16:19], v[216:219]
    s_mul_i32 s11, s98, 3072
    buffer_load_dwordx4 v1, s[56:59], s21 offen offset:3072 sc1 lds
    v_mfma_f32_16x16x32_bf16 v[216:219], v[148:151], a[24:27], v[216:219]
    s_waitcnt vmcnt(11)
    v_mfma_f32_16x16x32_bf16 v[220:223], v[136:139], a[4:7], 0
    s_add_u32 s21, s21, 4096
    ds_read_b128 v[136:139], v12 offset:1024
    v_mfma_f32_16x16x32_bf16 v[220:223], v[140:143], a[12:15], v[220:223]
    s_add_u32 m0, s47, 4096
    ds_read_b128 v[140:143], v12 offset:9216
    v_mfma_f32_16x16x32_bf16 v[220:223], v[144:147], a[20:23], v[220:223]
    buffer_load_dwordx4 v1, s[56:59], s21 offen sc1 lds
    v_mfma_f32_16x16x32_bf16 v[220:223], v[148:151], a[28:31], v[220:223]
    s_waitcnt lgkmcnt(2)
    ds_read_b128 v[144:147], v12 offset:17408
    ds_read_b128 v[148:151], v12 offset:25600
    v_mfma_f32_16x16x32_bf16 v[224:227], v[104:107], a[0:3], 0
    s_cmp_eq_u32 s99, 0
    s_cselect_b32 s11, 1073741824, s11
    v_mfma_f32_16x16x32_bf16 v[224:227], v[108:111], a[8:11], v[224:227]
    v_mfma_f32_16x16x32_bf16 v[224:227], v[112:115], a[16:19], v[224:227]
    buffer_load_dwordx4 v1, s[56:59], s21 offen offset:1024 sc1 lds
    v_mfma_f32_16x16x32_bf16 v[224:227], v[116:119], a[24:27], v[224:227]
    v_mfma_f32_16x16x32_bf16 v[228:231], v[104:107], a[4:7], 0
    ds_read_b128 v[104:107], v12 offset:2048
    v_mfma_f32_16x16x32_bf16 v[228:231], v[108:111], a[12:15], v[228:231]
    ds_read_b128 v[108:111], v12 offset:10240
    v_mfma_f32_16x16x32_bf16 v[228:231], v[112:115], a[20:23], v[228:231]
    buffer_load_dwordx4 v1, s[56:59], s21 offen offset:2048 sc1 lds
    v_mfma_f32_16x16x32_bf16 v[228:231], v[116:119], a[28:31], v[228:231]
    ds_read_b128 v[112:115], v12 offset:18432
    ds_read_b128 v[116:119], v12 offset:26624
    v_mfma_f32_16x16x32_bf16 v[176:179], v[120:123], a[32:35], v[176:179]
    v_mfma_f32_16x16x32_bf16 v[176:179], v[124:127], a[40:43], v[176:179]
    v_mfma_f32_16x16x32_bf16 v[176:179], v[128:131], a[48:51], v[176:179]
    buffer_load_dwordx4 a[100:103], v5, s[40:43], s20 offen offset:0 sc1
    v_mfma_f32_16x16x32_bf16 v[176:179], v[132:135], a[56:59], v[176:179]
    v_mfma_f32_16x16x32_bf16 v[180:183], v[120:123], a[36:39], v[180:183]
    ds_read_b128 v[120:123], v12 offset:3072
    v_mfma_f32_16x16x32_bf16 v[180:183], v[124:127], a[44:47], v[180:183]
    ds_read_b128 v[124:127], v12 offset:11264
    v_mfma_f32_16x16x32_bf16 v[180:183], v[128:131], a[52:55], v[180:183]
    ds_read_b128 v[128:131], v12 offset:19456
    v_mfma_f32_16x16x32_bf16 v[180:183], v[132:135], a[60:63], v[180:183]
    s_waitcnt lgkmcnt(3)
    buffer_load_dwordx4 a[108:111], v5, s[40:43], s20 offen offset:1024 sc1
    v_mfma_f32_16x16x32_bf16 v[184:187], v[136:139], a[32:35], v[184:187]
    ds_read_b128 v[132:135], v12 offset:27648
    v_mfma_f32_16x16x32_bf16 v[184:187], v[140:143], a[40:43], v[184:187]
    v_mfma_f32_16x16x32_bf16 v[184:187], v[144:147], a[48:51], v[184:187]
    v_mfma_f32_16x16x32_bf16 v[184:187], v[148:151], a[56:59], v[184:187]
    buffer_load_dwordx4 a[116:119], v5, s[40:43], s20 offen offset:2048 sc1
    v_mfma_f32_16x16x32_bf16 v[188:191], v[136:139], a[36:39], v[188:191]
    ds_read_b128 v[136:139], v12 offset:4096
    v_mfma_f32_16x16x32_bf16 v[188:191], v[140:143], a[44:47], v[188:191]
    ds_read_b128 v[140:143], v12 offset:12288
    v_mfma_f32_16x16x32_bf16 v[188:191], v[144:147], a[52:55], v[188:191]
    ds_read_b128 v[144:147], v12 offset:20480
    v_mfma_f32_16x16x32_bf16 v[188:191], v[148:151], a[60:63], v[188:191]
    buffer_load_dwordx4 a[124:127], v5, s[40:43], s20 offen offset:3072 sc1
    v_mfma_f32_16x16x32_bf16 v[192:195], v[104:107], a[32:35], v[192:195]
    s_xor_b32 s21, s3, 4
    ds_read_b128 v[148:151], v12 offset:28672
    v_mfma_f32_16x16x32_bf16 v[192:195], v[108:111], a[40:43], v[192:195]
    s_lshl2_add_u32 s21, s21, s4
    v_mfma_f32_16x16x32_bf16 v[192:195], v[112:115], a[48:51], v[192:195]
    s_mul_i32 s21, s21, 36864
    v_mfma_f32_16x16x32_bf16 v[192:195], v[116:119], a[56:59], v[192:195]
    s_add_u32 s21, s21, s28
    s_mov_b32 m0, s79
    v_mfma_f32_16x16x32_bf16 v[196:199], v[104:107], a[36:39], v[196:199]
    s_xor_b32 s20, s20, 28672
    buffer_load_dwordx4 v1, s[56:59], s21 offen sc1 lds
    v_mfma_f32_16x16x32_bf16 v[196:199], v[108:111], a[44:47], v[196:199]
    ds_read_b128 v[104:107], v12 offset:5120
    ds_read_b128 v[108:111], v12 offset:13312
    v_mfma_f32_16x16x32_bf16 v[196:199], v[112:115], a[52:55], v[196:199]
    ds_read_b128 v[112:115], v12 offset:21504
    v_mfma_f32_16x16x32_bf16 v[196:199], v[116:119], a[60:63], v[196:199]
    s_waitcnt lgkmcnt(3)
    buffer_load_dwordx4 v1, s[56:59], s21 offen offset:1024 sc1 lds
    v_mfma_f32_16x16x32_bf16 v[200:203], v[120:123], a[32:35], v[200:203]
    ds_read_b128 v[116:119], v12 offset:29696
    v_mfma_f32_16x16x32_bf16 v[200:203], v[124:127], a[40:43], v[200:203]
    v_mfma_f32_16x16x32_bf16 v[200:203], v[128:131], a[48:51], v[200:203]
    v_mfma_f32_16x16x32_bf16 v[200:203], v[132:135], a[56:59], v[200:203]
    v_mfma_f32_16x16x32_bf16 v[204:207], v[120:123], a[36:39], v[204:207]
    buffer_load_dwordx4 v1, s[56:59], s21 offen offset:2048 sc1 lds
    v_mfma_f32_16x16x32_bf16 v[204:207], v[124:127], a[44:47], v[204:207]
    ds_read_b128 v[120:123], v12 offset:6144
    ds_read_b128 v[124:127], v12 offset:14336
    v_mfma_f32_16x16x32_bf16 v[204:207], v[128:131], a[52:55], v[204:207]
    ds_read_b128 v[128:131], v12 offset:22528
    v_mfma_f32_16x16x32_bf16 v[204:207], v[132:135], a[60:63], v[204:207]
    ds_read_b128 v[132:135], v12 offset:30720
    v_mfma_f32_16x16x32_bf16 v[208:211], v[136:139], a[32:35], v[208:211]
    buffer_load_dwordx4 v1, s[56:59], s21 offen offset:3072 sc1 lds
    v_mfma_f32_16x16x32_bf16 v[208:211], v[140:143], a[40:43], v[208:211]
    s_add_u32 s21, s21, 4096
    v_mfma_f32_16x16x32_bf16 v[208:211], v[144:147], a[48:51], v[208:211]
    s_add_u32 m0, s79, 4096
    v_mfma_f32_16x16x32_bf16 v[208:211], v[148:151], a[56:59], v[208:211]
    v_mfma_f32_16x16x32_bf16 v[212:215], v[136:139], a[36:39], v[212:215]
    buffer_load_dwordx4 v1, s[56:59], s21 offen sc1 lds
    v_mfma_f32_16x16x32_bf16 v[212:215], v[140:143], a[44:47], v[212:215]
    ds_read_b128 v[136:139], v13 offset:0
    ds_read_b128 v[140:143], v13 offset:8192
    v_mfma_f32_16x16x32_bf16 v[212:215], v[144:147], a[52:55], v[212:215]
    ds_read_b128 v[144:147], v13 offset:16384
    v_mfma_f32_16x16x32_bf16 v[212:215], v[148:151], a[60:63], v[212:215]
    s_waitcnt lgkmcnt(3)
    ds_read_b128 v[148:151], v13 offset:24576
    v_mfma_f32_16x16x32_bf16 v[216:219], v[104:107], a[32:35], v[216:219]
    buffer_load_dwordx4 v1, s[56:59], s21 offen offset:1024 sc1 lds
    v_mfma_f32_16x16x32_bf16 v[216:219], v[108:111], a[40:43], v[216:219]
    v_mfma_f32_16x16x32_bf16 v[216:219], v[112:115], a[48:51], v[216:219]
    v_mfma_f32_16x16x32_bf16 v[216:219], v[116:119], a[56:59], v[216:219]
    s_waitcnt vmcnt(20)
    s_barrier
    v_mfma_f32_16x16x32_bf16 v[220:223], v[104:107], a[36:39], v[220:223]
    buffer_load_dwordx4 v1, s[56:59], s21 offen offset:2048 sc1 lds
    v_mfma_f32_16x16x32_bf16 v[220:223], v[108:111], a[44:47], v[220:223]
    ds_read_b128 v[104:107], v13 offset:1024
    ds_read_b128 v[108:111], v13 offset:9216
    v_mfma_f32_16x16x32_bf16 v[220:223], v[112:115], a[52:55], v[220:223]
    ds_read_b128 v[112:115], v13 offset:17408
    v_mfma_f32_16x16x32_bf16 v[220:223], v[116:119], a[60:63], v[220:223]
    ds_read_b128 v[116:119], v13 offset:25600
    v_mfma_f32_16x16x32_bf16 v[224:227], v[120:123], a[32:35], v[224:227]
    v_mfma_f32_16x16x32_bf16 v[224:227], v[124:127], a[40:43], v[224:227]
    buffer_load_dwordx4 a[132:135], v5, s[40:43], s20 offen offset:0 sc1
    v_mfma_f32_16x16x32_bf16 v[224:227], v[128:131], a[48:51], v[224:227]
    v_mfma_f32_16x16x32_bf16 v[224:227], v[132:135], a[56:59], v[224:227]
    v_mfma_f32_16x16x32_bf16 v[228:231], v[120:123], a[36:39], v[228:231]
    ds_read_b128 v[120:123], v13 offset:2048
    v_mfma_f32_16x16x32_bf16 v[228:231], v[124:127], a[44:47], v[228:231]
    buffer_load_dwordx4 a[140:143], v5, s[40:43], s20 offen offset:1024 sc1
    v_mfma_f32_16x16x32_bf16 v[228:231], v[128:131], a[52:55], v[228:231]
    ds_read_b128 v[124:127], v13 offset:10240
    ds_read_b128 v[128:131], v13 offset:18432
    v_mfma_f32_16x16x32_bf16 v[228:231], v[132:135], a[60:63], v[228:231]
    s_waitcnt lgkmcnt(3)
    ds_read_b128 v[132:135], v13 offset:26624
    v_mfma_f32_16x16x32_bf16 v[176:179], v[136:139], a[64:67], v[176:179]
    v_mfma_f32_16x16x32_bf16 v[176:179], v[140:143], a[72:75], v[176:179]
    buffer_load_dwordx4 a[148:151], v5, s[40:43], s20 offen offset:2048 sc1
    v_mfma_f32_16x16x32_bf16 v[176:179], v[144:147], a[80:83], v[176:179]
    v_mfma_f32_16x16x32_bf16 v[176:179], v[148:151], a[88:91], v[176:179]
    v_mfma_f32_16x16x32_bf16 v[180:183], v[136:139], a[68:71], v[180:183]
    ds_read_b128 v[136:139], v13 offset:3072
    v_mfma_f32_16x16x32_bf16 v[180:183], v[140:143], a[76:79], v[180:183]
    buffer_load_dwordx4 a[156:159], v5, s[40:43], s20 offen offset:3072 sc1
    v_mfma_f32_16x16x32_bf16 v[180:183], v[144:147], a[84:87], v[180:183]
    s_xor_b32 s21, s3, 5
    ds_read_b128 v[140:143], v13 offset:11264
    ds_read_b128 v[144:147], v13 offset:19456
    v_mfma_f32_16x16x32_bf16 v[180:183], v[148:151], a[92:95], v[180:183]
    s_lshl2_add_u32 s21, s21, s4
    ds_read_b128 v[148:151], v13 offset:27648
    v_mfma_f32_16x16x32_bf16 v[184:187], v[104:107], a[64:67], v[184:187]
    s_mul_i32 s21, s21, 36864
    v_mfma_f32_16x16x32_bf16 v[184:187], v[108:111], a[72:75], v[184:187]
    s_add_u32 s21, s21, s28
    s_mov_b32 m0, s44
    v_mfma_f32_16x16x32_bf16 v[184:187], v[112:115], a[80:83], v[184:187]
    s_xor_b32 s20, s20, 4096
    buffer_load_dwordx4 v1, s[56:59], s21 offen sc1 lds
    v_mfma_f32_16x16x32_bf16 v[184:187], v[116:119], a[88:91], v[184:187]
    v_mfma_f32_16x16x32_bf16 v[188:191], v[104:107], a[68:71], v[188:191]
    ds_read_b128 v[104:107], v13 offset:4096
    v_mfma_f32_16x16x32_bf16 v[188:191], v[108:111], a[76:79], v[188:191]
    ds_read_b128 v[108:111], v13 offset:12288
    v_mfma_f32_16x16x32_bf16 v[188:191], v[112:115], a[84:87], v[188:191]
    buffer_load_dwordx4 v1, s[56:59], s21 offen offset:1024 sc1 lds
    v_mfma_f32_16x16x32_bf16 v[188:191], v[116:119], a[92:95], v[188:191]
    s_waitcnt lgkmcnt(2)
    ds_read_b128 v[112:115], v13 offset:20480
    ds_read_b128 v[116:119], v13 offset:28672
    v_mfma_f32_16x16x32_bf16 v[192:195], v[120:123], a[64:67], v[192:195]
    v_mfma_f32_16x16x32_bf16 v[192:195], v[124:127], a[72:75], v[192:195]
    v_mfma_f32_16x16x32_bf16 v[192:195], v[128:131], a[80:83], v[192:195]
    buffer_load_dwordx4 v1, s[56:59], s21 offen offset:2048 sc1 lds
    v_mfma_f32_16x16x32_bf16 v[192:195], v[132:135], a[88:91], v[192:195]
    v_mfma_f32_16x16x32_bf16 v[196:199], v[120:123], a[68:71], v[196:199]
    ds_read_b128 v[120:123], v13 offset:5120
    v_mfma_f32_16x16x32_bf16 v[196:199], v[124:127], a[76:79], v[196:199]
    ds_read_b128 v[124:127], v13 offset:13312
    v_mfma_f32_16x16x32_bf16 v[196:199], v[128:131], a[84:87], v[196:199]
    buffer_load_dwordx4 v1, s[56:59], s21 offen offset:3072 sc1 lds
    v_mfma_f32_16x16x32_bf16 v[196:199], v[132:135], a[92:95], v[196:199]
    s_add_u32 s21, s21, 4096
    ds_read_b128 v[128:131], v13 offset:21504
    ds_read_b128 v[132:135], v13 offset:29696
    v_mfma_f32_16x16x32_bf16 v[200:203], v[136:139], a[64:67], v[200:203]
    s_add_u32 m0, s44, 4096
    v_mfma_f32_16x16x32_bf16 v[200:203], v[140:143], a[72:75], v[200:203]
    v_mfma_f32_16x16x32_bf16 v[200:203], v[144:147], a[80:83], v[200:203]
    buffer_load_dwordx4 v1, s[56:59], s21 offen sc1 lds
    v_mfma_f32_16x16x32_bf16 v[200:203], v[148:151], a[88:91], v[200:203]
    v_mfma_f32_16x16x32_bf16 v[204:207], v[136:139], a[68:71], v[204:207]
    ds_read_b128 v[136:139], v13 offset:6144
    v_mfma_f32_16x16x32_bf16 v[204:207], v[140:143], a[76:79], v[204:207]
    ds_read_b128 v[140:143], v13 offset:14336
    v_mfma_f32_16x16x32_bf16 v[204:207], v[144:147], a[84:87], v[204:207]
    buffer_load_dwordx4 v1, s[56:59], s21 offen offset:1024 sc1 lds
    v_mfma_f32_16x16x32_bf16 v[204:207], v[148:151], a[92:95], v[204:207]
    s_waitcnt lgkmcnt(2)
    ds_read_b128 v[144:147], v13 offset:22528
    ds_read_b128 v[148:151], v13 offset:30720
    v_mfma_f32_16x16x32_bf16 v[208:211], v[104:107], a[64:67], v[208:211]
    v_mfma_f32_16x16x32_bf16 v[208:211], v[108:111], a[72:75], v[208:211]
    v_mfma_f32_16x16x32_bf16 v[208:211], v[112:115], a[80:83], v[208:211]
    v_mfma_f32_16x16x32_bf16 v[208:211], v[116:119], a[88:91], v[208:211]
    buffer_load_dwordx4 v1, s[56:59], s21 offen offset:2048 sc1 lds
    v_mfma_f32_16x16x32_bf16 v[212:215], v[104:107], a[68:71], v[212:215]
    v_mfma_f32_16x16x32_bf16 v[212:215], v[108:111], a[76:79], v[212:215]
    v_mfma_f32_16x16x32_bf16 v[212:215], v[112:115], a[84:87], v[212:215]
    v_mfma_f32_16x16x32_bf16 v[212:215], v[116:119], a[92:95], v[212:215]
    buffer_load_dwordx4 a[160:163], v4, s[40:43], s63 offen offset:0 sc1
    v_mfma_f32_16x16x32_bf16 v[216:219], v[120:123], a[64:67], v[216:219]
    v_mfma_f32_16x16x32_bf16 v[216:219], v[124:127], a[72:75], v[216:219]
    v_mfma_f32_16x16x32_bf16 v[216:219], v[128:131], a[80:83], v[216:219]
    v_mfma_f32_16x16x32_bf16 v[216:219], v[132:135], a[88:91], v[216:219]
    s_waitcnt vmcnt(19)
    s_barrier
    v_mov_b32 v31, 3
    v_mfma_f32_16x16x32_bf16 v[220:223], v[120:123], a[68:71], v[220:223]
    buffer_load_dwordx4 a[168:171], v4, s[40:43], s63 offen offset:1024 sc1
    v_mfma_f32_16x16x32_bf16 v[220:223], v[124:127], a[76:79], v[220:223]
    buffer_store_dword v31, v30, s[32:35], s101 offen sc1
    v_mfma_f32_16x16x32_bf16 v[220:223], v[128:131], a[84:87], v[220:223]
    ds_read_b128 v[104:107], v6 offset:0
    ds_read_b128 v[108:111], v6 offset:8192
    v_mfma_f32_16x16x32_bf16 v[220:223], v[132:135], a[92:95], v[220:223]
    s_waitcnt lgkmcnt(2)
    ds_read_b128 v[112:115], v6 offset:16384
    v_mfma_f32_16x16x32_bf16 v[224:227], v[136:139], a[64:67], v[224:227]
    buffer_load_dwordx4 a[176:179], v4, s[40:43], s63 offen offset:2048 sc1
    v_mfma_f32_16x16x32_bf16 v[224:227], v[140:143], a[72:75], v[224:227]
    ds_read_b128 v[116:119], v6 offset:24576
    ds_read_b128 v[120:123], v6 offset:1024
    v_mfma_f32_16x16x32_bf16 v[224:227], v[144:147], a[80:83], v[224:227]
    ds_read_b128 v[124:127], v6 offset:9216
    v_mfma_f32_16x16x32_bf16 v[224:227], v[148:151], a[88:91], v[224:227]
    ds_read_b128 v[128:131], v6 offset:17408
    v_mfma_f32_16x16x32_bf16 v[228:231], v[136:139], a[68:71], v[228:231]
    buffer_load_dwordx4 a[184:187], v4, s[40:43], s63 offen offset:3072 sc1
    v_mfma_f32_16x16x32_bf16 v[228:231], v[140:143], a[76:79], v[228:231]
    s_xor_b32 s63, s63, 12288
    ds_read_b128 v[132:135], v6 offset:25600
    ds_read_b128 v[136:139], v6 offset:2048
    v_mfma_f32_16x16x32_bf16 v[228:231], v[144:147], a[84:87], v[228:231]
    ds_read_b128 v[140:143], v6 offset:10240
    v_mfma_f32_16x16x32_bf16 v[228:231], v[148:151], a[92:95], v[228:231]
    s_waitcnt lgkmcnt(4)
    ds_read_b128 v[144:147], v6 offset:18432
    v_mfma_f32_16x16x32_bf16 v[176:179], v[104:107], a[96:99], v[176:179]
    buffer_load_dwordx4 a[164:167], v5, s[40:43], s20 offen offset:0 sc1
    v_mfma_f32_16x16x32_bf16 v[176:179], v[108:111], a[104:107], v[176:179]
    ds_read_b128 v[148:151], v6 offset:26624
    v_mfma_f32_16x16x32_bf16 v[176:179], v[112:115], a[112:115], v[176:179]
    v_mfma_f32_16x16x32_bf16 v[176:179], v[116:119], a[120:123], v[176:179]
    v_mfma_f32_16x16x32_bf16 v[180:183], v[104:107], a[100:103], v[180:183]
    buffer_load_dwordx4 a[172:175], v5, s[40:43], s20 offen offset:1024 sc1
    v_mfma_f32_16x16x32_bf16 v[180:183], v[108:111], a[108:111], v[180:183]
    ds_read_b128 v[104:107], v6 offset:3072
    ds_read_b128 v[108:111], v6 offset:11264
    v_mfma_f32_16x16x32_bf16 v[180:183], v[112:115], a[116:119], v[180:183]
    ds_read_b128 v[112:115], v6 offset:19456
    v_mfma_f32_16x16x32_bf16 v[180:183], v[116:119], a[124:127], v[180:183]
    ds_read_b128 v[116:119], v6 offset:27648
    v_mfma_f32_16x16x32_bf16 v[184:187], v[120:123], a[96:99], v[184:187]
    buffer_load_dwordx4 a[180:183], v5, s[40:43], s20 offen offset:2048 sc1
    v_mfma_f32_16x16x32_bf16 v[184:187], v[124:127], a[104:107], v[184:187]
    s_waitcnt lgkmcnt(4)
    v_mfma_f32_16x16x32_bf16 v[184:187], v[128:131], a[112:115], v[184:187]
    v_mfma_f32_16x16x32_bf16 v[184:187], v[132:135], a[120:123], v[184:187]
    v_mfma_f32_16x16x32_bf16 v[188:191], v[120:123], a[100:103], v[188:191]
    buffer_load_dwordx4 a[188:191], v5, s[40:43], s20 offen offset:3072 sc1
    v_mfma_f32_16x16x32_bf16 v[188:191], v[124:127], a[108:111], v[188:191]
    s_xor_b32 s21, s3, 6
    ds_read_b128 v[120:123], v6 offset:4096
    ds_read_b128 v[124:127], v6 offset:12288
    v_mfma_f32_16x16x32_bf16 v[188:191], v[128:131], a[116:119], v[188:191]
    s_lshl2_add_u32 s21, s21, s4
    ds_read_b128 v[128:131], v6 offset:20480
    v_mfma_f32_16x16x32_bf16 v[188:191], v[132:135], a[124:127], v[188:191]
    s_mul_i32 s21, s21, 36864
    ds_read_b128 v[132:135], v6 offset:28672
    v_mfma_f32_16x16x32_bf16 v[192:195], v[136:139], a[96:99], v[192:195]
    s_add_u32 s21, s21, s28
    s_mov_b32 m0, s45
    v_mfma_f32_16x16x32_bf16 v[192:195], v[140:143], a[104:107], v[192:195]
    s_xor_b32 s20, s20, 12288
    buffer_load_dwordx4 v1, s[56:59], s21 offen sc1 lds
    v_mfma_f32_16x16x32_bf16 v[192:195], v[144:147], a[112:115], v[192:195]
    v_mfma_f32_16x16x32_bf16 v[192:195], v[148:151], a[120:123], v[192:195]
    v_mfma_f32_16x16x32_bf16 v[196:199], v[136:139], a[100:103], v[196:199]
    buffer_load_dwordx4 v1, s[56:59], s21 offen offset:1024 sc1 lds
    v_mfma_f32_16x16x32_bf16 v[196:199], v[140:143], a[108:111], v[196:199]
    ds_read_b128 v[136:139], v6 offset:5120
    ds_read_b128 v[140:143], v6 offset:13312
    v_mfma_f32_16x16x32_bf16 v[196:199], v[144:147], a[116:119], v[196:199]
    ds_read_b128 v[144:147], v6 offset:21504
    v_mfma_f32_16x16x32_bf16 v[196:199], v[148:151], a[124:127], v[196:199]
    s_waitcnt lgkmcnt(3)
    ds_read_b128 v[148:151], v6 offset:29696
    v_mfma_f32_16x16x32_bf16 v[200:203], v[104:107], a[96:99], v[200:203]
    v_mfma_f32_16x16x32_bf16 v[200:203], v[108:111], a[104:107], v[200:203]
    buffer_load_dwordx4 v1, s[56:59], s21 offen offset:2048 sc1 lds
    v_mfma_f32_16x16x32_bf16 v[200:203], v[112:115], a[112:115], v[200:203]
    v_mfma_f32_16x16x32_bf16 v[200:203], v[116:119], a[120:123], v[200:203]
    v_mfma_f32_16x16x32_bf16 v[204:207], v[104:107], a[100:103], v[204:207]
    ds_read_b128 v[104:107], v6 offset:6144
    v_mfma_f32_16x16x32_bf16 v[204:207], v[108:111], a[108:111], v[204:207]
    buffer_load_dwordx4 v1, s[56:59], s21 offen offset:3072 sc1 lds
    v_mfma_f32_16x16x32_bf16 v[204:207], v[112:115], a[116:119], v[204:207]
    s_add_u32 s21, s21, 4096
    ds_read_b128 v[108:111], v6 offset:14336
    ds_read_b128 v[112:115], v6 offset:22528
    v_mfma_f32_16x16x32_bf16 v[204:207], v[116:119], a[124:127], v[204:207]
    s_add_u32 m0, s45, 4096
    ds_read_b128 v[116:119], v6 offset:30720
    v_mfma_f32_16x16x32_bf16 v[208:211], v[120:123], a[96:99], v[208:211]
    v_mfma_f32_16x16x32_bf16 v[208:211], v[124:127], a[104:107], v[208:211]
    buffer_load_dwordx4 v1, s[56:59], s21 offen sc1 lds
    v_mfma_f32_16x16x32_bf16 v[208:211], v[128:131], a[112:115], v[208:211]
    v_mfma_f32_16x16x32_bf16 v[208:211], v[132:135], a[120:123], v[208:211]
    v_mfma_f32_16x16x32_bf16 v[212:215], v[120:123], a[100:103], v[212:215]
    v_mfma_f32_16x16x32_bf16 v[212:215], v[124:127], a[108:111], v[212:215]
    buffer_load_dwordx4 v1, s[56:59], s21 offen offset:1024 sc1 lds
    v_mfma_f32_16x16x32_bf16 v[212:215], v[128:131], a[116:119], v[212:215]
    v_mfma_f32_16x16x32_bf16 v[212:215], v[132:135], a[124:127], v[212:215]
    s_waitcnt lgkmcnt(0)
    v_mfma_f32_16x16x32_bf16 v[216:219], v[136:139], a[96:99], v[216:219]
    v_mfma_f32_16x16x32_bf16 v[216:219], v[140:143], a[104:107], v[216:219]
    buffer_load_dwordx4 v1, s[56:59], s21 offen offset:2048 sc1 lds
    v_mfma_f32_16x16x32_bf16 v[216:219], v[144:147], a[112:115], v[216:219]
    v_mfma_f32_16x16x32_bf16 v[216:219], v[148:151], a[120:123], v[216:219]
    s_waitcnt vmcnt(23)
    s_barrier
    ds_read_b128 v[120:123], v7 offset:0
    v_mfma_f32_16x16x32_bf16 v[220:223], v[136:139], a[100:103], v[220:223]
    ds_read_b128 v[124:127], v7 offset:8192
    ds_read_b128 v[128:131], v7 offset:16384
    v_mfma_f32_16x16x32_bf16 v[220:223], v[140:143], a[108:111], v[220:223]
    ds_read_b128 v[132:135], v7 offset:24576
    v_mfma_f32_16x16x32_bf16 v[220:223], v[144:147], a[116:119], v[220:223]
    buffer_load_dwordx4 a[192:195], v4, s[40:43], s63 offen offset:0 sc1
    v_mfma_f32_16x16x32_bf16 v[220:223], v[148:151], a[124:127], v[220:223]
    ds_read_b128 v[136:139], v7 offset:1024
    ds_read_b128 v[140:143], v7 offset:9216
    v_mfma_f32_16x16x32_bf16 v[224:227], v[104:107], a[96:99], v[224:227]
    ds_read_b128 v[144:147], v7 offset:17408
    v_mfma_f32_16x16x32_bf16 v[224:227], v[108:111], a[104:107], v[224:227]
    ds_read_b128 v[148:151], v7 offset:25600
    v_mfma_f32_16x16x32_bf16 v[224:227], v[112:115], a[112:115], v[224:227]
    buffer_load_dwordx4 a[200:203], v4, s[40:43], s63 offen offset:1024 sc1
    v_mfma_f32_16x16x32_bf16 v[224:227], v[116:119], a[120:123], v[224:227]
    v_mfma_f32_16x16x32_bf16 v[228:231], v[104:107], a[100:103], v[228:231]
    ds_read_b128 v[104:107], v7 offset:2048
    v_mfma_f32_16x16x32_bf16 v[228:231], v[108:111], a[108:111], v[228:231]
    ds_read_b128 v[108:111], v7 offset:10240
    v_mfma_f32_16x16x32_bf16 v[228:231], v[112:115], a[116:119], v[228:231]
    buffer_load_dwordx4 a[208:211], v4, s[40:43], s63 offen offset:2048 sc1
    v_mfma_f32_16x16x32_bf16 v[228:231], v[116:119], a[124:127], v[228:231]
    s_waitcnt lgkmcnt(2)
    ds_read_b128 v[112:115], v7 offset:18432
    ds_read_b128 v[116:119], v7 offset:26624
    v_mfma_f32_16x16x32_bf16 v[176:179], v[120:123], a[128:131], v[176:179]
    v_mfma_f32_16x16x32_bf16 v[176:179], v[124:127], a[136:139], v[176:179]
    v_mfma_f32_16x16x32_bf16 v[176:179], v[128:131], a[144:147], v[176:179]
    buffer_load_dwordx4 a[216:219], v4, s[40:43], s63 offen offset:3072 sc1
    v_mfma_f32_16x16x32_bf16 v[176:179], v[132:135], a[152:155], v[176:179]
    s_xor_b32 s63, s63, 4096
    v_mfma_f32_16x16x32_bf16 v[180:183], v[120:123], a[132:135], v[180:183]
    ds_read_b128 v[120:123], v7 offset:3072
    v_mfma_f32_16x16x32_bf16 v[180:183], v[124:127], a[140:143], v[180:183]
    ds_read_b128 v[124:127], v7 offset:11264
    v_mfma_f32_16x16x32_bf16 v[180:183], v[128:131], a[148:151], v[180:183]
    buffer_load_dwordx4 a[196:199], v5, s[40:43], s20 offen offset:0 sc1
    v_mfma_f32_16x16x32_bf16 v[180:183], v[132:135], a[156:159], v[180:183]
    ds_read_b128 v[128:131], v7 offset:19456
    ds_read_b128 v[132:135], v7 offset:27648
    v_mfma_f32_16x16x32_bf16 v[184:187], v[136:139], a[128:131], v[184:187]
    v_mfma_f32_16x16x32_bf16 v[184:187], v[140:143], a[136:139], v[184:187]
    v_mfma_f32_16x16x32_bf16 v[184:187], v[144:147], a[144:147], v[184:187]
    v_mfma_f32_16x16x32_bf16 v[184:187], v[148:151], a[152:155], v[184:187]
    buffer_load_dwordx4 a[204:207], v5, s[40:43], s20 offen offset:1024 sc1
    v_mfma_f32_16x16x32_bf16 v[188:191], v[136:139], a[132:135], v[188:191]
    ds_read_b128 v[136:139], v7 offset:4096
    v_mfma_f32_16x16x32_bf16 v[188:191], v[140:143], a[140:143], v[188:191]
    ds_read_b128 v[140:143], v7 offset:12288
    v_mfma_f32_16x16x32_bf16 v[188:191], v[144:147], a[148:151], v[188:191]
    ds_read_b128 v[144:147], v7 offset:20480
    v_mfma_f32_16x16x32_bf16 v[188:191], v[148:151], a[156:159], v[188:191]
    s_waitcnt lgkmcnt(3)
    buffer_load_dwordx4 a[212:215], v5, s[40:43], s20 offen offset:2048 sc1
    v_mfma_f32_16x16x32_bf16 v[192:195], v[104:107], a[128:131], v[192:195]
    ds_read_b128 v[148:151], v7 offset:28672
    v_mfma_f32_16x16x32_bf16 v[192:195], v[108:111], a[136:139], v[192:195]
    v_mfma_f32_16x16x32_bf16 v[192:195], v[112:115], a[144:147], v[192:195]
    v_mfma_f32_16x16x32_bf16 v[192:195], v[116:119], a[152:155], v[192:195]
    buffer_load_dwordx4 a[220:223], v5, s[40:43], s20 offen offset:3072 sc1
    v_mfma_f32_16x16x32_bf16 v[196:199], v[104:107], a[132:135], v[196:199]
    s_xor_b32 s21, s3, 7
    ds_read_b128 v[104:107], v7 offset:5120
    v_mfma_f32_16x16x32_bf16 v[196:199], v[108:111], a[140:143], v[196:199]
    s_lshl2_add_u32 s21, s21, s4
    ds_read_b128 v[108:111], v7 offset:13312
    v_mfma_f32_16x16x32_bf16 v[196:199], v[112:115], a[148:151], v[196:199]
    s_mul_i32 s21, s21, 36864
    ds_read_b128 v[112:115], v7 offset:21504
    v_mfma_f32_16x16x32_bf16 v[196:199], v[116:119], a[156:159], v[196:199]
    s_add_u32 s21, s21, s28
    s_mov_b32 m0, s46
    ds_read_b128 v[116:119], v7 offset:29696
    v_mfma_f32_16x16x32_bf16 v[200:203], v[120:123], a[128:131], v[200:203]
    s_xor_b32 s20, s20, 4096
    buffer_load_dwordx4 v1, s[56:59], s21 offen sc1 lds
    v_mfma_f32_16x16x32_bf16 v[200:203], v[124:127], a[136:139], v[200:203]
    v_mfma_f32_16x16x32_bf16 v[200:203], v[128:131], a[144:147], v[200:203]
    v_mfma_f32_16x16x32_bf16 v[200:203], v[132:135], a[152:155], v[200:203]
    buffer_load_dwordx4 v1, s[56:59], s21 offen offset:1024 sc1 lds
    v_mfma_f32_16x16x32_bf16 v[204:207], v[120:123], a[132:135], v[204:207]
    ds_read_b128 v[120:123], v7 offset:6144
    v_mfma_f32_16x16x32_bf16 v[204:207], v[124:127], a[140:143], v[204:207]
    ds_read_b128 v[124:127], v7 offset:14336
    v_mfma_f32_16x16x32_bf16 v[204:207], v[128:131], a[148:151], v[204:207]
    buffer_load_dword v3, v19, s[32:35], s66 offen sc1
    v_mfma_f32_16x16x32_bf16 v[204:207], v[132:135], a[156:159], v[204:207]
    s_waitcnt lgkmcnt(2)
    ds_read_b128 v[128:131], v7 offset:22528
    ds_read_b128 v[132:135], v7 offset:30720
    v_mfma_f32_16x16x32_bf16 v[208:211], v[136:139], a[128:131], v[208:211]
    buffer_load_dwordx4 v1, s[56:59], s21 offen offset:2048 sc1 lds
    v_mfma_f32_16x16x32_bf16 v[208:211], v[140:143], a[136:139], v[208:211]
    v_mfma_f32_16x16x32_bf16 v[208:211], v[144:147], a[144:147], v[208:211]
    v_mfma_f32_16x16x32_bf16 v[208:211], v[148:151], a[152:155], v[208:211]
    v_mfma_f32_16x16x32_bf16 v[212:215], v[136:139], a[132:135], v[212:215]
    buffer_load_dwordx4 v1, s[56:59], s21 offen offset:3072 sc1 lds
    v_mfma_f32_16x16x32_bf16 v[212:215], v[140:143], a[140:143], v[212:215]
    s_add_u32 s21, s21, 4096
    v_mfma_f32_16x16x32_bf16 v[212:215], v[144:147], a[148:151], v[212:215]
    s_add_u32 m0, s46, 4096
    v_mfma_f32_16x16x32_bf16 v[212:215], v[148:151], a[156:159], v[212:215]
    v_mfma_f32_16x16x32_bf16 v[216:219], v[104:107], a[128:131], v[216:219]
    buffer_load_dwordx4 v1, s[56:59], s21 offen sc1 lds
    v_mfma_f32_16x16x32_bf16 v[216:219], v[108:111], a[136:139], v[216:219]
    v_mfma_f32_16x16x32_bf16 v[216:219], v[112:115], a[144:147], v[216:219]
    v_mfma_f32_16x16x32_bf16 v[216:219], v[116:119], a[152:155], v[216:219]
    s_waitcnt vmcnt(21)
    s_barrier
    ds_read_b128 v[136:139], v11 offset:0
    v_mfma_f32_16x16x32_bf16 v[220:223], v[104:107], a[132:135], v[220:223]
    buffer_load_dwordx4 v1, s[56:59], s21 offen offset:1024 sc1 lds
    v_mfma_f32_16x16x32_bf16 v[220:223], v[108:111], a[140:143], v[220:223]
    ds_read_b128 v[140:143], v11 offset:8192
    ds_read_b128 v[144:147], v11 offset:16384
    v_mfma_f32_16x16x32_bf16 v[220:223], v[112:115], a[148:151], v[220:223]
    ds_read_b128 v[148:151], v11 offset:24576
    v_mfma_f32_16x16x32_bf16 v[220:223], v[116:119], a[156:159], v[220:223]
    s_waitcnt lgkmcnt(4)
    ds_read_b128 v[104:107], v11 offset:1024
    v_mfma_f32_16x16x32_bf16 v[224:227], v[120:123], a[128:131], v[224:227]
    buffer_load_dwordx4 v1, s[56:59], s21 offen offset:2048 sc1 lds
    v_mfma_f32_16x16x32_bf16 v[224:227], v[124:127], a[136:139], v[224:227]
    ds_read_b128 v[108:111], v11 offset:9216
    ds_read_b128 v[112:115], v11 offset:17408
    v_mfma_f32_16x16x32_bf16 v[224:227], v[128:131], a[144:147], v[224:227]
    ds_read_b128 v[116:119], v11 offset:25600
    v_mfma_f32_16x16x32_bf16 v[224:227], v[132:135], a[152:155], v[224:227]
    v_mfma_f32_16x16x32_bf16 v[228:231], v[120:123], a[132:135], v[228:231]
    ds_read_b128 v[120:123], v11 offset:2048
    v_mfma_f32_16x16x32_bf16 v[228:231], v[124:127], a[140:143], v[228:231]
    buffer_load_dwordx4 a[224:227], v4, s[40:43], s63 offen offset:0 sc1
    v_mfma_f32_16x16x32_bf16 v[228:231], v[128:131], a[148:151], v[228:231]
    ds_read_b128 v[124:127], v11 offset:10240
    ds_read_b128 v[128:131], v11 offset:18432
    v_mfma_f32_16x16x32_bf16 v[228:231], v[132:135], a[156:159], v[228:231]
    s_waitcnt lgkmcnt(3)
    ds_read_b128 v[132:135], v11 offset:26624
    v_mfma_f32_16x16x32_bf16 v[176:179], v[136:139], a[160:163], v[176:179]
    v_mfma_f32_16x16x32_bf16 v[176:179], v[140:143], a[168:171], v[176:179]
    buffer_load_dwordx4 a[232:235], v4, s[40:43], s63 offen offset:1024 sc1
    v_mfma_f32_16x16x32_bf16 v[176:179], v[144:147], a[176:179], v[176:179]
    v_mfma_f32_16x16x32_bf16 v[176:179], v[148:151], a[184:187], v[176:179]
    v_mfma_f32_16x16x32_bf16 v[180:183], v[136:139], a[164:167], v[180:183]
    ds_read_b128 v[136:139], v11 offset:3072
    v_mfma_f32_16x16x32_bf16 v[180:183], v[140:143], a[172:175], v[180:183]
    buffer_load_dwordx4 a[240:243], v4, s[40:43], s63 offen offset:2048 sc1
    v_mfma_f32_16x16x32_bf16 v[180:183], v[144:147], a[180:183], v[180:183]
    ds_read_b128 v[140:143], v11 offset:11264
    ds_read_b128 v[144:147], v11 offset:19456
    v_mfma_f32_16x16x32_bf16 v[180:183], v[148:151], a[188:191], v[180:183]
    ds_read_b128 v[148:151], v11 offset:27648
    v_mfma_f32_16x16x32_bf16 v[184:187], v[104:107], a[160:163], v[184:187]
    v_mfma_f32_16x16x32_bf16 v[184:187], v[108:111], a[168:171], v[184:187]
    buffer_load_dwordx4 a[248:251], v4, s[40:43], s63 offen offset:3072 sc1
    v_mfma_f32_16x16x32_bf16 v[184:187], v[112:115], a[176:179], v[184:187]
    s_add_u32 s63, s63, 4096
    v_mfma_f32_16x16x32_bf16 v[184:187], v[116:119], a[184:187], v[184:187]
    v_mfma_f32_16x16x32_bf16 v[188:191], v[104:107], a[164:167], v[188:191]
    ds_read_b128 v[104:107], v11 offset:4096
    v_mfma_f32_16x16x32_bf16 v[188:191], v[108:111], a[172:175], v[188:191]
    buffer_load_dwordx4 a[228:231], v5, s[40:43], s20 offen offset:0 sc1
    v_mfma_f32_16x16x32_bf16 v[188:191], v[112:115], a[180:183], v[188:191]
    ds_read_b128 v[108:111], v11 offset:12288
    ds_read_b128 v[112:115], v11 offset:20480
    v_mfma_f32_16x16x32_bf16 v[188:191], v[116:119], a[188:191], v[188:191]
    s_waitcnt lgkmcnt(3)
    ds_read_b128 v[116:119], v11 offset:28672
    v_mfma_f32_16x16x32_bf16 v[192:195], v[120:123], a[160:163], v[192:195]
    v_mfma_f32_16x16x32_bf16 v[192:195], v[124:127], a[168:171], v[192:195]
    v_mfma_f32_16x16x32_bf16 v[192:195], v[128:131], a[176:179], v[192:195]
    buffer_load_dwordx4 a[236:239], v5, s[40:43], s20 offen offset:1024 sc1
    v_mfma_f32_16x16x32_bf16 v[192:195], v[132:135], a[184:187], v[192:195]
    v_mfma_f32_16x16x32_bf16 v[196:199], v[120:123], a[164:167], v[196:199]
    ds_read_b128 v[120:123], v11 offset:5120
    v_mfma_f32_16x16x32_bf16 v[196:199], v[124:127], a[172:175], v[196:199]
    ds_read_b128 v[124:127], v11 offset:13312
    v_mfma_f32_16x16x32_bf16 v[196:199], v[128:131], a[180:183], v[196:199]
    buffer_load_dwordx4 a[244:247], v5, s[40:43], s20 offen offset:2048 sc1
    v_mfma_f32_16x16x32_bf16 v[196:199], v[132:135], a[188:191], v[196:199]
    ds_read_b128 v[128:131], v11 offset:21504
    ds_read_b128 v[132:135], v11 offset:29696
    v_mfma_f32_16x16x32_bf16 v[200:203], v[136:139], a[160:163], v[200:203]
    v_mfma_f32_16x16x32_bf16 v[200:203], v[140:143], a[168:171], v[200:203]
    v_mfma_f32_16x16x32_bf16 v[200:203], v[144:147], a[176:179], v[200:203]
    buffer_load_dwordx4 a[252:255], v5, s[40:43], s20 offen offset:3072 sc1
    v_mfma_f32_16x16x32_bf16 v[200:203], v[148:151], a[184:187], v[200:203]
    s_mul_i32 s21, s61, 6
    s_add_u32 s21, s4, s21
    v_mfma_f32_16x16x32_bf16 v[204:207], v[136:139], a[164:167], v[204:207]
    s_add_u32 s21, s21, 128
    ds_read_b128 v[136:139], v11 offset:6144
    v_mfma_f32_16x16x32_bf16 v[204:207], v[140:143], a[172:175], v[204:207]
    s_mul_i32 s21, s21, 36864
    ds_read_b128 v[140:143], v11 offset:14336
    v_mfma_f32_16x16x32_bf16 v[204:207], v[144:147], a[180:183], v[204:207]
    s_add_u32 s21, s21, s28
    s_mov_b32 m0, s47
    ds_read_b128 v[144:147], v11 offset:22528
    v_mfma_f32_16x16x32_bf16 v[204:207], v[148:151], a[188:191], v[204:207]
    s_add_u32 s20, s20, 4096
    buffer_load_dwordx4 v1, s[56:59], s21 offen sc1 lds
    s_waitcnt lgkmcnt(3)
    v_mfma_f32_16x16x32_bf16 v[208:211], v[104:107], a[160:163], v[208:211]
    ds_read_b128 v[148:151], v11 offset:30720
    v_mfma_f32_16x16x32_bf16 v[208:211], v[108:111], a[168:171], v[208:211]
    v_mfma_f32_16x16x32_bf16 v[208:211], v[112:115], a[176:179], v[208:211]
    buffer_load_dwordx4 v1, s[56:59], s21 offen offset:1024 sc1 lds
    v_mfma_f32_16x16x32_bf16 v[208:211], v[116:119], a[184:187], v[208:211]
    v_mfma_f32_16x16x32_bf16 v[212:215], v[104:107], a[164:167], v[212:215]
    v_mfma_f32_16x16x32_bf16 v[212:215], v[108:111], a[172:175], v[212:215]
    v_mfma_f32_16x16x32_bf16 v[212:215], v[112:115], a[180:183], v[212:215]
    v_mfma_f32_16x16x32_bf16 v[212:215], v[116:119], a[188:191], v[212:215]
    buffer_load_dwordx4 v1, s[56:59], s21 offen offset:2048 sc1 lds
    v_mfma_f32_16x16x32_bf16 v[216:219], v[120:123], a[160:163], v[216:219]
    v_mfma_f32_16x16x32_bf16 v[216:219], v[124:127], a[168:171], v[216:219]
    v_mfma_f32_16x16x32_bf16 v[216:219], v[128:131], a[176:179], v[216:219]
    v_mfma_f32_16x16x32_bf16 v[216:219], v[132:135], a[184:187], v[216:219]
    buffer_load_dwordx4 v1, s[56:59], s21 offen offset:3072 sc1 lds
    s_waitcnt vmcnt(17)
    v_cmp_gt_u32 vcc, 3, v3
    s_nop 1
    s_and_b64 vcc, vcc, exec
    s_cbranch_scc1 SPIN_OA
BACK_OA:
    s_barrier
    v_mfma_f32_16x16x32_bf16 v[220:223], v[120:123], a[164:167], v[220:223]
    s_add_u32 s21, s21, 4096
    ds_read_b128 v[104:107], v12 offset:0
    ds_read_b128 v[108:111], v12 offset:8192
    v_mfma_f32_16x16x32_bf16 v[220:223], v[124:127], a[172:175], v[220:223]
    s_add_u32 m0, s47, 4096
    ds_read_b128 v[112:115], v12 offset:16384
    v_mfma_f32_16x16x32_bf16 v[220:223], v[128:131], a[180:183], v[220:223]
    ds_read_b128 v[116:119], v12 offset:24576
    v_mfma_f32_16x16x32_bf16 v[220:223], v[132:135], a[188:191], v[220:223]
    s_waitcnt lgkmcnt(4)
    buffer_load_dwordx4 v1, s[56:59], s21 offen sc1 lds
    v_mfma_f32_16x16x32_bf16 v[224:227], v[136:139], a[160:163], v[224:227]
    ds_read_b128 v[120:123], v12 offset:1024
    ds_read_b128 v[124:127], v12 offset:9216
    v_mfma_f32_16x16x32_bf16 v[224:227], v[140:143], a[168:171], v[224:227]
    ds_read_b128 v[128:131], v12 offset:17408
    v_mfma_f32_16x16x32_bf16 v[224:227], v[144:147], a[176:179], v[224:227]
    ds_read_b128 v[132:135], v12 offset:25600
    v_mfma_f32_16x16x32_bf16 v[224:227], v[148:151], a[184:187], v[224:227]
    buffer_load_dwordx4 v1, s[56:59], s21 offen offset:1024 sc1 lds
    v_mfma_f32_16x16x32_bf16 v[228:231], v[136:139], a[164:167], v[228:231]
    ds_read_b128 v[136:139], v12 offset:2048
    v_mfma_f32_16x16x32_bf16 v[228:231], v[140:143], a[172:175], v[228:231]
    ds_read_b128 v[140:143], v12 offset:10240
    v_mfma_f32_16x16x32_bf16 v[228:231], v[144:147], a[180:183], v[228:231]
    ds_read_b128 v[144:147], v12 offset:18432
    v_mfma_f32_16x16x32_bf16 v[228:231], v[148:151], a[188:191], v[228:231]
    s_waitcnt lgkmcnt(3)
    buffer_load_dwordx4 v1, s[56:59], s21 offen offset:2048 sc1 lds
    v_mfma_f32_16x16x32_bf16 v[176:179], v[104:107], a[192:195], v[176:179]
    ds_read_b128 v[148:151], v12 offset:26624
    v_mfma_f32_16x16x32_bf16 v[176:179], v[108:111], a[200:203], v[176:179]
    s_mul_i32 s63, s61, 6144
    v_mfma_f32_16x16x32_bf16 v[176:179], v[112:115], a[208:211], v[176:179]
    s_add_u32 s63, s63, 131072
    v_mfma_f32_16x16x32_bf16 v[176:179], v[116:119], a[216:219], v[176:179]
    v_mfma_f32_16x16x32_bf16 v[180:183], v[104:107], a[196:199], v[180:183]
    buffer_load_dwordx4 v[32:35], v4, s[40:43], s63 offen offset:0 sc1
    v_mfma_f32_16x16x32_bf16 v[180:183], v[108:111], a[204:207], v[180:183]
    ds_read_b128 v[104:107], v12 offset:3072
    ds_read_b128 v[108:111], v12 offset:11264
    v_mfma_f32_16x16x32_bf16 v[180:183], v[112:115], a[212:215], v[180:183]
    ds_read_b128 v[112:115], v12 offset:19456
    v_mfma_f32_16x16x32_bf16 v[180:183], v[116:119], a[220:223], v[180:183]
    ds_read_b128 v[116:119], v12 offset:27648
    v_mfma_f32_16x16x32_bf16 v[184:187], v[120:123], a[192:195], v[184:187]
    buffer_load_dwordx4 v[40:43], v4, s[40:43], s63 offen offset:1024 sc1
    v_mfma_f32_16x16x32_bf16 v[184:187], v[124:127], a[200:203], v[184:187]
    v_mfma_f32_16x16x32_bf16 v[184:187], v[128:131], a[208:211], v[184:187]
    v_mfma_f32_16x16x32_bf16 v[184:187], v[132:135], a[216:219], v[184:187]
    v_mfma_f32_16x16x32_bf16 v[188:191], v[120:123], a[196:199], v[188:191]
    buffer_load_dwordx4 v[48:51], v4, s[40:43], s63 offen offset:2048 sc1
    v_mfma_f32_16x16x32_bf16 v[188:191], v[124:127], a[204:207], v[188:191]
    ds_read_b128 v[120:123], v12 offset:4096
    ds_read_b128 v[124:127], v12 offset:12288
    v_mfma_f32_16x16x32_bf16 v[188:191], v[128:131], a[212:215], v[188:191]
    ds_read_b128 v[128:131], v12 offset:20480
    v_mfma_f32_16x16x32_bf16 v[188:191], v[132:135], a[220:223], v[188:191]
    s_waitcnt lgkmcnt(3)
    ds_read_b128 v[132:135], v12 offset:28672
    v_mfma_f32_16x16x32_bf16 v[192:195], v[136:139], a[192:195], v[192:195]
    buffer_load_dwordx4 v[56:59], v4, s[40:43], s63 offen offset:3072 sc1
    v_mfma_f32_16x16x32_bf16 v[192:195], v[140:143], a[200:203], v[192:195]
    s_mul_i32 s20, s61, 6144
    v_mfma_f32_16x16x32_bf16 v[192:195], v[144:147], a[208:211], v[192:195]
    s_add_u32 s20, s20, 131072
    v_mfma_f32_16x16x32_bf16 v[192:195], v[148:151], a[216:219], v[192:195]
    s_add_u32 s63, s63, 4096
    v_mfma_f32_16x16x32_bf16 v[196:199], v[136:139], a[196:199], v[196:199]
    buffer_load_dwordx4 v[36:39], v5, s[40:43], s20 offen offset:0 sc1
    v_mfma_f32_16x16x32_bf16 v[196:199], v[140:143], a[204:207], v[196:199]
    ds_read_b128 v[136:139], v12 offset:5120
    ds_read_b128 v[140:143], v12 offset:13312
    v_mfma_f32_16x16x32_bf16 v[196:199], v[144:147], a[212:215], v[196:199]
    ds_read_b128 v[144:147], v12 offset:21504
    v_mfma_f32_16x16x32_bf16 v[196:199], v[148:151], a[220:223], v[196:199]
    ds_read_b128 v[148:151], v12 offset:29696
    v_mfma_f32_16x16x32_bf16 v[200:203], v[104:107], a[192:195], v[200:203]
    v_mfma_f32_16x16x32_bf16 v[200:203], v[108:111], a[200:203], v[200:203]
    buffer_load_dwordx4 v[44:47], v5, s[40:43], s20 offen offset:1024 sc1
    v_mfma_f32_16x16x32_bf16 v[200:203], v[112:115], a[208:211], v[200:203]
    v_mfma_f32_16x16x32_bf16 v[200:203], v[116:119], a[216:219], v[200:203]
    v_mfma_f32_16x16x32_bf16 v[204:207], v[104:107], a[196:199], v[204:207]
    ds_read_b128 v[104:107], v12 offset:6144
    v_mfma_f32_16x16x32_bf16 v[204:207], v[108:111], a[204:207], v[204:207]
    buffer_load_dwordx4 v[52:55], v5, s[40:43], s20 offen offset:2048 sc1
    v_mfma_f32_16x16x32_bf16 v[204:207], v[112:115], a[212:215], v[204:207]
    ds_read_b128 v[108:111], v12 offset:14336
    ds_read_b128 v[112:115], v12 offset:22528
    v_mfma_f32_16x16x32_bf16 v[204:207], v[116:119], a[220:223], v[204:207]
    s_waitcnt lgkmcnt(3)
    ds_read_b128 v[116:119], v12 offset:30720
    v_mfma_f32_16x16x32_bf16 v[208:211], v[120:123], a[192:195], v[208:211]
    v_mfma_f32_16x16x32_bf16 v[208:211], v[124:127], a[200:203], v[208:211]
    buffer_load_dwordx4 v[60:63], v5, s[40:43], s20 offen offset:3072 sc1
    v_mfma_f32_16x16x32_bf16 v[208:211], v[128:131], a[208:211], v[208:211]
    s_mul_i32 s21, s61, 6
    s_lshr_b32 s64, s4, 1
    s_add_u32 s21, s21, s64
    v_mfma_f32_16x16x32_bf16 v[208:211], v[132:135], a[216:219], v[208:211]
    s_add_u32 s21, s21, 132
    s_mul_i32 s21, s21, 36864
    v_mfma_f32_16x16x32_bf16 v[212:215], v[120:123], a[196:199], v[212:215]
    s_add_u32 s21, s21, s28
    s_and_b32 s64, s69, 4096
    v_mfma_f32_16x16x32_bf16 v[212:215], v[124:127], a[204:207], v[212:215]
    s_add_u32 s21, s21, s64
    s_mov_b32 m0, s79
    v_mfma_f32_16x16x32_bf16 v[212:215], v[128:131], a[212:215], v[212:215]
    s_add_u32 s20, s20, 4096
    buffer_load_dwordx4 v1, s[56:59], s21 offen sc1 lds
    v_mfma_f32_16x16x32_bf16 v[212:215], v[132:135], a[220:223], v[212:215]
    v_mfma_f32_16x16x32_bf16 v[216:219], v[136:139], a[192:195], v[216:219]
    v_mfma_f32_16x16x32_bf16 v[216:219], v[140:143], a[200:203], v[216:219]
    buffer_load_dwordx4 v1, s[56:59], s21 offen offset:1024 sc1 lds
    v_mfma_f32_16x16x32_bf16 v[216:219], v[144:147], a[208:211], v[216:219]
    v_mfma_f32_16x16x32_bf16 v[216:219], v[148:151], a[216:219], v[216:219]
    s_waitcnt vmcnt(17)
    s_barrier
    ds_read_b128 v[120:123], v13 offset:0
    v_mfma_f32_16x16x32_bf16 v[220:223], v[136:139], a[196:199], v[220:223]
    ds_read_b128 v[124:127], v13 offset:8192
    ds_read_b128 v[128:131], v13 offset:16384
    v_mfma_f32_16x16x32_bf16 v[220:223], v[140:143], a[204:207], v[220:223]
    ds_read_b128 v[132:135], v13 offset:24576
    v_mfma_f32_16x16x32_bf16 v[220:223], v[144:147], a[212:215], v[220:223]
    buffer_load_dwordx4 v1, s[56:59], s21 offen offset:2048 sc1 lds
    v_mfma_f32_16x16x32_bf16 v[220:223], v[148:151], a[220:223], v[220:223]
    s_waitcnt lgkmcnt(4)
    ds_read_b128 v[136:139], v13 offset:1024
    ds_read_b128 v[140:143], v13 offset:9216
    v_mfma_f32_16x16x32_bf16 v[224:227], v[104:107], a[192:195], v[224:227]
    ds_read_b128 v[144:147], v13 offset:17408
    v_mfma_f32_16x16x32_bf16 v[224:227], v[108:111], a[200:203], v[224:227]
    ds_read_b128 v[148:151], v13 offset:25600
    v_mfma_f32_16x16x32_bf16 v[224:227], v[112:115], a[208:211], v[224:227]
    buffer_load_dwordx4 v1, s[56:59], s21 offen offset:3072 sc1 lds
    v_mfma_f32_16x16x32_bf16 v[224:227], v[116:119], a[216:219], v[224:227]
    v_mfma_f32_16x16x32_bf16 v[228:231], v[104:107], a[196:199], v[228:231]
    ds_read_b128 v[104:107], v13 offset:2048
    v_mfma_f32_16x16x32_bf16 v[228:231], v[108:111], a[204:207], v[228:231]
    ds_read_b128 v[108:111], v13 offset:10240
    v_mfma_f32_16x16x32_bf16 v[228:231], v[112:115], a[212:215], v[228:231]
    buffer_load_dwordx4 v[64:67], v4, s[40:43], s63 offen offset:0 sc1
    v_mfma_f32_16x16x32_bf16 v[228:231], v[116:119], a[220:223], v[228:231]
    s_waitcnt lgkmcnt(2)
    ds_read_b128 v[112:115], v13 offset:18432
    ds_read_b128 v[116:119], v13 offset:26624
    v_mfma_f32_16x16x32_bf16 v[176:179], v[120:123], a[224:227], v[176:179]
    s_add_u32 s23, s5, 8
    v_lshrrev_b32 v19, 4, v1
    v_min_u32 v19, 2, v19
    v_mfma_f32_16x16x32_bf16 v[176:179], v[124:127], a[232:235], v[176:179]
    s_and_b32 s65, s5, 3
    v_lshl_add_u32 v19, v19, 3, s23
    v_bfe_u32 v20, v1, 4, 4
    v_mfma_f32_16x16x32_bf16 v[176:179], v[128:131], a[240:243], v[176:179]
    s_lshl3_add_u32 s23, s6, s62
    buffer_load_dwordx4 v[72:75], v4, s[40:43], s63 offen offset:1024 sc1
    v_mfma_f32_16x16x32_bf16 v[176:179], v[132:135], a[248:251], v[176:179]
    s_add_u32 s63, s63, 4096
    v_lshrrev_b32 v21, 8, v1
    v_and_b32 v19, 31, v19
    v_mfma_f32_16x16x32_bf16 v[180:183], v[120:123], a[228:231], v[180:183]
    s_lshl_b32 s23, s23, 4
    ds_read_b128 v[120:123], v13 offset:3072
    v_add_u32 v20, s23, v20
    v_mfma_f32_16x16x32_bf16 v[180:183], v[124:127], a[236:239], v[180:183]
    s_mul_i32 s23, s6, 294912
    ds_read_b128 v[124:127], v13 offset:11264
    v_mul_u32_u24 v20, 1152, v20
    v_mfma_f32_16x16x32_bf16 v[180:183], v[128:131], a[244:247], v[180:183]
    s_sub_u32 s23, 2211840, s23
    buffer_load_dwordx4 v[68:71], v5, s[40:43], s20 offen offset:0 sc1
    v_mfma_f32_16x16x32_bf16 v[180:183], v[132:135], a[252:255], v[180:183]
    s_mul_i32 s70, s4, 3072
    ds_read_b128 v[128:131], v13 offset:19456
    ds_read_b128 v[132:135], v13 offset:27648
    v_mfma_f32_16x16x32_bf16 v[184:187], v[136:139], a[224:227], v[184:187]
    s_andn2_b32 s66, s74, 0xfff
    v_lshl_add_u32 v20, v21, 3, v20
    v_add_u32 v21, s23, v20
    v_mfma_f32_16x16x32_bf16 v[184:187], v[140:143], a[232:235], v[184:187]
    s_mul_i32 s23, s101, 288
    v_mov_b32 v31, 3
    v_lshlrev_b32 v23, 20, v1
    v_mfma_f32_16x16x32_bf16 v[184:187], v[144:147], a[240:243], v[184:187]
    s_add_u32 s23, s23, s70
    v_lshlrev_b32 v19, 7, v19
    v_mfma_f32_16x16x32_bf16 v[184:187], v[148:151], a[248:251], v[184:187]
    buffer_load_dwordx4 v[76:79], v5, s[40:43], s20 offen offset:1024 sc1
    v_mfma_f32_16x16x32_bf16 v[188:191], v[136:139], a[228:231], v[188:191]
    s_add_u32 s21, s4, 0
    s_xor_b32 s21, s21, s3
    s_lshl_b32 s21, s21, 2
    v_mfma_f32_16x16x32_bf16 v[188:191], v[140:143], a[236:239], v[188:191]
    s_mul_i32 s21, s21, 36864
    ds_read_b128 v[136:139], v13 offset:4096
    ds_read_b128 v[140:143], v13 offset:12288
    v_mfma_f32_16x16x32_bf16 v[188:191], v[144:147], a[244:247], v[188:191]
    s_add_u32 s21, s21, s28
    ds_read_b128 v[144:147], v13 offset:20480
    v_mfma_f32_16x16x32_bf16 v[188:191], v[148:151], a[252:255], v[188:191]
    s_add_u32 s21, s21, 7168
    s_add_u32 m0, s44, 0
    ds_read_b128 v[148:151], v13 offset:28672
    s_waitcnt lgkmcnt(4)
    v_mfma_f32_16x16x32_bf16 v[192:195], v[104:107], a[224:227], v[192:195]
    s_add_u32 s20, s20, 4096
    buffer_load_dwordx4 v1, s[56:59], s21 offen sc1 lds
    v_mfma_f32_16x16x32_bf16 v[192:195], v[108:111], a[232:235], v[192:195]
    v_mfma_f32_16x16x32_bf16 v[192:195], v[112:115], a[240:243], v[192:195]
    v_mfma_f32_16x16x32_bf16 v[192:195], v[116:119], a[248:251], v[192:195]
    buffer_load_dwordx4 v1, s[56:59], s21 offen offset:1024 sc1 lds
    v_mfma_f32_16x16x32_bf16 v[196:199], v[104:107], a[228:231], v[196:199]
    s_add_u32 s21, s21, 36864
    ds_read_b128 v[104:107], v13 offset:5120
    v_mfma_f32_16x16x32_bf16 v[196:199], v[108:111], a[236:239], v[196:199]
    s_add_u32 m0, s44, 2048
    ds_read_b128 v[108:111], v13 offset:13312
    v_mfma_f32_16x16x32_bf16 v[196:199], v[112:115], a[244:247], v[196:199]
    ds_read_b128 v[112:115], v13 offset:21504
    v_mfma_f32_16x16x32_bf16 v[196:199], v[116:119], a[252:255], v[196:199]
    buffer_load_dwordx4 v1, s[56:59], s21 offen sc1 lds
    v_mfma_f32_16x16x32_bf16 v[200:203], v[120:123], a[224:227], v[200:203]
    ds_read_b128 v[116:119], v13 offset:29696
    v_mfma_f32_16x16x32_bf16 v[200:203], v[124:127], a[232:235], v[200:203]
    v_mfma_f32_16x16x32_bf16 v[200:203], v[128:131], a[240:243], v[200:203]
    v_mfma_f32_16x16x32_bf16 v[200:203], v[132:135], a[248:251], v[200:203]
    buffer_load_dwordx4 v1, s[56:59], s21 offen offset:1024 sc1 lds
    v_mfma_f32_16x16x32_bf16 v[204:207], v[120:123], a[228:231], v[204:207]
    ds_read_b128 v[120:123], v13 offset:6144
    v_mfma_f32_16x16x32_bf16 v[204:207], v[124:127], a[236:239], v[204:207]
    s_add_u32 s21, s21, 36864
    ds_read_b128 v[124:127], v13 offset:14336
    v_mfma_f32_16x16x32_bf16 v[204:207], v[128:131], a[244:247], v[204:207]
    s_add_u32 m0, s44, 4096
    ds_read_b128 v[128:131], v13 offset:22528
    v_mfma_f32_16x16x32_bf16 v[204:207], v[132:135], a[252:255], v[204:207]
    s_waitcnt lgkmcnt(3)
    ds_read_b128 v[132:135], v13 offset:30720
    v_mfma_f32_16x16x32_bf16 v[208:211], v[136:139], a[224:227], v[208:211]
    buffer_load_dwordx4 v1, s[56:59], s21 offen sc1 lds
    v_mfma_f32_16x16x32_bf16 v[208:211], v[140:143], a[232:235], v[208:211]
    v_mfma_f32_16x16x32_bf16 v[208:211], v[144:147], a[240:243], v[208:211]
    v_mfma_f32_16x16x32_bf16 v[208:211], v[148:151], a[248:251], v[208:211]
    v_mfma_f32_16x16x32_bf16 v[212:215], v[136:139], a[228:231], v[212:215]
    buffer_load_dwordx4 v1, s[56:59], s21 offen offset:1024 sc1 lds
    v_mfma_f32_16x16x32_bf16 v[212:215], v[140:143], a[236:239], v[212:215]
    s_add_u32 s21, s21, 36864
    v_mfma_f32_16x16x32_bf16 v[212:215], v[144:147], a[244:247], v[212:215]
    s_add_u32 m0, s44, 6144
    v_mfma_f32_16x16x32_bf16 v[212:215], v[148:151], a[252:255], v[212:215]
    v_mfma_f32_16x16x32_bf16 v[216:219], v[104:107], a[224:227], v[216:219]
    buffer_load_dwordx4 v1, s[56:59], s21 offen sc1 lds
    v_mfma_f32_16x16x32_bf16 v[216:219], v[108:111], a[232:235], v[216:219]
    v_mfma_f32_16x16x32_bf16 v[216:219], v[112:115], a[240:243], v[216:219]
    v_mfma_f32_16x16x32_bf16 v[216:219], v[116:119], a[248:251], v[216:219]
    s_waitcnt vmcnt(15)
    s_barrier
    ds_read_b128 v[136:139], v6 offset:0
    v_mfma_f32_16x16x32_bf16 v[220:223], v[104:107], a[228:231], v[220:223]
    buffer_load_dwordx4 v1, s[56:59], s21 offen offset:1024 sc1 lds
    v_mfma_f32_16x16x32_bf16 v[220:223], v[108:111], a[236:239], v[220:223]
    s_add_u32 s21, s21, 36864
    s_add_u32 s21, s4, 4
    s_xor_b32 s21, s21, s3
    v_mfma_f32_16x16x32_bf16 v[220:223], v[112:115], a[244:247], v[220:223]
    s_lshl_b32 s21, s21, 2
    s_mul_i32 s21, s21, 36864
    ds_read_b128 v[140:143], v6 offset:8192
    v_mfma_f32_16x16x32_bf16 v[220:223], v[116:119], a[252:255], v[220:223]
    s_add_u32 s21, s21, s28
    ds_read_b128 v[144:147], v6 offset:1024
    ds_read_b128 v[148:151], v6 offset:9216
    s_waitcnt lgkmcnt(4)
    v_mfma_f32_16x16x32_bf16 v[224:227], v[120:123], a[224:227], v[224:227]
    s_add_u32 s21, s21, 7168
    s_add_u32 m0, s45, 0
    ds_read_b128 v[104:107], v6 offset:2048
    v_mfma_f32_16x16x32_bf16 v[224:227], v[124:127], a[232:235], v[224:227]
    buffer_load_dwordx4 v1, s[56:59], s21 offen sc1 lds
    v_mfma_f32_16x16x32_bf16 v[224:227], v[128:131], a[240:243], v[224:227]
    ds_read_b128 v[108:111], v6 offset:10240
    ds_read_b128 v[112:115], v6 offset:3072
    v_mfma_f32_16x16x32_bf16 v[224:227], v[132:135], a[248:251], v[224:227]
    ds_read_b128 v[116:119], v6 offset:11264
    v_mfma_f32_16x16x32_bf16 v[228:231], v[120:123], a[228:231], v[228:231]
    ds_read_b128 v[120:123], v6 offset:4096
    v_mfma_f32_16x16x32_bf16 v[228:231], v[124:127], a[236:239], v[228:231]
    buffer_load_dwordx4 v1, s[56:59], s21 offen offset:1024 sc1 lds
    v_mfma_f32_16x16x32_bf16 v[228:231], v[128:131], a[244:247], v[228:231]
    s_add_u32 s21, s21, 36864
    ds_read_b128 v[124:127], v6 offset:12288
    ds_read_b128 v[128:131], v6 offset:5120
    v_mfma_f32_16x16x32_bf16 v[228:231], v[132:135], a[252:255], v[228:231]
    s_add_u32 m0, s45, 2048
    ds_read_b128 v[132:135], v6 offset:13312
    s_waitcnt lgkmcnt(5)
    v_mfma_f32_16x16x32_bf16 v[176:179], v[136:139], v[32:35], v[176:179]
    v_mfma_f32_16x16x32_bf16 v[176:179], v[140:143], v[40:43], v[176:179]
    buffer_load_dwordx4 v1, s[56:59], s21 offen sc1 lds
    v_mfma_f32_16x16x32_bf16 v[180:183], v[136:139], v[36:39], v[180:183]
    ds_read_b128 v[136:139], v6 offset:6144
    v_mfma_f32_16x16x32_bf16 v[180:183], v[140:143], v[44:47], v[180:183]
    ds_read_b128 v[140:143], v6 offset:14336
    v_mfma_f32_16x16x32_bf16 v[184:187], v[144:147], v[32:35], v[184:187]
    v_mfma_f32_16x16x32_bf16 v[184:187], v[148:151], v[40:43], v[184:187]
    buffer_load_dwordx4 v1, s[56:59], s21 offen offset:1024 sc1 lds
    v_mfma_f32_16x16x32_bf16 v[188:191], v[144:147], v[36:39], v[188:191]
    s_add_u32 s21, s21, 36864
    ds_read_b128 v[144:147], v6 offset:16384
    v_mfma_f32_16x16x32_bf16 v[188:191], v[148:151], v[44:47], v[188:191]
    s_add_u32 m0, s45, 4096
    ds_read_b128 v[148:151], v6 offset:24576
    v_mfma_f32_16x16x32_bf16 v[192:195], v[104:107], v[32:35], v[192:195]
    v_mfma_f32_16x16x32_bf16 v[192:195], v[108:111], v[40:43], v[192:195]
    buffer_load_dwordx4 v1, s[56:59], s21 offen sc1 lds
    v_mfma_f32_16x16x32_bf16 v[196:199], v[104:107], v[36:39], v[196:199]
    v_mfma_f32_16x16x32_bf16 v[196:199], v[108:111], v[44:47], v[196:199]
    v_mfma_f32_16x16x32_bf16 v[200:203], v[112:115], v[32:35], v[200:203]
    s_waitcnt lgkmcnt(0)
    v_mfma_f32_16x16x32_bf16 v[200:203], v[116:119], v[40:43], v[200:203]
    buffer_load_dwordx4 v1, s[56:59], s21 offen offset:1024 sc1 lds
    v_mfma_f32_16x16x32_bf16 v[204:207], v[112:115], v[36:39], v[204:207]
    ds_read_b128 v[112:115], v6 offset:17408
    v_mfma_f32_16x16x32_bf16 v[204:207], v[116:119], v[44:47], v[204:207]
    s_waitcnt vmcnt(14)
    s_barrier
    ds_read_b128 v[104:107], v7 offset:0
    v_mfma_f32_16x16x32_bf16 v[208:211], v[120:123], v[32:35], v[208:211]
    s_add_u32 s21, s21, 36864
    ds_read_b128 v[108:111], v7 offset:16384
    ds_read_b128 v[116:119], v6 offset:25600
    v_mfma_f32_16x16x32_bf16 v[208:211], v[124:127], v[40:43], v[208:211]
    s_add_u32 m0, s45, 6144
    v_mfma_f32_16x16x32_bf16 v[212:215], v[120:123], v[36:39], v[212:215]
    buffer_load_dwordx4 v1, s[56:59], s21 offen sc1 lds
    v_mfma_f32_16x16x32_bf16 v[212:215], v[124:127], v[44:47], v[212:215]
    ds_read_b128 v[120:123], v7 offset:1024
    ds_read_b128 v[124:127], v7 offset:17408
    v_mfma_f32_16x16x32_bf16 v[216:219], v[128:131], v[32:35], v[216:219]
    v_mfma_f32_16x16x32_bf16 v[216:219], v[132:135], v[40:43], v[216:219]
    v_mfma_f32_16x16x32_bf16 v[220:223], v[128:131], v[36:39], v[220:223]
    buffer_load_dwordx4 v1, s[56:59], s21 offen offset:1024 sc1 lds
    v_mfma_f32_16x16x32_bf16 v[220:223], v[132:135], v[44:47], v[220:223]
    s_add_u32 s21, s21, 36864
    ds_read_b128 v[128:131], v6 offset:18432
    ds_read_b128 v[132:135], v6 offset:26624
    v_mfma_f32_16x16x32_bf16 v[224:227], v[136:139], v[32:35], v[224:227]
    v_mfma_f32_16x16x32_bf16 v[224:227], v[140:143], v[40:43], v[224:227]
    v_mfma_f32_16x16x32_bf16 v[228:231], v[136:139], v[36:39], v[228:231]
    ds_read_b128 v[136:139], v7 offset:2048
    v_mfma_f32_16x16x32_bf16 v[228:231], v[140:143], v[44:47], v[228:231]
    ds_read_b128 v[140:143], v7 offset:18432
    v_mfma_f32_16x16x32_bf16 v[176:179], v[144:147], v[48:51], v[176:179]
    v_mfma_f32_16x16x32_bf16 v[176:179], v[148:151], v[56:59], v[176:179]
    s_waitcnt lgkmcnt(2)
    v_mfma_f32_16x16x32_bf16 v[176:179], v[104:107], v[64:67], v[176:179]
    v_mfma_f32_16x16x32_bf16 v[176:179], v[108:111], v[72:75], v[176:179]
    v_mfma_f32_16x16x32_bf16 v[180:183], v[144:147], v[52:55], v[180:183]
    ds_read_b128 v[144:147], v6 offset:19456
    v_mfma_f32_16x16x32_bf16 v[180:183], v[148:151], v[60:63], v[180:183]
    ds_read_b128 v[148:151], v6 offset:27648
    v_mfma_f32_16x16x32_bf16 v[180:183], v[104:107], v[68:71], v[180:183]
    ds_read_b128 v[104:107], v7 offset:3072
    v_mfma_f32_16x16x32_bf16 v[180:183], v[108:111], v[76:79], v[180:183]
    ds_read_b128 v[108:111], v7 offset:19456
    v_cvt_pk_bf16_f32 v232, v176, v177
    v_mfma_f32_16x16x32_bf16 v[184:187], v[112:115], v[48:51], v[184:187]
    v_cvt_pk_bf16_f32 v233, v178, v179
    v_mfma_f32_16x16x32_bf16 v[184:187], v[116:119], v[56:59], v[184:187]
    v_mfma_f32_16x16x32_bf16 v[184:187], v[120:123], v[64:67], v[184:187]
    v_mfma_f32_16x16x32_bf16 v[184:187], v[124:127], v[72:75], v[184:187]
    v_mfma_f32_16x16x32_bf16 v[188:191], v[112:115], v[52:55], v[188:191]
    v_cvt_pk_bf16_f32 v234, v180, v181
    v_cvt_pk_bf16_f32 v235, v182, v183
    v_mfma_f32_16x16x32_bf16 v[188:191], v[116:119], v[60:63], v[188:191]
    buffer_store_dwordx4 v[232:235], v1, s[48:51], s8 offen offset:0 sc1
    v_mfma_f32_16x16x32_bf16 v[188:191], v[120:123], v[68:71], v[188:191]
    ds_read_b128 v[112:115], v6 offset:20480
    ds_read_b128 v[116:119], v6 offset:28672
    v_mfma_f32_16x16x32_bf16 v[188:191], v[124:127], v[76:79], v[188:191]
    v_cvt_pk_bf16_f32 v236, v184, v185
    v_cvt_pk_bf16_f32 v237, v186, v187
    v_mfma_f32_16x16x32_bf16 v[192:195], v[128:131], v[48:51], v[192:195]
    ds_read_b128 v[120:123], v7 offset:8192
    ds_read_b128 v[124:127], v7 offset:24576
    v_mfma_f32_16x16x32_bf16 v[192:195], v[132:135], v[56:59], v[192:195]
    s_waitcnt lgkmcnt(4)
    v_mfma_f32_16x16x32_bf16 v[192:195], v[136:139], v[64:67], v[192:195]
    v_mfma_f32_16x16x32_bf16 v[192:195], v[140:143], v[72:75], v[192:195]
    v_cvt_pk_bf16_f32 v238, v188, v189
    v_cvt_pk_bf16_f32 v239, v190, v191
    v_mfma_f32_16x16x32_bf16 v[196:199], v[128:131], v[52:55], v[196:199]
    buffer_store_dwordx4 v[236:239], v1, s[48:51], s8 offen offset:1024 sc1
    v_mfma_f32_16x16x32_bf16 v[196:199], v[132:135], v[60:63], v[196:199]
    ds_read_b128 v[128:131], v6 offset:21504
    ds_read_b128 v[132:135], v6 offset:29696
    v_mfma_f32_16x16x32_bf16 v[196:199], v[136:139], v[68:71], v[196:199]
    v_cvt_pk_bf16_f32 v240, v192, v193
    v_cvt_pk_bf16_f32 v241, v194, v195
    v_mfma_f32_16x16x32_bf16 v[196:199], v[140:143], v[76:79], v[196:199]
    ds_read_b128 v[136:139], v7 offset:9216
    ds_read_b128 v[140:143], v7 offset:25600
    v_mfma_f32_16x16x32_bf16 v[200:203], v[144:147], v[48:51], v[200:203]
    v_mfma_f32_16x16x32_bf16 v[200:203], v[148:151], v[56:59], v[200:203]
    v_mfma_f32_16x16x32_bf16 v[200:203], v[104:107], v[64:67], v[200:203]
    v_mfma_f32_16x16x32_bf16 v[200:203], v[108:111], v[72:75], v[200:203]
    v_mfma_f32_16x16x32_bf16 v[204:207], v[144:147], v[52:55], v[204:207]
    ds_read_b128 v[144:147], v6 offset:22528
    v_cvt_pk_bf16_f32 v242, v196, v197
    v_mfma_f32_16x16x32_bf16 v[204:207], v[148:151], v[60:63], v[204:207]
    v_cvt_pk_bf16_f32 v243, v198, v199
    ds_read_b128 v[148:151], v6 offset:30720
    v_mfma_f32_16x16x32_bf16 v[204:207], v[104:107], v[68:71], v[204:207]
    buffer_store_dwordx4 v[240:243], v1, s[48:51], s9 offen offset:0 sc1
    v_mfma_f32_16x16x32_bf16 v[204:207], v[108:111], v[76:79], v[204:207]
    s_waitcnt lgkmcnt(2)
    v_cvt_pk_bf16_f32 v244, v200, v201
    v_cvt_pk_bf16_f32 v245, v202, v203
    v_mfma_f32_16x16x32_bf16 v[208:211], v[112:115], v[48:51], v[208:211]
    ds_read_b128 v[104:107], v7 offset:10240
    ds_read_b128 v[108:111], v7 offset:26624
    v_mfma_f32_16x16x32_bf16 v[208:211], v[116:119], v[56:59], v[208:211]
    v_mfma_f32_16x16x32_bf16 v[208:211], v[120:123], v[64:67], v[208:211]
    v_mfma_f32_16x16x32_bf16 v[208:211], v[124:127], v[72:75], v[208:211]
    v_cvt_pk_bf16_f32 v246, v204, v205
    v_cvt_pk_bf16_f32 v247, v206, v207
    v_mfma_f32_16x16x32_bf16 v[212:215], v[112:115], v[52:55], v[212:215]
    buffer_store_dwordx4 v[244:247], v1, s[48:51], s9 offen offset:1024 sc1
    v_mfma_f32_16x16x32_bf16 v[212:215], v[116:119], v[60:63], v[212:215]
    v_mfma_f32_16x16x32_bf16 v[212:215], v[120:123], v[68:71], v[212:215]
    v_mfma_f32_16x16x32_bf16 v[212:215], v[124:127], v[76:79], v[212:215]
    v_mfma_f32_16x16x32_bf16 v[216:219], v[128:131], v[48:51], v[216:219]
    v_cvt_pk_bf16_f32 v232, v208, v209
    v_cvt_pk_bf16_f32 v233, v210, v211
    v_mfma_f32_16x16x32_bf16 v[216:219], v[132:135], v[56:59], v[216:219]
    v_mfma_f32_16x16x32_bf16 v[216:219], v[136:139], v[64:67], v[216:219]
    v_mfma_f32_16x16x32_bf16 v[216:219], v[140:143], v[72:75], v[216:219]
    s_waitcnt vmcnt(12)
    s_barrier
    v_cvt_pk_bf16_f32 v234, v212, v213
    v_mfma_f32_16x16x32_bf16 v[220:223], v[128:131], v[52:55], v[220:223]
    v_cvt_pk_bf16_f32 v235, v214, v215
    ds_read_b128 v[112:115], v11 offset:0
    v_mfma_f32_16x16x32_bf16 v[220:223], v[132:135], v[60:63], v[220:223]
    buffer_store_dwordx4 v[232:235], v1, s[48:51], s10 offen offset:0 sc1
    v_mfma_f32_16x16x32_bf16 v[220:223], v[136:139], v[68:71], v[220:223]
    ds_read_b128 v[116:119], v11 offset:2048
    ds_read_b128 v[120:123], v11 offset:4096
    v_mfma_f32_16x16x32_bf16 v[220:223], v[140:143], v[76:79], v[220:223]
    s_waitcnt lgkmcnt(3)
    ds_read_b128 v[124:127], v11 offset:6144
    v_cvt_pk_bf16_f32 v236, v216, v217
    v_mfma_f32_16x16x32_bf16 v[224:227], v[144:147], v[48:51], v[224:227]
    v_cvt_pk_bf16_f32 v237, v218, v219
    ds_read_b128 v[128:131], v11 offset:1024
    v_mfma_f32_16x16x32_bf16 v[224:227], v[148:151], v[56:59], v[224:227]
    ds_read_b128 v[132:135], v11 offset:3072
    v_mfma_f32_16x16x32_bf16 v[224:227], v[104:107], v[64:67], v[224:227]
    v_cvt_pk_bf16_f32 v238, v220, v221
    v_cvt_pk_bf16_f32 v239, v222, v223
    v_mfma_f32_16x16x32_bf16 v[224:227], v[108:111], v[72:75], v[224:227]
    buffer_store_dwordx4 v[236:239], v1, s[48:51], s10 offen offset:1024 sc1
    v_mfma_f32_16x16x32_bf16 v[228:231], v[144:147], v[52:55], v[228:231]
    ds_read_b128 v[136:139], v11 offset:5120
    ds_read_b128 v[140:143], v11 offset:7168
    v_mfma_f32_16x16x32_bf16 v[228:231], v[148:151], v[60:63], v[228:231]
    ds_read_b128 v[144:147], v11 offset:8192
    v_mfma_f32_16x16x32_bf16 v[228:231], v[104:107], v[68:71], v[228:231]
    ds_read_b128 v[148:151], v11 offset:10240
    v_cvt_pk_bf16_f32 v240, v224, v225
    v_mfma_f32_16x16x32_bf16 v[228:231], v[108:111], v[76:79], v[228:231]
    s_waitcnt lgkmcnt(4)
    v_cvt_pk_bf16_f32 v241, v226, v227
    ds_read_b128 v[104:107], v11 offset:12288
    v_mfma_f32_16x16x32_bf16 v[160:163], v[112:115], a[0:3], 0
    ds_read_b128 v[108:111], v11 offset:14336
    v_mfma_f32_16x16x32_bf16 v[160:163], v[116:119], a[8:11], v[160:163]
    v_mfma_f32_16x16x32_bf16 v[160:163], v[120:123], a[16:19], v[160:163]
    v_mfma_f32_16x16x32_bf16 v[160:163], v[124:127], a[24:27], v[160:163]
    v_mfma_f32_16x16x32_bf16 v[164:167], v[112:115], a[4:7], 0
    v_cvt_pk_bf16_f32 v242, v228, v229
    v_cvt_pk_bf16_f32 v243, v230, v231
    v_mfma_f32_16x16x32_bf16 v[164:167], v[116:119], a[12:15], v[164:167]
    buffer_store_dwordx4 v[240:243], v1, s[48:51], s11 offen offset:2048 sc1
    v_mfma_f32_16x16x32_bf16 v[164:167], v[120:123], a[20:23], v[164:167]
    ds_read_b128 v[112:115], v11 offset:9216
    ds_read_b128 v[116:119], v11 offset:11264
    v_mfma_f32_16x16x32_bf16 v[164:167], v[124:127], a[28:31], v[164:167]
    ds_read_b128 v[120:123], v11 offset:13312
    v_mfma_f32_16x16x32_bf16 v[168:171], v[128:131], a[0:3], 0
    ds_read_b128 v[124:127], v11 offset:15360
    v_mfma_f32_16x16x32_bf16 v[168:171], v[132:135], a[8:11], v[168:171]
    s_waitcnt lgkmcnt(4)
    v_mfma_f32_16x16x32_bf16 v[168:171], v[136:139], a[16:19], v[168:171]
    v_mfma_f32_16x16x32_bf16 v[168:171], v[140:143], a[24:27], v[168:171]
    v_mfma_f32_16x16x32_bf16 v[172:175], v[128:131], a[4:7], 0
    ds_read_b128 v[128:131], v11 offset:16384
    v_mfma_f32_16x16x32_bf16 v[172:175], v[132:135], a[12:15], v[172:175]
    ds_read_b128 v[132:135], v11 offset:18432
    v_mfma_f32_16x16x32_bf16 v[172:175], v[136:139], a[20:23], v[172:175]
    ds_read_b128 v[136:139], v11 offset:20480
    v_mfma_f32_16x16x32_bf16 v[172:175], v[140:143], a[28:31], v[172:175]
    ds_read_b128 v[140:143], v11 offset:22528
    v_mfma_f32_16x16x32_bf16 v[160:163], v[144:147], a[32:35], v[160:163]
    v_mfma_f32_16x16x32_bf16 v[160:163], v[148:151], a[40:43], v[160:163]
    v_mfma_f32_16x16x32_bf16 v[160:163], v[104:107], a[48:51], v[160:163]
    v_mfma_f32_16x16x32_bf16 v[160:163], v[108:111], a[56:59], v[160:163]
    v_mfma_f32_16x16x32_bf16 v[164:167], v[144:147], a[36:39], v[164:167]
    ds_read_b128 v[144:147], v11 offset:17408
    v_mfma_f32_16x16x32_bf16 v[164:167], v[148:151], a[44:47], v[164:167]
    ds_read_b128 v[148:151], v11 offset:19456
    v_mfma_f32_16x16x32_bf16 v[164:167], v[104:107], a[52:55], v[164:167]
    ds_read_b128 v[104:107], v11 offset:21504
    v_mfma_f32_16x16x32_bf16 v[164:167], v[108:111], a[60:63], v[164:167]
    s_waitcnt lgkmcnt(3)
    ds_read_b128 v[108:111], v11 offset:23552
    v_mfma_f32_16x16x32_bf16 v[168:171], v[112:115], a[32:35], v[168:171]
    v_mfma_f32_16x16x32_bf16 v[168:171], v[116:119], a[40:43], v[168:171]
    v_mfma_f32_16x16x32_bf16 v[168:171], v[120:123], a[48:51], v[168:171]
    v_mfma_f32_16x16x32_bf16 v[168:171], v[124:127], a[56:59], v[168:171]
    v_mfma_f32_16x16x32_bf16 v[172:175], v[112:115], a[36:39], v[172:175]
    ds_read_b128 v[112:115], v11 offset:24576
    v_mfma_f32_16x16x32_bf16 v[172:175], v[116:119], a[44:47], v[172:175]
    ds_read_b128 v[116:119], v11 offset:26624
    v_mfma_f32_16x16x32_bf16 v[172:175], v[120:123], a[52:55], v[172:175]
    ds_read_b128 v[120:123], v11 offset:28672
    v_mfma_f32_16x16x32_bf16 v[172:175], v[124:127], a[60:63], v[172:175]
    ds_read_b128 v[124:127], v11 offset:30720
    v_mfma_f32_16x16x32_bf16 v[160:163], v[128:131], a[64:67], v[160:163]
    v_mfma_f32_16x16x32_bf16 v[160:163], v[132:135], a[72:75], v[160:163]
    v_mfma_f32_16x16x32_bf16 v[160:163], v[136:139], a[80:83], v[160:163]
    v_mfma_f32_16x16x32_bf16 v[160:163], v[140:143], a[88:91], v[160:163]
    v_mfma_f32_16x16x32_bf16 v[164:167], v[128:131], a[68:71], v[164:167]
    ds_read_b128 v[128:131], v11 offset:25600
    v_mfma_f32_16x16x32_bf16 v[164:167], v[132:135], a[76:79], v[164:167]
    ds_read_b128 v[132:135], v11 offset:27648
    v_mfma_f32_16x16x32_bf16 v[164:167], v[136:139], a[84:87], v[164:167]
    ds_read_b128 v[136:139], v11 offset:29696
    v_mfma_f32_16x16x32_bf16 v[164:167], v[140:143], a[92:95], v[164:167]
    s_waitcnt lgkmcnt(3)
    ds_read_b128 v[140:143], v11 offset:31744
    v_mfma_f32_16x16x32_bf16 v[168:171], v[144:147], a[64:67], v[168:171]
    v_mfma_f32_16x16x32_bf16 v[168:171], v[148:151], a[72:75], v[168:171]
    v_mfma_f32_16x16x32_bf16 v[168:171], v[104:107], a[80:83], v[168:171]
    v_mfma_f32_16x16x32_bf16 v[168:171], v[108:111], a[88:91], v[168:171]
    v_mfma_f32_16x16x32_bf16 v[172:175], v[144:147], a[68:71], v[172:175]
    v_mfma_f32_16x16x32_bf16 v[172:175], v[148:151], a[76:79], v[172:175]
    v_mfma_f32_16x16x32_bf16 v[172:175], v[104:107], a[84:87], v[172:175]
    v_mfma_f32_16x16x32_bf16 v[172:175], v[108:111], a[92:95], v[172:175]
    v_mfma_f32_16x16x32_bf16 v[160:163], v[112:115], a[96:99], v[160:163]
    v_mfma_f32_16x16x32_bf16 v[160:163], v[116:119], a[104:107], v[160:163]
    v_mfma_f32_16x16x32_bf16 v[160:163], v[120:123], a[112:115], v[160:163]
    s_waitcnt vmcnt(0)
    buffer_store_dword v31, v23, s[32:35], s74 offen sc1
    v_mfma_f32_16x16x32_bf16 v[160:163], v[124:127], a[120:123], v[160:163]
    s_waitcnt vmcnt(8)
    s_barrier
    ds_read_b128 v[144:147], v12 offset:0
    v_mfma_f32_16x16x32_bf16 v[164:167], v[112:115], a[100:103], v[164:167]
    ds_read_b128 v[148:151], v12 offset:2048
    ds_read_b128 v[104:107], v12 offset:4096
    v_mfma_f32_16x16x32_bf16 v[164:167], v[116:119], a[108:111], v[164:167]
    ds_read_b128 v[108:111], v12 offset:6144
    v_mfma_f32_16x16x32_bf16 v[164:167], v[120:123], a[116:119], v[164:167]
    ds_read_b128 v[112:115], v12 offset:1024
    v_mfma_f32_16x16x32_bf16 v[164:167], v[124:127], a[124:127], v[164:167]
    s_lshr_b32 s64, s4, 1
    s_lshl1_add_u32 s21, s61, s64
    s_mul_i32 s21, s21, 3
    s_waitcnt lgkmcnt(5)
    v_mfma_f32_16x16x32_bf16 v[168:171], v[128:131], a[96:99], v[168:171]
    s_add_u32 s21, s21, 128
    s_mul_i32 s21, s21, 36864
    s_add_u32 s21, s21, s28
    v_mfma_f32_16x16x32_bf16 v[168:171], v[132:135], a[104:107], v[168:171]
    s_add_u32 s21, s21, 7168
    s_and_b32 s64, s68, 1024
    s_add_u32 s21, s21, s64
    v_mfma_f32_16x16x32_bf16 v[168:171], v[136:139], a[112:115], v[168:171]
    s_add_u32 m0, s46, 0
    ds_read_b128 v[116:119], v12 offset:3072
    ds_read_b128 v[120:123], v12 offset:5120
    v_mfma_f32_16x16x32_bf16 v[168:171], v[140:143], a[120:123], v[168:171]
    s_lshl2_add_u32 s64, s61, s65
    buffer_load_dwordx4 v1, s[56:59], s21 offen sc1 lds
    v_mfma_f32_16x16x32_bf16 v[172:175], v[128:131], a[100:103], v[172:175]
    s_add_u32 s21, s21, 36864
    ds_read_b128 v[124:127], v12 offset:7168
    ds_read_b128 v[128:131], v12 offset:8192
    v_mfma_f32_16x16x32_bf16 v[172:175], v[132:135], a[108:111], v[172:175]
    s_add_u32 m0, s46, 1024
    ds_read_b128 v[132:135], v12 offset:10240
    s_lshl_b32 s65, s65, 5
    v_mfma_f32_16x16x32_bf16 v[172:175], v[136:139], a[116:119], v[172:175]
    s_add_u32 s65, s65, 1024
    buffer_load_dwordx4 v1, s[56:59], s21 offen sc1 lds
    v_mfma_f32_16x16x32_bf16 v[172:175], v[140:143], a[124:127], v[172:175]
    s_add_u32 s21, s21, 36864
    ds_read_b128 v[136:139], v12 offset:12288
    ds_read_b128 v[140:143], v12 offset:14336
    s_waitcnt lgkmcnt(5)
    v_mfma_f32_16x16x32_bf16 v[160:163], v[144:147], a[128:131], v[160:163]
    s_add_u32 m0, s46, 2048
    s_lshl_b32 s64, s64, 6
    v_mfma_f32_16x16x32_bf16 v[160:163], v[148:151], a[136:139], v[160:163]
    s_cmp_eq_u32 s4, s61
    s_cselect_b32 s65, s65, 1073741824
    s_cselect_b32 s70, s23, 1073741824
    v_mfma_f32_16x16x32_bf16 v[160:163], v[104:107], a[144:147], v[160:163]
    s_add_u32 s98, s70, 0
    buffer_load_dwordx4 v1, s[56:59], s21 offen sc1 lds
    v_mfma_f32_16x16x32_bf16 v[160:163], v[108:111], a[152:155], v[160:163]
    s_add_u32 s21, s21, 36864
    v_mfma_f32_16x16x32_bf16 v[164:167], v[144:147], a[132:135], v[164:167]
    ds_read_b128 v[144:147], v12 offset:9216
    v_mfma_f32_16x16x32_bf16 v[164:167], v[148:151], a[140:143], v[164:167]
    ds_read_b128 v[148:151], v12 offset:11264
    v_mfma_f32_16x16x32_bf16 v[164:167], v[104:107], a[148:151], v[164:167]
    ds_read_b128 v[104:107], v12 offset:13312
    v_mfma_f32_16x16x32_bf16 v[164:167], v[108:111], a[156:159], v[164:167]
    ds_read_b128 v[108:111], v12 offset:15360
    v_mfma_f32_16x16x32_bf16 v[168:171], v[112:115], a[128:131], v[168:171]
    v_mfma_f32_16x16x32_bf16 v[168:171], v[116:119], a[136:139], v[168:171]
    v_mfma_f32_16x16x32_bf16 v[168:171], v[120:123], a[144:147], v[168:171]
    s_waitcnt lgkmcnt(2)
    v_mfma_f32_16x16x32_bf16 v[168:171], v[124:127], a[152:155], v[168:171]
    v_mfma_f32_16x16x32_bf16 v[172:175], v[112:115], a[132:135], v[172:175]
    ds_read_b128 v[112:115], v12 offset:16384
    v_mfma_f32_16x16x32_bf16 v[172:175], v[116:119], a[140:143], v[172:175]
    ds_read_b128 v[116:119], v12 offset:18432
    v_mfma_f32_16x16x32_bf16 v[172:175], v[120:123], a[148:151], v[172:175]
    ds_read_b128 v[120:123], v12 offset:20480
    v_mfma_f32_16x16x32_bf16 v[172:175], v[124:127], a[156:159], v[172:175]
    ds_read_b128 v[124:127], v12 offset:22528
    v_mfma_f32_16x16x32_bf16 v[160:163], v[128:131], a[160:163], v[160:163]
    v_mfma_f32_16x16x32_bf16 v[160:163], v[132:135], a[168:171], v[160:163]
    v_mfma_f32_16x16x32_bf16 v[160:163], v[136:139], a[176:179], v[160:163]
    v_mfma_f32_16x16x32_bf16 v[160:163], v[140:143], a[184:187], v[160:163]
    v_mfma_f32_16x16x32_bf16 v[164:167], v[128:131], a[164:167], v[164:167]
    ds_read_b128 v[128:131], v12 offset:17408
    v_mfma_f32_16x16x32_bf16 v[164:167], v[132:135], a[172:175], v[164:167]
    buffer_load_dword v3, v19, s[32:35], s66 offen sc1
    v_mfma_f32_16x16x32_bf16 v[164:167], v[136:139], a[180:183], v[164:167]
    ds_read_b128 v[132:135], v12 offset:19456
    ds_read_b128 v[136:139], v12 offset:21504
    v_mfma_f32_16x16x32_bf16 v[164:167], v[140:143], a[188:191], v[164:167]
    ds_read_b128 v[140:143], v12 offset:23552
    v_mfma_f32_16x16x32_bf16 v[168:171], v[144:147], a[160:163], v[168:171]
    v_mfma_f32_16x16x32_bf16 v[168:171], v[148:151], a[168:171], v[168:171]
    s_waitcnt lgkmcnt(3)
    v_mfma_f32_16x16x32_bf16 v[168:171], v[104:107], a[176:179], v[168:171]
    v_mfma_f32_16x16x32_bf16 v[168:171], v[108:111], a[184:187], v[168:171]
    v_mfma_f32_16x16x32_bf16 v[172:175], v[144:147], a[164:167], v[172:175]
    ds_read_b128 v[144:147], v12 offset:24576
    v_mfma_f32_16x16x32_bf16 v[172:175], v[148:151], a[172:175], v[172:175]
    ds_read_b128 v[148:151], v12 offset:26624
    v_mfma_f32_16x16x32_bf16 v[172:175], v[104:107], a[180:183], v[172:175]
    ds_read_b128 v[104:107], v12 offset:28672
    v_mfma_f32_16x16x32_bf16 v[172:175], v[108:111], a[188:191], v[172:175]
    ds_read_b128 v[108:111], v12 offset:30720
    v_mfma_f32_16x16x32_bf16 v[160:163], v[112:115], a[192:195], v[160:163]
    v_mfma_f32_16x16x32_bf16 v[160:163], v[116:119], a[200:203], v[160:163]
    v_mfma_f32_16x16x32_bf16 v[160:163], v[120:123], a[208:211], v[160:163]
    v_mfma_f32_16x16x32_bf16 v[160:163], v[124:127], a[216:219], v[160:163]
    v_mfma_f32_16x16x32_bf16 v[164:167], v[112:115], a[196:199], v[164:167]
    ds_read_b128 v[112:115], v12 offset:25600
    v_mfma_f32_16x16x32_bf16 v[164:167], v[116:119], a[204:207], v[164:167]
    ds_read_b128 v[116:119], v12 offset:27648
    v_mfma_f32_16x16x32_bf16 v[164:167], v[120:123], a[212:215], v[164:167]
    ds_read_b128 v[120:123], v12 offset:29696
    v_mfma_f32_16x16x32_bf16 v[164:167], v[124:127], a[220:223], v[164:167]
    ds_read_b128 v[124:127], v12 offset:31744
    v_mfma_f32_16x16x32_bf16 v[168:171], v[128:131], a[192:195], v[168:171]
    s_waitcnt lgkmcnt(4)
    v_mfma_f32_16x16x32_bf16 v[168:171], v[132:135], a[200:203], v[168:171]
    v_mfma_f32_16x16x32_bf16 v[168:171], v[136:139], a[208:211], v[168:171]
    v_mfma_f32_16x16x32_bf16 v[168:171], v[140:143], a[216:219], v[168:171]
    v_mfma_f32_16x16x32_bf16 v[172:175], v[128:131], a[196:199], v[172:175]
    v_mfma_f32_16x16x32_bf16 v[172:175], v[132:135], a[204:207], v[172:175]
    v_mfma_f32_16x16x32_bf16 v[172:175], v[136:139], a[212:215], v[172:175]
    v_mfma_f32_16x16x32_bf16 v[172:175], v[140:143], a[220:223], v[172:175]
    v_mfma_f32_16x16x32_bf16 v[160:163], v[144:147], a[224:227], v[160:163]
    s_waitcnt vmcnt(0)
    v_cmp_gt_u32 vcc, 3, v3
    s_nop 1
    s_and_b64 vcc, vcc, exec
    s_cbranch_scc1 SPIN_X
BACK_X:
    v_mfma_f32_16x16x32_bf16 v[160:163], v[148:151], a[232:235], v[160:163]
    buffer_load_dwordx4 v[200:203], v1, s[48:51], s98 offen offset:2048 sc1
    v_mfma_f32_16x16x32_bf16 v[160:163], v[104:107], a[240:243], v[160:163]
    s_add_u32 s98, s70, 12288
    buffer_load_dwordx4 v[204:207], v1, s[48:51], s98 offen offset:2048 sc1
    v_mfma_f32_16x16x32_bf16 v[160:163], v[108:111], a[248:251], v[160:163]
    s_waitcnt vmcnt(3)
    s_barrier
    ds_read_b128 v[128:131], v13 offset:0
    v_mfma_f32_16x16x32_bf16 v[164:167], v[144:147], a[228:231], v[164:167]
    s_add_u32 s98, s70, 24576
    ds_read_b128 v[132:135], v13 offset:1024
    ds_read_b128 v[136:139], v13 offset:2048
    v_mfma_f32_16x16x32_bf16 v[164:167], v[148:151], a[236:239], v[164:167]
    buffer_load_dwordx4 v[208:211], v1, s[48:51], s98 offen offset:2048 sc1
    v_mfma_f32_16x16x32_bf16 v[164:167], v[104:107], a[244:247], v[164:167]
    s_add_u32 s98, s23, 0
    ds_read_b128 v[140:143], v13 offset:8192
    ds_read_b128 v[144:147], v13 offset:9216
    v_mfma_f32_16x16x32_bf16 v[164:167], v[108:111], a[252:255], v[164:167]
    s_waitcnt lgkmcnt(5)
    ds_read_b128 v[148:151], v13 offset:10240
    v_mfma_f32_16x16x32_bf16 v[168:171], v[112:115], a[224:227], v[168:171]
    ds_read_b128 v[104:107], v13 offset:16384
    v_mfma_f32_16x16x32_bf16 v[168:171], v[116:119], a[232:235], v[168:171]
    buffer_load_dwordx4 v[176:179], v1, s[48:51], s98 offen offset:0 sc1
    v_mfma_f32_16x16x32_bf16 v[168:171], v[120:123], a[240:243], v[168:171]
    s_add_u32 s98, s23, 12288
    ds_read_b128 v[108:111], v13 offset:17408
    v_mfma_f32_16x16x32_bf16 v[168:171], v[124:127], a[248:251], v[168:171]
    v_mfma_f32_16x16x32_bf16 v[172:175], v[112:115], a[228:231], v[172:175]
    ds_read_b128 v[112:115], v13 offset:18432
    v_mfma_f32_16x16x32_bf16 v[172:175], v[116:119], a[236:239], v[172:175]
    buffer_load_dwordx4 v[180:183], v1, s[48:51], s98 offen offset:0 sc1
    v_mfma_f32_16x16x32_bf16 v[172:175], v[120:123], a[244:247], v[172:175]
    s_add_u32 s98, s23, 24576
    ds_read_b128 v[116:119], v13 offset:24576
    ds_read_b128 v[120:123], v13 offset:25600
    v_mfma_f32_16x16x32_bf16 v[172:175], v[124:127], a[252:255], v[172:175]
    s_waitcnt lgkmcnt(3)
    ds_read_b128 v[124:127], v13 offset:26624
    v_mfma_f32_16x16x32_bf16 v[160:163], v[128:131], v[32:35], v[160:163]
    v_mfma_f32_16x16x32_bf16 v[160:163], v[132:135], v[40:43], v[160:163]
    buffer_load_dwordx4 v[184:187], v1, s[48:51], s98 offen offset:0 sc1
    v_mfma_f32_16x16x32_bf16 v[160:163], v[136:139], v[48:51], v[160:163]
    s_add_u32 s98, s23, 0
    v_mfma_f32_16x16x32_bf16 v[164:167], v[128:131], v[36:39], v[164:167]
    v_mfma_f32_16x16x32_bf16 v[164:167], v[132:135], v[44:47], v[164:167]
    v_mfma_f32_16x16x32_bf16 v[164:167], v[136:139], v[52:55], v[164:167]
    buffer_load_dwordx4 v[188:191], v1, s[48:51], s98 offen offset:1024 sc1
    v_mfma_f32_16x16x32_bf16 v[168:171], v[140:143], v[32:35], v[168:171]
    s_add_u32 s98, s23, 12288
    v_mfma_f32_16x16x32_bf16 v[168:171], v[144:147], v[40:43], v[168:171]
    v_mfma_f32_16x16x32_bf16 v[168:171], v[148:151], v[48:51], v[168:171]
    v_mfma_f32_16x16x32_bf16 v[172:175], v[140:143], v[36:39], v[172:175]
    buffer_load_dwordx4 v[192:195], v1, s[48:51], s98 offen offset:1024 sc1
    v_mfma_f32_16x16x32_bf16 v[172:175], v[144:147], v[44:47], v[172:175]
    s_add_u32 s98, s23, 24576
    v_mfma_f32_16x16x32_bf16 v[172:175], v[148:151], v[52:55], v[172:175]
    v_mfma_f32_16x16x32_bf16 v[160:163], v[104:107], v[56:59], v[160:163]
    v_mfma_f32_16x16x32_bf16 v[160:163], v[108:111], v[64:67], v[160:163]
    s_waitcnt lgkmcnt(0)
    buffer_load_dwordx4 v[196:199], v1, s[48:51], s98 offen offset:1024 sc1
    v_mfma_f32_16x16x32_bf16 v[160:163], v[112:115], v[72:75], v[160:163]
    v_mfma_f32_16x16x32_bf16 v[164:167], v[104:107], v[60:63], v[164:167]
    v_mfma_f32_16x16x32_bf16 v[164:167], v[108:111], v[68:71], v[164:167]
    v_mfma_f32_16x16x32_bf16 v[164:167], v[112:115], v[76:79], v[164:167]
    v_mfma_f32_16x16x32_bf16 v[168:171], v[116:119], v[56:59], v[168:171]
    v_mfma_f32_16x16x32_bf16 v[168:171], v[120:123], v[64:67], v[168:171]
    v_mfma_f32_16x16x32_bf16 v[168:171], v[124:127], v[72:75], v[168:171]
    v_mfma_f32_16x16x32_bf16 v[172:175], v[116:119], v[60:63], v[172:175]
    v_mfma_f32_16x16x32_bf16 v[172:175], v[120:123], v[68:71], v[172:175]
    v_mfma_f32_16x16x32_bf16 v[172:175], v[124:127], v[76:79], v[172:175]
    s_cmp_lg_u32 s4, s61
    s_cbranch_scc1 K1_X2
    s_waitcnt vmcnt(6)
    v_lshlrev_b32 v80, 16, v200
    v_and_b32 v81, 0xffff0000, v200
    v_lshlrev_b32 v82, 16, v204
    v_and_b32 v83, 0xffff0000, v204
    v_lshlrev_b32 v84, 16, v208
    v_and_b32 v85, 0xffff0000, v208
    v_pk_add_f32 v[80:81], v[80:81], v[82:83]
    v_pk_add_f32 v[224:225], v[224:225], v[84:85]
    v_pk_add_f32 v[224:225], v[224:225], v[80:81]
    v_cvt_pk_bf16_f32 v200, v224, v225
    v_lshlrev_b32 v86, 16, v201
    v_and_b32 v87, 0xffff0000, v201
    v_lshlrev_b32 v88, 16, v205
    v_and_b32 v89, 0xffff0000, v205
    v_lshlrev_b32 v90, 16, v209
    v_and_b32 v91, 0xffff0000, v209
    v_pk_add_f32 v[86:87], v[86:87], v[88:89]
    v_pk_add_f32 v[226:227], v[226:227], v[90:91]
    v_pk_add_f32 v[226:227], v[226:227], v[86:87]
    v_cvt_pk_bf16_f32 v201, v226, v227
    buffer_store_dwordx2 v[200:201], v20, s[24:27], s65 offen
    v_lshlrev_b32 v92, 16, v202
    v_and_b32 v93, 0xffff0000, v202
    v_lshlrev_b32 v94, 16, v206
    v_and_b32 v95, 0xffff0000, v206
    v_lshlrev_b32 v96, 16, v210
    v_and_b32 v97, 0xffff0000, v210
    v_pk_add_f32 v[92:93], v[92:93], v[94:95]
    v_pk_add_f32 v[228:229], v[228:229], v[96:97]
    v_pk_add_f32 v[228:229], v[228:229], v[92:93]
    v_cvt_pk_bf16_f32 v202, v228, v229
    v_lshlrev_b32 v98, 16, v203
    v_and_b32 v99, 0xffff0000, v203
    v_lshlrev_b32 v100, 16, v207
    v_and_b32 v101, 0xffff0000, v207
    v_lshlrev_b32 v102, 16, v211
    v_and_b32 v103, 0xffff0000, v211
    v_pk_add_f32 v[98:99], v[98:99], v[100:101]
    v_pk_add_f32 v[230:231], v[230:231], v[102:103]
    v_pk_add_f32 v[230:231], v[230:231], v[98:99]
    v_cvt_pk_bf16_f32 v203, v230, v231
    buffer_store_dwordx2 v[202:203], v21, s[24:27], s65 offen
    s_waitcnt vmcnt(2)
K1_X2:
    s_waitcnt vmcnt(3)
    v_lshlrev_b32 v80, 16, v176
    v_and_b32 v81, 0xffff0000, v176
    v_lshlrev_b32 v82, 16, v180
    v_and_b32 v83, 0xffff0000, v180
    v_lshlrev_b32 v84, 16, v184
    v_and_b32 v85, 0xffff0000, v184
    v_pk_add_f32 v[80:81], v[80:81], v[82:83]
    v_pk_add_f32 v[160:161], v[160:161], v[84:85]
    v_pk_add_f32 v[160:161], v[160:161], v[80:81]
    v_cvt_pk_bf16_f32 v176, v160, v161
    v_lshlrev_b32 v86, 16, v177
    v_and_b32 v87, 0xffff0000, v177
    v_lshlrev_b32 v88, 16, v181
    v_and_b32 v89, 0xffff0000, v181
    v_lshlrev_b32 v90, 16, v185
    v_and_b32 v91, 0xffff0000, v185
    v_pk_add_f32 v[86:87], v[86:87], v[88:89]
    v_pk_add_f32 v[162:163], v[162:163], v[90:91]
    v_pk_add_f32 v[162:163], v[162:163], v[86:87]
    v_cvt_pk_bf16_f32 v177, v162, v163
    buffer_store_dwordx2 v[176:177], v20, s[24:27], s64 offen
    v_lshlrev_b32 v92, 16, v178
    v_and_b32 v93, 0xffff0000, v178
    v_lshlrev_b32 v94, 16, v182
    v_and_b32 v95, 0xffff0000, v182
    v_lshlrev_b32 v96, 16, v186
    v_and_b32 v97, 0xffff0000, v186
    v_pk_add_f32 v[92:93], v[92:93], v[94:95]
    v_pk_add_f32 v[164:165], v[164:165], v[96:97]
    v_pk_add_f32 v[164:165], v[164:165], v[92:93]
    v_cvt_pk_bf16_f32 v178, v164, v165
    v_lshlrev_b32 v98, 16, v179
    v_and_b32 v99, 0xffff0000, v179
    v_lshlrev_b32 v100, 16, v183
    v_and_b32 v101, 0xffff0000, v183
    v_lshlrev_b32 v102, 16, v187
    v_and_b32 v103, 0xffff0000, v187
    v_pk_add_f32 v[98:99], v[98:99], v[100:101]
    v_pk_add_f32 v[166:167], v[166:167], v[102:103]
    v_pk_add_f32 v[166:167], v[166:167], v[98:99]
    v_cvt_pk_bf16_f32 v179, v166, v167
    buffer_store_dwordx2 v[178:179], v21, s[24:27], s64 offen
    s_waitcnt vmcnt(2)
    v_lshlrev_b32 v80, 16, v188
    v_and_b32 v81, 0xffff0000, v188
    v_lshlrev_b32 v82, 16, v192
    v_and_b32 v83, 0xffff0000, v192
    v_lshlrev_b32 v84, 16, v196
    v_and_b32 v85, 0xffff0000, v196
    v_pk_add_f32 v[80:81], v[80:81], v[82:83]
    v_pk_add_f32 v[168:169], v[168:169], v[84:85]
    v_pk_add_f32 v[168:169], v[168:169], v[80:81]
    v_cvt_pk_bf16_f32 v188, v168, v169
    v_lshlrev_b32 v86, 16, v189
    v_and_b32 v87, 0xffff0000, v189
    v_lshlrev_b32 v88, 16, v193
    v_and_b32 v89, 0xffff0000, v193
    v_lshlrev_b32 v90, 16, v197
    v_and_b32 v91, 0xffff0000, v197
    v_pk_add_f32 v[86:87], v[86:87], v[88:89]
    v_pk_add_f32 v[170:171], v[170:171], v[90:91]
    v_pk_add_f32 v[170:171], v[170:171], v[86:87]
    v_cvt_pk_bf16_f32 v189, v170, v171
    buffer_store_dwordx2 v[188:189], v20, s[24:27], s64 offen offset:32
    v_lshlrev_b32 v92, 16, v190
    v_and_b32 v93, 0xffff0000, v190
    v_lshlrev_b32 v94, 16, v194
    v_and_b32 v95, 0xffff0000, v194
    v_lshlrev_b32 v96, 16, v198
    v_and_b32 v97, 0xffff0000, v198
    v_pk_add_f32 v[92:93], v[92:93], v[94:95]
    v_pk_add_f32 v[172:173], v[172:173], v[96:97]
    v_pk_add_f32 v[172:173], v[172:173], v[92:93]
    v_cvt_pk_bf16_f32 v190, v172, v173
    v_lshlrev_b32 v98, 16, v191
    v_and_b32 v99, 0xffff0000, v191
    v_lshlrev_b32 v100, 16, v195
    v_and_b32 v101, 0xffff0000, v195
    v_lshlrev_b32 v102, 16, v199
    v_and_b32 v103, 0xffff0000, v199
    v_pk_add_f32 v[98:99], v[98:99], v[100:101]
    v_pk_add_f32 v[174:175], v[174:175], v[102:103]
    v_pk_add_f32 v[174:175], v[174:175], v[98:99]
    v_cvt_pk_bf16_f32 v191, v174, v175
    buffer_store_dwordx2 v[190:191], v21, s[24:27], s64 offen offset:32
K1_END:
    s_endpgm
K1_LB_MASK:
    buffer_load_dword v3, v29, s[32:35], s92 offen sc1
    s_nop 1
    v_add_f32 v212, s12, v144
    v_fma_f32 v176, v208, s8, v212
    v_fma_f32 v177, v209, s8, v212
    v_fma_f32 v178, v210, s8, v212
    v_fma_f32 v179, v211, s8, v212
    v_add_f32 v213, s13, v144
    v_fma_f32 v180, v208, s9, v213
    v_fma_f32 v181, v209, s9, v213
    v_fma_f32 v182, v210, s9, v213
    v_fma_f32 v183, v211, s9, v213
    v_add_f32 v214, s14, v144
    v_fma_f32 v184, v208, s10, v214
    v_fma_f32 v185, v209, s10, v214
    v_fma_f32 v186, v210, s10, v214
    v_fma_f32 v187, v211, s10, v214
    v_add_f32 v215, s15, v144
    v_fma_f32 v188, v208, s11, v215
    v_fma_f32 v189, v209, s11, v215
    v_fma_f32 v190, v210, s11, v215
    v_fma_f32 v191, v211, s11, v215
    s_nop 1
    s_branch K1_LB_BACK
K1_LS_MASK:
    s_cmp_eq_u32 s78, 1
    s_cbranch_scc1 K1_LS_LAST
    buffer_load_dword v3, v29, s[32:35], s92 offen sc1
    v_mov_b32 v218, 1
    s_cmp_eq_u64 s[84:85], 0
    s_cselect_b32 s7, s74, 1073741824
    s_cmp_lg_u32 s83, 0
    s_cselect_b32 s7, s74, s7
    s_waitcnt vmcnt(9)
    buffer_store_dword v218, v216, s[32:35], s7 offen sc1
    s_branch K1_LS_BACK
K1_LS_LAST:
    v_cmp_gt_u32 vcc, 1, v3
    s_nop 1
    s_cmp_lg_u32 vcc_lo, 0
    s_cbranch_scc1 SPIN_W0
BACK_W0:
    s_mov_b64 s[36:37], s[56:57]
    s_mov_b32 s38, 5603328
    s_xor_b32 s77, s3, 0
    s_lshl2_add_u32 s77, s77, s4
    s_mul_i32 s77, s77, 36864
    s_add_u32 s77, s77, s28
    s_nop 1
    v_add_f32 v212, s12, v152
    v_fma_f32 v176, v208, s8, v212
    v_fma_f32 v177, v209, s8, v212
    v_fma_f32 v178, v210, s8, v212
    v_fma_f32 v179, v211, s8, v212
    v_add_f32 v213, s13, v152
    v_fma_f32 v180, v208, s9, v213
    v_fma_f32 v181, v209, s9, v213
    v_fma_f32 v182, v210, s9, v213
    v_fma_f32 v183, v211, s9, v213
    v_add_f32 v214, s14, v152
    v_fma_f32 v184, v208, s10, v214
    v_fma_f32 v185, v209, s10, v214
    v_fma_f32 v186, v210, s10, v214
    v_fma_f32 v187, v211, s10, v214
    v_add_f32 v215, s15, v152
    v_fma_f32 v188, v208, s11, v215
    v_fma_f32 v189, v209, s11, v215
    v_fma_f32 v190, v210, s11, v215
    v_fma_f32 v191, v211, s11, v215
    s_nop 1
    s_branch K1_LS_BACK
K1_S7:
    v_mov_b32 v218, 1
    s_cmp_eq_u64 s[84:85], 0
    s_cselect_b32 s7, s74, 1073741824
    s_cmp_lg_u32 s83, 0
    s_cselect_b32 s7, s74, s7
    s_waitcnt vmcnt(8)
    buffer_store_dword v218, v216, s[32:35], s7 offen sc1
    s_branch K1_S7_BACK
K1_J7:
    v_cmp_gt_u32 vcc, 1, v3
    s_nop 1
    s_cmp_lg_u32 vcc_lo, 0
    s_cbranch_scc1 SPIN_W7
BACK_W7:
    s_mov_b64 s[36:37], s[56:57]
    s_mov_b32 s38, 5603328
    s_xor_b32 s77, s3, 0
    s_lshl2_add_u32 s77, s77, s4
    s_mul_i32 s77, s77, 36864
    s_add_u32 s77, s77, s28
    s_branch K1_J7_BACK
K1_REDO:
    s_mov_b32 s83, 1
    s_mov_b32 s63, 1073741824
    s_mov_b32 s64, 1073741824
    s_mov_b32 s62, 1073741824
    s_mul_i32 s7, s5, 1081344
    s_sub_u32 s7, 56623104, s7
    s_sub_u32 s36, s56, s7
    s_subb_u32 s37, s57, 0
    s_mov_b32 s38, 1081344
    s_mov_b32 s50, 0
    s_mov_b32 s54, 0
    s_waitcnt vmcnt(0) lgkmcnt(0)
    s_barrier
    v_lshrrev_b32 v92, 4, v1
    v_and_b32 v64, 15, v92
    v_lshrrev_b32 v92, 4, v92
    v_lshlrev_b32 v92, 2, v92
    v_sub_u32 v92, v64, v92
    s_lshl_b32 s98, s4, 4
    v_add_u32 v92, s98, v92
    s_lshl_b32 s98, s6, 7
    s_sub_u32 s99, 1920, s98
    v_add_u32 v64, s98, v92
    v_add_u32 v65, 64, v64
    v_add_u32 v66, s99, v92
    v_add_u32 v67, 64, v66
    v_mov_b32 v93, 0xf149f2ca
    v_mov_b32 v68, v93
    v_mov_b32 v69, v93
    v_mov_b32 v70, v93
    v_mov_b32 v71, v93
    s_mov_b32 s78, 0
    s_add_u32 s99, s99, 128
K1_REDO_L:
    s_lshr_b32 s7, s78, 6
    s_lshl_b32 s7, s7, 15
    s_bfe_u32 s98, s78, 0x20004
    s_lshl_b32 s98, s98, 12
    s_add_u32 s7, s7, s98
    buffer_load_dwordx4 v[72:75], v1, s[36:39], s7 offen offset:0 sc1
    buffer_load_dwordx4 v[76:79], v1, s[36:39], s7 offen offset:1024 sc1
    buffer_load_dwordx4 v[80:83], v1, s[36:39], s7 offen offset:2048 sc1
    buffer_load_dwordx4 v[84:87], v1, s[36:39], s7 offen offset:3072 sc1
    s_waitcnt vmcnt(0)
    v_mfma_f32_16x16x32_bf16 v[88:91], v[72:75], v[128:131], 0
    v_mfma_f32_16x16x32_bf16 v[88:91], v[76:79], v[160:163], v[88:91]
    v_mfma_f32_16x16x32_bf16 v[88:91], v[80:83], v[192:195], v[88:91]
    v_mfma_f32_16x16x32_bf16 v[88:91], v[84:87], v[224:227], v[88:91]
    v_subrev_u32 v92, s78, v64
    v_cmp_le_i32 vcc, 0, v92
    s_nop 5
    v_cndmask_b32 v88, v93, v88, vcc
    v_max_f32 v68, v68, v88
    v_cmp_le_i32 vcc, 1, v92
    s_nop 1
    v_cndmask_b32 v89, v93, v89, vcc
    v_max_f32 v68, v68, v89
    v_cmp_le_i32 vcc, 2, v92
    s_nop 1
    v_cndmask_b32 v90, v93, v90, vcc
    v_max_f32 v68, v68, v90
    v_cmp_le_i32 vcc, 3, v92
    s_nop 1
    v_cndmask_b32 v91, v93, v91, vcc
    v_max_f32 v68, v68, v91
    v_mfma_f32_16x16x32_bf16 v[88:91], v[72:75], v[132:135], 0
    v_mfma_f32_16x16x32_bf16 v[88:91], v[76:79], v[164:167], v[88:91]
    v_mfma_f32_16x16x32_bf16 v[88:91], v[80:83], v[196:199], v[88:91]
    v_mfma_f32_16x16x32_bf16 v[88:91], v[84:87], v[228:231], v[88:91]
    v_subrev_u32 v92, s78, v65
    v_cmp_le_i32 vcc, 0, v92
    s_nop 5
    v_cndmask_b32 v88, v93, v88, vcc
    v_max_f32 v69, v69, v88
    v_cmp_le_i32 vcc, 1, v92
    s_nop 1
    v_cndmask_b32 v89, v93, v89, vcc
    v_max_f32 v69, v69, v89
    v_cmp_le_i32 vcc, 2, v92
    s_nop 1
    v_cndmask_b32 v90, v93, v90, vcc
    v_max_f32 v69, v69, v90
    v_cmp_le_i32 vcc, 3, v92
    s_nop 1
    v_cndmask_b32 v91, v93, v91, vcc
    v_max_f32 v69, v69, v91
    v_mfma_f32_16x16x32_bf16 v[88:91], v[72:75], v[136:139], 0
    v_mfma_f32_16x16x32_bf16 v[88:91], v[76:79], v[168:171], v[88:91]
    v_mfma_f32_16x16x32_bf16 v[88:91], v[80:83], v[200:203], v[88:91]
    v_mfma_f32_16x16x32_bf16 v[88:91], v[84:87], v[232:235], v[88:91]
    v_subrev_u32 v92, s78, v66
    v_cmp_le_i32 vcc, 0, v92
    s_nop 5
    v_cndmask_b32 v88, v93, v88, vcc
    v_max_f32 v70, v70, v88
    v_cmp_le_i32 vcc, 1, v92
    s_nop 1
    v_cndmask_b32 v89, v93, v89, vcc
    v_max_f32 v70, v70, v89
    v_cmp_le_i32 vcc, 2, v92
    s_nop 1
    v_cndmask_b32 v90, v93, v90, vcc
    v_max_f32 v70, v70, v90
    v_cmp_le_i32 vcc, 3, v92
    s_nop 1
    v_cndmask_b32 v91, v93, v91, vcc
    v_max_f32 v70, v70, v91
    v_mfma_f32_16x16x32_bf16 v[88:91], v[72:75], v[140:143], 0
    v_mfma_f32_16x16x32_bf16 v[88:91], v[76:79], v[172:175], v[88:91]
    v_mfma_f32_16x16x32_bf16 v[88:91], v[80:83], v[204:207], v[88:91]
    v_mfma_f32_16x16x32_bf16 v[88:91], v[84:87], v[236:239], v[88:91]
    v_subrev_u32 v92, s78, v67
    v_cmp_le_i32 vcc, 0, v92
    s_nop 5
    v_cndmask_b32 v88, v93, v88, vcc
    v_max_f32 v71, v71, v88
    v_cmp_le_i32 vcc, 1, v92
    s_nop 1
    v_cndmask_b32 v89, v93, v89, vcc
    v_max_f32 v71, v71, v89
    v_cmp_le_i32 vcc, 2, v92
    s_nop 1
    v_cndmask_b32 v90, v93, v90, vcc
    v_max_f32 v71, v71, v90
    v_cmp_le_i32 vcc, 3, v92
    s_nop 1
    v_cndmask_b32 v91, v93, v91, vcc
    v_max_f32 v71, v71, v91
    s_add_u32 s78, s78, 16
    s_cmp_lt_u32 s78, s99
    s_cbranch_scc1 K1_REDO_L
    v_mov_b32 v92, v68
    s_nop 1
    v_permlane32_swap_b32 v68, v92
    v_max_f32 v68, v68, v92
    v_mov_b32 v92, v68
    s_nop 1
    v_permlane16_swap_b32 v68, v92
    v_max_f32 v68, v68, v92
    v_sub_f32 v144, 0, v68
    v_sub_f32 v145, 0, v68
    v_sub_f32 v146, 0, v68
    v_sub_f32 v147, 0, v68
    v_mov_b32 v92, v69
    s_nop 1
    v_permlane32_swap_b32 v69, v92
    v_max_f32 v69, v69, v92
    v_mov_b32 v92, v69
    s_nop 1
    v_permlane16_swap_b32 v69, v92
    v_max_f32 v69, v69, v92
    v_sub_f32 v148, 0, v69
    v_sub_f32 v149, 0, v69
    v_sub_f32 v150, 0, v69
    v_sub_f32 v151, 0, v69
    v_mov_b32 v92, v70
    s_nop 1
    v_permlane32_swap_b32 v70, v92
    v_max_f32 v70, v70, v92
    v_mov_b32 v92, v70
    s_nop 1
    v_permlane16_swap_b32 v70, v92
    v_max_f32 v70, v70, v92
    v_sub_f32 v152, 0, v70
    v_sub_f32 v153, 0, v70
    v_sub_f32 v154, 0, v70
    v_sub_f32 v155, 0, v70
    v_mov_b32 v92, v71
    s_nop 1
    v_permlane32_swap_b32 v71, v92
    v_max_f32 v71, v71, v92
    v_mov_b32 v92, v71
    s_nop 1
    v_permlane16_swap_b32 v71, v92
    v_max_f32 v71, v71, v92
    v_sub_f32 v156, 0, v71
    v_sub_f32 v157, 0, v71
    v_sub_f32 v158, 0, v71
    v_sub_f32 v159, 0, v71
    v_accvgpr_write_b32 a0, 0
    v_accvgpr_write_b32 a1, 0
    v_accvgpr_write_b32 a2, 0
    v_accvgpr_write_b32 a3, 0
    v_accvgpr_write_b32 a4, 0
    v_accvgpr_write_b32 a5, 0
    v_accvgpr_write_b32 a6, 0
    v_accvgpr_write_b32 a7, 0
    v_accvgpr_write_b32 a8, 0
    v_accvgpr_write_b32 a9, 0
    v_accvgpr_write_b32 a10, 0
    v_accvgpr_write_b32 a11, 0
    v_accvgpr_write_b32 a12, 0
    v_accvgpr_write_b32 a13, 0
    v_accvgpr_write_b32 a14, 0
    v_accvgpr_write_b32 a15, 0
    v_accvgpr_write_b32 a16, 0
    v_accvgpr_write_b32 a17, 0
    v_accvgpr_write_b32 a18, 0
    v_accvgpr_write_b32 a19, 0
    v_accvgpr_write_b32 a20, 0
    v_accvgpr_write_b32 a21, 0
    v_accvgpr_write_b32 a22, 0
    v_accvgpr_write_b32 a23, 0
    v_accvgpr_write_b32 a24, 0
    v_accvgpr_write_b32 a25, 0
    v_accvgpr_write_b32 a26, 0
    v_accvgpr_write_b32 a27, 0
    v_accvgpr_write_b32 a28, 0
    v_accvgpr_write_b32 a29, 0
    v_accvgpr_write_b32 a30, 0
    v_accvgpr_write_b32 a31, 0
    v_accvgpr_write_b32 a32, 0
    v_accvgpr_write_b32 a33, 0
    v_accvgpr_write_b32 a34, 0
    v_accvgpr_write_b32 a35, 0
    v_accvgpr_write_b32 a36, 0
    v_accvgpr_write_b32 a37, 0
    v_accvgpr_write_b32 a38, 0
    v_accvgpr_write_b32 a39, 0
    v_accvgpr_write_b32 a40, 0
    v_accvgpr_write_b32 a41, 0
    v_accvgpr_write_b32 a42, 0
    v_accvgpr_write_b32 a43, 0
    v_accvgpr_write_b32 a44, 0
    v_accvgpr_write_b32 a45, 0
    v_accvgpr_write_b32 a46, 0
    v_accvgpr_write_b32 a47, 0
    v_accvgpr_write_b32 a48, 0
    v_accvgpr_write_b32 a49, 0
    v_accvgpr_write_b32 a50, 0
    v_accvgpr_write_b32 a51, 0
    v_accvgpr_write_b32 a52, 0
    v_accvgpr_write_b32 a53, 0
    v_accvgpr_write_b32 a54, 0
    v_accvgpr_write_b32 a55, 0
    v_accvgpr_write_b32 a56, 0
    v_accvgpr_write_b32 a57, 0
    v_accvgpr_write_b32 a58, 0
    v_accvgpr_write_b32 a59, 0
    v_accvgpr_write_b32 a60, 0
    v_accvgpr_write_b32 a61, 0
    v_accvgpr_write_b32 a62, 0
    v_accvgpr_write_b32 a63, 0
    v_accvgpr_write_b32 a144, 0
    v_accvgpr_write_b32 a145, 0
    v_accvgpr_write_b32 a146, 0
    v_accvgpr_write_b32 a147, 0
    v_accvgpr_write_b32 a148, 0
    v_accvgpr_write_b32 a149, 0
    v_accvgpr_write_b32 a150, 0
    v_accvgpr_write_b32 a151, 0
    v_accvgpr_write_b32 a152, 0
    v_accvgpr_write_b32 a153, 0
    v_accvgpr_write_b32 a154, 0
    v_accvgpr_write_b32 a155, 0
    v_accvgpr_write_b32 a156, 0
    v_accvgpr_write_b32 a157, 0
    v_accvgpr_write_b32 a158, 0
    v_accvgpr_write_b32 a159, 0
    v_accvgpr_write_b32 a160, 0
    v_accvgpr_write_b32 a161, 0
    v_accvgpr_write_b32 a162, 0
    v_accvgpr_write_b32 a163, 0
    v_accvgpr_write_b32 a164, 0
    v_accvgpr_write_b32 a165, 0
    v_accvgpr_write_b32 a166, 0
    v_accvgpr_write_b32 a167, 0
    v_accvgpr_write_b32 a168, 0
    v_accvgpr_write_b32 a169, 0
    v_accvgpr_write_b32 a170, 0
    v_accvgpr_write_b32 a171, 0
    v_accvgpr_write_b32 a172, 0
    v_accvgpr_write_b32 a173, 0
    v_accvgpr_write_b32 a174, 0
    v_accvgpr_write_b32 a175, 0
    v_accvgpr_write_b32 a176, 0
    v_accvgpr_write_b32 a177, 0
    v_accvgpr_write_b32 a178, 0
    v_accvgpr_write_b32 a179, 0
    v_accvgpr_write_b32 a180, 0
    v_accvgpr_write_b32 a181, 0
    v_accvgpr_write_b32 a182, 0
    v_accvgpr_write_b32 a183, 0
    v_accvgpr_write_b32 a184, 0
    v_accvgpr_write_b32 a185, 0
    v_accvgpr_write_b32 a186, 0
    v_accvgpr_write_b32 a187, 0
    v_accvgpr_write_b32 a188, 0
    v_accvgpr_write_b32 a189, 0
    v_accvgpr_write_b32 a190, 0
    v_accvgpr_write_b32 a191, 0
    v_accvgpr_write_b32 a192, 0
    v_accvgpr_write_b32 a193, 0
    v_accvgpr_write_b32 a194, 0
    v_accvgpr_write_b32 a195, 0
    v_accvgpr_write_b32 a196, 0
    v_accvgpr_write_b32 a197, 0
    v_accvgpr_write_b32 a198, 0
    v_accvgpr_write_b32 a199, 0
    v_accvgpr_write_b32 a200, 0
    v_accvgpr_write_b32 a201, 0
    v_accvgpr_write_b32 a202, 0
    v_accvgpr_write_b32 a203, 0
    v_accvgpr_write_b32 a204, 0
    v_accvgpr_write_b32 a205, 0
    v_accvgpr_write_b32 a206, 0
    v_accvgpr_write_b32 a207, 0
    v_accvgpr_write_b32 a208, 0
    v_accvgpr_write_b32 a209, 0
    v_accvgpr_write_b32 a210, 0
    v_accvgpr_write_b32 a211, 0
    v_accvgpr_write_b32 a212, 0
    v_accvgpr_write_b32 a213, 0
    v_accvgpr_write_b32 a214, 0
    v_accvgpr_write_b32 a215, 0
    v_accvgpr_write_b32 a216, 0
    v_accvgpr_write_b32 a217, 0
    v_accvgpr_write_b32 a218, 0
    v_accvgpr_write_b32 a219, 0
    v_accvgpr_write_b32 a220, 0
    v_accvgpr_write_b32 a221, 0
    v_accvgpr_write_b32 a222, 0
    v_accvgpr_write_b32 a223, 0
    v_bfe_u32 v92, v1, 4, 2
    v_cmp_eq_u32 vcc, 0, v92
    v_mov_b32 v92, 0x3f803f80
    s_nop 0
    v_cndmask_b32 v92, 0, v92, vcc
    v_accvgpr_write_b32 a136, v92
    v_accvgpr_write_b32 a137, v92
    v_accvgpr_write_b32 a138, v92
    v_accvgpr_write_b32 a139, v92
    s_mov_b32 s77, s75
    s_mov_b32 s76, 0
    s_mov_b32 s38, 16384
    s_add_u32 m0, s76, s75
    s_nop 0
    buffer_load_dwordx4 v1, s[36:39], s77 offen sc1 lds
    buffer_load_dwordx4 v1, s[36:39], s77 offen offset:1024 sc1 lds
    buffer_load_dwordx4 v1, s[36:39], s77 offen offset:2048 sc1 lds
    buffer_load_dwordx4 v1, s[36:39], s77 offen offset:3072 sc1 lds
    s_add_u32 s100, s77, 4096
    s_add_u32 m0, m0, 4096
    s_nop 0
    buffer_load_dwordx4 v1, s[36:39], s100 offen sc1 lds
    buffer_load_dwordx4 v1, s[36:39], s100 offen offset:1024 sc1 lds
    buffer_load_dwordx4 v1, s[36:39], s100 offen offset:2048 sc1 lds
    buffer_load_dwordx4 v1, s[36:39], s100 offen offset:3072 sc1 lds
    s_add_u32 s77, s77, 32768
    s_add_u32 s76, s76, 32768
    s_lshr_b32 s82, s4, 1
    s_add_u32 s82, s82, 32
    s_sub_u32 s82, s82, s6
    s_sub_u32 s82, s82, s6
    s_lshl_b32 s38, s82, 15
    s_add_u32 m0, s76, s75
    s_nop 0
    buffer_load_dwordx4 v1, s[36:39], s77 offen sc1 lds
    buffer_load_dwordx4 v1, s[36:39], s77 offen offset:1024 sc1 lds
    buffer_load_dwordx4 v1, s[36:39], s77 offen offset:2048 sc1 lds
    buffer_load_dwordx4 v1, s[36:39], s77 offen offset:3072 sc1 lds
    s_add_u32 s100, s77, 4096
    s_add_u32 m0, m0, 4096
    s_nop 0
    buffer_load_dwordx4 v1, s[36:39], s100 offen sc1 lds
    buffer_load_dwordx4 v1, s[36:39], s100 offen offset:1024 sc1 lds
    buffer_load_dwordx4 v1, s[36:39], s100 offen offset:2048 sc1 lds
    buffer_load_dwordx4 v1, s[36:39], s100 offen offset:3072 sc1 lds
    s_add_u32 s77, s77, 32768
    s_add_u32 s76, s76, 32768
    s_add_u32 m0, s76, s75
    s_nop 0
    buffer_load_dwordx4 v1, s[36:39], s77 offen sc1 lds
    buffer_load_dwordx4 v1, s[36:39], s77 offen offset:1024 sc1 lds
    buffer_load_dwordx4 v1, s[36:39], s77 offen offset:2048 sc1 lds
    buffer_load_dwordx4 v1, s[36:39], s77 offen offset:3072 sc1 lds
    s_add_u32 s100, s77, 4096
    s_add_u32 m0, m0, 4096
    s_nop 0
    buffer_load_dwordx4 v1, s[36:39], s100 offen sc1 lds
    buffer_load_dwordx4 v1, s[36:39], s100 offen offset:1024 sc1 lds
    buffer_load_dwordx4 v1, s[36:39], s100 offen offset:2048 sc1 lds
    buffer_load_dwordx4 v1, s[36:39], s100 offen offset:3072 sc1 lds
    s_add_u32 s77, s77, 32768
    s_add_u32 s76, s76, 32768
    s_mov_b32 s82, 0
    s_mov_b32 s60, 131072
    v_mov_b32 v2, v1
    s_cmp_eq_u32 s6, 0
    s_cselect_b32 s16, s8, 0
    s_cselect_b32 s17, s9, 0
    s_cmp_eq_u32 s6, 0
    s_cselect_b32 s18, s10, 0
    s_cselect_b32 s19, s11, 0
    s_cmp_eq_u32 s6, 0
    s_cselect_b32 s20, s12, 0
    s_cselect_b32 s21, s13, 0
    s_cmp_eq_u32 s6, 0
    s_cselect_b32 s22, s14, 0
    s_cselect_b32 s23, s15, 0
    s_waitcnt vmcnt(16)
    s_barrier
    ds_read_b128 a[224:227], v2 offset:0
    ds_read_b128 a[228:231], v2 offset:1024
    ds_read_b128 a[232:235], v2 offset:2048
    ds_read_b128 a[236:239], v2 offset:3072
    s_waitcnt lgkmcnt(0)
    ds_read_b128 a[240:243], v2 offset:4096
    ds_read_b128 a[244:247], v2 offset:5120
    ds_read_b128 a[248:251], v2 offset:6144
    ds_read_b128 a[252:255], v2 offset:7168
    v_mul_f32 v176, s16, v208
    v_mul_f32 v177, s16, v209
    v_mul_f32 v178, s16, v210
    v_mul_f32 v179, s16, v211
    s_nop 1
    v_mfma_f32_16x16x32_bf16 v[240:243], a[224:227], v[128:131], v[176:179]
    v_mfma_f32_16x16x32_bf16 v[240:243], a[228:231], v[160:163], v[240:243]
    v_mfma_f32_16x16x32_bf16 v[240:243], a[232:235], v[192:195], v[240:243]
    v_mfma_f32_16x16x32_bf16 v[240:243], a[236:239], v[224:227], v[240:243]
    v_mfma_f32_16x16x32_bf16 v[244:247], a[224:227], v[132:135], 0
    v_mfma_f32_16x16x32_bf16 v[244:247], a[228:231], v[164:167], v[244:247]
    v_mfma_f32_16x16x32_bf16 v[244:247], a[232:235], v[196:199], v[244:247]
    v_mfma_f32_16x16x32_bf16 v[244:247], a[236:239], v[228:231], v[244:247]
    v_mfma_f32_16x16x32_bf16 v[248:251], a[224:227], v[136:139], 0
    v_mfma_f32_16x16x32_bf16 v[248:251], a[228:231], v[168:171], v[248:251]
    v_mfma_f32_16x16x32_bf16 v[248:251], a[232:235], v[200:203], v[248:251]
    v_mfma_f32_16x16x32_bf16 v[248:251], a[236:239], v[232:235], v[248:251]
    v_mfma_f32_16x16x32_bf16 v[252:255], a[224:227], v[140:143], 0
    v_mfma_f32_16x16x32_bf16 v[252:255], a[228:231], v[172:175], v[252:255]
    v_mfma_f32_16x16x32_bf16 v[252:255], a[232:235], v[204:207], v[252:255]
    v_mfma_f32_16x16x32_bf16 v[252:255], a[236:239], v[236:239], v[252:255]
    v_add_f32 v240, v240, v144
    v_exp_f32 v240, v240
    v_add_f32 v241, v241, v144
    v_exp_f32 v241, v241
    v_add_f32 v242, v242, v144
    v_exp_f32 v242, v242
    v_add_f32 v243, v243, v144
    v_exp_f32 v243, v243
    v_add_f32 v244, v244, v148
    v_exp_f32 v244, v244
    v_add_f32 v245, v245, v148
    v_exp_f32 v245, v245
    v_add_f32 v246, v246, v148
    v_exp_f32 v246, v246
    v_add_f32 v247, v247, v148
    v_exp_f32 v247, v247
    v_add_f32 v248, v248, v152
    v_exp_f32 v248, v248
    v_add_f32 v249, v249, v152
    v_exp_f32 v249, v249
    v_add_f32 v250, v250, v152
    v_exp_f32 v250, v250
    v_add_f32 v251, v251, v152
    v_exp_f32 v251, v251
    v_add_f32 v252, v252, v156
    v_exp_f32 v252, v252
    v_add_f32 v253, v253, v156
    v_exp_f32 v253, v253
    v_add_f32 v254, v254, v156
    v_exp_f32 v254, v254
    v_add_f32 v255, v255, v156
    v_exp_f32 v255, v255
    s_nop 1
    s_branch K1_ATT
SPIN_WA:
    s_mov_b32 s94, 0
SPIN_WA_L:
    s_sleep 2
    buffer_load_dword v7, v9, s[44:47], s69 offen sc1
    s_add_u32 s94, s94, 1
    s_cmp_ge_u32 s94, 0x40000
    s_waitcnt vmcnt(0)
    s_cbranch_scc1 BACK_WA
    v_cmp_gt_u32 vcc, 8, v7
    s_nop 1
    s_and_b64 vcc, vcc, s[86:87]
    s_cbranch_scc1 SPIN_WA_L
    s_branch BACK_WA
SPIN_KV:
    s_mov_b32 s94, 0
SPIN_KV_L:
    s_sleep 2
    buffer_load_dword v7, v8, s[32:35], s61 offen sc1
    s_add_u32 s94, s94, 1
    s_cmp_ge_u32 s94, 0x40000
    s_waitcnt vmcnt(0)
    s_cbranch_scc1 BACK_KV
    v_cmp_gt_u32 vcc, 1, v7
    s_nop 1
    s_and_b64 vcc, vcc, exec
    s_cbranch_scc1 SPIN_KV_L
    s_branch BACK_KV
SPIN_SHORT:
    s_mov_b32 s94, 0
SPIN_SHORT_L:
    s_sleep 2
    buffer_load_dword v3, v217, s[32:35], s19 offen sc1
    s_add_u32 s94, s94, 1
    s_cmp_ge_u32 s94, 0x40000
    s_waitcnt vmcnt(0)
    s_cbranch_scc1 BACK_SHORT
    v_cmp_gt_u32 vcc, 1, v3
    s_nop 1
    s_and_b64 vcc, vcc, exec
    s_cbranch_scc1 SPIN_SHORT_L
    s_branch BACK_SHORT
SPIN_CTX:
    s_mov_b32 s94, 0
SPIN_CTX_L:
    s_sleep 2
    buffer_load_dword v3, v217, s[32:35], s19 offen sc1
    s_add_u32 s94, s94, 1
    s_cmp_ge_u32 s94, 0x40000
    s_waitcnt vmcnt(0)
    s_cbranch_scc1 BACK_CTX
    v_cmp_gt_u32 vcc, 2, v3
    s_nop 1
    s_and_b64 vcc, vcc, exec
    s_cbranch_scc1 SPIN_CTX_L
    s_branch BACK_CTX
SPIN_ALL:
    s_mov_b32 s94, 0
SPIN_ALL_L:
    s_sleep 2
    buffer_load_dword v28, v29, s[32:35], s92 offen sc1
    s_add_u32 s94, s94, 1
    s_cmp_ge_u32 s94, 0x40000
    s_waitcnt vmcnt(0)
    s_cbranch_scc1 BACK_ALL
    v_cmp_gt_u32 vcc, 1, v28
    s_nop 1
    s_and_b64 vcc, vcc, exec
    s_cbranch_scc1 SPIN_ALL_L
    s_branch BACK_ALL
SPIN_OA:
    s_mov_b32 s94, 0
SPIN_OA_L:
    s_sleep 2
    buffer_load_dword v3, v19, s[32:35], s66 offen sc1
    s_add_u32 s94, s94, 1
    s_cmp_ge_u32 s94, 0x40000
    s_waitcnt vmcnt(0)
    s_cbranch_scc1 BACK_OA
    v_cmp_gt_u32 vcc, 3, v3
    s_nop 1
    s_and_b64 vcc, vcc, exec
    s_cbranch_scc1 SPIN_OA_L
    s_branch BACK_OA
SPIN_X:
    s_mov_b32 s94, 0
SPIN_X_L:
    s_sleep 2
    buffer_load_dword v3, v19, s[32:35], s66 offen sc1
    s_add_u32 s94, s94, 1
    s_cmp_ge_u32 s94, 0x40000
    s_waitcnt vmcnt(0)
    s_cbranch_scc1 BACK_X
    v_cmp_gt_u32 vcc, 3, v3
    s_nop 1
    s_and_b64 vcc, vcc, exec
    s_cbranch_scc1 SPIN_X_L
    s_branch BACK_X
SPIN_W0:
    s_mov_b32 s94, 0
SPIN_W0_L:
    s_sleep 2
    buffer_load_dword v3, v29, s[32:35], s92 offen sc1
    s_add_u32 s94, s94, 1
    s_cmp_ge_u32 s94, 0x40000
    s_waitcnt vmcnt(0)
    s_cbranch_scc1 BACK_W0
    v_cmp_gt_u32 vcc, 1, v3
    s_nop 1
    s_cmp_lg_u32 vcc_lo, 0
    s_cbranch_scc1 SPIN_W0_L
    s_branch BACK_W0
SPIN_W7:
    s_mov_b32 s94, 0
SPIN_W7_L:
    s_sleep 2
    buffer_load_dword v3, v29, s[32:35], s92 offen sc1
    s_add_u32 s94, s94, 1
    s_cmp_ge_u32 s94, 0x40000
    s_waitcnt vmcnt(0)
    s_cbranch_scc1 BACK_W7
    v_cmp_gt_u32 vcc, 1, v3
    s_nop 1
    s_cmp_lg_u32 vcc_lo, 0
    s_cbranch_scc1 SPIN_W7_L
    s_branch BACK_W7
.section .rodata,"a"
.p2align 6
.amdhsa_kernel gated_mix__sliding_local_dilated__compressed_kv_cla__prompt_kernel
.amdhsa_next_free_vgpr 512
.amdhsa_next_free_sgpr 102
.amdhsa_accum_offset 256
.amdhsa_group_segment_fixed_size 0
.amdhsa_kernarg_size 104
.amdhsa_user_sgpr_count 2
.amdhsa_user_sgpr_kernarg_segment_ptr 1
.amdhsa_system_sgpr_workgroup_id_x 1
.amdhsa_ieee_mode 0
.amdhsa_dx10_clamp 0
.end_amdhsa_kernel
```

```asm
; @launch grid=(256,1,1) block=(256,1,1) lds=163840
.amdgcn_target "amdgcn-amd-amdhsa--gfx950"
.text
.globl gated_mix__sliding_local_dilated__compressed_kv_cla__prompt_kernel
.p2align 8
.type gated_mix__sliding_local_dilated__compressed_kv_cla__prompt_kernel,@function
gated_mix__sliding_local_dilated__compressed_kv_cla__prompt_kernel:
    s_cmp_ge_u32 s2, 256
    s_cbranch_scc1 K1_END
    s_getpc_b64 s[94:95]
    s_load_dwordx8 s[36:43], s[0:1], 32
    v_min_u32 v74, 16, v0
    s_lshr_b32 s7, s2, 3
    s_mul_i32 s7, s7, 17
    v_add_lshl_u32 v74, v74, s7, 7
    global_load_dword v76, v74, s[94:95]
    v_lshrrev_b32 v64, 6, v0
    v_and_b32 v31, 63, v0
    v_readfirstlane_b32 s4, v64
    s_and_b32 s5, s2, 7
    s_lshl_b32 s5, s5, 2
    s_bfe_u32 s7, s2, 0x20003
    s_add_u32 s5, s5, s7
    s_lshr_b32 s6, s2, 5
    s_lshl_b32 s69, s4, 12
    s_mov_b32 s10, 2097152
    s_mov_b32 s11, 0x20000
    s_mov_b32 s14, 4194304
    s_mov_b32 s15, 0x20000
    s_mov_b32 s18, 4194304
    s_mov_b32 s19, 0x20000
    v_lshrrev_b32 v65, 3, v31
    v_and_b32 v66, 7, v31
    v_lshrrev_b32 v67, 1, v65
    v_xor_b32 v66, v66, v67
    v_lshlrev_b32 v66, 4, v66
    v_xor_b32 v67, 64, v66
    s_lshr_b32 s7, s4, 1
    s_lshl_b32 s73, s7, 7
    s_and_b32 s100, s4, 1
    s_lshl_b32 s98, s100, 5
    s_add_u32 s98, s98, s73
    v_add_lshl_u32 v68, v65, s98, 10
    v_add_u32 v6, v68, v66
    v_add_u32 v7, v68, v67
    v_add_u32 v7, 7168, v7
    v_add_u32 v8, v68, v66
    v_add_u32 v8, 14336, v8
    v_add_u32 v9, v68, v67
    v_add_u32 v9, 21504, v9
    v_lshrrev_b32 v69, 4, v31
    v_and_b32 v70, 15, v31
    v_lshlrev_b32 v71, 1, v69
    v_xor_b32 v71, v71, v70
    v_lshlrev_b32 v71, 4, v71
    v_xor_b32 v72, 128, v71
    s_lshl_b32 s98, s4, 4
    v_add_lshl_u32 v73, v69, s98, 13
    v_add_u32 v2, v73, v71
    v_add_u32 v3, v73, v71
    v_add_u32 v3, 31744, v3
    v_add_u32 v4, v73, v72
    v_add_u32 v4, 63488, v4
    v_add_u32 v5, v73, v72
    v_add_u32 v5, 95232, v5
    s_and_b32 s3, s2, 0
    s_lshl_b32 s66, s3, 7
    s_lshl_b32 s60, s3, 11
    s_add_u32 s60, s60, s5
    s_lshl_b32 s60, s60, 8
    s_lshl_b32 s61, s6, 18
    s_add_u32 s61, s61, s66
    s_add_u32 s62, s61, 65536
    s_waitcnt lgkmcnt(0)
    s_mov_b64 s[8:9], s[36:37]
    s_mov_b64 s[24:25], s[38:39]
    s_mov_b64 s[12:13], s[40:41]
    s_mov_b64 s[16:17], s[42:43]
    s_load_dwordx2 s[20:21], s[0:1], 0
    s_load_dwordx2 s[28:29], s[0:1], 8
    s_load_dwordx2 s[32:33], s[0:1], 72
    s_load_dwordx2 s[48:49], s[0:1], 64
    s_load_dwordx2 s[92:93], s[0:1], 16
    s_load_dwordx2 s[44:45], s[0:1], 88
    s_load_dwordx2 s[56:57], s[0:1], 96
    s_load_dwordx2 s[0:1], s[0:1], 80
    s_add_u32 m0, s69, 0
    s_nop 0
    buffer_load_dwordx4 v6, s[8:11], s61 offen lds
    buffer_load_dwordx4 v7, s[8:11], s61 offen offset:1024 lds
    buffer_load_dwordx4 v8, s[8:11], s61 offen offset:2048 lds
    buffer_load_dwordx4 v9, s[8:11], s61 offen offset:3072 lds
    s_xor_b32 s61, s61, 128
    s_add_u32 m0, s69, 16384
    s_nop 0
    buffer_load_dwordx4 v6, s[8:11], s62 offen lds
    buffer_load_dwordx4 v7, s[8:11], s62 offen offset:1024 lds
    buffer_load_dwordx4 v8, s[8:11], s62 offen offset:2048 lds
    buffer_load_dwordx4 v9, s[8:11], s62 offen offset:3072 lds
    s_xor_b32 s62, s62, 128
    s_add_u32 m0, s69, 32768
    s_nop 0
    buffer_load_dwordx4 v2, s[12:15], s60 offen nt lds
    buffer_load_dwordx4 v3, s[12:15], s60 offen offset:1024 nt lds
    buffer_load_dwordx4 v4, s[12:15], s60 offen offset:2048 nt lds
    buffer_load_dwordx4 v5, s[12:15], s60 offen offset:3072 nt lds
    s_add_u32 m0, s69, 49152
    s_nop 0
    buffer_load_dwordx4 v6, s[8:11], s61 offen lds
    buffer_load_dwordx4 v7, s[8:11], s61 offen offset:1024 lds
    buffer_load_dwordx4 v8, s[8:11], s61 offen offset:2048 lds
    buffer_load_dwordx4 v9, s[8:11], s61 offen offset:3072 lds
    s_xor_b32 s61, s61, 384
    v_min_u32 v74, 15, v31
    s_lshl2_add_u32 s98, s2, s4
    s_lshl_b32 s98, s98, 11
    v_lshlrev_b32 v74, 7, v74
    buffer_load_dword v117, v74, s[8:11], s98 offen
    s_waitcnt lgkmcnt(0)
    s_mov_b32 s22, 2359296
    s_mov_b32 s23, 0x20000
    s_mov_b32 s26, 4718592
    s_mov_b32 s27, 0x20000
    s_mov_b32 s50, 4718592
    s_mov_b32 s51, 0x20000
    s_mov_b32 s46, 256
    s_mov_b32 s47, 0x20000
    s_mov_b32 s30, 1990656
    s_mov_b32 s31, 0x20000
    s_mov_b32 s34, 1152
    s_mov_b32 s35, 0x20000
    s_mul_i32 s7, s5, 1081344
    s_add_u32 s36, s56, s7
    s_addc_u32 s37, s57, 0
    s_mov_b32 s38, 1081344
    s_mov_b32 s39, 0x20000
    s_cmp_eq_u32 s4, 0
    s_cselect_b32 s86, 0x55555555, 0
    s_cselect_b32 s87, 0x55555555, 0
    s_cselect_b32 s52, s48, s92
    s_cselect_b32 s53, s49, s93
    s_cselect_b32 s54, s50, 663552
    s_mov_b32 s55, 0x20000
    s_mul_i32 s63, s6, 147456
    s_sub_u32 s64, 2211840, s63
    s_add_u32 s63, s63, s66
    s_add_u32 s64, s64, s66
    s_lshl_b32 s67, s4, 11
    s_lshl_b32 s68, s4, 10
    s_lshl_b32 s75, s4, 13
    s_lshl_b32 s65, s3, 13
    s_add_u32 s65, s65, s67
    s_lshl_b32 s70, s6, 2
    s_lshl1_add_u32 s70, s100, s70
    s_lshl_b32 s70, s70, 15
    s_lshl_b32 s98, s73, 6
    s_add_u32 s71, s70, s98
    s_add_u32 s71, s71, 49152
    s_lshl_b32 s98, s73, 4
    s_add_u32 s70, s70, s98
    v_lshlrev_b32 v1, 4, v31
    v_mov_b32 v77, 1073741824
    v_cmp_eq_u32 vcc, 0, v0
    s_nop 1
    v_cndmask_b32_e64 v30, v77, 0, vcc
    v_lshlrev_b32 v103, 7, v31
    v_cmp_gt_u32 vcc, 9, v31
    s_nop 1
    v_cndmask_b32 v103, v77, v103, vcc
    s_lshl_b32 s98, s4, 5
    v_add_u32 v68, s98, v65
    v_mul_u32_u24 v68, 1152, v68
    v_add_u32 v10, v68, v66
    v_add_u32 v11, v68, v67
    v_add_u32 v11, 8192, v11
    v_add_u32 v12, v68, v66
    v_add_u32 v12, 16384, v12
    v_add_u32 v13, v68, v67
    v_add_u32 v13, 24576, v13
    s_sub_u32 s98, 15, s6
    s_cmp_eq_u32 s73, 0
    s_cselect_b32 s98, s6, s98
    s_lshl_b32 s98, s98, 7
    s_sub_u32 s98, s98, 16
    s_max_i32 s98, s98, 0
    s_lshl3_add_u32 s98, s100, s98
    v_add_u32 v68, s98, v65
    v_mul_u32_u24 v68, 1152, v68
    s_lshl_b32 s98, s100, 6
    v_xor_b32 v73, s98, v66
    v_add_u32 v96, v68, v73
    s_add_u32 m0, s69, 65536
    s_nop 0
    buffer_load_dwordx4 v2, s[16:19], s60 offen nt lds
    v_lshrrev_b32 v71, 1, v70
    v_xor_b32 v71, v71, v69
    v_lshlrev_b32 v71, 4, v71
    v_lshl_add_u32 v71, v70, 7, v71
    v_xor_b32 v72, 64, v71
    s_lshl_b32 s98, s100, 13
    v_add_u32 v22, s98, v71
    v_add_u32 v23, s98, v72
    v_add_u32 v24, s67, v71
    v_add_u32 v25, s67, v72
    s_lshl_b32 s98, s100, 11
    s_add_u32 s98, s98, 8192
    v_add_u32 v100, s98, v71
    v_add_u32 v101, s98, v72
    v_bfe_u32 v73, v31, 2, 2
    v_and_b32 v74, 3, v31
    v_lshl_add_u32 v75, v69, 3, v73
    v_and_b32 v78, 1, v69
    buffer_load_dwordx4 v3, s[16:19], s60 offen offset:1024 nt lds
    v_lshl_add_u32 v77, v78, 2, v73
    v_lshlrev_b32 v77, 5, v77
    v_lshl_add_u32 v77, v74, 3, v77
    v_lshl_add_u32 v77, v75, 8, v77
    v_xor_b32 v14, 0, v77
    v_xor_b32 v14, s73, v14
    v_xor_b32 v15, 32, v77
    v_xor_b32 v15, s73, v15
    v_xor_b32 v16, 64, v77
    v_xor_b32 v16, s73, v16
    v_xor_b32 v17, 96, v77
    v_xor_b32 v17, s73, v17
    v_xor_b32 v18, 128, v77
    v_xor_b32 v19, 160, v77
    v_xor_b32 v20, 192, v77
    v_xor_b32 v21, 224, v77
    v_lshrrev_b32 v77, 1, v73
    v_lshl_add_u32 v77, v78, 1, v77
    buffer_load_dwordx4 v4, s[16:19], s60 offen offset:2048 nt lds
    v_lshlrev_b32 v77, 5, v77
    v_lshl_add_u32 v77, v74, 3, v77
    v_lshl_add_u32 v77, v75, 7, v77
    s_lshr_b32 s98, s73, 1
    v_xor_b32 v26, 0, v77
    v_xor_b32 v26, s98, v26
    v_xor_b32 v27, 32, v77
    v_xor_b32 v28, 64, v77
    v_xor_b32 v28, s98, v28
    v_xor_b32 v29, 96, v77
    v_and_b32 v73, 7, v0
    v_lshrrev_b32 v74, 3, v0
    v_lshl_add_u32 v75, v73, 1, 0
    v_mul_u32_u24 v78, 52, v75
    v_lshrrev_b32 v78, 8, v78
    v_mul_u32_u24 v79, 5, v78
    v_sub_u32 v75, v75, v79
    v_add_u32 v78, 1, v78
    buffer_load_dwordx4 v5, s[16:19], s60 offen offset:3072 nt lds
    s_xor_b32 s60, s60, 524288
    v_cmp_le_u32 vcc, 3, v78
    s_nop 1
    v_cndmask_b32_e64 v78, v78, 0, vcc
    v_mul_u32_u24 v78, 1152, v78
    v_lshl_add_u32 v75, v75, 3, v78
    v_mad_u32_u24 v75, v74, 36, v75
    v_lshl_add_u32 v77, v73, 1, 1
    v_mul_u32_u24 v78, 52, v77
    v_lshrrev_b32 v78, 8, v78
    v_mul_u32_u24 v79, 5, v78
    v_sub_u32 v77, v77, v79
    v_add_u32 v78, 1, v78
    v_cmp_le_u32 vcc, 3, v78
    s_nop 1
    v_cndmask_b32_e64 v78, v78, 0, vcc
    v_mul_u32_u24 v78, 1152, v78
    v_lshl_add_u32 v77, v77, 3, v78
    v_mad_u32_u24 v77, v74, 36, v77
    s_mul_i32 s98, s2, 10368
    s_mul_i32 s99, s2, 6
    s_mov_b32 s7, 73728
    v_mul_lo_u32 v95, v74, s7
    v_lshl_add_u32 v95, v73, 4, v95
    v_cmp_eq_u32 s[92:93], 7, v73
    s_add_u32 s56, s56, 56623104
    s_addc_u32 s57, s57, 0
    s_mov_b32 s58, 5603328
    s_mov_b32 s59, 0x20000
    s_lshl_b32 s101, s6, 5
    s_add_u32 s101, s101, s5
    s_lshl_b32 s101, s101, 7
    v_mov_b32 v65, 0
    v_lshrrev_b32 v64, 2, v0
    v_lshlrev_b32 v64, 15, v64
    v_and_b32 v79, 3, v0
    v_lshl_add_u32 v64, v79, 2, v64
    s_mov_b32 s74, 0x3e0293ee
    s_lshl_b32 s95, s5, 3
    s_waitcnt vmcnt(5)
    s_barrier
    ds_read_b128 a[0:3], v22 offset:0
    ds_read_b64_tr_b16 v[40:41], v14 offset:32768
    ds_read_b64_tr_b16 v[42:43], v14 offset:33792
    ds_read_b128 a[4:7], v23 offset:0
    ds_read_b64_tr_b16 v[44:45], v14 offset:40960
    ds_read_b64_tr_b16 v[46:47], v14 offset:41984
    ds_read_b128 a[8:11], v22 offset:2048
    ds_read_b128 a[12:15], v23 offset:2048
    ds_read_b128 a[16:19], v22 offset:4096
    ds_read_b128 a[20:23], v23 offset:4096
    ds_read_b128 a[24:27], v22 offset:6144
    ds_read_b128 a[28:31], v23 offset:6144
    ds_read_b128 a[32:35], v22 offset:16384
    ds_read_b128 a[36:39], v23 offset:16384
    ds_read_b128 a[40:43], v22 offset:18432
    s_waitcnt lgkmcnt(14)
    ds_read_b128 a[44:47], v23 offset:18432
    s_waitcnt lgkmcnt(14)
    ds_read_b128 a[48:51], v22 offset:20480
    s_waitcnt lgkmcnt(14)
    ds_read_b128 a[52:55], v23 offset:20480
    s_waitcnt lgkmcnt(14)
    ds_read_b128 a[56:59], v22 offset:22528
    s_waitcnt lgkmcnt(14)
    ds_read_b128 a[60:63], v23 offset:22528
    v_mfma_f32_16x16x32_bf16 v[128:131], v[40:43], a[0:3], 0
    s_add_u32 m0, s69, 81920
    s_waitcnt lgkmcnt(14)
    ds_read_b64_tr_b16 v[48:49], v15 offset:32768
    s_waitcnt lgkmcnt(14)
    ds_read_b64_tr_b16 v[50:51], v15 offset:33792
    v_mfma_f32_16x16x32_bf16 v[128:131], v[44:47], a[4:7], v[128:131]
    s_mul_i32 s77, s2, 9216
    buffer_load_dwordx4 v6, s[8:11], s62 offen lds
    v_mfma_f32_16x16x32_bf16 v[132:135], v[40:43], a[8:11], 0
    s_mul_i32 s76, s4, 1152
    s_waitcnt lgkmcnt(14)
    ds_read_b128 a[64:67], v22 offset:49152
    s_waitcnt lgkmcnt(13)
    ds_read_b64_tr_b16 v[52:53], v15 offset:40960
    v_mfma_f32_16x16x32_bf16 v[132:135], v[44:47], a[12:15], v[132:135]
    s_add_u32 s77, s77, s76
    ds_read_b64_tr_b16 v[54:55], v15 offset:41984
    s_waitcnt lgkmcnt(10)
    ds_read_b64_tr_b16 v[56:57], v16 offset:32768
    v_mfma_f32_16x16x32_bf16 v[136:139], v[40:43], a[16:19], 0
    s_mul_i32 s76, s4, 1152
    buffer_load_dwordx4 v7, s[8:11], s62 offen offset:1024 lds
    v_mfma_f32_16x16x32_bf16 v[136:139], v[44:47], a[20:23], v[136:139]
    s_mul_i32 s72, s2, 3
    ds_read_b64_tr_b16 v[58:59], v16 offset:33792
    ds_read_b64_tr_b16 v[60:61], v16 offset:40960
    v_mfma_f32_16x16x32_bf16 v[140:143], v[40:43], a[24:27], 0
    s_add_u32 s72, s72, 0
    ds_read_b64_tr_b16 v[62:63], v16 offset:41984
    v_add_u32 v14, 0x10000, v14
    v_mfma_f32_16x16x32_bf16 v[140:143], v[44:47], a[28:31], v[140:143]
    s_mul_i32 s7, s5, 73728
    ds_read_b128 a[68:71], v23 offset:49152
    v_add_u32 v15, 0x10000, v15
    v_mfma_f32_16x16x32_bf16 v[144:147], v[40:43], a[32:35], 0
    s_and_b32 s100, s5, 1
    buffer_load_dwordx4 v8, s[8:11], s62 offen offset:2048 lds
    v_mfma_f32_16x16x32_bf16 v[144:147], v[44:47], a[36:39], v[144:147]
    s_mov_b64 s[84:85], 0
    v_add_u32 v16, 0x10000, v16
    v_mov_b32 v31, 1
    v_mfma_f32_16x16x32_bf16 v[148:151], v[40:43], a[40:43], 0
    s_mov_b32 vcc_lo, 0x84848484
    s_mov_b32 vcc_hi, 0x84848484
    v_add_u32 v18, 0x10000, v18
    s_waitcnt lgkmcnt(2)
    v_mfma_f32_16x16x32_bf16 v[148:151], v[44:47], a[44:47], v[148:151]
    s_mov_b32 s83, 0
    v_add_u32 v19, 0x10000, v19
    v_add_u32 v20, 0x10000, v20
    v_mfma_f32_16x16x32_bf16 v[152:155], v[40:43], a[48:51], 0
    buffer_load_dwordx4 v9, s[8:11], s62 offen offset:3072 lds
    v_mfma_f32_16x16x32_bf16 v[152:155], v[44:47], a[52:55], v[152:155]
    ds_read_b128 a[72:75], v22 offset:51200
    v_add_u32 v21, 0x10000, v21
    v_mfma_f32_16x16x32_bf16 v[156:159], v[40:43], a[56:59], 0
    s_add_u32 m0, s69, 98304
    ds_read_b64_tr_b16 v[40:41], v17 offset:32768
    ds_read_b64_tr_b16 v[42:43], v17 offset:33792
    v_mfma_f32_16x16x32_bf16 v[156:159], v[44:47], a[60:63], v[156:159]
    s_xor_b32 s62, s62, 384
    ds_read_b64_tr_b16 v[44:45], v17 offset:40960
    ds_read_b64_tr_b16 v[46:47], v17 offset:41984
    v_mfma_f32_16x16x32_bf16 v[160:163], v[48:51], a[0:3], 0
    buffer_load_dwordx4 v2, s[12:15], s60 offen nt lds
    v_mfma_f32_16x16x32_bf16 v[160:163], v[52:55], a[4:7], v[160:163]
    v_add_u32 v17, 0x10000, v17
    v_add_u32 v26, 0x10000, v26
    v_mfma_f32_16x16x32_bf16 v[164:167], v[48:51], a[8:11], 0
    ds_read_b128 a[76:79], v23 offset:51200
    v_add_u32 v27, 0x10000, v27
    v_mfma_f32_16x16x32_bf16 v[164:167], v[52:55], a[12:15], v[164:167]
    v_add_u32 v28, 0x10000, v28
    v_add_u32 v29, 0x10000, v29
    v_mfma_f32_16x16x32_bf16 v[168:171], v[48:51], a[16:19], 0
    buffer_load_dwordx4 v3, s[12:15], s60 offen offset:1024 nt lds
    v_mfma_f32_16x16x32_bf16 v[168:171], v[52:55], a[20:23], v[168:171]
    v_bfe_u32 v37, v1, 4, 4
    v_mul_u32_u24 v36, 1152, v37
    v_mfma_f32_16x16x32_bf16 v[172:175], v[48:51], a[24:27], 0
    v_lshrrev_b32 v38, 8, v1
    v_lshl_add_u32 v36, v38, 4, v36
    v_mfma_f32_16x16x32_bf16 v[172:175], v[52:55], a[28:31], v[172:175]
    v_lshrrev_b32 v39, 3, v37
    v_mul_u32_u24 v39, 9152, v39
    v_mfma_f32_16x16x32_bf16 v[176:179], v[48:51], a[32:35], 0
    buffer_load_dwordx4 v4, s[12:15], s60 offen offset:2048 nt lds
    v_mfma_f32_16x16x32_bf16 v[176:179], v[52:55], a[36:39], v[176:179]
    ds_read_b128 a[80:83], v22 offset:53248
    v_mfma_f32_16x16x32_bf16 v[180:183], v[48:51], a[40:43], 0
    v_mfma_f32_16x16x32_bf16 v[180:183], v[52:55], a[44:47], v[180:183]
    v_mfma_f32_16x16x32_bf16 v[184:187], v[48:51], a[48:51], 0
    buffer_load_dwordx4 v5, s[12:15], s60 offen offset:3072 nt lds
    v_mfma_f32_16x16x32_bf16 v[184:187], v[52:55], a[52:55], v[184:187]
    ds_read_b128 a[84:87], v23 offset:53248
    v_mfma_f32_16x16x32_bf16 v[188:191], v[48:51], a[56:59], 0
    s_add_u32 m0, s69, 114688
    v_mfma_f32_16x16x32_bf16 v[188:191], v[52:55], a[60:63], v[188:191]
    v_mfma_f32_16x16x32_bf16 v[192:195], v[56:59], a[0:3], 0
    s_waitcnt lgkmcnt(1)
    buffer_load_dwordx4 v6, s[8:11], s61 offen lds
    v_mfma_f32_16x16x32_bf16 v[192:195], v[60:63], a[4:7], v[192:195]
    v_mfma_f32_16x16x32_bf16 v[196:199], v[56:59], a[8:11], 0
    v_mfma_f32_16x16x32_bf16 v[196:199], v[60:63], a[12:15], v[196:199]
    ds_read_b128 a[88:91], v22 offset:55296
    v_mfma_f32_16x16x32_bf16 v[200:203], v[56:59], a[16:19], 0
    buffer_load_dwordx4 v7, s[8:11], s61 offen offset:1024 lds
    v_mfma_f32_16x16x32_bf16 v[200:203], v[60:63], a[20:23], v[200:203]
    v_mfma_f32_16x16x32_bf16 v[204:207], v[56:59], a[24:27], 0
    v_mfma_f32_16x16x32_bf16 v[204:207], v[60:63], a[28:31], v[204:207]
    v_mfma_f32_16x16x32_bf16 v[208:211], v[56:59], a[32:35], 0
    buffer_load_dwordx4 v8, s[8:11], s61 offen offset:2048 lds
    v_mfma_f32_16x16x32_bf16 v[208:211], v[60:63], a[36:39], v[208:211]
    ds_read_b128 a[92:95], v23 offset:55296
    v_mfma_f32_16x16x32_bf16 v[212:215], v[56:59], a[40:43], 0
    v_mfma_f32_16x16x32_bf16 v[212:215], v[60:63], a[44:47], v[212:215]
    v_mfma_f32_16x16x32_bf16 v[216:219], v[56:59], a[48:51], 0
    buffer_load_dwordx4 v9, s[8:11], s61 offen offset:3072 lds
    v_mfma_f32_16x16x32_bf16 v[216:219], v[60:63], a[52:55], v[216:219]
    v_mfma_f32_16x16x32_bf16 v[220:223], v[56:59], a[56:59], 0
    s_xor_b32 s61, s61, 128
    v_mfma_f32_16x16x32_bf16 v[220:223], v[60:63], a[60:63], v[220:223]
    s_add_u32 m0, s69, 131072
    v_mfma_f32_16x16x32_bf16 v[224:227], v[40:43], a[0:3], 0
    buffer_load_dwordx4 v2, s[16:19], s60 offen nt lds
    v_mfma_f32_16x16x32_bf16 v[224:227], v[44:47], a[4:7], v[224:227]
    v_mfma_f32_16x16x32_bf16 v[228:231], v[40:43], a[8:11], 0
    buffer_load_dword v104, v103, s[20:23], s77 offen
    v_mfma_f32_16x16x32_bf16 v[228:231], v[44:47], a[12:15], v[228:231]
    s_add_u32 s77, s77, 4608
    v_mfma_f32_16x16x32_bf16 v[232:235], v[40:43], a[16:19], 0
    v_mfma_f32_16x16x32_bf16 v[232:235], v[44:47], a[20:23], v[232:235]
    s_waitcnt vmcnt(10)
    s_barrier
    ds_read_b64_tr_b16 v[48:49], v14 offset:0
    v_mfma_f32_16x16x32_bf16 v[236:239], v[40:43], a[24:27], 0
    buffer_load_dwordx4 v3, s[16:19], s60 offen offset:1024 nt lds
    v_mfma_f32_16x16x32_bf16 v[236:239], v[44:47], a[28:31], v[236:239]
    ds_read_b64_tr_b16 v[50:51], v14 offset:1024
    ds_read_b64_tr_b16 v[52:53], v14 offset:8192
    v_mfma_f32_16x16x32_bf16 v[240:243], v[40:43], a[32:35], 0
    ds_read_b64_tr_b16 v[54:55], v14 offset:9216
    ds_read_b64_tr_b16 v[56:57], v15 offset:0
    v_mfma_f32_16x16x32_bf16 v[240:243], v[44:47], a[36:39], v[240:243]
    buffer_load_dwordx4 v4, s[16:19], s60 offen offset:2048 nt lds
    v_mfma_f32_16x16x32_bf16 v[244:247], v[40:43], a[40:43], 0
    ds_read_b64_tr_b16 v[58:59], v15 offset:1024
    ds_read_b64_tr_b16 v[60:61], v15 offset:8192
    v_mfma_f32_16x16x32_bf16 v[244:247], v[44:47], a[44:47], v[244:247]
    ds_read_b64_tr_b16 v[62:63], v15 offset:9216
    v_mfma_f32_16x16x32_bf16 v[248:251], v[40:43], a[48:51], 0
    v_mfma_f32_16x16x32_bf16 v[248:251], v[44:47], a[52:55], v[248:251]
    buffer_load_dwordx4 v5, s[16:19], s60 offen offset:3072 nt lds
    v_mfma_f32_16x16x32_bf16 v[252:255], v[40:43], a[56:59], 0
    ds_read_b64_tr_b16 v[40:41], v16 offset:0
    ds_read_b64_tr_b16 v[42:43], v16 offset:1024
    v_mfma_f32_16x16x32_bf16 v[252:255], v[44:47], a[60:63], v[252:255]
    s_waitcnt lgkmcnt(3)
    ds_read_b64_tr_b16 v[44:45], v16 offset:8192
    ds_read_b64_tr_b16 v[46:47], v16 offset:9216
    v_mfma_f32_16x16x32_bf16 a[128:131], a[0:3], v[48:51], 0
    v_mfma_f32_16x16x32_bf16 a[128:131], a[4:7], v[52:55], a[128:131]
    s_add_u32 m0, s69, 147456
    v_add_u32 v22, 0x10000, v22
    v_mfma_f32_16x16x32_bf16 a[132:135], a[8:11], v[48:51], 0
    s_xor_b32 s60, s60, 1572864
    buffer_load_dwordx4 v6, s[8:11], s62 offen lds
    v_mfma_f32_16x16x32_bf16 a[132:135], a[12:15], v[52:55], a[132:135]
    ds_read_b128 a[96:99], v22 offset:16384
    v_mfma_f32_16x16x32_bf16 a[136:139], a[16:19], v[48:51], 0
    v_mfma_f32_16x16x32_bf16 a[136:139], a[20:23], v[52:55], a[136:139]
    v_mfma_f32_16x16x32_bf16 a[140:143], a[24:27], v[48:51], 0
    buffer_load_dwordx4 v7, s[8:11], s62 offen offset:1024 lds
    v_mfma_f32_16x16x32_bf16 a[140:143], a[28:31], v[52:55], a[140:143]
    v_add_u32 v23, 0x10000, v23
    ds_read_b128 a[100:103], v23 offset:16384
    v_mfma_f32_16x16x32_bf16 a[144:147], a[32:35], v[48:51], 0
    v_mfma_f32_16x16x32_bf16 a[144:147], a[36:39], v[52:55], a[144:147]
    v_mfma_f32_16x16x32_bf16 a[148:151], a[40:43], v[48:51], 0
    v_mfma_f32_16x16x32_bf16 a[148:151], a[44:47], v[52:55], a[148:151]
    buffer_load_dwordx4 v8, s[8:11], s62 offen offset:2048 lds
    v_mfma_f32_16x16x32_bf16 a[152:155], a[48:51], v[48:51], 0
    v_mfma_f32_16x16x32_bf16 a[152:155], a[52:55], v[52:55], a[152:155]
    ds_read_b128 a[104:107], v22 offset:18432
    v_mfma_f32_16x16x32_bf16 a[156:159], a[56:59], v[48:51], 0
    ds_read_b64_tr_b16 v[48:49], v17 offset:0
    ds_read_b64_tr_b16 v[50:51], v17 offset:1024
    v_mfma_f32_16x16x32_bf16 a[156:159], a[60:63], v[52:55], a[156:159]
    buffer_load_dwordx4 v9, s[8:11], s62 offen offset:3072 lds
    v_mfma_f32_16x16x32_bf16 a[160:163], a[0:3], v[56:59], 0
    s_waitcnt lgkmcnt(3)
    ds_read_b64_tr_b16 v[52:53], v17 offset:8192
    ds_read_b64_tr_b16 v[54:55], v17 offset:9216
    v_mfma_f32_16x16x32_bf16 a[160:163], a[4:7], v[60:63], a[160:163]
    v_mfma_f32_16x16x32_bf16 a[164:167], a[8:11], v[56:59], 0
    ds_read_b128 a[108:111], v23 offset:18432
    v_mfma_f32_16x16x32_bf16 a[164:167], a[12:15], v[60:63], a[164:167]
    s_add_u32 m0, s69, 0
    v_mfma_f32_16x16x32_bf16 a[168:171], a[16:19], v[56:59], 0
    s_xor_b32 s62, s62, 128
    buffer_load_dwordx4 v2, s[12:15], s60 offen nt lds
    v_mfma_f32_16x16x32_bf16 a[168:171], a[20:23], v[60:63], a[168:171]
    v_mfma_f32_16x16x32_bf16 a[172:175], a[24:27], v[56:59], 0
    v_mfma_f32_16x16x32_bf16 a[172:175], a[28:31], v[60:63], a[172:175]
    v_mfma_f32_16x16x32_bf16 a[176:179], a[32:35], v[56:59], 0
    buffer_load_dwordx4 v3, s[12:15], s60 offen offset:1024 nt lds
    v_mfma_f32_16x16x32_bf16 a[176:179], a[36:39], v[60:63], a[176:179]
    ds_read_b128 a[112:115], v22 offset:20480
    v_mfma_f32_16x16x32_bf16 a[180:183], a[40:43], v[56:59], 0
    v_mfma_f32_16x16x32_bf16 a[180:183], a[44:47], v[60:63], a[180:183]
    v_mfma_f32_16x16x32_bf16 a[184:187], a[48:51], v[56:59], 0
    v_mfma_f32_16x16x32_bf16 a[184:187], a[52:55], v[60:63], a[184:187]
    buffer_load_dwordx4 v4, s[12:15], s60 offen offset:2048 nt lds
    v_mfma_f32_16x16x32_bf16 a[188:191], a[56:59], v[56:59], 0
    ds_read_b128 a[116:119], v23 offset:20480
    v_mfma_f32_16x16x32_bf16 a[188:191], a[60:63], v[60:63], a[188:191]
    v_mfma_f32_16x16x32_bf16 a[192:195], a[0:3], v[40:43], 0
    v_mfma_f32_16x16x32_bf16 a[192:195], a[4:7], v[44:47], a[192:195]
    buffer_load_dwordx4 v5, s[12:15], s60 offen offset:3072 nt lds
    v_mfma_f32_16x16x32_bf16 a[196:199], a[8:11], v[40:43], 0
    v_mfma_f32_16x16x32_bf16 a[196:199], a[12:15], v[44:47], a[196:199]
    ds_read_b128 a[120:123], v22 offset:22528
    v_mfma_f32_16x16x32_bf16 a[200:203], a[16:19], v[40:43], 0
    v_mfma_f32_16x16x32_bf16 a[200:203], a[20:23], v[44:47], a[200:203]
    s_add_u32 m0, s69, 16384
    v_mfma_f32_16x16x32_bf16 a[204:207], a[24:27], v[40:43], 0
    buffer_load_dwordx4 v6, s[8:11], s61 offen lds
    v_mfma_f32_16x16x32_bf16 a[204:207], a[28:31], v[44:47], a[204:207]
    v_mfma_f32_16x16x32_bf16 a[208:211], a[32:35], v[40:43], 0
    ds_read_b128 a[124:127], v23 offset:22528
    v_mfma_f32_16x16x32_bf16 a[208:211], a[36:39], v[44:47], a[208:211]
    v_mfma_f32_16x16x32_bf16 a[212:215], a[40:43], v[40:43], 0
    buffer_load_dwordx4 v7, s[8:11], s61 offen offset:1024 lds
    v_mfma_f32_16x16x32_bf16 a[212:215], a[44:47], v[44:47], a[212:215]
    v_mfma_f32_16x16x32_bf16 a[216:219], a[48:51], v[40:43], 0
    v_mfma_f32_16x16x32_bf16 a[216:219], a[52:55], v[44:47], a[216:219]
    v_mfma_f32_16x16x32_bf16 a[220:223], a[56:59], v[40:43], 0
    v_mfma_f32_16x16x32_bf16 a[220:223], a[60:63], v[44:47], a[220:223]
    s_waitcnt lgkmcnt(0)
    buffer_load_dwordx4 v8, s[8:11], s61 offen offset:2048 lds
    v_mfma_f32_16x16x32_bf16 a[224:227], a[0:3], v[48:51], 0
    v_mfma_f32_16x16x32_bf16 a[224:227], a[4:7], v[52:55], a[224:227]
    v_mfma_f32_16x16x32_bf16 a[228:231], a[8:11], v[48:51], 0
    v_mfma_f32_16x16x32_bf16 a[228:231], a[12:15], v[52:55], a[228:231]
    buffer_load_dwordx4 v9, s[8:11], s61 offen offset:3072 lds
    v_mfma_f32_16x16x32_bf16 a[232:235], a[16:19], v[48:51], 0
    v_mfma_f32_16x16x32_bf16 a[232:235], a[20:23], v[52:55], a[232:235]
    s_waitcnt vmcnt(8) lgkmcnt(0)
    s_barrier
    ds_read_b64_tr_b16 v[56:57], v14 offset:32768
    v_mfma_f32_16x16x32_bf16 a[236:239], a[24:27], v[48:51], 0
    s_add_u32 m0, s69, 32768
    ds_read_b64_tr_b16 v[58:59], v14 offset:33792
    ds_read_b64_tr_b16 v[60:61], v14 offset:40960
    v_mfma_f32_16x16x32_bf16 a[236:239], a[28:31], v[52:55], a[236:239]
    s_xor_b32 s61, s61, 896
    buffer_load_dwordx4 v2, s[16:19], s60 offen nt lds
    v_mfma_f32_16x16x32_bf16 a[240:243], a[32:35], v[48:51], 0
    ds_read_b64_tr_b16 v[62:63], v14 offset:41984
    ds_read_b64_tr_b16 v[40:41], v15 offset:32768
    v_mfma_f32_16x16x32_bf16 a[240:243], a[36:39], v[52:55], a[240:243]
    ds_read_b64_tr_b16 v[42:43], v15 offset:33792
    ds_read_b64_tr_b16 v[44:45], v15 offset:40960
    v_mfma_f32_16x16x32_bf16 a[244:247], a[40:43], v[48:51], 0
    ds_read_b64_tr_b16 v[46:47], v15 offset:41984
    v_add_u32 v14, 0x10000, v14
    v_mfma_f32_16x16x32_bf16 a[244:247], a[44:47], v[52:55], a[244:247]
    v_add_u32 v15, 0x10000, v15
    v_mfma_f32_16x16x32_bf16 a[248:251], a[48:51], v[48:51], 0
    v_mfma_f32_16x16x32_bf16 a[248:251], a[52:55], v[52:55], a[248:251]
    buffer_load_dwordx4 v3, s[16:19], s60 offen offset:1024 nt lds
    v_mfma_f32_16x16x32_bf16 a[252:255], a[56:59], v[48:51], 0
    ds_read_b64_tr_b16 v[48:49], v16 offset:32768
    ds_read_b64_tr_b16 v[50:51], v16 offset:33792
    v_mfma_f32_16x16x32_bf16 a[252:255], a[60:63], v[52:55], a[252:255]
    s_waitcnt lgkmcnt(2)
    ds_read_b64_tr_b16 v[52:53], v16 offset:40960
    ds_read_b64_tr_b16 v[54:55], v16 offset:41984
    v_mfma_f32_16x16x32_bf16 v[128:131], v[56:59], a[64:67], v[128:131]
    v_add_u32 v16, 0x10000, v16
    v_mfma_f32_16x16x32_bf16 v[128:131], v[60:63], a[68:71], v[128:131]
    v_mfma_f32_16x16x32_bf16 v[132:135], v[56:59], a[72:75], v[132:135]
    ds_read_b128 a[0:3], v22 offset:49152
    v_mfma_f32_16x16x32_bf16 v[132:135], v[60:63], a[76:79], v[132:135]
    v_mfma_f32_16x16x32_bf16 v[136:139], v[56:59], a[80:83], v[136:139]
    v_mfma_f32_16x16x32_bf16 v[136:139], v[60:63], a[84:87], v[136:139]
    buffer_load_dwordx4 v4, s[16:19], s60 offen offset:2048 nt lds
    v_mfma_f32_16x16x32_bf16 v[140:143], v[56:59], a[88:91], v[140:143]
    v_mfma_f32_16x16x32_bf16 v[140:143], v[60:63], a[92:95], v[140:143]
    ds_read_b128 a[4:7], v23 offset:49152
    v_mfma_f32_16x16x32_bf16 v[144:147], v[56:59], a[96:99], v[144:147]
    v_mfma_f32_16x16x32_bf16 v[144:147], v[60:63], a[100:103], v[144:147]
    v_mfma_f32_16x16x32_bf16 v[148:151], v[56:59], a[104:107], v[148:151]
    v_mfma_f32_16x16x32_bf16 v[148:151], v[60:63], a[108:111], v[148:151]
    v_mfma_f32_16x16x32_bf16 v[152:155], v[56:59], a[112:115], v[152:155]
    buffer_load_dwordx4 v5, s[16:19], s60 offen offset:3072 nt lds
    v_mfma_f32_16x16x32_bf16 v[152:155], v[60:63], a[116:119], v[152:155]
    ds_read_b128 a[8:11], v22 offset:51200
    v_mfma_f32_16x16x32_bf16 v[156:159], v[56:59], a[120:123], v[156:159]
    ds_read_b64_tr_b16 v[56:57], v17 offset:32768
    ds_read_b64_tr_b16 v[58:59], v17 offset:33792
    v_mfma_f32_16x16x32_bf16 v[156:159], v[60:63], a[124:127], v[156:159]
    ds_read_b64_tr_b16 v[60:61], v17 offset:40960
    ds_read_b64_tr_b16 v[62:63], v17 offset:41984
    v_mfma_f32_16x16x32_bf16 v[160:163], v[40:43], a[64:67], v[160:163]
    v_add_u32 v17, 0x10000, v17
    v_mfma_f32_16x16x32_bf16 v[160:163], v[44:47], a[68:71], v[160:163]
    v_mfma_f32_16x16x32_bf16 v[164:167], v[40:43], a[72:75], v[164:167]
    ds_read_b128 a[12:15], v23 offset:51200
    v_mfma_f32_16x16x32_bf16 v[164:167], v[44:47], a[76:79], v[164:167]
    s_add_u32 m0, s69, 49152
    v_mfma_f32_16x16x32_bf16 v[168:171], v[40:43], a[80:83], v[168:171]
    s_xor_b32 s60, s60, 524288
    buffer_load_dwordx4 v6, s[8:11], s62 offen lds
    v_mfma_f32_16x16x32_bf16 v[168:171], v[44:47], a[84:87], v[168:171]
    v_mfma_f32_16x16x32_bf16 v[172:175], v[40:43], a[88:91], v[172:175]
    v_mfma_f32_16x16x32_bf16 v[172:175], v[44:47], a[92:95], v[172:175]
    v_mfma_f32_16x16x32_bf16 v[176:179], v[40:43], a[96:99], v[176:179]
    ds_read_b128 a[16:19], v22 offset:53248
    v_mfma_f32_16x16x32_bf16 v[176:179], v[44:47], a[100:103], v[176:179]
    v_mfma_f32_16x16x32_bf16 v[180:183], v[40:43], a[104:107], v[180:183]
    v_mfma_f32_16x16x32_bf16 v[180:183], v[44:47], a[108:111], v[180:183]
    buffer_load_dwordx4 v7, s[8:11], s62 offen offset:1024 lds
    v_mfma_f32_16x16x32_bf16 v[184:187], v[40:43], a[112:115], v[184:187]
    v_mfma_f32_16x16x32_bf16 v[184:187], v[44:47], a[116:119], v[184:187]
    ds_read_b128 a[20:23], v23 offset:53248
    v_mfma_f32_16x16x32_bf16 v[188:191], v[40:43], a[120:123], v[188:191]
    s_waitcnt lgkmcnt(1)
    ds_read_b64_tr_b16 v[40:41], v14 offset:0
    ds_read_b64_tr_b16 v[42:43], v14 offset:1024
    v_mfma_f32_16x16x32_bf16 v[188:191], v[44:47], a[124:127], v[188:191]
    ds_read_b64_tr_b16 v[44:45], v14 offset:8192
    ds_read_b64_tr_b16 v[46:47], v14 offset:9216
    v_mfma_f32_16x16x32_bf16 v[192:195], v[48:51], a[64:67], v[192:195]
    v_add_u32 v14, 0xfffe0000, v14
    v_mfma_f32_16x16x32_bf16 v[192:195], v[52:55], a[68:71], v[192:195]
    v_mfma_f32_16x16x32_bf16 v[196:199], v[48:51], a[72:75], v[196:199]
    v_mfma_f32_16x16x32_bf16 v[196:199], v[52:55], a[76:79], v[196:199]
    buffer_load_dwordx4 v8, s[8:11], s62 offen offset:2048 lds
    v_mfma_f32_16x16x32_bf16 v[200:203], v[48:51], a[80:83], v[200:203]
    ds_read_b128 a[24:27], v22 offset:55296
    v_mfma_f32_16x16x32_bf16 v[200:203], v[52:55], a[84:87], v[200:203]
    v_mfma_f32_16x16x32_bf16 v[204:207], v[48:51], a[88:91], v[204:207]
    v_mfma_f32_16x16x32_bf16 v[204:207], v[52:55], a[92:95], v[204:207]
    v_mfma_f32_16x16x32_bf16 v[208:211], v[48:51], a[96:99], v[208:211]
    ds_read_b128 a[28:31], v23 offset:55296
    v_mfma_f32_16x16x32_bf16 v[208:211], v[52:55], a[100:103], v[208:211]
    v_mfma_f32_16x16x32_bf16 v[212:215], v[48:51], a[104:107], v[212:215]
    buffer_load_dwordx4 v9, s[8:11], s62 offen offset:3072 lds
    v_mfma_f32_16x16x32_bf16 v[212:215], v[52:55], a[108:111], v[212:215]
    v_mfma_f32_16x16x32_bf16 v[216:219], v[48:51], a[112:115], v[216:219]
    v_mfma_f32_16x16x32_bf16 v[216:219], v[52:55], a[116:119], v[216:219]
    v_mfma_f32_16x16x32_bf16 v[220:223], v[48:51], a[120:123], v[220:223]
    ds_read_b64_tr_b16 v[48:49], v15 offset:0
    ds_read_b64_tr_b16 v[50:51], v15 offset:1024
    v_mfma_f32_16x16x32_bf16 v[220:223], v[52:55], a[124:127], v[220:223]
    ds_read_b64_tr_b16 v[52:53], v15 offset:8192
    ds_read_b64_tr_b16 v[54:55], v15 offset:9216
    v_mfma_f32_16x16x32_bf16 v[224:227], v[56:59], a[64:67], v[224:227]
    buffer_load_dwordx2 v[80:81], v75, s[28:31], s98 offen nt
    v_mfma_f32_16x16x32_bf16 v[224:227], v[60:63], a[68:71], v[224:227]
    s_xor_b32 s62, s62, 896
    v_add_u32 v15, 0xfffe0000, v15
    v_mfma_f32_16x16x32_bf16 v[228:231], v[56:59], a[72:75], v[228:231]
    buffer_load_dword v105, v103, s[20:23], s77 offen
    v_mfma_f32_16x16x32_bf16 v[228:231], v[60:63], a[76:79], v[228:231]
    s_mul_i32 s77, s2, 18432
    v_mfma_f32_16x16x32_bf16 v[232:235], v[56:59], a[80:83], v[232:235]
    s_add_u32 s77, s77, s76
    buffer_load_dwordx2 v[82:83], v77, s[28:31], s98 offen nt
    v_mfma_f32_16x16x32_bf16 v[232:235], v[60:63], a[84:87], v[232:235]
    s_add_u32 s98, s98, 3456
    v_mfma_f32_16x16x32_bf16 v[236:239], v[56:59], a[88:91], v[236:239]
    s_add_u32 m0, s69, 65536
    v_mfma_f32_16x16x32_bf16 v[236:239], v[60:63], a[92:95], v[236:239]
    s_mov_b32 s76, 0
    v_mfma_f32_16x16x32_bf16 v[240:243], v[56:59], a[96:99], v[240:243]
    buffer_load_ushort v92, v65, s[32:35], s99 offen offset:0
    v_mfma_f32_16x16x32_bf16 v[240:243], v[60:63], a[100:103], v[240:243]
    v_mfma_f32_16x16x32_bf16 v[244:247], v[56:59], a[104:107], v[244:247]
    v_mfma_f32_16x16x32_bf16 v[244:247], v[60:63], a[108:111], v[244:247]
    v_mfma_f32_16x16x32_bf16 v[248:251], v[56:59], a[112:115], v[248:251]
    buffer_load_dwordx2 v[84:85], v75, s[28:31], s98 offen nt
    v_mfma_f32_16x16x32_bf16 v[248:251], v[60:63], a[116:119], v[248:251]
    v_mfma_f32_16x16x32_bf16 v[252:255], v[56:59], a[120:123], v[252:255]
    ds_read_b64_tr_b16 v[56:57], v16 offset:0
    ds_read_b64_tr_b16 v[58:59], v16 offset:1024
    v_mfma_f32_16x16x32_bf16 v[252:255], v[60:63], a[124:127], v[252:255]
    s_waitcnt lgkmcnt(2)
    ds_read_b64_tr_b16 v[60:61], v16 offset:8192
    ds_read_b64_tr_b16 v[62:63], v16 offset:9216
    v_mfma_f32_16x16x32_bf16 a[128:131], a[64:67], v[40:43], a[128:131]
    buffer_load_dwordx4 v2, s[12:15], s60 offen nt lds
    v_mfma_f32_16x16x32_bf16 a[128:131], a[68:71], v[44:47], a[128:131]
    v_add_u32 v22, 0x10000, v22
    v_add_u32 v16, 0xfffe0000, v16
    v_mfma_f32_16x16x32_bf16 a[132:135], a[72:75], v[40:43], a[132:135]
    ds_read_b128 a[32:35], v22 offset:16384
    v_mfma_f32_16x16x32_bf16 a[132:135], a[76:79], v[44:47], a[132:135]
    v_mfma_f32_16x16x32_bf16 a[136:139], a[80:83], v[40:43], a[136:139]
    buffer_load_dwordx2 v[86:87], v77, s[28:31], s98 offen nt
    v_mfma_f32_16x16x32_bf16 a[136:139], a[84:87], v[44:47], a[136:139]
    s_add_u32 s98, s98, 3456
    v_mfma_f32_16x16x32_bf16 a[140:143], a[88:91], v[40:43], a[140:143]
    v_add_u32 v23, 0x10000, v23
    v_mfma_f32_16x16x32_bf16 a[140:143], a[92:95], v[44:47], a[140:143]
    ds_read_b128 a[36:39], v23 offset:16384
    v_mfma_f32_16x16x32_bf16 a[144:147], a[96:99], v[40:43], a[144:147]
    buffer_load_ushort v93, v65, s[32:35], s99 offen offset:2
    v_mfma_f32_16x16x32_bf16 a[144:147], a[100:103], v[44:47], a[144:147]
    v_mfma_f32_16x16x32_bf16 a[148:151], a[104:107], v[40:43], a[148:151]
    v_mfma_f32_16x16x32_bf16 a[148:151], a[108:111], v[44:47], a[148:151]
    v_mfma_f32_16x16x32_bf16 a[152:155], a[112:115], v[40:43], a[152:155]
    buffer_load_dwordx2 v[88:89], v75, s[28:31], s98 offen nt
    v_mfma_f32_16x16x32_bf16 a[152:155], a[116:119], v[44:47], a[152:155]
    ds_read_b128 a[40:43], v22 offset:18432
    v_mfma_f32_16x16x32_bf16 a[156:159], a[120:123], v[40:43], a[156:159]
    ds_read_b64_tr_b16 v[40:41], v17 offset:0
    ds_read_b64_tr_b16 v[42:43], v17 offset:1024
    v_mfma_f32_16x16x32_bf16 a[156:159], a[124:127], v[44:47], a[156:159]
    ds_read_b64_tr_b16 v[44:45], v17 offset:8192
    ds_read_b64_tr_b16 v[46:47], v17 offset:9216
    v_mfma_f32_16x16x32_bf16 a[160:163], a[64:67], v[48:51], a[160:163]
    buffer_load_dwordx4 v3, s[12:15], s60 offen offset:1024 nt lds
    v_mfma_f32_16x16x32_bf16 a[160:163], a[68:71], v[52:55], a[160:163]
    v_add_u32 v17, 0xfffe0000, v17
    v_mfma_f32_16x16x32_bf16 a[164:167], a[72:75], v[48:51], a[164:167]
    ds_read_b128 a[44:47], v23 offset:18432
    v_mfma_f32_16x16x32_bf16 a[164:167], a[76:79], v[52:55], a[164:167]
    v_mfma_f32_16x16x32_bf16 a[168:171], a[80:83], v[48:51], a[168:171]
    buffer_load_dwordx2 v[90:91], v77, s[28:31], s98 offen nt
    v_mfma_f32_16x16x32_bf16 a[168:171], a[84:87], v[52:55], a[168:171]
    s_add_u32 s98, s98, 3456
    s_add_u32 s28, s56, 6291456
    s_addc_u32 s29, s57, 0
    v_mfma_f32_16x16x32_bf16 a[172:175], a[88:91], v[48:51], a[172:175]
    s_mov_b32 s30, 2359296
    v_mfma_f32_16x16x32_bf16 a[172:175], a[92:95], v[52:55], a[172:175]
    s_bfe_u32 s98, s72, 0x10001
    v_mfma_f32_16x16x32_bf16 a[176:179], a[96:99], v[48:51], a[176:179]
    buffer_load_ushort v94, v65, s[32:35], s99 offen offset:4
    v_mfma_f32_16x16x32_bf16 a[176:179], a[100:103], v[52:55], a[176:179]
    s_add_u32 s32, s56, 9437184
    s_addc_u32 s33, s57, 0
    s_mov_b32 s34, 196608
    v_mfma_f32_16x16x32_bf16 a[180:183], a[104:107], v[48:51], a[180:183]
    s_bfe_u32 s99, s72, 0x10003
    ds_read_b128 a[48:51], v22 offset:20480
    v_mfma_f32_16x16x32_bf16 a[180:183], a[108:111], v[52:55], a[180:183]
    s_lshl1_add_u32 s98, s99, s98
    v_mfma_f32_16x16x32_bf16 a[184:187], a[112:115], v[48:51], a[184:187]
    s_lshl_b32 s98, s98, 5
    buffer_store_dword v65, v64, s[32:35], s101 offen sc1
    v_mfma_f32_16x16x32_bf16 a[184:187], a[116:119], v[52:55], a[184:187]
    s_lshl_b32 s72, s72, 7
    ds_read_b128 a[52:55], v23 offset:20480
    v_mfma_f32_16x16x32_bf16 a[188:191], a[120:123], v[48:51], a[188:191]
    v_mfma_f32_16x16x32_bf16 a[188:191], a[124:127], v[52:55], a[188:191]
    s_waitcnt lgkmcnt(1)
    v_mfma_f32_16x16x32_bf16 a[192:195], a[64:67], v[56:59], a[192:195]
    buffer_load_dwordx4 v4, s[12:15], s60 offen offset:2048 nt lds
    v_mfma_f32_16x16x32_bf16 a[192:195], a[68:71], v[60:63], a[192:195]
    v_mfma_f32_16x16x32_bf16 a[196:199], a[72:75], v[56:59], a[196:199]
    v_mfma_f32_16x16x32_bf16 a[196:199], a[76:79], v[60:63], a[196:199]
    ds_read_b128 a[56:59], v22 offset:22528
    v_mfma_f32_16x16x32_bf16 a[200:203], a[80:83], v[56:59], a[200:203]
    buffer_load_dwordx4 v5, s[12:15], s60 offen offset:3072 nt lds
    v_mfma_f32_16x16x32_bf16 a[200:203], a[84:87], v[60:63], a[200:203]
    s_add_u32 m0, s69, 81920
    v_mfma_f32_16x16x32_bf16 a[204:207], a[88:91], v[56:59], a[204:207]
    v_mfma_f32_16x16x32_bf16 a[204:207], a[92:95], v[60:63], a[204:207]
    v_mfma_f32_16x16x32_bf16 a[208:211], a[96:99], v[56:59], a[208:211]
    buffer_load_dwordx4 v6, s[8:11], s61 offen lds
    v_mfma_f32_16x16x32_bf16 a[208:211], a[100:103], v[60:63], a[208:211]
    ds_read_b128 a[60:63], v23 offset:22528
    v_mfma_f32_16x16x32_bf16 a[212:215], a[104:107], v[56:59], a[212:215]
    v_mfma_f32_16x16x32_bf16 a[212:215], a[108:111], v[60:63], a[212:215]
    v_mfma_f32_16x16x32_bf16 a[216:219], a[112:115], v[56:59], a[216:219]
    buffer_load_dwordx4 v7, s[8:11], s61 offen offset:1024 lds
    v_mfma_f32_16x16x32_bf16 a[216:219], a[116:119], v[60:63], a[216:219]
    v_mfma_f32_16x16x32_bf16 a[220:223], a[120:123], v[56:59], a[220:223]
    v_mfma_f32_16x16x32_bf16 a[220:223], a[124:127], v[60:63], a[220:223]
    v_mfma_f32_16x16x32_bf16 a[224:227], a[64:67], v[40:43], a[224:227]
    buffer_load_dwordx4 v8, s[8:11], s61 offen offset:2048 lds
    v_mfma_f32_16x16x32_bf16 a[224:227], a[68:71], v[44:47], a[224:227]
    v_mfma_f32_16x16x32_bf16 a[228:231], a[72:75], v[40:43], a[228:231]
    v_mfma_f32_16x16x32_bf16 a[228:231], a[76:79], v[44:47], a[228:231]
    v_mfma_f32_16x16x32_bf16 a[232:235], a[80:83], v[40:43], a[232:235]
    buffer_load_dwordx4 v9, s[8:11], s61 offen offset:3072 lds
    v_mfma_f32_16x16x32_bf16 a[232:235], a[84:87], v[44:47], a[232:235]
    s_xor_b32 s61, s61, 128
    s_waitcnt vmcnt(19) lgkmcnt(0)
    s_barrier
    v_mfma_f32_16x16x32_bf16 a[236:239], a[88:91], v[40:43], a[236:239]
    s_add_u32 m0, s69, 98304
    ds_read_b64_tr_b16 v[48:49], v14 offset:0
    ds_read_b64_tr_b16 v[50:51], v14 offset:1024
    v_mfma_f32_16x16x32_bf16 a[236:239], a[92:95], v[44:47], a[236:239]
    ds_read_b64_tr_b16 v[52:53], v14 offset:8192
    ds_read_b64_tr_b16 v[54:55], v14 offset:9216
    v_mfma_f32_16x16x32_bf16 a[240:243], a[96:99], v[40:43], a[240:243]
    buffer_load_dwordx4 v2, s[16:19], s60 offen nt lds
    v_mfma_f32_16x16x32_bf16 a[240:243], a[100:103], v[44:47], a[240:243]
    ds_read_b64_tr_b16 v[56:57], v15 offset:0
    ds_read_b64_tr_b16 v[58:59], v15 offset:1024
    v_mfma_f32_16x16x32_bf16 a[244:247], a[104:107], v[40:43], a[244:247]
    ds_read_b64_tr_b16 v[60:61], v15 offset:8192
    ds_read_b64_tr_b16 v[62:63], v15 offset:9216
    v_mfma_f32_16x16x32_bf16 a[244:247], a[108:111], v[44:47], a[244:247]
    s_cmp_lt_u32 s2, 192
    s_cselect_b32 s72, s72, 1073741824
    v_mfma_f32_16x16x32_bf16 a[248:251], a[112:115], v[40:43], a[248:251]
    v_mfma_f32_16x16x32_bf16 a[248:251], a[116:119], v[44:47], a[248:251]
    buffer_load_dwordx4 v3, s[16:19], s60 offen offset:1024 nt lds
    v_mfma_f32_16x16x32_bf16 a[252:255], a[120:123], v[40:43], a[252:255]
    ds_read_b64_tr_b16 v[40:41], v16 offset:0
    ds_read_b64_tr_b16 v[42:43], v16 offset:1024
    v_mfma_f32_16x16x32_bf16 a[252:255], a[124:127], v[44:47], a[252:255]
    s_waitcnt lgkmcnt(2)
    ds_read_b64_tr_b16 v[44:45], v16 offset:8192
    ds_read_b64_tr_b16 v[46:47], v16 offset:9216
    v_mfma_f32_16x16x32_bf16 v[128:131], v[48:51], a[0:3], v[128:131]
    v_mfma_f32_16x16x32_bf16 v[128:131], v[52:55], a[4:7], v[128:131]
    v_add_u32 v22, 0xfffe0000, v22
    v_mfma_f32_16x16x32_bf16 v[132:135], v[48:51], a[8:11], v[132:135]
    ds_read_b128 a[64:67], v22 offset:16384
    v_mfma_f32_16x16x32_bf16 v[132:135], v[52:55], a[12:15], v[132:135]
    v_mfma_f32_16x16x32_bf16 v[136:139], v[48:51], a[16:19], v[136:139]
    v_mfma_f32_16x16x32_bf16 v[136:139], v[52:55], a[20:23], v[136:139]
    buffer_load_dwordx4 v4, s[16:19], s60 offen offset:2048 nt lds
    v_mfma_f32_16x16x32_bf16 v[140:143], v[48:51], a[24:27], v[140:143]
    v_add_u32 v23, 0xfffe0000, v23
    v_mfma_f32_16x16x32_bf16 v[140:143], v[52:55], a[28:31], v[140:143]
    ds_read_b128 a[68:71], v23 offset:16384
    v_mfma_f32_16x16x32_bf16 v[144:147], v[48:51], a[32:35], v[144:147]
    v_mfma_f32_16x16x32_bf16 v[144:147], v[52:55], a[36:39], v[144:147]
    v_mfma_f32_16x16x32_bf16 v[148:151], v[48:51], a[40:43], v[148:151]
    v_mfma_f32_16x16x32_bf16 v[148:151], v[52:55], a[44:47], v[148:151]
    v_mfma_f32_16x16x32_bf16 v[152:155], v[48:51], a[48:51], v[152:155]
    buffer_load_dwordx4 v5, s[16:19], s60 offen offset:3072 nt lds
    v_mfma_f32_16x16x32_bf16 v[152:155], v[52:55], a[52:55], v[152:155]
    ds_read_b128 a[72:75], v22 offset:18432
    v_mfma_f32_16x16x32_bf16 v[156:159], v[48:51], a[56:59], v[156:159]
    ds_read_b64_tr_b16 v[48:49], v17 offset:0
    ds_read_b64_tr_b16 v[50:51], v17 offset:1024
    v_mfma_f32_16x16x32_bf16 v[156:159], v[52:55], a[60:63], v[156:159]
    ds_read_b64_tr_b16 v[52:53], v17 offset:8192
    ds_read_b64_tr_b16 v[54:55], v17 offset:9216
    v_mfma_f32_16x16x32_bf16 v[160:163], v[56:59], a[0:3], v[160:163]
    v_mfma_f32_16x16x32_bf16 v[160:163], v[60:63], a[4:7], v[160:163]
    v_mfma_f32_16x16x32_bf16 v[164:167], v[56:59], a[8:11], v[164:167]
    ds_read_b128 a[76:79], v23 offset:18432
    v_mfma_f32_16x16x32_bf16 v[164:167], v[60:63], a[12:15], v[164:167]
    s_add_u32 m0, s69, 114688
    v_mfma_f32_16x16x32_bf16 v[168:171], v[56:59], a[16:19], v[168:171]
    s_xor_b32 s60, s60, 3670016
    buffer_load_dwordx4 v6, s[8:11], s62 offen lds
    v_mfma_f32_16x16x32_bf16 v[168:171], v[60:63], a[20:23], v[168:171]
    v_mfma_f32_16x16x32_bf16 v[172:175], v[56:59], a[24:27], v[172:175]
    v_mfma_f32_16x16x32_bf16 v[172:175], v[60:63], a[28:31], v[172:175]
    v_mfma_f32_16x16x32_bf16 v[176:179], v[56:59], a[32:35], v[176:179]
    ds_read_b128 a[80:83], v22 offset:20480
    v_mfma_f32_16x16x32_bf16 v[176:179], v[60:63], a[36:39], v[176:179]
    v_mfma_f32_16x16x32_bf16 v[180:183], v[56:59], a[40:43], v[180:183]
    v_mfma_f32_16x16x32_bf16 v[180:183], v[60:63], a[44:47], v[180:183]
    buffer_load_dwordx4 v7, s[8:11], s62 offen offset:1024 lds
    v_mfma_f32_16x16x32_bf16 v[184:187], v[56:59], a[48:51], v[184:187]
    v_mfma_f32_16x16x32_bf16 v[184:187], v[60:63], a[52:55], v[184:187]
    ds_read_b128 a[84:87], v23 offset:20480
    v_mfma_f32_16x16x32_bf16 v[188:191], v[56:59], a[56:59], v[188:191]
    s_waitcnt lgkmcnt(1)
    ds_read_b64_tr_b16 v[56:57], v14 offset:32768
    ds_read_b64_tr_b16 v[58:59], v14 offset:33792
    v_mfma_f32_16x16x32_bf16 v[188:191], v[60:63], a[60:63], v[188:191]
    ds_read_b64_tr_b16 v[60:61], v14 offset:40960
    ds_read_b64_tr_b16 v[62:63], v14 offset:41984
    v_mfma_f32_16x16x32_bf16 v[192:195], v[40:43], a[0:3], v[192:195]
    v_add_u32 v14, 0x10000, v14
    v_mfma_f32_16x16x32_bf16 v[192:195], v[44:47], a[4:7], v[192:195]
    v_mfma_f32_16x16x32_bf16 v[196:199], v[40:43], a[8:11], v[196:199]
    v_mfma_f32_16x16x32_bf16 v[196:199], v[44:47], a[12:15], v[196:199]
    buffer_load_dwordx4 v8, s[8:11], s62 offen offset:2048 lds
    v_mfma_f32_16x16x32_bf16 v[200:203], v[40:43], a[16:19], v[200:203]
    ds_read_b128 a[88:91], v22 offset:22528
    v_mfma_f32_16x16x32_bf16 v[200:203], v[44:47], a[20:23], v[200:203]
    v_mfma_f32_16x16x32_bf16 v[204:207], v[40:43], a[24:27], v[204:207]
    v_mfma_f32_16x16x32_bf16 v[204:207], v[44:47], a[28:31], v[204:207]
    v_mfma_f32_16x16x32_bf16 v[208:211], v[40:43], a[32:35], v[208:211]
    ds_read_b128 a[92:95], v23 offset:22528
    v_mfma_f32_16x16x32_bf16 v[208:211], v[44:47], a[36:39], v[208:211]
    v_mfma_f32_16x16x32_bf16 v[212:215], v[40:43], a[40:43], v[212:215]
    buffer_load_dwordx4 v9, s[8:11], s62 offen offset:3072 lds
    v_mfma_f32_16x16x32_bf16 v[212:215], v[44:47], a[44:47], v[212:215]
    v_mfma_f32_16x16x32_bf16 v[216:219], v[40:43], a[48:51], v[216:219]
    v_mfma_f32_16x16x32_bf16 v[216:219], v[44:47], a[52:55], v[216:219]
    v_mfma_f32_16x16x32_bf16 v[220:223], v[40:43], a[56:59], v[220:223]
    ds_read_b64_tr_b16 v[40:41], v15 offset:32768
    ds_read_b64_tr_b16 v[42:43], v15 offset:33792
    v_mfma_f32_16x16x32_bf16 v[220:223], v[44:47], a[60:63], v[220:223]
    ds_read_b64_tr_b16 v[44:45], v15 offset:40960
    ds_read_b64_tr_b16 v[46:47], v15 offset:41984
    v_mfma_f32_16x16x32_bf16 v[224:227], v[48:51], a[0:3], v[224:227]
    v_add_u32 v15, 0x10000, v15
    v_mfma_f32_16x16x32_bf16 v[224:227], v[52:55], a[4:7], v[224:227]
    s_xor_b32 s62, s62, 128
    v_mfma_f32_16x16x32_bf16 v[228:231], v[48:51], a[8:11], v[228:231]
    buffer_load_dword v106, v103, s[24:27], s77 offen
    v_mfma_f32_16x16x32_bf16 v[228:231], v[52:55], a[12:15], v[228:231]
    s_add_u32 s77, s77, 4608
    v_mfma_f32_16x16x32_bf16 v[232:235], v[48:51], a[16:19], v[232:235]
    v_mfma_f32_16x16x32_bf16 v[232:235], v[52:55], a[20:23], v[232:235]
    s_add_u32 m0, s69, 131072
    v_mfma_f32_16x16x32_bf16 v[236:239], v[48:51], a[24:27], v[236:239]
    buffer_load_dwordx4 v2, s[12:15], s60 offen nt lds
    v_mfma_f32_16x16x32_bf16 v[236:239], v[52:55], a[28:31], v[236:239]
    v_mfma_f32_16x16x32_bf16 v[240:243], v[48:51], a[32:35], v[240:243]
    v_mfma_f32_16x16x32_bf16 v[240:243], v[52:55], a[36:39], v[240:243]
    v_mfma_f32_16x16x32_bf16 v[244:247], v[48:51], a[40:43], v[244:247]
    v_mfma_f32_16x16x32_bf16 v[244:247], v[52:55], a[44:47], v[244:247]
    v_mfma_f32_16x16x32_bf16 v[248:251], v[48:51], a[48:51], v[248:251]
    v_mfma_f32_16x16x32_bf16 v[248:251], v[52:55], a[52:55], v[248:251]
    buffer_load_dwordx4 v3, s[12:15], s60 offen offset:1024 nt lds
    v_mfma_f32_16x16x32_bf16 v[252:255], v[48:51], a[56:59], v[252:255]
    ds_read_b64_tr_b16 v[48:49], v16 offset:32768
    ds_read_b64_tr_b16 v[50:51], v16 offset:33792
    v_mfma_f32_16x16x32_bf16 v[252:255], v[52:55], a[60:63], v[252:255]
    s_waitcnt lgkmcnt(2)
    ds_read_b64_tr_b16 v[52:53], v16 offset:40960
    ds_read_b64_tr_b16 v[54:55], v16 offset:41984
    v_mfma_f32_16x16x32_bf16 a[128:131], a[0:3], v[56:59], a[128:131]
    v_add_u32 v16, 0x10000, v16
    v_mfma_f32_16x16x32_bf16 a[128:131], a[4:7], v[60:63], a[128:131]
    v_mfma_f32_16x16x32_bf16 a[132:135], a[8:11], v[56:59], a[132:135]
    ds_read_b128 a[96:99], v22 offset:49152
    v_mfma_f32_16x16x32_bf16 a[132:135], a[12:15], v[60:63], a[132:135]
    v_mfma_f32_16x16x32_bf16 a[136:139], a[16:19], v[56:59], a[136:139]
    v_mfma_f32_16x16x32_bf16 a[136:139], a[20:23], v[60:63], a[136:139]
    buffer_load_dwordx4 v4, s[12:15], s60 offen offset:2048 nt lds
    v_mfma_f32_16x16x32_bf16 a[140:143], a[24:27], v[56:59], a[140:143]
    v_mfma_f32_16x16x32_bf16 a[140:143], a[28:31], v[60:63], a[140:143]
    ds_read_b128 a[100:103], v23 offset:49152
    v_mfma_f32_16x16x32_bf16 a[144:147], a[32:35], v[56:59], a[144:147]
    v_mfma_f32_16x16x32_bf16 a[144:147], a[36:39], v[60:63], a[144:147]
    v_mfma_f32_16x16x32_bf16 a[148:151], a[40:43], v[56:59], a[148:151]
    v_mfma_f32_16x16x32_bf16 a[148:151], a[44:47], v[60:63], a[148:151]
    v_mfma_f32_16x16x32_bf16 a[152:155], a[48:51], v[56:59], a[152:155]
    buffer_load_dwordx4 v5, s[12:15], s60 offen offset:3072 nt lds
    v_mfma_f32_16x16x32_bf16 a[152:155], a[52:55], v[60:63], a[152:155]
    ds_read_b128 a[104:107], v22 offset:51200
    v_mfma_f32_16x16x32_bf16 a[156:159], a[56:59], v[56:59], a[156:159]
    ds_read_b64_tr_b16 v[56:57], v17 offset:32768
    ds_read_b64_tr_b16 v[58:59], v17 offset:33792
    v_mfma_f32_16x16x32_bf16 a[156:159], a[60:63], v[60:63], a[156:159]
    ds_read_b64_tr_b16 v[60:61], v17 offset:40960
    ds_read_b64_tr_b16 v[62:63], v17 offset:41984
    v_mfma_f32_16x16x32_bf16 a[160:163], a[0:3], v[40:43], a[160:163]
    v_add_u32 v17, 0x10000, v17
    v_mfma_f32_16x16x32_bf16 a[160:163], a[4:7], v[44:47], a[160:163]
    v_mfma_f32_16x16x32_bf16 a[164:167], a[8:11], v[40:43], a[164:167]
    ds_read_b128 a[108:111], v23 offset:51200
    v_mfma_f32_16x16x32_bf16 a[164:167], a[12:15], v[44:47], a[164:167]
    s_add_u32 m0, s69, 147456
    v_mfma_f32_16x16x32_bf16 a[168:171], a[16:19], v[40:43], a[168:171]
    buffer_load_dwordx4 v6, s[8:11], s61 offen lds
    v_mfma_f32_16x16x32_bf16 a[168:171], a[20:23], v[44:47], a[168:171]
    v_mfma_f32_16x16x32_bf16 a[172:175], a[24:27], v[40:43], a[172:175]
    v_mfma_f32_16x16x32_bf16 a[172:175], a[28:31], v[44:47], a[172:175]
    v_mfma_f32_16x16x32_bf16 a[176:179], a[32:35], v[40:43], a[176:179]
    ds_read_b128 a[112:115], v22 offset:53248
    v_mfma_f32_16x16x32_bf16 a[176:179], a[36:39], v[44:47], a[176:179]
    v_mfma_f32_16x16x32_bf16 a[180:183], a[40:43], v[40:43], a[180:183]
    v_mfma_f32_16x16x32_bf16 a[180:183], a[44:47], v[44:47], a[180:183]
    buffer_load_dwordx4 v7, s[8:11], s61 offen offset:1024 lds
    v_mfma_f32_16x16x32_bf16 a[184:187], a[48:51], v[40:43], a[184:187]
    v_mfma_f32_16x16x32_bf16 a[184:187], a[52:55], v[44:47], a[184:187]
    ds_read_b128 a[116:119], v23 offset:53248
    v_mfma_f32_16x16x32_bf16 a[188:191], a[56:59], v[40:43], a[188:191]
    v_mfma_f32_16x16x32_bf16 a[188:191], a[60:63], v[44:47], a[188:191]
    s_waitcnt lgkmcnt(1)
    v_mfma_f32_16x16x32_bf16 a[192:195], a[0:3], v[48:51], a[192:195]
    v_mfma_f32_16x16x32_bf16 a[192:195], a[4:7], v[52:55], a[192:195]
    v_mfma_f32_16x16x32_bf16 a[196:199], a[8:11], v[48:51], a[196:199]
    v_mfma_f32_16x16x32_bf16 a[196:199], a[12:15], v[52:55], a[196:199]
    buffer_load_dwordx4 v8, s[8:11], s61 offen offset:2048 lds
    v_mfma_f32_16x16x32_bf16 a[200:203], a[16:19], v[48:51], a[200:203]
    ds_read_b128 a[120:123], v22 offset:55296
    v_mfma_f32_16x16x32_bf16 a[200:203], a[20:23], v[52:55], a[200:203]
    v_mfma_f32_16x16x32_bf16 a[204:207], a[24:27], v[48:51], a[204:207]
    v_mfma_f32_16x16x32_bf16 a[204:207], a[28:31], v[52:55], a[204:207]
    v_mfma_f32_16x16x32_bf16 a[208:211], a[32:35], v[48:51], a[208:211]
    ds_read_b128 a[124:127], v23 offset:55296
    v_mfma_f32_16x16x32_bf16 a[208:211], a[36:39], v[52:55], a[208:211]
    v_mfma_f32_16x16x32_bf16 a[212:215], a[40:43], v[48:51], a[212:215]
    buffer_load_dwordx4 v9, s[8:11], s61 offen offset:3072 lds
    v_mfma_f32_16x16x32_bf16 a[212:215], a[44:47], v[52:55], a[212:215]
    v_mfma_f32_16x16x32_bf16 a[216:219], a[48:51], v[48:51], a[216:219]
    v_mfma_f32_16x16x32_bf16 a[216:219], a[52:55], v[52:55], a[216:219]
    v_mfma_f32_16x16x32_bf16 a[220:223], a[56:59], v[48:51], a[220:223]
    v_mfma_f32_16x16x32_bf16 a[220:223], a[60:63], v[52:55], a[220:223]
    v_mfma_f32_16x16x32_bf16 a[224:227], a[0:3], v[56:59], a[224:227]
    v_mfma_f32_16x16x32_bf16 a[224:227], a[4:7], v[60:63], a[224:227]
    s_xor_b32 s61, s61, 384
    v_mfma_f32_16x16x32_bf16 a[228:231], a[8:11], v[56:59], a[228:231]
    v_mfma_f32_16x16x32_bf16 a[228:231], a[12:15], v[60:63], a[228:231]
    v_mfma_f32_16x16x32_bf16 a[232:235], a[16:19], v[56:59], a[232:235]
    v_mfma_f32_16x16x32_bf16 a[232:235], a[20:23], v[60:63], a[232:235]
    s_waitcnt vmcnt(9) lgkmcnt(0)
    s_barrier
    ds_read_b64_tr_b16 v[40:41], v14 offset:0
    v_mfma_f32_16x16x32_bf16 a[236:239], a[24:27], v[56:59], a[236:239]
    s_add_u32 m0, s69, 0
    ds_read_b64_tr_b16 v[42:43], v14 offset:1024
    ds_read_b64_tr_b16 v[44:45], v14 offset:8192
    v_mfma_f32_16x16x32_bf16 a[236:239], a[28:31], v[60:63], a[236:239]
    buffer_load_dwordx4 v2, s[16:19], s60 offen nt lds
    v_mfma_f32_16x16x32_bf16 a[240:243], a[32:35], v[56:59], a[240:243]
    ds_read_b64_tr_b16 v[46:47], v14 offset:9216
    v_cndmask_b32_e64 v83, v83, 0, s[92:93]
    v_mfma_f32_16x16x32_bf16 a[240:243], a[36:39], v[60:63], a[240:243]
    v_cndmask_b32_e64 v81, v81, 0, vcc
    v_cndmask_b32 v82, v82, v92, s[92:93]
    v_mfma_f32_16x16x32_bf16 a[244:247], a[40:43], v[56:59], a[244:247]
    s_mov_b32 vcc_lo, 0x10101010
    s_mov_b32 vcc_hi, 0x10101010
    v_cndmask_b32_e64 v83, v83, 0, vcc
    v_mfma_f32_16x16x32_bf16 a[244:247], a[44:47], v[60:63], a[244:247]
    v_xor_b32 v92, s98, v95
    ds_read_b64_tr_b16 v[48:49], v15 offset:0
    v_mfma_f32_16x16x32_bf16 a[248:251], a[48:51], v[56:59], a[248:251]
    buffer_store_dwordx4 v[80:83], v92, s[28:31], s72 offen sc1
    v_mfma_f32_16x16x32_bf16 a[248:251], a[52:55], v[60:63], a[248:251]
    s_mul_i32 s72, s2, 3
    buffer_load_dwordx4 v3, s[16:19], s60 offen offset:1024 nt lds
    v_mfma_f32_16x16x32_bf16 a[252:255], a[56:59], v[56:59], a[252:255]
    s_add_u32 s72, s72, 1
    ds_read_b64_tr_b16 v[50:51], v15 offset:1024
    ds_read_b64_tr_b16 v[52:53], v15 offset:8192
    v_mfma_f32_16x16x32_bf16 a[252:255], a[60:63], v[60:63], a[252:255]
    s_bfe_u32 s98, s72, 0x10001
    ds_read_b64_tr_b16 v[54:55], v15 offset:9216
    v_cndmask_b32_e64 v87, v87, 0, s[92:93]
    s_waitcnt lgkmcnt(4)
    v_mfma_f32_16x16x32_bf16 v[128:131], v[40:43], a[64:67], v[128:131]
    s_bfe_u32 s99, s72, 0x10003
    v_cndmask_b32 v86, v86, v93, s[92:93]
    v_cndmask_b32_e64 v91, v91, 0, s[92:93]
    v_mfma_f32_16x16x32_bf16 v[128:131], v[44:47], a[68:71], v[128:131]
    s_lshl1_add_u32 s98, s99, s98
    v_add_u32 v22, 0x10000, v22
    v_cndmask_b32 v90, v90, v94, s[92:93]
    v_mfma_f32_16x16x32_bf16 v[132:135], v[40:43], a[72:75], v[132:135]
    s_lshl_b32 s98, s98, 5
    ds_read_b128 a[0:3], v22 offset:16384
    v_xor_b32 v93, s98, v95
    v_mfma_f32_16x16x32_bf16 v[132:135], v[44:47], a[76:79], v[132:135]
    s_mov_b32 vcc_lo, 0x84848484
    s_mov_b32 vcc_hi, 0x84848484
    v_cndmask_b32_e64 v85, v85, 0, vcc
    v_mfma_f32_16x16x32_bf16 v[136:139], v[40:43], a[80:83], v[136:139]
    s_mov_b32 vcc_lo, 0x10101010
    s_mov_b32 vcc_hi, 0x10101010
    v_cndmask_b32_e64 v87, v87, 0, vcc
    v_mfma_f32_16x16x32_bf16 v[136:139], v[44:47], a[84:87], v[136:139]
    s_lshl_b32 s72, s72, 7
    buffer_load_dwordx4 v4, s[16:19], s60 offen offset:2048 nt lds
    v_mfma_f32_16x16x32_bf16 v[140:143], v[40:43], a[88:91], v[140:143]
    v_add_u32 v23, 0x10000, v23
    ds_read_b64_tr_b16 v[56:57], v16 offset:0
    v_mfma_f32_16x16x32_bf16 v[140:143], v[44:47], a[92:95], v[140:143]
    ds_read_b128 a[4:7], v23 offset:16384
    ds_read_b64_tr_b16 v[58:59], v16 offset:1024
    v_mfma_f32_16x16x32_bf16 v[144:147], v[40:43], a[96:99], v[144:147]
    s_cmp_lt_u32 s2, 192
    s_cselect_b32 s72, s72, 1073741824
    ds_read_b64_tr_b16 v[60:61], v16 offset:8192
    v_mfma_f32_16x16x32_bf16 v[144:147], v[44:47], a[100:103], v[144:147]
    buffer_store_dwordx4 v[84:87], v93, s[28:31], s72 offen sc1
    v_mfma_f32_16x16x32_bf16 v[148:151], v[40:43], a[104:107], v[148:151]
    s_mul_i32 s72, s2, 3
    ds_read_b64_tr_b16 v[62:63], v16 offset:9216
    v_mfma_f32_16x16x32_bf16 v[148:151], v[44:47], a[108:111], v[148:151]
    s_add_u32 s72, s72, 2
    v_mfma_f32_16x16x32_bf16 v[152:155], v[40:43], a[112:115], v[152:155]
    s_bfe_u32 s98, s72, 0x10001
    buffer_load_dwordx4 v5, s[16:19], s60 offen offset:3072 nt lds
    v_mfma_f32_16x16x32_bf16 v[152:155], v[44:47], a[116:119], v[152:155]
    s_bfe_u32 s99, s72, 0x10003
    ds_read_b128 a[8:11], v22 offset:18432
    v_mfma_f32_16x16x32_bf16 v[156:159], v[40:43], a[120:123], v[156:159]
    s_mov_b32 vcc_lo, 0x84848484
    s_mov_b32 vcc_hi, 0x84848484
    v_cndmask_b32_e64 v89, v89, 0, vcc
    v_mfma_f32_16x16x32_bf16 v[156:159], v[44:47], a[124:127], v[156:159]
    s_lshl1_add_u32 s98, s99, s98
    ds_read_b64_tr_b16 v[40:41], v17 offset:0
    ds_read_b64_tr_b16 v[42:43], v17 offset:1024
    s_waitcnt lgkmcnt(3)
    v_mfma_f32_16x16x32_bf16 v[160:163], v[48:51], a[64:67], v[160:163]
    s_mov_b32 vcc_lo, 0x10101010
    s_mov_b32 vcc_hi, 0x10101010
    v_cndmask_b32_e64 v91, v91, 0, vcc
    v_mfma_f32_16x16x32_bf16 v[160:163], v[52:55], a[68:71], v[160:163]
    s_lshl_b32 s98, s98, 5
    v_xor_b32 v94, s98, v95
    ds_read_b64_tr_b16 v[44:45], v17 offset:8192
    v_mfma_f32_16x16x32_bf16 v[164:167], v[48:51], a[72:75], v[164:167]
    s_lshl_b32 s72, s72, 7
    ds_read_b128 a[12:15], v23 offset:18432
    ds_read_b64_tr_b16 v[46:47], v17 offset:9216
    v_mfma_f32_16x16x32_bf16 v[164:167], v[52:55], a[76:79], v[164:167]
    s_add_u32 m0, s69, 16384
    v_mfma_f32_16x16x32_bf16 v[168:171], v[48:51], a[80:83], v[168:171]
    s_xor_b32 s60, s60, 524288
    buffer_load_dwordx4 v6, s[8:11], s62 offen lds
    v_mfma_f32_16x16x32_bf16 v[168:171], v[52:55], a[84:87], v[168:171]
    s_cmp_lt_u32 s2, 192
    s_cselect_b32 s72, s72, 1073741824
    v_mfma_f32_16x16x32_bf16 v[172:175], v[48:51], a[88:91], v[172:175]
    s_bfe_u32 s98, s5, 0x20001
    buffer_store_dwordx4 v[88:91], v94, s[28:31], s72 offen sc1
    v_mfma_f32_16x16x32_bf16 v[172:175], v[52:55], a[92:95], v[172:175]
    s_add_u32 s28, s28, s7
    s_addc_u32 s29, s29, 0
    v_mfma_f32_16x16x32_bf16 v[176:179], v[48:51], a[96:99], v[176:179]
    s_mov_b32 s30, 73728
    ds_read_b128 a[16:19], v22 offset:20480
    v_mfma_f32_16x16x32_bf16 v[176:179], v[52:55], a[100:103], v[176:179]
    s_and_b32 s7, s5, 24
    v_mfma_f32_16x16x32_bf16 v[180:183], v[48:51], a[104:107], v[180:183]
    s_add_u32 s7, s7, s6
    v_mfma_f32_16x16x32_bf16 v[180:183], v[52:55], a[108:111], v[180:183]
    s_lshl2_add_u32 s7, s7, s98
    buffer_load_dwordx4 v7, s[8:11], s62 offen offset:1024 lds
    v_mfma_f32_16x16x32_bf16 v[184:187], v[48:51], a[112:115], v[184:187]
    s_mul_i32 s98, s7, 36864
    v_add_u32 v36, s98, v36
    v_sub_u32 v39, v36, v39
    v_mfma_f32_16x16x32_bf16 v[184:187], v[52:55], a[116:119], v[184:187]
    s_lshl2_add_u32 s99, s100, s4
    ds_read_b128 a[20:23], v23 offset:20480
    v_lshl_add_u32 v36, s100, 6, v36
    v_mfma_f32_16x16x32_bf16 v[188:191], v[48:51], a[120:123], v[188:191]
    s_lshl_b32 s99, s99, 7
    ds_read_b64_tr_b16 v[48:49], v14 offset:32768
    ds_read_b64_tr_b16 v[50:51], v14 offset:33792
    v_mfma_f32_16x16x32_bf16 v[188:191], v[52:55], a[124:127], v[188:191]
    ds_read_b64_tr_b16 v[52:53], v14 offset:40960
    ds_read_b64_tr_b16 v[54:55], v14 offset:41984
    v_mfma_f32_16x16x32_bf16 v[192:195], v[56:59], a[64:67], v[192:195]
    v_add_u32 v14, 0x10000, v14
    v_mfma_f32_16x16x32_bf16 v[192:195], v[60:63], a[68:71], v[192:195]
    v_mfma_f32_16x16x32_bf16 v[196:199], v[56:59], a[72:75], v[196:199]
    v_mfma_f32_16x16x32_bf16 v[196:199], v[60:63], a[76:79], v[196:199]
    buffer_load_dwordx4 v8, s[8:11], s62 offen offset:2048 lds
    v_mfma_f32_16x16x32_bf16 v[200:203], v[56:59], a[80:83], v[200:203]
    ds_read_b128 a[24:27], v22 offset:22528
    v_mfma_f32_16x16x32_bf16 v[200:203], v[60:63], a[84:87], v[200:203]
    v_mfma_f32_16x16x32_bf16 v[204:207], v[56:59], a[88:91], v[204:207]
    v_mfma_f32_16x16x32_bf16 v[204:207], v[60:63], a[92:95], v[204:207]
    v_mfma_f32_16x16x32_bf16 v[208:211], v[56:59], a[96:99], v[208:211]
    ds_read_b128 a[28:31], v23 offset:22528
    v_mfma_f32_16x16x32_bf16 v[208:211], v[60:63], a[100:103], v[208:211]
    v_mfma_f32_16x16x32_bf16 v[212:215], v[56:59], a[104:107], v[212:215]
    buffer_load_dwordx4 v9, s[8:11], s62 offen offset:3072 lds
    v_mfma_f32_16x16x32_bf16 v[212:215], v[60:63], a[108:111], v[212:215]
    v_mfma_f32_16x16x32_bf16 v[216:219], v[56:59], a[112:115], v[216:219]
    v_mfma_f32_16x16x32_bf16 v[216:219], v[60:63], a[116:119], v[216:219]
    v_mfma_f32_16x16x32_bf16 v[220:223], v[56:59], a[120:123], v[220:223]
    s_waitcnt lgkmcnt(0)
    ds_read_b64_tr_b16 v[56:57], v15 offset:32768
    ds_read_b64_tr_b16 v[58:59], v15 offset:33792
    v_mfma_f32_16x16x32_bf16 v[220:223], v[60:63], a[124:127], v[220:223]
    ds_read_b64_tr_b16 v[60:61], v15 offset:40960
    ds_read_b64_tr_b16 v[62:63], v15 offset:41984
    v_mfma_f32_16x16x32_bf16 v[224:227], v[40:43], a[64:67], v[224:227]
    v_add_u32 v15, 0x10000, v15
    v_mfma_f32_16x16x32_bf16 v[224:227], v[44:47], a[68:71], v[224:227]
    s_xor_b32 s62, s62, 384
    v_mfma_f32_16x16x32_bf16 v[228:231], v[40:43], a[72:75], v[228:231]
    buffer_load_dword v107, v103, s[24:27], s77 offen
    v_mfma_f32_16x16x32_bf16 v[228:231], v[44:47], a[76:79], v[228:231]
    s_add_u32 s77, s77, 4608
    v_mfma_f32_16x16x32_bf16 v[232:235], v[40:43], a[80:83], v[232:235]
    v_mfma_f32_16x16x32_bf16 v[232:235], v[44:47], a[84:87], v[232:235]
    s_add_u32 m0, s69, 32768
    v_mfma_f32_16x16x32_bf16 v[236:239], v[40:43], a[88:91], v[236:239]
    buffer_load_dwordx4 v2, s[12:15], s60 offen nt lds
    v_mfma_f32_16x16x32_bf16 v[236:239], v[44:47], a[92:95], v[236:239]
    v_mfma_f32_16x16x32_bf16 v[240:243], v[40:43], a[96:99], v[240:243]
    v_mfma_f32_16x16x32_bf16 v[240:243], v[44:47], a[100:103], v[240:243]
    v_mfma_f32_16x16x32_bf16 v[244:247], v[40:43], a[104:107], v[244:247]
    v_mfma_f32_16x16x32_bf16 v[244:247], v[44:47], a[108:111], v[244:247]
    v_mfma_f32_16x16x32_bf16 v[248:251], v[40:43], a[112:115], v[248:251]
    v_mfma_f32_16x16x32_bf16 v[248:251], v[44:47], a[116:119], v[248:251]
    buffer_load_dwordx4 v3, s[12:15], s60 offen offset:1024 nt lds
    v_mfma_f32_16x16x32_bf16 v[252:255], v[40:43], a[120:123], v[252:255]
    ds_read_b64_tr_b16 v[40:41], v16 offset:32768
    ds_read_b64_tr_b16 v[42:43], v16 offset:33792
    v_mfma_f32_16x16x32_bf16 v[252:255], v[44:47], a[124:127], v[252:255]
    ds_read_b64_tr_b16 v[44:45], v16 offset:40960
    ds_read_b64_tr_b16 v[46:47], v16 offset:41984
    v_mfma_f32_16x16x32_bf16 a[128:131], a[64:67], v[48:51], a[128:131]
    v_add_u32 v16, 0x10000, v16
    v_mfma_f32_16x16x32_bf16 a[128:131], a[68:71], v[52:55], a[128:131]
    v_mfma_f32_16x16x32_bf16 a[132:135], a[72:75], v[48:51], a[132:135]
    ds_read_b128 a[32:35], v22 offset:49152
    v_mfma_f32_16x16x32_bf16 a[132:135], a[76:79], v[52:55], a[132:135]
    v_mfma_f32_16x16x32_bf16 a[136:139], a[80:83], v[48:51], a[136:139]
    v_mfma_f32_16x16x32_bf16 a[136:139], a[84:87], v[52:55], a[136:139]
    buffer_load_dwordx4 v4, s[12:15], s60 offen offset:2048 nt lds
    v_mfma_f32_16x16x32_bf16 a[140:143], a[88:91], v[48:51], a[140:143]
    v_mfma_f32_16x16x32_bf16 a[140:143], a[92:95], v[52:55], a[140:143]
    ds_read_b128 a[36:39], v23 offset:49152
    v_mfma_f32_16x16x32_bf16 a[144:147], a[96:99], v[48:51], a[144:147]
    v_mfma_f32_16x16x32_bf16 a[144:147], a[100:103], v[52:55], a[144:147]
    v_mfma_f32_16x16x32_bf16 a[148:151], a[104:107], v[48:51], a[148:151]
    v_mfma_f32_16x16x32_bf16 a[148:151], a[108:111], v[52:55], a[148:151]
    v_mfma_f32_16x16x32_bf16 a[152:155], a[112:115], v[48:51], a[152:155]
    buffer_load_dwordx4 v5, s[12:15], s60 offen offset:3072 nt lds
    v_mfma_f32_16x16x32_bf16 a[152:155], a[116:119], v[52:55], a[152:155]
    ds_read_b128 a[40:43], v22 offset:51200
    v_mfma_f32_16x16x32_bf16 a[156:159], a[120:123], v[48:51], a[156:159]
    ds_read_b64_tr_b16 v[48:49], v17 offset:32768
    ds_read_b64_tr_b16 v[50:51], v17 offset:33792
    v_mfma_f32_16x16x32_bf16 a[156:159], a[124:127], v[52:55], a[156:159]
    s_waitcnt lgkmcnt(3)
    ds_read_b64_tr_b16 v[52:53], v17 offset:40960
    ds_read_b64_tr_b16 v[54:55], v17 offset:41984
    v_mfma_f32_16x16x32_bf16 a[160:163], a[64:67], v[56:59], a[160:163]
    v_add_u32 v17, 0x10000, v17
    v_mfma_f32_16x16x32_bf16 a[160:163], a[68:71], v[60:63], a[160:163]
    v_mfma_f32_16x16x32_bf16 a[164:167], a[72:75], v[56:59], a[164:167]
    ds_read_b128 a[44:47], v23 offset:51200
    v_mfma_f32_16x16x32_bf16 a[164:167], a[76:79], v[60:63], a[164:167]
    s_add_u32 m0, s69, 49152
    v_mfma_f32_16x16x32_bf16 a[168:171], a[80:83], v[56:59], a[168:171]
    buffer_load_dwordx4 v6, s[8:11], s61 offen lds
    v_mfma_f32_16x16x32_bf16 a[168:171], a[84:87], v[60:63], a[168:171]
    v_mfma_f32_16x16x32_bf16 a[172:175], a[88:91], v[56:59], a[172:175]
    v_mfma_f32_16x16x32_bf16 a[172:175], a[92:95], v[60:63], a[172:175]
    v_mfma_f32_16x16x32_bf16 a[176:179], a[96:99], v[56:59], a[176:179]
    ds_read_b128 a[48:51], v22 offset:53248
    v_mfma_f32_16x16x32_bf16 a[176:179], a[100:103], v[60:63], a[176:179]
    v_mfma_f32_16x16x32_bf16 a[180:183], a[104:107], v[56:59], a[180:183]
    v_mfma_f32_16x16x32_bf16 a[180:183], a[108:111], v[60:63], a[180:183]
    buffer_load_dwordx4 v7, s[8:11], s61 offen offset:1024 lds
    v_mfma_f32_16x16x32_bf16 a[184:187], a[112:115], v[56:59], a[184:187]
    v_mfma_f32_16x16x32_bf16 a[184:187], a[116:119], v[60:63], a[184:187]
    ds_read_b128 a[52:55], v23 offset:53248
    v_mfma_f32_16x16x32_bf16 a[188:191], a[120:123], v[56:59], a[188:191]
    v_mfma_f32_16x16x32_bf16 a[188:191], a[124:127], v[60:63], a[188:191]
    v_mfma_f32_16x16x32_bf16 a[192:195], a[64:67], v[40:43], a[192:195]
    v_mfma_f32_16x16x32_bf16 a[192:195], a[68:71], v[44:47], a[192:195]
    v_mfma_f32_16x16x32_bf16 a[196:199], a[72:75], v[40:43], a[196:199]
    v_mfma_f32_16x16x32_bf16 a[196:199], a[76:79], v[44:47], a[196:199]
    buffer_load_dwordx4 v8, s[8:11], s61 offen offset:2048 lds
    v_mfma_f32_16x16x32_bf16 a[200:203], a[80:83], v[40:43], a[200:203]
    ds_read_b128 a[56:59], v22 offset:55296
    v_mfma_f32_16x16x32_bf16 a[200:203], a[84:87], v[44:47], a[200:203]
    v_mfma_f32_16x16x32_bf16 a[204:207], a[88:91], v[40:43], a[204:207]
    v_mfma_f32_16x16x32_bf16 a[204:207], a[92:95], v[44:47], a[204:207]
    v_mfma_f32_16x16x32_bf16 a[208:211], a[96:99], v[40:43], a[208:211]
    ds_read_b128 a[60:63], v23 offset:55296
    v_mfma_f32_16x16x32_bf16 a[208:211], a[100:103], v[44:47], a[208:211]
    v_mfma_f32_16x16x32_bf16 a[212:215], a[104:107], v[40:43], a[212:215]
    buffer_load_dwordx4 v9, s[8:11], s61 offen offset:3072 lds
    v_mfma_f32_16x16x32_bf16 a[212:215], a[108:111], v[44:47], a[212:215]
    v_mfma_f32_16x16x32_bf16 a[216:219], a[112:115], v[40:43], a[216:219]
    v_mfma_f32_16x16x32_bf16 a[216:219], a[116:119], v[44:47], a[216:219]
    v_mfma_f32_16x16x32_bf16 a[220:223], a[120:123], v[40:43], a[220:223]
    v_mfma_f32_16x16x32_bf16 a[220:223], a[124:127], v[44:47], a[220:223]
    s_waitcnt lgkmcnt(0)
    v_mfma_f32_16x16x32_bf16 a[224:227], a[64:67], v[48:51], a[224:227]
    v_mfma_f32_16x16x32_bf16 a[224:227], a[68:71], v[52:55], a[224:227]
    s_xor_b32 s61, s61, 128
    v_mfma_f32_16x16x32_bf16 a[228:231], a[72:75], v[48:51], a[228:231]
    v_mfma_f32_16x16x32_bf16 a[228:231], a[76:79], v[52:55], a[228:231]
    v_mfma_f32_16x16x32_bf16 a[232:235], a[80:83], v[48:51], a[232:235]
    v_mfma_f32_16x16x32_bf16 a[232:235], a[84:87], v[52:55], a[232:235]
    s_waitcnt vmcnt(9) lgkmcnt(0)
    s_barrier
    ds_read_b64_tr_b16 v[56:57], v14 offset:0
    v_mfma_f32_16x16x32_bf16 a[236:239], a[88:91], v[48:51], a[236:239]
    s_add_u32 m0, s69, 65536
    ds_read_b64_tr_b16 v[58:59], v14 offset:1024
    ds_read_b64_tr_b16 v[60:61], v14 offset:8192
    v_mfma_f32_16x16x32_bf16 a[236:239], a[92:95], v[52:55], a[236:239]
    buffer_load_dwordx4 v2, s[16:19], s60 offen nt lds
    v_mfma_f32_16x16x32_bf16 a[240:243], a[96:99], v[48:51], a[240:243]
    ds_read_b64_tr_b16 v[62:63], v14 offset:9216
    ds_read_b64_tr_b16 v[40:41], v15 offset:0
    v_mfma_f32_16x16x32_bf16 a[240:243], a[100:103], v[52:55], a[240:243]
    buffer_atomic_add v31, v30, s[44:47], s95 offen sc1
    v_mfma_f32_16x16x32_bf16 a[244:247], a[104:107], v[48:51], a[244:247]
    ds_read_b64_tr_b16 v[42:43], v15 offset:1024
    ds_read_b64_tr_b16 v[44:45], v15 offset:8192
    v_mfma_f32_16x16x32_bf16 a[244:247], a[108:111], v[52:55], a[244:247]
    ds_read_b64_tr_b16 v[46:47], v15 offset:9216
    v_add_u32 v14, 0xfffe0000, v14
    v_mfma_f32_16x16x32_bf16 a[248:251], a[112:115], v[48:51], a[248:251]
    v_add_u32 v15, 0xfffe0000, v15
    v_mfma_f32_16x16x32_bf16 a[248:251], a[116:119], v[52:55], a[248:251]
    buffer_load_dwordx4 v3, s[16:19], s60 offen offset:1024 nt lds
    v_mfma_f32_16x16x32_bf16 a[252:255], a[120:123], v[48:51], a[252:255]
    ds_read_b64_tr_b16 v[48:49], v16 offset:0
    ds_read_b64_tr_b16 v[50:51], v16 offset:1024
    v_mfma_f32_16x16x32_bf16 a[252:255], a[124:127], v[52:55], a[252:255]
    s_waitcnt lgkmcnt(3)
    ds_read_b64_tr_b16 v[52:53], v16 offset:8192
    ds_read_b64_tr_b16 v[54:55], v16 offset:9216
    v_mfma_f32_16x16x32_bf16 v[128:131], v[56:59], a[0:3], v[128:131]
    v_add_u32 v16, 0xfffe0000, v16
    v_mfma_f32_16x16x32_bf16 v[128:131], v[60:63], a[4:7], v[128:131]
    v_add_u32 v22, 0x10000, v22
    v_mfma_f32_16x16x32_bf16 v[132:135], v[56:59], a[8:11], v[132:135]
    ds_read_b128 a[64:67], v22 offset:16384
    v_mfma_f32_16x16x32_bf16 v[132:135], v[60:63], a[12:15], v[132:135]
    v_mfma_f32_16x16x32_bf16 v[136:139], v[56:59], a[16:19], v[136:139]
    v_mfma_f32_16x16x32_bf16 v[136:139], v[60:63], a[20:23], v[136:139]
    buffer_load_dwordx4 v4, s[16:19], s60 offen offset:2048 nt lds
    v_mfma_f32_16x16x32_bf16 v[140:143], v[56:59], a[24:27], v[140:143]
    v_add_u32 v23, 0x10000, v23
    v_mfma_f32_16x16x32_bf16 v[140:143], v[60:63], a[28:31], v[140:143]
    ds_read_b128 a[68:71], v23 offset:16384
    v_mfma_f32_16x16x32_bf16 v[144:147], v[56:59], a[32:35], v[144:147]
    v_mfma_f32_16x16x32_bf16 v[144:147], v[60:63], a[36:39], v[144:147]
    v_mfma_f32_16x16x32_bf16 v[148:151], v[56:59], a[40:43], v[148:151]
    v_mfma_f32_16x16x32_bf16 v[148:151], v[60:63], a[44:47], v[148:151]
    v_mfma_f32_16x16x32_bf16 v[152:155], v[56:59], a[48:51], v[152:155]
    buffer_load_dwordx4 v5, s[16:19], s60 offen offset:3072 nt lds
    v_mfma_f32_16x16x32_bf16 v[152:155], v[60:63], a[52:55], v[152:155]
    ds_read_b128 a[72:75], v22 offset:18432
    v_mfma_f32_16x16x32_bf16 v[156:159], v[56:59], a[56:59], v[156:159]
    ds_read_b64_tr_b16 v[56:57], v17 offset:0
    ds_read_b64_tr_b16 v[58:59], v17 offset:1024
    v_mfma_f32_16x16x32_bf16 v[156:159], v[60:63], a[60:63], v[156:159]
    ds_read_b64_tr_b16 v[60:61], v17 offset:8192
    ds_read_b64_tr_b16 v[62:63], v17 offset:9216
    v_mfma_f32_16x16x32_bf16 v[160:163], v[40:43], a[0:3], v[160:163]
    s_waitcnt lgkmcnt(5)
    v_add_u32 v17, 0xfffe0000, v17
    v_mfma_f32_16x16x32_bf16 v[160:163], v[44:47], a[4:7], v[160:163]
    v_mfma_f32_16x16x32_bf16 v[164:167], v[40:43], a[8:11], v[164:167]
    ds_read_b128 a[76:79], v23 offset:18432
    v_mfma_f32_16x16x32_bf16 v[164:167], v[44:47], a[12:15], v[164:167]
    s_add_u32 m0, s69, 81920
    v_mfma_f32_16x16x32_bf16 v[168:171], v[40:43], a[16:19], v[168:171]
    s_xor_b32 s60, s60, 1572864
    buffer_load_dwordx4 v6, s[8:11], s62 offen lds
    v_mfma_f32_16x16x32_bf16 v[168:171], v[44:47], a[20:23], v[168:171]
    v_mfma_f32_16x16x32_bf16 v[172:175], v[40:43], a[24:27], v[172:175]
    v_mfma_f32_16x16x32_bf16 v[172:175], v[44:47], a[28:31], v[172:175]
    v_mfma_f32_16x16x32_bf16 v[176:179], v[40:43], a[32:35], v[176:179]
    ds_read_b128 a[80:83], v22 offset:20480
    v_mfma_f32_16x16x32_bf16 v[176:179], v[44:47], a[36:39], v[176:179]
    v_mfma_f32_16x16x32_bf16 v[180:183], v[40:43], a[40:43], v[180:183]
    v_mfma_f32_16x16x32_bf16 v[180:183], v[44:47], a[44:47], v[180:183]
    buffer_load_dwordx4 v7, s[8:11], s62 offen offset:1024 lds
    v_mfma_f32_16x16x32_bf16 v[184:187], v[40:43], a[48:51], v[184:187]
    v_mfma_f32_16x16x32_bf16 v[184:187], v[44:47], a[52:55], v[184:187]
    ds_read_b128 a[84:87], v23 offset:20480
    v_mfma_f32_16x16x32_bf16 v[188:191], v[40:43], a[56:59], v[188:191]
    ds_read_b64_tr_b16 v[40:41], v14 offset:0
    ds_read_b64_tr_b16 v[42:43], v14 offset:1024
    v_mfma_f32_16x16x32_bf16 v[188:191], v[44:47], a[60:63], v[188:191]
    ds_read_b64_tr_b16 v[44:45], v14 offset:8192
    ds_read_b64_tr_b16 v[46:47], v14 offset:9216
    v_mfma_f32_16x16x32_bf16 v[192:195], v[48:51], a[0:3], v[192:195]
    v_mfma_f32_16x16x32_bf16 v[192:195], v[52:55], a[4:7], v[192:195]
    v_mfma_f32_16x16x32_bf16 v[196:199], v[48:51], a[8:11], v[196:199]
    v_mfma_f32_16x16x32_bf16 v[196:199], v[52:55], a[12:15], v[196:199]
    buffer_load_dwordx4 v8, s[8:11], s62 offen offset:2048 lds
    v_mfma_f32_16x16x32_bf16 v[200:203], v[48:51], a[16:19], v[200:203]
    ds_read_b128 a[88:91], v22 offset:22528
    v_mfma_f32_16x16x32_bf16 v[200:203], v[52:55], a[20:23], v[200:203]
    v_mfma_f32_16x16x32_bf16 v[204:207], v[48:51], a[24:27], v[204:207]
    v_mfma_f32_16x16x32_bf16 v[204:207], v[52:55], a[28:31], v[204:207]
    v_mfma_f32_16x16x32_bf16 v[208:211], v[48:51], a[32:35], v[208:211]
    ds_read_b128 a[92:95], v23 offset:22528
    v_mfma_f32_16x16x32_bf16 v[208:211], v[52:55], a[36:39], v[208:211]
    v_mfma_f32_16x16x32_bf16 v[212:215], v[48:51], a[40:43], v[212:215]
    buffer_load_dwordx4 v9, s[8:11], s62 offen offset:3072 lds
    v_mfma_f32_16x16x32_bf16 v[212:215], v[52:55], a[44:47], v[212:215]
    v_mfma_f32_16x16x32_bf16 v[216:219], v[48:51], a[48:51], v[216:219]
    v_mfma_f32_16x16x32_bf16 v[216:219], v[52:55], a[52:55], v[216:219]
    v_mfma_f32_16x16x32_bf16 v[220:223], v[48:51], a[56:59], v[220:223]
    s_waitcnt lgkmcnt(0)
    ds_read_b64_tr_b16 v[48:49], v15 offset:0
    ds_read_b64_tr_b16 v[50:51], v15 offset:1024
    v_mfma_f32_16x16x32_bf16 v[220:223], v[52:55], a[60:63], v[220:223]
    ds_read_b64_tr_b16 v[52:53], v15 offset:8192
    ds_read_b64_tr_b16 v[54:55], v15 offset:9216
    v_mfma_f32_16x16x32_bf16 v[224:227], v[56:59], a[0:3], v[224:227]
    v_mfma_f32_16x16x32_bf16 v[224:227], v[60:63], a[4:7], v[224:227]
    s_xor_b32 s62, s62, 128
    v_mfma_f32_16x16x32_bf16 v[228:231], v[56:59], a[8:11], v[228:231]
    buffer_load_dword v108, v103, s[24:27], s77 offen
    v_mfma_f32_16x16x32_bf16 v[228:231], v[60:63], a[12:15], v[228:231]
    s_add_u32 s77, s77, 4608
    v_mfma_f32_16x16x32_bf16 v[232:235], v[56:59], a[16:19], v[232:235]
    v_mfma_f32_16x16x32_bf16 v[232:235], v[60:63], a[20:23], v[232:235]
    s_add_u32 m0, s69, 98304
    v_mfma_f32_16x16x32_bf16 v[236:239], v[56:59], a[24:27], v[236:239]
    buffer_load_dwordx4 v2, s[12:15], s60 offen nt lds
    v_mfma_f32_16x16x32_bf16 v[236:239], v[60:63], a[28:31], v[236:239]
    v_mfma_f32_16x16x32_bf16 v[240:243], v[56:59], a[32:35], v[240:243]
    v_mfma_f32_16x16x32_bf16 v[240:243], v[60:63], a[36:39], v[240:243]
    v_mfma_f32_16x16x32_bf16 v[244:247], v[56:59], a[40:43], v[244:247]
    v_mfma_f32_16x16x32_bf16 v[244:247], v[60:63], a[44:47], v[244:247]
    v_mfma_f32_16x16x32_bf16 v[248:251], v[56:59], a[48:51], v[248:251]
    v_mfma_f32_16x16x32_bf16 v[248:251], v[60:63], a[52:55], v[248:251]
    buffer_load_dwordx4 v3, s[12:15], s60 offen offset:1024 nt lds
    v_mfma_f32_16x16x32_bf16 v[252:255], v[56:59], a[56:59], v[252:255]
    ds_read_b64_tr_b16 v[56:57], v16 offset:0
    ds_read_b64_tr_b16 v[58:59], v16 offset:1024
    v_mfma_f32_16x16x32_bf16 v[252:255], v[60:63], a[60:63], v[252:255]
    ds_read_b64_tr_b16 v[60:61], v16 offset:8192
    ds_read_b64_tr_b16 v[62:63], v16 offset:9216
    v_mfma_f32_16x16x32_bf16 a[128:131], a[0:3], v[40:43], a[128:131]
    v_mfma_f32_16x16x32_bf16 a[128:131], a[4:7], v[44:47], a[128:131]
    v_add_u32 v22, 0xfffe0000, v22
    v_mfma_f32_16x16x32_bf16 a[132:135], a[8:11], v[40:43], a[132:135]
    ds_read_b128 a[96:99], v22 offset:16384
    v_mfma_f32_16x16x32_bf16 a[132:135], a[12:15], v[44:47], a[132:135]
    v_mfma_f32_16x16x32_bf16 a[136:139], a[16:19], v[40:43], a[136:139]
    v_mfma_f32_16x16x32_bf16 a[136:139], a[20:23], v[44:47], a[136:139]
    buffer_load_dwordx4 v4, s[12:15], s60 offen offset:2048 nt lds
    v_mfma_f32_16x16x32_bf16 a[140:143], a[24:27], v[40:43], a[140:143]
    v_add_u32 v23, 0xfffe0000, v23
    v_mfma_f32_16x16x32_bf16 a[140:143], a[28:31], v[44:47], a[140:143]
    ds_read_b128 a[100:103], v23 offset:16384
    v_mfma_f32_16x16x32_bf16 a[144:147], a[32:35], v[40:43], a[144:147]
    v_mfma_f32_16x16x32_bf16 a[144:147], a[36:39], v[44:47], a[144:147]
    v_mfma_f32_16x16x32_bf16 a[148:151], a[40:43], v[40:43], a[148:151]
    v_mfma_f32_16x16x32_bf16 a[148:151], a[44:47], v[44:47], a[148:151]
    v_mfma_f32_16x16x32_bf16 a[152:155], a[48:51], v[40:43], a[152:155]
    buffer_load_dwordx4 v5, s[12:15], s60 offen offset:3072 nt lds
    v_mfma_f32_16x16x32_bf16 a[152:155], a[52:55], v[44:47], a[152:155]
    ds_read_b128 a[104:107], v22 offset:18432
    v_mfma_f32_16x16x32_bf16 a[156:159], a[56:59], v[40:43], a[156:159]
    ds_read_b64_tr_b16 v[40:41], v17 offset:0
    ds_read_b64_tr_b16 v[42:43], v17 offset:1024
    v_mfma_f32_16x16x32_bf16 a[156:159], a[60:63], v[44:47], a[156:159]
    s_waitcnt lgkmcnt(3)
    ds_read_b64_tr_b16 v[44:45], v17 offset:8192
    ds_read_b64_tr_b16 v[46:47], v17 offset:9216
    v_mfma_f32_16x16x32_bf16 a[160:163], a[0:3], v[48:51], a[160:163]
    v_mfma_f32_16x16x32_bf16 a[160:163], a[4:7], v[52:55], a[160:163]
    v_mfma_f32_16x16x32_bf16 a[164:167], a[8:11], v[48:51], a[164:167]
    ds_read_b128 a[108:111], v23 offset:18432
    v_mfma_f32_16x16x32_bf16 a[164:167], a[12:15], v[52:55], a[164:167]
    s_add_u32 m0, s69, 114688
    v_mfma_f32_16x16x32_bf16 a[168:171], a[16:19], v[48:51], a[168:171]
    s_xor_b32 s60, s60, 524288
    buffer_load_dwordx4 v6, s[8:11], s61 offen lds
    v_mfma_f32_16x16x32_bf16 a[168:171], a[20:23], v[52:55], a[168:171]
    v_mfma_f32_16x16x32_bf16 a[172:175], a[24:27], v[48:51], a[172:175]
    v_mfma_f32_16x16x32_bf16 a[172:175], a[28:31], v[52:55], a[172:175]
    v_mfma_f32_16x16x32_bf16 a[176:179], a[32:35], v[48:51], a[176:179]
    ds_read_b128 a[112:115], v22 offset:20480
    v_mfma_f32_16x16x32_bf16 a[176:179], a[36:39], v[52:55], a[176:179]
    v_mfma_f32_16x16x32_bf16 a[180:183], a[40:43], v[48:51], a[180:183]
    v_mfma_f32_16x16x32_bf16 a[180:183], a[44:47], v[52:55], a[180:183]
    buffer_load_dwordx4 v7, s[8:11], s61 offen offset:1024 lds
    v_mfma_f32_16x16x32_bf16 a[184:187], a[48:51], v[48:51], a[184:187]
    v_mfma_f32_16x16x32_bf16 a[184:187], a[52:55], v[52:55], a[184:187]
    ds_read_b128 a[116:119], v23 offset:20480
    v_mfma_f32_16x16x32_bf16 a[188:191], a[56:59], v[48:51], a[188:191]
    v_mfma_f32_16x16x32_bf16 a[188:191], a[60:63], v[52:55], a[188:191]
    v_mfma_f32_16x16x32_bf16 a[192:195], a[0:3], v[56:59], a[192:195]
    v_mfma_f32_16x16x32_bf16 a[192:195], a[4:7], v[60:63], a[192:195]
    v_mfma_f32_16x16x32_bf16 a[196:199], a[8:11], v[56:59], a[196:199]
    v_mfma_f32_16x16x32_bf16 a[196:199], a[12:15], v[60:63], a[196:199]
    buffer_load_dwordx4 v8, s[8:11], s61 offen offset:2048 lds
    v_mfma_f32_16x16x32_bf16 a[200:203], a[16:19], v[56:59], a[200:203]
    ds_read_b128 a[120:123], v22 offset:22528
    v_mfma_f32_16x16x32_bf16 a[200:203], a[20:23], v[60:63], a[200:203]
    v_mfma_f32_16x16x32_bf16 a[204:207], a[24:27], v[56:59], a[204:207]
    v_mfma_f32_16x16x32_bf16 a[204:207], a[28:31], v[60:63], a[204:207]
    v_mfma_f32_16x16x32_bf16 a[208:211], a[32:35], v[56:59], a[208:211]
    ds_read_b128 a[124:127], v23 offset:22528
    v_mfma_f32_16x16x32_bf16 a[208:211], a[36:39], v[60:63], a[208:211]
    v_mfma_f32_16x16x32_bf16 a[212:215], a[40:43], v[56:59], a[212:215]
    buffer_load_dwordx4 v9, s[8:11], s61 offen offset:3072 lds
    v_mfma_f32_16x16x32_bf16 a[212:215], a[44:47], v[60:63], a[212:215]
    v_mfma_f32_16x16x32_bf16 a[216:219], a[48:51], v[56:59], a[216:219]
    v_mfma_f32_16x16x32_bf16 a[216:219], a[52:55], v[60:63], a[216:219]
    v_mfma_f32_16x16x32_bf16 a[220:223], a[56:59], v[56:59], a[220:223]
    v_mfma_f32_16x16x32_bf16 a[220:223], a[60:63], v[60:63], a[220:223]
    s_waitcnt lgkmcnt(0)
    v_mfma_f32_16x16x32_bf16 a[224:227], a[0:3], v[40:43], a[224:227]
    v_mfma_f32_16x16x32_bf16 a[224:227], a[4:7], v[44:47], a[224:227]
    s_xor_b32 s61, s61, 1920
    v_mfma_f32_16x16x32_bf16 a[228:231], a[8:11], v[40:43], a[228:231]
    s_andn2_b32 s61, s61, 896
    v_mfma_f32_16x16x32_bf16 a[228:231], a[12:15], v[44:47], a[228:231]
    s_lshl_b32 s61, s5, 7
    v_mfma_f32_16x16x32_bf16 a[232:235], a[16:19], v[40:43], a[232:235]
    v_mfma_f32_16x16x32_bf16 a[232:235], a[20:23], v[44:47], a[232:235]
    s_waitcnt vmcnt(9) lgkmcnt(0)
    s_barrier
    ds_read_b64_tr_b16 v[48:49], v14 offset:32768
    v_mfma_f32_16x16x32_bf16 a[236:239], a[24:27], v[40:43], a[236:239]
    s_add_u32 m0, s69, 131072
    ds_read_b64_tr_b16 v[50:51], v14 offset:33792
    ds_read_b64_tr_b16 v[52:53], v14 offset:40960
    v_mfma_f32_16x16x32_bf16 a[236:239], a[28:31], v[44:47], a[236:239]
    buffer_load_dwordx4 v2, s[12:15], s60 offen nt lds
    v_mfma_f32_16x16x32_bf16 a[240:243], a[32:35], v[40:43], a[240:243]
    ds_read_b64_tr_b16 v[54:55], v14 offset:41984
    ds_read_b64_tr_b16 v[56:57], v15 offset:32768
    v_mfma_f32_16x16x32_bf16 a[240:243], a[36:39], v[44:47], a[240:243]
    ds_read_b64_tr_b16 v[58:59], v15 offset:33792
    ds_read_b64_tr_b16 v[60:61], v15 offset:40960
    v_mfma_f32_16x16x32_bf16 a[244:247], a[40:43], v[40:43], a[244:247]
    ds_read_b64_tr_b16 v[62:63], v15 offset:41984
    v_add_u32 v14, 0x10000, v14
    v_mfma_f32_16x16x32_bf16 a[244:247], a[44:47], v[44:47], a[244:247]
    v_add_u32 v15, 0x10000, v15
    v_mfma_f32_16x16x32_bf16 a[248:251], a[48:51], v[40:43], a[248:251]
    v_mfma_f32_16x16x32_bf16 a[248:251], a[52:55], v[44:47], a[248:251]
    buffer_load_dwordx4 v3, s[12:15], s60 offen offset:1024 nt lds
    v_mfma_f32_16x16x32_bf16 a[252:255], a[56:59], v[40:43], a[252:255]
    ds_read_b64_tr_b16 v[40:41], v16 offset:32768
    ds_read_b64_tr_b16 v[42:43], v16 offset:33792
    v_mfma_f32_16x16x32_bf16 a[252:255], a[60:63], v[44:47], a[252:255]
    s_waitcnt lgkmcnt(2)
    ds_read_b64_tr_b16 v[44:45], v16 offset:40960
    ds_read_b64_tr_b16 v[46:47], v16 offset:41984
    v_mfma_f32_16x16x32_bf16 v[128:131], v[48:51], a[64:67], v[128:131]
    v_add_u32 v16, 0x10000, v16
    v_mfma_f32_16x16x32_bf16 v[128:131], v[52:55], a[68:71], v[128:131]
    v_mfma_f32_16x16x32_bf16 v[132:135], v[48:51], a[72:75], v[132:135]
    ds_read_b128 a[0:3], v22 offset:49152
    v_mfma_f32_16x16x32_bf16 v[132:135], v[52:55], a[76:79], v[132:135]
    v_mfma_f32_16x16x32_bf16 v[136:139], v[48:51], a[80:83], v[136:139]
    v_mfma_f32_16x16x32_bf16 v[136:139], v[52:55], a[84:87], v[136:139]
    buffer_load_dwordx4 v4, s[12:15], s60 offen offset:2048 nt lds
    v_mfma_f32_16x16x32_bf16 v[140:143], v[48:51], a[88:91], v[140:143]
    v_mfma_f32_16x16x32_bf16 v[140:143], v[52:55], a[92:95], v[140:143]
    ds_read_b128 a[4:7], v23 offset:49152
    v_mfma_f32_16x16x32_bf16 v[144:147], v[48:51], a[96:99], v[144:147]
    v_mfma_f32_16x16x32_bf16 v[144:147], v[52:55], a[100:103], v[144:147]
    v_mfma_f32_16x16x32_bf16 v[148:151], v[48:51], a[104:107], v[148:151]
    v_mfma_f32_16x16x32_bf16 v[148:151], v[52:55], a[108:111], v[148:151]
    v_mfma_f32_16x16x32_bf16 v[152:155], v[48:51], a[112:115], v[152:155]
    buffer_load_dwordx4 v5, s[12:15], s60 offen offset:3072 nt lds
    v_mfma_f32_16x16x32_bf16 v[152:155], v[52:55], a[116:119], v[152:155]
    ds_read_b128 a[8:11], v22 offset:51200
    v_mfma_f32_16x16x32_bf16 v[156:159], v[48:51], a[120:123], v[156:159]
    ds_read_b64_tr_b16 v[48:49], v17 offset:32768
    ds_read_b64_tr_b16 v[50:51], v17 offset:33792
    v_mfma_f32_16x16x32_bf16 v[156:159], v[52:55], a[124:127], v[156:159]
    ds_read_b64_tr_b16 v[52:53], v17 offset:40960
    ds_read_b64_tr_b16 v[54:55], v17 offset:41984
    v_mfma_f32_16x16x32_bf16 v[160:163], v[56:59], a[64:67], v[160:163]
    v_add_u32 v17, 0x10000, v17
    v_mfma_f32_16x16x32_bf16 v[160:163], v[60:63], a[68:71], v[160:163]
    s_cmp_lt_u32 s4, 0
    s_cselect_b32 s12, 0xf149f2ca, 0
    v_mfma_f32_16x16x32_bf16 v[164:167], v[56:59], a[72:75], v[164:167]
    ds_read_b128 a[12:15], v23 offset:51200
    v_mfma_f32_16x16x32_bf16 v[164:167], v[60:63], a[76:79], v[164:167]
    s_add_u32 m0, s69, 147456
    v_mfma_f32_16x16x32_bf16 v[168:171], v[56:59], a[80:83], v[168:171]
    s_xor_b32 s60, s60, 524288
    buffer_load_dwordx4 v6, s[8:11], s62 offen lds
    v_mfma_f32_16x16x32_bf16 v[168:171], v[60:63], a[84:87], v[168:171]
    v_mov_b32 v6, v96
    v_mfma_f32_16x16x32_bf16 v[172:175], v[56:59], a[88:91], v[172:175]
    s_cmp_lt_u32 s4, 1
    s_cselect_b32 s13, 0xf149f2ca, 0
    v_mfma_f32_16x16x32_bf16 v[172:175], v[60:63], a[92:95], v[172:175]
    s_cmp_lt_u32 s4, 2
    s_cselect_b32 s14, 0xf149f2ca, 0
    v_mfma_f32_16x16x32_bf16 v[176:179], v[56:59], a[96:99], v[176:179]
    ds_read_b128 a[16:19], v22 offset:53248
    v_mfma_f32_16x16x32_bf16 v[176:179], v[60:63], a[100:103], v[176:179]
    s_cmp_lt_u32 s4, 3
    s_cselect_b32 s15, 0xf149f2ca, 0
    v_mfma_f32_16x16x32_bf16 v[180:183], v[56:59], a[104:107], v[180:183]
    v_mfma_f32_16x16x32_bf16 v[180:183], v[60:63], a[108:111], v[180:183]
    buffer_load_dwordx4 v7, s[8:11], s62 offen offset:1024 lds
    v_mfma_f32_16x16x32_bf16 v[184:187], v[56:59], a[112:115], v[184:187]
    v_mfma_f32_16x16x32_bf16 v[184:187], v[60:63], a[116:119], v[184:187]
    ds_read_b128 a[20:23], v23 offset:53248
    v_mfma_f32_16x16x32_bf16 v[188:191], v[56:59], a[120:123], v[188:191]
    s_waitcnt lgkmcnt(1)
    ds_read_b64_tr_b16 v[56:57], v14 offset:0
    ds_read_b64_tr_b16 v[58:59], v14 offset:1024
    v_mfma_f32_16x16x32_bf16 v[188:191], v[60:63], a[124:127], v[188:191]
    ds_read_b64_tr_b16 v[60:61], v14 offset:8192
    ds_read_b64_tr_b16 v[62:63], v14 offset:9216
    v_mfma_f32_16x16x32_bf16 v[192:195], v[40:43], a[64:67], v[192:195]
    v_mfma_f32_16x16x32_bf16 v[192:195], v[44:47], a[68:71], v[192:195]
    v_mfma_f32_16x16x32_bf16 v[196:199], v[40:43], a[72:75], v[196:199]
    v_mfma_f32_16x16x32_bf16 v[196:199], v[44:47], a[76:79], v[196:199]
    buffer_load_dwordx4 v8, s[8:11], s62 offen offset:2048 lds
    v_mfma_f32_16x16x32_bf16 v[200:203], v[40:43], a[80:83], v[200:203]
    ds_read_b128 a[24:27], v22 offset:55296
    v_bfe_u32 v8, v1, 4, 3
    v_mfma_f32_16x16x32_bf16 v[200:203], v[44:47], a[84:87], v[200:203]
    v_lshlrev_b32 v8, 12, v8
    v_mfma_f32_16x16x32_bf16 v[204:207], v[40:43], a[88:91], v[204:207]
    v_mfma_f32_16x16x32_bf16 v[204:207], v[44:47], a[92:95], v[204:207]
    v_mfma_f32_16x16x32_bf16 v[208:211], v[40:43], a[96:99], v[208:211]
    ds_read_b128 a[28:31], v23 offset:55296
    v_mfma_f32_16x16x32_bf16 v[208:211], v[44:47], a[100:103], v[208:211]
    v_mfma_f32_16x16x32_bf16 v[212:215], v[40:43], a[104:107], v[212:215]
    buffer_load_dwordx4 v9, s[8:11], s62 offen offset:3072 lds
    v_mfma_f32_16x16x32_bf16 v[212:215], v[44:47], a[108:111], v[212:215]
    s_and_b32 s8, s5, 7
    v_lshrrev_b32 v9, 2, v1
    v_mfma_f32_16x16x32_bf16 v[216:219], v[40:43], a[112:115], v[216:219]
    s_lshl3_add_u32 s8, s6, s8
    v_mfma_f32_16x16x32_bf16 v[216:219], v[44:47], a[116:119], v[216:219]
    s_mul_hi_u32 s98, s8, 715827883
    v_mfma_f32_16x16x32_bf16 v[220:223], v[40:43], a[120:123], v[220:223]
    s_lshr_b32 s10, s5, 3
    ds_read_b64_tr_b16 v[40:41], v15 offset:0
    ds_read_b64_tr_b16 v[42:43], v15 offset:1024
    v_mfma_f32_16x16x32_bf16 v[220:223], v[44:47], a[124:127], v[220:223]
    ds_read_b64_tr_b16 v[44:45], v15 offset:8192
    ds_read_b64_tr_b16 v[46:47], v15 offset:9216
    v_mfma_f32_16x16x32_bf16 v[224:227], v[48:51], a[64:67], v[224:227]
    s_cmp_eq_u32 s4, 3
    s_cselect_b32 s11, 1.0, 0
    v_mfma_f32_16x16x32_bf16 v[224:227], v[52:55], a[68:71], v[224:227]
    s_xor_b32 s62, s62, 1920
    v_mfma_f32_16x16x32_bf16 v[228:231], v[48:51], a[72:75], v[228:231]
    s_andn2_b32 s62, s62, 896
    buffer_load_dword v109, v103, s[24:27], s77 offen
    v_mfma_f32_16x16x32_bf16 v[228:231], v[52:55], a[76:79], v[228:231]
    v_mfma_f32_16x16x32_bf16 v[232:235], v[48:51], a[80:83], v[232:235]
    v_mfma_f32_16x16x32_bf16 v[232:235], v[52:55], a[84:87], v[232:235]
    s_add_u32 m0, s69, 0
    v_mfma_f32_16x16x32_bf16 v[236:239], v[48:51], a[88:91], v[236:239]
    buffer_load_dwordx4 v2, s[16:19], s60 offen nt lds
    v_mfma_f32_16x16x32_bf16 v[236:239], v[52:55], a[92:95], v[236:239]
    v_mfma_f32_16x16x32_bf16 v[240:243], v[48:51], a[96:99], v[240:243]
    v_mfma_f32_16x16x32_bf16 v[240:243], v[52:55], a[100:103], v[240:243]
    v_mfma_f32_16x16x32_bf16 v[244:247], v[48:51], a[104:107], v[244:247]
    v_mfma_f32_16x16x32_bf16 v[244:247], v[52:55], a[108:111], v[244:247]
    v_mfma_f32_16x16x32_bf16 v[248:251], v[48:51], a[112:115], v[248:251]
    v_mfma_f32_16x16x32_bf16 v[248:251], v[52:55], a[116:119], v[248:251]
    buffer_load_dwordx4 v3, s[16:19], s60 offen offset:1024 nt lds
    v_mfma_f32_16x16x32_bf16 v[252:255], v[48:51], a[120:123], v[252:255]
    ds_read_b64_tr_b16 v[48:49], v16 offset:0
    ds_read_b64_tr_b16 v[50:51], v16 offset:1024
    v_mfma_f32_16x16x32_bf16 v[252:255], v[52:55], a[124:127], v[252:255]
    s_waitcnt lgkmcnt(2)
    ds_read_b64_tr_b16 v[52:53], v16 offset:8192
    ds_read_b64_tr_b16 v[54:55], v16 offset:9216
    v_mfma_f32_16x16x32_bf16 a[128:131], a[64:67], v[56:59], a[128:131]
    v_mfma_f32_16x16x32_bf16 a[128:131], a[68:71], v[60:63], a[128:131]
    v_add_u32 v22, 0x10000, v22
    v_mfma_f32_16x16x32_bf16 a[132:135], a[72:75], v[56:59], a[132:135]
    ds_read_b128 a[32:35], v22 offset:16384
    v_mfma_f32_16x16x32_bf16 a[132:135], a[76:79], v[60:63], a[132:135]
    v_mfma_f32_16x16x32_bf16 a[136:139], a[80:83], v[56:59], a[136:139]
    v_mfma_f32_16x16x32_bf16 a[136:139], a[84:87], v[60:63], a[136:139]
    buffer_load_dwordx4 v4, s[16:19], s60 offen offset:2048 nt lds
    v_mfma_f32_16x16x32_bf16 a[140:143], a[88:91], v[56:59], a[140:143]
    v_add_u32 v23, 0x10000, v23
    v_mfma_f32_16x16x32_bf16 a[140:143], a[92:95], v[60:63], a[140:143]
    ds_read_b128 a[36:39], v23 offset:16384
    v_mfma_f32_16x16x32_bf16 a[144:147], a[96:99], v[56:59], a[144:147]
    v_mfma_f32_16x16x32_bf16 a[144:147], a[100:103], v[60:63], a[144:147]
    v_mfma_f32_16x16x32_bf16 a[148:151], a[104:107], v[56:59], a[148:151]
    v_mfma_f32_16x16x32_bf16 a[148:151], a[108:111], v[60:63], a[148:151]
    v_mfma_f32_16x16x32_bf16 a[152:155], a[112:115], v[56:59], a[152:155]
    buffer_load_dwordx4 v5, s[16:19], s60 offen offset:3072 nt lds
    v_mfma_f32_16x16x32_bf16 a[152:155], a[116:119], v[60:63], a[152:155]
    ds_read_b128 a[40:43], v22 offset:18432
    v_mfma_f32_16x16x32_bf16 a[156:159], a[120:123], v[56:59], a[156:159]
    ds_read_b64_tr_b16 v[56:57], v17 offset:0
    ds_read_b64_tr_b16 v[58:59], v17 offset:1024
    v_mfma_f32_16x16x32_bf16 a[156:159], a[124:127], v[60:63], a[156:159]
    ds_read_b64_tr_b16 v[60:61], v17 offset:8192
    ds_read_b64_tr_b16 v[62:63], v17 offset:9216
    v_mfma_f32_16x16x32_bf16 a[160:163], a[64:67], v[40:43], a[160:163]
    v_mfma_f32_16x16x32_bf16 a[160:163], a[68:71], v[44:47], a[160:163]
    v_mfma_f32_16x16x32_bf16 a[164:167], a[72:75], v[40:43], a[164:167]
    ds_read_b128 a[44:47], v23 offset:18432
    v_mfma_f32_16x16x32_bf16 a[164:167], a[76:79], v[44:47], a[164:167]
    s_add_u32 m0, s69, 16384
    v_mfma_f32_16x16x32_bf16 a[168:171], a[80:83], v[40:43], a[168:171]
    s_xor_b32 s60, s60, 524288
    buffer_load_dwordx4 v10, s[20:23], s63 offen lds
    v_mfma_f32_16x16x32_bf16 a[168:171], a[84:87], v[44:47], a[168:171]
    v_mfma_f32_16x16x32_bf16 a[172:175], a[88:91], v[40:43], a[172:175]
    v_mfma_f32_16x16x32_bf16 a[172:175], a[92:95], v[44:47], a[172:175]
    v_mfma_f32_16x16x32_bf16 a[176:179], a[96:99], v[40:43], a[176:179]
    ds_read_b128 a[48:51], v22 offset:20480
    v_mfma_f32_16x16x32_bf16 a[176:179], a[100:103], v[44:47], a[176:179]
    v_mfma_f32_16x16x32_bf16 a[180:183], a[104:107], v[40:43], a[180:183]
    v_mfma_f32_16x16x32_bf16 a[180:183], a[108:111], v[44:47], a[180:183]
    buffer_load_dwordx4 v11, s[20:23], s63 offen offset:1024 lds
    v_mfma_f32_16x16x32_bf16 a[184:187], a[112:115], v[40:43], a[184:187]
    v_mfma_f32_16x16x32_bf16 a[184:187], a[116:119], v[44:47], a[184:187]
    ds_read_b128 a[52:55], v23 offset:20480
    v_mfma_f32_16x16x32_bf16 a[188:191], a[120:123], v[40:43], a[188:191]
    v_mfma_f32_16x16x32_bf16 a[188:191], a[124:127], v[44:47], a[188:191]
    s_waitcnt lgkmcnt(1)
    v_mfma_f32_16x16x32_bf16 a[192:195], a[64:67], v[48:51], a[192:195]
    v_mfma_f32_16x16x32_bf16 a[192:195], a[68:71], v[52:55], a[192:195]
    v_mfma_f32_16x16x32_bf16 a[196:199], a[72:75], v[48:51], a[196:199]
    v_mfma_f32_16x16x32_bf16 a[196:199], a[76:79], v[52:55], a[196:199]
    buffer_load_dwordx4 v12, s[20:23], s63 offen offset:2048 lds
    v_mfma_f32_16x16x32_bf16 a[200:203], a[80:83], v[48:51], a[200:203]
    ds_read_b128 a[56:59], v22 offset:22528
    v_mfma_f32_16x16x32_bf16 a[200:203], a[84:87], v[52:55], a[200:203]
    v_mfma_f32_16x16x32_bf16 a[204:207], a[88:91], v[48:51], a[204:207]
    v_mfma_f32_16x16x32_bf16 a[204:207], a[92:95], v[52:55], a[204:207]
    v_mfma_f32_16x16x32_bf16 a[208:211], a[96:99], v[48:51], a[208:211]
    ds_read_b128 a[60:63], v23 offset:22528
    v_mfma_f32_16x16x32_bf16 a[208:211], a[100:103], v[52:55], a[208:211]
    v_mfma_f32_16x16x32_bf16 a[212:215], a[104:107], v[48:51], a[212:215]
    buffer_load_dwordx4 v13, s[20:23], s63 offen offset:3072 lds
    v_mfma_f32_16x16x32_bf16 a[212:215], a[108:111], v[52:55], a[212:215]
    v_mfma_f32_16x16x32_bf16 a[216:219], a[112:115], v[48:51], a[216:219]
    v_mfma_f32_16x16x32_bf16 a[216:219], a[116:119], v[52:55], a[216:219]
    v_mfma_f32_16x16x32_bf16 a[220:223], a[120:123], v[48:51], a[220:223]
    v_mfma_f32_16x16x32_bf16 a[220:223], a[124:127], v[52:55], a[220:223]
    v_mfma_f32_16x16x32_bf16 a[224:227], a[64:67], v[56:59], a[224:227]
    v_mfma_f32_16x16x32_bf16 a[224:227], a[68:71], v[60:63], a[224:227]
    s_xor_b32 s63, s63, 128
    v_mfma_f32_16x16x32_bf16 a[228:231], a[72:75], v[56:59], a[228:231]
    v_mfma_f32_16x16x32_bf16 a[228:231], a[76:79], v[60:63], a[228:231]
    v_mfma_f32_16x16x32_bf16 a[232:235], a[80:83], v[56:59], a[232:235]
    v_mfma_f32_16x16x32_bf16 a[232:235], a[84:87], v[60:63], a[232:235]
    s_waitcnt vmcnt(9) lgkmcnt(0)
    s_barrier
    ds_read_b64_tr_b16 v[40:41], v14 offset:32768
    v_mfma_f32_16x16x32_bf16 a[236:239], a[88:91], v[56:59], a[236:239]
    s_add_u32 m0, s69, 32768
    ds_read_b64_tr_b16 v[42:43], v14 offset:33792
    ds_read_b64_tr_b16 v[44:45], v14 offset:40960
    v_mfma_f32_16x16x32_bf16 a[236:239], a[92:95], v[60:63], a[236:239]
    buffer_load_dwordx4 v2, s[16:19], s60 offen nt lds
    v_mfma_f32_16x16x32_bf16 a[240:243], a[96:99], v[56:59], a[240:243]
    ds_read_b64_tr_b16 v[46:47], v14 offset:41984
    ds_read_b64_tr_b16 v[48:49], v15 offset:32768
    v_mfma_f32_16x16x32_bf16 a[240:243], a[100:103], v[60:63], a[240:243]
    ds_read_b64_tr_b16 v[50:51], v15 offset:33792
    ds_read_b64_tr_b16 v[52:53], v15 offset:40960
    v_mfma_f32_16x16x32_bf16 a[244:247], a[104:107], v[56:59], a[244:247]
    ds_read_b64_tr_b16 v[54:55], v15 offset:41984
    v_add_u32 v14, 0x10000, v14
    v_mfma_f32_16x16x32_bf16 a[244:247], a[108:111], v[60:63], a[244:247]
    v_add_u32 v15, 0x10000, v15
    v_mfma_f32_16x16x32_bf16 a[248:251], a[112:115], v[56:59], a[248:251]
    v_mfma_f32_16x16x32_bf16 a[248:251], a[116:119], v[60:63], a[248:251]
    buffer_load_dwordx4 v3, s[16:19], s60 offen offset:1024 nt lds
    v_mfma_f32_16x16x32_bf16 a[252:255], a[120:123], v[56:59], a[252:255]
    ds_read_b64_tr_b16 v[56:57], v16 offset:32768
    ds_read_b64_tr_b16 v[58:59], v16 offset:33792
    v_mfma_f32_16x16x32_bf16 a[252:255], a[124:127], v[60:63], a[252:255]
    s_waitcnt lgkmcnt(2)
    ds_read_b64_tr_b16 v[60:61], v16 offset:40960
    ds_read_b64_tr_b16 v[62:63], v16 offset:41984
    v_mfma_f32_16x16x32_bf16 v[128:131], v[40:43], a[0:3], v[128:131]
    v_add_u32 v16, 0x10000, v16
    v_mfma_f32_16x16x32_bf16 v[128:131], v[44:47], a[4:7], v[128:131]
    ds_read_b128 a[64:67], v22 offset:49152
    v_mfma_f32_16x16x32_bf16 v[132:135], v[40:43], a[8:11], v[132:135]
    v_mfma_f32_16x16x32_bf16 v[132:135], v[44:47], a[12:15], v[132:135]
    v_mfma_f32_16x16x32_bf16 v[136:139], v[40:43], a[16:19], v[136:139]
    ds_read_b128 a[68:71], v23 offset:49152
    v_mfma_f32_16x16x32_bf16 v[136:139], v[44:47], a[20:23], v[136:139]
    buffer_load_dwordx4 v4, s[16:19], s60 offen offset:2048 nt lds
    v_mfma_f32_16x16x32_bf16 v[140:143], v[40:43], a[24:27], v[140:143]
    v_mfma_f32_16x16x32_bf16 v[140:143], v[44:47], a[28:31], v[140:143]
    ds_read_b128 a[72:75], v22 offset:51200
    v_mfma_f32_16x16x32_bf16 v[144:147], v[40:43], a[32:35], v[144:147]
    v_mfma_f32_16x16x32_bf16 v[144:147], v[44:47], a[36:39], v[144:147]
    v_mfma_f32_16x16x32_bf16 v[148:151], v[40:43], a[40:43], v[148:151]
    ds_read_b128 a[76:79], v23 offset:51200
    v_mfma_f32_16x16x32_bf16 v[148:151], v[44:47], a[44:47], v[148:151]
    v_mfma_f32_16x16x32_bf16 v[152:155], v[40:43], a[48:51], v[152:155]
    buffer_load_dwordx4 v5, s[16:19], s60 offen offset:3072 nt lds
    v_mfma_f32_16x16x32_bf16 v[152:155], v[44:47], a[52:55], v[152:155]
    v_mfma_f32_16x16x32_bf16 v[156:159], v[40:43], a[56:59], v[156:159]
    ds_read_b128 a[80:83], v22 offset:53248
    ds_read_b64_tr_b16 v[40:41], v17 offset:32768
    v_mfma_f32_16x16x32_bf16 v[156:159], v[44:47], a[60:63], v[156:159]
    ds_read_b64_tr_b16 v[42:43], v17 offset:33792
    ds_read_b64_tr_b16 v[44:45], v17 offset:40960
    v_mfma_f32_16x16x32_bf16 v[160:163], v[48:51], a[0:3], v[160:163]
    ds_read_b64_tr_b16 v[46:47], v17 offset:41984
    v_add_u32 v17, 0x10000, v17
    v_mfma_f32_16x16x32_bf16 v[160:163], v[52:55], a[4:7], v[160:163]
    ds_read_b128 a[84:87], v23 offset:53248
    v_mfma_f32_16x16x32_bf16 v[164:167], v[48:51], a[8:11], v[164:167]
    v_mfma_f32_16x16x32_bf16 v[164:167], v[52:55], a[12:15], v[164:167]
    s_add_u32 m0, s69, 49152
    buffer_load_dword v7, v9, s[44:47], s69 offen sc1
    v_mfma_f32_16x16x32_bf16 v[168:171], v[48:51], a[16:19], v[168:171]
    s_xor_b32 s60, s60, 3670016
    buffer_load_dwordx4 v10, s[20:23], s64 offen lds
    v_mfma_f32_16x16x32_bf16 v[168:171], v[52:55], a[20:23], v[168:171]
    ds_read_b128 a[88:91], v22 offset:55296
    v_mfma_f32_16x16x32_bf16 v[172:175], v[48:51], a[24:27], v[172:175]
    v_mfma_f32_16x16x32_bf16 v[172:175], v[52:55], a[28:31], v[172:175]
    s_waitcnt lgkmcnt(1)
    ds_read_b128 a[92:95], v23 offset:55296
    v_mfma_f32_16x16x32_bf16 v[176:179], v[48:51], a[32:35], v[176:179]
    v_mfma_f32_16x16x32_bf16 v[176:179], v[52:55], a[36:39], v[176:179]
    v_mfma_f32_16x16x32_bf16 v[180:183], v[48:51], a[40:43], v[180:183]
    v_mfma_f32_16x16x32_bf16 v[180:183], v[52:55], a[44:47], v[180:183]
    buffer_load_dwordx4 v11, s[20:23], s64 offen offset:1024 lds
    v_mfma_f32_16x16x32_bf16 v[184:187], v[48:51], a[48:51], v[184:187]
    v_add_u32 v22, 0x10000, v22
    ds_read_b128 a[96:99], v22 offset:16384
    v_mfma_f32_16x16x32_bf16 v[184:187], v[52:55], a[52:55], v[184:187]
    v_mfma_f32_16x16x32_bf16 v[188:191], v[48:51], a[56:59], v[188:191]
    v_add_u32 v23, 0x10000, v23
    ds_read_b64_tr_b16 v[48:49], v14 offset:0
    v_mfma_f32_16x16x32_bf16 v[188:191], v[52:55], a[60:63], v[188:191]
    ds_read_b128 a[100:103], v23 offset:16384
    ds_read_b64_tr_b16 v[50:51], v14 offset:1024
    v_mfma_f32_16x16x32_bf16 v[192:195], v[56:59], a[0:3], v[192:195]
    ds_read_b64_tr_b16 v[52:53], v14 offset:8192
    ds_read_b64_tr_b16 v[54:55], v14 offset:9216
    v_mfma_f32_16x16x32_bf16 v[192:195], v[60:63], a[4:7], v[192:195]
    v_add_u32 v14, 0xfffe0000, v14
    v_mfma_f32_16x16x32_bf16 v[196:199], v[56:59], a[8:11], v[196:199]
    ds_read_b128 a[104:107], v22 offset:18432
    v_mfma_f32_16x16x32_bf16 v[196:199], v[60:63], a[12:15], v[196:199]
    buffer_load_dwordx4 v12, s[20:23], s64 offen offset:2048 lds
    v_mfma_f32_16x16x32_bf16 v[200:203], v[56:59], a[16:19], v[200:203]
    v_mfma_f32_16x16x32_bf16 v[200:203], v[60:63], a[20:23], v[200:203]
    ds_read_b128 a[108:111], v23 offset:18432
    v_mfma_f32_16x16x32_bf16 v[204:207], v[56:59], a[24:27], v[204:207]
    v_mfma_f32_16x16x32_bf16 v[204:207], v[60:63], a[28:31], v[204:207]
    v_mfma_f32_16x16x32_bf16 v[208:211], v[56:59], a[32:35], v[208:211]
    v_mfma_f32_16x16x32_bf16 v[208:211], v[60:63], a[36:39], v[208:211]
    ds_read_b128 a[112:115], v22 offset:20480
    v_mfma_f32_16x16x32_bf16 v[212:215], v[56:59], a[40:43], v[212:215]
    buffer_load_dwordx4 v13, s[20:23], s64 offen offset:3072 lds
    v_mfma_f32_16x16x32_bf16 v[212:215], v[60:63], a[44:47], v[212:215]
    v_mfma_f32_16x16x32_bf16 v[216:219], v[56:59], a[48:51], v[216:219]
    ds_read_b128 a[116:119], v23 offset:20480
    v_mfma_f32_16x16x32_bf16 v[216:219], v[60:63], a[52:55], v[216:219]
    v_mfma_f32_16x16x32_bf16 v[220:223], v[56:59], a[56:59], v[220:223]
    ds_read_b64_tr_b16 v[56:57], v15 offset:0
    ds_read_b64_tr_b16 v[58:59], v15 offset:1024
    v_mfma_f32_16x16x32_bf16 v[220:223], v[60:63], a[60:63], v[220:223]
    s_waitcnt lgkmcnt(3)
    ds_read_b128 a[120:123], v22 offset:22528
    ds_read_b64_tr_b16 v[60:61], v15 offset:8192
    v_mfma_f32_16x16x32_bf16 v[224:227], v[40:43], a[0:3], v[224:227]
    ds_read_b64_tr_b16 v[62:63], v15 offset:9216
    v_add_u32 v15, 0xfffe0000, v15
    v_mfma_f32_16x16x32_bf16 v[224:227], v[44:47], a[4:7], v[224:227]
    s_xor_b32 s64, s64, 128
    v_mov_b32 v22, v100
    v_add_u32 v22, 0x10000, v22
    v_mfma_f32_16x16x32_bf16 v[228:231], v[40:43], a[8:11], v[228:231]
    ds_read_b128 a[124:127], v23 offset:22528
    v_mov_b32 v23, v101
    v_mfma_f32_16x16x32_bf16 v[228:231], v[44:47], a[12:15], v[228:231]
    v_add_u32 v23, 0x10000, v23
    v_mfma_f32_16x16x32_bf16 v[232:235], v[40:43], a[16:19], v[232:235]
    v_mfma_f32_16x16x32_bf16 v[232:235], v[44:47], a[20:23], v[232:235]
    s_add_u32 m0, s69, 65536
    v_mfma_f32_16x16x32_bf16 v[236:239], v[40:43], a[24:27], v[236:239]
    buffer_load_dwordx4 v2, s[24:27], s60 offen lds
    v_mfma_f32_16x16x32_bf16 v[236:239], v[44:47], a[28:31], v[236:239]
    v_mfma_f32_16x16x32_bf16 v[240:243], v[40:43], a[32:35], v[240:243]
    v_mfma_f32_16x16x32_bf16 v[240:243], v[44:47], a[36:39], v[240:243]
    v_mfma_f32_16x16x32_bf16 v[244:247], v[40:43], a[40:43], v[244:247]
    v_mfma_f32_16x16x32_bf16 v[244:247], v[44:47], a[44:47], v[244:247]
    v_mfma_f32_16x16x32_bf16 v[248:251], v[40:43], a[48:51], v[248:251]
    v_mfma_f32_16x16x32_bf16 v[248:251], v[44:47], a[52:55], v[248:251]
    buffer_load_dwordx4 v3, s[24:27], s60 offen offset:1024 lds
    v_mfma_f32_16x16x32_bf16 v[252:255], v[40:43], a[56:59], v[252:255]
    ds_read_b64_tr_b16 v[40:41], v16 offset:0
    ds_read_b64_tr_b16 v[42:43], v16 offset:1024
    v_mfma_f32_16x16x32_bf16 v[252:255], v[44:47], a[60:63], v[252:255]
    ds_read_b64_tr_b16 v[44:45], v16 offset:8192
    ds_read_b64_tr_b16 v[46:47], v16 offset:9216
    v_mfma_f32_16x16x32_bf16 v[128:131], v[48:51], a[64:67], v[128:131]
    v_add_u32 v16, 0xfffe0000, v16
    v_mfma_f32_16x16x32_bf16 v[128:131], v[52:55], a[68:71], v[128:131]
    v_mfma_f32_16x16x32_bf16 v[132:135], v[48:51], a[72:75], v[132:135]
    v_mfma_f32_16x16x32_bf16 v[132:135], v[52:55], a[76:79], v[132:135]
    v_mfma_f32_16x16x32_bf16 v[136:139], v[48:51], a[80:83], v[136:139]
    v_mfma_f32_16x16x32_bf16 v[136:139], v[52:55], a[84:87], v[136:139]
    buffer_load_dwordx4 v4, s[24:27], s60 offen offset:2048 lds
    v_mfma_f32_16x16x32_bf16 v[140:143], v[48:51], a[88:91], v[140:143]
    v_mfma_f32_16x16x32_bf16 v[140:143], v[52:55], a[92:95], v[140:143]
    v_mfma_f32_16x16x32_bf16 v[144:147], v[48:51], a[96:99], v[144:147]
    v_mul_f32 v128, s74, v128
    v_mul_f32 v129, s74, v129
    v_mfma_f32_16x16x32_bf16 v[144:147], v[52:55], a[100:103], v[144:147]
    v_mul_f32 v130, s74, v130
    v_mul_f32 v131, s74, v131
    v_mfma_f32_16x16x32_bf16 v[148:151], v[48:51], a[104:107], v[148:151]
    v_cvt_pk_bf16_f32 v128, v128, v129
    v_cvt_pk_bf16_f32 v129, v130, v131
    v_mfma_f32_16x16x32_bf16 v[148:151], v[52:55], a[108:111], v[148:151]
    v_mul_f32 v132, s74, v132
    v_mul_f32 v133, s74, v133
    v_mfma_f32_16x16x32_bf16 v[152:155], v[48:51], a[112:115], v[152:155]
    s_waitcnt lgkmcnt(0)
    buffer_load_dwordx4 v5, s[24:27], s60 offen offset:3072 lds
    v_mfma_f32_16x16x32_bf16 v[152:155], v[52:55], a[116:119], v[152:155]
    v_mul_f32 v134, s74, v134
    v_mul_f32 v135, s74, v135
    v_mfma_f32_16x16x32_bf16 v[156:159], v[48:51], a[120:123], v[156:159]
    ds_read_b64_tr_b16 v[48:49], v17 offset:0
    ds_read_b64_tr_b16 v[50:51], v17 offset:1024
    v_mfma_f32_16x16x32_bf16 v[156:159], v[52:55], a[124:127], v[156:159]
    ds_read_b64_tr_b16 v[52:53], v17 offset:8192
    ds_read_b64_tr_b16 v[54:55], v17 offset:9216
    v_mfma_f32_16x16x32_bf16 v[160:163], v[56:59], a[64:67], v[160:163]
    v_add_u32 v17, 0xfffe0000, v17
    v_cvt_pk_bf16_f32 v132, v132, v133
    v_mfma_f32_16x16x32_bf16 v[160:163], v[60:63], a[68:71], v[160:163]
    v_cvt_pk_bf16_f32 v133, v134, v135
    v_mul_f32 v136, s74, v136
    v_mfma_f32_16x16x32_bf16 v[164:167], v[56:59], a[72:75], v[164:167]
    v_mul_f32 v137, s74, v137
    v_mul_f32 v138, s74, v138
    v_mfma_f32_16x16x32_bf16 v[164:167], v[60:63], a[76:79], v[164:167]
    s_add_u32 m0, s69, 81920
    v_mul_f32 v139, s74, v139
    v_mul_f32 v160, s74, v160
    v_mfma_f32_16x16x32_bf16 v[168:171], v[56:59], a[80:83], v[168:171]
    s_xor_b32 s60, s60, 524288
    buffer_load_dwordx4 v10, s[20:23], s63 offen lds
    v_mfma_f32_16x16x32_bf16 v[168:171], v[60:63], a[84:87], v[168:171]
    v_mul_f32 v161, s74, v161
    v_mul_f32 v162, s74, v162
    v_mfma_f32_16x16x32_bf16 v[172:175], v[56:59], a[88:91], v[172:175]
    v_mul_f32 v163, s74, v163
    v_cvt_pk_bf16_f32 v130, v160, v161
    v_mfma_f32_16x16x32_bf16 v[172:175], v[60:63], a[92:95], v[172:175]
    v_cvt_pk_bf16_f32 v131, v162, v163
    v_mul_f32 v164, s74, v164
    v_mfma_f32_16x16x32_bf16 v[176:179], v[56:59], a[96:99], v[176:179]
    v_mul_f32 v165, s74, v165
    v_mul_f32 v166, s74, v166
    v_mfma_f32_16x16x32_bf16 v[176:179], v[60:63], a[100:103], v[176:179]
    v_mul_f32 v167, s74, v167
    v_cvt_pk_bf16_f32 v134, v164, v165
    v_mfma_f32_16x16x32_bf16 v[180:183], v[56:59], a[104:107], v[180:183]
    v_cvt_pk_bf16_f32 v135, v166, v167
    v_mul_f32 v168, s74, v168
    v_mfma_f32_16x16x32_bf16 v[180:183], v[60:63], a[108:111], v[180:183]
    buffer_load_dwordx4 v11, s[20:23], s63 offen offset:1024 lds
    v_mfma_f32_16x16x32_bf16 v[184:187], v[56:59], a[112:115], v[184:187]
    v_mul_f32 v169, s74, v169
    v_mul_f32 v170, s74, v170
    v_mfma_f32_16x16x32_bf16 v[184:187], v[60:63], a[116:119], v[184:187]
    v_mul_f32 v171, s74, v171
    v_cvt_pk_bf16_f32 v136, v136, v137
    v_mfma_f32_16x16x32_bf16 v[188:191], v[56:59], a[120:123], v[188:191]
    v_cvt_pk_bf16_f32 v137, v138, v139
    v_cvt_pk_bf16_f32 v138, v168, v169
    v_mfma_f32_16x16x32_bf16 v[188:191], v[60:63], a[124:127], v[188:191]
    v_cvt_pk_bf16_f32 v139, v170, v171
    v_mul_f32 v140, s74, v140
    v_mfma_f32_16x16x32_bf16 v[192:195], v[40:43], a[64:67], v[192:195]
    v_mul_f32 v141, s74, v141
    v_mul_f32 v142, s74, v142
    v_mfma_f32_16x16x32_bf16 v[192:195], v[44:47], a[68:71], v[192:195]
    v_mul_f32 v143, s74, v143
    v_mul_f32 v172, s74, v172
    v_mfma_f32_16x16x32_bf16 v[196:199], v[40:43], a[72:75], v[196:199]
    v_mul_f32 v173, s74, v173
    v_mul_f32 v174, s74, v174
    v_mfma_f32_16x16x32_bf16 v[196:199], v[44:47], a[76:79], v[196:199]
    buffer_load_dwordx4 v12, s[20:23], s63 offen offset:2048 lds
    v_mfma_f32_16x16x32_bf16 v[200:203], v[40:43], a[80:83], v[200:203]
    v_mul_f32 v175, s74, v175
    v_cvt_pk_bf16_f32 v140, v140, v141
    v_mfma_f32_16x16x32_bf16 v[200:203], v[44:47], a[84:87], v[200:203]
    v_cvt_pk_bf16_f32 v141, v142, v143
    v_cvt_pk_bf16_f32 v142, v172, v173
    v_mfma_f32_16x16x32_bf16 v[204:207], v[40:43], a[88:91], v[204:207]
    v_cvt_pk_bf16_f32 v143, v174, v175
    v_mul_f32 v144, s74, v144
    v_mfma_f32_16x16x32_bf16 v[204:207], v[44:47], a[92:95], v[204:207]
    v_mul_f32 v145, s74, v145
    v_mul_f32 v146, s74, v146
    v_mfma_f32_16x16x32_bf16 v[208:211], v[40:43], a[96:99], v[208:211]
    v_mul_f32 v147, s74, v147
    v_mul_f32 v176, s74, v176
    v_mfma_f32_16x16x32_bf16 v[208:211], v[44:47], a[100:103], v[208:211]
    v_mul_f32 v177, s74, v177
    v_mul_f32 v178, s74, v178
    v_mfma_f32_16x16x32_bf16 v[212:215], v[40:43], a[104:107], v[212:215]
    buffer_load_dwordx4 v13, s[20:23], s63 offen offset:3072 lds
    v_mfma_f32_16x16x32_bf16 v[212:215], v[44:47], a[108:111], v[212:215]
    v_mul_f32 v179, s74, v179
    v_cvt_pk_bf16_f32 v144, v144, v145
    v_mfma_f32_16x16x32_bf16 v[216:219], v[40:43], a[112:115], v[216:219]
    v_cvt_pk_bf16_f32 v145, v146, v147
    v_cvt_pk_bf16_f32 v146, v176, v177
    v_mfma_f32_16x16x32_bf16 v[216:219], v[44:47], a[116:119], v[216:219]
    v_cvt_pk_bf16_f32 v147, v178, v179
    v_mul_f32 v148, s74, v148
    v_mfma_f32_16x16x32_bf16 v[220:223], v[40:43], a[120:123], v[220:223]
    v_mul_f32 v149, s74, v149
    v_mul_f32 v150, s74, v150
    v_mfma_f32_16x16x32_bf16 v[220:223], v[44:47], a[124:127], v[220:223]
    s_add_u32 s72, s70, 0
    v_mul_f32 v151, s74, v151
    v_mul_f32 v180, s74, v180
    s_waitcnt lgkmcnt(0)
    v_mfma_f32_16x16x32_bf16 v[224:227], v[48:51], a[64:67], v[224:227]
    buffer_store_dwordx4 v[128:131], v1, s[36:39], s72 offen sc1
    v_mfma_f32_16x16x32_bf16 v[224:227], v[52:55], a[68:71], v[224:227]
    s_xor_b32 s63, s63, 384
    v_mul_f32 v181, s74, v181
    v_mul_f32 v182, s74, v182
    v_mfma_f32_16x16x32_bf16 v[228:231], v[48:51], a[72:75], v[228:231]
    v_mul_f32 v183, s74, v183
    v_cvt_pk_bf16_f32 v148, v148, v149
    v_mfma_f32_16x16x32_bf16 v[228:231], v[52:55], a[76:79], v[228:231]
    v_cvt_pk_bf16_f32 v149, v150, v151
    v_cvt_pk_bf16_f32 v150, v180, v181
    v_mfma_f32_16x16x32_bf16 v[232:235], v[48:51], a[80:83], v[232:235]
    v_cvt_pk_bf16_f32 v151, v182, v183
    v_mul_f32 v152, s74, v152
    v_mfma_f32_16x16x32_bf16 v[232:235], v[52:55], a[84:87], v[232:235]
    s_add_u32 m0, s67, 98304
    v_mul_f32 v153, s74, v153
    v_mul_f32 v154, s74, v154
    s_waitcnt vmcnt(9) lgkmcnt(0)
    v_cmp_gt_u32 vcc, 8, v7
    s_nop 1
    s_and_b64 vcc, vcc, s[86:87]
    s_cbranch_scc1 SPIN_WA
BACK_WA:
    s_barrier
    v_mfma_f32_16x16x32_bf16 v[236:239], v[48:51], a[88:91], v[236:239]
    buffer_load_dwordx4 v1, s[28:31], s65 offen sc1 lds
    v_mfma_f32_16x16x32_bf16 v[236:239], v[52:55], a[92:95], v[236:239]
    ds_read_b64_tr_b16 v[56:57], v14 offset:0
    ds_read_b64_tr_b16 v[58:59], v14 offset:1024
    v_mfma_f32_16x16x32_bf16 v[240:243], v[48:51], a[96:99], v[240:243]
    ds_read_b64_tr_b16 v[60:61], v14 offset:8192
    ds_read_b64_tr_b16 v[62:63], v14 offset:9216
    v_mfma_f32_16x16x32_bf16 v[240:243], v[52:55], a[100:103], v[240:243]
    ds_read_b64_tr_b16 v[40:41], v15 offset:0
    ds_read_b64_tr_b16 v[42:43], v15 offset:1024
    v_mfma_f32_16x16x32_bf16 v[244:247], v[48:51], a[104:107], v[244:247]
    ds_read_b64_tr_b16 v[44:45], v15 offset:8192
    ds_read_b64_tr_b16 v[46:47], v15 offset:9216
    v_mfma_f32_16x16x32_bf16 v[244:247], v[52:55], a[108:111], v[244:247]
    v_mul_f32 v155, s74, v155
    v_mul_f32 v184, s74, v184
    v_mfma_f32_16x16x32_bf16 v[248:251], v[48:51], a[112:115], v[248:251]
    v_mul_f32 v185, s74, v185
    v_mul_f32 v186, s74, v186
    v_mfma_f32_16x16x32_bf16 v[248:251], v[52:55], a[116:119], v[248:251]
    v_mul_f32 v187, s74, v187
    v_cvt_pk_bf16_f32 v152, v152, v153
    v_mfma_f32_16x16x32_bf16 v[252:255], v[48:51], a[120:123], v[252:255]
    s_lshr_b32 s92, s2, 3
    buffer_load_dwordx4 v1, s[28:31], s65 offen offset:1024 sc1 lds
    v_mfma_f32_16x16x32_bf16 v[252:255], v[52:55], a[124:127], v[252:255]
    s_lshl2_add_u32 s92, s92, s4
    v_lshrrev_b32 v9, 4, v1
    v_min_u32 v9, 0, v9
    s_waitcnt lgkmcnt(0)
    v_mfma_f32_16x16x32_bf16 a[128:131], a[0:3], v[56:59], a[128:131]
    s_mul_i32 s92, s92, 1
    ds_read_b64_tr_b16 v[48:49], v16 offset:0
    ds_read_b64_tr_b16 v[50:51], v16 offset:1024
    v_mfma_f32_16x16x32_bf16 a[128:131], a[4:7], v[60:63], a[128:131]
    s_add_u32 s92, s92, 32
    v_add_lshl_u32 v9, v9, s92, 7
    ds_read_b64_tr_b16 v[52:53], v16 offset:8192
    v_mfma_f32_16x16x32_bf16 a[132:135], a[8:11], v[56:59], a[132:135]
    s_getpc_b64 s[92:93]
    global_load_dword v9, v9, s[92:93]
    v_mfma_f32_16x16x32_bf16 a[132:135], a[12:15], v[60:63], a[132:135]
    ds_read_b128 v[64:67], v24 offset:16384
    ds_read_b64_tr_b16 v[54:55], v16 offset:9216
    v_mfma_f32_16x16x32_bf16 a[136:139], a[16:19], v[56:59], a[136:139]
    v_cvt_pk_bf16_f32 v153, v154, v155
    v_cvt_pk_bf16_f32 v154, v184, v185
    v_mfma_f32_16x16x32_bf16 a[136:139], a[20:23], v[60:63], a[136:139]
    v_cvt_pk_bf16_f32 v155, v186, v187
    v_mul_f32 v156, s74, v156
    v_mfma_f32_16x16x32_bf16 a[140:143], a[24:27], v[56:59], a[140:143]
    s_add_u32 m0, s68, 106496
    v_mul_f32 v157, s74, v157
    v_mul_f32 v158, s74, v158
    v_mfma_f32_16x16x32_bf16 a[140:143], a[28:31], v[60:63], a[140:143]
    buffer_load_dwordx4 v6, s[20:23], s66 offen lds
    v_mfma_f32_16x16x32_bf16 a[144:147], a[32:35], v[56:59], a[144:147]
    s_add_u32 s72, s70, 4096
    v_mul_f32 v159, s74, v159
    v_mul_f32 v188, s74, v188
    v_mfma_f32_16x16x32_bf16 a[144:147], a[36:39], v[60:63], a[144:147]
    buffer_store_dwordx4 v[132:135], v1, s[36:39], s72 offen sc1
    v_mfma_f32_16x16x32_bf16 a[148:151], a[40:43], v[56:59], a[148:151]
    v_mul_f32 v189, s74, v189
    v_mul_f32 v190, s74, v190
    v_mfma_f32_16x16x32_bf16 a[148:151], a[44:47], v[60:63], a[148:151]
    v_mul_f32 v191, s74, v191
    v_cvt_pk_bf16_f32 v156, v156, v157
    v_mfma_f32_16x16x32_bf16 a[152:155], a[48:51], v[56:59], a[152:155]
    v_cvt_pk_bf16_f32 v157, v158, v159
    v_cvt_pk_bf16_f32 v158, v188, v189
    v_mfma_f32_16x16x32_bf16 a[152:155], a[52:55], v[60:63], a[152:155]
    ds_read_b128 v[68:71], v25 offset:16384
    v_cvt_pk_bf16_f32 v159, v190, v191
    v_mfma_f32_16x16x32_bf16 a[156:159], a[56:59], v[56:59], a[156:159]
    s_add_u32 m0, s69, 114688
    ds_read_b64_tr_b16 v[56:57], v17 offset:0
    ds_read_b64_tr_b16 v[58:59], v17 offset:1024
    v_mfma_f32_16x16x32_bf16 a[156:159], a[60:63], v[60:63], a[156:159]
    s_xor_b32 s65, s65, 8192
    buffer_load_dwordx4 v10, s[20:23], s64 offen lds
    v_mfma_f32_16x16x32_bf16 a[160:163], a[0:3], v[40:43], a[160:163]
    s_xor_b32 s66, s66, 128
    ds_read_b64_tr_b16 v[60:61], v17 offset:8192
    ds_read_b64_tr_b16 v[62:63], v17 offset:9216
    v_mfma_f32_16x16x32_bf16 a[160:163], a[4:7], v[44:47], a[160:163]
    v_mul_f32 v192, s74, v192
    v_mul_f32 v193, s74, v193
    v_mfma_f32_16x16x32_bf16 a[164:167], a[8:11], v[40:43], a[164:167]
    v_mul_f32 v194, s74, v194
    v_mul_f32 v195, s74, v195
    v_mfma_f32_16x16x32_bf16 a[164:167], a[12:15], v[44:47], a[164:167]
    v_mul_f32 v224, s74, v224
    v_mul_f32 v225, s74, v225
    v_mfma_f32_16x16x32_bf16 a[168:171], a[16:19], v[40:43], a[168:171]
    v_mul_f32 v226, s74, v226
    v_mul_f32 v227, s74, v227
    v_mfma_f32_16x16x32_bf16 a[168:171], a[20:23], v[44:47], a[168:171]
    v_cvt_pk_bf16_f32 v192, v192, v193
    v_cvt_pk_bf16_f32 v193, v194, v195
    v_mfma_f32_16x16x32_bf16 a[172:175], a[24:27], v[40:43], a[172:175]
    v_cvt_pk_bf16_f32 v194, v224, v225
    v_cvt_pk_bf16_f32 v195, v226, v227
    v_mfma_f32_16x16x32_bf16 a[172:175], a[28:31], v[44:47], a[172:175]
    v_mul_f32 v196, s74, v196
    v_mul_f32 v197, s74, v197
    v_mfma_f32_16x16x32_bf16 a[176:179], a[32:35], v[40:43], a[176:179]
    buffer_load_dwordx4 v11, s[20:23], s64 offen offset:1024 lds
    v_mfma_f32_16x16x32_bf16 a[176:179], a[36:39], v[44:47], a[176:179]
    ds_read_b128 v[72:75], v24 offset:24576
    v_mul_f32 v198, s74, v198
    v_mfma_f32_16x16x32_bf16 a[180:183], a[40:43], v[40:43], a[180:183]
    v_mul_f32 v199, s74, v199
    v_mul_f32 v228, s74, v228
    v_mfma_f32_16x16x32_bf16 a[180:183], a[44:47], v[44:47], a[180:183]
    v_mul_f32 v229, s74, v229
    v_mul_f32 v230, s74, v230
    v_mfma_f32_16x16x32_bf16 a[184:187], a[48:51], v[40:43], a[184:187]
    v_mul_f32 v231, s74, v231
    v_cvt_pk_bf16_f32 v196, v196, v197
    v_mfma_f32_16x16x32_bf16 a[184:187], a[52:55], v[44:47], a[184:187]
    v_cvt_pk_bf16_f32 v197, v198, v199
    v_cvt_pk_bf16_f32 v198, v228, v229
    v_mfma_f32_16x16x32_bf16 a[188:191], a[56:59], v[40:43], a[188:191]
    ds_read_b64_tr_b16 v[40:41], v14 offset:32768
    ds_read_b64_tr_b16 v[42:43], v14 offset:33792
    v_mfma_f32_16x16x32_bf16 a[188:191], a[60:63], v[44:47], a[188:191]
    s_waitcnt lgkmcnt(2)
    ds_read_b64_tr_b16 v[44:45], v14 offset:40960
    ds_read_b64_tr_b16 v[46:47], v14 offset:41984
    v_mfma_f32_16x16x32_bf16 a[192:195], a[0:3], v[48:51], a[192:195]
    buffer_load_dwordx4 v12, s[20:23], s64 offen offset:2048 lds
    v_mfma_f32_16x16x32_bf16 a[192:195], a[4:7], v[52:55], a[192:195]
    s_add_u32 s72, s70, 8192
    v_xor_b32 v14, s73, v14
    v_add_u32 v14, 0x10000, v14
    v_mfma_f32_16x16x32_bf16 a[196:199], a[8:11], v[48:51], a[196:199]
    buffer_store_dwordx4 v[136:139], v1, s[36:39], s72 offen sc1
    v_mfma_f32_16x16x32_bf16 a[196:199], a[12:15], v[52:55], a[196:199]
    ds_read_b128 v[76:79], v25 offset:24576
    v_cvt_pk_bf16_f32 v199, v230, v231
    v_mfma_f32_16x16x32_bf16 a[200:203], a[16:19], v[48:51], a[200:203]
    v_mul_f32 v200, s74, v200
    v_mul_f32 v201, s74, v201
    v_mfma_f32_16x16x32_bf16 a[200:203], a[20:23], v[52:55], a[200:203]
    v_mul_f32 v202, s74, v202
    v_mul_f32 v203, s74, v203
    v_mfma_f32_16x16x32_bf16 a[204:207], a[24:27], v[48:51], a[204:207]
    v_mul_f32 v232, s74, v232
    v_mul_f32 v233, s74, v233
    v_mfma_f32_16x16x32_bf16 a[204:207], a[28:31], v[52:55], a[204:207]
    v_mul_f32 v234, s74, v234
    v_mul_f32 v235, s74, v235
    v_mfma_f32_16x16x32_bf16 a[208:211], a[32:35], v[48:51], a[208:211]
    v_cvt_pk_bf16_f32 v200, v200, v201
    v_cvt_pk_bf16_f32 v201, v202, v203
    v_mfma_f32_16x16x32_bf16 a[208:211], a[36:39], v[52:55], a[208:211]
    buffer_load_dwordx4 v13, s[20:23], s64 offen offset:3072 lds
    v_mfma_f32_16x16x32_bf16 a[212:215], a[40:43], v[48:51], a[212:215]
    v_cvt_pk_bf16_f32 v202, v232, v233
    v_cvt_pk_bf16_f32 v203, v234, v235
    v_mfma_f32_16x16x32_bf16 a[212:215], a[44:47], v[52:55], a[212:215]
    v_mul_f32 v204, s74, v204
    v_mul_f32 v205, s74, v205
    v_mfma_f32_16x16x32_bf16 a[216:219], a[48:51], v[48:51], a[216:219]
    v_mul_f32 v206, s74, v206
    v_mul_f32 v207, s74, v207
    v_mfma_f32_16x16x32_bf16 a[216:219], a[52:55], v[52:55], a[216:219]
    v_mul_f32 v236, s74, v236
    v_mul_f32 v237, s74, v237
    v_mfma_f32_16x16x32_bf16 a[220:223], a[56:59], v[48:51], a[220:223]
    ds_read_b64_tr_b16 v[48:49], v15 offset:32768
    ds_read_b64_tr_b16 v[50:51], v15 offset:33792
    v_mfma_f32_16x16x32_bf16 a[220:223], a[60:63], v[52:55], a[220:223]
    ds_read_b64_tr_b16 v[52:53], v15 offset:40960
    ds_read_b64_tr_b16 v[54:55], v15 offset:41984
    v_mfma_f32_16x16x32_bf16 a[224:227], a[0:3], v[56:59], a[224:227]
    v_xor_b32 v15, s73, v15
    v_add_u32 v15, 0x10000, v15
    v_mfma_f32_16x16x32_bf16 a[224:227], a[4:7], v[60:63], a[224:227]
    s_xor_b32 s64, s64, 384
    v_accvgpr_write_b32 a4, v192
    v_accvgpr_write_b32 a5, v193
    v_mfma_f32_16x16x32_bf16 a[228:231], a[8:11], v[56:59], a[228:231]
    v_accvgpr_write_b32 a6, v194
    v_accvgpr_write_b32 a7, v195
    v_mfma_f32_16x16x32_bf16 a[228:231], a[12:15], v[60:63], a[228:231]
    v_accvgpr_write_b32 a12, v196
    v_accvgpr_write_b32 a13, v197
    v_mfma_f32_16x16x32_bf16 a[232:235], a[16:19], v[56:59], a[232:235]
    v_accvgpr_write_b32 a14, v198
    v_accvgpr_write_b32 a15, v199
    v_mfma_f32_16x16x32_bf16 a[232:235], a[20:23], v[60:63], a[232:235]
    s_add_u32 m0, s69, 131072
    v_mul_f32 v238, s74, v238
    v_mul_f32 v239, s74, v239
    v_mfma_f32_16x16x32_bf16 a[236:239], a[24:27], v[56:59], a[236:239]
    buffer_load_dwordx4 v2, s[24:27], s60 offen lds
    v_mfma_f32_16x16x32_bf16 a[236:239], a[28:31], v[60:63], a[236:239]
    v_accvgpr_write_b32 a20, v200
    v_accvgpr_write_b32 a21, v201
    v_mfma_f32_16x16x32_bf16 a[240:243], a[32:35], v[56:59], a[240:243]
    v_accvgpr_write_b32 a22, v202
    v_accvgpr_write_b32 a23, v203
    v_mfma_f32_16x16x32_bf16 a[240:243], a[36:39], v[60:63], a[240:243]
    v_cvt_pk_bf16_f32 v204, v204, v205
    v_cvt_pk_bf16_f32 v205, v206, v207
    v_mfma_f32_16x16x32_bf16 a[244:247], a[40:43], v[56:59], a[244:247]
    s_add_u32 s72, s70, 12288
    v_accvgpr_write_b32 a40, v148
    v_accvgpr_write_b32 a41, v149
    v_mfma_f32_16x16x32_bf16 a[244:247], a[44:47], v[60:63], a[244:247]
    buffer_store_dwordx4 v[140:143], v1, s[36:39], s72 offen sc1
    v_mfma_f32_16x16x32_bf16 a[248:251], a[48:51], v[56:59], a[248:251]
    v_accvgpr_write_b32 a42, v150
    v_accvgpr_write_b32 a43, v151
    v_mfma_f32_16x16x32_bf16 a[248:251], a[52:55], v[60:63], a[248:251]
    buffer_load_dwordx4 v3, s[24:27], s60 offen offset:1024 lds
    v_mfma_f32_16x16x32_bf16 a[252:255], a[56:59], v[56:59], a[252:255]
    ds_read_b64_tr_b16 v[56:57], v16 offset:32768
    ds_read_b64_tr_b16 v[58:59], v16 offset:33792
    v_mfma_f32_16x16x32_bf16 a[252:255], a[60:63], v[60:63], a[252:255]
    s_waitcnt lgkmcnt(2)
    ds_read_b64_tr_b16 v[60:61], v16 offset:40960
    ds_read_b64_tr_b16 v[62:63], v16 offset:41984
    v_mfma_f32_16x16x32_bf16 a[128:131], a[64:67], v[40:43], a[128:131]
    v_xor_b32 v16, s73, v16
    v_add_u32 v16, 0x10000, v16
    v_mfma_f32_16x16x32_bf16 a[128:131], a[68:71], v[44:47], a[128:131]
    v_accvgpr_write_b32 a48, v152
    v_accvgpr_write_b32 a49, v153
    v_mfma_f32_16x16x32_bf16 a[132:135], a[72:75], v[40:43], a[132:135]
    ds_read_b128 v[80:83], v24 offset:49152
    v_accvgpr_write_b32 a50, v154
    v_mfma_f32_16x16x32_bf16 a[132:135], a[76:79], v[44:47], a[132:135]
    v_accvgpr_write_b32 a51, v155
    v_accvgpr_write_b32 a56, v156
    v_mfma_f32_16x16x32_bf16 a[136:139], a[80:83], v[40:43], a[136:139]
    v_accvgpr_write_b32 a57, v157
    v_accvgpr_write_b32 a58, v158
    v_mfma_f32_16x16x32_bf16 a[136:139], a[84:87], v[44:47], a[136:139]
    buffer_load_dwordx4 v4, s[24:27], s60 offen offset:2048 lds
    v_mfma_f32_16x16x32_bf16 a[140:143], a[88:91], v[40:43], a[140:143]
    v_accvgpr_write_b32 a59, v159
    v_cvt_pk_bf16_f32 v206, v236, v237
    v_mfma_f32_16x16x32_bf16 a[140:143], a[92:95], v[44:47], a[140:143]
    v_cvt_pk_bf16_f32 v207, v238, v239
    v_mul_f32 v208, s74, v208
    v_mfma_f32_16x16x32_bf16 a[144:147], a[96:99], v[40:43], a[144:147]
    v_mul_f32 v209, s74, v209
    v_mul_f32 v210, s74, v210
    v_mfma_f32_16x16x32_bf16 a[144:147], a[100:103], v[44:47], a[144:147]
    v_mul_f32 v211, s74, v211
    v_mul_f32 v240, s74, v240
    v_mfma_f32_16x16x32_bf16 a[148:151], a[104:107], v[40:43], a[148:151]
    v_mul_f32 v241, s74, v241
    v_mul_f32 v242, s74, v242
    v_mfma_f32_16x16x32_bf16 a[148:151], a[108:111], v[44:47], a[148:151]
    v_mul_f32 v243, s74, v243
    v_accvgpr_write_b32 a28, v204
    v_mfma_f32_16x16x32_bf16 a[152:155], a[112:115], v[40:43], a[152:155]
    buffer_load_dwordx4 v5, s[24:27], s60 offen offset:3072 lds
    v_mfma_f32_16x16x32_bf16 a[152:155], a[116:119], v[44:47], a[152:155]
    ds_read_b128 v[84:87], v25 offset:49152
    v_accvgpr_write_b32 a29, v205
    v_mfma_f32_16x16x32_bf16 a[156:159], a[120:123], v[40:43], a[156:159]
    ds_read_b64_tr_b16 v[40:41], v17 offset:32768
    ds_read_b64_tr_b16 v[42:43], v17 offset:33792
    v_mfma_f32_16x16x32_bf16 a[156:159], a[124:127], v[44:47], a[156:159]
    ds_read_b64_tr_b16 v[44:45], v17 offset:40960
    ds_read_b64_tr_b16 v[46:47], v17 offset:41984
    v_mfma_f32_16x16x32_bf16 a[160:163], a[64:67], v[48:51], a[160:163]
    v_xor_b32 v17, s73, v17
    v_add_u32 v17, 0x10000, v17
    v_mfma_f32_16x16x32_bf16 a[160:163], a[68:71], v[52:55], a[160:163]
    v_accvgpr_write_b32 a30, v206
    v_accvgpr_write_b32 a31, v207
    v_mfma_f32_16x16x32_bf16 a[164:167], a[72:75], v[48:51], a[164:167]
    v_cvt_pk_bf16_f32 v208, v208, v209
    v_cvt_pk_bf16_f32 v209, v210, v211
    v_mfma_f32_16x16x32_bf16 a[164:167], a[76:79], v[52:55], a[164:167]
    s_add_u32 m0, s69, 147456
    v_cvt_pk_bf16_f32 v210, v240, v241
    v_cvt_pk_bf16_f32 v211, v242, v243
    v_mfma_f32_16x16x32_bf16 a[168:171], a[80:83], v[48:51], a[168:171]
    s_xor_b32 s60, s60, 1572864
    buffer_load_dwordx4 v10, s[20:23], s63 offen lds
    v_mfma_f32_16x16x32_bf16 a[168:171], a[84:87], v[52:55], a[168:171]
    s_add_u32 s72, s70, 32768
    buffer_store_dwordx4 v[144:147], v1, s[36:39], s72 offen sc1
    v_mfma_f32_16x16x32_bf16 a[172:175], a[88:91], v[48:51], a[172:175]
    v_mul_f32 v212, s74, v212
    v_mul_f32 v213, s74, v213
    v_mfma_f32_16x16x32_bf16 a[172:175], a[92:95], v[52:55], a[172:175]
    v_mul_f32 v214, s74, v214
    v_mul_f32 v215, s74, v215
    v_mfma_f32_16x16x32_bf16 a[176:179], a[96:99], v[48:51], a[176:179]
    ds_read_b128 v[88:91], v24 offset:57344
    v_mul_f32 v244, s74, v244
    v_mfma_f32_16x16x32_bf16 a[176:179], a[100:103], v[52:55], a[176:179]
    v_mul_f32 v245, s74, v245
    v_mul_f32 v246, s74, v246
    v_mfma_f32_16x16x32_bf16 a[180:183], a[104:107], v[48:51], a[180:183]
    v_mul_f32 v247, s74, v247
    v_accvgpr_write_b32 a36, v208
    v_mfma_f32_16x16x32_bf16 a[180:183], a[108:111], v[52:55], a[180:183]
    buffer_load_dwordx4 v11, s[20:23], s63 offen offset:1024 lds
    v_mfma_f32_16x16x32_bf16 a[184:187], a[112:115], v[48:51], a[184:187]
    v_accvgpr_write_b32 a37, v209
    v_accvgpr_write_b32 a38, v210
    v_mfma_f32_16x16x32_bf16 a[184:187], a[116:119], v[52:55], a[184:187]
    v_accvgpr_write_b32 a39, v211
    v_cvt_pk_bf16_f32 v212, v212, v213
    v_mfma_f32_16x16x32_bf16 a[188:191], a[120:123], v[48:51], a[188:191]
    v_cvt_pk_bf16_f32 v213, v214, v215
    v_cvt_pk_bf16_f32 v214, v244, v245
    v_mfma_f32_16x16x32_bf16 a[188:191], a[124:127], v[52:55], a[188:191]
    s_waitcnt lgkmcnt(0)
    v_cvt_pk_bf16_f32 v215, v246, v247
    v_mul_f32 v216, s74, v216
    v_mfma_f32_16x16x32_bf16 a[192:195], a[64:67], v[56:59], a[192:195]
    v_mul_f32 v217, s74, v217
    v_mul_f32 v218, s74, v218
    v_mfma_f32_16x16x32_bf16 a[192:195], a[68:71], v[60:63], a[192:195]
    v_accvgpr_read_b32 v32, a128
    v_accvgpr_read_b32 v31, a129
    v_mfma_f32_16x16x32_bf16 a[196:199], a[72:75], v[56:59], a[196:199]
    v_cvt_pk_bf16_f32 v32, v32, v31
    v_accvgpr_read_b32 v33, a130
    v_mfma_f32_16x16x32_bf16 a[196:199], a[76:79], v[60:63], a[196:199]
    buffer_load_dwordx4 v12, s[20:23], s63 offen offset:2048 lds
    v_mfma_f32_16x16x32_bf16 a[200:203], a[80:83], v[56:59], a[200:203]
    ds_read_b128 v[92:95], v25 offset:57344
    v_accvgpr_read_b32 v31, a131
    v_mfma_f32_16x16x32_bf16 a[200:203], a[84:87], v[60:63], a[200:203]
    v_cvt_pk_bf16_f32 v33, v33, v31
    v_accvgpr_read_b32 v34, a132
    v_mfma_f32_16x16x32_bf16 a[204:207], a[88:91], v[56:59], a[204:207]
    v_accvgpr_read_b32 v31, a133
    v_cvt_pk_bf16_f32 v34, v34, v31
    v_mfma_f32_16x16x32_bf16 a[204:207], a[92:95], v[60:63], a[204:207]
    v_accvgpr_read_b32 v35, a134
    v_accvgpr_read_b32 v31, a135
    v_mfma_f32_16x16x32_bf16 a[208:211], a[96:99], v[56:59], a[208:211]
    v_cvt_pk_bf16_f32 v35, v35, v31
    v_mul_f32 v219, s74, v219
    v_mfma_f32_16x16x32_bf16 a[208:211], a[100:103], v[60:63], a[208:211]
    v_mul_f32 v248, s74, v248
    v_mul_f32 v249, s74, v249
    v_mfma_f32_16x16x32_bf16 a[212:215], a[104:107], v[56:59], a[212:215]
    buffer_load_dwordx4 v13, s[20:23], s63 offen offset:3072 lds
    v_mfma_f32_16x16x32_bf16 a[212:215], a[108:111], v[60:63], a[212:215]
    v_mul_f32 v250, s74, v250
    v_mul_f32 v251, s74, v251
    v_mfma_f32_16x16x32_bf16 a[216:219], a[112:115], v[56:59], a[216:219]
    s_add_u32 s72, s71, 0
    v_accvgpr_write_b32 a44, v212
    v_accvgpr_write_b32 a45, v213
    v_mfma_f32_16x16x32_bf16 a[216:219], a[116:119], v[60:63], a[216:219]
    buffer_store_dwordx4 v[32:35], v1, s[36:39], s72 offen sc1
    v_mfma_f32_16x16x32_bf16 a[220:223], a[120:123], v[56:59], a[220:223]
    v_accvgpr_write_b32 a46, v214
    v_accvgpr_write_b32 a47, v215
    v_mfma_f32_16x16x32_bf16 a[220:223], a[124:127], v[60:63], a[220:223]
    v_cvt_pk_bf16_f32 v216, v216, v217
    v_cvt_pk_bf16_f32 v217, v218, v219
    v_mfma_f32_16x16x32_bf16 a[224:227], a[64:67], v[40:43], a[224:227]
    v_cvt_pk_bf16_f32 v218, v248, v249
    v_cvt_pk_bf16_f32 v219, v250, v251
    v_mfma_f32_16x16x32_bf16 a[224:227], a[68:71], v[44:47], a[224:227]
    s_xor_b32 s63, s63, 128
    v_mul_f32 v220, s74, v220
    v_mul_f32 v221, s74, v221
    v_mfma_f32_16x16x32_bf16 a[228:231], a[72:75], v[40:43], a[228:231]
    v_mul_f32 v222, s74, v222
    v_mul_f32 v223, s74, v223
    v_mfma_f32_16x16x32_bf16 a[228:231], a[76:79], v[44:47], a[228:231]
    v_mul_f32 v252, s74, v252
    v_mul_f32 v253, s74, v253
    v_mfma_f32_16x16x32_bf16 a[232:235], a[80:83], v[40:43], a[232:235]
    v_mul_f32 v254, s74, v254
    v_mul_f32 v255, s74, v255
    v_mfma_f32_16x16x32_bf16 a[232:235], a[84:87], v[44:47], a[232:235]
    s_waitcnt vmcnt(11) lgkmcnt(0)
    s_barrier
    ds_read_b64_tr_b16 v[48:49], v14 offset:0
    v_mfma_f32_16x16x32_bf16 a[236:239], a[88:91], v[40:43], a[236:239]
    s_add_u32 m0, s67, 0
    ds_read_b64_tr_b16 v[50:51], v14 offset:1024
    ds_read_b64_tr_b16 v[52:53], v14 offset:8192
    v_mfma_f32_16x16x32_bf16 a[236:239], a[92:95], v[44:47], a[236:239]
    buffer_load_dwordx4 v1, s[28:31], s65 offen sc1 lds
    v_mfma_f32_16x16x32_bf16 a[240:243], a[96:99], v[40:43], a[240:243]
    ds_read_b64_tr_b16 v[54:55], v14 offset:9216
    ds_read_b64_tr_b16 v[56:57], v15 offset:0
    v_mfma_f32_16x16x32_bf16 a[240:243], a[100:103], v[44:47], a[240:243]
    ds_read_b64_tr_b16 v[58:59], v15 offset:1024
    ds_read_b64_tr_b16 v[60:61], v15 offset:8192
    v_mfma_f32_16x16x32_bf16 a[244:247], a[104:107], v[40:43], a[244:247]
    ds_read_b64_tr_b16 v[62:63], v15 offset:9216
    v_add_u32 v14, 0x10000, v14
    v_mfma_f32_16x16x32_bf16 a[244:247], a[108:111], v[44:47], a[244:247]
    v_add_u32 v15, 0x10000, v15
    v_accvgpr_read_b32 v32, a136
    v_mfma_f32_16x16x32_bf16 a[248:251], a[112:115], v[40:43], a[248:251]
    v_accvgpr_read_b32 v31, a137
    v_cvt_pk_bf16_f32 v32, v32, v31
    v_mfma_f32_16x16x32_bf16 a[248:251], a[116:119], v[44:47], a[248:251]
    v_accvgpr_read_b32 v33, a138
    v_accvgpr_read_b32 v31, a139
    v_mfma_f32_16x16x32_bf16 a[252:255], a[120:123], v[40:43], a[252:255]
    buffer_load_dwordx4 v1, s[28:31], s65 offen offset:1024 sc1 lds
    v_mfma_f32_16x16x32_bf16 a[252:255], a[124:127], v[44:47], a[252:255]
    s_waitcnt lgkmcnt(0)
    ds_read_b64_tr_b16 v[40:41], v16 offset:0
    ds_read_b64_tr_b16 v[42:43], v16 offset:1024
    v_mfma_f32_16x16x32_bf16 v[128:131], v[48:51], v[64:67], 0
    ds_read_b64_tr_b16 v[44:45], v16 offset:8192
    ds_read_b64_tr_b16 v[46:47], v16 offset:9216
    v_mfma_f32_16x16x32_bf16 v[128:131], v[52:55], v[68:71], v[128:131]
    v_add_u32 v24, 0x10000, v24
    ds_read_b128 a[136:139], v22 offset:32768
    v_mfma_f32_16x16x32_bf16 v[132:135], v[48:51], v[72:75], 0
    ds_read_b128 v[96:99], v24 offset:16384
    v_add_u32 v16, 0x10000, v16
    v_mfma_f32_16x16x32_bf16 v[132:135], v[52:55], v[76:79], v[132:135]
    v_add_u32 v22, 0xffff0000, v22
    v_cvt_pk_bf16_f32 v33, v33, v31
    v_mfma_f32_16x16x32_bf16 v[136:139], v[48:51], v[80:83], 0
    v_accvgpr_read_b32 v34, a140
    v_accvgpr_read_b32 v31, a141
    v_mfma_f32_16x16x32_bf16 v[136:139], v[52:55], v[84:87], v[136:139]
    s_add_u32 s72, s71, 1024
    v_cvt_pk_bf16_f32 v34, v34, v31
    v_accvgpr_read_b32 v35, a142
    v_mfma_f32_16x16x32_bf16 v[140:143], v[48:51], v[88:91], 0
    s_add_u32 m0, s68, 8192
    ds_read_b64_tr_b16 v[48:49], v17 offset:0
    ds_read_b64_tr_b16 v[50:51], v17 offset:1024
    v_mfma_f32_16x16x32_bf16 v[140:143], v[52:55], v[92:95], v[140:143]
    buffer_load_dwordx4 v6, s[20:23], s66 offen lds
    v_mfma_f32_16x16x32_bf16 v[144:147], v[56:59], v[64:67], 0
    ds_read_b64_tr_b16 v[52:53], v17 offset:8192
    ds_read_b64_tr_b16 v[54:55], v17 offset:9216
    v_mfma_f32_16x16x32_bf16 v[144:147], v[60:63], v[68:71], v[144:147]
    v_add_u32 v17, 0x10000, v17
    v_accvgpr_read_b32 v31, a143
    v_mfma_f32_16x16x32_bf16 v[148:151], v[56:59], v[72:75], 0
    ds_read_b128 a[140:143], v23 offset:32768
    v_add_u32 v23, 0xffff0000, v23
    v_mfma_f32_16x16x32_bf16 v[148:151], v[60:63], v[76:79], v[148:151]
    v_cvt_pk_bf16_f32 v35, v35, v31
    v_accvgpr_write_b32 a52, v216
    v_mfma_f32_16x16x32_bf16 v[152:155], v[56:59], v[80:83], 0
    v_add_u32 v25, 0x10000, v25
    v_accvgpr_write_b32 a53, v217
    v_mfma_f32_16x16x32_bf16 v[152:155], v[60:63], v[84:87], v[152:155]
    ds_read_b128 v[100:103], v25 offset:16384
    v_accvgpr_write_b32 a54, v218
    v_mfma_f32_16x16x32_bf16 v[156:159], v[56:59], v[88:91], 0
    s_add_u32 m0, s69, 16384
    ds_read_b64_tr_b16 v[56:57], v18 offset:0
    ds_read_b64_tr_b16 v[58:59], v18 offset:1024
    v_mfma_f32_16x16x32_bf16 v[156:159], v[60:63], v[92:95], v[156:159]
    s_xor_b32 s65, s65, 24576
    buffer_load_dwordx4 v10, s[20:23], s64 offen lds
    s_waitcnt lgkmcnt(3)
    v_mfma_f32_16x16x32_bf16 v[160:163], v[40:43], v[64:67], 0
    s_xor_b32 s66, s66, 384
    ds_read_b64_tr_b16 v[60:61], v18 offset:8192
    ds_read_b64_tr_b16 v[62:63], v18 offset:9216
    v_mfma_f32_16x16x32_bf16 v[160:163], v[44:47], v[68:71], v[160:163]
    v_add_u32 v18, 0x10000, v18
    v_accvgpr_write_b32 a55, v219
    v_mfma_f32_16x16x32_bf16 v[164:167], v[40:43], v[72:75], 0
    buffer_store_dwordx4 v[32:35], v1, s[36:39], s72 offen sc1
    v_mfma_f32_16x16x32_bf16 v[164:167], v[44:47], v[76:79], v[164:167]
    v_cvt_pk_bf16_f32 v220, v220, v221
    v_cvt_pk_bf16_f32 v221, v222, v223
    v_mfma_f32_16x16x32_bf16 v[168:171], v[40:43], v[80:83], 0
    v_cvt_pk_bf16_f32 v222, v252, v253
    v_cvt_pk_bf16_f32 v223, v254, v255
    v_mfma_f32_16x16x32_bf16 v[168:171], v[44:47], v[84:87], v[168:171]
    v_accvgpr_write_b32 a60, v220
    v_accvgpr_write_b32 a61, v221
    v_mfma_f32_16x16x32_bf16 v[172:175], v[40:43], v[88:91], 0
    ds_read_b64_tr_b16 v[40:41], v19 offset:0
    ds_read_b64_tr_b16 v[42:43], v19 offset:1024
    v_mfma_f32_16x16x32_bf16 v[172:175], v[44:47], v[92:95], v[172:175]
    ds_read_b64_tr_b16 v[44:45], v19 offset:8192
    ds_read_b64_tr_b16 v[46:47], v19 offset:9216
    v_mfma_f32_16x16x32_bf16 v[176:179], v[48:51], v[64:67], 0
    buffer_load_dwordx4 v11, s[20:23], s64 offen offset:1024 lds
    v_mfma_f32_16x16x32_bf16 v[176:179], v[52:55], v[68:71], v[176:179]
    ds_read_b128 v[104:107], v24 offset:24576
    v_add_u32 v19, 0x10000, v19
    v_mfma_f32_16x16x32_bf16 v[180:183], v[48:51], v[72:75], 0
    v_accvgpr_write_b32 a62, v222
    v_accvgpr_write_b32 a63, v223
    v_mfma_f32_16x16x32_bf16 v[180:183], v[52:55], v[76:79], v[180:183]
    v_accvgpr_write_b32 a0, 0
    v_accvgpr_write_b32 a1, 0
    v_mfma_f32_16x16x32_bf16 v[184:187], v[48:51], v[80:83], 0
    v_accvgpr_write_b32 a2, 0
    v_accvgpr_write_b32 a3, 0
    v_mfma_f32_16x16x32_bf16 v[184:187], v[52:55], v[84:87], v[184:187]
    v_accvgpr_write_b32 a8, 0
    v_accvgpr_write_b32 a9, 0
    v_mfma_f32_16x16x32_bf16 v[188:191], v[48:51], v[88:91], 0
    s_add_u32 s72, s70, 36864
    ds_read_b64_tr_b16 v[48:49], v20 offset:0
    ds_read_b64_tr_b16 v[50:51], v20 offset:1024
    v_mfma_f32_16x16x32_bf16 v[188:191], v[52:55], v[92:95], v[188:191]
    s_waitcnt lgkmcnt(2)
    ds_read_b64_tr_b16 v[52:53], v20 offset:8192
    ds_read_b64_tr_b16 v[54:55], v20 offset:9216
    v_mfma_f32_16x16x32_bf16 v[192:195], v[56:59], v[64:67], 0
    buffer_load_dwordx4 v12, s[20:23], s64 offen offset:2048 lds
    v_mfma_f32_16x16x32_bf16 v[192:195], v[60:63], v[68:71], v[192:195]
    v_add_u32 v20, 0x10000, v20
    v_accvgpr_write_b32 a10, 0
    v_mfma_f32_16x16x32_bf16 v[196:199], v[56:59], v[72:75], 0
    buffer_store_dwordx4 a[40:43], v1, s[36:39], s72 offen sc1
    v_mfma_f32_16x16x32_bf16 v[196:199], v[60:63], v[76:79], v[196:199]
    ds_read_b128 v[108:111], v25 offset:24576
    v_accvgpr_write_b32 a11, 0
    v_mfma_f32_16x16x32_bf16 v[200:203], v[56:59], v[80:83], 0
    v_accvgpr_write_b32 a16, 0
    v_accvgpr_write_b32 a17, 0
    v_mfma_f32_16x16x32_bf16 v[200:203], v[60:63], v[84:87], v[200:203]
    v_accvgpr_write_b32 a18, 0
    v_accvgpr_write_b32 a19, 0
    v_mfma_f32_16x16x32_bf16 v[204:207], v[56:59], v[88:91], 0
    ds_read_b64_tr_b16 v[56:57], v21 offset:0
    ds_read_b64_tr_b16 v[58:59], v21 offset:1024
    v_mfma_f32_16x16x32_bf16 v[204:207], v[60:63], v[92:95], v[204:207]
    ds_read_b64_tr_b16 v[60:61], v21 offset:8192
    ds_read_b64_tr_b16 v[62:63], v21 offset:9216
    v_mfma_f32_16x16x32_bf16 v[208:211], v[40:43], v[64:67], 0
    v_add_u32 v21, 0x10000, v21
    v_accvgpr_write_b32 a24, 0
    v_mfma_f32_16x16x32_bf16 v[208:211], v[44:47], v[68:71], v[208:211]
    buffer_load_dwordx4 v13, s[20:23], s64 offen offset:3072 lds
    v_mfma_f32_16x16x32_bf16 v[212:215], v[40:43], v[72:75], 0
    v_accvgpr_write_b32 a25, 0
    v_accvgpr_write_b32 a26, 0
    v_mfma_f32_16x16x32_bf16 v[212:215], v[44:47], v[76:79], v[212:215]
    v_accvgpr_write_b32 a27, 0
    v_accvgpr_write_b32 a32, 0
    v_mfma_f32_16x16x32_bf16 v[216:219], v[40:43], v[80:83], 0
    v_accvgpr_write_b32 a33, 0
    v_accvgpr_write_b32 a34, 0
    v_mfma_f32_16x16x32_bf16 v[216:219], v[44:47], v[84:87], v[216:219]
    v_accvgpr_write_b32 a35, 0
    v_accvgpr_write_b32 a40, 0
    v_mfma_f32_16x16x32_bf16 v[220:223], v[40:43], v[88:91], 0
    ds_read_b64_tr_b16 v[40:41], v26 offset:32768
    ds_read_b64_tr_b16 v[42:43], v26 offset:33280
    v_mfma_f32_16x16x32_bf16 v[220:223], v[44:47], v[92:95], v[220:223]
    s_waitcnt lgkmcnt(2)
    ds_read_b64_tr_b16 v[44:45], v26 offset:36864
    ds_read_b64_tr_b16 v[46:47], v26 offset:37376
    v_mfma_f32_16x16x32_bf16 v[224:227], v[48:51], v[64:67], 0
    v_add_u32 v26, 0xffff0000, v26
    v_accvgpr_write_b32 a41, 0
    v_mfma_f32_16x16x32_bf16 v[224:227], v[52:55], v[68:71], v[224:227]
    s_xor_b32 s64, s64, 128
    v_accvgpr_write_b32 a42, 0
    v_accvgpr_write_b32 a43, 0
    v_mfma_f32_16x16x32_bf16 v[228:231], v[48:51], v[72:75], 0
    v_mfma_f32_16x16x32_bf16 v[228:231], v[52:55], v[76:79], v[228:231]
    v_mfma_f32_16x16x32_bf16 v[232:235], v[48:51], v[80:83], 0
    v_mfma_f32_16x16x32_bf16 v[232:235], v[52:55], v[84:87], v[232:235]
    s_add_u32 m0, s69, 32768
    v_mfma_f32_16x16x32_bf16 v[236:239], v[48:51], v[88:91], 0
    buffer_load_dwordx4 v2, s[24:27], s60 offen lds
    v_mfma_f32_16x16x32_bf16 v[236:239], v[52:55], v[92:95], v[236:239]
    s_add_u32 s72, s70, 40960
    ds_read_b64_tr_b16 v[48:49], v27 offset:32768
    ds_read_b64_tr_b16 v[50:51], v27 offset:33280
    v_mfma_f32_16x16x32_bf16 v[240:243], v[56:59], v[64:67], 0
    ds_read_b64_tr_b16 v[52:53], v27 offset:36864
    ds_read_b64_tr_b16 v[54:55], v27 offset:37376
    v_mfma_f32_16x16x32_bf16 v[240:243], v[60:63], v[68:71], v[240:243]
    buffer_store_dwordx4 a[48:51], v1, s[36:39], s72 offen sc1
    v_mfma_f32_16x16x32_bf16 v[244:247], v[56:59], v[72:75], 0
    buffer_load_dwordx4 v3, s[24:27], s60 offen offset:1024 lds
    v_mfma_f32_16x16x32_bf16 v[244:247], v[60:63], v[76:79], v[244:247]
    v_add_u32 v27, 0xffff0000, v27
    v_accvgpr_write_b32 a48, 0
    v_mfma_f32_16x16x32_bf16 v[248:251], v[56:59], v[80:83], 0
    v_accvgpr_write_b32 a49, 0
    v_accvgpr_write_b32 a50, 0
    v_mfma_f32_16x16x32_bf16 v[248:251], v[60:63], v[84:87], v[248:251]
    v_accvgpr_write_b32 a51, 0
    v_mfma_f32_16x16x32_bf16 v[252:255], v[56:59], v[88:91], 0
    buffer_load_dwordx4 v4, s[24:27], s60 offen offset:2048 lds
    v_mfma_f32_16x16x32_bf16 v[252:255], v[60:63], v[92:95], v[252:255]
    s_waitcnt lgkmcnt(0)
    ds_read_b64_tr_b16 v[56:57], v28 offset:32768
    ds_read_b64_tr_b16 v[58:59], v28 offset:33280
    v_mfma_f32_16x16x32_bf16 a[64:67], v[40:43], v[64:67], 0
    ds_read_b64_tr_b16 v[60:61], v28 offset:36864
    ds_read_b64_tr_b16 v[62:63], v28 offset:37376
    v_mfma_f32_16x16x32_bf16 a[64:67], v[44:47], v[68:71], a[64:67]
    v_add_u32 v28, 0xffff0000, v28
    v_mfma_f32_16x16x32_bf16 a[68:71], v[40:43], v[72:75], 0
    buffer_load_dwordx4 v5, s[24:27], s60 offen offset:3072 lds
    v_mfma_f32_16x16x32_bf16 a[68:71], v[44:47], v[76:79], a[68:71]
    ds_read_b128 v[112:115], v24 offset:49152
    v_mfma_f32_16x16x32_bf16 a[72:75], v[40:43], v[80:83], 0
    v_mfma_f32_16x16x32_bf16 a[72:75], v[44:47], v[84:87], a[72:75]
    s_add_u32 m0, s69, 49152
    v_mfma_f32_16x16x32_bf16 a[76:79], v[40:43], v[88:91], 0
    s_xor_b32 s60, s60, 524288
    buffer_load_dwordx4 v10, s[20:23], s63 offen lds
    v_mfma_f32_16x16x32_bf16 a[76:79], v[44:47], v[92:95], a[76:79]
    ds_read_b128 v[116:119], v25 offset:49152
    v_mfma_f32_16x16x32_bf16 a[128:131], v[40:43], a[136:139], 0
    ds_read_b64_tr_b16 v[40:41], v29 offset:32768
    ds_read_b64_tr_b16 v[42:43], v29 offset:33280
    v_mfma_f32_16x16x32_bf16 a[128:131], v[44:47], a[140:143], a[128:131]
    ds_read_b64_tr_b16 v[44:45], v29 offset:36864
    ds_read_b64_tr_b16 v[46:47], v29 offset:37376
    v_mfma_f32_16x16x32_bf16 a[80:83], v[48:51], v[64:67], 0
    buffer_load_dwordx4 v11, s[20:23], s63 offen offset:1024 lds
    v_mfma_f32_16x16x32_bf16 a[80:83], v[52:55], v[68:71], a[80:83]
    ds_read_b128 v[120:123], v24 offset:57344
    v_add_u32 v29, 0xffff0000, v29
    v_mfma_f32_16x16x32_bf16 a[84:87], v[48:51], v[72:75], 0
    v_mfma_f32_16x16x32_bf16 a[84:87], v[52:55], v[76:79], a[84:87]
    v_mfma_f32_16x16x32_bf16 a[88:91], v[48:51], v[80:83], 0
    buffer_load_dwordx4 v12, s[20:23], s63 offen offset:2048 lds
    v_mfma_f32_16x16x32_bf16 a[88:91], v[52:55], v[84:87], a[88:91]
    ds_read_b128 v[124:127], v25 offset:57344
    v_mfma_f32_16x16x32_bf16 a[92:95], v[48:51], v[88:91], 0
    s_add_u32 s72, s70, 45056
    v_mfma_f32_16x16x32_bf16 a[92:95], v[52:55], v[92:95], a[92:95]
    v_mfma_f32_16x16x32_bf16 a[132:135], v[48:51], a[136:139], 0
    buffer_load_dwordx4 v13, s[20:23], s63 offen offset:3072 lds
    v_mfma_f32_16x16x32_bf16 a[132:135], v[52:55], a[140:143], a[132:135]
    s_waitcnt lgkmcnt(1)
    v_mfma_f32_16x16x32_bf16 a[96:99], v[56:59], v[64:67], 0
    v_mfma_f32_16x16x32_bf16 a[96:99], v[60:63], v[68:71], a[96:99]
    s_xor_b32 s63, s63, 896
    v_mfma_f32_16x16x32_bf16 a[100:103], v[56:59], v[72:75], 0
    buffer_store_dwordx4 a[56:59], v1, s[36:39], s72 offen sc1
    v_mfma_f32_16x16x32_bf16 a[100:103], v[60:63], v[76:79], a[100:103]
    v_mfma_f32_16x16x32_bf16 a[104:107], v[56:59], v[80:83], 0
    v_accvgpr_write_b32 a56, 0
    v_accvgpr_write_b32 a57, 0
    v_mfma_f32_16x16x32_bf16 a[104:107], v[60:63], v[84:87], a[104:107]
    s_waitcnt vmcnt(10) lgkmcnt(0)
    s_barrier
    ds_read_b64_tr_b16 v[48:49], v14 offset:0
    v_mfma_f32_16x16x32_bf16 a[108:111], v[56:59], v[88:91], 0
    s_add_u32 m0, s67, 65536
    ds_read_b64_tr_b16 v[50:51], v14 offset:1024
    ds_read_b64_tr_b16 v[52:53], v14 offset:8192
    v_mfma_f32_16x16x32_bf16 a[108:111], v[60:63], v[92:95], a[108:111]
    buffer_load_dwordx4 v1, s[28:31], s65 offen sc1 lds
    v_mfma_f32_16x16x32_bf16 a[112:115], v[40:43], v[64:67], 0
    ds_read_b64_tr_b16 v[54:55], v14 offset:9216
    ds_read_b64_tr_b16 v[56:57], v15 offset:0
    v_mfma_f32_16x16x32_bf16 a[112:115], v[44:47], v[68:71], a[112:115]
    ds_read_b64_tr_b16 v[58:59], v15 offset:1024
    ds_read_b64_tr_b16 v[60:61], v15 offset:8192
    v_mfma_f32_16x16x32_bf16 a[116:119], v[40:43], v[72:75], 0
    ds_read_b64_tr_b16 v[62:63], v15 offset:9216
    ds_read_b128 a[136:139], v22 offset:0
    v_mfma_f32_16x16x32_bf16 a[116:119], v[44:47], v[76:79], a[116:119]
    ds_read_b128 a[140:143], v23 offset:0
    v_add_u32 v14, 0xfffe0000, v14
    v_mfma_f32_16x16x32_bf16 a[120:123], v[40:43], v[80:83], 0
    v_add_u32 v15, 0xfffe0000, v15
    v_add_u32 v22, 0x10000, v22
    v_mfma_f32_16x16x32_bf16 a[120:123], v[44:47], v[84:87], a[120:123]
    v_add_u32 v23, 0x10000, v23
    v_accvgpr_write_b32 a58, 0
    v_mfma_f32_16x16x32_bf16 a[124:127], v[40:43], v[88:91], 0
    buffer_load_dwordx4 v1, s[28:31], s65 offen offset:1024 sc1 lds
    v_mfma_f32_16x16x32_bf16 a[124:127], v[44:47], v[92:95], a[124:127]
    s_waitcnt lgkmcnt(1)
    ds_read_b64_tr_b16 v[40:41], v16 offset:0
    ds_read_b64_tr_b16 v[42:43], v16 offset:1024
    v_mfma_f32_16x16x32_bf16 v[128:131], v[48:51], v[96:99], v[128:131]
    ds_read_b64_tr_b16 v[44:45], v16 offset:8192
    ds_read_b64_tr_b16 v[46:47], v16 offset:9216
    v_mfma_f32_16x16x32_bf16 v[128:131], v[52:55], v[100:103], v[128:131]
    v_add_u32 v24, 0x10000, v24
    v_add_u32 v16, 0xfffe0000, v16
    v_mfma_f32_16x16x32_bf16 v[132:135], v[48:51], v[104:107], v[132:135]
    ds_read_b128 v[64:67], v24 offset:16384
    v_accvgpr_write_b32 a59, 0
    v_mfma_f32_16x16x32_bf16 v[132:135], v[52:55], v[108:111], v[132:135]
    v_mfma_f32_16x16x32_bf16 v[136:139], v[48:51], v[112:115], v[136:139]
    v_mfma_f32_16x16x32_bf16 v[136:139], v[52:55], v[116:119], v[136:139]
    s_add_u32 s72, s70, 1024
    v_mfma_f32_16x16x32_bf16 v[140:143], v[48:51], v[120:123], v[140:143]
    s_add_u32 m0, s68, 73728
    ds_read_b64_tr_b16 v[48:49], v17 offset:0
    ds_read_b64_tr_b16 v[50:51], v17 offset:1024
    v_mfma_f32_16x16x32_bf16 v[140:143], v[52:55], v[124:127], v[140:143]
    buffer_load_dwordx4 v6, s[20:23], s66 offen lds
    v_mfma_f32_16x16x32_bf16 v[144:147], v[56:59], v[96:99], v[144:147]
    ds_read_b64_tr_b16 v[52:53], v17 offset:8192
    ds_read_b64_tr_b16 v[54:55], v17 offset:9216
    v_mfma_f32_16x16x32_bf16 v[144:147], v[60:63], v[100:103], v[144:147]
    buffer_store_dwordx4 a[4:7], v1, s[36:39], s72 offen sc1
    v_mfma_f32_16x16x32_bf16 v[148:151], v[56:59], v[104:107], v[148:151]
    v_add_u32 v17, 0xfffe0000, v17
    v_accvgpr_write_b32 a4, 0
    v_mfma_f32_16x16x32_bf16 v[148:151], v[60:63], v[108:111], v[148:151]
    v_accvgpr_write_b32 a5, 0
    v_accvgpr_write_b32 a6, 0
    v_mfma_f32_16x16x32_bf16 v[152:155], v[56:59], v[112:115], v[152:155]
    v_add_u32 v25, 0x10000, v25
    v_accvgpr_write_b32 a7, 0
    v_mfma_f32_16x16x32_bf16 v[152:155], v[60:63], v[116:119], v[152:155]
    ds_read_b128 v[68:71], v25 offset:16384
    v_mfma_f32_16x16x32_bf16 v[156:159], v[56:59], v[120:123], v[156:159]
    s_add_u32 m0, s69, 81920
    ds_read_b64_tr_b16 v[56:57], v18 offset:0
    ds_read_b64_tr_b16 v[58:59], v18 offset:1024
    v_mfma_f32_16x16x32_bf16 v[156:159], v[60:63], v[124:127], v[156:159]
    s_xor_b32 s65, s65, 8192
    buffer_load_dwordx4 v10, s[20:23], s64 offen lds
    s_waitcnt lgkmcnt(3)
    v_mfma_f32_16x16x32_bf16 v[160:163], v[40:43], v[96:99], v[160:163]
    s_xor_b32 s66, s66, 128
    ds_read_b64_tr_b16 v[60:61], v18 offset:8192
    ds_read_b64_tr_b16 v[62:63], v18 offset:9216
    v_mfma_f32_16x16x32_bf16 v[160:163], v[44:47], v[100:103], v[160:163]
    v_add_u32 v18, 0xfffe0000, v18
    v_mfma_f32_16x16x32_bf16 v[164:167], v[40:43], v[104:107], v[164:167]
    v_mfma_f32_16x16x32_bf16 v[164:167], v[44:47], v[108:111], v[164:167]
    v_mfma_f32_16x16x32_bf16 v[168:171], v[40:43], v[112:115], v[168:171]
    v_mfma_f32_16x16x32_bf16 v[168:171], v[44:47], v[116:119], v[168:171]
    v_mfma_f32_16x16x32_bf16 v[172:175], v[40:43], v[120:123], v[172:175]
    ds_read_b64_tr_b16 v[40:41], v19 offset:0
    ds_read_b64_tr_b16 v[42:43], v19 offset:1024
    v_mfma_f32_16x16x32_bf16 v[172:175], v[44:47], v[124:127], v[172:175]
    ds_read_b64_tr_b16 v[44:45], v19 offset:8192
    ds_read_b64_tr_b16 v[46:47], v19 offset:9216
    v_mfma_f32_16x16x32_bf16 v[176:179], v[48:51], v[96:99], v[176:179]
    buffer_load_dwordx4 v11, s[20:23], s64 offen offset:1024 lds
    v_mfma_f32_16x16x32_bf16 v[176:179], v[52:55], v[100:103], v[176:179]
    ds_read_b128 v[72:75], v24 offset:24576
    v_add_u32 v19, 0xfffe0000, v19
    v_mfma_f32_16x16x32_bf16 v[180:183], v[48:51], v[104:107], v[180:183]
    v_mfma_f32_16x16x32_bf16 v[180:183], v[52:55], v[108:111], v[180:183]
    v_mfma_f32_16x16x32_bf16 v[184:187], v[48:51], v[112:115], v[184:187]
    v_mfma_f32_16x16x32_bf16 v[184:187], v[52:55], v[116:119], v[184:187]
    v_mfma_f32_16x16x32_bf16 v[188:191], v[48:51], v[120:123], v[188:191]
    s_add_u32 s72, s70, 5120
    ds_read_b64_tr_b16 v[48:49], v20 offset:0
    ds_read_b64_tr_b16 v[50:51], v20 offset:1024
    v_mfma_f32_16x16x32_bf16 v[188:191], v[52:55], v[124:127], v[188:191]
    s_waitcnt lgkmcnt(2)
    ds_read_b64_tr_b16 v[52:53], v20 offset:8192
    ds_read_b64_tr_b16 v[54:55], v20 offset:9216
    v_mfma_f32_16x16x32_bf16 v[192:195], v[56:59], v[96:99], v[192:195]
    buffer_load_dwordx4 v12, s[20:23], s64 offen offset:2048 lds
    v_mfma_f32_16x16x32_bf16 v[192:195], v[60:63], v[100:103], v[192:195]
    buffer_store_dwordx4 a[12:15], v1, s[36:39], s72 offen sc1
    v_mfma_f32_16x16x32_bf16 v[196:199], v[56:59], v[104:107], v[196:199]
    v_add_u32 v20, 0xfffe0000, v20
    v_accvgpr_write_b32 a12, 0
    v_mfma_f32_16x16x32_bf16 v[196:199], v[60:63], v[108:111], v[196:199]
    ds_read_b128 v[76:79], v25 offset:24576
    v_accvgpr_write_b32 a13, 0
    v_mfma_f32_16x16x32_bf16 v[200:203], v[56:59], v[112:115], v[200:203]
    v_accvgpr_write_b32 a14, 0
    v_accvgpr_write_b32 a15, 0
    v_mfma_f32_16x16x32_bf16 v[200:203], v[60:63], v[116:119], v[200:203]
    v_mfma_f32_16x16x32_bf16 v[204:207], v[56:59], v[120:123], v[204:207]
    ds_read_b64_tr_b16 v[56:57], v21 offset:0
    ds_read_b64_tr_b16 v[58:59], v21 offset:1024
    v_mfma_f32_16x16x32_bf16 v[204:207], v[60:63], v[124:127], v[204:207]
    ds_read_b64_tr_b16 v[60:61], v21 offset:8192
    ds_read_b64_tr_b16 v[62:63], v21 offset:9216
    v_mfma_f32_16x16x32_bf16 v[208:211], v[40:43], v[96:99], v[208:211]
    v_add_u32 v21, 0xfffe0000, v21
    v_mfma_f32_16x16x32_bf16 v[208:211], v[44:47], v[100:103], v[208:211]
    buffer_load_dwordx4 v13, s[20:23], s64 offen offset:3072 lds
    v_mfma_f32_16x16x32_bf16 v[212:215], v[40:43], v[104:107], v[212:215]
    v_mfma_f32_16x16x32_bf16 v[212:215], v[44:47], v[108:111], v[212:215]
    v_mfma_f32_16x16x32_bf16 v[216:219], v[40:43], v[112:115], v[216:219]
    v_mfma_f32_16x16x32_bf16 v[216:219], v[44:47], v[116:119], v[216:219]
    v_mfma_f32_16x16x32_bf16 v[220:223], v[40:43], v[120:123], v[220:223]
    ds_read_b64_tr_b16 v[40:41], v26 offset:0
    ds_read_b64_tr_b16 v[42:43], v26 offset:512
    v_mfma_f32_16x16x32_bf16 v[220:223], v[44:47], v[124:127], v[220:223]
    s_waitcnt lgkmcnt(2)
    ds_read_b64_tr_b16 v[44:45], v26 offset:4096
    ds_read_b64_tr_b16 v[46:47], v26 offset:4608
    v_mfma_f32_16x16x32_bf16 v[224:227], v[48:51], v[96:99], v[224:227]
    v_add_u32 v26, 0x10000, v26
    v_mfma_f32_16x16x32_bf16 v[224:227], v[52:55], v[100:103], v[224:227]
    s_xor_b32 s64, s64, 896
    v_mfma_f32_16x16x32_bf16 v[228:231], v[48:51], v[104:107], v[228:231]
    v_mfma_f32_16x16x32_bf16 v[228:231], v[52:55], v[108:111], v[228:231]
    v_mfma_f32_16x16x32_bf16 v[232:235], v[48:51], v[112:115], v[232:235]
    v_mfma_f32_16x16x32_bf16 v[232:235], v[52:55], v[116:119], v[232:235]
    s_add_u32 m0, s69, 98304
    v_mfma_f32_16x16x32_bf16 v[236:239], v[48:51], v[120:123], v[236:239]
    buffer_load_dwordx4 v2, s[24:27], s60 offen lds
    v_mfma_f32_16x16x32_bf16 v[236:239], v[52:55], v[124:127], v[236:239]
    s_add_u32 s72, s70, 9216
    ds_read_b64_tr_b16 v[48:49], v27 offset:0
    ds_read_b64_tr_b16 v[50:51], v27 offset:512
    v_mfma_f32_16x16x32_bf16 v[240:243], v[56:59], v[96:99], v[240:243]
    ds_read_b64_tr_b16 v[52:53], v27 offset:4096
    ds_read_b64_tr_b16 v[54:55], v27 offset:4608
    v_mfma_f32_16x16x32_bf16 v[240:243], v[60:63], v[100:103], v[240:243]
    buffer_store_dwordx4 a[20:23], v1, s[36:39], s72 offen sc1
    v_mfma_f32_16x16x32_bf16 v[244:247], v[56:59], v[104:107], v[244:247]
    buffer_load_dwordx4 v3, s[24:27], s60 offen offset:1024 lds
    v_mfma_f32_16x16x32_bf16 v[244:247], v[60:63], v[108:111], v[244:247]
    v_add_u32 v27, 0x10000, v27
    v_accvgpr_write_b32 a20, 0
    v_mfma_f32_16x16x32_bf16 v[248:251], v[56:59], v[112:115], v[248:251]
    v_accvgpr_write_b32 a21, 0
    v_accvgpr_write_b32 a22, 0
    v_mfma_f32_16x16x32_bf16 v[248:251], v[60:63], v[116:119], v[248:251]
    v_accvgpr_write_b32 a23, 0
    v_mfma_f32_16x16x32_bf16 v[252:255], v[56:59], v[120:123], v[252:255]
    buffer_load_dwordx4 v4, s[24:27], s60 offen offset:2048 lds
    v_mfma_f32_16x16x32_bf16 v[252:255], v[60:63], v[124:127], v[252:255]
    s_waitcnt lgkmcnt(0)
    ds_read_b64_tr_b16 v[56:57], v28 offset:0
    ds_read_b64_tr_b16 v[58:59], v28 offset:512
    v_mfma_f32_16x16x32_bf16 a[64:67], v[40:43], v[96:99], a[64:67]
    ds_read_b64_tr_b16 v[60:61], v28 offset:4096
    ds_read_b64_tr_b16 v[62:63], v28 offset:4608
    v_mfma_f32_16x16x32_bf16 a[64:67], v[44:47], v[100:103], a[64:67]
    v_add_u32 v24, 0xfffe0000, v24
    v_add_u32 v28, 0x10000, v28
    v_mfma_f32_16x16x32_bf16 a[68:71], v[40:43], v[104:107], a[68:71]
    buffer_load_dwordx4 v5, s[24:27], s60 offen offset:3072 lds
    v_mfma_f32_16x16x32_bf16 a[68:71], v[44:47], v[108:111], a[68:71]
    ds_read_b128 v[80:83], v24 offset:16384
    v_mfma_f32_16x16x32_bf16 a[72:75], v[40:43], v[112:115], a[72:75]
    v_mfma_f32_16x16x32_bf16 a[72:75], v[44:47], v[116:119], a[72:75]
    s_add_u32 m0, s69, 114688
    v_add_u32 v25, 0xfffe0000, v25
    v_mfma_f32_16x16x32_bf16 a[76:79], v[40:43], v[120:123], a[76:79]
    s_xor_b32 s60, s60, 3670016
    buffer_load_dwordx4 v10, s[20:23], s63 offen lds
    v_mfma_f32_16x16x32_bf16 a[76:79], v[44:47], v[124:127], a[76:79]
    ds_read_b128 v[84:87], v25 offset:16384
    v_mfma_f32_16x16x32_bf16 a[128:131], v[40:43], a[136:139], a[128:131]
    ds_read_b64_tr_b16 v[40:41], v29 offset:0
    ds_read_b64_tr_b16 v[42:43], v29 offset:512
    v_mfma_f32_16x16x32_bf16 a[128:131], v[44:47], a[140:143], a[128:131]
    ds_read_b64_tr_b16 v[44:45], v29 offset:4096
    ds_read_b64_tr_b16 v[46:47], v29 offset:4608
    v_mfma_f32_16x16x32_bf16 a[80:83], v[48:51], v[96:99], a[80:83]
    buffer_load_dwordx4 v11, s[20:23], s63 offen offset:1024 lds
    v_mfma_f32_16x16x32_bf16 a[80:83], v[52:55], v[100:103], a[80:83]
    ds_read_b128 v[88:91], v24 offset:24576
    v_add_u32 v29, 0x10000, v29
    v_mfma_f32_16x16x32_bf16 a[84:87], v[48:51], v[104:107], a[84:87]
    v_mfma_f32_16x16x32_bf16 a[84:87], v[52:55], v[108:111], a[84:87]
    v_mfma_f32_16x16x32_bf16 a[88:91], v[48:51], v[112:115], a[88:91]
    buffer_load_dwordx4 v12, s[20:23], s63 offen offset:2048 lds
    v_mfma_f32_16x16x32_bf16 a[88:91], v[52:55], v[116:119], a[88:91]
    ds_read_b128 v[92:95], v25 offset:24576
    v_mfma_f32_16x16x32_bf16 a[92:95], v[48:51], v[120:123], a[92:95]
    s_add_u32 s72, s70, 13312
    v_mfma_f32_16x16x32_bf16 a[92:95], v[52:55], v[124:127], a[92:95]
    v_mfma_f32_16x16x32_bf16 a[132:135], v[48:51], a[136:139], a[132:135]
    buffer_load_dwordx4 v13, s[20:23], s63 offen offset:3072 lds
    v_mfma_f32_16x16x32_bf16 a[132:135], v[52:55], a[140:143], a[132:135]
    s_waitcnt lgkmcnt(1)
    v_mfma_f32_16x16x32_bf16 a[96:99], v[56:59], v[96:99], a[96:99]
    v_mfma_f32_16x16x32_bf16 a[96:99], v[60:63], v[100:103], a[96:99]
    s_xor_b32 s63, s63, 128
    v_mfma_f32_16x16x32_bf16 a[100:103], v[56:59], v[104:107], a[100:103]
    buffer_store_dwordx4 a[28:31], v1, s[36:39], s72 offen sc1
    v_mfma_f32_16x16x32_bf16 a[100:103], v[60:63], v[108:111], a[100:103]
    v_mfma_f32_16x16x32_bf16 a[104:107], v[56:59], v[112:115], a[104:107]
    v_accvgpr_write_b32 a28, 0
    v_accvgpr_write_b32 a29, 0
    v_mfma_f32_16x16x32_bf16 a[104:107], v[60:63], v[116:119], a[104:107]
    s_waitcnt vmcnt(10) lgkmcnt(0)
    s_barrier
    ds_read_b64_tr_b16 v[48:49], v14 offset:32768
    v_mfma_f32_16x16x32_bf16 a[108:111], v[56:59], v[120:123], a[108:111]
    s_add_u32 m0, s67, 131072
    ds_read_b64_tr_b16 v[50:51], v14 offset:33792
    ds_read_b64_tr_b16 v[52:53], v14 offset:40960
    v_mfma_f32_16x16x32_bf16 a[108:111], v[60:63], v[124:127], a[108:111]
    buffer_load_dwordx4 v1, s[28:31], s65 offen sc1 lds
    v_mfma_f32_16x16x32_bf16 a[112:115], v[40:43], v[96:99], a[112:115]
    ds_read_b64_tr_b16 v[54:55], v14 offset:41984
    ds_read_b64_tr_b16 v[56:57], v15 offset:32768
    v_mfma_f32_16x16x32_bf16 a[112:115], v[44:47], v[100:103], a[112:115]
    ds_read_b64_tr_b16 v[58:59], v15 offset:33792
    ds_read_b64_tr_b16 v[60:61], v15 offset:40960
    v_mfma_f32_16x16x32_bf16 a[116:119], v[40:43], v[104:107], a[116:119]
    ds_read_b64_tr_b16 v[62:63], v15 offset:41984
    ds_read_b128 a[136:139], v22 offset:0
    v_mfma_f32_16x16x32_bf16 a[116:119], v[44:47], v[108:111], a[116:119]
    ds_read_b128 a[140:143], v23 offset:0
    v_add_u32 v14, 0x10000, v14
    v_mfma_f32_16x16x32_bf16 a[120:123], v[40:43], v[112:115], a[120:123]
    v_add_u32 v15, 0x10000, v15
    v_add_u32 v22, 0x10000, v22
    v_mfma_f32_16x16x32_bf16 a[120:123], v[44:47], v[116:119], a[120:123]
    v_add_u32 v23, 0x10000, v23
    v_accvgpr_write_b32 a30, 0
    v_mfma_f32_16x16x32_bf16 a[124:127], v[40:43], v[120:123], a[124:127]
    buffer_load_dwordx4 v1, s[28:31], s65 offen offset:1024 sc1 lds
    v_mfma_f32_16x16x32_bf16 a[124:127], v[44:47], v[124:127], a[124:127]
    s_waitcnt lgkmcnt(1)
    ds_read_b64_tr_b16 v[40:41], v16 offset:32768
    ds_read_b64_tr_b16 v[42:43], v16 offset:33792
    v_mfma_f32_16x16x32_bf16 v[128:131], v[48:51], v[64:67], v[128:131]
    ds_read_b64_tr_b16 v[44:45], v16 offset:40960
    ds_read_b64_tr_b16 v[46:47], v16 offset:41984
    v_mfma_f32_16x16x32_bf16 v[128:131], v[52:55], v[68:71], v[128:131]
    v_add_u32 v16, 0x10000, v16
    v_accvgpr_write_b32 a31, 0
    v_mfma_f32_16x16x32_bf16 v[132:135], v[48:51], v[72:75], v[132:135]
    ds_read_b128 v[96:99], v24 offset:49152
    v_mfma_f32_16x16x32_bf16 v[132:135], v[52:55], v[76:79], v[132:135]
    v_mfma_f32_16x16x32_bf16 v[136:139], v[48:51], v[80:83], v[136:139]
    v_mfma_f32_16x16x32_bf16 v[136:139], v[52:55], v[84:87], v[136:139]
    s_add_u32 s72, s70, 33792
    v_mfma_f32_16x16x32_bf16 v[140:143], v[48:51], v[88:91], v[140:143]
    s_add_u32 m0, s68, 139264
    ds_read_b64_tr_b16 v[48:49], v17 offset:32768
    ds_read_b64_tr_b16 v[50:51], v17 offset:33792
    v_mfma_f32_16x16x32_bf16 v[140:143], v[52:55], v[92:95], v[140:143]
    buffer_load_dwordx4 v6, s[20:23], s66 offen lds
    v_mfma_f32_16x16x32_bf16 v[144:147], v[56:59], v[64:67], v[144:147]
    ds_read_b64_tr_b16 v[52:53], v17 offset:40960
    ds_read_b64_tr_b16 v[54:55], v17 offset:41984
    v_mfma_f32_16x16x32_bf16 v[144:147], v[60:63], v[68:71], v[144:147]
    buffer_store_dwordx4 a[36:39], v1, s[36:39], s72 offen sc1
    v_mfma_f32_16x16x32_bf16 v[148:151], v[56:59], v[72:75], v[148:151]
    v_add_u32 v17, 0x10000, v17
    v_accvgpr_write_b32 a36, 0
    v_mfma_f32_16x16x32_bf16 v[148:151], v[60:63], v[76:79], v[148:151]
    v_accvgpr_write_b32 a37, 0
    v_accvgpr_write_b32 a38, 0
    v_mfma_f32_16x16x32_bf16 v[152:155], v[56:59], v[80:83], v[152:155]
    v_accvgpr_write_b32 a39, 0
    v_mfma_f32_16x16x32_bf16 v[152:155], v[60:63], v[84:87], v[152:155]
    ds_read_b128 v[100:103], v25 offset:49152
    v_mfma_f32_16x16x32_bf16 v[156:159], v[56:59], v[88:91], v[156:159]
    s_add_u32 m0, s69, 147456
    ds_read_b64_tr_b16 v[56:57], v18 offset:32768
    ds_read_b64_tr_b16 v[58:59], v18 offset:33792
    v_mfma_f32_16x16x32_bf16 v[156:159], v[60:63], v[92:95], v[156:159]
    s_xor_b32 s65, s65, 57344
    buffer_load_dwordx4 v10, s[20:23], s64 offen lds
    s_waitcnt lgkmcnt(3)
    v_mfma_f32_16x16x32_bf16 v[160:163], v[40:43], v[64:67], v[160:163]
    s_xor_b32 s66, s66, 896
    ds_read_b64_tr_b16 v[60:61], v18 offset:40960
    ds_read_b64_tr_b16 v[62:63], v18 offset:41984
    v_mfma_f32_16x16x32_bf16 v[160:163], v[44:47], v[68:71], v[160:163]
    v_add_u32 v18, 0x10000, v18
    v_mfma_f32_16x16x32_bf16 v[164:167], v[40:43], v[72:75], v[164:167]
    v_mfma_f32_16x16x32_bf16 v[164:167], v[44:47], v[76:79], v[164:167]
    v_mfma_f32_16x16x32_bf16 v[168:171], v[40:43], v[80:83], v[168:171]
    v_mfma_f32_16x16x32_bf16 v[168:171], v[44:47], v[84:87], v[168:171]
    v_mfma_f32_16x16x32_bf16 v[172:175], v[40:43], v[88:91], v[172:175]
    ds_read_b64_tr_b16 v[40:41], v19 offset:32768
    ds_read_b64_tr_b16 v[42:43], v19 offset:33792
    v_mfma_f32_16x16x32_bf16 v[172:175], v[44:47], v[92:95], v[172:175]
    ds_read_b64_tr_b16 v[44:45], v19 offset:40960
    ds_read_b64_tr_b16 v[46:47], v19 offset:41984
    v_mfma_f32_16x16x32_bf16 v[176:179], v[48:51], v[64:67], v[176:179]
    buffer_load_dwordx4 v11, s[20:23], s64 offen offset:1024 lds
    v_mfma_f32_16x16x32_bf16 v[176:179], v[52:55], v[68:71], v[176:179]
    ds_read_b128 v[104:107], v24 offset:57344
    v_add_u32 v19, 0x10000, v19
    v_mfma_f32_16x16x32_bf16 v[180:183], v[48:51], v[72:75], v[180:183]
    v_mfma_f32_16x16x32_bf16 v[180:183], v[52:55], v[76:79], v[180:183]
    v_mfma_f32_16x16x32_bf16 v[184:187], v[48:51], v[80:83], v[184:187]
    v_mfma_f32_16x16x32_bf16 v[184:187], v[52:55], v[84:87], v[184:187]
    v_mfma_f32_16x16x32_bf16 v[188:191], v[48:51], v[88:91], v[188:191]
    s_add_u32 s72, s70, 37888
    ds_read_b64_tr_b16 v[48:49], v20 offset:32768
    ds_read_b64_tr_b16 v[50:51], v20 offset:33792
    v_mfma_f32_16x16x32_bf16 v[188:191], v[52:55], v[92:95], v[188:191]
    s_waitcnt lgkmcnt(2)
    ds_read_b64_tr_b16 v[52:53], v20 offset:40960
    ds_read_b64_tr_b16 v[54:55], v20 offset:41984
    v_mfma_f32_16x16x32_bf16 v[192:195], v[56:59], v[64:67], v[192:195]
    buffer_load_dwordx4 v12, s[20:23], s64 offen offset:2048 lds
    v_mfma_f32_16x16x32_bf16 v[192:195], v[60:63], v[68:71], v[192:195]
    buffer_store_dwordx4 a[44:47], v1, s[36:39], s72 offen sc1
    v_mfma_f32_16x16x32_bf16 v[196:199], v[56:59], v[72:75], v[196:199]
    v_add_u32 v20, 0x10000, v20
    v_accvgpr_write_b32 a44, 0
    v_mfma_f32_16x16x32_bf16 v[196:199], v[60:63], v[76:79], v[196:199]
    ds_read_b128 v[108:111], v25 offset:57344
    v_accvgpr_write_b32 a45, 0
    v_mfma_f32_16x16x32_bf16 v[200:203], v[56:59], v[80:83], v[200:203]
    v_accvgpr_write_b32 a46, 0
    v_accvgpr_write_b32 a47, 0
    v_mfma_f32_16x16x32_bf16 v[200:203], v[60:63], v[84:87], v[200:203]
    v_mfma_f32_16x16x32_bf16 v[204:207], v[56:59], v[88:91], v[204:207]
    ds_read_b64_tr_b16 v[56:57], v21 offset:32768
    ds_read_b64_tr_b16 v[58:59], v21 offset:33792
    v_mfma_f32_16x16x32_bf16 v[204:207], v[60:63], v[92:95], v[204:207]
    ds_read_b64_tr_b16 v[60:61], v21 offset:40960
    ds_read_b64_tr_b16 v[62:63], v21 offset:41984
    v_mfma_f32_16x16x32_bf16 v[208:211], v[40:43], v[64:67], v[208:211]
    v_add_u32 v21, 0x10000, v21
    v_mfma_f32_16x16x32_bf16 v[208:211], v[44:47], v[68:71], v[208:211]
    buffer_load_dwordx4 v13, s[20:23], s64 offen offset:3072 lds
    v_mfma_f32_16x16x32_bf16 v[212:215], v[40:43], v[72:75], v[212:215]
    v_mfma_f32_16x16x32_bf16 v[212:215], v[44:47], v[76:79], v[212:215]
    v_mfma_f32_16x16x32_bf16 v[216:219], v[40:43], v[80:83], v[216:219]
    v_mfma_f32_16x16x32_bf16 v[216:219], v[44:47], v[84:87], v[216:219]
    v_mfma_f32_16x16x32_bf16 v[220:223], v[40:43], v[88:91], v[220:223]
    ds_read_b64_tr_b16 v[40:41], v26 offset:0
    ds_read_b64_tr_b16 v[42:43], v26 offset:512
    v_mfma_f32_16x16x32_bf16 v[220:223], v[44:47], v[92:95], v[220:223]
    s_waitcnt lgkmcnt(2)
    ds_read_b64_tr_b16 v[44:45], v26 offset:4096
    ds_read_b64_tr_b16 v[46:47], v26 offset:4608
    v_mfma_f32_16x16x32_bf16 v[224:227], v[48:51], v[64:67], v[224:227]
    v_add_u32 v26, 0x10000, v26
    v_mfma_f32_16x16x32_bf16 v[224:227], v[52:55], v[68:71], v[224:227]
    s_xor_b32 s64, s64, 128
    v_mfma_f32_16x16x32_bf16 v[228:231], v[48:51], v[72:75], v[228:231]
    v_mfma_f32_16x16x32_bf16 v[228:231], v[52:55], v[76:79], v[228:231]
    v_mfma_f32_16x16x32_bf16 v[232:235], v[48:51], v[80:83], v[232:235]
    v_mfma_f32_16x16x32_bf16 v[232:235], v[52:55], v[84:87], v[232:235]
    s_add_u32 m0, s69, 0
    v_mfma_f32_16x16x32_bf16 v[236:239], v[48:51], v[88:91], v[236:239]
    buffer_load_dwordx4 v2, s[24:27], s60 offen lds
    v_mfma_f32_16x16x32_bf16 v[236:239], v[52:55], v[92:95], v[236:239]
    s_add_u32 s72, s70, 41984
    ds_read_b64_tr_b16 v[48:49], v27 offset:0
    ds_read_b64_tr_b16 v[50:51], v27 offset:512
    v_mfma_f32_16x16x32_bf16 v[240:243], v[56:59], v[64:67], v[240:243]
    ds_read_b64_tr_b16 v[52:53], v27 offset:4096
    ds_read_b64_tr_b16 v[54:55], v27 offset:4608
    v_mfma_f32_16x16x32_bf16 v[240:243], v[60:63], v[68:71], v[240:243]
    buffer_store_dwordx4 a[52:55], v1, s[36:39], s72 offen sc1
    v_mfma_f32_16x16x32_bf16 v[244:247], v[56:59], v[72:75], v[244:247]
    buffer_load_dwordx4 v3, s[24:27], s60 offen offset:1024 lds
    v_mfma_f32_16x16x32_bf16 v[244:247], v[60:63], v[76:79], v[244:247]
    v_add_u32 v27, 0x10000, v27
    v_accvgpr_write_b32 a52, 0
    v_mfma_f32_16x16x32_bf16 v[248:251], v[56:59], v[80:83], v[248:251]
    v_accvgpr_write_b32 a53, 0
    v_accvgpr_write_b32 a54, 0
    v_mfma_f32_16x16x32_bf16 v[248:251], v[60:63], v[84:87], v[248:251]
    v_accvgpr_write_b32 a55, 0
    v_mfma_f32_16x16x32_bf16 v[252:255], v[56:59], v[88:91], v[252:255]
    buffer_load_dwordx4 v4, s[24:27], s60 offen offset:2048 lds
    v_mfma_f32_16x16x32_bf16 v[252:255], v[60:63], v[92:95], v[252:255]
    s_waitcnt lgkmcnt(0)
    ds_read_b64_tr_b16 v[56:57], v28 offset:0
    ds_read_b64_tr_b16 v[58:59], v28 offset:512
    v_mfma_f32_16x16x32_bf16 a[64:67], v[40:43], v[64:67], a[64:67]
    ds_read_b64_tr_b16 v[60:61], v28 offset:4096
    ds_read_b64_tr_b16 v[62:63], v28 offset:4608
    v_mfma_f32_16x16x32_bf16 a[64:67], v[44:47], v[68:71], a[64:67]
    v_add_u32 v24, 0x10000, v24
    v_add_u32 v28, 0x10000, v28
    v_mfma_f32_16x16x32_bf16 a[68:71], v[40:43], v[72:75], a[68:71]
    buffer_load_dwordx4 v5, s[24:27], s60 offen offset:3072 lds
    v_mfma_f32_16x16x32_bf16 a[68:71], v[44:47], v[76:79], a[68:71]
    ds_read_b128 v[112:115], v24 offset:16384
    v_mfma_f32_16x16x32_bf16 a[72:75], v[40:43], v[80:83], a[72:75]
    v_mfma_f32_16x16x32_bf16 a[72:75], v[44:47], v[84:87], a[72:75]
    s_add_u32 m0, s69, 16384
    v_add_u32 v25, 0x10000, v25
    v_mfma_f32_16x16x32_bf16 a[76:79], v[40:43], v[88:91], a[76:79]
    s_xor_b32 s60, s60, 524288
    buffer_load_dwordx4 v10, s[20:23], s63 offen lds
    v_mfma_f32_16x16x32_bf16 a[76:79], v[44:47], v[92:95], a[76:79]
    ds_read_b128 v[116:119], v25 offset:16384
    v_mfma_f32_16x16x32_bf16 a[128:131], v[40:43], a[136:139], a[128:131]
    ds_read_b64_tr_b16 v[40:41], v29 offset:0
    ds_read_b64_tr_b16 v[42:43], v29 offset:512
    v_mfma_f32_16x16x32_bf16 a[128:131], v[44:47], a[140:143], a[128:131]
    ds_read_b64_tr_b16 v[44:45], v29 offset:4096
    ds_read_b64_tr_b16 v[46:47], v29 offset:4608
    v_mfma_f32_16x16x32_bf16 a[80:83], v[48:51], v[64:67], a[80:83]
    buffer_load_dwordx4 v11, s[20:23], s63 offen offset:1024 lds
    v_mfma_f32_16x16x32_bf16 a[80:83], v[52:55], v[68:71], a[80:83]
    ds_read_b128 v[120:123], v24 offset:24576
    v_add_u32 v29, 0x10000, v29
    v_mfma_f32_16x16x32_bf16 a[84:87], v[48:51], v[72:75], a[84:87]
    v_mfma_f32_16x16x32_bf16 a[84:87], v[52:55], v[76:79], a[84:87]
    v_mfma_f32_16x16x32_bf16 a[88:91], v[48:51], v[80:83], a[88:91]
    buffer_load_dwordx4 v12, s[20:23], s63 offen offset:2048 lds
    v_mfma_f32_16x16x32_bf16 a[88:91], v[52:55], v[84:87], a[88:91]
    ds_read_b128 v[124:127], v25 offset:24576
    v_mfma_f32_16x16x32_bf16 a[92:95], v[48:51], v[88:91], a[92:95]
    s_add_u32 s72, s70, 46080
    v_mfma_f32_16x16x32_bf16 a[92:95], v[52:55], v[92:95], a[92:95]
    v_mfma_f32_16x16x32_bf16 a[132:135], v[48:51], a[136:139], a[132:135]
    buffer_load_dwordx4 v13, s[20:23], s63 offen offset:3072 lds
    v_mfma_f32_16x16x32_bf16 a[132:135], v[52:55], a[140:143], a[132:135]
    s_waitcnt lgkmcnt(1)
    v_mfma_f32_16x16x32_bf16 a[96:99], v[56:59], v[64:67], a[96:99]
    v_mfma_f32_16x16x32_bf16 a[96:99], v[60:63], v[68:71], a[96:99]
    s_xor_b32 s63, s63, 384
    v_mfma_f32_16x16x32_bf16 a[100:103], v[56:59], v[72:75], a[100:103]
    buffer_store_dwordx4 a[60:63], v1, s[36:39], s72 offen sc1
    v_mfma_f32_16x16x32_bf16 a[100:103], v[60:63], v[76:79], a[100:103]
    v_mfma_f32_16x16x32_bf16 a[104:107], v[56:59], v[80:83], a[104:107]
    v_accvgpr_write_b32 a60, 0
    v_accvgpr_write_b32 a61, 0
    v_mfma_f32_16x16x32_bf16 a[104:107], v[60:63], v[84:87], a[104:107]
    s_waitcnt vmcnt(10) lgkmcnt(0)
    s_barrier
    ds_read_b64_tr_b16 v[48:49], v14 offset:32768
    v_mfma_f32_16x16x32_bf16 a[108:111], v[56:59], v[88:91], a[108:111]
    s_add_u32 m0, s67, 32768
    ds_read_b64_tr_b16 v[50:51], v14 offset:33792
    ds_read_b64_tr_b16 v[52:53], v14 offset:40960
    v_mfma_f32_16x16x32_bf16 a[108:111], v[60:63], v[92:95], a[108:111]
    buffer_load_dwordx4 v1, s[28:31], s65 offen sc1 lds
    v_mfma_f32_16x16x32_bf16 a[112:115], v[40:43], v[64:67], a[112:115]
    ds_read_b64_tr_b16 v[54:55], v14 offset:41984
    ds_read_b64_tr_b16 v[56:57], v15 offset:32768
    v_mfma_f32_16x16x32_bf16 a[112:115], v[44:47], v[68:71], a[112:115]
    ds_read_b64_tr_b16 v[58:59], v15 offset:33792
    ds_read_b64_tr_b16 v[60:61], v15 offset:40960
    v_mfma_f32_16x16x32_bf16 a[116:119], v[40:43], v[72:75], a[116:119]
    ds_read_b64_tr_b16 v[62:63], v15 offset:41984
    ds_read_b128 a[136:139], v22 offset:0
    v_mfma_f32_16x16x32_bf16 a[116:119], v[44:47], v[76:79], a[116:119]
    ds_read_b128 a[140:143], v23 offset:0
    v_add_u32 v14, 0xffff0000, v14
    v_mfma_f32_16x16x32_bf16 a[120:123], v[40:43], v[80:83], a[120:123]
    v_add_u32 v15, 0xffff0000, v15
    v_add_u32 v22, 0xfffe0000, v22
    v_mfma_f32_16x16x32_bf16 a[120:123], v[44:47], v[84:87], a[120:123]
    v_add_u32 v23, 0xfffe0000, v23
    v_accvgpr_read_b32 v32, a144
    v_mfma_f32_16x16x32_bf16 a[124:127], v[40:43], v[88:91], a[124:127]
    buffer_load_dwordx4 v1, s[28:31], s65 offen offset:1024 sc1 lds
    v_mfma_f32_16x16x32_bf16 a[124:127], v[44:47], v[92:95], a[124:127]
    s_waitcnt lgkmcnt(1)
    ds_read_b64_tr_b16 v[40:41], v16 offset:32768
    ds_read_b64_tr_b16 v[42:43], v16 offset:33792
    v_mfma_f32_16x16x32_bf16 v[128:131], v[48:51], v[96:99], v[128:131]
    ds_read_b64_tr_b16 v[44:45], v16 offset:40960
    ds_read_b64_tr_b16 v[46:47], v16 offset:41984
    v_mfma_f32_16x16x32_bf16 v[128:131], v[52:55], v[100:103], v[128:131]
    v_add_u32 v16, 0xffff0000, v16
    v_accvgpr_read_b32 v31, a145
    v_mfma_f32_16x16x32_bf16 v[132:135], v[48:51], v[104:107], v[132:135]
    ds_read_b128 v[64:67], v24 offset:49152
    v_cvt_pk_bf16_f32 v32, v32, v31
    v_mfma_f32_16x16x32_bf16 v[132:135], v[52:55], v[108:111], v[132:135]
    v_accvgpr_read_b32 v33, a146
    v_accvgpr_read_b32 v31, a147
    v_mfma_f32_16x16x32_bf16 v[136:139], v[48:51], v[112:115], v[136:139]
    v_cvt_pk_bf16_f32 v33, v33, v31
    v_accvgpr_read_b32 v34, a148
    v_mfma_f32_16x16x32_bf16 v[136:139], v[52:55], v[116:119], v[136:139]
    s_add_u32 s72, s71, 32768
    v_accvgpr_read_b32 v31, a149
    v_cvt_pk_bf16_f32 v34, v34, v31
    v_mfma_f32_16x16x32_bf16 v[140:143], v[48:51], v[120:123], v[140:143]
    s_add_u32 m0, s68, 40960
    ds_read_b64_tr_b16 v[48:49], v17 offset:32768
    ds_read_b64_tr_b16 v[50:51], v17 offset:33792
    v_mfma_f32_16x16x32_bf16 v[140:143], v[52:55], v[124:127], v[140:143]
    buffer_load_dwordx4 v6, s[20:23], s66 offen lds
    v_mfma_f32_16x16x32_bf16 v[144:147], v[56:59], v[96:99], v[144:147]
    ds_read_b64_tr_b16 v[52:53], v17 offset:40960
    ds_read_b64_tr_b16 v[54:55], v17 offset:41984
    v_mfma_f32_16x16x32_bf16 v[144:147], v[60:63], v[100:103], v[144:147]
    v_add_u32 v17, 0xffff0000, v17
    v_accvgpr_read_b32 v35, a150
    v_mfma_f32_16x16x32_bf16 v[148:151], v[56:59], v[104:107], v[148:151]
    v_accvgpr_read_b32 v31, a151
    v_cvt_pk_bf16_f32 v35, v35, v31
    v_mfma_f32_16x16x32_bf16 v[148:151], v[60:63], v[108:111], v[148:151]
    buffer_store_dwordx4 v[32:35], v1, s[36:39], s72 offen sc1
    v_mfma_f32_16x16x32_bf16 v[152:155], v[56:59], v[112:115], v[152:155]
    v_accvgpr_write_b32 a62, 0
    v_accvgpr_write_b32 a63, 0
    v_mfma_f32_16x16x32_bf16 v[152:155], v[60:63], v[116:119], v[152:155]
    ds_read_b128 v[68:71], v25 offset:49152
    v_accvgpr_write_b32 a144, 0
    v_mfma_f32_16x16x32_bf16 v[156:159], v[56:59], v[120:123], v[156:159]
    s_add_u32 m0, s69, 49152
    ds_read_b64_tr_b16 v[56:57], v18 offset:32768
    ds_read_b64_tr_b16 v[58:59], v18 offset:33792
    v_mfma_f32_16x16x32_bf16 v[156:159], v[60:63], v[124:127], v[156:159]
    s_xor_b32 s65, s65, 8192
    buffer_load_dwordx4 v10, s[20:23], s64 offen lds
    s_waitcnt lgkmcnt(3)
    v_mfma_f32_16x16x32_bf16 v[160:163], v[40:43], v[96:99], v[160:163]
    s_xor_b32 s66, s66, 128
    ds_read_b64_tr_b16 v[60:61], v18 offset:40960
    ds_read_b64_tr_b16 v[62:63], v18 offset:41984
    v_mfma_f32_16x16x32_bf16 v[160:163], v[44:47], v[100:103], v[160:163]
    v_add_u32 v18, 0xffff0000, v18
    v_accvgpr_write_b32 a145, 0
    v_mfma_f32_16x16x32_bf16 v[164:167], v[40:43], v[104:107], v[164:167]
    v_accvgpr_write_b32 a146, 0
    v_accvgpr_write_b32 a147, 0
    v_mfma_f32_16x16x32_bf16 v[164:167], v[44:47], v[108:111], v[164:167]
    v_accvgpr_read_b32 v32, a152
    v_accvgpr_read_b32 v31, a153
    v_mfma_f32_16x16x32_bf16 v[168:171], v[40:43], v[112:115], v[168:171]
    v_cvt_pk_bf16_f32 v32, v32, v31
    v_accvgpr_read_b32 v33, a154
    v_mfma_f32_16x16x32_bf16 v[168:171], v[44:47], v[116:119], v[168:171]
    v_accvgpr_read_b32 v31, a155
    v_cvt_pk_bf16_f32 v33, v33, v31
    v_mfma_f32_16x16x32_bf16 v[172:175], v[40:43], v[120:123], v[172:175]
    ds_read_b64_tr_b16 v[40:41], v19 offset:32768
    ds_read_b64_tr_b16 v[42:43], v19 offset:33792
    v_mfma_f32_16x16x32_bf16 v[172:175], v[44:47], v[124:127], v[172:175]
    ds_read_b64_tr_b16 v[44:45], v19 offset:40960
    ds_read_b64_tr_b16 v[46:47], v19 offset:41984
    v_mfma_f32_16x16x32_bf16 v[176:179], v[48:51], v[96:99], v[176:179]
    buffer_load_dwordx4 v11, s[20:23], s64 offen offset:1024 lds
    v_mfma_f32_16x16x32_bf16 v[176:179], v[52:55], v[100:103], v[176:179]
    ds_read_b128 v[72:75], v24 offset:57344
    v_add_u32 v19, 0xffff0000, v19
    v_mfma_f32_16x16x32_bf16 v[180:183], v[48:51], v[104:107], v[180:183]
    v_accvgpr_read_b32 v34, a156
    v_accvgpr_read_b32 v31, a157
    v_mfma_f32_16x16x32_bf16 v[180:183], v[52:55], v[108:111], v[180:183]
    v_cvt_pk_bf16_f32 v34, v34, v31
    v_accvgpr_read_b32 v35, a158
    v_mfma_f32_16x16x32_bf16 v[184:187], v[48:51], v[112:115], v[184:187]
    v_accvgpr_read_b32 v31, a159
    v_cvt_pk_bf16_f32 v35, v35, v31
    v_mfma_f32_16x16x32_bf16 v[184:187], v[52:55], v[116:119], v[184:187]
    v_accvgpr_write_b32 a148, 0
    v_accvgpr_write_b32 a149, 0
    v_mfma_f32_16x16x32_bf16 v[188:191], v[48:51], v[120:123], v[188:191]
    s_add_u32 s72, s71, 33792
    ds_read_b64_tr_b16 v[48:49], v20 offset:32768
    ds_read_b64_tr_b16 v[50:51], v20 offset:33792
    v_mfma_f32_16x16x32_bf16 v[188:191], v[52:55], v[124:127], v[188:191]
    s_waitcnt lgkmcnt(2)
    ds_read_b64_tr_b16 v[52:53], v20 offset:40960
    ds_read_b64_tr_b16 v[54:55], v20 offset:41984
    v_mfma_f32_16x16x32_bf16 v[192:195], v[56:59], v[96:99], v[192:195]
    buffer_load_dwordx4 v12, s[20:23], s64 offen offset:2048 lds
    v_mfma_f32_16x16x32_bf16 v[192:195], v[60:63], v[100:103], v[192:195]
    v_add_u32 v20, 0xffff0000, v20
    v_accvgpr_write_b32 a150, 0
    v_mfma_f32_16x16x32_bf16 v[196:199], v[56:59], v[104:107], v[196:199]
    buffer_store_dwordx4 v[32:35], v1, s[36:39], s72 offen sc1
    v_mfma_f32_16x16x32_bf16 v[196:199], v[60:63], v[108:111], v[196:199]
    ds_read_b128 v[76:79], v25 offset:57344
    v_accvgpr_write_b32 a151, 0
    v_mfma_f32_16x16x32_bf16 v[200:203], v[56:59], v[112:115], v[200:203]
    v_accvgpr_write_b32 a152, 0
    v_accvgpr_write_b32 a153, 0
    v_mfma_f32_16x16x32_bf16 v[200:203], v[60:63], v[116:119], v[200:203]
    v_accvgpr_write_b32 a154, 0
    v_accvgpr_write_b32 a155, 0
    v_mfma_f32_16x16x32_bf16 v[204:207], v[56:59], v[120:123], v[204:207]
    ds_read_b64_tr_b16 v[56:57], v21 offset:32768
    ds_read_b64_tr_b16 v[58:59], v21 offset:33792
    v_mfma_f32_16x16x32_bf16 v[204:207], v[60:63], v[124:127], v[204:207]
    ds_read_b64_tr_b16 v[60:61], v21 offset:40960
    ds_read_b64_tr_b16 v[62:63], v21 offset:41984
    v_mfma_f32_16x16x32_bf16 v[208:211], v[40:43], v[96:99], v[208:211]
    v_add_u32 v21, 0xffff0000, v21
    v_accvgpr_write_b32 a156, 0
    v_mfma_f32_16x16x32_bf16 v[208:211], v[44:47], v[100:103], v[208:211]
    buffer_load_dwordx4 v13, s[20:23], s64 offen offset:3072 lds
    v_mfma_f32_16x16x32_bf16 v[212:215], v[40:43], v[104:107], v[212:215]
    v_accvgpr_write_b32 a157, 0
    v_accvgpr_write_b32 a158, 0
    v_mfma_f32_16x16x32_bf16 v[212:215], v[44:47], v[108:111], v[212:215]
    v_accvgpr_write_b32 a159, 0
    v_mfma_f32_16x16x32_bf16 v[216:219], v[40:43], v[112:115], v[216:219]
    v_accvgpr_read_b32 v32, a160
    v_accvgpr_read_b32 v31, a161
    v_mfma_f32_16x16x32_bf16 v[216:219], v[44:47], v[116:119], v[216:219]
    v_cvt_pk_bf16_f32 v32, v32, v31
    v_accvgpr_read_b32 v33, a162
    v_mfma_f32_16x16x32_bf16 v[220:223], v[40:43], v[120:123], v[220:223]
    ds_read_b64_tr_b16 v[40:41], v26 offset:0
    ds_read_b64_tr_b16 v[42:43], v26 offset:512
    v_mfma_f32_16x16x32_bf16 v[220:223], v[44:47], v[124:127], v[220:223]
    s_waitcnt lgkmcnt(2)
    ds_read_b64_tr_b16 v[44:45], v26 offset:4096
    ds_read_b64_tr_b16 v[46:47], v26 offset:4608
    v_mfma_f32_16x16x32_bf16 v[224:227], v[48:51], v[96:99], v[224:227]
    v_add_u32 v26, 0xfffe0000, v26
    v_accvgpr_read_b32 v31, a163
    v_mfma_f32_16x16x32_bf16 v[224:227], v[52:55], v[100:103], v[224:227]
    s_xor_b32 s64, s64, 384
    v_cvt_pk_bf16_f32 v33, v33, v31
    v_accvgpr_read_b32 v34, a164
    v_mfma_f32_16x16x32_bf16 v[228:231], v[48:51], v[104:107], v[228:231]
    v_accvgpr_read_b32 v31, a165
    v_cvt_pk_bf16_f32 v34, v34, v31
    v_mfma_f32_16x16x32_bf16 v[228:231], v[52:55], v[108:111], v[228:231]
    v_accvgpr_read_b32 v35, a166
    v_accvgpr_read_b32 v31, a167
    v_mfma_f32_16x16x32_bf16 v[232:235], v[48:51], v[112:115], v[232:235]
    v_cvt_pk_bf16_f32 v35, v35, v31
    v_accvgpr_write_b32 a160, 0
    v_mfma_f32_16x16x32_bf16 v[232:235], v[52:55], v[116:119], v[232:235]
    s_add_u32 m0, s69, 65536
    v_accvgpr_write_b32 a161, 0
    v_accvgpr_write_b32 a162, 0
    v_mfma_f32_16x16x32_bf16 v[236:239], v[48:51], v[120:123], v[236:239]
    buffer_load_dwordx4 v2, s[24:27], s60 offen lds
    v_mfma_f32_16x16x32_bf16 v[236:239], v[52:55], v[124:127], v[236:239]
    s_add_u32 s72, s71, 2048
    ds_read_b64_tr_b16 v[48:49], v27 offset:0
    ds_read_b64_tr_b16 v[50:51], v27 offset:512
    v_mfma_f32_16x16x32_bf16 v[240:243], v[56:59], v[96:99], v[240:243]
    ds_read_b64_tr_b16 v[52:53], v27 offset:4096
    ds_read_b64_tr_b16 v[54:55], v27 offset:4608
    v_mfma_f32_16x16x32_bf16 v[240:243], v[60:63], v[100:103], v[240:243]
    v_add_u32 v27, 0xfffe0000, v27
    v_accvgpr_write_b32 a163, 0
    v_mfma_f32_16x16x32_bf16 v[244:247], v[56:59], v[104:107], v[244:247]
    buffer_load_dwordx4 v3, s[24:27], s60 offen offset:1024 lds
    v_mfma_f32_16x16x32_bf16 v[244:247], v[60:63], v[108:111], v[244:247]
    buffer_store_dwordx4 v[32:35], v1, s[36:39], s72 offen sc1
    v_mfma_f32_16x16x32_bf16 v[248:251], v[56:59], v[112:115], v[248:251]
    v_accvgpr_write_b32 a164, 0
    v_accvgpr_write_b32 a165, 0
    v_mfma_f32_16x16x32_bf16 v[248:251], v[60:63], v[116:119], v[248:251]
    v_accvgpr_write_b32 a166, 0
    v_accvgpr_write_b32 a167, 0
    v_mfma_f32_16x16x32_bf16 v[252:255], v[56:59], v[120:123], v[252:255]
    buffer_load_dwordx4 v4, s[24:27], s60 offen offset:2048 lds
    v_mfma_f32_16x16x32_bf16 v[252:255], v[60:63], v[124:127], v[252:255]
    s_waitcnt lgkmcnt(0)
    ds_read_b64_tr_b16 v[56:57], v28 offset:0
    ds_read_b64_tr_b16 v[58:59], v28 offset:512
    v_mfma_f32_16x16x32_bf16 a[64:67], v[40:43], v[96:99], a[64:67]
    ds_read_b64_tr_b16 v[60:61], v28 offset:4096
    ds_read_b64_tr_b16 v[62:63], v28 offset:4608
    v_mfma_f32_16x16x32_bf16 a[64:67], v[44:47], v[100:103], a[64:67]
    v_add_u32 v24, 0x10000, v24
    v_add_u32 v28, 0xfffe0000, v28
    v_mfma_f32_16x16x32_bf16 a[68:71], v[40:43], v[104:107], a[68:71]
    buffer_load_dwordx4 v5, s[24:27], s60 offen offset:3072 lds
    v_mfma_f32_16x16x32_bf16 a[68:71], v[44:47], v[108:111], a[68:71]
    ds_read_b128 v[80:83], v24 offset:16384
    v_mfma_f32_16x16x32_bf16 a[72:75], v[40:43], v[112:115], a[72:75]
    v_mfma_f32_16x16x32_bf16 a[72:75], v[44:47], v[116:119], a[72:75]
    s_add_u32 m0, s69, 81920
    v_add_u32 v25, 0x10000, v25
    v_accvgpr_read_b32 v32, a168
    v_mfma_f32_16x16x32_bf16 a[76:79], v[40:43], v[120:123], a[76:79]
    s_xor_b32 s60, s60, 1572864
    buffer_load_dwordx4 v10, s[20:23], s63 offen lds
    v_mfma_f32_16x16x32_bf16 a[76:79], v[44:47], v[124:127], a[76:79]
    ds_read_b128 v[84:87], v25 offset:16384
    v_accvgpr_read_b32 v31, a169
    v_mfma_f32_16x16x32_bf16 a[128:131], v[40:43], a[136:139], a[128:131]
    ds_read_b64_tr_b16 v[40:41], v29 offset:0
    ds_read_b64_tr_b16 v[42:43], v29 offset:512
    v_mfma_f32_16x16x32_bf16 a[128:131], v[44:47], a[140:143], a[128:131]
    ds_read_b64_tr_b16 v[44:45], v29 offset:4096
    ds_read_b64_tr_b16 v[46:47], v29 offset:4608
    v_mfma_f32_16x16x32_bf16 a[80:83], v[48:51], v[96:99], a[80:83]
    buffer_load_dwordx4 v11, s[20:23], s63 offen offset:1024 lds
    v_mfma_f32_16x16x32_bf16 a[80:83], v[52:55], v[100:103], a[80:83]
    ds_read_b128 v[88:91], v24 offset:24576
    v_add_u32 v29, 0xfffe0000, v29
    v_mfma_f32_16x16x32_bf16 a[84:87], v[48:51], v[104:107], a[84:87]
    v_cvt_pk_bf16_f32 v32, v32, v31
    v_accvgpr_read_b32 v33, a170
    v_mfma_f32_16x16x32_bf16 a[84:87], v[52:55], v[108:111], a[84:87]
    v_accvgpr_read_b32 v31, a171
    v_cvt_pk_bf16_f32 v33, v33, v31
    v_mfma_f32_16x16x32_bf16 a[88:91], v[48:51], v[112:115], a[88:91]
    buffer_load_dwordx4 v12, s[20:23], s63 offen offset:2048 lds
    v_mfma_f32_16x16x32_bf16 a[88:91], v[52:55], v[116:119], a[88:91]
    ds_read_b128 v[92:95], v25 offset:24576
    v_accvgpr_read_b32 v34, a172
    v_mfma_f32_16x16x32_bf16 a[92:95], v[48:51], v[120:123], a[92:95]
    s_add_u32 s72, s71, 3072
    v_accvgpr_read_b32 v31, a173
    v_cvt_pk_bf16_f32 v34, v34, v31
    v_mfma_f32_16x16x32_bf16 a[92:95], v[52:55], v[124:127], a[92:95]
    v_accvgpr_read_b32 v35, a174
    v_accvgpr_read_b32 v31, a175
    v_mfma_f32_16x16x32_bf16 a[132:135], v[48:51], a[136:139], a[132:135]
    buffer_load_dwordx4 v13, s[20:23], s63 offen offset:3072 lds
    v_mfma_f32_16x16x32_bf16 a[132:135], v[52:55], a[140:143], a[132:135]
    s_waitcnt lgkmcnt(1)
    v_cvt_pk_bf16_f32 v35, v35, v31
    v_accvgpr_write_b32 a168, 0
    v_mfma_f32_16x16x32_bf16 a[96:99], v[56:59], v[96:99], a[96:99]
    v_accvgpr_write_b32 a169, 0
    v_accvgpr_write_b32 a170, 0
    v_mfma_f32_16x16x32_bf16 a[96:99], v[60:63], v[100:103], a[96:99]
    s_xor_b32 s63, s63, 128
    v_accvgpr_write_b32 a171, 0
    v_accvgpr_write_b32 a172, 0
    v_mfma_f32_16x16x32_bf16 a[100:103], v[56:59], v[104:107], a[100:103]
    buffer_store_dwordx4 v[32:35], v1, s[36:39], s72 offen sc1
    v_mfma_f32_16x16x32_bf16 a[100:103], v[60:63], v[108:111], a[100:103]
    v_accvgpr_write_b32 a173, 0
    v_accvgpr_write_b32 a174, 0
    v_mfma_f32_16x16x32_bf16 a[104:107], v[56:59], v[112:115], a[104:107]
    v_accvgpr_write_b32 a175, 0
    v_mfma_f32_16x16x32_bf16 a[104:107], v[60:63], v[116:119], a[104:107]
    s_waitcnt vmcnt(10) lgkmcnt(0)
    s_barrier
    ds_read_b64_tr_b16 v[48:49], v14 offset:0
    v_mfma_f32_16x16x32_bf16 a[108:111], v[56:59], v[120:123], a[108:111]
    s_add_u32 m0, s67, 98304
    ds_read_b64_tr_b16 v[50:51], v14 offset:1024
    ds_read_b64_tr_b16 v[52:53], v14 offset:8192
    v_mfma_f32_16x16x32_bf16 a[108:111], v[60:63], v[124:127], a[108:111]
    buffer_load_dwordx4 v1, s[28:31], s65 offen sc1 lds
    v_mfma_f32_16x16x32_bf16 a[112:115], v[40:43], v[96:99], a[112:115]
    ds_read_b64_tr_b16 v[54:55], v14 offset:9216
    ds_read_b64_tr_b16 v[56:57], v15 offset:0
    v_mfma_f32_16x16x32_bf16 a[112:115], v[44:47], v[100:103], a[112:115]
    ds_read_b64_tr_b16 v[58:59], v15 offset:1024
    ds_read_b64_tr_b16 v[60:61], v15 offset:8192
    v_mfma_f32_16x16x32_bf16 a[116:119], v[40:43], v[104:107], a[116:119]
    ds_read_b64_tr_b16 v[62:63], v15 offset:9216
    ds_read_b128 a[136:139], v22 offset:32768
    v_mfma_f32_16x16x32_bf16 a[116:119], v[44:47], v[108:111], a[116:119]
    ds_read_b128 a[140:143], v23 offset:32768
    v_add_u32 v14, 0x10000, v14
    v_mfma_f32_16x16x32_bf16 a[120:123], v[40:43], v[112:115], a[120:123]
    v_add_u32 v15, 0x10000, v15
    v_add_u32 v22, 0x10000, v22
    v_mfma_f32_16x16x32_bf16 a[120:123], v[44:47], v[116:119], a[120:123]
    v_add_u32 v23, 0x10000, v23
    v_accvgpr_read_b32 v32, a176
    v_mfma_f32_16x16x32_bf16 a[124:127], v[40:43], v[120:123], a[124:127]
    buffer_load_dwordx4 v1, s[28:31], s65 offen offset:1024 sc1 lds
    v_mfma_f32_16x16x32_bf16 a[124:127], v[44:47], v[124:127], a[124:127]
    s_waitcnt lgkmcnt(1)
    ds_read_b64_tr_b16 v[40:41], v16 offset:0
    ds_read_b64_tr_b16 v[42:43], v16 offset:1024
    v_mfma_f32_16x16x32_bf16 v[128:131], v[48:51], v[64:67], v[128:131]
    ds_read_b64_tr_b16 v[44:45], v16 offset:8192
    ds_read_b64_tr_b16 v[46:47], v16 offset:9216
    v_mfma_f32_16x16x32_bf16 v[128:131], v[52:55], v[68:71], v[128:131]
    v_add_u32 v24, 0xfffe0000, v24
    v_add_u32 v16, 0x10000, v16
    v_mfma_f32_16x16x32_bf16 v[132:135], v[48:51], v[72:75], v[132:135]
    ds_read_b128 v[96:99], v24 offset:16384
    v_accvgpr_read_b32 v31, a177
    v_mfma_f32_16x16x32_bf16 v[132:135], v[52:55], v[76:79], v[132:135]
    v_cvt_pk_bf16_f32 v32, v32, v31
    v_accvgpr_read_b32 v33, a178
    v_mfma_f32_16x16x32_bf16 v[136:139], v[48:51], v[80:83], v[136:139]
    v_accvgpr_read_b32 v31, a179
    v_cvt_pk_bf16_f32 v33, v33, v31
    v_mfma_f32_16x16x32_bf16 v[136:139], v[52:55], v[84:87], v[136:139]
    s_add_u32 s72, s71, 34816
    v_accvgpr_read_b32 v34, a180
    v_accvgpr_read_b32 v31, a181
    v_mfma_f32_16x16x32_bf16 v[140:143], v[48:51], v[88:91], v[140:143]
    s_add_u32 m0, s68, 106496
    ds_read_b64_tr_b16 v[48:49], v17 offset:0
    ds_read_b64_tr_b16 v[50:51], v17 offset:1024
    v_mfma_f32_16x16x32_bf16 v[140:143], v[52:55], v[92:95], v[140:143]
    buffer_load_dwordx4 v6, s[20:23], s66 offen lds
    v_mfma_f32_16x16x32_bf16 v[144:147], v[56:59], v[64:67], v[144:147]
    ds_read_b64_tr_b16 v[52:53], v17 offset:8192
    ds_read_b64_tr_b16 v[54:55], v17 offset:9216
    v_mfma_f32_16x16x32_bf16 v[144:147], v[60:63], v[68:71], v[144:147]
    v_add_u32 v17, 0x10000, v17
    v_cvt_pk_bf16_f32 v34, v34, v31
    v_mfma_f32_16x16x32_bf16 v[148:151], v[56:59], v[72:75], v[148:151]
    v_accvgpr_read_b32 v35, a182
    v_accvgpr_read_b32 v31, a183
    v_mfma_f32_16x16x32_bf16 v[148:151], v[60:63], v[76:79], v[148:151]
    v_cvt_pk_bf16_f32 v35, v35, v31
    v_accvgpr_write_b32 a176, 0
    v_mfma_f32_16x16x32_bf16 v[152:155], v[56:59], v[80:83], v[152:155]
    v_add_u32 v25, 0xfffe0000, v25
    v_accvgpr_write_b32 a177, 0
    v_mfma_f32_16x16x32_bf16 v[152:155], v[60:63], v[84:87], v[152:155]
    ds_read_b128 v[100:103], v25 offset:16384
    v_accvgpr_write_b32 a178, 0
    v_mfma_f32_16x16x32_bf16 v[156:159], v[56:59], v[88:91], v[156:159]
    s_add_u32 m0, s69, 114688
    ds_read_b64_tr_b16 v[56:57], v18 offset:0
    ds_read_b64_tr_b16 v[58:59], v18 offset:1024
    v_mfma_f32_16x16x32_bf16 v[156:159], v[60:63], v[92:95], v[156:159]
    s_xor_b32 s65, s65, 24576
    buffer_load_dwordx4 v10, s[20:23], s64 offen lds
    s_waitcnt lgkmcnt(3)
    v_mfma_f32_16x16x32_bf16 v[160:163], v[40:43], v[64:67], v[160:163]
    s_xor_b32 s66, s66, 384
    ds_read_b64_tr_b16 v[60:61], v18 offset:8192
    ds_read_b64_tr_b16 v[62:63], v18 offset:9216
    v_mfma_f32_16x16x32_bf16 v[160:163], v[44:47], v[68:71], v[160:163]
    v_add_u32 v18, 0x10000, v18
    v_accvgpr_write_b32 a179, 0
    v_mfma_f32_16x16x32_bf16 v[164:167], v[40:43], v[72:75], v[164:167]
    buffer_store_dwordx4 v[32:35], v1, s[36:39], s72 offen sc1
    v_mfma_f32_16x16x32_bf16 v[164:167], v[44:47], v[76:79], v[164:167]
    v_accvgpr_read_b32 v31, a185
    v_accvgpr_read_b32 v32, a184
    v_mfma_f32_16x16x32_bf16 v[168:171], v[40:43], v[80:83], v[168:171]
    v_cvt_pk_bf16_f32 v32, v32, v31
    v_accvgpr_read_b32 v33, a186
    v_mfma_f32_16x16x32_bf16 v[168:171], v[44:47], v[84:87], v[168:171]
    v_accvgpr_read_b32 v31, a187
    v_cvt_pk_bf16_f32 v33, v33, v31
    v_mfma_f32_16x16x32_bf16 v[172:175], v[40:43], v[88:91], v[172:175]
    ds_read_b64_tr_b16 v[40:41], v19 offset:0
    ds_read_b64_tr_b16 v[42:43], v19 offset:1024
    v_mfma_f32_16x16x32_bf16 v[172:175], v[44:47], v[92:95], v[172:175]
    ds_read_b64_tr_b16 v[44:45], v19 offset:8192
    ds_read_b64_tr_b16 v[46:47], v19 offset:9216
    v_mfma_f32_16x16x32_bf16 v[176:179], v[48:51], v[64:67], v[176:179]
    buffer_load_dwordx4 v11, s[20:23], s64 offen offset:1024 lds
    v_mfma_f32_16x16x32_bf16 v[176:179], v[52:55], v[68:71], v[176:179]
    ds_read_b128 v[104:107], v24 offset:24576
    v_add_u32 v19, 0x10000, v19
    v_mfma_f32_16x16x32_bf16 v[180:183], v[48:51], v[72:75], v[180:183]
    v_accvgpr_read_b32 v34, a188
    v_accvgpr_read_b32 v31, a189
    v_mfma_f32_16x16x32_bf16 v[180:183], v[52:55], v[76:79], v[180:183]
    v_cvt_pk_bf16_f32 v34, v34, v31
    v_accvgpr_read_b32 v35, a190
    v_mfma_f32_16x16x32_bf16 v[184:187], v[48:51], v[80:83], v[184:187]
    v_accvgpr_read_b32 v31, a191
    v_cvt_pk_bf16_f32 v35, v35, v31
    v_mfma_f32_16x16x32_bf16 v[184:187], v[52:55], v[84:87], v[184:187]
    v_accvgpr_write_b32 a180, 0
    v_accvgpr_write_b32 a181, 0
    v_mfma_f32_16x16x32_bf16 v[188:191], v[48:51], v[88:91], v[188:191]
    s_add_u32 s72, s71, 35840
    ds_read_b64_tr_b16 v[48:49], v20 offset:0
    ds_read_b64_tr_b16 v[50:51], v20 offset:1024
    v_mfma_f32_16x16x32_bf16 v[188:191], v[52:55], v[92:95], v[188:191]
    s_waitcnt lgkmcnt(2)
    ds_read_b64_tr_b16 v[52:53], v20 offset:8192
    ds_read_b64_tr_b16 v[54:55], v20 offset:9216
    v_mfma_f32_16x16x32_bf16 v[192:195], v[56:59], v[64:67], v[192:195]
    buffer_load_dwordx4 v12, s[20:23], s64 offen offset:2048 lds
    v_mfma_f32_16x16x32_bf16 v[192:195], v[60:63], v[68:71], v[192:195]
    v_add_u32 v20, 0x10000, v20
    v_accvgpr_write_b32 a182, 0
    v_mfma_f32_16x16x32_bf16 v[196:199], v[56:59], v[72:75], v[196:199]
    buffer_store_dwordx4 v[32:35], v1, s[36:39], s72 offen sc1
    v_mfma_f32_16x16x32_bf16 v[196:199], v[60:63], v[76:79], v[196:199]
    ds_read_b128 v[108:111], v25 offset:24576
    v_accvgpr_write_b32 a183, 0
    v_mfma_f32_16x16x32_bf16 v[200:203], v[56:59], v[80:83], v[200:203]
    v_accvgpr_write_b32 a184, 0
    v_accvgpr_write_b32 a185, 0
    v_mfma_f32_16x16x32_bf16 v[200:203], v[60:63], v[84:87], v[200:203]
    v_accvgpr_write_b32 a186, 0
    v_accvgpr_write_b32 a187, 0
    v_mfma_f32_16x16x32_bf16 v[204:207], v[56:59], v[88:91], v[204:207]
    ds_read_b64_tr_b16 v[56:57], v21 offset:0
    ds_read_b64_tr_b16 v[58:59], v21 offset:1024
    v_mfma_f32_16x16x32_bf16 v[204:207], v[60:63], v[92:95], v[204:207]
    ds_read_b64_tr_b16 v[60:61], v21 offset:8192
    ds_read_b64_tr_b16 v[62:63], v21 offset:9216
    v_mfma_f32_16x16x32_bf16 v[208:211], v[40:43], v[64:67], v[208:211]
    v_add_u32 v21, 0x10000, v21
    v_accvgpr_write_b32 a188, 0
    v_mfma_f32_16x16x32_bf16 v[208:211], v[44:47], v[68:71], v[208:211]
    buffer_load_dwordx4 v13, s[20:23], s64 offen offset:3072 lds
    v_mfma_f32_16x16x32_bf16 v[212:215], v[40:43], v[72:75], v[212:215]
    v_accvgpr_write_b32 a189, 0
    v_accvgpr_write_b32 a190, 0
    v_mfma_f32_16x16x32_bf16 v[212:215], v[44:47], v[76:79], v[212:215]
    v_accvgpr_write_b32 a191, 0
    v_mfma_f32_16x16x32_bf16 v[216:219], v[40:43], v[80:83], v[216:219]
    v_accvgpr_read_b32 v32, a192
    v_accvgpr_read_b32 v31, a193
    v_mfma_f32_16x16x32_bf16 v[216:219], v[44:47], v[84:87], v[216:219]
    v_cvt_pk_bf16_f32 v32, v32, v31
    v_accvgpr_read_b32 v33, a194
    v_mfma_f32_16x16x32_bf16 v[220:223], v[40:43], v[88:91], v[220:223]
    ds_read_b64_tr_b16 v[40:41], v26 offset:32768
    ds_read_b64_tr_b16 v[42:43], v26 offset:33280
    v_mfma_f32_16x16x32_bf16 v[220:223], v[44:47], v[92:95], v[220:223]
    s_waitcnt lgkmcnt(2)
    ds_read_b64_tr_b16 v[44:45], v26 offset:36864
    ds_read_b64_tr_b16 v[46:47], v26 offset:37376
    v_mfma_f32_16x16x32_bf16 v[224:227], v[48:51], v[64:67], v[224:227]
    v_add_u32 v26, 0x10000, v26
    v_accvgpr_read_b32 v31, a195
    v_mfma_f32_16x16x32_bf16 v[224:227], v[52:55], v[68:71], v[224:227]
    s_xor_b32 s64, s64, 128
    v_cvt_pk_bf16_f32 v33, v33, v31
    v_accvgpr_read_b32 v34, a196
    v_mfma_f32_16x16x32_bf16 v[228:231], v[48:51], v[72:75], v[228:231]
    v_accvgpr_read_b32 v31, a197
    v_cvt_pk_bf16_f32 v34, v34, v31
    v_mfma_f32_16x16x32_bf16 v[228:231], v[52:55], v[76:79], v[228:231]
    v_accvgpr_read_b32 v35, a198
    v_accvgpr_read_b32 v31, a199
    v_mfma_f32_16x16x32_bf16 v[232:235], v[48:51], v[80:83], v[232:235]
    v_cvt_pk_bf16_f32 v35, v35, v31
    v_accvgpr_write_b32 a192, 0
    v_mfma_f32_16x16x32_bf16 v[232:235], v[52:55], v[84:87], v[232:235]
    s_add_u32 m0, s69, 131072
    v_accvgpr_write_b32 a193, 0
    v_accvgpr_write_b32 a194, 0
    v_mfma_f32_16x16x32_bf16 v[236:239], v[48:51], v[88:91], v[236:239]
    buffer_load_dwordx4 v2, s[24:27], s60 offen lds
    v_mfma_f32_16x16x32_bf16 v[236:239], v[52:55], v[92:95], v[236:239]
    s_add_u32 s72, s71, 4096
    ds_read_b64_tr_b16 v[48:49], v27 offset:32768
    ds_read_b64_tr_b16 v[50:51], v27 offset:33280
    v_mfma_f32_16x16x32_bf16 v[240:243], v[56:59], v[64:67], v[240:243]
    ds_read_b64_tr_b16 v[52:53], v27 offset:36864
    ds_read_b64_tr_b16 v[54:55], v27 offset:37376
    v_mfma_f32_16x16x32_bf16 v[240:243], v[60:63], v[68:71], v[240:243]
    v_add_u32 v27, 0x10000, v27
    v_accvgpr_write_b32 a195, 0
    v_mfma_f32_16x16x32_bf16 v[244:247], v[56:59], v[72:75], v[244:247]
    buffer_load_dwordx4 v3, s[24:27], s60 offen offset:1024 lds
    v_mfma_f32_16x16x32_bf16 v[244:247], v[60:63], v[76:79], v[244:247]
    buffer_store_dwordx4 v[32:35], v1, s[36:39], s72 offen sc1
    v_mfma_f32_16x16x32_bf16 v[248:251], v[56:59], v[80:83], v[248:251]
    v_accvgpr_write_b32 a196, 0
    v_accvgpr_write_b32 a197, 0
    v_mfma_f32_16x16x32_bf16 v[248:251], v[60:63], v[84:87], v[248:251]
    v_accvgpr_write_b32 a198, 0
    v_accvgpr_write_b32 a199, 0
    v_mfma_f32_16x16x32_bf16 v[252:255], v[56:59], v[88:91], v[252:255]
    buffer_load_dwordx4 v4, s[24:27], s60 offen offset:2048 lds
    v_mfma_f32_16x16x32_bf16 v[252:255], v[60:63], v[92:95], v[252:255]
    s_waitcnt lgkmcnt(0)
    ds_read_b64_tr_b16 v[56:57], v28 offset:32768
    ds_read_b64_tr_b16 v[58:59], v28 offset:33280
    v_mfma_f32_16x16x32_bf16 a[64:67], v[40:43], v[64:67], a[64:67]
    ds_read_b64_tr_b16 v[60:61], v28 offset:36864
    ds_read_b64_tr_b16 v[62:63], v28 offset:37376
    v_mfma_f32_16x16x32_bf16 a[64:67], v[44:47], v[68:71], a[64:67]
    v_add_u32 v28, 0x10000, v28
    v_mfma_f32_16x16x32_bf16 a[68:71], v[40:43], v[72:75], a[68:71]
    buffer_load_dwordx4 v5, s[24:27], s60 offen offset:3072 lds
    v_mfma_f32_16x16x32_bf16 a[68:71], v[44:47], v[76:79], a[68:71]
    ds_read_b128 v[112:115], v24 offset:49152
    v_mfma_f32_16x16x32_bf16 a[72:75], v[40:43], v[80:83], a[72:75]
    v_mfma_f32_16x16x32_bf16 a[72:75], v[44:47], v[84:87], a[72:75]
    s_add_u32 m0, s69, 147456
    v_accvgpr_read_b32 v32, a200
    v_accvgpr_read_b32 v31, a201
    v_mfma_f32_16x16x32_bf16 a[76:79], v[40:43], v[88:91], a[76:79]
    s_xor_b32 s60, s60, 524288
    buffer_load_dwordx4 v10, s[20:23], s63 offen lds
    v_mfma_f32_16x16x32_bf16 a[76:79], v[44:47], v[92:95], a[76:79]
    ds_read_b128 v[116:119], v25 offset:49152
    v_cvt_pk_bf16_f32 v32, v32, v31
    v_mfma_f32_16x16x32_bf16 a[128:131], v[40:43], a[136:139], a[128:131]
    ds_read_b64_tr_b16 v[40:41], v29 offset:32768
    ds_read_b64_tr_b16 v[42:43], v29 offset:33280
    v_mfma_f32_16x16x32_bf16 a[128:131], v[44:47], a[140:143], a[128:131]
    ds_read_b64_tr_b16 v[44:45], v29 offset:36864
    ds_read_b64_tr_b16 v[46:47], v29 offset:37376
    v_mfma_f32_16x16x32_bf16 a[80:83], v[48:51], v[64:67], a[80:83]
    buffer_load_dwordx4 v11, s[20:23], s63 offen offset:1024 lds
    v_mfma_f32_16x16x32_bf16 a[80:83], v[52:55], v[68:71], a[80:83]
    ds_read_b128 v[120:123], v24 offset:57344
    v_add_u32 v29, 0x10000, v29
    v_mfma_f32_16x16x32_bf16 a[84:87], v[48:51], v[72:75], a[84:87]
    v_accvgpr_read_b32 v33, a202
    v_accvgpr_read_b32 v31, a203
    v_mfma_f32_16x16x32_bf16 a[84:87], v[52:55], v[76:79], a[84:87]
    v_cvt_pk_bf16_f32 v33, v33, v31
    v_accvgpr_read_b32 v34, a204
    v_mfma_f32_16x16x32_bf16 a[88:91], v[48:51], v[80:83], a[88:91]
    buffer_load_dwordx4 v12, s[20:23], s63 offen offset:2048 lds
    v_mfma_f32_16x16x32_bf16 a[88:91], v[52:55], v[84:87], a[88:91]
    ds_read_b128 v[124:127], v25 offset:57344
    v_accvgpr_read_b32 v31, a205
    v_mfma_f32_16x16x32_bf16 a[92:95], v[48:51], v[88:91], a[92:95]
    s_add_u32 s72, s71, 5120
    v_cvt_pk_bf16_f32 v34, v34, v31
    v_accvgpr_read_b32 v35, a206
    v_mfma_f32_16x16x32_bf16 a[92:95], v[52:55], v[92:95], a[92:95]
    v_accvgpr_read_b32 v31, a207
    v_cvt_pk_bf16_f32 v35, v35, v31
    v_mfma_f32_16x16x32_bf16 a[132:135], v[48:51], a[136:139], a[132:135]
    buffer_load_dwordx4 v13, s[20:23], s63 offen offset:3072 lds
    v_mfma_f32_16x16x32_bf16 a[132:135], v[52:55], a[140:143], a[132:135]
    s_waitcnt lgkmcnt(1)
    v_accvgpr_write_b32 a200, 0
    v_accvgpr_write_b32 a201, 0
    v_mfma_f32_16x16x32_bf16 a[96:99], v[56:59], v[64:67], a[96:99]
    v_accvgpr_write_b32 a202, 0
    v_accvgpr_write_b32 a203, 0
    v_mfma_f32_16x16x32_bf16 a[96:99], v[60:63], v[68:71], a[96:99]
    s_xor_b32 s63, s63, 1920
    v_accvgpr_write_b32 a204, 0
    v_accvgpr_write_b32 a205, 0
    v_mfma_f32_16x16x32_bf16 a[100:103], v[56:59], v[72:75], a[100:103]
    s_andn2_b32 s63, s63, 896
    buffer_store_dwordx4 v[32:35], v1, s[36:39], s72 offen sc1
    v_mfma_f32_16x16x32_bf16 a[100:103], v[60:63], v[76:79], a[100:103]
    v_accvgpr_write_b32 a206, 0
    v_accvgpr_write_b32 a207, 0
    v_mfma_f32_16x16x32_bf16 a[104:107], v[56:59], v[80:83], a[104:107]
    v_mfma_f32_16x16x32_bf16 a[104:107], v[60:63], v[84:87], a[104:107]
    s_waitcnt vmcnt(10) lgkmcnt(0)
    s_barrier
    ds_read_b64_tr_b16 v[48:49], v14 offset:0
    v_mfma_f32_16x16x32_bf16 a[108:111], v[56:59], v[88:91], a[108:111]
    s_add_u32 m0, s67, 0
    ds_read_b64_tr_b16 v[50:51], v14 offset:1024
    ds_read_b64_tr_b16 v[52:53], v14 offset:8192
    v_mfma_f32_16x16x32_bf16 a[108:111], v[60:63], v[92:95], a[108:111]
    buffer_load_dwordx4 v1, s[28:31], s65 offen sc1 lds
    v_mfma_f32_16x16x32_bf16 a[112:115], v[40:43], v[64:67], a[112:115]
    ds_read_b64_tr_b16 v[54:55], v14 offset:9216
    ds_read_b64_tr_b16 v[56:57], v15 offset:0
    v_mfma_f32_16x16x32_bf16 a[112:115], v[44:47], v[68:71], a[112:115]
    ds_read_b64_tr_b16 v[58:59], v15 offset:1024
    ds_read_b64_tr_b16 v[60:61], v15 offset:8192
    v_mfma_f32_16x16x32_bf16 a[116:119], v[40:43], v[72:75], a[116:119]
    ds_read_b64_tr_b16 v[62:63], v15 offset:9216
    ds_read_b128 a[136:139], v22 offset:32768
    v_mfma_f32_16x16x32_bf16 a[116:119], v[44:47], v[76:79], a[116:119]
    ds_read_b128 a[140:143], v23 offset:32768
    v_add_u32 v14, 0x10000, v14
    v_mfma_f32_16x16x32_bf16 a[120:123], v[40:43], v[80:83], a[120:123]
    v_add_u32 v15, 0x10000, v15
    v_add_u32 v22, 0xffff0000, v22
    v_mfma_f32_16x16x32_bf16 a[120:123], v[44:47], v[84:87], a[120:123]
    v_add_u32 v23, 0xffff0000, v23
    v_accvgpr_read_b32 v32, a208
    v_mfma_f32_16x16x32_bf16 a[124:127], v[40:43], v[88:91], a[124:127]
    buffer_load_dwordx4 v1, s[28:31], s65 offen offset:1024 sc1 lds
    v_mfma_f32_16x16x32_bf16 a[124:127], v[44:47], v[92:95], a[124:127]
    s_waitcnt lgkmcnt(1)
    ds_read_b64_tr_b16 v[40:41], v16 offset:0
    ds_read_b64_tr_b16 v[42:43], v16 offset:1024
    v_mfma_f32_16x16x32_bf16 v[128:131], v[48:51], v[96:99], v[128:131]
    ds_read_b64_tr_b16 v[44:45], v16 offset:8192
    ds_read_b64_tr_b16 v[46:47], v16 offset:9216
    v_mfma_f32_16x16x32_bf16 v[128:131], v[52:55], v[100:103], v[128:131]
    v_add_u32 v24, 0x10000, v24
    v_add_u32 v16, 0x10000, v16
    v_mfma_f32_16x16x32_bf16 v[132:135], v[48:51], v[104:107], v[132:135]
    ds_read_b128 v[64:67], v24 offset:16384
    v_accvgpr_read_b32 v31, a209
    v_mfma_f32_16x16x32_bf16 v[132:135], v[52:55], v[108:111], v[132:135]
    v_cvt_pk_bf16_f32 v32, v32, v31
    v_accvgpr_read_b32 v33, a210
    v_mfma_f32_16x16x32_bf16 v[136:139], v[48:51], v[112:115], v[136:139]
    v_accvgpr_read_b32 v31, a211
    v_cvt_pk_bf16_f32 v33, v33, v31
    v_mfma_f32_16x16x32_bf16 v[136:139], v[52:55], v[116:119], v[136:139]
    s_add_u32 s72, s71, 36864
    v_accvgpr_read_b32 v34, a212
    v_accvgpr_read_b32 v31, a213
    v_mfma_f32_16x16x32_bf16 v[140:143], v[48:51], v[120:123], v[140:143]
    s_add_u32 m0, s68, 8192
    ds_read_b64_tr_b16 v[48:49], v17 offset:0
    ds_read_b64_tr_b16 v[50:51], v17 offset:1024
    v_mfma_f32_16x16x32_bf16 v[140:143], v[52:55], v[124:127], v[140:143]
    buffer_load_dwordx4 v6, s[20:23], s66 offen lds
    v_mfma_f32_16x16x32_bf16 v[144:147], v[56:59], v[96:99], v[144:147]
    ds_read_b64_tr_b16 v[52:53], v17 offset:8192
    ds_read_b64_tr_b16 v[54:55], v17 offset:9216
    v_mfma_f32_16x16x32_bf16 v[144:147], v[60:63], v[100:103], v[144:147]
    v_add_u32 v17, 0x10000, v17
    v_cvt_pk_bf16_f32 v34, v34, v31
    v_mfma_f32_16x16x32_bf16 v[148:151], v[56:59], v[104:107], v[148:151]
    v_accvgpr_read_b32 v35, a214
    v_accvgpr_read_b32 v31, a215
    v_mfma_f32_16x16x32_bf16 v[148:151], v[60:63], v[108:111], v[148:151]
    v_cvt_pk_bf16_f32 v35, v35, v31
    v_accvgpr_write_b32 a208, 0
    v_mfma_f32_16x16x32_bf16 v[152:155], v[56:59], v[112:115], v[152:155]
    v_add_u32 v25, 0x10000, v25
    v_accvgpr_write_b32 a209, 0
    v_mfma_f32_16x16x32_bf16 v[152:155], v[60:63], v[116:119], v[152:155]
    ds_read_b128 v[68:71], v25 offset:16384
    v_accvgpr_write_b32 a210, 0
    v_mfma_f32_16x16x32_bf16 v[156:159], v[56:59], v[120:123], v[156:159]
    s_add_u32 m0, s69, 16384
    ds_read_b64_tr_b16 v[56:57], v18 offset:0
    ds_read_b64_tr_b16 v[58:59], v18 offset:1024
    v_mfma_f32_16x16x32_bf16 v[156:159], v[60:63], v[124:127], v[156:159]
    s_xor_b32 s65, s65, 8192
    buffer_load_dwordx4 v10, s[20:23], s64 offen lds
    s_waitcnt lgkmcnt(3)
    v_mfma_f32_16x16x32_bf16 v[160:163], v[40:43], v[96:99], v[160:163]
    s_xor_b32 s66, s66, 128
    ds_read_b64_tr_b16 v[60:61], v18 offset:8192
    ds_read_b64_tr_b16 v[62:63], v18 offset:9216
    v_mfma_f32_16x16x32_bf16 v[160:163], v[44:47], v[100:103], v[160:163]
    v_add_u32 v18, 0x10000, v18
    v_accvgpr_write_b32 a211, 0
    v_mfma_f32_16x16x32_bf16 v[164:167], v[40:43], v[104:107], v[164:167]
    buffer_store_dwordx4 v[32:35], v1, s[36:39], s72 offen sc1
    v_mfma_f32_16x16x32_bf16 v[164:167], v[44:47], v[108:111], v[164:167]
    v_accvgpr_read_b32 v31, a217
    v_accvgpr_read_b32 v32, a216
    v_mfma_f32_16x16x32_bf16 v[168:171], v[40:43], v[112:115], v[168:171]
    v_cvt_pk_bf16_f32 v32, v32, v31
    v_accvgpr_read_b32 v33, a218
    v_mfma_f32_16x16x32_bf16 v[168:171], v[44:47], v[116:119], v[168:171]
    v_accvgpr_read_b32 v31, a219
    v_cvt_pk_bf16_f32 v33, v33, v31
    v_mfma_f32_16x16x32_bf16 v[172:175], v[40:43], v[120:123], v[172:175]
    ds_read_b64_tr_b16 v[40:41], v19 offset:0
    ds_read_b64_tr_b16 v[42:43], v19 offset:1024
    v_mfma_f32_16x16x32_bf16 v[172:175], v[44:47], v[124:127], v[172:175]
    ds_read_b64_tr_b16 v[44:45], v19 offset:8192
    ds_read_b64_tr_b16 v[46:47], v19 offset:9216
    v_mfma_f32_16x16x32_bf16 v[176:179], v[48:51], v[96:99], v[176:179]
    buffer_load_dwordx4 v11, s[20:23], s64 offen offset:1024 lds
    v_mfma_f32_16x16x32_bf16 v[176:179], v[52:55], v[100:103], v[176:179]
    ds_read_b128 v[72:75], v24 offset:24576
    v_add_u32 v19, 0x10000, v19
    v_mfma_f32_16x16x32_bf16 v[180:183], v[48:51], v[104:107], v[180:183]
    v_accvgpr_read_b32 v34, a220
    v_accvgpr_read_b32 v31, a221
    v_mfma_f32_16x16x32_bf16 v[180:183], v[52:55], v[108:111], v[180:183]
    v_cvt_pk_bf16_f32 v34, v34, v31
    v_accvgpr_read_b32 v35, a222
    v_mfma_f32_16x16x32_bf16 v[184:187], v[48:51], v[112:115], v[184:187]
    v_accvgpr_read_b32 v31, a223
    v_cvt_pk_bf16_f32 v35, v35, v31
    v_mfma_f32_16x16x32_bf16 v[184:187], v[52:55], v[116:119], v[184:187]
    v_accvgpr_write_b32 a212, 0
    v_accvgpr_write_b32 a213, 0
    v_mfma_f32_16x16x32_bf16 v[188:191], v[48:51], v[120:123], v[188:191]
    s_add_u32 s72, s71, 37888
    ds_read_b64_tr_b16 v[48:49], v20 offset:0
    ds_read_b64_tr_b16 v[50:51], v20 offset:1024
    v_mfma_f32_16x16x32_bf16 v[188:191], v[52:55], v[124:127], v[188:191]
    s_waitcnt lgkmcnt(2)
    ds_read_b64_tr_b16 v[52:53], v20 offset:8192
    ds_read_b64_tr_b16 v[54:55], v20 offset:9216
    v_mfma_f32_16x16x32_bf16 v[192:195], v[56:59], v[96:99], v[192:195]
    buffer_load_dwordx4 v12, s[20:23], s64 offen offset:2048 lds
    v_mfma_f32_16x16x32_bf16 v[192:195], v[60:63], v[100:103], v[192:195]
    v_add_u32 v20, 0x10000, v20
    v_accvgpr_write_b32 a214, 0
    v_mfma_f32_16x16x32_bf16 v[196:199], v[56:59], v[104:107], v[196:199]
    buffer_store_dwordx4 v[32:35], v1, s[36:39], s72 offen sc1
    v_mfma_f32_16x16x32_bf16 v[196:199], v[60:63], v[108:111], v[196:199]
    ds_read_b128 v[76:79], v25 offset:24576
    v_accvgpr_write_b32 a215, 0
    v_mfma_f32_16x16x32_bf16 v[200:203], v[56:59], v[112:115], v[200:203]
    v_accvgpr_write_b32 a216, 0
    v_accvgpr_write_b32 a217, 0
    v_mfma_f32_16x16x32_bf16 v[200:203], v[60:63], v[116:119], v[200:203]
    v_accvgpr_write_b32 a218, 0
    v_accvgpr_write_b32 a219, 0
    v_mfma_f32_16x16x32_bf16 v[204:207], v[56:59], v[120:123], v[204:207]
    ds_read_b64_tr_b16 v[56:57], v21 offset:0
    ds_read_b64_tr_b16 v[58:59], v21 offset:1024
    v_mfma_f32_16x16x32_bf16 v[204:207], v[60:63], v[124:127], v[204:207]
    ds_read_b64_tr_b16 v[60:61], v21 offset:8192
    ds_read_b64_tr_b16 v[62:63], v21 offset:9216
    v_mfma_f32_16x16x32_bf16 v[208:211], v[40:43], v[96:99], v[208:211]
    v_add_u32 v21, 0x10000, v21
    v_accvgpr_write_b32 a220, 0
    v_mfma_f32_16x16x32_bf16 v[208:211], v[44:47], v[100:103], v[208:211]
    buffer_load_dwordx4 v13, s[20:23], s64 offen offset:3072 lds
    v_mfma_f32_16x16x32_bf16 v[212:215], v[40:43], v[104:107], v[212:215]
    v_accvgpr_write_b32 a221, 0
    v_accvgpr_write_b32 a222, 0
    v_mfma_f32_16x16x32_bf16 v[212:215], v[44:47], v[108:111], v[212:215]
    v_accvgpr_write_b32 a223, 0
    v_mfma_f32_16x16x32_bf16 v[216:219], v[40:43], v[112:115], v[216:219]
    v_accvgpr_read_b32 v32, a224
    v_accvgpr_read_b32 v31, a225
    v_mfma_f32_16x16x32_bf16 v[216:219], v[44:47], v[116:119], v[216:219]
    v_cvt_pk_bf16_f32 v32, v32, v31
    v_accvgpr_read_b32 v33, a226
    v_mfma_f32_16x16x32_bf16 v[220:223], v[40:43], v[120:123], v[220:223]
    ds_read_b64_tr_b16 v[40:41], v26 offset:32768
    ds_read_b64_tr_b16 v[42:43], v26 offset:33280
    v_mfma_f32_16x16x32_bf16 v[220:223], v[44:47], v[124:127], v[220:223]
    s_waitcnt lgkmcnt(2)
    ds_read_b64_tr_b16 v[44:45], v26 offset:36864
    ds_read_b64_tr_b16 v[46:47], v26 offset:37376
    v_mfma_f32_16x16x32_bf16 v[224:227], v[48:51], v[96:99], v[224:227]
    v_add_u32 v26, 0xffff0000, v26
    v_accvgpr_read_b32 v31, a227
    v_mfma_f32_16x16x32_bf16 v[224:227], v[52:55], v[100:103], v[224:227]
    s_xor_b32 s64, s64, 1920
    v_cvt_pk_bf16_f32 v33, v33, v31
    v_accvgpr_read_b32 v34, a228
    v_mfma_f32_16x16x32_bf16 v[228:231], v[48:51], v[104:107], v[228:231]
    s_andn2_b32 s64, s64, 896
    v_accvgpr_read_b32 v31, a229
    v_cvt_pk_bf16_f32 v34, v34, v31
    v_mfma_f32_16x16x32_bf16 v[228:231], v[52:55], v[108:111], v[228:231]
    v_accvgpr_read_b32 v35, a230
    v_accvgpr_read_b32 v31, a231
    v_mfma_f32_16x16x32_bf16 v[232:235], v[48:51], v[112:115], v[232:235]
    v_cvt_pk_bf16_f32 v35, v35, v31
    v_mfma_f32_16x16x32_bf16 v[232:235], v[52:55], v[116:119], v[232:235]
    s_add_u32 m0, s69, 32768
    v_mfma_f32_16x16x32_bf16 v[236:239], v[48:51], v[120:123], v[236:239]
    buffer_load_dwordx4 v2, s[24:27], s60 offen lds
    v_mfma_f32_16x16x32_bf16 v[236:239], v[52:55], v[124:127], v[236:239]
    s_add_u32 s72, s71, 6144
    ds_read_b64_tr_b16 v[48:49], v27 offset:32768
    ds_read_b64_tr_b16 v[50:51], v27 offset:33280
    v_mfma_f32_16x16x32_bf16 v[240:243], v[56:59], v[96:99], v[240:243]
    ds_read_b64_tr_b16 v[52:53], v27 offset:36864
    ds_read_b64_tr_b16 v[54:55], v27 offset:37376
    v_mfma_f32_16x16x32_bf16 v[240:243], v[60:63], v[100:103], v[240:243]
    buffer_store_dwordx4 v[32:35], v1, s[36:39], s72 offen sc1
    v_mfma_f32_16x16x32_bf16 v[244:247], v[56:59], v[104:107], v[244:247]
    buffer_load_dwordx4 v3, s[24:27], s60 offen offset:1024 lds
    v_mfma_f32_16x16x32_bf16 v[244:247], v[60:63], v[108:111], v[244:247]
    v_add_u32 v27, 0xffff0000, v27
    v_mfma_f32_16x16x32_bf16 v[248:251], v[56:59], v[112:115], v[248:251]
    v_mfma_f32_16x16x32_bf16 v[248:251], v[60:63], v[116:119], v[248:251]
    v_mfma_f32_16x16x32_bf16 v[252:255], v[56:59], v[120:123], v[252:255]
    buffer_load_dwordx4 v4, s[24:27], s60 offen offset:2048 lds
    v_mfma_f32_16x16x32_bf16 v[252:255], v[60:63], v[124:127], v[252:255]
    s_waitcnt lgkmcnt(0)
    ds_read_b64_tr_b16 v[56:57], v28 offset:32768
    ds_read_b64_tr_b16 v[58:59], v28 offset:33280
    v_mfma_f32_16x16x32_bf16 a[64:67], v[40:43], v[96:99], a[64:67]
    ds_read_b64_tr_b16 v[60:61], v28 offset:36864
    ds_read_b64_tr_b16 v[62:63], v28 offset:37376
    v_mfma_f32_16x16x32_bf16 a[64:67], v[44:47], v[100:103], a[64:67]
    v_add_u32 v28, 0xffff0000, v28
    v_mfma_f32_16x16x32_bf16 a[68:71], v[40:43], v[104:107], a[68:71]
    buffer_load_dwordx4 v5, s[24:27], s60 offen offset:3072 lds
    v_mfma_f32_16x16x32_bf16 a[68:71], v[44:47], v[108:111], a[68:71]
    ds_read_b128 v[80:83], v24 offset:49152
    v_mfma_f32_16x16x32_bf16 a[72:75], v[40:43], v[112:115], a[72:75]
    v_mfma_f32_16x16x32_bf16 a[72:75], v[44:47], v[116:119], a[72:75]
    s_xor_b32 s60, s60, 7864320
    v_accvgpr_read_b32 v32, a232
    v_accvgpr_read_b32 v31, a233
    v_mfma_f32_16x16x32_bf16 a[76:79], v[40:43], v[120:123], a[76:79]
    s_add_u32 m0, s69, 49152
    ds_read_b128 v[84:87], v25 offset:49152
    v_cvt_pk_bf16_f32 v32, v32, v31
    v_mfma_f32_16x16x32_bf16 a[76:79], v[44:47], v[124:127], a[76:79]
    s_andn2_b32 s60, s60, 3670016
    buffer_load_dwordx4 v10, s[20:23], s63 offen lds
    v_mfma_f32_16x16x32_bf16 a[128:131], v[40:43], a[136:139], a[128:131]
    ds_read_b64_tr_b16 v[40:41], v29 offset:32768
    ds_read_b64_tr_b16 v[42:43], v29 offset:33280
    v_mfma_f32_16x16x32_bf16 a[128:131], v[44:47], a[140:143], a[128:131]
    ds_read_b64_tr_b16 v[44:45], v29 offset:36864
    ds_read_b64_tr_b16 v[46:47], v29 offset:37376
    v_mfma_f32_16x16x32_bf16 a[80:83], v[48:51], v[96:99], a[80:83]
    buffer_load_dwordx4 v11, s[20:23], s63 offen offset:1024 lds
    v_mfma_f32_16x16x32_bf16 a[80:83], v[52:55], v[100:103], a[80:83]
    ds_read_b128 v[88:91], v24 offset:57344
    v_add_u32 v29, 0xffff0000, v29
    v_mfma_f32_16x16x32_bf16 a[84:87], v[48:51], v[104:107], a[84:87]
    v_accvgpr_read_b32 v33, a234
    v_accvgpr_read_b32 v31, a235
    v_mfma_f32_16x16x32_bf16 a[84:87], v[52:55], v[108:111], a[84:87]
    v_cvt_pk_bf16_f32 v33, v33, v31
    v_accvgpr_read_b32 v34, a236
    v_mfma_f32_16x16x32_bf16 a[88:91], v[48:51], v[112:115], a[88:91]
    buffer_load_dwordx4 v12, s[20:23], s63 offen offset:2048 lds
    v_mfma_f32_16x16x32_bf16 a[88:91], v[52:55], v[116:119], a[88:91]
    ds_read_b128 v[92:95], v25 offset:57344
    v_accvgpr_read_b32 v31, a237
    v_mfma_f32_16x16x32_bf16 a[92:95], v[48:51], v[120:123], a[92:95]
    s_add_u32 s72, s71, 7168
    v_cvt_pk_bf16_f32 v34, v34, v31
    v_accvgpr_read_b32 v35, a238
    v_mfma_f32_16x16x32_bf16 a[92:95], v[52:55], v[124:127], a[92:95]
    v_accvgpr_read_b32 v31, a239
    v_cvt_pk_bf16_f32 v35, v35, v31
    v_mfma_f32_16x16x32_bf16 a[132:135], v[48:51], a[136:139], a[132:135]
    buffer_load_dwordx4 v13, s[20:23], s63 offen offset:3072 lds
    v_mfma_f32_16x16x32_bf16 a[132:135], v[52:55], a[140:143], a[132:135]
    s_waitcnt lgkmcnt(1)
    v_mfma_f32_16x16x32_bf16 a[96:99], v[56:59], v[96:99], a[96:99]
    v_mfma_f32_16x16x32_bf16 a[96:99], v[60:63], v[100:103], a[96:99]
    s_xor_b32 s63, s63, 128
    v_mfma_f32_16x16x32_bf16 a[100:103], v[56:59], v[104:107], a[100:103]
    buffer_store_dwordx4 v[32:35], v1, s[36:39], s72 offen sc1
    v_mfma_f32_16x16x32_bf16 a[100:103], v[60:63], v[108:111], a[100:103]
    v_mfma_f32_16x16x32_bf16 a[104:107], v[56:59], v[112:115], a[104:107]
    v_mfma_f32_16x16x32_bf16 a[104:107], v[60:63], v[116:119], a[104:107]
    s_waitcnt vmcnt(10) lgkmcnt(0)
    s_barrier
    ds_read_b64_tr_b16 v[48:49], v14 offset:0
    v_mfma_f32_16x16x32_bf16 a[108:111], v[56:59], v[120:123], a[108:111]
    s_add_u32 m0, s69, 65536
    ds_read_b64_tr_b16 v[50:51], v14 offset:1024
    ds_read_b64_tr_b16 v[52:53], v14 offset:8192
    v_mfma_f32_16x16x32_bf16 a[108:111], v[60:63], v[124:127], a[108:111]
    buffer_load_dwordx4 v2, s[24:27], s60 offen lds
    v_mfma_f32_16x16x32_bf16 a[112:115], v[40:43], v[96:99], a[112:115]
    ds_read_b64_tr_b16 v[54:55], v14 offset:9216
    ds_read_b64_tr_b16 v[56:57], v15 offset:0
    v_mfma_f32_16x16x32_bf16 a[112:115], v[44:47], v[100:103], a[112:115]
    ds_read_b64_tr_b16 v[58:59], v15 offset:1024
    ds_read_b64_tr_b16 v[60:61], v15 offset:8192
    v_mfma_f32_16x16x32_bf16 a[116:119], v[40:43], v[104:107], a[116:119]
    ds_read_b64_tr_b16 v[62:63], v15 offset:9216
    ds_read_b128 a[136:139], v22 offset:0
    v_mfma_f32_16x16x32_bf16 a[116:119], v[44:47], v[108:111], a[116:119]
    ds_read_b128 a[140:143], v23 offset:0
    v_add_u32 v14, 0xfffe0000, v14
    v_mfma_f32_16x16x32_bf16 a[120:123], v[40:43], v[112:115], a[120:123]
    v_add_u32 v15, 0xfffe0000, v15
    v_add_u32 v22, 0x10000, v22
    v_mfma_f32_16x16x32_bf16 a[120:123], v[44:47], v[116:119], a[120:123]
    buffer_load_dwordx4 v3, s[24:27], s60 offen offset:1024 lds
    v_mfma_f32_16x16x32_bf16 a[124:127], v[40:43], v[120:123], a[124:127]
    ds_read_b64_tr_b16 v[40:41], v16 offset:0
    ds_read_b64_tr_b16 v[42:43], v16 offset:1024
    v_mfma_f32_16x16x32_bf16 a[124:127], v[44:47], v[124:127], a[124:127]
    s_waitcnt lgkmcnt(3)
    ds_read_b64_tr_b16 v[44:45], v16 offset:8192
    ds_read_b64_tr_b16 v[46:47], v16 offset:9216
    v_mfma_f32_16x16x32_bf16 v[128:131], v[48:51], v[64:67], v[128:131]
    v_add_u32 v16, 0xfffe0000, v16
    v_add_u32 v23, 0x10000, v23
    v_mfma_f32_16x16x32_bf16 v[128:131], v[52:55], v[68:71], v[128:131]
    v_add_u32 v24, 0x10000, v24
    v_accvgpr_read_b32 v32, a240
    v_mfma_f32_16x16x32_bf16 v[132:135], v[48:51], v[72:75], v[132:135]
    ds_read_b128 v[96:99], v24 offset:16384
    v_accvgpr_read_b32 v31, a241
    v_mfma_f32_16x16x32_bf16 v[132:135], v[52:55], v[76:79], v[132:135]
    v_cvt_pk_bf16_f32 v32, v32, v31
    v_accvgpr_read_b32 v33, a242
    v_mfma_f32_16x16x32_bf16 v[136:139], v[48:51], v[80:83], v[136:139]
    v_accvgpr_read_b32 v31, a243
    v_cvt_pk_bf16_f32 v33, v33, v31
    v_mfma_f32_16x16x32_bf16 v[136:139], v[52:55], v[84:87], v[136:139]
    s_add_u32 s72, s71, 38912
    buffer_load_dwordx4 v4, s[24:27], s60 offen offset:2048 lds
    v_mfma_f32_16x16x32_bf16 v[140:143], v[48:51], v[88:91], v[140:143]
    ds_read_b64_tr_b16 v[48:49], v17 offset:0
    ds_read_b64_tr_b16 v[50:51], v17 offset:1024
    v_mfma_f32_16x16x32_bf16 v[140:143], v[52:55], v[92:95], v[140:143]
    ds_read_b64_tr_b16 v[52:53], v17 offset:8192
    ds_read_b64_tr_b16 v[54:55], v17 offset:9216
    v_mfma_f32_16x16x32_bf16 v[144:147], v[56:59], v[64:67], v[144:147]
    v_add_u32 v17, 0xfffe0000, v17
    v_accvgpr_read_b32 v34, a244
    v_mfma_f32_16x16x32_bf16 v[144:147], v[60:63], v[68:71], v[144:147]
    v_accvgpr_read_b32 v31, a245
    v_cvt_pk_bf16_f32 v34, v34, v31
    v_mfma_f32_16x16x32_bf16 v[148:151], v[56:59], v[72:75], v[148:151]
    v_accvgpr_read_b32 v35, a246
    v_accvgpr_read_b32 v31, a247
    v_mfma_f32_16x16x32_bf16 v[148:151], v[60:63], v[76:79], v[148:151]
    v_cvt_pk_bf16_f32 v35, v35, v31
    v_mov_b32 v2, v1
    v_mfma_f32_16x16x32_bf16 v[152:155], v[56:59], v[80:83], v[152:155]
    buffer_load_dwordx4 v5, s[24:27], s60 offen offset:3072 lds
    v_mfma_f32_16x16x32_bf16 v[152:155], v[60:63], v[84:87], v[152:155]
    v_add_u32 v25, 0x10000, v25
    ds_read_b128 v[100:103], v25 offset:16384
    v_mfma_f32_16x16x32_bf16 v[156:159], v[56:59], v[88:91], v[156:159]
    ds_read_b64_tr_b16 v[56:57], v18 offset:0
    ds_read_b64_tr_b16 v[58:59], v18 offset:1024
    v_mfma_f32_16x16x32_bf16 v[156:159], v[60:63], v[92:95], v[156:159]
    s_waitcnt lgkmcnt(3)
    ds_read_b64_tr_b16 v[60:61], v18 offset:8192
    ds_read_b64_tr_b16 v[62:63], v18 offset:9216
    v_mfma_f32_16x16x32_bf16 v[160:163], v[40:43], v[64:67], v[160:163]
    buffer_store_dwordx4 v[32:35], v1, s[36:39], s72 offen sc1
    v_mfma_f32_16x16x32_bf16 v[160:163], v[44:47], v[68:71], v[160:163]
    v_add_u32 v18, 0xfffe0000, v18
    v_mfma_f32_16x16x32_bf16 v[164:167], v[40:43], v[72:75], v[164:167]
    v_mfma_f32_16x16x32_bf16 v[164:167], v[44:47], v[76:79], v[164:167]
    s_add_u32 m0, s69, 81920
    v_accvgpr_read_b32 v32, a248
    v_accvgpr_read_b32 v31, a249
    v_mfma_f32_16x16x32_bf16 v[168:171], v[40:43], v[80:83], v[168:171]
    s_xor_b32 s60, s60, 524288
    buffer_load_dwordx4 v10, s[20:23], s64 offen lds
    v_mfma_f32_16x16x32_bf16 v[168:171], v[44:47], v[84:87], v[168:171]
    s_mov_b32 s60, 131072
    v_cvt_pk_bf16_f32 v32, v32, v31
    v_accvgpr_read_b32 v33, a250
    v_mfma_f32_16x16x32_bf16 v[172:175], v[40:43], v[88:91], v[172:175]
    ds_read_b64_tr_b16 v[40:41], v19 offset:0
    ds_read_b64_tr_b16 v[42:43], v19 offset:1024
    v_mfma_f32_16x16x32_bf16 v[172:175], v[44:47], v[92:95], v[172:175]
    ds_read_b64_tr_b16 v[44:45], v19 offset:8192
    ds_read_b64_tr_b16 v[46:47], v19 offset:9216
    v_mfma_f32_16x16x32_bf16 v[176:179], v[48:51], v[64:67], v[176:179]
    ds_read_b128 v[104:107], v24 offset:24576
    v_add_u32 v19, 0xfffe0000, v19
    v_mfma_f32_16x16x32_bf16 v[176:179], v[52:55], v[68:71], v[176:179]
    v_accvgpr_read_b32 v31, a251
    v_cvt_pk_bf16_f32 v33, v33, v31
    v_mfma_f32_16x16x32_bf16 v[180:183], v[48:51], v[72:75], v[180:183]
    v_accvgpr_read_b32 v34, a252
    v_accvgpr_read_b32 v31, a253
    v_mfma_f32_16x16x32_bf16 v[180:183], v[52:55], v[76:79], v[180:183]
    buffer_load_dwordx4 v11, s[20:23], s64 offen offset:1024 lds
    v_mfma_f32_16x16x32_bf16 v[184:187], v[48:51], v[80:83], v[184:187]
    v_cvt_pk_bf16_f32 v34, v34, v31
    v_accvgpr_read_b32 v35, a254
    v_mfma_f32_16x16x32_bf16 v[184:187], v[52:55], v[84:87], v[184:187]
    v_accvgpr_read_b32 v31, a255
    v_cvt_pk_bf16_f32 v35, v35, v31
    v_mfma_f32_16x16x32_bf16 v[188:191], v[48:51], v[88:91], v[188:191]
    s_add_u32 s72, s71, 39936
    ds_read_b64_tr_b16 v[48:49], v20 offset:0
    ds_read_b64_tr_b16 v[50:51], v20 offset:1024
    v_mfma_f32_16x16x32_bf16 v[188:191], v[52:55], v[92:95], v[188:191]
    s_waitcnt lgkmcnt(2)
    ds_read_b64_tr_b16 v[52:53], v20 offset:8192
    ds_read_b64_tr_b16 v[54:55], v20 offset:9216
    v_mfma_f32_16x16x32_bf16 v[192:195], v[56:59], v[64:67], v[192:195]
    v_mov_b32 v31, 1
    v_add_u32 v20, 0xfffe0000, v20
    v_mfma_f32_16x16x32_bf16 v[192:195], v[60:63], v[68:71], v[192:195]
    buffer_store_dwordx4 v[32:35], v1, s[36:39], s72 offen sc1
    v_mfma_f32_16x16x32_bf16 v[196:199], v[56:59], v[72:75], v[196:199]
    v_add_u32 v11, s99, v39
    v_mfma_f32_16x16x32_bf16 v[196:199], v[60:63], v[76:79], v[196:199]
    s_mul_i32 s99, s98, 6
    buffer_load_dwordx4 v12, s[20:23], s64 offen offset:2048 lds
    v_mfma_f32_16x16x32_bf16 v[200:203], v[56:59], v[80:83], v[200:203]
    s_sub_u32 s99, s8, s99
    ds_read_b128 v[108:111], v25 offset:24576
    v_mfma_f32_16x16x32_bf16 v[200:203], v[60:63], v[84:87], v[200:203]
    s_mul_i32 s99, s99, 6
    v_mfma_f32_16x16x32_bf16 v[204:207], v[56:59], v[88:91], v[204:207]
    s_lshr_b32 s8, s5, 3
    ds_read_b64_tr_b16 v[56:57], v21 offset:0
    ds_read_b64_tr_b16 v[58:59], v21 offset:1024
    v_mfma_f32_16x16x32_bf16 v[204:207], v[60:63], v[92:95], v[204:207]
    s_lshl1_add_u32 s99, s4, s99
    ds_read_b64_tr_b16 v[60:61], v21 offset:8192
    ds_read_b64_tr_b16 v[62:63], v21 offset:9216
    v_mfma_f32_16x16x32_bf16 v[208:211], v[40:43], v[64:67], v[208:211]
    s_mul_i32 s8, s8, 6
    v_add_u32 v21, 0xfffe0000, v21
    v_mfma_f32_16x16x32_bf16 v[208:211], v[44:47], v[68:71], v[208:211]
    s_cmp_lt_u32 s98, 6
    s_cselect_b32 s98, s98, 40
    v_mfma_f32_16x16x32_bf16 v[212:215], v[40:43], v[72:75], v[212:215]
    s_sub_u32 s99, s99, 2
    buffer_load_dwordx4 v13, s[20:23], s64 offen offset:3072 lds
    v_mfma_f32_16x16x32_bf16 v[212:215], v[44:47], v[76:79], v[212:215]
    s_add_u32 s98, s98, s8
    v_mfma_f32_16x16x32_bf16 v[216:219], v[40:43], v[80:83], v[216:219]
    s_lshl_b32 s8, s99, 5
    v_lshl_add_u32 v10, v38, 4, s8
    v_lshrrev_b32 v38, 2, v37
    v_mfma_f32_16x16x32_bf16 v[216:219], v[44:47], v[84:87], v[216:219]
    s_lshr_b32 s99, s99, 1
    v_lshl_add_u32 v38, s98, 2, v38
    v_mul_u32_u24 v39, 171, v38
    v_mfma_f32_16x16x32_bf16 v[220:223], v[40:43], v[88:91], v[220:223]
    s_add_u32 s98, s98, 128
    ds_read_b64_tr_b16 v[40:41], v26 offset:0
    ds_read_b64_tr_b16 v[42:43], v26 offset:512
    v_mfma_f32_16x16x32_bf16 v[220:223], v[44:47], v[92:95], v[220:223]
    s_add_u32 s8, s100, 16
    ds_read_b64_tr_b16 v[44:45], v26 offset:4096
    ds_read_b64_tr_b16 v[46:47], v26 offset:4608
    s_waitcnt lgkmcnt(4)
    v_mfma_f32_16x16x32_bf16 v[224:227], v[48:51], v[64:67], v[224:227]
    v_add_u32 v26, 0x10000, v26
    v_and_b32 v37, 3, v37
    v_mfma_f32_16x16x32_bf16 v[224:227], v[52:55], v[68:71], v[224:227]
    s_xor_b32 s64, s64, 128
    v_lshrrev_b32 v39, 9, v39
    v_lshl_add_u32 v37, v38, 3, v37
    v_mfma_f32_16x16x32_bf16 v[228:231], v[48:51], v[72:75], v[228:231]
    v_mul_u32_u24 v38, 24, v39
    v_sub_u32 v37, v37, v38
    v_mfma_f32_16x16x32_bf16 v[228:231], v[52:55], v[76:79], v[228:231]
    v_mad_u32_u24 v39, v39, 18, v37
    v_mul_u32_u24 v39, 1152, v39
    v_mfma_f32_16x16x32_bf16 v[232:235], v[48:51], v[80:83], v[232:235]
    v_add_u32 v39, v39, v10
    v_add_u32 v12, 0, v39
    v_mfma_f32_16x16x32_bf16 v[232:235], v[52:55], v[84:87], v[232:235]
    s_add_u32 m0, s67, 98304
    v_mov_b32 v38, 1073741824
    v_cmp_gt_u32 vcc, 18, v37
    v_mfma_f32_16x16x32_bf16 v[236:239], v[48:51], v[88:91], v[236:239]
    buffer_load_dwordx4 v1, s[28:31], s65 offen sc1 lds
    v_mfma_f32_16x16x32_bf16 v[236:239], v[52:55], v[92:95], v[236:239]
    ds_read_b64_tr_b16 v[48:49], v27 offset:0
    ds_read_b64_tr_b16 v[50:51], v27 offset:512
    v_mfma_f32_16x16x32_bf16 v[240:243], v[56:59], v[64:67], v[240:243]
    ds_read_b64_tr_b16 v[52:53], v27 offset:4096
    ds_read_b64_tr_b16 v[54:55], v27 offset:4608
    v_mfma_f32_16x16x32_bf16 v[240:243], v[60:63], v[68:71], v[240:243]
    v_add_u32 v27, 0x10000, v27
    v_cndmask_b32 v12, v38, v12, vcc
    v_mfma_f32_16x16x32_bf16 v[244:247], v[56:59], v[72:75], v[244:247]
    v_add_u32 v38, 1024, v36
    v_add_u32 v13, 4608, v39
    v_mfma_f32_16x16x32_bf16 v[244:247], v[60:63], v[76:79], v[244:247]
    s_cmp_eq_u32 s4, 0
    s_cselect_b64 vcc, -1, 0
    v_cndmask_b32 v12, v12, v38, vcc
    v_mfma_f32_16x16x32_bf16 v[248:251], v[56:59], v[80:83], v[248:251]
    v_mov_b32 v38, 1073741824
    v_cmp_gt_u32 vcc, 14, v37
    v_mfma_f32_16x16x32_bf16 v[248:251], v[60:63], v[84:87], v[248:251]
    v_lshrrev_b32 v37, 8, v1
    v_cndmask_b32 v13, v38, v13, vcc
    v_mfma_f32_16x16x32_bf16 v[252:255], v[56:59], v[88:91], v[252:255]
    ds_read_b64_tr_b16 v[56:57], v28 offset:0
    ds_read_b64_tr_b16 v[58:59], v28 offset:512
    v_mfma_f32_16x16x32_bf16 v[252:255], v[60:63], v[92:95], v[252:255]
    s_waitcnt lgkmcnt(2)
    ds_read_b64_tr_b16 v[60:61], v28 offset:4096
    ds_read_b64_tr_b16 v[62:63], v28 offset:4608
    v_mfma_f32_16x16x32_bf16 a[64:67], v[40:43], v[64:67], a[64:67]
    buffer_load_dwordx4 v1, s[28:31], s65 offen offset:1024 sc1 lds
    v_mfma_f32_16x16x32_bf16 a[64:67], v[44:47], v[68:71], a[64:67]
    v_add_u32 v24, 0xfffe0000, v24
    v_add_u32 v28, 0x10000, v28
    v_mfma_f32_16x16x32_bf16 a[68:71], v[40:43], v[72:75], a[68:71]
    ds_read_b128 v[112:115], v24 offset:16384
    v_add_u32 v38, 19456, v36
    v_mfma_f32_16x16x32_bf16 a[68:71], v[44:47], v[76:79], a[68:71]
    s_cmp_eq_u32 s4, 0
    s_cselect_b64 vcc, -1, 0
    v_cndmask_b32 v13, v13, v38, vcc
    v_mfma_f32_16x16x32_bf16 a[72:75], v[40:43], v[80:83], a[72:75]
    s_cmp_eq_u32 s4, 0
    s_cselect_b32 s98, s7, s98
    s_cselect_b32 s99, s8, s99
    v_mfma_f32_16x16x32_bf16 a[72:75], v[44:47], v[84:87], a[72:75]
    s_lshr_b32 s9, s99, 2
    v_add_u32 v25, 0xfffe0000, v25
    v_bfe_u32 v36, v1, 4, 4
    v_mfma_f32_16x16x32_bf16 a[76:79], v[40:43], v[88:91], a[76:79]
    s_lshr_b32 s92, s2, 3
    ds_read_b128 v[116:119], v25 offset:16384
    v_lshrrev_b32 v9, 4, v1
    v_mfma_f32_16x16x32_bf16 a[76:79], v[44:47], v[92:95], a[76:79]
    s_lshl2_add_u32 s92, s92, s4
    v_min_u32 v9, 0, v9
    v_lshlrev_b32 v37, 2, v37
    v_mfma_f32_16x16x32_bf16 a[128:131], v[40:43], a[136:139], a[128:131]
    s_mul_i32 s92, s92, 1
    ds_read_b64_tr_b16 v[40:41], v29 offset:0
    ds_read_b64_tr_b16 v[42:43], v29 offset:512
    v_mfma_f32_16x16x32_bf16 a[128:131], v[44:47], a[140:143], a[128:131]
    s_add_u32 s92, s92, 32
    v_add_lshl_u32 v9, v9, s92, 7
    ds_read_b64_tr_b16 v[44:45], v29 offset:4096
    v_mfma_f32_16x16x32_bf16 a[80:83], v[48:51], v[64:67], a[80:83]
    s_add_u32 m0, s68, 106496
    ds_read_b128 v[120:123], v24 offset:24576
    ds_read_b64_tr_b16 v[46:47], v29 offset:4608
    v_mfma_f32_16x16x32_bf16 a[80:83], v[52:55], v[68:71], a[80:83]
    s_getpc_b64 s[92:93]
    global_load_dword v9, v9, s[92:93]
    v_mfma_f32_16x16x32_bf16 a[84:87], v[48:51], v[72:75], a[84:87]
    s_sub_u32 s9, s9, s10
    buffer_load_dwordx4 v6, s[20:23], s66 offen lds
    v_mfma_f32_16x16x32_bf16 a[84:87], v[52:55], v[76:79], a[84:87]
    s_sub_u32 s9, s9, 1
    v_add_u32 v29, 0x10000, v29
    v_sub_u32 v36, v36, v37
    v_mfma_f32_16x16x32_bf16 a[88:91], v[48:51], v[80:83], a[88:91]
    s_and_b32 s9, s9, 3
    ds_read_b128 v[124:127], v25 offset:24576
    v_mov_b32 v37, 0xf149f2ca
    v_mfma_f32_16x16x32_bf16 a[88:91], v[52:55], v[84:87], a[88:91]
    s_lshl_b32 s9, s9, 1
    v_bfe_u32 v38, v1, 4, 2
    v_and_b32 v39, 0x40, v1
    v_mfma_f32_16x16x32_bf16 a[92:95], v[48:51], v[88:91], a[92:95]
    s_and_b32 s10, s99, 3
    v_mfma_f32_16x16x32_bf16 a[92:95], v[52:55], v[92:95], a[92:95]
    s_cmp_eq_u32 s9, 6
    s_cselect_b32 s9, 7, s9
    v_mfma_f32_16x16x32_bf16 a[132:135], v[48:51], a[136:139], a[132:135]
    s_mul_i32 s10, s10, 9
    v_mfma_f32_16x16x32_bf16 a[132:135], v[52:55], a[140:143], a[132:135]
    s_add_u32 s9, s9, s10
    s_waitcnt lgkmcnt(0)
    v_mfma_f32_16x16x32_bf16 a[96:99], v[56:59], v[64:67], a[96:99]
    s_lshl_b32 s64, s9, 10
    v_mfma_f32_16x16x32_bf16 a[96:99], v[60:63], v[68:71], a[96:99]
    s_xor_b32 s65, s65, 122880
    v_mfma_f32_16x16x32_bf16 a[100:103], v[56:59], v[72:75], a[100:103]
    s_xor_b32 s66, s66, 1920
    v_mfma_f32_16x16x32_bf16 a[100:103], v[60:63], v[76:79], a[100:103]
    s_andn2_b32 s65, s65, 57344
    v_mfma_f32_16x16x32_bf16 a[104:107], v[56:59], v[80:83], a[104:107]
    s_andn2_b32 s66, s66, 896
    v_mfma_f32_16x16x32_bf16 a[104:107], v[60:63], v[84:87], a[104:107]
    s_waitcnt vmcnt(4) lgkmcnt(0)
    s_barrier
    ds_read_b64_tr_b16 v[48:49], v14 offset:32768
    v_mfma_f32_16x16x32_bf16 a[108:111], v[56:59], v[88:91], a[108:111]
    s_add_u32 m0, s67, 131072
    buffer_store_dword v31, v30, s[32:35], s101 offen sc1
    v_mfma_f32_16x16x32_bf16 a[108:111], v[60:63], v[92:95], a[108:111]
    s_sub_u32 s9, s99, 16
    buffer_load_dwordx4 v1, s[28:31], s65 offen sc1 lds
    v_mfma_f32_16x16x32_bf16 a[112:115], v[40:43], v[64:67], a[112:115]
    s_mul_i32 s9, s9, 18432
    ds_read_b64_tr_b16 v[50:51], v14 offset:33792
    ds_read_b64_tr_b16 v[52:53], v14 offset:40960
    v_mfma_f32_16x16x32_bf16 a[112:115], v[44:47], v[68:71], a[112:115]
    s_add_u32 s9, s9, 6144
    ds_read_b64_tr_b16 v[54:55], v14 offset:41984
    ds_read_b64_tr_b16 v[56:57], v15 offset:32768
    v_mfma_f32_16x16x32_bf16 a[116:119], v[40:43], v[72:75], a[116:119]
    s_mov_b32 s10, 1024
    ds_read_b64_tr_b16 v[58:59], v15 offset:33792
    ds_read_b64_tr_b16 v[60:61], v15 offset:40960
    v_mfma_f32_16x16x32_bf16 a[116:119], v[44:47], v[76:79], a[116:119]
    s_mul_i32 s98, s98, 36864
    ds_read_b64_tr_b16 v[62:63], v15 offset:41984
    v_add_u32 v14, 0x10000, v14
    v_mfma_f32_16x16x32_bf16 a[120:123], v[40:43], v[80:83], a[120:123]
    s_mul_i32 s7, s7, 36864
    v_add_u32 v15, 0x10000, v15
    v_mfma_f32_16x16x32_bf16 a[120:123], v[44:47], v[84:87], a[120:123]
    s_cmp_lt_u32 s99, 16
    s_cselect_b32 s64, s64, s9
    s_cselect_b32 s10, s10, 9216
    v_mfma_f32_16x16x32_bf16 a[124:127], v[40:43], v[88:91], a[124:127]
    s_lshl2_add_u32 s99, s100, s4
    ds_read_b64_tr_b16 v[40:41], v16 offset:32768
    ds_read_b64_tr_b16 v[42:43], v16 offset:33792
    v_mfma_f32_16x16x32_bf16 a[124:127], v[44:47], v[92:95], a[124:127]
    s_add_u32 s64, s64, s98
    ds_read_b64_tr_b16 v[44:45], v16 offset:40960
    ds_read_b64_tr_b16 v[46:47], v16 offset:41984
    s_waitcnt lgkmcnt(5)
    v_mfma_f32_16x16x32_bf16 v[128:131], v[48:51], v[96:99], v[128:131]
    s_lshl_b32 s99, s99, 1
    v_add_u32 v16, 0x10000, v16
    v_mfma_f32_16x16x32_bf16 v[128:131], v[52:55], v[100:103], v[128:131]
    s_add_u32 s62, s64, s10
    v_mfma_f32_16x16x32_bf16 v[132:135], v[48:51], v[104:107], v[132:135]
    s_lshr_b32 s9, s99, 2
    ds_read_b128 v[64:67], v24 offset:49152
    v_mfma_f32_16x16x32_bf16 v[132:135], v[52:55], v[108:111], v[132:135]
    s_lshr_b32 s10, s5, 3
    v_mfma_f32_16x16x32_bf16 v[136:139], v[48:51], v[112:115], v[136:139]
    s_sub_u32 s9, s9, s10
    v_mfma_f32_16x16x32_bf16 v[136:139], v[52:55], v[116:119], v[136:139]
    s_sub_u32 s9, s9, 1
    v_mfma_f32_16x16x32_bf16 v[140:143], v[48:51], v[120:123], v[140:143]
    s_and_b32 s9, s9, 3
    ds_read_b64_tr_b16 v[48:49], v17 offset:32768
    ds_read_b64_tr_b16 v[50:51], v17 offset:33792
    v_mfma_f32_16x16x32_bf16 v[140:143], v[52:55], v[124:127], v[140:143]
    s_lshl_b32 s9, s9, 1
    ds_read_b64_tr_b16 v[52:53], v17 offset:40960
    ds_read_b64_tr_b16 v[54:55], v17 offset:41984
    v_mfma_f32_16x16x32_bf16 v[144:147], v[56:59], v[96:99], v[144:147]
    s_and_b32 s10, s99, 3
    ds_read_b128 v[68:71], v25 offset:49152
    v_add_u32 v17, 0x10000, v17
    s_waitcnt lgkmcnt(5)
    v_mfma_f32_16x16x32_bf16 v[144:147], v[60:63], v[100:103], v[144:147]
    s_cmp_eq_u32 s9, 6
    s_cselect_b32 s9, 7, s9
    v_mfma_f32_16x16x32_bf16 v[148:151], v[56:59], v[104:107], v[148:151]
    s_mul_i32 s10, s10, 9
    buffer_load_dwordx4 v1, s[28:31], s65 offen offset:1024 sc1 lds
    v_mfma_f32_16x16x32_bf16 v[148:151], v[60:63], v[108:111], v[148:151]
    s_add_u32 s9, s9, s10
    v_mfma_f32_16x16x32_bf16 v[152:155], v[56:59], v[112:115], v[152:155]
    s_lshl_b32 s63, s9, 10
    v_mfma_f32_16x16x32_bf16 v[152:155], v[60:63], v[116:119], v[152:155]
    s_cmp_eq_u32 s4, 0
    s_cselect_b32 s8, 1.0, 0
    v_mfma_f32_16x16x32_bf16 v[156:159], v[56:59], v[120:123], v[156:159]
    s_add_u32 s63, s63, s7
    ds_read_b128 v[72:75], v24 offset:57344
    ds_read_b64_tr_b16 v[56:57], v18 offset:32768
    v_mfma_f32_16x16x32_bf16 v[156:159], v[60:63], v[124:127], v[156:159]
    ds_read_b64_tr_b16 v[58:59], v18 offset:33792
    ds_read_b64_tr_b16 v[60:61], v18 offset:40960
    v_mfma_f32_16x16x32_bf16 v[160:163], v[40:43], v[96:99], v[160:163]
    ds_read_b64_tr_b16 v[62:63], v18 offset:41984
    v_add_u32 v18, 0x10000, v18
    v_mfma_f32_16x16x32_bf16 v[160:163], v[44:47], v[100:103], v[160:163]
    s_cmp_eq_u32 s4, 1
    s_cselect_b32 s9, 1.0, 0
    v_mfma_f32_16x16x32_bf16 v[164:167], v[40:43], v[104:107], v[164:167]
    s_cmp_eq_u32 s6, 0
    s_cselect_b32 s16, s8, 0
    s_cselect_b32 s17, s9, 0
    v_mfma_f32_16x16x32_bf16 v[164:167], v[44:47], v[108:111], v[164:167]
    s_cmp_eq_u32 s4, 2
    s_cselect_b32 s10, 1.0, 0
    v_mfma_f32_16x16x32_bf16 v[168:171], v[40:43], v[112:115], v[168:171]
    ds_read_b128 v[76:79], v25 offset:57344
    v_mfma_f32_16x16x32_bf16 v[168:171], v[44:47], v[116:119], v[168:171]
    s_cmp_eq_u32 s6, 0
    s_cselect_b32 s18, s10, 0
    s_cselect_b32 s19, s11, 0
    v_mfma_f32_16x16x32_bf16 v[172:175], v[40:43], v[120:123], v[172:175]
    ds_read_b64_tr_b16 v[40:41], v19 offset:32768
    ds_read_b64_tr_b16 v[42:43], v19 offset:33792
    v_mfma_f32_16x16x32_bf16 v[172:175], v[44:47], v[124:127], v[172:175]
    s_waitcnt lgkmcnt(3)
    ds_read_b64_tr_b16 v[44:45], v19 offset:40960
    ds_read_b64_tr_b16 v[46:47], v19 offset:41984
    v_mfma_f32_16x16x32_bf16 v[176:179], v[48:51], v[96:99], v[176:179]
    v_add_u32 v19, 0x10000, v19
    v_mfma_f32_16x16x32_bf16 v[176:179], v[52:55], v[100:103], v[176:179]
    v_mfma_f32_16x16x32_bf16 v[180:183], v[48:51], v[104:107], v[180:183]
    v_mfma_f32_16x16x32_bf16 v[180:183], v[52:55], v[108:111], v[180:183]
    v_add_u32 v24, 0x10000, v24
    v_mfma_f32_16x16x32_bf16 v[184:187], v[48:51], v[112:115], v[184:187]
    ds_read_b128 v[80:83], v24 offset:16384
    v_mfma_f32_16x16x32_bf16 v[184:187], v[52:55], v[116:119], v[184:187]
    s_add_u32 m0, s68, 139264
    v_mfma_f32_16x16x32_bf16 v[188:191], v[48:51], v[120:123], v[188:191]
    buffer_load_dwordx4 v6, s[20:23], s66 offen lds
    v_mfma_f32_16x16x32_bf16 v[188:191], v[52:55], v[124:127], v[188:191]
    ds_read_b64_tr_b16 v[48:49], v20 offset:32768
    ds_read_b64_tr_b16 v[50:51], v20 offset:33792
    v_mfma_f32_16x16x32_bf16 v[192:195], v[56:59], v[96:99], v[192:195]
    ds_read_b64_tr_b16 v[52:53], v20 offset:40960
    ds_read_b64_tr_b16 v[54:55], v20 offset:41984
    v_mfma_f32_16x16x32_bf16 v[192:195], v[60:63], v[100:103], v[192:195]
    v_add_u32 v25, 0x10000, v25
    v_add_u32 v20, 0x10000, v20
    v_mfma_f32_16x16x32_bf16 v[196:199], v[56:59], v[104:107], v[196:199]
    ds_read_b128 v[84:87], v25 offset:16384
    v_mfma_f32_16x16x32_bf16 v[196:199], v[60:63], v[108:111], v[196:199]
    s_cmp_eq_u32 s6, 0
    s_cselect_b32 s20, s12, 0
    s_cselect_b32 s21, s13, 0
    v_mfma_f32_16x16x32_bf16 v[200:203], v[56:59], v[112:115], v[200:203]
    s_cmp_eq_u32 s6, 0
    s_cselect_b32 s22, s14, 0
    s_cselect_b32 s23, s15, 0
    v_mfma_f32_16x16x32_bf16 v[200:203], v[60:63], v[116:119], v[200:203]
    v_mfma_f32_16x16x32_bf16 v[204:207], v[56:59], v[120:123], v[204:207]
    ds_read_b64_tr_b16 v[56:57], v21 offset:32768
    ds_read_b64_tr_b16 v[58:59], v21 offset:33792
    v_mfma_f32_16x16x32_bf16 v[204:207], v[60:63], v[124:127], v[204:207]
    s_waitcnt lgkmcnt(2)
    ds_read_b64_tr_b16 v[60:61], v21 offset:40960
    ds_read_b64_tr_b16 v[62:63], v21 offset:41984
    v_mfma_f32_16x16x32_bf16 v[208:211], v[40:43], v[96:99], v[208:211]
    ds_read_b128 v[88:91], v24 offset:24576
    v_add_u32 v21, 0x10000, v21
    v_mfma_f32_16x16x32_bf16 v[208:211], v[44:47], v[100:103], v[208:211]
    v_mfma_f32_16x16x32_bf16 v[212:215], v[40:43], v[104:107], v[212:215]
    v_mfma_f32_16x16x32_bf16 v[212:215], v[44:47], v[108:111], v[212:215]
    v_mfma_f32_16x16x32_bf16 v[216:219], v[40:43], v[112:115], v[216:219]
    v_mfma_f32_16x16x32_bf16 v[216:219], v[44:47], v[116:119], v[216:219]
    v_mfma_f32_16x16x32_bf16 v[220:223], v[40:43], v[120:123], v[220:223]
    ds_read_b128 v[92:95], v25 offset:24576
    ds_read_b64_tr_b16 v[40:41], v14 offset:0
    v_mfma_f32_16x16x32_bf16 v[220:223], v[44:47], v[124:127], v[220:223]
    ds_read_b64_tr_b16 v[42:43], v14 offset:1024
    ds_read_b64_tr_b16 v[44:45], v14 offset:8192
    v_mfma_f32_16x16x32_bf16 v[224:227], v[48:51], v[96:99], v[224:227]
    ds_read_b64_tr_b16 v[46:47], v14 offset:9216
    v_mfma_f32_16x16x32_bf16 v[224:227], v[52:55], v[100:103], v[224:227]
    s_xor_b32 s65, s65, 8192
    v_mfma_f32_16x16x32_bf16 v[228:231], v[48:51], v[104:107], v[228:231]
    s_xor_b32 s66, s66, 128
    v_mfma_f32_16x16x32_bf16 v[228:231], v[52:55], v[108:111], v[228:231]
    v_mfma_f32_16x16x32_bf16 v[232:235], v[48:51], v[112:115], v[232:235]
    v_mfma_f32_16x16x32_bf16 v[232:235], v[52:55], v[116:119], v[232:235]
    v_mfma_f32_16x16x32_bf16 v[236:239], v[48:51], v[120:123], v[236:239]
    ds_read_b64_tr_b16 v[48:49], v15 offset:0
    ds_read_b64_tr_b16 v[50:51], v15 offset:1024
    v_mfma_f32_16x16x32_bf16 v[236:239], v[52:55], v[124:127], v[236:239]
    s_waitcnt lgkmcnt(2)
    ds_read_b64_tr_b16 v[52:53], v15 offset:8192
    ds_read_b64_tr_b16 v[54:55], v15 offset:9216
    v_mfma_f32_16x16x32_bf16 v[240:243], v[56:59], v[96:99], v[240:243]
    v_mfma_f32_16x16x32_bf16 v[240:243], v[60:63], v[100:103], v[240:243]
    v_mfma_f32_16x16x32_bf16 v[244:247], v[56:59], v[104:107], v[244:247]
    v_mfma_f32_16x16x32_bf16 v[244:247], v[60:63], v[108:111], v[244:247]
    v_mfma_f32_16x16x32_bf16 v[248:251], v[56:59], v[112:115], v[248:251]
    v_mfma_f32_16x16x32_bf16 v[248:251], v[60:63], v[116:119], v[248:251]
    v_mfma_f32_16x16x32_bf16 v[252:255], v[56:59], v[120:123], v[252:255]
    ds_read_b64_tr_b16 v[56:57], v16 offset:0
    ds_read_b64_tr_b16 v[58:59], v16 offset:1024
    v_mfma_f32_16x16x32_bf16 v[252:255], v[60:63], v[124:127], v[252:255]
    buffer_load_dword v7, v8, s[32:35], s61 offen sc1
    v_mfma_f32_16x16x32_bf16 v[128:131], v[40:43], v[64:67], v[128:131]
    ds_read_b64_tr_b16 v[60:61], v16 offset:8192
    ds_read_b64_tr_b16 v[62:63], v16 offset:9216
    v_mfma_f32_16x16x32_bf16 v[128:131], v[44:47], v[68:71], v[128:131]
    v_mfma_f32_16x16x32_bf16 v[132:135], v[40:43], v[72:75], v[132:135]
    v_mfma_f32_16x16x32_bf16 v[132:135], v[44:47], v[76:79], v[132:135]
    v_mfma_f32_16x16x32_bf16 v[136:139], v[40:43], v[80:83], v[136:139]
    v_mfma_f32_16x16x32_bf16 v[136:139], v[44:47], v[84:87], v[136:139]
    v_mfma_f32_16x16x32_bf16 v[140:143], v[40:43], v[88:91], v[140:143]
    ds_read_b64_tr_b16 v[40:41], v17 offset:0
    ds_read_b64_tr_b16 v[42:43], v17 offset:1024
    v_mfma_f32_16x16x32_bf16 v[140:143], v[44:47], v[92:95], v[140:143]
    s_waitcnt lgkmcnt(2)
    ds_read_b64_tr_b16 v[44:45], v17 offset:8192
    ds_read_b64_tr_b16 v[46:47], v17 offset:9216
    v_mfma_f32_16x16x32_bf16 v[144:147], v[48:51], v[64:67], v[144:147]
    v_cvt_pk_bf16_f32 v128, v128, v129
    v_cvt_pk_bf16_f32 v129, v130, v131
    v_mfma_f32_16x16x32_bf16 v[144:147], v[52:55], v[68:71], v[144:147]
    v_cvt_pk_bf16_f32 v132, v132, v133
    v_cvt_pk_bf16_f32 v133, v134, v135
    v_mfma_f32_16x16x32_bf16 v[148:151], v[48:51], v[72:75], v[148:151]
    v_cvt_pk_bf16_f32 v136, v136, v137
    v_cvt_pk_bf16_f32 v137, v138, v139
    v_mfma_f32_16x16x32_bf16 v[148:151], v[52:55], v[76:79], v[148:151]
    v_cvt_pk_bf16_f32 v140, v140, v141
    v_cvt_pk_bf16_f32 v141, v142, v143
    v_mfma_f32_16x16x32_bf16 v[152:155], v[48:51], v[80:83], v[152:155]
    v_cvt_pk_bf16_f32 v130, v144, v145
    v_cvt_pk_bf16_f32 v131, v146, v147
    v_mfma_f32_16x16x32_bf16 v[152:155], v[52:55], v[84:87], v[152:155]
    v_mfma_f32_16x16x32_bf16 v[156:159], v[48:51], v[88:91], v[156:159]
    ds_read_b64_tr_b16 v[48:49], v18 offset:0
    ds_read_b64_tr_b16 v[50:51], v18 offset:1024
    v_mfma_f32_16x16x32_bf16 v[156:159], v[52:55], v[92:95], v[156:159]
    ds_read_b64_tr_b16 v[52:53], v18 offset:8192
    ds_read_b64_tr_b16 v[54:55], v18 offset:9216
    v_mfma_f32_16x16x32_bf16 v[160:163], v[56:59], v[64:67], v[160:163]
    v_cvt_pk_bf16_f32 v134, v148, v149
    v_cvt_pk_bf16_f32 v135, v150, v151
    v_mfma_f32_16x16x32_bf16 v[160:163], v[60:63], v[68:71], v[160:163]
    v_cvt_pk_bf16_f32 v138, v152, v153
    v_cvt_pk_bf16_f32 v139, v154, v155
    v_mfma_f32_16x16x32_bf16 v[164:167], v[56:59], v[72:75], v[164:167]
    v_cvt_pk_bf16_f32 v142, v156, v157
    v_cvt_pk_bf16_f32 v143, v158, v159
    v_mfma_f32_16x16x32_bf16 v[164:167], v[60:63], v[76:79], v[164:167]
    v_mfma_f32_16x16x32_bf16 v[168:171], v[56:59], v[80:83], v[168:171]
    v_mfma_f32_16x16x32_bf16 v[168:171], v[60:63], v[84:87], v[168:171]
    v_cvt_pk_bf16_f32 v160, v160, v161
    v_cvt_pk_bf16_f32 v161, v162, v163
    v_mfma_f32_16x16x32_bf16 v[172:175], v[56:59], v[88:91], v[172:175]
    ds_read_b64_tr_b16 v[56:57], v19 offset:0
    ds_read_b64_tr_b16 v[58:59], v19 offset:1024
    v_mfma_f32_16x16x32_bf16 v[172:175], v[60:63], v[92:95], v[172:175]
    s_waitcnt lgkmcnt(2)
    ds_read_b64_tr_b16 v[60:61], v19 offset:8192
    ds_read_b64_tr_b16 v[62:63], v19 offset:9216
    v_mfma_f32_16x16x32_bf16 v[176:179], v[40:43], v[64:67], v[176:179]
    v_cvt_pk_bf16_f32 v164, v164, v165
    v_cvt_pk_bf16_f32 v165, v166, v167
    v_mfma_f32_16x16x32_bf16 v[176:179], v[44:47], v[68:71], v[176:179]
    v_cvt_pk_bf16_f32 v168, v168, v169
    v_cvt_pk_bf16_f32 v169, v170, v171
    v_mfma_f32_16x16x32_bf16 v[180:183], v[40:43], v[72:75], v[180:183]
    v_cvt_pk_bf16_f32 v172, v172, v173
    v_cvt_pk_bf16_f32 v173, v174, v175
    v_mfma_f32_16x16x32_bf16 v[180:183], v[44:47], v[76:79], v[180:183]
    v_mfma_f32_16x16x32_bf16 v[184:187], v[40:43], v[80:83], v[184:187]
    v_mfma_f32_16x16x32_bf16 v[184:187], v[44:47], v[84:87], v[184:187]
    v_cvt_pk_bf16_f32 v162, v176, v177
    v_cvt_pk_bf16_f32 v163, v178, v179
    v_mfma_f32_16x16x32_bf16 v[188:191], v[40:43], v[88:91], v[188:191]
    ds_read_b64_tr_b16 v[40:41], v20 offset:0
    ds_read_b64_tr_b16 v[42:43], v20 offset:1024
    v_mfma_f32_16x16x32_bf16 v[188:191], v[44:47], v[92:95], v[188:191]
    ds_read_b64_tr_b16 v[44:45], v20 offset:8192
    ds_read_b64_tr_b16 v[46:47], v20 offset:9216
    v_mfma_f32_16x16x32_bf16 v[192:195], v[48:51], v[64:67], v[192:195]
    v_cvt_pk_bf16_f32 v166, v180, v181
    v_cvt_pk_bf16_f32 v167, v182, v183
    v_mfma_f32_16x16x32_bf16 v[192:195], v[52:55], v[68:71], v[192:195]
    v_cvt_pk_bf16_f32 v170, v184, v185
    v_cvt_pk_bf16_f32 v171, v186, v187
    s_waitcnt vmcnt(0)
    v_cmp_gt_u32 vcc, 1, v7
    s_nop 1
    s_and_b64 vcc, vcc, exec
    s_cbranch_scc1 SPIN_KV
BACK_KV:
    v_mfma_f32_16x16x32_bf16 v[196:199], v[48:51], v[72:75], v[196:199]
    s_mov_b32 s77, s75
    buffer_load_dwordx4 a[224:227], v1, s[36:39], 0 offen offset:0 sc1
    v_mfma_f32_16x16x32_bf16 v[196:199], v[52:55], v[76:79], v[196:199]
    buffer_load_dwordx4 a[228:231], v1, s[36:39], 0 offen offset:1024 sc1
    v_mfma_f32_16x16x32_bf16 v[200:203], v[48:51], v[80:83], v[200:203]
    v_cmp_le_i32 vcc, 0, v36
    v_cvt_pk_bf16_f32 v192, v192, v193
    v_mfma_f32_16x16x32_bf16 v[200:203], v[52:55], v[84:87], v[200:203]
    v_cvt_pk_bf16_f32 v193, v194, v195
    v_cvt_pk_bf16_f32 v174, v188, v189
    v_mfma_f32_16x16x32_bf16 v[204:207], v[48:51], v[88:91], v[204:207]
    buffer_load_dwordx4 a[232:235], v1, s[36:39], 0 offen offset:2048 sc1
    v_mfma_f32_16x16x32_bf16 v[204:207], v[52:55], v[92:95], v[204:207]
    s_waitcnt lgkmcnt(0)
    ds_read_b64_tr_b16 v[48:49], v21 offset:0
    ds_read_b64_tr_b16 v[50:51], v21 offset:1024
    v_mfma_f32_16x16x32_bf16 v[208:211], v[56:59], v[64:67], v[208:211]
    ds_read_b64_tr_b16 v[52:53], v21 offset:8192
    ds_read_b64_tr_b16 v[54:55], v21 offset:9216
    v_mfma_f32_16x16x32_bf16 v[208:211], v[60:63], v[68:71], v[208:211]
    v_cvt_pk_bf16_f32 v196, v196, v197
    v_cvt_pk_bf16_f32 v197, v198, v199
    v_mfma_f32_16x16x32_bf16 v[212:215], v[56:59], v[72:75], v[212:215]
    buffer_load_dwordx4 a[236:239], v1, s[36:39], 0 offen offset:3072 sc1
    v_mfma_f32_16x16x32_bf16 v[212:215], v[60:63], v[76:79], v[212:215]
    v_cvt_pk_bf16_f32 v200, v200, v201
    v_cvt_pk_bf16_f32 v201, v202, v203
    v_mfma_f32_16x16x32_bf16 v[216:219], v[56:59], v[80:83], v[216:219]
    v_cvt_pk_bf16_f32 v194, v208, v209
    v_cndmask_b32_e64 v208, v37, 0, vcc
    v_mfma_f32_16x16x32_bf16 v[216:219], v[60:63], v[84:87], v[216:219]
    v_mul_f32 v176, s16, v208
    v_cmp_le_i32 vcc, 1, v36
    v_mfma_f32_16x16x32_bf16 v[220:223], v[56:59], v[88:91], v[220:223]
    v_cvt_pk_bf16_f32 v195, v210, v211
    v_cndmask_b32_e64 v209, v37, 0, vcc
    v_mfma_f32_16x16x32_bf16 v[220:223], v[60:63], v[92:95], v[220:223]
    v_mul_f32 v177, s16, v209
    v_cmp_le_i32 vcc, 2, v36
    v_mfma_f32_16x16x32_bf16 v[224:227], v[40:43], v[64:67], v[224:227]
    s_mov_b32 s38, 16384
    v_cndmask_b32_e64 v210, v37, 0, vcc
    v_mul_f32 v178, s16, v210
    v_mfma_f32_16x16x32_bf16 v[224:227], v[44:47], v[68:71], v[224:227]
    s_add_u32 m0, s76, s75
    v_cmp_le_i32 vcc, 3, v36
    v_cvt_pk_bf16_f32 v198, v212, v213
    v_mfma_f32_16x16x32_bf16 v[228:231], v[40:43], v[72:75], v[228:231]
    buffer_load_dwordx4 v1, s[36:39], s77 offen sc1 lds
    v_mfma_f32_16x16x32_bf16 v[228:231], v[44:47], v[76:79], v[228:231]
    v_cndmask_b32_e64 v211, v37, 0, vcc
    v_mul_f32 v179, s16, v211
    v_mfma_f32_16x16x32_bf16 v[232:235], v[40:43], v[80:83], v[232:235]
    v_cvt_pk_bf16_f32 v224, v224, v225
    v_cvt_pk_bf16_f32 v225, v226, v227
    v_mfma_f32_16x16x32_bf16 v[232:235], v[44:47], v[84:87], v[232:235]
    s_waitcnt vmcnt(6) lgkmcnt(0)
    s_barrier
    ds_read_b64_tr_b16 v[56:57], v26 offset:32768
    v_mfma_f32_16x16x32_bf16 v[236:239], v[40:43], v[88:91], v[236:239]
    buffer_load_dwordx4 v1, s[36:39], s77 offen offset:1024 sc1 lds
    v_mfma_f32_16x16x32_bf16 v[236:239], v[44:47], v[92:95], v[236:239]
    ds_read_b64_tr_b16 v[58:59], v26 offset:33280
    ds_read_b64_tr_b16 v[60:61], v26 offset:36864
    v_mfma_f32_16x16x32_bf16 v[240:243], v[48:51], v[64:67], v[240:243]
    ds_read_b64_tr_b16 v[62:63], v26 offset:37376
    ds_read_b128 a[136:139], v22 offset:32768
    v_mfma_f32_16x16x32_bf16 v[240:243], v[52:55], v[68:71], v[240:243]
    ds_read_b128 a[140:143], v23 offset:32768
    v_add_u32 v26, 0x10000, v26
    v_mfma_f32_16x16x32_bf16 v[244:247], v[48:51], v[72:75], v[244:247]
    buffer_load_dwordx4 v1, s[36:39], s77 offen offset:2048 sc1 lds
    v_mfma_f32_16x16x32_bf16 v[244:247], v[52:55], v[76:79], v[244:247]
    ds_read_b64_tr_b16 v[40:41], v27 offset:32768
    ds_read_b64_tr_b16 v[42:43], v27 offset:33280
    v_mfma_f32_16x16x32_bf16 v[248:251], v[48:51], v[80:83], v[248:251]
    ds_read_b64_tr_b16 v[44:45], v27 offset:36864
    ds_read_b64_tr_b16 v[46:47], v27 offset:37376
    v_mfma_f32_16x16x32_bf16 v[248:251], v[52:55], v[84:87], v[248:251]
    v_add_u32 v22, 0x10000, v22
    v_add_u32 v23, 0x10000, v23
    v_mfma_f32_16x16x32_bf16 v[252:255], v[48:51], v[88:91], v[252:255]
    buffer_load_dwordx4 v1, s[36:39], s77 offen offset:3072 sc1 lds
    v_mfma_f32_16x16x32_bf16 v[252:255], v[52:55], v[92:95], v[252:255]
    s_waitcnt lgkmcnt(4)
    ds_read_b64_tr_b16 v[48:49], v28 offset:32768
    ds_read_b64_tr_b16 v[50:51], v28 offset:33280
    v_mfma_f32_16x16x32_bf16 a[64:67], v[56:59], v[96:99], a[64:67]
    s_add_u32 s100, s77, 4096
    ds_read_b64_tr_b16 v[52:53], v28 offset:36864
    ds_read_b64_tr_b16 v[54:55], v28 offset:37376
    v_mfma_f32_16x16x32_bf16 a[64:67], v[60:63], v[100:103], a[64:67]
    s_add_u32 m0, m0, 4096
    v_add_u32 v27, 0x10000, v27
    v_add_u32 v28, 0x10000, v28
    v_mfma_f32_16x16x32_bf16 a[68:71], v[56:59], v[104:107], a[68:71]
    buffer_load_dwordx4 v1, s[36:39], s100 offen sc1 lds
    v_mfma_f32_16x16x32_bf16 a[68:71], v[60:63], v[108:111], a[68:71]
    v_cvt_pk_bf16_f32 v226, v240, v241
    v_cvt_pk_bf16_f32 v227, v242, v243
    v_mfma_f32_16x16x32_bf16 a[72:75], v[56:59], v[112:115], a[72:75]
    v_cvt_pk_bf16_f32 v228, v228, v229
    v_cvt_pk_bf16_f32 v229, v230, v231
    v_mfma_f32_16x16x32_bf16 a[72:75], v[60:63], v[116:119], a[72:75]
    v_cvt_pk_bf16_f32 v230, v244, v245
    v_cvt_pk_bf16_f32 v231, v246, v247
    v_mfma_f32_16x16x32_bf16 a[76:79], v[56:59], v[120:123], a[76:79]
    buffer_load_dwordx4 v1, s[36:39], s100 offen offset:1024 sc1 lds
    v_mfma_f32_16x16x32_bf16 a[76:79], v[60:63], v[124:127], a[76:79]
    v_cvt_pk_bf16_f32 v199, v214, v215
    v_cvt_pk_bf16_f32 v232, v232, v233
    v_mfma_f32_16x16x32_bf16 a[128:131], v[56:59], a[136:139], a[128:131]
    ds_read_b64_tr_b16 v[56:57], v29 offset:32768
    ds_read_b64_tr_b16 v[58:59], v29 offset:33280
    v_mfma_f32_16x16x32_bf16 a[128:131], v[60:63], a[140:143], a[128:131]
    s_waitcnt lgkmcnt(2)
    ds_read_b64_tr_b16 v[60:61], v29 offset:36864
    ds_read_b64_tr_b16 v[62:63], v29 offset:37376
    v_mfma_f32_16x16x32_bf16 a[80:83], v[40:43], v[96:99], a[80:83]
    buffer_load_dwordx4 v1, s[36:39], s100 offen offset:2048 sc1 lds
    v_mfma_f32_16x16x32_bf16 a[80:83], v[44:47], v[100:103], a[80:83]
    v_add_u32 v29, 0x10000, v29
    v_cvt_pk_bf16_f32 v233, v234, v235
    v_mfma_f32_16x16x32_bf16 a[84:87], v[40:43], v[104:107], a[84:87]
    v_cvt_pk_bf16_f32 v234, v248, v249
    v_cvt_pk_bf16_f32 v235, v250, v251
    v_mfma_f32_16x16x32_bf16 a[84:87], v[44:47], v[108:111], a[84:87]
    v_cvt_pk_bf16_f32 v202, v216, v217
    v_cvt_pk_bf16_f32 v203, v218, v219
    v_mfma_f32_16x16x32_bf16 a[88:91], v[40:43], v[112:115], a[88:91]
    buffer_load_dwordx4 v1, s[36:39], s100 offen offset:3072 sc1 lds
    v_mfma_f32_16x16x32_bf16 a[88:91], v[44:47], v[116:119], a[88:91]
    v_cvt_pk_bf16_f32 v175, v190, v191
    v_cvt_pk_bf16_f32 v236, v236, v237
    v_mfma_f32_16x16x32_bf16 a[92:95], v[40:43], v[120:123], a[92:95]
    s_lshr_b32 s82, s4, 1
    s_add_u32 s82, s82, 32
    v_cvt_pk_bf16_f32 v237, v238, v239
    v_mfma_f32_16x16x32_bf16 a[92:95], v[44:47], v[124:127], a[92:95]
    s_sub_u32 s82, s82, s6
    v_cvt_pk_bf16_f32 v238, v252, v253
    v_cvt_pk_bf16_f32 v239, v254, v255
    v_mfma_f32_16x16x32_bf16 a[132:135], v[40:43], a[136:139], a[132:135]
    s_add_u32 s76, s76, 32768
    s_sub_u32 s82, s82, s6
    ds_read_b64_tr_b16 v[40:41], v26 offset:0
    v_mfma_f32_16x16x32_bf16 a[132:135], v[44:47], a[140:143], a[132:135]
    s_waitcnt vmcnt(8)
    s_add_u32 s77, s77, 32768
    s_lshl_b32 s38, s82, 15
    v_mfma_f32_16x16x32_bf16 v[240:243], a[224:227], v[128:131], v[176:179]
    s_add_u32 m0, s76, s75
    ds_read_b64_tr_b16 v[42:43], v26 offset:512
    ds_read_b64_tr_b16 v[44:45], v26 offset:4096
    v_mfma_f32_16x16x32_bf16 v[240:243], a[228:231], v[160:163], v[240:243]
    s_mov_b32 s82, 0
    buffer_load_dwordx4 v1, s[36:39], s77 offen sc1 lds
    v_mfma_f32_16x16x32_bf16 v[240:243], a[232:235], v[192:195], v[240:243]
    buffer_load_dwordx4 v1, s[36:39], s77 offen offset:1024 sc1 lds
    v_mfma_f32_16x16x32_bf16 v[240:243], a[236:239], v[224:227], v[240:243]
    ds_read_b64_tr_b16 v[46:47], v26 offset:4608
    ds_read_b128 a[136:139], v22 offset:0
    v_mfma_f32_16x16x32_bf16 v[244:247], a[224:227], v[132:135], 0
    ds_read_b128 a[140:143], v23 offset:0
    v_cvt_pk_bf16_f32 v204, v204, v205
    v_mfma_f32_16x16x32_bf16 v[244:247], a[228:231], v[164:167], v[244:247]
    v_cvt_pk_bf16_f32 v205, v206, v207
    v_cvt_pk_bf16_f32 v206, v220, v221
    v_mfma_f32_16x16x32_bf16 v[244:247], a[232:235], v[196:199], v[244:247]
    buffer_load_dwordx4 v1, s[36:39], s77 offen offset:2048 sc1 lds
    v_mfma_f32_16x16x32_bf16 v[244:247], a[236:239], v[228:231], v[244:247]
    v_max3_f32 v147, v240, v241, v242
    v_max_f32 v147, v147, v243
    v_mfma_f32_16x16x32_bf16 v[248:251], a[224:227], v[136:139], 0
    v_mov_b32 v146, v147
    v_cvt_pk_bf16_f32 v207, v222, v223
    v_mfma_f32_16x16x32_bf16 v[248:251], a[228:231], v[168:171], v[248:251]
    v_permlane32_swap_b32 v147, v146
    v_max_f32 v147, v147, v146
    v_mfma_f32_16x16x32_bf16 v[248:251], a[232:235], v[200:203], v[248:251]
    buffer_load_dwordx4 v1, s[36:39], s77 offen offset:3072 sc1 lds
    v_mfma_f32_16x16x32_bf16 v[248:251], a[236:239], v[232:235], v[248:251]
    v_max3_f32 v151, v244, v245, v246
    v_max_f32 v151, v151, v247
    v_mfma_f32_16x16x32_bf16 v[252:255], a[224:227], v[140:143], 0
    s_add_u32 s100, s77, 4096
    v_mov_b32 v150, v151
    v_mov_b32 v146, v147
    v_mfma_f32_16x16x32_bf16 v[252:255], a[228:231], v[172:175], v[252:255]
    s_add_u32 m0, m0, 4096
    v_max3_f32 v155, v248, v249, v250
    v_max_f32 v155, v155, v251
    v_mfma_f32_16x16x32_bf16 v[252:255], a[232:235], v[204:207], v[252:255]
    buffer_load_dwordx4 v1, s[36:39], s100 offen sc1 lds
    v_mfma_f32_16x16x32_bf16 v[252:255], a[236:239], v[236:239], v[252:255]
    v_mov_b32 v154, v155
    v_permlane32_swap_b32 v151, v150
    v_mfma_f32_16x16x32_bf16 a[96:99], v[48:51], v[96:99], a[96:99]
    v_permlane32_swap_b32 v155, v154
    v_max_f32 v151, v151, v150
    v_mfma_f32_16x16x32_bf16 a[96:99], v[52:55], v[100:103], a[96:99]
    v_max_f32 v155, v155, v154
    v_mov_b32 v150, v151
    v_mfma_f32_16x16x32_bf16 a[100:103], v[48:51], v[104:107], a[100:103]
    buffer_load_dwordx4 v1, s[36:39], s100 offen offset:1024 sc1 lds
    v_mfma_f32_16x16x32_bf16 a[100:103], v[52:55], v[108:111], a[100:103]
    v_max3_f32 v159, v252, v253, v254
    v_max_f32 v159, v159, v255
    v_mfma_f32_16x16x32_bf16 a[104:107], v[48:51], v[112:115], a[104:107]
    v_mov_b32 v158, v159
    v_mov_b32 v154, v155
    v_mfma_f32_16x16x32_bf16 a[104:107], v[52:55], v[116:119], a[104:107]
    v_permlane32_swap_b32 v159, v158
    v_max_f32 v159, v159, v158
    v_mfma_f32_16x16x32_bf16 a[108:111], v[48:51], v[120:123], a[108:111]
    buffer_load_dwordx4 v1, s[36:39], s100 offen offset:2048 sc1 lds
    v_mfma_f32_16x16x32_bf16 a[108:111], v[52:55], v[124:127], a[108:111]
    s_waitcnt lgkmcnt(0)
    ds_read_b64_tr_b16 v[48:49], v27 offset:0
    ds_read_b64_tr_b16 v[50:51], v27 offset:512
    v_mfma_f32_16x16x32_bf16 a[112:115], v[56:59], v[96:99], a[112:115]
    ds_read_b64_tr_b16 v[52:53], v27 offset:4096
    ds_read_b64_tr_b16 v[54:55], v27 offset:4608
    v_mfma_f32_16x16x32_bf16 a[112:115], v[60:63], v[100:103], a[112:115]
    v_mov_b32 v158, v159
    v_permlane16_swap_b32 v147, v146
    v_mfma_f32_16x16x32_bf16 a[116:119], v[56:59], v[104:107], a[116:119]
    buffer_load_dwordx4 v1, s[36:39], s100 offen offset:3072 sc1 lds
    v_mfma_f32_16x16x32_bf16 a[116:119], v[60:63], v[108:111], a[116:119]
    v_permlane16_swap_b32 v151, v150
    v_permlane16_swap_b32 v155, v154
    v_mfma_f32_16x16x32_bf16 a[120:123], v[56:59], v[112:115], a[120:123]
    s_add_u32 s76, s76, 32768
    v_permlane16_swap_b32 v159, v158
    v_max_f32 v147, v147, v146
    v_mfma_f32_16x16x32_bf16 a[120:123], v[60:63], v[116:119], a[120:123]
    s_add_u32 s77, s77, 32768
    v_max_f32 v151, v151, v150
    v_max_f32 v155, v155, v154
    v_mfma_f32_16x16x32_bf16 a[124:127], v[56:59], v[120:123], a[124:127]
    s_add_u32 m0, s76, s75
    ds_read_b64_tr_b16 v[56:57], v28 offset:0
    ds_read_b64_tr_b16 v[58:59], v28 offset:512
    v_mfma_f32_16x16x32_bf16 a[124:127], v[60:63], v[124:127], a[124:127]
    buffer_load_dwordx4 v1, s[36:39], s77 offen sc1 lds
    v_mfma_f32_16x16x32_bf16 a[64:67], v[40:43], v[64:67], a[64:67]
    ds_read_b64_tr_b16 v[60:61], v28 offset:4096
    ds_read_b64_tr_b16 v[62:63], v28 offset:4608
    v_mfma_f32_16x16x32_bf16 a[64:67], v[44:47], v[68:71], a[64:67]
    v_max_f32 v159, v159, v158
    v_sub_f32 v144, 0, v147
    v_mfma_f32_16x16x32_bf16 a[68:71], v[40:43], v[72:75], a[68:71]
    buffer_load_dwordx4 v1, s[36:39], s77 offen offset:1024 sc1 lds
    v_mfma_f32_16x16x32_bf16 a[68:71], v[44:47], v[76:79], a[68:71]
    v_sub_f32 v148, 0, v151
    v_sub_f32 v152, 0, v155
    v_mfma_f32_16x16x32_bf16 a[72:75], v[40:43], v[80:83], a[72:75]
    v_sub_f32 v156, 0, v159
    v_sub_f32 v145, 0, v147
    v_mfma_f32_16x16x32_bf16 a[72:75], v[44:47], v[84:87], a[72:75]
    v_sub_f32 v146, 0, v147
    v_sub_f32 v147, 0, v147
    v_mfma_f32_16x16x32_bf16 a[76:79], v[40:43], v[88:91], a[76:79]
    buffer_load_dwordx4 v1, s[36:39], s77 offen offset:2048 sc1 lds
    v_mfma_f32_16x16x32_bf16 a[76:79], v[44:47], v[92:95], a[76:79]
    v_sub_f32 v149, 0, v151
    v_sub_f32 v150, 0, v151
    v_mfma_f32_16x16x32_bf16 a[128:131], v[40:43], a[136:139], a[128:131]
    ds_read_b64_tr_b16 v[40:41], v29 offset:0
    ds_read_b64_tr_b16 v[42:43], v29 offset:512
    v_mfma_f32_16x16x32_bf16 a[128:131], v[44:47], a[140:143], a[128:131]
    s_waitcnt lgkmcnt(2)
    ds_read_b64_tr_b16 v[44:45], v29 offset:4096
    ds_read_b64_tr_b16 v[46:47], v29 offset:4608
    v_mfma_f32_16x16x32_bf16 a[80:83], v[48:51], v[64:67], a[80:83]
    buffer_load_dwordx4 v1, s[36:39], s77 offen offset:3072 sc1 lds
    v_mfma_f32_16x16x32_bf16 a[80:83], v[52:55], v[68:71], a[80:83]
    v_sub_f32 v151, 0, v151
    v_sub_f32 v153, 0, v155
    v_mfma_f32_16x16x32_bf16 a[84:87], v[48:51], v[72:75], a[84:87]
    s_add_u32 s100, s77, 4096
    v_sub_f32 v154, 0, v155
    v_sub_f32 v155, 0, v155
    v_mfma_f32_16x16x32_bf16 a[84:87], v[52:55], v[76:79], a[84:87]
    s_add_u32 m0, m0, 4096
    v_sub_f32 v157, 0, v159
    v_sub_f32 v158, 0, v159
    v_mfma_f32_16x16x32_bf16 a[88:91], v[48:51], v[80:83], a[88:91]
    buffer_load_dwordx4 v1, s[36:39], s100 offen sc1 lds
    v_mfma_f32_16x16x32_bf16 a[88:91], v[52:55], v[84:87], a[88:91]
    v_sub_f32 v159, 0, v159
    v_cmp_eq_u32 vcc, 0, v38
    v_mfma_f32_16x16x32_bf16 a[92:95], v[48:51], v[88:91], a[92:95]
    v_mov_b32 v38, 0x3f803f80
    v_and_b32 v29, 0x380, v1
    v_mfma_f32_16x16x32_bf16 a[92:95], v[52:55], v[92:95], a[92:95]
    v_add_f32 v240, v240, v144
    v_add_f32 v241, v241, v144
    v_mfma_f32_16x16x32_bf16 a[132:135], v[48:51], a[136:139], a[132:135]
    buffer_load_dwordx4 v1, s[36:39], s100 offen offset:1024 sc1 lds
    v_mfma_f32_16x16x32_bf16 a[132:135], v[52:55], a[140:143], a[132:135]
    v_add_f32 v242, v242, v144
    v_add_f32 v243, v243, v144
    v_mfma_f32_16x16x32_bf16 a[96:99], v[56:59], v[64:67], a[96:99]
    v_add_f32 v244, v244, v148
    v_add_f32 v245, v245, v148
    v_mfma_f32_16x16x32_bf16 a[96:99], v[60:63], v[68:71], a[96:99]
    v_add_f32 v246, v246, v148
    v_add_f32 v247, v247, v148
    v_mfma_f32_16x16x32_bf16 a[100:103], v[56:59], v[72:75], a[100:103]
    buffer_load_dwordx4 v1, s[36:39], s100 offen offset:2048 sc1 lds
    v_mfma_f32_16x16x32_bf16 a[100:103], v[60:63], v[76:79], a[100:103]
    v_add_f32 v248, v248, v152
    v_add_f32 v249, v249, v152
    v_mfma_f32_16x16x32_bf16 a[104:107], v[56:59], v[80:83], a[104:107]
    v_add_f32 v250, v250, v152
    v_add_f32 v251, v251, v152
    v_mfma_f32_16x16x32_bf16 a[104:107], v[60:63], v[84:87], a[104:107]
    s_waitcnt vmcnt(15) lgkmcnt(0)
    s_barrier
    ds_read_b128 a[240:243], v2 offset:4096
    v_mfma_f32_16x16x32_bf16 a[108:111], v[56:59], v[88:91], a[108:111]
    ds_read_b128 a[244:247], v2 offset:5120
    ds_read_b128 a[248:251], v2 offset:6144
    v_mfma_f32_16x16x32_bf16 a[108:111], v[60:63], v[92:95], a[108:111]
    buffer_load_dwordx4 v1, s[36:39], s100 offen offset:3072 sc1 lds
    v_mfma_f32_16x16x32_bf16 a[112:115], v[40:43], v[64:67], a[112:115]
    s_add_u32 s77, s77, 32768
    ds_read_b128 a[252:255], v2 offset:7168
    v_add_f32 v252, v252, v156
    v_mfma_f32_16x16x32_bf16 a[112:115], v[44:47], v[68:71], a[112:115]
    s_add_u32 s76, s76, 32768
    v_add_f32 v253, v253, v156
    v_add_f32 v254, v254, v156
    v_mfma_f32_16x16x32_bf16 a[116:119], v[40:43], v[72:75], a[116:119]
    v_add_f32 v255, v255, v156
    v_cndmask_b32 v38, 0, v38, vcc
    v_mfma_f32_16x16x32_bf16 a[116:119], v[44:47], v[76:79], a[116:119]
    v_lshl_add_u32 v29, v29, 4, v39
    v_bfe_u32 v39, v1, 2, 4
    v_mfma_f32_16x16x32_bf16 a[120:123], v[40:43], v[80:83], a[120:123]
    v_exp_f32 v240, v240
    v_mfma_f32_16x16x32_bf16 a[120:123], v[44:47], v[84:87], a[120:123]
    v_exp_f32 v241, v241
    v_mfma_f32_16x16x32_bf16 a[124:127], v[40:43], v[88:91], a[124:127]
    v_exp_f32 v242, v242
    v_mfma_f32_16x16x32_bf16 a[124:127], v[44:47], v[92:95], a[124:127]
    v_exp_f32 v243, v243
    v_exp_f32 v244, v244
    v_exp_f32 v245, v245
    v_exp_f32 v246, v246
    v_exp_f32 v247, v247
    v_exp_f32 v248, v248
    v_exp_f32 v249, v249
    v_exp_f32 v250, v250
    v_exp_f32 v251, v251
    v_exp_f32 v252, v252
    v_exp_f32 v253, v253
    v_exp_f32 v254, v254
    v_exp_f32 v255, v255
    v_accvgpr_write_b32 a136, v38
    v_accvgpr_write_b32 a137, v38
    v_accvgpr_write_b32 a138, v38
    v_accvgpr_write_b32 a139, v38
    v_lshl_add_u32 v29, v29, 1, v39
K1_ATT:
    v_cvt_pk_bf16_f32 v32, v240, v241
    v_cvt_pk_bf16_f32 v33, v242, v243
    v_add_f32 v213, s21, v144
    v_fma_f32 v180, v208, s17, v213
    v_fma_f32 v181, v209, s17, v213
    v_fma_f32 v182, v210, s17, v213
    v_fma_f32 v183, v211, s17, v213
    s_nop 1
    s_waitcnt lgkmcnt(0)
    v_mfma_f32_16x16x32_bf16 v[240:243], a[240:243], v[128:131], v[180:183]
    s_add_u32 m0, s76, s75
    v_cvt_pk_bf16_f32 v40, v244, v245
    v_cvt_pk_bf16_f32 v41, v246, v247
    v_mfma_f32_16x16x32_bf16 v[240:243], a[244:247], v[160:163], v[240:243]
    s_mov_b32 s76, s60
    buffer_load_dwordx4 v1, s[36:39], s77 offen sc1 lds
    v_mfma_f32_16x16x32_bf16 v[240:243], a[248:251], v[192:195], v[240:243]
    s_mov_b32 s60, s82
    v_cvt_pk_bf16_f32 v48, v248, v249
    v_cvt_pk_bf16_f32 v49, v250, v251
    v_mfma_f32_16x16x32_bf16 v[240:243], a[252:255], v[224:227], v[240:243]
    s_add_u32 s82, s82, 32768
    ds_read_b128 a[224:227], v2 offset:8192
    ds_read_b128 a[228:231], v2 offset:9216
    v_mfma_f32_16x16x32_bf16 v[244:247], a[240:243], v[132:135], v[148:151]
    s_sub_u32 s7, 15, s6
    buffer_load_dwordx4 v1, s[36:39], s77 offen offset:1024 sc1 lds
    v_mfma_f32_16x16x32_bf16 v[244:247], a[244:247], v[164:167], v[244:247]
    s_lshl3_add_u32 s80, s6, s4
    ds_read_b128 a[232:235], v2 offset:10240
    v_cvt_pk_bf16_f32 v56, v252, v253
    v_mfma_f32_16x16x32_bf16 v[244:247], a[248:251], v[196:199], v[244:247]
    s_lshl3_add_u32 s81, s7, s4
    v_cvt_pk_bf16_f32 v57, v254, v255
    ds_read_b128 a[236:239], v2 offset:11264
    v_mfma_f32_16x16x32_bf16 v[244:247], a[252:255], v[228:231], v[244:247]
    s_mul_i32 s80, s80, 155648
    buffer_load_dwordx4 v1, s[36:39], s77 offen offset:2048 sc1 lds
    v_mfma_f32_16x16x32_bf16 v[248:251], a[240:243], v[136:139], v[152:155]
    s_mul_i32 s81, s81, 155648
    v_add_f32 v214, s22, v144
    v_fma_f32 v184, v208, s18, v214
    v_mfma_f32_16x16x32_bf16 v[248:251], a[244:247], v[168:171], v[248:251]
    s_lshl_b32 s7, s5, 12
    v_exp_f32 v240, v240
    v_mfma_f32_16x16x32_bf16 v[248:251], a[248:251], v[200:203], v[248:251]
    s_add_u32 s80, s80, s7
    buffer_load_dwordx4 v1, s[36:39], s77 offen offset:3072 sc1 lds
    v_mfma_f32_16x16x32_bf16 v[248:251], a[252:255], v[232:235], v[248:251]
    s_add_u32 s81, s81, s7
    v_exp_f32 v241, v241
    v_mfma_f32_16x16x32_bf16 v[252:255], a[240:243], v[140:143], v[156:159]
    s_lshr_b32 s7, s5, 3
    v_exp_f32 v242, v242
    v_mfma_f32_16x16x32_bf16 v[252:255], a[244:247], v[172:175], v[252:255]
    s_add_u32 s100, s77, 4096
    v_exp_f32 v243, v243
    v_mfma_f32_16x16x32_bf16 v[252:255], a[248:251], v[204:207], v[252:255]
    s_add_u32 m0, m0, 4096
    v_fma_f32 v185, v209, s18, v214
    v_fma_f32 v186, v210, s18, v214
    v_mfma_f32_16x16x32_bf16 v[252:255], a[252:255], v[236:239], v[252:255]
    s_lshl2_add_u32 s7, s7, s4
    v_fma_f32 v187, v211, s18, v214
    v_cvt_pk_bf16_f32 v34, v240, v241
    v_cvt_pk_bf16_f32 v35, v242, v243
    s_waitcnt lgkmcnt(0)
    v_mfma_f32_16x16x32_bf16 v[240:243], a[224:227], v[128:131], v[184:187]
    s_lshl_b32 s7, s7, 8
    buffer_load_dwordx4 v1, s[36:39], s100 offen sc1 lds
    v_mfma_f32_16x16x32_bf16 v[240:243], a[228:231], v[160:163], v[240:243]
    s_mov_b32 s42, 19922944
    v_exp_f32 v244, v244
    v_mfma_f32_16x16x32_bf16 v[240:243], a[232:235], v[192:195], v[240:243]
    s_mov_b32 s43, 0x20000
    v_exp_f32 v245, v245
    v_mfma_f32_16x16x32_bf16 v[240:243], a[236:239], v[224:227], v[240:243]
    s_add_u32 s92, s7, 163840
    v_exp_f32 v246, v246
    v_exp_f32 v247, v247
    v_cvt_pk_bf16_f32 v42, v244, v245
    v_cvt_pk_bf16_f32 v43, v246, v247
    v_mfma_f32_16x16x32_bf16 v[244:247], a[224:227], v[132:135], v[148:151]
    s_mov_b64 s[24:25], s[0:1]
    buffer_load_dwordx4 v1, s[36:39], s100 offen offset:1024 sc1 lds
    v_mfma_f32_16x16x32_bf16 v[244:247], a[228:231], v[164:167], v[244:247]
    s_mov_b32 s78, s6
    v_exp_f32 v248, v248
    v_mfma_f32_16x16x32_bf16 v[244:247], a[232:235], v[196:199], v[244:247]
    s_mov_b32 s26, 2359296
    v_exp_f32 v249, v249
    v_mfma_f32_16x16x32_bf16 v[244:247], a[236:239], v[228:231], v[244:247]
    s_mov_b32 s27, 0x20000
    v_exp_f32 v250, v250
    v_exp_f32 v251, v251
    v_cvt_pk_bf16_f32 v50, v248, v249
    v_cvt_pk_bf16_f32 v51, v250, v251
    v_mfma_f32_16x16x32_bf16 v[248:251], a[224:227], v[136:139], v[152:155]
    buffer_load_dwordx4 v1, s[36:39], s100 offen offset:2048 sc1 lds
    v_mfma_f32_16x16x32_bf16 v[248:251], a[228:231], v[168:171], v[248:251]
    ds_read_b128 a[240:243], v2 offset:12288
    ds_read_b128 a[244:247], v2 offset:13312
    v_mfma_f32_16x16x32_bf16 v[248:251], a[232:235], v[200:203], v[248:251]
    s_add_u32 s77, s77, 32768
    buffer_load_dwordx4 v1, s[36:39], s100 offen offset:3072 sc1 lds
    v_mfma_f32_16x16x32_bf16 v[248:251], a[236:239], v[232:235], v[248:251]
    v_exp_f32 v252, v252
    v_exp_f32 v253, v253
    v_exp_f32 v254, v254
    v_exp_f32 v255, v255
    v_cvt_pk_bf16_f32 v58, v252, v253
    v_cvt_pk_bf16_f32 v59, v254, v255
    v_mfma_f32_16x16x32_bf16 v[252:255], a[224:227], v[140:143], v[156:159]
    ds_read_b128 a[248:251], v2 offset:14336
    ds_read_b128 a[252:255], v2 offset:15360
    v_mfma_f32_16x16x32_bf16 v[252:255], a[228:231], v[172:175], v[252:255]
    v_add_f32 v215, s23, v144
    v_fma_f32 v188, v208, s19, v215
    v_mfma_f32_16x16x32_bf16 v[252:255], a[232:235], v[204:207], v[252:255]
    v_exp_f32 v240, v240
    v_mfma_f32_16x16x32_bf16 v[252:255], a[236:239], v[236:239], v[252:255]
    s_waitcnt lgkmcnt(2)
    v_exp_f32 v241, v241
    v_exp_f32 v242, v242
    v_exp_f32 v243, v243
    v_fma_f32 v189, v209, s19, v215
    v_fma_f32 v190, v210, s19, v215
    v_fma_f32 v191, v211, s19, v215
    v_cvt_pk_bf16_f32 v36, v240, v241
    v_cvt_pk_bf16_f32 v37, v242, v243
    v_mfma_f32_16x16x32_bf16 v[240:243], a[240:243], v[128:131], v[188:191]
    v_exp_f32 v244, v244
    v_mfma_f32_16x16x32_bf16 v[240:243], a[244:247], v[160:163], v[240:243]
    s_cmp_eq_u32 s82, 163840
    s_cselect_b32 s82, 0, s82
    v_add_u32 v2, s82, v1
    s_waitcnt lgkmcnt(0)
    v_mfma_f32_16x16x32_bf16 v[240:243], a[248:251], v[192:195], v[240:243]
    v_exp_f32 v245, v245
    v_mfma_f32_16x16x32_bf16 v[240:243], a[252:255], v[224:227], v[240:243]
    s_waitcnt vmcnt(8) lgkmcnt(0)
    s_barrier
    v_cvt_pk_bf16_f32 v44, v244, v245
    v_exp_f32 v246, v246
    v_exp_f32 v247, v247
    s_nop 0
    v_cvt_pk_bf16_f32 v45, v246, v247
    v_mfma_f32_16x16x32_bf16 v[244:247], a[240:243], v[132:135], v[148:151]
    ds_read_b128 a[224:227], v2 offset:0
    ds_read_b128 a[228:231], v2 offset:1024
    v_mfma_f32_16x16x32_bf16 v[244:247], a[244:247], v[164:167], v[244:247]
    v_exp_f32 v248, v248
    v_mfma_f32_16x16x32_bf16 v[244:247], a[248:251], v[196:199], v[244:247]
    v_exp_f32 v249, v249
    v_mfma_f32_16x16x32_bf16 v[244:247], a[252:255], v[228:231], v[244:247]
    v_exp_f32 v250, v250
    v_exp_f32 v251, v251
    v_cvt_pk_bf16_f32 v52, v248, v249
    v_cvt_pk_bf16_f32 v53, v250, v251
    v_mfma_f32_16x16x32_bf16 v[248:251], a[240:243], v[136:139], v[152:155]
    ds_read_b128 a[232:235], v2 offset:2048
    ds_read_b128 a[236:239], v2 offset:3072
    v_mfma_f32_16x16x32_bf16 v[248:251], a[244:247], v[168:171], v[248:251]
    ds_read_b128 v[96:99], v2 offset:16384
    v_add_f32 v212, s20, v144
    v_mfma_f32_16x16x32_bf16 v[248:251], a[248:251], v[200:203], v[248:251]
    v_exp_f32 v252, v252
    v_mfma_f32_16x16x32_bf16 v[248:251], a[252:255], v[232:235], v[248:251]
    v_exp_f32 v253, v253
    v_exp_f32 v254, v254
    v_exp_f32 v255, v255
    v_cvt_pk_bf16_f32 v60, v252, v253
    v_cvt_pk_bf16_f32 v61, v254, v255
    v_mfma_f32_16x16x32_bf16 v[252:255], a[240:243], v[140:143], v[156:159]
    ds_read_b128 v[100:103], v2 offset:17408
    v_fma_f32 v176, v208, s16, v212
    v_mfma_f32_16x16x32_bf16 v[252:255], a[244:247], v[172:175], v[252:255]
    v_exp_f32 v240, v240
    v_mfma_f32_16x16x32_bf16 v[252:255], a[248:251], v[204:207], v[252:255]
    s_sub_u32 s40, s56, 20971520
    s_subb_u32 s41, s57, 0
    v_fma_f32 v177, v209, s16, v212
    v_mfma_f32_16x16x32_bf16 v[252:255], a[252:255], v[236:239], v[252:255]
    v_exp_f32 v241, v241
    v_exp_f32 v242, v242
    v_exp_f32 v243, v243
    v_exp_f32 v244, v244
    v_exp_f32 v245, v245
    v_exp_f32 v246, v246
    v_exp_f32 v247, v247
    v_exp_f32 v248, v248
    v_exp_f32 v249, v249
    v_exp_f32 v250, v250
    v_exp_f32 v251, v251
    v_exp_f32 v252, v252
    v_exp_f32 v253, v253
    v_fma_f32 v178, v210, s16, v212
    v_fma_f32 v179, v211, s16, v212
    v_cvt_pk_bf16_f32 v38, v240, v241
    v_cvt_pk_bf16_f32 v39, v242, v243
    v_cvt_pk_bf16_f32 v46, v244, v245
    v_cvt_pk_bf16_f32 v47, v246, v247
    v_cvt_pk_bf16_f32 v54, v248, v249
    v_cvt_pk_bf16_f32 v55, v250, v251
    v_cvt_pk_bf16_f32 v62, v252, v253
    s_cmp_eq_u32 s78, 0
    s_cbranch_scc1 K1_LB_END
.p2align 3
K1_LB:
    s_waitcnt lgkmcnt(0)
    v_mfma_f32_16x16x32_bf16 v[240:243], a[224:227], v[128:131], v[176:179]
    s_add_u32 m0, s76, s75
    v_exp_f32 v254, v254
    v_mfma_f32_16x16x32_bf16 v[240:243], a[228:231], v[160:163], v[240:243]
    s_mov_b32 s76, s60
    buffer_load_dwordx4 v1, s[36:39], s77 offen sc1 lds
    v_mfma_f32_16x16x32_bf16 v[240:243], a[232:235], v[192:195], v[240:243]
    s_mov_b32 s60, s82
    v_exp_f32 v255, v255
    v_mfma_f32_16x16x32_bf16 v[240:243], a[236:239], v[224:227], v[240:243]
    s_add_u32 s82, s82, 32768
    ds_read_b128 v[104:107], v2 offset:18432
    v_cvt_pk_bf16_f32 v63, v254, v255
    v_mfma_f32_16x16x32_bf16 a[0:3], v[96:99], v[32:35], a[0:3]
    ds_read_b128 v[108:111], v2 offset:19456
    ds_read_b128 a[240:243], v2 offset:4096
    v_mfma_f32_16x16x32_bf16 a[0:3], v[100:103], v[36:39], a[0:3]
    ds_read_b128 a[244:247], v2 offset:5120
    v_mfma_f32_16x16x32_bf16 a[4:7], v[96:99], v[40:43], a[4:7]
    v_exp_f32 v240, v240
    v_mfma_f32_16x16x32_bf16 a[4:7], v[100:103], v[44:47], a[4:7]
    ds_read_b128 a[248:251], v2 offset:6144
    ds_read_b128 a[252:255], v2 offset:7168
    v_mfma_f32_16x16x32_bf16 v[244:247], a[224:227], v[132:135], v[148:151]
    v_exp_f32 v241, v241
    v_mfma_f32_16x16x32_bf16 v[244:247], a[228:231], v[164:167], v[244:247]
    ds_read_b128 v[112:115], v2 offset:20480
    ds_read_b128 v[116:119], v2 offset:21504
    v_mfma_f32_16x16x32_bf16 v[244:247], a[232:235], v[196:199], v[244:247]
    v_exp_f32 v242, v242
    v_mfma_f32_16x16x32_bf16 v[244:247], a[236:239], v[228:231], v[244:247]
    v_exp_f32 v243, v243
    v_mfma_f32_16x16x32_bf16 a[8:11], v[96:99], v[48:51], a[8:11]
    v_cvt_pk_bf16_f32 v64, v240, v241
    v_cvt_pk_bf16_f32 v65, v242, v243
    v_mfma_f32_16x16x32_bf16 a[8:11], v[100:103], v[52:55], a[8:11]
    ds_read_b128 v[120:123], v2 offset:22528
    ds_read_b128 v[124:127], v2 offset:23552
    v_mfma_f32_16x16x32_bf16 a[12:15], v[96:99], v[56:59], a[12:15]
    v_exp_f32 v244, v244
    v_mfma_f32_16x16x32_bf16 a[12:15], v[100:103], v[60:63], a[12:15]
    buffer_load_dwordx4 v1, s[36:39], s77 offen offset:1024 sc1 lds
    v_mfma_f32_16x16x32_bf16 v[248:251], a[224:227], v[136:139], v[152:155]
    v_exp_f32 v245, v245
    v_mfma_f32_16x16x32_bf16 v[248:251], a[228:231], v[168:171], v[248:251]
    v_exp_f32 v246, v246
    v_mfma_f32_16x16x32_bf16 v[248:251], a[232:235], v[200:203], v[248:251]
    v_exp_f32 v247, v247
    v_mfma_f32_16x16x32_bf16 v[248:251], a[236:239], v[232:235], v[248:251]
    s_waitcnt lgkmcnt(0)
    v_cvt_pk_bf16_f32 v72, v244, v245
    v_cvt_pk_bf16_f32 v73, v246, v247
    v_mfma_f32_16x16x32_bf16 a[16:19], v[104:107], v[32:35], a[16:19]
    ds_read_b128 v[96:99], v2 offset:24576
    ds_read_b128 v[100:103], v2 offset:25600
    v_mfma_f32_16x16x32_bf16 a[16:19], v[108:111], v[36:39], a[16:19]
    v_mfma_f32_16x16x32_bf16 a[20:23], v[104:107], v[40:43], a[20:23]
    v_mfma_f32_16x16x32_bf16 a[20:23], v[108:111], v[44:47], a[20:23]
    v_exp_f32 v248, v248
    v_mfma_f32_16x16x32_bf16 v[252:255], a[224:227], v[140:143], v[156:159]
    v_exp_f32 v249, v249
    v_mfma_f32_16x16x32_bf16 v[252:255], a[228:231], v[172:175], v[252:255]
    v_exp_f32 v250, v250
    v_mfma_f32_16x16x32_bf16 v[252:255], a[232:235], v[204:207], v[252:255]
    v_exp_f32 v251, v251
    v_mfma_f32_16x16x32_bf16 v[252:255], a[236:239], v[236:239], v[252:255]
    v_cvt_pk_bf16_f32 v80, v248, v249
    v_cvt_pk_bf16_f32 v81, v250, v251
    v_mfma_f32_16x16x32_bf16 a[24:27], v[104:107], v[48:51], a[24:27]
    ds_read_b128 a[224:227], v2 offset:8192
    ds_read_b128 a[228:231], v2 offset:9216
    v_mfma_f32_16x16x32_bf16 a[24:27], v[108:111], v[52:55], a[24:27]
    buffer_load_dwordx4 v1, s[36:39], s77 offen offset:2048 sc1 lds
    v_mfma_f32_16x16x32_bf16 a[28:31], v[104:107], v[56:59], a[28:31]
    v_exp_f32 v252, v252
    v_mfma_f32_16x16x32_bf16 a[28:31], v[108:111], v[60:63], a[28:31]
    v_exp_f32 v253, v253
    v_mfma_f32_16x16x32_bf16 v[240:243], a[240:243], v[128:131], v[180:183]
    v_exp_f32 v254, v254
    v_mfma_f32_16x16x32_bf16 v[240:243], a[244:247], v[160:163], v[240:243]
    v_exp_f32 v255, v255
    v_mfma_f32_16x16x32_bf16 v[240:243], a[248:251], v[192:195], v[240:243]
    v_cvt_pk_bf16_f32 v88, v252, v253
    v_cvt_pk_bf16_f32 v89, v254, v255
    v_mfma_f32_16x16x32_bf16 v[240:243], a[252:255], v[224:227], v[240:243]
    ds_read_b128 a[232:235], v2 offset:10240
    ds_read_b128 a[236:239], v2 offset:11264
    v_mfma_f32_16x16x32_bf16 a[32:35], v[112:115], v[32:35], a[32:35]
    ds_read_b128 v[104:107], v2 offset:26624
    v_mfma_f32_16x16x32_bf16 a[32:35], v[116:119], v[36:39], a[32:35]
    ds_read_b128 v[108:111], v2 offset:27648
    v_mfma_f32_16x16x32_bf16 a[36:39], v[112:115], v[40:43], a[36:39]
    v_mfma_f32_16x16x32_bf16 a[36:39], v[116:119], v[44:47], a[36:39]
    v_exp_f32 v240, v240
    v_mfma_f32_16x16x32_bf16 v[244:247], a[240:243], v[132:135], v[148:151]
    v_exp_f32 v241, v241
    v_mfma_f32_16x16x32_bf16 v[244:247], a[244:247], v[164:167], v[244:247]
    v_exp_f32 v242, v242
    v_mfma_f32_16x16x32_bf16 v[244:247], a[248:251], v[196:199], v[244:247]
    v_exp_f32 v243, v243
    v_mfma_f32_16x16x32_bf16 v[244:247], a[252:255], v[228:231], v[244:247]
    buffer_load_dwordx4 v1, s[36:39], s77 offen offset:3072 sc1 lds
    v_mfma_f32_16x16x32_bf16 a[40:43], v[112:115], v[48:51], a[40:43]
    v_cvt_pk_bf16_f32 v66, v240, v241
    v_cvt_pk_bf16_f32 v67, v242, v243
    v_mfma_f32_16x16x32_bf16 a[40:43], v[116:119], v[52:55], a[40:43]
    v_mfma_f32_16x16x32_bf16 a[44:47], v[112:115], v[56:59], a[44:47]
    ds_read_b128 v[112:115], v2 offset:28672
    v_mfma_f32_16x16x32_bf16 a[44:47], v[116:119], v[60:63], a[44:47]
    v_exp_f32 v244, v244
    v_mfma_f32_16x16x32_bf16 v[248:251], a[240:243], v[136:139], v[152:155]
    v_exp_f32 v245, v245
    v_mfma_f32_16x16x32_bf16 v[248:251], a[244:247], v[168:171], v[248:251]
    v_exp_f32 v246, v246
    v_mfma_f32_16x16x32_bf16 v[248:251], a[248:251], v[200:203], v[248:251]
    v_exp_f32 v247, v247
    v_mfma_f32_16x16x32_bf16 v[248:251], a[252:255], v[232:235], v[248:251]
    v_cvt_pk_bf16_f32 v74, v244, v245
    v_cvt_pk_bf16_f32 v75, v246, v247
    v_mfma_f32_16x16x32_bf16 a[48:51], v[120:123], v[32:35], a[48:51]
    ds_read_b128 v[116:119], v2 offset:29696
    v_mfma_f32_16x16x32_bf16 a[48:51], v[124:127], v[36:39], a[48:51]
    v_mfma_f32_16x16x32_bf16 a[52:55], v[120:123], v[40:43], a[52:55]
    v_mfma_f32_16x16x32_bf16 a[52:55], v[124:127], v[44:47], a[52:55]
    v_mfma_f32_16x16x32_bf16 v[252:255], a[240:243], v[140:143], v[156:159]
    v_exp_f32 v248, v248
    v_mfma_f32_16x16x32_bf16 v[252:255], a[244:247], v[172:175], v[252:255]
    s_add_u32 s100, s77, 4096
    v_exp_f32 v249, v249
    v_mfma_f32_16x16x32_bf16 v[252:255], a[248:251], v[204:207], v[252:255]
    s_add_u32 m0, m0, 4096
    v_exp_f32 v250, v250
    v_mfma_f32_16x16x32_bf16 v[252:255], a[252:255], v[236:239], v[252:255]
    buffer_load_dwordx4 v1, s[36:39], s100 offen sc1 lds
    v_mfma_f32_16x16x32_bf16 a[56:59], v[120:123], v[48:51], a[56:59]
    v_exp_f32 v251, v251
    v_mfma_f32_16x16x32_bf16 a[56:59], v[124:127], v[52:55], a[56:59]
    v_cvt_pk_bf16_f32 v82, v248, v249
    v_cvt_pk_bf16_f32 v83, v250, v251
    v_mfma_f32_16x16x32_bf16 a[60:63], v[120:123], v[56:59], a[60:63]
    ds_read_b128 a[240:243], v2 offset:12288
    ds_read_b128 a[244:247], v2 offset:13312
    v_mfma_f32_16x16x32_bf16 a[60:63], v[124:127], v[60:63], a[60:63]
    s_waitcnt lgkmcnt(2)
    v_exp_f32 v252, v252
    v_mfma_f32_16x16x32_bf16 v[240:243], a[224:227], v[128:131], v[184:187]
    v_exp_f32 v253, v253
    v_mfma_f32_16x16x32_bf16 v[240:243], a[228:231], v[160:163], v[240:243]
    v_exp_f32 v254, v254
    v_mfma_f32_16x16x32_bf16 v[240:243], a[232:235], v[192:195], v[240:243]
    v_exp_f32 v255, v255
    v_mfma_f32_16x16x32_bf16 v[240:243], a[236:239], v[224:227], v[240:243]
    v_cvt_pk_bf16_f32 v90, v252, v253
    v_cvt_pk_bf16_f32 v91, v254, v255
    v_mfma_f32_16x16x32_bf16 a[144:147], v[96:99], v[32:35], a[144:147]
    ds_read_b128 a[248:251], v2 offset:14336
    ds_read_b128 a[252:255], v2 offset:15360
    v_mfma_f32_16x16x32_bf16 a[144:147], v[100:103], v[36:39], a[144:147]
    ds_read_b128 v[120:123], v2 offset:30720
    v_mfma_f32_16x16x32_bf16 a[148:151], v[96:99], v[40:43], a[148:151]
    v_exp_f32 v240, v240
    v_mfma_f32_16x16x32_bf16 a[148:151], v[100:103], v[44:47], a[148:151]
    v_exp_f32 v241, v241
    v_mfma_f32_16x16x32_bf16 v[244:247], a[224:227], v[132:135], v[148:151]
    buffer_load_dwordx4 v1, s[36:39], s100 offen offset:1024 sc1 lds
    v_mfma_f32_16x16x32_bf16 v[244:247], a[228:231], v[164:167], v[244:247]
    v_exp_f32 v242, v242
    v_mfma_f32_16x16x32_bf16 v[244:247], a[232:235], v[196:199], v[244:247]
    v_exp_f32 v243, v243
    v_mfma_f32_16x16x32_bf16 v[244:247], a[236:239], v[228:231], v[244:247]
    v_cvt_pk_bf16_f32 v68, v240, v241
    v_cvt_pk_bf16_f32 v69, v242, v243
    v_mfma_f32_16x16x32_bf16 a[152:155], v[96:99], v[48:51], a[152:155]
    ds_read_b128 v[124:127], v2 offset:31744
    v_mfma_f32_16x16x32_bf16 a[152:155], v[100:103], v[52:55], a[152:155]
    v_mfma_f32_16x16x32_bf16 a[156:159], v[96:99], v[56:59], a[156:159]
    v_mfma_f32_16x16x32_bf16 a[156:159], v[100:103], v[60:63], a[156:159]
    v_mfma_f32_16x16x32_bf16 v[248:251], a[224:227], v[136:139], v[152:155]
    v_exp_f32 v244, v244
    v_mfma_f32_16x16x32_bf16 v[248:251], a[228:231], v[168:171], v[248:251]
    v_exp_f32 v245, v245
    v_mfma_f32_16x16x32_bf16 v[248:251], a[232:235], v[200:203], v[248:251]
    v_exp_f32 v246, v246
    v_mfma_f32_16x16x32_bf16 v[248:251], a[236:239], v[232:235], v[248:251]
    v_exp_f32 v247, v247
    v_mfma_f32_16x16x32_bf16 a[160:163], v[104:107], v[32:35], a[160:163]
    v_cvt_pk_bf16_f32 v76, v244, v245
    v_cvt_pk_bf16_f32 v77, v246, v247
    v_mfma_f32_16x16x32_bf16 a[160:163], v[108:111], v[36:39], a[160:163]
    v_mfma_f32_16x16x32_bf16 a[164:167], v[104:107], v[40:43], a[164:167]
    buffer_load_dwordx4 v1, s[36:39], s100 offen offset:2048 sc1 lds
    v_mfma_f32_16x16x32_bf16 a[164:167], v[108:111], v[44:47], a[164:167]
    v_exp_f32 v248, v248
    v_mfma_f32_16x16x32_bf16 v[252:255], a[224:227], v[140:143], v[156:159]
    v_exp_f32 v249, v249
    v_mfma_f32_16x16x32_bf16 v[252:255], a[228:231], v[172:175], v[252:255]
    v_exp_f32 v250, v250
    v_mfma_f32_16x16x32_bf16 v[252:255], a[232:235], v[204:207], v[252:255]
    v_exp_f32 v251, v251
    v_mfma_f32_16x16x32_bf16 v[252:255], a[236:239], v[236:239], v[252:255]
    v_cvt_pk_bf16_f32 v84, v248, v249
    v_cvt_pk_bf16_f32 v85, v250, v251
    v_mfma_f32_16x16x32_bf16 a[168:171], v[104:107], v[48:51], a[168:171]
    v_mfma_f32_16x16x32_bf16 a[168:171], v[108:111], v[52:55], a[168:171]
    v_mfma_f32_16x16x32_bf16 a[172:175], v[104:107], v[56:59], a[172:175]
    v_mfma_f32_16x16x32_bf16 a[172:175], v[108:111], v[60:63], a[172:175]
    s_waitcnt lgkmcnt(0)
    v_mfma_f32_16x16x32_bf16 v[240:243], a[240:243], v[128:131], v[188:191]
    v_mfma_f32_16x16x32_bf16 v[240:243], a[244:247], v[160:163], v[240:243]
    v_exp_f32 v252, v252
    v_mfma_f32_16x16x32_bf16 v[240:243], a[248:251], v[192:195], v[240:243]
    v_exp_f32 v253, v253
    v_mfma_f32_16x16x32_bf16 v[240:243], a[252:255], v[224:227], v[240:243]
    v_exp_f32 v254, v254
    v_mfma_f32_16x16x32_bf16 a[176:179], v[112:115], v[32:35], a[176:179]
    buffer_load_dwordx4 v1, s[36:39], s100 offen offset:3072 sc1 lds
    v_mfma_f32_16x16x32_bf16 a[176:179], v[116:119], v[36:39], a[176:179]
    v_exp_f32 v255, v255
    v_mfma_f32_16x16x32_bf16 a[180:183], v[112:115], v[40:43], a[180:183]
    v_cvt_pk_bf16_f32 v92, v252, v253
    v_cvt_pk_bf16_f32 v93, v254, v255
    v_mfma_f32_16x16x32_bf16 a[180:183], v[116:119], v[44:47], a[180:183]
    s_cmp_eq_u32 s82, 163840
    s_cselect_b32 s82, 0, s82
    v_add_u32 v2, s82, v1
    v_mfma_f32_16x16x32_bf16 v[244:247], a[240:243], v[132:135], v[148:151]
    ds_read_b128 a[224:227], v2 offset:0
    ds_read_b128 a[228:231], v2 offset:1024
    v_mfma_f32_16x16x32_bf16 v[244:247], a[244:247], v[164:167], v[244:247]
    v_exp_f32 v240, v240
    v_mfma_f32_16x16x32_bf16 v[244:247], a[248:251], v[196:199], v[244:247]
    ds_read_b128 a[232:235], v2 offset:2048
    ds_read_b128 a[236:239], v2 offset:3072
    v_mfma_f32_16x16x32_bf16 v[244:247], a[252:255], v[228:231], v[244:247]
    v_exp_f32 v241, v241
    v_mfma_f32_16x16x32_bf16 a[184:187], v[112:115], v[48:51], a[184:187]
    ds_read_b128 v[96:99], v2 offset:16384
    ds_read_b128 v[100:103], v2 offset:17408
    v_mfma_f32_16x16x32_bf16 a[184:187], v[116:119], v[52:55], a[184:187]
    v_exp_f32 v242, v242
    v_mfma_f32_16x16x32_bf16 a[188:191], v[112:115], v[56:59], a[188:191]
    v_exp_f32 v243, v243
    v_mfma_f32_16x16x32_bf16 a[188:191], v[116:119], v[60:63], a[188:191]
    v_exp_f32 v244, v244
    v_mfma_f32_16x16x32_bf16 v[248:251], a[240:243], v[136:139], v[152:155]
    v_exp_f32 v245, v245
    v_mfma_f32_16x16x32_bf16 v[248:251], a[244:247], v[168:171], v[248:251]
    v_exp_f32 v246, v246
    v_mfma_f32_16x16x32_bf16 v[248:251], a[248:251], v[200:203], v[248:251]
    s_add_u32 s77, s77, 32768
    v_exp_f32 v247, v247
    v_mfma_f32_16x16x32_bf16 v[248:251], a[252:255], v[232:235], v[248:251]
    v_cvt_pk_bf16_f32 v70, v240, v241
    v_cvt_pk_bf16_f32 v71, v242, v243
    v_mfma_f32_16x16x32_bf16 a[192:195], v[120:123], v[32:35], a[192:195]
    v_cvt_pk_bf16_f32 v78, v244, v245
    v_cvt_pk_bf16_f32 v79, v246, v247
    v_mfma_f32_16x16x32_bf16 a[192:195], v[124:127], v[36:39], a[192:195]
    v_mfma_f32_16x16x32_bf16 a[196:199], v[120:123], v[40:43], a[196:199]
    v_mfma_f32_16x16x32_bf16 a[196:199], v[124:127], v[44:47], a[196:199]
    v_exp_f32 v248, v248
    v_mfma_f32_16x16x32_bf16 v[252:255], a[240:243], v[140:143], v[156:159]
    v_exp_f32 v249, v249
    v_mfma_f32_16x16x32_bf16 v[252:255], a[244:247], v[172:175], v[252:255]
    v_exp_f32 v250, v250
    v_mfma_f32_16x16x32_bf16 v[252:255], a[248:251], v[204:207], v[252:255]
    v_exp_f32 v251, v251
    v_mfma_f32_16x16x32_bf16 v[252:255], a[252:255], v[236:239], v[252:255]
    v_cvt_pk_bf16_f32 v86, v248, v249
    v_cvt_pk_bf16_f32 v87, v250, v251
    v_mfma_f32_16x16x32_bf16 a[200:203], v[120:123], v[48:51], a[200:203]
    v_mfma_f32_16x16x32_bf16 a[200:203], v[124:127], v[52:55], a[200:203]
    v_mfma_f32_16x16x32_bf16 a[204:207], v[120:123], v[56:59], a[204:207]
    v_mfma_f32_16x16x32_bf16 a[204:207], v[124:127], v[60:63], a[204:207]
    v_mfma_f32_16x16x32_bf16 a[208:211], a[136:139], v[32:35], a[208:211]
    v_mfma_f32_16x16x32_bf16 a[208:211], a[136:139], v[36:39], a[208:211]
    v_exp_f32 v252, v252
    v_mfma_f32_16x16x32_bf16 a[212:215], a[136:139], v[40:43], a[212:215]
    v_exp_f32 v253, v253
    v_mfma_f32_16x16x32_bf16 a[212:215], a[136:139], v[44:47], a[212:215]
    v_cvt_pk_bf16_f32 v94, v252, v253
    v_mfma_f32_16x16x32_bf16 a[216:219], a[136:139], v[48:51], a[216:219]
    v_mfma_f32_16x16x32_bf16 a[216:219], a[136:139], v[52:55], a[216:219]
    v_mfma_f32_16x16x32_bf16 a[220:223], a[136:139], v[56:59], a[220:223]
    v_mfma_f32_16x16x32_bf16 a[220:223], a[136:139], v[60:63], a[220:223]
    s_cmp_le_u32 s78, 1
    s_cbranch_scc1 K1_LB_MASK
K1_LB_BACK:
    s_waitcnt lgkmcnt(0)
    v_mfma_f32_16x16x32_bf16 v[240:243], a[224:227], v[128:131], v[176:179]
    s_add_u32 m0, s76, s75
    v_exp_f32 v254, v254
    v_mfma_f32_16x16x32_bf16 v[240:243], a[228:231], v[160:163], v[240:243]
    s_mov_b32 s76, s60
    buffer_load_dwordx4 v1, s[36:39], s77 offen sc1 lds
    v_mfma_f32_16x16x32_bf16 v[240:243], a[232:235], v[192:195], v[240:243]
    s_mov_b32 s60, s82
    v_exp_f32 v255, v255
    v_mfma_f32_16x16x32_bf16 v[240:243], a[236:239], v[224:227], v[240:243]
    s_add_u32 s82, s82, 32768
    ds_read_b128 v[104:107], v2 offset:18432
    v_cvt_pk_bf16_f32 v95, v254, v255
    v_mfma_f32_16x16x32_bf16 a[0:3], v[96:99], v[64:67], a[0:3]
    ds_read_b128 v[108:111], v2 offset:19456
    ds_read_b128 a[240:243], v2 offset:4096
    v_mfma_f32_16x16x32_bf16 a[0:3], v[100:103], v[68:71], a[0:3]
    ds_read_b128 a[244:247], v2 offset:5120
    v_mfma_f32_16x16x32_bf16 a[4:7], v[96:99], v[72:75], a[4:7]
    v_exp_f32 v240, v240
    v_mfma_f32_16x16x32_bf16 a[4:7], v[100:103], v[76:79], a[4:7]
    ds_read_b128 a[248:251], v2 offset:6144
    ds_read_b128 a[252:255], v2 offset:7168
    v_mfma_f32_16x16x32_bf16 v[244:247], a[224:227], v[132:135], v[148:151]
    v_exp_f32 v241, v241
    v_mfma_f32_16x16x32_bf16 v[244:247], a[228:231], v[164:167], v[244:247]
    ds_read_b128 v[112:115], v2 offset:20480
    ds_read_b128 v[116:119], v2 offset:21504
    v_mfma_f32_16x16x32_bf16 v[244:247], a[232:235], v[196:199], v[244:247]
    v_exp_f32 v242, v242
    v_mfma_f32_16x16x32_bf16 v[244:247], a[236:239], v[228:231], v[244:247]
    v_exp_f32 v243, v243
    v_mfma_f32_16x16x32_bf16 a[8:11], v[96:99], v[80:83], a[8:11]
    v_cvt_pk_bf16_f32 v32, v240, v241
    v_cvt_pk_bf16_f32 v33, v242, v243
    v_mfma_f32_16x16x32_bf16 a[8:11], v[100:103], v[84:87], a[8:11]
    ds_read_b128 v[120:123], v2 offset:22528
    ds_read_b128 v[124:127], v2 offset:23552
    v_mfma_f32_16x16x32_bf16 a[12:15], v[96:99], v[88:91], a[12:15]
    v_exp_f32 v244, v244
    v_mfma_f32_16x16x32_bf16 a[12:15], v[100:103], v[92:95], a[12:15]
    buffer_load_dwordx4 v1, s[36:39], s77 offen offset:1024 sc1 lds
    v_mfma_f32_16x16x32_bf16 v[248:251], a[224:227], v[136:139], v[152:155]
    v_exp_f32 v245, v245
    v_mfma_f32_16x16x32_bf16 v[248:251], a[228:231], v[168:171], v[248:251]
    v_exp_f32 v246, v246
    v_mfma_f32_16x16x32_bf16 v[248:251], a[232:235], v[200:203], v[248:251]
    v_exp_f32 v247, v247
    v_mfma_f32_16x16x32_bf16 v[248:251], a[236:239], v[232:235], v[248:251]
    s_waitcnt lgkmcnt(0)
    v_cvt_pk_bf16_f32 v40, v244, v245
    v_cvt_pk_bf16_f32 v41, v246, v247
    v_mfma_f32_16x16x32_bf16 a[16:19], v[104:107], v[64:67], a[16:19]
    ds_read_b128 v[96:99], v2 offset:24576
    ds_read_b128 v[100:103], v2 offset:25600
    v_mfma_f32_16x16x32_bf16 a[16:19], v[108:111], v[68:71], a[16:19]
    v_mfma_f32_16x16x32_bf16 a[20:23], v[104:107], v[72:75], a[20:23]
    v_mfma_f32_16x16x32_bf16 a[20:23], v[108:111], v[76:79], a[20:23]
    v_exp_f32 v248, v248
    v_mfma_f32_16x16x32_bf16 v[252:255], a[224:227], v[140:143], v[156:159]
    v_exp_f32 v249, v249
    v_mfma_f32_16x16x32_bf16 v[252:255], a[228:231], v[172:175], v[252:255]
    v_exp_f32 v250, v250
    v_mfma_f32_16x16x32_bf16 v[252:255], a[232:235], v[204:207], v[252:255]
    v_exp_f32 v251, v251
    v_mfma_f32_16x16x32_bf16 v[252:255], a[236:239], v[236:239], v[252:255]
    v_cvt_pk_bf16_f32 v48, v248, v249
    v_cvt_pk_bf16_f32 v49, v250, v251
    v_mfma_f32_16x16x32_bf16 a[24:27], v[104:107], v[80:83], a[24:27]
    ds_read_b128 a[224:227], v2 offset:8192
    ds_read_b128 a[228:231], v2 offset:9216
    v_mfma_f32_16x16x32_bf16 a[24:27], v[108:111], v[84:87], a[24:27]
    buffer_load_dwordx4 v1, s[36:39], s77 offen offset:2048 sc1 lds
    v_mfma_f32_16x16x32_bf16 a[28:31], v[104:107], v[88:91], a[28:31]
    v_exp_f32 v252, v252
    v_mfma_f32_16x16x32_bf16 a[28:31], v[108:111], v[92:95], a[28:31]
    v_exp_f32 v253, v253
    v_mfma_f32_16x16x32_bf16 v[240:243], a[240:243], v[128:131], v[180:183]
    v_exp_f32 v254, v254
    v_mfma_f32_16x16x32_bf16 v[240:243], a[244:247], v[160:163], v[240:243]
    v_exp_f32 v255, v255
    v_mfma_f32_16x16x32_bf16 v[240:243], a[248:251], v[192:195], v[240:243]
    v_cvt_pk_bf16_f32 v56, v252, v253
    v_cvt_pk_bf16_f32 v57, v254, v255
    v_mfma_f32_16x16x32_bf16 v[240:243], a[252:255], v[224:227], v[240:243]
    ds_read_b128 a[232:235], v2 offset:10240
    ds_read_b128 a[236:239], v2 offset:11264
    v_mfma_f32_16x16x32_bf16 a[32:35], v[112:115], v[64:67], a[32:35]
    ds_read_b128 v[104:107], v2 offset:26624
    v_mfma_f32_16x16x32_bf16 a[32:35], v[116:119], v[68:71], a[32:35]
    ds_read_b128 v[108:111], v2 offset:27648
    v_mfma_f32_16x16x32_bf16 a[36:39], v[112:115], v[72:75], a[36:39]
    v_mfma_f32_16x16x32_bf16 a[36:39], v[116:119], v[76:79], a[36:39]
    v_exp_f32 v240, v240
    v_mfma_f32_16x16x32_bf16 v[244:247], a[240:243], v[132:135], v[148:151]
    v_exp_f32 v241, v241
    v_mfma_f32_16x16x32_bf16 v[244:247], a[244:247], v[164:167], v[244:247]
    v_exp_f32 v242, v242
    v_mfma_f32_16x16x32_bf16 v[244:247], a[248:251], v[196:199], v[244:247]
    v_exp_f32 v243, v243
    v_mfma_f32_16x16x32_bf16 v[244:247], a[252:255], v[228:231], v[244:247]
    buffer_load_dwordx4 v1, s[36:39], s77 offen offset:3072 sc1 lds
    v_mfma_f32_16x16x32_bf16 a[40:43], v[112:115], v[80:83], a[40:43]
    v_cvt_pk_bf16_f32 v34, v240, v241
    v_cvt_pk_bf16_f32 v35, v242, v243
    v_mfma_f32_16x16x32_bf16 a[40:43], v[116:119], v[84:87], a[40:43]
    v_mfma_f32_16x16x32_bf16 a[44:47], v[112:115], v[88:91], a[44:47]
    ds_read_b128 v[112:115], v2 offset:28672
    v_mfma_f32_16x16x32_bf16 a[44:47], v[116:119], v[92:95], a[44:47]
    v_exp_f32 v244, v244
    v_mfma_f32_16x16x32_bf16 v[248:251], a[240:243], v[136:139], v[152:155]
    v_exp_f32 v245, v245
    v_mfma_f32_16x16x32_bf16 v[248:251], a[244:247], v[168:171], v[248:251]
    v_exp_f32 v246, v246
    v_mfma_f32_16x16x32_bf16 v[248:251], a[248:251], v[200:203], v[248:251]
    v_exp_f32 v247, v247
    v_mfma_f32_16x16x32_bf16 v[248:251], a[252:255], v[232:235], v[248:251]
    v_cvt_pk_bf16_f32 v42, v244, v245
    v_cvt_pk_bf16_f32 v43, v246, v247
    v_mfma_f32_16x16x32_bf16 a[48:51], v[120:123], v[64:67], a[48:51]
    ds_read_b128 v[116:119], v2 offset:29696
    v_mfma_f32_16x16x32_bf16 a[48:51], v[124:127], v[68:71], a[48:51]
    v_mfma_f32_16x16x32_bf16 a[52:55], v[120:123], v[72:75], a[52:55]
    v_mfma_f32_16x16x32_bf16 a[52:55], v[124:127], v[76:79], a[52:55]
    v_mfma_f32_16x16x32_bf16 v[252:255], a[240:243], v[140:143], v[156:159]
    v_exp_f32 v248, v248
    v_mfma_f32_16x16x32_bf16 v[252:255], a[244:247], v[172:175], v[252:255]
    s_add_u32 s100, s77, 4096
    v_exp_f32 v249, v249
    v_mfma_f32_16x16x32_bf16 v[252:255], a[248:251], v[204:207], v[252:255]
    s_add_u32 m0, m0, 4096
    v_exp_f32 v250, v250
    v_mfma_f32_16x16x32_bf16 v[252:255], a[252:255], v[236:239], v[252:255]
    buffer_load_dwordx4 v1, s[36:39], s100 offen sc1 lds
    v_mfma_f32_16x16x32_bf16 a[56:59], v[120:123], v[80:83], a[56:59]
    v_exp_f32 v251, v251
    v_mfma_f32_16x16x32_bf16 a[56:59], v[124:127], v[84:87], a[56:59]
    v_cvt_pk_bf16_f32 v50, v248, v249
    v_cvt_pk_bf16_f32 v51, v250, v251
    v_mfma_f32_16x16x32_bf16 a[60:63], v[120:123], v[88:91], a[60:63]
    ds_read_b128 a[240:243], v2 offset:12288
    ds_read_b128 a[244:247], v2 offset:13312
    v_mfma_f32_16x16x32_bf16 a[60:63], v[124:127], v[92:95], a[60:63]
    s_waitcnt lgkmcnt(2)
    v_exp_f32 v252, v252
    v_mfma_f32_16x16x32_bf16 v[240:243], a[224:227], v[128:131], v[184:187]
    v_exp_f32 v253, v253
    v_mfma_f32_16x16x32_bf16 v[240:243], a[228:231], v[160:163], v[240:243]
    v_exp_f32 v254, v254
    v_mfma_f32_16x16x32_bf16 v[240:243], a[232:235], v[192:195], v[240:243]
    v_exp_f32 v255, v255
    v_mfma_f32_16x16x32_bf16 v[240:243], a[236:239], v[224:227], v[240:243]
    v_cvt_pk_bf16_f32 v58, v252, v253
    v_cvt_pk_bf16_f32 v59, v254, v255
    v_mfma_f32_16x16x32_bf16 a[144:147], v[96:99], v[64:67], a[144:147]
    ds_read_b128 a[248:251], v2 offset:14336
    ds_read_b128 a[252:255], v2 offset:15360
    v_mfma_f32_16x16x32_bf16 a[144:147], v[100:103], v[68:71], a[144:147]
    ds_read_b128 v[120:123], v2 offset:30720
    v_mfma_f32_16x16x32_bf16 a[148:151], v[96:99], v[72:75], a[148:151]
    v_exp_f32 v240, v240
    v_mfma_f32_16x16x32_bf16 a[148:151], v[100:103], v[76:79], a[148:151]
    v_exp_f32 v241, v241
    v_mfma_f32_16x16x32_bf16 v[244:247], a[224:227], v[132:135], v[148:151]
    buffer_load_dwordx4 v1, s[36:39], s100 offen offset:1024 sc1 lds
    v_mfma_f32_16x16x32_bf16 v[244:247], a[228:231], v[164:167], v[244:247]
    v_exp_f32 v242, v242
    v_mfma_f32_16x16x32_bf16 v[244:247], a[232:235], v[196:199], v[244:247]
    v_exp_f32 v243, v243
    v_mfma_f32_16x16x32_bf16 v[244:247], a[236:239], v[228:231], v[244:247]
    v_cvt_pk_bf16_f32 v36, v240, v241
    v_cvt_pk_bf16_f32 v37, v242, v243
    v_mfma_f32_16x16x32_bf16 a[152:155], v[96:99], v[80:83], a[152:155]
    ds_read_b128 v[124:127], v2 offset:31744
    v_mfma_f32_16x16x32_bf16 a[152:155], v[100:103], v[84:87], a[152:155]
    v_mfma_f32_16x16x32_bf16 a[156:159], v[96:99], v[88:91], a[156:159]
    v_mfma_f32_16x16x32_bf16 a[156:159], v[100:103], v[92:95], a[156:159]
    v_mfma_f32_16x16x32_bf16 v[248:251], a[224:227], v[136:139], v[152:155]
    v_exp_f32 v244, v244
    v_mfma_f32_16x16x32_bf16 v[248:251], a[228:231], v[168:171], v[248:251]
    v_exp_f32 v245, v245
    v_mfma_f32_16x16x32_bf16 v[248:251], a[232:235], v[200:203], v[248:251]
    v_exp_f32 v246, v246
    v_mfma_f32_16x16x32_bf16 v[248:251], a[236:239], v[232:235], v[248:251]
    v_exp_f32 v247, v247
    v_mfma_f32_16x16x32_bf16 a[160:163], v[104:107], v[64:67], a[160:163]
    v_cvt_pk_bf16_f32 v44, v244, v245
    v_cvt_pk_bf16_f32 v45, v246, v247
    v_mfma_f32_16x16x32_bf16 a[160:163], v[108:111], v[68:71], a[160:163]
    v_mfma_f32_16x16x32_bf16 a[164:167], v[104:107], v[72:75], a[164:167]
    buffer_load_dwordx4 v1, s[36:39], s100 offen offset:2048 sc1 lds
    v_mfma_f32_16x16x32_bf16 a[164:167], v[108:111], v[76:79], a[164:167]
    v_exp_f32 v248, v248
    v_mfma_f32_16x16x32_bf16 v[252:255], a[224:227], v[140:143], v[156:159]
    v_exp_f32 v249, v249
    v_mfma_f32_16x16x32_bf16 v[252:255], a[228:231], v[172:175], v[252:255]
    v_exp_f32 v250, v250
    v_mfma_f32_16x16x32_bf16 v[252:255], a[232:235], v[204:207], v[252:255]
    v_exp_f32 v251, v251
    v_mfma_f32_16x16x32_bf16 v[252:255], a[236:239], v[236:239], v[252:255]
    v_cvt_pk_bf16_f32 v52, v248, v249
    v_cvt_pk_bf16_f32 v53, v250, v251
    v_mfma_f32_16x16x32_bf16 a[168:171], v[104:107], v[80:83], a[168:171]
    v_mfma_f32_16x16x32_bf16 a[168:171], v[108:111], v[84:87], a[168:171]
    v_mfma_f32_16x16x32_bf16 a[172:175], v[104:107], v[88:91], a[172:175]
    v_mfma_f32_16x16x32_bf16 a[172:175], v[108:111], v[92:95], a[172:175]
    s_waitcnt lgkmcnt(0)
    v_mfma_f32_16x16x32_bf16 v[240:243], a[240:243], v[128:131], v[188:191]
    v_mfma_f32_16x16x32_bf16 v[240:243], a[244:247], v[160:163], v[240:243]
    v_exp_f32 v252, v252
    v_mfma_f32_16x16x32_bf16 v[240:243], a[248:251], v[192:195], v[240:243]
    v_exp_f32 v253, v253
    v_mfma_f32_16x16x32_bf16 v[240:243], a[252:255], v[224:227], v[240:243]
    v_exp_f32 v254, v254
    v_mfma_f32_16x16x32_bf16 a[176:179], v[112:115], v[64:67], a[176:179]
    buffer_load_dwordx4 v1, s[36:39], s100 offen offset:3072 sc1 lds
    v_mfma_f32_16x16x32_bf16 a[176:179], v[116:119], v[68:71], a[176:179]
    v_exp_f32 v255, v255
    v_mfma_f32_16x16x32_bf16 a[180:183], v[112:115], v[72:75], a[180:183]
    v_cvt_pk_bf16_f32 v60, v252, v253
    v_cvt_pk_bf16_f32 v61, v254, v255
    v_mfma_f32_16x16x32_bf16 a[180:183], v[116:119], v[76:79], a[180:183]
    s_cmp_eq_u32 s82, 163840
    s_cselect_b32 s82, 0, s82
    v_add_u32 v2, s82, v1
    v_mfma_f32_16x16x32_bf16 v[244:247], a[240:243], v[132:135], v[148:151]
    v_exp_f32 v240, v240
    v_mfma_f32_16x16x32_bf16 v[244:247], a[244:247], v[164:167], v[244:247]
    v_exp_f32 v241, v241
    v_mfma_f32_16x16x32_bf16 v[244:247], a[248:251], v[196:199], v[244:247]
    v_exp_f32 v242, v242
    v_mfma_f32_16x16x32_bf16 v[244:247], a[252:255], v[228:231], v[244:247]
    v_exp_f32 v243, v243
    v_mfma_f32_16x16x32_bf16 a[184:187], v[112:115], v[80:83], a[184:187]
    v_cvt_pk_bf16_f32 v38, v240, v241
    v_cvt_pk_bf16_f32 v39, v242, v243
    v_mfma_f32_16x16x32_bf16 a[184:187], v[116:119], v[84:87], a[184:187]
    v_mfma_f32_16x16x32_bf16 a[188:191], v[112:115], v[88:91], a[188:191]
    v_mfma_f32_16x16x32_bf16 a[188:191], v[116:119], v[92:95], a[188:191]
    v_mfma_f32_16x16x32_bf16 v[248:251], a[240:243], v[136:139], v[152:155]
    v_exp_f32 v244, v244
    v_mfma_f32_16x16x32_bf16 v[248:251], a[244:247], v[168:171], v[248:251]
    v_exp_f32 v245, v245
    v_mfma_f32_16x16x32_bf16 v[248:251], a[248:251], v[200:203], v[248:251]
    s_add_u32 s77, s77, 32768
    v_exp_f32 v246, v246
    v_mfma_f32_16x16x32_bf16 v[248:251], a[252:255], v[232:235], v[248:251]
    v_exp_f32 v247, v247
    v_mfma_f32_16x16x32_bf16 a[192:195], v[120:123], v[64:67], a[192:195]
    v_cvt_pk_bf16_f32 v46, v244, v245
    v_cvt_pk_bf16_f32 v47, v246, v247
    v_mfma_f32_16x16x32_bf16 a[192:195], v[124:127], v[68:71], a[192:195]
    v_mfma_f32_16x16x32_bf16 a[196:199], v[120:123], v[72:75], a[196:199]
    v_mfma_f32_16x16x32_bf16 a[196:199], v[124:127], v[76:79], a[196:199]
    v_mfma_f32_16x16x32_bf16 v[252:255], a[240:243], v[140:143], v[156:159]
    v_exp_f32 v248, v248
    v_mfma_f32_16x16x32_bf16 v[252:255], a[244:247], v[172:175], v[252:255]
    v_exp_f32 v249, v249
    v_mfma_f32_16x16x32_bf16 v[252:255], a[248:251], v[204:207], v[252:255]
    v_exp_f32 v250, v250
    v_mfma_f32_16x16x32_bf16 v[252:255], a[252:255], v[236:239], v[252:255]
    s_waitcnt vmcnt(8) lgkmcnt(0)
    s_barrier
    ds_read_b128 a[224:227], v2 offset:0
    v_mfma_f32_16x16x32_bf16 a[200:203], v[120:123], v[80:83], a[200:203]
    ds_read_b128 a[228:231], v2 offset:1024
    ds_read_b128 a[232:235], v2 offset:2048
    v_mfma_f32_16x16x32_bf16 a[200:203], v[124:127], v[84:87], a[200:203]
    ds_read_b128 a[236:239], v2 offset:3072
    v_cvt_pk_bf16_f32 v54, v248, v249
    v_mfma_f32_16x16x32_bf16 a[204:207], v[120:123], v[88:91], a[204:207]
    v_exp_f32 v251, v251
    v_mfma_f32_16x16x32_bf16 a[204:207], v[124:127], v[92:95], a[204:207]
    ds_read_b128 v[96:99], v2 offset:16384
    ds_read_b128 v[100:103], v2 offset:17408
    v_mfma_f32_16x16x32_bf16 a[208:211], a[136:139], v[64:67], a[208:211]
    v_exp_f32 v252, v252
    v_mfma_f32_16x16x32_bf16 a[208:211], a[136:139], v[68:71], a[208:211]
    v_exp_f32 v253, v253
    v_mfma_f32_16x16x32_bf16 a[212:215], a[136:139], v[72:75], a[212:215]
    v_cvt_pk_bf16_f32 v55, v250, v251
    v_cvt_pk_bf16_f32 v62, v252, v253
    v_mfma_f32_16x16x32_bf16 a[212:215], a[136:139], v[76:79], a[212:215]
    v_mfma_f32_16x16x32_bf16 a[216:219], a[136:139], v[80:83], a[216:219]
    v_mfma_f32_16x16x32_bf16 a[216:219], a[136:139], v[84:87], a[216:219]
    v_mfma_f32_16x16x32_bf16 a[220:223], a[136:139], v[88:91], a[220:223]
    v_mfma_f32_16x16x32_bf16 a[220:223], a[136:139], v[92:95], a[220:223]
    s_sub_u32 s78, s78, 1
    s_cmp_lg_u32 s78, 0
    s_cbranch_scc1 K1_LB
K1_LB_END:
    v_add_f32 v212, s12, v148
    v_fma_f32 v176, v208, s8, v212
    v_fma_f32 v177, v209, s8, v212
    v_fma_f32 v178, v210, s8, v212
    v_fma_f32 v179, v211, s8, v212
    s_nop 1
    s_waitcnt lgkmcnt(0)
    v_mfma_f32_16x16x32_bf16 v[240:243], a[224:227], v[132:135], v[176:179]
    s_mov_b32 s7, 0
    ds_read_b128 v[104:107], v2 offset:18432
    ds_read_b128 v[108:111], v2 offset:19456
    v_mfma_f32_16x16x32_bf16 v[240:243], a[228:231], v[164:167], v[240:243]
    s_lshl_b32 s29, s6, 2
    buffer_load_dwordx4 v[64:67], v11, s[48:51], s7 offen nt
    v_mfma_f32_16x16x32_bf16 v[240:243], a[232:235], v[196:199], v[240:243]
    s_mov_b32 s7, 18432
    v_exp_f32 v254, v254
    v_mfma_f32_16x16x32_bf16 v[240:243], a[236:239], v[228:231], v[240:243]
    s_lshr_b32 s29, 0x41302413, s29
    v_exp_f32 v255, v255
    v_mfma_f32_16x16x32_bf16 a[0:3], v[96:99], v[32:35], a[0:3]
    s_and_b32 s29, s29, 7
    v_cvt_pk_bf16_f32 v63, v254, v255
    ds_read_b128 a[240:243], v2 offset:4096
    v_mfma_f32_16x16x32_bf16 a[0:3], v[100:103], v[36:39], a[0:3]
    s_lshl_b32 s29, s29, 15
    buffer_load_dwordx4 v[68:71], v11, s[48:51], s7 offen nt
    v_mfma_f32_16x16x32_bf16 a[4:7], v[96:99], v[40:43], a[4:7]
    s_mov_b32 s7, 9216
    ds_read_b128 a[244:247], v2 offset:5120
    ds_read_b128 a[248:251], v2 offset:6144
    v_mfma_f32_16x16x32_bf16 a[4:7], v[100:103], v[44:47], a[4:7]
    s_add_u32 s44, s29, s75
    ds_read_b128 a[252:255], v2 offset:7168
    v_add_f32 v213, s13, v148
    v_mfma_f32_16x16x32_bf16 v[244:247], a[224:227], v[136:139], v[152:155]
    s_lshl_b32 s29, s6, 2
    ds_read_b128 v[112:115], v2 offset:20480
    v_fma_f32 v180, v208, s9, v213
    v_mfma_f32_16x16x32_bf16 v[244:247], a[228:231], v[168:171], v[244:247]
    s_lshr_b32 s29, 0x2413024, s29
    buffer_load_dwordx4 v[20:23], v11, s[48:51], s7 offen nt
    v_mfma_f32_16x16x32_bf16 v[244:247], a[232:235], v[200:203], v[244:247]
    s_mov_b32 s7, 27648
    ds_read_b128 v[116:119], v2 offset:21504
    v_fma_f32 v181, v209, s9, v213
    v_mfma_f32_16x16x32_bf16 v[244:247], a[236:239], v[232:235], v[244:247]
    s_and_b32 s29, s29, 7
    v_fma_f32 v182, v210, s9, v213
    v_fma_f32 v183, v211, s9, v213
    v_mfma_f32_16x16x32_bf16 a[8:11], v[96:99], v[48:51], a[8:11]
    s_lshl_b32 s29, s29, 15
    v_exp_f32 v240, v240
    v_mfma_f32_16x16x32_bf16 a[8:11], v[100:103], v[52:55], a[8:11]
    s_add_u32 s45, s29, s75
    buffer_load_dwordx4 v[24:27], v11, s[48:51], s7 offen nt
    v_mfma_f32_16x16x32_bf16 a[12:15], v[96:99], v[56:59], a[12:15]
    s_lshl_b32 s29, s6, 2
    v_exp_f32 v241, v241
    v_mfma_f32_16x16x32_bf16 a[12:15], v[100:103], v[60:63], a[12:15]
    s_lshr_b32 s29, 0x13024130, s29
    v_exp_f32 v242, v242
    s_waitcnt lgkmcnt(0)
    v_mfma_f32_16x16x32_bf16 a[16:19], v[104:107], v[32:35], a[16:19]
    s_and_b32 s29, s29, 7
    v_exp_f32 v243, v243
    v_mfma_f32_16x16x32_bf16 a[16:19], v[108:111], v[36:39], a[16:19]
    s_lshl_b32 s29, s29, 15
    buffer_load_dwordx4 v[144:147], v12, s[52:55], 0 offen nt
    v_mfma_f32_16x16x32_bf16 v[248:251], a[224:227], v[140:143], v[156:159]
    s_add_u32 s46, s29, s75
    v_cvt_pk_bf16_f32 v72, v240, v241
    v_cvt_pk_bf16_f32 v73, v242, v243
    v_mfma_f32_16x16x32_bf16 v[248:251], a[228:231], v[172:175], v[248:251]
    s_lshl_b32 s29, s6, 2
    ds_read_b128 v[120:123], v2 offset:22528
    ds_read_b128 v[124:127], v2 offset:23552
    v_mfma_f32_16x16x32_bf16 v[248:251], a[232:235], v[204:207], v[248:251]
    s_lshr_b32 s29, 0x24130241, s29
    v_exp_f32 v244, v244
    v_mfma_f32_16x16x32_bf16 v[248:251], a[236:239], v[236:239], v[248:251]
    s_and_b32 s29, s29, 7
    buffer_load_dwordx4 a[140:143], v13, s[52:55], 0 offen nt
    v_mfma_f32_16x16x32_bf16 a[20:23], v[104:107], v[40:43], a[20:23]
    s_lshl_b32 s29, s29, 15
    v_exp_f32 v245, v245
    v_mfma_f32_16x16x32_bf16 a[20:23], v[108:111], v[44:47], a[20:23]
    s_mov_b32 s98, 0x3fb8aa3b
    v_exp_f32 v246, v246
    v_mfma_f32_16x16x32_bf16 a[24:27], v[104:107], v[48:51], a[24:27]
    s_add_u32 s47, s29, s75
    v_exp_f32 v247, v247
    v_mfma_f32_16x16x32_bf16 a[24:27], v[108:111], v[52:55], a[24:27]
    s_lshl_b32 s29, s6, 2
    v_cvt_pk_bf16_f32 v80, v244, v245
    v_cvt_pk_bf16_f32 v81, v246, v247
    v_mfma_f32_16x16x32_bf16 a[28:31], v[104:107], v[56:59], a[28:31]
    s_lshr_b32 s29, 0x30241302, s29
    ds_read_b128 a[224:227], v2 offset:8192
    ds_read_b128 a[228:231], v2 offset:9216
    v_mfma_f32_16x16x32_bf16 a[28:31], v[108:111], v[60:63], a[28:31]
    s_lshr_b32 s61, s5, 3
    ds_read_b128 a[232:235], v2 offset:10240
    v_add_f32 v214, s14, v148
    v_mfma_f32_16x16x32_bf16 v[252:255], a[240:243], v[132:135], v[180:183]
    s_add_u32 s3, s5, s6
    ds_read_b128 a[236:239], v2 offset:11264
    v_fma_f32 v184, v208, s10, v214
    v_mfma_f32_16x16x32_bf16 v[252:255], a[244:247], v[164:167], v[252:255]
    s_and_b32 s29, s29, 7
    ds_read_b128 v[96:99], v2 offset:24576
    v_fma_f32 v185, v209, s10, v214
    v_mfma_f32_16x16x32_bf16 v[252:255], a[248:251], v[196:199], v[252:255]
    s_add_u32 s74, s4, 1
    ds_read_b128 v[100:103], v2 offset:25600
    v_fma_f32 v186, v210, s10, v214
    v_mfma_f32_16x16x32_bf16 v[252:255], a[252:255], v[228:231], v[252:255]
    s_and_b32 s28, s5, 3
    v_exp_f32 v248, v248
    v_mfma_f32_16x16x32_bf16 a[32:35], v[112:115], v[32:35], a[32:35]
    s_and_b32 s3, s3, 1
    v_exp_f32 v249, v249
    v_mfma_f32_16x16x32_bf16 a[32:35], v[116:119], v[36:39], a[32:35]
    s_lshl_b32 s29, s29, 15
    v_exp_f32 v250, v250
    v_mfma_f32_16x16x32_bf16 a[36:39], v[112:115], v[40:43], a[36:39]
    s_lshl2_add_u32 s66, s6, s61
    v_exp_f32 v251, v251
    v_mfma_f32_16x16x32_bf16 a[36:39], v[116:119], v[44:47], a[36:39]
    s_mul_i32 s71, s5, 768
    v_fma_f32 v187, v211, s10, v214
    v_cvt_pk_bf16_f32 v88, v248, v249
    v_mfma_f32_16x16x32_bf16 v[240:243], a[240:243], v[136:139], v[152:155]
    s_lshl_b32 s74, s74, 15
    v_cvt_pk_bf16_f32 v89, v250, v251
    ds_read_b128 v[104:107], v2 offset:26624
    v_mfma_f32_16x16x32_bf16 v[240:243], a[244:247], v[168:171], v[240:243]
    s_mul_i32 s28, s28, 9216
    v_exp_f32 v252, v252
    v_mfma_f32_16x16x32_bf16 v[240:243], a[248:251], v[200:203], v[240:243]
    s_lshl3_add_u32 s3, s61, s3
    v_exp_f32 v253, v253
    v_mfma_f32_16x16x32_bf16 v[240:243], a[252:255], v[232:235], v[240:243]
    s_add_u32 s79, s29, s75
    v_exp_f32 v254, v254
    v_mfma_f32_16x16x32_bf16 a[40:43], v[112:115], v[48:51], a[40:43]
    s_lshl_b32 s66, s66, 10
    v_exp_f32 v255, v255
    v_mfma_f32_16x16x32_bf16 a[40:43], v[116:119], v[52:55], a[40:43]
    s_add_u32 s71, s71, 131072
    v_cvt_pk_bf16_f32 v74, v252, v253
    v_cvt_pk_bf16_f32 v75, v254, v255
    v_mfma_f32_16x16x32_bf16 a[44:47], v[112:115], v[56:59], a[44:47]
    s_add_u32 s74, s74, s101
    ds_read_b128 v[108:111], v2 offset:27648
    ds_read_b128 v[112:115], v2 offset:28672
    v_mfma_f32_16x16x32_bf16 a[44:47], v[116:119], v[60:63], a[44:47]
    s_waitcnt lgkmcnt(2)
    v_exp_f32 v240, v240
    v_mfma_f32_16x16x32_bf16 a[48:51], v[120:123], v[32:35], a[48:51]
    v_exp_f32 v241, v241
    v_mfma_f32_16x16x32_bf16 a[48:51], v[124:127], v[36:39], a[48:51]
    v_exp_f32 v242, v242
    v_mfma_f32_16x16x32_bf16 v[244:247], a[240:243], v[140:143], v[156:159]
    v_exp_f32 v243, v243
    v_mfma_f32_16x16x32_bf16 v[244:247], a[244:247], v[172:175], v[244:247]
    v_cvt_pk_bf16_f32 v82, v240, v241
    v_cvt_pk_bf16_f32 v83, v242, v243
    v_mfma_f32_16x16x32_bf16 v[244:247], a[248:251], v[204:207], v[244:247]
    ds_read_b128 a[240:243], v2 offset:12288
    ds_read_b128 a[244:247], v2 offset:13312
    v_mfma_f32_16x16x32_bf16 v[244:247], a[252:255], v[236:239], v[244:247]
    ds_read_b128 a[248:251], v2 offset:14336
    v_add_f32 v215, s15, v148
    v_mfma_f32_16x16x32_bf16 a[52:55], v[120:123], v[40:43], a[52:55]
    ds_read_b128 a[252:255], v2 offset:15360
    v_fma_f32 v188, v208, s11, v215
    v_mfma_f32_16x16x32_bf16 a[52:55], v[124:127], v[44:47], a[52:55]
    ds_read_b128 v[116:119], v2 offset:29696
    v_fma_f32 v189, v209, s11, v215
    v_mfma_f32_16x16x32_bf16 a[56:59], v[120:123], v[48:51], a[56:59]
    v_exp_f32 v244, v244
    v_mfma_f32_16x16x32_bf16 a[56:59], v[124:127], v[52:55], a[56:59]
    v_exp_f32 v245, v245
    v_mfma_f32_16x16x32_bf16 a[60:63], v[120:123], v[56:59], a[60:63]
    v_exp_f32 v246, v246
    v_mfma_f32_16x16x32_bf16 a[60:63], v[124:127], v[60:63], a[60:63]
    v_exp_f32 v247, v247
    v_mfma_f32_16x16x32_bf16 v[248:251], a[224:227], v[132:135], v[184:187]
    v_fma_f32 v190, v210, s11, v215
    v_fma_f32 v191, v211, s11, v215
    v_mfma_f32_16x16x32_bf16 v[248:251], a[228:231], v[164:167], v[248:251]
    v_cvt_pk_bf16_f32 v90, v244, v245
    v_cvt_pk_bf16_f32 v91, v246, v247
    v_mfma_f32_16x16x32_bf16 v[248:251], a[232:235], v[196:199], v[248:251]
    ds_read_b128 v[120:123], v2 offset:30720
    ds_read_b128 v[124:127], v2 offset:31744
    v_mfma_f32_16x16x32_bf16 v[248:251], a[236:239], v[228:231], v[248:251]
    s_add_u32 m0, s76, s75
    v_bfe_u32 v8, v1, 2, 6
    v_accvgpr_read_b32 v4, a112
    v_mfma_f32_16x16x32_bf16 a[144:147], v[96:99], v[32:35], a[144:147]
    s_mov_b32 s76, s60
    buffer_load_dwordx4 v1, s[36:39], s77 offen sc1 lds
    v_mfma_f32_16x16x32_bf16 a[144:147], v[100:103], v[36:39], a[144:147]
    s_mov_b32 s60, s82
    v_exp_f32 v248, v248
    v_mfma_f32_16x16x32_bf16 a[148:151], v[96:99], v[40:43], a[148:151]
    s_add_u32 s82, s82, 32768
    v_exp_f32 v249, v249
    v_mfma_f32_16x16x32_bf16 a[148:151], v[100:103], v[44:47], a[148:151]
    v_exp_f32 v250, v250
    v_mfma_f32_16x16x32_bf16 v[252:255], a[224:227], v[136:139], v[152:155]
    v_exp_f32 v251, v251
    v_mfma_f32_16x16x32_bf16 v[252:255], a[228:231], v[168:171], v[252:255]
    v_cvt_pk_bf16_f32 v76, v248, v249
    v_cvt_pk_bf16_f32 v77, v250, v251
    v_mfma_f32_16x16x32_bf16 v[252:255], a[232:235], v[200:203], v[252:255]
    s_cmp_eq_u32 s82, 163840
    s_cselect_b32 s82, 0, s82
    v_add_u32 v2, s82, v1
    v_mfma_f32_16x16x32_bf16 v[252:255], a[236:239], v[232:235], v[252:255]
    buffer_load_dwordx4 v1, s[36:39], s77 offen offset:1024 sc1 lds
    v_mfma_f32_16x16x32_bf16 a[152:155], v[96:99], v[48:51], a[152:155]
    v_accvgpr_read_b32 v5, a116
    v_add_u32 v8, 192, v8
    v_mfma_f32_16x16x32_bf16 a[152:155], v[100:103], v[52:55], a[152:155]
    v_cvt_pk_bf16_f32 v4, 0, v4
    v_cvt_pk_bf16_f32 v5, 0, v5
    v_mfma_f32_16x16x32_bf16 a[156:159], v[96:99], v[56:59], a[156:159]
    v_exp_f32 v252, v252
    v_mfma_f32_16x16x32_bf16 a[156:159], v[100:103], v[60:63], a[156:159]
    v_exp_f32 v253, v253
    v_mfma_f32_16x16x32_bf16 a[160:163], v[104:107], v[32:35], a[160:163]
    s_waitcnt lgkmcnt(0)
    v_exp_f32 v254, v254
    v_mfma_f32_16x16x32_bf16 a[160:163], v[108:111], v[36:39], a[160:163]
    v_exp_f32 v255, v255
    v_mfma_f32_16x16x32_bf16 v[240:243], a[224:227], v[140:143], v[156:159]
    v_cvt_pk_bf16_f32 v84, v252, v253
    v_cvt_pk_bf16_f32 v85, v254, v255
    v_mfma_f32_16x16x32_bf16 v[240:243], a[228:231], v[172:175], v[240:243]
    buffer_load_dwordx4 v1, s[36:39], s77 offen offset:2048 sc1 lds
    v_mfma_f32_16x16x32_bf16 v[240:243], a[232:235], v[204:207], v[240:243]
    v_lshrrev_b32 v15, 8, v1
    ds_bpermute_b32 v4, v8, v4
    v_mfma_f32_16x16x32_bf16 v[240:243], a[236:239], v[236:239], v[240:243]
    ds_bpermute_b32 v5, v8, v5
    ds_read_b128 a[224:227], v2 offset:0
    v_mfma_f32_16x16x32_bf16 a[164:167], v[104:107], v[40:43], a[164:167]
    ds_read_b128 a[228:231], v2 offset:1024
    v_bfe_u32 v14, v1, 4, 4
    v_mfma_f32_16x16x32_bf16 a[164:167], v[108:111], v[44:47], a[164:167]
    ds_read_b128 a[232:235], v2 offset:2048
    v_lshlrev_b32 v15, 3, v15
    v_mfma_f32_16x16x32_bf16 a[168:171], v[104:107], v[48:51], a[168:171]
    ds_read_b128 a[236:239], v2 offset:3072
    v_sub_u32 v14, v14, v15
    v_mfma_f32_16x16x32_bf16 a[168:171], v[108:111], v[52:55], a[168:171]
    ds_read_b128 v[96:99], v2 offset:16384
    v_and_b32 v15, 16, v1
    v_mfma_f32_16x16x32_bf16 a[172:175], v[104:107], v[56:59], a[172:175]
    buffer_load_dwordx4 v1, s[36:39], s77 offen offset:3072 sc1 lds
    v_mfma_f32_16x16x32_bf16 a[172:175], v[108:111], v[60:63], a[172:175]
    ds_read_b128 v[100:103], v2 offset:17408
    v_mov_b32 v31, 0x3f80
    v_mfma_f32_16x16x32_bf16 v[244:247], a[240:243], v[132:135], v[188:191]
    v_exp_f32 v240, v240
    v_mfma_f32_16x16x32_bf16 v[244:247], a[244:247], v[164:167], v[244:247]
    v_exp_f32 v241, v241
    v_mfma_f32_16x16x32_bf16 v[244:247], a[248:251], v[196:199], v[244:247]
    v_exp_f32 v242, v242
    v_mfma_f32_16x16x32_bf16 v[244:247], a[252:255], v[228:231], v[244:247]
    v_exp_f32 v243, v243
    v_mfma_f32_16x16x32_bf16 a[176:179], v[112:115], v[32:35], a[176:179]
    v_cvt_pk_bf16_f32 v92, v240, v241
    v_cvt_pk_bf16_f32 v93, v242, v243
    v_mfma_f32_16x16x32_bf16 a[176:179], v[116:119], v[36:39], a[176:179]
    s_add_u32 s100, s77, 4096
    v_ashrrev_i32 v14, 1, v14
    v_lshlrev_b32 v15, v15, v31
    v_mfma_f32_16x16x32_bf16 a[180:183], v[112:115], v[40:43], a[180:183]
    s_add_u32 m0, m0, 4096
    v_exp_f32 v244, v244
    v_mfma_f32_16x16x32_bf16 a[180:183], v[116:119], v[44:47], a[180:183]
    buffer_load_dwordx4 v1, s[36:39], s100 offen sc1 lds
    v_mfma_f32_16x16x32_bf16 v[248:251], a[240:243], v[136:139], v[152:155]
    v_exp_f32 v245, v245
    v_mfma_f32_16x16x32_bf16 v[248:251], a[244:247], v[168:171], v[248:251]
    v_exp_f32 v246, v246
    v_mfma_f32_16x16x32_bf16 v[248:251], a[248:251], v[200:203], v[248:251]
    v_exp_f32 v247, v247
    v_mfma_f32_16x16x32_bf16 v[248:251], a[252:255], v[232:235], v[248:251]
    v_cvt_pk_bf16_f32 v78, v244, v245
    v_cvt_pk_bf16_f32 v79, v246, v247
    v_mfma_f32_16x16x32_bf16 a[184:187], v[112:115], v[48:51], a[184:187]
    s_waitcnt lgkmcnt(0)
    v_cmp_eq_i32 vcc, 0, v14
    v_mul_f32 v4, s98, v4
    v_mfma_f32_16x16x32_bf16 a[184:187], v[116:119], v[52:55], a[184:187]
    buffer_load_dwordx4 v1, s[36:39], s100 offen offset:1024 sc1 lds
    v_mfma_f32_16x16x32_bf16 a[188:191], v[112:115], v[56:59], a[188:191]
    v_exp_f32 v248, v248
    v_mfma_f32_16x16x32_bf16 a[188:191], v[116:119], v[60:63], a[188:191]
    v_exp_f32 v249, v249
    v_mfma_f32_16x16x32_bf16 a[192:195], v[120:123], v[32:35], a[192:195]
    v_exp_f32 v250, v250
    v_mfma_f32_16x16x32_bf16 a[192:195], v[124:127], v[36:39], a[192:195]
    v_exp_f32 v251, v251
    v_mfma_f32_16x16x32_bf16 v[252:255], a[240:243], v[140:143], v[156:159]
    v_cvt_pk_bf16_f32 v86, v248, v249
    v_cvt_pk_bf16_f32 v87, v250, v251
    v_mfma_f32_16x16x32_bf16 v[252:255], a[244:247], v[172:175], v[252:255]
    v_cndmask_b32 v216, 0, v15, vcc
    v_cmp_eq_i32 vcc, 1, v14
    v_mfma_f32_16x16x32_bf16 v[252:255], a[248:251], v[204:207], v[252:255]
    v_mul_f32 v5, s98, v5
    v_cndmask_b32 v217, 0, v15, vcc
    v_mfma_f32_16x16x32_bf16 v[252:255], a[252:255], v[236:239], v[252:255]
    buffer_load_dwordx4 v1, s[36:39], s100 offen offset:2048 sc1 lds
    v_mfma_f32_16x16x32_bf16 a[196:199], v[120:123], v[40:43], a[196:199]
    v_cmp_eq_i32 vcc, 2, v14
    v_and_b32 v31, 512, v1
    v_mfma_f32_16x16x32_bf16 a[196:199], v[124:127], v[44:47], a[196:199]
    v_cndmask_b32 v218, 0, v15, vcc
    v_cmp_eq_i32 vcc, 3, v14
    v_mfma_f32_16x16x32_bf16 a[200:203], v[120:123], v[48:51], a[200:203]
    v_exp_f32 v252, v252
    v_mfma_f32_16x16x32_bf16 a[200:203], v[124:127], v[52:55], a[200:203]
    v_exp_f32 v253, v253
    v_mfma_f32_16x16x32_bf16 a[204:207], v[120:123], v[56:59], a[204:207]
    v_cvt_pk_bf16_f32 v94, v252, v253
    v_cndmask_b32 v219, 0, v15, vcc
    v_mfma_f32_16x16x32_bf16 a[204:207], v[124:127], v[60:63], a[204:207]
    v_cmp_eq_i32 vcc, -8, v14
    v_mad_u32_u24 v31, v31, 17, v1
    v_mfma_f32_16x16x32_bf16 a[208:211], a[136:139], v[32:35], a[208:211]
    buffer_load_dwordx4 v1, s[36:39], s100 offen offset:3072 sc1 lds
    v_mfma_f32_16x16x32_bf16 a[208:211], a[136:139], v[36:39], a[208:211]
    v_cndmask_b32 v220, 0, v15, vcc
    v_cmp_eq_i32 vcc, -7, v14
    v_mfma_f32_16x16x32_bf16 a[212:215], a[136:139], v[40:43], a[212:215]
    v_exp_f32 v4, v4
    v_mfma_f32_16x16x32_bf16 a[212:215], a[136:139], v[44:47], a[212:215]
    v_exp_f32 v5, v5
    v_mfma_f32_16x16x32_bf16 a[216:219], a[136:139], v[48:51], a[216:219]
    v_cndmask_b32 v221, 0, v15, vcc
    v_cmp_eq_i32 vcc, -6, v14
    v_mfma_f32_16x16x32_bf16 a[216:219], a[136:139], v[52:55], a[216:219]
    v_add_f32 v4, 1.0, v4
    v_add_f32 v5, 1.0, v5
    v_mfma_f32_16x16x32_bf16 a[220:223], a[136:139], v[56:59], a[220:223]
    v_cndmask_b32 v222, 0, v15, vcc
    v_cmp_eq_i32 vcc, -5, v14
    v_mfma_f32_16x16x32_bf16 a[220:223], a[136:139], v[60:63], a[220:223]
    s_add_u32 s77, s77, 32768
    v_rcp_f32 v4, v4
    v_rcp_f32 v5, v5
    v_cndmask_b32 v223, 0, v15, vcc
    s_cmp_eq_u32 s6, 7
    s_cselect_b32 s16, s8, 0
    s_cselect_b32 s17, s9, 0
    s_cselect_b32 s18, s10, 0
    s_cselect_b32 s19, s11, 0
    s_cselect_b32 s20, s12, 0
    s_cselect_b32 s21, s13, 0
    s_cselect_b32 s22, s14, 0
    s_cselect_b32 s23, s15, 0
    s_cbranch_scc1 K1_J7
K1_J7_BACK:
    v_add_f32 v212, s20, v152
    v_fma_f32 v176, v208, s16, v212
    v_fma_f32 v177, v209, s16, v212
    v_fma_f32 v178, v210, s16, v212
    v_fma_f32 v179, v211, s16, v212
    s_nop 1
    s_waitcnt lgkmcnt(0)
    v_mfma_f32_16x16x32_bf16 v[240:243], a[224:227], v[136:139], v[176:179]
    s_add_u32 m0, s76, s75
    v_exp_f32 v254, v254
    v_mfma_f32_16x16x32_bf16 v[240:243], a[228:231], v[168:171], v[240:243]
    s_mov_b32 s76, s60
    buffer_load_dwordx4 v1, s[36:39], s77 offen sc1 lds
    v_mfma_f32_16x16x32_bf16 v[240:243], a[232:235], v[200:203], v[240:243]
    s_mov_b32 s60, s82
    v_exp_f32 v255, v255
    v_mfma_f32_16x16x32_bf16 v[240:243], a[236:239], v[232:235], v[240:243]
    s_add_u32 s82, s82, 32768
    ds_read_b128 v[104:107], v2 offset:18432
    v_cvt_pk_bf16_f32 v95, v254, v255
    v_mfma_f32_16x16x32_bf16 a[4:7], v[96:99], v[72:75], a[4:7]
    ds_read_b128 v[108:111], v2 offset:19456
    ds_read_b128 a[240:243], v2 offset:4096
    v_mfma_f32_16x16x32_bf16 a[4:7], v[100:103], v[76:79], a[4:7]
    ds_read_b128 a[244:247], v2 offset:5120
    v_add_f32 v213, s21, v152
    v_mfma_f32_16x16x32_bf16 a[8:11], v[96:99], v[80:83], a[8:11]
    ds_read_b128 a[248:251], v2 offset:6144
    v_fma_f32 v180, v208, s17, v213
    v_mfma_f32_16x16x32_bf16 a[8:11], v[100:103], v[84:87], a[8:11]
    ds_read_b128 a[252:255], v2 offset:7168
    v_fma_f32 v181, v209, s17, v213
    v_mfma_f32_16x16x32_bf16 a[12:15], v[96:99], v[88:91], a[12:15]
    ds_read_b128 v[112:115], v2 offset:20480
    v_fma_f32 v182, v210, s17, v213
    v_mfma_f32_16x16x32_bf16 a[12:15], v[100:103], v[92:95], a[12:15]
    ds_read_b128 v[116:119], v2 offset:21504
    v_fma_f32 v183, v211, s17, v213
    v_mfma_f32_16x16x32_bf16 v[244:247], a[224:227], v[140:143], v[156:159]
    buffer_load_dwordx4 v1, s[36:39], s77 offen offset:1024 sc1 lds
    v_mfma_f32_16x16x32_bf16 v[244:247], a[228:231], v[172:175], v[244:247]
    ds_read_b128 v[120:123], v2 offset:22528
    ds_read_b128 v[124:127], v2 offset:23552
    v_mfma_f32_16x16x32_bf16 v[244:247], a[232:235], v[204:207], v[244:247]
    ds_read_b128 a[224:227], v2 offset:8192
    v_add_f32 v214, s22, v152
    v_mfma_f32_16x16x32_bf16 v[244:247], a[236:239], v[236:239], v[244:247]
    s_waitcnt lgkmcnt(4)
    ds_read_b128 a[228:231], v2 offset:9216
    v_fma_f32 v184, v208, s18, v214
    v_mfma_f32_16x16x32_bf16 a[20:23], v[104:107], v[72:75], a[20:23]
    ds_read_b128 a[232:235], v2 offset:10240
    v_fma_f32 v185, v209, s18, v214
    v_mfma_f32_16x16x32_bf16 a[20:23], v[108:111], v[76:79], a[20:23]
    ds_read_b128 a[236:239], v2 offset:11264
    v_fma_f32 v186, v210, s18, v214
    v_mfma_f32_16x16x32_bf16 a[24:27], v[104:107], v[80:83], a[24:27]
    ds_read_b128 v[96:99], v2 offset:24576
    v_fma_f32 v187, v211, s18, v214
    v_mfma_f32_16x16x32_bf16 a[24:27], v[108:111], v[84:87], a[24:27]
    ds_read_b128 v[100:103], v2 offset:25600
    v_add_f32 v215, s23, v152
    v_mfma_f32_16x16x32_bf16 a[28:31], v[104:107], v[88:91], a[28:31]
    v_exp_f32 v240, v240
    v_mfma_f32_16x16x32_bf16 a[28:31], v[108:111], v[92:95], a[28:31]
    v_exp_f32 v241, v241
    v_mfma_f32_16x16x32_bf16 v[248:251], a[240:243], v[136:139], v[180:183]
    buffer_load_dwordx4 v1, s[36:39], s77 offen offset:2048 sc1 lds
    v_mfma_f32_16x16x32_bf16 v[248:251], a[244:247], v[168:171], v[248:251]
    v_exp_f32 v242, v242
    v_mfma_f32_16x16x32_bf16 v[248:251], a[248:251], v[200:203], v[248:251]
    v_exp_f32 v243, v243
    v_mfma_f32_16x16x32_bf16 v[248:251], a[252:255], v[232:235], v[248:251]
    v_cvt_pk_bf16_f32 v48, v240, v241
    v_cvt_pk_bf16_f32 v49, v242, v243
    v_mfma_f32_16x16x32_bf16 a[36:39], v[112:115], v[72:75], a[36:39]
    s_waitcnt lgkmcnt(0)
    ds_read_b128 v[104:107], v2 offset:26624
    ds_read_b128 v[108:111], v2 offset:27648
    v_mfma_f32_16x16x32_bf16 a[36:39], v[116:119], v[76:79], a[36:39]
    v_exp_f32 v244, v244
    v_mfma_f32_16x16x32_bf16 a[40:43], v[112:115], v[80:83], a[40:43]
    v_exp_f32 v245, v245
    v_mfma_f32_16x16x32_bf16 a[40:43], v[116:119], v[84:87], a[40:43]
    v_exp_f32 v246, v246
    v_mfma_f32_16x16x32_bf16 a[44:47], v[112:115], v[88:91], a[44:47]
    v_exp_f32 v247, v247
    v_mfma_f32_16x16x32_bf16 a[44:47], v[116:119], v[92:95], a[44:47]
    s_waitcnt vmcnt(11)
    buffer_load_dwordx4 v1, s[36:39], s77 offen offset:3072 sc1 lds
    v_mfma_f32_16x16x32_bf16 v[12:15], v[64:67], v[216:219], 0
    v_cvt_pk_bf16_f32 v56, v244, v245
    v_cvt_pk_bf16_f32 v57, v246, v247
    v_mfma_f32_16x16x32_bf16 v[16:19], v[68:71], v[216:219], 0
    ds_read_b128 v[112:115], v2 offset:28672
    ds_read_b128 v[116:119], v2 offset:29696
    v_mfma_f32_16x16x32_bf16 v[252:255], a[240:243], v[140:143], v[156:159]
    ds_read_b128 a[240:243], v2 offset:12288
    v_fma_f32 v188, v208, s19, v215
    v_mfma_f32_16x16x32_bf16 v[252:255], a[244:247], v[172:175], v[252:255]
    v_cvt_pk_bf16_f32 v12, v12, v13
    v_cvt_pk_bf16_f32 v13, v14, v15
    v_mfma_f32_16x16x32_bf16 v[252:255], a[248:251], v[204:207], v[252:255]
    v_cvt_pk_bf16_f32 v14, v16, v17
    v_cvt_pk_bf16_f32 v15, v18, v19
    v_mfma_f32_16x16x32_bf16 v[252:255], a[252:255], v[236:239], v[252:255]
    buffer_store_dwordx4 v[12:15], v31, s[56:59], s63 offen offset:0 sc1
    v_mfma_f32_16x16x32_bf16 a[52:55], v[120:123], v[72:75], a[52:55]
    ds_read_b128 a[244:247], v2 offset:13312
    ds_read_b128 a[248:251], v2 offset:14336
    v_mfma_f32_16x16x32_bf16 a[52:55], v[124:127], v[76:79], a[52:55]
    ds_read_b128 a[252:255], v2 offset:15360
    v_fma_f32 v189, v209, s19, v215
    v_mfma_f32_16x16x32_bf16 a[56:59], v[120:123], v[80:83], a[56:59]
    s_add_u32 s100, s77, 4096
    v_exp_f32 v248, v248
    v_mfma_f32_16x16x32_bf16 a[56:59], v[124:127], v[84:87], a[56:59]
    s_add_u32 m0, m0, 4096
    v_exp_f32 v249, v249
    v_mfma_f32_16x16x32_bf16 a[60:63], v[120:123], v[88:91], a[60:63]
    buffer_load_dwordx4 v1, s[36:39], s100 offen sc1 lds
    v_mfma_f32_16x16x32_bf16 a[60:63], v[124:127], v[92:95], a[60:63]
    v_exp_f32 v250, v250
    v_mfma_f32_16x16x32_bf16 v[12:15], v[64:67], v[220:223], 0
    v_exp_f32 v251, v251
    v_mfma_f32_16x16x32_bf16 v[16:19], v[68:71], v[220:223], 0
    v_fma_f32 v190, v210, s19, v215
    v_fma_f32 v191, v211, s19, v215
    v_mfma_f32_16x16x32_bf16 v[240:243], a[224:227], v[136:139], v[184:187]
    v_cvt_pk_bf16_f32 v50, v248, v249
    v_cvt_pk_bf16_f32 v51, v250, v251
    v_mfma_f32_16x16x32_bf16 v[240:243], a[228:231], v[168:171], v[240:243]
    v_cvt_pk_bf16_f32 v12, v12, v13
    v_cvt_pk_bf16_f32 v13, v14, v15
    v_mfma_f32_16x16x32_bf16 v[240:243], a[232:235], v[200:203], v[240:243]
    v_cvt_pk_bf16_f32 v14, v16, v17
    v_cvt_pk_bf16_f32 v15, v18, v19
    v_mfma_f32_16x16x32_bf16 v[240:243], a[236:239], v[232:235], v[240:243]
    buffer_store_dwordx4 v[12:15], v31, s[56:59], s63 offen offset:1024 sc1
    v_mfma_f32_16x16x32_bf16 a[148:151], v[96:99], v[72:75], a[148:151]
    buffer_load_dwordx4 v1, s[36:39], s100 offen offset:1024 sc1 lds
    v_mfma_f32_16x16x32_bf16 a[148:151], v[100:103], v[76:79], a[148:151]
    ds_read_b128 v[120:123], v2 offset:30720
    ds_read_b128 v[124:127], v2 offset:31744
    v_mfma_f32_16x16x32_bf16 a[152:155], v[96:99], v[80:83], a[152:155]
    v_exp_f32 v252, v252
    v_mfma_f32_16x16x32_bf16 a[152:155], v[100:103], v[84:87], a[152:155]
    v_exp_f32 v253, v253
    v_mfma_f32_16x16x32_bf16 a[156:159], v[96:99], v[88:91], a[156:159]
    v_exp_f32 v254, v254
    v_mfma_f32_16x16x32_bf16 a[156:159], v[100:103], v[92:95], a[156:159]
    v_exp_f32 v255, v255
    v_mfma_f32_16x16x32_bf16 v[12:15], v[20:23], v[216:219], 0
    v_cvt_pk_bf16_f32 v58, v252, v253
    v_cvt_pk_bf16_f32 v59, v254, v255
    v_mfma_f32_16x16x32_bf16 v[16:19], v[24:27], v[216:219], 0
    v_exp_f32 v240, v240
    v_mfma_f32_16x16x32_bf16 v[244:247], a[224:227], v[140:143], v[156:159]
    v_exp_f32 v241, v241
    v_mfma_f32_16x16x32_bf16 v[244:247], a[228:231], v[172:175], v[244:247]
    v_exp_f32 v242, v242
    v_mfma_f32_16x16x32_bf16 v[244:247], a[232:235], v[204:207], v[244:247]
    buffer_load_dwordx4 v1, s[36:39], s100 offen offset:2048 sc1 lds
    v_mfma_f32_16x16x32_bf16 v[244:247], a[236:239], v[236:239], v[244:247]
    s_waitcnt lgkmcnt(0)
    v_cvt_pk_bf16_f32 v12, v12, v13
    v_cvt_pk_bf16_f32 v13, v14, v15
    v_mfma_f32_16x16x32_bf16 a[164:167], v[104:107], v[72:75], a[164:167]
    v_cvt_pk_bf16_f32 v14, v16, v17
    v_cvt_pk_bf16_f32 v15, v18, v19
    v_mfma_f32_16x16x32_bf16 a[164:167], v[108:111], v[76:79], a[164:167]
    buffer_store_dwordx4 v[12:15], v31, s[56:59], s63 offen offset:512 sc1
    v_mfma_f32_16x16x32_bf16 a[168:171], v[104:107], v[80:83], a[168:171]
    s_cmp_eq_u32 s82, 163840
    s_cselect_b32 s82, 0, s82
    v_add_u32 v2, s82, v1
    v_mfma_f32_16x16x32_bf16 a[168:171], v[108:111], v[84:87], a[168:171]
    v_exp_f32 v243, v243
    v_mfma_f32_16x16x32_bf16 a[172:175], v[104:107], v[88:91], a[172:175]
    v_exp_f32 v244, v244
    v_mfma_f32_16x16x32_bf16 a[172:175], v[108:111], v[92:95], a[172:175]
    v_exp_f32 v245, v245
    v_mfma_f32_16x16x32_bf16 v[12:15], v[20:23], v[220:223], 0
    v_exp_f32 v246, v246
    v_mfma_f32_16x16x32_bf16 v[16:19], v[24:27], v[220:223], 0
    buffer_load_dwordx4 v1, s[36:39], s100 offen offset:3072 sc1 lds
    v_mfma_f32_16x16x32_bf16 v[248:251], a[240:243], v[136:139], v[188:191]
    v_exp_f32 v247, v247
    v_mfma_f32_16x16x32_bf16 v[248:251], a[244:247], v[168:171], v[248:251]
    v_cvt_pk_bf16_f32 v52, v240, v241
    v_cvt_pk_bf16_f32 v53, v242, v243
    v_mfma_f32_16x16x32_bf16 v[248:251], a[248:251], v[200:203], v[248:251]
    v_cvt_pk_bf16_f32 v12, v12, v13
    v_cvt_pk_bf16_f32 v13, v14, v15
    v_mfma_f32_16x16x32_bf16 v[248:251], a[252:255], v[232:235], v[248:251]
    v_cvt_pk_bf16_f32 v14, v16, v17
    v_cvt_pk_bf16_f32 v15, v18, v19
    v_mfma_f32_16x16x32_bf16 a[180:183], v[112:115], v[72:75], a[180:183]
    buffer_store_dwordx4 v[12:15], v31, s[56:59], s63 offen offset:1536 sc1
    v_mfma_f32_16x16x32_bf16 a[180:183], v[116:119], v[76:79], a[180:183]
    v_cvt_pk_bf16_f32 v60, v244, v245
    v_cvt_pk_bf16_f32 v61, v246, v247
    v_mfma_f32_16x16x32_bf16 a[184:187], v[112:115], v[80:83], a[184:187]
    v_exp_f32 v248, v248
    v_mfma_f32_16x16x32_bf16 a[184:187], v[116:119], v[84:87], a[184:187]
    v_exp_f32 v249, v249
    v_mfma_f32_16x16x32_bf16 a[188:191], v[112:115], v[88:91], a[188:191]
    s_add_u32 s77, s77, 32768
    v_exp_f32 v250, v250
    v_mfma_f32_16x16x32_bf16 a[188:191], v[116:119], v[92:95], a[188:191]
    v_exp_f32 v251, v251
    v_mfma_f32_16x16x32_bf16 v[12:15], v[144:147], v[216:219], 0
    v_cvt_pk_bf16_f32 v54, v248, v249
    v_cvt_pk_bf16_f32 v55, v250, v251
    v_mfma_f32_16x16x32_bf16 v[16:19], a[140:143], v[216:219], 0
    v_accvgpr_read_b32 v6, a120
    v_accvgpr_read_b32 v7, a124
    v_mfma_f32_16x16x32_bf16 v[252:255], a[240:243], v[140:143], v[156:159]
    v_cvt_pk_bf16_f32 v6, 0, v6
    v_cvt_pk_bf16_f32 v7, 0, v7
    v_mfma_f32_16x16x32_bf16 v[252:255], a[244:247], v[172:175], v[252:255]
    v_cvt_pk_bf16_f32 v12, v12, v13
    v_cvt_pk_bf16_f32 v13, v14, v15
    v_mfma_f32_16x16x32_bf16 v[252:255], a[248:251], v[204:207], v[252:255]
    v_cvt_pk_bf16_f32 v14, v16, v17
    v_cvt_pk_bf16_f32 v15, v18, v19
    v_mfma_f32_16x16x32_bf16 v[252:255], a[252:255], v[236:239], v[252:255]
    buffer_store_dwordx4 v[12:15], v1, s[56:59], s64 offen offset:0 sc1
    v_mfma_f32_16x16x32_bf16 a[196:199], v[120:123], v[72:75], a[196:199]
    ds_bpermute_b32 v6, v8, v6
    ds_bpermute_b32 v7, v8, v7
    v_mfma_f32_16x16x32_bf16 a[196:199], v[124:127], v[76:79], a[196:199]
    s_waitcnt vmcnt(8) lgkmcnt(0)
    s_barrier
    ds_read_b128 a[224:227], v2 offset:0
    v_mfma_f32_16x16x32_bf16 a[200:203], v[120:123], v[80:83], a[200:203]
    ds_read_b128 a[228:231], v2 offset:1024
    ds_read_b128 a[232:235], v2 offset:2048
    v_mfma_f32_16x16x32_bf16 a[200:203], v[124:127], v[84:87], a[200:203]
    ds_read_b128 a[236:239], v2 offset:3072
    v_mul_f32 v6, s98, v6
    v_mfma_f32_16x16x32_bf16 a[204:207], v[120:123], v[88:91], a[204:207]
    ds_read_b128 v[96:99], v2 offset:16384
    v_mul_f32 v7, s98, v7
    v_mfma_f32_16x16x32_bf16 a[204:207], v[124:127], v[92:95], a[204:207]
    v_exp_f32 v252, v252
    v_mfma_f32_16x16x32_bf16 v[12:15], v[144:147], v[220:223], 0
    v_exp_f32 v253, v253
    v_mfma_f32_16x16x32_bf16 v[16:19], a[140:143], v[220:223], 0
    ds_read_b128 v[100:103], v2 offset:17408
    v_cvt_pk_bf16_f32 v62, v252, v253
    v_mfma_f32_16x16x32_bf16 a[212:215], a[136:139], v[72:75], a[212:215]
    v_exp_f32 v6, v6
    v_mfma_f32_16x16x32_bf16 a[212:215], a[136:139], v[76:79], a[212:215]
    v_exp_f32 v7, v7
    v_mfma_f32_16x16x32_bf16 a[216:219], a[136:139], v[80:83], a[216:219]
    v_cvt_pk_bf16_f32 v12, v12, v13
    v_cvt_pk_bf16_f32 v13, v14, v15
    v_mfma_f32_16x16x32_bf16 a[216:219], a[136:139], v[84:87], a[216:219]
    v_cvt_pk_bf16_f32 v14, v16, v17
    v_cvt_pk_bf16_f32 v15, v18, v19
    v_mfma_f32_16x16x32_bf16 a[220:223], a[136:139], v[88:91], a[220:223]
    buffer_store_dwordx4 v[12:15], v1, s[56:59], s62 offen offset:0 sc1
    v_mfma_f32_16x16x32_bf16 a[220:223], a[136:139], v[92:95], a[220:223]
    v_add_f32 v6, 1.0, v6
    v_add_f32 v7, 1.0, v7
    v_rcp_f32 v6, v6
    v_rcp_f32 v7, v7
    s_nop 1
    v_accvgpr_read_b32 v9, a208
    v_cmp_nge_f32 vcc, 0x71800000, v9
    v_rcp_f32 v10, v9
    s_nop 0
    s_or_b64 s[84:85], s[84:85], vcc
    v_mul_f32 v10, v10, v4
    v_accvgpr_read_b32 v12, a0
    v_accvgpr_read_b32 v13, a1
    v_accvgpr_read_b32 v14, a2
    v_accvgpr_read_b32 v15, a3
    v_accvgpr_read_b32 v16, a16
    v_accvgpr_read_b32 v17, a17
    v_accvgpr_read_b32 v18, a18
    v_accvgpr_read_b32 v19, a19
    v_pk_mul_f32 v[12:13], v[12:13], v[10:11] op_sel_hi:[1,0]
    v_pk_mul_f32 v[14:15], v[14:15], v[10:11] op_sel_hi:[1,0]
    v_pk_mul_f32 v[16:17], v[16:17], v[10:11] op_sel_hi:[1,0]
    v_pk_mul_f32 v[18:19], v[18:19], v[10:11] op_sel_hi:[1,0]
    v_cvt_pk_bf16_f32 v12, v12, v13
    v_cvt_pk_bf16_f32 v13, v14, v15
    v_cvt_pk_bf16_f32 v14, v16, v17
    v_cvt_pk_bf16_f32 v15, v18, v19
    buffer_store_dwordx4 v[12:15], v1, s[40:43], s80 offen offset:0 sc1
    v_accvgpr_read_b32 v20, a32
    v_accvgpr_read_b32 v21, a33
    v_accvgpr_read_b32 v22, a34
    v_accvgpr_read_b32 v23, a35
    v_accvgpr_read_b32 v24, a48
    v_accvgpr_read_b32 v25, a49
    v_accvgpr_read_b32 v26, a50
    v_accvgpr_read_b32 v27, a51
    v_pk_mul_f32 v[20:21], v[20:21], v[10:11] op_sel_hi:[1,0]
    v_pk_mul_f32 v[22:23], v[22:23], v[10:11] op_sel_hi:[1,0]
    v_pk_mul_f32 v[24:25], v[24:25], v[10:11] op_sel_hi:[1,0]
    v_pk_mul_f32 v[26:27], v[26:27], v[10:11] op_sel_hi:[1,0]
    v_cvt_pk_bf16_f32 v20, v20, v21
    v_cvt_pk_bf16_f32 v21, v22, v23
    v_cvt_pk_bf16_f32 v22, v24, v25
    v_cvt_pk_bf16_f32 v23, v26, v27
    buffer_store_dwordx4 v[20:23], v1, s[40:43], s80 offen offset:1024 sc1
    v_accvgpr_read_b32 v12, a144
    v_accvgpr_read_b32 v13, a145
    v_accvgpr_read_b32 v14, a146
    v_accvgpr_read_b32 v15, a147
    v_accvgpr_read_b32 v16, a160
    v_accvgpr_read_b32 v17, a161
    v_accvgpr_read_b32 v18, a162
    v_accvgpr_read_b32 v19, a163
    v_pk_mul_f32 v[12:13], v[12:13], v[10:11] op_sel_hi:[1,0]
    v_pk_mul_f32 v[14:15], v[14:15], v[10:11] op_sel_hi:[1,0]
    v_pk_mul_f32 v[16:17], v[16:17], v[10:11] op_sel_hi:[1,0]
    v_pk_mul_f32 v[18:19], v[18:19], v[10:11] op_sel_hi:[1,0]
    v_cvt_pk_bf16_f32 v12, v12, v13
    v_cvt_pk_bf16_f32 v13, v14, v15
    v_cvt_pk_bf16_f32 v14, v16, v17
    v_cvt_pk_bf16_f32 v15, v18, v19
    buffer_store_dwordx4 v[12:15], v1, s[40:43], s80 offen offset:2048 sc1
    v_accvgpr_read_b32 v20, a176
    v_accvgpr_read_b32 v21, a177
    v_accvgpr_read_b32 v22, a178
    v_accvgpr_read_b32 v23, a179
    v_accvgpr_read_b32 v24, a192
    v_accvgpr_read_b32 v25, a193
    v_accvgpr_read_b32 v26, a194
    v_accvgpr_read_b32 v27, a195
    v_pk_mul_f32 v[20:21], v[20:21], v[10:11] op_sel_hi:[1,0]
    v_pk_mul_f32 v[22:23], v[22:23], v[10:11] op_sel_hi:[1,0]
    v_pk_mul_f32 v[24:25], v[24:25], v[10:11] op_sel_hi:[1,0]
    v_pk_mul_f32 v[26:27], v[26:27], v[10:11] op_sel_hi:[1,0]
    v_cvt_pk_bf16_f32 v20, v20, v21
    v_cvt_pk_bf16_f32 v21, v22, v23
    v_cvt_pk_bf16_f32 v22, v24, v25
    v_cvt_pk_bf16_f32 v23, v26, v27
    buffer_store_dwordx4 v[20:23], v1, s[40:43], s80 offen offset:3072 sc1
    v_accvgpr_read_b32 v9, a212
    v_cmp_nge_f32 vcc, 0x71800000, v9
    v_rcp_f32 v10, v9
    s_nop 0
    s_or_b64 s[84:85], s[84:85], vcc
    v_mul_f32 v10, v10, v5
    s_add_u32 s72, s80, 622592
    v_accvgpr_read_b32 v12, a4
    v_accvgpr_read_b32 v13, a5
    v_accvgpr_read_b32 v14, a6
    v_accvgpr_read_b32 v15, a7
    v_accvgpr_read_b32 v16, a20
    v_accvgpr_read_b32 v17, a21
    v_accvgpr_read_b32 v18, a22
    v_accvgpr_read_b32 v19, a23
    v_pk_mul_f32 v[12:13], v[12:13], v[10:11] op_sel_hi:[1,0]
    v_pk_mul_f32 v[14:15], v[14:15], v[10:11] op_sel_hi:[1,0]
    v_pk_mul_f32 v[16:17], v[16:17], v[10:11] op_sel_hi:[1,0]
    v_pk_mul_f32 v[18:19], v[18:19], v[10:11] op_sel_hi:[1,0]
    v_cvt_pk_bf16_f32 v12, v12, v13
    v_cvt_pk_bf16_f32 v13, v14, v15
    v_cvt_pk_bf16_f32 v14, v16, v17
    v_cvt_pk_bf16_f32 v15, v18, v19
    buffer_store_dwordx4 v[12:15], v1, s[40:43], s72 offen offset:0 sc1
    v_accvgpr_read_b32 v20, a36
    v_accvgpr_read_b32 v21, a37
    v_accvgpr_read_b32 v22, a38
    v_accvgpr_read_b32 v23, a39
    v_accvgpr_read_b32 v24, a52
    v_accvgpr_read_b32 v25, a53
    v_accvgpr_read_b32 v26, a54
    v_accvgpr_read_b32 v27, a55
    v_pk_mul_f32 v[20:21], v[20:21], v[10:11] op_sel_hi:[1,0]
    v_pk_mul_f32 v[22:23], v[22:23], v[10:11] op_sel_hi:[1,0]
    v_pk_mul_f32 v[24:25], v[24:25], v[10:11] op_sel_hi:[1,0]
    v_pk_mul_f32 v[26:27], v[26:27], v[10:11] op_sel_hi:[1,0]
    v_cvt_pk_bf16_f32 v20, v20, v21
    v_cvt_pk_bf16_f32 v21, v22, v23
    v_cvt_pk_bf16_f32 v22, v24, v25
    v_cvt_pk_bf16_f32 v23, v26, v27
    buffer_store_dwordx4 v[20:23], v1, s[40:43], s72 offen offset:1024 sc1
    v_accvgpr_read_b32 v12, a148
    v_accvgpr_read_b32 v13, a149
    v_accvgpr_read_b32 v14, a150
    v_accvgpr_read_b32 v15, a151
    v_accvgpr_read_b32 v16, a164
    v_accvgpr_read_b32 v17, a165
    v_accvgpr_read_b32 v18, a166
    v_accvgpr_read_b32 v19, a167
    v_pk_mul_f32 v[12:13], v[12:13], v[10:11] op_sel_hi:[1,0]
    v_pk_mul_f32 v[14:15], v[14:15], v[10:11] op_sel_hi:[1,0]
    v_pk_mul_f32 v[16:17], v[16:17], v[10:11] op_sel_hi:[1,0]
    v_pk_mul_f32 v[18:19], v[18:19], v[10:11] op_sel_hi:[1,0]
    v_cvt_pk_bf16_f32 v12, v12, v13
    v_cvt_pk_bf16_f32 v13, v14, v15
    v_cvt_pk_bf16_f32 v14, v16, v17
    v_cvt_pk_bf16_f32 v15, v18, v19
    buffer_store_dwordx4 v[12:15], v1, s[40:43], s72 offen offset:2048 sc1
    v_accvgpr_read_b32 v20, a180
    v_accvgpr_read_b32 v21, a181
    v_accvgpr_read_b32 v22, a182
    v_accvgpr_read_b32 v23, a183
    v_accvgpr_read_b32 v24, a196
    v_accvgpr_read_b32 v25, a197
    v_accvgpr_read_b32 v26, a198
    v_accvgpr_read_b32 v27, a199
    v_pk_mul_f32 v[20:21], v[20:21], v[10:11] op_sel_hi:[1,0]
    v_pk_mul_f32 v[22:23], v[22:23], v[10:11] op_sel_hi:[1,0]
    v_pk_mul_f32 v[24:25], v[24:25], v[10:11] op_sel_hi:[1,0]
    v_pk_mul_f32 v[26:27], v[26:27], v[10:11] op_sel_hi:[1,0]
    v_cvt_pk_bf16_f32 v20, v20, v21
    v_cvt_pk_bf16_f32 v21, v22, v23
    v_cvt_pk_bf16_f32 v22, v24, v25
    v_cvt_pk_bf16_f32 v23, v26, v27
    buffer_store_dwordx4 v[20:23], v1, s[40:43], s72 offen offset:3072 sc1
    v_mov_b32 v9, 1
    v_lshlrev_b32 v216, 20, v1
    s_lshl2_add_u32 s7, s4, s101
    s_add_u32 s7, s7, 163840
    s_waitcnt vmcnt(8)
    buffer_store_dword v9, v216, s[32:35], s7 offen sc1
    s_sub_u32 s78, 14, s6
    s_sub_u32 s78, s78, s6
    s_cmp_eq_u32 s78, 0
    s_cbranch_scc1 K1_LS_END
.p2align 3
K1_LS:
    s_waitcnt lgkmcnt(0)
    v_mfma_f32_16x16x32_bf16 v[240:243], a[224:227], v[136:139], v[176:179]
    s_add_u32 m0, s76, s75
    v_exp_f32 v254, v254
    v_mfma_f32_16x16x32_bf16 v[240:243], a[228:231], v[168:171], v[240:243]
    s_mov_b32 s76, s60
    v_exp_f32 v255, v255
    v_mfma_f32_16x16x32_bf16 v[240:243], a[232:235], v[200:203], v[240:243]
    s_mov_b32 s60, s82
    buffer_load_dwordx4 v1, s[36:39], s77 offen sc1 lds
    v_mfma_f32_16x16x32_bf16 v[240:243], a[236:239], v[232:235], v[240:243]
    s_add_u32 s82, s82, 32768
    ds_read_b128 v[104:107], v2 offset:18432
    v_cvt_pk_bf16_f32 v63, v254, v255
    v_mfma_f32_16x16x32_bf16 a[8:11], v[96:99], v[48:51], a[8:11]
    ds_read_b128 v[108:111], v2 offset:19456
    ds_read_b128 a[240:243], v2 offset:4096
    v_mfma_f32_16x16x32_bf16 a[8:11], v[100:103], v[52:55], a[8:11]
    ds_read_b128 a[244:247], v2 offset:5120
    v_mfma_f32_16x16x32_bf16 a[12:15], v[96:99], v[56:59], a[12:15]
    buffer_load_dwordx4 v1, s[36:39], s77 offen offset:1024 sc1 lds
    v_mfma_f32_16x16x32_bf16 a[12:15], v[100:103], v[60:63], a[12:15]
    ds_read_b128 a[248:251], v2 offset:6144
    ds_read_b128 a[252:255], v2 offset:7168
    v_mfma_f32_16x16x32_bf16 v[244:247], a[224:227], v[140:143], v[156:159]
    v_exp_f32 v240, v240
    v_mfma_f32_16x16x32_bf16 v[244:247], a[228:231], v[172:175], v[244:247]
    ds_read_b128 v[112:115], v2 offset:20480
    ds_read_b128 v[116:119], v2 offset:21504
    v_mfma_f32_16x16x32_bf16 v[244:247], a[232:235], v[204:207], v[244:247]
    v_exp_f32 v241, v241
    v_mfma_f32_16x16x32_bf16 v[244:247], a[236:239], v[236:239], v[244:247]
    s_waitcnt lgkmcnt(4)
    ds_read_b128 v[120:123], v2 offset:22528
    ds_read_b128 v[124:127], v2 offset:23552
    v_mfma_f32_16x16x32_bf16 a[24:27], v[104:107], v[48:51], a[24:27]
    buffer_load_dwordx4 v1, s[36:39], s77 offen offset:2048 sc1 lds
    v_mfma_f32_16x16x32_bf16 a[24:27], v[108:111], v[52:55], a[24:27]
    ds_read_b128 a[224:227], v2 offset:8192
    ds_read_b128 a[228:231], v2 offset:9216
    v_mfma_f32_16x16x32_bf16 a[28:31], v[104:107], v[56:59], a[28:31]
    ds_read_b128 a[232:235], v2 offset:10240
    v_cvt_pk_bf16_f32 v80, v240, v241
    v_mfma_f32_16x16x32_bf16 a[28:31], v[108:111], v[60:63], a[28:31]
    v_exp_f32 v242, v242
    v_mfma_f32_16x16x32_bf16 v[248:251], a[240:243], v[136:139], v[180:183]
    ds_read_b128 a[236:239], v2 offset:11264
    ds_read_b128 v[96:99], v2 offset:24576
    v_mfma_f32_16x16x32_bf16 v[248:251], a[244:247], v[168:171], v[248:251]
    s_waitcnt lgkmcnt(5)
    v_exp_f32 v243, v243
    v_mfma_f32_16x16x32_bf16 v[248:251], a[248:251], v[200:203], v[248:251]
    buffer_load_dwordx4 v1, s[36:39], s77 offen offset:3072 sc1 lds
    v_mfma_f32_16x16x32_bf16 v[248:251], a[252:255], v[232:235], v[248:251]
    ds_read_b128 v[100:103], v2 offset:25600
    v_cvt_pk_bf16_f32 v81, v242, v243
    v_mfma_f32_16x16x32_bf16 a[40:43], v[112:115], v[48:51], a[40:43]
    ds_read_b128 v[104:107], v2 offset:26624
    ds_read_b128 v[108:111], v2 offset:27648
    v_mfma_f32_16x16x32_bf16 a[40:43], v[116:119], v[52:55], a[40:43]
    v_exp_f32 v244, v244
    v_mfma_f32_16x16x32_bf16 a[44:47], v[112:115], v[56:59], a[44:47]
    v_exp_f32 v245, v245
    v_mfma_f32_16x16x32_bf16 a[44:47], v[116:119], v[60:63], a[44:47]
    s_add_u32 s100, s77, 4096
    v_exp_f32 v246, v246
    v_mfma_f32_16x16x32_bf16 v[252:255], a[240:243], v[140:143], v[156:159]
    s_add_u32 m0, m0, 4096
    v_exp_f32 v247, v247
    v_mfma_f32_16x16x32_bf16 v[252:255], a[244:247], v[172:175], v[252:255]
    buffer_load_dwordx4 v1, s[36:39], s100 offen sc1 lds
    v_mfma_f32_16x16x32_bf16 v[252:255], a[248:251], v[204:207], v[252:255]
    v_cvt_pk_bf16_f32 v88, v244, v245
    v_cvt_pk_bf16_f32 v89, v246, v247
    v_mfma_f32_16x16x32_bf16 v[252:255], a[252:255], v[236:239], v[252:255]
    ds_read_b128 a[240:243], v2 offset:12288
    ds_read_b128 a[244:247], v2 offset:13312
    v_mfma_f32_16x16x32_bf16 a[56:59], v[120:123], v[48:51], a[56:59]
    v_exp_f32 v248, v248
    v_mfma_f32_16x16x32_bf16 a[56:59], v[124:127], v[52:55], a[56:59]
    buffer_load_dwordx4 v1, s[36:39], s100 offen offset:1024 sc1 lds
    v_mfma_f32_16x16x32_bf16 a[60:63], v[120:123], v[56:59], a[60:63]
    ds_read_b128 a[248:251], v2 offset:14336
    ds_read_b128 a[252:255], v2 offset:15360
    v_mfma_f32_16x16x32_bf16 a[60:63], v[124:127], v[60:63], a[60:63]
    s_waitcnt lgkmcnt(4)
    v_exp_f32 v249, v249
    v_mfma_f32_16x16x32_bf16 v[240:243], a[224:227], v[136:139], v[184:187]
    ds_read_b128 v[112:115], v2 offset:28672
    ds_read_b128 v[116:119], v2 offset:29696
    v_mfma_f32_16x16x32_bf16 v[240:243], a[228:231], v[168:171], v[240:243]
    v_exp_f32 v250, v250
    v_mfma_f32_16x16x32_bf16 v[240:243], a[232:235], v[200:203], v[240:243]
    v_exp_f32 v251, v251
    v_mfma_f32_16x16x32_bf16 v[240:243], a[236:239], v[232:235], v[240:243]
    buffer_load_dwordx4 v1, s[36:39], s100 offen offset:2048 sc1 lds
    v_mfma_f32_16x16x32_bf16 a[152:155], v[96:99], v[48:51], a[152:155]
    v_cvt_pk_bf16_f32 v82, v248, v249
    v_cvt_pk_bf16_f32 v83, v250, v251
    v_mfma_f32_16x16x32_bf16 a[152:155], v[100:103], v[52:55], a[152:155]
    ds_read_b128 v[120:123], v2 offset:30720
    ds_read_b128 v[124:127], v2 offset:31744
    v_mfma_f32_16x16x32_bf16 a[156:159], v[96:99], v[56:59], a[156:159]
    v_exp_f32 v252, v252
    v_mfma_f32_16x16x32_bf16 a[156:159], v[100:103], v[60:63], a[156:159]
    v_exp_f32 v253, v253
    v_mfma_f32_16x16x32_bf16 v[244:247], a[224:227], v[140:143], v[156:159]
    v_exp_f32 v254, v254
    v_mfma_f32_16x16x32_bf16 v[244:247], a[228:231], v[172:175], v[244:247]
    buffer_load_dwordx4 v1, s[36:39], s100 offen offset:3072 sc1 lds
    v_mfma_f32_16x16x32_bf16 v[244:247], a[232:235], v[204:207], v[244:247]
    v_exp_f32 v255, v255
    v_mfma_f32_16x16x32_bf16 v[244:247], a[236:239], v[236:239], v[244:247]
    s_cmp_eq_u32 s82, 163840
    s_cselect_b32 s82, 0, s82
    v_cvt_pk_bf16_f32 v90, v252, v253
    v_mfma_f32_16x16x32_bf16 a[168:171], v[104:107], v[48:51], a[168:171]
    v_cvt_pk_bf16_f32 v91, v254, v255
    v_add_u32 v2, s82, v1
    v_mfma_f32_16x16x32_bf16 a[168:171], v[108:111], v[52:55], a[168:171]
    ds_read_b128 a[224:227], v2 offset:0
    ds_read_b128 a[228:231], v2 offset:1024
    v_mfma_f32_16x16x32_bf16 a[172:175], v[104:107], v[56:59], a[172:175]
    s_add_u32 s77, s77, 32768
    v_exp_f32 v240, v240
    v_mfma_f32_16x16x32_bf16 a[172:175], v[108:111], v[60:63], a[172:175]
    s_waitcnt lgkmcnt(2)
    ds_read_b128 a[232:235], v2 offset:2048
    ds_read_b128 a[236:239], v2 offset:3072
    v_mfma_f32_16x16x32_bf16 v[248:251], a[240:243], v[136:139], v[188:191]
    v_exp_f32 v241, v241
    v_mfma_f32_16x16x32_bf16 v[248:251], a[244:247], v[168:171], v[248:251]
    ds_read_b128 v[96:99], v2 offset:16384
    ds_read_b128 v[100:103], v2 offset:17408
    v_mfma_f32_16x16x32_bf16 v[248:251], a[248:251], v[200:203], v[248:251]
    v_exp_f32 v242, v242
    v_mfma_f32_16x16x32_bf16 v[248:251], a[252:255], v[232:235], v[248:251]
    v_exp_f32 v243, v243
    v_mfma_f32_16x16x32_bf16 a[184:187], v[112:115], v[48:51], a[184:187]
    v_exp_f32 v244, v244
    v_mfma_f32_16x16x32_bf16 a[184:187], v[116:119], v[52:55], a[184:187]
    v_exp_f32 v245, v245
    v_mfma_f32_16x16x32_bf16 a[188:191], v[112:115], v[56:59], a[188:191]
    v_exp_f32 v246, v246
    v_mfma_f32_16x16x32_bf16 a[188:191], v[116:119], v[60:63], a[188:191]
    v_exp_f32 v247, v247
    v_mfma_f32_16x16x32_bf16 v[252:255], a[240:243], v[140:143], v[156:159]
    v_exp_f32 v248, v248
    v_mfma_f32_16x16x32_bf16 v[252:255], a[244:247], v[172:175], v[252:255]
    v_exp_f32 v249, v249
    v_mfma_f32_16x16x32_bf16 v[252:255], a[248:251], v[204:207], v[252:255]
    v_exp_f32 v250, v250
    v_mfma_f32_16x16x32_bf16 v[252:255], a[252:255], v[236:239], v[252:255]
    v_exp_f32 v251, v251
    v_mfma_f32_16x16x32_bf16 a[200:203], v[120:123], v[48:51], a[200:203]
    v_cvt_pk_bf16_f32 v84, v240, v241
    v_cvt_pk_bf16_f32 v85, v242, v243
    v_mfma_f32_16x16x32_bf16 a[200:203], v[124:127], v[52:55], a[200:203]
    v_cvt_pk_bf16_f32 v92, v244, v245
    v_cvt_pk_bf16_f32 v93, v246, v247
    v_mfma_f32_16x16x32_bf16 a[204:207], v[120:123], v[56:59], a[204:207]
    v_exp_f32 v252, v252
    v_mfma_f32_16x16x32_bf16 a[204:207], v[124:127], v[60:63], a[204:207]
    v_exp_f32 v253, v253
    v_mfma_f32_16x16x32_bf16 a[216:219], a[136:139], v[48:51], a[216:219]
    v_cvt_pk_bf16_f32 v86, v248, v249
    v_cvt_pk_bf16_f32 v87, v250, v251
    v_mfma_f32_16x16x32_bf16 a[216:219], a[136:139], v[52:55], a[216:219]
    v_cvt_pk_bf16_f32 v94, v252, v253
    v_mfma_f32_16x16x32_bf16 a[220:223], a[136:139], v[56:59], a[220:223]
    v_mfma_f32_16x16x32_bf16 a[220:223], a[136:139], v[60:63], a[220:223]
    s_cmp_le_u32 s78, 2
    s_cbranch_scc1 K1_LS_MASK
K1_LS_BACK:
    s_waitcnt lgkmcnt(0)
    v_mfma_f32_16x16x32_bf16 v[240:243], a[224:227], v[136:139], v[176:179]
    s_add_u32 m0, s76, s75
    v_exp_f32 v254, v254
    v_mfma_f32_16x16x32_bf16 v[240:243], a[228:231], v[168:171], v[240:243]
    s_mov_b32 s76, s60
    v_exp_f32 v255, v255
    v_mfma_f32_16x16x32_bf16 v[240:243], a[232:235], v[200:203], v[240:243]
    s_mov_b32 s60, s82
    buffer_load_dwordx4 v1, s[36:39], s77 offen sc1 lds
    v_mfma_f32_16x16x32_bf16 v[240:243], a[236:239], v[232:235], v[240:243]
    s_add_u32 s82, s82, 32768
    ds_read_b128 v[104:107], v2 offset:18432
    v_cvt_pk_bf16_f32 v95, v254, v255
    v_mfma_f32_16x16x32_bf16 a[8:11], v[96:99], v[80:83], a[8:11]
    ds_read_b128 v[108:111], v2 offset:19456
    ds_read_b128 a[240:243], v2 offset:4096
    v_mfma_f32_16x16x32_bf16 a[8:11], v[100:103], v[84:87], a[8:11]
    ds_read_b128 a[244:247], v2 offset:5120
    v_mfma_f32_16x16x32_bf16 a[12:15], v[96:99], v[88:91], a[12:15]
    buffer_load_dwordx4 v1, s[36:39], s77 offen offset:1024 sc1 lds
    v_mfma_f32_16x16x32_bf16 a[12:15], v[100:103], v[92:95], a[12:15]
    ds_read_b128 a[248:251], v2 offset:6144
    ds_read_b128 a[252:255], v2 offset:7168
    v_mfma_f32_16x16x32_bf16 v[244:247], a[224:227], v[140:143], v[156:159]
    v_exp_f32 v240, v240
    v_mfma_f32_16x16x32_bf16 v[244:247], a[228:231], v[172:175], v[244:247]
    ds_read_b128 v[112:115], v2 offset:20480
    ds_read_b128 v[116:119], v2 offset:21504
    v_mfma_f32_16x16x32_bf16 v[244:247], a[232:235], v[204:207], v[244:247]
    v_exp_f32 v241, v241
    v_mfma_f32_16x16x32_bf16 v[244:247], a[236:239], v[236:239], v[244:247]
    s_waitcnt lgkmcnt(4)
    ds_read_b128 v[120:123], v2 offset:22528
    ds_read_b128 v[124:127], v2 offset:23552
    v_mfma_f32_16x16x32_bf16 a[24:27], v[104:107], v[80:83], a[24:27]
    buffer_load_dwordx4 v1, s[36:39], s77 offen offset:2048 sc1 lds
    v_mfma_f32_16x16x32_bf16 a[24:27], v[108:111], v[84:87], a[24:27]
    ds_read_b128 a[224:227], v2 offset:8192
    ds_read_b128 a[228:231], v2 offset:9216
    v_mfma_f32_16x16x32_bf16 a[28:31], v[104:107], v[88:91], a[28:31]
    ds_read_b128 a[232:235], v2 offset:10240
    v_cvt_pk_bf16_f32 v48, v240, v241
    v_mfma_f32_16x16x32_bf16 a[28:31], v[108:111], v[92:95], a[28:31]
    v_exp_f32 v242, v242
    v_mfma_f32_16x16x32_bf16 v[248:251], a[240:243], v[136:139], v[180:183]
    ds_read_b128 a[236:239], v2 offset:11264
    ds_read_b128 v[96:99], v2 offset:24576
    v_mfma_f32_16x16x32_bf16 v[248:251], a[244:247], v[168:171], v[248:251]
    s_waitcnt lgkmcnt(5)
    v_exp_f32 v243, v243
    v_mfma_f32_16x16x32_bf16 v[248:251], a[248:251], v[200:203], v[248:251]
    buffer_load_dwordx4 v1, s[36:39], s77 offen offset:3072 sc1 lds
    v_mfma_f32_16x16x32_bf16 v[248:251], a[252:255], v[232:235], v[248:251]
    ds_read_b128 v[100:103], v2 offset:25600
    v_cvt_pk_bf16_f32 v49, v242, v243
    v_mfma_f32_16x16x32_bf16 a[40:43], v[112:115], v[80:83], a[40:43]
    ds_read_b128 v[104:107], v2 offset:26624
    ds_read_b128 v[108:111], v2 offset:27648
    v_mfma_f32_16x16x32_bf16 a[40:43], v[116:119], v[84:87], a[40:43]
    v_exp_f32 v244, v244
    v_mfma_f32_16x16x32_bf16 a[44:47], v[112:115], v[88:91], a[44:47]
    v_exp_f32 v245, v245
    v_mfma_f32_16x16x32_bf16 a[44:47], v[116:119], v[92:95], a[44:47]
    s_add_u32 s100, s77, 4096
    v_exp_f32 v246, v246
    v_mfma_f32_16x16x32_bf16 v[252:255], a[240:243], v[140:143], v[156:159]
    s_add_u32 m0, m0, 4096
    v_exp_f32 v247, v247
    v_mfma_f32_16x16x32_bf16 v[252:255], a[244:247], v[172:175], v[252:255]
    buffer_load_dwordx4 v1, s[36:39], s100 offen sc1 lds
    v_mfma_f32_16x16x32_bf16 v[252:255], a[248:251], v[204:207], v[252:255]
    v_cvt_pk_bf16_f32 v56, v244, v245
    v_cvt_pk_bf16_f32 v57, v246, v247
    v_mfma_f32_16x16x32_bf16 v[252:255], a[252:255], v[236:239], v[252:255]
    ds_read_b128 a[240:243], v2 offset:12288
    ds_read_b128 a[244:247], v2 offset:13312
    v_mfma_f32_16x16x32_bf16 a[56:59], v[120:123], v[80:83], a[56:59]
    v_exp_f32 v248, v248
    v_mfma_f32_16x16x32_bf16 a[56:59], v[124:127], v[84:87], a[56:59]
    buffer_load_dwordx4 v1, s[36:39], s100 offen offset:1024 sc1 lds
    v_mfma_f32_16x16x32_bf16 a[60:63], v[120:123], v[88:91], a[60:63]
    ds_read_b128 a[248:251], v2 offset:14336
    ds_read_b128 a[252:255], v2 offset:15360
    v_mfma_f32_16x16x32_bf16 a[60:63], v[124:127], v[92:95], a[60:63]
    s_waitcnt lgkmcnt(4)
    v_exp_f32 v249, v249
    v_mfma_f32_16x16x32_bf16 v[240:243], a[224:227], v[136:139], v[184:187]
    ds_read_b128 v[112:115], v2 offset:28672
    ds_read_b128 v[116:119], v2 offset:29696
    v_mfma_f32_16x16x32_bf16 v[240:243], a[228:231], v[168:171], v[240:243]
    v_exp_f32 v250, v250
    v_mfma_f32_16x16x32_bf16 v[240:243], a[232:235], v[200:203], v[240:243]
    v_exp_f32 v251, v251
    v_mfma_f32_16x16x32_bf16 v[240:243], a[236:239], v[232:235], v[240:243]
    buffer_load_dwordx4 v1, s[36:39], s100 offen offset:2048 sc1 lds
    v_mfma_f32_16x16x32_bf16 a[152:155], v[96:99], v[80:83], a[152:155]
    v_cvt_pk_bf16_f32 v50, v248, v249
    v_cvt_pk_bf16_f32 v51, v250, v251
    v_mfma_f32_16x16x32_bf16 a[152:155], v[100:103], v[84:87], a[152:155]
    ds_read_b128 v[120:123], v2 offset:30720
    ds_read_b128 v[124:127], v2 offset:31744
    v_mfma_f32_16x16x32_bf16 a[156:159], v[96:99], v[88:91], a[156:159]
    v_exp_f32 v252, v252
    v_mfma_f32_16x16x32_bf16 a[156:159], v[100:103], v[92:95], a[156:159]
    v_exp_f32 v253, v253
    v_mfma_f32_16x16x32_bf16 v[244:247], a[224:227], v[140:143], v[156:159]
    v_exp_f32 v254, v254
    v_mfma_f32_16x16x32_bf16 v[244:247], a[228:231], v[172:175], v[244:247]
    buffer_load_dwordx4 v1, s[36:39], s100 offen offset:3072 sc1 lds
    v_mfma_f32_16x16x32_bf16 v[244:247], a[232:235], v[204:207], v[244:247]
    v_exp_f32 v255, v255
    v_mfma_f32_16x16x32_bf16 v[244:247], a[236:239], v[236:239], v[244:247]
    s_cmp_eq_u32 s82, 163840
    s_cselect_b32 s82, 0, s82
    v_cvt_pk_bf16_f32 v58, v252, v253
    v_mfma_f32_16x16x32_bf16 a[168:171], v[104:107], v[80:83], a[168:171]
    v_cvt_pk_bf16_f32 v59, v254, v255
    v_add_u32 v2, s82, v1
    v_mfma_f32_16x16x32_bf16 a[168:171], v[108:111], v[84:87], a[168:171]
    v_exp_f32 v240, v240
    v_mfma_f32_16x16x32_bf16 a[172:175], v[104:107], v[88:91], a[172:175]
    s_add_u32 s77, s77, 32768
    v_exp_f32 v241, v241
    v_mfma_f32_16x16x32_bf16 a[172:175], v[108:111], v[92:95], a[172:175]
    s_waitcnt lgkmcnt(0)
    v_exp_f32 v242, v242
    v_mfma_f32_16x16x32_bf16 v[248:251], a[240:243], v[136:139], v[188:191]
    v_exp_f32 v243, v243
    v_mfma_f32_16x16x32_bf16 v[248:251], a[244:247], v[168:171], v[248:251]
    v_exp_f32 v244, v244
    v_mfma_f32_16x16x32_bf16 v[248:251], a[248:251], v[200:203], v[248:251]
    v_exp_f32 v245, v245
    v_mfma_f32_16x16x32_bf16 v[248:251], a[252:255], v[232:235], v[248:251]
    v_exp_f32 v246, v246
    v_mfma_f32_16x16x32_bf16 a[184:187], v[112:115], v[80:83], a[184:187]
    v_exp_f32 v247, v247
    v_mfma_f32_16x16x32_bf16 a[184:187], v[116:119], v[84:87], a[184:187]
    v_cvt_pk_bf16_f32 v52, v240, v241
    v_cvt_pk_bf16_f32 v53, v242, v243
    v_mfma_f32_16x16x32_bf16 a[188:191], v[112:115], v[88:91], a[188:191]
    v_cvt_pk_bf16_f32 v60, v244, v245
    v_cvt_pk_bf16_f32 v61, v246, v247
    v_mfma_f32_16x16x32_bf16 a[188:191], v[116:119], v[92:95], a[188:191]
    s_waitcnt vmcnt(8) lgkmcnt(0)
    s_barrier
    ds_read_b128 a[224:227], v2 offset:0
    v_mfma_f32_16x16x32_bf16 v[252:255], a[240:243], v[140:143], v[156:159]
    ds_read_b128 a[228:231], v2 offset:1024
    ds_read_b128 a[232:235], v2 offset:2048
    v_mfma_f32_16x16x32_bf16 v[252:255], a[244:247], v[172:175], v[252:255]
    v_exp_f32 v248, v248
    v_mfma_f32_16x16x32_bf16 v[252:255], a[248:251], v[204:207], v[252:255]
    ds_read_b128 a[236:239], v2 offset:3072
    ds_read_b128 v[96:99], v2 offset:16384
    v_mfma_f32_16x16x32_bf16 v[252:255], a[252:255], v[236:239], v[252:255]
    v_exp_f32 v249, v249
    v_mfma_f32_16x16x32_bf16 a[200:203], v[120:123], v[80:83], a[200:203]
    ds_read_b128 v[100:103], v2 offset:17408
    v_cvt_pk_bf16_f32 v54, v248, v249
    v_mfma_f32_16x16x32_bf16 a[200:203], v[124:127], v[84:87], a[200:203]
    v_exp_f32 v250, v250
    v_mfma_f32_16x16x32_bf16 a[204:207], v[120:123], v[88:91], a[204:207]
    v_exp_f32 v251, v251
    v_mfma_f32_16x16x32_bf16 a[204:207], v[124:127], v[92:95], a[204:207]
    v_exp_f32 v252, v252
    v_mfma_f32_16x16x32_bf16 a[216:219], a[136:139], v[80:83], a[216:219]
    v_exp_f32 v253, v253
    v_mfma_f32_16x16x32_bf16 a[216:219], a[136:139], v[84:87], a[216:219]
    v_cvt_pk_bf16_f32 v55, v250, v251
    v_cvt_pk_bf16_f32 v62, v252, v253
    v_mfma_f32_16x16x32_bf16 a[220:223], a[136:139], v[88:91], a[220:223]
    v_mfma_f32_16x16x32_bf16 a[220:223], a[136:139], v[92:95], a[220:223]
    s_sub_u32 s78, s78, 1
    s_cmp_lg_u32 s78, 0
    s_cbranch_scc1 K1_LS
K1_LS_END:
    v_add_f32 v212, s12, v156
    v_fma_f32 v176, v208, s8, v212
    v_fma_f32 v177, v209, s8, v212
    v_fma_f32 v178, v210, s8, v212
    v_fma_f32 v179, v211, s8, v212
    s_nop 1
    s_waitcnt lgkmcnt(0)
    v_mfma_f32_16x16x32_bf16 v[240:243], a[224:227], v[140:143], v[176:179]
    s_xor_b32 s21, s3, 1
    s_lshl2_add_u32 s21, s21, s4
    ds_read_b128 v[104:107], v2 offset:18432
    v_mfma_f32_16x16x32_bf16 v[240:243], a[228:231], v[172:175], v[240:243]
    s_mul_i32 s21, s21, 36864
    ds_read_b128 v[108:111], v2 offset:19456
    ds_read_b128 a[240:243], v2 offset:4096
    v_mfma_f32_16x16x32_bf16 v[240:243], a[232:235], v[204:207], v[240:243]
    s_add_u32 s21, s21, s28
    s_mov_b32 m0, s45
    ds_read_b128 a[244:247], v2 offset:5120
    v_mfma_f32_16x16x32_bf16 v[240:243], a[236:239], v[236:239], v[240:243]
    s_mul_i32 s86, s4, 34
    buffer_load_dwordx4 v1, s[56:59], s21 offen sc1 lds
    v_mfma_f32_16x16x32_bf16 a[8:11], v[96:99], v[48:51], a[8:11]
    s_add_u32 s86, s86, 8
    v_exp_f32 v254, v254
    v_mfma_f32_16x16x32_bf16 a[8:11], v[100:103], v[52:55], a[8:11]
    s_mov_b32 s76, s60
    v_exp_f32 v255, v255
    v_mfma_f32_16x16x32_bf16 a[12:15], v[96:99], v[56:59], a[12:15]
    s_mov_b32 s60, s82
    v_cvt_pk_bf16_f32 v63, v254, v255
    ds_read_b128 a[248:251], v2 offset:6144
    s_nop 0
    v_mfma_f32_16x16x32_bf16 a[12:15], v[100:103], v[60:63], a[12:15]
    s_add_u32 s82, s82, 32768
    v_lshrrev_b32 v28, 4, v1
    ds_read_b128 a[252:255], v2 offset:7168
    s_waitcnt lgkmcnt(2)
    v_mfma_f32_16x16x32_bf16 a[24:27], v[104:107], v[48:51], a[24:27]
    s_and_b32 s62, s5, 4
    v_min_u32 v28, 33, v28
    ds_read_b128 v[112:115], v2 offset:20480
    v_mfma_f32_16x16x32_bf16 a[24:27], v[108:111], v[52:55], a[24:27]
    s_lshl_b32 s63, s3, 12
    buffer_load_dwordx4 v1, s[56:59], s21 offen offset:1024 sc1 lds
    v_mfma_f32_16x16x32_bf16 a[28:31], v[104:107], v[56:59], a[28:31]
    s_sub_u32 s19, s74, s101
    v_add_lshl_u32 v28, v28, s86, 7
    v_add_f32 v213, s13, v156
    v_mfma_f32_16x16x32_bf16 a[28:31], v[108:111], v[60:63], a[28:31]
    s_getpc_b64 s[86:87]
    global_load_dword v28, v28, s[86:87]
    v_fma_f32 v180, v208, s9, v213
    v_fma_f32 v181, v209, s9, v213
    v_fma_f32 v182, v210, s9, v213
    v_fma_f32 v183, v211, s9, v213
    s_nop 1
    v_mfma_f32_16x16x32_bf16 v[244:247], a[240:243], v[140:143], v[180:183]
    s_add_u32 s62, s62, s4
    ds_read_b128 v[116:119], v2 offset:21504
    ds_read_b128 v[120:123], v2 offset:22528
    v_mfma_f32_16x16x32_bf16 v[244:247], a[244:247], v[172:175], v[244:247]
    s_mov_b32 s20, s63
    ds_read_b128 v[124:127], v2 offset:23552
    v_add_f32 v214, s14, v156
    s_waitcnt lgkmcnt(3)
    v_mfma_f32_16x16x32_bf16 v[244:247], a[248:251], v[204:207], v[244:247]
    s_add_u32 s19, s66, s19
    buffer_load_dwordx4 v1, s[56:59], s21 offen offset:2048 sc1 lds
    v_mfma_f32_16x16x32_bf16 v[244:247], a[252:255], v[236:239], v[244:247]
    s_mov_b32 s50, 9437184
    ds_read_b128 a[224:227], v2 offset:8192
    ds_read_b128 a[228:231], v2 offset:9216
    v_mfma_f32_16x16x32_bf16 a[40:43], v[112:115], v[48:51], a[40:43]
    s_waitcnt lgkmcnt(4)
    ds_read_b128 a[232:235], v2 offset:10240
    v_fma_f32 v184, v208, s10, v214
    v_mfma_f32_16x16x32_bf16 a[40:43], v[116:119], v[52:55], a[40:43]
    ds_read_b128 a[236:239], v2 offset:11264
    v_fma_f32 v185, v209, s10, v214
    v_mfma_f32_16x16x32_bf16 a[44:47], v[112:115], v[56:59], a[44:47]
    ds_read_b128 v[96:99], v2 offset:24576
    v_fma_f32 v186, v210, s10, v214
    v_mfma_f32_16x16x32_bf16 a[44:47], v[116:119], v[60:63], a[44:47]
    s_waitcnt lgkmcnt(5)
    ds_read_b128 v[100:103], v2 offset:25600
    v_fma_f32 v187, v211, s10, v214
    v_mfma_f32_16x16x32_bf16 a[56:59], v[120:123], v[48:51], a[56:59]
    buffer_load_dwordx4 v1, s[56:59], s21 offen offset:3072 sc1 lds
    v_mfma_f32_16x16x32_bf16 a[56:59], v[124:127], v[52:55], a[56:59]
    s_add_u32 s21, s21, 4096
    ds_read_b128 v[104:107], v2 offset:26624
    ds_read_b128 v[108:111], v2 offset:27648
    v_mfma_f32_16x16x32_bf16 a[60:63], v[120:123], v[56:59], a[60:63]
    s_add_u32 m0, s45, 4096
    ds_read_b128 a[240:243], v2 offset:12288
    v_add_f32 v215, s15, v156
    v_mfma_f32_16x16x32_bf16 a[60:63], v[124:127], v[60:63], a[60:63]
    s_waitcnt lgkmcnt(4)
    ds_read_b128 a[244:247], v2 offset:13312
    v_fma_f32 v188, v208, s11, v215
    v_mfma_f32_16x16x32_bf16 v[248:251], a[224:227], v[140:143], v[184:187]
    ds_read_b128 a[248:251], v2 offset:14336
    v_fma_f32 v189, v209, s11, v215
    v_mfma_f32_16x16x32_bf16 v[248:251], a[228:231], v[172:175], v[248:251]
    ds_read_b128 a[252:255], v2 offset:15360
    v_fma_f32 v190, v210, s11, v215
    v_mfma_f32_16x16x32_bf16 v[248:251], a[232:235], v[204:207], v[248:251]
    buffer_load_dwordx4 v1, s[56:59], s21 offen sc1 lds
    v_mfma_f32_16x16x32_bf16 v[248:251], a[236:239], v[236:239], v[248:251]
    ds_read_b128 v[112:115], v2 offset:28672
    ds_read_b128 v[116:119], v2 offset:29696
    v_mfma_f32_16x16x32_bf16 a[152:155], v[96:99], v[48:51], a[152:155]
    s_waitcnt lgkmcnt(4)
    v_fma_f32 v191, v211, s11, v215
    ds_read_b128 v[120:123], v2 offset:30720
    v_mfma_f32_16x16x32_bf16 a[152:155], v[100:103], v[52:55], a[152:155]
    ds_read_b128 v[124:127], v2 offset:31744
    v_bfe_u32 v217, v1, 4, 3
    v_mfma_f32_16x16x32_bf16 a[156:159], v[96:99], v[56:59], a[156:159]
    s_cmp_eq_u32 s82, 163840
    s_cselect_b32 s82, 0, s82
    v_add_u32 v2, s82, v1
    v_mfma_f32_16x16x32_bf16 a[156:159], v[100:103], v[60:63], a[156:159]
    ds_read_b128 v[96:99], v2 offset:16384
    ds_read_b128 v[100:103], v2 offset:17408
    v_mfma_f32_16x16x32_bf16 a[168:171], v[104:107], v[48:51], a[168:171]
    buffer_load_dwordx4 v1, s[56:59], s21 offen offset:1024 sc1 lds
    v_mfma_f32_16x16x32_bf16 a[168:171], v[108:111], v[52:55], a[168:171]
    v_exp_f32 v240, v240
    v_mfma_f32_16x16x32_bf16 a[172:175], v[104:107], v[56:59], a[172:175]
    ds_read_b128 v[104:107], v2 offset:18432
    v_lshlrev_b32 v217, 7, v217
    v_mfma_f32_16x16x32_bf16 a[172:175], v[108:111], v[60:63], a[172:175]
    v_exp_f32 v241, v241
    v_mfma_f32_16x16x32_bf16 v[252:255], a[240:243], v[140:143], v[188:191]
    ds_read_b128 v[108:111], v2 offset:19456
    v_cvt_pk_bf16_f32 v88, v240, v241
    v_mfma_f32_16x16x32_bf16 v[252:255], a[244:247], v[172:175], v[252:255]
    s_waitcnt lgkmcnt(2)
    v_exp_f32 v242, v242
    v_mfma_f32_16x16x32_bf16 v[252:255], a[248:251], v[204:207], v[252:255]
    buffer_load_dwordx4 v1, s[56:59], s21 offen offset:2048 sc1 lds
    v_mfma_f32_16x16x32_bf16 v[252:255], a[252:255], v[236:239], v[252:255]
    v_exp_f32 v243, v243
    v_mfma_f32_16x16x32_bf16 a[184:187], v[112:115], v[48:51], a[184:187]
    v_exp_f32 v244, v244
    v_mfma_f32_16x16x32_bf16 a[184:187], v[116:119], v[52:55], a[184:187]
    v_exp_f32 v245, v245
    v_mfma_f32_16x16x32_bf16 a[188:191], v[112:115], v[56:59], a[188:191]
    ds_read_b128 v[112:115], v2 offset:20480
    v_cvt_pk_bf16_f32 v89, v242, v243
    v_mfma_f32_16x16x32_bf16 a[188:191], v[116:119], v[60:63], a[188:191]
    v_exp_f32 v246, v246
    v_mfma_f32_16x16x32_bf16 a[200:203], v[120:123], v[48:51], a[200:203]
    v_exp_f32 v247, v247
    v_mfma_f32_16x16x32_bf16 a[200:203], v[124:127], v[52:55], a[200:203]
    v_exp_f32 v248, v248
    v_mfma_f32_16x16x32_bf16 a[204:207], v[120:123], v[56:59], a[204:207]
    v_exp_f32 v249, v249
    v_mfma_f32_16x16x32_bf16 a[204:207], v[124:127], v[60:63], a[204:207]
    v_exp_f32 v250, v250
    v_mfma_f32_16x16x32_bf16 a[216:219], a[136:139], v[48:51], a[216:219]
    v_exp_f32 v251, v251
    v_mfma_f32_16x16x32_bf16 a[216:219], a[136:139], v[52:55], a[216:219]
    v_exp_f32 v252, v252
    v_mfma_f32_16x16x32_bf16 a[220:223], a[136:139], v[56:59], a[220:223]
    s_add_u32 s48, s32, 1048576
    s_addc_u32 s49, s33, 0
    ds_read_b128 v[116:119], v2 offset:21504
    v_mfma_f32_16x16x32_bf16 a[220:223], a[136:139], v[60:63], a[220:223]
    v_exp_f32 v253, v253
    v_cvt_pk_bf16_f32 v90, v244, v245
    v_cvt_pk_bf16_f32 v91, v246, v247
    v_cvt_pk_bf16_f32 v92, v248, v249
    v_cvt_pk_bf16_f32 v93, v250, v251
    v_cvt_pk_bf16_f32 v94, v252, v253
    s_cmp_eq_u32 s6, 7
    s_cbranch_scc1 K1_S7
K1_S7_BACK:
    s_waitcnt lgkmcnt(0)
    v_mfma_f32_16x16x32_bf16 a[12:15], v[96:99], v[88:91], a[12:15]
    v_exp_f32 v254, v254
    v_exp_f32 v255, v255
    s_nop 0
    v_cvt_pk_bf16_f32 v95, v254, v255
    s_nop 1
    v_mfma_f32_16x16x32_bf16 a[12:15], v[100:103], v[92:95], a[12:15]
    ds_read_b128 v[120:123], v2 offset:22528
    ds_read_b128 v[124:127], v2 offset:23552
    v_accvgpr_read_b32 v9, a216
    v_rcp_f32 v10, v9
    v_mfma_f32_16x16x32_bf16 a[28:31], v[104:107], v[88:91], a[28:31]
    ds_read_b128 v[96:99], v2 offset:24576
    v_mul_f32 v10, v10, v6
    v_accvgpr_read_b32 v12, a8
    v_accvgpr_read_b32 v13, a9
    v_accvgpr_read_b32 v14, a10
    v_mfma_f32_16x16x32_bf16 a[28:31], v[108:111], v[92:95], a[28:31]
    ds_read_b128 v[100:103], v2 offset:25600
    v_accvgpr_read_b32 v15, a11
    v_accvgpr_read_b32 v16, a24
    v_accvgpr_read_b32 v17, a25
    v_accvgpr_read_b32 v18, a26
    v_mfma_f32_16x16x32_bf16 a[44:47], v[112:115], v[88:91], a[44:47]
    ds_read_b128 v[104:107], v2 offset:26624
    v_accvgpr_read_b32 v19, a27
    v_accvgpr_read_b32 v20, a40
    v_accvgpr_read_b32 v21, a41
    v_accvgpr_read_b32 v22, a42
    v_mfma_f32_16x16x32_bf16 a[44:47], v[116:119], v[92:95], a[44:47]
    s_waitcnt lgkmcnt(4)
    ds_read_b128 v[108:111], v2 offset:27648
    v_accvgpr_read_b32 v23, a43
    v_accvgpr_read_b32 v24, a56
    v_accvgpr_read_b32 v25, a57
    v_accvgpr_read_b32 v26, a58
    v_mfma_f32_16x16x32_bf16 a[60:63], v[120:123], v[88:91], a[60:63]
    s_waitcnt lgkmcnt(3)
    ds_read_b128 v[112:115], v2 offset:28672
    v_accvgpr_read_b32 v27, a59
    v_mul_f32 v12, v10, v12
    v_mul_f32 v13, v10, v13
    v_mul_f32 v14, v10, v14
    v_mfma_f32_16x16x32_bf16 a[60:63], v[124:127], v[92:95], a[60:63]
    ds_read_b128 v[116:119], v2 offset:29696
    v_mul_f32 v15, v10, v15
    v_mul_f32 v16, v10, v16
    v_mul_f32 v17, v10, v17
    v_mul_f32 v18, v10, v18
    v_mfma_f32_16x16x32_bf16 a[156:159], v[96:99], v[88:91], a[156:159]
    s_waitcnt lgkmcnt(3)
    ds_read_b128 v[120:123], v2 offset:30720
    v_mul_f32 v19, v10, v19
    v_mul_f32 v20, v10, v20
    v_mul_f32 v21, v10, v21
    v_mul_f32 v22, v10, v22
    v_mfma_f32_16x16x32_bf16 a[156:159], v[100:103], v[92:95], a[156:159]
    ds_read_b128 v[124:127], v2 offset:31744
    v_mul_f32 v23, v10, v23
    v_mul_f32 v24, v10, v24
    v_mul_f32 v25, v10, v25
    v_mul_f32 v26, v10, v26
    v_mfma_f32_16x16x32_bf16 a[172:175], v[104:107], v[88:91], a[172:175]
    s_waitcnt lgkmcnt(3)
    v_mul_f32 v27, v10, v27
    v_cvt_pk_bf16_f32 v12, v12, v13
    v_cvt_pk_bf16_f32 v13, v14, v15
    v_cvt_pk_bf16_f32 v14, v16, v17
    v_cvt_pk_bf16_f32 v15, v18, v19
    v_mfma_f32_16x16x32_bf16 a[172:175], v[108:111], v[92:95], a[172:175]
    v_cvt_pk_bf16_f32 v20, v20, v21
    v_cvt_pk_bf16_f32 v21, v22, v23
    v_cvt_pk_bf16_f32 v22, v24, v25
    v_cvt_pk_bf16_f32 v23, v26, v27
    v_accvgpr_read_b32 v16, a168
    v_mfma_f32_16x16x32_bf16 a[188:191], v[112:115], v[88:91], a[188:191]
    s_waitcnt lgkmcnt(1)
    buffer_store_dwordx4 v[12:15], v1, s[40:43], s81 offen offset:0 sc1
    buffer_store_dwordx4 v[20:23], v1, s[40:43], s81 offen offset:1024 sc1
    v_accvgpr_read_b32 v17, a169
    v_mfma_f32_16x16x32_bf16 a[188:191], v[116:119], v[92:95], a[188:191]
    v_accvgpr_read_b32 v12, a152
    v_accvgpr_read_b32 v13, a153
    v_accvgpr_read_b32 v14, a154
    v_accvgpr_read_b32 v15, a155
    v_accvgpr_read_b32 v18, a170
    v_mfma_f32_16x16x32_bf16 a[204:207], v[120:123], v[88:91], a[204:207]
    s_waitcnt lgkmcnt(0)
    v_accvgpr_read_b32 v19, a171
    v_accvgpr_read_b32 v20, a184
    v_accvgpr_read_b32 v21, a185
    v_accvgpr_read_b32 v22, a186
    v_accvgpr_read_b32 v23, a187
    v_mfma_f32_16x16x32_bf16 a[204:207], v[124:127], v[92:95], a[204:207]
    v_accvgpr_read_b32 v24, a200
    v_accvgpr_read_b32 v25, a201
    v_accvgpr_read_b32 v26, a202
    v_accvgpr_read_b32 v27, a203
    v_mul_f32 v12, v10, v12
    v_mfma_f32_16x16x32_bf16 a[220:223], a[136:139], v[88:91], a[220:223]
    v_mul_f32 v13, v10, v13
    v_mul_f32 v14, v10, v14
    v_mul_f32 v15, v10, v15
    v_mul_f32 v16, v10, v16
    v_mul_f32 v17, v10, v17
    v_mfma_f32_16x16x32_bf16 a[220:223], a[136:139], v[92:95], a[220:223]
    v_mul_f32 v18, v10, v18
    v_mul_f32 v19, v10, v19
    v_mul_f32 v20, v10, v20
    v_mul_f32 v21, v10, v21
    v_mul_f32 v22, v10, v22
    v_mul_f32 v23, v10, v23
    v_mul_f32 v24, v10, v24
    v_mul_f32 v25, v10, v25
    v_mul_f32 v26, v10, v26
    v_mul_f32 v27, v10, v27
    v_cmp_nge_f32 vcc, 0x71800000, v9
    v_cvt_pk_bf16_f32 v12, v12, v13
    v_cvt_pk_bf16_f32 v13, v14, v15
    v_cvt_pk_bf16_f32 v14, v16, v17
    v_cvt_pk_bf16_f32 v15, v18, v19
    v_cvt_pk_bf16_f32 v20, v20, v21
    v_cvt_pk_bf16_f32 v21, v22, v23
    v_cvt_pk_bf16_f32 v22, v24, v25
    v_cvt_pk_bf16_f32 v23, v26, v27
    s_or_b64 s[84:85], s[84:85], vcc
    buffer_store_dwordx4 v[12:15], v1, s[40:43], s81 offen offset:2048 sc1
    buffer_store_dwordx4 v[20:23], v1, s[40:43], s81 offen offset:3072 sc1
    s_nop 3
    v_accvgpr_read_b32 v9, a220
    v_cmp_nge_f32 vcc, 0x71800000, v9
    v_rcp_f32 v10, v9
    s_nop 0
    s_or_b64 s[84:85], s[84:85], vcc
    v_mul_f32 v10, v10, v7
    s_add_u32 s72, s81, 622592
    v_accvgpr_read_b32 v12, a12
    v_accvgpr_read_b32 v13, a13
    v_accvgpr_read_b32 v14, a14
    v_accvgpr_read_b32 v15, a15
    v_accvgpr_read_b32 v16, a28
    v_accvgpr_read_b32 v17, a29
    v_accvgpr_read_b32 v18, a30
    v_accvgpr_read_b32 v19, a31
    v_pk_mul_f32 v[12:13], v[12:13], v[10:11] op_sel_hi:[1,0]
    v_pk_mul_f32 v[14:15], v[14:15], v[10:11] op_sel_hi:[1,0]
    v_pk_mul_f32 v[16:17], v[16:17], v[10:11] op_sel_hi:[1,0]
    v_pk_mul_f32 v[18:19], v[18:19], v[10:11] op_sel_hi:[1,0]
    v_cvt_pk_bf16_f32 v12, v12, v13
    v_cvt_pk_bf16_f32 v13, v14, v15
    v_cvt_pk_bf16_f32 v14, v16, v17
    v_cvt_pk_bf16_f32 v15, v18, v19
    buffer_store_dwordx4 v[12:15], v1, s[40:43], s72 offen offset:0 sc1
    v_accvgpr_read_b32 v20, a44
    v_accvgpr_read_b32 v21, a45
    v_accvgpr_read_b32 v22, a46
    v_accvgpr_read_b32 v23, a47
    v_accvgpr_read_b32 v24, a60
    v_accvgpr_read_b32 v25, a61
    v_accvgpr_read_b32 v26, a62
    v_accvgpr_read_b32 v27, a63
    v_pk_mul_f32 v[20:21], v[20:21], v[10:11] op_sel_hi:[1,0]
    v_pk_mul_f32 v[22:23], v[22:23], v[10:11] op_sel_hi:[1,0]
    v_pk_mul_f32 v[24:25], v[24:25], v[10:11] op_sel_hi:[1,0]
    v_pk_mul_f32 v[26:27], v[26:27], v[10:11] op_sel_hi:[1,0]
    v_cvt_pk_bf16_f32 v20, v20, v21
    v_cvt_pk_bf16_f32 v21, v22, v23
    v_cvt_pk_bf16_f32 v22, v24, v25
    v_cvt_pk_bf16_f32 v23, v26, v27
    buffer_store_dwordx4 v[20:23], v1, s[40:43], s72 offen offset:1024 sc1
    v_accvgpr_read_b32 v12, a156
    v_accvgpr_read_b32 v13, a157
    v_accvgpr_read_b32 v14, a158
    v_accvgpr_read_b32 v15, a159
    v_accvgpr_read_b32 v16, a172
    v_accvgpr_read_b32 v17, a173
    v_accvgpr_read_b32 v18, a174
    v_accvgpr_read_b32 v19, a175
    v_pk_mul_f32 v[12:13], v[12:13], v[10:11] op_sel_hi:[1,0]
    v_pk_mul_f32 v[14:15], v[14:15], v[10:11] op_sel_hi:[1,0]
    v_pk_mul_f32 v[16:17], v[16:17], v[10:11] op_sel_hi:[1,0]
    v_pk_mul_f32 v[18:19], v[18:19], v[10:11] op_sel_hi:[1,0]
    v_cvt_pk_bf16_f32 v12, v12, v13
    v_cvt_pk_bf16_f32 v13, v14, v15
    v_cvt_pk_bf16_f32 v14, v16, v17
    v_cvt_pk_bf16_f32 v15, v18, v19
    buffer_store_dwordx4 v[12:15], v1, s[40:43], s72 offen offset:2048 sc1
    v_accvgpr_read_b32 v20, a188
    v_accvgpr_read_b32 v21, a189
    v_accvgpr_read_b32 v22, a190
    v_accvgpr_read_b32 v23, a191
    v_accvgpr_read_b32 v24, a204
    v_accvgpr_read_b32 v25, a205
    v_accvgpr_read_b32 v26, a206
    v_accvgpr_read_b32 v27, a207
    v_pk_mul_f32 v[20:21], v[20:21], v[10:11] op_sel_hi:[1,0]
    v_pk_mul_f32 v[22:23], v[22:23], v[10:11] op_sel_hi:[1,0]
    v_pk_mul_f32 v[24:25], v[24:25], v[10:11] op_sel_hi:[1,0]
    v_pk_mul_f32 v[26:27], v[26:27], v[10:11] op_sel_hi:[1,0]
    v_cvt_pk_bf16_f32 v20, v20, v21
    v_cvt_pk_bf16_f32 v21, v22, v23
    v_cvt_pk_bf16_f32 v22, v24, v25
    v_cvt_pk_bf16_f32 v23, v26, v27
    buffer_store_dwordx4 v[20:23], v1, s[40:43], s72 offen offset:3072 sc1
    buffer_load_dword v3, v217, s[32:35], s19 offen sc1
    s_waitcnt lgkmcnt(0)
    s_barrier
    s_sub_u32 s30, s47, s75
    s_sub_u32 s31, s79, s75
    v_bfe_u32 v20, v1, 4, 4
    v_lshrrev_b32 v21, 8, v1
    s_lshl_b32 s98, s4, 4
    s_add_u32 s98, s98, 16
    v_add_u32 v22, s98, v20
    v_mul_u32_u24 v22, 144, v22
    v_add_u32 v22, s30, v22
    v_lshl_add_u32 v9, v21, 3, v22
    s_lshr_b32 s98, s73, 1
    v_add_u32 v8, s98, v9
    v_subrev_u32 v10, s98, v9
    s_sub_u32 s99, s31, s30
    v_add_u32 v24, s99, v8
    v_add_u32 v25, s99, v9
    v_add_u32 v26, s99, v10
    s_bitcmp1_b32 s4, 0
    s_cselect_b32 s99, s31, s30
    v_mul_u32_u24 v23, 144, v20
    v_lshl_add_u32 v23, v21, 3, v23
    v_add_u32 v13, s99, v23
    v_add_u32 v12, s98, v13
    v_accvgpr_read_b32 v32, a64
    v_accvgpr_read_b32 v33, a65
    v_accvgpr_read_b32 v34, a66
    v_accvgpr_read_b32 v35, a67
    v_cvt_pk_bf16_f32 v32, v32, v33
    v_cvt_pk_bf16_f32 v33, v34, v35
    ds_write_b64 v8, v[32:33] offset:0
    v_accvgpr_read_b32 v36, a68
    v_accvgpr_read_b32 v37, a69
    v_accvgpr_read_b32 v38, a70
    v_accvgpr_read_b32 v39, a71
    v_cvt_pk_bf16_f32 v36, v36, v37
    v_cvt_pk_bf16_f32 v37, v38, v39
    ds_write_b64 v8, v[36:37] offset:9216
    v_accvgpr_read_b32 v40, a72
    v_accvgpr_read_b32 v41, a73
    v_accvgpr_read_b32 v42, a74
    v_accvgpr_read_b32 v43, a75
    v_cvt_pk_bf16_f32 v40, v40, v41
    v_cvt_pk_bf16_f32 v41, v42, v43
    ds_write_b64 v24, v[40:41] offset:0
    v_accvgpr_read_b32 v44, a76
    v_accvgpr_read_b32 v45, a77
    v_accvgpr_read_b32 v46, a78
    v_accvgpr_read_b32 v47, a79
    v_cvt_pk_bf16_f32 v44, v44, v45
    v_cvt_pk_bf16_f32 v45, v46, v47
    ds_write_b64 v24, v[44:45] offset:9216
    v_accvgpr_read_b32 v32, a80
    v_accvgpr_read_b32 v33, a81
    v_accvgpr_read_b32 v34, a82
    v_accvgpr_read_b32 v35, a83
    v_cvt_pk_bf16_f32 v32, v32, v33
    v_cvt_pk_bf16_f32 v33, v34, v35
    ds_write_b64 v9, v[32:33] offset:32
    v_accvgpr_read_b32 v36, a84
    v_accvgpr_read_b32 v37, a85
    v_accvgpr_read_b32 v38, a86
    v_accvgpr_read_b32 v39, a87
    v_cvt_pk_bf16_f32 v36, v36, v37
    v_cvt_pk_bf16_f32 v37, v38, v39
    ds_write_b64 v9, v[36:37] offset:9248
    v_accvgpr_read_b32 v40, a88
    v_accvgpr_read_b32 v41, a89
    v_accvgpr_read_b32 v42, a90
    v_accvgpr_read_b32 v43, a91
    v_cvt_pk_bf16_f32 v40, v40, v41
    v_cvt_pk_bf16_f32 v41, v42, v43
    ds_write_b64 v25, v[40:41] offset:32
    v_accvgpr_read_b32 v44, a92
    v_accvgpr_read_b32 v45, a93
    v_accvgpr_read_b32 v46, a94
    v_accvgpr_read_b32 v47, a95
    v_cvt_pk_bf16_f32 v44, v44, v45
    v_cvt_pk_bf16_f32 v45, v46, v47
    ds_write_b64 v25, v[44:45] offset:9248
    v_accvgpr_read_b32 v32, a96
    v_accvgpr_read_b32 v33, a97
    v_accvgpr_read_b32 v34, a98
    v_accvgpr_read_b32 v35, a99
    v_cvt_pk_bf16_f32 v32, v32, v33
    v_cvt_pk_bf16_f32 v33, v34, v35
    ds_write_b64 v10, v[32:33] offset:64
    v_accvgpr_read_b32 v36, a100
    v_accvgpr_read_b32 v37, a101
    v_accvgpr_read_b32 v38, a102
    v_accvgpr_read_b32 v39, a103
    v_cvt_pk_bf16_f32 v36, v36, v37
    v_cvt_pk_bf16_f32 v37, v38, v39
    ds_write_b64 v10, v[36:37] offset:9280
    v_accvgpr_read_b32 v40, a104
    v_accvgpr_read_b32 v41, a105
    v_accvgpr_read_b32 v42, a106
    v_accvgpr_read_b32 v43, a107
    v_cvt_pk_bf16_f32 v40, v40, v41
    v_cvt_pk_bf16_f32 v41, v42, v43
    ds_write_b64 v26, v[40:41] offset:64
    v_accvgpr_read_b32 v44, a108
    v_accvgpr_read_b32 v45, a109
    v_accvgpr_read_b32 v46, a110
    v_accvgpr_read_b32 v47, a111
    v_cvt_pk_bf16_f32 v44, v44, v45
    v_cvt_pk_bf16_f32 v45, v46, v47
    ds_write_b64 v26, v[44:45] offset:9280
    v_mov_b32 v218, 2
    s_cmp_eq_u64 s[84:85], 0
    s_cselect_b32 s7, s74, 1073741824
    s_cmp_lg_u32 s83, 0
    s_cselect_b32 s7, s74, s7
    s_waitcnt vmcnt(1)
    buffer_store_dword v218, v216, s[32:35], s7 offen sc1
    s_xor_b32 s21, s3, 2
    s_lshl2_add_u32 s21, s21, s4
    s_mul_i32 s21, s21, 36864
    s_add_u32 s21, s21, s28
    s_mov_b32 m0, s46
    s_nop 0
    buffer_load_dwordx4 v1, s[56:59], s21 offen sc1 lds
    v_accvgpr_read_b32 v32, a112
    v_accvgpr_read_b32 v33, a113
    v_accvgpr_read_b32 v34, a114
    v_accvgpr_read_b32 v35, a115
    v_cvt_pk_bf16_f32 v32, v32, v33
    v_cvt_pk_bf16_f32 v33, v34, v35
    ds_write_b64 v9, v[32:33] offset:96
    v_accvgpr_read_b32 v36, a116
    v_accvgpr_read_b32 v37, a117
    v_accvgpr_read_b32 v38, a118
    v_accvgpr_read_b32 v39, a119
    v_cvt_pk_bf16_f32 v36, v36, v37
    buffer_load_dwordx4 v1, s[56:59], s21 offen offset:1024 sc1 lds
    v_cvt_pk_bf16_f32 v37, v38, v39
    ds_write_b64 v9, v[36:37] offset:9312
    v_accvgpr_read_b32 v40, a120
    v_accvgpr_read_b32 v41, a121
    v_accvgpr_read_b32 v42, a122
    v_accvgpr_read_b32 v43, a123
    v_cvt_pk_bf16_f32 v40, v40, v41
    v_cvt_pk_bf16_f32 v41, v42, v43
    ds_write_b64 v25, v[40:41] offset:96
    v_accvgpr_read_b32 v44, a124
    v_accvgpr_read_b32 v45, a125
    v_accvgpr_read_b32 v46, a126
    buffer_load_dwordx4 v1, s[56:59], s21 offen offset:2048 sc1 lds
    v_accvgpr_read_b32 v47, a127
    v_cvt_pk_bf16_f32 v44, v44, v45
    v_cvt_pk_bf16_f32 v45, v46, v47
    s_waitcnt lgkmcnt(3)
    ds_write_b64 v25, v[44:45] offset:9312
    v_accvgpr_read_b32 v32, a128
    v_accvgpr_read_b32 v33, a129
    v_accvgpr_read_b32 v34, a130
    v_accvgpr_read_b32 v35, a131
    v_cvt_pk_bf16_f32 v32, v32, v33
    v_cvt_pk_bf16_f32 v33, v34, v35
    ds_write_b64 v12, v[32:33] offset:0
    v_accvgpr_read_b32 v36, a132
    buffer_load_dwordx4 v1, s[56:59], s21 offen offset:3072 sc1 lds
    v_accvgpr_read_b32 v37, a133
    v_accvgpr_read_b32 v38, a134
    v_accvgpr_read_b32 v39, a135
    v_cvt_pk_bf16_f32 v36, v36, v37
    v_cvt_pk_bf16_f32 v37, v38, v39
    s_cmp_eq_u32 s73, 0
    s_cselect_b64 exec, -1, 0
    ds_write_b64 v13, v[36:37] offset:32
    s_mov_b64 exec, -1
    s_cmp_lg_u64 s[84:85], 0
    s_cselect_b32 s7, 1, 0
    v_mov_b32 v20, s7
    s_lshl2_add_u32 s98, s4, s30
    s_add_u32 s21, s21, 4096
    s_add_u32 m0, s46, 4096
    s_nop 0
    buffer_load_dwordx4 v1, s[56:59], s21 offen sc1 lds
    v_mov_b32 v21, s98
    ds_write_b32 v21, v20 offset:20736
    v_mov_b32 v21, s30
    s_and_b32 s98, s4, 1
    s_lshl_b32 s98, s98, 6
    v_lshrrev_b32 v14, 4, v1
    v_add_u32 v14, s98, v14
    s_sub_u32 s7, 15, s6
    s_cmp_lt_u32 s4, 2
    s_cselect_b32 s7, s6, s7
    s_cselect_b32 s99, s30, s31
    s_lshl_b32 s7, s7, 7
    buffer_load_dwordx4 v1, s[56:59], s21 offen offset:1024 sc1 lds
    v_add_u32 v2, 2, v14
    v_mul_u32_u24 v2, 144, v2
    v_add_u32 v2, s99, v2
    v_add_u32 v14, s7, v14
    v_lshrrev_b32 v15, 4, v14
    s_mov_b32 s98, 155648
    v_mul_lo_u32 v15, v15, s98
    v_and_b32 v23, 0xf0, v1
    v_add_u32 v15, v15, v23
    s_lshl3_add_u32 s98, s6, s62
    s_mul_i32 s98, s98, 155648
    v_add_u32 v4, s98, v1
    buffer_load_dwordx4 v1, s[56:59], s21 offen offset:2048 sc1 lds
    s_sub_u32 s98, 15, s6
    s_lshl3_add_u32 s98, s98, s62
    s_mul_i32 s98, s98, 155648
    v_add_u32 v5, s98, v1
    v_mov_b32 v19, v217
    v_subrev_u32 v23, s75, v1
    v_add_u32 v11, s44, v23
    v_add_u32 v12, s45, v23
    v_add_u32 v13, s46, v23
    v_add_u32 v6, s47, v23
    v_add_u32 v7, s79, v23
    s_mov_b32 s98, 0xbfb8aa3b
    s_mov_b32 s99, 0x3eae1a93
    s_waitcnt vmcnt(8) lgkmcnt(0)
    s_barrier
    ds_read_b128 v[24:27], v21 offset:20736
    ds_read_b128 v[32:35], v2 offset:2016
    ds_read_b128 v[36:39], v2 offset:2032
    ds_read_b128 v[40:43], v2 offset:2048
    ds_read_b128 v[44:47], v2 offset:1728
    ds_read_b128 v[48:51], v2 offset:1744
    ds_read_b128 v[52:55], v2 offset:1760
    s_waitcnt lgkmcnt(6)
    v_or3_b32 v24, v24, v25, v26
    v_or_b32 v24, v24, v27
    s_nop 0
    v_readfirstlane_b32 s7, v24
    s_nop 1
    s_andn2_b32 s7, s7, s83
    s_cbranch_scc1 K1_REDO
    buffer_load_dword v28, v29, s[32:35], s92 offen sc1
    v_cmp_gt_u32 vcc, 1, v3
    s_nop 1
    s_and_b64 vcc, vcc, exec
    s_cbranch_scc1 SPIN_SHORT
BACK_SHORT:
    buffer_load_dwordx4 a[0:3], v4, s[40:43], s63 offen offset:0 sc1
    ds_read_b128 v[128:131], v2 offset:2096
    ds_read_b128 v[132:135], v2 offset:2112
    ds_read_b128 v[136:139], v2 offset:2128
    ds_read_b128 v[56:59], v2 offset:1440
    ds_read_b128 v[60:63], v2 offset:1456
    ds_read_b128 v[64:67], v2 offset:1472
    ds_read_b128 v[68:71], v2 offset:1152
    ds_read_b128 v[72:75], v2 offset:1168
    ds_read_b128 v[76:79], v2 offset:1184
    s_waitcnt lgkmcnt(8)
    v_dot2_f32_bf16 v140, v128, v32, 0
    v_dot2_f32_bf16 v141, v128, v44, 0
    buffer_load_dwordx4 a[8:11], v4, s[40:43], s63 offen offset:1024 sc1
    ds_read_b128 v[80:83], v2 offset:864
    s_waitcnt lgkmcnt(6)
    v_dot2_f32_bf16 v142, v128, v56, 0
    s_waitcnt lgkmcnt(3)
    v_dot2_f32_bf16 v143, v128, v68, 0
    ds_read_b128 v[84:87], v2 offset:880
    v_dot2c_f32_bf16 v140, v129, v33
    v_dot2c_f32_bf16 v141, v129, v45
    ds_read_b128 v[88:91], v2 offset:896
    v_dot2c_f32_bf16 v142, v129, v57
    v_dot2c_f32_bf16 v143, v129, v69
    ds_read_b128 v[92:95], v2 offset:576
    v_dot2c_f32_bf16 v140, v130, v34
    buffer_load_dwordx4 a[16:19], v4, s[40:43], s63 offen offset:2048 sc1
    v_dot2c_f32_bf16 v141, v130, v46
    ds_read_b128 v[96:99], v2 offset:592
    v_dot2c_f32_bf16 v142, v130, v58
    v_dot2c_f32_bf16 v143, v130, v70
    ds_read_b128 v[100:103], v2 offset:608
    v_dot2c_f32_bf16 v140, v131, v35
    v_dot2c_f32_bf16 v141, v131, v47
    ds_read_b128 v[104:107], v2 offset:288
    v_dot2c_f32_bf16 v142, v131, v59
    v_dot2c_f32_bf16 v143, v131, v71
    ds_read_b128 v[108:111], v2 offset:304
    v_dot2c_f32_bf16 v140, v132, v36
    buffer_load_dwordx4 a[24:27], v4, s[40:43], s63 offen offset:3072 sc1
    v_dot2c_f32_bf16 v141, v132, v48
    ds_read_b128 v[112:115], v2 offset:320
    v_dot2c_f32_bf16 v142, v132, v60
    s_waitcnt lgkmcnt(8)
    v_dot2c_f32_bf16 v143, v132, v72
    ds_read_b128 v[116:119], v2 offset:0
    v_dot2c_f32_bf16 v140, v133, v37
    v_dot2c_f32_bf16 v141, v133, v49
    ds_read_b128 v[120:123], v2 offset:16
    v_dot2c_f32_bf16 v142, v133, v61
    v_dot2c_f32_bf16 v143, v133, v73
    ds_read_b128 v[124:127], v2 offset:32
    s_xor_b32 s63, s63, 4096
    buffer_load_dwordx4 a[32:35], v4, s[40:43], s63 offen offset:0 sc1
    v_dot2c_f32_bf16 v140, v134, v38
    v_dot2c_f32_bf16 v141, v134, v50
    v_dot2c_f32_bf16 v142, v134, v62
    v_dot2c_f32_bf16 v143, v134, v74
    v_dot2c_f32_bf16 v140, v135, v39
    v_dot2c_f32_bf16 v141, v135, v51
    v_dot2c_f32_bf16 v142, v135, v63
    v_dot2c_f32_bf16 v143, v135, v75
    v_dot2c_f32_bf16 v140, v136, v40
    v_dot2c_f32_bf16 v141, v136, v52
    v_dot2c_f32_bf16 v142, v136, v64
    buffer_load_dwordx4 a[40:43], v4, s[40:43], s63 offen offset:1024 sc1
    v_dot2c_f32_bf16 v143, v136, v76
    v_dot2_f32_bf16 v144, v128, v80, 0
    s_waitcnt lgkmcnt(4)
    v_dot2_f32_bf16 v145, v128, v92, 0
    ds_read_b128 v[32:35], v2 offset:2064
    v_dot2_f32_bf16 v146, v128, v104, 0
    s_waitcnt lgkmcnt(3)
    v_dot2_f32_bf16 v147, v128, v116, 0
    ds_read_b128 v[36:39], v2 offset:2080
    v_dot2c_f32_bf16 v144, v129, v81
    v_dot2c_f32_bf16 v145, v129, v93
    ds_read_b128 v[44:47], v2 offset:1776
    v_dot2c_f32_bf16 v146, v129, v105
    v_dot2c_f32_bf16 v147, v129, v117
    buffer_load_dwordx4 a[48:51], v4, s[40:43], s63 offen offset:2048 sc1
    ds_read_b128 v[48:51], v2 offset:1792
    v_dot2c_f32_bf16 v144, v130, v82
    v_dot2c_f32_bf16 v145, v130, v94
    ds_read_b128 v[56:59], v2 offset:1488
    v_dot2c_f32_bf16 v146, v130, v106
    v_dot2c_f32_bf16 v147, v130, v118
    ds_read_b128 v[60:63], v2 offset:1504
    v_dot2c_f32_bf16 v144, v131, v83
    v_dot2c_f32_bf16 v145, v131, v95
    ds_read_b128 v[68:71], v2 offset:1200
    v_dot2c_f32_bf16 v146, v131, v107
    buffer_load_dwordx4 a[56:59], v4, s[40:43], s63 offen offset:3072 sc1
    v_dot2c_f32_bf16 v147, v131, v119
    ds_read_b128 v[72:75], v2 offset:1216
    v_dot2c_f32_bf16 v144, v132, v84
    v_dot2c_f32_bf16 v145, v132, v96
    v_dot2c_f32_bf16 v146, v132, v108
    s_waitcnt lgkmcnt(8)
    v_dot2c_f32_bf16 v147, v132, v120
    v_dot2c_f32_bf16 v144, v133, v85
    v_dot2c_f32_bf16 v145, v133, v97
    v_dot2c_f32_bf16 v146, v133, v109
    v_dot2c_f32_bf16 v147, v133, v121
    v_dot2c_f32_bf16 v144, v134, v86
    s_xor_b32 s63, s63, 12288
    buffer_load_dwordx4 a[64:67], v4, s[40:43], s63 offen offset:0 sc1
    v_dot2c_f32_bf16 v145, v134, v98
    v_dot2c_f32_bf16 v146, v134, v110
    v_dot2c_f32_bf16 v147, v134, v122
    v_dot2c_f32_bf16 v144, v135, v87
    v_dot2c_f32_bf16 v145, v135, v99
    v_dot2c_f32_bf16 v146, v135, v111
    v_dot2c_f32_bf16 v147, v135, v123
    v_dot2c_f32_bf16 v144, v136, v88
    v_dot2c_f32_bf16 v145, v136, v100
    v_dot2c_f32_bf16 v146, v136, v112
    v_dot2c_f32_bf16 v147, v136, v124
    v_lshlrev_b32 v8, 16, v138
    buffer_load_dwordx4 a[72:75], v4, s[40:43], s63 offen offset:1024 sc1
    v_mul_f32 v8, s98, v8
    v_exp_f32 v8, v8
    s_or_b32 s7, s6, s4
    s_cbranch_scc0 K1_WMASK
K1_WMASK_BACK:
    v_max3_f32 v9, v140, v141, v142
    v_max3_f32 v10, v143, v144, v145
    v_max3_f32 v9, v9, v146, v147
    v_max_f32 v9, v9, v10
    v_mul_f32 v9, s99, v9
    v_add_f32 v8, 1.0, v8
    buffer_load_dwordx4 a[80:83], v4, s[40:43], s63 offen offset:2048 sc1
    v_fma_f32 v140, v140, s99, -v9
    ds_read_b128 v[80:83], v2 offset:912
    v_fma_f32 v141, v141, s99, -v9
    ds_read_b128 v[84:87], v2 offset:928
    v_fma_f32 v142, v142, s99, -v9
    ds_read_b128 v[92:95], v2 offset:624
    v_fma_f32 v143, v143, s99, -v9
    ds_read_b128 v[96:99], v2 offset:640
    v_fma_f32 v144, v144, s99, -v9
    ds_read_b128 v[104:107], v2 offset:336
    v_fma_f32 v145, v145, s99, -v9
    buffer_load_dwordx4 a[88:91], v4, s[40:43], s63 offen offset:3072 sc1
    s_xor_b32 s63, s63, 4096
    ds_read_b128 v[108:111], v2 offset:352
    v_fma_f32 v146, v146, s99, -v9
    ds_read_b128 v[116:119], v2 offset:48
    v_fma_f32 v147, v147, s99, -v9
    s_waitcnt lgkmcnt(7)
    ds_read_b128 v[120:123], v2 offset:64
    v_exp_f32 v140, v140
    v_exp_f32 v141, v141
    v_exp_f32 v142, v142
    v_exp_f32 v143, v143
    v_exp_f32 v144, v144
    v_exp_f32 v145, v145
    v_exp_f32 v146, v146
    buffer_load_dword v3, v217, s[32:35], s19 offen sc1
    buffer_load_dwordx4 a[96:99], v4, s[40:43], s63 offen offset:0 sc1
    v_exp_f32 v147, v147
    v_add_f32 v10, v140, v141
    v_add_f32 v10, v10, v142
    v_add_f32 v10, v10, v143
    v_add_f32 v10, v10, v144
    v_add_f32 v10, v10, v145
    buffer_load_dwordx4 a[104:107], v4, s[40:43], s63 offen offset:1024 sc1
    v_add_f32 v10, v10, v146
    v_add_f32 v10, v10, v147
    v_mul_f32 v10, v10, v8
    v_rcp_f32 v10, v10
    s_nop 0
    v_mul_f32 v140, v140, v10
    v_mul_f32 v141, v141, v10
    v_mul_f32 v142, v142, v10
    buffer_load_dwordx4 a[112:115], v4, s[40:43], s63 offen offset:2048 sc1
    v_mul_f32 v143, v143, v10
    v_mul_f32 v144, v144, v10
    v_mul_f32 v145, v145, v10
    v_mul_f32 v146, v146, v10
    v_mul_f32 v147, v147, v10
    v_cvt_pk_bf16_f32 v148, 0, v140
    buffer_load_dwordx4 a[120:123], v4, s[40:43], s63 offen offset:3072 sc1
    v_cvt_pk_bf16_f32 v149, 0, v141
    v_cvt_pk_bf16_f32 v150, 0, v142
    v_cvt_pk_bf16_f32 v151, 0, v143
    v_cvt_pk_bf16_f32 v152, 0, v144
    v_cvt_pk_bf16_f32 v153, 0, v145
    v_cvt_pk_bf16_f32 v154, 0, v146
    v_cvt_pk_bf16_f32 v155, 0, v147
    s_xor_b32 s63, s63, 28672
    buffer_load_dwordx4 a[128:131], v4, s[40:43], s63 offen offset:0 sc1
    v_lshrrev_b32 v140, 16, v148
    v_lshrrev_b32 v141, 16, v149
    v_lshrrev_b32 v142, 16, v150
    v_lshrrev_b32 v143, 16, v151
    v_lshrrev_b32 v144, 16, v152
    v_lshrrev_b32 v145, 16, v153
    v_lshrrev_b32 v146, 16, v154
    buffer_load_dwordx4 a[136:139], v4, s[40:43], s63 offen offset:1024 sc1
    v_lshrrev_b32 v147, 16, v155
    v_dot2_f32_bf16 v128, v42, v140, 0
    v_dot2_f32_bf16 v129, v42, v148, 0
    v_dot2_f32_bf16 v130, v43, v140, 0
    v_dot2_f32_bf16 v131, v43, v148, 0
    v_dot2_f32_bf16 v132, v32, v140, 0
    buffer_load_dwordx4 a[144:147], v4, s[40:43], s63 offen offset:2048 sc1
    v_dot2_f32_bf16 v133, v32, v148, 0
    v_dot2_f32_bf16 v134, v33, v140, 0
    v_dot2_f32_bf16 v135, v33, v148, 0
    v_dot2_f32_bf16 v136, v34, v140, 0
    v_dot2_f32_bf16 v137, v34, v148, 0
    v_dot2_f32_bf16 v138, v35, v140, 0
    v_dot2_f32_bf16 v139, v35, v148, 0
    buffer_load_dwordx4 a[152:155], v4, s[40:43], s63 offen offset:3072 sc1
    s_xor_b32 s63, s63, 4096
    v_dot2_f32_bf16 v156, v36, v140, 0
    v_dot2_f32_bf16 v157, v36, v148, 0
    v_dot2_f32_bf16 v158, v37, v140, 0
    v_dot2_f32_bf16 v159, v37, v148, 0
    v_dot2_f32_bf16 v17, v38, v140, 0
    v_dot2_f32_bf16 v18, v38, v148, 0
    v_dot2c_f32_bf16 v128, v54, v141
    s_waitcnt vmcnt(8)
    v_cmp_gt_u32 vcc, 2, v3
    s_nop 1
    s_and_b64 vcc, vcc, exec
    s_cbranch_scc1 SPIN_CTX
BACK_CTX:
    buffer_load_dwordx4 a[4:7], v5, s[40:43], s20 offen offset:0 sc1
    v_dot2c_f32_bf16 v129, v54, v149
    v_dot2c_f32_bf16 v130, v55, v141
    v_dot2c_f32_bf16 v131, v55, v149
    v_dot2c_f32_bf16 v132, v44, v141
    v_dot2c_f32_bf16 v133, v44, v149
    v_dot2c_f32_bf16 v134, v45, v141
    v_dot2c_f32_bf16 v135, v45, v149
    v_dot2c_f32_bf16 v136, v46, v141
    v_dot2c_f32_bf16 v137, v46, v149
    v_dot2c_f32_bf16 v138, v47, v141
    v_dot2c_f32_bf16 v139, v47, v149
    v_dot2c_f32_bf16 v156, v48, v141
    v_dot2c_f32_bf16 v157, v48, v149
    buffer_load_dwordx4 a[12:15], v5, s[40:43], s20 offen offset:1024 sc1
    v_dot2c_f32_bf16 v158, v49, v141
    v_dot2c_f32_bf16 v159, v49, v149
    v_dot2c_f32_bf16 v17, v50, v141
    v_dot2c_f32_bf16 v18, v50, v149
    v_dot2c_f32_bf16 v128, v66, v142
    v_dot2c_f32_bf16 v129, v66, v150
    v_dot2c_f32_bf16 v130, v67, v142
    v_dot2c_f32_bf16 v131, v67, v150
    v_dot2c_f32_bf16 v132, v56, v142
    v_dot2c_f32_bf16 v133, v56, v150
    v_dot2c_f32_bf16 v134, v57, v142
    v_dot2c_f32_bf16 v135, v57, v150
    v_dot2c_f32_bf16 v136, v58, v142
    v_dot2c_f32_bf16 v137, v58, v150
    buffer_load_dwordx4 a[20:23], v5, s[40:43], s20 offen offset:2048 sc1
    v_dot2c_f32_bf16 v138, v59, v142
    v_dot2c_f32_bf16 v139, v59, v150
    v_dot2c_f32_bf16 v156, v60, v142
    v_dot2c_f32_bf16 v157, v60, v150
    v_dot2c_f32_bf16 v158, v61, v142
    v_dot2c_f32_bf16 v159, v61, v150
    v_dot2c_f32_bf16 v17, v62, v142
    v_dot2c_f32_bf16 v18, v62, v150
    v_dot2c_f32_bf16 v128, v78, v143
    v_dot2c_f32_bf16 v129, v78, v151
    v_dot2c_f32_bf16 v130, v79, v143
    v_dot2c_f32_bf16 v131, v79, v151
    v_dot2c_f32_bf16 v132, v68, v143
    v_dot2c_f32_bf16 v133, v68, v151
    buffer_load_dwordx4 a[28:31], v5, s[40:43], s20 offen offset:3072 sc1
    v_dot2c_f32_bf16 v134, v69, v143
    v_dot2c_f32_bf16 v135, v69, v151
    v_dot2c_f32_bf16 v136, v70, v143
    v_dot2c_f32_bf16 v137, v70, v151
    v_dot2c_f32_bf16 v138, v71, v143
    v_dot2c_f32_bf16 v139, v71, v151
    v_dot2c_f32_bf16 v156, v72, v143
    v_dot2c_f32_bf16 v157, v72, v151
    v_dot2c_f32_bf16 v158, v73, v143
    v_dot2c_f32_bf16 v159, v73, v151
    v_dot2c_f32_bf16 v17, v74, v143
    v_dot2c_f32_bf16 v18, v74, v151
    v_dot2c_f32_bf16 v128, v90, v144
    v_dot2c_f32_bf16 v129, v90, v152
    s_xor_b32 s20, s20, 4096
    buffer_load_dwordx4 a[36:39], v5, s[40:43], s20 offen offset:0 sc1
    v_dot2c_f32_bf16 v130, v91, v144
    v_dot2c_f32_bf16 v131, v91, v152
    s_waitcnt lgkmcnt(0)
    v_dot2c_f32_bf16 v132, v80, v144
    v_dot2c_f32_bf16 v133, v80, v152
    v_dot2c_f32_bf16 v134, v81, v144
    v_dot2c_f32_bf16 v135, v81, v152
    v_dot2c_f32_bf16 v136, v82, v144
    v_dot2c_f32_bf16 v137, v82, v152
    v_dot2c_f32_bf16 v138, v83, v144
    v_dot2c_f32_bf16 v139, v83, v152
    v_dot2c_f32_bf16 v156, v84, v144
    v_dot2c_f32_bf16 v157, v84, v152
    v_dot2c_f32_bf16 v158, v85, v144
    buffer_load_dwordx4 a[44:47], v5, s[40:43], s20 offen offset:1024 sc1
    v_dot2c_f32_bf16 v159, v85, v152
    v_dot2c_f32_bf16 v17, v86, v144
    v_dot2c_f32_bf16 v18, v86, v152
    v_dot2c_f32_bf16 v128, v102, v145
    v_dot2c_f32_bf16 v129, v102, v153
    v_dot2c_f32_bf16 v130, v103, v145
    v_dot2c_f32_bf16 v131, v103, v153
    v_dot2c_f32_bf16 v132, v92, v145
    v_dot2c_f32_bf16 v133, v92, v153
    v_dot2c_f32_bf16 v134, v93, v145
    v_dot2c_f32_bf16 v135, v93, v153
    v_dot2c_f32_bf16 v136, v94, v145
    v_dot2c_f32_bf16 v137, v94, v153
    v_dot2c_f32_bf16 v138, v95, v145
    buffer_load_dwordx4 a[52:55], v5, s[40:43], s20 offen offset:2048 sc1
    v_dot2c_f32_bf16 v139, v95, v153
    v_dot2c_f32_bf16 v156, v96, v145
    v_dot2c_f32_bf16 v157, v96, v153
    v_dot2c_f32_bf16 v158, v97, v145
    v_dot2c_f32_bf16 v159, v97, v153
    v_dot2c_f32_bf16 v17, v98, v145
    v_dot2c_f32_bf16 v18, v98, v153
    v_dot2c_f32_bf16 v128, v114, v146
    v_dot2c_f32_bf16 v129, v114, v154
    v_dot2c_f32_bf16 v130, v115, v146
    v_dot2c_f32_bf16 v131, v115, v154
    v_dot2c_f32_bf16 v132, v104, v146
    v_dot2c_f32_bf16 v133, v104, v154
    v_dot2c_f32_bf16 v134, v105, v146
    buffer_load_dwordx4 a[60:63], v5, s[40:43], s20 offen offset:3072 sc1
    s_xor_b32 s20, s20, 12288
    v_dot2c_f32_bf16 v135, v105, v154
    v_dot2c_f32_bf16 v136, v106, v146
    v_dot2c_f32_bf16 v137, v106, v154
    v_dot2c_f32_bf16 v138, v107, v146
    v_dot2c_f32_bf16 v139, v107, v154
    v_dot2c_f32_bf16 v156, v108, v146
    v_dot2c_f32_bf16 v157, v108, v154
    v_dot2c_f32_bf16 v158, v109, v146
    v_dot2c_f32_bf16 v159, v109, v154
    v_dot2c_f32_bf16 v17, v110, v146
    v_dot2c_f32_bf16 v18, v110, v154
    v_dot2c_f32_bf16 v128, v126, v147
    v_dot2c_f32_bf16 v129, v126, v155
    v_dot2c_f32_bf16 v130, v127, v147
    v_dot2c_f32_bf16 v131, v127, v155
    v_dot2c_f32_bf16 v132, v116, v147
    v_dot2c_f32_bf16 v133, v116, v155
    v_dot2c_f32_bf16 v134, v117, v147
    v_dot2c_f32_bf16 v135, v117, v155
    v_dot2c_f32_bf16 v136, v118, v147
    v_dot2c_f32_bf16 v137, v118, v155
    v_dot2c_f32_bf16 v138, v119, v147
    v_dot2c_f32_bf16 v139, v119, v155
    v_dot2c_f32_bf16 v156, v120, v147
    v_dot2c_f32_bf16 v157, v120, v155
    v_dot2c_f32_bf16 v158, v121, v147
    v_dot2c_f32_bf16 v159, v121, v155
    v_dot2c_f32_bf16 v17, v122, v147
    v_dot2c_f32_bf16 v18, v122, v155
    v_mov_b32 v89, 0
    v_mov_b32 v90, 0
    v_mov_b32 v91, 0
    v_cvt_pk_bf16_f32 v80, v128, v129
    v_cvt_pk_bf16_f32 v81, v130, v131
    v_cvt_pk_bf16_f32 v82, v132, v133
    v_cvt_pk_bf16_f32 v83, v134, v135
    v_cvt_pk_bf16_f32 v84, v136, v137
    v_cvt_pk_bf16_f32 v85, v138, v139
    v_cvt_pk_bf16_f32 v86, v156, v157
    v_cvt_pk_bf16_f32 v87, v158, v159
    v_cvt_pk_bf16_f32 v88, v17, v18
    v_cmp_gt_u32 vcc, 1, v28
    s_nop 1
    s_and_b64 vcc, vcc, exec
    s_cbranch_scc1 SPIN_ALL
BACK_ALL:
    s_waitcnt vmcnt(4)
    s_barrier
    ds_read_b128 v[104:107], v11 offset:0
    ds_read_b128 v[108:111], v11 offset:8192
    ds_read_b128 v[112:115], v11 offset:16384
    ds_read_b128 v[116:119], v11 offset:24576
    s_waitcnt lgkmcnt(3)
    v_mfma_f32_16x16x32_bf16 v[176:179], v[104:107], a[0:3], 0
    s_lshl3_add_u32 s98, 1, s5
    ds_read_b128 v[120:123], v11 offset:1024
    ds_read_b128 v[124:127], v11 offset:9216
    s_waitcnt lgkmcnt(4)
    v_mfma_f32_16x16x32_bf16 v[176:179], v[108:111], a[8:11], v[176:179]
    s_and_b32 s98, s98, 31
    buffer_load_dwordx4 a[68:71], v5, s[40:43], s20 offen offset:0 sc1
    s_waitcnt lgkmcnt(3)
    v_mfma_f32_16x16x32_bf16 v[176:179], v[112:115], a[16:19], v[176:179]
    s_lshl_b32 s8, s6, 5
    ds_read_b128 v[128:131], v11 offset:17408
    ds_read_b128 v[132:135], v11 offset:25600
    s_waitcnt lgkmcnt(4)
    v_mfma_f32_16x16x32_bf16 v[176:179], v[116:119], a[24:27], v[176:179]
    s_add_u32 s98, s98, s8
    ds_read_b128 v[136:139], v11 offset:2048
    v_mfma_f32_16x16x32_bf16 v[180:183], v[104:107], a[4:7], 0
    s_mul_i32 s98, s98, 3
    buffer_load_dwordx4 a[76:79], v5, s[40:43], s20 offen offset:1024 sc1
    v_mfma_f32_16x16x32_bf16 v[180:183], v[108:111], a[12:15], v[180:183]
    s_sub_u32 s98, s98, 1
    ds_read_b128 v[140:143], v11 offset:10240
    ds_read_b128 v[144:147], v11 offset:18432
    v_mfma_f32_16x16x32_bf16 v[180:183], v[112:115], a[20:23], v[180:183]
    s_add_u32 s98, s98, 3
    ds_read_b128 v[148:151], v11 offset:26624
    v_mfma_f32_16x16x32_bf16 v[180:183], v[116:119], a[28:31], v[180:183]
    s_lshl2_add_u32 s98, s98, s4
    ds_read_b128 v[104:107], v11 offset:3072
    s_waitcnt lgkmcnt(5)
    v_mfma_f32_16x16x32_bf16 v[184:187], v[120:123], a[0:3], 0
    s_mul_i32 s8, s98, 3072
    buffer_load_dwordx4 a[84:87], v5, s[40:43], s20 offen offset:2048 sc1
    v_mfma_f32_16x16x32_bf16 v[184:187], v[124:127], a[8:11], v[184:187]
    s_lshl3_add_u32 s98, 2, s5
    ds_read_b128 v[108:111], v11 offset:11264
    ds_read_b128 v[112:115], v11 offset:19456
    v_mfma_f32_16x16x32_bf16 v[184:187], v[128:131], a[16:19], v[184:187]
    s_and_b32 s98, s98, 31
    ds_read_b128 v[116:119], v11 offset:27648
    v_mfma_f32_16x16x32_bf16 v[184:187], v[132:135], a[24:27], v[184:187]
    s_lshl_b32 s9, s6, 5
    v_mfma_f32_16x16x32_bf16 v[188:191], v[120:123], a[4:7], 0
    s_add_u32 s98, s98, s9
    buffer_load_dwordx4 a[92:95], v5, s[40:43], s20 offen offset:3072 sc1
    v_mfma_f32_16x16x32_bf16 v[188:191], v[124:127], a[12:15], v[188:191]
    s_xor_b32 s20, s20, 4096
    ds_read_b128 v[120:123], v11 offset:4096
    ds_read_b128 v[124:127], v11 offset:12288
    v_mfma_f32_16x16x32_bf16 v[188:191], v[128:131], a[20:23], v[188:191]
    s_mul_i32 s98, s98, 3
    ds_read_b128 v[128:131], v11 offset:20480
    v_mfma_f32_16x16x32_bf16 v[188:191], v[132:135], a[28:31], v[188:191]
    s_sub_u32 s98, s98, 2
    ds_read_b128 v[132:135], v11 offset:28672
    s_waitcnt lgkmcnt(4)
    v_mfma_f32_16x16x32_bf16 v[192:195], v[136:139], a[0:3], 0
    s_add_u32 s98, s98, 3
    buffer_store_dwordx4 v[80:83], v15, s[40:43], s71 offen offset:0 sc1
    v_mfma_f32_16x16x32_bf16 v[192:195], v[140:143], a[8:11], v[192:195]
    s_lshl2_add_u32 s98, s98, s4
    v_mfma_f32_16x16x32_bf16 v[192:195], v[144:147], a[16:19], v[192:195]
    s_mul_i32 s9, s98, 3072
    v_mfma_f32_16x16x32_bf16 v[192:195], v[148:151], a[24:27], v[192:195]
    s_lshl3_add_u32 s98, 3, s5
    v_mfma_f32_16x16x32_bf16 v[196:199], v[136:139], a[4:7], 0
    s_and_b32 s98, s98, 31
    ds_read_b128 v[136:139], v11 offset:5120
    v_mfma_f32_16x16x32_bf16 v[196:199], v[140:143], a[12:15], v[196:199]
    s_lshl_b32 s10, s6, 5
    buffer_store_dwordx4 v[84:87], v15, s[40:43], s71 offen offset:256 sc1
    v_mfma_f32_16x16x32_bf16 v[196:199], v[144:147], a[20:23], v[196:199]
    s_add_u32 s98, s98, s10
    ds_read_b128 v[140:143], v11 offset:13312
    ds_read_b128 v[144:147], v11 offset:21504
    v_mfma_f32_16x16x32_bf16 v[196:199], v[148:151], a[28:31], v[196:199]
    s_mul_i32 s98, s98, 3
    ds_read_b128 v[148:151], v11 offset:29696
    v_mfma_f32_16x16x32_bf16 v[200:203], v[104:107], a[0:3], 0
    s_sub_u32 s98, s98, 3
    v_mfma_f32_16x16x32_bf16 v[200:203], v[108:111], a[8:11], v[200:203]
    s_add_u32 s98, s98, 3
    buffer_store_dwordx4 v[88:91], v15, s[40:43], s71 offen offset:512 sc1
    v_mfma_f32_16x16x32_bf16 v[200:203], v[112:115], a[16:19], v[200:203]
    s_xor_b32 s21, s3, 3
    v_mfma_f32_16x16x32_bf16 v[200:203], v[116:119], a[24:27], v[200:203]
    s_lshl2_add_u32 s21, s21, s4
    v_mfma_f32_16x16x32_bf16 v[204:207], v[104:107], a[4:7], 0
    s_mul_i32 s21, s21, 36864
    ds_read_b128 v[104:107], v11 offset:6144
    v_mfma_f32_16x16x32_bf16 v[204:207], v[108:111], a[12:15], v[204:207]
    s_add_u32 s21, s21, s28
    s_mov_b32 m0, s47
    ds_read_b128 v[108:111], v11 offset:14336
    v_mfma_f32_16x16x32_bf16 v[204:207], v[112:115], a[20:23], v[204:207]
    s_lshl2_add_u32 s98, s98, s4
    buffer_load_dwordx4 v1, s[56:59], s21 offen sc1 lds
    v_mfma_f32_16x16x32_bf16 v[204:207], v[116:119], a[28:31], v[204:207]
    s_mul_i32 s10, s98, 3072
    ds_read_b128 v[112:115], v11 offset:22528
    ds_read_b128 v[116:119], v11 offset:30720
    s_waitcnt lgkmcnt(4)
    v_mfma_f32_16x16x32_bf16 v[208:211], v[120:123], a[0:3], 0
    s_sub_u32 s99, s4, s61
    v_mfma_f32_16x16x32_bf16 v[208:211], v[124:127], a[8:11], v[208:211]
    s_and_b32 s99, s99, 3
    buffer_load_dwordx4 v1, s[56:59], s21 offen offset:1024 sc1 lds
    v_mfma_f32_16x16x32_bf16 v[208:211], v[128:131], a[16:19], v[208:211]
    s_lshl3_add_u32 s98, s99, s5
    v_mfma_f32_16x16x32_bf16 v[208:211], v[132:135], a[24:27], v[208:211]
    s_and_b32 s98, s98, 31
    v_mfma_f32_16x16x32_bf16 v[212:215], v[120:123], a[4:7], 0
    s_lshl_b32 s11, s6, 5
    ds_read_b128 v[120:123], v12 offset:0
    v_mfma_f32_16x16x32_bf16 v[212:215], v[124:127], a[12:15], v[212:215]
    s_add_u32 s98, s98, s11
    buffer_load_dwordx4 v1, s[56:59], s21 offen offset:2048 sc1 lds
    v_mfma_f32_16x16x32_bf16 v[212:215], v[128:131], a[20:23], v[212:215]
    s_mul_i32 s98, s98, 3
    ds_read_b128 v[124:127], v12 offset:8192
    ds_read_b128 v[128:131], v12 offset:16384
    v_mfma_f32_16x16x32_bf16 v[212:215], v[132:135], a[28:31], v[212:215]
    s_sub_u32 s98, s98, s99
    ds_read_b128 v[132:135], v12 offset:24576
    v_mfma_f32_16x16x32_bf16 v[216:219], v[136:139], a[0:3], 0
    s_add_u32 s98, s98, 3
    v_mfma_f32_16x16x32_bf16 v[216:219], v[140:143], a[8:11], v[216:219]
    s_lshl2_add_u32 s98, s98, s4
    v_mfma_f32_16x16x32_bf16 v[216:219], v[144:147], a[16:19], v[216:219]
    s_mul_i32 s11, s98, 3072
    buffer_load_dwordx4 v1, s[56:59], s21 offen offset:3072 sc1 lds
    v_mfma_f32_16x16x32_bf16 v[216:219], v[148:151], a[24:27], v[216:219]
    s_waitcnt vmcnt(11)
    v_mfma_f32_16x16x32_bf16 v[220:223], v[136:139], a[4:7], 0
    s_add_u32 s21, s21, 4096
    ds_read_b128 v[136:139], v12 offset:1024
    v_mfma_f32_16x16x32_bf16 v[220:223], v[140:143], a[12:15], v[220:223]
    s_add_u32 m0, s47, 4096
    ds_read_b128 v[140:143], v12 offset:9216
    v_mfma_f32_16x16x32_bf16 v[220:223], v[144:147], a[20:23], v[220:223]
    buffer_load_dwordx4 v1, s[56:59], s21 offen sc1 lds
    v_mfma_f32_16x16x32_bf16 v[220:223], v[148:151], a[28:31], v[220:223]
    s_waitcnt lgkmcnt(2)
    ds_read_b128 v[144:147], v12 offset:17408
    ds_read_b128 v[148:151], v12 offset:25600
    v_mfma_f32_16x16x32_bf16 v[224:227], v[104:107], a[0:3], 0
    s_cmp_eq_u32 s99, 0
    s_cselect_b32 s11, 1073741824, s11
    v_mfma_f32_16x16x32_bf16 v[224:227], v[108:111], a[8:11], v[224:227]
    v_mfma_f32_16x16x32_bf16 v[224:227], v[112:115], a[16:19], v[224:227]
    buffer_load_dwordx4 v1, s[56:59], s21 offen offset:1024 sc1 lds
    v_mfma_f32_16x16x32_bf16 v[224:227], v[116:119], a[24:27], v[224:227]
    v_mfma_f32_16x16x32_bf16 v[228:231], v[104:107], a[4:7], 0
    ds_read_b128 v[104:107], v12 offset:2048
    v_mfma_f32_16x16x32_bf16 v[228:231], v[108:111], a[12:15], v[228:231]
    ds_read_b128 v[108:111], v12 offset:10240
    v_mfma_f32_16x16x32_bf16 v[228:231], v[112:115], a[20:23], v[228:231]
    buffer_load_dwordx4 v1, s[56:59], s21 offen offset:2048 sc1 lds
    v_mfma_f32_16x16x32_bf16 v[228:231], v[116:119], a[28:31], v[228:231]
    ds_read_b128 v[112:115], v12 offset:18432
    ds_read_b128 v[116:119], v12 offset:26624
    v_mfma_f32_16x16x32_bf16 v[176:179], v[120:123], a[32:35], v[176:179]
    v_mfma_f32_16x16x32_bf16 v[176:179], v[124:127], a[40:43], v[176:179]
    v_mfma_f32_16x16x32_bf16 v[176:179], v[128:131], a[48:51], v[176:179]
    buffer_load_dwordx4 a[100:103], v5, s[40:43], s20 offen offset:0 sc1
    v_mfma_f32_16x16x32_bf16 v[176:179], v[132:135], a[56:59], v[176:179]
    v_mfma_f32_16x16x32_bf16 v[180:183], v[120:123], a[36:39], v[180:183]
    ds_read_b128 v[120:123], v12 offset:3072
    v_mfma_f32_16x16x32_bf16 v[180:183], v[124:127], a[44:47], v[180:183]
    ds_read_b128 v[124:127], v12 offset:11264
    v_mfma_f32_16x16x32_bf16 v[180:183], v[128:131], a[52:55], v[180:183]
    ds_read_b128 v[128:131], v12 offset:19456
    v_mfma_f32_16x16x32_bf16 v[180:183], v[132:135], a[60:63], v[180:183]
    s_waitcnt lgkmcnt(3)
    buffer_load_dwordx4 a[108:111], v5, s[40:43], s20 offen offset:1024 sc1
    v_mfma_f32_16x16x32_bf16 v[184:187], v[136:139], a[32:35], v[184:187]
    ds_read_b128 v[132:135], v12 offset:27648
    v_mfma_f32_16x16x32_bf16 v[184:187], v[140:143], a[40:43], v[184:187]
    v_mfma_f32_16x16x32_bf16 v[184:187], v[144:147], a[48:51], v[184:187]
    v_mfma_f32_16x16x32_bf16 v[184:187], v[148:151], a[56:59], v[184:187]
    buffer_load_dwordx4 a[116:119], v5, s[40:43], s20 offen offset:2048 sc1
    v_mfma_f32_16x16x32_bf16 v[188:191], v[136:139], a[36:39], v[188:191]
    ds_read_b128 v[136:139], v12 offset:4096
    v_mfma_f32_16x16x32_bf16 v[188:191], v[140:143], a[44:47], v[188:191]
    ds_read_b128 v[140:143], v12 offset:12288
    v_mfma_f32_16x16x32_bf16 v[188:191], v[144:147], a[52:55], v[188:191]
    ds_read_b128 v[144:147], v12 offset:20480
    v_mfma_f32_16x16x32_bf16 v[188:191], v[148:151], a[60:63], v[188:191]
    buffer_load_dwordx4 a[124:127], v5, s[40:43], s20 offen offset:3072 sc1
    v_mfma_f32_16x16x32_bf16 v[192:195], v[104:107], a[32:35], v[192:195]
    s_xor_b32 s21, s3, 4
    ds_read_b128 v[148:151], v12 offset:28672
    v_mfma_f32_16x16x32_bf16 v[192:195], v[108:111], a[40:43], v[192:195]
    s_lshl2_add_u32 s21, s21, s4
    v_mfma_f32_16x16x32_bf16 v[192:195], v[112:115], a[48:51], v[192:195]
    s_mul_i32 s21, s21, 36864
    v_mfma_f32_16x16x32_bf16 v[192:195], v[116:119], a[56:59], v[192:195]
    s_add_u32 s21, s21, s28
    s_mov_b32 m0, s79
    v_mfma_f32_16x16x32_bf16 v[196:199], v[104:107], a[36:39], v[196:199]
    s_xor_b32 s20, s20, 28672
    buffer_load_dwordx4 v1, s[56:59], s21 offen sc1 lds
    v_mfma_f32_16x16x32_bf16 v[196:199], v[108:111], a[44:47], v[196:199]
    ds_read_b128 v[104:107], v12 offset:5120
    ds_read_b128 v[108:111], v12 offset:13312
    v_mfma_f32_16x16x32_bf16 v[196:199], v[112:115], a[52:55], v[196:199]
    ds_read_b128 v[112:115], v12 offset:21504
    v_mfma_f32_16x16x32_bf16 v[196:199], v[116:119], a[60:63], v[196:199]
    s_waitcnt lgkmcnt(3)
    buffer_load_dwordx4 v1, s[56:59], s21 offen offset:1024 sc1 lds
    v_mfma_f32_16x16x32_bf16 v[200:203], v[120:123], a[32:35], v[200:203]
    ds_read_b128 v[116:119], v12 offset:29696
    v_mfma_f32_16x16x32_bf16 v[200:203], v[124:127], a[40:43], v[200:203]
    v_mfma_f32_16x16x32_bf16 v[200:203], v[128:131], a[48:51], v[200:203]
    v_mfma_f32_16x16x32_bf16 v[200:203], v[132:135], a[56:59], v[200:203]
    v_mfma_f32_16x16x32_bf16 v[204:207], v[120:123], a[36:39], v[204:207]
    buffer_load_dwordx4 v1, s[56:59], s21 offen offset:2048 sc1 lds
    v_mfma_f32_16x16x32_bf16 v[204:207], v[124:127], a[44:47], v[204:207]
    ds_read_b128 v[120:123], v12 offset:6144
    ds_read_b128 v[124:127], v12 offset:14336
    v_mfma_f32_16x16x32_bf16 v[204:207], v[128:131], a[52:55], v[204:207]
    ds_read_b128 v[128:131], v12 offset:22528
    v_mfma_f32_16x16x32_bf16 v[204:207], v[132:135], a[60:63], v[204:207]
    ds_read_b128 v[132:135], v12 offset:30720
    v_mfma_f32_16x16x32_bf16 v[208:211], v[136:139], a[32:35], v[208:211]
    buffer_load_dwordx4 v1, s[56:59], s21 offen offset:3072 sc1 lds
    v_mfma_f32_16x16x32_bf16 v[208:211], v[140:143], a[40:43], v[208:211]
    s_add_u32 s21, s21, 4096
    v_mfma_f32_16x16x32_bf16 v[208:211], v[144:147], a[48:51], v[208:211]
    s_add_u32 m0, s79, 4096
    v_mfma_f32_16x16x32_bf16 v[208:211], v[148:151], a[56:59], v[208:211]
    v_mfma_f32_16x16x32_bf16 v[212:215], v[136:139], a[36:39], v[212:215]
    buffer_load_dwordx4 v1, s[56:59], s21 offen sc1 lds
    v_mfma_f32_16x16x32_bf16 v[212:215], v[140:143], a[44:47], v[212:215]
    ds_read_b128 v[136:139], v13 offset:0
    ds_read_b128 v[140:143], v13 offset:8192
    v_mfma_f32_16x16x32_bf16 v[212:215], v[144:147], a[52:55], v[212:215]
    ds_read_b128 v[144:147], v13 offset:16384
    v_mfma_f32_16x16x32_bf16 v[212:215], v[148:151], a[60:63], v[212:215]
    s_waitcnt lgkmcnt(3)
    ds_read_b128 v[148:151], v13 offset:24576
    v_mfma_f32_16x16x32_bf16 v[216:219], v[104:107], a[32:35], v[216:219]
    buffer_load_dwordx4 v1, s[56:59], s21 offen offset:1024 sc1 lds
    v_mfma_f32_16x16x32_bf16 v[216:219], v[108:111], a[40:43], v[216:219]
    v_mfma_f32_16x16x32_bf16 v[216:219], v[112:115], a[48:51], v[216:219]
    v_mfma_f32_16x16x32_bf16 v[216:219], v[116:119], a[56:59], v[216:219]
    s_waitcnt vmcnt(20)
    s_barrier
    v_mfma_f32_16x16x32_bf16 v[220:223], v[104:107], a[36:39], v[220:223]
    buffer_load_dwordx4 v1, s[56:59], s21 offen offset:2048 sc1 lds
    v_mfma_f32_16x16x32_bf16 v[220:223], v[108:111], a[44:47], v[220:223]
    ds_read_b128 v[104:107], v13 offset:1024
    ds_read_b128 v[108:111], v13 offset:9216
    v_mfma_f32_16x16x32_bf16 v[220:223], v[112:115], a[52:55], v[220:223]
    ds_read_b128 v[112:115], v13 offset:17408
    v_mfma_f32_16x16x32_bf16 v[220:223], v[116:119], a[60:63], v[220:223]
    ds_read_b128 v[116:119], v13 offset:25600
    v_mfma_f32_16x16x32_bf16 v[224:227], v[120:123], a[32:35], v[224:227]
    v_mfma_f32_16x16x32_bf16 v[224:227], v[124:127], a[40:43], v[224:227]
    buffer_load_dwordx4 a[132:135], v5, s[40:43], s20 offen offset:0 sc1
    v_mfma_f32_16x16x32_bf16 v[224:227], v[128:131], a[48:51], v[224:227]
    v_mfma_f32_16x16x32_bf16 v[224:227], v[132:135], a[56:59], v[224:227]
    v_mfma_f32_16x16x32_bf16 v[228:231], v[120:123], a[36:39], v[228:231]
    ds_read_b128 v[120:123], v13 offset:2048
    v_mfma_f32_16x16x32_bf16 v[228:231], v[124:127], a[44:47], v[228:231]
    buffer_load_dwordx4 a[140:143], v5, s[40:43], s20 offen offset:1024 sc1
    v_mfma_f32_16x16x32_bf16 v[228:231], v[128:131], a[52:55], v[228:231]
    ds_read_b128 v[124:127], v13 offset:10240
    ds_read_b128 v[128:131], v13 offset:18432
    v_mfma_f32_16x16x32_bf16 v[228:231], v[132:135], a[60:63], v[228:231]
    s_waitcnt lgkmcnt(3)
    ds_read_b128 v[132:135], v13 offset:26624
    v_mfma_f32_16x16x32_bf16 v[176:179], v[136:139], a[64:67], v[176:179]
    v_mfma_f32_16x16x32_bf16 v[176:179], v[140:143], a[72:75], v[176:179]
    buffer_load_dwordx4 a[148:151], v5, s[40:43], s20 offen offset:2048 sc1
    v_mfma_f32_16x16x32_bf16 v[176:179], v[144:147], a[80:83], v[176:179]
    v_mfma_f32_16x16x32_bf16 v[176:179], v[148:151], a[88:91], v[176:179]
    v_mfma_f32_16x16x32_bf16 v[180:183], v[136:139], a[68:71], v[180:183]
    ds_read_b128 v[136:139], v13 offset:3072
    v_mfma_f32_16x16x32_bf16 v[180:183], v[140:143], a[76:79], v[180:183]
    buffer_load_dwordx4 a[156:159], v5, s[40:43], s20 offen offset:3072 sc1
    v_mfma_f32_16x16x32_bf16 v[180:183], v[144:147], a[84:87], v[180:183]
    s_xor_b32 s21, s3, 5
    ds_read_b128 v[140:143], v13 offset:11264
    ds_read_b128 v[144:147], v13 offset:19456
    v_mfma_f32_16x16x32_bf16 v[180:183], v[148:151], a[92:95], v[180:183]
    s_lshl2_add_u32 s21, s21, s4
    ds_read_b128 v[148:151], v13 offset:27648
    v_mfma_f32_16x16x32_bf16 v[184:187], v[104:107], a[64:67], v[184:187]
    s_mul_i32 s21, s21, 36864
    v_mfma_f32_16x16x32_bf16 v[184:187], v[108:111], a[72:75], v[184:187]
    s_add_u32 s21, s21, s28
    s_mov_b32 m0, s44
    v_mfma_f32_16x16x32_bf16 v[184:187], v[112:115], a[80:83], v[184:187]
    s_xor_b32 s20, s20, 4096
    buffer_load_dwordx4 v1, s[56:59], s21 offen sc1 lds
    v_mfma_f32_16x16x32_bf16 v[184:187], v[116:119], a[88:91], v[184:187]
    v_mfma_f32_16x16x32_bf16 v[188:191], v[104:107], a[68:71], v[188:191]
    ds_read_b128 v[104:107], v13 offset:4096
    v_mfma_f32_16x16x32_bf16 v[188:191], v[108:111], a[76:79], v[188:191]
    ds_read_b128 v[108:111], v13 offset:12288
    v_mfma_f32_16x16x32_bf16 v[188:191], v[112:115], a[84:87], v[188:191]
    buffer_load_dwordx4 v1, s[56:59], s21 offen offset:1024 sc1 lds
    v_mfma_f32_16x16x32_bf16 v[188:191], v[116:119], a[92:95], v[188:191]
    s_waitcnt lgkmcnt(2)
    ds_read_b128 v[112:115], v13 offset:20480
    ds_read_b128 v[116:119], v13 offset:28672
    v_mfma_f32_16x16x32_bf16 v[192:195], v[120:123], a[64:67], v[192:195]
    v_mfma_f32_16x16x32_bf16 v[192:195], v[124:127], a[72:75], v[192:195]
    v_mfma_f32_16x16x32_bf16 v[192:195], v[128:131], a[80:83], v[192:195]
    buffer_load_dwordx4 v1, s[56:59], s21 offen offset:2048 sc1 lds
    v_mfma_f32_16x16x32_bf16 v[192:195], v[132:135], a[88:91], v[192:195]
    v_mfma_f32_16x16x32_bf16 v[196:199], v[120:123], a[68:71], v[196:199]
    ds_read_b128 v[120:123], v13 offset:5120
    v_mfma_f32_16x16x32_bf16 v[196:199], v[124:127], a[76:79], v[196:199]
    ds_read_b128 v[124:127], v13 offset:13312
    v_mfma_f32_16x16x32_bf16 v[196:199], v[128:131], a[84:87], v[196:199]
    buffer_load_dwordx4 v1, s[56:59], s21 offen offset:3072 sc1 lds
    v_mfma_f32_16x16x32_bf16 v[196:199], v[132:135], a[92:95], v[196:199]
    s_add_u32 s21, s21, 4096
    ds_read_b128 v[128:131], v13 offset:21504
    ds_read_b128 v[132:135], v13 offset:29696
    v_mfma_f32_16x16x32_bf16 v[200:203], v[136:139], a[64:67], v[200:203]
    s_add_u32 m0, s44, 4096
    v_mfma_f32_16x16x32_bf16 v[200:203], v[140:143], a[72:75], v[200:203]
    v_mfma_f32_16x16x32_bf16 v[200:203], v[144:147], a[80:83], v[200:203]
    buffer_load_dwordx4 v1, s[56:59], s21 offen sc1 lds
    v_mfma_f32_16x16x32_bf16 v[200:203], v[148:151], a[88:91], v[200:203]
    v_mfma_f32_16x16x32_bf16 v[204:207], v[136:139], a[68:71], v[204:207]
    ds_read_b128 v[136:139], v13 offset:6144
    v_mfma_f32_16x16x32_bf16 v[204:207], v[140:143], a[76:79], v[204:207]
    ds_read_b128 v[140:143], v13 offset:14336
    v_mfma_f32_16x16x32_bf16 v[204:207], v[144:147], a[84:87], v[204:207]
    buffer_load_dwordx4 v1, s[56:59], s21 offen offset:1024 sc1 lds
    v_mfma_f32_16x16x32_bf16 v[204:207], v[148:151], a[92:95], v[204:207]
    s_waitcnt lgkmcnt(2)
    ds_read_b128 v[144:147], v13 offset:22528
    ds_read_b128 v[148:151], v13 offset:30720
    v_mfma_f32_16x16x32_bf16 v[208:211], v[104:107], a[64:67], v[208:211]
    v_mfma_f32_16x16x32_bf16 v[208:211], v[108:111], a[72:75], v[208:211]
    v_mfma_f32_16x16x32_bf16 v[208:211], v[112:115], a[80:83], v[208:211]
    v_mfma_f32_16x16x32_bf16 v[208:211], v[116:119], a[88:91], v[208:211]
    buffer_load_dwordx4 v1, s[56:59], s21 offen offset:2048 sc1 lds
    v_mfma_f32_16x16x32_bf16 v[212:215], v[104:107], a[68:71], v[212:215]
    v_mfma_f32_16x16x32_bf16 v[212:215], v[108:111], a[76:79], v[212:215]
    v_mfma_f32_16x16x32_bf16 v[212:215], v[112:115], a[84:87], v[212:215]
    v_mfma_f32_16x16x32_bf16 v[212:215], v[116:119], a[92:95], v[212:215]
    buffer_load_dwordx4 a[160:163], v4, s[40:43], s63 offen offset:0 sc1
    v_mfma_f32_16x16x32_bf16 v[216:219], v[120:123], a[64:67], v[216:219]
    v_mfma_f32_16x16x32_bf16 v[216:219], v[124:127], a[72:75], v[216:219]
    v_mfma_f32_16x16x32_bf16 v[216:219], v[128:131], a[80:83], v[216:219]
    v_mfma_f32_16x16x32_bf16 v[216:219], v[132:135], a[88:91], v[216:219]
    s_waitcnt vmcnt(19)
    s_barrier
    v_mov_b32 v31, 3
    v_mfma_f32_16x16x32_bf16 v[220:223], v[120:123], a[68:71], v[220:223]
    buffer_load_dwordx4 a[168:171], v4, s[40:43], s63 offen offset:1024 sc1
    v_mfma_f32_16x16x32_bf16 v[220:223], v[124:127], a[76:79], v[220:223]
    buffer_store_dword v31, v30, s[32:35], s101 offen sc1
    v_mfma_f32_16x16x32_bf16 v[220:223], v[128:131], a[84:87], v[220:223]
    ds_read_b128 v[104:107], v6 offset:0
    ds_read_b128 v[108:111], v6 offset:8192
    v_mfma_f32_16x16x32_bf16 v[220:223], v[132:135], a[92:95], v[220:223]
    s_waitcnt lgkmcnt(2)
    ds_read_b128 v[112:115], v6 offset:16384
    v_mfma_f32_16x16x32_bf16 v[224:227], v[136:139], a[64:67], v[224:227]
    buffer_load_dwordx4 a[176:179], v4, s[40:43], s63 offen offset:2048 sc1
    v_mfma_f32_16x16x32_bf16 v[224:227], v[140:143], a[72:75], v[224:227]
    ds_read_b128 v[116:119], v6 offset:24576
    ds_read_b128 v[120:123], v6 offset:1024
    v_mfma_f32_16x16x32_bf16 v[224:227], v[144:147], a[80:83], v[224:227]
    ds_read_b128 v[124:127], v6 offset:9216
    v_mfma_f32_16x16x32_bf16 v[224:227], v[148:151], a[88:91], v[224:227]
    ds_read_b128 v[128:131], v6 offset:17408
    v_mfma_f32_16x16x32_bf16 v[228:231], v[136:139], a[68:71], v[228:231]
    buffer_load_dwordx4 a[184:187], v4, s[40:43], s63 offen offset:3072 sc1
    v_mfma_f32_16x16x32_bf16 v[228:231], v[140:143], a[76:79], v[228:231]
    s_xor_b32 s63, s63, 12288
    ds_read_b128 v[132:135], v6 offset:25600
    ds_read_b128 v[136:139], v6 offset:2048
    v_mfma_f32_16x16x32_bf16 v[228:231], v[144:147], a[84:87], v[228:231]
    ds_read_b128 v[140:143], v6 offset:10240
    v_mfma_f32_16x16x32_bf16 v[228:231], v[148:151], a[92:95], v[228:231]
    s_waitcnt lgkmcnt(4)
    ds_read_b128 v[144:147], v6 offset:18432
    v_mfma_f32_16x16x32_bf16 v[176:179], v[104:107], a[96:99], v[176:179]
    buffer_load_dwordx4 a[164:167], v5, s[40:43], s20 offen offset:0 sc1
    v_mfma_f32_16x16x32_bf16 v[176:179], v[108:111], a[104:107], v[176:179]
    ds_read_b128 v[148:151], v6 offset:26624
    v_mfma_f32_16x16x32_bf16 v[176:179], v[112:115], a[112:115], v[176:179]
    v_mfma_f32_16x16x32_bf16 v[176:179], v[116:119], a[120:123], v[176:179]
    v_mfma_f32_16x16x32_bf16 v[180:183], v[104:107], a[100:103], v[180:183]
    buffer_load_dwordx4 a[172:175], v5, s[40:43], s20 offen offset:1024 sc1
    v_mfma_f32_16x16x32_bf16 v[180:183], v[108:111], a[108:111], v[180:183]
    ds_read_b128 v[104:107], v6 offset:3072
    ds_read_b128 v[108:111], v6 offset:11264
    v_mfma_f32_16x16x32_bf16 v[180:183], v[112:115], a[116:119], v[180:183]
    ds_read_b128 v[112:115], v6 offset:19456
    v_mfma_f32_16x16x32_bf16 v[180:183], v[116:119], a[124:127], v[180:183]
    ds_read_b128 v[116:119], v6 offset:27648
    v_mfma_f32_16x16x32_bf16 v[184:187], v[120:123], a[96:99], v[184:187]
    buffer_load_dwordx4 a[180:183], v5, s[40:43], s20 offen offset:2048 sc1
    v_mfma_f32_16x16x32_bf16 v[184:187], v[124:127], a[104:107], v[184:187]
    s_waitcnt lgkmcnt(4)
    v_mfma_f32_16x16x32_bf16 v[184:187], v[128:131], a[112:115], v[184:187]
    v_mfma_f32_16x16x32_bf16 v[184:187], v[132:135], a[120:123], v[184:187]
    v_mfma_f32_16x16x32_bf16 v[188:191], v[120:123], a[100:103], v[188:191]
    buffer_load_dwordx4 a[188:191], v5, s[40:43], s20 offen offset:3072 sc1
    v_mfma_f32_16x16x32_bf16 v[188:191], v[124:127], a[108:111], v[188:191]
    s_xor_b32 s21, s3, 6
    ds_read_b128 v[120:123], v6 offset:4096
    ds_read_b128 v[124:127], v6 offset:12288
    v_mfma_f32_16x16x32_bf16 v[188:191], v[128:131], a[116:119], v[188:191]
    s_lshl2_add_u32 s21, s21, s4
    ds_read_b128 v[128:131], v6 offset:20480
    v_mfma_f32_16x16x32_bf16 v[188:191], v[132:135], a[124:127], v[188:191]
    s_mul_i32 s21, s21, 36864
    ds_read_b128 v[132:135], v6 offset:28672
    v_mfma_f32_16x16x32_bf16 v[192:195], v[136:139], a[96:99], v[192:195]
    s_add_u32 s21, s21, s28
    s_mov_b32 m0, s45
    v_mfma_f32_16x16x32_bf16 v[192:195], v[140:143], a[104:107], v[192:195]
    s_xor_b32 s20, s20, 12288
    buffer_load_dwordx4 v1, s[56:59], s21 offen sc1 lds
    v_mfma_f32_16x16x32_bf16 v[192:195], v[144:147], a[112:115], v[192:195]
    v_mfma_f32_16x16x32_bf16 v[192:195], v[148:151], a[120:123], v[192:195]
    v_mfma_f32_16x16x32_bf16 v[196:199], v[136:139], a[100:103], v[196:199]
    buffer_load_dwordx4 v1, s[56:59], s21 offen offset:1024 sc1 lds
    v_mfma_f32_16x16x32_bf16 v[196:199], v[140:143], a[108:111], v[196:199]
    ds_read_b128 v[136:139], v6 offset:5120
    ds_read_b128 v[140:143], v6 offset:13312
    v_mfma_f32_16x16x32_bf16 v[196:199], v[144:147], a[116:119], v[196:199]
    ds_read_b128 v[144:147], v6 offset:21504
    v_mfma_f32_16x16x32_bf16 v[196:199], v[148:151], a[124:127], v[196:199]
    s_waitcnt lgkmcnt(3)
    ds_read_b128 v[148:151], v6 offset:29696
    v_mfma_f32_16x16x32_bf16 v[200:203], v[104:107], a[96:99], v[200:203]
    v_mfma_f32_16x16x32_bf16 v[200:203], v[108:111], a[104:107], v[200:203]
    buffer_load_dwordx4 v1, s[56:59], s21 offen offset:2048 sc1 lds
    v_mfma_f32_16x16x32_bf16 v[200:203], v[112:115], a[112:115], v[200:203]
    v_mfma_f32_16x16x32_bf16 v[200:203], v[116:119], a[120:123], v[200:203]
    v_mfma_f32_16x16x32_bf16 v[204:207], v[104:107], a[100:103], v[204:207]
    ds_read_b128 v[104:107], v6 offset:6144
    v_mfma_f32_16x16x32_bf16 v[204:207], v[108:111], a[108:111], v[204:207]
    buffer_load_dwordx4 v1, s[56:59], s21 offen offset:3072 sc1 lds
    v_mfma_f32_16x16x32_bf16 v[204:207], v[112:115], a[116:119], v[204:207]
    s_add_u32 s21, s21, 4096
    ds_read_b128 v[108:111], v6 offset:14336
    ds_read_b128 v[112:115], v6 offset:22528
    v_mfma_f32_16x16x32_bf16 v[204:207], v[116:119], a[124:127], v[204:207]
    s_add_u32 m0, s45, 4096
    ds_read_b128 v[116:119], v6 offset:30720
    v_mfma_f32_16x16x32_bf16 v[208:211], v[120:123], a[96:99], v[208:211]
    v_mfma_f32_16x16x32_bf16 v[208:211], v[124:127], a[104:107], v[208:211]
    buffer_load_dwordx4 v1, s[56:59], s21 offen sc1 lds
    v_mfma_f32_16x16x32_bf16 v[208:211], v[128:131], a[112:115], v[208:211]
    v_mfma_f32_16x16x32_bf16 v[208:211], v[132:135], a[120:123], v[208:211]
    v_mfma_f32_16x16x32_bf16 v[212:215], v[120:123], a[100:103], v[212:215]
    v_mfma_f32_16x16x32_bf16 v[212:215], v[124:127], a[108:111], v[212:215]
    buffer_load_dwordx4 v1, s[56:59], s21 offen offset:1024 sc1 lds
    v_mfma_f32_16x16x32_bf16 v[212:215], v[128:131], a[116:119], v[212:215]
    v_mfma_f32_16x16x32_bf16 v[212:215], v[132:135], a[124:127], v[212:215]
    s_waitcnt lgkmcnt(0)
    v_mfma_f32_16x16x32_bf16 v[216:219], v[136:139], a[96:99], v[216:219]
    v_mfma_f32_16x16x32_bf16 v[216:219], v[140:143], a[104:107], v[216:219]
    buffer_load_dwordx4 v1, s[56:59], s21 offen offset:2048 sc1 lds
    v_mfma_f32_16x16x32_bf16 v[216:219], v[144:147], a[112:115], v[216:219]
    v_mfma_f32_16x16x32_bf16 v[216:219], v[148:151], a[120:123], v[216:219]
    s_waitcnt vmcnt(23)
    s_barrier
    ds_read_b128 v[120:123], v7 offset:0
    v_mfma_f32_16x16x32_bf16 v[220:223], v[136:139], a[100:103], v[220:223]
    ds_read_b128 v[124:127], v7 offset:8192
    ds_read_b128 v[128:131], v7 offset:16384
    v_mfma_f32_16x16x32_bf16 v[220:223], v[140:143], a[108:111], v[220:223]
    ds_read_b128 v[132:135], v7 offset:24576
    v_mfma_f32_16x16x32_bf16 v[220:223], v[144:147], a[116:119], v[220:223]
    buffer_load_dwordx4 a[192:195], v4, s[40:43], s63 offen offset:0 sc1
    v_mfma_f32_16x16x32_bf16 v[220:223], v[148:151], a[124:127], v[220:223]
    ds_read_b128 v[136:139], v7 offset:1024
    ds_read_b128 v[140:143], v7 offset:9216
    v_mfma_f32_16x16x32_bf16 v[224:227], v[104:107], a[96:99], v[224:227]
    ds_read_b128 v[144:147], v7 offset:17408
    v_mfma_f32_16x16x32_bf16 v[224:227], v[108:111], a[104:107], v[224:227]
    ds_read_b128 v[148:151], v7 offset:25600
    v_mfma_f32_16x16x32_bf16 v[224:227], v[112:115], a[112:115], v[224:227]
    buffer_load_dwordx4 a[200:203], v4, s[40:43], s63 offen offset:1024 sc1
    v_mfma_f32_16x16x32_bf16 v[224:227], v[116:119], a[120:123], v[224:227]
    v_mfma_f32_16x16x32_bf16 v[228:231], v[104:107], a[100:103], v[228:231]
    ds_read_b128 v[104:107], v7 offset:2048
    v_mfma_f32_16x16x32_bf16 v[228:231], v[108:111], a[108:111], v[228:231]
    ds_read_b128 v[108:111], v7 offset:10240
    v_mfma_f32_16x16x32_bf16 v[228:231], v[112:115], a[116:119], v[228:231]
    buffer_load_dwordx4 a[208:211], v4, s[40:43], s63 offen offset:2048 sc1
    v_mfma_f32_16x16x32_bf16 v[228:231], v[116:119], a[124:127], v[228:231]
    s_waitcnt lgkmcnt(2)
    ds_read_b128 v[112:115], v7 offset:18432
    ds_read_b128 v[116:119], v7 offset:26624
    v_mfma_f32_16x16x32_bf16 v[176:179], v[120:123], a[128:131], v[176:179]
    v_mfma_f32_16x16x32_bf16 v[176:179], v[124:127], a[136:139], v[176:179]
    v_mfma_f32_16x16x32_bf16 v[176:179], v[128:131], a[144:147], v[176:179]
    buffer_load_dwordx4 a[216:219], v4, s[40:43], s63 offen offset:3072 sc1
    v_mfma_f32_16x16x32_bf16 v[176:179], v[132:135], a[152:155], v[176:179]
    s_xor_b32 s63, s63, 4096
    v_mfma_f32_16x16x32_bf16 v[180:183], v[120:123], a[132:135], v[180:183]
    ds_read_b128 v[120:123], v7 offset:3072
    v_mfma_f32_16x16x32_bf16 v[180:183], v[124:127], a[140:143], v[180:183]
    ds_read_b128 v[124:127], v7 offset:11264
    v_mfma_f32_16x16x32_bf16 v[180:183], v[128:131], a[148:151], v[180:183]
    buffer_load_dwordx4 a[196:199], v5, s[40:43], s20 offen offset:0 sc1
    v_mfma_f32_16x16x32_bf16 v[180:183], v[132:135], a[156:159], v[180:183]
    ds_read_b128 v[128:131], v7 offset:19456
    ds_read_b128 v[132:135], v7 offset:27648
    v_mfma_f32_16x16x32_bf16 v[184:187], v[136:139], a[128:131], v[184:187]
    v_mfma_f32_16x16x32_bf16 v[184:187], v[140:143], a[136:139], v[184:187]
    v_mfma_f32_16x16x32_bf16 v[184:187], v[144:147], a[144:147], v[184:187]
    v_mfma_f32_16x16x32_bf16 v[184:187], v[148:151], a[152:155], v[184:187]
    buffer_load_dwordx4 a[204:207], v5, s[40:43], s20 offen offset:1024 sc1
    v_mfma_f32_16x16x32_bf16 v[188:191], v[136:139], a[132:135], v[188:191]
    ds_read_b128 v[136:139], v7 offset:4096
    v_mfma_f32_16x16x32_bf16 v[188:191], v[140:143], a[140:143], v[188:191]
    ds_read_b128 v[140:143], v7 offset:12288
    v_mfma_f32_16x16x32_bf16 v[188:191], v[144:147], a[148:151], v[188:191]
    ds_read_b128 v[144:147], v7 offset:20480
    v_mfma_f32_16x16x32_bf16 v[188:191], v[148:151], a[156:159], v[188:191]
    s_waitcnt lgkmcnt(3)
    buffer_load_dwordx4 a[212:215], v5, s[40:43], s20 offen offset:2048 sc1
    v_mfma_f32_16x16x32_bf16 v[192:195], v[104:107], a[128:131], v[192:195]
    ds_read_b128 v[148:151], v7 offset:28672
    v_mfma_f32_16x16x32_bf16 v[192:195], v[108:111], a[136:139], v[192:195]
    v_mfma_f32_16x16x32_bf16 v[192:195], v[112:115], a[144:147], v[192:195]
    v_mfma_f32_16x16x32_bf16 v[192:195], v[116:119], a[152:155], v[192:195]
    buffer_load_dwordx4 a[220:223], v5, s[40:43], s20 offen offset:3072 sc1
    v_mfma_f32_16x16x32_bf16 v[196:199], v[104:107], a[132:135], v[196:199]
    s_xor_b32 s21, s3, 7
    ds_read_b128 v[104:107], v7 offset:5120
    v_mfma_f32_16x16x32_bf16 v[196:199], v[108:111], a[140:143], v[196:199]
    s_lshl2_add_u32 s21, s21, s4
    ds_read_b128 v[108:111], v7 offset:13312
    v_mfma_f32_16x16x32_bf16 v[196:199], v[112:115], a[148:151], v[196:199]
    s_mul_i32 s21, s21, 36864
    ds_read_b128 v[112:115], v7 offset:21504
    v_mfma_f32_16x16x32_bf16 v[196:199], v[116:119], a[156:159], v[196:199]
    s_add_u32 s21, s21, s28
    s_mov_b32 m0, s46
    ds_read_b128 v[116:119], v7 offset:29696
    v_mfma_f32_16x16x32_bf16 v[200:203], v[120:123], a[128:131], v[200:203]
    s_xor_b32 s20, s20, 4096
    buffer_load_dwordx4 v1, s[56:59], s21 offen sc1 lds
    v_mfma_f32_16x16x32_bf16 v[200:203], v[124:127], a[136:139], v[200:203]
    v_mfma_f32_16x16x32_bf16 v[200:203], v[128:131], a[144:147], v[200:203]
    v_mfma_f32_16x16x32_bf16 v[200:203], v[132:135], a[152:155], v[200:203]
    buffer_load_dwordx4 v1, s[56:59], s21 offen offset:1024 sc1 lds
    v_mfma_f32_16x16x32_bf16 v[204:207], v[120:123], a[132:135], v[204:207]
    ds_read_b128 v[120:123], v7 offset:6144
    v_mfma_f32_16x16x32_bf16 v[204:207], v[124:127], a[140:143], v[204:207]
    ds_read_b128 v[124:127], v7 offset:14336
    v_mfma_f32_16x16x32_bf16 v[204:207], v[128:131], a[148:151], v[204:207]
    buffer_load_dword v3, v19, s[32:35], s66 offen sc1
    v_mfma_f32_16x16x32_bf16 v[204:207], v[132:135], a[156:159], v[204:207]
    s_waitcnt lgkmcnt(2)
    ds_read_b128 v[128:131], v7 offset:22528
    ds_read_b128 v[132:135], v7 offset:30720
    v_mfma_f32_16x16x32_bf16 v[208:211], v[136:139], a[128:131], v[208:211]
    buffer_load_dwordx4 v1, s[56:59], s21 offen offset:2048 sc1 lds
    v_mfma_f32_16x16x32_bf16 v[208:211], v[140:143], a[136:139], v[208:211]
    v_mfma_f32_16x16x32_bf16 v[208:211], v[144:147], a[144:147], v[208:211]
    v_mfma_f32_16x16x32_bf16 v[208:211], v[148:151], a[152:155], v[208:211]
    v_mfma_f32_16x16x32_bf16 v[212:215], v[136:139], a[132:135], v[212:215]
    buffer_load_dwordx4 v1, s[56:59], s21 offen offset:3072 sc1 lds
    v_mfma_f32_16x16x32_bf16 v[212:215], v[140:143], a[140:143], v[212:215]
    s_add_u32 s21, s21, 4096
    v_mfma_f32_16x16x32_bf16 v[212:215], v[144:147], a[148:151], v[212:215]
    s_add_u32 m0, s46, 4096
    v_mfma_f32_16x16x32_bf16 v[212:215], v[148:151], a[156:159], v[212:215]
    v_mfma_f32_16x16x32_bf16 v[216:219], v[104:107], a[128:131], v[216:219]
    buffer_load_dwordx4 v1, s[56:59], s21 offen sc1 lds
    v_mfma_f32_16x16x32_bf16 v[216:219], v[108:111], a[136:139], v[216:219]
    v_mfma_f32_16x16x32_bf16 v[216:219], v[112:115], a[144:147], v[216:219]
    v_mfma_f32_16x16x32_bf16 v[216:219], v[116:119], a[152:155], v[216:219]
    s_waitcnt vmcnt(21)
    s_barrier
    ds_read_b128 v[136:139], v11 offset:0
    v_mfma_f32_16x16x32_bf16 v[220:223], v[104:107], a[132:135], v[220:223]
    buffer_load_dwordx4 v1, s[56:59], s21 offen offset:1024 sc1 lds
    v_mfma_f32_16x16x32_bf16 v[220:223], v[108:111], a[140:143], v[220:223]
    ds_read_b128 v[140:143], v11 offset:8192
    ds_read_b128 v[144:147], v11 offset:16384
    v_mfma_f32_16x16x32_bf16 v[220:223], v[112:115], a[148:151], v[220:223]
    ds_read_b128 v[148:151], v11 offset:24576
    v_mfma_f32_16x16x32_bf16 v[220:223], v[116:119], a[156:159], v[220:223]
    s_waitcnt lgkmcnt(4)
    ds_read_b128 v[104:107], v11 offset:1024
    v_mfma_f32_16x16x32_bf16 v[224:227], v[120:123], a[128:131], v[224:227]
    buffer_load_dwordx4 v1, s[56:59], s21 offen offset:2048 sc1 lds
    v_mfma_f32_16x16x32_bf16 v[224:227], v[124:127], a[136:139], v[224:227]
    ds_read_b128 v[108:111], v11 offset:9216
    ds_read_b128 v[112:115], v11 offset:17408
    v_mfma_f32_16x16x32_bf16 v[224:227], v[128:131], a[144:147], v[224:227]
    ds_read_b128 v[116:119], v11 offset:25600
    v_mfma_f32_16x16x32_bf16 v[224:227], v[132:135], a[152:155], v[224:227]
    v_mfma_f32_16x16x32_bf16 v[228:231], v[120:123], a[132:135], v[228:231]
    ds_read_b128 v[120:123], v11 offset:2048
    v_mfma_f32_16x16x32_bf16 v[228:231], v[124:127], a[140:143], v[228:231]
    buffer_load_dwordx4 a[224:227], v4, s[40:43], s63 offen offset:0 sc1
    v_mfma_f32_16x16x32_bf16 v[228:231], v[128:131], a[148:151], v[228:231]
    ds_read_b128 v[124:127], v11 offset:10240
    ds_read_b128 v[128:131], v11 offset:18432
    v_mfma_f32_16x16x32_bf16 v[228:231], v[132:135], a[156:159], v[228:231]
    s_waitcnt lgkmcnt(3)
    ds_read_b128 v[132:135], v11 offset:26624
    v_mfma_f32_16x16x32_bf16 v[176:179], v[136:139], a[160:163], v[176:179]
    v_mfma_f32_16x16x32_bf16 v[176:179], v[140:143], a[168:171], v[176:179]
    buffer_load_dwordx4 a[232:235], v4, s[40:43], s63 offen offset:1024 sc1
    v_mfma_f32_16x16x32_bf16 v[176:179], v[144:147], a[176:179], v[176:179]
    v_mfma_f32_16x16x32_bf16 v[176:179], v[148:151], a[184:187], v[176:179]
    v_mfma_f32_16x16x32_bf16 v[180:183], v[136:139], a[164:167], v[180:183]
    ds_read_b128 v[136:139], v11 offset:3072
    v_mfma_f32_16x16x32_bf16 v[180:183], v[140:143], a[172:175], v[180:183]
    buffer_load_dwordx4 a[240:243], v4, s[40:43], s63 offen offset:2048 sc1
    v_mfma_f32_16x16x32_bf16 v[180:183], v[144:147], a[180:183], v[180:183]
    ds_read_b128 v[140:143], v11 offset:11264
    ds_read_b128 v[144:147], v11 offset:19456
    v_mfma_f32_16x16x32_bf16 v[180:183], v[148:151], a[188:191], v[180:183]
    ds_read_b128 v[148:151], v11 offset:27648
    v_mfma_f32_16x16x32_bf16 v[184:187], v[104:107], a[160:163], v[184:187]
    v_mfma_f32_16x16x32_bf16 v[184:187], v[108:111], a[168:171], v[184:187]
    buffer_load_dwordx4 a[248:251], v4, s[40:43], s63 offen offset:3072 sc1
    v_mfma_f32_16x16x32_bf16 v[184:187], v[112:115], a[176:179], v[184:187]
    s_add_u32 s63, s63, 4096
    v_mfma_f32_16x16x32_bf16 v[184:187], v[116:119], a[184:187], v[184:187]
    v_mfma_f32_16x16x32_bf16 v[188:191], v[104:107], a[164:167], v[188:191]
    ds_read_b128 v[104:107], v11 offset:4096
    v_mfma_f32_16x16x32_bf16 v[188:191], v[108:111], a[172:175], v[188:191]
    buffer_load_dwordx4 a[228:231], v5, s[40:43], s20 offen offset:0 sc1
    v_mfma_f32_16x16x32_bf16 v[188:191], v[112:115], a[180:183], v[188:191]
    ds_read_b128 v[108:111], v11 offset:12288
    ds_read_b128 v[112:115], v11 offset:20480
    v_mfma_f32_16x16x32_bf16 v[188:191], v[116:119], a[188:191], v[188:191]
    s_waitcnt lgkmcnt(3)
    ds_read_b128 v[116:119], v11 offset:28672
    v_mfma_f32_16x16x32_bf16 v[192:195], v[120:123], a[160:163], v[192:195]
    v_mfma_f32_16x16x32_bf16 v[192:195], v[124:127], a[168:171], v[192:195]
    v_mfma_f32_16x16x32_bf16 v[192:195], v[128:131], a[176:179], v[192:195]
    buffer_load_dwordx4 a[236:239], v5, s[40:43], s20 offen offset:1024 sc1
    v_mfma_f32_16x16x32_bf16 v[192:195], v[132:135], a[184:187], v[192:195]
    v_mfma_f32_16x16x32_bf16 v[196:199], v[120:123], a[164:167], v[196:199]
    ds_read_b128 v[120:123], v11 offset:5120
    v_mfma_f32_16x16x32_bf16 v[196:199], v[124:127], a[172:175], v[196:199]
    ds_read_b128 v[124:127], v11 offset:13312
    v_mfma_f32_16x16x32_bf16 v[196:199], v[128:131], a[180:183], v[196:199]
    buffer_load_dwordx4 a[244:247], v5, s[40:43], s20 offen offset:2048 sc1
    v_mfma_f32_16x16x32_bf16 v[196:199], v[132:135], a[188:191], v[196:199]
    ds_read_b128 v[128:131], v11 offset:21504
    ds_read_b128 v[132:135], v11 offset:29696
    v_mfma_f32_16x16x32_bf16 v[200:203], v[136:139], a[160:163], v[200:203]
    v_mfma_f32_16x16x32_bf16 v[200:203], v[140:143], a[168:171], v[200:203]
    v_mfma_f32_16x16x32_bf16 v[200:203], v[144:147], a[176:179], v[200:203]
    buffer_load_dwordx4 a[252:255], v5, s[40:43], s20 offen offset:3072 sc1
    v_mfma_f32_16x16x32_bf16 v[200:203], v[148:151], a[184:187], v[200:203]
    s_mul_i32 s21, s61, 6
    s_add_u32 s21, s4, s21
    v_mfma_f32_16x16x32_bf16 v[204:207], v[136:139], a[164:167], v[204:207]
    s_add_u32 s21, s21, 128
    ds_read_b128 v[136:139], v11 offset:6144
    v_mfma_f32_16x16x32_bf16 v[204:207], v[140:143], a[172:175], v[204:207]
    s_mul_i32 s21, s21, 36864
    ds_read_b128 v[140:143], v11 offset:14336
    v_mfma_f32_16x16x32_bf16 v[204:207], v[144:147], a[180:183], v[204:207]
    s_add_u32 s21, s21, s28
    s_mov_b32 m0, s47
    ds_read_b128 v[144:147], v11 offset:22528
    v_mfma_f32_16x16x32_bf16 v[204:207], v[148:151], a[188:191], v[204:207]
    s_add_u32 s20, s20, 4096
    buffer_load_dwordx4 v1, s[56:59], s21 offen sc1 lds
    s_waitcnt lgkmcnt(3)
    v_mfma_f32_16x16x32_bf16 v[208:211], v[104:107], a[160:163], v[208:211]
    ds_read_b128 v[148:151], v11 offset:30720
    v_mfma_f32_16x16x32_bf16 v[208:211], v[108:111], a[168:171], v[208:211]
    v_mfma_f32_16x16x32_bf16 v[208:211], v[112:115], a[176:179], v[208:211]
    buffer_load_dwordx4 v1, s[56:59], s21 offen offset:1024 sc1 lds
    v_mfma_f32_16x16x32_bf16 v[208:211], v[116:119], a[184:187], v[208:211]
    v_mfma_f32_16x16x32_bf16 v[212:215], v[104:107], a[164:167], v[212:215]
    v_mfma_f32_16x16x32_bf16 v[212:215], v[108:111], a[172:175], v[212:215]
    v_mfma_f32_16x16x32_bf16 v[212:215], v[112:115], a[180:183], v[212:215]
    v_mfma_f32_16x16x32_bf16 v[212:215], v[116:119], a[188:191], v[212:215]
    buffer_load_dwordx4 v1, s[56:59], s21 offen offset:2048 sc1 lds
    v_mfma_f32_16x16x32_bf16 v[216:219], v[120:123], a[160:163], v[216:219]
    v_mfma_f32_16x16x32_bf16 v[216:219], v[124:127], a[168:171], v[216:219]
    v_mfma_f32_16x16x32_bf16 v[216:219], v[128:131], a[176:179], v[216:219]
    v_mfma_f32_16x16x32_bf16 v[216:219], v[132:135], a[184:187], v[216:219]
    buffer_load_dwordx4 v1, s[56:59], s21 offen offset:3072 sc1 lds
    s_waitcnt vmcnt(17)
    v_cmp_gt_u32 vcc, 3, v3
    s_nop 1
    s_and_b64 vcc, vcc, exec
    s_cbranch_scc1 SPIN_OA
BACK_OA:
    s_barrier
    v_mfma_f32_16x16x32_bf16 v[220:223], v[120:123], a[164:167], v[220:223]
    s_add_u32 s21, s21, 4096
    ds_read_b128 v[104:107], v12 offset:0
    ds_read_b128 v[108:111], v12 offset:8192
    v_mfma_f32_16x16x32_bf16 v[220:223], v[124:127], a[172:175], v[220:223]
    s_add_u32 m0, s47, 4096
    ds_read_b128 v[112:115], v12 offset:16384
    v_mfma_f32_16x16x32_bf16 v[220:223], v[128:131], a[180:183], v[220:223]
    ds_read_b128 v[116:119], v12 offset:24576
    v_mfma_f32_16x16x32_bf16 v[220:223], v[132:135], a[188:191], v[220:223]
    s_waitcnt lgkmcnt(4)
    buffer_load_dwordx4 v1, s[56:59], s21 offen sc1 lds
    v_mfma_f32_16x16x32_bf16 v[224:227], v[136:139], a[160:163], v[224:227]
    ds_read_b128 v[120:123], v12 offset:1024
    ds_read_b128 v[124:127], v12 offset:9216
    v_mfma_f32_16x16x32_bf16 v[224:227], v[140:143], a[168:171], v[224:227]
    ds_read_b128 v[128:131], v12 offset:17408
    v_mfma_f32_16x16x32_bf16 v[224:227], v[144:147], a[176:179], v[224:227]
    ds_read_b128 v[132:135], v12 offset:25600
    v_mfma_f32_16x16x32_bf16 v[224:227], v[148:151], a[184:187], v[224:227]
    buffer_load_dwordx4 v1, s[56:59], s21 offen offset:1024 sc1 lds
    v_mfma_f32_16x16x32_bf16 v[228:231], v[136:139], a[164:167], v[228:231]
    ds_read_b128 v[136:139], v12 offset:2048
    v_mfma_f32_16x16x32_bf16 v[228:231], v[140:143], a[172:175], v[228:231]
    ds_read_b128 v[140:143], v12 offset:10240
    v_mfma_f32_16x16x32_bf16 v[228:231], v[144:147], a[180:183], v[228:231]
    ds_read_b128 v[144:147], v12 offset:18432
    v_mfma_f32_16x16x32_bf16 v[228:231], v[148:151], a[188:191], v[228:231]
    s_waitcnt lgkmcnt(3)
    buffer_load_dwordx4 v1, s[56:59], s21 offen offset:2048 sc1 lds
    v_mfma_f32_16x16x32_bf16 v[176:179], v[104:107], a[192:195], v[176:179]
    ds_read_b128 v[148:151], v12 offset:26624
    v_mfma_f32_16x16x32_bf16 v[176:179], v[108:111], a[200:203], v[176:179]
    s_mul_i32 s63, s61, 6144
    v_mfma_f32_16x16x32_bf16 v[176:179], v[112:115], a[208:211], v[176:179]
    s_add_u32 s63, s63, 131072
    v_mfma_f32_16x16x32_bf16 v[176:179], v[116:119], a[216:219], v[176:179]
    v_mfma_f32_16x16x32_bf16 v[180:183], v[104:107], a[196:199], v[180:183]
    buffer_load_dwordx4 v[32:35], v4, s[40:43], s63 offen offset:0 sc1
    v_mfma_f32_16x16x32_bf16 v[180:183], v[108:111], a[204:207], v[180:183]
    ds_read_b128 v[104:107], v12 offset:3072
    ds_read_b128 v[108:111], v12 offset:11264
    v_mfma_f32_16x16x32_bf16 v[180:183], v[112:115], a[212:215], v[180:183]
    ds_read_b128 v[112:115], v12 offset:19456
    v_mfma_f32_16x16x32_bf16 v[180:183], v[116:119], a[220:223], v[180:183]
    ds_read_b128 v[116:119], v12 offset:27648
    v_mfma_f32_16x16x32_bf16 v[184:187], v[120:123], a[192:195], v[184:187]
    buffer_load_dwordx4 v[40:43], v4, s[40:43], s63 offen offset:1024 sc1
    v_mfma_f32_16x16x32_bf16 v[184:187], v[124:127], a[200:203], v[184:187]
    v_mfma_f32_16x16x32_bf16 v[184:187], v[128:131], a[208:211], v[184:187]
    v_mfma_f32_16x16x32_bf16 v[184:187], v[132:135], a[216:219], v[184:187]
    v_mfma_f32_16x16x32_bf16 v[188:191], v[120:123], a[196:199], v[188:191]
    buffer_load_dwordx4 v[48:51], v4, s[40:43], s63 offen offset:2048 sc1
    v_mfma_f32_16x16x32_bf16 v[188:191], v[124:127], a[204:207], v[188:191]
    ds_read_b128 v[120:123], v12 offset:4096
    ds_read_b128 v[124:127], v12 offset:12288
    v_mfma_f32_16x16x32_bf16 v[188:191], v[128:131], a[212:215], v[188:191]
    ds_read_b128 v[128:131], v12 offset:20480
    v_mfma_f32_16x16x32_bf16 v[188:191], v[132:135], a[220:223], v[188:191]
    s_waitcnt lgkmcnt(3)
    ds_read_b128 v[132:135], v12 offset:28672
    v_mfma_f32_16x16x32_bf16 v[192:195], v[136:139], a[192:195], v[192:195]
    buffer_load_dwordx4 v[56:59], v4, s[40:43], s63 offen offset:3072 sc1
    v_mfma_f32_16x16x32_bf16 v[192:195], v[140:143], a[200:203], v[192:195]
    s_mul_i32 s20, s61, 6144
    v_mfma_f32_16x16x32_bf16 v[192:195], v[144:147], a[208:211], v[192:195]
    s_add_u32 s20, s20, 131072
    v_mfma_f32_16x16x32_bf16 v[192:195], v[148:151], a[216:219], v[192:195]
    s_add_u32 s63, s63, 4096
    v_mfma_f32_16x16x32_bf16 v[196:199], v[136:139], a[196:199], v[196:199]
    buffer_load_dwordx4 v[36:39], v5, s[40:43], s20 offen offset:0 sc1
    v_mfma_f32_16x16x32_bf16 v[196:199], v[140:143], a[204:207], v[196:199]
    ds_read_b128 v[136:139], v12 offset:5120
    ds_read_b128 v[140:143], v12 offset:13312
    v_mfma_f32_16x16x32_bf16 v[196:199], v[144:147], a[212:215], v[196:199]
    ds_read_b128 v[144:147], v12 offset:21504
    v_mfma_f32_16x16x32_bf16 v[196:199], v[148:151], a[220:223], v[196:199]
    ds_read_b128 v[148:151], v12 offset:29696
    v_mfma_f32_16x16x32_bf16 v[200:203], v[104:107], a[192:195], v[200:203]
    v_mfma_f32_16x16x32_bf16 v[200:203], v[108:111], a[200:203], v[200:203]
    buffer_load_dwordx4 v[44:47], v5, s[40:43], s20 offen offset:1024 sc1
    v_mfma_f32_16x16x32_bf16 v[200:203], v[112:115], a[208:211], v[200:203]
    v_mfma_f32_16x16x32_bf16 v[200:203], v[116:119], a[216:219], v[200:203]
    v_mfma_f32_16x16x32_bf16 v[204:207], v[104:107], a[196:199], v[204:207]
    ds_read_b128 v[104:107], v12 offset:6144
    v_mfma_f32_16x16x32_bf16 v[204:207], v[108:111], a[204:207], v[204:207]
    buffer_load_dwordx4 v[52:55], v5, s[40:43], s20 offen offset:2048 sc1
    v_mfma_f32_16x16x32_bf16 v[204:207], v[112:115], a[212:215], v[204:207]
    ds_read_b128 v[108:111], v12 offset:14336
    ds_read_b128 v[112:115], v12 offset:22528
    v_mfma_f32_16x16x32_bf16 v[204:207], v[116:119], a[220:223], v[204:207]
    s_waitcnt lgkmcnt(3)
    ds_read_b128 v[116:119], v12 offset:30720
    v_mfma_f32_16x16x32_bf16 v[208:211], v[120:123], a[192:195], v[208:211]
    v_mfma_f32_16x16x32_bf16 v[208:211], v[124:127], a[200:203], v[208:211]
    buffer_load_dwordx4 v[60:63], v5, s[40:43], s20 offen offset:3072 sc1
    v_mfma_f32_16x16x32_bf16 v[208:211], v[128:131], a[208:211], v[208:211]
    s_mul_i32 s21, s61, 6
    s_lshr_b32 s64, s4, 1
    s_add_u32 s21, s21, s64
    v_mfma_f32_16x16x32_bf16 v[208:211], v[132:135], a[216:219], v[208:211]
    s_add_u32 s21, s21, 132
    s_mul_i32 s21, s21, 36864
    v_mfma_f32_16x16x32_bf16 v[212:215], v[120:123], a[196:199], v[212:215]
    s_add_u32 s21, s21, s28
    s_and_b32 s64, s69, 4096
    v_mfma_f32_16x16x32_bf16 v[212:215], v[124:127], a[204:207], v[212:215]
    s_add_u32 s21, s21, s64
    s_mov_b32 m0, s79
    v_mfma_f32_16x16x32_bf16 v[212:215], v[128:131], a[212:215], v[212:215]
    s_add_u32 s20, s20, 4096
    buffer_load_dwordx4 v1, s[56:59], s21 offen sc1 lds
    v_mfma_f32_16x16x32_bf16 v[212:215], v[132:135], a[220:223], v[212:215]
    v_mfma_f32_16x16x32_bf16 v[216:219], v[136:139], a[192:195], v[216:219]
    v_mfma_f32_16x16x32_bf16 v[216:219], v[140:143], a[200:203], v[216:219]
    buffer_load_dwordx4 v1, s[56:59], s21 offen offset:1024 sc1 lds
    v_mfma_f32_16x16x32_bf16 v[216:219], v[144:147], a[208:211], v[216:219]
    v_mfma_f32_16x16x32_bf16 v[216:219], v[148:151], a[216:219], v[216:219]
    s_waitcnt vmcnt(17)
    s_barrier
    ds_read_b128 v[120:123], v13 offset:0
    v_mfma_f32_16x16x32_bf16 v[220:223], v[136:139], a[196:199], v[220:223]
    ds_read_b128 v[124:127], v13 offset:8192
    ds_read_b128 v[128:131], v13 offset:16384
    v_mfma_f32_16x16x32_bf16 v[220:223], v[140:143], a[204:207], v[220:223]
    ds_read_b128 v[132:135], v13 offset:24576
    v_mfma_f32_16x16x32_bf16 v[220:223], v[144:147], a[212:215], v[220:223]
    buffer_load_dwordx4 v1, s[56:59], s21 offen offset:2048 sc1 lds
    v_mfma_f32_16x16x32_bf16 v[220:223], v[148:151], a[220:223], v[220:223]
    s_waitcnt lgkmcnt(4)
    ds_read_b128 v[136:139], v13 offset:1024
    ds_read_b128 v[140:143], v13 offset:9216
    v_mfma_f32_16x16x32_bf16 v[224:227], v[104:107], a[192:195], v[224:227]
    ds_read_b128 v[144:147], v13 offset:17408
    v_mfma_f32_16x16x32_bf16 v[224:227], v[108:111], a[200:203], v[224:227]
    ds_read_b128 v[148:151], v13 offset:25600
    v_mfma_f32_16x16x32_bf16 v[224:227], v[112:115], a[208:211], v[224:227]
    buffer_load_dwordx4 v1, s[56:59], s21 offen offset:3072 sc1 lds
    v_mfma_f32_16x16x32_bf16 v[224:227], v[116:119], a[216:219], v[224:227]
    v_mfma_f32_16x16x32_bf16 v[228:231], v[104:107], a[196:199], v[228:231]
    ds_read_b128 v[104:107], v13 offset:2048
    v_mfma_f32_16x16x32_bf16 v[228:231], v[108:111], a[204:207], v[228:231]
    ds_read_b128 v[108:111], v13 offset:10240
    v_mfma_f32_16x16x32_bf16 v[228:231], v[112:115], a[212:215], v[228:231]
    buffer_load_dwordx4 v[64:67], v4, s[40:43], s63 offen offset:0 sc1
    v_mfma_f32_16x16x32_bf16 v[228:231], v[116:119], a[220:223], v[228:231]
    s_waitcnt lgkmcnt(2)
    ds_read_b128 v[112:115], v13 offset:18432
    ds_read_b128 v[116:119], v13 offset:26624
    v_mfma_f32_16x16x32_bf16 v[176:179], v[120:123], a[224:227], v[176:179]
    s_add_u32 s23, s5, 8
    v_lshrrev_b32 v19, 4, v1
    v_min_u32 v19, 2, v19
    v_mfma_f32_16x16x32_bf16 v[176:179], v[124:127], a[232:235], v[176:179]
    s_and_b32 s65, s5, 3
    v_lshl_add_u32 v19, v19, 3, s23
    v_bfe_u32 v20, v1, 4, 4
    v_mfma_f32_16x16x32_bf16 v[176:179], v[128:131], a[240:243], v[176:179]
    s_lshl3_add_u32 s23, s6, s62
    buffer_load_dwordx4 v[72:75], v4, s[40:43], s63 offen offset:1024 sc1
    v_mfma_f32_16x16x32_bf16 v[176:179], v[132:135], a[248:251], v[176:179]
    s_add_u32 s63, s63, 4096
    v_lshrrev_b32 v21, 8, v1
    v_and_b32 v19, 31, v19
    v_mfma_f32_16x16x32_bf16 v[180:183], v[120:123], a[228:231], v[180:183]
    s_lshl_b32 s23, s23, 4
    ds_read_b128 v[120:123], v13 offset:3072
    v_add_u32 v20, s23, v20
    v_mfma_f32_16x16x32_bf16 v[180:183], v[124:127], a[236:239], v[180:183]
    s_mul_i32 s23, s6, 294912
    ds_read_b128 v[124:127], v13 offset:11264
    v_mul_u32_u24 v20, 1152, v20
    v_mfma_f32_16x16x32_bf16 v[180:183], v[128:131], a[244:247], v[180:183]
    s_sub_u32 s23, 2211840, s23
    buffer_load_dwordx4 v[68:71], v5, s[40:43], s20 offen offset:0 sc1
    v_mfma_f32_16x16x32_bf16 v[180:183], v[132:135], a[252:255], v[180:183]
    s_mul_i32 s70, s4, 3072
    ds_read_b128 v[128:131], v13 offset:19456
    ds_read_b128 v[132:135], v13 offset:27648
    v_mfma_f32_16x16x32_bf16 v[184:187], v[136:139], a[224:227], v[184:187]
    s_andn2_b32 s66, s74, 0xfff
    v_lshl_add_u32 v20, v21, 3, v20
    v_add_u32 v21, s23, v20
    v_mfma_f32_16x16x32_bf16 v[184:187], v[140:143], a[232:235], v[184:187]
    s_mul_i32 s23, s101, 288
    v_mov_b32 v31, 3
    v_lshlrev_b32 v23, 20, v1
    v_mfma_f32_16x16x32_bf16 v[184:187], v[144:147], a[240:243], v[184:187]
    s_add_u32 s23, s23, s70
    v_lshlrev_b32 v19, 7, v19
    v_bfe_u32 v92, v1, 6, 2
    v_mfma_f32_16x16x32_bf16 v[184:187], v[148:151], a[248:251], v[184:187]
    s_add_u32 s98, s23, 0
    buffer_load_dwordx4 v[76:79], v5, s[40:43], s20 offen offset:1024 sc1
    v_mfma_f32_16x16x32_bf16 v[188:191], v[136:139], a[228:231], v[188:191]
    s_add_u32 s21, s4, 0
    s_xor_b32 s21, s21, s3
    s_lshl_b32 s21, s21, 2
    v_mfma_f32_16x16x32_bf16 v[188:191], v[140:143], a[236:239], v[188:191]
    s_mul_i32 s21, s21, 36864
    ds_read_b128 v[136:139], v13 offset:4096
    ds_read_b128 v[140:143], v13 offset:12288
    v_mfma_f32_16x16x32_bf16 v[188:191], v[144:147], a[244:247], v[188:191]
    s_add_u32 s21, s21, s28
    ds_read_b128 v[144:147], v13 offset:20480
    v_lshrrev_b32 v93, 8, v1
    v_mfma_f32_16x16x32_bf16 v[188:191], v[148:151], a[252:255], v[188:191]
    s_add_u32 s21, s21, 7168
    s_add_u32 m0, s44, 0
    ds_read_b128 v[148:151], v13 offset:28672
    s_waitcnt lgkmcnt(4)
    v_mfma_f32_16x16x32_bf16 v[192:195], v[104:107], a[224:227], v[192:195]
    s_add_u32 s20, s20, 4096
    buffer_load_dwordx4 v1, s[56:59], s21 offen sc1 lds
    v_mfma_f32_16x16x32_bf16 v[192:195], v[108:111], a[232:235], v[192:195]
    v_cmp_eq_u32 vcc, v92, v93
    v_and_b32 v92, 16, v1
    v_mfma_f32_16x16x32_bf16 v[192:195], v[112:115], a[240:243], v[192:195]
    v_mov_b32 v93, 0x3f80
    v_lshlrev_b32 v92, v92, v93
    v_mfma_f32_16x16x32_bf16 v[192:195], v[116:119], a[248:251], v[192:195]
    buffer_load_dwordx4 v1, s[56:59], s21 offen offset:1024 sc1 lds
    v_mfma_f32_16x16x32_bf16 v[196:199], v[104:107], a[228:231], v[196:199]
    s_add_u32 s21, s21, 36864
    ds_read_b128 v[104:107], v13 offset:5120
    v_and_b32 v93, 32, v1
    v_mfma_f32_16x16x32_bf16 v[196:199], v[108:111], a[236:239], v[196:199]
    s_add_u32 m0, s44, 2048
    ds_read_b128 v[108:111], v13 offset:13312
    v_cndmask_b32 v92, 0, v92, vcc
    v_mfma_f32_16x16x32_bf16 v[196:199], v[112:115], a[244:247], v[196:199]
    ds_read_b128 v[112:115], v13 offset:21504
    v_cmp_eq_u32 vcc, 0, v93
    v_mfma_f32_16x16x32_bf16 v[196:199], v[116:119], a[252:255], v[196:199]
    buffer_load_dwordx4 v1, s[56:59], s21 offen sc1 lds
    v_mfma_f32_16x16x32_bf16 v[200:203], v[120:123], a[224:227], v[200:203]
    ds_read_b128 v[116:119], v13 offset:29696
    v_cndmask_b32 v96, 0, v92, vcc
    v_mfma_f32_16x16x32_bf16 v[200:203], v[124:127], a[232:235], v[200:203]
    v_cndmask_b32_e64 v97, v92, 0, vcc
    v_mov_b32 v98, 0
    v_mfma_f32_16x16x32_bf16 v[200:203], v[128:131], a[240:243], v[200:203]
    v_mov_b32 v99, 0
    v_mov_b32 v100, v96
    v_mfma_f32_16x16x32_bf16 v[200:203], v[132:135], a[248:251], v[200:203]
    buffer_load_dwordx4 v1, s[56:59], s21 offen offset:1024 sc1 lds
    v_mfma_f32_16x16x32_bf16 v[204:207], v[120:123], a[228:231], v[204:207]
    ds_read_b128 v[120:123], v13 offset:6144
    v_mov_b32 v101, v97
    v_mfma_f32_16x16x32_bf16 v[204:207], v[124:127], a[236:239], v[204:207]
    s_add_u32 s21, s21, 36864
    ds_read_b128 v[124:127], v13 offset:14336
    v_mfma_f32_16x16x32_bf16 v[204:207], v[128:131], a[244:247], v[204:207]
    s_add_u32 m0, s44, 4096
    ds_read_b128 v[128:131], v13 offset:22528
    v_mfma_f32_16x16x32_bf16 v[204:207], v[132:135], a[252:255], v[204:207]
    s_waitcnt lgkmcnt(3)
    ds_read_b128 v[132:135], v13 offset:30720
    v_mfma_f32_16x16x32_bf16 v[208:211], v[136:139], a[224:227], v[208:211]
    buffer_load_dwordx4 v1, s[56:59], s21 offen sc1 lds
    v_mfma_f32_16x16x32_bf16 v[208:211], v[140:143], a[232:235], v[208:211]
    v_mfma_f32_16x16x32_bf16 v[208:211], v[144:147], a[240:243], v[208:211]
    v_mfma_f32_16x16x32_bf16 v[208:211], v[148:151], a[248:251], v[208:211]
    v_mfma_f32_16x16x32_bf16 v[212:215], v[136:139], a[228:231], v[212:215]
    buffer_load_dwordx4 v1, s[56:59], s21 offen offset:1024 sc1 lds
    v_mfma_f32_16x16x32_bf16 v[212:215], v[140:143], a[236:239], v[212:215]
    s_add_u32 s21, s21, 36864
    v_mfma_f32_16x16x32_bf16 v[212:215], v[144:147], a[244:247], v[212:215]
    s_add_u32 m0, s44, 6144
    v_mfma_f32_16x16x32_bf16 v[212:215], v[148:151], a[252:255], v[212:215]
    v_mfma_f32_16x16x32_bf16 v[216:219], v[104:107], a[224:227], v[216:219]
    buffer_load_dwordx4 v1, s[56:59], s21 offen sc1 lds
    v_mfma_f32_16x16x32_bf16 v[216:219], v[108:111], a[232:235], v[216:219]
    v_mfma_f32_16x16x32_bf16 v[216:219], v[112:115], a[240:243], v[216:219]
    v_mfma_f32_16x16x32_bf16 v[216:219], v[116:119], a[248:251], v[216:219]
    s_waitcnt vmcnt(15)
    s_barrier
    ds_read_b128 v[136:139], v6 offset:0
    v_mfma_f32_16x16x32_bf16 v[220:223], v[104:107], a[228:231], v[220:223]
    buffer_load_dwordx4 v1, s[56:59], s21 offen offset:1024 sc1 lds
    v_mfma_f32_16x16x32_bf16 v[220:223], v[108:111], a[236:239], v[220:223]
    s_add_u32 s21, s21, 36864
    s_add_u32 s21, s4, 4
    s_xor_b32 s21, s21, s3
    v_mfma_f32_16x16x32_bf16 v[220:223], v[112:115], a[244:247], v[220:223]
    s_lshl_b32 s21, s21, 2
    s_mul_i32 s21, s21, 36864
    ds_read_b128 v[140:143], v6 offset:8192
    v_mfma_f32_16x16x32_bf16 v[220:223], v[116:119], a[252:255], v[220:223]
    s_add_u32 s21, s21, s28
    ds_read_b128 v[144:147], v6 offset:1024
    ds_read_b128 v[148:151], v6 offset:9216
    s_waitcnt lgkmcnt(4)
    v_mfma_f32_16x16x32_bf16 v[224:227], v[120:123], a[224:227], v[224:227]
    s_add_u32 s21, s21, 7168
    s_add_u32 m0, s45, 0
    ds_read_b128 v[104:107], v6 offset:2048
    v_mfma_f32_16x16x32_bf16 v[224:227], v[124:127], a[232:235], v[224:227]
    buffer_load_dwordx4 v1, s[56:59], s21 offen sc1 lds
    v_mfma_f32_16x16x32_bf16 v[224:227], v[128:131], a[240:243], v[224:227]
    ds_read_b128 v[108:111], v6 offset:10240
    ds_read_b128 v[112:115], v6 offset:3072
    v_mfma_f32_16x16x32_bf16 v[224:227], v[132:135], a[248:251], v[224:227]
    ds_read_b128 v[116:119], v6 offset:11264
    v_mfma_f32_16x16x32_bf16 v[228:231], v[120:123], a[228:231], v[228:231]
    ds_read_b128 v[120:123], v6 offset:4096
    v_mfma_f32_16x16x32_bf16 v[228:231], v[124:127], a[236:239], v[228:231]
    buffer_load_dwordx4 v1, s[56:59], s21 offen offset:1024 sc1 lds
    v_mfma_f32_16x16x32_bf16 v[228:231], v[128:131], a[244:247], v[228:231]
    s_add_u32 s21, s21, 36864
    ds_read_b128 v[124:127], v6 offset:12288
    ds_read_b128 v[128:131], v6 offset:5120
    v_mfma_f32_16x16x32_bf16 v[228:231], v[132:135], a[252:255], v[228:231]
    s_add_u32 m0, s45, 2048
    ds_read_b128 v[132:135], v6 offset:13312
    s_waitcnt lgkmcnt(5)
    v_mfma_f32_16x16x32_bf16 v[176:179], v[136:139], v[32:35], v[176:179]
    v_mfma_f32_16x16x32_bf16 v[176:179], v[140:143], v[40:43], v[176:179]
    buffer_load_dwordx4 v1, s[56:59], s21 offen sc1 lds
    v_mfma_f32_16x16x32_bf16 v[180:183], v[136:139], v[36:39], v[180:183]
    ds_read_b128 v[136:139], v6 offset:6144
    v_mfma_f32_16x16x32_bf16 v[180:183], v[140:143], v[44:47], v[180:183]
    ds_read_b128 v[140:143], v6 offset:14336
    v_mfma_f32_16x16x32_bf16 v[184:187], v[144:147], v[32:35], v[184:187]
    v_mfma_f32_16x16x32_bf16 v[184:187], v[148:151], v[40:43], v[184:187]
    buffer_load_dwordx4 v1, s[56:59], s21 offen offset:1024 sc1 lds
    v_mfma_f32_16x16x32_bf16 v[188:191], v[144:147], v[36:39], v[188:191]
    s_add_u32 s21, s21, 36864
    ds_read_b128 v[144:147], v6 offset:16384
    v_mfma_f32_16x16x32_bf16 v[188:191], v[148:151], v[44:47], v[188:191]
    s_add_u32 m0, s45, 4096
    ds_read_b128 v[148:151], v6 offset:24576
    v_mfma_f32_16x16x32_bf16 v[192:195], v[104:107], v[32:35], v[192:195]
    v_mfma_f32_16x16x32_bf16 v[192:195], v[108:111], v[40:43], v[192:195]
    buffer_load_dwordx4 v1, s[56:59], s21 offen sc1 lds
    v_mfma_f32_16x16x32_bf16 v[196:199], v[104:107], v[36:39], v[196:199]
    v_mfma_f32_16x16x32_bf16 v[196:199], v[108:111], v[44:47], v[196:199]
    v_mfma_f32_16x16x32_bf16 v[200:203], v[112:115], v[32:35], v[200:203]
    s_waitcnt lgkmcnt(0)
    v_mfma_f32_16x16x32_bf16 v[200:203], v[116:119], v[40:43], v[200:203]
    buffer_load_dwordx4 v1, s[56:59], s21 offen offset:1024 sc1 lds
    v_mfma_f32_16x16x32_bf16 v[204:207], v[112:115], v[36:39], v[204:207]
    ds_read_b128 v[112:115], v6 offset:17408
    v_mfma_f32_16x16x32_bf16 v[204:207], v[116:119], v[44:47], v[204:207]
    s_waitcnt vmcnt(14)
    s_barrier
    ds_read_b128 v[104:107], v7 offset:0
    v_mfma_f32_16x16x32_bf16 v[208:211], v[120:123], v[32:35], v[208:211]
    s_add_u32 s21, s21, 36864
    ds_read_b128 v[108:111], v7 offset:16384
    ds_read_b128 v[116:119], v6 offset:25600
    v_mfma_f32_16x16x32_bf16 v[208:211], v[124:127], v[40:43], v[208:211]
    s_add_u32 m0, s45, 6144
    v_mfma_f32_16x16x32_bf16 v[212:215], v[120:123], v[36:39], v[212:215]
    buffer_load_dwordx4 v1, s[56:59], s21 offen sc1 lds
    v_mfma_f32_16x16x32_bf16 v[212:215], v[124:127], v[44:47], v[212:215]
    ds_read_b128 v[120:123], v7 offset:1024
    ds_read_b128 v[124:127], v7 offset:17408
    v_mfma_f32_16x16x32_bf16 v[216:219], v[128:131], v[32:35], v[216:219]
    v_mfma_f32_16x16x32_bf16 v[216:219], v[132:135], v[40:43], v[216:219]
    v_mfma_f32_16x16x32_bf16 v[220:223], v[128:131], v[36:39], v[220:223]
    buffer_load_dwordx4 v1, s[56:59], s21 offen offset:1024 sc1 lds
    v_mfma_f32_16x16x32_bf16 v[220:223], v[132:135], v[44:47], v[220:223]
    s_add_u32 s21, s21, 36864
    ds_read_b128 v[128:131], v6 offset:18432
    ds_read_b128 v[132:135], v6 offset:26624
    v_mfma_f32_16x16x32_bf16 v[224:227], v[136:139], v[32:35], v[224:227]
    v_mfma_f32_16x16x32_bf16 v[224:227], v[140:143], v[40:43], v[224:227]
    v_mfma_f32_16x16x32_bf16 v[228:231], v[136:139], v[36:39], v[228:231]
    ds_read_b128 v[136:139], v7 offset:2048
    v_mfma_f32_16x16x32_bf16 v[228:231], v[140:143], v[44:47], v[228:231]
    ds_read_b128 v[140:143], v7 offset:18432
    v_mfma_f32_16x16x32_bf16 v[176:179], v[144:147], v[48:51], v[176:179]
    v_mfma_f32_16x16x32_bf16 v[176:179], v[148:151], v[56:59], v[176:179]
    s_waitcnt lgkmcnt(2)
    v_mfma_f32_16x16x32_bf16 v[176:179], v[104:107], v[64:67], v[176:179]
    v_mfma_f32_16x16x32_bf16 v[176:179], v[108:111], v[72:75], v[176:179]
    v_mfma_f32_16x16x32_bf16 v[180:183], v[144:147], v[52:55], v[180:183]
    ds_read_b128 v[144:147], v6 offset:19456
    v_mfma_f32_16x16x32_bf16 v[180:183], v[148:151], v[60:63], v[180:183]
    ds_read_b128 v[148:151], v6 offset:27648
    v_mfma_f32_16x16x32_bf16 v[180:183], v[104:107], v[68:71], v[180:183]
    ds_read_b128 v[104:107], v7 offset:3072
    v_mfma_f32_16x16x32_bf16 v[180:183], v[108:111], v[76:79], v[180:183]
    ds_read_b128 v[108:111], v7 offset:19456
    v_cvt_pk_bf16_f32 v232, v176, v177
    v_mfma_f32_16x16x32_bf16 v[184:187], v[112:115], v[48:51], v[184:187]
    v_cvt_pk_bf16_f32 v233, v178, v179
    v_mfma_f32_16x16x32_bf16 v[184:187], v[116:119], v[56:59], v[184:187]
    v_mfma_f32_16x16x32_bf16 v[184:187], v[120:123], v[64:67], v[184:187]
    v_mfma_f32_16x16x32_bf16 v[184:187], v[124:127], v[72:75], v[184:187]
    v_mfma_f32_16x16x32_bf16 v[188:191], v[112:115], v[52:55], v[188:191]
    v_cvt_pk_bf16_f32 v234, v180, v181
    v_cvt_pk_bf16_f32 v235, v182, v183
    v_mfma_f32_16x16x32_bf16 v[188:191], v[116:119], v[60:63], v[188:191]
    buffer_store_dwordx4 v[232:235], v1, s[48:51], s8 offen offset:0 sc1
    v_mfma_f32_16x16x32_bf16 v[188:191], v[120:123], v[68:71], v[188:191]
    ds_read_b128 v[112:115], v6 offset:20480
    ds_read_b128 v[116:119], v6 offset:28672
    v_mfma_f32_16x16x32_bf16 v[188:191], v[124:127], v[76:79], v[188:191]
    v_cvt_pk_bf16_f32 v236, v184, v185
    v_cvt_pk_bf16_f32 v237, v186, v187
    v_mfma_f32_16x16x32_bf16 v[192:195], v[128:131], v[48:51], v[192:195]
    ds_read_b128 v[120:123], v7 offset:8192
    ds_read_b128 v[124:127], v7 offset:24576
    v_mfma_f32_16x16x32_bf16 v[192:195], v[132:135], v[56:59], v[192:195]
    s_waitcnt lgkmcnt(4)
    v_mfma_f32_16x16x32_bf16 v[192:195], v[136:139], v[64:67], v[192:195]
    v_mfma_f32_16x16x32_bf16 v[192:195], v[140:143], v[72:75], v[192:195]
    v_cvt_pk_bf16_f32 v238, v188, v189
    v_cvt_pk_bf16_f32 v239, v190, v191
    v_mfma_f32_16x16x32_bf16 v[196:199], v[128:131], v[52:55], v[196:199]
    buffer_store_dwordx4 v[236:239], v1, s[48:51], s8 offen offset:1024 sc1
    v_mfma_f32_16x16x32_bf16 v[196:199], v[132:135], v[60:63], v[196:199]
    ds_read_b128 v[128:131], v6 offset:21504
    ds_read_b128 v[132:135], v6 offset:29696
    v_mfma_f32_16x16x32_bf16 v[196:199], v[136:139], v[68:71], v[196:199]
    v_cvt_pk_bf16_f32 v240, v192, v193
    v_cvt_pk_bf16_f32 v241, v194, v195
    v_mfma_f32_16x16x32_bf16 v[196:199], v[140:143], v[76:79], v[196:199]
    ds_read_b128 v[136:139], v7 offset:9216
    ds_read_b128 v[140:143], v7 offset:25600
    v_mfma_f32_16x16x32_bf16 v[200:203], v[144:147], v[48:51], v[200:203]
    v_mfma_f32_16x16x32_bf16 v[200:203], v[148:151], v[56:59], v[200:203]
    v_mfma_f32_16x16x32_bf16 v[200:203], v[104:107], v[64:67], v[200:203]
    v_mfma_f32_16x16x32_bf16 v[200:203], v[108:111], v[72:75], v[200:203]
    v_mfma_f32_16x16x32_bf16 v[204:207], v[144:147], v[52:55], v[204:207]
    ds_read_b128 v[144:147], v6 offset:22528
    v_cvt_pk_bf16_f32 v242, v196, v197
    v_mfma_f32_16x16x32_bf16 v[204:207], v[148:151], v[60:63], v[204:207]
    v_cvt_pk_bf16_f32 v243, v198, v199
    ds_read_b128 v[148:151], v6 offset:30720
    v_mfma_f32_16x16x32_bf16 v[204:207], v[104:107], v[68:71], v[204:207]
    buffer_store_dwordx4 v[240:243], v1, s[48:51], s9 offen offset:0 sc1
    v_mfma_f32_16x16x32_bf16 v[204:207], v[108:111], v[76:79], v[204:207]
    s_waitcnt lgkmcnt(2)
    v_cvt_pk_bf16_f32 v244, v200, v201
    v_cvt_pk_bf16_f32 v245, v202, v203
    v_mfma_f32_16x16x32_bf16 v[208:211], v[112:115], v[48:51], v[208:211]
    ds_read_b128 v[104:107], v7 offset:10240
    ds_read_b128 v[108:111], v7 offset:26624
    v_mfma_f32_16x16x32_bf16 v[208:211], v[116:119], v[56:59], v[208:211]
    v_mfma_f32_16x16x32_bf16 v[208:211], v[120:123], v[64:67], v[208:211]
    v_mfma_f32_16x16x32_bf16 v[208:211], v[124:127], v[72:75], v[208:211]
    v_cvt_pk_bf16_f32 v246, v204, v205
    v_cvt_pk_bf16_f32 v247, v206, v207
    v_mfma_f32_16x16x32_bf16 v[212:215], v[112:115], v[52:55], v[212:215]
    buffer_store_dwordx4 v[244:247], v1, s[48:51], s9 offen offset:1024 sc1
    v_mfma_f32_16x16x32_bf16 v[212:215], v[116:119], v[60:63], v[212:215]
    v_mfma_f32_16x16x32_bf16 v[212:215], v[120:123], v[68:71], v[212:215]
    v_mfma_f32_16x16x32_bf16 v[212:215], v[124:127], v[76:79], v[212:215]
    v_mfma_f32_16x16x32_bf16 v[216:219], v[128:131], v[48:51], v[216:219]
    v_cvt_pk_bf16_f32 v232, v208, v209
    v_cvt_pk_bf16_f32 v233, v210, v211
    v_mfma_f32_16x16x32_bf16 v[216:219], v[132:135], v[56:59], v[216:219]
    v_mfma_f32_16x16x32_bf16 v[216:219], v[136:139], v[64:67], v[216:219]
    v_mfma_f32_16x16x32_bf16 v[216:219], v[140:143], v[72:75], v[216:219]
    s_waitcnt vmcnt(12)
    s_barrier
    v_cvt_pk_bf16_f32 v234, v212, v213
    v_mfma_f32_16x16x32_bf16 v[220:223], v[128:131], v[52:55], v[220:223]
    v_cvt_pk_bf16_f32 v235, v214, v215
    ds_read_b128 v[112:115], v11 offset:0
    v_mfma_f32_16x16x32_bf16 v[220:223], v[132:135], v[60:63], v[220:223]
    buffer_store_dwordx4 v[232:235], v1, s[48:51], s10 offen offset:0 sc1
    v_mfma_f32_16x16x32_bf16 v[220:223], v[136:139], v[68:71], v[220:223]
    ds_read_b128 v[116:119], v11 offset:2048
    ds_read_b128 v[120:123], v11 offset:4096
    v_mfma_f32_16x16x32_bf16 v[220:223], v[140:143], v[76:79], v[220:223]
    s_waitcnt lgkmcnt(3)
    ds_read_b128 v[124:127], v11 offset:6144
    v_cvt_pk_bf16_f32 v236, v216, v217
    v_mfma_f32_16x16x32_bf16 v[224:227], v[144:147], v[48:51], v[224:227]
    v_cvt_pk_bf16_f32 v237, v218, v219
    ds_read_b128 v[128:131], v11 offset:1024
    v_mfma_f32_16x16x32_bf16 v[224:227], v[148:151], v[56:59], v[224:227]
    ds_read_b128 v[132:135], v11 offset:3072
    v_mfma_f32_16x16x32_bf16 v[224:227], v[104:107], v[64:67], v[224:227]
    v_cvt_pk_bf16_f32 v238, v220, v221
    v_cvt_pk_bf16_f32 v239, v222, v223
    v_mfma_f32_16x16x32_bf16 v[224:227], v[108:111], v[72:75], v[224:227]
    buffer_store_dwordx4 v[236:239], v1, s[48:51], s10 offen offset:1024 sc1
    v_mfma_f32_16x16x32_bf16 v[228:231], v[144:147], v[52:55], v[228:231]
    ds_read_b128 v[136:139], v11 offset:5120
    ds_read_b128 v[140:143], v11 offset:7168
    v_mfma_f32_16x16x32_bf16 v[228:231], v[148:151], v[60:63], v[228:231]
    ds_read_b128 v[144:147], v11 offset:8192
    v_mfma_f32_16x16x32_bf16 v[228:231], v[104:107], v[68:71], v[228:231]
    ds_read_b128 v[148:151], v11 offset:10240
    v_cvt_pk_bf16_f32 v240, v224, v225
    v_mfma_f32_16x16x32_bf16 v[228:231], v[108:111], v[76:79], v[228:231]
    s_waitcnt lgkmcnt(4)
    v_cvt_pk_bf16_f32 v241, v226, v227
    ds_read_b128 v[104:107], v11 offset:12288
    v_mfma_f32_16x16x32_bf16 v[160:163], v[112:115], a[0:3], 0
    ds_read_b128 v[108:111], v11 offset:14336
    v_mfma_f32_16x16x32_bf16 v[160:163], v[116:119], a[8:11], v[160:163]
    v_mfma_f32_16x16x32_bf16 v[160:163], v[120:123], a[16:19], v[160:163]
    v_mfma_f32_16x16x32_bf16 v[160:163], v[124:127], a[24:27], v[160:163]
    v_mfma_f32_16x16x32_bf16 v[164:167], v[112:115], a[4:7], 0
    v_cvt_pk_bf16_f32 v242, v228, v229
    v_cvt_pk_bf16_f32 v243, v230, v231
    v_mfma_f32_16x16x32_bf16 v[164:167], v[116:119], a[12:15], v[164:167]
    buffer_store_dwordx4 v[240:243], v1, s[48:51], s11 offen offset:2048 sc1
    v_mfma_f32_16x16x32_bf16 v[164:167], v[120:123], a[20:23], v[164:167]
    ds_read_b128 v[112:115], v11 offset:9216
    ds_read_b128 v[116:119], v11 offset:11264
    v_mfma_f32_16x16x32_bf16 v[164:167], v[124:127], a[28:31], v[164:167]
    ds_read_b128 v[120:123], v11 offset:13312
    v_mfma_f32_16x16x32_bf16 v[168:171], v[128:131], a[0:3], 0
    ds_read_b128 v[124:127], v11 offset:15360
    v_mfma_f32_16x16x32_bf16 v[168:171], v[132:135], a[8:11], v[168:171]
    s_waitcnt lgkmcnt(4)
    v_mfma_f32_16x16x32_bf16 v[168:171], v[136:139], a[16:19], v[168:171]
    v_mfma_f32_16x16x32_bf16 v[168:171], v[140:143], a[24:27], v[168:171]
    v_mfma_f32_16x16x32_bf16 v[172:175], v[128:131], a[4:7], 0
    ds_read_b128 v[128:131], v11 offset:16384
    v_mfma_f32_16x16x32_bf16 v[172:175], v[132:135], a[12:15], v[172:175]
    ds_read_b128 v[132:135], v11 offset:18432
    v_mfma_f32_16x16x32_bf16 v[172:175], v[136:139], a[20:23], v[172:175]
    ds_read_b128 v[136:139], v11 offset:20480
    v_mfma_f32_16x16x32_bf16 v[172:175], v[140:143], a[28:31], v[172:175]
    ds_read_b128 v[140:143], v11 offset:22528
    v_mfma_f32_16x16x32_bf16 v[160:163], v[144:147], a[32:35], v[160:163]
    v_mfma_f32_16x16x32_bf16 v[160:163], v[148:151], a[40:43], v[160:163]
    v_mfma_f32_16x16x32_bf16 v[160:163], v[104:107], a[48:51], v[160:163]
    v_mfma_f32_16x16x32_bf16 v[160:163], v[108:111], a[56:59], v[160:163]
    v_mfma_f32_16x16x32_bf16 v[164:167], v[144:147], a[36:39], v[164:167]
    ds_read_b128 v[144:147], v11 offset:17408
    v_mfma_f32_16x16x32_bf16 v[164:167], v[148:151], a[44:47], v[164:167]
    ds_read_b128 v[148:151], v11 offset:19456
    v_mfma_f32_16x16x32_bf16 v[164:167], v[104:107], a[52:55], v[164:167]
    ds_read_b128 v[104:107], v11 offset:21504
    v_mfma_f32_16x16x32_bf16 v[164:167], v[108:111], a[60:63], v[164:167]
    s_waitcnt lgkmcnt(3)
    ds_read_b128 v[108:111], v11 offset:23552
    v_mfma_f32_16x16x32_bf16 v[168:171], v[112:115], a[32:35], v[168:171]
    v_mfma_f32_16x16x32_bf16 v[168:171], v[116:119], a[40:43], v[168:171]
    v_mfma_f32_16x16x32_bf16 v[168:171], v[120:123], a[48:51], v[168:171]
    v_mfma_f32_16x16x32_bf16 v[168:171], v[124:127], a[56:59], v[168:171]
    v_mfma_f32_16x16x32_bf16 v[172:175], v[112:115], a[36:39], v[172:175]
    ds_read_b128 v[112:115], v11 offset:24576
    v_mfma_f32_16x16x32_bf16 v[172:175], v[116:119], a[44:47], v[172:175]
    ds_read_b128 v[116:119], v11 offset:26624
    v_mfma_f32_16x16x32_bf16 v[172:175], v[120:123], a[52:55], v[172:175]
    ds_read_b128 v[120:123], v11 offset:28672
    v_mfma_f32_16x16x32_bf16 v[172:175], v[124:127], a[60:63], v[172:175]
    ds_read_b128 v[124:127], v11 offset:30720
    v_mfma_f32_16x16x32_bf16 v[160:163], v[128:131], a[64:67], v[160:163]
    v_mfma_f32_16x16x32_bf16 v[160:163], v[132:135], a[72:75], v[160:163]
    v_mfma_f32_16x16x32_bf16 v[160:163], v[136:139], a[80:83], v[160:163]
    v_mfma_f32_16x16x32_bf16 v[160:163], v[140:143], a[88:91], v[160:163]
    v_mfma_f32_16x16x32_bf16 v[164:167], v[128:131], a[68:71], v[164:167]
    ds_read_b128 v[128:131], v11 offset:25600
    v_mfma_f32_16x16x32_bf16 v[164:167], v[132:135], a[76:79], v[164:167]
    ds_read_b128 v[132:135], v11 offset:27648
    v_mfma_f32_16x16x32_bf16 v[164:167], v[136:139], a[84:87], v[164:167]
    ds_read_b128 v[136:139], v11 offset:29696
    v_mfma_f32_16x16x32_bf16 v[164:167], v[140:143], a[92:95], v[164:167]
    s_waitcnt lgkmcnt(3)
    ds_read_b128 v[140:143], v11 offset:31744
    v_mfma_f32_16x16x32_bf16 v[168:171], v[144:147], a[64:67], v[168:171]
    v_mfma_f32_16x16x32_bf16 v[168:171], v[148:151], a[72:75], v[168:171]
    v_mfma_f32_16x16x32_bf16 v[168:171], v[104:107], a[80:83], v[168:171]
    v_mfma_f32_16x16x32_bf16 v[168:171], v[108:111], a[88:91], v[168:171]
    v_mfma_f32_16x16x32_bf16 v[172:175], v[144:147], a[68:71], v[172:175]
    v_mfma_f32_16x16x32_bf16 v[172:175], v[148:151], a[76:79], v[172:175]
    v_mfma_f32_16x16x32_bf16 v[172:175], v[104:107], a[84:87], v[172:175]
    v_mfma_f32_16x16x32_bf16 v[172:175], v[108:111], a[92:95], v[172:175]
    v_mfma_f32_16x16x32_bf16 v[160:163], v[112:115], a[96:99], v[160:163]
    v_mfma_f32_16x16x32_bf16 v[160:163], v[116:119], a[104:107], v[160:163]
    v_mfma_f32_16x16x32_bf16 v[160:163], v[120:123], a[112:115], v[160:163]
    s_waitcnt vmcnt(0)
    buffer_store_dword v31, v23, s[32:35], s74 offen sc1
    v_mfma_f32_16x16x32_bf16 v[160:163], v[124:127], a[120:123], v[160:163]
    s_waitcnt vmcnt(8)
    s_barrier
    ds_read_b128 v[144:147], v12 offset:0
    v_mfma_f32_16x16x32_bf16 v[164:167], v[112:115], a[100:103], v[164:167]
    ds_read_b128 v[148:151], v12 offset:2048
    ds_read_b128 v[104:107], v12 offset:4096
    v_mfma_f32_16x16x32_bf16 v[164:167], v[116:119], a[108:111], v[164:167]
    ds_read_b128 v[108:111], v12 offset:6144
    v_mfma_f32_16x16x32_bf16 v[164:167], v[120:123], a[116:119], v[164:167]
    ds_read_b128 v[112:115], v12 offset:1024
    v_mfma_f32_16x16x32_bf16 v[164:167], v[124:127], a[124:127], v[164:167]
    s_lshr_b32 s64, s4, 1
    s_lshl1_add_u32 s21, s61, s64
    s_mul_i32 s21, s21, 3
    s_waitcnt lgkmcnt(5)
    v_mfma_f32_16x16x32_bf16 v[168:171], v[128:131], a[96:99], v[168:171]
    s_add_u32 s21, s21, 128
    s_mul_i32 s21, s21, 36864
    s_add_u32 s21, s21, s28
    v_mfma_f32_16x16x32_bf16 v[168:171], v[132:135], a[104:107], v[168:171]
    s_add_u32 s21, s21, 7168
    s_and_b32 s64, s68, 1024
    s_add_u32 s21, s21, s64
    v_mfma_f32_16x16x32_bf16 v[168:171], v[136:139], a[112:115], v[168:171]
    s_add_u32 m0, s46, 0
    ds_read_b128 v[116:119], v12 offset:3072
    ds_read_b128 v[120:123], v12 offset:5120
    v_mfma_f32_16x16x32_bf16 v[168:171], v[140:143], a[120:123], v[168:171]
    s_lshl2_add_u32 s64, s61, s65
    buffer_load_dwordx4 v1, s[56:59], s21 offen sc1 lds
    v_mfma_f32_16x16x32_bf16 v[172:175], v[128:131], a[100:103], v[172:175]
    s_add_u32 s21, s21, 36864
    ds_read_b128 v[124:127], v12 offset:7168
    ds_read_b128 v[128:131], v12 offset:8192
    v_mfma_f32_16x16x32_bf16 v[172:175], v[132:135], a[108:111], v[172:175]
    s_add_u32 m0, s46, 1024
    ds_read_b128 v[132:135], v12 offset:10240
    s_lshl_b32 s65, s65, 5
    v_mfma_f32_16x16x32_bf16 v[172:175], v[136:139], a[116:119], v[172:175]
    s_add_u32 s65, s65, 1024
    buffer_load_dwordx4 v1, s[56:59], s21 offen sc1 lds
    v_mfma_f32_16x16x32_bf16 v[172:175], v[140:143], a[124:127], v[172:175]
    s_add_u32 s21, s21, 36864
    ds_read_b128 v[136:139], v12 offset:12288
    ds_read_b128 v[140:143], v12 offset:14336
    s_waitcnt lgkmcnt(5)
    v_mfma_f32_16x16x32_bf16 v[160:163], v[144:147], a[128:131], v[160:163]
    s_add_u32 m0, s46, 2048
    s_lshl_b32 s64, s64, 6
    v_mfma_f32_16x16x32_bf16 v[160:163], v[148:151], a[136:139], v[160:163]
    s_cmp_eq_u32 s4, s61
    s_cselect_b32 s65, s65, 1073741824
    s_cselect_b32 s70, s23, 1073741824
    v_mfma_f32_16x16x32_bf16 v[160:163], v[104:107], a[144:147], v[160:163]
    buffer_load_dwordx4 v1, s[56:59], s21 offen sc1 lds
    v_mfma_f32_16x16x32_bf16 v[160:163], v[108:111], a[152:155], v[160:163]
    s_add_u32 s21, s21, 36864
    v_mfma_f32_16x16x32_bf16 v[164:167], v[144:147], a[132:135], v[164:167]
    ds_read_b128 v[144:147], v12 offset:9216
    v_mfma_f32_16x16x32_bf16 v[164:167], v[148:151], a[140:143], v[164:167]
    ds_read_b128 v[148:151], v12 offset:11264
    v_mfma_f32_16x16x32_bf16 v[164:167], v[104:107], a[148:151], v[164:167]
    ds_read_b128 v[104:107], v12 offset:13312
    v_mfma_f32_16x16x32_bf16 v[164:167], v[108:111], a[156:159], v[164:167]
    ds_read_b128 v[108:111], v12 offset:15360
    v_mfma_f32_16x16x32_bf16 v[168:171], v[112:115], a[128:131], v[168:171]
    v_mfma_f32_16x16x32_bf16 v[168:171], v[116:119], a[136:139], v[168:171]
    v_mfma_f32_16x16x32_bf16 v[168:171], v[120:123], a[144:147], v[168:171]
    s_waitcnt lgkmcnt(2)
    v_mfma_f32_16x16x32_bf16 v[168:171], v[124:127], a[152:155], v[168:171]
    v_mfma_f32_16x16x32_bf16 v[172:175], v[112:115], a[132:135], v[172:175]
    ds_read_b128 v[112:115], v12 offset:16384
    v_mfma_f32_16x16x32_bf16 v[172:175], v[116:119], a[140:143], v[172:175]
    ds_read_b128 v[116:119], v12 offset:18432
    v_mfma_f32_16x16x32_bf16 v[172:175], v[120:123], a[148:151], v[172:175]
    ds_read_b128 v[120:123], v12 offset:20480
    v_mfma_f32_16x16x32_bf16 v[172:175], v[124:127], a[156:159], v[172:175]
    ds_read_b128 v[124:127], v12 offset:22528
    v_mfma_f32_16x16x32_bf16 v[160:163], v[128:131], a[160:163], v[160:163]
    v_mfma_f32_16x16x32_bf16 v[160:163], v[132:135], a[168:171], v[160:163]
    v_mfma_f32_16x16x32_bf16 v[160:163], v[136:139], a[176:179], v[160:163]
    v_mfma_f32_16x16x32_bf16 v[160:163], v[140:143], a[184:187], v[160:163]
    v_mfma_f32_16x16x32_bf16 v[164:167], v[128:131], a[164:167], v[164:167]
    ds_read_b128 v[128:131], v12 offset:17408
    v_mfma_f32_16x16x32_bf16 v[164:167], v[132:135], a[172:175], v[164:167]
    buffer_load_dword v3, v19, s[32:35], s66 offen sc1
    v_mfma_f32_16x16x32_bf16 v[164:167], v[136:139], a[180:183], v[164:167]
    ds_read_b128 v[132:135], v12 offset:19456
    ds_read_b128 v[136:139], v12 offset:21504
    v_mfma_f32_16x16x32_bf16 v[164:167], v[140:143], a[188:191], v[164:167]
    ds_read_b128 v[140:143], v12 offset:23552
    v_mfma_f32_16x16x32_bf16 v[168:171], v[144:147], a[160:163], v[168:171]
    v_mfma_f32_16x16x32_bf16 v[168:171], v[148:151], a[168:171], v[168:171]
    s_waitcnt lgkmcnt(3)
    v_mfma_f32_16x16x32_bf16 v[168:171], v[104:107], a[176:179], v[168:171]
    v_mfma_f32_16x16x32_bf16 v[168:171], v[108:111], a[184:187], v[168:171]
    v_mfma_f32_16x16x32_bf16 v[172:175], v[144:147], a[164:167], v[172:175]
    ds_read_b128 v[144:147], v12 offset:24576
    v_mfma_f32_16x16x32_bf16 v[172:175], v[148:151], a[172:175], v[172:175]
    ds_read_b128 v[148:151], v12 offset:26624
    v_mfma_f32_16x16x32_bf16 v[172:175], v[104:107], a[180:183], v[172:175]
    ds_read_b128 v[104:107], v12 offset:28672
    v_mfma_f32_16x16x32_bf16 v[172:175], v[108:111], a[188:191], v[172:175]
    ds_read_b128 v[108:111], v12 offset:30720
    v_mfma_f32_16x16x32_bf16 v[160:163], v[112:115], a[192:195], v[160:163]
    v_mfma_f32_16x16x32_bf16 v[160:163], v[116:119], a[200:203], v[160:163]
    v_mfma_f32_16x16x32_bf16 v[160:163], v[120:123], a[208:211], v[160:163]
    v_mfma_f32_16x16x32_bf16 v[160:163], v[124:127], a[216:219], v[160:163]
    v_mfma_f32_16x16x32_bf16 v[164:167], v[112:115], a[196:199], v[164:167]
    ds_read_b128 v[112:115], v12 offset:25600
    v_mfma_f32_16x16x32_bf16 v[164:167], v[116:119], a[204:207], v[164:167]
    ds_read_b128 v[116:119], v12 offset:27648
    v_mfma_f32_16x16x32_bf16 v[164:167], v[120:123], a[212:215], v[164:167]
    ds_read_b128 v[120:123], v12 offset:29696
    v_mfma_f32_16x16x32_bf16 v[164:167], v[124:127], a[220:223], v[164:167]
    ds_read_b128 v[124:127], v12 offset:31744
    v_mfma_f32_16x16x32_bf16 v[168:171], v[128:131], a[192:195], v[168:171]
    s_waitcnt lgkmcnt(4)
    v_mfma_f32_16x16x32_bf16 v[168:171], v[132:135], a[200:203], v[168:171]
    v_mfma_f32_16x16x32_bf16 v[168:171], v[136:139], a[208:211], v[168:171]
    v_mfma_f32_16x16x32_bf16 v[168:171], v[140:143], a[216:219], v[168:171]
    v_mfma_f32_16x16x32_bf16 v[172:175], v[128:131], a[196:199], v[172:175]
    v_mfma_f32_16x16x32_bf16 v[172:175], v[132:135], a[204:207], v[172:175]
    v_mfma_f32_16x16x32_bf16 v[172:175], v[136:139], a[212:215], v[172:175]
    v_mfma_f32_16x16x32_bf16 v[172:175], v[140:143], a[220:223], v[172:175]
    v_mfma_f32_16x16x32_bf16 v[160:163], v[144:147], a[224:227], v[160:163]
    s_waitcnt vmcnt(0)
    v_cmp_gt_u32 vcc, 3, v3
    s_nop 1
    s_and_b64 vcc, vcc, exec
    s_cbranch_scc1 SPIN_X
BACK_X:
    v_mfma_f32_16x16x32_bf16 v[160:163], v[148:151], a[232:235], v[160:163]
    buffer_load_dwordx4 v[176:179], v1, s[48:51], s98 offen offset:0 sc1
    v_mfma_f32_16x16x32_bf16 v[160:163], v[104:107], a[240:243], v[160:163]
    s_add_u32 s98, s23, 12288
    buffer_load_dwordx4 v[180:183], v1, s[48:51], s98 offen offset:0 sc1
    v_mfma_f32_16x16x32_bf16 v[160:163], v[108:111], a[248:251], v[160:163]
    s_waitcnt vmcnt(3)
    s_barrier
    ds_read_b128 v[128:131], v13 offset:0
    v_mfma_f32_16x16x32_bf16 v[164:167], v[144:147], a[228:231], v[164:167]
    s_add_u32 s98, s23, 24576
    ds_read_b128 v[132:135], v13 offset:1024
    ds_read_b128 v[136:139], v13 offset:2048
    v_mfma_f32_16x16x32_bf16 v[164:167], v[148:151], a[236:239], v[164:167]
    buffer_load_dwordx4 v[184:187], v1, s[48:51], s98 offen offset:0 sc1
    v_mfma_f32_16x16x32_bf16 v[164:167], v[104:107], a[244:247], v[164:167]
    s_add_u32 s98, s23, 0
    ds_read_b128 v[140:143], v13 offset:8192
    ds_read_b128 v[144:147], v13 offset:9216
    v_mfma_f32_16x16x32_bf16 v[164:167], v[108:111], a[252:255], v[164:167]
    s_waitcnt lgkmcnt(5)
    ds_read_b128 v[148:151], v13 offset:10240
    v_mfma_f32_16x16x32_bf16 v[168:171], v[112:115], a[224:227], v[168:171]
    ds_read_b128 v[104:107], v13 offset:16384
    v_mfma_f32_16x16x32_bf16 v[168:171], v[116:119], a[232:235], v[168:171]
    buffer_load_dwordx4 v[188:191], v1, s[48:51], s98 offen offset:1024 sc1
    v_mfma_f32_16x16x32_bf16 v[168:171], v[120:123], a[240:243], v[168:171]
    s_add_u32 s98, s23, 12288
    ds_read_b128 v[108:111], v13 offset:17408
    v_mfma_f32_16x16x32_bf16 v[168:171], v[124:127], a[248:251], v[168:171]
    v_mfma_f32_16x16x32_bf16 v[172:175], v[112:115], a[228:231], v[172:175]
    ds_read_b128 v[112:115], v13 offset:18432
    v_mfma_f32_16x16x32_bf16 v[172:175], v[116:119], a[236:239], v[172:175]
    buffer_load_dwordx4 v[192:195], v1, s[48:51], s98 offen offset:1024 sc1
    v_mfma_f32_16x16x32_bf16 v[172:175], v[120:123], a[244:247], v[172:175]
    s_add_u32 s98, s23, 24576
    ds_read_b128 v[116:119], v13 offset:24576
    ds_read_b128 v[120:123], v13 offset:25600
    v_mfma_f32_16x16x32_bf16 v[172:175], v[124:127], a[252:255], v[172:175]
    s_waitcnt lgkmcnt(3)
    ds_read_b128 v[124:127], v13 offset:26624
    v_mfma_f32_16x16x32_bf16 v[160:163], v[128:131], v[32:35], v[160:163]
    v_mfma_f32_16x16x32_bf16 v[160:163], v[132:135], v[40:43], v[160:163]
    buffer_load_dwordx4 v[196:199], v1, s[48:51], s98 offen offset:1024 sc1
    v_mfma_f32_16x16x32_bf16 v[160:163], v[136:139], v[48:51], v[160:163]
    s_add_u32 s98, s70, 0
    v_mfma_f32_16x16x32_bf16 v[164:167], v[128:131], v[36:39], v[164:167]
    v_mfma_f32_16x16x32_bf16 v[164:167], v[132:135], v[44:47], v[164:167]
    v_mfma_f32_16x16x32_bf16 v[164:167], v[136:139], v[52:55], v[164:167]
    buffer_load_dwordx4 v[200:203], v1, s[48:51], s98 offen offset:2048 sc1
    v_mfma_f32_16x16x32_bf16 v[168:171], v[140:143], v[32:35], v[168:171]
    s_add_u32 s98, s70, 12288
    v_mfma_f32_16x16x32_bf16 v[168:171], v[144:147], v[40:43], v[168:171]
    v_mfma_f32_16x16x32_bf16 v[168:171], v[148:151], v[48:51], v[168:171]
    v_mfma_f32_16x16x32_bf16 v[172:175], v[140:143], v[36:39], v[172:175]
    buffer_load_dwordx4 v[204:207], v1, s[48:51], s98 offen offset:2048 sc1
    v_mfma_f32_16x16x32_bf16 v[172:175], v[144:147], v[44:47], v[172:175]
    s_add_u32 s98, s70, 24576
    v_mfma_f32_16x16x32_bf16 v[172:175], v[148:151], v[52:55], v[172:175]
    v_mfma_f32_16x16x32_bf16 v[160:163], v[104:107], v[56:59], v[160:163]
    v_mfma_f32_16x16x32_bf16 v[160:163], v[108:111], v[64:67], v[160:163]
    s_waitcnt lgkmcnt(0)
    buffer_load_dwordx4 v[208:211], v1, s[48:51], s98 offen offset:2048 sc1
    v_mfma_f32_16x16x32_bf16 v[160:163], v[112:115], v[72:75], v[160:163]
    v_mfma_f32_16x16x32_bf16 v[164:167], v[104:107], v[60:63], v[164:167]
    v_mfma_f32_16x16x32_bf16 v[164:167], v[108:111], v[68:71], v[164:167]
    v_mfma_f32_16x16x32_bf16 v[164:167], v[112:115], v[76:79], v[164:167]
    v_mfma_f32_16x16x32_bf16 v[168:171], v[116:119], v[56:59], v[168:171]
    v_mfma_f32_16x16x32_bf16 v[168:171], v[120:123], v[64:67], v[168:171]
    v_mfma_f32_16x16x32_bf16 v[168:171], v[124:127], v[72:75], v[168:171]
    v_mfma_f32_16x16x32_bf16 v[172:175], v[116:119], v[60:63], v[172:175]
    v_mfma_f32_16x16x32_bf16 v[172:175], v[120:123], v[68:71], v[172:175]
    v_mfma_f32_16x16x32_bf16 v[172:175], v[124:127], v[76:79], v[172:175]
    s_waitcnt vmcnt(6)
    v_mfma_f32_16x16x32_bf16 v[160:163], v[96:99], v[176:179], v[160:163]
    v_mfma_f32_16x16x32_bf16 v[160:163], v[96:99], v[180:183], v[160:163]
    v_mfma_f32_16x16x32_bf16 v[160:163], v[96:99], v[184:187], v[160:163]
    v_mfma_f32_16x16x32_bf16 v[164:167], v[98:101], v[176:179], v[164:167]
    v_mfma_f32_16x16x32_bf16 v[164:167], v[98:101], v[180:183], v[164:167]
    v_mfma_f32_16x16x32_bf16 v[164:167], v[98:101], v[184:187], v[164:167]
    s_waitcnt vmcnt(3)
    v_mfma_f32_16x16x32_bf16 v[168:171], v[96:99], v[188:191], v[168:171]
    v_mfma_f32_16x16x32_bf16 v[168:171], v[96:99], v[192:195], v[168:171]
    v_mfma_f32_16x16x32_bf16 v[168:171], v[96:99], v[196:199], v[168:171]
    v_mfma_f32_16x16x32_bf16 v[172:175], v[98:101], v[188:191], v[172:175]
    v_mfma_f32_16x16x32_bf16 v[172:175], v[98:101], v[192:195], v[172:175]
    v_mfma_f32_16x16x32_bf16 v[172:175], v[98:101], v[196:199], v[172:175]
    v_cvt_pk_bf16_f32 v160, v160, v161
    v_cvt_pk_bf16_f32 v161, v162, v163
    buffer_store_dwordx2 v[160:161], v20, s[24:27], s64 offen
    v_cvt_pk_bf16_f32 v164, v164, v165
    v_cvt_pk_bf16_f32 v165, v166, v167
    buffer_store_dwordx2 v[164:165], v21, s[24:27], s64 offen
    s_cmp_lg_u32 s4, s61
    s_cbranch_scc1 K1_X2
    s_waitcnt vmcnt(2)
    v_mfma_f32_16x16x32_bf16 v[224:227], v[96:99], v[200:203], v[224:227]
    v_mfma_f32_16x16x32_bf16 v[224:227], v[96:99], v[204:207], v[224:227]
    v_mfma_f32_16x16x32_bf16 v[224:227], v[96:99], v[208:211], v[224:227]
    v_mfma_f32_16x16x32_bf16 v[228:231], v[98:101], v[200:203], v[228:231]
    v_mfma_f32_16x16x32_bf16 v[228:231], v[98:101], v[204:207], v[228:231]
    v_mfma_f32_16x16x32_bf16 v[228:231], v[98:101], v[208:211], v[228:231]
    s_nop 4
    v_cvt_pk_bf16_f32 v224, v224, v225
    v_cvt_pk_bf16_f32 v225, v226, v227
    buffer_store_dwordx2 v[224:225], v20, s[24:27], s65 offen
    v_cvt_pk_bf16_f32 v228, v228, v229
    v_cvt_pk_bf16_f32 v229, v230, v231
    buffer_store_dwordx2 v[228:229], v21, s[24:27], s65 offen
K1_X2:
    v_cvt_pk_bf16_f32 v168, v168, v169
    v_cvt_pk_bf16_f32 v169, v170, v171
    buffer_store_dwordx2 v[168:169], v20, s[24:27], s64 offen offset:32
    v_cvt_pk_bf16_f32 v172, v172, v173
    v_cvt_pk_bf16_f32 v173, v174, v175
    buffer_store_dwordx2 v[172:173], v21, s[24:27], s64 offen offset:32
K1_END:
    s_endpgm
K1_LB_MASK:
    buffer_load_dword v3, v29, s[32:35], s92 offen sc1
    s_nop 1
    v_add_f32 v212, s12, v144
    v_fma_f32 v176, v208, s8, v212
    v_fma_f32 v177, v209, s8, v212
    v_fma_f32 v178, v210, s8, v212
    v_fma_f32 v179, v211, s8, v212
    v_add_f32 v213, s13, v144
    v_fma_f32 v180, v208, s9, v213
    v_fma_f32 v181, v209, s9, v213
    v_fma_f32 v182, v210, s9, v213
    v_fma_f32 v183, v211, s9, v213
    v_add_f32 v214, s14, v144
    v_fma_f32 v184, v208, s10, v214
    v_fma_f32 v185, v209, s10, v214
    v_fma_f32 v186, v210, s10, v214
    v_fma_f32 v187, v211, s10, v214
    v_add_f32 v215, s15, v144
    v_fma_f32 v188, v208, s11, v215
    v_fma_f32 v189, v209, s11, v215
    v_fma_f32 v190, v210, s11, v215
    v_fma_f32 v191, v211, s11, v215
    s_nop 1
    s_branch K1_LB_BACK
K1_LS_MASK:
    s_cmp_eq_u32 s78, 1
    s_cbranch_scc1 K1_LS_LAST
    buffer_load_dword v3, v29, s[32:35], s92 offen sc1
    v_mov_b32 v218, 1
    s_cmp_eq_u64 s[84:85], 0
    s_cselect_b32 s7, s74, 1073741824
    s_cmp_lg_u32 s83, 0
    s_cselect_b32 s7, s74, s7
    s_waitcnt vmcnt(9)
    buffer_store_dword v218, v216, s[32:35], s7 offen sc1
    s_branch K1_LS_BACK
K1_LS_LAST:
    v_cmp_gt_u32 vcc, 1, v3
    s_nop 1
    s_cmp_lg_u32 vcc_lo, 0
    s_cbranch_scc1 SPIN_W0
BACK_W0:
    s_mov_b64 s[36:37], s[56:57]
    s_mov_b32 s38, 5603328
    s_xor_b32 s77, s3, 0
    s_lshl2_add_u32 s77, s77, s4
    s_mul_i32 s77, s77, 36864
    s_add_u32 s77, s77, s28
    s_nop 1
    v_add_f32 v212, s12, v152
    v_fma_f32 v176, v208, s8, v212
    v_fma_f32 v177, v209, s8, v212
    v_fma_f32 v178, v210, s8, v212
    v_fma_f32 v179, v211, s8, v212
    v_add_f32 v213, s13, v152
    v_fma_f32 v180, v208, s9, v213
    v_fma_f32 v181, v209, s9, v213
    v_fma_f32 v182, v210, s9, v213
    v_fma_f32 v183, v211, s9, v213
    v_add_f32 v214, s14, v152
    v_fma_f32 v184, v208, s10, v214
    v_fma_f32 v185, v209, s10, v214
    v_fma_f32 v186, v210, s10, v214
    v_fma_f32 v187, v211, s10, v214
    v_add_f32 v215, s15, v152
    v_fma_f32 v188, v208, s11, v215
    v_fma_f32 v189, v209, s11, v215
    v_fma_f32 v190, v210, s11, v215
    v_fma_f32 v191, v211, s11, v215
    s_nop 1
    s_branch K1_LS_BACK
K1_WMASK:
    v_mov_b32 v9, 0xf149f2ca
    v_cmp_le_u32 vcc, 2, v14
    s_nop 1
    v_cndmask_b32 v141, v9, v141, vcc
    v_cmp_le_u32 vcc, 4, v14
    s_nop 1
    v_cndmask_b32 v142, v9, v142, vcc
    v_cmp_le_u32 vcc, 6, v14
    s_nop 1
    v_cndmask_b32 v143, v9, v143, vcc
    v_cmp_le_u32 vcc, 8, v14
    s_nop 1
    v_cndmask_b32 v144, v9, v144, vcc
    v_cmp_le_u32 vcc, 10, v14
    s_nop 1
    v_cndmask_b32 v145, v9, v145, vcc
    v_cmp_le_u32 vcc, 12, v14
    s_nop 1
    v_cndmask_b32 v146, v9, v146, vcc
    v_cmp_le_u32 vcc, 14, v14
    s_nop 1
    v_cndmask_b32 v147, v9, v147, vcc
    s_branch K1_WMASK_BACK
K1_S7:
    v_mov_b32 v218, 1
    s_cmp_eq_u64 s[84:85], 0
    s_cselect_b32 s7, s74, 1073741824
    s_cmp_lg_u32 s83, 0
    s_cselect_b32 s7, s74, s7
    s_waitcnt vmcnt(8)
    buffer_store_dword v218, v216, s[32:35], s7 offen sc1
    s_branch K1_S7_BACK
K1_J7:
    v_cmp_gt_u32 vcc, 1, v3
    s_nop 1
    s_cmp_lg_u32 vcc_lo, 0
    s_cbranch_scc1 SPIN_W7
BACK_W7:
    s_mov_b64 s[36:37], s[56:57]
    s_mov_b32 s38, 5603328
    s_xor_b32 s77, s3, 0
    s_lshl2_add_u32 s77, s77, s4
    s_mul_i32 s77, s77, 36864
    s_add_u32 s77, s77, s28
    s_branch K1_J7_BACK
K1_REDO:
    s_mov_b32 s83, 1
    s_mov_b32 s63, 1073741824
    s_mov_b32 s64, 1073741824
    s_mov_b32 s62, 1073741824
    s_mul_i32 s7, s5, 1081344
    s_sub_u32 s7, 56623104, s7
    s_sub_u32 s36, s56, s7
    s_subb_u32 s37, s57, 0
    s_mov_b32 s38, 1081344
    s_mov_b32 s50, 0
    s_mov_b32 s54, 0
    s_waitcnt vmcnt(0) lgkmcnt(0)
    s_barrier
    v_lshrrev_b32 v92, 4, v1
    v_and_b32 v64, 15, v92
    v_lshrrev_b32 v92, 4, v92
    v_lshlrev_b32 v92, 2, v92
    v_sub_u32 v92, v64, v92
    s_lshl_b32 s98, s4, 4
    v_add_u32 v92, s98, v92
    s_lshl_b32 s98, s6, 7
    s_sub_u32 s99, 1920, s98
    v_add_u32 v64, s98, v92
    v_add_u32 v65, 64, v64
    v_add_u32 v66, s99, v92
    v_add_u32 v67, 64, v66
    v_mov_b32 v93, 0xf149f2ca
    v_mov_b32 v68, v93
    v_mov_b32 v69, v93
    v_mov_b32 v70, v93
    v_mov_b32 v71, v93
    s_mov_b32 s78, 0
    s_add_u32 s99, s99, 128
K1_REDO_L:
    s_lshr_b32 s7, s78, 6
    s_lshl_b32 s7, s7, 15
    s_bfe_u32 s98, s78, 0x20004
    s_lshl_b32 s98, s98, 12
    s_add_u32 s7, s7, s98
    buffer_load_dwordx4 v[72:75], v1, s[36:39], s7 offen offset:0 sc1
    buffer_load_dwordx4 v[76:79], v1, s[36:39], s7 offen offset:1024 sc1
    buffer_load_dwordx4 v[80:83], v1, s[36:39], s7 offen offset:2048 sc1
    buffer_load_dwordx4 v[84:87], v1, s[36:39], s7 offen offset:3072 sc1
    s_waitcnt vmcnt(0)
    v_mfma_f32_16x16x32_bf16 v[88:91], v[72:75], v[128:131], 0
    v_mfma_f32_16x16x32_bf16 v[88:91], v[76:79], v[160:163], v[88:91]
    v_mfma_f32_16x16x32_bf16 v[88:91], v[80:83], v[192:195], v[88:91]
    v_mfma_f32_16x16x32_bf16 v[88:91], v[84:87], v[224:227], v[88:91]
    v_subrev_u32 v92, s78, v64
    v_cmp_le_i32 vcc, 0, v92
    s_nop 5
    v_cndmask_b32 v88, v93, v88, vcc
    v_max_f32 v68, v68, v88
    v_cmp_le_i32 vcc, 1, v92
    s_nop 1
    v_cndmask_b32 v89, v93, v89, vcc
    v_max_f32 v68, v68, v89
    v_cmp_le_i32 vcc, 2, v92
    s_nop 1
    v_cndmask_b32 v90, v93, v90, vcc
    v_max_f32 v68, v68, v90
    v_cmp_le_i32 vcc, 3, v92
    s_nop 1
    v_cndmask_b32 v91, v93, v91, vcc
    v_max_f32 v68, v68, v91
    v_mfma_f32_16x16x32_bf16 v[88:91], v[72:75], v[132:135], 0
    v_mfma_f32_16x16x32_bf16 v[88:91], v[76:79], v[164:167], v[88:91]
    v_mfma_f32_16x16x32_bf16 v[88:91], v[80:83], v[196:199], v[88:91]
    v_mfma_f32_16x16x32_bf16 v[88:91], v[84:87], v[228:231], v[88:91]
    v_subrev_u32 v92, s78, v65
    v_cmp_le_i32 vcc, 0, v92
    s_nop 5
    v_cndmask_b32 v88, v93, v88, vcc
    v_max_f32 v69, v69, v88
    v_cmp_le_i32 vcc, 1, v92
    s_nop 1
    v_cndmask_b32 v89, v93, v89, vcc
    v_max_f32 v69, v69, v89
    v_cmp_le_i32 vcc, 2, v92
    s_nop 1
    v_cndmask_b32 v90, v93, v90, vcc
    v_max_f32 v69, v69, v90
    v_cmp_le_i32 vcc, 3, v92
    s_nop 1
    v_cndmask_b32 v91, v93, v91, vcc
    v_max_f32 v69, v69, v91
    v_mfma_f32_16x16x32_bf16 v[88:91], v[72:75], v[136:139], 0
    v_mfma_f32_16x16x32_bf16 v[88:91], v[76:79], v[168:171], v[88:91]
    v_mfma_f32_16x16x32_bf16 v[88:91], v[80:83], v[200:203], v[88:91]
    v_mfma_f32_16x16x32_bf16 v[88:91], v[84:87], v[232:235], v[88:91]
    v_subrev_u32 v92, s78, v66
    v_cmp_le_i32 vcc, 0, v92
    s_nop 5
    v_cndmask_b32 v88, v93, v88, vcc
    v_max_f32 v70, v70, v88
    v_cmp_le_i32 vcc, 1, v92
    s_nop 1
    v_cndmask_b32 v89, v93, v89, vcc
    v_max_f32 v70, v70, v89
    v_cmp_le_i32 vcc, 2, v92
    s_nop 1
    v_cndmask_b32 v90, v93, v90, vcc
    v_max_f32 v70, v70, v90
    v_cmp_le_i32 vcc, 3, v92
    s_nop 1
    v_cndmask_b32 v91, v93, v91, vcc
    v_max_f32 v70, v70, v91
    v_mfma_f32_16x16x32_bf16 v[88:91], v[72:75], v[140:143], 0
    v_mfma_f32_16x16x32_bf16 v[88:91], v[76:79], v[172:175], v[88:91]
    v_mfma_f32_16x16x32_bf16 v[88:91], v[80:83], v[204:207], v[88:91]
    v_mfma_f32_16x16x32_bf16 v[88:91], v[84:87], v[236:239], v[88:91]
    v_subrev_u32 v92, s78, v67
    v_cmp_le_i32 vcc, 0, v92
    s_nop 5
    v_cndmask_b32 v88, v93, v88, vcc
    v_max_f32 v71, v71, v88
    v_cmp_le_i32 vcc, 1, v92
    s_nop 1
    v_cndmask_b32 v89, v93, v89, vcc
    v_max_f32 v71, v71, v89
    v_cmp_le_i32 vcc, 2, v92
    s_nop 1
    v_cndmask_b32 v90, v93, v90, vcc
    v_max_f32 v71, v71, v90
    v_cmp_le_i32 vcc, 3, v92
    s_nop 1
    v_cndmask_b32 v91, v93, v91, vcc
    v_max_f32 v71, v71, v91
    s_add_u32 s78, s78, 16
    s_cmp_lt_u32 s78, s99
    s_cbranch_scc1 K1_REDO_L
    v_mov_b32 v92, v68
    s_nop 1
    v_permlane32_swap_b32 v68, v92
    v_max_f32 v68, v68, v92
    v_mov_b32 v92, v68
    s_nop 1
    v_permlane16_swap_b32 v68, v92
    v_max_f32 v68, v68, v92
    v_sub_f32 v144, 0, v68
    v_sub_f32 v145, 0, v68
    v_sub_f32 v146, 0, v68
    v_sub_f32 v147, 0, v68
    v_mov_b32 v92, v69
    s_nop 1
    v_permlane32_swap_b32 v69, v92
    v_max_f32 v69, v69, v92
    v_mov_b32 v92, v69
    s_nop 1
    v_permlane16_swap_b32 v69, v92
    v_max_f32 v69, v69, v92
    v_sub_f32 v148, 0, v69
    v_sub_f32 v149, 0, v69
    v_sub_f32 v150, 0, v69
    v_sub_f32 v151, 0, v69
    v_mov_b32 v92, v70
    s_nop 1
    v_permlane32_swap_b32 v70, v92
    v_max_f32 v70, v70, v92
    v_mov_b32 v92, v70
    s_nop 1
    v_permlane16_swap_b32 v70, v92
    v_max_f32 v70, v70, v92
    v_sub_f32 v152, 0, v70
    v_sub_f32 v153, 0, v70
    v_sub_f32 v154, 0, v70
    v_sub_f32 v155, 0, v70
    v_mov_b32 v92, v71
    s_nop 1
    v_permlane32_swap_b32 v71, v92
    v_max_f32 v71, v71, v92
    v_mov_b32 v92, v71
    s_nop 1
    v_permlane16_swap_b32 v71, v92
    v_max_f32 v71, v71, v92
    v_sub_f32 v156, 0, v71
    v_sub_f32 v157, 0, v71
    v_sub_f32 v158, 0, v71
    v_sub_f32 v159, 0, v71
    v_accvgpr_write_b32 a0, 0
    v_accvgpr_write_b32 a1, 0
    v_accvgpr_write_b32 a2, 0
    v_accvgpr_write_b32 a3, 0
    v_accvgpr_write_b32 a4, 0
    v_accvgpr_write_b32 a5, 0
    v_accvgpr_write_b32 a6, 0
    v_accvgpr_write_b32 a7, 0
    v_accvgpr_write_b32 a8, 0
    v_accvgpr_write_b32 a9, 0
    v_accvgpr_write_b32 a10, 0
    v_accvgpr_write_b32 a11, 0
    v_accvgpr_write_b32 a12, 0
    v_accvgpr_write_b32 a13, 0
    v_accvgpr_write_b32 a14, 0
    v_accvgpr_write_b32 a15, 0
    v_accvgpr_write_b32 a16, 0
    v_accvgpr_write_b32 a17, 0
    v_accvgpr_write_b32 a18, 0
    v_accvgpr_write_b32 a19, 0
    v_accvgpr_write_b32 a20, 0
    v_accvgpr_write_b32 a21, 0
    v_accvgpr_write_b32 a22, 0
    v_accvgpr_write_b32 a23, 0
    v_accvgpr_write_b32 a24, 0
    v_accvgpr_write_b32 a25, 0
    v_accvgpr_write_b32 a26, 0
    v_accvgpr_write_b32 a27, 0
    v_accvgpr_write_b32 a28, 0
    v_accvgpr_write_b32 a29, 0
    v_accvgpr_write_b32 a30, 0
    v_accvgpr_write_b32 a31, 0
    v_accvgpr_write_b32 a32, 0
    v_accvgpr_write_b32 a33, 0
    v_accvgpr_write_b32 a34, 0
    v_accvgpr_write_b32 a35, 0
    v_accvgpr_write_b32 a36, 0
    v_accvgpr_write_b32 a37, 0
    v_accvgpr_write_b32 a38, 0
    v_accvgpr_write_b32 a39, 0
    v_accvgpr_write_b32 a40, 0
    v_accvgpr_write_b32 a41, 0
    v_accvgpr_write_b32 a42, 0
    v_accvgpr_write_b32 a43, 0
    v_accvgpr_write_b32 a44, 0
    v_accvgpr_write_b32 a45, 0
    v_accvgpr_write_b32 a46, 0
    v_accvgpr_write_b32 a47, 0
    v_accvgpr_write_b32 a48, 0
    v_accvgpr_write_b32 a49, 0
    v_accvgpr_write_b32 a50, 0
    v_accvgpr_write_b32 a51, 0
    v_accvgpr_write_b32 a52, 0
    v_accvgpr_write_b32 a53, 0
    v_accvgpr_write_b32 a54, 0
    v_accvgpr_write_b32 a55, 0
    v_accvgpr_write_b32 a56, 0
    v_accvgpr_write_b32 a57, 0
    v_accvgpr_write_b32 a58, 0
    v_accvgpr_write_b32 a59, 0
    v_accvgpr_write_b32 a60, 0
    v_accvgpr_write_b32 a61, 0
    v_accvgpr_write_b32 a62, 0
    v_accvgpr_write_b32 a63, 0
    v_accvgpr_write_b32 a144, 0
    v_accvgpr_write_b32 a145, 0
    v_accvgpr_write_b32 a146, 0
    v_accvgpr_write_b32 a147, 0
    v_accvgpr_write_b32 a148, 0
    v_accvgpr_write_b32 a149, 0
    v_accvgpr_write_b32 a150, 0
    v_accvgpr_write_b32 a151, 0
    v_accvgpr_write_b32 a152, 0
    v_accvgpr_write_b32 a153, 0
    v_accvgpr_write_b32 a154, 0
    v_accvgpr_write_b32 a155, 0
    v_accvgpr_write_b32 a156, 0
    v_accvgpr_write_b32 a157, 0
    v_accvgpr_write_b32 a158, 0
    v_accvgpr_write_b32 a159, 0
    v_accvgpr_write_b32 a160, 0
    v_accvgpr_write_b32 a161, 0
    v_accvgpr_write_b32 a162, 0
    v_accvgpr_write_b32 a163, 0
    v_accvgpr_write_b32 a164, 0
    v_accvgpr_write_b32 a165, 0
    v_accvgpr_write_b32 a166, 0
    v_accvgpr_write_b32 a167, 0
    v_accvgpr_write_b32 a168, 0
    v_accvgpr_write_b32 a169, 0
    v_accvgpr_write_b32 a170, 0
    v_accvgpr_write_b32 a171, 0
    v_accvgpr_write_b32 a172, 0
    v_accvgpr_write_b32 a173, 0
    v_accvgpr_write_b32 a174, 0
    v_accvgpr_write_b32 a175, 0
    v_accvgpr_write_b32 a176, 0
    v_accvgpr_write_b32 a177, 0
    v_accvgpr_write_b32 a178, 0
    v_accvgpr_write_b32 a179, 0
    v_accvgpr_write_b32 a180, 0
    v_accvgpr_write_b32 a181, 0
    v_accvgpr_write_b32 a182, 0
    v_accvgpr_write_b32 a183, 0
    v_accvgpr_write_b32 a184, 0
    v_accvgpr_write_b32 a185, 0
    v_accvgpr_write_b32 a186, 0
    v_accvgpr_write_b32 a187, 0
    v_accvgpr_write_b32 a188, 0
    v_accvgpr_write_b32 a189, 0
    v_accvgpr_write_b32 a190, 0
    v_accvgpr_write_b32 a191, 0
    v_accvgpr_write_b32 a192, 0
    v_accvgpr_write_b32 a193, 0
    v_accvgpr_write_b32 a194, 0
    v_accvgpr_write_b32 a195, 0
    v_accvgpr_write_b32 a196, 0
    v_accvgpr_write_b32 a197, 0
    v_accvgpr_write_b32 a198, 0
    v_accvgpr_write_b32 a199, 0
    v_accvgpr_write_b32 a200, 0
    v_accvgpr_write_b32 a201, 0
    v_accvgpr_write_b32 a202, 0
    v_accvgpr_write_b32 a203, 0
    v_accvgpr_write_b32 a204, 0
    v_accvgpr_write_b32 a205, 0
    v_accvgpr_write_b32 a206, 0
    v_accvgpr_write_b32 a207, 0
    v_accvgpr_write_b32 a208, 0
    v_accvgpr_write_b32 a209, 0
    v_accvgpr_write_b32 a210, 0
    v_accvgpr_write_b32 a211, 0
    v_accvgpr_write_b32 a212, 0
    v_accvgpr_write_b32 a213, 0
    v_accvgpr_write_b32 a214, 0
    v_accvgpr_write_b32 a215, 0
    v_accvgpr_write_b32 a216, 0
    v_accvgpr_write_b32 a217, 0
    v_accvgpr_write_b32 a218, 0
    v_accvgpr_write_b32 a219, 0
    v_accvgpr_write_b32 a220, 0
    v_accvgpr_write_b32 a221, 0
    v_accvgpr_write_b32 a222, 0
    v_accvgpr_write_b32 a223, 0
    v_bfe_u32 v92, v1, 4, 2
    v_cmp_eq_u32 vcc, 0, v92
    v_mov_b32 v92, 0x3f803f80
    s_nop 0
    v_cndmask_b32 v92, 0, v92, vcc
    v_accvgpr_write_b32 a136, v92
    v_accvgpr_write_b32 a137, v92
    v_accvgpr_write_b32 a138, v92
    v_accvgpr_write_b32 a139, v92
    s_mov_b32 s77, s75
    s_mov_b32 s76, 0
    s_mov_b32 s38, 16384
    s_add_u32 m0, s76, s75
    s_nop 0
    buffer_load_dwordx4 v1, s[36:39], s77 offen sc1 lds
    buffer_load_dwordx4 v1, s[36:39], s77 offen offset:1024 sc1 lds
    buffer_load_dwordx4 v1, s[36:39], s77 offen offset:2048 sc1 lds
    buffer_load_dwordx4 v1, s[36:39], s77 offen offset:3072 sc1 lds
    s_add_u32 s100, s77, 4096
    s_add_u32 m0, m0, 4096
    s_nop 0
    buffer_load_dwordx4 v1, s[36:39], s100 offen sc1 lds
    buffer_load_dwordx4 v1, s[36:39], s100 offen offset:1024 sc1 lds
    buffer_load_dwordx4 v1, s[36:39], s100 offen offset:2048 sc1 lds
    buffer_load_dwordx4 v1, s[36:39], s100 offen offset:3072 sc1 lds
    s_add_u32 s77, s77, 32768
    s_add_u32 s76, s76, 32768
    s_lshr_b32 s82, s4, 1
    s_add_u32 s82, s82, 32
    s_sub_u32 s82, s82, s6
    s_sub_u32 s82, s82, s6
    s_lshl_b32 s38, s82, 15
    s_add_u32 m0, s76, s75
    s_nop 0
    buffer_load_dwordx4 v1, s[36:39], s77 offen sc1 lds
    buffer_load_dwordx4 v1, s[36:39], s77 offen offset:1024 sc1 lds
    buffer_load_dwordx4 v1, s[36:39], s77 offen offset:2048 sc1 lds
    buffer_load_dwordx4 v1, s[36:39], s77 offen offset:3072 sc1 lds
    s_add_u32 s100, s77, 4096
    s_add_u32 m0, m0, 4096
    s_nop 0
    buffer_load_dwordx4 v1, s[36:39], s100 offen sc1 lds
    buffer_load_dwordx4 v1, s[36:39], s100 offen offset:1024 sc1 lds
    buffer_load_dwordx4 v1, s[36:39], s100 offen offset:2048 sc1 lds
    buffer_load_dwordx4 v1, s[36:39], s100 offen offset:3072 sc1 lds
    s_add_u32 s77, s77, 32768
    s_add_u32 s76, s76, 32768
    s_add_u32 m0, s76, s75
    s_nop 0
    buffer_load_dwordx4 v1, s[36:39], s77 offen sc1 lds
    buffer_load_dwordx4 v1, s[36:39], s77 offen offset:1024 sc1 lds
    buffer_load_dwordx4 v1, s[36:39], s77 offen offset:2048 sc1 lds
    buffer_load_dwordx4 v1, s[36:39], s77 offen offset:3072 sc1 lds
    s_add_u32 s100, s77, 4096
    s_add_u32 m0, m0, 4096
    s_nop 0
    buffer_load_dwordx4 v1, s[36:39], s100 offen sc1 lds
    buffer_load_dwordx4 v1, s[36:39], s100 offen offset:1024 sc1 lds
    buffer_load_dwordx4 v1, s[36:39], s100 offen offset:2048 sc1 lds
    buffer_load_dwordx4 v1, s[36:39], s100 offen offset:3072 sc1 lds
    s_add_u32 s77, s77, 32768
    s_add_u32 s76, s76, 32768
    s_mov_b32 s82, 0
    s_mov_b32 s60, 131072
    v_mov_b32 v2, v1
    s_cmp_eq_u32 s6, 0
    s_cselect_b32 s16, s8, 0
    s_cselect_b32 s17, s9, 0
    s_cmp_eq_u32 s6, 0
    s_cselect_b32 s18, s10, 0
    s_cselect_b32 s19, s11, 0
    s_cmp_eq_u32 s6, 0
    s_cselect_b32 s20, s12, 0
    s_cselect_b32 s21, s13, 0
    s_cmp_eq_u32 s6, 0
    s_cselect_b32 s22, s14, 0
    s_cselect_b32 s23, s15, 0
    s_waitcnt vmcnt(16)
    s_barrier
    ds_read_b128 a[224:227], v2 offset:0
    ds_read_b128 a[228:231], v2 offset:1024
    ds_read_b128 a[232:235], v2 offset:2048
    ds_read_b128 a[236:239], v2 offset:3072
    s_waitcnt lgkmcnt(0)
    ds_read_b128 a[240:243], v2 offset:4096
    ds_read_b128 a[244:247], v2 offset:5120
    ds_read_b128 a[248:251], v2 offset:6144
    ds_read_b128 a[252:255], v2 offset:7168
    v_mul_f32 v176, s16, v208
    v_mul_f32 v177, s16, v209
    v_mul_f32 v178, s16, v210
    v_mul_f32 v179, s16, v211
    s_nop 1
    v_mfma_f32_16x16x32_bf16 v[240:243], a[224:227], v[128:131], v[176:179]
    v_mfma_f32_16x16x32_bf16 v[240:243], a[228:231], v[160:163], v[240:243]
    v_mfma_f32_16x16x32_bf16 v[240:243], a[232:235], v[192:195], v[240:243]
    v_mfma_f32_16x16x32_bf16 v[240:243], a[236:239], v[224:227], v[240:243]
    v_mfma_f32_16x16x32_bf16 v[244:247], a[224:227], v[132:135], 0
    v_mfma_f32_16x16x32_bf16 v[244:247], a[228:231], v[164:167], v[244:247]
    v_mfma_f32_16x16x32_bf16 v[244:247], a[232:235], v[196:199], v[244:247]
    v_mfma_f32_16x16x32_bf16 v[244:247], a[236:239], v[228:231], v[244:247]
    v_mfma_f32_16x16x32_bf16 v[248:251], a[224:227], v[136:139], 0
    v_mfma_f32_16x16x32_bf16 v[248:251], a[228:231], v[168:171], v[248:251]
    v_mfma_f32_16x16x32_bf16 v[248:251], a[232:235], v[200:203], v[248:251]
    v_mfma_f32_16x16x32_bf16 v[248:251], a[236:239], v[232:235], v[248:251]
    v_mfma_f32_16x16x32_bf16 v[252:255], a[224:227], v[140:143], 0
    v_mfma_f32_16x16x32_bf16 v[252:255], a[228:231], v[172:175], v[252:255]
    v_mfma_f32_16x16x32_bf16 v[252:255], a[232:235], v[204:207], v[252:255]
    v_mfma_f32_16x16x32_bf16 v[252:255], a[236:239], v[236:239], v[252:255]
    v_add_f32 v240, v240, v144
    v_exp_f32 v240, v240
    v_add_f32 v241, v241, v144
    v_exp_f32 v241, v241
    v_add_f32 v242, v242, v144
    v_exp_f32 v242, v242
    v_add_f32 v243, v243, v144
    v_exp_f32 v243, v243
    v_add_f32 v244, v244, v148
    v_exp_f32 v244, v244
    v_add_f32 v245, v245, v148
    v_exp_f32 v245, v245
    v_add_f32 v246, v246, v148
    v_exp_f32 v246, v246
    v_add_f32 v247, v247, v148
    v_exp_f32 v247, v247
    v_add_f32 v248, v248, v152
    v_exp_f32 v248, v248
    v_add_f32 v249, v249, v152
    v_exp_f32 v249, v249
    v_add_f32 v250, v250, v152
    v_exp_f32 v250, v250
    v_add_f32 v251, v251, v152
    v_exp_f32 v251, v251
    v_add_f32 v252, v252, v156
    v_exp_f32 v252, v252
    v_add_f32 v253, v253, v156
    v_exp_f32 v253, v253
    v_add_f32 v254, v254, v156
    v_exp_f32 v254, v254
    v_add_f32 v255, v255, v156
    v_exp_f32 v255, v255
    s_nop 1
    s_branch K1_ATT
SPIN_WA:
    s_mov_b32 s94, 0
SPIN_WA_L:
    s_sleep 2
    buffer_load_dword v7, v9, s[44:47], s69 offen sc1
    s_add_u32 s94, s94, 1
    s_cmp_ge_u32 s94, 0x40000
    s_waitcnt vmcnt(0)
    s_cbranch_scc1 BACK_WA
    v_cmp_gt_u32 vcc, 8, v7
    s_nop 1
    s_and_b64 vcc, vcc, s[86:87]
    s_cbranch_scc1 SPIN_WA_L
    s_branch BACK_WA
SPIN_KV:
    s_mov_b32 s94, 0
SPIN_KV_L:
    s_sleep 2
    buffer_load_dword v7, v8, s[32:35], s61 offen sc1
    s_add_u32 s94, s94, 1
    s_cmp_ge_u32 s94, 0x40000
    s_waitcnt vmcnt(0)
    s_cbranch_scc1 BACK_KV
    v_cmp_gt_u32 vcc, 1, v7
    s_nop 1
    s_and_b64 vcc, vcc, exec
    s_cbranch_scc1 SPIN_KV_L
    s_branch BACK_KV
SPIN_SHORT:
    s_mov_b32 s94, 0
SPIN_SHORT_L:
    s_sleep 2
    buffer_load_dword v3, v217, s[32:35], s19 offen sc1
    s_add_u32 s94, s94, 1
    s_cmp_ge_u32 s94, 0x40000
    s_waitcnt vmcnt(0)
    s_cbranch_scc1 BACK_SHORT
    v_cmp_gt_u32 vcc, 1, v3
    s_nop 1
    s_and_b64 vcc, vcc, exec
    s_cbranch_scc1 SPIN_SHORT_L
    s_branch BACK_SHORT
SPIN_CTX:
    s_mov_b32 s94, 0
SPIN_CTX_L:
    s_sleep 2
    buffer_load_dword v3, v217, s[32:35], s19 offen sc1
    s_add_u32 s94, s94, 1
    s_cmp_ge_u32 s94, 0x40000
    s_waitcnt vmcnt(0)
    s_cbranch_scc1 BACK_CTX
    v_cmp_gt_u32 vcc, 2, v3
    s_nop 1
    s_and_b64 vcc, vcc, exec
    s_cbranch_scc1 SPIN_CTX_L
    s_branch BACK_CTX
SPIN_ALL:
    s_mov_b32 s94, 0
SPIN_ALL_L:
    s_sleep 2
    buffer_load_dword v28, v29, s[32:35], s92 offen sc1
    s_add_u32 s94, s94, 1
    s_cmp_ge_u32 s94, 0x40000
    s_waitcnt vmcnt(0)
    s_cbranch_scc1 BACK_ALL
    v_cmp_gt_u32 vcc, 1, v28
    s_nop 1
    s_and_b64 vcc, vcc, exec
    s_cbranch_scc1 SPIN_ALL_L
    s_branch BACK_ALL
SPIN_OA:
    s_mov_b32 s94, 0
SPIN_OA_L:
    s_sleep 2
    buffer_load_dword v3, v19, s[32:35], s66 offen sc1
    s_add_u32 s94, s94, 1
    s_cmp_ge_u32 s94, 0x40000
    s_waitcnt vmcnt(0)
    s_cbranch_scc1 BACK_OA
    v_cmp_gt_u32 vcc, 3, v3
    s_nop 1
    s_and_b64 vcc, vcc, exec
    s_cbranch_scc1 SPIN_OA_L
    s_branch BACK_OA
SPIN_X:
    s_mov_b32 s94, 0
SPIN_X_L:
    s_sleep 2
    buffer_load_dword v3, v19, s[32:35], s66 offen sc1
    s_add_u32 s94, s94, 1
    s_cmp_ge_u32 s94, 0x40000
    s_waitcnt vmcnt(0)
    s_cbranch_scc1 BACK_X
    v_cmp_gt_u32 vcc, 3, v3
    s_nop 1
    s_and_b64 vcc, vcc, exec
    s_cbranch_scc1 SPIN_X_L
    s_branch BACK_X
SPIN_W0:
    s_mov_b32 s94, 0
SPIN_W0_L:
    s_sleep 2
    buffer_load_dword v3, v29, s[32:35], s92 offen sc1
    s_add_u32 s94, s94, 1
    s_cmp_ge_u32 s94, 0x40000
    s_waitcnt vmcnt(0)
    s_cbranch_scc1 BACK_W0
    v_cmp_gt_u32 vcc, 1, v3
    s_nop 1
    s_cmp_lg_u32 vcc_lo, 0
    s_cbranch_scc1 SPIN_W0_L
    s_branch BACK_W0
SPIN_W7:
    s_mov_b32 s94, 0
SPIN_W7_L:
    s_sleep 2
    buffer_load_dword v3, v29, s[32:35], s92 offen sc1
    s_add_u32 s94, s94, 1
    s_cmp_ge_u32 s94, 0x40000
    s_waitcnt vmcnt(0)
    s_cbranch_scc1 BACK_W7
    v_cmp_gt_u32 vcc, 1, v3
    s_nop 1
    s_cmp_lg_u32 vcc_lo, 0
    s_cbranch_scc1 SPIN_W7_L
    s_branch BACK_W7
.section .rodata,"a"
.p2align 6
.amdhsa_kernel gated_mix__sliding_local_dilated__compressed_kv_cla__prompt_kernel
.amdhsa_next_free_vgpr 512
.amdhsa_next_free_sgpr 102
.amdhsa_accum_offset 256
.amdhsa_group_segment_fixed_size 0
.amdhsa_kernarg_size 104
.amdhsa_user_sgpr_count 2
.amdhsa_user_sgpr_kernarg_segment_ptr 1
.amdhsa_system_sgpr_workgroup_id_x 1
.amdhsa_ieee_mode 0
.amdhsa_dx10_clamp 0
.end_amdhsa_kernel
```

```asm
; @launch grid=(256,1,1) block=(256,1,1) lds=163840
.amdgcn_target "amdgcn-amd-amdhsa--gfx950"
.text
.globl gated_mix__sliding_local_dilated__compressed_kv_cla__prompt_kernel
.p2align 8
.type gated_mix__sliding_local_dilated__compressed_kv_cla__prompt_kernel,@function
gated_mix__sliding_local_dilated__compressed_kv_cla__prompt_kernel:
    s_cmp_ge_u32 s2, 256
    s_cbranch_scc1 K1_END
    s_getpc_b64 s[94:95]
    s_load_dwordx8 s[36:43], s[0:1], 32
    v_min_u32 v74, 16, v0
    s_lshr_b32 s7, s2, 3
    s_mul_i32 s7, s7, 17
    v_add_lshl_u32 v74, v74, s7, 7
    global_load_dword v76, v74, s[94:95]
    v_lshrrev_b32 v64, 6, v0
    v_and_b32 v31, 63, v0
    v_readfirstlane_b32 s4, v64
    s_and_b32 s5, s2, 7
    s_lshl_b32 s5, s5, 2
    s_bfe_u32 s7, s2, 0x20003
    s_add_u32 s5, s5, s7
    s_lshr_b32 s6, s2, 5
    s_lshl_b32 s69, s4, 12
    s_mov_b32 s10, 2097152
    s_mov_b32 s11, 0x20000
    s_mov_b32 s14, 4194304
    s_mov_b32 s15, 0x20000
    s_mov_b32 s18, 4194304
    s_mov_b32 s19, 0x20000
    v_lshrrev_b32 v65, 3, v31
    v_and_b32 v66, 7, v31
    v_lshrrev_b32 v67, 1, v65
    v_xor_b32 v66, v66, v67
    v_lshlrev_b32 v66, 4, v66
    v_xor_b32 v67, 64, v66
    s_lshr_b32 s7, s4, 1
    s_lshl_b32 s73, s7, 7
    s_and_b32 s100, s4, 1
    s_lshl_b32 s98, s100, 5
    s_add_u32 s98, s98, s73
    v_add_lshl_u32 v68, v65, s98, 10
    v_add_u32 v6, v68, v66
    v_add_u32 v7, v68, v67
    v_add_u32 v7, 7168, v7
    v_add_u32 v8, v68, v66
    v_add_u32 v8, 14336, v8
    v_add_u32 v9, v68, v67
    v_add_u32 v9, 21504, v9
    v_lshrrev_b32 v69, 4, v31
    v_and_b32 v70, 15, v31
    v_lshlrev_b32 v71, 1, v69
    v_xor_b32 v71, v71, v70
    v_lshlrev_b32 v71, 4, v71
    v_xor_b32 v72, 128, v71
    s_lshl_b32 s98, s4, 4
    v_add_lshl_u32 v73, v69, s98, 13
    v_add_u32 v2, v73, v71
    v_add_u32 v3, v73, v71
    v_add_u32 v3, 31744, v3
    v_add_u32 v4, v73, v72
    v_add_u32 v4, 63488, v4
    v_add_u32 v5, v73, v72
    v_add_u32 v5, 95232, v5
    s_and_b32 s3, s2, 0
    s_lshl_b32 s66, s3, 7
    s_lshl_b32 s60, s3, 11
    s_add_u32 s60, s60, s5
    s_lshl_b32 s60, s60, 8
    s_lshl_b32 s61, s6, 18
    s_add_u32 s61, s61, s66
    s_add_u32 s62, s61, 65536
    s_waitcnt lgkmcnt(0)
    s_mov_b64 s[8:9], s[36:37]
    s_mov_b64 s[24:25], s[38:39]
    s_mov_b64 s[12:13], s[40:41]
    s_mov_b64 s[16:17], s[42:43]
    s_load_dwordx2 s[20:21], s[0:1], 0
    s_load_dwordx2 s[28:29], s[0:1], 8
    s_load_dwordx2 s[32:33], s[0:1], 72
    s_load_dwordx2 s[48:49], s[0:1], 64
    s_load_dwordx2 s[92:93], s[0:1], 16
    s_load_dwordx2 s[44:45], s[0:1], 88
    s_load_dwordx2 s[56:57], s[0:1], 96
    s_load_dwordx2 s[0:1], s[0:1], 80
    s_add_u32 m0, s69, 0
    s_nop 0
    buffer_load_dwordx4 v6, s[8:11], s61 offen lds
    buffer_load_dwordx4 v7, s[8:11], s61 offen offset:1024 lds
    buffer_load_dwordx4 v8, s[8:11], s61 offen offset:2048 lds
    buffer_load_dwordx4 v9, s[8:11], s61 offen offset:3072 lds
    s_xor_b32 s61, s61, 128
    s_add_u32 m0, s69, 16384
    s_nop 0
    buffer_load_dwordx4 v6, s[8:11], s62 offen lds
    buffer_load_dwordx4 v7, s[8:11], s62 offen offset:1024 lds
    buffer_load_dwordx4 v8, s[8:11], s62 offen offset:2048 lds
    buffer_load_dwordx4 v9, s[8:11], s62 offen offset:3072 lds
    s_xor_b32 s62, s62, 128
    s_add_u32 m0, s69, 32768
    s_nop 0
    buffer_load_dwordx4 v2, s[12:15], s60 offen nt lds
    buffer_load_dwordx4 v3, s[12:15], s60 offen offset:1024 nt lds
    buffer_load_dwordx4 v4, s[12:15], s60 offen offset:2048 nt lds
    buffer_load_dwordx4 v5, s[12:15], s60 offen offset:3072 nt lds
    s_add_u32 m0, s69, 49152
    s_nop 0
    buffer_load_dwordx4 v6, s[8:11], s61 offen lds
    buffer_load_dwordx4 v7, s[8:11], s61 offen offset:1024 lds
    buffer_load_dwordx4 v8, s[8:11], s61 offen offset:2048 lds
    buffer_load_dwordx4 v9, s[8:11], s61 offen offset:3072 lds
    s_xor_b32 s61, s61, 384
    v_min_u32 v74, 15, v31
    s_lshl2_add_u32 s98, s2, s4
    s_lshl_b32 s98, s98, 11
    v_lshlrev_b32 v74, 7, v74
    buffer_load_dword v117, v74, s[8:11], s98 offen
    s_waitcnt lgkmcnt(0)
    s_mov_b32 s22, 2359296
    s_mov_b32 s23, 0x20000
    s_mov_b32 s26, 4718592
    s_mov_b32 s27, 0x20000
    s_mov_b32 s50, 4718592
    s_mov_b32 s51, 0x20000
    s_mov_b32 s46, 256
    s_mov_b32 s47, 0x20000
    s_mov_b32 s30, 1990656
    s_mov_b32 s31, 0x20000
    s_mov_b32 s34, 1152
    s_mov_b32 s35, 0x20000
    s_mul_i32 s7, s5, 1081344
    s_add_u32 s36, s56, s7
    s_addc_u32 s37, s57, 0
    s_mov_b32 s38, 1081344
    s_mov_b32 s39, 0x20000
    s_cmp_eq_u32 s4, 0
    s_cselect_b32 s86, 0x55555555, 0
    s_cselect_b32 s87, 0x55555555, 0
    s_cselect_b32 s52, s48, s92
    s_cselect_b32 s53, s49, s93
    s_cselect_b32 s54, s50, 663552
    s_mov_b32 s55, 0x20000
    s_mul_i32 s63, s6, 147456
    s_sub_u32 s64, 2211840, s63
    s_add_u32 s63, s63, s66
    s_add_u32 s64, s64, s66
    s_lshl_b32 s67, s4, 11
    s_lshl_b32 s68, s4, 10
    s_lshl_b32 s75, s4, 13
    s_lshl_b32 s65, s3, 13
    s_add_u32 s65, s65, s67
    s_lshl_b32 s70, s6, 2
    s_lshl1_add_u32 s70, s100, s70
    s_lshl_b32 s70, s70, 15
    s_lshl_b32 s98, s73, 6
    s_add_u32 s71, s70, s98
    s_add_u32 s71, s71, 49152
    s_lshl_b32 s98, s73, 4
    s_add_u32 s70, s70, s98
    v_lshlrev_b32 v1, 4, v31
    v_mov_b32 v77, 1073741824
    v_cmp_eq_u32 vcc, 0, v0
    s_nop 1
    v_cndmask_b32_e64 v30, v77, 0, vcc
    v_lshlrev_b32 v103, 7, v31
    v_cmp_gt_u32 vcc, 9, v31
    s_nop 1
    v_cndmask_b32 v103, v77, v103, vcc
    s_lshl_b32 s98, s4, 5
    v_add_u32 v68, s98, v65
    v_mul_u32_u24 v68, 1152, v68
    v_add_u32 v10, v68, v66
    v_add_u32 v11, v68, v67
    v_add_u32 v11, 8192, v11
    v_add_u32 v12, v68, v66
    v_add_u32 v12, 16384, v12
    v_add_u32 v13, v68, v67
    v_add_u32 v13, 24576, v13
    s_sub_u32 s98, 15, s6
    s_cmp_eq_u32 s73, 0
    s_cselect_b32 s98, s6, s98
    s_lshl_b32 s98, s98, 7
    s_sub_u32 s98, s98, 16
    s_max_i32 s98, s98, 0
    s_lshl3_add_u32 s98, s100, s98
    v_add_u32 v68, s98, v65
    v_mul_u32_u24 v68, 1152, v68
    s_lshl_b32 s98, s100, 6
    v_xor_b32 v73, s98, v66
    v_add_u32 v96, v68, v73
    s_add_u32 m0, s69, 65536
    s_nop 0
    buffer_load_dwordx4 v2, s[16:19], s60 offen nt lds
    v_lshrrev_b32 v71, 1, v70
    v_xor_b32 v71, v71, v69
    v_lshlrev_b32 v71, 4, v71
    v_lshl_add_u32 v71, v70, 7, v71
    v_xor_b32 v72, 64, v71
    s_lshl_b32 s98, s100, 13
    v_add_u32 v22, s98, v71
    v_add_u32 v23, s98, v72
    v_add_u32 v24, s67, v71
    v_add_u32 v25, s67, v72
    s_lshl_b32 s98, s100, 11
    s_add_u32 s98, s98, 8192
    v_add_u32 v100, s98, v71
    v_add_u32 v101, s98, v72
    v_bfe_u32 v73, v31, 2, 2
    v_and_b32 v74, 3, v31
    v_lshl_add_u32 v75, v69, 3, v73
    v_and_b32 v78, 1, v69
    buffer_load_dwordx4 v3, s[16:19], s60 offen offset:1024 nt lds
    v_lshl_add_u32 v77, v78, 2, v73
    v_lshlrev_b32 v77, 5, v77
    v_lshl_add_u32 v77, v74, 3, v77
    v_lshl_add_u32 v77, v75, 8, v77
    v_xor_b32 v14, 0, v77
    v_xor_b32 v14, s73, v14
    v_xor_b32 v15, 32, v77
    v_xor_b32 v15, s73, v15
    v_xor_b32 v16, 64, v77
    v_xor_b32 v16, s73, v16
    v_xor_b32 v17, 96, v77
    v_xor_b32 v17, s73, v17
    v_xor_b32 v18, 128, v77
    v_xor_b32 v19, 160, v77
    v_xor_b32 v20, 192, v77
    v_xor_b32 v21, 224, v77
    v_lshrrev_b32 v77, 1, v73
    v_lshl_add_u32 v77, v78, 1, v77
    buffer_load_dwordx4 v4, s[16:19], s60 offen offset:2048 nt lds
    v_lshlrev_b32 v77, 5, v77
    v_lshl_add_u32 v77, v74, 3, v77
    v_lshl_add_u32 v77, v75, 7, v77
    s_lshr_b32 s98, s73, 1
    v_xor_b32 v26, 0, v77
    v_xor_b32 v26, s98, v26
    v_xor_b32 v27, 32, v77
    v_xor_b32 v28, 64, v77
    v_xor_b32 v28, s98, v28
    v_xor_b32 v29, 96, v77
    v_and_b32 v73, 7, v0
    v_lshrrev_b32 v74, 3, v0
    v_lshl_add_u32 v75, v73, 1, 0
    v_mul_u32_u24 v78, 52, v75
    v_lshrrev_b32 v78, 8, v78
    v_mul_u32_u24 v79, 5, v78
    v_sub_u32 v75, v75, v79
    v_add_u32 v78, 1, v78
    buffer_load_dwordx4 v5, s[16:19], s60 offen offset:3072 nt lds
    s_xor_b32 s60, s60, 524288
    v_cmp_le_u32 vcc, 3, v78
    s_nop 1
    v_cndmask_b32_e64 v78, v78, 0, vcc
    v_mul_u32_u24 v78, 1152, v78
    v_lshl_add_u32 v75, v75, 3, v78
    v_mad_u32_u24 v75, v74, 36, v75
    v_lshl_add_u32 v77, v73, 1, 1
    v_mul_u32_u24 v78, 52, v77
    v_lshrrev_b32 v78, 8, v78
    v_mul_u32_u24 v79, 5, v78
    v_sub_u32 v77, v77, v79
    v_add_u32 v78, 1, v78
    v_cmp_le_u32 vcc, 3, v78
    s_nop 1
    v_cndmask_b32_e64 v78, v78, 0, vcc
    v_mul_u32_u24 v78, 1152, v78
    v_lshl_add_u32 v77, v77, 3, v78
    v_mad_u32_u24 v77, v74, 36, v77
    s_mul_i32 s98, s2, 10368
    s_mul_i32 s99, s2, 6
    s_mov_b32 s7, 73728
    v_mul_lo_u32 v95, v74, s7
    v_lshl_add_u32 v95, v73, 4, v95
    v_cmp_eq_u32 s[92:93], 7, v73
    s_add_u32 s56, s56, 56623104
    s_addc_u32 s57, s57, 0
    s_mov_b32 s58, 5603328
    s_mov_b32 s59, 0x20000
    s_lshl_b32 s101, s6, 5
    s_add_u32 s101, s101, s5
    s_lshl_b32 s101, s101, 7
    v_mov_b32 v65, 0
    v_lshrrev_b32 v64, 2, v0
    v_lshlrev_b32 v64, 15, v64
    v_and_b32 v79, 3, v0
    v_lshl_add_u32 v64, v79, 2, v64
    s_mov_b32 s74, 0x3e0293ee
    s_lshl_b32 s95, s5, 3
    s_waitcnt vmcnt(5)
    s_barrier
    ds_read_b128 a[0:3], v22 offset:0
    ds_read_b64_tr_b16 v[40:41], v14 offset:32768
    ds_read_b64_tr_b16 v[42:43], v14 offset:33792
    ds_read_b128 a[4:7], v23 offset:0
    ds_read_b64_tr_b16 v[44:45], v14 offset:40960
    ds_read_b64_tr_b16 v[46:47], v14 offset:41984
    ds_read_b128 a[8:11], v22 offset:2048
    ds_read_b128 a[12:15], v23 offset:2048
    ds_read_b128 a[16:19], v22 offset:4096
    ds_read_b128 a[20:23], v23 offset:4096
    ds_read_b128 a[24:27], v22 offset:6144
    ds_read_b128 a[28:31], v23 offset:6144
    ds_read_b128 a[32:35], v22 offset:16384
    ds_read_b128 a[36:39], v23 offset:16384
    ds_read_b128 a[40:43], v22 offset:18432
    s_waitcnt lgkmcnt(14)
    ds_read_b128 a[44:47], v23 offset:18432
    s_waitcnt lgkmcnt(14)
    ds_read_b128 a[48:51], v22 offset:20480
    s_waitcnt lgkmcnt(14)
    ds_read_b128 a[52:55], v23 offset:20480
    s_waitcnt lgkmcnt(14)
    ds_read_b128 a[56:59], v22 offset:22528
    s_waitcnt lgkmcnt(14)
    ds_read_b128 a[60:63], v23 offset:22528
    v_mfma_f32_16x16x32_bf16 v[128:131], v[40:43], a[0:3], 0
    s_add_u32 m0, s69, 81920
    s_waitcnt lgkmcnt(14)
    ds_read_b64_tr_b16 v[48:49], v15 offset:32768
    s_waitcnt lgkmcnt(14)
    ds_read_b64_tr_b16 v[50:51], v15 offset:33792
    v_mfma_f32_16x16x32_bf16 v[128:131], v[44:47], a[4:7], v[128:131]
    s_mul_i32 s77, s2, 9216
    buffer_load_dwordx4 v6, s[8:11], s62 offen lds
    v_mfma_f32_16x16x32_bf16 v[132:135], v[40:43], a[8:11], 0
    s_mul_i32 s76, s4, 1152
    s_waitcnt lgkmcnt(14)
    ds_read_b128 a[64:67], v22 offset:49152
    s_waitcnt lgkmcnt(13)
    ds_read_b64_tr_b16 v[52:53], v15 offset:40960
    v_mfma_f32_16x16x32_bf16 v[132:135], v[44:47], a[12:15], v[132:135]
    s_add_u32 s77, s77, s76
    ds_read_b64_tr_b16 v[54:55], v15 offset:41984
    s_waitcnt lgkmcnt(10)
    ds_read_b64_tr_b16 v[56:57], v16 offset:32768
    v_mfma_f32_16x16x32_bf16 v[136:139], v[40:43], a[16:19], 0
    s_mul_i32 s76, s4, 1152
    buffer_load_dwordx4 v7, s[8:11], s62 offen offset:1024 lds
    v_mfma_f32_16x16x32_bf16 v[136:139], v[44:47], a[20:23], v[136:139]
    s_mul_i32 s72, s2, 3
    ds_read_b64_tr_b16 v[58:59], v16 offset:33792
    ds_read_b64_tr_b16 v[60:61], v16 offset:40960
    v_mfma_f32_16x16x32_bf16 v[140:143], v[40:43], a[24:27], 0
    s_add_u32 s72, s72, 0
    ds_read_b64_tr_b16 v[62:63], v16 offset:41984
    v_add_u32 v14, 0x10000, v14
    v_mfma_f32_16x16x32_bf16 v[140:143], v[44:47], a[28:31], v[140:143]
    s_mul_i32 s7, s5, 73728
    ds_read_b128 a[68:71], v23 offset:49152
    v_add_u32 v15, 0x10000, v15
    v_mfma_f32_16x16x32_bf16 v[144:147], v[40:43], a[32:35], 0
    s_and_b32 s100, s5, 1
    buffer_load_dwordx4 v8, s[8:11], s62 offen offset:2048 lds
    v_mfma_f32_16x16x32_bf16 v[144:147], v[44:47], a[36:39], v[144:147]
    s_mov_b64 s[84:85], 0
    v_add_u32 v16, 0x10000, v16
    v_mov_b32 v31, 1
    v_mfma_f32_16x16x32_bf16 v[148:151], v[40:43], a[40:43], 0
    s_mov_b32 vcc_lo, 0x84848484
    s_mov_b32 vcc_hi, 0x84848484
    v_add_u32 v18, 0x10000, v18
    s_waitcnt lgkmcnt(2)
    v_mfma_f32_16x16x32_bf16 v[148:151], v[44:47], a[44:47], v[148:151]
    s_mov_b32 s83, 0
    v_add_u32 v19, 0x10000, v19
    v_add_u32 v20, 0x10000, v20
    v_mfma_f32_16x16x32_bf16 v[152:155], v[40:43], a[48:51], 0
    buffer_load_dwordx4 v9, s[8:11], s62 offen offset:3072 lds
    v_mfma_f32_16x16x32_bf16 v[152:155], v[44:47], a[52:55], v[152:155]
    ds_read_b128 a[72:75], v22 offset:51200
    v_add_u32 v21, 0x10000, v21
    v_mfma_f32_16x16x32_bf16 v[156:159], v[40:43], a[56:59], 0
    s_add_u32 m0, s69, 98304
    ds_read_b64_tr_b16 v[40:41], v17 offset:32768
    ds_read_b64_tr_b16 v[42:43], v17 offset:33792
    v_mfma_f32_16x16x32_bf16 v[156:159], v[44:47], a[60:63], v[156:159]
    s_xor_b32 s62, s62, 384
    ds_read_b64_tr_b16 v[44:45], v17 offset:40960
    ds_read_b64_tr_b16 v[46:47], v17 offset:41984
    v_mfma_f32_16x16x32_bf16 v[160:163], v[48:51], a[0:3], 0
    buffer_load_dwordx4 v2, s[12:15], s60 offen nt lds
    v_mfma_f32_16x16x32_bf16 v[160:163], v[52:55], a[4:7], v[160:163]
    v_add_u32 v17, 0x10000, v17
    v_add_u32 v26, 0x10000, v26
    v_mfma_f32_16x16x32_bf16 v[164:167], v[48:51], a[8:11], 0
    ds_read_b128 a[76:79], v23 offset:51200
    v_add_u32 v27, 0x10000, v27
    v_mfma_f32_16x16x32_bf16 v[164:167], v[52:55], a[12:15], v[164:167]
    v_add_u32 v28, 0x10000, v28
    v_add_u32 v29, 0x10000, v29
    v_mfma_f32_16x16x32_bf16 v[168:171], v[48:51], a[16:19], 0
    buffer_load_dwordx4 v3, s[12:15], s60 offen offset:1024 nt lds
    v_mfma_f32_16x16x32_bf16 v[168:171], v[52:55], a[20:23], v[168:171]
    v_bfe_u32 v37, v1, 4, 4
    v_mul_u32_u24 v36, 1152, v37
    v_mfma_f32_16x16x32_bf16 v[172:175], v[48:51], a[24:27], 0
    v_lshrrev_b32 v38, 8, v1
    v_lshl_add_u32 v36, v38, 4, v36
    v_mfma_f32_16x16x32_bf16 v[172:175], v[52:55], a[28:31], v[172:175]
    v_lshrrev_b32 v39, 3, v37
    v_mul_u32_u24 v39, 9152, v39
    v_mfma_f32_16x16x32_bf16 v[176:179], v[48:51], a[32:35], 0
    buffer_load_dwordx4 v4, s[12:15], s60 offen offset:2048 nt lds
    v_mfma_f32_16x16x32_bf16 v[176:179], v[52:55], a[36:39], v[176:179]
    ds_read_b128 a[80:83], v22 offset:53248
    v_mfma_f32_16x16x32_bf16 v[180:183], v[48:51], a[40:43], 0
    v_mfma_f32_16x16x32_bf16 v[180:183], v[52:55], a[44:47], v[180:183]
    v_mfma_f32_16x16x32_bf16 v[184:187], v[48:51], a[48:51], 0
    buffer_load_dwordx4 v5, s[12:15], s60 offen offset:3072 nt lds
    v_mfma_f32_16x16x32_bf16 v[184:187], v[52:55], a[52:55], v[184:187]
    ds_read_b128 a[84:87], v23 offset:53248
    v_mfma_f32_16x16x32_bf16 v[188:191], v[48:51], a[56:59], 0
    s_add_u32 m0, s69, 114688
    v_mfma_f32_16x16x32_bf16 v[188:191], v[52:55], a[60:63], v[188:191]
    v_mfma_f32_16x16x32_bf16 v[192:195], v[56:59], a[0:3], 0
    s_waitcnt lgkmcnt(1)
    buffer_load_dwordx4 v6, s[8:11], s61 offen lds
    v_mfma_f32_16x16x32_bf16 v[192:195], v[60:63], a[4:7], v[192:195]
    v_mfma_f32_16x16x32_bf16 v[196:199], v[56:59], a[8:11], 0
    v_mfma_f32_16x16x32_bf16 v[196:199], v[60:63], a[12:15], v[196:199]
    ds_read_b128 a[88:91], v22 offset:55296
    v_mfma_f32_16x16x32_bf16 v[200:203], v[56:59], a[16:19], 0
    buffer_load_dwordx4 v7, s[8:11], s61 offen offset:1024 lds
    v_mfma_f32_16x16x32_bf16 v[200:203], v[60:63], a[20:23], v[200:203]
    v_mfma_f32_16x16x32_bf16 v[204:207], v[56:59], a[24:27], 0
    v_mfma_f32_16x16x32_bf16 v[204:207], v[60:63], a[28:31], v[204:207]
    v_mfma_f32_16x16x32_bf16 v[208:211], v[56:59], a[32:35], 0
    buffer_load_dwordx4 v8, s[8:11], s61 offen offset:2048 lds
    v_mfma_f32_16x16x32_bf16 v[208:211], v[60:63], a[36:39], v[208:211]
    ds_read_b128 a[92:95], v23 offset:55296
    v_mfma_f32_16x16x32_bf16 v[212:215], v[56:59], a[40:43], 0
    v_mfma_f32_16x16x32_bf16 v[212:215], v[60:63], a[44:47], v[212:215]
    v_mfma_f32_16x16x32_bf16 v[216:219], v[56:59], a[48:51], 0
    buffer_load_dwordx4 v9, s[8:11], s61 offen offset:3072 lds
    v_mfma_f32_16x16x32_bf16 v[216:219], v[60:63], a[52:55], v[216:219]
    v_mfma_f32_16x16x32_bf16 v[220:223], v[56:59], a[56:59], 0
    s_xor_b32 s61, s61, 128
    v_mfma_f32_16x16x32_bf16 v[220:223], v[60:63], a[60:63], v[220:223]
    s_add_u32 m0, s69, 131072
    v_mfma_f32_16x16x32_bf16 v[224:227], v[40:43], a[0:3], 0
    buffer_load_dwordx4 v2, s[16:19], s60 offen nt lds
    v_mfma_f32_16x16x32_bf16 v[224:227], v[44:47], a[4:7], v[224:227]
    v_mfma_f32_16x16x32_bf16 v[228:231], v[40:43], a[8:11], 0
    buffer_load_dword v104, v103, s[20:23], s77 offen
    v_mfma_f32_16x16x32_bf16 v[228:231], v[44:47], a[12:15], v[228:231]
    s_add_u32 s77, s77, 4608
    v_mfma_f32_16x16x32_bf16 v[232:235], v[40:43], a[16:19], 0
    v_mfma_f32_16x16x32_bf16 v[232:235], v[44:47], a[20:23], v[232:235]
    s_waitcnt vmcnt(10)
    s_barrier
    ds_read_b64_tr_b16 v[48:49], v14 offset:0
    v_mfma_f32_16x16x32_bf16 v[236:239], v[40:43], a[24:27], 0
    buffer_load_dwordx4 v3, s[16:19], s60 offen offset:1024 nt lds
    v_mfma_f32_16x16x32_bf16 v[236:239], v[44:47], a[28:31], v[236:239]
    ds_read_b64_tr_b16 v[50:51], v14 offset:1024
    ds_read_b64_tr_b16 v[52:53], v14 offset:8192
    v_mfma_f32_16x16x32_bf16 v[240:243], v[40:43], a[32:35], 0
    ds_read_b64_tr_b16 v[54:55], v14 offset:9216
    ds_read_b64_tr_b16 v[56:57], v15 offset:0
    v_mfma_f32_16x16x32_bf16 v[240:243], v[44:47], a[36:39], v[240:243]
    buffer_load_dwordx4 v4, s[16:19], s60 offen offset:2048 nt lds
    v_mfma_f32_16x16x32_bf16 v[244:247], v[40:43], a[40:43], 0
    ds_read_b64_tr_b16 v[58:59], v15 offset:1024
    ds_read_b64_tr_b16 v[60:61], v15 offset:8192
    v_mfma_f32_16x16x32_bf16 v[244:247], v[44:47], a[44:47], v[244:247]
    ds_read_b64_tr_b16 v[62:63], v15 offset:9216
    v_mfma_f32_16x16x32_bf16 v[248:251], v[40:43], a[48:51], 0
    v_mfma_f32_16x16x32_bf16 v[248:251], v[44:47], a[52:55], v[248:251]
    buffer_load_dwordx4 v5, s[16:19], s60 offen offset:3072 nt lds
    v_mfma_f32_16x16x32_bf16 v[252:255], v[40:43], a[56:59], 0
    ds_read_b64_tr_b16 v[40:41], v16 offset:0
    ds_read_b64_tr_b16 v[42:43], v16 offset:1024
    v_mfma_f32_16x16x32_bf16 v[252:255], v[44:47], a[60:63], v[252:255]
    s_waitcnt lgkmcnt(3)
    ds_read_b64_tr_b16 v[44:45], v16 offset:8192
    ds_read_b64_tr_b16 v[46:47], v16 offset:9216
    v_mfma_f32_16x16x32_bf16 a[128:131], a[0:3], v[48:51], 0
    v_mfma_f32_16x16x32_bf16 a[128:131], a[4:7], v[52:55], a[128:131]
    s_add_u32 m0, s69, 147456
    v_add_u32 v22, 0x10000, v22
    v_mfma_f32_16x16x32_bf16 a[132:135], a[8:11], v[48:51], 0
    s_xor_b32 s60, s60, 1572864
    buffer_load_dwordx4 v6, s[8:11], s62 offen lds
    v_mfma_f32_16x16x32_bf16 a[132:135], a[12:15], v[52:55], a[132:135]
    ds_read_b128 a[96:99], v22 offset:16384
    v_mfma_f32_16x16x32_bf16 a[136:139], a[16:19], v[48:51], 0
    v_mfma_f32_16x16x32_bf16 a[136:139], a[20:23], v[52:55], a[136:139]
    v_mfma_f32_16x16x32_bf16 a[140:143], a[24:27], v[48:51], 0
    buffer_load_dwordx4 v7, s[8:11], s62 offen offset:1024 lds
    v_mfma_f32_16x16x32_bf16 a[140:143], a[28:31], v[52:55], a[140:143]
    v_add_u32 v23, 0x10000, v23
    ds_read_b128 a[100:103], v23 offset:16384
    v_mfma_f32_16x16x32_bf16 a[144:147], a[32:35], v[48:51], 0
    v_mfma_f32_16x16x32_bf16 a[144:147], a[36:39], v[52:55], a[144:147]
    v_mfma_f32_16x16x32_bf16 a[148:151], a[40:43], v[48:51], 0
    v_mfma_f32_16x16x32_bf16 a[148:151], a[44:47], v[52:55], a[148:151]
    buffer_load_dwordx4 v8, s[8:11], s62 offen offset:2048 lds
    v_mfma_f32_16x16x32_bf16 a[152:155], a[48:51], v[48:51], 0
    v_mfma_f32_16x16x32_bf16 a[152:155], a[52:55], v[52:55], a[152:155]
    ds_read_b128 a[104:107], v22 offset:18432
    v_mfma_f32_16x16x32_bf16 a[156:159], a[56:59], v[48:51], 0
    ds_read_b64_tr_b16 v[48:49], v17 offset:0
    ds_read_b64_tr_b16 v[50:51], v17 offset:1024
    v_mfma_f32_16x16x32_bf16 a[156:159], a[60:63], v[52:55], a[156:159]
    buffer_load_dwordx4 v9, s[8:11], s62 offen offset:3072 lds
    v_mfma_f32_16x16x32_bf16 a[160:163], a[0:3], v[56:59], 0
    s_waitcnt lgkmcnt(3)
    ds_read_b64_tr_b16 v[52:53], v17 offset:8192
    ds_read_b64_tr_b16 v[54:55], v17 offset:9216
    v_mfma_f32_16x16x32_bf16 a[160:163], a[4:7], v[60:63], a[160:163]
    v_mfma_f32_16x16x32_bf16 a[164:167], a[8:11], v[56:59], 0
    ds_read_b128 a[108:111], v23 offset:18432
    v_mfma_f32_16x16x32_bf16 a[164:167], a[12:15], v[60:63], a[164:167]
    s_add_u32 m0, s69, 0
    v_mfma_f32_16x16x32_bf16 a[168:171], a[16:19], v[56:59], 0
    s_xor_b32 s62, s62, 128
    buffer_load_dwordx4 v2, s[12:15], s60 offen nt lds
    v_mfma_f32_16x16x32_bf16 a[168:171], a[20:23], v[60:63], a[168:171]
    v_mfma_f32_16x16x32_bf16 a[172:175], a[24:27], v[56:59], 0
    v_mfma_f32_16x16x32_bf16 a[172:175], a[28:31], v[60:63], a[172:175]
    v_mfma_f32_16x16x32_bf16 a[176:179], a[32:35], v[56:59], 0
    buffer_load_dwordx4 v3, s[12:15], s60 offen offset:1024 nt lds
    v_mfma_f32_16x16x32_bf16 a[176:179], a[36:39], v[60:63], a[176:179]
    ds_read_b128 a[112:115], v22 offset:20480
    v_mfma_f32_16x16x32_bf16 a[180:183], a[40:43], v[56:59], 0
    v_mfma_f32_16x16x32_bf16 a[180:183], a[44:47], v[60:63], a[180:183]
    v_mfma_f32_16x16x32_bf16 a[184:187], a[48:51], v[56:59], 0
    v_mfma_f32_16x16x32_bf16 a[184:187], a[52:55], v[60:63], a[184:187]
    buffer_load_dwordx4 v4, s[12:15], s60 offen offset:2048 nt lds
    v_mfma_f32_16x16x32_bf16 a[188:191], a[56:59], v[56:59], 0
    ds_read_b128 a[116:119], v23 offset:20480
    v_mfma_f32_16x16x32_bf16 a[188:191], a[60:63], v[60:63], a[188:191]
    v_mfma_f32_16x16x32_bf16 a[192:195], a[0:3], v[40:43], 0
    v_mfma_f32_16x16x32_bf16 a[192:195], a[4:7], v[44:47], a[192:195]
    buffer_load_dwordx4 v5, s[12:15], s60 offen offset:3072 nt lds
    v_mfma_f32_16x16x32_bf16 a[196:199], a[8:11], v[40:43], 0
    v_mfma_f32_16x16x32_bf16 a[196:199], a[12:15], v[44:47], a[196:199]
    ds_read_b128 a[120:123], v22 offset:22528
    v_mfma_f32_16x16x32_bf16 a[200:203], a[16:19], v[40:43], 0
    v_mfma_f32_16x16x32_bf16 a[200:203], a[20:23], v[44:47], a[200:203]
    s_add_u32 m0, s69, 16384
    v_mfma_f32_16x16x32_bf16 a[204:207], a[24:27], v[40:43], 0
    buffer_load_dwordx4 v6, s[8:11], s61 offen lds
    v_mfma_f32_16x16x32_bf16 a[204:207], a[28:31], v[44:47], a[204:207]
    v_mfma_f32_16x16x32_bf16 a[208:211], a[32:35], v[40:43], 0
    ds_read_b128 a[124:127], v23 offset:22528
    v_mfma_f32_16x16x32_bf16 a[208:211], a[36:39], v[44:47], a[208:211]
    v_mfma_f32_16x16x32_bf16 a[212:215], a[40:43], v[40:43], 0
    buffer_load_dwordx4 v7, s[8:11], s61 offen offset:1024 lds
    v_mfma_f32_16x16x32_bf16 a[212:215], a[44:47], v[44:47], a[212:215]
    v_mfma_f32_16x16x32_bf16 a[216:219], a[48:51], v[40:43], 0
    v_mfma_f32_16x16x32_bf16 a[216:219], a[52:55], v[44:47], a[216:219]
    v_mfma_f32_16x16x32_bf16 a[220:223], a[56:59], v[40:43], 0
    v_mfma_f32_16x16x32_bf16 a[220:223], a[60:63], v[44:47], a[220:223]
    s_waitcnt lgkmcnt(0)
    buffer_load_dwordx4 v8, s[8:11], s61 offen offset:2048 lds
    v_mfma_f32_16x16x32_bf16 a[224:227], a[0:3], v[48:51], 0
    v_mfma_f32_16x16x32_bf16 a[224:227], a[4:7], v[52:55], a[224:227]
    v_mfma_f32_16x16x32_bf16 a[228:231], a[8:11], v[48:51], 0
    v_mfma_f32_16x16x32_bf16 a[228:231], a[12:15], v[52:55], a[228:231]
    buffer_load_dwordx4 v9, s[8:11], s61 offen offset:3072 lds
    v_mfma_f32_16x16x32_bf16 a[232:235], a[16:19], v[48:51], 0
    v_mfma_f32_16x16x32_bf16 a[232:235], a[20:23], v[52:55], a[232:235]
    s_waitcnt vmcnt(8) lgkmcnt(0)
    s_barrier
    ds_read_b64_tr_b16 v[56:57], v14 offset:32768
    v_mfma_f32_16x16x32_bf16 a[236:239], a[24:27], v[48:51], 0
    s_add_u32 m0, s69, 32768
    ds_read_b64_tr_b16 v[58:59], v14 offset:33792
    ds_read_b64_tr_b16 v[60:61], v14 offset:40960
    v_mfma_f32_16x16x32_bf16 a[236:239], a[28:31], v[52:55], a[236:239]
    s_xor_b32 s61, s61, 896
    buffer_load_dwordx4 v2, s[16:19], s60 offen nt lds
    v_mfma_f32_16x16x32_bf16 a[240:243], a[32:35], v[48:51], 0
    ds_read_b64_tr_b16 v[62:63], v14 offset:41984
    ds_read_b64_tr_b16 v[40:41], v15 offset:32768
    v_mfma_f32_16x16x32_bf16 a[240:243], a[36:39], v[52:55], a[240:243]
    ds_read_b64_tr_b16 v[42:43], v15 offset:33792
    ds_read_b64_tr_b16 v[44:45], v15 offset:40960
    v_mfma_f32_16x16x32_bf16 a[244:247], a[40:43], v[48:51], 0
    ds_read_b64_tr_b16 v[46:47], v15 offset:41984
    v_add_u32 v14, 0x10000, v14
    v_mfma_f32_16x16x32_bf16 a[244:247], a[44:47], v[52:55], a[244:247]
    v_add_u32 v15, 0x10000, v15
    v_mfma_f32_16x16x32_bf16 a[248:251], a[48:51], v[48:51], 0
    v_mfma_f32_16x16x32_bf16 a[248:251], a[52:55], v[52:55], a[248:251]
    buffer_load_dwordx4 v3, s[16:19], s60 offen offset:1024 nt lds
    v_mfma_f32_16x16x32_bf16 a[252:255], a[56:59], v[48:51], 0
    ds_read_b64_tr_b16 v[48:49], v16 offset:32768
    ds_read_b64_tr_b16 v[50:51], v16 offset:33792
    v_mfma_f32_16x16x32_bf16 a[252:255], a[60:63], v[52:55], a[252:255]
    s_waitcnt lgkmcnt(2)
    ds_read_b64_tr_b16 v[52:53], v16 offset:40960
    ds_read_b64_tr_b16 v[54:55], v16 offset:41984
    v_mfma_f32_16x16x32_bf16 v[128:131], v[56:59], a[64:67], v[128:131]
    v_add_u32 v16, 0x10000, v16
    v_mfma_f32_16x16x32_bf16 v[128:131], v[60:63], a[68:71], v[128:131]
    v_mfma_f32_16x16x32_bf16 v[132:135], v[56:59], a[72:75], v[132:135]
    ds_read_b128 a[0:3], v22 offset:49152
    v_mfma_f32_16x16x32_bf16 v[132:135], v[60:63], a[76:79], v[132:135]
    v_mfma_f32_16x16x32_bf16 v[136:139], v[56:59], a[80:83], v[136:139]
    v_mfma_f32_16x16x32_bf16 v[136:139], v[60:63], a[84:87], v[136:139]
    buffer_load_dwordx4 v4, s[16:19], s60 offen offset:2048 nt lds
    v_mfma_f32_16x16x32_bf16 v[140:143], v[56:59], a[88:91], v[140:143]
    v_mfma_f32_16x16x32_bf16 v[140:143], v[60:63], a[92:95], v[140:143]
    ds_read_b128 a[4:7], v23 offset:49152
    v_mfma_f32_16x16x32_bf16 v[144:147], v[56:59], a[96:99], v[144:147]
    v_mfma_f32_16x16x32_bf16 v[144:147], v[60:63], a[100:103], v[144:147]
    v_mfma_f32_16x16x32_bf16 v[148:151], v[56:59], a[104:107], v[148:151]
    v_mfma_f32_16x16x32_bf16 v[148:151], v[60:63], a[108:111], v[148:151]
    v_mfma_f32_16x16x32_bf16 v[152:155], v[56:59], a[112:115], v[152:155]
    buffer_load_dwordx4 v5, s[16:19], s60 offen offset:3072 nt lds
    v_mfma_f32_16x16x32_bf16 v[152:155], v[60:63], a[116:119], v[152:155]
    ds_read_b128 a[8:11], v22 offset:51200
    v_mfma_f32_16x16x32_bf16 v[156:159], v[56:59], a[120:123], v[156:159]
    ds_read_b64_tr_b16 v[56:57], v17 offset:32768
    ds_read_b64_tr_b16 v[58:59], v17 offset:33792
    v_mfma_f32_16x16x32_bf16 v[156:159], v[60:63], a[124:127], v[156:159]
    ds_read_b64_tr_b16 v[60:61], v17 offset:40960
    ds_read_b64_tr_b16 v[62:63], v17 offset:41984
    v_mfma_f32_16x16x32_bf16 v[160:163], v[40:43], a[64:67], v[160:163]
    v_add_u32 v17, 0x10000, v17
    v_mfma_f32_16x16x32_bf16 v[160:163], v[44:47], a[68:71], v[160:163]
    v_mfma_f32_16x16x32_bf16 v[164:167], v[40:43], a[72:75], v[164:167]
    ds_read_b128 a[12:15], v23 offset:51200
    v_mfma_f32_16x16x32_bf16 v[164:167], v[44:47], a[76:79], v[164:167]
    s_add_u32 m0, s69, 49152
    v_mfma_f32_16x16x32_bf16 v[168:171], v[40:43], a[80:83], v[168:171]
    s_xor_b32 s60, s60, 524288
    buffer_load_dwordx4 v6, s[8:11], s62 offen lds
    v_mfma_f32_16x16x32_bf16 v[168:171], v[44:47], a[84:87], v[168:171]
    v_mfma_f32_16x16x32_bf16 v[172:175], v[40:43], a[88:91], v[172:175]
    v_mfma_f32_16x16x32_bf16 v[172:175], v[44:47], a[92:95], v[172:175]
    v_mfma_f32_16x16x32_bf16 v[176:179], v[40:43], a[96:99], v[176:179]
    ds_read_b128 a[16:19], v22 offset:53248
    v_mfma_f32_16x16x32_bf16 v[176:179], v[44:47], a[100:103], v[176:179]
    v_mfma_f32_16x16x32_bf16 v[180:183], v[40:43], a[104:107], v[180:183]
    v_mfma_f32_16x16x32_bf16 v[180:183], v[44:47], a[108:111], v[180:183]
    buffer_load_dwordx4 v7, s[8:11], s62 offen offset:1024 lds
    v_mfma_f32_16x16x32_bf16 v[184:187], v[40:43], a[112:115], v[184:187]
    v_mfma_f32_16x16x32_bf16 v[184:187], v[44:47], a[116:119], v[184:187]
    ds_read_b128 a[20:23], v23 offset:53248
    v_mfma_f32_16x16x32_bf16 v[188:191], v[40:43], a[120:123], v[188:191]
    s_waitcnt lgkmcnt(1)
    ds_read_b64_tr_b16 v[40:41], v14 offset:0
    ds_read_b64_tr_b16 v[42:43], v14 offset:1024
    v_mfma_f32_16x16x32_bf16 v[188:191], v[44:47], a[124:127], v[188:191]
    ds_read_b64_tr_b16 v[44:45], v14 offset:8192
    ds_read_b64_tr_b16 v[46:47], v14 offset:9216
    v_mfma_f32_16x16x32_bf16 v[192:195], v[48:51], a[64:67], v[192:195]
    v_add_u32 v14, 0xfffe0000, v14
    v_mfma_f32_16x16x32_bf16 v[192:195], v[52:55], a[68:71], v[192:195]
    v_mfma_f32_16x16x32_bf16 v[196:199], v[48:51], a[72:75], v[196:199]
    v_mfma_f32_16x16x32_bf16 v[196:199], v[52:55], a[76:79], v[196:199]
    buffer_load_dwordx4 v8, s[8:11], s62 offen offset:2048 lds
    v_mfma_f32_16x16x32_bf16 v[200:203], v[48:51], a[80:83], v[200:203]
    ds_read_b128 a[24:27], v22 offset:55296
    v_mfma_f32_16x16x32_bf16 v[200:203], v[52:55], a[84:87], v[200:203]
    v_mfma_f32_16x16x32_bf16 v[204:207], v[48:51], a[88:91], v[204:207]
    v_mfma_f32_16x16x32_bf16 v[204:207], v[52:55], a[92:95], v[204:207]
    v_mfma_f32_16x16x32_bf16 v[208:211], v[48:51], a[96:99], v[208:211]
    ds_read_b128 a[28:31], v23 offset:55296
    v_mfma_f32_16x16x32_bf16 v[208:211], v[52:55], a[100:103], v[208:211]
    v_mfma_f32_16x16x32_bf16 v[212:215], v[48:51], a[104:107], v[212:215]
    buffer_load_dwordx4 v9, s[8:11], s62 offen offset:3072 lds
    v_mfma_f32_16x16x32_bf16 v[212:215], v[52:55], a[108:111], v[212:215]
    v_mfma_f32_16x16x32_bf16 v[216:219], v[48:51], a[112:115], v[216:219]
    v_mfma_f32_16x16x32_bf16 v[216:219], v[52:55], a[116:119], v[216:219]
    v_mfma_f32_16x16x32_bf16 v[220:223], v[48:51], a[120:123], v[220:223]
    ds_read_b64_tr_b16 v[48:49], v15 offset:0
    ds_read_b64_tr_b16 v[50:51], v15 offset:1024
    v_mfma_f32_16x16x32_bf16 v[220:223], v[52:55], a[124:127], v[220:223]
    ds_read_b64_tr_b16 v[52:53], v15 offset:8192
    ds_read_b64_tr_b16 v[54:55], v15 offset:9216
    v_mfma_f32_16x16x32_bf16 v[224:227], v[56:59], a[64:67], v[224:227]
    buffer_load_dwordx2 v[80:81], v75, s[28:31], s98 offen nt
    v_mfma_f32_16x16x32_bf16 v[224:227], v[60:63], a[68:71], v[224:227]
    s_xor_b32 s62, s62, 896
    v_add_u32 v15, 0xfffe0000, v15
    v_mfma_f32_16x16x32_bf16 v[228:231], v[56:59], a[72:75], v[228:231]
    buffer_load_dword v105, v103, s[20:23], s77 offen
    v_mfma_f32_16x16x32_bf16 v[228:231], v[60:63], a[76:79], v[228:231]
    s_mul_i32 s77, s2, 18432
    v_mfma_f32_16x16x32_bf16 v[232:235], v[56:59], a[80:83], v[232:235]
    s_add_u32 s77, s77, s76
    buffer_load_dwordx2 v[82:83], v77, s[28:31], s98 offen nt
    v_mfma_f32_16x16x32_bf16 v[232:235], v[60:63], a[84:87], v[232:235]
    s_add_u32 s98, s98, 3456
    v_mfma_f32_16x16x32_bf16 v[236:239], v[56:59], a[88:91], v[236:239]
    s_add_u32 m0, s69, 65536
    v_mfma_f32_16x16x32_bf16 v[236:239], v[60:63], a[92:95], v[236:239]
    s_mov_b32 s76, 0
    v_mfma_f32_16x16x32_bf16 v[240:243], v[56:59], a[96:99], v[240:243]
    buffer_load_ushort v92, v65, s[32:35], s99 offen offset:0
    v_mfma_f32_16x16x32_bf16 v[240:243], v[60:63], a[100:103], v[240:243]
    v_mfma_f32_16x16x32_bf16 v[244:247], v[56:59], a[104:107], v[244:247]
    v_mfma_f32_16x16x32_bf16 v[244:247], v[60:63], a[108:111], v[244:247]
    v_mfma_f32_16x16x32_bf16 v[248:251], v[56:59], a[112:115], v[248:251]
    buffer_load_dwordx2 v[84:85], v75, s[28:31], s98 offen nt
    v_mfma_f32_16x16x32_bf16 v[248:251], v[60:63], a[116:119], v[248:251]
    v_mfma_f32_16x16x32_bf16 v[252:255], v[56:59], a[120:123], v[252:255]
    ds_read_b64_tr_b16 v[56:57], v16 offset:0
    ds_read_b64_tr_b16 v[58:59], v16 offset:1024
    v_mfma_f32_16x16x32_bf16 v[252:255], v[60:63], a[124:127], v[252:255]
    s_waitcnt lgkmcnt(2)
    ds_read_b64_tr_b16 v[60:61], v16 offset:8192
    ds_read_b64_tr_b16 v[62:63], v16 offset:9216
    v_mfma_f32_16x16x32_bf16 a[128:131], a[64:67], v[40:43], a[128:131]
    buffer_load_dwordx4 v2, s[12:15], s60 offen nt lds
    v_mfma_f32_16x16x32_bf16 a[128:131], a[68:71], v[44:47], a[128:131]
    v_add_u32 v22, 0x10000, v22
    v_add_u32 v16, 0xfffe0000, v16
    v_mfma_f32_16x16x32_bf16 a[132:135], a[72:75], v[40:43], a[132:135]
    ds_read_b128 a[32:35], v22 offset:16384
    v_mfma_f32_16x16x32_bf16 a[132:135], a[76:79], v[44:47], a[132:135]
    v_mfma_f32_16x16x32_bf16 a[136:139], a[80:83], v[40:43], a[136:139]
    buffer_load_dwordx2 v[86:87], v77, s[28:31], s98 offen nt
    v_mfma_f32_16x16x32_bf16 a[136:139], a[84:87], v[44:47], a[136:139]
    s_add_u32 s98, s98, 3456
    v_mfma_f32_16x16x32_bf16 a[140:143], a[88:91], v[40:43], a[140:143]
    v_add_u32 v23, 0x10000, v23
    v_mfma_f32_16x16x32_bf16 a[140:143], a[92:95], v[44:47], a[140:143]
    ds_read_b128 a[36:39], v23 offset:16384
    v_mfma_f32_16x16x32_bf16 a[144:147], a[96:99], v[40:43], a[144:147]
    buffer_load_ushort v93, v65, s[32:35], s99 offen offset:2
    v_mfma_f32_16x16x32_bf16 a[144:147], a[100:103], v[44:47], a[144:147]
    v_mfma_f32_16x16x32_bf16 a[148:151], a[104:107], v[40:43], a[148:151]
    v_mfma_f32_16x16x32_bf16 a[148:151], a[108:111], v[44:47], a[148:151]
    v_mfma_f32_16x16x32_bf16 a[152:155], a[112:115], v[40:43], a[152:155]
    buffer_load_dwordx2 v[88:89], v75, s[28:31], s98 offen nt
    v_mfma_f32_16x16x32_bf16 a[152:155], a[116:119], v[44:47], a[152:155]
    ds_read_b128 a[40:43], v22 offset:18432
    v_mfma_f32_16x16x32_bf16 a[156:159], a[120:123], v[40:43], a[156:159]
    ds_read_b64_tr_b16 v[40:41], v17 offset:0
    ds_read_b64_tr_b16 v[42:43], v17 offset:1024
    v_mfma_f32_16x16x32_bf16 a[156:159], a[124:127], v[44:47], a[156:159]
    ds_read_b64_tr_b16 v[44:45], v17 offset:8192
    ds_read_b64_tr_b16 v[46:47], v17 offset:9216
    v_mfma_f32_16x16x32_bf16 a[160:163], a[64:67], v[48:51], a[160:163]
    buffer_load_dwordx4 v3, s[12:15], s60 offen offset:1024 nt lds
    v_mfma_f32_16x16x32_bf16 a[160:163], a[68:71], v[52:55], a[160:163]
    v_add_u32 v17, 0xfffe0000, v17
    v_mfma_f32_16x16x32_bf16 a[164:167], a[72:75], v[48:51], a[164:167]
    ds_read_b128 a[44:47], v23 offset:18432
    v_mfma_f32_16x16x32_bf16 a[164:167], a[76:79], v[52:55], a[164:167]
    v_mfma_f32_16x16x32_bf16 a[168:171], a[80:83], v[48:51], a[168:171]
    buffer_load_dwordx2 v[90:91], v77, s[28:31], s98 offen nt
    v_mfma_f32_16x16x32_bf16 a[168:171], a[84:87], v[52:55], a[168:171]
    s_add_u32 s98, s98, 3456
    s_add_u32 s28, s56, 6291456
    s_addc_u32 s29, s57, 0
    v_mfma_f32_16x16x32_bf16 a[172:175], a[88:91], v[48:51], a[172:175]
    s_mov_b32 s30, 2359296
    v_mfma_f32_16x16x32_bf16 a[172:175], a[92:95], v[52:55], a[172:175]
    s_bfe_u32 s98, s72, 0x10001
    v_mfma_f32_16x16x32_bf16 a[176:179], a[96:99], v[48:51], a[176:179]
    buffer_load_ushort v94, v65, s[32:35], s99 offen offset:4
    v_mfma_f32_16x16x32_bf16 a[176:179], a[100:103], v[52:55], a[176:179]
    s_add_u32 s32, s56, 9437184
    s_addc_u32 s33, s57, 0
    s_mov_b32 s34, 196608
    v_mfma_f32_16x16x32_bf16 a[180:183], a[104:107], v[48:51], a[180:183]
    s_bfe_u32 s99, s72, 0x10003
    ds_read_b128 a[48:51], v22 offset:20480
    v_mfma_f32_16x16x32_bf16 a[180:183], a[108:111], v[52:55], a[180:183]
    s_lshl1_add_u32 s98, s99, s98
    v_mfma_f32_16x16x32_bf16 a[184:187], a[112:115], v[48:51], a[184:187]
    s_lshl_b32 s98, s98, 5
    buffer_store_dword v65, v64, s[32:35], s101 offen sc1
    v_mfma_f32_16x16x32_bf16 a[184:187], a[116:119], v[52:55], a[184:187]
    s_lshl_b32 s72, s72, 7
    ds_read_b128 a[52:55], v23 offset:20480
    v_mfma_f32_16x16x32_bf16 a[188:191], a[120:123], v[48:51], a[188:191]
    v_mfma_f32_16x16x32_bf16 a[188:191], a[124:127], v[52:55], a[188:191]
    s_waitcnt lgkmcnt(1)
    v_mfma_f32_16x16x32_bf16 a[192:195], a[64:67], v[56:59], a[192:195]
    buffer_load_dwordx4 v4, s[12:15], s60 offen offset:2048 nt lds
    v_mfma_f32_16x16x32_bf16 a[192:195], a[68:71], v[60:63], a[192:195]
    v_mfma_f32_16x16x32_bf16 a[196:199], a[72:75], v[56:59], a[196:199]
    v_mfma_f32_16x16x32_bf16 a[196:199], a[76:79], v[60:63], a[196:199]
    ds_read_b128 a[56:59], v22 offset:22528
    v_mfma_f32_16x16x32_bf16 a[200:203], a[80:83], v[56:59], a[200:203]
    buffer_load_dwordx4 v5, s[12:15], s60 offen offset:3072 nt lds
    v_mfma_f32_16x16x32_bf16 a[200:203], a[84:87], v[60:63], a[200:203]
    s_add_u32 m0, s69, 81920
    v_mfma_f32_16x16x32_bf16 a[204:207], a[88:91], v[56:59], a[204:207]
    v_mfma_f32_16x16x32_bf16 a[204:207], a[92:95], v[60:63], a[204:207]
    v_mfma_f32_16x16x32_bf16 a[208:211], a[96:99], v[56:59], a[208:211]
    buffer_load_dwordx4 v6, s[8:11], s61 offen lds
    v_mfma_f32_16x16x32_bf16 a[208:211], a[100:103], v[60:63], a[208:211]
    ds_read_b128 a[60:63], v23 offset:22528
    v_mfma_f32_16x16x32_bf16 a[212:215], a[104:107], v[56:59], a[212:215]
    v_mfma_f32_16x16x32_bf16 a[212:215], a[108:111], v[60:63], a[212:215]
    v_mfma_f32_16x16x32_bf16 a[216:219], a[112:115], v[56:59], a[216:219]
    buffer_load_dwordx4 v7, s[8:11], s61 offen offset:1024 lds
    v_mfma_f32_16x16x32_bf16 a[216:219], a[116:119], v[60:63], a[216:219]
    v_mfma_f32_16x16x32_bf16 a[220:223], a[120:123], v[56:59], a[220:223]
    v_mfma_f32_16x16x32_bf16 a[220:223], a[124:127], v[60:63], a[220:223]
    v_mfma_f32_16x16x32_bf16 a[224:227], a[64:67], v[40:43], a[224:227]
    buffer_load_dwordx4 v8, s[8:11], s61 offen offset:2048 lds
    v_mfma_f32_16x16x32_bf16 a[224:227], a[68:71], v[44:47], a[224:227]
    v_mfma_f32_16x16x32_bf16 a[228:231], a[72:75], v[40:43], a[228:231]
    v_mfma_f32_16x16x32_bf16 a[228:231], a[76:79], v[44:47], a[228:231]
    v_mfma_f32_16x16x32_bf16 a[232:235], a[80:83], v[40:43], a[232:235]
    buffer_load_dwordx4 v9, s[8:11], s61 offen offset:3072 lds
    v_mfma_f32_16x16x32_bf16 a[232:235], a[84:87], v[44:47], a[232:235]
    s_xor_b32 s61, s61, 128
    s_waitcnt vmcnt(19) lgkmcnt(0)
    s_barrier
    v_mfma_f32_16x16x32_bf16 a[236:239], a[88:91], v[40:43], a[236:239]
    s_add_u32 m0, s69, 98304
    ds_read_b64_tr_b16 v[48:49], v14 offset:0
    ds_read_b64_tr_b16 v[50:51], v14 offset:1024
    v_mfma_f32_16x16x32_bf16 a[236:239], a[92:95], v[44:47], a[236:239]
    ds_read_b64_tr_b16 v[52:53], v14 offset:8192
    ds_read_b64_tr_b16 v[54:55], v14 offset:9216
    v_mfma_f32_16x16x32_bf16 a[240:243], a[96:99], v[40:43], a[240:243]
    buffer_load_dwordx4 v2, s[16:19], s60 offen nt lds
    v_mfma_f32_16x16x32_bf16 a[240:243], a[100:103], v[44:47], a[240:243]
    ds_read_b64_tr_b16 v[56:57], v15 offset:0
    ds_read_b64_tr_b16 v[58:59], v15 offset:1024
    v_mfma_f32_16x16x32_bf16 a[244:247], a[104:107], v[40:43], a[244:247]
    ds_read_b64_tr_b16 v[60:61], v15 offset:8192
    ds_read_b64_tr_b16 v[62:63], v15 offset:9216
    v_mfma_f32_16x16x32_bf16 a[244:247], a[108:111], v[44:47], a[244:247]
    s_cmp_lt_u32 s2, 192
    s_cselect_b32 s72, s72, 1073741824
    v_mfma_f32_16x16x32_bf16 a[248:251], a[112:115], v[40:43], a[248:251]
    v_mfma_f32_16x16x32_bf16 a[248:251], a[116:119], v[44:47], a[248:251]
    buffer_load_dwordx4 v3, s[16:19], s60 offen offset:1024 nt lds
    v_mfma_f32_16x16x32_bf16 a[252:255], a[120:123], v[40:43], a[252:255]
    ds_read_b64_tr_b16 v[40:41], v16 offset:0
    ds_read_b64_tr_b16 v[42:43], v16 offset:1024
    v_mfma_f32_16x16x32_bf16 a[252:255], a[124:127], v[44:47], a[252:255]
    s_waitcnt lgkmcnt(2)
    ds_read_b64_tr_b16 v[44:45], v16 offset:8192
    ds_read_b64_tr_b16 v[46:47], v16 offset:9216
    v_mfma_f32_16x16x32_bf16 v[128:131], v[48:51], a[0:3], v[128:131]
    v_mfma_f32_16x16x32_bf16 v[128:131], v[52:55], a[4:7], v[128:131]
    v_add_u32 v22, 0xfffe0000, v22
    v_mfma_f32_16x16x32_bf16 v[132:135], v[48:51], a[8:11], v[132:135]
    ds_read_b128 a[64:67], v22 offset:16384
    v_mfma_f32_16x16x32_bf16 v[132:135], v[52:55], a[12:15], v[132:135]
    v_mfma_f32_16x16x32_bf16 v[136:139], v[48:51], a[16:19], v[136:139]
    v_mfma_f32_16x16x32_bf16 v[136:139], v[52:55], a[20:23], v[136:139]
    buffer_load_dwordx4 v4, s[16:19], s60 offen offset:2048 nt lds
    v_mfma_f32_16x16x32_bf16 v[140:143], v[48:51], a[24:27], v[140:143]
    v_add_u32 v23, 0xfffe0000, v23
    v_mfma_f32_16x16x32_bf16 v[140:143], v[52:55], a[28:31], v[140:143]
    ds_read_b128 a[68:71], v23 offset:16384
    v_mfma_f32_16x16x32_bf16 v[144:147], v[48:51], a[32:35], v[144:147]
    v_mfma_f32_16x16x32_bf16 v[144:147], v[52:55], a[36:39], v[144:147]
    v_mfma_f32_16x16x32_bf16 v[148:151], v[48:51], a[40:43], v[148:151]
    v_mfma_f32_16x16x32_bf16 v[148:151], v[52:55], a[44:47], v[148:151]
    v_mfma_f32_16x16x32_bf16 v[152:155], v[48:51], a[48:51], v[152:155]
    buffer_load_dwordx4 v5, s[16:19], s60 offen offset:3072 nt lds
    v_mfma_f32_16x16x32_bf16 v[152:155], v[52:55], a[52:55], v[152:155]
    ds_read_b128 a[72:75], v22 offset:18432
    v_mfma_f32_16x16x32_bf16 v[156:159], v[48:51], a[56:59], v[156:159]
    ds_read_b64_tr_b16 v[48:49], v17 offset:0
    ds_read_b64_tr_b16 v[50:51], v17 offset:1024
    v_mfma_f32_16x16x32_bf16 v[156:159], v[52:55], a[60:63], v[156:159]
    ds_read_b64_tr_b16 v[52:53], v17 offset:8192
    ds_read_b64_tr_b16 v[54:55], v17 offset:9216
    v_mfma_f32_16x16x32_bf16 v[160:163], v[56:59], a[0:3], v[160:163]
    v_mfma_f32_16x16x32_bf16 v[160:163], v[60:63], a[4:7], v[160:163]
    v_mfma_f32_16x16x32_bf16 v[164:167], v[56:59], a[8:11], v[164:167]
    ds_read_b128 a[76:79], v23 offset:18432
    v_mfma_f32_16x16x32_bf16 v[164:167], v[60:63], a[12:15], v[164:167]
    s_add_u32 m0, s69, 114688
    v_mfma_f32_16x16x32_bf16 v[168:171], v[56:59], a[16:19], v[168:171]
    s_xor_b32 s60, s60, 3670016
    buffer_load_dwordx4 v6, s[8:11], s62 offen lds
    v_mfma_f32_16x16x32_bf16 v[168:171], v[60:63], a[20:23], v[168:171]
    v_mfma_f32_16x16x32_bf16 v[172:175], v[56:59], a[24:27], v[172:175]
    v_mfma_f32_16x16x32_bf16 v[172:175], v[60:63], a[28:31], v[172:175]
    v_mfma_f32_16x16x32_bf16 v[176:179], v[56:59], a[32:35], v[176:179]
    ds_read_b128 a[80:83], v22 offset:20480
    v_mfma_f32_16x16x32_bf16 v[176:179], v[60:63], a[36:39], v[176:179]
    v_mfma_f32_16x16x32_bf16 v[180:183], v[56:59], a[40:43], v[180:183]
    v_mfma_f32_16x16x32_bf16 v[180:183], v[60:63], a[44:47], v[180:183]
    buffer_load_dwordx4 v7, s[8:11], s62 offen offset:1024 lds
    v_mfma_f32_16x16x32_bf16 v[184:187], v[56:59], a[48:51], v[184:187]
    v_mfma_f32_16x16x32_bf16 v[184:187], v[60:63], a[52:55], v[184:187]
    ds_read_b128 a[84:87], v23 offset:20480
    v_mfma_f32_16x16x32_bf16 v[188:191], v[56:59], a[56:59], v[188:191]
    s_waitcnt lgkmcnt(1)
    ds_read_b64_tr_b16 v[56:57], v14 offset:32768
    ds_read_b64_tr_b16 v[58:59], v14 offset:33792
    v_mfma_f32_16x16x32_bf16 v[188:191], v[60:63], a[60:63], v[188:191]
    ds_read_b64_tr_b16 v[60:61], v14 offset:40960
    ds_read_b64_tr_b16 v[62:63], v14 offset:41984
    v_mfma_f32_16x16x32_bf16 v[192:195], v[40:43], a[0:3], v[192:195]
    v_add_u32 v14, 0x10000, v14
    v_mfma_f32_16x16x32_bf16 v[192:195], v[44:47], a[4:7], v[192:195]
    v_mfma_f32_16x16x32_bf16 v[196:199], v[40:43], a[8:11], v[196:199]
    v_mfma_f32_16x16x32_bf16 v[196:199], v[44:47], a[12:15], v[196:199]
    buffer_load_dwordx4 v8, s[8:11], s62 offen offset:2048 lds
    v_mfma_f32_16x16x32_bf16 v[200:203], v[40:43], a[16:19], v[200:203]
    ds_read_b128 a[88:91], v22 offset:22528
    v_mfma_f32_16x16x32_bf16 v[200:203], v[44:47], a[20:23], v[200:203]
    v_mfma_f32_16x16x32_bf16 v[204:207], v[40:43], a[24:27], v[204:207]
    v_mfma_f32_16x16x32_bf16 v[204:207], v[44:47], a[28:31], v[204:207]
    v_mfma_f32_16x16x32_bf16 v[208:211], v[40:43], a[32:35], v[208:211]
    ds_read_b128 a[92:95], v23 offset:22528
    v_mfma_f32_16x16x32_bf16 v[208:211], v[44:47], a[36:39], v[208:211]
    v_mfma_f32_16x16x32_bf16 v[212:215], v[40:43], a[40:43], v[212:215]
    buffer_load_dwordx4 v9, s[8:11], s62 offen offset:3072 lds
    v_mfma_f32_16x16x32_bf16 v[212:215], v[44:47], a[44:47], v[212:215]
    v_mfma_f32_16x16x32_bf16 v[216:219], v[40:43], a[48:51], v[216:219]
    v_mfma_f32_16x16x32_bf16 v[216:219], v[44:47], a[52:55], v[216:219]
    v_mfma_f32_16x16x32_bf16 v[220:223], v[40:43], a[56:59], v[220:223]
    ds_read_b64_tr_b16 v[40:41], v15 offset:32768
    ds_read_b64_tr_b16 v[42:43], v15 offset:33792
    v_mfma_f32_16x16x32_bf16 v[220:223], v[44:47], a[60:63], v[220:223]
    ds_read_b64_tr_b16 v[44:45], v15 offset:40960
    ds_read_b64_tr_b16 v[46:47], v15 offset:41984
    v_mfma_f32_16x16x32_bf16 v[224:227], v[48:51], a[0:3], v[224:227]
    v_add_u32 v15, 0x10000, v15
    v_mfma_f32_16x16x32_bf16 v[224:227], v[52:55], a[4:7], v[224:227]
    s_xor_b32 s62, s62, 128
    v_mfma_f32_16x16x32_bf16 v[228:231], v[48:51], a[8:11], v[228:231]
    buffer_load_dword v106, v103, s[24:27], s77 offen
    v_mfma_f32_16x16x32_bf16 v[228:231], v[52:55], a[12:15], v[228:231]
    s_add_u32 s77, s77, 4608
    v_mfma_f32_16x16x32_bf16 v[232:235], v[48:51], a[16:19], v[232:235]
    v_mfma_f32_16x16x32_bf16 v[232:235], v[52:55], a[20:23], v[232:235]
    s_add_u32 m0, s69, 131072
    v_mfma_f32_16x16x32_bf16 v[236:239], v[48:51], a[24:27], v[236:239]
    buffer_load_dwordx4 v2, s[12:15], s60 offen nt lds
    v_mfma_f32_16x16x32_bf16 v[236:239], v[52:55], a[28:31], v[236:239]
    v_mfma_f32_16x16x32_bf16 v[240:243], v[48:51], a[32:35], v[240:243]
    v_mfma_f32_16x16x32_bf16 v[240:243], v[52:55], a[36:39], v[240:243]
    v_mfma_f32_16x16x32_bf16 v[244:247], v[48:51], a[40:43], v[244:247]
    v_mfma_f32_16x16x32_bf16 v[244:247], v[52:55], a[44:47], v[244:247]
    v_mfma_f32_16x16x32_bf16 v[248:251], v[48:51], a[48:51], v[248:251]
    v_mfma_f32_16x16x32_bf16 v[248:251], v[52:55], a[52:55], v[248:251]
    buffer_load_dwordx4 v3, s[12:15], s60 offen offset:1024 nt lds
    v_mfma_f32_16x16x32_bf16 v[252:255], v[48:51], a[56:59], v[252:255]
    ds_read_b64_tr_b16 v[48:49], v16 offset:32768
    ds_read_b64_tr_b16 v[50:51], v16 offset:33792
    v_mfma_f32_16x16x32_bf16 v[252:255], v[52:55], a[60:63], v[252:255]
    s_waitcnt lgkmcnt(2)
    ds_read_b64_tr_b16 v[52:53], v16 offset:40960
    ds_read_b64_tr_b16 v[54:55], v16 offset:41984
    v_mfma_f32_16x16x32_bf16 a[128:131], a[0:3], v[56:59], a[128:131]
    v_add_u32 v16, 0x10000, v16
    v_mfma_f32_16x16x32_bf16 a[128:131], a[4:7], v[60:63], a[128:131]
    v_mfma_f32_16x16x32_bf16 a[132:135], a[8:11], v[56:59], a[132:135]
    ds_read_b128 a[96:99], v22 offset:49152
    v_mfma_f32_16x16x32_bf16 a[132:135], a[12:15], v[60:63], a[132:135]
    v_mfma_f32_16x16x32_bf16 a[136:139], a[16:19], v[56:59], a[136:139]
    v_mfma_f32_16x16x32_bf16 a[136:139], a[20:23], v[60:63], a[136:139]
    buffer_load_dwordx4 v4, s[12:15], s60 offen offset:2048 nt lds
    v_mfma_f32_16x16x32_bf16 a[140:143], a[24:27], v[56:59], a[140:143]
    v_mfma_f32_16x16x32_bf16 a[140:143], a[28:31], v[60:63], a[140:143]
    ds_read_b128 a[100:103], v23 offset:49152
    v_mfma_f32_16x16x32_bf16 a[144:147], a[32:35], v[56:59], a[144:147]
    v_mfma_f32_16x16x32_bf16 a[144:147], a[36:39], v[60:63], a[144:147]
    v_mfma_f32_16x16x32_bf16 a[148:151], a[40:43], v[56:59], a[148:151]
    v_mfma_f32_16x16x32_bf16 a[148:151], a[44:47], v[60:63], a[148:151]
    v_mfma_f32_16x16x32_bf16 a[152:155], a[48:51], v[56:59], a[152:155]
    buffer_load_dwordx4 v5, s[12:15], s60 offen offset:3072 nt lds
    v_mfma_f32_16x16x32_bf16 a[152:155], a[52:55], v[60:63], a[152:155]
    ds_read_b128 a[104:107], v22 offset:51200
    v_mfma_f32_16x16x32_bf16 a[156:159], a[56:59], v[56:59], a[156:159]
    ds_read_b64_tr_b16 v[56:57], v17 offset:32768
    ds_read_b64_tr_b16 v[58:59], v17 offset:33792
    v_mfma_f32_16x16x32_bf16 a[156:159], a[60:63], v[60:63], a[156:159]
    ds_read_b64_tr_b16 v[60:61], v17 offset:40960
    ds_read_b64_tr_b16 v[62:63], v17 offset:41984
    v_mfma_f32_16x16x32_bf16 a[160:163], a[0:3], v[40:43], a[160:163]
    v_add_u32 v17, 0x10000, v17
    v_mfma_f32_16x16x32_bf16 a[160:163], a[4:7], v[44:47], a[160:163]
    v_mfma_f32_16x16x32_bf16 a[164:167], a[8:11], v[40:43], a[164:167]
    ds_read_b128 a[108:111], v23 offset:51200
    v_mfma_f32_16x16x32_bf16 a[164:167], a[12:15], v[44:47], a[164:167]
    s_add_u32 m0, s69, 147456
    v_mfma_f32_16x16x32_bf16 a[168:171], a[16:19], v[40:43], a[168:171]
    buffer_load_dwordx4 v6, s[8:11], s61 offen lds
    v_mfma_f32_16x16x32_bf16 a[168:171], a[20:23], v[44:47], a[168:171]
    v_mfma_f32_16x16x32_bf16 a[172:175], a[24:27], v[40:43], a[172:175]
    v_mfma_f32_16x16x32_bf16 a[172:175], a[28:31], v[44:47], a[172:175]
    v_mfma_f32_16x16x32_bf16 a[176:179], a[32:35], v[40:43], a[176:179]
    ds_read_b128 a[112:115], v22 offset:53248
    v_mfma_f32_16x16x32_bf16 a[176:179], a[36:39], v[44:47], a[176:179]
    v_mfma_f32_16x16x32_bf16 a[180:183], a[40:43], v[40:43], a[180:183]
    v_mfma_f32_16x16x32_bf16 a[180:183], a[44:47], v[44:47], a[180:183]
    buffer_load_dwordx4 v7, s[8:11], s61 offen offset:1024 lds
    v_mfma_f32_16x16x32_bf16 a[184:187], a[48:51], v[40:43], a[184:187]
    v_mfma_f32_16x16x32_bf16 a[184:187], a[52:55], v[44:47], a[184:187]
    ds_read_b128 a[116:119], v23 offset:53248
    v_mfma_f32_16x16x32_bf16 a[188:191], a[56:59], v[40:43], a[188:191]
    v_mfma_f32_16x16x32_bf16 a[188:191], a[60:63], v[44:47], a[188:191]
    s_waitcnt lgkmcnt(1)
    v_mfma_f32_16x16x32_bf16 a[192:195], a[0:3], v[48:51], a[192:195]
    v_mfma_f32_16x16x32_bf16 a[192:195], a[4:7], v[52:55], a[192:195]
    v_mfma_f32_16x16x32_bf16 a[196:199], a[8:11], v[48:51], a[196:199]
    v_mfma_f32_16x16x32_bf16 a[196:199], a[12:15], v[52:55], a[196:199]
    buffer_load_dwordx4 v8, s[8:11], s61 offen offset:2048 lds
    v_mfma_f32_16x16x32_bf16 a[200:203], a[16:19], v[48:51], a[200:203]
    ds_read_b128 a[120:123], v22 offset:55296
    v_mfma_f32_16x16x32_bf16 a[200:203], a[20:23], v[52:55], a[200:203]
    v_mfma_f32_16x16x32_bf16 a[204:207], a[24:27], v[48:51], a[204:207]
    v_mfma_f32_16x16x32_bf16 a[204:207], a[28:31], v[52:55], a[204:207]
    v_mfma_f32_16x16x32_bf16 a[208:211], a[32:35], v[48:51], a[208:211]
    ds_read_b128 a[124:127], v23 offset:55296
    v_mfma_f32_16x16x32_bf16 a[208:211], a[36:39], v[52:55], a[208:211]
    v_mfma_f32_16x16x32_bf16 a[212:215], a[40:43], v[48:51], a[212:215]
    buffer_load_dwordx4 v9, s[8:11], s61 offen offset:3072 lds
    v_mfma_f32_16x16x32_bf16 a[212:215], a[44:47], v[52:55], a[212:215]
    v_mfma_f32_16x16x32_bf16 a[216:219], a[48:51], v[48:51], a[216:219]
    v_mfma_f32_16x16x32_bf16 a[216:219], a[52:55], v[52:55], a[216:219]
    v_mfma_f32_16x16x32_bf16 a[220:223], a[56:59], v[48:51], a[220:223]
    v_mfma_f32_16x16x32_bf16 a[220:223], a[60:63], v[52:55], a[220:223]
    v_mfma_f32_16x16x32_bf16 a[224:227], a[0:3], v[56:59], a[224:227]
    v_mfma_f32_16x16x32_bf16 a[224:227], a[4:7], v[60:63], a[224:227]
    s_xor_b32 s61, s61, 384
    v_mfma_f32_16x16x32_bf16 a[228:231], a[8:11], v[56:59], a[228:231]
    v_mfma_f32_16x16x32_bf16 a[228:231], a[12:15], v[60:63], a[228:231]
    v_mfma_f32_16x16x32_bf16 a[232:235], a[16:19], v[56:59], a[232:235]
    v_mfma_f32_16x16x32_bf16 a[232:235], a[20:23], v[60:63], a[232:235]
    s_waitcnt vmcnt(9) lgkmcnt(0)
    s_barrier
    ds_read_b64_tr_b16 v[40:41], v14 offset:0
    v_mfma_f32_16x16x32_bf16 a[236:239], a[24:27], v[56:59], a[236:239]
    s_add_u32 m0, s69, 0
    ds_read_b64_tr_b16 v[42:43], v14 offset:1024
    ds_read_b64_tr_b16 v[44:45], v14 offset:8192
    v_mfma_f32_16x16x32_bf16 a[236:239], a[28:31], v[60:63], a[236:239]
    buffer_load_dwordx4 v2, s[16:19], s60 offen nt lds
    v_mfma_f32_16x16x32_bf16 a[240:243], a[32:35], v[56:59], a[240:243]
    ds_read_b64_tr_b16 v[46:47], v14 offset:9216
    v_cndmask_b32_e64 v83, v83, 0, s[92:93]
    v_mfma_f32_16x16x32_bf16 a[240:243], a[36:39], v[60:63], a[240:243]
    v_cndmask_b32_e64 v81, v81, 0, vcc
    v_cndmask_b32 v82, v82, v92, s[92:93]
    v_mfma_f32_16x16x32_bf16 a[244:247], a[40:43], v[56:59], a[244:247]
    s_mov_b32 vcc_lo, 0x10101010
    s_mov_b32 vcc_hi, 0x10101010
    v_cndmask_b32_e64 v83, v83, 0, vcc
    v_mfma_f32_16x16x32_bf16 a[244:247], a[44:47], v[60:63], a[244:247]
    v_xor_b32 v92, s98, v95
    ds_read_b64_tr_b16 v[48:49], v15 offset:0
    v_mfma_f32_16x16x32_bf16 a[248:251], a[48:51], v[56:59], a[248:251]
    buffer_store_dwordx4 v[80:83], v92, s[28:31], s72 offen sc1
    v_mfma_f32_16x16x32_bf16 a[248:251], a[52:55], v[60:63], a[248:251]
    s_mul_i32 s72, s2, 3
    buffer_load_dwordx4 v3, s[16:19], s60 offen offset:1024 nt lds
    v_mfma_f32_16x16x32_bf16 a[252:255], a[56:59], v[56:59], a[252:255]
    s_add_u32 s72, s72, 1
    ds_read_b64_tr_b16 v[50:51], v15 offset:1024
    ds_read_b64_tr_b16 v[52:53], v15 offset:8192
    v_mfma_f32_16x16x32_bf16 a[252:255], a[60:63], v[60:63], a[252:255]
    s_bfe_u32 s98, s72, 0x10001
    ds_read_b64_tr_b16 v[54:55], v15 offset:9216
    v_cndmask_b32_e64 v87, v87, 0, s[92:93]
    s_waitcnt lgkmcnt(4)
    v_mfma_f32_16x16x32_bf16 v[128:131], v[40:43], a[64:67], v[128:131]
    s_bfe_u32 s99, s72, 0x10003
    v_cndmask_b32 v86, v86, v93, s[92:93]
    v_cndmask_b32_e64 v91, v91, 0, s[92:93]
    v_mfma_f32_16x16x32_bf16 v[128:131], v[44:47], a[68:71], v[128:131]
    s_lshl1_add_u32 s98, s99, s98
    v_add_u32 v22, 0x10000, v22
    v_cndmask_b32 v90, v90, v94, s[92:93]
    v_mfma_f32_16x16x32_bf16 v[132:135], v[40:43], a[72:75], v[132:135]
    s_lshl_b32 s98, s98, 5
    ds_read_b128 a[0:3], v22 offset:16384
    v_xor_b32 v93, s98, v95
    v_mfma_f32_16x16x32_bf16 v[132:135], v[44:47], a[76:79], v[132:135]
    s_mov_b32 vcc_lo, 0x84848484
    s_mov_b32 vcc_hi, 0x84848484
    v_cndmask_b32_e64 v85, v85, 0, vcc
    v_mfma_f32_16x16x32_bf16 v[136:139], v[40:43], a[80:83], v[136:139]
    s_mov_b32 vcc_lo, 0x10101010
    s_mov_b32 vcc_hi, 0x10101010
    v_cndmask_b32_e64 v87, v87, 0, vcc
    v_mfma_f32_16x16x32_bf16 v[136:139], v[44:47], a[84:87], v[136:139]
    s_lshl_b32 s72, s72, 7
    buffer_load_dwordx4 v4, s[16:19], s60 offen offset:2048 nt lds
    v_mfma_f32_16x16x32_bf16 v[140:143], v[40:43], a[88:91], v[140:143]
    v_add_u32 v23, 0x10000, v23
    ds_read_b64_tr_b16 v[56:57], v16 offset:0
    v_mfma_f32_16x16x32_bf16 v[140:143], v[44:47], a[92:95], v[140:143]
    ds_read_b128 a[4:7], v23 offset:16384
    ds_read_b64_tr_b16 v[58:59], v16 offset:1024
    v_mfma_f32_16x16x32_bf16 v[144:147], v[40:43], a[96:99], v[144:147]
    s_cmp_lt_u32 s2, 192
    s_cselect_b32 s72, s72, 1073741824
    ds_read_b64_tr_b16 v[60:61], v16 offset:8192
    v_mfma_f32_16x16x32_bf16 v[144:147], v[44:47], a[100:103], v[144:147]
    buffer_store_dwordx4 v[84:87], v93, s[28:31], s72 offen sc1
    v_mfma_f32_16x16x32_bf16 v[148:151], v[40:43], a[104:107], v[148:151]
    s_mul_i32 s72, s2, 3
    ds_read_b64_tr_b16 v[62:63], v16 offset:9216
    v_mfma_f32_16x16x32_bf16 v[148:151], v[44:47], a[108:111], v[148:151]
    s_add_u32 s72, s72, 2
    v_mfma_f32_16x16x32_bf16 v[152:155], v[40:43], a[112:115], v[152:155]
    s_bfe_u32 s98, s72, 0x10001
    buffer_load_dwordx4 v5, s[16:19], s60 offen offset:3072 nt lds
    v_mfma_f32_16x16x32_bf16 v[152:155], v[44:47], a[116:119], v[152:155]
    s_bfe_u32 s99, s72, 0x10003
    ds_read_b128 a[8:11], v22 offset:18432
    v_mfma_f32_16x16x32_bf16 v[156:159], v[40:43], a[120:123], v[156:159]
    s_mov_b32 vcc_lo, 0x84848484
    s_mov_b32 vcc_hi, 0x84848484
    v_cndmask_b32_e64 v89, v89, 0, vcc
    v_mfma_f32_16x16x32_bf16 v[156:159], v[44:47], a[124:127], v[156:159]
    s_lshl1_add_u32 s98, s99, s98
    ds_read_b64_tr_b16 v[40:41], v17 offset:0
    ds_read_b64_tr_b16 v[42:43], v17 offset:1024
    s_waitcnt lgkmcnt(3)
    v_mfma_f32_16x16x32_bf16 v[160:163], v[48:51], a[64:67], v[160:163]
    s_mov_b32 vcc_lo, 0x10101010
    s_mov_b32 vcc_hi, 0x10101010
    v_cndmask_b32_e64 v91, v91, 0, vcc
    v_mfma_f32_16x16x32_bf16 v[160:163], v[52:55], a[68:71], v[160:163]
    s_lshl_b32 s98, s98, 5
    v_xor_b32 v94, s98, v95
    ds_read_b64_tr_b16 v[44:45], v17 offset:8192
    v_mfma_f32_16x16x32_bf16 v[164:167], v[48:51], a[72:75], v[164:167]
    s_lshl_b32 s72, s72, 7
    ds_read_b128 a[12:15], v23 offset:18432
    ds_read_b64_tr_b16 v[46:47], v17 offset:9216
    v_mfma_f32_16x16x32_bf16 v[164:167], v[52:55], a[76:79], v[164:167]
    s_add_u32 m0, s69, 16384
    v_mfma_f32_16x16x32_bf16 v[168:171], v[48:51], a[80:83], v[168:171]
    s_xor_b32 s60, s60, 524288
    buffer_load_dwordx4 v6, s[8:11], s62 offen lds
    v_mfma_f32_16x16x32_bf16 v[168:171], v[52:55], a[84:87], v[168:171]
    s_cmp_lt_u32 s2, 192
    s_cselect_b32 s72, s72, 1073741824
    v_mfma_f32_16x16x32_bf16 v[172:175], v[48:51], a[88:91], v[172:175]
    s_bfe_u32 s98, s5, 0x20001
    buffer_store_dwordx4 v[88:91], v94, s[28:31], s72 offen sc1
    v_mfma_f32_16x16x32_bf16 v[172:175], v[52:55], a[92:95], v[172:175]
    s_add_u32 s28, s28, s7
    s_addc_u32 s29, s29, 0
    v_mfma_f32_16x16x32_bf16 v[176:179], v[48:51], a[96:99], v[176:179]
    s_mov_b32 s30, 73728
    ds_read_b128 a[16:19], v22 offset:20480
    v_mfma_f32_16x16x32_bf16 v[176:179], v[52:55], a[100:103], v[176:179]
    s_and_b32 s7, s5, 24
    v_mfma_f32_16x16x32_bf16 v[180:183], v[48:51], a[104:107], v[180:183]
    s_add_u32 s7, s7, s6
    v_mfma_f32_16x16x32_bf16 v[180:183], v[52:55], a[108:111], v[180:183]
    s_lshl2_add_u32 s7, s7, s98
    buffer_load_dwordx4 v7, s[8:11], s62 offen offset:1024 lds
    v_mfma_f32_16x16x32_bf16 v[184:187], v[48:51], a[112:115], v[184:187]
    s_mul_i32 s98, s7, 36864
    v_add_u32 v36, s98, v36
    v_sub_u32 v39, v36, v39
    v_mfma_f32_16x16x32_bf16 v[184:187], v[52:55], a[116:119], v[184:187]
    s_lshl2_add_u32 s99, s100, s4
    ds_read_b128 a[20:23], v23 offset:20480
    v_lshl_add_u32 v36, s100, 6, v36
    v_mfma_f32_16x16x32_bf16 v[188:191], v[48:51], a[120:123], v[188:191]
    s_lshl_b32 s99, s99, 7
    ds_read_b64_tr_b16 v[48:49], v14 offset:32768
    ds_read_b64_tr_b16 v[50:51], v14 offset:33792
    v_mfma_f32_16x16x32_bf16 v[188:191], v[52:55], a[124:127], v[188:191]
    ds_read_b64_tr_b16 v[52:53], v14 offset:40960
    ds_read_b64_tr_b16 v[54:55], v14 offset:41984
    v_mfma_f32_16x16x32_bf16 v[192:195], v[56:59], a[64:67], v[192:195]
    v_add_u32 v14, 0x10000, v14
    v_mfma_f32_16x16x32_bf16 v[192:195], v[60:63], a[68:71], v[192:195]
    v_mfma_f32_16x16x32_bf16 v[196:199], v[56:59], a[72:75], v[196:199]
    v_mfma_f32_16x16x32_bf16 v[196:199], v[60:63], a[76:79], v[196:199]
    buffer_load_dwordx4 v8, s[8:11], s62 offen offset:2048 lds
    v_mfma_f32_16x16x32_bf16 v[200:203], v[56:59], a[80:83], v[200:203]
    ds_read_b128 a[24:27], v22 offset:22528
    v_mfma_f32_16x16x32_bf16 v[200:203], v[60:63], a[84:87], v[200:203]
    v_mfma_f32_16x16x32_bf16 v[204:207], v[56:59], a[88:91], v[204:207]
    v_mfma_f32_16x16x32_bf16 v[204:207], v[60:63], a[92:95], v[204:207]
    v_mfma_f32_16x16x32_bf16 v[208:211], v[56:59], a[96:99], v[208:211]
    ds_read_b128 a[28:31], v23 offset:22528
    v_mfma_f32_16x16x32_bf16 v[208:211], v[60:63], a[100:103], v[208:211]
    v_mfma_f32_16x16x32_bf16 v[212:215], v[56:59], a[104:107], v[212:215]
    buffer_load_dwordx4 v9, s[8:11], s62 offen offset:3072 lds
    v_mfma_f32_16x16x32_bf16 v[212:215], v[60:63], a[108:111], v[212:215]
    v_mfma_f32_16x16x32_bf16 v[216:219], v[56:59], a[112:115], v[216:219]
    v_mfma_f32_16x16x32_bf16 v[216:219], v[60:63], a[116:119], v[216:219]
    v_mfma_f32_16x16x32_bf16 v[220:223], v[56:59], a[120:123], v[220:223]
    s_waitcnt lgkmcnt(0)
    ds_read_b64_tr_b16 v[56:57], v15 offset:32768
    ds_read_b64_tr_b16 v[58:59], v15 offset:33792
    v_mfma_f32_16x16x32_bf16 v[220:223], v[60:63], a[124:127], v[220:223]
    ds_read_b64_tr_b16 v[60:61], v15 offset:40960
    ds_read_b64_tr_b16 v[62:63], v15 offset:41984
    v_mfma_f32_16x16x32_bf16 v[224:227], v[40:43], a[64:67], v[224:227]
    v_add_u32 v15, 0x10000, v15
    v_mfma_f32_16x16x32_bf16 v[224:227], v[44:47], a[68:71], v[224:227]
    s_xor_b32 s62, s62, 384
    v_mfma_f32_16x16x32_bf16 v[228:231], v[40:43], a[72:75], v[228:231]
    buffer_load_dword v107, v103, s[24:27], s77 offen
    v_mfma_f32_16x16x32_bf16 v[228:231], v[44:47], a[76:79], v[228:231]
    s_add_u32 s77, s77, 4608
    v_mfma_f32_16x16x32_bf16 v[232:235], v[40:43], a[80:83], v[232:235]
    v_mfma_f32_16x16x32_bf16 v[232:235], v[44:47], a[84:87], v[232:235]
    s_add_u32 m0, s69, 32768
    v_mfma_f32_16x16x32_bf16 v[236:239], v[40:43], a[88:91], v[236:239]
    buffer_load_dwordx4 v2, s[12:15], s60 offen nt lds
    v_mfma_f32_16x16x32_bf16 v[236:239], v[44:47], a[92:95], v[236:239]
    v_mfma_f32_16x16x32_bf16 v[240:243], v[40:43], a[96:99], v[240:243]
    v_mfma_f32_16x16x32_bf16 v[240:243], v[44:47], a[100:103], v[240:243]
    v_mfma_f32_16x16x32_bf16 v[244:247], v[40:43], a[104:107], v[244:247]
    v_mfma_f32_16x16x32_bf16 v[244:247], v[44:47], a[108:111], v[244:247]
    v_mfma_f32_16x16x32_bf16 v[248:251], v[40:43], a[112:115], v[248:251]
    v_mfma_f32_16x16x32_bf16 v[248:251], v[44:47], a[116:119], v[248:251]
    buffer_load_dwordx4 v3, s[12:15], s60 offen offset:1024 nt lds
    v_mfma_f32_16x16x32_bf16 v[252:255], v[40:43], a[120:123], v[252:255]
    ds_read_b64_tr_b16 v[40:41], v16 offset:32768
    ds_read_b64_tr_b16 v[42:43], v16 offset:33792
    v_mfma_f32_16x16x32_bf16 v[252:255], v[44:47], a[124:127], v[252:255]
    ds_read_b64_tr_b16 v[44:45], v16 offset:40960
    ds_read_b64_tr_b16 v[46:47], v16 offset:41984
    v_mfma_f32_16x16x32_bf16 a[128:131], a[64:67], v[48:51], a[128:131]
    v_add_u32 v16, 0x10000, v16
    v_mfma_f32_16x16x32_bf16 a[128:131], a[68:71], v[52:55], a[128:131]
    v_mfma_f32_16x16x32_bf16 a[132:135], a[72:75], v[48:51], a[132:135]
    ds_read_b128 a[32:35], v22 offset:49152
    v_mfma_f32_16x16x32_bf16 a[132:135], a[76:79], v[52:55], a[132:135]
    v_mfma_f32_16x16x32_bf16 a[136:139], a[80:83], v[48:51], a[136:139]
    v_mfma_f32_16x16x32_bf16 a[136:139], a[84:87], v[52:55], a[136:139]
    buffer_load_dwordx4 v4, s[12:15], s60 offen offset:2048 nt lds
    v_mfma_f32_16x16x32_bf16 a[140:143], a[88:91], v[48:51], a[140:143]
    v_mfma_f32_16x16x32_bf16 a[140:143], a[92:95], v[52:55], a[140:143]
    ds_read_b128 a[36:39], v23 offset:49152
    v_mfma_f32_16x16x32_bf16 a[144:147], a[96:99], v[48:51], a[144:147]
    v_mfma_f32_16x16x32_bf16 a[144:147], a[100:103], v[52:55], a[144:147]
    v_mfma_f32_16x16x32_bf16 a[148:151], a[104:107], v[48:51], a[148:151]
    v_mfma_f32_16x16x32_bf16 a[148:151], a[108:111], v[52:55], a[148:151]
    v_mfma_f32_16x16x32_bf16 a[152:155], a[112:115], v[48:51], a[152:155]
    buffer_load_dwordx4 v5, s[12:15], s60 offen offset:3072 nt lds
    v_mfma_f32_16x16x32_bf16 a[152:155], a[116:119], v[52:55], a[152:155]
    ds_read_b128 a[40:43], v22 offset:51200
    v_mfma_f32_16x16x32_bf16 a[156:159], a[120:123], v[48:51], a[156:159]
    ds_read_b64_tr_b16 v[48:49], v17 offset:32768
    ds_read_b64_tr_b16 v[50:51], v17 offset:33792
    v_mfma_f32_16x16x32_bf16 a[156:159], a[124:127], v[52:55], a[156:159]
    s_waitcnt lgkmcnt(3)
    ds_read_b64_tr_b16 v[52:53], v17 offset:40960
    ds_read_b64_tr_b16 v[54:55], v17 offset:41984
    v_mfma_f32_16x16x32_bf16 a[160:163], a[64:67], v[56:59], a[160:163]
    v_add_u32 v17, 0x10000, v17
    v_mfma_f32_16x16x32_bf16 a[160:163], a[68:71], v[60:63], a[160:163]
    v_mfma_f32_16x16x32_bf16 a[164:167], a[72:75], v[56:59], a[164:167]
    ds_read_b128 a[44:47], v23 offset:51200
    v_mfma_f32_16x16x32_bf16 a[164:167], a[76:79], v[60:63], a[164:167]
    s_add_u32 m0, s69, 49152
    v_mfma_f32_16x16x32_bf16 a[168:171], a[80:83], v[56:59], a[168:171]
    buffer_load_dwordx4 v6, s[8:11], s61 offen lds
    v_mfma_f32_16x16x32_bf16 a[168:171], a[84:87], v[60:63], a[168:171]
    v_mfma_f32_16x16x32_bf16 a[172:175], a[88:91], v[56:59], a[172:175]
    v_mfma_f32_16x16x32_bf16 a[172:175], a[92:95], v[60:63], a[172:175]
    v_mfma_f32_16x16x32_bf16 a[176:179], a[96:99], v[56:59], a[176:179]
    ds_read_b128 a[48:51], v22 offset:53248
    v_mfma_f32_16x16x32_bf16 a[176:179], a[100:103], v[60:63], a[176:179]
    v_mfma_f32_16x16x32_bf16 a[180:183], a[104:107], v[56:59], a[180:183]
    v_mfma_f32_16x16x32_bf16 a[180:183], a[108:111], v[60:63], a[180:183]
    buffer_load_dwordx4 v7, s[8:11], s61 offen offset:1024 lds
    v_mfma_f32_16x16x32_bf16 a[184:187], a[112:115], v[56:59], a[184:187]
    v_mfma_f32_16x16x32_bf16 a[184:187], a[116:119], v[60:63], a[184:187]
    ds_read_b128 a[52:55], v23 offset:53248
    v_mfma_f32_16x16x32_bf16 a[188:191], a[120:123], v[56:59], a[188:191]
    v_mfma_f32_16x16x32_bf16 a[188:191], a[124:127], v[60:63], a[188:191]
    v_mfma_f32_16x16x32_bf16 a[192:195], a[64:67], v[40:43], a[192:195]
    v_mfma_f32_16x16x32_bf16 a[192:195], a[68:71], v[44:47], a[192:195]
    v_mfma_f32_16x16x32_bf16 a[196:199], a[72:75], v[40:43], a[196:199]
    v_mfma_f32_16x16x32_bf16 a[196:199], a[76:79], v[44:47], a[196:199]
    buffer_load_dwordx4 v8, s[8:11], s61 offen offset:2048 lds
    v_mfma_f32_16x16x32_bf16 a[200:203], a[80:83], v[40:43], a[200:203]
    ds_read_b128 a[56:59], v22 offset:55296
    v_mfma_f32_16x16x32_bf16 a[200:203], a[84:87], v[44:47], a[200:203]
    v_mfma_f32_16x16x32_bf16 a[204:207], a[88:91], v[40:43], a[204:207]
    v_mfma_f32_16x16x32_bf16 a[204:207], a[92:95], v[44:47], a[204:207]
    v_mfma_f32_16x16x32_bf16 a[208:211], a[96:99], v[40:43], a[208:211]
    ds_read_b128 a[60:63], v23 offset:55296
    v_mfma_f32_16x16x32_bf16 a[208:211], a[100:103], v[44:47], a[208:211]
    v_mfma_f32_16x16x32_bf16 a[212:215], a[104:107], v[40:43], a[212:215]
    buffer_load_dwordx4 v9, s[8:11], s61 offen offset:3072 lds
    v_mfma_f32_16x16x32_bf16 a[212:215], a[108:111], v[44:47], a[212:215]
    v_mfma_f32_16x16x32_bf16 a[216:219], a[112:115], v[40:43], a[216:219]
    v_mfma_f32_16x16x32_bf16 a[216:219], a[116:119], v[44:47], a[216:219]
    v_mfma_f32_16x16x32_bf16 a[220:223], a[120:123], v[40:43], a[220:223]
    v_mfma_f32_16x16x32_bf16 a[220:223], a[124:127], v[44:47], a[220:223]
    s_waitcnt lgkmcnt(0)
    v_mfma_f32_16x16x32_bf16 a[224:227], a[64:67], v[48:51], a[224:227]
    v_mfma_f32_16x16x32_bf16 a[224:227], a[68:71], v[52:55], a[224:227]
    s_xor_b32 s61, s61, 128
    v_mfma_f32_16x16x32_bf16 a[228:231], a[72:75], v[48:51], a[228:231]
    v_mfma_f32_16x16x32_bf16 a[228:231], a[76:79], v[52:55], a[228:231]
    v_mfma_f32_16x16x32_bf16 a[232:235], a[80:83], v[48:51], a[232:235]
    v_mfma_f32_16x16x32_bf16 a[232:235], a[84:87], v[52:55], a[232:235]
    s_waitcnt vmcnt(9) lgkmcnt(0)
    s_barrier
    ds_read_b64_tr_b16 v[56:57], v14 offset:0
    v_mfma_f32_16x16x32_bf16 a[236:239], a[88:91], v[48:51], a[236:239]
    s_add_u32 m0, s69, 65536
    ds_read_b64_tr_b16 v[58:59], v14 offset:1024
    ds_read_b64_tr_b16 v[60:61], v14 offset:8192
    v_mfma_f32_16x16x32_bf16 a[236:239], a[92:95], v[52:55], a[236:239]
    buffer_load_dwordx4 v2, s[16:19], s60 offen nt lds
    v_mfma_f32_16x16x32_bf16 a[240:243], a[96:99], v[48:51], a[240:243]
    ds_read_b64_tr_b16 v[62:63], v14 offset:9216
    ds_read_b64_tr_b16 v[40:41], v15 offset:0
    v_mfma_f32_16x16x32_bf16 a[240:243], a[100:103], v[52:55], a[240:243]
    buffer_atomic_add v31, v30, s[44:47], s95 offen sc1
    v_mfma_f32_16x16x32_bf16 a[244:247], a[104:107], v[48:51], a[244:247]
    s_mov_b32 s95, 32768
    ds_read_b64_tr_b16 v[42:43], v15 offset:1024
    ds_read_b64_tr_b16 v[44:45], v15 offset:8192
    v_mfma_f32_16x16x32_bf16 a[244:247], a[108:111], v[52:55], a[244:247]
    ds_read_b64_tr_b16 v[46:47], v15 offset:9216
    v_add_u32 v14, 0xfffe0000, v14
    v_mfma_f32_16x16x32_bf16 a[248:251], a[112:115], v[48:51], a[248:251]
    v_add_u32 v15, 0xfffe0000, v15
    v_mfma_f32_16x16x32_bf16 a[248:251], a[116:119], v[52:55], a[248:251]
    buffer_load_dwordx4 v3, s[16:19], s60 offen offset:1024 nt lds
    v_mfma_f32_16x16x32_bf16 a[252:255], a[120:123], v[48:51], a[252:255]
    ds_read_b64_tr_b16 v[48:49], v16 offset:0
    ds_read_b64_tr_b16 v[50:51], v16 offset:1024
    v_mfma_f32_16x16x32_bf16 a[252:255], a[124:127], v[52:55], a[252:255]
    s_waitcnt lgkmcnt(3)
    ds_read_b64_tr_b16 v[52:53], v16 offset:8192
    ds_read_b64_tr_b16 v[54:55], v16 offset:9216
    v_mfma_f32_16x16x32_bf16 v[128:131], v[56:59], a[0:3], v[128:131]
    v_add_u32 v16, 0xfffe0000, v16
    v_mfma_f32_16x16x32_bf16 v[128:131], v[60:63], a[4:7], v[128:131]
    v_add_u32 v22, 0x10000, v22
    v_mfma_f32_16x16x32_bf16 v[132:135], v[56:59], a[8:11], v[132:135]
    ds_read_b128 a[64:67], v22 offset:16384
    v_mfma_f32_16x16x32_bf16 v[132:135], v[60:63], a[12:15], v[132:135]
    v_mfma_f32_16x16x32_bf16 v[136:139], v[56:59], a[16:19], v[136:139]
    v_mfma_f32_16x16x32_bf16 v[136:139], v[60:63], a[20:23], v[136:139]
    buffer_load_dwordx4 v4, s[16:19], s60 offen offset:2048 nt lds
    v_mfma_f32_16x16x32_bf16 v[140:143], v[56:59], a[24:27], v[140:143]
    v_add_u32 v23, 0x10000, v23
    v_mfma_f32_16x16x32_bf16 v[140:143], v[60:63], a[28:31], v[140:143]
    ds_read_b128 a[68:71], v23 offset:16384
    v_mfma_f32_16x16x32_bf16 v[144:147], v[56:59], a[32:35], v[144:147]
    v_mfma_f32_16x16x32_bf16 v[144:147], v[60:63], a[36:39], v[144:147]
    v_mfma_f32_16x16x32_bf16 v[148:151], v[56:59], a[40:43], v[148:151]
    v_mfma_f32_16x16x32_bf16 v[148:151], v[60:63], a[44:47], v[148:151]
    v_mfma_f32_16x16x32_bf16 v[152:155], v[56:59], a[48:51], v[152:155]
    buffer_load_dwordx4 v5, s[16:19], s60 offen offset:3072 nt lds
    v_mfma_f32_16x16x32_bf16 v[152:155], v[60:63], a[52:55], v[152:155]
    ds_read_b128 a[72:75], v22 offset:18432
    v_mfma_f32_16x16x32_bf16 v[156:159], v[56:59], a[56:59], v[156:159]
    ds_read_b64_tr_b16 v[56:57], v17 offset:0
    ds_read_b64_tr_b16 v[58:59], v17 offset:1024
    v_mfma_f32_16x16x32_bf16 v[156:159], v[60:63], a[60:63], v[156:159]
    ds_read_b64_tr_b16 v[60:61], v17 offset:8192
    ds_read_b64_tr_b16 v[62:63], v17 offset:9216
    v_mfma_f32_16x16x32_bf16 v[160:163], v[40:43], a[0:3], v[160:163]
    s_waitcnt lgkmcnt(5)
    v_add_u32 v17, 0xfffe0000, v17
    v_mfma_f32_16x16x32_bf16 v[160:163], v[44:47], a[4:7], v[160:163]
    v_mfma_f32_16x16x32_bf16 v[164:167], v[40:43], a[8:11], v[164:167]
    ds_read_b128 a[76:79], v23 offset:18432
    v_mfma_f32_16x16x32_bf16 v[164:167], v[44:47], a[12:15], v[164:167]
    s_add_u32 m0, s69, 81920
    v_mfma_f32_16x16x32_bf16 v[168:171], v[40:43], a[16:19], v[168:171]
    s_xor_b32 s60, s60, 1572864
    buffer_load_dwordx4 v6, s[8:11], s62 offen lds
    v_mfma_f32_16x16x32_bf16 v[168:171], v[44:47], a[20:23], v[168:171]
    v_mfma_f32_16x16x32_bf16 v[172:175], v[40:43], a[24:27], v[172:175]
    v_mfma_f32_16x16x32_bf16 v[172:175], v[44:47], a[28:31], v[172:175]
    v_mfma_f32_16x16x32_bf16 v[176:179], v[40:43], a[32:35], v[176:179]
    ds_read_b128 a[80:83], v22 offset:20480
    v_mfma_f32_16x16x32_bf16 v[176:179], v[44:47], a[36:39], v[176:179]
    v_mfma_f32_16x16x32_bf16 v[180:183], v[40:43], a[40:43], v[180:183]
    v_mfma_f32_16x16x32_bf16 v[180:183], v[44:47], a[44:47], v[180:183]
    buffer_load_dwordx4 v7, s[8:11], s62 offen offset:1024 lds
    v_mfma_f32_16x16x32_bf16 v[184:187], v[40:43], a[48:51], v[184:187]
    v_mfma_f32_16x16x32_bf16 v[184:187], v[44:47], a[52:55], v[184:187]
    ds_read_b128 a[84:87], v23 offset:20480
    v_mfma_f32_16x16x32_bf16 v[188:191], v[40:43], a[56:59], v[188:191]
    ds_read_b64_tr_b16 v[40:41], v14 offset:0
    ds_read_b64_tr_b16 v[42:43], v14 offset:1024
    v_mfma_f32_16x16x32_bf16 v[188:191], v[44:47], a[60:63], v[188:191]
    ds_read_b64_tr_b16 v[44:45], v14 offset:8192
    ds_read_b64_tr_b16 v[46:47], v14 offset:9216
    v_mfma_f32_16x16x32_bf16 v[192:195], v[48:51], a[0:3], v[192:195]
    v_mfma_f32_16x16x32_bf16 v[192:195], v[52:55], a[4:7], v[192:195]
    v_mfma_f32_16x16x32_bf16 v[196:199], v[48:51], a[8:11], v[196:199]
    v_mfma_f32_16x16x32_bf16 v[196:199], v[52:55], a[12:15], v[196:199]
    buffer_load_dwordx4 v8, s[8:11], s62 offen offset:2048 lds
    v_mfma_f32_16x16x32_bf16 v[200:203], v[48:51], a[16:19], v[200:203]
    ds_read_b128 a[88:91], v22 offset:22528
    v_mfma_f32_16x16x32_bf16 v[200:203], v[52:55], a[20:23], v[200:203]
    v_mfma_f32_16x16x32_bf16 v[204:207], v[48:51], a[24:27], v[204:207]
    v_mfma_f32_16x16x32_bf16 v[204:207], v[52:55], a[28:31], v[204:207]
    v_mfma_f32_16x16x32_bf16 v[208:211], v[48:51], a[32:35], v[208:211]
    ds_read_b128 a[92:95], v23 offset:22528
    v_mfma_f32_16x16x32_bf16 v[208:211], v[52:55], a[36:39], v[208:211]
    v_mfma_f32_16x16x32_bf16 v[212:215], v[48:51], a[40:43], v[212:215]
    buffer_load_dwordx4 v9, s[8:11], s62 offen offset:3072 lds
    v_mfma_f32_16x16x32_bf16 v[212:215], v[52:55], a[44:47], v[212:215]
    v_mfma_f32_16x16x32_bf16 v[216:219], v[48:51], a[48:51], v[216:219]
    v_mfma_f32_16x16x32_bf16 v[216:219], v[52:55], a[52:55], v[216:219]
    v_mfma_f32_16x16x32_bf16 v[220:223], v[48:51], a[56:59], v[220:223]
    s_waitcnt lgkmcnt(0)
    ds_read_b64_tr_b16 v[48:49], v15 offset:0
    ds_read_b64_tr_b16 v[50:51], v15 offset:1024
    v_mfma_f32_16x16x32_bf16 v[220:223], v[52:55], a[60:63], v[220:223]
    ds_read_b64_tr_b16 v[52:53], v15 offset:8192
    ds_read_b64_tr_b16 v[54:55], v15 offset:9216
    v_mfma_f32_16x16x32_bf16 v[224:227], v[56:59], a[0:3], v[224:227]
    v_mfma_f32_16x16x32_bf16 v[224:227], v[60:63], a[4:7], v[224:227]
    s_xor_b32 s62, s62, 128
    v_mfma_f32_16x16x32_bf16 v[228:231], v[56:59], a[8:11], v[228:231]
    buffer_load_dword v108, v103, s[24:27], s77 offen
    v_mfma_f32_16x16x32_bf16 v[228:231], v[60:63], a[12:15], v[228:231]
    s_add_u32 s77, s77, 4608
    v_mfma_f32_16x16x32_bf16 v[232:235], v[56:59], a[16:19], v[232:235]
    v_mfma_f32_16x16x32_bf16 v[232:235], v[60:63], a[20:23], v[232:235]
    s_add_u32 m0, s69, 98304
    v_mfma_f32_16x16x32_bf16 v[236:239], v[56:59], a[24:27], v[236:239]
    buffer_load_dwordx4 v2, s[12:15], s60 offen nt lds
    v_mfma_f32_16x16x32_bf16 v[236:239], v[60:63], a[28:31], v[236:239]
    v_mfma_f32_16x16x32_bf16 v[240:243], v[56:59], a[32:35], v[240:243]
    v_mfma_f32_16x16x32_bf16 v[240:243], v[60:63], a[36:39], v[240:243]
    v_mfma_f32_16x16x32_bf16 v[244:247], v[56:59], a[40:43], v[244:247]
    v_mfma_f32_16x16x32_bf16 v[244:247], v[60:63], a[44:47], v[244:247]
    v_mfma_f32_16x16x32_bf16 v[248:251], v[56:59], a[48:51], v[248:251]
    v_mfma_f32_16x16x32_bf16 v[248:251], v[60:63], a[52:55], v[248:251]
    buffer_load_dwordx4 v3, s[12:15], s60 offen offset:1024 nt lds
    v_mfma_f32_16x16x32_bf16 v[252:255], v[56:59], a[56:59], v[252:255]
    ds_read_b64_tr_b16 v[56:57], v16 offset:0
    ds_read_b64_tr_b16 v[58:59], v16 offset:1024
    v_mfma_f32_16x16x32_bf16 v[252:255], v[60:63], a[60:63], v[252:255]
    ds_read_b64_tr_b16 v[60:61], v16 offset:8192
    ds_read_b64_tr_b16 v[62:63], v16 offset:9216
    v_mfma_f32_16x16x32_bf16 a[128:131], a[0:3], v[40:43], a[128:131]
    v_mfma_f32_16x16x32_bf16 a[128:131], a[4:7], v[44:47], a[128:131]
    v_add_u32 v22, 0xfffe0000, v22
    v_mfma_f32_16x16x32_bf16 a[132:135], a[8:11], v[40:43], a[132:135]
    ds_read_b128 a[96:99], v22 offset:16384
    v_mfma_f32_16x16x32_bf16 a[132:135], a[12:15], v[44:47], a[132:135]
    v_mfma_f32_16x16x32_bf16 a[136:139], a[16:19], v[40:43], a[136:139]
    v_mfma_f32_16x16x32_bf16 a[136:139], a[20:23], v[44:47], a[136:139]
    buffer_load_dwordx4 v4, s[12:15], s60 offen offset:2048 nt lds
    v_mfma_f32_16x16x32_bf16 a[140:143], a[24:27], v[40:43], a[140:143]
    v_add_u32 v23, 0xfffe0000, v23
    v_mfma_f32_16x16x32_bf16 a[140:143], a[28:31], v[44:47], a[140:143]
    ds_read_b128 a[100:103], v23 offset:16384
    v_mfma_f32_16x16x32_bf16 a[144:147], a[32:35], v[40:43], a[144:147]
    v_mfma_f32_16x16x32_bf16 a[144:147], a[36:39], v[44:47], a[144:147]
    v_mfma_f32_16x16x32_bf16 a[148:151], a[40:43], v[40:43], a[148:151]
    v_mfma_f32_16x16x32_bf16 a[148:151], a[44:47], v[44:47], a[148:151]
    v_mfma_f32_16x16x32_bf16 a[152:155], a[48:51], v[40:43], a[152:155]
    buffer_load_dwordx4 v5, s[12:15], s60 offen offset:3072 nt lds
    v_mfma_f32_16x16x32_bf16 a[152:155], a[52:55], v[44:47], a[152:155]
    ds_read_b128 a[104:107], v22 offset:18432
    v_mfma_f32_16x16x32_bf16 a[156:159], a[56:59], v[40:43], a[156:159]
    ds_read_b64_tr_b16 v[40:41], v17 offset:0
    ds_read_b64_tr_b16 v[42:43], v17 offset:1024
    v_mfma_f32_16x16x32_bf16 a[156:159], a[60:63], v[44:47], a[156:159]
    s_waitcnt lgkmcnt(3)
    ds_read_b64_tr_b16 v[44:45], v17 offset:8192
    ds_read_b64_tr_b16 v[46:47], v17 offset:9216
    v_mfma_f32_16x16x32_bf16 a[160:163], a[0:3], v[48:51], a[160:163]
    v_mfma_f32_16x16x32_bf16 a[160:163], a[4:7], v[52:55], a[160:163]
    v_mfma_f32_16x16x32_bf16 a[164:167], a[8:11], v[48:51], a[164:167]
    ds_read_b128 a[108:111], v23 offset:18432
    v_mfma_f32_16x16x32_bf16 a[164:167], a[12:15], v[52:55], a[164:167]
    s_add_u32 m0, s69, 114688
    v_mfma_f32_16x16x32_bf16 a[168:171], a[16:19], v[48:51], a[168:171]
    s_xor_b32 s60, s60, 524288
    buffer_load_dwordx4 v6, s[8:11], s61 offen lds
    v_mfma_f32_16x16x32_bf16 a[168:171], a[20:23], v[52:55], a[168:171]
    v_mfma_f32_16x16x32_bf16 a[172:175], a[24:27], v[48:51], a[172:175]
    v_mfma_f32_16x16x32_bf16 a[172:175], a[28:31], v[52:55], a[172:175]
    v_mfma_f32_16x16x32_bf16 a[176:179], a[32:35], v[48:51], a[176:179]
    ds_read_b128 a[112:115], v22 offset:20480
    v_mfma_f32_16x16x32_bf16 a[176:179], a[36:39], v[52:55], a[176:179]
    v_mfma_f32_16x16x32_bf16 a[180:183], a[40:43], v[48:51], a[180:183]
    v_mfma_f32_16x16x32_bf16 a[180:183], a[44:47], v[52:55], a[180:183]
    buffer_load_dwordx4 v7, s[8:11], s61 offen offset:1024 lds
    v_mfma_f32_16x16x32_bf16 a[184:187], a[48:51], v[48:51], a[184:187]
    v_mfma_f32_16x16x32_bf16 a[184:187], a[52:55], v[52:55], a[184:187]
    ds_read_b128 a[116:119], v23 offset:20480
    v_mfma_f32_16x16x32_bf16 a[188:191], a[56:59], v[48:51], a[188:191]
    v_mfma_f32_16x16x32_bf16 a[188:191], a[60:63], v[52:55], a[188:191]
    v_mfma_f32_16x16x32_bf16 a[192:195], a[0:3], v[56:59], a[192:195]
    v_mfma_f32_16x16x32_bf16 a[192:195], a[4:7], v[60:63], a[192:195]
    v_mfma_f32_16x16x32_bf16 a[196:199], a[8:11], v[56:59], a[196:199]
    v_mfma_f32_16x16x32_bf16 a[196:199], a[12:15], v[60:63], a[196:199]
    buffer_load_dwordx4 v8, s[8:11], s61 offen offset:2048 lds
    v_mfma_f32_16x16x32_bf16 a[200:203], a[16:19], v[56:59], a[200:203]
    ds_read_b128 a[120:123], v22 offset:22528
    v_mfma_f32_16x16x32_bf16 a[200:203], a[20:23], v[60:63], a[200:203]
    v_mfma_f32_16x16x32_bf16 a[204:207], a[24:27], v[56:59], a[204:207]
    v_mfma_f32_16x16x32_bf16 a[204:207], a[28:31], v[60:63], a[204:207]
    v_mfma_f32_16x16x32_bf16 a[208:211], a[32:35], v[56:59], a[208:211]
    ds_read_b128 a[124:127], v23 offset:22528
    v_mfma_f32_16x16x32_bf16 a[208:211], a[36:39], v[60:63], a[208:211]
    v_mfma_f32_16x16x32_bf16 a[212:215], a[40:43], v[56:59], a[212:215]
    buffer_load_dwordx4 v9, s[8:11], s61 offen offset:3072 lds
    v_mfma_f32_16x16x32_bf16 a[212:215], a[44:47], v[60:63], a[212:215]
    v_mfma_f32_16x16x32_bf16 a[216:219], a[48:51], v[56:59], a[216:219]
    v_mfma_f32_16x16x32_bf16 a[216:219], a[52:55], v[60:63], a[216:219]
    v_mfma_f32_16x16x32_bf16 a[220:223], a[56:59], v[56:59], a[220:223]
    v_mfma_f32_16x16x32_bf16 a[220:223], a[60:63], v[60:63], a[220:223]
    s_waitcnt lgkmcnt(0)
    v_mfma_f32_16x16x32_bf16 a[224:227], a[0:3], v[40:43], a[224:227]
    v_mfma_f32_16x16x32_bf16 a[224:227], a[4:7], v[44:47], a[224:227]
    s_xor_b32 s61, s61, 1920
    v_mfma_f32_16x16x32_bf16 a[228:231], a[8:11], v[40:43], a[228:231]
    s_andn2_b32 s61, s61, 896
    v_mfma_f32_16x16x32_bf16 a[228:231], a[12:15], v[44:47], a[228:231]
    s_lshl_b32 s61, s5, 7
    v_mfma_f32_16x16x32_bf16 a[232:235], a[16:19], v[40:43], a[232:235]
    v_mfma_f32_16x16x32_bf16 a[232:235], a[20:23], v[44:47], a[232:235]
    s_waitcnt vmcnt(9) lgkmcnt(0)
    s_barrier
    ds_read_b64_tr_b16 v[48:49], v14 offset:32768
    v_mfma_f32_16x16x32_bf16 a[236:239], a[24:27], v[40:43], a[236:239]
    s_add_u32 m0, s69, 131072
    ds_read_b64_tr_b16 v[50:51], v14 offset:33792
    ds_read_b64_tr_b16 v[52:53], v14 offset:40960
    v_mfma_f32_16x16x32_bf16 a[236:239], a[28:31], v[44:47], a[236:239]
    buffer_load_dwordx4 v2, s[12:15], s60 offen nt lds
    v_mfma_f32_16x16x32_bf16 a[240:243], a[32:35], v[40:43], a[240:243]
    ds_read_b64_tr_b16 v[54:55], v14 offset:41984
    ds_read_b64_tr_b16 v[56:57], v15 offset:32768
    v_mfma_f32_16x16x32_bf16 a[240:243], a[36:39], v[44:47], a[240:243]
    ds_read_b64_tr_b16 v[58:59], v15 offset:33792
    ds_read_b64_tr_b16 v[60:61], v15 offset:40960
    v_mfma_f32_16x16x32_bf16 a[244:247], a[40:43], v[40:43], a[244:247]
    ds_read_b64_tr_b16 v[62:63], v15 offset:41984
    v_add_u32 v14, 0x10000, v14
    v_mfma_f32_16x16x32_bf16 a[244:247], a[44:47], v[44:47], a[244:247]
    v_add_u32 v15, 0x10000, v15
    v_mfma_f32_16x16x32_bf16 a[248:251], a[48:51], v[40:43], a[248:251]
    v_mfma_f32_16x16x32_bf16 a[248:251], a[52:55], v[44:47], a[248:251]
    buffer_load_dwordx4 v3, s[12:15], s60 offen offset:1024 nt lds
    v_mfma_f32_16x16x32_bf16 a[252:255], a[56:59], v[40:43], a[252:255]
    ds_read_b64_tr_b16 v[40:41], v16 offset:32768
    ds_read_b64_tr_b16 v[42:43], v16 offset:33792
    v_mfma_f32_16x16x32_bf16 a[252:255], a[60:63], v[44:47], a[252:255]
    s_waitcnt lgkmcnt(2)
    ds_read_b64_tr_b16 v[44:45], v16 offset:40960
    ds_read_b64_tr_b16 v[46:47], v16 offset:41984
    v_mfma_f32_16x16x32_bf16 v[128:131], v[48:51], a[64:67], v[128:131]
    v_add_u32 v16, 0x10000, v16
    v_mfma_f32_16x16x32_bf16 v[128:131], v[52:55], a[68:71], v[128:131]
    v_mfma_f32_16x16x32_bf16 v[132:135], v[48:51], a[72:75], v[132:135]
    ds_read_b128 a[0:3], v22 offset:49152
    v_mfma_f32_16x16x32_bf16 v[132:135], v[52:55], a[76:79], v[132:135]
    v_mfma_f32_16x16x32_bf16 v[136:139], v[48:51], a[80:83], v[136:139]
    v_mfma_f32_16x16x32_bf16 v[136:139], v[52:55], a[84:87], v[136:139]
    buffer_load_dwordx4 v4, s[12:15], s60 offen offset:2048 nt lds
    v_mfma_f32_16x16x32_bf16 v[140:143], v[48:51], a[88:91], v[140:143]
    v_mfma_f32_16x16x32_bf16 v[140:143], v[52:55], a[92:95], v[140:143]
    ds_read_b128 a[4:7], v23 offset:49152
    v_mfma_f32_16x16x32_bf16 v[144:147], v[48:51], a[96:99], v[144:147]
    v_mfma_f32_16x16x32_bf16 v[144:147], v[52:55], a[100:103], v[144:147]
    v_mfma_f32_16x16x32_bf16 v[148:151], v[48:51], a[104:107], v[148:151]
    v_mfma_f32_16x16x32_bf16 v[148:151], v[52:55], a[108:111], v[148:151]
    v_mfma_f32_16x16x32_bf16 v[152:155], v[48:51], a[112:115], v[152:155]
    buffer_load_dwordx4 v5, s[12:15], s60 offen offset:3072 nt lds
    v_mfma_f32_16x16x32_bf16 v[152:155], v[52:55], a[116:119], v[152:155]
    ds_read_b128 a[8:11], v22 offset:51200
    v_mfma_f32_16x16x32_bf16 v[156:159], v[48:51], a[120:123], v[156:159]
    ds_read_b64_tr_b16 v[48:49], v17 offset:32768
    ds_read_b64_tr_b16 v[50:51], v17 offset:33792
    v_mfma_f32_16x16x32_bf16 v[156:159], v[52:55], a[124:127], v[156:159]
    ds_read_b64_tr_b16 v[52:53], v17 offset:40960
    ds_read_b64_tr_b16 v[54:55], v17 offset:41984
    v_mfma_f32_16x16x32_bf16 v[160:163], v[56:59], a[64:67], v[160:163]
    v_add_u32 v17, 0x10000, v17
    v_mfma_f32_16x16x32_bf16 v[160:163], v[60:63], a[68:71], v[160:163]
    s_cmp_lt_u32 s4, 0
    s_cselect_b32 s12, 0xf149f2ca, 0
    v_mfma_f32_16x16x32_bf16 v[164:167], v[56:59], a[72:75], v[164:167]
    ds_read_b128 a[12:15], v23 offset:51200
    v_mfma_f32_16x16x32_bf16 v[164:167], v[60:63], a[76:79], v[164:167]
    s_add_u32 m0, s69, 147456
    v_mfma_f32_16x16x32_bf16 v[168:171], v[56:59], a[80:83], v[168:171]
    s_xor_b32 s60, s60, 524288
    buffer_load_dwordx4 v6, s[8:11], s62 offen lds
    v_mfma_f32_16x16x32_bf16 v[168:171], v[60:63], a[84:87], v[168:171]
    v_mov_b32 v6, v96
    v_mfma_f32_16x16x32_bf16 v[172:175], v[56:59], a[88:91], v[172:175]
    s_cmp_lt_u32 s4, 1
    s_cselect_b32 s13, 0xf149f2ca, 0
    v_mfma_f32_16x16x32_bf16 v[172:175], v[60:63], a[92:95], v[172:175]
    s_cmp_lt_u32 s4, 2
    s_cselect_b32 s14, 0xf149f2ca, 0
    v_mfma_f32_16x16x32_bf16 v[176:179], v[56:59], a[96:99], v[176:179]
    ds_read_b128 a[16:19], v22 offset:53248
    v_mfma_f32_16x16x32_bf16 v[176:179], v[60:63], a[100:103], v[176:179]
    s_cmp_lt_u32 s4, 3
    s_cselect_b32 s15, 0xf149f2ca, 0
    v_mfma_f32_16x16x32_bf16 v[180:183], v[56:59], a[104:107], v[180:183]
    v_mfma_f32_16x16x32_bf16 v[180:183], v[60:63], a[108:111], v[180:183]
    buffer_load_dwordx4 v7, s[8:11], s62 offen offset:1024 lds
    v_mfma_f32_16x16x32_bf16 v[184:187], v[56:59], a[112:115], v[184:187]
    v_mfma_f32_16x16x32_bf16 v[184:187], v[60:63], a[116:119], v[184:187]
    ds_read_b128 a[20:23], v23 offset:53248
    v_mfma_f32_16x16x32_bf16 v[188:191], v[56:59], a[120:123], v[188:191]
    s_waitcnt lgkmcnt(1)
    ds_read_b64_tr_b16 v[56:57], v14 offset:0
    ds_read_b64_tr_b16 v[58:59], v14 offset:1024
    v_mfma_f32_16x16x32_bf16 v[188:191], v[60:63], a[124:127], v[188:191]
    ds_read_b64_tr_b16 v[60:61], v14 offset:8192
    ds_read_b64_tr_b16 v[62:63], v14 offset:9216
    v_mfma_f32_16x16x32_bf16 v[192:195], v[40:43], a[64:67], v[192:195]
    v_mfma_f32_16x16x32_bf16 v[192:195], v[44:47], a[68:71], v[192:195]
    v_mfma_f32_16x16x32_bf16 v[196:199], v[40:43], a[72:75], v[196:199]
    v_mfma_f32_16x16x32_bf16 v[196:199], v[44:47], a[76:79], v[196:199]
    buffer_load_dwordx4 v8, s[8:11], s62 offen offset:2048 lds
    v_mfma_f32_16x16x32_bf16 v[200:203], v[40:43], a[80:83], v[200:203]
    ds_read_b128 a[24:27], v22 offset:55296
    v_bfe_u32 v8, v1, 4, 3
    v_mfma_f32_16x16x32_bf16 v[200:203], v[44:47], a[84:87], v[200:203]
    v_lshlrev_b32 v8, 12, v8
    v_mfma_f32_16x16x32_bf16 v[204:207], v[40:43], a[88:91], v[204:207]
    v_mfma_f32_16x16x32_bf16 v[204:207], v[44:47], a[92:95], v[204:207]
    v_mfma_f32_16x16x32_bf16 v[208:211], v[40:43], a[96:99], v[208:211]
    ds_read_b128 a[28:31], v23 offset:55296
    v_mfma_f32_16x16x32_bf16 v[208:211], v[44:47], a[100:103], v[208:211]
    v_mfma_f32_16x16x32_bf16 v[212:215], v[40:43], a[104:107], v[212:215]
    buffer_load_dwordx4 v9, s[8:11], s62 offen offset:3072 lds
    v_mfma_f32_16x16x32_bf16 v[212:215], v[44:47], a[108:111], v[212:215]
    s_and_b32 s8, s5, 7
    v_lshrrev_b32 v9, 2, v1
    v_mfma_f32_16x16x32_bf16 v[216:219], v[40:43], a[112:115], v[216:219]
    s_lshl3_add_u32 s8, s6, s8
    v_mfma_f32_16x16x32_bf16 v[216:219], v[44:47], a[116:119], v[216:219]
    s_mul_hi_u32 s98, s8, 715827883
    v_mfma_f32_16x16x32_bf16 v[220:223], v[40:43], a[120:123], v[220:223]
    s_lshr_b32 s10, s5, 3
    ds_read_b64_tr_b16 v[40:41], v15 offset:0
    ds_read_b64_tr_b16 v[42:43], v15 offset:1024
    v_mfma_f32_16x16x32_bf16 v[220:223], v[44:47], a[124:127], v[220:223]
    ds_read_b64_tr_b16 v[44:45], v15 offset:8192
    ds_read_b64_tr_b16 v[46:47], v15 offset:9216
    v_mfma_f32_16x16x32_bf16 v[224:227], v[48:51], a[64:67], v[224:227]
    s_cmp_eq_u32 s4, 3
    s_cselect_b32 s11, 1.0, 0
    v_mfma_f32_16x16x32_bf16 v[224:227], v[52:55], a[68:71], v[224:227]
    s_xor_b32 s62, s62, 1920
    v_mfma_f32_16x16x32_bf16 v[228:231], v[48:51], a[72:75], v[228:231]
    s_andn2_b32 s62, s62, 896
    buffer_load_dword v109, v103, s[24:27], s77 offen
    v_mfma_f32_16x16x32_bf16 v[228:231], v[52:55], a[76:79], v[228:231]
    v_mfma_f32_16x16x32_bf16 v[232:235], v[48:51], a[80:83], v[232:235]
    v_mfma_f32_16x16x32_bf16 v[232:235], v[52:55], a[84:87], v[232:235]
    s_add_u32 m0, s69, 0
    v_mfma_f32_16x16x32_bf16 v[236:239], v[48:51], a[88:91], v[236:239]
    buffer_load_dwordx4 v2, s[16:19], s60 offen nt lds
    v_mfma_f32_16x16x32_bf16 v[236:239], v[52:55], a[92:95], v[236:239]
    v_mfma_f32_16x16x32_bf16 v[240:243], v[48:51], a[96:99], v[240:243]
    v_mfma_f32_16x16x32_bf16 v[240:243], v[52:55], a[100:103], v[240:243]
    v_mfma_f32_16x16x32_bf16 v[244:247], v[48:51], a[104:107], v[244:247]
    v_mfma_f32_16x16x32_bf16 v[244:247], v[52:55], a[108:111], v[244:247]
    v_mfma_f32_16x16x32_bf16 v[248:251], v[48:51], a[112:115], v[248:251]
    v_mfma_f32_16x16x32_bf16 v[248:251], v[52:55], a[116:119], v[248:251]
    buffer_load_dwordx4 v3, s[16:19], s60 offen offset:1024 nt lds
    v_mfma_f32_16x16x32_bf16 v[252:255], v[48:51], a[120:123], v[252:255]
    ds_read_b64_tr_b16 v[48:49], v16 offset:0
    ds_read_b64_tr_b16 v[50:51], v16 offset:1024
    v_mfma_f32_16x16x32_bf16 v[252:255], v[52:55], a[124:127], v[252:255]
    s_waitcnt lgkmcnt(2)
    ds_read_b64_tr_b16 v[52:53], v16 offset:8192
    ds_read_b64_tr_b16 v[54:55], v16 offset:9216
    v_mfma_f32_16x16x32_bf16 a[128:131], a[64:67], v[56:59], a[128:131]
    v_mfma_f32_16x16x32_bf16 a[128:131], a[68:71], v[60:63], a[128:131]
    v_add_u32 v22, 0x10000, v22
    v_mfma_f32_16x16x32_bf16 a[132:135], a[72:75], v[56:59], a[132:135]
    ds_read_b128 a[32:35], v22 offset:16384
    v_mfma_f32_16x16x32_bf16 a[132:135], a[76:79], v[60:63], a[132:135]
    v_mfma_f32_16x16x32_bf16 a[136:139], a[80:83], v[56:59], a[136:139]
    v_mfma_f32_16x16x32_bf16 a[136:139], a[84:87], v[60:63], a[136:139]
    buffer_load_dwordx4 v4, s[16:19], s60 offen offset:2048 nt lds
    v_mfma_f32_16x16x32_bf16 a[140:143], a[88:91], v[56:59], a[140:143]
    v_add_u32 v23, 0x10000, v23
    v_mfma_f32_16x16x32_bf16 a[140:143], a[92:95], v[60:63], a[140:143]
    ds_read_b128 a[36:39], v23 offset:16384
    v_mfma_f32_16x16x32_bf16 a[144:147], a[96:99], v[56:59], a[144:147]
    v_mfma_f32_16x16x32_bf16 a[144:147], a[100:103], v[60:63], a[144:147]
    v_mfma_f32_16x16x32_bf16 a[148:151], a[104:107], v[56:59], a[148:151]
    v_mfma_f32_16x16x32_bf16 a[148:151], a[108:111], v[60:63], a[148:151]
    v_mfma_f32_16x16x32_bf16 a[152:155], a[112:115], v[56:59], a[152:155]
    buffer_load_dwordx4 v5, s[16:19], s60 offen offset:3072 nt lds
    v_mfma_f32_16x16x32_bf16 a[152:155], a[116:119], v[60:63], a[152:155]
    ds_read_b128 a[40:43], v22 offset:18432
    v_mfma_f32_16x16x32_bf16 a[156:159], a[120:123], v[56:59], a[156:159]
    ds_read_b64_tr_b16 v[56:57], v17 offset:0
    ds_read_b64_tr_b16 v[58:59], v17 offset:1024
    v_mfma_f32_16x16x32_bf16 a[156:159], a[124:127], v[60:63], a[156:159]
    ds_read_b64_tr_b16 v[60:61], v17 offset:8192
    ds_read_b64_tr_b16 v[62:63], v17 offset:9216
    v_mfma_f32_16x16x32_bf16 a[160:163], a[64:67], v[40:43], a[160:163]
    v_mfma_f32_16x16x32_bf16 a[160:163], a[68:71], v[44:47], a[160:163]
    v_mfma_f32_16x16x32_bf16 a[164:167], a[72:75], v[40:43], a[164:167]
    ds_read_b128 a[44:47], v23 offset:18432
    v_mfma_f32_16x16x32_bf16 a[164:167], a[76:79], v[44:47], a[164:167]
    s_add_u32 m0, s69, 16384
    v_mfma_f32_16x16x32_bf16 a[168:171], a[80:83], v[40:43], a[168:171]
    s_xor_b32 s60, s60, 524288
    buffer_load_dwordx4 v10, s[20:23], s63 offen lds
    v_mfma_f32_16x16x32_bf16 a[168:171], a[84:87], v[44:47], a[168:171]
    v_mfma_f32_16x16x32_bf16 a[172:175], a[88:91], v[40:43], a[172:175]
    v_mfma_f32_16x16x32_bf16 a[172:175], a[92:95], v[44:47], a[172:175]
    v_mfma_f32_16x16x32_bf16 a[176:179], a[96:99], v[40:43], a[176:179]
    ds_read_b128 a[48:51], v22 offset:20480
    v_mfma_f32_16x16x32_bf16 a[176:179], a[100:103], v[44:47], a[176:179]
    v_mfma_f32_16x16x32_bf16 a[180:183], a[104:107], v[40:43], a[180:183]
    v_mfma_f32_16x16x32_bf16 a[180:183], a[108:111], v[44:47], a[180:183]
    buffer_load_dwordx4 v11, s[20:23], s63 offen offset:1024 lds
    v_mfma_f32_16x16x32_bf16 a[184:187], a[112:115], v[40:43], a[184:187]
    v_mfma_f32_16x16x32_bf16 a[184:187], a[116:119], v[44:47], a[184:187]
    ds_read_b128 a[52:55], v23 offset:20480
    v_mfma_f32_16x16x32_bf16 a[188:191], a[120:123], v[40:43], a[188:191]
    v_mfma_f32_16x16x32_bf16 a[188:191], a[124:127], v[44:47], a[188:191]
    s_waitcnt lgkmcnt(1)
    v_mfma_f32_16x16x32_bf16 a[192:195], a[64:67], v[48:51], a[192:195]
    v_mfma_f32_16x16x32_bf16 a[192:195], a[68:71], v[52:55], a[192:195]
    v_mfma_f32_16x16x32_bf16 a[196:199], a[72:75], v[48:51], a[196:199]
    v_mfma_f32_16x16x32_bf16 a[196:199], a[76:79], v[52:55], a[196:199]
    buffer_load_dwordx4 v12, s[20:23], s63 offen offset:2048 lds
    v_mfma_f32_16x16x32_bf16 a[200:203], a[80:83], v[48:51], a[200:203]
    ds_read_b128 a[56:59], v22 offset:22528
    v_mfma_f32_16x16x32_bf16 a[200:203], a[84:87], v[52:55], a[200:203]
    v_mfma_f32_16x16x32_bf16 a[204:207], a[88:91], v[48:51], a[204:207]
    v_mfma_f32_16x16x32_bf16 a[204:207], a[92:95], v[52:55], a[204:207]
    v_mfma_f32_16x16x32_bf16 a[208:211], a[96:99], v[48:51], a[208:211]
    ds_read_b128 a[60:63], v23 offset:22528
    v_mfma_f32_16x16x32_bf16 a[208:211], a[100:103], v[52:55], a[208:211]
    v_mfma_f32_16x16x32_bf16 a[212:215], a[104:107], v[48:51], a[212:215]
    buffer_load_dwordx4 v13, s[20:23], s63 offen offset:3072 lds
    v_mfma_f32_16x16x32_bf16 a[212:215], a[108:111], v[52:55], a[212:215]
    v_mfma_f32_16x16x32_bf16 a[216:219], a[112:115], v[48:51], a[216:219]
    v_mfma_f32_16x16x32_bf16 a[216:219], a[116:119], v[52:55], a[216:219]
    v_mfma_f32_16x16x32_bf16 a[220:223], a[120:123], v[48:51], a[220:223]
    v_mfma_f32_16x16x32_bf16 a[220:223], a[124:127], v[52:55], a[220:223]
    v_mfma_f32_16x16x32_bf16 a[224:227], a[64:67], v[56:59], a[224:227]
    v_mfma_f32_16x16x32_bf16 a[224:227], a[68:71], v[60:63], a[224:227]
    s_xor_b32 s63, s63, 128
    v_mfma_f32_16x16x32_bf16 a[228:231], a[72:75], v[56:59], a[228:231]
    v_mfma_f32_16x16x32_bf16 a[228:231], a[76:79], v[60:63], a[228:231]
    v_mfma_f32_16x16x32_bf16 a[232:235], a[80:83], v[56:59], a[232:235]
    v_mfma_f32_16x16x32_bf16 a[232:235], a[84:87], v[60:63], a[232:235]
    s_waitcnt vmcnt(9) lgkmcnt(0)
    s_barrier
    ds_read_b64_tr_b16 v[40:41], v14 offset:32768
    v_mfma_f32_16x16x32_bf16 a[236:239], a[88:91], v[56:59], a[236:239]
    s_add_u32 m0, s69, 32768
    ds_read_b64_tr_b16 v[42:43], v14 offset:33792
    ds_read_b64_tr_b16 v[44:45], v14 offset:40960
    v_mfma_f32_16x16x32_bf16 a[236:239], a[92:95], v[60:63], a[236:239]
    buffer_load_dwordx4 v2, s[16:19], s60 offen nt lds
    v_mfma_f32_16x16x32_bf16 a[240:243], a[96:99], v[56:59], a[240:243]
    ds_read_b64_tr_b16 v[46:47], v14 offset:41984
    ds_read_b64_tr_b16 v[48:49], v15 offset:32768
    v_mfma_f32_16x16x32_bf16 a[240:243], a[100:103], v[60:63], a[240:243]
    ds_read_b64_tr_b16 v[50:51], v15 offset:33792
    ds_read_b64_tr_b16 v[52:53], v15 offset:40960
    v_mfma_f32_16x16x32_bf16 a[244:247], a[104:107], v[56:59], a[244:247]
    ds_read_b64_tr_b16 v[54:55], v15 offset:41984
    v_add_u32 v14, 0x10000, v14
    v_mfma_f32_16x16x32_bf16 a[244:247], a[108:111], v[60:63], a[244:247]
    v_add_u32 v15, 0x10000, v15
    v_mfma_f32_16x16x32_bf16 a[248:251], a[112:115], v[56:59], a[248:251]
    v_mfma_f32_16x16x32_bf16 a[248:251], a[116:119], v[60:63], a[248:251]
    buffer_load_dwordx4 v3, s[16:19], s60 offen offset:1024 nt lds
    v_mfma_f32_16x16x32_bf16 a[252:255], a[120:123], v[56:59], a[252:255]
    ds_read_b64_tr_b16 v[56:57], v16 offset:32768
    ds_read_b64_tr_b16 v[58:59], v16 offset:33792
    v_mfma_f32_16x16x32_bf16 a[252:255], a[124:127], v[60:63], a[252:255]
    s_waitcnt lgkmcnt(2)
    ds_read_b64_tr_b16 v[60:61], v16 offset:40960
    ds_read_b64_tr_b16 v[62:63], v16 offset:41984
    v_mfma_f32_16x16x32_bf16 v[128:131], v[40:43], a[0:3], v[128:131]
    v_add_u32 v16, 0x10000, v16
    v_mfma_f32_16x16x32_bf16 v[128:131], v[44:47], a[4:7], v[128:131]
    ds_read_b128 a[64:67], v22 offset:49152
    v_mfma_f32_16x16x32_bf16 v[132:135], v[40:43], a[8:11], v[132:135]
    v_mfma_f32_16x16x32_bf16 v[132:135], v[44:47], a[12:15], v[132:135]
    v_mfma_f32_16x16x32_bf16 v[136:139], v[40:43], a[16:19], v[136:139]
    ds_read_b128 a[68:71], v23 offset:49152
    v_mfma_f32_16x16x32_bf16 v[136:139], v[44:47], a[20:23], v[136:139]
    buffer_load_dwordx4 v4, s[16:19], s60 offen offset:2048 nt lds
    v_mfma_f32_16x16x32_bf16 v[140:143], v[40:43], a[24:27], v[140:143]
    v_mfma_f32_16x16x32_bf16 v[140:143], v[44:47], a[28:31], v[140:143]
    ds_read_b128 a[72:75], v22 offset:51200
    v_mfma_f32_16x16x32_bf16 v[144:147], v[40:43], a[32:35], v[144:147]
    v_mfma_f32_16x16x32_bf16 v[144:147], v[44:47], a[36:39], v[144:147]
    v_mfma_f32_16x16x32_bf16 v[148:151], v[40:43], a[40:43], v[148:151]
    ds_read_b128 a[76:79], v23 offset:51200
    v_mfma_f32_16x16x32_bf16 v[148:151], v[44:47], a[44:47], v[148:151]
    v_mfma_f32_16x16x32_bf16 v[152:155], v[40:43], a[48:51], v[152:155]
    buffer_load_dwordx4 v5, s[16:19], s60 offen offset:3072 nt lds
    v_mfma_f32_16x16x32_bf16 v[152:155], v[44:47], a[52:55], v[152:155]
    v_mfma_f32_16x16x32_bf16 v[156:159], v[40:43], a[56:59], v[156:159]
    ds_read_b128 a[80:83], v22 offset:53248
    ds_read_b64_tr_b16 v[40:41], v17 offset:32768
    v_mfma_f32_16x16x32_bf16 v[156:159], v[44:47], a[60:63], v[156:159]
    ds_read_b64_tr_b16 v[42:43], v17 offset:33792
    ds_read_b64_tr_b16 v[44:45], v17 offset:40960
    v_mfma_f32_16x16x32_bf16 v[160:163], v[48:51], a[0:3], v[160:163]
    ds_read_b64_tr_b16 v[46:47], v17 offset:41984
    v_add_u32 v17, 0x10000, v17
    v_mfma_f32_16x16x32_bf16 v[160:163], v[52:55], a[4:7], v[160:163]
    ds_read_b128 a[84:87], v23 offset:53248
    v_mfma_f32_16x16x32_bf16 v[164:167], v[48:51], a[8:11], v[164:167]
    v_mfma_f32_16x16x32_bf16 v[164:167], v[52:55], a[12:15], v[164:167]
    s_add_u32 m0, s69, 49152
    buffer_load_dword v7, v9, s[44:47], s69 offen sc1
    v_mfma_f32_16x16x32_bf16 v[168:171], v[48:51], a[16:19], v[168:171]
    s_xor_b32 s60, s60, 3670016
    buffer_load_dwordx4 v10, s[20:23], s64 offen lds
    v_mfma_f32_16x16x32_bf16 v[168:171], v[52:55], a[20:23], v[168:171]
    ds_read_b128 a[88:91], v22 offset:55296
    v_mfma_f32_16x16x32_bf16 v[172:175], v[48:51], a[24:27], v[172:175]
    v_mfma_f32_16x16x32_bf16 v[172:175], v[52:55], a[28:31], v[172:175]
    s_waitcnt lgkmcnt(1)
    ds_read_b128 a[92:95], v23 offset:55296
    v_mfma_f32_16x16x32_bf16 v[176:179], v[48:51], a[32:35], v[176:179]
    v_mfma_f32_16x16x32_bf16 v[176:179], v[52:55], a[36:39], v[176:179]
    v_mfma_f32_16x16x32_bf16 v[180:183], v[48:51], a[40:43], v[180:183]
    v_mfma_f32_16x16x32_bf16 v[180:183], v[52:55], a[44:47], v[180:183]
    buffer_load_dwordx4 v11, s[20:23], s64 offen offset:1024 lds
    v_mfma_f32_16x16x32_bf16 v[184:187], v[48:51], a[48:51], v[184:187]
    v_add_u32 v22, 0x10000, v22
    ds_read_b128 a[96:99], v22 offset:16384
    v_mfma_f32_16x16x32_bf16 v[184:187], v[52:55], a[52:55], v[184:187]
    v_mfma_f32_16x16x32_bf16 v[188:191], v[48:51], a[56:59], v[188:191]
    v_add_u32 v23, 0x10000, v23
    ds_read_b64_tr_b16 v[48:49], v14 offset:0
    v_mfma_f32_16x16x32_bf16 v[188:191], v[52:55], a[60:63], v[188:191]
    ds_read_b128 a[100:103], v23 offset:16384
    ds_read_b64_tr_b16 v[50:51], v14 offset:1024
    v_mfma_f32_16x16x32_bf16 v[192:195], v[56:59], a[0:3], v[192:195]
    ds_read_b64_tr_b16 v[52:53], v14 offset:8192
    ds_read_b64_tr_b16 v[54:55], v14 offset:9216
    v_mfma_f32_16x16x32_bf16 v[192:195], v[60:63], a[4:7], v[192:195]
    v_add_u32 v14, 0xfffe0000, v14
    v_mfma_f32_16x16x32_bf16 v[196:199], v[56:59], a[8:11], v[196:199]
    ds_read_b128 a[104:107], v22 offset:18432
    v_mfma_f32_16x16x32_bf16 v[196:199], v[60:63], a[12:15], v[196:199]
    buffer_load_dwordx4 v12, s[20:23], s64 offen offset:2048 lds
    v_mfma_f32_16x16x32_bf16 v[200:203], v[56:59], a[16:19], v[200:203]
    v_mfma_f32_16x16x32_bf16 v[200:203], v[60:63], a[20:23], v[200:203]
    ds_read_b128 a[108:111], v23 offset:18432
    v_mfma_f32_16x16x32_bf16 v[204:207], v[56:59], a[24:27], v[204:207]
    v_mfma_f32_16x16x32_bf16 v[204:207], v[60:63], a[28:31], v[204:207]
    v_mfma_f32_16x16x32_bf16 v[208:211], v[56:59], a[32:35], v[208:211]
    v_mfma_f32_16x16x32_bf16 v[208:211], v[60:63], a[36:39], v[208:211]
    ds_read_b128 a[112:115], v22 offset:20480
    v_mfma_f32_16x16x32_bf16 v[212:215], v[56:59], a[40:43], v[212:215]
    buffer_load_dwordx4 v13, s[20:23], s64 offen offset:3072 lds
    v_mfma_f32_16x16x32_bf16 v[212:215], v[60:63], a[44:47], v[212:215]
    v_mfma_f32_16x16x32_bf16 v[216:219], v[56:59], a[48:51], v[216:219]
    ds_read_b128 a[116:119], v23 offset:20480
    v_mfma_f32_16x16x32_bf16 v[216:219], v[60:63], a[52:55], v[216:219]
    v_mfma_f32_16x16x32_bf16 v[220:223], v[56:59], a[56:59], v[220:223]
    ds_read_b64_tr_b16 v[56:57], v15 offset:0
    ds_read_b64_tr_b16 v[58:59], v15 offset:1024
    v_mfma_f32_16x16x32_bf16 v[220:223], v[60:63], a[60:63], v[220:223]
    s_waitcnt lgkmcnt(3)
    ds_read_b128 a[120:123], v22 offset:22528
    ds_read_b64_tr_b16 v[60:61], v15 offset:8192
    v_mfma_f32_16x16x32_bf16 v[224:227], v[40:43], a[0:3], v[224:227]
    ds_read_b64_tr_b16 v[62:63], v15 offset:9216
    v_add_u32 v15, 0xfffe0000, v15
    v_mfma_f32_16x16x32_bf16 v[224:227], v[44:47], a[4:7], v[224:227]
    s_xor_b32 s64, s64, 128
    v_mov_b32 v22, v100
    v_add_u32 v22, 0x10000, v22
    v_mfma_f32_16x16x32_bf16 v[228:231], v[40:43], a[8:11], v[228:231]
    ds_read_b128 a[124:127], v23 offset:22528
    v_mov_b32 v23, v101
    v_mfma_f32_16x16x32_bf16 v[228:231], v[44:47], a[12:15], v[228:231]
    v_add_u32 v23, 0x10000, v23
    v_mfma_f32_16x16x32_bf16 v[232:235], v[40:43], a[16:19], v[232:235]
    v_mfma_f32_16x16x32_bf16 v[232:235], v[44:47], a[20:23], v[232:235]
    s_add_u32 m0, s69, 65536
    v_mfma_f32_16x16x32_bf16 v[236:239], v[40:43], a[24:27], v[236:239]
    buffer_load_dwordx4 v2, s[24:27], s60 offen lds
    v_mfma_f32_16x16x32_bf16 v[236:239], v[44:47], a[28:31], v[236:239]
    v_mfma_f32_16x16x32_bf16 v[240:243], v[40:43], a[32:35], v[240:243]
    v_mfma_f32_16x16x32_bf16 v[240:243], v[44:47], a[36:39], v[240:243]
    v_mfma_f32_16x16x32_bf16 v[244:247], v[40:43], a[40:43], v[244:247]
    v_mfma_f32_16x16x32_bf16 v[244:247], v[44:47], a[44:47], v[244:247]
    v_mfma_f32_16x16x32_bf16 v[248:251], v[40:43], a[48:51], v[248:251]
    v_mfma_f32_16x16x32_bf16 v[248:251], v[44:47], a[52:55], v[248:251]
    buffer_load_dwordx4 v3, s[24:27], s60 offen offset:1024 lds
    v_mfma_f32_16x16x32_bf16 v[252:255], v[40:43], a[56:59], v[252:255]
    ds_read_b64_tr_b16 v[40:41], v16 offset:0
    ds_read_b64_tr_b16 v[42:43], v16 offset:1024
    v_mfma_f32_16x16x32_bf16 v[252:255], v[44:47], a[60:63], v[252:255]
    ds_read_b64_tr_b16 v[44:45], v16 offset:8192
    ds_read_b64_tr_b16 v[46:47], v16 offset:9216
    v_mfma_f32_16x16x32_bf16 v[128:131], v[48:51], a[64:67], v[128:131]
    v_add_u32 v16, 0xfffe0000, v16
    v_mfma_f32_16x16x32_bf16 v[128:131], v[52:55], a[68:71], v[128:131]
    v_mfma_f32_16x16x32_bf16 v[132:135], v[48:51], a[72:75], v[132:135]
    v_mfma_f32_16x16x32_bf16 v[132:135], v[52:55], a[76:79], v[132:135]
    v_mfma_f32_16x16x32_bf16 v[136:139], v[48:51], a[80:83], v[136:139]
    v_mfma_f32_16x16x32_bf16 v[136:139], v[52:55], a[84:87], v[136:139]
    buffer_load_dwordx4 v4, s[24:27], s60 offen offset:2048 lds
    v_mfma_f32_16x16x32_bf16 v[140:143], v[48:51], a[88:91], v[140:143]
    v_mfma_f32_16x16x32_bf16 v[140:143], v[52:55], a[92:95], v[140:143]
    v_mfma_f32_16x16x32_bf16 v[144:147], v[48:51], a[96:99], v[144:147]
    v_mul_f32 v128, s74, v128
    v_mul_f32 v129, s74, v129
    v_mfma_f32_16x16x32_bf16 v[144:147], v[52:55], a[100:103], v[144:147]
    v_mul_f32 v130, s74, v130
    v_mul_f32 v131, s74, v131
    v_mfma_f32_16x16x32_bf16 v[148:151], v[48:51], a[104:107], v[148:151]
    v_cvt_pk_bf16_f32 v128, v128, v129
    v_cvt_pk_bf16_f32 v129, v130, v131
    v_mfma_f32_16x16x32_bf16 v[148:151], v[52:55], a[108:111], v[148:151]
    v_mul_f32 v132, s74, v132
    v_mul_f32 v133, s74, v133
    v_mfma_f32_16x16x32_bf16 v[152:155], v[48:51], a[112:115], v[152:155]
    s_waitcnt lgkmcnt(0)
    buffer_load_dwordx4 v5, s[24:27], s60 offen offset:3072 lds
    v_mfma_f32_16x16x32_bf16 v[152:155], v[52:55], a[116:119], v[152:155]
    v_mul_f32 v134, s74, v134
    v_mul_f32 v135, s74, v135
    v_mfma_f32_16x16x32_bf16 v[156:159], v[48:51], a[120:123], v[156:159]
    ds_read_b64_tr_b16 v[48:49], v17 offset:0
    ds_read_b64_tr_b16 v[50:51], v17 offset:1024
    v_mfma_f32_16x16x32_bf16 v[156:159], v[52:55], a[124:127], v[156:159]
    ds_read_b64_tr_b16 v[52:53], v17 offset:8192
    ds_read_b64_tr_b16 v[54:55], v17 offset:9216
    v_mfma_f32_16x16x32_bf16 v[160:163], v[56:59], a[64:67], v[160:163]
    v_add_u32 v17, 0xfffe0000, v17
    v_cvt_pk_bf16_f32 v132, v132, v133
    v_mfma_f32_16x16x32_bf16 v[160:163], v[60:63], a[68:71], v[160:163]
    v_cvt_pk_bf16_f32 v133, v134, v135
    v_mul_f32 v136, s74, v136
    v_mfma_f32_16x16x32_bf16 v[164:167], v[56:59], a[72:75], v[164:167]
    v_mul_f32 v137, s74, v137
    v_mul_f32 v138, s74, v138
    v_mfma_f32_16x16x32_bf16 v[164:167], v[60:63], a[76:79], v[164:167]
    s_add_u32 m0, s69, 81920
    v_mul_f32 v139, s74, v139
    v_mul_f32 v160, s74, v160
    v_mfma_f32_16x16x32_bf16 v[168:171], v[56:59], a[80:83], v[168:171]
    s_xor_b32 s60, s60, 524288
    buffer_load_dwordx4 v10, s[20:23], s63 offen lds
    v_mfma_f32_16x16x32_bf16 v[168:171], v[60:63], a[84:87], v[168:171]
    v_mul_f32 v161, s74, v161
    v_mul_f32 v162, s74, v162
    v_mfma_f32_16x16x32_bf16 v[172:175], v[56:59], a[88:91], v[172:175]
    v_mul_f32 v163, s74, v163
    v_cvt_pk_bf16_f32 v130, v160, v161
    v_mfma_f32_16x16x32_bf16 v[172:175], v[60:63], a[92:95], v[172:175]
    v_cvt_pk_bf16_f32 v131, v162, v163
    v_mul_f32 v164, s74, v164
    v_mfma_f32_16x16x32_bf16 v[176:179], v[56:59], a[96:99], v[176:179]
    v_mul_f32 v165, s74, v165
    v_mul_f32 v166, s74, v166
    v_mfma_f32_16x16x32_bf16 v[176:179], v[60:63], a[100:103], v[176:179]
    v_mul_f32 v167, s74, v167
    v_cvt_pk_bf16_f32 v134, v164, v165
    v_mfma_f32_16x16x32_bf16 v[180:183], v[56:59], a[104:107], v[180:183]
    v_cvt_pk_bf16_f32 v135, v166, v167
    v_mul_f32 v168, s74, v168
    v_mfma_f32_16x16x32_bf16 v[180:183], v[60:63], a[108:111], v[180:183]
    buffer_load_dwordx4 v11, s[20:23], s63 offen offset:1024 lds
    v_mfma_f32_16x16x32_bf16 v[184:187], v[56:59], a[112:115], v[184:187]
    v_mul_f32 v169, s74, v169
    v_mul_f32 v170, s74, v170
    v_mfma_f32_16x16x32_bf16 v[184:187], v[60:63], a[116:119], v[184:187]
    v_mul_f32 v171, s74, v171
    v_cvt_pk_bf16_f32 v136, v136, v137
    v_mfma_f32_16x16x32_bf16 v[188:191], v[56:59], a[120:123], v[188:191]
    v_cvt_pk_bf16_f32 v137, v138, v139
    v_cvt_pk_bf16_f32 v138, v168, v169
    v_mfma_f32_16x16x32_bf16 v[188:191], v[60:63], a[124:127], v[188:191]
    v_cvt_pk_bf16_f32 v139, v170, v171
    v_mul_f32 v140, s74, v140
    v_mfma_f32_16x16x32_bf16 v[192:195], v[40:43], a[64:67], v[192:195]
    v_mul_f32 v141, s74, v141
    v_mul_f32 v142, s74, v142
    v_mfma_f32_16x16x32_bf16 v[192:195], v[44:47], a[68:71], v[192:195]
    v_mul_f32 v143, s74, v143
    v_mul_f32 v172, s74, v172
    v_mfma_f32_16x16x32_bf16 v[196:199], v[40:43], a[72:75], v[196:199]
    v_mul_f32 v173, s74, v173
    v_mul_f32 v174, s74, v174
    v_mfma_f32_16x16x32_bf16 v[196:199], v[44:47], a[76:79], v[196:199]
    buffer_load_dwordx4 v12, s[20:23], s63 offen offset:2048 lds
    v_mfma_f32_16x16x32_bf16 v[200:203], v[40:43], a[80:83], v[200:203]
    v_mul_f32 v175, s74, v175
    v_cvt_pk_bf16_f32 v140, v140, v141
    v_mfma_f32_16x16x32_bf16 v[200:203], v[44:47], a[84:87], v[200:203]
    v_cvt_pk_bf16_f32 v141, v142, v143
    v_cvt_pk_bf16_f32 v142, v172, v173
    v_mfma_f32_16x16x32_bf16 v[204:207], v[40:43], a[88:91], v[204:207]
    v_cvt_pk_bf16_f32 v143, v174, v175
    v_mul_f32 v144, s74, v144
    v_mfma_f32_16x16x32_bf16 v[204:207], v[44:47], a[92:95], v[204:207]
    v_mul_f32 v145, s74, v145
    v_mul_f32 v146, s74, v146
    v_mfma_f32_16x16x32_bf16 v[208:211], v[40:43], a[96:99], v[208:211]
    v_mul_f32 v147, s74, v147
    v_mul_f32 v176, s74, v176
    v_mfma_f32_16x16x32_bf16 v[208:211], v[44:47], a[100:103], v[208:211]
    v_mul_f32 v177, s74, v177
    v_mul_f32 v178, s74, v178
    v_mfma_f32_16x16x32_bf16 v[212:215], v[40:43], a[104:107], v[212:215]
    buffer_load_dwordx4 v13, s[20:23], s63 offen offset:3072 lds
    v_mfma_f32_16x16x32_bf16 v[212:215], v[44:47], a[108:111], v[212:215]
    v_mul_f32 v179, s74, v179
    v_cvt_pk_bf16_f32 v144, v144, v145
    v_mfma_f32_16x16x32_bf16 v[216:219], v[40:43], a[112:115], v[216:219]
    v_cvt_pk_bf16_f32 v145, v146, v147
    v_cvt_pk_bf16_f32 v146, v176, v177
    v_mfma_f32_16x16x32_bf16 v[216:219], v[44:47], a[116:119], v[216:219]
    v_cvt_pk_bf16_f32 v147, v178, v179
    v_mul_f32 v148, s74, v148
    v_mfma_f32_16x16x32_bf16 v[220:223], v[40:43], a[120:123], v[220:223]
    v_mul_f32 v149, s74, v149
    v_mul_f32 v150, s74, v150
    v_mfma_f32_16x16x32_bf16 v[220:223], v[44:47], a[124:127], v[220:223]
    s_add_u32 s72, s70, 0
    v_mul_f32 v151, s74, v151
    v_mul_f32 v180, s74, v180
    s_waitcnt lgkmcnt(0)
    v_mfma_f32_16x16x32_bf16 v[224:227], v[48:51], a[64:67], v[224:227]
    buffer_store_dwordx4 v[128:131], v1, s[36:39], s72 offen sc1
    v_mfma_f32_16x16x32_bf16 v[224:227], v[52:55], a[68:71], v[224:227]
    s_xor_b32 s63, s63, 384
    v_mul_f32 v181, s74, v181
    v_mul_f32 v182, s74, v182
    v_mfma_f32_16x16x32_bf16 v[228:231], v[48:51], a[72:75], v[228:231]
    v_mul_f32 v183, s74, v183
    v_cvt_pk_bf16_f32 v148, v148, v149
    v_mfma_f32_16x16x32_bf16 v[228:231], v[52:55], a[76:79], v[228:231]
    v_cvt_pk_bf16_f32 v149, v150, v151
    v_cvt_pk_bf16_f32 v150, v180, v181
    v_mfma_f32_16x16x32_bf16 v[232:235], v[48:51], a[80:83], v[232:235]
    v_cvt_pk_bf16_f32 v151, v182, v183
    v_mul_f32 v152, s74, v152
    v_mfma_f32_16x16x32_bf16 v[232:235], v[52:55], a[84:87], v[232:235]
    s_add_u32 m0, s67, 98304
    v_mul_f32 v153, s74, v153
    v_mul_f32 v154, s74, v154
    s_waitcnt vmcnt(9) lgkmcnt(0)
    v_cmp_gt_u32 vcc, 8, v7
    s_nop 1
    s_and_b64 vcc, vcc, s[86:87]
    s_cbranch_scc1 SPIN_WA
BACK_WA:
    s_barrier
    v_mfma_f32_16x16x32_bf16 v[236:239], v[48:51], a[88:91], v[236:239]
    buffer_load_dwordx4 v1, s[28:31], s65 offen sc1 lds
    v_mfma_f32_16x16x32_bf16 v[236:239], v[52:55], a[92:95], v[236:239]
    ds_read_b64_tr_b16 v[56:57], v14 offset:0
    ds_read_b64_tr_b16 v[58:59], v14 offset:1024
    v_mfma_f32_16x16x32_bf16 v[240:243], v[48:51], a[96:99], v[240:243]
    ds_read_b64_tr_b16 v[60:61], v14 offset:8192
    ds_read_b64_tr_b16 v[62:63], v14 offset:9216
    v_mfma_f32_16x16x32_bf16 v[240:243], v[52:55], a[100:103], v[240:243]
    ds_read_b64_tr_b16 v[40:41], v15 offset:0
    ds_read_b64_tr_b16 v[42:43], v15 offset:1024
    v_mfma_f32_16x16x32_bf16 v[244:247], v[48:51], a[104:107], v[244:247]
    ds_read_b64_tr_b16 v[44:45], v15 offset:8192
    ds_read_b64_tr_b16 v[46:47], v15 offset:9216
    v_mfma_f32_16x16x32_bf16 v[244:247], v[52:55], a[108:111], v[244:247]
    v_mul_f32 v155, s74, v155
    v_mul_f32 v184, s74, v184
    v_mfma_f32_16x16x32_bf16 v[248:251], v[48:51], a[112:115], v[248:251]
    v_mul_f32 v185, s74, v185
    v_mul_f32 v186, s74, v186
    v_mfma_f32_16x16x32_bf16 v[248:251], v[52:55], a[116:119], v[248:251]
    v_mul_f32 v187, s74, v187
    v_cvt_pk_bf16_f32 v152, v152, v153
    v_mfma_f32_16x16x32_bf16 v[252:255], v[48:51], a[120:123], v[252:255]
    s_lshr_b32 s92, s2, 3
    buffer_load_dwordx4 v1, s[28:31], s65 offen offset:1024 sc1 lds
    v_mfma_f32_16x16x32_bf16 v[252:255], v[52:55], a[124:127], v[252:255]
    s_lshl2_add_u32 s92, s92, s4
    v_lshrrev_b32 v9, 4, v1
    v_min_u32 v9, 0, v9
    s_waitcnt lgkmcnt(0)
    v_mfma_f32_16x16x32_bf16 a[128:131], a[0:3], v[56:59], a[128:131]
    s_mul_i32 s92, s92, 1
    ds_read_b64_tr_b16 v[48:49], v16 offset:0
    ds_read_b64_tr_b16 v[50:51], v16 offset:1024
    v_mfma_f32_16x16x32_bf16 a[128:131], a[4:7], v[60:63], a[128:131]
    s_add_u32 s92, s92, 32
    v_add_lshl_u32 v9, v9, s92, 7
    ds_read_b64_tr_b16 v[52:53], v16 offset:8192
    v_mfma_f32_16x16x32_bf16 a[132:135], a[8:11], v[56:59], a[132:135]
    s_getpc_b64 s[92:93]
    global_load_dword v9, v9, s[92:93]
    v_mfma_f32_16x16x32_bf16 a[132:135], a[12:15], v[60:63], a[132:135]
    ds_read_b128 v[64:67], v24 offset:16384
    ds_read_b64_tr_b16 v[54:55], v16 offset:9216
    v_mfma_f32_16x16x32_bf16 a[136:139], a[16:19], v[56:59], a[136:139]
    v_cvt_pk_bf16_f32 v153, v154, v155
    v_cvt_pk_bf16_f32 v154, v184, v185
    v_mfma_f32_16x16x32_bf16 a[136:139], a[20:23], v[60:63], a[136:139]
    v_cvt_pk_bf16_f32 v155, v186, v187
    v_mul_f32 v156, s74, v156
    v_mfma_f32_16x16x32_bf16 a[140:143], a[24:27], v[56:59], a[140:143]
    s_add_u32 m0, s68, 106496
    v_mul_f32 v157, s74, v157
    v_mul_f32 v158, s74, v158
    v_mfma_f32_16x16x32_bf16 a[140:143], a[28:31], v[60:63], a[140:143]
    buffer_load_dwordx4 v6, s[20:23], s66 offen lds
    v_mfma_f32_16x16x32_bf16 a[144:147], a[32:35], v[56:59], a[144:147]
    s_add_u32 s72, s70, 4096
    v_mul_f32 v159, s74, v159
    v_mul_f32 v188, s74, v188
    v_mfma_f32_16x16x32_bf16 a[144:147], a[36:39], v[60:63], a[144:147]
    buffer_store_dwordx4 v[132:135], v1, s[36:39], s72 offen sc1
    v_mfma_f32_16x16x32_bf16 a[148:151], a[40:43], v[56:59], a[148:151]
    v_mul_f32 v189, s74, v189
    v_mul_f32 v190, s74, v190
    v_mfma_f32_16x16x32_bf16 a[148:151], a[44:47], v[60:63], a[148:151]
    v_mul_f32 v191, s74, v191
    v_cvt_pk_bf16_f32 v156, v156, v157
    v_mfma_f32_16x16x32_bf16 a[152:155], a[48:51], v[56:59], a[152:155]
    v_cvt_pk_bf16_f32 v157, v158, v159
    v_cvt_pk_bf16_f32 v158, v188, v189
    v_mfma_f32_16x16x32_bf16 a[152:155], a[52:55], v[60:63], a[152:155]
    ds_read_b128 v[68:71], v25 offset:16384
    v_cvt_pk_bf16_f32 v159, v190, v191
    v_mfma_f32_16x16x32_bf16 a[156:159], a[56:59], v[56:59], a[156:159]
    s_add_u32 m0, s69, 114688
    ds_read_b64_tr_b16 v[56:57], v17 offset:0
    ds_read_b64_tr_b16 v[58:59], v17 offset:1024
    v_mfma_f32_16x16x32_bf16 a[156:159], a[60:63], v[60:63], a[156:159]
    s_xor_b32 s65, s65, 8192
    buffer_load_dwordx4 v10, s[20:23], s64 offen lds
    v_mfma_f32_16x16x32_bf16 a[160:163], a[0:3], v[40:43], a[160:163]
    s_xor_b32 s66, s66, 128
    ds_read_b64_tr_b16 v[60:61], v17 offset:8192
    ds_read_b64_tr_b16 v[62:63], v17 offset:9216
    v_mfma_f32_16x16x32_bf16 a[160:163], a[4:7], v[44:47], a[160:163]
    v_mul_f32 v192, s74, v192
    v_mul_f32 v193, s74, v193
    v_mfma_f32_16x16x32_bf16 a[164:167], a[8:11], v[40:43], a[164:167]
    v_mul_f32 v194, s74, v194
    v_mul_f32 v195, s74, v195
    v_mfma_f32_16x16x32_bf16 a[164:167], a[12:15], v[44:47], a[164:167]
    v_mul_f32 v224, s74, v224
    v_mul_f32 v225, s74, v225
    v_mfma_f32_16x16x32_bf16 a[168:171], a[16:19], v[40:43], a[168:171]
    v_mul_f32 v226, s74, v226
    v_mul_f32 v227, s74, v227
    v_mfma_f32_16x16x32_bf16 a[168:171], a[20:23], v[44:47], a[168:171]
    v_cvt_pk_bf16_f32 v192, v192, v193
    v_cvt_pk_bf16_f32 v193, v194, v195
    v_mfma_f32_16x16x32_bf16 a[172:175], a[24:27], v[40:43], a[172:175]
    v_cvt_pk_bf16_f32 v194, v224, v225
    v_cvt_pk_bf16_f32 v195, v226, v227
    v_mfma_f32_16x16x32_bf16 a[172:175], a[28:31], v[44:47], a[172:175]
    v_mul_f32 v196, s74, v196
    v_mul_f32 v197, s74, v197
    v_mfma_f32_16x16x32_bf16 a[176:179], a[32:35], v[40:43], a[176:179]
    buffer_load_dwordx4 v11, s[20:23], s64 offen offset:1024 lds
    v_mfma_f32_16x16x32_bf16 a[176:179], a[36:39], v[44:47], a[176:179]
    ds_read_b128 v[72:75], v24 offset:24576
    v_mul_f32 v198, s74, v198
    v_mfma_f32_16x16x32_bf16 a[180:183], a[40:43], v[40:43], a[180:183]
    v_mul_f32 v199, s74, v199
    v_mul_f32 v228, s74, v228
    v_mfma_f32_16x16x32_bf16 a[180:183], a[44:47], v[44:47], a[180:183]
    v_mul_f32 v229, s74, v229
    v_mul_f32 v230, s74, v230
    v_mfma_f32_16x16x32_bf16 a[184:187], a[48:51], v[40:43], a[184:187]
    v_mul_f32 v231, s74, v231
    v_cvt_pk_bf16_f32 v196, v196, v197
    v_mfma_f32_16x16x32_bf16 a[184:187], a[52:55], v[44:47], a[184:187]
    v_cvt_pk_bf16_f32 v197, v198, v199
    v_cvt_pk_bf16_f32 v198, v228, v229
    v_mfma_f32_16x16x32_bf16 a[188:191], a[56:59], v[40:43], a[188:191]
    ds_read_b64_tr_b16 v[40:41], v14 offset:32768
    ds_read_b64_tr_b16 v[42:43], v14 offset:33792
    v_mfma_f32_16x16x32_bf16 a[188:191], a[60:63], v[44:47], a[188:191]
    s_waitcnt lgkmcnt(2)
    ds_read_b64_tr_b16 v[44:45], v14 offset:40960
    ds_read_b64_tr_b16 v[46:47], v14 offset:41984
    v_mfma_f32_16x16x32_bf16 a[192:195], a[0:3], v[48:51], a[192:195]
    buffer_load_dwordx4 v12, s[20:23], s64 offen offset:2048 lds
    v_mfma_f32_16x16x32_bf16 a[192:195], a[4:7], v[52:55], a[192:195]
    s_add_u32 s72, s70, 8192
    v_xor_b32 v14, s73, v14
    v_add_u32 v14, 0x10000, v14
    v_mfma_f32_16x16x32_bf16 a[196:199], a[8:11], v[48:51], a[196:199]
    buffer_store_dwordx4 v[136:139], v1, s[36:39], s72 offen sc1
    v_mfma_f32_16x16x32_bf16 a[196:199], a[12:15], v[52:55], a[196:199]
    ds_read_b128 v[76:79], v25 offset:24576
    v_cvt_pk_bf16_f32 v199, v230, v231
    v_mfma_f32_16x16x32_bf16 a[200:203], a[16:19], v[48:51], a[200:203]
    v_mul_f32 v200, s74, v200
    v_mul_f32 v201, s74, v201
    v_mfma_f32_16x16x32_bf16 a[200:203], a[20:23], v[52:55], a[200:203]
    v_mul_f32 v202, s74, v202
    v_mul_f32 v203, s74, v203
    v_mfma_f32_16x16x32_bf16 a[204:207], a[24:27], v[48:51], a[204:207]
    v_mul_f32 v232, s74, v232
    v_mul_f32 v233, s74, v233
    v_mfma_f32_16x16x32_bf16 a[204:207], a[28:31], v[52:55], a[204:207]
    v_mul_f32 v234, s74, v234
    v_mul_f32 v235, s74, v235
    v_mfma_f32_16x16x32_bf16 a[208:211], a[32:35], v[48:51], a[208:211]
    v_cvt_pk_bf16_f32 v200, v200, v201
    v_cvt_pk_bf16_f32 v201, v202, v203
    v_mfma_f32_16x16x32_bf16 a[208:211], a[36:39], v[52:55], a[208:211]
    buffer_load_dwordx4 v13, s[20:23], s64 offen offset:3072 lds
    v_mfma_f32_16x16x32_bf16 a[212:215], a[40:43], v[48:51], a[212:215]
    v_cvt_pk_bf16_f32 v202, v232, v233
    v_cvt_pk_bf16_f32 v203, v234, v235
    v_mfma_f32_16x16x32_bf16 a[212:215], a[44:47], v[52:55], a[212:215]
    v_mul_f32 v204, s74, v204
    v_mul_f32 v205, s74, v205
    v_mfma_f32_16x16x32_bf16 a[216:219], a[48:51], v[48:51], a[216:219]
    v_mul_f32 v206, s74, v206
    v_mul_f32 v207, s74, v207
    v_mfma_f32_16x16x32_bf16 a[216:219], a[52:55], v[52:55], a[216:219]
    v_mul_f32 v236, s74, v236
    v_mul_f32 v237, s74, v237
    v_mfma_f32_16x16x32_bf16 a[220:223], a[56:59], v[48:51], a[220:223]
    ds_read_b64_tr_b16 v[48:49], v15 offset:32768
    ds_read_b64_tr_b16 v[50:51], v15 offset:33792
    v_mfma_f32_16x16x32_bf16 a[220:223], a[60:63], v[52:55], a[220:223]
    ds_read_b64_tr_b16 v[52:53], v15 offset:40960
    ds_read_b64_tr_b16 v[54:55], v15 offset:41984
    v_mfma_f32_16x16x32_bf16 a[224:227], a[0:3], v[56:59], a[224:227]
    v_xor_b32 v15, s73, v15
    v_add_u32 v15, 0x10000, v15
    v_mfma_f32_16x16x32_bf16 a[224:227], a[4:7], v[60:63], a[224:227]
    s_xor_b32 s64, s64, 384
    v_accvgpr_write_b32 a4, v192
    v_accvgpr_write_b32 a5, v193
    v_mfma_f32_16x16x32_bf16 a[228:231], a[8:11], v[56:59], a[228:231]
    v_accvgpr_write_b32 a6, v194
    v_accvgpr_write_b32 a7, v195
    v_mfma_f32_16x16x32_bf16 a[228:231], a[12:15], v[60:63], a[228:231]
    v_accvgpr_write_b32 a12, v196
    v_accvgpr_write_b32 a13, v197
    v_mfma_f32_16x16x32_bf16 a[232:235], a[16:19], v[56:59], a[232:235]
    v_accvgpr_write_b32 a14, v198
    v_accvgpr_write_b32 a15, v199
    v_mfma_f32_16x16x32_bf16 a[232:235], a[20:23], v[60:63], a[232:235]
    s_add_u32 m0, s69, 131072
    v_mul_f32 v238, s74, v238
    v_mul_f32 v239, s74, v239
    v_mfma_f32_16x16x32_bf16 a[236:239], a[24:27], v[56:59], a[236:239]
    buffer_load_dwordx4 v2, s[24:27], s60 offen lds
    v_mfma_f32_16x16x32_bf16 a[236:239], a[28:31], v[60:63], a[236:239]
    v_accvgpr_write_b32 a20, v200
    v_accvgpr_write_b32 a21, v201
    v_mfma_f32_16x16x32_bf16 a[240:243], a[32:35], v[56:59], a[240:243]
    v_accvgpr_write_b32 a22, v202
    v_accvgpr_write_b32 a23, v203
    v_mfma_f32_16x16x32_bf16 a[240:243], a[36:39], v[60:63], a[240:243]
    v_cvt_pk_bf16_f32 v204, v204, v205
    v_cvt_pk_bf16_f32 v205, v206, v207
    v_mfma_f32_16x16x32_bf16 a[244:247], a[40:43], v[56:59], a[244:247]
    s_add_u32 s72, s70, 12288
    v_accvgpr_write_b32 a40, v148
    v_accvgpr_write_b32 a41, v149
    v_mfma_f32_16x16x32_bf16 a[244:247], a[44:47], v[60:63], a[244:247]
    buffer_store_dwordx4 v[140:143], v1, s[36:39], s72 offen sc1
    v_mfma_f32_16x16x32_bf16 a[248:251], a[48:51], v[56:59], a[248:251]
    v_accvgpr_write_b32 a42, v150
    v_accvgpr_write_b32 a43, v151
    v_mfma_f32_16x16x32_bf16 a[248:251], a[52:55], v[60:63], a[248:251]
    buffer_load_dwordx4 v3, s[24:27], s60 offen offset:1024 lds
    v_mfma_f32_16x16x32_bf16 a[252:255], a[56:59], v[56:59], a[252:255]
    ds_read_b64_tr_b16 v[56:57], v16 offset:32768
    ds_read_b64_tr_b16 v[58:59], v16 offset:33792
    v_mfma_f32_16x16x32_bf16 a[252:255], a[60:63], v[60:63], a[252:255]
    s_waitcnt lgkmcnt(2)
    ds_read_b64_tr_b16 v[60:61], v16 offset:40960
    ds_read_b64_tr_b16 v[62:63], v16 offset:41984
    v_mfma_f32_16x16x32_bf16 a[128:131], a[64:67], v[40:43], a[128:131]
    v_xor_b32 v16, s73, v16
    v_add_u32 v16, 0x10000, v16
    v_mfma_f32_16x16x32_bf16 a[128:131], a[68:71], v[44:47], a[128:131]
    v_accvgpr_write_b32 a48, v152
    v_accvgpr_write_b32 a49, v153
    v_mfma_f32_16x16x32_bf16 a[132:135], a[72:75], v[40:43], a[132:135]
    ds_read_b128 v[80:83], v24 offset:49152
    v_accvgpr_write_b32 a50, v154
    v_mfma_f32_16x16x32_bf16 a[132:135], a[76:79], v[44:47], a[132:135]
    v_accvgpr_write_b32 a51, v155
    v_accvgpr_write_b32 a56, v156
    v_mfma_f32_16x16x32_bf16 a[136:139], a[80:83], v[40:43], a[136:139]
    v_accvgpr_write_b32 a57, v157
    v_accvgpr_write_b32 a58, v158
    v_mfma_f32_16x16x32_bf16 a[136:139], a[84:87], v[44:47], a[136:139]
    buffer_load_dwordx4 v4, s[24:27], s60 offen offset:2048 lds
    v_mfma_f32_16x16x32_bf16 a[140:143], a[88:91], v[40:43], a[140:143]
    v_accvgpr_write_b32 a59, v159
    v_cvt_pk_bf16_f32 v206, v236, v237
    v_mfma_f32_16x16x32_bf16 a[140:143], a[92:95], v[44:47], a[140:143]
    v_cvt_pk_bf16_f32 v207, v238, v239
    v_mul_f32 v208, s74, v208
    v_mfma_f32_16x16x32_bf16 a[144:147], a[96:99], v[40:43], a[144:147]
    v_mul_f32 v209, s74, v209
    v_mul_f32 v210, s74, v210
    v_mfma_f32_16x16x32_bf16 a[144:147], a[100:103], v[44:47], a[144:147]
    v_mul_f32 v211, s74, v211
    v_mul_f32 v240, s74, v240
    v_mfma_f32_16x16x32_bf16 a[148:151], a[104:107], v[40:43], a[148:151]
    v_mul_f32 v241, s74, v241
    v_mul_f32 v242, s74, v242
    v_mfma_f32_16x16x32_bf16 a[148:151], a[108:111], v[44:47], a[148:151]
    v_mul_f32 v243, s74, v243
    v_accvgpr_write_b32 a28, v204
    v_mfma_f32_16x16x32_bf16 a[152:155], a[112:115], v[40:43], a[152:155]
    buffer_load_dwordx4 v5, s[24:27], s60 offen offset:3072 lds
    v_mfma_f32_16x16x32_bf16 a[152:155], a[116:119], v[44:47], a[152:155]
    ds_read_b128 v[84:87], v25 offset:49152
    v_accvgpr_write_b32 a29, v205
    v_mfma_f32_16x16x32_bf16 a[156:159], a[120:123], v[40:43], a[156:159]
    ds_read_b64_tr_b16 v[40:41], v17 offset:32768
    ds_read_b64_tr_b16 v[42:43], v17 offset:33792
    v_mfma_f32_16x16x32_bf16 a[156:159], a[124:127], v[44:47], a[156:159]
    ds_read_b64_tr_b16 v[44:45], v17 offset:40960
    ds_read_b64_tr_b16 v[46:47], v17 offset:41984
    v_mfma_f32_16x16x32_bf16 a[160:163], a[64:67], v[48:51], a[160:163]
    v_xor_b32 v17, s73, v17
    v_add_u32 v17, 0x10000, v17
    v_mfma_f32_16x16x32_bf16 a[160:163], a[68:71], v[52:55], a[160:163]
    v_accvgpr_write_b32 a30, v206
    v_accvgpr_write_b32 a31, v207
    v_mfma_f32_16x16x32_bf16 a[164:167], a[72:75], v[48:51], a[164:167]
    v_cvt_pk_bf16_f32 v208, v208, v209
    v_cvt_pk_bf16_f32 v209, v210, v211
    v_mfma_f32_16x16x32_bf16 a[164:167], a[76:79], v[52:55], a[164:167]
    s_add_u32 m0, s69, 147456
    v_cvt_pk_bf16_f32 v210, v240, v241
    v_cvt_pk_bf16_f32 v211, v242, v243
    v_mfma_f32_16x16x32_bf16 a[168:171], a[80:83], v[48:51], a[168:171]
    s_xor_b32 s60, s60, 1572864
    buffer_load_dwordx4 v10, s[20:23], s63 offen lds
    v_mfma_f32_16x16x32_bf16 a[168:171], a[84:87], v[52:55], a[168:171]
    s_add_u32 s72, s70, 32768
    buffer_store_dwordx4 v[144:147], v1, s[36:39], s72 offen sc1
    v_mfma_f32_16x16x32_bf16 a[172:175], a[88:91], v[48:51], a[172:175]
    v_mul_f32 v212, s74, v212
    v_mul_f32 v213, s74, v213
    v_mfma_f32_16x16x32_bf16 a[172:175], a[92:95], v[52:55], a[172:175]
    v_mul_f32 v214, s74, v214
    v_mul_f32 v215, s74, v215
    v_mfma_f32_16x16x32_bf16 a[176:179], a[96:99], v[48:51], a[176:179]
    ds_read_b128 v[88:91], v24 offset:57344
    v_mul_f32 v244, s74, v244
    v_mfma_f32_16x16x32_bf16 a[176:179], a[100:103], v[52:55], a[176:179]
    v_mul_f32 v245, s74, v245
    v_mul_f32 v246, s74, v246
    v_mfma_f32_16x16x32_bf16 a[180:183], a[104:107], v[48:51], a[180:183]
    v_mul_f32 v247, s74, v247
    v_accvgpr_write_b32 a36, v208
    v_mfma_f32_16x16x32_bf16 a[180:183], a[108:111], v[52:55], a[180:183]
    buffer_load_dwordx4 v11, s[20:23], s63 offen offset:1024 lds
    v_mfma_f32_16x16x32_bf16 a[184:187], a[112:115], v[48:51], a[184:187]
    v_accvgpr_write_b32 a37, v209
    v_accvgpr_write_b32 a38, v210
    v_mfma_f32_16x16x32_bf16 a[184:187], a[116:119], v[52:55], a[184:187]
    v_accvgpr_write_b32 a39, v211
    v_cvt_pk_bf16_f32 v212, v212, v213
    v_mfma_f32_16x16x32_bf16 a[188:191], a[120:123], v[48:51], a[188:191]
    v_cvt_pk_bf16_f32 v213, v214, v215
    v_cvt_pk_bf16_f32 v214, v244, v245
    v_mfma_f32_16x16x32_bf16 a[188:191], a[124:127], v[52:55], a[188:191]
    s_waitcnt lgkmcnt(0)
    v_cvt_pk_bf16_f32 v215, v246, v247
    v_mul_f32 v216, s74, v216
    v_mfma_f32_16x16x32_bf16 a[192:195], a[64:67], v[56:59], a[192:195]
    v_mul_f32 v217, s74, v217
    v_mul_f32 v218, s74, v218
    v_mfma_f32_16x16x32_bf16 a[192:195], a[68:71], v[60:63], a[192:195]
    v_accvgpr_read_b32 v32, a128
    v_accvgpr_read_b32 v31, a129
    v_mfma_f32_16x16x32_bf16 a[196:199], a[72:75], v[56:59], a[196:199]
    v_cvt_pk_bf16_f32 v32, v32, v31
    v_accvgpr_read_b32 v33, a130
    v_mfma_f32_16x16x32_bf16 a[196:199], a[76:79], v[60:63], a[196:199]
    buffer_load_dwordx4 v12, s[20:23], s63 offen offset:2048 lds
    v_mfma_f32_16x16x32_bf16 a[200:203], a[80:83], v[56:59], a[200:203]
    ds_read_b128 v[92:95], v25 offset:57344
    v_accvgpr_read_b32 v31, a131
    v_mfma_f32_16x16x32_bf16 a[200:203], a[84:87], v[60:63], a[200:203]
    v_cvt_pk_bf16_f32 v33, v33, v31
    v_accvgpr_read_b32 v34, a132
    v_mfma_f32_16x16x32_bf16 a[204:207], a[88:91], v[56:59], a[204:207]
    v_accvgpr_read_b32 v31, a133
    v_cvt_pk_bf16_f32 v34, v34, v31
    v_mfma_f32_16x16x32_bf16 a[204:207], a[92:95], v[60:63], a[204:207]
    v_accvgpr_read_b32 v35, a134
    v_accvgpr_read_b32 v31, a135
    v_mfma_f32_16x16x32_bf16 a[208:211], a[96:99], v[56:59], a[208:211]
    v_cvt_pk_bf16_f32 v35, v35, v31
    v_mul_f32 v219, s74, v219
    v_mfma_f32_16x16x32_bf16 a[208:211], a[100:103], v[60:63], a[208:211]
    v_mul_f32 v248, s74, v248
    v_mul_f32 v249, s74, v249
    v_mfma_f32_16x16x32_bf16 a[212:215], a[104:107], v[56:59], a[212:215]
    buffer_load_dwordx4 v13, s[20:23], s63 offen offset:3072 lds
    v_mfma_f32_16x16x32_bf16 a[212:215], a[108:111], v[60:63], a[212:215]
    v_mul_f32 v250, s74, v250
    v_mul_f32 v251, s74, v251
    v_mfma_f32_16x16x32_bf16 a[216:219], a[112:115], v[56:59], a[216:219]
    s_add_u32 s72, s71, 0
    v_accvgpr_write_b32 a44, v212
    v_accvgpr_write_b32 a45, v213
    v_mfma_f32_16x16x32_bf16 a[216:219], a[116:119], v[60:63], a[216:219]
    buffer_store_dwordx4 v[32:35], v1, s[36:39], s72 offen sc1
    v_mfma_f32_16x16x32_bf16 a[220:223], a[120:123], v[56:59], a[220:223]
    v_accvgpr_write_b32 a46, v214
    v_accvgpr_write_b32 a47, v215
    v_mfma_f32_16x16x32_bf16 a[220:223], a[124:127], v[60:63], a[220:223]
    v_cvt_pk_bf16_f32 v216, v216, v217
    v_cvt_pk_bf16_f32 v217, v218, v219
    v_mfma_f32_16x16x32_bf16 a[224:227], a[64:67], v[40:43], a[224:227]
    v_cvt_pk_bf16_f32 v218, v248, v249
    v_cvt_pk_bf16_f32 v219, v250, v251
    v_mfma_f32_16x16x32_bf16 a[224:227], a[68:71], v[44:47], a[224:227]
    s_xor_b32 s63, s63, 128
    v_mul_f32 v220, s74, v220
    v_mul_f32 v221, s74, v221
    v_mfma_f32_16x16x32_bf16 a[228:231], a[72:75], v[40:43], a[228:231]
    v_mul_f32 v222, s74, v222
    v_mul_f32 v223, s74, v223
    v_mfma_f32_16x16x32_bf16 a[228:231], a[76:79], v[44:47], a[228:231]
    v_mul_f32 v252, s74, v252
    v_mul_f32 v253, s74, v253
    v_mfma_f32_16x16x32_bf16 a[232:235], a[80:83], v[40:43], a[232:235]
    v_mul_f32 v254, s74, v254
    v_mul_f32 v255, s74, v255
    v_mfma_f32_16x16x32_bf16 a[232:235], a[84:87], v[44:47], a[232:235]
    s_waitcnt vmcnt(11) lgkmcnt(0)
    s_barrier
    ds_read_b64_tr_b16 v[48:49], v14 offset:0
    v_mfma_f32_16x16x32_bf16 a[236:239], a[88:91], v[40:43], a[236:239]
    s_add_u32 m0, s67, 0
    ds_read_b64_tr_b16 v[50:51], v14 offset:1024
    ds_read_b64_tr_b16 v[52:53], v14 offset:8192
    v_mfma_f32_16x16x32_bf16 a[236:239], a[92:95], v[44:47], a[236:239]
    buffer_load_dwordx4 v1, s[28:31], s65 offen sc1 lds
    v_mfma_f32_16x16x32_bf16 a[240:243], a[96:99], v[40:43], a[240:243]
    ds_read_b64_tr_b16 v[54:55], v14 offset:9216
    ds_read_b64_tr_b16 v[56:57], v15 offset:0
    v_mfma_f32_16x16x32_bf16 a[240:243], a[100:103], v[44:47], a[240:243]
    ds_read_b64_tr_b16 v[58:59], v15 offset:1024
    ds_read_b64_tr_b16 v[60:61], v15 offset:8192
    v_mfma_f32_16x16x32_bf16 a[244:247], a[104:107], v[40:43], a[244:247]
    ds_read_b64_tr_b16 v[62:63], v15 offset:9216
    v_add_u32 v14, 0x10000, v14
    v_mfma_f32_16x16x32_bf16 a[244:247], a[108:111], v[44:47], a[244:247]
    v_add_u32 v15, 0x10000, v15
    v_accvgpr_read_b32 v32, a136
    v_mfma_f32_16x16x32_bf16 a[248:251], a[112:115], v[40:43], a[248:251]
    v_accvgpr_read_b32 v31, a137
    v_cvt_pk_bf16_f32 v32, v32, v31
    v_mfma_f32_16x16x32_bf16 a[248:251], a[116:119], v[44:47], a[248:251]
    v_accvgpr_read_b32 v33, a138
    v_accvgpr_read_b32 v31, a139
    v_mfma_f32_16x16x32_bf16 a[252:255], a[120:123], v[40:43], a[252:255]
    buffer_load_dwordx4 v1, s[28:31], s65 offen offset:1024 sc1 lds
    v_mfma_f32_16x16x32_bf16 a[252:255], a[124:127], v[44:47], a[252:255]
    s_waitcnt lgkmcnt(0)
    ds_read_b64_tr_b16 v[40:41], v16 offset:0
    ds_read_b64_tr_b16 v[42:43], v16 offset:1024
    v_mfma_f32_16x16x32_bf16 v[128:131], v[48:51], v[64:67], 0
    ds_read_b64_tr_b16 v[44:45], v16 offset:8192
    ds_read_b64_tr_b16 v[46:47], v16 offset:9216
    v_mfma_f32_16x16x32_bf16 v[128:131], v[52:55], v[68:71], v[128:131]
    v_add_u32 v24, 0x10000, v24
    ds_read_b128 a[136:139], v22 offset:32768
    v_mfma_f32_16x16x32_bf16 v[132:135], v[48:51], v[72:75], 0
    ds_read_b128 v[96:99], v24 offset:16384
    v_add_u32 v16, 0x10000, v16
    v_mfma_f32_16x16x32_bf16 v[132:135], v[52:55], v[76:79], v[132:135]
    v_add_u32 v22, 0xffff0000, v22
    v_cvt_pk_bf16_f32 v33, v33, v31
    v_mfma_f32_16x16x32_bf16 v[136:139], v[48:51], v[80:83], 0
    v_accvgpr_read_b32 v34, a140
    v_accvgpr_read_b32 v31, a141
    v_mfma_f32_16x16x32_bf16 v[136:139], v[52:55], v[84:87], v[136:139]
    s_add_u32 s72, s71, 1024
    v_cvt_pk_bf16_f32 v34, v34, v31
    v_accvgpr_read_b32 v35, a142
    v_mfma_f32_16x16x32_bf16 v[140:143], v[48:51], v[88:91], 0
    s_add_u32 m0, s68, 8192
    ds_read_b64_tr_b16 v[48:49], v17 offset:0
    ds_read_b64_tr_b16 v[50:51], v17 offset:1024
    v_mfma_f32_16x16x32_bf16 v[140:143], v[52:55], v[92:95], v[140:143]
    buffer_load_dwordx4 v6, s[20:23], s66 offen lds
    v_mfma_f32_16x16x32_bf16 v[144:147], v[56:59], v[64:67], 0
    ds_read_b64_tr_b16 v[52:53], v17 offset:8192
    ds_read_b64_tr_b16 v[54:55], v17 offset:9216
    v_mfma_f32_16x16x32_bf16 v[144:147], v[60:63], v[68:71], v[144:147]
    v_add_u32 v17, 0x10000, v17
    v_accvgpr_read_b32 v31, a143
    v_mfma_f32_16x16x32_bf16 v[148:151], v[56:59], v[72:75], 0
    ds_read_b128 a[140:143], v23 offset:32768
    v_add_u32 v23, 0xffff0000, v23
    v_mfma_f32_16x16x32_bf16 v[148:151], v[60:63], v[76:79], v[148:151]
    v_cvt_pk_bf16_f32 v35, v35, v31
    v_accvgpr_write_b32 a52, v216
    v_mfma_f32_16x16x32_bf16 v[152:155], v[56:59], v[80:83], 0
    v_add_u32 v25, 0x10000, v25
    v_accvgpr_write_b32 a53, v217
    v_mfma_f32_16x16x32_bf16 v[152:155], v[60:63], v[84:87], v[152:155]
    ds_read_b128 v[100:103], v25 offset:16384
    v_accvgpr_write_b32 a54, v218
    v_mfma_f32_16x16x32_bf16 v[156:159], v[56:59], v[88:91], 0
    s_add_u32 m0, s69, 16384
    ds_read_b64_tr_b16 v[56:57], v18 offset:0
    ds_read_b64_tr_b16 v[58:59], v18 offset:1024
    v_mfma_f32_16x16x32_bf16 v[156:159], v[60:63], v[92:95], v[156:159]
    s_xor_b32 s65, s65, 24576
    buffer_load_dwordx4 v10, s[20:23], s64 offen lds
    s_waitcnt lgkmcnt(3)
    v_mfma_f32_16x16x32_bf16 v[160:163], v[40:43], v[64:67], 0
    s_xor_b32 s66, s66, 384
    ds_read_b64_tr_b16 v[60:61], v18 offset:8192
    ds_read_b64_tr_b16 v[62:63], v18 offset:9216
    v_mfma_f32_16x16x32_bf16 v[160:163], v[44:47], v[68:71], v[160:163]
    v_add_u32 v18, 0x10000, v18
    v_accvgpr_write_b32 a55, v219
    v_mfma_f32_16x16x32_bf16 v[164:167], v[40:43], v[72:75], 0
    buffer_store_dwordx4 v[32:35], v1, s[36:39], s72 offen sc1
    v_mfma_f32_16x16x32_bf16 v[164:167], v[44:47], v[76:79], v[164:167]
    v_cvt_pk_bf16_f32 v220, v220, v221
    v_cvt_pk_bf16_f32 v221, v222, v223
    v_mfma_f32_16x16x32_bf16 v[168:171], v[40:43], v[80:83], 0
    v_cvt_pk_bf16_f32 v222, v252, v253
    v_cvt_pk_bf16_f32 v223, v254, v255
    v_mfma_f32_16x16x32_bf16 v[168:171], v[44:47], v[84:87], v[168:171]
    v_accvgpr_write_b32 a60, v220
    v_accvgpr_write_b32 a61, v221
    v_mfma_f32_16x16x32_bf16 v[172:175], v[40:43], v[88:91], 0
    ds_read_b64_tr_b16 v[40:41], v19 offset:0
    ds_read_b64_tr_b16 v[42:43], v19 offset:1024
    v_mfma_f32_16x16x32_bf16 v[172:175], v[44:47], v[92:95], v[172:175]
    ds_read_b64_tr_b16 v[44:45], v19 offset:8192
    ds_read_b64_tr_b16 v[46:47], v19 offset:9216
    v_mfma_f32_16x16x32_bf16 v[176:179], v[48:51], v[64:67], 0
    buffer_load_dwordx4 v11, s[20:23], s64 offen offset:1024 lds
    v_mfma_f32_16x16x32_bf16 v[176:179], v[52:55], v[68:71], v[176:179]
    ds_read_b128 v[104:107], v24 offset:24576
    v_add_u32 v19, 0x10000, v19
    v_mfma_f32_16x16x32_bf16 v[180:183], v[48:51], v[72:75], 0
    v_accvgpr_write_b32 a62, v222
    v_accvgpr_write_b32 a63, v223
    v_mfma_f32_16x16x32_bf16 v[180:183], v[52:55], v[76:79], v[180:183]
    v_accvgpr_write_b32 a0, 0
    v_accvgpr_write_b32 a1, 0
    v_mfma_f32_16x16x32_bf16 v[184:187], v[48:51], v[80:83], 0
    v_accvgpr_write_b32 a2, 0
    v_accvgpr_write_b32 a3, 0
    v_mfma_f32_16x16x32_bf16 v[184:187], v[52:55], v[84:87], v[184:187]
    v_accvgpr_write_b32 a8, 0
    v_accvgpr_write_b32 a9, 0
    v_mfma_f32_16x16x32_bf16 v[188:191], v[48:51], v[88:91], 0
    s_add_u32 s72, s70, 36864
    ds_read_b64_tr_b16 v[48:49], v20 offset:0
    ds_read_b64_tr_b16 v[50:51], v20 offset:1024
    v_mfma_f32_16x16x32_bf16 v[188:191], v[52:55], v[92:95], v[188:191]
    s_waitcnt lgkmcnt(2)
    ds_read_b64_tr_b16 v[52:53], v20 offset:8192
    ds_read_b64_tr_b16 v[54:55], v20 offset:9216
    v_mfma_f32_16x16x32_bf16 v[192:195], v[56:59], v[64:67], 0
    buffer_load_dwordx4 v12, s[20:23], s64 offen offset:2048 lds
    v_mfma_f32_16x16x32_bf16 v[192:195], v[60:63], v[68:71], v[192:195]
    v_add_u32 v20, 0x10000, v20
    v_accvgpr_write_b32 a10, 0
    v_mfma_f32_16x16x32_bf16 v[196:199], v[56:59], v[72:75], 0
    buffer_store_dwordx4 a[40:43], v1, s[36:39], s72 offen sc1
    v_mfma_f32_16x16x32_bf16 v[196:199], v[60:63], v[76:79], v[196:199]
    ds_read_b128 v[108:111], v25 offset:24576
    v_accvgpr_write_b32 a11, 0
    v_mfma_f32_16x16x32_bf16 v[200:203], v[56:59], v[80:83], 0
    v_accvgpr_write_b32 a16, 0
    v_accvgpr_write_b32 a17, 0
    v_mfma_f32_16x16x32_bf16 v[200:203], v[60:63], v[84:87], v[200:203]
    v_accvgpr_write_b32 a18, 0
    v_accvgpr_write_b32 a19, 0
    v_mfma_f32_16x16x32_bf16 v[204:207], v[56:59], v[88:91], 0
    ds_read_b64_tr_b16 v[56:57], v21 offset:0
    ds_read_b64_tr_b16 v[58:59], v21 offset:1024
    v_mfma_f32_16x16x32_bf16 v[204:207], v[60:63], v[92:95], v[204:207]
    ds_read_b64_tr_b16 v[60:61], v21 offset:8192
    ds_read_b64_tr_b16 v[62:63], v21 offset:9216
    v_mfma_f32_16x16x32_bf16 v[208:211], v[40:43], v[64:67], 0
    v_add_u32 v21, 0x10000, v21
    v_accvgpr_write_b32 a24, 0
    v_mfma_f32_16x16x32_bf16 v[208:211], v[44:47], v[68:71], v[208:211]
    buffer_load_dwordx4 v13, s[20:23], s64 offen offset:3072 lds
    v_mfma_f32_16x16x32_bf16 v[212:215], v[40:43], v[72:75], 0
    v_accvgpr_write_b32 a25, 0
    v_accvgpr_write_b32 a26, 0
    v_mfma_f32_16x16x32_bf16 v[212:215], v[44:47], v[76:79], v[212:215]
    v_accvgpr_write_b32 a27, 0
    v_accvgpr_write_b32 a32, 0
    v_mfma_f32_16x16x32_bf16 v[216:219], v[40:43], v[80:83], 0
    v_accvgpr_write_b32 a33, 0
    v_accvgpr_write_b32 a34, 0
    v_mfma_f32_16x16x32_bf16 v[216:219], v[44:47], v[84:87], v[216:219]
    v_accvgpr_write_b32 a35, 0
    v_accvgpr_write_b32 a40, 0
    v_mfma_f32_16x16x32_bf16 v[220:223], v[40:43], v[88:91], 0
    ds_read_b64_tr_b16 v[40:41], v26 offset:32768
    ds_read_b64_tr_b16 v[42:43], v26 offset:33280
    v_mfma_f32_16x16x32_bf16 v[220:223], v[44:47], v[92:95], v[220:223]
    s_waitcnt lgkmcnt(2)
    ds_read_b64_tr_b16 v[44:45], v26 offset:36864
    ds_read_b64_tr_b16 v[46:47], v26 offset:37376
    v_mfma_f32_16x16x32_bf16 v[224:227], v[48:51], v[64:67], 0
    v_add_u32 v26, 0xffff0000, v26
    v_accvgpr_write_b32 a41, 0
    v_mfma_f32_16x16x32_bf16 v[224:227], v[52:55], v[68:71], v[224:227]
    s_xor_b32 s64, s64, 128
    v_accvgpr_write_b32 a42, 0
    v_accvgpr_write_b32 a43, 0
    v_mfma_f32_16x16x32_bf16 v[228:231], v[48:51], v[72:75], 0
    v_mfma_f32_16x16x32_bf16 v[228:231], v[52:55], v[76:79], v[228:231]
    v_mfma_f32_16x16x32_bf16 v[232:235], v[48:51], v[80:83], 0
    v_mfma_f32_16x16x32_bf16 v[232:235], v[52:55], v[84:87], v[232:235]
    s_add_u32 m0, s69, 32768
    v_mfma_f32_16x16x32_bf16 v[236:239], v[48:51], v[88:91], 0
    buffer_load_dwordx4 v2, s[24:27], s60 offen lds
    v_mfma_f32_16x16x32_bf16 v[236:239], v[52:55], v[92:95], v[236:239]
    s_add_u32 s72, s70, 40960
    ds_read_b64_tr_b16 v[48:49], v27 offset:32768
    ds_read_b64_tr_b16 v[50:51], v27 offset:33280
    v_mfma_f32_16x16x32_bf16 v[240:243], v[56:59], v[64:67], 0
    ds_read_b64_tr_b16 v[52:53], v27 offset:36864
    ds_read_b64_tr_b16 v[54:55], v27 offset:37376
    v_mfma_f32_16x16x32_bf16 v[240:243], v[60:63], v[68:71], v[240:243]
    buffer_store_dwordx4 a[48:51], v1, s[36:39], s72 offen sc1
    v_mfma_f32_16x16x32_bf16 v[244:247], v[56:59], v[72:75], 0
    buffer_load_dwordx4 v3, s[24:27], s60 offen offset:1024 lds
    v_mfma_f32_16x16x32_bf16 v[244:247], v[60:63], v[76:79], v[244:247]
    v_add_u32 v27, 0xffff0000, v27
    v_accvgpr_write_b32 a48, 0
    v_mfma_f32_16x16x32_bf16 v[248:251], v[56:59], v[80:83], 0
    v_accvgpr_write_b32 a49, 0
    v_accvgpr_write_b32 a50, 0
    v_mfma_f32_16x16x32_bf16 v[248:251], v[60:63], v[84:87], v[248:251]
    v_accvgpr_write_b32 a51, 0
    v_mfma_f32_16x16x32_bf16 v[252:255], v[56:59], v[88:91], 0
    buffer_load_dwordx4 v4, s[24:27], s60 offen offset:2048 lds
    v_mfma_f32_16x16x32_bf16 v[252:255], v[60:63], v[92:95], v[252:255]
    s_waitcnt lgkmcnt(0)
    ds_read_b64_tr_b16 v[56:57], v28 offset:32768
    ds_read_b64_tr_b16 v[58:59], v28 offset:33280
    v_mfma_f32_16x16x32_bf16 a[64:67], v[40:43], v[64:67], 0
    ds_read_b64_tr_b16 v[60:61], v28 offset:36864
    ds_read_b64_tr_b16 v[62:63], v28 offset:37376
    v_mfma_f32_16x16x32_bf16 a[64:67], v[44:47], v[68:71], a[64:67]
    v_add_u32 v28, 0xffff0000, v28
    v_mfma_f32_16x16x32_bf16 a[68:71], v[40:43], v[72:75], 0
    buffer_load_dwordx4 v5, s[24:27], s60 offen offset:3072 lds
    v_mfma_f32_16x16x32_bf16 a[68:71], v[44:47], v[76:79], a[68:71]
    ds_read_b128 v[112:115], v24 offset:49152
    v_mfma_f32_16x16x32_bf16 a[72:75], v[40:43], v[80:83], 0
    v_mfma_f32_16x16x32_bf16 a[72:75], v[44:47], v[84:87], a[72:75]
    s_add_u32 m0, s69, 49152
    v_mfma_f32_16x16x32_bf16 a[76:79], v[40:43], v[88:91], 0
    s_xor_b32 s60, s60, 524288
    buffer_load_dwordx4 v10, s[20:23], s63 offen lds
    v_mfma_f32_16x16x32_bf16 a[76:79], v[44:47], v[92:95], a[76:79]
    ds_read_b128 v[116:119], v25 offset:49152
    v_mfma_f32_16x16x32_bf16 a[128:131], v[40:43], a[136:139], 0
    ds_read_b64_tr_b16 v[40:41], v29 offset:32768
    ds_read_b64_tr_b16 v[42:43], v29 offset:33280
    v_mfma_f32_16x16x32_bf16 a[128:131], v[44:47], a[140:143], a[128:131]
    ds_read_b64_tr_b16 v[44:45], v29 offset:36864
    ds_read_b64_tr_b16 v[46:47], v29 offset:37376
    v_mfma_f32_16x16x32_bf16 a[80:83], v[48:51], v[64:67], 0
    buffer_load_dwordx4 v11, s[20:23], s63 offen offset:1024 lds
    v_mfma_f32_16x16x32_bf16 a[80:83], v[52:55], v[68:71], a[80:83]
    ds_read_b128 v[120:123], v24 offset:57344
    v_add_u32 v29, 0xffff0000, v29
    v_mfma_f32_16x16x32_bf16 a[84:87], v[48:51], v[72:75], 0
    v_mfma_f32_16x16x32_bf16 a[84:87], v[52:55], v[76:79], a[84:87]
    v_mfma_f32_16x16x32_bf16 a[88:91], v[48:51], v[80:83], 0
    buffer_load_dwordx4 v12, s[20:23], s63 offen offset:2048 lds
    v_mfma_f32_16x16x32_bf16 a[88:91], v[52:55], v[84:87], a[88:91]
    ds_read_b128 v[124:127], v25 offset:57344
    v_mfma_f32_16x16x32_bf16 a[92:95], v[48:51], v[88:91], 0
    s_add_u32 s72, s70, 45056
    v_mfma_f32_16x16x32_bf16 a[92:95], v[52:55], v[92:95], a[92:95]
    v_mfma_f32_16x16x32_bf16 a[132:135], v[48:51], a[136:139], 0
    buffer_load_dwordx4 v13, s[20:23], s63 offen offset:3072 lds
    v_mfma_f32_16x16x32_bf16 a[132:135], v[52:55], a[140:143], a[132:135]
    s_waitcnt lgkmcnt(1)
    v_mfma_f32_16x16x32_bf16 a[96:99], v[56:59], v[64:67], 0
    v_mfma_f32_16x16x32_bf16 a[96:99], v[60:63], v[68:71], a[96:99]
    s_xor_b32 s63, s63, 896
    v_mfma_f32_16x16x32_bf16 a[100:103], v[56:59], v[72:75], 0
    buffer_store_dwordx4 a[56:59], v1, s[36:39], s72 offen sc1
    v_mfma_f32_16x16x32_bf16 a[100:103], v[60:63], v[76:79], a[100:103]
    v_mfma_f32_16x16x32_bf16 a[104:107], v[56:59], v[80:83], 0
    v_accvgpr_write_b32 a56, 0
    v_accvgpr_write_b32 a57, 0
    v_mfma_f32_16x16x32_bf16 a[104:107], v[60:63], v[84:87], a[104:107]
    s_waitcnt vmcnt(10) lgkmcnt(0)
    s_barrier
    ds_read_b64_tr_b16 v[48:49], v14 offset:0
    v_mfma_f32_16x16x32_bf16 a[108:111], v[56:59], v[88:91], 0
    s_add_u32 m0, s67, 65536
    ds_read_b64_tr_b16 v[50:51], v14 offset:1024
    ds_read_b64_tr_b16 v[52:53], v14 offset:8192
    v_mfma_f32_16x16x32_bf16 a[108:111], v[60:63], v[92:95], a[108:111]
    buffer_load_dwordx4 v1, s[28:31], s65 offen sc1 lds
    v_mfma_f32_16x16x32_bf16 a[112:115], v[40:43], v[64:67], 0
    ds_read_b64_tr_b16 v[54:55], v14 offset:9216
    ds_read_b64_tr_b16 v[56:57], v15 offset:0
    v_mfma_f32_16x16x32_bf16 a[112:115], v[44:47], v[68:71], a[112:115]
    ds_read_b64_tr_b16 v[58:59], v15 offset:1024
    ds_read_b64_tr_b16 v[60:61], v15 offset:8192
    v_mfma_f32_16x16x32_bf16 a[116:119], v[40:43], v[72:75], 0
    ds_read_b64_tr_b16 v[62:63], v15 offset:9216
    ds_read_b128 a[136:139], v22 offset:0
    v_mfma_f32_16x16x32_bf16 a[116:119], v[44:47], v[76:79], a[116:119]
    ds_read_b128 a[140:143], v23 offset:0
    v_add_u32 v14, 0xfffe0000, v14
    v_mfma_f32_16x16x32_bf16 a[120:123], v[40:43], v[80:83], 0
    v_add_u32 v15, 0xfffe0000, v15
    v_add_u32 v22, 0x10000, v22
    v_mfma_f32_16x16x32_bf16 a[120:123], v[44:47], v[84:87], a[120:123]
    v_add_u32 v23, 0x10000, v23
    v_accvgpr_write_b32 a58, 0
    v_mfma_f32_16x16x32_bf16 a[124:127], v[40:43], v[88:91], 0
    buffer_load_dwordx4 v1, s[28:31], s65 offen offset:1024 sc1 lds
    v_mfma_f32_16x16x32_bf16 a[124:127], v[44:47], v[92:95], a[124:127]
    s_waitcnt lgkmcnt(1)
    ds_read_b64_tr_b16 v[40:41], v16 offset:0
    ds_read_b64_tr_b16 v[42:43], v16 offset:1024
    v_mfma_f32_16x16x32_bf16 v[128:131], v[48:51], v[96:99], v[128:131]
    ds_read_b64_tr_b16 v[44:45], v16 offset:8192
    ds_read_b64_tr_b16 v[46:47], v16 offset:9216
    v_mfma_f32_16x16x32_bf16 v[128:131], v[52:55], v[100:103], v[128:131]
    v_add_u32 v24, 0x10000, v24
    v_add_u32 v16, 0xfffe0000, v16
    v_mfma_f32_16x16x32_bf16 v[132:135], v[48:51], v[104:107], v[132:135]
    ds_read_b128 v[64:67], v24 offset:16384
    v_accvgpr_write_b32 a59, 0
    v_mfma_f32_16x16x32_bf16 v[132:135], v[52:55], v[108:111], v[132:135]
    v_mfma_f32_16x16x32_bf16 v[136:139], v[48:51], v[112:115], v[136:139]
    v_mfma_f32_16x16x32_bf16 v[136:139], v[52:55], v[116:119], v[136:139]
    s_add_u32 s72, s70, 1024
    v_mfma_f32_16x16x32_bf16 v[140:143], v[48:51], v[120:123], v[140:143]
    s_add_u32 m0, s68, 73728
    ds_read_b64_tr_b16 v[48:49], v17 offset:0
    ds_read_b64_tr_b16 v[50:51], v17 offset:1024
    v_mfma_f32_16x16x32_bf16 v[140:143], v[52:55], v[124:127], v[140:143]
    buffer_load_dwordx4 v6, s[20:23], s66 offen lds
    v_mfma_f32_16x16x32_bf16 v[144:147], v[56:59], v[96:99], v[144:147]
    ds_read_b64_tr_b16 v[52:53], v17 offset:8192
    ds_read_b64_tr_b16 v[54:55], v17 offset:9216
    v_mfma_f32_16x16x32_bf16 v[144:147], v[60:63], v[100:103], v[144:147]
    buffer_store_dwordx4 a[4:7], v1, s[36:39], s72 offen sc1
    v_mfma_f32_16x16x32_bf16 v[148:151], v[56:59], v[104:107], v[148:151]
    v_add_u32 v17, 0xfffe0000, v17
    v_accvgpr_write_b32 a4, 0
    v_mfma_f32_16x16x32_bf16 v[148:151], v[60:63], v[108:111], v[148:151]
    v_accvgpr_write_b32 a5, 0
    v_accvgpr_write_b32 a6, 0
    v_mfma_f32_16x16x32_bf16 v[152:155], v[56:59], v[112:115], v[152:155]
    v_add_u32 v25, 0x10000, v25
    v_accvgpr_write_b32 a7, 0
    v_mfma_f32_16x16x32_bf16 v[152:155], v[60:63], v[116:119], v[152:155]
    ds_read_b128 v[68:71], v25 offset:16384
    v_mfma_f32_16x16x32_bf16 v[156:159], v[56:59], v[120:123], v[156:159]
    s_add_u32 m0, s69, 81920
    ds_read_b64_tr_b16 v[56:57], v18 offset:0
    ds_read_b64_tr_b16 v[58:59], v18 offset:1024
    v_mfma_f32_16x16x32_bf16 v[156:159], v[60:63], v[124:127], v[156:159]
    s_xor_b32 s65, s65, 8192
    buffer_load_dwordx4 v10, s[20:23], s64 offen lds
    s_waitcnt lgkmcnt(3)
    v_mfma_f32_16x16x32_bf16 v[160:163], v[40:43], v[96:99], v[160:163]
    s_xor_b32 s66, s66, 128
    ds_read_b64_tr_b16 v[60:61], v18 offset:8192
    ds_read_b64_tr_b16 v[62:63], v18 offset:9216
    v_mfma_f32_16x16x32_bf16 v[160:163], v[44:47], v[100:103], v[160:163]
    v_add_u32 v18, 0xfffe0000, v18
    v_mfma_f32_16x16x32_bf16 v[164:167], v[40:43], v[104:107], v[164:167]
    v_mfma_f32_16x16x32_bf16 v[164:167], v[44:47], v[108:111], v[164:167]
    v_mfma_f32_16x16x32_bf16 v[168:171], v[40:43], v[112:115], v[168:171]
    v_mfma_f32_16x16x32_bf16 v[168:171], v[44:47], v[116:119], v[168:171]
    v_mfma_f32_16x16x32_bf16 v[172:175], v[40:43], v[120:123], v[172:175]
    ds_read_b64_tr_b16 v[40:41], v19 offset:0
    ds_read_b64_tr_b16 v[42:43], v19 offset:1024
    v_mfma_f32_16x16x32_bf16 v[172:175], v[44:47], v[124:127], v[172:175]
    ds_read_b64_tr_b16 v[44:45], v19 offset:8192
    ds_read_b64_tr_b16 v[46:47], v19 offset:9216
    v_mfma_f32_16x16x32_bf16 v[176:179], v[48:51], v[96:99], v[176:179]
    buffer_load_dwordx4 v11, s[20:23], s64 offen offset:1024 lds
    v_mfma_f32_16x16x32_bf16 v[176:179], v[52:55], v[100:103], v[176:179]
    ds_read_b128 v[72:75], v24 offset:24576
    v_add_u32 v19, 0xfffe0000, v19
    v_mfma_f32_16x16x32_bf16 v[180:183], v[48:51], v[104:107], v[180:183]
    v_mfma_f32_16x16x32_bf16 v[180:183], v[52:55], v[108:111], v[180:183]
    v_mfma_f32_16x16x32_bf16 v[184:187], v[48:51], v[112:115], v[184:187]
    v_mfma_f32_16x16x32_bf16 v[184:187], v[52:55], v[116:119], v[184:187]
    v_mfma_f32_16x16x32_bf16 v[188:191], v[48:51], v[120:123], v[188:191]
    s_add_u32 s72, s70, 5120
    ds_read_b64_tr_b16 v[48:49], v20 offset:0
    ds_read_b64_tr_b16 v[50:51], v20 offset:1024
    v_mfma_f32_16x16x32_bf16 v[188:191], v[52:55], v[124:127], v[188:191]
    s_waitcnt lgkmcnt(2)
    ds_read_b64_tr_b16 v[52:53], v20 offset:8192
    ds_read_b64_tr_b16 v[54:55], v20 offset:9216
    v_mfma_f32_16x16x32_bf16 v[192:195], v[56:59], v[96:99], v[192:195]
    buffer_load_dwordx4 v12, s[20:23], s64 offen offset:2048 lds
    v_mfma_f32_16x16x32_bf16 v[192:195], v[60:63], v[100:103], v[192:195]
    buffer_store_dwordx4 a[12:15], v1, s[36:39], s72 offen sc1
    v_mfma_f32_16x16x32_bf16 v[196:199], v[56:59], v[104:107], v[196:199]
    v_add_u32 v20, 0xfffe0000, v20
    v_accvgpr_write_b32 a12, 0
    v_mfma_f32_16x16x32_bf16 v[196:199], v[60:63], v[108:111], v[196:199]
    ds_read_b128 v[76:79], v25 offset:24576
    v_accvgpr_write_b32 a13, 0
    v_mfma_f32_16x16x32_bf16 v[200:203], v[56:59], v[112:115], v[200:203]
    v_accvgpr_write_b32 a14, 0
    v_accvgpr_write_b32 a15, 0
    v_mfma_f32_16x16x32_bf16 v[200:203], v[60:63], v[116:119], v[200:203]
    v_mfma_f32_16x16x32_bf16 v[204:207], v[56:59], v[120:123], v[204:207]
    ds_read_b64_tr_b16 v[56:57], v21 offset:0
    ds_read_b64_tr_b16 v[58:59], v21 offset:1024
    v_mfma_f32_16x16x32_bf16 v[204:207], v[60:63], v[124:127], v[204:207]
    ds_read_b64_tr_b16 v[60:61], v21 offset:8192
    ds_read_b64_tr_b16 v[62:63], v21 offset:9216
    v_mfma_f32_16x16x32_bf16 v[208:211], v[40:43], v[96:99], v[208:211]
    v_add_u32 v21, 0xfffe0000, v21
    v_mfma_f32_16x16x32_bf16 v[208:211], v[44:47], v[100:103], v[208:211]
    buffer_load_dwordx4 v13, s[20:23], s64 offen offset:3072 lds
    v_mfma_f32_16x16x32_bf16 v[212:215], v[40:43], v[104:107], v[212:215]
    v_mfma_f32_16x16x32_bf16 v[212:215], v[44:47], v[108:111], v[212:215]
    v_mfma_f32_16x16x32_bf16 v[216:219], v[40:43], v[112:115], v[216:219]
    v_mfma_f32_16x16x32_bf16 v[216:219], v[44:47], v[116:119], v[216:219]
    v_mfma_f32_16x16x32_bf16 v[220:223], v[40:43], v[120:123], v[220:223]
    ds_read_b64_tr_b16 v[40:41], v26 offset:0
    ds_read_b64_tr_b16 v[42:43], v26 offset:512
    v_mfma_f32_16x16x32_bf16 v[220:223], v[44:47], v[124:127], v[220:223]
    s_waitcnt lgkmcnt(2)
    ds_read_b64_tr_b16 v[44:45], v26 offset:4096
    ds_read_b64_tr_b16 v[46:47], v26 offset:4608
    v_mfma_f32_16x16x32_bf16 v[224:227], v[48:51], v[96:99], v[224:227]
    v_add_u32 v26, 0x10000, v26
    v_mfma_f32_16x16x32_bf16 v[224:227], v[52:55], v[100:103], v[224:227]
    s_xor_b32 s64, s64, 896
    v_mfma_f32_16x16x32_bf16 v[228:231], v[48:51], v[104:107], v[228:231]
    v_mfma_f32_16x16x32_bf16 v[228:231], v[52:55], v[108:111], v[228:231]
    v_mfma_f32_16x16x32_bf16 v[232:235], v[48:51], v[112:115], v[232:235]
    v_mfma_f32_16x16x32_bf16 v[232:235], v[52:55], v[116:119], v[232:235]
    s_add_u32 m0, s69, 98304
    v_mfma_f32_16x16x32_bf16 v[236:239], v[48:51], v[120:123], v[236:239]
    buffer_load_dwordx4 v2, s[24:27], s60 offen lds
    v_mfma_f32_16x16x32_bf16 v[236:239], v[52:55], v[124:127], v[236:239]
    s_add_u32 s72, s70, 9216
    ds_read_b64_tr_b16 v[48:49], v27 offset:0
    ds_read_b64_tr_b16 v[50:51], v27 offset:512
    v_mfma_f32_16x16x32_bf16 v[240:243], v[56:59], v[96:99], v[240:243]
    ds_read_b64_tr_b16 v[52:53], v27 offset:4096
    ds_read_b64_tr_b16 v[54:55], v27 offset:4608
    v_mfma_f32_16x16x32_bf16 v[240:243], v[60:63], v[100:103], v[240:243]
    buffer_store_dwordx4 a[20:23], v1, s[36:39], s72 offen sc1
    v_mfma_f32_16x16x32_bf16 v[244:247], v[56:59], v[104:107], v[244:247]
    buffer_load_dwordx4 v3, s[24:27], s60 offen offset:1024 lds
    v_mfma_f32_16x16x32_bf16 v[244:247], v[60:63], v[108:111], v[244:247]
    v_add_u32 v27, 0x10000, v27
    v_accvgpr_write_b32 a20, 0
    v_mfma_f32_16x16x32_bf16 v[248:251], v[56:59], v[112:115], v[248:251]
    v_accvgpr_write_b32 a21, 0
    v_accvgpr_write_b32 a22, 0
    v_mfma_f32_16x16x32_bf16 v[248:251], v[60:63], v[116:119], v[248:251]
    v_accvgpr_write_b32 a23, 0
    v_mfma_f32_16x16x32_bf16 v[252:255], v[56:59], v[120:123], v[252:255]
    buffer_load_dwordx4 v4, s[24:27], s60 offen offset:2048 lds
    v_mfma_f32_16x16x32_bf16 v[252:255], v[60:63], v[124:127], v[252:255]
    s_waitcnt lgkmcnt(0)
    ds_read_b64_tr_b16 v[56:57], v28 offset:0
    ds_read_b64_tr_b16 v[58:59], v28 offset:512
    v_mfma_f32_16x16x32_bf16 a[64:67], v[40:43], v[96:99], a[64:67]
    ds_read_b64_tr_b16 v[60:61], v28 offset:4096
    ds_read_b64_tr_b16 v[62:63], v28 offset:4608
    v_mfma_f32_16x16x32_bf16 a[64:67], v[44:47], v[100:103], a[64:67]
    v_add_u32 v24, 0xfffe0000, v24
    v_add_u32 v28, 0x10000, v28
    v_mfma_f32_16x16x32_bf16 a[68:71], v[40:43], v[104:107], a[68:71]
    buffer_load_dwordx4 v5, s[24:27], s60 offen offset:3072 lds
    v_mfma_f32_16x16x32_bf16 a[68:71], v[44:47], v[108:111], a[68:71]
    ds_read_b128 v[80:83], v24 offset:16384
    v_mfma_f32_16x16x32_bf16 a[72:75], v[40:43], v[112:115], a[72:75]
    v_mfma_f32_16x16x32_bf16 a[72:75], v[44:47], v[116:119], a[72:75]
    s_add_u32 m0, s69, 114688
    v_add_u32 v25, 0xfffe0000, v25
    v_mfma_f32_16x16x32_bf16 a[76:79], v[40:43], v[120:123], a[76:79]
    s_xor_b32 s60, s60, 3670016
    buffer_load_dwordx4 v10, s[20:23], s63 offen lds
    v_mfma_f32_16x16x32_bf16 a[76:79], v[44:47], v[124:127], a[76:79]
    ds_read_b128 v[84:87], v25 offset:16384
    v_mfma_f32_16x16x32_bf16 a[128:131], v[40:43], a[136:139], a[128:131]
    ds_read_b64_tr_b16 v[40:41], v29 offset:0
    ds_read_b64_tr_b16 v[42:43], v29 offset:512
    v_mfma_f32_16x16x32_bf16 a[128:131], v[44:47], a[140:143], a[128:131]
    ds_read_b64_tr_b16 v[44:45], v29 offset:4096
    ds_read_b64_tr_b16 v[46:47], v29 offset:4608
    v_mfma_f32_16x16x32_bf16 a[80:83], v[48:51], v[96:99], a[80:83]
    buffer_load_dwordx4 v11, s[20:23], s63 offen offset:1024 lds
    v_mfma_f32_16x16x32_bf16 a[80:83], v[52:55], v[100:103], a[80:83]
    ds_read_b128 v[88:91], v24 offset:24576
    v_add_u32 v29, 0x10000, v29
    v_mfma_f32_16x16x32_bf16 a[84:87], v[48:51], v[104:107], a[84:87]
    v_mfma_f32_16x16x32_bf16 a[84:87], v[52:55], v[108:111], a[84:87]
    v_mfma_f32_16x16x32_bf16 a[88:91], v[48:51], v[112:115], a[88:91]
    buffer_load_dwordx4 v12, s[20:23], s63 offen offset:2048 lds
    v_mfma_f32_16x16x32_bf16 a[88:91], v[52:55], v[116:119], a[88:91]
    ds_read_b128 v[92:95], v25 offset:24576
    v_mfma_f32_16x16x32_bf16 a[92:95], v[48:51], v[120:123], a[92:95]
    s_add_u32 s72, s70, 13312
    v_mfma_f32_16x16x32_bf16 a[92:95], v[52:55], v[124:127], a[92:95]
    v_mfma_f32_16x16x32_bf16 a[132:135], v[48:51], a[136:139], a[132:135]
    buffer_load_dwordx4 v13, s[20:23], s63 offen offset:3072 lds
    v_mfma_f32_16x16x32_bf16 a[132:135], v[52:55], a[140:143], a[132:135]
    s_waitcnt lgkmcnt(1)
    v_mfma_f32_16x16x32_bf16 a[96:99], v[56:59], v[96:99], a[96:99]
    v_mfma_f32_16x16x32_bf16 a[96:99], v[60:63], v[100:103], a[96:99]
    s_xor_b32 s63, s63, 128
    v_mfma_f32_16x16x32_bf16 a[100:103], v[56:59], v[104:107], a[100:103]
    buffer_store_dwordx4 a[28:31], v1, s[36:39], s72 offen sc1
    v_mfma_f32_16x16x32_bf16 a[100:103], v[60:63], v[108:111], a[100:103]
    v_mfma_f32_16x16x32_bf16 a[104:107], v[56:59], v[112:115], a[104:107]
    v_accvgpr_write_b32 a28, 0
    v_accvgpr_write_b32 a29, 0
    v_mfma_f32_16x16x32_bf16 a[104:107], v[60:63], v[116:119], a[104:107]
    s_waitcnt vmcnt(10) lgkmcnt(0)
    s_barrier
    ds_read_b64_tr_b16 v[48:49], v14 offset:32768
    v_mfma_f32_16x16x32_bf16 a[108:111], v[56:59], v[120:123], a[108:111]
    s_add_u32 m0, s67, 131072
    ds_read_b64_tr_b16 v[50:51], v14 offset:33792
    ds_read_b64_tr_b16 v[52:53], v14 offset:40960
    v_mfma_f32_16x16x32_bf16 a[108:111], v[60:63], v[124:127], a[108:111]
    buffer_load_dwordx4 v1, s[28:31], s65 offen sc1 lds
    v_mfma_f32_16x16x32_bf16 a[112:115], v[40:43], v[96:99], a[112:115]
    ds_read_b64_tr_b16 v[54:55], v14 offset:41984
    ds_read_b64_tr_b16 v[56:57], v15 offset:32768
    v_mfma_f32_16x16x32_bf16 a[112:115], v[44:47], v[100:103], a[112:115]
    ds_read_b64_tr_b16 v[58:59], v15 offset:33792
    ds_read_b64_tr_b16 v[60:61], v15 offset:40960
    v_mfma_f32_16x16x32_bf16 a[116:119], v[40:43], v[104:107], a[116:119]
    ds_read_b64_tr_b16 v[62:63], v15 offset:41984
    ds_read_b128 a[136:139], v22 offset:0
    v_mfma_f32_16x16x32_bf16 a[116:119], v[44:47], v[108:111], a[116:119]
    ds_read_b128 a[140:143], v23 offset:0
    v_add_u32 v14, 0x10000, v14
    v_mfma_f32_16x16x32_bf16 a[120:123], v[40:43], v[112:115], a[120:123]
    v_add_u32 v15, 0x10000, v15
    v_add_u32 v22, 0x10000, v22
    v_mfma_f32_16x16x32_bf16 a[120:123], v[44:47], v[116:119], a[120:123]
    v_add_u32 v23, 0x10000, v23
    v_accvgpr_write_b32 a30, 0
    v_mfma_f32_16x16x32_bf16 a[124:127], v[40:43], v[120:123], a[124:127]
    buffer_load_dwordx4 v1, s[28:31], s65 offen offset:1024 sc1 lds
    v_mfma_f32_16x16x32_bf16 a[124:127], v[44:47], v[124:127], a[124:127]
    s_waitcnt lgkmcnt(1)
    ds_read_b64_tr_b16 v[40:41], v16 offset:32768
    ds_read_b64_tr_b16 v[42:43], v16 offset:33792
    v_mfma_f32_16x16x32_bf16 v[128:131], v[48:51], v[64:67], v[128:131]
    ds_read_b64_tr_b16 v[44:45], v16 offset:40960
    ds_read_b64_tr_b16 v[46:47], v16 offset:41984
    v_mfma_f32_16x16x32_bf16 v[128:131], v[52:55], v[68:71], v[128:131]
    v_add_u32 v16, 0x10000, v16
    v_accvgpr_write_b32 a31, 0
    v_mfma_f32_16x16x32_bf16 v[132:135], v[48:51], v[72:75], v[132:135]
    ds_read_b128 v[96:99], v24 offset:49152
    v_mfma_f32_16x16x32_bf16 v[132:135], v[52:55], v[76:79], v[132:135]
    v_mfma_f32_16x16x32_bf16 v[136:139], v[48:51], v[80:83], v[136:139]
    v_mfma_f32_16x16x32_bf16 v[136:139], v[52:55], v[84:87], v[136:139]
    s_add_u32 s72, s70, 33792
    v_mfma_f32_16x16x32_bf16 v[140:143], v[48:51], v[88:91], v[140:143]
    s_add_u32 m0, s68, 139264
    ds_read_b64_tr_b16 v[48:49], v17 offset:32768
    ds_read_b64_tr_b16 v[50:51], v17 offset:33792
    v_mfma_f32_16x16x32_bf16 v[140:143], v[52:55], v[92:95], v[140:143]
    buffer_load_dwordx4 v6, s[20:23], s66 offen lds
    v_mfma_f32_16x16x32_bf16 v[144:147], v[56:59], v[64:67], v[144:147]
    ds_read_b64_tr_b16 v[52:53], v17 offset:40960
    ds_read_b64_tr_b16 v[54:55], v17 offset:41984
    v_mfma_f32_16x16x32_bf16 v[144:147], v[60:63], v[68:71], v[144:147]
    buffer_store_dwordx4 a[36:39], v1, s[36:39], s72 offen sc1
    v_mfma_f32_16x16x32_bf16 v[148:151], v[56:59], v[72:75], v[148:151]
    v_add_u32 v17, 0x10000, v17
    v_accvgpr_write_b32 a36, 0
    v_mfma_f32_16x16x32_bf16 v[148:151], v[60:63], v[76:79], v[148:151]
    v_accvgpr_write_b32 a37, 0
    v_accvgpr_write_b32 a38, 0
    v_mfma_f32_16x16x32_bf16 v[152:155], v[56:59], v[80:83], v[152:155]
    v_accvgpr_write_b32 a39, 0
    v_mfma_f32_16x16x32_bf16 v[152:155], v[60:63], v[84:87], v[152:155]
    ds_read_b128 v[100:103], v25 offset:49152
    v_mfma_f32_16x16x32_bf16 v[156:159], v[56:59], v[88:91], v[156:159]
    s_add_u32 m0, s69, 147456
    ds_read_b64_tr_b16 v[56:57], v18 offset:32768
    ds_read_b64_tr_b16 v[58:59], v18 offset:33792
    v_mfma_f32_16x16x32_bf16 v[156:159], v[60:63], v[92:95], v[156:159]
    s_xor_b32 s65, s65, 57344
    buffer_load_dwordx4 v10, s[20:23], s64 offen lds
    s_waitcnt lgkmcnt(3)
    v_mfma_f32_16x16x32_bf16 v[160:163], v[40:43], v[64:67], v[160:163]
    s_xor_b32 s66, s66, 896
    ds_read_b64_tr_b16 v[60:61], v18 offset:40960
    ds_read_b64_tr_b16 v[62:63], v18 offset:41984
    v_mfma_f32_16x16x32_bf16 v[160:163], v[44:47], v[68:71], v[160:163]
    v_add_u32 v18, 0x10000, v18
    v_mfma_f32_16x16x32_bf16 v[164:167], v[40:43], v[72:75], v[164:167]
    v_mfma_f32_16x16x32_bf16 v[164:167], v[44:47], v[76:79], v[164:167]
    v_mfma_f32_16x16x32_bf16 v[168:171], v[40:43], v[80:83], v[168:171]
    v_mfma_f32_16x16x32_bf16 v[168:171], v[44:47], v[84:87], v[168:171]
    v_mfma_f32_16x16x32_bf16 v[172:175], v[40:43], v[88:91], v[172:175]
    ds_read_b64_tr_b16 v[40:41], v19 offset:32768
    ds_read_b64_tr_b16 v[42:43], v19 offset:33792
    v_mfma_f32_16x16x32_bf16 v[172:175], v[44:47], v[92:95], v[172:175]
    ds_read_b64_tr_b16 v[44:45], v19 offset:40960
    ds_read_b64_tr_b16 v[46:47], v19 offset:41984
    v_mfma_f32_16x16x32_bf16 v[176:179], v[48:51], v[64:67], v[176:179]
    buffer_load_dwordx4 v11, s[20:23], s64 offen offset:1024 lds
    v_mfma_f32_16x16x32_bf16 v[176:179], v[52:55], v[68:71], v[176:179]
    ds_read_b128 v[104:107], v24 offset:57344
    v_add_u32 v19, 0x10000, v19
    v_mfma_f32_16x16x32_bf16 v[180:183], v[48:51], v[72:75], v[180:183]
    v_mfma_f32_16x16x32_bf16 v[180:183], v[52:55], v[76:79], v[180:183]
    v_mfma_f32_16x16x32_bf16 v[184:187], v[48:51], v[80:83], v[184:187]
    v_mfma_f32_16x16x32_bf16 v[184:187], v[52:55], v[84:87], v[184:187]
    v_mfma_f32_16x16x32_bf16 v[188:191], v[48:51], v[88:91], v[188:191]
    s_add_u32 s72, s70, 37888
    ds_read_b64_tr_b16 v[48:49], v20 offset:32768
    ds_read_b64_tr_b16 v[50:51], v20 offset:33792
    v_mfma_f32_16x16x32_bf16 v[188:191], v[52:55], v[92:95], v[188:191]
    s_waitcnt lgkmcnt(2)
    ds_read_b64_tr_b16 v[52:53], v20 offset:40960
    ds_read_b64_tr_b16 v[54:55], v20 offset:41984
    v_mfma_f32_16x16x32_bf16 v[192:195], v[56:59], v[64:67], v[192:195]
    buffer_load_dwordx4 v12, s[20:23], s64 offen offset:2048 lds
    v_mfma_f32_16x16x32_bf16 v[192:195], v[60:63], v[68:71], v[192:195]
    buffer_store_dwordx4 a[44:47], v1, s[36:39], s72 offen sc1
    v_mfma_f32_16x16x32_bf16 v[196:199], v[56:59], v[72:75], v[196:199]
    v_add_u32 v20, 0x10000, v20
    v_accvgpr_write_b32 a44, 0
    v_mfma_f32_16x16x32_bf16 v[196:199], v[60:63], v[76:79], v[196:199]
    ds_read_b128 v[108:111], v25 offset:57344
    v_accvgpr_write_b32 a45, 0
    v_mfma_f32_16x16x32_bf16 v[200:203], v[56:59], v[80:83], v[200:203]
    v_accvgpr_write_b32 a46, 0
    v_accvgpr_write_b32 a47, 0
    v_mfma_f32_16x16x32_bf16 v[200:203], v[60:63], v[84:87], v[200:203]
    v_mfma_f32_16x16x32_bf16 v[204:207], v[56:59], v[88:91], v[204:207]
    ds_read_b64_tr_b16 v[56:57], v21 offset:32768
    ds_read_b64_tr_b16 v[58:59], v21 offset:33792
    v_mfma_f32_16x16x32_bf16 v[204:207], v[60:63], v[92:95], v[204:207]
    ds_read_b64_tr_b16 v[60:61], v21 offset:40960
    ds_read_b64_tr_b16 v[62:63], v21 offset:41984
    v_mfma_f32_16x16x32_bf16 v[208:211], v[40:43], v[64:67], v[208:211]
    v_add_u32 v21, 0x10000, v21
    v_mfma_f32_16x16x32_bf16 v[208:211], v[44:47], v[68:71], v[208:211]
    buffer_load_dwordx4 v13, s[20:23], s64 offen offset:3072 lds
    v_mfma_f32_16x16x32_bf16 v[212:215], v[40:43], v[72:75], v[212:215]
    v_mfma_f32_16x16x32_bf16 v[212:215], v[44:47], v[76:79], v[212:215]
    v_mfma_f32_16x16x32_bf16 v[216:219], v[40:43], v[80:83], v[216:219]
    v_mfma_f32_16x16x32_bf16 v[216:219], v[44:47], v[84:87], v[216:219]
    v_mfma_f32_16x16x32_bf16 v[220:223], v[40:43], v[88:91], v[220:223]
    ds_read_b64_tr_b16 v[40:41], v26 offset:0
    ds_read_b64_tr_b16 v[42:43], v26 offset:512
    v_mfma_f32_16x16x32_bf16 v[220:223], v[44:47], v[92:95], v[220:223]
    s_waitcnt lgkmcnt(2)
    ds_read_b64_tr_b16 v[44:45], v26 offset:4096
    ds_read_b64_tr_b16 v[46:47], v26 offset:4608
    v_mfma_f32_16x16x32_bf16 v[224:227], v[48:51], v[64:67], v[224:227]
    v_add_u32 v26, 0x10000, v26
    v_mfma_f32_16x16x32_bf16 v[224:227], v[52:55], v[68:71], v[224:227]
    s_xor_b32 s64, s64, 128
    v_mfma_f32_16x16x32_bf16 v[228:231], v[48:51], v[72:75], v[228:231]
    v_mfma_f32_16x16x32_bf16 v[228:231], v[52:55], v[76:79], v[228:231]
    v_mfma_f32_16x16x32_bf16 v[232:235], v[48:51], v[80:83], v[232:235]
    v_mfma_f32_16x16x32_bf16 v[232:235], v[52:55], v[84:87], v[232:235]
    s_add_u32 m0, s69, 0
    v_mfma_f32_16x16x32_bf16 v[236:239], v[48:51], v[88:91], v[236:239]
    buffer_load_dwordx4 v2, s[24:27], s60 offen lds
    v_mfma_f32_16x16x32_bf16 v[236:239], v[52:55], v[92:95], v[236:239]
    s_add_u32 s72, s70, 41984
    ds_read_b64_tr_b16 v[48:49], v27 offset:0
    ds_read_b64_tr_b16 v[50:51], v27 offset:512
    v_mfma_f32_16x16x32_bf16 v[240:243], v[56:59], v[64:67], v[240:243]
    ds_read_b64_tr_b16 v[52:53], v27 offset:4096
    ds_read_b64_tr_b16 v[54:55], v27 offset:4608
    v_mfma_f32_16x16x32_bf16 v[240:243], v[60:63], v[68:71], v[240:243]
    buffer_store_dwordx4 a[52:55], v1, s[36:39], s72 offen sc1
    v_mfma_f32_16x16x32_bf16 v[244:247], v[56:59], v[72:75], v[244:247]
    buffer_load_dwordx4 v3, s[24:27], s60 offen offset:1024 lds
    v_mfma_f32_16x16x32_bf16 v[244:247], v[60:63], v[76:79], v[244:247]
    v_add_u32 v27, 0x10000, v27
    v_accvgpr_write_b32 a52, 0
    v_mfma_f32_16x16x32_bf16 v[248:251], v[56:59], v[80:83], v[248:251]
    v_accvgpr_write_b32 a53, 0
    v_accvgpr_write_b32 a54, 0
    v_mfma_f32_16x16x32_bf16 v[248:251], v[60:63], v[84:87], v[248:251]
    v_accvgpr_write_b32 a55, 0
    v_mfma_f32_16x16x32_bf16 v[252:255], v[56:59], v[88:91], v[252:255]
    buffer_load_dwordx4 v4, s[24:27], s60 offen offset:2048 lds
    v_mfma_f32_16x16x32_bf16 v[252:255], v[60:63], v[92:95], v[252:255]
    s_waitcnt lgkmcnt(0)
    ds_read_b64_tr_b16 v[56:57], v28 offset:0
    ds_read_b64_tr_b16 v[58:59], v28 offset:512
    v_mfma_f32_16x16x32_bf16 a[64:67], v[40:43], v[64:67], a[64:67]
    ds_read_b64_tr_b16 v[60:61], v28 offset:4096
    ds_read_b64_tr_b16 v[62:63], v28 offset:4608
    v_mfma_f32_16x16x32_bf16 a[64:67], v[44:47], v[68:71], a[64:67]
    v_add_u32 v24, 0x10000, v24
    v_add_u32 v28, 0x10000, v28
    v_mfma_f32_16x16x32_bf16 a[68:71], v[40:43], v[72:75], a[68:71]
    buffer_load_dwordx4 v5, s[24:27], s60 offen offset:3072 lds
    v_mfma_f32_16x16x32_bf16 a[68:71], v[44:47], v[76:79], a[68:71]
    ds_read_b128 v[112:115], v24 offset:16384
    v_mfma_f32_16x16x32_bf16 a[72:75], v[40:43], v[80:83], a[72:75]
    v_mfma_f32_16x16x32_bf16 a[72:75], v[44:47], v[84:87], a[72:75]
    s_add_u32 m0, s69, 16384
    v_add_u32 v25, 0x10000, v25
    v_mfma_f32_16x16x32_bf16 a[76:79], v[40:43], v[88:91], a[76:79]
    s_xor_b32 s60, s60, 524288
    buffer_load_dwordx4 v10, s[20:23], s63 offen lds
    v_mfma_f32_16x16x32_bf16 a[76:79], v[44:47], v[92:95], a[76:79]
    ds_read_b128 v[116:119], v25 offset:16384
    v_mfma_f32_16x16x32_bf16 a[128:131], v[40:43], a[136:139], a[128:131]
    ds_read_b64_tr_b16 v[40:41], v29 offset:0
    ds_read_b64_tr_b16 v[42:43], v29 offset:512
    v_mfma_f32_16x16x32_bf16 a[128:131], v[44:47], a[140:143], a[128:131]
    ds_read_b64_tr_b16 v[44:45], v29 offset:4096
    ds_read_b64_tr_b16 v[46:47], v29 offset:4608
    v_mfma_f32_16x16x32_bf16 a[80:83], v[48:51], v[64:67], a[80:83]
    buffer_load_dwordx4 v11, s[20:23], s63 offen offset:1024 lds
    v_mfma_f32_16x16x32_bf16 a[80:83], v[52:55], v[68:71], a[80:83]
    ds_read_b128 v[120:123], v24 offset:24576
    v_add_u32 v29, 0x10000, v29
    v_mfma_f32_16x16x32_bf16 a[84:87], v[48:51], v[72:75], a[84:87]
    v_mfma_f32_16x16x32_bf16 a[84:87], v[52:55], v[76:79], a[84:87]
    v_mfma_f32_16x16x32_bf16 a[88:91], v[48:51], v[80:83], a[88:91]
    buffer_load_dwordx4 v12, s[20:23], s63 offen offset:2048 lds
    v_mfma_f32_16x16x32_bf16 a[88:91], v[52:55], v[84:87], a[88:91]
    ds_read_b128 v[124:127], v25 offset:24576
    v_mfma_f32_16x16x32_bf16 a[92:95], v[48:51], v[88:91], a[92:95]
    s_add_u32 s72, s70, 46080
    v_mfma_f32_16x16x32_bf16 a[92:95], v[52:55], v[92:95], a[92:95]
    v_mfma_f32_16x16x32_bf16 a[132:135], v[48:51], a[136:139], a[132:135]
    buffer_load_dwordx4 v13, s[20:23], s63 offen offset:3072 lds
    v_mfma_f32_16x16x32_bf16 a[132:135], v[52:55], a[140:143], a[132:135]
    s_waitcnt lgkmcnt(1)
    v_mfma_f32_16x16x32_bf16 a[96:99], v[56:59], v[64:67], a[96:99]
    v_mfma_f32_16x16x32_bf16 a[96:99], v[60:63], v[68:71], a[96:99]
    s_xor_b32 s63, s63, 384
    v_mfma_f32_16x16x32_bf16 a[100:103], v[56:59], v[72:75], a[100:103]
    buffer_store_dwordx4 a[60:63], v1, s[36:39], s72 offen sc1
    v_mfma_f32_16x16x32_bf16 a[100:103], v[60:63], v[76:79], a[100:103]
    v_mfma_f32_16x16x32_bf16 a[104:107], v[56:59], v[80:83], a[104:107]
    v_accvgpr_write_b32 a60, 0
    v_accvgpr_write_b32 a61, 0
    v_mfma_f32_16x16x32_bf16 a[104:107], v[60:63], v[84:87], a[104:107]
    s_waitcnt vmcnt(10) lgkmcnt(0)
    s_barrier
    ds_read_b64_tr_b16 v[48:49], v14 offset:32768
    v_mfma_f32_16x16x32_bf16 a[108:111], v[56:59], v[88:91], a[108:111]
    s_add_u32 m0, s67, 32768
    ds_read_b64_tr_b16 v[50:51], v14 offset:33792
    ds_read_b64_tr_b16 v[52:53], v14 offset:40960
    v_mfma_f32_16x16x32_bf16 a[108:111], v[60:63], v[92:95], a[108:111]
    buffer_load_dwordx4 v1, s[28:31], s65 offen sc1 lds
    v_mfma_f32_16x16x32_bf16 a[112:115], v[40:43], v[64:67], a[112:115]
    ds_read_b64_tr_b16 v[54:55], v14 offset:41984
    ds_read_b64_tr_b16 v[56:57], v15 offset:32768
    v_mfma_f32_16x16x32_bf16 a[112:115], v[44:47], v[68:71], a[112:115]
    ds_read_b64_tr_b16 v[58:59], v15 offset:33792
    ds_read_b64_tr_b16 v[60:61], v15 offset:40960
    v_mfma_f32_16x16x32_bf16 a[116:119], v[40:43], v[72:75], a[116:119]
    ds_read_b64_tr_b16 v[62:63], v15 offset:41984
    ds_read_b128 a[136:139], v22 offset:0
    v_mfma_f32_16x16x32_bf16 a[116:119], v[44:47], v[76:79], a[116:119]
    ds_read_b128 a[140:143], v23 offset:0
    v_add_u32 v14, 0xffff0000, v14
    v_mfma_f32_16x16x32_bf16 a[120:123], v[40:43], v[80:83], a[120:123]
    v_add_u32 v15, 0xffff0000, v15
    v_add_u32 v22, 0xfffe0000, v22
    v_mfma_f32_16x16x32_bf16 a[120:123], v[44:47], v[84:87], a[120:123]
    v_add_u32 v23, 0xfffe0000, v23
    v_accvgpr_read_b32 v32, a144
    v_mfma_f32_16x16x32_bf16 a[124:127], v[40:43], v[88:91], a[124:127]
    buffer_load_dwordx4 v1, s[28:31], s65 offen offset:1024 sc1 lds
    v_mfma_f32_16x16x32_bf16 a[124:127], v[44:47], v[92:95], a[124:127]
    s_waitcnt lgkmcnt(1)
    ds_read_b64_tr_b16 v[40:41], v16 offset:32768
    ds_read_b64_tr_b16 v[42:43], v16 offset:33792
    v_mfma_f32_16x16x32_bf16 v[128:131], v[48:51], v[96:99], v[128:131]
    ds_read_b64_tr_b16 v[44:45], v16 offset:40960
    ds_read_b64_tr_b16 v[46:47], v16 offset:41984
    v_mfma_f32_16x16x32_bf16 v[128:131], v[52:55], v[100:103], v[128:131]
    v_add_u32 v16, 0xffff0000, v16
    v_accvgpr_read_b32 v31, a145
    v_mfma_f32_16x16x32_bf16 v[132:135], v[48:51], v[104:107], v[132:135]
    ds_read_b128 v[64:67], v24 offset:49152
    v_cvt_pk_bf16_f32 v32, v32, v31
    v_mfma_f32_16x16x32_bf16 v[132:135], v[52:55], v[108:111], v[132:135]
    v_accvgpr_read_b32 v33, a146
    v_accvgpr_read_b32 v31, a147
    v_mfma_f32_16x16x32_bf16 v[136:139], v[48:51], v[112:115], v[136:139]
    v_cvt_pk_bf16_f32 v33, v33, v31
    v_accvgpr_read_b32 v34, a148
    v_mfma_f32_16x16x32_bf16 v[136:139], v[52:55], v[116:119], v[136:139]
    s_add_u32 s72, s71, 32768
    v_accvgpr_read_b32 v31, a149
    v_cvt_pk_bf16_f32 v34, v34, v31
    v_mfma_f32_16x16x32_bf16 v[140:143], v[48:51], v[120:123], v[140:143]
    s_add_u32 m0, s68, 40960
    ds_read_b64_tr_b16 v[48:49], v17 offset:32768
    ds_read_b64_tr_b16 v[50:51], v17 offset:33792
    v_mfma_f32_16x16x32_bf16 v[140:143], v[52:55], v[124:127], v[140:143]
    buffer_load_dwordx4 v6, s[20:23], s66 offen lds
    v_mfma_f32_16x16x32_bf16 v[144:147], v[56:59], v[96:99], v[144:147]
    ds_read_b64_tr_b16 v[52:53], v17 offset:40960
    ds_read_b64_tr_b16 v[54:55], v17 offset:41984
    v_mfma_f32_16x16x32_bf16 v[144:147], v[60:63], v[100:103], v[144:147]
    v_add_u32 v17, 0xffff0000, v17
    v_accvgpr_read_b32 v35, a150
    v_mfma_f32_16x16x32_bf16 v[148:151], v[56:59], v[104:107], v[148:151]
    v_accvgpr_read_b32 v31, a151
    v_cvt_pk_bf16_f32 v35, v35, v31
    v_mfma_f32_16x16x32_bf16 v[148:151], v[60:63], v[108:111], v[148:151]
    buffer_store_dwordx4 v[32:35], v1, s[36:39], s72 offen sc1
    v_mfma_f32_16x16x32_bf16 v[152:155], v[56:59], v[112:115], v[152:155]
    v_accvgpr_write_b32 a62, 0
    v_accvgpr_write_b32 a63, 0
    v_mfma_f32_16x16x32_bf16 v[152:155], v[60:63], v[116:119], v[152:155]
    ds_read_b128 v[68:71], v25 offset:49152
    v_accvgpr_write_b32 a144, 0
    v_mfma_f32_16x16x32_bf16 v[156:159], v[56:59], v[120:123], v[156:159]
    s_add_u32 m0, s69, 49152
    ds_read_b64_tr_b16 v[56:57], v18 offset:32768
    ds_read_b64_tr_b16 v[58:59], v18 offset:33792
    v_mfma_f32_16x16x32_bf16 v[156:159], v[60:63], v[124:127], v[156:159]
    s_xor_b32 s65, s65, 8192
    buffer_load_dwordx4 v10, s[20:23], s64 offen lds
    s_waitcnt lgkmcnt(3)
    v_mfma_f32_16x16x32_bf16 v[160:163], v[40:43], v[96:99], v[160:163]
    s_xor_b32 s66, s66, 128
    ds_read_b64_tr_b16 v[60:61], v18 offset:40960
    ds_read_b64_tr_b16 v[62:63], v18 offset:41984
    v_mfma_f32_16x16x32_bf16 v[160:163], v[44:47], v[100:103], v[160:163]
    v_add_u32 v18, 0xffff0000, v18
    v_accvgpr_write_b32 a145, 0
    v_mfma_f32_16x16x32_bf16 v[164:167], v[40:43], v[104:107], v[164:167]
    v_accvgpr_write_b32 a146, 0
    v_accvgpr_write_b32 a147, 0
    v_mfma_f32_16x16x32_bf16 v[164:167], v[44:47], v[108:111], v[164:167]
    v_accvgpr_read_b32 v32, a152
    v_accvgpr_read_b32 v31, a153
    v_mfma_f32_16x16x32_bf16 v[168:171], v[40:43], v[112:115], v[168:171]
    v_cvt_pk_bf16_f32 v32, v32, v31
    v_accvgpr_read_b32 v33, a154
    v_mfma_f32_16x16x32_bf16 v[168:171], v[44:47], v[116:119], v[168:171]
    v_accvgpr_read_b32 v31, a155
    v_cvt_pk_bf16_f32 v33, v33, v31
    v_mfma_f32_16x16x32_bf16 v[172:175], v[40:43], v[120:123], v[172:175]
    ds_read_b64_tr_b16 v[40:41], v19 offset:32768
    ds_read_b64_tr_b16 v[42:43], v19 offset:33792
    v_mfma_f32_16x16x32_bf16 v[172:175], v[44:47], v[124:127], v[172:175]
    ds_read_b64_tr_b16 v[44:45], v19 offset:40960
    ds_read_b64_tr_b16 v[46:47], v19 offset:41984
    v_mfma_f32_16x16x32_bf16 v[176:179], v[48:51], v[96:99], v[176:179]
    buffer_load_dwordx4 v11, s[20:23], s64 offen offset:1024 lds
    v_mfma_f32_16x16x32_bf16 v[176:179], v[52:55], v[100:103], v[176:179]
    ds_read_b128 v[72:75], v24 offset:57344
    v_add_u32 v19, 0xffff0000, v19
    v_mfma_f32_16x16x32_bf16 v[180:183], v[48:51], v[104:107], v[180:183]
    v_accvgpr_read_b32 v34, a156
    v_accvgpr_read_b32 v31, a157
    v_mfma_f32_16x16x32_bf16 v[180:183], v[52:55], v[108:111], v[180:183]
    v_cvt_pk_bf16_f32 v34, v34, v31
    v_accvgpr_read_b32 v35, a158
    v_mfma_f32_16x16x32_bf16 v[184:187], v[48:51], v[112:115], v[184:187]
    v_accvgpr_read_b32 v31, a159
    v_cvt_pk_bf16_f32 v35, v35, v31
    v_mfma_f32_16x16x32_bf16 v[184:187], v[52:55], v[116:119], v[184:187]
    v_accvgpr_write_b32 a148, 0
    v_accvgpr_write_b32 a149, 0
    v_mfma_f32_16x16x32_bf16 v[188:191], v[48:51], v[120:123], v[188:191]
    s_add_u32 s72, s71, 33792
    ds_read_b64_tr_b16 v[48:49], v20 offset:32768
    ds_read_b64_tr_b16 v[50:51], v20 offset:33792
    v_mfma_f32_16x16x32_bf16 v[188:191], v[52:55], v[124:127], v[188:191]
    s_waitcnt lgkmcnt(2)
    ds_read_b64_tr_b16 v[52:53], v20 offset:40960
    ds_read_b64_tr_b16 v[54:55], v20 offset:41984
    v_mfma_f32_16x16x32_bf16 v[192:195], v[56:59], v[96:99], v[192:195]
    buffer_load_dwordx4 v12, s[20:23], s64 offen offset:2048 lds
    v_mfma_f32_16x16x32_bf16 v[192:195], v[60:63], v[100:103], v[192:195]
    v_add_u32 v20, 0xffff0000, v20
    v_accvgpr_write_b32 a150, 0
    v_mfma_f32_16x16x32_bf16 v[196:199], v[56:59], v[104:107], v[196:199]
    buffer_store_dwordx4 v[32:35], v1, s[36:39], s72 offen sc1
    v_mfma_f32_16x16x32_bf16 v[196:199], v[60:63], v[108:111], v[196:199]
    ds_read_b128 v[76:79], v25 offset:57344
    v_accvgpr_write_b32 a151, 0
    v_mfma_f32_16x16x32_bf16 v[200:203], v[56:59], v[112:115], v[200:203]
    v_accvgpr_write_b32 a152, 0
    v_accvgpr_write_b32 a153, 0
    v_mfma_f32_16x16x32_bf16 v[200:203], v[60:63], v[116:119], v[200:203]
    v_accvgpr_write_b32 a154, 0
    v_accvgpr_write_b32 a155, 0
    v_mfma_f32_16x16x32_bf16 v[204:207], v[56:59], v[120:123], v[204:207]
    ds_read_b64_tr_b16 v[56:57], v21 offset:32768
    ds_read_b64_tr_b16 v[58:59], v21 offset:33792
    v_mfma_f32_16x16x32_bf16 v[204:207], v[60:63], v[124:127], v[204:207]
    ds_read_b64_tr_b16 v[60:61], v21 offset:40960
    ds_read_b64_tr_b16 v[62:63], v21 offset:41984
    v_mfma_f32_16x16x32_bf16 v[208:211], v[40:43], v[96:99], v[208:211]
    v_add_u32 v21, 0xffff0000, v21
    v_accvgpr_write_b32 a156, 0
    v_mfma_f32_16x16x32_bf16 v[208:211], v[44:47], v[100:103], v[208:211]
    buffer_load_dwordx4 v13, s[20:23], s64 offen offset:3072 lds
    v_mfma_f32_16x16x32_bf16 v[212:215], v[40:43], v[104:107], v[212:215]
    v_accvgpr_write_b32 a157, 0
    v_accvgpr_write_b32 a158, 0
    v_mfma_f32_16x16x32_bf16 v[212:215], v[44:47], v[108:111], v[212:215]
    v_accvgpr_write_b32 a159, 0
    v_mfma_f32_16x16x32_bf16 v[216:219], v[40:43], v[112:115], v[216:219]
    v_accvgpr_read_b32 v32, a160
    v_accvgpr_read_b32 v31, a161
    v_mfma_f32_16x16x32_bf16 v[216:219], v[44:47], v[116:119], v[216:219]
    v_cvt_pk_bf16_f32 v32, v32, v31
    v_accvgpr_read_b32 v33, a162
    v_mfma_f32_16x16x32_bf16 v[220:223], v[40:43], v[120:123], v[220:223]
    ds_read_b64_tr_b16 v[40:41], v26 offset:0
    ds_read_b64_tr_b16 v[42:43], v26 offset:512
    v_mfma_f32_16x16x32_bf16 v[220:223], v[44:47], v[124:127], v[220:223]
    s_waitcnt lgkmcnt(2)
    ds_read_b64_tr_b16 v[44:45], v26 offset:4096
    ds_read_b64_tr_b16 v[46:47], v26 offset:4608
    v_mfma_f32_16x16x32_bf16 v[224:227], v[48:51], v[96:99], v[224:227]
    v_add_u32 v26, 0xfffe0000, v26
    v_accvgpr_read_b32 v31, a163
    v_mfma_f32_16x16x32_bf16 v[224:227], v[52:55], v[100:103], v[224:227]
    s_xor_b32 s64, s64, 384
    v_cvt_pk_bf16_f32 v33, v33, v31
    v_accvgpr_read_b32 v34, a164
    v_mfma_f32_16x16x32_bf16 v[228:231], v[48:51], v[104:107], v[228:231]
    v_accvgpr_read_b32 v31, a165
    v_cvt_pk_bf16_f32 v34, v34, v31
    v_mfma_f32_16x16x32_bf16 v[228:231], v[52:55], v[108:111], v[228:231]
    v_accvgpr_read_b32 v35, a166
    v_accvgpr_read_b32 v31, a167
    v_mfma_f32_16x16x32_bf16 v[232:235], v[48:51], v[112:115], v[232:235]
    v_cvt_pk_bf16_f32 v35, v35, v31
    v_accvgpr_write_b32 a160, 0
    v_mfma_f32_16x16x32_bf16 v[232:235], v[52:55], v[116:119], v[232:235]
    s_add_u32 m0, s69, 65536
    v_accvgpr_write_b32 a161, 0
    v_accvgpr_write_b32 a162, 0
    v_mfma_f32_16x16x32_bf16 v[236:239], v[48:51], v[120:123], v[236:239]
    buffer_load_dwordx4 v2, s[24:27], s60 offen lds
    v_mfma_f32_16x16x32_bf16 v[236:239], v[52:55], v[124:127], v[236:239]
    s_add_u32 s72, s71, 2048
    ds_read_b64_tr_b16 v[48:49], v27 offset:0
    ds_read_b64_tr_b16 v[50:51], v27 offset:512
    v_mfma_f32_16x16x32_bf16 v[240:243], v[56:59], v[96:99], v[240:243]
    ds_read_b64_tr_b16 v[52:53], v27 offset:4096
    ds_read_b64_tr_b16 v[54:55], v27 offset:4608
    v_mfma_f32_16x16x32_bf16 v[240:243], v[60:63], v[100:103], v[240:243]
    v_add_u32 v27, 0xfffe0000, v27
    v_accvgpr_write_b32 a163, 0
    v_mfma_f32_16x16x32_bf16 v[244:247], v[56:59], v[104:107], v[244:247]
    buffer_load_dwordx4 v3, s[24:27], s60 offen offset:1024 lds
    v_mfma_f32_16x16x32_bf16 v[244:247], v[60:63], v[108:111], v[244:247]
    buffer_store_dwordx4 v[32:35], v1, s[36:39], s72 offen sc1
    v_mfma_f32_16x16x32_bf16 v[248:251], v[56:59], v[112:115], v[248:251]
    v_accvgpr_write_b32 a164, 0
    v_accvgpr_write_b32 a165, 0
    v_mfma_f32_16x16x32_bf16 v[248:251], v[60:63], v[116:119], v[248:251]
    v_accvgpr_write_b32 a166, 0
    v_accvgpr_write_b32 a167, 0
    v_mfma_f32_16x16x32_bf16 v[252:255], v[56:59], v[120:123], v[252:255]
    buffer_load_dwordx4 v4, s[24:27], s60 offen offset:2048 lds
    v_mfma_f32_16x16x32_bf16 v[252:255], v[60:63], v[124:127], v[252:255]
    s_waitcnt lgkmcnt(0)
    ds_read_b64_tr_b16 v[56:57], v28 offset:0
    ds_read_b64_tr_b16 v[58:59], v28 offset:512
    v_mfma_f32_16x16x32_bf16 a[64:67], v[40:43], v[96:99], a[64:67]
    ds_read_b64_tr_b16 v[60:61], v28 offset:4096
    ds_read_b64_tr_b16 v[62:63], v28 offset:4608
    v_mfma_f32_16x16x32_bf16 a[64:67], v[44:47], v[100:103], a[64:67]
    v_add_u32 v24, 0x10000, v24
    v_add_u32 v28, 0xfffe0000, v28
    v_mfma_f32_16x16x32_bf16 a[68:71], v[40:43], v[104:107], a[68:71]
    buffer_load_dwordx4 v5, s[24:27], s60 offen offset:3072 lds
    v_mfma_f32_16x16x32_bf16 a[68:71], v[44:47], v[108:111], a[68:71]
    ds_read_b128 v[80:83], v24 offset:16384
    v_mfma_f32_16x16x32_bf16 a[72:75], v[40:43], v[112:115], a[72:75]
    v_mfma_f32_16x16x32_bf16 a[72:75], v[44:47], v[116:119], a[72:75]
    s_add_u32 m0, s69, 81920
    v_add_u32 v25, 0x10000, v25
    v_accvgpr_read_b32 v32, a168
    v_mfma_f32_16x16x32_bf16 a[76:79], v[40:43], v[120:123], a[76:79]
    s_xor_b32 s60, s60, 1572864
    buffer_load_dwordx4 v10, s[20:23], s63 offen lds
    v_mfma_f32_16x16x32_bf16 a[76:79], v[44:47], v[124:127], a[76:79]
    ds_read_b128 v[84:87], v25 offset:16384
    v_accvgpr_read_b32 v31, a169
    v_mfma_f32_16x16x32_bf16 a[128:131], v[40:43], a[136:139], a[128:131]
    ds_read_b64_tr_b16 v[40:41], v29 offset:0
    ds_read_b64_tr_b16 v[42:43], v29 offset:512
    v_mfma_f32_16x16x32_bf16 a[128:131], v[44:47], a[140:143], a[128:131]
    ds_read_b64_tr_b16 v[44:45], v29 offset:4096
    ds_read_b64_tr_b16 v[46:47], v29 offset:4608
    v_mfma_f32_16x16x32_bf16 a[80:83], v[48:51], v[96:99], a[80:83]
    buffer_load_dwordx4 v11, s[20:23], s63 offen offset:1024 lds
    v_mfma_f32_16x16x32_bf16 a[80:83], v[52:55], v[100:103], a[80:83]
    ds_read_b128 v[88:91], v24 offset:24576
    v_add_u32 v29, 0xfffe0000, v29
    v_mfma_f32_16x16x32_bf16 a[84:87], v[48:51], v[104:107], a[84:87]
    v_cvt_pk_bf16_f32 v32, v32, v31
    v_accvgpr_read_b32 v33, a170
    v_mfma_f32_16x16x32_bf16 a[84:87], v[52:55], v[108:111], a[84:87]
    v_accvgpr_read_b32 v31, a171
    v_cvt_pk_bf16_f32 v33, v33, v31
    v_mfma_f32_16x16x32_bf16 a[88:91], v[48:51], v[112:115], a[88:91]
    buffer_load_dwordx4 v12, s[20:23], s63 offen offset:2048 lds
    v_mfma_f32_16x16x32_bf16 a[88:91], v[52:55], v[116:119], a[88:91]
    ds_read_b128 v[92:95], v25 offset:24576
    v_accvgpr_read_b32 v34, a172
    v_mfma_f32_16x16x32_bf16 a[92:95], v[48:51], v[120:123], a[92:95]
    s_add_u32 s72, s71, 3072
    v_accvgpr_read_b32 v31, a173
    v_cvt_pk_bf16_f32 v34, v34, v31
    v_mfma_f32_16x16x32_bf16 a[92:95], v[52:55], v[124:127], a[92:95]
    v_accvgpr_read_b32 v35, a174
    v_accvgpr_read_b32 v31, a175
    v_mfma_f32_16x16x32_bf16 a[132:135], v[48:51], a[136:139], a[132:135]
    buffer_load_dwordx4 v13, s[20:23], s63 offen offset:3072 lds
    v_mfma_f32_16x16x32_bf16 a[132:135], v[52:55], a[140:143], a[132:135]
    s_waitcnt lgkmcnt(1)
    v_cvt_pk_bf16_f32 v35, v35, v31
    v_accvgpr_write_b32 a168, 0
    v_mfma_f32_16x16x32_bf16 a[96:99], v[56:59], v[96:99], a[96:99]
    v_accvgpr_write_b32 a169, 0
    v_accvgpr_write_b32 a170, 0
    v_mfma_f32_16x16x32_bf16 a[96:99], v[60:63], v[100:103], a[96:99]
    s_xor_b32 s63, s63, 128
    v_accvgpr_write_b32 a171, 0
    v_accvgpr_write_b32 a172, 0
    v_mfma_f32_16x16x32_bf16 a[100:103], v[56:59], v[104:107], a[100:103]
    buffer_store_dwordx4 v[32:35], v1, s[36:39], s72 offen sc1
    v_mfma_f32_16x16x32_bf16 a[100:103], v[60:63], v[108:111], a[100:103]
    v_accvgpr_write_b32 a173, 0
    v_accvgpr_write_b32 a174, 0
    v_mfma_f32_16x16x32_bf16 a[104:107], v[56:59], v[112:115], a[104:107]
    v_accvgpr_write_b32 a175, 0
    v_mfma_f32_16x16x32_bf16 a[104:107], v[60:63], v[116:119], a[104:107]
    s_waitcnt vmcnt(10) lgkmcnt(0)
    s_barrier
    ds_read_b64_tr_b16 v[48:49], v14 offset:0
    v_mfma_f32_16x16x32_bf16 a[108:111], v[56:59], v[120:123], a[108:111]
    s_add_u32 m0, s67, 98304
    ds_read_b64_tr_b16 v[50:51], v14 offset:1024
    ds_read_b64_tr_b16 v[52:53], v14 offset:8192
    v_mfma_f32_16x16x32_bf16 a[108:111], v[60:63], v[124:127], a[108:111]
    buffer_load_dwordx4 v1, s[28:31], s65 offen sc1 lds
    v_mfma_f32_16x16x32_bf16 a[112:115], v[40:43], v[96:99], a[112:115]
    ds_read_b64_tr_b16 v[54:55], v14 offset:9216
    ds_read_b64_tr_b16 v[56:57], v15 offset:0
    v_mfma_f32_16x16x32_bf16 a[112:115], v[44:47], v[100:103], a[112:115]
    ds_read_b64_tr_b16 v[58:59], v15 offset:1024
    ds_read_b64_tr_b16 v[60:61], v15 offset:8192
    v_mfma_f32_16x16x32_bf16 a[116:119], v[40:43], v[104:107], a[116:119]
    ds_read_b64_tr_b16 v[62:63], v15 offset:9216
    ds_read_b128 a[136:139], v22 offset:32768
    v_mfma_f32_16x16x32_bf16 a[116:119], v[44:47], v[108:111], a[116:119]
    ds_read_b128 a[140:143], v23 offset:32768
    v_add_u32 v14, 0x10000, v14
    v_mfma_f32_16x16x32_bf16 a[120:123], v[40:43], v[112:115], a[120:123]
    v_add_u32 v15, 0x10000, v15
    v_add_u32 v22, 0x10000, v22
    v_mfma_f32_16x16x32_bf16 a[120:123], v[44:47], v[116:119], a[120:123]
    v_add_u32 v23, 0x10000, v23
    v_accvgpr_read_b32 v32, a176
    v_mfma_f32_16x16x32_bf16 a[124:127], v[40:43], v[120:123], a[124:127]
    buffer_load_dwordx4 v1, s[28:31], s65 offen offset:1024 sc1 lds
    v_mfma_f32_16x16x32_bf16 a[124:127], v[44:47], v[124:127], a[124:127]
    s_waitcnt lgkmcnt(1)
    ds_read_b64_tr_b16 v[40:41], v16 offset:0
    ds_read_b64_tr_b16 v[42:43], v16 offset:1024
    v_mfma_f32_16x16x32_bf16 v[128:131], v[48:51], v[64:67], v[128:131]
    ds_read_b64_tr_b16 v[44:45], v16 offset:8192
    ds_read_b64_tr_b16 v[46:47], v16 offset:9216
    v_mfma_f32_16x16x32_bf16 v[128:131], v[52:55], v[68:71], v[128:131]
    v_add_u32 v24, 0xfffe0000, v24
    v_add_u32 v16, 0x10000, v16
    v_mfma_f32_16x16x32_bf16 v[132:135], v[48:51], v[72:75], v[132:135]
    ds_read_b128 v[96:99], v24 offset:16384
    v_accvgpr_read_b32 v31, a177
    v_mfma_f32_16x16x32_bf16 v[132:135], v[52:55], v[76:79], v[132:135]
    v_cvt_pk_bf16_f32 v32, v32, v31
    v_accvgpr_read_b32 v33, a178
    v_mfma_f32_16x16x32_bf16 v[136:139], v[48:51], v[80:83], v[136:139]
    v_accvgpr_read_b32 v31, a179
    v_cvt_pk_bf16_f32 v33, v33, v31
    v_mfma_f32_16x16x32_bf16 v[136:139], v[52:55], v[84:87], v[136:139]
    s_add_u32 s72, s71, 34816
    v_accvgpr_read_b32 v34, a180
    v_accvgpr_read_b32 v31, a181
    v_mfma_f32_16x16x32_bf16 v[140:143], v[48:51], v[88:91], v[140:143]
    s_add_u32 m0, s68, 106496
    ds_read_b64_tr_b16 v[48:49], v17 offset:0
    ds_read_b64_tr_b16 v[50:51], v17 offset:1024
    v_mfma_f32_16x16x32_bf16 v[140:143], v[52:55], v[92:95], v[140:143]
    buffer_load_dwordx4 v6, s[20:23], s66 offen lds
    v_mfma_f32_16x16x32_bf16 v[144:147], v[56:59], v[64:67], v[144:147]
    ds_read_b64_tr_b16 v[52:53], v17 offset:8192
    ds_read_b64_tr_b16 v[54:55], v17 offset:9216
    v_mfma_f32_16x16x32_bf16 v[144:147], v[60:63], v[68:71], v[144:147]
    v_add_u32 v17, 0x10000, v17
    v_cvt_pk_bf16_f32 v34, v34, v31
    v_mfma_f32_16x16x32_bf16 v[148:151], v[56:59], v[72:75], v[148:151]
    v_accvgpr_read_b32 v35, a182
    v_accvgpr_read_b32 v31, a183
    v_mfma_f32_16x16x32_bf16 v[148:151], v[60:63], v[76:79], v[148:151]
    v_cvt_pk_bf16_f32 v35, v35, v31
    v_accvgpr_write_b32 a176, 0
    v_mfma_f32_16x16x32_bf16 v[152:155], v[56:59], v[80:83], v[152:155]
    v_add_u32 v25, 0xfffe0000, v25
    v_accvgpr_write_b32 a177, 0
    v_mfma_f32_16x16x32_bf16 v[152:155], v[60:63], v[84:87], v[152:155]
    ds_read_b128 v[100:103], v25 offset:16384
    v_accvgpr_write_b32 a178, 0
    v_mfma_f32_16x16x32_bf16 v[156:159], v[56:59], v[88:91], v[156:159]
    s_add_u32 m0, s69, 114688
    ds_read_b64_tr_b16 v[56:57], v18 offset:0
    ds_read_b64_tr_b16 v[58:59], v18 offset:1024
    v_mfma_f32_16x16x32_bf16 v[156:159], v[60:63], v[92:95], v[156:159]
    s_xor_b32 s65, s65, 24576
    buffer_load_dwordx4 v10, s[20:23], s64 offen lds
    s_waitcnt lgkmcnt(3)
    v_mfma_f32_16x16x32_bf16 v[160:163], v[40:43], v[64:67], v[160:163]
    s_xor_b32 s66, s66, 384
    ds_read_b64_tr_b16 v[60:61], v18 offset:8192
    ds_read_b64_tr_b16 v[62:63], v18 offset:9216
    v_mfma_f32_16x16x32_bf16 v[160:163], v[44:47], v[68:71], v[160:163]
    v_add_u32 v18, 0x10000, v18
    v_accvgpr_write_b32 a179, 0
    v_mfma_f32_16x16x32_bf16 v[164:167], v[40:43], v[72:75], v[164:167]
    buffer_store_dwordx4 v[32:35], v1, s[36:39], s72 offen sc1
    v_mfma_f32_16x16x32_bf16 v[164:167], v[44:47], v[76:79], v[164:167]
    v_accvgpr_read_b32 v31, a185
    v_accvgpr_read_b32 v32, a184
    v_mfma_f32_16x16x32_bf16 v[168:171], v[40:43], v[80:83], v[168:171]
    v_cvt_pk_bf16_f32 v32, v32, v31
    v_accvgpr_read_b32 v33, a186
    v_mfma_f32_16x16x32_bf16 v[168:171], v[44:47], v[84:87], v[168:171]
    v_accvgpr_read_b32 v31, a187
    v_cvt_pk_bf16_f32 v33, v33, v31
    v_mfma_f32_16x16x32_bf16 v[172:175], v[40:43], v[88:91], v[172:175]
    ds_read_b64_tr_b16 v[40:41], v19 offset:0
    ds_read_b64_tr_b16 v[42:43], v19 offset:1024
    v_mfma_f32_16x16x32_bf16 v[172:175], v[44:47], v[92:95], v[172:175]
    ds_read_b64_tr_b16 v[44:45], v19 offset:8192
    ds_read_b64_tr_b16 v[46:47], v19 offset:9216
    v_mfma_f32_16x16x32_bf16 v[176:179], v[48:51], v[64:67], v[176:179]
    buffer_load_dwordx4 v11, s[20:23], s64 offen offset:1024 lds
    v_mfma_f32_16x16x32_bf16 v[176:179], v[52:55], v[68:71], v[176:179]
    ds_read_b128 v[104:107], v24 offset:24576
    v_add_u32 v19, 0x10000, v19
    v_mfma_f32_16x16x32_bf16 v[180:183], v[48:51], v[72:75], v[180:183]
    v_accvgpr_read_b32 v34, a188
    v_accvgpr_read_b32 v31, a189
    v_mfma_f32_16x16x32_bf16 v[180:183], v[52:55], v[76:79], v[180:183]
    v_cvt_pk_bf16_f32 v34, v34, v31
    v_accvgpr_read_b32 v35, a190
    v_mfma_f32_16x16x32_bf16 v[184:187], v[48:51], v[80:83], v[184:187]
    v_accvgpr_read_b32 v31, a191
    v_cvt_pk_bf16_f32 v35, v35, v31
    v_mfma_f32_16x16x32_bf16 v[184:187], v[52:55], v[84:87], v[184:187]
    v_accvgpr_write_b32 a180, 0
    v_accvgpr_write_b32 a181, 0
    v_mfma_f32_16x16x32_bf16 v[188:191], v[48:51], v[88:91], v[188:191]
    s_add_u32 s72, s71, 35840
    ds_read_b64_tr_b16 v[48:49], v20 offset:0
    ds_read_b64_tr_b16 v[50:51], v20 offset:1024
    v_mfma_f32_16x16x32_bf16 v[188:191], v[52:55], v[92:95], v[188:191]
    s_waitcnt lgkmcnt(2)
    ds_read_b64_tr_b16 v[52:53], v20 offset:8192
    ds_read_b64_tr_b16 v[54:55], v20 offset:9216
    v_mfma_f32_16x16x32_bf16 v[192:195], v[56:59], v[64:67], v[192:195]
    buffer_load_dwordx4 v12, s[20:23], s64 offen offset:2048 lds
    v_mfma_f32_16x16x32_bf16 v[192:195], v[60:63], v[68:71], v[192:195]
    v_add_u32 v20, 0x10000, v20
    v_accvgpr_write_b32 a182, 0
    v_mfma_f32_16x16x32_bf16 v[196:199], v[56:59], v[72:75], v[196:199]
    buffer_store_dwordx4 v[32:35], v1, s[36:39], s72 offen sc1
    v_mfma_f32_16x16x32_bf16 v[196:199], v[60:63], v[76:79], v[196:199]
    ds_read_b128 v[108:111], v25 offset:24576
    v_accvgpr_write_b32 a183, 0
    v_mfma_f32_16x16x32_bf16 v[200:203], v[56:59], v[80:83], v[200:203]
    v_accvgpr_write_b32 a184, 0
    v_accvgpr_write_b32 a185, 0
    v_mfma_f32_16x16x32_bf16 v[200:203], v[60:63], v[84:87], v[200:203]
    v_accvgpr_write_b32 a186, 0
    v_accvgpr_write_b32 a187, 0
    v_mfma_f32_16x16x32_bf16 v[204:207], v[56:59], v[88:91], v[204:207]
    ds_read_b64_tr_b16 v[56:57], v21 offset:0
    ds_read_b64_tr_b16 v[58:59], v21 offset:1024
    v_mfma_f32_16x16x32_bf16 v[204:207], v[60:63], v[92:95], v[204:207]
    ds_read_b64_tr_b16 v[60:61], v21 offset:8192
    ds_read_b64_tr_b16 v[62:63], v21 offset:9216
    v_mfma_f32_16x16x32_bf16 v[208:211], v[40:43], v[64:67], v[208:211]
    v_add_u32 v21, 0x10000, v21
    v_accvgpr_write_b32 a188, 0
    v_mfma_f32_16x16x32_bf16 v[208:211], v[44:47], v[68:71], v[208:211]
    buffer_load_dwordx4 v13, s[20:23], s64 offen offset:3072 lds
    v_mfma_f32_16x16x32_bf16 v[212:215], v[40:43], v[72:75], v[212:215]
    v_accvgpr_write_b32 a189, 0
    v_accvgpr_write_b32 a190, 0
    v_mfma_f32_16x16x32_bf16 v[212:215], v[44:47], v[76:79], v[212:215]
    v_accvgpr_write_b32 a191, 0
    v_mfma_f32_16x16x32_bf16 v[216:219], v[40:43], v[80:83], v[216:219]
    v_accvgpr_read_b32 v32, a192
    v_accvgpr_read_b32 v31, a193
    v_mfma_f32_16x16x32_bf16 v[216:219], v[44:47], v[84:87], v[216:219]
    v_cvt_pk_bf16_f32 v32, v32, v31
    v_accvgpr_read_b32 v33, a194
    v_mfma_f32_16x16x32_bf16 v[220:223], v[40:43], v[88:91], v[220:223]
    ds_read_b64_tr_b16 v[40:41], v26 offset:32768
    ds_read_b64_tr_b16 v[42:43], v26 offset:33280
    v_mfma_f32_16x16x32_bf16 v[220:223], v[44:47], v[92:95], v[220:223]
    s_waitcnt lgkmcnt(2)
    ds_read_b64_tr_b16 v[44:45], v26 offset:36864
    ds_read_b64_tr_b16 v[46:47], v26 offset:37376
    v_mfma_f32_16x16x32_bf16 v[224:227], v[48:51], v[64:67], v[224:227]
    v_add_u32 v26, 0x10000, v26
    v_accvgpr_read_b32 v31, a195
    v_mfma_f32_16x16x32_bf16 v[224:227], v[52:55], v[68:71], v[224:227]
    s_xor_b32 s64, s64, 128
    v_cvt_pk_bf16_f32 v33, v33, v31
    v_accvgpr_read_b32 v34, a196
    v_mfma_f32_16x16x32_bf16 v[228:231], v[48:51], v[72:75], v[228:231]
    v_accvgpr_read_b32 v31, a197
    v_cvt_pk_bf16_f32 v34, v34, v31
    v_mfma_f32_16x16x32_bf16 v[228:231], v[52:55], v[76:79], v[228:231]
    v_accvgpr_read_b32 v35, a198
    v_accvgpr_read_b32 v31, a199
    v_mfma_f32_16x16x32_bf16 v[232:235], v[48:51], v[80:83], v[232:235]
    v_cvt_pk_bf16_f32 v35, v35, v31
    v_accvgpr_write_b32 a192, 0
    v_mfma_f32_16x16x32_bf16 v[232:235], v[52:55], v[84:87], v[232:235]
    s_add_u32 m0, s69, 131072
    v_accvgpr_write_b32 a193, 0
    v_accvgpr_write_b32 a194, 0
    v_mfma_f32_16x16x32_bf16 v[236:239], v[48:51], v[88:91], v[236:239]
    buffer_load_dwordx4 v2, s[24:27], s60 offen lds
    v_mfma_f32_16x16x32_bf16 v[236:239], v[52:55], v[92:95], v[236:239]
    s_add_u32 s72, s71, 4096
    ds_read_b64_tr_b16 v[48:49], v27 offset:32768
    ds_read_b64_tr_b16 v[50:51], v27 offset:33280
    v_mfma_f32_16x16x32_bf16 v[240:243], v[56:59], v[64:67], v[240:243]
    ds_read_b64_tr_b16 v[52:53], v27 offset:36864
    ds_read_b64_tr_b16 v[54:55], v27 offset:37376
    v_mfma_f32_16x16x32_bf16 v[240:243], v[60:63], v[68:71], v[240:243]
    v_add_u32 v27, 0x10000, v27
    v_accvgpr_write_b32 a195, 0
    v_mfma_f32_16x16x32_bf16 v[244:247], v[56:59], v[72:75], v[244:247]
    buffer_load_dwordx4 v3, s[24:27], s60 offen offset:1024 lds
    v_mfma_f32_16x16x32_bf16 v[244:247], v[60:63], v[76:79], v[244:247]
    buffer_store_dwordx4 v[32:35], v1, s[36:39], s72 offen sc1
    v_mfma_f32_16x16x32_bf16 v[248:251], v[56:59], v[80:83], v[248:251]
    v_accvgpr_write_b32 a196, 0
    v_accvgpr_write_b32 a197, 0
    v_mfma_f32_16x16x32_bf16 v[248:251], v[60:63], v[84:87], v[248:251]
    v_accvgpr_write_b32 a198, 0
    v_accvgpr_write_b32 a199, 0
    v_mfma_f32_16x16x32_bf16 v[252:255], v[56:59], v[88:91], v[252:255]
    buffer_load_dwordx4 v4, s[24:27], s60 offen offset:2048 lds
    v_mfma_f32_16x16x32_bf16 v[252:255], v[60:63], v[92:95], v[252:255]
    s_waitcnt lgkmcnt(0)
    ds_read_b64_tr_b16 v[56:57], v28 offset:32768
    ds_read_b64_tr_b16 v[58:59], v28 offset:33280
    v_mfma_f32_16x16x32_bf16 a[64:67], v[40:43], v[64:67], a[64:67]
    ds_read_b64_tr_b16 v[60:61], v28 offset:36864
    ds_read_b64_tr_b16 v[62:63], v28 offset:37376
    v_mfma_f32_16x16x32_bf16 a[64:67], v[44:47], v[68:71], a[64:67]
    v_add_u32 v28, 0x10000, v28
    v_mfma_f32_16x16x32_bf16 a[68:71], v[40:43], v[72:75], a[68:71]
    buffer_load_dwordx4 v5, s[24:27], s60 offen offset:3072 lds
    v_mfma_f32_16x16x32_bf16 a[68:71], v[44:47], v[76:79], a[68:71]
    ds_read_b128 v[112:115], v24 offset:49152
    v_mfma_f32_16x16x32_bf16 a[72:75], v[40:43], v[80:83], a[72:75]
    v_mfma_f32_16x16x32_bf16 a[72:75], v[44:47], v[84:87], a[72:75]
    s_add_u32 m0, s69, 147456
    v_accvgpr_read_b32 v32, a200
    v_accvgpr_read_b32 v31, a201
    v_mfma_f32_16x16x32_bf16 a[76:79], v[40:43], v[88:91], a[76:79]
    s_xor_b32 s60, s60, 524288
    buffer_load_dwordx4 v10, s[20:23], s63 offen lds
    v_mfma_f32_16x16x32_bf16 a[76:79], v[44:47], v[92:95], a[76:79]
    ds_read_b128 v[116:119], v25 offset:49152
    v_cvt_pk_bf16_f32 v32, v32, v31
    v_mfma_f32_16x16x32_bf16 a[128:131], v[40:43], a[136:139], a[128:131]
    ds_read_b64_tr_b16 v[40:41], v29 offset:32768
    ds_read_b64_tr_b16 v[42:43], v29 offset:33280
    v_mfma_f32_16x16x32_bf16 a[128:131], v[44:47], a[140:143], a[128:131]
    ds_read_b64_tr_b16 v[44:45], v29 offset:36864
    ds_read_b64_tr_b16 v[46:47], v29 offset:37376
    v_mfma_f32_16x16x32_bf16 a[80:83], v[48:51], v[64:67], a[80:83]
    buffer_load_dwordx4 v11, s[20:23], s63 offen offset:1024 lds
    v_mfma_f32_16x16x32_bf16 a[80:83], v[52:55], v[68:71], a[80:83]
    ds_read_b128 v[120:123], v24 offset:57344
    v_add_u32 v29, 0x10000, v29
    v_mfma_f32_16x16x32_bf16 a[84:87], v[48:51], v[72:75], a[84:87]
    v_accvgpr_read_b32 v33, a202
    v_accvgpr_read_b32 v31, a203
    v_mfma_f32_16x16x32_bf16 a[84:87], v[52:55], v[76:79], a[84:87]
    v_cvt_pk_bf16_f32 v33, v33, v31
    v_accvgpr_read_b32 v34, a204
    v_mfma_f32_16x16x32_bf16 a[88:91], v[48:51], v[80:83], a[88:91]
    buffer_load_dwordx4 v12, s[20:23], s63 offen offset:2048 lds
    v_mfma_f32_16x16x32_bf16 a[88:91], v[52:55], v[84:87], a[88:91]
    ds_read_b128 v[124:127], v25 offset:57344
    v_accvgpr_read_b32 v31, a205
    v_mfma_f32_16x16x32_bf16 a[92:95], v[48:51], v[88:91], a[92:95]
    s_add_u32 s72, s71, 5120
    v_cvt_pk_bf16_f32 v34, v34, v31
    v_accvgpr_read_b32 v35, a206
    v_mfma_f32_16x16x32_bf16 a[92:95], v[52:55], v[92:95], a[92:95]
    v_accvgpr_read_b32 v31, a207
    v_cvt_pk_bf16_f32 v35, v35, v31
    v_mfma_f32_16x16x32_bf16 a[132:135], v[48:51], a[136:139], a[132:135]
    buffer_load_dwordx4 v13, s[20:23], s63 offen offset:3072 lds
    v_mfma_f32_16x16x32_bf16 a[132:135], v[52:55], a[140:143], a[132:135]
    s_waitcnt lgkmcnt(1)
    v_accvgpr_write_b32 a200, 0
    v_accvgpr_write_b32 a201, 0
    v_mfma_f32_16x16x32_bf16 a[96:99], v[56:59], v[64:67], a[96:99]
    v_accvgpr_write_b32 a202, 0
    v_accvgpr_write_b32 a203, 0
    v_mfma_f32_16x16x32_bf16 a[96:99], v[60:63], v[68:71], a[96:99]
    s_xor_b32 s63, s63, 1920
    v_accvgpr_write_b32 a204, 0
    v_accvgpr_write_b32 a205, 0
    v_mfma_f32_16x16x32_bf16 a[100:103], v[56:59], v[72:75], a[100:103]
    s_andn2_b32 s63, s63, 896
    buffer_store_dwordx4 v[32:35], v1, s[36:39], s72 offen sc1
    v_mfma_f32_16x16x32_bf16 a[100:103], v[60:63], v[76:79], a[100:103]
    v_accvgpr_write_b32 a206, 0
    v_accvgpr_write_b32 a207, 0
    v_mfma_f32_16x16x32_bf16 a[104:107], v[56:59], v[80:83], a[104:107]
    v_mfma_f32_16x16x32_bf16 a[104:107], v[60:63], v[84:87], a[104:107]
    s_waitcnt vmcnt(10) lgkmcnt(0)
    s_barrier
    ds_read_b64_tr_b16 v[48:49], v14 offset:0
    v_mfma_f32_16x16x32_bf16 a[108:111], v[56:59], v[88:91], a[108:111]
    s_add_u32 m0, s67, 0
    ds_read_b64_tr_b16 v[50:51], v14 offset:1024
    ds_read_b64_tr_b16 v[52:53], v14 offset:8192
    v_mfma_f32_16x16x32_bf16 a[108:111], v[60:63], v[92:95], a[108:111]
    buffer_load_dwordx4 v1, s[28:31], s65 offen sc1 lds
    v_mfma_f32_16x16x32_bf16 a[112:115], v[40:43], v[64:67], a[112:115]
    ds_read_b64_tr_b16 v[54:55], v14 offset:9216
    ds_read_b64_tr_b16 v[56:57], v15 offset:0
    v_mfma_f32_16x16x32_bf16 a[112:115], v[44:47], v[68:71], a[112:115]
    ds_read_b64_tr_b16 v[58:59], v15 offset:1024
    ds_read_b64_tr_b16 v[60:61], v15 offset:8192
    v_mfma_f32_16x16x32_bf16 a[116:119], v[40:43], v[72:75], a[116:119]
    ds_read_b64_tr_b16 v[62:63], v15 offset:9216
    ds_read_b128 a[136:139], v22 offset:32768
    v_mfma_f32_16x16x32_bf16 a[116:119], v[44:47], v[76:79], a[116:119]
    ds_read_b128 a[140:143], v23 offset:32768
    v_add_u32 v14, 0x10000, v14
    v_mfma_f32_16x16x32_bf16 a[120:123], v[40:43], v[80:83], a[120:123]
    v_add_u32 v15, 0x10000, v15
    v_add_u32 v22, 0xffff0000, v22
    v_mfma_f32_16x16x32_bf16 a[120:123], v[44:47], v[84:87], a[120:123]
    v_add_u32 v23, 0xffff0000, v23
    v_accvgpr_read_b32 v32, a208
    v_mfma_f32_16x16x32_bf16 a[124:127], v[40:43], v[88:91], a[124:127]
    buffer_load_dwordx4 v1, s[28:31], s65 offen offset:1024 sc1 lds
    v_mfma_f32_16x16x32_bf16 a[124:127], v[44:47], v[92:95], a[124:127]
    s_waitcnt lgkmcnt(1)
    ds_read_b64_tr_b16 v[40:41], v16 offset:0
    ds_read_b64_tr_b16 v[42:43], v16 offset:1024
    v_mfma_f32_16x16x32_bf16 v[128:131], v[48:51], v[96:99], v[128:131]
    ds_read_b64_tr_b16 v[44:45], v16 offset:8192
    ds_read_b64_tr_b16 v[46:47], v16 offset:9216
    v_mfma_f32_16x16x32_bf16 v[128:131], v[52:55], v[100:103], v[128:131]
    v_add_u32 v24, 0x10000, v24
    v_add_u32 v16, 0x10000, v16
    v_mfma_f32_16x16x32_bf16 v[132:135], v[48:51], v[104:107], v[132:135]
    ds_read_b128 v[64:67], v24 offset:16384
    v_accvgpr_read_b32 v31, a209
    v_mfma_f32_16x16x32_bf16 v[132:135], v[52:55], v[108:111], v[132:135]
    v_cvt_pk_bf16_f32 v32, v32, v31
    v_accvgpr_read_b32 v33, a210
    v_mfma_f32_16x16x32_bf16 v[136:139], v[48:51], v[112:115], v[136:139]
    v_accvgpr_read_b32 v31, a211
    v_cvt_pk_bf16_f32 v33, v33, v31
    v_mfma_f32_16x16x32_bf16 v[136:139], v[52:55], v[116:119], v[136:139]
    s_add_u32 s72, s71, 36864
    v_accvgpr_read_b32 v34, a212
    v_accvgpr_read_b32 v31, a213
    v_mfma_f32_16x16x32_bf16 v[140:143], v[48:51], v[120:123], v[140:143]
    s_add_u32 m0, s68, 8192
    ds_read_b64_tr_b16 v[48:49], v17 offset:0
    ds_read_b64_tr_b16 v[50:51], v17 offset:1024
    v_mfma_f32_16x16x32_bf16 v[140:143], v[52:55], v[124:127], v[140:143]
    buffer_load_dwordx4 v6, s[20:23], s66 offen lds
    v_mfma_f32_16x16x32_bf16 v[144:147], v[56:59], v[96:99], v[144:147]
    ds_read_b64_tr_b16 v[52:53], v17 offset:8192
    ds_read_b64_tr_b16 v[54:55], v17 offset:9216
    v_mfma_f32_16x16x32_bf16 v[144:147], v[60:63], v[100:103], v[144:147]
    v_add_u32 v17, 0x10000, v17
    v_cvt_pk_bf16_f32 v34, v34, v31
    v_mfma_f32_16x16x32_bf16 v[148:151], v[56:59], v[104:107], v[148:151]
    v_accvgpr_read_b32 v35, a214
    v_accvgpr_read_b32 v31, a215
    v_mfma_f32_16x16x32_bf16 v[148:151], v[60:63], v[108:111], v[148:151]
    v_cvt_pk_bf16_f32 v35, v35, v31
    v_accvgpr_write_b32 a208, 0
    v_mfma_f32_16x16x32_bf16 v[152:155], v[56:59], v[112:115], v[152:155]
    v_add_u32 v25, 0x10000, v25
    v_accvgpr_write_b32 a209, 0
    v_mfma_f32_16x16x32_bf16 v[152:155], v[60:63], v[116:119], v[152:155]
    ds_read_b128 v[68:71], v25 offset:16384
    v_accvgpr_write_b32 a210, 0
    v_mfma_f32_16x16x32_bf16 v[156:159], v[56:59], v[120:123], v[156:159]
    s_add_u32 m0, s69, 16384
    ds_read_b64_tr_b16 v[56:57], v18 offset:0
    ds_read_b64_tr_b16 v[58:59], v18 offset:1024
    v_mfma_f32_16x16x32_bf16 v[156:159], v[60:63], v[124:127], v[156:159]
    s_xor_b32 s65, s65, 8192
    buffer_load_dwordx4 v10, s[20:23], s64 offen lds
    s_waitcnt lgkmcnt(3)
    v_mfma_f32_16x16x32_bf16 v[160:163], v[40:43], v[96:99], v[160:163]
    s_xor_b32 s66, s66, 128
    ds_read_b64_tr_b16 v[60:61], v18 offset:8192
    ds_read_b64_tr_b16 v[62:63], v18 offset:9216
    v_mfma_f32_16x16x32_bf16 v[160:163], v[44:47], v[100:103], v[160:163]
    v_add_u32 v18, 0x10000, v18
    v_accvgpr_write_b32 a211, 0
    v_mfma_f32_16x16x32_bf16 v[164:167], v[40:43], v[104:107], v[164:167]
    buffer_store_dwordx4 v[32:35], v1, s[36:39], s72 offen sc1
    v_mfma_f32_16x16x32_bf16 v[164:167], v[44:47], v[108:111], v[164:167]
    v_accvgpr_read_b32 v31, a217
    v_accvgpr_read_b32 v32, a216
    v_mfma_f32_16x16x32_bf16 v[168:171], v[40:43], v[112:115], v[168:171]
    v_cvt_pk_bf16_f32 v32, v32, v31
    v_accvgpr_read_b32 v33, a218
    v_mfma_f32_16x16x32_bf16 v[168:171], v[44:47], v[116:119], v[168:171]
    v_accvgpr_read_b32 v31, a219
    v_cvt_pk_bf16_f32 v33, v33, v31
    v_mfma_f32_16x16x32_bf16 v[172:175], v[40:43], v[120:123], v[172:175]
    ds_read_b64_tr_b16 v[40:41], v19 offset:0
    ds_read_b64_tr_b16 v[42:43], v19 offset:1024
    v_mfma_f32_16x16x32_bf16 v[172:175], v[44:47], v[124:127], v[172:175]
    ds_read_b64_tr_b16 v[44:45], v19 offset:8192
    ds_read_b64_tr_b16 v[46:47], v19 offset:9216
    v_mfma_f32_16x16x32_bf16 v[176:179], v[48:51], v[96:99], v[176:179]
    buffer_load_dwordx4 v11, s[20:23], s64 offen offset:1024 lds
    v_mfma_f32_16x16x32_bf16 v[176:179], v[52:55], v[100:103], v[176:179]
    ds_read_b128 v[72:75], v24 offset:24576
    v_add_u32 v19, 0x10000, v19
    v_mfma_f32_16x16x32_bf16 v[180:183], v[48:51], v[104:107], v[180:183]
    v_accvgpr_read_b32 v34, a220
    v_accvgpr_read_b32 v31, a221
    v_mfma_f32_16x16x32_bf16 v[180:183], v[52:55], v[108:111], v[180:183]
    v_cvt_pk_bf16_f32 v34, v34, v31
    v_accvgpr_read_b32 v35, a222
    v_mfma_f32_16x16x32_bf16 v[184:187], v[48:51], v[112:115], v[184:187]
    v_accvgpr_read_b32 v31, a223
    v_cvt_pk_bf16_f32 v35, v35, v31
    v_mfma_f32_16x16x32_bf16 v[184:187], v[52:55], v[116:119], v[184:187]
    v_accvgpr_write_b32 a212, 0
    v_accvgpr_write_b32 a213, 0
    v_mfma_f32_16x16x32_bf16 v[188:191], v[48:51], v[120:123], v[188:191]
    s_add_u32 s72, s71, 37888
    ds_read_b64_tr_b16 v[48:49], v20 offset:0
    ds_read_b64_tr_b16 v[50:51], v20 offset:1024
    v_mfma_f32_16x16x32_bf16 v[188:191], v[52:55], v[124:127], v[188:191]
    s_waitcnt lgkmcnt(2)
    ds_read_b64_tr_b16 v[52:53], v20 offset:8192
    ds_read_b64_tr_b16 v[54:55], v20 offset:9216
    v_mfma_f32_16x16x32_bf16 v[192:195], v[56:59], v[96:99], v[192:195]
    buffer_load_dwordx4 v12, s[20:23], s64 offen offset:2048 lds
    v_mfma_f32_16x16x32_bf16 v[192:195], v[60:63], v[100:103], v[192:195]
    v_add_u32 v20, 0x10000, v20
    v_accvgpr_write_b32 a214, 0
    v_mfma_f32_16x16x32_bf16 v[196:199], v[56:59], v[104:107], v[196:199]
    buffer_store_dwordx4 v[32:35], v1, s[36:39], s72 offen sc1
    v_mfma_f32_16x16x32_bf16 v[196:199], v[60:63], v[108:111], v[196:199]
    ds_read_b128 v[76:79], v25 offset:24576
    v_accvgpr_write_b32 a215, 0
    v_mfma_f32_16x16x32_bf16 v[200:203], v[56:59], v[112:115], v[200:203]
    v_accvgpr_write_b32 a216, 0
    v_accvgpr_write_b32 a217, 0
    v_mfma_f32_16x16x32_bf16 v[200:203], v[60:63], v[116:119], v[200:203]
    v_accvgpr_write_b32 a218, 0
    v_accvgpr_write_b32 a219, 0
    v_mfma_f32_16x16x32_bf16 v[204:207], v[56:59], v[120:123], v[204:207]
    ds_read_b64_tr_b16 v[56:57], v21 offset:0
    ds_read_b64_tr_b16 v[58:59], v21 offset:1024
    v_mfma_f32_16x16x32_bf16 v[204:207], v[60:63], v[124:127], v[204:207]
    ds_read_b64_tr_b16 v[60:61], v21 offset:8192
    ds_read_b64_tr_b16 v[62:63], v21 offset:9216
    v_mfma_f32_16x16x32_bf16 v[208:211], v[40:43], v[96:99], v[208:211]
    v_add_u32 v21, 0x10000, v21
    v_accvgpr_write_b32 a220, 0
    v_mfma_f32_16x16x32_bf16 v[208:211], v[44:47], v[100:103], v[208:211]
    buffer_load_dwordx4 v13, s[20:23], s64 offen offset:3072 lds
    v_mfma_f32_16x16x32_bf16 v[212:215], v[40:43], v[104:107], v[212:215]
    v_accvgpr_write_b32 a221, 0
    v_accvgpr_write_b32 a222, 0
    v_mfma_f32_16x16x32_bf16 v[212:215], v[44:47], v[108:111], v[212:215]
    v_accvgpr_write_b32 a223, 0
    v_mfma_f32_16x16x32_bf16 v[216:219], v[40:43], v[112:115], v[216:219]
    v_accvgpr_read_b32 v32, a224
    v_accvgpr_read_b32 v31, a225
    v_mfma_f32_16x16x32_bf16 v[216:219], v[44:47], v[116:119], v[216:219]
    v_cvt_pk_bf16_f32 v32, v32, v31
    v_accvgpr_read_b32 v33, a226
    v_mfma_f32_16x16x32_bf16 v[220:223], v[40:43], v[120:123], v[220:223]
    ds_read_b64_tr_b16 v[40:41], v26 offset:32768
    ds_read_b64_tr_b16 v[42:43], v26 offset:33280
    v_mfma_f32_16x16x32_bf16 v[220:223], v[44:47], v[124:127], v[220:223]
    s_waitcnt lgkmcnt(2)
    ds_read_b64_tr_b16 v[44:45], v26 offset:36864
    ds_read_b64_tr_b16 v[46:47], v26 offset:37376
    v_mfma_f32_16x16x32_bf16 v[224:227], v[48:51], v[96:99], v[224:227]
    v_add_u32 v26, 0xffff0000, v26
    v_accvgpr_read_b32 v31, a227
    v_mfma_f32_16x16x32_bf16 v[224:227], v[52:55], v[100:103], v[224:227]
    s_xor_b32 s64, s64, 1920
    v_cvt_pk_bf16_f32 v33, v33, v31
    v_accvgpr_read_b32 v34, a228
    v_mfma_f32_16x16x32_bf16 v[228:231], v[48:51], v[104:107], v[228:231]
    s_andn2_b32 s64, s64, 896
    v_accvgpr_read_b32 v31, a229
    v_cvt_pk_bf16_f32 v34, v34, v31
    v_mfma_f32_16x16x32_bf16 v[228:231], v[52:55], v[108:111], v[228:231]
    v_accvgpr_read_b32 v35, a230
    v_accvgpr_read_b32 v31, a231
    v_mfma_f32_16x16x32_bf16 v[232:235], v[48:51], v[112:115], v[232:235]
    v_cvt_pk_bf16_f32 v35, v35, v31
    v_mfma_f32_16x16x32_bf16 v[232:235], v[52:55], v[116:119], v[232:235]
    s_add_u32 m0, s69, 32768
    v_mfma_f32_16x16x32_bf16 v[236:239], v[48:51], v[120:123], v[236:239]
    buffer_load_dwordx4 v2, s[24:27], s60 offen lds
    v_mfma_f32_16x16x32_bf16 v[236:239], v[52:55], v[124:127], v[236:239]
    s_add_u32 s72, s71, 6144
    ds_read_b64_tr_b16 v[48:49], v27 offset:32768
    ds_read_b64_tr_b16 v[50:51], v27 offset:33280
    v_mfma_f32_16x16x32_bf16 v[240:243], v[56:59], v[96:99], v[240:243]
    ds_read_b64_tr_b16 v[52:53], v27 offset:36864
    ds_read_b64_tr_b16 v[54:55], v27 offset:37376
    v_mfma_f32_16x16x32_bf16 v[240:243], v[60:63], v[100:103], v[240:243]
    buffer_store_dwordx4 v[32:35], v1, s[36:39], s72 offen sc1
    v_mfma_f32_16x16x32_bf16 v[244:247], v[56:59], v[104:107], v[244:247]
    buffer_load_dwordx4 v3, s[24:27], s60 offen offset:1024 lds
    v_mfma_f32_16x16x32_bf16 v[244:247], v[60:63], v[108:111], v[244:247]
    v_add_u32 v27, 0xffff0000, v27
    v_mfma_f32_16x16x32_bf16 v[248:251], v[56:59], v[112:115], v[248:251]
    v_mfma_f32_16x16x32_bf16 v[248:251], v[60:63], v[116:119], v[248:251]
    v_mfma_f32_16x16x32_bf16 v[252:255], v[56:59], v[120:123], v[252:255]
    buffer_load_dwordx4 v4, s[24:27], s60 offen offset:2048 lds
    v_mfma_f32_16x16x32_bf16 v[252:255], v[60:63], v[124:127], v[252:255]
    s_waitcnt lgkmcnt(0)
    ds_read_b64_tr_b16 v[56:57], v28 offset:32768
    ds_read_b64_tr_b16 v[58:59], v28 offset:33280
    v_mfma_f32_16x16x32_bf16 a[64:67], v[40:43], v[96:99], a[64:67]
    ds_read_b64_tr_b16 v[60:61], v28 offset:36864
    ds_read_b64_tr_b16 v[62:63], v28 offset:37376
    v_mfma_f32_16x16x32_bf16 a[64:67], v[44:47], v[100:103], a[64:67]
    v_add_u32 v28, 0xffff0000, v28
    v_mfma_f32_16x16x32_bf16 a[68:71], v[40:43], v[104:107], a[68:71]
    buffer_load_dwordx4 v5, s[24:27], s60 offen offset:3072 lds
    v_mfma_f32_16x16x32_bf16 a[68:71], v[44:47], v[108:111], a[68:71]
    ds_read_b128 v[80:83], v24 offset:49152
    v_mfma_f32_16x16x32_bf16 a[72:75], v[40:43], v[112:115], a[72:75]
    v_mfma_f32_16x16x32_bf16 a[72:75], v[44:47], v[116:119], a[72:75]
    s_xor_b32 s60, s60, 7864320
    v_accvgpr_read_b32 v32, a232
    v_accvgpr_read_b32 v31, a233
    v_mfma_f32_16x16x32_bf16 a[76:79], v[40:43], v[120:123], a[76:79]
    s_add_u32 m0, s69, 49152
    ds_read_b128 v[84:87], v25 offset:49152
    v_cvt_pk_bf16_f32 v32, v32, v31
    v_mfma_f32_16x16x32_bf16 a[76:79], v[44:47], v[124:127], a[76:79]
    s_andn2_b32 s60, s60, 3670016
    buffer_load_dwordx4 v10, s[20:23], s63 offen lds
    v_mfma_f32_16x16x32_bf16 a[128:131], v[40:43], a[136:139], a[128:131]
    ds_read_b64_tr_b16 v[40:41], v29 offset:32768
    ds_read_b64_tr_b16 v[42:43], v29 offset:33280
    v_mfma_f32_16x16x32_bf16 a[128:131], v[44:47], a[140:143], a[128:131]
    ds_read_b64_tr_b16 v[44:45], v29 offset:36864
    ds_read_b64_tr_b16 v[46:47], v29 offset:37376
    v_mfma_f32_16x16x32_bf16 a[80:83], v[48:51], v[96:99], a[80:83]
    buffer_load_dwordx4 v11, s[20:23], s63 offen offset:1024 lds
    v_mfma_f32_16x16x32_bf16 a[80:83], v[52:55], v[100:103], a[80:83]
    ds_read_b128 v[88:91], v24 offset:57344
    v_add_u32 v29, 0xffff0000, v29
    v_mfma_f32_16x16x32_bf16 a[84:87], v[48:51], v[104:107], a[84:87]
    v_accvgpr_read_b32 v33, a234
    v_accvgpr_read_b32 v31, a235
    v_mfma_f32_16x16x32_bf16 a[84:87], v[52:55], v[108:111], a[84:87]
    v_cvt_pk_bf16_f32 v33, v33, v31
    v_accvgpr_read_b32 v34, a236
    v_mfma_f32_16x16x32_bf16 a[88:91], v[48:51], v[112:115], a[88:91]
    buffer_load_dwordx4 v12, s[20:23], s63 offen offset:2048 lds
    v_mfma_f32_16x16x32_bf16 a[88:91], v[52:55], v[116:119], a[88:91]
    ds_read_b128 v[92:95], v25 offset:57344
    v_accvgpr_read_b32 v31, a237
    v_mfma_f32_16x16x32_bf16 a[92:95], v[48:51], v[120:123], a[92:95]
    s_add_u32 s72, s71, 7168
    v_cvt_pk_bf16_f32 v34, v34, v31
    v_accvgpr_read_b32 v35, a238
    v_mfma_f32_16x16x32_bf16 a[92:95], v[52:55], v[124:127], a[92:95]
    v_accvgpr_read_b32 v31, a239
    v_cvt_pk_bf16_f32 v35, v35, v31
    v_mfma_f32_16x16x32_bf16 a[132:135], v[48:51], a[136:139], a[132:135]
    buffer_load_dwordx4 v13, s[20:23], s63 offen offset:3072 lds
    v_mfma_f32_16x16x32_bf16 a[132:135], v[52:55], a[140:143], a[132:135]
    s_waitcnt lgkmcnt(1)
    v_mfma_f32_16x16x32_bf16 a[96:99], v[56:59], v[96:99], a[96:99]
    v_mfma_f32_16x16x32_bf16 a[96:99], v[60:63], v[100:103], a[96:99]
    s_xor_b32 s63, s63, 128
    v_mfma_f32_16x16x32_bf16 a[100:103], v[56:59], v[104:107], a[100:103]
    buffer_store_dwordx4 v[32:35], v1, s[36:39], s72 offen sc1
    v_mfma_f32_16x16x32_bf16 a[100:103], v[60:63], v[108:111], a[100:103]
    v_mfma_f32_16x16x32_bf16 a[104:107], v[56:59], v[112:115], a[104:107]
    v_mfma_f32_16x16x32_bf16 a[104:107], v[60:63], v[116:119], a[104:107]
    s_waitcnt vmcnt(10) lgkmcnt(0)
    s_barrier
    ds_read_b64_tr_b16 v[48:49], v14 offset:0
    v_mfma_f32_16x16x32_bf16 a[108:111], v[56:59], v[120:123], a[108:111]
    s_add_u32 m0, s69, 65536
    ds_read_b64_tr_b16 v[50:51], v14 offset:1024
    ds_read_b64_tr_b16 v[52:53], v14 offset:8192
    v_mfma_f32_16x16x32_bf16 a[108:111], v[60:63], v[124:127], a[108:111]
    buffer_load_dwordx4 v2, s[24:27], s60 offen lds
    v_mfma_f32_16x16x32_bf16 a[112:115], v[40:43], v[96:99], a[112:115]
    ds_read_b64_tr_b16 v[54:55], v14 offset:9216
    ds_read_b64_tr_b16 v[56:57], v15 offset:0
    v_mfma_f32_16x16x32_bf16 a[112:115], v[44:47], v[100:103], a[112:115]
    ds_read_b64_tr_b16 v[58:59], v15 offset:1024
    ds_read_b64_tr_b16 v[60:61], v15 offset:8192
    v_mfma_f32_16x16x32_bf16 a[116:119], v[40:43], v[104:107], a[116:119]
    ds_read_b64_tr_b16 v[62:63], v15 offset:9216
    ds_read_b128 a[136:139], v22 offset:0
    v_mfma_f32_16x16x32_bf16 a[116:119], v[44:47], v[108:111], a[116:119]
    ds_read_b128 a[140:143], v23 offset:0
    v_add_u32 v14, 0xfffe0000, v14
    v_mfma_f32_16x16x32_bf16 a[120:123], v[40:43], v[112:115], a[120:123]
    v_add_u32 v15, 0xfffe0000, v15
    v_add_u32 v22, 0x10000, v22
    v_mfma_f32_16x16x32_bf16 a[120:123], v[44:47], v[116:119], a[120:123]
    buffer_load_dwordx4 v3, s[24:27], s60 offen offset:1024 lds
    v_mfma_f32_16x16x32_bf16 a[124:127], v[40:43], v[120:123], a[124:127]
    ds_read_b64_tr_b16 v[40:41], v16 offset:0
    ds_read_b64_tr_b16 v[42:43], v16 offset:1024
    v_mfma_f32_16x16x32_bf16 a[124:127], v[44:47], v[124:127], a[124:127]
    s_waitcnt lgkmcnt(3)
    ds_read_b64_tr_b16 v[44:45], v16 offset:8192
    ds_read_b64_tr_b16 v[46:47], v16 offset:9216
    v_mfma_f32_16x16x32_bf16 v[128:131], v[48:51], v[64:67], v[128:131]
    v_add_u32 v16, 0xfffe0000, v16
    v_add_u32 v23, 0x10000, v23
    v_mfma_f32_16x16x32_bf16 v[128:131], v[52:55], v[68:71], v[128:131]
    v_add_u32 v24, 0x10000, v24
    v_accvgpr_read_b32 v32, a240
    v_mfma_f32_16x16x32_bf16 v[132:135], v[48:51], v[72:75], v[132:135]
    ds_read_b128 v[96:99], v24 offset:16384
    v_accvgpr_read_b32 v31, a241
    v_mfma_f32_16x16x32_bf16 v[132:135], v[52:55], v[76:79], v[132:135]
    v_cvt_pk_bf16_f32 v32, v32, v31
    v_accvgpr_read_b32 v33, a242
    v_mfma_f32_16x16x32_bf16 v[136:139], v[48:51], v[80:83], v[136:139]
    v_accvgpr_read_b32 v31, a243
    v_cvt_pk_bf16_f32 v33, v33, v31
    v_mfma_f32_16x16x32_bf16 v[136:139], v[52:55], v[84:87], v[136:139]
    s_add_u32 s72, s71, 38912
    buffer_load_dwordx4 v4, s[24:27], s60 offen offset:2048 lds
    v_mfma_f32_16x16x32_bf16 v[140:143], v[48:51], v[88:91], v[140:143]
    ds_read_b64_tr_b16 v[48:49], v17 offset:0
    ds_read_b64_tr_b16 v[50:51], v17 offset:1024
    v_mfma_f32_16x16x32_bf16 v[140:143], v[52:55], v[92:95], v[140:143]
    ds_read_b64_tr_b16 v[52:53], v17 offset:8192
    ds_read_b64_tr_b16 v[54:55], v17 offset:9216
    v_mfma_f32_16x16x32_bf16 v[144:147], v[56:59], v[64:67], v[144:147]
    v_add_u32 v17, 0xfffe0000, v17
    v_accvgpr_read_b32 v34, a244
    v_mfma_f32_16x16x32_bf16 v[144:147], v[60:63], v[68:71], v[144:147]
    v_accvgpr_read_b32 v31, a245
    v_cvt_pk_bf16_f32 v34, v34, v31
    v_mfma_f32_16x16x32_bf16 v[148:151], v[56:59], v[72:75], v[148:151]
    v_accvgpr_read_b32 v35, a246
    v_accvgpr_read_b32 v31, a247
    v_mfma_f32_16x16x32_bf16 v[148:151], v[60:63], v[76:79], v[148:151]
    v_cvt_pk_bf16_f32 v35, v35, v31
    v_mov_b32 v2, v1
    v_mfma_f32_16x16x32_bf16 v[152:155], v[56:59], v[80:83], v[152:155]
    buffer_load_dwordx4 v5, s[24:27], s60 offen offset:3072 lds
    v_mfma_f32_16x16x32_bf16 v[152:155], v[60:63], v[84:87], v[152:155]
    v_add_u32 v25, 0x10000, v25
    ds_read_b128 v[100:103], v25 offset:16384
    v_mfma_f32_16x16x32_bf16 v[156:159], v[56:59], v[88:91], v[156:159]
    ds_read_b64_tr_b16 v[56:57], v18 offset:0
    ds_read_b64_tr_b16 v[58:59], v18 offset:1024
    v_mfma_f32_16x16x32_bf16 v[156:159], v[60:63], v[92:95], v[156:159]
    s_waitcnt lgkmcnt(3)
    ds_read_b64_tr_b16 v[60:61], v18 offset:8192
    ds_read_b64_tr_b16 v[62:63], v18 offset:9216
    v_mfma_f32_16x16x32_bf16 v[160:163], v[40:43], v[64:67], v[160:163]
    buffer_store_dwordx4 v[32:35], v1, s[36:39], s72 offen sc1
    v_mfma_f32_16x16x32_bf16 v[160:163], v[44:47], v[68:71], v[160:163]
    v_add_u32 v18, 0xfffe0000, v18
    v_mfma_f32_16x16x32_bf16 v[164:167], v[40:43], v[72:75], v[164:167]
    v_mfma_f32_16x16x32_bf16 v[164:167], v[44:47], v[76:79], v[164:167]
    s_add_u32 m0, s69, 81920
    v_accvgpr_read_b32 v32, a248
    v_accvgpr_read_b32 v31, a249
    v_mfma_f32_16x16x32_bf16 v[168:171], v[40:43], v[80:83], v[168:171]
    s_xor_b32 s60, s60, 524288
    buffer_load_dwordx4 v10, s[20:23], s64 offen lds
    v_mfma_f32_16x16x32_bf16 v[168:171], v[44:47], v[84:87], v[168:171]
    s_mov_b32 s60, 131072
    v_cvt_pk_bf16_f32 v32, v32, v31
    v_accvgpr_read_b32 v33, a250
    v_mfma_f32_16x16x32_bf16 v[172:175], v[40:43], v[88:91], v[172:175]
    ds_read_b64_tr_b16 v[40:41], v19 offset:0
    ds_read_b64_tr_b16 v[42:43], v19 offset:1024
    v_mfma_f32_16x16x32_bf16 v[172:175], v[44:47], v[92:95], v[172:175]
    ds_read_b64_tr_b16 v[44:45], v19 offset:8192
    ds_read_b64_tr_b16 v[46:47], v19 offset:9216
    v_mfma_f32_16x16x32_bf16 v[176:179], v[48:51], v[64:67], v[176:179]
    ds_read_b128 v[104:107], v24 offset:24576
    v_add_u32 v19, 0xfffe0000, v19
    v_mfma_f32_16x16x32_bf16 v[176:179], v[52:55], v[68:71], v[176:179]
    v_accvgpr_read_b32 v31, a251
    v_cvt_pk_bf16_f32 v33, v33, v31
    v_mfma_f32_16x16x32_bf16 v[180:183], v[48:51], v[72:75], v[180:183]
    v_accvgpr_read_b32 v34, a252
    v_accvgpr_read_b32 v31, a253
    v_mfma_f32_16x16x32_bf16 v[180:183], v[52:55], v[76:79], v[180:183]
    buffer_load_dwordx4 v11, s[20:23], s64 offen offset:1024 lds
    v_mfma_f32_16x16x32_bf16 v[184:187], v[48:51], v[80:83], v[184:187]
    v_cvt_pk_bf16_f32 v34, v34, v31
    v_accvgpr_read_b32 v35, a254
    v_mfma_f32_16x16x32_bf16 v[184:187], v[52:55], v[84:87], v[184:187]
    v_accvgpr_read_b32 v31, a255
    v_cvt_pk_bf16_f32 v35, v35, v31
    v_mfma_f32_16x16x32_bf16 v[188:191], v[48:51], v[88:91], v[188:191]
    s_add_u32 s72, s71, 39936
    ds_read_b64_tr_b16 v[48:49], v20 offset:0
    ds_read_b64_tr_b16 v[50:51], v20 offset:1024
    v_mfma_f32_16x16x32_bf16 v[188:191], v[52:55], v[92:95], v[188:191]
    s_waitcnt lgkmcnt(2)
    ds_read_b64_tr_b16 v[52:53], v20 offset:8192
    ds_read_b64_tr_b16 v[54:55], v20 offset:9216
    v_mfma_f32_16x16x32_bf16 v[192:195], v[56:59], v[64:67], v[192:195]
    v_mov_b32 v31, 1
    v_add_u32 v20, 0xfffe0000, v20
    v_mfma_f32_16x16x32_bf16 v[192:195], v[60:63], v[68:71], v[192:195]
    buffer_store_dwordx4 v[32:35], v1, s[36:39], s72 offen sc1
    v_mfma_f32_16x16x32_bf16 v[196:199], v[56:59], v[72:75], v[196:199]
    v_add_u32 v11, s99, v39
    v_mfma_f32_16x16x32_bf16 v[196:199], v[60:63], v[76:79], v[196:199]
    s_mul_i32 s99, s98, 6
    buffer_load_dwordx4 v12, s[20:23], s64 offen offset:2048 lds
    v_mfma_f32_16x16x32_bf16 v[200:203], v[56:59], v[80:83], v[200:203]
    s_sub_u32 s99, s8, s99
    ds_read_b128 v[108:111], v25 offset:24576
    v_mfma_f32_16x16x32_bf16 v[200:203], v[60:63], v[84:87], v[200:203]
    s_mul_i32 s99, s99, 6
    v_mfma_f32_16x16x32_bf16 v[204:207], v[56:59], v[88:91], v[204:207]
    s_lshr_b32 s8, s5, 3
    ds_read_b64_tr_b16 v[56:57], v21 offset:0
    ds_read_b64_tr_b16 v[58:59], v21 offset:1024
    v_mfma_f32_16x16x32_bf16 v[204:207], v[60:63], v[92:95], v[204:207]
    s_lshl1_add_u32 s99, s4, s99
    ds_read_b64_tr_b16 v[60:61], v21 offset:8192
    ds_read_b64_tr_b16 v[62:63], v21 offset:9216
    v_mfma_f32_16x16x32_bf16 v[208:211], v[40:43], v[64:67], v[208:211]
    s_mul_i32 s8, s8, 6
    v_add_u32 v21, 0xfffe0000, v21
    v_mfma_f32_16x16x32_bf16 v[208:211], v[44:47], v[68:71], v[208:211]
    s_cmp_lt_u32 s98, 6
    s_cselect_b32 s98, s98, 40
    v_mfma_f32_16x16x32_bf16 v[212:215], v[40:43], v[72:75], v[212:215]
    s_sub_u32 s99, s99, 2
    buffer_load_dwordx4 v13, s[20:23], s64 offen offset:3072 lds
    v_mfma_f32_16x16x32_bf16 v[212:215], v[44:47], v[76:79], v[212:215]
    s_add_u32 s98, s98, s8
    v_mfma_f32_16x16x32_bf16 v[216:219], v[40:43], v[80:83], v[216:219]
    s_lshl_b32 s8, s99, 5
    v_lshl_add_u32 v10, v38, 4, s8
    v_lshrrev_b32 v38, 2, v37
    v_mfma_f32_16x16x32_bf16 v[216:219], v[44:47], v[84:87], v[216:219]
    s_lshr_b32 s99, s99, 1
    v_lshl_add_u32 v38, s98, 2, v38
    v_mul_u32_u24 v39, 171, v38
    v_mfma_f32_16x16x32_bf16 v[220:223], v[40:43], v[88:91], v[220:223]
    s_add_u32 s98, s98, 128
    ds_read_b64_tr_b16 v[40:41], v26 offset:0
    ds_read_b64_tr_b16 v[42:43], v26 offset:512
    v_mfma_f32_16x16x32_bf16 v[220:223], v[44:47], v[92:95], v[220:223]
    s_add_u32 s8, s100, 16
    ds_read_b64_tr_b16 v[44:45], v26 offset:4096
    ds_read_b64_tr_b16 v[46:47], v26 offset:4608
    s_waitcnt lgkmcnt(4)
    v_mfma_f32_16x16x32_bf16 v[224:227], v[48:51], v[64:67], v[224:227]
    v_add_u32 v26, 0x10000, v26
    v_and_b32 v37, 3, v37
    v_mfma_f32_16x16x32_bf16 v[224:227], v[52:55], v[68:71], v[224:227]
    s_xor_b32 s64, s64, 128
    v_lshrrev_b32 v39, 9, v39
    v_lshl_add_u32 v37, v38, 3, v37
    v_mfma_f32_16x16x32_bf16 v[228:231], v[48:51], v[72:75], v[228:231]
    v_mul_u32_u24 v38, 24, v39
    v_sub_u32 v37, v37, v38
    v_mfma_f32_16x16x32_bf16 v[228:231], v[52:55], v[76:79], v[228:231]
    v_mad_u32_u24 v39, v39, 18, v37
    v_mul_u32_u24 v39, 1152, v39
    v_mfma_f32_16x16x32_bf16 v[232:235], v[48:51], v[80:83], v[232:235]
    v_add_u32 v39, v39, v10
    v_add_u32 v12, 0, v39
    v_mfma_f32_16x16x32_bf16 v[232:235], v[52:55], v[84:87], v[232:235]
    s_add_u32 m0, s67, 98304
    v_mov_b32 v38, 1073741824
    v_cmp_gt_u32 vcc, 18, v37
    v_mfma_f32_16x16x32_bf16 v[236:239], v[48:51], v[88:91], v[236:239]
    buffer_load_dwordx4 v1, s[28:31], s65 offen sc1 lds
    v_mfma_f32_16x16x32_bf16 v[236:239], v[52:55], v[92:95], v[236:239]
    ds_read_b64_tr_b16 v[48:49], v27 offset:0
    ds_read_b64_tr_b16 v[50:51], v27 offset:512
    v_mfma_f32_16x16x32_bf16 v[240:243], v[56:59], v[64:67], v[240:243]
    ds_read_b64_tr_b16 v[52:53], v27 offset:4096
    ds_read_b64_tr_b16 v[54:55], v27 offset:4608
    v_mfma_f32_16x16x32_bf16 v[240:243], v[60:63], v[68:71], v[240:243]
    v_add_u32 v27, 0x10000, v27
    v_cndmask_b32 v12, v38, v12, vcc
    v_mfma_f32_16x16x32_bf16 v[244:247], v[56:59], v[72:75], v[244:247]
    v_add_u32 v38, 1024, v36
    v_add_u32 v13, 4608, v39
    v_mfma_f32_16x16x32_bf16 v[244:247], v[60:63], v[76:79], v[244:247]
    s_cmp_eq_u32 s4, 0
    s_cselect_b64 vcc, -1, 0
    v_cndmask_b32 v12, v12, v38, vcc
    v_mfma_f32_16x16x32_bf16 v[248:251], v[56:59], v[80:83], v[248:251]
    v_mov_b32 v38, 1073741824
    v_cmp_gt_u32 vcc, 14, v37
    v_mfma_f32_16x16x32_bf16 v[248:251], v[60:63], v[84:87], v[248:251]
    v_lshrrev_b32 v37, 8, v1
    v_cndmask_b32 v13, v38, v13, vcc
    v_mfma_f32_16x16x32_bf16 v[252:255], v[56:59], v[88:91], v[252:255]
    ds_read_b64_tr_b16 v[56:57], v28 offset:0
    ds_read_b64_tr_b16 v[58:59], v28 offset:512
    v_mfma_f32_16x16x32_bf16 v[252:255], v[60:63], v[92:95], v[252:255]
    s_waitcnt lgkmcnt(2)
    ds_read_b64_tr_b16 v[60:61], v28 offset:4096
    ds_read_b64_tr_b16 v[62:63], v28 offset:4608
    v_mfma_f32_16x16x32_bf16 a[64:67], v[40:43], v[64:67], a[64:67]
    buffer_load_dwordx4 v1, s[28:31], s65 offen offset:1024 sc1 lds
    v_mfma_f32_16x16x32_bf16 a[64:67], v[44:47], v[68:71], a[64:67]
    v_add_u32 v24, 0xfffe0000, v24
    v_add_u32 v28, 0x10000, v28
    v_mfma_f32_16x16x32_bf16 a[68:71], v[40:43], v[72:75], a[68:71]
    ds_read_b128 v[112:115], v24 offset:16384
    v_add_u32 v38, 19456, v36
    v_mfma_f32_16x16x32_bf16 a[68:71], v[44:47], v[76:79], a[68:71]
    s_cmp_eq_u32 s4, 0
    s_cselect_b64 vcc, -1, 0
    v_cndmask_b32 v13, v13, v38, vcc
    v_mfma_f32_16x16x32_bf16 a[72:75], v[40:43], v[80:83], a[72:75]
    s_cmp_eq_u32 s4, 0
    s_cselect_b32 s98, s7, s98
    s_cselect_b32 s99, s8, s99
    v_mfma_f32_16x16x32_bf16 a[72:75], v[44:47], v[84:87], a[72:75]
    s_lshr_b32 s9, s99, 2
    v_add_u32 v25, 0xfffe0000, v25
    v_bfe_u32 v36, v1, 4, 4
    v_mfma_f32_16x16x32_bf16 a[76:79], v[40:43], v[88:91], a[76:79]
    s_lshr_b32 s92, s2, 3
    ds_read_b128 v[116:119], v25 offset:16384
    v_lshrrev_b32 v9, 4, v1
    v_mfma_f32_16x16x32_bf16 a[76:79], v[44:47], v[92:95], a[76:79]
    s_lshl2_add_u32 s92, s92, s4
    v_min_u32 v9, 0, v9
    v_lshlrev_b32 v37, 2, v37
    v_mfma_f32_16x16x32_bf16 a[128:131], v[40:43], a[136:139], a[128:131]
    s_mul_i32 s92, s92, 1
    ds_read_b64_tr_b16 v[40:41], v29 offset:0
    ds_read_b64_tr_b16 v[42:43], v29 offset:512
    v_mfma_f32_16x16x32_bf16 a[128:131], v[44:47], a[140:143], a[128:131]
    s_add_u32 s92, s92, 32
    v_add_lshl_u32 v9, v9, s92, 7
    ds_read_b64_tr_b16 v[44:45], v29 offset:4096
    v_mfma_f32_16x16x32_bf16 a[80:83], v[48:51], v[64:67], a[80:83]
    s_add_u32 m0, s68, 106496
    ds_read_b128 v[120:123], v24 offset:24576
    ds_read_b64_tr_b16 v[46:47], v29 offset:4608
    v_mfma_f32_16x16x32_bf16 a[80:83], v[52:55], v[68:71], a[80:83]
    s_getpc_b64 s[92:93]
    global_load_dword v9, v9, s[92:93]
    v_mfma_f32_16x16x32_bf16 a[84:87], v[48:51], v[72:75], a[84:87]
    s_sub_u32 s9, s9, s10
    buffer_load_dwordx4 v6, s[20:23], s66 offen lds
    v_mfma_f32_16x16x32_bf16 a[84:87], v[52:55], v[76:79], a[84:87]
    s_sub_u32 s9, s9, 1
    v_add_u32 v29, 0x10000, v29
    v_sub_u32 v36, v36, v37
    v_mfma_f32_16x16x32_bf16 a[88:91], v[48:51], v[80:83], a[88:91]
    s_and_b32 s9, s9, 3
    ds_read_b128 v[124:127], v25 offset:24576
    v_mov_b32 v37, 0xf149f2ca
    v_mfma_f32_16x16x32_bf16 a[88:91], v[52:55], v[84:87], a[88:91]
    s_lshl_b32 s9, s9, 1
    v_bfe_u32 v38, v1, 4, 1
    v_sub_u32 v38, 0, v38
    v_mfma_f32_16x16x32_bf16 a[92:95], v[48:51], v[88:91], a[92:95]
    s_and_b32 s10, s99, 3
    v_and_b32 v38, 0xaaaaaaaa, v38
    v_and_b32 v39, 0x40, v1
    v_mfma_f32_16x16x32_bf16 a[92:95], v[52:55], v[92:95], a[92:95]
    s_cmp_eq_u32 s9, 6
    s_cselect_b32 s9, 7, s9
    v_mfma_f32_16x16x32_bf16 a[132:135], v[48:51], a[136:139], a[132:135]
    s_mul_i32 s10, s10, 9
    v_mfma_f32_16x16x32_bf16 a[132:135], v[52:55], a[140:143], a[132:135]
    s_add_u32 s9, s9, s10
    s_waitcnt lgkmcnt(0)
    v_mfma_f32_16x16x32_bf16 a[96:99], v[56:59], v[64:67], a[96:99]
    s_lshl_b32 s64, s9, 10
    v_mfma_f32_16x16x32_bf16 a[96:99], v[60:63], v[68:71], a[96:99]
    s_xor_b32 s65, s65, 122880
    v_mfma_f32_16x16x32_bf16 a[100:103], v[56:59], v[72:75], a[100:103]
    s_xor_b32 s66, s66, 1920
    v_mfma_f32_16x16x32_bf16 a[100:103], v[60:63], v[76:79], a[100:103]
    s_andn2_b32 s65, s65, 57344
    v_mfma_f32_16x16x32_bf16 a[104:107], v[56:59], v[80:83], a[104:107]
    s_andn2_b32 s66, s66, 896
    v_mfma_f32_16x16x32_bf16 a[104:107], v[60:63], v[84:87], a[104:107]
    s_waitcnt vmcnt(4) lgkmcnt(0)
    s_barrier
    ds_read_b64_tr_b16 v[48:49], v14 offset:32768
    v_mfma_f32_16x16x32_bf16 a[108:111], v[56:59], v[88:91], a[108:111]
    s_add_u32 m0, s67, 131072
    buffer_store_dword v31, v30, s[32:35], s101 offen sc1
    v_mfma_f32_16x16x32_bf16 a[108:111], v[60:63], v[92:95], a[108:111]
    s_sub_u32 s9, s99, 16
    buffer_load_dwordx4 v1, s[28:31], s65 offen sc1 lds
    v_mfma_f32_16x16x32_bf16 a[112:115], v[40:43], v[64:67], a[112:115]
    s_mul_i32 s9, s9, 18432
    ds_read_b64_tr_b16 v[50:51], v14 offset:33792
    ds_read_b64_tr_b16 v[52:53], v14 offset:40960
    v_mfma_f32_16x16x32_bf16 a[112:115], v[44:47], v[68:71], a[112:115]
    s_add_u32 s9, s9, 6144
    ds_read_b64_tr_b16 v[54:55], v14 offset:41984
    ds_read_b64_tr_b16 v[56:57], v15 offset:32768
    v_mfma_f32_16x16x32_bf16 a[116:119], v[40:43], v[72:75], a[116:119]
    s_mov_b32 s10, 1024
    ds_read_b64_tr_b16 v[58:59], v15 offset:33792
    ds_read_b64_tr_b16 v[60:61], v15 offset:40960
    v_mfma_f32_16x16x32_bf16 a[116:119], v[44:47], v[76:79], a[116:119]
    s_mul_i32 s98, s98, 36864
    ds_read_b64_tr_b16 v[62:63], v15 offset:41984
    v_add_u32 v14, 0x10000, v14
    v_mfma_f32_16x16x32_bf16 a[120:123], v[40:43], v[80:83], a[120:123]
    s_mul_i32 s7, s7, 36864
    v_add_u32 v15, 0x10000, v15
    v_mfma_f32_16x16x32_bf16 a[120:123], v[44:47], v[84:87], a[120:123]
    s_cmp_lt_u32 s99, 16
    s_cselect_b32 s64, s64, s9
    s_cselect_b32 s10, s10, 9216
    v_mfma_f32_16x16x32_bf16 a[124:127], v[40:43], v[88:91], a[124:127]
    s_lshl2_add_u32 s99, s100, s4
    ds_read_b64_tr_b16 v[40:41], v16 offset:32768
    ds_read_b64_tr_b16 v[42:43], v16 offset:33792
    v_mfma_f32_16x16x32_bf16 a[124:127], v[44:47], v[92:95], a[124:127]
    s_add_u32 s64, s64, s98
    ds_read_b64_tr_b16 v[44:45], v16 offset:40960
    ds_read_b64_tr_b16 v[46:47], v16 offset:41984
    s_waitcnt lgkmcnt(5)
    v_mfma_f32_16x16x32_bf16 v[128:131], v[48:51], v[96:99], v[128:131]
    s_lshl_b32 s99, s99, 1
    v_add_u32 v16, 0x10000, v16
    v_mfma_f32_16x16x32_bf16 v[128:131], v[52:55], v[100:103], v[128:131]
    s_add_u32 s62, s64, s10
    v_mfma_f32_16x16x32_bf16 v[132:135], v[48:51], v[104:107], v[132:135]
    s_lshr_b32 s9, s99, 2
    ds_read_b128 v[64:67], v24 offset:49152
    v_mfma_f32_16x16x32_bf16 v[132:135], v[52:55], v[108:111], v[132:135]
    s_lshr_b32 s10, s5, 3
    v_mfma_f32_16x16x32_bf16 v[136:139], v[48:51], v[112:115], v[136:139]
    s_sub_u32 s9, s9, s10
    v_mfma_f32_16x16x32_bf16 v[136:139], v[52:55], v[116:119], v[136:139]
    s_sub_u32 s9, s9, 1
    v_mfma_f32_16x16x32_bf16 v[140:143], v[48:51], v[120:123], v[140:143]
    s_and_b32 s9, s9, 3
    ds_read_b64_tr_b16 v[48:49], v17 offset:32768
    ds_read_b64_tr_b16 v[50:51], v17 offset:33792
    v_mfma_f32_16x16x32_bf16 v[140:143], v[52:55], v[124:127], v[140:143]
    s_lshl_b32 s9, s9, 1
    ds_read_b64_tr_b16 v[52:53], v17 offset:40960
    ds_read_b64_tr_b16 v[54:55], v17 offset:41984
    v_mfma_f32_16x16x32_bf16 v[144:147], v[56:59], v[96:99], v[144:147]
    s_and_b32 s10, s99, 3
    ds_read_b128 v[68:71], v25 offset:49152
    v_add_u32 v17, 0x10000, v17
    s_waitcnt lgkmcnt(5)
    v_mfma_f32_16x16x32_bf16 v[144:147], v[60:63], v[100:103], v[144:147]
    s_cmp_eq_u32 s9, 6
    s_cselect_b32 s9, 7, s9
    v_mfma_f32_16x16x32_bf16 v[148:151], v[56:59], v[104:107], v[148:151]
    s_mul_i32 s10, s10, 9
    buffer_load_dwordx4 v1, s[28:31], s65 offen offset:1024 sc1 lds
    v_mfma_f32_16x16x32_bf16 v[148:151], v[60:63], v[108:111], v[148:151]
    s_add_u32 s9, s9, s10
    v_mfma_f32_16x16x32_bf16 v[152:155], v[56:59], v[112:115], v[152:155]
    s_lshl_b32 s63, s9, 10
    v_mfma_f32_16x16x32_bf16 v[152:155], v[60:63], v[116:119], v[152:155]
    s_cmp_eq_u32 s4, 0
    s_cselect_b32 s8, 1.0, 0
    v_mfma_f32_16x16x32_bf16 v[156:159], v[56:59], v[120:123], v[156:159]
    s_add_u32 s63, s63, s7
    ds_read_b128 v[72:75], v24 offset:57344
    ds_read_b64_tr_b16 v[56:57], v18 offset:32768
    v_mfma_f32_16x16x32_bf16 v[156:159], v[60:63], v[124:127], v[156:159]
    s_mov_b32 s93, 65536
    ds_read_b64_tr_b16 v[58:59], v18 offset:33792
    ds_read_b64_tr_b16 v[60:61], v18 offset:40960
    v_mfma_f32_16x16x32_bf16 v[160:163], v[40:43], v[96:99], v[160:163]
    ds_read_b64_tr_b16 v[62:63], v18 offset:41984
    v_add_u32 v18, 0x10000, v18
    v_mfma_f32_16x16x32_bf16 v[160:163], v[44:47], v[100:103], v[160:163]
    s_cmp_eq_u32 s4, 1
    s_cselect_b32 s9, 1.0, 0
    v_mfma_f32_16x16x32_bf16 v[164:167], v[40:43], v[104:107], v[164:167]
    s_cmp_eq_u32 s6, 0
    s_cselect_b32 s16, s8, 0
    s_cselect_b32 s17, s9, 0
    v_mfma_f32_16x16x32_bf16 v[164:167], v[44:47], v[108:111], v[164:167]
    s_cmp_eq_u32 s4, 2
    s_cselect_b32 s10, 1.0, 0
    v_mfma_f32_16x16x32_bf16 v[168:171], v[40:43], v[112:115], v[168:171]
    ds_read_b128 v[76:79], v25 offset:57344
    v_mfma_f32_16x16x32_bf16 v[168:171], v[44:47], v[116:119], v[168:171]
    s_cmp_eq_u32 s6, 0
    s_cselect_b32 s18, s10, 0
    s_cselect_b32 s19, s11, 0
    v_mfma_f32_16x16x32_bf16 v[172:175], v[40:43], v[120:123], v[172:175]
    ds_read_b64_tr_b16 v[40:41], v19 offset:32768
    ds_read_b64_tr_b16 v[42:43], v19 offset:33792
    v_mfma_f32_16x16x32_bf16 v[172:175], v[44:47], v[124:127], v[172:175]
    s_waitcnt lgkmcnt(3)
    ds_read_b64_tr_b16 v[44:45], v19 offset:40960
    ds_read_b64_tr_b16 v[46:47], v19 offset:41984
    v_mfma_f32_16x16x32_bf16 v[176:179], v[48:51], v[96:99], v[176:179]
    v_add_u32 v19, 0x10000, v19
    v_mfma_f32_16x16x32_bf16 v[176:179], v[52:55], v[100:103], v[176:179]
    v_mfma_f32_16x16x32_bf16 v[180:183], v[48:51], v[104:107], v[180:183]
    v_mfma_f32_16x16x32_bf16 v[180:183], v[52:55], v[108:111], v[180:183]
    v_add_u32 v24, 0x10000, v24
    v_mfma_f32_16x16x32_bf16 v[184:187], v[48:51], v[112:115], v[184:187]
    ds_read_b128 v[80:83], v24 offset:16384
    v_mfma_f32_16x16x32_bf16 v[184:187], v[52:55], v[116:119], v[184:187]
    s_add_u32 m0, s68, 139264
    v_mfma_f32_16x16x32_bf16 v[188:191], v[48:51], v[120:123], v[188:191]
    buffer_load_dwordx4 v6, s[20:23], s66 offen lds
    v_mfma_f32_16x16x32_bf16 v[188:191], v[52:55], v[124:127], v[188:191]
    ds_read_b64_tr_b16 v[48:49], v20 offset:32768
    ds_read_b64_tr_b16 v[50:51], v20 offset:33792
    v_mfma_f32_16x16x32_bf16 v[192:195], v[56:59], v[96:99], v[192:195]
    ds_read_b64_tr_b16 v[52:53], v20 offset:40960
    ds_read_b64_tr_b16 v[54:55], v20 offset:41984
    v_mfma_f32_16x16x32_bf16 v[192:195], v[60:63], v[100:103], v[192:195]
    v_add_u32 v25, 0x10000, v25
    v_add_u32 v20, 0x10000, v20
    v_mfma_f32_16x16x32_bf16 v[196:199], v[56:59], v[104:107], v[196:199]
    ds_read_b128 v[84:87], v25 offset:16384
    v_mfma_f32_16x16x32_bf16 v[196:199], v[60:63], v[108:111], v[196:199]
    s_cmp_eq_u32 s6, 0
    s_cselect_b32 s20, s12, 0
    s_cselect_b32 s21, s13, 0
    v_mfma_f32_16x16x32_bf16 v[200:203], v[56:59], v[112:115], v[200:203]
    s_cmp_eq_u32 s6, 0
    s_cselect_b32 s22, s14, 0
    s_cselect_b32 s23, s15, 0
    v_mfma_f32_16x16x32_bf16 v[200:203], v[60:63], v[116:119], v[200:203]
    v_mfma_f32_16x16x32_bf16 v[204:207], v[56:59], v[120:123], v[204:207]
    ds_read_b64_tr_b16 v[56:57], v21 offset:32768
    ds_read_b64_tr_b16 v[58:59], v21 offset:33792
    v_mfma_f32_16x16x32_bf16 v[204:207], v[60:63], v[124:127], v[204:207]
    s_waitcnt lgkmcnt(2)
    ds_read_b64_tr_b16 v[60:61], v21 offset:40960
    ds_read_b64_tr_b16 v[62:63], v21 offset:41984
    v_mfma_f32_16x16x32_bf16 v[208:211], v[40:43], v[96:99], v[208:211]
    ds_read_b128 v[88:91], v24 offset:24576
    v_add_u32 v21, 0x10000, v21
    v_mfma_f32_16x16x32_bf16 v[208:211], v[44:47], v[100:103], v[208:211]
    v_mfma_f32_16x16x32_bf16 v[212:215], v[40:43], v[104:107], v[212:215]
    v_mfma_f32_16x16x32_bf16 v[212:215], v[44:47], v[108:111], v[212:215]
    v_mfma_f32_16x16x32_bf16 v[216:219], v[40:43], v[112:115], v[216:219]
    v_mfma_f32_16x16x32_bf16 v[216:219], v[44:47], v[116:119], v[216:219]
    v_mfma_f32_16x16x32_bf16 v[220:223], v[40:43], v[120:123], v[220:223]
    ds_read_b128 v[92:95], v25 offset:24576
    ds_read_b64_tr_b16 v[40:41], v14 offset:0
    v_mfma_f32_16x16x32_bf16 v[220:223], v[44:47], v[124:127], v[220:223]
    ds_read_b64_tr_b16 v[42:43], v14 offset:1024
    ds_read_b64_tr_b16 v[44:45], v14 offset:8192
    v_mfma_f32_16x16x32_bf16 v[224:227], v[48:51], v[96:99], v[224:227]
    ds_read_b64_tr_b16 v[46:47], v14 offset:9216
    v_mfma_f32_16x16x32_bf16 v[224:227], v[52:55], v[100:103], v[224:227]
    s_xor_b32 s65, s65, 8192
    v_mfma_f32_16x16x32_bf16 v[228:231], v[48:51], v[104:107], v[228:231]
    s_xor_b32 s66, s66, 128
    v_mfma_f32_16x16x32_bf16 v[228:231], v[52:55], v[108:111], v[228:231]
    v_mfma_f32_16x16x32_bf16 v[232:235], v[48:51], v[112:115], v[232:235]
    v_mfma_f32_16x16x32_bf16 v[232:235], v[52:55], v[116:119], v[232:235]
    v_mfma_f32_16x16x32_bf16 v[236:239], v[48:51], v[120:123], v[236:239]
    ds_read_b64_tr_b16 v[48:49], v15 offset:0
    ds_read_b64_tr_b16 v[50:51], v15 offset:1024
    v_mfma_f32_16x16x32_bf16 v[236:239], v[52:55], v[124:127], v[236:239]
    s_waitcnt lgkmcnt(2)
    ds_read_b64_tr_b16 v[52:53], v15 offset:8192
    ds_read_b64_tr_b16 v[54:55], v15 offset:9216
    v_mfma_f32_16x16x32_bf16 v[240:243], v[56:59], v[96:99], v[240:243]
    v_mfma_f32_16x16x32_bf16 v[240:243], v[60:63], v[100:103], v[240:243]
    v_mfma_f32_16x16x32_bf16 v[244:247], v[56:59], v[104:107], v[244:247]
    v_mfma_f32_16x16x32_bf16 v[244:247], v[60:63], v[108:111], v[244:247]
    v_mfma_f32_16x16x32_bf16 v[248:251], v[56:59], v[112:115], v[248:251]
    v_mfma_f32_16x16x32_bf16 v[248:251], v[60:63], v[116:119], v[248:251]
    v_mfma_f32_16x16x32_bf16 v[252:255], v[56:59], v[120:123], v[252:255]
    ds_read_b64_tr_b16 v[56:57], v16 offset:0
    ds_read_b64_tr_b16 v[58:59], v16 offset:1024
    v_mfma_f32_16x16x32_bf16 v[252:255], v[60:63], v[124:127], v[252:255]
    buffer_load_dword v7, v8, s[32:35], s61 offen sc1
    v_mfma_f32_16x16x32_bf16 v[128:131], v[40:43], v[64:67], v[128:131]
    ds_read_b64_tr_b16 v[60:61], v16 offset:8192
    ds_read_b64_tr_b16 v[62:63], v16 offset:9216
    v_mfma_f32_16x16x32_bf16 v[128:131], v[44:47], v[68:71], v[128:131]
    v_mfma_f32_16x16x32_bf16 v[132:135], v[40:43], v[72:75], v[132:135]
    v_mfma_f32_16x16x32_bf16 v[132:135], v[44:47], v[76:79], v[132:135]
    v_mfma_f32_16x16x32_bf16 v[136:139], v[40:43], v[80:83], v[136:139]
    v_mfma_f32_16x16x32_bf16 v[136:139], v[44:47], v[84:87], v[136:139]
    v_mfma_f32_16x16x32_bf16 v[140:143], v[40:43], v[88:91], v[140:143]
    ds_read_b64_tr_b16 v[40:41], v17 offset:0
    ds_read_b64_tr_b16 v[42:43], v17 offset:1024
    v_mfma_f32_16x16x32_bf16 v[140:143], v[44:47], v[92:95], v[140:143]
    s_waitcnt lgkmcnt(2)
    ds_read_b64_tr_b16 v[44:45], v17 offset:8192
    ds_read_b64_tr_b16 v[46:47], v17 offset:9216
    v_mfma_f32_16x16x32_bf16 v[144:147], v[48:51], v[64:67], v[144:147]
    v_cvt_pk_bf16_f32 v128, v128, v129
    v_cvt_pk_bf16_f32 v129, v130, v131
    v_mfma_f32_16x16x32_bf16 v[144:147], v[52:55], v[68:71], v[144:147]
    v_cvt_pk_bf16_f32 v132, v132, v133
    v_cvt_pk_bf16_f32 v133, v134, v135
    v_mfma_f32_16x16x32_bf16 v[148:151], v[48:51], v[72:75], v[148:151]
    v_cvt_pk_bf16_f32 v136, v136, v137
    v_cvt_pk_bf16_f32 v137, v138, v139
    v_mfma_f32_16x16x32_bf16 v[148:151], v[52:55], v[76:79], v[148:151]
    v_cvt_pk_bf16_f32 v140, v140, v141
    v_cvt_pk_bf16_f32 v141, v142, v143
    v_mfma_f32_16x16x32_bf16 v[152:155], v[48:51], v[80:83], v[152:155]
    v_cvt_pk_bf16_f32 v130, v144, v145
    v_cvt_pk_bf16_f32 v131, v146, v147
    v_mfma_f32_16x16x32_bf16 v[152:155], v[52:55], v[84:87], v[152:155]
    v_mfma_f32_16x16x32_bf16 v[156:159], v[48:51], v[88:91], v[156:159]
    ds_read_b64_tr_b16 v[48:49], v18 offset:0
    ds_read_b64_tr_b16 v[50:51], v18 offset:1024
    v_mfma_f32_16x16x32_bf16 v[156:159], v[52:55], v[92:95], v[156:159]
    ds_read_b64_tr_b16 v[52:53], v18 offset:8192
    ds_read_b64_tr_b16 v[54:55], v18 offset:9216
    v_mfma_f32_16x16x32_bf16 v[160:163], v[56:59], v[64:67], v[160:163]
    v_cvt_pk_bf16_f32 v134, v148, v149
    v_cvt_pk_bf16_f32 v135, v150, v151
    v_mfma_f32_16x16x32_bf16 v[160:163], v[60:63], v[68:71], v[160:163]
    v_cvt_pk_bf16_f32 v138, v152, v153
    v_cvt_pk_bf16_f32 v139, v154, v155
    v_mfma_f32_16x16x32_bf16 v[164:167], v[56:59], v[72:75], v[164:167]
    v_cvt_pk_bf16_f32 v142, v156, v157
    v_cvt_pk_bf16_f32 v143, v158, v159
    v_mfma_f32_16x16x32_bf16 v[164:167], v[60:63], v[76:79], v[164:167]
    v_mfma_f32_16x16x32_bf16 v[168:171], v[56:59], v[80:83], v[168:171]
    v_mfma_f32_16x16x32_bf16 v[168:171], v[60:63], v[84:87], v[168:171]
    v_cvt_pk_bf16_f32 v160, v160, v161
    v_cvt_pk_bf16_f32 v161, v162, v163
    v_mfma_f32_16x16x32_bf16 v[172:175], v[56:59], v[88:91], v[172:175]
    ds_read_b64_tr_b16 v[56:57], v19 offset:0
    ds_read_b64_tr_b16 v[58:59], v19 offset:1024
    v_mfma_f32_16x16x32_bf16 v[172:175], v[60:63], v[92:95], v[172:175]
    s_waitcnt lgkmcnt(2)
    ds_read_b64_tr_b16 v[60:61], v19 offset:8192
    ds_read_b64_tr_b16 v[62:63], v19 offset:9216
    v_mfma_f32_16x16x32_bf16 v[176:179], v[40:43], v[64:67], v[176:179]
    v_cvt_pk_bf16_f32 v164, v164, v165
    v_cvt_pk_bf16_f32 v165, v166, v167
    v_mfma_f32_16x16x32_bf16 v[176:179], v[44:47], v[68:71], v[176:179]
    v_cvt_pk_bf16_f32 v168, v168, v169
    v_cvt_pk_bf16_f32 v169, v170, v171
    v_mfma_f32_16x16x32_bf16 v[180:183], v[40:43], v[72:75], v[180:183]
    v_cvt_pk_bf16_f32 v172, v172, v173
    v_cvt_pk_bf16_f32 v173, v174, v175
    v_mfma_f32_16x16x32_bf16 v[180:183], v[44:47], v[76:79], v[180:183]
    v_mfma_f32_16x16x32_bf16 v[184:187], v[40:43], v[80:83], v[184:187]
    v_mfma_f32_16x16x32_bf16 v[184:187], v[44:47], v[84:87], v[184:187]
    v_cvt_pk_bf16_f32 v162, v176, v177
    v_cvt_pk_bf16_f32 v163, v178, v179
    v_mfma_f32_16x16x32_bf16 v[188:191], v[40:43], v[88:91], v[188:191]
    ds_read_b64_tr_b16 v[40:41], v20 offset:0
    ds_read_b64_tr_b16 v[42:43], v20 offset:1024
    v_mfma_f32_16x16x32_bf16 v[188:191], v[44:47], v[92:95], v[188:191]
    ds_read_b64_tr_b16 v[44:45], v20 offset:8192
    ds_read_b64_tr_b16 v[46:47], v20 offset:9216
    v_mfma_f32_16x16x32_bf16 v[192:195], v[48:51], v[64:67], v[192:195]
    v_cvt_pk_bf16_f32 v166, v180, v181
    v_cvt_pk_bf16_f32 v167, v182, v183
    v_mfma_f32_16x16x32_bf16 v[192:195], v[52:55], v[68:71], v[192:195]
    v_cvt_pk_bf16_f32 v170, v184, v185
    v_cvt_pk_bf16_f32 v171, v186, v187
    s_waitcnt vmcnt(0)
    v_cmp_gt_u32 vcc, 1, v7
    s_nop 1
    s_and_b64 vcc, vcc, exec
    s_cbranch_scc1 SPIN_KV
BACK_KV:
    v_mfma_f32_16x16x32_bf16 v[196:199], v[48:51], v[72:75], v[196:199]
    s_mov_b32 s77, s75
    buffer_load_dwordx4 a[224:227], v1, s[36:39], 0 offen offset:0 sc1
    v_mfma_f32_16x16x32_bf16 v[196:199], v[52:55], v[76:79], v[196:199]
    buffer_load_dwordx4 a[228:231], v1, s[36:39], 0 offen offset:1024 sc1
    v_mfma_f32_16x16x32_bf16 v[200:203], v[48:51], v[80:83], v[200:203]
    v_cmp_le_i32 vcc, 0, v36
    v_cvt_pk_bf16_f32 v192, v192, v193
    v_mfma_f32_16x16x32_bf16 v[200:203], v[52:55], v[84:87], v[200:203]
    v_cvt_pk_bf16_f32 v193, v194, v195
    v_cvt_pk_bf16_f32 v174, v188, v189
    v_mfma_f32_16x16x32_bf16 v[204:207], v[48:51], v[88:91], v[204:207]
    buffer_load_dwordx4 a[232:235], v1, s[36:39], 0 offen offset:2048 sc1
    v_mfma_f32_16x16x32_bf16 v[204:207], v[52:55], v[92:95], v[204:207]
    s_waitcnt lgkmcnt(0)
    ds_read_b64_tr_b16 v[48:49], v21 offset:0
    ds_read_b64_tr_b16 v[50:51], v21 offset:1024
    v_mfma_f32_16x16x32_bf16 v[208:211], v[56:59], v[64:67], v[208:211]
    ds_read_b64_tr_b16 v[52:53], v21 offset:8192
    ds_read_b64_tr_b16 v[54:55], v21 offset:9216
    v_mfma_f32_16x16x32_bf16 v[208:211], v[60:63], v[68:71], v[208:211]
    v_cvt_pk_bf16_f32 v196, v196, v197
    v_cvt_pk_bf16_f32 v197, v198, v199
    v_mfma_f32_16x16x32_bf16 v[212:215], v[56:59], v[72:75], v[212:215]
    buffer_load_dwordx4 a[236:239], v1, s[36:39], 0 offen offset:3072 sc1
    v_mfma_f32_16x16x32_bf16 v[212:215], v[60:63], v[76:79], v[212:215]
    v_cvt_pk_bf16_f32 v200, v200, v201
    v_cvt_pk_bf16_f32 v201, v202, v203
    v_mfma_f32_16x16x32_bf16 v[216:219], v[56:59], v[80:83], v[216:219]
    v_cvt_pk_bf16_f32 v194, v208, v209
    v_cndmask_b32_e64 v208, v37, 0, vcc
    v_mfma_f32_16x16x32_bf16 v[216:219], v[60:63], v[84:87], v[216:219]
    v_mul_f32 v176, s16, v208
    v_cmp_le_i32 vcc, 1, v36
    v_mfma_f32_16x16x32_bf16 v[220:223], v[56:59], v[88:91], v[220:223]
    v_cvt_pk_bf16_f32 v195, v210, v211
    v_cndmask_b32_e64 v209, v37, 0, vcc
    v_mfma_f32_16x16x32_bf16 v[220:223], v[60:63], v[92:95], v[220:223]
    v_mul_f32 v177, s16, v209
    v_cmp_le_i32 vcc, 2, v36
    v_mfma_f32_16x16x32_bf16 v[224:227], v[40:43], v[64:67], v[224:227]
    s_mov_b32 s38, 16384
    v_cndmask_b32_e64 v210, v37, 0, vcc
    v_mul_f32 v178, s16, v210
    v_mfma_f32_16x16x32_bf16 v[224:227], v[44:47], v[68:71], v[224:227]
    s_add_u32 m0, s76, s75
    v_cmp_le_i32 vcc, 3, v36
    v_cvt_pk_bf16_f32 v198, v212, v213
    v_mfma_f32_16x16x32_bf16 v[228:231], v[40:43], v[72:75], v[228:231]
    buffer_load_dwordx4 v1, s[36:39], s77 offen sc1 lds
    v_mfma_f32_16x16x32_bf16 v[228:231], v[44:47], v[76:79], v[228:231]
    v_cndmask_b32_e64 v211, v37, 0, vcc
    v_mul_f32 v179, s16, v211
    v_mfma_f32_16x16x32_bf16 v[232:235], v[40:43], v[80:83], v[232:235]
    v_cvt_pk_bf16_f32 v224, v224, v225
    v_cvt_pk_bf16_f32 v225, v226, v227
    v_mfma_f32_16x16x32_bf16 v[232:235], v[44:47], v[84:87], v[232:235]
    s_waitcnt vmcnt(6) lgkmcnt(0)
    s_barrier
    ds_read_b64_tr_b16 v[56:57], v26 offset:32768
    v_mfma_f32_16x16x32_bf16 v[236:239], v[40:43], v[88:91], v[236:239]
    buffer_load_dwordx4 v1, s[36:39], s77 offen offset:1024 sc1 lds
    v_mfma_f32_16x16x32_bf16 v[236:239], v[44:47], v[92:95], v[236:239]
    ds_read_b64_tr_b16 v[58:59], v26 offset:33280
    ds_read_b64_tr_b16 v[60:61], v26 offset:36864
    v_mfma_f32_16x16x32_bf16 v[240:243], v[48:51], v[64:67], v[240:243]
    ds_read_b64_tr_b16 v[62:63], v26 offset:37376
    ds_read_b128 a[136:139], v22 offset:32768
    v_mfma_f32_16x16x32_bf16 v[240:243], v[52:55], v[68:71], v[240:243]
    ds_read_b128 a[140:143], v23 offset:32768
    v_add_u32 v26, 0x10000, v26
    v_mfma_f32_16x16x32_bf16 v[244:247], v[48:51], v[72:75], v[244:247]
    buffer_load_dwordx4 v1, s[36:39], s77 offen offset:2048 sc1 lds
    v_mfma_f32_16x16x32_bf16 v[244:247], v[52:55], v[76:79], v[244:247]
    ds_read_b64_tr_b16 v[40:41], v27 offset:32768
    ds_read_b64_tr_b16 v[42:43], v27 offset:33280
    v_mfma_f32_16x16x32_bf16 v[248:251], v[48:51], v[80:83], v[248:251]
    ds_read_b64_tr_b16 v[44:45], v27 offset:36864
    ds_read_b64_tr_b16 v[46:47], v27 offset:37376
    v_mfma_f32_16x16x32_bf16 v[248:251], v[52:55], v[84:87], v[248:251]
    v_add_u32 v22, 0x10000, v22
    v_add_u32 v23, 0x10000, v23
    v_mfma_f32_16x16x32_bf16 v[252:255], v[48:51], v[88:91], v[252:255]
    buffer_load_dwordx4 v1, s[36:39], s77 offen offset:3072 sc1 lds
    v_mfma_f32_16x16x32_bf16 v[252:255], v[52:55], v[92:95], v[252:255]
    s_waitcnt lgkmcnt(4)
    ds_read_b64_tr_b16 v[48:49], v28 offset:32768
    ds_read_b64_tr_b16 v[50:51], v28 offset:33280
    v_mfma_f32_16x16x32_bf16 a[64:67], v[56:59], v[96:99], a[64:67]
    s_add_u32 s100, s77, 4096
    ds_read_b64_tr_b16 v[52:53], v28 offset:36864
    ds_read_b64_tr_b16 v[54:55], v28 offset:37376
    v_mfma_f32_16x16x32_bf16 a[64:67], v[60:63], v[100:103], a[64:67]
    s_add_u32 m0, m0, 4096
    v_add_u32 v27, 0x10000, v27
    v_add_u32 v28, 0x10000, v28
    v_mfma_f32_16x16x32_bf16 a[68:71], v[56:59], v[104:107], a[68:71]
    buffer_load_dwordx4 v1, s[36:39], s100 offen sc1 lds
    v_mfma_f32_16x16x32_bf16 a[68:71], v[60:63], v[108:111], a[68:71]
    v_cvt_pk_bf16_f32 v226, v240, v241
    v_cvt_pk_bf16_f32 v227, v242, v243
    v_mfma_f32_16x16x32_bf16 a[72:75], v[56:59], v[112:115], a[72:75]
    v_cvt_pk_bf16_f32 v228, v228, v229
    v_cvt_pk_bf16_f32 v229, v230, v231
    v_mfma_f32_16x16x32_bf16 a[72:75], v[60:63], v[116:119], a[72:75]
    v_cvt_pk_bf16_f32 v230, v244, v245
    v_cvt_pk_bf16_f32 v231, v246, v247
    v_mfma_f32_16x16x32_bf16 a[76:79], v[56:59], v[120:123], a[76:79]
    buffer_load_dwordx4 v1, s[36:39], s100 offen offset:1024 sc1 lds
    v_mfma_f32_16x16x32_bf16 a[76:79], v[60:63], v[124:127], a[76:79]
    v_cvt_pk_bf16_f32 v199, v214, v215
    v_cvt_pk_bf16_f32 v232, v232, v233
    v_mfma_f32_16x16x32_bf16 a[128:131], v[56:59], a[136:139], a[128:131]
    ds_read_b64_tr_b16 v[56:57], v29 offset:32768
    ds_read_b64_tr_b16 v[58:59], v29 offset:33280
    v_mfma_f32_16x16x32_bf16 a[128:131], v[60:63], a[140:143], a[128:131]
    s_waitcnt lgkmcnt(2)
    ds_read_b64_tr_b16 v[60:61], v29 offset:36864
    ds_read_b64_tr_b16 v[62:63], v29 offset:37376
    v_mfma_f32_16x16x32_bf16 a[80:83], v[40:43], v[96:99], a[80:83]
    buffer_load_dwordx4 v1, s[36:39], s100 offen offset:2048 sc1 lds
    v_mfma_f32_16x16x32_bf16 a[80:83], v[44:47], v[100:103], a[80:83]
    v_add_u32 v29, 0x10000, v29
    v_cvt_pk_bf16_f32 v233, v234, v235
    v_mfma_f32_16x16x32_bf16 a[84:87], v[40:43], v[104:107], a[84:87]
    v_cvt_pk_bf16_f32 v234, v248, v249
    v_cvt_pk_bf16_f32 v235, v250, v251
    v_mfma_f32_16x16x32_bf16 a[84:87], v[44:47], v[108:111], a[84:87]
    v_cvt_pk_bf16_f32 v202, v216, v217
    v_cvt_pk_bf16_f32 v203, v218, v219
    v_mfma_f32_16x16x32_bf16 a[88:91], v[40:43], v[112:115], a[88:91]
    buffer_load_dwordx4 v1, s[36:39], s100 offen offset:3072 sc1 lds
    v_mfma_f32_16x16x32_bf16 a[88:91], v[44:47], v[116:119], a[88:91]
    v_cvt_pk_bf16_f32 v175, v190, v191
    v_cvt_pk_bf16_f32 v236, v236, v237
    v_mfma_f32_16x16x32_bf16 a[92:95], v[40:43], v[120:123], a[92:95]
    s_lshr_b32 s82, s4, 1
    s_add_u32 s82, s82, 32
    v_cvt_pk_bf16_f32 v237, v238, v239
    v_mfma_f32_16x16x32_bf16 a[92:95], v[44:47], v[124:127], a[92:95]
    s_sub_u32 s82, s82, s6
    v_cvt_pk_bf16_f32 v238, v252, v253
    v_cvt_pk_bf16_f32 v239, v254, v255
    v_mfma_f32_16x16x32_bf16 a[132:135], v[40:43], a[136:139], a[132:135]
    s_add_u32 s76, s76, 32768
    s_sub_u32 s82, s82, s6
    ds_read_b64_tr_b16 v[40:41], v26 offset:0
    v_mfma_f32_16x16x32_bf16 a[132:135], v[44:47], a[140:143], a[132:135]
    s_waitcnt vmcnt(8)
    s_add_u32 s77, s77, 32768
    s_lshl_b32 s38, s82, 15
    v_mfma_f32_16x16x32_bf16 v[240:243], a[224:227], v[128:131], v[176:179]
    s_add_u32 m0, s76, s75
    ds_read_b64_tr_b16 v[42:43], v26 offset:512
    ds_read_b64_tr_b16 v[44:45], v26 offset:4096
    v_mfma_f32_16x16x32_bf16 v[240:243], a[228:231], v[160:163], v[240:243]
    s_mov_b32 s82, 0
    buffer_load_dwordx4 v1, s[36:39], s77 offen sc1 lds
    v_mfma_f32_16x16x32_bf16 v[240:243], a[232:235], v[192:195], v[240:243]
    buffer_load_dwordx4 v1, s[36:39], s77 offen offset:1024 sc1 lds
    v_mfma_f32_16x16x32_bf16 v[240:243], a[236:239], v[224:227], v[240:243]
    ds_read_b64_tr_b16 v[46:47], v26 offset:4608
    ds_read_b128 a[136:139], v22 offset:0
    v_mfma_f32_16x16x32_bf16 v[244:247], a[224:227], v[132:135], 0
    ds_read_b128 a[140:143], v23 offset:0
    v_cvt_pk_bf16_f32 v204, v204, v205
    v_mfma_f32_16x16x32_bf16 v[244:247], a[228:231], v[164:167], v[244:247]
    v_cvt_pk_bf16_f32 v205, v206, v207
    v_cvt_pk_bf16_f32 v206, v220, v221
    v_mfma_f32_16x16x32_bf16 v[244:247], a[232:235], v[196:199], v[244:247]
    buffer_load_dwordx4 v1, s[36:39], s77 offen offset:2048 sc1 lds
    v_mfma_f32_16x16x32_bf16 v[244:247], a[236:239], v[228:231], v[244:247]
    v_max3_f32 v147, v240, v241, v242
    v_max_f32 v147, v147, v243
    v_mfma_f32_16x16x32_bf16 v[248:251], a[224:227], v[136:139], 0
    v_mov_b32 v146, v147
    v_cvt_pk_bf16_f32 v207, v222, v223
    v_mfma_f32_16x16x32_bf16 v[248:251], a[228:231], v[168:171], v[248:251]
    v_permlane32_swap_b32 v147, v146
    v_max_f32 v147, v147, v146
    v_mfma_f32_16x16x32_bf16 v[248:251], a[232:235], v[200:203], v[248:251]
    buffer_load_dwordx4 v1, s[36:39], s77 offen offset:3072 sc1 lds
    v_mfma_f32_16x16x32_bf16 v[248:251], a[236:239], v[232:235], v[248:251]
    v_max3_f32 v151, v244, v245, v246
    v_max_f32 v151, v151, v247
    v_mfma_f32_16x16x32_bf16 v[252:255], a[224:227], v[140:143], 0
    s_add_u32 s100, s77, 4096
    v_mov_b32 v150, v151
    v_mov_b32 v146, v147
    v_mfma_f32_16x16x32_bf16 v[252:255], a[228:231], v[172:175], v[252:255]
    s_add_u32 m0, m0, 4096
    v_max3_f32 v155, v248, v249, v250
    v_max_f32 v155, v155, v251
    v_mfma_f32_16x16x32_bf16 v[252:255], a[232:235], v[204:207], v[252:255]
    buffer_load_dwordx4 v1, s[36:39], s100 offen sc1 lds
    v_mfma_f32_16x16x32_bf16 v[252:255], a[236:239], v[236:239], v[252:255]
    v_mov_b32 v154, v155
    v_permlane32_swap_b32 v151, v150
    v_mfma_f32_16x16x32_bf16 a[96:99], v[48:51], v[96:99], a[96:99]
    v_permlane32_swap_b32 v155, v154
    v_max_f32 v151, v151, v150
    v_mfma_f32_16x16x32_bf16 a[96:99], v[52:55], v[100:103], a[96:99]
    v_max_f32 v155, v155, v154
    v_mov_b32 v150, v151
    v_mfma_f32_16x16x32_bf16 a[100:103], v[48:51], v[104:107], a[100:103]
    buffer_load_dwordx4 v1, s[36:39], s100 offen offset:1024 sc1 lds
    v_mfma_f32_16x16x32_bf16 a[100:103], v[52:55], v[108:111], a[100:103]
    v_max3_f32 v159, v252, v253, v254
    v_max_f32 v159, v159, v255
    v_mfma_f32_16x16x32_bf16 a[104:107], v[48:51], v[112:115], a[104:107]
    v_mov_b32 v158, v159
    v_mov_b32 v154, v155
    v_mfma_f32_16x16x32_bf16 a[104:107], v[52:55], v[116:119], a[104:107]
    v_permlane32_swap_b32 v159, v158
    v_max_f32 v159, v159, v158
    v_mfma_f32_16x16x32_bf16 a[108:111], v[48:51], v[120:123], a[108:111]
    buffer_load_dwordx4 v1, s[36:39], s100 offen offset:2048 sc1 lds
    v_mfma_f32_16x16x32_bf16 a[108:111], v[52:55], v[124:127], a[108:111]
    s_waitcnt lgkmcnt(0)
    ds_read_b64_tr_b16 v[48:49], v27 offset:0
    ds_read_b64_tr_b16 v[50:51], v27 offset:512
    v_mfma_f32_16x16x32_bf16 a[112:115], v[56:59], v[96:99], a[112:115]
    ds_read_b64_tr_b16 v[52:53], v27 offset:4096
    ds_read_b64_tr_b16 v[54:55], v27 offset:4608
    v_mfma_f32_16x16x32_bf16 a[112:115], v[60:63], v[100:103], a[112:115]
    v_mov_b32 v158, v159
    v_permlane16_swap_b32 v147, v146
    v_mfma_f32_16x16x32_bf16 a[116:119], v[56:59], v[104:107], a[116:119]
    buffer_load_dwordx4 v1, s[36:39], s100 offen offset:3072 sc1 lds
    v_mfma_f32_16x16x32_bf16 a[116:119], v[60:63], v[108:111], a[116:119]
    v_permlane16_swap_b32 v151, v150
    v_permlane16_swap_b32 v155, v154
    v_mfma_f32_16x16x32_bf16 a[120:123], v[56:59], v[112:115], a[120:123]
    s_add_u32 s76, s76, 32768
    v_permlane16_swap_b32 v159, v158
    v_max_f32 v147, v147, v146
    v_mfma_f32_16x16x32_bf16 a[120:123], v[60:63], v[116:119], a[120:123]
    s_add_u32 s77, s77, 32768
    v_max_f32 v151, v151, v150
    v_max_f32 v155, v155, v154
    v_mfma_f32_16x16x32_bf16 a[124:127], v[56:59], v[120:123], a[124:127]
    s_add_u32 m0, s76, s75
    ds_read_b64_tr_b16 v[56:57], v28 offset:0
    ds_read_b64_tr_b16 v[58:59], v28 offset:512
    v_mfma_f32_16x16x32_bf16 a[124:127], v[60:63], v[124:127], a[124:127]
    buffer_load_dwordx4 v1, s[36:39], s77 offen sc1 lds
    v_mfma_f32_16x16x32_bf16 a[64:67], v[40:43], v[64:67], a[64:67]
    ds_read_b64_tr_b16 v[60:61], v28 offset:4096
    ds_read_b64_tr_b16 v[62:63], v28 offset:4608
    v_mfma_f32_16x16x32_bf16 a[64:67], v[44:47], v[68:71], a[64:67]
    v_max_f32 v159, v159, v158
    v_sub_f32 v144, 0, v147
    v_mfma_f32_16x16x32_bf16 a[68:71], v[40:43], v[72:75], a[68:71]
    buffer_load_dwordx4 v1, s[36:39], s77 offen offset:1024 sc1 lds
    v_mfma_f32_16x16x32_bf16 a[68:71], v[44:47], v[76:79], a[68:71]
    v_sub_f32 v148, 0, v151
    v_sub_f32 v152, 0, v155
    v_mfma_f32_16x16x32_bf16 a[72:75], v[40:43], v[80:83], a[72:75]
    v_sub_f32 v156, 0, v159
    v_sub_f32 v145, 0, v147
    v_mfma_f32_16x16x32_bf16 a[72:75], v[44:47], v[84:87], a[72:75]
    v_sub_f32 v146, 0, v147
    v_sub_f32 v147, 0, v147
    v_mfma_f32_16x16x32_bf16 a[76:79], v[40:43], v[88:91], a[76:79]
    buffer_load_dwordx4 v1, s[36:39], s77 offen offset:2048 sc1 lds
    v_mfma_f32_16x16x32_bf16 a[76:79], v[44:47], v[92:95], a[76:79]
    v_sub_f32 v149, 0, v151
    v_sub_f32 v150, 0, v151
    v_mfma_f32_16x16x32_bf16 a[128:131], v[40:43], a[136:139], a[128:131]
    ds_read_b64_tr_b16 v[40:41], v29 offset:0
    ds_read_b64_tr_b16 v[42:43], v29 offset:512
    v_mfma_f32_16x16x32_bf16 a[128:131], v[44:47], a[140:143], a[128:131]
    s_waitcnt lgkmcnt(2)
    ds_read_b64_tr_b16 v[44:45], v29 offset:4096
    ds_read_b64_tr_b16 v[46:47], v29 offset:4608
    v_mfma_f32_16x16x32_bf16 a[80:83], v[48:51], v[64:67], a[80:83]
    buffer_load_dwordx4 v1, s[36:39], s77 offen offset:3072 sc1 lds
    v_mfma_f32_16x16x32_bf16 a[80:83], v[52:55], v[68:71], a[80:83]
    v_sub_f32 v151, 0, v151
    v_sub_f32 v153, 0, v155
    v_mfma_f32_16x16x32_bf16 a[84:87], v[48:51], v[72:75], a[84:87]
    s_add_u32 s100, s77, 4096
    v_sub_f32 v154, 0, v155
    v_sub_f32 v155, 0, v155
    v_mfma_f32_16x16x32_bf16 a[84:87], v[52:55], v[76:79], a[84:87]
    s_add_u32 m0, m0, 4096
    v_sub_f32 v157, 0, v159
    v_sub_f32 v158, 0, v159
    v_mfma_f32_16x16x32_bf16 a[88:91], v[48:51], v[80:83], a[88:91]
    buffer_load_dwordx4 v1, s[36:39], s100 offen sc1 lds
    v_mfma_f32_16x16x32_bf16 a[88:91], v[52:55], v[84:87], a[88:91]
    v_sub_f32 v159, 0, v159
    v_or_b32 v215, 0x44444444, v38
    v_mfma_f32_16x16x32_bf16 a[92:95], v[48:51], v[88:91], a[92:95]
    v_bfe_u32 v38, v1, 5, 1
    v_cmp_eq_u32 vcc, 0, v38
    v_mfma_f32_16x16x32_bf16 a[92:95], v[52:55], v[92:95], a[92:95]
    v_mov_b32 v38, 0x3f803f80
    v_and_b32 v29, 0x380, v1
    v_mfma_f32_16x16x32_bf16 a[132:135], v[48:51], a[136:139], a[132:135]
    buffer_load_dwordx4 v1, s[36:39], s100 offen offset:1024 sc1 lds
    v_mfma_f32_16x16x32_bf16 a[132:135], v[52:55], a[140:143], a[132:135]
    v_add_f32 v240, v240, v144
    v_add_f32 v241, v241, v144
    v_mfma_f32_16x16x32_bf16 a[96:99], v[56:59], v[64:67], a[96:99]
    v_add_f32 v242, v242, v144
    v_add_f32 v243, v243, v144
    v_mfma_f32_16x16x32_bf16 a[96:99], v[60:63], v[68:71], a[96:99]
    v_add_f32 v244, v244, v148
    v_add_f32 v245, v245, v148
    v_mfma_f32_16x16x32_bf16 a[100:103], v[56:59], v[72:75], a[100:103]
    buffer_load_dwordx4 v1, s[36:39], s100 offen offset:2048 sc1 lds
    v_mfma_f32_16x16x32_bf16 a[100:103], v[60:63], v[76:79], a[100:103]
    v_add_f32 v246, v246, v148
    v_add_f32 v247, v247, v148
    v_mfma_f32_16x16x32_bf16 a[104:107], v[56:59], v[80:83], a[104:107]
    v_add_f32 v248, v248, v152
    v_add_f32 v249, v249, v152
    v_mfma_f32_16x16x32_bf16 a[104:107], v[60:63], v[84:87], a[104:107]
    s_waitcnt vmcnt(15) lgkmcnt(0)
    s_barrier
    ds_read_b128 a[240:243], v2 offset:4096
    v_mfma_f32_16x16x32_bf16 a[108:111], v[56:59], v[88:91], a[108:111]
    ds_read_b128 a[244:247], v2 offset:5120
    ds_read_b128 a[248:251], v2 offset:6144
    v_mfma_f32_16x16x32_bf16 a[108:111], v[60:63], v[92:95], a[108:111]
    buffer_load_dwordx4 v1, s[36:39], s100 offen offset:3072 sc1 lds
    v_mfma_f32_16x16x32_bf16 a[112:115], v[40:43], v[64:67], a[112:115]
    s_add_u32 s77, s77, 32768
    ds_read_b128 a[252:255], v2 offset:7168
    v_add_f32 v250, v250, v152
    v_mfma_f32_16x16x32_bf16 a[112:115], v[44:47], v[68:71], a[112:115]
    s_add_u32 s76, s76, 32768
    v_add_f32 v251, v251, v152
    v_add_f32 v252, v252, v156
    v_mfma_f32_16x16x32_bf16 a[116:119], v[40:43], v[72:75], a[116:119]
    v_add_f32 v253, v253, v156
    v_add_f32 v254, v254, v156
    v_mfma_f32_16x16x32_bf16 a[116:119], v[44:47], v[76:79], a[116:119]
    v_add_f32 v255, v255, v156
    v_cndmask_b32 v38, 0, v38, vcc
    v_mfma_f32_16x16x32_bf16 a[120:123], v[40:43], v[80:83], a[120:123]
    v_lshl_add_u32 v29, v29, 4, v39
    v_bfe_u32 v39, v1, 2, 4
    v_mfma_f32_16x16x32_bf16 a[120:123], v[44:47], v[84:87], a[120:123]
    v_exp_f32 v240, v240
    v_mfma_f32_16x16x32_bf16 a[124:127], v[40:43], v[88:91], a[124:127]
    v_exp_f32 v241, v241
    v_mfma_f32_16x16x32_bf16 a[124:127], v[44:47], v[92:95], a[124:127]
    v_exp_f32 v242, v242
    v_exp_f32 v243, v243
    v_exp_f32 v244, v244
    v_exp_f32 v245, v245
    v_exp_f32 v246, v246
    v_exp_f32 v247, v247
    v_exp_f32 v248, v248
    v_exp_f32 v249, v249
    v_exp_f32 v250, v250
    v_exp_f32 v251, v251
    v_exp_f32 v252, v252
    v_exp_f32 v253, v253
    v_exp_f32 v254, v254
    v_exp_f32 v255, v255
    v_accvgpr_write_b32 a136, v38
    v_accvgpr_write_b32 a137, v38
    v_accvgpr_write_b32 a138, v38
    v_accvgpr_write_b32 a139, v38
    v_lshl_add_u32 v29, v29, 1, v39
K1_ATT:
    v_cvt_pk_bf16_f32 v32, v240, v241
    v_cvt_pk_bf16_f32 v33, v242, v243
    v_add_f32 v213, s21, v144
    v_fma_f32 v180, v208, s17, v213
    v_fma_f32 v181, v209, s17, v213
    v_fma_f32 v182, v210, s17, v213
    v_fma_f32 v183, v211, s17, v213
    s_nop 1
    s_waitcnt lgkmcnt(0)
    v_mfma_f32_16x16x32_bf16 v[240:243], a[240:243], v[128:131], v[180:183]
    s_mov_b32 s99, s76
    v_cvt_pk_bf16_f32 v40, v244, v245
    v_cvt_pk_bf16_f32 v41, v246, v247
    v_mfma_f32_16x16x32_bf16 v[240:243], a[244:247], v[160:163], v[240:243]
    s_sub_u32 s7, 15, s6
    v_cvt_pk_bf16_f32 v48, v248, v249
    v_cvt_pk_bf16_f32 v49, v250, v251
    v_mfma_f32_16x16x32_bf16 v[240:243], a[248:251], v[192:195], v[240:243]
    s_lshl3_add_u32 s80, s6, s4
    ds_read_b128 a[224:227], v2 offset:8192
    ds_read_b128 a[228:231], v2 offset:9216
    v_mfma_f32_16x16x32_bf16 v[240:243], a[252:255], v[224:227], v[240:243]
    s_lshl3_add_u32 s81, s7, s4
    ds_read_b128 a[232:235], v2 offset:10240
    v_cvt_pk_bf16_f32 v56, v252, v253
    v_mfma_f32_16x16x32_bf16 v[244:247], a[240:243], v[132:135], v[148:151]
    s_add_u32 m0, s76, s75
    ds_read_b128 a[236:239], v2 offset:11264
    v_cvt_pk_bf16_f32 v57, v254, v255
    v_mfma_f32_16x16x32_bf16 v[244:247], a[244:247], v[164:167], v[244:247]
    s_mov_b32 s76, s60
    buffer_load_dwordx4 v1, s[36:39], s77 offen sc1 lds
    v_mfma_f32_16x16x32_bf16 v[244:247], a[248:251], v[196:199], v[244:247]
    s_mov_b32 s60, s82
    v_exp_f32 v240, v240
    v_mfma_f32_16x16x32_bf16 v[244:247], a[252:255], v[228:231], v[244:247]
    s_mov_b32 s82, s95
    buffer_load_dwordx4 v1, s[36:39], s77 offen offset:1024 sc1 lds
    v_mfma_f32_16x16x32_bf16 v[248:251], a[240:243], v[136:139], v[152:155]
    s_mov_b32 s95, s93
    v_exp_f32 v241, v241
    v_mfma_f32_16x16x32_bf16 v[248:251], a[244:247], v[168:171], v[248:251]
    s_mov_b32 s93, s99
    v_exp_f32 v242, v242
    v_mfma_f32_16x16x32_bf16 v[248:251], a[248:251], v[200:203], v[248:251]
    s_mul_i32 s80, s80, 155648
    buffer_load_dwordx4 v1, s[36:39], s77 offen offset:2048 sc1 lds
    v_mfma_f32_16x16x32_bf16 v[248:251], a[252:255], v[232:235], v[248:251]
    s_mul_i32 s81, s81, 155648
    v_exp_f32 v243, v243
    v_mfma_f32_16x16x32_bf16 v[252:255], a[240:243], v[140:143], v[156:159]
    s_lshl_b32 s7, s5, 12
    v_cvt_pk_bf16_f32 v34, v240, v241
    v_cvt_pk_bf16_f32 v35, v242, v243
    v_mfma_f32_16x16x32_bf16 v[252:255], a[244:247], v[172:175], v[252:255]
    s_add_u32 s80, s80, s7
    buffer_load_dwordx4 v1, s[36:39], s77 offen offset:3072 sc1 lds
    v_mfma_f32_16x16x32_bf16 v[252:255], a[248:251], v[204:207], v[252:255]
    s_add_u32 s81, s81, s7
    v_exp_f32 v244, v244
    v_mfma_f32_16x16x32_bf16 v[252:255], a[252:255], v[236:239], v[252:255]
    s_add_u32 s100, s77, 4096
    v_exp_f32 v245, v245
    v_add_f32 v212, s20, v144
    v_fma_f32 v176, v208, s16, v212
    v_fma_f32 v177, v209, s16, v212
    v_fma_f32 v178, v210, s16, v212
    v_fma_f32 v179, v211, s16, v212
    v_add_f32 v212, s22, v144
    v_fma_f32 v184, v208, s18, v212
    v_fma_f32 v185, v209, s18, v212
    v_fma_f32 v186, v210, s18, v212
    v_fma_f32 v187, v211, s18, v212
    s_nop 1
    s_waitcnt lgkmcnt(0)
    v_mfma_f32_16x16x32_bf16 v[240:243], a[224:227], v[128:131], v[184:187]
    s_add_u32 m0, m0, 4096
    v_exp_f32 v246, v246
    v_mfma_f32_16x16x32_bf16 v[240:243], a[228:231], v[160:163], v[240:243]
    s_lshr_b32 s7, s5, 3
    v_exp_f32 v247, v247
    v_mfma_f32_16x16x32_bf16 v[240:243], a[232:235], v[192:195], v[240:243]
    s_lshl2_add_u32 s7, s7, s4
    buffer_load_dwordx4 v1, s[36:39], s100 offen sc1 lds
    v_mfma_f32_16x16x32_bf16 v[240:243], a[236:239], v[224:227], v[240:243]
    s_lshl_b32 s7, s7, 8
    v_cvt_pk_bf16_f32 v42, v244, v245
    v_cvt_pk_bf16_f32 v43, v246, v247
    v_mfma_f32_16x16x32_bf16 v[244:247], a[224:227], v[132:135], v[148:151]
    s_mov_b32 s42, 19922944
    v_exp_f32 v248, v248
    v_mfma_f32_16x16x32_bf16 v[244:247], a[228:231], v[164:167], v[244:247]
    s_mov_b32 s43, 0x20000
    buffer_load_dwordx4 v1, s[36:39], s100 offen offset:1024 sc1 lds
    v_mfma_f32_16x16x32_bf16 v[244:247], a[232:235], v[196:199], v[244:247]
    s_add_u32 s92, s7, 163840
    v_exp_f32 v249, v249
    v_mfma_f32_16x16x32_bf16 v[244:247], a[236:239], v[228:231], v[244:247]
    s_mov_b64 s[24:25], s[0:1]
    v_exp_f32 v250, v250
    v_exp_f32 v251, v251
    v_cvt_pk_bf16_f32 v50, v248, v249
    v_cvt_pk_bf16_f32 v51, v250, v251
    v_mfma_f32_16x16x32_bf16 v[248:251], a[224:227], v[136:139], v[152:155]
    s_mov_b32 s78, s6
    ds_read_b128 a[240:243], v2 offset:12288
    ds_read_b128 a[244:247], v2 offset:13312
    v_mfma_f32_16x16x32_bf16 v[248:251], a[228:231], v[168:171], v[248:251]
    s_mov_b32 s26, 2359296
    buffer_load_dwordx4 v1, s[36:39], s100 offen offset:2048 sc1 lds
    v_mfma_f32_16x16x32_bf16 v[248:251], a[232:235], v[200:203], v[248:251]
    s_add_u32 s77, s77, 32768
    ds_read_b128 a[248:251], v2 offset:14336
    ds_read_b128 a[252:255], v2 offset:15360
    v_mfma_f32_16x16x32_bf16 v[248:251], a[236:239], v[232:235], v[248:251]
    s_mov_b32 s27, 0x20000
    v_exp_f32 v252, v252
    v_exp_f32 v253, v253
    v_exp_f32 v254, v254
    v_exp_f32 v255, v255
    v_cvt_pk_bf16_f32 v58, v252, v253
    v_cvt_pk_bf16_f32 v59, v254, v255
    v_mfma_f32_16x16x32_bf16 v[252:255], a[224:227], v[140:143], v[156:159]
    v_add_f32 v213, s23, v144
    v_fma_f32 v188, v208, s19, v213
    v_mfma_f32_16x16x32_bf16 v[252:255], a[228:231], v[172:175], v[252:255]
    buffer_load_dwordx4 v1, s[36:39], s100 offen offset:3072 sc1 lds
    v_mfma_f32_16x16x32_bf16 v[252:255], a[232:235], v[204:207], v[252:255]
    v_exp_f32 v240, v240
    v_mfma_f32_16x16x32_bf16 v[252:255], a[236:239], v[236:239], v[252:255]
    s_waitcnt lgkmcnt(0)
    v_exp_f32 v241, v241
    v_exp_f32 v242, v242
    v_exp_f32 v243, v243
    v_fma_f32 v189, v209, s19, v213
    v_fma_f32 v190, v210, s19, v213
    v_fma_f32 v191, v211, s19, v213
    v_cvt_pk_bf16_f32 v36, v240, v241
    v_cvt_pk_bf16_f32 v37, v242, v243
    v_mfma_f32_16x16x32_bf16 v[240:243], a[240:243], v[128:131], v[188:191]
    v_exp_f32 v244, v244
    v_mfma_f32_16x16x32_bf16 v[240:243], a[244:247], v[160:163], v[240:243]
    v_exp_f32 v245, v245
    v_mfma_f32_16x16x32_bf16 v[240:243], a[248:251], v[192:195], v[240:243]
    s_waitcnt vmcnt(8) lgkmcnt(0)
    v_exp_f32 v246, v246
    v_mfma_f32_16x16x32_bf16 v[240:243], a[252:255], v[224:227], v[240:243]
    s_barrier
    v_exp_f32 v247, v247
    v_cvt_pk_bf16_f32 v44, v244, v245
    v_cvt_pk_bf16_f32 v45, v246, v247
    v_mfma_f32_16x16x32_bf16 v[244:247], a[240:243], v[132:135], v[148:151]
    v_add_u32 v2, s82, v1
    ds_read_b128 a[224:227], v2 offset:0
    v_mfma_f32_16x16x32_bf16 v[244:247], a[244:247], v[164:167], v[244:247]
    ds_read_b128 a[228:231], v2 offset:1024
    ds_read_b128 a[232:235], v2 offset:2048
    v_mfma_f32_16x16x32_bf16 v[244:247], a[248:251], v[196:199], v[244:247]
    v_exp_f32 v248, v248
    v_mfma_f32_16x16x32_bf16 v[244:247], a[252:255], v[228:231], v[244:247]
    v_exp_f32 v249, v249
    v_exp_f32 v250, v250
    v_exp_f32 v251, v251
    v_cvt_pk_bf16_f32 v52, v248, v249
    v_cvt_pk_bf16_f32 v53, v250, v251
    v_mfma_f32_16x16x32_bf16 v[248:251], a[240:243], v[136:139], v[152:155]
    ds_read_b128 a[236:239], v2 offset:3072
    ds_read_b128 v[96:99], v2 offset:16384
    v_mfma_f32_16x16x32_bf16 v[248:251], a[244:247], v[168:171], v[248:251]
    v_exp_f32 v252, v252
    v_mfma_f32_16x16x32_bf16 v[248:251], a[248:251], v[200:203], v[248:251]
    v_exp_f32 v253, v253
    v_mfma_f32_16x16x32_bf16 v[248:251], a[252:255], v[232:235], v[248:251]
    v_exp_f32 v254, v254
    v_exp_f32 v255, v255
    v_cvt_pk_bf16_f32 v60, v252, v253
    v_cvt_pk_bf16_f32 v61, v254, v255
    v_mfma_f32_16x16x32_bf16 v[252:255], a[240:243], v[140:143], v[156:159]
    ds_read_b128 v[100:103], v2 offset:17408
    v_mfma_f32_16x16x32_bf16 v[252:255], a[244:247], v[172:175], v[252:255]
    v_exp_f32 v240, v240
    v_mfma_f32_16x16x32_bf16 v[252:255], a[248:251], v[204:207], v[252:255]
    s_sub_u32 s40, s56, 20971520
    s_subb_u32 s41, s57, 0
    v_mfma_f32_16x16x32_bf16 v[252:255], a[252:255], v[236:239], v[252:255]
    v_exp_f32 v241, v241
    v_exp_f32 v242, v242
    v_exp_f32 v243, v243
    v_exp_f32 v244, v244
    v_exp_f32 v245, v245
    v_exp_f32 v246, v246
    v_exp_f32 v247, v247
    v_exp_f32 v248, v248
    v_exp_f32 v249, v249
    v_exp_f32 v250, v250
    v_exp_f32 v251, v251
    v_cvt_pk_bf16_f32 v38, v240, v241
    v_cvt_pk_bf16_f32 v39, v242, v243
    v_cvt_pk_bf16_f32 v46, v244, v245
    v_cvt_pk_bf16_f32 v47, v246, v247
    v_cvt_pk_bf16_f32 v54, v248, v249
    v_cvt_pk_bf16_f32 v55, v250, v251
    v_exp_f32 v252, v252
    s_cmp_eq_u32 s78, 0
    s_cbranch_scc1 K1_LB_END
.p2align 3
K1_LB:
    s_waitcnt lgkmcnt(0)
    v_mfma_f32_16x16x32_bf16 v[240:243], a[224:227], v[128:131], v[176:179]
    s_mov_b32 s99, s76
    v_exp_f32 v253, v253
    v_mfma_f32_16x16x32_bf16 v[240:243], a[228:231], v[160:163], v[240:243]
    v_exp_f32 v254, v254
    v_mfma_f32_16x16x32_bf16 v[240:243], a[232:235], v[192:195], v[240:243]
    v_exp_f32 v255, v255
    v_mfma_f32_16x16x32_bf16 v[240:243], a[236:239], v[224:227], v[240:243]
    v_cvt_pk_bf16_f32 v62, v252, v253
    v_cvt_pk_bf16_f32 v63, v254, v255
    v_mfma_f32_16x16x32_bf16 a[0:3], v[96:99], v[32:35], a[0:3]
    s_add_u32 m0, s76, s75
    v_mfma_f32_16x16x32_bf16 a[0:3], v[100:103], v[36:39], a[0:3]
    s_mov_b32 s76, s60
    buffer_load_dwordx4 v1, s[36:39], s77 offen sc1 lds
    v_mfma_f32_16x16x32_bf16 a[4:7], v[96:99], v[40:43], a[4:7]
    s_mov_b32 s60, s82
    ds_read_b128 v[104:107], v2 offset:18432
    ds_read_b128 v[108:111], v2 offset:19456
    v_mfma_f32_16x16x32_bf16 a[4:7], v[100:103], v[44:47], a[4:7]
    s_mov_b32 s82, s95
    v_exp_f32 v240, v240
    v_mfma_f32_16x16x32_bf16 v[244:247], a[224:227], v[132:135], v[148:151]
    s_mov_b32 s95, s93
    v_exp_f32 v241, v241
    v_mfma_f32_16x16x32_bf16 v[244:247], a[228:231], v[164:167], v[244:247]
    s_mov_b32 s93, s99
    v_exp_f32 v242, v242
    v_mfma_f32_16x16x32_bf16 v[244:247], a[232:235], v[196:199], v[244:247]
    v_exp_f32 v243, v243
    v_mfma_f32_16x16x32_bf16 v[244:247], a[236:239], v[228:231], v[244:247]
    v_cvt_pk_bf16_f32 v64, v240, v241
    v_cvt_pk_bf16_f32 v65, v242, v243
    v_mfma_f32_16x16x32_bf16 a[8:11], v[96:99], v[48:51], a[8:11]
    v_mfma_f32_16x16x32_bf16 a[8:11], v[100:103], v[52:55], a[8:11]
    v_mfma_f32_16x16x32_bf16 a[12:15], v[96:99], v[56:59], a[12:15]
    v_mfma_f32_16x16x32_bf16 a[12:15], v[100:103], v[60:63], a[12:15]
    v_mfma_f32_16x16x32_bf16 v[248:251], a[224:227], v[136:139], v[152:155]
    v_mfma_f32_16x16x32_bf16 v[248:251], a[228:231], v[168:171], v[248:251]
    ds_read_b128 a[240:243], v2 offset:4096
    ds_read_b128 a[244:247], v2 offset:5120
    v_mfma_f32_16x16x32_bf16 v[248:251], a[232:235], v[200:203], v[248:251]
    buffer_load_dwordx4 v1, s[36:39], s77 offen offset:1024 sc1 lds
    v_mfma_f32_16x16x32_bf16 v[248:251], a[236:239], v[232:235], v[248:251]
    s_waitcnt lgkmcnt(2)
    ds_read_b128 a[248:251], v2 offset:6144
    ds_read_b128 a[252:255], v2 offset:7168
    v_mfma_f32_16x16x32_bf16 a[16:19], v[104:107], v[32:35], a[16:19]
    v_exp_f32 v244, v244
    v_mfma_f32_16x16x32_bf16 a[16:19], v[108:111], v[36:39], a[16:19]
    ds_read_b128 v[112:115], v2 offset:20480
    ds_read_b128 v[116:119], v2 offset:21504
    v_mfma_f32_16x16x32_bf16 a[20:23], v[104:107], v[40:43], a[20:23]
    v_exp_f32 v245, v245
    v_mfma_f32_16x16x32_bf16 a[20:23], v[108:111], v[44:47], a[20:23]
    v_exp_f32 v246, v246
    v_mfma_f32_16x16x32_bf16 v[252:255], a[224:227], v[140:143], v[156:159]
    v_exp_f32 v247, v247
    v_mfma_f32_16x16x32_bf16 v[252:255], a[228:231], v[172:175], v[252:255]
    v_cvt_pk_bf16_f32 v72, v244, v245
    v_cvt_pk_bf16_f32 v73, v246, v247
    v_mfma_f32_16x16x32_bf16 v[252:255], a[232:235], v[204:207], v[252:255]
    v_exp_f32 v248, v248
    v_mfma_f32_16x16x32_bf16 v[252:255], a[236:239], v[236:239], v[252:255]
    v_exp_f32 v249, v249
    v_mfma_f32_16x16x32_bf16 a[24:27], v[104:107], v[48:51], a[24:27]
    v_exp_f32 v250, v250
    v_mfma_f32_16x16x32_bf16 a[24:27], v[108:111], v[52:55], a[24:27]
    v_exp_f32 v251, v251
    v_mfma_f32_16x16x32_bf16 a[28:31], v[104:107], v[56:59], a[28:31]
    v_cvt_pk_bf16_f32 v80, v248, v249
    v_cvt_pk_bf16_f32 v81, v250, v251
    v_mfma_f32_16x16x32_bf16 a[28:31], v[108:111], v[60:63], a[28:31]
    s_waitcnt lgkmcnt(0)
    buffer_load_dwordx4 v1, s[36:39], s77 offen offset:2048 sc1 lds
    v_mfma_f32_16x16x32_bf16 v[240:243], a[240:243], v[128:131], v[180:183]
    v_exp_f32 v252, v252
    v_mfma_f32_16x16x32_bf16 v[240:243], a[244:247], v[160:163], v[240:243]
    v_exp_f32 v253, v253
    v_mfma_f32_16x16x32_bf16 v[240:243], a[248:251], v[192:195], v[240:243]
    v_exp_f32 v254, v254
    v_mfma_f32_16x16x32_bf16 v[240:243], a[252:255], v[224:227], v[240:243]
    v_exp_f32 v255, v255
    v_mfma_f32_16x16x32_bf16 a[32:35], v[112:115], v[32:35], a[32:35]
    v_cvt_pk_bf16_f32 v88, v252, v253
    v_cvt_pk_bf16_f32 v89, v254, v255
    v_mfma_f32_16x16x32_bf16 a[32:35], v[116:119], v[36:39], a[32:35]
    ds_read_b128 v[120:123], v2 offset:22528
    ds_read_b128 v[124:127], v2 offset:23552
    v_mfma_f32_16x16x32_bf16 a[36:39], v[112:115], v[40:43], a[36:39]
    v_exp_f32 v240, v240
    v_mfma_f32_16x16x32_bf16 a[36:39], v[116:119], v[44:47], a[36:39]
    v_exp_f32 v241, v241
    v_mfma_f32_16x16x32_bf16 v[244:247], a[240:243], v[132:135], v[148:151]
    v_exp_f32 v242, v242
    v_mfma_f32_16x16x32_bf16 v[244:247], a[244:247], v[164:167], v[244:247]
    v_exp_f32 v243, v243
    v_mfma_f32_16x16x32_bf16 v[244:247], a[248:251], v[196:199], v[244:247]
    v_cvt_pk_bf16_f32 v66, v240, v241
    v_cvt_pk_bf16_f32 v67, v242, v243
    v_mfma_f32_16x16x32_bf16 v[244:247], a[252:255], v[228:231], v[244:247]
    v_mfma_f32_16x16x32_bf16 a[40:43], v[112:115], v[48:51], a[40:43]
    buffer_load_dwordx4 v1, s[36:39], s77 offen offset:3072 sc1 lds
    v_mfma_f32_16x16x32_bf16 a[40:43], v[116:119], v[52:55], a[40:43]
    v_mfma_f32_16x16x32_bf16 a[44:47], v[112:115], v[56:59], a[44:47]
    v_mfma_f32_16x16x32_bf16 a[44:47], v[116:119], v[60:63], a[44:47]
    v_mfma_f32_16x16x32_bf16 v[248:251], a[240:243], v[136:139], v[152:155]
    v_mfma_f32_16x16x32_bf16 v[248:251], a[244:247], v[168:171], v[248:251]
    ds_read_b128 a[224:227], v2 offset:8192
    ds_read_b128 a[228:231], v2 offset:9216
    v_mfma_f32_16x16x32_bf16 v[248:251], a[248:251], v[200:203], v[248:251]
    v_exp_f32 v244, v244
    v_mfma_f32_16x16x32_bf16 v[248:251], a[252:255], v[232:235], v[248:251]
    s_waitcnt lgkmcnt(2)
    ds_read_b128 a[232:235], v2 offset:10240
    ds_read_b128 a[236:239], v2 offset:11264
    v_mfma_f32_16x16x32_bf16 a[48:51], v[120:123], v[32:35], a[48:51]
    v_exp_f32 v245, v245
    v_mfma_f32_16x16x32_bf16 a[48:51], v[124:127], v[36:39], a[48:51]
    ds_read_b128 v[96:99], v2 offset:24576
    ds_read_b128 v[100:103], v2 offset:25600
    v_mfma_f32_16x16x32_bf16 a[52:55], v[120:123], v[40:43], a[52:55]
    v_exp_f32 v246, v246
    v_mfma_f32_16x16x32_bf16 a[52:55], v[124:127], v[44:47], a[52:55]
    v_exp_f32 v247, v247
    v_mfma_f32_16x16x32_bf16 v[252:255], a[240:243], v[140:143], v[156:159]
    v_cvt_pk_bf16_f32 v74, v244, v245
    v_cvt_pk_bf16_f32 v75, v246, v247
    v_mfma_f32_16x16x32_bf16 v[252:255], a[244:247], v[172:175], v[252:255]
    s_add_u32 s100, s77, 4096
    v_exp_f32 v248, v248
    v_mfma_f32_16x16x32_bf16 v[252:255], a[248:251], v[204:207], v[252:255]
    s_add_u32 m0, m0, 4096
    v_exp_f32 v249, v249
    v_mfma_f32_16x16x32_bf16 v[252:255], a[252:255], v[236:239], v[252:255]
    buffer_load_dwordx4 v1, s[36:39], s100 offen sc1 lds
    v_mfma_f32_16x16x32_bf16 a[56:59], v[120:123], v[48:51], a[56:59]
    v_exp_f32 v250, v250
    v_mfma_f32_16x16x32_bf16 a[56:59], v[124:127], v[52:55], a[56:59]
    v_exp_f32 v251, v251
    v_mfma_f32_16x16x32_bf16 a[60:63], v[120:123], v[56:59], a[60:63]
    v_cvt_pk_bf16_f32 v82, v248, v249
    v_cvt_pk_bf16_f32 v83, v250, v251
    v_mfma_f32_16x16x32_bf16 a[60:63], v[124:127], v[60:63], a[60:63]
    s_waitcnt lgkmcnt(0)
    v_exp_f32 v252, v252
    v_mfma_f32_16x16x32_bf16 v[240:243], a[224:227], v[128:131], v[184:187]
    v_exp_f32 v253, v253
    v_mfma_f32_16x16x32_bf16 v[240:243], a[228:231], v[160:163], v[240:243]
    v_exp_f32 v254, v254
    v_mfma_f32_16x16x32_bf16 v[240:243], a[232:235], v[192:195], v[240:243]
    v_exp_f32 v255, v255
    v_mfma_f32_16x16x32_bf16 v[240:243], a[236:239], v[224:227], v[240:243]
    v_cvt_pk_bf16_f32 v90, v252, v253
    v_cvt_pk_bf16_f32 v91, v254, v255
    v_mfma_f32_16x16x32_bf16 a[144:147], v[96:99], v[32:35], a[144:147]
    v_mfma_f32_16x16x32_bf16 a[144:147], v[100:103], v[36:39], a[144:147]
    ds_read_b128 v[104:107], v2 offset:26624
    ds_read_b128 v[108:111], v2 offset:27648
    v_mfma_f32_16x16x32_bf16 a[148:151], v[96:99], v[40:43], a[148:151]
    v_mfma_f32_16x16x32_bf16 a[148:151], v[100:103], v[44:47], a[148:151]
    buffer_load_dwordx4 v1, s[36:39], s100 offen offset:1024 sc1 lds
    v_mfma_f32_16x16x32_bf16 v[244:247], a[224:227], v[132:135], v[148:151]
    v_exp_f32 v240, v240
    v_mfma_f32_16x16x32_bf16 v[244:247], a[228:231], v[164:167], v[244:247]
    v_exp_f32 v241, v241
    v_mfma_f32_16x16x32_bf16 v[244:247], a[232:235], v[196:199], v[244:247]
    v_exp_f32 v242, v242
    v_mfma_f32_16x16x32_bf16 v[244:247], a[236:239], v[228:231], v[244:247]
    v_exp_f32 v243, v243
    v_mfma_f32_16x16x32_bf16 a[152:155], v[96:99], v[48:51], a[152:155]
    v_cvt_pk_bf16_f32 v68, v240, v241
    v_cvt_pk_bf16_f32 v69, v242, v243
    v_mfma_f32_16x16x32_bf16 a[152:155], v[100:103], v[52:55], a[152:155]
    v_mfma_f32_16x16x32_bf16 a[156:159], v[96:99], v[56:59], a[156:159]
    v_mfma_f32_16x16x32_bf16 a[156:159], v[100:103], v[60:63], a[156:159]
    v_mfma_f32_16x16x32_bf16 v[248:251], a[224:227], v[136:139], v[152:155]
    v_exp_f32 v244, v244
    v_mfma_f32_16x16x32_bf16 v[248:251], a[228:231], v[168:171], v[248:251]
    ds_read_b128 a[240:243], v2 offset:12288
    ds_read_b128 a[244:247], v2 offset:13312
    v_mfma_f32_16x16x32_bf16 v[248:251], a[232:235], v[200:203], v[248:251]
    v_exp_f32 v245, v245
    v_mfma_f32_16x16x32_bf16 v[248:251], a[236:239], v[232:235], v[248:251]
    s_waitcnt lgkmcnt(2)
    ds_read_b128 a[248:251], v2 offset:14336
    ds_read_b128 a[252:255], v2 offset:15360
    v_mfma_f32_16x16x32_bf16 a[160:163], v[104:107], v[32:35], a[160:163]
    buffer_load_dwordx4 v1, s[36:39], s100 offen offset:2048 sc1 lds
    v_mfma_f32_16x16x32_bf16 a[160:163], v[108:111], v[36:39], a[160:163]
    ds_read_b128 v[112:115], v2 offset:28672
    ds_read_b128 v[116:119], v2 offset:29696
    v_mfma_f32_16x16x32_bf16 a[164:167], v[104:107], v[40:43], a[164:167]
    v_exp_f32 v246, v246
    v_mfma_f32_16x16x32_bf16 a[164:167], v[108:111], v[44:47], a[164:167]
    v_exp_f32 v247, v247
    v_mfma_f32_16x16x32_bf16 v[252:255], a[224:227], v[140:143], v[156:159]
    v_cvt_pk_bf16_f32 v76, v244, v245
    v_cvt_pk_bf16_f32 v77, v246, v247
    v_mfma_f32_16x16x32_bf16 v[252:255], a[228:231], v[172:175], v[252:255]
    v_exp_f32 v248, v248
    v_mfma_f32_16x16x32_bf16 v[252:255], a[232:235], v[204:207], v[252:255]
    v_exp_f32 v249, v249
    v_mfma_f32_16x16x32_bf16 v[252:255], a[236:239], v[236:239], v[252:255]
    v_exp_f32 v250, v250
    v_mfma_f32_16x16x32_bf16 a[168:171], v[104:107], v[48:51], a[168:171]
    v_exp_f32 v251, v251
    v_mfma_f32_16x16x32_bf16 a[168:171], v[108:111], v[52:55], a[168:171]
    v_cvt_pk_bf16_f32 v84, v248, v249
    v_cvt_pk_bf16_f32 v85, v250, v251
    v_mfma_f32_16x16x32_bf16 a[172:175], v[104:107], v[56:59], a[172:175]
    v_mfma_f32_16x16x32_bf16 a[172:175], v[108:111], v[60:63], a[172:175]
    s_waitcnt lgkmcnt(0)
    v_exp_f32 v252, v252
    v_mfma_f32_16x16x32_bf16 v[240:243], a[240:243], v[128:131], v[188:191]
    v_exp_f32 v253, v253
    v_mfma_f32_16x16x32_bf16 v[240:243], a[244:247], v[160:163], v[240:243]
    buffer_load_dwordx4 v1, s[36:39], s100 offen offset:3072 sc1 lds
    v_mfma_f32_16x16x32_bf16 v[240:243], a[248:251], v[192:195], v[240:243]
    v_exp_f32 v254, v254
    v_mfma_f32_16x16x32_bf16 v[240:243], a[252:255], v[224:227], v[240:243]
    v_exp_f32 v255, v255
    v_mfma_f32_16x16x32_bf16 a[176:179], v[112:115], v[32:35], a[176:179]
    v_cvt_pk_bf16_f32 v92, v252, v253
    v_cvt_pk_bf16_f32 v93, v254, v255
    v_mfma_f32_16x16x32_bf16 a[176:179], v[116:119], v[36:39], a[176:179]
    ds_read_b128 v[120:123], v2 offset:30720
    ds_read_b128 v[124:127], v2 offset:31744
    v_mfma_f32_16x16x32_bf16 a[180:183], v[112:115], v[40:43], a[180:183]
    v_exp_f32 v240, v240
    v_mfma_f32_16x16x32_bf16 a[180:183], v[116:119], v[44:47], a[180:183]
    v_exp_f32 v241, v241
    v_mfma_f32_16x16x32_bf16 v[244:247], a[240:243], v[132:135], v[148:151]
    v_add_u32 v2, s82, v1
    v_cvt_pk_bf16_f32 v70, v240, v241
    v_mfma_f32_16x16x32_bf16 v[244:247], a[244:247], v[164:167], v[244:247]
    v_exp_f32 v242, v242
    v_mfma_f32_16x16x32_bf16 v[244:247], a[248:251], v[196:199], v[244:247]
    v_exp_f32 v243, v243
    v_mfma_f32_16x16x32_bf16 v[244:247], a[252:255], v[228:231], v[244:247]
    v_cvt_pk_bf16_f32 v71, v242, v243
    v_mfma_f32_16x16x32_bf16 a[184:187], v[112:115], v[48:51], a[184:187]
    v_mfma_f32_16x16x32_bf16 a[184:187], v[116:119], v[52:55], a[184:187]
    v_mfma_f32_16x16x32_bf16 a[188:191], v[112:115], v[56:59], a[188:191]
    s_add_u32 s77, s77, 32768
    v_mfma_f32_16x16x32_bf16 a[188:191], v[116:119], v[60:63], a[188:191]
    v_mfma_f32_16x16x32_bf16 v[248:251], a[240:243], v[136:139], v[152:155]
    v_mfma_f32_16x16x32_bf16 v[248:251], a[244:247], v[168:171], v[248:251]
    v_exp_f32 v244, v244
    v_mfma_f32_16x16x32_bf16 v[248:251], a[248:251], v[200:203], v[248:251]
    v_exp_f32 v245, v245
    v_mfma_f32_16x16x32_bf16 v[248:251], a[252:255], v[232:235], v[248:251]
    s_waitcnt lgkmcnt(0)
    v_exp_f32 v246, v246
    v_mfma_f32_16x16x32_bf16 a[192:195], v[120:123], v[32:35], a[192:195]
    v_exp_f32 v247, v247
    v_mfma_f32_16x16x32_bf16 a[192:195], v[124:127], v[36:39], a[192:195]
    ds_read_b128 a[224:227], v2 offset:0
    ds_read_b128 a[228:231], v2 offset:1024
    v_mfma_f32_16x16x32_bf16 a[196:199], v[120:123], v[40:43], a[196:199]
    ds_read_b128 a[232:235], v2 offset:2048
    v_cvt_pk_bf16_f32 v78, v244, v245
    v_mfma_f32_16x16x32_bf16 a[196:199], v[124:127], v[44:47], a[196:199]
    ds_read_b128 a[236:239], v2 offset:3072
    v_cvt_pk_bf16_f32 v79, v246, v247
    v_mfma_f32_16x16x32_bf16 v[252:255], a[240:243], v[140:143], v[156:159]
    v_exp_f32 v248, v248
    v_mfma_f32_16x16x32_bf16 v[252:255], a[244:247], v[172:175], v[252:255]
    ds_read_b128 v[96:99], v2 offset:16384
    ds_read_b128 v[100:103], v2 offset:17408
    v_mfma_f32_16x16x32_bf16 v[252:255], a[248:251], v[204:207], v[252:255]
    v_exp_f32 v249, v249
    v_mfma_f32_16x16x32_bf16 v[252:255], a[252:255], v[236:239], v[252:255]
    v_exp_f32 v250, v250
    v_mfma_f32_16x16x32_bf16 a[200:203], v[120:123], v[48:51], a[200:203]
    v_exp_f32 v251, v251
    v_mfma_f32_16x16x32_bf16 a[200:203], v[124:127], v[52:55], a[200:203]
    v_cvt_pk_bf16_f32 v86, v248, v249
    v_cvt_pk_bf16_f32 v87, v250, v251
    v_mfma_f32_16x16x32_bf16 a[204:207], v[120:123], v[56:59], a[204:207]
    v_mfma_f32_16x16x32_bf16 a[204:207], v[124:127], v[60:63], a[204:207]
    v_exp_f32 v252, v252
    v_smfmac_f32_16x16x64_bf16 a[208:211], a[136:139], v[32:39], v215
    v_smfmac_f32_16x16x64_bf16 a[212:215], a[136:139], v[40:47], v215
    v_smfmac_f32_16x16x64_bf16 a[216:219], a[136:139], v[48:55], v215
    s_cmp_le_u32 s78, 1
    v_smfmac_f32_16x16x64_bf16 a[220:223], a[136:139], v[56:63], v215
    s_cbranch_scc1 K1_LB_MASK
K1_LB_BACK:
    s_waitcnt lgkmcnt(0)
    v_mfma_f32_16x16x32_bf16 v[240:243], a[224:227], v[128:131], v[176:179]
    s_mov_b32 s99, s76
    v_exp_f32 v253, v253
    v_mfma_f32_16x16x32_bf16 v[240:243], a[228:231], v[160:163], v[240:243]
    v_exp_f32 v254, v254
    v_mfma_f32_16x16x32_bf16 v[240:243], a[232:235], v[192:195], v[240:243]
    v_exp_f32 v255, v255
    v_mfma_f32_16x16x32_bf16 v[240:243], a[236:239], v[224:227], v[240:243]
    v_cvt_pk_bf16_f32 v94, v252, v253
    v_cvt_pk_bf16_f32 v95, v254, v255
    v_mfma_f32_16x16x32_bf16 a[0:3], v[96:99], v[64:67], a[0:3]
    s_add_u32 m0, s76, s75
    v_mfma_f32_16x16x32_bf16 a[0:3], v[100:103], v[68:71], a[0:3]
    s_mov_b32 s76, s60
    buffer_load_dwordx4 v1, s[36:39], s77 offen sc1 lds
    v_mfma_f32_16x16x32_bf16 a[4:7], v[96:99], v[72:75], a[4:7]
    s_mov_b32 s60, s82
    ds_read_b128 v[104:107], v2 offset:18432
    ds_read_b128 v[108:111], v2 offset:19456
    v_mfma_f32_16x16x32_bf16 a[4:7], v[100:103], v[76:79], a[4:7]
    s_mov_b32 s82, s95
    v_exp_f32 v240, v240
    v_mfma_f32_16x16x32_bf16 v[244:247], a[224:227], v[132:135], v[148:151]
    s_mov_b32 s95, s93
    v_exp_f32 v241, v241
    v_mfma_f32_16x16x32_bf16 v[244:247], a[228:231], v[164:167], v[244:247]
    s_mov_b32 s93, s99
    v_exp_f32 v242, v242
    v_mfma_f32_16x16x32_bf16 v[244:247], a[232:235], v[196:199], v[244:247]
    v_exp_f32 v243, v243
    v_mfma_f32_16x16x32_bf16 v[244:247], a[236:239], v[228:231], v[244:247]
    v_cvt_pk_bf16_f32 v32, v240, v241
    v_cvt_pk_bf16_f32 v33, v242, v243
    v_mfma_f32_16x16x32_bf16 a[8:11], v[96:99], v[80:83], a[8:11]
    v_mfma_f32_16x16x32_bf16 a[8:11], v[100:103], v[84:87], a[8:11]
    v_mfma_f32_16x16x32_bf16 a[12:15], v[96:99], v[88:91], a[12:15]
    v_mfma_f32_16x16x32_bf16 a[12:15], v[100:103], v[92:95], a[12:15]
    v_mfma_f32_16x16x32_bf16 v[248:251], a[224:227], v[136:139], v[152:155]
    v_mfma_f32_16x16x32_bf16 v[248:251], a[228:231], v[168:171], v[248:251]
    ds_read_b128 a[240:243], v2 offset:4096
    ds_read_b128 a[244:247], v2 offset:5120
    v_mfma_f32_16x16x32_bf16 v[248:251], a[232:235], v[200:203], v[248:251]
    buffer_load_dwordx4 v1, s[36:39], s77 offen offset:1024 sc1 lds
    v_mfma_f32_16x16x32_bf16 v[248:251], a[236:239], v[232:235], v[248:251]
    s_waitcnt lgkmcnt(2)
    ds_read_b128 a[248:251], v2 offset:6144
    ds_read_b128 a[252:255], v2 offset:7168
    v_mfma_f32_16x16x32_bf16 a[16:19], v[104:107], v[64:67], a[16:19]
    v_exp_f32 v244, v244
    v_mfma_f32_16x16x32_bf16 a[16:19], v[108:111], v[68:71], a[16:19]
    ds_read_b128 v[112:115], v2 offset:20480
    ds_read_b128 v[116:119], v2 offset:21504
    v_mfma_f32_16x16x32_bf16 a[20:23], v[104:107], v[72:75], a[20:23]
    v_exp_f32 v245, v245
    v_mfma_f32_16x16x32_bf16 a[20:23], v[108:111], v[76:79], a[20:23]
    v_exp_f32 v246, v246
    v_mfma_f32_16x16x32_bf16 v[252:255], a[224:227], v[140:143], v[156:159]
    v_exp_f32 v247, v247
    v_mfma_f32_16x16x32_bf16 v[252:255], a[228:231], v[172:175], v[252:255]
    v_cvt_pk_bf16_f32 v40, v244, v245
    v_cvt_pk_bf16_f32 v41, v246, v247
    v_mfma_f32_16x16x32_bf16 v[252:255], a[232:235], v[204:207], v[252:255]
    v_exp_f32 v248, v248
    v_mfma_f32_16x16x32_bf16 v[252:255], a[236:239], v[236:239], v[252:255]
    v_exp_f32 v249, v249
    v_mfma_f32_16x16x32_bf16 a[24:27], v[104:107], v[80:83], a[24:27]
    v_exp_f32 v250, v250
    v_mfma_f32_16x16x32_bf16 a[24:27], v[108:111], v[84:87], a[24:27]
    v_exp_f32 v251, v251
    v_mfma_f32_16x16x32_bf16 a[28:31], v[104:107], v[88:91], a[28:31]
    v_cvt_pk_bf16_f32 v48, v248, v249
    v_cvt_pk_bf16_f32 v49, v250, v251
    v_mfma_f32_16x16x32_bf16 a[28:31], v[108:111], v[92:95], a[28:31]
    s_waitcnt lgkmcnt(0)
    buffer_load_dwordx4 v1, s[36:39], s77 offen offset:2048 sc1 lds
    v_mfma_f32_16x16x32_bf16 v[240:243], a[240:243], v[128:131], v[180:183]
    v_exp_f32 v252, v252
    v_mfma_f32_16x16x32_bf16 v[240:243], a[244:247], v[160:163], v[240:243]
    v_exp_f32 v253, v253
    v_mfma_f32_16x16x32_bf16 v[240:243], a[248:251], v[192:195], v[240:243]
    v_exp_f32 v254, v254
    v_mfma_f32_16x16x32_bf16 v[240:243], a[252:255], v[224:227], v[240:243]
    v_exp_f32 v255, v255
    v_mfma_f32_16x16x32_bf16 a[32:35], v[112:115], v[64:67], a[32:35]
    v_cvt_pk_bf16_f32 v56, v252, v253
    v_cvt_pk_bf16_f32 v57, v254, v255
    v_mfma_f32_16x16x32_bf16 a[32:35], v[116:119], v[68:71], a[32:35]
    ds_read_b128 v[120:123], v2 offset:22528
    ds_read_b128 v[124:127], v2 offset:23552
    v_mfma_f32_16x16x32_bf16 a[36:39], v[112:115], v[72:75], a[36:39]
    v_exp_f32 v240, v240
    v_mfma_f32_16x16x32_bf16 a[36:39], v[116:119], v[76:79], a[36:39]
    v_exp_f32 v241, v241
    v_mfma_f32_16x16x32_bf16 v[244:247], a[240:243], v[132:135], v[148:151]
    v_exp_f32 v242, v242
    v_mfma_f32_16x16x32_bf16 v[244:247], a[244:247], v[164:167], v[244:247]
    v_exp_f32 v243, v243
    v_mfma_f32_16x16x32_bf16 v[244:247], a[248:251], v[196:199], v[244:247]
    v_cvt_pk_bf16_f32 v34, v240, v241
    v_cvt_pk_bf16_f32 v35, v242, v243
    v_mfma_f32_16x16x32_bf16 v[244:247], a[252:255], v[228:231], v[244:247]
    v_mfma_f32_16x16x32_bf16 a[40:43], v[112:115], v[80:83], a[40:43]
    buffer_load_dwordx4 v1, s[36:39], s77 offen offset:3072 sc1 lds
    v_mfma_f32_16x16x32_bf16 a[40:43], v[116:119], v[84:87], a[40:43]
    v_mfma_f32_16x16x32_bf16 a[44:47], v[112:115], v[88:91], a[44:47]
    v_mfma_f32_16x16x32_bf16 a[44:47], v[116:119], v[92:95], a[44:47]
    v_mfma_f32_16x16x32_bf16 v[248:251], a[240:243], v[136:139], v[152:155]
    v_mfma_f32_16x16x32_bf16 v[248:251], a[244:247], v[168:171], v[248:251]
    ds_read_b128 a[224:227], v2 offset:8192
    ds_read_b128 a[228:231], v2 offset:9216
    v_mfma_f32_16x16x32_bf16 v[248:251], a[248:251], v[200:203], v[248:251]
    v_exp_f32 v244, v244
    v_mfma_f32_16x16x32_bf16 v[248:251], a[252:255], v[232:235], v[248:251]
    s_waitcnt lgkmcnt(2)
    ds_read_b128 a[232:235], v2 offset:10240
    ds_read_b128 a[236:239], v2 offset:11264
    v_mfma_f32_16x16x32_bf16 a[48:51], v[120:123], v[64:67], a[48:51]
    v_exp_f32 v245, v245
    v_mfma_f32_16x16x32_bf16 a[48:51], v[124:127], v[68:71], a[48:51]
    ds_read_b128 v[96:99], v2 offset:24576
    ds_read_b128 v[100:103], v2 offset:25600
    v_mfma_f32_16x16x32_bf16 a[52:55], v[120:123], v[72:75], a[52:55]
    v_exp_f32 v246, v246
    v_mfma_f32_16x16x32_bf16 a[52:55], v[124:127], v[76:79], a[52:55]
    v_exp_f32 v247, v247
    v_mfma_f32_16x16x32_bf16 v[252:255], a[240:243], v[140:143], v[156:159]
    v_cvt_pk_bf16_f32 v42, v244, v245
    v_cvt_pk_bf16_f32 v43, v246, v247
    v_mfma_f32_16x16x32_bf16 v[252:255], a[244:247], v[172:175], v[252:255]
    s_add_u32 s100, s77, 4096
    v_exp_f32 v248, v248
    v_mfma_f32_16x16x32_bf16 v[252:255], a[248:251], v[204:207], v[252:255]
    s_add_u32 m0, m0, 4096
    v_exp_f32 v249, v249
    v_mfma_f32_16x16x32_bf16 v[252:255], a[252:255], v[236:239], v[252:255]
    buffer_load_dwordx4 v1, s[36:39], s100 offen sc1 lds
    v_mfma_f32_16x16x32_bf16 a[56:59], v[120:123], v[80:83], a[56:59]
    v_exp_f32 v250, v250
    v_mfma_f32_16x16x32_bf16 a[56:59], v[124:127], v[84:87], a[56:59]
    v_exp_f32 v251, v251
    v_mfma_f32_16x16x32_bf16 a[60:63], v[120:123], v[88:91], a[60:63]
    v_cvt_pk_bf16_f32 v50, v248, v249
    v_cvt_pk_bf16_f32 v51, v250, v251
    v_mfma_f32_16x16x32_bf16 a[60:63], v[124:127], v[92:95], a[60:63]
    s_waitcnt lgkmcnt(0)
    v_exp_f32 v252, v252
    v_mfma_f32_16x16x32_bf16 v[240:243], a[224:227], v[128:131], v[184:187]
    v_exp_f32 v253, v253
    v_mfma_f32_16x16x32_bf16 v[240:243], a[228:231], v[160:163], v[240:243]
    v_exp_f32 v254, v254
    v_mfma_f32_16x16x32_bf16 v[240:243], a[232:235], v[192:195], v[240:243]
    v_exp_f32 v255, v255
    v_mfma_f32_16x16x32_bf16 v[240:243], a[236:239], v[224:227], v[240:243]
    v_cvt_pk_bf16_f32 v58, v252, v253
    v_cvt_pk_bf16_f32 v59, v254, v255
    v_mfma_f32_16x16x32_bf16 a[144:147], v[96:99], v[64:67], a[144:147]
    v_mfma_f32_16x16x32_bf16 a[144:147], v[100:103], v[68:71], a[144:147]
    ds_read_b128 v[104:107], v2 offset:26624
    ds_read_b128 v[108:111], v2 offset:27648
    v_mfma_f32_16x16x32_bf16 a[148:151], v[96:99], v[72:75], a[148:151]
    v_mfma_f32_16x16x32_bf16 a[148:151], v[100:103], v[76:79], a[148:151]
    buffer_load_dwordx4 v1, s[36:39], s100 offen offset:1024 sc1 lds
    v_mfma_f32_16x16x32_bf16 v[244:247], a[224:227], v[132:135], v[148:151]
    v_exp_f32 v240, v240
    v_mfma_f32_16x16x32_bf16 v[244:247], a[228:231], v[164:167], v[244:247]
    v_exp_f32 v241, v241
    v_mfma_f32_16x16x32_bf16 v[244:247], a[232:235], v[196:199], v[244:247]
    v_exp_f32 v242, v242
    v_mfma_f32_16x16x32_bf16 v[244:247], a[236:239], v[228:231], v[244:247]
    v_exp_f32 v243, v243
    v_mfma_f32_16x16x32_bf16 a[152:155], v[96:99], v[80:83], a[152:155]
    v_cvt_pk_bf16_f32 v36, v240, v241
    v_cvt_pk_bf16_f32 v37, v242, v243
    v_mfma_f32_16x16x32_bf16 a[152:155], v[100:103], v[84:87], a[152:155]
    v_mfma_f32_16x16x32_bf16 a[156:159], v[96:99], v[88:91], a[156:159]
    v_mfma_f32_16x16x32_bf16 a[156:159], v[100:103], v[92:95], a[156:159]
    v_mfma_f32_16x16x32_bf16 v[248:251], a[224:227], v[136:139], v[152:155]
    v_exp_f32 v244, v244
    v_mfma_f32_16x16x32_bf16 v[248:251], a[228:231], v[168:171], v[248:251]
    ds_read_b128 a[240:243], v2 offset:12288
    ds_read_b128 a[244:247], v2 offset:13312
    v_mfma_f32_16x16x32_bf16 v[248:251], a[232:235], v[200:203], v[248:251]
    v_exp_f32 v245, v245
    v_mfma_f32_16x16x32_bf16 v[248:251], a[236:239], v[232:235], v[248:251]
    s_waitcnt lgkmcnt(2)
    ds_read_b128 a[248:251], v2 offset:14336
    ds_read_b128 a[252:255], v2 offset:15360
    v_mfma_f32_16x16x32_bf16 a[160:163], v[104:107], v[64:67], a[160:163]
    buffer_load_dwordx4 v1, s[36:39], s100 offen offset:2048 sc1 lds
    v_mfma_f32_16x16x32_bf16 a[160:163], v[108:111], v[68:71], a[160:163]
    ds_read_b128 v[112:115], v2 offset:28672
    ds_read_b128 v[116:119], v2 offset:29696
    v_mfma_f32_16x16x32_bf16 a[164:167], v[104:107], v[72:75], a[164:167]
    v_exp_f32 v246, v246
    v_mfma_f32_16x16x32_bf16 a[164:167], v[108:111], v[76:79], a[164:167]
    v_exp_f32 v247, v247
    v_mfma_f32_16x16x32_bf16 v[252:255], a[224:227], v[140:143], v[156:159]
    v_cvt_pk_bf16_f32 v44, v244, v245
    v_cvt_pk_bf16_f32 v45, v246, v247
    v_mfma_f32_16x16x32_bf16 v[252:255], a[228:231], v[172:175], v[252:255]
    v_exp_f32 v248, v248
    v_mfma_f32_16x16x32_bf16 v[252:255], a[232:235], v[204:207], v[252:255]
    v_exp_f32 v249, v249
    v_mfma_f32_16x16x32_bf16 v[252:255], a[236:239], v[236:239], v[252:255]
    v_exp_f32 v250, v250
    v_mfma_f32_16x16x32_bf16 a[168:171], v[104:107], v[80:83], a[168:171]
    v_exp_f32 v251, v251
    v_mfma_f32_16x16x32_bf16 a[168:171], v[108:111], v[84:87], a[168:171]
    v_cvt_pk_bf16_f32 v52, v248, v249
    v_cvt_pk_bf16_f32 v53, v250, v251
    v_mfma_f32_16x16x32_bf16 a[172:175], v[104:107], v[88:91], a[172:175]
    v_mfma_f32_16x16x32_bf16 a[172:175], v[108:111], v[92:95], a[172:175]
    s_waitcnt lgkmcnt(0)
    v_exp_f32 v252, v252
    v_mfma_f32_16x16x32_bf16 v[240:243], a[240:243], v[128:131], v[188:191]
    v_exp_f32 v253, v253
    v_mfma_f32_16x16x32_bf16 v[240:243], a[244:247], v[160:163], v[240:243]
    buffer_load_dwordx4 v1, s[36:39], s100 offen offset:3072 sc1 lds
    v_mfma_f32_16x16x32_bf16 v[240:243], a[248:251], v[192:195], v[240:243]
    v_exp_f32 v254, v254
    v_mfma_f32_16x16x32_bf16 v[240:243], a[252:255], v[224:227], v[240:243]
    v_exp_f32 v255, v255
    v_mfma_f32_16x16x32_bf16 a[176:179], v[112:115], v[64:67], a[176:179]
    v_cvt_pk_bf16_f32 v60, v252, v253
    v_cvt_pk_bf16_f32 v61, v254, v255
    v_mfma_f32_16x16x32_bf16 a[176:179], v[116:119], v[68:71], a[176:179]
    ds_read_b128 v[120:123], v2 offset:30720
    ds_read_b128 v[124:127], v2 offset:31744
    v_mfma_f32_16x16x32_bf16 a[180:183], v[112:115], v[72:75], a[180:183]
    v_exp_f32 v240, v240
    v_mfma_f32_16x16x32_bf16 a[180:183], v[116:119], v[76:79], a[180:183]
    v_exp_f32 v241, v241
    v_mfma_f32_16x16x32_bf16 v[244:247], a[240:243], v[132:135], v[148:151]
    v_add_u32 v2, s82, v1
    v_cvt_pk_bf16_f32 v38, v240, v241
    v_mfma_f32_16x16x32_bf16 v[244:247], a[244:247], v[164:167], v[244:247]
    v_exp_f32 v242, v242
    v_mfma_f32_16x16x32_bf16 v[244:247], a[248:251], v[196:199], v[244:247]
    v_exp_f32 v243, v243
    v_mfma_f32_16x16x32_bf16 v[244:247], a[252:255], v[228:231], v[244:247]
    v_cvt_pk_bf16_f32 v39, v242, v243
    v_mfma_f32_16x16x32_bf16 a[184:187], v[112:115], v[80:83], a[184:187]
    v_mfma_f32_16x16x32_bf16 a[184:187], v[116:119], v[84:87], a[184:187]
    v_mfma_f32_16x16x32_bf16 a[188:191], v[112:115], v[88:91], a[188:191]
    s_add_u32 s77, s77, 32768
    v_mfma_f32_16x16x32_bf16 a[188:191], v[116:119], v[92:95], a[188:191]
    v_mfma_f32_16x16x32_bf16 v[248:251], a[240:243], v[136:139], v[152:155]
    v_mfma_f32_16x16x32_bf16 v[248:251], a[244:247], v[168:171], v[248:251]
    v_exp_f32 v244, v244
    v_mfma_f32_16x16x32_bf16 v[248:251], a[248:251], v[200:203], v[248:251]
    v_exp_f32 v245, v245
    v_mfma_f32_16x16x32_bf16 v[248:251], a[252:255], v[232:235], v[248:251]
    s_waitcnt lgkmcnt(0)
    v_exp_f32 v246, v246
    v_mfma_f32_16x16x32_bf16 a[192:195], v[120:123], v[64:67], a[192:195]
    v_exp_f32 v247, v247
    v_mfma_f32_16x16x32_bf16 a[192:195], v[124:127], v[68:71], a[192:195]
    v_cvt_pk_bf16_f32 v46, v244, v245
    v_cvt_pk_bf16_f32 v47, v246, v247
    v_mfma_f32_16x16x32_bf16 a[196:199], v[120:123], v[72:75], a[196:199]
    s_waitcnt vmcnt(8) lgkmcnt(0)
    v_exp_f32 v248, v248
    v_mfma_f32_16x16x32_bf16 a[196:199], v[124:127], v[76:79], a[196:199]
    s_barrier
    ds_read_b128 a[224:227], v2 offset:0
    ds_read_b128 a[228:231], v2 offset:1024
    v_mfma_f32_16x16x32_bf16 v[252:255], a[240:243], v[140:143], v[156:159]
    v_exp_f32 v249, v249
    v_mfma_f32_16x16x32_bf16 v[252:255], a[244:247], v[172:175], v[252:255]
    ds_read_b128 a[232:235], v2 offset:2048
    ds_read_b128 a[236:239], v2 offset:3072
    v_mfma_f32_16x16x32_bf16 v[252:255], a[248:251], v[204:207], v[252:255]
    ds_read_b128 v[96:99], v2 offset:16384
    v_cvt_pk_bf16_f32 v54, v248, v249
    v_mfma_f32_16x16x32_bf16 v[252:255], a[252:255], v[236:239], v[252:255]
    v_exp_f32 v250, v250
    v_mfma_f32_16x16x32_bf16 a[200:203], v[120:123], v[80:83], a[200:203]
    v_exp_f32 v251, v251
    v_mfma_f32_16x16x32_bf16 a[200:203], v[124:127], v[84:87], a[200:203]
    ds_read_b128 v[100:103], v2 offset:17408
    v_cvt_pk_bf16_f32 v55, v250, v251
    v_mfma_f32_16x16x32_bf16 a[204:207], v[120:123], v[88:91], a[204:207]
    v_mfma_f32_16x16x32_bf16 a[204:207], v[124:127], v[92:95], a[204:207]
    v_exp_f32 v252, v252
    v_smfmac_f32_16x16x64_bf16 a[208:211], a[136:139], v[64:71], v215
    v_smfmac_f32_16x16x64_bf16 a[212:215], a[136:139], v[72:79], v215
    s_sub_u32 s78, s78, 1
    v_smfmac_f32_16x16x64_bf16 a[216:219], a[136:139], v[80:87], v215
    s_cmp_lg_u32 s78, 0
    v_smfmac_f32_16x16x64_bf16 a[220:223], a[136:139], v[88:95], v215
    s_cbranch_scc1 K1_LB
K1_LB_END:
    v_add_f32 v212, s12, v148
    v_fma_f32 v176, v208, s8, v212
    v_fma_f32 v177, v209, s8, v212
    v_fma_f32 v178, v210, s8, v212
    v_fma_f32 v179, v211, s8, v212
    s_nop 1
    s_waitcnt lgkmcnt(0)
    v_mfma_f32_16x16x32_bf16 v[240:243], a[224:227], v[132:135], v[176:179]
    s_mov_b32 s7, 0
    ds_read_b128 v[104:107], v2 offset:18432
    ds_read_b128 v[108:111], v2 offset:19456
    v_mfma_f32_16x16x32_bf16 v[240:243], a[228:231], v[164:167], v[240:243]
    s_mov_b32 s99, s76
    buffer_load_dwordx4 v[64:67], v11, s[48:51], s7 offen nt
    v_mfma_f32_16x16x32_bf16 v[240:243], a[232:235], v[196:199], v[240:243]
    s_mov_b32 s7, 18432
    v_exp_f32 v253, v253
    v_mfma_f32_16x16x32_bf16 v[240:243], a[236:239], v[228:231], v[240:243]
    s_lshl_b32 s29, s6, 2
    v_exp_f32 v254, v254
    v_mfma_f32_16x16x32_bf16 a[0:3], v[96:99], v[32:35], a[0:3]
    s_lshr_b32 s29, 0x41302413, s29
    v_exp_f32 v255, v255
    v_mfma_f32_16x16x32_bf16 a[0:3], v[100:103], v[36:39], a[0:3]
    s_and_b32 s29, s29, 7
    buffer_load_dwordx4 v[68:71], v11, s[48:51], s7 offen nt
    v_mfma_f32_16x16x32_bf16 a[4:7], v[96:99], v[40:43], a[4:7]
    s_mov_b32 s7, 9216
    v_cvt_pk_bf16_f32 v62, v252, v253
    v_cvt_pk_bf16_f32 v63, v254, v255
    v_mfma_f32_16x16x32_bf16 a[4:7], v[100:103], v[44:47], a[4:7]
    s_lshl_b32 s29, s29, 15
    ds_read_b128 a[240:243], v2 offset:4096
    ds_read_b128 a[244:247], v2 offset:5120
    v_mfma_f32_16x16x32_bf16 v[244:247], a[224:227], v[136:139], v[152:155]
    s_add_u32 s44, s29, s75
    ds_read_b128 a[248:251], v2 offset:6144
    v_add_f32 v213, s13, v148
    v_mfma_f32_16x16x32_bf16 v[244:247], a[228:231], v[168:171], v[244:247]
    s_lshl_b32 s29, s6, 2
    buffer_load_dwordx4 v[20:23], v11, s[48:51], s7 offen nt
    v_mfma_f32_16x16x32_bf16 v[244:247], a[232:235], v[200:203], v[244:247]
    s_mov_b32 s7, 27648
    ds_read_b128 a[252:255], v2 offset:7168
    ds_read_b128 v[112:115], v2 offset:20480
    v_mfma_f32_16x16x32_bf16 v[244:247], a[236:239], v[232:235], v[244:247]
    s_lshr_b32 s29, 0x2413024, s29
    ds_read_b128 v[116:119], v2 offset:21504
    v_fma_f32 v180, v208, s9, v213
    v_mfma_f32_16x16x32_bf16 a[8:11], v[96:99], v[48:51], a[8:11]
    s_and_b32 s29, s29, 7
    v_fma_f32 v181, v209, s9, v213
    v_fma_f32 v182, v210, s9, v213
    v_mfma_f32_16x16x32_bf16 a[8:11], v[100:103], v[52:55], a[8:11]
    s_lshl_b32 s29, s29, 15
    buffer_load_dwordx4 v[24:27], v11, s[48:51], s7 offen nt
    v_mfma_f32_16x16x32_bf16 a[12:15], v[96:99], v[56:59], a[12:15]
    s_add_u32 s45, s29, s75
    v_fma_f32 v183, v211, s9, v213
    ds_read_b128 v[120:123], v2 offset:22528
    v_mfma_f32_16x16x32_bf16 a[12:15], v[100:103], v[60:63], a[12:15]
    s_lshl_b32 s29, s6, 2
    v_exp_f32 v240, v240
    s_waitcnt lgkmcnt(2)
    v_mfma_f32_16x16x32_bf16 a[16:19], v[104:107], v[32:35], a[16:19]
    s_lshr_b32 s29, 0x13024130, s29
    v_exp_f32 v241, v241
    v_mfma_f32_16x16x32_bf16 a[16:19], v[108:111], v[36:39], a[16:19]
    s_and_b32 s29, s29, 7
    buffer_load_dwordx4 v[144:147], v12, s[52:55], 0 offen nt
    v_mfma_f32_16x16x32_bf16 v[248:251], a[224:227], v[140:143], v[156:159]
    s_lshl_b32 s29, s29, 15
    v_exp_f32 v242, v242
    v_mfma_f32_16x16x32_bf16 v[248:251], a[228:231], v[172:175], v[248:251]
    s_add_u32 s46, s29, s75
    v_exp_f32 v243, v243
    v_mfma_f32_16x16x32_bf16 v[248:251], a[232:235], v[204:207], v[248:251]
    s_lshl_b32 s29, s6, 2
    v_cvt_pk_bf16_f32 v72, v240, v241
    v_cvt_pk_bf16_f32 v73, v242, v243
    v_mfma_f32_16x16x32_bf16 v[248:251], a[236:239], v[236:239], v[248:251]
    s_lshr_b32 s29, 0x24130241, s29
    buffer_load_dwordx4 a[140:143], v13, s[52:55], 0 offen nt
    v_mfma_f32_16x16x32_bf16 a[20:23], v[104:107], v[40:43], a[20:23]
    s_and_b32 s29, s29, 7
    ds_read_b128 v[124:127], v2 offset:23552
    ds_read_b128 a[224:227], v2 offset:8192
    v_mfma_f32_16x16x32_bf16 a[20:23], v[108:111], v[44:47], a[20:23]
    s_lshl_b32 s29, s29, 15
    v_exp_f32 v244, v244
    v_mfma_f32_16x16x32_bf16 a[24:27], v[104:107], v[48:51], a[24:27]
    s_mov_b32 s98, 0x3fb8aa3b
    v_exp_f32 v245, v245
    v_mfma_f32_16x16x32_bf16 a[24:27], v[108:111], v[52:55], a[24:27]
    s_add_u32 s47, s29, s75
    v_exp_f32 v246, v246
    v_mfma_f32_16x16x32_bf16 a[28:31], v[104:107], v[56:59], a[28:31]
    s_lshl_b32 s29, s6, 2
    v_exp_f32 v247, v247
    v_mfma_f32_16x16x32_bf16 a[28:31], v[108:111], v[60:63], a[28:31]
    s_lshr_b32 s29, 0x30241302, s29
    v_cvt_pk_bf16_f32 v80, v244, v245
    v_cvt_pk_bf16_f32 v81, v246, v247
    v_mfma_f32_16x16x32_bf16 v[252:255], a[240:243], v[132:135], v[180:183]
    s_lshr_b32 s61, s5, 3
    ds_read_b128 a[228:231], v2 offset:9216
    ds_read_b128 a[232:235], v2 offset:10240
    v_mfma_f32_16x16x32_bf16 v[252:255], a[244:247], v[164:167], v[252:255]
    s_add_u32 s3, s5, s6
    ds_read_b128 a[236:239], v2 offset:11264
    v_add_f32 v212, s14, v148
    v_mfma_f32_16x16x32_bf16 v[252:255], a[248:251], v[196:199], v[252:255]
    s_and_b32 s29, s29, 7
    ds_read_b128 v[96:99], v2 offset:24576
    v_fma_f32 v184, v208, s10, v212
    v_mfma_f32_16x16x32_bf16 v[252:255], a[252:255], v[228:231], v[252:255]
    s_add_u32 s74, s4, 1
    ds_read_b128 v[100:103], v2 offset:25600
    v_fma_f32 v185, v209, s10, v212
    v_mfma_f32_16x16x32_bf16 a[32:35], v[112:115], v[32:35], a[32:35]
    s_and_b32 s28, s5, 3
    v_exp_f32 v248, v248
    s_waitcnt lgkmcnt(5)
    v_mfma_f32_16x16x32_bf16 a[32:35], v[116:119], v[36:39], a[32:35]
    s_and_b32 s3, s3, 1
    v_exp_f32 v249, v249
    v_mfma_f32_16x16x32_bf16 a[36:39], v[112:115], v[40:43], a[36:39]
    s_lshl_b32 s29, s29, 15
    v_exp_f32 v250, v250
    v_mfma_f32_16x16x32_bf16 a[36:39], v[116:119], v[44:47], a[36:39]
    s_lshl2_add_u32 s66, s6, s61
    v_exp_f32 v251, v251
    v_mfma_f32_16x16x32_bf16 v[240:243], a[240:243], v[136:139], v[152:155]
    s_mul_i32 s71, s5, 768
    v_fma_f32 v186, v210, s10, v212
    v_fma_f32 v187, v211, s10, v212
    v_mfma_f32_16x16x32_bf16 v[240:243], a[244:247], v[168:171], v[240:243]
    s_lshl_b32 s74, s74, 15
    v_cvt_pk_bf16_f32 v88, v248, v249
    v_cvt_pk_bf16_f32 v89, v250, v251
    v_mfma_f32_16x16x32_bf16 v[240:243], a[248:251], v[200:203], v[240:243]
    s_mul_i32 s28, s28, 9216
    v_exp_f32 v252, v252
    v_mfma_f32_16x16x32_bf16 v[240:243], a[252:255], v[232:235], v[240:243]
    s_lshl3_add_u32 s3, s61, s3
    v_exp_f32 v253, v253
    v_mfma_f32_16x16x32_bf16 a[40:43], v[112:115], v[48:51], a[40:43]
    s_add_u32 s79, s29, s75
    v_exp_f32 v254, v254
    v_mfma_f32_16x16x32_bf16 a[40:43], v[116:119], v[52:55], a[40:43]
    s_lshl_b32 s66, s66, 10
    v_exp_f32 v255, v255
    v_mfma_f32_16x16x32_bf16 a[44:47], v[112:115], v[56:59], a[44:47]
    s_add_u32 s71, s71, 131072
    v_cvt_pk_bf16_f32 v74, v252, v253
    v_cvt_pk_bf16_f32 v75, v254, v255
    v_mfma_f32_16x16x32_bf16 a[44:47], v[116:119], v[60:63], a[44:47]
    s_add_u32 s74, s74, s101
    ds_read_b128 v[104:107], v2 offset:26624
    ds_read_b128 v[108:111], v2 offset:27648
    v_mfma_f32_16x16x32_bf16 a[48:51], v[120:123], v[32:35], a[48:51]
    v_exp_f32 v240, v240
    v_mfma_f32_16x16x32_bf16 a[48:51], v[124:127], v[36:39], a[48:51]
    v_exp_f32 v241, v241
    v_mfma_f32_16x16x32_bf16 v[244:247], a[240:243], v[140:143], v[156:159]
    v_exp_f32 v242, v242
    v_mfma_f32_16x16x32_bf16 v[244:247], a[244:247], v[172:175], v[244:247]
    v_exp_f32 v243, v243
    v_mfma_f32_16x16x32_bf16 v[244:247], a[248:251], v[204:207], v[244:247]
    v_cvt_pk_bf16_f32 v82, v240, v241
    v_cvt_pk_bf16_f32 v83, v242, v243
    v_mfma_f32_16x16x32_bf16 v[244:247], a[252:255], v[236:239], v[244:247]
    ds_read_b128 a[240:243], v2 offset:12288
    ds_read_b128 a[244:247], v2 offset:13312
    v_mfma_f32_16x16x32_bf16 a[52:55], v[120:123], v[40:43], a[52:55]
    ds_read_b128 a[248:251], v2 offset:14336
    v_add_f32 v213, s15, v148
    v_mfma_f32_16x16x32_bf16 a[52:55], v[124:127], v[44:47], a[52:55]
    ds_read_b128 a[252:255], v2 offset:15360
    v_fma_f32 v188, v208, s11, v213
    v_mfma_f32_16x16x32_bf16 a[56:59], v[120:123], v[48:51], a[56:59]
    ds_read_b128 v[112:115], v2 offset:28672
    v_fma_f32 v189, v209, s11, v213
    v_mfma_f32_16x16x32_bf16 a[56:59], v[124:127], v[52:55], a[56:59]
    ds_read_b128 v[116:119], v2 offset:29696
    v_fma_f32 v190, v210, s11, v213
    v_mfma_f32_16x16x32_bf16 a[60:63], v[120:123], v[56:59], a[60:63]
    v_exp_f32 v244, v244
    v_mfma_f32_16x16x32_bf16 a[60:63], v[124:127], v[60:63], a[60:63]
    v_exp_f32 v245, v245
    v_mfma_f32_16x16x32_bf16 v[248:251], a[224:227], v[132:135], v[184:187]
    s_waitcnt lgkmcnt(2)
    v_exp_f32 v246, v246
    v_mfma_f32_16x16x32_bf16 v[248:251], a[228:231], v[164:167], v[248:251]
    v_exp_f32 v247, v247
    v_mfma_f32_16x16x32_bf16 v[248:251], a[232:235], v[196:199], v[248:251]
    v_fma_f32 v191, v211, s11, v213
    v_cvt_pk_bf16_f32 v90, v244, v245
    v_mfma_f32_16x16x32_bf16 v[248:251], a[236:239], v[228:231], v[248:251]
    s_add_u32 m0, s76, s75
    v_cvt_pk_bf16_f32 v91, v246, v247
    ds_read_b128 v[120:123], v2 offset:30720
    v_mfma_f32_16x16x32_bf16 a[144:147], v[96:99], v[32:35], a[144:147]
    s_mov_b32 s76, s60
    buffer_load_dwordx4 v1, s[36:39], s77 offen sc1 lds
    v_mfma_f32_16x16x32_bf16 a[144:147], v[100:103], v[36:39], a[144:147]
    s_mov_b32 s60, s82
    v_exp_f32 v248, v248
    v_mfma_f32_16x16x32_bf16 a[148:151], v[96:99], v[40:43], a[148:151]
    s_mov_b32 s82, s95
    v_exp_f32 v249, v249
    v_mfma_f32_16x16x32_bf16 a[148:151], v[100:103], v[44:47], a[148:151]
    s_mov_b32 s95, s93
    v_exp_f32 v250, v250
    v_mfma_f32_16x16x32_bf16 v[252:255], a[224:227], v[136:139], v[152:155]
    s_mov_b32 s93, s99
    v_exp_f32 v251, v251
    v_mfma_f32_16x16x32_bf16 v[252:255], a[228:231], v[168:171], v[252:255]
    v_cvt_pk_bf16_f32 v76, v248, v249
    v_cvt_pk_bf16_f32 v77, v250, v251
    v_mfma_f32_16x16x32_bf16 v[252:255], a[232:235], v[200:203], v[252:255]
    ds_read_b128 v[124:127], v2 offset:31744
    v_add_u32 v2, s82, v1
    v_mfma_f32_16x16x32_bf16 v[252:255], a[236:239], v[232:235], v[252:255]
    buffer_load_dwordx4 v1, s[36:39], s77 offen offset:1024 sc1 lds
    v_mfma_f32_16x16x32_bf16 a[152:155], v[96:99], v[48:51], a[152:155]
    v_bfe_u32 v8, v1, 2, 6
    v_accvgpr_read_b32 v4, a112
    v_mfma_f32_16x16x32_bf16 a[152:155], v[100:103], v[52:55], a[152:155]
    v_accvgpr_read_b32 v5, a116
    v_add_u32 v8, 192, v8
    v_mfma_f32_16x16x32_bf16 a[156:159], v[96:99], v[56:59], a[156:159]
    v_exp_f32 v252, v252
    v_mfma_f32_16x16x32_bf16 a[156:159], v[100:103], v[60:63], a[156:159]
    v_exp_f32 v253, v253
    v_mfma_f32_16x16x32_bf16 a[160:163], v[104:107], v[32:35], a[160:163]
    v_exp_f32 v254, v254
    v_mfma_f32_16x16x32_bf16 a[160:163], v[108:111], v[36:39], a[160:163]
    v_exp_f32 v255, v255
    v_mfma_f32_16x16x32_bf16 v[240:243], a[224:227], v[140:143], v[156:159]
    buffer_load_dwordx4 v1, s[36:39], s77 offen offset:2048 sc1 lds
    v_mfma_f32_16x16x32_bf16 v[240:243], a[228:231], v[172:175], v[240:243]
    v_cvt_pk_bf16_f32 v84, v252, v253
    v_cvt_pk_bf16_f32 v85, v254, v255
    v_mfma_f32_16x16x32_bf16 v[240:243], a[232:235], v[204:207], v[240:243]
    v_cvt_pk_bf16_f32 v4, 0, v4
    v_cvt_pk_bf16_f32 v5, 0, v5
    v_mfma_f32_16x16x32_bf16 v[240:243], a[236:239], v[236:239], v[240:243]
    v_lshrrev_b32 v15, 8, v1
    ds_bpermute_b32 v4, v8, v4
    v_mfma_f32_16x16x32_bf16 a[164:167], v[104:107], v[40:43], a[164:167]
    ds_bpermute_b32 v5, v8, v5
    ds_read_b128 a[224:227], v2 offset:0
    v_mfma_f32_16x16x32_bf16 a[164:167], v[108:111], v[44:47], a[164:167]
    ds_read_b128 a[228:231], v2 offset:1024
    v_bfe_u32 v14, v1, 4, 4
    v_mfma_f32_16x16x32_bf16 a[168:171], v[104:107], v[48:51], a[168:171]
    ds_read_b128 a[232:235], v2 offset:2048
    v_lshlrev_b32 v15, 3, v15
    v_mfma_f32_16x16x32_bf16 a[168:171], v[108:111], v[52:55], a[168:171]
    buffer_load_dwordx4 v1, s[36:39], s77 offen offset:3072 sc1 lds
    v_mfma_f32_16x16x32_bf16 a[172:175], v[104:107], v[56:59], a[172:175]
    ds_read_b128 a[236:239], v2 offset:3072
    ds_read_b128 v[96:99], v2 offset:16384
    v_mfma_f32_16x16x32_bf16 a[172:175], v[108:111], v[60:63], a[172:175]
    ds_read_b128 v[100:103], v2 offset:17408
    v_sub_u32 v14, v14, v15
    v_mfma_f32_16x16x32_bf16 v[244:247], a[240:243], v[132:135], v[188:191]
    v_exp_f32 v240, v240
    v_mfma_f32_16x16x32_bf16 v[244:247], a[244:247], v[164:167], v[244:247]
    v_exp_f32 v241, v241
    v_mfma_f32_16x16x32_bf16 v[244:247], a[248:251], v[196:199], v[244:247]
    v_exp_f32 v242, v242
    v_mfma_f32_16x16x32_bf16 v[244:247], a[252:255], v[228:231], v[244:247]
    s_add_u32 s100, s77, 4096
    v_exp_f32 v243, v243
    s_waitcnt lgkmcnt(1)
    v_mfma_f32_16x16x32_bf16 a[176:179], v[112:115], v[32:35], a[176:179]
    s_add_u32 m0, m0, 4096
    v_cvt_pk_bf16_f32 v92, v240, v241
    v_cvt_pk_bf16_f32 v93, v242, v243
    v_mfma_f32_16x16x32_bf16 a[176:179], v[116:119], v[36:39], a[176:179]
    buffer_load_dwordx4 v1, s[36:39], s100 offen sc1 lds
    v_mfma_f32_16x16x32_bf16 a[180:183], v[112:115], v[40:43], a[180:183]
    v_exp_f32 v244, v244
    v_mfma_f32_16x16x32_bf16 a[180:183], v[116:119], v[44:47], a[180:183]
    v_exp_f32 v245, v245
    v_mfma_f32_16x16x32_bf16 v[248:251], a[240:243], v[136:139], v[152:155]
    v_exp_f32 v246, v246
    v_mfma_f32_16x16x32_bf16 v[248:251], a[244:247], v[168:171], v[248:251]
    v_exp_f32 v247, v247
    v_mfma_f32_16x16x32_bf16 v[248:251], a[248:251], v[200:203], v[248:251]
    v_cvt_pk_bf16_f32 v78, v244, v245
    v_cvt_pk_bf16_f32 v79, v246, v247
    v_mfma_f32_16x16x32_bf16 v[248:251], a[252:255], v[232:235], v[248:251]
    buffer_load_dwordx4 v1, s[36:39], s100 offen offset:1024 sc1 lds
    v_mfma_f32_16x16x32_bf16 a[184:187], v[112:115], v[48:51], a[184:187]
    v_and_b32 v15, 16, v1
    v_mov_b32 v31, 0x3f80
    v_mfma_f32_16x16x32_bf16 a[184:187], v[116:119], v[52:55], a[184:187]
    v_ashrrev_i32 v14, 1, v14
    v_lshlrev_b32 v15, v15, v31
    v_mfma_f32_16x16x32_bf16 a[188:191], v[112:115], v[56:59], a[188:191]
    v_exp_f32 v248, v248
    v_mfma_f32_16x16x32_bf16 a[188:191], v[116:119], v[60:63], a[188:191]
    v_exp_f32 v249, v249
    v_mfma_f32_16x16x32_bf16 a[192:195], v[120:123], v[32:35], a[192:195]
    v_exp_f32 v250, v250
    v_mfma_f32_16x16x32_bf16 a[192:195], v[124:127], v[36:39], a[192:195]
    v_exp_f32 v251, v251
    v_mfma_f32_16x16x32_bf16 v[252:255], a[240:243], v[140:143], v[156:159]
    buffer_load_dwordx4 v1, s[36:39], s100 offen offset:2048 sc1 lds
    v_mfma_f32_16x16x32_bf16 v[252:255], a[244:247], v[172:175], v[252:255]
    v_cvt_pk_bf16_f32 v86, v248, v249
    v_cvt_pk_bf16_f32 v87, v250, v251
    v_mfma_f32_16x16x32_bf16 v[252:255], a[248:251], v[204:207], v[252:255]
    v_cmp_eq_i32 vcc, 0, v14
    v_mul_f32 v4, s98, v4
    v_mfma_f32_16x16x32_bf16 v[252:255], a[252:255], v[236:239], v[252:255]
    v_cndmask_b32 v216, 0, v15, vcc
    v_cmp_eq_i32 vcc, 1, v14
    v_mfma_f32_16x16x32_bf16 a[196:199], v[120:123], v[40:43], a[196:199]
    v_mul_f32 v5, s98, v5
    v_cndmask_b32 v217, 0, v15, vcc
    v_mfma_f32_16x16x32_bf16 a[196:199], v[124:127], v[44:47], a[196:199]
    v_cmp_eq_i32 vcc, 2, v14
    v_and_b32 v31, 512, v1
    v_mfma_f32_16x16x32_bf16 a[200:203], v[120:123], v[48:51], a[200:203]
    v_exp_f32 v252, v252
    v_mfma_f32_16x16x32_bf16 a[200:203], v[124:127], v[52:55], a[200:203]
    buffer_load_dwordx4 v1, s[36:39], s100 offen offset:3072 sc1 lds
    v_mfma_f32_16x16x32_bf16 a[204:207], v[120:123], v[56:59], a[204:207]
    v_cndmask_b32 v218, 0, v15, vcc
    v_cmp_eq_i32 vcc, 3, v14
    v_mfma_f32_16x16x32_bf16 a[204:207], v[124:127], v[60:63], a[204:207]
    v_exp_f32 v4, v4
    v_smfmac_f32_16x16x64_bf16 a[208:211], a[136:139], v[32:39], v215
    v_cndmask_b32 v219, 0, v15, vcc
    v_cmp_eq_i32 vcc, -8, v14
    v_smfmac_f32_16x16x64_bf16 a[212:215], a[136:139], v[40:47], v215
    v_exp_f32 v5, v5
    v_smfmac_f32_16x16x64_bf16 a[216:219], a[136:139], v[48:55], v215
    v_cndmask_b32 v220, 0, v15, vcc
    v_cmp_eq_i32 vcc, -7, v14
    v_smfmac_f32_16x16x64_bf16 a[220:223], a[136:139], v[56:63], v215
    s_add_u32 s77, s77, 32768
    v_cndmask_b32 v221, 0, v15, vcc
    v_cmp_eq_i32 vcc, -6, v14
    v_add_f32 v4, 1.0, v4
    v_add_f32 v5, 1.0, v5
    v_cndmask_b32 v222, 0, v15, vcc
    v_cmp_eq_i32 vcc, -5, v14
    v_rcp_f32 v4, v4
    v_rcp_f32 v5, v5
    v_cndmask_b32 v223, 0, v15, vcc
    v_mad_u32_u24 v31, v31, 17, v1
    s_cmp_eq_u32 s6, 7
    s_cselect_b32 s16, s8, 0
    s_cselect_b32 s17, s9, 0
    s_cselect_b32 s18, s10, 0
    s_cselect_b32 s19, s11, 0
    s_cselect_b32 s20, s12, 0
    s_cselect_b32 s21, s13, 0
    s_cselect_b32 s22, s14, 0
    s_cselect_b32 s23, s15, 0
    s_cbranch_scc1 K1_J7
K1_J7_BACK:
    v_add_f32 v212, s20, v152
    v_fma_f32 v176, v208, s16, v212
    v_fma_f32 v177, v209, s16, v212
    v_fma_f32 v178, v210, s16, v212
    v_fma_f32 v179, v211, s16, v212
    s_nop 1
    s_waitcnt lgkmcnt(0)
    v_mfma_f32_16x16x32_bf16 v[240:243], a[224:227], v[136:139], v[176:179]
    s_mov_b32 s99, s76
    ds_read_b128 v[104:107], v2 offset:18432
    ds_read_b128 v[108:111], v2 offset:19456
    v_mfma_f32_16x16x32_bf16 v[240:243], a[228:231], v[168:171], v[240:243]
    v_exp_f32 v253, v253
    v_mfma_f32_16x16x32_bf16 v[240:243], a[232:235], v[200:203], v[240:243]
    v_exp_f32 v254, v254
    v_mfma_f32_16x16x32_bf16 v[240:243], a[236:239], v[232:235], v[240:243]
    v_exp_f32 v255, v255
    v_mfma_f32_16x16x32_bf16 a[4:7], v[96:99], v[72:75], a[4:7]
    s_add_u32 m0, s76, s75
    v_cvt_pk_bf16_f32 v94, v252, v253
    v_cvt_pk_bf16_f32 v95, v254, v255
    v_mfma_f32_16x16x32_bf16 a[4:7], v[100:103], v[76:79], a[4:7]
    s_mov_b32 s76, s60
    buffer_load_dwordx4 v1, s[36:39], s77 offen sc1 lds
    v_mfma_f32_16x16x32_bf16 a[8:11], v[96:99], v[80:83], a[8:11]
    s_mov_b32 s60, s82
    ds_read_b128 a[240:243], v2 offset:4096
    ds_read_b128 a[244:247], v2 offset:5120
    v_mfma_f32_16x16x32_bf16 a[8:11], v[100:103], v[84:87], a[8:11]
    s_mov_b32 s82, s95
    ds_read_b128 a[248:251], v2 offset:6144
    v_add_f32 v213, s21, v152
    v_mfma_f32_16x16x32_bf16 a[12:15], v[96:99], v[88:91], a[12:15]
    s_mov_b32 s95, s93
    ds_read_b128 a[252:255], v2 offset:7168
    v_fma_f32 v180, v208, s17, v213
    v_mfma_f32_16x16x32_bf16 a[12:15], v[100:103], v[92:95], a[12:15]
    s_mov_b32 s93, s99
    ds_read_b128 v[112:115], v2 offset:20480
    v_fma_f32 v181, v209, s17, v213
    v_mfma_f32_16x16x32_bf16 v[244:247], a[224:227], v[140:143], v[156:159]
    ds_read_b128 v[116:119], v2 offset:21504
    v_fma_f32 v182, v210, s17, v213
    v_mfma_f32_16x16x32_bf16 v[244:247], a[228:231], v[172:175], v[244:247]
    v_fma_f32 v183, v211, s17, v213
    ds_read_b128 v[120:123], v2 offset:22528
    v_mfma_f32_16x16x32_bf16 v[244:247], a[232:235], v[204:207], v[244:247]
    ds_read_b128 v[124:127], v2 offset:23552
    v_add_f32 v212, s22, v152
    v_mfma_f32_16x16x32_bf16 v[244:247], a[236:239], v[236:239], v[244:247]
    s_waitcnt lgkmcnt(4)
    buffer_load_dwordx4 v1, s[36:39], s77 offen offset:1024 sc1 lds
    v_mfma_f32_16x16x32_bf16 a[20:23], v[104:107], v[72:75], a[20:23]
    ds_read_b128 a[224:227], v2 offset:8192
    ds_read_b128 a[228:231], v2 offset:9216
    v_mfma_f32_16x16x32_bf16 a[20:23], v[108:111], v[76:79], a[20:23]
    ds_read_b128 a[232:235], v2 offset:10240
    v_fma_f32 v184, v208, s18, v212
    v_mfma_f32_16x16x32_bf16 a[24:27], v[104:107], v[80:83], a[24:27]
    ds_read_b128 a[236:239], v2 offset:11264
    v_fma_f32 v185, v209, s18, v212
    v_mfma_f32_16x16x32_bf16 a[24:27], v[108:111], v[84:87], a[24:27]
    ds_read_b128 v[96:99], v2 offset:24576
    v_fma_f32 v186, v210, s18, v212
    v_mfma_f32_16x16x32_bf16 a[28:31], v[104:107], v[88:91], a[28:31]
    ds_read_b128 v[100:103], v2 offset:25600
    v_fma_f32 v187, v211, s18, v212
    v_mfma_f32_16x16x32_bf16 a[28:31], v[108:111], v[92:95], a[28:31]
    v_exp_f32 v240, v240
    v_mfma_f32_16x16x32_bf16 v[248:251], a[240:243], v[136:139], v[180:183]
    v_exp_f32 v241, v241
    v_mfma_f32_16x16x32_bf16 v[248:251], a[244:247], v[168:171], v[248:251]
    v_exp_f32 v242, v242
    v_mfma_f32_16x16x32_bf16 v[248:251], a[248:251], v[200:203], v[248:251]
    buffer_load_dwordx4 v1, s[36:39], s77 offen offset:2048 sc1 lds
    v_mfma_f32_16x16x32_bf16 v[248:251], a[252:255], v[232:235], v[248:251]
    s_waitcnt lgkmcnt(0)
    v_exp_f32 v243, v243
    v_mfma_f32_16x16x32_bf16 a[36:39], v[112:115], v[72:75], a[36:39]
    v_cvt_pk_bf16_f32 v48, v240, v241
    v_cvt_pk_bf16_f32 v49, v242, v243
    v_mfma_f32_16x16x32_bf16 a[36:39], v[116:119], v[76:79], a[36:39]
    ds_read_b128 v[104:107], v2 offset:26624
    ds_read_b128 v[108:111], v2 offset:27648
    v_mfma_f32_16x16x32_bf16 a[40:43], v[112:115], v[80:83], a[40:43]
    v_exp_f32 v244, v244
    v_mfma_f32_16x16x32_bf16 a[40:43], v[116:119], v[84:87], a[40:43]
    v_exp_f32 v245, v245
    v_mfma_f32_16x16x32_bf16 a[44:47], v[112:115], v[88:91], a[44:47]
    v_exp_f32 v246, v246
    v_mfma_f32_16x16x32_bf16 a[44:47], v[116:119], v[92:95], a[44:47]
    s_waitcnt vmcnt(11)
    v_exp_f32 v247, v247
    v_mfma_f32_16x16x32_bf16 v[12:15], v[64:67], v[216:219], 0
    buffer_load_dwordx4 v1, s[36:39], s77 offen offset:3072 sc1 lds
    v_mfma_f32_16x16x32_bf16 v[16:19], v[68:71], v[216:219], 0
    v_cvt_pk_bf16_f32 v56, v244, v245
    v_cvt_pk_bf16_f32 v57, v246, v247
    v_mfma_f32_16x16x32_bf16 v[252:255], a[240:243], v[140:143], v[156:159]
    ds_read_b128 a[240:243], v2 offset:12288
    ds_read_b128 v[112:115], v2 offset:28672
    v_mfma_f32_16x16x32_bf16 v[252:255], a[244:247], v[172:175], v[252:255]
    v_cvt_pk_bf16_f32 v12, v12, v13
    v_cvt_pk_bf16_f32 v13, v14, v15
    v_mfma_f32_16x16x32_bf16 v[252:255], a[248:251], v[204:207], v[252:255]
    v_cvt_pk_bf16_f32 v14, v16, v17
    v_cvt_pk_bf16_f32 v15, v18, v19
    v_mfma_f32_16x16x32_bf16 v[252:255], a[252:255], v[236:239], v[252:255]
    buffer_store_dwordx4 v[12:15], v31, s[56:59], s63 offen offset:0 sc1
    v_mfma_f32_16x16x32_bf16 a[52:55], v[120:123], v[72:75], a[52:55]
    ds_read_b128 a[244:247], v2 offset:13312
    ds_read_b128 a[248:251], v2 offset:14336
    v_mfma_f32_16x16x32_bf16 a[52:55], v[124:127], v[76:79], a[52:55]
    ds_read_b128 a[252:255], v2 offset:15360
    v_add_f32 v213, s23, v152
    v_mfma_f32_16x16x32_bf16 a[56:59], v[120:123], v[80:83], a[56:59]
    s_add_u32 s100, s77, 4096
    ds_read_b128 v[116:119], v2 offset:29696
    v_fma_f32 v188, v208, s19, v213
    v_mfma_f32_16x16x32_bf16 a[56:59], v[124:127], v[84:87], a[56:59]
    s_add_u32 m0, m0, 4096
    v_exp_f32 v248, v248
    v_mfma_f32_16x16x32_bf16 a[60:63], v[120:123], v[88:91], a[60:63]
    buffer_load_dwordx4 v1, s[36:39], s100 offen sc1 lds
    v_mfma_f32_16x16x32_bf16 a[60:63], v[124:127], v[92:95], a[60:63]
    v_exp_f32 v249, v249
    v_mfma_f32_16x16x32_bf16 v[12:15], v[64:67], v[220:223], 0
    v_exp_f32 v250, v250
    v_mfma_f32_16x16x32_bf16 v[16:19], v[68:71], v[220:223], 0
    v_exp_f32 v251, v251
    v_mfma_f32_16x16x32_bf16 v[240:243], a[224:227], v[136:139], v[184:187]
    v_fma_f32 v189, v209, s19, v213
    v_fma_f32 v190, v210, s19, v213
    v_mfma_f32_16x16x32_bf16 v[240:243], a[228:231], v[168:171], v[240:243]
    v_fma_f32 v191, v211, s19, v213
    v_cvt_pk_bf16_f32 v12, v12, v13
    v_mfma_f32_16x16x32_bf16 v[240:243], a[232:235], v[200:203], v[240:243]
    v_cvt_pk_bf16_f32 v13, v14, v15
    v_cvt_pk_bf16_f32 v14, v16, v17
    v_mfma_f32_16x16x32_bf16 v[240:243], a[236:239], v[232:235], v[240:243]
    v_cvt_pk_bf16_f32 v15, v18, v19
    v_cvt_pk_bf16_f32 v50, v248, v249
    v_mfma_f32_16x16x32_bf16 a[148:151], v[96:99], v[72:75], a[148:151]
    buffer_load_dwordx4 v1, s[36:39], s100 offen offset:1024 sc1 lds
    v_mfma_f32_16x16x32_bf16 a[148:151], v[100:103], v[76:79], a[148:151]
    buffer_store_dwordx4 v[12:15], v31, s[56:59], s63 offen offset:1024 sc1
    v_mfma_f32_16x16x32_bf16 a[152:155], v[96:99], v[80:83], a[152:155]
    v_cvt_pk_bf16_f32 v51, v250, v251
    ds_read_b128 v[120:123], v2 offset:30720
    v_mfma_f32_16x16x32_bf16 a[152:155], v[100:103], v[84:87], a[152:155]
    ds_read_b128 v[124:127], v2 offset:31744
    v_add_u32 v2, s82, v1
    v_mfma_f32_16x16x32_bf16 a[156:159], v[96:99], v[88:91], a[156:159]
    v_exp_f32 v252, v252
    v_mfma_f32_16x16x32_bf16 a[156:159], v[100:103], v[92:95], a[156:159]
    v_exp_f32 v253, v253
    v_mfma_f32_16x16x32_bf16 v[12:15], v[20:23], v[216:219], 0
    v_exp_f32 v254, v254
    v_mfma_f32_16x16x32_bf16 v[16:19], v[24:27], v[216:219], 0
    v_exp_f32 v255, v255
    v_mfma_f32_16x16x32_bf16 v[244:247], a[224:227], v[140:143], v[156:159]
    buffer_load_dwordx4 v1, s[36:39], s100 offen offset:2048 sc1 lds
    v_mfma_f32_16x16x32_bf16 v[244:247], a[228:231], v[172:175], v[244:247]
    v_cvt_pk_bf16_f32 v58, v252, v253
    v_cvt_pk_bf16_f32 v59, v254, v255
    v_mfma_f32_16x16x32_bf16 v[244:247], a[232:235], v[204:207], v[244:247]
    v_cvt_pk_bf16_f32 v12, v12, v13
    v_cvt_pk_bf16_f32 v13, v14, v15
    v_mfma_f32_16x16x32_bf16 v[244:247], a[236:239], v[236:239], v[244:247]
    s_waitcnt lgkmcnt(0)
    v_cvt_pk_bf16_f32 v14, v16, v17
    v_cvt_pk_bf16_f32 v15, v18, v19
    v_mfma_f32_16x16x32_bf16 a[164:167], v[104:107], v[72:75], a[164:167]
    buffer_store_dwordx4 v[12:15], v31, s[56:59], s63 offen offset:512 sc1
    v_mfma_f32_16x16x32_bf16 a[164:167], v[108:111], v[76:79], a[164:167]
    v_exp_f32 v240, v240
    v_mfma_f32_16x16x32_bf16 a[168:171], v[104:107], v[80:83], a[168:171]
    v_exp_f32 v241, v241
    v_mfma_f32_16x16x32_bf16 a[168:171], v[108:111], v[84:87], a[168:171]
    v_exp_f32 v242, v242
    v_mfma_f32_16x16x32_bf16 a[172:175], v[104:107], v[88:91], a[172:175]
    v_exp_f32 v243, v243
    v_mfma_f32_16x16x32_bf16 a[172:175], v[108:111], v[92:95], a[172:175]
    buffer_load_dwordx4 v1, s[36:39], s100 offen offset:3072 sc1 lds
    v_mfma_f32_16x16x32_bf16 v[12:15], v[20:23], v[220:223], 0
    v_exp_f32 v244, v244
    v_mfma_f32_16x16x32_bf16 v[16:19], v[24:27], v[220:223], 0
    v_exp_f32 v245, v245
    v_mfma_f32_16x16x32_bf16 v[248:251], a[240:243], v[136:139], v[188:191]
    v_exp_f32 v246, v246
    v_mfma_f32_16x16x32_bf16 v[248:251], a[244:247], v[168:171], v[248:251]
    v_exp_f32 v247, v247
    v_mfma_f32_16x16x32_bf16 v[248:251], a[248:251], v[200:203], v[248:251]
    v_cvt_pk_bf16_f32 v12, v12, v13
    v_cvt_pk_bf16_f32 v13, v14, v15
    v_mfma_f32_16x16x32_bf16 v[248:251], a[252:255], v[232:235], v[248:251]
    v_cvt_pk_bf16_f32 v14, v16, v17
    v_cvt_pk_bf16_f32 v15, v18, v19
    v_mfma_f32_16x16x32_bf16 a[180:183], v[112:115], v[72:75], a[180:183]
    buffer_store_dwordx4 v[12:15], v31, s[56:59], s63 offen offset:1536 sc1
    v_mfma_f32_16x16x32_bf16 a[180:183], v[116:119], v[76:79], a[180:183]
    s_add_u32 s77, s77, 32768
    v_cvt_pk_bf16_f32 v52, v240, v241
    v_cvt_pk_bf16_f32 v53, v242, v243
    v_mfma_f32_16x16x32_bf16 a[184:187], v[112:115], v[80:83], a[184:187]
    v_exp_f32 v248, v248
    v_mfma_f32_16x16x32_bf16 a[184:187], v[116:119], v[84:87], a[184:187]
    v_exp_f32 v249, v249
    v_mfma_f32_16x16x32_bf16 a[188:191], v[112:115], v[88:91], a[188:191]
    v_exp_f32 v250, v250
    v_mfma_f32_16x16x32_bf16 a[188:191], v[116:119], v[92:95], a[188:191]
    v_exp_f32 v251, v251
    v_mfma_f32_16x16x32_bf16 v[12:15], v[144:147], v[216:219], 0
    v_cvt_pk_bf16_f32 v60, v244, v245
    v_cvt_pk_bf16_f32 v61, v246, v247
    v_mfma_f32_16x16x32_bf16 v[16:19], a[140:143], v[216:219], 0
    v_cvt_pk_bf16_f32 v54, v248, v249
    v_cvt_pk_bf16_f32 v55, v250, v251
    v_mfma_f32_16x16x32_bf16 v[252:255], a[240:243], v[140:143], v[156:159]
    v_accvgpr_read_b32 v6, a120
    v_accvgpr_read_b32 v7, a124
    v_mfma_f32_16x16x32_bf16 v[252:255], a[244:247], v[172:175], v[252:255]
    v_cvt_pk_bf16_f32 v12, v12, v13
    v_cvt_pk_bf16_f32 v13, v14, v15
    v_mfma_f32_16x16x32_bf16 v[252:255], a[248:251], v[204:207], v[252:255]
    v_cvt_pk_bf16_f32 v14, v16, v17
    v_cvt_pk_bf16_f32 v15, v18, v19
    v_mfma_f32_16x16x32_bf16 v[252:255], a[252:255], v[236:239], v[252:255]
    buffer_store_dwordx4 v[12:15], v1, s[56:59], s64 offen offset:0 sc1
    v_mfma_f32_16x16x32_bf16 a[196:199], v[120:123], v[72:75], a[196:199]
    v_cvt_pk_bf16_f32 v6, 0, v6
    v_cvt_pk_bf16_f32 v7, 0, v7
    v_mfma_f32_16x16x32_bf16 a[196:199], v[124:127], v[76:79], a[196:199]
    ds_bpermute_b32 v6, v8, v6
    ds_bpermute_b32 v7, v8, v7
    s_waitcnt vmcnt(8) lgkmcnt(0)
    s_barrier
    v_mfma_f32_16x16x32_bf16 a[200:203], v[120:123], v[80:83], a[200:203]
    ds_read_b128 a[224:227], v2 offset:0
    ds_read_b128 a[228:231], v2 offset:1024
    v_mfma_f32_16x16x32_bf16 a[200:203], v[124:127], v[84:87], a[200:203]
    ds_read_b128 a[232:235], v2 offset:2048
    v_mul_f32 v6, s98, v6
    v_mfma_f32_16x16x32_bf16 a[204:207], v[120:123], v[88:91], a[204:207]
    ds_read_b128 a[236:239], v2 offset:3072
    v_mul_f32 v7, s98, v7
    v_mfma_f32_16x16x32_bf16 a[204:207], v[124:127], v[92:95], a[204:207]
    ds_read_b128 v[96:99], v2 offset:16384
    v_mfma_f32_16x16x32_bf16 v[12:15], v[144:147], v[220:223], 0
    ds_read_b128 v[100:103], v2 offset:17408
    v_mfma_f32_16x16x32_bf16 v[16:19], a[140:143], v[220:223], 0
    v_exp_f32 v252, v252
    v_smfmac_f32_16x16x64_bf16 a[212:215], a[136:139], v[72:79], v215
    v_exp_f32 v6, v6
    v_smfmac_f32_16x16x64_bf16 a[216:219], a[136:139], v[80:87], v215
    v_exp_f32 v7, v7
    v_smfmac_f32_16x16x64_bf16 a[220:223], a[136:139], v[88:95], v215
    v_cvt_pk_bf16_f32 v12, v12, v13
    v_cvt_pk_bf16_f32 v13, v14, v15
    v_add_f32 v6, 1.0, v6
    v_add_f32 v7, 1.0, v7
    v_cvt_pk_bf16_f32 v14, v16, v17
    v_cvt_pk_bf16_f32 v15, v18, v19
    v_rcp_f32 v6, v6
    v_rcp_f32 v7, v7
    buffer_store_dwordx4 v[12:15], v1, s[56:59], s62 offen offset:0 sc1
    s_nop 1
    v_accvgpr_read_b32 v9, a208
    v_accvgpr_read_b32 v10, a209
    v_add_f32 v9, v9, v10
    v_cmp_nge_f32 vcc, 0x71800000, v9
    v_rcp_f32 v10, v9
    s_nop 0
    s_or_b64 s[84:85], s[84:85], vcc
    v_mul_f32 v10, v10, v4
    v_accvgpr_read_b32 v12, a0
    v_accvgpr_read_b32 v13, a1
    v_accvgpr_read_b32 v14, a2
    v_accvgpr_read_b32 v15, a3
    v_accvgpr_read_b32 v16, a16
    v_accvgpr_read_b32 v17, a17
    v_accvgpr_read_b32 v18, a18
    v_accvgpr_read_b32 v19, a19
    v_pk_mul_f32 v[12:13], v[12:13], v[10:11] op_sel_hi:[1,0]
    v_pk_mul_f32 v[14:15], v[14:15], v[10:11] op_sel_hi:[1,0]
    v_pk_mul_f32 v[16:17], v[16:17], v[10:11] op_sel_hi:[1,0]
    v_pk_mul_f32 v[18:19], v[18:19], v[10:11] op_sel_hi:[1,0]
    v_cvt_pk_bf16_f32 v12, v12, v13
    v_cvt_pk_bf16_f32 v13, v14, v15
    v_cvt_pk_bf16_f32 v14, v16, v17
    v_cvt_pk_bf16_f32 v15, v18, v19
    buffer_store_dwordx4 v[12:15], v1, s[40:43], s80 offen offset:0 sc1
    v_accvgpr_read_b32 v20, a32
    v_accvgpr_read_b32 v21, a33
    v_accvgpr_read_b32 v22, a34
    v_accvgpr_read_b32 v23, a35
    v_accvgpr_read_b32 v24, a48
    v_accvgpr_read_b32 v25, a49
    v_accvgpr_read_b32 v26, a50
    v_accvgpr_read_b32 v27, a51
    v_pk_mul_f32 v[20:21], v[20:21], v[10:11] op_sel_hi:[1,0]
    v_pk_mul_f32 v[22:23], v[22:23], v[10:11] op_sel_hi:[1,0]
    v_pk_mul_f32 v[24:25], v[24:25], v[10:11] op_sel_hi:[1,0]
    v_pk_mul_f32 v[26:27], v[26:27], v[10:11] op_sel_hi:[1,0]
    v_cvt_pk_bf16_f32 v20, v20, v21
    v_cvt_pk_bf16_f32 v21, v22, v23
    v_cvt_pk_bf16_f32 v22, v24, v25
    v_cvt_pk_bf16_f32 v23, v26, v27
    buffer_store_dwordx4 v[20:23], v1, s[40:43], s80 offen offset:1024 sc1
    v_accvgpr_read_b32 v12, a144
    v_accvgpr_read_b32 v13, a145
    v_accvgpr_read_b32 v14, a146
    v_accvgpr_read_b32 v15, a147
    v_accvgpr_read_b32 v16, a160
    v_accvgpr_read_b32 v17, a161
    v_accvgpr_read_b32 v18, a162
    v_accvgpr_read_b32 v19, a163
    v_pk_mul_f32 v[12:13], v[12:13], v[10:11] op_sel_hi:[1,0]
    v_pk_mul_f32 v[14:15], v[14:15], v[10:11] op_sel_hi:[1,0]
    v_pk_mul_f32 v[16:17], v[16:17], v[10:11] op_sel_hi:[1,0]
    v_pk_mul_f32 v[18:19], v[18:19], v[10:11] op_sel_hi:[1,0]
    v_cvt_pk_bf16_f32 v12, v12, v13
    v_cvt_pk_bf16_f32 v13, v14, v15
    v_cvt_pk_bf16_f32 v14, v16, v17
    v_cvt_pk_bf16_f32 v15, v18, v19
    buffer_store_dwordx4 v[12:15], v1, s[40:43], s80 offen offset:2048 sc1
    v_accvgpr_read_b32 v20, a176
    v_accvgpr_read_b32 v21, a177
    v_accvgpr_read_b32 v22, a178
    v_accvgpr_read_b32 v23, a179
    v_accvgpr_read_b32 v24, a192
    v_accvgpr_read_b32 v25, a193
    v_accvgpr_read_b32 v26, a194
    v_accvgpr_read_b32 v27, a195
    v_pk_mul_f32 v[20:21], v[20:21], v[10:11] op_sel_hi:[1,0]
    v_pk_mul_f32 v[22:23], v[22:23], v[10:11] op_sel_hi:[1,0]
    v_pk_mul_f32 v[24:25], v[24:25], v[10:11] op_sel_hi:[1,0]
    v_pk_mul_f32 v[26:27], v[26:27], v[10:11] op_sel_hi:[1,0]
    v_cvt_pk_bf16_f32 v20, v20, v21
    v_cvt_pk_bf16_f32 v21, v22, v23
    v_cvt_pk_bf16_f32 v22, v24, v25
    v_cvt_pk_bf16_f32 v23, v26, v27
    buffer_store_dwordx4 v[20:23], v1, s[40:43], s80 offen offset:3072 sc1
    v_accvgpr_read_b32 v9, a212
    v_accvgpr_read_b32 v10, a213
    v_add_f32 v9, v9, v10
    v_cmp_nge_f32 vcc, 0x71800000, v9
    v_rcp_f32 v10, v9
    s_nop 0
    s_or_b64 s[84:85], s[84:85], vcc
    v_mul_f32 v10, v10, v5
    s_add_u32 s72, s80, 622592
    v_accvgpr_read_b32 v12, a4
    v_accvgpr_read_b32 v13, a5
    v_accvgpr_read_b32 v14, a6
    v_accvgpr_read_b32 v15, a7
    v_accvgpr_read_b32 v16, a20
    v_accvgpr_read_b32 v17, a21
    v_accvgpr_read_b32 v18, a22
    v_accvgpr_read_b32 v19, a23
    v_pk_mul_f32 v[12:13], v[12:13], v[10:11] op_sel_hi:[1,0]
    v_pk_mul_f32 v[14:15], v[14:15], v[10:11] op_sel_hi:[1,0]
    v_pk_mul_f32 v[16:17], v[16:17], v[10:11] op_sel_hi:[1,0]
    v_pk_mul_f32 v[18:19], v[18:19], v[10:11] op_sel_hi:[1,0]
    v_cvt_pk_bf16_f32 v12, v12, v13
    v_cvt_pk_bf16_f32 v13, v14, v15
    v_cvt_pk_bf16_f32 v14, v16, v17
    v_cvt_pk_bf16_f32 v15, v18, v19
    buffer_store_dwordx4 v[12:15], v1, s[40:43], s72 offen offset:0 sc1
    v_accvgpr_read_b32 v20, a36
    v_accvgpr_read_b32 v21, a37
    v_accvgpr_read_b32 v22, a38
    v_accvgpr_read_b32 v23, a39
    v_accvgpr_read_b32 v24, a52
    v_accvgpr_read_b32 v25, a53
    v_accvgpr_read_b32 v26, a54
    v_accvgpr_read_b32 v27, a55
    v_pk_mul_f32 v[20:21], v[20:21], v[10:11] op_sel_hi:[1,0]
    v_pk_mul_f32 v[22:23], v[22:23], v[10:11] op_sel_hi:[1,0]
    v_pk_mul_f32 v[24:25], v[24:25], v[10:11] op_sel_hi:[1,0]
    v_pk_mul_f32 v[26:27], v[26:27], v[10:11] op_sel_hi:[1,0]
    v_cvt_pk_bf16_f32 v20, v20, v21
    v_cvt_pk_bf16_f32 v21, v22, v23
    v_cvt_pk_bf16_f32 v22, v24, v25
    v_cvt_pk_bf16_f32 v23, v26, v27
    buffer_store_dwordx4 v[20:23], v1, s[40:43], s72 offen offset:1024 sc1
    v_accvgpr_read_b32 v12, a148
    v_accvgpr_read_b32 v13, a149
    v_accvgpr_read_b32 v14, a150
    v_accvgpr_read_b32 v15, a151
    v_accvgpr_read_b32 v16, a164
    v_accvgpr_read_b32 v17, a165
    v_accvgpr_read_b32 v18, a166
    v_accvgpr_read_b32 v19, a167
    v_pk_mul_f32 v[12:13], v[12:13], v[10:11] op_sel_hi:[1,0]
    v_pk_mul_f32 v[14:15], v[14:15], v[10:11] op_sel_hi:[1,0]
    v_pk_mul_f32 v[16:17], v[16:17], v[10:11] op_sel_hi:[1,0]
    v_pk_mul_f32 v[18:19], v[18:19], v[10:11] op_sel_hi:[1,0]
    v_cvt_pk_bf16_f32 v12, v12, v13
    v_cvt_pk_bf16_f32 v13, v14, v15
    v_cvt_pk_bf16_f32 v14, v16, v17
    v_cvt_pk_bf16_f32 v15, v18, v19
    buffer_store_dwordx4 v[12:15], v1, s[40:43], s72 offen offset:2048 sc1
    v_accvgpr_read_b32 v20, a180
    v_accvgpr_read_b32 v21, a181
    v_accvgpr_read_b32 v22, a182
    v_accvgpr_read_b32 v23, a183
    v_accvgpr_read_b32 v24, a196
    v_accvgpr_read_b32 v25, a197
    v_accvgpr_read_b32 v26, a198
    v_accvgpr_read_b32 v27, a199
    v_pk_mul_f32 v[20:21], v[20:21], v[10:11] op_sel_hi:[1,0]
    v_pk_mul_f32 v[22:23], v[22:23], v[10:11] op_sel_hi:[1,0]
    v_pk_mul_f32 v[24:25], v[24:25], v[10:11] op_sel_hi:[1,0]
    v_pk_mul_f32 v[26:27], v[26:27], v[10:11] op_sel_hi:[1,0]
    v_cvt_pk_bf16_f32 v20, v20, v21
    v_cvt_pk_bf16_f32 v21, v22, v23
    v_cvt_pk_bf16_f32 v22, v24, v25
    v_cvt_pk_bf16_f32 v23, v26, v27
    buffer_store_dwordx4 v[20:23], v1, s[40:43], s72 offen offset:3072 sc1
    v_mov_b32 v9, 1
    v_lshlrev_b32 v216, 20, v1
    s_lshl2_add_u32 s7, s4, s101
    s_add_u32 s7, s7, 163840
    s_waitcnt vmcnt(8)
    buffer_store_dword v9, v216, s[32:35], s7 offen sc1
    s_sub_u32 s78, 14, s6
    s_sub_u32 s78, s78, s6
    s_cmp_eq_u32 s78, 0
    s_cbranch_scc1 K1_LS_END
.p2align 3
K1_LS:
    s_waitcnt lgkmcnt(0)
    v_mfma_f32_16x16x32_bf16 v[240:243], a[224:227], v[136:139], v[176:179]
    s_mov_b32 s99, s76
    ds_read_b128 v[104:107], v2 offset:18432
    ds_read_b128 v[108:111], v2 offset:19456
    v_mfma_f32_16x16x32_bf16 v[240:243], a[228:231], v[168:171], v[240:243]
    v_exp_f32 v253, v253
    v_mfma_f32_16x16x32_bf16 v[240:243], a[232:235], v[200:203], v[240:243]
    v_exp_f32 v254, v254
    v_mfma_f32_16x16x32_bf16 v[240:243], a[236:239], v[232:235], v[240:243]
    v_exp_f32 v255, v255
    v_mfma_f32_16x16x32_bf16 a[8:11], v[96:99], v[48:51], a[8:11]
    s_add_u32 m0, s76, s75
    v_cvt_pk_bf16_f32 v62, v252, v253
    v_cvt_pk_bf16_f32 v63, v254, v255
    v_mfma_f32_16x16x32_bf16 a[8:11], v[100:103], v[52:55], a[8:11]
    s_mov_b32 s76, s60
    ds_read_b128 a[240:243], v2 offset:4096
    ds_read_b128 a[244:247], v2 offset:5120
    v_mfma_f32_16x16x32_bf16 a[12:15], v[96:99], v[56:59], a[12:15]
    s_mov_b32 s60, s82
    buffer_load_dwordx4 v1, s[36:39], s77 offen sc1 lds
    v_mfma_f32_16x16x32_bf16 a[12:15], v[100:103], v[60:63], a[12:15]
    s_mov_b32 s82, s95
    ds_read_b128 a[248:251], v2 offset:6144
    ds_read_b128 a[252:255], v2 offset:7168
    v_mfma_f32_16x16x32_bf16 v[244:247], a[224:227], v[140:143], v[156:159]
    s_mov_b32 s95, s93
    v_exp_f32 v240, v240
    v_mfma_f32_16x16x32_bf16 v[244:247], a[228:231], v[172:175], v[244:247]
    s_mov_b32 s93, s99
    ds_read_b128 v[112:115], v2 offset:20480
    ds_read_b128 v[116:119], v2 offset:21504
    v_mfma_f32_16x16x32_bf16 v[244:247], a[232:235], v[204:207], v[244:247]
    buffer_load_dwordx4 v1, s[36:39], s77 offen offset:1024 sc1 lds
    v_mfma_f32_16x16x32_bf16 v[244:247], a[236:239], v[236:239], v[244:247]
    s_waitcnt lgkmcnt(6)
    v_exp_f32 v241, v241
    v_mfma_f32_16x16x32_bf16 a[24:27], v[104:107], v[48:51], a[24:27]
    v_exp_f32 v242, v242
    v_mfma_f32_16x16x32_bf16 a[24:27], v[108:111], v[52:55], a[24:27]
    v_exp_f32 v243, v243
    v_mfma_f32_16x16x32_bf16 a[28:31], v[104:107], v[56:59], a[28:31]
    buffer_load_dwordx4 v1, s[36:39], s77 offen offset:2048 sc1 lds
    v_mfma_f32_16x16x32_bf16 a[28:31], v[108:111], v[60:63], a[28:31]
    s_waitcnt lgkmcnt(2)
    ds_read_b128 v[120:123], v2 offset:22528
    ds_read_b128 v[124:127], v2 offset:23552
    v_mfma_f32_16x16x32_bf16 v[248:251], a[240:243], v[136:139], v[180:183]
    v_cvt_pk_bf16_f32 v80, v240, v241
    v_cvt_pk_bf16_f32 v81, v242, v243
    v_mfma_f32_16x16x32_bf16 v[248:251], a[244:247], v[168:171], v[248:251]
    v_exp_f32 v244, v244
    v_mfma_f32_16x16x32_bf16 v[248:251], a[248:251], v[200:203], v[248:251]
    buffer_load_dwordx4 v1, s[36:39], s77 offen offset:3072 sc1 lds
    v_mfma_f32_16x16x32_bf16 v[248:251], a[252:255], v[232:235], v[248:251]
    s_waitcnt lgkmcnt(2)
    ds_read_b128 a[224:227], v2 offset:8192
    ds_read_b128 a[228:231], v2 offset:9216
    v_mfma_f32_16x16x32_bf16 a[40:43], v[112:115], v[48:51], a[40:43]
    v_exp_f32 v245, v245
    v_mfma_f32_16x16x32_bf16 a[40:43], v[116:119], v[52:55], a[40:43]
    ds_read_b128 a[232:235], v2 offset:10240
    ds_read_b128 a[236:239], v2 offset:11264
    v_mfma_f32_16x16x32_bf16 a[44:47], v[112:115], v[56:59], a[44:47]
    s_add_u32 s100, s77, 4096
    ds_read_b128 v[96:99], v2 offset:24576
    v_cvt_pk_bf16_f32 v88, v244, v245
    v_mfma_f32_16x16x32_bf16 a[44:47], v[116:119], v[60:63], a[44:47]
    s_add_u32 m0, m0, 4096
    v_exp_f32 v246, v246
    v_mfma_f32_16x16x32_bf16 v[252:255], a[240:243], v[140:143], v[156:159]
    buffer_load_dwordx4 v1, s[36:39], s100 offen sc1 lds
    v_mfma_f32_16x16x32_bf16 v[252:255], a[244:247], v[172:175], v[252:255]
    v_exp_f32 v247, v247
    v_mfma_f32_16x16x32_bf16 v[252:255], a[248:251], v[204:207], v[252:255]
    ds_read_b128 v[100:103], v2 offset:25600
    v_cvt_pk_bf16_f32 v89, v246, v247
    v_mfma_f32_16x16x32_bf16 v[252:255], a[252:255], v[236:239], v[252:255]
    s_waitcnt lgkmcnt(4)
    buffer_load_dwordx4 v1, s[36:39], s100 offen offset:1024 sc1 lds
    v_mfma_f32_16x16x32_bf16 a[56:59], v[120:123], v[48:51], a[56:59]
    v_exp_f32 v248, v248
    v_mfma_f32_16x16x32_bf16 a[56:59], v[124:127], v[52:55], a[56:59]
    v_exp_f32 v249, v249
    v_mfma_f32_16x16x32_bf16 a[60:63], v[120:123], v[56:59], a[60:63]
    ds_read_b128 v[104:107], v2 offset:26624
    ds_read_b128 v[108:111], v2 offset:27648
    v_mfma_f32_16x16x32_bf16 a[60:63], v[124:127], v[60:63], a[60:63]
    v_exp_f32 v250, v250
    v_mfma_f32_16x16x32_bf16 v[240:243], a[224:227], v[136:139], v[184:187]
    buffer_load_dwordx4 v1, s[36:39], s100 offen offset:2048 sc1 lds
    v_mfma_f32_16x16x32_bf16 v[240:243], a[228:231], v[168:171], v[240:243]
    s_waitcnt lgkmcnt(2)
    v_exp_f32 v251, v251
    v_mfma_f32_16x16x32_bf16 v[240:243], a[232:235], v[200:203], v[240:243]
    ds_read_b128 a[240:243], v2 offset:12288
    ds_read_b128 a[244:247], v2 offset:13312
    v_mfma_f32_16x16x32_bf16 v[240:243], a[236:239], v[232:235], v[240:243]
    ds_read_b128 a[248:251], v2 offset:14336
    v_cvt_pk_bf16_f32 v82, v248, v249
    v_mfma_f32_16x16x32_bf16 a[152:155], v[96:99], v[48:51], a[152:155]
    buffer_load_dwordx4 v1, s[36:39], s100 offen offset:3072 sc1 lds
    v_mfma_f32_16x16x32_bf16 a[152:155], v[100:103], v[52:55], a[152:155]
    ds_read_b128 a[252:255], v2 offset:15360
    v_cvt_pk_bf16_f32 v83, v250, v251
    v_mfma_f32_16x16x32_bf16 a[156:159], v[96:99], v[56:59], a[156:159]
    ds_read_b128 v[112:115], v2 offset:28672
    ds_read_b128 v[116:119], v2 offset:29696
    v_mfma_f32_16x16x32_bf16 a[156:159], v[100:103], v[60:63], a[156:159]
    v_exp_f32 v252, v252
    v_mfma_f32_16x16x32_bf16 v[244:247], a[224:227], v[140:143], v[156:159]
    s_add_u32 s77, s77, 32768
    v_exp_f32 v253, v253
    v_mfma_f32_16x16x32_bf16 v[244:247], a[228:231], v[172:175], v[244:247]
    v_exp_f32 v254, v254
    v_mfma_f32_16x16x32_bf16 v[244:247], a[232:235], v[204:207], v[244:247]
    v_exp_f32 v255, v255
    v_mfma_f32_16x16x32_bf16 v[244:247], a[236:239], v[236:239], v[244:247]
    s_waitcnt lgkmcnt(3)
    v_cvt_pk_bf16_f32 v90, v252, v253
    v_cvt_pk_bf16_f32 v91, v254, v255
    v_mfma_f32_16x16x32_bf16 a[168:171], v[104:107], v[48:51], a[168:171]
    v_exp_f32 v240, v240
    v_mfma_f32_16x16x32_bf16 a[168:171], v[108:111], v[52:55], a[168:171]
    v_exp_f32 v241, v241
    v_mfma_f32_16x16x32_bf16 a[172:175], v[104:107], v[56:59], a[172:175]
    ds_read_b128 v[120:123], v2 offset:30720
    ds_read_b128 v[124:127], v2 offset:31744
    v_mfma_f32_16x16x32_bf16 a[172:175], v[108:111], v[60:63], a[172:175]
    v_add_u32 v2, s82, v1
    v_cvt_pk_bf16_f32 v84, v240, v241
    v_mfma_f32_16x16x32_bf16 v[248:251], a[240:243], v[136:139], v[188:191]
    v_exp_f32 v242, v242
    v_mfma_f32_16x16x32_bf16 v[248:251], a[244:247], v[168:171], v[248:251]
    v_exp_f32 v243, v243
    v_mfma_f32_16x16x32_bf16 v[248:251], a[248:251], v[200:203], v[248:251]
    s_waitcnt lgkmcnt(2)
    v_exp_f32 v244, v244
    v_mfma_f32_16x16x32_bf16 v[248:251], a[252:255], v[232:235], v[248:251]
    v_exp_f32 v245, v245
    v_mfma_f32_16x16x32_bf16 a[184:187], v[112:115], v[48:51], a[184:187]
    ds_read_b128 a[224:227], v2 offset:0
    ds_read_b128 a[228:231], v2 offset:1024
    v_mfma_f32_16x16x32_bf16 a[184:187], v[116:119], v[52:55], a[184:187]
    ds_read_b128 a[232:235], v2 offset:2048
    v_cvt_pk_bf16_f32 v85, v242, v243
    v_mfma_f32_16x16x32_bf16 a[188:191], v[112:115], v[56:59], a[188:191]
    ds_read_b128 a[236:239], v2 offset:3072
    v_cvt_pk_bf16_f32 v92, v244, v245
    v_mfma_f32_16x16x32_bf16 a[188:191], v[116:119], v[60:63], a[188:191]
    v_exp_f32 v246, v246
    v_mfma_f32_16x16x32_bf16 v[252:255], a[240:243], v[140:143], v[156:159]
    ds_read_b128 v[96:99], v2 offset:16384
    ds_read_b128 v[100:103], v2 offset:17408
    v_mfma_f32_16x16x32_bf16 v[252:255], a[244:247], v[172:175], v[252:255]
    v_exp_f32 v247, v247
    v_mfma_f32_16x16x32_bf16 v[252:255], a[248:251], v[204:207], v[252:255]
    v_exp_f32 v248, v248
    v_mfma_f32_16x16x32_bf16 v[252:255], a[252:255], v[236:239], v[252:255]
    s_waitcnt lgkmcnt(4)
    v_exp_f32 v249, v249
    v_mfma_f32_16x16x32_bf16 a[200:203], v[120:123], v[48:51], a[200:203]
    v_exp_f32 v250, v250
    v_mfma_f32_16x16x32_bf16 a[200:203], v[124:127], v[52:55], a[200:203]
    v_exp_f32 v251, v251
    v_mfma_f32_16x16x32_bf16 a[204:207], v[120:123], v[56:59], a[204:207]
    v_cvt_pk_bf16_f32 v93, v246, v247
    v_cvt_pk_bf16_f32 v86, v248, v249
    v_mfma_f32_16x16x32_bf16 a[204:207], v[124:127], v[60:63], a[204:207]
    v_exp_f32 v252, v252
    v_smfmac_f32_16x16x64_bf16 a[216:219], a[136:139], v[48:55], v215
    s_cmp_le_u32 s78, 2
    v_cvt_pk_bf16_f32 v87, v250, v251
    v_smfmac_f32_16x16x64_bf16 a[220:223], a[136:139], v[56:63], v215
    s_cbranch_scc1 K1_LS_MASK
K1_LS_BACK:
    s_waitcnt lgkmcnt(0)
    v_mfma_f32_16x16x32_bf16 v[240:243], a[224:227], v[136:139], v[176:179]
    s_mov_b32 s99, s76
    ds_read_b128 v[104:107], v2 offset:18432
    ds_read_b128 v[108:111], v2 offset:19456
    v_mfma_f32_16x16x32_bf16 v[240:243], a[228:231], v[168:171], v[240:243]
    v_exp_f32 v253, v253
    v_mfma_f32_16x16x32_bf16 v[240:243], a[232:235], v[200:203], v[240:243]
    v_exp_f32 v254, v254
    v_mfma_f32_16x16x32_bf16 v[240:243], a[236:239], v[232:235], v[240:243]
    v_exp_f32 v255, v255
    v_mfma_f32_16x16x32_bf16 a[8:11], v[96:99], v[80:83], a[8:11]
    s_add_u32 m0, s76, s75
    v_cvt_pk_bf16_f32 v94, v252, v253
    v_cvt_pk_bf16_f32 v95, v254, v255
    v_mfma_f32_16x16x32_bf16 a[8:11], v[100:103], v[84:87], a[8:11]
    s_mov_b32 s76, s60
    ds_read_b128 a[240:243], v2 offset:4096
    ds_read_b128 a[244:247], v2 offset:5120
    v_mfma_f32_16x16x32_bf16 a[12:15], v[96:99], v[88:91], a[12:15]
    s_mov_b32 s60, s82
    buffer_load_dwordx4 v1, s[36:39], s77 offen sc1 lds
    v_mfma_f32_16x16x32_bf16 a[12:15], v[100:103], v[92:95], a[12:15]
    s_mov_b32 s82, s95
    ds_read_b128 a[248:251], v2 offset:6144
    ds_read_b128 a[252:255], v2 offset:7168
    v_mfma_f32_16x16x32_bf16 v[244:247], a[224:227], v[140:143], v[156:159]
    s_mov_b32 s95, s93
    v_exp_f32 v240, v240
    v_mfma_f32_16x16x32_bf16 v[244:247], a[228:231], v[172:175], v[244:247]
    s_mov_b32 s93, s99
    ds_read_b128 v[112:115], v2 offset:20480
    ds_read_b128 v[116:119], v2 offset:21504
    v_mfma_f32_16x16x32_bf16 v[244:247], a[232:235], v[204:207], v[244:247]
    buffer_load_dwordx4 v1, s[36:39], s77 offen offset:1024 sc1 lds
    v_mfma_f32_16x16x32_bf16 v[244:247], a[236:239], v[236:239], v[244:247]
    s_waitcnt lgkmcnt(6)
    v_exp_f32 v241, v241
    v_mfma_f32_16x16x32_bf16 a[24:27], v[104:107], v[80:83], a[24:27]
    v_exp_f32 v242, v242
    v_mfma_f32_16x16x32_bf16 a[24:27], v[108:111], v[84:87], a[24:27]
    v_exp_f32 v243, v243
    v_mfma_f32_16x16x32_bf16 a[28:31], v[104:107], v[88:91], a[28:31]
    buffer_load_dwordx4 v1, s[36:39], s77 offen offset:2048 sc1 lds
    v_mfma_f32_16x16x32_bf16 a[28:31], v[108:111], v[92:95], a[28:31]
    s_waitcnt lgkmcnt(2)
    ds_read_b128 v[120:123], v2 offset:22528
    ds_read_b128 v[124:127], v2 offset:23552
    v_mfma_f32_16x16x32_bf16 v[248:251], a[240:243], v[136:139], v[180:183]
    v_cvt_pk_bf16_f32 v48, v240, v241
    v_cvt_pk_bf16_f32 v49, v242, v243
    v_mfma_f32_16x16x32_bf16 v[248:251], a[244:247], v[168:171], v[248:251]
    v_exp_f32 v244, v244
    v_mfma_f32_16x16x32_bf16 v[248:251], a[248:251], v[200:203], v[248:251]
    buffer_load_dwordx4 v1, s[36:39], s77 offen offset:3072 sc1 lds
    v_mfma_f32_16x16x32_bf16 v[248:251], a[252:255], v[232:235], v[248:251]
    s_waitcnt lgkmcnt(2)
    ds_read_b128 a[224:227], v2 offset:8192
    ds_read_b128 a[228:231], v2 offset:9216
    v_mfma_f32_16x16x32_bf16 a[40:43], v[112:115], v[80:83], a[40:43]
    v_exp_f32 v245, v245
    v_mfma_f32_16x16x32_bf16 a[40:43], v[116:119], v[84:87], a[40:43]
    ds_read_b128 a[232:235], v2 offset:10240
    ds_read_b128 a[236:239], v2 offset:11264
    v_mfma_f32_16x16x32_bf16 a[44:47], v[112:115], v[88:91], a[44:47]
    s_add_u32 s100, s77, 4096
    ds_read_b128 v[96:99], v2 offset:24576
    v_cvt_pk_bf16_f32 v56, v244, v245
    v_mfma_f32_16x16x32_bf16 a[44:47], v[116:119], v[92:95], a[44:47]
    s_add_u32 m0, m0, 4096
    v_exp_f32 v246, v246
    v_mfma_f32_16x16x32_bf16 v[252:255], a[240:243], v[140:143], v[156:159]
    buffer_load_dwordx4 v1, s[36:39], s100 offen sc1 lds
    v_mfma_f32_16x16x32_bf16 v[252:255], a[244:247], v[172:175], v[252:255]
    v_exp_f32 v247, v247
    v_mfma_f32_16x16x32_bf16 v[252:255], a[248:251], v[204:207], v[252:255]
    ds_read_b128 v[100:103], v2 offset:25600
    v_cvt_pk_bf16_f32 v57, v246, v247
    v_mfma_f32_16x16x32_bf16 v[252:255], a[252:255], v[236:239], v[252:255]
    s_waitcnt lgkmcnt(4)
    buffer_load_dwordx4 v1, s[36:39], s100 offen offset:1024 sc1 lds
    v_mfma_f32_16x16x32_bf16 a[56:59], v[120:123], v[80:83], a[56:59]
    v_exp_f32 v248, v248
    v_mfma_f32_16x16x32_bf16 a[56:59], v[124:127], v[84:87], a[56:59]
    v_exp_f32 v249, v249
    v_mfma_f32_16x16x32_bf16 a[60:63], v[120:123], v[88:91], a[60:63]
    ds_read_b128 v[104:107], v2 offset:26624
    ds_read_b128 v[108:111], v2 offset:27648
    v_mfma_f32_16x16x32_bf16 a[60:63], v[124:127], v[92:95], a[60:63]
    v_exp_f32 v250, v250
    v_mfma_f32_16x16x32_bf16 v[240:243], a[224:227], v[136:139], v[184:187]
    buffer_load_dwordx4 v1, s[36:39], s100 offen offset:2048 sc1 lds
    v_mfma_f32_16x16x32_bf16 v[240:243], a[228:231], v[168:171], v[240:243]
    s_waitcnt lgkmcnt(2)
    v_exp_f32 v251, v251
    v_mfma_f32_16x16x32_bf16 v[240:243], a[232:235], v[200:203], v[240:243]
    ds_read_b128 a[240:243], v2 offset:12288
    ds_read_b128 a[244:247], v2 offset:13312
    v_mfma_f32_16x16x32_bf16 v[240:243], a[236:239], v[232:235], v[240:243]
    ds_read_b128 a[248:251], v2 offset:14336
    v_cvt_pk_bf16_f32 v50, v248, v249
    v_mfma_f32_16x16x32_bf16 a[152:155], v[96:99], v[80:83], a[152:155]
    buffer_load_dwordx4 v1, s[36:39], s100 offen offset:3072 sc1 lds
    v_mfma_f32_16x16x32_bf16 a[152:155], v[100:103], v[84:87], a[152:155]
    ds_read_b128 a[252:255], v2 offset:15360
    v_cvt_pk_bf16_f32 v51, v250, v251
    v_mfma_f32_16x16x32_bf16 a[156:159], v[96:99], v[88:91], a[156:159]
    ds_read_b128 v[112:115], v2 offset:28672
    ds_read_b128 v[116:119], v2 offset:29696
    v_mfma_f32_16x16x32_bf16 a[156:159], v[100:103], v[92:95], a[156:159]
    v_exp_f32 v252, v252
    v_mfma_f32_16x16x32_bf16 v[244:247], a[224:227], v[140:143], v[156:159]
    s_add_u32 s77, s77, 32768
    v_exp_f32 v253, v253
    v_mfma_f32_16x16x32_bf16 v[244:247], a[228:231], v[172:175], v[244:247]
    ds_read_b128 v[120:123], v2 offset:30720
    ds_read_b128 v[124:127], v2 offset:31744
    v_mfma_f32_16x16x32_bf16 v[244:247], a[232:235], v[204:207], v[244:247]
    v_add_u32 v2, s82, v1
    v_cvt_pk_bf16_f32 v58, v252, v253
    v_mfma_f32_16x16x32_bf16 v[244:247], a[236:239], v[236:239], v[244:247]
    s_waitcnt lgkmcnt(5)
    v_exp_f32 v254, v254
    v_mfma_f32_16x16x32_bf16 a[168:171], v[104:107], v[80:83], a[168:171]
    v_exp_f32 v255, v255
    v_mfma_f32_16x16x32_bf16 a[168:171], v[108:111], v[84:87], a[168:171]
    v_exp_f32 v240, v240
    v_mfma_f32_16x16x32_bf16 a[172:175], v[104:107], v[88:91], a[172:175]
    v_exp_f32 v241, v241
    v_mfma_f32_16x16x32_bf16 a[172:175], v[108:111], v[92:95], a[172:175]
    v_cvt_pk_bf16_f32 v59, v254, v255
    v_cvt_pk_bf16_f32 v52, v240, v241
    v_mfma_f32_16x16x32_bf16 v[248:251], a[240:243], v[136:139], v[188:191]
    v_exp_f32 v242, v242
    v_mfma_f32_16x16x32_bf16 v[248:251], a[244:247], v[168:171], v[248:251]
    v_exp_f32 v243, v243
    v_mfma_f32_16x16x32_bf16 v[248:251], a[248:251], v[200:203], v[248:251]
    s_waitcnt lgkmcnt(0)
    v_exp_f32 v244, v244
    v_mfma_f32_16x16x32_bf16 v[248:251], a[252:255], v[232:235], v[248:251]
    v_exp_f32 v245, v245
    v_mfma_f32_16x16x32_bf16 a[184:187], v[112:115], v[80:83], a[184:187]
    s_waitcnt vmcnt(8) lgkmcnt(0)
    v_exp_f32 v246, v246
    v_mfma_f32_16x16x32_bf16 a[184:187], v[116:119], v[84:87], a[184:187]
    s_barrier
    ds_read_b128 a[224:227], v2 offset:0
    ds_read_b128 a[228:231], v2 offset:1024
    v_mfma_f32_16x16x32_bf16 a[188:191], v[112:115], v[88:91], a[188:191]
    ds_read_b128 a[232:235], v2 offset:2048
    v_cvt_pk_bf16_f32 v53, v242, v243
    v_mfma_f32_16x16x32_bf16 a[188:191], v[116:119], v[92:95], a[188:191]
    ds_read_b128 a[236:239], v2 offset:3072
    v_cvt_pk_bf16_f32 v60, v244, v245
    v_mfma_f32_16x16x32_bf16 v[252:255], a[240:243], v[140:143], v[156:159]
    v_exp_f32 v247, v247
    v_mfma_f32_16x16x32_bf16 v[252:255], a[244:247], v[172:175], v[252:255]
    ds_read_b128 v[96:99], v2 offset:16384
    ds_read_b128 v[100:103], v2 offset:17408
    v_mfma_f32_16x16x32_bf16 v[252:255], a[248:251], v[204:207], v[252:255]
    v_exp_f32 v248, v248
    v_mfma_f32_16x16x32_bf16 v[252:255], a[252:255], v[236:239], v[252:255]
    v_exp_f32 v249, v249
    v_mfma_f32_16x16x32_bf16 a[200:203], v[120:123], v[80:83], a[200:203]
    v_exp_f32 v250, v250
    v_mfma_f32_16x16x32_bf16 a[200:203], v[124:127], v[84:87], a[200:203]
    v_exp_f32 v251, v251
    v_mfma_f32_16x16x32_bf16 a[204:207], v[120:123], v[88:91], a[204:207]
    v_cvt_pk_bf16_f32 v61, v246, v247
    v_cvt_pk_bf16_f32 v54, v248, v249
    v_mfma_f32_16x16x32_bf16 a[204:207], v[124:127], v[92:95], a[204:207]
    s_sub_u32 s78, s78, 1
    v_exp_f32 v252, v252
    v_smfmac_f32_16x16x64_bf16 a[216:219], a[136:139], v[80:87], v215
    s_cmp_lg_u32 s78, 0
    v_cvt_pk_bf16_f32 v55, v250, v251
    v_smfmac_f32_16x16x64_bf16 a[220:223], a[136:139], v[88:95], v215
    s_cbranch_scc1 K1_LS
K1_LS_END:
    v_add_f32 v212, s12, v156
    v_fma_f32 v176, v208, s8, v212
    v_fma_f32 v177, v209, s8, v212
    v_fma_f32 v178, v210, s8, v212
    v_fma_f32 v179, v211, s8, v212
    s_nop 1
    s_waitcnt lgkmcnt(0)
    v_mfma_f32_16x16x32_bf16 v[240:243], a[224:227], v[140:143], v[176:179]
    s_xor_b32 s21, s3, 1
    ds_read_b128 v[104:107], v2 offset:18432
    s_lshl2_add_u32 s21, s21, s4
    v_mfma_f32_16x16x32_bf16 v[240:243], a[228:231], v[172:175], v[240:243]
    s_mul_i32 s21, s21, 36864
    ds_read_b128 v[108:111], v2 offset:19456
    ds_read_b128 a[240:243], v2 offset:4096
    v_mfma_f32_16x16x32_bf16 v[240:243], a[232:235], v[204:207], v[240:243]
    s_add_u32 s21, s21, s28
    s_mov_b32 m0, s45
    ds_read_b128 a[244:247], v2 offset:5120
    v_mfma_f32_16x16x32_bf16 v[240:243], a[236:239], v[236:239], v[240:243]
    s_mul_i32 s86, s4, 34
    buffer_load_dwordx4 v1, s[56:59], s21 offen sc1 lds
    v_mfma_f32_16x16x32_bf16 a[8:11], v[96:99], v[48:51], a[8:11]
    s_add_u32 s86, s86, 8
    v_exp_f32 v253, v253
    v_mfma_f32_16x16x32_bf16 a[8:11], v[100:103], v[52:55], a[8:11]
    s_mov_b32 s99, s76
    v_exp_f32 v254, v254
    v_mfma_f32_16x16x32_bf16 a[12:15], v[96:99], v[56:59], a[12:15]
    s_mov_b32 s76, s60
    v_exp_f32 v255, v255
    v_cvt_pk_bf16_f32 v62, v252, v253
    v_cvt_pk_bf16_f32 v63, v254, v255
    s_nop 1
    v_mfma_f32_16x16x32_bf16 a[12:15], v[100:103], v[60:63], a[12:15]
    s_mov_b32 s60, s82
    ds_read_b128 a[248:251], v2 offset:6144
    ds_read_b128 a[252:255], v2 offset:7168
    s_waitcnt lgkmcnt(2)
    v_mfma_f32_16x16x32_bf16 a[24:27], v[104:107], v[48:51], a[24:27]
    s_mov_b32 s82, s95
    v_lshrrev_b32 v28, 4, v1
    ds_read_b128 v[112:115], v2 offset:20480
    v_mfma_f32_16x16x32_bf16 a[24:27], v[108:111], v[52:55], a[24:27]
    s_mov_b32 s95, s93
    v_min_u32 v28, 33, v28
    ds_read_b128 v[116:119], v2 offset:21504
    v_mfma_f32_16x16x32_bf16 a[28:31], v[104:107], v[56:59], a[28:31]
    s_mov_b32 s93, s99
    buffer_load_dwordx4 v1, s[56:59], s21 offen offset:1024 sc1 lds
    v_mfma_f32_16x16x32_bf16 a[28:31], v[108:111], v[60:63], a[28:31]
    s_and_b32 s62, s5, 4
    v_add_lshl_u32 v28, v28, s86, 7
    v_add_f32 v213, s13, v156
    v_fma_f32 v180, v208, s9, v213
    v_fma_f32 v181, v209, s9, v213
    v_fma_f32 v182, v210, s9, v213
    v_fma_f32 v183, v211, s9, v213
    s_nop 1
    v_mfma_f32_16x16x32_bf16 v[244:247], a[240:243], v[140:143], v[180:183]
    s_getpc_b64 s[86:87]
    global_load_dword v28, v28, s[86:87]
    v_mfma_f32_16x16x32_bf16 v[244:247], a[244:247], v[172:175], v[244:247]
    s_lshl_b32 s63, s3, 12
    ds_read_b128 v[120:123], v2 offset:22528
    ds_read_b128 v[124:127], v2 offset:23552
    s_waitcnt lgkmcnt(3)
    v_mfma_f32_16x16x32_bf16 v[244:247], a[248:251], v[204:207], v[244:247]
    s_sub_u32 s19, s74, s101
    buffer_load_dwordx4 v1, s[56:59], s21 offen offset:2048 sc1 lds
    v_mfma_f32_16x16x32_bf16 v[244:247], a[252:255], v[236:239], v[244:247]
    s_add_u32 s62, s62, s4
    ds_read_b128 a[224:227], v2 offset:8192
    ds_read_b128 a[228:231], v2 offset:9216
    v_mfma_f32_16x16x32_bf16 a[40:43], v[112:115], v[48:51], a[40:43]
    s_mov_b32 s20, s63
    ds_read_b128 a[232:235], v2 offset:10240
    v_add_f32 v212, s14, v156
    s_waitcnt lgkmcnt(5)
    v_mfma_f32_16x16x32_bf16 a[40:43], v[116:119], v[52:55], a[40:43]
    s_add_u32 s19, s66, s19
    ds_read_b128 a[236:239], v2 offset:11264
    v_fma_f32 v184, v208, s10, v212
    v_mfma_f32_16x16x32_bf16 a[44:47], v[112:115], v[56:59], a[44:47]
    s_mov_b32 s50, 9437184
    ds_read_b128 v[96:99], v2 offset:24576
    v_fma_f32 v185, v209, s10, v212
    v_mfma_f32_16x16x32_bf16 a[44:47], v[116:119], v[60:63], a[44:47]
    s_waitcnt lgkmcnt(5)
    ds_read_b128 v[100:103], v2 offset:25600
    v_fma_f32 v186, v210, s10, v212
    v_mfma_f32_16x16x32_bf16 a[56:59], v[120:123], v[48:51], a[56:59]
    buffer_load_dwordx4 v1, s[56:59], s21 offen offset:3072 sc1 lds
    v_mfma_f32_16x16x32_bf16 a[56:59], v[124:127], v[52:55], a[56:59]
    s_add_u32 s21, s21, 4096
    v_fma_f32 v187, v211, s10, v212
    ds_read_b128 v[104:107], v2 offset:26624
    v_mfma_f32_16x16x32_bf16 a[60:63], v[120:123], v[56:59], a[60:63]
    s_add_u32 m0, s45, 4096
    ds_read_b128 v[108:111], v2 offset:27648
    ds_read_b128 a[240:243], v2 offset:12288
    v_mfma_f32_16x16x32_bf16 a[60:63], v[124:127], v[60:63], a[60:63]
    s_waitcnt lgkmcnt(4)
    ds_read_b128 a[244:247], v2 offset:13312
    v_add_f32 v213, s15, v156
    v_mfma_f32_16x16x32_bf16 v[248:251], a[224:227], v[140:143], v[184:187]
    ds_read_b128 a[248:251], v2 offset:14336
    v_fma_f32 v188, v208, s11, v213
    v_mfma_f32_16x16x32_bf16 v[248:251], a[228:231], v[172:175], v[248:251]
    ds_read_b128 a[252:255], v2 offset:15360
    v_fma_f32 v189, v209, s11, v213
    v_mfma_f32_16x16x32_bf16 v[248:251], a[232:235], v[204:207], v[248:251]
    buffer_load_dwordx4 v1, s[56:59], s21 offen sc1 lds
    v_mfma_f32_16x16x32_bf16 v[248:251], a[236:239], v[236:239], v[248:251]
    ds_read_b128 v[112:115], v2 offset:28672
    ds_read_b128 v[116:119], v2 offset:29696
    v_mfma_f32_16x16x32_bf16 a[152:155], v[96:99], v[48:51], a[152:155]
    s_waitcnt lgkmcnt(4)
    v_fma_f32 v190, v210, s11, v213
    v_fma_f32 v191, v211, s11, v213
    v_mfma_f32_16x16x32_bf16 a[152:155], v[100:103], v[52:55], a[152:155]
    ds_read_b128 v[120:123], v2 offset:30720
    ds_read_b128 v[124:127], v2 offset:31744
    v_mfma_f32_16x16x32_bf16 a[156:159], v[96:99], v[56:59], a[156:159]
    v_add_u32 v2, s82, v1
    ds_read_b128 v[96:99], v2 offset:16384
    v_mfma_f32_16x16x32_bf16 a[156:159], v[100:103], v[60:63], a[156:159]
    ds_read_b128 v[100:103], v2 offset:17408
    v_bfe_u32 v217, v1, 4, 3
    v_mfma_f32_16x16x32_bf16 a[168:171], v[104:107], v[48:51], a[168:171]
    buffer_load_dwordx4 v1, s[56:59], s21 offen offset:1024 sc1 lds
    v_mfma_f32_16x16x32_bf16 a[168:171], v[108:111], v[52:55], a[168:171]
    v_exp_f32 v240, v240
    v_mfma_f32_16x16x32_bf16 a[172:175], v[104:107], v[56:59], a[172:175]
    ds_read_b128 v[104:107], v2 offset:18432
    v_lshlrev_b32 v217, 7, v217
    v_mfma_f32_16x16x32_bf16 a[172:175], v[108:111], v[60:63], a[172:175]
    v_exp_f32 v241, v241
    v_mfma_f32_16x16x32_bf16 v[252:255], a[240:243], v[140:143], v[188:191]
    ds_read_b128 v[108:111], v2 offset:19456
    v_cvt_pk_bf16_f32 v88, v240, v241
    v_mfma_f32_16x16x32_bf16 v[252:255], a[244:247], v[172:175], v[252:255]
    s_waitcnt lgkmcnt(2)
    v_exp_f32 v242, v242
    v_mfma_f32_16x16x32_bf16 v[252:255], a[248:251], v[204:207], v[252:255]
    buffer_load_dwordx4 v1, s[56:59], s21 offen offset:2048 sc1 lds
    v_mfma_f32_16x16x32_bf16 v[252:255], a[252:255], v[236:239], v[252:255]
    v_exp_f32 v243, v243
    v_mfma_f32_16x16x32_bf16 a[184:187], v[112:115], v[48:51], a[184:187]
    v_exp_f32 v244, v244
    v_mfma_f32_16x16x32_bf16 a[184:187], v[116:119], v[52:55], a[184:187]
    v_exp_f32 v245, v245
    v_mfma_f32_16x16x32_bf16 a[188:191], v[112:115], v[56:59], a[188:191]
    ds_read_b128 v[112:115], v2 offset:20480
    v_cvt_pk_bf16_f32 v89, v242, v243
    v_mfma_f32_16x16x32_bf16 a[188:191], v[116:119], v[60:63], a[188:191]
    v_exp_f32 v246, v246
    v_mfma_f32_16x16x32_bf16 a[200:203], v[120:123], v[48:51], a[200:203]
    v_exp_f32 v247, v247
    v_mfma_f32_16x16x32_bf16 a[200:203], v[124:127], v[52:55], a[200:203]
    v_exp_f32 v248, v248
    v_mfma_f32_16x16x32_bf16 a[204:207], v[120:123], v[56:59], a[204:207]
    v_exp_f32 v249, v249
    v_mfma_f32_16x16x32_bf16 a[204:207], v[124:127], v[60:63], a[204:207]
    v_exp_f32 v250, v250
    v_smfmac_f32_16x16x64_bf16 a[216:219], a[136:139], v[48:55], v215
    s_add_u32 s48, s32, 1048576
    s_addc_u32 s49, s33, 0
    ds_read_b128 v[116:119], v2 offset:21504
    v_smfmac_f32_16x16x64_bf16 a[220:223], a[136:139], v[56:63], v215
    v_exp_f32 v251, v251
    v_cvt_pk_bf16_f32 v90, v244, v245
    v_cvt_pk_bf16_f32 v91, v246, v247
    v_cvt_pk_bf16_f32 v92, v248, v249
    v_cvt_pk_bf16_f32 v93, v250, v251
    v_exp_f32 v252, v252
    s_cmp_eq_u32 s6, 7
    s_cbranch_scc1 K1_S7
K1_S7_BACK:
    s_waitcnt lgkmcnt(0)
    v_mfma_f32_16x16x32_bf16 a[12:15], v[96:99], v[88:91], a[12:15]
    ds_read_b128 v[120:123], v2 offset:22528
    v_exp_f32 v253, v253
    v_exp_f32 v254, v254
    v_exp_f32 v255, v255
    v_cvt_pk_bf16_f32 v94, v252, v253
    v_cvt_pk_bf16_f32 v95, v254, v255
    s_nop 1
    v_mfma_f32_16x16x32_bf16 a[12:15], v[100:103], v[92:95], a[12:15]
    ds_read_b128 v[124:127], v2 offset:23552
    ds_read_b128 v[96:99], v2 offset:24576
    v_accvgpr_read_b32 v12, a8
    v_accvgpr_read_b32 v13, a9
    v_accvgpr_read_b32 v14, a10
    v_mfma_f32_16x16x32_bf16 a[28:31], v[104:107], v[88:91], a[28:31]
    ds_read_b128 v[100:103], v2 offset:25600
    v_accvgpr_read_b32 v9, a216
    v_accvgpr_read_b32 v10, a217
    v_add_f32 v9, v9, v10
    v_accvgpr_read_b32 v15, a11
    v_mfma_f32_16x16x32_bf16 a[28:31], v[108:111], v[92:95], a[28:31]
    ds_read_b128 v[104:107], v2 offset:26624
    v_rcp_f32 v10, v9
    v_accvgpr_read_b32 v16, a24
    v_mul_f32 v10, v10, v6
    v_mfma_f32_16x16x32_bf16 a[44:47], v[112:115], v[88:91], a[44:47]
    ds_read_b128 v[108:111], v2 offset:27648
    v_accvgpr_read_b32 v17, a25
    v_accvgpr_read_b32 v18, a26
    v_accvgpr_read_b32 v19, a27
    v_accvgpr_read_b32 v20, a40
    v_mfma_f32_16x16x32_bf16 a[44:47], v[116:119], v[92:95], a[44:47]
    s_waitcnt lgkmcnt(5)
    ds_read_b128 v[112:115], v2 offset:28672
    v_accvgpr_read_b32 v21, a41
    v_accvgpr_read_b32 v22, a42
    v_accvgpr_read_b32 v23, a43
    v_accvgpr_read_b32 v24, a56
    v_mfma_f32_16x16x32_bf16 a[60:63], v[120:123], v[88:91], a[60:63]
    s_waitcnt lgkmcnt(3)
    ds_read_b128 v[116:119], v2 offset:29696
    v_accvgpr_read_b32 v25, a57
    v_accvgpr_read_b32 v26, a58
    v_accvgpr_read_b32 v27, a59
    v_mul_f32 v12, v10, v12
    v_mfma_f32_16x16x32_bf16 a[60:63], v[124:127], v[92:95], a[60:63]
    ds_read_b128 v[120:123], v2 offset:30720
    v_mul_f32 v13, v10, v13
    v_mul_f32 v14, v10, v14
    v_mul_f32 v15, v10, v15
    v_mul_f32 v16, v10, v16
    v_mfma_f32_16x16x32_bf16 a[156:159], v[96:99], v[88:91], a[156:159]
    ds_read_b128 v[124:127], v2 offset:31744
    v_mul_f32 v17, v10, v17
    v_mul_f32 v18, v10, v18
    v_mul_f32 v19, v10, v19
    v_mul_f32 v20, v10, v20
    v_mfma_f32_16x16x32_bf16 a[156:159], v[100:103], v[92:95], a[156:159]
    s_waitcnt lgkmcnt(3)
    v_mul_f32 v21, v10, v21
    v_mul_f32 v22, v10, v22
    v_mul_f32 v23, v10, v23
    v_mul_f32 v24, v10, v24
    v_mul_f32 v25, v10, v25
    v_mfma_f32_16x16x32_bf16 a[172:175], v[104:107], v[88:91], a[172:175]
    v_mul_f32 v26, v10, v26
    v_mul_f32 v27, v10, v27
    v_cvt_pk_bf16_f32 v12, v12, v13
    v_cvt_pk_bf16_f32 v13, v14, v15
    v_cvt_pk_bf16_f32 v14, v16, v17
    v_mfma_f32_16x16x32_bf16 a[172:175], v[108:111], v[92:95], a[172:175]
    v_cvt_pk_bf16_f32 v15, v18, v19
    v_cvt_pk_bf16_f32 v20, v20, v21
    v_cvt_pk_bf16_f32 v21, v22, v23
    v_cvt_pk_bf16_f32 v22, v24, v25
    v_cvt_pk_bf16_f32 v23, v26, v27
    v_mfma_f32_16x16x32_bf16 a[188:191], v[112:115], v[88:91], a[188:191]
    s_waitcnt lgkmcnt(1)
    buffer_store_dwordx4 v[12:15], v1, s[40:43], s81 offen offset:0 sc1
    buffer_store_dwordx4 v[20:23], v1, s[40:43], s81 offen offset:1024 sc1
    v_accvgpr_read_b32 v16, a168
    v_mfma_f32_16x16x32_bf16 a[188:191], v[116:119], v[92:95], a[188:191]
    v_accvgpr_read_b32 v12, a152
    v_accvgpr_read_b32 v13, a153
    v_accvgpr_read_b32 v14, a154
    v_accvgpr_read_b32 v15, a155
    v_accvgpr_read_b32 v17, a169
    v_mfma_f32_16x16x32_bf16 a[204:207], v[120:123], v[88:91], a[204:207]
    s_waitcnt lgkmcnt(0)
    v_accvgpr_read_b32 v18, a170
    v_accvgpr_read_b32 v19, a171
    v_accvgpr_read_b32 v20, a184
    v_accvgpr_read_b32 v21, a185
    v_accvgpr_read_b32 v22, a186
    v_mfma_f32_16x16x32_bf16 a[204:207], v[124:127], v[92:95], a[204:207]
    v_accvgpr_read_b32 v23, a187
    v_accvgpr_read_b32 v24, a200
    v_accvgpr_read_b32 v25, a201
    v_accvgpr_read_b32 v26, a202
    v_accvgpr_read_b32 v27, a203
    v_smfmac_f32_16x16x64_bf16 a[220:223], a[136:139], v[88:95], v215
    v_mul_f32 v12, v10, v12
    v_mul_f32 v13, v10, v13
    v_mul_f32 v14, v10, v14
    v_mul_f32 v15, v10, v15
    v_mul_f32 v16, v10, v16
    v_mul_f32 v17, v10, v17
    v_mul_f32 v18, v10, v18
    v_mul_f32 v19, v10, v19
    v_mul_f32 v20, v10, v20
    v_mul_f32 v21, v10, v21
    v_mul_f32 v22, v10, v22
    v_mul_f32 v23, v10, v23
    v_mul_f32 v24, v10, v24
    v_mul_f32 v25, v10, v25
    v_mul_f32 v26, v10, v26
    v_mul_f32 v27, v10, v27
    v_cmp_nge_f32 vcc, 0x71800000, v9
    v_cvt_pk_bf16_f32 v12, v12, v13
    v_cvt_pk_bf16_f32 v13, v14, v15
    v_cvt_pk_bf16_f32 v14, v16, v17
    v_cvt_pk_bf16_f32 v15, v18, v19
    v_cvt_pk_bf16_f32 v20, v20, v21
    v_cvt_pk_bf16_f32 v21, v22, v23
    v_cvt_pk_bf16_f32 v22, v24, v25
    v_cvt_pk_bf16_f32 v23, v26, v27
    s_or_b64 s[84:85], s[84:85], vcc
    buffer_store_dwordx4 v[12:15], v1, s[40:43], s81 offen offset:2048 sc1
    buffer_store_dwordx4 v[20:23], v1, s[40:43], s81 offen offset:3072 sc1
    s_nop 3
    v_accvgpr_read_b32 v9, a220
    v_accvgpr_read_b32 v10, a221
    v_add_f32 v9, v9, v10
    v_cmp_nge_f32 vcc, 0x71800000, v9
    v_rcp_f32 v10, v9
    s_nop 0
    s_or_b64 s[84:85], s[84:85], vcc
    v_mul_f32 v10, v10, v7
    s_add_u32 s72, s81, 622592
    v_accvgpr_read_b32 v12, a12
    v_accvgpr_read_b32 v13, a13
    v_accvgpr_read_b32 v14, a14
    v_accvgpr_read_b32 v15, a15
    v_accvgpr_read_b32 v16, a28
    v_accvgpr_read_b32 v17, a29
    v_accvgpr_read_b32 v18, a30
    v_accvgpr_read_b32 v19, a31
    v_pk_mul_f32 v[12:13], v[12:13], v[10:11] op_sel_hi:[1,0]
    v_pk_mul_f32 v[14:15], v[14:15], v[10:11] op_sel_hi:[1,0]
    v_pk_mul_f32 v[16:17], v[16:17], v[10:11] op_sel_hi:[1,0]
    v_pk_mul_f32 v[18:19], v[18:19], v[10:11] op_sel_hi:[1,0]
    v_cvt_pk_bf16_f32 v12, v12, v13
    v_cvt_pk_bf16_f32 v13, v14, v15
    v_cvt_pk_bf16_f32 v14, v16, v17
    v_cvt_pk_bf16_f32 v15, v18, v19
    buffer_store_dwordx4 v[12:15], v1, s[40:43], s72 offen offset:0 sc1
    v_accvgpr_read_b32 v20, a44
    v_accvgpr_read_b32 v21, a45
    v_accvgpr_read_b32 v22, a46
    v_accvgpr_read_b32 v23, a47
    v_accvgpr_read_b32 v24, a60
    v_accvgpr_read_b32 v25, a61
    v_accvgpr_read_b32 v26, a62
    v_accvgpr_read_b32 v27, a63
    v_pk_mul_f32 v[20:21], v[20:21], v[10:11] op_sel_hi:[1,0]
    v_pk_mul_f32 v[22:23], v[22:23], v[10:11] op_sel_hi:[1,0]
    v_pk_mul_f32 v[24:25], v[24:25], v[10:11] op_sel_hi:[1,0]
    v_pk_mul_f32 v[26:27], v[26:27], v[10:11] op_sel_hi:[1,0]
    v_cvt_pk_bf16_f32 v20, v20, v21
    v_cvt_pk_bf16_f32 v21, v22, v23
    v_cvt_pk_bf16_f32 v22, v24, v25
    v_cvt_pk_bf16_f32 v23, v26, v27
    buffer_store_dwordx4 v[20:23], v1, s[40:43], s72 offen offset:1024 sc1
    v_accvgpr_read_b32 v12, a156
    v_accvgpr_read_b32 v13, a157
    v_accvgpr_read_b32 v14, a158
    v_accvgpr_read_b32 v15, a159
    v_accvgpr_read_b32 v16, a172
    v_accvgpr_read_b32 v17, a173
    v_accvgpr_read_b32 v18, a174
    v_accvgpr_read_b32 v19, a175
    v_pk_mul_f32 v[12:13], v[12:13], v[10:11] op_sel_hi:[1,0]
    v_pk_mul_f32 v[14:15], v[14:15], v[10:11] op_sel_hi:[1,0]
    v_pk_mul_f32 v[16:17], v[16:17], v[10:11] op_sel_hi:[1,0]
    v_pk_mul_f32 v[18:19], v[18:19], v[10:11] op_sel_hi:[1,0]
    v_cvt_pk_bf16_f32 v12, v12, v13
    v_cvt_pk_bf16_f32 v13, v14, v15
    v_cvt_pk_bf16_f32 v14, v16, v17
    v_cvt_pk_bf16_f32 v15, v18, v19
    buffer_store_dwordx4 v[12:15], v1, s[40:43], s72 offen offset:2048 sc1
    v_accvgpr_read_b32 v20, a188
    v_accvgpr_read_b32 v21, a189
    v_accvgpr_read_b32 v22, a190
    v_accvgpr_read_b32 v23, a191
    v_accvgpr_read_b32 v24, a204
    v_accvgpr_read_b32 v25, a205
    v_accvgpr_read_b32 v26, a206
    v_accvgpr_read_b32 v27, a207
    v_pk_mul_f32 v[20:21], v[20:21], v[10:11] op_sel_hi:[1,0]
    v_pk_mul_f32 v[22:23], v[22:23], v[10:11] op_sel_hi:[1,0]
    v_pk_mul_f32 v[24:25], v[24:25], v[10:11] op_sel_hi:[1,0]
    v_pk_mul_f32 v[26:27], v[26:27], v[10:11] op_sel_hi:[1,0]
    v_cvt_pk_bf16_f32 v20, v20, v21
    v_cvt_pk_bf16_f32 v21, v22, v23
    v_cvt_pk_bf16_f32 v22, v24, v25
    v_cvt_pk_bf16_f32 v23, v26, v27
    buffer_store_dwordx4 v[20:23], v1, s[40:43], s72 offen offset:3072 sc1
    buffer_load_dword v3, v217, s[32:35], s19 offen sc1
    s_waitcnt lgkmcnt(0)
    s_barrier
    s_sub_u32 s30, s47, s75
    s_sub_u32 s31, s79, s75
    v_bfe_u32 v20, v1, 4, 4
    v_lshrrev_b32 v21, 8, v1
    s_lshl_b32 s98, s4, 4
    s_add_u32 s98, s98, 16
    v_add_u32 v22, s98, v20
    v_mul_u32_u24 v22, 144, v22
    v_add_u32 v22, s30, v22
    v_lshl_add_u32 v9, v21, 3, v22
    s_lshr_b32 s98, s73, 1
    v_add_u32 v8, s98, v9
    v_subrev_u32 v10, s98, v9
    s_sub_u32 s99, s31, s30
    v_add_u32 v24, s99, v8
    v_add_u32 v25, s99, v9
    v_add_u32 v26, s99, v10
    s_bitcmp1_b32 s4, 0
    s_cselect_b32 s99, s31, s30
    v_mul_u32_u24 v23, 144, v20
    v_lshl_add_u32 v23, v21, 3, v23
    v_add_u32 v13, s99, v23
    v_add_u32 v12, s98, v13
    v_accvgpr_read_b32 v32, a64
    v_accvgpr_read_b32 v33, a65
    v_accvgpr_read_b32 v34, a66
    v_accvgpr_read_b32 v35, a67
    v_cvt_pk_bf16_f32 v32, v32, v33
    v_cvt_pk_bf16_f32 v33, v34, v35
    ds_write_b64 v8, v[32:33] offset:0
    v_accvgpr_read_b32 v36, a68
    v_accvgpr_read_b32 v37, a69
    v_accvgpr_read_b32 v38, a70
    v_accvgpr_read_b32 v39, a71
    v_cvt_pk_bf16_f32 v36, v36, v37
    v_cvt_pk_bf16_f32 v37, v38, v39
    ds_write_b64 v8, v[36:37] offset:9216
    v_accvgpr_read_b32 v40, a72
    v_accvgpr_read_b32 v41, a73
    v_accvgpr_read_b32 v42, a74
    v_accvgpr_read_b32 v43, a75
    v_cvt_pk_bf16_f32 v40, v40, v41
    v_cvt_pk_bf16_f32 v41, v42, v43
    ds_write_b64 v24, v[40:41] offset:0
    v_accvgpr_read_b32 v44, a76
    v_accvgpr_read_b32 v45, a77
    v_accvgpr_read_b32 v46, a78
    v_accvgpr_read_b32 v47, a79
    v_cvt_pk_bf16_f32 v44, v44, v45
    v_cvt_pk_bf16_f32 v45, v46, v47
    ds_write_b64 v24, v[44:45] offset:9216
    v_accvgpr_read_b32 v32, a80
    v_accvgpr_read_b32 v33, a81
    v_accvgpr_read_b32 v34, a82
    v_accvgpr_read_b32 v35, a83
    v_cvt_pk_bf16_f32 v32, v32, v33
    v_cvt_pk_bf16_f32 v33, v34, v35
    ds_write_b64 v9, v[32:33] offset:32
    v_accvgpr_read_b32 v36, a84
    v_accvgpr_read_b32 v37, a85
    v_accvgpr_read_b32 v38, a86
    v_accvgpr_read_b32 v39, a87
    v_cvt_pk_bf16_f32 v36, v36, v37
    v_cvt_pk_bf16_f32 v37, v38, v39
    ds_write_b64 v9, v[36:37] offset:9248
    v_accvgpr_read_b32 v40, a88
    v_accvgpr_read_b32 v41, a89
    v_accvgpr_read_b32 v42, a90
    v_accvgpr_read_b32 v43, a91
    v_cvt_pk_bf16_f32 v40, v40, v41
    v_cvt_pk_bf16_f32 v41, v42, v43
    ds_write_b64 v25, v[40:41] offset:32
    v_accvgpr_read_b32 v44, a92
    v_accvgpr_read_b32 v45, a93
    v_accvgpr_read_b32 v46, a94
    v_accvgpr_read_b32 v47, a95
    v_cvt_pk_bf16_f32 v44, v44, v45
    v_cvt_pk_bf16_f32 v45, v46, v47
    ds_write_b64 v25, v[44:45] offset:9248
    v_accvgpr_read_b32 v32, a96
    v_accvgpr_read_b32 v33, a97
    v_accvgpr_read_b32 v34, a98
    v_accvgpr_read_b32 v35, a99
    v_cvt_pk_bf16_f32 v32, v32, v33
    v_cvt_pk_bf16_f32 v33, v34, v35
    ds_write_b64 v10, v[32:33] offset:64
    v_accvgpr_read_b32 v36, a100
    v_accvgpr_read_b32 v37, a101
    v_accvgpr_read_b32 v38, a102
    v_accvgpr_read_b32 v39, a103
    v_cvt_pk_bf16_f32 v36, v36, v37
    v_cvt_pk_bf16_f32 v37, v38, v39
    ds_write_b64 v10, v[36:37] offset:9280
    v_accvgpr_read_b32 v40, a104
    v_accvgpr_read_b32 v41, a105
    v_accvgpr_read_b32 v42, a106
    v_accvgpr_read_b32 v43, a107
    v_cvt_pk_bf16_f32 v40, v40, v41
    v_cvt_pk_bf16_f32 v41, v42, v43
    ds_write_b64 v26, v[40:41] offset:64
    v_accvgpr_read_b32 v44, a108
    v_accvgpr_read_b32 v45, a109
    v_accvgpr_read_b32 v46, a110
    v_accvgpr_read_b32 v47, a111
    v_cvt_pk_bf16_f32 v44, v44, v45
    v_cvt_pk_bf16_f32 v45, v46, v47
    ds_write_b64 v26, v[44:45] offset:9280
    v_mov_b32 v218, 2
    s_cmp_eq_u64 s[84:85], 0
    s_cselect_b32 s7, s74, 1073741824
    s_cmp_lg_u32 s83, 0
    s_cselect_b32 s7, s74, s7
    s_waitcnt vmcnt(1)
    buffer_store_dword v218, v216, s[32:35], s7 offen sc1
    s_xor_b32 s21, s3, 2
    s_lshl2_add_u32 s21, s21, s4
    s_mul_i32 s21, s21, 36864
    s_add_u32 s21, s21, s28
    s_mov_b32 m0, s46
    s_nop 0
    buffer_load_dwordx4 v1, s[56:59], s21 offen sc1 lds
    v_accvgpr_read_b32 v32, a112
    v_accvgpr_read_b32 v33, a113
    v_accvgpr_read_b32 v34, a114
    v_accvgpr_read_b32 v35, a115
    v_cvt_pk_bf16_f32 v32, v32, v33
    v_cvt_pk_bf16_f32 v33, v34, v35
    ds_write_b64 v9, v[32:33] offset:96
    v_accvgpr_read_b32 v36, a116
    v_accvgpr_read_b32 v37, a117
    v_accvgpr_read_b32 v38, a118
    v_accvgpr_read_b32 v39, a119
    v_cvt_pk_bf16_f32 v36, v36, v37
    buffer_load_dwordx4 v1, s[56:59], s21 offen offset:1024 sc1 lds
    v_cvt_pk_bf16_f32 v37, v38, v39
    ds_write_b64 v9, v[36:37] offset:9312
    v_accvgpr_read_b32 v40, a120
    v_accvgpr_read_b32 v41, a121
    v_accvgpr_read_b32 v42, a122
    v_accvgpr_read_b32 v43, a123
    v_cvt_pk_bf16_f32 v40, v40, v41
    v_cvt_pk_bf16_f32 v41, v42, v43
    ds_write_b64 v25, v[40:41] offset:96
    v_accvgpr_read_b32 v44, a124
    v_accvgpr_read_b32 v45, a125
    v_accvgpr_read_b32 v46, a126
    buffer_load_dwordx4 v1, s[56:59], s21 offen offset:2048 sc1 lds
    v_accvgpr_read_b32 v47, a127
    v_cvt_pk_bf16_f32 v44, v44, v45
    v_cvt_pk_bf16_f32 v45, v46, v47
    s_waitcnt lgkmcnt(3)
    ds_write_b64 v25, v[44:45] offset:9312
    v_accvgpr_read_b32 v32, a128
    v_accvgpr_read_b32 v33, a129
    v_accvgpr_read_b32 v34, a130
    v_accvgpr_read_b32 v35, a131
    v_cvt_pk_bf16_f32 v32, v32, v33
    v_cvt_pk_bf16_f32 v33, v34, v35
    ds_write_b64 v12, v[32:33] offset:0
    v_accvgpr_read_b32 v36, a132
    buffer_load_dwordx4 v1, s[56:59], s21 offen offset:3072 sc1 lds
    v_accvgpr_read_b32 v37, a133
    v_accvgpr_read_b32 v38, a134
    v_accvgpr_read_b32 v39, a135
    v_cvt_pk_bf16_f32 v36, v36, v37
    v_cvt_pk_bf16_f32 v37, v38, v39
    s_cmp_eq_u32 s73, 0
    s_cselect_b64 exec, -1, 0
    ds_write_b64 v13, v[36:37] offset:32
    s_mov_b64 exec, -1
    s_cmp_lg_u64 s[84:85], 0
    s_cselect_b32 s7, 1, 0
    v_mov_b32 v20, s7
    s_lshl2_add_u32 s98, s4, s30
    s_add_u32 s21, s21, 4096
    s_add_u32 m0, s46, 4096
    s_nop 0
    buffer_load_dwordx4 v1, s[56:59], s21 offen sc1 lds
    v_mov_b32 v21, s98
    ds_write_b32 v21, v20 offset:20736
    v_mov_b32 v21, s30
    s_and_b32 s98, s4, 1
    s_lshl_b32 s98, s98, 6
    v_lshrrev_b32 v14, 4, v1
    v_add_u32 v14, s98, v14
    s_sub_u32 s7, 15, s6
    s_cmp_lt_u32 s4, 2
    s_cselect_b32 s7, s6, s7
    s_cselect_b32 s99, s30, s31
    s_lshl_b32 s7, s7, 7
    buffer_load_dwordx4 v1, s[56:59], s21 offen offset:1024 sc1 lds
    v_add_u32 v2, 2, v14
    v_mul_u32_u24 v2, 144, v2
    v_add_u32 v2, s99, v2
    v_add_u32 v14, s7, v14
    v_lshrrev_b32 v15, 4, v14
    s_mov_b32 s98, 155648
    v_mul_lo_u32 v15, v15, s98
    v_and_b32 v23, 0xf0, v1
    v_add_u32 v15, v15, v23
    s_lshl3_add_u32 s98, s6, s62
    s_mul_i32 s98, s98, 155648
    v_add_u32 v4, s98, v1
    buffer_load_dwordx4 v1, s[56:59], s21 offen offset:2048 sc1 lds
    s_sub_u32 s98, 15, s6
    s_lshl3_add_u32 s98, s98, s62
    s_mul_i32 s98, s98, 155648
    v_add_u32 v5, s98, v1
    v_mov_b32 v19, v217
    v_subrev_u32 v23, s75, v1
    v_add_u32 v11, s44, v23
    v_add_u32 v12, s45, v23
    v_add_u32 v13, s46, v23
    v_add_u32 v6, s47, v23
    v_add_u32 v7, s79, v23
    s_mov_b32 s98, 0xbfb8aa3b
    s_mov_b32 s99, 0x3eae1a93
    s_waitcnt vmcnt(8) lgkmcnt(0)
    s_barrier
    ds_read_b128 v[24:27], v21 offset:20736
    ds_read_b128 v[32:35], v2 offset:2016
    ds_read_b128 v[36:39], v2 offset:2032
    ds_read_b128 v[40:43], v2 offset:2048
    ds_read_b128 v[44:47], v2 offset:1728
    ds_read_b128 v[48:51], v2 offset:1744
    ds_read_b128 v[52:55], v2 offset:1760
    s_waitcnt lgkmcnt(6)
    v_or3_b32 v24, v24, v25, v26
    v_or_b32 v24, v24, v27
    s_nop 0
    v_readfirstlane_b32 s7, v24
    s_nop 1
    s_andn2_b32 s7, s7, s83
    s_cbranch_scc1 K1_REDO
    buffer_load_dword v28, v29, s[32:35], s92 offen sc1
    v_cmp_gt_u32 vcc, 1, v3
    s_nop 1
    s_and_b64 vcc, vcc, exec
    s_cbranch_scc1 SPIN_SHORT
BACK_SHORT:
    buffer_load_dwordx4 a[0:3], v4, s[40:43], s63 offen offset:0 sc1
    ds_read_b128 v[128:131], v2 offset:2096
    ds_read_b128 v[132:135], v2 offset:2112
    ds_read_b128 v[136:139], v2 offset:2128
    ds_read_b128 v[56:59], v2 offset:1440
    ds_read_b128 v[60:63], v2 offset:1456
    ds_read_b128 v[64:67], v2 offset:1472
    ds_read_b128 v[68:71], v2 offset:1152
    ds_read_b128 v[72:75], v2 offset:1168
    ds_read_b128 v[76:79], v2 offset:1184
    s_waitcnt lgkmcnt(8)
    v_dot2_f32_bf16 v140, v128, v32, 0
    v_dot2_f32_bf16 v141, v128, v44, 0
    buffer_load_dwordx4 a[8:11], v4, s[40:43], s63 offen offset:1024 sc1
    ds_read_b128 v[80:83], v2 offset:864
    s_waitcnt lgkmcnt(6)
    v_dot2_f32_bf16 v142, v128, v56, 0
    s_waitcnt lgkmcnt(3)
    v_dot2_f32_bf16 v143, v128, v68, 0
    ds_read_b128 v[84:87], v2 offset:880
    v_dot2c_f32_bf16 v140, v129, v33
    v_dot2c_f32_bf16 v141, v129, v45
    ds_read_b128 v[88:91], v2 offset:896
    v_dot2c_f32_bf16 v142, v129, v57
    v_dot2c_f32_bf16 v143, v129, v69
    ds_read_b128 v[92:95], v2 offset:576
    v_dot2c_f32_bf16 v140, v130, v34
    buffer_load_dwordx4 a[16:19], v4, s[40:43], s63 offen offset:2048 sc1
    v_dot2c_f32_bf16 v141, v130, v46
    ds_read_b128 v[96:99], v2 offset:592
    v_dot2c_f32_bf16 v142, v130, v58
    v_dot2c_f32_bf16 v143, v130, v70
    ds_read_b128 v[100:103], v2 offset:608
    v_dot2c_f32_bf16 v140, v131, v35
    v_dot2c_f32_bf16 v141, v131, v47
    ds_read_b128 v[104:107], v2 offset:288
    v_dot2c_f32_bf16 v142, v131, v59
    v_dot2c_f32_bf16 v143, v131, v71
    ds_read_b128 v[108:111], v2 offset:304
    v_dot2c_f32_bf16 v140, v132, v36
    buffer_load_dwordx4 a[24:27], v4, s[40:43], s63 offen offset:3072 sc1
    v_dot2c_f32_bf16 v141, v132, v48
    ds_read_b128 v[112:115], v2 offset:320
    v_dot2c_f32_bf16 v142, v132, v60
    s_waitcnt lgkmcnt(8)
    v_dot2c_f32_bf16 v143, v132, v72
    ds_read_b128 v[116:119], v2 offset:0
    v_dot2c_f32_bf16 v140, v133, v37
    v_dot2c_f32_bf16 v141, v133, v49
    ds_read_b128 v[120:123], v2 offset:16
    v_dot2c_f32_bf16 v142, v133, v61
    v_dot2c_f32_bf16 v143, v133, v73
    ds_read_b128 v[124:127], v2 offset:32
    s_xor_b32 s63, s63, 4096
    buffer_load_dwordx4 a[32:35], v4, s[40:43], s63 offen offset:0 sc1
    v_dot2c_f32_bf16 v140, v134, v38
    v_dot2c_f32_bf16 v141, v134, v50
    v_dot2c_f32_bf16 v142, v134, v62
    v_dot2c_f32_bf16 v143, v134, v74
    v_dot2c_f32_bf16 v140, v135, v39
    v_dot2c_f32_bf16 v141, v135, v51
    v_dot2c_f32_bf16 v142, v135, v63
    v_dot2c_f32_bf16 v143, v135, v75
    v_dot2c_f32_bf16 v140, v136, v40
    v_dot2c_f32_bf16 v141, v136, v52
    v_dot2c_f32_bf16 v142, v136, v64
    buffer_load_dwordx4 a[40:43], v4, s[40:43], s63 offen offset:1024 sc1
    v_dot2c_f32_bf16 v143, v136, v76
    v_dot2_f32_bf16 v144, v128, v80, 0
    s_waitcnt lgkmcnt(4)
    v_dot2_f32_bf16 v145, v128, v92, 0
    ds_read_b128 v[32:35], v2 offset:2064
    v_dot2_f32_bf16 v146, v128, v104, 0
    s_waitcnt lgkmcnt(3)
    v_dot2_f32_bf16 v147, v128, v116, 0
    ds_read_b128 v[36:39], v2 offset:2080
    v_dot2c_f32_bf16 v144, v129, v81
    v_dot2c_f32_bf16 v145, v129, v93
    ds_read_b128 v[44:47], v2 offset:1776
    v_dot2c_f32_bf16 v146, v129, v105
    v_dot2c_f32_bf16 v147, v129, v117
    buffer_load_dwordx4 a[48:51], v4, s[40:43], s63 offen offset:2048 sc1
    ds_read_b128 v[48:51], v2 offset:1792
    v_dot2c_f32_bf16 v144, v130, v82
    v_dot2c_f32_bf16 v145, v130, v94
    ds_read_b128 v[56:59], v2 offset:1488
    v_dot2c_f32_bf16 v146, v130, v106
    v_dot2c_f32_bf16 v147, v130, v118
    ds_read_b128 v[60:63], v2 offset:1504
    v_dot2c_f32_bf16 v144, v131, v83
    v_dot2c_f32_bf16 v145, v131, v95
    ds_read_b128 v[68:71], v2 offset:1200
    v_dot2c_f32_bf16 v146, v131, v107
    buffer_load_dwordx4 a[56:59], v4, s[40:43], s63 offen offset:3072 sc1
    v_dot2c_f32_bf16 v147, v131, v119
    ds_read_b128 v[72:75], v2 offset:1216
    v_dot2c_f32_bf16 v144, v132, v84
    v_dot2c_f32_bf16 v145, v132, v96
    v_dot2c_f32_bf16 v146, v132, v108
    s_waitcnt lgkmcnt(8)
    v_dot2c_f32_bf16 v147, v132, v120
    v_dot2c_f32_bf16 v144, v133, v85
    v_dot2c_f32_bf16 v145, v133, v97
    v_dot2c_f32_bf16 v146, v133, v109
    v_dot2c_f32_bf16 v147, v133, v121
    v_dot2c_f32_bf16 v144, v134, v86
    s_xor_b32 s63, s63, 12288
    buffer_load_dwordx4 a[64:67], v4, s[40:43], s63 offen offset:0 sc1
    v_dot2c_f32_bf16 v145, v134, v98
    v_dot2c_f32_bf16 v146, v134, v110
    v_dot2c_f32_bf16 v147, v134, v122
    v_dot2c_f32_bf16 v144, v135, v87
    v_dot2c_f32_bf16 v145, v135, v99
    v_dot2c_f32_bf16 v146, v135, v111
    v_dot2c_f32_bf16 v147, v135, v123
    v_dot2c_f32_bf16 v144, v136, v88
    v_dot2c_f32_bf16 v145, v136, v100
    v_dot2c_f32_bf16 v146, v136, v112
    v_dot2c_f32_bf16 v147, v136, v124
    v_lshlrev_b32 v8, 16, v138
    buffer_load_dwordx4 a[72:75], v4, s[40:43], s63 offen offset:1024 sc1
    v_mul_f32 v8, s98, v8
    v_exp_f32 v8, v8
    s_or_b32 s7, s6, s4
    s_cbranch_scc0 K1_WMASK
K1_WMASK_BACK:
    v_max3_f32 v9, v140, v141, v142
    v_max3_f32 v10, v143, v144, v145
    v_max3_f32 v9, v9, v146, v147
    v_max_f32 v9, v9, v10
    v_mul_f32 v9, s99, v9
    v_add_f32 v8, 1.0, v8
    buffer_load_dwordx4 a[80:83], v4, s[40:43], s63 offen offset:2048 sc1
    v_fma_f32 v140, v140, s99, -v9
    ds_read_b128 v[80:83], v2 offset:912
    v_fma_f32 v141, v141, s99, -v9
    ds_read_b128 v[84:87], v2 offset:928
    v_fma_f32 v142, v142, s99, -v9
    ds_read_b128 v[92:95], v2 offset:624
    v_fma_f32 v143, v143, s99, -v9
    ds_read_b128 v[96:99], v2 offset:640
    v_fma_f32 v144, v144, s99, -v9
    ds_read_b128 v[104:107], v2 offset:336
    v_fma_f32 v145, v145, s99, -v9
    buffer_load_dwordx4 a[88:91], v4, s[40:43], s63 offen offset:3072 sc1
    s_xor_b32 s63, s63, 4096
    ds_read_b128 v[108:111], v2 offset:352
    v_fma_f32 v146, v146, s99, -v9
    ds_read_b128 v[116:119], v2 offset:48
    v_fma_f32 v147, v147, s99, -v9
    s_waitcnt lgkmcnt(7)
    ds_read_b128 v[120:123], v2 offset:64
    v_exp_f32 v140, v140
    v_exp_f32 v141, v141
    v_exp_f32 v142, v142
    v_exp_f32 v143, v143
    v_exp_f32 v144, v144
    v_exp_f32 v145, v145
    v_exp_f32 v146, v146
    buffer_load_dword v3, v217, s[32:35], s19 offen sc1
    buffer_load_dwordx4 a[96:99], v4, s[40:43], s63 offen offset:0 sc1
    v_exp_f32 v147, v147
    v_add_f32 v10, v140, v141
    v_add_f32 v10, v10, v142
    v_add_f32 v10, v10, v143
    v_add_f32 v10, v10, v144
    v_add_f32 v10, v10, v145
    buffer_load_dwordx4 a[104:107], v4, s[40:43], s63 offen offset:1024 sc1
    v_add_f32 v10, v10, v146
    v_add_f32 v10, v10, v147
    v_mul_f32 v10, v10, v8
    v_rcp_f32 v10, v10
    s_nop 0
    v_mul_f32 v140, v140, v10
    v_mul_f32 v141, v141, v10
    v_mul_f32 v142, v142, v10
    buffer_load_dwordx4 a[112:115], v4, s[40:43], s63 offen offset:2048 sc1
    v_mul_f32 v143, v143, v10
    v_mul_f32 v144, v144, v10
    v_mul_f32 v145, v145, v10
    v_mul_f32 v146, v146, v10
    v_mul_f32 v147, v147, v10
    v_cvt_pk_bf16_f32 v148, 0, v140
    buffer_load_dwordx4 a[120:123], v4, s[40:43], s63 offen offset:3072 sc1
    v_cvt_pk_bf16_f32 v149, 0, v141
    v_cvt_pk_bf16_f32 v150, 0, v142
    v_cvt_pk_bf16_f32 v151, 0, v143
    v_cvt_pk_bf16_f32 v152, 0, v144
    v_cvt_pk_bf16_f32 v153, 0, v145
    v_cvt_pk_bf16_f32 v154, 0, v146
    v_cvt_pk_bf16_f32 v155, 0, v147
    s_xor_b32 s63, s63, 28672
    buffer_load_dwordx4 a[128:131], v4, s[40:43], s63 offen offset:0 sc1
    v_lshrrev_b32 v140, 16, v148
    v_lshrrev_b32 v141, 16, v149
    v_lshrrev_b32 v142, 16, v150
    v_lshrrev_b32 v143, 16, v151
    v_lshrrev_b32 v144, 16, v152
    v_lshrrev_b32 v145, 16, v153
    v_lshrrev_b32 v146, 16, v154
    buffer_load_dwordx4 a[136:139], v4, s[40:43], s63 offen offset:1024 sc1
    v_lshrrev_b32 v147, 16, v155
    v_dot2_f32_bf16 v128, v42, v140, 0
    v_dot2_f32_bf16 v129, v42, v148, 0
    v_dot2_f32_bf16 v130, v43, v140, 0
    v_dot2_f32_bf16 v131, v43, v148, 0
    v_dot2_f32_bf16 v132, v32, v140, 0
    buffer_load_dwordx4 a[144:147], v4, s[40:43], s63 offen offset:2048 sc1
    v_dot2_f32_bf16 v133, v32, v148, 0
    v_dot2_f32_bf16 v134, v33, v140, 0
    v_dot2_f32_bf16 v135, v33, v148, 0
    v_dot2_f32_bf16 v136, v34, v140, 0
    v_dot2_f32_bf16 v137, v34, v148, 0
    v_dot2_f32_bf16 v138, v35, v140, 0
    v_dot2_f32_bf16 v139, v35, v148, 0
    buffer_load_dwordx4 a[152:155], v4, s[40:43], s63 offen offset:3072 sc1
    s_xor_b32 s63, s63, 4096
    v_dot2_f32_bf16 v156, v36, v140, 0
    v_dot2_f32_bf16 v157, v36, v148, 0
    v_dot2_f32_bf16 v158, v37, v140, 0
    v_dot2_f32_bf16 v159, v37, v148, 0
    v_dot2_f32_bf16 v17, v38, v140, 0
    v_dot2_f32_bf16 v18, v38, v148, 0
    v_dot2c_f32_bf16 v128, v54, v141
    s_waitcnt vmcnt(8)
    v_cmp_gt_u32 vcc, 2, v3
    s_nop 1
    s_and_b64 vcc, vcc, exec
    s_cbranch_scc1 SPIN_CTX
BACK_CTX:
    buffer_load_dwordx4 a[4:7], v5, s[40:43], s20 offen offset:0 sc1
    v_dot2c_f32_bf16 v129, v54, v149
    v_dot2c_f32_bf16 v130, v55, v141
    v_dot2c_f32_bf16 v131, v55, v149
    v_dot2c_f32_bf16 v132, v44, v141
    v_dot2c_f32_bf16 v133, v44, v149
    v_dot2c_f32_bf16 v134, v45, v141
    v_dot2c_f32_bf16 v135, v45, v149
    v_dot2c_f32_bf16 v136, v46, v141
    v_dot2c_f32_bf16 v137, v46, v149
    v_dot2c_f32_bf16 v138, v47, v141
    v_dot2c_f32_bf16 v139, v47, v149
    v_dot2c_f32_bf16 v156, v48, v141
    v_dot2c_f32_bf16 v157, v48, v149
    buffer_load_dwordx4 a[12:15], v5, s[40:43], s20 offen offset:1024 sc1
    v_dot2c_f32_bf16 v158, v49, v141
    v_dot2c_f32_bf16 v159, v49, v149
    v_dot2c_f32_bf16 v17, v50, v141
    v_dot2c_f32_bf16 v18, v50, v149
    v_dot2c_f32_bf16 v128, v66, v142
    v_dot2c_f32_bf16 v129, v66, v150
    v_dot2c_f32_bf16 v130, v67, v142
    v_dot2c_f32_bf16 v131, v67, v150
    v_dot2c_f32_bf16 v132, v56, v142
    v_dot2c_f32_bf16 v133, v56, v150
    v_dot2c_f32_bf16 v134, v57, v142
    v_dot2c_f32_bf16 v135, v57, v150
    v_dot2c_f32_bf16 v136, v58, v142
    v_dot2c_f32_bf16 v137, v58, v150
    buffer_load_dwordx4 a[20:23], v5, s[40:43], s20 offen offset:2048 sc1
    v_dot2c_f32_bf16 v138, v59, v142
    v_dot2c_f32_bf16 v139, v59, v150
    v_dot2c_f32_bf16 v156, v60, v142
    v_dot2c_f32_bf16 v157, v60, v150
    v_dot2c_f32_bf16 v158, v61, v142
    v_dot2c_f32_bf16 v159, v61, v150
    v_dot2c_f32_bf16 v17, v62, v142
    v_dot2c_f32_bf16 v18, v62, v150
    v_dot2c_f32_bf16 v128, v78, v143
    v_dot2c_f32_bf16 v129, v78, v151
    v_dot2c_f32_bf16 v130, v79, v143
    v_dot2c_f32_bf16 v131, v79, v151
    v_dot2c_f32_bf16 v132, v68, v143
    v_dot2c_f32_bf16 v133, v68, v151
    buffer_load_dwordx4 a[28:31], v5, s[40:43], s20 offen offset:3072 sc1
    v_dot2c_f32_bf16 v134, v69, v143
    v_dot2c_f32_bf16 v135, v69, v151
    v_dot2c_f32_bf16 v136, v70, v143
    v_dot2c_f32_bf16 v137, v70, v151
    v_dot2c_f32_bf16 v138, v71, v143
    v_dot2c_f32_bf16 v139, v71, v151
    v_dot2c_f32_bf16 v156, v72, v143
    v_dot2c_f32_bf16 v157, v72, v151
    v_dot2c_f32_bf16 v158, v73, v143
    v_dot2c_f32_bf16 v159, v73, v151
    v_dot2c_f32_bf16 v17, v74, v143
    v_dot2c_f32_bf16 v18, v74, v151
    v_dot2c_f32_bf16 v128, v90, v144
    v_dot2c_f32_bf16 v129, v90, v152
    s_xor_b32 s20, s20, 4096
    buffer_load_dwordx4 a[36:39], v5, s[40:43], s20 offen offset:0 sc1
    v_dot2c_f32_bf16 v130, v91, v144
    v_dot2c_f32_bf16 v131, v91, v152
    s_waitcnt lgkmcnt(0)
    v_dot2c_f32_bf16 v132, v80, v144
    v_dot2c_f32_bf16 v133, v80, v152
    v_dot2c_f32_bf16 v134, v81, v144
    v_dot2c_f32_bf16 v135, v81, v152
    v_dot2c_f32_bf16 v136, v82, v144
    v_dot2c_f32_bf16 v137, v82, v152
    v_dot2c_f32_bf16 v138, v83, v144
    v_dot2c_f32_bf16 v139, v83, v152
    v_dot2c_f32_bf16 v156, v84, v144
    v_dot2c_f32_bf16 v157, v84, v152
    v_dot2c_f32_bf16 v158, v85, v144
    buffer_load_dwordx4 a[44:47], v5, s[40:43], s20 offen offset:1024 sc1
    v_dot2c_f32_bf16 v159, v85, v152
    v_dot2c_f32_bf16 v17, v86, v144
    v_dot2c_f32_bf16 v18, v86, v152
    v_dot2c_f32_bf16 v128, v102, v145
    v_dot2c_f32_bf16 v129, v102, v153
    v_dot2c_f32_bf16 v130, v103, v145
    v_dot2c_f32_bf16 v131, v103, v153
    v_dot2c_f32_bf16 v132, v92, v145
    v_dot2c_f32_bf16 v133, v92, v153
    v_dot2c_f32_bf16 v134, v93, v145
    v_dot2c_f32_bf16 v135, v93, v153
    v_dot2c_f32_bf16 v136, v94, v145
    v_dot2c_f32_bf16 v137, v94, v153
    v_dot2c_f32_bf16 v138, v95, v145
    buffer_load_dwordx4 a[52:55], v5, s[40:43], s20 offen offset:2048 sc1
    v_dot2c_f32_bf16 v139, v95, v153
    v_dot2c_f32_bf16 v156, v96, v145
    v_dot2c_f32_bf16 v157, v96, v153
    v_dot2c_f32_bf16 v158, v97, v145
    v_dot2c_f32_bf16 v159, v97, v153
    v_dot2c_f32_bf16 v17, v98, v145
    v_dot2c_f32_bf16 v18, v98, v153
    v_dot2c_f32_bf16 v128, v114, v146
    v_dot2c_f32_bf16 v129, v114, v154
    v_dot2c_f32_bf16 v130, v115, v146
    v_dot2c_f32_bf16 v131, v115, v154
    v_dot2c_f32_bf16 v132, v104, v146
    v_dot2c_f32_bf16 v133, v104, v154
    v_dot2c_f32_bf16 v134, v105, v146
    buffer_load_dwordx4 a[60:63], v5, s[40:43], s20 offen offset:3072 sc1
    s_xor_b32 s20, s20, 12288
    v_dot2c_f32_bf16 v135, v105, v154
    v_dot2c_f32_bf16 v136, v106, v146
    v_dot2c_f32_bf16 v137, v106, v154
    v_dot2c_f32_bf16 v138, v107, v146
    v_dot2c_f32_bf16 v139, v107, v154
    v_dot2c_f32_bf16 v156, v108, v146
    v_dot2c_f32_bf16 v157, v108, v154
    v_dot2c_f32_bf16 v158, v109, v146
    v_dot2c_f32_bf16 v159, v109, v154
    v_dot2c_f32_bf16 v17, v110, v146
    v_dot2c_f32_bf16 v18, v110, v154
    v_dot2c_f32_bf16 v128, v126, v147
    v_dot2c_f32_bf16 v129, v126, v155
    v_dot2c_f32_bf16 v130, v127, v147
    v_dot2c_f32_bf16 v131, v127, v155
    v_dot2c_f32_bf16 v132, v116, v147
    v_dot2c_f32_bf16 v133, v116, v155
    v_dot2c_f32_bf16 v134, v117, v147
    v_dot2c_f32_bf16 v135, v117, v155
    v_dot2c_f32_bf16 v136, v118, v147
    v_dot2c_f32_bf16 v137, v118, v155
    v_dot2c_f32_bf16 v138, v119, v147
    v_dot2c_f32_bf16 v139, v119, v155
    v_dot2c_f32_bf16 v156, v120, v147
    v_dot2c_f32_bf16 v157, v120, v155
    v_dot2c_f32_bf16 v158, v121, v147
    v_dot2c_f32_bf16 v159, v121, v155
    v_dot2c_f32_bf16 v17, v122, v147
    v_dot2c_f32_bf16 v18, v122, v155
    v_mov_b32 v89, 0
    v_mov_b32 v90, 0
    v_mov_b32 v91, 0
    v_cvt_pk_bf16_f32 v80, v128, v129
    v_cvt_pk_bf16_f32 v81, v130, v131
    v_cvt_pk_bf16_f32 v82, v132, v133
    v_cvt_pk_bf16_f32 v83, v134, v135
    v_cvt_pk_bf16_f32 v84, v136, v137
    v_cvt_pk_bf16_f32 v85, v138, v139
    v_cvt_pk_bf16_f32 v86, v156, v157
    v_cvt_pk_bf16_f32 v87, v158, v159
    v_cvt_pk_bf16_f32 v88, v17, v18
    v_cmp_gt_u32 vcc, 1, v28
    s_nop 1
    s_and_b64 vcc, vcc, exec
    s_cbranch_scc1 SPIN_ALL
BACK_ALL:
    s_waitcnt vmcnt(4)
    s_barrier
    ds_read_b128 v[104:107], v11 offset:0
    ds_read_b128 v[108:111], v11 offset:8192
    ds_read_b128 v[112:115], v11 offset:16384
    ds_read_b128 v[116:119], v11 offset:24576
    s_waitcnt lgkmcnt(3)
    v_mfma_f32_16x16x32_bf16 v[176:179], v[104:107], a[0:3], 0
    s_lshl3_add_u32 s98, 1, s5
    ds_read_b128 v[120:123], v11 offset:1024
    ds_read_b128 v[124:127], v11 offset:9216
    s_waitcnt lgkmcnt(4)
    v_mfma_f32_16x16x32_bf16 v[176:179], v[108:111], a[8:11], v[176:179]
    s_and_b32 s98, s98, 31
    buffer_load_dwordx4 a[68:71], v5, s[40:43], s20 offen offset:0 sc1
    s_waitcnt lgkmcnt(3)
    v_mfma_f32_16x16x32_bf16 v[176:179], v[112:115], a[16:19], v[176:179]
    s_lshl_b32 s8, s6, 5
    ds_read_b128 v[128:131], v11 offset:17408
    ds_read_b128 v[132:135], v11 offset:25600
    s_waitcnt lgkmcnt(4)
    v_mfma_f32_16x16x32_bf16 v[176:179], v[116:119], a[24:27], v[176:179]
    s_add_u32 s98, s98, s8
    ds_read_b128 v[136:139], v11 offset:2048
    v_mfma_f32_16x16x32_bf16 v[180:183], v[104:107], a[4:7], 0
    s_mul_i32 s98, s98, 3
    buffer_load_dwordx4 a[76:79], v5, s[40:43], s20 offen offset:1024 sc1
    v_mfma_f32_16x16x32_bf16 v[180:183], v[108:111], a[12:15], v[180:183]
    s_sub_u32 s98, s98, 1
    ds_read_b128 v[140:143], v11 offset:10240
    ds_read_b128 v[144:147], v11 offset:18432
    v_mfma_f32_16x16x32_bf16 v[180:183], v[112:115], a[20:23], v[180:183]
    s_add_u32 s98, s98, 3
    ds_read_b128 v[148:151], v11 offset:26624
    v_mfma_f32_16x16x32_bf16 v[180:183], v[116:119], a[28:31], v[180:183]
    s_lshl2_add_u32 s98, s98, s4
    ds_read_b128 v[104:107], v11 offset:3072
    s_waitcnt lgkmcnt(5)
    v_mfma_f32_16x16x32_bf16 v[184:187], v[120:123], a[0:3], 0
    s_mul_i32 s8, s98, 3072
    buffer_load_dwordx4 a[84:87], v5, s[40:43], s20 offen offset:2048 sc1
    v_mfma_f32_16x16x32_bf16 v[184:187], v[124:127], a[8:11], v[184:187]
    s_lshl3_add_u32 s98, 2, s5
    ds_read_b128 v[108:111], v11 offset:11264
    ds_read_b128 v[112:115], v11 offset:19456
    v_mfma_f32_16x16x32_bf16 v[184:187], v[128:131], a[16:19], v[184:187]
    s_and_b32 s98, s98, 31
    ds_read_b128 v[116:119], v11 offset:27648
    v_mfma_f32_16x16x32_bf16 v[184:187], v[132:135], a[24:27], v[184:187]
    s_lshl_b32 s9, s6, 5
    v_mfma_f32_16x16x32_bf16 v[188:191], v[120:123], a[4:7], 0
    s_add_u32 s98, s98, s9
    buffer_load_dwordx4 a[92:95], v5, s[40:43], s20 offen offset:3072 sc1
    v_mfma_f32_16x16x32_bf16 v[188:191], v[124:127], a[12:15], v[188:191]
    s_xor_b32 s20, s20, 4096
    ds_read_b128 v[120:123], v11 offset:4096
    ds_read_b128 v[124:127], v11 offset:12288
    v_mfma_f32_16x16x32_bf16 v[188:191], v[128:131], a[20:23], v[188:191]
    s_mul_i32 s98, s98, 3
    ds_read_b128 v[128:131], v11 offset:20480
    v_mfma_f32_16x16x32_bf16 v[188:191], v[132:135], a[28:31], v[188:191]
    s_sub_u32 s98, s98, 2
    ds_read_b128 v[132:135], v11 offset:28672
    s_waitcnt lgkmcnt(4)
    v_mfma_f32_16x16x32_bf16 v[192:195], v[136:139], a[0:3], 0
    s_add_u32 s98, s98, 3
    buffer_store_dwordx4 v[80:83], v15, s[40:43], s71 offen offset:0 sc1
    v_mfma_f32_16x16x32_bf16 v[192:195], v[140:143], a[8:11], v[192:195]
    s_lshl2_add_u32 s98, s98, s4
    v_mfma_f32_16x16x32_bf16 v[192:195], v[144:147], a[16:19], v[192:195]
    s_mul_i32 s9, s98, 3072
    v_mfma_f32_16x16x32_bf16 v[192:195], v[148:151], a[24:27], v[192:195]
    s_lshl3_add_u32 s98, 3, s5
    v_mfma_f32_16x16x32_bf16 v[196:199], v[136:139], a[4:7], 0
    s_and_b32 s98, s98, 31
    ds_read_b128 v[136:139], v11 offset:5120
    v_mfma_f32_16x16x32_bf16 v[196:199], v[140:143], a[12:15], v[196:199]
    s_lshl_b32 s10, s6, 5
    buffer_store_dwordx4 v[84:87], v15, s[40:43], s71 offen offset:256 sc1
    v_mfma_f32_16x16x32_bf16 v[196:199], v[144:147], a[20:23], v[196:199]
    s_add_u32 s98, s98, s10
    ds_read_b128 v[140:143], v11 offset:13312
    ds_read_b128 v[144:147], v11 offset:21504
    v_mfma_f32_16x16x32_bf16 v[196:199], v[148:151], a[28:31], v[196:199]
    s_mul_i32 s98, s98, 3
    ds_read_b128 v[148:151], v11 offset:29696
    v_mfma_f32_16x16x32_bf16 v[200:203], v[104:107], a[0:3], 0
    s_sub_u32 s98, s98, 3
    v_mfma_f32_16x16x32_bf16 v[200:203], v[108:111], a[8:11], v[200:203]
    s_add_u32 s98, s98, 3
    buffer_store_dwordx4 v[88:91], v15, s[40:43], s71 offen offset:512 sc1
    v_mfma_f32_16x16x32_bf16 v[200:203], v[112:115], a[16:19], v[200:203]
    s_xor_b32 s21, s3, 3
    v_mfma_f32_16x16x32_bf16 v[200:203], v[116:119], a[24:27], v[200:203]
    s_lshl2_add_u32 s21, s21, s4
    v_mfma_f32_16x16x32_bf16 v[204:207], v[104:107], a[4:7], 0
    s_mul_i32 s21, s21, 36864
    ds_read_b128 v[104:107], v11 offset:6144
    v_mfma_f32_16x16x32_bf16 v[204:207], v[108:111], a[12:15], v[204:207]
    s_add_u32 s21, s21, s28
    s_mov_b32 m0, s47
    ds_read_b128 v[108:111], v11 offset:14336
    v_mfma_f32_16x16x32_bf16 v[204:207], v[112:115], a[20:23], v[204:207]
    s_lshl2_add_u32 s98, s98, s4
    buffer_load_dwordx4 v1, s[56:59], s21 offen sc1 lds
    v_mfma_f32_16x16x32_bf16 v[204:207], v[116:119], a[28:31], v[204:207]
    s_mul_i32 s10, s98, 3072
    ds_read_b128 v[112:115], v11 offset:22528
    ds_read_b128 v[116:119], v11 offset:30720
    s_waitcnt lgkmcnt(4)
    v_mfma_f32_16x16x32_bf16 v[208:211], v[120:123], a[0:3], 0
    s_sub_u32 s99, s4, s61
    v_mfma_f32_16x16x32_bf16 v[208:211], v[124:127], a[8:11], v[208:211]
    s_and_b32 s99, s99, 3
    buffer_load_dwordx4 v1, s[56:59], s21 offen offset:1024 sc1 lds
    v_mfma_f32_16x16x32_bf16 v[208:211], v[128:131], a[16:19], v[208:211]
    s_lshl3_add_u32 s98, s99, s5
    v_mfma_f32_16x16x32_bf16 v[208:211], v[132:135], a[24:27], v[208:211]
    s_and_b32 s98, s98, 31
    v_mfma_f32_16x16x32_bf16 v[212:215], v[120:123], a[4:7], 0
    s_lshl_b32 s11, s6, 5
    ds_read_b128 v[120:123], v12 offset:0
    v_mfma_f32_16x16x32_bf16 v[212:215], v[124:127], a[12:15], v[212:215]
    s_add_u32 s98, s98, s11
    buffer_load_dwordx4 v1, s[56:59], s21 offen offset:2048 sc1 lds
    v_mfma_f32_16x16x32_bf16 v[212:215], v[128:131], a[20:23], v[212:215]
    s_mul_i32 s98, s98, 3
    ds_read_b128 v[124:127], v12 offset:8192
    ds_read_b128 v[128:131], v12 offset:16384
    v_mfma_f32_16x16x32_bf16 v[212:215], v[132:135], a[28:31], v[212:215]
    s_sub_u32 s98, s98, s99
    ds_read_b128 v[132:135], v12 offset:24576
    v_mfma_f32_16x16x32_bf16 v[216:219], v[136:139], a[0:3], 0
    s_add_u32 s98, s98, 3
    v_mfma_f32_16x16x32_bf16 v[216:219], v[140:143], a[8:11], v[216:219]
    s_lshl2_add_u32 s98, s98, s4
    v_mfma_f32_16x16x32_bf16 v[216:219], v[144:147], a[16:19], v[216:219]
    s_mul_i32 s11, s98, 3072
    buffer_load_dwordx4 v1, s[56:59], s21 offen offset:3072 sc1 lds
    v_mfma_f32_16x16x32_bf16 v[216:219], v[148:151], a[24:27], v[216:219]
    s_waitcnt vmcnt(11)
    v_mfma_f32_16x16x32_bf16 v[220:223], v[136:139], a[4:7], 0
    s_add_u32 s21, s21, 4096
    ds_read_b128 v[136:139], v12 offset:1024
    v_mfma_f32_16x16x32_bf16 v[220:223], v[140:143], a[12:15], v[220:223]
    s_add_u32 m0, s47, 4096
    ds_read_b128 v[140:143], v12 offset:9216
    v_mfma_f32_16x16x32_bf16 v[220:223], v[144:147], a[20:23], v[220:223]
    buffer_load_dwordx4 v1, s[56:59], s21 offen sc1 lds
    v_mfma_f32_16x16x32_bf16 v[220:223], v[148:151], a[28:31], v[220:223]
    s_waitcnt lgkmcnt(2)
    ds_read_b128 v[144:147], v12 offset:17408
    ds_read_b128 v[148:151], v12 offset:25600
    v_mfma_f32_16x16x32_bf16 v[224:227], v[104:107], a[0:3], 0
    s_cmp_eq_u32 s99, 0
    s_cselect_b32 s11, 1073741824, s11
    v_mfma_f32_16x16x32_bf16 v[224:227], v[108:111], a[8:11], v[224:227]
    v_mfma_f32_16x16x32_bf16 v[224:227], v[112:115], a[16:19], v[224:227]
    buffer_load_dwordx4 v1, s[56:59], s21 offen offset:1024 sc1 lds
    v_mfma_f32_16x16x32_bf16 v[224:227], v[116:119], a[24:27], v[224:227]
    v_mfma_f32_16x16x32_bf16 v[228:231], v[104:107], a[4:7], 0
    ds_read_b128 v[104:107], v12 offset:2048
    v_mfma_f32_16x16x32_bf16 v[228:231], v[108:111], a[12:15], v[228:231]
    ds_read_b128 v[108:111], v12 offset:10240
    v_mfma_f32_16x16x32_bf16 v[228:231], v[112:115], a[20:23], v[228:231]
    buffer_load_dwordx4 v1, s[56:59], s21 offen offset:2048 sc1 lds
    v_mfma_f32_16x16x32_bf16 v[228:231], v[116:119], a[28:31], v[228:231]
    ds_read_b128 v[112:115], v12 offset:18432
    ds_read_b128 v[116:119], v12 offset:26624
    v_mfma_f32_16x16x32_bf16 v[176:179], v[120:123], a[32:35], v[176:179]
    v_mfma_f32_16x16x32_bf16 v[176:179], v[124:127], a[40:43], v[176:179]
    v_mfma_f32_16x16x32_bf16 v[176:179], v[128:131], a[48:51], v[176:179]
    buffer_load_dwordx4 a[100:103], v5, s[40:43], s20 offen offset:0 sc1
    v_mfma_f32_16x16x32_bf16 v[176:179], v[132:135], a[56:59], v[176:179]
    v_mfma_f32_16x16x32_bf16 v[180:183], v[120:123], a[36:39], v[180:183]
    ds_read_b128 v[120:123], v12 offset:3072
    v_mfma_f32_16x16x32_bf16 v[180:183], v[124:127], a[44:47], v[180:183]
    ds_read_b128 v[124:127], v12 offset:11264
    v_mfma_f32_16x16x32_bf16 v[180:183], v[128:131], a[52:55], v[180:183]
    ds_read_b128 v[128:131], v12 offset:19456
    v_mfma_f32_16x16x32_bf16 v[180:183], v[132:135], a[60:63], v[180:183]
    s_waitcnt lgkmcnt(3)
    buffer_load_dwordx4 a[108:111], v5, s[40:43], s20 offen offset:1024 sc1
    v_mfma_f32_16x16x32_bf16 v[184:187], v[136:139], a[32:35], v[184:187]
    ds_read_b128 v[132:135], v12 offset:27648
    v_mfma_f32_16x16x32_bf16 v[184:187], v[140:143], a[40:43], v[184:187]
    v_mfma_f32_16x16x32_bf16 v[184:187], v[144:147], a[48:51], v[184:187]
    v_mfma_f32_16x16x32_bf16 v[184:187], v[148:151], a[56:59], v[184:187]
    buffer_load_dwordx4 a[116:119], v5, s[40:43], s20 offen offset:2048 sc1
    v_mfma_f32_16x16x32_bf16 v[188:191], v[136:139], a[36:39], v[188:191]
    ds_read_b128 v[136:139], v12 offset:4096
    v_mfma_f32_16x16x32_bf16 v[188:191], v[140:143], a[44:47], v[188:191]
    ds_read_b128 v[140:143], v12 offset:12288
    v_mfma_f32_16x16x32_bf16 v[188:191], v[144:147], a[52:55], v[188:191]
    ds_read_b128 v[144:147], v12 offset:20480
    v_mfma_f32_16x16x32_bf16 v[188:191], v[148:151], a[60:63], v[188:191]
    buffer_load_dwordx4 a[124:127], v5, s[40:43], s20 offen offset:3072 sc1
    v_mfma_f32_16x16x32_bf16 v[192:195], v[104:107], a[32:35], v[192:195]
    s_xor_b32 s21, s3, 4
    ds_read_b128 v[148:151], v12 offset:28672
    v_mfma_f32_16x16x32_bf16 v[192:195], v[108:111], a[40:43], v[192:195]
    s_lshl2_add_u32 s21, s21, s4
    v_mfma_f32_16x16x32_bf16 v[192:195], v[112:115], a[48:51], v[192:195]
    s_mul_i32 s21, s21, 36864
    v_mfma_f32_16x16x32_bf16 v[192:195], v[116:119], a[56:59], v[192:195]
    s_add_u32 s21, s21, s28
    s_mov_b32 m0, s79
    v_mfma_f32_16x16x32_bf16 v[196:199], v[104:107], a[36:39], v[196:199]
    s_xor_b32 s20, s20, 28672
    buffer_load_dwordx4 v1, s[56:59], s21 offen sc1 lds
    v_mfma_f32_16x16x32_bf16 v[196:199], v[108:111], a[44:47], v[196:199]
    ds_read_b128 v[104:107], v12 offset:5120
    ds_read_b128 v[108:111], v12 offset:13312
    v_mfma_f32_16x16x32_bf16 v[196:199], v[112:115], a[52:55], v[196:199]
    ds_read_b128 v[112:115], v12 offset:21504
    v_mfma_f32_16x16x32_bf16 v[196:199], v[116:119], a[60:63], v[196:199]
    s_waitcnt lgkmcnt(3)
    buffer_load_dwordx4 v1, s[56:59], s21 offen offset:1024 sc1 lds
    v_mfma_f32_16x16x32_bf16 v[200:203], v[120:123], a[32:35], v[200:203]
    ds_read_b128 v[116:119], v12 offset:29696
    v_mfma_f32_16x16x32_bf16 v[200:203], v[124:127], a[40:43], v[200:203]
    v_mfma_f32_16x16x32_bf16 v[200:203], v[128:131], a[48:51], v[200:203]
    v_mfma_f32_16x16x32_bf16 v[200:203], v[132:135], a[56:59], v[200:203]
    v_mfma_f32_16x16x32_bf16 v[204:207], v[120:123], a[36:39], v[204:207]
    buffer_load_dwordx4 v1, s[56:59], s21 offen offset:2048 sc1 lds
    v_mfma_f32_16x16x32_bf16 v[204:207], v[124:127], a[44:47], v[204:207]
    ds_read_b128 v[120:123], v12 offset:6144
    ds_read_b128 v[124:127], v12 offset:14336
    v_mfma_f32_16x16x32_bf16 v[204:207], v[128:131], a[52:55], v[204:207]
    ds_read_b128 v[128:131], v12 offset:22528
    v_mfma_f32_16x16x32_bf16 v[204:207], v[132:135], a[60:63], v[204:207]
    ds_read_b128 v[132:135], v12 offset:30720
    v_mfma_f32_16x16x32_bf16 v[208:211], v[136:139], a[32:35], v[208:211]
    buffer_load_dwordx4 v1, s[56:59], s21 offen offset:3072 sc1 lds
    v_mfma_f32_16x16x32_bf16 v[208:211], v[140:143], a[40:43], v[208:211]
    s_add_u32 s21, s21, 4096
    v_mfma_f32_16x16x32_bf16 v[208:211], v[144:147], a[48:51], v[208:211]
    s_add_u32 m0, s79, 4096
    v_mfma_f32_16x16x32_bf16 v[208:211], v[148:151], a[56:59], v[208:211]
    v_mfma_f32_16x16x32_bf16 v[212:215], v[136:139], a[36:39], v[212:215]
    buffer_load_dwordx4 v1, s[56:59], s21 offen sc1 lds
    v_mfma_f32_16x16x32_bf16 v[212:215], v[140:143], a[44:47], v[212:215]
    ds_read_b128 v[136:139], v13 offset:0
    ds_read_b128 v[140:143], v13 offset:8192
    v_mfma_f32_16x16x32_bf16 v[212:215], v[144:147], a[52:55], v[212:215]
    ds_read_b128 v[144:147], v13 offset:16384
    v_mfma_f32_16x16x32_bf16 v[212:215], v[148:151], a[60:63], v[212:215]
    s_waitcnt lgkmcnt(3)
    ds_read_b128 v[148:151], v13 offset:24576
    v_mfma_f32_16x16x32_bf16 v[216:219], v[104:107], a[32:35], v[216:219]
    buffer_load_dwordx4 v1, s[56:59], s21 offen offset:1024 sc1 lds
    v_mfma_f32_16x16x32_bf16 v[216:219], v[108:111], a[40:43], v[216:219]
    v_mfma_f32_16x16x32_bf16 v[216:219], v[112:115], a[48:51], v[216:219]
    v_mfma_f32_16x16x32_bf16 v[216:219], v[116:119], a[56:59], v[216:219]
    s_waitcnt vmcnt(20)
    s_barrier
    v_mfma_f32_16x16x32_bf16 v[220:223], v[104:107], a[36:39], v[220:223]
    buffer_load_dwordx4 v1, s[56:59], s21 offen offset:2048 sc1 lds
    v_mfma_f32_16x16x32_bf16 v[220:223], v[108:111], a[44:47], v[220:223]
    ds_read_b128 v[104:107], v13 offset:1024
    ds_read_b128 v[108:111], v13 offset:9216
    v_mfma_f32_16x16x32_bf16 v[220:223], v[112:115], a[52:55], v[220:223]
    ds_read_b128 v[112:115], v13 offset:17408
    v_mfma_f32_16x16x32_bf16 v[220:223], v[116:119], a[60:63], v[220:223]
    ds_read_b128 v[116:119], v13 offset:25600
    v_mfma_f32_16x16x32_bf16 v[224:227], v[120:123], a[32:35], v[224:227]
    v_mfma_f32_16x16x32_bf16 v[224:227], v[124:127], a[40:43], v[224:227]
    buffer_load_dwordx4 a[132:135], v5, s[40:43], s20 offen offset:0 sc1
    v_mfma_f32_16x16x32_bf16 v[224:227], v[128:131], a[48:51], v[224:227]
    v_mfma_f32_16x16x32_bf16 v[224:227], v[132:135], a[56:59], v[224:227]
    v_mfma_f32_16x16x32_bf16 v[228:231], v[120:123], a[36:39], v[228:231]
    ds_read_b128 v[120:123], v13 offset:2048
    v_mfma_f32_16x16x32_bf16 v[228:231], v[124:127], a[44:47], v[228:231]
    buffer_load_dwordx4 a[140:143], v5, s[40:43], s20 offen offset:1024 sc1
    v_mfma_f32_16x16x32_bf16 v[228:231], v[128:131], a[52:55], v[228:231]
    ds_read_b128 v[124:127], v13 offset:10240
    ds_read_b128 v[128:131], v13 offset:18432
    v_mfma_f32_16x16x32_bf16 v[228:231], v[132:135], a[60:63], v[228:231]
    s_waitcnt lgkmcnt(3)
    ds_read_b128 v[132:135], v13 offset:26624
    v_mfma_f32_16x16x32_bf16 v[176:179], v[136:139], a[64:67], v[176:179]
    v_mfma_f32_16x16x32_bf16 v[176:179], v[140:143], a[72:75], v[176:179]
    buffer_load_dwordx4 a[148:151], v5, s[40:43], s20 offen offset:2048 sc1
    v_mfma_f32_16x16x32_bf16 v[176:179], v[144:147], a[80:83], v[176:179]
    v_mfma_f32_16x16x32_bf16 v[176:179], v[148:151], a[88:91], v[176:179]
    v_mfma_f32_16x16x32_bf16 v[180:183], v[136:139], a[68:71], v[180:183]
    ds_read_b128 v[136:139], v13 offset:3072
    v_mfma_f32_16x16x32_bf16 v[180:183], v[140:143], a[76:79], v[180:183]
    buffer_load_dwordx4 a[156:159], v5, s[40:43], s20 offen offset:3072 sc1
    v_mfma_f32_16x16x32_bf16 v[180:183], v[144:147], a[84:87], v[180:183]
    s_xor_b32 s21, s3, 5
    ds_read_b128 v[140:143], v13 offset:11264
    ds_read_b128 v[144:147], v13 offset:19456
    v_mfma_f32_16x16x32_bf16 v[180:183], v[148:151], a[92:95], v[180:183]
    s_lshl2_add_u32 s21, s21, s4
    ds_read_b128 v[148:151], v13 offset:27648
    v_mfma_f32_16x16x32_bf16 v[184:187], v[104:107], a[64:67], v[184:187]
    s_mul_i32 s21, s21, 36864
    v_mfma_f32_16x16x32_bf16 v[184:187], v[108:111], a[72:75], v[184:187]
    s_add_u32 s21, s21, s28
    s_mov_b32 m0, s44
    v_mfma_f32_16x16x32_bf16 v[184:187], v[112:115], a[80:83], v[184:187]
    s_xor_b32 s20, s20, 4096
    buffer_load_dwordx4 v1, s[56:59], s21 offen sc1 lds
    v_mfma_f32_16x16x32_bf16 v[184:187], v[116:119], a[88:91], v[184:187]
    v_mfma_f32_16x16x32_bf16 v[188:191], v[104:107], a[68:71], v[188:191]
    ds_read_b128 v[104:107], v13 offset:4096
    v_mfma_f32_16x16x32_bf16 v[188:191], v[108:111], a[76:79], v[188:191]
    ds_read_b128 v[108:111], v13 offset:12288
    v_mfma_f32_16x16x32_bf16 v[188:191], v[112:115], a[84:87], v[188:191]
    buffer_load_dwordx4 v1, s[56:59], s21 offen offset:1024 sc1 lds
    v_mfma_f32_16x16x32_bf16 v[188:191], v[116:119], a[92:95], v[188:191]
    s_waitcnt lgkmcnt(2)
    ds_read_b128 v[112:115], v13 offset:20480
    ds_read_b128 v[116:119], v13 offset:28672
    v_mfma_f32_16x16x32_bf16 v[192:195], v[120:123], a[64:67], v[192:195]
    v_mfma_f32_16x16x32_bf16 v[192:195], v[124:127], a[72:75], v[192:195]
    v_mfma_f32_16x16x32_bf16 v[192:195], v[128:131], a[80:83], v[192:195]
    buffer_load_dwordx4 v1, s[56:59], s21 offen offset:2048 sc1 lds
    v_mfma_f32_16x16x32_bf16 v[192:195], v[132:135], a[88:91], v[192:195]
    v_mfma_f32_16x16x32_bf16 v[196:199], v[120:123], a[68:71], v[196:199]
    ds_read_b128 v[120:123], v13 offset:5120
    v_mfma_f32_16x16x32_bf16 v[196:199], v[124:127], a[76:79], v[196:199]
    ds_read_b128 v[124:127], v13 offset:13312
    v_mfma_f32_16x16x32_bf16 v[196:199], v[128:131], a[84:87], v[196:199]
    buffer_load_dwordx4 v1, s[56:59], s21 offen offset:3072 sc1 lds
    v_mfma_f32_16x16x32_bf16 v[196:199], v[132:135], a[92:95], v[196:199]
    s_add_u32 s21, s21, 4096
    ds_read_b128 v[128:131], v13 offset:21504
    ds_read_b128 v[132:135], v13 offset:29696
    v_mfma_f32_16x16x32_bf16 v[200:203], v[136:139], a[64:67], v[200:203]
    s_add_u32 m0, s44, 4096
    v_mfma_f32_16x16x32_bf16 v[200:203], v[140:143], a[72:75], v[200:203]
    v_mfma_f32_16x16x32_bf16 v[200:203], v[144:147], a[80:83], v[200:203]
    buffer_load_dwordx4 v1, s[56:59], s21 offen sc1 lds
    v_mfma_f32_16x16x32_bf16 v[200:203], v[148:151], a[88:91], v[200:203]
    v_mfma_f32_16x16x32_bf16 v[204:207], v[136:139], a[68:71], v[204:207]
    ds_read_b128 v[136:139], v13 offset:6144
    v_mfma_f32_16x16x32_bf16 v[204:207], v[140:143], a[76:79], v[204:207]
    ds_read_b128 v[140:143], v13 offset:14336
    v_mfma_f32_16x16x32_bf16 v[204:207], v[144:147], a[84:87], v[204:207]
    buffer_load_dwordx4 v1, s[56:59], s21 offen offset:1024 sc1 lds
    v_mfma_f32_16x16x32_bf16 v[204:207], v[148:151], a[92:95], v[204:207]
    s_waitcnt lgkmcnt(2)
    ds_read_b128 v[144:147], v13 offset:22528
    ds_read_b128 v[148:151], v13 offset:30720
    v_mfma_f32_16x16x32_bf16 v[208:211], v[104:107], a[64:67], v[208:211]
    v_mfma_f32_16x16x32_bf16 v[208:211], v[108:111], a[72:75], v[208:211]
    v_mfma_f32_16x16x32_bf16 v[208:211], v[112:115], a[80:83], v[208:211]
    v_mfma_f32_16x16x32_bf16 v[208:211], v[116:119], a[88:91], v[208:211]
    buffer_load_dwordx4 v1, s[56:59], s21 offen offset:2048 sc1 lds
    v_mfma_f32_16x16x32_bf16 v[212:215], v[104:107], a[68:71], v[212:215]
    v_mfma_f32_16x16x32_bf16 v[212:215], v[108:111], a[76:79], v[212:215]
    v_mfma_f32_16x16x32_bf16 v[212:215], v[112:115], a[84:87], v[212:215]
    v_mfma_f32_16x16x32_bf16 v[212:215], v[116:119], a[92:95], v[212:215]
    buffer_load_dwordx4 a[160:163], v4, s[40:43], s63 offen offset:0 sc1
    v_mfma_f32_16x16x32_bf16 v[216:219], v[120:123], a[64:67], v[216:219]
    v_mfma_f32_16x16x32_bf16 v[216:219], v[124:127], a[72:75], v[216:219]
    v_mfma_f32_16x16x32_bf16 v[216:219], v[128:131], a[80:83], v[216:219]
    v_mfma_f32_16x16x32_bf16 v[216:219], v[132:135], a[88:91], v[216:219]
    s_waitcnt vmcnt(19)
    s_barrier
    v_mov_b32 v31, 3
    v_mfma_f32_16x16x32_bf16 v[220:223], v[120:123], a[68:71], v[220:223]
    buffer_load_dwordx4 a[168:171], v4, s[40:43], s63 offen offset:1024 sc1
    v_mfma_f32_16x16x32_bf16 v[220:223], v[124:127], a[76:79], v[220:223]
    buffer_store_dword v31, v30, s[32:35], s101 offen sc1
    v_mfma_f32_16x16x32_bf16 v[220:223], v[128:131], a[84:87], v[220:223]
    ds_read_b128 v[104:107], v6 offset:0
    ds_read_b128 v[108:111], v6 offset:8192
    v_mfma_f32_16x16x32_bf16 v[220:223], v[132:135], a[92:95], v[220:223]
    s_waitcnt lgkmcnt(2)
    ds_read_b128 v[112:115], v6 offset:16384
    v_mfma_f32_16x16x32_bf16 v[224:227], v[136:139], a[64:67], v[224:227]
    buffer_load_dwordx4 a[176:179], v4, s[40:43], s63 offen offset:2048 sc1
    v_mfma_f32_16x16x32_bf16 v[224:227], v[140:143], a[72:75], v[224:227]
    ds_read_b128 v[116:119], v6 offset:24576
    ds_read_b128 v[120:123], v6 offset:1024
    v_mfma_f32_16x16x32_bf16 v[224:227], v[144:147], a[80:83], v[224:227]
    ds_read_b128 v[124:127], v6 offset:9216
    v_mfma_f32_16x16x32_bf16 v[224:227], v[148:151], a[88:91], v[224:227]
    ds_read_b128 v[128:131], v6 offset:17408
    v_mfma_f32_16x16x32_bf16 v[228:231], v[136:139], a[68:71], v[228:231]
    buffer_load_dwordx4 a[184:187], v4, s[40:43], s63 offen offset:3072 sc1
    v_mfma_f32_16x16x32_bf16 v[228:231], v[140:143], a[76:79], v[228:231]
    s_xor_b32 s63, s63, 12288
    ds_read_b128 v[132:135], v6 offset:25600
    ds_read_b128 v[136:139], v6 offset:2048
    v_mfma_f32_16x16x32_bf16 v[228:231], v[144:147], a[84:87], v[228:231]
    ds_read_b128 v[140:143], v6 offset:10240
    v_mfma_f32_16x16x32_bf16 v[228:231], v[148:151], a[92:95], v[228:231]
    s_waitcnt lgkmcnt(4)
    ds_read_b128 v[144:147], v6 offset:18432
    v_mfma_f32_16x16x32_bf16 v[176:179], v[104:107], a[96:99], v[176:179]
    buffer_load_dwordx4 a[164:167], v5, s[40:43], s20 offen offset:0 sc1
    v_mfma_f32_16x16x32_bf16 v[176:179], v[108:111], a[104:107], v[176:179]
    ds_read_b128 v[148:151], v6 offset:26624
    v_mfma_f32_16x16x32_bf16 v[176:179], v[112:115], a[112:115], v[176:179]
    v_mfma_f32_16x16x32_bf16 v[176:179], v[116:119], a[120:123], v[176:179]
    v_mfma_f32_16x16x32_bf16 v[180:183], v[104:107], a[100:103], v[180:183]
    buffer_load_dwordx4 a[172:175], v5, s[40:43], s20 offen offset:1024 sc1
    v_mfma_f32_16x16x32_bf16 v[180:183], v[108:111], a[108:111], v[180:183]
    ds_read_b128 v[104:107], v6 offset:3072
    ds_read_b128 v[108:111], v6 offset:11264
    v_mfma_f32_16x16x32_bf16 v[180:183], v[112:115], a[116:119], v[180:183]
    ds_read_b128 v[112:115], v6 offset:19456
    v_mfma_f32_16x16x32_bf16 v[180:183], v[116:119], a[124:127], v[180:183]
    ds_read_b128 v[116:119], v6 offset:27648
    v_mfma_f32_16x16x32_bf16 v[184:187], v[120:123], a[96:99], v[184:187]
    buffer_load_dwordx4 a[180:183], v5, s[40:43], s20 offen offset:2048 sc1
    v_mfma_f32_16x16x32_bf16 v[184:187], v[124:127], a[104:107], v[184:187]
    s_waitcnt lgkmcnt(4)
    v_mfma_f32_16x16x32_bf16 v[184:187], v[128:131], a[112:115], v[184:187]
    v_mfma_f32_16x16x32_bf16 v[184:187], v[132:135], a[120:123], v[184:187]
    v_mfma_f32_16x16x32_bf16 v[188:191], v[120:123], a[100:103], v[188:191]
    buffer_load_dwordx4 a[188:191], v5, s[40:43], s20 offen offset:3072 sc1
    v_mfma_f32_16x16x32_bf16 v[188:191], v[124:127], a[108:111], v[188:191]
    s_xor_b32 s21, s3, 6
    ds_read_b128 v[120:123], v6 offset:4096
    ds_read_b128 v[124:127], v6 offset:12288
    v_mfma_f32_16x16x32_bf16 v[188:191], v[128:131], a[116:119], v[188:191]
    s_lshl2_add_u32 s21, s21, s4
    ds_read_b128 v[128:131], v6 offset:20480
    v_mfma_f32_16x16x32_bf16 v[188:191], v[132:135], a[124:127], v[188:191]
    s_mul_i32 s21, s21, 36864
    ds_read_b128 v[132:135], v6 offset:28672
    v_mfma_f32_16x16x32_bf16 v[192:195], v[136:139], a[96:99], v[192:195]
    s_add_u32 s21, s21, s28
    s_mov_b32 m0, s45
    v_mfma_f32_16x16x32_bf16 v[192:195], v[140:143], a[104:107], v[192:195]
    s_xor_b32 s20, s20, 12288
    buffer_load_dwordx4 v1, s[56:59], s21 offen sc1 lds
    v_mfma_f32_16x16x32_bf16 v[192:195], v[144:147], a[112:115], v[192:195]
    v_mfma_f32_16x16x32_bf16 v[192:195], v[148:151], a[120:123], v[192:195]
    v_mfma_f32_16x16x32_bf16 v[196:199], v[136:139], a[100:103], v[196:199]
    buffer_load_dwordx4 v1, s[56:59], s21 offen offset:1024 sc1 lds
    v_mfma_f32_16x16x32_bf16 v[196:199], v[140:143], a[108:111], v[196:199]
    ds_read_b128 v[136:139], v6 offset:5120
    ds_read_b128 v[140:143], v6 offset:13312
    v_mfma_f32_16x16x32_bf16 v[196:199], v[144:147], a[116:119], v[196:199]
    ds_read_b128 v[144:147], v6 offset:21504
    v_mfma_f32_16x16x32_bf16 v[196:199], v[148:151], a[124:127], v[196:199]
    s_waitcnt lgkmcnt(3)
    ds_read_b128 v[148:151], v6 offset:29696
    v_mfma_f32_16x16x32_bf16 v[200:203], v[104:107], a[96:99], v[200:203]
    v_mfma_f32_16x16x32_bf16 v[200:203], v[108:111], a[104:107], v[200:203]
    buffer_load_dwordx4 v1, s[56:59], s21 offen offset:2048 sc1 lds
    v_mfma_f32_16x16x32_bf16 v[200:203], v[112:115], a[112:115], v[200:203]
    v_mfma_f32_16x16x32_bf16 v[200:203], v[116:119], a[120:123], v[200:203]
    v_mfma_f32_16x16x32_bf16 v[204:207], v[104:107], a[100:103], v[204:207]
    ds_read_b128 v[104:107], v6 offset:6144
    v_mfma_f32_16x16x32_bf16 v[204:207], v[108:111], a[108:111], v[204:207]
    buffer_load_dwordx4 v1, s[56:59], s21 offen offset:3072 sc1 lds
    v_mfma_f32_16x16x32_bf16 v[204:207], v[112:115], a[116:119], v[204:207]
    s_add_u32 s21, s21, 4096
    ds_read_b128 v[108:111], v6 offset:14336
    ds_read_b128 v[112:115], v6 offset:22528
    v_mfma_f32_16x16x32_bf16 v[204:207], v[116:119], a[124:127], v[204:207]
    s_add_u32 m0, s45, 4096
    ds_read_b128 v[116:119], v6 offset:30720
    v_mfma_f32_16x16x32_bf16 v[208:211], v[120:123], a[96:99], v[208:211]
    v_mfma_f32_16x16x32_bf16 v[208:211], v[124:127], a[104:107], v[208:211]
    buffer_load_dwordx4 v1, s[56:59], s21 offen sc1 lds
    v_mfma_f32_16x16x32_bf16 v[208:211], v[128:131], a[112:115], v[208:211]
    v_mfma_f32_16x16x32_bf16 v[208:211], v[132:135], a[120:123], v[208:211]
    v_mfma_f32_16x16x32_bf16 v[212:215], v[120:123], a[100:103], v[212:215]
    v_mfma_f32_16x16x32_bf16 v[212:215], v[124:127], a[108:111], v[212:215]
    buffer_load_dwordx4 v1, s[56:59], s21 offen offset:1024 sc1 lds
    v_mfma_f32_16x16x32_bf16 v[212:215], v[128:131], a[116:119], v[212:215]
    v_mfma_f32_16x16x32_bf16 v[212:215], v[132:135], a[124:127], v[212:215]
    s_waitcnt lgkmcnt(0)
    v_mfma_f32_16x16x32_bf16 v[216:219], v[136:139], a[96:99], v[216:219]
    v_mfma_f32_16x16x32_bf16 v[216:219], v[140:143], a[104:107], v[216:219]
    buffer_load_dwordx4 v1, s[56:59], s21 offen offset:2048 sc1 lds
    v_mfma_f32_16x16x32_bf16 v[216:219], v[144:147], a[112:115], v[216:219]
    v_mfma_f32_16x16x32_bf16 v[216:219], v[148:151], a[120:123], v[216:219]
    s_waitcnt vmcnt(23)
    s_barrier
    ds_read_b128 v[120:123], v7 offset:0
    v_mfma_f32_16x16x32_bf16 v[220:223], v[136:139], a[100:103], v[220:223]
    ds_read_b128 v[124:127], v7 offset:8192
    ds_read_b128 v[128:131], v7 offset:16384
    v_mfma_f32_16x16x32_bf16 v[220:223], v[140:143], a[108:111], v[220:223]
    ds_read_b128 v[132:135], v7 offset:24576
    v_mfma_f32_16x16x32_bf16 v[220:223], v[144:147], a[116:119], v[220:223]
    buffer_load_dwordx4 a[192:195], v4, s[40:43], s63 offen offset:0 sc1
    v_mfma_f32_16x16x32_bf16 v[220:223], v[148:151], a[124:127], v[220:223]
    ds_read_b128 v[136:139], v7 offset:1024
    ds_read_b128 v[140:143], v7 offset:9216
    v_mfma_f32_16x16x32_bf16 v[224:227], v[104:107], a[96:99], v[224:227]
    ds_read_b128 v[144:147], v7 offset:17408
    v_mfma_f32_16x16x32_bf16 v[224:227], v[108:111], a[104:107], v[224:227]
    ds_read_b128 v[148:151], v7 offset:25600
    v_mfma_f32_16x16x32_bf16 v[224:227], v[112:115], a[112:115], v[224:227]
    buffer_load_dwordx4 a[200:203], v4, s[40:43], s63 offen offset:1024 sc1
    v_mfma_f32_16x16x32_bf16 v[224:227], v[116:119], a[120:123], v[224:227]
    v_mfma_f32_16x16x32_bf16 v[228:231], v[104:107], a[100:103], v[228:231]
    ds_read_b128 v[104:107], v7 offset:2048
    v_mfma_f32_16x16x32_bf16 v[228:231], v[108:111], a[108:111], v[228:231]
    ds_read_b128 v[108:111], v7 offset:10240
    v_mfma_f32_16x16x32_bf16 v[228:231], v[112:115], a[116:119], v[228:231]
    buffer_load_dwordx4 a[208:211], v4, s[40:43], s63 offen offset:2048 sc1
    v_mfma_f32_16x16x32_bf16 v[228:231], v[116:119], a[124:127], v[228:231]
    s_waitcnt lgkmcnt(2)
    ds_read_b128 v[112:115], v7 offset:18432
    ds_read_b128 v[116:119], v7 offset:26624
    v_mfma_f32_16x16x32_bf16 v[176:179], v[120:123], a[128:131], v[176:179]
    v_mfma_f32_16x16x32_bf16 v[176:179], v[124:127], a[136:139], v[176:179]
    v_mfma_f32_16x16x32_bf16 v[176:179], v[128:131], a[144:147], v[176:179]
    buffer_load_dwordx4 a[216:219], v4, s[40:43], s63 offen offset:3072 sc1
    v_mfma_f32_16x16x32_bf16 v[176:179], v[132:135], a[152:155], v[176:179]
    s_xor_b32 s63, s63, 4096
    v_mfma_f32_16x16x32_bf16 v[180:183], v[120:123], a[132:135], v[180:183]
    ds_read_b128 v[120:123], v7 offset:3072
    v_mfma_f32_16x16x32_bf16 v[180:183], v[124:127], a[140:143], v[180:183]
    ds_read_b128 v[124:127], v7 offset:11264
    v_mfma_f32_16x16x32_bf16 v[180:183], v[128:131], a[148:151], v[180:183]
    buffer_load_dwordx4 a[196:199], v5, s[40:43], s20 offen offset:0 sc1
    v_mfma_f32_16x16x32_bf16 v[180:183], v[132:135], a[156:159], v[180:183]
    ds_read_b128 v[128:131], v7 offset:19456
    ds_read_b128 v[132:135], v7 offset:27648
    v_mfma_f32_16x16x32_bf16 v[184:187], v[136:139], a[128:131], v[184:187]
    v_mfma_f32_16x16x32_bf16 v[184:187], v[140:143], a[136:139], v[184:187]
    v_mfma_f32_16x16x32_bf16 v[184:187], v[144:147], a[144:147], v[184:187]
    v_mfma_f32_16x16x32_bf16 v[184:187], v[148:151], a[152:155], v[184:187]
    buffer_load_dwordx4 a[204:207], v5, s[40:43], s20 offen offset:1024 sc1
    v_mfma_f32_16x16x32_bf16 v[188:191], v[136:139], a[132:135], v[188:191]
    ds_read_b128 v[136:139], v7 offset:4096
    v_mfma_f32_16x16x32_bf16 v[188:191], v[140:143], a[140:143], v[188:191]
    ds_read_b128 v[140:143], v7 offset:12288
    v_mfma_f32_16x16x32_bf16 v[188:191], v[144:147], a[148:151], v[188:191]
    ds_read_b128 v[144:147], v7 offset:20480
    v_mfma_f32_16x16x32_bf16 v[188:191], v[148:151], a[156:159], v[188:191]
    s_waitcnt lgkmcnt(3)
    buffer_load_dwordx4 a[212:215], v5, s[40:43], s20 offen offset:2048 sc1
    v_mfma_f32_16x16x32_bf16 v[192:195], v[104:107], a[128:131], v[192:195]
    ds_read_b128 v[148:151], v7 offset:28672
    v_mfma_f32_16x16x32_bf16 v[192:195], v[108:111], a[136:139], v[192:195]
    v_mfma_f32_16x16x32_bf16 v[192:195], v[112:115], a[144:147], v[192:195]
    v_mfma_f32_16x16x32_bf16 v[192:195], v[116:119], a[152:155], v[192:195]
    buffer_load_dwordx4 a[220:223], v5, s[40:43], s20 offen offset:3072 sc1
    v_mfma_f32_16x16x32_bf16 v[196:199], v[104:107], a[132:135], v[196:199]
    s_xor_b32 s21, s3, 7
    ds_read_b128 v[104:107], v7 offset:5120
    v_mfma_f32_16x16x32_bf16 v[196:199], v[108:111], a[140:143], v[196:199]
    s_lshl2_add_u32 s21, s21, s4
    ds_read_b128 v[108:111], v7 offset:13312
    v_mfma_f32_16x16x32_bf16 v[196:199], v[112:115], a[148:151], v[196:199]
    s_mul_i32 s21, s21, 36864
    ds_read_b128 v[112:115], v7 offset:21504
    v_mfma_f32_16x16x32_bf16 v[196:199], v[116:119], a[156:159], v[196:199]
    s_add_u32 s21, s21, s28
    s_mov_b32 m0, s46
    ds_read_b128 v[116:119], v7 offset:29696
    v_mfma_f32_16x16x32_bf16 v[200:203], v[120:123], a[128:131], v[200:203]
    s_xor_b32 s20, s20, 4096
    buffer_load_dwordx4 v1, s[56:59], s21 offen sc1 lds
    v_mfma_f32_16x16x32_bf16 v[200:203], v[124:127], a[136:139], v[200:203]
    v_mfma_f32_16x16x32_bf16 v[200:203], v[128:131], a[144:147], v[200:203]
    v_mfma_f32_16x16x32_bf16 v[200:203], v[132:135], a[152:155], v[200:203]
    buffer_load_dwordx4 v1, s[56:59], s21 offen offset:1024 sc1 lds
    v_mfma_f32_16x16x32_bf16 v[204:207], v[120:123], a[132:135], v[204:207]
    ds_read_b128 v[120:123], v7 offset:6144
    v_mfma_f32_16x16x32_bf16 v[204:207], v[124:127], a[140:143], v[204:207]
    ds_read_b128 v[124:127], v7 offset:14336
    v_mfma_f32_16x16x32_bf16 v[204:207], v[128:131], a[148:151], v[204:207]
    buffer_load_dword v3, v19, s[32:35], s66 offen sc1
    v_mfma_f32_16x16x32_bf16 v[204:207], v[132:135], a[156:159], v[204:207]
    s_waitcnt lgkmcnt(2)
    ds_read_b128 v[128:131], v7 offset:22528
    ds_read_b128 v[132:135], v7 offset:30720
    v_mfma_f32_16x16x32_bf16 v[208:211], v[136:139], a[128:131], v[208:211]
    buffer_load_dwordx4 v1, s[56:59], s21 offen offset:2048 sc1 lds
    v_mfma_f32_16x16x32_bf16 v[208:211], v[140:143], a[136:139], v[208:211]
    v_mfma_f32_16x16x32_bf16 v[208:211], v[144:147], a[144:147], v[208:211]
    v_mfma_f32_16x16x32_bf16 v[208:211], v[148:151], a[152:155], v[208:211]
    v_mfma_f32_16x16x32_bf16 v[212:215], v[136:139], a[132:135], v[212:215]
    buffer_load_dwordx4 v1, s[56:59], s21 offen offset:3072 sc1 lds
    v_mfma_f32_16x16x32_bf16 v[212:215], v[140:143], a[140:143], v[212:215]
    s_add_u32 s21, s21, 4096
    v_mfma_f32_16x16x32_bf16 v[212:215], v[144:147], a[148:151], v[212:215]
    s_add_u32 m0, s46, 4096
    v_mfma_f32_16x16x32_bf16 v[212:215], v[148:151], a[156:159], v[212:215]
    v_mfma_f32_16x16x32_bf16 v[216:219], v[104:107], a[128:131], v[216:219]
    buffer_load_dwordx4 v1, s[56:59], s21 offen sc1 lds
    v_mfma_f32_16x16x32_bf16 v[216:219], v[108:111], a[136:139], v[216:219]
    v_mfma_f32_16x16x32_bf16 v[216:219], v[112:115], a[144:147], v[216:219]
    v_mfma_f32_16x16x32_bf16 v[216:219], v[116:119], a[152:155], v[216:219]
    s_waitcnt vmcnt(21)
    s_barrier
    ds_read_b128 v[136:139], v11 offset:0
    v_mfma_f32_16x16x32_bf16 v[220:223], v[104:107], a[132:135], v[220:223]
    buffer_load_dwordx4 v1, s[56:59], s21 offen offset:1024 sc1 lds
    v_mfma_f32_16x16x32_bf16 v[220:223], v[108:111], a[140:143], v[220:223]
    ds_read_b128 v[140:143], v11 offset:8192
    ds_read_b128 v[144:147], v11 offset:16384
    v_mfma_f32_16x16x32_bf16 v[220:223], v[112:115], a[148:151], v[220:223]
    ds_read_b128 v[148:151], v11 offset:24576
    v_mfma_f32_16x16x32_bf16 v[220:223], v[116:119], a[156:159], v[220:223]
    s_waitcnt lgkmcnt(4)
    ds_read_b128 v[104:107], v11 offset:1024
    v_mfma_f32_16x16x32_bf16 v[224:227], v[120:123], a[128:131], v[224:227]
    buffer_load_dwordx4 v1, s[56:59], s21 offen offset:2048 sc1 lds
    v_mfma_f32_16x16x32_bf16 v[224:227], v[124:127], a[136:139], v[224:227]
    ds_read_b128 v[108:111], v11 offset:9216
    ds_read_b128 v[112:115], v11 offset:17408
    v_mfma_f32_16x16x32_bf16 v[224:227], v[128:131], a[144:147], v[224:227]
    ds_read_b128 v[116:119], v11 offset:25600
    v_mfma_f32_16x16x32_bf16 v[224:227], v[132:135], a[152:155], v[224:227]
    v_mfma_f32_16x16x32_bf16 v[228:231], v[120:123], a[132:135], v[228:231]
    ds_read_b128 v[120:123], v11 offset:2048
    v_mfma_f32_16x16x32_bf16 v[228:231], v[124:127], a[140:143], v[228:231]
    buffer_load_dwordx4 a[224:227], v4, s[40:43], s63 offen offset:0 sc1
    v_mfma_f32_16x16x32_bf16 v[228:231], v[128:131], a[148:151], v[228:231]
    ds_read_b128 v[124:127], v11 offset:10240
    ds_read_b128 v[128:131], v11 offset:18432
    v_mfma_f32_16x16x32_bf16 v[228:231], v[132:135], a[156:159], v[228:231]
    s_waitcnt lgkmcnt(3)
    ds_read_b128 v[132:135], v11 offset:26624
    v_mfma_f32_16x16x32_bf16 v[176:179], v[136:139], a[160:163], v[176:179]
    v_mfma_f32_16x16x32_bf16 v[176:179], v[140:143], a[168:171], v[176:179]
    buffer_load_dwordx4 a[232:235], v4, s[40:43], s63 offen offset:1024 sc1
    v_mfma_f32_16x16x32_bf16 v[176:179], v[144:147], a[176:179], v[176:179]
    v_mfma_f32_16x16x32_bf16 v[176:179], v[148:151], a[184:187], v[176:179]
    v_mfma_f32_16x16x32_bf16 v[180:183], v[136:139], a[164:167], v[180:183]
    ds_read_b128 v[136:139], v11 offset:3072
    v_mfma_f32_16x16x32_bf16 v[180:183], v[140:143], a[172:175], v[180:183]
    buffer_load_dwordx4 a[240:243], v4, s[40:43], s63 offen offset:2048 sc1
    v_mfma_f32_16x16x32_bf16 v[180:183], v[144:147], a[180:183], v[180:183]
    ds_read_b128 v[140:143], v11 offset:11264
    ds_read_b128 v[144:147], v11 offset:19456
    v_mfma_f32_16x16x32_bf16 v[180:183], v[148:151], a[188:191], v[180:183]
    ds_read_b128 v[148:151], v11 offset:27648
    v_mfma_f32_16x16x32_bf16 v[184:187], v[104:107], a[160:163], v[184:187]
    v_mfma_f32_16x16x32_bf16 v[184:187], v[108:111], a[168:171], v[184:187]
    buffer_load_dwordx4 a[248:251], v4, s[40:43], s63 offen offset:3072 sc1
    v_mfma_f32_16x16x32_bf16 v[184:187], v[112:115], a[176:179], v[184:187]
    s_add_u32 s63, s63, 4096
    v_mfma_f32_16x16x32_bf16 v[184:187], v[116:119], a[184:187], v[184:187]
    v_mfma_f32_16x16x32_bf16 v[188:191], v[104:107], a[164:167], v[188:191]
    ds_read_b128 v[104:107], v11 offset:4096
    v_mfma_f32_16x16x32_bf16 v[188:191], v[108:111], a[172:175], v[188:191]
    buffer_load_dwordx4 a[228:231], v5, s[40:43], s20 offen offset:0 sc1
    v_mfma_f32_16x16x32_bf16 v[188:191], v[112:115], a[180:183], v[188:191]
    ds_read_b128 v[108:111], v11 offset:12288
    ds_read_b128 v[112:115], v11 offset:20480
    v_mfma_f32_16x16x32_bf16 v[188:191], v[116:119], a[188:191], v[188:191]
    s_waitcnt lgkmcnt(3)
    ds_read_b128 v[116:119], v11 offset:28672
    v_mfma_f32_16x16x32_bf16 v[192:195], v[120:123], a[160:163], v[192:195]
    v_mfma_f32_16x16x32_bf16 v[192:195], v[124:127], a[168:171], v[192:195]
    v_mfma_f32_16x16x32_bf16 v[192:195], v[128:131], a[176:179], v[192:195]
    buffer_load_dwordx4 a[236:239], v5, s[40:43], s20 offen offset:1024 sc1
    v_mfma_f32_16x16x32_bf16 v[192:195], v[132:135], a[184:187], v[192:195]
    v_mfma_f32_16x16x32_bf16 v[196:199], v[120:123], a[164:167], v[196:199]
    ds_read_b128 v[120:123], v11 offset:5120
    v_mfma_f32_16x16x32_bf16 v[196:199], v[124:127], a[172:175], v[196:199]
    ds_read_b128 v[124:127], v11 offset:13312
    v_mfma_f32_16x16x32_bf16 v[196:199], v[128:131], a[180:183], v[196:199]
    buffer_load_dwordx4 a[244:247], v5, s[40:43], s20 offen offset:2048 sc1
    v_mfma_f32_16x16x32_bf16 v[196:199], v[132:135], a[188:191], v[196:199]
    ds_read_b128 v[128:131], v11 offset:21504
    ds_read_b128 v[132:135], v11 offset:29696
    v_mfma_f32_16x16x32_bf16 v[200:203], v[136:139], a[160:163], v[200:203]
    v_mfma_f32_16x16x32_bf16 v[200:203], v[140:143], a[168:171], v[200:203]
    v_mfma_f32_16x16x32_bf16 v[200:203], v[144:147], a[176:179], v[200:203]
    buffer_load_dwordx4 a[252:255], v5, s[40:43], s20 offen offset:3072 sc1
    v_mfma_f32_16x16x32_bf16 v[200:203], v[148:151], a[184:187], v[200:203]
    s_mul_i32 s21, s61, 6
    s_add_u32 s21, s4, s21
    v_mfma_f32_16x16x32_bf16 v[204:207], v[136:139], a[164:167], v[204:207]
    s_add_u32 s21, s21, 128
    ds_read_b128 v[136:139], v11 offset:6144
    v_mfma_f32_16x16x32_bf16 v[204:207], v[140:143], a[172:175], v[204:207]
    s_mul_i32 s21, s21, 36864
    ds_read_b128 v[140:143], v11 offset:14336
    v_mfma_f32_16x16x32_bf16 v[204:207], v[144:147], a[180:183], v[204:207]
    s_add_u32 s21, s21, s28
    s_mov_b32 m0, s47
    ds_read_b128 v[144:147], v11 offset:22528
    v_mfma_f32_16x16x32_bf16 v[204:207], v[148:151], a[188:191], v[204:207]
    s_add_u32 s20, s20, 4096
    buffer_load_dwordx4 v1, s[56:59], s21 offen sc1 lds
    s_waitcnt lgkmcnt(3)
    v_mfma_f32_16x16x32_bf16 v[208:211], v[104:107], a[160:163], v[208:211]
    ds_read_b128 v[148:151], v11 offset:30720
    v_mfma_f32_16x16x32_bf16 v[208:211], v[108:111], a[168:171], v[208:211]
    v_mfma_f32_16x16x32_bf16 v[208:211], v[112:115], a[176:179], v[208:211]
    buffer_load_dwordx4 v1, s[56:59], s21 offen offset:1024 sc1 lds
    v_mfma_f32_16x16x32_bf16 v[208:211], v[116:119], a[184:187], v[208:211]
    v_mfma_f32_16x16x32_bf16 v[212:215], v[104:107], a[164:167], v[212:215]
    v_mfma_f32_16x16x32_bf16 v[212:215], v[108:111], a[172:175], v[212:215]
    v_mfma_f32_16x16x32_bf16 v[212:215], v[112:115], a[180:183], v[212:215]
    v_mfma_f32_16x16x32_bf16 v[212:215], v[116:119], a[188:191], v[212:215]
    buffer_load_dwordx4 v1, s[56:59], s21 offen offset:2048 sc1 lds
    v_mfma_f32_16x16x32_bf16 v[216:219], v[120:123], a[160:163], v[216:219]
    v_mfma_f32_16x16x32_bf16 v[216:219], v[124:127], a[168:171], v[216:219]
    v_mfma_f32_16x16x32_bf16 v[216:219], v[128:131], a[176:179], v[216:219]
    v_mfma_f32_16x16x32_bf16 v[216:219], v[132:135], a[184:187], v[216:219]
    buffer_load_dwordx4 v1, s[56:59], s21 offen offset:3072 sc1 lds
    s_waitcnt vmcnt(17)
    v_cmp_gt_u32 vcc, 3, v3
    s_nop 1
    s_and_b64 vcc, vcc, exec
    s_cbranch_scc1 SPIN_OA
BACK_OA:
    s_barrier
    v_mfma_f32_16x16x32_bf16 v[220:223], v[120:123], a[164:167], v[220:223]
    s_add_u32 s21, s21, 4096
    ds_read_b128 v[104:107], v12 offset:0
    ds_read_b128 v[108:111], v12 offset:8192
    v_mfma_f32_16x16x32_bf16 v[220:223], v[124:127], a[172:175], v[220:223]
    s_add_u32 m0, s47, 4096
    ds_read_b128 v[112:115], v12 offset:16384
    v_mfma_f32_16x16x32_bf16 v[220:223], v[128:131], a[180:183], v[220:223]
    ds_read_b128 v[116:119], v12 offset:24576
    v_mfma_f32_16x16x32_bf16 v[220:223], v[132:135], a[188:191], v[220:223]
    s_waitcnt lgkmcnt(4)
    buffer_load_dwordx4 v1, s[56:59], s21 offen sc1 lds
    v_mfma_f32_16x16x32_bf16 v[224:227], v[136:139], a[160:163], v[224:227]
    ds_read_b128 v[120:123], v12 offset:1024
    ds_read_b128 v[124:127], v12 offset:9216
    v_mfma_f32_16x16x32_bf16 v[224:227], v[140:143], a[168:171], v[224:227]
    ds_read_b128 v[128:131], v12 offset:17408
    v_mfma_f32_16x16x32_bf16 v[224:227], v[144:147], a[176:179], v[224:227]
    ds_read_b128 v[132:135], v12 offset:25600
    v_mfma_f32_16x16x32_bf16 v[224:227], v[148:151], a[184:187], v[224:227]
    buffer_load_dwordx4 v1, s[56:59], s21 offen offset:1024 sc1 lds
    v_mfma_f32_16x16x32_bf16 v[228:231], v[136:139], a[164:167], v[228:231]
    ds_read_b128 v[136:139], v12 offset:2048
    v_mfma_f32_16x16x32_bf16 v[228:231], v[140:143], a[172:175], v[228:231]
    ds_read_b128 v[140:143], v12 offset:10240
    v_mfma_f32_16x16x32_bf16 v[228:231], v[144:147], a[180:183], v[228:231]
    ds_read_b128 v[144:147], v12 offset:18432
    v_mfma_f32_16x16x32_bf16 v[228:231], v[148:151], a[188:191], v[228:231]
    s_waitcnt lgkmcnt(3)
    buffer_load_dwordx4 v1, s[56:59], s21 offen offset:2048 sc1 lds
    v_mfma_f32_16x16x32_bf16 v[176:179], v[104:107], a[192:195], v[176:179]
    ds_read_b128 v[148:151], v12 offset:26624
    v_mfma_f32_16x16x32_bf16 v[176:179], v[108:111], a[200:203], v[176:179]
    s_mul_i32 s63, s61, 6144
    v_mfma_f32_16x16x32_bf16 v[176:179], v[112:115], a[208:211], v[176:179]
    s_add_u32 s63, s63, 131072
    v_mfma_f32_16x16x32_bf16 v[176:179], v[116:119], a[216:219], v[176:179]
    v_mfma_f32_16x16x32_bf16 v[180:183], v[104:107], a[196:199], v[180:183]
    buffer_load_dwordx4 v[32:35], v4, s[40:43], s63 offen offset:0 sc1
    v_mfma_f32_16x16x32_bf16 v[180:183], v[108:111], a[204:207], v[180:183]
    ds_read_b128 v[104:107], v12 offset:3072
    ds_read_b128 v[108:111], v12 offset:11264
    v_mfma_f32_16x16x32_bf16 v[180:183], v[112:115], a[212:215], v[180:183]
    ds_read_b128 v[112:115], v12 offset:19456
    v_mfma_f32_16x16x32_bf16 v[180:183], v[116:119], a[220:223], v[180:183]
    ds_read_b128 v[116:119], v12 offset:27648
    v_mfma_f32_16x16x32_bf16 v[184:187], v[120:123], a[192:195], v[184:187]
    buffer_load_dwordx4 v[40:43], v4, s[40:43], s63 offen offset:1024 sc1
    v_mfma_f32_16x16x32_bf16 v[184:187], v[124:127], a[200:203], v[184:187]
    v_mfma_f32_16x16x32_bf16 v[184:187], v[128:131], a[208:211], v[184:187]
    v_mfma_f32_16x16x32_bf16 v[184:187], v[132:135], a[216:219], v[184:187]
    v_mfma_f32_16x16x32_bf16 v[188:191], v[120:123], a[196:199], v[188:191]
    buffer_load_dwordx4 v[48:51], v4, s[40:43], s63 offen offset:2048 sc1
    v_mfma_f32_16x16x32_bf16 v[188:191], v[124:127], a[204:207], v[188:191]
    ds_read_b128 v[120:123], v12 offset:4096
    ds_read_b128 v[124:127], v12 offset:12288
    v_mfma_f32_16x16x32_bf16 v[188:191], v[128:131], a[212:215], v[188:191]
    ds_read_b128 v[128:131], v12 offset:20480
    v_mfma_f32_16x16x32_bf16 v[188:191], v[132:135], a[220:223], v[188:191]
    s_waitcnt lgkmcnt(3)
    ds_read_b128 v[132:135], v12 offset:28672
    v_mfma_f32_16x16x32_bf16 v[192:195], v[136:139], a[192:195], v[192:195]
    buffer_load_dwordx4 v[56:59], v4, s[40:43], s63 offen offset:3072 sc1
    v_mfma_f32_16x16x32_bf16 v[192:195], v[140:143], a[200:203], v[192:195]
    s_mul_i32 s20, s61, 6144
    v_mfma_f32_16x16x32_bf16 v[192:195], v[144:147], a[208:211], v[192:195]
    s_add_u32 s20, s20, 131072
    v_mfma_f32_16x16x32_bf16 v[192:195], v[148:151], a[216:219], v[192:195]
    s_add_u32 s63, s63, 4096
    v_mfma_f32_16x16x32_bf16 v[196:199], v[136:139], a[196:199], v[196:199]
    buffer_load_dwordx4 v[36:39], v5, s[40:43], s20 offen offset:0 sc1
    v_mfma_f32_16x16x32_bf16 v[196:199], v[140:143], a[204:207], v[196:199]
    ds_read_b128 v[136:139], v12 offset:5120
    ds_read_b128 v[140:143], v12 offset:13312
    v_mfma_f32_16x16x32_bf16 v[196:199], v[144:147], a[212:215], v[196:199]
    ds_read_b128 v[144:147], v12 offset:21504
    v_mfma_f32_16x16x32_bf16 v[196:199], v[148:151], a[220:223], v[196:199]
    ds_read_b128 v[148:151], v12 offset:29696
    v_mfma_f32_16x16x32_bf16 v[200:203], v[104:107], a[192:195], v[200:203]
    v_mfma_f32_16x16x32_bf16 v[200:203], v[108:111], a[200:203], v[200:203]
    buffer_load_dwordx4 v[44:47], v5, s[40:43], s20 offen offset:1024 sc1
    v_mfma_f32_16x16x32_bf16 v[200:203], v[112:115], a[208:211], v[200:203]
    v_mfma_f32_16x16x32_bf16 v[200:203], v[116:119], a[216:219], v[200:203]
    v_mfma_f32_16x16x32_bf16 v[204:207], v[104:107], a[196:199], v[204:207]
    ds_read_b128 v[104:107], v12 offset:6144
    v_mfma_f32_16x16x32_bf16 v[204:207], v[108:111], a[204:207], v[204:207]
    buffer_load_dwordx4 v[52:55], v5, s[40:43], s20 offen offset:2048 sc1
    v_mfma_f32_16x16x32_bf16 v[204:207], v[112:115], a[212:215], v[204:207]
    ds_read_b128 v[108:111], v12 offset:14336
    ds_read_b128 v[112:115], v12 offset:22528
    v_mfma_f32_16x16x32_bf16 v[204:207], v[116:119], a[220:223], v[204:207]
    s_waitcnt lgkmcnt(3)
    ds_read_b128 v[116:119], v12 offset:30720
    v_mfma_f32_16x16x32_bf16 v[208:211], v[120:123], a[192:195], v[208:211]
    v_mfma_f32_16x16x32_bf16 v[208:211], v[124:127], a[200:203], v[208:211]
    buffer_load_dwordx4 v[60:63], v5, s[40:43], s20 offen offset:3072 sc1
    v_mfma_f32_16x16x32_bf16 v[208:211], v[128:131], a[208:211], v[208:211]
    s_mul_i32 s21, s61, 6
    s_lshr_b32 s64, s4, 1
    s_add_u32 s21, s21, s64
    v_mfma_f32_16x16x32_bf16 v[208:211], v[132:135], a[216:219], v[208:211]
    s_add_u32 s21, s21, 132
    s_mul_i32 s21, s21, 36864
    v_mfma_f32_16x16x32_bf16 v[212:215], v[120:123], a[196:199], v[212:215]
    s_add_u32 s21, s21, s28
    s_and_b32 s64, s69, 4096
    v_mfma_f32_16x16x32_bf16 v[212:215], v[124:127], a[204:207], v[212:215]
    s_add_u32 s21, s21, s64
    s_mov_b32 m0, s79
    v_mfma_f32_16x16x32_bf16 v[212:215], v[128:131], a[212:215], v[212:215]
    s_add_u32 s20, s20, 4096
    buffer_load_dwordx4 v1, s[56:59], s21 offen sc1 lds
    v_mfma_f32_16x16x32_bf16 v[212:215], v[132:135], a[220:223], v[212:215]
    v_mfma_f32_16x16x32_bf16 v[216:219], v[136:139], a[192:195], v[216:219]
    v_mfma_f32_16x16x32_bf16 v[216:219], v[140:143], a[200:203], v[216:219]
    buffer_load_dwordx4 v1, s[56:59], s21 offen offset:1024 sc1 lds
    v_mfma_f32_16x16x32_bf16 v[216:219], v[144:147], a[208:211], v[216:219]
    v_mfma_f32_16x16x32_bf16 v[216:219], v[148:151], a[216:219], v[216:219]
    s_waitcnt vmcnt(17)
    s_barrier
    ds_read_b128 v[120:123], v13 offset:0
    v_mfma_f32_16x16x32_bf16 v[220:223], v[136:139], a[196:199], v[220:223]
    ds_read_b128 v[124:127], v13 offset:8192
    ds_read_b128 v[128:131], v13 offset:16384
    v_mfma_f32_16x16x32_bf16 v[220:223], v[140:143], a[204:207], v[220:223]
    ds_read_b128 v[132:135], v13 offset:24576
    v_mfma_f32_16x16x32_bf16 v[220:223], v[144:147], a[212:215], v[220:223]
    buffer_load_dwordx4 v1, s[56:59], s21 offen offset:2048 sc1 lds
    v_mfma_f32_16x16x32_bf16 v[220:223], v[148:151], a[220:223], v[220:223]
    s_waitcnt lgkmcnt(4)
    ds_read_b128 v[136:139], v13 offset:1024
    ds_read_b128 v[140:143], v13 offset:9216
    v_mfma_f32_16x16x32_bf16 v[224:227], v[104:107], a[192:195], v[224:227]
    ds_read_b128 v[144:147], v13 offset:17408
    v_mfma_f32_16x16x32_bf16 v[224:227], v[108:111], a[200:203], v[224:227]
    ds_read_b128 v[148:151], v13 offset:25600
    v_mfma_f32_16x16x32_bf16 v[224:227], v[112:115], a[208:211], v[224:227]
    buffer_load_dwordx4 v1, s[56:59], s21 offen offset:3072 sc1 lds
    v_mfma_f32_16x16x32_bf16 v[224:227], v[116:119], a[216:219], v[224:227]
    v_mfma_f32_16x16x32_bf16 v[228:231], v[104:107], a[196:199], v[228:231]
    ds_read_b128 v[104:107], v13 offset:2048
    v_mfma_f32_16x16x32_bf16 v[228:231], v[108:111], a[204:207], v[228:231]
    ds_read_b128 v[108:111], v13 offset:10240
    v_mfma_f32_16x16x32_bf16 v[228:231], v[112:115], a[212:215], v[228:231]
    buffer_load_dwordx4 v[64:67], v4, s[40:43], s63 offen offset:0 sc1
    v_mfma_f32_16x16x32_bf16 v[228:231], v[116:119], a[220:223], v[228:231]
    s_waitcnt lgkmcnt(2)
    ds_read_b128 v[112:115], v13 offset:18432
    ds_read_b128 v[116:119], v13 offset:26624
    v_mfma_f32_16x16x32_bf16 v[176:179], v[120:123], a[224:227], v[176:179]
    s_add_u32 s23, s5, 8
    v_lshrrev_b32 v19, 4, v1
    v_min_u32 v19, 2, v19
    v_mfma_f32_16x16x32_bf16 v[176:179], v[124:127], a[232:235], v[176:179]
    s_and_b32 s65, s5, 3
    v_lshl_add_u32 v19, v19, 3, s23
    v_bfe_u32 v20, v1, 4, 4
    v_mfma_f32_16x16x32_bf16 v[176:179], v[128:131], a[240:243], v[176:179]
    s_lshl3_add_u32 s23, s6, s62
    buffer_load_dwordx4 v[72:75], v4, s[40:43], s63 offen offset:1024 sc1
    v_mfma_f32_16x16x32_bf16 v[176:179], v[132:135], a[248:251], v[176:179]
    s_add_u32 s63, s63, 4096
    v_lshrrev_b32 v21, 8, v1
    v_and_b32 v19, 31, v19
    v_mfma_f32_16x16x32_bf16 v[180:183], v[120:123], a[228:231], v[180:183]
    s_lshl_b32 s23, s23, 4
    ds_read_b128 v[120:123], v13 offset:3072
    v_add_u32 v20, s23, v20
    v_mfma_f32_16x16x32_bf16 v[180:183], v[124:127], a[236:239], v[180:183]
    s_mul_i32 s23, s6, 294912
    ds_read_b128 v[124:127], v13 offset:11264
    v_mul_u32_u24 v20, 1152, v20
    v_mfma_f32_16x16x32_bf16 v[180:183], v[128:131], a[244:247], v[180:183]
    s_sub_u32 s23, 2211840, s23
    buffer_load_dwordx4 v[68:71], v5, s[40:43], s20 offen offset:0 sc1
    v_mfma_f32_16x16x32_bf16 v[180:183], v[132:135], a[252:255], v[180:183]
    s_mul_i32 s70, s4, 3072
    ds_read_b128 v[128:131], v13 offset:19456
    ds_read_b128 v[132:135], v13 offset:27648
    v_mfma_f32_16x16x32_bf16 v[184:187], v[136:139], a[224:227], v[184:187]
    s_andn2_b32 s66, s74, 0xfff
    v_lshl_add_u32 v20, v21, 3, v20
    v_add_u32 v21, s23, v20
    v_mfma_f32_16x16x32_bf16 v[184:187], v[140:143], a[232:235], v[184:187]
    s_mul_i32 s23, s101, 288
    v_mov_b32 v31, 3
    v_lshlrev_b32 v23, 20, v1
    v_mfma_f32_16x16x32_bf16 v[184:187], v[144:147], a[240:243], v[184:187]
    s_add_u32 s23, s23, s70
    v_lshlrev_b32 v19, 7, v19
    v_bfe_u32 v92, v1, 6, 2
    v_mfma_f32_16x16x32_bf16 v[184:187], v[148:151], a[248:251], v[184:187]
    s_add_u32 s98, s23, 0
    buffer_load_dwordx4 v[76:79], v5, s[40:43], s20 offen offset:1024 sc1
    v_mfma_f32_16x16x32_bf16 v[188:191], v[136:139], a[228:231], v[188:191]
    s_add_u32 s21, s4, 0
    s_xor_b32 s21, s21, s3
    s_lshl_b32 s21, s21, 2
    v_mfma_f32_16x16x32_bf16 v[188:191], v[140:143], a[236:239], v[188:191]
    s_mul_i32 s21, s21, 36864
    ds_read_b128 v[136:139], v13 offset:4096
    ds_read_b128 v[140:143], v13 offset:12288
    v_mfma_f32_16x16x32_bf16 v[188:191], v[144:147], a[244:247], v[188:191]
    s_add_u32 s21, s21, s28
    ds_read_b128 v[144:147], v13 offset:20480
    v_lshrrev_b32 v93, 8, v1
    v_mfma_f32_16x16x32_bf16 v[188:191], v[148:151], a[252:255], v[188:191]
    s_add_u32 s21, s21, 7168
    s_add_u32 m0, s44, 0
    ds_read_b128 v[148:151], v13 offset:28672
    s_waitcnt lgkmcnt(4)
    v_mfma_f32_16x16x32_bf16 v[192:195], v[104:107], a[224:227], v[192:195]
    s_add_u32 s20, s20, 4096
    buffer_load_dwordx4 v1, s[56:59], s21 offen sc1 lds
    v_mfma_f32_16x16x32_bf16 v[192:195], v[108:111], a[232:235], v[192:195]
    v_cmp_eq_u32 vcc, v92, v93
    v_and_b32 v92, 16, v1
    v_mfma_f32_16x16x32_bf16 v[192:195], v[112:115], a[240:243], v[192:195]
    v_mov_b32 v93, 0x3f80
    v_lshlrev_b32 v92, v92, v93
    v_mfma_f32_16x16x32_bf16 v[192:195], v[116:119], a[248:251], v[192:195]
    buffer_load_dwordx4 v1, s[56:59], s21 offen offset:1024 sc1 lds
    v_mfma_f32_16x16x32_bf16 v[196:199], v[104:107], a[228:231], v[196:199]
    s_add_u32 s21, s21, 36864
    ds_read_b128 v[104:107], v13 offset:5120
    v_and_b32 v93, 32, v1
    v_mfma_f32_16x16x32_bf16 v[196:199], v[108:111], a[236:239], v[196:199]
    s_add_u32 m0, s44, 2048
    ds_read_b128 v[108:111], v13 offset:13312
    v_cndmask_b32 v92, 0, v92, vcc
    v_mfma_f32_16x16x32_bf16 v[196:199], v[112:115], a[244:247], v[196:199]
    ds_read_b128 v[112:115], v13 offset:21504
    v_cmp_eq_u32 vcc, 0, v93
    v_mfma_f32_16x16x32_bf16 v[196:199], v[116:119], a[252:255], v[196:199]
    buffer_load_dwordx4 v1, s[56:59], s21 offen sc1 lds
    v_mfma_f32_16x16x32_bf16 v[200:203], v[120:123], a[224:227], v[200:203]
    ds_read_b128 v[116:119], v13 offset:29696
    v_cndmask_b32 v96, 0, v92, vcc
    v_mfma_f32_16x16x32_bf16 v[200:203], v[124:127], a[232:235], v[200:203]
    v_cndmask_b32_e64 v97, v92, 0, vcc
    v_mov_b32 v98, 0
    v_mfma_f32_16x16x32_bf16 v[200:203], v[128:131], a[240:243], v[200:203]
    v_mov_b32 v99, 0
    v_mov_b32 v100, v96
    v_mfma_f32_16x16x32_bf16 v[200:203], v[132:135], a[248:251], v[200:203]
    buffer_load_dwordx4 v1, s[56:59], s21 offen offset:1024 sc1 lds
    v_mfma_f32_16x16x32_bf16 v[204:207], v[120:123], a[228:231], v[204:207]
    ds_read_b128 v[120:123], v13 offset:6144
    v_mov_b32 v101, v97
    v_mfma_f32_16x16x32_bf16 v[204:207], v[124:127], a[236:239], v[204:207]
    s_add_u32 s21, s21, 36864
    ds_read_b128 v[124:127], v13 offset:14336
    v_mfma_f32_16x16x32_bf16 v[204:207], v[128:131], a[244:247], v[204:207]
    s_add_u32 m0, s44, 4096
    ds_read_b128 v[128:131], v13 offset:22528
    v_mfma_f32_16x16x32_bf16 v[204:207], v[132:135], a[252:255], v[204:207]
    s_waitcnt lgkmcnt(3)
    ds_read_b128 v[132:135], v13 offset:30720
    v_mfma_f32_16x16x32_bf16 v[208:211], v[136:139], a[224:227], v[208:211]
    buffer_load_dwordx4 v1, s[56:59], s21 offen sc1 lds
    v_mfma_f32_16x16x32_bf16 v[208:211], v[140:143], a[232:235], v[208:211]
    v_mfma_f32_16x16x32_bf16 v[208:211], v[144:147], a[240:243], v[208:211]
    v_mfma_f32_16x16x32_bf16 v[208:211], v[148:151], a[248:251], v[208:211]
    v_mfma_f32_16x16x32_bf16 v[212:215], v[136:139], a[228:231], v[212:215]
    buffer_load_dwordx4 v1, s[56:59], s21 offen offset:1024 sc1 lds
    v_mfma_f32_16x16x32_bf16 v[212:215], v[140:143], a[236:239], v[212:215]
    s_add_u32 s21, s21, 36864
    v_mfma_f32_16x16x32_bf16 v[212:215], v[144:147], a[244:247], v[212:215]
    s_add_u32 m0, s44, 6144
    v_mfma_f32_16x16x32_bf16 v[212:215], v[148:151], a[252:255], v[212:215]
    v_mfma_f32_16x16x32_bf16 v[216:219], v[104:107], a[224:227], v[216:219]
    buffer_load_dwordx4 v1, s[56:59], s21 offen sc1 lds
    v_mfma_f32_16x16x32_bf16 v[216:219], v[108:111], a[232:235], v[216:219]
    v_mfma_f32_16x16x32_bf16 v[216:219], v[112:115], a[240:243], v[216:219]
    v_mfma_f32_16x16x32_bf16 v[216:219], v[116:119], a[248:251], v[216:219]
    s_waitcnt vmcnt(15)
    s_barrier
    ds_read_b128 v[136:139], v6 offset:0
    v_mfma_f32_16x16x32_bf16 v[220:223], v[104:107], a[228:231], v[220:223]
    buffer_load_dwordx4 v1, s[56:59], s21 offen offset:1024 sc1 lds
    v_mfma_f32_16x16x32_bf16 v[220:223], v[108:111], a[236:239], v[220:223]
    s_add_u32 s21, s21, 36864
    s_add_u32 s21, s4, 4
    s_xor_b32 s21, s21, s3
    v_mfma_f32_16x16x32_bf16 v[220:223], v[112:115], a[244:247], v[220:223]
    s_lshl_b32 s21, s21, 2
    s_mul_i32 s21, s21, 36864
    ds_read_b128 v[140:143], v6 offset:8192
    v_mfma_f32_16x16x32_bf16 v[220:223], v[116:119], a[252:255], v[220:223]
    s_add_u32 s21, s21, s28
    ds_read_b128 v[144:147], v6 offset:1024
    ds_read_b128 v[148:151], v6 offset:9216
    s_waitcnt lgkmcnt(4)
    v_mfma_f32_16x16x32_bf16 v[224:227], v[120:123], a[224:227], v[224:227]
    s_add_u32 s21, s21, 7168
    s_add_u32 m0, s45, 0
    ds_read_b128 v[104:107], v6 offset:2048
    v_mfma_f32_16x16x32_bf16 v[224:227], v[124:127], a[232:235], v[224:227]
    buffer_load_dwordx4 v1, s[56:59], s21 offen sc1 lds
    v_mfma_f32_16x16x32_bf16 v[224:227], v[128:131], a[240:243], v[224:227]
    ds_read_b128 v[108:111], v6 offset:10240
    ds_read_b128 v[112:115], v6 offset:3072
    v_mfma_f32_16x16x32_bf16 v[224:227], v[132:135], a[248:251], v[224:227]
    ds_read_b128 v[116:119], v6 offset:11264
    v_mfma_f32_16x16x32_bf16 v[228:231], v[120:123], a[228:231], v[228:231]
    ds_read_b128 v[120:123], v6 offset:4096
    v_mfma_f32_16x16x32_bf16 v[228:231], v[124:127], a[236:239], v[228:231]
    buffer_load_dwordx4 v1, s[56:59], s21 offen offset:1024 sc1 lds
    v_mfma_f32_16x16x32_bf16 v[228:231], v[128:131], a[244:247], v[228:231]
    s_add_u32 s21, s21, 36864
    ds_read_b128 v[124:127], v6 offset:12288
    ds_read_b128 v[128:131], v6 offset:5120
    v_mfma_f32_16x16x32_bf16 v[228:231], v[132:135], a[252:255], v[228:231]
    s_add_u32 m0, s45, 2048
    ds_read_b128 v[132:135], v6 offset:13312
    s_waitcnt lgkmcnt(5)
    v_mfma_f32_16x16x32_bf16 v[176:179], v[136:139], v[32:35], v[176:179]
    v_mfma_f32_16x16x32_bf16 v[176:179], v[140:143], v[40:43], v[176:179]
    buffer_load_dwordx4 v1, s[56:59], s21 offen sc1 lds
    v_mfma_f32_16x16x32_bf16 v[180:183], v[136:139], v[36:39], v[180:183]
    ds_read_b128 v[136:139], v6 offset:6144
    v_mfma_f32_16x16x32_bf16 v[180:183], v[140:143], v[44:47], v[180:183]
    ds_read_b128 v[140:143], v6 offset:14336
    v_mfma_f32_16x16x32_bf16 v[184:187], v[144:147], v[32:35], v[184:187]
    v_mfma_f32_16x16x32_bf16 v[184:187], v[148:151], v[40:43], v[184:187]
    buffer_load_dwordx4 v1, s[56:59], s21 offen offset:1024 sc1 lds
    v_mfma_f32_16x16x32_bf16 v[188:191], v[144:147], v[36:39], v[188:191]
    s_add_u32 s21, s21, 36864
    ds_read_b128 v[144:147], v6 offset:16384
    v_mfma_f32_16x16x32_bf16 v[188:191], v[148:151], v[44:47], v[188:191]
    s_add_u32 m0, s45, 4096
    ds_read_b128 v[148:151], v6 offset:24576
    v_mfma_f32_16x16x32_bf16 v[192:195], v[104:107], v[32:35], v[192:195]
    v_mfma_f32_16x16x32_bf16 v[192:195], v[108:111], v[40:43], v[192:195]
    buffer_load_dwordx4 v1, s[56:59], s21 offen sc1 lds
    v_mfma_f32_16x16x32_bf16 v[196:199], v[104:107], v[36:39], v[196:199]
    v_mfma_f32_16x16x32_bf16 v[196:199], v[108:111], v[44:47], v[196:199]
    v_mfma_f32_16x16x32_bf16 v[200:203], v[112:115], v[32:35], v[200:203]
    s_waitcnt lgkmcnt(0)
    v_mfma_f32_16x16x32_bf16 v[200:203], v[116:119], v[40:43], v[200:203]
    buffer_load_dwordx4 v1, s[56:59], s21 offen offset:1024 sc1 lds
    v_mfma_f32_16x16x32_bf16 v[204:207], v[112:115], v[36:39], v[204:207]
    ds_read_b128 v[112:115], v6 offset:17408
    v_mfma_f32_16x16x32_bf16 v[204:207], v[116:119], v[44:47], v[204:207]
    s_waitcnt vmcnt(14)
    s_barrier
    ds_read_b128 v[104:107], v7 offset:0
    v_mfma_f32_16x16x32_bf16 v[208:211], v[120:123], v[32:35], v[208:211]
    s_add_u32 s21, s21, 36864
    ds_read_b128 v[108:111], v7 offset:16384
    ds_read_b128 v[116:119], v6 offset:25600
    v_mfma_f32_16x16x32_bf16 v[208:211], v[124:127], v[40:43], v[208:211]
    s_add_u32 m0, s45, 6144
    v_mfma_f32_16x16x32_bf16 v[212:215], v[120:123], v[36:39], v[212:215]
    buffer_load_dwordx4 v1, s[56:59], s21 offen sc1 lds
    v_mfma_f32_16x16x32_bf16 v[212:215], v[124:127], v[44:47], v[212:215]
    ds_read_b128 v[120:123], v7 offset:1024
    ds_read_b128 v[124:127], v7 offset:17408
    v_mfma_f32_16x16x32_bf16 v[216:219], v[128:131], v[32:35], v[216:219]
    v_mfma_f32_16x16x32_bf16 v[216:219], v[132:135], v[40:43], v[216:219]
    v_mfma_f32_16x16x32_bf16 v[220:223], v[128:131], v[36:39], v[220:223]
    buffer_load_dwordx4 v1, s[56:59], s21 offen offset:1024 sc1 lds
    v_mfma_f32_16x16x32_bf16 v[220:223], v[132:135], v[44:47], v[220:223]
    s_add_u32 s21, s21, 36864
    ds_read_b128 v[128:131], v6 offset:18432
    ds_read_b128 v[132:135], v6 offset:26624
    v_mfma_f32_16x16x32_bf16 v[224:227], v[136:139], v[32:35], v[224:227]
    v_mfma_f32_16x16x32_bf16 v[224:227], v[140:143], v[40:43], v[224:227]
    v_mfma_f32_16x16x32_bf16 v[228:231], v[136:139], v[36:39], v[228:231]
    ds_read_b128 v[136:139], v7 offset:2048
    v_mfma_f32_16x16x32_bf16 v[228:231], v[140:143], v[44:47], v[228:231]
    ds_read_b128 v[140:143], v7 offset:18432
    v_mfma_f32_16x16x32_bf16 v[176:179], v[144:147], v[48:51], v[176:179]
    v_mfma_f32_16x16x32_bf16 v[176:179], v[148:151], v[56:59], v[176:179]
    s_waitcnt lgkmcnt(2)
    v_mfma_f32_16x16x32_bf16 v[176:179], v[104:107], v[64:67], v[176:179]
    v_mfma_f32_16x16x32_bf16 v[176:179], v[108:111], v[72:75], v[176:179]
    v_mfma_f32_16x16x32_bf16 v[180:183], v[144:147], v[52:55], v[180:183]
    ds_read_b128 v[144:147], v6 offset:19456
    v_mfma_f32_16x16x32_bf16 v[180:183], v[148:151], v[60:63], v[180:183]
    ds_read_b128 v[148:151], v6 offset:27648
    v_mfma_f32_16x16x32_bf16 v[180:183], v[104:107], v[68:71], v[180:183]
    ds_read_b128 v[104:107], v7 offset:3072
    v_mfma_f32_16x16x32_bf16 v[180:183], v[108:111], v[76:79], v[180:183]
    ds_read_b128 v[108:111], v7 offset:19456
    v_cvt_pk_bf16_f32 v232, v176, v177
    v_mfma_f32_16x16x32_bf16 v[184:187], v[112:115], v[48:51], v[184:187]
    v_cvt_pk_bf16_f32 v233, v178, v179
    v_mfma_f32_16x16x32_bf16 v[184:187], v[116:119], v[56:59], v[184:187]
    v_mfma_f32_16x16x32_bf16 v[184:187], v[120:123], v[64:67], v[184:187]
    v_mfma_f32_16x16x32_bf16 v[184:187], v[124:127], v[72:75], v[184:187]
    v_mfma_f32_16x16x32_bf16 v[188:191], v[112:115], v[52:55], v[188:191]
    v_cvt_pk_bf16_f32 v234, v180, v181
    v_cvt_pk_bf16_f32 v235, v182, v183
    v_mfma_f32_16x16x32_bf16 v[188:191], v[116:119], v[60:63], v[188:191]
    buffer_store_dwordx4 v[232:235], v1, s[48:51], s8 offen offset:0 sc1
    v_mfma_f32_16x16x32_bf16 v[188:191], v[120:123], v[68:71], v[188:191]
    ds_read_b128 v[112:115], v6 offset:20480
    ds_read_b128 v[116:119], v6 offset:28672
    v_mfma_f32_16x16x32_bf16 v[188:191], v[124:127], v[76:79], v[188:191]
    v_cvt_pk_bf16_f32 v236, v184, v185
    v_cvt_pk_bf16_f32 v237, v186, v187
    v_mfma_f32_16x16x32_bf16 v[192:195], v[128:131], v[48:51], v[192:195]
    ds_read_b128 v[120:123], v7 offset:8192
    ds_read_b128 v[124:127], v7 offset:24576
    v_mfma_f32_16x16x32_bf16 v[192:195], v[132:135], v[56:59], v[192:195]
    s_waitcnt lgkmcnt(4)
    v_mfma_f32_16x16x32_bf16 v[192:195], v[136:139], v[64:67], v[192:195]
    v_mfma_f32_16x16x32_bf16 v[192:195], v[140:143], v[72:75], v[192:195]
    v_cvt_pk_bf16_f32 v238, v188, v189
    v_cvt_pk_bf16_f32 v239, v190, v191
    v_mfma_f32_16x16x32_bf16 v[196:199], v[128:131], v[52:55], v[196:199]
    buffer_store_dwordx4 v[236:239], v1, s[48:51], s8 offen offset:1024 sc1
    v_mfma_f32_16x16x32_bf16 v[196:199], v[132:135], v[60:63], v[196:199]
    ds_read_b128 v[128:131], v6 offset:21504
    ds_read_b128 v[132:135], v6 offset:29696
    v_mfma_f32_16x16x32_bf16 v[196:199], v[136:139], v[68:71], v[196:199]
    v_cvt_pk_bf16_f32 v240, v192, v193
    v_cvt_pk_bf16_f32 v241, v194, v195
    v_mfma_f32_16x16x32_bf16 v[196:199], v[140:143], v[76:79], v[196:199]
    ds_read_b128 v[136:139], v7 offset:9216
    ds_read_b128 v[140:143], v7 offset:25600
    v_mfma_f32_16x16x32_bf16 v[200:203], v[144:147], v[48:51], v[200:203]
    v_mfma_f32_16x16x32_bf16 v[200:203], v[148:151], v[56:59], v[200:203]
    v_mfma_f32_16x16x32_bf16 v[200:203], v[104:107], v[64:67], v[200:203]
    v_mfma_f32_16x16x32_bf16 v[200:203], v[108:111], v[72:75], v[200:203]
    v_mfma_f32_16x16x32_bf16 v[204:207], v[144:147], v[52:55], v[204:207]
    ds_read_b128 v[144:147], v6 offset:22528
    v_cvt_pk_bf16_f32 v242, v196, v197
    v_mfma_f32_16x16x32_bf16 v[204:207], v[148:151], v[60:63], v[204:207]
    v_cvt_pk_bf16_f32 v243, v198, v199
    ds_read_b128 v[148:151], v6 offset:30720
    v_mfma_f32_16x16x32_bf16 v[204:207], v[104:107], v[68:71], v[204:207]
    buffer_store_dwordx4 v[240:243], v1, s[48:51], s9 offen offset:0 sc1
    v_mfma_f32_16x16x32_bf16 v[204:207], v[108:111], v[76:79], v[204:207]
    s_waitcnt lgkmcnt(2)
    v_cvt_pk_bf16_f32 v244, v200, v201
    v_cvt_pk_bf16_f32 v245, v202, v203
    v_mfma_f32_16x16x32_bf16 v[208:211], v[112:115], v[48:51], v[208:211]
    ds_read_b128 v[104:107], v7 offset:10240
    ds_read_b128 v[108:111], v7 offset:26624
    v_mfma_f32_16x16x32_bf16 v[208:211], v[116:119], v[56:59], v[208:211]
    v_mfma_f32_16x16x32_bf16 v[208:211], v[120:123], v[64:67], v[208:211]
    v_mfma_f32_16x16x32_bf16 v[208:211], v[124:127], v[72:75], v[208:211]
    v_cvt_pk_bf16_f32 v246, v204, v205
    v_cvt_pk_bf16_f32 v247, v206, v207
    v_mfma_f32_16x16x32_bf16 v[212:215], v[112:115], v[52:55], v[212:215]
    buffer_store_dwordx4 v[244:247], v1, s[48:51], s9 offen offset:1024 sc1
    v_mfma_f32_16x16x32_bf16 v[212:215], v[116:119], v[60:63], v[212:215]
    v_mfma_f32_16x16x32_bf16 v[212:215], v[120:123], v[68:71], v[212:215]
    v_mfma_f32_16x16x32_bf16 v[212:215], v[124:127], v[76:79], v[212:215]
    v_mfma_f32_16x16x32_bf16 v[216:219], v[128:131], v[48:51], v[216:219]
    v_cvt_pk_bf16_f32 v232, v208, v209
    v_cvt_pk_bf16_f32 v233, v210, v211
    v_mfma_f32_16x16x32_bf16 v[216:219], v[132:135], v[56:59], v[216:219]
    v_mfma_f32_16x16x32_bf16 v[216:219], v[136:139], v[64:67], v[216:219]
    v_mfma_f32_16x16x32_bf16 v[216:219], v[140:143], v[72:75], v[216:219]
    s_waitcnt vmcnt(12)
    s_barrier
    v_cvt_pk_bf16_f32 v234, v212, v213
    v_mfma_f32_16x16x32_bf16 v[220:223], v[128:131], v[52:55], v[220:223]
    v_cvt_pk_bf16_f32 v235, v214, v215
    ds_read_b128 v[112:115], v11 offset:0
    v_mfma_f32_16x16x32_bf16 v[220:223], v[132:135], v[60:63], v[220:223]
    buffer_store_dwordx4 v[232:235], v1, s[48:51], s10 offen offset:0 sc1
    v_mfma_f32_16x16x32_bf16 v[220:223], v[136:139], v[68:71], v[220:223]
    ds_read_b128 v[116:119], v11 offset:2048
    ds_read_b128 v[120:123], v11 offset:4096
    v_mfma_f32_16x16x32_bf16 v[220:223], v[140:143], v[76:79], v[220:223]
    s_waitcnt lgkmcnt(3)
    ds_read_b128 v[124:127], v11 offset:6144
    v_cvt_pk_bf16_f32 v236, v216, v217
    v_mfma_f32_16x16x32_bf16 v[224:227], v[144:147], v[48:51], v[224:227]
    v_cvt_pk_bf16_f32 v237, v218, v219
    ds_read_b128 v[128:131], v11 offset:1024
    v_mfma_f32_16x16x32_bf16 v[224:227], v[148:151], v[56:59], v[224:227]
    ds_read_b128 v[132:135], v11 offset:3072
    v_mfma_f32_16x16x32_bf16 v[224:227], v[104:107], v[64:67], v[224:227]
    v_cvt_pk_bf16_f32 v238, v220, v221
    v_cvt_pk_bf16_f32 v239, v222, v223
    v_mfma_f32_16x16x32_bf16 v[224:227], v[108:111], v[72:75], v[224:227]
    buffer_store_dwordx4 v[236:239], v1, s[48:51], s10 offen offset:1024 sc1
    v_mfma_f32_16x16x32_bf16 v[228:231], v[144:147], v[52:55], v[228:231]
    ds_read_b128 v[136:139], v11 offset:5120
    ds_read_b128 v[140:143], v11 offset:7168
    v_mfma_f32_16x16x32_bf16 v[228:231], v[148:151], v[60:63], v[228:231]
    ds_read_b128 v[144:147], v11 offset:8192
    v_mfma_f32_16x16x32_bf16 v[228:231], v[104:107], v[68:71], v[228:231]
    ds_read_b128 v[148:151], v11 offset:10240
    v_cvt_pk_bf16_f32 v240, v224, v225
    v_mfma_f32_16x16x32_bf16 v[228:231], v[108:111], v[76:79], v[228:231]
    s_waitcnt lgkmcnt(4)
    v_cvt_pk_bf16_f32 v241, v226, v227
    ds_read_b128 v[104:107], v11 offset:12288
    v_mfma_f32_16x16x32_bf16 v[160:163], v[112:115], a[0:3], 0
    ds_read_b128 v[108:111], v11 offset:14336
    v_mfma_f32_16x16x32_bf16 v[160:163], v[116:119], a[8:11], v[160:163]
    v_mfma_f32_16x16x32_bf16 v[160:163], v[120:123], a[16:19], v[160:163]
    v_mfma_f32_16x16x32_bf16 v[160:163], v[124:127], a[24:27], v[160:163]
    v_mfma_f32_16x16x32_bf16 v[164:167], v[112:115], a[4:7], 0
    v_cvt_pk_bf16_f32 v242, v228, v229
    v_cvt_pk_bf16_f32 v243, v230, v231
    v_mfma_f32_16x16x32_bf16 v[164:167], v[116:119], a[12:15], v[164:167]
    buffer_store_dwordx4 v[240:243], v1, s[48:51], s11 offen offset:2048 sc1
    v_mfma_f32_16x16x32_bf16 v[164:167], v[120:123], a[20:23], v[164:167]
    ds_read_b128 v[112:115], v11 offset:9216
    ds_read_b128 v[116:119], v11 offset:11264
    v_mfma_f32_16x16x32_bf16 v[164:167], v[124:127], a[28:31], v[164:167]
    ds_read_b128 v[120:123], v11 offset:13312
    v_mfma_f32_16x16x32_bf16 v[168:171], v[128:131], a[0:3], 0
    ds_read_b128 v[124:127], v11 offset:15360
    v_mfma_f32_16x16x32_bf16 v[168:171], v[132:135], a[8:11], v[168:171]
    s_waitcnt lgkmcnt(4)
    v_mfma_f32_16x16x32_bf16 v[168:171], v[136:139], a[16:19], v[168:171]
    v_mfma_f32_16x16x32_bf16 v[168:171], v[140:143], a[24:27], v[168:171]
    v_mfma_f32_16x16x32_bf16 v[172:175], v[128:131], a[4:7], 0
    ds_read_b128 v[128:131], v11 offset:16384
    v_mfma_f32_16x16x32_bf16 v[172:175], v[132:135], a[12:15], v[172:175]
    ds_read_b128 v[132:135], v11 offset:18432
    v_mfma_f32_16x16x32_bf16 v[172:175], v[136:139], a[20:23], v[172:175]
    ds_read_b128 v[136:139], v11 offset:20480
    v_mfma_f32_16x16x32_bf16 v[172:175], v[140:143], a[28:31], v[172:175]
    ds_read_b128 v[140:143], v11 offset:22528
    v_mfma_f32_16x16x32_bf16 v[160:163], v[144:147], a[32:35], v[160:163]
    v_mfma_f32_16x16x32_bf16 v[160:163], v[148:151], a[40:43], v[160:163]
    v_mfma_f32_16x16x32_bf16 v[160:163], v[104:107], a[48:51], v[160:163]
    v_mfma_f32_16x16x32_bf16 v[160:163], v[108:111], a[56:59], v[160:163]
    v_mfma_f32_16x16x32_bf16 v[164:167], v[144:147], a[36:39], v[164:167]
    ds_read_b128 v[144:147], v11 offset:17408
    v_mfma_f32_16x16x32_bf16 v[164:167], v[148:151], a[44:47], v[164:167]
    ds_read_b128 v[148:151], v11 offset:19456
    v_mfma_f32_16x16x32_bf16 v[164:167], v[104:107], a[52:55], v[164:167]
    ds_read_b128 v[104:107], v11 offset:21504
    v_mfma_f32_16x16x32_bf16 v[164:167], v[108:111], a[60:63], v[164:167]
    s_waitcnt lgkmcnt(3)
    ds_read_b128 v[108:111], v11 offset:23552
    v_mfma_f32_16x16x32_bf16 v[168:171], v[112:115], a[32:35], v[168:171]
    v_mfma_f32_16x16x32_bf16 v[168:171], v[116:119], a[40:43], v[168:171]
    v_mfma_f32_16x16x32_bf16 v[168:171], v[120:123], a[48:51], v[168:171]
    v_mfma_f32_16x16x32_bf16 v[168:171], v[124:127], a[56:59], v[168:171]
    v_mfma_f32_16x16x32_bf16 v[172:175], v[112:115], a[36:39], v[172:175]
    ds_read_b128 v[112:115], v11 offset:24576
    v_mfma_f32_16x16x32_bf16 v[172:175], v[116:119], a[44:47], v[172:175]
    ds_read_b128 v[116:119], v11 offset:26624
    v_mfma_f32_16x16x32_bf16 v[172:175], v[120:123], a[52:55], v[172:175]
    ds_read_b128 v[120:123], v11 offset:28672
    v_mfma_f32_16x16x32_bf16 v[172:175], v[124:127], a[60:63], v[172:175]
    ds_read_b128 v[124:127], v11 offset:30720
    v_mfma_f32_16x16x32_bf16 v[160:163], v[128:131], a[64:67], v[160:163]
    v_mfma_f32_16x16x32_bf16 v[160:163], v[132:135], a[72:75], v[160:163]
    v_mfma_f32_16x16x32_bf16 v[160:163], v[136:139], a[80:83], v[160:163]
    v_mfma_f32_16x16x32_bf16 v[160:163], v[140:143], a[88:91], v[160:163]
    v_mfma_f32_16x16x32_bf16 v[164:167], v[128:131], a[68:71], v[164:167]
    ds_read_b128 v[128:131], v11 offset:25600
    v_mfma_f32_16x16x32_bf16 v[164:167], v[132:135], a[76:79], v[164:167]
    ds_read_b128 v[132:135], v11 offset:27648
    v_mfma_f32_16x16x32_bf16 v[164:167], v[136:139], a[84:87], v[164:167]
    ds_read_b128 v[136:139], v11 offset:29696
    v_mfma_f32_16x16x32_bf16 v[164:167], v[140:143], a[92:95], v[164:167]
    s_waitcnt lgkmcnt(3)
    ds_read_b128 v[140:143], v11 offset:31744
    v_mfma_f32_16x16x32_bf16 v[168:171], v[144:147], a[64:67], v[168:171]
    v_mfma_f32_16x16x32_bf16 v[168:171], v[148:151], a[72:75], v[168:171]
    v_mfma_f32_16x16x32_bf16 v[168:171], v[104:107], a[80:83], v[168:171]
    v_mfma_f32_16x16x32_bf16 v[168:171], v[108:111], a[88:91], v[168:171]
    v_mfma_f32_16x16x32_bf16 v[172:175], v[144:147], a[68:71], v[172:175]
    v_mfma_f32_16x16x32_bf16 v[172:175], v[148:151], a[76:79], v[172:175]
    v_mfma_f32_16x16x32_bf16 v[172:175], v[104:107], a[84:87], v[172:175]
    v_mfma_f32_16x16x32_bf16 v[172:175], v[108:111], a[92:95], v[172:175]
    v_mfma_f32_16x16x32_bf16 v[160:163], v[112:115], a[96:99], v[160:163]
    v_mfma_f32_16x16x32_bf16 v[160:163], v[116:119], a[104:107], v[160:163]
    v_mfma_f32_16x16x32_bf16 v[160:163], v[120:123], a[112:115], v[160:163]
    s_waitcnt vmcnt(0)
    buffer_store_dword v31, v23, s[32:35], s74 offen sc1
    v_mfma_f32_16x16x32_bf16 v[160:163], v[124:127], a[120:123], v[160:163]
    s_waitcnt vmcnt(8)
    s_barrier
    ds_read_b128 v[144:147], v12 offset:0
    v_mfma_f32_16x16x32_bf16 v[164:167], v[112:115], a[100:103], v[164:167]
    ds_read_b128 v[148:151], v12 offset:2048
    ds_read_b128 v[104:107], v12 offset:4096
    v_mfma_f32_16x16x32_bf16 v[164:167], v[116:119], a[108:111], v[164:167]
    ds_read_b128 v[108:111], v12 offset:6144
    v_mfma_f32_16x16x32_bf16 v[164:167], v[120:123], a[116:119], v[164:167]
    ds_read_b128 v[112:115], v12 offset:1024
    v_mfma_f32_16x16x32_bf16 v[164:167], v[124:127], a[124:127], v[164:167]
    s_lshr_b32 s64, s4, 1
    s_lshl1_add_u32 s21, s61, s64
    s_mul_i32 s21, s21, 3
    s_waitcnt lgkmcnt(5)
    v_mfma_f32_16x16x32_bf16 v[168:171], v[128:131], a[96:99], v[168:171]
    s_add_u32 s21, s21, 128
    s_mul_i32 s21, s21, 36864
    s_add_u32 s21, s21, s28
    v_mfma_f32_16x16x32_bf16 v[168:171], v[132:135], a[104:107], v[168:171]
    s_add_u32 s21, s21, 7168
    s_and_b32 s64, s68, 1024
    s_add_u32 s21, s21, s64
    v_mfma_f32_16x16x32_bf16 v[168:171], v[136:139], a[112:115], v[168:171]
    s_add_u32 m0, s46, 0
    ds_read_b128 v[116:119], v12 offset:3072
    ds_read_b128 v[120:123], v12 offset:5120
    v_mfma_f32_16x16x32_bf16 v[168:171], v[140:143], a[120:123], v[168:171]
    s_lshl2_add_u32 s64, s61, s65
    buffer_load_dwordx4 v1, s[56:59], s21 offen sc1 lds
    v_mfma_f32_16x16x32_bf16 v[172:175], v[128:131], a[100:103], v[172:175]
    s_add_u32 s21, s21, 36864
    ds_read_b128 v[124:127], v12 offset:7168
    ds_read_b128 v[128:131], v12 offset:8192
    v_mfma_f32_16x16x32_bf16 v[172:175], v[132:135], a[108:111], v[172:175]
    s_add_u32 m0, s46, 1024
    ds_read_b128 v[132:135], v12 offset:10240
    s_lshl_b32 s65, s65, 5
    v_mfma_f32_16x16x32_bf16 v[172:175], v[136:139], a[116:119], v[172:175]
    s_add_u32 s65, s65, 1024
    buffer_load_dwordx4 v1, s[56:59], s21 offen sc1 lds
    v_mfma_f32_16x16x32_bf16 v[172:175], v[140:143], a[124:127], v[172:175]
    s_add_u32 s21, s21, 36864
    ds_read_b128 v[136:139], v12 offset:12288
    ds_read_b128 v[140:143], v12 offset:14336
    s_waitcnt lgkmcnt(5)
    v_mfma_f32_16x16x32_bf16 v[160:163], v[144:147], a[128:131], v[160:163]
    s_add_u32 m0, s46, 2048
    s_lshl_b32 s64, s64, 6
    v_mfma_f32_16x16x32_bf16 v[160:163], v[148:151], a[136:139], v[160:163]
    s_cmp_eq_u32 s4, s61
    s_cselect_b32 s65, s65, 1073741824
    s_cselect_b32 s70, s23, 1073741824
    v_mfma_f32_16x16x32_bf16 v[160:163], v[104:107], a[144:147], v[160:163]
    buffer_load_dwordx4 v1, s[56:59], s21 offen sc1 lds
    v_mfma_f32_16x16x32_bf16 v[160:163], v[108:111], a[152:155], v[160:163]
    s_add_u32 s21, s21, 36864
    v_mfma_f32_16x16x32_bf16 v[164:167], v[144:147], a[132:135], v[164:167]
    ds_read_b128 v[144:147], v12 offset:9216
    v_mfma_f32_16x16x32_bf16 v[164:167], v[148:151], a[140:143], v[164:167]
    ds_read_b128 v[148:151], v12 offset:11264
    v_mfma_f32_16x16x32_bf16 v[164:167], v[104:107], a[148:151], v[164:167]
    ds_read_b128 v[104:107], v12 offset:13312
    v_mfma_f32_16x16x32_bf16 v[164:167], v[108:111], a[156:159], v[164:167]
    ds_read_b128 v[108:111], v12 offset:15360
    v_mfma_f32_16x16x32_bf16 v[168:171], v[112:115], a[128:131], v[168:171]
    v_mfma_f32_16x16x32_bf16 v[168:171], v[116:119], a[136:139], v[168:171]
    v_mfma_f32_16x16x32_bf16 v[168:171], v[120:123], a[144:147], v[168:171]
    s_waitcnt lgkmcnt(2)
    v_mfma_f32_16x16x32_bf16 v[168:171], v[124:127], a[152:155], v[168:171]
    v_mfma_f32_16x16x32_bf16 v[172:175], v[112:115], a[132:135], v[172:175]
    ds_read_b128 v[112:115], v12 offset:16384
    v_mfma_f32_16x16x32_bf16 v[172:175], v[116:119], a[140:143], v[172:175]
    ds_read_b128 v[116:119], v12 offset:18432
    v_mfma_f32_16x16x32_bf16 v[172:175], v[120:123], a[148:151], v[172:175]
    ds_read_b128 v[120:123], v12 offset:20480
    v_mfma_f32_16x16x32_bf16 v[172:175], v[124:127], a[156:159], v[172:175]
    ds_read_b128 v[124:127], v12 offset:22528
    v_mfma_f32_16x16x32_bf16 v[160:163], v[128:131], a[160:163], v[160:163]
    v_mfma_f32_16x16x32_bf16 v[160:163], v[132:135], a[168:171], v[160:163]
    v_mfma_f32_16x16x32_bf16 v[160:163], v[136:139], a[176:179], v[160:163]
    v_mfma_f32_16x16x32_bf16 v[160:163], v[140:143], a[184:187], v[160:163]
    v_mfma_f32_16x16x32_bf16 v[164:167], v[128:131], a[164:167], v[164:167]
    ds_read_b128 v[128:131], v12 offset:17408
    v_mfma_f32_16x16x32_bf16 v[164:167], v[132:135], a[172:175], v[164:167]
    buffer_load_dword v3, v19, s[32:35], s66 offen sc1
    v_mfma_f32_16x16x32_bf16 v[164:167], v[136:139], a[180:183], v[164:167]
    ds_read_b128 v[132:135], v12 offset:19456
    ds_read_b128 v[136:139], v12 offset:21504
    v_mfma_f32_16x16x32_bf16 v[164:167], v[140:143], a[188:191], v[164:167]
    ds_read_b128 v[140:143], v12 offset:23552
    v_mfma_f32_16x16x32_bf16 v[168:171], v[144:147], a[160:163], v[168:171]
    v_mfma_f32_16x16x32_bf16 v[168:171], v[148:151], a[168:171], v[168:171]
    s_waitcnt lgkmcnt(3)
    v_mfma_f32_16x16x32_bf16 v[168:171], v[104:107], a[176:179], v[168:171]
    v_mfma_f32_16x16x32_bf16 v[168:171], v[108:111], a[184:187], v[168:171]
    v_mfma_f32_16x16x32_bf16 v[172:175], v[144:147], a[164:167], v[172:175]
    ds_read_b128 v[144:147], v12 offset:24576
    v_mfma_f32_16x16x32_bf16 v[172:175], v[148:151], a[172:175], v[172:175]
    ds_read_b128 v[148:151], v12 offset:26624
    v_mfma_f32_16x16x32_bf16 v[172:175], v[104:107], a[180:183], v[172:175]
    ds_read_b128 v[104:107], v12 offset:28672
    v_mfma_f32_16x16x32_bf16 v[172:175], v[108:111], a[188:191], v[172:175]
    ds_read_b128 v[108:111], v12 offset:30720
    v_mfma_f32_16x16x32_bf16 v[160:163], v[112:115], a[192:195], v[160:163]
    v_mfma_f32_16x16x32_bf16 v[160:163], v[116:119], a[200:203], v[160:163]
    v_mfma_f32_16x16x32_bf16 v[160:163], v[120:123], a[208:211], v[160:163]
    v_mfma_f32_16x16x32_bf16 v[160:163], v[124:127], a[216:219], v[160:163]
    v_mfma_f32_16x16x32_bf16 v[164:167], v[112:115], a[196:199], v[164:167]
    ds_read_b128 v[112:115], v12 offset:25600
    v_mfma_f32_16x16x32_bf16 v[164:167], v[116:119], a[204:207], v[164:167]
    ds_read_b128 v[116:119], v12 offset:27648
    v_mfma_f32_16x16x32_bf16 v[164:167], v[120:123], a[212:215], v[164:167]
    ds_read_b128 v[120:123], v12 offset:29696
    v_mfma_f32_16x16x32_bf16 v[164:167], v[124:127], a[220:223], v[164:167]
    ds_read_b128 v[124:127], v12 offset:31744
    v_mfma_f32_16x16x32_bf16 v[168:171], v[128:131], a[192:195], v[168:171]
    s_waitcnt lgkmcnt(4)
    v_mfma_f32_16x16x32_bf16 v[168:171], v[132:135], a[200:203], v[168:171]
    v_mfma_f32_16x16x32_bf16 v[168:171], v[136:139], a[208:211], v[168:171]
    v_mfma_f32_16x16x32_bf16 v[168:171], v[140:143], a[216:219], v[168:171]
    v_mfma_f32_16x16x32_bf16 v[172:175], v[128:131], a[196:199], v[172:175]
    v_mfma_f32_16x16x32_bf16 v[172:175], v[132:135], a[204:207], v[172:175]
    v_mfma_f32_16x16x32_bf16 v[172:175], v[136:139], a[212:215], v[172:175]
    v_mfma_f32_16x16x32_bf16 v[172:175], v[140:143], a[220:223], v[172:175]
    v_mfma_f32_16x16x32_bf16 v[160:163], v[144:147], a[224:227], v[160:163]
    s_waitcnt vmcnt(0)
    v_cmp_gt_u32 vcc, 3, v3
    s_nop 1
    s_and_b64 vcc, vcc, exec
    s_cbranch_scc1 SPIN_X
BACK_X:
    v_mfma_f32_16x16x32_bf16 v[160:163], v[148:151], a[232:235], v[160:163]
    buffer_load_dwordx4 v[176:179], v1, s[48:51], s98 offen offset:0 sc1
    v_mfma_f32_16x16x32_bf16 v[160:163], v[104:107], a[240:243], v[160:163]
    s_add_u32 s98, s23, 12288
    buffer_load_dwordx4 v[180:183], v1, s[48:51], s98 offen offset:0 sc1
    v_mfma_f32_16x16x32_bf16 v[160:163], v[108:111], a[248:251], v[160:163]
    s_waitcnt vmcnt(3)
    s_barrier
    ds_read_b128 v[128:131], v13 offset:0
    v_mfma_f32_16x16x32_bf16 v[164:167], v[144:147], a[228:231], v[164:167]
    s_add_u32 s98, s23, 24576
    ds_read_b128 v[132:135], v13 offset:1024
    ds_read_b128 v[136:139], v13 offset:2048
    v_mfma_f32_16x16x32_bf16 v[164:167], v[148:151], a[236:239], v[164:167]
    buffer_load_dwordx4 v[184:187], v1, s[48:51], s98 offen offset:0 sc1
    v_mfma_f32_16x16x32_bf16 v[164:167], v[104:107], a[244:247], v[164:167]
    s_add_u32 s98, s23, 0
    ds_read_b128 v[140:143], v13 offset:8192
    ds_read_b128 v[144:147], v13 offset:9216
    v_mfma_f32_16x16x32_bf16 v[164:167], v[108:111], a[252:255], v[164:167]
    s_waitcnt lgkmcnt(5)
    ds_read_b128 v[148:151], v13 offset:10240
    v_mfma_f32_16x16x32_bf16 v[168:171], v[112:115], a[224:227], v[168:171]
    ds_read_b128 v[104:107], v13 offset:16384
    v_mfma_f32_16x16x32_bf16 v[168:171], v[116:119], a[232:235], v[168:171]
    buffer_load_dwordx4 v[188:191], v1, s[48:51], s98 offen offset:1024 sc1
    v_mfma_f32_16x16x32_bf16 v[168:171], v[120:123], a[240:243], v[168:171]
    s_add_u32 s98, s23, 12288
    ds_read_b128 v[108:111], v13 offset:17408
    v_mfma_f32_16x16x32_bf16 v[168:171], v[124:127], a[248:251], v[168:171]
    v_mfma_f32_16x16x32_bf16 v[172:175], v[112:115], a[228:231], v[172:175]
    ds_read_b128 v[112:115], v13 offset:18432
    v_mfma_f32_16x16x32_bf16 v[172:175], v[116:119], a[236:239], v[172:175]
    buffer_load_dwordx4 v[192:195], v1, s[48:51], s98 offen offset:1024 sc1
    v_mfma_f32_16x16x32_bf16 v[172:175], v[120:123], a[244:247], v[172:175]
    s_add_u32 s98, s23, 24576
    ds_read_b128 v[116:119], v13 offset:24576
    ds_read_b128 v[120:123], v13 offset:25600
    v_mfma_f32_16x16x32_bf16 v[172:175], v[124:127], a[252:255], v[172:175]
    s_waitcnt lgkmcnt(3)
    ds_read_b128 v[124:127], v13 offset:26624
    v_mfma_f32_16x16x32_bf16 v[160:163], v[128:131], v[32:35], v[160:163]
    v_mfma_f32_16x16x32_bf16 v[160:163], v[132:135], v[40:43], v[160:163]
    buffer_load_dwordx4 v[196:199], v1, s[48:51], s98 offen offset:1024 sc1
    v_mfma_f32_16x16x32_bf16 v[160:163], v[136:139], v[48:51], v[160:163]
    s_add_u32 s98, s70, 0
    v_mfma_f32_16x16x32_bf16 v[164:167], v[128:131], v[36:39], v[164:167]
    v_mfma_f32_16x16x32_bf16 v[164:167], v[132:135], v[44:47], v[164:167]
    v_mfma_f32_16x16x32_bf16 v[164:167], v[136:139], v[52:55], v[164:167]
    buffer_load_dwordx4 v[200:203], v1, s[48:51], s98 offen offset:2048 sc1
    v_mfma_f32_16x16x32_bf16 v[168:171], v[140:143], v[32:35], v[168:171]
    s_add_u32 s98, s70, 12288
    v_mfma_f32_16x16x32_bf16 v[168:171], v[144:147], v[40:43], v[168:171]
    v_mfma_f32_16x16x32_bf16 v[168:171], v[148:151], v[48:51], v[168:171]
    v_mfma_f32_16x16x32_bf16 v[172:175], v[140:143], v[36:39], v[172:175]
    buffer_load_dwordx4 v[204:207], v1, s[48:51], s98 offen offset:2048 sc1
    v_mfma_f32_16x16x32_bf16 v[172:175], v[144:147], v[44:47], v[172:175]
    s_add_u32 s98, s70, 24576
    v_mfma_f32_16x16x32_bf16 v[172:175], v[148:151], v[52:55], v[172:175]
    v_mfma_f32_16x16x32_bf16 v[160:163], v[104:107], v[56:59], v[160:163]
    v_mfma_f32_16x16x32_bf16 v[160:163], v[108:111], v[64:67], v[160:163]
    s_waitcnt lgkmcnt(0)
    buffer_load_dwordx4 v[208:211], v1, s[48:51], s98 offen offset:2048 sc1
    v_mfma_f32_16x16x32_bf16 v[160:163], v[112:115], v[72:75], v[160:163]
    v_mfma_f32_16x16x32_bf16 v[164:167], v[104:107], v[60:63], v[164:167]
    v_mfma_f32_16x16x32_bf16 v[164:167], v[108:111], v[68:71], v[164:167]
    v_mfma_f32_16x16x32_bf16 v[164:167], v[112:115], v[76:79], v[164:167]
    v_mfma_f32_16x16x32_bf16 v[168:171], v[116:119], v[56:59], v[168:171]
    v_mfma_f32_16x16x32_bf16 v[168:171], v[120:123], v[64:67], v[168:171]
    v_mfma_f32_16x16x32_bf16 v[168:171], v[124:127], v[72:75], v[168:171]
    v_mfma_f32_16x16x32_bf16 v[172:175], v[116:119], v[60:63], v[172:175]
    v_mfma_f32_16x16x32_bf16 v[172:175], v[120:123], v[68:71], v[172:175]
    v_mfma_f32_16x16x32_bf16 v[172:175], v[124:127], v[76:79], v[172:175]
    s_waitcnt vmcnt(6)
    v_mfma_f32_16x16x32_bf16 v[160:163], v[96:99], v[176:179], v[160:163]
    v_mfma_f32_16x16x32_bf16 v[160:163], v[96:99], v[180:183], v[160:163]
    v_mfma_f32_16x16x32_bf16 v[160:163], v[96:99], v[184:187], v[160:163]
    v_mfma_f32_16x16x32_bf16 v[164:167], v[98:101], v[176:179], v[164:167]
    v_mfma_f32_16x16x32_bf16 v[164:167], v[98:101], v[180:183], v[164:167]
    v_mfma_f32_16x16x32_bf16 v[164:167], v[98:101], v[184:187], v[164:167]
    s_waitcnt vmcnt(3)
    v_mfma_f32_16x16x32_bf16 v[168:171], v[96:99], v[188:191], v[168:171]
    v_mfma_f32_16x16x32_bf16 v[168:171], v[96:99], v[192:195], v[168:171]
    v_mfma_f32_16x16x32_bf16 v[168:171], v[96:99], v[196:199], v[168:171]
    v_mfma_f32_16x16x32_bf16 v[172:175], v[98:101], v[188:191], v[172:175]
    v_mfma_f32_16x16x32_bf16 v[172:175], v[98:101], v[192:195], v[172:175]
    v_mfma_f32_16x16x32_bf16 v[172:175], v[98:101], v[196:199], v[172:175]
    v_cvt_pk_bf16_f32 v160, v160, v161
    v_cvt_pk_bf16_f32 v161, v162, v163
    buffer_store_dwordx2 v[160:161], v20, s[24:27], s64 offen
    v_cvt_pk_bf16_f32 v164, v164, v165
    v_cvt_pk_bf16_f32 v165, v166, v167
    buffer_store_dwordx2 v[164:165], v21, s[24:27], s64 offen
    s_cmp_lg_u32 s4, s61
    s_cbranch_scc1 K1_X2
    s_waitcnt vmcnt(2)
    v_mfma_f32_16x16x32_bf16 v[224:227], v[96:99], v[200:203], v[224:227]
    v_mfma_f32_16x16x32_bf16 v[224:227], v[96:99], v[204:207], v[224:227]
    v_mfma_f32_16x16x32_bf16 v[224:227], v[96:99], v[208:211], v[224:227]
    v_mfma_f32_16x16x32_bf16 v[228:231], v[98:101], v[200:203], v[228:231]
    v_mfma_f32_16x16x32_bf16 v[228:231], v[98:101], v[204:207], v[228:231]
    v_mfma_f32_16x16x32_bf16 v[228:231], v[98:101], v[208:211], v[228:231]
    s_nop 4
    v_cvt_pk_bf16_f32 v224, v224, v225
    v_cvt_pk_bf16_f32 v225, v226, v227
    buffer_store_dwordx2 v[224:225], v20, s[24:27], s65 offen
    v_cvt_pk_bf16_f32 v228, v228, v229
    v_cvt_pk_bf16_f32 v229, v230, v231
    buffer_store_dwordx2 v[228:229], v21, s[24:27], s65 offen
K1_X2:
    v_cvt_pk_bf16_f32 v168, v168, v169
    v_cvt_pk_bf16_f32 v169, v170, v171
    buffer_store_dwordx2 v[168:169], v20, s[24:27], s64 offen offset:32
    v_cvt_pk_bf16_f32 v172, v172, v173
    v_cvt_pk_bf16_f32 v173, v174, v175
    buffer_store_dwordx2 v[172:173], v21, s[24:27], s64 offen offset:32
K1_END:
    s_endpgm
K1_LB_MASK:
    v_add_f32 v212, s12, v144
    v_fma_f32 v176, v208, s8, v212
    v_fma_f32 v177, v209, s8, v212
    v_fma_f32 v178, v210, s8, v212
    v_fma_f32 v179, v211, s8, v212
    v_add_f32 v213, s13, v144
    v_fma_f32 v180, v208, s9, v213
    v_fma_f32 v181, v209, s9, v213
    v_fma_f32 v182, v210, s9, v213
    v_fma_f32 v183, v211, s9, v213
    v_add_f32 v212, s14, v144
    v_fma_f32 v184, v208, s10, v212
    v_fma_f32 v185, v209, s10, v212
    v_fma_f32 v186, v210, s10, v212
    v_fma_f32 v187, v211, s10, v212
    v_add_f32 v213, s15, v144
    v_fma_f32 v188, v208, s11, v213
    v_fma_f32 v189, v209, s11, v213
    v_fma_f32 v190, v210, s11, v213
    v_fma_f32 v191, v211, s11, v213
    buffer_load_dword v3, v29, s[32:35], s92 offen sc1
    s_branch K1_LB_BACK
K1_LS_MASK:
    s_cmp_eq_u32 s78, 1
    s_cbranch_scc1 K1_LS_LAST
    buffer_load_dword v3, v29, s[32:35], s92 offen sc1
    v_mov_b32 v218, 1
    s_cmp_eq_u64 s[84:85], 0
    s_cselect_b32 s7, s74, 1073741824
    s_cmp_lg_u32 s83, 0
    s_cselect_b32 s7, s74, s7
    s_waitcnt vmcnt(9)
    buffer_store_dword v218, v216, s[32:35], s7 offen sc1
    s_branch K1_LS_BACK
K1_LS_LAST:
    v_add_f32 v212, s12, v152
    v_fma_f32 v176, v208, s8, v212
    v_fma_f32 v177, v209, s8, v212
    v_fma_f32 v178, v210, s8, v212
    v_fma_f32 v179, v211, s8, v212
    v_add_f32 v213, s13, v152
    v_fma_f32 v180, v208, s9, v213
    v_fma_f32 v181, v209, s9, v213
    v_fma_f32 v182, v210, s9, v213
    v_fma_f32 v183, v211, s9, v213
    v_add_f32 v212, s14, v152
    v_fma_f32 v184, v208, s10, v212
    v_fma_f32 v185, v209, s10, v212
    v_fma_f32 v186, v210, s10, v212
    v_fma_f32 v187, v211, s10, v212
    v_add_f32 v213, s15, v152
    v_fma_f32 v188, v208, s11, v213
    v_fma_f32 v189, v209, s11, v213
    v_fma_f32 v190, v210, s11, v213
    v_fma_f32 v191, v211, s11, v213
    v_cmp_gt_u32 vcc, 1, v3
    s_nop 1
    s_cmp_lg_u32 vcc_lo, 0
    s_cbranch_scc1 SPIN_W0
BACK_W0:
    s_mov_b64 s[36:37], s[56:57]
    s_mov_b32 s38, 5603328
    s_xor_b32 s77, s3, 0
    s_lshl2_add_u32 s77, s77, s4
    s_mul_i32 s77, s77, 36864
    s_add_u32 s77, s77, s28
    s_branch K1_LS_BACK
K1_WMASK:
    v_mov_b32 v9, 0xf149f2ca
    v_cmp_le_u32 vcc, 2, v14
    s_nop 1
    v_cndmask_b32 v141, v9, v141, vcc
    v_cmp_le_u32 vcc, 4, v14
    s_nop 1
    v_cndmask_b32 v142, v9, v142, vcc
    v_cmp_le_u32 vcc, 6, v14
    s_nop 1
    v_cndmask_b32 v143, v9, v143, vcc
    v_cmp_le_u32 vcc, 8, v14
    s_nop 1
    v_cndmask_b32 v144, v9, v144, vcc
    v_cmp_le_u32 vcc, 10, v14
    s_nop 1
    v_cndmask_b32 v145, v9, v145, vcc
    v_cmp_le_u32 vcc, 12, v14
    s_nop 1
    v_cndmask_b32 v146, v9, v146, vcc
    v_cmp_le_u32 vcc, 14, v14
    s_nop 1
    v_cndmask_b32 v147, v9, v147, vcc
    s_branch K1_WMASK_BACK
K1_S7:
    v_mov_b32 v218, 1
    s_cmp_eq_u64 s[84:85], 0
    s_cselect_b32 s7, s74, 1073741824
    s_cmp_lg_u32 s83, 0
    s_cselect_b32 s7, s74, s7
    s_waitcnt vmcnt(8)
    buffer_store_dword v218, v216, s[32:35], s7 offen sc1
    s_branch K1_S7_BACK
K1_J7:
    v_cmp_gt_u32 vcc, 1, v3
    s_nop 1
    s_cmp_lg_u32 vcc_lo, 0
    s_cbranch_scc1 SPIN_W7
BACK_W7:
    s_mov_b64 s[36:37], s[56:57]
    s_mov_b32 s38, 5603328
    s_xor_b32 s77, s3, 0
    s_lshl2_add_u32 s77, s77, s4
    s_mul_i32 s77, s77, 36864
    s_add_u32 s77, s77, s28
    s_branch K1_J7_BACK
K1_REDO:
    s_mov_b32 s83, 1
    s_mov_b32 s63, 1073741824
    s_mov_b32 s64, 1073741824
    s_mov_b32 s62, 1073741824
    s_mul_i32 s7, s5, 1081344
    s_sub_u32 s7, 56623104, s7
    s_sub_u32 s36, s56, s7
    s_subb_u32 s37, s57, 0
    s_mov_b32 s38, 1081344
    s_mov_b32 s50, 0
    s_mov_b32 s54, 0
    s_waitcnt vmcnt(0) lgkmcnt(0)
    s_barrier
    v_lshrrev_b32 v92, 4, v1
    v_and_b32 v64, 15, v92
    v_lshrrev_b32 v92, 4, v92
    v_lshlrev_b32 v92, 2, v92
    v_sub_u32 v92, v64, v92
    s_lshl_b32 s98, s4, 4
    v_add_u32 v92, s98, v92
    s_lshl_b32 s98, s6, 7
    s_sub_u32 s99, 1920, s98
    v_add_u32 v64, s98, v92
    v_add_u32 v65, 64, v64
    v_add_u32 v66, s99, v92
    v_add_u32 v67, 64, v66
    v_mov_b32 v93, 0xf149f2ca
    v_mov_b32 v68, v93
    v_mov_b32 v69, v93
    v_mov_b32 v70, v93
    v_mov_b32 v71, v93
    s_mov_b32 s78, 0
    s_add_u32 s99, s99, 128
K1_REDO_L:
    s_lshr_b32 s7, s78, 6
    s_lshl_b32 s7, s7, 15
    s_bfe_u32 s98, s78, 0x20004
    s_lshl_b32 s98, s98, 12
    s_add_u32 s7, s7, s98
    buffer_load_dwordx4 v[72:75], v1, s[36:39], s7 offen offset:0 sc1
    buffer_load_dwordx4 v[76:79], v1, s[36:39], s7 offen offset:1024 sc1
    buffer_load_dwordx4 v[80:83], v1, s[36:39], s7 offen offset:2048 sc1
    buffer_load_dwordx4 v[84:87], v1, s[36:39], s7 offen offset:3072 sc1
    s_waitcnt vmcnt(0)
    v_mfma_f32_16x16x32_bf16 v[88:91], v[72:75], v[128:131], 0
    v_mfma_f32_16x16x32_bf16 v[88:91], v[76:79], v[160:163], v[88:91]
    v_mfma_f32_16x16x32_bf16 v[88:91], v[80:83], v[192:195], v[88:91]
    v_mfma_f32_16x16x32_bf16 v[88:91], v[84:87], v[224:227], v[88:91]
    v_subrev_u32 v92, s78, v64
    v_cmp_le_i32 vcc, 0, v92
    s_nop 5
    v_cndmask_b32 v88, v93, v88, vcc
    v_max_f32 v68, v68, v88
    v_cmp_le_i32 vcc, 1, v92
    s_nop 1
    v_cndmask_b32 v89, v93, v89, vcc
    v_max_f32 v68, v68, v89
    v_cmp_le_i32 vcc, 2, v92
    s_nop 1
    v_cndmask_b32 v90, v93, v90, vcc
    v_max_f32 v68, v68, v90
    v_cmp_le_i32 vcc, 3, v92
    s_nop 1
    v_cndmask_b32 v91, v93, v91, vcc
    v_max_f32 v68, v68, v91
    v_mfma_f32_16x16x32_bf16 v[88:91], v[72:75], v[132:135], 0
    v_mfma_f32_16x16x32_bf16 v[88:91], v[76:79], v[164:167], v[88:91]
    v_mfma_f32_16x16x32_bf16 v[88:91], v[80:83], v[196:199], v[88:91]
    v_mfma_f32_16x16x32_bf16 v[88:91], v[84:87], v[228:231], v[88:91]
    v_subrev_u32 v92, s78, v65
    v_cmp_le_i32 vcc, 0, v92
    s_nop 5
    v_cndmask_b32 v88, v93, v88, vcc
    v_max_f32 v69, v69, v88
    v_cmp_le_i32 vcc, 1, v92
    s_nop 1
    v_cndmask_b32 v89, v93, v89, vcc
    v_max_f32 v69, v69, v89
    v_cmp_le_i32 vcc, 2, v92
    s_nop 1
    v_cndmask_b32 v90, v93, v90, vcc
    v_max_f32 v69, v69, v90
    v_cmp_le_i32 vcc, 3, v92
    s_nop 1
    v_cndmask_b32 v91, v93, v91, vcc
    v_max_f32 v69, v69, v91
    v_mfma_f32_16x16x32_bf16 v[88:91], v[72:75], v[136:139], 0
    v_mfma_f32_16x16x32_bf16 v[88:91], v[76:79], v[168:171], v[88:91]
    v_mfma_f32_16x16x32_bf16 v[88:91], v[80:83], v[200:203], v[88:91]
    v_mfma_f32_16x16x32_bf16 v[88:91], v[84:87], v[232:235], v[88:91]
    v_subrev_u32 v92, s78, v66
    v_cmp_le_i32 vcc, 0, v92
    s_nop 5
    v_cndmask_b32 v88, v93, v88, vcc
    v_max_f32 v70, v70, v88
    v_cmp_le_i32 vcc, 1, v92
    s_nop 1
    v_cndmask_b32 v89, v93, v89, vcc
    v_max_f32 v70, v70, v89
    v_cmp_le_i32 vcc, 2, v92
    s_nop 1
    v_cndmask_b32 v90, v93, v90, vcc
    v_max_f32 v70, v70, v90
    v_cmp_le_i32 vcc, 3, v92
    s_nop 1
    v_cndmask_b32 v91, v93, v91, vcc
    v_max_f32 v70, v70, v91
    v_mfma_f32_16x16x32_bf16 v[88:91], v[72:75], v[140:143], 0
    v_mfma_f32_16x16x32_bf16 v[88:91], v[76:79], v[172:175], v[88:91]
    v_mfma_f32_16x16x32_bf16 v[88:91], v[80:83], v[204:207], v[88:91]
    v_mfma_f32_16x16x32_bf16 v[88:91], v[84:87], v[236:239], v[88:91]
    v_subrev_u32 v92, s78, v67
    v_cmp_le_i32 vcc, 0, v92
    s_nop 5
    v_cndmask_b32 v88, v93, v88, vcc
    v_max_f32 v71, v71, v88
    v_cmp_le_i32 vcc, 1, v92
    s_nop 1
    v_cndmask_b32 v89, v93, v89, vcc
    v_max_f32 v71, v71, v89
    v_cmp_le_i32 vcc, 2, v92
    s_nop 1
    v_cndmask_b32 v90, v93, v90, vcc
    v_max_f32 v71, v71, v90
    v_cmp_le_i32 vcc, 3, v92
    s_nop 1
    v_cndmask_b32 v91, v93, v91, vcc
    v_max_f32 v71, v71, v91
    s_add_u32 s78, s78, 16
    s_cmp_lt_u32 s78, s99
    s_cbranch_scc1 K1_REDO_L
    v_mov_b32 v92, v68
    s_nop 1
    v_permlane32_swap_b32 v68, v92
    v_max_f32 v68, v68, v92
    v_mov_b32 v92, v68
    s_nop 1
    v_permlane16_swap_b32 v68, v92
    v_max_f32 v68, v68, v92
    v_sub_f32 v144, 0, v68
    v_sub_f32 v145, 0, v68
    v_sub_f32 v146, 0, v68
    v_sub_f32 v147, 0, v68
    v_mov_b32 v92, v69
    s_nop 1
    v_permlane32_swap_b32 v69, v92
    v_max_f32 v69, v69, v92
    v_mov_b32 v92, v69
    s_nop 1
    v_permlane16_swap_b32 v69, v92
    v_max_f32 v69, v69, v92
    v_sub_f32 v148, 0, v69
    v_sub_f32 v149, 0, v69
    v_sub_f32 v150, 0, v69
    v_sub_f32 v151, 0, v69
    v_mov_b32 v92, v70
    s_nop 1
    v_permlane32_swap_b32 v70, v92
    v_max_f32 v70, v70, v92
    v_mov_b32 v92, v70
    s_nop 1
    v_permlane16_swap_b32 v70, v92
    v_max_f32 v70, v70, v92
    v_sub_f32 v152, 0, v70
    v_sub_f32 v153, 0, v70
    v_sub_f32 v154, 0, v70
    v_sub_f32 v155, 0, v70
    v_mov_b32 v92, v71
    s_nop 1
    v_permlane32_swap_b32 v71, v92
    v_max_f32 v71, v71, v92
    v_mov_b32 v92, v71
    s_nop 1
    v_permlane16_swap_b32 v71, v92
    v_max_f32 v71, v71, v92
    v_sub_f32 v156, 0, v71
    v_sub_f32 v157, 0, v71
    v_sub_f32 v158, 0, v71
    v_sub_f32 v159, 0, v71
    v_accvgpr_write_b32 a0, 0
    v_accvgpr_write_b32 a1, 0
    v_accvgpr_write_b32 a2, 0
    v_accvgpr_write_b32 a3, 0
    v_accvgpr_write_b32 a4, 0
    v_accvgpr_write_b32 a5, 0
    v_accvgpr_write_b32 a6, 0
    v_accvgpr_write_b32 a7, 0
    v_accvgpr_write_b32 a8, 0
    v_accvgpr_write_b32 a9, 0
    v_accvgpr_write_b32 a10, 0
    v_accvgpr_write_b32 a11, 0
    v_accvgpr_write_b32 a12, 0
    v_accvgpr_write_b32 a13, 0
    v_accvgpr_write_b32 a14, 0
    v_accvgpr_write_b32 a15, 0
    v_accvgpr_write_b32 a16, 0
    v_accvgpr_write_b32 a17, 0
    v_accvgpr_write_b32 a18, 0
    v_accvgpr_write_b32 a19, 0
    v_accvgpr_write_b32 a20, 0
    v_accvgpr_write_b32 a21, 0
    v_accvgpr_write_b32 a22, 0
    v_accvgpr_write_b32 a23, 0
    v_accvgpr_write_b32 a24, 0
    v_accvgpr_write_b32 a25, 0
    v_accvgpr_write_b32 a26, 0
    v_accvgpr_write_b32 a27, 0
    v_accvgpr_write_b32 a28, 0
    v_accvgpr_write_b32 a29, 0
    v_accvgpr_write_b32 a30, 0
    v_accvgpr_write_b32 a31, 0
    v_accvgpr_write_b32 a32, 0
    v_accvgpr_write_b32 a33, 0
    v_accvgpr_write_b32 a34, 0
    v_accvgpr_write_b32 a35, 0
    v_accvgpr_write_b32 a36, 0
    v_accvgpr_write_b32 a37, 0
    v_accvgpr_write_b32 a38, 0
    v_accvgpr_write_b32 a39, 0
    v_accvgpr_write_b32 a40, 0
    v_accvgpr_write_b32 a41, 0
    v_accvgpr_write_b32 a42, 0
    v_accvgpr_write_b32 a43, 0
    v_accvgpr_write_b32 a44, 0
    v_accvgpr_write_b32 a45, 0
    v_accvgpr_write_b32 a46, 0
    v_accvgpr_write_b32 a47, 0
    v_accvgpr_write_b32 a48, 0
    v_accvgpr_write_b32 a49, 0
    v_accvgpr_write_b32 a50, 0
    v_accvgpr_write_b32 a51, 0
    v_accvgpr_write_b32 a52, 0
    v_accvgpr_write_b32 a53, 0
    v_accvgpr_write_b32 a54, 0
    v_accvgpr_write_b32 a55, 0
    v_accvgpr_write_b32 a56, 0
    v_accvgpr_write_b32 a57, 0
    v_accvgpr_write_b32 a58, 0
    v_accvgpr_write_b32 a59, 0
    v_accvgpr_write_b32 a60, 0
    v_accvgpr_write_b32 a61, 0
    v_accvgpr_write_b32 a62, 0
    v_accvgpr_write_b32 a63, 0
    v_accvgpr_write_b32 a144, 0
    v_accvgpr_write_b32 a145, 0
    v_accvgpr_write_b32 a146, 0
    v_accvgpr_write_b32 a147, 0
    v_accvgpr_write_b32 a148, 0
    v_accvgpr_write_b32 a149, 0
    v_accvgpr_write_b32 a150, 0
    v_accvgpr_write_b32 a151, 0
    v_accvgpr_write_b32 a152, 0
    v_accvgpr_write_b32 a153, 0
    v_accvgpr_write_b32 a154, 0
    v_accvgpr_write_b32 a155, 0
    v_accvgpr_write_b32 a156, 0
    v_accvgpr_write_b32 a157, 0
    v_accvgpr_write_b32 a158, 0
    v_accvgpr_write_b32 a159, 0
    v_accvgpr_write_b32 a160, 0
    v_accvgpr_write_b32 a161, 0
    v_accvgpr_write_b32 a162, 0
    v_accvgpr_write_b32 a163, 0
    v_accvgpr_write_b32 a164, 0
    v_accvgpr_write_b32 a165, 0
    v_accvgpr_write_b32 a166, 0
    v_accvgpr_write_b32 a167, 0
    v_accvgpr_write_b32 a168, 0
    v_accvgpr_write_b32 a169, 0
    v_accvgpr_write_b32 a170, 0
    v_accvgpr_write_b32 a171, 0
    v_accvgpr_write_b32 a172, 0
    v_accvgpr_write_b32 a173, 0
    v_accvgpr_write_b32 a174, 0
    v_accvgpr_write_b32 a175, 0
    v_accvgpr_write_b32 a176, 0
    v_accvgpr_write_b32 a177, 0
    v_accvgpr_write_b32 a178, 0
    v_accvgpr_write_b32 a179, 0
    v_accvgpr_write_b32 a180, 0
    v_accvgpr_write_b32 a181, 0
    v_accvgpr_write_b32 a182, 0
    v_accvgpr_write_b32 a183, 0
    v_accvgpr_write_b32 a184, 0
    v_accvgpr_write_b32 a185, 0
    v_accvgpr_write_b32 a186, 0
    v_accvgpr_write_b32 a187, 0
    v_accvgpr_write_b32 a188, 0
    v_accvgpr_write_b32 a189, 0
    v_accvgpr_write_b32 a190, 0
    v_accvgpr_write_b32 a191, 0
    v_accvgpr_write_b32 a192, 0
    v_accvgpr_write_b32 a193, 0
    v_accvgpr_write_b32 a194, 0
    v_accvgpr_write_b32 a195, 0
    v_accvgpr_write_b32 a196, 0
    v_accvgpr_write_b32 a197, 0
    v_accvgpr_write_b32 a198, 0
    v_accvgpr_write_b32 a199, 0
    v_accvgpr_write_b32 a200, 0
    v_accvgpr_write_b32 a201, 0
    v_accvgpr_write_b32 a202, 0
    v_accvgpr_write_b32 a203, 0
    v_accvgpr_write_b32 a204, 0
    v_accvgpr_write_b32 a205, 0
    v_accvgpr_write_b32 a206, 0
    v_accvgpr_write_b32 a207, 0
    v_accvgpr_write_b32 a208, 0
    v_accvgpr_write_b32 a209, 0
    v_accvgpr_write_b32 a210, 0
    v_accvgpr_write_b32 a211, 0
    v_accvgpr_write_b32 a212, 0
    v_accvgpr_write_b32 a213, 0
    v_accvgpr_write_b32 a214, 0
    v_accvgpr_write_b32 a215, 0
    v_accvgpr_write_b32 a216, 0
    v_accvgpr_write_b32 a217, 0
    v_accvgpr_write_b32 a218, 0
    v_accvgpr_write_b32 a219, 0
    v_accvgpr_write_b32 a220, 0
    v_accvgpr_write_b32 a221, 0
    v_accvgpr_write_b32 a222, 0
    v_accvgpr_write_b32 a223, 0
    v_bfe_u32 v92, v1, 4, 1
    v_sub_u32 v92, 0, v92
    v_and_b32 v92, 0xaaaaaaaa, v92
    v_or_b32 v215, 0x44444444, v92
    v_bfe_u32 v92, v1, 5, 1
    v_cmp_eq_u32 vcc, 0, v92
    v_mov_b32 v92, 0x3f803f80
    s_nop 0
    v_cndmask_b32 v92, 0, v92, vcc
    v_accvgpr_write_b32 a136, v92
    v_accvgpr_write_b32 a137, v92
    v_accvgpr_write_b32 a138, v92
    v_accvgpr_write_b32 a139, v92
    s_mov_b32 s77, s75
    s_mov_b32 s76, 0
    s_mov_b32 s38, 16384
    s_add_u32 m0, s76, s75
    s_nop 0
    buffer_load_dwordx4 v1, s[36:39], s77 offen sc1 lds
    buffer_load_dwordx4 v1, s[36:39], s77 offen offset:1024 sc1 lds
    buffer_load_dwordx4 v1, s[36:39], s77 offen offset:2048 sc1 lds
    buffer_load_dwordx4 v1, s[36:39], s77 offen offset:3072 sc1 lds
    s_add_u32 s100, s77, 4096
    s_add_u32 m0, m0, 4096
    s_nop 0
    buffer_load_dwordx4 v1, s[36:39], s100 offen sc1 lds
    buffer_load_dwordx4 v1, s[36:39], s100 offen offset:1024 sc1 lds
    buffer_load_dwordx4 v1, s[36:39], s100 offen offset:2048 sc1 lds
    buffer_load_dwordx4 v1, s[36:39], s100 offen offset:3072 sc1 lds
    s_add_u32 s77, s77, 32768
    s_add_u32 s76, s76, 32768
    s_lshr_b32 s82, s4, 1
    s_add_u32 s82, s82, 32
    s_sub_u32 s82, s82, s6
    s_sub_u32 s82, s82, s6
    s_lshl_b32 s38, s82, 15
    s_add_u32 m0, s76, s75
    s_nop 0
    buffer_load_dwordx4 v1, s[36:39], s77 offen sc1 lds
    buffer_load_dwordx4 v1, s[36:39], s77 offen offset:1024 sc1 lds
    buffer_load_dwordx4 v1, s[36:39], s77 offen offset:2048 sc1 lds
    buffer_load_dwordx4 v1, s[36:39], s77 offen offset:3072 sc1 lds
    s_add_u32 s100, s77, 4096
    s_add_u32 m0, m0, 4096
    s_nop 0
    buffer_load_dwordx4 v1, s[36:39], s100 offen sc1 lds
    buffer_load_dwordx4 v1, s[36:39], s100 offen offset:1024 sc1 lds
    buffer_load_dwordx4 v1, s[36:39], s100 offen offset:2048 sc1 lds
    buffer_load_dwordx4 v1, s[36:39], s100 offen offset:3072 sc1 lds
    s_add_u32 s77, s77, 32768
    s_add_u32 s76, s76, 32768
    s_add_u32 m0, s76, s75
    s_nop 0
    buffer_load_dwordx4 v1, s[36:39], s77 offen sc1 lds
    buffer_load_dwordx4 v1, s[36:39], s77 offen offset:1024 sc1 lds
    buffer_load_dwordx4 v1, s[36:39], s77 offen offset:2048 sc1 lds
    buffer_load_dwordx4 v1, s[36:39], s77 offen offset:3072 sc1 lds
    s_add_u32 s100, s77, 4096
    s_add_u32 m0, m0, 4096
    s_nop 0
    buffer_load_dwordx4 v1, s[36:39], s100 offen sc1 lds
    buffer_load_dwordx4 v1, s[36:39], s100 offen offset:1024 sc1 lds
    buffer_load_dwordx4 v1, s[36:39], s100 offen offset:2048 sc1 lds
    buffer_load_dwordx4 v1, s[36:39], s100 offen offset:3072 sc1 lds
    s_add_u32 s77, s77, 32768
    s_add_u32 s76, s76, 32768
    s_mov_b32 s82, 0
    s_mov_b32 s95, 32768
    s_mov_b32 s93, 65536
    s_mov_b32 s60, 131072
    v_mov_b32 v2, v1
    s_cmp_eq_u32 s6, 0
    s_cselect_b32 s16, s8, 0
    s_cselect_b32 s17, s9, 0
    s_cmp_eq_u32 s6, 0
    s_cselect_b32 s18, s10, 0
    s_cselect_b32 s19, s11, 0
    s_cmp_eq_u32 s6, 0
    s_cselect_b32 s20, s12, 0
    s_cselect_b32 s21, s13, 0
    s_cmp_eq_u32 s6, 0
    s_cselect_b32 s22, s14, 0
    s_cselect_b32 s23, s15, 0
    s_waitcnt vmcnt(16)
    s_barrier
    ds_read_b128 a[224:227], v2 offset:0
    ds_read_b128 a[228:231], v2 offset:1024
    ds_read_b128 a[232:235], v2 offset:2048
    ds_read_b128 a[236:239], v2 offset:3072
    s_waitcnt lgkmcnt(0)
    ds_read_b128 a[240:243], v2 offset:4096
    ds_read_b128 a[244:247], v2 offset:5120
    ds_read_b128 a[248:251], v2 offset:6144
    ds_read_b128 a[252:255], v2 offset:7168
    v_mul_f32 v176, s16, v208
    v_mul_f32 v177, s16, v209
    v_mul_f32 v178, s16, v210
    v_mul_f32 v179, s16, v211
    s_nop 1
    v_mfma_f32_16x16x32_bf16 v[240:243], a[224:227], v[128:131], v[176:179]
    v_mfma_f32_16x16x32_bf16 v[240:243], a[228:231], v[160:163], v[240:243]
    v_mfma_f32_16x16x32_bf16 v[240:243], a[232:235], v[192:195], v[240:243]
    v_mfma_f32_16x16x32_bf16 v[240:243], a[236:239], v[224:227], v[240:243]
    v_mfma_f32_16x16x32_bf16 v[244:247], a[224:227], v[132:135], 0
    v_mfma_f32_16x16x32_bf16 v[244:247], a[228:231], v[164:167], v[244:247]
    v_mfma_f32_16x16x32_bf16 v[244:247], a[232:235], v[196:199], v[244:247]
    v_mfma_f32_16x16x32_bf16 v[244:247], a[236:239], v[228:231], v[244:247]
    v_mfma_f32_16x16x32_bf16 v[248:251], a[224:227], v[136:139], 0
    v_mfma_f32_16x16x32_bf16 v[248:251], a[228:231], v[168:171], v[248:251]
    v_mfma_f32_16x16x32_bf16 v[248:251], a[232:235], v[200:203], v[248:251]
    v_mfma_f32_16x16x32_bf16 v[248:251], a[236:239], v[232:235], v[248:251]
    v_mfma_f32_16x16x32_bf16 v[252:255], a[224:227], v[140:143], 0
    v_mfma_f32_16x16x32_bf16 v[252:255], a[228:231], v[172:175], v[252:255]
    v_mfma_f32_16x16x32_bf16 v[252:255], a[232:235], v[204:207], v[252:255]
    v_mfma_f32_16x16x32_bf16 v[252:255], a[236:239], v[236:239], v[252:255]
    v_add_f32 v240, v240, v144
    v_exp_f32 v240, v240
    v_add_f32 v241, v241, v144
    v_exp_f32 v241, v241
    v_add_f32 v242, v242, v144
    v_exp_f32 v242, v242
    v_add_f32 v243, v243, v144
    v_exp_f32 v243, v243
    v_add_f32 v244, v244, v148
    v_exp_f32 v244, v244
    v_add_f32 v245, v245, v148
    v_exp_f32 v245, v245
    v_add_f32 v246, v246, v148
    v_exp_f32 v246, v246
    v_add_f32 v247, v247, v148
    v_exp_f32 v247, v247
    v_add_f32 v248, v248, v152
    v_exp_f32 v248, v248
    v_add_f32 v249, v249, v152
    v_exp_f32 v249, v249
    v_add_f32 v250, v250, v152
    v_exp_f32 v250, v250
    v_add_f32 v251, v251, v152
    v_exp_f32 v251, v251
    v_add_f32 v252, v252, v156
    v_exp_f32 v252, v252
    v_add_f32 v253, v253, v156
    v_exp_f32 v253, v253
    v_add_f32 v254, v254, v156
    v_exp_f32 v254, v254
    v_add_f32 v255, v255, v156
    v_exp_f32 v255, v255
    s_nop 1
    s_branch K1_ATT
SPIN_WA:
    s_mov_b32 s94, 0
SPIN_WA_L:
    s_sleep 2
    buffer_load_dword v7, v9, s[44:47], s69 offen sc1
    s_add_u32 s94, s94, 1
    s_cmp_ge_u32 s94, 0x40000
    s_waitcnt vmcnt(0)
    s_cbranch_scc1 BACK_WA
    v_cmp_gt_u32 vcc, 8, v7
    s_nop 1
    s_and_b64 vcc, vcc, s[86:87]
    s_cbranch_scc1 SPIN_WA_L
    s_branch BACK_WA
SPIN_KV:
    s_mov_b32 s94, 0
SPIN_KV_L:
    s_sleep 2
    buffer_load_dword v7, v8, s[32:35], s61 offen sc1
    s_add_u32 s94, s94, 1
    s_cmp_ge_u32 s94, 0x40000
    s_waitcnt vmcnt(0)
    s_cbranch_scc1 BACK_KV
    v_cmp_gt_u32 vcc, 1, v7
    s_nop 1
    s_and_b64 vcc, vcc, exec
    s_cbranch_scc1 SPIN_KV_L
    s_branch BACK_KV
SPIN_SHORT:
    s_mov_b32 s94, 0
SPIN_SHORT_L:
    s_sleep 2
    buffer_load_dword v3, v217, s[32:35], s19 offen sc1
    s_add_u32 s94, s94, 1
    s_cmp_ge_u32 s94, 0x40000
    s_waitcnt vmcnt(0)
    s_cbranch_scc1 BACK_SHORT
    v_cmp_gt_u32 vcc, 1, v3
    s_nop 1
    s_and_b64 vcc, vcc, exec
    s_cbranch_scc1 SPIN_SHORT_L
    s_branch BACK_SHORT
SPIN_CTX:
    s_mov_b32 s94, 0
SPIN_CTX_L:
    s_sleep 2
    buffer_load_dword v3, v217, s[32:35], s19 offen sc1
    s_add_u32 s94, s94, 1
    s_cmp_ge_u32 s94, 0x40000
    s_waitcnt vmcnt(0)
    s_cbranch_scc1 BACK_CTX
    v_cmp_gt_u32 vcc, 2, v3
    s_nop 1
    s_and_b64 vcc, vcc, exec
    s_cbranch_scc1 SPIN_CTX_L
    s_branch BACK_CTX
SPIN_ALL:
    s_mov_b32 s94, 0
SPIN_ALL_L:
    s_sleep 2
    buffer_load_dword v28, v29, s[32:35], s92 offen sc1
    s_add_u32 s94, s94, 1
    s_cmp_ge_u32 s94, 0x40000
    s_waitcnt vmcnt(0)
    s_cbranch_scc1 BACK_ALL
    v_cmp_gt_u32 vcc, 1, v28
    s_nop 1
    s_and_b64 vcc, vcc, exec
    s_cbranch_scc1 SPIN_ALL_L
    s_branch BACK_ALL
SPIN_OA:
    s_mov_b32 s94, 0
SPIN_OA_L:
    s_sleep 2
    buffer_load_dword v3, v19, s[32:35], s66 offen sc1
    s_add_u32 s94, s94, 1
    s_cmp_ge_u32 s94, 0x40000
    s_waitcnt vmcnt(0)
    s_cbranch_scc1 BACK_OA
    v_cmp_gt_u32 vcc, 3, v3
    s_nop 1
    s_and_b64 vcc, vcc, exec
    s_cbranch_scc1 SPIN_OA_L
    s_branch BACK_OA
SPIN_X:
    s_mov_b32 s94, 0
SPIN_X_L:
    s_sleep 2
    buffer_load_dword v3, v19, s[32:35], s66 offen sc1
    s_add_u32 s94, s94, 1
    s_cmp_ge_u32 s94, 0x40000
    s_waitcnt vmcnt(0)
    s_cbranch_scc1 BACK_X
    v_cmp_gt_u32 vcc, 3, v3
    s_nop 1
    s_and_b64 vcc, vcc, exec
    s_cbranch_scc1 SPIN_X_L
    s_branch BACK_X
SPIN_W0:
    s_mov_b32 s94, 0
SPIN_W0_L:
    s_sleep 2
    buffer_load_dword v3, v29, s[32:35], s92 offen sc1
    s_add_u32 s94, s94, 1
    s_cmp_ge_u32 s94, 0x40000
    s_waitcnt vmcnt(0)
    s_cbranch_scc1 BACK_W0
    v_cmp_gt_u32 vcc, 1, v3
    s_nop 1
    s_cmp_lg_u32 vcc_lo, 0
    s_cbranch_scc1 SPIN_W0_L
    s_branch BACK_W0
SPIN_W7:
    s_mov_b32 s94, 0
SPIN_W7_L:
    s_sleep 2
    buffer_load_dword v3, v29, s[32:35], s92 offen sc1
    s_add_u32 s94, s94, 1
    s_cmp_ge_u32 s94, 0x40000
    s_waitcnt vmcnt(0)
    s_cbranch_scc1 BACK_W7
    v_cmp_gt_u32 vcc, 1, v3
    s_nop 1
    s_cmp_lg_u32 vcc_lo, 0
    s_cbranch_scc1 SPIN_W7_L
    s_branch BACK_W7
.section .rodata,"a"
.p2align 6
.amdhsa_kernel gated_mix__sliding_local_dilated__compressed_kv_cla__prompt_kernel
.amdhsa_next_free_vgpr 512
.amdhsa_next_free_sgpr 102
.amdhsa_accum_offset 256
.amdhsa_group_segment_fixed_size 0
.amdhsa_kernarg_size 104
.amdhsa_user_sgpr_count 2
.amdhsa_user_sgpr_kernarg_segment_ptr 1
.amdhsa_system_sgpr_workgroup_id_x 1
.amdhsa_ieee_mode 0
.amdhsa_dx10_clamp 0
.end_amdhsa_kernel
```

```asm
; @launch grid=(256,1,1) block=(256,1,1) lds=163840
.amdgcn_target "amdgcn-amd-amdhsa--gfx950"
.text
.globl gated_mix__sliding_local_dilated__compressed_kv_cla__prompt_kernel
.p2align 8
.type gated_mix__sliding_local_dilated__compressed_kv_cla__prompt_kernel,@function
gated_mix__sliding_local_dilated__compressed_kv_cla__prompt_kernel:
    s_cmp_ge_u32 s2, 256
    s_cbranch_scc1 K1_END
    s_getpc_b64 s[94:95]
    s_load_dwordx8 s[36:43], s[0:1], 32
    v_min_u32 v74, 16, v0
    s_lshr_b32 s7, s2, 3
    s_mul_i32 s7, s7, 17
    v_add_lshl_u32 v74, v74, s7, 7
    global_load_dword v76, v74, s[94:95]
    v_lshrrev_b32 v64, 6, v0
    v_and_b32 v31, 63, v0
    v_readfirstlane_b32 s4, v64
    s_and_b32 s5, s2, 7
    s_lshl_b32 s5, s5, 2
    s_bfe_u32 s7, s2, 0x20003
    s_add_u32 s5, s5, s7
    s_lshr_b32 s6, s2, 5
    s_lshl_b32 s69, s4, 12
    s_mov_b32 s10, 2097152
    s_mov_b32 s11, 0x20000
    s_mov_b32 s14, 4194304
    s_mov_b32 s15, 0x20000
    s_mov_b32 s18, 4194304
    s_mov_b32 s19, 0x20000
    v_lshrrev_b32 v65, 3, v31
    v_and_b32 v66, 7, v31
    v_lshrrev_b32 v67, 1, v65
    v_xor_b32 v66, v66, v67
    v_lshlrev_b32 v66, 4, v66
    v_xor_b32 v67, 64, v66
    s_lshr_b32 s7, s4, 1
    s_lshl_b32 s73, s7, 7
    s_and_b32 s100, s4, 1
    s_lshl_b32 s98, s100, 5
    s_add_u32 s98, s98, s73
    v_add_lshl_u32 v68, v65, s98, 10
    v_add_u32 v6, v68, v66
    v_add_u32 v7, v68, v67
    v_add_u32 v7, 7168, v7
    v_add_u32 v8, v68, v66
    v_add_u32 v8, 14336, v8
    v_add_u32 v9, v68, v67
    v_add_u32 v9, 21504, v9
    v_lshrrev_b32 v69, 4, v31
    v_and_b32 v70, 15, v31
    v_lshlrev_b32 v71, 1, v69
    v_xor_b32 v71, v71, v70
    v_lshlrev_b32 v71, 4, v71
    v_xor_b32 v72, 128, v71
    s_lshl_b32 s98, s4, 4
    v_add_lshl_u32 v73, v69, s98, 13
    v_add_u32 v2, v73, v71
    v_add_u32 v3, v73, v71
    v_add_u32 v3, 31744, v3
    v_add_u32 v4, v73, v72
    v_add_u32 v4, 63488, v4
    v_add_u32 v5, v73, v72
    v_add_u32 v5, 95232, v5
    s_and_b32 s3, s2, 0
    s_lshl_b32 s66, s3, 7
    s_lshl_b32 s60, s3, 11
    s_add_u32 s60, s60, s5
    s_lshl_b32 s60, s60, 8
    s_lshl_b32 s61, s6, 18
    s_add_u32 s61, s61, s66
    s_add_u32 s62, s61, 65536
    s_waitcnt lgkmcnt(0)
    s_mov_b64 s[8:9], s[36:37]
    s_mov_b64 s[24:25], s[38:39]
    s_mov_b64 s[12:13], s[40:41]
    s_mov_b64 s[16:17], s[42:43]
    s_load_dwordx2 s[20:21], s[0:1], 0
    s_load_dwordx2 s[28:29], s[0:1], 8
    s_load_dwordx2 s[32:33], s[0:1], 72
    s_load_dwordx2 s[48:49], s[0:1], 64
    s_load_dwordx2 s[92:93], s[0:1], 16
    s_load_dwordx2 s[44:45], s[0:1], 88
    s_load_dwordx2 s[56:57], s[0:1], 96
    s_load_dwordx2 s[0:1], s[0:1], 80
    s_add_u32 m0, s69, 0
    s_nop 0
    buffer_load_dwordx4 v6, s[8:11], s61 offen lds
    buffer_load_dwordx4 v7, s[8:11], s61 offen offset:1024 lds
    buffer_load_dwordx4 v8, s[8:11], s61 offen offset:2048 lds
    buffer_load_dwordx4 v9, s[8:11], s61 offen offset:3072 lds
    s_xor_b32 s61, s61, 128
    s_add_u32 m0, s69, 16384
    s_nop 0
    buffer_load_dwordx4 v6, s[8:11], s62 offen lds
    buffer_load_dwordx4 v7, s[8:11], s62 offen offset:1024 lds
    buffer_load_dwordx4 v8, s[8:11], s62 offen offset:2048 lds
    buffer_load_dwordx4 v9, s[8:11], s62 offen offset:3072 lds
    s_xor_b32 s62, s62, 128
    s_add_u32 m0, s69, 32768
    s_nop 0
    buffer_load_dwordx4 v2, s[12:15], s60 offen nt lds
    buffer_load_dwordx4 v3, s[12:15], s60 offen offset:1024 nt lds
    buffer_load_dwordx4 v4, s[12:15], s60 offen offset:2048 nt lds
    buffer_load_dwordx4 v5, s[12:15], s60 offen offset:3072 nt lds
    s_add_u32 m0, s69, 49152
    s_nop 0
    buffer_load_dwordx4 v6, s[8:11], s61 offen lds
    buffer_load_dwordx4 v7, s[8:11], s61 offen offset:1024 lds
    buffer_load_dwordx4 v8, s[8:11], s61 offen offset:2048 lds
    buffer_load_dwordx4 v9, s[8:11], s61 offen offset:3072 lds
    s_xor_b32 s61, s61, 384
    v_min_u32 v74, 15, v31
    s_lshl2_add_u32 s98, s2, s4
    s_lshl_b32 s98, s98, 11
    v_lshlrev_b32 v74, 7, v74
    buffer_load_dword v117, v74, s[8:11], s98 offen
    s_waitcnt lgkmcnt(0)
    s_mov_b32 s22, 2359296
    s_mov_b32 s23, 0x20000
    s_mov_b32 s26, 4718592
    s_mov_b32 s27, 0x20000
    s_mov_b32 s50, 4718592
    s_mov_b32 s51, 0x20000
    s_mov_b32 s46, 256
    s_mov_b32 s47, 0x20000
    s_mov_b32 s30, 1990656
    s_mov_b32 s31, 0x20000
    s_mov_b32 s34, 1152
    s_mov_b32 s35, 0x20000
    s_mul_i32 s7, s5, 1081344
    s_add_u32 s36, s56, s7
    s_addc_u32 s37, s57, 0
    s_mov_b32 s38, 1081344
    s_mov_b32 s39, 0x20000
    s_cmp_eq_u32 s4, 0
    s_cselect_b32 s86, 0x55555555, 0
    s_cselect_b32 s87, 0x55555555, 0
    s_cselect_b32 s52, s48, s92
    s_cselect_b32 s53, s49, s93
    s_cselect_b32 s54, s50, 663552
    s_mov_b32 s55, 0x20000
    s_mul_i32 s63, s6, 147456
    s_sub_u32 s64, 2211840, s63
    s_add_u32 s63, s63, s66
    s_add_u32 s64, s64, s66
    s_lshl_b32 s67, s4, 11
    s_lshl_b32 s68, s4, 10
    s_lshl_b32 s75, s4, 13
    s_lshl_b32 s65, s3, 13
    s_add_u32 s65, s65, s67
    s_lshl_b32 s70, s6, 2
    s_lshl1_add_u32 s70, s100, s70
    s_lshl_b32 s70, s70, 15
    s_lshl_b32 s98, s73, 6
    s_add_u32 s71, s70, s98
    s_add_u32 s71, s71, 49152
    s_lshl_b32 s98, s73, 4
    s_add_u32 s70, s70, s98
    v_lshlrev_b32 v1, 4, v31
    v_mov_b32 v77, 1073741824
    v_cmp_eq_u32 vcc, 0, v0
    s_nop 1
    v_cndmask_b32_e64 v30, v77, 0, vcc
    v_lshlrev_b32 v103, 7, v31
    v_cmp_gt_u32 vcc, 9, v31
    s_nop 1
    v_cndmask_b32 v103, v77, v103, vcc
    s_lshl_b32 s98, s4, 5
    v_add_u32 v68, s98, v65
    v_mul_u32_u24 v68, 1152, v68
    v_add_u32 v10, v68, v66
    v_add_u32 v11, v68, v67
    v_add_u32 v11, 8192, v11
    v_add_u32 v12, v68, v66
    v_add_u32 v12, 16384, v12
    v_add_u32 v13, v68, v67
    v_add_u32 v13, 24576, v13
    s_sub_u32 s98, 15, s6
    s_cmp_eq_u32 s73, 0
    s_cselect_b32 s98, s6, s98
    s_lshl_b32 s98, s98, 7
    s_sub_u32 s98, s98, 16
    s_max_i32 s98, s98, 0
    s_lshl3_add_u32 s98, s100, s98
    v_add_u32 v68, s98, v65
    v_mul_u32_u24 v68, 1152, v68
    s_lshl_b32 s98, s100, 6
    v_xor_b32 v73, s98, v66
    v_add_u32 v96, v68, v73
    s_add_u32 m0, s69, 65536
    s_nop 0
    buffer_load_dwordx4 v2, s[16:19], s60 offen nt lds
    v_lshrrev_b32 v71, 1, v70
    v_xor_b32 v71, v71, v69
    v_lshlrev_b32 v71, 4, v71
    v_lshl_add_u32 v71, v70, 7, v71
    v_xor_b32 v72, 64, v71
    s_lshl_b32 s98, s100, 13
    v_add_u32 v22, s98, v71
    v_add_u32 v23, s98, v72
    v_add_u32 v24, s67, v71
    v_add_u32 v25, s67, v72
    s_lshl_b32 s98, s100, 11
    s_add_u32 s98, s98, 8192
    v_add_u32 v100, s98, v71
    v_add_u32 v101, s98, v72
    v_bfe_u32 v73, v31, 2, 2
    v_and_b32 v74, 3, v31
    v_lshl_add_u32 v75, v69, 3, v73
    v_and_b32 v78, 1, v69
    buffer_load_dwordx4 v3, s[16:19], s60 offen offset:1024 nt lds
    v_lshl_add_u32 v77, v78, 2, v73
    v_lshlrev_b32 v77, 5, v77
    v_lshl_add_u32 v77, v74, 3, v77
    v_lshl_add_u32 v77, v75, 8, v77
    v_xor_b32 v14, 0, v77
    v_xor_b32 v14, s73, v14
    v_xor_b32 v15, 32, v77
    v_xor_b32 v15, s73, v15
    v_xor_b32 v16, 64, v77
    v_xor_b32 v16, s73, v16
    v_xor_b32 v17, 96, v77
    v_xor_b32 v17, s73, v17
    v_xor_b32 v18, 128, v77
    v_xor_b32 v19, 160, v77
    v_xor_b32 v20, 192, v77
    v_xor_b32 v21, 224, v77
    v_lshrrev_b32 v77, 1, v73
    v_lshl_add_u32 v77, v78, 1, v77
    buffer_load_dwordx4 v4, s[16:19], s60 offen offset:2048 nt lds
    v_lshlrev_b32 v77, 5, v77
    v_lshl_add_u32 v77, v74, 3, v77
    v_lshl_add_u32 v77, v75, 7, v77
    s_lshr_b32 s98, s73, 1
    v_xor_b32 v26, 0, v77
    v_xor_b32 v26, s98, v26
    v_xor_b32 v27, 32, v77
    v_xor_b32 v28, 64, v77
    v_xor_b32 v28, s98, v28
    v_xor_b32 v29, 96, v77
    v_and_b32 v73, 7, v0
    v_lshrrev_b32 v74, 3, v0
    v_lshl_add_u32 v75, v73, 1, 0
    v_mul_u32_u24 v78, 52, v75
    v_lshrrev_b32 v78, 8, v78
    v_mul_u32_u24 v79, 5, v78
    v_sub_u32 v75, v75, v79
    v_add_u32 v78, 1, v78
    buffer_load_dwordx4 v5, s[16:19], s60 offen offset:3072 nt lds
    s_xor_b32 s60, s60, 524288
    v_cmp_le_u32 vcc, 3, v78
    s_nop 1
    v_cndmask_b32_e64 v78, v78, 0, vcc
    v_mul_u32_u24 v78, 1152, v78
    v_lshl_add_u32 v75, v75, 3, v78
    v_mad_u32_u24 v75, v74, 36, v75
    v_lshl_add_u32 v77, v73, 1, 1
    v_mul_u32_u24 v78, 52, v77
    v_lshrrev_b32 v78, 8, v78
    v_mul_u32_u24 v79, 5, v78
    v_sub_u32 v77, v77, v79
    v_add_u32 v78, 1, v78
    v_cmp_le_u32 vcc, 3, v78
    s_nop 1
    v_cndmask_b32_e64 v78, v78, 0, vcc
    v_mul_u32_u24 v78, 1152, v78
    v_lshl_add_u32 v77, v77, 3, v78
    v_mad_u32_u24 v77, v74, 36, v77
    s_mul_i32 s98, s2, 10368
    s_mul_i32 s99, s2, 6
    s_mov_b32 s7, 73728
    v_mul_lo_u32 v95, v74, s7
    v_lshl_add_u32 v95, v73, 4, v95
    v_cmp_eq_u32 s[92:93], 7, v73
    s_add_u32 s56, s56, 56623104
    s_addc_u32 s57, s57, 0
    s_mov_b32 s58, 5603328
    s_mov_b32 s59, 0x20000
    s_lshl_b32 s101, s6, 5
    s_add_u32 s101, s101, s5
    s_lshl_b32 s101, s101, 7
    v_mov_b32 v65, 0
    v_lshrrev_b32 v64, 2, v0
    v_lshlrev_b32 v64, 15, v64
    v_and_b32 v79, 3, v0
    v_lshl_add_u32 v64, v79, 2, v64
    s_mov_b32 s74, 0x3e0293ee
    s_lshl_b32 s95, s5, 3
    s_waitcnt vmcnt(5)
    s_barrier
    ds_read_b128 a[0:3], v22 offset:0
    ds_read_b64_tr_b16 v[40:41], v14 offset:32768
    ds_read_b64_tr_b16 v[42:43], v14 offset:33792
    ds_read_b128 a[4:7], v23 offset:0
    ds_read_b64_tr_b16 v[44:45], v14 offset:40960
    ds_read_b64_tr_b16 v[46:47], v14 offset:41984
    ds_read_b128 a[8:11], v22 offset:2048
    ds_read_b128 a[12:15], v23 offset:2048
    ds_read_b128 a[16:19], v22 offset:4096
    ds_read_b128 a[20:23], v23 offset:4096
    ds_read_b128 a[24:27], v22 offset:6144
    ds_read_b128 a[28:31], v23 offset:6144
    ds_read_b128 a[32:35], v22 offset:16384
    ds_read_b128 a[36:39], v23 offset:16384
    ds_read_b128 a[40:43], v22 offset:18432
    s_waitcnt lgkmcnt(14)
    ds_read_b128 a[44:47], v23 offset:18432
    s_waitcnt lgkmcnt(14)
    ds_read_b128 a[48:51], v22 offset:20480
    s_waitcnt lgkmcnt(14)
    ds_read_b128 a[52:55], v23 offset:20480
    s_waitcnt lgkmcnt(14)
    ds_read_b128 a[56:59], v22 offset:22528
    s_waitcnt lgkmcnt(14)
    ds_read_b128 a[60:63], v23 offset:22528
    v_mfma_f32_16x16x32_bf16 v[128:131], v[40:43], a[0:3], 0
    s_add_u32 m0, s69, 81920
    s_waitcnt lgkmcnt(14)
    ds_read_b64_tr_b16 v[48:49], v15 offset:32768
    s_waitcnt lgkmcnt(14)
    ds_read_b64_tr_b16 v[50:51], v15 offset:33792
    v_mfma_f32_16x16x32_bf16 v[128:131], v[44:47], a[4:7], v[128:131]
    s_mul_i32 s77, s2, 9216
    buffer_load_dwordx4 v6, s[8:11], s62 offen lds
    v_mfma_f32_16x16x32_bf16 v[132:135], v[40:43], a[8:11], 0
    s_mul_i32 s76, s4, 1152
    s_waitcnt lgkmcnt(14)
    ds_read_b128 a[64:67], v22 offset:49152
    s_waitcnt lgkmcnt(13)
    ds_read_b64_tr_b16 v[52:53], v15 offset:40960
    v_mfma_f32_16x16x32_bf16 v[132:135], v[44:47], a[12:15], v[132:135]
    s_add_u32 s77, s77, s76
    ds_read_b64_tr_b16 v[54:55], v15 offset:41984
    s_waitcnt lgkmcnt(10)
    ds_read_b64_tr_b16 v[56:57], v16 offset:32768
    v_mfma_f32_16x16x32_bf16 v[136:139], v[40:43], a[16:19], 0
    s_mul_i32 s76, s4, 1152
    buffer_load_dwordx4 v7, s[8:11], s62 offen offset:1024 lds
    v_mfma_f32_16x16x32_bf16 v[136:139], v[44:47], a[20:23], v[136:139]
    s_mul_i32 s72, s2, 3
    ds_read_b64_tr_b16 v[58:59], v16 offset:33792
    ds_read_b64_tr_b16 v[60:61], v16 offset:40960
    v_mfma_f32_16x16x32_bf16 v[140:143], v[40:43], a[24:27], 0
    s_add_u32 s72, s72, 0
    ds_read_b64_tr_b16 v[62:63], v16 offset:41984
    v_add_u32 v14, 0x10000, v14
    v_mfma_f32_16x16x32_bf16 v[140:143], v[44:47], a[28:31], v[140:143]
    s_mul_i32 s7, s5, 73728
    ds_read_b128 a[68:71], v23 offset:49152
    v_add_u32 v15, 0x10000, v15
    v_mfma_f32_16x16x32_bf16 v[144:147], v[40:43], a[32:35], 0
    s_and_b32 s100, s5, 1
    buffer_load_dwordx4 v8, s[8:11], s62 offen offset:2048 lds
    v_mfma_f32_16x16x32_bf16 v[144:147], v[44:47], a[36:39], v[144:147]
    s_mov_b64 s[84:85], 0
    v_add_u32 v16, 0x10000, v16
    v_mov_b32 v31, 1
    v_mfma_f32_16x16x32_bf16 v[148:151], v[40:43], a[40:43], 0
    s_mov_b32 vcc_lo, 0x84848484
    s_mov_b32 vcc_hi, 0x84848484
    v_add_u32 v18, 0x10000, v18
    s_waitcnt lgkmcnt(2)
    v_mfma_f32_16x16x32_bf16 v[148:151], v[44:47], a[44:47], v[148:151]
    s_mov_b32 s83, 0
    v_add_u32 v19, 0x10000, v19
    v_add_u32 v20, 0x10000, v20
    v_mfma_f32_16x16x32_bf16 v[152:155], v[40:43], a[48:51], 0
    buffer_load_dwordx4 v9, s[8:11], s62 offen offset:3072 lds
    v_mfma_f32_16x16x32_bf16 v[152:155], v[44:47], a[52:55], v[152:155]
    ds_read_b128 a[72:75], v22 offset:51200
    v_add_u32 v21, 0x10000, v21
    v_mfma_f32_16x16x32_bf16 v[156:159], v[40:43], a[56:59], 0
    s_add_u32 m0, s69, 98304
    ds_read_b64_tr_b16 v[40:41], v17 offset:32768
    ds_read_b64_tr_b16 v[42:43], v17 offset:33792
    v_mfma_f32_16x16x32_bf16 v[156:159], v[44:47], a[60:63], v[156:159]
    s_xor_b32 s62, s62, 384
    ds_read_b64_tr_b16 v[44:45], v17 offset:40960
    ds_read_b64_tr_b16 v[46:47], v17 offset:41984
    v_mfma_f32_16x16x32_bf16 v[160:163], v[48:51], a[0:3], 0
    buffer_load_dwordx4 v2, s[12:15], s60 offen nt lds
    v_mfma_f32_16x16x32_bf16 v[160:163], v[52:55], a[4:7], v[160:163]
    v_add_u32 v17, 0x10000, v17
    v_add_u32 v26, 0x10000, v26
    v_mfma_f32_16x16x32_bf16 v[164:167], v[48:51], a[8:11], 0
    ds_read_b128 a[76:79], v23 offset:51200
    v_add_u32 v27, 0x10000, v27
    v_mfma_f32_16x16x32_bf16 v[164:167], v[52:55], a[12:15], v[164:167]
    v_add_u32 v28, 0x10000, v28
    v_add_u32 v29, 0x10000, v29
    v_mfma_f32_16x16x32_bf16 v[168:171], v[48:51], a[16:19], 0
    buffer_load_dwordx4 v3, s[12:15], s60 offen offset:1024 nt lds
    v_mfma_f32_16x16x32_bf16 v[168:171], v[52:55], a[20:23], v[168:171]
    v_bfe_u32 v37, v1, 4, 4
    v_mul_u32_u24 v36, 1152, v37
    v_mfma_f32_16x16x32_bf16 v[172:175], v[48:51], a[24:27], 0
    v_lshrrev_b32 v38, 8, v1
    v_lshl_add_u32 v36, v38, 4, v36
    v_mfma_f32_16x16x32_bf16 v[172:175], v[52:55], a[28:31], v[172:175]
    v_lshrrev_b32 v39, 3, v37
    v_mul_u32_u24 v39, 9152, v39
    v_mfma_f32_16x16x32_bf16 v[176:179], v[48:51], a[32:35], 0
    buffer_load_dwordx4 v4, s[12:15], s60 offen offset:2048 nt lds
    v_mfma_f32_16x16x32_bf16 v[176:179], v[52:55], a[36:39], v[176:179]
    ds_read_b128 a[80:83], v22 offset:53248
    v_mfma_f32_16x16x32_bf16 v[180:183], v[48:51], a[40:43], 0
    v_mfma_f32_16x16x32_bf16 v[180:183], v[52:55], a[44:47], v[180:183]
    v_mfma_f32_16x16x32_bf16 v[184:187], v[48:51], a[48:51], 0
    buffer_load_dwordx4 v5, s[12:15], s60 offen offset:3072 nt lds
    v_mfma_f32_16x16x32_bf16 v[184:187], v[52:55], a[52:55], v[184:187]
    ds_read_b128 a[84:87], v23 offset:53248
    v_mfma_f32_16x16x32_bf16 v[188:191], v[48:51], a[56:59], 0
    s_add_u32 m0, s69, 114688
    v_mfma_f32_16x16x32_bf16 v[188:191], v[52:55], a[60:63], v[188:191]
    v_mfma_f32_16x16x32_bf16 v[192:195], v[56:59], a[0:3], 0
    s_waitcnt lgkmcnt(1)
    buffer_load_dwordx4 v6, s[8:11], s61 offen lds
    v_mfma_f32_16x16x32_bf16 v[192:195], v[60:63], a[4:7], v[192:195]
    v_mfma_f32_16x16x32_bf16 v[196:199], v[56:59], a[8:11], 0
    v_mfma_f32_16x16x32_bf16 v[196:199], v[60:63], a[12:15], v[196:199]
    ds_read_b128 a[88:91], v22 offset:55296
    v_mfma_f32_16x16x32_bf16 v[200:203], v[56:59], a[16:19], 0
    buffer_load_dwordx4 v7, s[8:11], s61 offen offset:1024 lds
    v_mfma_f32_16x16x32_bf16 v[200:203], v[60:63], a[20:23], v[200:203]
    v_mfma_f32_16x16x32_bf16 v[204:207], v[56:59], a[24:27], 0
    v_mfma_f32_16x16x32_bf16 v[204:207], v[60:63], a[28:31], v[204:207]
    v_mfma_f32_16x16x32_bf16 v[208:211], v[56:59], a[32:35], 0
    buffer_load_dwordx4 v8, s[8:11], s61 offen offset:2048 lds
    v_mfma_f32_16x16x32_bf16 v[208:211], v[60:63], a[36:39], v[208:211]
    ds_read_b128 a[92:95], v23 offset:55296
    v_mfma_f32_16x16x32_bf16 v[212:215], v[56:59], a[40:43], 0
    v_mfma_f32_16x16x32_bf16 v[212:215], v[60:63], a[44:47], v[212:215]
    v_mfma_f32_16x16x32_bf16 v[216:219], v[56:59], a[48:51], 0
    buffer_load_dwordx4 v9, s[8:11], s61 offen offset:3072 lds
    v_mfma_f32_16x16x32_bf16 v[216:219], v[60:63], a[52:55], v[216:219]
    v_mfma_f32_16x16x32_bf16 v[220:223], v[56:59], a[56:59], 0
    s_xor_b32 s61, s61, 128
    v_mfma_f32_16x16x32_bf16 v[220:223], v[60:63], a[60:63], v[220:223]
    s_add_u32 m0, s69, 131072
    v_mfma_f32_16x16x32_bf16 v[224:227], v[40:43], a[0:3], 0
    buffer_load_dwordx4 v2, s[16:19], s60 offen nt lds
    v_mfma_f32_16x16x32_bf16 v[224:227], v[44:47], a[4:7], v[224:227]
    v_mfma_f32_16x16x32_bf16 v[228:231], v[40:43], a[8:11], 0
    buffer_load_dword v104, v103, s[20:23], s77 offen
    v_mfma_f32_16x16x32_bf16 v[228:231], v[44:47], a[12:15], v[228:231]
    s_add_u32 s77, s77, 4608
    v_mfma_f32_16x16x32_bf16 v[232:235], v[40:43], a[16:19], 0
    v_mfma_f32_16x16x32_bf16 v[232:235], v[44:47], a[20:23], v[232:235]
    s_waitcnt vmcnt(10)
    s_barrier
    ds_read_b64_tr_b16 v[48:49], v14 offset:0
    v_mfma_f32_16x16x32_bf16 v[236:239], v[40:43], a[24:27], 0
    buffer_load_dwordx4 v3, s[16:19], s60 offen offset:1024 nt lds
    v_mfma_f32_16x16x32_bf16 v[236:239], v[44:47], a[28:31], v[236:239]
    ds_read_b64_tr_b16 v[50:51], v14 offset:1024
    ds_read_b64_tr_b16 v[52:53], v14 offset:8192
    v_mfma_f32_16x16x32_bf16 v[240:243], v[40:43], a[32:35], 0
    ds_read_b64_tr_b16 v[54:55], v14 offset:9216
    ds_read_b64_tr_b16 v[56:57], v15 offset:0
    v_mfma_f32_16x16x32_bf16 v[240:243], v[44:47], a[36:39], v[240:243]
    buffer_load_dwordx4 v4, s[16:19], s60 offen offset:2048 nt lds
    v_mfma_f32_16x16x32_bf16 v[244:247], v[40:43], a[40:43], 0
    ds_read_b64_tr_b16 v[58:59], v15 offset:1024
    ds_read_b64_tr_b16 v[60:61], v15 offset:8192
    v_mfma_f32_16x16x32_bf16 v[244:247], v[44:47], a[44:47], v[244:247]
    ds_read_b64_tr_b16 v[62:63], v15 offset:9216
    v_mfma_f32_16x16x32_bf16 v[248:251], v[40:43], a[48:51], 0
    v_mfma_f32_16x16x32_bf16 v[248:251], v[44:47], a[52:55], v[248:251]
    buffer_load_dwordx4 v5, s[16:19], s60 offen offset:3072 nt lds
    v_mfma_f32_16x16x32_bf16 v[252:255], v[40:43], a[56:59], 0
    ds_read_b64_tr_b16 v[40:41], v16 offset:0
    ds_read_b64_tr_b16 v[42:43], v16 offset:1024
    v_mfma_f32_16x16x32_bf16 v[252:255], v[44:47], a[60:63], v[252:255]
    s_waitcnt lgkmcnt(3)
    ds_read_b64_tr_b16 v[44:45], v16 offset:8192
    ds_read_b64_tr_b16 v[46:47], v16 offset:9216
    v_mfma_f32_16x16x32_bf16 a[128:131], a[0:3], v[48:51], 0
    v_mfma_f32_16x16x32_bf16 a[128:131], a[4:7], v[52:55], a[128:131]
    s_add_u32 m0, s69, 147456
    v_add_u32 v22, 0x10000, v22
    v_mfma_f32_16x16x32_bf16 a[132:135], a[8:11], v[48:51], 0
    s_xor_b32 s60, s60, 1572864
    buffer_load_dwordx4 v6, s[8:11], s62 offen lds
    v_mfma_f32_16x16x32_bf16 a[132:135], a[12:15], v[52:55], a[132:135]
    ds_read_b128 a[96:99], v22 offset:16384
    v_mfma_f32_16x16x32_bf16 a[136:139], a[16:19], v[48:51], 0
    v_mfma_f32_16x16x32_bf16 a[136:139], a[20:23], v[52:55], a[136:139]
    v_mfma_f32_16x16x32_bf16 a[140:143], a[24:27], v[48:51], 0
    buffer_load_dwordx4 v7, s[8:11], s62 offen offset:1024 lds
    v_mfma_f32_16x16x32_bf16 a[140:143], a[28:31], v[52:55], a[140:143]
    v_add_u32 v23, 0x10000, v23
    ds_read_b128 a[100:103], v23 offset:16384
    v_mfma_f32_16x16x32_bf16 a[144:147], a[32:35], v[48:51], 0
    v_mfma_f32_16x16x32_bf16 a[144:147], a[36:39], v[52:55], a[144:147]
    v_mfma_f32_16x16x32_bf16 a[148:151], a[40:43], v[48:51], 0
    v_mfma_f32_16x16x32_bf16 a[148:151], a[44:47], v[52:55], a[148:151]
    buffer_load_dwordx4 v8, s[8:11], s62 offen offset:2048 lds
    v_mfma_f32_16x16x32_bf16 a[152:155], a[48:51], v[48:51], 0
    v_mfma_f32_16x16x32_bf16 a[152:155], a[52:55], v[52:55], a[152:155]
    ds_read_b128 a[104:107], v22 offset:18432
    v_mfma_f32_16x16x32_bf16 a[156:159], a[56:59], v[48:51], 0
    ds_read_b64_tr_b16 v[48:49], v17 offset:0
    ds_read_b64_tr_b16 v[50:51], v17 offset:1024
    v_mfma_f32_16x16x32_bf16 a[156:159], a[60:63], v[52:55], a[156:159]
    buffer_load_dwordx4 v9, s[8:11], s62 offen offset:3072 lds
    v_mfma_f32_16x16x32_bf16 a[160:163], a[0:3], v[56:59], 0
    s_waitcnt lgkmcnt(3)
    ds_read_b64_tr_b16 v[52:53], v17 offset:8192
    ds_read_b64_tr_b16 v[54:55], v17 offset:9216
    v_mfma_f32_16x16x32_bf16 a[160:163], a[4:7], v[60:63], a[160:163]
    v_mfma_f32_16x16x32_bf16 a[164:167], a[8:11], v[56:59], 0
    ds_read_b128 a[108:111], v23 offset:18432
    v_mfma_f32_16x16x32_bf16 a[164:167], a[12:15], v[60:63], a[164:167]
    s_add_u32 m0, s69, 0
    v_mfma_f32_16x16x32_bf16 a[168:171], a[16:19], v[56:59], 0
    s_xor_b32 s62, s62, 128
    buffer_load_dwordx4 v2, s[12:15], s60 offen nt lds
    v_mfma_f32_16x16x32_bf16 a[168:171], a[20:23], v[60:63], a[168:171]
    v_mfma_f32_16x16x32_bf16 a[172:175], a[24:27], v[56:59], 0
    v_mfma_f32_16x16x32_bf16 a[172:175], a[28:31], v[60:63], a[172:175]
    v_mfma_f32_16x16x32_bf16 a[176:179], a[32:35], v[56:59], 0
    buffer_load_dwordx4 v3, s[12:15], s60 offen offset:1024 nt lds
    v_mfma_f32_16x16x32_bf16 a[176:179], a[36:39], v[60:63], a[176:179]
    ds_read_b128 a[112:115], v22 offset:20480
    v_mfma_f32_16x16x32_bf16 a[180:183], a[40:43], v[56:59], 0
    v_mfma_f32_16x16x32_bf16 a[180:183], a[44:47], v[60:63], a[180:183]
    v_mfma_f32_16x16x32_bf16 a[184:187], a[48:51], v[56:59], 0
    v_mfma_f32_16x16x32_bf16 a[184:187], a[52:55], v[60:63], a[184:187]
    buffer_load_dwordx4 v4, s[12:15], s60 offen offset:2048 nt lds
    v_mfma_f32_16x16x32_bf16 a[188:191], a[56:59], v[56:59], 0
    ds_read_b128 a[116:119], v23 offset:20480
    v_mfma_f32_16x16x32_bf16 a[188:191], a[60:63], v[60:63], a[188:191]
    v_mfma_f32_16x16x32_bf16 a[192:195], a[0:3], v[40:43], 0
    v_mfma_f32_16x16x32_bf16 a[192:195], a[4:7], v[44:47], a[192:195]
    buffer_load_dwordx4 v5, s[12:15], s60 offen offset:3072 nt lds
    v_mfma_f32_16x16x32_bf16 a[196:199], a[8:11], v[40:43], 0
    v_mfma_f32_16x16x32_bf16 a[196:199], a[12:15], v[44:47], a[196:199]
    ds_read_b128 a[120:123], v22 offset:22528
    v_mfma_f32_16x16x32_bf16 a[200:203], a[16:19], v[40:43], 0
    v_mfma_f32_16x16x32_bf16 a[200:203], a[20:23], v[44:47], a[200:203]
    s_add_u32 m0, s69, 16384
    v_mfma_f32_16x16x32_bf16 a[204:207], a[24:27], v[40:43], 0
    buffer_load_dwordx4 v6, s[8:11], s61 offen lds
    v_mfma_f32_16x16x32_bf16 a[204:207], a[28:31], v[44:47], a[204:207]
    v_mfma_f32_16x16x32_bf16 a[208:211], a[32:35], v[40:43], 0
    ds_read_b128 a[124:127], v23 offset:22528
    v_mfma_f32_16x16x32_bf16 a[208:211], a[36:39], v[44:47], a[208:211]
    v_mfma_f32_16x16x32_bf16 a[212:215], a[40:43], v[40:43], 0
    buffer_load_dwordx4 v7, s[8:11], s61 offen offset:1024 lds
    v_mfma_f32_16x16x32_bf16 a[212:215], a[44:47], v[44:47], a[212:215]
    v_mfma_f32_16x16x32_bf16 a[216:219], a[48:51], v[40:43], 0
    v_mfma_f32_16x16x32_bf16 a[216:219], a[52:55], v[44:47], a[216:219]
    v_mfma_f32_16x16x32_bf16 a[220:223], a[56:59], v[40:43], 0
    v_mfma_f32_16x16x32_bf16 a[220:223], a[60:63], v[44:47], a[220:223]
    s_waitcnt lgkmcnt(0)
    buffer_load_dwordx4 v8, s[8:11], s61 offen offset:2048 lds
    v_mfma_f32_16x16x32_bf16 a[224:227], a[0:3], v[48:51], 0
    v_mfma_f32_16x16x32_bf16 a[224:227], a[4:7], v[52:55], a[224:227]
    v_mfma_f32_16x16x32_bf16 a[228:231], a[8:11], v[48:51], 0
    v_mfma_f32_16x16x32_bf16 a[228:231], a[12:15], v[52:55], a[228:231]
    buffer_load_dwordx4 v9, s[8:11], s61 offen offset:3072 lds
    v_mfma_f32_16x16x32_bf16 a[232:235], a[16:19], v[48:51], 0
    v_mfma_f32_16x16x32_bf16 a[232:235], a[20:23], v[52:55], a[232:235]
    s_waitcnt vmcnt(8) lgkmcnt(0)
    s_barrier
    ds_read_b64_tr_b16 v[56:57], v14 offset:32768
    v_mfma_f32_16x16x32_bf16 a[236:239], a[24:27], v[48:51], 0
    s_add_u32 m0, s69, 32768
    ds_read_b64_tr_b16 v[58:59], v14 offset:33792
    ds_read_b64_tr_b16 v[60:61], v14 offset:40960
    v_mfma_f32_16x16x32_bf16 a[236:239], a[28:31], v[52:55], a[236:239]
    s_xor_b32 s61, s61, 896
    buffer_load_dwordx4 v2, s[16:19], s60 offen nt lds
    v_mfma_f32_16x16x32_bf16 a[240:243], a[32:35], v[48:51], 0
    ds_read_b64_tr_b16 v[62:63], v14 offset:41984
    ds_read_b64_tr_b16 v[40:41], v15 offset:32768
    v_mfma_f32_16x16x32_bf16 a[240:243], a[36:39], v[52:55], a[240:243]
    ds_read_b64_tr_b16 v[42:43], v15 offset:33792
    ds_read_b64_tr_b16 v[44:45], v15 offset:40960
    v_mfma_f32_16x16x32_bf16 a[244:247], a[40:43], v[48:51], 0
    ds_read_b64_tr_b16 v[46:47], v15 offset:41984
    v_add_u32 v14, 0x10000, v14
    v_mfma_f32_16x16x32_bf16 a[244:247], a[44:47], v[52:55], a[244:247]
    v_add_u32 v15, 0x10000, v15
    v_mfma_f32_16x16x32_bf16 a[248:251], a[48:51], v[48:51], 0
    v_mfma_f32_16x16x32_bf16 a[248:251], a[52:55], v[52:55], a[248:251]
    buffer_load_dwordx4 v3, s[16:19], s60 offen offset:1024 nt lds
    v_mfma_f32_16x16x32_bf16 a[252:255], a[56:59], v[48:51], 0
    ds_read_b64_tr_b16 v[48:49], v16 offset:32768
    ds_read_b64_tr_b16 v[50:51], v16 offset:33792
    v_mfma_f32_16x16x32_bf16 a[252:255], a[60:63], v[52:55], a[252:255]
    s_waitcnt lgkmcnt(2)
    ds_read_b64_tr_b16 v[52:53], v16 offset:40960
    ds_read_b64_tr_b16 v[54:55], v16 offset:41984
    v_mfma_f32_16x16x32_bf16 v[128:131], v[56:59], a[64:67], v[128:131]
    v_add_u32 v16, 0x10000, v16
    v_mfma_f32_16x16x32_bf16 v[128:131], v[60:63], a[68:71], v[128:131]
    v_mfma_f32_16x16x32_bf16 v[132:135], v[56:59], a[72:75], v[132:135]
    ds_read_b128 a[0:3], v22 offset:49152
    v_mfma_f32_16x16x32_bf16 v[132:135], v[60:63], a[76:79], v[132:135]
    v_mfma_f32_16x16x32_bf16 v[136:139], v[56:59], a[80:83], v[136:139]
    v_mfma_f32_16x16x32_bf16 v[136:139], v[60:63], a[84:87], v[136:139]
    buffer_load_dwordx4 v4, s[16:19], s60 offen offset:2048 nt lds
    v_mfma_f32_16x16x32_bf16 v[140:143], v[56:59], a[88:91], v[140:143]
    v_mfma_f32_16x16x32_bf16 v[140:143], v[60:63], a[92:95], v[140:143]
    ds_read_b128 a[4:7], v23 offset:49152
    v_mfma_f32_16x16x32_bf16 v[144:147], v[56:59], a[96:99], v[144:147]
    v_mfma_f32_16x16x32_bf16 v[144:147], v[60:63], a[100:103], v[144:147]
    v_mfma_f32_16x16x32_bf16 v[148:151], v[56:59], a[104:107], v[148:151]
    v_mfma_f32_16x16x32_bf16 v[148:151], v[60:63], a[108:111], v[148:151]
    v_mfma_f32_16x16x32_bf16 v[152:155], v[56:59], a[112:115], v[152:155]
    buffer_load_dwordx4 v5, s[16:19], s60 offen offset:3072 nt lds
    v_mfma_f32_16x16x32_bf16 v[152:155], v[60:63], a[116:119], v[152:155]
    ds_read_b128 a[8:11], v22 offset:51200
    v_mfma_f32_16x16x32_bf16 v[156:159], v[56:59], a[120:123], v[156:159]
    ds_read_b64_tr_b16 v[56:57], v17 offset:32768
    ds_read_b64_tr_b16 v[58:59], v17 offset:33792
    v_mfma_f32_16x16x32_bf16 v[156:159], v[60:63], a[124:127], v[156:159]
    ds_read_b64_tr_b16 v[60:61], v17 offset:40960
    ds_read_b64_tr_b16 v[62:63], v17 offset:41984
    v_mfma_f32_16x16x32_bf16 v[160:163], v[40:43], a[64:67], v[160:163]
    v_add_u32 v17, 0x10000, v17
    v_mfma_f32_16x16x32_bf16 v[160:163], v[44:47], a[68:71], v[160:163]
    v_mfma_f32_16x16x32_bf16 v[164:167], v[40:43], a[72:75], v[164:167]
    ds_read_b128 a[12:15], v23 offset:51200
    v_mfma_f32_16x16x32_bf16 v[164:167], v[44:47], a[76:79], v[164:167]
    s_add_u32 m0, s69, 49152
    v_mfma_f32_16x16x32_bf16 v[168:171], v[40:43], a[80:83], v[168:171]
    s_xor_b32 s60, s60, 524288
    buffer_load_dwordx4 v6, s[8:11], s62 offen lds
    v_mfma_f32_16x16x32_bf16 v[168:171], v[44:47], a[84:87], v[168:171]
    v_mfma_f32_16x16x32_bf16 v[172:175], v[40:43], a[88:91], v[172:175]
    v_mfma_f32_16x16x32_bf16 v[172:175], v[44:47], a[92:95], v[172:175]
    v_mfma_f32_16x16x32_bf16 v[176:179], v[40:43], a[96:99], v[176:179]
    ds_read_b128 a[16:19], v22 offset:53248
    v_mfma_f32_16x16x32_bf16 v[176:179], v[44:47], a[100:103], v[176:179]
    v_mfma_f32_16x16x32_bf16 v[180:183], v[40:43], a[104:107], v[180:183]
    v_mfma_f32_16x16x32_bf16 v[180:183], v[44:47], a[108:111], v[180:183]
    buffer_load_dwordx4 v7, s[8:11], s62 offen offset:1024 lds
    v_mfma_f32_16x16x32_bf16 v[184:187], v[40:43], a[112:115], v[184:187]
    v_mfma_f32_16x16x32_bf16 v[184:187], v[44:47], a[116:119], v[184:187]
    ds_read_b128 a[20:23], v23 offset:53248
    v_mfma_f32_16x16x32_bf16 v[188:191], v[40:43], a[120:123], v[188:191]
    s_waitcnt lgkmcnt(1)
    ds_read_b64_tr_b16 v[40:41], v14 offset:0
    ds_read_b64_tr_b16 v[42:43], v14 offset:1024
    v_mfma_f32_16x16x32_bf16 v[188:191], v[44:47], a[124:127], v[188:191]
    ds_read_b64_tr_b16 v[44:45], v14 offset:8192
    ds_read_b64_tr_b16 v[46:47], v14 offset:9216
    v_mfma_f32_16x16x32_bf16 v[192:195], v[48:51], a[64:67], v[192:195]
    v_add_u32 v14, 0xfffe0000, v14
    v_mfma_f32_16x16x32_bf16 v[192:195], v[52:55], a[68:71], v[192:195]
    v_mfma_f32_16x16x32_bf16 v[196:199], v[48:51], a[72:75], v[196:199]
    v_mfma_f32_16x16x32_bf16 v[196:199], v[52:55], a[76:79], v[196:199]
    buffer_load_dwordx4 v8, s[8:11], s62 offen offset:2048 lds
    v_mfma_f32_16x16x32_bf16 v[200:203], v[48:51], a[80:83], v[200:203]
    ds_read_b128 a[24:27], v22 offset:55296
    v_mfma_f32_16x16x32_bf16 v[200:203], v[52:55], a[84:87], v[200:203]
    v_mfma_f32_16x16x32_bf16 v[204:207], v[48:51], a[88:91], v[204:207]
    v_mfma_f32_16x16x32_bf16 v[204:207], v[52:55], a[92:95], v[204:207]
    v_mfma_f32_16x16x32_bf16 v[208:211], v[48:51], a[96:99], v[208:211]
    ds_read_b128 a[28:31], v23 offset:55296
    v_mfma_f32_16x16x32_bf16 v[208:211], v[52:55], a[100:103], v[208:211]
    v_mfma_f32_16x16x32_bf16 v[212:215], v[48:51], a[104:107], v[212:215]
    buffer_load_dwordx4 v9, s[8:11], s62 offen offset:3072 lds
    v_mfma_f32_16x16x32_bf16 v[212:215], v[52:55], a[108:111], v[212:215]
    v_mfma_f32_16x16x32_bf16 v[216:219], v[48:51], a[112:115], v[216:219]
    v_mfma_f32_16x16x32_bf16 v[216:219], v[52:55], a[116:119], v[216:219]
    v_mfma_f32_16x16x32_bf16 v[220:223], v[48:51], a[120:123], v[220:223]
    ds_read_b64_tr_b16 v[48:49], v15 offset:0
    ds_read_b64_tr_b16 v[50:51], v15 offset:1024
    v_mfma_f32_16x16x32_bf16 v[220:223], v[52:55], a[124:127], v[220:223]
    ds_read_b64_tr_b16 v[52:53], v15 offset:8192
    ds_read_b64_tr_b16 v[54:55], v15 offset:9216
    v_mfma_f32_16x16x32_bf16 v[224:227], v[56:59], a[64:67], v[224:227]
    buffer_load_dwordx2 v[80:81], v75, s[28:31], s98 offen nt
    v_mfma_f32_16x16x32_bf16 v[224:227], v[60:63], a[68:71], v[224:227]
    s_xor_b32 s62, s62, 896
    v_add_u32 v15, 0xfffe0000, v15
    v_mfma_f32_16x16x32_bf16 v[228:231], v[56:59], a[72:75], v[228:231]
    buffer_load_dword v105, v103, s[20:23], s77 offen
    v_mfma_f32_16x16x32_bf16 v[228:231], v[60:63], a[76:79], v[228:231]
    s_mul_i32 s77, s2, 18432
    v_mfma_f32_16x16x32_bf16 v[232:235], v[56:59], a[80:83], v[232:235]
    s_add_u32 s77, s77, s76
    buffer_load_dwordx2 v[82:83], v77, s[28:31], s98 offen nt
    v_mfma_f32_16x16x32_bf16 v[232:235], v[60:63], a[84:87], v[232:235]
    s_add_u32 s98, s98, 3456
    v_mfma_f32_16x16x32_bf16 v[236:239], v[56:59], a[88:91], v[236:239]
    s_add_u32 m0, s69, 65536
    v_mfma_f32_16x16x32_bf16 v[236:239], v[60:63], a[92:95], v[236:239]
    s_mov_b32 s76, 0
    v_mfma_f32_16x16x32_bf16 v[240:243], v[56:59], a[96:99], v[240:243]
    buffer_load_ushort v92, v65, s[32:35], s99 offen offset:0
    v_mfma_f32_16x16x32_bf16 v[240:243], v[60:63], a[100:103], v[240:243]
    v_mfma_f32_16x16x32_bf16 v[244:247], v[56:59], a[104:107], v[244:247]
    v_mfma_f32_16x16x32_bf16 v[244:247], v[60:63], a[108:111], v[244:247]
    v_mfma_f32_16x16x32_bf16 v[248:251], v[56:59], a[112:115], v[248:251]
    buffer_load_dwordx2 v[84:85], v75, s[28:31], s98 offen nt
    v_mfma_f32_16x16x32_bf16 v[248:251], v[60:63], a[116:119], v[248:251]
    v_mfma_f32_16x16x32_bf16 v[252:255], v[56:59], a[120:123], v[252:255]
    ds_read_b64_tr_b16 v[56:57], v16 offset:0
    ds_read_b64_tr_b16 v[58:59], v16 offset:1024
    v_mfma_f32_16x16x32_bf16 v[252:255], v[60:63], a[124:127], v[252:255]
    s_waitcnt lgkmcnt(2)
    ds_read_b64_tr_b16 v[60:61], v16 offset:8192
    ds_read_b64_tr_b16 v[62:63], v16 offset:9216
    v_mfma_f32_16x16x32_bf16 a[128:131], a[64:67], v[40:43], a[128:131]
    buffer_load_dwordx4 v2, s[12:15], s60 offen nt lds
    v_mfma_f32_16x16x32_bf16 a[128:131], a[68:71], v[44:47], a[128:131]
    v_add_u32 v22, 0x10000, v22
    v_add_u32 v16, 0xfffe0000, v16
    v_mfma_f32_16x16x32_bf16 a[132:135], a[72:75], v[40:43], a[132:135]
    ds_read_b128 a[32:35], v22 offset:16384
    v_mfma_f32_16x16x32_bf16 a[132:135], a[76:79], v[44:47], a[132:135]
    v_mfma_f32_16x16x32_bf16 a[136:139], a[80:83], v[40:43], a[136:139]
    buffer_load_dwordx2 v[86:87], v77, s[28:31], s98 offen nt
    v_mfma_f32_16x16x32_bf16 a[136:139], a[84:87], v[44:47], a[136:139]
    s_add_u32 s98, s98, 3456
    v_mfma_f32_16x16x32_bf16 a[140:143], a[88:91], v[40:43], a[140:143]
    v_add_u32 v23, 0x10000, v23
    v_mfma_f32_16x16x32_bf16 a[140:143], a[92:95], v[44:47], a[140:143]
    ds_read_b128 a[36:39], v23 offset:16384
    v_mfma_f32_16x16x32_bf16 a[144:147], a[96:99], v[40:43], a[144:147]
    buffer_load_ushort v93, v65, s[32:35], s99 offen offset:2
    v_mfma_f32_16x16x32_bf16 a[144:147], a[100:103], v[44:47], a[144:147]
    v_mfma_f32_16x16x32_bf16 a[148:151], a[104:107], v[40:43], a[148:151]
    v_mfma_f32_16x16x32_bf16 a[148:151], a[108:111], v[44:47], a[148:151]
    v_mfma_f32_16x16x32_bf16 a[152:155], a[112:115], v[40:43], a[152:155]
    buffer_load_dwordx2 v[88:89], v75, s[28:31], s98 offen nt
    v_mfma_f32_16x16x32_bf16 a[152:155], a[116:119], v[44:47], a[152:155]
    ds_read_b128 a[40:43], v22 offset:18432
    v_mfma_f32_16x16x32_bf16 a[156:159], a[120:123], v[40:43], a[156:159]
    ds_read_b64_tr_b16 v[40:41], v17 offset:0
    ds_read_b64_tr_b16 v[42:43], v17 offset:1024
    v_mfma_f32_16x16x32_bf16 a[156:159], a[124:127], v[44:47], a[156:159]
    ds_read_b64_tr_b16 v[44:45], v17 offset:8192
    ds_read_b64_tr_b16 v[46:47], v17 offset:9216
    v_mfma_f32_16x16x32_bf16 a[160:163], a[64:67], v[48:51], a[160:163]
    buffer_load_dwordx4 v3, s[12:15], s60 offen offset:1024 nt lds
    v_mfma_f32_16x16x32_bf16 a[160:163], a[68:71], v[52:55], a[160:163]
    v_add_u32 v17, 0xfffe0000, v17
    v_mfma_f32_16x16x32_bf16 a[164:167], a[72:75], v[48:51], a[164:167]
    ds_read_b128 a[44:47], v23 offset:18432
    v_mfma_f32_16x16x32_bf16 a[164:167], a[76:79], v[52:55], a[164:167]
    v_mfma_f32_16x16x32_bf16 a[168:171], a[80:83], v[48:51], a[168:171]
    buffer_load_dwordx2 v[90:91], v77, s[28:31], s98 offen nt
    v_mfma_f32_16x16x32_bf16 a[168:171], a[84:87], v[52:55], a[168:171]
    s_add_u32 s98, s98, 3456
    s_add_u32 s28, s56, 6291456
    s_addc_u32 s29, s57, 0
    v_mfma_f32_16x16x32_bf16 a[172:175], a[88:91], v[48:51], a[172:175]
    s_mov_b32 s30, 2359296
    v_mfma_f32_16x16x32_bf16 a[172:175], a[92:95], v[52:55], a[172:175]
    s_bfe_u32 s98, s72, 0x10001
    v_mfma_f32_16x16x32_bf16 a[176:179], a[96:99], v[48:51], a[176:179]
    buffer_load_ushort v94, v65, s[32:35], s99 offen offset:4
    v_mfma_f32_16x16x32_bf16 a[176:179], a[100:103], v[52:55], a[176:179]
    s_add_u32 s32, s56, 9437184
    s_addc_u32 s33, s57, 0
    s_mov_b32 s34, 196608
    v_mfma_f32_16x16x32_bf16 a[180:183], a[104:107], v[48:51], a[180:183]
    s_bfe_u32 s99, s72, 0x10003
    ds_read_b128 a[48:51], v22 offset:20480
    v_mfma_f32_16x16x32_bf16 a[180:183], a[108:111], v[52:55], a[180:183]
    s_lshl1_add_u32 s98, s99, s98
    v_mfma_f32_16x16x32_bf16 a[184:187], a[112:115], v[48:51], a[184:187]
    s_lshl_b32 s98, s98, 5
    buffer_store_dword v65, v64, s[32:35], s101 offen sc1
    v_mfma_f32_16x16x32_bf16 a[184:187], a[116:119], v[52:55], a[184:187]
    s_lshl_b32 s72, s72, 7
    ds_read_b128 a[52:55], v23 offset:20480
    v_mfma_f32_16x16x32_bf16 a[188:191], a[120:123], v[48:51], a[188:191]
    v_mfma_f32_16x16x32_bf16 a[188:191], a[124:127], v[52:55], a[188:191]
    s_waitcnt lgkmcnt(1)
    v_mfma_f32_16x16x32_bf16 a[192:195], a[64:67], v[56:59], a[192:195]
    buffer_load_dwordx4 v4, s[12:15], s60 offen offset:2048 nt lds
    v_mfma_f32_16x16x32_bf16 a[192:195], a[68:71], v[60:63], a[192:195]
    v_mfma_f32_16x16x32_bf16 a[196:199], a[72:75], v[56:59], a[196:199]
    v_mfma_f32_16x16x32_bf16 a[196:199], a[76:79], v[60:63], a[196:199]
    ds_read_b128 a[56:59], v22 offset:22528
    v_mfma_f32_16x16x32_bf16 a[200:203], a[80:83], v[56:59], a[200:203]
    buffer_load_dwordx4 v5, s[12:15], s60 offen offset:3072 nt lds
    v_mfma_f32_16x16x32_bf16 a[200:203], a[84:87], v[60:63], a[200:203]
    s_add_u32 m0, s69, 81920
    v_mfma_f32_16x16x32_bf16 a[204:207], a[88:91], v[56:59], a[204:207]
    v_mfma_f32_16x16x32_bf16 a[204:207], a[92:95], v[60:63], a[204:207]
    v_mfma_f32_16x16x32_bf16 a[208:211], a[96:99], v[56:59], a[208:211]
    buffer_load_dwordx4 v6, s[8:11], s61 offen lds
    v_mfma_f32_16x16x32_bf16 a[208:211], a[100:103], v[60:63], a[208:211]
    ds_read_b128 a[60:63], v23 offset:22528
    v_mfma_f32_16x16x32_bf16 a[212:215], a[104:107], v[56:59], a[212:215]
    v_mfma_f32_16x16x32_bf16 a[212:215], a[108:111], v[60:63], a[212:215]
    v_mfma_f32_16x16x32_bf16 a[216:219], a[112:115], v[56:59], a[216:219]
    buffer_load_dwordx4 v7, s[8:11], s61 offen offset:1024 lds
    v_mfma_f32_16x16x32_bf16 a[216:219], a[116:119], v[60:63], a[216:219]
    v_mfma_f32_16x16x32_bf16 a[220:223], a[120:123], v[56:59], a[220:223]
    v_mfma_f32_16x16x32_bf16 a[220:223], a[124:127], v[60:63], a[220:223]
    v_mfma_f32_16x16x32_bf16 a[224:227], a[64:67], v[40:43], a[224:227]
    buffer_load_dwordx4 v8, s[8:11], s61 offen offset:2048 lds
    v_mfma_f32_16x16x32_bf16 a[224:227], a[68:71], v[44:47], a[224:227]
    v_mfma_f32_16x16x32_bf16 a[228:231], a[72:75], v[40:43], a[228:231]
    v_mfma_f32_16x16x32_bf16 a[228:231], a[76:79], v[44:47], a[228:231]
    v_mfma_f32_16x16x32_bf16 a[232:235], a[80:83], v[40:43], a[232:235]
    buffer_load_dwordx4 v9, s[8:11], s61 offen offset:3072 lds
    v_mfma_f32_16x16x32_bf16 a[232:235], a[84:87], v[44:47], a[232:235]
    s_xor_b32 s61, s61, 128
    s_waitcnt vmcnt(19) lgkmcnt(0)
    s_barrier
    v_mfma_f32_16x16x32_bf16 a[236:239], a[88:91], v[40:43], a[236:239]
    s_add_u32 m0, s69, 98304
    ds_read_b64_tr_b16 v[48:49], v14 offset:0
    ds_read_b64_tr_b16 v[50:51], v14 offset:1024
    v_mfma_f32_16x16x32_bf16 a[236:239], a[92:95], v[44:47], a[236:239]
    ds_read_b64_tr_b16 v[52:53], v14 offset:8192
    ds_read_b64_tr_b16 v[54:55], v14 offset:9216
    v_mfma_f32_16x16x32_bf16 a[240:243], a[96:99], v[40:43], a[240:243]
    buffer_load_dwordx4 v2, s[16:19], s60 offen nt lds
    v_mfma_f32_16x16x32_bf16 a[240:243], a[100:103], v[44:47], a[240:243]
    ds_read_b64_tr_b16 v[56:57], v15 offset:0
    ds_read_b64_tr_b16 v[58:59], v15 offset:1024
    v_mfma_f32_16x16x32_bf16 a[244:247], a[104:107], v[40:43], a[244:247]
    ds_read_b64_tr_b16 v[60:61], v15 offset:8192
    ds_read_b64_tr_b16 v[62:63], v15 offset:9216
    v_mfma_f32_16x16x32_bf16 a[244:247], a[108:111], v[44:47], a[244:247]
    s_cmp_lt_u32 s2, 192
    s_cselect_b32 s72, s72, 1073741824
    v_mfma_f32_16x16x32_bf16 a[248:251], a[112:115], v[40:43], a[248:251]
    v_mfma_f32_16x16x32_bf16 a[248:251], a[116:119], v[44:47], a[248:251]
    buffer_load_dwordx4 v3, s[16:19], s60 offen offset:1024 nt lds
    v_mfma_f32_16x16x32_bf16 a[252:255], a[120:123], v[40:43], a[252:255]
    ds_read_b64_tr_b16 v[40:41], v16 offset:0
    ds_read_b64_tr_b16 v[42:43], v16 offset:1024
    v_mfma_f32_16x16x32_bf16 a[252:255], a[124:127], v[44:47], a[252:255]
    s_waitcnt lgkmcnt(2)
    ds_read_b64_tr_b16 v[44:45], v16 offset:8192
    ds_read_b64_tr_b16 v[46:47], v16 offset:9216
    v_mfma_f32_16x16x32_bf16 v[128:131], v[48:51], a[0:3], v[128:131]
    v_mfma_f32_16x16x32_bf16 v[128:131], v[52:55], a[4:7], v[128:131]
    v_add_u32 v22, 0xfffe0000, v22
    v_mfma_f32_16x16x32_bf16 v[132:135], v[48:51], a[8:11], v[132:135]
    ds_read_b128 a[64:67], v22 offset:16384
    v_mfma_f32_16x16x32_bf16 v[132:135], v[52:55], a[12:15], v[132:135]
    v_mfma_f32_16x16x32_bf16 v[136:139], v[48:51], a[16:19], v[136:139]
    v_mfma_f32_16x16x32_bf16 v[136:139], v[52:55], a[20:23], v[136:139]
    buffer_load_dwordx4 v4, s[16:19], s60 offen offset:2048 nt lds
    v_mfma_f32_16x16x32_bf16 v[140:143], v[48:51], a[24:27], v[140:143]
    v_add_u32 v23, 0xfffe0000, v23
    v_mfma_f32_16x16x32_bf16 v[140:143], v[52:55], a[28:31], v[140:143]
    ds_read_b128 a[68:71], v23 offset:16384
    v_mfma_f32_16x16x32_bf16 v[144:147], v[48:51], a[32:35], v[144:147]
    v_mfma_f32_16x16x32_bf16 v[144:147], v[52:55], a[36:39], v[144:147]
    v_mfma_f32_16x16x32_bf16 v[148:151], v[48:51], a[40:43], v[148:151]
    v_mfma_f32_16x16x32_bf16 v[148:151], v[52:55], a[44:47], v[148:151]
    v_mfma_f32_16x16x32_bf16 v[152:155], v[48:51], a[48:51], v[152:155]
    buffer_load_dwordx4 v5, s[16:19], s60 offen offset:3072 nt lds
    v_mfma_f32_16x16x32_bf16 v[152:155], v[52:55], a[52:55], v[152:155]
    ds_read_b128 a[72:75], v22 offset:18432
    v_mfma_f32_16x16x32_bf16 v[156:159], v[48:51], a[56:59], v[156:159]
    ds_read_b64_tr_b16 v[48:49], v17 offset:0
    ds_read_b64_tr_b16 v[50:51], v17 offset:1024
    v_mfma_f32_16x16x32_bf16 v[156:159], v[52:55], a[60:63], v[156:159]
    ds_read_b64_tr_b16 v[52:53], v17 offset:8192
    ds_read_b64_tr_b16 v[54:55], v17 offset:9216
    v_mfma_f32_16x16x32_bf16 v[160:163], v[56:59], a[0:3], v[160:163]
    v_mfma_f32_16x16x32_bf16 v[160:163], v[60:63], a[4:7], v[160:163]
    v_mfma_f32_16x16x32_bf16 v[164:167], v[56:59], a[8:11], v[164:167]
    ds_read_b128 a[76:79], v23 offset:18432
    v_mfma_f32_16x16x32_bf16 v[164:167], v[60:63], a[12:15], v[164:167]
    s_add_u32 m0, s69, 114688
    v_mfma_f32_16x16x32_bf16 v[168:171], v[56:59], a[16:19], v[168:171]
    s_xor_b32 s60, s60, 3670016
    buffer_load_dwordx4 v6, s[8:11], s62 offen lds
    v_mfma_f32_16x16x32_bf16 v[168:171], v[60:63], a[20:23], v[168:171]
    v_mfma_f32_16x16x32_bf16 v[172:175], v[56:59], a[24:27], v[172:175]
    v_mfma_f32_16x16x32_bf16 v[172:175], v[60:63], a[28:31], v[172:175]
    v_mfma_f32_16x16x32_bf16 v[176:179], v[56:59], a[32:35], v[176:179]
    ds_read_b128 a[80:83], v22 offset:20480
    v_mfma_f32_16x16x32_bf16 v[176:179], v[60:63], a[36:39], v[176:179]
    v_mfma_f32_16x16x32_bf16 v[180:183], v[56:59], a[40:43], v[180:183]
    v_mfma_f32_16x16x32_bf16 v[180:183], v[60:63], a[44:47], v[180:183]
    buffer_load_dwordx4 v7, s[8:11], s62 offen offset:1024 lds
    v_mfma_f32_16x16x32_bf16 v[184:187], v[56:59], a[48:51], v[184:187]
    v_mfma_f32_16x16x32_bf16 v[184:187], v[60:63], a[52:55], v[184:187]
    ds_read_b128 a[84:87], v23 offset:20480
    v_mfma_f32_16x16x32_bf16 v[188:191], v[56:59], a[56:59], v[188:191]
    s_waitcnt lgkmcnt(1)
    ds_read_b64_tr_b16 v[56:57], v14 offset:32768
    ds_read_b64_tr_b16 v[58:59], v14 offset:33792
    v_mfma_f32_16x16x32_bf16 v[188:191], v[60:63], a[60:63], v[188:191]
    ds_read_b64_tr_b16 v[60:61], v14 offset:40960
    ds_read_b64_tr_b16 v[62:63], v14 offset:41984
    v_mfma_f32_16x16x32_bf16 v[192:195], v[40:43], a[0:3], v[192:195]
    v_add_u32 v14, 0x10000, v14
    v_mfma_f32_16x16x32_bf16 v[192:195], v[44:47], a[4:7], v[192:195]
    v_mfma_f32_16x16x32_bf16 v[196:199], v[40:43], a[8:11], v[196:199]
    v_mfma_f32_16x16x32_bf16 v[196:199], v[44:47], a[12:15], v[196:199]
    buffer_load_dwordx4 v8, s[8:11], s62 offen offset:2048 lds
    v_mfma_f32_16x16x32_bf16 v[200:203], v[40:43], a[16:19], v[200:203]
    ds_read_b128 a[88:91], v22 offset:22528
    v_mfma_f32_16x16x32_bf16 v[200:203], v[44:47], a[20:23], v[200:203]
    v_mfma_f32_16x16x32_bf16 v[204:207], v[40:43], a[24:27], v[204:207]
    v_mfma_f32_16x16x32_bf16 v[204:207], v[44:47], a[28:31], v[204:207]
    v_mfma_f32_16x16x32_bf16 v[208:211], v[40:43], a[32:35], v[208:211]
    ds_read_b128 a[92:95], v23 offset:22528
    v_mfma_f32_16x16x32_bf16 v[208:211], v[44:47], a[36:39], v[208:211]
    v_mfma_f32_16x16x32_bf16 v[212:215], v[40:43], a[40:43], v[212:215]
    buffer_load_dwordx4 v9, s[8:11], s62 offen offset:3072 lds
    v_mfma_f32_16x16x32_bf16 v[212:215], v[44:47], a[44:47], v[212:215]
    v_mfma_f32_16x16x32_bf16 v[216:219], v[40:43], a[48:51], v[216:219]
    v_mfma_f32_16x16x32_bf16 v[216:219], v[44:47], a[52:55], v[216:219]
    v_mfma_f32_16x16x32_bf16 v[220:223], v[40:43], a[56:59], v[220:223]
    ds_read_b64_tr_b16 v[40:41], v15 offset:32768
    ds_read_b64_tr_b16 v[42:43], v15 offset:33792
    v_mfma_f32_16x16x32_bf16 v[220:223], v[44:47], a[60:63], v[220:223]
    ds_read_b64_tr_b16 v[44:45], v15 offset:40960
    ds_read_b64_tr_b16 v[46:47], v15 offset:41984
    v_mfma_f32_16x16x32_bf16 v[224:227], v[48:51], a[0:3], v[224:227]
    v_add_u32 v15, 0x10000, v15
    v_mfma_f32_16x16x32_bf16 v[224:227], v[52:55], a[4:7], v[224:227]
    s_xor_b32 s62, s62, 128
    v_mfma_f32_16x16x32_bf16 v[228:231], v[48:51], a[8:11], v[228:231]
    buffer_load_dword v106, v103, s[24:27], s77 offen
    v_mfma_f32_16x16x32_bf16 v[228:231], v[52:55], a[12:15], v[228:231]
    s_add_u32 s77, s77, 4608
    v_mfma_f32_16x16x32_bf16 v[232:235], v[48:51], a[16:19], v[232:235]
    v_mfma_f32_16x16x32_bf16 v[232:235], v[52:55], a[20:23], v[232:235]
    s_add_u32 m0, s69, 131072
    v_mfma_f32_16x16x32_bf16 v[236:239], v[48:51], a[24:27], v[236:239]
    buffer_load_dwordx4 v2, s[12:15], s60 offen nt lds
    v_mfma_f32_16x16x32_bf16 v[236:239], v[52:55], a[28:31], v[236:239]
    v_mfma_f32_16x16x32_bf16 v[240:243], v[48:51], a[32:35], v[240:243]
    v_mfma_f32_16x16x32_bf16 v[240:243], v[52:55], a[36:39], v[240:243]
    v_mfma_f32_16x16x32_bf16 v[244:247], v[48:51], a[40:43], v[244:247]
    v_mfma_f32_16x16x32_bf16 v[244:247], v[52:55], a[44:47], v[244:247]
    v_mfma_f32_16x16x32_bf16 v[248:251], v[48:51], a[48:51], v[248:251]
    v_mfma_f32_16x16x32_bf16 v[248:251], v[52:55], a[52:55], v[248:251]
    buffer_load_dwordx4 v3, s[12:15], s60 offen offset:1024 nt lds
    v_mfma_f32_16x16x32_bf16 v[252:255], v[48:51], a[56:59], v[252:255]
    ds_read_b64_tr_b16 v[48:49], v16 offset:32768
    ds_read_b64_tr_b16 v[50:51], v16 offset:33792
    v_mfma_f32_16x16x32_bf16 v[252:255], v[52:55], a[60:63], v[252:255]
    s_waitcnt lgkmcnt(2)
    ds_read_b64_tr_b16 v[52:53], v16 offset:40960
    ds_read_b64_tr_b16 v[54:55], v16 offset:41984
    v_mfma_f32_16x16x32_bf16 a[128:131], a[0:3], v[56:59], a[128:131]
    v_add_u32 v16, 0x10000, v16
    v_mfma_f32_16x16x32_bf16 a[128:131], a[4:7], v[60:63], a[128:131]
    v_mfma_f32_16x16x32_bf16 a[132:135], a[8:11], v[56:59], a[132:135]
    ds_read_b128 a[96:99], v22 offset:49152
    v_mfma_f32_16x16x32_bf16 a[132:135], a[12:15], v[60:63], a[132:135]
    v_mfma_f32_16x16x32_bf16 a[136:139], a[16:19], v[56:59], a[136:139]
    v_mfma_f32_16x16x32_bf16 a[136:139], a[20:23], v[60:63], a[136:139]
    buffer_load_dwordx4 v4, s[12:15], s60 offen offset:2048 nt lds
    v_mfma_f32_16x16x32_bf16 a[140:143], a[24:27], v[56:59], a[140:143]
    v_mfma_f32_16x16x32_bf16 a[140:143], a[28:31], v[60:63], a[140:143]
    ds_read_b128 a[100:103], v23 offset:49152
    v_mfma_f32_16x16x32_bf16 a[144:147], a[32:35], v[56:59], a[144:147]
    v_mfma_f32_16x16x32_bf16 a[144:147], a[36:39], v[60:63], a[144:147]
    v_mfma_f32_16x16x32_bf16 a[148:151], a[40:43], v[56:59], a[148:151]
    v_mfma_f32_16x16x32_bf16 a[148:151], a[44:47], v[60:63], a[148:151]
    v_mfma_f32_16x16x32_bf16 a[152:155], a[48:51], v[56:59], a[152:155]
    buffer_load_dwordx4 v5, s[12:15], s60 offen offset:3072 nt lds
    v_mfma_f32_16x16x32_bf16 a[152:155], a[52:55], v[60:63], a[152:155]
    ds_read_b128 a[104:107], v22 offset:51200
    v_mfma_f32_16x16x32_bf16 a[156:159], a[56:59], v[56:59], a[156:159]
    ds_read_b64_tr_b16 v[56:57], v17 offset:32768
    ds_read_b64_tr_b16 v[58:59], v17 offset:33792
    v_mfma_f32_16x16x32_bf16 a[156:159], a[60:63], v[60:63], a[156:159]
    ds_read_b64_tr_b16 v[60:61], v17 offset:40960
    ds_read_b64_tr_b16 v[62:63], v17 offset:41984
    v_mfma_f32_16x16x32_bf16 a[160:163], a[0:3], v[40:43], a[160:163]
    v_add_u32 v17, 0x10000, v17
    v_mfma_f32_16x16x32_bf16 a[160:163], a[4:7], v[44:47], a[160:163]
    v_mfma_f32_16x16x32_bf16 a[164:167], a[8:11], v[40:43], a[164:167]
    ds_read_b128 a[108:111], v23 offset:51200
    v_mfma_f32_16x16x32_bf16 a[164:167], a[12:15], v[44:47], a[164:167]
    s_add_u32 m0, s69, 147456
    v_mfma_f32_16x16x32_bf16 a[168:171], a[16:19], v[40:43], a[168:171]
    buffer_load_dwordx4 v6, s[8:11], s61 offen lds
    v_mfma_f32_16x16x32_bf16 a[168:171], a[20:23], v[44:47], a[168:171]
    v_mfma_f32_16x16x32_bf16 a[172:175], a[24:27], v[40:43], a[172:175]
    v_mfma_f32_16x16x32_bf16 a[172:175], a[28:31], v[44:47], a[172:175]
    v_mfma_f32_16x16x32_bf16 a[176:179], a[32:35], v[40:43], a[176:179]
    ds_read_b128 a[112:115], v22 offset:53248
    v_mfma_f32_16x16x32_bf16 a[176:179], a[36:39], v[44:47], a[176:179]
    v_mfma_f32_16x16x32_bf16 a[180:183], a[40:43], v[40:43], a[180:183]
    v_mfma_f32_16x16x32_bf16 a[180:183], a[44:47], v[44:47], a[180:183]
    buffer_load_dwordx4 v7, s[8:11], s61 offen offset:1024 lds
    v_mfma_f32_16x16x32_bf16 a[184:187], a[48:51], v[40:43], a[184:187]
    v_mfma_f32_16x16x32_bf16 a[184:187], a[52:55], v[44:47], a[184:187]
    ds_read_b128 a[116:119], v23 offset:53248
    v_mfma_f32_16x16x32_bf16 a[188:191], a[56:59], v[40:43], a[188:191]
    v_mfma_f32_16x16x32_bf16 a[188:191], a[60:63], v[44:47], a[188:191]
    s_waitcnt lgkmcnt(1)
    v_mfma_f32_16x16x32_bf16 a[192:195], a[0:3], v[48:51], a[192:195]
    v_mfma_f32_16x16x32_bf16 a[192:195], a[4:7], v[52:55], a[192:195]
    v_mfma_f32_16x16x32_bf16 a[196:199], a[8:11], v[48:51], a[196:199]
    v_mfma_f32_16x16x32_bf16 a[196:199], a[12:15], v[52:55], a[196:199]
    buffer_load_dwordx4 v8, s[8:11], s61 offen offset:2048 lds
    v_mfma_f32_16x16x32_bf16 a[200:203], a[16:19], v[48:51], a[200:203]
    ds_read_b128 a[120:123], v22 offset:55296
    v_mfma_f32_16x16x32_bf16 a[200:203], a[20:23], v[52:55], a[200:203]
    v_mfma_f32_16x16x32_bf16 a[204:207], a[24:27], v[48:51], a[204:207]
    v_mfma_f32_16x16x32_bf16 a[204:207], a[28:31], v[52:55], a[204:207]
    v_mfma_f32_16x16x32_bf16 a[208:211], a[32:35], v[48:51], a[208:211]
    ds_read_b128 a[124:127], v23 offset:55296
    v_mfma_f32_16x16x32_bf16 a[208:211], a[36:39], v[52:55], a[208:211]
    v_mfma_f32_16x16x32_bf16 a[212:215], a[40:43], v[48:51], a[212:215]
    buffer_load_dwordx4 v9, s[8:11], s61 offen offset:3072 lds
    v_mfma_f32_16x16x32_bf16 a[212:215], a[44:47], v[52:55], a[212:215]
    v_mfma_f32_16x16x32_bf16 a[216:219], a[48:51], v[48:51], a[216:219]
    v_mfma_f32_16x16x32_bf16 a[216:219], a[52:55], v[52:55], a[216:219]
    v_mfma_f32_16x16x32_bf16 a[220:223], a[56:59], v[48:51], a[220:223]
    v_mfma_f32_16x16x32_bf16 a[220:223], a[60:63], v[52:55], a[220:223]
    v_mfma_f32_16x16x32_bf16 a[224:227], a[0:3], v[56:59], a[224:227]
    v_mfma_f32_16x16x32_bf16 a[224:227], a[4:7], v[60:63], a[224:227]
    s_xor_b32 s61, s61, 384
    v_mfma_f32_16x16x32_bf16 a[228:231], a[8:11], v[56:59], a[228:231]
    v_mfma_f32_16x16x32_bf16 a[228:231], a[12:15], v[60:63], a[228:231]
    v_mfma_f32_16x16x32_bf16 a[232:235], a[16:19], v[56:59], a[232:235]
    v_mfma_f32_16x16x32_bf16 a[232:235], a[20:23], v[60:63], a[232:235]
    s_waitcnt vmcnt(9) lgkmcnt(0)
    s_barrier
    ds_read_b64_tr_b16 v[40:41], v14 offset:0
    v_mfma_f32_16x16x32_bf16 a[236:239], a[24:27], v[56:59], a[236:239]
    s_add_u32 m0, s69, 0
    ds_read_b64_tr_b16 v[42:43], v14 offset:1024
    ds_read_b64_tr_b16 v[44:45], v14 offset:8192
    v_mfma_f32_16x16x32_bf16 a[236:239], a[28:31], v[60:63], a[236:239]
    buffer_load_dwordx4 v2, s[16:19], s60 offen nt lds
    v_mfma_f32_16x16x32_bf16 a[240:243], a[32:35], v[56:59], a[240:243]
    ds_read_b64_tr_b16 v[46:47], v14 offset:9216
    v_cndmask_b32_e64 v83, v83, 0, s[92:93]
    v_mfma_f32_16x16x32_bf16 a[240:243], a[36:39], v[60:63], a[240:243]
    v_cndmask_b32_e64 v81, v81, 0, vcc
    v_cndmask_b32 v82, v82, v92, s[92:93]
    v_mfma_f32_16x16x32_bf16 a[244:247], a[40:43], v[56:59], a[244:247]
    s_mov_b32 vcc_lo, 0x10101010
    s_mov_b32 vcc_hi, 0x10101010
    v_cndmask_b32_e64 v83, v83, 0, vcc
    v_mfma_f32_16x16x32_bf16 a[244:247], a[44:47], v[60:63], a[244:247]
    v_xor_b32 v92, s98, v95
    ds_read_b64_tr_b16 v[48:49], v15 offset:0
    v_mfma_f32_16x16x32_bf16 a[248:251], a[48:51], v[56:59], a[248:251]
    buffer_store_dwordx4 v[80:83], v92, s[28:31], s72 offen sc1
    v_mfma_f32_16x16x32_bf16 a[248:251], a[52:55], v[60:63], a[248:251]
    s_mul_i32 s72, s2, 3
    buffer_load_dwordx4 v3, s[16:19], s60 offen offset:1024 nt lds
    v_mfma_f32_16x16x32_bf16 a[252:255], a[56:59], v[56:59], a[252:255]
    s_add_u32 s72, s72, 1
    ds_read_b64_tr_b16 v[50:51], v15 offset:1024
    ds_read_b64_tr_b16 v[52:53], v15 offset:8192
    v_mfma_f32_16x16x32_bf16 a[252:255], a[60:63], v[60:63], a[252:255]
    s_bfe_u32 s98, s72, 0x10001
    ds_read_b64_tr_b16 v[54:55], v15 offset:9216
    v_cndmask_b32_e64 v87, v87, 0, s[92:93]
    s_waitcnt lgkmcnt(4)
    v_mfma_f32_16x16x32_bf16 v[128:131], v[40:43], a[64:67], v[128:131]
    s_bfe_u32 s99, s72, 0x10003
    v_cndmask_b32 v86, v86, v93, s[92:93]
    v_cndmask_b32_e64 v91, v91, 0, s[92:93]
    v_mfma_f32_16x16x32_bf16 v[128:131], v[44:47], a[68:71], v[128:131]
    s_lshl1_add_u32 s98, s99, s98
    v_add_u32 v22, 0x10000, v22
    v_cndmask_b32 v90, v90, v94, s[92:93]
    v_mfma_f32_16x16x32_bf16 v[132:135], v[40:43], a[72:75], v[132:135]
    s_lshl_b32 s98, s98, 5
    ds_read_b128 a[0:3], v22 offset:16384
    v_xor_b32 v93, s98, v95
    v_mfma_f32_16x16x32_bf16 v[132:135], v[44:47], a[76:79], v[132:135]
    s_mov_b32 vcc_lo, 0x84848484
    s_mov_b32 vcc_hi, 0x84848484
    v_cndmask_b32_e64 v85, v85, 0, vcc
    v_mfma_f32_16x16x32_bf16 v[136:139], v[40:43], a[80:83], v[136:139]
    s_mov_b32 vcc_lo, 0x10101010
    s_mov_b32 vcc_hi, 0x10101010
    v_cndmask_b32_e64 v87, v87, 0, vcc
    v_mfma_f32_16x16x32_bf16 v[136:139], v[44:47], a[84:87], v[136:139]
    s_lshl_b32 s72, s72, 7
    buffer_load_dwordx4 v4, s[16:19], s60 offen offset:2048 nt lds
    v_mfma_f32_16x16x32_bf16 v[140:143], v[40:43], a[88:91], v[140:143]
    v_add_u32 v23, 0x10000, v23
    ds_read_b64_tr_b16 v[56:57], v16 offset:0
    v_mfma_f32_16x16x32_bf16 v[140:143], v[44:47], a[92:95], v[140:143]
    ds_read_b128 a[4:7], v23 offset:16384
    ds_read_b64_tr_b16 v[58:59], v16 offset:1024
    v_mfma_f32_16x16x32_bf16 v[144:147], v[40:43], a[96:99], v[144:147]
    s_cmp_lt_u32 s2, 192
    s_cselect_b32 s72, s72, 1073741824
    ds_read_b64_tr_b16 v[60:61], v16 offset:8192
    v_mfma_f32_16x16x32_bf16 v[144:147], v[44:47], a[100:103], v[144:147]
    buffer_store_dwordx4 v[84:87], v93, s[28:31], s72 offen sc1
    v_mfma_f32_16x16x32_bf16 v[148:151], v[40:43], a[104:107], v[148:151]
    s_mul_i32 s72, s2, 3
    ds_read_b64_tr_b16 v[62:63], v16 offset:9216
    v_mfma_f32_16x16x32_bf16 v[148:151], v[44:47], a[108:111], v[148:151]
    s_add_u32 s72, s72, 2
    v_mfma_f32_16x16x32_bf16 v[152:155], v[40:43], a[112:115], v[152:155]
    s_bfe_u32 s98, s72, 0x10001
    buffer_load_dwordx4 v5, s[16:19], s60 offen offset:3072 nt lds
    v_mfma_f32_16x16x32_bf16 v[152:155], v[44:47], a[116:119], v[152:155]
    s_bfe_u32 s99, s72, 0x10003
    ds_read_b128 a[8:11], v22 offset:18432
    v_mfma_f32_16x16x32_bf16 v[156:159], v[40:43], a[120:123], v[156:159]
    s_mov_b32 vcc_lo, 0x84848484
    s_mov_b32 vcc_hi, 0x84848484
    v_cndmask_b32_e64 v89, v89, 0, vcc
    v_mfma_f32_16x16x32_bf16 v[156:159], v[44:47], a[124:127], v[156:159]
    s_lshl1_add_u32 s98, s99, s98
    ds_read_b64_tr_b16 v[40:41], v17 offset:0
    ds_read_b64_tr_b16 v[42:43], v17 offset:1024
    s_waitcnt lgkmcnt(3)
    v_mfma_f32_16x16x32_bf16 v[160:163], v[48:51], a[64:67], v[160:163]
    s_mov_b32 vcc_lo, 0x10101010
    s_mov_b32 vcc_hi, 0x10101010
    v_cndmask_b32_e64 v91, v91, 0, vcc
    v_mfma_f32_16x16x32_bf16 v[160:163], v[52:55], a[68:71], v[160:163]
    s_lshl_b32 s98, s98, 5
    v_xor_b32 v94, s98, v95
    ds_read_b64_tr_b16 v[44:45], v17 offset:8192
    v_mfma_f32_16x16x32_bf16 v[164:167], v[48:51], a[72:75], v[164:167]
    s_lshl_b32 s72, s72, 7
    ds_read_b128 a[12:15], v23 offset:18432
    ds_read_b64_tr_b16 v[46:47], v17 offset:9216
    v_mfma_f32_16x16x32_bf16 v[164:167], v[52:55], a[76:79], v[164:167]
    s_add_u32 m0, s69, 16384
    v_mfma_f32_16x16x32_bf16 v[168:171], v[48:51], a[80:83], v[168:171]
    s_xor_b32 s60, s60, 524288
    buffer_load_dwordx4 v6, s[8:11], s62 offen lds
    v_mfma_f32_16x16x32_bf16 v[168:171], v[52:55], a[84:87], v[168:171]
    s_cmp_lt_u32 s2, 192
    s_cselect_b32 s72, s72, 1073741824
    v_mfma_f32_16x16x32_bf16 v[172:175], v[48:51], a[88:91], v[172:175]
    s_bfe_u32 s98, s5, 0x20001
    buffer_store_dwordx4 v[88:91], v94, s[28:31], s72 offen sc1
    v_mfma_f32_16x16x32_bf16 v[172:175], v[52:55], a[92:95], v[172:175]
    s_add_u32 s28, s28, s7
    s_addc_u32 s29, s29, 0
    v_mfma_f32_16x16x32_bf16 v[176:179], v[48:51], a[96:99], v[176:179]
    s_mov_b32 s30, 73728
    ds_read_b128 a[16:19], v22 offset:20480
    v_mfma_f32_16x16x32_bf16 v[176:179], v[52:55], a[100:103], v[176:179]
    s_and_b32 s7, s5, 24
    v_mfma_f32_16x16x32_bf16 v[180:183], v[48:51], a[104:107], v[180:183]
    s_add_u32 s7, s7, s6
    v_mfma_f32_16x16x32_bf16 v[180:183], v[52:55], a[108:111], v[180:183]
    s_lshl2_add_u32 s7, s7, s98
    buffer_load_dwordx4 v7, s[8:11], s62 offen offset:1024 lds
    v_mfma_f32_16x16x32_bf16 v[184:187], v[48:51], a[112:115], v[184:187]
    s_mul_i32 s98, s7, 36864
    v_add_u32 v36, s98, v36
    v_sub_u32 v39, v36, v39
    v_mfma_f32_16x16x32_bf16 v[184:187], v[52:55], a[116:119], v[184:187]
    s_lshl2_add_u32 s99, s100, s4
    ds_read_b128 a[20:23], v23 offset:20480
    v_lshl_add_u32 v36, s100, 6, v36
    v_mfma_f32_16x16x32_bf16 v[188:191], v[48:51], a[120:123], v[188:191]
    s_lshl_b32 s99, s99, 7
    ds_read_b64_tr_b16 v[48:49], v14 offset:32768
    ds_read_b64_tr_b16 v[50:51], v14 offset:33792
    v_mfma_f32_16x16x32_bf16 v[188:191], v[52:55], a[124:127], v[188:191]
    ds_read_b64_tr_b16 v[52:53], v14 offset:40960
    ds_read_b64_tr_b16 v[54:55], v14 offset:41984
    v_mfma_f32_16x16x32_bf16 v[192:195], v[56:59], a[64:67], v[192:195]
    v_add_u32 v14, 0x10000, v14
    v_mfma_f32_16x16x32_bf16 v[192:195], v[60:63], a[68:71], v[192:195]
    v_mfma_f32_16x16x32_bf16 v[196:199], v[56:59], a[72:75], v[196:199]
    v_mfma_f32_16x16x32_bf16 v[196:199], v[60:63], a[76:79], v[196:199]
    buffer_load_dwordx4 v8, s[8:11], s62 offen offset:2048 lds
    v_mfma_f32_16x16x32_bf16 v[200:203], v[56:59], a[80:83], v[200:203]
    ds_read_b128 a[24:27], v22 offset:22528
    v_mfma_f32_16x16x32_bf16 v[200:203], v[60:63], a[84:87], v[200:203]
    v_mfma_f32_16x16x32_bf16 v[204:207], v[56:59], a[88:91], v[204:207]
    v_mfma_f32_16x16x32_bf16 v[204:207], v[60:63], a[92:95], v[204:207]
    v_mfma_f32_16x16x32_bf16 v[208:211], v[56:59], a[96:99], v[208:211]
    ds_read_b128 a[28:31], v23 offset:22528
    v_mfma_f32_16x16x32_bf16 v[208:211], v[60:63], a[100:103], v[208:211]
    v_mfma_f32_16x16x32_bf16 v[212:215], v[56:59], a[104:107], v[212:215]
    buffer_load_dwordx4 v9, s[8:11], s62 offen offset:3072 lds
    v_mfma_f32_16x16x32_bf16 v[212:215], v[60:63], a[108:111], v[212:215]
    v_mfma_f32_16x16x32_bf16 v[216:219], v[56:59], a[112:115], v[216:219]
    v_mfma_f32_16x16x32_bf16 v[216:219], v[60:63], a[116:119], v[216:219]
    v_mfma_f32_16x16x32_bf16 v[220:223], v[56:59], a[120:123], v[220:223]
    s_waitcnt lgkmcnt(0)
    ds_read_b64_tr_b16 v[56:57], v15 offset:32768
    ds_read_b64_tr_b16 v[58:59], v15 offset:33792
    v_mfma_f32_16x16x32_bf16 v[220:223], v[60:63], a[124:127], v[220:223]
    ds_read_b64_tr_b16 v[60:61], v15 offset:40960
    ds_read_b64_tr_b16 v[62:63], v15 offset:41984
    v_mfma_f32_16x16x32_bf16 v[224:227], v[40:43], a[64:67], v[224:227]
    v_add_u32 v15, 0x10000, v15
    v_mfma_f32_16x16x32_bf16 v[224:227], v[44:47], a[68:71], v[224:227]
    s_xor_b32 s62, s62, 384
    v_mfma_f32_16x16x32_bf16 v[228:231], v[40:43], a[72:75], v[228:231]
    buffer_load_dword v107, v103, s[24:27], s77 offen
    v_mfma_f32_16x16x32_bf16 v[228:231], v[44:47], a[76:79], v[228:231]
    s_add_u32 s77, s77, 4608
    v_mfma_f32_16x16x32_bf16 v[232:235], v[40:43], a[80:83], v[232:235]
    v_mfma_f32_16x16x32_bf16 v[232:235], v[44:47], a[84:87], v[232:235]
    s_add_u32 m0, s69, 32768
    v_mfma_f32_16x16x32_bf16 v[236:239], v[40:43], a[88:91], v[236:239]
    buffer_load_dwordx4 v2, s[12:15], s60 offen nt lds
    v_mfma_f32_16x16x32_bf16 v[236:239], v[44:47], a[92:95], v[236:239]
    v_mfma_f32_16x16x32_bf16 v[240:243], v[40:43], a[96:99], v[240:243]
    v_mfma_f32_16x16x32_bf16 v[240:243], v[44:47], a[100:103], v[240:243]
    v_mfma_f32_16x16x32_bf16 v[244:247], v[40:43], a[104:107], v[244:247]
    v_mfma_f32_16x16x32_bf16 v[244:247], v[44:47], a[108:111], v[244:247]
    v_mfma_f32_16x16x32_bf16 v[248:251], v[40:43], a[112:115], v[248:251]
    v_mfma_f32_16x16x32_bf16 v[248:251], v[44:47], a[116:119], v[248:251]
    buffer_load_dwordx4 v3, s[12:15], s60 offen offset:1024 nt lds
    v_mfma_f32_16x16x32_bf16 v[252:255], v[40:43], a[120:123], v[252:255]
    ds_read_b64_tr_b16 v[40:41], v16 offset:32768
    ds_read_b64_tr_b16 v[42:43], v16 offset:33792
    v_mfma_f32_16x16x32_bf16 v[252:255], v[44:47], a[124:127], v[252:255]
    ds_read_b64_tr_b16 v[44:45], v16 offset:40960
    ds_read_b64_tr_b16 v[46:47], v16 offset:41984
    v_mfma_f32_16x16x32_bf16 a[128:131], a[64:67], v[48:51], a[128:131]
    v_add_u32 v16, 0x10000, v16
    v_mfma_f32_16x16x32_bf16 a[128:131], a[68:71], v[52:55], a[128:131]
    v_mfma_f32_16x16x32_bf16 a[132:135], a[72:75], v[48:51], a[132:135]
    ds_read_b128 a[32:35], v22 offset:49152
    v_mfma_f32_16x16x32_bf16 a[132:135], a[76:79], v[52:55], a[132:135]
    v_mfma_f32_16x16x32_bf16 a[136:139], a[80:83], v[48:51], a[136:139]
    v_mfma_f32_16x16x32_bf16 a[136:139], a[84:87], v[52:55], a[136:139]
    buffer_load_dwordx4 v4, s[12:15], s60 offen offset:2048 nt lds
    v_mfma_f32_16x16x32_bf16 a[140:143], a[88:91], v[48:51], a[140:143]
    v_mfma_f32_16x16x32_bf16 a[140:143], a[92:95], v[52:55], a[140:143]
    ds_read_b128 a[36:39], v23 offset:49152
    v_mfma_f32_16x16x32_bf16 a[144:147], a[96:99], v[48:51], a[144:147]
    v_mfma_f32_16x16x32_bf16 a[144:147], a[100:103], v[52:55], a[144:147]
    v_mfma_f32_16x16x32_bf16 a[148:151], a[104:107], v[48:51], a[148:151]
    v_mfma_f32_16x16x32_bf16 a[148:151], a[108:111], v[52:55], a[148:151]
    v_mfma_f32_16x16x32_bf16 a[152:155], a[112:115], v[48:51], a[152:155]
    buffer_load_dwordx4 v5, s[12:15], s60 offen offset:3072 nt lds
    v_mfma_f32_16x16x32_bf16 a[152:155], a[116:119], v[52:55], a[152:155]
    ds_read_b128 a[40:43], v22 offset:51200
    v_mfma_f32_16x16x32_bf16 a[156:159], a[120:123], v[48:51], a[156:159]
    ds_read_b64_tr_b16 v[48:49], v17 offset:32768
    ds_read_b64_tr_b16 v[50:51], v17 offset:33792
    v_mfma_f32_16x16x32_bf16 a[156:159], a[124:127], v[52:55], a[156:159]
    s_waitcnt lgkmcnt(3)
    ds_read_b64_tr_b16 v[52:53], v17 offset:40960
    ds_read_b64_tr_b16 v[54:55], v17 offset:41984
    v_mfma_f32_16x16x32_bf16 a[160:163], a[64:67], v[56:59], a[160:163]
    v_add_u32 v17, 0x10000, v17
    v_mfma_f32_16x16x32_bf16 a[160:163], a[68:71], v[60:63], a[160:163]
    v_mfma_f32_16x16x32_bf16 a[164:167], a[72:75], v[56:59], a[164:167]
    ds_read_b128 a[44:47], v23 offset:51200
    v_mfma_f32_16x16x32_bf16 a[164:167], a[76:79], v[60:63], a[164:167]
    s_add_u32 m0, s69, 49152
    v_mfma_f32_16x16x32_bf16 a[168:171], a[80:83], v[56:59], a[168:171]
    buffer_load_dwordx4 v6, s[8:11], s61 offen lds
    v_mfma_f32_16x16x32_bf16 a[168:171], a[84:87], v[60:63], a[168:171]
    v_mfma_f32_16x16x32_bf16 a[172:175], a[88:91], v[56:59], a[172:175]
    v_mfma_f32_16x16x32_bf16 a[172:175], a[92:95], v[60:63], a[172:175]
    v_mfma_f32_16x16x32_bf16 a[176:179], a[96:99], v[56:59], a[176:179]
    ds_read_b128 a[48:51], v22 offset:53248
    v_mfma_f32_16x16x32_bf16 a[176:179], a[100:103], v[60:63], a[176:179]
    v_mfma_f32_16x16x32_bf16 a[180:183], a[104:107], v[56:59], a[180:183]
    v_mfma_f32_16x16x32_bf16 a[180:183], a[108:111], v[60:63], a[180:183]
    buffer_load_dwordx4 v7, s[8:11], s61 offen offset:1024 lds
    v_mfma_f32_16x16x32_bf16 a[184:187], a[112:115], v[56:59], a[184:187]
    v_mfma_f32_16x16x32_bf16 a[184:187], a[116:119], v[60:63], a[184:187]
    ds_read_b128 a[52:55], v23 offset:53248
    v_mfma_f32_16x16x32_bf16 a[188:191], a[120:123], v[56:59], a[188:191]
    v_mfma_f32_16x16x32_bf16 a[188:191], a[124:127], v[60:63], a[188:191]
    v_mfma_f32_16x16x32_bf16 a[192:195], a[64:67], v[40:43], a[192:195]
    v_mfma_f32_16x16x32_bf16 a[192:195], a[68:71], v[44:47], a[192:195]
    v_mfma_f32_16x16x32_bf16 a[196:199], a[72:75], v[40:43], a[196:199]
    v_mfma_f32_16x16x32_bf16 a[196:199], a[76:79], v[44:47], a[196:199]
    buffer_load_dwordx4 v8, s[8:11], s61 offen offset:2048 lds
    v_mfma_f32_16x16x32_bf16 a[200:203], a[80:83], v[40:43], a[200:203]
    ds_read_b128 a[56:59], v22 offset:55296
    v_mfma_f32_16x16x32_bf16 a[200:203], a[84:87], v[44:47], a[200:203]
    v_mfma_f32_16x16x32_bf16 a[204:207], a[88:91], v[40:43], a[204:207]
    v_mfma_f32_16x16x32_bf16 a[204:207], a[92:95], v[44:47], a[204:207]
    v_mfma_f32_16x16x32_bf16 a[208:211], a[96:99], v[40:43], a[208:211]
    ds_read_b128 a[60:63], v23 offset:55296
    v_mfma_f32_16x16x32_bf16 a[208:211], a[100:103], v[44:47], a[208:211]
    v_mfma_f32_16x16x32_bf16 a[212:215], a[104:107], v[40:43], a[212:215]
    buffer_load_dwordx4 v9, s[8:11], s61 offen offset:3072 lds
    v_mfma_f32_16x16x32_bf16 a[212:215], a[108:111], v[44:47], a[212:215]
    v_mfma_f32_16x16x32_bf16 a[216:219], a[112:115], v[40:43], a[216:219]
    v_mfma_f32_16x16x32_bf16 a[216:219], a[116:119], v[44:47], a[216:219]
    v_mfma_f32_16x16x32_bf16 a[220:223], a[120:123], v[40:43], a[220:223]
    v_mfma_f32_16x16x32_bf16 a[220:223], a[124:127], v[44:47], a[220:223]
    s_waitcnt lgkmcnt(0)
    v_mfma_f32_16x16x32_bf16 a[224:227], a[64:67], v[48:51], a[224:227]
    v_mfma_f32_16x16x32_bf16 a[224:227], a[68:71], v[52:55], a[224:227]
    s_xor_b32 s61, s61, 128
    v_mfma_f32_16x16x32_bf16 a[228:231], a[72:75], v[48:51], a[228:231]
    v_mfma_f32_16x16x32_bf16 a[228:231], a[76:79], v[52:55], a[228:231]
    v_mfma_f32_16x16x32_bf16 a[232:235], a[80:83], v[48:51], a[232:235]
    v_mfma_f32_16x16x32_bf16 a[232:235], a[84:87], v[52:55], a[232:235]
    s_waitcnt vmcnt(9) lgkmcnt(0)
    s_barrier
    ds_read_b64_tr_b16 v[56:57], v14 offset:0
    v_mfma_f32_16x16x32_bf16 a[236:239], a[88:91], v[48:51], a[236:239]
    s_add_u32 m0, s69, 65536
    ds_read_b64_tr_b16 v[58:59], v14 offset:1024
    ds_read_b64_tr_b16 v[60:61], v14 offset:8192
    v_mfma_f32_16x16x32_bf16 a[236:239], a[92:95], v[52:55], a[236:239]
    buffer_load_dwordx4 v2, s[16:19], s60 offen nt lds
    v_mfma_f32_16x16x32_bf16 a[240:243], a[96:99], v[48:51], a[240:243]
    ds_read_b64_tr_b16 v[62:63], v14 offset:9216
    ds_read_b64_tr_b16 v[40:41], v15 offset:0
    v_mfma_f32_16x16x32_bf16 a[240:243], a[100:103], v[52:55], a[240:243]
    buffer_atomic_add v31, v30, s[44:47], s95 offen sc1
    v_mfma_f32_16x16x32_bf16 a[244:247], a[104:107], v[48:51], a[244:247]
    s_mov_b32 s95, 32768
    ds_read_b64_tr_b16 v[42:43], v15 offset:1024
    ds_read_b64_tr_b16 v[44:45], v15 offset:8192
    v_mfma_f32_16x16x32_bf16 a[244:247], a[108:111], v[52:55], a[244:247]
    ds_read_b64_tr_b16 v[46:47], v15 offset:9216
    v_add_u32 v14, 0xfffe0000, v14
    v_mfma_f32_16x16x32_bf16 a[248:251], a[112:115], v[48:51], a[248:251]
    v_add_u32 v15, 0xfffe0000, v15
    v_mfma_f32_16x16x32_bf16 a[248:251], a[116:119], v[52:55], a[248:251]
    buffer_load_dwordx4 v3, s[16:19], s60 offen offset:1024 nt lds
    v_mfma_f32_16x16x32_bf16 a[252:255], a[120:123], v[48:51], a[252:255]
    ds_read_b64_tr_b16 v[48:49], v16 offset:0
    ds_read_b64_tr_b16 v[50:51], v16 offset:1024
    v_mfma_f32_16x16x32_bf16 a[252:255], a[124:127], v[52:55], a[252:255]
    s_waitcnt lgkmcnt(3)
    ds_read_b64_tr_b16 v[52:53], v16 offset:8192
    ds_read_b64_tr_b16 v[54:55], v16 offset:9216
    v_mfma_f32_16x16x32_bf16 v[128:131], v[56:59], a[0:3], v[128:131]
    v_add_u32 v16, 0xfffe0000, v16
    v_mfma_f32_16x16x32_bf16 v[128:131], v[60:63], a[4:7], v[128:131]
    v_add_u32 v22, 0x10000, v22
    v_mfma_f32_16x16x32_bf16 v[132:135], v[56:59], a[8:11], v[132:135]
    ds_read_b128 a[64:67], v22 offset:16384
    v_mfma_f32_16x16x32_bf16 v[132:135], v[60:63], a[12:15], v[132:135]
    v_mfma_f32_16x16x32_bf16 v[136:139], v[56:59], a[16:19], v[136:139]
    v_mfma_f32_16x16x32_bf16 v[136:139], v[60:63], a[20:23], v[136:139]
    buffer_load_dwordx4 v4, s[16:19], s60 offen offset:2048 nt lds
    v_mfma_f32_16x16x32_bf16 v[140:143], v[56:59], a[24:27], v[140:143]
    v_add_u32 v23, 0x10000, v23
    v_mfma_f32_16x16x32_bf16 v[140:143], v[60:63], a[28:31], v[140:143]
    ds_read_b128 a[68:71], v23 offset:16384
    v_mfma_f32_16x16x32_bf16 v[144:147], v[56:59], a[32:35], v[144:147]
    v_mfma_f32_16x16x32_bf16 v[144:147], v[60:63], a[36:39], v[144:147]
    v_mfma_f32_16x16x32_bf16 v[148:151], v[56:59], a[40:43], v[148:151]
    v_mfma_f32_16x16x32_bf16 v[148:151], v[60:63], a[44:47], v[148:151]
    v_mfma_f32_16x16x32_bf16 v[152:155], v[56:59], a[48:51], v[152:155]
    buffer_load_dwordx4 v5, s[16:19], s60 offen offset:3072 nt lds
    v_mfma_f32_16x16x32_bf16 v[152:155], v[60:63], a[52:55], v[152:155]
    ds_read_b128 a[72:75], v22 offset:18432
    v_mfma_f32_16x16x32_bf16 v[156:159], v[56:59], a[56:59], v[156:159]
    ds_read_b64_tr_b16 v[56:57], v17 offset:0
    ds_read_b64_tr_b16 v[58:59], v17 offset:1024
    v_mfma_f32_16x16x32_bf16 v[156:159], v[60:63], a[60:63], v[156:159]
    ds_read_b64_tr_b16 v[60:61], v17 offset:8192
    ds_read_b64_tr_b16 v[62:63], v17 offset:9216
    v_mfma_f32_16x16x32_bf16 v[160:163], v[40:43], a[0:3], v[160:163]
    s_waitcnt lgkmcnt(5)
    v_add_u32 v17, 0xfffe0000, v17
    v_mfma_f32_16x16x32_bf16 v[160:163], v[44:47], a[4:7], v[160:163]
    v_mfma_f32_16x16x32_bf16 v[164:167], v[40:43], a[8:11], v[164:167]
    ds_read_b128 a[76:79], v23 offset:18432
    v_mfma_f32_16x16x32_bf16 v[164:167], v[44:47], a[12:15], v[164:167]
    s_add_u32 m0, s69, 81920
    v_mfma_f32_16x16x32_bf16 v[168:171], v[40:43], a[16:19], v[168:171]
    s_xor_b32 s60, s60, 1572864
    buffer_load_dwordx4 v6, s[8:11], s62 offen lds
    v_mfma_f32_16x16x32_bf16 v[168:171], v[44:47], a[20:23], v[168:171]
    v_mfma_f32_16x16x32_bf16 v[172:175], v[40:43], a[24:27], v[172:175]
    v_mfma_f32_16x16x32_bf16 v[172:175], v[44:47], a[28:31], v[172:175]
    v_mfma_f32_16x16x32_bf16 v[176:179], v[40:43], a[32:35], v[176:179]
    ds_read_b128 a[80:83], v22 offset:20480
    v_mfma_f32_16x16x32_bf16 v[176:179], v[44:47], a[36:39], v[176:179]
    v_mfma_f32_16x16x32_bf16 v[180:183], v[40:43], a[40:43], v[180:183]
    v_mfma_f32_16x16x32_bf16 v[180:183], v[44:47], a[44:47], v[180:183]
    buffer_load_dwordx4 v7, s[8:11], s62 offen offset:1024 lds
    v_mfma_f32_16x16x32_bf16 v[184:187], v[40:43], a[48:51], v[184:187]
    v_mfma_f32_16x16x32_bf16 v[184:187], v[44:47], a[52:55], v[184:187]
    ds_read_b128 a[84:87], v23 offset:20480
    v_mfma_f32_16x16x32_bf16 v[188:191], v[40:43], a[56:59], v[188:191]
    ds_read_b64_tr_b16 v[40:41], v14 offset:0
    ds_read_b64_tr_b16 v[42:43], v14 offset:1024
    v_mfma_f32_16x16x32_bf16 v[188:191], v[44:47], a[60:63], v[188:191]
    ds_read_b64_tr_b16 v[44:45], v14 offset:8192
    ds_read_b64_tr_b16 v[46:47], v14 offset:9216
    v_mfma_f32_16x16x32_bf16 v[192:195], v[48:51], a[0:3], v[192:195]
    v_mfma_f32_16x16x32_bf16 v[192:195], v[52:55], a[4:7], v[192:195]
    v_mfma_f32_16x16x32_bf16 v[196:199], v[48:51], a[8:11], v[196:199]
    v_mfma_f32_16x16x32_bf16 v[196:199], v[52:55], a[12:15], v[196:199]
    buffer_load_dwordx4 v8, s[8:11], s62 offen offset:2048 lds
    v_mfma_f32_16x16x32_bf16 v[200:203], v[48:51], a[16:19], v[200:203]
    ds_read_b128 a[88:91], v22 offset:22528
    v_mfma_f32_16x16x32_bf16 v[200:203], v[52:55], a[20:23], v[200:203]
    v_mfma_f32_16x16x32_bf16 v[204:207], v[48:51], a[24:27], v[204:207]
    v_mfma_f32_16x16x32_bf16 v[204:207], v[52:55], a[28:31], v[204:207]
    v_mfma_f32_16x16x32_bf16 v[208:211], v[48:51], a[32:35], v[208:211]
    ds_read_b128 a[92:95], v23 offset:22528
    v_mfma_f32_16x16x32_bf16 v[208:211], v[52:55], a[36:39], v[208:211]
    v_mfma_f32_16x16x32_bf16 v[212:215], v[48:51], a[40:43], v[212:215]
    buffer_load_dwordx4 v9, s[8:11], s62 offen offset:3072 lds
    v_mfma_f32_16x16x32_bf16 v[212:215], v[52:55], a[44:47], v[212:215]
    v_mfma_f32_16x16x32_bf16 v[216:219], v[48:51], a[48:51], v[216:219]
    v_mfma_f32_16x16x32_bf16 v[216:219], v[52:55], a[52:55], v[216:219]
    v_mfma_f32_16x16x32_bf16 v[220:223], v[48:51], a[56:59], v[220:223]
    s_waitcnt lgkmcnt(0)
    ds_read_b64_tr_b16 v[48:49], v15 offset:0
    ds_read_b64_tr_b16 v[50:51], v15 offset:1024
    v_mfma_f32_16x16x32_bf16 v[220:223], v[52:55], a[60:63], v[220:223]
    ds_read_b64_tr_b16 v[52:53], v15 offset:8192
    ds_read_b64_tr_b16 v[54:55], v15 offset:9216
    v_mfma_f32_16x16x32_bf16 v[224:227], v[56:59], a[0:3], v[224:227]
    v_mfma_f32_16x16x32_bf16 v[224:227], v[60:63], a[4:7], v[224:227]
    s_xor_b32 s62, s62, 128
    v_mfma_f32_16x16x32_bf16 v[228:231], v[56:59], a[8:11], v[228:231]
    buffer_load_dword v108, v103, s[24:27], s77 offen
    v_mfma_f32_16x16x32_bf16 v[228:231], v[60:63], a[12:15], v[228:231]
    s_add_u32 s77, s77, 4608
    v_mfma_f32_16x16x32_bf16 v[232:235], v[56:59], a[16:19], v[232:235]
    v_mfma_f32_16x16x32_bf16 v[232:235], v[60:63], a[20:23], v[232:235]
    s_add_u32 m0, s69, 98304
    v_mfma_f32_16x16x32_bf16 v[236:239], v[56:59], a[24:27], v[236:239]
    buffer_load_dwordx4 v2, s[12:15], s60 offen nt lds
    v_mfma_f32_16x16x32_bf16 v[236:239], v[60:63], a[28:31], v[236:239]
    v_mfma_f32_16x16x32_bf16 v[240:243], v[56:59], a[32:35], v[240:243]
    v_mfma_f32_16x16x32_bf16 v[240:243], v[60:63], a[36:39], v[240:243]
    v_mfma_f32_16x16x32_bf16 v[244:247], v[56:59], a[40:43], v[244:247]
    v_mfma_f32_16x16x32_bf16 v[244:247], v[60:63], a[44:47], v[244:247]
    v_mfma_f32_16x16x32_bf16 v[248:251], v[56:59], a[48:51], v[248:251]
    v_mfma_f32_16x16x32_bf16 v[248:251], v[60:63], a[52:55], v[248:251]
    buffer_load_dwordx4 v3, s[12:15], s60 offen offset:1024 nt lds
    v_mfma_f32_16x16x32_bf16 v[252:255], v[56:59], a[56:59], v[252:255]
    ds_read_b64_tr_b16 v[56:57], v16 offset:0
    ds_read_b64_tr_b16 v[58:59], v16 offset:1024
    v_mfma_f32_16x16x32_bf16 v[252:255], v[60:63], a[60:63], v[252:255]
    ds_read_b64_tr_b16 v[60:61], v16 offset:8192
    ds_read_b64_tr_b16 v[62:63], v16 offset:9216
    v_mfma_f32_16x16x32_bf16 a[128:131], a[0:3], v[40:43], a[128:131]
    v_mfma_f32_16x16x32_bf16 a[128:131], a[4:7], v[44:47], a[128:131]
    v_add_u32 v22, 0xfffe0000, v22
    v_mfma_f32_16x16x32_bf16 a[132:135], a[8:11], v[40:43], a[132:135]
    ds_read_b128 a[96:99], v22 offset:16384
    v_mfma_f32_16x16x32_bf16 a[132:135], a[12:15], v[44:47], a[132:135]
    v_mfma_f32_16x16x32_bf16 a[136:139], a[16:19], v[40:43], a[136:139]
    v_mfma_f32_16x16x32_bf16 a[136:139], a[20:23], v[44:47], a[136:139]
    buffer_load_dwordx4 v4, s[12:15], s60 offen offset:2048 nt lds
    v_mfma_f32_16x16x32_bf16 a[140:143], a[24:27], v[40:43], a[140:143]
    v_add_u32 v23, 0xfffe0000, v23
    v_mfma_f32_16x16x32_bf16 a[140:143], a[28:31], v[44:47], a[140:143]
    ds_read_b128 a[100:103], v23 offset:16384
    v_mfma_f32_16x16x32_bf16 a[144:147], a[32:35], v[40:43], a[144:147]
    v_mfma_f32_16x16x32_bf16 a[144:147], a[36:39], v[44:47], a[144:147]
    v_mfma_f32_16x16x32_bf16 a[148:151], a[40:43], v[40:43], a[148:151]
    v_mfma_f32_16x16x32_bf16 a[148:151], a[44:47], v[44:47], a[148:151]
    v_mfma_f32_16x16x32_bf16 a[152:155], a[48:51], v[40:43], a[152:155]
    buffer_load_dwordx4 v5, s[12:15], s60 offen offset:3072 nt lds
    v_mfma_f32_16x16x32_bf16 a[152:155], a[52:55], v[44:47], a[152:155]
    ds_read_b128 a[104:107], v22 offset:18432
    v_mfma_f32_16x16x32_bf16 a[156:159], a[56:59], v[40:43], a[156:159]
    ds_read_b64_tr_b16 v[40:41], v17 offset:0
    ds_read_b64_tr_b16 v[42:43], v17 offset:1024
    v_mfma_f32_16x16x32_bf16 a[156:159], a[60:63], v[44:47], a[156:159]
    s_waitcnt lgkmcnt(3)
    ds_read_b64_tr_b16 v[44:45], v17 offset:8192
    ds_read_b64_tr_b16 v[46:47], v17 offset:9216
    v_mfma_f32_16x16x32_bf16 a[160:163], a[0:3], v[48:51], a[160:163]
    v_mfma_f32_16x16x32_bf16 a[160:163], a[4:7], v[52:55], a[160:163]
    v_mfma_f32_16x16x32_bf16 a[164:167], a[8:11], v[48:51], a[164:167]
    ds_read_b128 a[108:111], v23 offset:18432
    v_mfma_f32_16x16x32_bf16 a[164:167], a[12:15], v[52:55], a[164:167]
    s_add_u32 m0, s69, 114688
    v_mfma_f32_16x16x32_bf16 a[168:171], a[16:19], v[48:51], a[168:171]
    s_xor_b32 s60, s60, 524288
    buffer_load_dwordx4 v6, s[8:11], s61 offen lds
    v_mfma_f32_16x16x32_bf16 a[168:171], a[20:23], v[52:55], a[168:171]
    v_mfma_f32_16x16x32_bf16 a[172:175], a[24:27], v[48:51], a[172:175]
    v_mfma_f32_16x16x32_bf16 a[172:175], a[28:31], v[52:55], a[172:175]
    v_mfma_f32_16x16x32_bf16 a[176:179], a[32:35], v[48:51], a[176:179]
    ds_read_b128 a[112:115], v22 offset:20480
    v_mfma_f32_16x16x32_bf16 a[176:179], a[36:39], v[52:55], a[176:179]
    v_mfma_f32_16x16x32_bf16 a[180:183], a[40:43], v[48:51], a[180:183]
    v_mfma_f32_16x16x32_bf16 a[180:183], a[44:47], v[52:55], a[180:183]
    buffer_load_dwordx4 v7, s[8:11], s61 offen offset:1024 lds
    v_mfma_f32_16x16x32_bf16 a[184:187], a[48:51], v[48:51], a[184:187]
    v_mfma_f32_16x16x32_bf16 a[184:187], a[52:55], v[52:55], a[184:187]
    ds_read_b128 a[116:119], v23 offset:20480
    v_mfma_f32_16x16x32_bf16 a[188:191], a[56:59], v[48:51], a[188:191]
    v_mfma_f32_16x16x32_bf16 a[188:191], a[60:63], v[52:55], a[188:191]
    v_mfma_f32_16x16x32_bf16 a[192:195], a[0:3], v[56:59], a[192:195]
    v_mfma_f32_16x16x32_bf16 a[192:195], a[4:7], v[60:63], a[192:195]
    v_mfma_f32_16x16x32_bf16 a[196:199], a[8:11], v[56:59], a[196:199]
    v_mfma_f32_16x16x32_bf16 a[196:199], a[12:15], v[60:63], a[196:199]
    buffer_load_dwordx4 v8, s[8:11], s61 offen offset:2048 lds
    v_mfma_f32_16x16x32_bf16 a[200:203], a[16:19], v[56:59], a[200:203]
    ds_read_b128 a[120:123], v22 offset:22528
    v_mfma_f32_16x16x32_bf16 a[200:203], a[20:23], v[60:63], a[200:203]
    v_mfma_f32_16x16x32_bf16 a[204:207], a[24:27], v[56:59], a[204:207]
    v_mfma_f32_16x16x32_bf16 a[204:207], a[28:31], v[60:63], a[204:207]
    v_mfma_f32_16x16x32_bf16 a[208:211], a[32:35], v[56:59], a[208:211]
    ds_read_b128 a[124:127], v23 offset:22528
    v_mfma_f32_16x16x32_bf16 a[208:211], a[36:39], v[60:63], a[208:211]
    v_mfma_f32_16x16x32_bf16 a[212:215], a[40:43], v[56:59], a[212:215]
    buffer_load_dwordx4 v9, s[8:11], s61 offen offset:3072 lds
    v_mfma_f32_16x16x32_bf16 a[212:215], a[44:47], v[60:63], a[212:215]
    v_mfma_f32_16x16x32_bf16 a[216:219], a[48:51], v[56:59], a[216:219]
    v_mfma_f32_16x16x32_bf16 a[216:219], a[52:55], v[60:63], a[216:219]
    v_mfma_f32_16x16x32_bf16 a[220:223], a[56:59], v[56:59], a[220:223]
    v_mfma_f32_16x16x32_bf16 a[220:223], a[60:63], v[60:63], a[220:223]
    s_waitcnt lgkmcnt(0)
    v_mfma_f32_16x16x32_bf16 a[224:227], a[0:3], v[40:43], a[224:227]
    v_mfma_f32_16x16x32_bf16 a[224:227], a[4:7], v[44:47], a[224:227]
    s_xor_b32 s61, s61, 1920
    v_mfma_f32_16x16x32_bf16 a[228:231], a[8:11], v[40:43], a[228:231]
    s_andn2_b32 s61, s61, 896
    v_mfma_f32_16x16x32_bf16 a[228:231], a[12:15], v[44:47], a[228:231]
    s_lshl_b32 s61, s5, 7
    v_mfma_f32_16x16x32_bf16 a[232:235], a[16:19], v[40:43], a[232:235]
    v_mfma_f32_16x16x32_bf16 a[232:235], a[20:23], v[44:47], a[232:235]
    s_waitcnt vmcnt(9) lgkmcnt(0)
    s_barrier
    ds_read_b64_tr_b16 v[48:49], v14 offset:32768
    v_mfma_f32_16x16x32_bf16 a[236:239], a[24:27], v[40:43], a[236:239]
    s_add_u32 m0, s69, 131072
    ds_read_b64_tr_b16 v[50:51], v14 offset:33792
    ds_read_b64_tr_b16 v[52:53], v14 offset:40960
    v_mfma_f32_16x16x32_bf16 a[236:239], a[28:31], v[44:47], a[236:239]
    buffer_load_dwordx4 v2, s[12:15], s60 offen nt lds
    v_mfma_f32_16x16x32_bf16 a[240:243], a[32:35], v[40:43], a[240:243]
    ds_read_b64_tr_b16 v[54:55], v14 offset:41984
    ds_read_b64_tr_b16 v[56:57], v15 offset:32768
    v_mfma_f32_16x16x32_bf16 a[240:243], a[36:39], v[44:47], a[240:243]
    ds_read_b64_tr_b16 v[58:59], v15 offset:33792
    ds_read_b64_tr_b16 v[60:61], v15 offset:40960
    v_mfma_f32_16x16x32_bf16 a[244:247], a[40:43], v[40:43], a[244:247]
    ds_read_b64_tr_b16 v[62:63], v15 offset:41984
    v_add_u32 v14, 0x10000, v14
    v_mfma_f32_16x16x32_bf16 a[244:247], a[44:47], v[44:47], a[244:247]
    v_add_u32 v15, 0x10000, v15
    v_mfma_f32_16x16x32_bf16 a[248:251], a[48:51], v[40:43], a[248:251]
    v_mfma_f32_16x16x32_bf16 a[248:251], a[52:55], v[44:47], a[248:251]
    buffer_load_dwordx4 v3, s[12:15], s60 offen offset:1024 nt lds
    v_mfma_f32_16x16x32_bf16 a[252:255], a[56:59], v[40:43], a[252:255]
    ds_read_b64_tr_b16 v[40:41], v16 offset:32768
    ds_read_b64_tr_b16 v[42:43], v16 offset:33792
    v_mfma_f32_16x16x32_bf16 a[252:255], a[60:63], v[44:47], a[252:255]
    s_waitcnt lgkmcnt(2)
    ds_read_b64_tr_b16 v[44:45], v16 offset:40960
    ds_read_b64_tr_b16 v[46:47], v16 offset:41984
    v_mfma_f32_16x16x32_bf16 v[128:131], v[48:51], a[64:67], v[128:131]
    v_add_u32 v16, 0x10000, v16
    v_mfma_f32_16x16x32_bf16 v[128:131], v[52:55], a[68:71], v[128:131]
    v_mfma_f32_16x16x32_bf16 v[132:135], v[48:51], a[72:75], v[132:135]
    ds_read_b128 a[0:3], v22 offset:49152
    v_mfma_f32_16x16x32_bf16 v[132:135], v[52:55], a[76:79], v[132:135]
    v_mfma_f32_16x16x32_bf16 v[136:139], v[48:51], a[80:83], v[136:139]
    v_mfma_f32_16x16x32_bf16 v[136:139], v[52:55], a[84:87], v[136:139]
    buffer_load_dwordx4 v4, s[12:15], s60 offen offset:2048 nt lds
    v_mfma_f32_16x16x32_bf16 v[140:143], v[48:51], a[88:91], v[140:143]
    v_mfma_f32_16x16x32_bf16 v[140:143], v[52:55], a[92:95], v[140:143]
    ds_read_b128 a[4:7], v23 offset:49152
    v_mfma_f32_16x16x32_bf16 v[144:147], v[48:51], a[96:99], v[144:147]
    v_mfma_f32_16x16x32_bf16 v[144:147], v[52:55], a[100:103], v[144:147]
    v_mfma_f32_16x16x32_bf16 v[148:151], v[48:51], a[104:107], v[148:151]
    v_mfma_f32_16x16x32_bf16 v[148:151], v[52:55], a[108:111], v[148:151]
    v_mfma_f32_16x16x32_bf16 v[152:155], v[48:51], a[112:115], v[152:155]
    buffer_load_dwordx4 v5, s[12:15], s60 offen offset:3072 nt lds
    v_mfma_f32_16x16x32_bf16 v[152:155], v[52:55], a[116:119], v[152:155]
    ds_read_b128 a[8:11], v22 offset:51200
    v_mfma_f32_16x16x32_bf16 v[156:159], v[48:51], a[120:123], v[156:159]
    ds_read_b64_tr_b16 v[48:49], v17 offset:32768
    ds_read_b64_tr_b16 v[50:51], v17 offset:33792
    v_mfma_f32_16x16x32_bf16 v[156:159], v[52:55], a[124:127], v[156:159]
    ds_read_b64_tr_b16 v[52:53], v17 offset:40960
    ds_read_b64_tr_b16 v[54:55], v17 offset:41984
    v_mfma_f32_16x16x32_bf16 v[160:163], v[56:59], a[64:67], v[160:163]
    v_add_u32 v17, 0x10000, v17
    v_mfma_f32_16x16x32_bf16 v[160:163], v[60:63], a[68:71], v[160:163]
    s_cmp_lt_u32 s4, 0
    s_cselect_b32 s12, 0xf149f2ca, 0
    v_mfma_f32_16x16x32_bf16 v[164:167], v[56:59], a[72:75], v[164:167]
    ds_read_b128 a[12:15], v23 offset:51200
    v_mfma_f32_16x16x32_bf16 v[164:167], v[60:63], a[76:79], v[164:167]
    s_add_u32 m0, s69, 147456
    v_mfma_f32_16x16x32_bf16 v[168:171], v[56:59], a[80:83], v[168:171]
    s_xor_b32 s60, s60, 524288
    buffer_load_dwordx4 v6, s[8:11], s62 offen lds
    v_mfma_f32_16x16x32_bf16 v[168:171], v[60:63], a[84:87], v[168:171]
    v_mov_b32 v6, v96
    v_mfma_f32_16x16x32_bf16 v[172:175], v[56:59], a[88:91], v[172:175]
    s_cmp_lt_u32 s4, 1
    s_cselect_b32 s13, 0xf149f2ca, 0
    v_mfma_f32_16x16x32_bf16 v[172:175], v[60:63], a[92:95], v[172:175]
    s_cmp_lt_u32 s4, 2
    s_cselect_b32 s14, 0xf149f2ca, 0
    v_mfma_f32_16x16x32_bf16 v[176:179], v[56:59], a[96:99], v[176:179]
    ds_read_b128 a[16:19], v22 offset:53248
    v_mfma_f32_16x16x32_bf16 v[176:179], v[60:63], a[100:103], v[176:179]
    s_cmp_lt_u32 s4, 3
    s_cselect_b32 s15, 0xf149f2ca, 0
    v_mfma_f32_16x16x32_bf16 v[180:183], v[56:59], a[104:107], v[180:183]
    v_mfma_f32_16x16x32_bf16 v[180:183], v[60:63], a[108:111], v[180:183]
    buffer_load_dwordx4 v7, s[8:11], s62 offen offset:1024 lds
    v_mfma_f32_16x16x32_bf16 v[184:187], v[56:59], a[112:115], v[184:187]
    v_mfma_f32_16x16x32_bf16 v[184:187], v[60:63], a[116:119], v[184:187]
    ds_read_b128 a[20:23], v23 offset:53248
    v_mfma_f32_16x16x32_bf16 v[188:191], v[56:59], a[120:123], v[188:191]
    s_waitcnt lgkmcnt(1)
    ds_read_b64_tr_b16 v[56:57], v14 offset:0
    ds_read_b64_tr_b16 v[58:59], v14 offset:1024
    v_mfma_f32_16x16x32_bf16 v[188:191], v[60:63], a[124:127], v[188:191]
    ds_read_b64_tr_b16 v[60:61], v14 offset:8192
    ds_read_b64_tr_b16 v[62:63], v14 offset:9216
    v_mfma_f32_16x16x32_bf16 v[192:195], v[40:43], a[64:67], v[192:195]
    v_mfma_f32_16x16x32_bf16 v[192:195], v[44:47], a[68:71], v[192:195]
    v_mfma_f32_16x16x32_bf16 v[196:199], v[40:43], a[72:75], v[196:199]
    v_mfma_f32_16x16x32_bf16 v[196:199], v[44:47], a[76:79], v[196:199]
    buffer_load_dwordx4 v8, s[8:11], s62 offen offset:2048 lds
    v_mfma_f32_16x16x32_bf16 v[200:203], v[40:43], a[80:83], v[200:203]
    ds_read_b128 a[24:27], v22 offset:55296
    v_bfe_u32 v8, v1, 4, 3
    v_mfma_f32_16x16x32_bf16 v[200:203], v[44:47], a[84:87], v[200:203]
    v_lshlrev_b32 v8, 12, v8
    v_mfma_f32_16x16x32_bf16 v[204:207], v[40:43], a[88:91], v[204:207]
    v_mfma_f32_16x16x32_bf16 v[204:207], v[44:47], a[92:95], v[204:207]
    v_mfma_f32_16x16x32_bf16 v[208:211], v[40:43], a[96:99], v[208:211]
    ds_read_b128 a[28:31], v23 offset:55296
    v_mfma_f32_16x16x32_bf16 v[208:211], v[44:47], a[100:103], v[208:211]
    v_mfma_f32_16x16x32_bf16 v[212:215], v[40:43], a[104:107], v[212:215]
    buffer_load_dwordx4 v9, s[8:11], s62 offen offset:3072 lds
    v_mfma_f32_16x16x32_bf16 v[212:215], v[44:47], a[108:111], v[212:215]
    s_and_b32 s8, s5, 7
    v_lshrrev_b32 v9, 2, v1
    v_mfma_f32_16x16x32_bf16 v[216:219], v[40:43], a[112:115], v[216:219]
    s_lshl3_add_u32 s8, s6, s8
    v_mfma_f32_16x16x32_bf16 v[216:219], v[44:47], a[116:119], v[216:219]
    s_mul_hi_u32 s98, s8, 715827883
    v_mfma_f32_16x16x32_bf16 v[220:223], v[40:43], a[120:123], v[220:223]
    s_and_b32 s9, s5, 24
    ds_read_b64_tr_b16 v[40:41], v15 offset:0
    ds_read_b64_tr_b16 v[42:43], v15 offset:1024
    v_mfma_f32_16x16x32_bf16 v[220:223], v[44:47], a[124:127], v[220:223]
    s_mul_i32 s10, s9, 18
    ds_read_b64_tr_b16 v[44:45], v15 offset:8192
    ds_read_b64_tr_b16 v[46:47], v15 offset:9216
    v_mfma_f32_16x16x32_bf16 v[224:227], v[48:51], a[64:67], v[224:227]
    s_add_u32 s10, s10, 16
    v_mfma_f32_16x16x32_bf16 v[224:227], v[52:55], a[68:71], v[224:227]
    s_xor_b32 s62, s62, 1920
    v_mfma_f32_16x16x32_bf16 v[228:231], v[48:51], a[72:75], v[228:231]
    s_andn2_b32 s62, s62, 896
    buffer_load_dword v109, v103, s[24:27], s77 offen
    v_mfma_f32_16x16x32_bf16 v[228:231], v[52:55], a[76:79], v[228:231]
    s_cmp_eq_u32 s4, 3
    s_cselect_b32 s11, 1.0, 0
    v_mfma_f32_16x16x32_bf16 v[232:235], v[48:51], a[80:83], v[232:235]
    v_mfma_f32_16x16x32_bf16 v[232:235], v[52:55], a[84:87], v[232:235]
    s_add_u32 m0, s69, 0
    v_mfma_f32_16x16x32_bf16 v[236:239], v[48:51], a[88:91], v[236:239]
    buffer_load_dwordx4 v2, s[16:19], s60 offen nt lds
    v_mfma_f32_16x16x32_bf16 v[236:239], v[52:55], a[92:95], v[236:239]
    v_mfma_f32_16x16x32_bf16 v[240:243], v[48:51], a[96:99], v[240:243]
    v_mfma_f32_16x16x32_bf16 v[240:243], v[52:55], a[100:103], v[240:243]
    v_mfma_f32_16x16x32_bf16 v[244:247], v[48:51], a[104:107], v[244:247]
    v_mfma_f32_16x16x32_bf16 v[244:247], v[52:55], a[108:111], v[244:247]
    v_mfma_f32_16x16x32_bf16 v[248:251], v[48:51], a[112:115], v[248:251]
    v_mfma_f32_16x16x32_bf16 v[248:251], v[52:55], a[116:119], v[248:251]
    buffer_load_dwordx4 v3, s[16:19], s60 offen offset:1024 nt lds
    v_mfma_f32_16x16x32_bf16 v[252:255], v[48:51], a[120:123], v[252:255]
    ds_read_b64_tr_b16 v[48:49], v16 offset:0
    ds_read_b64_tr_b16 v[50:51], v16 offset:1024
    v_mfma_f32_16x16x32_bf16 v[252:255], v[52:55], a[124:127], v[252:255]
    s_waitcnt lgkmcnt(2)
    ds_read_b64_tr_b16 v[52:53], v16 offset:8192
    ds_read_b64_tr_b16 v[54:55], v16 offset:9216
    v_mfma_f32_16x16x32_bf16 a[128:131], a[64:67], v[56:59], a[128:131]
    v_mfma_f32_16x16x32_bf16 a[128:131], a[68:71], v[60:63], a[128:131]
    v_add_u32 v22, 0x10000, v22
    v_mfma_f32_16x16x32_bf16 a[132:135], a[72:75], v[56:59], a[132:135]
    ds_read_b128 a[32:35], v22 offset:16384
    v_mfma_f32_16x16x32_bf16 a[132:135], a[76:79], v[60:63], a[132:135]
    v_mfma_f32_16x16x32_bf16 a[136:139], a[80:83], v[56:59], a[136:139]
    v_mfma_f32_16x16x32_bf16 a[136:139], a[84:87], v[60:63], a[136:139]
    buffer_load_dwordx4 v4, s[16:19], s60 offen offset:2048 nt lds
    v_mfma_f32_16x16x32_bf16 a[140:143], a[88:91], v[56:59], a[140:143]
    v_add_u32 v23, 0x10000, v23
    v_mfma_f32_16x16x32_bf16 a[140:143], a[92:95], v[60:63], a[140:143]
    ds_read_b128 a[36:39], v23 offset:16384
    v_mfma_f32_16x16x32_bf16 a[144:147], a[96:99], v[56:59], a[144:147]
    v_mfma_f32_16x16x32_bf16 a[144:147], a[100:103], v[60:63], a[144:147]
    v_mfma_f32_16x16x32_bf16 a[148:151], a[104:107], v[56:59], a[148:151]
    v_mfma_f32_16x16x32_bf16 a[148:151], a[108:111], v[60:63], a[148:151]
    v_mfma_f32_16x16x32_bf16 a[152:155], a[112:115], v[56:59], a[152:155]
    buffer_load_dwordx4 v5, s[16:19], s60 offen offset:3072 nt lds
    v_mfma_f32_16x16x32_bf16 a[152:155], a[116:119], v[60:63], a[152:155]
    ds_read_b128 a[40:43], v22 offset:18432
    v_mfma_f32_16x16x32_bf16 a[156:159], a[120:123], v[56:59], a[156:159]
    ds_read_b64_tr_b16 v[56:57], v17 offset:0
    ds_read_b64_tr_b16 v[58:59], v17 offset:1024
    v_mfma_f32_16x16x32_bf16 a[156:159], a[124:127], v[60:63], a[156:159]
    ds_read_b64_tr_b16 v[60:61], v17 offset:8192
    ds_read_b64_tr_b16 v[62:63], v17 offset:9216
    v_mfma_f32_16x16x32_bf16 a[160:163], a[64:67], v[40:43], a[160:163]
    v_mfma_f32_16x16x32_bf16 a[160:163], a[68:71], v[44:47], a[160:163]
    v_mfma_f32_16x16x32_bf16 a[164:167], a[72:75], v[40:43], a[164:167]
    ds_read_b128 a[44:47], v23 offset:18432
    v_mfma_f32_16x16x32_bf16 a[164:167], a[76:79], v[44:47], a[164:167]
    s_add_u32 m0, s69, 16384
    v_mfma_f32_16x16x32_bf16 a[168:171], a[80:83], v[40:43], a[168:171]
    s_xor_b32 s60, s60, 524288
    buffer_load_dwordx4 v10, s[20:23], s63 offen lds
    v_mfma_f32_16x16x32_bf16 a[168:171], a[84:87], v[44:47], a[168:171]
    v_mfma_f32_16x16x32_bf16 a[172:175], a[88:91], v[40:43], a[172:175]
    v_mfma_f32_16x16x32_bf16 a[172:175], a[92:95], v[44:47], a[172:175]
    v_mfma_f32_16x16x32_bf16 a[176:179], a[96:99], v[40:43], a[176:179]
    ds_read_b128 a[48:51], v22 offset:20480
    v_mfma_f32_16x16x32_bf16 a[176:179], a[100:103], v[44:47], a[176:179]
    v_mfma_f32_16x16x32_bf16 a[180:183], a[104:107], v[40:43], a[180:183]
    v_mfma_f32_16x16x32_bf16 a[180:183], a[108:111], v[44:47], a[180:183]
    buffer_load_dwordx4 v11, s[20:23], s63 offen offset:1024 lds
    v_mfma_f32_16x16x32_bf16 a[184:187], a[112:115], v[40:43], a[184:187]
    v_mfma_f32_16x16x32_bf16 a[184:187], a[116:119], v[44:47], a[184:187]
    ds_read_b128 a[52:55], v23 offset:20480
    v_mfma_f32_16x16x32_bf16 a[188:191], a[120:123], v[40:43], a[188:191]
    v_mfma_f32_16x16x32_bf16 a[188:191], a[124:127], v[44:47], a[188:191]
    s_waitcnt lgkmcnt(1)
    v_mfma_f32_16x16x32_bf16 a[192:195], a[64:67], v[48:51], a[192:195]
    v_mfma_f32_16x16x32_bf16 a[192:195], a[68:71], v[52:55], a[192:195]
    v_mfma_f32_16x16x32_bf16 a[196:199], a[72:75], v[48:51], a[196:199]
    v_mfma_f32_16x16x32_bf16 a[196:199], a[76:79], v[52:55], a[196:199]
    buffer_load_dwordx4 v12, s[20:23], s63 offen offset:2048 lds
    v_mfma_f32_16x16x32_bf16 a[200:203], a[80:83], v[48:51], a[200:203]
    ds_read_b128 a[56:59], v22 offset:22528
    v_mfma_f32_16x16x32_bf16 a[200:203], a[84:87], v[52:55], a[200:203]
    v_mfma_f32_16x16x32_bf16 a[204:207], a[88:91], v[48:51], a[204:207]
    v_mfma_f32_16x16x32_bf16 a[204:207], a[92:95], v[52:55], a[204:207]
    v_mfma_f32_16x16x32_bf16 a[208:211], a[96:99], v[48:51], a[208:211]
    ds_read_b128 a[60:63], v23 offset:22528
    v_mfma_f32_16x16x32_bf16 a[208:211], a[100:103], v[52:55], a[208:211]
    v_mfma_f32_16x16x32_bf16 a[212:215], a[104:107], v[48:51], a[212:215]
    buffer_load_dwordx4 v13, s[20:23], s63 offen offset:3072 lds
    v_mfma_f32_16x16x32_bf16 a[212:215], a[108:111], v[52:55], a[212:215]
    v_mfma_f32_16x16x32_bf16 a[216:219], a[112:115], v[48:51], a[216:219]
    v_mfma_f32_16x16x32_bf16 a[216:219], a[116:119], v[52:55], a[216:219]
    v_mfma_f32_16x16x32_bf16 a[220:223], a[120:123], v[48:51], a[220:223]
    v_mfma_f32_16x16x32_bf16 a[220:223], a[124:127], v[52:55], a[220:223]
    v_mfma_f32_16x16x32_bf16 a[224:227], a[64:67], v[56:59], a[224:227]
    v_mfma_f32_16x16x32_bf16 a[224:227], a[68:71], v[60:63], a[224:227]
    s_xor_b32 s63, s63, 128
    v_mfma_f32_16x16x32_bf16 a[228:231], a[72:75], v[56:59], a[228:231]
    v_mfma_f32_16x16x32_bf16 a[228:231], a[76:79], v[60:63], a[228:231]
    v_mfma_f32_16x16x32_bf16 a[232:235], a[80:83], v[56:59], a[232:235]
    v_mfma_f32_16x16x32_bf16 a[232:235], a[84:87], v[60:63], a[232:235]
    s_waitcnt vmcnt(9) lgkmcnt(0)
    s_barrier
    ds_read_b64_tr_b16 v[40:41], v14 offset:32768
    v_mfma_f32_16x16x32_bf16 a[236:239], a[88:91], v[56:59], a[236:239]
    s_add_u32 m0, s69, 32768
    ds_read_b64_tr_b16 v[42:43], v14 offset:33792
    ds_read_b64_tr_b16 v[44:45], v14 offset:40960
    v_mfma_f32_16x16x32_bf16 a[236:239], a[92:95], v[60:63], a[236:239]
    buffer_load_dwordx4 v2, s[16:19], s60 offen nt lds
    v_mfma_f32_16x16x32_bf16 a[240:243], a[96:99], v[56:59], a[240:243]
    ds_read_b64_tr_b16 v[46:47], v14 offset:41984
    ds_read_b64_tr_b16 v[48:49], v15 offset:32768
    v_mfma_f32_16x16x32_bf16 a[240:243], a[100:103], v[60:63], a[240:243]
    ds_read_b64_tr_b16 v[50:51], v15 offset:33792
    ds_read_b64_tr_b16 v[52:53], v15 offset:40960
    v_mfma_f32_16x16x32_bf16 a[244:247], a[104:107], v[56:59], a[244:247]
    ds_read_b64_tr_b16 v[54:55], v15 offset:41984
    v_add_u32 v14, 0x10000, v14
    v_mfma_f32_16x16x32_bf16 a[244:247], a[108:111], v[60:63], a[244:247]
    v_add_u32 v15, 0x10000, v15
    v_mfma_f32_16x16x32_bf16 a[248:251], a[112:115], v[56:59], a[248:251]
    v_mfma_f32_16x16x32_bf16 a[248:251], a[116:119], v[60:63], a[248:251]
    buffer_load_dwordx4 v3, s[16:19], s60 offen offset:1024 nt lds
    v_mfma_f32_16x16x32_bf16 a[252:255], a[120:123], v[56:59], a[252:255]
    ds_read_b64_tr_b16 v[56:57], v16 offset:32768
    ds_read_b64_tr_b16 v[58:59], v16 offset:33792
    v_mfma_f32_16x16x32_bf16 a[252:255], a[124:127], v[60:63], a[252:255]
    s_waitcnt lgkmcnt(2)
    ds_read_b64_tr_b16 v[60:61], v16 offset:40960
    ds_read_b64_tr_b16 v[62:63], v16 offset:41984
    v_mfma_f32_16x16x32_bf16 v[128:131], v[40:43], a[0:3], v[128:131]
    v_add_u32 v16, 0x10000, v16
    v_mfma_f32_16x16x32_bf16 v[128:131], v[44:47], a[4:7], v[128:131]
    ds_read_b128 a[64:67], v22 offset:49152
    v_mfma_f32_16x16x32_bf16 v[132:135], v[40:43], a[8:11], v[132:135]
    v_mfma_f32_16x16x32_bf16 v[132:135], v[44:47], a[12:15], v[132:135]
    v_mfma_f32_16x16x32_bf16 v[136:139], v[40:43], a[16:19], v[136:139]
    ds_read_b128 a[68:71], v23 offset:49152
    v_mfma_f32_16x16x32_bf16 v[136:139], v[44:47], a[20:23], v[136:139]
    buffer_load_dwordx4 v4, s[16:19], s60 offen offset:2048 nt lds
    v_mfma_f32_16x16x32_bf16 v[140:143], v[40:43], a[24:27], v[140:143]
    v_mfma_f32_16x16x32_bf16 v[140:143], v[44:47], a[28:31], v[140:143]
    ds_read_b128 a[72:75], v22 offset:51200
    v_mfma_f32_16x16x32_bf16 v[144:147], v[40:43], a[32:35], v[144:147]
    v_mfma_f32_16x16x32_bf16 v[144:147], v[44:47], a[36:39], v[144:147]
    v_mfma_f32_16x16x32_bf16 v[148:151], v[40:43], a[40:43], v[148:151]
    ds_read_b128 a[76:79], v23 offset:51200
    v_mfma_f32_16x16x32_bf16 v[148:151], v[44:47], a[44:47], v[148:151]
    v_mfma_f32_16x16x32_bf16 v[152:155], v[40:43], a[48:51], v[152:155]
    buffer_load_dwordx4 v5, s[16:19], s60 offen offset:3072 nt lds
    v_mfma_f32_16x16x32_bf16 v[152:155], v[44:47], a[52:55], v[152:155]
    v_mfma_f32_16x16x32_bf16 v[156:159], v[40:43], a[56:59], v[156:159]
    ds_read_b128 a[80:83], v22 offset:53248
    ds_read_b64_tr_b16 v[40:41], v17 offset:32768
    v_mfma_f32_16x16x32_bf16 v[156:159], v[44:47], a[60:63], v[156:159]
    ds_read_b64_tr_b16 v[42:43], v17 offset:33792
    ds_read_b64_tr_b16 v[44:45], v17 offset:40960
    v_mfma_f32_16x16x32_bf16 v[160:163], v[48:51], a[0:3], v[160:163]
    ds_read_b64_tr_b16 v[46:47], v17 offset:41984
    v_add_u32 v17, 0x10000, v17
    v_mfma_f32_16x16x32_bf16 v[160:163], v[52:55], a[4:7], v[160:163]
    ds_read_b128 a[84:87], v23 offset:53248
    v_mfma_f32_16x16x32_bf16 v[164:167], v[48:51], a[8:11], v[164:167]
    v_mfma_f32_16x16x32_bf16 v[164:167], v[52:55], a[12:15], v[164:167]
    s_add_u32 m0, s69, 49152
    buffer_load_dword v7, v9, s[44:47], s69 offen sc1
    v_mfma_f32_16x16x32_bf16 v[168:171], v[48:51], a[16:19], v[168:171]
    s_xor_b32 s60, s60, 3670016
    buffer_load_dwordx4 v10, s[20:23], s64 offen lds
    v_mfma_f32_16x16x32_bf16 v[168:171], v[52:55], a[20:23], v[168:171]
    ds_read_b128 a[88:91], v22 offset:55296
    v_mfma_f32_16x16x32_bf16 v[172:175], v[48:51], a[24:27], v[172:175]
    v_mfma_f32_16x16x32_bf16 v[172:175], v[52:55], a[28:31], v[172:175]
    s_waitcnt lgkmcnt(1)
    ds_read_b128 a[92:95], v23 offset:55296
    v_mfma_f32_16x16x32_bf16 v[176:179], v[48:51], a[32:35], v[176:179]
    v_mfma_f32_16x16x32_bf16 v[176:179], v[52:55], a[36:39], v[176:179]
    v_mfma_f32_16x16x32_bf16 v[180:183], v[48:51], a[40:43], v[180:183]
    v_mfma_f32_16x16x32_bf16 v[180:183], v[52:55], a[44:47], v[180:183]
    buffer_load_dwordx4 v11, s[20:23], s64 offen offset:1024 lds
    v_mfma_f32_16x16x32_bf16 v[184:187], v[48:51], a[48:51], v[184:187]
    v_add_u32 v22, 0x10000, v22
    ds_read_b128 a[96:99], v22 offset:16384
    v_mfma_f32_16x16x32_bf16 v[184:187], v[52:55], a[52:55], v[184:187]
    v_mfma_f32_16x16x32_bf16 v[188:191], v[48:51], a[56:59], v[188:191]
    v_add_u32 v23, 0x10000, v23
    ds_read_b64_tr_b16 v[48:49], v14 offset:0
    v_mfma_f32_16x16x32_bf16 v[188:191], v[52:55], a[60:63], v[188:191]
    ds_read_b128 a[100:103], v23 offset:16384
    ds_read_b64_tr_b16 v[50:51], v14 offset:1024
    v_mfma_f32_16x16x32_bf16 v[192:195], v[56:59], a[0:3], v[192:195]
    ds_read_b64_tr_b16 v[52:53], v14 offset:8192
    ds_read_b64_tr_b16 v[54:55], v14 offset:9216
    v_mfma_f32_16x16x32_bf16 v[192:195], v[60:63], a[4:7], v[192:195]
    v_add_u32 v14, 0xfffe0000, v14
    v_mfma_f32_16x16x32_bf16 v[196:199], v[56:59], a[8:11], v[196:199]
    ds_read_b128 a[104:107], v22 offset:18432
    v_mfma_f32_16x16x32_bf16 v[196:199], v[60:63], a[12:15], v[196:199]
    buffer_load_dwordx4 v12, s[20:23], s64 offen offset:2048 lds
    v_mfma_f32_16x16x32_bf16 v[200:203], v[56:59], a[16:19], v[200:203]
    v_mfma_f32_16x16x32_bf16 v[200:203], v[60:63], a[20:23], v[200:203]
    ds_read_b128 a[108:111], v23 offset:18432
    v_mfma_f32_16x16x32_bf16 v[204:207], v[56:59], a[24:27], v[204:207]
    v_mfma_f32_16x16x32_bf16 v[204:207], v[60:63], a[28:31], v[204:207]
    v_mfma_f32_16x16x32_bf16 v[208:211], v[56:59], a[32:35], v[208:211]
    v_mfma_f32_16x16x32_bf16 v[208:211], v[60:63], a[36:39], v[208:211]
    ds_read_b128 a[112:115], v22 offset:20480
    v_mfma_f32_16x16x32_bf16 v[212:215], v[56:59], a[40:43], v[212:215]
    buffer_load_dwordx4 v13, s[20:23], s64 offen offset:3072 lds
    v_mfma_f32_16x16x32_bf16 v[212:215], v[60:63], a[44:47], v[212:215]
    v_mfma_f32_16x16x32_bf16 v[216:219], v[56:59], a[48:51], v[216:219]
    ds_read_b128 a[116:119], v23 offset:20480
    v_mfma_f32_16x16x32_bf16 v[216:219], v[60:63], a[52:55], v[216:219]
    v_mfma_f32_16x16x32_bf16 v[220:223], v[56:59], a[56:59], v[220:223]
    ds_read_b64_tr_b16 v[56:57], v15 offset:0
    ds_read_b64_tr_b16 v[58:59], v15 offset:1024
    v_mfma_f32_16x16x32_bf16 v[220:223], v[60:63], a[60:63], v[220:223]
    s_waitcnt lgkmcnt(3)
    ds_read_b128 a[120:123], v22 offset:22528
    ds_read_b64_tr_b16 v[60:61], v15 offset:8192
    v_mfma_f32_16x16x32_bf16 v[224:227], v[40:43], a[0:3], v[224:227]
    ds_read_b64_tr_b16 v[62:63], v15 offset:9216
    v_add_u32 v15, 0xfffe0000, v15
    v_mfma_f32_16x16x32_bf16 v[224:227], v[44:47], a[4:7], v[224:227]
    s_xor_b32 s64, s64, 128
    v_mov_b32 v22, v100
    v_add_u32 v22, 0x10000, v22
    v_mfma_f32_16x16x32_bf16 v[228:231], v[40:43], a[8:11], v[228:231]
    ds_read_b128 a[124:127], v23 offset:22528
    v_mov_b32 v23, v101
    v_mfma_f32_16x16x32_bf16 v[228:231], v[44:47], a[12:15], v[228:231]
    v_add_u32 v23, 0x10000, v23
    v_mfma_f32_16x16x32_bf16 v[232:235], v[40:43], a[16:19], v[232:235]
    v_mfma_f32_16x16x32_bf16 v[232:235], v[44:47], a[20:23], v[232:235]
    s_add_u32 m0, s69, 65536
    v_mfma_f32_16x16x32_bf16 v[236:239], v[40:43], a[24:27], v[236:239]
    buffer_load_dwordx4 v2, s[24:27], s60 offen lds
    v_mfma_f32_16x16x32_bf16 v[236:239], v[44:47], a[28:31], v[236:239]
    v_mfma_f32_16x16x32_bf16 v[240:243], v[40:43], a[32:35], v[240:243]
    v_mfma_f32_16x16x32_bf16 v[240:243], v[44:47], a[36:39], v[240:243]
    v_mfma_f32_16x16x32_bf16 v[244:247], v[40:43], a[40:43], v[244:247]
    v_mfma_f32_16x16x32_bf16 v[244:247], v[44:47], a[44:47], v[244:247]
    v_mfma_f32_16x16x32_bf16 v[248:251], v[40:43], a[48:51], v[248:251]
    v_mfma_f32_16x16x32_bf16 v[248:251], v[44:47], a[52:55], v[248:251]
    buffer_load_dwordx4 v3, s[24:27], s60 offen offset:1024 lds
    v_mfma_f32_16x16x32_bf16 v[252:255], v[40:43], a[56:59], v[252:255]
    ds_read_b64_tr_b16 v[40:41], v16 offset:0
    ds_read_b64_tr_b16 v[42:43], v16 offset:1024
    v_mfma_f32_16x16x32_bf16 v[252:255], v[44:47], a[60:63], v[252:255]
    ds_read_b64_tr_b16 v[44:45], v16 offset:8192
    ds_read_b64_tr_b16 v[46:47], v16 offset:9216
    v_mfma_f32_16x16x32_bf16 v[128:131], v[48:51], a[64:67], v[128:131]
    v_add_u32 v16, 0xfffe0000, v16
    v_mfma_f32_16x16x32_bf16 v[128:131], v[52:55], a[68:71], v[128:131]
    v_mfma_f32_16x16x32_bf16 v[132:135], v[48:51], a[72:75], v[132:135]
    v_mfma_f32_16x16x32_bf16 v[132:135], v[52:55], a[76:79], v[132:135]
    v_mfma_f32_16x16x32_bf16 v[136:139], v[48:51], a[80:83], v[136:139]
    v_mfma_f32_16x16x32_bf16 v[136:139], v[52:55], a[84:87], v[136:139]
    buffer_load_dwordx4 v4, s[24:27], s60 offen offset:2048 lds
    v_mfma_f32_16x16x32_bf16 v[140:143], v[48:51], a[88:91], v[140:143]
    v_mfma_f32_16x16x32_bf16 v[140:143], v[52:55], a[92:95], v[140:143]
    v_mfma_f32_16x16x32_bf16 v[144:147], v[48:51], a[96:99], v[144:147]
    v_mul_f32 v128, s74, v128
    v_mul_f32 v129, s74, v129
    v_mfma_f32_16x16x32_bf16 v[144:147], v[52:55], a[100:103], v[144:147]
    v_mul_f32 v130, s74, v130
    v_mul_f32 v131, s74, v131
    v_mfma_f32_16x16x32_bf16 v[148:151], v[48:51], a[104:107], v[148:151]
    v_cvt_pk_bf16_f32 v128, v128, v129
    v_cvt_pk_bf16_f32 v129, v130, v131
    v_mfma_f32_16x16x32_bf16 v[148:151], v[52:55], a[108:111], v[148:151]
    v_mul_f32 v132, s74, v132
    v_mul_f32 v133, s74, v133
    v_mfma_f32_16x16x32_bf16 v[152:155], v[48:51], a[112:115], v[152:155]
    s_waitcnt lgkmcnt(0)
    buffer_load_dwordx4 v5, s[24:27], s60 offen offset:3072 lds
    v_mfma_f32_16x16x32_bf16 v[152:155], v[52:55], a[116:119], v[152:155]
    v_mul_f32 v134, s74, v134
    v_mul_f32 v135, s74, v135
    v_mfma_f32_16x16x32_bf16 v[156:159], v[48:51], a[120:123], v[156:159]
    ds_read_b64_tr_b16 v[48:49], v17 offset:0
    ds_read_b64_tr_b16 v[50:51], v17 offset:1024
    v_mfma_f32_16x16x32_bf16 v[156:159], v[52:55], a[124:127], v[156:159]
    ds_read_b64_tr_b16 v[52:53], v17 offset:8192
    ds_read_b64_tr_b16 v[54:55], v17 offset:9216
    v_mfma_f32_16x16x32_bf16 v[160:163], v[56:59], a[64:67], v[160:163]
    v_add_u32 v17, 0xfffe0000, v17
    v_cvt_pk_bf16_f32 v132, v132, v133
    v_mfma_f32_16x16x32_bf16 v[160:163], v[60:63], a[68:71], v[160:163]
    v_cvt_pk_bf16_f32 v133, v134, v135
    v_mul_f32 v136, s74, v136
    v_mfma_f32_16x16x32_bf16 v[164:167], v[56:59], a[72:75], v[164:167]
    v_mul_f32 v137, s74, v137
    v_mul_f32 v138, s74, v138
    v_mfma_f32_16x16x32_bf16 v[164:167], v[60:63], a[76:79], v[164:167]
    s_add_u32 m0, s69, 81920
    v_mul_f32 v139, s74, v139
    v_mul_f32 v160, s74, v160
    v_mfma_f32_16x16x32_bf16 v[168:171], v[56:59], a[80:83], v[168:171]
    s_xor_b32 s60, s60, 524288
    buffer_load_dwordx4 v10, s[20:23], s63 offen lds
    v_mfma_f32_16x16x32_bf16 v[168:171], v[60:63], a[84:87], v[168:171]
    v_mul_f32 v161, s74, v161
    v_mul_f32 v162, s74, v162
    v_mfma_f32_16x16x32_bf16 v[172:175], v[56:59], a[88:91], v[172:175]
    v_mul_f32 v163, s74, v163
    v_cvt_pk_bf16_f32 v130, v160, v161
    v_mfma_f32_16x16x32_bf16 v[172:175], v[60:63], a[92:95], v[172:175]
    v_cvt_pk_bf16_f32 v131, v162, v163
    v_mul_f32 v164, s74, v164
    v_mfma_f32_16x16x32_bf16 v[176:179], v[56:59], a[96:99], v[176:179]
    v_mul_f32 v165, s74, v165
    v_mul_f32 v166, s74, v166
    v_mfma_f32_16x16x32_bf16 v[176:179], v[60:63], a[100:103], v[176:179]
    v_mul_f32 v167, s74, v167
    v_cvt_pk_bf16_f32 v134, v164, v165
    v_mfma_f32_16x16x32_bf16 v[180:183], v[56:59], a[104:107], v[180:183]
    v_cvt_pk_bf16_f32 v135, v166, v167
    v_mul_f32 v168, s74, v168
    v_mfma_f32_16x16x32_bf16 v[180:183], v[60:63], a[108:111], v[180:183]
    buffer_load_dwordx4 v11, s[20:23], s63 offen offset:1024 lds
    v_mfma_f32_16x16x32_bf16 v[184:187], v[56:59], a[112:115], v[184:187]
    v_mul_f32 v169, s74, v169
    v_mul_f32 v170, s74, v170
    v_mfma_f32_16x16x32_bf16 v[184:187], v[60:63], a[116:119], v[184:187]
    v_mul_f32 v171, s74, v171
    v_cvt_pk_bf16_f32 v136, v136, v137
    v_mfma_f32_16x16x32_bf16 v[188:191], v[56:59], a[120:123], v[188:191]
    v_cvt_pk_bf16_f32 v137, v138, v139
    v_cvt_pk_bf16_f32 v138, v168, v169
    v_mfma_f32_16x16x32_bf16 v[188:191], v[60:63], a[124:127], v[188:191]
    v_cvt_pk_bf16_f32 v139, v170, v171
    v_mul_f32 v140, s74, v140
    v_mfma_f32_16x16x32_bf16 v[192:195], v[40:43], a[64:67], v[192:195]
    v_mul_f32 v141, s74, v141
    v_mul_f32 v142, s74, v142
    v_mfma_f32_16x16x32_bf16 v[192:195], v[44:47], a[68:71], v[192:195]
    v_mul_f32 v143, s74, v143
    v_mul_f32 v172, s74, v172
    v_mfma_f32_16x16x32_bf16 v[196:199], v[40:43], a[72:75], v[196:199]
    v_mul_f32 v173, s74, v173
    v_mul_f32 v174, s74, v174
    v_mfma_f32_16x16x32_bf16 v[196:199], v[44:47], a[76:79], v[196:199]
    buffer_load_dwordx4 v12, s[20:23], s63 offen offset:2048 lds
    v_mfma_f32_16x16x32_bf16 v[200:203], v[40:43], a[80:83], v[200:203]
    v_mul_f32 v175, s74, v175
    v_cvt_pk_bf16_f32 v140, v140, v141
    v_mfma_f32_16x16x32_bf16 v[200:203], v[44:47], a[84:87], v[200:203]
    v_cvt_pk_bf16_f32 v141, v142, v143
    v_cvt_pk_bf16_f32 v142, v172, v173
    v_mfma_f32_16x16x32_bf16 v[204:207], v[40:43], a[88:91], v[204:207]
    v_cvt_pk_bf16_f32 v143, v174, v175
    v_mul_f32 v144, s74, v144
    v_mfma_f32_16x16x32_bf16 v[204:207], v[44:47], a[92:95], v[204:207]
    v_mul_f32 v145, s74, v145
    v_mul_f32 v146, s74, v146
    v_mfma_f32_16x16x32_bf16 v[208:211], v[40:43], a[96:99], v[208:211]
    v_mul_f32 v147, s74, v147
    v_mul_f32 v176, s74, v176
    v_mfma_f32_16x16x32_bf16 v[208:211], v[44:47], a[100:103], v[208:211]
    v_mul_f32 v177, s74, v177
    v_mul_f32 v178, s74, v178
    v_mfma_f32_16x16x32_bf16 v[212:215], v[40:43], a[104:107], v[212:215]
    buffer_load_dwordx4 v13, s[20:23], s63 offen offset:3072 lds
    v_mfma_f32_16x16x32_bf16 v[212:215], v[44:47], a[108:111], v[212:215]
    v_mul_f32 v179, s74, v179
    v_cvt_pk_bf16_f32 v144, v144, v145
    v_mfma_f32_16x16x32_bf16 v[216:219], v[40:43], a[112:115], v[216:219]
    v_cvt_pk_bf16_f32 v145, v146, v147
    v_cvt_pk_bf16_f32 v146, v176, v177
    v_mfma_f32_16x16x32_bf16 v[216:219], v[44:47], a[116:119], v[216:219]
    v_cvt_pk_bf16_f32 v147, v178, v179
    v_mul_f32 v148, s74, v148
    v_mfma_f32_16x16x32_bf16 v[220:223], v[40:43], a[120:123], v[220:223]
    v_mul_f32 v149, s74, v149
    v_mul_f32 v150, s74, v150
    v_mfma_f32_16x16x32_bf16 v[220:223], v[44:47], a[124:127], v[220:223]
    s_add_u32 s72, s70, 0
    v_mul_f32 v151, s74, v151
    v_mul_f32 v180, s74, v180
    s_waitcnt lgkmcnt(0)
    v_mfma_f32_16x16x32_bf16 v[224:227], v[48:51], a[64:67], v[224:227]
    buffer_store_dwordx4 v[128:131], v1, s[36:39], s72 offen sc1
    v_mfma_f32_16x16x32_bf16 v[224:227], v[52:55], a[68:71], v[224:227]
    s_xor_b32 s63, s63, 384
    v_mul_f32 v181, s74, v181
    v_mul_f32 v182, s74, v182
    v_mfma_f32_16x16x32_bf16 v[228:231], v[48:51], a[72:75], v[228:231]
    v_mul_f32 v183, s74, v183
    v_cvt_pk_bf16_f32 v148, v148, v149
    v_mfma_f32_16x16x32_bf16 v[228:231], v[52:55], a[76:79], v[228:231]
    v_cvt_pk_bf16_f32 v149, v150, v151
    v_cvt_pk_bf16_f32 v150, v180, v181
    v_mfma_f32_16x16x32_bf16 v[232:235], v[48:51], a[80:83], v[232:235]
    v_cvt_pk_bf16_f32 v151, v182, v183
    v_mul_f32 v152, s74, v152
    v_mfma_f32_16x16x32_bf16 v[232:235], v[52:55], a[84:87], v[232:235]
    s_add_u32 m0, s67, 98304
    v_mul_f32 v153, s74, v153
    v_mul_f32 v154, s74, v154
    s_waitcnt vmcnt(9) lgkmcnt(0)
    v_cmp_gt_u32 vcc, 8, v7
    s_nop 1
    s_and_b64 vcc, vcc, s[86:87]
    s_cbranch_scc1 SPIN_WA
BACK_WA:
    s_barrier
    v_mfma_f32_16x16x32_bf16 v[236:239], v[48:51], a[88:91], v[236:239]
    buffer_load_dwordx4 v1, s[28:31], s65 offen sc1 lds
    v_mfma_f32_16x16x32_bf16 v[236:239], v[52:55], a[92:95], v[236:239]
    ds_read_b64_tr_b16 v[56:57], v14 offset:0
    ds_read_b64_tr_b16 v[58:59], v14 offset:1024
    v_mfma_f32_16x16x32_bf16 v[240:243], v[48:51], a[96:99], v[240:243]
    ds_read_b64_tr_b16 v[60:61], v14 offset:8192
    ds_read_b64_tr_b16 v[62:63], v14 offset:9216
    v_mfma_f32_16x16x32_bf16 v[240:243], v[52:55], a[100:103], v[240:243]
    ds_read_b64_tr_b16 v[40:41], v15 offset:0
    ds_read_b64_tr_b16 v[42:43], v15 offset:1024
    v_mfma_f32_16x16x32_bf16 v[244:247], v[48:51], a[104:107], v[244:247]
    ds_read_b64_tr_b16 v[44:45], v15 offset:8192
    ds_read_b64_tr_b16 v[46:47], v15 offset:9216
    v_mfma_f32_16x16x32_bf16 v[244:247], v[52:55], a[108:111], v[244:247]
    v_mul_f32 v155, s74, v155
    v_mul_f32 v184, s74, v184
    v_mfma_f32_16x16x32_bf16 v[248:251], v[48:51], a[112:115], v[248:251]
    v_mul_f32 v185, s74, v185
    v_mul_f32 v186, s74, v186
    v_mfma_f32_16x16x32_bf16 v[248:251], v[52:55], a[116:119], v[248:251]
    v_mul_f32 v187, s74, v187
    v_cvt_pk_bf16_f32 v152, v152, v153
    v_mfma_f32_16x16x32_bf16 v[252:255], v[48:51], a[120:123], v[252:255]
    s_lshr_b32 s92, s2, 3
    buffer_load_dwordx4 v1, s[28:31], s65 offen offset:1024 sc1 lds
    v_mfma_f32_16x16x32_bf16 v[252:255], v[52:55], a[124:127], v[252:255]
    s_lshl2_add_u32 s92, s92, s4
    v_lshrrev_b32 v9, 4, v1
    v_min_u32 v9, 0, v9
    s_waitcnt lgkmcnt(0)
    v_mfma_f32_16x16x32_bf16 a[128:131], a[0:3], v[56:59], a[128:131]
    s_mul_i32 s92, s92, 1
    ds_read_b64_tr_b16 v[48:49], v16 offset:0
    ds_read_b64_tr_b16 v[50:51], v16 offset:1024
    v_mfma_f32_16x16x32_bf16 a[128:131], a[4:7], v[60:63], a[128:131]
    s_add_u32 s92, s92, 32
    v_add_lshl_u32 v9, v9, s92, 7
    ds_read_b64_tr_b16 v[52:53], v16 offset:8192
    v_mfma_f32_16x16x32_bf16 a[132:135], a[8:11], v[56:59], a[132:135]
    s_getpc_b64 s[92:93]
    global_load_dword v9, v9, s[92:93]
    v_mfma_f32_16x16x32_bf16 a[132:135], a[12:15], v[60:63], a[132:135]
    ds_read_b128 v[64:67], v24 offset:16384
    ds_read_b64_tr_b16 v[54:55], v16 offset:9216
    v_mfma_f32_16x16x32_bf16 a[136:139], a[16:19], v[56:59], a[136:139]
    v_cvt_pk_bf16_f32 v153, v154, v155
    v_cvt_pk_bf16_f32 v154, v184, v185
    v_mfma_f32_16x16x32_bf16 a[136:139], a[20:23], v[60:63], a[136:139]
    v_cvt_pk_bf16_f32 v155, v186, v187
    v_mul_f32 v156, s74, v156
    v_mfma_f32_16x16x32_bf16 a[140:143], a[24:27], v[56:59], a[140:143]
    s_add_u32 m0, s68, 106496
    v_mul_f32 v157, s74, v157
    v_mul_f32 v158, s74, v158
    v_mfma_f32_16x16x32_bf16 a[140:143], a[28:31], v[60:63], a[140:143]
    buffer_load_dwordx4 v6, s[20:23], s66 offen lds
    v_mfma_f32_16x16x32_bf16 a[144:147], a[32:35], v[56:59], a[144:147]
    s_add_u32 s72, s70, 4096
    v_mul_f32 v159, s74, v159
    v_mul_f32 v188, s74, v188
    v_mfma_f32_16x16x32_bf16 a[144:147], a[36:39], v[60:63], a[144:147]
    buffer_store_dwordx4 v[132:135], v1, s[36:39], s72 offen sc1
    v_mfma_f32_16x16x32_bf16 a[148:151], a[40:43], v[56:59], a[148:151]
    v_mul_f32 v189, s74, v189
    v_mul_f32 v190, s74, v190
    v_mfma_f32_16x16x32_bf16 a[148:151], a[44:47], v[60:63], a[148:151]
    v_mul_f32 v191, s74, v191
    v_cvt_pk_bf16_f32 v156, v156, v157
    v_mfma_f32_16x16x32_bf16 a[152:155], a[48:51], v[56:59], a[152:155]
    v_cvt_pk_bf16_f32 v157, v158, v159
    v_cvt_pk_bf16_f32 v158, v188, v189
    v_mfma_f32_16x16x32_bf16 a[152:155], a[52:55], v[60:63], a[152:155]
    ds_read_b128 v[68:71], v25 offset:16384
    v_cvt_pk_bf16_f32 v159, v190, v191
    v_mfma_f32_16x16x32_bf16 a[156:159], a[56:59], v[56:59], a[156:159]
    s_add_u32 m0, s69, 114688
    ds_read_b64_tr_b16 v[56:57], v17 offset:0
    ds_read_b64_tr_b16 v[58:59], v17 offset:1024
    v_mfma_f32_16x16x32_bf16 a[156:159], a[60:63], v[60:63], a[156:159]
    s_xor_b32 s65, s65, 8192
    buffer_load_dwordx4 v10, s[20:23], s64 offen lds
    v_mfma_f32_16x16x32_bf16 a[160:163], a[0:3], v[40:43], a[160:163]
    s_xor_b32 s66, s66, 128
    ds_read_b64_tr_b16 v[60:61], v17 offset:8192
    ds_read_b64_tr_b16 v[62:63], v17 offset:9216
    v_mfma_f32_16x16x32_bf16 a[160:163], a[4:7], v[44:47], a[160:163]
    v_mul_f32 v192, s74, v192
    v_mul_f32 v193, s74, v193
    v_mfma_f32_16x16x32_bf16 a[164:167], a[8:11], v[40:43], a[164:167]
    v_mul_f32 v194, s74, v194
    v_mul_f32 v195, s74, v195
    v_mfma_f32_16x16x32_bf16 a[164:167], a[12:15], v[44:47], a[164:167]
    v_mul_f32 v224, s74, v224
    v_mul_f32 v225, s74, v225
    v_mfma_f32_16x16x32_bf16 a[168:171], a[16:19], v[40:43], a[168:171]
    v_mul_f32 v226, s74, v226
    v_mul_f32 v227, s74, v227
    v_mfma_f32_16x16x32_bf16 a[168:171], a[20:23], v[44:47], a[168:171]
    v_cvt_pk_bf16_f32 v192, v192, v193
    v_cvt_pk_bf16_f32 v193, v194, v195
    v_mfma_f32_16x16x32_bf16 a[172:175], a[24:27], v[40:43], a[172:175]
    v_cvt_pk_bf16_f32 v194, v224, v225
    v_cvt_pk_bf16_f32 v195, v226, v227
    v_mfma_f32_16x16x32_bf16 a[172:175], a[28:31], v[44:47], a[172:175]
    v_mul_f32 v196, s74, v196
    v_mul_f32 v197, s74, v197
    v_mfma_f32_16x16x32_bf16 a[176:179], a[32:35], v[40:43], a[176:179]
    buffer_load_dwordx4 v11, s[20:23], s64 offen offset:1024 lds
    v_mfma_f32_16x16x32_bf16 a[176:179], a[36:39], v[44:47], a[176:179]
    ds_read_b128 v[72:75], v24 offset:24576
    v_mul_f32 v198, s74, v198
    v_mfma_f32_16x16x32_bf16 a[180:183], a[40:43], v[40:43], a[180:183]
    v_mul_f32 v199, s74, v199
    v_mul_f32 v228, s74, v228
    v_mfma_f32_16x16x32_bf16 a[180:183], a[44:47], v[44:47], a[180:183]
    v_mul_f32 v229, s74, v229
    v_mul_f32 v230, s74, v230
    v_mfma_f32_16x16x32_bf16 a[184:187], a[48:51], v[40:43], a[184:187]
    v_mul_f32 v231, s74, v231
    v_cvt_pk_bf16_f32 v196, v196, v197
    v_mfma_f32_16x16x32_bf16 a[184:187], a[52:55], v[44:47], a[184:187]
    v_cvt_pk_bf16_f32 v197, v198, v199
    v_cvt_pk_bf16_f32 v198, v228, v229
    v_mfma_f32_16x16x32_bf16 a[188:191], a[56:59], v[40:43], a[188:191]
    ds_read_b64_tr_b16 v[40:41], v14 offset:32768
    ds_read_b64_tr_b16 v[42:43], v14 offset:33792
    v_mfma_f32_16x16x32_bf16 a[188:191], a[60:63], v[44:47], a[188:191]
    s_waitcnt lgkmcnt(2)
    ds_read_b64_tr_b16 v[44:45], v14 offset:40960
    ds_read_b64_tr_b16 v[46:47], v14 offset:41984
    v_mfma_f32_16x16x32_bf16 a[192:195], a[0:3], v[48:51], a[192:195]
    buffer_load_dwordx4 v12, s[20:23], s64 offen offset:2048 lds
    v_mfma_f32_16x16x32_bf16 a[192:195], a[4:7], v[52:55], a[192:195]
    s_add_u32 s72, s70, 8192
    v_xor_b32 v14, s73, v14
    v_add_u32 v14, 0x10000, v14
    v_mfma_f32_16x16x32_bf16 a[196:199], a[8:11], v[48:51], a[196:199]
    buffer_store_dwordx4 v[136:139], v1, s[36:39], s72 offen sc1
    v_mfma_f32_16x16x32_bf16 a[196:199], a[12:15], v[52:55], a[196:199]
    ds_read_b128 v[76:79], v25 offset:24576
    v_cvt_pk_bf16_f32 v199, v230, v231
    v_mfma_f32_16x16x32_bf16 a[200:203], a[16:19], v[48:51], a[200:203]
    v_mul_f32 v200, s74, v200
    v_mul_f32 v201, s74, v201
    v_mfma_f32_16x16x32_bf16 a[200:203], a[20:23], v[52:55], a[200:203]
    v_mul_f32 v202, s74, v202
    v_mul_f32 v203, s74, v203
    v_mfma_f32_16x16x32_bf16 a[204:207], a[24:27], v[48:51], a[204:207]
    v_mul_f32 v232, s74, v232
    v_mul_f32 v233, s74, v233
    v_mfma_f32_16x16x32_bf16 a[204:207], a[28:31], v[52:55], a[204:207]
    v_mul_f32 v234, s74, v234
    v_mul_f32 v235, s74, v235
    v_mfma_f32_16x16x32_bf16 a[208:211], a[32:35], v[48:51], a[208:211]
    v_cvt_pk_bf16_f32 v200, v200, v201
    v_cvt_pk_bf16_f32 v201, v202, v203
    v_mfma_f32_16x16x32_bf16 a[208:211], a[36:39], v[52:55], a[208:211]
    buffer_load_dwordx4 v13, s[20:23], s64 offen offset:3072 lds
    v_mfma_f32_16x16x32_bf16 a[212:215], a[40:43], v[48:51], a[212:215]
    v_cvt_pk_bf16_f32 v202, v232, v233
    v_cvt_pk_bf16_f32 v203, v234, v235
    v_mfma_f32_16x16x32_bf16 a[212:215], a[44:47], v[52:55], a[212:215]
    v_mul_f32 v204, s74, v204
    v_mul_f32 v205, s74, v205
    v_mfma_f32_16x16x32_bf16 a[216:219], a[48:51], v[48:51], a[216:219]
    v_mul_f32 v206, s74, v206
    v_mul_f32 v207, s74, v207
    v_mfma_f32_16x16x32_bf16 a[216:219], a[52:55], v[52:55], a[216:219]
    v_mul_f32 v236, s74, v236
    v_mul_f32 v237, s74, v237
    v_mfma_f32_16x16x32_bf16 a[220:223], a[56:59], v[48:51], a[220:223]
    ds_read_b64_tr_b16 v[48:49], v15 offset:32768
    ds_read_b64_tr_b16 v[50:51], v15 offset:33792
    v_mfma_f32_16x16x32_bf16 a[220:223], a[60:63], v[52:55], a[220:223]
    ds_read_b64_tr_b16 v[52:53], v15 offset:40960
    ds_read_b64_tr_b16 v[54:55], v15 offset:41984
    v_mfma_f32_16x16x32_bf16 a[224:227], a[0:3], v[56:59], a[224:227]
    v_xor_b32 v15, s73, v15
    v_add_u32 v15, 0x10000, v15
    v_mfma_f32_16x16x32_bf16 a[224:227], a[4:7], v[60:63], a[224:227]
    s_xor_b32 s64, s64, 384
    v_accvgpr_write_b32 a4, v192
    v_accvgpr_write_b32 a5, v193
    v_mfma_f32_16x16x32_bf16 a[228:231], a[8:11], v[56:59], a[228:231]
    v_accvgpr_write_b32 a6, v194
    v_accvgpr_write_b32 a7, v195
    v_mfma_f32_16x16x32_bf16 a[228:231], a[12:15], v[60:63], a[228:231]
    v_accvgpr_write_b32 a12, v196
    v_accvgpr_write_b32 a13, v197
    v_mfma_f32_16x16x32_bf16 a[232:235], a[16:19], v[56:59], a[232:235]
    v_accvgpr_write_b32 a14, v198
    v_accvgpr_write_b32 a15, v199
    v_mfma_f32_16x16x32_bf16 a[232:235], a[20:23], v[60:63], a[232:235]
    s_add_u32 m0, s69, 131072
    v_mul_f32 v238, s74, v238
    v_mul_f32 v239, s74, v239
    v_mfma_f32_16x16x32_bf16 a[236:239], a[24:27], v[56:59], a[236:239]
    buffer_load_dwordx4 v2, s[24:27], s60 offen lds
    v_mfma_f32_16x16x32_bf16 a[236:239], a[28:31], v[60:63], a[236:239]
    v_accvgpr_write_b32 a20, v200
    v_accvgpr_write_b32 a21, v201
    v_mfma_f32_16x16x32_bf16 a[240:243], a[32:35], v[56:59], a[240:243]
    v_accvgpr_write_b32 a22, v202
    v_accvgpr_write_b32 a23, v203
    v_mfma_f32_16x16x32_bf16 a[240:243], a[36:39], v[60:63], a[240:243]
    v_cvt_pk_bf16_f32 v204, v204, v205
    v_cvt_pk_bf16_f32 v205, v206, v207
    v_mfma_f32_16x16x32_bf16 a[244:247], a[40:43], v[56:59], a[244:247]
    s_add_u32 s72, s70, 12288
    v_accvgpr_write_b32 a40, v148
    v_accvgpr_write_b32 a41, v149
    v_mfma_f32_16x16x32_bf16 a[244:247], a[44:47], v[60:63], a[244:247]
    buffer_store_dwordx4 v[140:143], v1, s[36:39], s72 offen sc1
    v_mfma_f32_16x16x32_bf16 a[248:251], a[48:51], v[56:59], a[248:251]
    v_accvgpr_write_b32 a42, v150
    v_accvgpr_write_b32 a43, v151
    v_mfma_f32_16x16x32_bf16 a[248:251], a[52:55], v[60:63], a[248:251]
    buffer_load_dwordx4 v3, s[24:27], s60 offen offset:1024 lds
    v_mfma_f32_16x16x32_bf16 a[252:255], a[56:59], v[56:59], a[252:255]
    ds_read_b64_tr_b16 v[56:57], v16 offset:32768
    ds_read_b64_tr_b16 v[58:59], v16 offset:33792
    v_mfma_f32_16x16x32_bf16 a[252:255], a[60:63], v[60:63], a[252:255]
    s_waitcnt lgkmcnt(2)
    ds_read_b64_tr_b16 v[60:61], v16 offset:40960
    ds_read_b64_tr_b16 v[62:63], v16 offset:41984
    v_mfma_f32_16x16x32_bf16 a[128:131], a[64:67], v[40:43], a[128:131]
    v_xor_b32 v16, s73, v16
    v_add_u32 v16, 0x10000, v16
    v_mfma_f32_16x16x32_bf16 a[128:131], a[68:71], v[44:47], a[128:131]
    v_accvgpr_write_b32 a48, v152
    v_accvgpr_write_b32 a49, v153
    v_mfma_f32_16x16x32_bf16 a[132:135], a[72:75], v[40:43], a[132:135]
    ds_read_b128 v[80:83], v24 offset:49152
    v_accvgpr_write_b32 a50, v154
    v_mfma_f32_16x16x32_bf16 a[132:135], a[76:79], v[44:47], a[132:135]
    v_accvgpr_write_b32 a51, v155
    v_accvgpr_write_b32 a56, v156
    v_mfma_f32_16x16x32_bf16 a[136:139], a[80:83], v[40:43], a[136:139]
    v_accvgpr_write_b32 a57, v157
    v_accvgpr_write_b32 a58, v158
    v_mfma_f32_16x16x32_bf16 a[136:139], a[84:87], v[44:47], a[136:139]
    buffer_load_dwordx4 v4, s[24:27], s60 offen offset:2048 lds
    v_mfma_f32_16x16x32_bf16 a[140:143], a[88:91], v[40:43], a[140:143]
    v_accvgpr_write_b32 a59, v159
    v_cvt_pk_bf16_f32 v206, v236, v237
    v_mfma_f32_16x16x32_bf16 a[140:143], a[92:95], v[44:47], a[140:143]
    v_cvt_pk_bf16_f32 v207, v238, v239
    v_mul_f32 v208, s74, v208
    v_mfma_f32_16x16x32_bf16 a[144:147], a[96:99], v[40:43], a[144:147]
    v_mul_f32 v209, s74, v209
    v_mul_f32 v210, s74, v210
    v_mfma_f32_16x16x32_bf16 a[144:147], a[100:103], v[44:47], a[144:147]
    v_mul_f32 v211, s74, v211
    v_mul_f32 v240, s74, v240
    v_mfma_f32_16x16x32_bf16 a[148:151], a[104:107], v[40:43], a[148:151]
    v_mul_f32 v241, s74, v241
    v_mul_f32 v242, s74, v242
    v_mfma_f32_16x16x32_bf16 a[148:151], a[108:111], v[44:47], a[148:151]
    v_mul_f32 v243, s74, v243
    v_accvgpr_write_b32 a28, v204
    v_mfma_f32_16x16x32_bf16 a[152:155], a[112:115], v[40:43], a[152:155]
    buffer_load_dwordx4 v5, s[24:27], s60 offen offset:3072 lds
    v_mfma_f32_16x16x32_bf16 a[152:155], a[116:119], v[44:47], a[152:155]
    ds_read_b128 v[84:87], v25 offset:49152
    v_accvgpr_write_b32 a29, v205
    v_mfma_f32_16x16x32_bf16 a[156:159], a[120:123], v[40:43], a[156:159]
    ds_read_b64_tr_b16 v[40:41], v17 offset:32768
    ds_read_b64_tr_b16 v[42:43], v17 offset:33792
    v_mfma_f32_16x16x32_bf16 a[156:159], a[124:127], v[44:47], a[156:159]
    ds_read_b64_tr_b16 v[44:45], v17 offset:40960
    ds_read_b64_tr_b16 v[46:47], v17 offset:41984
    v_mfma_f32_16x16x32_bf16 a[160:163], a[64:67], v[48:51], a[160:163]
    v_xor_b32 v17, s73, v17
    v_add_u32 v17, 0x10000, v17
    v_mfma_f32_16x16x32_bf16 a[160:163], a[68:71], v[52:55], a[160:163]
    v_accvgpr_write_b32 a30, v206
    v_accvgpr_write_b32 a31, v207
    v_mfma_f32_16x16x32_bf16 a[164:167], a[72:75], v[48:51], a[164:167]
    v_cvt_pk_bf16_f32 v208, v208, v209
    v_cvt_pk_bf16_f32 v209, v210, v211
    v_mfma_f32_16x16x32_bf16 a[164:167], a[76:79], v[52:55], a[164:167]
    s_add_u32 m0, s69, 147456
    v_cvt_pk_bf16_f32 v210, v240, v241
    v_cvt_pk_bf16_f32 v211, v242, v243
    v_mfma_f32_16x16x32_bf16 a[168:171], a[80:83], v[48:51], a[168:171]
    s_xor_b32 s60, s60, 1572864
    buffer_load_dwordx4 v10, s[20:23], s63 offen lds
    v_mfma_f32_16x16x32_bf16 a[168:171], a[84:87], v[52:55], a[168:171]
    s_add_u32 s72, s70, 32768
    buffer_store_dwordx4 v[144:147], v1, s[36:39], s72 offen sc1
    v_mfma_f32_16x16x32_bf16 a[172:175], a[88:91], v[48:51], a[172:175]
    v_mul_f32 v212, s74, v212
    v_mul_f32 v213, s74, v213
    v_mfma_f32_16x16x32_bf16 a[172:175], a[92:95], v[52:55], a[172:175]
    v_mul_f32 v214, s74, v214
    v_mul_f32 v215, s74, v215
    v_mfma_f32_16x16x32_bf16 a[176:179], a[96:99], v[48:51], a[176:179]
    ds_read_b128 v[88:91], v24 offset:57344
    v_mul_f32 v244, s74, v244
    v_mfma_f32_16x16x32_bf16 a[176:179], a[100:103], v[52:55], a[176:179]
    v_mul_f32 v245, s74, v245
    v_mul_f32 v246, s74, v246
    v_mfma_f32_16x16x32_bf16 a[180:183], a[104:107], v[48:51], a[180:183]
    v_mul_f32 v247, s74, v247
    v_accvgpr_write_b32 a36, v208
    v_mfma_f32_16x16x32_bf16 a[180:183], a[108:111], v[52:55], a[180:183]
    buffer_load_dwordx4 v11, s[20:23], s63 offen offset:1024 lds
    v_mfma_f32_16x16x32_bf16 a[184:187], a[112:115], v[48:51], a[184:187]
    v_accvgpr_write_b32 a37, v209
    v_accvgpr_write_b32 a38, v210
    v_mfma_f32_16x16x32_bf16 a[184:187], a[116:119], v[52:55], a[184:187]
    v_accvgpr_write_b32 a39, v211
    v_cvt_pk_bf16_f32 v212, v212, v213
    v_mfma_f32_16x16x32_bf16 a[188:191], a[120:123], v[48:51], a[188:191]
    v_cvt_pk_bf16_f32 v213, v214, v215
    v_cvt_pk_bf16_f32 v214, v244, v245
    v_mfma_f32_16x16x32_bf16 a[188:191], a[124:127], v[52:55], a[188:191]
    s_waitcnt lgkmcnt(0)
    v_cvt_pk_bf16_f32 v215, v246, v247
    v_mul_f32 v216, s74, v216
    v_mfma_f32_16x16x32_bf16 a[192:195], a[64:67], v[56:59], a[192:195]
    v_mul_f32 v217, s74, v217
    v_mul_f32 v218, s74, v218
    v_mfma_f32_16x16x32_bf16 a[192:195], a[68:71], v[60:63], a[192:195]
    v_accvgpr_read_b32 v32, a128
    v_accvgpr_read_b32 v31, a129
    v_mfma_f32_16x16x32_bf16 a[196:199], a[72:75], v[56:59], a[196:199]
    v_cvt_pk_bf16_f32 v32, v32, v31
    v_accvgpr_read_b32 v33, a130
    v_mfma_f32_16x16x32_bf16 a[196:199], a[76:79], v[60:63], a[196:199]
    buffer_load_dwordx4 v12, s[20:23], s63 offen offset:2048 lds
    v_mfma_f32_16x16x32_bf16 a[200:203], a[80:83], v[56:59], a[200:203]
    ds_read_b128 v[92:95], v25 offset:57344
    v_accvgpr_read_b32 v31, a131
    v_mfma_f32_16x16x32_bf16 a[200:203], a[84:87], v[60:63], a[200:203]
    v_cvt_pk_bf16_f32 v33, v33, v31
    v_accvgpr_read_b32 v34, a132
    v_mfma_f32_16x16x32_bf16 a[204:207], a[88:91], v[56:59], a[204:207]
    v_accvgpr_read_b32 v31, a133
    v_cvt_pk_bf16_f32 v34, v34, v31
    v_mfma_f32_16x16x32_bf16 a[204:207], a[92:95], v[60:63], a[204:207]
    v_accvgpr_read_b32 v35, a134
    v_accvgpr_read_b32 v31, a135
    v_mfma_f32_16x16x32_bf16 a[208:211], a[96:99], v[56:59], a[208:211]
    v_cvt_pk_bf16_f32 v35, v35, v31
    v_mul_f32 v219, s74, v219
    v_mfma_f32_16x16x32_bf16 a[208:211], a[100:103], v[60:63], a[208:211]
    v_mul_f32 v248, s74, v248
    v_mul_f32 v249, s74, v249
    v_mfma_f32_16x16x32_bf16 a[212:215], a[104:107], v[56:59], a[212:215]
    buffer_load_dwordx4 v13, s[20:23], s63 offen offset:3072 lds
    v_mfma_f32_16x16x32_bf16 a[212:215], a[108:111], v[60:63], a[212:215]
    v_mul_f32 v250, s74, v250
    v_mul_f32 v251, s74, v251
    v_mfma_f32_16x16x32_bf16 a[216:219], a[112:115], v[56:59], a[216:219]
    s_add_u32 s72, s71, 0
    v_accvgpr_write_b32 a44, v212
    v_accvgpr_write_b32 a45, v213
    v_mfma_f32_16x16x32_bf16 a[216:219], a[116:119], v[60:63], a[216:219]
    buffer_store_dwordx4 v[32:35], v1, s[36:39], s72 offen sc1
    v_mfma_f32_16x16x32_bf16 a[220:223], a[120:123], v[56:59], a[220:223]
    v_accvgpr_write_b32 a46, v214
    v_accvgpr_write_b32 a47, v215
    v_mfma_f32_16x16x32_bf16 a[220:223], a[124:127], v[60:63], a[220:223]
    v_cvt_pk_bf16_f32 v216, v216, v217
    v_cvt_pk_bf16_f32 v217, v218, v219
    v_mfma_f32_16x16x32_bf16 a[224:227], a[64:67], v[40:43], a[224:227]
    v_cvt_pk_bf16_f32 v218, v248, v249
    v_cvt_pk_bf16_f32 v219, v250, v251
    v_mfma_f32_16x16x32_bf16 a[224:227], a[68:71], v[44:47], a[224:227]
    s_xor_b32 s63, s63, 128
    v_mul_f32 v220, s74, v220
    v_mul_f32 v221, s74, v221
    v_mfma_f32_16x16x32_bf16 a[228:231], a[72:75], v[40:43], a[228:231]
    v_mul_f32 v222, s74, v222
    v_mul_f32 v223, s74, v223
    v_mfma_f32_16x16x32_bf16 a[228:231], a[76:79], v[44:47], a[228:231]
    v_mul_f32 v252, s74, v252
    v_mul_f32 v253, s74, v253
    v_mfma_f32_16x16x32_bf16 a[232:235], a[80:83], v[40:43], a[232:235]
    v_mul_f32 v254, s74, v254
    v_mul_f32 v255, s74, v255
    v_mfma_f32_16x16x32_bf16 a[232:235], a[84:87], v[44:47], a[232:235]
    s_waitcnt vmcnt(11) lgkmcnt(0)
    s_barrier
    ds_read_b64_tr_b16 v[48:49], v14 offset:0
    v_mfma_f32_16x16x32_bf16 a[236:239], a[88:91], v[40:43], a[236:239]
    s_add_u32 m0, s67, 0
    ds_read_b64_tr_b16 v[50:51], v14 offset:1024
    ds_read_b64_tr_b16 v[52:53], v14 offset:8192
    v_mfma_f32_16x16x32_bf16 a[236:239], a[92:95], v[44:47], a[236:239]
    buffer_load_dwordx4 v1, s[28:31], s65 offen sc1 lds
    v_mfma_f32_16x16x32_bf16 a[240:243], a[96:99], v[40:43], a[240:243]
    ds_read_b64_tr_b16 v[54:55], v14 offset:9216
    ds_read_b64_tr_b16 v[56:57], v15 offset:0
    v_mfma_f32_16x16x32_bf16 a[240:243], a[100:103], v[44:47], a[240:243]
    ds_read_b64_tr_b16 v[58:59], v15 offset:1024
    ds_read_b64_tr_b16 v[60:61], v15 offset:8192
    v_mfma_f32_16x16x32_bf16 a[244:247], a[104:107], v[40:43], a[244:247]
    ds_read_b64_tr_b16 v[62:63], v15 offset:9216
    v_add_u32 v14, 0x10000, v14
    v_mfma_f32_16x16x32_bf16 a[244:247], a[108:111], v[44:47], a[244:247]
    v_add_u32 v15, 0x10000, v15
    v_accvgpr_read_b32 v32, a136
    v_mfma_f32_16x16x32_bf16 a[248:251], a[112:115], v[40:43], a[248:251]
    v_accvgpr_read_b32 v31, a137
    v_cvt_pk_bf16_f32 v32, v32, v31
    v_mfma_f32_16x16x32_bf16 a[248:251], a[116:119], v[44:47], a[248:251]
    v_accvgpr_read_b32 v33, a138
    v_accvgpr_read_b32 v31, a139
    v_mfma_f32_16x16x32_bf16 a[252:255], a[120:123], v[40:43], a[252:255]
    buffer_load_dwordx4 v1, s[28:31], s65 offen offset:1024 sc1 lds
    v_mfma_f32_16x16x32_bf16 a[252:255], a[124:127], v[44:47], a[252:255]
    s_waitcnt lgkmcnt(0)
    ds_read_b64_tr_b16 v[40:41], v16 offset:0
    ds_read_b64_tr_b16 v[42:43], v16 offset:1024
    v_mfma_f32_16x16x32_bf16 v[128:131], v[48:51], v[64:67], 0
    ds_read_b64_tr_b16 v[44:45], v16 offset:8192
    ds_read_b64_tr_b16 v[46:47], v16 offset:9216
    v_mfma_f32_16x16x32_bf16 v[128:131], v[52:55], v[68:71], v[128:131]
    v_add_u32 v24, 0x10000, v24
    ds_read_b128 a[136:139], v22 offset:32768
    v_mfma_f32_16x16x32_bf16 v[132:135], v[48:51], v[72:75], 0
    ds_read_b128 v[96:99], v24 offset:16384
    v_add_u32 v16, 0x10000, v16
    v_mfma_f32_16x16x32_bf16 v[132:135], v[52:55], v[76:79], v[132:135]
    v_add_u32 v22, 0xffff0000, v22
    v_cvt_pk_bf16_f32 v33, v33, v31
    v_mfma_f32_16x16x32_bf16 v[136:139], v[48:51], v[80:83], 0
    v_accvgpr_read_b32 v34, a140
    v_accvgpr_read_b32 v31, a141
    v_mfma_f32_16x16x32_bf16 v[136:139], v[52:55], v[84:87], v[136:139]
    s_add_u32 s72, s71, 1024
    v_cvt_pk_bf16_f32 v34, v34, v31
    v_accvgpr_read_b32 v35, a142
    v_mfma_f32_16x16x32_bf16 v[140:143], v[48:51], v[88:91], 0
    s_add_u32 m0, s68, 8192
    ds_read_b64_tr_b16 v[48:49], v17 offset:0
    ds_read_b64_tr_b16 v[50:51], v17 offset:1024
    v_mfma_f32_16x16x32_bf16 v[140:143], v[52:55], v[92:95], v[140:143]
    buffer_load_dwordx4 v6, s[20:23], s66 offen lds
    v_mfma_f32_16x16x32_bf16 v[144:147], v[56:59], v[64:67], 0
    ds_read_b64_tr_b16 v[52:53], v17 offset:8192
    ds_read_b64_tr_b16 v[54:55], v17 offset:9216
    v_mfma_f32_16x16x32_bf16 v[144:147], v[60:63], v[68:71], v[144:147]
    v_add_u32 v17, 0x10000, v17
    v_accvgpr_read_b32 v31, a143
    v_mfma_f32_16x16x32_bf16 v[148:151], v[56:59], v[72:75], 0
    ds_read_b128 a[140:143], v23 offset:32768
    v_add_u32 v23, 0xffff0000, v23
    v_mfma_f32_16x16x32_bf16 v[148:151], v[60:63], v[76:79], v[148:151]
    v_cvt_pk_bf16_f32 v35, v35, v31
    v_accvgpr_write_b32 a52, v216
    v_mfma_f32_16x16x32_bf16 v[152:155], v[56:59], v[80:83], 0
    v_add_u32 v25, 0x10000, v25
    v_accvgpr_write_b32 a53, v217
    v_mfma_f32_16x16x32_bf16 v[152:155], v[60:63], v[84:87], v[152:155]
    ds_read_b128 v[100:103], v25 offset:16384
    v_accvgpr_write_b32 a54, v218
    v_mfma_f32_16x16x32_bf16 v[156:159], v[56:59], v[88:91], 0
    s_add_u32 m0, s69, 16384
    ds_read_b64_tr_b16 v[56:57], v18 offset:0
    ds_read_b64_tr_b16 v[58:59], v18 offset:1024
    v_mfma_f32_16x16x32_bf16 v[156:159], v[60:63], v[92:95], v[156:159]
    s_xor_b32 s65, s65, 24576
    buffer_load_dwordx4 v10, s[20:23], s64 offen lds
    s_waitcnt lgkmcnt(3)
    v_mfma_f32_16x16x32_bf16 v[160:163], v[40:43], v[64:67], 0
    s_xor_b32 s66, s66, 384
    ds_read_b64_tr_b16 v[60:61], v18 offset:8192
    ds_read_b64_tr_b16 v[62:63], v18 offset:9216
    v_mfma_f32_16x16x32_bf16 v[160:163], v[44:47], v[68:71], v[160:163]
    v_add_u32 v18, 0x10000, v18
    v_accvgpr_write_b32 a55, v219
    v_mfma_f32_16x16x32_bf16 v[164:167], v[40:43], v[72:75], 0
    buffer_store_dwordx4 v[32:35], v1, s[36:39], s72 offen sc1
    v_mfma_f32_16x16x32_bf16 v[164:167], v[44:47], v[76:79], v[164:167]
    v_cvt_pk_bf16_f32 v220, v220, v221
    v_cvt_pk_bf16_f32 v221, v222, v223
    v_mfma_f32_16x16x32_bf16 v[168:171], v[40:43], v[80:83], 0
    v_cvt_pk_bf16_f32 v222, v252, v253
    v_cvt_pk_bf16_f32 v223, v254, v255
    v_mfma_f32_16x16x32_bf16 v[168:171], v[44:47], v[84:87], v[168:171]
    v_accvgpr_write_b32 a60, v220
    v_accvgpr_write_b32 a61, v221
    v_mfma_f32_16x16x32_bf16 v[172:175], v[40:43], v[88:91], 0
    ds_read_b64_tr_b16 v[40:41], v19 offset:0
    ds_read_b64_tr_b16 v[42:43], v19 offset:1024
    v_mfma_f32_16x16x32_bf16 v[172:175], v[44:47], v[92:95], v[172:175]
    ds_read_b64_tr_b16 v[44:45], v19 offset:8192
    ds_read_b64_tr_b16 v[46:47], v19 offset:9216
    v_mfma_f32_16x16x32_bf16 v[176:179], v[48:51], v[64:67], 0
    buffer_load_dwordx4 v11, s[20:23], s64 offen offset:1024 lds
    v_mfma_f32_16x16x32_bf16 v[176:179], v[52:55], v[68:71], v[176:179]
    ds_read_b128 v[104:107], v24 offset:24576
    v_add_u32 v19, 0x10000, v19
    v_mfma_f32_16x16x32_bf16 v[180:183], v[48:51], v[72:75], 0
    v_accvgpr_write_b32 a62, v222
    v_accvgpr_write_b32 a63, v223
    v_mfma_f32_16x16x32_bf16 v[180:183], v[52:55], v[76:79], v[180:183]
    v_accvgpr_write_b32 a0, 0
    v_accvgpr_write_b32 a1, 0
    v_mfma_f32_16x16x32_bf16 v[184:187], v[48:51], v[80:83], 0
    v_accvgpr_write_b32 a2, 0
    v_accvgpr_write_b32 a3, 0
    v_mfma_f32_16x16x32_bf16 v[184:187], v[52:55], v[84:87], v[184:187]
    v_accvgpr_write_b32 a8, 0
    v_accvgpr_write_b32 a9, 0
    v_mfma_f32_16x16x32_bf16 v[188:191], v[48:51], v[88:91], 0
    s_add_u32 s72, s70, 36864
    ds_read_b64_tr_b16 v[48:49], v20 offset:0
    ds_read_b64_tr_b16 v[50:51], v20 offset:1024
    v_mfma_f32_16x16x32_bf16 v[188:191], v[52:55], v[92:95], v[188:191]
    s_waitcnt lgkmcnt(2)
    ds_read_b64_tr_b16 v[52:53], v20 offset:8192
    ds_read_b64_tr_b16 v[54:55], v20 offset:9216
    v_mfma_f32_16x16x32_bf16 v[192:195], v[56:59], v[64:67], 0
    buffer_load_dwordx4 v12, s[20:23], s64 offen offset:2048 lds
    v_mfma_f32_16x16x32_bf16 v[192:195], v[60:63], v[68:71], v[192:195]
    v_add_u32 v20, 0x10000, v20
    v_accvgpr_write_b32 a10, 0
    v_mfma_f32_16x16x32_bf16 v[196:199], v[56:59], v[72:75], 0
    buffer_store_dwordx4 a[40:43], v1, s[36:39], s72 offen sc1
    v_mfma_f32_16x16x32_bf16 v[196:199], v[60:63], v[76:79], v[196:199]
    ds_read_b128 v[108:111], v25 offset:24576
    v_accvgpr_write_b32 a11, 0
    v_mfma_f32_16x16x32_bf16 v[200:203], v[56:59], v[80:83], 0
    v_accvgpr_write_b32 a16, 0
    v_accvgpr_write_b32 a17, 0
    v_mfma_f32_16x16x32_bf16 v[200:203], v[60:63], v[84:87], v[200:203]
    v_accvgpr_write_b32 a18, 0
    v_accvgpr_write_b32 a19, 0
    v_mfma_f32_16x16x32_bf16 v[204:207], v[56:59], v[88:91], 0
    ds_read_b64_tr_b16 v[56:57], v21 offset:0
    ds_read_b64_tr_b16 v[58:59], v21 offset:1024
    v_mfma_f32_16x16x32_bf16 v[204:207], v[60:63], v[92:95], v[204:207]
    ds_read_b64_tr_b16 v[60:61], v21 offset:8192
    ds_read_b64_tr_b16 v[62:63], v21 offset:9216
    v_mfma_f32_16x16x32_bf16 v[208:211], v[40:43], v[64:67], 0
    v_add_u32 v21, 0x10000, v21
    v_accvgpr_write_b32 a24, 0
    v_mfma_f32_16x16x32_bf16 v[208:211], v[44:47], v[68:71], v[208:211]
    buffer_load_dwordx4 v13, s[20:23], s64 offen offset:3072 lds
    v_mfma_f32_16x16x32_bf16 v[212:215], v[40:43], v[72:75], 0
    v_accvgpr_write_b32 a25, 0
    v_accvgpr_write_b32 a26, 0
    v_mfma_f32_16x16x32_bf16 v[212:215], v[44:47], v[76:79], v[212:215]
    v_accvgpr_write_b32 a27, 0
    v_accvgpr_write_b32 a32, 0
    v_mfma_f32_16x16x32_bf16 v[216:219], v[40:43], v[80:83], 0
    v_accvgpr_write_b32 a33, 0
    v_accvgpr_write_b32 a34, 0
    v_mfma_f32_16x16x32_bf16 v[216:219], v[44:47], v[84:87], v[216:219]
    v_accvgpr_write_b32 a35, 0
    v_accvgpr_write_b32 a40, 0
    v_mfma_f32_16x16x32_bf16 v[220:223], v[40:43], v[88:91], 0
    ds_read_b64_tr_b16 v[40:41], v26 offset:32768
    ds_read_b64_tr_b16 v[42:43], v26 offset:33280
    v_mfma_f32_16x16x32_bf16 v[220:223], v[44:47], v[92:95], v[220:223]
    s_waitcnt lgkmcnt(2)
    ds_read_b64_tr_b16 v[44:45], v26 offset:36864
    ds_read_b64_tr_b16 v[46:47], v26 offset:37376
    v_mfma_f32_16x16x32_bf16 v[224:227], v[48:51], v[64:67], 0
    v_add_u32 v26, 0xffff0000, v26
    v_accvgpr_write_b32 a41, 0
    v_mfma_f32_16x16x32_bf16 v[224:227], v[52:55], v[68:71], v[224:227]
    s_xor_b32 s64, s64, 128
    v_accvgpr_write_b32 a42, 0
    v_accvgpr_write_b32 a43, 0
    v_mfma_f32_16x16x32_bf16 v[228:231], v[48:51], v[72:75], 0
    v_mfma_f32_16x16x32_bf16 v[228:231], v[52:55], v[76:79], v[228:231]
    v_mfma_f32_16x16x32_bf16 v[232:235], v[48:51], v[80:83], 0
    v_mfma_f32_16x16x32_bf16 v[232:235], v[52:55], v[84:87], v[232:235]
    s_add_u32 m0, s69, 32768
    v_mfma_f32_16x16x32_bf16 v[236:239], v[48:51], v[88:91], 0
    buffer_load_dwordx4 v2, s[24:27], s60 offen lds
    v_mfma_f32_16x16x32_bf16 v[236:239], v[52:55], v[92:95], v[236:239]
    s_add_u32 s72, s70, 40960
    ds_read_b64_tr_b16 v[48:49], v27 offset:32768
    ds_read_b64_tr_b16 v[50:51], v27 offset:33280
    v_mfma_f32_16x16x32_bf16 v[240:243], v[56:59], v[64:67], 0
    ds_read_b64_tr_b16 v[52:53], v27 offset:36864
    ds_read_b64_tr_b16 v[54:55], v27 offset:37376
    v_mfma_f32_16x16x32_bf16 v[240:243], v[60:63], v[68:71], v[240:243]
    buffer_store_dwordx4 a[48:51], v1, s[36:39], s72 offen sc1
    v_mfma_f32_16x16x32_bf16 v[244:247], v[56:59], v[72:75], 0
    buffer_load_dwordx4 v3, s[24:27], s60 offen offset:1024 lds
    v_mfma_f32_16x16x32_bf16 v[244:247], v[60:63], v[76:79], v[244:247]
    v_add_u32 v27, 0xffff0000, v27
    v_accvgpr_write_b32 a48, 0
    v_mfma_f32_16x16x32_bf16 v[248:251], v[56:59], v[80:83], 0
    v_accvgpr_write_b32 a49, 0
    v_accvgpr_write_b32 a50, 0
    v_mfma_f32_16x16x32_bf16 v[248:251], v[60:63], v[84:87], v[248:251]
    v_accvgpr_write_b32 a51, 0
    v_mfma_f32_16x16x32_bf16 v[252:255], v[56:59], v[88:91], 0
    buffer_load_dwordx4 v4, s[24:27], s60 offen offset:2048 lds
    v_mfma_f32_16x16x32_bf16 v[252:255], v[60:63], v[92:95], v[252:255]
    s_waitcnt lgkmcnt(0)
    ds_read_b64_tr_b16 v[56:57], v28 offset:32768
    ds_read_b64_tr_b16 v[58:59], v28 offset:33280
    v_mfma_f32_16x16x32_bf16 a[64:67], v[40:43], v[64:67], 0
    ds_read_b64_tr_b16 v[60:61], v28 offset:36864
    ds_read_b64_tr_b16 v[62:63], v28 offset:37376
    v_mfma_f32_16x16x32_bf16 a[64:67], v[44:47], v[68:71], a[64:67]
    v_add_u32 v28, 0xffff0000, v28
    v_mfma_f32_16x16x32_bf16 a[68:71], v[40:43], v[72:75], 0
    buffer_load_dwordx4 v5, s[24:27], s60 offen offset:3072 lds
    v_mfma_f32_16x16x32_bf16 a[68:71], v[44:47], v[76:79], a[68:71]
    ds_read_b128 v[112:115], v24 offset:49152
    v_mfma_f32_16x16x32_bf16 a[72:75], v[40:43], v[80:83], 0
    v_mfma_f32_16x16x32_bf16 a[72:75], v[44:47], v[84:87], a[72:75]
    s_add_u32 m0, s69, 49152
    v_mfma_f32_16x16x32_bf16 a[76:79], v[40:43], v[88:91], 0
    s_xor_b32 s60, s60, 524288
    buffer_load_dwordx4 v10, s[20:23], s63 offen lds
    v_mfma_f32_16x16x32_bf16 a[76:79], v[44:47], v[92:95], a[76:79]
    ds_read_b128 v[116:119], v25 offset:49152
    v_mfma_f32_16x16x32_bf16 a[128:131], v[40:43], a[136:139], 0
    ds_read_b64_tr_b16 v[40:41], v29 offset:32768
    ds_read_b64_tr_b16 v[42:43], v29 offset:33280
    v_mfma_f32_16x16x32_bf16 a[128:131], v[44:47], a[140:143], a[128:131]
    ds_read_b64_tr_b16 v[44:45], v29 offset:36864
    ds_read_b64_tr_b16 v[46:47], v29 offset:37376
    v_mfma_f32_16x16x32_bf16 a[80:83], v[48:51], v[64:67], 0
    buffer_load_dwordx4 v11, s[20:23], s63 offen offset:1024 lds
    v_mfma_f32_16x16x32_bf16 a[80:83], v[52:55], v[68:71], a[80:83]
    ds_read_b128 v[120:123], v24 offset:57344
    v_add_u32 v29, 0xffff0000, v29
    v_mfma_f32_16x16x32_bf16 a[84:87], v[48:51], v[72:75], 0
    v_mfma_f32_16x16x32_bf16 a[84:87], v[52:55], v[76:79], a[84:87]
    v_mfma_f32_16x16x32_bf16 a[88:91], v[48:51], v[80:83], 0
    buffer_load_dwordx4 v12, s[20:23], s63 offen offset:2048 lds
    v_mfma_f32_16x16x32_bf16 a[88:91], v[52:55], v[84:87], a[88:91]
    ds_read_b128 v[124:127], v25 offset:57344
    v_mfma_f32_16x16x32_bf16 a[92:95], v[48:51], v[88:91], 0
    s_add_u32 s72, s70, 45056
    v_mfma_f32_16x16x32_bf16 a[92:95], v[52:55], v[92:95], a[92:95]
    v_mfma_f32_16x16x32_bf16 a[132:135], v[48:51], a[136:139], 0
    buffer_load_dwordx4 v13, s[20:23], s63 offen offset:3072 lds
    v_mfma_f32_16x16x32_bf16 a[132:135], v[52:55], a[140:143], a[132:135]
    s_waitcnt lgkmcnt(1)
    v_mfma_f32_16x16x32_bf16 a[96:99], v[56:59], v[64:67], 0
    v_mfma_f32_16x16x32_bf16 a[96:99], v[60:63], v[68:71], a[96:99]
    s_xor_b32 s63, s63, 896
    v_mfma_f32_16x16x32_bf16 a[100:103], v[56:59], v[72:75], 0
    buffer_store_dwordx4 a[56:59], v1, s[36:39], s72 offen sc1
    v_mfma_f32_16x16x32_bf16 a[100:103], v[60:63], v[76:79], a[100:103]
    v_mfma_f32_16x16x32_bf16 a[104:107], v[56:59], v[80:83], 0
    v_accvgpr_write_b32 a56, 0
    v_accvgpr_write_b32 a57, 0
    v_mfma_f32_16x16x32_bf16 a[104:107], v[60:63], v[84:87], a[104:107]
    s_waitcnt vmcnt(10) lgkmcnt(0)
    s_barrier
    ds_read_b64_tr_b16 v[48:49], v14 offset:0
    v_mfma_f32_16x16x32_bf16 a[108:111], v[56:59], v[88:91], 0
    s_add_u32 m0, s67, 65536
    ds_read_b64_tr_b16 v[50:51], v14 offset:1024
    ds_read_b64_tr_b16 v[52:53], v14 offset:8192
    v_mfma_f32_16x16x32_bf16 a[108:111], v[60:63], v[92:95], a[108:111]
    buffer_load_dwordx4 v1, s[28:31], s65 offen sc1 lds
    v_mfma_f32_16x16x32_bf16 a[112:115], v[40:43], v[64:67], 0
    ds_read_b64_tr_b16 v[54:55], v14 offset:9216
    ds_read_b64_tr_b16 v[56:57], v15 offset:0
    v_mfma_f32_16x16x32_bf16 a[112:115], v[44:47], v[68:71], a[112:115]
    ds_read_b64_tr_b16 v[58:59], v15 offset:1024
    ds_read_b64_tr_b16 v[60:61], v15 offset:8192
    v_mfma_f32_16x16x32_bf16 a[116:119], v[40:43], v[72:75], 0
    ds_read_b64_tr_b16 v[62:63], v15 offset:9216
    ds_read_b128 a[136:139], v22 offset:0
    v_mfma_f32_16x16x32_bf16 a[116:119], v[44:47], v[76:79], a[116:119]
    ds_read_b128 a[140:143], v23 offset:0
    v_add_u32 v14, 0xfffe0000, v14
    v_mfma_f32_16x16x32_bf16 a[120:123], v[40:43], v[80:83], 0
    v_add_u32 v15, 0xfffe0000, v15
    v_add_u32 v22, 0x10000, v22
    v_mfma_f32_16x16x32_bf16 a[120:123], v[44:47], v[84:87], a[120:123]
    v_add_u32 v23, 0x10000, v23
    v_accvgpr_write_b32 a58, 0
    v_mfma_f32_16x16x32_bf16 a[124:127], v[40:43], v[88:91], 0
    buffer_load_dwordx4 v1, s[28:31], s65 offen offset:1024 sc1 lds
    v_mfma_f32_16x16x32_bf16 a[124:127], v[44:47], v[92:95], a[124:127]
    s_waitcnt lgkmcnt(1)
    ds_read_b64_tr_b16 v[40:41], v16 offset:0
    ds_read_b64_tr_b16 v[42:43], v16 offset:1024
    v_mfma_f32_16x16x32_bf16 v[128:131], v[48:51], v[96:99], v[128:131]
    ds_read_b64_tr_b16 v[44:45], v16 offset:8192
    ds_read_b64_tr_b16 v[46:47], v16 offset:9216
    v_mfma_f32_16x16x32_bf16 v[128:131], v[52:55], v[100:103], v[128:131]
    v_add_u32 v24, 0x10000, v24
    v_add_u32 v16, 0xfffe0000, v16
    v_mfma_f32_16x16x32_bf16 v[132:135], v[48:51], v[104:107], v[132:135]
    ds_read_b128 v[64:67], v24 offset:16384
    v_accvgpr_write_b32 a59, 0
    v_mfma_f32_16x16x32_bf16 v[132:135], v[52:55], v[108:111], v[132:135]
    v_mfma_f32_16x16x32_bf16 v[136:139], v[48:51], v[112:115], v[136:139]
    v_mfma_f32_16x16x32_bf16 v[136:139], v[52:55], v[116:119], v[136:139]
    s_add_u32 s72, s70, 1024
    v_mfma_f32_16x16x32_bf16 v[140:143], v[48:51], v[120:123], v[140:143]
    s_add_u32 m0, s68, 73728
    ds_read_b64_tr_b16 v[48:49], v17 offset:0
    ds_read_b64_tr_b16 v[50:51], v17 offset:1024
    v_mfma_f32_16x16x32_bf16 v[140:143], v[52:55], v[124:127], v[140:143]
    buffer_load_dwordx4 v6, s[20:23], s66 offen lds
    v_mfma_f32_16x16x32_bf16 v[144:147], v[56:59], v[96:99], v[144:147]
    ds_read_b64_tr_b16 v[52:53], v17 offset:8192
    ds_read_b64_tr_b16 v[54:55], v17 offset:9216
    v_mfma_f32_16x16x32_bf16 v[144:147], v[60:63], v[100:103], v[144:147]
    buffer_store_dwordx4 a[4:7], v1, s[36:39], s72 offen sc1
    v_mfma_f32_16x16x32_bf16 v[148:151], v[56:59], v[104:107], v[148:151]
    v_add_u32 v17, 0xfffe0000, v17
    v_accvgpr_write_b32 a4, 0
    v_mfma_f32_16x16x32_bf16 v[148:151], v[60:63], v[108:111], v[148:151]
    v_accvgpr_write_b32 a5, 0
    v_accvgpr_write_b32 a6, 0
    v_mfma_f32_16x16x32_bf16 v[152:155], v[56:59], v[112:115], v[152:155]
    v_add_u32 v25, 0x10000, v25
    v_accvgpr_write_b32 a7, 0
    v_mfma_f32_16x16x32_bf16 v[152:155], v[60:63], v[116:119], v[152:155]
    ds_read_b128 v[68:71], v25 offset:16384
    v_mfma_f32_16x16x32_bf16 v[156:159], v[56:59], v[120:123], v[156:159]
    s_add_u32 m0, s69, 81920
    ds_read_b64_tr_b16 v[56:57], v18 offset:0
    ds_read_b64_tr_b16 v[58:59], v18 offset:1024
    v_mfma_f32_16x16x32_bf16 v[156:159], v[60:63], v[124:127], v[156:159]
    s_xor_b32 s65, s65, 8192
    buffer_load_dwordx4 v10, s[20:23], s64 offen lds
    s_waitcnt lgkmcnt(3)
    v_mfma_f32_16x16x32_bf16 v[160:163], v[40:43], v[96:99], v[160:163]
    s_xor_b32 s66, s66, 128
    ds_read_b64_tr_b16 v[60:61], v18 offset:8192
    ds_read_b64_tr_b16 v[62:63], v18 offset:9216
    v_mfma_f32_16x16x32_bf16 v[160:163], v[44:47], v[100:103], v[160:163]
    v_add_u32 v18, 0xfffe0000, v18
    v_mfma_f32_16x16x32_bf16 v[164:167], v[40:43], v[104:107], v[164:167]
    v_mfma_f32_16x16x32_bf16 v[164:167], v[44:47], v[108:111], v[164:167]
    v_mfma_f32_16x16x32_bf16 v[168:171], v[40:43], v[112:115], v[168:171]
    v_mfma_f32_16x16x32_bf16 v[168:171], v[44:47], v[116:119], v[168:171]
    v_mfma_f32_16x16x32_bf16 v[172:175], v[40:43], v[120:123], v[172:175]
    ds_read_b64_tr_b16 v[40:41], v19 offset:0
    ds_read_b64_tr_b16 v[42:43], v19 offset:1024
    v_mfma_f32_16x16x32_bf16 v[172:175], v[44:47], v[124:127], v[172:175]
    ds_read_b64_tr_b16 v[44:45], v19 offset:8192
    ds_read_b64_tr_b16 v[46:47], v19 offset:9216
    v_mfma_f32_16x16x32_bf16 v[176:179], v[48:51], v[96:99], v[176:179]
    buffer_load_dwordx4 v11, s[20:23], s64 offen offset:1024 lds
    v_mfma_f32_16x16x32_bf16 v[176:179], v[52:55], v[100:103], v[176:179]
    ds_read_b128 v[72:75], v24 offset:24576
    v_add_u32 v19, 0xfffe0000, v19
    v_mfma_f32_16x16x32_bf16 v[180:183], v[48:51], v[104:107], v[180:183]
    v_mfma_f32_16x16x32_bf16 v[180:183], v[52:55], v[108:111], v[180:183]
    v_mfma_f32_16x16x32_bf16 v[184:187], v[48:51], v[112:115], v[184:187]
    v_mfma_f32_16x16x32_bf16 v[184:187], v[52:55], v[116:119], v[184:187]
    v_mfma_f32_16x16x32_bf16 v[188:191], v[48:51], v[120:123], v[188:191]
    s_add_u32 s72, s70, 5120
    ds_read_b64_tr_b16 v[48:49], v20 offset:0
    ds_read_b64_tr_b16 v[50:51], v20 offset:1024
    v_mfma_f32_16x16x32_bf16 v[188:191], v[52:55], v[124:127], v[188:191]
    s_waitcnt lgkmcnt(2)
    ds_read_b64_tr_b16 v[52:53], v20 offset:8192
    ds_read_b64_tr_b16 v[54:55], v20 offset:9216
    v_mfma_f32_16x16x32_bf16 v[192:195], v[56:59], v[96:99], v[192:195]
    buffer_load_dwordx4 v12, s[20:23], s64 offen offset:2048 lds
    v_mfma_f32_16x16x32_bf16 v[192:195], v[60:63], v[100:103], v[192:195]
    buffer_store_dwordx4 a[12:15], v1, s[36:39], s72 offen sc1
    v_mfma_f32_16x16x32_bf16 v[196:199], v[56:59], v[104:107], v[196:199]
    v_add_u32 v20, 0xfffe0000, v20
    v_accvgpr_write_b32 a12, 0
    v_mfma_f32_16x16x32_bf16 v[196:199], v[60:63], v[108:111], v[196:199]
    ds_read_b128 v[76:79], v25 offset:24576
    v_accvgpr_write_b32 a13, 0
    v_mfma_f32_16x16x32_bf16 v[200:203], v[56:59], v[112:115], v[200:203]
    v_accvgpr_write_b32 a14, 0
    v_accvgpr_write_b32 a15, 0
    v_mfma_f32_16x16x32_bf16 v[200:203], v[60:63], v[116:119], v[200:203]
    v_mfma_f32_16x16x32_bf16 v[204:207], v[56:59], v[120:123], v[204:207]
    ds_read_b64_tr_b16 v[56:57], v21 offset:0
    ds_read_b64_tr_b16 v[58:59], v21 offset:1024
    v_mfma_f32_16x16x32_bf16 v[204:207], v[60:63], v[124:127], v[204:207]
    ds_read_b64_tr_b16 v[60:61], v21 offset:8192
    ds_read_b64_tr_b16 v[62:63], v21 offset:9216
    v_mfma_f32_16x16x32_bf16 v[208:211], v[40:43], v[96:99], v[208:211]
    v_add_u32 v21, 0xfffe0000, v21
    v_mfma_f32_16x16x32_bf16 v[208:211], v[44:47], v[100:103], v[208:211]
    buffer_load_dwordx4 v13, s[20:23], s64 offen offset:3072 lds
    v_mfma_f32_16x16x32_bf16 v[212:215], v[40:43], v[104:107], v[212:215]
    v_mfma_f32_16x16x32_bf16 v[212:215], v[44:47], v[108:111], v[212:215]
    v_mfma_f32_16x16x32_bf16 v[216:219], v[40:43], v[112:115], v[216:219]
    v_mfma_f32_16x16x32_bf16 v[216:219], v[44:47], v[116:119], v[216:219]
    v_mfma_f32_16x16x32_bf16 v[220:223], v[40:43], v[120:123], v[220:223]
    ds_read_b64_tr_b16 v[40:41], v26 offset:0
    ds_read_b64_tr_b16 v[42:43], v26 offset:512
    v_mfma_f32_16x16x32_bf16 v[220:223], v[44:47], v[124:127], v[220:223]
    s_waitcnt lgkmcnt(2)
    ds_read_b64_tr_b16 v[44:45], v26 offset:4096
    ds_read_b64_tr_b16 v[46:47], v26 offset:4608
    v_mfma_f32_16x16x32_bf16 v[224:227], v[48:51], v[96:99], v[224:227]
    v_add_u32 v26, 0x10000, v26
    v_mfma_f32_16x16x32_bf16 v[224:227], v[52:55], v[100:103], v[224:227]
    s_xor_b32 s64, s64, 896
    v_mfma_f32_16x16x32_bf16 v[228:231], v[48:51], v[104:107], v[228:231]
    v_mfma_f32_16x16x32_bf16 v[228:231], v[52:55], v[108:111], v[228:231]
    v_mfma_f32_16x16x32_bf16 v[232:235], v[48:51], v[112:115], v[232:235]
    v_mfma_f32_16x16x32_bf16 v[232:235], v[52:55], v[116:119], v[232:235]
    s_add_u32 m0, s69, 98304
    v_mfma_f32_16x16x32_bf16 v[236:239], v[48:51], v[120:123], v[236:239]
    buffer_load_dwordx4 v2, s[24:27], s60 offen lds
    v_mfma_f32_16x16x32_bf16 v[236:239], v[52:55], v[124:127], v[236:239]
    s_add_u32 s72, s70, 9216
    ds_read_b64_tr_b16 v[48:49], v27 offset:0
    ds_read_b64_tr_b16 v[50:51], v27 offset:512
    v_mfma_f32_16x16x32_bf16 v[240:243], v[56:59], v[96:99], v[240:243]
    ds_read_b64_tr_b16 v[52:53], v27 offset:4096
    ds_read_b64_tr_b16 v[54:55], v27 offset:4608
    v_mfma_f32_16x16x32_bf16 v[240:243], v[60:63], v[100:103], v[240:243]
    buffer_store_dwordx4 a[20:23], v1, s[36:39], s72 offen sc1
    v_mfma_f32_16x16x32_bf16 v[244:247], v[56:59], v[104:107], v[244:247]
    buffer_load_dwordx4 v3, s[24:27], s60 offen offset:1024 lds
    v_mfma_f32_16x16x32_bf16 v[244:247], v[60:63], v[108:111], v[244:247]
    v_add_u32 v27, 0x10000, v27
    v_accvgpr_write_b32 a20, 0
    v_mfma_f32_16x16x32_bf16 v[248:251], v[56:59], v[112:115], v[248:251]
    v_accvgpr_write_b32 a21, 0
    v_accvgpr_write_b32 a22, 0
    v_mfma_f32_16x16x32_bf16 v[248:251], v[60:63], v[116:119], v[248:251]
    v_accvgpr_write_b32 a23, 0
    v_mfma_f32_16x16x32_bf16 v[252:255], v[56:59], v[120:123], v[252:255]
    buffer_load_dwordx4 v4, s[24:27], s60 offen offset:2048 lds
    v_mfma_f32_16x16x32_bf16 v[252:255], v[60:63], v[124:127], v[252:255]
    s_waitcnt lgkmcnt(0)
    ds_read_b64_tr_b16 v[56:57], v28 offset:0
    ds_read_b64_tr_b16 v[58:59], v28 offset:512
    v_mfma_f32_16x16x32_bf16 a[64:67], v[40:43], v[96:99], a[64:67]
    ds_read_b64_tr_b16 v[60:61], v28 offset:4096
    ds_read_b64_tr_b16 v[62:63], v28 offset:4608
    v_mfma_f32_16x16x32_bf16 a[64:67], v[44:47], v[100:103], a[64:67]
    v_add_u32 v24, 0xfffe0000, v24
    v_add_u32 v28, 0x10000, v28
    v_mfma_f32_16x16x32_bf16 a[68:71], v[40:43], v[104:107], a[68:71]
    buffer_load_dwordx4 v5, s[24:27], s60 offen offset:3072 lds
    v_mfma_f32_16x16x32_bf16 a[68:71], v[44:47], v[108:111], a[68:71]
    ds_read_b128 v[80:83], v24 offset:16384
    v_mfma_f32_16x16x32_bf16 a[72:75], v[40:43], v[112:115], a[72:75]
    v_mfma_f32_16x16x32_bf16 a[72:75], v[44:47], v[116:119], a[72:75]
    s_add_u32 m0, s69, 114688
    v_add_u32 v25, 0xfffe0000, v25
    v_mfma_f32_16x16x32_bf16 a[76:79], v[40:43], v[120:123], a[76:79]
    s_xor_b32 s60, s60, 3670016
    buffer_load_dwordx4 v10, s[20:23], s63 offen lds
    v_mfma_f32_16x16x32_bf16 a[76:79], v[44:47], v[124:127], a[76:79]
    ds_read_b128 v[84:87], v25 offset:16384
    v_mfma_f32_16x16x32_bf16 a[128:131], v[40:43], a[136:139], a[128:131]
    ds_read_b64_tr_b16 v[40:41], v29 offset:0
    ds_read_b64_tr_b16 v[42:43], v29 offset:512
    v_mfma_f32_16x16x32_bf16 a[128:131], v[44:47], a[140:143], a[128:131]
    ds_read_b64_tr_b16 v[44:45], v29 offset:4096
    ds_read_b64_tr_b16 v[46:47], v29 offset:4608
    v_mfma_f32_16x16x32_bf16 a[80:83], v[48:51], v[96:99], a[80:83]
    buffer_load_dwordx4 v11, s[20:23], s63 offen offset:1024 lds
    v_mfma_f32_16x16x32_bf16 a[80:83], v[52:55], v[100:103], a[80:83]
    ds_read_b128 v[88:91], v24 offset:24576
    v_add_u32 v29, 0x10000, v29
    v_mfma_f32_16x16x32_bf16 a[84:87], v[48:51], v[104:107], a[84:87]
    v_mfma_f32_16x16x32_bf16 a[84:87], v[52:55], v[108:111], a[84:87]
    v_mfma_f32_16x16x32_bf16 a[88:91], v[48:51], v[112:115], a[88:91]
    buffer_load_dwordx4 v12, s[20:23], s63 offen offset:2048 lds
    v_mfma_f32_16x16x32_bf16 a[88:91], v[52:55], v[116:119], a[88:91]
    ds_read_b128 v[92:95], v25 offset:24576
    v_mfma_f32_16x16x32_bf16 a[92:95], v[48:51], v[120:123], a[92:95]
    s_add_u32 s72, s70, 13312
    v_mfma_f32_16x16x32_bf16 a[92:95], v[52:55], v[124:127], a[92:95]
    v_mfma_f32_16x16x32_bf16 a[132:135], v[48:51], a[136:139], a[132:135]
    buffer_load_dwordx4 v13, s[20:23], s63 offen offset:3072 lds
    v_mfma_f32_16x16x32_bf16 a[132:135], v[52:55], a[140:143], a[132:135]
    s_waitcnt lgkmcnt(1)
    v_mfma_f32_16x16x32_bf16 a[96:99], v[56:59], v[96:99], a[96:99]
    v_mfma_f32_16x16x32_bf16 a[96:99], v[60:63], v[100:103], a[96:99]
    s_xor_b32 s63, s63, 128
    v_mfma_f32_16x16x32_bf16 a[100:103], v[56:59], v[104:107], a[100:103]
    buffer_store_dwordx4 a[28:31], v1, s[36:39], s72 offen sc1
    v_mfma_f32_16x16x32_bf16 a[100:103], v[60:63], v[108:111], a[100:103]
    v_mfma_f32_16x16x32_bf16 a[104:107], v[56:59], v[112:115], a[104:107]
    v_accvgpr_write_b32 a28, 0
    v_accvgpr_write_b32 a29, 0
    v_mfma_f32_16x16x32_bf16 a[104:107], v[60:63], v[116:119], a[104:107]
    s_waitcnt vmcnt(10) lgkmcnt(0)
    s_barrier
    ds_read_b64_tr_b16 v[48:49], v14 offset:32768
    v_mfma_f32_16x16x32_bf16 a[108:111], v[56:59], v[120:123], a[108:111]
    s_add_u32 m0, s67, 131072
    ds_read_b64_tr_b16 v[50:51], v14 offset:33792
    ds_read_b64_tr_b16 v[52:53], v14 offset:40960
    v_mfma_f32_16x16x32_bf16 a[108:111], v[60:63], v[124:127], a[108:111]
    buffer_load_dwordx4 v1, s[28:31], s65 offen sc1 lds
    v_mfma_f32_16x16x32_bf16 a[112:115], v[40:43], v[96:99], a[112:115]
    ds_read_b64_tr_b16 v[54:55], v14 offset:41984
    ds_read_b64_tr_b16 v[56:57], v15 offset:32768
    v_mfma_f32_16x16x32_bf16 a[112:115], v[44:47], v[100:103], a[112:115]
    ds_read_b64_tr_b16 v[58:59], v15 offset:33792
    ds_read_b64_tr_b16 v[60:61], v15 offset:40960
    v_mfma_f32_16x16x32_bf16 a[116:119], v[40:43], v[104:107], a[116:119]
    ds_read_b64_tr_b16 v[62:63], v15 offset:41984
    ds_read_b128 a[136:139], v22 offset:0
    v_mfma_f32_16x16x32_bf16 a[116:119], v[44:47], v[108:111], a[116:119]
    ds_read_b128 a[140:143], v23 offset:0
    v_add_u32 v14, 0x10000, v14
    v_mfma_f32_16x16x32_bf16 a[120:123], v[40:43], v[112:115], a[120:123]
    v_add_u32 v15, 0x10000, v15
    v_add_u32 v22, 0x10000, v22
    v_mfma_f32_16x16x32_bf16 a[120:123], v[44:47], v[116:119], a[120:123]
    v_add_u32 v23, 0x10000, v23
    v_accvgpr_write_b32 a30, 0
    v_mfma_f32_16x16x32_bf16 a[124:127], v[40:43], v[120:123], a[124:127]
    buffer_load_dwordx4 v1, s[28:31], s65 offen offset:1024 sc1 lds
    v_mfma_f32_16x16x32_bf16 a[124:127], v[44:47], v[124:127], a[124:127]
    s_waitcnt lgkmcnt(1)
    ds_read_b64_tr_b16 v[40:41], v16 offset:32768
    ds_read_b64_tr_b16 v[42:43], v16 offset:33792
    v_mfma_f32_16x16x32_bf16 v[128:131], v[48:51], v[64:67], v[128:131]
    ds_read_b64_tr_b16 v[44:45], v16 offset:40960
    ds_read_b64_tr_b16 v[46:47], v16 offset:41984
    v_mfma_f32_16x16x32_bf16 v[128:131], v[52:55], v[68:71], v[128:131]
    v_add_u32 v16, 0x10000, v16
    v_accvgpr_write_b32 a31, 0
    v_mfma_f32_16x16x32_bf16 v[132:135], v[48:51], v[72:75], v[132:135]
    ds_read_b128 v[96:99], v24 offset:49152
    v_mfma_f32_16x16x32_bf16 v[132:135], v[52:55], v[76:79], v[132:135]
    v_mfma_f32_16x16x32_bf16 v[136:139], v[48:51], v[80:83], v[136:139]
    v_mfma_f32_16x16x32_bf16 v[136:139], v[52:55], v[84:87], v[136:139]
    s_add_u32 s72, s70, 33792
    v_mfma_f32_16x16x32_bf16 v[140:143], v[48:51], v[88:91], v[140:143]
    s_add_u32 m0, s68, 139264
    ds_read_b64_tr_b16 v[48:49], v17 offset:32768
    ds_read_b64_tr_b16 v[50:51], v17 offset:33792
    v_mfma_f32_16x16x32_bf16 v[140:143], v[52:55], v[92:95], v[140:143]
    buffer_load_dwordx4 v6, s[20:23], s66 offen lds
    v_mfma_f32_16x16x32_bf16 v[144:147], v[56:59], v[64:67], v[144:147]
    ds_read_b64_tr_b16 v[52:53], v17 offset:40960
    ds_read_b64_tr_b16 v[54:55], v17 offset:41984
    v_mfma_f32_16x16x32_bf16 v[144:147], v[60:63], v[68:71], v[144:147]
    buffer_store_dwordx4 a[36:39], v1, s[36:39], s72 offen sc1
    v_mfma_f32_16x16x32_bf16 v[148:151], v[56:59], v[72:75], v[148:151]
    v_add_u32 v17, 0x10000, v17
    v_accvgpr_write_b32 a36, 0
    v_mfma_f32_16x16x32_bf16 v[148:151], v[60:63], v[76:79], v[148:151]
    v_accvgpr_write_b32 a37, 0
    v_accvgpr_write_b32 a38, 0
    v_mfma_f32_16x16x32_bf16 v[152:155], v[56:59], v[80:83], v[152:155]
    v_accvgpr_write_b32 a39, 0
    v_mfma_f32_16x16x32_bf16 v[152:155], v[60:63], v[84:87], v[152:155]
    ds_read_b128 v[100:103], v25 offset:49152
    v_mfma_f32_16x16x32_bf16 v[156:159], v[56:59], v[88:91], v[156:159]
    s_add_u32 m0, s69, 147456
    ds_read_b64_tr_b16 v[56:57], v18 offset:32768
    ds_read_b64_tr_b16 v[58:59], v18 offset:33792
    v_mfma_f32_16x16x32_bf16 v[156:159], v[60:63], v[92:95], v[156:159]
    s_xor_b32 s65, s65, 57344
    buffer_load_dwordx4 v10, s[20:23], s64 offen lds
    s_waitcnt lgkmcnt(3)
    v_mfma_f32_16x16x32_bf16 v[160:163], v[40:43], v[64:67], v[160:163]
    s_xor_b32 s66, s66, 896
    ds_read_b64_tr_b16 v[60:61], v18 offset:40960
    ds_read_b64_tr_b16 v[62:63], v18 offset:41984
    v_mfma_f32_16x16x32_bf16 v[160:163], v[44:47], v[68:71], v[160:163]
    v_add_u32 v18, 0x10000, v18
    v_mfma_f32_16x16x32_bf16 v[164:167], v[40:43], v[72:75], v[164:167]
    v_mfma_f32_16x16x32_bf16 v[164:167], v[44:47], v[76:79], v[164:167]
    v_mfma_f32_16x16x32_bf16 v[168:171], v[40:43], v[80:83], v[168:171]
    v_mfma_f32_16x16x32_bf16 v[168:171], v[44:47], v[84:87], v[168:171]
    v_mfma_f32_16x16x32_bf16 v[172:175], v[40:43], v[88:91], v[172:175]
    ds_read_b64_tr_b16 v[40:41], v19 offset:32768
    ds_read_b64_tr_b16 v[42:43], v19 offset:33792
    v_mfma_f32_16x16x32_bf16 v[172:175], v[44:47], v[92:95], v[172:175]
    ds_read_b64_tr_b16 v[44:45], v19 offset:40960
    ds_read_b64_tr_b16 v[46:47], v19 offset:41984
    v_mfma_f32_16x16x32_bf16 v[176:179], v[48:51], v[64:67], v[176:179]
    buffer_load_dwordx4 v11, s[20:23], s64 offen offset:1024 lds
    v_mfma_f32_16x16x32_bf16 v[176:179], v[52:55], v[68:71], v[176:179]
    ds_read_b128 v[104:107], v24 offset:57344
    v_add_u32 v19, 0x10000, v19
    v_mfma_f32_16x16x32_bf16 v[180:183], v[48:51], v[72:75], v[180:183]
    v_mfma_f32_16x16x32_bf16 v[180:183], v[52:55], v[76:79], v[180:183]
    v_mfma_f32_16x16x32_bf16 v[184:187], v[48:51], v[80:83], v[184:187]
    v_mfma_f32_16x16x32_bf16 v[184:187], v[52:55], v[84:87], v[184:187]
    v_mfma_f32_16x16x32_bf16 v[188:191], v[48:51], v[88:91], v[188:191]
    s_add_u32 s72, s70, 37888
    ds_read_b64_tr_b16 v[48:49], v20 offset:32768
    ds_read_b64_tr_b16 v[50:51], v20 offset:33792
    v_mfma_f32_16x16x32_bf16 v[188:191], v[52:55], v[92:95], v[188:191]
    s_waitcnt lgkmcnt(2)
    ds_read_b64_tr_b16 v[52:53], v20 offset:40960
    ds_read_b64_tr_b16 v[54:55], v20 offset:41984
    v_mfma_f32_16x16x32_bf16 v[192:195], v[56:59], v[64:67], v[192:195]
    buffer_load_dwordx4 v12, s[20:23], s64 offen offset:2048 lds
    v_mfma_f32_16x16x32_bf16 v[192:195], v[60:63], v[68:71], v[192:195]
    buffer_store_dwordx4 a[44:47], v1, s[36:39], s72 offen sc1
    v_mfma_f32_16x16x32_bf16 v[196:199], v[56:59], v[72:75], v[196:199]
    v_add_u32 v20, 0x10000, v20
    v_accvgpr_write_b32 a44, 0
    v_mfma_f32_16x16x32_bf16 v[196:199], v[60:63], v[76:79], v[196:199]
    ds_read_b128 v[108:111], v25 offset:57344
    v_accvgpr_write_b32 a45, 0
    v_mfma_f32_16x16x32_bf16 v[200:203], v[56:59], v[80:83], v[200:203]
    v_accvgpr_write_b32 a46, 0
    v_accvgpr_write_b32 a47, 0
    v_mfma_f32_16x16x32_bf16 v[200:203], v[60:63], v[84:87], v[200:203]
    v_mfma_f32_16x16x32_bf16 v[204:207], v[56:59], v[88:91], v[204:207]
    ds_read_b64_tr_b16 v[56:57], v21 offset:32768
    ds_read_b64_tr_b16 v[58:59], v21 offset:33792
    v_mfma_f32_16x16x32_bf16 v[204:207], v[60:63], v[92:95], v[204:207]
    ds_read_b64_tr_b16 v[60:61], v21 offset:40960
    ds_read_b64_tr_b16 v[62:63], v21 offset:41984
    v_mfma_f32_16x16x32_bf16 v[208:211], v[40:43], v[64:67], v[208:211]
    v_add_u32 v21, 0x10000, v21
    v_mfma_f32_16x16x32_bf16 v[208:211], v[44:47], v[68:71], v[208:211]
    buffer_load_dwordx4 v13, s[20:23], s64 offen offset:3072 lds
    v_mfma_f32_16x16x32_bf16 v[212:215], v[40:43], v[72:75], v[212:215]
    v_mfma_f32_16x16x32_bf16 v[212:215], v[44:47], v[76:79], v[212:215]
    v_mfma_f32_16x16x32_bf16 v[216:219], v[40:43], v[80:83], v[216:219]
    v_mfma_f32_16x16x32_bf16 v[216:219], v[44:47], v[84:87], v[216:219]
    v_mfma_f32_16x16x32_bf16 v[220:223], v[40:43], v[88:91], v[220:223]
    ds_read_b64_tr_b16 v[40:41], v26 offset:0
    ds_read_b64_tr_b16 v[42:43], v26 offset:512
    v_mfma_f32_16x16x32_bf16 v[220:223], v[44:47], v[92:95], v[220:223]
    s_waitcnt lgkmcnt(2)
    ds_read_b64_tr_b16 v[44:45], v26 offset:4096
    ds_read_b64_tr_b16 v[46:47], v26 offset:4608
    v_mfma_f32_16x16x32_bf16 v[224:227], v[48:51], v[64:67], v[224:227]
    v_add_u32 v26, 0x10000, v26
    v_mfma_f32_16x16x32_bf16 v[224:227], v[52:55], v[68:71], v[224:227]
    s_xor_b32 s64, s64, 128
    v_mfma_f32_16x16x32_bf16 v[228:231], v[48:51], v[72:75], v[228:231]
    v_mfma_f32_16x16x32_bf16 v[228:231], v[52:55], v[76:79], v[228:231]
    v_mfma_f32_16x16x32_bf16 v[232:235], v[48:51], v[80:83], v[232:235]
    v_mfma_f32_16x16x32_bf16 v[232:235], v[52:55], v[84:87], v[232:235]
    s_add_u32 m0, s69, 0
    v_mfma_f32_16x16x32_bf16 v[236:239], v[48:51], v[88:91], v[236:239]
    buffer_load_dwordx4 v2, s[24:27], s60 offen lds
    v_mfma_f32_16x16x32_bf16 v[236:239], v[52:55], v[92:95], v[236:239]
    s_add_u32 s72, s70, 41984
    ds_read_b64_tr_b16 v[48:49], v27 offset:0
    ds_read_b64_tr_b16 v[50:51], v27 offset:512
    v_mfma_f32_16x16x32_bf16 v[240:243], v[56:59], v[64:67], v[240:243]
    ds_read_b64_tr_b16 v[52:53], v27 offset:4096
    ds_read_b64_tr_b16 v[54:55], v27 offset:4608
    v_mfma_f32_16x16x32_bf16 v[240:243], v[60:63], v[68:71], v[240:243]
    buffer_store_dwordx4 a[52:55], v1, s[36:39], s72 offen sc1
    v_mfma_f32_16x16x32_bf16 v[244:247], v[56:59], v[72:75], v[244:247]
    buffer_load_dwordx4 v3, s[24:27], s60 offen offset:1024 lds
    v_mfma_f32_16x16x32_bf16 v[244:247], v[60:63], v[76:79], v[244:247]
    v_add_u32 v27, 0x10000, v27
    v_accvgpr_write_b32 a52, 0
    v_mfma_f32_16x16x32_bf16 v[248:251], v[56:59], v[80:83], v[248:251]
    v_accvgpr_write_b32 a53, 0
    v_accvgpr_write_b32 a54, 0
    v_mfma_f32_16x16x32_bf16 v[248:251], v[60:63], v[84:87], v[248:251]
    v_accvgpr_write_b32 a55, 0
    v_mfma_f32_16x16x32_bf16 v[252:255], v[56:59], v[88:91], v[252:255]
    buffer_load_dwordx4 v4, s[24:27], s60 offen offset:2048 lds
    v_mfma_f32_16x16x32_bf16 v[252:255], v[60:63], v[92:95], v[252:255]
    s_waitcnt lgkmcnt(0)
    ds_read_b64_tr_b16 v[56:57], v28 offset:0
    ds_read_b64_tr_b16 v[58:59], v28 offset:512
    v_mfma_f32_16x16x32_bf16 a[64:67], v[40:43], v[64:67], a[64:67]
    ds_read_b64_tr_b16 v[60:61], v28 offset:4096
    ds_read_b64_tr_b16 v[62:63], v28 offset:4608
    v_mfma_f32_16x16x32_bf16 a[64:67], v[44:47], v[68:71], a[64:67]
    v_add_u32 v24, 0x10000, v24
    v_add_u32 v28, 0x10000, v28
    v_mfma_f32_16x16x32_bf16 a[68:71], v[40:43], v[72:75], a[68:71]
    buffer_load_dwordx4 v5, s[24:27], s60 offen offset:3072 lds
    v_mfma_f32_16x16x32_bf16 a[68:71], v[44:47], v[76:79], a[68:71]
    ds_read_b128 v[112:115], v24 offset:16384
    v_mfma_f32_16x16x32_bf16 a[72:75], v[40:43], v[80:83], a[72:75]
    v_mfma_f32_16x16x32_bf16 a[72:75], v[44:47], v[84:87], a[72:75]
    s_add_u32 m0, s69, 16384
    v_add_u32 v25, 0x10000, v25
    v_mfma_f32_16x16x32_bf16 a[76:79], v[40:43], v[88:91], a[76:79]
    s_xor_b32 s60, s60, 524288
    buffer_load_dwordx4 v10, s[20:23], s63 offen lds
    v_mfma_f32_16x16x32_bf16 a[76:79], v[44:47], v[92:95], a[76:79]
    ds_read_b128 v[116:119], v25 offset:16384
    v_mfma_f32_16x16x32_bf16 a[128:131], v[40:43], a[136:139], a[128:131]
    ds_read_b64_tr_b16 v[40:41], v29 offset:0
    ds_read_b64_tr_b16 v[42:43], v29 offset:512
    v_mfma_f32_16x16x32_bf16 a[128:131], v[44:47], a[140:143], a[128:131]
    ds_read_b64_tr_b16 v[44:45], v29 offset:4096
    ds_read_b64_tr_b16 v[46:47], v29 offset:4608
    v_mfma_f32_16x16x32_bf16 a[80:83], v[48:51], v[64:67], a[80:83]
    buffer_load_dwordx4 v11, s[20:23], s63 offen offset:1024 lds
    v_mfma_f32_16x16x32_bf16 a[80:83], v[52:55], v[68:71], a[80:83]
    ds_read_b128 v[120:123], v24 offset:24576
    v_add_u32 v29, 0x10000, v29
    v_mfma_f32_16x16x32_bf16 a[84:87], v[48:51], v[72:75], a[84:87]
    v_mfma_f32_16x16x32_bf16 a[84:87], v[52:55], v[76:79], a[84:87]
    v_mfma_f32_16x16x32_bf16 a[88:91], v[48:51], v[80:83], a[88:91]
    buffer_load_dwordx4 v12, s[20:23], s63 offen offset:2048 lds
    v_mfma_f32_16x16x32_bf16 a[88:91], v[52:55], v[84:87], a[88:91]
    ds_read_b128 v[124:127], v25 offset:24576
    v_mfma_f32_16x16x32_bf16 a[92:95], v[48:51], v[88:91], a[92:95]
    s_add_u32 s72, s70, 46080
    v_mfma_f32_16x16x32_bf16 a[92:95], v[52:55], v[92:95], a[92:95]
    v_mfma_f32_16x16x32_bf16 a[132:135], v[48:51], a[136:139], a[132:135]
    buffer_load_dwordx4 v13, s[20:23], s63 offen offset:3072 lds
    v_mfma_f32_16x16x32_bf16 a[132:135], v[52:55], a[140:143], a[132:135]
    s_waitcnt lgkmcnt(1)
    v_mfma_f32_16x16x32_bf16 a[96:99], v[56:59], v[64:67], a[96:99]
    v_mfma_f32_16x16x32_bf16 a[96:99], v[60:63], v[68:71], a[96:99]
    s_xor_b32 s63, s63, 384
    v_mfma_f32_16x16x32_bf16 a[100:103], v[56:59], v[72:75], a[100:103]
    buffer_store_dwordx4 a[60:63], v1, s[36:39], s72 offen sc1
    v_mfma_f32_16x16x32_bf16 a[100:103], v[60:63], v[76:79], a[100:103]
    v_mfma_f32_16x16x32_bf16 a[104:107], v[56:59], v[80:83], a[104:107]
    v_accvgpr_write_b32 a60, 0
    v_accvgpr_write_b32 a61, 0
    v_mfma_f32_16x16x32_bf16 a[104:107], v[60:63], v[84:87], a[104:107]
    s_waitcnt vmcnt(10) lgkmcnt(0)
    s_barrier
    ds_read_b64_tr_b16 v[48:49], v14 offset:32768
    v_mfma_f32_16x16x32_bf16 a[108:111], v[56:59], v[88:91], a[108:111]
    s_add_u32 m0, s67, 32768
    ds_read_b64_tr_b16 v[50:51], v14 offset:33792
    ds_read_b64_tr_b16 v[52:53], v14 offset:40960
    v_mfma_f32_16x16x32_bf16 a[108:111], v[60:63], v[92:95], a[108:111]
    buffer_load_dwordx4 v1, s[28:31], s65 offen sc1 lds
    v_mfma_f32_16x16x32_bf16 a[112:115], v[40:43], v[64:67], a[112:115]
    ds_read_b64_tr_b16 v[54:55], v14 offset:41984
    ds_read_b64_tr_b16 v[56:57], v15 offset:32768
    v_mfma_f32_16x16x32_bf16 a[112:115], v[44:47], v[68:71], a[112:115]
    ds_read_b64_tr_b16 v[58:59], v15 offset:33792
    ds_read_b64_tr_b16 v[60:61], v15 offset:40960
    v_mfma_f32_16x16x32_bf16 a[116:119], v[40:43], v[72:75], a[116:119]
    ds_read_b64_tr_b16 v[62:63], v15 offset:41984
    ds_read_b128 a[136:139], v22 offset:0
    v_mfma_f32_16x16x32_bf16 a[116:119], v[44:47], v[76:79], a[116:119]
    ds_read_b128 a[140:143], v23 offset:0
    v_add_u32 v14, 0xffff0000, v14
    v_mfma_f32_16x16x32_bf16 a[120:123], v[40:43], v[80:83], a[120:123]
    v_add_u32 v15, 0xffff0000, v15
    v_add_u32 v22, 0xfffe0000, v22
    v_mfma_f32_16x16x32_bf16 a[120:123], v[44:47], v[84:87], a[120:123]
    v_add_u32 v23, 0xfffe0000, v23
    v_accvgpr_read_b32 v32, a144
    v_mfma_f32_16x16x32_bf16 a[124:127], v[40:43], v[88:91], a[124:127]
    buffer_load_dwordx4 v1, s[28:31], s65 offen offset:1024 sc1 lds
    v_mfma_f32_16x16x32_bf16 a[124:127], v[44:47], v[92:95], a[124:127]
    s_waitcnt lgkmcnt(1)
    ds_read_b64_tr_b16 v[40:41], v16 offset:32768
    ds_read_b64_tr_b16 v[42:43], v16 offset:33792
    v_mfma_f32_16x16x32_bf16 v[128:131], v[48:51], v[96:99], v[128:131]
    ds_read_b64_tr_b16 v[44:45], v16 offset:40960
    ds_read_b64_tr_b16 v[46:47], v16 offset:41984
    v_mfma_f32_16x16x32_bf16 v[128:131], v[52:55], v[100:103], v[128:131]
    v_add_u32 v16, 0xffff0000, v16
    v_accvgpr_read_b32 v31, a145
    v_mfma_f32_16x16x32_bf16 v[132:135], v[48:51], v[104:107], v[132:135]
    ds_read_b128 v[64:67], v24 offset:49152
    v_cvt_pk_bf16_f32 v32, v32, v31
    v_mfma_f32_16x16x32_bf16 v[132:135], v[52:55], v[108:111], v[132:135]
    v_accvgpr_read_b32 v33, a146
    v_accvgpr_read_b32 v31, a147
    v_mfma_f32_16x16x32_bf16 v[136:139], v[48:51], v[112:115], v[136:139]
    v_cvt_pk_bf16_f32 v33, v33, v31
    v_accvgpr_read_b32 v34, a148
    v_mfma_f32_16x16x32_bf16 v[136:139], v[52:55], v[116:119], v[136:139]
    s_add_u32 s72, s71, 32768
    v_accvgpr_read_b32 v31, a149
    v_cvt_pk_bf16_f32 v34, v34, v31
    v_mfma_f32_16x16x32_bf16 v[140:143], v[48:51], v[120:123], v[140:143]
    s_add_u32 m0, s68, 40960
    ds_read_b64_tr_b16 v[48:49], v17 offset:32768
    ds_read_b64_tr_b16 v[50:51], v17 offset:33792
    v_mfma_f32_16x16x32_bf16 v[140:143], v[52:55], v[124:127], v[140:143]
    buffer_load_dwordx4 v6, s[20:23], s66 offen lds
    v_mfma_f32_16x16x32_bf16 v[144:147], v[56:59], v[96:99], v[144:147]
    ds_read_b64_tr_b16 v[52:53], v17 offset:40960
    ds_read_b64_tr_b16 v[54:55], v17 offset:41984
    v_mfma_f32_16x16x32_bf16 v[144:147], v[60:63], v[100:103], v[144:147]
    v_add_u32 v17, 0xffff0000, v17
    v_accvgpr_read_b32 v35, a150
    v_mfma_f32_16x16x32_bf16 v[148:151], v[56:59], v[104:107], v[148:151]
    v_accvgpr_read_b32 v31, a151
    v_cvt_pk_bf16_f32 v35, v35, v31
    v_mfma_f32_16x16x32_bf16 v[148:151], v[60:63], v[108:111], v[148:151]
    buffer_store_dwordx4 v[32:35], v1, s[36:39], s72 offen sc1
    v_mfma_f32_16x16x32_bf16 v[152:155], v[56:59], v[112:115], v[152:155]
    v_accvgpr_write_b32 a62, 0
    v_accvgpr_write_b32 a63, 0
    v_mfma_f32_16x16x32_bf16 v[152:155], v[60:63], v[116:119], v[152:155]
    ds_read_b128 v[68:71], v25 offset:49152
    v_accvgpr_write_b32 a144, 0
    v_mfma_f32_16x16x32_bf16 v[156:159], v[56:59], v[120:123], v[156:159]
    s_add_u32 m0, s69, 49152
    ds_read_b64_tr_b16 v[56:57], v18 offset:32768
    ds_read_b64_tr_b16 v[58:59], v18 offset:33792
    v_mfma_f32_16x16x32_bf16 v[156:159], v[60:63], v[124:127], v[156:159]
    s_xor_b32 s65, s65, 8192
    buffer_load_dwordx4 v10, s[20:23], s64 offen lds
    s_waitcnt lgkmcnt(3)
    v_mfma_f32_16x16x32_bf16 v[160:163], v[40:43], v[96:99], v[160:163]
    s_xor_b32 s66, s66, 128
    ds_read_b64_tr_b16 v[60:61], v18 offset:40960
    ds_read_b64_tr_b16 v[62:63], v18 offset:41984
    v_mfma_f32_16x16x32_bf16 v[160:163], v[44:47], v[100:103], v[160:163]
    v_add_u32 v18, 0xffff0000, v18
    v_accvgpr_write_b32 a145, 0
    v_mfma_f32_16x16x32_bf16 v[164:167], v[40:43], v[104:107], v[164:167]
    v_accvgpr_write_b32 a146, 0
    v_accvgpr_write_b32 a147, 0
    v_mfma_f32_16x16x32_bf16 v[164:167], v[44:47], v[108:111], v[164:167]
    v_accvgpr_read_b32 v32, a152
    v_accvgpr_read_b32 v31, a153
    v_mfma_f32_16x16x32_bf16 v[168:171], v[40:43], v[112:115], v[168:171]
    v_cvt_pk_bf16_f32 v32, v32, v31
    v_accvgpr_read_b32 v33, a154
    v_mfma_f32_16x16x32_bf16 v[168:171], v[44:47], v[116:119], v[168:171]
    v_accvgpr_read_b32 v31, a155
    v_cvt_pk_bf16_f32 v33, v33, v31
    v_mfma_f32_16x16x32_bf16 v[172:175], v[40:43], v[120:123], v[172:175]
    ds_read_b64_tr_b16 v[40:41], v19 offset:32768
    ds_read_b64_tr_b16 v[42:43], v19 offset:33792
    v_mfma_f32_16x16x32_bf16 v[172:175], v[44:47], v[124:127], v[172:175]
    ds_read_b64_tr_b16 v[44:45], v19 offset:40960
    ds_read_b64_tr_b16 v[46:47], v19 offset:41984
    v_mfma_f32_16x16x32_bf16 v[176:179], v[48:51], v[96:99], v[176:179]
    buffer_load_dwordx4 v11, s[20:23], s64 offen offset:1024 lds
    v_mfma_f32_16x16x32_bf16 v[176:179], v[52:55], v[100:103], v[176:179]
    ds_read_b128 v[72:75], v24 offset:57344
    v_add_u32 v19, 0xffff0000, v19
    v_mfma_f32_16x16x32_bf16 v[180:183], v[48:51], v[104:107], v[180:183]
    v_accvgpr_read_b32 v34, a156
    v_accvgpr_read_b32 v31, a157
    v_mfma_f32_16x16x32_bf16 v[180:183], v[52:55], v[108:111], v[180:183]
    v_cvt_pk_bf16_f32 v34, v34, v31
    v_accvgpr_read_b32 v35, a158
    v_mfma_f32_16x16x32_bf16 v[184:187], v[48:51], v[112:115], v[184:187]
    v_accvgpr_read_b32 v31, a159
    v_cvt_pk_bf16_f32 v35, v35, v31
    v_mfma_f32_16x16x32_bf16 v[184:187], v[52:55], v[116:119], v[184:187]
    v_accvgpr_write_b32 a148, 0
    v_accvgpr_write_b32 a149, 0
    v_mfma_f32_16x16x32_bf16 v[188:191], v[48:51], v[120:123], v[188:191]
    s_add_u32 s72, s71, 33792
    ds_read_b64_tr_b16 v[48:49], v20 offset:32768
    ds_read_b64_tr_b16 v[50:51], v20 offset:33792
    v_mfma_f32_16x16x32_bf16 v[188:191], v[52:55], v[124:127], v[188:191]
    s_waitcnt lgkmcnt(2)
    ds_read_b64_tr_b16 v[52:53], v20 offset:40960
    ds_read_b64_tr_b16 v[54:55], v20 offset:41984
    v_mfma_f32_16x16x32_bf16 v[192:195], v[56:59], v[96:99], v[192:195]
    buffer_load_dwordx4 v12, s[20:23], s64 offen offset:2048 lds
    v_mfma_f32_16x16x32_bf16 v[192:195], v[60:63], v[100:103], v[192:195]
    v_add_u32 v20, 0xffff0000, v20
    v_accvgpr_write_b32 a150, 0
    v_mfma_f32_16x16x32_bf16 v[196:199], v[56:59], v[104:107], v[196:199]
    buffer_store_dwordx4 v[32:35], v1, s[36:39], s72 offen sc1
    v_mfma_f32_16x16x32_bf16 v[196:199], v[60:63], v[108:111], v[196:199]
    ds_read_b128 v[76:79], v25 offset:57344
    v_accvgpr_write_b32 a151, 0
    v_mfma_f32_16x16x32_bf16 v[200:203], v[56:59], v[112:115], v[200:203]
    v_accvgpr_write_b32 a152, 0
    v_accvgpr_write_b32 a153, 0
    v_mfma_f32_16x16x32_bf16 v[200:203], v[60:63], v[116:119], v[200:203]
    v_accvgpr_write_b32 a154, 0
    v_accvgpr_write_b32 a155, 0
    v_mfma_f32_16x16x32_bf16 v[204:207], v[56:59], v[120:123], v[204:207]
    ds_read_b64_tr_b16 v[56:57], v21 offset:32768
    ds_read_b64_tr_b16 v[58:59], v21 offset:33792
    v_mfma_f32_16x16x32_bf16 v[204:207], v[60:63], v[124:127], v[204:207]
    ds_read_b64_tr_b16 v[60:61], v21 offset:40960
    ds_read_b64_tr_b16 v[62:63], v21 offset:41984
    v_mfma_f32_16x16x32_bf16 v[208:211], v[40:43], v[96:99], v[208:211]
    v_add_u32 v21, 0xffff0000, v21
    v_accvgpr_write_b32 a156, 0
    v_mfma_f32_16x16x32_bf16 v[208:211], v[44:47], v[100:103], v[208:211]
    buffer_load_dwordx4 v13, s[20:23], s64 offen offset:3072 lds
    v_mfma_f32_16x16x32_bf16 v[212:215], v[40:43], v[104:107], v[212:215]
    v_accvgpr_write_b32 a157, 0
    v_accvgpr_write_b32 a158, 0
    v_mfma_f32_16x16x32_bf16 v[212:215], v[44:47], v[108:111], v[212:215]
    v_accvgpr_write_b32 a159, 0
    v_mfma_f32_16x16x32_bf16 v[216:219], v[40:43], v[112:115], v[216:219]
    v_accvgpr_read_b32 v32, a160
    v_accvgpr_read_b32 v31, a161
    v_mfma_f32_16x16x32_bf16 v[216:219], v[44:47], v[116:119], v[216:219]
    v_cvt_pk_bf16_f32 v32, v32, v31
    v_accvgpr_read_b32 v33, a162
    v_mfma_f32_16x16x32_bf16 v[220:223], v[40:43], v[120:123], v[220:223]
    ds_read_b64_tr_b16 v[40:41], v26 offset:0
    ds_read_b64_tr_b16 v[42:43], v26 offset:512
    v_mfma_f32_16x16x32_bf16 v[220:223], v[44:47], v[124:127], v[220:223]
    s_waitcnt lgkmcnt(2)
    ds_read_b64_tr_b16 v[44:45], v26 offset:4096
    ds_read_b64_tr_b16 v[46:47], v26 offset:4608
    v_mfma_f32_16x16x32_bf16 v[224:227], v[48:51], v[96:99], v[224:227]
    v_add_u32 v26, 0xfffe0000, v26
    v_accvgpr_read_b32 v31, a163
    v_mfma_f32_16x16x32_bf16 v[224:227], v[52:55], v[100:103], v[224:227]
    s_xor_b32 s64, s64, 384
    v_cvt_pk_bf16_f32 v33, v33, v31
    v_accvgpr_read_b32 v34, a164
    v_mfma_f32_16x16x32_bf16 v[228:231], v[48:51], v[104:107], v[228:231]
    v_accvgpr_read_b32 v31, a165
    v_cvt_pk_bf16_f32 v34, v34, v31
    v_mfma_f32_16x16x32_bf16 v[228:231], v[52:55], v[108:111], v[228:231]
    v_accvgpr_read_b32 v35, a166
    v_accvgpr_read_b32 v31, a167
    v_mfma_f32_16x16x32_bf16 v[232:235], v[48:51], v[112:115], v[232:235]
    v_cvt_pk_bf16_f32 v35, v35, v31
    v_accvgpr_write_b32 a160, 0
    v_mfma_f32_16x16x32_bf16 v[232:235], v[52:55], v[116:119], v[232:235]
    s_add_u32 m0, s69, 65536
    v_accvgpr_write_b32 a161, 0
    v_accvgpr_write_b32 a162, 0
    v_mfma_f32_16x16x32_bf16 v[236:239], v[48:51], v[120:123], v[236:239]
    buffer_load_dwordx4 v2, s[24:27], s60 offen lds
    v_mfma_f32_16x16x32_bf16 v[236:239], v[52:55], v[124:127], v[236:239]
    s_add_u32 s72, s71, 2048
    ds_read_b64_tr_b16 v[48:49], v27 offset:0
    ds_read_b64_tr_b16 v[50:51], v27 offset:512
    v_mfma_f32_16x16x32_bf16 v[240:243], v[56:59], v[96:99], v[240:243]
    ds_read_b64_tr_b16 v[52:53], v27 offset:4096
    ds_read_b64_tr_b16 v[54:55], v27 offset:4608
    v_mfma_f32_16x16x32_bf16 v[240:243], v[60:63], v[100:103], v[240:243]
    v_add_u32 v27, 0xfffe0000, v27
    v_accvgpr_write_b32 a163, 0
    v_mfma_f32_16x16x32_bf16 v[244:247], v[56:59], v[104:107], v[244:247]
    buffer_load_dwordx4 v3, s[24:27], s60 offen offset:1024 lds
    v_mfma_f32_16x16x32_bf16 v[244:247], v[60:63], v[108:111], v[244:247]
    buffer_store_dwordx4 v[32:35], v1, s[36:39], s72 offen sc1
    v_mfma_f32_16x16x32_bf16 v[248:251], v[56:59], v[112:115], v[248:251]
    v_accvgpr_write_b32 a164, 0
    v_accvgpr_write_b32 a165, 0
    v_mfma_f32_16x16x32_bf16 v[248:251], v[60:63], v[116:119], v[248:251]
    v_accvgpr_write_b32 a166, 0
    v_accvgpr_write_b32 a167, 0
    v_mfma_f32_16x16x32_bf16 v[252:255], v[56:59], v[120:123], v[252:255]
    buffer_load_dwordx4 v4, s[24:27], s60 offen offset:2048 lds
    v_mfma_f32_16x16x32_bf16 v[252:255], v[60:63], v[124:127], v[252:255]
    s_waitcnt lgkmcnt(0)
    ds_read_b64_tr_b16 v[56:57], v28 offset:0
    ds_read_b64_tr_b16 v[58:59], v28 offset:512
    v_mfma_f32_16x16x32_bf16 a[64:67], v[40:43], v[96:99], a[64:67]
    ds_read_b64_tr_b16 v[60:61], v28 offset:4096
    ds_read_b64_tr_b16 v[62:63], v28 offset:4608
    v_mfma_f32_16x16x32_bf16 a[64:67], v[44:47], v[100:103], a[64:67]
    v_add_u32 v24, 0x10000, v24
    v_add_u32 v28, 0xfffe0000, v28
    v_mfma_f32_16x16x32_bf16 a[68:71], v[40:43], v[104:107], a[68:71]
    buffer_load_dwordx4 v5, s[24:27], s60 offen offset:3072 lds
    v_mfma_f32_16x16x32_bf16 a[68:71], v[44:47], v[108:111], a[68:71]
    ds_read_b128 v[80:83], v24 offset:16384
    v_mfma_f32_16x16x32_bf16 a[72:75], v[40:43], v[112:115], a[72:75]
    v_mfma_f32_16x16x32_bf16 a[72:75], v[44:47], v[116:119], a[72:75]
    s_add_u32 m0, s69, 81920
    v_add_u32 v25, 0x10000, v25
    v_accvgpr_read_b32 v32, a168
    v_mfma_f32_16x16x32_bf16 a[76:79], v[40:43], v[120:123], a[76:79]
    s_xor_b32 s60, s60, 1572864
    buffer_load_dwordx4 v10, s[20:23], s63 offen lds
    v_mfma_f32_16x16x32_bf16 a[76:79], v[44:47], v[124:127], a[76:79]
    ds_read_b128 v[84:87], v25 offset:16384
    v_accvgpr_read_b32 v31, a169
    v_mfma_f32_16x16x32_bf16 a[128:131], v[40:43], a[136:139], a[128:131]
    ds_read_b64_tr_b16 v[40:41], v29 offset:0
    ds_read_b64_tr_b16 v[42:43], v29 offset:512
    v_mfma_f32_16x16x32_bf16 a[128:131], v[44:47], a[140:143], a[128:131]
    ds_read_b64_tr_b16 v[44:45], v29 offset:4096
    ds_read_b64_tr_b16 v[46:47], v29 offset:4608
    v_mfma_f32_16x16x32_bf16 a[80:83], v[48:51], v[96:99], a[80:83]
    buffer_load_dwordx4 v11, s[20:23], s63 offen offset:1024 lds
    v_mfma_f32_16x16x32_bf16 a[80:83], v[52:55], v[100:103], a[80:83]
    ds_read_b128 v[88:91], v24 offset:24576
    v_add_u32 v29, 0xfffe0000, v29
    v_mfma_f32_16x16x32_bf16 a[84:87], v[48:51], v[104:107], a[84:87]
    v_cvt_pk_bf16_f32 v32, v32, v31
    v_accvgpr_read_b32 v33, a170
    v_mfma_f32_16x16x32_bf16 a[84:87], v[52:55], v[108:111], a[84:87]
    v_accvgpr_read_b32 v31, a171
    v_cvt_pk_bf16_f32 v33, v33, v31
    v_mfma_f32_16x16x32_bf16 a[88:91], v[48:51], v[112:115], a[88:91]
    buffer_load_dwordx4 v12, s[20:23], s63 offen offset:2048 lds
    v_mfma_f32_16x16x32_bf16 a[88:91], v[52:55], v[116:119], a[88:91]
    ds_read_b128 v[92:95], v25 offset:24576
    v_accvgpr_read_b32 v34, a172
    v_mfma_f32_16x16x32_bf16 a[92:95], v[48:51], v[120:123], a[92:95]
    s_add_u32 s72, s71, 3072
    v_accvgpr_read_b32 v31, a173
    v_cvt_pk_bf16_f32 v34, v34, v31
    v_mfma_f32_16x16x32_bf16 a[92:95], v[52:55], v[124:127], a[92:95]
    v_accvgpr_read_b32 v35, a174
    v_accvgpr_read_b32 v31, a175
    v_mfma_f32_16x16x32_bf16 a[132:135], v[48:51], a[136:139], a[132:135]
    buffer_load_dwordx4 v13, s[20:23], s63 offen offset:3072 lds
    v_mfma_f32_16x16x32_bf16 a[132:135], v[52:55], a[140:143], a[132:135]
    s_waitcnt lgkmcnt(1)
    v_cvt_pk_bf16_f32 v35, v35, v31
    v_accvgpr_write_b32 a168, 0
    v_mfma_f32_16x16x32_bf16 a[96:99], v[56:59], v[96:99], a[96:99]
    v_accvgpr_write_b32 a169, 0
    v_accvgpr_write_b32 a170, 0
    v_mfma_f32_16x16x32_bf16 a[96:99], v[60:63], v[100:103], a[96:99]
    s_xor_b32 s63, s63, 128
    v_accvgpr_write_b32 a171, 0
    v_accvgpr_write_b32 a172, 0
    v_mfma_f32_16x16x32_bf16 a[100:103], v[56:59], v[104:107], a[100:103]
    buffer_store_dwordx4 v[32:35], v1, s[36:39], s72 offen sc1
    v_mfma_f32_16x16x32_bf16 a[100:103], v[60:63], v[108:111], a[100:103]
    v_accvgpr_write_b32 a173, 0
    v_accvgpr_write_b32 a174, 0
    v_mfma_f32_16x16x32_bf16 a[104:107], v[56:59], v[112:115], a[104:107]
    v_accvgpr_write_b32 a175, 0
    v_mfma_f32_16x16x32_bf16 a[104:107], v[60:63], v[116:119], a[104:107]
    s_waitcnt vmcnt(10) lgkmcnt(0)
    s_barrier
    ds_read_b64_tr_b16 v[48:49], v14 offset:0
    v_mfma_f32_16x16x32_bf16 a[108:111], v[56:59], v[120:123], a[108:111]
    s_add_u32 m0, s67, 98304
    ds_read_b64_tr_b16 v[50:51], v14 offset:1024
    ds_read_b64_tr_b16 v[52:53], v14 offset:8192
    v_mfma_f32_16x16x32_bf16 a[108:111], v[60:63], v[124:127], a[108:111]
    buffer_load_dwordx4 v1, s[28:31], s65 offen sc1 lds
    v_mfma_f32_16x16x32_bf16 a[112:115], v[40:43], v[96:99], a[112:115]
    ds_read_b64_tr_b16 v[54:55], v14 offset:9216
    ds_read_b64_tr_b16 v[56:57], v15 offset:0
    v_mfma_f32_16x16x32_bf16 a[112:115], v[44:47], v[100:103], a[112:115]
    ds_read_b64_tr_b16 v[58:59], v15 offset:1024
    ds_read_b64_tr_b16 v[60:61], v15 offset:8192
    v_mfma_f32_16x16x32_bf16 a[116:119], v[40:43], v[104:107], a[116:119]
    ds_read_b64_tr_b16 v[62:63], v15 offset:9216
    ds_read_b128 a[136:139], v22 offset:32768
    v_mfma_f32_16x16x32_bf16 a[116:119], v[44:47], v[108:111], a[116:119]
    ds_read_b128 a[140:143], v23 offset:32768
    v_add_u32 v14, 0x10000, v14
    v_mfma_f32_16x16x32_bf16 a[120:123], v[40:43], v[112:115], a[120:123]
    v_add_u32 v15, 0x10000, v15
    v_add_u32 v22, 0x10000, v22
    v_mfma_f32_16x16x32_bf16 a[120:123], v[44:47], v[116:119], a[120:123]
    v_add_u32 v23, 0x10000, v23
    v_accvgpr_read_b32 v32, a176
    v_mfma_f32_16x16x32_bf16 a[124:127], v[40:43], v[120:123], a[124:127]
    buffer_load_dwordx4 v1, s[28:31], s65 offen offset:1024 sc1 lds
    v_mfma_f32_16x16x32_bf16 a[124:127], v[44:47], v[124:127], a[124:127]
    s_waitcnt lgkmcnt(1)
    ds_read_b64_tr_b16 v[40:41], v16 offset:0
    ds_read_b64_tr_b16 v[42:43], v16 offset:1024
    v_mfma_f32_16x16x32_bf16 v[128:131], v[48:51], v[64:67], v[128:131]
    ds_read_b64_tr_b16 v[44:45], v16 offset:8192
    ds_read_b64_tr_b16 v[46:47], v16 offset:9216
    v_mfma_f32_16x16x32_bf16 v[128:131], v[52:55], v[68:71], v[128:131]
    v_add_u32 v24, 0xfffe0000, v24
    v_add_u32 v16, 0x10000, v16
    v_mfma_f32_16x16x32_bf16 v[132:135], v[48:51], v[72:75], v[132:135]
    ds_read_b128 v[96:99], v24 offset:16384
    v_accvgpr_read_b32 v31, a177
    v_mfma_f32_16x16x32_bf16 v[132:135], v[52:55], v[76:79], v[132:135]
    v_cvt_pk_bf16_f32 v32, v32, v31
    v_accvgpr_read_b32 v33, a178
    v_mfma_f32_16x16x32_bf16 v[136:139], v[48:51], v[80:83], v[136:139]
    v_accvgpr_read_b32 v31, a179
    v_cvt_pk_bf16_f32 v33, v33, v31
    v_mfma_f32_16x16x32_bf16 v[136:139], v[52:55], v[84:87], v[136:139]
    s_add_u32 s72, s71, 34816
    v_accvgpr_read_b32 v34, a180
    v_accvgpr_read_b32 v31, a181
    v_mfma_f32_16x16x32_bf16 v[140:143], v[48:51], v[88:91], v[140:143]
    s_add_u32 m0, s68, 106496
    ds_read_b64_tr_b16 v[48:49], v17 offset:0
    ds_read_b64_tr_b16 v[50:51], v17 offset:1024
    v_mfma_f32_16x16x32_bf16 v[140:143], v[52:55], v[92:95], v[140:143]
    buffer_load_dwordx4 v6, s[20:23], s66 offen lds
    v_mfma_f32_16x16x32_bf16 v[144:147], v[56:59], v[64:67], v[144:147]
    ds_read_b64_tr_b16 v[52:53], v17 offset:8192
    ds_read_b64_tr_b16 v[54:55], v17 offset:9216
    v_mfma_f32_16x16x32_bf16 v[144:147], v[60:63], v[68:71], v[144:147]
    v_add_u32 v17, 0x10000, v17
    v_cvt_pk_bf16_f32 v34, v34, v31
    v_mfma_f32_16x16x32_bf16 v[148:151], v[56:59], v[72:75], v[148:151]
    v_accvgpr_read_b32 v35, a182
    v_accvgpr_read_b32 v31, a183
    v_mfma_f32_16x16x32_bf16 v[148:151], v[60:63], v[76:79], v[148:151]
    v_cvt_pk_bf16_f32 v35, v35, v31
    v_accvgpr_write_b32 a176, 0
    v_mfma_f32_16x16x32_bf16 v[152:155], v[56:59], v[80:83], v[152:155]
    v_add_u32 v25, 0xfffe0000, v25
    v_accvgpr_write_b32 a177, 0
    v_mfma_f32_16x16x32_bf16 v[152:155], v[60:63], v[84:87], v[152:155]
    ds_read_b128 v[100:103], v25 offset:16384
    v_accvgpr_write_b32 a178, 0
    v_mfma_f32_16x16x32_bf16 v[156:159], v[56:59], v[88:91], v[156:159]
    s_add_u32 m0, s69, 114688
    ds_read_b64_tr_b16 v[56:57], v18 offset:0
    ds_read_b64_tr_b16 v[58:59], v18 offset:1024
    v_mfma_f32_16x16x32_bf16 v[156:159], v[60:63], v[92:95], v[156:159]
    s_xor_b32 s65, s65, 24576
    buffer_load_dwordx4 v10, s[20:23], s64 offen lds
    s_waitcnt lgkmcnt(3)
    v_mfma_f32_16x16x32_bf16 v[160:163], v[40:43], v[64:67], v[160:163]
    s_xor_b32 s66, s66, 384
    ds_read_b64_tr_b16 v[60:61], v18 offset:8192
    ds_read_b64_tr_b16 v[62:63], v18 offset:9216
    v_mfma_f32_16x16x32_bf16 v[160:163], v[44:47], v[68:71], v[160:163]
    v_add_u32 v18, 0x10000, v18
    v_accvgpr_write_b32 a179, 0
    v_mfma_f32_16x16x32_bf16 v[164:167], v[40:43], v[72:75], v[164:167]
    buffer_store_dwordx4 v[32:35], v1, s[36:39], s72 offen sc1
    v_mfma_f32_16x16x32_bf16 v[164:167], v[44:47], v[76:79], v[164:167]
    v_accvgpr_read_b32 v31, a185
    v_accvgpr_read_b32 v32, a184
    v_mfma_f32_16x16x32_bf16 v[168:171], v[40:43], v[80:83], v[168:171]
    v_cvt_pk_bf16_f32 v32, v32, v31
    v_accvgpr_read_b32 v33, a186
    v_mfma_f32_16x16x32_bf16 v[168:171], v[44:47], v[84:87], v[168:171]
    v_accvgpr_read_b32 v31, a187
    v_cvt_pk_bf16_f32 v33, v33, v31
    v_mfma_f32_16x16x32_bf16 v[172:175], v[40:43], v[88:91], v[172:175]
    ds_read_b64_tr_b16 v[40:41], v19 offset:0
    ds_read_b64_tr_b16 v[42:43], v19 offset:1024
    v_mfma_f32_16x16x32_bf16 v[172:175], v[44:47], v[92:95], v[172:175]
    ds_read_b64_tr_b16 v[44:45], v19 offset:8192
    ds_read_b64_tr_b16 v[46:47], v19 offset:9216
    v_mfma_f32_16x16x32_bf16 v[176:179], v[48:51], v[64:67], v[176:179]
    buffer_load_dwordx4 v11, s[20:23], s64 offen offset:1024 lds
    v_mfma_f32_16x16x32_bf16 v[176:179], v[52:55], v[68:71], v[176:179]
    ds_read_b128 v[104:107], v24 offset:24576
    v_add_u32 v19, 0x10000, v19
    v_mfma_f32_16x16x32_bf16 v[180:183], v[48:51], v[72:75], v[180:183]
    v_accvgpr_read_b32 v34, a188
    v_accvgpr_read_b32 v31, a189
    v_mfma_f32_16x16x32_bf16 v[180:183], v[52:55], v[76:79], v[180:183]
    v_cvt_pk_bf16_f32 v34, v34, v31
    v_accvgpr_read_b32 v35, a190
    v_mfma_f32_16x16x32_bf16 v[184:187], v[48:51], v[80:83], v[184:187]
    v_accvgpr_read_b32 v31, a191
    v_cvt_pk_bf16_f32 v35, v35, v31
    v_mfma_f32_16x16x32_bf16 v[184:187], v[52:55], v[84:87], v[184:187]
    v_accvgpr_write_b32 a180, 0
    v_accvgpr_write_b32 a181, 0
    v_mfma_f32_16x16x32_bf16 v[188:191], v[48:51], v[88:91], v[188:191]
    s_add_u32 s72, s71, 35840
    ds_read_b64_tr_b16 v[48:49], v20 offset:0
    ds_read_b64_tr_b16 v[50:51], v20 offset:1024
    v_mfma_f32_16x16x32_bf16 v[188:191], v[52:55], v[92:95], v[188:191]
    s_waitcnt lgkmcnt(2)
    ds_read_b64_tr_b16 v[52:53], v20 offset:8192
    ds_read_b64_tr_b16 v[54:55], v20 offset:9216
    v_mfma_f32_16x16x32_bf16 v[192:195], v[56:59], v[64:67], v[192:195]
    buffer_load_dwordx4 v12, s[20:23], s64 offen offset:2048 lds
    v_mfma_f32_16x16x32_bf16 v[192:195], v[60:63], v[68:71], v[192:195]
    v_add_u32 v20, 0x10000, v20
    v_accvgpr_write_b32 a182, 0
    v_mfma_f32_16x16x32_bf16 v[196:199], v[56:59], v[72:75], v[196:199]
    buffer_store_dwordx4 v[32:35], v1, s[36:39], s72 offen sc1
    v_mfma_f32_16x16x32_bf16 v[196:199], v[60:63], v[76:79], v[196:199]
    ds_read_b128 v[108:111], v25 offset:24576
    v_accvgpr_write_b32 a183, 0
    v_mfma_f32_16x16x32_bf16 v[200:203], v[56:59], v[80:83], v[200:203]
    v_accvgpr_write_b32 a184, 0
    v_accvgpr_write_b32 a185, 0
    v_mfma_f32_16x16x32_bf16 v[200:203], v[60:63], v[84:87], v[200:203]
    v_accvgpr_write_b32 a186, 0
    v_accvgpr_write_b32 a187, 0
    v_mfma_f32_16x16x32_bf16 v[204:207], v[56:59], v[88:91], v[204:207]
    ds_read_b64_tr_b16 v[56:57], v21 offset:0
    ds_read_b64_tr_b16 v[58:59], v21 offset:1024
    v_mfma_f32_16x16x32_bf16 v[204:207], v[60:63], v[92:95], v[204:207]
    ds_read_b64_tr_b16 v[60:61], v21 offset:8192
    ds_read_b64_tr_b16 v[62:63], v21 offset:9216
    v_mfma_f32_16x16x32_bf16 v[208:211], v[40:43], v[64:67], v[208:211]
    v_add_u32 v21, 0x10000, v21
    v_accvgpr_write_b32 a188, 0
    v_mfma_f32_16x16x32_bf16 v[208:211], v[44:47], v[68:71], v[208:211]
    buffer_load_dwordx4 v13, s[20:23], s64 offen offset:3072 lds
    v_mfma_f32_16x16x32_bf16 v[212:215], v[40:43], v[72:75], v[212:215]
    v_accvgpr_write_b32 a189, 0
    v_accvgpr_write_b32 a190, 0
    v_mfma_f32_16x16x32_bf16 v[212:215], v[44:47], v[76:79], v[212:215]
    v_accvgpr_write_b32 a191, 0
    v_mfma_f32_16x16x32_bf16 v[216:219], v[40:43], v[80:83], v[216:219]
    v_accvgpr_read_b32 v32, a192
    v_accvgpr_read_b32 v31, a193
    v_mfma_f32_16x16x32_bf16 v[216:219], v[44:47], v[84:87], v[216:219]
    v_cvt_pk_bf16_f32 v32, v32, v31
    v_accvgpr_read_b32 v33, a194
    v_mfma_f32_16x16x32_bf16 v[220:223], v[40:43], v[88:91], v[220:223]
    ds_read_b64_tr_b16 v[40:41], v26 offset:32768
    ds_read_b64_tr_b16 v[42:43], v26 offset:33280
    v_mfma_f32_16x16x32_bf16 v[220:223], v[44:47], v[92:95], v[220:223]
    s_waitcnt lgkmcnt(2)
    ds_read_b64_tr_b16 v[44:45], v26 offset:36864
    ds_read_b64_tr_b16 v[46:47], v26 offset:37376
    v_mfma_f32_16x16x32_bf16 v[224:227], v[48:51], v[64:67], v[224:227]
    v_add_u32 v26, 0x10000, v26
    v_accvgpr_read_b32 v31, a195
    v_mfma_f32_16x16x32_bf16 v[224:227], v[52:55], v[68:71], v[224:227]
    s_xor_b32 s64, s64, 128
    v_cvt_pk_bf16_f32 v33, v33, v31
    v_accvgpr_read_b32 v34, a196
    v_mfma_f32_16x16x32_bf16 v[228:231], v[48:51], v[72:75], v[228:231]
    v_accvgpr_read_b32 v31, a197
    v_cvt_pk_bf16_f32 v34, v34, v31
    v_mfma_f32_16x16x32_bf16 v[228:231], v[52:55], v[76:79], v[228:231]
    v_accvgpr_read_b32 v35, a198
    v_accvgpr_read_b32 v31, a199
    v_mfma_f32_16x16x32_bf16 v[232:235], v[48:51], v[80:83], v[232:235]
    v_cvt_pk_bf16_f32 v35, v35, v31
    v_accvgpr_write_b32 a192, 0
    v_mfma_f32_16x16x32_bf16 v[232:235], v[52:55], v[84:87], v[232:235]
    s_add_u32 m0, s69, 131072
    v_accvgpr_write_b32 a193, 0
    v_accvgpr_write_b32 a194, 0
    v_mfma_f32_16x16x32_bf16 v[236:239], v[48:51], v[88:91], v[236:239]
    buffer_load_dwordx4 v2, s[24:27], s60 offen lds
    v_mfma_f32_16x16x32_bf16 v[236:239], v[52:55], v[92:95], v[236:239]
    s_add_u32 s72, s71, 4096
    ds_read_b64_tr_b16 v[48:49], v27 offset:32768
    ds_read_b64_tr_b16 v[50:51], v27 offset:33280
    v_mfma_f32_16x16x32_bf16 v[240:243], v[56:59], v[64:67], v[240:243]
    ds_read_b64_tr_b16 v[52:53], v27 offset:36864
    ds_read_b64_tr_b16 v[54:55], v27 offset:37376
    v_mfma_f32_16x16x32_bf16 v[240:243], v[60:63], v[68:71], v[240:243]
    v_add_u32 v27, 0x10000, v27
    v_accvgpr_write_b32 a195, 0
    v_mfma_f32_16x16x32_bf16 v[244:247], v[56:59], v[72:75], v[244:247]
    buffer_load_dwordx4 v3, s[24:27], s60 offen offset:1024 lds
    v_mfma_f32_16x16x32_bf16 v[244:247], v[60:63], v[76:79], v[244:247]
    buffer_store_dwordx4 v[32:35], v1, s[36:39], s72 offen sc1
    v_mfma_f32_16x16x32_bf16 v[248:251], v[56:59], v[80:83], v[248:251]
    v_accvgpr_write_b32 a196, 0
    v_accvgpr_write_b32 a197, 0
    v_mfma_f32_16x16x32_bf16 v[248:251], v[60:63], v[84:87], v[248:251]
    v_accvgpr_write_b32 a198, 0
    v_accvgpr_write_b32 a199, 0
    v_mfma_f32_16x16x32_bf16 v[252:255], v[56:59], v[88:91], v[252:255]
    buffer_load_dwordx4 v4, s[24:27], s60 offen offset:2048 lds
    v_mfma_f32_16x16x32_bf16 v[252:255], v[60:63], v[92:95], v[252:255]
    s_waitcnt lgkmcnt(0)
    ds_read_b64_tr_b16 v[56:57], v28 offset:32768
    ds_read_b64_tr_b16 v[58:59], v28 offset:33280
    v_mfma_f32_16x16x32_bf16 a[64:67], v[40:43], v[64:67], a[64:67]
    ds_read_b64_tr_b16 v[60:61], v28 offset:36864
    ds_read_b64_tr_b16 v[62:63], v28 offset:37376
    v_mfma_f32_16x16x32_bf16 a[64:67], v[44:47], v[68:71], a[64:67]
    v_add_u32 v28, 0x10000, v28
    v_mfma_f32_16x16x32_bf16 a[68:71], v[40:43], v[72:75], a[68:71]
    buffer_load_dwordx4 v5, s[24:27], s60 offen offset:3072 lds
    v_mfma_f32_16x16x32_bf16 a[68:71], v[44:47], v[76:79], a[68:71]
    ds_read_b128 v[112:115], v24 offset:49152
    v_mfma_f32_16x16x32_bf16 a[72:75], v[40:43], v[80:83], a[72:75]
    v_mfma_f32_16x16x32_bf16 a[72:75], v[44:47], v[84:87], a[72:75]
    s_add_u32 m0, s69, 147456
    v_accvgpr_read_b32 v32, a200
    v_accvgpr_read_b32 v31, a201
    v_mfma_f32_16x16x32_bf16 a[76:79], v[40:43], v[88:91], a[76:79]
    s_xor_b32 s60, s60, 524288
    buffer_load_dwordx4 v10, s[20:23], s63 offen lds
    v_mfma_f32_16x16x32_bf16 a[76:79], v[44:47], v[92:95], a[76:79]
    ds_read_b128 v[116:119], v25 offset:49152
    v_cvt_pk_bf16_f32 v32, v32, v31
    v_mfma_f32_16x16x32_bf16 a[128:131], v[40:43], a[136:139], a[128:131]
    ds_read_b64_tr_b16 v[40:41], v29 offset:32768
    ds_read_b64_tr_b16 v[42:43], v29 offset:33280
    v_mfma_f32_16x16x32_bf16 a[128:131], v[44:47], a[140:143], a[128:131]
    ds_read_b64_tr_b16 v[44:45], v29 offset:36864
    ds_read_b64_tr_b16 v[46:47], v29 offset:37376
    v_mfma_f32_16x16x32_bf16 a[80:83], v[48:51], v[64:67], a[80:83]
    buffer_load_dwordx4 v11, s[20:23], s63 offen offset:1024 lds
    v_mfma_f32_16x16x32_bf16 a[80:83], v[52:55], v[68:71], a[80:83]
    ds_read_b128 v[120:123], v24 offset:57344
    v_add_u32 v29, 0x10000, v29
    v_mfma_f32_16x16x32_bf16 a[84:87], v[48:51], v[72:75], a[84:87]
    v_accvgpr_read_b32 v33, a202
    v_accvgpr_read_b32 v31, a203
    v_mfma_f32_16x16x32_bf16 a[84:87], v[52:55], v[76:79], a[84:87]
    v_cvt_pk_bf16_f32 v33, v33, v31
    v_accvgpr_read_b32 v34, a204
    v_mfma_f32_16x16x32_bf16 a[88:91], v[48:51], v[80:83], a[88:91]
    buffer_load_dwordx4 v12, s[20:23], s63 offen offset:2048 lds
    v_mfma_f32_16x16x32_bf16 a[88:91], v[52:55], v[84:87], a[88:91]
    ds_read_b128 v[124:127], v25 offset:57344
    v_accvgpr_read_b32 v31, a205
    v_mfma_f32_16x16x32_bf16 a[92:95], v[48:51], v[88:91], a[92:95]
    s_add_u32 s72, s71, 5120
    v_cvt_pk_bf16_f32 v34, v34, v31
    v_accvgpr_read_b32 v35, a206
    v_mfma_f32_16x16x32_bf16 a[92:95], v[52:55], v[92:95], a[92:95]
    v_accvgpr_read_b32 v31, a207
    v_cvt_pk_bf16_f32 v35, v35, v31
    v_mfma_f32_16x16x32_bf16 a[132:135], v[48:51], a[136:139], a[132:135]
    buffer_load_dwordx4 v13, s[20:23], s63 offen offset:3072 lds
    v_mfma_f32_16x16x32_bf16 a[132:135], v[52:55], a[140:143], a[132:135]
    s_waitcnt lgkmcnt(1)
    v_accvgpr_write_b32 a200, 0
    v_accvgpr_write_b32 a201, 0
    v_mfma_f32_16x16x32_bf16 a[96:99], v[56:59], v[64:67], a[96:99]
    v_accvgpr_write_b32 a202, 0
    v_accvgpr_write_b32 a203, 0
    v_mfma_f32_16x16x32_bf16 a[96:99], v[60:63], v[68:71], a[96:99]
    s_xor_b32 s63, s63, 1920
    v_accvgpr_write_b32 a204, 0
    v_accvgpr_write_b32 a205, 0
    v_mfma_f32_16x16x32_bf16 a[100:103], v[56:59], v[72:75], a[100:103]
    s_andn2_b32 s63, s63, 896
    buffer_store_dwordx4 v[32:35], v1, s[36:39], s72 offen sc1
    v_mfma_f32_16x16x32_bf16 a[100:103], v[60:63], v[76:79], a[100:103]
    v_accvgpr_write_b32 a206, 0
    v_accvgpr_write_b32 a207, 0
    v_mfma_f32_16x16x32_bf16 a[104:107], v[56:59], v[80:83], a[104:107]
    v_mfma_f32_16x16x32_bf16 a[104:107], v[60:63], v[84:87], a[104:107]
    s_waitcnt vmcnt(10) lgkmcnt(0)
    s_barrier
    ds_read_b64_tr_b16 v[48:49], v14 offset:0
    v_mfma_f32_16x16x32_bf16 a[108:111], v[56:59], v[88:91], a[108:111]
    s_add_u32 m0, s67, 0
    ds_read_b64_tr_b16 v[50:51], v14 offset:1024
    ds_read_b64_tr_b16 v[52:53], v14 offset:8192
    v_mfma_f32_16x16x32_bf16 a[108:111], v[60:63], v[92:95], a[108:111]
    buffer_load_dwordx4 v1, s[28:31], s65 offen sc1 lds
    v_mfma_f32_16x16x32_bf16 a[112:115], v[40:43], v[64:67], a[112:115]
    ds_read_b64_tr_b16 v[54:55], v14 offset:9216
    ds_read_b64_tr_b16 v[56:57], v15 offset:0
    v_mfma_f32_16x16x32_bf16 a[112:115], v[44:47], v[68:71], a[112:115]
    ds_read_b64_tr_b16 v[58:59], v15 offset:1024
    ds_read_b64_tr_b16 v[60:61], v15 offset:8192
    v_mfma_f32_16x16x32_bf16 a[116:119], v[40:43], v[72:75], a[116:119]
    ds_read_b64_tr_b16 v[62:63], v15 offset:9216
    ds_read_b128 a[136:139], v22 offset:32768
    v_mfma_f32_16x16x32_bf16 a[116:119], v[44:47], v[76:79], a[116:119]
    ds_read_b128 a[140:143], v23 offset:32768
    v_add_u32 v14, 0x10000, v14
    v_mfma_f32_16x16x32_bf16 a[120:123], v[40:43], v[80:83], a[120:123]
    v_add_u32 v15, 0x10000, v15
    v_add_u32 v22, 0xffff0000, v22
    v_mfma_f32_16x16x32_bf16 a[120:123], v[44:47], v[84:87], a[120:123]
    v_add_u32 v23, 0xffff0000, v23
    v_accvgpr_read_b32 v32, a208
    v_mfma_f32_16x16x32_bf16 a[124:127], v[40:43], v[88:91], a[124:127]
    buffer_load_dwordx4 v1, s[28:31], s65 offen offset:1024 sc1 lds
    v_mfma_f32_16x16x32_bf16 a[124:127], v[44:47], v[92:95], a[124:127]
    s_waitcnt lgkmcnt(1)
    ds_read_b64_tr_b16 v[40:41], v16 offset:0
    ds_read_b64_tr_b16 v[42:43], v16 offset:1024
    v_mfma_f32_16x16x32_bf16 v[128:131], v[48:51], v[96:99], v[128:131]
    ds_read_b64_tr_b16 v[44:45], v16 offset:8192
    ds_read_b64_tr_b16 v[46:47], v16 offset:9216
    v_mfma_f32_16x16x32_bf16 v[128:131], v[52:55], v[100:103], v[128:131]
    v_add_u32 v24, 0x10000, v24
    v_add_u32 v16, 0x10000, v16
    v_mfma_f32_16x16x32_bf16 v[132:135], v[48:51], v[104:107], v[132:135]
    ds_read_b128 v[64:67], v24 offset:16384
    v_accvgpr_read_b32 v31, a209
    v_mfma_f32_16x16x32_bf16 v[132:135], v[52:55], v[108:111], v[132:135]
    v_cvt_pk_bf16_f32 v32, v32, v31
    v_accvgpr_read_b32 v33, a210
    v_mfma_f32_16x16x32_bf16 v[136:139], v[48:51], v[112:115], v[136:139]
    v_accvgpr_read_b32 v31, a211
    v_cvt_pk_bf16_f32 v33, v33, v31
    v_mfma_f32_16x16x32_bf16 v[136:139], v[52:55], v[116:119], v[136:139]
    s_add_u32 s72, s71, 36864
    v_accvgpr_read_b32 v34, a212
    v_accvgpr_read_b32 v31, a213
    v_mfma_f32_16x16x32_bf16 v[140:143], v[48:51], v[120:123], v[140:143]
    s_add_u32 m0, s68, 8192
    ds_read_b64_tr_b16 v[48:49], v17 offset:0
    ds_read_b64_tr_b16 v[50:51], v17 offset:1024
    v_mfma_f32_16x16x32_bf16 v[140:143], v[52:55], v[124:127], v[140:143]
    buffer_load_dwordx4 v6, s[20:23], s66 offen lds
    v_mfma_f32_16x16x32_bf16 v[144:147], v[56:59], v[96:99], v[144:147]
    ds_read_b64_tr_b16 v[52:53], v17 offset:8192
    ds_read_b64_tr_b16 v[54:55], v17 offset:9216
    v_mfma_f32_16x16x32_bf16 v[144:147], v[60:63], v[100:103], v[144:147]
    v_add_u32 v17, 0x10000, v17
    v_cvt_pk_bf16_f32 v34, v34, v31
    v_mfma_f32_16x16x32_bf16 v[148:151], v[56:59], v[104:107], v[148:151]
    v_accvgpr_read_b32 v35, a214
    v_accvgpr_read_b32 v31, a215
    v_mfma_f32_16x16x32_bf16 v[148:151], v[60:63], v[108:111], v[148:151]
    v_cvt_pk_bf16_f32 v35, v35, v31
    v_accvgpr_write_b32 a208, 0
    v_mfma_f32_16x16x32_bf16 v[152:155], v[56:59], v[112:115], v[152:155]
    v_add_u32 v25, 0x10000, v25
    v_accvgpr_write_b32 a209, 0
    v_mfma_f32_16x16x32_bf16 v[152:155], v[60:63], v[116:119], v[152:155]
    ds_read_b128 v[68:71], v25 offset:16384
    v_accvgpr_write_b32 a210, 0
    v_mfma_f32_16x16x32_bf16 v[156:159], v[56:59], v[120:123], v[156:159]
    s_add_u32 m0, s69, 16384
    ds_read_b64_tr_b16 v[56:57], v18 offset:0
    ds_read_b64_tr_b16 v[58:59], v18 offset:1024
    v_mfma_f32_16x16x32_bf16 v[156:159], v[60:63], v[124:127], v[156:159]
    s_xor_b32 s65, s65, 8192
    buffer_load_dwordx4 v10, s[20:23], s64 offen lds
    s_waitcnt lgkmcnt(3)
    v_mfma_f32_16x16x32_bf16 v[160:163], v[40:43], v[96:99], v[160:163]
    s_xor_b32 s66, s66, 128
    ds_read_b64_tr_b16 v[60:61], v18 offset:8192
    ds_read_b64_tr_b16 v[62:63], v18 offset:9216
    v_mfma_f32_16x16x32_bf16 v[160:163], v[44:47], v[100:103], v[160:163]
    v_add_u32 v18, 0x10000, v18
    v_accvgpr_write_b32 a211, 0
    v_mfma_f32_16x16x32_bf16 v[164:167], v[40:43], v[104:107], v[164:167]
    buffer_store_dwordx4 v[32:35], v1, s[36:39], s72 offen sc1
    v_mfma_f32_16x16x32_bf16 v[164:167], v[44:47], v[108:111], v[164:167]
    v_accvgpr_read_b32 v31, a217
    v_accvgpr_read_b32 v32, a216
    v_mfma_f32_16x16x32_bf16 v[168:171], v[40:43], v[112:115], v[168:171]
    v_cvt_pk_bf16_f32 v32, v32, v31
    v_accvgpr_read_b32 v33, a218
    v_mfma_f32_16x16x32_bf16 v[168:171], v[44:47], v[116:119], v[168:171]
    v_accvgpr_read_b32 v31, a219
    v_cvt_pk_bf16_f32 v33, v33, v31
    v_mfma_f32_16x16x32_bf16 v[172:175], v[40:43], v[120:123], v[172:175]
    ds_read_b64_tr_b16 v[40:41], v19 offset:0
    ds_read_b64_tr_b16 v[42:43], v19 offset:1024
    v_mfma_f32_16x16x32_bf16 v[172:175], v[44:47], v[124:127], v[172:175]
    ds_read_b64_tr_b16 v[44:45], v19 offset:8192
    ds_read_b64_tr_b16 v[46:47], v19 offset:9216
    v_mfma_f32_16x16x32_bf16 v[176:179], v[48:51], v[96:99], v[176:179]
    buffer_load_dwordx4 v11, s[20:23], s64 offen offset:1024 lds
    v_mfma_f32_16x16x32_bf16 v[176:179], v[52:55], v[100:103], v[176:179]
    ds_read_b128 v[72:75], v24 offset:24576
    v_add_u32 v19, 0x10000, v19
    v_mfma_f32_16x16x32_bf16 v[180:183], v[48:51], v[104:107], v[180:183]
    v_accvgpr_read_b32 v34, a220
    v_accvgpr_read_b32 v31, a221
    v_mfma_f32_16x16x32_bf16 v[180:183], v[52:55], v[108:111], v[180:183]
    v_cvt_pk_bf16_f32 v34, v34, v31
    v_accvgpr_read_b32 v35, a222
    v_mfma_f32_16x16x32_bf16 v[184:187], v[48:51], v[112:115], v[184:187]
    v_accvgpr_read_b32 v31, a223
    v_cvt_pk_bf16_f32 v35, v35, v31
    v_mfma_f32_16x16x32_bf16 v[184:187], v[52:55], v[116:119], v[184:187]
    v_accvgpr_write_b32 a212, 0
    v_accvgpr_write_b32 a213, 0
    v_mfma_f32_16x16x32_bf16 v[188:191], v[48:51], v[120:123], v[188:191]
    s_add_u32 s72, s71, 37888
    ds_read_b64_tr_b16 v[48:49], v20 offset:0
    ds_read_b64_tr_b16 v[50:51], v20 offset:1024
    v_mfma_f32_16x16x32_bf16 v[188:191], v[52:55], v[124:127], v[188:191]
    s_waitcnt lgkmcnt(2)
    ds_read_b64_tr_b16 v[52:53], v20 offset:8192
    ds_read_b64_tr_b16 v[54:55], v20 offset:9216
    v_mfma_f32_16x16x32_bf16 v[192:195], v[56:59], v[96:99], v[192:195]
    buffer_load_dwordx4 v12, s[20:23], s64 offen offset:2048 lds
    v_mfma_f32_16x16x32_bf16 v[192:195], v[60:63], v[100:103], v[192:195]
    v_add_u32 v20, 0x10000, v20
    v_accvgpr_write_b32 a214, 0
    v_mfma_f32_16x16x32_bf16 v[196:199], v[56:59], v[104:107], v[196:199]
    buffer_store_dwordx4 v[32:35], v1, s[36:39], s72 offen sc1
    v_mfma_f32_16x16x32_bf16 v[196:199], v[60:63], v[108:111], v[196:199]
    ds_read_b128 v[76:79], v25 offset:24576
    v_accvgpr_write_b32 a215, 0
    v_mfma_f32_16x16x32_bf16 v[200:203], v[56:59], v[112:115], v[200:203]
    v_accvgpr_write_b32 a216, 0
    v_accvgpr_write_b32 a217, 0
    v_mfma_f32_16x16x32_bf16 v[200:203], v[60:63], v[116:119], v[200:203]
    v_accvgpr_write_b32 a218, 0
    v_accvgpr_write_b32 a219, 0
    v_mfma_f32_16x16x32_bf16 v[204:207], v[56:59], v[120:123], v[204:207]
    ds_read_b64_tr_b16 v[56:57], v21 offset:0
    ds_read_b64_tr_b16 v[58:59], v21 offset:1024
    v_mfma_f32_16x16x32_bf16 v[204:207], v[60:63], v[124:127], v[204:207]
    ds_read_b64_tr_b16 v[60:61], v21 offset:8192
    ds_read_b64_tr_b16 v[62:63], v21 offset:9216
    v_mfma_f32_16x16x32_bf16 v[208:211], v[40:43], v[96:99], v[208:211]
    v_add_u32 v21, 0x10000, v21
    v_accvgpr_write_b32 a220, 0
    v_mfma_f32_16x16x32_bf16 v[208:211], v[44:47], v[100:103], v[208:211]
    buffer_load_dwordx4 v13, s[20:23], s64 offen offset:3072 lds
    v_mfma_f32_16x16x32_bf16 v[212:215], v[40:43], v[104:107], v[212:215]
    v_accvgpr_write_b32 a221, 0
    v_accvgpr_write_b32 a222, 0
    v_mfma_f32_16x16x32_bf16 v[212:215], v[44:47], v[108:111], v[212:215]
    v_accvgpr_write_b32 a223, 0
    v_mfma_f32_16x16x32_bf16 v[216:219], v[40:43], v[112:115], v[216:219]
    v_accvgpr_read_b32 v32, a224
    v_accvgpr_read_b32 v31, a225
    v_mfma_f32_16x16x32_bf16 v[216:219], v[44:47], v[116:119], v[216:219]
    v_cvt_pk_bf16_f32 v32, v32, v31
    v_accvgpr_read_b32 v33, a226
    v_mfma_f32_16x16x32_bf16 v[220:223], v[40:43], v[120:123], v[220:223]
    ds_read_b64_tr_b16 v[40:41], v26 offset:32768
    ds_read_b64_tr_b16 v[42:43], v26 offset:33280
    v_mfma_f32_16x16x32_bf16 v[220:223], v[44:47], v[124:127], v[220:223]
    s_waitcnt lgkmcnt(2)
    ds_read_b64_tr_b16 v[44:45], v26 offset:36864
    ds_read_b64_tr_b16 v[46:47], v26 offset:37376
    v_mfma_f32_16x16x32_bf16 v[224:227], v[48:51], v[96:99], v[224:227]
    v_add_u32 v26, 0xffff0000, v26
    v_accvgpr_read_b32 v31, a227
    v_mfma_f32_16x16x32_bf16 v[224:227], v[52:55], v[100:103], v[224:227]
    s_xor_b32 s64, s64, 1920
    v_cvt_pk_bf16_f32 v33, v33, v31
    v_accvgpr_read_b32 v34, a228
    v_mfma_f32_16x16x32_bf16 v[228:231], v[48:51], v[104:107], v[228:231]
    s_andn2_b32 s64, s64, 896
    v_accvgpr_read_b32 v31, a229
    v_cvt_pk_bf16_f32 v34, v34, v31
    v_mfma_f32_16x16x32_bf16 v[228:231], v[52:55], v[108:111], v[228:231]
    v_accvgpr_read_b32 v35, a230
    v_accvgpr_read_b32 v31, a231
    v_mfma_f32_16x16x32_bf16 v[232:235], v[48:51], v[112:115], v[232:235]
    v_cvt_pk_bf16_f32 v35, v35, v31
    v_mfma_f32_16x16x32_bf16 v[232:235], v[52:55], v[116:119], v[232:235]
    s_add_u32 m0, s69, 32768
    v_mfma_f32_16x16x32_bf16 v[236:239], v[48:51], v[120:123], v[236:239]
    buffer_load_dwordx4 v2, s[24:27], s60 offen lds
    v_mfma_f32_16x16x32_bf16 v[236:239], v[52:55], v[124:127], v[236:239]
    s_add_u32 s72, s71, 6144
    ds_read_b64_tr_b16 v[48:49], v27 offset:32768
    ds_read_b64_tr_b16 v[50:51], v27 offset:33280
    v_mfma_f32_16x16x32_bf16 v[240:243], v[56:59], v[96:99], v[240:243]
    ds_read_b64_tr_b16 v[52:53], v27 offset:36864
    ds_read_b64_tr_b16 v[54:55], v27 offset:37376
    v_mfma_f32_16x16x32_bf16 v[240:243], v[60:63], v[100:103], v[240:243]
    buffer_store_dwordx4 v[32:35], v1, s[36:39], s72 offen sc1
    v_mfma_f32_16x16x32_bf16 v[244:247], v[56:59], v[104:107], v[244:247]
    buffer_load_dwordx4 v3, s[24:27], s60 offen offset:1024 lds
    v_mfma_f32_16x16x32_bf16 v[244:247], v[60:63], v[108:111], v[244:247]
    v_add_u32 v27, 0xffff0000, v27
    v_mfma_f32_16x16x32_bf16 v[248:251], v[56:59], v[112:115], v[248:251]
    v_mfma_f32_16x16x32_bf16 v[248:251], v[60:63], v[116:119], v[248:251]
    v_mfma_f32_16x16x32_bf16 v[252:255], v[56:59], v[120:123], v[252:255]
    buffer_load_dwordx4 v4, s[24:27], s60 offen offset:2048 lds
    v_mfma_f32_16x16x32_bf16 v[252:255], v[60:63], v[124:127], v[252:255]
    s_waitcnt lgkmcnt(0)
    ds_read_b64_tr_b16 v[56:57], v28 offset:32768
    ds_read_b64_tr_b16 v[58:59], v28 offset:33280
    v_mfma_f32_16x16x32_bf16 a[64:67], v[40:43], v[96:99], a[64:67]
    ds_read_b64_tr_b16 v[60:61], v28 offset:36864
    ds_read_b64_tr_b16 v[62:63], v28 offset:37376
    v_mfma_f32_16x16x32_bf16 a[64:67], v[44:47], v[100:103], a[64:67]
    v_add_u32 v28, 0xffff0000, v28
    v_mfma_f32_16x16x32_bf16 a[68:71], v[40:43], v[104:107], a[68:71]
    buffer_load_dwordx4 v5, s[24:27], s60 offen offset:3072 lds
    v_mfma_f32_16x16x32_bf16 a[68:71], v[44:47], v[108:111], a[68:71]
    ds_read_b128 v[80:83], v24 offset:49152
    v_mfma_f32_16x16x32_bf16 a[72:75], v[40:43], v[112:115], a[72:75]
    v_mfma_f32_16x16x32_bf16 a[72:75], v[44:47], v[116:119], a[72:75]
    s_xor_b32 s60, s60, 7864320
    v_accvgpr_read_b32 v32, a232
    v_accvgpr_read_b32 v31, a233
    v_mfma_f32_16x16x32_bf16 a[76:79], v[40:43], v[120:123], a[76:79]
    s_add_u32 m0, s69, 49152
    ds_read_b128 v[84:87], v25 offset:49152
    v_cvt_pk_bf16_f32 v32, v32, v31
    v_mfma_f32_16x16x32_bf16 a[76:79], v[44:47], v[124:127], a[76:79]
    s_andn2_b32 s60, s60, 3670016
    buffer_load_dwordx4 v10, s[20:23], s63 offen lds
    v_mfma_f32_16x16x32_bf16 a[128:131], v[40:43], a[136:139], a[128:131]
    ds_read_b64_tr_b16 v[40:41], v29 offset:32768
    ds_read_b64_tr_b16 v[42:43], v29 offset:33280
    v_mfma_f32_16x16x32_bf16 a[128:131], v[44:47], a[140:143], a[128:131]
    ds_read_b64_tr_b16 v[44:45], v29 offset:36864
    ds_read_b64_tr_b16 v[46:47], v29 offset:37376
    v_mfma_f32_16x16x32_bf16 a[80:83], v[48:51], v[96:99], a[80:83]
    buffer_load_dwordx4 v11, s[20:23], s63 offen offset:1024 lds
    v_mfma_f32_16x16x32_bf16 a[80:83], v[52:55], v[100:103], a[80:83]
    ds_read_b128 v[88:91], v24 offset:57344
    v_add_u32 v29, 0xffff0000, v29
    v_mfma_f32_16x16x32_bf16 a[84:87], v[48:51], v[104:107], a[84:87]
    v_accvgpr_read_b32 v33, a234
    v_accvgpr_read_b32 v31, a235
    v_mfma_f32_16x16x32_bf16 a[84:87], v[52:55], v[108:111], a[84:87]
    v_cvt_pk_bf16_f32 v33, v33, v31
    v_accvgpr_read_b32 v34, a236
    v_mfma_f32_16x16x32_bf16 a[88:91], v[48:51], v[112:115], a[88:91]
    buffer_load_dwordx4 v12, s[20:23], s63 offen offset:2048 lds
    v_mfma_f32_16x16x32_bf16 a[88:91], v[52:55], v[116:119], a[88:91]
    ds_read_b128 v[92:95], v25 offset:57344
    v_accvgpr_read_b32 v31, a237
    v_mfma_f32_16x16x32_bf16 a[92:95], v[48:51], v[120:123], a[92:95]
    s_add_u32 s72, s71, 7168
    v_cvt_pk_bf16_f32 v34, v34, v31
    v_accvgpr_read_b32 v35, a238
    v_mfma_f32_16x16x32_bf16 a[92:95], v[52:55], v[124:127], a[92:95]
    v_accvgpr_read_b32 v31, a239
    v_cvt_pk_bf16_f32 v35, v35, v31
    v_mfma_f32_16x16x32_bf16 a[132:135], v[48:51], a[136:139], a[132:135]
    buffer_load_dwordx4 v13, s[20:23], s63 offen offset:3072 lds
    v_mfma_f32_16x16x32_bf16 a[132:135], v[52:55], a[140:143], a[132:135]
    s_waitcnt lgkmcnt(1)
    v_mfma_f32_16x16x32_bf16 a[96:99], v[56:59], v[96:99], a[96:99]
    v_mfma_f32_16x16x32_bf16 a[96:99], v[60:63], v[100:103], a[96:99]
    s_xor_b32 s63, s63, 128
    v_mfma_f32_16x16x32_bf16 a[100:103], v[56:59], v[104:107], a[100:103]
    buffer_store_dwordx4 v[32:35], v1, s[36:39], s72 offen sc1
    v_mfma_f32_16x16x32_bf16 a[100:103], v[60:63], v[108:111], a[100:103]
    v_mfma_f32_16x16x32_bf16 a[104:107], v[56:59], v[112:115], a[104:107]
    v_mfma_f32_16x16x32_bf16 a[104:107], v[60:63], v[116:119], a[104:107]
    s_waitcnt vmcnt(10) lgkmcnt(0)
    s_barrier
    ds_read_b64_tr_b16 v[48:49], v14 offset:0
    v_mfma_f32_16x16x32_bf16 a[108:111], v[56:59], v[120:123], a[108:111]
    s_add_u32 m0, s69, 65536
    ds_read_b64_tr_b16 v[50:51], v14 offset:1024
    ds_read_b64_tr_b16 v[52:53], v14 offset:8192
    v_mfma_f32_16x16x32_bf16 a[108:111], v[60:63], v[124:127], a[108:111]
    buffer_load_dwordx4 v2, s[24:27], s60 offen lds
    v_mfma_f32_16x16x32_bf16 a[112:115], v[40:43], v[96:99], a[112:115]
    ds_read_b64_tr_b16 v[54:55], v14 offset:9216
    ds_read_b64_tr_b16 v[56:57], v15 offset:0
    v_mfma_f32_16x16x32_bf16 a[112:115], v[44:47], v[100:103], a[112:115]
    ds_read_b64_tr_b16 v[58:59], v15 offset:1024
    ds_read_b64_tr_b16 v[60:61], v15 offset:8192
    v_mfma_f32_16x16x32_bf16 a[116:119], v[40:43], v[104:107], a[116:119]
    ds_read_b64_tr_b16 v[62:63], v15 offset:9216
    ds_read_b128 a[136:139], v22 offset:0
    v_mfma_f32_16x16x32_bf16 a[116:119], v[44:47], v[108:111], a[116:119]
    ds_read_b128 a[140:143], v23 offset:0
    v_add_u32 v14, 0xfffe0000, v14
    v_mfma_f32_16x16x32_bf16 a[120:123], v[40:43], v[112:115], a[120:123]
    v_add_u32 v15, 0xfffe0000, v15
    v_add_u32 v22, 0x10000, v22
    v_mfma_f32_16x16x32_bf16 a[120:123], v[44:47], v[116:119], a[120:123]
    buffer_load_dwordx4 v3, s[24:27], s60 offen offset:1024 lds
    v_mfma_f32_16x16x32_bf16 a[124:127], v[40:43], v[120:123], a[124:127]
    ds_read_b64_tr_b16 v[40:41], v16 offset:0
    ds_read_b64_tr_b16 v[42:43], v16 offset:1024
    v_mfma_f32_16x16x32_bf16 a[124:127], v[44:47], v[124:127], a[124:127]
    s_waitcnt lgkmcnt(3)
    ds_read_b64_tr_b16 v[44:45], v16 offset:8192
    ds_read_b64_tr_b16 v[46:47], v16 offset:9216
    v_mfma_f32_16x16x32_bf16 v[128:131], v[48:51], v[64:67], v[128:131]
    v_add_u32 v16, 0xfffe0000, v16
    v_add_u32 v23, 0x10000, v23
    v_mfma_f32_16x16x32_bf16 v[128:131], v[52:55], v[68:71], v[128:131]
    v_add_u32 v24, 0x10000, v24
    v_accvgpr_read_b32 v32, a240
    v_mfma_f32_16x16x32_bf16 v[132:135], v[48:51], v[72:75], v[132:135]
    ds_read_b128 v[96:99], v24 offset:16384
    v_accvgpr_read_b32 v31, a241
    v_mfma_f32_16x16x32_bf16 v[132:135], v[52:55], v[76:79], v[132:135]
    v_cvt_pk_bf16_f32 v32, v32, v31
    v_accvgpr_read_b32 v33, a242
    v_mfma_f32_16x16x32_bf16 v[136:139], v[48:51], v[80:83], v[136:139]
    v_accvgpr_read_b32 v31, a243
    v_cvt_pk_bf16_f32 v33, v33, v31
    v_mfma_f32_16x16x32_bf16 v[136:139], v[52:55], v[84:87], v[136:139]
    s_add_u32 s72, s71, 38912
    buffer_load_dwordx4 v4, s[24:27], s60 offen offset:2048 lds
    v_mfma_f32_16x16x32_bf16 v[140:143], v[48:51], v[88:91], v[140:143]
    ds_read_b64_tr_b16 v[48:49], v17 offset:0
    ds_read_b64_tr_b16 v[50:51], v17 offset:1024
    v_mfma_f32_16x16x32_bf16 v[140:143], v[52:55], v[92:95], v[140:143]
    ds_read_b64_tr_b16 v[52:53], v17 offset:8192
    ds_read_b64_tr_b16 v[54:55], v17 offset:9216
    v_mfma_f32_16x16x32_bf16 v[144:147], v[56:59], v[64:67], v[144:147]
    v_add_u32 v17, 0xfffe0000, v17
    v_accvgpr_read_b32 v34, a244
    v_mfma_f32_16x16x32_bf16 v[144:147], v[60:63], v[68:71], v[144:147]
    v_accvgpr_read_b32 v31, a245
    v_cvt_pk_bf16_f32 v34, v34, v31
    v_mfma_f32_16x16x32_bf16 v[148:151], v[56:59], v[72:75], v[148:151]
    v_accvgpr_read_b32 v35, a246
    v_accvgpr_read_b32 v31, a247
    v_mfma_f32_16x16x32_bf16 v[148:151], v[60:63], v[76:79], v[148:151]
    v_cvt_pk_bf16_f32 v35, v35, v31
    v_mov_b32 v2, v1
    v_mfma_f32_16x16x32_bf16 v[152:155], v[56:59], v[80:83], v[152:155]
    buffer_load_dwordx4 v5, s[24:27], s60 offen offset:3072 lds
    v_mfma_f32_16x16x32_bf16 v[152:155], v[60:63], v[84:87], v[152:155]
    v_add_u32 v25, 0x10000, v25
    ds_read_b128 v[100:103], v25 offset:16384
    v_mfma_f32_16x16x32_bf16 v[156:159], v[56:59], v[88:91], v[156:159]
    ds_read_b64_tr_b16 v[56:57], v18 offset:0
    ds_read_b64_tr_b16 v[58:59], v18 offset:1024
    v_mfma_f32_16x16x32_bf16 v[156:159], v[60:63], v[92:95], v[156:159]
    s_waitcnt lgkmcnt(3)
    ds_read_b64_tr_b16 v[60:61], v18 offset:8192
    ds_read_b64_tr_b16 v[62:63], v18 offset:9216
    v_mfma_f32_16x16x32_bf16 v[160:163], v[40:43], v[64:67], v[160:163]
    buffer_store_dwordx4 v[32:35], v1, s[36:39], s72 offen sc1
    v_mfma_f32_16x16x32_bf16 v[160:163], v[44:47], v[68:71], v[160:163]
    v_add_u32 v18, 0xfffe0000, v18
    v_mfma_f32_16x16x32_bf16 v[164:167], v[40:43], v[72:75], v[164:167]
    v_mfma_f32_16x16x32_bf16 v[164:167], v[44:47], v[76:79], v[164:167]
    s_add_u32 m0, s69, 81920
    v_accvgpr_read_b32 v32, a248
    v_accvgpr_read_b32 v31, a249
    v_mfma_f32_16x16x32_bf16 v[168:171], v[40:43], v[80:83], v[168:171]
    s_xor_b32 s60, s60, 524288
    buffer_load_dwordx4 v10, s[20:23], s64 offen lds
    v_mfma_f32_16x16x32_bf16 v[168:171], v[44:47], v[84:87], v[168:171]
    s_mov_b32 s60, 131072
    v_cvt_pk_bf16_f32 v32, v32, v31
    v_accvgpr_read_b32 v33, a250
    v_mfma_f32_16x16x32_bf16 v[172:175], v[40:43], v[88:91], v[172:175]
    ds_read_b64_tr_b16 v[40:41], v19 offset:0
    ds_read_b64_tr_b16 v[42:43], v19 offset:1024
    v_mfma_f32_16x16x32_bf16 v[172:175], v[44:47], v[92:95], v[172:175]
    ds_read_b64_tr_b16 v[44:45], v19 offset:8192
    ds_read_b64_tr_b16 v[46:47], v19 offset:9216
    v_mfma_f32_16x16x32_bf16 v[176:179], v[48:51], v[64:67], v[176:179]
    ds_read_b128 v[104:107], v24 offset:24576
    v_add_u32 v19, 0xfffe0000, v19
    v_mfma_f32_16x16x32_bf16 v[176:179], v[52:55], v[68:71], v[176:179]
    v_accvgpr_read_b32 v31, a251
    v_cvt_pk_bf16_f32 v33, v33, v31
    v_mfma_f32_16x16x32_bf16 v[180:183], v[48:51], v[72:75], v[180:183]
    v_accvgpr_read_b32 v34, a252
    v_accvgpr_read_b32 v31, a253
    v_mfma_f32_16x16x32_bf16 v[180:183], v[52:55], v[76:79], v[180:183]
    buffer_load_dwordx4 v11, s[20:23], s64 offen offset:1024 lds
    v_mfma_f32_16x16x32_bf16 v[184:187], v[48:51], v[80:83], v[184:187]
    v_cvt_pk_bf16_f32 v34, v34, v31
    v_accvgpr_read_b32 v35, a254
    v_mfma_f32_16x16x32_bf16 v[184:187], v[52:55], v[84:87], v[184:187]
    v_accvgpr_read_b32 v31, a255
    v_cvt_pk_bf16_f32 v35, v35, v31
    v_mfma_f32_16x16x32_bf16 v[188:191], v[48:51], v[88:91], v[188:191]
    s_add_u32 s72, s71, 39936
    ds_read_b64_tr_b16 v[48:49], v20 offset:0
    ds_read_b64_tr_b16 v[50:51], v20 offset:1024
    v_mfma_f32_16x16x32_bf16 v[188:191], v[52:55], v[92:95], v[188:191]
    s_waitcnt lgkmcnt(2)
    ds_read_b64_tr_b16 v[52:53], v20 offset:8192
    ds_read_b64_tr_b16 v[54:55], v20 offset:9216
    v_mfma_f32_16x16x32_bf16 v[192:195], v[56:59], v[64:67], v[192:195]
    v_mov_b32 v31, 1
    v_add_u32 v20, 0xfffe0000, v20
    v_mfma_f32_16x16x32_bf16 v[192:195], v[60:63], v[68:71], v[192:195]
    buffer_store_dwordx4 v[32:35], v1, s[36:39], s72 offen sc1
    v_mfma_f32_16x16x32_bf16 v[196:199], v[56:59], v[72:75], v[196:199]
    v_add_u32 v11, s99, v39
    v_mfma_f32_16x16x32_bf16 v[196:199], v[60:63], v[76:79], v[196:199]
    s_mul_i32 s99, s98, 6
    buffer_load_dwordx4 v12, s[20:23], s64 offen offset:2048 lds
    v_mfma_f32_16x16x32_bf16 v[200:203], v[56:59], v[80:83], v[200:203]
    s_sub_u32 s99, s8, s99
    ds_read_b128 v[108:111], v25 offset:24576
    v_mfma_f32_16x16x32_bf16 v[200:203], v[60:63], v[84:87], v[200:203]
    s_mul_i32 s99, s99, 6
    v_mfma_f32_16x16x32_bf16 v[204:207], v[56:59], v[88:91], v[204:207]
    s_lshl1_add_u32 s99, s4, s99
    ds_read_b64_tr_b16 v[56:57], v21 offset:0
    ds_read_b64_tr_b16 v[58:59], v21 offset:1024
    v_mfma_f32_16x16x32_bf16 v[204:207], v[60:63], v[92:95], v[204:207]
    s_sub_u32 s99, s99, 2
    ds_read_b64_tr_b16 v[60:61], v21 offset:8192
    ds_read_b64_tr_b16 v[62:63], v21 offset:9216
    v_mfma_f32_16x16x32_bf16 v[208:211], v[40:43], v[64:67], v[208:211]
    s_lshl_b32 s8, s99, 5
    v_add_u32 v21, 0xfffe0000, v21
    v_lshl_add_u32 v10, v38, 4, s8
    v_mfma_f32_16x16x32_bf16 v[208:211], v[44:47], v[68:71], v[208:211]
    s_lshr_b32 s8, s5, 3
    v_lshrrev_b32 v38, 3, v37
    v_mul_u32_u24 v39, 18, v38
    v_mfma_f32_16x16x32_bf16 v[212:215], v[40:43], v[72:75], v[212:215]
    s_mul_i32 s8, s8, 6
    buffer_load_dwordx4 v13, s[20:23], s64 offen offset:3072 lds
    v_mfma_f32_16x16x32_bf16 v[212:215], v[44:47], v[76:79], v[212:215]
    s_cmp_lt_u32 s98, 5
    s_cselect_b32 s98, s98, 40
    v_and_b32 v38, 4, v37
    v_mfma_f32_16x16x32_bf16 v[216:219], v[40:43], v[80:83], v[216:219]
    s_lshl1_add_u32 s9, s98, s9
    v_lshl_add_u32 v39, v38, 1, v39
    v_lshrrev_b32 v38, 2, v37
    v_mfma_f32_16x16x32_bf16 v[216:219], v[44:47], v[84:87], v[216:219]
    s_mul_i32 s9, s9, 18
    v_mul_u32_u24 v38, 36, v38
    v_add_u32 v39, s9, v39
    v_mfma_f32_16x16x32_bf16 v[220:223], v[40:43], v[88:91], v[220:223]
    s_lshr_b32 s99, s99, 1
    ds_read_b64_tr_b16 v[40:41], v26 offset:0
    ds_read_b64_tr_b16 v[42:43], v26 offset:512
    v_mfma_f32_16x16x32_bf16 v[220:223], v[44:47], v[92:95], v[220:223]
    s_waitcnt lgkmcnt(2)
    ds_read_b64_tr_b16 v[44:45], v26 offset:4096
    ds_read_b64_tr_b16 v[46:47], v26 offset:4608
    v_mfma_f32_16x16x32_bf16 v[224:227], v[48:51], v[64:67], v[224:227]
    v_add_u32 v26, 0x10000, v26
    v_add_u32 v38, s10, v38
    v_mfma_f32_16x16x32_bf16 v[224:227], v[52:55], v[68:71], v[224:227]
    s_xor_b32 s64, s64, 128
    v_and_b32 v37, 3, v37
    v_mfma_f32_16x16x32_bf16 v[228:231], v[48:51], v[72:75], v[228:231]
    s_cmp_eq_u32 s98, 4
    s_cselect_b64 vcc, -1, 0
    v_cndmask_b32 v39, v39, v38, vcc
    v_mfma_f32_16x16x32_bf16 v[228:231], v[52:55], v[76:79], v[228:231]
    v_add_u32 v39, v39, v37
    v_mul_u32_u24 v39, 1152, v39
    v_mfma_f32_16x16x32_bf16 v[232:235], v[48:51], v[80:83], v[232:235]
    s_cmp_eq_u32 s98, 4
    s_cselect_b32 s9, 18, 4
    s_cselect_b32 s10, 2, 4
    v_mfma_f32_16x16x32_bf16 v[232:235], v[52:55], v[84:87], v[232:235]
    s_add_u32 m0, s67, 98304
    v_add_u32 v39, v39, v10
    v_mov_b32 v38, 1073741824
    v_mfma_f32_16x16x32_bf16 v[236:239], v[48:51], v[88:91], v[236:239]
    s_mul_i32 s9, s9, 1152
    buffer_load_dwordx4 v1, s[28:31], s65 offen sc1 lds
    v_mfma_f32_16x16x32_bf16 v[236:239], v[52:55], v[92:95], v[236:239]
    s_add_u32 s98, s98, s8
    ds_read_b64_tr_b16 v[48:49], v27 offset:0
    ds_read_b64_tr_b16 v[50:51], v27 offset:512
    v_mfma_f32_16x16x32_bf16 v[240:243], v[56:59], v[64:67], v[240:243]
    s_add_u32 s98, s98, 128
    ds_read_b64_tr_b16 v[52:53], v27 offset:4096
    ds_read_b64_tr_b16 v[54:55], v27 offset:4608
    v_mfma_f32_16x16x32_bf16 v[240:243], v[60:63], v[68:71], v[240:243]
    s_add_u32 s8, s100, 16
    v_add_u32 v27, 0x10000, v27
    v_cmp_gt_u32 vcc, s10, v37
    v_mfma_f32_16x16x32_bf16 v[244:247], v[56:59], v[72:75], v[244:247]
    s_lshr_b32 s10, s5, 3
    v_cndmask_b32 v12, v38, v39, vcc
    v_add_u32 v38, 1024, v36
    v_mfma_f32_16x16x32_bf16 v[244:247], v[60:63], v[76:79], v[244:247]
    s_cmp_eq_u32 s4, 0
    s_cselect_b64 vcc, -1, 0
    v_add_u32 v13, s9, v12
    v_mfma_f32_16x16x32_bf16 v[248:251], v[56:59], v[80:83], v[248:251]
    v_cndmask_b32 v12, v12, v38, vcc
    v_add_u32 v38, 19456, v36
    v_mfma_f32_16x16x32_bf16 v[248:251], v[60:63], v[84:87], v[248:251]
    s_cmp_eq_u32 s4, 0
    s_cselect_b64 vcc, -1, 0
    v_cndmask_b32 v13, v13, v38, vcc
    v_mfma_f32_16x16x32_bf16 v[252:255], v[56:59], v[88:91], v[252:255]
    ds_read_b64_tr_b16 v[56:57], v28 offset:0
    ds_read_b64_tr_b16 v[58:59], v28 offset:512
    v_mfma_f32_16x16x32_bf16 v[252:255], v[60:63], v[92:95], v[252:255]
    s_waitcnt lgkmcnt(2)
    ds_read_b64_tr_b16 v[60:61], v28 offset:4096
    ds_read_b64_tr_b16 v[62:63], v28 offset:4608
    v_mfma_f32_16x16x32_bf16 a[64:67], v[40:43], v[64:67], a[64:67]
    buffer_load_dwordx4 v1, s[28:31], s65 offen offset:1024 sc1 lds
    v_mfma_f32_16x16x32_bf16 a[64:67], v[44:47], v[68:71], a[64:67]
    v_add_u32 v24, 0xfffe0000, v24
    v_add_u32 v28, 0x10000, v28
    v_mfma_f32_16x16x32_bf16 a[68:71], v[40:43], v[72:75], a[68:71]
    ds_read_b128 v[112:115], v24 offset:16384
    v_lshrrev_b32 v37, 8, v1
    v_mfma_f32_16x16x32_bf16 a[68:71], v[44:47], v[76:79], a[68:71]
    s_cmp_eq_u32 s4, 0
    s_cselect_b32 s98, s7, s98
    s_cselect_b32 s99, s8, s99
    v_mfma_f32_16x16x32_bf16 a[72:75], v[40:43], v[80:83], a[72:75]
    s_lshr_b32 s9, s99, 2
    v_bfe_u32 v36, v1, 4, 4
    v_lshlrev_b32 v37, 2, v37
    v_mfma_f32_16x16x32_bf16 a[72:75], v[44:47], v[84:87], a[72:75]
    s_sub_u32 s9, s9, s10
    v_add_u32 v25, 0xfffe0000, v25
    v_sub_u32 v36, v36, v37
    v_mfma_f32_16x16x32_bf16 a[76:79], v[40:43], v[88:91], a[76:79]
    s_lshr_b32 s92, s2, 3
    ds_read_b128 v[116:119], v25 offset:16384
    v_lshrrev_b32 v9, 4, v1
    v_mfma_f32_16x16x32_bf16 a[76:79], v[44:47], v[92:95], a[76:79]
    s_lshl2_add_u32 s92, s92, s4
    v_min_u32 v9, 0, v9
    v_mov_b32 v37, 0xf149f2ca
    v_mfma_f32_16x16x32_bf16 a[128:131], v[40:43], a[136:139], a[128:131]
    s_mul_i32 s92, s92, 1
    ds_read_b64_tr_b16 v[40:41], v29 offset:0
    ds_read_b64_tr_b16 v[42:43], v29 offset:512
    v_mfma_f32_16x16x32_bf16 a[128:131], v[44:47], a[140:143], a[128:131]
    s_add_u32 s92, s92, 32
    v_add_lshl_u32 v9, v9, s92, 7
    ds_read_b64_tr_b16 v[44:45], v29 offset:4096
    v_mfma_f32_16x16x32_bf16 a[80:83], v[48:51], v[64:67], a[80:83]
    s_add_u32 m0, s68, 106496
    ds_read_b128 v[120:123], v24 offset:24576
    ds_read_b64_tr_b16 v[46:47], v29 offset:4608
    v_mfma_f32_16x16x32_bf16 a[80:83], v[52:55], v[68:71], a[80:83]
    s_getpc_b64 s[92:93]
    global_load_dword v9, v9, s[92:93]
    v_mfma_f32_16x16x32_bf16 a[84:87], v[48:51], v[72:75], a[84:87]
    s_sub_u32 s9, s9, 1
    buffer_load_dwordx4 v6, s[20:23], s66 offen lds
    v_mfma_f32_16x16x32_bf16 a[84:87], v[52:55], v[76:79], a[84:87]
    s_and_b32 s9, s9, 3
    v_add_u32 v29, 0x10000, v29
    v_bfe_u32 v38, v1, 4, 1
    v_mfma_f32_16x16x32_bf16 a[88:91], v[48:51], v[80:83], a[88:91]
    s_lshl_b32 s9, s9, 1
    ds_read_b128 v[124:127], v25 offset:24576
    v_sub_u32 v38, 0, v38
    v_mfma_f32_16x16x32_bf16 a[88:91], v[52:55], v[84:87], a[88:91]
    s_and_b32 s10, s99, 3
    v_and_b32 v38, 0xaaaaaaaa, v38
    v_and_b32 v39, 0x40, v1
    v_mfma_f32_16x16x32_bf16 a[92:95], v[48:51], v[88:91], a[92:95]
    s_cmp_eq_u32 s9, 6
    s_cselect_b32 s9, 7, s9
    v_mfma_f32_16x16x32_bf16 a[92:95], v[52:55], v[92:95], a[92:95]
    s_mul_i32 s10, s10, 9
    v_mfma_f32_16x16x32_bf16 a[132:135], v[48:51], a[136:139], a[132:135]
    s_add_u32 s9, s9, s10
    v_mfma_f32_16x16x32_bf16 a[132:135], v[52:55], a[140:143], a[132:135]
    s_lshl_b32 s64, s9, 10
    s_waitcnt lgkmcnt(0)
    v_mfma_f32_16x16x32_bf16 a[96:99], v[56:59], v[64:67], a[96:99]
    s_sub_u32 s9, s99, 16
    v_mfma_f32_16x16x32_bf16 a[96:99], v[60:63], v[68:71], a[96:99]
    s_xor_b32 s65, s65, 122880
    v_mfma_f32_16x16x32_bf16 a[100:103], v[56:59], v[72:75], a[100:103]
    s_xor_b32 s66, s66, 1920
    v_mfma_f32_16x16x32_bf16 a[100:103], v[60:63], v[76:79], a[100:103]
    s_andn2_b32 s65, s65, 57344
    v_mfma_f32_16x16x32_bf16 a[104:107], v[56:59], v[80:83], a[104:107]
    s_andn2_b32 s66, s66, 896
    v_mfma_f32_16x16x32_bf16 a[104:107], v[60:63], v[84:87], a[104:107]
    s_waitcnt vmcnt(4) lgkmcnt(0)
    s_barrier
    ds_read_b64_tr_b16 v[48:49], v14 offset:32768
    v_mfma_f32_16x16x32_bf16 a[108:111], v[56:59], v[88:91], a[108:111]
    s_add_u32 m0, s67, 131072
    buffer_store_dword v31, v30, s[32:35], s101 offen sc1
    v_mfma_f32_16x16x32_bf16 a[108:111], v[60:63], v[92:95], a[108:111]
    s_mul_i32 s9, s9, 18432
    buffer_load_dwordx4 v1, s[28:31], s65 offen sc1 lds
    v_mfma_f32_16x16x32_bf16 a[112:115], v[40:43], v[64:67], a[112:115]
    s_add_u32 s9, s9, 6144
    ds_read_b64_tr_b16 v[50:51], v14 offset:33792
    ds_read_b64_tr_b16 v[52:53], v14 offset:40960
    v_mfma_f32_16x16x32_bf16 a[112:115], v[44:47], v[68:71], a[112:115]
    s_mov_b32 s10, 1024
    ds_read_b64_tr_b16 v[54:55], v14 offset:41984
    ds_read_b64_tr_b16 v[56:57], v15 offset:32768
    v_mfma_f32_16x16x32_bf16 a[116:119], v[40:43], v[72:75], a[116:119]
    s_mul_i32 s98, s98, 36864
    ds_read_b64_tr_b16 v[58:59], v15 offset:33792
    ds_read_b64_tr_b16 v[60:61], v15 offset:40960
    v_mfma_f32_16x16x32_bf16 a[116:119], v[44:47], v[76:79], a[116:119]
    s_mul_i32 s7, s7, 36864
    ds_read_b64_tr_b16 v[62:63], v15 offset:41984
    v_add_u32 v14, 0x10000, v14
    v_mfma_f32_16x16x32_bf16 a[120:123], v[40:43], v[80:83], a[120:123]
    s_mov_b32 s93, 65536
    v_add_u32 v15, 0x10000, v15
    v_mfma_f32_16x16x32_bf16 a[120:123], v[44:47], v[84:87], a[120:123]
    s_cmp_lt_u32 s99, 16
    s_cselect_b32 s64, s64, s9
    s_cselect_b32 s10, s10, 9216
    v_mfma_f32_16x16x32_bf16 a[124:127], v[40:43], v[88:91], a[124:127]
    s_lshl2_add_u32 s99, s100, s4
    ds_read_b64_tr_b16 v[40:41], v16 offset:32768
    ds_read_b64_tr_b16 v[42:43], v16 offset:33792
    v_mfma_f32_16x16x32_bf16 a[124:127], v[44:47], v[92:95], a[124:127]
    s_add_u32 s64, s64, s98
    ds_read_b64_tr_b16 v[44:45], v16 offset:40960
    ds_read_b64_tr_b16 v[46:47], v16 offset:41984
    s_waitcnt lgkmcnt(5)
    v_mfma_f32_16x16x32_bf16 v[128:131], v[48:51], v[96:99], v[128:131]
    s_lshl_b32 s99, s99, 1
    v_add_u32 v16, 0x10000, v16
    v_mfma_f32_16x16x32_bf16 v[128:131], v[52:55], v[100:103], v[128:131]
    s_add_u32 s62, s64, s10
    v_mfma_f32_16x16x32_bf16 v[132:135], v[48:51], v[104:107], v[132:135]
    s_lshr_b32 s9, s99, 2
    ds_read_b128 v[64:67], v24 offset:49152
    v_mfma_f32_16x16x32_bf16 v[132:135], v[52:55], v[108:111], v[132:135]
    s_lshr_b32 s10, s5, 3
    v_mfma_f32_16x16x32_bf16 v[136:139], v[48:51], v[112:115], v[136:139]
    s_sub_u32 s9, s9, s10
    v_mfma_f32_16x16x32_bf16 v[136:139], v[52:55], v[116:119], v[136:139]
    s_sub_u32 s9, s9, 1
    v_mfma_f32_16x16x32_bf16 v[140:143], v[48:51], v[120:123], v[140:143]
    s_and_b32 s9, s9, 3
    ds_read_b64_tr_b16 v[48:49], v17 offset:32768
    ds_read_b64_tr_b16 v[50:51], v17 offset:33792
    v_mfma_f32_16x16x32_bf16 v[140:143], v[52:55], v[124:127], v[140:143]
    s_lshl_b32 s9, s9, 1
    ds_read_b64_tr_b16 v[52:53], v17 offset:40960
    ds_read_b64_tr_b16 v[54:55], v17 offset:41984
    v_mfma_f32_16x16x32_bf16 v[144:147], v[56:59], v[96:99], v[144:147]
    s_and_b32 s10, s99, 3
    ds_read_b128 v[68:71], v25 offset:49152
    v_add_u32 v17, 0x10000, v17
    s_waitcnt lgkmcnt(5)
    v_mfma_f32_16x16x32_bf16 v[144:147], v[60:63], v[100:103], v[144:147]
    s_cmp_eq_u32 s9, 6
    s_cselect_b32 s9, 7, s9
    v_mfma_f32_16x16x32_bf16 v[148:151], v[56:59], v[104:107], v[148:151]
    s_mul_i32 s10, s10, 9
    buffer_load_dwordx4 v1, s[28:31], s65 offen offset:1024 sc1 lds
    v_mfma_f32_16x16x32_bf16 v[148:151], v[60:63], v[108:111], v[148:151]
    s_add_u32 s9, s9, s10
    v_mfma_f32_16x16x32_bf16 v[152:155], v[56:59], v[112:115], v[152:155]
    s_lshl_b32 s63, s9, 10
    v_mfma_f32_16x16x32_bf16 v[152:155], v[60:63], v[116:119], v[152:155]
    s_cmp_eq_u32 s4, 0
    s_cselect_b32 s8, 1.0, 0
    v_mfma_f32_16x16x32_bf16 v[156:159], v[56:59], v[120:123], v[156:159]
    s_add_u32 s63, s63, s7
    ds_read_b128 v[72:75], v24 offset:57344
    ds_read_b64_tr_b16 v[56:57], v18 offset:32768
    v_mfma_f32_16x16x32_bf16 v[156:159], v[60:63], v[124:127], v[156:159]
    ds_read_b64_tr_b16 v[58:59], v18 offset:33792
    ds_read_b64_tr_b16 v[60:61], v18 offset:40960
    v_mfma_f32_16x16x32_bf16 v[160:163], v[40:43], v[96:99], v[160:163]
    ds_read_b64_tr_b16 v[62:63], v18 offset:41984
    v_add_u32 v18, 0x10000, v18
    v_mfma_f32_16x16x32_bf16 v[160:163], v[44:47], v[100:103], v[160:163]
    s_cmp_eq_u32 s4, 1
    s_cselect_b32 s9, 1.0, 0
    v_mfma_f32_16x16x32_bf16 v[164:167], v[40:43], v[104:107], v[164:167]
    s_cmp_eq_u32 s6, 0
    s_cselect_b32 s16, s8, 0
    s_cselect_b32 s17, s9, 0
    v_mfma_f32_16x16x32_bf16 v[164:167], v[44:47], v[108:111], v[164:167]
    s_cmp_eq_u32 s4, 2
    s_cselect_b32 s10, 1.0, 0
    v_mfma_f32_16x16x32_bf16 v[168:171], v[40:43], v[112:115], v[168:171]
    ds_read_b128 v[76:79], v25 offset:57344
    v_mfma_f32_16x16x32_bf16 v[168:171], v[44:47], v[116:119], v[168:171]
    s_cmp_eq_u32 s6, 0
    s_cselect_b32 s18, s10, 0
    s_cselect_b32 s19, s11, 0
    v_mfma_f32_16x16x32_bf16 v[172:175], v[40:43], v[120:123], v[172:175]
    ds_read_b64_tr_b16 v[40:41], v19 offset:32768
    ds_read_b64_tr_b16 v[42:43], v19 offset:33792
    v_mfma_f32_16x16x32_bf16 v[172:175], v[44:47], v[124:127], v[172:175]
    s_waitcnt lgkmcnt(3)
    ds_read_b64_tr_b16 v[44:45], v19 offset:40960
    ds_read_b64_tr_b16 v[46:47], v19 offset:41984
    v_mfma_f32_16x16x32_bf16 v[176:179], v[48:51], v[96:99], v[176:179]
    v_add_u32 v19, 0x10000, v19
    v_mfma_f32_16x16x32_bf16 v[176:179], v[52:55], v[100:103], v[176:179]
    v_mfma_f32_16x16x32_bf16 v[180:183], v[48:51], v[104:107], v[180:183]
    v_mfma_f32_16x16x32_bf16 v[180:183], v[52:55], v[108:111], v[180:183]
    v_add_u32 v24, 0x10000, v24
    v_mfma_f32_16x16x32_bf16 v[184:187], v[48:51], v[112:115], v[184:187]
    ds_read_b128 v[80:83], v24 offset:16384
    v_mfma_f32_16x16x32_bf16 v[184:187], v[52:55], v[116:119], v[184:187]
    s_add_u32 m0, s68, 139264
    v_mfma_f32_16x16x32_bf16 v[188:191], v[48:51], v[120:123], v[188:191]
    buffer_load_dwordx4 v6, s[20:23], s66 offen lds
    v_mfma_f32_16x16x32_bf16 v[188:191], v[52:55], v[124:127], v[188:191]
    ds_read_b64_tr_b16 v[48:49], v20 offset:32768
    ds_read_b64_tr_b16 v[50:51], v20 offset:33792
    v_mfma_f32_16x16x32_bf16 v[192:195], v[56:59], v[96:99], v[192:195]
    ds_read_b64_tr_b16 v[52:53], v20 offset:40960
    ds_read_b64_tr_b16 v[54:55], v20 offset:41984
    v_mfma_f32_16x16x32_bf16 v[192:195], v[60:63], v[100:103], v[192:195]
    v_add_u32 v25, 0x10000, v25
    v_add_u32 v20, 0x10000, v20
    v_mfma_f32_16x16x32_bf16 v[196:199], v[56:59], v[104:107], v[196:199]
    ds_read_b128 v[84:87], v25 offset:16384
    v_mfma_f32_16x16x32_bf16 v[196:199], v[60:63], v[108:111], v[196:199]
    s_cmp_eq_u32 s6, 0
    s_cselect_b32 s20, s12, 0
    s_cselect_b32 s21, s13, 0
    v_mfma_f32_16x16x32_bf16 v[200:203], v[56:59], v[112:115], v[200:203]
    s_cmp_eq_u32 s6, 0
    s_cselect_b32 s22, s14, 0
    s_cselect_b32 s23, s15, 0
    v_mfma_f32_16x16x32_bf16 v[200:203], v[60:63], v[116:119], v[200:203]
    v_mfma_f32_16x16x32_bf16 v[204:207], v[56:59], v[120:123], v[204:207]
    ds_read_b64_tr_b16 v[56:57], v21 offset:32768
    ds_read_b64_tr_b16 v[58:59], v21 offset:33792
    v_mfma_f32_16x16x32_bf16 v[204:207], v[60:63], v[124:127], v[204:207]
    s_waitcnt lgkmcnt(2)
    ds_read_b64_tr_b16 v[60:61], v21 offset:40960
    ds_read_b64_tr_b16 v[62:63], v21 offset:41984
    v_mfma_f32_16x16x32_bf16 v[208:211], v[40:43], v[96:99], v[208:211]
    ds_read_b128 v[88:91], v24 offset:24576
    v_add_u32 v21, 0x10000, v21
    v_mfma_f32_16x16x32_bf16 v[208:211], v[44:47], v[100:103], v[208:211]
    v_mfma_f32_16x16x32_bf16 v[212:215], v[40:43], v[104:107], v[212:215]
    v_mfma_f32_16x16x32_bf16 v[212:215], v[44:47], v[108:111], v[212:215]
    v_mfma_f32_16x16x32_bf16 v[216:219], v[40:43], v[112:115], v[216:219]
    v_mfma_f32_16x16x32_bf16 v[216:219], v[44:47], v[116:119], v[216:219]
    v_mfma_f32_16x16x32_bf16 v[220:223], v[40:43], v[120:123], v[220:223]
    ds_read_b128 v[92:95], v25 offset:24576
    ds_read_b64_tr_b16 v[40:41], v14 offset:0
    v_mfma_f32_16x16x32_bf16 v[220:223], v[44:47], v[124:127], v[220:223]
    ds_read_b64_tr_b16 v[42:43], v14 offset:1024
    ds_read_b64_tr_b16 v[44:45], v14 offset:8192
    v_mfma_f32_16x16x32_bf16 v[224:227], v[48:51], v[96:99], v[224:227]
    ds_read_b64_tr_b16 v[46:47], v14 offset:9216
    v_mfma_f32_16x16x32_bf16 v[224:227], v[52:55], v[100:103], v[224:227]
    s_xor_b32 s65, s65, 8192
    v_mfma_f32_16x16x32_bf16 v[228:231], v[48:51], v[104:107], v[228:231]
    s_xor_b32 s66, s66, 128
    v_mfma_f32_16x16x32_bf16 v[228:231], v[52:55], v[108:111], v[228:231]
    v_mfma_f32_16x16x32_bf16 v[232:235], v[48:51], v[112:115], v[232:235]
    v_mfma_f32_16x16x32_bf16 v[232:235], v[52:55], v[116:119], v[232:235]
    v_mfma_f32_16x16x32_bf16 v[236:239], v[48:51], v[120:123], v[236:239]
    ds_read_b64_tr_b16 v[48:49], v15 offset:0
    ds_read_b64_tr_b16 v[50:51], v15 offset:1024
    v_mfma_f32_16x16x32_bf16 v[236:239], v[52:55], v[124:127], v[236:239]
    s_waitcnt lgkmcnt(2)
    ds_read_b64_tr_b16 v[52:53], v15 offset:8192
    ds_read_b64_tr_b16 v[54:55], v15 offset:9216
    v_mfma_f32_16x16x32_bf16 v[240:243], v[56:59], v[96:99], v[240:243]
    v_mfma_f32_16x16x32_bf16 v[240:243], v[60:63], v[100:103], v[240:243]
    v_mfma_f32_16x16x32_bf16 v[244:247], v[56:59], v[104:107], v[244:247]
    v_mfma_f32_16x16x32_bf16 v[244:247], v[60:63], v[108:111], v[244:247]
    v_mfma_f32_16x16x32_bf16 v[248:251], v[56:59], v[112:115], v[248:251]
    v_mfma_f32_16x16x32_bf16 v[248:251], v[60:63], v[116:119], v[248:251]
    v_mfma_f32_16x16x32_bf16 v[252:255], v[56:59], v[120:123], v[252:255]
    ds_read_b64_tr_b16 v[56:57], v16 offset:0
    ds_read_b64_tr_b16 v[58:59], v16 offset:1024
    v_mfma_f32_16x16x32_bf16 v[252:255], v[60:63], v[124:127], v[252:255]
    buffer_load_dword v7, v8, s[32:35], s61 offen sc1
    v_mfma_f32_16x16x32_bf16 v[128:131], v[40:43], v[64:67], v[128:131]
    ds_read_b64_tr_b16 v[60:61], v16 offset:8192
    ds_read_b64_tr_b16 v[62:63], v16 offset:9216
    v_mfma_f32_16x16x32_bf16 v[128:131], v[44:47], v[68:71], v[128:131]
    v_mfma_f32_16x16x32_bf16 v[132:135], v[40:43], v[72:75], v[132:135]
    v_mfma_f32_16x16x32_bf16 v[132:135], v[44:47], v[76:79], v[132:135]
    v_mfma_f32_16x16x32_bf16 v[136:139], v[40:43], v[80:83], v[136:139]
    v_mfma_f32_16x16x32_bf16 v[136:139], v[44:47], v[84:87], v[136:139]
    v_mfma_f32_16x16x32_bf16 v[140:143], v[40:43], v[88:91], v[140:143]
    ds_read_b64_tr_b16 v[40:41], v17 offset:0
    ds_read_b64_tr_b16 v[42:43], v17 offset:1024
    v_mfma_f32_16x16x32_bf16 v[140:143], v[44:47], v[92:95], v[140:143]
    s_waitcnt lgkmcnt(2)
    ds_read_b64_tr_b16 v[44:45], v17 offset:8192
    ds_read_b64_tr_b16 v[46:47], v17 offset:9216
    v_mfma_f32_16x16x32_bf16 v[144:147], v[48:51], v[64:67], v[144:147]
    v_cvt_pk_bf16_f32 v128, v128, v129
    v_cvt_pk_bf16_f32 v129, v130, v131
    v_mfma_f32_16x16x32_bf16 v[144:147], v[52:55], v[68:71], v[144:147]
    v_cvt_pk_bf16_f32 v132, v132, v133
    v_cvt_pk_bf16_f32 v133, v134, v135
    v_mfma_f32_16x16x32_bf16 v[148:151], v[48:51], v[72:75], v[148:151]
    v_cvt_pk_bf16_f32 v136, v136, v137
    v_cvt_pk_bf16_f32 v137, v138, v139
    v_mfma_f32_16x16x32_bf16 v[148:151], v[52:55], v[76:79], v[148:151]
    v_cvt_pk_bf16_f32 v140, v140, v141
    v_cvt_pk_bf16_f32 v141, v142, v143
    v_mfma_f32_16x16x32_bf16 v[152:155], v[48:51], v[80:83], v[152:155]
    v_cvt_pk_bf16_f32 v130, v144, v145
    v_cvt_pk_bf16_f32 v131, v146, v147
    v_mfma_f32_16x16x32_bf16 v[152:155], v[52:55], v[84:87], v[152:155]
    v_mfma_f32_16x16x32_bf16 v[156:159], v[48:51], v[88:91], v[156:159]
    ds_read_b64_tr_b16 v[48:49], v18 offset:0
    ds_read_b64_tr_b16 v[50:51], v18 offset:1024
    v_mfma_f32_16x16x32_bf16 v[156:159], v[52:55], v[92:95], v[156:159]
    ds_read_b64_tr_b16 v[52:53], v18 offset:8192
    ds_read_b64_tr_b16 v[54:55], v18 offset:9216
    v_mfma_f32_16x16x32_bf16 v[160:163], v[56:59], v[64:67], v[160:163]
    v_cvt_pk_bf16_f32 v134, v148, v149
    v_cvt_pk_bf16_f32 v135, v150, v151
    v_mfma_f32_16x16x32_bf16 v[160:163], v[60:63], v[68:71], v[160:163]
    v_cvt_pk_bf16_f32 v138, v152, v153
    v_cvt_pk_bf16_f32 v139, v154, v155
    v_mfma_f32_16x16x32_bf16 v[164:167], v[56:59], v[72:75], v[164:167]
    v_cvt_pk_bf16_f32 v142, v156, v157
    v_cvt_pk_bf16_f32 v143, v158, v159
    v_mfma_f32_16x16x32_bf16 v[164:167], v[60:63], v[76:79], v[164:167]
    v_mfma_f32_16x16x32_bf16 v[168:171], v[56:59], v[80:83], v[168:171]
    v_mfma_f32_16x16x32_bf16 v[168:171], v[60:63], v[84:87], v[168:171]
    v_cvt_pk_bf16_f32 v160, v160, v161
    v_cvt_pk_bf16_f32 v161, v162, v163
    v_mfma_f32_16x16x32_bf16 v[172:175], v[56:59], v[88:91], v[172:175]
    ds_read_b64_tr_b16 v[56:57], v19 offset:0
    ds_read_b64_tr_b16 v[58:59], v19 offset:1024
    v_mfma_f32_16x16x32_bf16 v[172:175], v[60:63], v[92:95], v[172:175]
    s_waitcnt lgkmcnt(2)
    ds_read_b64_tr_b16 v[60:61], v19 offset:8192
    ds_read_b64_tr_b16 v[62:63], v19 offset:9216
    v_mfma_f32_16x16x32_bf16 v[176:179], v[40:43], v[64:67], v[176:179]
    v_cvt_pk_bf16_f32 v164, v164, v165
    v_cvt_pk_bf16_f32 v165, v166, v167
    v_mfma_f32_16x16x32_bf16 v[176:179], v[44:47], v[68:71], v[176:179]
    v_cvt_pk_bf16_f32 v168, v168, v169
    v_cvt_pk_bf16_f32 v169, v170, v171
    v_mfma_f32_16x16x32_bf16 v[180:183], v[40:43], v[72:75], v[180:183]
    v_cvt_pk_bf16_f32 v172, v172, v173
    v_cvt_pk_bf16_f32 v173, v174, v175
    v_mfma_f32_16x16x32_bf16 v[180:183], v[44:47], v[76:79], v[180:183]
    v_mfma_f32_16x16x32_bf16 v[184:187], v[40:43], v[80:83], v[184:187]
    v_mfma_f32_16x16x32_bf16 v[184:187], v[44:47], v[84:87], v[184:187]
    v_cvt_pk_bf16_f32 v162, v176, v177
    v_cvt_pk_bf16_f32 v163, v178, v179
    v_mfma_f32_16x16x32_bf16 v[188:191], v[40:43], v[88:91], v[188:191]
    ds_read_b64_tr_b16 v[40:41], v20 offset:0
    ds_read_b64_tr_b16 v[42:43], v20 offset:1024
    v_mfma_f32_16x16x32_bf16 v[188:191], v[44:47], v[92:95], v[188:191]
    ds_read_b64_tr_b16 v[44:45], v20 offset:8192
    ds_read_b64_tr_b16 v[46:47], v20 offset:9216
    v_mfma_f32_16x16x32_bf16 v[192:195], v[48:51], v[64:67], v[192:195]
    v_cvt_pk_bf16_f32 v166, v180, v181
    v_cvt_pk_bf16_f32 v167, v182, v183
    v_mfma_f32_16x16x32_bf16 v[192:195], v[52:55], v[68:71], v[192:195]
    v_cvt_pk_bf16_f32 v170, v184, v185
    v_cvt_pk_bf16_f32 v171, v186, v187
    s_waitcnt vmcnt(0)
    v_cmp_gt_u32 vcc, 1, v7
    s_nop 1
    s_and_b64 vcc, vcc, exec
    s_cbranch_scc1 SPIN_KV
BACK_KV:
    v_mfma_f32_16x16x32_bf16 v[196:199], v[48:51], v[72:75], v[196:199]
    s_mov_b32 s77, s75
    buffer_load_dwordx4 a[224:227], v1, s[36:39], 0 offen offset:0 sc1
    v_mfma_f32_16x16x32_bf16 v[196:199], v[52:55], v[76:79], v[196:199]
    buffer_load_dwordx4 a[228:231], v1, s[36:39], 0 offen offset:1024 sc1
    v_mfma_f32_16x16x32_bf16 v[200:203], v[48:51], v[80:83], v[200:203]
    v_cmp_le_i32 vcc, 0, v36
    v_cvt_pk_bf16_f32 v192, v192, v193
    v_mfma_f32_16x16x32_bf16 v[200:203], v[52:55], v[84:87], v[200:203]
    v_cvt_pk_bf16_f32 v193, v194, v195
    v_cvt_pk_bf16_f32 v174, v188, v189
    v_mfma_f32_16x16x32_bf16 v[204:207], v[48:51], v[88:91], v[204:207]
    buffer_load_dwordx4 a[232:235], v1, s[36:39], 0 offen offset:2048 sc1
    v_mfma_f32_16x16x32_bf16 v[204:207], v[52:55], v[92:95], v[204:207]
    s_waitcnt lgkmcnt(0)
    ds_read_b64_tr_b16 v[48:49], v21 offset:0
    ds_read_b64_tr_b16 v[50:51], v21 offset:1024
    v_mfma_f32_16x16x32_bf16 v[208:211], v[56:59], v[64:67], v[208:211]
    ds_read_b64_tr_b16 v[52:53], v21 offset:8192
    ds_read_b64_tr_b16 v[54:55], v21 offset:9216
    v_mfma_f32_16x16x32_bf16 v[208:211], v[60:63], v[68:71], v[208:211]
    v_cvt_pk_bf16_f32 v196, v196, v197
    v_cvt_pk_bf16_f32 v197, v198, v199
    v_mfma_f32_16x16x32_bf16 v[212:215], v[56:59], v[72:75], v[212:215]
    buffer_load_dwordx4 a[236:239], v1, s[36:39], 0 offen offset:3072 sc1
    v_mfma_f32_16x16x32_bf16 v[212:215], v[60:63], v[76:79], v[212:215]
    v_cvt_pk_bf16_f32 v200, v200, v201
    v_cvt_pk_bf16_f32 v201, v202, v203
    v_mfma_f32_16x16x32_bf16 v[216:219], v[56:59], v[80:83], v[216:219]
    v_cvt_pk_bf16_f32 v194, v208, v209
    v_cndmask_b32_e64 v208, v37, 0, vcc
    v_mfma_f32_16x16x32_bf16 v[216:219], v[60:63], v[84:87], v[216:219]
    v_mul_f32 v176, s16, v208
    v_cmp_le_i32 vcc, 1, v36
    v_mfma_f32_16x16x32_bf16 v[220:223], v[56:59], v[88:91], v[220:223]
    v_cvt_pk_bf16_f32 v195, v210, v211
    v_cndmask_b32_e64 v209, v37, 0, vcc
    v_mfma_f32_16x16x32_bf16 v[220:223], v[60:63], v[92:95], v[220:223]
    v_mul_f32 v177, s16, v209
    v_cmp_le_i32 vcc, 2, v36
    v_mfma_f32_16x16x32_bf16 v[224:227], v[40:43], v[64:67], v[224:227]
    s_mov_b32 s38, 16384
    v_cndmask_b32_e64 v210, v37, 0, vcc
    v_mul_f32 v178, s16, v210
    v_mfma_f32_16x16x32_bf16 v[224:227], v[44:47], v[68:71], v[224:227]
    s_add_u32 m0, s76, s75
    v_cmp_le_i32 vcc, 3, v36
    v_cvt_pk_bf16_f32 v198, v212, v213
    v_mfma_f32_16x16x32_bf16 v[228:231], v[40:43], v[72:75], v[228:231]
    buffer_load_dwordx4 v1, s[36:39], s77 offen sc1 lds
    v_mfma_f32_16x16x32_bf16 v[228:231], v[44:47], v[76:79], v[228:231]
    v_cndmask_b32_e64 v211, v37, 0, vcc
    v_mul_f32 v179, s16, v211
    v_mfma_f32_16x16x32_bf16 v[232:235], v[40:43], v[80:83], v[232:235]
    v_cvt_pk_bf16_f32 v224, v224, v225
    v_cvt_pk_bf16_f32 v225, v226, v227
    v_mfma_f32_16x16x32_bf16 v[232:235], v[44:47], v[84:87], v[232:235]
    s_waitcnt vmcnt(6) lgkmcnt(0)
    s_barrier
    ds_read_b64_tr_b16 v[56:57], v26 offset:32768
    v_mfma_f32_16x16x32_bf16 v[236:239], v[40:43], v[88:91], v[236:239]
    buffer_load_dwordx4 v1, s[36:39], s77 offen offset:1024 sc1 lds
    v_mfma_f32_16x16x32_bf16 v[236:239], v[44:47], v[92:95], v[236:239]
    ds_read_b64_tr_b16 v[58:59], v26 offset:33280
    ds_read_b64_tr_b16 v[60:61], v26 offset:36864
    v_mfma_f32_16x16x32_bf16 v[240:243], v[48:51], v[64:67], v[240:243]
    ds_read_b64_tr_b16 v[62:63], v26 offset:37376
    ds_read_b128 a[136:139], v22 offset:32768
    v_mfma_f32_16x16x32_bf16 v[240:243], v[52:55], v[68:71], v[240:243]
    ds_read_b128 a[140:143], v23 offset:32768
    v_add_u32 v26, 0x10000, v26
    v_mfma_f32_16x16x32_bf16 v[244:247], v[48:51], v[72:75], v[244:247]
    buffer_load_dwordx4 v1, s[36:39], s77 offen offset:2048 sc1 lds
    v_mfma_f32_16x16x32_bf16 v[244:247], v[52:55], v[76:79], v[244:247]
    ds_read_b64_tr_b16 v[40:41], v27 offset:32768
    ds_read_b64_tr_b16 v[42:43], v27 offset:33280
    v_mfma_f32_16x16x32_bf16 v[248:251], v[48:51], v[80:83], v[248:251]
    ds_read_b64_tr_b16 v[44:45], v27 offset:36864
    ds_read_b64_tr_b16 v[46:47], v27 offset:37376
    v_mfma_f32_16x16x32_bf16 v[248:251], v[52:55], v[84:87], v[248:251]
    v_add_u32 v22, 0x10000, v22
    v_add_u32 v23, 0x10000, v23
    v_mfma_f32_16x16x32_bf16 v[252:255], v[48:51], v[88:91], v[252:255]
    buffer_load_dwordx4 v1, s[36:39], s77 offen offset:3072 sc1 lds
    v_mfma_f32_16x16x32_bf16 v[252:255], v[52:55], v[92:95], v[252:255]
    s_waitcnt lgkmcnt(4)
    ds_read_b64_tr_b16 v[48:49], v28 offset:32768
    ds_read_b64_tr_b16 v[50:51], v28 offset:33280
    v_mfma_f32_16x16x32_bf16 a[64:67], v[56:59], v[96:99], a[64:67]
    s_add_u32 s100, s77, 4096
    ds_read_b64_tr_b16 v[52:53], v28 offset:36864
    ds_read_b64_tr_b16 v[54:55], v28 offset:37376
    v_mfma_f32_16x16x32_bf16 a[64:67], v[60:63], v[100:103], a[64:67]
    s_add_u32 m0, m0, 4096
    v_add_u32 v27, 0x10000, v27
    v_add_u32 v28, 0x10000, v28
    v_mfma_f32_16x16x32_bf16 a[68:71], v[56:59], v[104:107], a[68:71]
    buffer_load_dwordx4 v1, s[36:39], s100 offen sc1 lds
    v_mfma_f32_16x16x32_bf16 a[68:71], v[60:63], v[108:111], a[68:71]
    v_cvt_pk_bf16_f32 v226, v240, v241
    v_cvt_pk_bf16_f32 v227, v242, v243
    v_mfma_f32_16x16x32_bf16 a[72:75], v[56:59], v[112:115], a[72:75]
    v_cvt_pk_bf16_f32 v228, v228, v229
    v_cvt_pk_bf16_f32 v229, v230, v231
    v_mfma_f32_16x16x32_bf16 a[72:75], v[60:63], v[116:119], a[72:75]
    v_cvt_pk_bf16_f32 v230, v244, v245
    v_cvt_pk_bf16_f32 v231, v246, v247
    v_mfma_f32_16x16x32_bf16 a[76:79], v[56:59], v[120:123], a[76:79]
    buffer_load_dwordx4 v1, s[36:39], s100 offen offset:1024 sc1 lds
    v_mfma_f32_16x16x32_bf16 a[76:79], v[60:63], v[124:127], a[76:79]
    v_cvt_pk_bf16_f32 v199, v214, v215
    v_cvt_pk_bf16_f32 v232, v232, v233
    v_mfma_f32_16x16x32_bf16 a[128:131], v[56:59], a[136:139], a[128:131]
    ds_read_b64_tr_b16 v[56:57], v29 offset:32768
    ds_read_b64_tr_b16 v[58:59], v29 offset:33280
    v_mfma_f32_16x16x32_bf16 a[128:131], v[60:63], a[140:143], a[128:131]
    s_waitcnt lgkmcnt(2)
    ds_read_b64_tr_b16 v[60:61], v29 offset:36864
    ds_read_b64_tr_b16 v[62:63], v29 offset:37376
    v_mfma_f32_16x16x32_bf16 a[80:83], v[40:43], v[96:99], a[80:83]
    buffer_load_dwordx4 v1, s[36:39], s100 offen offset:2048 sc1 lds
    v_mfma_f32_16x16x32_bf16 a[80:83], v[44:47], v[100:103], a[80:83]
    v_add_u32 v29, 0x10000, v29
    v_cvt_pk_bf16_f32 v233, v234, v235
    v_mfma_f32_16x16x32_bf16 a[84:87], v[40:43], v[104:107], a[84:87]
    v_cvt_pk_bf16_f32 v234, v248, v249
    v_cvt_pk_bf16_f32 v235, v250, v251
    v_mfma_f32_16x16x32_bf16 a[84:87], v[44:47], v[108:111], a[84:87]
    v_cvt_pk_bf16_f32 v202, v216, v217
    v_cvt_pk_bf16_f32 v203, v218, v219
    v_mfma_f32_16x16x32_bf16 a[88:91], v[40:43], v[112:115], a[88:91]
    buffer_load_dwordx4 v1, s[36:39], s100 offen offset:3072 sc1 lds
    v_mfma_f32_16x16x32_bf16 a[88:91], v[44:47], v[116:119], a[88:91]
    v_cvt_pk_bf16_f32 v175, v190, v191
    v_cvt_pk_bf16_f32 v236, v236, v237
    v_mfma_f32_16x16x32_bf16 a[92:95], v[40:43], v[120:123], a[92:95]
    s_lshr_b32 s82, s4, 1
    s_add_u32 s82, s82, 32
    v_cvt_pk_bf16_f32 v237, v238, v239
    v_mfma_f32_16x16x32_bf16 a[92:95], v[44:47], v[124:127], a[92:95]
    s_sub_u32 s82, s82, s6
    v_cvt_pk_bf16_f32 v238, v252, v253
    v_cvt_pk_bf16_f32 v239, v254, v255
    v_mfma_f32_16x16x32_bf16 a[132:135], v[40:43], a[136:139], a[132:135]
    s_add_u32 s76, s76, 32768
    s_sub_u32 s82, s82, s6
    ds_read_b64_tr_b16 v[40:41], v26 offset:0
    v_mfma_f32_16x16x32_bf16 a[132:135], v[44:47], a[140:143], a[132:135]
    s_waitcnt vmcnt(8)
    s_add_u32 s77, s77, 32768
    s_lshl_b32 s38, s82, 15
    v_mfma_f32_16x16x32_bf16 v[240:243], a[224:227], v[128:131], v[176:179]
    s_add_u32 m0, s76, s75
    ds_read_b64_tr_b16 v[42:43], v26 offset:512
    ds_read_b64_tr_b16 v[44:45], v26 offset:4096
    v_mfma_f32_16x16x32_bf16 v[240:243], a[228:231], v[160:163], v[240:243]
    s_mov_b32 s82, 0
    buffer_load_dwordx4 v1, s[36:39], s77 offen sc1 lds
    v_mfma_f32_16x16x32_bf16 v[240:243], a[232:235], v[192:195], v[240:243]
    buffer_load_dwordx4 v1, s[36:39], s77 offen offset:1024 sc1 lds
    v_mfma_f32_16x16x32_bf16 v[240:243], a[236:239], v[224:227], v[240:243]
    ds_read_b64_tr_b16 v[46:47], v26 offset:4608
    ds_read_b128 a[136:139], v22 offset:0
    v_mfma_f32_16x16x32_bf16 v[244:247], a[224:227], v[132:135], 0
    ds_read_b128 a[140:143], v23 offset:0
    v_cvt_pk_bf16_f32 v204, v204, v205
    v_mfma_f32_16x16x32_bf16 v[244:247], a[228:231], v[164:167], v[244:247]
    v_cvt_pk_bf16_f32 v205, v206, v207
    v_cvt_pk_bf16_f32 v206, v220, v221
    v_mfma_f32_16x16x32_bf16 v[244:247], a[232:235], v[196:199], v[244:247]
    buffer_load_dwordx4 v1, s[36:39], s77 offen offset:2048 sc1 lds
    v_mfma_f32_16x16x32_bf16 v[244:247], a[236:239], v[228:231], v[244:247]
    v_max3_f32 v147, v240, v241, v242
    v_max_f32 v147, v147, v243
    v_mfma_f32_16x16x32_bf16 v[248:251], a[224:227], v[136:139], 0
    v_mov_b32 v146, v147
    v_cvt_pk_bf16_f32 v207, v222, v223
    v_mfma_f32_16x16x32_bf16 v[248:251], a[228:231], v[168:171], v[248:251]
    v_permlane32_swap_b32 v147, v146
    v_max_f32 v147, v147, v146
    v_mfma_f32_16x16x32_bf16 v[248:251], a[232:235], v[200:203], v[248:251]
    buffer_load_dwordx4 v1, s[36:39], s77 offen offset:3072 sc1 lds
    v_mfma_f32_16x16x32_bf16 v[248:251], a[236:239], v[232:235], v[248:251]
    v_max3_f32 v151, v244, v245, v246
    v_max_f32 v151, v151, v247
    v_mfma_f32_16x16x32_bf16 v[252:255], a[224:227], v[140:143], 0
    s_add_u32 s100, s77, 4096
    v_mov_b32 v150, v151
    v_mov_b32 v146, v147
    v_mfma_f32_16x16x32_bf16 v[252:255], a[228:231], v[172:175], v[252:255]
    s_add_u32 m0, m0, 4096
    v_max3_f32 v155, v248, v249, v250
    v_max_f32 v155, v155, v251
    v_mfma_f32_16x16x32_bf16 v[252:255], a[232:235], v[204:207], v[252:255]
    buffer_load_dwordx4 v1, s[36:39], s100 offen sc1 lds
    v_mfma_f32_16x16x32_bf16 v[252:255], a[236:239], v[236:239], v[252:255]
    v_mov_b32 v154, v155
    v_permlane32_swap_b32 v151, v150
    v_mfma_f32_16x16x32_bf16 a[96:99], v[48:51], v[96:99], a[96:99]
    v_permlane32_swap_b32 v155, v154
    v_max_f32 v151, v151, v150
    v_mfma_f32_16x16x32_bf16 a[96:99], v[52:55], v[100:103], a[96:99]
    v_max_f32 v155, v155, v154
    v_mov_b32 v150, v151
    v_mfma_f32_16x16x32_bf16 a[100:103], v[48:51], v[104:107], a[100:103]
    buffer_load_dwordx4 v1, s[36:39], s100 offen offset:1024 sc1 lds
    v_mfma_f32_16x16x32_bf16 a[100:103], v[52:55], v[108:111], a[100:103]
    v_max3_f32 v159, v252, v253, v254
    v_max_f32 v159, v159, v255
    v_mfma_f32_16x16x32_bf16 a[104:107], v[48:51], v[112:115], a[104:107]
    v_mov_b32 v158, v159
    v_mov_b32 v154, v155
    v_mfma_f32_16x16x32_bf16 a[104:107], v[52:55], v[116:119], a[104:107]
    v_permlane32_swap_b32 v159, v158
    v_max_f32 v159, v159, v158
    v_mfma_f32_16x16x32_bf16 a[108:111], v[48:51], v[120:123], a[108:111]
    buffer_load_dwordx4 v1, s[36:39], s100 offen offset:2048 sc1 lds
    v_mfma_f32_16x16x32_bf16 a[108:111], v[52:55], v[124:127], a[108:111]
    s_waitcnt lgkmcnt(0)
    ds_read_b64_tr_b16 v[48:49], v27 offset:0
    ds_read_b64_tr_b16 v[50:51], v27 offset:512
    v_mfma_f32_16x16x32_bf16 a[112:115], v[56:59], v[96:99], a[112:115]
    ds_read_b64_tr_b16 v[52:53], v27 offset:4096
    ds_read_b64_tr_b16 v[54:55], v27 offset:4608
    v_mfma_f32_16x16x32_bf16 a[112:115], v[60:63], v[100:103], a[112:115]
    v_mov_b32 v158, v159
    v_permlane16_swap_b32 v147, v146
    v_mfma_f32_16x16x32_bf16 a[116:119], v[56:59], v[104:107], a[116:119]
    buffer_load_dwordx4 v1, s[36:39], s100 offen offset:3072 sc1 lds
    v_mfma_f32_16x16x32_bf16 a[116:119], v[60:63], v[108:111], a[116:119]
    v_permlane16_swap_b32 v151, v150
    v_permlane16_swap_b32 v155, v154
    v_mfma_f32_16x16x32_bf16 a[120:123], v[56:59], v[112:115], a[120:123]
    s_add_u32 s76, s76, 32768
    v_permlane16_swap_b32 v159, v158
    v_max_f32 v147, v147, v146
    v_mfma_f32_16x16x32_bf16 a[120:123], v[60:63], v[116:119], a[120:123]
    s_add_u32 s77, s77, 32768
    v_max_f32 v151, v151, v150
    v_max_f32 v155, v155, v154
    v_mfma_f32_16x16x32_bf16 a[124:127], v[56:59], v[120:123], a[124:127]
    s_add_u32 m0, s76, s75
    ds_read_b64_tr_b16 v[56:57], v28 offset:0
    ds_read_b64_tr_b16 v[58:59], v28 offset:512
    v_mfma_f32_16x16x32_bf16 a[124:127], v[60:63], v[124:127], a[124:127]
    buffer_load_dwordx4 v1, s[36:39], s77 offen sc1 lds
    v_mfma_f32_16x16x32_bf16 a[64:67], v[40:43], v[64:67], a[64:67]
    ds_read_b64_tr_b16 v[60:61], v28 offset:4096
    ds_read_b64_tr_b16 v[62:63], v28 offset:4608
    v_mfma_f32_16x16x32_bf16 a[64:67], v[44:47], v[68:71], a[64:67]
    v_max_f32 v159, v159, v158
    v_sub_f32 v144, 0, v147
    v_mfma_f32_16x16x32_bf16 a[68:71], v[40:43], v[72:75], a[68:71]
    buffer_load_dwordx4 v1, s[36:39], s77 offen offset:1024 sc1 lds
    v_mfma_f32_16x16x32_bf16 a[68:71], v[44:47], v[76:79], a[68:71]
    v_sub_f32 v148, 0, v151
    v_sub_f32 v152, 0, v155
    v_mfma_f32_16x16x32_bf16 a[72:75], v[40:43], v[80:83], a[72:75]
    v_sub_f32 v156, 0, v159
    v_sub_f32 v145, 0, v147
    v_mfma_f32_16x16x32_bf16 a[72:75], v[44:47], v[84:87], a[72:75]
    v_sub_f32 v146, 0, v147
    v_sub_f32 v147, 0, v147
    v_mfma_f32_16x16x32_bf16 a[76:79], v[40:43], v[88:91], a[76:79]
    buffer_load_dwordx4 v1, s[36:39], s77 offen offset:2048 sc1 lds
    v_mfma_f32_16x16x32_bf16 a[76:79], v[44:47], v[92:95], a[76:79]
    v_sub_f32 v149, 0, v151
    v_sub_f32 v150, 0, v151
    v_mfma_f32_16x16x32_bf16 a[128:131], v[40:43], a[136:139], a[128:131]
    ds_read_b64_tr_b16 v[40:41], v29 offset:0
    ds_read_b64_tr_b16 v[42:43], v29 offset:512
    v_mfma_f32_16x16x32_bf16 a[128:131], v[44:47], a[140:143], a[128:131]
    s_waitcnt lgkmcnt(2)
    ds_read_b64_tr_b16 v[44:45], v29 offset:4096
    ds_read_b64_tr_b16 v[46:47], v29 offset:4608
    v_mfma_f32_16x16x32_bf16 a[80:83], v[48:51], v[64:67], a[80:83]
    buffer_load_dwordx4 v1, s[36:39], s77 offen offset:3072 sc1 lds
    v_mfma_f32_16x16x32_bf16 a[80:83], v[52:55], v[68:71], a[80:83]
    v_sub_f32 v151, 0, v151
    v_sub_f32 v153, 0, v155
    v_mfma_f32_16x16x32_bf16 a[84:87], v[48:51], v[72:75], a[84:87]
    s_add_u32 s100, s77, 4096
    v_sub_f32 v154, 0, v155
    v_sub_f32 v155, 0, v155
    v_mfma_f32_16x16x32_bf16 a[84:87], v[52:55], v[76:79], a[84:87]
    s_add_u32 m0, m0, 4096
    v_sub_f32 v157, 0, v159
    v_sub_f32 v158, 0, v159
    v_mfma_f32_16x16x32_bf16 a[88:91], v[48:51], v[80:83], a[88:91]
    buffer_load_dwordx4 v1, s[36:39], s100 offen sc1 lds
    v_mfma_f32_16x16x32_bf16 a[88:91], v[52:55], v[84:87], a[88:91]
    v_sub_f32 v159, 0, v159
    v_or_b32 v215, 0x44444444, v38
    v_mfma_f32_16x16x32_bf16 a[92:95], v[48:51], v[88:91], a[92:95]
    v_bfe_u32 v38, v1, 5, 1
    v_cmp_eq_u32 vcc, 0, v38
    v_mfma_f32_16x16x32_bf16 a[92:95], v[52:55], v[92:95], a[92:95]
    v_mov_b32 v38, 0x3f803f80
    v_and_b32 v29, 0x380, v1
    v_mfma_f32_16x16x32_bf16 a[132:135], v[48:51], a[136:139], a[132:135]
    buffer_load_dwordx4 v1, s[36:39], s100 offen offset:1024 sc1 lds
    v_mfma_f32_16x16x32_bf16 a[132:135], v[52:55], a[140:143], a[132:135]
    v_add_f32 v240, v240, v144
    v_add_f32 v241, v241, v144
    v_mfma_f32_16x16x32_bf16 a[96:99], v[56:59], v[64:67], a[96:99]
    v_add_f32 v242, v242, v144
    v_add_f32 v243, v243, v144
    v_mfma_f32_16x16x32_bf16 a[96:99], v[60:63], v[68:71], a[96:99]
    v_add_f32 v244, v244, v148
    v_add_f32 v245, v245, v148
    v_mfma_f32_16x16x32_bf16 a[100:103], v[56:59], v[72:75], a[100:103]
    buffer_load_dwordx4 v1, s[36:39], s100 offen offset:2048 sc1 lds
    v_mfma_f32_16x16x32_bf16 a[100:103], v[60:63], v[76:79], a[100:103]
    v_add_f32 v246, v246, v148
    v_add_f32 v247, v247, v148
    v_mfma_f32_16x16x32_bf16 a[104:107], v[56:59], v[80:83], a[104:107]
    v_add_f32 v248, v248, v152
    v_add_f32 v249, v249, v152
    v_mfma_f32_16x16x32_bf16 a[104:107], v[60:63], v[84:87], a[104:107]
    s_waitcnt vmcnt(15) lgkmcnt(0)
    s_barrier
    ds_read_b128 a[240:243], v2 offset:4096
    v_mfma_f32_16x16x32_bf16 a[108:111], v[56:59], v[88:91], a[108:111]
    ds_read_b128 a[244:247], v2 offset:5120
    ds_read_b128 a[248:251], v2 offset:6144
    v_mfma_f32_16x16x32_bf16 a[108:111], v[60:63], v[92:95], a[108:111]
    buffer_load_dwordx4 v1, s[36:39], s100 offen offset:3072 sc1 lds
    v_mfma_f32_16x16x32_bf16 a[112:115], v[40:43], v[64:67], a[112:115]
    s_add_u32 s77, s77, 32768
    ds_read_b128 a[252:255], v2 offset:7168
    v_add_f32 v250, v250, v152
    v_mfma_f32_16x16x32_bf16 a[112:115], v[44:47], v[68:71], a[112:115]
    s_add_u32 s76, s76, 32768
    v_add_f32 v251, v251, v152
    v_add_f32 v252, v252, v156
    v_mfma_f32_16x16x32_bf16 a[116:119], v[40:43], v[72:75], a[116:119]
    v_add_f32 v253, v253, v156
    v_add_f32 v254, v254, v156
    v_mfma_f32_16x16x32_bf16 a[116:119], v[44:47], v[76:79], a[116:119]
    v_add_f32 v255, v255, v156
    v_cndmask_b32 v38, 0, v38, vcc
    v_mfma_f32_16x16x32_bf16 a[120:123], v[40:43], v[80:83], a[120:123]
    v_lshl_add_u32 v29, v29, 4, v39
    v_bfe_u32 v39, v1, 2, 4
    v_mfma_f32_16x16x32_bf16 a[120:123], v[44:47], v[84:87], a[120:123]
    v_exp_f32 v240, v240
    v_mfma_f32_16x16x32_bf16 a[124:127], v[40:43], v[88:91], a[124:127]
    v_exp_f32 v241, v241
    v_mfma_f32_16x16x32_bf16 a[124:127], v[44:47], v[92:95], a[124:127]
    v_exp_f32 v242, v242
    v_exp_f32 v243, v243
    v_exp_f32 v244, v244
    v_exp_f32 v245, v245
    v_exp_f32 v246, v246
    v_exp_f32 v247, v247
    v_exp_f32 v248, v248
    v_exp_f32 v249, v249
    v_exp_f32 v250, v250
    v_exp_f32 v251, v251
    v_exp_f32 v252, v252
    v_exp_f32 v253, v253
    v_exp_f32 v254, v254
    v_exp_f32 v255, v255
    v_accvgpr_write_b32 a136, v38
    v_accvgpr_write_b32 a137, v38
    v_accvgpr_write_b32 a138, v38
    v_accvgpr_write_b32 a139, v38
    v_lshl_add_u32 v29, v29, 1, v39
K1_ATT:
    v_cvt_pk_bf16_f32 v32, v240, v241
    v_cvt_pk_bf16_f32 v33, v242, v243
    v_add_f32 v213, s21, v144
    v_fma_f32 v180, v208, s17, v213
    v_fma_f32 v181, v209, s17, v213
    v_fma_f32 v182, v210, s17, v213
    v_fma_f32 v183, v211, s17, v213
    s_nop 1
    s_waitcnt lgkmcnt(0)
    v_mfma_f32_16x16x32_bf16 v[240:243], a[240:243], v[128:131], v[180:183]
    s_mov_b32 s99, s76
    v_cvt_pk_bf16_f32 v40, v244, v245
    v_cvt_pk_bf16_f32 v41, v246, v247
    v_mfma_f32_16x16x32_bf16 v[240:243], a[244:247], v[160:163], v[240:243]
    s_sub_u32 s7, 15, s6
    v_cvt_pk_bf16_f32 v48, v248, v249
    v_cvt_pk_bf16_f32 v49, v250, v251
    v_mfma_f32_16x16x32_bf16 v[240:243], a[248:251], v[192:195], v[240:243]
    s_lshl3_add_u32 s80, s6, s4
    ds_read_b128 a[224:227], v2 offset:8192
    ds_read_b128 a[228:231], v2 offset:9216
    v_mfma_f32_16x16x32_bf16 v[240:243], a[252:255], v[224:227], v[240:243]
    s_lshl3_add_u32 s81, s7, s4
    ds_read_b128 a[232:235], v2 offset:10240
    v_cvt_pk_bf16_f32 v56, v252, v253
    v_mfma_f32_16x16x32_bf16 v[244:247], a[240:243], v[132:135], v[148:151]
    s_add_u32 m0, s76, s75
    ds_read_b128 a[236:239], v2 offset:11264
    v_cvt_pk_bf16_f32 v57, v254, v255
    v_mfma_f32_16x16x32_bf16 v[244:247], a[244:247], v[164:167], v[244:247]
    s_mov_b32 s76, s60
    buffer_load_dwordx4 v1, s[36:39], s77 offen sc1 lds
    v_mfma_f32_16x16x32_bf16 v[244:247], a[248:251], v[196:199], v[244:247]
    s_mov_b32 s60, s82
    v_exp_f32 v240, v240
    v_mfma_f32_16x16x32_bf16 v[244:247], a[252:255], v[228:231], v[244:247]
    s_mov_b32 s82, s95
    buffer_load_dwordx4 v1, s[36:39], s77 offen offset:1024 sc1 lds
    v_mfma_f32_16x16x32_bf16 v[248:251], a[240:243], v[136:139], v[152:155]
    s_mov_b32 s95, s93
    v_exp_f32 v241, v241
    v_mfma_f32_16x16x32_bf16 v[248:251], a[244:247], v[168:171], v[248:251]
    s_mov_b32 s93, s99
    v_exp_f32 v242, v242
    v_mfma_f32_16x16x32_bf16 v[248:251], a[248:251], v[200:203], v[248:251]
    s_mul_i32 s80, s80, 155648
    buffer_load_dwordx4 v1, s[36:39], s77 offen offset:2048 sc1 lds
    v_mfma_f32_16x16x32_bf16 v[248:251], a[252:255], v[232:235], v[248:251]
    s_mul_i32 s81, s81, 155648
    v_exp_f32 v243, v243
    v_mfma_f32_16x16x32_bf16 v[252:255], a[240:243], v[140:143], v[156:159]
    s_lshl_b32 s7, s5, 12
    v_cvt_pk_bf16_f32 v34, v240, v241
    v_cvt_pk_bf16_f32 v35, v242, v243
    v_mfma_f32_16x16x32_bf16 v[252:255], a[244:247], v[172:175], v[252:255]
    s_add_u32 s80, s80, s7
    buffer_load_dwordx4 v1, s[36:39], s77 offen offset:3072 sc1 lds
    v_mfma_f32_16x16x32_bf16 v[252:255], a[248:251], v[204:207], v[252:255]
    s_add_u32 s81, s81, s7
    v_exp_f32 v244, v244
    v_mfma_f32_16x16x32_bf16 v[252:255], a[252:255], v[236:239], v[252:255]
    s_add_u32 s100, s77, 4096
    v_exp_f32 v245, v245
    v_add_f32 v212, s20, v144
    v_fma_f32 v176, v208, s16, v212
    v_fma_f32 v177, v209, s16, v212
    v_fma_f32 v178, v210, s16, v212
    v_fma_f32 v179, v211, s16, v212
    v_add_f32 v212, s22, v144
    v_fma_f32 v184, v208, s18, v212
    v_fma_f32 v185, v209, s18, v212
    v_fma_f32 v186, v210, s18, v212
    v_fma_f32 v187, v211, s18, v212
    s_nop 1
    s_waitcnt lgkmcnt(0)
    v_mfma_f32_16x16x32_bf16 v[240:243], a[224:227], v[128:131], v[184:187]
    s_add_u32 m0, m0, 4096
    v_exp_f32 v246, v246
    v_mfma_f32_16x16x32_bf16 v[240:243], a[228:231], v[160:163], v[240:243]
    s_lshr_b32 s7, s5, 3
    v_exp_f32 v247, v247
    v_mfma_f32_16x16x32_bf16 v[240:243], a[232:235], v[192:195], v[240:243]
    s_lshl2_add_u32 s7, s7, s4
    buffer_load_dwordx4 v1, s[36:39], s100 offen sc1 lds
    v_mfma_f32_16x16x32_bf16 v[240:243], a[236:239], v[224:227], v[240:243]
    s_lshl_b32 s7, s7, 8
    v_cvt_pk_bf16_f32 v42, v244, v245
    v_cvt_pk_bf16_f32 v43, v246, v247
    v_mfma_f32_16x16x32_bf16 v[244:247], a[224:227], v[132:135], v[148:151]
    s_mov_b32 s42, 19922944
    v_exp_f32 v248, v248
    v_mfma_f32_16x16x32_bf16 v[244:247], a[228:231], v[164:167], v[244:247]
    s_mov_b32 s43, 0x20000
    buffer_load_dwordx4 v1, s[36:39], s100 offen offset:1024 sc1 lds
    v_mfma_f32_16x16x32_bf16 v[244:247], a[232:235], v[196:199], v[244:247]
    s_add_u32 s92, s7, 163840
    v_exp_f32 v249, v249
    v_mfma_f32_16x16x32_bf16 v[244:247], a[236:239], v[228:231], v[244:247]
    s_mov_b64 s[24:25], s[0:1]
    v_exp_f32 v250, v250
    v_exp_f32 v251, v251
    v_cvt_pk_bf16_f32 v50, v248, v249
    v_cvt_pk_bf16_f32 v51, v250, v251
    v_mfma_f32_16x16x32_bf16 v[248:251], a[224:227], v[136:139], v[152:155]
    s_mov_b32 s78, s6
    ds_read_b128 a[240:243], v2 offset:12288
    ds_read_b128 a[244:247], v2 offset:13312
    v_mfma_f32_16x16x32_bf16 v[248:251], a[228:231], v[168:171], v[248:251]
    s_mov_b32 s26, 2359296
    buffer_load_dwordx4 v1, s[36:39], s100 offen offset:2048 sc1 lds
    v_mfma_f32_16x16x32_bf16 v[248:251], a[232:235], v[200:203], v[248:251]
    s_add_u32 s77, s77, 32768
    ds_read_b128 a[248:251], v2 offset:14336
    ds_read_b128 a[252:255], v2 offset:15360
    v_mfma_f32_16x16x32_bf16 v[248:251], a[236:239], v[232:235], v[248:251]
    s_mov_b32 s27, 0x20000
    v_exp_f32 v252, v252
    v_exp_f32 v253, v253
    v_exp_f32 v254, v254
    v_exp_f32 v255, v255
    v_cvt_pk_bf16_f32 v58, v252, v253
    v_cvt_pk_bf16_f32 v59, v254, v255
    v_mfma_f32_16x16x32_bf16 v[252:255], a[224:227], v[140:143], v[156:159]
    v_add_f32 v213, s23, v144
    v_fma_f32 v188, v208, s19, v213
    v_mfma_f32_16x16x32_bf16 v[252:255], a[228:231], v[172:175], v[252:255]
    buffer_load_dwordx4 v1, s[36:39], s100 offen offset:3072 sc1 lds
    v_mfma_f32_16x16x32_bf16 v[252:255], a[232:235], v[204:207], v[252:255]
    v_exp_f32 v240, v240
    v_mfma_f32_16x16x32_bf16 v[252:255], a[236:239], v[236:239], v[252:255]
    s_waitcnt lgkmcnt(0)
    v_exp_f32 v241, v241
    v_exp_f32 v242, v242
    v_exp_f32 v243, v243
    v_fma_f32 v189, v209, s19, v213
    v_fma_f32 v190, v210, s19, v213
    v_fma_f32 v191, v211, s19, v213
    v_cvt_pk_bf16_f32 v36, v240, v241
    v_cvt_pk_bf16_f32 v37, v242, v243
    v_mfma_f32_16x16x32_bf16 v[240:243], a[240:243], v[128:131], v[188:191]
    v_exp_f32 v244, v244
    v_mfma_f32_16x16x32_bf16 v[240:243], a[244:247], v[160:163], v[240:243]
    v_exp_f32 v245, v245
    v_mfma_f32_16x16x32_bf16 v[240:243], a[248:251], v[192:195], v[240:243]
    s_waitcnt vmcnt(8) lgkmcnt(0)
    v_exp_f32 v246, v246
    v_mfma_f32_16x16x32_bf16 v[240:243], a[252:255], v[224:227], v[240:243]
    s_barrier
    v_exp_f32 v247, v247
    v_cvt_pk_bf16_f32 v44, v244, v245
    v_cvt_pk_bf16_f32 v45, v246, v247
    v_mfma_f32_16x16x32_bf16 v[244:247], a[240:243], v[132:135], v[148:151]
    v_add_u32 v2, s82, v1
    ds_read_b128 a[224:227], v2 offset:0
    v_mfma_f32_16x16x32_bf16 v[244:247], a[244:247], v[164:167], v[244:247]
    ds_read_b128 a[228:231], v2 offset:1024
    ds_read_b128 a[232:235], v2 offset:2048
    v_mfma_f32_16x16x32_bf16 v[244:247], a[248:251], v[196:199], v[244:247]
    v_exp_f32 v248, v248
    v_mfma_f32_16x16x32_bf16 v[244:247], a[252:255], v[228:231], v[244:247]
    v_exp_f32 v249, v249
    v_exp_f32 v250, v250
    v_exp_f32 v251, v251
    v_cvt_pk_bf16_f32 v52, v248, v249
    v_cvt_pk_bf16_f32 v53, v250, v251
    v_mfma_f32_16x16x32_bf16 v[248:251], a[240:243], v[136:139], v[152:155]
    ds_read_b128 a[236:239], v2 offset:3072
    ds_read_b128 v[96:99], v2 offset:16384
    v_mfma_f32_16x16x32_bf16 v[248:251], a[244:247], v[168:171], v[248:251]
    v_exp_f32 v252, v252
    v_mfma_f32_16x16x32_bf16 v[248:251], a[248:251], v[200:203], v[248:251]
    v_exp_f32 v253, v253
    v_mfma_f32_16x16x32_bf16 v[248:251], a[252:255], v[232:235], v[248:251]
    v_exp_f32 v254, v254
    v_exp_f32 v255, v255
    v_cvt_pk_bf16_f32 v60, v252, v253
    v_cvt_pk_bf16_f32 v61, v254, v255
    v_mfma_f32_16x16x32_bf16 v[252:255], a[240:243], v[140:143], v[156:159]
    ds_read_b128 v[100:103], v2 offset:17408
    v_mfma_f32_16x16x32_bf16 v[252:255], a[244:247], v[172:175], v[252:255]
    v_exp_f32 v240, v240
    v_mfma_f32_16x16x32_bf16 v[252:255], a[248:251], v[204:207], v[252:255]
    s_sub_u32 s40, s56, 20971520
    s_subb_u32 s41, s57, 0
    v_mfma_f32_16x16x32_bf16 v[252:255], a[252:255], v[236:239], v[252:255]
    v_exp_f32 v241, v241
    v_exp_f32 v242, v242
    v_exp_f32 v243, v243
    v_exp_f32 v244, v244
    v_exp_f32 v245, v245
    v_exp_f32 v246, v246
    v_exp_f32 v247, v247
    v_exp_f32 v248, v248
    v_exp_f32 v249, v249
    v_exp_f32 v250, v250
    v_exp_f32 v251, v251
    v_cvt_pk_bf16_f32 v38, v240, v241
    v_cvt_pk_bf16_f32 v39, v242, v243
    v_cvt_pk_bf16_f32 v46, v244, v245
    v_cvt_pk_bf16_f32 v47, v246, v247
    v_cvt_pk_bf16_f32 v54, v248, v249
    v_cvt_pk_bf16_f32 v55, v250, v251
    v_exp_f32 v252, v252
    s_cmp_eq_u32 s78, 0
    s_cbranch_scc1 K1_LB_END
.p2align 3
K1_LB:
    s_waitcnt lgkmcnt(0)
    v_mfma_f32_16x16x32_bf16 v[240:243], a[224:227], v[128:131], v[176:179]
    s_mov_b32 s99, s76
    v_exp_f32 v253, v253
    v_mfma_f32_16x16x32_bf16 v[240:243], a[228:231], v[160:163], v[240:243]
    v_exp_f32 v254, v254
    v_mfma_f32_16x16x32_bf16 v[240:243], a[232:235], v[192:195], v[240:243]
    v_exp_f32 v255, v255
    v_mfma_f32_16x16x32_bf16 v[240:243], a[236:239], v[224:227], v[240:243]
    v_cvt_pk_bf16_f32 v62, v252, v253
    v_cvt_pk_bf16_f32 v63, v254, v255
    v_mfma_f32_16x16x32_bf16 a[0:3], v[96:99], v[32:35], a[0:3]
    s_add_u32 m0, s76, s75
    v_mfma_f32_16x16x32_bf16 a[0:3], v[100:103], v[36:39], a[0:3]
    s_mov_b32 s76, s60
    buffer_load_dwordx4 v1, s[36:39], s77 offen sc1 lds
    v_mfma_f32_16x16x32_bf16 a[4:7], v[96:99], v[40:43], a[4:7]
    s_mov_b32 s60, s82
    ds_read_b128 v[104:107], v2 offset:18432
    ds_read_b128 v[108:111], v2 offset:19456
    v_mfma_f32_16x16x32_bf16 a[4:7], v[100:103], v[44:47], a[4:7]
    s_mov_b32 s82, s95
    v_exp_f32 v240, v240
    v_mfma_f32_16x16x32_bf16 v[244:247], a[224:227], v[132:135], v[148:151]
    s_mov_b32 s95, s93
    v_exp_f32 v241, v241
    v_mfma_f32_16x16x32_bf16 v[244:247], a[228:231], v[164:167], v[244:247]
    s_mov_b32 s93, s99
    v_exp_f32 v242, v242
    v_mfma_f32_16x16x32_bf16 v[244:247], a[232:235], v[196:199], v[244:247]
    v_exp_f32 v243, v243
    v_mfma_f32_16x16x32_bf16 v[244:247], a[236:239], v[228:231], v[244:247]
    v_cvt_pk_bf16_f32 v64, v240, v241
    v_cvt_pk_bf16_f32 v65, v242, v243
    v_mfma_f32_16x16x32_bf16 a[8:11], v[96:99], v[48:51], a[8:11]
    v_mfma_f32_16x16x32_bf16 a[8:11], v[100:103], v[52:55], a[8:11]
    v_mfma_f32_16x16x32_bf16 a[12:15], v[96:99], v[56:59], a[12:15]
    v_mfma_f32_16x16x32_bf16 a[12:15], v[100:103], v[60:63], a[12:15]
    v_mfma_f32_16x16x32_bf16 v[248:251], a[224:227], v[136:139], v[152:155]
    v_mfma_f32_16x16x32_bf16 v[248:251], a[228:231], v[168:171], v[248:251]
    ds_read_b128 a[240:243], v2 offset:4096
    ds_read_b128 a[244:247], v2 offset:5120
    v_mfma_f32_16x16x32_bf16 v[248:251], a[232:235], v[200:203], v[248:251]
    buffer_load_dwordx4 v1, s[36:39], s77 offen offset:1024 sc1 lds
    v_mfma_f32_16x16x32_bf16 v[248:251], a[236:239], v[232:235], v[248:251]
    s_waitcnt lgkmcnt(2)
    ds_read_b128 a[248:251], v2 offset:6144
    ds_read_b128 a[252:255], v2 offset:7168
    v_mfma_f32_16x16x32_bf16 a[16:19], v[104:107], v[32:35], a[16:19]
    v_exp_f32 v244, v244
    v_mfma_f32_16x16x32_bf16 a[16:19], v[108:111], v[36:39], a[16:19]
    ds_read_b128 v[112:115], v2 offset:20480
    ds_read_b128 v[116:119], v2 offset:21504
    v_mfma_f32_16x16x32_bf16 a[20:23], v[104:107], v[40:43], a[20:23]
    v_exp_f32 v245, v245
    v_mfma_f32_16x16x32_bf16 a[20:23], v[108:111], v[44:47], a[20:23]
    v_exp_f32 v246, v246
    v_mfma_f32_16x16x32_bf16 v[252:255], a[224:227], v[140:143], v[156:159]
    v_exp_f32 v247, v247
    v_mfma_f32_16x16x32_bf16 v[252:255], a[228:231], v[172:175], v[252:255]
    v_cvt_pk_bf16_f32 v72, v244, v245
    v_cvt_pk_bf16_f32 v73, v246, v247
    v_mfma_f32_16x16x32_bf16 v[252:255], a[232:235], v[204:207], v[252:255]
    v_exp_f32 v248, v248
    v_mfma_f32_16x16x32_bf16 v[252:255], a[236:239], v[236:239], v[252:255]
    v_exp_f32 v249, v249
    v_mfma_f32_16x16x32_bf16 a[24:27], v[104:107], v[48:51], a[24:27]
    v_exp_f32 v250, v250
    v_mfma_f32_16x16x32_bf16 a[24:27], v[108:111], v[52:55], a[24:27]
    v_exp_f32 v251, v251
    v_mfma_f32_16x16x32_bf16 a[28:31], v[104:107], v[56:59], a[28:31]
    v_cvt_pk_bf16_f32 v80, v248, v249
    v_cvt_pk_bf16_f32 v81, v250, v251
    v_mfma_f32_16x16x32_bf16 a[28:31], v[108:111], v[60:63], a[28:31]
    s_waitcnt lgkmcnt(0)
    buffer_load_dwordx4 v1, s[36:39], s77 offen offset:2048 sc1 lds
    v_mfma_f32_16x16x32_bf16 v[240:243], a[240:243], v[128:131], v[180:183]
    v_exp_f32 v252, v252
    v_mfma_f32_16x16x32_bf16 v[240:243], a[244:247], v[160:163], v[240:243]
    v_exp_f32 v253, v253
    v_mfma_f32_16x16x32_bf16 v[240:243], a[248:251], v[192:195], v[240:243]
    v_exp_f32 v254, v254
    v_mfma_f32_16x16x32_bf16 v[240:243], a[252:255], v[224:227], v[240:243]
    v_exp_f32 v255, v255
    v_mfma_f32_16x16x32_bf16 a[32:35], v[112:115], v[32:35], a[32:35]
    v_cvt_pk_bf16_f32 v88, v252, v253
    v_cvt_pk_bf16_f32 v89, v254, v255
    v_mfma_f32_16x16x32_bf16 a[32:35], v[116:119], v[36:39], a[32:35]
    ds_read_b128 v[120:123], v2 offset:22528
    ds_read_b128 v[124:127], v2 offset:23552
    v_mfma_f32_16x16x32_bf16 a[36:39], v[112:115], v[40:43], a[36:39]
    v_exp_f32 v240, v240
    v_mfma_f32_16x16x32_bf16 a[36:39], v[116:119], v[44:47], a[36:39]
    v_exp_f32 v241, v241
    v_mfma_f32_16x16x32_bf16 v[244:247], a[240:243], v[132:135], v[148:151]
    v_exp_f32 v242, v242
    v_mfma_f32_16x16x32_bf16 v[244:247], a[244:247], v[164:167], v[244:247]
    v_exp_f32 v243, v243
    v_mfma_f32_16x16x32_bf16 v[244:247], a[248:251], v[196:199], v[244:247]
    v_cvt_pk_bf16_f32 v66, v240, v241
    v_cvt_pk_bf16_f32 v67, v242, v243
    v_mfma_f32_16x16x32_bf16 v[244:247], a[252:255], v[228:231], v[244:247]
    v_mfma_f32_16x16x32_bf16 a[40:43], v[112:115], v[48:51], a[40:43]
    buffer_load_dwordx4 v1, s[36:39], s77 offen offset:3072 sc1 lds
    v_mfma_f32_16x16x32_bf16 a[40:43], v[116:119], v[52:55], a[40:43]
    v_mfma_f32_16x16x32_bf16 a[44:47], v[112:115], v[56:59], a[44:47]
    v_mfma_f32_16x16x32_bf16 a[44:47], v[116:119], v[60:63], a[44:47]
    v_mfma_f32_16x16x32_bf16 v[248:251], a[240:243], v[136:139], v[152:155]
    v_mfma_f32_16x16x32_bf16 v[248:251], a[244:247], v[168:171], v[248:251]
    ds_read_b128 a[224:227], v2 offset:8192
    ds_read_b128 a[228:231], v2 offset:9216
    v_mfma_f32_16x16x32_bf16 v[248:251], a[248:251], v[200:203], v[248:251]
    v_exp_f32 v244, v244
    v_mfma_f32_16x16x32_bf16 v[248:251], a[252:255], v[232:235], v[248:251]
    s_waitcnt lgkmcnt(2)
    ds_read_b128 a[232:235], v2 offset:10240
    ds_read_b128 a[236:239], v2 offset:11264
    v_mfma_f32_16x16x32_bf16 a[48:51], v[120:123], v[32:35], a[48:51]
    v_exp_f32 v245, v245
    v_mfma_f32_16x16x32_bf16 a[48:51], v[124:127], v[36:39], a[48:51]
    ds_read_b128 v[96:99], v2 offset:24576
    ds_read_b128 v[100:103], v2 offset:25600
    v_mfma_f32_16x16x32_bf16 a[52:55], v[120:123], v[40:43], a[52:55]
    v_exp_f32 v246, v246
    v_mfma_f32_16x16x32_bf16 a[52:55], v[124:127], v[44:47], a[52:55]
    v_exp_f32 v247, v247
    v_mfma_f32_16x16x32_bf16 v[252:255], a[240:243], v[140:143], v[156:159]
    v_cvt_pk_bf16_f32 v74, v244, v245
    v_cvt_pk_bf16_f32 v75, v246, v247
    v_mfma_f32_16x16x32_bf16 v[252:255], a[244:247], v[172:175], v[252:255]
    s_add_u32 s100, s77, 4096
    v_exp_f32 v248, v248
    v_mfma_f32_16x16x32_bf16 v[252:255], a[248:251], v[204:207], v[252:255]
    s_add_u32 m0, m0, 4096
    v_exp_f32 v249, v249
    v_mfma_f32_16x16x32_bf16 v[252:255], a[252:255], v[236:239], v[252:255]
    buffer_load_dwordx4 v1, s[36:39], s100 offen sc1 lds
    v_mfma_f32_16x16x32_bf16 a[56:59], v[120:123], v[48:51], a[56:59]
    v_exp_f32 v250, v250
    v_mfma_f32_16x16x32_bf16 a[56:59], v[124:127], v[52:55], a[56:59]
    v_exp_f32 v251, v251
    v_mfma_f32_16x16x32_bf16 a[60:63], v[120:123], v[56:59], a[60:63]
    v_cvt_pk_bf16_f32 v82, v248, v249
    v_cvt_pk_bf16_f32 v83, v250, v251
    v_mfma_f32_16x16x32_bf16 a[60:63], v[124:127], v[60:63], a[60:63]
    s_waitcnt lgkmcnt(0)
    v_exp_f32 v252, v252
    v_mfma_f32_16x16x32_bf16 v[240:243], a[224:227], v[128:131], v[184:187]
    v_exp_f32 v253, v253
    v_mfma_f32_16x16x32_bf16 v[240:243], a[228:231], v[160:163], v[240:243]
    v_exp_f32 v254, v254
    v_mfma_f32_16x16x32_bf16 v[240:243], a[232:235], v[192:195], v[240:243]
    v_exp_f32 v255, v255
    v_mfma_f32_16x16x32_bf16 v[240:243], a[236:239], v[224:227], v[240:243]
    v_cvt_pk_bf16_f32 v90, v252, v253
    v_cvt_pk_bf16_f32 v91, v254, v255
    v_mfma_f32_16x16x32_bf16 a[144:147], v[96:99], v[32:35], a[144:147]
    v_mfma_f32_16x16x32_bf16 a[144:147], v[100:103], v[36:39], a[144:147]
    ds_read_b128 v[104:107], v2 offset:26624
    ds_read_b128 v[108:111], v2 offset:27648
    v_mfma_f32_16x16x32_bf16 a[148:151], v[96:99], v[40:43], a[148:151]
    v_mfma_f32_16x16x32_bf16 a[148:151], v[100:103], v[44:47], a[148:151]
    buffer_load_dwordx4 v1, s[36:39], s100 offen offset:1024 sc1 lds
    v_mfma_f32_16x16x32_bf16 v[244:247], a[224:227], v[132:135], v[148:151]
    v_exp_f32 v240, v240
    v_mfma_f32_16x16x32_bf16 v[244:247], a[228:231], v[164:167], v[244:247]
    v_exp_f32 v241, v241
    v_mfma_f32_16x16x32_bf16 v[244:247], a[232:235], v[196:199], v[244:247]
    v_exp_f32 v242, v242
    v_mfma_f32_16x16x32_bf16 v[244:247], a[236:239], v[228:231], v[244:247]
    v_exp_f32 v243, v243
    v_mfma_f32_16x16x32_bf16 a[152:155], v[96:99], v[48:51], a[152:155]
    v_cvt_pk_bf16_f32 v68, v240, v241
    v_cvt_pk_bf16_f32 v69, v242, v243
    v_mfma_f32_16x16x32_bf16 a[152:155], v[100:103], v[52:55], a[152:155]
    v_mfma_f32_16x16x32_bf16 a[156:159], v[96:99], v[56:59], a[156:159]
    v_mfma_f32_16x16x32_bf16 a[156:159], v[100:103], v[60:63], a[156:159]
    v_mfma_f32_16x16x32_bf16 v[248:251], a[224:227], v[136:139], v[152:155]
    v_exp_f32 v244, v244
    v_mfma_f32_16x16x32_bf16 v[248:251], a[228:231], v[168:171], v[248:251]
    ds_read_b128 a[240:243], v2 offset:12288
    ds_read_b128 a[244:247], v2 offset:13312
    v_mfma_f32_16x16x32_bf16 v[248:251], a[232:235], v[200:203], v[248:251]
    v_exp_f32 v245, v245
    v_mfma_f32_16x16x32_bf16 v[248:251], a[236:239], v[232:235], v[248:251]
    s_waitcnt lgkmcnt(2)
    ds_read_b128 a[248:251], v2 offset:14336
    ds_read_b128 a[252:255], v2 offset:15360
    v_mfma_f32_16x16x32_bf16 a[160:163], v[104:107], v[32:35], a[160:163]
    buffer_load_dwordx4 v1, s[36:39], s100 offen offset:2048 sc1 lds
    v_mfma_f32_16x16x32_bf16 a[160:163], v[108:111], v[36:39], a[160:163]
    ds_read_b128 v[112:115], v2 offset:28672
    ds_read_b128 v[116:119], v2 offset:29696
    v_mfma_f32_16x16x32_bf16 a[164:167], v[104:107], v[40:43], a[164:167]
    v_exp_f32 v246, v246
    v_mfma_f32_16x16x32_bf16 a[164:167], v[108:111], v[44:47], a[164:167]
    v_exp_f32 v247, v247
    v_mfma_f32_16x16x32_bf16 v[252:255], a[224:227], v[140:143], v[156:159]
    v_cvt_pk_bf16_f32 v76, v244, v245
    v_cvt_pk_bf16_f32 v77, v246, v247
    v_mfma_f32_16x16x32_bf16 v[252:255], a[228:231], v[172:175], v[252:255]
    v_exp_f32 v248, v248
    v_mfma_f32_16x16x32_bf16 v[252:255], a[232:235], v[204:207], v[252:255]
    v_exp_f32 v249, v249
    v_mfma_f32_16x16x32_bf16 v[252:255], a[236:239], v[236:239], v[252:255]
    v_exp_f32 v250, v250
    v_mfma_f32_16x16x32_bf16 a[168:171], v[104:107], v[48:51], a[168:171]
    v_exp_f32 v251, v251
    v_mfma_f32_16x16x32_bf16 a[168:171], v[108:111], v[52:55], a[168:171]
    v_cvt_pk_bf16_f32 v84, v248, v249
    v_cvt_pk_bf16_f32 v85, v250, v251
    v_mfma_f32_16x16x32_bf16 a[172:175], v[104:107], v[56:59], a[172:175]
    v_mfma_f32_16x16x32_bf16 a[172:175], v[108:111], v[60:63], a[172:175]
    s_waitcnt lgkmcnt(0)
    v_exp_f32 v252, v252
    v_mfma_f32_16x16x32_bf16 v[240:243], a[240:243], v[128:131], v[188:191]
    v_exp_f32 v253, v253
    v_mfma_f32_16x16x32_bf16 v[240:243], a[244:247], v[160:163], v[240:243]
    buffer_load_dwordx4 v1, s[36:39], s100 offen offset:3072 sc1 lds
    v_mfma_f32_16x16x32_bf16 v[240:243], a[248:251], v[192:195], v[240:243]
    v_exp_f32 v254, v254
    v_mfma_f32_16x16x32_bf16 v[240:243], a[252:255], v[224:227], v[240:243]
    v_exp_f32 v255, v255
    v_mfma_f32_16x16x32_bf16 a[176:179], v[112:115], v[32:35], a[176:179]
    v_cvt_pk_bf16_f32 v92, v252, v253
    v_cvt_pk_bf16_f32 v93, v254, v255
    v_mfma_f32_16x16x32_bf16 a[176:179], v[116:119], v[36:39], a[176:179]
    ds_read_b128 v[120:123], v2 offset:30720
    ds_read_b128 v[124:127], v2 offset:31744
    v_mfma_f32_16x16x32_bf16 a[180:183], v[112:115], v[40:43], a[180:183]
    v_exp_f32 v240, v240
    v_mfma_f32_16x16x32_bf16 a[180:183], v[116:119], v[44:47], a[180:183]
    v_exp_f32 v241, v241
    v_mfma_f32_16x16x32_bf16 v[244:247], a[240:243], v[132:135], v[148:151]
    v_add_u32 v2, s82, v1
    v_cvt_pk_bf16_f32 v70, v240, v241
    v_mfma_f32_16x16x32_bf16 v[244:247], a[244:247], v[164:167], v[244:247]
    v_exp_f32 v242, v242
    v_mfma_f32_16x16x32_bf16 v[244:247], a[248:251], v[196:199], v[244:247]
    v_exp_f32 v243, v243
    v_mfma_f32_16x16x32_bf16 v[244:247], a[252:255], v[228:231], v[244:247]
    v_cvt_pk_bf16_f32 v71, v242, v243
    v_mfma_f32_16x16x32_bf16 a[184:187], v[112:115], v[48:51], a[184:187]
    v_mfma_f32_16x16x32_bf16 a[184:187], v[116:119], v[52:55], a[184:187]
    v_mfma_f32_16x16x32_bf16 a[188:191], v[112:115], v[56:59], a[188:191]
    s_add_u32 s77, s77, 32768
    v_mfma_f32_16x16x32_bf16 a[188:191], v[116:119], v[60:63], a[188:191]
    v_mfma_f32_16x16x32_bf16 v[248:251], a[240:243], v[136:139], v[152:155]
    v_mfma_f32_16x16x32_bf16 v[248:251], a[244:247], v[168:171], v[248:251]
    v_exp_f32 v244, v244
    v_mfma_f32_16x16x32_bf16 v[248:251], a[248:251], v[200:203], v[248:251]
    v_exp_f32 v245, v245
    v_mfma_f32_16x16x32_bf16 v[248:251], a[252:255], v[232:235], v[248:251]
    s_waitcnt lgkmcnt(0)
    v_exp_f32 v246, v246
    v_mfma_f32_16x16x32_bf16 a[192:195], v[120:123], v[32:35], a[192:195]
    v_exp_f32 v247, v247
    v_mfma_f32_16x16x32_bf16 a[192:195], v[124:127], v[36:39], a[192:195]
    ds_read_b128 a[224:227], v2 offset:0
    ds_read_b128 a[228:231], v2 offset:1024
    v_mfma_f32_16x16x32_bf16 a[196:199], v[120:123], v[40:43], a[196:199]
    ds_read_b128 a[232:235], v2 offset:2048
    v_cvt_pk_bf16_f32 v78, v244, v245
    v_mfma_f32_16x16x32_bf16 a[196:199], v[124:127], v[44:47], a[196:199]
    ds_read_b128 a[236:239], v2 offset:3072
    v_cvt_pk_bf16_f32 v79, v246, v247
    v_mfma_f32_16x16x32_bf16 v[252:255], a[240:243], v[140:143], v[156:159]
    v_exp_f32 v248, v248
    v_mfma_f32_16x16x32_bf16 v[252:255], a[244:247], v[172:175], v[252:255]
    ds_read_b128 v[96:99], v2 offset:16384
    ds_read_b128 v[100:103], v2 offset:17408
    v_mfma_f32_16x16x32_bf16 v[252:255], a[248:251], v[204:207], v[252:255]
    v_exp_f32 v249, v249
    v_mfma_f32_16x16x32_bf16 v[252:255], a[252:255], v[236:239], v[252:255]
    v_exp_f32 v250, v250
    v_mfma_f32_16x16x32_bf16 a[200:203], v[120:123], v[48:51], a[200:203]
    v_exp_f32 v251, v251
    v_mfma_f32_16x16x32_bf16 a[200:203], v[124:127], v[52:55], a[200:203]
    v_cvt_pk_bf16_f32 v86, v248, v249
    v_cvt_pk_bf16_f32 v87, v250, v251
    v_mfma_f32_16x16x32_bf16 a[204:207], v[120:123], v[56:59], a[204:207]
    v_mfma_f32_16x16x32_bf16 a[204:207], v[124:127], v[60:63], a[204:207]
    v_exp_f32 v252, v252
    v_smfmac_f32_16x16x64_bf16 a[208:211], a[136:139], v[32:39], v215
    v_smfmac_f32_16x16x64_bf16 a[212:215], a[136:139], v[40:47], v215
    v_smfmac_f32_16x16x64_bf16 a[216:219], a[136:139], v[48:55], v215
    s_cmp_le_u32 s78, 1
    v_smfmac_f32_16x16x64_bf16 a[220:223], a[136:139], v[56:63], v215
    s_cbranch_scc1 K1_LB_MASK
K1_LB_BACK:
    s_waitcnt lgkmcnt(0)
    v_mfma_f32_16x16x32_bf16 v[240:243], a[224:227], v[128:131], v[176:179]
    s_mov_b32 s99, s76
    v_exp_f32 v253, v253
    v_mfma_f32_16x16x32_bf16 v[240:243], a[228:231], v[160:163], v[240:243]
    v_exp_f32 v254, v254
    v_mfma_f32_16x16x32_bf16 v[240:243], a[232:235], v[192:195], v[240:243]
    v_exp_f32 v255, v255
    v_mfma_f32_16x16x32_bf16 v[240:243], a[236:239], v[224:227], v[240:243]
    v_cvt_pk_bf16_f32 v94, v252, v253
    v_cvt_pk_bf16_f32 v95, v254, v255
    v_mfma_f32_16x16x32_bf16 a[0:3], v[96:99], v[64:67], a[0:3]
    s_add_u32 m0, s76, s75
    v_mfma_f32_16x16x32_bf16 a[0:3], v[100:103], v[68:71], a[0:3]
    s_mov_b32 s76, s60
    buffer_load_dwordx4 v1, s[36:39], s77 offen sc1 lds
    v_mfma_f32_16x16x32_bf16 a[4:7], v[96:99], v[72:75], a[4:7]
    s_mov_b32 s60, s82
    ds_read_b128 v[104:107], v2 offset:18432
    ds_read_b128 v[108:111], v2 offset:19456
    v_mfma_f32_16x16x32_bf16 a[4:7], v[100:103], v[76:79], a[4:7]
    s_mov_b32 s82, s95
    v_exp_f32 v240, v240
    v_mfma_f32_16x16x32_bf16 v[244:247], a[224:227], v[132:135], v[148:151]
    s_mov_b32 s95, s93
    v_exp_f32 v241, v241
    v_mfma_f32_16x16x32_bf16 v[244:247], a[228:231], v[164:167], v[244:247]
    s_mov_b32 s93, s99
    v_exp_f32 v242, v242
    v_mfma_f32_16x16x32_bf16 v[244:247], a[232:235], v[196:199], v[244:247]
    v_exp_f32 v243, v243
    v_mfma_f32_16x16x32_bf16 v[244:247], a[236:239], v[228:231], v[244:247]
    v_cvt_pk_bf16_f32 v32, v240, v241
    v_cvt_pk_bf16_f32 v33, v242, v243
    v_mfma_f32_16x16x32_bf16 a[8:11], v[96:99], v[80:83], a[8:11]
    v_mfma_f32_16x16x32_bf16 a[8:11], v[100:103], v[84:87], a[8:11]
    v_mfma_f32_16x16x32_bf16 a[12:15], v[96:99], v[88:91], a[12:15]
    v_mfma_f32_16x16x32_bf16 a[12:15], v[100:103], v[92:95], a[12:15]
    v_mfma_f32_16x16x32_bf16 v[248:251], a[224:227], v[136:139], v[152:155]
    v_mfma_f32_16x16x32_bf16 v[248:251], a[228:231], v[168:171], v[248:251]
    ds_read_b128 a[240:243], v2 offset:4096
    ds_read_b128 a[244:247], v2 offset:5120
    v_mfma_f32_16x16x32_bf16 v[248:251], a[232:235], v[200:203], v[248:251]
    buffer_load_dwordx4 v1, s[36:39], s77 offen offset:1024 sc1 lds
    v_mfma_f32_16x16x32_bf16 v[248:251], a[236:239], v[232:235], v[248:251]
    s_waitcnt lgkmcnt(2)
    ds_read_b128 a[248:251], v2 offset:6144
    ds_read_b128 a[252:255], v2 offset:7168
    v_mfma_f32_16x16x32_bf16 a[16:19], v[104:107], v[64:67], a[16:19]
    v_exp_f32 v244, v244
    v_mfma_f32_16x16x32_bf16 a[16:19], v[108:111], v[68:71], a[16:19]
    ds_read_b128 v[112:115], v2 offset:20480
    ds_read_b128 v[116:119], v2 offset:21504
    v_mfma_f32_16x16x32_bf16 a[20:23], v[104:107], v[72:75], a[20:23]
    v_exp_f32 v245, v245
    v_mfma_f32_16x16x32_bf16 a[20:23], v[108:111], v[76:79], a[20:23]
    v_exp_f32 v246, v246
    v_mfma_f32_16x16x32_bf16 v[252:255], a[224:227], v[140:143], v[156:159]
    v_exp_f32 v247, v247
    v_mfma_f32_16x16x32_bf16 v[252:255], a[228:231], v[172:175], v[252:255]
    v_cvt_pk_bf16_f32 v40, v244, v245
    v_cvt_pk_bf16_f32 v41, v246, v247
    v_mfma_f32_16x16x32_bf16 v[252:255], a[232:235], v[204:207], v[252:255]
    v_exp_f32 v248, v248
    v_mfma_f32_16x16x32_bf16 v[252:255], a[236:239], v[236:239], v[252:255]
    v_exp_f32 v249, v249
    v_mfma_f32_16x16x32_bf16 a[24:27], v[104:107], v[80:83], a[24:27]
    v_exp_f32 v250, v250
    v_mfma_f32_16x16x32_bf16 a[24:27], v[108:111], v[84:87], a[24:27]
    v_exp_f32 v251, v251
    v_mfma_f32_16x16x32_bf16 a[28:31], v[104:107], v[88:91], a[28:31]
    v_cvt_pk_bf16_f32 v48, v248, v249
    v_cvt_pk_bf16_f32 v49, v250, v251
    v_mfma_f32_16x16x32_bf16 a[28:31], v[108:111], v[92:95], a[28:31]
    s_waitcnt lgkmcnt(0)
    buffer_load_dwordx4 v1, s[36:39], s77 offen offset:2048 sc1 lds
    v_mfma_f32_16x16x32_bf16 v[240:243], a[240:243], v[128:131], v[180:183]
    v_exp_f32 v252, v252
    v_mfma_f32_16x16x32_bf16 v[240:243], a[244:247], v[160:163], v[240:243]
    v_exp_f32 v253, v253
    v_mfma_f32_16x16x32_bf16 v[240:243], a[248:251], v[192:195], v[240:243]
    v_exp_f32 v254, v254
    v_mfma_f32_16x16x32_bf16 v[240:243], a[252:255], v[224:227], v[240:243]
    v_exp_f32 v255, v255
    v_mfma_f32_16x16x32_bf16 a[32:35], v[112:115], v[64:67], a[32:35]
    v_cvt_pk_bf16_f32 v56, v252, v253
    v_cvt_pk_bf16_f32 v57, v254, v255
    v_mfma_f32_16x16x32_bf16 a[32:35], v[116:119], v[68:71], a[32:35]
    ds_read_b128 v[120:123], v2 offset:22528
    ds_read_b128 v[124:127], v2 offset:23552
    v_mfma_f32_16x16x32_bf16 a[36:39], v[112:115], v[72:75], a[36:39]
    v_exp_f32 v240, v240
    v_mfma_f32_16x16x32_bf16 a[36:39], v[116:119], v[76:79], a[36:39]
    v_exp_f32 v241, v241
    v_mfma_f32_16x16x32_bf16 v[244:247], a[240:243], v[132:135], v[148:151]
    v_exp_f32 v242, v242
    v_mfma_f32_16x16x32_bf16 v[244:247], a[244:247], v[164:167], v[244:247]
    v_exp_f32 v243, v243
    v_mfma_f32_16x16x32_bf16 v[244:247], a[248:251], v[196:199], v[244:247]
    v_cvt_pk_bf16_f32 v34, v240, v241
    v_cvt_pk_bf16_f32 v35, v242, v243
    v_mfma_f32_16x16x32_bf16 v[244:247], a[252:255], v[228:231], v[244:247]
    v_mfma_f32_16x16x32_bf16 a[40:43], v[112:115], v[80:83], a[40:43]
    buffer_load_dwordx4 v1, s[36:39], s77 offen offset:3072 sc1 lds
    v_mfma_f32_16x16x32_bf16 a[40:43], v[116:119], v[84:87], a[40:43]
    v_mfma_f32_16x16x32_bf16 a[44:47], v[112:115], v[88:91], a[44:47]
    v_mfma_f32_16x16x32_bf16 a[44:47], v[116:119], v[92:95], a[44:47]
    v_mfma_f32_16x16x32_bf16 v[248:251], a[240:243], v[136:139], v[152:155]
    v_mfma_f32_16x16x32_bf16 v[248:251], a[244:247], v[168:171], v[248:251]
    ds_read_b128 a[224:227], v2 offset:8192
    ds_read_b128 a[228:231], v2 offset:9216
    v_mfma_f32_16x16x32_bf16 v[248:251], a[248:251], v[200:203], v[248:251]
    v_exp_f32 v244, v244
    v_mfma_f32_16x16x32_bf16 v[248:251], a[252:255], v[232:235], v[248:251]
    s_waitcnt lgkmcnt(2)
    ds_read_b128 a[232:235], v2 offset:10240
    ds_read_b128 a[236:239], v2 offset:11264
    v_mfma_f32_16x16x32_bf16 a[48:51], v[120:123], v[64:67], a[48:51]
    v_exp_f32 v245, v245
    v_mfma_f32_16x16x32_bf16 a[48:51], v[124:127], v[68:71], a[48:51]
    ds_read_b128 v[96:99], v2 offset:24576
    ds_read_b128 v[100:103], v2 offset:25600
    v_mfma_f32_16x16x32_bf16 a[52:55], v[120:123], v[72:75], a[52:55]
    v_exp_f32 v246, v246
    v_mfma_f32_16x16x32_bf16 a[52:55], v[124:127], v[76:79], a[52:55]
    v_exp_f32 v247, v247
    v_mfma_f32_16x16x32_bf16 v[252:255], a[240:243], v[140:143], v[156:159]
    v_cvt_pk_bf16_f32 v42, v244, v245
    v_cvt_pk_bf16_f32 v43, v246, v247
    v_mfma_f32_16x16x32_bf16 v[252:255], a[244:247], v[172:175], v[252:255]
    s_add_u32 s100, s77, 4096
    v_exp_f32 v248, v248
    v_mfma_f32_16x16x32_bf16 v[252:255], a[248:251], v[204:207], v[252:255]
    s_add_u32 m0, m0, 4096
    v_exp_f32 v249, v249
    v_mfma_f32_16x16x32_bf16 v[252:255], a[252:255], v[236:239], v[252:255]
    buffer_load_dwordx4 v1, s[36:39], s100 offen sc1 lds
    v_mfma_f32_16x16x32_bf16 a[56:59], v[120:123], v[80:83], a[56:59]
    v_exp_f32 v250, v250
    v_mfma_f32_16x16x32_bf16 a[56:59], v[124:127], v[84:87], a[56:59]
    v_exp_f32 v251, v251
    v_mfma_f32_16x16x32_bf16 a[60:63], v[120:123], v[88:91], a[60:63]
    v_cvt_pk_bf16_f32 v50, v248, v249
    v_cvt_pk_bf16_f32 v51, v250, v251
    v_mfma_f32_16x16x32_bf16 a[60:63], v[124:127], v[92:95], a[60:63]
    s_waitcnt lgkmcnt(0)
    v_exp_f32 v252, v252
    v_mfma_f32_16x16x32_bf16 v[240:243], a[224:227], v[128:131], v[184:187]
    v_exp_f32 v253, v253
    v_mfma_f32_16x16x32_bf16 v[240:243], a[228:231], v[160:163], v[240:243]
    v_exp_f32 v254, v254
    v_mfma_f32_16x16x32_bf16 v[240:243], a[232:235], v[192:195], v[240:243]
    v_exp_f32 v255, v255
    v_mfma_f32_16x16x32_bf16 v[240:243], a[236:239], v[224:227], v[240:243]
    v_cvt_pk_bf16_f32 v58, v252, v253
    v_cvt_pk_bf16_f32 v59, v254, v255
    v_mfma_f32_16x16x32_bf16 a[144:147], v[96:99], v[64:67], a[144:147]
    v_mfma_f32_16x16x32_bf16 a[144:147], v[100:103], v[68:71], a[144:147]
    ds_read_b128 v[104:107], v2 offset:26624
    ds_read_b128 v[108:111], v2 offset:27648
    v_mfma_f32_16x16x32_bf16 a[148:151], v[96:99], v[72:75], a[148:151]
    v_mfma_f32_16x16x32_bf16 a[148:151], v[100:103], v[76:79], a[148:151]
    buffer_load_dwordx4 v1, s[36:39], s100 offen offset:1024 sc1 lds
    v_mfma_f32_16x16x32_bf16 v[244:247], a[224:227], v[132:135], v[148:151]
    v_exp_f32 v240, v240
    v_mfma_f32_16x16x32_bf16 v[244:247], a[228:231], v[164:167], v[244:247]
    v_exp_f32 v241, v241
    v_mfma_f32_16x16x32_bf16 v[244:247], a[232:235], v[196:199], v[244:247]
    v_exp_f32 v242, v242
    v_mfma_f32_16x16x32_bf16 v[244:247], a[236:239], v[228:231], v[244:247]
    v_exp_f32 v243, v243
    v_mfma_f32_16x16x32_bf16 a[152:155], v[96:99], v[80:83], a[152:155]
    v_cvt_pk_bf16_f32 v36, v240, v241
    v_cvt_pk_bf16_f32 v37, v242, v243
    v_mfma_f32_16x16x32_bf16 a[152:155], v[100:103], v[84:87], a[152:155]
    v_mfma_f32_16x16x32_bf16 a[156:159], v[96:99], v[88:91], a[156:159]
    v_mfma_f32_16x16x32_bf16 a[156:159], v[100:103], v[92:95], a[156:159]
    v_mfma_f32_16x16x32_bf16 v[248:251], a[224:227], v[136:139], v[152:155]
    v_exp_f32 v244, v244
    v_mfma_f32_16x16x32_bf16 v[248:251], a[228:231], v[168:171], v[248:251]
    ds_read_b128 a[240:243], v2 offset:12288
    ds_read_b128 a[244:247], v2 offset:13312
    v_mfma_f32_16x16x32_bf16 v[248:251], a[232:235], v[200:203], v[248:251]
    v_exp_f32 v245, v245
    v_mfma_f32_16x16x32_bf16 v[248:251], a[236:239], v[232:235], v[248:251]
    s_waitcnt lgkmcnt(2)
    ds_read_b128 a[248:251], v2 offset:14336
    ds_read_b128 a[252:255], v2 offset:15360
    v_mfma_f32_16x16x32_bf16 a[160:163], v[104:107], v[64:67], a[160:163]
    buffer_load_dwordx4 v1, s[36:39], s100 offen offset:2048 sc1 lds
    v_mfma_f32_16x16x32_bf16 a[160:163], v[108:111], v[68:71], a[160:163]
    ds_read_b128 v[112:115], v2 offset:28672
    ds_read_b128 v[116:119], v2 offset:29696
    v_mfma_f32_16x16x32_bf16 a[164:167], v[104:107], v[72:75], a[164:167]
    v_exp_f32 v246, v246
    v_mfma_f32_16x16x32_bf16 a[164:167], v[108:111], v[76:79], a[164:167]
    v_exp_f32 v247, v247
    v_mfma_f32_16x16x32_bf16 v[252:255], a[224:227], v[140:143], v[156:159]
    v_cvt_pk_bf16_f32 v44, v244, v245
    v_cvt_pk_bf16_f32 v45, v246, v247
    v_mfma_f32_16x16x32_bf16 v[252:255], a[228:231], v[172:175], v[252:255]
    v_exp_f32 v248, v248
    v_mfma_f32_16x16x32_bf16 v[252:255], a[232:235], v[204:207], v[252:255]
    v_exp_f32 v249, v249
    v_mfma_f32_16x16x32_bf16 v[252:255], a[236:239], v[236:239], v[252:255]
    v_exp_f32 v250, v250
    v_mfma_f32_16x16x32_bf16 a[168:171], v[104:107], v[80:83], a[168:171]
    v_exp_f32 v251, v251
    v_mfma_f32_16x16x32_bf16 a[168:171], v[108:111], v[84:87], a[168:171]
    v_cvt_pk_bf16_f32 v52, v248, v249
    v_cvt_pk_bf16_f32 v53, v250, v251
    v_mfma_f32_16x16x32_bf16 a[172:175], v[104:107], v[88:91], a[172:175]
    v_mfma_f32_16x16x32_bf16 a[172:175], v[108:111], v[92:95], a[172:175]
    s_waitcnt lgkmcnt(0)
    v_exp_f32 v252, v252
    v_mfma_f32_16x16x32_bf16 v[240:243], a[240:243], v[128:131], v[188:191]
    v_exp_f32 v253, v253
    v_mfma_f32_16x16x32_bf16 v[240:243], a[244:247], v[160:163], v[240:243]
    buffer_load_dwordx4 v1, s[36:39], s100 offen offset:3072 sc1 lds
    v_mfma_f32_16x16x32_bf16 v[240:243], a[248:251], v[192:195], v[240:243]
    v_exp_f32 v254, v254
    v_mfma_f32_16x16x32_bf16 v[240:243], a[252:255], v[224:227], v[240:243]
    v_exp_f32 v255, v255
    v_mfma_f32_16x16x32_bf16 a[176:179], v[112:115], v[64:67], a[176:179]
    v_cvt_pk_bf16_f32 v60, v252, v253
    v_cvt_pk_bf16_f32 v61, v254, v255
    v_mfma_f32_16x16x32_bf16 a[176:179], v[116:119], v[68:71], a[176:179]
    ds_read_b128 v[120:123], v2 offset:30720
    ds_read_b128 v[124:127], v2 offset:31744
    v_mfma_f32_16x16x32_bf16 a[180:183], v[112:115], v[72:75], a[180:183]
    v_exp_f32 v240, v240
    v_mfma_f32_16x16x32_bf16 a[180:183], v[116:119], v[76:79], a[180:183]
    v_exp_f32 v241, v241
    v_mfma_f32_16x16x32_bf16 v[244:247], a[240:243], v[132:135], v[148:151]
    v_add_u32 v2, s82, v1
    v_cvt_pk_bf16_f32 v38, v240, v241
    v_mfma_f32_16x16x32_bf16 v[244:247], a[244:247], v[164:167], v[244:247]
    v_exp_f32 v242, v242
    v_mfma_f32_16x16x32_bf16 v[244:247], a[248:251], v[196:199], v[244:247]
    v_exp_f32 v243, v243
    v_mfma_f32_16x16x32_bf16 v[244:247], a[252:255], v[228:231], v[244:247]
    v_cvt_pk_bf16_f32 v39, v242, v243
    v_mfma_f32_16x16x32_bf16 a[184:187], v[112:115], v[80:83], a[184:187]
    v_mfma_f32_16x16x32_bf16 a[184:187], v[116:119], v[84:87], a[184:187]
    v_mfma_f32_16x16x32_bf16 a[188:191], v[112:115], v[88:91], a[188:191]
    s_add_u32 s77, s77, 32768
    v_mfma_f32_16x16x32_bf16 a[188:191], v[116:119], v[92:95], a[188:191]
    v_mfma_f32_16x16x32_bf16 v[248:251], a[240:243], v[136:139], v[152:155]
    v_mfma_f32_16x16x32_bf16 v[248:251], a[244:247], v[168:171], v[248:251]
    v_exp_f32 v244, v244
    v_mfma_f32_16x16x32_bf16 v[248:251], a[248:251], v[200:203], v[248:251]
    v_exp_f32 v245, v245
    v_mfma_f32_16x16x32_bf16 v[248:251], a[252:255], v[232:235], v[248:251]
    s_waitcnt lgkmcnt(0)
    v_exp_f32 v246, v246
    v_mfma_f32_16x16x32_bf16 a[192:195], v[120:123], v[64:67], a[192:195]
    v_exp_f32 v247, v247
    v_mfma_f32_16x16x32_bf16 a[192:195], v[124:127], v[68:71], a[192:195]
    v_cvt_pk_bf16_f32 v46, v244, v245
    v_cvt_pk_bf16_f32 v47, v246, v247
    v_mfma_f32_16x16x32_bf16 a[196:199], v[120:123], v[72:75], a[196:199]
    s_waitcnt vmcnt(8) lgkmcnt(0)
    v_exp_f32 v248, v248
    v_mfma_f32_16x16x32_bf16 a[196:199], v[124:127], v[76:79], a[196:199]
    s_barrier
    ds_read_b128 a[224:227], v2 offset:0
    ds_read_b128 a[228:231], v2 offset:1024
    v_mfma_f32_16x16x32_bf16 v[252:255], a[240:243], v[140:143], v[156:159]
    v_exp_f32 v249, v249
    v_mfma_f32_16x16x32_bf16 v[252:255], a[244:247], v[172:175], v[252:255]
    ds_read_b128 a[232:235], v2 offset:2048
    ds_read_b128 a[236:239], v2 offset:3072
    v_mfma_f32_16x16x32_bf16 v[252:255], a[248:251], v[204:207], v[252:255]
    ds_read_b128 v[96:99], v2 offset:16384
    v_cvt_pk_bf16_f32 v54, v248, v249
    v_mfma_f32_16x16x32_bf16 v[252:255], a[252:255], v[236:239], v[252:255]
    v_exp_f32 v250, v250
    v_mfma_f32_16x16x32_bf16 a[200:203], v[120:123], v[80:83], a[200:203]
    v_exp_f32 v251, v251
    v_mfma_f32_16x16x32_bf16 a[200:203], v[124:127], v[84:87], a[200:203]
    ds_read_b128 v[100:103], v2 offset:17408
    v_cvt_pk_bf16_f32 v55, v250, v251
    v_mfma_f32_16x16x32_bf16 a[204:207], v[120:123], v[88:91], a[204:207]
    v_mfma_f32_16x16x32_bf16 a[204:207], v[124:127], v[92:95], a[204:207]
    v_exp_f32 v252, v252
    v_smfmac_f32_16x16x64_bf16 a[208:211], a[136:139], v[64:71], v215
    v_smfmac_f32_16x16x64_bf16 a[212:215], a[136:139], v[72:79], v215
    s_sub_u32 s78, s78, 1
    v_smfmac_f32_16x16x64_bf16 a[216:219], a[136:139], v[80:87], v215
    s_cmp_lg_u32 s78, 0
    v_smfmac_f32_16x16x64_bf16 a[220:223], a[136:139], v[88:95], v215
    s_cbranch_scc1 K1_LB
K1_LB_END:
    v_add_f32 v212, s12, v148
    v_fma_f32 v176, v208, s8, v212
    v_fma_f32 v177, v209, s8, v212
    v_fma_f32 v178, v210, s8, v212
    v_fma_f32 v179, v211, s8, v212
    s_nop 1
    s_waitcnt lgkmcnt(0)
    v_mfma_f32_16x16x32_bf16 v[240:243], a[224:227], v[132:135], v[176:179]
    s_mov_b32 s7, 0
    ds_read_b128 v[104:107], v2 offset:18432
    ds_read_b128 v[108:111], v2 offset:19456
    v_mfma_f32_16x16x32_bf16 v[240:243], a[228:231], v[164:167], v[240:243]
    s_mov_b32 s99, s76
    buffer_load_dwordx4 v[64:67], v11, s[48:51], s7 offen nt
    v_mfma_f32_16x16x32_bf16 v[240:243], a[232:235], v[196:199], v[240:243]
    s_mov_b32 s7, 18432
    v_exp_f32 v253, v253
    v_mfma_f32_16x16x32_bf16 v[240:243], a[236:239], v[228:231], v[240:243]
    s_lshl_b32 s29, s6, 2
    v_exp_f32 v254, v254
    v_mfma_f32_16x16x32_bf16 a[0:3], v[96:99], v[32:35], a[0:3]
    s_lshr_b32 s29, 0x41302413, s29
    v_exp_f32 v255, v255
    v_mfma_f32_16x16x32_bf16 a[0:3], v[100:103], v[36:39], a[0:3]
    s_and_b32 s29, s29, 7
    buffer_load_dwordx4 v[68:71], v11, s[48:51], s7 offen nt
    v_mfma_f32_16x16x32_bf16 a[4:7], v[96:99], v[40:43], a[4:7]
    s_mov_b32 s7, 9216
    v_cvt_pk_bf16_f32 v62, v252, v253
    v_cvt_pk_bf16_f32 v63, v254, v255
    v_mfma_f32_16x16x32_bf16 a[4:7], v[100:103], v[44:47], a[4:7]
    s_lshl_b32 s29, s29, 15
    ds_read_b128 a[240:243], v2 offset:4096
    ds_read_b128 a[244:247], v2 offset:5120
    v_mfma_f32_16x16x32_bf16 v[244:247], a[224:227], v[136:139], v[152:155]
    s_add_u32 s44, s29, s75
    ds_read_b128 a[248:251], v2 offset:6144
    v_add_f32 v213, s13, v148
    v_mfma_f32_16x16x32_bf16 v[244:247], a[228:231], v[168:171], v[244:247]
    s_lshl_b32 s29, s6, 2
    buffer_load_dwordx4 v[20:23], v11, s[48:51], s7 offen nt
    v_mfma_f32_16x16x32_bf16 v[244:247], a[232:235], v[200:203], v[244:247]
    s_mov_b32 s7, 27648
    ds_read_b128 a[252:255], v2 offset:7168
    ds_read_b128 v[112:115], v2 offset:20480
    v_mfma_f32_16x16x32_bf16 v[244:247], a[236:239], v[232:235], v[244:247]
    s_lshr_b32 s29, 0x2413024, s29
    ds_read_b128 v[116:119], v2 offset:21504
    v_fma_f32 v180, v208, s9, v213
    v_mfma_f32_16x16x32_bf16 a[8:11], v[96:99], v[48:51], a[8:11]
    s_and_b32 s29, s29, 7
    v_fma_f32 v181, v209, s9, v213
    v_fma_f32 v182, v210, s9, v213
    v_mfma_f32_16x16x32_bf16 a[8:11], v[100:103], v[52:55], a[8:11]
    s_lshl_b32 s29, s29, 15
    buffer_load_dwordx4 v[24:27], v11, s[48:51], s7 offen nt
    v_mfma_f32_16x16x32_bf16 a[12:15], v[96:99], v[56:59], a[12:15]
    s_add_u32 s45, s29, s75
    v_fma_f32 v183, v211, s9, v213
    ds_read_b128 v[120:123], v2 offset:22528
    v_mfma_f32_16x16x32_bf16 a[12:15], v[100:103], v[60:63], a[12:15]
    s_lshl_b32 s29, s6, 2
    v_exp_f32 v240, v240
    s_waitcnt lgkmcnt(2)
    v_mfma_f32_16x16x32_bf16 a[16:19], v[104:107], v[32:35], a[16:19]
    s_lshr_b32 s29, 0x13024130, s29
    v_exp_f32 v241, v241
    v_mfma_f32_16x16x32_bf16 a[16:19], v[108:111], v[36:39], a[16:19]
    s_and_b32 s29, s29, 7
    buffer_load_dwordx4 v[144:147], v12, s[52:55], 0 offen nt
    v_mfma_f32_16x16x32_bf16 v[248:251], a[224:227], v[140:143], v[156:159]
    s_lshl_b32 s29, s29, 15
    v_exp_f32 v242, v242
    v_mfma_f32_16x16x32_bf16 v[248:251], a[228:231], v[172:175], v[248:251]
    s_add_u32 s46, s29, s75
    v_exp_f32 v243, v243
    v_mfma_f32_16x16x32_bf16 v[248:251], a[232:235], v[204:207], v[248:251]
    s_lshl_b32 s29, s6, 2
    v_cvt_pk_bf16_f32 v72, v240, v241
    v_cvt_pk_bf16_f32 v73, v242, v243
    v_mfma_f32_16x16x32_bf16 v[248:251], a[236:239], v[236:239], v[248:251]
    s_lshr_b32 s29, 0x24130241, s29
    buffer_load_dwordx4 a[140:143], v13, s[52:55], 0 offen nt
    v_mfma_f32_16x16x32_bf16 a[20:23], v[104:107], v[40:43], a[20:23]
    s_and_b32 s29, s29, 7
    ds_read_b128 v[124:127], v2 offset:23552
    ds_read_b128 a[224:227], v2 offset:8192
    v_mfma_f32_16x16x32_bf16 a[20:23], v[108:111], v[44:47], a[20:23]
    s_lshl_b32 s29, s29, 15
    v_exp_f32 v244, v244
    v_mfma_f32_16x16x32_bf16 a[24:27], v[104:107], v[48:51], a[24:27]
    s_add_u32 s47, s29, s75
    v_exp_f32 v245, v245
    v_mfma_f32_16x16x32_bf16 a[24:27], v[108:111], v[52:55], a[24:27]
    s_lshl_b32 s29, s6, 2
    v_exp_f32 v246, v246
    v_mfma_f32_16x16x32_bf16 a[28:31], v[104:107], v[56:59], a[28:31]
    s_lshr_b32 s29, 0x30241302, s29
    v_exp_f32 v247, v247
    v_mfma_f32_16x16x32_bf16 a[28:31], v[108:111], v[60:63], a[28:31]
    s_and_b32 s29, s29, 7
    v_cvt_pk_bf16_f32 v80, v244, v245
    v_cvt_pk_bf16_f32 v81, v246, v247
    v_mfma_f32_16x16x32_bf16 v[252:255], a[240:243], v[132:135], v[180:183]
    s_mov_b32 s98, 0x3fb8aa3b
    ds_read_b128 a[228:231], v2 offset:9216
    ds_read_b128 a[232:235], v2 offset:10240
    v_mfma_f32_16x16x32_bf16 v[252:255], a[244:247], v[164:167], v[252:255]
    s_lshr_b32 s61, s5, 3
    ds_read_b128 a[236:239], v2 offset:11264
    v_add_f32 v212, s14, v148
    v_mfma_f32_16x16x32_bf16 v[252:255], a[248:251], v[196:199], v[252:255]
    s_lshl_b32 s29, s29, 15
    ds_read_b128 v[96:99], v2 offset:24576
    v_fma_f32 v184, v208, s10, v212
    v_mfma_f32_16x16x32_bf16 v[252:255], a[252:255], v[228:231], v[252:255]
    s_add_u32 s79, s29, s75
    ds_read_b128 v[100:103], v2 offset:25600
    v_fma_f32 v185, v209, s10, v212
    v_mfma_f32_16x16x32_bf16 a[32:35], v[112:115], v[32:35], a[32:35]
    s_mul_i32 s71, s61, 6144
    v_exp_f32 v248, v248
    s_waitcnt lgkmcnt(5)
    v_mfma_f32_16x16x32_bf16 a[32:35], v[116:119], v[36:39], a[32:35]
    s_and_b32 s29, s5, 7
    v_exp_f32 v249, v249
    v_mfma_f32_16x16x32_bf16 a[36:39], v[112:115], v[40:43], a[36:39]
    s_add_u32 s3, s5, s6
    v_exp_f32 v250, v250
    v_mfma_f32_16x16x32_bf16 a[36:39], v[116:119], v[44:47], a[36:39]
    s_add_u32 s71, s71, 131072
    v_exp_f32 v251, v251
    v_mfma_f32_16x16x32_bf16 v[240:243], a[240:243], v[136:139], v[152:155]
    s_lshl_b32 s29, s29, 8
    v_fma_f32 v186, v210, s10, v212
    v_fma_f32 v187, v211, s10, v212
    v_mfma_f32_16x16x32_bf16 v[240:243], a[244:247], v[168:171], v[240:243]
    s_add_u32 s74, s4, 1
    v_cvt_pk_bf16_f32 v88, v248, v249
    v_cvt_pk_bf16_f32 v89, v250, v251
    v_mfma_f32_16x16x32_bf16 v[240:243], a[248:251], v[200:203], v[240:243]
    s_and_b32 s28, s5, 3
    v_exp_f32 v252, v252
    v_mfma_f32_16x16x32_bf16 v[240:243], a[252:255], v[232:235], v[240:243]
    s_and_b32 s3, s3, 1
    v_exp_f32 v253, v253
    v_mfma_f32_16x16x32_bf16 a[40:43], v[112:115], v[48:51], a[40:43]
    s_lshl2_add_u32 s66, s6, s61
    v_exp_f32 v254, v254
    v_mfma_f32_16x16x32_bf16 a[40:43], v[116:119], v[52:55], a[40:43]
    s_add_u32 s71, s71, s29
    v_exp_f32 v255, v255
    v_mfma_f32_16x16x32_bf16 a[44:47], v[112:115], v[56:59], a[44:47]
    s_lshl_b32 s74, s74, 15
    v_cvt_pk_bf16_f32 v74, v252, v253
    v_cvt_pk_bf16_f32 v75, v254, v255
    v_mfma_f32_16x16x32_bf16 a[44:47], v[116:119], v[60:63], a[44:47]
    s_mul_i32 s28, s28, 9216
    ds_read_b128 v[104:107], v2 offset:26624
    ds_read_b128 v[108:111], v2 offset:27648
    v_mfma_f32_16x16x32_bf16 a[48:51], v[120:123], v[32:35], a[48:51]
    s_lshl3_add_u32 s3, s61, s3
    v_exp_f32 v240, v240
    v_mfma_f32_16x16x32_bf16 a[48:51], v[124:127], v[36:39], a[48:51]
    s_lshl_b32 s66, s66, 10
    v_exp_f32 v241, v241
    v_mfma_f32_16x16x32_bf16 v[244:247], a[240:243], v[140:143], v[156:159]
    s_add_u32 s70, s71, 4096
    v_exp_f32 v242, v242
    v_mfma_f32_16x16x32_bf16 v[244:247], a[244:247], v[172:175], v[244:247]
    s_add_u32 s71, s71, s29
    v_exp_f32 v243, v243
    v_mfma_f32_16x16x32_bf16 v[244:247], a[248:251], v[204:207], v[244:247]
    s_add_u32 s74, s74, s101
    v_cvt_pk_bf16_f32 v82, v240, v241
    v_cvt_pk_bf16_f32 v83, v242, v243
    v_mfma_f32_16x16x32_bf16 v[244:247], a[252:255], v[236:239], v[244:247]
    ds_read_b128 a[240:243], v2 offset:12288
    ds_read_b128 a[244:247], v2 offset:13312
    v_mfma_f32_16x16x32_bf16 a[52:55], v[120:123], v[40:43], a[52:55]
    ds_read_b128 a[248:251], v2 offset:14336
    v_add_f32 v213, s15, v148
    v_mfma_f32_16x16x32_bf16 a[52:55], v[124:127], v[44:47], a[52:55]
    ds_read_b128 a[252:255], v2 offset:15360
    v_fma_f32 v188, v208, s11, v213
    v_mfma_f32_16x16x32_bf16 a[56:59], v[120:123], v[48:51], a[56:59]
    ds_read_b128 v[112:115], v2 offset:28672
    v_fma_f32 v189, v209, s11, v213
    v_mfma_f32_16x16x32_bf16 a[56:59], v[124:127], v[52:55], a[56:59]
    ds_read_b128 v[116:119], v2 offset:29696
    v_fma_f32 v190, v210, s11, v213
    v_mfma_f32_16x16x32_bf16 a[60:63], v[120:123], v[56:59], a[60:63]
    v_exp_f32 v244, v244
    v_mfma_f32_16x16x32_bf16 a[60:63], v[124:127], v[60:63], a[60:63]
    v_exp_f32 v245, v245
    v_mfma_f32_16x16x32_bf16 v[248:251], a[224:227], v[132:135], v[184:187]
    s_waitcnt lgkmcnt(2)
    v_exp_f32 v246, v246
    v_mfma_f32_16x16x32_bf16 v[248:251], a[228:231], v[164:167], v[248:251]
    v_exp_f32 v247, v247
    v_mfma_f32_16x16x32_bf16 v[248:251], a[232:235], v[196:199], v[248:251]
    v_fma_f32 v191, v211, s11, v213
    v_cvt_pk_bf16_f32 v90, v244, v245
    v_mfma_f32_16x16x32_bf16 v[248:251], a[236:239], v[228:231], v[248:251]
    s_add_u32 m0, s76, s75
    v_cvt_pk_bf16_f32 v91, v246, v247
    ds_read_b128 v[120:123], v2 offset:30720
    v_mfma_f32_16x16x32_bf16 a[144:147], v[96:99], v[32:35], a[144:147]
    s_mov_b32 s76, s60
    buffer_load_dwordx4 v1, s[36:39], s77 offen sc1 lds
    v_mfma_f32_16x16x32_bf16 a[144:147], v[100:103], v[36:39], a[144:147]
    s_mov_b32 s60, s82
    v_exp_f32 v248, v248
    v_mfma_f32_16x16x32_bf16 a[148:151], v[96:99], v[40:43], a[148:151]
    s_mov_b32 s82, s95
    v_exp_f32 v249, v249
    v_mfma_f32_16x16x32_bf16 a[148:151], v[100:103], v[44:47], a[148:151]
    s_mov_b32 s95, s93
    v_exp_f32 v250, v250
    v_mfma_f32_16x16x32_bf16 v[252:255], a[224:227], v[136:139], v[152:155]
    s_mov_b32 s93, s99
    v_exp_f32 v251, v251
    v_mfma_f32_16x16x32_bf16 v[252:255], a[228:231], v[168:171], v[252:255]
    v_cvt_pk_bf16_f32 v76, v248, v249
    v_cvt_pk_bf16_f32 v77, v250, v251
    v_mfma_f32_16x16x32_bf16 v[252:255], a[232:235], v[200:203], v[252:255]
    ds_read_b128 v[124:127], v2 offset:31744
    v_add_u32 v2, s82, v1
    v_mfma_f32_16x16x32_bf16 v[252:255], a[236:239], v[232:235], v[252:255]
    buffer_load_dwordx4 v1, s[36:39], s77 offen offset:1024 sc1 lds
    v_mfma_f32_16x16x32_bf16 a[152:155], v[96:99], v[48:51], a[152:155]
    v_bfe_u32 v8, v1, 2, 6
    v_accvgpr_read_b32 v4, a112
    v_mfma_f32_16x16x32_bf16 a[152:155], v[100:103], v[52:55], a[152:155]
    v_accvgpr_read_b32 v5, a116
    v_add_u32 v8, 192, v8
    v_mfma_f32_16x16x32_bf16 a[156:159], v[96:99], v[56:59], a[156:159]
    v_exp_f32 v252, v252
    v_mfma_f32_16x16x32_bf16 a[156:159], v[100:103], v[60:63], a[156:159]
    v_exp_f32 v253, v253
    v_mfma_f32_16x16x32_bf16 a[160:163], v[104:107], v[32:35], a[160:163]
    v_exp_f32 v254, v254
    v_mfma_f32_16x16x32_bf16 a[160:163], v[108:111], v[36:39], a[160:163]
    v_exp_f32 v255, v255
    v_mfma_f32_16x16x32_bf16 v[240:243], a[224:227], v[140:143], v[156:159]
    buffer_load_dwordx4 v1, s[36:39], s77 offen offset:2048 sc1 lds
    v_mfma_f32_16x16x32_bf16 v[240:243], a[228:231], v[172:175], v[240:243]
    v_cvt_pk_bf16_f32 v84, v252, v253
    v_cvt_pk_bf16_f32 v85, v254, v255
    v_mfma_f32_16x16x32_bf16 v[240:243], a[232:235], v[204:207], v[240:243]
    v_cvt_pk_bf16_f32 v4, 0, v4
    v_cvt_pk_bf16_f32 v5, 0, v5
    v_mfma_f32_16x16x32_bf16 v[240:243], a[236:239], v[236:239], v[240:243]
    v_lshrrev_b32 v15, 8, v1
    ds_bpermute_b32 v4, v8, v4
    v_mfma_f32_16x16x32_bf16 a[164:167], v[104:107], v[40:43], a[164:167]
    ds_bpermute_b32 v5, v8, v5
    ds_read_b128 a[224:227], v2 offset:0
    v_mfma_f32_16x16x32_bf16 a[164:167], v[108:111], v[44:47], a[164:167]
    ds_read_b128 a[228:231], v2 offset:1024
    v_bfe_u32 v14, v1, 4, 4
    v_mfma_f32_16x16x32_bf16 a[168:171], v[104:107], v[48:51], a[168:171]
    ds_read_b128 a[232:235], v2 offset:2048
    v_lshlrev_b32 v15, 3, v15
    v_mfma_f32_16x16x32_bf16 a[168:171], v[108:111], v[52:55], a[168:171]
    buffer_load_dwordx4 v1, s[36:39], s77 offen offset:3072 sc1 lds
    v_mfma_f32_16x16x32_bf16 a[172:175], v[104:107], v[56:59], a[172:175]
    ds_read_b128 a[236:239], v2 offset:3072
    ds_read_b128 v[96:99], v2 offset:16384
    v_mfma_f32_16x16x32_bf16 a[172:175], v[108:111], v[60:63], a[172:175]
    ds_read_b128 v[100:103], v2 offset:17408
    v_sub_u32 v14, v14, v15
    v_mfma_f32_16x16x32_bf16 v[244:247], a[240:243], v[132:135], v[188:191]
    v_exp_f32 v240, v240
    v_mfma_f32_16x16x32_bf16 v[244:247], a[244:247], v[164:167], v[244:247]
    v_exp_f32 v241, v241
    v_mfma_f32_16x16x32_bf16 v[244:247], a[248:251], v[196:199], v[244:247]
    v_exp_f32 v242, v242
    v_mfma_f32_16x16x32_bf16 v[244:247], a[252:255], v[228:231], v[244:247]
    s_add_u32 s100, s77, 4096
    v_exp_f32 v243, v243
    s_waitcnt lgkmcnt(1)
    v_mfma_f32_16x16x32_bf16 a[176:179], v[112:115], v[32:35], a[176:179]
    s_add_u32 m0, m0, 4096
    v_cvt_pk_bf16_f32 v92, v240, v241
    v_cvt_pk_bf16_f32 v93, v242, v243
    v_mfma_f32_16x16x32_bf16 a[176:179], v[116:119], v[36:39], a[176:179]
    buffer_load_dwordx4 v1, s[36:39], s100 offen sc1 lds
    v_mfma_f32_16x16x32_bf16 a[180:183], v[112:115], v[40:43], a[180:183]
    v_exp_f32 v244, v244
    v_mfma_f32_16x16x32_bf16 a[180:183], v[116:119], v[44:47], a[180:183]
    v_exp_f32 v245, v245
    v_mfma_f32_16x16x32_bf16 v[248:251], a[240:243], v[136:139], v[152:155]
    v_exp_f32 v246, v246
    v_mfma_f32_16x16x32_bf16 v[248:251], a[244:247], v[168:171], v[248:251]
    v_exp_f32 v247, v247
    v_mfma_f32_16x16x32_bf16 v[248:251], a[248:251], v[200:203], v[248:251]
    v_cvt_pk_bf16_f32 v78, v244, v245
    v_cvt_pk_bf16_f32 v79, v246, v247
    v_mfma_f32_16x16x32_bf16 v[248:251], a[252:255], v[232:235], v[248:251]
    buffer_load_dwordx4 v1, s[36:39], s100 offen offset:1024 sc1 lds
    v_mfma_f32_16x16x32_bf16 a[184:187], v[112:115], v[48:51], a[184:187]
    v_and_b32 v15, 16, v1
    v_mov_b32 v31, 0x3f80
    v_mfma_f32_16x16x32_bf16 a[184:187], v[116:119], v[52:55], a[184:187]
    v_ashrrev_i32 v14, 1, v14
    v_lshlrev_b32 v15, v15, v31
    v_mfma_f32_16x16x32_bf16 a[188:191], v[112:115], v[56:59], a[188:191]
    v_exp_f32 v248, v248
    v_mfma_f32_16x16x32_bf16 a[188:191], v[116:119], v[60:63], a[188:191]
    v_exp_f32 v249, v249
    v_mfma_f32_16x16x32_bf16 a[192:195], v[120:123], v[32:35], a[192:195]
    v_exp_f32 v250, v250
    v_mfma_f32_16x16x32_bf16 a[192:195], v[124:127], v[36:39], a[192:195]
    v_exp_f32 v251, v251
    v_mfma_f32_16x16x32_bf16 v[252:255], a[240:243], v[140:143], v[156:159]
    buffer_load_dwordx4 v1, s[36:39], s100 offen offset:2048 sc1 lds
    v_mfma_f32_16x16x32_bf16 v[252:255], a[244:247], v[172:175], v[252:255]
    v_cvt_pk_bf16_f32 v86, v248, v249
    v_cvt_pk_bf16_f32 v87, v250, v251
    v_mfma_f32_16x16x32_bf16 v[252:255], a[248:251], v[204:207], v[252:255]
    v_cmp_eq_i32 vcc, 0, v14
    v_mul_f32 v4, s98, v4
    v_mfma_f32_16x16x32_bf16 v[252:255], a[252:255], v[236:239], v[252:255]
    v_cndmask_b32 v216, 0, v15, vcc
    v_cmp_eq_i32 vcc, 1, v14
    v_mfma_f32_16x16x32_bf16 a[196:199], v[120:123], v[40:43], a[196:199]
    v_mul_f32 v5, s98, v5
    v_cndmask_b32 v217, 0, v15, vcc
    v_mfma_f32_16x16x32_bf16 a[196:199], v[124:127], v[44:47], a[196:199]
    v_cmp_eq_i32 vcc, 2, v14
    v_and_b32 v31, 512, v1
    v_mfma_f32_16x16x32_bf16 a[200:203], v[120:123], v[48:51], a[200:203]
    v_exp_f32 v252, v252
    v_mfma_f32_16x16x32_bf16 a[200:203], v[124:127], v[52:55], a[200:203]
    buffer_load_dwordx4 v1, s[36:39], s100 offen offset:3072 sc1 lds
    v_mfma_f32_16x16x32_bf16 a[204:207], v[120:123], v[56:59], a[204:207]
    v_cndmask_b32 v218, 0, v15, vcc
    v_cmp_eq_i32 vcc, 3, v14
    v_mfma_f32_16x16x32_bf16 a[204:207], v[124:127], v[60:63], a[204:207]
    v_exp_f32 v4, v4
    v_smfmac_f32_16x16x64_bf16 a[208:211], a[136:139], v[32:39], v215
    v_cndmask_b32 v219, 0, v15, vcc
    v_cmp_eq_i32 vcc, -8, v14
    v_smfmac_f32_16x16x64_bf16 a[212:215], a[136:139], v[40:47], v215
    v_exp_f32 v5, v5
    v_smfmac_f32_16x16x64_bf16 a[216:219], a[136:139], v[48:55], v215
    v_cndmask_b32 v220, 0, v15, vcc
    v_cmp_eq_i32 vcc, -7, v14
    v_smfmac_f32_16x16x64_bf16 a[220:223], a[136:139], v[56:63], v215
    s_add_u32 s77, s77, 32768
    v_cndmask_b32 v221, 0, v15, vcc
    v_cmp_eq_i32 vcc, -6, v14
    v_add_f32 v4, 1.0, v4
    v_add_f32 v5, 1.0, v5
    v_cndmask_b32 v222, 0, v15, vcc
    v_cmp_eq_i32 vcc, -5, v14
    v_rcp_f32 v4, v4
    v_rcp_f32 v5, v5
    v_cndmask_b32 v223, 0, v15, vcc
    v_mad_u32_u24 v31, v31, 17, v1
    s_cmp_eq_u32 s6, 7
    s_cselect_b32 s16, s8, 0
    s_cselect_b32 s17, s9, 0
    s_cselect_b32 s18, s10, 0
    s_cselect_b32 s19, s11, 0
    s_cselect_b32 s20, s12, 0
    s_cselect_b32 s21, s13, 0
    s_cselect_b32 s22, s14, 0
    s_cselect_b32 s23, s15, 0
    s_cbranch_scc1 K1_J7
K1_J7_BACK:
    v_add_f32 v212, s20, v152
    v_fma_f32 v176, v208, s16, v212
    v_fma_f32 v177, v209, s16, v212
    v_fma_f32 v178, v210, s16, v212
    v_fma_f32 v179, v211, s16, v212
    s_nop 1
    s_waitcnt lgkmcnt(0)
    v_mfma_f32_16x16x32_bf16 v[240:243], a[224:227], v[136:139], v[176:179]
    s_mov_b32 s99, s76
    ds_read_b128 v[104:107], v2 offset:18432
    ds_read_b128 v[108:111], v2 offset:19456
    v_mfma_f32_16x16x32_bf16 v[240:243], a[228:231], v[168:171], v[240:243]
    v_exp_f32 v253, v253
    v_mfma_f32_16x16x32_bf16 v[240:243], a[232:235], v[200:203], v[240:243]
    v_exp_f32 v254, v254
    v_mfma_f32_16x16x32_bf16 v[240:243], a[236:239], v[232:235], v[240:243]
    v_exp_f32 v255, v255
    v_mfma_f32_16x16x32_bf16 a[4:7], v[96:99], v[72:75], a[4:7]
    s_add_u32 m0, s76, s75
    v_cvt_pk_bf16_f32 v94, v252, v253
    v_cvt_pk_bf16_f32 v95, v254, v255
    v_mfma_f32_16x16x32_bf16 a[4:7], v[100:103], v[76:79], a[4:7]
    s_mov_b32 s76, s60
    buffer_load_dwordx4 v1, s[36:39], s77 offen sc1 lds
    v_mfma_f32_16x16x32_bf16 a[8:11], v[96:99], v[80:83], a[8:11]
    s_mov_b32 s60, s82
    ds_read_b128 a[240:243], v2 offset:4096
    ds_read_b128 a[244:247], v2 offset:5120
    v_mfma_f32_16x16x32_bf16 a[8:11], v[100:103], v[84:87], a[8:11]
    s_mov_b32 s82, s95
    ds_read_b128 a[248:251], v2 offset:6144
    v_add_f32 v213, s21, v152
    v_mfma_f32_16x16x32_bf16 a[12:15], v[96:99], v[88:91], a[12:15]
    s_mov_b32 s95, s93
    ds_read_b128 a[252:255], v2 offset:7168
    v_fma_f32 v180, v208, s17, v213
    v_mfma_f32_16x16x32_bf16 a[12:15], v[100:103], v[92:95], a[12:15]
    s_mov_b32 s93, s99
    ds_read_b128 v[112:115], v2 offset:20480
    v_fma_f32 v181, v209, s17, v213
    v_mfma_f32_16x16x32_bf16 v[244:247], a[224:227], v[140:143], v[156:159]
    ds_read_b128 v[116:119], v2 offset:21504
    v_fma_f32 v182, v210, s17, v213
    v_mfma_f32_16x16x32_bf16 v[244:247], a[228:231], v[172:175], v[244:247]
    v_fma_f32 v183, v211, s17, v213
    ds_read_b128 v[120:123], v2 offset:22528
    v_mfma_f32_16x16x32_bf16 v[244:247], a[232:235], v[204:207], v[244:247]
    ds_read_b128 v[124:127], v2 offset:23552
    v_add_f32 v212, s22, v152
    v_mfma_f32_16x16x32_bf16 v[244:247], a[236:239], v[236:239], v[244:247]
    s_waitcnt lgkmcnt(4)
    buffer_load_dwordx4 v1, s[36:39], s77 offen offset:1024 sc1 lds
    v_mfma_f32_16x16x32_bf16 a[20:23], v[104:107], v[72:75], a[20:23]
    ds_read_b128 a[224:227], v2 offset:8192
    ds_read_b128 a[228:231], v2 offset:9216
    v_mfma_f32_16x16x32_bf16 a[20:23], v[108:111], v[76:79], a[20:23]
    ds_read_b128 a[232:235], v2 offset:10240
    v_fma_f32 v184, v208, s18, v212
    v_mfma_f32_16x16x32_bf16 a[24:27], v[104:107], v[80:83], a[24:27]
    ds_read_b128 a[236:239], v2 offset:11264
    v_fma_f32 v185, v209, s18, v212
    v_mfma_f32_16x16x32_bf16 a[24:27], v[108:111], v[84:87], a[24:27]
    ds_read_b128 v[96:99], v2 offset:24576
    v_fma_f32 v186, v210, s18, v212
    v_mfma_f32_16x16x32_bf16 a[28:31], v[104:107], v[88:91], a[28:31]
    ds_read_b128 v[100:103], v2 offset:25600
    v_fma_f32 v187, v211, s18, v212
    v_mfma_f32_16x16x32_bf16 a[28:31], v[108:111], v[92:95], a[28:31]
    v_exp_f32 v240, v240
    v_mfma_f32_16x16x32_bf16 v[248:251], a[240:243], v[136:139], v[180:183]
    v_exp_f32 v241, v241
    v_mfma_f32_16x16x32_bf16 v[248:251], a[244:247], v[168:171], v[248:251]
    v_exp_f32 v242, v242
    v_mfma_f32_16x16x32_bf16 v[248:251], a[248:251], v[200:203], v[248:251]
    buffer_load_dwordx4 v1, s[36:39], s77 offen offset:2048 sc1 lds
    v_mfma_f32_16x16x32_bf16 v[248:251], a[252:255], v[232:235], v[248:251]
    s_waitcnt lgkmcnt(0)
    v_exp_f32 v243, v243
    v_mfma_f32_16x16x32_bf16 a[36:39], v[112:115], v[72:75], a[36:39]
    v_cvt_pk_bf16_f32 v48, v240, v241
    v_cvt_pk_bf16_f32 v49, v242, v243
    v_mfma_f32_16x16x32_bf16 a[36:39], v[116:119], v[76:79], a[36:39]
    ds_read_b128 v[104:107], v2 offset:26624
    ds_read_b128 v[108:111], v2 offset:27648
    v_mfma_f32_16x16x32_bf16 a[40:43], v[112:115], v[80:83], a[40:43]
    v_exp_f32 v244, v244
    v_mfma_f32_16x16x32_bf16 a[40:43], v[116:119], v[84:87], a[40:43]
    v_exp_f32 v245, v245
    v_mfma_f32_16x16x32_bf16 a[44:47], v[112:115], v[88:91], a[44:47]
    v_exp_f32 v246, v246
    v_mfma_f32_16x16x32_bf16 a[44:47], v[116:119], v[92:95], a[44:47]
    s_waitcnt vmcnt(11)
    v_exp_f32 v247, v247
    v_mfma_f32_16x16x32_bf16 v[12:15], v[64:67], v[216:219], 0
    buffer_load_dwordx4 v1, s[36:39], s77 offen offset:3072 sc1 lds
    v_mfma_f32_16x16x32_bf16 v[16:19], v[68:71], v[216:219], 0
    v_cvt_pk_bf16_f32 v56, v244, v245
    v_cvt_pk_bf16_f32 v57, v246, v247
    v_mfma_f32_16x16x32_bf16 v[252:255], a[240:243], v[140:143], v[156:159]
    ds_read_b128 a[240:243], v2 offset:12288
    ds_read_b128 v[112:115], v2 offset:28672
    v_mfma_f32_16x16x32_bf16 v[252:255], a[244:247], v[172:175], v[252:255]
    v_cvt_pk_bf16_f32 v12, v12, v13
    v_cvt_pk_bf16_f32 v13, v14, v15
    v_mfma_f32_16x16x32_bf16 v[252:255], a[248:251], v[204:207], v[252:255]
    v_cvt_pk_bf16_f32 v14, v16, v17
    v_cvt_pk_bf16_f32 v15, v18, v19
    v_mfma_f32_16x16x32_bf16 v[252:255], a[252:255], v[236:239], v[252:255]
    buffer_store_dwordx4 v[12:15], v31, s[56:59], s63 offen offset:0 sc1
    v_mfma_f32_16x16x32_bf16 a[52:55], v[120:123], v[72:75], a[52:55]
    ds_read_b128 a[244:247], v2 offset:13312
    ds_read_b128 a[248:251], v2 offset:14336
    v_mfma_f32_16x16x32_bf16 a[52:55], v[124:127], v[76:79], a[52:55]
    ds_read_b128 a[252:255], v2 offset:15360
    v_add_f32 v213, s23, v152
    v_mfma_f32_16x16x32_bf16 a[56:59], v[120:123], v[80:83], a[56:59]
    s_add_u32 s100, s77, 4096
    ds_read_b128 v[116:119], v2 offset:29696
    v_fma_f32 v188, v208, s19, v213
    v_mfma_f32_16x16x32_bf16 a[56:59], v[124:127], v[84:87], a[56:59]
    s_add_u32 m0, m0, 4096
    v_exp_f32 v248, v248
    v_mfma_f32_16x16x32_bf16 a[60:63], v[120:123], v[88:91], a[60:63]
    buffer_load_dwordx4 v1, s[36:39], s100 offen sc1 lds
    v_mfma_f32_16x16x32_bf16 a[60:63], v[124:127], v[92:95], a[60:63]
    v_exp_f32 v249, v249
    v_mfma_f32_16x16x32_bf16 v[12:15], v[64:67], v[220:223], 0
    v_exp_f32 v250, v250
    v_mfma_f32_16x16x32_bf16 v[16:19], v[68:71], v[220:223], 0
    v_exp_f32 v251, v251
    v_mfma_f32_16x16x32_bf16 v[240:243], a[224:227], v[136:139], v[184:187]
    v_fma_f32 v189, v209, s19, v213
    v_fma_f32 v190, v210, s19, v213
    v_mfma_f32_16x16x32_bf16 v[240:243], a[228:231], v[168:171], v[240:243]
    v_fma_f32 v191, v211, s19, v213
    v_cvt_pk_bf16_f32 v12, v12, v13
    v_mfma_f32_16x16x32_bf16 v[240:243], a[232:235], v[200:203], v[240:243]
    v_cvt_pk_bf16_f32 v13, v14, v15
    v_cvt_pk_bf16_f32 v14, v16, v17
    v_mfma_f32_16x16x32_bf16 v[240:243], a[236:239], v[232:235], v[240:243]
    v_cvt_pk_bf16_f32 v15, v18, v19
    v_cvt_pk_bf16_f32 v50, v248, v249
    v_mfma_f32_16x16x32_bf16 a[148:151], v[96:99], v[72:75], a[148:151]
    buffer_load_dwordx4 v1, s[36:39], s100 offen offset:1024 sc1 lds
    v_mfma_f32_16x16x32_bf16 a[148:151], v[100:103], v[76:79], a[148:151]
    buffer_store_dwordx4 v[12:15], v31, s[56:59], s63 offen offset:1024 sc1
    v_mfma_f32_16x16x32_bf16 a[152:155], v[96:99], v[80:83], a[152:155]
    v_cvt_pk_bf16_f32 v51, v250, v251
    ds_read_b128 v[120:123], v2 offset:30720
    v_mfma_f32_16x16x32_bf16 a[152:155], v[100:103], v[84:87], a[152:155]
    ds_read_b128 v[124:127], v2 offset:31744
    v_add_u32 v2, s82, v1
    v_mfma_f32_16x16x32_bf16 a[156:159], v[96:99], v[88:91], a[156:159]
    v_exp_f32 v252, v252
    v_mfma_f32_16x16x32_bf16 a[156:159], v[100:103], v[92:95], a[156:159]
    v_exp_f32 v253, v253
    v_mfma_f32_16x16x32_bf16 v[12:15], v[20:23], v[216:219], 0
    v_exp_f32 v254, v254
    v_mfma_f32_16x16x32_bf16 v[16:19], v[24:27], v[216:219], 0
    v_exp_f32 v255, v255
    v_mfma_f32_16x16x32_bf16 v[244:247], a[224:227], v[140:143], v[156:159]
    buffer_load_dwordx4 v1, s[36:39], s100 offen offset:2048 sc1 lds
    v_mfma_f32_16x16x32_bf16 v[244:247], a[228:231], v[172:175], v[244:247]
    v_cvt_pk_bf16_f32 v58, v252, v253
    v_cvt_pk_bf16_f32 v59, v254, v255
    v_mfma_f32_16x16x32_bf16 v[244:247], a[232:235], v[204:207], v[244:247]
    v_cvt_pk_bf16_f32 v12, v12, v13
    v_cvt_pk_bf16_f32 v13, v14, v15
    v_mfma_f32_16x16x32_bf16 v[244:247], a[236:239], v[236:239], v[244:247]
    s_waitcnt lgkmcnt(0)
    v_cvt_pk_bf16_f32 v14, v16, v17
    v_cvt_pk_bf16_f32 v15, v18, v19
    v_mfma_f32_16x16x32_bf16 a[164:167], v[104:107], v[72:75], a[164:167]
    buffer_store_dwordx4 v[12:15], v31, s[56:59], s63 offen offset:512 sc1
    v_mfma_f32_16x16x32_bf16 a[164:167], v[108:111], v[76:79], a[164:167]
    v_exp_f32 v240, v240
    v_mfma_f32_16x16x32_bf16 a[168:171], v[104:107], v[80:83], a[168:171]
    v_exp_f32 v241, v241
    v_mfma_f32_16x16x32_bf16 a[168:171], v[108:111], v[84:87], a[168:171]
    v_exp_f32 v242, v242
    v_mfma_f32_16x16x32_bf16 a[172:175], v[104:107], v[88:91], a[172:175]
    v_exp_f32 v243, v243
    v_mfma_f32_16x16x32_bf16 a[172:175], v[108:111], v[92:95], a[172:175]
    buffer_load_dwordx4 v1, s[36:39], s100 offen offset:3072 sc1 lds
    v_mfma_f32_16x16x32_bf16 v[12:15], v[20:23], v[220:223], 0
    v_exp_f32 v244, v244
    v_mfma_f32_16x16x32_bf16 v[16:19], v[24:27], v[220:223], 0
    v_exp_f32 v245, v245
    v_mfma_f32_16x16x32_bf16 v[248:251], a[240:243], v[136:139], v[188:191]
    v_exp_f32 v246, v246
    v_mfma_f32_16x16x32_bf16 v[248:251], a[244:247], v[168:171], v[248:251]
    v_exp_f32 v247, v247
    v_mfma_f32_16x16x32_bf16 v[248:251], a[248:251], v[200:203], v[248:251]
    v_cvt_pk_bf16_f32 v12, v12, v13
    v_cvt_pk_bf16_f32 v13, v14, v15
    v_mfma_f32_16x16x32_bf16 v[248:251], a[252:255], v[232:235], v[248:251]
    v_cvt_pk_bf16_f32 v14, v16, v17
    v_cvt_pk_bf16_f32 v15, v18, v19
    v_mfma_f32_16x16x32_bf16 a[180:183], v[112:115], v[72:75], a[180:183]
    buffer_store_dwordx4 v[12:15], v31, s[56:59], s63 offen offset:1536 sc1
    v_mfma_f32_16x16x32_bf16 a[180:183], v[116:119], v[76:79], a[180:183]
    s_add_u32 s77, s77, 32768
    v_cvt_pk_bf16_f32 v52, v240, v241
    v_cvt_pk_bf16_f32 v53, v242, v243
    v_mfma_f32_16x16x32_bf16 a[184:187], v[112:115], v[80:83], a[184:187]
    v_exp_f32 v248, v248
    v_mfma_f32_16x16x32_bf16 a[184:187], v[116:119], v[84:87], a[184:187]
    v_exp_f32 v249, v249
    v_mfma_f32_16x16x32_bf16 a[188:191], v[112:115], v[88:91], a[188:191]
    v_exp_f32 v250, v250
    v_mfma_f32_16x16x32_bf16 a[188:191], v[116:119], v[92:95], a[188:191]
    v_exp_f32 v251, v251
    v_mfma_f32_16x16x32_bf16 v[12:15], v[144:147], v[216:219], 0
    v_cvt_pk_bf16_f32 v60, v244, v245
    v_cvt_pk_bf16_f32 v61, v246, v247
    v_mfma_f32_16x16x32_bf16 v[16:19], a[140:143], v[216:219], 0
    v_cvt_pk_bf16_f32 v54, v248, v249
    v_cvt_pk_bf16_f32 v55, v250, v251
    v_mfma_f32_16x16x32_bf16 v[252:255], a[240:243], v[140:143], v[156:159]
    v_accvgpr_read_b32 v6, a120
    v_accvgpr_read_b32 v7, a124
    v_mfma_f32_16x16x32_bf16 v[252:255], a[244:247], v[172:175], v[252:255]
    v_cvt_pk_bf16_f32 v12, v12, v13
    v_cvt_pk_bf16_f32 v13, v14, v15
    v_mfma_f32_16x16x32_bf16 v[252:255], a[248:251], v[204:207], v[252:255]
    v_cvt_pk_bf16_f32 v14, v16, v17
    v_cvt_pk_bf16_f32 v15, v18, v19
    v_mfma_f32_16x16x32_bf16 v[252:255], a[252:255], v[236:239], v[252:255]
    buffer_store_dwordx4 v[12:15], v1, s[56:59], s64 offen offset:0 sc1
    v_mfma_f32_16x16x32_bf16 a[196:199], v[120:123], v[72:75], a[196:199]
    v_cvt_pk_bf16_f32 v6, 0, v6
    v_cvt_pk_bf16_f32 v7, 0, v7
    v_mfma_f32_16x16x32_bf16 a[196:199], v[124:127], v[76:79], a[196:199]
    ds_bpermute_b32 v6, v8, v6
    ds_bpermute_b32 v7, v8, v7
    s_waitcnt vmcnt(8) lgkmcnt(0)
    s_barrier
    v_mfma_f32_16x16x32_bf16 a[200:203], v[120:123], v[80:83], a[200:203]
    ds_read_b128 a[224:227], v2 offset:0
    ds_read_b128 a[228:231], v2 offset:1024
    v_mfma_f32_16x16x32_bf16 a[200:203], v[124:127], v[84:87], a[200:203]
    ds_read_b128 a[232:235], v2 offset:2048
    v_mul_f32 v6, s98, v6
    v_mfma_f32_16x16x32_bf16 a[204:207], v[120:123], v[88:91], a[204:207]
    ds_read_b128 a[236:239], v2 offset:3072
    v_mul_f32 v7, s98, v7
    v_mfma_f32_16x16x32_bf16 a[204:207], v[124:127], v[92:95], a[204:207]
    ds_read_b128 v[96:99], v2 offset:16384
    v_mfma_f32_16x16x32_bf16 v[12:15], v[144:147], v[220:223], 0
    ds_read_b128 v[100:103], v2 offset:17408
    v_mfma_f32_16x16x32_bf16 v[16:19], a[140:143], v[220:223], 0
    v_exp_f32 v252, v252
    v_smfmac_f32_16x16x64_bf16 a[212:215], a[136:139], v[72:79], v215
    v_exp_f32 v6, v6
    v_smfmac_f32_16x16x64_bf16 a[216:219], a[136:139], v[80:87], v215
    v_exp_f32 v7, v7
    v_smfmac_f32_16x16x64_bf16 a[220:223], a[136:139], v[88:95], v215
    v_cvt_pk_bf16_f32 v12, v12, v13
    v_cvt_pk_bf16_f32 v13, v14, v15
    v_add_f32 v6, 1.0, v6
    v_add_f32 v7, 1.0, v7
    v_cvt_pk_bf16_f32 v14, v16, v17
    v_cvt_pk_bf16_f32 v15, v18, v19
    v_rcp_f32 v6, v6
    v_rcp_f32 v7, v7
    buffer_store_dwordx4 v[12:15], v1, s[56:59], s62 offen offset:0 sc1
    s_nop 1
    v_accvgpr_read_b32 v9, a208
    v_accvgpr_read_b32 v10, a209
    v_add_f32 v9, v9, v10
    v_cmp_nge_f32 vcc, 0x71800000, v9
    v_rcp_f32 v10, v9
    s_nop 0
    s_or_b64 s[84:85], s[84:85], vcc
    v_mul_f32 v10, v10, v4
    v_accvgpr_read_b32 v12, a0
    v_accvgpr_read_b32 v13, a1
    v_accvgpr_read_b32 v14, a2
    v_accvgpr_read_b32 v15, a3
    v_accvgpr_read_b32 v16, a16
    v_accvgpr_read_b32 v17, a17
    v_accvgpr_read_b32 v18, a18
    v_accvgpr_read_b32 v19, a19
    v_pk_mul_f32 v[12:13], v[12:13], v[10:11] op_sel_hi:[1,0]
    v_pk_mul_f32 v[14:15], v[14:15], v[10:11] op_sel_hi:[1,0]
    v_pk_mul_f32 v[16:17], v[16:17], v[10:11] op_sel_hi:[1,0]
    v_pk_mul_f32 v[18:19], v[18:19], v[10:11] op_sel_hi:[1,0]
    v_cvt_pk_bf16_f32 v12, v12, v13
    v_cvt_pk_bf16_f32 v13, v14, v15
    v_cvt_pk_bf16_f32 v14, v16, v17
    v_cvt_pk_bf16_f32 v15, v18, v19
    buffer_store_dwordx4 v[12:15], v1, s[40:43], s80 offen offset:0 sc1
    v_accvgpr_read_b32 v20, a32
    v_accvgpr_read_b32 v21, a33
    v_accvgpr_read_b32 v22, a34
    v_accvgpr_read_b32 v23, a35
    v_accvgpr_read_b32 v24, a48
    v_accvgpr_read_b32 v25, a49
    v_accvgpr_read_b32 v26, a50
    v_accvgpr_read_b32 v27, a51
    v_pk_mul_f32 v[20:21], v[20:21], v[10:11] op_sel_hi:[1,0]
    v_pk_mul_f32 v[22:23], v[22:23], v[10:11] op_sel_hi:[1,0]
    v_pk_mul_f32 v[24:25], v[24:25], v[10:11] op_sel_hi:[1,0]
    v_pk_mul_f32 v[26:27], v[26:27], v[10:11] op_sel_hi:[1,0]
    v_cvt_pk_bf16_f32 v20, v20, v21
    v_cvt_pk_bf16_f32 v21, v22, v23
    v_cvt_pk_bf16_f32 v22, v24, v25
    v_cvt_pk_bf16_f32 v23, v26, v27
    buffer_store_dwordx4 v[20:23], v1, s[40:43], s80 offen offset:1024 sc1
    v_accvgpr_read_b32 v12, a144
    v_accvgpr_read_b32 v13, a145
    v_accvgpr_read_b32 v14, a146
    v_accvgpr_read_b32 v15, a147
    v_accvgpr_read_b32 v16, a160
    v_accvgpr_read_b32 v17, a161
    v_accvgpr_read_b32 v18, a162
    v_accvgpr_read_b32 v19, a163
    v_pk_mul_f32 v[12:13], v[12:13], v[10:11] op_sel_hi:[1,0]
    v_pk_mul_f32 v[14:15], v[14:15], v[10:11] op_sel_hi:[1,0]
    v_pk_mul_f32 v[16:17], v[16:17], v[10:11] op_sel_hi:[1,0]
    v_pk_mul_f32 v[18:19], v[18:19], v[10:11] op_sel_hi:[1,0]
    v_cvt_pk_bf16_f32 v12, v12, v13
    v_cvt_pk_bf16_f32 v13, v14, v15
    v_cvt_pk_bf16_f32 v14, v16, v17
    v_cvt_pk_bf16_f32 v15, v18, v19
    buffer_store_dwordx4 v[12:15], v1, s[40:43], s80 offen offset:2048 sc1
    v_accvgpr_read_b32 v20, a176
    v_accvgpr_read_b32 v21, a177
    v_accvgpr_read_b32 v22, a178
    v_accvgpr_read_b32 v23, a179
    v_accvgpr_read_b32 v24, a192
    v_accvgpr_read_b32 v25, a193
    v_accvgpr_read_b32 v26, a194
    v_accvgpr_read_b32 v27, a195
    v_pk_mul_f32 v[20:21], v[20:21], v[10:11] op_sel_hi:[1,0]
    v_pk_mul_f32 v[22:23], v[22:23], v[10:11] op_sel_hi:[1,0]
    v_pk_mul_f32 v[24:25], v[24:25], v[10:11] op_sel_hi:[1,0]
    v_pk_mul_f32 v[26:27], v[26:27], v[10:11] op_sel_hi:[1,0]
    v_cvt_pk_bf16_f32 v20, v20, v21
    v_cvt_pk_bf16_f32 v21, v22, v23
    v_cvt_pk_bf16_f32 v22, v24, v25
    v_cvt_pk_bf16_f32 v23, v26, v27
    buffer_store_dwordx4 v[20:23], v1, s[40:43], s80 offen offset:3072 sc1
    v_accvgpr_read_b32 v9, a212
    v_accvgpr_read_b32 v10, a213
    v_add_f32 v9, v9, v10
    v_cmp_nge_f32 vcc, 0x71800000, v9
    v_rcp_f32 v10, v9
    s_nop 0
    s_or_b64 s[84:85], s[84:85], vcc
    v_mul_f32 v10, v10, v5
    s_add_u32 s72, s80, 622592
    v_accvgpr_read_b32 v12, a4
    v_accvgpr_read_b32 v13, a5
    v_accvgpr_read_b32 v14, a6
    v_accvgpr_read_b32 v15, a7
    v_accvgpr_read_b32 v16, a20
    v_accvgpr_read_b32 v17, a21
    v_accvgpr_read_b32 v18, a22
    v_accvgpr_read_b32 v19, a23
    v_pk_mul_f32 v[12:13], v[12:13], v[10:11] op_sel_hi:[1,0]
    v_pk_mul_f32 v[14:15], v[14:15], v[10:11] op_sel_hi:[1,0]
    v_pk_mul_f32 v[16:17], v[16:17], v[10:11] op_sel_hi:[1,0]
    v_pk_mul_f32 v[18:19], v[18:19], v[10:11] op_sel_hi:[1,0]
    v_cvt_pk_bf16_f32 v12, v12, v13
    v_cvt_pk_bf16_f32 v13, v14, v15
    v_cvt_pk_bf16_f32 v14, v16, v17
    v_cvt_pk_bf16_f32 v15, v18, v19
    buffer_store_dwordx4 v[12:15], v1, s[40:43], s72 offen offset:0 sc1
    v_accvgpr_read_b32 v20, a36
    v_accvgpr_read_b32 v21, a37
    v_accvgpr_read_b32 v22, a38
    v_accvgpr_read_b32 v23, a39
    v_accvgpr_read_b32 v24, a52
    v_accvgpr_read_b32 v25, a53
    v_accvgpr_read_b32 v26, a54
    v_accvgpr_read_b32 v27, a55
    v_pk_mul_f32 v[20:21], v[20:21], v[10:11] op_sel_hi:[1,0]
    v_pk_mul_f32 v[22:23], v[22:23], v[10:11] op_sel_hi:[1,0]
    v_pk_mul_f32 v[24:25], v[24:25], v[10:11] op_sel_hi:[1,0]
    v_pk_mul_f32 v[26:27], v[26:27], v[10:11] op_sel_hi:[1,0]
    v_cvt_pk_bf16_f32 v20, v20, v21
    v_cvt_pk_bf16_f32 v21, v22, v23
    v_cvt_pk_bf16_f32 v22, v24, v25
    v_cvt_pk_bf16_f32 v23, v26, v27
    buffer_store_dwordx4 v[20:23], v1, s[40:43], s72 offen offset:1024 sc1
    v_accvgpr_read_b32 v12, a148
    v_accvgpr_read_b32 v13, a149
    v_accvgpr_read_b32 v14, a150
    v_accvgpr_read_b32 v15, a151
    v_accvgpr_read_b32 v16, a164
    v_accvgpr_read_b32 v17, a165
    v_accvgpr_read_b32 v18, a166
    v_accvgpr_read_b32 v19, a167
    v_pk_mul_f32 v[12:13], v[12:13], v[10:11] op_sel_hi:[1,0]
    v_pk_mul_f32 v[14:15], v[14:15], v[10:11] op_sel_hi:[1,0]
    v_pk_mul_f32 v[16:17], v[16:17], v[10:11] op_sel_hi:[1,0]
    v_pk_mul_f32 v[18:19], v[18:19], v[10:11] op_sel_hi:[1,0]
    v_cvt_pk_bf16_f32 v12, v12, v13
    v_cvt_pk_bf16_f32 v13, v14, v15
    v_cvt_pk_bf16_f32 v14, v16, v17
    v_cvt_pk_bf16_f32 v15, v18, v19
    buffer_store_dwordx4 v[12:15], v1, s[40:43], s72 offen offset:2048 sc1
    v_accvgpr_read_b32 v20, a180
    v_accvgpr_read_b32 v21, a181
    v_accvgpr_read_b32 v22, a182
    v_accvgpr_read_b32 v23, a183
    v_accvgpr_read_b32 v24, a196
    v_accvgpr_read_b32 v25, a197
    v_accvgpr_read_b32 v26, a198
    v_accvgpr_read_b32 v27, a199
    v_pk_mul_f32 v[20:21], v[20:21], v[10:11] op_sel_hi:[1,0]
    v_pk_mul_f32 v[22:23], v[22:23], v[10:11] op_sel_hi:[1,0]
    v_pk_mul_f32 v[24:25], v[24:25], v[10:11] op_sel_hi:[1,0]
    v_pk_mul_f32 v[26:27], v[26:27], v[10:11] op_sel_hi:[1,0]
    v_cvt_pk_bf16_f32 v20, v20, v21
    v_cvt_pk_bf16_f32 v21, v22, v23
    v_cvt_pk_bf16_f32 v22, v24, v25
    v_cvt_pk_bf16_f32 v23, v26, v27
    buffer_store_dwordx4 v[20:23], v1, s[40:43], s72 offen offset:3072 sc1
    v_mov_b32 v9, 1
    v_lshlrev_b32 v216, 20, v1
    s_lshl2_add_u32 s7, s4, s101
    s_add_u32 s7, s7, 163840
    s_waitcnt vmcnt(8)
    buffer_store_dword v9, v216, s[32:35], s7 offen sc1
    s_sub_u32 s78, 14, s6
    s_sub_u32 s78, s78, s6
    s_cmp_eq_u32 s78, 0
    s_cbranch_scc1 K1_LS_END
.p2align 3
K1_LS:
    s_waitcnt lgkmcnt(0)
    v_mfma_f32_16x16x32_bf16 v[240:243], a[224:227], v[136:139], v[176:179]
    s_mov_b32 s99, s76
    ds_read_b128 v[104:107], v2 offset:18432
    ds_read_b128 v[108:111], v2 offset:19456
    v_mfma_f32_16x16x32_bf16 v[240:243], a[228:231], v[168:171], v[240:243]
    v_exp_f32 v253, v253
    v_mfma_f32_16x16x32_bf16 v[240:243], a[232:235], v[200:203], v[240:243]
    v_exp_f32 v254, v254
    v_mfma_f32_16x16x32_bf16 v[240:243], a[236:239], v[232:235], v[240:243]
    v_exp_f32 v255, v255
    v_mfma_f32_16x16x32_bf16 a[8:11], v[96:99], v[48:51], a[8:11]
    s_add_u32 m0, s76, s75
    v_cvt_pk_bf16_f32 v62, v252, v253
    v_cvt_pk_bf16_f32 v63, v254, v255
    v_mfma_f32_16x16x32_bf16 a[8:11], v[100:103], v[52:55], a[8:11]
    s_mov_b32 s76, s60
    ds_read_b128 a[240:243], v2 offset:4096
    ds_read_b128 a[244:247], v2 offset:5120
    v_mfma_f32_16x16x32_bf16 a[12:15], v[96:99], v[56:59], a[12:15]
    s_mov_b32 s60, s82
    buffer_load_dwordx4 v1, s[36:39], s77 offen sc1 lds
    v_mfma_f32_16x16x32_bf16 a[12:15], v[100:103], v[60:63], a[12:15]
    s_mov_b32 s82, s95
    ds_read_b128 a[248:251], v2 offset:6144
    ds_read_b128 a[252:255], v2 offset:7168
    v_mfma_f32_16x16x32_bf16 v[244:247], a[224:227], v[140:143], v[156:159]
    s_mov_b32 s95, s93
    v_exp_f32 v240, v240
    v_mfma_f32_16x16x32_bf16 v[244:247], a[228:231], v[172:175], v[244:247]
    s_mov_b32 s93, s99
    ds_read_b128 v[112:115], v2 offset:20480
    ds_read_b128 v[116:119], v2 offset:21504
    v_mfma_f32_16x16x32_bf16 v[244:247], a[232:235], v[204:207], v[244:247]
    buffer_load_dwordx4 v1, s[36:39], s77 offen offset:1024 sc1 lds
    v_mfma_f32_16x16x32_bf16 v[244:247], a[236:239], v[236:239], v[244:247]
    s_waitcnt lgkmcnt(6)
    v_exp_f32 v241, v241
    v_mfma_f32_16x16x32_bf16 a[24:27], v[104:107], v[48:51], a[24:27]
    v_exp_f32 v242, v242
    v_mfma_f32_16x16x32_bf16 a[24:27], v[108:111], v[52:55], a[24:27]
    v_exp_f32 v243, v243
    v_mfma_f32_16x16x32_bf16 a[28:31], v[104:107], v[56:59], a[28:31]
    buffer_load_dwordx4 v1, s[36:39], s77 offen offset:2048 sc1 lds
    v_mfma_f32_16x16x32_bf16 a[28:31], v[108:111], v[60:63], a[28:31]
    s_waitcnt lgkmcnt(2)
    ds_read_b128 v[120:123], v2 offset:22528
    ds_read_b128 v[124:127], v2 offset:23552
    v_mfma_f32_16x16x32_bf16 v[248:251], a[240:243], v[136:139], v[180:183]
    v_cvt_pk_bf16_f32 v80, v240, v241
    v_cvt_pk_bf16_f32 v81, v242, v243
    v_mfma_f32_16x16x32_bf16 v[248:251], a[244:247], v[168:171], v[248:251]
    v_exp_f32 v244, v244
    v_mfma_f32_16x16x32_bf16 v[248:251], a[248:251], v[200:203], v[248:251]
    buffer_load_dwordx4 v1, s[36:39], s77 offen offset:3072 sc1 lds
    v_mfma_f32_16x16x32_bf16 v[248:251], a[252:255], v[232:235], v[248:251]
    s_waitcnt lgkmcnt(2)
    ds_read_b128 a[224:227], v2 offset:8192
    ds_read_b128 a[228:231], v2 offset:9216
    v_mfma_f32_16x16x32_bf16 a[40:43], v[112:115], v[48:51], a[40:43]
    v_exp_f32 v245, v245
    v_mfma_f32_16x16x32_bf16 a[40:43], v[116:119], v[52:55], a[40:43]
    ds_read_b128 a[232:235], v2 offset:10240
    ds_read_b128 a[236:239], v2 offset:11264
    v_mfma_f32_16x16x32_bf16 a[44:47], v[112:115], v[56:59], a[44:47]
    s_add_u32 s100, s77, 4096
    ds_read_b128 v[96:99], v2 offset:24576
    v_cvt_pk_bf16_f32 v88, v244, v245
    v_mfma_f32_16x16x32_bf16 a[44:47], v[116:119], v[60:63], a[44:47]
    s_add_u32 m0, m0, 4096
    v_exp_f32 v246, v246
    v_mfma_f32_16x16x32_bf16 v[252:255], a[240:243], v[140:143], v[156:159]
    buffer_load_dwordx4 v1, s[36:39], s100 offen sc1 lds
    v_mfma_f32_16x16x32_bf16 v[252:255], a[244:247], v[172:175], v[252:255]
    v_exp_f32 v247, v247
    v_mfma_f32_16x16x32_bf16 v[252:255], a[248:251], v[204:207], v[252:255]
    ds_read_b128 v[100:103], v2 offset:25600
    v_cvt_pk_bf16_f32 v89, v246, v247
    v_mfma_f32_16x16x32_bf16 v[252:255], a[252:255], v[236:239], v[252:255]
    s_waitcnt lgkmcnt(4)
    buffer_load_dwordx4 v1, s[36:39], s100 offen offset:1024 sc1 lds
    v_mfma_f32_16x16x32_bf16 a[56:59], v[120:123], v[48:51], a[56:59]
    v_exp_f32 v248, v248
    v_mfma_f32_16x16x32_bf16 a[56:59], v[124:127], v[52:55], a[56:59]
    v_exp_f32 v249, v249
    v_mfma_f32_16x16x32_bf16 a[60:63], v[120:123], v[56:59], a[60:63]
    ds_read_b128 v[104:107], v2 offset:26624
    ds_read_b128 v[108:111], v2 offset:27648
    v_mfma_f32_16x16x32_bf16 a[60:63], v[124:127], v[60:63], a[60:63]
    v_exp_f32 v250, v250
    v_mfma_f32_16x16x32_bf16 v[240:243], a[224:227], v[136:139], v[184:187]
    buffer_load_dwordx4 v1, s[36:39], s100 offen offset:2048 sc1 lds
    v_mfma_f32_16x16x32_bf16 v[240:243], a[228:231], v[168:171], v[240:243]
    s_waitcnt lgkmcnt(2)
    v_exp_f32 v251, v251
    v_mfma_f32_16x16x32_bf16 v[240:243], a[232:235], v[200:203], v[240:243]
    ds_read_b128 a[240:243], v2 offset:12288
    ds_read_b128 a[244:247], v2 offset:13312
    v_mfma_f32_16x16x32_bf16 v[240:243], a[236:239], v[232:235], v[240:243]
    ds_read_b128 a[248:251], v2 offset:14336
    v_cvt_pk_bf16_f32 v82, v248, v249
    v_mfma_f32_16x16x32_bf16 a[152:155], v[96:99], v[48:51], a[152:155]
    buffer_load_dwordx4 v1, s[36:39], s100 offen offset:3072 sc1 lds
    v_mfma_f32_16x16x32_bf16 a[152:155], v[100:103], v[52:55], a[152:155]
    ds_read_b128 a[252:255], v2 offset:15360
    v_cvt_pk_bf16_f32 v83, v250, v251
    v_mfma_f32_16x16x32_bf16 a[156:159], v[96:99], v[56:59], a[156:159]
    ds_read_b128 v[112:115], v2 offset:28672
    ds_read_b128 v[116:119], v2 offset:29696
    v_mfma_f32_16x16x32_bf16 a[156:159], v[100:103], v[60:63], a[156:159]
    v_exp_f32 v252, v252
    v_mfma_f32_16x16x32_bf16 v[244:247], a[224:227], v[140:143], v[156:159]
    s_add_u32 s77, s77, 32768
    v_exp_f32 v253, v253
    v_mfma_f32_16x16x32_bf16 v[244:247], a[228:231], v[172:175], v[244:247]
    v_exp_f32 v254, v254
    v_mfma_f32_16x16x32_bf16 v[244:247], a[232:235], v[204:207], v[244:247]
    v_exp_f32 v255, v255
    v_mfma_f32_16x16x32_bf16 v[244:247], a[236:239], v[236:239], v[244:247]
    s_waitcnt lgkmcnt(3)
    v_cvt_pk_bf16_f32 v90, v252, v253
    v_cvt_pk_bf16_f32 v91, v254, v255
    v_mfma_f32_16x16x32_bf16 a[168:171], v[104:107], v[48:51], a[168:171]
    v_exp_f32 v240, v240
    v_mfma_f32_16x16x32_bf16 a[168:171], v[108:111], v[52:55], a[168:171]
    v_exp_f32 v241, v241
    v_mfma_f32_16x16x32_bf16 a[172:175], v[104:107], v[56:59], a[172:175]
    ds_read_b128 v[120:123], v2 offset:30720
    ds_read_b128 v[124:127], v2 offset:31744
    v_mfma_f32_16x16x32_bf16 a[172:175], v[108:111], v[60:63], a[172:175]
    v_add_u32 v2, s82, v1
    v_cvt_pk_bf16_f32 v84, v240, v241
    v_mfma_f32_16x16x32_bf16 v[248:251], a[240:243], v[136:139], v[188:191]
    v_exp_f32 v242, v242
    v_mfma_f32_16x16x32_bf16 v[248:251], a[244:247], v[168:171], v[248:251]
    v_exp_f32 v243, v243
    v_mfma_f32_16x16x32_bf16 v[248:251], a[248:251], v[200:203], v[248:251]
    s_waitcnt lgkmcnt(2)
    v_exp_f32 v244, v244
    v_mfma_f32_16x16x32_bf16 v[248:251], a[252:255], v[232:235], v[248:251]
    v_exp_f32 v245, v245
    v_mfma_f32_16x16x32_bf16 a[184:187], v[112:115], v[48:51], a[184:187]
    ds_read_b128 a[224:227], v2 offset:0
    ds_read_b128 a[228:231], v2 offset:1024
    v_mfma_f32_16x16x32_bf16 a[184:187], v[116:119], v[52:55], a[184:187]
    ds_read_b128 a[232:235], v2 offset:2048
    v_cvt_pk_bf16_f32 v85, v242, v243
    v_mfma_f32_16x16x32_bf16 a[188:191], v[112:115], v[56:59], a[188:191]
    ds_read_b128 a[236:239], v2 offset:3072
    v_cvt_pk_bf16_f32 v92, v244, v245
    v_mfma_f32_16x16x32_bf16 a[188:191], v[116:119], v[60:63], a[188:191]
    v_exp_f32 v246, v246
    v_mfma_f32_16x16x32_bf16 v[252:255], a[240:243], v[140:143], v[156:159]
    ds_read_b128 v[96:99], v2 offset:16384
    ds_read_b128 v[100:103], v2 offset:17408
    v_mfma_f32_16x16x32_bf16 v[252:255], a[244:247], v[172:175], v[252:255]
    v_exp_f32 v247, v247
    v_mfma_f32_16x16x32_bf16 v[252:255], a[248:251], v[204:207], v[252:255]
    v_exp_f32 v248, v248
    v_mfma_f32_16x16x32_bf16 v[252:255], a[252:255], v[236:239], v[252:255]
    s_waitcnt lgkmcnt(4)
    v_exp_f32 v249, v249
    v_mfma_f32_16x16x32_bf16 a[200:203], v[120:123], v[48:51], a[200:203]
    v_exp_f32 v250, v250
    v_mfma_f32_16x16x32_bf16 a[200:203], v[124:127], v[52:55], a[200:203]
    v_exp_f32 v251, v251
    v_mfma_f32_16x16x32_bf16 a[204:207], v[120:123], v[56:59], a[204:207]
    v_cvt_pk_bf16_f32 v93, v246, v247
    v_cvt_pk_bf16_f32 v86, v248, v249
    v_mfma_f32_16x16x32_bf16 a[204:207], v[124:127], v[60:63], a[204:207]
    v_exp_f32 v252, v252
    v_smfmac_f32_16x16x64_bf16 a[216:219], a[136:139], v[48:55], v215
    s_cmp_le_u32 s78, 2
    v_cvt_pk_bf16_f32 v87, v250, v251
    v_smfmac_f32_16x16x64_bf16 a[220:223], a[136:139], v[56:63], v215
    s_cbranch_scc1 K1_LS_MASK
K1_LS_BACK:
    s_waitcnt lgkmcnt(0)
    v_mfma_f32_16x16x32_bf16 v[240:243], a[224:227], v[136:139], v[176:179]
    s_mov_b32 s99, s76
    ds_read_b128 v[104:107], v2 offset:18432
    ds_read_b128 v[108:111], v2 offset:19456
    v_mfma_f32_16x16x32_bf16 v[240:243], a[228:231], v[168:171], v[240:243]
    v_exp_f32 v253, v253
    v_mfma_f32_16x16x32_bf16 v[240:243], a[232:235], v[200:203], v[240:243]
    v_exp_f32 v254, v254
    v_mfma_f32_16x16x32_bf16 v[240:243], a[236:239], v[232:235], v[240:243]
    v_exp_f32 v255, v255
    v_mfma_f32_16x16x32_bf16 a[8:11], v[96:99], v[80:83], a[8:11]
    s_add_u32 m0, s76, s75
    v_cvt_pk_bf16_f32 v94, v252, v253
    v_cvt_pk_bf16_f32 v95, v254, v255
    v_mfma_f32_16x16x32_bf16 a[8:11], v[100:103], v[84:87], a[8:11]
    s_mov_b32 s76, s60
    ds_read_b128 a[240:243], v2 offset:4096
    ds_read_b128 a[244:247], v2 offset:5120
    v_mfma_f32_16x16x32_bf16 a[12:15], v[96:99], v[88:91], a[12:15]
    s_mov_b32 s60, s82
    buffer_load_dwordx4 v1, s[36:39], s77 offen sc1 lds
    v_mfma_f32_16x16x32_bf16 a[12:15], v[100:103], v[92:95], a[12:15]
    s_mov_b32 s82, s95
    ds_read_b128 a[248:251], v2 offset:6144
    ds_read_b128 a[252:255], v2 offset:7168
    v_mfma_f32_16x16x32_bf16 v[244:247], a[224:227], v[140:143], v[156:159]
    s_mov_b32 s95, s93
    v_exp_f32 v240, v240
    v_mfma_f32_16x16x32_bf16 v[244:247], a[228:231], v[172:175], v[244:247]
    s_mov_b32 s93, s99
    ds_read_b128 v[112:115], v2 offset:20480
    ds_read_b128 v[116:119], v2 offset:21504
    v_mfma_f32_16x16x32_bf16 v[244:247], a[232:235], v[204:207], v[244:247]
    buffer_load_dwordx4 v1, s[36:39], s77 offen offset:1024 sc1 lds
    v_mfma_f32_16x16x32_bf16 v[244:247], a[236:239], v[236:239], v[244:247]
    s_waitcnt lgkmcnt(6)
    v_exp_f32 v241, v241
    v_mfma_f32_16x16x32_bf16 a[24:27], v[104:107], v[80:83], a[24:27]
    v_exp_f32 v242, v242
    v_mfma_f32_16x16x32_bf16 a[24:27], v[108:111], v[84:87], a[24:27]
    v_exp_f32 v243, v243
    v_mfma_f32_16x16x32_bf16 a[28:31], v[104:107], v[88:91], a[28:31]
    buffer_load_dwordx4 v1, s[36:39], s77 offen offset:2048 sc1 lds
    v_mfma_f32_16x16x32_bf16 a[28:31], v[108:111], v[92:95], a[28:31]
    s_waitcnt lgkmcnt(2)
    ds_read_b128 v[120:123], v2 offset:22528
    ds_read_b128 v[124:127], v2 offset:23552
    v_mfma_f32_16x16x32_bf16 v[248:251], a[240:243], v[136:139], v[180:183]
    v_cvt_pk_bf16_f32 v48, v240, v241
    v_cvt_pk_bf16_f32 v49, v242, v243
    v_mfma_f32_16x16x32_bf16 v[248:251], a[244:247], v[168:171], v[248:251]
    v_exp_f32 v244, v244
    v_mfma_f32_16x16x32_bf16 v[248:251], a[248:251], v[200:203], v[248:251]
    buffer_load_dwordx4 v1, s[36:39], s77 offen offset:3072 sc1 lds
    v_mfma_f32_16x16x32_bf16 v[248:251], a[252:255], v[232:235], v[248:251]
    s_waitcnt lgkmcnt(2)
    ds_read_b128 a[224:227], v2 offset:8192
    ds_read_b128 a[228:231], v2 offset:9216
    v_mfma_f32_16x16x32_bf16 a[40:43], v[112:115], v[80:83], a[40:43]
    v_exp_f32 v245, v245
    v_mfma_f32_16x16x32_bf16 a[40:43], v[116:119], v[84:87], a[40:43]
    ds_read_b128 a[232:235], v2 offset:10240
    ds_read_b128 a[236:239], v2 offset:11264
    v_mfma_f32_16x16x32_bf16 a[44:47], v[112:115], v[88:91], a[44:47]
    s_add_u32 s100, s77, 4096
    ds_read_b128 v[96:99], v2 offset:24576
    v_cvt_pk_bf16_f32 v56, v244, v245
    v_mfma_f32_16x16x32_bf16 a[44:47], v[116:119], v[92:95], a[44:47]
    s_add_u32 m0, m0, 4096
    v_exp_f32 v246, v246
    v_mfma_f32_16x16x32_bf16 v[252:255], a[240:243], v[140:143], v[156:159]
    buffer_load_dwordx4 v1, s[36:39], s100 offen sc1 lds
    v_mfma_f32_16x16x32_bf16 v[252:255], a[244:247], v[172:175], v[252:255]
    v_exp_f32 v247, v247
    v_mfma_f32_16x16x32_bf16 v[252:255], a[248:251], v[204:207], v[252:255]
    ds_read_b128 v[100:103], v2 offset:25600
    v_cvt_pk_bf16_f32 v57, v246, v247
    v_mfma_f32_16x16x32_bf16 v[252:255], a[252:255], v[236:239], v[252:255]
    s_waitcnt lgkmcnt(4)
    buffer_load_dwordx4 v1, s[36:39], s100 offen offset:1024 sc1 lds
    v_mfma_f32_16x16x32_bf16 a[56:59], v[120:123], v[80:83], a[56:59]
    v_exp_f32 v248, v248
    v_mfma_f32_16x16x32_bf16 a[56:59], v[124:127], v[84:87], a[56:59]
    v_exp_f32 v249, v249
    v_mfma_f32_16x16x32_bf16 a[60:63], v[120:123], v[88:91], a[60:63]
    ds_read_b128 v[104:107], v2 offset:26624
    ds_read_b128 v[108:111], v2 offset:27648
    v_mfma_f32_16x16x32_bf16 a[60:63], v[124:127], v[92:95], a[60:63]
    v_exp_f32 v250, v250
    v_mfma_f32_16x16x32_bf16 v[240:243], a[224:227], v[136:139], v[184:187]
    buffer_load_dwordx4 v1, s[36:39], s100 offen offset:2048 sc1 lds
    v_mfma_f32_16x16x32_bf16 v[240:243], a[228:231], v[168:171], v[240:243]
    s_waitcnt lgkmcnt(2)
    v_exp_f32 v251, v251
    v_mfma_f32_16x16x32_bf16 v[240:243], a[232:235], v[200:203], v[240:243]
    ds_read_b128 a[240:243], v2 offset:12288
    ds_read_b128 a[244:247], v2 offset:13312
    v_mfma_f32_16x16x32_bf16 v[240:243], a[236:239], v[232:235], v[240:243]
    ds_read_b128 a[248:251], v2 offset:14336
    v_cvt_pk_bf16_f32 v50, v248, v249
    v_mfma_f32_16x16x32_bf16 a[152:155], v[96:99], v[80:83], a[152:155]
    buffer_load_dwordx4 v1, s[36:39], s100 offen offset:3072 sc1 lds
    v_mfma_f32_16x16x32_bf16 a[152:155], v[100:103], v[84:87], a[152:155]
    ds_read_b128 a[252:255], v2 offset:15360
    v_cvt_pk_bf16_f32 v51, v250, v251
    v_mfma_f32_16x16x32_bf16 a[156:159], v[96:99], v[88:91], a[156:159]
    ds_read_b128 v[112:115], v2 offset:28672
    ds_read_b128 v[116:119], v2 offset:29696
    v_mfma_f32_16x16x32_bf16 a[156:159], v[100:103], v[92:95], a[156:159]
    v_exp_f32 v252, v252
    v_mfma_f32_16x16x32_bf16 v[244:247], a[224:227], v[140:143], v[156:159]
    s_add_u32 s77, s77, 32768
    v_exp_f32 v253, v253
    v_mfma_f32_16x16x32_bf16 v[244:247], a[228:231], v[172:175], v[244:247]
    ds_read_b128 v[120:123], v2 offset:30720
    ds_read_b128 v[124:127], v2 offset:31744
    v_mfma_f32_16x16x32_bf16 v[244:247], a[232:235], v[204:207], v[244:247]
    v_add_u32 v2, s82, v1
    v_cvt_pk_bf16_f32 v58, v252, v253
    v_mfma_f32_16x16x32_bf16 v[244:247], a[236:239], v[236:239], v[244:247]
    s_waitcnt lgkmcnt(5)
    v_exp_f32 v254, v254
    v_mfma_f32_16x16x32_bf16 a[168:171], v[104:107], v[80:83], a[168:171]
    v_exp_f32 v255, v255
    v_mfma_f32_16x16x32_bf16 a[168:171], v[108:111], v[84:87], a[168:171]
    v_exp_f32 v240, v240
    v_mfma_f32_16x16x32_bf16 a[172:175], v[104:107], v[88:91], a[172:175]
    v_exp_f32 v241, v241
    v_mfma_f32_16x16x32_bf16 a[172:175], v[108:111], v[92:95], a[172:175]
    v_cvt_pk_bf16_f32 v59, v254, v255
    v_cvt_pk_bf16_f32 v52, v240, v241
    v_mfma_f32_16x16x32_bf16 v[248:251], a[240:243], v[136:139], v[188:191]
    v_exp_f32 v242, v242
    v_mfma_f32_16x16x32_bf16 v[248:251], a[244:247], v[168:171], v[248:251]
    v_exp_f32 v243, v243
    v_mfma_f32_16x16x32_bf16 v[248:251], a[248:251], v[200:203], v[248:251]
    s_waitcnt lgkmcnt(0)
    v_exp_f32 v244, v244
    v_mfma_f32_16x16x32_bf16 v[248:251], a[252:255], v[232:235], v[248:251]
    v_exp_f32 v245, v245
    v_mfma_f32_16x16x32_bf16 a[184:187], v[112:115], v[80:83], a[184:187]
    s_waitcnt vmcnt(8) lgkmcnt(0)
    v_exp_f32 v246, v246
    v_mfma_f32_16x16x32_bf16 a[184:187], v[116:119], v[84:87], a[184:187]
    s_barrier
    ds_read_b128 a[224:227], v2 offset:0
    ds_read_b128 a[228:231], v2 offset:1024
    v_mfma_f32_16x16x32_bf16 a[188:191], v[112:115], v[88:91], a[188:191]
    ds_read_b128 a[232:235], v2 offset:2048
    v_cvt_pk_bf16_f32 v53, v242, v243
    v_mfma_f32_16x16x32_bf16 a[188:191], v[116:119], v[92:95], a[188:191]
    ds_read_b128 a[236:239], v2 offset:3072
    v_cvt_pk_bf16_f32 v60, v244, v245
    v_mfma_f32_16x16x32_bf16 v[252:255], a[240:243], v[140:143], v[156:159]
    v_exp_f32 v247, v247
    v_mfma_f32_16x16x32_bf16 v[252:255], a[244:247], v[172:175], v[252:255]
    ds_read_b128 v[96:99], v2 offset:16384
    ds_read_b128 v[100:103], v2 offset:17408
    v_mfma_f32_16x16x32_bf16 v[252:255], a[248:251], v[204:207], v[252:255]
    v_exp_f32 v248, v248
    v_mfma_f32_16x16x32_bf16 v[252:255], a[252:255], v[236:239], v[252:255]
    v_exp_f32 v249, v249
    v_mfma_f32_16x16x32_bf16 a[200:203], v[120:123], v[80:83], a[200:203]
    v_exp_f32 v250, v250
    v_mfma_f32_16x16x32_bf16 a[200:203], v[124:127], v[84:87], a[200:203]
    v_exp_f32 v251, v251
    v_mfma_f32_16x16x32_bf16 a[204:207], v[120:123], v[88:91], a[204:207]
    v_cvt_pk_bf16_f32 v61, v246, v247
    v_cvt_pk_bf16_f32 v54, v248, v249
    v_mfma_f32_16x16x32_bf16 a[204:207], v[124:127], v[92:95], a[204:207]
    s_sub_u32 s78, s78, 1
    v_exp_f32 v252, v252
    v_smfmac_f32_16x16x64_bf16 a[216:219], a[136:139], v[80:87], v215
    s_cmp_lg_u32 s78, 0
    v_cvt_pk_bf16_f32 v55, v250, v251
    v_smfmac_f32_16x16x64_bf16 a[220:223], a[136:139], v[88:95], v215
    s_cbranch_scc1 K1_LS
K1_LS_END:
    v_add_f32 v212, s12, v156
    v_fma_f32 v176, v208, s8, v212
    v_fma_f32 v177, v209, s8, v212
    v_fma_f32 v178, v210, s8, v212
    v_fma_f32 v179, v211, s8, v212
    s_nop 1
    s_waitcnt lgkmcnt(0)
    v_mfma_f32_16x16x32_bf16 v[240:243], a[224:227], v[140:143], v[176:179]
    s_xor_b32 s21, s3, 1
    ds_read_b128 v[104:107], v2 offset:18432
    s_lshl2_add_u32 s21, s21, s4
    v_mfma_f32_16x16x32_bf16 v[240:243], a[228:231], v[172:175], v[240:243]
    s_mul_i32 s21, s21, 36864
    ds_read_b128 v[108:111], v2 offset:19456
    ds_read_b128 a[240:243], v2 offset:4096
    v_mfma_f32_16x16x32_bf16 v[240:243], a[232:235], v[204:207], v[240:243]
    s_add_u32 s21, s21, s28
    s_mov_b32 m0, s45
    ds_read_b128 a[244:247], v2 offset:5120
    v_mfma_f32_16x16x32_bf16 v[240:243], a[236:239], v[236:239], v[240:243]
    s_mul_i32 s86, s4, 34
    buffer_load_dwordx4 v1, s[56:59], s21 offen sc1 lds
    v_mfma_f32_16x16x32_bf16 a[8:11], v[96:99], v[48:51], a[8:11]
    s_add_u32 s86, s86, 8
    v_exp_f32 v253, v253
    v_mfma_f32_16x16x32_bf16 a[8:11], v[100:103], v[52:55], a[8:11]
    s_mov_b32 s99, s76
    v_exp_f32 v254, v254
    v_mfma_f32_16x16x32_bf16 a[12:15], v[96:99], v[56:59], a[12:15]
    s_mov_b32 s76, s60
    v_exp_f32 v255, v255
    v_cvt_pk_bf16_f32 v62, v252, v253
    v_cvt_pk_bf16_f32 v63, v254, v255
    s_nop 1
    v_mfma_f32_16x16x32_bf16 a[12:15], v[100:103], v[60:63], a[12:15]
    s_mov_b32 s60, s82
    ds_read_b128 a[248:251], v2 offset:6144
    ds_read_b128 a[252:255], v2 offset:7168
    s_waitcnt lgkmcnt(2)
    v_mfma_f32_16x16x32_bf16 a[24:27], v[104:107], v[48:51], a[24:27]
    s_mov_b32 s82, s95
    v_lshrrev_b32 v28, 4, v1
    ds_read_b128 v[112:115], v2 offset:20480
    v_mfma_f32_16x16x32_bf16 a[24:27], v[108:111], v[52:55], a[24:27]
    s_mov_b32 s95, s93
    v_min_u32 v28, 33, v28
    ds_read_b128 v[116:119], v2 offset:21504
    v_mfma_f32_16x16x32_bf16 a[28:31], v[104:107], v[56:59], a[28:31]
    s_mov_b32 s93, s99
    buffer_load_dwordx4 v1, s[56:59], s21 offen offset:1024 sc1 lds
    v_mfma_f32_16x16x32_bf16 a[28:31], v[108:111], v[60:63], a[28:31]
    s_and_b32 s62, s5, 4
    v_add_lshl_u32 v28, v28, s86, 7
    v_add_f32 v213, s13, v156
    v_fma_f32 v180, v208, s9, v213
    v_fma_f32 v181, v209, s9, v213
    v_fma_f32 v182, v210, s9, v213
    v_fma_f32 v183, v211, s9, v213
    s_nop 1
    v_mfma_f32_16x16x32_bf16 v[244:247], a[240:243], v[140:143], v[180:183]
    s_getpc_b64 s[86:87]
    global_load_dword v28, v28, s[86:87]
    v_mfma_f32_16x16x32_bf16 v[244:247], a[244:247], v[172:175], v[244:247]
    s_lshl_b32 s63, s3, 12
    ds_read_b128 v[120:123], v2 offset:22528
    ds_read_b128 v[124:127], v2 offset:23552
    s_waitcnt lgkmcnt(3)
    v_mfma_f32_16x16x32_bf16 v[244:247], a[248:251], v[204:207], v[244:247]
    s_sub_u32 s19, s74, s101
    buffer_load_dwordx4 v1, s[56:59], s21 offen offset:2048 sc1 lds
    v_mfma_f32_16x16x32_bf16 v[244:247], a[252:255], v[236:239], v[244:247]
    s_add_u32 s62, s62, s4
    ds_read_b128 a[224:227], v2 offset:8192
    ds_read_b128 a[228:231], v2 offset:9216
    v_mfma_f32_16x16x32_bf16 a[40:43], v[112:115], v[48:51], a[40:43]
    s_mov_b32 s20, s63
    ds_read_b128 a[232:235], v2 offset:10240
    v_add_f32 v212, s14, v156
    s_waitcnt lgkmcnt(5)
    v_mfma_f32_16x16x32_bf16 a[40:43], v[116:119], v[52:55], a[40:43]
    s_add_u32 s19, s66, s19
    ds_read_b128 a[236:239], v2 offset:11264
    v_fma_f32 v184, v208, s10, v212
    v_mfma_f32_16x16x32_bf16 a[44:47], v[112:115], v[56:59], a[44:47]
    s_mov_b32 s50, 9437184
    ds_read_b128 v[96:99], v2 offset:24576
    v_fma_f32 v185, v209, s10, v212
    v_mfma_f32_16x16x32_bf16 a[44:47], v[116:119], v[60:63], a[44:47]
    s_waitcnt lgkmcnt(5)
    ds_read_b128 v[100:103], v2 offset:25600
    v_fma_f32 v186, v210, s10, v212
    v_mfma_f32_16x16x32_bf16 a[56:59], v[120:123], v[48:51], a[56:59]
    buffer_load_dwordx4 v1, s[56:59], s21 offen offset:3072 sc1 lds
    v_mfma_f32_16x16x32_bf16 a[56:59], v[124:127], v[52:55], a[56:59]
    s_add_u32 s21, s21, 4096
    v_fma_f32 v187, v211, s10, v212
    ds_read_b128 v[104:107], v2 offset:26624
    v_mfma_f32_16x16x32_bf16 a[60:63], v[120:123], v[56:59], a[60:63]
    s_add_u32 m0, s45, 4096
    ds_read_b128 v[108:111], v2 offset:27648
    ds_read_b128 a[240:243], v2 offset:12288
    v_mfma_f32_16x16x32_bf16 a[60:63], v[124:127], v[60:63], a[60:63]
    s_waitcnt lgkmcnt(4)
    ds_read_b128 a[244:247], v2 offset:13312
    v_add_f32 v213, s15, v156
    v_mfma_f32_16x16x32_bf16 v[248:251], a[224:227], v[140:143], v[184:187]
    ds_read_b128 a[248:251], v2 offset:14336
    v_fma_f32 v188, v208, s11, v213
    v_mfma_f32_16x16x32_bf16 v[248:251], a[228:231], v[172:175], v[248:251]
    ds_read_b128 a[252:255], v2 offset:15360
    v_fma_f32 v189, v209, s11, v213
    v_mfma_f32_16x16x32_bf16 v[248:251], a[232:235], v[204:207], v[248:251]
    buffer_load_dwordx4 v1, s[56:59], s21 offen sc1 lds
    v_mfma_f32_16x16x32_bf16 v[248:251], a[236:239], v[236:239], v[248:251]
    ds_read_b128 v[112:115], v2 offset:28672
    ds_read_b128 v[116:119], v2 offset:29696
    v_mfma_f32_16x16x32_bf16 a[152:155], v[96:99], v[48:51], a[152:155]
    s_waitcnt lgkmcnt(4)
    v_fma_f32 v190, v210, s11, v213
    v_fma_f32 v191, v211, s11, v213
    v_mfma_f32_16x16x32_bf16 a[152:155], v[100:103], v[52:55], a[152:155]
    ds_read_b128 v[120:123], v2 offset:30720
    ds_read_b128 v[124:127], v2 offset:31744
    v_mfma_f32_16x16x32_bf16 a[156:159], v[96:99], v[56:59], a[156:159]
    v_add_u32 v2, s82, v1
    ds_read_b128 v[96:99], v2 offset:16384
    v_mfma_f32_16x16x32_bf16 a[156:159], v[100:103], v[60:63], a[156:159]
    ds_read_b128 v[100:103], v2 offset:17408
    v_bfe_u32 v217, v1, 4, 3
    v_mfma_f32_16x16x32_bf16 a[168:171], v[104:107], v[48:51], a[168:171]
    buffer_load_dwordx4 v1, s[56:59], s21 offen offset:1024 sc1 lds
    v_mfma_f32_16x16x32_bf16 a[168:171], v[108:111], v[52:55], a[168:171]
    v_exp_f32 v240, v240
    v_mfma_f32_16x16x32_bf16 a[172:175], v[104:107], v[56:59], a[172:175]
    ds_read_b128 v[104:107], v2 offset:18432
    v_lshlrev_b32 v217, 7, v217
    v_mfma_f32_16x16x32_bf16 a[172:175], v[108:111], v[60:63], a[172:175]
    v_exp_f32 v241, v241
    v_mfma_f32_16x16x32_bf16 v[252:255], a[240:243], v[140:143], v[188:191]
    ds_read_b128 v[108:111], v2 offset:19456
    v_cvt_pk_bf16_f32 v88, v240, v241
    v_mfma_f32_16x16x32_bf16 v[252:255], a[244:247], v[172:175], v[252:255]
    s_waitcnt lgkmcnt(2)
    v_exp_f32 v242, v242
    v_mfma_f32_16x16x32_bf16 v[252:255], a[248:251], v[204:207], v[252:255]
    buffer_load_dwordx4 v1, s[56:59], s21 offen offset:2048 sc1 lds
    v_mfma_f32_16x16x32_bf16 v[252:255], a[252:255], v[236:239], v[252:255]
    v_exp_f32 v243, v243
    v_mfma_f32_16x16x32_bf16 a[184:187], v[112:115], v[48:51], a[184:187]
    v_exp_f32 v244, v244
    v_mfma_f32_16x16x32_bf16 a[184:187], v[116:119], v[52:55], a[184:187]
    v_exp_f32 v245, v245
    v_mfma_f32_16x16x32_bf16 a[188:191], v[112:115], v[56:59], a[188:191]
    ds_read_b128 v[112:115], v2 offset:20480
    v_cvt_pk_bf16_f32 v89, v242, v243
    v_mfma_f32_16x16x32_bf16 a[188:191], v[116:119], v[60:63], a[188:191]
    v_exp_f32 v246, v246
    v_mfma_f32_16x16x32_bf16 a[200:203], v[120:123], v[48:51], a[200:203]
    v_exp_f32 v247, v247
    v_mfma_f32_16x16x32_bf16 a[200:203], v[124:127], v[52:55], a[200:203]
    v_exp_f32 v248, v248
    v_mfma_f32_16x16x32_bf16 a[204:207], v[120:123], v[56:59], a[204:207]
    v_exp_f32 v249, v249
    v_mfma_f32_16x16x32_bf16 a[204:207], v[124:127], v[60:63], a[204:207]
    v_exp_f32 v250, v250
    v_smfmac_f32_16x16x64_bf16 a[216:219], a[136:139], v[48:55], v215
    s_add_u32 s48, s32, 1048576
    s_addc_u32 s49, s33, 0
    ds_read_b128 v[116:119], v2 offset:21504
    v_smfmac_f32_16x16x64_bf16 a[220:223], a[136:139], v[56:63], v215
    v_exp_f32 v251, v251
    v_cvt_pk_bf16_f32 v90, v244, v245
    v_cvt_pk_bf16_f32 v91, v246, v247
    v_cvt_pk_bf16_f32 v92, v248, v249
    v_cvt_pk_bf16_f32 v93, v250, v251
    v_exp_f32 v252, v252
    s_cmp_eq_u32 s6, 7
    s_cbranch_scc1 K1_S7
K1_S7_BACK:
    s_waitcnt lgkmcnt(0)
    v_mfma_f32_16x16x32_bf16 a[12:15], v[96:99], v[88:91], a[12:15]
    ds_read_b128 v[120:123], v2 offset:22528
    v_exp_f32 v253, v253
    v_exp_f32 v254, v254
    v_exp_f32 v255, v255
    v_cvt_pk_bf16_f32 v94, v252, v253
    v_cvt_pk_bf16_f32 v95, v254, v255
    s_nop 1
    v_mfma_f32_16x16x32_bf16 a[12:15], v[100:103], v[92:95], a[12:15]
    ds_read_b128 v[124:127], v2 offset:23552
    ds_read_b128 v[96:99], v2 offset:24576
    v_accvgpr_read_b32 v12, a8
    v_accvgpr_read_b32 v13, a9
    v_accvgpr_read_b32 v14, a10
    v_mfma_f32_16x16x32_bf16 a[28:31], v[104:107], v[88:91], a[28:31]
    ds_read_b128 v[100:103], v2 offset:25600
    v_accvgpr_read_b32 v9, a216
    v_accvgpr_read_b32 v10, a217
    v_add_f32 v9, v9, v10
    v_accvgpr_read_b32 v15, a11
    v_mfma_f32_16x16x32_bf16 a[28:31], v[108:111], v[92:95], a[28:31]
    ds_read_b128 v[104:107], v2 offset:26624
    v_rcp_f32 v10, v9
    v_accvgpr_read_b32 v16, a24
    v_mul_f32 v10, v10, v6
    v_mfma_f32_16x16x32_bf16 a[44:47], v[112:115], v[88:91], a[44:47]
    ds_read_b128 v[108:111], v2 offset:27648
    v_accvgpr_read_b32 v17, a25
    v_accvgpr_read_b32 v18, a26
    v_accvgpr_read_b32 v19, a27
    v_accvgpr_read_b32 v20, a40
    v_mfma_f32_16x16x32_bf16 a[44:47], v[116:119], v[92:95], a[44:47]
    s_waitcnt lgkmcnt(5)
    ds_read_b128 v[112:115], v2 offset:28672
    v_accvgpr_read_b32 v21, a41
    v_accvgpr_read_b32 v22, a42
    v_accvgpr_read_b32 v23, a43
    v_accvgpr_read_b32 v24, a56
    v_mfma_f32_16x16x32_bf16 a[60:63], v[120:123], v[88:91], a[60:63]
    s_waitcnt lgkmcnt(3)
    ds_read_b128 v[116:119], v2 offset:29696
    v_accvgpr_read_b32 v25, a57
    v_accvgpr_read_b32 v26, a58
    v_accvgpr_read_b32 v27, a59
    v_mul_f32 v12, v10, v12
    v_mfma_f32_16x16x32_bf16 a[60:63], v[124:127], v[92:95], a[60:63]
    ds_read_b128 v[120:123], v2 offset:30720
    v_mul_f32 v13, v10, v13
    v_mul_f32 v14, v10, v14
    v_mul_f32 v15, v10, v15
    v_mul_f32 v16, v10, v16
    v_mfma_f32_16x16x32_bf16 a[156:159], v[96:99], v[88:91], a[156:159]
    ds_read_b128 v[124:127], v2 offset:31744
    v_mul_f32 v17, v10, v17
    v_mul_f32 v18, v10, v18
    v_mul_f32 v19, v10, v19
    v_mul_f32 v20, v10, v20
    v_mfma_f32_16x16x32_bf16 a[156:159], v[100:103], v[92:95], a[156:159]
    s_waitcnt lgkmcnt(3)
    v_mul_f32 v21, v10, v21
    v_mul_f32 v22, v10, v22
    v_mul_f32 v23, v10, v23
    v_mul_f32 v24, v10, v24
    v_mul_f32 v25, v10, v25
    v_mfma_f32_16x16x32_bf16 a[172:175], v[104:107], v[88:91], a[172:175]
    v_mul_f32 v26, v10, v26
    v_mul_f32 v27, v10, v27
    v_cvt_pk_bf16_f32 v12, v12, v13
    v_cvt_pk_bf16_f32 v13, v14, v15
    v_cvt_pk_bf16_f32 v14, v16, v17
    v_mfma_f32_16x16x32_bf16 a[172:175], v[108:111], v[92:95], a[172:175]
    v_cvt_pk_bf16_f32 v15, v18, v19
    v_cvt_pk_bf16_f32 v20, v20, v21
    v_cvt_pk_bf16_f32 v21, v22, v23
    v_cvt_pk_bf16_f32 v22, v24, v25
    v_cvt_pk_bf16_f32 v23, v26, v27
    v_mfma_f32_16x16x32_bf16 a[188:191], v[112:115], v[88:91], a[188:191]
    s_waitcnt lgkmcnt(1)
    buffer_store_dwordx4 v[12:15], v1, s[40:43], s81 offen offset:0 sc1
    buffer_store_dwordx4 v[20:23], v1, s[40:43], s81 offen offset:1024 sc1
    v_accvgpr_read_b32 v16, a168
    v_mfma_f32_16x16x32_bf16 a[188:191], v[116:119], v[92:95], a[188:191]
    v_accvgpr_read_b32 v12, a152
    v_accvgpr_read_b32 v13, a153
    v_accvgpr_read_b32 v14, a154
    v_accvgpr_read_b32 v15, a155
    v_accvgpr_read_b32 v17, a169
    v_mfma_f32_16x16x32_bf16 a[204:207], v[120:123], v[88:91], a[204:207]
    s_waitcnt lgkmcnt(0)
    v_accvgpr_read_b32 v18, a170
    v_accvgpr_read_b32 v19, a171
    v_accvgpr_read_b32 v20, a184
    v_accvgpr_read_b32 v21, a185
    v_accvgpr_read_b32 v22, a186
    v_mfma_f32_16x16x32_bf16 a[204:207], v[124:127], v[92:95], a[204:207]
    v_accvgpr_read_b32 v23, a187
    v_accvgpr_read_b32 v24, a200
    v_accvgpr_read_b32 v25, a201
    v_accvgpr_read_b32 v26, a202
    v_accvgpr_read_b32 v27, a203
    v_smfmac_f32_16x16x64_bf16 a[220:223], a[136:139], v[88:95], v215
    v_mul_f32 v12, v10, v12
    v_mul_f32 v13, v10, v13
    v_mul_f32 v14, v10, v14
    v_mul_f32 v15, v10, v15
    v_mul_f32 v16, v10, v16
    v_mul_f32 v17, v10, v17
    v_mul_f32 v18, v10, v18
    v_mul_f32 v19, v10, v19
    v_mul_f32 v20, v10, v20
    v_mul_f32 v21, v10, v21
    v_mul_f32 v22, v10, v22
    v_mul_f32 v23, v10, v23
    v_mul_f32 v24, v10, v24
    v_mul_f32 v25, v10, v25
    v_mul_f32 v26, v10, v26
    v_mul_f32 v27, v10, v27
    v_cmp_nge_f32 vcc, 0x71800000, v9
    v_cvt_pk_bf16_f32 v12, v12, v13
    v_cvt_pk_bf16_f32 v13, v14, v15
    v_cvt_pk_bf16_f32 v14, v16, v17
    v_cvt_pk_bf16_f32 v15, v18, v19
    v_cvt_pk_bf16_f32 v20, v20, v21
    v_cvt_pk_bf16_f32 v21, v22, v23
    v_cvt_pk_bf16_f32 v22, v24, v25
    v_cvt_pk_bf16_f32 v23, v26, v27
    s_or_b64 s[84:85], s[84:85], vcc
    buffer_store_dwordx4 v[12:15], v1, s[40:43], s81 offen offset:2048 sc1
    buffer_store_dwordx4 v[20:23], v1, s[40:43], s81 offen offset:3072 sc1
    s_nop 3
    v_accvgpr_read_b32 v9, a220
    v_accvgpr_read_b32 v10, a221
    v_add_f32 v9, v9, v10
    v_cmp_nge_f32 vcc, 0x71800000, v9
    v_rcp_f32 v10, v9
    s_nop 0
    s_or_b64 s[84:85], s[84:85], vcc
    v_mul_f32 v10, v10, v7
    s_add_u32 s72, s81, 622592
    v_accvgpr_read_b32 v12, a12
    v_accvgpr_read_b32 v13, a13
    v_accvgpr_read_b32 v14, a14
    v_accvgpr_read_b32 v15, a15
    v_accvgpr_read_b32 v16, a28
    v_accvgpr_read_b32 v17, a29
    v_accvgpr_read_b32 v18, a30
    v_accvgpr_read_b32 v19, a31
    v_pk_mul_f32 v[12:13], v[12:13], v[10:11] op_sel_hi:[1,0]
    v_pk_mul_f32 v[14:15], v[14:15], v[10:11] op_sel_hi:[1,0]
    v_pk_mul_f32 v[16:17], v[16:17], v[10:11] op_sel_hi:[1,0]
    v_pk_mul_f32 v[18:19], v[18:19], v[10:11] op_sel_hi:[1,0]
    v_cvt_pk_bf16_f32 v12, v12, v13
    v_cvt_pk_bf16_f32 v13, v14, v15
    v_cvt_pk_bf16_f32 v14, v16, v17
    v_cvt_pk_bf16_f32 v15, v18, v19
    buffer_store_dwordx4 v[12:15], v1, s[40:43], s72 offen offset:0 sc1
    v_accvgpr_read_b32 v20, a44
    v_accvgpr_read_b32 v21, a45
    v_accvgpr_read_b32 v22, a46
    v_accvgpr_read_b32 v23, a47
    v_accvgpr_read_b32 v24, a60
    v_accvgpr_read_b32 v25, a61
    v_accvgpr_read_b32 v26, a62
    v_accvgpr_read_b32 v27, a63
    v_pk_mul_f32 v[20:21], v[20:21], v[10:11] op_sel_hi:[1,0]
    v_pk_mul_f32 v[22:23], v[22:23], v[10:11] op_sel_hi:[1,0]
    v_pk_mul_f32 v[24:25], v[24:25], v[10:11] op_sel_hi:[1,0]
    v_pk_mul_f32 v[26:27], v[26:27], v[10:11] op_sel_hi:[1,0]
    v_cvt_pk_bf16_f32 v20, v20, v21
    v_cvt_pk_bf16_f32 v21, v22, v23
    v_cvt_pk_bf16_f32 v22, v24, v25
    v_cvt_pk_bf16_f32 v23, v26, v27
    buffer_store_dwordx4 v[20:23], v1, s[40:43], s72 offen offset:1024 sc1
    v_accvgpr_read_b32 v12, a156
    v_accvgpr_read_b32 v13, a157
    v_accvgpr_read_b32 v14, a158
    v_accvgpr_read_b32 v15, a159
    v_accvgpr_read_b32 v16, a172
    v_accvgpr_read_b32 v17, a173
    v_accvgpr_read_b32 v18, a174
    v_accvgpr_read_b32 v19, a175
    v_pk_mul_f32 v[12:13], v[12:13], v[10:11] op_sel_hi:[1,0]
    v_pk_mul_f32 v[14:15], v[14:15], v[10:11] op_sel_hi:[1,0]
    v_pk_mul_f32 v[16:17], v[16:17], v[10:11] op_sel_hi:[1,0]
    v_pk_mul_f32 v[18:19], v[18:19], v[10:11] op_sel_hi:[1,0]
    v_cvt_pk_bf16_f32 v12, v12, v13
    v_cvt_pk_bf16_f32 v13, v14, v15
    v_cvt_pk_bf16_f32 v14, v16, v17
    v_cvt_pk_bf16_f32 v15, v18, v19
    buffer_store_dwordx4 v[12:15], v1, s[40:43], s72 offen offset:2048 sc1
    v_accvgpr_read_b32 v20, a188
    v_accvgpr_read_b32 v21, a189
    v_accvgpr_read_b32 v22, a190
    v_accvgpr_read_b32 v23, a191
    v_accvgpr_read_b32 v24, a204
    v_accvgpr_read_b32 v25, a205
    v_accvgpr_read_b32 v26, a206
    v_accvgpr_read_b32 v27, a207
    v_pk_mul_f32 v[20:21], v[20:21], v[10:11] op_sel_hi:[1,0]
    v_pk_mul_f32 v[22:23], v[22:23], v[10:11] op_sel_hi:[1,0]
    v_pk_mul_f32 v[24:25], v[24:25], v[10:11] op_sel_hi:[1,0]
    v_pk_mul_f32 v[26:27], v[26:27], v[10:11] op_sel_hi:[1,0]
    v_cvt_pk_bf16_f32 v20, v20, v21
    v_cvt_pk_bf16_f32 v21, v22, v23
    v_cvt_pk_bf16_f32 v22, v24, v25
    v_cvt_pk_bf16_f32 v23, v26, v27
    buffer_store_dwordx4 v[20:23], v1, s[40:43], s72 offen offset:3072 sc1
    buffer_load_dword v3, v217, s[32:35], s19 offen sc1
    s_waitcnt lgkmcnt(0)
    s_barrier
    s_sub_u32 s30, s47, s75
    s_sub_u32 s31, s79, s75
    v_bfe_u32 v20, v1, 4, 4
    v_lshrrev_b32 v21, 8, v1
    s_lshl_b32 s98, s4, 4
    s_add_u32 s98, s98, 16
    v_add_u32 v22, s98, v20
    v_mul_u32_u24 v22, 144, v22
    v_add_u32 v22, s30, v22
    v_lshl_add_u32 v9, v21, 3, v22
    s_lshr_b32 s98, s73, 1
    v_add_u32 v8, s98, v9
    v_subrev_u32 v10, s98, v9
    s_sub_u32 s99, s31, s30
    v_add_u32 v24, s99, v8
    v_add_u32 v25, s99, v9
    v_add_u32 v26, s99, v10
    s_bitcmp1_b32 s4, 0
    s_cselect_b32 s99, s31, s30
    v_mul_u32_u24 v23, 144, v20
    v_lshl_add_u32 v23, v21, 3, v23
    v_add_u32 v13, s99, v23
    v_add_u32 v12, s98, v13
    v_accvgpr_read_b32 v32, a64
    v_accvgpr_read_b32 v33, a65
    v_accvgpr_read_b32 v34, a66
    v_accvgpr_read_b32 v35, a67
    v_cvt_pk_bf16_f32 v32, v32, v33
    v_cvt_pk_bf16_f32 v33, v34, v35
    ds_write_b64 v8, v[32:33] offset:0
    v_accvgpr_read_b32 v36, a68
    v_accvgpr_read_b32 v37, a69
    v_accvgpr_read_b32 v38, a70
    v_accvgpr_read_b32 v39, a71
    v_cvt_pk_bf16_f32 v36, v36, v37
    v_cvt_pk_bf16_f32 v37, v38, v39
    ds_write_b64 v8, v[36:37] offset:9216
    v_accvgpr_read_b32 v40, a72
    v_accvgpr_read_b32 v41, a73
    v_accvgpr_read_b32 v42, a74
    v_accvgpr_read_b32 v43, a75
    v_cvt_pk_bf16_f32 v40, v40, v41
    v_cvt_pk_bf16_f32 v41, v42, v43
    ds_write_b64 v24, v[40:41] offset:0
    v_accvgpr_read_b32 v44, a76
    v_accvgpr_read_b32 v45, a77
    v_accvgpr_read_b32 v46, a78
    v_accvgpr_read_b32 v47, a79
    v_cvt_pk_bf16_f32 v44, v44, v45
    v_cvt_pk_bf16_f32 v45, v46, v47
    ds_write_b64 v24, v[44:45] offset:9216
    v_accvgpr_read_b32 v32, a80
    v_accvgpr_read_b32 v33, a81
    v_accvgpr_read_b32 v34, a82
    v_accvgpr_read_b32 v35, a83
    v_cvt_pk_bf16_f32 v32, v32, v33
    v_cvt_pk_bf16_f32 v33, v34, v35
    ds_write_b64 v9, v[32:33] offset:32
    v_accvgpr_read_b32 v36, a84
    v_accvgpr_read_b32 v37, a85
    v_accvgpr_read_b32 v38, a86
    v_accvgpr_read_b32 v39, a87
    v_cvt_pk_bf16_f32 v36, v36, v37
    v_cvt_pk_bf16_f32 v37, v38, v39
    ds_write_b64 v9, v[36:37] offset:9248
    v_accvgpr_read_b32 v40, a88
    v_accvgpr_read_b32 v41, a89
    v_accvgpr_read_b32 v42, a90
    v_accvgpr_read_b32 v43, a91
    v_cvt_pk_bf16_f32 v40, v40, v41
    v_cvt_pk_bf16_f32 v41, v42, v43
    ds_write_b64 v25, v[40:41] offset:32
    v_accvgpr_read_b32 v44, a92
    v_accvgpr_read_b32 v45, a93
    v_accvgpr_read_b32 v46, a94
    v_accvgpr_read_b32 v47, a95
    v_cvt_pk_bf16_f32 v44, v44, v45
    v_cvt_pk_bf16_f32 v45, v46, v47
    ds_write_b64 v25, v[44:45] offset:9248
    v_accvgpr_read_b32 v32, a96
    v_accvgpr_read_b32 v33, a97
    v_accvgpr_read_b32 v34, a98
    v_accvgpr_read_b32 v35, a99
    v_cvt_pk_bf16_f32 v32, v32, v33
    v_cvt_pk_bf16_f32 v33, v34, v35
    ds_write_b64 v10, v[32:33] offset:64
    v_accvgpr_read_b32 v36, a100
    v_accvgpr_read_b32 v37, a101
    v_accvgpr_read_b32 v38, a102
    v_accvgpr_read_b32 v39, a103
    v_cvt_pk_bf16_f32 v36, v36, v37
    v_cvt_pk_bf16_f32 v37, v38, v39
    ds_write_b64 v10, v[36:37] offset:9280
    v_accvgpr_read_b32 v40, a104
    v_accvgpr_read_b32 v41, a105
    v_accvgpr_read_b32 v42, a106
    v_accvgpr_read_b32 v43, a107
    v_cvt_pk_bf16_f32 v40, v40, v41
    v_cvt_pk_bf16_f32 v41, v42, v43
    ds_write_b64 v26, v[40:41] offset:64
    v_accvgpr_read_b32 v44, a108
    v_accvgpr_read_b32 v45, a109
    v_accvgpr_read_b32 v46, a110
    v_accvgpr_read_b32 v47, a111
    v_cvt_pk_bf16_f32 v44, v44, v45
    v_cvt_pk_bf16_f32 v45, v46, v47
    ds_write_b64 v26, v[44:45] offset:9280
    v_mov_b32 v218, 2
    s_cmp_eq_u64 s[84:85], 0
    s_cselect_b32 s7, s74, 1073741824
    s_cmp_lg_u32 s83, 0
    s_cselect_b32 s7, s74, s7
    s_waitcnt vmcnt(1)
    buffer_store_dword v218, v216, s[32:35], s7 offen sc1
    s_xor_b32 s21, s3, 2
    s_lshl2_add_u32 s21, s21, s4
    s_mul_i32 s21, s21, 36864
    s_add_u32 s21, s21, s28
    s_mov_b32 m0, s46
    s_nop 0
    buffer_load_dwordx4 v1, s[56:59], s21 offen sc1 lds
    v_accvgpr_read_b32 v32, a112
    v_accvgpr_read_b32 v33, a113
    v_accvgpr_read_b32 v34, a114
    v_accvgpr_read_b32 v35, a115
    v_cvt_pk_bf16_f32 v32, v32, v33
    v_cvt_pk_bf16_f32 v33, v34, v35
    ds_write_b64 v9, v[32:33] offset:96
    v_accvgpr_read_b32 v36, a116
    v_accvgpr_read_b32 v37, a117
    v_accvgpr_read_b32 v38, a118
    v_accvgpr_read_b32 v39, a119
    v_cvt_pk_bf16_f32 v36, v36, v37
    buffer_load_dwordx4 v1, s[56:59], s21 offen offset:1024 sc1 lds
    v_cvt_pk_bf16_f32 v37, v38, v39
    ds_write_b64 v9, v[36:37] offset:9312
    v_accvgpr_read_b32 v40, a120
    v_accvgpr_read_b32 v41, a121
    v_accvgpr_read_b32 v42, a122
    v_accvgpr_read_b32 v43, a123
    v_cvt_pk_bf16_f32 v40, v40, v41
    v_cvt_pk_bf16_f32 v41, v42, v43
    ds_write_b64 v25, v[40:41] offset:96
    v_accvgpr_read_b32 v44, a124
    v_accvgpr_read_b32 v45, a125
    v_accvgpr_read_b32 v46, a126
    buffer_load_dwordx4 v1, s[56:59], s21 offen offset:2048 sc1 lds
    v_accvgpr_read_b32 v47, a127
    v_cvt_pk_bf16_f32 v44, v44, v45
    v_cvt_pk_bf16_f32 v45, v46, v47
    s_waitcnt lgkmcnt(3)
    ds_write_b64 v25, v[44:45] offset:9312
    v_accvgpr_read_b32 v32, a128
    v_accvgpr_read_b32 v33, a129
    v_accvgpr_read_b32 v34, a130
    v_accvgpr_read_b32 v35, a131
    v_cvt_pk_bf16_f32 v32, v32, v33
    v_cvt_pk_bf16_f32 v33, v34, v35
    ds_write_b64 v12, v[32:33] offset:0
    v_accvgpr_read_b32 v36, a132
    buffer_load_dwordx4 v1, s[56:59], s21 offen offset:3072 sc1 lds
    v_accvgpr_read_b32 v37, a133
    v_accvgpr_read_b32 v38, a134
    v_accvgpr_read_b32 v39, a135
    v_cvt_pk_bf16_f32 v36, v36, v37
    v_cvt_pk_bf16_f32 v37, v38, v39
    s_cmp_eq_u32 s73, 0
    s_cselect_b64 exec, -1, 0
    ds_write_b64 v13, v[36:37] offset:32
    s_mov_b64 exec, -1
    s_cmp_lg_u64 s[84:85], 0
    s_cselect_b32 s7, 1, 0
    v_mov_b32 v20, s7
    s_lshl2_add_u32 s98, s4, s30
    s_add_u32 s21, s21, 4096
    s_add_u32 m0, s46, 4096
    s_nop 0
    buffer_load_dwordx4 v1, s[56:59], s21 offen sc1 lds
    v_mov_b32 v21, s98
    ds_write_b32 v21, v20 offset:20736
    v_mov_b32 v21, s30
    s_and_b32 s98, s4, 1
    s_lshl_b32 s98, s98, 6
    v_lshrrev_b32 v14, 4, v1
    v_add_u32 v14, s98, v14
    s_sub_u32 s7, 15, s6
    s_cmp_lt_u32 s4, 2
    s_cselect_b32 s7, s6, s7
    s_cselect_b32 s99, s30, s31
    s_lshl_b32 s7, s7, 7
    buffer_load_dwordx4 v1, s[56:59], s21 offen offset:1024 sc1 lds
    v_add_u32 v2, 2, v14
    v_mul_u32_u24 v2, 144, v2
    v_add_u32 v2, s99, v2
    v_add_u32 v14, s7, v14
    v_lshrrev_b32 v15, 4, v14
    s_mov_b32 s98, 155648
    v_mul_lo_u32 v15, v15, s98
    v_and_b32 v23, 0xf0, v1
    v_add_u32 v15, v15, v23
    s_lshl3_add_u32 s98, s6, s62
    s_mul_i32 s98, s98, 155648
    v_add_u32 v4, s98, v1
    buffer_load_dwordx4 v1, s[56:59], s21 offen offset:2048 sc1 lds
    s_sub_u32 s98, 15, s6
    s_lshl3_add_u32 s98, s98, s62
    s_mul_i32 s98, s98, 155648
    v_add_u32 v5, s98, v1
    v_mov_b32 v19, v217
    v_subrev_u32 v23, s75, v1
    v_add_u32 v11, s44, v23
    v_add_u32 v12, s45, v23
    v_add_u32 v13, s46, v23
    v_add_u32 v6, s47, v23
    v_add_u32 v7, s79, v23
    s_mov_b32 s98, 0xbfb8aa3b
    s_mov_b32 s99, 0x3eae1a93
    s_waitcnt vmcnt(8) lgkmcnt(0)
    s_barrier
    ds_read_b128 v[24:27], v21 offset:20736
    ds_read_b128 v[32:35], v2 offset:2016
    ds_read_b128 v[36:39], v2 offset:2032
    ds_read_b128 v[40:43], v2 offset:2048
    ds_read_b128 v[44:47], v2 offset:1728
    ds_read_b128 v[48:51], v2 offset:1744
    ds_read_b128 v[52:55], v2 offset:1760
    s_waitcnt lgkmcnt(6)
    v_or3_b32 v24, v24, v25, v26
    v_or_b32 v24, v24, v27
    s_nop 0
    v_readfirstlane_b32 s7, v24
    s_nop 1
    s_andn2_b32 s7, s7, s83
    s_cbranch_scc1 K1_REDO
    buffer_load_dword v28, v29, s[32:35], s92 offen sc1
    v_cmp_gt_u32 vcc, 1, v3
    s_nop 1
    s_and_b64 vcc, vcc, exec
    s_cbranch_scc1 SPIN_SHORT
BACK_SHORT:
    buffer_load_dwordx4 a[0:3], v4, s[40:43], s63 offen offset:0 sc1
    ds_read_b128 v[128:131], v2 offset:2096
    ds_read_b128 v[132:135], v2 offset:2112
    ds_read_b128 v[136:139], v2 offset:2128
    ds_read_b128 v[56:59], v2 offset:1440
    ds_read_b128 v[60:63], v2 offset:1456
    ds_read_b128 v[64:67], v2 offset:1472
    ds_read_b128 v[68:71], v2 offset:1152
    ds_read_b128 v[72:75], v2 offset:1168
    ds_read_b128 v[76:79], v2 offset:1184
    s_waitcnt lgkmcnt(8)
    v_dot2_f32_bf16 v140, v128, v32, 0
    v_dot2_f32_bf16 v141, v128, v44, 0
    buffer_load_dwordx4 a[8:11], v4, s[40:43], s63 offen offset:1024 sc1
    ds_read_b128 v[80:83], v2 offset:864
    s_waitcnt lgkmcnt(6)
    v_dot2_f32_bf16 v142, v128, v56, 0
    s_waitcnt lgkmcnt(3)
    v_dot2_f32_bf16 v143, v128, v68, 0
    ds_read_b128 v[84:87], v2 offset:880
    v_dot2c_f32_bf16 v140, v129, v33
    v_dot2c_f32_bf16 v141, v129, v45
    ds_read_b128 v[88:91], v2 offset:896
    v_dot2c_f32_bf16 v142, v129, v57
    v_dot2c_f32_bf16 v143, v129, v69
    ds_read_b128 v[92:95], v2 offset:576
    v_dot2c_f32_bf16 v140, v130, v34
    buffer_load_dwordx4 a[16:19], v4, s[40:43], s63 offen offset:2048 sc1
    v_dot2c_f32_bf16 v141, v130, v46
    ds_read_b128 v[96:99], v2 offset:592
    v_dot2c_f32_bf16 v142, v130, v58
    v_dot2c_f32_bf16 v143, v130, v70
    ds_read_b128 v[100:103], v2 offset:608
    v_dot2c_f32_bf16 v140, v131, v35
    v_dot2c_f32_bf16 v141, v131, v47
    ds_read_b128 v[104:107], v2 offset:288
    v_dot2c_f32_bf16 v142, v131, v59
    v_dot2c_f32_bf16 v143, v131, v71
    ds_read_b128 v[108:111], v2 offset:304
    v_dot2c_f32_bf16 v140, v132, v36
    buffer_load_dwordx4 a[24:27], v4, s[40:43], s63 offen offset:3072 sc1
    v_dot2c_f32_bf16 v141, v132, v48
    ds_read_b128 v[112:115], v2 offset:320
    v_dot2c_f32_bf16 v142, v132, v60
    s_waitcnt lgkmcnt(8)
    v_dot2c_f32_bf16 v143, v132, v72
    ds_read_b128 v[116:119], v2 offset:0
    v_dot2c_f32_bf16 v140, v133, v37
    v_dot2c_f32_bf16 v141, v133, v49
    ds_read_b128 v[120:123], v2 offset:16
    v_dot2c_f32_bf16 v142, v133, v61
    v_dot2c_f32_bf16 v143, v133, v73
    ds_read_b128 v[124:127], v2 offset:32
    s_xor_b32 s63, s63, 4096
    buffer_load_dwordx4 a[32:35], v4, s[40:43], s63 offen offset:0 sc1
    v_dot2c_f32_bf16 v140, v134, v38
    v_dot2c_f32_bf16 v141, v134, v50
    v_dot2c_f32_bf16 v142, v134, v62
    v_dot2c_f32_bf16 v143, v134, v74
    v_dot2c_f32_bf16 v140, v135, v39
    v_dot2c_f32_bf16 v141, v135, v51
    v_dot2c_f32_bf16 v142, v135, v63
    v_dot2c_f32_bf16 v143, v135, v75
    v_dot2c_f32_bf16 v140, v136, v40
    v_dot2c_f32_bf16 v141, v136, v52
    v_dot2c_f32_bf16 v142, v136, v64
    buffer_load_dwordx4 a[40:43], v4, s[40:43], s63 offen offset:1024 sc1
    v_dot2c_f32_bf16 v143, v136, v76
    v_dot2_f32_bf16 v144, v128, v80, 0
    s_waitcnt lgkmcnt(4)
    v_dot2_f32_bf16 v145, v128, v92, 0
    ds_read_b128 v[32:35], v2 offset:2064
    v_dot2_f32_bf16 v146, v128, v104, 0
    s_waitcnt lgkmcnt(3)
    v_dot2_f32_bf16 v147, v128, v116, 0
    ds_read_b128 v[36:39], v2 offset:2080
    v_dot2c_f32_bf16 v144, v129, v81
    v_dot2c_f32_bf16 v145, v129, v93
    ds_read_b128 v[44:47], v2 offset:1776
    v_dot2c_f32_bf16 v146, v129, v105
    v_dot2c_f32_bf16 v147, v129, v117
    buffer_load_dwordx4 a[48:51], v4, s[40:43], s63 offen offset:2048 sc1
    ds_read_b128 v[48:51], v2 offset:1792
    v_dot2c_f32_bf16 v144, v130, v82
    v_dot2c_f32_bf16 v145, v130, v94
    ds_read_b128 v[56:59], v2 offset:1488
    v_dot2c_f32_bf16 v146, v130, v106
    v_dot2c_f32_bf16 v147, v130, v118
    ds_read_b128 v[60:63], v2 offset:1504
    v_dot2c_f32_bf16 v144, v131, v83
    v_dot2c_f32_bf16 v145, v131, v95
    ds_read_b128 v[68:71], v2 offset:1200
    v_dot2c_f32_bf16 v146, v131, v107
    buffer_load_dwordx4 a[56:59], v4, s[40:43], s63 offen offset:3072 sc1
    v_dot2c_f32_bf16 v147, v131, v119
    ds_read_b128 v[72:75], v2 offset:1216
    v_dot2c_f32_bf16 v144, v132, v84
    v_dot2c_f32_bf16 v145, v132, v96
    v_dot2c_f32_bf16 v146, v132, v108
    s_waitcnt lgkmcnt(8)
    v_dot2c_f32_bf16 v147, v132, v120
    v_dot2c_f32_bf16 v144, v133, v85
    v_dot2c_f32_bf16 v145, v133, v97
    v_dot2c_f32_bf16 v146, v133, v109
    v_dot2c_f32_bf16 v147, v133, v121
    v_dot2c_f32_bf16 v144, v134, v86
    s_xor_b32 s63, s63, 12288
    buffer_load_dwordx4 a[64:67], v4, s[40:43], s63 offen offset:0 sc1
    v_dot2c_f32_bf16 v145, v134, v98
    v_dot2c_f32_bf16 v146, v134, v110
    v_dot2c_f32_bf16 v147, v134, v122
    v_dot2c_f32_bf16 v144, v135, v87
    v_dot2c_f32_bf16 v145, v135, v99
    v_dot2c_f32_bf16 v146, v135, v111
    v_dot2c_f32_bf16 v147, v135, v123
    v_dot2c_f32_bf16 v144, v136, v88
    v_dot2c_f32_bf16 v145, v136, v100
    v_dot2c_f32_bf16 v146, v136, v112
    v_dot2c_f32_bf16 v147, v136, v124
    v_lshlrev_b32 v8, 16, v138
    buffer_load_dwordx4 a[72:75], v4, s[40:43], s63 offen offset:1024 sc1
    v_mul_f32 v8, s98, v8
    v_exp_f32 v8, v8
    s_or_b32 s7, s6, s4
    s_cbranch_scc0 K1_WMASK
K1_WMASK_BACK:
    v_max3_f32 v9, v140, v141, v142
    v_max3_f32 v10, v143, v144, v145
    v_max3_f32 v9, v9, v146, v147
    v_max_f32 v9, v9, v10
    v_mul_f32 v9, s99, v9
    v_add_f32 v8, 1.0, v8
    buffer_load_dwordx4 a[80:83], v4, s[40:43], s63 offen offset:2048 sc1
    v_fma_f32 v140, v140, s99, -v9
    ds_read_b128 v[80:83], v2 offset:912
    v_fma_f32 v141, v141, s99, -v9
    ds_read_b128 v[84:87], v2 offset:928
    v_fma_f32 v142, v142, s99, -v9
    ds_read_b128 v[92:95], v2 offset:624
    v_fma_f32 v143, v143, s99, -v9
    ds_read_b128 v[96:99], v2 offset:640
    v_fma_f32 v144, v144, s99, -v9
    ds_read_b128 v[104:107], v2 offset:336
    v_fma_f32 v145, v145, s99, -v9
    buffer_load_dwordx4 a[88:91], v4, s[40:43], s63 offen offset:3072 sc1
    s_xor_b32 s63, s63, 4096
    ds_read_b128 v[108:111], v2 offset:352
    v_fma_f32 v146, v146, s99, -v9
    ds_read_b128 v[116:119], v2 offset:48
    v_fma_f32 v147, v147, s99, -v9
    s_waitcnt lgkmcnt(7)
    ds_read_b128 v[120:123], v2 offset:64
    v_exp_f32 v140, v140
    v_exp_f32 v141, v141
    v_exp_f32 v142, v142
    v_exp_f32 v143, v143
    v_exp_f32 v144, v144
    v_exp_f32 v145, v145
    v_exp_f32 v146, v146
    buffer_load_dword v3, v217, s[32:35], s19 offen sc1
    buffer_load_dwordx4 a[96:99], v4, s[40:43], s63 offen offset:0 sc1
    v_exp_f32 v147, v147
    v_add_f32 v10, v140, v141
    v_add_f32 v10, v10, v142
    v_add_f32 v10, v10, v143
    v_add_f32 v10, v10, v144
    v_add_f32 v10, v10, v145
    buffer_load_dwordx4 a[104:107], v4, s[40:43], s63 offen offset:1024 sc1
    v_add_f32 v10, v10, v146
    v_add_f32 v10, v10, v147
    v_mul_f32 v10, v10, v8
    v_rcp_f32 v10, v10
    s_nop 0
    v_mul_f32 v140, v140, v10
    v_mul_f32 v141, v141, v10
    v_mul_f32 v142, v142, v10
    buffer_load_dwordx4 a[112:115], v4, s[40:43], s63 offen offset:2048 sc1
    v_mul_f32 v143, v143, v10
    v_mul_f32 v144, v144, v10
    v_mul_f32 v145, v145, v10
    v_mul_f32 v146, v146, v10
    v_mul_f32 v147, v147, v10
    v_cvt_pk_bf16_f32 v148, 0, v140
    buffer_load_dwordx4 a[120:123], v4, s[40:43], s63 offen offset:3072 sc1
    v_cvt_pk_bf16_f32 v149, 0, v141
    v_cvt_pk_bf16_f32 v150, 0, v142
    v_cvt_pk_bf16_f32 v151, 0, v143
    v_cvt_pk_bf16_f32 v152, 0, v144
    v_cvt_pk_bf16_f32 v153, 0, v145
    v_cvt_pk_bf16_f32 v154, 0, v146
    v_cvt_pk_bf16_f32 v155, 0, v147
    s_xor_b32 s63, s63, 28672
    buffer_load_dwordx4 a[128:131], v4, s[40:43], s63 offen offset:0 sc1
    v_lshrrev_b32 v140, 16, v148
    v_lshrrev_b32 v141, 16, v149
    v_lshrrev_b32 v142, 16, v150
    v_lshrrev_b32 v143, 16, v151
    v_lshrrev_b32 v144, 16, v152
    v_lshrrev_b32 v145, 16, v153
    v_lshrrev_b32 v146, 16, v154
    buffer_load_dwordx4 a[136:139], v4, s[40:43], s63 offen offset:1024 sc1
    v_lshrrev_b32 v147, 16, v155
    v_dot2_f32_bf16 v128, v42, v140, 0
    v_dot2_f32_bf16 v129, v42, v148, 0
    v_dot2_f32_bf16 v130, v43, v140, 0
    v_dot2_f32_bf16 v131, v43, v148, 0
    v_dot2_f32_bf16 v132, v32, v140, 0
    buffer_load_dwordx4 a[144:147], v4, s[40:43], s63 offen offset:2048 sc1
    v_dot2_f32_bf16 v133, v32, v148, 0
    v_dot2_f32_bf16 v134, v33, v140, 0
    v_dot2_f32_bf16 v135, v33, v148, 0
    v_dot2_f32_bf16 v136, v34, v140, 0
    v_dot2_f32_bf16 v137, v34, v148, 0
    v_dot2_f32_bf16 v138, v35, v140, 0
    v_dot2_f32_bf16 v139, v35, v148, 0
    buffer_load_dwordx4 a[152:155], v4, s[40:43], s63 offen offset:3072 sc1
    s_xor_b32 s63, s63, 4096
    v_dot2_f32_bf16 v156, v36, v140, 0
    v_dot2_f32_bf16 v157, v36, v148, 0
    v_dot2_f32_bf16 v158, v37, v140, 0
    v_dot2_f32_bf16 v159, v37, v148, 0
    v_dot2_f32_bf16 v17, v38, v140, 0
    v_dot2_f32_bf16 v18, v38, v148, 0
    v_dot2c_f32_bf16 v128, v54, v141
    s_waitcnt vmcnt(8)
    v_cmp_gt_u32 vcc, 2, v3
    s_nop 1
    s_and_b64 vcc, vcc, exec
    s_cbranch_scc1 SPIN_CTX
BACK_CTX:
    buffer_load_dwordx4 a[4:7], v5, s[40:43], s20 offen offset:0 sc1
    v_dot2c_f32_bf16 v129, v54, v149
    v_dot2c_f32_bf16 v130, v55, v141
    v_dot2c_f32_bf16 v131, v55, v149
    v_dot2c_f32_bf16 v132, v44, v141
    v_dot2c_f32_bf16 v133, v44, v149
    v_dot2c_f32_bf16 v134, v45, v141
    v_dot2c_f32_bf16 v135, v45, v149
    v_dot2c_f32_bf16 v136, v46, v141
    v_dot2c_f32_bf16 v137, v46, v149
    v_dot2c_f32_bf16 v138, v47, v141
    v_dot2c_f32_bf16 v139, v47, v149
    v_dot2c_f32_bf16 v156, v48, v141
    v_dot2c_f32_bf16 v157, v48, v149
    buffer_load_dwordx4 a[12:15], v5, s[40:43], s20 offen offset:1024 sc1
    v_dot2c_f32_bf16 v158, v49, v141
    v_dot2c_f32_bf16 v159, v49, v149
    v_dot2c_f32_bf16 v17, v50, v141
    v_dot2c_f32_bf16 v18, v50, v149
    v_dot2c_f32_bf16 v128, v66, v142
    v_dot2c_f32_bf16 v129, v66, v150
    v_dot2c_f32_bf16 v130, v67, v142
    v_dot2c_f32_bf16 v131, v67, v150
    v_dot2c_f32_bf16 v132, v56, v142
    v_dot2c_f32_bf16 v133, v56, v150
    v_dot2c_f32_bf16 v134, v57, v142
    v_dot2c_f32_bf16 v135, v57, v150
    v_dot2c_f32_bf16 v136, v58, v142
    v_dot2c_f32_bf16 v137, v58, v150
    buffer_load_dwordx4 a[20:23], v5, s[40:43], s20 offen offset:2048 sc1
    v_dot2c_f32_bf16 v138, v59, v142
    v_dot2c_f32_bf16 v139, v59, v150
    v_dot2c_f32_bf16 v156, v60, v142
    v_dot2c_f32_bf16 v157, v60, v150
    v_dot2c_f32_bf16 v158, v61, v142
    v_dot2c_f32_bf16 v159, v61, v150
    v_dot2c_f32_bf16 v17, v62, v142
    v_dot2c_f32_bf16 v18, v62, v150
    v_dot2c_f32_bf16 v128, v78, v143
    v_dot2c_f32_bf16 v129, v78, v151
    v_dot2c_f32_bf16 v130, v79, v143
    v_dot2c_f32_bf16 v131, v79, v151
    v_dot2c_f32_bf16 v132, v68, v143
    v_dot2c_f32_bf16 v133, v68, v151
    buffer_load_dwordx4 a[28:31], v5, s[40:43], s20 offen offset:3072 sc1
    v_dot2c_f32_bf16 v134, v69, v143
    v_dot2c_f32_bf16 v135, v69, v151
    v_dot2c_f32_bf16 v136, v70, v143
    v_dot2c_f32_bf16 v137, v70, v151
    v_dot2c_f32_bf16 v138, v71, v143
    v_dot2c_f32_bf16 v139, v71, v151
    v_dot2c_f32_bf16 v156, v72, v143
    v_dot2c_f32_bf16 v157, v72, v151
    v_dot2c_f32_bf16 v158, v73, v143
    v_dot2c_f32_bf16 v159, v73, v151
    v_dot2c_f32_bf16 v17, v74, v143
    v_dot2c_f32_bf16 v18, v74, v151
    v_dot2c_f32_bf16 v128, v90, v144
    v_dot2c_f32_bf16 v129, v90, v152
    s_xor_b32 s20, s20, 4096
    buffer_load_dwordx4 a[36:39], v5, s[40:43], s20 offen offset:0 sc1
    v_dot2c_f32_bf16 v130, v91, v144
    v_dot2c_f32_bf16 v131, v91, v152
    s_waitcnt lgkmcnt(0)
    v_dot2c_f32_bf16 v132, v80, v144
    v_dot2c_f32_bf16 v133, v80, v152
    v_dot2c_f32_bf16 v134, v81, v144
    v_dot2c_f32_bf16 v135, v81, v152
    v_dot2c_f32_bf16 v136, v82, v144
    v_dot2c_f32_bf16 v137, v82, v152
    v_dot2c_f32_bf16 v138, v83, v144
    v_dot2c_f32_bf16 v139, v83, v152
    v_dot2c_f32_bf16 v156, v84, v144
    v_dot2c_f32_bf16 v157, v84, v152
    v_dot2c_f32_bf16 v158, v85, v144
    buffer_load_dwordx4 a[44:47], v5, s[40:43], s20 offen offset:1024 sc1
    v_dot2c_f32_bf16 v159, v85, v152
    v_dot2c_f32_bf16 v17, v86, v144
    v_dot2c_f32_bf16 v18, v86, v152
    v_dot2c_f32_bf16 v128, v102, v145
    v_dot2c_f32_bf16 v129, v102, v153
    v_dot2c_f32_bf16 v130, v103, v145
    v_dot2c_f32_bf16 v131, v103, v153
    v_dot2c_f32_bf16 v132, v92, v145
    v_dot2c_f32_bf16 v133, v92, v153
    v_dot2c_f32_bf16 v134, v93, v145
    v_dot2c_f32_bf16 v135, v93, v153
    v_dot2c_f32_bf16 v136, v94, v145
    v_dot2c_f32_bf16 v137, v94, v153
    v_dot2c_f32_bf16 v138, v95, v145
    buffer_load_dwordx4 a[52:55], v5, s[40:43], s20 offen offset:2048 sc1
    v_dot2c_f32_bf16 v139, v95, v153
    v_dot2c_f32_bf16 v156, v96, v145
    v_dot2c_f32_bf16 v157, v96, v153
    v_dot2c_f32_bf16 v158, v97, v145
    v_dot2c_f32_bf16 v159, v97, v153
    v_dot2c_f32_bf16 v17, v98, v145
    v_dot2c_f32_bf16 v18, v98, v153
    v_dot2c_f32_bf16 v128, v114, v146
    v_dot2c_f32_bf16 v129, v114, v154
    v_dot2c_f32_bf16 v130, v115, v146
    v_dot2c_f32_bf16 v131, v115, v154
    v_dot2c_f32_bf16 v132, v104, v146
    v_dot2c_f32_bf16 v133, v104, v154
    v_dot2c_f32_bf16 v134, v105, v146
    buffer_load_dwordx4 a[60:63], v5, s[40:43], s20 offen offset:3072 sc1
    s_xor_b32 s20, s20, 12288
    v_dot2c_f32_bf16 v135, v105, v154
    v_dot2c_f32_bf16 v136, v106, v146
    v_dot2c_f32_bf16 v137, v106, v154
    v_dot2c_f32_bf16 v138, v107, v146
    v_dot2c_f32_bf16 v139, v107, v154
    v_dot2c_f32_bf16 v156, v108, v146
    v_dot2c_f32_bf16 v157, v108, v154
    v_dot2c_f32_bf16 v158, v109, v146
    v_dot2c_f32_bf16 v159, v109, v154
    v_dot2c_f32_bf16 v17, v110, v146
    v_dot2c_f32_bf16 v18, v110, v154
    v_dot2c_f32_bf16 v128, v126, v147
    v_dot2c_f32_bf16 v129, v126, v155
    v_dot2c_f32_bf16 v130, v127, v147
    v_dot2c_f32_bf16 v131, v127, v155
    v_dot2c_f32_bf16 v132, v116, v147
    v_dot2c_f32_bf16 v133, v116, v155
    v_dot2c_f32_bf16 v134, v117, v147
    v_dot2c_f32_bf16 v135, v117, v155
    v_dot2c_f32_bf16 v136, v118, v147
    v_dot2c_f32_bf16 v137, v118, v155
    v_dot2c_f32_bf16 v138, v119, v147
    v_dot2c_f32_bf16 v139, v119, v155
    v_dot2c_f32_bf16 v156, v120, v147
    v_dot2c_f32_bf16 v157, v120, v155
    v_dot2c_f32_bf16 v158, v121, v147
    v_dot2c_f32_bf16 v159, v121, v155
    v_dot2c_f32_bf16 v17, v122, v147
    v_dot2c_f32_bf16 v18, v122, v155
    v_mov_b32 v89, 0
    v_mov_b32 v90, 0
    v_mov_b32 v91, 0
    v_cvt_pk_bf16_f32 v80, v128, v129
    v_cvt_pk_bf16_f32 v81, v130, v131
    v_cvt_pk_bf16_f32 v82, v132, v133
    v_cvt_pk_bf16_f32 v83, v134, v135
    v_cvt_pk_bf16_f32 v84, v136, v137
    v_cvt_pk_bf16_f32 v85, v138, v139
    v_cvt_pk_bf16_f32 v86, v156, v157
    v_cvt_pk_bf16_f32 v87, v158, v159
    v_cvt_pk_bf16_f32 v88, v17, v18
    v_cmp_gt_u32 vcc, 1, v28
    s_nop 1
    s_and_b64 vcc, vcc, exec
    s_cbranch_scc1 SPIN_ALL
BACK_ALL:
    s_waitcnt vmcnt(4)
    s_barrier
    ds_read_b128 v[104:107], v11 offset:0
    ds_read_b128 v[108:111], v11 offset:8192
    ds_read_b128 v[112:115], v11 offset:16384
    ds_read_b128 v[116:119], v11 offset:24576
    s_waitcnt lgkmcnt(3)
    v_mfma_f32_16x16x32_bf16 v[176:179], v[104:107], a[0:3], 0
    s_lshl3_add_u32 s98, 1, s5
    ds_read_b128 v[120:123], v11 offset:1024
    ds_read_b128 v[124:127], v11 offset:9216
    s_waitcnt lgkmcnt(4)
    v_mfma_f32_16x16x32_bf16 v[176:179], v[108:111], a[8:11], v[176:179]
    s_and_b32 s98, s98, 31
    buffer_load_dwordx4 a[68:71], v5, s[40:43], s20 offen offset:0 sc1
    s_waitcnt lgkmcnt(3)
    v_mfma_f32_16x16x32_bf16 v[176:179], v[112:115], a[16:19], v[176:179]
    s_lshl_b32 s8, s6, 5
    ds_read_b128 v[128:131], v11 offset:17408
    ds_read_b128 v[132:135], v11 offset:25600
    s_waitcnt lgkmcnt(4)
    v_mfma_f32_16x16x32_bf16 v[176:179], v[116:119], a[24:27], v[176:179]
    s_add_u32 s98, s98, s8
    ds_read_b128 v[136:139], v11 offset:2048
    v_mov_b32 v16, 0x44444444
    v_mfma_f32_16x16x32_bf16 v[180:183], v[104:107], a[4:7], 0
    s_mul_i32 s98, s98, 3
    buffer_load_dwordx4 a[76:79], v5, s[40:43], s20 offen offset:1024 sc1
    v_mfma_f32_16x16x32_bf16 v[180:183], v[108:111], a[12:15], v[180:183]
    s_sub_u32 s98, s98, 1
    ds_read_b128 v[140:143], v11 offset:10240
    ds_read_b128 v[144:147], v11 offset:18432
    v_mfma_f32_16x16x32_bf16 v[180:183], v[112:115], a[20:23], v[180:183]
    s_add_u32 s98, s98, 3
    ds_read_b128 v[148:151], v11 offset:26624
    v_mfma_f32_16x16x32_bf16 v[180:183], v[116:119], a[28:31], v[180:183]
    s_lshl2_add_u32 s98, s98, s4
    ds_read_b128 v[104:107], v11 offset:3072
    s_waitcnt lgkmcnt(5)
    v_mfma_f32_16x16x32_bf16 v[184:187], v[120:123], a[0:3], 0
    s_mul_i32 s8, s98, 3072
    buffer_load_dwordx4 a[84:87], v5, s[40:43], s20 offen offset:2048 sc1
    v_mfma_f32_16x16x32_bf16 v[184:187], v[124:127], a[8:11], v[184:187]
    s_lshl3_add_u32 s98, 2, s5
    ds_read_b128 v[108:111], v11 offset:11264
    ds_read_b128 v[112:115], v11 offset:19456
    v_mfma_f32_16x16x32_bf16 v[184:187], v[128:131], a[16:19], v[184:187]
    s_and_b32 s98, s98, 31
    ds_read_b128 v[116:119], v11 offset:27648
    v_mfma_f32_16x16x32_bf16 v[184:187], v[132:135], a[24:27], v[184:187]
    s_lshl_b32 s9, s6, 5
    v_mfma_f32_16x16x32_bf16 v[188:191], v[120:123], a[4:7], 0
    s_add_u32 s98, s98, s9
    buffer_load_dwordx4 a[92:95], v5, s[40:43], s20 offen offset:3072 sc1
    v_mfma_f32_16x16x32_bf16 v[188:191], v[124:127], a[12:15], v[188:191]
    s_xor_b32 s20, s20, 4096
    ds_read_b128 v[120:123], v11 offset:4096
    ds_read_b128 v[124:127], v11 offset:12288
    v_mfma_f32_16x16x32_bf16 v[188:191], v[128:131], a[20:23], v[188:191]
    s_mul_i32 s98, s98, 3
    ds_read_b128 v[128:131], v11 offset:20480
    v_mfma_f32_16x16x32_bf16 v[188:191], v[132:135], a[28:31], v[188:191]
    s_sub_u32 s98, s98, 2
    ds_read_b128 v[132:135], v11 offset:28672
    s_waitcnt lgkmcnt(4)
    v_mfma_f32_16x16x32_bf16 v[192:195], v[136:139], a[0:3], 0
    s_add_u32 s98, s98, 3
    buffer_store_dwordx4 v[80:83], v15, s[40:43], s71 offen offset:0 sc1
    v_mfma_f32_16x16x32_bf16 v[192:195], v[140:143], a[8:11], v[192:195]
    s_lshl2_add_u32 s98, s98, s4
    v_mfma_f32_16x16x32_bf16 v[192:195], v[144:147], a[16:19], v[192:195]
    s_mul_i32 s9, s98, 3072
    v_mfma_f32_16x16x32_bf16 v[192:195], v[148:151], a[24:27], v[192:195]
    s_lshl3_add_u32 s98, 3, s5
    v_mfma_f32_16x16x32_bf16 v[196:199], v[136:139], a[4:7], 0
    s_and_b32 s98, s98, 31
    ds_read_b128 v[136:139], v11 offset:5120
    v_mfma_f32_16x16x32_bf16 v[196:199], v[140:143], a[12:15], v[196:199]
    s_lshl_b32 s10, s6, 5
    buffer_store_dwordx4 v[84:87], v15, s[40:43], s71 offen offset:256 sc1
    v_mfma_f32_16x16x32_bf16 v[196:199], v[144:147], a[20:23], v[196:199]
    s_add_u32 s98, s98, s10
    ds_read_b128 v[140:143], v11 offset:13312
    ds_read_b128 v[144:147], v11 offset:21504
    v_mfma_f32_16x16x32_bf16 v[196:199], v[148:151], a[28:31], v[196:199]
    s_mul_i32 s98, s98, 3
    ds_read_b128 v[148:151], v11 offset:29696
    v_mfma_f32_16x16x32_bf16 v[200:203], v[104:107], a[0:3], 0
    s_sub_u32 s98, s98, 3
    v_mfma_f32_16x16x32_bf16 v[200:203], v[108:111], a[8:11], v[200:203]
    s_add_u32 s98, s98, 3
    buffer_store_dwordx4 v[88:91], v15, s[40:43], s70 offen offset:0 sc1
    v_mfma_f32_16x16x32_bf16 v[200:203], v[112:115], a[16:19], v[200:203]
    s_xor_b32 s21, s3, 3
    v_mfma_f32_16x16x32_bf16 v[200:203], v[116:119], a[24:27], v[200:203]
    s_lshl2_add_u32 s21, s21, s4
    v_mfma_f32_16x16x32_bf16 v[204:207], v[104:107], a[4:7], 0
    s_mul_i32 s21, s21, 36864
    ds_read_b128 v[104:107], v11 offset:6144
    v_mfma_f32_16x16x32_bf16 v[204:207], v[108:111], a[12:15], v[204:207]
    s_add_u32 s21, s21, s28
    s_mov_b32 m0, s47
    ds_read_b128 v[108:111], v11 offset:14336
    v_mfma_f32_16x16x32_bf16 v[204:207], v[112:115], a[20:23], v[204:207]
    s_lshl2_add_u32 s98, s98, s4
    buffer_load_dwordx4 v1, s[56:59], s21 offen sc1 lds
    v_mfma_f32_16x16x32_bf16 v[204:207], v[116:119], a[28:31], v[204:207]
    s_mul_i32 s10, s98, 3072
    ds_read_b128 v[112:115], v11 offset:22528
    ds_read_b128 v[116:119], v11 offset:30720
    s_waitcnt lgkmcnt(4)
    v_mfma_f32_16x16x32_bf16 v[208:211], v[120:123], a[0:3], 0
    s_sub_u32 s99, s4, s61
    v_mfma_f32_16x16x32_bf16 v[208:211], v[124:127], a[8:11], v[208:211]
    s_and_b32 s99, s99, 3
    buffer_load_dwordx4 v1, s[56:59], s21 offen offset:1024 sc1 lds
    v_mfma_f32_16x16x32_bf16 v[208:211], v[128:131], a[16:19], v[208:211]
    s_lshl3_add_u32 s98, s99, s5
    v_mfma_f32_16x16x32_bf16 v[208:211], v[132:135], a[24:27], v[208:211]
    s_and_b32 s98, s98, 31
    v_mfma_f32_16x16x32_bf16 v[212:215], v[120:123], a[4:7], 0
    s_lshl_b32 s11, s6, 5
    ds_read_b128 v[120:123], v12 offset:0
    v_mfma_f32_16x16x32_bf16 v[212:215], v[124:127], a[12:15], v[212:215]
    s_add_u32 s98, s98, s11
    buffer_load_dwordx4 v1, s[56:59], s21 offen offset:2048 sc1 lds
    v_mfma_f32_16x16x32_bf16 v[212:215], v[128:131], a[20:23], v[212:215]
    s_mul_i32 s98, s98, 3
    ds_read_b128 v[124:127], v12 offset:8192
    ds_read_b128 v[128:131], v12 offset:16384
    v_mfma_f32_16x16x32_bf16 v[212:215], v[132:135], a[28:31], v[212:215]
    s_sub_u32 s98, s98, s99
    ds_read_b128 v[132:135], v12 offset:24576
    v_mfma_f32_16x16x32_bf16 v[216:219], v[136:139], a[0:3], 0
    s_add_u32 s98, s98, 3
    v_mfma_f32_16x16x32_bf16 v[216:219], v[140:143], a[8:11], v[216:219]
    s_lshl2_add_u32 s98, s98, s4
    v_mfma_f32_16x16x32_bf16 v[216:219], v[144:147], a[16:19], v[216:219]
    s_mul_i32 s11, s98, 3072
    buffer_load_dwordx4 v1, s[56:59], s21 offen offset:3072 sc1 lds
    v_mfma_f32_16x16x32_bf16 v[216:219], v[148:151], a[24:27], v[216:219]
    s_waitcnt vmcnt(11)
    v_mfma_f32_16x16x32_bf16 v[220:223], v[136:139], a[4:7], 0
    s_add_u32 s21, s21, 4096
    ds_read_b128 v[136:139], v12 offset:1024
    v_mfma_f32_16x16x32_bf16 v[220:223], v[140:143], a[12:15], v[220:223]
    s_add_u32 m0, s47, 4096
    ds_read_b128 v[140:143], v12 offset:9216
    v_mfma_f32_16x16x32_bf16 v[220:223], v[144:147], a[20:23], v[220:223]
    buffer_load_dwordx4 v1, s[56:59], s21 offen sc1 lds
    v_mfma_f32_16x16x32_bf16 v[220:223], v[148:151], a[28:31], v[220:223]
    s_waitcnt lgkmcnt(2)
    ds_read_b128 v[144:147], v12 offset:17408
    ds_read_b128 v[148:151], v12 offset:25600
    v_mfma_f32_16x16x32_bf16 v[224:227], v[104:107], a[0:3], 0
    s_cmp_eq_u32 s99, 0
    s_cselect_b32 s11, 1073741824, s11
    v_mfma_f32_16x16x32_bf16 v[224:227], v[108:111], a[8:11], v[224:227]
    v_mfma_f32_16x16x32_bf16 v[224:227], v[112:115], a[16:19], v[224:227]
    buffer_load_dwordx4 v1, s[56:59], s21 offen offset:1024 sc1 lds
    v_mfma_f32_16x16x32_bf16 v[224:227], v[116:119], a[24:27], v[224:227]
    v_mfma_f32_16x16x32_bf16 v[228:231], v[104:107], a[4:7], 0
    ds_read_b128 v[104:107], v12 offset:2048
    v_mfma_f32_16x16x32_bf16 v[228:231], v[108:111], a[12:15], v[228:231]
    ds_read_b128 v[108:111], v12 offset:10240
    v_mfma_f32_16x16x32_bf16 v[228:231], v[112:115], a[20:23], v[228:231]
    buffer_load_dwordx4 v1, s[56:59], s21 offen offset:2048 sc1 lds
    v_mfma_f32_16x16x32_bf16 v[228:231], v[116:119], a[28:31], v[228:231]
    ds_read_b128 v[112:115], v12 offset:18432
    ds_read_b128 v[116:119], v12 offset:26624
    v_mfma_f32_16x16x32_bf16 v[176:179], v[120:123], a[32:35], v[176:179]
    v_mfma_f32_16x16x32_bf16 v[176:179], v[124:127], a[40:43], v[176:179]
    v_mfma_f32_16x16x32_bf16 v[176:179], v[128:131], a[48:51], v[176:179]
    buffer_load_dwordx4 a[100:103], v5, s[40:43], s20 offen offset:0 sc1
    v_mfma_f32_16x16x32_bf16 v[176:179], v[132:135], a[56:59], v[176:179]
    v_mfma_f32_16x16x32_bf16 v[180:183], v[120:123], a[36:39], v[180:183]
    ds_read_b128 v[120:123], v12 offset:3072
    v_mfma_f32_16x16x32_bf16 v[180:183], v[124:127], a[44:47], v[180:183]
    ds_read_b128 v[124:127], v12 offset:11264
    v_mfma_f32_16x16x32_bf16 v[180:183], v[128:131], a[52:55], v[180:183]
    ds_read_b128 v[128:131], v12 offset:19456
    v_mfma_f32_16x16x32_bf16 v[180:183], v[132:135], a[60:63], v[180:183]
    s_waitcnt lgkmcnt(3)
    buffer_load_dwordx4 a[108:111], v5, s[40:43], s20 offen offset:1024 sc1
    v_mfma_f32_16x16x32_bf16 v[184:187], v[136:139], a[32:35], v[184:187]
    ds_read_b128 v[132:135], v12 offset:27648
    v_mfma_f32_16x16x32_bf16 v[184:187], v[140:143], a[40:43], v[184:187]
    v_mfma_f32_16x16x32_bf16 v[184:187], v[144:147], a[48:51], v[184:187]
    v_mfma_f32_16x16x32_bf16 v[184:187], v[148:151], a[56:59], v[184:187]
    buffer_load_dwordx4 a[116:119], v5, s[40:43], s20 offen offset:2048 sc1
    v_mfma_f32_16x16x32_bf16 v[188:191], v[136:139], a[36:39], v[188:191]
    ds_read_b128 v[136:139], v12 offset:4096
    v_mfma_f32_16x16x32_bf16 v[188:191], v[140:143], a[44:47], v[188:191]
    ds_read_b128 v[140:143], v12 offset:12288
    v_mfma_f32_16x16x32_bf16 v[188:191], v[144:147], a[52:55], v[188:191]
    ds_read_b128 v[144:147], v12 offset:20480
    v_mfma_f32_16x16x32_bf16 v[188:191], v[148:151], a[60:63], v[188:191]
    buffer_load_dwordx4 a[124:127], v5, s[40:43], s20 offen offset:3072 sc1
    v_mfma_f32_16x16x32_bf16 v[192:195], v[104:107], a[32:35], v[192:195]
    s_xor_b32 s21, s3, 4
    ds_read_b128 v[148:151], v12 offset:28672
    v_mfma_f32_16x16x32_bf16 v[192:195], v[108:111], a[40:43], v[192:195]
    s_lshl2_add_u32 s21, s21, s4
    v_mfma_f32_16x16x32_bf16 v[192:195], v[112:115], a[48:51], v[192:195]
    s_mul_i32 s21, s21, 36864
    v_mfma_f32_16x16x32_bf16 v[192:195], v[116:119], a[56:59], v[192:195]
    s_add_u32 s21, s21, s28
    s_mov_b32 m0, s79
    v_mfma_f32_16x16x32_bf16 v[196:199], v[104:107], a[36:39], v[196:199]
    s_xor_b32 s20, s20, 28672
    buffer_load_dwordx4 v1, s[56:59], s21 offen sc1 lds
    v_mfma_f32_16x16x32_bf16 v[196:199], v[108:111], a[44:47], v[196:199]
    ds_read_b128 v[104:107], v12 offset:5120
    ds_read_b128 v[108:111], v12 offset:13312
    v_mfma_f32_16x16x32_bf16 v[196:199], v[112:115], a[52:55], v[196:199]
    ds_read_b128 v[112:115], v12 offset:21504
    v_mfma_f32_16x16x32_bf16 v[196:199], v[116:119], a[60:63], v[196:199]
    s_waitcnt lgkmcnt(3)
    buffer_load_dwordx4 v1, s[56:59], s21 offen offset:1024 sc1 lds
    v_mfma_f32_16x16x32_bf16 v[200:203], v[120:123], a[32:35], v[200:203]
    ds_read_b128 v[116:119], v12 offset:29696
    v_mfma_f32_16x16x32_bf16 v[200:203], v[124:127], a[40:43], v[200:203]
    v_mfma_f32_16x16x32_bf16 v[200:203], v[128:131], a[48:51], v[200:203]
    v_mfma_f32_16x16x32_bf16 v[200:203], v[132:135], a[56:59], v[200:203]
    v_mfma_f32_16x16x32_bf16 v[204:207], v[120:123], a[36:39], v[204:207]
    buffer_load_dwordx4 v1, s[56:59], s21 offen offset:2048 sc1 lds
    v_mfma_f32_16x16x32_bf16 v[204:207], v[124:127], a[44:47], v[204:207]
    ds_read_b128 v[120:123], v12 offset:6144
    ds_read_b128 v[124:127], v12 offset:14336
    v_mfma_f32_16x16x32_bf16 v[204:207], v[128:131], a[52:55], v[204:207]
    ds_read_b128 v[128:131], v12 offset:22528
    v_mfma_f32_16x16x32_bf16 v[204:207], v[132:135], a[60:63], v[204:207]
    ds_read_b128 v[132:135], v12 offset:30720
    v_mfma_f32_16x16x32_bf16 v[208:211], v[136:139], a[32:35], v[208:211]
    buffer_load_dwordx4 v1, s[56:59], s21 offen offset:3072 sc1 lds
    v_mfma_f32_16x16x32_bf16 v[208:211], v[140:143], a[40:43], v[208:211]
    s_add_u32 s21, s21, 4096
    v_mfma_f32_16x16x32_bf16 v[208:211], v[144:147], a[48:51], v[208:211]
    s_add_u32 m0, s79, 4096
    v_mfma_f32_16x16x32_bf16 v[208:211], v[148:151], a[56:59], v[208:211]
    v_mfma_f32_16x16x32_bf16 v[212:215], v[136:139], a[36:39], v[212:215]
    buffer_load_dwordx4 v1, s[56:59], s21 offen sc1 lds
    v_mfma_f32_16x16x32_bf16 v[212:215], v[140:143], a[44:47], v[212:215]
    ds_read_b128 v[136:139], v13 offset:0
    ds_read_b128 v[140:143], v13 offset:8192
    v_mfma_f32_16x16x32_bf16 v[212:215], v[144:147], a[52:55], v[212:215]
    ds_read_b128 v[144:147], v13 offset:16384
    v_mfma_f32_16x16x32_bf16 v[212:215], v[148:151], a[60:63], v[212:215]
    s_waitcnt lgkmcnt(3)
    ds_read_b128 v[148:151], v13 offset:24576
    v_mfma_f32_16x16x32_bf16 v[216:219], v[104:107], a[32:35], v[216:219]
    buffer_load_dwordx4 v1, s[56:59], s21 offen offset:1024 sc1 lds
    v_mfma_f32_16x16x32_bf16 v[216:219], v[108:111], a[40:43], v[216:219]
    v_mfma_f32_16x16x32_bf16 v[216:219], v[112:115], a[48:51], v[216:219]
    v_mfma_f32_16x16x32_bf16 v[216:219], v[116:119], a[56:59], v[216:219]
    s_waitcnt vmcnt(20)
    s_barrier
    v_mfma_f32_16x16x32_bf16 v[220:223], v[104:107], a[36:39], v[220:223]
    buffer_load_dwordx4 v1, s[56:59], s21 offen offset:2048 sc1 lds
    v_mfma_f32_16x16x32_bf16 v[220:223], v[108:111], a[44:47], v[220:223]
    ds_read_b128 v[104:107], v13 offset:1024
    ds_read_b128 v[108:111], v13 offset:9216
    v_mfma_f32_16x16x32_bf16 v[220:223], v[112:115], a[52:55], v[220:223]
    ds_read_b128 v[112:115], v13 offset:17408
    v_mfma_f32_16x16x32_bf16 v[220:223], v[116:119], a[60:63], v[220:223]
    ds_read_b128 v[116:119], v13 offset:25600
    v_mfma_f32_16x16x32_bf16 v[224:227], v[120:123], a[32:35], v[224:227]
    v_mfma_f32_16x16x32_bf16 v[224:227], v[124:127], a[40:43], v[224:227]
    buffer_load_dwordx4 a[132:135], v5, s[40:43], s20 offen offset:0 sc1
    v_mfma_f32_16x16x32_bf16 v[224:227], v[128:131], a[48:51], v[224:227]
    v_mfma_f32_16x16x32_bf16 v[224:227], v[132:135], a[56:59], v[224:227]
    v_mfma_f32_16x16x32_bf16 v[228:231], v[120:123], a[36:39], v[228:231]
    ds_read_b128 v[120:123], v13 offset:2048
    v_mfma_f32_16x16x32_bf16 v[228:231], v[124:127], a[44:47], v[228:231]
    buffer_load_dwordx4 a[140:143], v5, s[40:43], s20 offen offset:1024 sc1
    v_mfma_f32_16x16x32_bf16 v[228:231], v[128:131], a[52:55], v[228:231]
    ds_read_b128 v[124:127], v13 offset:10240
    ds_read_b128 v[128:131], v13 offset:18432
    v_mfma_f32_16x16x32_bf16 v[228:231], v[132:135], a[60:63], v[228:231]
    s_waitcnt lgkmcnt(3)
    ds_read_b128 v[132:135], v13 offset:26624
    v_mfma_f32_16x16x32_bf16 v[176:179], v[136:139], a[64:67], v[176:179]
    v_mfma_f32_16x16x32_bf16 v[176:179], v[140:143], a[72:75], v[176:179]
    buffer_load_dwordx4 a[148:151], v5, s[40:43], s20 offen offset:2048 sc1
    v_mfma_f32_16x16x32_bf16 v[176:179], v[144:147], a[80:83], v[176:179]
    v_mfma_f32_16x16x32_bf16 v[176:179], v[148:151], a[88:91], v[176:179]
    v_mfma_f32_16x16x32_bf16 v[180:183], v[136:139], a[68:71], v[180:183]
    ds_read_b128 v[136:139], v13 offset:3072
    v_mfma_f32_16x16x32_bf16 v[180:183], v[140:143], a[76:79], v[180:183]
    buffer_load_dwordx4 a[156:159], v5, s[40:43], s20 offen offset:3072 sc1
    v_mfma_f32_16x16x32_bf16 v[180:183], v[144:147], a[84:87], v[180:183]
    s_xor_b32 s21, s3, 5
    ds_read_b128 v[140:143], v13 offset:11264
    ds_read_b128 v[144:147], v13 offset:19456
    v_mfma_f32_16x16x32_bf16 v[180:183], v[148:151], a[92:95], v[180:183]
    s_lshl2_add_u32 s21, s21, s4
    ds_read_b128 v[148:151], v13 offset:27648
    v_mfma_f32_16x16x32_bf16 v[184:187], v[104:107], a[64:67], v[184:187]
    s_mul_i32 s21, s21, 36864
    v_mfma_f32_16x16x32_bf16 v[184:187], v[108:111], a[72:75], v[184:187]
    s_add_u32 s21, s21, s28
    s_mov_b32 m0, s44
    v_mfma_f32_16x16x32_bf16 v[184:187], v[112:115], a[80:83], v[184:187]
    s_xor_b32 s20, s20, 4096
    buffer_load_dwordx4 v1, s[56:59], s21 offen sc1 lds
    v_mfma_f32_16x16x32_bf16 v[184:187], v[116:119], a[88:91], v[184:187]
    v_mfma_f32_16x16x32_bf16 v[188:191], v[104:107], a[68:71], v[188:191]
    ds_read_b128 v[104:107], v13 offset:4096
    v_mfma_f32_16x16x32_bf16 v[188:191], v[108:111], a[76:79], v[188:191]
    ds_read_b128 v[108:111], v13 offset:12288
    v_mfma_f32_16x16x32_bf16 v[188:191], v[112:115], a[84:87], v[188:191]
    buffer_load_dwordx4 v1, s[56:59], s21 offen offset:1024 sc1 lds
    v_mfma_f32_16x16x32_bf16 v[188:191], v[116:119], a[92:95], v[188:191]
    s_waitcnt lgkmcnt(2)
    ds_read_b128 v[112:115], v13 offset:20480
    ds_read_b128 v[116:119], v13 offset:28672
    v_mfma_f32_16x16x32_bf16 v[192:195], v[120:123], a[64:67], v[192:195]
    v_mfma_f32_16x16x32_bf16 v[192:195], v[124:127], a[72:75], v[192:195]
    v_mfma_f32_16x16x32_bf16 v[192:195], v[128:131], a[80:83], v[192:195]
    buffer_load_dwordx4 v1, s[56:59], s21 offen offset:2048 sc1 lds
    v_mfma_f32_16x16x32_bf16 v[192:195], v[132:135], a[88:91], v[192:195]
    v_mfma_f32_16x16x32_bf16 v[196:199], v[120:123], a[68:71], v[196:199]
    ds_read_b128 v[120:123], v13 offset:5120
    v_mfma_f32_16x16x32_bf16 v[196:199], v[124:127], a[76:79], v[196:199]
    ds_read_b128 v[124:127], v13 offset:13312
    v_mfma_f32_16x16x32_bf16 v[196:199], v[128:131], a[84:87], v[196:199]
    buffer_load_dwordx4 v1, s[56:59], s21 offen offset:3072 sc1 lds
    v_mfma_f32_16x16x32_bf16 v[196:199], v[132:135], a[92:95], v[196:199]
    s_add_u32 s21, s21, 4096
    ds_read_b128 v[128:131], v13 offset:21504
    ds_read_b128 v[132:135], v13 offset:29696
    v_mfma_f32_16x16x32_bf16 v[200:203], v[136:139], a[64:67], v[200:203]
    s_add_u32 m0, s44, 4096
    v_mfma_f32_16x16x32_bf16 v[200:203], v[140:143], a[72:75], v[200:203]
    v_mfma_f32_16x16x32_bf16 v[200:203], v[144:147], a[80:83], v[200:203]
    buffer_load_dwordx4 v1, s[56:59], s21 offen sc1 lds
    v_mfma_f32_16x16x32_bf16 v[200:203], v[148:151], a[88:91], v[200:203]
    v_mfma_f32_16x16x32_bf16 v[204:207], v[136:139], a[68:71], v[204:207]
    ds_read_b128 v[136:139], v13 offset:6144
    v_mfma_f32_16x16x32_bf16 v[204:207], v[140:143], a[76:79], v[204:207]
    ds_read_b128 v[140:143], v13 offset:14336
    v_mfma_f32_16x16x32_bf16 v[204:207], v[144:147], a[84:87], v[204:207]
    buffer_load_dwordx4 v1, s[56:59], s21 offen offset:1024 sc1 lds
    v_mfma_f32_16x16x32_bf16 v[204:207], v[148:151], a[92:95], v[204:207]
    s_waitcnt lgkmcnt(2)
    ds_read_b128 v[144:147], v13 offset:22528
    ds_read_b128 v[148:151], v13 offset:30720
    v_mfma_f32_16x16x32_bf16 v[208:211], v[104:107], a[64:67], v[208:211]
    v_mfma_f32_16x16x32_bf16 v[208:211], v[108:111], a[72:75], v[208:211]
    v_mfma_f32_16x16x32_bf16 v[208:211], v[112:115], a[80:83], v[208:211]
    v_mfma_f32_16x16x32_bf16 v[208:211], v[116:119], a[88:91], v[208:211]
    buffer_load_dwordx4 v1, s[56:59], s21 offen offset:2048 sc1 lds
    v_mfma_f32_16x16x32_bf16 v[212:215], v[104:107], a[68:71], v[212:215]
    v_mfma_f32_16x16x32_bf16 v[212:215], v[108:111], a[76:79], v[212:215]
    v_mfma_f32_16x16x32_bf16 v[212:215], v[112:115], a[84:87], v[212:215]
    v_mfma_f32_16x16x32_bf16 v[212:215], v[116:119], a[92:95], v[212:215]
    buffer_load_dwordx4 a[160:163], v4, s[40:43], s63 offen offset:0 sc1
    v_mfma_f32_16x16x32_bf16 v[216:219], v[120:123], a[64:67], v[216:219]
    v_mfma_f32_16x16x32_bf16 v[216:219], v[124:127], a[72:75], v[216:219]
    v_mfma_f32_16x16x32_bf16 v[216:219], v[128:131], a[80:83], v[216:219]
    v_mfma_f32_16x16x32_bf16 v[216:219], v[132:135], a[88:91], v[216:219]
    s_waitcnt vmcnt(19)
    s_barrier
    v_mov_b32 v31, 3
    v_mfma_f32_16x16x32_bf16 v[220:223], v[120:123], a[68:71], v[220:223]
    buffer_load_dwordx4 a[168:171], v4, s[40:43], s63 offen offset:1024 sc1
    v_mfma_f32_16x16x32_bf16 v[220:223], v[124:127], a[76:79], v[220:223]
    buffer_store_dword v31, v30, s[32:35], s101 offen sc1
    v_mfma_f32_16x16x32_bf16 v[220:223], v[128:131], a[84:87], v[220:223]
    ds_read_b128 v[104:107], v6 offset:0
    ds_read_b128 v[108:111], v6 offset:8192
    v_mfma_f32_16x16x32_bf16 v[220:223], v[132:135], a[92:95], v[220:223]
    s_waitcnt lgkmcnt(2)
    ds_read_b128 v[112:115], v6 offset:16384
    v_mfma_f32_16x16x32_bf16 v[224:227], v[136:139], a[64:67], v[224:227]
    buffer_load_dwordx4 a[176:179], v4, s[40:43], s63 offen offset:2048 sc1
    v_mfma_f32_16x16x32_bf16 v[224:227], v[140:143], a[72:75], v[224:227]
    ds_read_b128 v[116:119], v6 offset:24576
    ds_read_b128 v[120:123], v6 offset:1024
    v_mfma_f32_16x16x32_bf16 v[224:227], v[144:147], a[80:83], v[224:227]
    ds_read_b128 v[124:127], v6 offset:9216
    v_mfma_f32_16x16x32_bf16 v[224:227], v[148:151], a[88:91], v[224:227]
    ds_read_b128 v[128:131], v6 offset:17408
    v_mfma_f32_16x16x32_bf16 v[228:231], v[136:139], a[68:71], v[228:231]
    buffer_load_dwordx4 a[184:187], v4, s[40:43], s63 offen offset:3072 sc1
    v_mfma_f32_16x16x32_bf16 v[228:231], v[140:143], a[76:79], v[228:231]
    s_xor_b32 s63, s63, 12288
    ds_read_b128 v[132:135], v6 offset:25600
    ds_read_b128 v[136:139], v6 offset:2048
    v_mfma_f32_16x16x32_bf16 v[228:231], v[144:147], a[84:87], v[228:231]
    ds_read_b128 v[140:143], v6 offset:10240
    v_mfma_f32_16x16x32_bf16 v[228:231], v[148:151], a[92:95], v[228:231]
    s_waitcnt lgkmcnt(4)
    ds_read_b128 v[144:147], v6 offset:18432
    v_mfma_f32_16x16x32_bf16 v[176:179], v[104:107], a[96:99], v[176:179]
    buffer_load_dwordx4 a[164:167], v5, s[40:43], s20 offen offset:0 sc1
    v_mfma_f32_16x16x32_bf16 v[176:179], v[108:111], a[104:107], v[176:179]
    ds_read_b128 v[148:151], v6 offset:26624
    v_mfma_f32_16x16x32_bf16 v[176:179], v[112:115], a[112:115], v[176:179]
    v_mfma_f32_16x16x32_bf16 v[176:179], v[116:119], a[120:123], v[176:179]
    v_mfma_f32_16x16x32_bf16 v[180:183], v[104:107], a[100:103], v[180:183]
    buffer_load_dwordx4 a[172:175], v5, s[40:43], s20 offen offset:1024 sc1
    v_mfma_f32_16x16x32_bf16 v[180:183], v[108:111], a[108:111], v[180:183]
    ds_read_b128 v[104:107], v6 offset:3072
    ds_read_b128 v[108:111], v6 offset:11264
    v_mfma_f32_16x16x32_bf16 v[180:183], v[112:115], a[116:119], v[180:183]
    ds_read_b128 v[112:115], v6 offset:19456
    v_mfma_f32_16x16x32_bf16 v[180:183], v[116:119], a[124:127], v[180:183]
    ds_read_b128 v[116:119], v6 offset:27648
    v_mfma_f32_16x16x32_bf16 v[184:187], v[120:123], a[96:99], v[184:187]
    buffer_load_dwordx4 a[180:183], v5, s[40:43], s20 offen offset:2048 sc1
    v_mfma_f32_16x16x32_bf16 v[184:187], v[124:127], a[104:107], v[184:187]
    s_waitcnt lgkmcnt(4)
    v_mfma_f32_16x16x32_bf16 v[184:187], v[128:131], a[112:115], v[184:187]
    v_mfma_f32_16x16x32_bf16 v[184:187], v[132:135], a[120:123], v[184:187]
    v_mfma_f32_16x16x32_bf16 v[188:191], v[120:123], a[100:103], v[188:191]
    buffer_load_dwordx4 a[188:191], v5, s[40:43], s20 offen offset:3072 sc1
    v_mfma_f32_16x16x32_bf16 v[188:191], v[124:127], a[108:111], v[188:191]
    s_xor_b32 s21, s3, 6
    ds_read_b128 v[120:123], v6 offset:4096
    ds_read_b128 v[124:127], v6 offset:12288
    v_mfma_f32_16x16x32_bf16 v[188:191], v[128:131], a[116:119], v[188:191]
    s_lshl2_add_u32 s21, s21, s4
    ds_read_b128 v[128:131], v6 offset:20480
    v_mfma_f32_16x16x32_bf16 v[188:191], v[132:135], a[124:127], v[188:191]
    s_mul_i32 s21, s21, 36864
    ds_read_b128 v[132:135], v6 offset:28672
    v_mfma_f32_16x16x32_bf16 v[192:195], v[136:139], a[96:99], v[192:195]
    s_add_u32 s21, s21, s28
    s_mov_b32 m0, s45
    v_mfma_f32_16x16x32_bf16 v[192:195], v[140:143], a[104:107], v[192:195]
    s_xor_b32 s20, s20, 12288
    buffer_load_dwordx4 v1, s[56:59], s21 offen sc1 lds
    v_mfma_f32_16x16x32_bf16 v[192:195], v[144:147], a[112:115], v[192:195]
    v_mfma_f32_16x16x32_bf16 v[192:195], v[148:151], a[120:123], v[192:195]
    v_mfma_f32_16x16x32_bf16 v[196:199], v[136:139], a[100:103], v[196:199]
    buffer_load_dwordx4 v1, s[56:59], s21 offen offset:1024 sc1 lds
    v_mfma_f32_16x16x32_bf16 v[196:199], v[140:143], a[108:111], v[196:199]
    ds_read_b128 v[136:139], v6 offset:5120
    ds_read_b128 v[140:143], v6 offset:13312
    v_mfma_f32_16x16x32_bf16 v[196:199], v[144:147], a[116:119], v[196:199]
    ds_read_b128 v[144:147], v6 offset:21504
    v_mfma_f32_16x16x32_bf16 v[196:199], v[148:151], a[124:127], v[196:199]
    s_waitcnt lgkmcnt(3)
    ds_read_b128 v[148:151], v6 offset:29696
    v_mfma_f32_16x16x32_bf16 v[200:203], v[104:107], a[96:99], v[200:203]
    v_mfma_f32_16x16x32_bf16 v[200:203], v[108:111], a[104:107], v[200:203]
    buffer_load_dwordx4 v1, s[56:59], s21 offen offset:2048 sc1 lds
    v_mfma_f32_16x16x32_bf16 v[200:203], v[112:115], a[112:115], v[200:203]
    v_mfma_f32_16x16x32_bf16 v[200:203], v[116:119], a[120:123], v[200:203]
    v_mfma_f32_16x16x32_bf16 v[204:207], v[104:107], a[100:103], v[204:207]
    ds_read_b128 v[104:107], v6 offset:6144
    v_mfma_f32_16x16x32_bf16 v[204:207], v[108:111], a[108:111], v[204:207]
    buffer_load_dwordx4 v1, s[56:59], s21 offen offset:3072 sc1 lds
    v_mfma_f32_16x16x32_bf16 v[204:207], v[112:115], a[116:119], v[204:207]
    s_add_u32 s21, s21, 4096
    ds_read_b128 v[108:111], v6 offset:14336
    ds_read_b128 v[112:115], v6 offset:22528
    v_mfma_f32_16x16x32_bf16 v[204:207], v[116:119], a[124:127], v[204:207]
    s_add_u32 m0, s45, 4096
    ds_read_b128 v[116:119], v6 offset:30720
    v_mfma_f32_16x16x32_bf16 v[208:211], v[120:123], a[96:99], v[208:211]
    v_mfma_f32_16x16x32_bf16 v[208:211], v[124:127], a[104:107], v[208:211]
    buffer_load_dwordx4 v1, s[56:59], s21 offen sc1 lds
    v_mfma_f32_16x16x32_bf16 v[208:211], v[128:131], a[112:115], v[208:211]
    v_mfma_f32_16x16x32_bf16 v[208:211], v[132:135], a[120:123], v[208:211]
    v_mfma_f32_16x16x32_bf16 v[212:215], v[120:123], a[100:103], v[212:215]
    v_mfma_f32_16x16x32_bf16 v[212:215], v[124:127], a[108:111], v[212:215]
    buffer_load_dwordx4 v1, s[56:59], s21 offen offset:1024 sc1 lds
    v_mfma_f32_16x16x32_bf16 v[212:215], v[128:131], a[116:119], v[212:215]
    v_mfma_f32_16x16x32_bf16 v[212:215], v[132:135], a[124:127], v[212:215]
    s_waitcnt lgkmcnt(0)
    v_mfma_f32_16x16x32_bf16 v[216:219], v[136:139], a[96:99], v[216:219]
    v_mfma_f32_16x16x32_bf16 v[216:219], v[140:143], a[104:107], v[216:219]
    buffer_load_dwordx4 v1, s[56:59], s21 offen offset:2048 sc1 lds
    v_mfma_f32_16x16x32_bf16 v[216:219], v[144:147], a[112:115], v[216:219]
    v_mfma_f32_16x16x32_bf16 v[216:219], v[148:151], a[120:123], v[216:219]
    s_waitcnt vmcnt(23)
    s_barrier
    ds_read_b128 v[120:123], v7 offset:0
    v_mfma_f32_16x16x32_bf16 v[220:223], v[136:139], a[100:103], v[220:223]
    ds_read_b128 v[124:127], v7 offset:8192
    ds_read_b128 v[128:131], v7 offset:16384
    v_mfma_f32_16x16x32_bf16 v[220:223], v[140:143], a[108:111], v[220:223]
    ds_read_b128 v[132:135], v7 offset:24576
    v_mfma_f32_16x16x32_bf16 v[220:223], v[144:147], a[116:119], v[220:223]
    buffer_load_dwordx4 a[192:195], v4, s[40:43], s63 offen offset:0 sc1
    v_mfma_f32_16x16x32_bf16 v[220:223], v[148:151], a[124:127], v[220:223]
    ds_read_b128 v[136:139], v7 offset:1024
    ds_read_b128 v[140:143], v7 offset:9216
    v_mfma_f32_16x16x32_bf16 v[224:227], v[104:107], a[96:99], v[224:227]
    ds_read_b128 v[144:147], v7 offset:17408
    v_mfma_f32_16x16x32_bf16 v[224:227], v[108:111], a[104:107], v[224:227]
    ds_read_b128 v[148:151], v7 offset:25600
    v_mfma_f32_16x16x32_bf16 v[224:227], v[112:115], a[112:115], v[224:227]
    buffer_load_dwordx4 a[200:203], v4, s[40:43], s63 offen offset:1024 sc1
    v_mfma_f32_16x16x32_bf16 v[224:227], v[116:119], a[120:123], v[224:227]
    v_mfma_f32_16x16x32_bf16 v[228:231], v[104:107], a[100:103], v[228:231]
    ds_read_b128 v[104:107], v7 offset:2048
    v_mfma_f32_16x16x32_bf16 v[228:231], v[108:111], a[108:111], v[228:231]
    ds_read_b128 v[108:111], v7 offset:10240
    v_mfma_f32_16x16x32_bf16 v[228:231], v[112:115], a[116:119], v[228:231]
    buffer_load_dwordx4 a[208:211], v4, s[40:43], s63 offen offset:2048 sc1
    v_mfma_f32_16x16x32_bf16 v[228:231], v[116:119], a[124:127], v[228:231]
    s_waitcnt lgkmcnt(2)
    ds_read_b128 v[112:115], v7 offset:18432
    ds_read_b128 v[116:119], v7 offset:26624
    v_mfma_f32_16x16x32_bf16 v[176:179], v[120:123], a[128:131], v[176:179]
    v_mfma_f32_16x16x32_bf16 v[176:179], v[124:127], a[136:139], v[176:179]
    v_mfma_f32_16x16x32_bf16 v[176:179], v[128:131], a[144:147], v[176:179]
    buffer_load_dwordx4 a[216:219], v4, s[40:43], s63 offen offset:3072 sc1
    v_mfma_f32_16x16x32_bf16 v[176:179], v[132:135], a[152:155], v[176:179]
    s_xor_b32 s63, s63, 4096
    v_mfma_f32_16x16x32_bf16 v[180:183], v[120:123], a[132:135], v[180:183]
    ds_read_b128 v[120:123], v7 offset:3072
    v_mfma_f32_16x16x32_bf16 v[180:183], v[124:127], a[140:143], v[180:183]
    ds_read_b128 v[124:127], v7 offset:11264
    v_mfma_f32_16x16x32_bf16 v[180:183], v[128:131], a[148:151], v[180:183]
    buffer_load_dwordx4 a[196:199], v5, s[40:43], s20 offen offset:0 sc1
    v_mfma_f32_16x16x32_bf16 v[180:183], v[132:135], a[156:159], v[180:183]
    ds_read_b128 v[128:131], v7 offset:19456
    ds_read_b128 v[132:135], v7 offset:27648
    v_mfma_f32_16x16x32_bf16 v[184:187], v[136:139], a[128:131], v[184:187]
    v_mfma_f32_16x16x32_bf16 v[184:187], v[140:143], a[136:139], v[184:187]
    v_mfma_f32_16x16x32_bf16 v[184:187], v[144:147], a[144:147], v[184:187]
    v_mfma_f32_16x16x32_bf16 v[184:187], v[148:151], a[152:155], v[184:187]
    buffer_load_dwordx4 a[204:207], v5, s[40:43], s20 offen offset:1024 sc1
    v_mfma_f32_16x16x32_bf16 v[188:191], v[136:139], a[132:135], v[188:191]
    ds_read_b128 v[136:139], v7 offset:4096
    v_mfma_f32_16x16x32_bf16 v[188:191], v[140:143], a[140:143], v[188:191]
    ds_read_b128 v[140:143], v7 offset:12288
    v_mfma_f32_16x16x32_bf16 v[188:191], v[144:147], a[148:151], v[188:191]
    ds_read_b128 v[144:147], v7 offset:20480
    v_mfma_f32_16x16x32_bf16 v[188:191], v[148:151], a[156:159], v[188:191]
    s_waitcnt lgkmcnt(3)
    buffer_load_dwordx4 a[212:215], v5, s[40:43], s20 offen offset:2048 sc1
    v_mfma_f32_16x16x32_bf16 v[192:195], v[104:107], a[128:131], v[192:195]
    ds_read_b128 v[148:151], v7 offset:28672
    v_mfma_f32_16x16x32_bf16 v[192:195], v[108:111], a[136:139], v[192:195]
    v_mfma_f32_16x16x32_bf16 v[192:195], v[112:115], a[144:147], v[192:195]
    v_mfma_f32_16x16x32_bf16 v[192:195], v[116:119], a[152:155], v[192:195]
    buffer_load_dwordx4 a[220:223], v5, s[40:43], s20 offen offset:3072 sc1
    v_mfma_f32_16x16x32_bf16 v[196:199], v[104:107], a[132:135], v[196:199]
    s_xor_b32 s21, s3, 7
    ds_read_b128 v[104:107], v7 offset:5120
    v_mfma_f32_16x16x32_bf16 v[196:199], v[108:111], a[140:143], v[196:199]
    s_lshl2_add_u32 s21, s21, s4
    ds_read_b128 v[108:111], v7 offset:13312
    v_mfma_f32_16x16x32_bf16 v[196:199], v[112:115], a[148:151], v[196:199]
    s_mul_i32 s21, s21, 36864
    ds_read_b128 v[112:115], v7 offset:21504
    v_mfma_f32_16x16x32_bf16 v[196:199], v[116:119], a[156:159], v[196:199]
    s_add_u32 s21, s21, s28
    s_mov_b32 m0, s46
    ds_read_b128 v[116:119], v7 offset:29696
    v_mfma_f32_16x16x32_bf16 v[200:203], v[120:123], a[128:131], v[200:203]
    s_xor_b32 s20, s20, 4096
    buffer_load_dwordx4 v1, s[56:59], s21 offen sc1 lds
    v_mfma_f32_16x16x32_bf16 v[200:203], v[124:127], a[136:139], v[200:203]
    v_mfma_f32_16x16x32_bf16 v[200:203], v[128:131], a[144:147], v[200:203]
    v_mfma_f32_16x16x32_bf16 v[200:203], v[132:135], a[152:155], v[200:203]
    buffer_load_dwordx4 v1, s[56:59], s21 offen offset:1024 sc1 lds
    v_mfma_f32_16x16x32_bf16 v[204:207], v[120:123], a[132:135], v[204:207]
    ds_read_b128 v[120:123], v7 offset:6144
    v_mfma_f32_16x16x32_bf16 v[204:207], v[124:127], a[140:143], v[204:207]
    ds_read_b128 v[124:127], v7 offset:14336
    v_mfma_f32_16x16x32_bf16 v[204:207], v[128:131], a[148:151], v[204:207]
    buffer_load_dword v3, v19, s[32:35], s66 offen sc1
    v_mfma_f32_16x16x32_bf16 v[204:207], v[132:135], a[156:159], v[204:207]
    s_waitcnt lgkmcnt(2)
    ds_read_b128 v[128:131], v7 offset:22528
    ds_read_b128 v[132:135], v7 offset:30720
    v_mfma_f32_16x16x32_bf16 v[208:211], v[136:139], a[128:131], v[208:211]
    buffer_load_dwordx4 v1, s[56:59], s21 offen offset:2048 sc1 lds
    v_mfma_f32_16x16x32_bf16 v[208:211], v[140:143], a[136:139], v[208:211]
    v_mfma_f32_16x16x32_bf16 v[208:211], v[144:147], a[144:147], v[208:211]
    v_mfma_f32_16x16x32_bf16 v[208:211], v[148:151], a[152:155], v[208:211]
    v_mfma_f32_16x16x32_bf16 v[212:215], v[136:139], a[132:135], v[212:215]
    buffer_load_dwordx4 v1, s[56:59], s21 offen offset:3072 sc1 lds
    v_mfma_f32_16x16x32_bf16 v[212:215], v[140:143], a[140:143], v[212:215]
    s_add_u32 s21, s21, 4096
    v_mfma_f32_16x16x32_bf16 v[212:215], v[144:147], a[148:151], v[212:215]
    s_add_u32 m0, s46, 4096
    v_mfma_f32_16x16x32_bf16 v[212:215], v[148:151], a[156:159], v[212:215]
    v_mfma_f32_16x16x32_bf16 v[216:219], v[104:107], a[128:131], v[216:219]
    buffer_load_dwordx4 v1, s[56:59], s21 offen sc1 lds
    v_mfma_f32_16x16x32_bf16 v[216:219], v[108:111], a[136:139], v[216:219]
    v_mfma_f32_16x16x32_bf16 v[216:219], v[112:115], a[144:147], v[216:219]
    v_mfma_f32_16x16x32_bf16 v[216:219], v[116:119], a[152:155], v[216:219]
    s_waitcnt vmcnt(21)
    s_barrier
    ds_read_b128 v[136:139], v11 offset:0
    v_mfma_f32_16x16x32_bf16 v[220:223], v[104:107], a[132:135], v[220:223]
    buffer_load_dwordx4 v1, s[56:59], s21 offen offset:1024 sc1 lds
    v_mfma_f32_16x16x32_bf16 v[220:223], v[108:111], a[140:143], v[220:223]
    ds_read_b128 v[140:143], v11 offset:8192
    ds_read_b128 v[144:147], v11 offset:16384
    v_mfma_f32_16x16x32_bf16 v[220:223], v[112:115], a[148:151], v[220:223]
    ds_read_b128 v[148:151], v11 offset:24576
    v_mfma_f32_16x16x32_bf16 v[220:223], v[116:119], a[156:159], v[220:223]
    s_waitcnt lgkmcnt(4)
    ds_read_b128 v[104:107], v11 offset:1024
    v_mfma_f32_16x16x32_bf16 v[224:227], v[120:123], a[128:131], v[224:227]
    buffer_load_dwordx4 v1, s[56:59], s21 offen offset:2048 sc1 lds
    v_mfma_f32_16x16x32_bf16 v[224:227], v[124:127], a[136:139], v[224:227]
    ds_read_b128 v[108:111], v11 offset:9216
    ds_read_b128 v[112:115], v11 offset:17408
    v_mfma_f32_16x16x32_bf16 v[224:227], v[128:131], a[144:147], v[224:227]
    ds_read_b128 v[116:119], v11 offset:25600
    v_mfma_f32_16x16x32_bf16 v[224:227], v[132:135], a[152:155], v[224:227]
    v_mfma_f32_16x16x32_bf16 v[228:231], v[120:123], a[132:135], v[228:231]
    ds_read_b128 v[120:123], v11 offset:2048
    v_mfma_f32_16x16x32_bf16 v[228:231], v[124:127], a[140:143], v[228:231]
    buffer_load_dwordx4 a[224:227], v4, s[40:43], s63 offen offset:0 sc1
    v_mfma_f32_16x16x32_bf16 v[228:231], v[128:131], a[148:151], v[228:231]
    ds_read_b128 v[124:127], v11 offset:10240
    ds_read_b128 v[128:131], v11 offset:18432
    v_mfma_f32_16x16x32_bf16 v[228:231], v[132:135], a[156:159], v[228:231]
    s_waitcnt lgkmcnt(3)
    ds_read_b128 v[132:135], v11 offset:26624
    v_mfma_f32_16x16x32_bf16 v[176:179], v[136:139], a[160:163], v[176:179]
    v_mfma_f32_16x16x32_bf16 v[176:179], v[140:143], a[168:171], v[176:179]
    buffer_load_dwordx4 a[232:235], v4, s[40:43], s63 offen offset:1024 sc1
    v_mfma_f32_16x16x32_bf16 v[176:179], v[144:147], a[176:179], v[176:179]
    v_mfma_f32_16x16x32_bf16 v[176:179], v[148:151], a[184:187], v[176:179]
    v_mfma_f32_16x16x32_bf16 v[180:183], v[136:139], a[164:167], v[180:183]
    ds_read_b128 v[136:139], v11 offset:3072
    v_mfma_f32_16x16x32_bf16 v[180:183], v[140:143], a[172:175], v[180:183]
    buffer_load_dwordx4 a[240:243], v4, s[40:43], s63 offen offset:2048 sc1
    v_mfma_f32_16x16x32_bf16 v[180:183], v[144:147], a[180:183], v[180:183]
    ds_read_b128 v[140:143], v11 offset:11264
    ds_read_b128 v[144:147], v11 offset:19456
    v_mfma_f32_16x16x32_bf16 v[180:183], v[148:151], a[188:191], v[180:183]
    ds_read_b128 v[148:151], v11 offset:27648
    v_mfma_f32_16x16x32_bf16 v[184:187], v[104:107], a[160:163], v[184:187]
    v_mfma_f32_16x16x32_bf16 v[184:187], v[108:111], a[168:171], v[184:187]
    buffer_load_dwordx4 a[248:251], v4, s[40:43], s63 offen offset:3072 sc1
    v_mfma_f32_16x16x32_bf16 v[184:187], v[112:115], a[176:179], v[184:187]
    s_sub_u32 s63, s63, 4096
    v_mfma_f32_16x16x32_bf16 v[184:187], v[116:119], a[184:187], v[184:187]
    v_mfma_f32_16x16x32_bf16 v[188:191], v[104:107], a[164:167], v[188:191]
    ds_read_b128 v[104:107], v11 offset:4096
    v_mfma_f32_16x16x32_bf16 v[188:191], v[108:111], a[172:175], v[188:191]
    buffer_load_dwordx4 a[228:231], v5, s[40:43], s20 offen offset:0 sc1
    v_mfma_f32_16x16x32_bf16 v[188:191], v[112:115], a[180:183], v[188:191]
    ds_read_b128 v[108:111], v11 offset:12288
    ds_read_b128 v[112:115], v11 offset:20480
    v_mfma_f32_16x16x32_bf16 v[188:191], v[116:119], a[188:191], v[188:191]
    s_waitcnt lgkmcnt(3)
    ds_read_b128 v[116:119], v11 offset:28672
    v_mfma_f32_16x16x32_bf16 v[192:195], v[120:123], a[160:163], v[192:195]
    v_mfma_f32_16x16x32_bf16 v[192:195], v[124:127], a[168:171], v[192:195]
    v_mfma_f32_16x16x32_bf16 v[192:195], v[128:131], a[176:179], v[192:195]
    buffer_load_dwordx4 a[236:239], v5, s[40:43], s20 offen offset:1024 sc1
    v_mfma_f32_16x16x32_bf16 v[192:195], v[132:135], a[184:187], v[192:195]
    v_mfma_f32_16x16x32_bf16 v[196:199], v[120:123], a[164:167], v[196:199]
    ds_read_b128 v[120:123], v11 offset:5120
    v_mfma_f32_16x16x32_bf16 v[196:199], v[124:127], a[172:175], v[196:199]
    ds_read_b128 v[124:127], v11 offset:13312
    v_mfma_f32_16x16x32_bf16 v[196:199], v[128:131], a[180:183], v[196:199]
    buffer_load_dwordx4 a[244:247], v5, s[40:43], s20 offen offset:2048 sc1
    v_mfma_f32_16x16x32_bf16 v[196:199], v[132:135], a[188:191], v[196:199]
    ds_read_b128 v[128:131], v11 offset:21504
    ds_read_b128 v[132:135], v11 offset:29696
    v_mfma_f32_16x16x32_bf16 v[200:203], v[136:139], a[160:163], v[200:203]
    v_mfma_f32_16x16x32_bf16 v[200:203], v[140:143], a[168:171], v[200:203]
    v_mfma_f32_16x16x32_bf16 v[200:203], v[144:147], a[176:179], v[200:203]
    buffer_load_dwordx4 a[252:255], v5, s[40:43], s20 offen offset:3072 sc1
    v_mfma_f32_16x16x32_bf16 v[200:203], v[148:151], a[184:187], v[200:203]
    s_mul_i32 s21, s61, 6
    s_add_u32 s21, s21, 132
    v_mfma_f32_16x16x32_bf16 v[204:207], v[136:139], a[164:167], v[204:207]
    s_mul_i32 s21, s21, 36864
    ds_read_b128 v[136:139], v11 offset:6144
    v_mfma_f32_16x16x32_bf16 v[204:207], v[140:143], a[172:175], v[204:207]
    s_add_u32 s21, s21, s28
    ds_read_b128 v[140:143], v11 offset:14336
    v_mfma_f32_16x16x32_bf16 v[204:207], v[144:147], a[180:183], v[204:207]
    s_add_u32 s21, s21, s67
    s_mov_b32 m0, s47
    ds_read_b128 v[144:147], v11 offset:22528
    v_mfma_f32_16x16x32_bf16 v[204:207], v[148:151], a[188:191], v[204:207]
    s_sub_u32 s20, s20, 4096
    buffer_load_dwordx4 v1, s[56:59], s21 offen sc1 lds
    s_waitcnt lgkmcnt(3)
    v_mfma_f32_16x16x32_bf16 v[208:211], v[104:107], a[160:163], v[208:211]
    ds_read_b128 v[148:151], v11 offset:30720
    v_mfma_f32_16x16x32_bf16 v[208:211], v[108:111], a[168:171], v[208:211]
    v_mfma_f32_16x16x32_bf16 v[208:211], v[112:115], a[176:179], v[208:211]
    buffer_load_dwordx4 v1, s[56:59], s21 offen offset:1024 sc1 lds
    v_mfma_f32_16x16x32_bf16 v[208:211], v[116:119], a[184:187], v[208:211]
    v_mfma_f32_16x16x32_bf16 v[212:215], v[104:107], a[164:167], v[212:215]
    v_mfma_f32_16x16x32_bf16 v[212:215], v[108:111], a[172:175], v[212:215]
    v_mfma_f32_16x16x32_bf16 v[212:215], v[112:115], a[180:183], v[212:215]
    v_mfma_f32_16x16x32_bf16 v[212:215], v[116:119], a[188:191], v[212:215]
    v_mfma_f32_16x16x32_bf16 v[216:219], v[120:123], a[160:163], v[216:219]
    v_mfma_f32_16x16x32_bf16 v[216:219], v[124:127], a[168:171], v[216:219]
    s_mul_i32 s63, s61, 6144
    v_mfma_f32_16x16x32_bf16 v[216:219], v[128:131], a[176:179], v[216:219]
    s_add_u32 s63, s63, 135168
    v_mfma_f32_16x16x32_bf16 v[216:219], v[132:135], a[184:187], v[216:219]
    s_waitcnt vmcnt(15)
    v_cmp_gt_u32 vcc, 3, v3
    s_nop 1
    s_and_b64 vcc, vcc, exec
    s_cbranch_scc1 SPIN_OA
BACK_OA:
    s_barrier
    v_mfma_f32_16x16x32_bf16 v[220:223], v[120:123], a[164:167], v[220:223]
    buffer_load_dwordx4 v[64:67], v4, s[40:43], s63 offen offset:0 sc1
    v_mfma_f32_16x16x32_bf16 v[220:223], v[124:127], a[172:175], v[220:223]
    ds_read_b128 v[104:107], v12 offset:0
    ds_read_b128 v[108:111], v12 offset:8192
    v_mfma_f32_16x16x32_bf16 v[220:223], v[128:131], a[180:183], v[220:223]
    ds_read_b128 v[112:115], v12 offset:16384
    v_mfma_f32_16x16x32_bf16 v[220:223], v[132:135], a[188:191], v[220:223]
    s_waitcnt lgkmcnt(3)
    ds_read_b128 v[116:119], v12 offset:24576
    v_mfma_f32_16x16x32_bf16 v[224:227], v[136:139], a[160:163], v[224:227]
    buffer_load_dwordx4 v[68:71], v4, s[40:43], s63 offen offset:1024 sc1
    v_mfma_f32_16x16x32_bf16 v[224:227], v[140:143], a[168:171], v[224:227]
    s_mul_i32 s20, s61, 6144
    ds_read_b128 v[120:123], v12 offset:1024
    ds_read_b128 v[124:127], v12 offset:9216
    v_mfma_f32_16x16x32_bf16 v[224:227], v[144:147], a[176:179], v[224:227]
    s_add_u32 s20, s20, 135168
    ds_read_b128 v[128:131], v12 offset:17408
    v_mfma_f32_16x16x32_bf16 v[224:227], v[148:151], a[184:187], v[224:227]
    s_sub_u32 s63, s63, 4096
    ds_read_b128 v[132:135], v12 offset:25600
    v_mfma_f32_16x16x32_bf16 v[228:231], v[136:139], a[164:167], v[228:231]
    buffer_load_dwordx4 v[72:75], v5, s[40:43], s20 offen offset:0 sc1
    v_mfma_f32_16x16x32_bf16 v[228:231], v[140:143], a[172:175], v[228:231]
    ds_read_b128 v[136:139], v12 offset:2048
    ds_read_b128 v[140:143], v12 offset:10240
    v_mfma_f32_16x16x32_bf16 v[228:231], v[144:147], a[180:183], v[228:231]
    ds_read_b128 v[144:147], v12 offset:18432
    v_mfma_f32_16x16x32_bf16 v[228:231], v[148:151], a[188:191], v[228:231]
    s_waitcnt lgkmcnt(4)
    ds_read_b128 v[148:151], v12 offset:26624
    v_mfma_f32_16x16x32_bf16 v[176:179], v[104:107], a[192:195], v[176:179]
    buffer_load_dwordx4 v[76:79], v5, s[40:43], s20 offen offset:1024 sc1
    v_mfma_f32_16x16x32_bf16 v[176:179], v[108:111], a[200:203], v[176:179]
    s_mul_i32 s21, s61, 6
    s_add_u32 s21, s4, s21
    v_mfma_f32_16x16x32_bf16 v[176:179], v[112:115], a[208:211], v[176:179]
    s_add_u32 s21, s21, 128
    v_mfma_f32_16x16x32_bf16 v[176:179], v[116:119], a[216:219], v[176:179]
    s_mul_i32 s21, s21, 36864
    v_mfma_f32_16x16x32_bf16 v[180:183], v[104:107], a[196:199], v[180:183]
    s_add_u32 s21, s21, s28
    s_mov_b32 m0, s79
    ds_read_b128 v[104:107], v12 offset:3072
    v_mfma_f32_16x16x32_bf16 v[180:183], v[108:111], a[204:207], v[180:183]
    s_sub_u32 s20, s20, 4096
    buffer_load_dwordx4 v1, s[56:59], s21 offen sc1 lds
    v_mfma_f32_16x16x32_bf16 v[180:183], v[112:115], a[212:215], v[180:183]
    ds_read_b128 v[108:111], v12 offset:11264
    ds_read_b128 v[112:115], v12 offset:19456
    v_mfma_f32_16x16x32_bf16 v[180:183], v[116:119], a[220:223], v[180:183]
    ds_read_b128 v[116:119], v12 offset:27648
    v_mfma_f32_16x16x32_bf16 v[184:187], v[120:123], a[192:195], v[184:187]
    buffer_load_dwordx4 v1, s[56:59], s21 offen offset:1024 sc1 lds
    v_mfma_f32_16x16x32_bf16 v[184:187], v[124:127], a[200:203], v[184:187]
    v_mfma_f32_16x16x32_bf16 v[184:187], v[128:131], a[208:211], v[184:187]
    s_waitcnt lgkmcnt(3)
    v_mfma_f32_16x16x32_bf16 v[184:187], v[132:135], a[216:219], v[184:187]
    v_mfma_f32_16x16x32_bf16 v[188:191], v[120:123], a[196:199], v[188:191]
    ds_read_b128 v[120:123], v12 offset:4096
    v_mfma_f32_16x16x32_bf16 v[188:191], v[124:127], a[204:207], v[188:191]
    buffer_load_dwordx4 v1, s[56:59], s21 offen offset:2048 sc1 lds
    v_mfma_f32_16x16x32_bf16 v[188:191], v[128:131], a[212:215], v[188:191]
    ds_read_b128 v[124:127], v12 offset:12288
    ds_read_b128 v[128:131], v12 offset:20480
    v_mfma_f32_16x16x32_bf16 v[188:191], v[132:135], a[220:223], v[188:191]
    ds_read_b128 v[132:135], v12 offset:28672
    v_mfma_f32_16x16x32_bf16 v[192:195], v[136:139], a[192:195], v[192:195]
    v_mfma_f32_16x16x32_bf16 v[192:195], v[140:143], a[200:203], v[192:195]
    buffer_load_dwordx4 v1, s[56:59], s21 offen offset:3072 sc1 lds
    v_mfma_f32_16x16x32_bf16 v[192:195], v[144:147], a[208:211], v[192:195]
    s_add_u32 s21, s21, 4096
    v_mfma_f32_16x16x32_bf16 v[192:195], v[148:151], a[216:219], v[192:195]
    s_add_u32 m0, s79, 4096
    v_mfma_f32_16x16x32_bf16 v[196:199], v[136:139], a[196:199], v[196:199]
    ds_read_b128 v[136:139], v12 offset:5120
    v_mfma_f32_16x16x32_bf16 v[196:199], v[140:143], a[204:207], v[196:199]
    buffer_load_dwordx4 v1, s[56:59], s21 offen sc1 lds
    v_mfma_f32_16x16x32_bf16 v[196:199], v[144:147], a[212:215], v[196:199]
    ds_read_b128 v[140:143], v12 offset:13312
    ds_read_b128 v[144:147], v12 offset:21504
    v_mfma_f32_16x16x32_bf16 v[196:199], v[148:151], a[220:223], v[196:199]
    ds_read_b128 v[148:151], v12 offset:29696
    v_mfma_f32_16x16x32_bf16 v[200:203], v[104:107], a[192:195], v[200:203]
    s_waitcnt lgkmcnt(4)
    v_mfma_f32_16x16x32_bf16 v[200:203], v[108:111], a[200:203], v[200:203]
    buffer_load_dwordx4 v1, s[56:59], s21 offen offset:1024 sc1 lds
    v_mfma_f32_16x16x32_bf16 v[200:203], v[112:115], a[208:211], v[200:203]
    v_mfma_f32_16x16x32_bf16 v[200:203], v[116:119], a[216:219], v[200:203]
    v_mfma_f32_16x16x32_bf16 v[204:207], v[104:107], a[196:199], v[204:207]
    ds_read_b128 v[104:107], v12 offset:6144
    v_mfma_f32_16x16x32_bf16 v[204:207], v[108:111], a[204:207], v[204:207]
    buffer_load_dwordx4 v1, s[56:59], s21 offen offset:2048 sc1 lds
    v_mfma_f32_16x16x32_bf16 v[204:207], v[112:115], a[212:215], v[204:207]
    ds_read_b128 v[108:111], v12 offset:14336
    ds_read_b128 v[112:115], v12 offset:22528
    v_mfma_f32_16x16x32_bf16 v[204:207], v[116:119], a[220:223], v[204:207]
    ds_read_b128 v[116:119], v12 offset:30720
    v_mfma_f32_16x16x32_bf16 v[208:211], v[120:123], a[192:195], v[208:211]
    v_mfma_f32_16x16x32_bf16 v[208:211], v[124:127], a[200:203], v[208:211]
    v_mfma_f32_16x16x32_bf16 v[208:211], v[128:131], a[208:211], v[208:211]
    buffer_load_dwordx4 v[32:35], v4, s[40:43], s63 offen offset:0 sc1
    v_mfma_f32_16x16x32_bf16 v[208:211], v[132:135], a[216:219], v[208:211]
    v_mfma_f32_16x16x32_bf16 v[212:215], v[120:123], a[196:199], v[212:215]
    v_mfma_f32_16x16x32_bf16 v[212:215], v[124:127], a[204:207], v[212:215]
    v_mfma_f32_16x16x32_bf16 v[212:215], v[128:131], a[212:215], v[212:215]
    buffer_load_dwordx4 v[40:43], v4, s[40:43], s63 offen offset:1024 sc1
    v_mfma_f32_16x16x32_bf16 v[212:215], v[132:135], a[220:223], v[212:215]
    s_waitcnt lgkmcnt(0)
    v_mfma_f32_16x16x32_bf16 v[216:219], v[136:139], a[192:195], v[216:219]
    v_mfma_f32_16x16x32_bf16 v[216:219], v[140:143], a[200:203], v[216:219]
    v_mfma_f32_16x16x32_bf16 v[216:219], v[144:147], a[208:211], v[216:219]
    s_add_u32 s23, s5, 8
    buffer_load_dwordx4 v[48:51], v4, s[40:43], s63 offen offset:2048 sc1
    v_mfma_f32_16x16x32_bf16 v[216:219], v[148:151], a[216:219], v[216:219]
    s_waitcnt vmcnt(16)
    s_barrier
    ds_read_b128 v[120:123], v13 offset:0
    v_mfma_f32_16x16x32_bf16 v[220:223], v[136:139], a[196:199], v[220:223]
    s_and_b32 s65, s5, 3
    ds_read_b128 v[124:127], v13 offset:8192
    ds_read_b128 v[128:131], v13 offset:16384
    v_mfma_f32_16x16x32_bf16 v[220:223], v[140:143], a[204:207], v[220:223]
    s_mul_i32 s70, s4, 3072
    ds_read_b128 v[132:135], v13 offset:24576
    v_lshrrev_b32 v19, 4, v1
    v_mfma_f32_16x16x32_bf16 v[220:223], v[144:147], a[212:215], v[220:223]
    s_andn2_b32 s66, s74, 0xfff
    buffer_load_dwordx4 v[56:59], v4, s[40:43], s63 offen offset:3072 sc1
    v_mfma_f32_16x16x32_bf16 v[220:223], v[148:151], a[220:223], v[220:223]
    s_sub_u32 s63, s63, 4096
    ds_read_b128 v[136:139], v13 offset:1024
    ds_read_b128 v[140:143], v13 offset:9216
    v_mfma_f32_16x16x32_bf16 v[224:227], v[104:107], a[192:195], v[224:227]
    ds_read_b128 v[144:147], v13 offset:17408
    v_min_u32 v19, 2, v19
    v_mfma_f32_16x16x32_bf16 v[224:227], v[108:111], a[200:203], v[224:227]
    ds_read_b128 v[148:151], v13 offset:25600
    v_lshl_add_u32 v19, v19, 3, s23
    v_mfma_f32_16x16x32_bf16 v[224:227], v[112:115], a[208:211], v[224:227]
    s_lshl3_add_u32 s23, s6, s62
    buffer_load_dwordx4 v[36:39], v5, s[40:43], s20 offen offset:0 sc1
    v_mfma_f32_16x16x32_bf16 v[224:227], v[116:119], a[216:219], v[224:227]
    s_lshl_b32 s23, s23, 4
    v_bfe_u32 v20, v1, 4, 4
    v_add_u32 v20, s23, v20
    v_mfma_f32_16x16x32_bf16 v[228:231], v[104:107], a[196:199], v[228:231]
    s_mul_i32 s23, s6, 294912
    ds_read_b128 v[104:107], v13 offset:2048
    v_mul_u32_u24 v20, 1152, v20
    v_mfma_f32_16x16x32_bf16 v[228:231], v[108:111], a[204:207], v[228:231]
    s_sub_u32 s23, 2211840, s23
    ds_read_b128 v[108:111], v13 offset:10240
    v_lshrrev_b32 v21, 8, v1
    v_mfma_f32_16x16x32_bf16 v[228:231], v[112:115], a[212:215], v[228:231]
    ds_read_b128 v[112:115], v13 offset:18432
    v_lshl_add_u32 v20, v21, 3, v20
    v_mfma_f32_16x16x32_bf16 v[228:231], v[116:119], a[220:223], v[228:231]
    s_waitcnt lgkmcnt(3)
    buffer_load_dwordx4 v[44:47], v5, s[40:43], s20 offen offset:1024 sc1
    v_mfma_f32_16x16x32_bf16 v[176:179], v[120:123], a[224:227], v[176:179]
    ds_read_b128 v[116:119], v13 offset:26624
    v_add_u32 v21, s23, v20
    v_mfma_f32_16x16x32_bf16 v[176:179], v[124:127], a[232:235], v[176:179]
    s_mul_i32 s23, s101, 288
    v_and_b32 v19, 31, v19
    v_mov_b32 v31, 3
    v_mfma_f32_16x16x32_bf16 v[176:179], v[128:131], a[240:243], v[176:179]
    s_add_u32 s23, s23, s70
    v_lshlrev_b32 v23, 20, v1
    v_lshlrev_b32 v19, 7, v19
    v_mfma_f32_16x16x32_bf16 v[176:179], v[132:135], a[248:251], v[176:179]
    s_add_u32 s98, s23, 0
    buffer_load_dwordx4 v[52:55], v5, s[40:43], s20 offen offset:2048 sc1
    v_mfma_f32_16x16x32_bf16 v[180:183], v[120:123], a[228:231], v[180:183]
    ds_read_b128 v[120:123], v13 offset:3072
    v_bfe_u32 v92, v1, 6, 2
    v_mfma_f32_16x16x32_bf16 v[180:183], v[124:127], a[236:239], v[180:183]
    ds_read_b128 v[124:127], v13 offset:11264
    v_lshrrev_b32 v93, 8, v1
    v_mfma_f32_16x16x32_bf16 v[180:183], v[128:131], a[244:247], v[180:183]
    ds_read_b128 v[128:131], v13 offset:19456
    v_cmp_eq_u32 vcc, v92, v93
    v_mfma_f32_16x16x32_bf16 v[180:183], v[132:135], a[252:255], v[180:183]
    buffer_load_dwordx4 v[60:63], v5, s[40:43], s20 offen offset:3072 sc1
    v_mfma_f32_16x16x32_bf16 v[184:187], v[136:139], a[224:227], v[184:187]
    s_add_u32 s21, s4, 0
    s_xor_b32 s21, s21, s3
    s_lshl_b32 s21, s21, 2
    v_mfma_f32_16x16x32_bf16 v[184:187], v[140:143], a[232:235], v[184:187]
    s_mul_i32 s21, s21, 36864
    ds_read_b128 v[132:135], v13 offset:27648
    v_and_b32 v92, 16, v1
    v_mfma_f32_16x16x32_bf16 v[184:187], v[144:147], a[240:243], v[184:187]
    s_add_u32 s21, s21, s28
    v_mov_b32 v93, 0x3f80
    v_lshlrev_b32 v92, v92, v93
    v_mfma_f32_16x16x32_bf16 v[184:187], v[148:151], a[248:251], v[184:187]
    s_add_u32 s21, s21, 7168
    s_add_u32 m0, s44, 0
    v_and_b32 v93, 32, v1
    v_mfma_f32_16x16x32_bf16 v[188:191], v[136:139], a[228:231], v[188:191]
    s_sub_u32 s20, s20, 4096
    buffer_load_dwordx4 v1, s[56:59], s21 offen sc1 lds
    v_mfma_f32_16x16x32_bf16 v[188:191], v[140:143], a[236:239], v[188:191]
    ds_read_b128 v[136:139], v13 offset:4096
    ds_read_b128 v[140:143], v13 offset:12288
    v_mfma_f32_16x16x32_bf16 v[188:191], v[144:147], a[244:247], v[188:191]
    ds_read_b128 v[144:147], v13 offset:20480
    v_cndmask_b32 v92, 0, v92, vcc
    v_mfma_f32_16x16x32_bf16 v[188:191], v[148:151], a[252:255], v[188:191]
    s_waitcnt lgkmcnt(3)
    buffer_load_dwordx4 v1, s[56:59], s21 offen offset:1024 sc1 lds
    v_mfma_f32_16x16x32_bf16 v[192:195], v[104:107], a[224:227], v[192:195]
    ds_read_b128 v[148:151], v13 offset:28672
    v_cmp_eq_u32 vcc, 0, v93
    v_mfma_f32_16x16x32_bf16 v[192:195], v[108:111], a[232:235], v[192:195]
    s_add_u32 s21, s21, 36864
    v_cndmask_b32 v96, 0, v92, vcc
    v_cndmask_b32_e64 v97, v92, 0, vcc
    v_mfma_f32_16x16x32_bf16 v[192:195], v[112:115], a[240:243], v[192:195]
    s_add_u32 m0, s44, 2048
    v_mov_b32 v98, 0
    v_mov_b32 v99, 0
    v_mfma_f32_16x16x32_bf16 v[192:195], v[116:119], a[248:251], v[192:195]
    v_mov_b32 v100, v96
    v_mov_b32 v101, v97
    v_mfma_f32_16x16x32_bf16 v[196:199], v[104:107], a[228:231], v[196:199]
    buffer_load_dwordx4 v1, s[56:59], s21 offen sc1 lds
    v_mfma_f32_16x16x32_bf16 v[196:199], v[108:111], a[236:239], v[196:199]
    ds_read_b128 v[104:107], v13 offset:5120
    ds_read_b128 v[108:111], v13 offset:13312
    v_mfma_f32_16x16x32_bf16 v[196:199], v[112:115], a[244:247], v[196:199]
    ds_read_b128 v[112:115], v13 offset:21504
    v_mfma_f32_16x16x32_bf16 v[196:199], v[116:119], a[252:255], v[196:199]
    ds_read_b128 v[116:119], v13 offset:29696
    v_mfma_f32_16x16x32_bf16 v[200:203], v[120:123], a[224:227], v[200:203]
    buffer_load_dwordx4 v1, s[56:59], s21 offen offset:1024 sc1 lds
    v_mfma_f32_16x16x32_bf16 v[200:203], v[124:127], a[232:235], v[200:203]
    s_add_u32 s21, s21, 36864
    v_mfma_f32_16x16x32_bf16 v[200:203], v[128:131], a[240:243], v[200:203]
    s_add_u32 m0, s44, 4096
    v_mfma_f32_16x16x32_bf16 v[200:203], v[132:135], a[248:251], v[200:203]
    v_mfma_f32_16x16x32_bf16 v[204:207], v[120:123], a[228:231], v[204:207]
    buffer_load_dwordx4 v1, s[56:59], s21 offen sc1 lds
    v_mfma_f32_16x16x32_bf16 v[204:207], v[124:127], a[236:239], v[204:207]
    ds_read_b128 v[120:123], v13 offset:6144
    ds_read_b128 v[124:127], v13 offset:14336
    v_mfma_f32_16x16x32_bf16 v[204:207], v[128:131], a[244:247], v[204:207]
    ds_read_b128 v[128:131], v13 offset:22528
    v_mfma_f32_16x16x32_bf16 v[204:207], v[132:135], a[252:255], v[204:207]
    s_waitcnt lgkmcnt(3)
    ds_read_b128 v[132:135], v13 offset:30720
    v_mfma_f32_16x16x32_bf16 v[208:211], v[136:139], a[224:227], v[208:211]
    buffer_load_dwordx4 v1, s[56:59], s21 offen offset:1024 sc1 lds
    v_mfma_f32_16x16x32_bf16 v[208:211], v[140:143], a[232:235], v[208:211]
    s_add_u32 s21, s21, 36864
    v_mfma_f32_16x16x32_bf16 v[208:211], v[144:147], a[240:243], v[208:211]
    s_add_u32 m0, s44, 6144
    v_mfma_f32_16x16x32_bf16 v[208:211], v[148:151], a[248:251], v[208:211]
    v_mfma_f32_16x16x32_bf16 v[212:215], v[136:139], a[228:231], v[212:215]
    buffer_load_dwordx4 v1, s[56:59], s21 offen sc1 lds
    v_mfma_f32_16x16x32_bf16 v[212:215], v[140:143], a[236:239], v[212:215]
    v_mfma_f32_16x16x32_bf16 v[212:215], v[144:147], a[244:247], v[212:215]
    v_mfma_f32_16x16x32_bf16 v[212:215], v[148:151], a[252:255], v[212:215]
    v_mfma_f32_16x16x32_bf16 v[216:219], v[104:107], a[224:227], v[216:219]
    v_mfma_f32_16x16x32_bf16 v[216:219], v[108:111], a[232:235], v[216:219]
    buffer_load_dwordx4 v1, s[56:59], s21 offen offset:1024 sc1 lds
    v_mfma_f32_16x16x32_bf16 v[216:219], v[112:115], a[240:243], v[216:219]
    s_add_u32 s21, s21, 36864
    s_add_u32 s21, s4, 4
    s_xor_b32 s21, s21, s3
    v_mfma_f32_16x16x32_bf16 v[216:219], v[116:119], a[248:251], v[216:219]
    s_lshl_b32 s21, s21, 2
    s_waitcnt vmcnt(16)
    s_barrier
    v_mfma_f32_16x16x32_bf16 v[220:223], v[104:107], a[228:231], v[220:223]
    s_mul_i32 s21, s21, 36864
    s_add_u32 s21, s21, s28
    ds_read_b128 v[136:139], v6 offset:0
    v_mfma_f32_16x16x32_bf16 v[220:223], v[108:111], a[236:239], v[220:223]
    s_add_u32 s21, s21, 7168
    s_add_u32 m0, s45, 0
    ds_read_b128 v[140:143], v6 offset:1024
    v_mfma_f32_16x16x32_bf16 v[220:223], v[112:115], a[244:247], v[220:223]
    buffer_load_dwordx4 v1, s[56:59], s21 offen sc1 lds
    v_mfma_f32_16x16x32_bf16 v[220:223], v[116:119], a[252:255], v[220:223]
    s_waitcnt lgkmcnt(2)
    ds_read_b128 v[144:147], v6 offset:8192
    ds_read_b128 v[148:151], v6 offset:9216
    v_mfma_f32_16x16x32_bf16 v[224:227], v[120:123], a[224:227], v[224:227]
    ds_read_b128 v[104:107], v6 offset:16384
    v_mfma_f32_16x16x32_bf16 v[224:227], v[124:127], a[232:235], v[224:227]
    buffer_load_dwordx4 v1, s[56:59], s21 offen offset:1024 sc1 lds
    v_mfma_f32_16x16x32_bf16 v[224:227], v[128:131], a[240:243], v[224:227]
    s_add_u32 s21, s21, 36864
    ds_read_b128 v[108:111], v6 offset:17408
    ds_read_b128 v[112:115], v6 offset:24576
    v_mfma_f32_16x16x32_bf16 v[224:227], v[132:135], a[248:251], v[224:227]
    s_add_u32 m0, s45, 2048
    ds_read_b128 v[116:119], v7 offset:0
    v_mfma_f32_16x16x32_bf16 v[228:231], v[120:123], a[228:231], v[228:231]
    ds_read_b128 v[120:123], v7 offset:8192
    v_mfma_f32_16x16x32_bf16 v[228:231], v[124:127], a[236:239], v[228:231]
    buffer_load_dwordx4 v1, s[56:59], s21 offen sc1 lds
    v_mfma_f32_16x16x32_bf16 v[228:231], v[128:131], a[244:247], v[228:231]
    ds_read_b128 v[124:127], v7 offset:16384
    ds_read_b128 v[128:131], v7 offset:24576
    v_mfma_f32_16x16x32_bf16 v[228:231], v[132:135], a[252:255], v[228:231]
    s_waitcnt lgkmcnt(4)
    ds_read_b128 v[132:135], v7 offset:1024
    v_smfmac_f32_16x16x64_bf16 v[176:179], v[136:139], v[64:71], v16
    v_smfmac_f32_16x16x64_bf16 v[180:183], v[136:139], v[72:79], v16
    buffer_load_dwordx4 v1, s[56:59], s21 offen offset:1024 sc1 lds
    v_smfmac_f32_16x16x64_bf16 v[184:187], v[140:143], v[64:71], v16
    ds_read_b128 v[136:139], v7 offset:9216
    v_smfmac_f32_16x16x64_bf16 v[188:191], v[140:143], v[72:79], v16
    s_add_u32 s21, s21, 36864
    ds_read_b128 v[140:143], v7 offset:17408
    v_smfmac_f32_16x16x64_bf16 v[192:195], v[144:147], v[64:71], v16
    s_add_u32 m0, s45, 4096
    v_smfmac_f32_16x16x64_bf16 v[196:199], v[144:147], v[72:79], v16
    ds_read_b128 v[144:147], v7 offset:25600
    v_smfmac_f32_16x16x64_bf16 v[200:203], v[148:151], v[64:71], v16
    buffer_load_dwordx4 v1, s[56:59], s21 offen sc1 lds
    v_smfmac_f32_16x16x64_bf16 v[204:207], v[148:151], v[72:79], v16
    ds_read_b128 v[148:151], v7 offset:2048
    v_smfmac_f32_16x16x64_bf16 v[208:211], v[104:107], v[64:71], v16
    v_smfmac_f32_16x16x64_bf16 v[212:215], v[104:107], v[72:79], v16
    ds_read_b128 v[104:107], v7 offset:10240
    v_smfmac_f32_16x16x64_bf16 v[216:219], v[108:111], v[64:71], v16
    buffer_load_dwordx4 v1, s[56:59], s21 offen offset:1024 sc1 lds
    v_smfmac_f32_16x16x64_bf16 v[220:223], v[108:111], v[72:79], v16
    s_add_u32 s21, s21, 36864
    ds_read_b128 v[108:111], v7 offset:18432
    v_smfmac_f32_16x16x64_bf16 v[224:227], v[112:115], v[64:71], v16
    s_waitcnt vmcnt(14)
    v_smfmac_f32_16x16x64_bf16 v[228:231], v[112:115], v[72:79], v16
    s_add_u32 m0, s45, 6144
    ds_read_b128 v[112:115], v7 offset:26624
    s_waitcnt lgkmcnt(3)
    v_mfma_f32_16x16x32_bf16 v[176:179], v[116:119], v[32:35], v[176:179]
    buffer_load_dwordx4 v1, s[56:59], s21 offen sc1 lds
    v_mfma_f32_16x16x32_bf16 v[176:179], v[120:123], v[40:43], v[176:179]
    v_mfma_f32_16x16x32_bf16 v[176:179], v[124:127], v[48:51], v[176:179]
    v_mfma_f32_16x16x32_bf16 v[176:179], v[128:131], v[56:59], v[176:179]
    v_mfma_f32_16x16x32_bf16 v[180:183], v[116:119], v[36:39], v[180:183]
    buffer_load_dwordx4 v1, s[56:59], s21 offen offset:1024 sc1 lds
    v_mfma_f32_16x16x32_bf16 v[180:183], v[120:123], v[44:47], v[180:183]
    s_add_u32 s21, s21, 36864
    ds_read_b128 v[116:119], v7 offset:3072
    ds_read_b128 v[120:123], v7 offset:11264
    v_mfma_f32_16x16x32_bf16 v[180:183], v[124:127], v[52:55], v[180:183]
    ds_read_b128 v[124:127], v7 offset:19456
    v_cvt_pk_bf16_f32 v232, v176, v177
    v_mfma_f32_16x16x32_bf16 v[180:183], v[128:131], v[60:63], v[180:183]
    v_cvt_pk_bf16_f32 v233, v178, v179
    ds_read_b128 v[128:131], v7 offset:27648
    v_mfma_f32_16x16x32_bf16 v[184:187], v[132:135], v[32:35], v[184:187]
    v_mfma_f32_16x16x32_bf16 v[184:187], v[136:139], v[40:43], v[184:187]
    v_mfma_f32_16x16x32_bf16 v[184:187], v[140:143], v[48:51], v[184:187]
    v_mfma_f32_16x16x32_bf16 v[184:187], v[144:147], v[56:59], v[184:187]
    v_mfma_f32_16x16x32_bf16 v[188:191], v[132:135], v[36:39], v[188:191]
    ds_read_b128 v[132:135], v7 offset:4096
    v_cvt_pk_bf16_f32 v234, v180, v181
    v_mfma_f32_16x16x32_bf16 v[188:191], v[136:139], v[44:47], v[188:191]
    v_cvt_pk_bf16_f32 v235, v182, v183
    ds_read_b128 v[136:139], v7 offset:12288
    v_mfma_f32_16x16x32_bf16 v[188:191], v[140:143], v[52:55], v[188:191]
    buffer_store_dwordx4 v[232:235], v1, s[48:51], s8 offen offset:0 sc1
    v_mfma_f32_16x16x32_bf16 v[188:191], v[144:147], v[60:63], v[188:191]
    v_cvt_pk_bf16_f32 v236, v184, v185
    v_cvt_pk_bf16_f32 v237, v186, v187
    v_mfma_f32_16x16x32_bf16 v[192:195], v[148:151], v[32:35], v[192:195]
    s_waitcnt lgkmcnt(2)
    ds_read_b128 v[140:143], v7 offset:20480
    ds_read_b128 v[144:147], v7 offset:28672
    v_mfma_f32_16x16x32_bf16 v[192:195], v[104:107], v[40:43], v[192:195]
    v_mfma_f32_16x16x32_bf16 v[192:195], v[108:111], v[48:51], v[192:195]
    v_mfma_f32_16x16x32_bf16 v[192:195], v[112:115], v[56:59], v[192:195]
    v_cvt_pk_bf16_f32 v238, v188, v189
    v_cvt_pk_bf16_f32 v239, v190, v191
    v_mfma_f32_16x16x32_bf16 v[196:199], v[148:151], v[36:39], v[196:199]
    buffer_store_dwordx4 v[236:239], v1, s[48:51], s8 offen offset:1024 sc1
    v_mfma_f32_16x16x32_bf16 v[196:199], v[104:107], v[44:47], v[196:199]
    ds_read_b128 v[148:151], v7 offset:5120
    ds_read_b128 v[104:107], v7 offset:13312
    v_mfma_f32_16x16x32_bf16 v[196:199], v[108:111], v[52:55], v[196:199]
    v_cvt_pk_bf16_f32 v240, v192, v193
    v_cvt_pk_bf16_f32 v241, v194, v195
    v_mfma_f32_16x16x32_bf16 v[196:199], v[112:115], v[60:63], v[196:199]
    ds_read_b128 v[108:111], v7 offset:21504
    ds_read_b128 v[112:115], v7 offset:29696
    v_mfma_f32_16x16x32_bf16 v[200:203], v[116:119], v[32:35], v[200:203]
    v_mfma_f32_16x16x32_bf16 v[200:203], v[120:123], v[40:43], v[200:203]
    v_mfma_f32_16x16x32_bf16 v[200:203], v[124:127], v[48:51], v[200:203]
    v_mfma_f32_16x16x32_bf16 v[200:203], v[128:131], v[56:59], v[200:203]
    v_mfma_f32_16x16x32_bf16 v[204:207], v[116:119], v[36:39], v[204:207]
    ds_read_b128 v[116:119], v7 offset:6144
    v_cvt_pk_bf16_f32 v242, v196, v197
    v_mfma_f32_16x16x32_bf16 v[204:207], v[120:123], v[44:47], v[204:207]
    v_cvt_pk_bf16_f32 v243, v198, v199
    ds_read_b128 v[120:123], v7 offset:14336
    v_mfma_f32_16x16x32_bf16 v[204:207], v[124:127], v[52:55], v[204:207]
    buffer_store_dwordx4 v[240:243], v1, s[48:51], s9 offen offset:0 sc1
    v_mfma_f32_16x16x32_bf16 v[204:207], v[128:131], v[60:63], v[204:207]
    s_waitcnt lgkmcnt(2)
    v_cvt_pk_bf16_f32 v244, v200, v201
    v_cvt_pk_bf16_f32 v245, v202, v203
    v_mfma_f32_16x16x32_bf16 v[208:211], v[132:135], v[32:35], v[208:211]
    ds_read_b128 v[124:127], v7 offset:22528
    ds_read_b128 v[128:131], v7 offset:30720
    v_mfma_f32_16x16x32_bf16 v[208:211], v[136:139], v[40:43], v[208:211]
    v_mfma_f32_16x16x32_bf16 v[208:211], v[140:143], v[48:51], v[208:211]
    v_mfma_f32_16x16x32_bf16 v[208:211], v[144:147], v[56:59], v[208:211]
    v_cvt_pk_bf16_f32 v246, v204, v205
    v_cvt_pk_bf16_f32 v247, v206, v207
    v_mfma_f32_16x16x32_bf16 v[212:215], v[132:135], v[36:39], v[212:215]
    buffer_store_dwordx4 v[244:247], v1, s[48:51], s9 offen offset:1024 sc1
    v_mfma_f32_16x16x32_bf16 v[212:215], v[136:139], v[44:47], v[212:215]
    v_mfma_f32_16x16x32_bf16 v[212:215], v[140:143], v[52:55], v[212:215]
    v_mfma_f32_16x16x32_bf16 v[212:215], v[144:147], v[60:63], v[212:215]
    v_mfma_f32_16x16x32_bf16 v[216:219], v[148:151], v[32:35], v[216:219]
    v_cvt_pk_bf16_f32 v232, v208, v209
    v_cvt_pk_bf16_f32 v233, v210, v211
    v_mfma_f32_16x16x32_bf16 v[216:219], v[104:107], v[40:43], v[216:219]
    v_mfma_f32_16x16x32_bf16 v[216:219], v[108:111], v[48:51], v[216:219]
    v_mfma_f32_16x16x32_bf16 v[216:219], v[112:115], v[56:59], v[216:219]
    s_waitcnt vmcnt(12)
    s_barrier
    v_cvt_pk_bf16_f32 v234, v212, v213
    v_mfma_f32_16x16x32_bf16 v[220:223], v[148:151], v[36:39], v[220:223]
    v_cvt_pk_bf16_f32 v235, v214, v215
    ds_read_b128 v[132:135], v11 offset:0
    v_mfma_f32_16x16x32_bf16 v[220:223], v[104:107], v[44:47], v[220:223]
    buffer_store_dwordx4 v[232:235], v1, s[48:51], s10 offen offset:0 sc1
    v_mfma_f32_16x16x32_bf16 v[220:223], v[108:111], v[52:55], v[220:223]
    ds_read_b128 v[136:139], v11 offset:2048
    ds_read_b128 v[140:143], v11 offset:4096
    v_mfma_f32_16x16x32_bf16 v[220:223], v[112:115], v[60:63], v[220:223]
    s_waitcnt lgkmcnt(3)
    ds_read_b128 v[144:147], v11 offset:6144
    v_cvt_pk_bf16_f32 v236, v216, v217
    v_mfma_f32_16x16x32_bf16 v[224:227], v[116:119], v[32:35], v[224:227]
    v_cvt_pk_bf16_f32 v237, v218, v219
    ds_read_b128 v[148:151], v11 offset:1024
    v_mfma_f32_16x16x32_bf16 v[224:227], v[120:123], v[40:43], v[224:227]
    ds_read_b128 v[104:107], v11 offset:3072
    v_mfma_f32_16x16x32_bf16 v[224:227], v[124:127], v[48:51], v[224:227]
    v_cvt_pk_bf16_f32 v238, v220, v221
    v_cvt_pk_bf16_f32 v239, v222, v223
    v_mfma_f32_16x16x32_bf16 v[224:227], v[128:131], v[56:59], v[224:227]
    buffer_store_dwordx4 v[236:239], v1, s[48:51], s10 offen offset:1024 sc1
    v_mfma_f32_16x16x32_bf16 v[228:231], v[116:119], v[36:39], v[228:231]
    ds_read_b128 v[108:111], v11 offset:5120
    ds_read_b128 v[112:115], v11 offset:7168
    v_mfma_f32_16x16x32_bf16 v[228:231], v[120:123], v[44:47], v[228:231]
    ds_read_b128 v[116:119], v11 offset:8192
    v_mfma_f32_16x16x32_bf16 v[228:231], v[124:127], v[52:55], v[228:231]
    ds_read_b128 v[120:123], v11 offset:10240
    v_cvt_pk_bf16_f32 v240, v224, v225
    v_mfma_f32_16x16x32_bf16 v[228:231], v[128:131], v[60:63], v[228:231]
    s_waitcnt lgkmcnt(4)
    v_cvt_pk_bf16_f32 v241, v226, v227
    ds_read_b128 v[124:127], v11 offset:12288
    v_mfma_f32_16x16x32_bf16 v[160:163], v[132:135], a[0:3], 0
    ds_read_b128 v[128:131], v11 offset:14336
    v_mfma_f32_16x16x32_bf16 v[160:163], v[136:139], a[8:11], v[160:163]
    v_mfma_f32_16x16x32_bf16 v[160:163], v[140:143], a[16:19], v[160:163]
    v_mfma_f32_16x16x32_bf16 v[160:163], v[144:147], a[24:27], v[160:163]
    v_mfma_f32_16x16x32_bf16 v[164:167], v[132:135], a[4:7], 0
    v_cvt_pk_bf16_f32 v242, v228, v229
    v_cvt_pk_bf16_f32 v243, v230, v231
    v_mfma_f32_16x16x32_bf16 v[164:167], v[136:139], a[12:15], v[164:167]
    buffer_store_dwordx4 v[240:243], v1, s[48:51], s11 offen offset:2048 sc1
    v_mfma_f32_16x16x32_bf16 v[164:167], v[140:143], a[20:23], v[164:167]
    ds_read_b128 v[132:135], v11 offset:9216
    ds_read_b128 v[136:139], v11 offset:11264
    v_mfma_f32_16x16x32_bf16 v[164:167], v[144:147], a[28:31], v[164:167]
    ds_read_b128 v[140:143], v11 offset:13312
    v_mfma_f32_16x16x32_bf16 v[168:171], v[148:151], a[0:3], 0
    ds_read_b128 v[144:147], v11 offset:15360
    v_mfma_f32_16x16x32_bf16 v[168:171], v[104:107], a[8:11], v[168:171]
    s_waitcnt lgkmcnt(4)
    v_mfma_f32_16x16x32_bf16 v[168:171], v[108:111], a[16:19], v[168:171]
    v_mfma_f32_16x16x32_bf16 v[168:171], v[112:115], a[24:27], v[168:171]
    v_mfma_f32_16x16x32_bf16 v[172:175], v[148:151], a[4:7], 0
    ds_read_b128 v[148:151], v11 offset:16384
    v_mfma_f32_16x16x32_bf16 v[172:175], v[104:107], a[12:15], v[172:175]
    ds_read_b128 v[104:107], v11 offset:18432
    v_mfma_f32_16x16x32_bf16 v[172:175], v[108:111], a[20:23], v[172:175]
    ds_read_b128 v[108:111], v11 offset:20480
    v_mfma_f32_16x16x32_bf16 v[172:175], v[112:115], a[28:31], v[172:175]
    ds_read_b128 v[112:115], v11 offset:22528
    v_mfma_f32_16x16x32_bf16 v[160:163], v[116:119], a[32:35], v[160:163]
    v_mfma_f32_16x16x32_bf16 v[160:163], v[120:123], a[40:43], v[160:163]
    v_mfma_f32_16x16x32_bf16 v[160:163], v[124:127], a[48:51], v[160:163]
    v_mfma_f32_16x16x32_bf16 v[160:163], v[128:131], a[56:59], v[160:163]
    v_mfma_f32_16x16x32_bf16 v[164:167], v[116:119], a[36:39], v[164:167]
    ds_read_b128 v[116:119], v11 offset:17408
    v_mfma_f32_16x16x32_bf16 v[164:167], v[120:123], a[44:47], v[164:167]
    ds_read_b128 v[120:123], v11 offset:19456
    v_mfma_f32_16x16x32_bf16 v[164:167], v[124:127], a[52:55], v[164:167]
    ds_read_b128 v[124:127], v11 offset:21504
    v_mfma_f32_16x16x32_bf16 v[164:167], v[128:131], a[60:63], v[164:167]
    s_waitcnt lgkmcnt(3)
    ds_read_b128 v[128:131], v11 offset:23552
    v_mfma_f32_16x16x32_bf16 v[168:171], v[132:135], a[32:35], v[168:171]
    v_mfma_f32_16x16x32_bf16 v[168:171], v[136:139], a[40:43], v[168:171]
    v_mfma_f32_16x16x32_bf16 v[168:171], v[140:143], a[48:51], v[168:171]
    v_mfma_f32_16x16x32_bf16 v[168:171], v[144:147], a[56:59], v[168:171]
    v_mfma_f32_16x16x32_bf16 v[172:175], v[132:135], a[36:39], v[172:175]
    ds_read_b128 v[132:135], v11 offset:24576
    v_mfma_f32_16x16x32_bf16 v[172:175], v[136:139], a[44:47], v[172:175]
    ds_read_b128 v[136:139], v11 offset:26624
    v_mfma_f32_16x16x32_bf16 v[172:175], v[140:143], a[52:55], v[172:175]
    ds_read_b128 v[140:143], v11 offset:28672
    v_mfma_f32_16x16x32_bf16 v[172:175], v[144:147], a[60:63], v[172:175]
    ds_read_b128 v[144:147], v11 offset:30720
    v_mfma_f32_16x16x32_bf16 v[160:163], v[148:151], a[64:67], v[160:163]
    v_mfma_f32_16x16x32_bf16 v[160:163], v[104:107], a[72:75], v[160:163]
    v_mfma_f32_16x16x32_bf16 v[160:163], v[108:111], a[80:83], v[160:163]
    v_mfma_f32_16x16x32_bf16 v[160:163], v[112:115], a[88:91], v[160:163]
    v_mfma_f32_16x16x32_bf16 v[164:167], v[148:151], a[68:71], v[164:167]
    ds_read_b128 v[148:151], v11 offset:25600
    v_mfma_f32_16x16x32_bf16 v[164:167], v[104:107], a[76:79], v[164:167]
    ds_read_b128 v[104:107], v11 offset:27648
    v_mfma_f32_16x16x32_bf16 v[164:167], v[108:111], a[84:87], v[164:167]
    ds_read_b128 v[108:111], v11 offset:29696
    v_mfma_f32_16x16x32_bf16 v[164:167], v[112:115], a[92:95], v[164:167]
    s_waitcnt lgkmcnt(3)
    ds_read_b128 v[112:115], v11 offset:31744
    v_mfma_f32_16x16x32_bf16 v[168:171], v[116:119], a[64:67], v[168:171]
    v_mfma_f32_16x16x32_bf16 v[168:171], v[120:123], a[72:75], v[168:171]
    v_mfma_f32_16x16x32_bf16 v[168:171], v[124:127], a[80:83], v[168:171]
    v_mfma_f32_16x16x32_bf16 v[168:171], v[128:131], a[88:91], v[168:171]
    v_mfma_f32_16x16x32_bf16 v[172:175], v[116:119], a[68:71], v[172:175]
    v_mfma_f32_16x16x32_bf16 v[172:175], v[120:123], a[76:79], v[172:175]
    v_mfma_f32_16x16x32_bf16 v[172:175], v[124:127], a[84:87], v[172:175]
    v_mfma_f32_16x16x32_bf16 v[172:175], v[128:131], a[92:95], v[172:175]
    v_mfma_f32_16x16x32_bf16 v[160:163], v[132:135], a[96:99], v[160:163]
    v_mfma_f32_16x16x32_bf16 v[160:163], v[136:139], a[104:107], v[160:163]
    v_mfma_f32_16x16x32_bf16 v[160:163], v[140:143], a[112:115], v[160:163]
    s_waitcnt vmcnt(0)
    buffer_store_dword v31, v23, s[32:35], s74 offen sc1
    v_mfma_f32_16x16x32_bf16 v[160:163], v[144:147], a[120:123], v[160:163]
    s_waitcnt vmcnt(8)
    s_barrier
    ds_read_b128 v[116:119], v12 offset:0
    v_mfma_f32_16x16x32_bf16 v[164:167], v[132:135], a[100:103], v[164:167]
    ds_read_b128 v[120:123], v12 offset:2048
    ds_read_b128 v[124:127], v12 offset:4096
    v_mfma_f32_16x16x32_bf16 v[164:167], v[136:139], a[108:111], v[164:167]
    ds_read_b128 v[128:131], v12 offset:6144
    v_mfma_f32_16x16x32_bf16 v[164:167], v[140:143], a[116:119], v[164:167]
    ds_read_b128 v[132:135], v12 offset:1024
    v_mfma_f32_16x16x32_bf16 v[164:167], v[144:147], a[124:127], v[164:167]
    s_mul_i32 s21, s61, 6
    s_add_u32 s21, s4, s21
    s_add_u32 s21, s21, 128
    s_waitcnt lgkmcnt(5)
    v_mfma_f32_16x16x32_bf16 v[168:171], v[148:151], a[96:99], v[168:171]
    s_mul_i32 s21, s21, 36864
    s_add_u32 s21, s21, s28
    s_add_u32 s21, s21, 7168
    v_mfma_f32_16x16x32_bf16 v[168:171], v[104:107], a[104:107], v[168:171]
    s_mov_b32 m0, s46
    ds_read_b128 v[136:139], v12 offset:3072
    ds_read_b128 v[140:143], v12 offset:5120
    v_mfma_f32_16x16x32_bf16 v[168:171], v[108:111], a[112:115], v[168:171]
    buffer_load_dwordx4 v1, s[56:59], s21 offen sc1 lds
    v_mfma_f32_16x16x32_bf16 v[168:171], v[112:115], a[120:123], v[168:171]
    ds_read_b128 v[144:147], v12 offset:7168
    v_mfma_f32_16x16x32_bf16 v[172:175], v[148:151], a[100:103], v[172:175]
    ds_read_b128 v[148:151], v12 offset:8192
    v_mfma_f32_16x16x32_bf16 v[172:175], v[104:107], a[108:111], v[172:175]
    ds_read_b128 v[104:107], v12 offset:10240
    v_mfma_f32_16x16x32_bf16 v[172:175], v[108:111], a[116:119], v[172:175]
    buffer_load_dwordx4 v1, s[56:59], s21 offen offset:1024 sc1 lds
    v_mfma_f32_16x16x32_bf16 v[172:175], v[112:115], a[124:127], v[172:175]
    s_mul_i32 s21, s61, 6
    s_add_u32 s21, s21, 132
    s_mul_i32 s21, s21, 36864
    s_waitcnt lgkmcnt(3)
    v_mfma_f32_16x16x32_bf16 v[160:163], v[116:119], a[128:131], v[160:163]
    s_add_u32 s21, s21, s28
    s_add_u32 s21, s21, 7168
    s_and_b32 s64, s68, 1024
    v_mfma_f32_16x16x32_bf16 v[160:163], v[120:123], a[136:139], v[160:163]
    s_add_u32 s21, s21, s64
    ds_read_b128 v[108:111], v12 offset:12288
    ds_read_b128 v[112:115], v12 offset:14336
    v_mfma_f32_16x16x32_bf16 v[160:163], v[124:127], a[144:147], v[160:163]
    s_add_u32 m0, s46, 2048
    s_lshl2_add_u32 s64, s61, s65
    s_lshl_b32 s65, s65, 5
    v_mfma_f32_16x16x32_bf16 v[160:163], v[128:131], a[152:155], v[160:163]
    s_add_u32 s65, s65, 1024
    buffer_load_dwordx4 v1, s[56:59], s21 offen sc1 lds
    v_mfma_f32_16x16x32_bf16 v[164:167], v[116:119], a[132:135], v[164:167]
    s_lshl_b32 s64, s64, 6
    ds_read_b128 v[116:119], v12 offset:9216
    v_mfma_f32_16x16x32_bf16 v[164:167], v[120:123], a[140:143], v[164:167]
    s_cmp_eq_u32 s4, s61
    s_cselect_b32 s65, s65, 1073741824
    s_cselect_b32 s70, s23, 1073741824
    v_mfma_f32_16x16x32_bf16 v[164:167], v[124:127], a[148:151], v[164:167]
    ds_read_b128 v[120:123], v12 offset:11264
    ds_read_b128 v[124:127], v12 offset:13312
    v_mfma_f32_16x16x32_bf16 v[164:167], v[128:131], a[156:159], v[164:167]
    ds_read_b128 v[128:131], v12 offset:15360
    v_mfma_f32_16x16x32_bf16 v[168:171], v[132:135], a[128:131], v[168:171]
    v_mfma_f32_16x16x32_bf16 v[168:171], v[136:139], a[136:139], v[168:171]
    v_mfma_f32_16x16x32_bf16 v[168:171], v[140:143], a[144:147], v[168:171]
    s_waitcnt lgkmcnt(3)
    v_mfma_f32_16x16x32_bf16 v[168:171], v[144:147], a[152:155], v[168:171]
    v_mfma_f32_16x16x32_bf16 v[172:175], v[132:135], a[132:135], v[172:175]
    ds_read_b128 v[132:135], v12 offset:16384
    v_mfma_f32_16x16x32_bf16 v[172:175], v[136:139], a[140:143], v[172:175]
    ds_read_b128 v[136:139], v12 offset:18432
    v_mfma_f32_16x16x32_bf16 v[172:175], v[140:143], a[148:151], v[172:175]
    ds_read_b128 v[140:143], v12 offset:20480
    v_mfma_f32_16x16x32_bf16 v[172:175], v[144:147], a[156:159], v[172:175]
    ds_read_b128 v[144:147], v12 offset:22528
    v_mfma_f32_16x16x32_bf16 v[160:163], v[148:151], a[160:163], v[160:163]
    v_mfma_f32_16x16x32_bf16 v[160:163], v[104:107], a[168:171], v[160:163]
    v_mfma_f32_16x16x32_bf16 v[160:163], v[108:111], a[176:179], v[160:163]
    v_mfma_f32_16x16x32_bf16 v[160:163], v[112:115], a[184:187], v[160:163]
    v_mfma_f32_16x16x32_bf16 v[164:167], v[148:151], a[164:167], v[164:167]
    ds_read_b128 v[148:151], v12 offset:17408
    v_mfma_f32_16x16x32_bf16 v[164:167], v[104:107], a[172:175], v[164:167]
    buffer_load_dword v3, v19, s[32:35], s66 offen sc1
    v_mfma_f32_16x16x32_bf16 v[164:167], v[108:111], a[180:183], v[164:167]
    ds_read_b128 v[104:107], v12 offset:19456
    ds_read_b128 v[108:111], v12 offset:21504
    v_mfma_f32_16x16x32_bf16 v[164:167], v[112:115], a[188:191], v[164:167]
    ds_read_b128 v[112:115], v12 offset:23552
    v_mfma_f32_16x16x32_bf16 v[168:171], v[116:119], a[160:163], v[168:171]
    s_waitcnt lgkmcnt(4)
    v_mfma_f32_16x16x32_bf16 v[168:171], v[120:123], a[168:171], v[168:171]
    v_mfma_f32_16x16x32_bf16 v[168:171], v[124:127], a[176:179], v[168:171]
    v_mfma_f32_16x16x32_bf16 v[168:171], v[128:131], a[184:187], v[168:171]
    v_mfma_f32_16x16x32_bf16 v[172:175], v[116:119], a[164:167], v[172:175]
    ds_read_b128 v[116:119], v12 offset:24576
    v_mfma_f32_16x16x32_bf16 v[172:175], v[120:123], a[172:175], v[172:175]
    ds_read_b128 v[120:123], v12 offset:26624
    v_mfma_f32_16x16x32_bf16 v[172:175], v[124:127], a[180:183], v[172:175]
    ds_read_b128 v[124:127], v12 offset:28672
    v_mfma_f32_16x16x32_bf16 v[172:175], v[128:131], a[188:191], v[172:175]
    ds_read_b128 v[128:131], v12 offset:30720
    v_mfma_f32_16x16x32_bf16 v[160:163], v[132:135], a[192:195], v[160:163]
    v_mfma_f32_16x16x32_bf16 v[160:163], v[136:139], a[200:203], v[160:163]
    v_mfma_f32_16x16x32_bf16 v[160:163], v[140:143], a[208:211], v[160:163]
    v_mfma_f32_16x16x32_bf16 v[160:163], v[144:147], a[216:219], v[160:163]
    v_mfma_f32_16x16x32_bf16 v[164:167], v[132:135], a[196:199], v[164:167]
    ds_read_b128 v[132:135], v12 offset:25600
    v_mfma_f32_16x16x32_bf16 v[164:167], v[136:139], a[204:207], v[164:167]
    ds_read_b128 v[136:139], v12 offset:27648
    v_mfma_f32_16x16x32_bf16 v[164:167], v[140:143], a[212:215], v[164:167]
    ds_read_b128 v[140:143], v12 offset:29696
    v_mfma_f32_16x16x32_bf16 v[164:167], v[144:147], a[220:223], v[164:167]
    s_waitcnt lgkmcnt(3)
    ds_read_b128 v[144:147], v12 offset:31744
    v_mfma_f32_16x16x32_bf16 v[168:171], v[148:151], a[192:195], v[168:171]
    v_mfma_f32_16x16x32_bf16 v[168:171], v[104:107], a[200:203], v[168:171]
    v_mfma_f32_16x16x32_bf16 v[168:171], v[108:111], a[208:211], v[168:171]
    v_mfma_f32_16x16x32_bf16 v[168:171], v[112:115], a[216:219], v[168:171]
    v_mfma_f32_16x16x32_bf16 v[172:175], v[148:151], a[196:199], v[172:175]
    v_mfma_f32_16x16x32_bf16 v[172:175], v[104:107], a[204:207], v[172:175]
    v_mfma_f32_16x16x32_bf16 v[172:175], v[108:111], a[212:215], v[172:175]
    v_mfma_f32_16x16x32_bf16 v[172:175], v[112:115], a[220:223], v[172:175]
    v_mfma_f32_16x16x32_bf16 v[160:163], v[116:119], a[224:227], v[160:163]
    s_waitcnt vmcnt(0)
    v_cmp_gt_u32 vcc, 3, v3
    s_nop 1
    s_and_b64 vcc, vcc, exec
    s_cbranch_scc1 SPIN_X
BACK_X:
    v_mfma_f32_16x16x32_bf16 v[160:163], v[120:123], a[232:235], v[160:163]
    buffer_load_dwordx4 v[176:179], v1, s[48:51], s98 offen offset:0 sc1
    v_mfma_f32_16x16x32_bf16 v[160:163], v[124:127], a[240:243], v[160:163]
    s_add_u32 s98, s23, 12288
    buffer_load_dwordx4 v[180:183], v1, s[48:51], s98 offen offset:0 sc1
    v_mfma_f32_16x16x32_bf16 v[160:163], v[128:131], a[248:251], v[160:163]
    s_waitcnt vmcnt(3)
    s_barrier
    ds_read_b128 v[148:151], v13 offset:2048
    v_mfma_f32_16x16x32_bf16 v[164:167], v[116:119], a[228:231], v[164:167]
    s_add_u32 s98, s23, 24576
    ds_read_b128 v[104:107], v13 offset:1024
    ds_read_b128 v[108:111], v13 offset:9216
    v_mfma_f32_16x16x32_bf16 v[164:167], v[120:123], a[236:239], v[164:167]
    buffer_load_dwordx4 v[184:187], v1, s[48:51], s98 offen offset:0 sc1
    v_mfma_f32_16x16x32_bf16 v[164:167], v[124:127], a[244:247], v[164:167]
    s_add_u32 s98, s23, 0
    ds_read_b128 v[112:115], v13 offset:17408
    ds_read_b128 v[116:119], v13 offset:25600
    v_mfma_f32_16x16x32_bf16 v[164:167], v[128:131], a[252:255], v[164:167]
    s_waitcnt lgkmcnt(5)
    ds_read_b128 v[120:123], v13 offset:0
    v_mfma_f32_16x16x32_bf16 v[168:171], v[132:135], a[224:227], v[168:171]
    ds_read_b128 v[124:127], v13 offset:8192
    v_mfma_f32_16x16x32_bf16 v[168:171], v[136:139], a[232:235], v[168:171]
    buffer_load_dwordx4 v[188:191], v1, s[48:51], s98 offen offset:1024 sc1
    v_mfma_f32_16x16x32_bf16 v[168:171], v[140:143], a[240:243], v[168:171]
    s_add_u32 s98, s23, 12288
    ds_read_b128 v[128:131], v13 offset:16384
    v_mfma_f32_16x16x32_bf16 v[168:171], v[144:147], a[248:251], v[168:171]
    v_mfma_f32_16x16x32_bf16 v[172:175], v[132:135], a[228:231], v[172:175]
    ds_read_b128 v[132:135], v13 offset:24576
    v_mfma_f32_16x16x32_bf16 v[172:175], v[136:139], a[236:239], v[172:175]
    buffer_load_dwordx4 v[192:195], v1, s[48:51], s98 offen offset:1024 sc1
    v_mfma_f32_16x16x32_bf16 v[172:175], v[140:143], a[244:247], v[172:175]
    s_add_u32 s98, s23, 24576
    ds_read_b128 v[136:139], v13 offset:10240
    v_mfma_f32_16x16x32_bf16 v[172:175], v[144:147], a[252:255], v[172:175]
    s_waitcnt lgkmcnt(2)
    v_smfmac_f32_16x16x64_bf16 v[160:163], v[148:151], v[64:71], v16
    v_smfmac_f32_16x16x64_bf16 v[164:167], v[148:151], v[72:79], v16
    buffer_load_dwordx4 v[196:199], v1, s[48:51], s98 offen offset:1024 sc1
    v_mfma_f32_16x16x32_bf16 v[168:171], v[104:107], v[32:35], v[168:171]
    s_add_u32 s98, s70, 0
    v_mfma_f32_16x16x32_bf16 v[168:171], v[108:111], v[40:43], v[168:171]
    v_mfma_f32_16x16x32_bf16 v[168:171], v[112:115], v[48:51], v[168:171]
    v_mfma_f32_16x16x32_bf16 v[168:171], v[116:119], v[56:59], v[168:171]
    buffer_load_dwordx4 v[200:203], v1, s[48:51], s98 offen offset:2048 sc1
    v_mfma_f32_16x16x32_bf16 v[172:175], v[104:107], v[36:39], v[172:175]
    s_add_u32 s98, s70, 12288
    v_mfma_f32_16x16x32_bf16 v[172:175], v[108:111], v[44:47], v[172:175]
    v_mfma_f32_16x16x32_bf16 v[172:175], v[112:115], v[52:55], v[172:175]
    v_mfma_f32_16x16x32_bf16 v[172:175], v[116:119], v[60:63], v[172:175]
    buffer_load_dwordx4 v[204:207], v1, s[48:51], s98 offen offset:2048 sc1
    v_mfma_f32_16x16x32_bf16 v[160:163], v[120:123], v[32:35], v[160:163]
    s_add_u32 s98, s70, 24576
    v_mfma_f32_16x16x32_bf16 v[160:163], v[124:127], v[40:43], v[160:163]
    v_mfma_f32_16x16x32_bf16 v[160:163], v[128:131], v[48:51], v[160:163]
    s_waitcnt lgkmcnt(0)
    v_mfma_f32_16x16x32_bf16 v[160:163], v[132:135], v[56:59], v[160:163]
    buffer_load_dwordx4 v[208:211], v1, s[48:51], s98 offen offset:2048 sc1
    v_mfma_f32_16x16x32_bf16 v[164:167], v[120:123], v[36:39], v[164:167]
    v_mfma_f32_16x16x32_bf16 v[164:167], v[124:127], v[44:47], v[164:167]
    v_mfma_f32_16x16x32_bf16 v[164:167], v[128:131], v[52:55], v[164:167]
    v_mfma_f32_16x16x32_bf16 v[164:167], v[132:135], v[60:63], v[164:167]
    v_smfmac_f32_16x16x64_bf16 v[168:171], v[136:139], v[64:71], v16
    v_smfmac_f32_16x16x64_bf16 v[172:175], v[136:139], v[72:79], v16
    s_waitcnt vmcnt(6)
    v_mfma_f32_16x16x32_bf16 v[160:163], v[96:99], v[176:179], v[160:163]
    v_mfma_f32_16x16x32_bf16 v[160:163], v[96:99], v[180:183], v[160:163]
    v_mfma_f32_16x16x32_bf16 v[160:163], v[96:99], v[184:187], v[160:163]
    v_mfma_f32_16x16x32_bf16 v[164:167], v[98:101], v[176:179], v[164:167]
    v_mfma_f32_16x16x32_bf16 v[164:167], v[98:101], v[180:183], v[164:167]
    v_mfma_f32_16x16x32_bf16 v[164:167], v[98:101], v[184:187], v[164:167]
    s_waitcnt vmcnt(3)
    s_nop 0
    v_mfma_f32_16x16x32_bf16 v[168:171], v[96:99], v[188:191], v[168:171]
    v_mfma_f32_16x16x32_bf16 v[168:171], v[96:99], v[192:195], v[168:171]
    v_mfma_f32_16x16x32_bf16 v[168:171], v[96:99], v[196:199], v[168:171]
    v_mfma_f32_16x16x32_bf16 v[172:175], v[98:101], v[188:191], v[172:175]
    v_mfma_f32_16x16x32_bf16 v[172:175], v[98:101], v[192:195], v[172:175]
    v_mfma_f32_16x16x32_bf16 v[172:175], v[98:101], v[196:199], v[172:175]
    v_cvt_pk_bf16_f32 v160, v160, v161
    v_cvt_pk_bf16_f32 v161, v162, v163
    buffer_store_dwordx2 v[160:161], v20, s[24:27], s64 offen
    v_cvt_pk_bf16_f32 v164, v164, v165
    v_cvt_pk_bf16_f32 v165, v166, v167
    buffer_store_dwordx2 v[164:165], v21, s[24:27], s64 offen
    s_cmp_lg_u32 s4, s61
    s_cbranch_scc1 K1_X2
    s_waitcnt vmcnt(2)
    v_mfma_f32_16x16x32_bf16 v[224:227], v[96:99], v[200:203], v[224:227]
    v_mfma_f32_16x16x32_bf16 v[224:227], v[96:99], v[204:207], v[224:227]
    v_mfma_f32_16x16x32_bf16 v[224:227], v[96:99], v[208:211], v[224:227]
    v_mfma_f32_16x16x32_bf16 v[228:231], v[98:101], v[200:203], v[228:231]
    v_mfma_f32_16x16x32_bf16 v[228:231], v[98:101], v[204:207], v[228:231]
    v_mfma_f32_16x16x32_bf16 v[228:231], v[98:101], v[208:211], v[228:231]
    s_nop 4
    v_cvt_pk_bf16_f32 v224, v224, v225
    v_cvt_pk_bf16_f32 v225, v226, v227
    buffer_store_dwordx2 v[224:225], v20, s[24:27], s65 offen
    v_cvt_pk_bf16_f32 v228, v228, v229
    v_cvt_pk_bf16_f32 v229, v230, v231
    buffer_store_dwordx2 v[228:229], v21, s[24:27], s65 offen
K1_X2:
    v_cvt_pk_bf16_f32 v168, v168, v169
    v_cvt_pk_bf16_f32 v169, v170, v171
    buffer_store_dwordx2 v[168:169], v20, s[24:27], s64 offen offset:32
    v_cvt_pk_bf16_f32 v172, v172, v173
    v_cvt_pk_bf16_f32 v173, v174, v175
    buffer_store_dwordx2 v[172:173], v21, s[24:27], s64 offen offset:32
K1_END:
    s_endpgm
K1_LB_MASK:
    v_add_f32 v212, s12, v144
    v_fma_f32 v176, v208, s8, v212
    v_fma_f32 v177, v209, s8, v212
    v_fma_f32 v178, v210, s8, v212
    v_fma_f32 v179, v211, s8, v212
    v_add_f32 v213, s13, v144
    v_fma_f32 v180, v208, s9, v213
    v_fma_f32 v181, v209, s9, v213
    v_fma_f32 v182, v210, s9, v213
    v_fma_f32 v183, v211, s9, v213
    v_add_f32 v212, s14, v144
    v_fma_f32 v184, v208, s10, v212
    v_fma_f32 v185, v209, s10, v212
    v_fma_f32 v186, v210, s10, v212
    v_fma_f32 v187, v211, s10, v212
    v_add_f32 v213, s15, v144
    v_fma_f32 v188, v208, s11, v213
    v_fma_f32 v189, v209, s11, v213
    v_fma_f32 v190, v210, s11, v213
    v_fma_f32 v191, v211, s11, v213
    buffer_load_dword v3, v29, s[32:35], s92 offen sc1
    s_branch K1_LB_BACK
K1_LS_MASK:
    s_cmp_eq_u32 s78, 1
    s_cbranch_scc1 K1_LS_LAST
    buffer_load_dword v3, v29, s[32:35], s92 offen sc1
    v_mov_b32 v218, 1
    s_cmp_eq_u64 s[84:85], 0
    s_cselect_b32 s7, s74, 1073741824
    s_cmp_lg_u32 s83, 0
    s_cselect_b32 s7, s74, s7
    s_waitcnt vmcnt(9)
    buffer_store_dword v218, v216, s[32:35], s7 offen sc1
    s_branch K1_LS_BACK
K1_LS_LAST:
    v_add_f32 v212, s12, v152
    v_fma_f32 v176, v208, s8, v212
    v_fma_f32 v177, v209, s8, v212
    v_fma_f32 v178, v210, s8, v212
    v_fma_f32 v179, v211, s8, v212
    v_add_f32 v213, s13, v152
    v_fma_f32 v180, v208, s9, v213
    v_fma_f32 v181, v209, s9, v213
    v_fma_f32 v182, v210, s9, v213
    v_fma_f32 v183, v211, s9, v213
    v_add_f32 v212, s14, v152
    v_fma_f32 v184, v208, s10, v212
    v_fma_f32 v185, v209, s10, v212
    v_fma_f32 v186, v210, s10, v212
    v_fma_f32 v187, v211, s10, v212
    v_add_f32 v213, s15, v152
    v_fma_f32 v188, v208, s11, v213
    v_fma_f32 v189, v209, s11, v213
    v_fma_f32 v190, v210, s11, v213
    v_fma_f32 v191, v211, s11, v213
    v_cmp_gt_u32 vcc, 1, v3
    s_nop 1
    s_cmp_lg_u32 vcc_lo, 0
    s_cbranch_scc1 SPIN_W0
BACK_W0:
    s_mov_b64 s[36:37], s[56:57]
    s_mov_b32 s38, 5603328
    s_xor_b32 s77, s3, 0
    s_lshl2_add_u32 s77, s77, s4
    s_mul_i32 s77, s77, 36864
    s_add_u32 s77, s77, s28
    s_branch K1_LS_BACK
K1_WMASK:
    v_mov_b32 v9, 0xf149f2ca
    v_cmp_le_u32 vcc, 2, v14
    s_nop 1
    v_cndmask_b32 v141, v9, v141, vcc
    v_cmp_le_u32 vcc, 4, v14
    s_nop 1
    v_cndmask_b32 v142, v9, v142, vcc
    v_cmp_le_u32 vcc, 6, v14
    s_nop 1
    v_cndmask_b32 v143, v9, v143, vcc
    v_cmp_le_u32 vcc, 8, v14
    s_nop 1
    v_cndmask_b32 v144, v9, v144, vcc
    v_cmp_le_u32 vcc, 10, v14
    s_nop 1
    v_cndmask_b32 v145, v9, v145, vcc
    v_cmp_le_u32 vcc, 12, v14
    s_nop 1
    v_cndmask_b32 v146, v9, v146, vcc
    v_cmp_le_u32 vcc, 14, v14
    s_nop 1
    v_cndmask_b32 v147, v9, v147, vcc
    s_branch K1_WMASK_BACK
K1_S7:
    v_mov_b32 v218, 1
    s_cmp_eq_u64 s[84:85], 0
    s_cselect_b32 s7, s74, 1073741824
    s_cmp_lg_u32 s83, 0
    s_cselect_b32 s7, s74, s7
    s_waitcnt vmcnt(8)
    buffer_store_dword v218, v216, s[32:35], s7 offen sc1
    s_branch K1_S7_BACK
K1_J7:
    v_cmp_gt_u32 vcc, 1, v3
    s_nop 1
    s_cmp_lg_u32 vcc_lo, 0
    s_cbranch_scc1 SPIN_W7
BACK_W7:
    s_mov_b64 s[36:37], s[56:57]
    s_mov_b32 s38, 5603328
    s_xor_b32 s77, s3, 0
    s_lshl2_add_u32 s77, s77, s4
    s_mul_i32 s77, s77, 36864
    s_add_u32 s77, s77, s28
    s_branch K1_J7_BACK
K1_REDO:
    s_mov_b32 s83, 1
    s_mov_b32 s63, 1073741824
    s_mov_b32 s64, 1073741824
    s_mov_b32 s62, 1073741824
    s_mul_i32 s7, s5, 1081344
    s_sub_u32 s7, 56623104, s7
    s_sub_u32 s36, s56, s7
    s_subb_u32 s37, s57, 0
    s_mov_b32 s38, 1081344
    s_mov_b32 s50, 0
    s_mov_b32 s54, 0
    s_waitcnt vmcnt(0) lgkmcnt(0)
    s_barrier
    v_lshrrev_b32 v92, 4, v1
    v_and_b32 v64, 15, v92
    v_lshrrev_b32 v92, 4, v92
    v_lshlrev_b32 v92, 2, v92
    v_sub_u32 v92, v64, v92
    s_lshl_b32 s98, s4, 4
    v_add_u32 v92, s98, v92
    s_lshl_b32 s98, s6, 7
    s_sub_u32 s99, 1920, s98
    v_add_u32 v64, s98, v92
    v_add_u32 v65, 64, v64
    v_add_u32 v66, s99, v92
    v_add_u32 v67, 64, v66
    v_mov_b32 v93, 0xf149f2ca
    v_mov_b32 v68, v93
    v_mov_b32 v69, v93
    v_mov_b32 v70, v93
    v_mov_b32 v71, v93
    s_mov_b32 s78, 0
    s_add_u32 s99, s99, 128
K1_REDO_L:
    s_lshr_b32 s7, s78, 6
    s_lshl_b32 s7, s7, 15
    s_bfe_u32 s98, s78, 0x20004
    s_lshl_b32 s98, s98, 12
    s_add_u32 s7, s7, s98
    buffer_load_dwordx4 v[72:75], v1, s[36:39], s7 offen offset:0 sc1
    buffer_load_dwordx4 v[76:79], v1, s[36:39], s7 offen offset:1024 sc1
    buffer_load_dwordx4 v[80:83], v1, s[36:39], s7 offen offset:2048 sc1
    buffer_load_dwordx4 v[84:87], v1, s[36:39], s7 offen offset:3072 sc1
    s_waitcnt vmcnt(0)
    v_mfma_f32_16x16x32_bf16 v[88:91], v[72:75], v[128:131], 0
    v_mfma_f32_16x16x32_bf16 v[88:91], v[76:79], v[160:163], v[88:91]
    v_mfma_f32_16x16x32_bf16 v[88:91], v[80:83], v[192:195], v[88:91]
    v_mfma_f32_16x16x32_bf16 v[88:91], v[84:87], v[224:227], v[88:91]
    v_subrev_u32 v92, s78, v64
    v_cmp_le_i32 vcc, 0, v92
    s_nop 5
    v_cndmask_b32 v88, v93, v88, vcc
    v_max_f32 v68, v68, v88
    v_cmp_le_i32 vcc, 1, v92
    s_nop 1
    v_cndmask_b32 v89, v93, v89, vcc
    v_max_f32 v68, v68, v89
    v_cmp_le_i32 vcc, 2, v92
    s_nop 1
    v_cndmask_b32 v90, v93, v90, vcc
    v_max_f32 v68, v68, v90
    v_cmp_le_i32 vcc, 3, v92
    s_nop 1
    v_cndmask_b32 v91, v93, v91, vcc
    v_max_f32 v68, v68, v91
    v_mfma_f32_16x16x32_bf16 v[88:91], v[72:75], v[132:135], 0
    v_mfma_f32_16x16x32_bf16 v[88:91], v[76:79], v[164:167], v[88:91]
    v_mfma_f32_16x16x32_bf16 v[88:91], v[80:83], v[196:199], v[88:91]
    v_mfma_f32_16x16x32_bf16 v[88:91], v[84:87], v[228:231], v[88:91]
    v_subrev_u32 v92, s78, v65
    v_cmp_le_i32 vcc, 0, v92
    s_nop 5
    v_cndmask_b32 v88, v93, v88, vcc
    v_max_f32 v69, v69, v88
    v_cmp_le_i32 vcc, 1, v92
    s_nop 1
    v_cndmask_b32 v89, v93, v89, vcc
    v_max_f32 v69, v69, v89
    v_cmp_le_i32 vcc, 2, v92
    s_nop 1
    v_cndmask_b32 v90, v93, v90, vcc
    v_max_f32 v69, v69, v90
    v_cmp_le_i32 vcc, 3, v92
    s_nop 1
    v_cndmask_b32 v91, v93, v91, vcc
    v_max_f32 v69, v69, v91
    v_mfma_f32_16x16x32_bf16 v[88:91], v[72:75], v[136:139], 0
    v_mfma_f32_16x16x32_bf16 v[88:91], v[76:79], v[168:171], v[88:91]
    v_mfma_f32_16x16x32_bf16 v[88:91], v[80:83], v[200:203], v[88:91]
    v_mfma_f32_16x16x32_bf16 v[88:91], v[84:87], v[232:235], v[88:91]
    v_subrev_u32 v92, s78, v66
    v_cmp_le_i32 vcc, 0, v92
    s_nop 5
    v_cndmask_b32 v88, v93, v88, vcc
    v_max_f32 v70, v70, v88
    v_cmp_le_i32 vcc, 1, v92
    s_nop 1
    v_cndmask_b32 v89, v93, v89, vcc
    v_max_f32 v70, v70, v89
    v_cmp_le_i32 vcc, 2, v92
    s_nop 1
    v_cndmask_b32 v90, v93, v90, vcc
    v_max_f32 v70, v70, v90
    v_cmp_le_i32 vcc, 3, v92
    s_nop 1
    v_cndmask_b32 v91, v93, v91, vcc
    v_max_f32 v70, v70, v91
    v_mfma_f32_16x16x32_bf16 v[88:91], v[72:75], v[140:143], 0
    v_mfma_f32_16x16x32_bf16 v[88:91], v[76:79], v[172:175], v[88:91]
    v_mfma_f32_16x16x32_bf16 v[88:91], v[80:83], v[204:207], v[88:91]
    v_mfma_f32_16x16x32_bf16 v[88:91], v[84:87], v[236:239], v[88:91]
    v_subrev_u32 v92, s78, v67
    v_cmp_le_i32 vcc, 0, v92
    s_nop 5
    v_cndmask_b32 v88, v93, v88, vcc
    v_max_f32 v71, v71, v88
    v_cmp_le_i32 vcc, 1, v92
    s_nop 1
    v_cndmask_b32 v89, v93, v89, vcc
    v_max_f32 v71, v71, v89
    v_cmp_le_i32 vcc, 2, v92
    s_nop 1
    v_cndmask_b32 v90, v93, v90, vcc
    v_max_f32 v71, v71, v90
    v_cmp_le_i32 vcc, 3, v92
    s_nop 1
    v_cndmask_b32 v91, v93, v91, vcc
    v_max_f32 v71, v71, v91
    s_add_u32 s78, s78, 16
    s_cmp_lt_u32 s78, s99
    s_cbranch_scc1 K1_REDO_L
    v_mov_b32 v92, v68
    s_nop 1
    v_permlane32_swap_b32 v68, v92
    v_max_f32 v68, v68, v92
    v_mov_b32 v92, v68
    s_nop 1
    v_permlane16_swap_b32 v68, v92
    v_max_f32 v68, v68, v92
    v_sub_f32 v144, 0, v68
    v_sub_f32 v145, 0, v68
    v_sub_f32 v146, 0, v68
    v_sub_f32 v147, 0, v68
    v_mov_b32 v92, v69
    s_nop 1
    v_permlane32_swap_b32 v69, v92
    v_max_f32 v69, v69, v92
    v_mov_b32 v92, v69
    s_nop 1
    v_permlane16_swap_b32 v69, v92
    v_max_f32 v69, v69, v92
    v_sub_f32 v148, 0, v69
    v_sub_f32 v149, 0, v69
    v_sub_f32 v150, 0, v69
    v_sub_f32 v151, 0, v69
    v_mov_b32 v92, v70
    s_nop 1
    v_permlane32_swap_b32 v70, v92
    v_max_f32 v70, v70, v92
    v_mov_b32 v92, v70
    s_nop 1
    v_permlane16_swap_b32 v70, v92
    v_max_f32 v70, v70, v92
    v_sub_f32 v152, 0, v70
    v_sub_f32 v153, 0, v70
    v_sub_f32 v154, 0, v70
    v_sub_f32 v155, 0, v70
    v_mov_b32 v92, v71
    s_nop 1
    v_permlane32_swap_b32 v71, v92
    v_max_f32 v71, v71, v92
    v_mov_b32 v92, v71
    s_nop 1
    v_permlane16_swap_b32 v71, v92
    v_max_f32 v71, v71, v92
    v_sub_f32 v156, 0, v71
    v_sub_f32 v157, 0, v71
    v_sub_f32 v158, 0, v71
    v_sub_f32 v159, 0, v71
    v_accvgpr_write_b32 a0, 0
    v_accvgpr_write_b32 a1, 0
    v_accvgpr_write_b32 a2, 0
    v_accvgpr_write_b32 a3, 0
    v_accvgpr_write_b32 a4, 0
    v_accvgpr_write_b32 a5, 0
    v_accvgpr_write_b32 a6, 0
    v_accvgpr_write_b32 a7, 0
    v_accvgpr_write_b32 a8, 0
    v_accvgpr_write_b32 a9, 0
    v_accvgpr_write_b32 a10, 0
    v_accvgpr_write_b32 a11, 0
    v_accvgpr_write_b32 a12, 0
    v_accvgpr_write_b32 a13, 0
    v_accvgpr_write_b32 a14, 0
    v_accvgpr_write_b32 a15, 0
    v_accvgpr_write_b32 a16, 0
    v_accvgpr_write_b32 a17, 0
    v_accvgpr_write_b32 a18, 0
    v_accvgpr_write_b32 a19, 0
    v_accvgpr_write_b32 a20, 0
    v_accvgpr_write_b32 a21, 0
    v_accvgpr_write_b32 a22, 0
    v_accvgpr_write_b32 a23, 0
    v_accvgpr_write_b32 a24, 0
    v_accvgpr_write_b32 a25, 0
    v_accvgpr_write_b32 a26, 0
    v_accvgpr_write_b32 a27, 0
    v_accvgpr_write_b32 a28, 0
    v_accvgpr_write_b32 a29, 0
    v_accvgpr_write_b32 a30, 0
    v_accvgpr_write_b32 a31, 0
    v_accvgpr_write_b32 a32, 0
    v_accvgpr_write_b32 a33, 0
    v_accvgpr_write_b32 a34, 0
    v_accvgpr_write_b32 a35, 0
    v_accvgpr_write_b32 a36, 0
    v_accvgpr_write_b32 a37, 0
    v_accvgpr_write_b32 a38, 0
    v_accvgpr_write_b32 a39, 0
    v_accvgpr_write_b32 a40, 0
    v_accvgpr_write_b32 a41, 0
    v_accvgpr_write_b32 a42, 0
    v_accvgpr_write_b32 a43, 0
    v_accvgpr_write_b32 a44, 0
    v_accvgpr_write_b32 a45, 0
    v_accvgpr_write_b32 a46, 0
    v_accvgpr_write_b32 a47, 0
    v_accvgpr_write_b32 a48, 0
    v_accvgpr_write_b32 a49, 0
    v_accvgpr_write_b32 a50, 0
    v_accvgpr_write_b32 a51, 0
    v_accvgpr_write_b32 a52, 0
    v_accvgpr_write_b32 a53, 0
    v_accvgpr_write_b32 a54, 0
    v_accvgpr_write_b32 a55, 0
    v_accvgpr_write_b32 a56, 0
    v_accvgpr_write_b32 a57, 0
    v_accvgpr_write_b32 a58, 0
    v_accvgpr_write_b32 a59, 0
    v_accvgpr_write_b32 a60, 0
    v_accvgpr_write_b32 a61, 0
    v_accvgpr_write_b32 a62, 0
    v_accvgpr_write_b32 a63, 0
    v_accvgpr_write_b32 a144, 0
    v_accvgpr_write_b32 a145, 0
    v_accvgpr_write_b32 a146, 0
    v_accvgpr_write_b32 a147, 0
    v_accvgpr_write_b32 a148, 0
    v_accvgpr_write_b32 a149, 0
    v_accvgpr_write_b32 a150, 0
    v_accvgpr_write_b32 a151, 0
    v_accvgpr_write_b32 a152, 0
    v_accvgpr_write_b32 a153, 0
    v_accvgpr_write_b32 a154, 0
    v_accvgpr_write_b32 a155, 0
    v_accvgpr_write_b32 a156, 0
    v_accvgpr_write_b32 a157, 0
    v_accvgpr_write_b32 a158, 0
    v_accvgpr_write_b32 a159, 0
    v_accvgpr_write_b32 a160, 0
    v_accvgpr_write_b32 a161, 0
    v_accvgpr_write_b32 a162, 0
    v_accvgpr_write_b32 a163, 0
    v_accvgpr_write_b32 a164, 0
    v_accvgpr_write_b32 a165, 0
    v_accvgpr_write_b32 a166, 0
    v_accvgpr_write_b32 a167, 0
    v_accvgpr_write_b32 a168, 0
    v_accvgpr_write_b32 a169, 0
    v_accvgpr_write_b32 a170, 0
    v_accvgpr_write_b32 a171, 0
    v_accvgpr_write_b32 a172, 0
    v_accvgpr_write_b32 a173, 0
    v_accvgpr_write_b32 a174, 0
    v_accvgpr_write_b32 a175, 0
    v_accvgpr_write_b32 a176, 0
    v_accvgpr_write_b32 a177, 0
    v_accvgpr_write_b32 a178, 0
    v_accvgpr_write_b32 a179, 0
    v_accvgpr_write_b32 a180, 0
    v_accvgpr_write_b32 a181, 0
    v_accvgpr_write_b32 a182, 0
    v_accvgpr_write_b32 a183, 0
    v_accvgpr_write_b32 a184, 0
    v_accvgpr_write_b32 a185, 0
    v_accvgpr_write_b32 a186, 0
    v_accvgpr_write_b32 a187, 0
    v_accvgpr_write_b32 a188, 0
    v_accvgpr_write_b32 a189, 0
    v_accvgpr_write_b32 a190, 0
    v_accvgpr_write_b32 a191, 0
    v_accvgpr_write_b32 a192, 0
    v_accvgpr_write_b32 a193, 0
    v_accvgpr_write_b32 a194, 0
    v_accvgpr_write_b32 a195, 0
    v_accvgpr_write_b32 a196, 0
    v_accvgpr_write_b32 a197, 0
    v_accvgpr_write_b32 a198, 0
    v_accvgpr_write_b32 a199, 0
    v_accvgpr_write_b32 a200, 0
    v_accvgpr_write_b32 a201, 0
    v_accvgpr_write_b32 a202, 0
    v_accvgpr_write_b32 a203, 0
    v_accvgpr_write_b32 a204, 0
    v_accvgpr_write_b32 a205, 0
    v_accvgpr_write_b32 a206, 0
    v_accvgpr_write_b32 a207, 0
    v_accvgpr_write_b32 a208, 0
    v_accvgpr_write_b32 a209, 0
    v_accvgpr_write_b32 a210, 0
    v_accvgpr_write_b32 a211, 0
    v_accvgpr_write_b32 a212, 0
    v_accvgpr_write_b32 a213, 0
    v_accvgpr_write_b32 a214, 0
    v_accvgpr_write_b32 a215, 0
    v_accvgpr_write_b32 a216, 0
    v_accvgpr_write_b32 a217, 0
    v_accvgpr_write_b32 a218, 0
    v_accvgpr_write_b32 a219, 0
    v_accvgpr_write_b32 a220, 0
    v_accvgpr_write_b32 a221, 0
    v_accvgpr_write_b32 a222, 0
    v_accvgpr_write_b32 a223, 0
    v_bfe_u32 v92, v1, 4, 1
    v_sub_u32 v92, 0, v92
    v_and_b32 v92, 0xaaaaaaaa, v92
    v_or_b32 v215, 0x44444444, v92
    v_bfe_u32 v92, v1, 5, 1
    v_cmp_eq_u32 vcc, 0, v92
    v_mov_b32 v92, 0x3f803f80
    s_nop 0
    v_cndmask_b32 v92, 0, v92, vcc
    v_accvgpr_write_b32 a136, v92
    v_accvgpr_write_b32 a137, v92
    v_accvgpr_write_b32 a138, v92
    v_accvgpr_write_b32 a139, v92
    s_mov_b32 s77, s75
    s_mov_b32 s76, 0
    s_mov_b32 s38, 16384
    s_add_u32 m0, s76, s75
    s_nop 0
    buffer_load_dwordx4 v1, s[36:39], s77 offen sc1 lds
    buffer_load_dwordx4 v1, s[36:39], s77 offen offset:1024 sc1 lds
    buffer_load_dwordx4 v1, s[36:39], s77 offen offset:2048 sc1 lds
    buffer_load_dwordx4 v1, s[36:39], s77 offen offset:3072 sc1 lds
    s_add_u32 s100, s77, 4096
    s_add_u32 m0, m0, 4096
    s_nop 0
    buffer_load_dwordx4 v1, s[36:39], s100 offen sc1 lds
    buffer_load_dwordx4 v1, s[36:39], s100 offen offset:1024 sc1 lds
    buffer_load_dwordx4 v1, s[36:39], s100 offen offset:2048 sc1 lds
    buffer_load_dwordx4 v1, s[36:39], s100 offen offset:3072 sc1 lds
    s_add_u32 s77, s77, 32768
    s_add_u32 s76, s76, 32768
    s_lshr_b32 s82, s4, 1
    s_add_u32 s82, s82, 32
    s_sub_u32 s82, s82, s6
    s_sub_u32 s82, s82, s6
    s_lshl_b32 s38, s82, 15
    s_add_u32 m0, s76, s75
    s_nop 0
    buffer_load_dwordx4 v1, s[36:39], s77 offen sc1 lds
    buffer_load_dwordx4 v1, s[36:39], s77 offen offset:1024 sc1 lds
    buffer_load_dwordx4 v1, s[36:39], s77 offen offset:2048 sc1 lds
    buffer_load_dwordx4 v1, s[36:39], s77 offen offset:3072 sc1 lds
    s_add_u32 s100, s77, 4096
    s_add_u32 m0, m0, 4096
    s_nop 0
    buffer_load_dwordx4 v1, s[36:39], s100 offen sc1 lds
    buffer_load_dwordx4 v1, s[36:39], s100 offen offset:1024 sc1 lds
    buffer_load_dwordx4 v1, s[36:39], s100 offen offset:2048 sc1 lds
    buffer_load_dwordx4 v1, s[36:39], s100 offen offset:3072 sc1 lds
    s_add_u32 s77, s77, 32768
    s_add_u32 s76, s76, 32768
    s_add_u32 m0, s76, s75
    s_nop 0
    buffer_load_dwordx4 v1, s[36:39], s77 offen sc1 lds
    buffer_load_dwordx4 v1, s[36:39], s77 offen offset:1024 sc1 lds
    buffer_load_dwordx4 v1, s[36:39], s77 offen offset:2048 sc1 lds
    buffer_load_dwordx4 v1, s[36:39], s77 offen offset:3072 sc1 lds
    s_add_u32 s100, s77, 4096
    s_add_u32 m0, m0, 4096
    s_nop 0
    buffer_load_dwordx4 v1, s[36:39], s100 offen sc1 lds
    buffer_load_dwordx4 v1, s[36:39], s100 offen offset:1024 sc1 lds
    buffer_load_dwordx4 v1, s[36:39], s100 offen offset:2048 sc1 lds
    buffer_load_dwordx4 v1, s[36:39], s100 offen offset:3072 sc1 lds
    s_add_u32 s77, s77, 32768
    s_add_u32 s76, s76, 32768
    s_mov_b32 s82, 0
    s_mov_b32 s95, 32768
    s_mov_b32 s93, 65536
    s_mov_b32 s60, 131072
    v_mov_b32 v2, v1
    s_cmp_eq_u32 s6, 0
    s_cselect_b32 s16, s8, 0
    s_cselect_b32 s17, s9, 0
    s_cmp_eq_u32 s6, 0
    s_cselect_b32 s18, s10, 0
    s_cselect_b32 s19, s11, 0
    s_cmp_eq_u32 s6, 0
    s_cselect_b32 s20, s12, 0
    s_cselect_b32 s21, s13, 0
    s_cmp_eq_u32 s6, 0
    s_cselect_b32 s22, s14, 0
    s_cselect_b32 s23, s15, 0
    s_waitcnt vmcnt(16)
    s_barrier
    ds_read_b128 a[224:227], v2 offset:0
    ds_read_b128 a[228:231], v2 offset:1024
    ds_read_b128 a[232:235], v2 offset:2048
    ds_read_b128 a[236:239], v2 offset:3072
    s_waitcnt lgkmcnt(0)
    ds_read_b128 a[240:243], v2 offset:4096
    ds_read_b128 a[244:247], v2 offset:5120
    ds_read_b128 a[248:251], v2 offset:6144
    ds_read_b128 a[252:255], v2 offset:7168
    v_mul_f32 v176, s16, v208
    v_mul_f32 v177, s16, v209
    v_mul_f32 v178, s16, v210
    v_mul_f32 v179, s16, v211
    s_nop 1
    v_mfma_f32_16x16x32_bf16 v[240:243], a[224:227], v[128:131], v[176:179]
    v_mfma_f32_16x16x32_bf16 v[240:243], a[228:231], v[160:163], v[240:243]
    v_mfma_f32_16x16x32_bf16 v[240:243], a[232:235], v[192:195], v[240:243]
    v_mfma_f32_16x16x32_bf16 v[240:243], a[236:239], v[224:227], v[240:243]
    v_mfma_f32_16x16x32_bf16 v[244:247], a[224:227], v[132:135], 0
    v_mfma_f32_16x16x32_bf16 v[244:247], a[228:231], v[164:167], v[244:247]
    v_mfma_f32_16x16x32_bf16 v[244:247], a[232:235], v[196:199], v[244:247]
    v_mfma_f32_16x16x32_bf16 v[244:247], a[236:239], v[228:231], v[244:247]
    v_mfma_f32_16x16x32_bf16 v[248:251], a[224:227], v[136:139], 0
    v_mfma_f32_16x16x32_bf16 v[248:251], a[228:231], v[168:171], v[248:251]
    v_mfma_f32_16x16x32_bf16 v[248:251], a[232:235], v[200:203], v[248:251]
    v_mfma_f32_16x16x32_bf16 v[248:251], a[236:239], v[232:235], v[248:251]
    v_mfma_f32_16x16x32_bf16 v[252:255], a[224:227], v[140:143], 0
    v_mfma_f32_16x16x32_bf16 v[252:255], a[228:231], v[172:175], v[252:255]
    v_mfma_f32_16x16x32_bf16 v[252:255], a[232:235], v[204:207], v[252:255]
    v_mfma_f32_16x16x32_bf16 v[252:255], a[236:239], v[236:239], v[252:255]
    v_add_f32 v240, v240, v144
    v_exp_f32 v240, v240
    v_add_f32 v241, v241, v144
    v_exp_f32 v241, v241
    v_add_f32 v242, v242, v144
    v_exp_f32 v242, v242
    v_add_f32 v243, v243, v144
    v_exp_f32 v243, v243
    v_add_f32 v244, v244, v148
    v_exp_f32 v244, v244
    v_add_f32 v245, v245, v148
    v_exp_f32 v245, v245
    v_add_f32 v246, v246, v148
    v_exp_f32 v246, v246
    v_add_f32 v247, v247, v148
    v_exp_f32 v247, v247
    v_add_f32 v248, v248, v152
    v_exp_f32 v248, v248
    v_add_f32 v249, v249, v152
    v_exp_f32 v249, v249
    v_add_f32 v250, v250, v152
    v_exp_f32 v250, v250
    v_add_f32 v251, v251, v152
    v_exp_f32 v251, v251
    v_add_f32 v252, v252, v156
    v_exp_f32 v252, v252
    v_add_f32 v253, v253, v156
    v_exp_f32 v253, v253
    v_add_f32 v254, v254, v156
    v_exp_f32 v254, v254
    v_add_f32 v255, v255, v156
    v_exp_f32 v255, v255
    s_nop 1
    s_branch K1_ATT
SPIN_WA:
    s_mov_b32 s94, 0
SPIN_WA_L:
    s_sleep 2
    buffer_load_dword v7, v9, s[44:47], s69 offen sc1
    s_add_u32 s94, s94, 1
    s_cmp_ge_u32 s94, 0x40000
    s_waitcnt vmcnt(0)
    s_cbranch_scc1 BACK_WA
    v_cmp_gt_u32 vcc, 8, v7
    s_nop 1
    s_and_b64 vcc, vcc, s[86:87]
    s_cbranch_scc1 SPIN_WA_L
    s_branch BACK_WA
SPIN_KV:
    s_mov_b32 s94, 0
SPIN_KV_L:
    s_sleep 2
    buffer_load_dword v7, v8, s[32:35], s61 offen sc1
    s_add_u32 s94, s94, 1
    s_cmp_ge_u32 s94, 0x40000
    s_waitcnt vmcnt(0)
    s_cbranch_scc1 BACK_KV
    v_cmp_gt_u32 vcc, 1, v7
    s_nop 1
    s_and_b64 vcc, vcc, exec
    s_cbranch_scc1 SPIN_KV_L
    s_branch BACK_KV
SPIN_SHORT:
    s_mov_b32 s94, 0
SPIN_SHORT_L:
    s_sleep 2
    buffer_load_dword v3, v217, s[32:35], s19 offen sc1
    s_add_u32 s94, s94, 1
    s_cmp_ge_u32 s94, 0x40000
    s_waitcnt vmcnt(0)
    s_cbranch_scc1 BACK_SHORT
    v_cmp_gt_u32 vcc, 1, v3
    s_nop 1
    s_and_b64 vcc, vcc, exec
    s_cbranch_scc1 SPIN_SHORT_L
    s_branch BACK_SHORT
SPIN_CTX:
    s_mov_b32 s94, 0
SPIN_CTX_L:
    s_sleep 2
    buffer_load_dword v3, v217, s[32:35], s19 offen sc1
    s_add_u32 s94, s94, 1
    s_cmp_ge_u32 s94, 0x40000
    s_waitcnt vmcnt(0)
    s_cbranch_scc1 BACK_CTX
    v_cmp_gt_u32 vcc, 2, v3
    s_nop 1
    s_and_b64 vcc, vcc, exec
    s_cbranch_scc1 SPIN_CTX_L
    s_branch BACK_CTX
SPIN_ALL:
    s_mov_b32 s94, 0
SPIN_ALL_L:
    s_sleep 2
    buffer_load_dword v28, v29, s[32:35], s92 offen sc1
    s_add_u32 s94, s94, 1
    s_cmp_ge_u32 s94, 0x40000
    s_waitcnt vmcnt(0)
    s_cbranch_scc1 BACK_ALL
    v_cmp_gt_u32 vcc, 1, v28
    s_nop 1
    s_and_b64 vcc, vcc, exec
    s_cbranch_scc1 SPIN_ALL_L
    s_branch BACK_ALL
SPIN_OA:
    s_mov_b32 s94, 0
SPIN_OA_L:
    s_sleep 2
    buffer_load_dword v3, v19, s[32:35], s66 offen sc1
    s_add_u32 s94, s94, 1
    s_cmp_ge_u32 s94, 0x40000
    s_waitcnt vmcnt(0)
    s_cbranch_scc1 BACK_OA
    v_cmp_gt_u32 vcc, 3, v3
    s_nop 1
    s_and_b64 vcc, vcc, exec
    s_cbranch_scc1 SPIN_OA_L
    s_branch BACK_OA
SPIN_X:
    s_mov_b32 s94, 0
SPIN_X_L:
    s_sleep 2
    buffer_load_dword v3, v19, s[32:35], s66 offen sc1
    s_add_u32 s94, s94, 1
    s_cmp_ge_u32 s94, 0x40000
    s_waitcnt vmcnt(0)
    s_cbranch_scc1 BACK_X
    v_cmp_gt_u32 vcc, 3, v3
    s_nop 1
    s_and_b64 vcc, vcc, exec
    s_cbranch_scc1 SPIN_X_L
    s_branch BACK_X
SPIN_W0:
    s_mov_b32 s94, 0
SPIN_W0_L:
    s_sleep 2
    buffer_load_dword v3, v29, s[32:35], s92 offen sc1
    s_add_u32 s94, s94, 1
    s_cmp_ge_u32 s94, 0x40000
    s_waitcnt vmcnt(0)
    s_cbranch_scc1 BACK_W0
    v_cmp_gt_u32 vcc, 1, v3
    s_nop 1
    s_cmp_lg_u32 vcc_lo, 0
    s_cbranch_scc1 SPIN_W0_L
    s_branch BACK_W0
SPIN_W7:
    s_mov_b32 s94, 0
SPIN_W7_L:
    s_sleep 2
    buffer_load_dword v3, v29, s[32:35], s92 offen sc1
    s_add_u32 s94, s94, 1
    s_cmp_ge_u32 s94, 0x40000
    s_waitcnt vmcnt(0)
    s_cbranch_scc1 BACK_W7
    v_cmp_gt_u32 vcc, 1, v3
    s_nop 1
    s_cmp_lg_u32 vcc_lo, 0
    s_cbranch_scc1 SPIN_W7_L
    s_branch BACK_W7
.section .rodata,"a"
.p2align 6
.amdhsa_kernel gated_mix__sliding_local_dilated__compressed_kv_cla__prompt_kernel
.amdhsa_next_free_vgpr 512
.amdhsa_next_free_sgpr 102
.amdhsa_accum_offset 256
.amdhsa_group_segment_fixed_size 0
.amdhsa_kernarg_size 104
.amdhsa_user_sgpr_count 2
.amdhsa_user_sgpr_kernarg_segment_ptr 1
.amdhsa_system_sgpr_workgroup_id_x 1
.amdhsa_ieee_mode 0
.amdhsa_dx10_clamp 0
.end_amdhsa_kernel
```

```asm
; @launch grid=(256,1,1) block=(256,1,1) lds=163840
.amdgcn_target "amdgcn-amd-amdhsa--gfx950"
.text
.globl gated_mix__sliding_local_dilated__compressed_kv_cla__prompt_kernel
.p2align 8
.type gated_mix__sliding_local_dilated__compressed_kv_cla__prompt_kernel,@function
gated_mix__sliding_local_dilated__compressed_kv_cla__prompt_kernel:
    s_cmp_ge_u32 s2, 256
    s_cbranch_scc1 K1_END
    s_getpc_b64 s[94:95]
    s_load_dwordx8 s[36:43], s[0:1], 32
    v_min_u32 v74, 16, v0
    s_lshr_b32 s7, s2, 3
    s_mul_i32 s7, s7, 17
    v_add_lshl_u32 v74, v74, s7, 7
    global_load_dword v76, v74, s[94:95]
    v_lshrrev_b32 v64, 6, v0
    v_and_b32 v31, 63, v0
    v_readfirstlane_b32 s4, v64
    s_and_b32 s5, s2, 7
    s_lshl_b32 s5, s5, 2
    s_bfe_u32 s7, s2, 0x20003
    s_add_u32 s5, s5, s7
    s_lshr_b32 s6, s2, 5
    s_lshl_b32 s69, s4, 12
    s_mov_b32 s10, 2097152
    s_mov_b32 s11, 0x20000
    s_mov_b32 s14, 4194304
    s_mov_b32 s15, 0x20000
    s_mov_b32 s18, 4194304
    s_mov_b32 s19, 0x20000
    v_lshrrev_b32 v65, 3, v31
    v_and_b32 v66, 7, v31
    v_lshrrev_b32 v67, 1, v65
    v_xor_b32 v66, v66, v67
    v_lshlrev_b32 v66, 4, v66
    v_xor_b32 v67, 64, v66
    s_lshr_b32 s7, s4, 1
    s_lshl_b32 s73, s7, 7
    s_and_b32 s100, s4, 1
    s_lshl_b32 s98, s100, 5
    s_add_u32 s98, s98, s73
    v_add_lshl_u32 v68, v65, s98, 10
    v_add_u32 v6, v68, v66
    v_add_u32 v7, v68, v67
    v_add_u32 v7, 7168, v7
    v_add_u32 v8, v68, v66
    v_add_u32 v8, 14336, v8
    v_add_u32 v9, v68, v67
    v_add_u32 v9, 21504, v9
    v_lshrrev_b32 v69, 4, v31
    v_and_b32 v70, 15, v31
    v_lshlrev_b32 v71, 1, v69
    v_xor_b32 v71, v71, v70
    v_lshlrev_b32 v71, 4, v71
    v_xor_b32 v72, 128, v71
    s_lshl_b32 s98, s4, 4
    v_add_lshl_u32 v73, v69, s98, 13
    v_add_u32 v2, v73, v71
    v_add_u32 v3, v73, v71
    v_add_u32 v3, 31744, v3
    v_add_u32 v4, v73, v72
    v_add_u32 v4, 63488, v4
    v_add_u32 v5, v73, v72
    v_add_u32 v5, 95232, v5
    s_and_b32 s3, s2, 0
    s_lshl_b32 s66, s3, 7
    s_lshl_b32 s60, s3, 11
    s_add_u32 s60, s60, s5
    s_lshl_b32 s60, s60, 8
    s_lshl_b32 s61, s6, 18
    s_add_u32 s61, s61, s66
    s_add_u32 s62, s61, 65536
    s_waitcnt lgkmcnt(0)
    s_mov_b64 s[8:9], s[36:37]
    s_mov_b64 s[24:25], s[38:39]
    s_mov_b64 s[12:13], s[40:41]
    s_mov_b64 s[16:17], s[42:43]
    s_load_dwordx2 s[20:21], s[0:1], 0
    s_load_dwordx2 s[28:29], s[0:1], 8
    s_load_dwordx2 s[32:33], s[0:1], 72
    s_load_dwordx2 s[48:49], s[0:1], 64
    s_load_dwordx2 s[92:93], s[0:1], 16
    s_load_dwordx2 s[44:45], s[0:1], 88
    s_load_dwordx2 s[56:57], s[0:1], 96
    s_load_dwordx2 s[0:1], s[0:1], 80
    s_add_u32 m0, s69, 0
    s_nop 0
    buffer_load_dwordx4 v6, s[8:11], s61 offen lds
    buffer_load_dwordx4 v7, s[8:11], s61 offen offset:1024 lds
    buffer_load_dwordx4 v8, s[8:11], s61 offen offset:2048 lds
    buffer_load_dwordx4 v9, s[8:11], s61 offen offset:3072 lds
    s_xor_b32 s61, s61, 128
    s_add_u32 m0, s69, 16384
    s_nop 0
    buffer_load_dwordx4 v6, s[8:11], s62 offen lds
    buffer_load_dwordx4 v7, s[8:11], s62 offen offset:1024 lds
    buffer_load_dwordx4 v8, s[8:11], s62 offen offset:2048 lds
    buffer_load_dwordx4 v9, s[8:11], s62 offen offset:3072 lds
    s_xor_b32 s62, s62, 128
    s_add_u32 m0, s69, 32768
    s_nop 0
    buffer_load_dwordx4 v2, s[12:15], s60 offen nt lds
    buffer_load_dwordx4 v3, s[12:15], s60 offen offset:1024 nt lds
    buffer_load_dwordx4 v4, s[12:15], s60 offen offset:2048 nt lds
    buffer_load_dwordx4 v5, s[12:15], s60 offen offset:3072 nt lds
    s_add_u32 m0, s69, 49152
    s_nop 0
    buffer_load_dwordx4 v6, s[8:11], s61 offen lds
    buffer_load_dwordx4 v7, s[8:11], s61 offen offset:1024 lds
    buffer_load_dwordx4 v8, s[8:11], s61 offen offset:2048 lds
    buffer_load_dwordx4 v9, s[8:11], s61 offen offset:3072 lds
    s_xor_b32 s61, s61, 384
    v_min_u32 v74, 15, v31
    s_lshl2_add_u32 s98, s2, s4
    s_lshl_b32 s98, s98, 11
    v_lshlrev_b32 v74, 7, v74
    buffer_load_dword v117, v74, s[8:11], s98 offen
    s_waitcnt lgkmcnt(0)
    s_mov_b32 s22, 2359296
    s_mov_b32 s23, 0x20000
    s_mov_b32 s26, 4718592
    s_mov_b32 s27, 0x20000
    s_mov_b32 s50, 4718592
    s_mov_b32 s51, 0x20000
    s_mov_b32 s46, 256
    s_mov_b32 s47, 0x20000
    s_mov_b32 s30, 1990656
    s_mov_b32 s31, 0x20000
    s_mov_b32 s34, 1152
    s_mov_b32 s35, 0x20000
    s_mul_i32 s7, s5, 1081344
    s_add_u32 s36, s56, s7
    s_addc_u32 s37, s57, 0
    s_mov_b32 s38, 1081344
    s_mov_b32 s39, 0x20000
    s_cmp_eq_u32 s4, 0
    s_cselect_b32 s86, 0x55555555, 0
    s_cselect_b32 s87, 0x55555555, 0
    s_cselect_b32 s52, s48, s92
    s_cselect_b32 s53, s49, s93
    s_cselect_b32 s54, s50, 663552
    s_mov_b32 s55, 0x20000
    s_mul_i32 s63, s6, 147456
    s_sub_u32 s64, 2211840, s63
    s_add_u32 s63, s63, s66
    s_add_u32 s64, s64, s66
    s_lshl_b32 s67, s4, 11
    s_lshl_b32 s68, s4, 10
    s_lshl_b32 s75, s4, 13
    s_lshl_b32 s65, s3, 13
    s_add_u32 s65, s65, s67
    s_lshl_b32 s70, s6, 2
    s_lshl1_add_u32 s70, s100, s70
    s_lshl_b32 s70, s70, 15
    s_lshl_b32 s98, s73, 6
    s_add_u32 s71, s70, s98
    s_add_u32 s71, s71, 49152
    s_lshl_b32 s98, s73, 4
    s_add_u32 s70, s70, s98
    v_lshlrev_b32 v1, 4, v31
    v_mov_b32 v77, 1073741824
    v_cmp_eq_u32 vcc, 0, v0
    s_nop 1
    v_cndmask_b32_e64 v30, v77, 0, vcc
    v_lshlrev_b32 v103, 7, v31
    v_cmp_gt_u32 vcc, 9, v31
    s_nop 1
    v_cndmask_b32 v103, v77, v103, vcc
    s_lshl_b32 s98, s4, 5
    v_add_u32 v68, s98, v65
    v_mul_u32_u24 v68, 1152, v68
    v_add_u32 v10, v68, v66
    v_add_u32 v11, v68, v67
    v_add_u32 v11, 8192, v11
    v_add_u32 v12, v68, v66
    v_add_u32 v12, 16384, v12
    v_add_u32 v13, v68, v67
    v_add_u32 v13, 24576, v13
    v_lshrrev_b32 v71, 1, v70
    v_xor_b32 v71, v71, v69
    v_lshlrev_b32 v71, 4, v71
    v_lshl_add_u32 v71, v70, 7, v71
    s_add_u32 m0, s69, 65536
    s_nop 0
    buffer_load_dwordx4 v2, s[16:19], s60 offen nt lds
    v_xor_b32 v72, 64, v71
    s_lshl_b32 s98, s100, 13
    v_add_u32 v22, s98, v71
    v_add_u32 v23, s98, v72
    v_add_u32 v24, s67, v71
    v_add_u32 v25, s67, v72
    v_bfe_u32 v73, v31, 2, 2
    v_and_b32 v74, 3, v31
    v_lshl_add_u32 v75, v69, 3, v73
    v_and_b32 v78, 1, v69
    v_lshl_add_u32 v77, v78, 2, v73
    v_lshlrev_b32 v77, 5, v77
    v_lshl_add_u32 v77, v74, 3, v77
    v_lshl_add_u32 v77, v75, 8, v77
    v_xor_b32 v14, 0, v77
    v_xor_b32 v14, s73, v14
    buffer_load_dwordx4 v3, s[16:19], s60 offen offset:1024 nt lds
    v_xor_b32 v15, 32, v77
    v_xor_b32 v15, s73, v15
    v_xor_b32 v16, 64, v77
    v_xor_b32 v16, s73, v16
    v_xor_b32 v17, 96, v77
    v_xor_b32 v17, s73, v17
    v_xor_b32 v18, 128, v77
    v_xor_b32 v19, 160, v77
    v_xor_b32 v20, 192, v77
    v_xor_b32 v21, 224, v77
    v_lshrrev_b32 v77, 1, v73
    v_lshl_add_u32 v77, v78, 1, v77
    v_lshlrev_b32 v77, 5, v77
    v_lshl_add_u32 v77, v74, 3, v77
    v_lshl_add_u32 v77, v75, 7, v77
    s_lshr_b32 s98, s73, 1
    buffer_load_dwordx4 v4, s[16:19], s60 offen offset:2048 nt lds
    v_xor_b32 v26, 0, v77
    v_xor_b32 v26, s98, v26
    v_xor_b32 v27, 32, v77
    v_xor_b32 v28, 64, v77
    v_xor_b32 v28, s98, v28
    v_xor_b32 v29, 96, v77
    v_and_b32 v73, 7, v0
    v_lshrrev_b32 v74, 3, v0
    v_lshl_add_u32 v75, v73, 1, 0
    v_mul_u32_u24 v78, 52, v75
    v_lshrrev_b32 v78, 8, v78
    v_mul_u32_u24 v79, 5, v78
    v_sub_u32 v75, v75, v79
    v_add_u32 v78, 1, v78
    v_cmp_le_u32 vcc, 3, v78
    s_nop 1
    v_cndmask_b32_e64 v78, v78, 0, vcc
    buffer_load_dwordx4 v5, s[16:19], s60 offen offset:3072 nt lds
    s_xor_b32 s60, s60, 524288
    v_mul_u32_u24 v78, 1152, v78
    v_lshl_add_u32 v75, v75, 3, v78
    v_mad_u32_u24 v75, v74, 36, v75
    v_lshl_add_u32 v77, v73, 1, 1
    v_mul_u32_u24 v78, 52, v77
    v_lshrrev_b32 v78, 8, v78
    v_mul_u32_u24 v79, 5, v78
    v_sub_u32 v77, v77, v79
    v_add_u32 v78, 1, v78
    v_cmp_le_u32 vcc, 3, v78
    s_nop 1
    v_cndmask_b32_e64 v78, v78, 0, vcc
    v_mul_u32_u24 v78, 1152, v78
    v_lshl_add_u32 v77, v77, 3, v78
    v_mad_u32_u24 v77, v74, 36, v77
    s_mul_i32 s98, s2, 10368
    s_mul_i32 s99, s2, 6
    s_mov_b32 s7, 73728
    v_mul_lo_u32 v95, v74, s7
    v_lshl_add_u32 v95, v73, 4, v95
    v_cmp_eq_u32 s[92:93], 7, v73
    s_add_u32 s56, s56, 56623104
    s_addc_u32 s57, s57, 0
    s_mov_b32 s58, 5603328
    s_mov_b32 s59, 0x20000
    s_lshl_b32 s101, s6, 5
    s_add_u32 s101, s101, s5
    s_lshl_b32 s101, s101, 7
    v_mov_b32 v65, 0
    v_lshrrev_b32 v64, 2, v0
    v_lshlrev_b32 v64, 15, v64
    v_and_b32 v79, 3, v0
    v_lshl_add_u32 v64, v79, 2, v64
    s_mov_b32 s74, 0x3e0293ee
    s_lshl_b32 s95, s5, 3
    s_waitcnt vmcnt(5)
    s_barrier
    ds_read_b128 a[0:3], v22 offset:0
    ds_read_b64_tr_b16 v[40:41], v14 offset:32768
    ds_read_b64_tr_b16 v[42:43], v14 offset:33792
    ds_read_b128 a[4:7], v23 offset:0
    ds_read_b64_tr_b16 v[44:45], v14 offset:40960
    ds_read_b64_tr_b16 v[46:47], v14 offset:41984
    ds_read_b128 a[8:11], v22 offset:2048
    ds_read_b128 a[12:15], v23 offset:2048
    ds_read_b128 a[16:19], v22 offset:4096
    ds_read_b128 a[20:23], v23 offset:4096
    ds_read_b128 a[24:27], v22 offset:6144
    ds_read_b128 a[28:31], v23 offset:6144
    ds_read_b128 a[32:35], v22 offset:16384
    ds_read_b128 a[36:39], v23 offset:16384
    ds_read_b128 a[40:43], v22 offset:18432
    s_waitcnt lgkmcnt(14)
    ds_read_b128 a[44:47], v23 offset:18432
    s_waitcnt lgkmcnt(14)
    ds_read_b128 a[48:51], v22 offset:20480
    s_waitcnt lgkmcnt(14)
    ds_read_b128 a[52:55], v23 offset:20480
    s_waitcnt lgkmcnt(14)
    ds_read_b128 a[56:59], v22 offset:22528
    s_waitcnt lgkmcnt(14)
    ds_read_b128 a[60:63], v23 offset:22528
    v_mfma_f32_16x16x32_bf16 v[128:131], v[40:43], a[0:3], 0
    s_add_u32 m0, s69, 81920
    s_waitcnt lgkmcnt(14)
    ds_read_b64_tr_b16 v[48:49], v15 offset:32768
    s_waitcnt lgkmcnt(14)
    ds_read_b64_tr_b16 v[50:51], v15 offset:33792
    v_mfma_f32_16x16x32_bf16 v[128:131], v[44:47], a[4:7], v[128:131]
    s_mul_i32 s77, s2, 9216
    buffer_load_dwordx4 v6, s[8:11], s62 offen lds
    v_mfma_f32_16x16x32_bf16 v[132:135], v[40:43], a[8:11], 0
    s_mul_i32 s76, s4, 1152
    s_waitcnt lgkmcnt(14)
    ds_read_b128 a[64:67], v22 offset:49152
    s_waitcnt lgkmcnt(13)
    ds_read_b64_tr_b16 v[52:53], v15 offset:40960
    v_mfma_f32_16x16x32_bf16 v[132:135], v[44:47], a[12:15], v[132:135]
    s_add_u32 s77, s77, s76
    ds_read_b64_tr_b16 v[54:55], v15 offset:41984
    s_waitcnt lgkmcnt(10)
    ds_read_b64_tr_b16 v[56:57], v16 offset:32768
    v_mfma_f32_16x16x32_bf16 v[136:139], v[40:43], a[16:19], 0
    s_mul_i32 s76, s4, 1152
    buffer_load_dwordx4 v7, s[8:11], s62 offen offset:1024 lds
    v_mfma_f32_16x16x32_bf16 v[136:139], v[44:47], a[20:23], v[136:139]
    s_mul_i32 s72, s2, 3
    ds_read_b64_tr_b16 v[58:59], v16 offset:33792
    ds_read_b64_tr_b16 v[60:61], v16 offset:40960
    v_mfma_f32_16x16x32_bf16 v[140:143], v[40:43], a[24:27], 0
    s_add_u32 s72, s72, 0
    ds_read_b64_tr_b16 v[62:63], v16 offset:41984
    v_add_u32 v14, 0x10000, v14
    v_mfma_f32_16x16x32_bf16 v[140:143], v[44:47], a[28:31], v[140:143]
    s_mul_i32 s7, s5, 73728
    ds_read_b128 a[68:71], v23 offset:49152
    v_add_u32 v15, 0x10000, v15
    v_mfma_f32_16x16x32_bf16 v[144:147], v[40:43], a[32:35], 0
    s_and_b32 s100, s5, 1
    buffer_load_dwordx4 v8, s[8:11], s62 offen offset:2048 lds
    v_mfma_f32_16x16x32_bf16 v[144:147], v[44:47], a[36:39], v[144:147]
    s_mov_b32 s83, 0
    v_add_u32 v16, 0x10000, v16
    v_mov_b32 v31, 1
    v_mfma_f32_16x16x32_bf16 v[148:151], v[40:43], a[40:43], 0
    s_mov_b32 vcc_lo, 0x84848484
    s_mov_b32 vcc_hi, 0x84848484
    v_add_u32 v18, 0x10000, v18
    s_waitcnt lgkmcnt(2)
    v_mfma_f32_16x16x32_bf16 v[148:151], v[44:47], a[44:47], v[148:151]
    v_add_u32 v19, 0x10000, v19
    v_add_u32 v20, 0x10000, v20
    v_mfma_f32_16x16x32_bf16 v[152:155], v[40:43], a[48:51], 0
    buffer_load_dwordx4 v9, s[8:11], s62 offen offset:3072 lds
    v_mfma_f32_16x16x32_bf16 v[152:155], v[44:47], a[52:55], v[152:155]
    ds_read_b128 a[72:75], v22 offset:51200
    v_add_u32 v21, 0x10000, v21
    v_mfma_f32_16x16x32_bf16 v[156:159], v[40:43], a[56:59], 0
    s_add_u32 m0, s69, 98304
    ds_read_b64_tr_b16 v[40:41], v17 offset:32768
    ds_read_b64_tr_b16 v[42:43], v17 offset:33792
    v_mfma_f32_16x16x32_bf16 v[156:159], v[44:47], a[60:63], v[156:159]
    s_xor_b32 s62, s62, 384
    ds_read_b64_tr_b16 v[44:45], v17 offset:40960
    ds_read_b64_tr_b16 v[46:47], v17 offset:41984
    v_mfma_f32_16x16x32_bf16 v[160:163], v[48:51], a[0:3], 0
    buffer_load_dwordx4 v2, s[12:15], s60 offen nt lds
    v_mfma_f32_16x16x32_bf16 v[160:163], v[52:55], a[4:7], v[160:163]
    v_add_u32 v17, 0x10000, v17
    v_add_u32 v26, 0x10000, v26
    v_mfma_f32_16x16x32_bf16 v[164:167], v[48:51], a[8:11], 0
    ds_read_b128 a[76:79], v23 offset:51200
    v_add_u32 v27, 0x10000, v27
    v_mfma_f32_16x16x32_bf16 v[164:167], v[52:55], a[12:15], v[164:167]
    v_add_u32 v28, 0x10000, v28
    v_add_u32 v29, 0x10000, v29
    v_mfma_f32_16x16x32_bf16 v[168:171], v[48:51], a[16:19], 0
    buffer_load_dwordx4 v3, s[12:15], s60 offen offset:1024 nt lds
    v_mfma_f32_16x16x32_bf16 v[168:171], v[52:55], a[20:23], v[168:171]
    v_bfe_u32 v37, v1, 4, 4
    v_mul_u32_u24 v36, 1152, v37
    v_mfma_f32_16x16x32_bf16 v[172:175], v[48:51], a[24:27], 0
    v_lshrrev_b32 v38, 8, v1
    v_lshl_add_u32 v36, v38, 4, v36
    v_mfma_f32_16x16x32_bf16 v[172:175], v[52:55], a[28:31], v[172:175]
    v_lshrrev_b32 v39, 3, v37
    v_mul_u32_u24 v39, 9152, v39
    v_mfma_f32_16x16x32_bf16 v[176:179], v[48:51], a[32:35], 0
    buffer_load_dwordx4 v4, s[12:15], s60 offen offset:2048 nt lds
    v_mfma_f32_16x16x32_bf16 v[176:179], v[52:55], a[36:39], v[176:179]
    ds_read_b128 a[80:83], v22 offset:53248
    v_mfma_f32_16x16x32_bf16 v[180:183], v[48:51], a[40:43], 0
    v_mfma_f32_16x16x32_bf16 v[180:183], v[52:55], a[44:47], v[180:183]
    v_mfma_f32_16x16x32_bf16 v[184:187], v[48:51], a[48:51], 0
    buffer_load_dwordx4 v5, s[12:15], s60 offen offset:3072 nt lds
    v_mfma_f32_16x16x32_bf16 v[184:187], v[52:55], a[52:55], v[184:187]
    ds_read_b128 a[84:87], v23 offset:53248
    v_mfma_f32_16x16x32_bf16 v[188:191], v[48:51], a[56:59], 0
    s_add_u32 m0, s69, 114688
    v_mfma_f32_16x16x32_bf16 v[188:191], v[52:55], a[60:63], v[188:191]
    v_mfma_f32_16x16x32_bf16 v[192:195], v[56:59], a[0:3], 0
    s_waitcnt lgkmcnt(1)
    buffer_load_dwordx4 v6, s[8:11], s61 offen lds
    v_mfma_f32_16x16x32_bf16 v[192:195], v[60:63], a[4:7], v[192:195]
    v_mfma_f32_16x16x32_bf16 v[196:199], v[56:59], a[8:11], 0
    v_mfma_f32_16x16x32_bf16 v[196:199], v[60:63], a[12:15], v[196:199]
    ds_read_b128 a[88:91], v22 offset:55296
    v_mfma_f32_16x16x32_bf16 v[200:203], v[56:59], a[16:19], 0
    buffer_load_dwordx4 v7, s[8:11], s61 offen offset:1024 lds
    v_mfma_f32_16x16x32_bf16 v[200:203], v[60:63], a[20:23], v[200:203]
    v_mfma_f32_16x16x32_bf16 v[204:207], v[56:59], a[24:27], 0
    v_mfma_f32_16x16x32_bf16 v[204:207], v[60:63], a[28:31], v[204:207]
    v_mfma_f32_16x16x32_bf16 v[208:211], v[56:59], a[32:35], 0
    buffer_load_dwordx4 v8, s[8:11], s61 offen offset:2048 lds
    v_mfma_f32_16x16x32_bf16 v[208:211], v[60:63], a[36:39], v[208:211]
    ds_read_b128 a[92:95], v23 offset:55296
    v_mfma_f32_16x16x32_bf16 v[212:215], v[56:59], a[40:43], 0
    v_mfma_f32_16x16x32_bf16 v[212:215], v[60:63], a[44:47], v[212:215]
    v_mfma_f32_16x16x32_bf16 v[216:219], v[56:59], a[48:51], 0
    buffer_load_dwordx4 v9, s[8:11], s61 offen offset:3072 lds
    v_mfma_f32_16x16x32_bf16 v[216:219], v[60:63], a[52:55], v[216:219]
    v_mfma_f32_16x16x32_bf16 v[220:223], v[56:59], a[56:59], 0
    s_xor_b32 s61, s61, 128
    v_mfma_f32_16x16x32_bf16 v[220:223], v[60:63], a[60:63], v[220:223]
    s_add_u32 m0, s69, 131072
    v_mfma_f32_16x16x32_bf16 v[224:227], v[40:43], a[0:3], 0
    buffer_load_dwordx4 v2, s[16:19], s60 offen nt lds
    v_mfma_f32_16x16x32_bf16 v[224:227], v[44:47], a[4:7], v[224:227]
    v_mfma_f32_16x16x32_bf16 v[228:231], v[40:43], a[8:11], 0
    buffer_load_dword v104, v103, s[20:23], s77 offen
    v_mfma_f32_16x16x32_bf16 v[228:231], v[44:47], a[12:15], v[228:231]
    s_add_u32 s77, s77, 4608
    v_mfma_f32_16x16x32_bf16 v[232:235], v[40:43], a[16:19], 0
    v_mfma_f32_16x16x32_bf16 v[232:235], v[44:47], a[20:23], v[232:235]
    s_waitcnt vmcnt(10)
    s_barrier
    ds_read_b64_tr_b16 v[48:49], v14 offset:0
    v_mfma_f32_16x16x32_bf16 v[236:239], v[40:43], a[24:27], 0
    buffer_load_dwordx4 v3, s[16:19], s60 offen offset:1024 nt lds
    v_mfma_f32_16x16x32_bf16 v[236:239], v[44:47], a[28:31], v[236:239]
    ds_read_b64_tr_b16 v[50:51], v14 offset:1024
    ds_read_b64_tr_b16 v[52:53], v14 offset:8192
    v_mfma_f32_16x16x32_bf16 v[240:243], v[40:43], a[32:35], 0
    ds_read_b64_tr_b16 v[54:55], v14 offset:9216
    ds_read_b64_tr_b16 v[56:57], v15 offset:0
    v_mfma_f32_16x16x32_bf16 v[240:243], v[44:47], a[36:39], v[240:243]
    buffer_load_dwordx4 v4, s[16:19], s60 offen offset:2048 nt lds
    v_mfma_f32_16x16x32_bf16 v[244:247], v[40:43], a[40:43], 0
    ds_read_b64_tr_b16 v[58:59], v15 offset:1024
    ds_read_b64_tr_b16 v[60:61], v15 offset:8192
    v_mfma_f32_16x16x32_bf16 v[244:247], v[44:47], a[44:47], v[244:247]
    ds_read_b64_tr_b16 v[62:63], v15 offset:9216
    v_mfma_f32_16x16x32_bf16 v[248:251], v[40:43], a[48:51], 0
    v_mfma_f32_16x16x32_bf16 v[248:251], v[44:47], a[52:55], v[248:251]
    buffer_load_dwordx4 v5, s[16:19], s60 offen offset:3072 nt lds
    v_mfma_f32_16x16x32_bf16 v[252:255], v[40:43], a[56:59], 0
    ds_read_b64_tr_b16 v[40:41], v16 offset:0
    ds_read_b64_tr_b16 v[42:43], v16 offset:1024
    v_mfma_f32_16x16x32_bf16 v[252:255], v[44:47], a[60:63], v[252:255]
    s_waitcnt lgkmcnt(3)
    ds_read_b64_tr_b16 v[44:45], v16 offset:8192
    ds_read_b64_tr_b16 v[46:47], v16 offset:9216
    v_mfma_f32_16x16x32_bf16 a[128:131], a[0:3], v[48:51], 0
    v_mfma_f32_16x16x32_bf16 a[128:131], a[4:7], v[52:55], a[128:131]
    s_add_u32 m0, s69, 147456
    v_add_u32 v22, 0x10000, v22
    v_mfma_f32_16x16x32_bf16 a[132:135], a[8:11], v[48:51], 0
    s_xor_b32 s60, s60, 1572864
    buffer_load_dwordx4 v6, s[8:11], s62 offen lds
    v_mfma_f32_16x16x32_bf16 a[132:135], a[12:15], v[52:55], a[132:135]
    ds_read_b128 a[96:99], v22 offset:16384
    v_mfma_f32_16x16x32_bf16 a[136:139], a[16:19], v[48:51], 0
    v_mfma_f32_16x16x32_bf16 a[136:139], a[20:23], v[52:55], a[136:139]
    v_mfma_f32_16x16x32_bf16 a[140:143], a[24:27], v[48:51], 0
    buffer_load_dwordx4 v7, s[8:11], s62 offen offset:1024 lds
    v_mfma_f32_16x16x32_bf16 a[140:143], a[28:31], v[52:55], a[140:143]
    v_add_u32 v23, 0x10000, v23
    ds_read_b128 a[100:103], v23 offset:16384
    v_mfma_f32_16x16x32_bf16 a[144:147], a[32:35], v[48:51], 0
    v_mfma_f32_16x16x32_bf16 a[144:147], a[36:39], v[52:55], a[144:147]
    v_mfma_f32_16x16x32_bf16 a[148:151], a[40:43], v[48:51], 0
    v_mfma_f32_16x16x32_bf16 a[148:151], a[44:47], v[52:55], a[148:151]
    buffer_load_dwordx4 v8, s[8:11], s62 offen offset:2048 lds
    v_mfma_f32_16x16x32_bf16 a[152:155], a[48:51], v[48:51], 0
    v_mfma_f32_16x16x32_bf16 a[152:155], a[52:55], v[52:55], a[152:155]
    ds_read_b128 a[104:107], v22 offset:18432
    v_mfma_f32_16x16x32_bf16 a[156:159], a[56:59], v[48:51], 0
    ds_read_b64_tr_b16 v[48:49], v17 offset:0
    ds_read_b64_tr_b16 v[50:51], v17 offset:1024
    v_mfma_f32_16x16x32_bf16 a[156:159], a[60:63], v[52:55], a[156:159]
    buffer_load_dwordx4 v9, s[8:11], s62 offen offset:3072 lds
    v_mfma_f32_16x16x32_bf16 a[160:163], a[0:3], v[56:59], 0
    s_waitcnt lgkmcnt(3)
    ds_read_b64_tr_b16 v[52:53], v17 offset:8192
    ds_read_b64_tr_b16 v[54:55], v17 offset:9216
    v_mfma_f32_16x16x32_bf16 a[160:163], a[4:7], v[60:63], a[160:163]
    v_mfma_f32_16x16x32_bf16 a[164:167], a[8:11], v[56:59], 0
    ds_read_b128 a[108:111], v23 offset:18432
    v_mfma_f32_16x16x32_bf16 a[164:167], a[12:15], v[60:63], a[164:167]
    s_add_u32 m0, s69, 0
    v_mfma_f32_16x16x32_bf16 a[168:171], a[16:19], v[56:59], 0
    s_xor_b32 s62, s62, 128
    buffer_load_dwordx4 v2, s[12:15], s60 offen nt lds
    v_mfma_f32_16x16x32_bf16 a[168:171], a[20:23], v[60:63], a[168:171]
    v_mfma_f32_16x16x32_bf16 a[172:175], a[24:27], v[56:59], 0
    v_mfma_f32_16x16x32_bf16 a[172:175], a[28:31], v[60:63], a[172:175]
    v_mfma_f32_16x16x32_bf16 a[176:179], a[32:35], v[56:59], 0
    buffer_load_dwordx4 v3, s[12:15], s60 offen offset:1024 nt lds
    v_mfma_f32_16x16x32_bf16 a[176:179], a[36:39], v[60:63], a[176:179]
    ds_read_b128 a[112:115], v22 offset:20480
    v_mfma_f32_16x16x32_bf16 a[180:183], a[40:43], v[56:59], 0
    v_mfma_f32_16x16x32_bf16 a[180:183], a[44:47], v[60:63], a[180:183]
    v_mfma_f32_16x16x32_bf16 a[184:187], a[48:51], v[56:59], 0
    v_mfma_f32_16x16x32_bf16 a[184:187], a[52:55], v[60:63], a[184:187]
    buffer_load_dwordx4 v4, s[12:15], s60 offen offset:2048 nt lds
    v_mfma_f32_16x16x32_bf16 a[188:191], a[56:59], v[56:59], 0
    ds_read_b128 a[116:119], v23 offset:20480
    v_mfma_f32_16x16x32_bf16 a[188:191], a[60:63], v[60:63], a[188:191]
    v_mfma_f32_16x16x32_bf16 a[192:195], a[0:3], v[40:43], 0
    v_mfma_f32_16x16x32_bf16 a[192:195], a[4:7], v[44:47], a[192:195]
    buffer_load_dwordx4 v5, s[12:15], s60 offen offset:3072 nt lds
    v_mfma_f32_16x16x32_bf16 a[196:199], a[8:11], v[40:43], 0
    v_mfma_f32_16x16x32_bf16 a[196:199], a[12:15], v[44:47], a[196:199]
    ds_read_b128 a[120:123], v22 offset:22528
    v_mfma_f32_16x16x32_bf16 a[200:203], a[16:19], v[40:43], 0
    v_mfma_f32_16x16x32_bf16 a[200:203], a[20:23], v[44:47], a[200:203]
    s_add_u32 m0, s69, 16384
    v_mfma_f32_16x16x32_bf16 a[204:207], a[24:27], v[40:43], 0
    buffer_load_dwordx4 v6, s[8:11], s61 offen lds
    v_mfma_f32_16x16x32_bf16 a[204:207], a[28:31], v[44:47], a[204:207]
    v_mfma_f32_16x16x32_bf16 a[208:211], a[32:35], v[40:43], 0
    ds_read_b128 a[124:127], v23 offset:22528
    v_mfma_f32_16x16x32_bf16 a[208:211], a[36:39], v[44:47], a[208:211]
    v_mfma_f32_16x16x32_bf16 a[212:215], a[40:43], v[40:43], 0
    buffer_load_dwordx4 v7, s[8:11], s61 offen offset:1024 lds
    v_mfma_f32_16x16x32_bf16 a[212:215], a[44:47], v[44:47], a[212:215]
    v_mfma_f32_16x16x32_bf16 a[216:219], a[48:51], v[40:43], 0
    v_mfma_f32_16x16x32_bf16 a[216:219], a[52:55], v[44:47], a[216:219]
    v_mfma_f32_16x16x32_bf16 a[220:223], a[56:59], v[40:43], 0
    v_mfma_f32_16x16x32_bf16 a[220:223], a[60:63], v[44:47], a[220:223]
    s_waitcnt lgkmcnt(0)
    buffer_load_dwordx4 v8, s[8:11], s61 offen offset:2048 lds
    v_mfma_f32_16x16x32_bf16 a[224:227], a[0:3], v[48:51], 0
    v_mfma_f32_16x16x32_bf16 a[224:227], a[4:7], v[52:55], a[224:227]
    v_mfma_f32_16x16x32_bf16 a[228:231], a[8:11], v[48:51], 0
    v_mfma_f32_16x16x32_bf16 a[228:231], a[12:15], v[52:55], a[228:231]
    buffer_load_dwordx4 v9, s[8:11], s61 offen offset:3072 lds
    v_mfma_f32_16x16x32_bf16 a[232:235], a[16:19], v[48:51], 0
    v_mfma_f32_16x16x32_bf16 a[232:235], a[20:23], v[52:55], a[232:235]
    s_waitcnt vmcnt(8) lgkmcnt(0)
    s_barrier
    ds_read_b64_tr_b16 v[56:57], v14 offset:32768
    v_mfma_f32_16x16x32_bf16 a[236:239], a[24:27], v[48:51], 0
    s_add_u32 m0, s69, 32768
    ds_read_b64_tr_b16 v[58:59], v14 offset:33792
    ds_read_b64_tr_b16 v[60:61], v14 offset:40960
    v_mfma_f32_16x16x32_bf16 a[236:239], a[28:31], v[52:55], a[236:239]
    s_xor_b32 s61, s61, 896
    buffer_load_dwordx4 v2, s[16:19], s60 offen nt lds
    v_mfma_f32_16x16x32_bf16 a[240:243], a[32:35], v[48:51], 0
    ds_read_b64_tr_b16 v[62:63], v14 offset:41984
    ds_read_b64_tr_b16 v[40:41], v15 offset:32768
    v_mfma_f32_16x16x32_bf16 a[240:243], a[36:39], v[52:55], a[240:243]
    ds_read_b64_tr_b16 v[42:43], v15 offset:33792
    ds_read_b64_tr_b16 v[44:45], v15 offset:40960
    v_mfma_f32_16x16x32_bf16 a[244:247], a[40:43], v[48:51], 0
    ds_read_b64_tr_b16 v[46:47], v15 offset:41984
    v_add_u32 v14, 0x10000, v14
    v_mfma_f32_16x16x32_bf16 a[244:247], a[44:47], v[52:55], a[244:247]
    v_add_u32 v15, 0x10000, v15
    v_mfma_f32_16x16x32_bf16 a[248:251], a[48:51], v[48:51], 0
    v_mfma_f32_16x16x32_bf16 a[248:251], a[52:55], v[52:55], a[248:251]
    buffer_load_dwordx4 v3, s[16:19], s60 offen offset:1024 nt lds
    v_mfma_f32_16x16x32_bf16 a[252:255], a[56:59], v[48:51], 0
    ds_read_b64_tr_b16 v[48:49], v16 offset:32768
    ds_read_b64_tr_b16 v[50:51], v16 offset:33792
    v_mfma_f32_16x16x32_bf16 a[252:255], a[60:63], v[52:55], a[252:255]
    s_waitcnt lgkmcnt(2)
    ds_read_b64_tr_b16 v[52:53], v16 offset:40960
    ds_read_b64_tr_b16 v[54:55], v16 offset:41984
    v_mfma_f32_16x16x32_bf16 v[128:131], v[56:59], a[64:67], v[128:131]
    v_add_u32 v16, 0x10000, v16
    v_mfma_f32_16x16x32_bf16 v[128:131], v[60:63], a[68:71], v[128:131]
    v_mfma_f32_16x16x32_bf16 v[132:135], v[56:59], a[72:75], v[132:135]
    ds_read_b128 a[0:3], v22 offset:49152
    v_mfma_f32_16x16x32_bf16 v[132:135], v[60:63], a[76:79], v[132:135]
    v_mfma_f32_16x16x32_bf16 v[136:139], v[56:59], a[80:83], v[136:139]
    v_mfma_f32_16x16x32_bf16 v[136:139], v[60:63], a[84:87], v[136:139]
    buffer_load_dwordx4 v4, s[16:19], s60 offen offset:2048 nt lds
    v_mfma_f32_16x16x32_bf16 v[140:143], v[56:59], a[88:91], v[140:143]
    v_mfma_f32_16x16x32_bf16 v[140:143], v[60:63], a[92:95], v[140:143]
    ds_read_b128 a[4:7], v23 offset:49152
    v_mfma_f32_16x16x32_bf16 v[144:147], v[56:59], a[96:99], v[144:147]
    v_mfma_f32_16x16x32_bf16 v[144:147], v[60:63], a[100:103], v[144:147]
    v_mfma_f32_16x16x32_bf16 v[148:151], v[56:59], a[104:107], v[148:151]
    v_mfma_f32_16x16x32_bf16 v[148:151], v[60:63], a[108:111], v[148:151]
    v_mfma_f32_16x16x32_bf16 v[152:155], v[56:59], a[112:115], v[152:155]
    buffer_load_dwordx4 v5, s[16:19], s60 offen offset:3072 nt lds
    v_mfma_f32_16x16x32_bf16 v[152:155], v[60:63], a[116:119], v[152:155]
    ds_read_b128 a[8:11], v22 offset:51200
    v_mfma_f32_16x16x32_bf16 v[156:159], v[56:59], a[120:123], v[156:159]
    ds_read_b64_tr_b16 v[56:57], v17 offset:32768
    ds_read_b64_tr_b16 v[58:59], v17 offset:33792
    v_mfma_f32_16x16x32_bf16 v[156:159], v[60:63], a[124:127], v[156:159]
    ds_read_b64_tr_b16 v[60:61], v17 offset:40960
    ds_read_b64_tr_b16 v[62:63], v17 offset:41984
    v_mfma_f32_16x16x32_bf16 v[160:163], v[40:43], a[64:67], v[160:163]
    v_add_u32 v17, 0x10000, v17
    v_mfma_f32_16x16x32_bf16 v[160:163], v[44:47], a[68:71], v[160:163]
    v_mfma_f32_16x16x32_bf16 v[164:167], v[40:43], a[72:75], v[164:167]
    ds_read_b128 a[12:15], v23 offset:51200
    v_mfma_f32_16x16x32_bf16 v[164:167], v[44:47], a[76:79], v[164:167]
    s_add_u32 m0, s69, 49152
    v_mfma_f32_16x16x32_bf16 v[168:171], v[40:43], a[80:83], v[168:171]
    s_xor_b32 s60, s60, 524288
    buffer_load_dwordx4 v6, s[8:11], s62 offen lds
    v_mfma_f32_16x16x32_bf16 v[168:171], v[44:47], a[84:87], v[168:171]
    v_mfma_f32_16x16x32_bf16 v[172:175], v[40:43], a[88:91], v[172:175]
    v_mfma_f32_16x16x32_bf16 v[172:175], v[44:47], a[92:95], v[172:175]
    v_mfma_f32_16x16x32_bf16 v[176:179], v[40:43], a[96:99], v[176:179]
    ds_read_b128 a[16:19], v22 offset:53248
    v_mfma_f32_16x16x32_bf16 v[176:179], v[44:47], a[100:103], v[176:179]
    v_mfma_f32_16x16x32_bf16 v[180:183], v[40:43], a[104:107], v[180:183]
    v_mfma_f32_16x16x32_bf16 v[180:183], v[44:47], a[108:111], v[180:183]
    buffer_load_dwordx4 v7, s[8:11], s62 offen offset:1024 lds
    v_mfma_f32_16x16x32_bf16 v[184:187], v[40:43], a[112:115], v[184:187]
    v_mfma_f32_16x16x32_bf16 v[184:187], v[44:47], a[116:119], v[184:187]
    ds_read_b128 a[20:23], v23 offset:53248
    v_mfma_f32_16x16x32_bf16 v[188:191], v[40:43], a[120:123], v[188:191]
    s_waitcnt lgkmcnt(1)
    ds_read_b64_tr_b16 v[40:41], v14 offset:0
    ds_read_b64_tr_b16 v[42:43], v14 offset:1024
    v_mfma_f32_16x16x32_bf16 v[188:191], v[44:47], a[124:127], v[188:191]
    ds_read_b64_tr_b16 v[44:45], v14 offset:8192
    ds_read_b64_tr_b16 v[46:47], v14 offset:9216
    v_mfma_f32_16x16x32_bf16 v[192:195], v[48:51], a[64:67], v[192:195]
    v_add_u32 v14, 0xfffe0000, v14
    v_mfma_f32_16x16x32_bf16 v[192:195], v[52:55], a[68:71], v[192:195]
    v_mfma_f32_16x16x32_bf16 v[196:199], v[48:51], a[72:75], v[196:199]
    v_mfma_f32_16x16x32_bf16 v[196:199], v[52:55], a[76:79], v[196:199]
    buffer_load_dwordx4 v8, s[8:11], s62 offen offset:2048 lds
    v_mfma_f32_16x16x32_bf16 v[200:203], v[48:51], a[80:83], v[200:203]
    ds_read_b128 a[24:27], v22 offset:55296
    v_mfma_f32_16x16x32_bf16 v[200:203], v[52:55], a[84:87], v[200:203]
    v_mfma_f32_16x16x32_bf16 v[204:207], v[48:51], a[88:91], v[204:207]
    v_mfma_f32_16x16x32_bf16 v[204:207], v[52:55], a[92:95], v[204:207]
    v_mfma_f32_16x16x32_bf16 v[208:211], v[48:51], a[96:99], v[208:211]
    ds_read_b128 a[28:31], v23 offset:55296
    v_mfma_f32_16x16x32_bf16 v[208:211], v[52:55], a[100:103], v[208:211]
    v_mfma_f32_16x16x32_bf16 v[212:215], v[48:51], a[104:107], v[212:215]
    buffer_load_dwordx4 v9, s[8:11], s62 offen offset:3072 lds
    v_mfma_f32_16x16x32_bf16 v[212:215], v[52:55], a[108:111], v[212:215]
    v_mfma_f32_16x16x32_bf16 v[216:219], v[48:51], a[112:115], v[216:219]
    v_mfma_f32_16x16x32_bf16 v[216:219], v[52:55], a[116:119], v[216:219]
    v_mfma_f32_16x16x32_bf16 v[220:223], v[48:51], a[120:123], v[220:223]
    ds_read_b64_tr_b16 v[48:49], v15 offset:0
    ds_read_b64_tr_b16 v[50:51], v15 offset:1024
    v_mfma_f32_16x16x32_bf16 v[220:223], v[52:55], a[124:127], v[220:223]
    ds_read_b64_tr_b16 v[52:53], v15 offset:8192
    ds_read_b64_tr_b16 v[54:55], v15 offset:9216
    v_mfma_f32_16x16x32_bf16 v[224:227], v[56:59], a[64:67], v[224:227]
    buffer_load_dwordx2 v[80:81], v75, s[28:31], s98 offen nt
    v_mfma_f32_16x16x32_bf16 v[224:227], v[60:63], a[68:71], v[224:227]
    s_xor_b32 s62, s62, 896
    v_add_u32 v15, 0xfffe0000, v15
    v_mfma_f32_16x16x32_bf16 v[228:231], v[56:59], a[72:75], v[228:231]
    buffer_load_dword v105, v103, s[20:23], s77 offen
    v_mfma_f32_16x16x32_bf16 v[228:231], v[60:63], a[76:79], v[228:231]
    s_mul_i32 s77, s2, 18432
    v_mfma_f32_16x16x32_bf16 v[232:235], v[56:59], a[80:83], v[232:235]
    s_add_u32 s77, s77, s76
    buffer_load_dwordx2 v[82:83], v77, s[28:31], s98 offen nt
    v_mfma_f32_16x16x32_bf16 v[232:235], v[60:63], a[84:87], v[232:235]
    s_add_u32 s98, s98, 3456
    v_mfma_f32_16x16x32_bf16 v[236:239], v[56:59], a[88:91], v[236:239]
    s_add_u32 m0, s69, 65536
    v_mfma_f32_16x16x32_bf16 v[236:239], v[60:63], a[92:95], v[236:239]
    s_mov_b32 s76, 0
    v_mfma_f32_16x16x32_bf16 v[240:243], v[56:59], a[96:99], v[240:243]
    buffer_load_ushort v92, v65, s[32:35], s99 offen offset:0
    v_mfma_f32_16x16x32_bf16 v[240:243], v[60:63], a[100:103], v[240:243]
    v_mfma_f32_16x16x32_bf16 v[244:247], v[56:59], a[104:107], v[244:247]
    v_mfma_f32_16x16x32_bf16 v[244:247], v[60:63], a[108:111], v[244:247]
    v_mfma_f32_16x16x32_bf16 v[248:251], v[56:59], a[112:115], v[248:251]
    buffer_load_dwordx2 v[84:85], v75, s[28:31], s98 offen nt
    v_mfma_f32_16x16x32_bf16 v[248:251], v[60:63], a[116:119], v[248:251]
    v_mfma_f32_16x16x32_bf16 v[252:255], v[56:59], a[120:123], v[252:255]
    ds_read_b64_tr_b16 v[56:57], v16 offset:0
    ds_read_b64_tr_b16 v[58:59], v16 offset:1024
    v_mfma_f32_16x16x32_bf16 v[252:255], v[60:63], a[124:127], v[252:255]
    s_waitcnt lgkmcnt(2)
    ds_read_b64_tr_b16 v[60:61], v16 offset:8192
    ds_read_b64_tr_b16 v[62:63], v16 offset:9216
    v_mfma_f32_16x16x32_bf16 a[128:131], a[64:67], v[40:43], a[128:131]
    buffer_load_dwordx4 v2, s[12:15], s60 offen nt lds
    v_mfma_f32_16x16x32_bf16 a[128:131], a[68:71], v[44:47], a[128:131]
    v_add_u32 v22, 0x10000, v22
    v_add_u32 v16, 0xfffe0000, v16
    v_mfma_f32_16x16x32_bf16 a[132:135], a[72:75], v[40:43], a[132:135]
    ds_read_b128 a[32:35], v22 offset:16384
    v_mfma_f32_16x16x32_bf16 a[132:135], a[76:79], v[44:47], a[132:135]
    v_mfma_f32_16x16x32_bf16 a[136:139], a[80:83], v[40:43], a[136:139]
    buffer_load_dwordx2 v[86:87], v77, s[28:31], s98 offen nt
    v_mfma_f32_16x16x32_bf16 a[136:139], a[84:87], v[44:47], a[136:139]
    s_add_u32 s98, s98, 3456
    v_mfma_f32_16x16x32_bf16 a[140:143], a[88:91], v[40:43], a[140:143]
    v_add_u32 v23, 0x10000, v23
    v_mfma_f32_16x16x32_bf16 a[140:143], a[92:95], v[44:47], a[140:143]
    ds_read_b128 a[36:39], v23 offset:16384
    v_mfma_f32_16x16x32_bf16 a[144:147], a[96:99], v[40:43], a[144:147]
    buffer_load_ushort v93, v65, s[32:35], s99 offen offset:2
    v_mfma_f32_16x16x32_bf16 a[144:147], a[100:103], v[44:47], a[144:147]
    v_mfma_f32_16x16x32_bf16 a[148:151], a[104:107], v[40:43], a[148:151]
    v_mfma_f32_16x16x32_bf16 a[148:151], a[108:111], v[44:47], a[148:151]
    v_mfma_f32_16x16x32_bf16 a[152:155], a[112:115], v[40:43], a[152:155]
    buffer_load_dwordx2 v[88:89], v75, s[28:31], s98 offen nt
    v_mfma_f32_16x16x32_bf16 a[152:155], a[116:119], v[44:47], a[152:155]
    ds_read_b128 a[40:43], v22 offset:18432
    v_mfma_f32_16x16x32_bf16 a[156:159], a[120:123], v[40:43], a[156:159]
    ds_read_b64_tr_b16 v[40:41], v17 offset:0
    ds_read_b64_tr_b16 v[42:43], v17 offset:1024
    v_mfma_f32_16x16x32_bf16 a[156:159], a[124:127], v[44:47], a[156:159]
    ds_read_b64_tr_b16 v[44:45], v17 offset:8192
    ds_read_b64_tr_b16 v[46:47], v17 offset:9216
    v_mfma_f32_16x16x32_bf16 a[160:163], a[64:67], v[48:51], a[160:163]
    buffer_load_dwordx4 v3, s[12:15], s60 offen offset:1024 nt lds
    v_mfma_f32_16x16x32_bf16 a[160:163], a[68:71], v[52:55], a[160:163]
    v_add_u32 v17, 0xfffe0000, v17
    v_mfma_f32_16x16x32_bf16 a[164:167], a[72:75], v[48:51], a[164:167]
    ds_read_b128 a[44:47], v23 offset:18432
    v_mfma_f32_16x16x32_bf16 a[164:167], a[76:79], v[52:55], a[164:167]
    v_mfma_f32_16x16x32_bf16 a[168:171], a[80:83], v[48:51], a[168:171]
    buffer_load_dwordx2 v[90:91], v77, s[28:31], s98 offen nt
    v_mfma_f32_16x16x32_bf16 a[168:171], a[84:87], v[52:55], a[168:171]
    s_add_u32 s98, s98, 3456
    s_add_u32 s28, s56, 6291456
    s_addc_u32 s29, s57, 0
    v_mfma_f32_16x16x32_bf16 a[172:175], a[88:91], v[48:51], a[172:175]
    s_mov_b32 s30, 2359296
    v_mfma_f32_16x16x32_bf16 a[172:175], a[92:95], v[52:55], a[172:175]
    s_bfe_u32 s98, s72, 0x10001
    v_mfma_f32_16x16x32_bf16 a[176:179], a[96:99], v[48:51], a[176:179]
    buffer_load_ushort v94, v65, s[32:35], s99 offen offset:4
    v_mfma_f32_16x16x32_bf16 a[176:179], a[100:103], v[52:55], a[176:179]
    s_add_u32 s32, s56, 9437184
    s_addc_u32 s33, s57, 0
    s_mov_b32 s34, 196608
    v_mfma_f32_16x16x32_bf16 a[180:183], a[104:107], v[48:51], a[180:183]
    s_bfe_u32 s99, s72, 0x10003
    ds_read_b128 a[48:51], v22 offset:20480
    v_mfma_f32_16x16x32_bf16 a[180:183], a[108:111], v[52:55], a[180:183]
    s_lshl1_add_u32 s98, s99, s98
    v_mfma_f32_16x16x32_bf16 a[184:187], a[112:115], v[48:51], a[184:187]
    s_lshl_b32 s98, s98, 5
    buffer_store_dword v65, v64, s[32:35], s101 offen sc1
    v_mfma_f32_16x16x32_bf16 a[184:187], a[116:119], v[52:55], a[184:187]
    s_lshl_b32 s72, s72, 7
    ds_read_b128 a[52:55], v23 offset:20480
    v_mfma_f32_16x16x32_bf16 a[188:191], a[120:123], v[48:51], a[188:191]
    v_mfma_f32_16x16x32_bf16 a[188:191], a[124:127], v[52:55], a[188:191]
    s_waitcnt lgkmcnt(1)
    v_mfma_f32_16x16x32_bf16 a[192:195], a[64:67], v[56:59], a[192:195]
    buffer_load_dwordx4 v4, s[12:15], s60 offen offset:2048 nt lds
    v_mfma_f32_16x16x32_bf16 a[192:195], a[68:71], v[60:63], a[192:195]
    v_mfma_f32_16x16x32_bf16 a[196:199], a[72:75], v[56:59], a[196:199]
    v_mfma_f32_16x16x32_bf16 a[196:199], a[76:79], v[60:63], a[196:199]
    ds_read_b128 a[56:59], v22 offset:22528
    v_mfma_f32_16x16x32_bf16 a[200:203], a[80:83], v[56:59], a[200:203]
    buffer_load_dwordx4 v5, s[12:15], s60 offen offset:3072 nt lds
    v_mfma_f32_16x16x32_bf16 a[200:203], a[84:87], v[60:63], a[200:203]
    s_add_u32 m0, s69, 81920
    v_mfma_f32_16x16x32_bf16 a[204:207], a[88:91], v[56:59], a[204:207]
    v_mfma_f32_16x16x32_bf16 a[204:207], a[92:95], v[60:63], a[204:207]
    v_mfma_f32_16x16x32_bf16 a[208:211], a[96:99], v[56:59], a[208:211]
    buffer_load_dwordx4 v6, s[8:11], s61 offen lds
    v_mfma_f32_16x16x32_bf16 a[208:211], a[100:103], v[60:63], a[208:211]
    ds_read_b128 a[60:63], v23 offset:22528
    v_mfma_f32_16x16x32_bf16 a[212:215], a[104:107], v[56:59], a[212:215]
    v_mfma_f32_16x16x32_bf16 a[212:215], a[108:111], v[60:63], a[212:215]
    v_mfma_f32_16x16x32_bf16 a[216:219], a[112:115], v[56:59], a[216:219]
    buffer_load_dwordx4 v7, s[8:11], s61 offen offset:1024 lds
    v_mfma_f32_16x16x32_bf16 a[216:219], a[116:119], v[60:63], a[216:219]
    v_mfma_f32_16x16x32_bf16 a[220:223], a[120:123], v[56:59], a[220:223]
    v_mfma_f32_16x16x32_bf16 a[220:223], a[124:127], v[60:63], a[220:223]
    v_mfma_f32_16x16x32_bf16 a[224:227], a[64:67], v[40:43], a[224:227]
    buffer_load_dwordx4 v8, s[8:11], s61 offen offset:2048 lds
    v_mfma_f32_16x16x32_bf16 a[224:227], a[68:71], v[44:47], a[224:227]
    v_mfma_f32_16x16x32_bf16 a[228:231], a[72:75], v[40:43], a[228:231]
    v_mfma_f32_16x16x32_bf16 a[228:231], a[76:79], v[44:47], a[228:231]
    v_mfma_f32_16x16x32_bf16 a[232:235], a[80:83], v[40:43], a[232:235]
    buffer_load_dwordx4 v9, s[8:11], s61 offen offset:3072 lds
    v_mfma_f32_16x16x32_bf16 a[232:235], a[84:87], v[44:47], a[232:235]
    s_xor_b32 s61, s61, 128
    s_waitcnt vmcnt(19) lgkmcnt(0)
    s_barrier
    v_mfma_f32_16x16x32_bf16 a[236:239], a[88:91], v[40:43], a[236:239]
    s_add_u32 m0, s69, 98304
    ds_read_b64_tr_b16 v[48:49], v14 offset:0
    ds_read_b64_tr_b16 v[50:51], v14 offset:1024
    v_mfma_f32_16x16x32_bf16 a[236:239], a[92:95], v[44:47], a[236:239]
    ds_read_b64_tr_b16 v[52:53], v14 offset:8192
    ds_read_b64_tr_b16 v[54:55], v14 offset:9216
    v_mfma_f32_16x16x32_bf16 a[240:243], a[96:99], v[40:43], a[240:243]
    buffer_load_dwordx4 v2, s[16:19], s60 offen nt lds
    v_mfma_f32_16x16x32_bf16 a[240:243], a[100:103], v[44:47], a[240:243]
    ds_read_b64_tr_b16 v[56:57], v15 offset:0
    ds_read_b64_tr_b16 v[58:59], v15 offset:1024
    v_mfma_f32_16x16x32_bf16 a[244:247], a[104:107], v[40:43], a[244:247]
    ds_read_b64_tr_b16 v[60:61], v15 offset:8192
    ds_read_b64_tr_b16 v[62:63], v15 offset:9216
    v_mfma_f32_16x16x32_bf16 a[244:247], a[108:111], v[44:47], a[244:247]
    s_cmp_lt_u32 s2, 192
    s_cselect_b32 s72, s72, 1073741824
    v_mfma_f32_16x16x32_bf16 a[248:251], a[112:115], v[40:43], a[248:251]
    v_mfma_f32_16x16x32_bf16 a[248:251], a[116:119], v[44:47], a[248:251]
    buffer_load_dwordx4 v3, s[16:19], s60 offen offset:1024 nt lds
    v_mfma_f32_16x16x32_bf16 a[252:255], a[120:123], v[40:43], a[252:255]
    ds_read_b64_tr_b16 v[40:41], v16 offset:0
    ds_read_b64_tr_b16 v[42:43], v16 offset:1024
    v_mfma_f32_16x16x32_bf16 a[252:255], a[124:127], v[44:47], a[252:255]
    s_waitcnt lgkmcnt(2)
    ds_read_b64_tr_b16 v[44:45], v16 offset:8192
    ds_read_b64_tr_b16 v[46:47], v16 offset:9216
    v_mfma_f32_16x16x32_bf16 v[128:131], v[48:51], a[0:3], v[128:131]
    v_mfma_f32_16x16x32_bf16 v[128:131], v[52:55], a[4:7], v[128:131]
    v_add_u32 v22, 0xfffe0000, v22
    v_mfma_f32_16x16x32_bf16 v[132:135], v[48:51], a[8:11], v[132:135]
    ds_read_b128 a[64:67], v22 offset:16384
    v_mfma_f32_16x16x32_bf16 v[132:135], v[52:55], a[12:15], v[132:135]
    v_mfma_f32_16x16x32_bf16 v[136:139], v[48:51], a[16:19], v[136:139]
    v_mfma_f32_16x16x32_bf16 v[136:139], v[52:55], a[20:23], v[136:139]
    buffer_load_dwordx4 v4, s[16:19], s60 offen offset:2048 nt lds
    v_mfma_f32_16x16x32_bf16 v[140:143], v[48:51], a[24:27], v[140:143]
    v_add_u32 v23, 0xfffe0000, v23
    v_mfma_f32_16x16x32_bf16 v[140:143], v[52:55], a[28:31], v[140:143]
    ds_read_b128 a[68:71], v23 offset:16384
    v_mfma_f32_16x16x32_bf16 v[144:147], v[48:51], a[32:35], v[144:147]
    v_mfma_f32_16x16x32_bf16 v[144:147], v[52:55], a[36:39], v[144:147]
    v_mfma_f32_16x16x32_bf16 v[148:151], v[48:51], a[40:43], v[148:151]
    v_mfma_f32_16x16x32_bf16 v[148:151], v[52:55], a[44:47], v[148:151]
    v_mfma_f32_16x16x32_bf16 v[152:155], v[48:51], a[48:51], v[152:155]
    buffer_load_dwordx4 v5, s[16:19], s60 offen offset:3072 nt lds
    v_mfma_f32_16x16x32_bf16 v[152:155], v[52:55], a[52:55], v[152:155]
    ds_read_b128 a[72:75], v22 offset:18432
    v_mfma_f32_16x16x32_bf16 v[156:159], v[48:51], a[56:59], v[156:159]
    ds_read_b64_tr_b16 v[48:49], v17 offset:0
    ds_read_b64_tr_b16 v[50:51], v17 offset:1024
    v_mfma_f32_16x16x32_bf16 v[156:159], v[52:55], a[60:63], v[156:159]
    ds_read_b64_tr_b16 v[52:53], v17 offset:8192
    ds_read_b64_tr_b16 v[54:55], v17 offset:9216
    v_mfma_f32_16x16x32_bf16 v[160:163], v[56:59], a[0:3], v[160:163]
    v_mfma_f32_16x16x32_bf16 v[160:163], v[60:63], a[4:7], v[160:163]
    v_mfma_f32_16x16x32_bf16 v[164:167], v[56:59], a[8:11], v[164:167]
    ds_read_b128 a[76:79], v23 offset:18432
    v_mfma_f32_16x16x32_bf16 v[164:167], v[60:63], a[12:15], v[164:167]
    s_add_u32 m0, s69, 114688
    v_mfma_f32_16x16x32_bf16 v[168:171], v[56:59], a[16:19], v[168:171]
    s_xor_b32 s60, s60, 3670016
    buffer_load_dwordx4 v6, s[8:11], s62 offen lds
    v_mfma_f32_16x16x32_bf16 v[168:171], v[60:63], a[20:23], v[168:171]
    v_mfma_f32_16x16x32_bf16 v[172:175], v[56:59], a[24:27], v[172:175]
    v_mfma_f32_16x16x32_bf16 v[172:175], v[60:63], a[28:31], v[172:175]
    v_mfma_f32_16x16x32_bf16 v[176:179], v[56:59], a[32:35], v[176:179]
    ds_read_b128 a[80:83], v22 offset:20480
    v_mfma_f32_16x16x32_bf16 v[176:179], v[60:63], a[36:39], v[176:179]
    v_mfma_f32_16x16x32_bf16 v[180:183], v[56:59], a[40:43], v[180:183]
    v_mfma_f32_16x16x32_bf16 v[180:183], v[60:63], a[44:47], v[180:183]
    buffer_load_dwordx4 v7, s[8:11], s62 offen offset:1024 lds
    v_mfma_f32_16x16x32_bf16 v[184:187], v[56:59], a[48:51], v[184:187]
    v_mfma_f32_16x16x32_bf16 v[184:187], v[60:63], a[52:55], v[184:187]
    ds_read_b128 a[84:87], v23 offset:20480
    v_mfma_f32_16x16x32_bf16 v[188:191], v[56:59], a[56:59], v[188:191]
    s_waitcnt lgkmcnt(1)
    ds_read_b64_tr_b16 v[56:57], v14 offset:32768
    ds_read_b64_tr_b16 v[58:59], v14 offset:33792
    v_mfma_f32_16x16x32_bf16 v[188:191], v[60:63], a[60:63], v[188:191]
    ds_read_b64_tr_b16 v[60:61], v14 offset:40960
    ds_read_b64_tr_b16 v[62:63], v14 offset:41984
    v_mfma_f32_16x16x32_bf16 v[192:195], v[40:43], a[0:3], v[192:195]
    v_add_u32 v14, 0x10000, v14
    v_mfma_f32_16x16x32_bf16 v[192:195], v[44:47], a[4:7], v[192:195]
    v_mfma_f32_16x16x32_bf16 v[196:199], v[40:43], a[8:11], v[196:199]
    v_mfma_f32_16x16x32_bf16 v[196:199], v[44:47], a[12:15], v[196:199]
    buffer_load_dwordx4 v8, s[8:11], s62 offen offset:2048 lds
    v_mfma_f32_16x16x32_bf16 v[200:203], v[40:43], a[16:19], v[200:203]
    ds_read_b128 a[88:91], v22 offset:22528
    v_mfma_f32_16x16x32_bf16 v[200:203], v[44:47], a[20:23], v[200:203]
    v_mfma_f32_16x16x32_bf16 v[204:207], v[40:43], a[24:27], v[204:207]
    v_mfma_f32_16x16x32_bf16 v[204:207], v[44:47], a[28:31], v[204:207]
    v_mfma_f32_16x16x32_bf16 v[208:211], v[40:43], a[32:35], v[208:211]
    ds_read_b128 a[92:95], v23 offset:22528
    v_mfma_f32_16x16x32_bf16 v[208:211], v[44:47], a[36:39], v[208:211]
    v_mfma_f32_16x16x32_bf16 v[212:215], v[40:43], a[40:43], v[212:215]
    buffer_load_dwordx4 v9, s[8:11], s62 offen offset:3072 lds
    v_mfma_f32_16x16x32_bf16 v[212:215], v[44:47], a[44:47], v[212:215]
    v_mfma_f32_16x16x32_bf16 v[216:219], v[40:43], a[48:51], v[216:219]
    v_mfma_f32_16x16x32_bf16 v[216:219], v[44:47], a[52:55], v[216:219]
    v_mfma_f32_16x16x32_bf16 v[220:223], v[40:43], a[56:59], v[220:223]
    ds_read_b64_tr_b16 v[40:41], v15 offset:32768
    ds_read_b64_tr_b16 v[42:43], v15 offset:33792
    v_mfma_f32_16x16x32_bf16 v[220:223], v[44:47], a[60:63], v[220:223]
    ds_read_b64_tr_b16 v[44:45], v15 offset:40960
    ds_read_b64_tr_b16 v[46:47], v15 offset:41984
    v_mfma_f32_16x16x32_bf16 v[224:227], v[48:51], a[0:3], v[224:227]
    v_add_u32 v15, 0x10000, v15
    v_mfma_f32_16x16x32_bf16 v[224:227], v[52:55], a[4:7], v[224:227]
    s_xor_b32 s62, s62, 128
    v_mfma_f32_16x16x32_bf16 v[228:231], v[48:51], a[8:11], v[228:231]
    buffer_load_dword v106, v103, s[24:27], s77 offen
    v_mfma_f32_16x16x32_bf16 v[228:231], v[52:55], a[12:15], v[228:231]
    s_add_u32 s77, s77, 4608
    v_mfma_f32_16x16x32_bf16 v[232:235], v[48:51], a[16:19], v[232:235]
    v_mfma_f32_16x16x32_bf16 v[232:235], v[52:55], a[20:23], v[232:235]
    s_add_u32 m0, s69, 131072
    v_mfma_f32_16x16x32_bf16 v[236:239], v[48:51], a[24:27], v[236:239]
    buffer_load_dwordx4 v2, s[12:15], s60 offen nt lds
    v_mfma_f32_16x16x32_bf16 v[236:239], v[52:55], a[28:31], v[236:239]
    v_mfma_f32_16x16x32_bf16 v[240:243], v[48:51], a[32:35], v[240:243]
    v_mfma_f32_16x16x32_bf16 v[240:243], v[52:55], a[36:39], v[240:243]
    v_mfma_f32_16x16x32_bf16 v[244:247], v[48:51], a[40:43], v[244:247]
    v_mfma_f32_16x16x32_bf16 v[244:247], v[52:55], a[44:47], v[244:247]
    v_mfma_f32_16x16x32_bf16 v[248:251], v[48:51], a[48:51], v[248:251]
    v_mfma_f32_16x16x32_bf16 v[248:251], v[52:55], a[52:55], v[248:251]
    buffer_load_dwordx4 v3, s[12:15], s60 offen offset:1024 nt lds
    v_mfma_f32_16x16x32_bf16 v[252:255], v[48:51], a[56:59], v[252:255]
    ds_read_b64_tr_b16 v[48:49], v16 offset:32768
    ds_read_b64_tr_b16 v[50:51], v16 offset:33792
    v_mfma_f32_16x16x32_bf16 v[252:255], v[52:55], a[60:63], v[252:255]
    s_waitcnt lgkmcnt(2)
    ds_read_b64_tr_b16 v[52:53], v16 offset:40960
    ds_read_b64_tr_b16 v[54:55], v16 offset:41984
    v_mfma_f32_16x16x32_bf16 a[128:131], a[0:3], v[56:59], a[128:131]
    v_add_u32 v16, 0x10000, v16
    v_mfma_f32_16x16x32_bf16 a[128:131], a[4:7], v[60:63], a[128:131]
    v_mfma_f32_16x16x32_bf16 a[132:135], a[8:11], v[56:59], a[132:135]
    ds_read_b128 a[96:99], v22 offset:49152
    v_mfma_f32_16x16x32_bf16 a[132:135], a[12:15], v[60:63], a[132:135]
    v_mfma_f32_16x16x32_bf16 a[136:139], a[16:19], v[56:59], a[136:139]
    v_mfma_f32_16x16x32_bf16 a[136:139], a[20:23], v[60:63], a[136:139]
    buffer_load_dwordx4 v4, s[12:15], s60 offen offset:2048 nt lds
    v_mfma_f32_16x16x32_bf16 a[140:143], a[24:27], v[56:59], a[140:143]
    v_mfma_f32_16x16x32_bf16 a[140:143], a[28:31], v[60:63], a[140:143]
    ds_read_b128 a[100:103], v23 offset:49152
    v_mfma_f32_16x16x32_bf16 a[144:147], a[32:35], v[56:59], a[144:147]
    v_mfma_f32_16x16x32_bf16 a[144:147], a[36:39], v[60:63], a[144:147]
    v_mfma_f32_16x16x32_bf16 a[148:151], a[40:43], v[56:59], a[148:151]
    v_mfma_f32_16x16x32_bf16 a[148:151], a[44:47], v[60:63], a[148:151]
    v_mfma_f32_16x16x32_bf16 a[152:155], a[48:51], v[56:59], a[152:155]
    buffer_load_dwordx4 v5, s[12:15], s60 offen offset:3072 nt lds
    v_mfma_f32_16x16x32_bf16 a[152:155], a[52:55], v[60:63], a[152:155]
    ds_read_b128 a[104:107], v22 offset:51200
    v_mfma_f32_16x16x32_bf16 a[156:159], a[56:59], v[56:59], a[156:159]
    ds_read_b64_tr_b16 v[56:57], v17 offset:32768
    ds_read_b64_tr_b16 v[58:59], v17 offset:33792
    v_mfma_f32_16x16x32_bf16 a[156:159], a[60:63], v[60:63], a[156:159]
    ds_read_b64_tr_b16 v[60:61], v17 offset:40960
    ds_read_b64_tr_b16 v[62:63], v17 offset:41984
    v_mfma_f32_16x16x32_bf16 a[160:163], a[0:3], v[40:43], a[160:163]
    v_add_u32 v17, 0x10000, v17
    v_mfma_f32_16x16x32_bf16 a[160:163], a[4:7], v[44:47], a[160:163]
    v_mfma_f32_16x16x32_bf16 a[164:167], a[8:11], v[40:43], a[164:167]
    ds_read_b128 a[108:111], v23 offset:51200
    v_mfma_f32_16x16x32_bf16 a[164:167], a[12:15], v[44:47], a[164:167]
    s_add_u32 m0, s69, 147456
    v_mfma_f32_16x16x32_bf16 a[168:171], a[16:19], v[40:43], a[168:171]
    buffer_load_dwordx4 v6, s[8:11], s61 offen lds
    v_mfma_f32_16x16x32_bf16 a[168:171], a[20:23], v[44:47], a[168:171]
    v_mfma_f32_16x16x32_bf16 a[172:175], a[24:27], v[40:43], a[172:175]
    v_mfma_f32_16x16x32_bf16 a[172:175], a[28:31], v[44:47], a[172:175]
    v_mfma_f32_16x16x32_bf16 a[176:179], a[32:35], v[40:43], a[176:179]
    ds_read_b128 a[112:115], v22 offset:53248
    v_mfma_f32_16x16x32_bf16 a[176:179], a[36:39], v[44:47], a[176:179]
    v_mfma_f32_16x16x32_bf16 a[180:183], a[40:43], v[40:43], a[180:183]
    v_mfma_f32_16x16x32_bf16 a[180:183], a[44:47], v[44:47], a[180:183]
    buffer_load_dwordx4 v7, s[8:11], s61 offen offset:1024 lds
    v_mfma_f32_16x16x32_bf16 a[184:187], a[48:51], v[40:43], a[184:187]
    v_mfma_f32_16x16x32_bf16 a[184:187], a[52:55], v[44:47], a[184:187]
    ds_read_b128 a[116:119], v23 offset:53248
    v_mfma_f32_16x16x32_bf16 a[188:191], a[56:59], v[40:43], a[188:191]
    v_mfma_f32_16x16x32_bf16 a[188:191], a[60:63], v[44:47], a[188:191]
    s_waitcnt lgkmcnt(1)
    v_mfma_f32_16x16x32_bf16 a[192:195], a[0:3], v[48:51], a[192:195]
    v_mfma_f32_16x16x32_bf16 a[192:195], a[4:7], v[52:55], a[192:195]
    v_mfma_f32_16x16x32_bf16 a[196:199], a[8:11], v[48:51], a[196:199]
    v_mfma_f32_16x16x32_bf16 a[196:199], a[12:15], v[52:55], a[196:199]
    buffer_load_dwordx4 v8, s[8:11], s61 offen offset:2048 lds
    v_mfma_f32_16x16x32_bf16 a[200:203], a[16:19], v[48:51], a[200:203]
    ds_read_b128 a[120:123], v22 offset:55296
    v_mfma_f32_16x16x32_bf16 a[200:203], a[20:23], v[52:55], a[200:203]
    v_mfma_f32_16x16x32_bf16 a[204:207], a[24:27], v[48:51], a[204:207]
    v_mfma_f32_16x16x32_bf16 a[204:207], a[28:31], v[52:55], a[204:207]
    v_mfma_f32_16x16x32_bf16 a[208:211], a[32:35], v[48:51], a[208:211]
    ds_read_b128 a[124:127], v23 offset:55296
    v_mfma_f32_16x16x32_bf16 a[208:211], a[36:39], v[52:55], a[208:211]
    v_mfma_f32_16x16x32_bf16 a[212:215], a[40:43], v[48:51], a[212:215]
    buffer_load_dwordx4 v9, s[8:11], s61 offen offset:3072 lds
    v_mfma_f32_16x16x32_bf16 a[212:215], a[44:47], v[52:55], a[212:215]
    v_mfma_f32_16x16x32_bf16 a[216:219], a[48:51], v[48:51], a[216:219]
    v_mfma_f32_16x16x32_bf16 a[216:219], a[52:55], v[52:55], a[216:219]
    v_mfma_f32_16x16x32_bf16 a[220:223], a[56:59], v[48:51], a[220:223]
    v_mfma_f32_16x16x32_bf16 a[220:223], a[60:63], v[52:55], a[220:223]
    v_mfma_f32_16x16x32_bf16 a[224:227], a[0:3], v[56:59], a[224:227]
    v_mfma_f32_16x16x32_bf16 a[224:227], a[4:7], v[60:63], a[224:227]
    s_xor_b32 s61, s61, 384
    v_mfma_f32_16x16x32_bf16 a[228:231], a[8:11], v[56:59], a[228:231]
    v_mfma_f32_16x16x32_bf16 a[228:231], a[12:15], v[60:63], a[228:231]
    v_mfma_f32_16x16x32_bf16 a[232:235], a[16:19], v[56:59], a[232:235]
    v_mfma_f32_16x16x32_bf16 a[232:235], a[20:23], v[60:63], a[232:235]
    s_waitcnt vmcnt(9) lgkmcnt(0)
    s_barrier
    ds_read_b64_tr_b16 v[40:41], v14 offset:0
    v_mfma_f32_16x16x32_bf16 a[236:239], a[24:27], v[56:59], a[236:239]
    s_add_u32 m0, s69, 0
    ds_read_b64_tr_b16 v[42:43], v14 offset:1024
    ds_read_b64_tr_b16 v[44:45], v14 offset:8192
    v_mfma_f32_16x16x32_bf16 a[236:239], a[28:31], v[60:63], a[236:239]
    buffer_load_dwordx4 v2, s[16:19], s60 offen nt lds
    v_mfma_f32_16x16x32_bf16 a[240:243], a[32:35], v[56:59], a[240:243]
    ds_read_b64_tr_b16 v[46:47], v14 offset:9216
    v_cndmask_b32_e64 v83, v83, 0, s[92:93]
    v_mfma_f32_16x16x32_bf16 a[240:243], a[36:39], v[60:63], a[240:243]
    v_cndmask_b32_e64 v81, v81, 0, vcc
    v_cndmask_b32 v82, v82, v92, s[92:93]
    v_mfma_f32_16x16x32_bf16 a[244:247], a[40:43], v[56:59], a[244:247]
    s_mov_b32 vcc_lo, 0x10101010
    s_mov_b32 vcc_hi, 0x10101010
    v_cndmask_b32_e64 v83, v83, 0, vcc
    v_mfma_f32_16x16x32_bf16 a[244:247], a[44:47], v[60:63], a[244:247]
    v_xor_b32 v92, s98, v95
    ds_read_b64_tr_b16 v[48:49], v15 offset:0
    v_mfma_f32_16x16x32_bf16 a[248:251], a[48:51], v[56:59], a[248:251]
    buffer_store_dwordx4 v[80:83], v92, s[28:31], s72 offen sc1
    v_mfma_f32_16x16x32_bf16 a[248:251], a[52:55], v[60:63], a[248:251]
    s_mul_i32 s72, s2, 3
    buffer_load_dwordx4 v3, s[16:19], s60 offen offset:1024 nt lds
    v_mfma_f32_16x16x32_bf16 a[252:255], a[56:59], v[56:59], a[252:255]
    s_add_u32 s72, s72, 1
    ds_read_b64_tr_b16 v[50:51], v15 offset:1024
    ds_read_b64_tr_b16 v[52:53], v15 offset:8192
    v_mfma_f32_16x16x32_bf16 a[252:255], a[60:63], v[60:63], a[252:255]
    s_bfe_u32 s98, s72, 0x10001
    ds_read_b64_tr_b16 v[54:55], v15 offset:9216
    v_cndmask_b32_e64 v87, v87, 0, s[92:93]
    s_waitcnt lgkmcnt(4)
    v_mfma_f32_16x16x32_bf16 v[128:131], v[40:43], a[64:67], v[128:131]
    s_bfe_u32 s99, s72, 0x10003
    v_cndmask_b32 v86, v86, v93, s[92:93]
    v_cndmask_b32_e64 v91, v91, 0, s[92:93]
    v_mfma_f32_16x16x32_bf16 v[128:131], v[44:47], a[68:71], v[128:131]
    s_lshl1_add_u32 s98, s99, s98
    v_add_u32 v22, 0x10000, v22
    v_cndmask_b32 v90, v90, v94, s[92:93]
    v_mfma_f32_16x16x32_bf16 v[132:135], v[40:43], a[72:75], v[132:135]
    s_lshl_b32 s98, s98, 5
    ds_read_b128 a[0:3], v22 offset:16384
    v_xor_b32 v93, s98, v95
    v_mfma_f32_16x16x32_bf16 v[132:135], v[44:47], a[76:79], v[132:135]
    s_mov_b32 vcc_lo, 0x84848484
    s_mov_b32 vcc_hi, 0x84848484
    v_cndmask_b32_e64 v85, v85, 0, vcc
    v_mfma_f32_16x16x32_bf16 v[136:139], v[40:43], a[80:83], v[136:139]
    s_mov_b32 vcc_lo, 0x10101010
    s_mov_b32 vcc_hi, 0x10101010
    v_cndmask_b32_e64 v87, v87, 0, vcc
    v_mfma_f32_16x16x32_bf16 v[136:139], v[44:47], a[84:87], v[136:139]
    s_lshl_b32 s72, s72, 7
    buffer_load_dwordx4 v4, s[16:19], s60 offen offset:2048 nt lds
    v_mfma_f32_16x16x32_bf16 v[140:143], v[40:43], a[88:91], v[140:143]
    v_add_u32 v23, 0x10000, v23
    ds_read_b64_tr_b16 v[56:57], v16 offset:0
    v_mfma_f32_16x16x32_bf16 v[140:143], v[44:47], a[92:95], v[140:143]
    ds_read_b128 a[4:7], v23 offset:16384
    ds_read_b64_tr_b16 v[58:59], v16 offset:1024
    v_mfma_f32_16x16x32_bf16 v[144:147], v[40:43], a[96:99], v[144:147]
    s_cmp_lt_u32 s2, 192
    s_cselect_b32 s72, s72, 1073741824
    ds_read_b64_tr_b16 v[60:61], v16 offset:8192
    v_mfma_f32_16x16x32_bf16 v[144:147], v[44:47], a[100:103], v[144:147]
    buffer_store_dwordx4 v[84:87], v93, s[28:31], s72 offen sc1
    v_mfma_f32_16x16x32_bf16 v[148:151], v[40:43], a[104:107], v[148:151]
    s_mul_i32 s72, s2, 3
    ds_read_b64_tr_b16 v[62:63], v16 offset:9216
    v_mfma_f32_16x16x32_bf16 v[148:151], v[44:47], a[108:111], v[148:151]
    s_add_u32 s72, s72, 2
    v_mfma_f32_16x16x32_bf16 v[152:155], v[40:43], a[112:115], v[152:155]
    s_bfe_u32 s98, s72, 0x10001
    buffer_load_dwordx4 v5, s[16:19], s60 offen offset:3072 nt lds
    v_mfma_f32_16x16x32_bf16 v[152:155], v[44:47], a[116:119], v[152:155]
    s_bfe_u32 s99, s72, 0x10003
    ds_read_b128 a[8:11], v22 offset:18432
    v_mfma_f32_16x16x32_bf16 v[156:159], v[40:43], a[120:123], v[156:159]
    s_mov_b32 vcc_lo, 0x84848484
    s_mov_b32 vcc_hi, 0x84848484
    v_cndmask_b32_e64 v89, v89, 0, vcc
    v_mfma_f32_16x16x32_bf16 v[156:159], v[44:47], a[124:127], v[156:159]
    s_lshl1_add_u32 s98, s99, s98
    ds_read_b64_tr_b16 v[40:41], v17 offset:0
    ds_read_b64_tr_b16 v[42:43], v17 offset:1024
    s_waitcnt lgkmcnt(3)
    v_mfma_f32_16x16x32_bf16 v[160:163], v[48:51], a[64:67], v[160:163]
    s_mov_b32 vcc_lo, 0x10101010
    s_mov_b32 vcc_hi, 0x10101010
    v_cndmask_b32_e64 v91, v91, 0, vcc
    v_mfma_f32_16x16x32_bf16 v[160:163], v[52:55], a[68:71], v[160:163]
    s_lshl_b32 s98, s98, 5
    v_xor_b32 v94, s98, v95
    ds_read_b64_tr_b16 v[44:45], v17 offset:8192
    v_mfma_f32_16x16x32_bf16 v[164:167], v[48:51], a[72:75], v[164:167]
    s_lshl_b32 s72, s72, 7
    ds_read_b128 a[12:15], v23 offset:18432
    ds_read_b64_tr_b16 v[46:47], v17 offset:9216
    v_mfma_f32_16x16x32_bf16 v[164:167], v[52:55], a[76:79], v[164:167]
    s_add_u32 m0, s69, 16384
    v_mfma_f32_16x16x32_bf16 v[168:171], v[48:51], a[80:83], v[168:171]
    s_xor_b32 s60, s60, 524288
    buffer_load_dwordx4 v6, s[8:11], s62 offen lds
    v_mfma_f32_16x16x32_bf16 v[168:171], v[52:55], a[84:87], v[168:171]
    s_cmp_lt_u32 s2, 192
    s_cselect_b32 s72, s72, 1073741824
    v_mfma_f32_16x16x32_bf16 v[172:175], v[48:51], a[88:91], v[172:175]
    s_lshl2_add_u32 s99, s100, s4
    buffer_store_dwordx4 v[88:91], v94, s[28:31], s72 offen sc1
    v_mfma_f32_16x16x32_bf16 v[172:175], v[52:55], a[92:95], v[172:175]
    s_add_u32 s28, s28, s7
    s_addc_u32 s29, s29, 0
    v_mfma_f32_16x16x32_bf16 v[176:179], v[48:51], a[96:99], v[176:179]
    s_mov_b32 s30, 73728
    ds_read_b128 a[16:19], v22 offset:20480
    v_mfma_f32_16x16x32_bf16 v[176:179], v[52:55], a[100:103], v[176:179]
    s_lshl_b32 s99, s99, 7
    v_mfma_f32_16x16x32_bf16 v[180:183], v[48:51], a[104:107], v[180:183]
    v_mfma_f32_16x16x32_bf16 v[180:183], v[52:55], a[108:111], v[180:183]
    buffer_load_dwordx4 v7, s[8:11], s62 offen offset:1024 lds
    v_mfma_f32_16x16x32_bf16 v[184:187], v[48:51], a[112:115], v[184:187]
    v_mfma_f32_16x16x32_bf16 v[184:187], v[52:55], a[116:119], v[184:187]
    ds_read_b128 a[20:23], v23 offset:20480
    v_mfma_f32_16x16x32_bf16 v[188:191], v[48:51], a[120:123], v[188:191]
    ds_read_b64_tr_b16 v[48:49], v14 offset:32768
    ds_read_b64_tr_b16 v[50:51], v14 offset:33792
    v_mfma_f32_16x16x32_bf16 v[188:191], v[52:55], a[124:127], v[188:191]
    ds_read_b64_tr_b16 v[52:53], v14 offset:40960
    ds_read_b64_tr_b16 v[54:55], v14 offset:41984
    v_mfma_f32_16x16x32_bf16 v[192:195], v[56:59], a[64:67], v[192:195]
    v_add_u32 v14, 0x10000, v14
    v_mfma_f32_16x16x32_bf16 v[192:195], v[60:63], a[68:71], v[192:195]
    v_mfma_f32_16x16x32_bf16 v[196:199], v[56:59], a[72:75], v[196:199]
    v_mfma_f32_16x16x32_bf16 v[196:199], v[60:63], a[76:79], v[196:199]
    buffer_load_dwordx4 v8, s[8:11], s62 offen offset:2048 lds
    v_mfma_f32_16x16x32_bf16 v[200:203], v[56:59], a[80:83], v[200:203]
    ds_read_b128 a[24:27], v22 offset:22528
    v_mfma_f32_16x16x32_bf16 v[200:203], v[60:63], a[84:87], v[200:203]
    v_mfma_f32_16x16x32_bf16 v[204:207], v[56:59], a[88:91], v[204:207]
    v_mfma_f32_16x16x32_bf16 v[204:207], v[60:63], a[92:95], v[204:207]
    v_mfma_f32_16x16x32_bf16 v[208:211], v[56:59], a[96:99], v[208:211]
    ds_read_b128 a[28:31], v23 offset:22528
    v_mfma_f32_16x16x32_bf16 v[208:211], v[60:63], a[100:103], v[208:211]
    v_mfma_f32_16x16x32_bf16 v[212:215], v[56:59], a[104:107], v[212:215]
    buffer_load_dwordx4 v9, s[8:11], s62 offen offset:3072 lds
    v_mfma_f32_16x16x32_bf16 v[212:215], v[60:63], a[108:111], v[212:215]
    v_mfma_f32_16x16x32_bf16 v[216:219], v[56:59], a[112:115], v[216:219]
    v_mfma_f32_16x16x32_bf16 v[216:219], v[60:63], a[116:119], v[216:219]
    v_mfma_f32_16x16x32_bf16 v[220:223], v[56:59], a[120:123], v[220:223]
    s_waitcnt lgkmcnt(0)
    ds_read_b64_tr_b16 v[56:57], v15 offset:32768
    ds_read_b64_tr_b16 v[58:59], v15 offset:33792
    v_mfma_f32_16x16x32_bf16 v[220:223], v[60:63], a[124:127], v[220:223]
    ds_read_b64_tr_b16 v[60:61], v15 offset:40960
    ds_read_b64_tr_b16 v[62:63], v15 offset:41984
    v_mfma_f32_16x16x32_bf16 v[224:227], v[40:43], a[64:67], v[224:227]
    v_add_u32 v15, 0x10000, v15
    v_mfma_f32_16x16x32_bf16 v[224:227], v[44:47], a[68:71], v[224:227]
    s_xor_b32 s62, s62, 384
    v_mfma_f32_16x16x32_bf16 v[228:231], v[40:43], a[72:75], v[228:231]
    buffer_load_dword v107, v103, s[24:27], s77 offen
    v_mfma_f32_16x16x32_bf16 v[228:231], v[44:47], a[76:79], v[228:231]
    s_add_u32 s77, s77, 4608
    v_mfma_f32_16x16x32_bf16 v[232:235], v[40:43], a[80:83], v[232:235]
    v_mfma_f32_16x16x32_bf16 v[232:235], v[44:47], a[84:87], v[232:235]
    s_add_u32 m0, s69, 32768
    v_mfma_f32_16x16x32_bf16 v[236:239], v[40:43], a[88:91], v[236:239]
    buffer_load_dwordx4 v2, s[12:15], s60 offen nt lds
    v_mfma_f32_16x16x32_bf16 v[236:239], v[44:47], a[92:95], v[236:239]
    v_mfma_f32_16x16x32_bf16 v[240:243], v[40:43], a[96:99], v[240:243]
    v_mfma_f32_16x16x32_bf16 v[240:243], v[44:47], a[100:103], v[240:243]
    v_mfma_f32_16x16x32_bf16 v[244:247], v[40:43], a[104:107], v[244:247]
    v_mfma_f32_16x16x32_bf16 v[244:247], v[44:47], a[108:111], v[244:247]
    v_mfma_f32_16x16x32_bf16 v[248:251], v[40:43], a[112:115], v[248:251]
    v_mfma_f32_16x16x32_bf16 v[248:251], v[44:47], a[116:119], v[248:251]
    buffer_load_dwordx4 v3, s[12:15], s60 offen offset:1024 nt lds
    v_mfma_f32_16x16x32_bf16 v[252:255], v[40:43], a[120:123], v[252:255]
    ds_read_b64_tr_b16 v[40:41], v16 offset:32768
    ds_read_b64_tr_b16 v[42:43], v16 offset:33792
    v_mfma_f32_16x16x32_bf16 v[252:255], v[44:47], a[124:127], v[252:255]
    ds_read_b64_tr_b16 v[44:45], v16 offset:40960
    ds_read_b64_tr_b16 v[46:47], v16 offset:41984
    v_mfma_f32_16x16x32_bf16 a[128:131], a[64:67], v[48:51], a[128:131]
    v_add_u32 v16, 0x10000, v16
    v_mfma_f32_16x16x32_bf16 a[128:131], a[68:71], v[52:55], a[128:131]
    v_mfma_f32_16x16x32_bf16 a[132:135], a[72:75], v[48:51], a[132:135]
    ds_read_b128 a[32:35], v22 offset:49152
    v_mfma_f32_16x16x32_bf16 a[132:135], a[76:79], v[52:55], a[132:135]
    v_mfma_f32_16x16x32_bf16 a[136:139], a[80:83], v[48:51], a[136:139]
    v_mfma_f32_16x16x32_bf16 a[136:139], a[84:87], v[52:55], a[136:139]
    buffer_load_dwordx4 v4, s[12:15], s60 offen offset:2048 nt lds
    v_mfma_f32_16x16x32_bf16 a[140:143], a[88:91], v[48:51], a[140:143]
    v_mfma_f32_16x16x32_bf16 a[140:143], a[92:95], v[52:55], a[140:143]
    ds_read_b128 a[36:39], v23 offset:49152
    v_mfma_f32_16x16x32_bf16 a[144:147], a[96:99], v[48:51], a[144:147]
    v_mfma_f32_16x16x32_bf16 a[144:147], a[100:103], v[52:55], a[144:147]
    v_mfma_f32_16x16x32_bf16 a[148:151], a[104:107], v[48:51], a[148:151]
    v_mfma_f32_16x16x32_bf16 a[148:151], a[108:111], v[52:55], a[148:151]
    v_mfma_f32_16x16x32_bf16 a[152:155], a[112:115], v[48:51], a[152:155]
    buffer_load_dwordx4 v5, s[12:15], s60 offen offset:3072 nt lds
    v_mfma_f32_16x16x32_bf16 a[152:155], a[116:119], v[52:55], a[152:155]
    ds_read_b128 a[40:43], v22 offset:51200
    v_mfma_f32_16x16x32_bf16 a[156:159], a[120:123], v[48:51], a[156:159]
    ds_read_b64_tr_b16 v[48:49], v17 offset:32768
    ds_read_b64_tr_b16 v[50:51], v17 offset:33792
    v_mfma_f32_16x16x32_bf16 a[156:159], a[124:127], v[52:55], a[156:159]
    s_waitcnt lgkmcnt(3)
    ds_read_b64_tr_b16 v[52:53], v17 offset:40960
    ds_read_b64_tr_b16 v[54:55], v17 offset:41984
    v_mfma_f32_16x16x32_bf16 a[160:163], a[64:67], v[56:59], a[160:163]
    v_add_u32 v17, 0x10000, v17
    v_mfma_f32_16x16x32_bf16 a[160:163], a[68:71], v[60:63], a[160:163]
    v_mfma_f32_16x16x32_bf16 a[164:167], a[72:75], v[56:59], a[164:167]
    ds_read_b128 a[44:47], v23 offset:51200
    v_mfma_f32_16x16x32_bf16 a[164:167], a[76:79], v[60:63], a[164:167]
    s_add_u32 m0, s69, 49152
    v_mfma_f32_16x16x32_bf16 a[168:171], a[80:83], v[56:59], a[168:171]
    buffer_load_dwordx4 v6, s[8:11], s61 offen lds
    v_mfma_f32_16x16x32_bf16 a[168:171], a[84:87], v[60:63], a[168:171]
    v_mfma_f32_16x16x32_bf16 a[172:175], a[88:91], v[56:59], a[172:175]
    v_mfma_f32_16x16x32_bf16 a[172:175], a[92:95], v[60:63], a[172:175]
    v_mfma_f32_16x16x32_bf16 a[176:179], a[96:99], v[56:59], a[176:179]
    ds_read_b128 a[48:51], v22 offset:53248
    v_mfma_f32_16x16x32_bf16 a[176:179], a[100:103], v[60:63], a[176:179]
    v_mfma_f32_16x16x32_bf16 a[180:183], a[104:107], v[56:59], a[180:183]
    v_mfma_f32_16x16x32_bf16 a[180:183], a[108:111], v[60:63], a[180:183]
    buffer_load_dwordx4 v7, s[8:11], s61 offen offset:1024 lds
    v_mfma_f32_16x16x32_bf16 a[184:187], a[112:115], v[56:59], a[184:187]
    v_mfma_f32_16x16x32_bf16 a[184:187], a[116:119], v[60:63], a[184:187]
    ds_read_b128 a[52:55], v23 offset:53248
    v_mfma_f32_16x16x32_bf16 a[188:191], a[120:123], v[56:59], a[188:191]
    v_mfma_f32_16x16x32_bf16 a[188:191], a[124:127], v[60:63], a[188:191]
    v_mfma_f32_16x16x32_bf16 a[192:195], a[64:67], v[40:43], a[192:195]
    v_mfma_f32_16x16x32_bf16 a[192:195], a[68:71], v[44:47], a[192:195]
    v_mfma_f32_16x16x32_bf16 a[196:199], a[72:75], v[40:43], a[196:199]
    v_mfma_f32_16x16x32_bf16 a[196:199], a[76:79], v[44:47], a[196:199]
    buffer_load_dwordx4 v8, s[8:11], s61 offen offset:2048 lds
    v_mfma_f32_16x16x32_bf16 a[200:203], a[80:83], v[40:43], a[200:203]
    ds_read_b128 a[56:59], v22 offset:55296
    v_mfma_f32_16x16x32_bf16 a[200:203], a[84:87], v[44:47], a[200:203]
    v_mfma_f32_16x16x32_bf16 a[204:207], a[88:91], v[40:43], a[204:207]
    v_mfma_f32_16x16x32_bf16 a[204:207], a[92:95], v[44:47], a[204:207]
    v_mfma_f32_16x16x32_bf16 a[208:211], a[96:99], v[40:43], a[208:211]
    ds_read_b128 a[60:63], v23 offset:55296
    v_mfma_f32_16x16x32_bf16 a[208:211], a[100:103], v[44:47], a[208:211]
    v_mfma_f32_16x16x32_bf16 a[212:215], a[104:107], v[40:43], a[212:215]
    buffer_load_dwordx4 v9, s[8:11], s61 offen offset:3072 lds
    v_mfma_f32_16x16x32_bf16 a[212:215], a[108:111], v[44:47], a[212:215]
    v_mfma_f32_16x16x32_bf16 a[216:219], a[112:115], v[40:43], a[216:219]
    v_mfma_f32_16x16x32_bf16 a[216:219], a[116:119], v[44:47], a[216:219]
    v_mfma_f32_16x16x32_bf16 a[220:223], a[120:123], v[40:43], a[220:223]
    v_mfma_f32_16x16x32_bf16 a[220:223], a[124:127], v[44:47], a[220:223]
    s_waitcnt lgkmcnt(0)
    v_mfma_f32_16x16x32_bf16 a[224:227], a[64:67], v[48:51], a[224:227]
    v_mfma_f32_16x16x32_bf16 a[224:227], a[68:71], v[52:55], a[224:227]
    s_xor_b32 s61, s61, 128
    v_mfma_f32_16x16x32_bf16 a[228:231], a[72:75], v[48:51], a[228:231]
    v_mfma_f32_16x16x32_bf16 a[228:231], a[76:79], v[52:55], a[228:231]
    v_mfma_f32_16x16x32_bf16 a[232:235], a[80:83], v[48:51], a[232:235]
    v_mfma_f32_16x16x32_bf16 a[232:235], a[84:87], v[52:55], a[232:235]
    s_waitcnt vmcnt(9) lgkmcnt(0)
    s_barrier
    ds_read_b64_tr_b16 v[56:57], v14 offset:0
    v_mfma_f32_16x16x32_bf16 a[236:239], a[88:91], v[48:51], a[236:239]
    s_add_u32 m0, s69, 65536
    ds_read_b64_tr_b16 v[58:59], v14 offset:1024
    ds_read_b64_tr_b16 v[60:61], v14 offset:8192
    v_mfma_f32_16x16x32_bf16 a[236:239], a[92:95], v[52:55], a[236:239]
    buffer_load_dwordx4 v2, s[16:19], s60 offen nt lds
    v_mfma_f32_16x16x32_bf16 a[240:243], a[96:99], v[48:51], a[240:243]
    ds_read_b64_tr_b16 v[62:63], v14 offset:9216
    ds_read_b64_tr_b16 v[40:41], v15 offset:0
    v_mfma_f32_16x16x32_bf16 a[240:243], a[100:103], v[52:55], a[240:243]
    buffer_atomic_add v31, v30, s[44:47], s95 offen sc1
    v_mfma_f32_16x16x32_bf16 a[244:247], a[104:107], v[48:51], a[244:247]
    s_mov_b32 s95, 32768
    ds_read_b64_tr_b16 v[42:43], v15 offset:1024
    ds_read_b64_tr_b16 v[44:45], v15 offset:8192
    v_mfma_f32_16x16x32_bf16 a[244:247], a[108:111], v[52:55], a[244:247]
    ds_read_b64_tr_b16 v[46:47], v15 offset:9216
    v_add_u32 v14, 0xfffe0000, v14
    v_mfma_f32_16x16x32_bf16 a[248:251], a[112:115], v[48:51], a[248:251]
    v_add_u32 v15, 0xfffe0000, v15
    v_mfma_f32_16x16x32_bf16 a[248:251], a[116:119], v[52:55], a[248:251]
    buffer_load_dwordx4 v3, s[16:19], s60 offen offset:1024 nt lds
    v_mfma_f32_16x16x32_bf16 a[252:255], a[120:123], v[48:51], a[252:255]
    ds_read_b64_tr_b16 v[48:49], v16 offset:0
    ds_read_b64_tr_b16 v[50:51], v16 offset:1024
    v_mfma_f32_16x16x32_bf16 a[252:255], a[124:127], v[52:55], a[252:255]
    s_waitcnt lgkmcnt(3)
    ds_read_b64_tr_b16 v[52:53], v16 offset:8192
    ds_read_b64_tr_b16 v[54:55], v16 offset:9216
    v_mfma_f32_16x16x32_bf16 v[128:131], v[56:59], a[0:3], v[128:131]
    v_add_u32 v16, 0xfffe0000, v16
    v_mfma_f32_16x16x32_bf16 v[128:131], v[60:63], a[4:7], v[128:131]
    v_add_u32 v22, 0x10000, v22
    v_mfma_f32_16x16x32_bf16 v[132:135], v[56:59], a[8:11], v[132:135]
    ds_read_b128 a[64:67], v22 offset:16384
    v_mfma_f32_16x16x32_bf16 v[132:135], v[60:63], a[12:15], v[132:135]
    v_mfma_f32_16x16x32_bf16 v[136:139], v[56:59], a[16:19], v[136:139]
    v_mfma_f32_16x16x32_bf16 v[136:139], v[60:63], a[20:23], v[136:139]
    buffer_load_dwordx4 v4, s[16:19], s60 offen offset:2048 nt lds
    v_mfma_f32_16x16x32_bf16 v[140:143], v[56:59], a[24:27], v[140:143]
    v_add_u32 v23, 0x10000, v23
    v_mfma_f32_16x16x32_bf16 v[140:143], v[60:63], a[28:31], v[140:143]
    ds_read_b128 a[68:71], v23 offset:16384
    v_mfma_f32_16x16x32_bf16 v[144:147], v[56:59], a[32:35], v[144:147]
    v_mfma_f32_16x16x32_bf16 v[144:147], v[60:63], a[36:39], v[144:147]
    v_mfma_f32_16x16x32_bf16 v[148:151], v[56:59], a[40:43], v[148:151]
    v_mfma_f32_16x16x32_bf16 v[148:151], v[60:63], a[44:47], v[148:151]
    v_mfma_f32_16x16x32_bf16 v[152:155], v[56:59], a[48:51], v[152:155]
    buffer_load_dwordx4 v5, s[16:19], s60 offen offset:3072 nt lds
    v_mfma_f32_16x16x32_bf16 v[152:155], v[60:63], a[52:55], v[152:155]
    ds_read_b128 a[72:75], v22 offset:18432
    v_mfma_f32_16x16x32_bf16 v[156:159], v[56:59], a[56:59], v[156:159]
    ds_read_b64_tr_b16 v[56:57], v17 offset:0
    ds_read_b64_tr_b16 v[58:59], v17 offset:1024
    v_mfma_f32_16x16x32_bf16 v[156:159], v[60:63], a[60:63], v[156:159]
    ds_read_b64_tr_b16 v[60:61], v17 offset:8192
    ds_read_b64_tr_b16 v[62:63], v17 offset:9216
    v_mfma_f32_16x16x32_bf16 v[160:163], v[40:43], a[0:3], v[160:163]
    s_waitcnt lgkmcnt(5)
    v_add_u32 v17, 0xfffe0000, v17
    v_mfma_f32_16x16x32_bf16 v[160:163], v[44:47], a[4:7], v[160:163]
    v_mfma_f32_16x16x32_bf16 v[164:167], v[40:43], a[8:11], v[164:167]
    ds_read_b128 a[76:79], v23 offset:18432
    v_mfma_f32_16x16x32_bf16 v[164:167], v[44:47], a[12:15], v[164:167]
    s_add_u32 m0, s69, 81920
    v_mfma_f32_16x16x32_bf16 v[168:171], v[40:43], a[16:19], v[168:171]
    s_xor_b32 s60, s60, 1572864
    buffer_load_dwordx4 v6, s[8:11], s62 offen lds
    v_mfma_f32_16x16x32_bf16 v[168:171], v[44:47], a[20:23], v[168:171]
    v_mfma_f32_16x16x32_bf16 v[172:175], v[40:43], a[24:27], v[172:175]
    v_mfma_f32_16x16x32_bf16 v[172:175], v[44:47], a[28:31], v[172:175]
    v_mfma_f32_16x16x32_bf16 v[176:179], v[40:43], a[32:35], v[176:179]
    ds_read_b128 a[80:83], v22 offset:20480
    v_mfma_f32_16x16x32_bf16 v[176:179], v[44:47], a[36:39], v[176:179]
    v_mfma_f32_16x16x32_bf16 v[180:183], v[40:43], a[40:43], v[180:183]
    v_mfma_f32_16x16x32_bf16 v[180:183], v[44:47], a[44:47], v[180:183]
    buffer_load_dwordx4 v7, s[8:11], s62 offen offset:1024 lds
    v_mfma_f32_16x16x32_bf16 v[184:187], v[40:43], a[48:51], v[184:187]
    v_mfma_f32_16x16x32_bf16 v[184:187], v[44:47], a[52:55], v[184:187]
    ds_read_b128 a[84:87], v23 offset:20480
    v_mfma_f32_16x16x32_bf16 v[188:191], v[40:43], a[56:59], v[188:191]
    ds_read_b64_tr_b16 v[40:41], v14 offset:0
    ds_read_b64_tr_b16 v[42:43], v14 offset:1024
    v_mfma_f32_16x16x32_bf16 v[188:191], v[44:47], a[60:63], v[188:191]
    ds_read_b64_tr_b16 v[44:45], v14 offset:8192
    ds_read_b64_tr_b16 v[46:47], v14 offset:9216
    v_mfma_f32_16x16x32_bf16 v[192:195], v[48:51], a[0:3], v[192:195]
    v_mfma_f32_16x16x32_bf16 v[192:195], v[52:55], a[4:7], v[192:195]
    v_mfma_f32_16x16x32_bf16 v[196:199], v[48:51], a[8:11], v[196:199]
    v_mfma_f32_16x16x32_bf16 v[196:199], v[52:55], a[12:15], v[196:199]
    buffer_load_dwordx4 v8, s[8:11], s62 offen offset:2048 lds
    v_mfma_f32_16x16x32_bf16 v[200:203], v[48:51], a[16:19], v[200:203]
    ds_read_b128 a[88:91], v22 offset:22528
    v_mfma_f32_16x16x32_bf16 v[200:203], v[52:55], a[20:23], v[200:203]
    v_mfma_f32_16x16x32_bf16 v[204:207], v[48:51], a[24:27], v[204:207]
    v_mfma_f32_16x16x32_bf16 v[204:207], v[52:55], a[28:31], v[204:207]
    v_mfma_f32_16x16x32_bf16 v[208:211], v[48:51], a[32:35], v[208:211]
    ds_read_b128 a[92:95], v23 offset:22528
    v_mfma_f32_16x16x32_bf16 v[208:211], v[52:55], a[36:39], v[208:211]
    v_mfma_f32_16x16x32_bf16 v[212:215], v[48:51], a[40:43], v[212:215]
    buffer_load_dwordx4 v9, s[8:11], s62 offen offset:3072 lds
    v_mfma_f32_16x16x32_bf16 v[212:215], v[52:55], a[44:47], v[212:215]
    v_mfma_f32_16x16x32_bf16 v[216:219], v[48:51], a[48:51], v[216:219]
    v_mfma_f32_16x16x32_bf16 v[216:219], v[52:55], a[52:55], v[216:219]
    v_mfma_f32_16x16x32_bf16 v[220:223], v[48:51], a[56:59], v[220:223]
    s_waitcnt lgkmcnt(0)
    ds_read_b64_tr_b16 v[48:49], v15 offset:0
    ds_read_b64_tr_b16 v[50:51], v15 offset:1024
    v_mfma_f32_16x16x32_bf16 v[220:223], v[52:55], a[60:63], v[220:223]
    ds_read_b64_tr_b16 v[52:53], v15 offset:8192
    ds_read_b64_tr_b16 v[54:55], v15 offset:9216
    v_mfma_f32_16x16x32_bf16 v[224:227], v[56:59], a[0:3], v[224:227]
    v_mfma_f32_16x16x32_bf16 v[224:227], v[60:63], a[4:7], v[224:227]
    s_xor_b32 s62, s62, 128
    v_mfma_f32_16x16x32_bf16 v[228:231], v[56:59], a[8:11], v[228:231]
    buffer_load_dword v108, v103, s[24:27], s77 offen
    v_mfma_f32_16x16x32_bf16 v[228:231], v[60:63], a[12:15], v[228:231]
    s_add_u32 s77, s77, 4608
    v_mfma_f32_16x16x32_bf16 v[232:235], v[56:59], a[16:19], v[232:235]
    v_mfma_f32_16x16x32_bf16 v[232:235], v[60:63], a[20:23], v[232:235]
    s_add_u32 m0, s69, 98304
    v_mfma_f32_16x16x32_bf16 v[236:239], v[56:59], a[24:27], v[236:239]
    buffer_load_dwordx4 v2, s[12:15], s60 offen nt lds
    v_mfma_f32_16x16x32_bf16 v[236:239], v[60:63], a[28:31], v[236:239]
    v_mfma_f32_16x16x32_bf16 v[240:243], v[56:59], a[32:35], v[240:243]
    v_mfma_f32_16x16x32_bf16 v[240:243], v[60:63], a[36:39], v[240:243]
    v_mfma_f32_16x16x32_bf16 v[244:247], v[56:59], a[40:43], v[244:247]
    v_mfma_f32_16x16x32_bf16 v[244:247], v[60:63], a[44:47], v[244:247]
    v_mfma_f32_16x16x32_bf16 v[248:251], v[56:59], a[48:51], v[248:251]
    v_mfma_f32_16x16x32_bf16 v[248:251], v[60:63], a[52:55], v[248:251]
    buffer_load_dwordx4 v3, s[12:15], s60 offen offset:1024 nt lds
    v_mfma_f32_16x16x32_bf16 v[252:255], v[56:59], a[56:59], v[252:255]
    ds_read_b64_tr_b16 v[56:57], v16 offset:0
    ds_read_b64_tr_b16 v[58:59], v16 offset:1024
    v_mfma_f32_16x16x32_bf16 v[252:255], v[60:63], a[60:63], v[252:255]
    ds_read_b64_tr_b16 v[60:61], v16 offset:8192
    ds_read_b64_tr_b16 v[62:63], v16 offset:9216
    v_mfma_f32_16x16x32_bf16 a[128:131], a[0:3], v[40:43], a[128:131]
    v_mfma_f32_16x16x32_bf16 a[128:131], a[4:7], v[44:47], a[128:131]
    v_add_u32 v22, 0xfffe0000, v22
    v_mfma_f32_16x16x32_bf16 a[132:135], a[8:11], v[40:43], a[132:135]
    ds_read_b128 a[96:99], v22 offset:16384
    v_mfma_f32_16x16x32_bf16 a[132:135], a[12:15], v[44:47], a[132:135]
    v_mfma_f32_16x16x32_bf16 a[136:139], a[16:19], v[40:43], a[136:139]
    v_mfma_f32_16x16x32_bf16 a[136:139], a[20:23], v[44:47], a[136:139]
    buffer_load_dwordx4 v4, s[12:15], s60 offen offset:2048 nt lds
    v_mfma_f32_16x16x32_bf16 a[140:143], a[24:27], v[40:43], a[140:143]
    v_add_u32 v23, 0xfffe0000, v23
    v_mfma_f32_16x16x32_bf16 a[140:143], a[28:31], v[44:47], a[140:143]
    ds_read_b128 a[100:103], v23 offset:16384
    v_mfma_f32_16x16x32_bf16 a[144:147], a[32:35], v[40:43], a[144:147]
    v_mfma_f32_16x16x32_bf16 a[144:147], a[36:39], v[44:47], a[144:147]
    v_mfma_f32_16x16x32_bf16 a[148:151], a[40:43], v[40:43], a[148:151]
    v_mfma_f32_16x16x32_bf16 a[148:151], a[44:47], v[44:47], a[148:151]
    v_mfma_f32_16x16x32_bf16 a[152:155], a[48:51], v[40:43], a[152:155]
    buffer_load_dwordx4 v5, s[12:15], s60 offen offset:3072 nt lds
    v_mfma_f32_16x16x32_bf16 a[152:155], a[52:55], v[44:47], a[152:155]
    ds_read_b128 a[104:107], v22 offset:18432
    v_mfma_f32_16x16x32_bf16 a[156:159], a[56:59], v[40:43], a[156:159]
    ds_read_b64_tr_b16 v[40:41], v17 offset:0
    ds_read_b64_tr_b16 v[42:43], v17 offset:1024
    v_mfma_f32_16x16x32_bf16 a[156:159], a[60:63], v[44:47], a[156:159]
    s_waitcnt lgkmcnt(3)
    ds_read_b64_tr_b16 v[44:45], v17 offset:8192
    ds_read_b64_tr_b16 v[46:47], v17 offset:9216
    v_mfma_f32_16x16x32_bf16 a[160:163], a[0:3], v[48:51], a[160:163]
    v_mfma_f32_16x16x32_bf16 a[160:163], a[4:7], v[52:55], a[160:163]
    v_mfma_f32_16x16x32_bf16 a[164:167], a[8:11], v[48:51], a[164:167]
    ds_read_b128 a[108:111], v23 offset:18432
    v_mfma_f32_16x16x32_bf16 a[164:167], a[12:15], v[52:55], a[164:167]
    s_add_u32 m0, s69, 114688
    v_mfma_f32_16x16x32_bf16 a[168:171], a[16:19], v[48:51], a[168:171]
    s_xor_b32 s60, s60, 524288
    buffer_load_dwordx4 v6, s[8:11], s61 offen lds
    v_mfma_f32_16x16x32_bf16 a[168:171], a[20:23], v[52:55], a[168:171]
    v_mfma_f32_16x16x32_bf16 a[172:175], a[24:27], v[48:51], a[172:175]
    v_mfma_f32_16x16x32_bf16 a[172:175], a[28:31], v[52:55], a[172:175]
    v_mfma_f32_16x16x32_bf16 a[176:179], a[32:35], v[48:51], a[176:179]
    ds_read_b128 a[112:115], v22 offset:20480
    v_mfma_f32_16x16x32_bf16 a[176:179], a[36:39], v[52:55], a[176:179]
    v_mfma_f32_16x16x32_bf16 a[180:183], a[40:43], v[48:51], a[180:183]
    v_mfma_f32_16x16x32_bf16 a[180:183], a[44:47], v[52:55], a[180:183]
    buffer_load_dwordx4 v7, s[8:11], s61 offen offset:1024 lds
    v_mfma_f32_16x16x32_bf16 a[184:187], a[48:51], v[48:51], a[184:187]
    v_mfma_f32_16x16x32_bf16 a[184:187], a[52:55], v[52:55], a[184:187]
    ds_read_b128 a[116:119], v23 offset:20480
    v_mfma_f32_16x16x32_bf16 a[188:191], a[56:59], v[48:51], a[188:191]
    v_mfma_f32_16x16x32_bf16 a[188:191], a[60:63], v[52:55], a[188:191]
    v_mfma_f32_16x16x32_bf16 a[192:195], a[0:3], v[56:59], a[192:195]
    v_mfma_f32_16x16x32_bf16 a[192:195], a[4:7], v[60:63], a[192:195]
    v_mfma_f32_16x16x32_bf16 a[196:199], a[8:11], v[56:59], a[196:199]
    v_mfma_f32_16x16x32_bf16 a[196:199], a[12:15], v[60:63], a[196:199]
    buffer_load_dwordx4 v8, s[8:11], s61 offen offset:2048 lds
    v_mfma_f32_16x16x32_bf16 a[200:203], a[16:19], v[56:59], a[200:203]
    ds_read_b128 a[120:123], v22 offset:22528
    v_mfma_f32_16x16x32_bf16 a[200:203], a[20:23], v[60:63], a[200:203]
    v_mfma_f32_16x16x32_bf16 a[204:207], a[24:27], v[56:59], a[204:207]
    v_mfma_f32_16x16x32_bf16 a[204:207], a[28:31], v[60:63], a[204:207]
    v_mfma_f32_16x16x32_bf16 a[208:211], a[32:35], v[56:59], a[208:211]
    ds_read_b128 a[124:127], v23 offset:22528
    v_mfma_f32_16x16x32_bf16 a[208:211], a[36:39], v[60:63], a[208:211]
    v_mfma_f32_16x16x32_bf16 a[212:215], a[40:43], v[56:59], a[212:215]
    buffer_load_dwordx4 v9, s[8:11], s61 offen offset:3072 lds
    v_mfma_f32_16x16x32_bf16 a[212:215], a[44:47], v[60:63], a[212:215]
    v_mfma_f32_16x16x32_bf16 a[216:219], a[48:51], v[56:59], a[216:219]
    v_mfma_f32_16x16x32_bf16 a[216:219], a[52:55], v[60:63], a[216:219]
    v_mfma_f32_16x16x32_bf16 a[220:223], a[56:59], v[56:59], a[220:223]
    v_mfma_f32_16x16x32_bf16 a[220:223], a[60:63], v[60:63], a[220:223]
    s_waitcnt lgkmcnt(0)
    v_mfma_f32_16x16x32_bf16 a[224:227], a[0:3], v[40:43], a[224:227]
    v_mfma_f32_16x16x32_bf16 a[224:227], a[4:7], v[44:47], a[224:227]
    s_xor_b32 s61, s61, 1920
    v_mfma_f32_16x16x32_bf16 a[228:231], a[8:11], v[40:43], a[228:231]
    s_andn2_b32 s61, s61, 896
    v_mfma_f32_16x16x32_bf16 a[228:231], a[12:15], v[44:47], a[228:231]
    s_lshl_b32 s61, s5, 7
    v_mfma_f32_16x16x32_bf16 a[232:235], a[16:19], v[40:43], a[232:235]
    v_mfma_f32_16x16x32_bf16 a[232:235], a[20:23], v[44:47], a[232:235]
    s_waitcnt vmcnt(9) lgkmcnt(0)
    s_barrier
    ds_read_b64_tr_b16 v[48:49], v14 offset:32768
    v_mfma_f32_16x16x32_bf16 a[236:239], a[24:27], v[40:43], a[236:239]
    s_add_u32 m0, s69, 131072
    ds_read_b64_tr_b16 v[50:51], v14 offset:33792
    ds_read_b64_tr_b16 v[52:53], v14 offset:40960
    v_mfma_f32_16x16x32_bf16 a[236:239], a[28:31], v[44:47], a[236:239]
    buffer_load_dwordx4 v2, s[12:15], s60 offen nt lds
    v_mfma_f32_16x16x32_bf16 a[240:243], a[32:35], v[40:43], a[240:243]
    ds_read_b64_tr_b16 v[54:55], v14 offset:41984
    ds_read_b64_tr_b16 v[56:57], v15 offset:32768
    v_mfma_f32_16x16x32_bf16 a[240:243], a[36:39], v[44:47], a[240:243]
    ds_read_b64_tr_b16 v[58:59], v15 offset:33792
    ds_read_b64_tr_b16 v[60:61], v15 offset:40960
    v_mfma_f32_16x16x32_bf16 a[244:247], a[40:43], v[40:43], a[244:247]
    ds_read_b64_tr_b16 v[62:63], v15 offset:41984
    v_add_u32 v14, 0x10000, v14
    v_mfma_f32_16x16x32_bf16 a[244:247], a[44:47], v[44:47], a[244:247]
    v_add_u32 v15, 0x10000, v15
    v_mfma_f32_16x16x32_bf16 a[248:251], a[48:51], v[40:43], a[248:251]
    v_mfma_f32_16x16x32_bf16 a[248:251], a[52:55], v[44:47], a[248:251]
    buffer_load_dwordx4 v3, s[12:15], s60 offen offset:1024 nt lds
    v_mfma_f32_16x16x32_bf16 a[252:255], a[56:59], v[40:43], a[252:255]
    ds_read_b64_tr_b16 v[40:41], v16 offset:32768
    ds_read_b64_tr_b16 v[42:43], v16 offset:33792
    v_mfma_f32_16x16x32_bf16 a[252:255], a[60:63], v[44:47], a[252:255]
    s_waitcnt lgkmcnt(2)
    ds_read_b64_tr_b16 v[44:45], v16 offset:40960
    ds_read_b64_tr_b16 v[46:47], v16 offset:41984
    v_mfma_f32_16x16x32_bf16 v[128:131], v[48:51], a[64:67], v[128:131]
    v_add_u32 v16, 0x10000, v16
    v_mfma_f32_16x16x32_bf16 v[128:131], v[52:55], a[68:71], v[128:131]
    v_mfma_f32_16x16x32_bf16 v[132:135], v[48:51], a[72:75], v[132:135]
    ds_read_b128 a[0:3], v22 offset:49152
    v_mfma_f32_16x16x32_bf16 v[132:135], v[52:55], a[76:79], v[132:135]
    v_mfma_f32_16x16x32_bf16 v[136:139], v[48:51], a[80:83], v[136:139]
    v_mfma_f32_16x16x32_bf16 v[136:139], v[52:55], a[84:87], v[136:139]
    buffer_load_dwordx4 v4, s[12:15], s60 offen offset:2048 nt lds
    v_mfma_f32_16x16x32_bf16 v[140:143], v[48:51], a[88:91], v[140:143]
    v_mfma_f32_16x16x32_bf16 v[140:143], v[52:55], a[92:95], v[140:143]
    ds_read_b128 a[4:7], v23 offset:49152
    v_mfma_f32_16x16x32_bf16 v[144:147], v[48:51], a[96:99], v[144:147]
    v_mfma_f32_16x16x32_bf16 v[144:147], v[52:55], a[100:103], v[144:147]
    v_mfma_f32_16x16x32_bf16 v[148:151], v[48:51], a[104:107], v[148:151]
    v_mfma_f32_16x16x32_bf16 v[148:151], v[52:55], a[108:111], v[148:151]
    v_mfma_f32_16x16x32_bf16 v[152:155], v[48:51], a[112:115], v[152:155]
    buffer_load_dwordx4 v5, s[12:15], s60 offen offset:3072 nt lds
    v_mfma_f32_16x16x32_bf16 v[152:155], v[52:55], a[116:119], v[152:155]
    ds_read_b128 a[8:11], v22 offset:51200
    v_mfma_f32_16x16x32_bf16 v[156:159], v[48:51], a[120:123], v[156:159]
    ds_read_b64_tr_b16 v[48:49], v17 offset:32768
    ds_read_b64_tr_b16 v[50:51], v17 offset:33792
    v_mfma_f32_16x16x32_bf16 v[156:159], v[52:55], a[124:127], v[156:159]
    ds_read_b64_tr_b16 v[52:53], v17 offset:40960
    ds_read_b64_tr_b16 v[54:55], v17 offset:41984
    v_mfma_f32_16x16x32_bf16 v[160:163], v[56:59], a[64:67], v[160:163]
    v_add_u32 v17, 0x10000, v17
    v_mfma_f32_16x16x32_bf16 v[160:163], v[60:63], a[68:71], v[160:163]
    s_cmp_lt_u32 s4, 0
    s_cselect_b32 s12, 0xf149f2ca, 0
    v_mfma_f32_16x16x32_bf16 v[164:167], v[56:59], a[72:75], v[164:167]
    ds_read_b128 a[12:15], v23 offset:51200
    v_mfma_f32_16x16x32_bf16 v[164:167], v[60:63], a[76:79], v[164:167]
    s_add_u32 m0, s69, 147456
    v_mfma_f32_16x16x32_bf16 v[168:171], v[56:59], a[80:83], v[168:171]
    s_xor_b32 s60, s60, 524288
    buffer_load_dwordx4 v6, s[8:11], s62 offen lds
    v_mfma_f32_16x16x32_bf16 v[168:171], v[60:63], a[84:87], v[168:171]
    s_cmp_lt_u32 s4, 1
    s_cselect_b32 s13, 0xf149f2ca, 0
    v_mfma_f32_16x16x32_bf16 v[172:175], v[56:59], a[88:91], v[172:175]
    s_cmp_lt_u32 s4, 2
    s_cselect_b32 s14, 0xf149f2ca, 0
    v_mfma_f32_16x16x32_bf16 v[172:175], v[60:63], a[92:95], v[172:175]
    s_cmp_lt_u32 s4, 3
    s_cselect_b32 s15, 0xf149f2ca, 0
    v_mfma_f32_16x16x32_bf16 v[176:179], v[56:59], a[96:99], v[176:179]
    ds_read_b128 a[16:19], v22 offset:53248
    v_mfma_f32_16x16x32_bf16 v[176:179], v[60:63], a[100:103], v[176:179]
    v_mfma_f32_16x16x32_bf16 v[180:183], v[56:59], a[104:107], v[180:183]
    v_mfma_f32_16x16x32_bf16 v[180:183], v[60:63], a[108:111], v[180:183]
    buffer_load_dwordx4 v7, s[8:11], s62 offen offset:1024 lds
    v_mfma_f32_16x16x32_bf16 v[184:187], v[56:59], a[112:115], v[184:187]
    v_mfma_f32_16x16x32_bf16 v[184:187], v[60:63], a[116:119], v[184:187]
    ds_read_b128 a[20:23], v23 offset:53248
    v_mfma_f32_16x16x32_bf16 v[188:191], v[56:59], a[120:123], v[188:191]
    s_waitcnt lgkmcnt(1)
    ds_read_b64_tr_b16 v[56:57], v14 offset:0
    ds_read_b64_tr_b16 v[58:59], v14 offset:1024
    v_mfma_f32_16x16x32_bf16 v[188:191], v[60:63], a[124:127], v[188:191]
    ds_read_b64_tr_b16 v[60:61], v14 offset:8192
    ds_read_b64_tr_b16 v[62:63], v14 offset:9216
    v_mfma_f32_16x16x32_bf16 v[192:195], v[40:43], a[64:67], v[192:195]
    v_mfma_f32_16x16x32_bf16 v[192:195], v[44:47], a[68:71], v[192:195]
    v_mfma_f32_16x16x32_bf16 v[196:199], v[40:43], a[72:75], v[196:199]
    v_mfma_f32_16x16x32_bf16 v[196:199], v[44:47], a[76:79], v[196:199]
    buffer_load_dwordx4 v8, s[8:11], s62 offen offset:2048 lds
    v_mfma_f32_16x16x32_bf16 v[200:203], v[40:43], a[80:83], v[200:203]
    ds_read_b128 a[24:27], v22 offset:55296
    v_bfe_u32 v8, v1, 4, 3
    v_mfma_f32_16x16x32_bf16 v[200:203], v[44:47], a[84:87], v[200:203]
    v_lshlrev_b32 v8, 12, v8
    v_mfma_f32_16x16x32_bf16 v[204:207], v[40:43], a[88:91], v[204:207]
    v_mfma_f32_16x16x32_bf16 v[204:207], v[44:47], a[92:95], v[204:207]
    v_mfma_f32_16x16x32_bf16 v[208:211], v[40:43], a[96:99], v[208:211]
    ds_read_b128 a[28:31], v23 offset:55296
    v_mfma_f32_16x16x32_bf16 v[208:211], v[44:47], a[100:103], v[208:211]
    v_mfma_f32_16x16x32_bf16 v[212:215], v[40:43], a[104:107], v[212:215]
    buffer_load_dwordx4 v9, s[8:11], s62 offen offset:3072 lds
    v_mfma_f32_16x16x32_bf16 v[212:215], v[44:47], a[108:111], v[212:215]
    s_and_b32 s8, s5, 7
    v_lshrrev_b32 v9, 2, v1
    v_mfma_f32_16x16x32_bf16 v[216:219], v[40:43], a[112:115], v[216:219]
    s_lshl3_add_u32 s8, s6, s8
    v_mfma_f32_16x16x32_bf16 v[216:219], v[44:47], a[116:119], v[216:219]
    s_and_b32 s9, s5, 24
    v_mfma_f32_16x16x32_bf16 v[220:223], v[40:43], a[120:123], v[220:223]
    s_mul_i32 s10, s9, 18
    ds_read_b64_tr_b16 v[40:41], v15 offset:0
    ds_read_b64_tr_b16 v[42:43], v15 offset:1024
    v_mfma_f32_16x16x32_bf16 v[220:223], v[44:47], a[124:127], v[220:223]
    s_add_u32 s10, s10, 16
    ds_read_b64_tr_b16 v[44:45], v15 offset:8192
    ds_read_b64_tr_b16 v[46:47], v15 offset:9216
    v_mfma_f32_16x16x32_bf16 v[224:227], v[48:51], a[64:67], v[224:227]
    s_cmp_eq_u32 s4, 3
    s_cselect_b32 s11, 1.0, 0
    v_mfma_f32_16x16x32_bf16 v[224:227], v[52:55], a[68:71], v[224:227]
    s_xor_b32 s62, s62, 1920
    v_mfma_f32_16x16x32_bf16 v[228:231], v[48:51], a[72:75], v[228:231]
    s_andn2_b32 s62, s62, 896
    buffer_load_dword v109, v103, s[24:27], s77 offen
    v_mfma_f32_16x16x32_bf16 v[228:231], v[52:55], a[76:79], v[228:231]
    v_mfma_f32_16x16x32_bf16 v[232:235], v[48:51], a[80:83], v[232:235]
    v_mfma_f32_16x16x32_bf16 v[232:235], v[52:55], a[84:87], v[232:235]
    s_add_u32 m0, s69, 0
    v_mfma_f32_16x16x32_bf16 v[236:239], v[48:51], a[88:91], v[236:239]
    buffer_load_dwordx4 v2, s[16:19], s60 offen nt lds
    v_mfma_f32_16x16x32_bf16 v[236:239], v[52:55], a[92:95], v[236:239]
    v_mfma_f32_16x16x32_bf16 v[240:243], v[48:51], a[96:99], v[240:243]
    v_mfma_f32_16x16x32_bf16 v[240:243], v[52:55], a[100:103], v[240:243]
    v_mfma_f32_16x16x32_bf16 v[244:247], v[48:51], a[104:107], v[244:247]
    v_mfma_f32_16x16x32_bf16 v[244:247], v[52:55], a[108:111], v[244:247]
    v_mfma_f32_16x16x32_bf16 v[248:251], v[48:51], a[112:115], v[248:251]
    v_mfma_f32_16x16x32_bf16 v[248:251], v[52:55], a[116:119], v[248:251]
    buffer_load_dwordx4 v3, s[16:19], s60 offen offset:1024 nt lds
    v_mfma_f32_16x16x32_bf16 v[252:255], v[48:51], a[120:123], v[252:255]
    ds_read_b64_tr_b16 v[48:49], v16 offset:0
    ds_read_b64_tr_b16 v[50:51], v16 offset:1024
    v_mfma_f32_16x16x32_bf16 v[252:255], v[52:55], a[124:127], v[252:255]
    s_waitcnt lgkmcnt(2)
    ds_read_b64_tr_b16 v[52:53], v16 offset:8192
    ds_read_b64_tr_b16 v[54:55], v16 offset:9216
    v_mfma_f32_16x16x32_bf16 a[128:131], a[64:67], v[56:59], a[128:131]
    v_mfma_f32_16x16x32_bf16 a[128:131], a[68:71], v[60:63], a[128:131]
    v_add_u32 v22, 0x10000, v22
    v_mfma_f32_16x16x32_bf16 a[132:135], a[72:75], v[56:59], a[132:135]
    ds_read_b128 a[32:35], v22 offset:16384
    v_mfma_f32_16x16x32_bf16 a[132:135], a[76:79], v[60:63], a[132:135]
    v_mfma_f32_16x16x32_bf16 a[136:139], a[80:83], v[56:59], a[136:139]
    v_mfma_f32_16x16x32_bf16 a[136:139], a[84:87], v[60:63], a[136:139]
    buffer_load_dwordx4 v4, s[16:19], s60 offen offset:2048 nt lds
    v_mfma_f32_16x16x32_bf16 a[140:143], a[88:91], v[56:59], a[140:143]
    v_add_u32 v23, 0x10000, v23
    v_mfma_f32_16x16x32_bf16 a[140:143], a[92:95], v[60:63], a[140:143]
    ds_read_b128 a[36:39], v23 offset:16384
    v_mfma_f32_16x16x32_bf16 a[144:147], a[96:99], v[56:59], a[144:147]
    v_mfma_f32_16x16x32_bf16 a[144:147], a[100:103], v[60:63], a[144:147]
    v_mfma_f32_16x16x32_bf16 a[148:151], a[104:107], v[56:59], a[148:151]
    v_mfma_f32_16x16x32_bf16 a[148:151], a[108:111], v[60:63], a[148:151]
    v_mfma_f32_16x16x32_bf16 a[152:155], a[112:115], v[56:59], a[152:155]
    buffer_load_dwordx4 v5, s[16:19], s60 offen offset:3072 nt lds
    v_mfma_f32_16x16x32_bf16 a[152:155], a[116:119], v[60:63], a[152:155]
    ds_read_b128 a[40:43], v22 offset:18432
    v_mfma_f32_16x16x32_bf16 a[156:159], a[120:123], v[56:59], a[156:159]
    ds_read_b64_tr_b16 v[56:57], v17 offset:0
    ds_read_b64_tr_b16 v[58:59], v17 offset:1024
    v_mfma_f32_16x16x32_bf16 a[156:159], a[124:127], v[60:63], a[156:159]
    ds_read_b64_tr_b16 v[60:61], v17 offset:8192
    ds_read_b64_tr_b16 v[62:63], v17 offset:9216
    v_mfma_f32_16x16x32_bf16 a[160:163], a[64:67], v[40:43], a[160:163]
    v_mfma_f32_16x16x32_bf16 a[160:163], a[68:71], v[44:47], a[160:163]
    v_mfma_f32_16x16x32_bf16 a[164:167], a[72:75], v[40:43], a[164:167]
    ds_read_b128 a[44:47], v23 offset:18432
    v_mfma_f32_16x16x32_bf16 a[164:167], a[76:79], v[44:47], a[164:167]
    s_add_u32 m0, s69, 16384
    v_mfma_f32_16x16x32_bf16 a[168:171], a[80:83], v[40:43], a[168:171]
    s_xor_b32 s60, s60, 524288
    buffer_load_dwordx4 v10, s[20:23], s63 offen lds
    v_mfma_f32_16x16x32_bf16 a[168:171], a[84:87], v[44:47], a[168:171]
    v_mfma_f32_16x16x32_bf16 a[172:175], a[88:91], v[40:43], a[172:175]
    v_mfma_f32_16x16x32_bf16 a[172:175], a[92:95], v[44:47], a[172:175]
    v_mfma_f32_16x16x32_bf16 a[176:179], a[96:99], v[40:43], a[176:179]
    ds_read_b128 a[48:51], v22 offset:20480
    v_mfma_f32_16x16x32_bf16 a[176:179], a[100:103], v[44:47], a[176:179]
    v_mfma_f32_16x16x32_bf16 a[180:183], a[104:107], v[40:43], a[180:183]
    v_mfma_f32_16x16x32_bf16 a[180:183], a[108:111], v[44:47], a[180:183]
    buffer_load_dwordx4 v11, s[20:23], s63 offen offset:1024 lds
    v_mfma_f32_16x16x32_bf16 a[184:187], a[112:115], v[40:43], a[184:187]
    v_mfma_f32_16x16x32_bf16 a[184:187], a[116:119], v[44:47], a[184:187]
    ds_read_b128 a[52:55], v23 offset:20480
    v_mfma_f32_16x16x32_bf16 a[188:191], a[120:123], v[40:43], a[188:191]
    v_mfma_f32_16x16x32_bf16 a[188:191], a[124:127], v[44:47], a[188:191]
    s_waitcnt lgkmcnt(1)
    v_mfma_f32_16x16x32_bf16 a[192:195], a[64:67], v[48:51], a[192:195]
    v_mfma_f32_16x16x32_bf16 a[192:195], a[68:71], v[52:55], a[192:195]
    v_mfma_f32_16x16x32_bf16 a[196:199], a[72:75], v[48:51], a[196:199]
    v_mfma_f32_16x16x32_bf16 a[196:199], a[76:79], v[52:55], a[196:199]
    buffer_load_dwordx4 v12, s[20:23], s63 offen offset:2048 lds
    v_mfma_f32_16x16x32_bf16 a[200:203], a[80:83], v[48:51], a[200:203]
    ds_read_b128 a[56:59], v22 offset:22528
    v_mfma_f32_16x16x32_bf16 a[200:203], a[84:87], v[52:55], a[200:203]
    v_mfma_f32_16x16x32_bf16 a[204:207], a[88:91], v[48:51], a[204:207]
    v_mfma_f32_16x16x32_bf16 a[204:207], a[92:95], v[52:55], a[204:207]
    v_mfma_f32_16x16x32_bf16 a[208:211], a[96:99], v[48:51], a[208:211]
    ds_read_b128 a[60:63], v23 offset:22528
    v_mfma_f32_16x16x32_bf16 a[208:211], a[100:103], v[52:55], a[208:211]
    v_mfma_f32_16x16x32_bf16 a[212:215], a[104:107], v[48:51], a[212:215]
    buffer_load_dwordx4 v13, s[20:23], s63 offen offset:3072 lds
    v_mfma_f32_16x16x32_bf16 a[212:215], a[108:111], v[52:55], a[212:215]
    v_mfma_f32_16x16x32_bf16 a[216:219], a[112:115], v[48:51], a[216:219]
    v_mfma_f32_16x16x32_bf16 a[216:219], a[116:119], v[52:55], a[216:219]
    v_mfma_f32_16x16x32_bf16 a[220:223], a[120:123], v[48:51], a[220:223]
    v_mfma_f32_16x16x32_bf16 a[220:223], a[124:127], v[52:55], a[220:223]
    v_mfma_f32_16x16x32_bf16 a[224:227], a[64:67], v[56:59], a[224:227]
    v_mfma_f32_16x16x32_bf16 a[224:227], a[68:71], v[60:63], a[224:227]
    s_xor_b32 s63, s63, 128
    v_mfma_f32_16x16x32_bf16 a[228:231], a[72:75], v[56:59], a[228:231]
    v_mfma_f32_16x16x32_bf16 a[228:231], a[76:79], v[60:63], a[228:231]
    v_mfma_f32_16x16x32_bf16 a[232:235], a[80:83], v[56:59], a[232:235]
    v_mfma_f32_16x16x32_bf16 a[232:235], a[84:87], v[60:63], a[232:235]
    s_waitcnt vmcnt(9) lgkmcnt(0)
    s_barrier
    ds_read_b64_tr_b16 v[40:41], v14 offset:32768
    v_mfma_f32_16x16x32_bf16 a[236:239], a[88:91], v[56:59], a[236:239]
    s_add_u32 m0, s69, 32768
    ds_read_b64_tr_b16 v[42:43], v14 offset:33792
    ds_read_b64_tr_b16 v[44:45], v14 offset:40960
    v_mfma_f32_16x16x32_bf16 a[236:239], a[92:95], v[60:63], a[236:239]
    buffer_load_dwordx4 v2, s[16:19], s60 offen nt lds
    v_mfma_f32_16x16x32_bf16 a[240:243], a[96:99], v[56:59], a[240:243]
    ds_read_b64_tr_b16 v[46:47], v14 offset:41984
    ds_read_b64_tr_b16 v[48:49], v15 offset:32768
    v_mfma_f32_16x16x32_bf16 a[240:243], a[100:103], v[60:63], a[240:243]
    ds_read_b64_tr_b16 v[50:51], v15 offset:33792
    ds_read_b64_tr_b16 v[52:53], v15 offset:40960
    v_mfma_f32_16x16x32_bf16 a[244:247], a[104:107], v[56:59], a[244:247]
    ds_read_b64_tr_b16 v[54:55], v15 offset:41984
    v_add_u32 v14, 0x10000, v14
    v_mfma_f32_16x16x32_bf16 a[244:247], a[108:111], v[60:63], a[244:247]
    v_add_u32 v15, 0x10000, v15
    v_mfma_f32_16x16x32_bf16 a[248:251], a[112:115], v[56:59], a[248:251]
    v_mfma_f32_16x16x32_bf16 a[248:251], a[116:119], v[60:63], a[248:251]
    buffer_load_dwordx4 v3, s[16:19], s60 offen offset:1024 nt lds
    v_mfma_f32_16x16x32_bf16 a[252:255], a[120:123], v[56:59], a[252:255]
    ds_read_b64_tr_b16 v[56:57], v16 offset:32768
    ds_read_b64_tr_b16 v[58:59], v16 offset:33792
    v_mfma_f32_16x16x32_bf16 a[252:255], a[124:127], v[60:63], a[252:255]
    s_waitcnt lgkmcnt(2)
    ds_read_b64_tr_b16 v[60:61], v16 offset:40960
    ds_read_b64_tr_b16 v[62:63], v16 offset:41984
    v_mfma_f32_16x16x32_bf16 v[128:131], v[40:43], a[0:3], v[128:131]
    v_add_u32 v16, 0x10000, v16
    v_mfma_f32_16x16x32_bf16 v[128:131], v[44:47], a[4:7], v[128:131]
    ds_read_b128 a[64:67], v22 offset:49152
    v_mfma_f32_16x16x32_bf16 v[132:135], v[40:43], a[8:11], v[132:135]
    v_mfma_f32_16x16x32_bf16 v[132:135], v[44:47], a[12:15], v[132:135]
    v_mfma_f32_16x16x32_bf16 v[136:139], v[40:43], a[16:19], v[136:139]
    ds_read_b128 a[68:71], v23 offset:49152
    v_mfma_f32_16x16x32_bf16 v[136:139], v[44:47], a[20:23], v[136:139]
    buffer_load_dwordx4 v4, s[16:19], s60 offen offset:2048 nt lds
    v_mfma_f32_16x16x32_bf16 v[140:143], v[40:43], a[24:27], v[140:143]
    v_mfma_f32_16x16x32_bf16 v[140:143], v[44:47], a[28:31], v[140:143]
    ds_read_b128 a[72:75], v22 offset:51200
    v_mfma_f32_16x16x32_bf16 v[144:147], v[40:43], a[32:35], v[144:147]
    v_mfma_f32_16x16x32_bf16 v[144:147], v[44:47], a[36:39], v[144:147]
    v_mfma_f32_16x16x32_bf16 v[148:151], v[40:43], a[40:43], v[148:151]
    ds_read_b128 a[76:79], v23 offset:51200
    v_mfma_f32_16x16x32_bf16 v[148:151], v[44:47], a[44:47], v[148:151]
    v_mfma_f32_16x16x32_bf16 v[152:155], v[40:43], a[48:51], v[152:155]
    buffer_load_dwordx4 v5, s[16:19], s60 offen offset:3072 nt lds
    v_mfma_f32_16x16x32_bf16 v[152:155], v[44:47], a[52:55], v[152:155]
    v_mfma_f32_16x16x32_bf16 v[156:159], v[40:43], a[56:59], v[156:159]
    ds_read_b128 a[80:83], v22 offset:53248
    ds_read_b64_tr_b16 v[40:41], v17 offset:32768
    v_mfma_f32_16x16x32_bf16 v[156:159], v[44:47], a[60:63], v[156:159]
    ds_read_b64_tr_b16 v[42:43], v17 offset:33792
    ds_read_b64_tr_b16 v[44:45], v17 offset:40960
    v_mfma_f32_16x16x32_bf16 v[160:163], v[48:51], a[0:3], v[160:163]
    ds_read_b64_tr_b16 v[46:47], v17 offset:41984
    v_add_u32 v17, 0x10000, v17
    v_mfma_f32_16x16x32_bf16 v[160:163], v[52:55], a[4:7], v[160:163]
    ds_read_b128 a[84:87], v23 offset:53248
    v_mfma_f32_16x16x32_bf16 v[164:167], v[48:51], a[8:11], v[164:167]
    v_mfma_f32_16x16x32_bf16 v[164:167], v[52:55], a[12:15], v[164:167]
    s_add_u32 m0, s69, 49152
    buffer_load_dword v7, v9, s[44:47], s69 offen sc1
    v_mfma_f32_16x16x32_bf16 v[168:171], v[48:51], a[16:19], v[168:171]
    s_xor_b32 s60, s60, 3670016
    buffer_load_dwordx4 v10, s[20:23], s64 offen lds
    v_mfma_f32_16x16x32_bf16 v[168:171], v[52:55], a[20:23], v[168:171]
    ds_read_b128 a[88:91], v22 offset:55296
    v_mfma_f32_16x16x32_bf16 v[172:175], v[48:51], a[24:27], v[172:175]
    v_mfma_f32_16x16x32_bf16 v[172:175], v[52:55], a[28:31], v[172:175]
    s_waitcnt lgkmcnt(1)
    ds_read_b128 a[92:95], v23 offset:55296
    v_mfma_f32_16x16x32_bf16 v[176:179], v[48:51], a[32:35], v[176:179]
    v_mfma_f32_16x16x32_bf16 v[176:179], v[52:55], a[36:39], v[176:179]
    v_mfma_f32_16x16x32_bf16 v[180:183], v[48:51], a[40:43], v[180:183]
    v_mfma_f32_16x16x32_bf16 v[180:183], v[52:55], a[44:47], v[180:183]
    buffer_load_dwordx4 v11, s[20:23], s64 offen offset:1024 lds
    v_mfma_f32_16x16x32_bf16 v[184:187], v[48:51], a[48:51], v[184:187]
    v_add_u32 v22, 0x10000, v22
    ds_read_b128 a[96:99], v22 offset:16384
    v_mfma_f32_16x16x32_bf16 v[184:187], v[52:55], a[52:55], v[184:187]
    v_mfma_f32_16x16x32_bf16 v[188:191], v[48:51], a[56:59], v[188:191]
    v_add_u32 v23, 0x10000, v23
    ds_read_b64_tr_b16 v[48:49], v14 offset:0
    v_mfma_f32_16x16x32_bf16 v[188:191], v[52:55], a[60:63], v[188:191]
    ds_read_b128 a[100:103], v23 offset:16384
    ds_read_b64_tr_b16 v[50:51], v14 offset:1024
    v_mfma_f32_16x16x32_bf16 v[192:195], v[56:59], a[0:3], v[192:195]
    ds_read_b64_tr_b16 v[52:53], v14 offset:8192
    ds_read_b64_tr_b16 v[54:55], v14 offset:9216
    v_mfma_f32_16x16x32_bf16 v[192:195], v[60:63], a[4:7], v[192:195]
    v_add_u32 v14, 0xfffe0000, v14
    v_mfma_f32_16x16x32_bf16 v[196:199], v[56:59], a[8:11], v[196:199]
    ds_read_b128 a[104:107], v22 offset:18432
    v_mfma_f32_16x16x32_bf16 v[196:199], v[60:63], a[12:15], v[196:199]
    buffer_load_dwordx4 v12, s[20:23], s64 offen offset:2048 lds
    v_mfma_f32_16x16x32_bf16 v[200:203], v[56:59], a[16:19], v[200:203]
    v_mfma_f32_16x16x32_bf16 v[200:203], v[60:63], a[20:23], v[200:203]
    ds_read_b128 a[108:111], v23 offset:18432
    v_mfma_f32_16x16x32_bf16 v[204:207], v[56:59], a[24:27], v[204:207]
    v_mfma_f32_16x16x32_bf16 v[204:207], v[60:63], a[28:31], v[204:207]
    v_mfma_f32_16x16x32_bf16 v[208:211], v[56:59], a[32:35], v[208:211]
    v_mfma_f32_16x16x32_bf16 v[208:211], v[60:63], a[36:39], v[208:211]
    ds_read_b128 a[112:115], v22 offset:20480
    v_mfma_f32_16x16x32_bf16 v[212:215], v[56:59], a[40:43], v[212:215]
    buffer_load_dwordx4 v13, s[20:23], s64 offen offset:3072 lds
    v_mfma_f32_16x16x32_bf16 v[212:215], v[60:63], a[44:47], v[212:215]
    v_mfma_f32_16x16x32_bf16 v[216:219], v[56:59], a[48:51], v[216:219]
    ds_read_b128 a[116:119], v23 offset:20480
    v_mfma_f32_16x16x32_bf16 v[216:219], v[60:63], a[52:55], v[216:219]
    v_mfma_f32_16x16x32_bf16 v[220:223], v[56:59], a[56:59], v[220:223]
    ds_read_b64_tr_b16 v[56:57], v15 offset:0
    ds_read_b64_tr_b16 v[58:59], v15 offset:1024
    v_mfma_f32_16x16x32_bf16 v[220:223], v[60:63], a[60:63], v[220:223]
    s_waitcnt lgkmcnt(3)
    ds_read_b128 a[120:123], v22 offset:22528
    ds_read_b64_tr_b16 v[60:61], v15 offset:8192
    v_mfma_f32_16x16x32_bf16 v[224:227], v[40:43], a[0:3], v[224:227]
    ds_read_b64_tr_b16 v[62:63], v15 offset:9216
    v_add_u32 v15, 0xfffe0000, v15
    v_mfma_f32_16x16x32_bf16 v[224:227], v[44:47], a[4:7], v[224:227]
    s_xor_b32 s64, s64, 128
    v_mfma_f32_16x16x32_bf16 v[228:231], v[40:43], a[8:11], v[228:231]
    ds_read_b128 a[124:127], v23 offset:22528
    v_mfma_f32_16x16x32_bf16 v[228:231], v[44:47], a[12:15], v[228:231]
    v_mfma_f32_16x16x32_bf16 v[232:235], v[40:43], a[16:19], v[232:235]
    v_mfma_f32_16x16x32_bf16 v[232:235], v[44:47], a[20:23], v[232:235]
    s_add_u32 m0, s69, 65536
    v_mfma_f32_16x16x32_bf16 v[236:239], v[40:43], a[24:27], v[236:239]
    buffer_load_dwordx4 v2, s[24:27], s60 offen lds
    v_mfma_f32_16x16x32_bf16 v[236:239], v[44:47], a[28:31], v[236:239]
    v_mfma_f32_16x16x32_bf16 v[240:243], v[40:43], a[32:35], v[240:243]
    v_mfma_f32_16x16x32_bf16 v[240:243], v[44:47], a[36:39], v[240:243]
    v_mfma_f32_16x16x32_bf16 v[244:247], v[40:43], a[40:43], v[244:247]
    v_mfma_f32_16x16x32_bf16 v[244:247], v[44:47], a[44:47], v[244:247]
    v_mfma_f32_16x16x32_bf16 v[248:251], v[40:43], a[48:51], v[248:251]
    v_mfma_f32_16x16x32_bf16 v[248:251], v[44:47], a[52:55], v[248:251]
    buffer_load_dwordx4 v3, s[24:27], s60 offen offset:1024 lds
    v_mfma_f32_16x16x32_bf16 v[252:255], v[40:43], a[56:59], v[252:255]
    ds_read_b64_tr_b16 v[40:41], v16 offset:0
    ds_read_b64_tr_b16 v[42:43], v16 offset:1024
    v_mfma_f32_16x16x32_bf16 v[252:255], v[44:47], a[60:63], v[252:255]
    ds_read_b64_tr_b16 v[44:45], v16 offset:8192
    ds_read_b64_tr_b16 v[46:47], v16 offset:9216
    v_mfma_f32_16x16x32_bf16 v[128:131], v[48:51], a[64:67], v[128:131]
    v_add_u32 v16, 0xfffe0000, v16
    v_mfma_f32_16x16x32_bf16 v[128:131], v[52:55], a[68:71], v[128:131]
    v_mfma_f32_16x16x32_bf16 v[132:135], v[48:51], a[72:75], v[132:135]
    v_mfma_f32_16x16x32_bf16 v[132:135], v[52:55], a[76:79], v[132:135]
    v_mfma_f32_16x16x32_bf16 v[136:139], v[48:51], a[80:83], v[136:139]
    v_mfma_f32_16x16x32_bf16 v[136:139], v[52:55], a[84:87], v[136:139]
    buffer_load_dwordx4 v4, s[24:27], s60 offen offset:2048 lds
    v_mfma_f32_16x16x32_bf16 v[140:143], v[48:51], a[88:91], v[140:143]
    v_mfma_f32_16x16x32_bf16 v[140:143], v[52:55], a[92:95], v[140:143]
    v_mfma_f32_16x16x32_bf16 v[144:147], v[48:51], a[96:99], v[144:147]
    v_mul_f32 v128, s74, v128
    v_mul_f32 v129, s74, v129
    v_mfma_f32_16x16x32_bf16 v[144:147], v[52:55], a[100:103], v[144:147]
    v_mul_f32 v130, s74, v130
    v_mul_f32 v131, s74, v131
    v_mfma_f32_16x16x32_bf16 v[148:151], v[48:51], a[104:107], v[148:151]
    v_cvt_pk_bf16_f32 v128, v128, v129
    v_cvt_pk_bf16_f32 v129, v130, v131
    v_mfma_f32_16x16x32_bf16 v[148:151], v[52:55], a[108:111], v[148:151]
    v_mul_f32 v132, s74, v132
    v_mul_f32 v133, s74, v133
    v_mfma_f32_16x16x32_bf16 v[152:155], v[48:51], a[112:115], v[152:155]
    s_waitcnt lgkmcnt(0)
    buffer_load_dwordx4 v5, s[24:27], s60 offen offset:3072 lds
    v_mfma_f32_16x16x32_bf16 v[152:155], v[52:55], a[116:119], v[152:155]
    v_mul_f32 v134, s74, v134
    v_mul_f32 v135, s74, v135
    v_mfma_f32_16x16x32_bf16 v[156:159], v[48:51], a[120:123], v[156:159]
    ds_read_b64_tr_b16 v[48:49], v17 offset:0
    ds_read_b64_tr_b16 v[50:51], v17 offset:1024
    v_mfma_f32_16x16x32_bf16 v[156:159], v[52:55], a[124:127], v[156:159]
    ds_read_b64_tr_b16 v[52:53], v17 offset:8192
    ds_read_b64_tr_b16 v[54:55], v17 offset:9216
    v_mfma_f32_16x16x32_bf16 v[160:163], v[56:59], a[64:67], v[160:163]
    v_add_u32 v17, 0xfffe0000, v17
    v_cvt_pk_bf16_f32 v132, v132, v133
    v_mfma_f32_16x16x32_bf16 v[160:163], v[60:63], a[68:71], v[160:163]
    v_cvt_pk_bf16_f32 v133, v134, v135
    v_mul_f32 v136, s74, v136
    v_mfma_f32_16x16x32_bf16 v[164:167], v[56:59], a[72:75], v[164:167]
    v_mul_f32 v137, s74, v137
    v_mul_f32 v138, s74, v138
    v_mfma_f32_16x16x32_bf16 v[164:167], v[60:63], a[76:79], v[164:167]
    s_add_u32 m0, s69, 81920
    v_mul_f32 v139, s74, v139
    v_mul_f32 v160, s74, v160
    v_mfma_f32_16x16x32_bf16 v[168:171], v[56:59], a[80:83], v[168:171]
    s_xor_b32 s60, s60, 524288
    buffer_load_dwordx4 v10, s[20:23], s63 offen lds
    v_mfma_f32_16x16x32_bf16 v[168:171], v[60:63], a[84:87], v[168:171]
    v_mul_f32 v161, s74, v161
    v_mul_f32 v162, s74, v162
    v_mfma_f32_16x16x32_bf16 v[172:175], v[56:59], a[88:91], v[172:175]
    v_mul_f32 v163, s74, v163
    v_cvt_pk_bf16_f32 v130, v160, v161
    v_mfma_f32_16x16x32_bf16 v[172:175], v[60:63], a[92:95], v[172:175]
    v_cvt_pk_bf16_f32 v131, v162, v163
    v_mul_f32 v164, s74, v164
    v_mfma_f32_16x16x32_bf16 v[176:179], v[56:59], a[96:99], v[176:179]
    v_mul_f32 v165, s74, v165
    v_mul_f32 v166, s74, v166
    v_mfma_f32_16x16x32_bf16 v[176:179], v[60:63], a[100:103], v[176:179]
    v_mul_f32 v167, s74, v167
    v_cvt_pk_bf16_f32 v134, v164, v165
    v_mfma_f32_16x16x32_bf16 v[180:183], v[56:59], a[104:107], v[180:183]
    v_cvt_pk_bf16_f32 v135, v166, v167
    v_mul_f32 v168, s74, v168
    v_mfma_f32_16x16x32_bf16 v[180:183], v[60:63], a[108:111], v[180:183]
    buffer_load_dwordx4 v11, s[20:23], s63 offen offset:1024 lds
    v_mfma_f32_16x16x32_bf16 v[184:187], v[56:59], a[112:115], v[184:187]
    v_mul_f32 v169, s74, v169
    v_mul_f32 v170, s74, v170
    v_mfma_f32_16x16x32_bf16 v[184:187], v[60:63], a[116:119], v[184:187]
    v_mul_f32 v171, s74, v171
    v_cvt_pk_bf16_f32 v136, v136, v137
    v_mfma_f32_16x16x32_bf16 v[188:191], v[56:59], a[120:123], v[188:191]
    v_cvt_pk_bf16_f32 v137, v138, v139
    v_cvt_pk_bf16_f32 v138, v168, v169
    v_mfma_f32_16x16x32_bf16 v[188:191], v[60:63], a[124:127], v[188:191]
    v_cvt_pk_bf16_f32 v139, v170, v171
    v_mul_f32 v140, s74, v140
    v_mfma_f32_16x16x32_bf16 v[192:195], v[40:43], a[64:67], v[192:195]
    v_mul_f32 v141, s74, v141
    v_mul_f32 v142, s74, v142
    v_mfma_f32_16x16x32_bf16 v[192:195], v[44:47], a[68:71], v[192:195]
    v_mul_f32 v143, s74, v143
    v_mul_f32 v172, s74, v172
    v_mfma_f32_16x16x32_bf16 v[196:199], v[40:43], a[72:75], v[196:199]
    v_mul_f32 v173, s74, v173
    v_mul_f32 v174, s74, v174
    v_mfma_f32_16x16x32_bf16 v[196:199], v[44:47], a[76:79], v[196:199]
    buffer_load_dwordx4 v12, s[20:23], s63 offen offset:2048 lds
    v_mfma_f32_16x16x32_bf16 v[200:203], v[40:43], a[80:83], v[200:203]
    v_mul_f32 v175, s74, v175
    v_cvt_pk_bf16_f32 v140, v140, v141
    v_mfma_f32_16x16x32_bf16 v[200:203], v[44:47], a[84:87], v[200:203]
    v_cvt_pk_bf16_f32 v141, v142, v143
    v_cvt_pk_bf16_f32 v142, v172, v173
    v_mfma_f32_16x16x32_bf16 v[204:207], v[40:43], a[88:91], v[204:207]
    v_cvt_pk_bf16_f32 v143, v174, v175
    v_mul_f32 v144, s74, v144
    v_mfma_f32_16x16x32_bf16 v[204:207], v[44:47], a[92:95], v[204:207]
    v_mul_f32 v145, s74, v145
    v_mul_f32 v146, s74, v146
    v_mfma_f32_16x16x32_bf16 v[208:211], v[40:43], a[96:99], v[208:211]
    v_mul_f32 v147, s74, v147
    v_mul_f32 v176, s74, v176
    v_mfma_f32_16x16x32_bf16 v[208:211], v[44:47], a[100:103], v[208:211]
    v_mul_f32 v177, s74, v177
    v_mul_f32 v178, s74, v178
    v_mfma_f32_16x16x32_bf16 v[212:215], v[40:43], a[104:107], v[212:215]
    buffer_load_dwordx4 v13, s[20:23], s63 offen offset:3072 lds
    v_mfma_f32_16x16x32_bf16 v[212:215], v[44:47], a[108:111], v[212:215]
    v_mul_f32 v179, s74, v179
    v_cvt_pk_bf16_f32 v144, v144, v145
    v_mfma_f32_16x16x32_bf16 v[216:219], v[40:43], a[112:115], v[216:219]
    v_cvt_pk_bf16_f32 v145, v146, v147
    v_cvt_pk_bf16_f32 v146, v176, v177
    v_mfma_f32_16x16x32_bf16 v[216:219], v[44:47], a[116:119], v[216:219]
    v_cvt_pk_bf16_f32 v147, v178, v179
    v_mul_f32 v148, s74, v148
    v_mfma_f32_16x16x32_bf16 v[220:223], v[40:43], a[120:123], v[220:223]
    v_mul_f32 v149, s74, v149
    v_mul_f32 v150, s74, v150
    v_mfma_f32_16x16x32_bf16 v[220:223], v[44:47], a[124:127], v[220:223]
    s_add_u32 s72, s70, 0
    v_mul_f32 v151, s74, v151
    v_mul_f32 v180, s74, v180
    s_waitcnt lgkmcnt(0)
    v_mfma_f32_16x16x32_bf16 v[224:227], v[48:51], a[64:67], v[224:227]
    buffer_store_dwordx4 v[128:131], v1, s[36:39], s72 offen sc1
    v_mfma_f32_16x16x32_bf16 v[224:227], v[52:55], a[68:71], v[224:227]
    s_xor_b32 s63, s63, 384
    v_mul_f32 v181, s74, v181
    v_mul_f32 v182, s74, v182
    v_mfma_f32_16x16x32_bf16 v[228:231], v[48:51], a[72:75], v[228:231]
    v_mul_f32 v183, s74, v183
    v_cvt_pk_bf16_f32 v148, v148, v149
    v_mfma_f32_16x16x32_bf16 v[228:231], v[52:55], a[76:79], v[228:231]
    v_cvt_pk_bf16_f32 v149, v150, v151
    v_cvt_pk_bf16_f32 v150, v180, v181
    v_mfma_f32_16x16x32_bf16 v[232:235], v[48:51], a[80:83], v[232:235]
    v_cvt_pk_bf16_f32 v151, v182, v183
    v_mul_f32 v152, s74, v152
    v_mfma_f32_16x16x32_bf16 v[232:235], v[52:55], a[84:87], v[232:235]
    s_add_u32 m0, s67, 98304
    v_mul_f32 v153, s74, v153
    v_mul_f32 v154, s74, v154
    s_waitcnt vmcnt(9) lgkmcnt(0)
    v_cmp_gt_u32 vcc, 8, v7
    s_nop 1
    s_and_b64 vcc, vcc, s[86:87]
    s_cbranch_scc1 SPIN_WA
BACK_WA:
    s_barrier
    v_mfma_f32_16x16x32_bf16 v[236:239], v[48:51], a[88:91], v[236:239]
    buffer_load_dwordx4 v1, s[28:31], s65 offen sc1 lds
    v_mfma_f32_16x16x32_bf16 v[236:239], v[52:55], a[92:95], v[236:239]
    ds_read_b64_tr_b16 v[56:57], v14 offset:0
    ds_read_b64_tr_b16 v[58:59], v14 offset:1024
    v_mfma_f32_16x16x32_bf16 v[240:243], v[48:51], a[96:99], v[240:243]
    ds_read_b64_tr_b16 v[60:61], v14 offset:8192
    ds_read_b64_tr_b16 v[62:63], v14 offset:9216
    v_mfma_f32_16x16x32_bf16 v[240:243], v[52:55], a[100:103], v[240:243]
    ds_read_b64_tr_b16 v[40:41], v15 offset:0
    ds_read_b64_tr_b16 v[42:43], v15 offset:1024
    v_mfma_f32_16x16x32_bf16 v[244:247], v[48:51], a[104:107], v[244:247]
    ds_read_b64_tr_b16 v[44:45], v15 offset:8192
    ds_read_b64_tr_b16 v[46:47], v15 offset:9216
    v_mfma_f32_16x16x32_bf16 v[244:247], v[52:55], a[108:111], v[244:247]
    v_mul_f32 v155, s74, v155
    v_mul_f32 v184, s74, v184
    v_mfma_f32_16x16x32_bf16 v[248:251], v[48:51], a[112:115], v[248:251]
    v_mul_f32 v185, s74, v185
    v_mul_f32 v186, s74, v186
    v_mfma_f32_16x16x32_bf16 v[248:251], v[52:55], a[116:119], v[248:251]
    v_mul_f32 v187, s74, v187
    v_cvt_pk_bf16_f32 v152, v152, v153
    v_mfma_f32_16x16x32_bf16 v[252:255], v[48:51], a[120:123], v[252:255]
    s_lshr_b32 s92, s2, 3
    v_lshrrev_b32 v9, 4, v1
    v_min_u32 v9, 0, v9
    v_mfma_f32_16x16x32_bf16 v[252:255], v[52:55], a[124:127], v[252:255]
    s_lshl2_add_u32 s92, s92, s4
    ds_read_b64_tr_b16 v[48:49], v16 offset:0
    ds_read_b64_tr_b16 v[50:51], v16 offset:1024
    s_waitcnt lgkmcnt(2)
    v_mfma_f32_16x16x32_bf16 a[128:131], a[0:3], v[56:59], a[128:131]
    s_mul_i32 s92, s92, 1
    buffer_load_dwordx4 v1, s[28:31], s65 offen offset:1024 sc1 lds
    v_mfma_f32_16x16x32_bf16 a[128:131], a[4:7], v[60:63], a[128:131]
    s_add_u32 s92, s92, 32
    v_add_lshl_u32 v9, v9, s92, 7
    ds_read_b64_tr_b16 v[52:53], v16 offset:8192
    v_mfma_f32_16x16x32_bf16 a[132:135], a[8:11], v[56:59], a[132:135]
    s_getpc_b64 s[92:93]
    global_load_dword v9, v9, s[92:93]
    v_mfma_f32_16x16x32_bf16 a[132:135], a[12:15], v[60:63], a[132:135]
    ds_read_b128 v[64:67], v24 offset:16384
    ds_read_b64_tr_b16 v[54:55], v16 offset:9216
    v_mfma_f32_16x16x32_bf16 a[136:139], a[16:19], v[56:59], a[136:139]
    v_cvt_pk_bf16_f32 v153, v154, v155
    v_cvt_pk_bf16_f32 v154, v184, v185
    v_mfma_f32_16x16x32_bf16 a[136:139], a[20:23], v[60:63], a[136:139]
    v_cvt_pk_bf16_f32 v155, v186, v187
    v_mul_f32 v156, s74, v156
    v_mfma_f32_16x16x32_bf16 a[140:143], a[24:27], v[56:59], a[140:143]
    v_mul_f32 v157, s74, v157
    v_mul_f32 v158, s74, v158
    v_mfma_f32_16x16x32_bf16 a[140:143], a[28:31], v[60:63], a[140:143]
    s_add_u32 s72, s70, 4096
    v_mul_f32 v159, s74, v159
    v_mul_f32 v188, s74, v188
    v_mfma_f32_16x16x32_bf16 a[144:147], a[32:35], v[56:59], a[144:147]
    buffer_store_dwordx4 v[132:135], v1, s[36:39], s72 offen sc1
    v_mfma_f32_16x16x32_bf16 a[144:147], a[36:39], v[60:63], a[144:147]
    s_add_u32 m0, s69, 114688
    v_mul_f32 v189, s74, v189
    v_mul_f32 v190, s74, v190
    v_mfma_f32_16x16x32_bf16 a[148:151], a[40:43], v[56:59], a[148:151]
    s_xor_b32 s65, s65, 8192
    buffer_load_dwordx4 v10, s[20:23], s64 offen lds
    v_mfma_f32_16x16x32_bf16 a[148:151], a[44:47], v[60:63], a[148:151]
    v_mul_f32 v191, s74, v191
    v_cvt_pk_bf16_f32 v156, v156, v157
    v_mfma_f32_16x16x32_bf16 a[152:155], a[48:51], v[56:59], a[152:155]
    v_cvt_pk_bf16_f32 v157, v158, v159
    v_cvt_pk_bf16_f32 v158, v188, v189
    v_mfma_f32_16x16x32_bf16 a[152:155], a[52:55], v[60:63], a[152:155]
    ds_read_b128 v[68:71], v25 offset:16384
    v_cvt_pk_bf16_f32 v159, v190, v191
    v_mfma_f32_16x16x32_bf16 a[156:159], a[56:59], v[56:59], a[156:159]
    ds_read_b64_tr_b16 v[56:57], v17 offset:0
    ds_read_b64_tr_b16 v[58:59], v17 offset:1024
    v_mfma_f32_16x16x32_bf16 a[156:159], a[60:63], v[60:63], a[156:159]
    ds_read_b64_tr_b16 v[60:61], v17 offset:8192
    ds_read_b64_tr_b16 v[62:63], v17 offset:9216
    v_mfma_f32_16x16x32_bf16 a[160:163], a[0:3], v[40:43], a[160:163]
    v_mul_f32 v192, s74, v192
    v_mul_f32 v193, s74, v193
    v_mfma_f32_16x16x32_bf16 a[160:163], a[4:7], v[44:47], a[160:163]
    v_mul_f32 v194, s74, v194
    v_mul_f32 v195, s74, v195
    v_mfma_f32_16x16x32_bf16 a[164:167], a[8:11], v[40:43], a[164:167]
    v_mul_f32 v224, s74, v224
    v_mul_f32 v225, s74, v225
    v_mfma_f32_16x16x32_bf16 a[164:167], a[12:15], v[44:47], a[164:167]
    v_mul_f32 v226, s74, v226
    v_mul_f32 v227, s74, v227
    v_mfma_f32_16x16x32_bf16 a[168:171], a[16:19], v[40:43], a[168:171]
    buffer_load_dwordx4 v11, s[20:23], s64 offen offset:1024 lds
    v_mfma_f32_16x16x32_bf16 a[168:171], a[20:23], v[44:47], a[168:171]
    v_cvt_pk_bf16_f32 v192, v192, v193
    v_cvt_pk_bf16_f32 v193, v194, v195
    v_mfma_f32_16x16x32_bf16 a[172:175], a[24:27], v[40:43], a[172:175]
    v_cvt_pk_bf16_f32 v194, v224, v225
    v_cvt_pk_bf16_f32 v195, v226, v227
    v_mfma_f32_16x16x32_bf16 a[172:175], a[28:31], v[44:47], a[172:175]
    v_mul_f32 v196, s74, v196
    v_mul_f32 v197, s74, v197
    v_mfma_f32_16x16x32_bf16 a[176:179], a[32:35], v[40:43], a[176:179]
    ds_read_b128 v[72:75], v24 offset:24576
    v_mul_f32 v198, s74, v198
    v_mfma_f32_16x16x32_bf16 a[176:179], a[36:39], v[44:47], a[176:179]
    v_mul_f32 v199, s74, v199
    v_mul_f32 v228, s74, v228
    v_mfma_f32_16x16x32_bf16 a[180:183], a[40:43], v[40:43], a[180:183]
    v_mul_f32 v229, s74, v229
    v_mul_f32 v230, s74, v230
    v_mfma_f32_16x16x32_bf16 a[180:183], a[44:47], v[44:47], a[180:183]
    v_mul_f32 v231, s74, v231
    v_cvt_pk_bf16_f32 v196, v196, v197
    v_mfma_f32_16x16x32_bf16 a[184:187], a[48:51], v[40:43], a[184:187]
    v_cvt_pk_bf16_f32 v197, v198, v199
    v_cvt_pk_bf16_f32 v198, v228, v229
    v_mfma_f32_16x16x32_bf16 a[184:187], a[52:55], v[44:47], a[184:187]
    v_cvt_pk_bf16_f32 v199, v230, v231
    v_mul_f32 v200, s74, v200
    v_mfma_f32_16x16x32_bf16 a[188:191], a[56:59], v[40:43], a[188:191]
    buffer_load_dwordx4 v12, s[20:23], s64 offen offset:2048 lds
    v_mfma_f32_16x16x32_bf16 a[188:191], a[60:63], v[44:47], a[188:191]
    s_add_u32 s72, s70, 8192
    ds_read_b64_tr_b16 v[40:41], v14 offset:32768
    ds_read_b64_tr_b16 v[42:43], v14 offset:33792
    s_waitcnt lgkmcnt(2)
    v_mfma_f32_16x16x32_bf16 a[192:195], a[0:3], v[48:51], a[192:195]
    ds_read_b64_tr_b16 v[44:45], v14 offset:40960
    ds_read_b64_tr_b16 v[46:47], v14 offset:41984
    v_mfma_f32_16x16x32_bf16 a[192:195], a[4:7], v[52:55], a[192:195]
    v_xor_b32 v14, s73, v14
    v_add_u32 v14, 0x10000, v14
    v_mfma_f32_16x16x32_bf16 a[196:199], a[8:11], v[48:51], a[196:199]
    buffer_store_dwordx4 v[136:139], v1, s[36:39], s72 offen sc1
    v_mfma_f32_16x16x32_bf16 a[196:199], a[12:15], v[52:55], a[196:199]
    ds_read_b128 v[76:79], v25 offset:24576
    v_mul_f32 v201, s74, v201
    v_mfma_f32_16x16x32_bf16 a[200:203], a[16:19], v[48:51], a[200:203]
    v_mul_f32 v202, s74, v202
    v_mul_f32 v203, s74, v203
    v_mfma_f32_16x16x32_bf16 a[200:203], a[20:23], v[52:55], a[200:203]
    v_mul_f32 v232, s74, v232
    v_mul_f32 v233, s74, v233
    v_mfma_f32_16x16x32_bf16 a[204:207], a[24:27], v[48:51], a[204:207]
    v_mul_f32 v234, s74, v234
    v_mul_f32 v235, s74, v235
    v_mfma_f32_16x16x32_bf16 a[204:207], a[28:31], v[52:55], a[204:207]
    v_cvt_pk_bf16_f32 v200, v200, v201
    v_cvt_pk_bf16_f32 v201, v202, v203
    v_mfma_f32_16x16x32_bf16 a[208:211], a[32:35], v[48:51], a[208:211]
    buffer_load_dwordx4 v13, s[20:23], s64 offen offset:3072 lds
    v_mfma_f32_16x16x32_bf16 a[208:211], a[36:39], v[52:55], a[208:211]
    v_cvt_pk_bf16_f32 v202, v232, v233
    v_cvt_pk_bf16_f32 v203, v234, v235
    v_mfma_f32_16x16x32_bf16 a[212:215], a[40:43], v[48:51], a[212:215]
    v_mul_f32 v204, s74, v204
    v_mul_f32 v205, s74, v205
    v_mfma_f32_16x16x32_bf16 a[212:215], a[44:47], v[52:55], a[212:215]
    v_mul_f32 v206, s74, v206
    v_mul_f32 v207, s74, v207
    v_mfma_f32_16x16x32_bf16 a[216:219], a[48:51], v[48:51], a[216:219]
    v_mul_f32 v236, s74, v236
    v_mul_f32 v237, s74, v237
    v_mfma_f32_16x16x32_bf16 a[216:219], a[52:55], v[52:55], a[216:219]
    v_mul_f32 v238, s74, v238
    v_mul_f32 v239, s74, v239
    v_mfma_f32_16x16x32_bf16 a[220:223], a[56:59], v[48:51], a[220:223]
    ds_read_b64_tr_b16 v[48:49], v15 offset:32768
    ds_read_b64_tr_b16 v[50:51], v15 offset:33792
    v_mfma_f32_16x16x32_bf16 a[220:223], a[60:63], v[52:55], a[220:223]
    ds_read_b64_tr_b16 v[52:53], v15 offset:40960
    ds_read_b64_tr_b16 v[54:55], v15 offset:41984
    v_mfma_f32_16x16x32_bf16 a[224:227], a[0:3], v[56:59], a[224:227]
    v_xor_b32 v15, s73, v15
    v_add_u32 v15, 0x10000, v15
    v_mfma_f32_16x16x32_bf16 a[224:227], a[4:7], v[60:63], a[224:227]
    s_xor_b32 s64, s64, 384
    v_accvgpr_write_b32 a4, v192
    v_accvgpr_write_b32 a5, v193
    v_mfma_f32_16x16x32_bf16 a[228:231], a[8:11], v[56:59], a[228:231]
    v_accvgpr_write_b32 a6, v194
    v_accvgpr_write_b32 a7, v195
    v_mfma_f32_16x16x32_bf16 a[228:231], a[12:15], v[60:63], a[228:231]
    v_accvgpr_write_b32 a12, v196
    v_accvgpr_write_b32 a13, v197
    v_mfma_f32_16x16x32_bf16 a[232:235], a[16:19], v[56:59], a[232:235]
    v_accvgpr_write_b32 a14, v198
    v_accvgpr_write_b32 a15, v199
    v_mfma_f32_16x16x32_bf16 a[232:235], a[20:23], v[60:63], a[232:235]
    s_add_u32 m0, s69, 131072
    v_accvgpr_write_b32 a20, v200
    v_accvgpr_write_b32 a21, v201
    v_mfma_f32_16x16x32_bf16 a[236:239], a[24:27], v[56:59], a[236:239]
    buffer_load_dwordx4 v2, s[24:27], s60 offen lds
    v_mfma_f32_16x16x32_bf16 a[236:239], a[28:31], v[60:63], a[236:239]
    s_add_u32 s72, s70, 12288
    v_accvgpr_write_b32 a22, v202
    v_accvgpr_write_b32 a23, v203
    v_mfma_f32_16x16x32_bf16 a[240:243], a[32:35], v[56:59], a[240:243]
    buffer_store_dwordx4 v[140:143], v1, s[36:39], s72 offen sc1
    v_mfma_f32_16x16x32_bf16 a[240:243], a[36:39], v[60:63], a[240:243]
    v_cvt_pk_bf16_f32 v204, v204, v205
    v_cvt_pk_bf16_f32 v205, v206, v207
    v_mfma_f32_16x16x32_bf16 a[244:247], a[40:43], v[56:59], a[244:247]
    v_accvgpr_write_b32 a40, v148
    v_accvgpr_write_b32 a41, v149
    v_mfma_f32_16x16x32_bf16 a[244:247], a[44:47], v[60:63], a[244:247]
    v_accvgpr_write_b32 a42, v150
    v_accvgpr_write_b32 a43, v151
    v_mfma_f32_16x16x32_bf16 a[248:251], a[48:51], v[56:59], a[248:251]
    v_accvgpr_write_b32 a48, v152
    v_accvgpr_write_b32 a49, v153
    v_mfma_f32_16x16x32_bf16 a[248:251], a[52:55], v[60:63], a[248:251]
    buffer_load_dwordx4 v3, s[24:27], s60 offen offset:1024 lds
    v_mfma_f32_16x16x32_bf16 a[252:255], a[56:59], v[56:59], a[252:255]
    ds_read_b64_tr_b16 v[56:57], v16 offset:32768
    ds_read_b64_tr_b16 v[58:59], v16 offset:33792
    v_mfma_f32_16x16x32_bf16 a[252:255], a[60:63], v[60:63], a[252:255]
    s_waitcnt lgkmcnt(2)
    ds_read_b64_tr_b16 v[60:61], v16 offset:40960
    ds_read_b64_tr_b16 v[62:63], v16 offset:41984
    v_mfma_f32_16x16x32_bf16 a[128:131], a[64:67], v[40:43], a[128:131]
    v_xor_b32 v16, s73, v16
    v_add_u32 v16, 0x10000, v16
    v_mfma_f32_16x16x32_bf16 a[128:131], a[68:71], v[44:47], a[128:131]
    v_accvgpr_write_b32 a50, v154
    v_accvgpr_write_b32 a51, v155
    v_mfma_f32_16x16x32_bf16 a[132:135], a[72:75], v[40:43], a[132:135]
    ds_read_b128 v[80:83], v24 offset:49152
    v_accvgpr_write_b32 a56, v156
    v_mfma_f32_16x16x32_bf16 a[132:135], a[76:79], v[44:47], a[132:135]
    v_accvgpr_write_b32 a57, v157
    v_accvgpr_write_b32 a58, v158
    v_mfma_f32_16x16x32_bf16 a[136:139], a[80:83], v[40:43], a[136:139]
    v_accvgpr_write_b32 a59, v159
    v_cvt_pk_bf16_f32 v206, v236, v237
    v_mfma_f32_16x16x32_bf16 a[136:139], a[84:87], v[44:47], a[136:139]
    buffer_load_dwordx4 v4, s[24:27], s60 offen offset:2048 lds
    v_mfma_f32_16x16x32_bf16 a[140:143], a[88:91], v[40:43], a[140:143]
    v_cvt_pk_bf16_f32 v207, v238, v239
    v_mul_f32 v208, s74, v208
    v_mfma_f32_16x16x32_bf16 a[140:143], a[92:95], v[44:47], a[140:143]
    v_mul_f32 v209, s74, v209
    v_mul_f32 v210, s74, v210
    v_mfma_f32_16x16x32_bf16 a[144:147], a[96:99], v[40:43], a[144:147]
    v_mul_f32 v211, s74, v211
    v_mul_f32 v240, s74, v240
    v_mfma_f32_16x16x32_bf16 a[144:147], a[100:103], v[44:47], a[144:147]
    v_mul_f32 v241, s74, v241
    v_mul_f32 v242, s74, v242
    v_mfma_f32_16x16x32_bf16 a[148:151], a[104:107], v[40:43], a[148:151]
    v_mul_f32 v243, s74, v243
    v_accvgpr_write_b32 a28, v204
    v_mfma_f32_16x16x32_bf16 a[148:151], a[108:111], v[44:47], a[148:151]
    v_accvgpr_write_b32 a29, v205
    v_accvgpr_write_b32 a30, v206
    v_mfma_f32_16x16x32_bf16 a[152:155], a[112:115], v[40:43], a[152:155]
    buffer_load_dwordx4 v5, s[24:27], s60 offen offset:3072 lds
    v_mfma_f32_16x16x32_bf16 a[152:155], a[116:119], v[44:47], a[152:155]
    ds_read_b128 v[84:87], v25 offset:49152
    v_accvgpr_write_b32 a31, v207
    v_mfma_f32_16x16x32_bf16 a[156:159], a[120:123], v[40:43], a[156:159]
    ds_read_b64_tr_b16 v[40:41], v17 offset:32768
    ds_read_b64_tr_b16 v[42:43], v17 offset:33792
    v_mfma_f32_16x16x32_bf16 a[156:159], a[124:127], v[44:47], a[156:159]
    s_add_u32 s72, s70, 32768
    ds_read_b64_tr_b16 v[44:45], v17 offset:40960
    ds_read_b64_tr_b16 v[46:47], v17 offset:41984
    v_mfma_f32_16x16x32_bf16 a[160:163], a[64:67], v[48:51], a[160:163]
    v_xor_b32 v17, s73, v17
    v_add_u32 v17, 0x10000, v17
    v_mfma_f32_16x16x32_bf16 a[160:163], a[68:71], v[52:55], a[160:163]
    buffer_store_dwordx4 v[144:147], v1, s[36:39], s72 offen sc1
    v_mfma_f32_16x16x32_bf16 a[164:167], a[72:75], v[48:51], a[164:167]
    v_cvt_pk_bf16_f32 v208, v208, v209
    v_cvt_pk_bf16_f32 v209, v210, v211
    v_mfma_f32_16x16x32_bf16 a[164:167], a[76:79], v[52:55], a[164:167]
    s_add_u32 m0, s69, 147456
    v_cvt_pk_bf16_f32 v210, v240, v241
    v_cvt_pk_bf16_f32 v211, v242, v243
    v_mfma_f32_16x16x32_bf16 a[168:171], a[80:83], v[48:51], a[168:171]
    s_xor_b32 s60, s60, 1572864
    buffer_load_dwordx4 v10, s[20:23], s63 offen lds
    v_mfma_f32_16x16x32_bf16 a[168:171], a[84:87], v[52:55], a[168:171]
    v_mul_f32 v212, s74, v212
    v_mul_f32 v213, s74, v213
    v_mfma_f32_16x16x32_bf16 a[172:175], a[88:91], v[48:51], a[172:175]
    v_mul_f32 v214, s74, v214
    v_mul_f32 v215, s74, v215
    v_mfma_f32_16x16x32_bf16 a[172:175], a[92:95], v[52:55], a[172:175]
    v_mul_f32 v244, s74, v244
    v_mul_f32 v245, s74, v245
    v_mfma_f32_16x16x32_bf16 a[176:179], a[96:99], v[48:51], a[176:179]
    ds_read_b128 v[88:91], v24 offset:57344
    v_mul_f32 v246, s74, v246
    v_mfma_f32_16x16x32_bf16 a[176:179], a[100:103], v[52:55], a[176:179]
    v_mul_f32 v247, s74, v247
    v_accvgpr_write_b32 a36, v208
    v_mfma_f32_16x16x32_bf16 a[180:183], a[104:107], v[48:51], a[180:183]
    v_accvgpr_write_b32 a37, v209
    v_accvgpr_write_b32 a38, v210
    v_mfma_f32_16x16x32_bf16 a[180:183], a[108:111], v[52:55], a[180:183]
    buffer_load_dwordx4 v11, s[20:23], s63 offen offset:1024 lds
    v_mfma_f32_16x16x32_bf16 a[184:187], a[112:115], v[48:51], a[184:187]
    v_accvgpr_write_b32 a39, v211
    v_cvt_pk_bf16_f32 v212, v212, v213
    v_mfma_f32_16x16x32_bf16 a[184:187], a[116:119], v[52:55], a[184:187]
    v_cvt_pk_bf16_f32 v213, v214, v215
    v_cvt_pk_bf16_f32 v214, v244, v245
    v_mfma_f32_16x16x32_bf16 a[188:191], a[120:123], v[48:51], a[188:191]
    v_cvt_pk_bf16_f32 v215, v246, v247
    v_mul_f32 v216, s74, v216
    v_mfma_f32_16x16x32_bf16 a[188:191], a[124:127], v[52:55], a[188:191]
    s_waitcnt lgkmcnt(0)
    v_mul_f32 v217, s74, v217
    v_mul_f32 v218, s74, v218
    v_mfma_f32_16x16x32_bf16 a[192:195], a[64:67], v[56:59], a[192:195]
    v_mul_f32 v219, s74, v219
    v_mul_f32 v248, s74, v248
    v_mfma_f32_16x16x32_bf16 a[192:195], a[68:71], v[60:63], a[192:195]
    v_mul_f32 v249, s74, v249
    v_mul_f32 v250, s74, v250
    v_mfma_f32_16x16x32_bf16 a[196:199], a[72:75], v[56:59], a[196:199]
    v_mul_f32 v251, s74, v251
    v_accvgpr_write_b32 a44, v212
    v_mfma_f32_16x16x32_bf16 a[196:199], a[76:79], v[60:63], a[196:199]
    buffer_load_dwordx4 v12, s[20:23], s63 offen offset:2048 lds
    v_mfma_f32_16x16x32_bf16 a[200:203], a[80:83], v[56:59], a[200:203]
    ds_read_b128 v[92:95], v25 offset:57344
    v_accvgpr_write_b32 a45, v213
    v_mfma_f32_16x16x32_bf16 a[200:203], a[84:87], v[60:63], a[200:203]
    v_accvgpr_write_b32 a46, v214
    v_accvgpr_write_b32 a47, v215
    v_mfma_f32_16x16x32_bf16 a[204:207], a[88:91], v[56:59], a[204:207]
    v_cvt_pk_bf16_f32 v216, v216, v217
    v_cvt_pk_bf16_f32 v217, v218, v219
    v_mfma_f32_16x16x32_bf16 a[204:207], a[92:95], v[60:63], a[204:207]
    s_add_u32 s72, s70, 36864
    v_cvt_pk_bf16_f32 v218, v248, v249
    v_cvt_pk_bf16_f32 v219, v250, v251
    v_mfma_f32_16x16x32_bf16 a[208:211], a[96:99], v[56:59], a[208:211]
    buffer_store_dwordx4 a[40:43], v1, s[36:39], s72 offen sc1
    v_mfma_f32_16x16x32_bf16 a[208:211], a[100:103], v[60:63], a[208:211]
    v_mul_f32 v220, s74, v220
    v_mul_f32 v221, s74, v221
    v_mfma_f32_16x16x32_bf16 a[212:215], a[104:107], v[56:59], a[212:215]
    buffer_load_dwordx4 v13, s[20:23], s63 offen offset:3072 lds
    v_mfma_f32_16x16x32_bf16 a[212:215], a[108:111], v[60:63], a[212:215]
    v_mul_f32 v222, s74, v222
    v_mul_f32 v223, s74, v223
    v_mfma_f32_16x16x32_bf16 a[216:219], a[112:115], v[56:59], a[216:219]
    v_mul_f32 v252, s74, v252
    v_mul_f32 v253, s74, v253
    v_mfma_f32_16x16x32_bf16 a[216:219], a[116:119], v[60:63], a[216:219]
    v_mul_f32 v254, s74, v254
    v_mul_f32 v255, s74, v255
    v_mfma_f32_16x16x32_bf16 a[220:223], a[120:123], v[56:59], a[220:223]
    v_accvgpr_write_b32 a52, v216
    v_accvgpr_write_b32 a53, v217
    v_mfma_f32_16x16x32_bf16 a[220:223], a[124:127], v[60:63], a[220:223]
    v_accvgpr_write_b32 a54, v218
    v_accvgpr_write_b32 a55, v219
    v_mfma_f32_16x16x32_bf16 a[224:227], a[64:67], v[40:43], a[224:227]
    v_cvt_pk_bf16_f32 v220, v220, v221
    v_cvt_pk_bf16_f32 v221, v222, v223
    v_mfma_f32_16x16x32_bf16 a[224:227], a[68:71], v[44:47], a[224:227]
    s_xor_b32 s63, s63, 128
    v_cvt_pk_bf16_f32 v222, v252, v253
    v_cvt_pk_bf16_f32 v223, v254, v255
    v_mfma_f32_16x16x32_bf16 a[228:231], a[72:75], v[40:43], a[228:231]
    v_accvgpr_write_b32 a60, v220
    v_accvgpr_write_b32 a61, v221
    v_mfma_f32_16x16x32_bf16 a[228:231], a[76:79], v[44:47], a[228:231]
    v_accvgpr_write_b32 a62, v222
    v_accvgpr_write_b32 a63, v223
    v_mfma_f32_16x16x32_bf16 a[232:235], a[80:83], v[40:43], a[232:235]
    v_accvgpr_write_b32 a0, 0
    v_accvgpr_write_b32 a1, 0
    v_mfma_f32_16x16x32_bf16 a[232:235], a[84:87], v[44:47], a[232:235]
    s_waitcnt vmcnt(11) lgkmcnt(0)
    s_barrier
    ds_read_b64_tr_b16 v[48:49], v14 offset:0
    v_mfma_f32_16x16x32_bf16 a[236:239], a[88:91], v[40:43], a[236:239]
    s_add_u32 m0, s67, 0
    ds_read_b64_tr_b16 v[50:51], v14 offset:1024
    ds_read_b64_tr_b16 v[52:53], v14 offset:8192
    v_mfma_f32_16x16x32_bf16 a[236:239], a[92:95], v[44:47], a[236:239]
    buffer_load_dwordx4 v1, s[28:31], s65 offen sc1 lds
    v_mfma_f32_16x16x32_bf16 a[240:243], a[96:99], v[40:43], a[240:243]
    ds_read_b64_tr_b16 v[54:55], v14 offset:9216
    ds_read_b64_tr_b16 v[56:57], v15 offset:0
    v_mfma_f32_16x16x32_bf16 a[240:243], a[100:103], v[44:47], a[240:243]
    ds_read_b64_tr_b16 v[58:59], v15 offset:1024
    ds_read_b64_tr_b16 v[60:61], v15 offset:8192
    v_mfma_f32_16x16x32_bf16 a[244:247], a[104:107], v[40:43], a[244:247]
    ds_read_b64_tr_b16 v[62:63], v15 offset:9216
    v_add_u32 v14, 0x10000, v14
    v_mfma_f32_16x16x32_bf16 a[244:247], a[108:111], v[44:47], a[244:247]
    v_add_u32 v15, 0x10000, v15
    v_accvgpr_write_b32 a2, 0
    v_mfma_f32_16x16x32_bf16 a[248:251], a[112:115], v[40:43], a[248:251]
    v_accvgpr_write_b32 a3, 0
    v_accvgpr_write_b32 a8, 0
    v_mfma_f32_16x16x32_bf16 a[248:251], a[116:119], v[44:47], a[248:251]
    v_accvgpr_write_b32 a9, 0
    v_accvgpr_write_b32 a10, 0
    v_mfma_f32_16x16x32_bf16 a[252:255], a[120:123], v[40:43], a[252:255]
    ds_read_b64_tr_b16 v[40:41], v16 offset:0
    ds_read_b64_tr_b16 v[42:43], v16 offset:1024
    v_mfma_f32_16x16x32_bf16 a[252:255], a[124:127], v[44:47], a[252:255]
    s_add_u32 s72, s70, 40960
    ds_read_b64_tr_b16 v[44:45], v16 offset:8192
    ds_read_b64_tr_b16 v[46:47], v16 offset:9216
    s_waitcnt lgkmcnt(4)
    v_mfma_f32_16x16x32_bf16 v[128:131], v[48:51], v[64:67], 0
    buffer_load_dwordx4 v1, s[28:31], s65 offen offset:1024 sc1 lds
    v_mfma_f32_16x16x32_bf16 v[128:131], v[52:55], v[68:71], v[128:131]
    v_add_u32 v24, 0x10000, v24
    v_add_u32 v16, 0x10000, v16
    v_mfma_f32_16x16x32_bf16 v[132:135], v[48:51], v[72:75], 0
    ds_read_b128 v[96:99], v24 offset:16384
    v_accvgpr_write_b32 a11, 0
    v_mfma_f32_16x16x32_bf16 v[132:135], v[52:55], v[76:79], v[132:135]
    buffer_store_dwordx4 a[48:51], v1, s[36:39], s72 offen sc1
    v_mfma_f32_16x16x32_bf16 v[136:139], v[48:51], v[80:83], 0
    v_accvgpr_write_b32 a16, 0
    v_accvgpr_write_b32 a17, 0
    v_mfma_f32_16x16x32_bf16 v[136:139], v[52:55], v[84:87], v[136:139]
    v_accvgpr_write_b32 a18, 0
    v_accvgpr_write_b32 a19, 0
    v_mfma_f32_16x16x32_bf16 v[140:143], v[48:51], v[88:91], 0
    ds_read_b64_tr_b16 v[48:49], v17 offset:0
    ds_read_b64_tr_b16 v[50:51], v17 offset:1024
    v_mfma_f32_16x16x32_bf16 v[140:143], v[52:55], v[92:95], v[140:143]
    ds_read_b64_tr_b16 v[52:53], v17 offset:8192
    ds_read_b64_tr_b16 v[54:55], v17 offset:9216
    v_mfma_f32_16x16x32_bf16 v[144:147], v[56:59], v[64:67], 0
    v_add_u32 v17, 0x10000, v17
    v_accvgpr_write_b32 a24, 0
    v_mfma_f32_16x16x32_bf16 v[144:147], v[60:63], v[68:71], v[144:147]
    s_add_u32 m0, s69, 16384
    v_accvgpr_write_b32 a25, 0
    v_accvgpr_write_b32 a26, 0
    v_mfma_f32_16x16x32_bf16 v[148:151], v[56:59], v[72:75], 0
    s_xor_b32 s65, s65, 24576
    buffer_load_dwordx4 v10, s[20:23], s64 offen lds
    v_mfma_f32_16x16x32_bf16 v[148:151], v[60:63], v[76:79], v[148:151]
    v_accvgpr_write_b32 a27, 0
    v_accvgpr_write_b32 a32, 0
    v_mfma_f32_16x16x32_bf16 v[152:155], v[56:59], v[80:83], 0
    v_add_u32 v25, 0x10000, v25
    v_accvgpr_write_b32 a33, 0
    v_mfma_f32_16x16x32_bf16 v[152:155], v[60:63], v[84:87], v[152:155]
    ds_read_b128 v[100:103], v25 offset:16384
    v_accvgpr_write_b32 a34, 0
    v_mfma_f32_16x16x32_bf16 v[156:159], v[56:59], v[88:91], 0
    ds_read_b64_tr_b16 v[56:57], v18 offset:0
    ds_read_b64_tr_b16 v[58:59], v18 offset:1024
    v_mfma_f32_16x16x32_bf16 v[156:159], v[60:63], v[92:95], v[156:159]
    s_waitcnt lgkmcnt(3)
    ds_read_b64_tr_b16 v[60:61], v18 offset:8192
    ds_read_b64_tr_b16 v[62:63], v18 offset:9216
    v_mfma_f32_16x16x32_bf16 v[160:163], v[40:43], v[64:67], 0
    v_add_u32 v18, 0x10000, v18
    v_accvgpr_write_b32 a35, 0
    v_mfma_f32_16x16x32_bf16 v[160:163], v[44:47], v[68:71], v[160:163]
    v_accvgpr_write_b32 a40, 0
    v_accvgpr_write_b32 a41, 0
    v_mfma_f32_16x16x32_bf16 v[164:167], v[40:43], v[72:75], 0
    v_accvgpr_write_b32 a42, 0
    v_accvgpr_write_b32 a43, 0
    v_mfma_f32_16x16x32_bf16 v[164:167], v[44:47], v[76:79], v[164:167]
    v_accvgpr_write_b32 a48, 0
    v_accvgpr_write_b32 a49, 0
    v_mfma_f32_16x16x32_bf16 v[168:171], v[40:43], v[80:83], 0
    buffer_load_dwordx4 v11, s[20:23], s64 offen offset:1024 lds
    v_mfma_f32_16x16x32_bf16 v[168:171], v[44:47], v[84:87], v[168:171]
    v_accvgpr_write_b32 a50, 0
    v_accvgpr_write_b32 a51, 0
    v_mfma_f32_16x16x32_bf16 v[172:175], v[40:43], v[88:91], 0
    ds_read_b64_tr_b16 v[40:41], v19 offset:0
    ds_read_b64_tr_b16 v[42:43], v19 offset:1024
    v_mfma_f32_16x16x32_bf16 v[172:175], v[44:47], v[92:95], v[172:175]
    s_add_u32 s72, s70, 45056
    ds_read_b64_tr_b16 v[44:45], v19 offset:8192
    ds_read_b64_tr_b16 v[46:47], v19 offset:9216
    v_mfma_f32_16x16x32_bf16 v[176:179], v[48:51], v[64:67], 0
    ds_read_b128 v[104:107], v24 offset:24576
    v_add_u32 v19, 0x10000, v19
    v_mfma_f32_16x16x32_bf16 v[176:179], v[52:55], v[68:71], v[176:179]
    buffer_store_dwordx4 a[56:59], v1, s[36:39], s72 offen sc1
    v_mfma_f32_16x16x32_bf16 v[180:183], v[48:51], v[72:75], 0
    v_mfma_f32_16x16x32_bf16 v[180:183], v[52:55], v[76:79], v[180:183]
    v_accvgpr_write_b32 a56, 0
    v_accvgpr_write_b32 a57, 0
    v_mfma_f32_16x16x32_bf16 v[184:187], v[48:51], v[80:83], 0
    v_accvgpr_write_b32 a58, 0
    v_accvgpr_write_b32 a59, 0
    v_mfma_f32_16x16x32_bf16 v[184:187], v[52:55], v[84:87], v[184:187]
    v_mfma_f32_16x16x32_bf16 v[188:191], v[48:51], v[88:91], 0
    buffer_load_dwordx4 v12, s[20:23], s64 offen offset:2048 lds
    v_mfma_f32_16x16x32_bf16 v[188:191], v[52:55], v[92:95], v[188:191]
    s_waitcnt lgkmcnt(0)
    ds_read_b64_tr_b16 v[48:49], v20 offset:0
    ds_read_b64_tr_b16 v[50:51], v20 offset:1024
    v_mfma_f32_16x16x32_bf16 v[192:195], v[56:59], v[64:67], 0
    ds_read_b64_tr_b16 v[52:53], v20 offset:8192
    ds_read_b64_tr_b16 v[54:55], v20 offset:9216
    v_mfma_f32_16x16x32_bf16 v[192:195], v[60:63], v[68:71], v[192:195]
    v_add_u32 v20, 0x10000, v20
    v_mfma_f32_16x16x32_bf16 v[196:199], v[56:59], v[72:75], 0
    v_mfma_f32_16x16x32_bf16 v[196:199], v[60:63], v[76:79], v[196:199]
    ds_read_b128 v[108:111], v25 offset:24576
    v_mfma_f32_16x16x32_bf16 v[200:203], v[56:59], v[80:83], 0
    v_mfma_f32_16x16x32_bf16 v[200:203], v[60:63], v[84:87], v[200:203]
    v_mfma_f32_16x16x32_bf16 v[204:207], v[56:59], v[88:91], 0
    ds_read_b64_tr_b16 v[56:57], v21 offset:0
    ds_read_b64_tr_b16 v[58:59], v21 offset:1024
    v_mfma_f32_16x16x32_bf16 v[204:207], v[60:63], v[92:95], v[204:207]
    ds_read_b64_tr_b16 v[60:61], v21 offset:8192
    ds_read_b64_tr_b16 v[62:63], v21 offset:9216
    v_mfma_f32_16x16x32_bf16 v[208:211], v[40:43], v[64:67], 0
    buffer_load_dwordx4 v13, s[20:23], s64 offen offset:3072 lds
    v_mfma_f32_16x16x32_bf16 v[208:211], v[44:47], v[68:71], v[208:211]
    v_add_u32 v21, 0x10000, v21
    v_mfma_f32_16x16x32_bf16 v[212:215], v[40:43], v[72:75], 0
    v_mfma_f32_16x16x32_bf16 v[212:215], v[44:47], v[76:79], v[212:215]
    v_mfma_f32_16x16x32_bf16 v[216:219], v[40:43], v[80:83], 0
    v_mfma_f32_16x16x32_bf16 v[216:219], v[44:47], v[84:87], v[216:219]
    v_mfma_f32_16x16x32_bf16 v[220:223], v[40:43], v[88:91], 0
    ds_read_b64_tr_b16 v[40:41], v26 offset:32768
    ds_read_b64_tr_b16 v[42:43], v26 offset:33280
    v_mfma_f32_16x16x32_bf16 v[220:223], v[44:47], v[92:95], v[220:223]
    s_add_u32 s72, s70, 1024
    ds_read_b64_tr_b16 v[44:45], v26 offset:36864
    ds_read_b64_tr_b16 v[46:47], v26 offset:37376
    s_waitcnt lgkmcnt(4)
    v_mfma_f32_16x16x32_bf16 v[224:227], v[48:51], v[64:67], 0
    buffer_store_dwordx4 a[4:7], v1, s[36:39], s72 offen sc1
    v_mfma_f32_16x16x32_bf16 v[224:227], v[52:55], v[68:71], v[224:227]
    s_xor_b32 s64, s64, 128
    v_add_u32 v26, 0xffff0000, v26
    v_accvgpr_write_b32 a4, 0
    v_mfma_f32_16x16x32_bf16 v[228:231], v[48:51], v[72:75], 0
    v_accvgpr_write_b32 a5, 0
    v_accvgpr_write_b32 a6, 0
    v_mfma_f32_16x16x32_bf16 v[228:231], v[52:55], v[76:79], v[228:231]
    v_accvgpr_write_b32 a7, 0
    v_mfma_f32_16x16x32_bf16 v[232:235], v[48:51], v[80:83], 0
    v_mfma_f32_16x16x32_bf16 v[232:235], v[52:55], v[84:87], v[232:235]
    s_add_u32 m0, s69, 32768
    v_mfma_f32_16x16x32_bf16 v[236:239], v[48:51], v[88:91], 0
    buffer_load_dwordx4 v2, s[24:27], s60 offen lds
    v_mfma_f32_16x16x32_bf16 v[236:239], v[52:55], v[92:95], v[236:239]
    ds_read_b64_tr_b16 v[48:49], v27 offset:32768
    ds_read_b64_tr_b16 v[50:51], v27 offset:33280
    v_mfma_f32_16x16x32_bf16 v[240:243], v[56:59], v[64:67], 0
    ds_read_b64_tr_b16 v[52:53], v27 offset:36864
    ds_read_b64_tr_b16 v[54:55], v27 offset:37376
    v_mfma_f32_16x16x32_bf16 v[240:243], v[60:63], v[68:71], v[240:243]
    buffer_load_dwordx4 v3, s[24:27], s60 offen offset:1024 lds
    v_mfma_f32_16x16x32_bf16 v[244:247], v[56:59], v[72:75], 0
    v_add_u32 v27, 0xffff0000, v27
    v_mfma_f32_16x16x32_bf16 v[244:247], v[60:63], v[76:79], v[244:247]
    v_mfma_f32_16x16x32_bf16 v[248:251], v[56:59], v[80:83], 0
    v_mfma_f32_16x16x32_bf16 v[248:251], v[60:63], v[84:87], v[248:251]
    buffer_load_dwordx4 v4, s[24:27], s60 offen offset:2048 lds
    v_mfma_f32_16x16x32_bf16 v[252:255], v[56:59], v[88:91], 0
    ds_read_b64_tr_b16 v[56:57], v28 offset:32768
    ds_read_b64_tr_b16 v[58:59], v28 offset:33280
    v_mfma_f32_16x16x32_bf16 v[252:255], v[60:63], v[92:95], v[252:255]
    s_waitcnt lgkmcnt(2)
    ds_read_b64_tr_b16 v[60:61], v28 offset:36864
    ds_read_b64_tr_b16 v[62:63], v28 offset:37376
    v_mfma_f32_16x16x32_bf16 a[64:67], v[40:43], v[64:67], 0
    buffer_load_dwordx4 v5, s[24:27], s60 offen offset:3072 lds
    v_mfma_f32_16x16x32_bf16 a[64:67], v[44:47], v[68:71], a[64:67]
    v_add_u32 v28, 0xffff0000, v28
    v_mfma_f32_16x16x32_bf16 a[68:71], v[40:43], v[72:75], 0
    ds_read_b128 v[112:115], v24 offset:49152
    v_mfma_f32_16x16x32_bf16 a[68:71], v[44:47], v[76:79], a[68:71]
    s_add_u32 m0, s69, 49152
    v_mfma_f32_16x16x32_bf16 a[72:75], v[40:43], v[80:83], 0
    s_xor_b32 s60, s60, 524288
    buffer_load_dwordx4 v10, s[20:23], s63 offen lds
    v_mfma_f32_16x16x32_bf16 a[72:75], v[44:47], v[84:87], a[72:75]
    ds_read_b128 v[116:119], v25 offset:49152
    v_mfma_f32_16x16x32_bf16 a[76:79], v[40:43], v[88:91], 0
    ds_read_b64_tr_b16 v[40:41], v29 offset:32768
    ds_read_b64_tr_b16 v[42:43], v29 offset:33280
    v_mfma_f32_16x16x32_bf16 a[76:79], v[44:47], v[92:95], a[76:79]
    s_add_u32 s72, s70, 5120
    buffer_load_dwordx4 v11, s[20:23], s63 offen offset:1024 lds
    v_mfma_f32_16x16x32_bf16 a[80:83], v[48:51], v[64:67], 0
    ds_read_b128 v[120:123], v24 offset:57344
    ds_read_b64_tr_b16 v[44:45], v29 offset:36864
    v_mfma_f32_16x16x32_bf16 a[80:83], v[52:55], v[68:71], a[80:83]
    ds_read_b64_tr_b16 v[46:47], v29 offset:37376
    v_add_u32 v29, 0xffff0000, v29
    v_mfma_f32_16x16x32_bf16 a[84:87], v[48:51], v[72:75], 0
    buffer_store_dwordx4 a[12:15], v1, s[36:39], s72 offen sc1
    v_mfma_f32_16x16x32_bf16 a[84:87], v[52:55], v[76:79], a[84:87]
    ds_read_b128 v[124:127], v25 offset:57344
    v_accvgpr_write_b32 a12, 0
    v_mfma_f32_16x16x32_bf16 a[88:91], v[48:51], v[80:83], 0
    v_accvgpr_write_b32 a13, 0
    v_accvgpr_write_b32 a14, 0
    v_mfma_f32_16x16x32_bf16 a[88:91], v[52:55], v[84:87], a[88:91]
    v_accvgpr_write_b32 a15, 0
    v_mfma_f32_16x16x32_bf16 a[92:95], v[48:51], v[88:91], 0
    buffer_load_dwordx4 v12, s[20:23], s63 offen offset:2048 lds
    v_mfma_f32_16x16x32_bf16 a[92:95], v[52:55], v[92:95], a[92:95]
    s_waitcnt lgkmcnt(1)
    v_mfma_f32_16x16x32_bf16 a[96:99], v[56:59], v[64:67], 0
    v_mfma_f32_16x16x32_bf16 a[96:99], v[60:63], v[68:71], a[96:99]
    v_mfma_f32_16x16x32_bf16 a[100:103], v[56:59], v[72:75], 0
    buffer_load_dwordx4 v13, s[20:23], s63 offen offset:3072 lds
    v_mfma_f32_16x16x32_bf16 a[100:103], v[60:63], v[76:79], a[100:103]
    s_xor_b32 s63, s63, 896
    v_mfma_f32_16x16x32_bf16 a[104:107], v[56:59], v[80:83], 0
    v_mfma_f32_16x16x32_bf16 a[104:107], v[60:63], v[84:87], a[104:107]
    s_waitcnt vmcnt(10) lgkmcnt(0)
    s_barrier
    ds_read_b64_tr_b16 v[48:49], v14 offset:0
    v_mfma_f32_16x16x32_bf16 a[108:111], v[56:59], v[88:91], 0
    s_add_u32 m0, s67, 65536
    ds_read_b64_tr_b16 v[50:51], v14 offset:1024
    ds_read_b64_tr_b16 v[52:53], v14 offset:8192
    v_mfma_f32_16x16x32_bf16 a[108:111], v[60:63], v[92:95], a[108:111]
    buffer_load_dwordx4 v1, s[28:31], s65 offen sc1 lds
    v_mfma_f32_16x16x32_bf16 a[112:115], v[40:43], v[64:67], 0
    ds_read_b64_tr_b16 v[54:55], v14 offset:9216
    ds_read_b64_tr_b16 v[56:57], v15 offset:0
    v_mfma_f32_16x16x32_bf16 a[112:115], v[44:47], v[68:71], a[112:115]
    ds_read_b64_tr_b16 v[58:59], v15 offset:1024
    ds_read_b64_tr_b16 v[60:61], v15 offset:8192
    v_mfma_f32_16x16x32_bf16 a[116:119], v[40:43], v[72:75], 0
    ds_read_b64_tr_b16 v[62:63], v15 offset:9216
    v_add_u32 v14, 0xfffe0000, v14
    v_mfma_f32_16x16x32_bf16 a[116:119], v[44:47], v[76:79], a[116:119]
    v_add_u32 v15, 0xfffe0000, v15
    v_mfma_f32_16x16x32_bf16 a[120:123], v[40:43], v[80:83], 0
    v_mfma_f32_16x16x32_bf16 a[120:123], v[44:47], v[84:87], a[120:123]
    v_mfma_f32_16x16x32_bf16 a[124:127], v[40:43], v[88:91], 0
    ds_read_b64_tr_b16 v[40:41], v16 offset:0
    ds_read_b64_tr_b16 v[42:43], v16 offset:1024
    v_mfma_f32_16x16x32_bf16 a[124:127], v[44:47], v[92:95], a[124:127]
    s_add_u32 s72, s70, 9216
    ds_read_b64_tr_b16 v[44:45], v16 offset:8192
    ds_read_b64_tr_b16 v[46:47], v16 offset:9216
    s_waitcnt lgkmcnt(4)
    v_mfma_f32_16x16x32_bf16 v[128:131], v[48:51], v[96:99], v[128:131]
    buffer_load_dwordx4 v1, s[28:31], s65 offen offset:1024 sc1 lds
    v_mfma_f32_16x16x32_bf16 v[128:131], v[52:55], v[100:103], v[128:131]
    v_add_u32 v24, 0x10000, v24
    v_add_u32 v16, 0xfffe0000, v16
    v_mfma_f32_16x16x32_bf16 v[132:135], v[48:51], v[104:107], v[132:135]
    buffer_store_dwordx4 a[20:23], v1, s[36:39], s72 offen sc1
    v_mfma_f32_16x16x32_bf16 v[132:135], v[52:55], v[108:111], v[132:135]
    ds_read_b128 v[64:67], v24 offset:16384
    v_accvgpr_write_b32 a20, 0
    v_mfma_f32_16x16x32_bf16 v[136:139], v[48:51], v[112:115], v[136:139]
    v_accvgpr_write_b32 a21, 0
    v_accvgpr_write_b32 a22, 0
    v_mfma_f32_16x16x32_bf16 v[136:139], v[52:55], v[116:119], v[136:139]
    v_accvgpr_write_b32 a23, 0
    v_mfma_f32_16x16x32_bf16 v[140:143], v[48:51], v[120:123], v[140:143]
    ds_read_b64_tr_b16 v[48:49], v17 offset:0
    ds_read_b64_tr_b16 v[50:51], v17 offset:1024
    v_mfma_f32_16x16x32_bf16 v[140:143], v[52:55], v[124:127], v[140:143]
    ds_read_b64_tr_b16 v[52:53], v17 offset:8192
    ds_read_b64_tr_b16 v[54:55], v17 offset:9216
    v_mfma_f32_16x16x32_bf16 v[144:147], v[56:59], v[96:99], v[144:147]
    v_add_u32 v17, 0xfffe0000, v17
    v_mfma_f32_16x16x32_bf16 v[144:147], v[60:63], v[100:103], v[144:147]
    s_add_u32 m0, s69, 81920
    v_mfma_f32_16x16x32_bf16 v[148:151], v[56:59], v[104:107], v[148:151]
    s_xor_b32 s65, s65, 8192
    buffer_load_dwordx4 v10, s[20:23], s64 offen lds
    v_mfma_f32_16x16x32_bf16 v[148:151], v[60:63], v[108:111], v[148:151]
    v_mfma_f32_16x16x32_bf16 v[152:155], v[56:59], v[112:115], v[152:155]
    v_add_u32 v25, 0x10000, v25
    v_mfma_f32_16x16x32_bf16 v[152:155], v[60:63], v[116:119], v[152:155]
    ds_read_b128 v[68:71], v25 offset:16384
    v_mfma_f32_16x16x32_bf16 v[156:159], v[56:59], v[120:123], v[156:159]
    ds_read_b64_tr_b16 v[56:57], v18 offset:0
    ds_read_b64_tr_b16 v[58:59], v18 offset:1024
    v_mfma_f32_16x16x32_bf16 v[156:159], v[60:63], v[124:127], v[156:159]
    s_waitcnt lgkmcnt(3)
    ds_read_b64_tr_b16 v[60:61], v18 offset:8192
    ds_read_b64_tr_b16 v[62:63], v18 offset:9216
    v_mfma_f32_16x16x32_bf16 v[160:163], v[40:43], v[96:99], v[160:163]
    v_add_u32 v18, 0xfffe0000, v18
    v_mfma_f32_16x16x32_bf16 v[160:163], v[44:47], v[100:103], v[160:163]
    v_mfma_f32_16x16x32_bf16 v[164:167], v[40:43], v[104:107], v[164:167]
    v_mfma_f32_16x16x32_bf16 v[164:167], v[44:47], v[108:111], v[164:167]
    v_mfma_f32_16x16x32_bf16 v[168:171], v[40:43], v[112:115], v[168:171]
    buffer_load_dwordx4 v11, s[20:23], s64 offen offset:1024 lds
    v_mfma_f32_16x16x32_bf16 v[168:171], v[44:47], v[116:119], v[168:171]
    v_mfma_f32_16x16x32_bf16 v[172:175], v[40:43], v[120:123], v[172:175]
    ds_read_b64_tr_b16 v[40:41], v19 offset:0
    ds_read_b64_tr_b16 v[42:43], v19 offset:1024
    v_mfma_f32_16x16x32_bf16 v[172:175], v[44:47], v[124:127], v[172:175]
    s_add_u32 s72, s70, 13312
    ds_read_b64_tr_b16 v[44:45], v19 offset:8192
    ds_read_b64_tr_b16 v[46:47], v19 offset:9216
    v_mfma_f32_16x16x32_bf16 v[176:179], v[48:51], v[96:99], v[176:179]
    ds_read_b128 v[72:75], v24 offset:24576
    v_add_u32 v19, 0xfffe0000, v19
    v_mfma_f32_16x16x32_bf16 v[176:179], v[52:55], v[100:103], v[176:179]
    buffer_store_dwordx4 a[28:31], v1, s[36:39], s72 offen sc1
    v_mfma_f32_16x16x32_bf16 v[180:183], v[48:51], v[104:107], v[180:183]
    v_mfma_f32_16x16x32_bf16 v[180:183], v[52:55], v[108:111], v[180:183]
    v_accvgpr_write_b32 a28, 0
    v_accvgpr_write_b32 a29, 0
    v_mfma_f32_16x16x32_bf16 v[184:187], v[48:51], v[112:115], v[184:187]
    v_accvgpr_write_b32 a30, 0
    v_accvgpr_write_b32 a31, 0
    v_mfma_f32_16x16x32_bf16 v[184:187], v[52:55], v[116:119], v[184:187]
    v_mfma_f32_16x16x32_bf16 v[188:191], v[48:51], v[120:123], v[188:191]
    buffer_load_dwordx4 v12, s[20:23], s64 offen offset:2048 lds
    v_mfma_f32_16x16x32_bf16 v[188:191], v[52:55], v[124:127], v[188:191]
    s_waitcnt lgkmcnt(0)
    ds_read_b64_tr_b16 v[48:49], v20 offset:0
    ds_read_b64_tr_b16 v[50:51], v20 offset:1024
    v_mfma_f32_16x16x32_bf16 v[192:195], v[56:59], v[96:99], v[192:195]
    ds_read_b64_tr_b16 v[52:53], v20 offset:8192
    ds_read_b64_tr_b16 v[54:55], v20 offset:9216
    v_mfma_f32_16x16x32_bf16 v[192:195], v[60:63], v[100:103], v[192:195]
    v_add_u32 v20, 0xfffe0000, v20
    v_mfma_f32_16x16x32_bf16 v[196:199], v[56:59], v[104:107], v[196:199]
    v_mfma_f32_16x16x32_bf16 v[196:199], v[60:63], v[108:111], v[196:199]
    ds_read_b128 v[76:79], v25 offset:24576
    v_mfma_f32_16x16x32_bf16 v[200:203], v[56:59], v[112:115], v[200:203]
    v_mfma_f32_16x16x32_bf16 v[200:203], v[60:63], v[116:119], v[200:203]
    v_mfma_f32_16x16x32_bf16 v[204:207], v[56:59], v[120:123], v[204:207]
    ds_read_b64_tr_b16 v[56:57], v21 offset:0
    ds_read_b64_tr_b16 v[58:59], v21 offset:1024
    v_mfma_f32_16x16x32_bf16 v[204:207], v[60:63], v[124:127], v[204:207]
    ds_read_b64_tr_b16 v[60:61], v21 offset:8192
    ds_read_b64_tr_b16 v[62:63], v21 offset:9216
    v_mfma_f32_16x16x32_bf16 v[208:211], v[40:43], v[96:99], v[208:211]
    buffer_load_dwordx4 v13, s[20:23], s64 offen offset:3072 lds
    v_mfma_f32_16x16x32_bf16 v[208:211], v[44:47], v[100:103], v[208:211]
    v_add_u32 v21, 0xfffe0000, v21
    v_mfma_f32_16x16x32_bf16 v[212:215], v[40:43], v[104:107], v[212:215]
    v_mfma_f32_16x16x32_bf16 v[212:215], v[44:47], v[108:111], v[212:215]
    v_mfma_f32_16x16x32_bf16 v[216:219], v[40:43], v[112:115], v[216:219]
    v_mfma_f32_16x16x32_bf16 v[216:219], v[44:47], v[116:119], v[216:219]
    v_mfma_f32_16x16x32_bf16 v[220:223], v[40:43], v[120:123], v[220:223]
    ds_read_b64_tr_b16 v[40:41], v26 offset:0
    ds_read_b64_tr_b16 v[42:43], v26 offset:512
    v_mfma_f32_16x16x32_bf16 v[220:223], v[44:47], v[124:127], v[220:223]
    s_add_u32 s72, s70, 33792
    ds_read_b64_tr_b16 v[44:45], v26 offset:4096
    ds_read_b64_tr_b16 v[46:47], v26 offset:4608
    s_waitcnt lgkmcnt(4)
    v_mfma_f32_16x16x32_bf16 v[224:227], v[48:51], v[96:99], v[224:227]
    buffer_store_dwordx4 a[36:39], v1, s[36:39], s72 offen sc1
    v_mfma_f32_16x16x32_bf16 v[224:227], v[52:55], v[100:103], v[224:227]
    s_xor_b32 s64, s64, 896
    v_add_u32 v26, 0x10000, v26
    v_accvgpr_write_b32 a36, 0
    v_mfma_f32_16x16x32_bf16 v[228:231], v[48:51], v[104:107], v[228:231]
    v_accvgpr_write_b32 a37, 0
    v_accvgpr_write_b32 a38, 0
    v_mfma_f32_16x16x32_bf16 v[228:231], v[52:55], v[108:111], v[228:231]
    v_accvgpr_write_b32 a39, 0
    v_mfma_f32_16x16x32_bf16 v[232:235], v[48:51], v[112:115], v[232:235]
    v_mfma_f32_16x16x32_bf16 v[232:235], v[52:55], v[116:119], v[232:235]
    s_add_u32 m0, s69, 98304
    v_mfma_f32_16x16x32_bf16 v[236:239], v[48:51], v[120:123], v[236:239]
    buffer_load_dwordx4 v2, s[24:27], s60 offen lds
    v_mfma_f32_16x16x32_bf16 v[236:239], v[52:55], v[124:127], v[236:239]
    ds_read_b64_tr_b16 v[48:49], v27 offset:0
    ds_read_b64_tr_b16 v[50:51], v27 offset:512
    v_mfma_f32_16x16x32_bf16 v[240:243], v[56:59], v[96:99], v[240:243]
    ds_read_b64_tr_b16 v[52:53], v27 offset:4096
    ds_read_b64_tr_b16 v[54:55], v27 offset:4608
    v_mfma_f32_16x16x32_bf16 v[240:243], v[60:63], v[100:103], v[240:243]
    buffer_load_dwordx4 v3, s[24:27], s60 offen offset:1024 lds
    v_mfma_f32_16x16x32_bf16 v[244:247], v[56:59], v[104:107], v[244:247]
    v_add_u32 v27, 0x10000, v27
    v_mfma_f32_16x16x32_bf16 v[244:247], v[60:63], v[108:111], v[244:247]
    v_mfma_f32_16x16x32_bf16 v[248:251], v[56:59], v[112:115], v[248:251]
    v_mfma_f32_16x16x32_bf16 v[248:251], v[60:63], v[116:119], v[248:251]
    buffer_load_dwordx4 v4, s[24:27], s60 offen offset:2048 lds
    v_mfma_f32_16x16x32_bf16 v[252:255], v[56:59], v[120:123], v[252:255]
    ds_read_b64_tr_b16 v[56:57], v28 offset:0
    ds_read_b64_tr_b16 v[58:59], v28 offset:512
    v_mfma_f32_16x16x32_bf16 v[252:255], v[60:63], v[124:127], v[252:255]
    s_waitcnt lgkmcnt(2)
    ds_read_b64_tr_b16 v[60:61], v28 offset:4096
    ds_read_b64_tr_b16 v[62:63], v28 offset:4608
    v_mfma_f32_16x16x32_bf16 a[64:67], v[40:43], v[96:99], a[64:67]
    buffer_load_dwordx4 v5, s[24:27], s60 offen offset:3072 lds
    v_mfma_f32_16x16x32_bf16 a[64:67], v[44:47], v[100:103], a[64:67]
    v_add_u32 v24, 0xfffe0000, v24
    v_add_u32 v28, 0x10000, v28
    v_mfma_f32_16x16x32_bf16 a[68:71], v[40:43], v[104:107], a[68:71]
    ds_read_b128 v[80:83], v24 offset:16384
    v_mfma_f32_16x16x32_bf16 a[68:71], v[44:47], v[108:111], a[68:71]
    s_add_u32 m0, s69, 114688
    v_mfma_f32_16x16x32_bf16 a[72:75], v[40:43], v[112:115], a[72:75]
    s_xor_b32 s60, s60, 3670016
    buffer_load_dwordx4 v10, s[20:23], s63 offen lds
    v_mfma_f32_16x16x32_bf16 a[72:75], v[44:47], v[116:119], a[72:75]
    v_add_u32 v25, 0xfffe0000, v25
    ds_read_b128 v[84:87], v25 offset:16384
    v_mfma_f32_16x16x32_bf16 a[76:79], v[40:43], v[120:123], a[76:79]
    ds_read_b64_tr_b16 v[40:41], v29 offset:0
    ds_read_b64_tr_b16 v[42:43], v29 offset:512
    v_mfma_f32_16x16x32_bf16 a[76:79], v[44:47], v[124:127], a[76:79]
    s_add_u32 s72, s70, 37888
    buffer_load_dwordx4 v11, s[20:23], s63 offen offset:1024 lds
    v_mfma_f32_16x16x32_bf16 a[80:83], v[48:51], v[96:99], a[80:83]
    ds_read_b128 v[88:91], v24 offset:24576
    ds_read_b64_tr_b16 v[44:45], v29 offset:4096
    v_mfma_f32_16x16x32_bf16 a[80:83], v[52:55], v[100:103], a[80:83]
    ds_read_b64_tr_b16 v[46:47], v29 offset:4608
    v_add_u32 v29, 0x10000, v29
    v_mfma_f32_16x16x32_bf16 a[84:87], v[48:51], v[104:107], a[84:87]
    buffer_store_dwordx4 a[44:47], v1, s[36:39], s72 offen sc1
    v_mfma_f32_16x16x32_bf16 a[84:87], v[52:55], v[108:111], a[84:87]
    ds_read_b128 v[92:95], v25 offset:24576
    v_accvgpr_write_b32 a44, 0
    v_mfma_f32_16x16x32_bf16 a[88:91], v[48:51], v[112:115], a[88:91]
    v_accvgpr_write_b32 a45, 0
    v_accvgpr_write_b32 a46, 0
    v_mfma_f32_16x16x32_bf16 a[88:91], v[52:55], v[116:119], a[88:91]
    v_accvgpr_write_b32 a47, 0
    v_mfma_f32_16x16x32_bf16 a[92:95], v[48:51], v[120:123], a[92:95]
    buffer_load_dwordx4 v12, s[20:23], s63 offen offset:2048 lds
    v_mfma_f32_16x16x32_bf16 a[92:95], v[52:55], v[124:127], a[92:95]
    s_waitcnt lgkmcnt(1)
    v_mfma_f32_16x16x32_bf16 a[96:99], v[56:59], v[96:99], a[96:99]
    v_mfma_f32_16x16x32_bf16 a[96:99], v[60:63], v[100:103], a[96:99]
    v_mfma_f32_16x16x32_bf16 a[100:103], v[56:59], v[104:107], a[100:103]
    buffer_load_dwordx4 v13, s[20:23], s63 offen offset:3072 lds
    v_mfma_f32_16x16x32_bf16 a[100:103], v[60:63], v[108:111], a[100:103]
    s_xor_b32 s63, s63, 128
    v_mfma_f32_16x16x32_bf16 a[104:107], v[56:59], v[112:115], a[104:107]
    v_mfma_f32_16x16x32_bf16 a[104:107], v[60:63], v[116:119], a[104:107]
    s_waitcnt vmcnt(10) lgkmcnt(0)
    s_barrier
    ds_read_b64_tr_b16 v[48:49], v14 offset:32768
    v_mfma_f32_16x16x32_bf16 a[108:111], v[56:59], v[120:123], a[108:111]
    s_add_u32 m0, s67, 131072
    ds_read_b64_tr_b16 v[50:51], v14 offset:33792
    ds_read_b64_tr_b16 v[52:53], v14 offset:40960
    v_mfma_f32_16x16x32_bf16 a[108:111], v[60:63], v[124:127], a[108:111]
    buffer_load_dwordx4 v1, s[28:31], s65 offen sc1 lds
    v_mfma_f32_16x16x32_bf16 a[112:115], v[40:43], v[96:99], a[112:115]
    ds_read_b64_tr_b16 v[54:55], v14 offset:41984
    ds_read_b64_tr_b16 v[56:57], v15 offset:32768
    v_mfma_f32_16x16x32_bf16 a[112:115], v[44:47], v[100:103], a[112:115]
    ds_read_b64_tr_b16 v[58:59], v15 offset:33792
    ds_read_b64_tr_b16 v[60:61], v15 offset:40960
    v_mfma_f32_16x16x32_bf16 a[116:119], v[40:43], v[104:107], a[116:119]
    ds_read_b64_tr_b16 v[62:63], v15 offset:41984
    v_add_u32 v14, 0x10000, v14
    v_mfma_f32_16x16x32_bf16 a[116:119], v[44:47], v[108:111], a[116:119]
    v_add_u32 v15, 0x10000, v15
    v_mfma_f32_16x16x32_bf16 a[120:123], v[40:43], v[112:115], a[120:123]
    v_mfma_f32_16x16x32_bf16 a[120:123], v[44:47], v[116:119], a[120:123]
    v_mfma_f32_16x16x32_bf16 a[124:127], v[40:43], v[120:123], a[124:127]
    ds_read_b64_tr_b16 v[40:41], v16 offset:32768
    ds_read_b64_tr_b16 v[42:43], v16 offset:33792
    v_mfma_f32_16x16x32_bf16 a[124:127], v[44:47], v[124:127], a[124:127]
    s_add_u32 s72, s70, 41984
    ds_read_b64_tr_b16 v[44:45], v16 offset:40960
    ds_read_b64_tr_b16 v[46:47], v16 offset:41984
    s_waitcnt lgkmcnt(4)
    v_mfma_f32_16x16x32_bf16 v[128:131], v[48:51], v[64:67], v[128:131]
    buffer_load_dwordx4 v1, s[28:31], s65 offen offset:1024 sc1 lds
    v_mfma_f32_16x16x32_bf16 v[128:131], v[52:55], v[68:71], v[128:131]
    buffer_store_dwordx4 a[52:55], v1, s[36:39], s72 offen sc1
    v_mfma_f32_16x16x32_bf16 v[132:135], v[48:51], v[72:75], v[132:135]
    ds_read_b128 v[96:99], v24 offset:49152
    v_add_u32 v16, 0x10000, v16
    v_mfma_f32_16x16x32_bf16 v[132:135], v[52:55], v[76:79], v[132:135]
    v_accvgpr_write_b32 a52, 0
    v_accvgpr_write_b32 a53, 0
    v_mfma_f32_16x16x32_bf16 v[136:139], v[48:51], v[80:83], v[136:139]
    v_accvgpr_write_b32 a54, 0
    v_accvgpr_write_b32 a55, 0
    v_mfma_f32_16x16x32_bf16 v[136:139], v[52:55], v[84:87], v[136:139]
    v_mfma_f32_16x16x32_bf16 v[140:143], v[48:51], v[88:91], v[140:143]
    ds_read_b64_tr_b16 v[48:49], v17 offset:32768
    ds_read_b64_tr_b16 v[50:51], v17 offset:33792
    v_mfma_f32_16x16x32_bf16 v[140:143], v[52:55], v[92:95], v[140:143]
    ds_read_b64_tr_b16 v[52:53], v17 offset:40960
    ds_read_b64_tr_b16 v[54:55], v17 offset:41984
    v_mfma_f32_16x16x32_bf16 v[144:147], v[56:59], v[64:67], v[144:147]
    v_add_u32 v17, 0x10000, v17
    v_mfma_f32_16x16x32_bf16 v[144:147], v[60:63], v[68:71], v[144:147]
    s_add_u32 m0, s69, 147456
    v_mfma_f32_16x16x32_bf16 v[148:151], v[56:59], v[72:75], v[148:151]
    s_xor_b32 s65, s65, 57344
    buffer_load_dwordx4 v10, s[20:23], s64 offen lds
    v_mfma_f32_16x16x32_bf16 v[148:151], v[60:63], v[76:79], v[148:151]
    v_mfma_f32_16x16x32_bf16 v[152:155], v[56:59], v[80:83], v[152:155]
    v_mfma_f32_16x16x32_bf16 v[152:155], v[60:63], v[84:87], v[152:155]
    ds_read_b128 v[100:103], v25 offset:49152
    v_mfma_f32_16x16x32_bf16 v[156:159], v[56:59], v[88:91], v[156:159]
    ds_read_b64_tr_b16 v[56:57], v18 offset:32768
    ds_read_b64_tr_b16 v[58:59], v18 offset:33792
    v_mfma_f32_16x16x32_bf16 v[156:159], v[60:63], v[92:95], v[156:159]
    s_waitcnt lgkmcnt(3)
    ds_read_b64_tr_b16 v[60:61], v18 offset:40960
    ds_read_b64_tr_b16 v[62:63], v18 offset:41984
    v_mfma_f32_16x16x32_bf16 v[160:163], v[40:43], v[64:67], v[160:163]
    v_add_u32 v18, 0x10000, v18
    v_mfma_f32_16x16x32_bf16 v[160:163], v[44:47], v[68:71], v[160:163]
    v_mfma_f32_16x16x32_bf16 v[164:167], v[40:43], v[72:75], v[164:167]
    v_mfma_f32_16x16x32_bf16 v[164:167], v[44:47], v[76:79], v[164:167]
    v_mfma_f32_16x16x32_bf16 v[168:171], v[40:43], v[80:83], v[168:171]
    buffer_load_dwordx4 v11, s[20:23], s64 offen offset:1024 lds
    v_mfma_f32_16x16x32_bf16 v[168:171], v[44:47], v[84:87], v[168:171]
    v_mfma_f32_16x16x32_bf16 v[172:175], v[40:43], v[88:91], v[172:175]
    ds_read_b64_tr_b16 v[40:41], v19 offset:32768
    ds_read_b64_tr_b16 v[42:43], v19 offset:33792
    v_mfma_f32_16x16x32_bf16 v[172:175], v[44:47], v[92:95], v[172:175]
    s_add_u32 s72, s70, 46080
    ds_read_b64_tr_b16 v[44:45], v19 offset:40960
    ds_read_b64_tr_b16 v[46:47], v19 offset:41984
    v_mfma_f32_16x16x32_bf16 v[176:179], v[48:51], v[64:67], v[176:179]
    ds_read_b128 v[104:107], v24 offset:57344
    v_add_u32 v19, 0x10000, v19
    v_mfma_f32_16x16x32_bf16 v[176:179], v[52:55], v[68:71], v[176:179]
    buffer_store_dwordx4 a[60:63], v1, s[36:39], s72 offen sc1
    v_mfma_f32_16x16x32_bf16 v[180:183], v[48:51], v[72:75], v[180:183]
    v_mfma_f32_16x16x32_bf16 v[180:183], v[52:55], v[76:79], v[180:183]
    v_accvgpr_write_b32 a60, 0
    v_accvgpr_write_b32 a61, 0
    v_mfma_f32_16x16x32_bf16 v[184:187], v[48:51], v[80:83], v[184:187]
    v_accvgpr_write_b32 a62, 0
    v_accvgpr_write_b32 a63, 0
    v_mfma_f32_16x16x32_bf16 v[184:187], v[52:55], v[84:87], v[184:187]
    v_mfma_f32_16x16x32_bf16 v[188:191], v[48:51], v[88:91], v[188:191]
    buffer_load_dwordx4 v12, s[20:23], s64 offen offset:2048 lds
    v_mfma_f32_16x16x32_bf16 v[188:191], v[52:55], v[92:95], v[188:191]
    s_waitcnt lgkmcnt(0)
    ds_read_b64_tr_b16 v[48:49], v20 offset:32768
    ds_read_b64_tr_b16 v[50:51], v20 offset:33792
    v_mfma_f32_16x16x32_bf16 v[192:195], v[56:59], v[64:67], v[192:195]
    ds_read_b64_tr_b16 v[52:53], v20 offset:40960
    ds_read_b64_tr_b16 v[54:55], v20 offset:41984
    v_mfma_f32_16x16x32_bf16 v[192:195], v[60:63], v[68:71], v[192:195]
    v_add_u32 v20, 0x10000, v20
    v_mfma_f32_16x16x32_bf16 v[196:199], v[56:59], v[72:75], v[196:199]
    v_mfma_f32_16x16x32_bf16 v[196:199], v[60:63], v[76:79], v[196:199]
    ds_read_b128 v[108:111], v25 offset:57344
    v_mfma_f32_16x16x32_bf16 v[200:203], v[56:59], v[80:83], v[200:203]
    v_accvgpr_read_b32 v32, a128
    v_accvgpr_read_b32 v31, a129
    v_mfma_f32_16x16x32_bf16 v[200:203], v[60:63], v[84:87], v[200:203]
    v_cvt_pk_bf16_f32 v32, v32, v31
    v_accvgpr_read_b32 v33, a130
    v_mfma_f32_16x16x32_bf16 v[204:207], v[56:59], v[88:91], v[204:207]
    ds_read_b64_tr_b16 v[56:57], v21 offset:32768
    ds_read_b64_tr_b16 v[58:59], v21 offset:33792
    v_mfma_f32_16x16x32_bf16 v[204:207], v[60:63], v[92:95], v[204:207]
    ds_read_b64_tr_b16 v[60:61], v21 offset:40960
    ds_read_b64_tr_b16 v[62:63], v21 offset:41984
    v_mfma_f32_16x16x32_bf16 v[208:211], v[40:43], v[64:67], v[208:211]
    buffer_load_dwordx4 v13, s[20:23], s64 offen offset:3072 lds
    v_mfma_f32_16x16x32_bf16 v[208:211], v[44:47], v[68:71], v[208:211]
    v_add_u32 v21, 0x10000, v21
    v_accvgpr_read_b32 v31, a131
    v_mfma_f32_16x16x32_bf16 v[212:215], v[40:43], v[72:75], v[212:215]
    v_cvt_pk_bf16_f32 v33, v33, v31
    v_accvgpr_read_b32 v34, a132
    v_mfma_f32_16x16x32_bf16 v[212:215], v[44:47], v[76:79], v[212:215]
    v_accvgpr_read_b32 v31, a133
    v_cvt_pk_bf16_f32 v34, v34, v31
    v_mfma_f32_16x16x32_bf16 v[216:219], v[40:43], v[80:83], v[216:219]
    v_accvgpr_read_b32 v35, a134
    v_accvgpr_read_b32 v31, a135
    v_mfma_f32_16x16x32_bf16 v[216:219], v[44:47], v[84:87], v[216:219]
    v_cvt_pk_bf16_f32 v35, v35, v31
    v_mfma_f32_16x16x32_bf16 v[220:223], v[40:43], v[88:91], v[220:223]
    ds_read_b64_tr_b16 v[40:41], v26 offset:0
    ds_read_b64_tr_b16 v[42:43], v26 offset:512
    v_mfma_f32_16x16x32_bf16 v[220:223], v[44:47], v[92:95], v[220:223]
    s_add_u32 s72, s71, 0
    ds_read_b64_tr_b16 v[44:45], v26 offset:4096
    ds_read_b64_tr_b16 v[46:47], v26 offset:4608
    s_waitcnt lgkmcnt(4)
    v_mfma_f32_16x16x32_bf16 v[224:227], v[48:51], v[64:67], v[224:227]
    buffer_store_dwordx4 v[32:35], v1, s[36:39], s72 offen sc1
    v_mfma_f32_16x16x32_bf16 v[224:227], v[52:55], v[68:71], v[224:227]
    s_xor_b32 s64, s64, 128
    v_add_u32 v26, 0x10000, v26
    v_mfma_f32_16x16x32_bf16 v[228:231], v[48:51], v[72:75], v[228:231]
    v_mfma_f32_16x16x32_bf16 v[228:231], v[52:55], v[76:79], v[228:231]
    v_mfma_f32_16x16x32_bf16 v[232:235], v[48:51], v[80:83], v[232:235]
    v_mfma_f32_16x16x32_bf16 v[232:235], v[52:55], v[84:87], v[232:235]
    s_add_u32 m0, s69, 0
    v_mfma_f32_16x16x32_bf16 v[236:239], v[48:51], v[88:91], v[236:239]
    buffer_load_dwordx4 v2, s[24:27], s60 offen lds
    v_mfma_f32_16x16x32_bf16 v[236:239], v[52:55], v[92:95], v[236:239]
    ds_read_b64_tr_b16 v[48:49], v27 offset:0
    ds_read_b64_tr_b16 v[50:51], v27 offset:512
    v_mfma_f32_16x16x32_bf16 v[240:243], v[56:59], v[64:67], v[240:243]
    ds_read_b64_tr_b16 v[52:53], v27 offset:4096
    ds_read_b64_tr_b16 v[54:55], v27 offset:4608
    v_mfma_f32_16x16x32_bf16 v[240:243], v[60:63], v[68:71], v[240:243]
    buffer_load_dwordx4 v3, s[24:27], s60 offen offset:1024 lds
    v_mfma_f32_16x16x32_bf16 v[244:247], v[56:59], v[72:75], v[244:247]
    v_add_u32 v27, 0x10000, v27
    v_mfma_f32_16x16x32_bf16 v[244:247], v[60:63], v[76:79], v[244:247]
    v_mfma_f32_16x16x32_bf16 v[248:251], v[56:59], v[80:83], v[248:251]
    v_accvgpr_read_b32 v32, a136
    v_accvgpr_read_b32 v31, a137
    v_mfma_f32_16x16x32_bf16 v[248:251], v[60:63], v[84:87], v[248:251]
    buffer_load_dwordx4 v4, s[24:27], s60 offen offset:2048 lds
    v_mfma_f32_16x16x32_bf16 v[252:255], v[56:59], v[88:91], v[252:255]
    ds_read_b64_tr_b16 v[56:57], v28 offset:0
    ds_read_b64_tr_b16 v[58:59], v28 offset:512
    v_mfma_f32_16x16x32_bf16 v[252:255], v[60:63], v[92:95], v[252:255]
    s_waitcnt lgkmcnt(2)
    ds_read_b64_tr_b16 v[60:61], v28 offset:4096
    ds_read_b64_tr_b16 v[62:63], v28 offset:4608
    v_mfma_f32_16x16x32_bf16 a[64:67], v[40:43], v[64:67], a[64:67]
    buffer_load_dwordx4 v5, s[24:27], s60 offen offset:3072 lds
    v_mfma_f32_16x16x32_bf16 a[64:67], v[44:47], v[68:71], a[64:67]
    v_add_u32 v24, 0x10000, v24
    v_add_u32 v28, 0x10000, v28
    v_mfma_f32_16x16x32_bf16 a[68:71], v[40:43], v[72:75], a[68:71]
    ds_read_b128 v[112:115], v24 offset:16384
    v_cvt_pk_bf16_f32 v32, v32, v31
    v_mfma_f32_16x16x32_bf16 a[68:71], v[44:47], v[76:79], a[68:71]
    s_add_u32 m0, s69, 16384
    v_accvgpr_read_b32 v33, a138
    v_accvgpr_read_b32 v31, a139
    v_mfma_f32_16x16x32_bf16 a[72:75], v[40:43], v[80:83], a[72:75]
    s_xor_b32 s60, s60, 524288
    v_add_u32 v25, 0x10000, v25
    v_cvt_pk_bf16_f32 v33, v33, v31
    v_mfma_f32_16x16x32_bf16 a[72:75], v[44:47], v[84:87], a[72:75]
    buffer_load_dwordx4 v10, s[20:23], s63 offen lds
    v_mfma_f32_16x16x32_bf16 a[76:79], v[40:43], v[88:91], a[76:79]
    ds_read_b128 v[116:119], v25 offset:16384
    ds_read_b64_tr_b16 v[40:41], v29 offset:0
    v_mfma_f32_16x16x32_bf16 a[76:79], v[44:47], v[92:95], a[76:79]
    s_add_u32 s72, s71, 1024
    buffer_load_dwordx4 v11, s[20:23], s63 offen offset:1024 lds
    v_mfma_f32_16x16x32_bf16 a[80:83], v[48:51], v[64:67], a[80:83]
    ds_read_b128 v[120:123], v24 offset:24576
    ds_read_b64_tr_b16 v[42:43], v29 offset:512
    v_mfma_f32_16x16x32_bf16 a[80:83], v[52:55], v[68:71], a[80:83]
    ds_read_b64_tr_b16 v[44:45], v29 offset:4096
    ds_read_b64_tr_b16 v[46:47], v29 offset:4608
    v_mfma_f32_16x16x32_bf16 a[84:87], v[48:51], v[72:75], a[84:87]
    v_add_u32 v29, 0x10000, v29
    v_accvgpr_read_b32 v34, a140
    v_mfma_f32_16x16x32_bf16 a[84:87], v[52:55], v[76:79], a[84:87]
    buffer_load_dwordx4 v12, s[20:23], s63 offen offset:2048 lds
    v_mfma_f32_16x16x32_bf16 a[88:91], v[48:51], v[80:83], a[88:91]
    ds_read_b128 v[124:127], v25 offset:24576
    v_accvgpr_read_b32 v31, a141
    v_mfma_f32_16x16x32_bf16 a[88:91], v[52:55], v[84:87], a[88:91]
    v_cvt_pk_bf16_f32 v34, v34, v31
    v_accvgpr_read_b32 v35, a142
    v_mfma_f32_16x16x32_bf16 a[92:95], v[48:51], v[88:91], a[92:95]
    buffer_load_dwordx4 v13, s[20:23], s63 offen offset:3072 lds
    v_mfma_f32_16x16x32_bf16 a[92:95], v[52:55], v[92:95], a[92:95]
    s_waitcnt lgkmcnt(1)
    v_accvgpr_read_b32 v31, a143
    v_cvt_pk_bf16_f32 v35, v35, v31
    v_mfma_f32_16x16x32_bf16 a[96:99], v[56:59], v[64:67], a[96:99]
    v_mfma_f32_16x16x32_bf16 a[96:99], v[60:63], v[68:71], a[96:99]
    s_xor_b32 s63, s63, 384
    v_mfma_f32_16x16x32_bf16 a[100:103], v[56:59], v[72:75], a[100:103]
    buffer_store_dwordx4 v[32:35], v1, s[36:39], s72 offen sc1
    v_mfma_f32_16x16x32_bf16 a[100:103], v[60:63], v[76:79], a[100:103]
    v_mfma_f32_16x16x32_bf16 a[104:107], v[56:59], v[80:83], a[104:107]
    v_accvgpr_read_b32 v32, a144
    v_accvgpr_read_b32 v31, a145
    v_mfma_f32_16x16x32_bf16 a[104:107], v[60:63], v[84:87], a[104:107]
    s_waitcnt vmcnt(10) lgkmcnt(0)
    s_barrier
    ds_read_b64_tr_b16 v[48:49], v14 offset:32768
    v_mfma_f32_16x16x32_bf16 a[108:111], v[56:59], v[88:91], a[108:111]
    s_add_u32 m0, s67, 32768
    ds_read_b64_tr_b16 v[50:51], v14 offset:33792
    ds_read_b64_tr_b16 v[52:53], v14 offset:40960
    v_mfma_f32_16x16x32_bf16 a[108:111], v[60:63], v[92:95], a[108:111]
    buffer_load_dwordx4 v1, s[28:31], s65 offen sc1 lds
    v_mfma_f32_16x16x32_bf16 a[112:115], v[40:43], v[64:67], a[112:115]
    ds_read_b64_tr_b16 v[54:55], v14 offset:41984
    ds_read_b64_tr_b16 v[56:57], v15 offset:32768
    v_mfma_f32_16x16x32_bf16 a[112:115], v[44:47], v[68:71], a[112:115]
    ds_read_b64_tr_b16 v[58:59], v15 offset:33792
    ds_read_b64_tr_b16 v[60:61], v15 offset:40960
    v_mfma_f32_16x16x32_bf16 a[116:119], v[40:43], v[72:75], a[116:119]
    ds_read_b64_tr_b16 v[62:63], v15 offset:41984
    v_add_u32 v14, 0xffff0000, v14
    v_mfma_f32_16x16x32_bf16 a[116:119], v[44:47], v[76:79], a[116:119]
    v_add_u32 v15, 0xffff0000, v15
    v_cvt_pk_bf16_f32 v32, v32, v31
    v_mfma_f32_16x16x32_bf16 a[120:123], v[40:43], v[80:83], a[120:123]
    v_accvgpr_read_b32 v33, a146
    v_accvgpr_read_b32 v31, a147
    v_mfma_f32_16x16x32_bf16 a[120:123], v[44:47], v[84:87], a[120:123]
    v_cvt_pk_bf16_f32 v33, v33, v31
    v_accvgpr_read_b32 v34, a148
    v_mfma_f32_16x16x32_bf16 a[124:127], v[40:43], v[88:91], a[124:127]
    ds_read_b64_tr_b16 v[40:41], v16 offset:32768
    ds_read_b64_tr_b16 v[42:43], v16 offset:33792
    v_mfma_f32_16x16x32_bf16 a[124:127], v[44:47], v[92:95], a[124:127]
    s_add_u32 s72, s71, 32768
    ds_read_b64_tr_b16 v[44:45], v16 offset:40960
    ds_read_b64_tr_b16 v[46:47], v16 offset:41984
    s_waitcnt lgkmcnt(4)
    v_mfma_f32_16x16x32_bf16 v[128:131], v[48:51], v[96:99], v[128:131]
    buffer_load_dwordx4 v1, s[28:31], s65 offen offset:1024 sc1 lds
    v_mfma_f32_16x16x32_bf16 v[128:131], v[52:55], v[100:103], v[128:131]
    v_add_u32 v16, 0xffff0000, v16
    v_accvgpr_read_b32 v31, a149
    v_mfma_f32_16x16x32_bf16 v[132:135], v[48:51], v[104:107], v[132:135]
    ds_read_b128 v[64:67], v24 offset:49152
    v_cvt_pk_bf16_f32 v34, v34, v31
    v_mfma_f32_16x16x32_bf16 v[132:135], v[52:55], v[108:111], v[132:135]
    v_accvgpr_read_b32 v35, a150
    v_accvgpr_read_b32 v31, a151
    v_mfma_f32_16x16x32_bf16 v[136:139], v[48:51], v[112:115], v[136:139]
    v_cvt_pk_bf16_f32 v35, v35, v31
    v_accvgpr_write_b32 a144, 0
    v_mfma_f32_16x16x32_bf16 v[136:139], v[52:55], v[116:119], v[136:139]
    buffer_store_dwordx4 v[32:35], v1, s[36:39], s72 offen sc1
    v_mfma_f32_16x16x32_bf16 v[140:143], v[48:51], v[120:123], v[140:143]
    ds_read_b64_tr_b16 v[48:49], v17 offset:32768
    ds_read_b64_tr_b16 v[50:51], v17 offset:33792
    v_mfma_f32_16x16x32_bf16 v[140:143], v[52:55], v[124:127], v[140:143]
    ds_read_b64_tr_b16 v[52:53], v17 offset:40960
    ds_read_b64_tr_b16 v[54:55], v17 offset:41984
    v_mfma_f32_16x16x32_bf16 v[144:147], v[56:59], v[96:99], v[144:147]
    v_add_u32 v17, 0xffff0000, v17
    v_accvgpr_write_b32 a145, 0
    v_mfma_f32_16x16x32_bf16 v[144:147], v[60:63], v[100:103], v[144:147]
    s_add_u32 m0, s69, 49152
    v_accvgpr_write_b32 a146, 0
    v_accvgpr_write_b32 a147, 0
    v_mfma_f32_16x16x32_bf16 v[148:151], v[56:59], v[104:107], v[148:151]
    s_xor_b32 s65, s65, 8192
    buffer_load_dwordx4 v10, s[20:23], s64 offen lds
    v_mfma_f32_16x16x32_bf16 v[148:151], v[60:63], v[108:111], v[148:151]
    v_accvgpr_write_b32 a148, 0
    v_accvgpr_write_b32 a149, 0
    v_mfma_f32_16x16x32_bf16 v[152:155], v[56:59], v[112:115], v[152:155]
    v_accvgpr_read_b32 v32, a152
    v_accvgpr_read_b32 v31, a153
    v_mfma_f32_16x16x32_bf16 v[152:155], v[60:63], v[116:119], v[152:155]
    ds_read_b128 v[68:71], v25 offset:49152
    v_cvt_pk_bf16_f32 v32, v32, v31
    v_mfma_f32_16x16x32_bf16 v[156:159], v[56:59], v[120:123], v[156:159]
    ds_read_b64_tr_b16 v[56:57], v18 offset:32768
    ds_read_b64_tr_b16 v[58:59], v18 offset:33792
    v_mfma_f32_16x16x32_bf16 v[156:159], v[60:63], v[124:127], v[156:159]
    s_waitcnt lgkmcnt(3)
    ds_read_b64_tr_b16 v[60:61], v18 offset:40960
    ds_read_b64_tr_b16 v[62:63], v18 offset:41984
    v_mfma_f32_16x16x32_bf16 v[160:163], v[40:43], v[96:99], v[160:163]
    v_add_u32 v18, 0xffff0000, v18
    v_accvgpr_read_b32 v33, a154
    v_mfma_f32_16x16x32_bf16 v[160:163], v[44:47], v[100:103], v[160:163]
    v_accvgpr_read_b32 v31, a155
    v_cvt_pk_bf16_f32 v33, v33, v31
    v_mfma_f32_16x16x32_bf16 v[164:167], v[40:43], v[104:107], v[164:167]
    v_accvgpr_read_b32 v34, a156
    v_accvgpr_read_b32 v31, a157
    v_mfma_f32_16x16x32_bf16 v[164:167], v[44:47], v[108:111], v[164:167]
    v_cvt_pk_bf16_f32 v34, v34, v31
    v_accvgpr_read_b32 v35, a158
    v_mfma_f32_16x16x32_bf16 v[168:171], v[40:43], v[112:115], v[168:171]
    buffer_load_dwordx4 v11, s[20:23], s64 offen offset:1024 lds
    v_mfma_f32_16x16x32_bf16 v[168:171], v[44:47], v[116:119], v[168:171]
    v_accvgpr_read_b32 v31, a159
    v_cvt_pk_bf16_f32 v35, v35, v31
    v_mfma_f32_16x16x32_bf16 v[172:175], v[40:43], v[120:123], v[172:175]
    ds_read_b64_tr_b16 v[40:41], v19 offset:32768
    ds_read_b64_tr_b16 v[42:43], v19 offset:33792
    v_mfma_f32_16x16x32_bf16 v[172:175], v[44:47], v[124:127], v[172:175]
    s_add_u32 s72, s71, 33792
    ds_read_b64_tr_b16 v[44:45], v19 offset:40960
    ds_read_b64_tr_b16 v[46:47], v19 offset:41984
    v_mfma_f32_16x16x32_bf16 v[176:179], v[48:51], v[96:99], v[176:179]
    ds_read_b128 v[72:75], v24 offset:57344
    v_add_u32 v19, 0xffff0000, v19
    v_mfma_f32_16x16x32_bf16 v[176:179], v[52:55], v[100:103], v[176:179]
    buffer_store_dwordx4 v[32:35], v1, s[36:39], s72 offen sc1
    v_mfma_f32_16x16x32_bf16 v[180:183], v[48:51], v[104:107], v[180:183]
    v_accvgpr_write_b32 a150, 0
    v_accvgpr_write_b32 a151, 0
    v_mfma_f32_16x16x32_bf16 v[180:183], v[52:55], v[108:111], v[180:183]
    v_accvgpr_write_b32 a152, 0
    v_accvgpr_write_b32 a153, 0
    v_mfma_f32_16x16x32_bf16 v[184:187], v[48:51], v[112:115], v[184:187]
    v_accvgpr_write_b32 a154, 0
    v_accvgpr_write_b32 a155, 0
    v_mfma_f32_16x16x32_bf16 v[184:187], v[52:55], v[116:119], v[184:187]
    v_accvgpr_write_b32 a156, 0
    v_accvgpr_write_b32 a157, 0
    v_mfma_f32_16x16x32_bf16 v[188:191], v[48:51], v[120:123], v[188:191]
    buffer_load_dwordx4 v12, s[20:23], s64 offen offset:2048 lds
    v_mfma_f32_16x16x32_bf16 v[188:191], v[52:55], v[124:127], v[188:191]
    s_waitcnt lgkmcnt(0)
    ds_read_b64_tr_b16 v[48:49], v20 offset:32768
    ds_read_b64_tr_b16 v[50:51], v20 offset:33792
    v_mfma_f32_16x16x32_bf16 v[192:195], v[56:59], v[96:99], v[192:195]
    ds_read_b64_tr_b16 v[52:53], v20 offset:40960
    ds_read_b64_tr_b16 v[54:55], v20 offset:41984
    v_mfma_f32_16x16x32_bf16 v[192:195], v[60:63], v[100:103], v[192:195]
    v_add_u32 v20, 0xffff0000, v20
    v_accvgpr_write_b32 a158, 0
    v_mfma_f32_16x16x32_bf16 v[196:199], v[56:59], v[104:107], v[196:199]
    v_accvgpr_write_b32 a159, 0
    v_mfma_f32_16x16x32_bf16 v[196:199], v[60:63], v[108:111], v[196:199]
    ds_read_b128 v[76:79], v25 offset:57344
    v_mfma_f32_16x16x32_bf16 v[200:203], v[56:59], v[112:115], v[200:203]
    v_accvgpr_read_b32 v32, a160
    v_accvgpr_read_b32 v31, a161
    v_mfma_f32_16x16x32_bf16 v[200:203], v[60:63], v[116:119], v[200:203]
    v_cvt_pk_bf16_f32 v32, v32, v31
    v_accvgpr_read_b32 v33, a162
    v_mfma_f32_16x16x32_bf16 v[204:207], v[56:59], v[120:123], v[204:207]
    ds_read_b64_tr_b16 v[56:57], v21 offset:32768
    ds_read_b64_tr_b16 v[58:59], v21 offset:33792
    v_mfma_f32_16x16x32_bf16 v[204:207], v[60:63], v[124:127], v[204:207]
    ds_read_b64_tr_b16 v[60:61], v21 offset:40960
    ds_read_b64_tr_b16 v[62:63], v21 offset:41984
    v_mfma_f32_16x16x32_bf16 v[208:211], v[40:43], v[96:99], v[208:211]
    buffer_load_dwordx4 v13, s[20:23], s64 offen offset:3072 lds
    v_mfma_f32_16x16x32_bf16 v[208:211], v[44:47], v[100:103], v[208:211]
    v_add_u32 v21, 0xffff0000, v21
    v_accvgpr_read_b32 v31, a163
    v_mfma_f32_16x16x32_bf16 v[212:215], v[40:43], v[104:107], v[212:215]
    v_cvt_pk_bf16_f32 v33, v33, v31
    v_accvgpr_read_b32 v34, a164
    v_mfma_f32_16x16x32_bf16 v[212:215], v[44:47], v[108:111], v[212:215]
    v_accvgpr_read_b32 v31, a165
    v_cvt_pk_bf16_f32 v34, v34, v31
    v_mfma_f32_16x16x32_bf16 v[216:219], v[40:43], v[112:115], v[216:219]
    v_accvgpr_read_b32 v35, a166
    v_accvgpr_read_b32 v31, a167
    v_mfma_f32_16x16x32_bf16 v[216:219], v[44:47], v[116:119], v[216:219]
    v_cvt_pk_bf16_f32 v35, v35, v31
    v_accvgpr_write_b32 a160, 0
    v_mfma_f32_16x16x32_bf16 v[220:223], v[40:43], v[120:123], v[220:223]
    ds_read_b64_tr_b16 v[40:41], v26 offset:0
    ds_read_b64_tr_b16 v[42:43], v26 offset:512
    v_mfma_f32_16x16x32_bf16 v[220:223], v[44:47], v[124:127], v[220:223]
    s_add_u32 s72, s71, 2048
    ds_read_b64_tr_b16 v[44:45], v26 offset:4096
    ds_read_b64_tr_b16 v[46:47], v26 offset:4608
    s_waitcnt lgkmcnt(4)
    v_mfma_f32_16x16x32_bf16 v[224:227], v[48:51], v[96:99], v[224:227]
    v_add_u32 v26, 0xfffe0000, v26
    v_accvgpr_write_b32 a161, 0
    v_mfma_f32_16x16x32_bf16 v[224:227], v[52:55], v[100:103], v[224:227]
    s_xor_b32 s64, s64, 384
    buffer_store_dwordx4 v[32:35], v1, s[36:39], s72 offen sc1
    v_mfma_f32_16x16x32_bf16 v[228:231], v[48:51], v[104:107], v[228:231]
    v_accvgpr_write_b32 a162, 0
    v_accvgpr_write_b32 a163, 0
    v_mfma_f32_16x16x32_bf16 v[228:231], v[52:55], v[108:111], v[228:231]
    v_accvgpr_write_b32 a164, 0
    v_accvgpr_write_b32 a165, 0
    v_mfma_f32_16x16x32_bf16 v[232:235], v[48:51], v[112:115], v[232:235]
    v_accvgpr_write_b32 a166, 0
    v_accvgpr_write_b32 a167, 0
    v_mfma_f32_16x16x32_bf16 v[232:235], v[52:55], v[116:119], v[232:235]
    s_add_u32 m0, s69, 65536
    v_mfma_f32_16x16x32_bf16 v[236:239], v[48:51], v[120:123], v[236:239]
    buffer_load_dwordx4 v2, s[24:27], s60 offen lds
    v_mfma_f32_16x16x32_bf16 v[236:239], v[52:55], v[124:127], v[236:239]
    ds_read_b64_tr_b16 v[48:49], v27 offset:0
    ds_read_b64_tr_b16 v[50:51], v27 offset:512
    v_mfma_f32_16x16x32_bf16 v[240:243], v[56:59], v[96:99], v[240:243]
    ds_read_b64_tr_b16 v[52:53], v27 offset:4096
    ds_read_b64_tr_b16 v[54:55], v27 offset:4608
    v_mfma_f32_16x16x32_bf16 v[240:243], v[60:63], v[100:103], v[240:243]
    buffer_load_dwordx4 v3, s[24:27], s60 offen offset:1024 lds
    v_mfma_f32_16x16x32_bf16 v[244:247], v[56:59], v[104:107], v[244:247]
    v_add_u32 v27, 0xfffe0000, v27
    v_mfma_f32_16x16x32_bf16 v[244:247], v[60:63], v[108:111], v[244:247]
    v_mfma_f32_16x16x32_bf16 v[248:251], v[56:59], v[112:115], v[248:251]
    v_accvgpr_read_b32 v32, a168
    v_accvgpr_read_b32 v31, a169
    v_mfma_f32_16x16x32_bf16 v[248:251], v[60:63], v[116:119], v[248:251]
    buffer_load_dwordx4 v4, s[24:27], s60 offen offset:2048 lds
    v_mfma_f32_16x16x32_bf16 v[252:255], v[56:59], v[120:123], v[252:255]
    ds_read_b64_tr_b16 v[56:57], v28 offset:0
    ds_read_b64_tr_b16 v[58:59], v28 offset:512
    v_mfma_f32_16x16x32_bf16 v[252:255], v[60:63], v[124:127], v[252:255]
    s_waitcnt lgkmcnt(2)
    ds_read_b64_tr_b16 v[60:61], v28 offset:4096
    ds_read_b64_tr_b16 v[62:63], v28 offset:4608
    v_mfma_f32_16x16x32_bf16 a[64:67], v[40:43], v[96:99], a[64:67]
    buffer_load_dwordx4 v5, s[24:27], s60 offen offset:3072 lds
    v_mfma_f32_16x16x32_bf16 a[64:67], v[44:47], v[100:103], a[64:67]
    v_add_u32 v24, 0x10000, v24
    v_add_u32 v28, 0xfffe0000, v28
    v_mfma_f32_16x16x32_bf16 a[68:71], v[40:43], v[104:107], a[68:71]
    ds_read_b128 v[80:83], v24 offset:16384
    v_cvt_pk_bf16_f32 v32, v32, v31
    v_mfma_f32_16x16x32_bf16 a[68:71], v[44:47], v[108:111], a[68:71]
    s_add_u32 m0, s69, 81920
    v_accvgpr_read_b32 v33, a170
    v_accvgpr_read_b32 v31, a171
    v_mfma_f32_16x16x32_bf16 a[72:75], v[40:43], v[112:115], a[72:75]
    s_xor_b32 s60, s60, 1572864
    v_add_u32 v25, 0x10000, v25
    v_cvt_pk_bf16_f32 v33, v33, v31
    v_mfma_f32_16x16x32_bf16 a[72:75], v[44:47], v[116:119], a[72:75]
    buffer_load_dwordx4 v10, s[20:23], s63 offen lds
    v_mfma_f32_16x16x32_bf16 a[76:79], v[40:43], v[120:123], a[76:79]
    ds_read_b128 v[84:87], v25 offset:16384
    ds_read_b64_tr_b16 v[40:41], v29 offset:0
    v_mfma_f32_16x16x32_bf16 a[76:79], v[44:47], v[124:127], a[76:79]
    s_add_u32 s72, s71, 3072
    buffer_load_dwordx4 v11, s[20:23], s63 offen offset:1024 lds
    v_mfma_f32_16x16x32_bf16 a[80:83], v[48:51], v[96:99], a[80:83]
    ds_read_b128 v[88:91], v24 offset:24576
    ds_read_b64_tr_b16 v[42:43], v29 offset:512
    v_mfma_f32_16x16x32_bf16 a[80:83], v[52:55], v[100:103], a[80:83]
    ds_read_b64_tr_b16 v[44:45], v29 offset:4096
    ds_read_b64_tr_b16 v[46:47], v29 offset:4608
    v_mfma_f32_16x16x32_bf16 a[84:87], v[48:51], v[104:107], a[84:87]
    v_add_u32 v29, 0xfffe0000, v29
    v_accvgpr_read_b32 v34, a172
    v_mfma_f32_16x16x32_bf16 a[84:87], v[52:55], v[108:111], a[84:87]
    buffer_load_dwordx4 v12, s[20:23], s63 offen offset:2048 lds
    v_mfma_f32_16x16x32_bf16 a[88:91], v[48:51], v[112:115], a[88:91]
    ds_read_b128 v[92:95], v25 offset:24576
    v_accvgpr_read_b32 v31, a173
    v_mfma_f32_16x16x32_bf16 a[88:91], v[52:55], v[116:119], a[88:91]
    v_cvt_pk_bf16_f32 v34, v34, v31
    v_accvgpr_read_b32 v35, a174
    v_mfma_f32_16x16x32_bf16 a[92:95], v[48:51], v[120:123], a[92:95]
    buffer_load_dwordx4 v13, s[20:23], s63 offen offset:3072 lds
    v_mfma_f32_16x16x32_bf16 a[92:95], v[52:55], v[124:127], a[92:95]
    s_waitcnt lgkmcnt(1)
    v_accvgpr_read_b32 v31, a175
    v_cvt_pk_bf16_f32 v35, v35, v31
    v_mfma_f32_16x16x32_bf16 a[96:99], v[56:59], v[96:99], a[96:99]
    v_accvgpr_write_b32 a168, 0
    v_accvgpr_write_b32 a169, 0
    v_mfma_f32_16x16x32_bf16 a[96:99], v[60:63], v[100:103], a[96:99]
    s_xor_b32 s63, s63, 128
    v_accvgpr_write_b32 a170, 0
    v_accvgpr_write_b32 a171, 0
    v_mfma_f32_16x16x32_bf16 a[100:103], v[56:59], v[104:107], a[100:103]
    buffer_store_dwordx4 v[32:35], v1, s[36:39], s72 offen sc1
    v_mfma_f32_16x16x32_bf16 a[100:103], v[60:63], v[108:111], a[100:103]
    v_accvgpr_write_b32 a172, 0
    v_accvgpr_write_b32 a173, 0
    v_mfma_f32_16x16x32_bf16 a[104:107], v[56:59], v[112:115], a[104:107]
    v_accvgpr_read_b32 v32, a176
    v_accvgpr_read_b32 v31, a177
    v_mfma_f32_16x16x32_bf16 a[104:107], v[60:63], v[116:119], a[104:107]
    s_waitcnt vmcnt(10) lgkmcnt(0)
    s_barrier
    ds_read_b64_tr_b16 v[48:49], v14 offset:0
    v_mfma_f32_16x16x32_bf16 a[108:111], v[56:59], v[120:123], a[108:111]
    s_add_u32 m0, s67, 98304
    ds_read_b64_tr_b16 v[50:51], v14 offset:1024
    ds_read_b64_tr_b16 v[52:53], v14 offset:8192
    v_mfma_f32_16x16x32_bf16 a[108:111], v[60:63], v[124:127], a[108:111]
    buffer_load_dwordx4 v1, s[28:31], s65 offen sc1 lds
    v_mfma_f32_16x16x32_bf16 a[112:115], v[40:43], v[96:99], a[112:115]
    ds_read_b64_tr_b16 v[54:55], v14 offset:9216
    ds_read_b64_tr_b16 v[56:57], v15 offset:0
    v_mfma_f32_16x16x32_bf16 a[112:115], v[44:47], v[100:103], a[112:115]
    ds_read_b64_tr_b16 v[58:59], v15 offset:1024
    ds_read_b64_tr_b16 v[60:61], v15 offset:8192
    v_mfma_f32_16x16x32_bf16 a[116:119], v[40:43], v[104:107], a[116:119]
    ds_read_b64_tr_b16 v[62:63], v15 offset:9216
    v_add_u32 v14, 0x10000, v14
    v_mfma_f32_16x16x32_bf16 a[116:119], v[44:47], v[108:111], a[116:119]
    v_add_u32 v15, 0x10000, v15
    v_cvt_pk_bf16_f32 v32, v32, v31
    v_mfma_f32_16x16x32_bf16 a[120:123], v[40:43], v[112:115], a[120:123]
    v_accvgpr_read_b32 v33, a178
    v_accvgpr_read_b32 v31, a179
    v_mfma_f32_16x16x32_bf16 a[120:123], v[44:47], v[116:119], a[120:123]
    v_cvt_pk_bf16_f32 v33, v33, v31
    v_accvgpr_read_b32 v34, a180
    v_mfma_f32_16x16x32_bf16 a[124:127], v[40:43], v[120:123], a[124:127]
    ds_read_b64_tr_b16 v[40:41], v16 offset:0
    ds_read_b64_tr_b16 v[42:43], v16 offset:1024
    v_mfma_f32_16x16x32_bf16 a[124:127], v[44:47], v[124:127], a[124:127]
    s_add_u32 s72, s71, 34816
    ds_read_b64_tr_b16 v[44:45], v16 offset:8192
    ds_read_b64_tr_b16 v[46:47], v16 offset:9216
    s_waitcnt lgkmcnt(4)
    v_mfma_f32_16x16x32_bf16 v[128:131], v[48:51], v[64:67], v[128:131]
    s_add_u32 s86, s101, 4096
    buffer_load_dwordx4 v1, s[28:31], s65 offen offset:1024 sc1 lds
    v_mfma_f32_16x16x32_bf16 v[128:131], v[52:55], v[68:71], v[128:131]
    s_mov_b32 s87, 3072
    v_add_u32 v24, 0xfffe0000, v24
    v_add_u32 v16, 0x10000, v16
    v_mfma_f32_16x16x32_bf16 v[132:135], v[48:51], v[72:75], v[132:135]
    s_sub_u32 s7, s101, 4096
    ds_read_b128 v[96:99], v24 offset:16384
    v_accvgpr_read_b32 v31, a181
    v_mfma_f32_16x16x32_bf16 v[132:135], v[52:55], v[76:79], v[132:135]
    s_mov_b32 s98, 0
    v_cvt_pk_bf16_f32 v34, v34, v31
    v_accvgpr_read_b32 v35, a182
    v_mfma_f32_16x16x32_bf16 v[136:139], v[48:51], v[80:83], v[136:139]
    s_mul_i32 s84, s101, 48
    v_accvgpr_read_b32 v31, a183
    v_cvt_pk_bf16_f32 v35, v35, v31
    v_mfma_f32_16x16x32_bf16 v[136:139], v[52:55], v[84:87], v[136:139]
    s_add_u32 s84, s84, 19922944
    buffer_store_dwordx4 v[32:35], v1, s[36:39], s72 offen sc1
    v_mfma_f32_16x16x32_bf16 v[140:143], v[48:51], v[88:91], v[140:143]
    s_mov_b32 s42, 21495808
    ds_read_b64_tr_b16 v[48:49], v17 offset:0
    ds_read_b64_tr_b16 v[50:51], v17 offset:1024
    v_mfma_f32_16x16x32_bf16 v[140:143], v[52:55], v[92:95], v[140:143]
    s_mov_b32 s43, 0x20000
    ds_read_b64_tr_b16 v[52:53], v17 offset:8192
    ds_read_b64_tr_b16 v[54:55], v17 offset:9216
    v_mfma_f32_16x16x32_bf16 v[144:147], v[56:59], v[64:67], v[144:147]
    v_add_u32 v17, 0x10000, v17
    v_accvgpr_write_b32 a174, 0
    v_mfma_f32_16x16x32_bf16 v[144:147], v[60:63], v[68:71], v[144:147]
    s_add_u32 m0, s69, 114688
    v_accvgpr_write_b32 a175, 0
    v_accvgpr_write_b32 a176, 0
    v_mfma_f32_16x16x32_bf16 v[148:151], v[56:59], v[72:75], v[148:151]
    s_xor_b32 s65, s65, 24576
    buffer_load_dwordx4 v10, s[20:23], s64 offen lds
    v_mfma_f32_16x16x32_bf16 v[148:151], v[60:63], v[76:79], v[148:151]
    s_cmp_eq_u32 s6, 7
    s_cselect_b32 s86, s101, s86
    s_cselect_b32 s87, 0, s87
    v_mfma_f32_16x16x32_bf16 v[152:155], v[56:59], v[80:83], v[152:155]
    v_add_u32 v25, 0xfffe0000, v25
    v_accvgpr_read_b32 v32, a184
    v_mfma_f32_16x16x32_bf16 v[152:155], v[60:63], v[84:87], v[152:155]
    ds_read_b128 v[100:103], v25 offset:16384
    v_accvgpr_read_b32 v31, a185
    v_mfma_f32_16x16x32_bf16 v[156:159], v[56:59], v[88:91], v[156:159]
    ds_read_b64_tr_b16 v[56:57], v18 offset:0
    ds_read_b64_tr_b16 v[58:59], v18 offset:1024
    v_mfma_f32_16x16x32_bf16 v[156:159], v[60:63], v[92:95], v[156:159]
    s_waitcnt lgkmcnt(3)
    ds_read_b64_tr_b16 v[60:61], v18 offset:8192
    ds_read_b64_tr_b16 v[62:63], v18 offset:9216
    v_mfma_f32_16x16x32_bf16 v[160:163], v[40:43], v[64:67], v[160:163]
    v_add_u32 v18, 0x10000, v18
    v_cvt_pk_bf16_f32 v32, v32, v31
    v_mfma_f32_16x16x32_bf16 v[160:163], v[44:47], v[68:71], v[160:163]
    v_accvgpr_read_b32 v33, a186
    v_accvgpr_read_b32 v31, a187
    v_mfma_f32_16x16x32_bf16 v[164:167], v[40:43], v[72:75], v[164:167]
    v_cvt_pk_bf16_f32 v33, v33, v31
    v_accvgpr_read_b32 v34, a188
    v_mfma_f32_16x16x32_bf16 v[164:167], v[44:47], v[76:79], v[164:167]
    v_accvgpr_read_b32 v31, a189
    v_cvt_pk_bf16_f32 v34, v34, v31
    v_mfma_f32_16x16x32_bf16 v[168:171], v[40:43], v[80:83], v[168:171]
    buffer_load_dwordx4 v11, s[20:23], s64 offen offset:1024 lds
    v_mfma_f32_16x16x32_bf16 v[168:171], v[44:47], v[84:87], v[168:171]
    v_accvgpr_read_b32 v35, a190
    v_accvgpr_read_b32 v31, a191
    v_mfma_f32_16x16x32_bf16 v[172:175], v[40:43], v[88:91], v[172:175]
    ds_read_b64_tr_b16 v[40:41], v19 offset:0
    ds_read_b64_tr_b16 v[42:43], v19 offset:1024
    v_mfma_f32_16x16x32_bf16 v[172:175], v[44:47], v[92:95], v[172:175]
    s_add_u32 s72, s71, 35840
    ds_read_b64_tr_b16 v[44:45], v19 offset:8192
    ds_read_b64_tr_b16 v[46:47], v19 offset:9216
    v_mfma_f32_16x16x32_bf16 v[176:179], v[48:51], v[64:67], v[176:179]
    ds_read_b128 v[104:107], v24 offset:24576
    v_add_u32 v19, 0x10000, v19
    v_mfma_f32_16x16x32_bf16 v[176:179], v[52:55], v[68:71], v[176:179]
    v_cvt_pk_bf16_f32 v35, v35, v31
    v_accvgpr_write_b32 a177, 0
    v_mfma_f32_16x16x32_bf16 v[180:183], v[48:51], v[72:75], v[180:183]
    buffer_store_dwordx4 v[32:35], v1, s[36:39], s72 offen sc1
    v_mfma_f32_16x16x32_bf16 v[180:183], v[52:55], v[76:79], v[180:183]
    s_cmp_eq_u32 s6, 0
    s_cselect_b32 s7, s101, s7
    s_cselect_b32 s98, 1073741824, s98
    v_mfma_f32_16x16x32_bf16 v[184:187], v[48:51], v[80:83], v[184:187]
    s_bitcmp1_b32 s4, 0
    s_cselect_b32 s86, s86, s7
    s_cselect_b32 s87, s87, s98
    v_mfma_f32_16x16x32_bf16 v[184:187], v[52:55], v[84:87], v[184:187]
    s_mul_i32 s7, s86, 48
    v_accvgpr_write_b32 a178, 0
    v_accvgpr_write_b32 a179, 0
    v_mfma_f32_16x16x32_bf16 v[188:191], v[48:51], v[88:91], v[188:191]
    s_add_u32 s87, s87, s7
    buffer_load_dwordx4 v12, s[20:23], s64 offen offset:2048 lds
    v_mfma_f32_16x16x32_bf16 v[188:191], v[52:55], v[92:95], v[188:191]
    s_and_b32 s7, s5, 24
    ds_read_b64_tr_b16 v[48:49], v20 offset:0
    ds_read_b64_tr_b16 v[50:51], v20 offset:1024
    s_waitcnt lgkmcnt(2)
    v_mfma_f32_16x16x32_bf16 v[192:195], v[56:59], v[64:67], v[192:195]
    s_add_u32 s7, s7, s6
    ds_read_b64_tr_b16 v[52:53], v20 offset:8192
    ds_read_b64_tr_b16 v[54:55], v20 offset:9216
    v_mfma_f32_16x16x32_bf16 v[192:195], v[60:63], v[68:71], v[192:195]
    s_bfe_u32 s98, s5, 0x20001
    v_add_u32 v20, 0x10000, v20
    v_accvgpr_write_b32 a180, 0
    v_mfma_f32_16x16x32_bf16 v[196:199], v[56:59], v[72:75], v[196:199]
    s_lshl2_add_u32 s7, s7, s98
    v_accvgpr_write_b32 a181, 0
    v_accvgpr_write_b32 a182, 0
    v_mfma_f32_16x16x32_bf16 v[196:199], v[60:63], v[76:79], v[196:199]
    s_mul_i32 s98, s7, 36864
    ds_read_b128 v[108:111], v25 offset:24576
    v_add_u32 v36, s98, v36
    v_mfma_f32_16x16x32_bf16 v[200:203], v[56:59], v[80:83], v[200:203]
    s_mul_hi_u32 s98, s8, 715827883
    v_accvgpr_read_b32 v32, a192
    v_accvgpr_read_b32 v31, a193
    v_mfma_f32_16x16x32_bf16 v[200:203], v[60:63], v[84:87], v[200:203]
    s_add_u32 s87, s87, 19922944
    v_cvt_pk_bf16_f32 v32, v32, v31
    v_accvgpr_read_b32 v33, a194
    v_mfma_f32_16x16x32_bf16 v[204:207], v[56:59], v[88:91], v[204:207]
    ds_read_b64_tr_b16 v[56:57], v21 offset:0
    ds_read_b64_tr_b16 v[58:59], v21 offset:1024
    v_mfma_f32_16x16x32_bf16 v[204:207], v[60:63], v[92:95], v[204:207]
    ds_read_b64_tr_b16 v[60:61], v21 offset:8192
    ds_read_b64_tr_b16 v[62:63], v21 offset:9216
    v_mfma_f32_16x16x32_bf16 v[208:211], v[40:43], v[64:67], v[208:211]
    buffer_load_dwordx4 v13, s[20:23], s64 offen offset:3072 lds
    v_mfma_f32_16x16x32_bf16 v[208:211], v[44:47], v[68:71], v[208:211]
    v_add_u32 v21, 0x10000, v21
    v_accvgpr_read_b32 v31, a195
    v_mfma_f32_16x16x32_bf16 v[212:215], v[40:43], v[72:75], v[212:215]
    v_cvt_pk_bf16_f32 v33, v33, v31
    v_accvgpr_read_b32 v34, a196
    v_mfma_f32_16x16x32_bf16 v[212:215], v[44:47], v[76:79], v[212:215]
    v_accvgpr_read_b32 v31, a197
    v_cvt_pk_bf16_f32 v34, v34, v31
    v_mfma_f32_16x16x32_bf16 v[216:219], v[40:43], v[80:83], v[216:219]
    v_accvgpr_read_b32 v35, a198
    v_accvgpr_read_b32 v31, a199
    v_mfma_f32_16x16x32_bf16 v[216:219], v[44:47], v[84:87], v[216:219]
    v_cvt_pk_bf16_f32 v35, v35, v31
    v_sub_u32 v39, v36, v39
    v_mfma_f32_16x16x32_bf16 v[220:223], v[40:43], v[88:91], v[220:223]
    ds_read_b64_tr_b16 v[40:41], v26 offset:32768
    ds_read_b64_tr_b16 v[42:43], v26 offset:33280
    v_mfma_f32_16x16x32_bf16 v[220:223], v[44:47], v[92:95], v[220:223]
    s_add_u32 s72, s71, 4096
    ds_read_b64_tr_b16 v[44:45], v26 offset:36864
    ds_read_b64_tr_b16 v[46:47], v26 offset:37376
    s_waitcnt lgkmcnt(4)
    v_mfma_f32_16x16x32_bf16 v[224:227], v[48:51], v[64:67], v[224:227]
    v_add_u32 v26, 0x10000, v26
    v_lshl_add_u32 v36, s100, 6, v36
    v_mfma_f32_16x16x32_bf16 v[224:227], v[52:55], v[68:71], v[224:227]
    s_xor_b32 s64, s64, 128
    buffer_store_dwordx4 v[32:35], v1, s[36:39], s72 offen sc1
    v_mfma_f32_16x16x32_bf16 v[228:231], v[48:51], v[72:75], v[228:231]
    s_cmp_eq_u32 s4, 3
    s_cselect_b32 s84, s84, 1073741824
    v_accvgpr_write_b32 a183, 0
    v_mfma_f32_16x16x32_bf16 v[228:231], v[52:55], v[76:79], v[228:231]
    s_sub_u32 s40, s56, 22020096
    s_subb_u32 s41, s57, 0
    v_accvgpr_write_b32 a184, 0
    v_mfma_f32_16x16x32_bf16 v[232:235], v[48:51], v[80:83], v[232:235]
    s_add_u32 s85, s84, 3072
    v_accvgpr_write_b32 a185, 0
    v_accvgpr_write_b32 a186, 0
    v_mfma_f32_16x16x32_bf16 v[232:235], v[52:55], v[84:87], v[232:235]
    s_add_u32 m0, s69, 131072
    v_accvgpr_write_b32 a187, 0
    v_accvgpr_write_b32 a188, 0
    v_mfma_f32_16x16x32_bf16 v[236:239], v[48:51], v[88:91], v[236:239]
    buffer_load_dwordx4 v2, s[24:27], s60 offen lds
    v_mfma_f32_16x16x32_bf16 v[236:239], v[52:55], v[92:95], v[236:239]
    ds_read_b64_tr_b16 v[48:49], v27 offset:32768
    ds_read_b64_tr_b16 v[50:51], v27 offset:33280
    v_mfma_f32_16x16x32_bf16 v[240:243], v[56:59], v[64:67], v[240:243]
    ds_read_b64_tr_b16 v[52:53], v27 offset:36864
    ds_read_b64_tr_b16 v[54:55], v27 offset:37376
    v_mfma_f32_16x16x32_bf16 v[240:243], v[60:63], v[68:71], v[240:243]
    buffer_load_dwordx4 v3, s[24:27], s60 offen offset:1024 lds
    v_mfma_f32_16x16x32_bf16 v[244:247], v[56:59], v[72:75], v[244:247]
    v_add_u32 v27, 0x10000, v27
    v_accvgpr_write_b32 a189, 0
    v_mfma_f32_16x16x32_bf16 v[244:247], v[60:63], v[76:79], v[244:247]
    v_accvgpr_write_b32 a190, 0
    v_accvgpr_write_b32 a191, 0
    v_mfma_f32_16x16x32_bf16 v[248:251], v[56:59], v[80:83], v[248:251]
    v_accvgpr_read_b32 v32, a200
    v_accvgpr_read_b32 v31, a201
    v_mfma_f32_16x16x32_bf16 v[248:251], v[60:63], v[84:87], v[248:251]
    buffer_load_dwordx4 v4, s[24:27], s60 offen offset:2048 lds
    v_mfma_f32_16x16x32_bf16 v[252:255], v[56:59], v[88:91], v[252:255]
    ds_read_b64_tr_b16 v[56:57], v28 offset:32768
    ds_read_b64_tr_b16 v[58:59], v28 offset:33280
    v_mfma_f32_16x16x32_bf16 v[252:255], v[60:63], v[92:95], v[252:255]
    s_waitcnt lgkmcnt(2)
    ds_read_b64_tr_b16 v[60:61], v28 offset:36864
    ds_read_b64_tr_b16 v[62:63], v28 offset:37376
    v_mfma_f32_16x16x32_bf16 a[64:67], v[40:43], v[64:67], a[64:67]
    buffer_load_dwordx4 v5, s[24:27], s60 offen offset:3072 lds
    v_mfma_f32_16x16x32_bf16 a[64:67], v[44:47], v[68:71], a[64:67]
    v_add_u32 v28, 0x10000, v28
    v_cvt_pk_bf16_f32 v32, v32, v31
    v_mfma_f32_16x16x32_bf16 a[68:71], v[40:43], v[72:75], a[68:71]
    ds_read_b128 v[112:115], v24 offset:49152
    v_accvgpr_read_b32 v33, a202
    v_mfma_f32_16x16x32_bf16 a[68:71], v[44:47], v[76:79], a[68:71]
    s_add_u32 m0, s69, 147456
    v_accvgpr_read_b32 v31, a203
    v_cvt_pk_bf16_f32 v33, v33, v31
    v_mfma_f32_16x16x32_bf16 a[72:75], v[40:43], v[80:83], a[72:75]
    s_xor_b32 s60, s60, 524288
    buffer_load_dwordx4 v10, s[20:23], s63 offen lds
    v_mfma_f32_16x16x32_bf16 a[72:75], v[44:47], v[84:87], a[72:75]
    ds_read_b128 v[116:119], v25 offset:49152
    v_accvgpr_read_b32 v34, a204
    v_mfma_f32_16x16x32_bf16 a[76:79], v[40:43], v[88:91], a[76:79]
    ds_read_b64_tr_b16 v[40:41], v29 offset:32768
    ds_read_b64_tr_b16 v[42:43], v29 offset:33280
    v_mfma_f32_16x16x32_bf16 a[76:79], v[44:47], v[92:95], a[76:79]
    s_add_u32 s72, s71, 5120
    buffer_load_dwordx4 v11, s[20:23], s63 offen offset:1024 lds
    v_mfma_f32_16x16x32_bf16 a[80:83], v[48:51], v[64:67], a[80:83]
    ds_read_b128 v[120:123], v24 offset:57344
    ds_read_b64_tr_b16 v[44:45], v29 offset:36864
    v_mfma_f32_16x16x32_bf16 a[80:83], v[52:55], v[68:71], a[80:83]
    ds_read_b64_tr_b16 v[46:47], v29 offset:37376
    v_add_u32 v29, 0x10000, v29
    v_mfma_f32_16x16x32_bf16 a[84:87], v[48:51], v[72:75], a[84:87]
    v_accvgpr_read_b32 v31, a205
    v_cvt_pk_bf16_f32 v34, v34, v31
    v_mfma_f32_16x16x32_bf16 a[84:87], v[52:55], v[76:79], a[84:87]
    buffer_load_dwordx4 v12, s[20:23], s63 offen offset:2048 lds
    v_mfma_f32_16x16x32_bf16 a[88:91], v[48:51], v[80:83], a[88:91]
    ds_read_b128 v[124:127], v25 offset:57344
    v_accvgpr_read_b32 v35, a206
    v_mfma_f32_16x16x32_bf16 a[88:91], v[52:55], v[84:87], a[88:91]
    v_accvgpr_read_b32 v31, a207
    v_cvt_pk_bf16_f32 v35, v35, v31
    v_mfma_f32_16x16x32_bf16 a[92:95], v[48:51], v[88:91], a[92:95]
    buffer_load_dwordx4 v13, s[20:23], s63 offen offset:3072 lds
    v_mfma_f32_16x16x32_bf16 a[92:95], v[52:55], v[92:95], a[92:95]
    s_waitcnt lgkmcnt(1)
    v_accvgpr_write_b32 a192, 0
    v_accvgpr_write_b32 a193, 0
    v_mfma_f32_16x16x32_bf16 a[96:99], v[56:59], v[64:67], a[96:99]
    v_accvgpr_write_b32 a194, 0
    v_accvgpr_write_b32 a195, 0
    v_mfma_f32_16x16x32_bf16 a[96:99], v[60:63], v[68:71], a[96:99]
    s_xor_b32 s63, s63, 1920
    v_accvgpr_write_b32 a196, 0
    v_accvgpr_write_b32 a197, 0
    v_mfma_f32_16x16x32_bf16 a[100:103], v[56:59], v[72:75], a[100:103]
    s_andn2_b32 s63, s63, 896
    buffer_store_dwordx4 v[32:35], v1, s[36:39], s72 offen sc1
    v_mfma_f32_16x16x32_bf16 a[100:103], v[60:63], v[76:79], a[100:103]
    v_accvgpr_write_b32 a198, 0
    v_accvgpr_write_b32 a199, 0
    v_mfma_f32_16x16x32_bf16 a[104:107], v[56:59], v[80:83], a[104:107]
    v_accvgpr_read_b32 v32, a208
    v_accvgpr_read_b32 v31, a209
    v_mfma_f32_16x16x32_bf16 a[104:107], v[60:63], v[84:87], a[104:107]
    s_waitcnt vmcnt(10) lgkmcnt(0)
    s_barrier
    ds_read_b64_tr_b16 v[48:49], v14 offset:0
    v_mfma_f32_16x16x32_bf16 a[108:111], v[56:59], v[88:91], a[108:111]
    s_add_u32 m0, s67, 0
    ds_read_b64_tr_b16 v[50:51], v14 offset:1024
    ds_read_b64_tr_b16 v[52:53], v14 offset:8192
    v_mfma_f32_16x16x32_bf16 a[108:111], v[60:63], v[92:95], a[108:111]
    buffer_load_dwordx4 v1, s[28:31], s65 offen sc1 lds
    v_mfma_f32_16x16x32_bf16 a[112:115], v[40:43], v[64:67], a[112:115]
    ds_read_b64_tr_b16 v[54:55], v14 offset:9216
    ds_read_b64_tr_b16 v[56:57], v15 offset:0
    v_mfma_f32_16x16x32_bf16 a[112:115], v[44:47], v[68:71], a[112:115]
    ds_read_b64_tr_b16 v[58:59], v15 offset:1024
    ds_read_b64_tr_b16 v[60:61], v15 offset:8192
    v_mfma_f32_16x16x32_bf16 a[116:119], v[40:43], v[72:75], a[116:119]
    ds_read_b64_tr_b16 v[62:63], v15 offset:9216
    v_add_u32 v14, 0x10000, v14
    v_mfma_f32_16x16x32_bf16 a[116:119], v[44:47], v[76:79], a[116:119]
    v_add_u32 v15, 0x10000, v15
    v_cvt_pk_bf16_f32 v32, v32, v31
    v_mfma_f32_16x16x32_bf16 a[120:123], v[40:43], v[80:83], a[120:123]
    v_accvgpr_read_b32 v33, a210
    v_accvgpr_read_b32 v31, a211
    v_mfma_f32_16x16x32_bf16 a[120:123], v[44:47], v[84:87], a[120:123]
    v_cvt_pk_bf16_f32 v33, v33, v31
    v_accvgpr_read_b32 v34, a212
    v_mfma_f32_16x16x32_bf16 a[124:127], v[40:43], v[88:91], a[124:127]
    ds_read_b64_tr_b16 v[40:41], v16 offset:0
    ds_read_b64_tr_b16 v[42:43], v16 offset:1024
    v_mfma_f32_16x16x32_bf16 a[124:127], v[44:47], v[92:95], a[124:127]
    s_add_u32 s72, s71, 36864
    ds_read_b64_tr_b16 v[44:45], v16 offset:8192
    ds_read_b64_tr_b16 v[46:47], v16 offset:9216
    s_waitcnt lgkmcnt(4)
    v_mfma_f32_16x16x32_bf16 v[128:131], v[48:51], v[96:99], v[128:131]
    buffer_load_dwordx4 v1, s[28:31], s65 offen offset:1024 sc1 lds
    v_mfma_f32_16x16x32_bf16 v[128:131], v[52:55], v[100:103], v[128:131]
    v_add_u32 v24, 0x10000, v24
    v_add_u32 v16, 0x10000, v16
    v_mfma_f32_16x16x32_bf16 v[132:135], v[48:51], v[104:107], v[132:135]
    ds_read_b128 v[64:67], v24 offset:16384
    v_accvgpr_read_b32 v31, a213
    v_mfma_f32_16x16x32_bf16 v[132:135], v[52:55], v[108:111], v[132:135]
    v_cvt_pk_bf16_f32 v34, v34, v31
    v_accvgpr_read_b32 v35, a214
    v_mfma_f32_16x16x32_bf16 v[136:139], v[48:51], v[112:115], v[136:139]
    v_accvgpr_read_b32 v31, a215
    v_cvt_pk_bf16_f32 v35, v35, v31
    v_mfma_f32_16x16x32_bf16 v[136:139], v[52:55], v[116:119], v[136:139]
    buffer_store_dwordx4 v[32:35], v1, s[36:39], s72 offen sc1
    v_mfma_f32_16x16x32_bf16 v[140:143], v[48:51], v[120:123], v[140:143]
    ds_read_b64_tr_b16 v[48:49], v17 offset:0
    ds_read_b64_tr_b16 v[50:51], v17 offset:1024
    v_mfma_f32_16x16x32_bf16 v[140:143], v[52:55], v[124:127], v[140:143]
    ds_read_b64_tr_b16 v[52:53], v17 offset:8192
    ds_read_b64_tr_b16 v[54:55], v17 offset:9216
    v_mfma_f32_16x16x32_bf16 v[144:147], v[56:59], v[96:99], v[144:147]
    v_add_u32 v17, 0x10000, v17
    v_accvgpr_write_b32 a200, 0
    v_mfma_f32_16x16x32_bf16 v[144:147], v[60:63], v[100:103], v[144:147]
    s_add_u32 m0, s69, 16384
    v_accvgpr_write_b32 a201, 0
    v_accvgpr_write_b32 a202, 0
    v_mfma_f32_16x16x32_bf16 v[148:151], v[56:59], v[104:107], v[148:151]
    s_xor_b32 s65, s65, 8192
    buffer_load_dwordx4 v10, s[20:23], s64 offen lds
    v_mfma_f32_16x16x32_bf16 v[148:151], v[60:63], v[108:111], v[148:151]
    v_accvgpr_write_b32 a203, 0
    v_accvgpr_write_b32 a204, 0
    v_mfma_f32_16x16x32_bf16 v[152:155], v[56:59], v[112:115], v[152:155]
    v_add_u32 v25, 0x10000, v25
    v_accvgpr_read_b32 v32, a216
    v_mfma_f32_16x16x32_bf16 v[152:155], v[60:63], v[116:119], v[152:155]
    ds_read_b128 v[68:71], v25 offset:16384
    v_accvgpr_read_b32 v31, a217
    v_mfma_f32_16x16x32_bf16 v[156:159], v[56:59], v[120:123], v[156:159]
    ds_read_b64_tr_b16 v[56:57], v18 offset:0
    ds_read_b64_tr_b16 v[58:59], v18 offset:1024
    v_mfma_f32_16x16x32_bf16 v[156:159], v[60:63], v[124:127], v[156:159]
    s_waitcnt lgkmcnt(3)
    ds_read_b64_tr_b16 v[60:61], v18 offset:8192
    ds_read_b64_tr_b16 v[62:63], v18 offset:9216
    v_mfma_f32_16x16x32_bf16 v[160:163], v[40:43], v[96:99], v[160:163]
    v_add_u32 v18, 0x10000, v18
    v_cvt_pk_bf16_f32 v32, v32, v31
    v_mfma_f32_16x16x32_bf16 v[160:163], v[44:47], v[100:103], v[160:163]
    v_accvgpr_read_b32 v33, a218
    v_accvgpr_read_b32 v31, a219
    v_mfma_f32_16x16x32_bf16 v[164:167], v[40:43], v[104:107], v[164:167]
    v_cvt_pk_bf16_f32 v33, v33, v31
    v_accvgpr_read_b32 v34, a220
    v_mfma_f32_16x16x32_bf16 v[164:167], v[44:47], v[108:111], v[164:167]
    v_accvgpr_read_b32 v31, a221
    v_cvt_pk_bf16_f32 v34, v34, v31
    v_mfma_f32_16x16x32_bf16 v[168:171], v[40:43], v[112:115], v[168:171]
    buffer_load_dwordx4 v11, s[20:23], s64 offen offset:1024 lds
    v_mfma_f32_16x16x32_bf16 v[168:171], v[44:47], v[116:119], v[168:171]
    v_accvgpr_read_b32 v35, a222
    v_accvgpr_read_b32 v31, a223
    v_mfma_f32_16x16x32_bf16 v[172:175], v[40:43], v[120:123], v[172:175]
    ds_read_b64_tr_b16 v[40:41], v19 offset:0
    ds_read_b64_tr_b16 v[42:43], v19 offset:1024
    v_mfma_f32_16x16x32_bf16 v[172:175], v[44:47], v[124:127], v[172:175]
    s_add_u32 s72, s71, 37888
    ds_read_b64_tr_b16 v[44:45], v19 offset:8192
    ds_read_b64_tr_b16 v[46:47], v19 offset:9216
    v_mfma_f32_16x16x32_bf16 v[176:179], v[48:51], v[96:99], v[176:179]
    ds_read_b128 v[72:75], v24 offset:24576
    v_add_u32 v19, 0x10000, v19
    v_mfma_f32_16x16x32_bf16 v[176:179], v[52:55], v[100:103], v[176:179]
    v_cvt_pk_bf16_f32 v35, v35, v31
    v_accvgpr_write_b32 a205, 0
    v_mfma_f32_16x16x32_bf16 v[180:183], v[48:51], v[104:107], v[180:183]
    buffer_store_dwordx4 v[32:35], v1, s[36:39], s72 offen sc1
    v_mfma_f32_16x16x32_bf16 v[180:183], v[52:55], v[108:111], v[180:183]
    v_accvgpr_write_b32 a206, 0
    v_accvgpr_write_b32 a207, 0
    v_mfma_f32_16x16x32_bf16 v[184:187], v[48:51], v[112:115], v[184:187]
    v_accvgpr_write_b32 a208, 0
    v_accvgpr_write_b32 a209, 0
    v_mfma_f32_16x16x32_bf16 v[184:187], v[52:55], v[116:119], v[184:187]
    v_accvgpr_write_b32 a210, 0
    v_accvgpr_write_b32 a211, 0
    v_mfma_f32_16x16x32_bf16 v[188:191], v[48:51], v[120:123], v[188:191]
    buffer_load_dwordx4 v12, s[20:23], s64 offen offset:2048 lds
    v_mfma_f32_16x16x32_bf16 v[188:191], v[52:55], v[124:127], v[188:191]
    s_waitcnt lgkmcnt(0)
    ds_read_b64_tr_b16 v[48:49], v20 offset:0
    ds_read_b64_tr_b16 v[50:51], v20 offset:1024
    v_mfma_f32_16x16x32_bf16 v[192:195], v[56:59], v[96:99], v[192:195]
    ds_read_b64_tr_b16 v[52:53], v20 offset:8192
    ds_read_b64_tr_b16 v[54:55], v20 offset:9216
    v_mfma_f32_16x16x32_bf16 v[192:195], v[60:63], v[100:103], v[192:195]
    v_add_u32 v20, 0x10000, v20
    v_accvgpr_write_b32 a212, 0
    v_mfma_f32_16x16x32_bf16 v[196:199], v[56:59], v[104:107], v[196:199]
    v_accvgpr_write_b32 a213, 0
    v_accvgpr_write_b32 a214, 0
    v_mfma_f32_16x16x32_bf16 v[196:199], v[60:63], v[108:111], v[196:199]
    ds_read_b128 v[76:79], v25 offset:24576
    v_accvgpr_write_b32 a215, 0
    v_mfma_f32_16x16x32_bf16 v[200:203], v[56:59], v[112:115], v[200:203]
    v_accvgpr_read_b32 v32, a224
    v_accvgpr_read_b32 v31, a225
    v_mfma_f32_16x16x32_bf16 v[200:203], v[60:63], v[116:119], v[200:203]
    v_cvt_pk_bf16_f32 v32, v32, v31
    v_accvgpr_read_b32 v33, a226
    v_mfma_f32_16x16x32_bf16 v[204:207], v[56:59], v[120:123], v[204:207]
    ds_read_b64_tr_b16 v[56:57], v21 offset:0
    ds_read_b64_tr_b16 v[58:59], v21 offset:1024
    v_mfma_f32_16x16x32_bf16 v[204:207], v[60:63], v[124:127], v[204:207]
    ds_read_b64_tr_b16 v[60:61], v21 offset:8192
    ds_read_b64_tr_b16 v[62:63], v21 offset:9216
    v_mfma_f32_16x16x32_bf16 v[208:211], v[40:43], v[96:99], v[208:211]
    buffer_load_dwordx4 v13, s[20:23], s64 offen offset:3072 lds
    v_mfma_f32_16x16x32_bf16 v[208:211], v[44:47], v[100:103], v[208:211]
    v_add_u32 v21, 0x10000, v21
    v_accvgpr_read_b32 v31, a227
    v_mfma_f32_16x16x32_bf16 v[212:215], v[40:43], v[104:107], v[212:215]
    v_cvt_pk_bf16_f32 v33, v33, v31
    v_accvgpr_read_b32 v34, a228
    v_mfma_f32_16x16x32_bf16 v[212:215], v[44:47], v[108:111], v[212:215]
    v_accvgpr_read_b32 v31, a229
    v_cvt_pk_bf16_f32 v34, v34, v31
    v_mfma_f32_16x16x32_bf16 v[216:219], v[40:43], v[112:115], v[216:219]
    v_accvgpr_read_b32 v35, a230
    v_accvgpr_read_b32 v31, a231
    v_mfma_f32_16x16x32_bf16 v[216:219], v[44:47], v[116:119], v[216:219]
    v_cvt_pk_bf16_f32 v35, v35, v31
    v_accvgpr_write_b32 a216, 0
    v_mfma_f32_16x16x32_bf16 v[220:223], v[40:43], v[120:123], v[220:223]
    ds_read_b64_tr_b16 v[40:41], v26 offset:32768
    ds_read_b64_tr_b16 v[42:43], v26 offset:33280
    v_mfma_f32_16x16x32_bf16 v[220:223], v[44:47], v[124:127], v[220:223]
    s_add_u32 s72, s71, 6144
    ds_read_b64_tr_b16 v[44:45], v26 offset:36864
    ds_read_b64_tr_b16 v[46:47], v26 offset:37376
    s_waitcnt lgkmcnt(4)
    v_mfma_f32_16x16x32_bf16 v[224:227], v[48:51], v[96:99], v[224:227]
    v_add_u32 v26, 0xffff0000, v26
    v_accvgpr_write_b32 a217, 0
    v_mfma_f32_16x16x32_bf16 v[224:227], v[52:55], v[100:103], v[224:227]
    s_xor_b32 s64, s64, 1920
    buffer_store_dwordx4 v[32:35], v1, s[36:39], s72 offen sc1
    v_mfma_f32_16x16x32_bf16 v[228:231], v[48:51], v[104:107], v[228:231]
    s_andn2_b32 s64, s64, 896
    v_accvgpr_write_b32 a218, 0
    v_accvgpr_write_b32 a219, 0
    v_mfma_f32_16x16x32_bf16 v[228:231], v[52:55], v[108:111], v[228:231]
    v_accvgpr_write_b32 a220, 0
    v_accvgpr_write_b32 a221, 0
    v_mfma_f32_16x16x32_bf16 v[232:235], v[48:51], v[112:115], v[232:235]
    v_accvgpr_write_b32 a222, 0
    v_accvgpr_write_b32 a223, 0
    v_mfma_f32_16x16x32_bf16 v[232:235], v[52:55], v[116:119], v[232:235]
    s_add_u32 m0, s69, 32768
    v_mfma_f32_16x16x32_bf16 v[236:239], v[48:51], v[120:123], v[236:239]
    buffer_load_dwordx4 v2, s[24:27], s60 offen lds
    v_mfma_f32_16x16x32_bf16 v[236:239], v[52:55], v[124:127], v[236:239]
    ds_read_b64_tr_b16 v[48:49], v27 offset:32768
    ds_read_b64_tr_b16 v[50:51], v27 offset:33280
    v_mfma_f32_16x16x32_bf16 v[240:243], v[56:59], v[96:99], v[240:243]
    ds_read_b64_tr_b16 v[52:53], v27 offset:36864
    ds_read_b64_tr_b16 v[54:55], v27 offset:37376
    v_mfma_f32_16x16x32_bf16 v[240:243], v[60:63], v[100:103], v[240:243]
    buffer_load_dwordx4 v3, s[24:27], s60 offen offset:1024 lds
    v_mfma_f32_16x16x32_bf16 v[244:247], v[56:59], v[104:107], v[244:247]
    v_add_u32 v27, 0xffff0000, v27
    v_mfma_f32_16x16x32_bf16 v[244:247], v[60:63], v[108:111], v[244:247]
    v_mfma_f32_16x16x32_bf16 v[248:251], v[56:59], v[112:115], v[248:251]
    v_accvgpr_read_b32 v32, a232
    v_accvgpr_read_b32 v31, a233
    v_mfma_f32_16x16x32_bf16 v[248:251], v[60:63], v[116:119], v[248:251]
    buffer_load_dwordx4 v4, s[24:27], s60 offen offset:2048 lds
    v_mfma_f32_16x16x32_bf16 v[252:255], v[56:59], v[120:123], v[252:255]
    ds_read_b64_tr_b16 v[56:57], v28 offset:32768
    ds_read_b64_tr_b16 v[58:59], v28 offset:33280
    v_mfma_f32_16x16x32_bf16 v[252:255], v[60:63], v[124:127], v[252:255]
    s_waitcnt lgkmcnt(2)
    ds_read_b64_tr_b16 v[60:61], v28 offset:36864
    ds_read_b64_tr_b16 v[62:63], v28 offset:37376
    v_mfma_f32_16x16x32_bf16 a[64:67], v[40:43], v[96:99], a[64:67]
    buffer_load_dwordx4 v5, s[24:27], s60 offen offset:3072 lds
    v_mfma_f32_16x16x32_bf16 a[64:67], v[44:47], v[100:103], a[64:67]
    v_add_u32 v28, 0xffff0000, v28
    v_cvt_pk_bf16_f32 v32, v32, v31
    v_mfma_f32_16x16x32_bf16 a[68:71], v[40:43], v[104:107], a[68:71]
    ds_read_b128 v[80:83], v24 offset:49152
    v_accvgpr_read_b32 v33, a234
    v_mfma_f32_16x16x32_bf16 a[68:71], v[44:47], v[108:111], a[68:71]
    s_xor_b32 s60, s60, 7864320
    v_accvgpr_read_b32 v31, a235
    v_cvt_pk_bf16_f32 v33, v33, v31
    v_mfma_f32_16x16x32_bf16 a[72:75], v[40:43], v[112:115], a[72:75]
    s_add_u32 m0, s69, 49152
    v_accvgpr_read_b32 v34, a236
    v_accvgpr_read_b32 v31, a237
    v_mfma_f32_16x16x32_bf16 a[72:75], v[44:47], v[116:119], a[72:75]
    s_andn2_b32 s60, s60, 3670016
    buffer_load_dwordx4 v10, s[20:23], s63 offen lds
    v_mfma_f32_16x16x32_bf16 a[76:79], v[40:43], v[120:123], a[76:79]
    ds_read_b128 v[84:87], v25 offset:49152
    ds_read_b64_tr_b16 v[40:41], v29 offset:32768
    v_mfma_f32_16x16x32_bf16 a[76:79], v[44:47], v[124:127], a[76:79]
    s_add_u32 s72, s71, 7168
    buffer_load_dwordx4 v11, s[20:23], s63 offen offset:1024 lds
    v_mfma_f32_16x16x32_bf16 a[80:83], v[48:51], v[96:99], a[80:83]
    ds_read_b128 v[88:91], v24 offset:57344
    ds_read_b64_tr_b16 v[42:43], v29 offset:33280
    v_mfma_f32_16x16x32_bf16 a[80:83], v[52:55], v[100:103], a[80:83]
    ds_read_b64_tr_b16 v[44:45], v29 offset:36864
    ds_read_b64_tr_b16 v[46:47], v29 offset:37376
    v_mfma_f32_16x16x32_bf16 a[84:87], v[48:51], v[104:107], a[84:87]
    v_add_u32 v29, 0xffff0000, v29
    v_cvt_pk_bf16_f32 v34, v34, v31
    v_mfma_f32_16x16x32_bf16 a[84:87], v[52:55], v[108:111], a[84:87]
    buffer_load_dwordx4 v12, s[20:23], s63 offen offset:2048 lds
    v_mfma_f32_16x16x32_bf16 a[88:91], v[48:51], v[112:115], a[88:91]
    ds_read_b128 v[92:95], v25 offset:57344
    v_accvgpr_read_b32 v35, a238
    v_mfma_f32_16x16x32_bf16 a[88:91], v[52:55], v[116:119], a[88:91]
    v_accvgpr_read_b32 v31, a239
    v_cvt_pk_bf16_f32 v35, v35, v31
    v_mfma_f32_16x16x32_bf16 a[92:95], v[48:51], v[120:123], a[92:95]
    buffer_load_dwordx4 v13, s[20:23], s63 offen offset:3072 lds
    v_mfma_f32_16x16x32_bf16 a[92:95], v[52:55], v[124:127], a[92:95]
    s_waitcnt lgkmcnt(1)
    v_mfma_f32_16x16x32_bf16 a[96:99], v[56:59], v[96:99], a[96:99]
    v_mfma_f32_16x16x32_bf16 a[96:99], v[60:63], v[100:103], a[96:99]
    s_xor_b32 s63, s63, 128
    v_mfma_f32_16x16x32_bf16 a[100:103], v[56:59], v[104:107], a[100:103]
    buffer_store_dwordx4 v[32:35], v1, s[36:39], s72 offen sc1
    v_mfma_f32_16x16x32_bf16 a[100:103], v[60:63], v[108:111], a[100:103]
    v_mfma_f32_16x16x32_bf16 a[104:107], v[56:59], v[112:115], a[104:107]
    v_accvgpr_read_b32 v32, a240
    v_accvgpr_read_b32 v31, a241
    v_mfma_f32_16x16x32_bf16 a[104:107], v[60:63], v[116:119], a[104:107]
    s_waitcnt vmcnt(10) lgkmcnt(0)
    s_barrier
    ds_read_b64_tr_b16 v[48:49], v14 offset:0
    v_mfma_f32_16x16x32_bf16 a[108:111], v[56:59], v[120:123], a[108:111]
    s_add_u32 m0, s69, 65536
    ds_read_b64_tr_b16 v[50:51], v14 offset:1024
    ds_read_b64_tr_b16 v[52:53], v14 offset:8192
    v_mfma_f32_16x16x32_bf16 a[108:111], v[60:63], v[124:127], a[108:111]
    buffer_load_dwordx4 v2, s[24:27], s60 offen lds
    v_mfma_f32_16x16x32_bf16 a[112:115], v[40:43], v[96:99], a[112:115]
    ds_read_b64_tr_b16 v[54:55], v14 offset:9216
    ds_read_b64_tr_b16 v[56:57], v15 offset:0
    v_mfma_f32_16x16x32_bf16 a[112:115], v[44:47], v[100:103], a[112:115]
    ds_read_b64_tr_b16 v[58:59], v15 offset:1024
    ds_read_b64_tr_b16 v[60:61], v15 offset:8192
    v_mfma_f32_16x16x32_bf16 a[116:119], v[40:43], v[104:107], a[116:119]
    ds_read_b64_tr_b16 v[62:63], v15 offset:9216
    v_add_u32 v14, 0xfffe0000, v14
    v_mfma_f32_16x16x32_bf16 a[116:119], v[44:47], v[108:111], a[116:119]
    v_add_u32 v15, 0xfffe0000, v15
    v_cvt_pk_bf16_f32 v32, v32, v31
    v_mfma_f32_16x16x32_bf16 a[120:123], v[40:43], v[112:115], a[120:123]
    v_accvgpr_read_b32 v33, a242
    v_accvgpr_read_b32 v31, a243
    v_mfma_f32_16x16x32_bf16 a[120:123], v[44:47], v[116:119], a[120:123]
    buffer_load_dwordx4 v3, s[24:27], s60 offen offset:1024 lds
    v_mfma_f32_16x16x32_bf16 a[124:127], v[40:43], v[120:123], a[124:127]
    ds_read_b64_tr_b16 v[40:41], v16 offset:0
    ds_read_b64_tr_b16 v[42:43], v16 offset:1024
    v_mfma_f32_16x16x32_bf16 a[124:127], v[44:47], v[124:127], a[124:127]
    s_add_u32 s72, s71, 38912
    ds_read_b64_tr_b16 v[44:45], v16 offset:8192
    ds_read_b64_tr_b16 v[46:47], v16 offset:9216
    s_waitcnt lgkmcnt(4)
    v_mfma_f32_16x16x32_bf16 v[128:131], v[48:51], v[64:67], v[128:131]
    v_add_u32 v16, 0xfffe0000, v16
    v_cvt_pk_bf16_f32 v33, v33, v31
    v_mfma_f32_16x16x32_bf16 v[128:131], v[52:55], v[68:71], v[128:131]
    v_add_u32 v24, 0x10000, v24
    v_accvgpr_read_b32 v34, a244
    v_mfma_f32_16x16x32_bf16 v[132:135], v[48:51], v[72:75], v[132:135]
    ds_read_b128 v[96:99], v24 offset:16384
    v_accvgpr_read_b32 v31, a245
    v_mfma_f32_16x16x32_bf16 v[132:135], v[52:55], v[76:79], v[132:135]
    v_cvt_pk_bf16_f32 v34, v34, v31
    v_accvgpr_read_b32 v35, a246
    v_mfma_f32_16x16x32_bf16 v[136:139], v[48:51], v[80:83], v[136:139]
    v_accvgpr_read_b32 v31, a247
    v_cvt_pk_bf16_f32 v35, v35, v31
    v_mfma_f32_16x16x32_bf16 v[136:139], v[52:55], v[84:87], v[136:139]
    buffer_load_dwordx4 v4, s[24:27], s60 offen offset:2048 lds
    v_mfma_f32_16x16x32_bf16 v[140:143], v[48:51], v[88:91], v[140:143]
    ds_read_b64_tr_b16 v[48:49], v17 offset:0
    ds_read_b64_tr_b16 v[50:51], v17 offset:1024
    v_mfma_f32_16x16x32_bf16 v[140:143], v[52:55], v[92:95], v[140:143]
    ds_read_b64_tr_b16 v[52:53], v17 offset:8192
    ds_read_b64_tr_b16 v[54:55], v17 offset:9216
    v_mfma_f32_16x16x32_bf16 v[144:147], v[56:59], v[64:67], v[144:147]
    v_add_u32 v17, 0xfffe0000, v17
    v_mov_b32 v2, v1
    v_mfma_f32_16x16x32_bf16 v[144:147], v[60:63], v[68:71], v[144:147]
    buffer_store_dwordx4 v[32:35], v1, s[36:39], s72 offen sc1
    v_mfma_f32_16x16x32_bf16 v[148:151], v[56:59], v[72:75], v[148:151]
    v_mfma_f32_16x16x32_bf16 v[148:151], v[60:63], v[76:79], v[148:151]
    v_mfma_f32_16x16x32_bf16 v[152:155], v[56:59], v[80:83], v[152:155]
    v_add_u32 v25, 0x10000, v25
    v_accvgpr_read_b32 v32, a248
    v_mfma_f32_16x16x32_bf16 v[152:155], v[60:63], v[84:87], v[152:155]
    buffer_load_dwordx4 v5, s[24:27], s60 offen offset:3072 lds
    v_mfma_f32_16x16x32_bf16 v[156:159], v[56:59], v[88:91], v[156:159]
    ds_read_b128 v[100:103], v25 offset:16384
    ds_read_b64_tr_b16 v[56:57], v18 offset:0
    v_mfma_f32_16x16x32_bf16 v[156:159], v[60:63], v[92:95], v[156:159]
    s_waitcnt lgkmcnt(2)
    ds_read_b64_tr_b16 v[58:59], v18 offset:1024
    ds_read_b64_tr_b16 v[60:61], v18 offset:8192
    v_mfma_f32_16x16x32_bf16 v[160:163], v[40:43], v[64:67], v[160:163]
    ds_read_b64_tr_b16 v[62:63], v18 offset:9216
    v_add_u32 v18, 0xfffe0000, v18
    v_mfma_f32_16x16x32_bf16 v[160:163], v[44:47], v[68:71], v[160:163]
    v_accvgpr_read_b32 v31, a249
    v_cvt_pk_bf16_f32 v32, v32, v31
    v_mfma_f32_16x16x32_bf16 v[164:167], v[40:43], v[72:75], v[164:167]
    v_accvgpr_read_b32 v33, a250
    v_accvgpr_read_b32 v31, a251
    v_mfma_f32_16x16x32_bf16 v[164:167], v[44:47], v[76:79], v[164:167]
    s_add_u32 m0, s69, 81920
    v_cvt_pk_bf16_f32 v33, v33, v31
    v_accvgpr_read_b32 v34, a252
    v_mfma_f32_16x16x32_bf16 v[168:171], v[40:43], v[80:83], v[168:171]
    s_xor_b32 s60, s60, 524288
    buffer_load_dwordx4 v10, s[20:23], s64 offen lds
    v_mfma_f32_16x16x32_bf16 v[168:171], v[44:47], v[84:87], v[168:171]
    s_mov_b32 s60, 131072
    v_accvgpr_read_b32 v31, a253
    v_cvt_pk_bf16_f32 v34, v34, v31
    v_mfma_f32_16x16x32_bf16 v[172:175], v[40:43], v[88:91], v[172:175]
    ds_read_b64_tr_b16 v[40:41], v19 offset:0
    ds_read_b64_tr_b16 v[42:43], v19 offset:1024
    v_mfma_f32_16x16x32_bf16 v[172:175], v[44:47], v[92:95], v[172:175]
    s_add_u32 s72, s71, 39936
    ds_read_b64_tr_b16 v[44:45], v19 offset:8192
    ds_read_b64_tr_b16 v[46:47], v19 offset:9216
    v_mfma_f32_16x16x32_bf16 v[176:179], v[48:51], v[64:67], v[176:179]
    ds_read_b128 v[104:107], v24 offset:24576
    v_add_u32 v19, 0xfffe0000, v19
    v_mfma_f32_16x16x32_bf16 v[176:179], v[52:55], v[68:71], v[176:179]
    v_accvgpr_read_b32 v35, a254
    v_accvgpr_read_b32 v31, a255
    v_mfma_f32_16x16x32_bf16 v[180:183], v[48:51], v[72:75], v[180:183]
    v_cvt_pk_bf16_f32 v35, v35, v31
    v_mov_b32 v31, 1
    v_mfma_f32_16x16x32_bf16 v[180:183], v[52:55], v[76:79], v[180:183]
    buffer_load_dwordx4 v11, s[20:23], s64 offen offset:1024 lds
    v_mfma_f32_16x16x32_bf16 v[184:187], v[48:51], v[80:83], v[184:187]
    buffer_store_dwordx4 v[32:35], v1, s[36:39], s72 offen sc1
    v_mfma_f32_16x16x32_bf16 v[184:187], v[52:55], v[84:87], v[184:187]
    v_add_u32 v11, s99, v39
    v_mfma_f32_16x16x32_bf16 v[188:191], v[48:51], v[88:91], v[188:191]
    s_mul_i32 s99, s98, 6
    ds_read_b64_tr_b16 v[48:49], v20 offset:0
    ds_read_b64_tr_b16 v[50:51], v20 offset:1024
    v_mfma_f32_16x16x32_bf16 v[188:191], v[52:55], v[92:95], v[188:191]
    s_sub_u32 s99, s8, s99
    ds_read_b64_tr_b16 v[52:53], v20 offset:8192
    ds_read_b64_tr_b16 v[54:55], v20 offset:9216
    s_waitcnt lgkmcnt(4)
    v_mfma_f32_16x16x32_bf16 v[192:195], v[56:59], v[64:67], v[192:195]
    s_mul_i32 s99, s99, 6
    v_add_u32 v20, 0xfffe0000, v20
    v_mfma_f32_16x16x32_bf16 v[192:195], v[60:63], v[68:71], v[192:195]
    s_lshl1_add_u32 s99, s4, s99
    v_mfma_f32_16x16x32_bf16 v[196:199], v[56:59], v[72:75], v[196:199]
    s_sub_u32 s99, s99, 2
    v_mfma_f32_16x16x32_bf16 v[196:199], v[60:63], v[76:79], v[196:199]
    s_lshl_b32 s8, s99, 5
    buffer_load_dwordx4 v12, s[20:23], s64 offen offset:2048 lds
    v_mfma_f32_16x16x32_bf16 v[200:203], v[56:59], v[80:83], v[200:203]
    s_lshr_b32 s99, s99, 1
    ds_read_b128 v[108:111], v25 offset:24576
    v_lshl_add_u32 v10, v38, 4, s8
    v_mfma_f32_16x16x32_bf16 v[200:203], v[60:63], v[84:87], v[200:203]
    s_lshr_b32 s8, s5, 3
    v_lshrrev_b32 v38, 3, v37
    v_mul_u32_u24 v39, 18, v38
    v_mfma_f32_16x16x32_bf16 v[204:207], v[56:59], v[88:91], v[204:207]
    s_mul_i32 s8, s8, 6
    ds_read_b64_tr_b16 v[56:57], v21 offset:0
    ds_read_b64_tr_b16 v[58:59], v21 offset:1024
    v_mfma_f32_16x16x32_bf16 v[204:207], v[60:63], v[92:95], v[204:207]
    ds_read_b64_tr_b16 v[60:61], v21 offset:8192
    ds_read_b64_tr_b16 v[62:63], v21 offset:9216
    v_mfma_f32_16x16x32_bf16 v[208:211], v[40:43], v[64:67], v[208:211]
    v_add_u32 v21, 0xfffe0000, v21
    v_and_b32 v38, 4, v37
    v_mfma_f32_16x16x32_bf16 v[208:211], v[44:47], v[68:71], v[208:211]
    s_cmp_lt_u32 s98, 5
    s_cselect_b32 s98, s98, 40
    v_lshl_add_u32 v39, v38, 1, v39
    v_mfma_f32_16x16x32_bf16 v[212:215], v[40:43], v[72:75], v[212:215]
    s_lshl1_add_u32 s9, s98, s9
    buffer_load_dwordx4 v13, s[20:23], s64 offen offset:3072 lds
    v_mfma_f32_16x16x32_bf16 v[212:215], v[44:47], v[76:79], v[212:215]
    s_mul_i32 s9, s9, 18
    v_lshrrev_b32 v38, 2, v37
    v_mul_u32_u24 v38, 36, v38
    v_mfma_f32_16x16x32_bf16 v[216:219], v[40:43], v[80:83], v[216:219]
    v_add_u32 v39, s9, v39
    v_add_u32 v38, s10, v38
    v_mfma_f32_16x16x32_bf16 v[216:219], v[44:47], v[84:87], v[216:219]
    s_cmp_eq_u32 s98, 4
    s_cselect_b64 vcc, -1, 0
    v_and_b32 v37, 3, v37
    v_mfma_f32_16x16x32_bf16 v[220:223], v[40:43], v[88:91], v[220:223]
    ds_read_b64_tr_b16 v[40:41], v26 offset:0
    ds_read_b64_tr_b16 v[42:43], v26 offset:512
    v_mfma_f32_16x16x32_bf16 v[220:223], v[44:47], v[92:95], v[220:223]
    s_waitcnt lgkmcnt(2)
    ds_read_b64_tr_b16 v[44:45], v26 offset:4096
    ds_read_b64_tr_b16 v[46:47], v26 offset:4608
    v_mfma_f32_16x16x32_bf16 v[224:227], v[48:51], v[64:67], v[224:227]
    v_add_u32 v26, 0x10000, v26
    v_cndmask_b32 v39, v39, v38, vcc
    v_mfma_f32_16x16x32_bf16 v[224:227], v[52:55], v[68:71], v[224:227]
    s_xor_b32 s64, s64, 128
    v_add_u32 v39, v39, v37
    v_mul_u32_u24 v39, 1152, v39
    v_mfma_f32_16x16x32_bf16 v[228:231], v[48:51], v[72:75], v[228:231]
    s_cmp_eq_u32 s98, 4
    s_cselect_b32 s9, 18, 4
    s_cselect_b32 s10, 2, 4
    v_mfma_f32_16x16x32_bf16 v[228:231], v[52:55], v[76:79], v[228:231]
    s_mul_i32 s9, s9, 1152
    v_add_u32 v39, v39, v10
    v_mov_b32 v38, 1073741824
    v_mfma_f32_16x16x32_bf16 v[232:235], v[48:51], v[80:83], v[232:235]
    s_add_u32 s98, s98, s8
    v_cmp_gt_u32 vcc, s10, v37
    v_lshrrev_b32 v37, 8, v1
    v_mfma_f32_16x16x32_bf16 v[232:235], v[52:55], v[84:87], v[232:235]
    s_add_u32 m0, s67, 98304
    v_cndmask_b32 v12, v38, v39, vcc
    v_add_u32 v38, 1024, v36
    v_mfma_f32_16x16x32_bf16 v[236:239], v[48:51], v[88:91], v[236:239]
    s_add_u32 s98, s98, 128
    buffer_load_dwordx4 v1, s[28:31], s65 offen sc1 lds
    v_mfma_f32_16x16x32_bf16 v[236:239], v[52:55], v[92:95], v[236:239]
    s_add_u32 s8, s100, 16
    ds_read_b64_tr_b16 v[48:49], v27 offset:0
    ds_read_b64_tr_b16 v[50:51], v27 offset:512
    v_mfma_f32_16x16x32_bf16 v[240:243], v[56:59], v[64:67], v[240:243]
    s_lshr_b32 s10, s5, 3
    ds_read_b64_tr_b16 v[52:53], v27 offset:4096
    ds_read_b64_tr_b16 v[54:55], v27 offset:4608
    v_mfma_f32_16x16x32_bf16 v[240:243], v[60:63], v[68:71], v[240:243]
    v_add_u32 v27, 0x10000, v27
    v_add_u32 v13, s9, v12
    v_mfma_f32_16x16x32_bf16 v[244:247], v[56:59], v[72:75], v[244:247]
    s_cmp_eq_u32 s4, 0
    s_cselect_b64 vcc, -1, 0
    v_cndmask_b32 v12, v12, v38, vcc
    v_mfma_f32_16x16x32_bf16 v[244:247], v[60:63], v[76:79], v[244:247]
    v_add_u32 v38, 19456, v36
    v_bfe_u32 v36, v1, 4, 4
    v_mfma_f32_16x16x32_bf16 v[248:251], v[56:59], v[80:83], v[248:251]
    s_cmp_eq_u32 s4, 0
    s_cselect_b64 vcc, -1, 0
    v_cndmask_b32 v13, v13, v38, vcc
    v_mfma_f32_16x16x32_bf16 v[248:251], v[60:63], v[84:87], v[248:251]
    s_cmp_eq_u32 s4, 0
    s_cselect_b32 s98, s7, s98
    s_cselect_b32 s99, s8, s99
    v_mfma_f32_16x16x32_bf16 v[252:255], v[56:59], v[88:91], v[252:255]
    s_lshr_b32 s9, s99, 2
    ds_read_b64_tr_b16 v[56:57], v28 offset:0
    ds_read_b64_tr_b16 v[58:59], v28 offset:512
    v_mfma_f32_16x16x32_bf16 v[252:255], v[60:63], v[92:95], v[252:255]
    s_sub_u32 s9, s9, s10
    ds_read_b64_tr_b16 v[60:61], v28 offset:4096
    ds_read_b64_tr_b16 v[62:63], v28 offset:4608
    s_waitcnt lgkmcnt(4)
    v_mfma_f32_16x16x32_bf16 a[64:67], v[40:43], v[64:67], a[64:67]
    s_lshr_b32 s92, s2, 3
    v_lshrrev_b32 v9, 4, v1
    v_min_u32 v9, 0, v9
    v_mfma_f32_16x16x32_bf16 a[64:67], v[44:47], v[68:71], a[64:67]
    s_lshl2_add_u32 s92, s92, s4
    v_add_u32 v24, 0xfffe0000, v24
    v_add_u32 v28, 0x10000, v28
    v_mfma_f32_16x16x32_bf16 a[68:71], v[40:43], v[72:75], a[68:71]
    s_mul_i32 s92, s92, 1
    ds_read_b128 v[112:115], v24 offset:16384
    v_lshlrev_b32 v37, 2, v37
    v_mfma_f32_16x16x32_bf16 a[68:71], v[44:47], v[76:79], a[68:71]
    s_add_u32 s92, s92, 32
    v_add_lshl_u32 v9, v9, s92, 7
    v_sub_u32 v36, v36, v37
    v_mfma_f32_16x16x32_bf16 a[72:75], v[40:43], v[80:83], a[72:75]
    s_sub_u32 s9, s9, 1
    v_add_u32 v25, 0xfffe0000, v25
    v_mov_b32 v37, 0xf149f2ca
    v_mfma_f32_16x16x32_bf16 a[72:75], v[44:47], v[84:87], a[72:75]
    s_getpc_b64 s[92:93]
    global_load_dword v9, v9, s[92:93]
    v_mfma_f32_16x16x32_bf16 a[76:79], v[40:43], v[88:91], a[76:79]
    s_and_b32 s9, s9, 3
    buffer_load_dwordx4 v1, s[28:31], s65 offen offset:1024 sc1 lds
    v_mfma_f32_16x16x32_bf16 a[76:79], v[44:47], v[92:95], a[76:79]
    s_lshl_b32 s9, s9, 1
    ds_read_b128 v[116:119], v25 offset:16384
    ds_read_b64_tr_b16 v[40:41], v29 offset:0
    v_mfma_f32_16x16x32_bf16 a[80:83], v[48:51], v[64:67], a[80:83]
    s_and_b32 s10, s99, 3
    ds_read_b128 v[120:123], v24 offset:24576
    v_bfe_u32 v38, v1, 4, 1
    v_mfma_f32_16x16x32_bf16 a[80:83], v[52:55], v[68:71], a[80:83]
    s_mul_i32 s10, s10, 9
    ds_read_b64_tr_b16 v[42:43], v29 offset:512
    ds_read_b64_tr_b16 v[44:45], v29 offset:4096
    v_mfma_f32_16x16x32_bf16 a[84:87], v[48:51], v[72:75], a[84:87]
    s_mul_i32 s98, s98, 36864
    ds_read_b64_tr_b16 v[46:47], v29 offset:4608
    v_add_u32 v29, 0x10000, v29
    v_mfma_f32_16x16x32_bf16 a[84:87], v[52:55], v[76:79], a[84:87]
    s_mul_i32 s7, s7, 36864
    ds_read_b128 v[124:127], v25 offset:24576
    v_sub_u32 v38, 0, v38
    v_mfma_f32_16x16x32_bf16 a[88:91], v[48:51], v[80:83], a[88:91]
    s_cmp_eq_u32 s9, 6
    s_cselect_b32 s9, 7, s9
    v_and_b32 v38, 0xaaaaaaaa, v38
    v_mfma_f32_16x16x32_bf16 a[88:91], v[52:55], v[84:87], a[88:91]
    s_add_u32 s9, s9, s10
    v_and_b32 v39, 0x40, v1
    v_mfma_f32_16x16x32_bf16 a[92:95], v[48:51], v[88:91], a[92:95]
    s_lshl_b32 s64, s9, 10
    v_mfma_f32_16x16x32_bf16 a[92:95], v[52:55], v[92:95], a[92:95]
    s_sub_u32 s9, s99, 16
    s_waitcnt lgkmcnt(1)
    v_mfma_f32_16x16x32_bf16 a[96:99], v[56:59], v[64:67], a[96:99]
    s_mul_i32 s9, s9, 18432
    v_mfma_f32_16x16x32_bf16 a[96:99], v[60:63], v[68:71], a[96:99]
    s_xor_b32 s65, s65, 122880
    v_mfma_f32_16x16x32_bf16 a[100:103], v[56:59], v[72:75], a[100:103]
    s_andn2_b32 s65, s65, 57344
    v_mfma_f32_16x16x32_bf16 a[100:103], v[60:63], v[76:79], a[100:103]
    s_add_u32 s9, s9, 6144
    v_mfma_f32_16x16x32_bf16 a[104:107], v[56:59], v[80:83], a[104:107]
    s_mov_b32 s10, 1024
    v_mfma_f32_16x16x32_bf16 a[104:107], v[60:63], v[84:87], a[104:107]
    s_waitcnt vmcnt(3) lgkmcnt(0)
    s_barrier
    ds_read_b64_tr_b16 v[48:49], v14 offset:32768
    v_mfma_f32_16x16x32_bf16 a[108:111], v[56:59], v[88:91], a[108:111]
    s_add_u32 m0, s67, 131072
    buffer_store_dword v31, v30, s[32:35], s101 offen sc1
    v_mfma_f32_16x16x32_bf16 a[108:111], v[60:63], v[92:95], a[108:111]
    s_mov_b32 s93, 65536
    buffer_load_dwordx4 v1, s[28:31], s65 offen sc1 lds
    v_mfma_f32_16x16x32_bf16 a[112:115], v[40:43], v[64:67], a[112:115]
    ds_read_b64_tr_b16 v[50:51], v14 offset:33792
    ds_read_b64_tr_b16 v[52:53], v14 offset:40960
    v_mfma_f32_16x16x32_bf16 a[112:115], v[44:47], v[68:71], a[112:115]
    ds_read_b64_tr_b16 v[54:55], v14 offset:41984
    ds_read_b64_tr_b16 v[56:57], v15 offset:32768
    v_mfma_f32_16x16x32_bf16 a[116:119], v[40:43], v[72:75], a[116:119]
    ds_read_b64_tr_b16 v[58:59], v15 offset:33792
    ds_read_b64_tr_b16 v[60:61], v15 offset:40960
    v_mfma_f32_16x16x32_bf16 a[116:119], v[44:47], v[76:79], a[116:119]
    ds_read_b64_tr_b16 v[62:63], v15 offset:41984
    v_add_u32 v14, 0x10000, v14
    v_mfma_f32_16x16x32_bf16 a[120:123], v[40:43], v[80:83], a[120:123]
    v_add_u32 v15, 0x10000, v15
    v_mfma_f32_16x16x32_bf16 a[120:123], v[44:47], v[84:87], a[120:123]
    s_cmp_lt_u32 s99, 16
    s_cselect_b32 s64, s64, s9
    s_cselect_b32 s10, s10, 9216
    v_mfma_f32_16x16x32_bf16 a[124:127], v[40:43], v[88:91], a[124:127]
    s_lshl2_add_u32 s99, s100, s4
    ds_read_b64_tr_b16 v[40:41], v16 offset:32768
    ds_read_b64_tr_b16 v[42:43], v16 offset:33792
    v_mfma_f32_16x16x32_bf16 a[124:127], v[44:47], v[92:95], a[124:127]
    s_add_u32 s64, s64, s98
    ds_read_b64_tr_b16 v[44:45], v16 offset:40960
    ds_read_b64_tr_b16 v[46:47], v16 offset:41984
    s_waitcnt lgkmcnt(5)
    v_mfma_f32_16x16x32_bf16 v[128:131], v[48:51], v[96:99], v[128:131]
    s_lshl_b32 s99, s99, 1
    v_add_u32 v16, 0x10000, v16
    v_mfma_f32_16x16x32_bf16 v[128:131], v[52:55], v[100:103], v[128:131]
    s_add_u32 s62, s64, s10
    v_mfma_f32_16x16x32_bf16 v[132:135], v[48:51], v[104:107], v[132:135]
    s_lshr_b32 s9, s99, 2
    ds_read_b128 v[64:67], v24 offset:49152
    v_mfma_f32_16x16x32_bf16 v[132:135], v[52:55], v[108:111], v[132:135]
    s_lshr_b32 s10, s5, 3
    v_mfma_f32_16x16x32_bf16 v[136:139], v[48:51], v[112:115], v[136:139]
    s_sub_u32 s9, s9, s10
    v_mfma_f32_16x16x32_bf16 v[136:139], v[52:55], v[116:119], v[136:139]
    s_sub_u32 s9, s9, 1
    v_mfma_f32_16x16x32_bf16 v[140:143], v[48:51], v[120:123], v[140:143]
    s_and_b32 s9, s9, 3
    ds_read_b64_tr_b16 v[48:49], v17 offset:32768
    ds_read_b64_tr_b16 v[50:51], v17 offset:33792
    v_mfma_f32_16x16x32_bf16 v[140:143], v[52:55], v[124:127], v[140:143]
    s_lshl_b32 s9, s9, 1
    ds_read_b64_tr_b16 v[52:53], v17 offset:40960
    ds_read_b64_tr_b16 v[54:55], v17 offset:41984
    v_mfma_f32_16x16x32_bf16 v[144:147], v[56:59], v[96:99], v[144:147]
    s_and_b32 s10, s99, 3
    ds_read_b128 v[68:71], v25 offset:49152
    v_add_u32 v17, 0x10000, v17
    s_waitcnt lgkmcnt(5)
    v_mfma_f32_16x16x32_bf16 v[144:147], v[60:63], v[100:103], v[144:147]
    s_cmp_eq_u32 s9, 6
    s_cselect_b32 s9, 7, s9
    v_mfma_f32_16x16x32_bf16 v[148:151], v[56:59], v[104:107], v[148:151]
    s_mul_i32 s10, s10, 9
    v_mfma_f32_16x16x32_bf16 v[148:151], v[60:63], v[108:111], v[148:151]
    s_add_u32 s9, s9, s10
    v_mfma_f32_16x16x32_bf16 v[152:155], v[56:59], v[112:115], v[152:155]
    s_lshl_b32 s63, s9, 10
    v_mfma_f32_16x16x32_bf16 v[152:155], v[60:63], v[116:119], v[152:155]
    s_cmp_eq_u32 s4, 0
    s_cselect_b32 s8, 1.0, 0
    v_mfma_f32_16x16x32_bf16 v[156:159], v[56:59], v[120:123], v[156:159]
    s_add_u32 s63, s63, s7
    ds_read_b128 v[72:75], v24 offset:57344
    ds_read_b64_tr_b16 v[56:57], v18 offset:32768
    v_mfma_f32_16x16x32_bf16 v[156:159], v[60:63], v[124:127], v[156:159]
    ds_read_b64_tr_b16 v[58:59], v18 offset:33792
    ds_read_b64_tr_b16 v[60:61], v18 offset:40960
    v_mfma_f32_16x16x32_bf16 v[160:163], v[40:43], v[96:99], v[160:163]
    ds_read_b64_tr_b16 v[62:63], v18 offset:41984
    v_add_u32 v18, 0x10000, v18
    v_mfma_f32_16x16x32_bf16 v[160:163], v[44:47], v[100:103], v[160:163]
    s_cmp_eq_u32 s4, 1
    s_cselect_b32 s9, 1.0, 0
    v_mfma_f32_16x16x32_bf16 v[164:167], v[40:43], v[104:107], v[164:167]
    s_cmp_eq_u32 s6, 0
    s_cselect_b32 s16, s8, 0
    s_cselect_b32 s17, s9, 0
    v_mfma_f32_16x16x32_bf16 v[164:167], v[44:47], v[108:111], v[164:167]
    s_cmp_eq_u32 s4, 2
    s_cselect_b32 s10, 1.0, 0
    v_mfma_f32_16x16x32_bf16 v[168:171], v[40:43], v[112:115], v[168:171]
    buffer_load_dwordx4 v1, s[28:31], s65 offen offset:1024 sc1 lds
    v_mfma_f32_16x16x32_bf16 v[168:171], v[44:47], v[116:119], v[168:171]
    ds_read_b128 v[76:79], v25 offset:57344
    v_mfma_f32_16x16x32_bf16 v[172:175], v[40:43], v[120:123], v[172:175]
    ds_read_b64_tr_b16 v[40:41], v19 offset:32768
    ds_read_b64_tr_b16 v[42:43], v19 offset:33792
    v_mfma_f32_16x16x32_bf16 v[172:175], v[44:47], v[124:127], v[172:175]
    s_waitcnt lgkmcnt(3)
    ds_read_b64_tr_b16 v[44:45], v19 offset:40960
    ds_read_b64_tr_b16 v[46:47], v19 offset:41984
    v_mfma_f32_16x16x32_bf16 v[176:179], v[48:51], v[96:99], v[176:179]
    v_add_u32 v19, 0x10000, v19
    v_mfma_f32_16x16x32_bf16 v[176:179], v[52:55], v[100:103], v[176:179]
    s_cmp_eq_u32 s6, 0
    s_cselect_b32 s18, s10, 0
    s_cselect_b32 s19, s11, 0
    v_mfma_f32_16x16x32_bf16 v[180:183], v[48:51], v[104:107], v[180:183]
    s_cmp_eq_u32 s6, 0
    s_cselect_b32 s20, s12, 0
    s_cselect_b32 s21, s13, 0
    v_mfma_f32_16x16x32_bf16 v[180:183], v[52:55], v[108:111], v[180:183]
    v_add_u32 v24, 0x10000, v24
    v_mfma_f32_16x16x32_bf16 v[184:187], v[48:51], v[112:115], v[184:187]
    ds_read_b128 v[80:83], v24 offset:16384
    v_mfma_f32_16x16x32_bf16 v[184:187], v[52:55], v[116:119], v[184:187]
    s_cmp_eq_u32 s6, 0
    s_cselect_b32 s22, s14, 0
    s_cselect_b32 s23, s15, 0
    v_mfma_f32_16x16x32_bf16 v[188:191], v[48:51], v[120:123], v[188:191]
    ds_read_b64_tr_b16 v[48:49], v20 offset:32768
    ds_read_b64_tr_b16 v[50:51], v20 offset:33792
    v_mfma_f32_16x16x32_bf16 v[188:191], v[52:55], v[124:127], v[188:191]
    ds_read_b64_tr_b16 v[52:53], v20 offset:40960
    ds_read_b64_tr_b16 v[54:55], v20 offset:41984
    v_mfma_f32_16x16x32_bf16 v[192:195], v[56:59], v[96:99], v[192:195]
    v_add_u32 v20, 0x10000, v20
    v_mfma_f32_16x16x32_bf16 v[192:195], v[60:63], v[100:103], v[192:195]
    v_add_u32 v25, 0x10000, v25
    v_mfma_f32_16x16x32_bf16 v[196:199], v[56:59], v[104:107], v[196:199]
    ds_read_b128 v[84:87], v25 offset:16384
    v_mfma_f32_16x16x32_bf16 v[196:199], v[60:63], v[108:111], v[196:199]
    v_mfma_f32_16x16x32_bf16 v[200:203], v[56:59], v[112:115], v[200:203]
    v_mfma_f32_16x16x32_bf16 v[200:203], v[60:63], v[116:119], v[200:203]
    v_mfma_f32_16x16x32_bf16 v[204:207], v[56:59], v[120:123], v[204:207]
    ds_read_b64_tr_b16 v[56:57], v21 offset:32768
    ds_read_b64_tr_b16 v[58:59], v21 offset:33792
    v_mfma_f32_16x16x32_bf16 v[204:207], v[60:63], v[124:127], v[204:207]
    s_waitcnt lgkmcnt(2)
    ds_read_b64_tr_b16 v[60:61], v21 offset:40960
    ds_read_b64_tr_b16 v[62:63], v21 offset:41984
    v_mfma_f32_16x16x32_bf16 v[208:211], v[40:43], v[96:99], v[208:211]
    ds_read_b128 v[88:91], v24 offset:24576
    v_add_u32 v21, 0x10000, v21
    v_mfma_f32_16x16x32_bf16 v[208:211], v[44:47], v[100:103], v[208:211]
    v_mfma_f32_16x16x32_bf16 v[212:215], v[40:43], v[104:107], v[212:215]
    v_mfma_f32_16x16x32_bf16 v[212:215], v[44:47], v[108:111], v[212:215]
    v_mfma_f32_16x16x32_bf16 v[216:219], v[40:43], v[112:115], v[216:219]
    v_mfma_f32_16x16x32_bf16 v[216:219], v[44:47], v[116:119], v[216:219]
    v_mfma_f32_16x16x32_bf16 v[220:223], v[40:43], v[120:123], v[220:223]
    ds_read_b128 v[92:95], v25 offset:24576
    ds_read_b64_tr_b16 v[40:41], v14 offset:0
    v_mfma_f32_16x16x32_bf16 v[220:223], v[44:47], v[124:127], v[220:223]
    ds_read_b64_tr_b16 v[42:43], v14 offset:1024
    ds_read_b64_tr_b16 v[44:45], v14 offset:8192
    v_mfma_f32_16x16x32_bf16 v[224:227], v[48:51], v[96:99], v[224:227]
    ds_read_b64_tr_b16 v[46:47], v14 offset:9216
    v_mfma_f32_16x16x32_bf16 v[224:227], v[52:55], v[100:103], v[224:227]
    s_xor_b32 s65, s65, 8192
    v_mfma_f32_16x16x32_bf16 v[228:231], v[48:51], v[104:107], v[228:231]
    v_mfma_f32_16x16x32_bf16 v[228:231], v[52:55], v[108:111], v[228:231]
    v_mfma_f32_16x16x32_bf16 v[232:235], v[48:51], v[112:115], v[232:235]
    v_mfma_f32_16x16x32_bf16 v[232:235], v[52:55], v[116:119], v[232:235]
    v_mfma_f32_16x16x32_bf16 v[236:239], v[48:51], v[120:123], v[236:239]
    ds_read_b64_tr_b16 v[48:49], v15 offset:0
    ds_read_b64_tr_b16 v[50:51], v15 offset:1024
    v_mfma_f32_16x16x32_bf16 v[236:239], v[52:55], v[124:127], v[236:239]
    s_waitcnt lgkmcnt(2)
    ds_read_b64_tr_b16 v[52:53], v15 offset:8192
    ds_read_b64_tr_b16 v[54:55], v15 offset:9216
    v_mfma_f32_16x16x32_bf16 v[240:243], v[56:59], v[96:99], v[240:243]
    v_mfma_f32_16x16x32_bf16 v[240:243], v[60:63], v[100:103], v[240:243]
    v_mfma_f32_16x16x32_bf16 v[244:247], v[56:59], v[104:107], v[244:247]
    v_mfma_f32_16x16x32_bf16 v[244:247], v[60:63], v[108:111], v[244:247]
    v_mfma_f32_16x16x32_bf16 v[248:251], v[56:59], v[112:115], v[248:251]
    v_mfma_f32_16x16x32_bf16 v[248:251], v[60:63], v[116:119], v[248:251]
    v_mfma_f32_16x16x32_bf16 v[252:255], v[56:59], v[120:123], v[252:255]
    ds_read_b64_tr_b16 v[56:57], v16 offset:0
    ds_read_b64_tr_b16 v[58:59], v16 offset:1024
    v_mfma_f32_16x16x32_bf16 v[252:255], v[60:63], v[124:127], v[252:255]
    buffer_load_dword v7, v8, s[32:35], s61 offen sc1
    v_mfma_f32_16x16x32_bf16 v[128:131], v[40:43], v[64:67], v[128:131]
    ds_read_b64_tr_b16 v[60:61], v16 offset:8192
    ds_read_b64_tr_b16 v[62:63], v16 offset:9216
    v_mfma_f32_16x16x32_bf16 v[128:131], v[44:47], v[68:71], v[128:131]
    v_mfma_f32_16x16x32_bf16 v[132:135], v[40:43], v[72:75], v[132:135]
    v_mfma_f32_16x16x32_bf16 v[132:135], v[44:47], v[76:79], v[132:135]
    v_mfma_f32_16x16x32_bf16 v[136:139], v[40:43], v[80:83], v[136:139]
    v_mfma_f32_16x16x32_bf16 v[136:139], v[44:47], v[84:87], v[136:139]
    v_mfma_f32_16x16x32_bf16 v[140:143], v[40:43], v[88:91], v[140:143]
    ds_read_b64_tr_b16 v[40:41], v17 offset:0
    ds_read_b64_tr_b16 v[42:43], v17 offset:1024
    v_mfma_f32_16x16x32_bf16 v[140:143], v[44:47], v[92:95], v[140:143]
    s_waitcnt lgkmcnt(2)
    ds_read_b64_tr_b16 v[44:45], v17 offset:8192
    ds_read_b64_tr_b16 v[46:47], v17 offset:9216
    v_mfma_f32_16x16x32_bf16 v[144:147], v[48:51], v[64:67], v[144:147]
    v_cvt_pk_bf16_f32 v128, v128, v129
    v_cvt_pk_bf16_f32 v129, v130, v131
    v_mfma_f32_16x16x32_bf16 v[144:147], v[52:55], v[68:71], v[144:147]
    v_cvt_pk_bf16_f32 v132, v132, v133
    v_cvt_pk_bf16_f32 v133, v134, v135
    v_mfma_f32_16x16x32_bf16 v[148:151], v[48:51], v[72:75], v[148:151]
    v_cvt_pk_bf16_f32 v136, v136, v137
    v_cvt_pk_bf16_f32 v137, v138, v139
    v_mfma_f32_16x16x32_bf16 v[148:151], v[52:55], v[76:79], v[148:151]
    v_cvt_pk_bf16_f32 v140, v140, v141
    v_cvt_pk_bf16_f32 v141, v142, v143
    v_mfma_f32_16x16x32_bf16 v[152:155], v[48:51], v[80:83], v[152:155]
    v_cvt_pk_bf16_f32 v130, v144, v145
    v_cvt_pk_bf16_f32 v131, v146, v147
    v_mfma_f32_16x16x32_bf16 v[152:155], v[52:55], v[84:87], v[152:155]
    v_mfma_f32_16x16x32_bf16 v[156:159], v[48:51], v[88:91], v[156:159]
    ds_read_b64_tr_b16 v[48:49], v18 offset:0
    ds_read_b64_tr_b16 v[50:51], v18 offset:1024
    v_mfma_f32_16x16x32_bf16 v[156:159], v[52:55], v[92:95], v[156:159]
    ds_read_b64_tr_b16 v[52:53], v18 offset:8192
    ds_read_b64_tr_b16 v[54:55], v18 offset:9216
    v_mfma_f32_16x16x32_bf16 v[160:163], v[56:59], v[64:67], v[160:163]
    v_cvt_pk_bf16_f32 v134, v148, v149
    v_cvt_pk_bf16_f32 v135, v150, v151
    v_mfma_f32_16x16x32_bf16 v[160:163], v[60:63], v[68:71], v[160:163]
    v_cvt_pk_bf16_f32 v138, v152, v153
    v_cvt_pk_bf16_f32 v139, v154, v155
    v_mfma_f32_16x16x32_bf16 v[164:167], v[56:59], v[72:75], v[164:167]
    v_cvt_pk_bf16_f32 v142, v156, v157
    v_cvt_pk_bf16_f32 v143, v158, v159
    v_mfma_f32_16x16x32_bf16 v[164:167], v[60:63], v[76:79], v[164:167]
    v_mfma_f32_16x16x32_bf16 v[168:171], v[56:59], v[80:83], v[168:171]
    v_mfma_f32_16x16x32_bf16 v[168:171], v[60:63], v[84:87], v[168:171]
    v_cvt_pk_bf16_f32 v160, v160, v161
    v_cvt_pk_bf16_f32 v161, v162, v163
    v_mfma_f32_16x16x32_bf16 v[172:175], v[56:59], v[88:91], v[172:175]
    ds_read_b64_tr_b16 v[56:57], v19 offset:0
    ds_read_b64_tr_b16 v[58:59], v19 offset:1024
    v_mfma_f32_16x16x32_bf16 v[172:175], v[60:63], v[92:95], v[172:175]
    s_waitcnt lgkmcnt(2)
    ds_read_b64_tr_b16 v[60:61], v19 offset:8192
    ds_read_b64_tr_b16 v[62:63], v19 offset:9216
    v_mfma_f32_16x16x32_bf16 v[176:179], v[40:43], v[64:67], v[176:179]
    v_cvt_pk_bf16_f32 v164, v164, v165
    v_cvt_pk_bf16_f32 v165, v166, v167
    v_mfma_f32_16x16x32_bf16 v[176:179], v[44:47], v[68:71], v[176:179]
    v_cvt_pk_bf16_f32 v168, v168, v169
    v_cvt_pk_bf16_f32 v169, v170, v171
    v_mfma_f32_16x16x32_bf16 v[180:183], v[40:43], v[72:75], v[180:183]
    v_cvt_pk_bf16_f32 v172, v172, v173
    v_cvt_pk_bf16_f32 v173, v174, v175
    v_mfma_f32_16x16x32_bf16 v[180:183], v[44:47], v[76:79], v[180:183]
    v_mfma_f32_16x16x32_bf16 v[184:187], v[40:43], v[80:83], v[184:187]
    v_mfma_f32_16x16x32_bf16 v[184:187], v[44:47], v[84:87], v[184:187]
    v_cvt_pk_bf16_f32 v162, v176, v177
    v_cvt_pk_bf16_f32 v163, v178, v179
    v_mfma_f32_16x16x32_bf16 v[188:191], v[40:43], v[88:91], v[188:191]
    ds_read_b64_tr_b16 v[40:41], v20 offset:0
    ds_read_b64_tr_b16 v[42:43], v20 offset:1024
    v_mfma_f32_16x16x32_bf16 v[188:191], v[44:47], v[92:95], v[188:191]
    ds_read_b64_tr_b16 v[44:45], v20 offset:8192
    ds_read_b64_tr_b16 v[46:47], v20 offset:9216
    v_mfma_f32_16x16x32_bf16 v[192:195], v[48:51], v[64:67], v[192:195]
    v_cvt_pk_bf16_f32 v166, v180, v181
    v_cvt_pk_bf16_f32 v167, v182, v183
    v_mfma_f32_16x16x32_bf16 v[192:195], v[52:55], v[68:71], v[192:195]
    v_cvt_pk_bf16_f32 v170, v184, v185
    v_cvt_pk_bf16_f32 v171, v186, v187
    s_waitcnt vmcnt(0)
    v_cmp_gt_u32 vcc, 1, v7
    s_nop 1
    s_and_b64 vcc, vcc, exec
    s_cbranch_scc1 SPIN_KV
BACK_KV:
    v_mfma_f32_16x16x32_bf16 v[196:199], v[48:51], v[72:75], v[196:199]
    s_mov_b32 s77, s75
    buffer_load_dwordx4 a[224:227], v1, s[36:39], 0 offen offset:0 sc1
    v_mfma_f32_16x16x32_bf16 v[196:199], v[52:55], v[76:79], v[196:199]
    buffer_load_dwordx4 a[228:231], v1, s[36:39], 0 offen offset:1024 sc1
    v_mfma_f32_16x16x32_bf16 v[200:203], v[48:51], v[80:83], v[200:203]
    v_cmp_le_i32 vcc, 0, v36
    v_cvt_pk_bf16_f32 v192, v192, v193
    v_mfma_f32_16x16x32_bf16 v[200:203], v[52:55], v[84:87], v[200:203]
    v_cvt_pk_bf16_f32 v193, v194, v195
    v_cvt_pk_bf16_f32 v174, v188, v189
    v_mfma_f32_16x16x32_bf16 v[204:207], v[48:51], v[88:91], v[204:207]
    buffer_load_dwordx4 a[232:235], v1, s[36:39], 0 offen offset:2048 sc1
    v_mfma_f32_16x16x32_bf16 v[204:207], v[52:55], v[92:95], v[204:207]
    s_waitcnt lgkmcnt(0)
    ds_read_b64_tr_b16 v[48:49], v21 offset:0
    ds_read_b64_tr_b16 v[50:51], v21 offset:1024
    v_mfma_f32_16x16x32_bf16 v[208:211], v[56:59], v[64:67], v[208:211]
    ds_read_b64_tr_b16 v[52:53], v21 offset:8192
    ds_read_b64_tr_b16 v[54:55], v21 offset:9216
    v_mfma_f32_16x16x32_bf16 v[208:211], v[60:63], v[68:71], v[208:211]
    v_cvt_pk_bf16_f32 v196, v196, v197
    v_cvt_pk_bf16_f32 v197, v198, v199
    v_mfma_f32_16x16x32_bf16 v[212:215], v[56:59], v[72:75], v[212:215]
    buffer_load_dwordx4 a[236:239], v1, s[36:39], 0 offen offset:3072 sc1
    v_mfma_f32_16x16x32_bf16 v[212:215], v[60:63], v[76:79], v[212:215]
    v_cvt_pk_bf16_f32 v200, v200, v201
    v_cvt_pk_bf16_f32 v201, v202, v203
    v_mfma_f32_16x16x32_bf16 v[216:219], v[56:59], v[80:83], v[216:219]
    v_cvt_pk_bf16_f32 v194, v208, v209
    v_cndmask_b32_e64 v208, v37, 0, vcc
    v_mfma_f32_16x16x32_bf16 v[216:219], v[60:63], v[84:87], v[216:219]
    v_mul_f32 v176, s16, v208
    v_cmp_le_i32 vcc, 1, v36
    v_mfma_f32_16x16x32_bf16 v[220:223], v[56:59], v[88:91], v[220:223]
    v_cvt_pk_bf16_f32 v195, v210, v211
    v_cndmask_b32_e64 v209, v37, 0, vcc
    v_mfma_f32_16x16x32_bf16 v[220:223], v[60:63], v[92:95], v[220:223]
    v_mul_f32 v177, s16, v209
    v_cmp_le_i32 vcc, 2, v36
    v_mfma_f32_16x16x32_bf16 v[224:227], v[40:43], v[64:67], v[224:227]
    s_mov_b32 s38, 16384
    v_cndmask_b32_e64 v210, v37, 0, vcc
    v_mul_f32 v178, s16, v210
    v_mfma_f32_16x16x32_bf16 v[224:227], v[44:47], v[68:71], v[224:227]
    s_add_u32 m0, s76, s75
    v_cmp_le_i32 vcc, 3, v36
    v_cvt_pk_bf16_f32 v198, v212, v213
    v_mfma_f32_16x16x32_bf16 v[228:231], v[40:43], v[72:75], v[228:231]
    buffer_load_dwordx4 v1, s[36:39], s77 offen sc1 lds
    v_mfma_f32_16x16x32_bf16 v[228:231], v[44:47], v[76:79], v[228:231]
    v_cndmask_b32_e64 v211, v37, 0, vcc
    v_mul_f32 v179, s16, v211
    v_mfma_f32_16x16x32_bf16 v[232:235], v[40:43], v[80:83], v[232:235]
    v_cvt_pk_bf16_f32 v224, v224, v225
    v_cvt_pk_bf16_f32 v225, v226, v227
    v_mfma_f32_16x16x32_bf16 v[232:235], v[44:47], v[84:87], v[232:235]
    s_waitcnt vmcnt(6) lgkmcnt(0)
    s_barrier
    ds_read_b64_tr_b16 v[56:57], v26 offset:32768
    v_mfma_f32_16x16x32_bf16 v[236:239], v[40:43], v[88:91], v[236:239]
    buffer_load_dwordx4 v1, s[36:39], s77 offen offset:1024 sc1 lds
    v_mfma_f32_16x16x32_bf16 v[236:239], v[44:47], v[92:95], v[236:239]
    ds_read_b64_tr_b16 v[58:59], v26 offset:33280
    ds_read_b64_tr_b16 v[60:61], v26 offset:36864
    v_mfma_f32_16x16x32_bf16 v[240:243], v[48:51], v[64:67], v[240:243]
    ds_read_b64_tr_b16 v[62:63], v26 offset:37376
    ds_read_b64_tr_b16 v[40:41], v27 offset:32768
    v_mfma_f32_16x16x32_bf16 v[240:243], v[52:55], v[68:71], v[240:243]
    ds_read_b64_tr_b16 v[42:43], v27 offset:33280
    ds_read_b64_tr_b16 v[44:45], v27 offset:36864
    v_mfma_f32_16x16x32_bf16 v[244:247], v[48:51], v[72:75], v[244:247]
    buffer_load_dwordx4 v1, s[36:39], s77 offen offset:2048 sc1 lds
    v_mfma_f32_16x16x32_bf16 v[244:247], v[52:55], v[76:79], v[244:247]
    ds_read_b64_tr_b16 v[46:47], v27 offset:37376
    v_add_u32 v26, 0x10000, v26
    v_mfma_f32_16x16x32_bf16 v[248:251], v[48:51], v[80:83], v[248:251]
    v_add_u32 v27, 0x10000, v27
    v_cvt_pk_bf16_f32 v226, v240, v241
    v_mfma_f32_16x16x32_bf16 v[248:251], v[52:55], v[84:87], v[248:251]
    v_cvt_pk_bf16_f32 v227, v242, v243
    v_cvt_pk_bf16_f32 v228, v228, v229
    v_mfma_f32_16x16x32_bf16 v[252:255], v[48:51], v[88:91], v[252:255]
    buffer_load_dwordx4 v1, s[36:39], s77 offen offset:3072 sc1 lds
    v_mfma_f32_16x16x32_bf16 v[252:255], v[52:55], v[92:95], v[252:255]
    s_waitcnt lgkmcnt(1)
    ds_read_b64_tr_b16 v[48:49], v28 offset:32768
    ds_read_b64_tr_b16 v[50:51], v28 offset:33280
    v_mfma_f32_16x16x32_bf16 a[64:67], v[56:59], v[96:99], a[64:67]
    s_add_u32 s100, s77, 4096
    ds_read_b64_tr_b16 v[52:53], v28 offset:36864
    ds_read_b64_tr_b16 v[54:55], v28 offset:37376
    v_mfma_f32_16x16x32_bf16 a[64:67], v[60:63], v[100:103], a[64:67]
    s_add_u32 m0, m0, 4096
    v_add_u32 v28, 0x10000, v28
    v_cvt_pk_bf16_f32 v229, v230, v231
    v_mfma_f32_16x16x32_bf16 a[68:71], v[56:59], v[104:107], a[68:71]
    buffer_load_dwordx4 v1, s[36:39], s100 offen sc1 lds
    v_mfma_f32_16x16x32_bf16 a[68:71], v[60:63], v[108:111], a[68:71]
    v_cvt_pk_bf16_f32 v230, v244, v245
    v_cvt_pk_bf16_f32 v231, v246, v247
    v_mfma_f32_16x16x32_bf16 a[72:75], v[56:59], v[112:115], a[72:75]
    v_cvt_pk_bf16_f32 v199, v214, v215
    v_cvt_pk_bf16_f32 v232, v232, v233
    v_mfma_f32_16x16x32_bf16 a[72:75], v[60:63], v[116:119], a[72:75]
    v_cvt_pk_bf16_f32 v233, v234, v235
    v_cvt_pk_bf16_f32 v234, v248, v249
    v_mfma_f32_16x16x32_bf16 a[76:79], v[56:59], v[120:123], a[76:79]
    buffer_load_dwordx4 v1, s[36:39], s100 offen offset:1024 sc1 lds
    v_mfma_f32_16x16x32_bf16 a[76:79], v[60:63], v[124:127], a[76:79]
    ds_read_b64_tr_b16 v[56:57], v29 offset:32768
    ds_read_b64_tr_b16 v[58:59], v29 offset:33280
    v_mfma_f32_16x16x32_bf16 a[80:83], v[40:43], v[96:99], a[80:83]
    s_waitcnt lgkmcnt(2)
    ds_read_b64_tr_b16 v[60:61], v29 offset:36864
    ds_read_b64_tr_b16 v[62:63], v29 offset:37376
    v_mfma_f32_16x16x32_bf16 a[80:83], v[44:47], v[100:103], a[80:83]
    v_add_u32 v29, 0x10000, v29
    v_cvt_pk_bf16_f32 v235, v250, v251
    v_mfma_f32_16x16x32_bf16 a[84:87], v[40:43], v[104:107], a[84:87]
    buffer_load_dwordx4 v1, s[36:39], s100 offen offset:2048 sc1 lds
    v_mfma_f32_16x16x32_bf16 a[84:87], v[44:47], v[108:111], a[84:87]
    v_cvt_pk_bf16_f32 v202, v216, v217
    v_cvt_pk_bf16_f32 v203, v218, v219
    v_mfma_f32_16x16x32_bf16 a[88:91], v[40:43], v[112:115], a[88:91]
    v_cvt_pk_bf16_f32 v175, v190, v191
    v_cvt_pk_bf16_f32 v236, v236, v237
    v_mfma_f32_16x16x32_bf16 a[88:91], v[44:47], v[116:119], a[88:91]
    v_cvt_pk_bf16_f32 v237, v238, v239
    v_cvt_pk_bf16_f32 v238, v252, v253
    v_mfma_f32_16x16x32_bf16 a[92:95], v[40:43], v[120:123], a[92:95]
    buffer_load_dwordx4 v1, s[36:39], s100 offen offset:3072 sc1 lds
    v_mfma_f32_16x16x32_bf16 a[92:95], v[44:47], v[124:127], a[92:95]
    s_waitcnt vmcnt(8)
    ds_read_b64_tr_b16 v[40:41], v26 offset:0
    ds_read_b64_tr_b16 v[42:43], v26 offset:512
    v_mfma_f32_16x16x32_bf16 v[240:243], a[224:227], v[128:131], v[176:179]
    s_lshr_b32 s82, s4, 1
    s_add_u32 s82, s82, 32
    ds_read_b64_tr_b16 v[44:45], v26 offset:4096
    v_mfma_f32_16x16x32_bf16 v[240:243], a[228:231], v[160:163], v[240:243]
    s_sub_u32 s82, s82, s6
    ds_read_b64_tr_b16 v[46:47], v26 offset:4608
    v_cvt_pk_bf16_f32 v239, v254, v255
    v_mfma_f32_16x16x32_bf16 v[240:243], a[232:235], v[192:195], v[240:243]
    s_add_u32 s76, s76, 32768
    s_sub_u32 s82, s82, s6
    v_cvt_pk_bf16_f32 v204, v204, v205
    v_mfma_f32_16x16x32_bf16 v[240:243], a[236:239], v[224:227], v[240:243]
    s_add_u32 s77, s77, 32768
    s_lshl_b32 s38, s82, 15
    s_add_u32 m0, s76, s75
    v_mfma_f32_16x16x32_bf16 v[244:247], a[224:227], v[132:135], 0
    s_mov_b32 s82, 0
    buffer_load_dwordx4 v1, s[36:39], s77 offen sc1 lds
    v_mfma_f32_16x16x32_bf16 v[244:247], a[228:231], v[164:167], v[244:247]
    v_cvt_pk_bf16_f32 v205, v206, v207
    v_max3_f32 v147, v240, v241, v242
    v_mfma_f32_16x16x32_bf16 v[244:247], a[232:235], v[196:199], v[244:247]
    buffer_load_dwordx4 v1, s[36:39], s77 offen offset:1024 sc1 lds
    v_mfma_f32_16x16x32_bf16 v[244:247], a[236:239], v[228:231], v[244:247]
    v_max_f32 v147, v147, v243
    v_mov_b32 v146, v147
    v_mfma_f32_16x16x32_bf16 v[248:251], a[224:227], v[136:139], 0
    v_cvt_pk_bf16_f32 v206, v220, v221
    v_permlane32_swap_b32 v147, v146
    v_mfma_f32_16x16x32_bf16 v[248:251], a[228:231], v[168:171], v[248:251]
    v_max_f32 v147, v147, v146
    v_mov_b32 v146, v147
    v_mfma_f32_16x16x32_bf16 v[248:251], a[232:235], v[200:203], v[248:251]
    buffer_load_dwordx4 v1, s[36:39], s77 offen offset:2048 sc1 lds
    v_mfma_f32_16x16x32_bf16 v[248:251], a[236:239], v[232:235], v[248:251]
    v_max3_f32 v151, v244, v245, v246
    v_max_f32 v151, v151, v247
    v_mfma_f32_16x16x32_bf16 v[252:255], a[224:227], v[140:143], 0
    v_mov_b32 v150, v151
    v_permlane16_swap_b32 v147, v146
    v_mfma_f32_16x16x32_bf16 v[252:255], a[228:231], v[172:175], v[252:255]
    v_permlane32_swap_b32 v151, v150
    v_max_f32 v151, v151, v150
    v_cvt_pk_bf16_f32 v207, v222, v223
    s_nop 1
    v_mfma_f32_16x16x32_bf16 v[252:255], a[232:235], v[204:207], v[252:255]
    buffer_load_dwordx4 v1, s[36:39], s77 offen offset:3072 sc1 lds
    v_mfma_f32_16x16x32_bf16 v[252:255], a[236:239], v[236:239], v[252:255]
    v_max3_f32 v155, v248, v249, v250
    v_max_f32 v155, v155, v251
    v_mfma_f32_16x16x32_bf16 a[96:99], v[48:51], v[96:99], a[96:99]
    s_add_u32 s100, s77, 4096
    v_mov_b32 v154, v155
    v_mov_b32 v150, v151
    v_mfma_f32_16x16x32_bf16 a[96:99], v[52:55], v[100:103], a[96:99]
    s_add_u32 m0, m0, 4096
    v_max3_f32 v159, v252, v253, v254
    v_max_f32 v159, v159, v255
    v_mfma_f32_16x16x32_bf16 a[100:103], v[48:51], v[104:107], a[100:103]
    buffer_load_dwordx4 v1, s[36:39], s100 offen sc1 lds
    v_mfma_f32_16x16x32_bf16 a[100:103], v[52:55], v[108:111], a[100:103]
    v_mov_b32 v158, v159
    v_permlane32_swap_b32 v155, v154
    v_mfma_f32_16x16x32_bf16 a[104:107], v[48:51], v[112:115], a[104:107]
    v_permlane32_swap_b32 v159, v158
    v_max_f32 v155, v155, v154
    v_mfma_f32_16x16x32_bf16 a[104:107], v[52:55], v[116:119], a[104:107]
    v_max_f32 v159, v159, v158
    v_mov_b32 v154, v155
    v_mfma_f32_16x16x32_bf16 a[108:111], v[48:51], v[120:123], a[108:111]
    buffer_load_dwordx4 v1, s[36:39], s100 offen offset:1024 sc1 lds
    v_mfma_f32_16x16x32_bf16 a[108:111], v[52:55], v[124:127], a[108:111]
    s_waitcnt lgkmcnt(0)
    ds_read_b64_tr_b16 v[48:49], v27 offset:0
    ds_read_b64_tr_b16 v[50:51], v27 offset:512
    v_mfma_f32_16x16x32_bf16 a[112:115], v[56:59], v[96:99], a[112:115]
    ds_read_b64_tr_b16 v[52:53], v27 offset:4096
    ds_read_b64_tr_b16 v[54:55], v27 offset:4608
    v_mfma_f32_16x16x32_bf16 a[112:115], v[60:63], v[100:103], a[112:115]
    v_mov_b32 v158, v159
    v_permlane16_swap_b32 v151, v150
    v_mfma_f32_16x16x32_bf16 a[116:119], v[56:59], v[104:107], a[116:119]
    buffer_load_dwordx4 v1, s[36:39], s100 offen offset:2048 sc1 lds
    v_mfma_f32_16x16x32_bf16 a[116:119], v[60:63], v[108:111], a[116:119]
    v_permlane16_swap_b32 v155, v154
    v_permlane16_swap_b32 v159, v158
    v_mfma_f32_16x16x32_bf16 a[120:123], v[56:59], v[112:115], a[120:123]
    v_max_f32 v147, v147, v146
    v_max_f32 v151, v151, v150
    v_mfma_f32_16x16x32_bf16 a[120:123], v[60:63], v[116:119], a[120:123]
    v_max_f32 v155, v155, v154
    v_max_f32 v159, v159, v158
    v_mfma_f32_16x16x32_bf16 a[124:127], v[56:59], v[120:123], a[124:127]
    buffer_load_dwordx4 v1, s[36:39], s100 offen offset:3072 sc1 lds
    v_mfma_f32_16x16x32_bf16 a[124:127], v[60:63], v[124:127], a[124:127]
    ds_read_b64_tr_b16 v[56:57], v28 offset:0
    ds_read_b64_tr_b16 v[58:59], v28 offset:512
    v_mfma_f32_16x16x32_bf16 a[64:67], v[40:43], v[64:67], a[64:67]
    s_add_u32 s76, s76, 32768
    ds_read_b64_tr_b16 v[60:61], v28 offset:4096
    ds_read_b64_tr_b16 v[62:63], v28 offset:4608
    v_mfma_f32_16x16x32_bf16 a[64:67], v[44:47], v[68:71], a[64:67]
    s_add_u32 s77, s77, 32768
    v_sub_f32 v144, 0, v147
    v_sub_f32 v148, 0, v151
    v_mfma_f32_16x16x32_bf16 a[68:71], v[40:43], v[72:75], a[68:71]
    s_add_u32 m0, s76, s75
    v_sub_f32 v152, 0, v155
    v_sub_f32 v156, 0, v159
    v_mfma_f32_16x16x32_bf16 a[68:71], v[44:47], v[76:79], a[68:71]
    buffer_load_dwordx4 v1, s[36:39], s77 offen sc1 lds
    v_mfma_f32_16x16x32_bf16 a[72:75], v[40:43], v[80:83], a[72:75]
    v_sub_f32 v145, 0, v147
    v_sub_f32 v146, 0, v147
    v_mfma_f32_16x16x32_bf16 a[72:75], v[44:47], v[84:87], a[72:75]
    v_sub_f32 v147, 0, v147
    v_sub_f32 v149, 0, v151
    v_mfma_f32_16x16x32_bf16 a[76:79], v[40:43], v[88:91], a[76:79]
    buffer_load_dwordx4 v1, s[36:39], s77 offen offset:1024 sc1 lds
    v_mfma_f32_16x16x32_bf16 a[76:79], v[44:47], v[92:95], a[76:79]
    s_waitcnt lgkmcnt(0)
    ds_read_b64_tr_b16 v[40:41], v29 offset:0
    ds_read_b64_tr_b16 v[42:43], v29 offset:512
    v_mfma_f32_16x16x32_bf16 a[80:83], v[48:51], v[64:67], a[80:83]
    ds_read_b64_tr_b16 v[44:45], v29 offset:4096
    ds_read_b64_tr_b16 v[46:47], v29 offset:4608
    v_mfma_f32_16x16x32_bf16 a[80:83], v[52:55], v[68:71], a[80:83]
    v_sub_f32 v150, 0, v151
    v_sub_f32 v151, 0, v151
    v_mfma_f32_16x16x32_bf16 a[84:87], v[48:51], v[72:75], a[84:87]
    buffer_load_dwordx4 v1, s[36:39], s77 offen offset:2048 sc1 lds
    v_mfma_f32_16x16x32_bf16 a[84:87], v[52:55], v[76:79], a[84:87]
    v_sub_f32 v153, 0, v155
    v_sub_f32 v154, 0, v155
    v_mfma_f32_16x16x32_bf16 a[88:91], v[48:51], v[80:83], a[88:91]
    v_sub_f32 v155, 0, v155
    v_sub_f32 v157, 0, v159
    v_mfma_f32_16x16x32_bf16 a[88:91], v[52:55], v[84:87], a[88:91]
    v_sub_f32 v158, 0, v159
    v_sub_f32 v159, 0, v159
    v_mfma_f32_16x16x32_bf16 a[92:95], v[48:51], v[88:91], a[92:95]
    buffer_load_dwordx4 v1, s[36:39], s77 offen offset:3072 sc1 lds
    v_mfma_f32_16x16x32_bf16 a[92:95], v[52:55], v[92:95], a[92:95]
    v_or_b32 v215, 0x44444444, v38
    v_bfe_u32 v38, v1, 5, 1
    v_mfma_f32_16x16x32_bf16 a[96:99], v[56:59], v[64:67], a[96:99]
    s_add_u32 s100, s77, 4096
    v_cmp_eq_u32 vcc, 0, v38
    v_mov_b32 v38, 0x3f803f80
    v_mfma_f32_16x16x32_bf16 a[96:99], v[60:63], v[68:71], a[96:99]
    s_add_u32 m0, m0, 4096
    v_and_b32 v29, 0x380, v1
    v_cndmask_b32 v38, 0, v38, vcc
    v_mfma_f32_16x16x32_bf16 a[100:103], v[56:59], v[72:75], a[100:103]
    buffer_load_dwordx4 v1, s[36:39], s100 offen sc1 lds
    v_mfma_f32_16x16x32_bf16 a[100:103], v[60:63], v[76:79], a[100:103]
    v_add_f32 v240, v240, v144
    v_add_f32 v241, v241, v144
    v_mfma_f32_16x16x32_bf16 a[104:107], v[56:59], v[80:83], a[104:107]
    v_add_f32 v242, v242, v144
    v_add_f32 v243, v243, v144
    v_mfma_f32_16x16x32_bf16 a[104:107], v[60:63], v[84:87], a[104:107]
    s_waitcnt vmcnt(13) lgkmcnt(0)
    s_barrier
    ds_read_b128 a[240:243], v2 offset:4096
    v_mfma_f32_16x16x32_bf16 a[108:111], v[56:59], v[88:91], a[108:111]
    ds_read_b128 a[244:247], v2 offset:5120
    ds_read_b128 a[248:251], v2 offset:6144
    v_mfma_f32_16x16x32_bf16 a[108:111], v[60:63], v[92:95], a[108:111]
    buffer_load_dwordx4 v1, s[36:39], s100 offen offset:1024 sc1 lds
    v_mfma_f32_16x16x32_bf16 a[112:115], v[40:43], v[64:67], a[112:115]
    ds_read_b128 a[252:255], v2 offset:7168
    v_add_f32 v244, v244, v148
    v_mfma_f32_16x16x32_bf16 a[112:115], v[44:47], v[68:71], a[112:115]
    v_add_f32 v245, v245, v148
    v_add_f32 v246, v246, v148
    v_mfma_f32_16x16x32_bf16 a[116:119], v[40:43], v[72:75], a[116:119]
    buffer_load_dwordx4 v1, s[36:39], s100 offen offset:2048 sc1 lds
    v_mfma_f32_16x16x32_bf16 a[116:119], v[44:47], v[76:79], a[116:119]
    v_add_f32 v247, v247, v148
    v_add_f32 v248, v248, v152
    v_mfma_f32_16x16x32_bf16 a[120:123], v[40:43], v[80:83], a[120:123]
    v_add_f32 v249, v249, v152
    v_add_f32 v250, v250, v152
    v_mfma_f32_16x16x32_bf16 a[120:123], v[44:47], v[84:87], a[120:123]
    v_add_f32 v251, v251, v152
    v_add_f32 v252, v252, v156
    v_mfma_f32_16x16x32_bf16 a[124:127], v[40:43], v[88:91], a[124:127]
    buffer_load_dwordx4 v1, s[36:39], s100 offen offset:3072 sc1 lds
    v_mfma_f32_16x16x32_bf16 a[124:127], v[44:47], v[92:95], a[124:127]
    v_add_f32 v253, v253, v156
    v_add_f32 v254, v254, v156
    v_add_f32 v255, v255, v156
    v_lshl_add_u32 v29, v29, 4, v39
    v_bfe_u32 v39, v1, 2, 4
    v_accvgpr_write_b32 a136, v38
    v_accvgpr_write_b32 a137, v38
    v_accvgpr_write_b32 a138, v38
    v_accvgpr_write_b32 a139, v38
    v_exp_f32 v240, v240
    v_exp_f32 v241, v241
    v_exp_f32 v242, v242
    v_exp_f32 v243, v243
    v_exp_f32 v244, v244
    v_exp_f32 v245, v245
    v_exp_f32 v246, v246
    v_exp_f32 v247, v247
    v_exp_f32 v248, v248
    v_exp_f32 v249, v249
    v_exp_f32 v250, v250
    v_exp_f32 v251, v251
    v_exp_f32 v252, v252
    v_exp_f32 v253, v253
    v_exp_f32 v254, v254
    v_exp_f32 v255, v255
    buffer_store_dwordx4 a[68:71], v1, s[40:43], s84 offen offset:2048 sc1
    buffer_store_dwordx4 a[76:79], v1, s[40:43], s85 offen offset:2048 sc1
    buffer_store_dwordx4 a[84:87], v1, s[40:43], s84 offen offset:1024 sc1
    buffer_store_dwordx4 a[92:95], v1, s[40:43], s85 offen offset:1024 sc1
    buffer_store_dwordx4 a[100:103], v1, s[40:43], s84 offen offset:0 sc1
    buffer_store_dwordx4 a[108:111], v1, s[40:43], s85 offen offset:0 sc1
    v_lshl_add_u32 v29, v29, 1, v39
    s_add_u32 s77, s77, 32768
    s_add_u32 s76, s76, 32768
K1_ATT:
    v_cvt_pk_bf16_f32 v32, v240, v241
    v_cvt_pk_bf16_f32 v33, v242, v243
    v_add_f32 v213, s21, v144
    v_fma_f32 v180, v208, s17, v213
    v_fma_f32 v181, v209, s17, v213
    v_fma_f32 v182, v210, s17, v213
    v_fma_f32 v183, v211, s17, v213
    s_nop 1
    s_waitcnt lgkmcnt(0)
    v_mfma_f32_16x16x32_bf16 v[240:243], a[240:243], v[128:131], v[180:183]
    s_mov_b32 s99, s76
    v_cvt_pk_bf16_f32 v40, v244, v245
    v_cvt_pk_bf16_f32 v41, v246, v247
    v_mfma_f32_16x16x32_bf16 v[240:243], a[244:247], v[160:163], v[240:243]
    s_sub_u32 s7, 15, s6
    v_cvt_pk_bf16_f32 v48, v248, v249
    v_cvt_pk_bf16_f32 v49, v250, v251
    v_mfma_f32_16x16x32_bf16 v[240:243], a[248:251], v[192:195], v[240:243]
    s_lshl3_add_u32 s80, s6, s4
    ds_read_b128 a[224:227], v2 offset:8192
    ds_read_b128 a[228:231], v2 offset:9216
    v_mfma_f32_16x16x32_bf16 v[240:243], a[252:255], v[224:227], v[240:243]
    s_lshl3_add_u32 s81, s7, s4
    ds_read_b128 a[232:235], v2 offset:10240
    v_cvt_pk_bf16_f32 v56, v252, v253
    v_mfma_f32_16x16x32_bf16 v[244:247], a[240:243], v[132:135], v[148:151]
    s_add_u32 m0, s76, s75
    ds_read_b128 a[236:239], v2 offset:11264
    v_cvt_pk_bf16_f32 v57, v254, v255
    v_mfma_f32_16x16x32_bf16 v[244:247], a[244:247], v[164:167], v[244:247]
    s_mov_b32 s76, s60
    buffer_load_dwordx4 v1, s[36:39], s77 offen sc1 lds
    v_mfma_f32_16x16x32_bf16 v[244:247], a[248:251], v[196:199], v[244:247]
    s_mov_b32 s60, s82
    v_exp_f32 v240, v240
    v_mfma_f32_16x16x32_bf16 v[244:247], a[252:255], v[228:231], v[244:247]
    s_mov_b32 s82, s95
    buffer_load_dwordx4 v1, s[36:39], s77 offen offset:1024 sc1 lds
    v_mfma_f32_16x16x32_bf16 v[248:251], a[240:243], v[136:139], v[152:155]
    s_mov_b32 s95, s93
    v_exp_f32 v241, v241
    v_mfma_f32_16x16x32_bf16 v[248:251], a[244:247], v[168:171], v[248:251]
    s_mov_b32 s93, s99
    v_exp_f32 v242, v242
    v_mfma_f32_16x16x32_bf16 v[248:251], a[248:251], v[200:203], v[248:251]
    s_mul_i32 s80, s80, 155648
    buffer_load_dwordx4 v1, s[36:39], s77 offen offset:2048 sc1 lds
    v_mfma_f32_16x16x32_bf16 v[248:251], a[252:255], v[232:235], v[248:251]
    s_mul_i32 s81, s81, 155648
    v_exp_f32 v243, v243
    v_mfma_f32_16x16x32_bf16 v[252:255], a[240:243], v[140:143], v[156:159]
    s_lshl_b32 s7, s5, 12
    v_cvt_pk_bf16_f32 v34, v240, v241
    v_cvt_pk_bf16_f32 v35, v242, v243
    v_mfma_f32_16x16x32_bf16 v[252:255], a[244:247], v[172:175], v[252:255]
    s_add_u32 s80, s80, s7
    buffer_load_dwordx4 v1, s[36:39], s77 offen offset:3072 sc1 lds
    v_mfma_f32_16x16x32_bf16 v[252:255], a[248:251], v[204:207], v[252:255]
    s_add_u32 s81, s81, s7
    v_exp_f32 v244, v244
    v_mfma_f32_16x16x32_bf16 v[252:255], a[252:255], v[236:239], v[252:255]
    s_add_u32 s100, s77, 4096
    v_exp_f32 v245, v245
    v_add_f32 v212, s20, v144
    v_fma_f32 v176, v208, s16, v212
    v_fma_f32 v177, v209, s16, v212
    v_fma_f32 v178, v210, s16, v212
    v_fma_f32 v179, v211, s16, v212
    v_add_f32 v212, s22, v144
    v_fma_f32 v184, v208, s18, v212
    v_fma_f32 v185, v209, s18, v212
    v_fma_f32 v186, v210, s18, v212
    v_fma_f32 v187, v211, s18, v212
    s_nop 1
    s_waitcnt lgkmcnt(0)
    v_mfma_f32_16x16x32_bf16 v[240:243], a[224:227], v[128:131], v[184:187]
    s_add_u32 m0, m0, 4096
    v_exp_f32 v246, v246
    v_mfma_f32_16x16x32_bf16 v[240:243], a[228:231], v[160:163], v[240:243]
    s_lshr_b32 s7, s5, 3
    v_exp_f32 v247, v247
    v_mfma_f32_16x16x32_bf16 v[240:243], a[232:235], v[192:195], v[240:243]
    s_lshl2_add_u32 s7, s7, s4
    buffer_load_dwordx4 v1, s[36:39], s100 offen sc1 lds
    v_mfma_f32_16x16x32_bf16 v[240:243], a[236:239], v[224:227], v[240:243]
    s_lshl_b32 s7, s7, 8
    v_cvt_pk_bf16_f32 v42, v244, v245
    v_cvt_pk_bf16_f32 v43, v246, v247
    v_mfma_f32_16x16x32_bf16 v[244:247], a[224:227], v[132:135], v[148:151]
    s_mov_b64 s[84:85], 0
    v_exp_f32 v248, v248
    v_mfma_f32_16x16x32_bf16 v[244:247], a[228:231], v[164:167], v[244:247]
    s_add_u32 s92, s7, 163840
    buffer_load_dwordx4 v1, s[36:39], s100 offen offset:1024 sc1 lds
    v_mfma_f32_16x16x32_bf16 v[244:247], a[232:235], v[196:199], v[244:247]
    s_mov_b64 s[24:25], s[0:1]
    v_exp_f32 v249, v249
    v_mfma_f32_16x16x32_bf16 v[244:247], a[236:239], v[228:231], v[244:247]
    s_mov_b32 s78, s6
    v_exp_f32 v250, v250
    v_exp_f32 v251, v251
    v_cvt_pk_bf16_f32 v50, v248, v249
    v_cvt_pk_bf16_f32 v51, v250, v251
    v_mfma_f32_16x16x32_bf16 v[248:251], a[224:227], v[136:139], v[152:155]
    s_mov_b32 s26, 2359296
    ds_read_b128 a[240:243], v2 offset:12288
    ds_read_b128 a[244:247], v2 offset:13312
    v_mfma_f32_16x16x32_bf16 v[248:251], a[228:231], v[168:171], v[248:251]
    s_mov_b32 s27, 0x20000
    buffer_load_dwordx4 v1, s[36:39], s100 offen offset:2048 sc1 lds
    v_mfma_f32_16x16x32_bf16 v[248:251], a[232:235], v[200:203], v[248:251]
    s_add_u32 s77, s77, 32768
    ds_read_b128 a[248:251], v2 offset:14336
    ds_read_b128 a[252:255], v2 offset:15360
    v_mfma_f32_16x16x32_bf16 v[248:251], a[236:239], v[232:235], v[248:251]
    v_exp_f32 v252, v252
    v_exp_f32 v253, v253
    v_exp_f32 v254, v254
    v_exp_f32 v255, v255
    v_cvt_pk_bf16_f32 v58, v252, v253
    v_cvt_pk_bf16_f32 v59, v254, v255
    v_mfma_f32_16x16x32_bf16 v[252:255], a[224:227], v[140:143], v[156:159]
    v_add_f32 v213, s23, v144
    v_fma_f32 v188, v208, s19, v213
    v_mfma_f32_16x16x32_bf16 v[252:255], a[228:231], v[172:175], v[252:255]
    buffer_load_dwordx4 v1, s[36:39], s100 offen offset:3072 sc1 lds
    v_mfma_f32_16x16x32_bf16 v[252:255], a[232:235], v[204:207], v[252:255]
    v_exp_f32 v240, v240
    v_mfma_f32_16x16x32_bf16 v[252:255], a[236:239], v[236:239], v[252:255]
    s_waitcnt lgkmcnt(0)
    v_exp_f32 v241, v241
    v_exp_f32 v242, v242
    v_exp_f32 v243, v243
    v_fma_f32 v189, v209, s19, v213
    v_fma_f32 v190, v210, s19, v213
    v_fma_f32 v191, v211, s19, v213
    v_cvt_pk_bf16_f32 v36, v240, v241
    v_cvt_pk_bf16_f32 v37, v242, v243
    v_mfma_f32_16x16x32_bf16 v[240:243], a[240:243], v[128:131], v[188:191]
    v_exp_f32 v244, v244
    v_mfma_f32_16x16x32_bf16 v[240:243], a[244:247], v[160:163], v[240:243]
    v_exp_f32 v245, v245
    v_mfma_f32_16x16x32_bf16 v[240:243], a[248:251], v[192:195], v[240:243]
    s_waitcnt vmcnt(8) lgkmcnt(0)
    v_exp_f32 v246, v246
    v_mfma_f32_16x16x32_bf16 v[240:243], a[252:255], v[224:227], v[240:243]
    s_barrier
    v_exp_f32 v247, v247
    v_cvt_pk_bf16_f32 v44, v244, v245
    v_cvt_pk_bf16_f32 v45, v246, v247
    v_mfma_f32_16x16x32_bf16 v[244:247], a[240:243], v[132:135], v[148:151]
    v_add_u32 v2, s82, v1
    ds_read_b128 a[224:227], v2 offset:0
    v_mfma_f32_16x16x32_bf16 v[244:247], a[244:247], v[164:167], v[244:247]
    ds_read_b128 a[228:231], v2 offset:1024
    ds_read_b128 a[232:235], v2 offset:2048
    v_mfma_f32_16x16x32_bf16 v[244:247], a[248:251], v[196:199], v[244:247]
    v_exp_f32 v248, v248
    v_mfma_f32_16x16x32_bf16 v[244:247], a[252:255], v[228:231], v[244:247]
    v_exp_f32 v249, v249
    v_exp_f32 v250, v250
    v_exp_f32 v251, v251
    v_cvt_pk_bf16_f32 v52, v248, v249
    v_cvt_pk_bf16_f32 v53, v250, v251
    v_mfma_f32_16x16x32_bf16 v[248:251], a[240:243], v[136:139], v[152:155]
    ds_read_b128 a[236:239], v2 offset:3072
    ds_read_b128 v[96:99], v2 offset:16384
    v_mfma_f32_16x16x32_bf16 v[248:251], a[244:247], v[168:171], v[248:251]
    v_exp_f32 v252, v252
    v_mfma_f32_16x16x32_bf16 v[248:251], a[248:251], v[200:203], v[248:251]
    v_exp_f32 v253, v253
    v_mfma_f32_16x16x32_bf16 v[248:251], a[252:255], v[232:235], v[248:251]
    v_exp_f32 v254, v254
    v_exp_f32 v255, v255
    v_cvt_pk_bf16_f32 v60, v252, v253
    v_cvt_pk_bf16_f32 v61, v254, v255
    v_mfma_f32_16x16x32_bf16 v[252:255], a[240:243], v[140:143], v[156:159]
    ds_read_b128 v[100:103], v2 offset:17408
    v_mfma_f32_16x16x32_bf16 v[252:255], a[244:247], v[172:175], v[252:255]
    v_exp_f32 v240, v240
    v_mfma_f32_16x16x32_bf16 v[252:255], a[248:251], v[204:207], v[252:255]
    v_exp_f32 v241, v241
    v_mfma_f32_16x16x32_bf16 v[252:255], a[252:255], v[236:239], v[252:255]
    v_exp_f32 v242, v242
    v_exp_f32 v243, v243
    v_exp_f32 v244, v244
    v_exp_f32 v245, v245
    v_exp_f32 v246, v246
    v_exp_f32 v247, v247
    v_exp_f32 v248, v248
    v_exp_f32 v249, v249
    v_exp_f32 v250, v250
    v_exp_f32 v251, v251
    v_cvt_pk_bf16_f32 v38, v240, v241
    v_cvt_pk_bf16_f32 v39, v242, v243
    v_cvt_pk_bf16_f32 v46, v244, v245
    v_cvt_pk_bf16_f32 v47, v246, v247
    v_cvt_pk_bf16_f32 v54, v248, v249
    v_cvt_pk_bf16_f32 v55, v250, v251
    v_exp_f32 v252, v252
    v_mov_b32 v28, 2
    s_cmp_eq_u32 s4, 3
    s_cselect_b32 s7, s101, 1073741824
    v_lshlrev_b32 v31, 20, v1
    buffer_store_dword v28, v31, s[32:35], s7 offen sc1
    s_cmp_eq_u32 s78, 0
    s_cbranch_scc1 K1_LB_END
.p2align 3
K1_LB:
    s_waitcnt lgkmcnt(0)
    v_mfma_f32_16x16x32_bf16 v[240:243], a[224:227], v[128:131], v[176:179]
    s_mov_b32 s99, s76
    v_exp_f32 v253, v253
    v_mfma_f32_16x16x32_bf16 v[240:243], a[228:231], v[160:163], v[240:243]
    v_exp_f32 v254, v254
    v_mfma_f32_16x16x32_bf16 v[240:243], a[232:235], v[192:195], v[240:243]
    v_exp_f32 v255, v255
    v_mfma_f32_16x16x32_bf16 v[240:243], a[236:239], v[224:227], v[240:243]
    v_cvt_pk_bf16_f32 v62, v252, v253
    v_cvt_pk_bf16_f32 v63, v254, v255
    v_mfma_f32_16x16x32_bf16 a[0:3], v[96:99], v[32:35], a[0:3]
    s_add_u32 m0, s76, s75
    v_mfma_f32_16x16x32_bf16 a[0:3], v[100:103], v[36:39], a[0:3]
    s_mov_b32 s76, s60
    buffer_load_dwordx4 v1, s[36:39], s77 offen sc1 lds
    v_mfma_f32_16x16x32_bf16 a[4:7], v[96:99], v[40:43], a[4:7]
    s_mov_b32 s60, s82
    ds_read_b128 v[104:107], v2 offset:18432
    ds_read_b128 v[108:111], v2 offset:19456
    v_mfma_f32_16x16x32_bf16 a[4:7], v[100:103], v[44:47], a[4:7]
    s_mov_b32 s82, s95
    v_exp_f32 v240, v240
    v_mfma_f32_16x16x32_bf16 v[244:247], a[224:227], v[132:135], v[148:151]
    s_mov_b32 s95, s93
    v_exp_f32 v241, v241
    v_mfma_f32_16x16x32_bf16 v[244:247], a[228:231], v[164:167], v[244:247]
    s_mov_b32 s93, s99
    v_exp_f32 v242, v242
    v_mfma_f32_16x16x32_bf16 v[244:247], a[232:235], v[196:199], v[244:247]
    v_exp_f32 v243, v243
    v_mfma_f32_16x16x32_bf16 v[244:247], a[236:239], v[228:231], v[244:247]
    v_cvt_pk_bf16_f32 v64, v240, v241
    v_cvt_pk_bf16_f32 v65, v242, v243
    v_mfma_f32_16x16x32_bf16 a[8:11], v[96:99], v[48:51], a[8:11]
    v_mfma_f32_16x16x32_bf16 a[8:11], v[100:103], v[52:55], a[8:11]
    v_mfma_f32_16x16x32_bf16 a[12:15], v[96:99], v[56:59], a[12:15]
    v_mfma_f32_16x16x32_bf16 a[12:15], v[100:103], v[60:63], a[12:15]
    v_mfma_f32_16x16x32_bf16 v[248:251], a[224:227], v[136:139], v[152:155]
    v_mfma_f32_16x16x32_bf16 v[248:251], a[228:231], v[168:171], v[248:251]
    ds_read_b128 a[240:243], v2 offset:4096
    ds_read_b128 a[244:247], v2 offset:5120
    v_mfma_f32_16x16x32_bf16 v[248:251], a[232:235], v[200:203], v[248:251]
    buffer_load_dwordx4 v1, s[36:39], s77 offen offset:1024 sc1 lds
    v_mfma_f32_16x16x32_bf16 v[248:251], a[236:239], v[232:235], v[248:251]
    s_waitcnt lgkmcnt(2)
    ds_read_b128 a[248:251], v2 offset:6144
    ds_read_b128 a[252:255], v2 offset:7168
    v_mfma_f32_16x16x32_bf16 a[16:19], v[104:107], v[32:35], a[16:19]
    v_exp_f32 v244, v244
    v_mfma_f32_16x16x32_bf16 a[16:19], v[108:111], v[36:39], a[16:19]
    ds_read_b128 v[112:115], v2 offset:20480
    ds_read_b128 v[116:119], v2 offset:21504
    v_mfma_f32_16x16x32_bf16 a[20:23], v[104:107], v[40:43], a[20:23]
    v_exp_f32 v245, v245
    v_mfma_f32_16x16x32_bf16 a[20:23], v[108:111], v[44:47], a[20:23]
    v_exp_f32 v246, v246
    v_mfma_f32_16x16x32_bf16 v[252:255], a[224:227], v[140:143], v[156:159]
    v_exp_f32 v247, v247
    v_mfma_f32_16x16x32_bf16 v[252:255], a[228:231], v[172:175], v[252:255]
    v_cvt_pk_bf16_f32 v72, v244, v245
    v_cvt_pk_bf16_f32 v73, v246, v247
    v_mfma_f32_16x16x32_bf16 v[252:255], a[232:235], v[204:207], v[252:255]
    v_exp_f32 v248, v248
    v_mfma_f32_16x16x32_bf16 v[252:255], a[236:239], v[236:239], v[252:255]
    v_exp_f32 v249, v249
    v_mfma_f32_16x16x32_bf16 a[24:27], v[104:107], v[48:51], a[24:27]
    v_exp_f32 v250, v250
    v_mfma_f32_16x16x32_bf16 a[24:27], v[108:111], v[52:55], a[24:27]
    v_exp_f32 v251, v251
    v_mfma_f32_16x16x32_bf16 a[28:31], v[104:107], v[56:59], a[28:31]
    v_cvt_pk_bf16_f32 v80, v248, v249
    v_cvt_pk_bf16_f32 v81, v250, v251
    v_mfma_f32_16x16x32_bf16 a[28:31], v[108:111], v[60:63], a[28:31]
    s_waitcnt lgkmcnt(0)
    buffer_load_dwordx4 v1, s[36:39], s77 offen offset:2048 sc1 lds
    v_mfma_f32_16x16x32_bf16 v[240:243], a[240:243], v[128:131], v[180:183]
    v_exp_f32 v252, v252
    v_mfma_f32_16x16x32_bf16 v[240:243], a[244:247], v[160:163], v[240:243]
    v_exp_f32 v253, v253
    v_mfma_f32_16x16x32_bf16 v[240:243], a[248:251], v[192:195], v[240:243]
    v_exp_f32 v254, v254
    v_mfma_f32_16x16x32_bf16 v[240:243], a[252:255], v[224:227], v[240:243]
    v_exp_f32 v255, v255
    v_mfma_f32_16x16x32_bf16 a[32:35], v[112:115], v[32:35], a[32:35]
    v_cvt_pk_bf16_f32 v88, v252, v253
    v_cvt_pk_bf16_f32 v89, v254, v255
    v_mfma_f32_16x16x32_bf16 a[32:35], v[116:119], v[36:39], a[32:35]
    ds_read_b128 v[120:123], v2 offset:22528
    ds_read_b128 v[124:127], v2 offset:23552
    v_mfma_f32_16x16x32_bf16 a[36:39], v[112:115], v[40:43], a[36:39]
    v_exp_f32 v240, v240
    v_mfma_f32_16x16x32_bf16 a[36:39], v[116:119], v[44:47], a[36:39]
    v_exp_f32 v241, v241
    v_mfma_f32_16x16x32_bf16 v[244:247], a[240:243], v[132:135], v[148:151]
    v_exp_f32 v242, v242
    v_mfma_f32_16x16x32_bf16 v[244:247], a[244:247], v[164:167], v[244:247]
    v_exp_f32 v243, v243
    v_mfma_f32_16x16x32_bf16 v[244:247], a[248:251], v[196:199], v[244:247]
    v_cvt_pk_bf16_f32 v66, v240, v241
    v_cvt_pk_bf16_f32 v67, v242, v243
    v_mfma_f32_16x16x32_bf16 v[244:247], a[252:255], v[228:231], v[244:247]
    v_mfma_f32_16x16x32_bf16 a[40:43], v[112:115], v[48:51], a[40:43]
    buffer_load_dwordx4 v1, s[36:39], s77 offen offset:3072 sc1 lds
    v_mfma_f32_16x16x32_bf16 a[40:43], v[116:119], v[52:55], a[40:43]
    v_mfma_f32_16x16x32_bf16 a[44:47], v[112:115], v[56:59], a[44:47]
    v_mfma_f32_16x16x32_bf16 a[44:47], v[116:119], v[60:63], a[44:47]
    v_mfma_f32_16x16x32_bf16 v[248:251], a[240:243], v[136:139], v[152:155]
    v_mfma_f32_16x16x32_bf16 v[248:251], a[244:247], v[168:171], v[248:251]
    ds_read_b128 a[224:227], v2 offset:8192
    ds_read_b128 a[228:231], v2 offset:9216
    v_mfma_f32_16x16x32_bf16 v[248:251], a[248:251], v[200:203], v[248:251]
    v_exp_f32 v244, v244
    v_mfma_f32_16x16x32_bf16 v[248:251], a[252:255], v[232:235], v[248:251]
    s_waitcnt lgkmcnt(2)
    ds_read_b128 a[232:235], v2 offset:10240
    ds_read_b128 a[236:239], v2 offset:11264
    v_mfma_f32_16x16x32_bf16 a[48:51], v[120:123], v[32:35], a[48:51]
    v_exp_f32 v245, v245
    v_mfma_f32_16x16x32_bf16 a[48:51], v[124:127], v[36:39], a[48:51]
    ds_read_b128 v[96:99], v2 offset:24576
    ds_read_b128 v[100:103], v2 offset:25600
    v_mfma_f32_16x16x32_bf16 a[52:55], v[120:123], v[40:43], a[52:55]
    v_exp_f32 v246, v246
    v_mfma_f32_16x16x32_bf16 a[52:55], v[124:127], v[44:47], a[52:55]
    v_exp_f32 v247, v247
    v_mfma_f32_16x16x32_bf16 v[252:255], a[240:243], v[140:143], v[156:159]
    v_cvt_pk_bf16_f32 v74, v244, v245
    v_cvt_pk_bf16_f32 v75, v246, v247
    v_mfma_f32_16x16x32_bf16 v[252:255], a[244:247], v[172:175], v[252:255]
    s_add_u32 s100, s77, 4096
    v_exp_f32 v248, v248
    v_mfma_f32_16x16x32_bf16 v[252:255], a[248:251], v[204:207], v[252:255]
    s_add_u32 m0, m0, 4096
    v_exp_f32 v249, v249
    v_mfma_f32_16x16x32_bf16 v[252:255], a[252:255], v[236:239], v[252:255]
    buffer_load_dwordx4 v1, s[36:39], s100 offen sc1 lds
    v_mfma_f32_16x16x32_bf16 a[56:59], v[120:123], v[48:51], a[56:59]
    v_exp_f32 v250, v250
    v_mfma_f32_16x16x32_bf16 a[56:59], v[124:127], v[52:55], a[56:59]
    v_exp_f32 v251, v251
    v_mfma_f32_16x16x32_bf16 a[60:63], v[120:123], v[56:59], a[60:63]
    v_cvt_pk_bf16_f32 v82, v248, v249
    v_cvt_pk_bf16_f32 v83, v250, v251
    v_mfma_f32_16x16x32_bf16 a[60:63], v[124:127], v[60:63], a[60:63]
    s_waitcnt lgkmcnt(0)
    v_exp_f32 v252, v252
    v_mfma_f32_16x16x32_bf16 v[240:243], a[224:227], v[128:131], v[184:187]
    v_exp_f32 v253, v253
    v_mfma_f32_16x16x32_bf16 v[240:243], a[228:231], v[160:163], v[240:243]
    v_exp_f32 v254, v254
    v_mfma_f32_16x16x32_bf16 v[240:243], a[232:235], v[192:195], v[240:243]
    v_exp_f32 v255, v255
    v_mfma_f32_16x16x32_bf16 v[240:243], a[236:239], v[224:227], v[240:243]
    v_cvt_pk_bf16_f32 v90, v252, v253
    v_cvt_pk_bf16_f32 v91, v254, v255
    v_mfma_f32_16x16x32_bf16 a[144:147], v[96:99], v[32:35], a[144:147]
    v_mfma_f32_16x16x32_bf16 a[144:147], v[100:103], v[36:39], a[144:147]
    ds_read_b128 v[104:107], v2 offset:26624
    ds_read_b128 v[108:111], v2 offset:27648
    v_mfma_f32_16x16x32_bf16 a[148:151], v[96:99], v[40:43], a[148:151]
    v_mfma_f32_16x16x32_bf16 a[148:151], v[100:103], v[44:47], a[148:151]
    buffer_load_dwordx4 v1, s[36:39], s100 offen offset:1024 sc1 lds
    v_mfma_f32_16x16x32_bf16 v[244:247], a[224:227], v[132:135], v[148:151]
    v_exp_f32 v240, v240
    v_mfma_f32_16x16x32_bf16 v[244:247], a[228:231], v[164:167], v[244:247]
    v_exp_f32 v241, v241
    v_mfma_f32_16x16x32_bf16 v[244:247], a[232:235], v[196:199], v[244:247]
    v_exp_f32 v242, v242
    v_mfma_f32_16x16x32_bf16 v[244:247], a[236:239], v[228:231], v[244:247]
    v_exp_f32 v243, v243
    v_mfma_f32_16x16x32_bf16 a[152:155], v[96:99], v[48:51], a[152:155]
    v_cvt_pk_bf16_f32 v68, v240, v241
    v_cvt_pk_bf16_f32 v69, v242, v243
    v_mfma_f32_16x16x32_bf16 a[152:155], v[100:103], v[52:55], a[152:155]
    v_mfma_f32_16x16x32_bf16 a[156:159], v[96:99], v[56:59], a[156:159]
    v_mfma_f32_16x16x32_bf16 a[156:159], v[100:103], v[60:63], a[156:159]
    v_mfma_f32_16x16x32_bf16 v[248:251], a[224:227], v[136:139], v[152:155]
    v_exp_f32 v244, v244
    v_mfma_f32_16x16x32_bf16 v[248:251], a[228:231], v[168:171], v[248:251]
    ds_read_b128 a[240:243], v2 offset:12288
    ds_read_b128 a[244:247], v2 offset:13312
    v_mfma_f32_16x16x32_bf16 v[248:251], a[232:235], v[200:203], v[248:251]
    v_exp_f32 v245, v245
    v_mfma_f32_16x16x32_bf16 v[248:251], a[236:239], v[232:235], v[248:251]
    s_waitcnt lgkmcnt(2)
    ds_read_b128 a[248:251], v2 offset:14336
    ds_read_b128 a[252:255], v2 offset:15360
    v_mfma_f32_16x16x32_bf16 a[160:163], v[104:107], v[32:35], a[160:163]
    buffer_load_dwordx4 v1, s[36:39], s100 offen offset:2048 sc1 lds
    v_mfma_f32_16x16x32_bf16 a[160:163], v[108:111], v[36:39], a[160:163]
    ds_read_b128 v[112:115], v2 offset:28672
    ds_read_b128 v[116:119], v2 offset:29696
    v_mfma_f32_16x16x32_bf16 a[164:167], v[104:107], v[40:43], a[164:167]
    v_exp_f32 v246, v246
    v_mfma_f32_16x16x32_bf16 a[164:167], v[108:111], v[44:47], a[164:167]
    v_exp_f32 v247, v247
    v_mfma_f32_16x16x32_bf16 v[252:255], a[224:227], v[140:143], v[156:159]
    v_cvt_pk_bf16_f32 v76, v244, v245
    v_cvt_pk_bf16_f32 v77, v246, v247
    v_mfma_f32_16x16x32_bf16 v[252:255], a[228:231], v[172:175], v[252:255]
    v_exp_f32 v248, v248
    v_mfma_f32_16x16x32_bf16 v[252:255], a[232:235], v[204:207], v[252:255]
    v_exp_f32 v249, v249
    v_mfma_f32_16x16x32_bf16 v[252:255], a[236:239], v[236:239], v[252:255]
    v_exp_f32 v250, v250
    v_mfma_f32_16x16x32_bf16 a[168:171], v[104:107], v[48:51], a[168:171]
    v_exp_f32 v251, v251
    v_mfma_f32_16x16x32_bf16 a[168:171], v[108:111], v[52:55], a[168:171]
    v_cvt_pk_bf16_f32 v84, v248, v249
    v_cvt_pk_bf16_f32 v85, v250, v251
    v_mfma_f32_16x16x32_bf16 a[172:175], v[104:107], v[56:59], a[172:175]
    v_mfma_f32_16x16x32_bf16 a[172:175], v[108:111], v[60:63], a[172:175]
    s_waitcnt lgkmcnt(0)
    v_exp_f32 v252, v252
    v_mfma_f32_16x16x32_bf16 v[240:243], a[240:243], v[128:131], v[188:191]
    v_exp_f32 v253, v253
    v_mfma_f32_16x16x32_bf16 v[240:243], a[244:247], v[160:163], v[240:243]
    buffer_load_dwordx4 v1, s[36:39], s100 offen offset:3072 sc1 lds
    v_mfma_f32_16x16x32_bf16 v[240:243], a[248:251], v[192:195], v[240:243]
    v_exp_f32 v254, v254
    v_mfma_f32_16x16x32_bf16 v[240:243], a[252:255], v[224:227], v[240:243]
    v_exp_f32 v255, v255
    v_mfma_f32_16x16x32_bf16 a[176:179], v[112:115], v[32:35], a[176:179]
    v_cvt_pk_bf16_f32 v92, v252, v253
    v_cvt_pk_bf16_f32 v93, v254, v255
    v_mfma_f32_16x16x32_bf16 a[176:179], v[116:119], v[36:39], a[176:179]
    ds_read_b128 v[120:123], v2 offset:30720
    ds_read_b128 v[124:127], v2 offset:31744
    v_mfma_f32_16x16x32_bf16 a[180:183], v[112:115], v[40:43], a[180:183]
    v_exp_f32 v240, v240
    v_mfma_f32_16x16x32_bf16 a[180:183], v[116:119], v[44:47], a[180:183]
    v_exp_f32 v241, v241
    v_mfma_f32_16x16x32_bf16 v[244:247], a[240:243], v[132:135], v[148:151]
    v_add_u32 v2, s82, v1
    v_cvt_pk_bf16_f32 v70, v240, v241
    v_mfma_f32_16x16x32_bf16 v[244:247], a[244:247], v[164:167], v[244:247]
    v_exp_f32 v242, v242
    v_mfma_f32_16x16x32_bf16 v[244:247], a[248:251], v[196:199], v[244:247]
    v_exp_f32 v243, v243
    v_mfma_f32_16x16x32_bf16 v[244:247], a[252:255], v[228:231], v[244:247]
    v_cvt_pk_bf16_f32 v71, v242, v243
    v_mfma_f32_16x16x32_bf16 a[184:187], v[112:115], v[48:51], a[184:187]
    v_mfma_f32_16x16x32_bf16 a[184:187], v[116:119], v[52:55], a[184:187]
    v_mfma_f32_16x16x32_bf16 a[188:191], v[112:115], v[56:59], a[188:191]
    s_add_u32 s77, s77, 32768
    v_mfma_f32_16x16x32_bf16 a[188:191], v[116:119], v[60:63], a[188:191]
    v_mfma_f32_16x16x32_bf16 v[248:251], a[240:243], v[136:139], v[152:155]
    v_mfma_f32_16x16x32_bf16 v[248:251], a[244:247], v[168:171], v[248:251]
    v_exp_f32 v244, v244
    v_mfma_f32_16x16x32_bf16 v[248:251], a[248:251], v[200:203], v[248:251]
    v_exp_f32 v245, v245
    v_mfma_f32_16x16x32_bf16 v[248:251], a[252:255], v[232:235], v[248:251]
    s_waitcnt lgkmcnt(0)
    v_exp_f32 v246, v246
    v_mfma_f32_16x16x32_bf16 a[192:195], v[120:123], v[32:35], a[192:195]
    v_exp_f32 v247, v247
    v_mfma_f32_16x16x32_bf16 a[192:195], v[124:127], v[36:39], a[192:195]
    ds_read_b128 a[224:227], v2 offset:0
    ds_read_b128 a[228:231], v2 offset:1024
    v_mfma_f32_16x16x32_bf16 a[196:199], v[120:123], v[40:43], a[196:199]
    ds_read_b128 a[232:235], v2 offset:2048
    v_cvt_pk_bf16_f32 v78, v244, v245
    v_mfma_f32_16x16x32_bf16 a[196:199], v[124:127], v[44:47], a[196:199]
    ds_read_b128 a[236:239], v2 offset:3072
    v_cvt_pk_bf16_f32 v79, v246, v247
    v_mfma_f32_16x16x32_bf16 v[252:255], a[240:243], v[140:143], v[156:159]
    v_exp_f32 v248, v248
    v_mfma_f32_16x16x32_bf16 v[252:255], a[244:247], v[172:175], v[252:255]
    ds_read_b128 v[96:99], v2 offset:16384
    ds_read_b128 v[100:103], v2 offset:17408
    v_mfma_f32_16x16x32_bf16 v[252:255], a[248:251], v[204:207], v[252:255]
    v_exp_f32 v249, v249
    v_mfma_f32_16x16x32_bf16 v[252:255], a[252:255], v[236:239], v[252:255]
    v_exp_f32 v250, v250
    v_mfma_f32_16x16x32_bf16 a[200:203], v[120:123], v[48:51], a[200:203]
    v_exp_f32 v251, v251
    v_mfma_f32_16x16x32_bf16 a[200:203], v[124:127], v[52:55], a[200:203]
    v_cvt_pk_bf16_f32 v86, v248, v249
    v_cvt_pk_bf16_f32 v87, v250, v251
    v_mfma_f32_16x16x32_bf16 a[204:207], v[120:123], v[56:59], a[204:207]
    v_mfma_f32_16x16x32_bf16 a[204:207], v[124:127], v[60:63], a[204:207]
    v_exp_f32 v252, v252
    v_smfmac_f32_16x16x64_bf16 a[208:211], a[136:139], v[32:39], v215
    v_smfmac_f32_16x16x64_bf16 a[212:215], a[136:139], v[40:47], v215
    v_smfmac_f32_16x16x64_bf16 a[216:219], a[136:139], v[48:55], v215
    s_cmp_le_u32 s78, 1
    v_smfmac_f32_16x16x64_bf16 a[220:223], a[136:139], v[56:63], v215
    s_cbranch_scc1 K1_LB_MASK
K1_LB_BACK:
    s_waitcnt lgkmcnt(0)
    v_mfma_f32_16x16x32_bf16 v[240:243], a[224:227], v[128:131], v[176:179]
    s_mov_b32 s99, s76
    v_exp_f32 v253, v253
    v_mfma_f32_16x16x32_bf16 v[240:243], a[228:231], v[160:163], v[240:243]
    v_exp_f32 v254, v254
    v_mfma_f32_16x16x32_bf16 v[240:243], a[232:235], v[192:195], v[240:243]
    v_exp_f32 v255, v255
    v_mfma_f32_16x16x32_bf16 v[240:243], a[236:239], v[224:227], v[240:243]
    v_cvt_pk_bf16_f32 v94, v252, v253
    v_cvt_pk_bf16_f32 v95, v254, v255
    v_mfma_f32_16x16x32_bf16 a[0:3], v[96:99], v[64:67], a[0:3]
    s_add_u32 m0, s76, s75
    v_mfma_f32_16x16x32_bf16 a[0:3], v[100:103], v[68:71], a[0:3]
    s_mov_b32 s76, s60
    buffer_load_dwordx4 v1, s[36:39], s77 offen sc1 lds
    v_mfma_f32_16x16x32_bf16 a[4:7], v[96:99], v[72:75], a[4:7]
    s_mov_b32 s60, s82
    ds_read_b128 v[104:107], v2 offset:18432
    ds_read_b128 v[108:111], v2 offset:19456
    v_mfma_f32_16x16x32_bf16 a[4:7], v[100:103], v[76:79], a[4:7]
    s_mov_b32 s82, s95
    v_exp_f32 v240, v240
    v_mfma_f32_16x16x32_bf16 v[244:247], a[224:227], v[132:135], v[148:151]
    s_mov_b32 s95, s93
    v_exp_f32 v241, v241
    v_mfma_f32_16x16x32_bf16 v[244:247], a[228:231], v[164:167], v[244:247]
    s_mov_b32 s93, s99
    v_exp_f32 v242, v242
    v_mfma_f32_16x16x32_bf16 v[244:247], a[232:235], v[196:199], v[244:247]
    v_exp_f32 v243, v243
    v_mfma_f32_16x16x32_bf16 v[244:247], a[236:239], v[228:231], v[244:247]
    v_cvt_pk_bf16_f32 v32, v240, v241
    v_cvt_pk_bf16_f32 v33, v242, v243
    v_mfma_f32_16x16x32_bf16 a[8:11], v[96:99], v[80:83], a[8:11]
    v_mfma_f32_16x16x32_bf16 a[8:11], v[100:103], v[84:87], a[8:11]
    v_mfma_f32_16x16x32_bf16 a[12:15], v[96:99], v[88:91], a[12:15]
    v_mfma_f32_16x16x32_bf16 a[12:15], v[100:103], v[92:95], a[12:15]
    v_mfma_f32_16x16x32_bf16 v[248:251], a[224:227], v[136:139], v[152:155]
    v_mfma_f32_16x16x32_bf16 v[248:251], a[228:231], v[168:171], v[248:251]
    ds_read_b128 a[240:243], v2 offset:4096
    ds_read_b128 a[244:247], v2 offset:5120
    v_mfma_f32_16x16x32_bf16 v[248:251], a[232:235], v[200:203], v[248:251]
    buffer_load_dwordx4 v1, s[36:39], s77 offen offset:1024 sc1 lds
    v_mfma_f32_16x16x32_bf16 v[248:251], a[236:239], v[232:235], v[248:251]
    s_waitcnt lgkmcnt(2)
    ds_read_b128 a[248:251], v2 offset:6144
    ds_read_b128 a[252:255], v2 offset:7168
    v_mfma_f32_16x16x32_bf16 a[16:19], v[104:107], v[64:67], a[16:19]
    v_exp_f32 v244, v244
    v_mfma_f32_16x16x32_bf16 a[16:19], v[108:111], v[68:71], a[16:19]
    ds_read_b128 v[112:115], v2 offset:20480
    ds_read_b128 v[116:119], v2 offset:21504
    v_mfma_f32_16x16x32_bf16 a[20:23], v[104:107], v[72:75], a[20:23]
    v_exp_f32 v245, v245
    v_mfma_f32_16x16x32_bf16 a[20:23], v[108:111], v[76:79], a[20:23]
    v_exp_f32 v246, v246
    v_mfma_f32_16x16x32_bf16 v[252:255], a[224:227], v[140:143], v[156:159]
    v_exp_f32 v247, v247
    v_mfma_f32_16x16x32_bf16 v[252:255], a[228:231], v[172:175], v[252:255]
    v_cvt_pk_bf16_f32 v40, v244, v245
    v_cvt_pk_bf16_f32 v41, v246, v247
    v_mfma_f32_16x16x32_bf16 v[252:255], a[232:235], v[204:207], v[252:255]
    v_exp_f32 v248, v248
    v_mfma_f32_16x16x32_bf16 v[252:255], a[236:239], v[236:239], v[252:255]
    v_exp_f32 v249, v249
    v_mfma_f32_16x16x32_bf16 a[24:27], v[104:107], v[80:83], a[24:27]
    v_exp_f32 v250, v250
    v_mfma_f32_16x16x32_bf16 a[24:27], v[108:111], v[84:87], a[24:27]
    v_exp_f32 v251, v251
    v_mfma_f32_16x16x32_bf16 a[28:31], v[104:107], v[88:91], a[28:31]
    v_cvt_pk_bf16_f32 v48, v248, v249
    v_cvt_pk_bf16_f32 v49, v250, v251
    v_mfma_f32_16x16x32_bf16 a[28:31], v[108:111], v[92:95], a[28:31]
    s_waitcnt lgkmcnt(0)
    buffer_load_dwordx4 v1, s[36:39], s77 offen offset:2048 sc1 lds
    v_mfma_f32_16x16x32_bf16 v[240:243], a[240:243], v[128:131], v[180:183]
    v_exp_f32 v252, v252
    v_mfma_f32_16x16x32_bf16 v[240:243], a[244:247], v[160:163], v[240:243]
    v_exp_f32 v253, v253
    v_mfma_f32_16x16x32_bf16 v[240:243], a[248:251], v[192:195], v[240:243]
    v_exp_f32 v254, v254
    v_mfma_f32_16x16x32_bf16 v[240:243], a[252:255], v[224:227], v[240:243]
    v_exp_f32 v255, v255
    v_mfma_f32_16x16x32_bf16 a[32:35], v[112:115], v[64:67], a[32:35]
    v_cvt_pk_bf16_f32 v56, v252, v253
    v_cvt_pk_bf16_f32 v57, v254, v255
    v_mfma_f32_16x16x32_bf16 a[32:35], v[116:119], v[68:71], a[32:35]
    ds_read_b128 v[120:123], v2 offset:22528
    ds_read_b128 v[124:127], v2 offset:23552
    v_mfma_f32_16x16x32_bf16 a[36:39], v[112:115], v[72:75], a[36:39]
    v_exp_f32 v240, v240
    v_mfma_f32_16x16x32_bf16 a[36:39], v[116:119], v[76:79], a[36:39]
    v_exp_f32 v241, v241
    v_mfma_f32_16x16x32_bf16 v[244:247], a[240:243], v[132:135], v[148:151]
    v_exp_f32 v242, v242
    v_mfma_f32_16x16x32_bf16 v[244:247], a[244:247], v[164:167], v[244:247]
    v_exp_f32 v243, v243
    v_mfma_f32_16x16x32_bf16 v[244:247], a[248:251], v[196:199], v[244:247]
    v_cvt_pk_bf16_f32 v34, v240, v241
    v_cvt_pk_bf16_f32 v35, v242, v243
    v_mfma_f32_16x16x32_bf16 v[244:247], a[252:255], v[228:231], v[244:247]
    v_mfma_f32_16x16x32_bf16 a[40:43], v[112:115], v[80:83], a[40:43]
    buffer_load_dwordx4 v1, s[36:39], s77 offen offset:3072 sc1 lds
    v_mfma_f32_16x16x32_bf16 a[40:43], v[116:119], v[84:87], a[40:43]
    v_mfma_f32_16x16x32_bf16 a[44:47], v[112:115], v[88:91], a[44:47]
    v_mfma_f32_16x16x32_bf16 a[44:47], v[116:119], v[92:95], a[44:47]
    v_mfma_f32_16x16x32_bf16 v[248:251], a[240:243], v[136:139], v[152:155]
    v_mfma_f32_16x16x32_bf16 v[248:251], a[244:247], v[168:171], v[248:251]
    ds_read_b128 a[224:227], v2 offset:8192
    ds_read_b128 a[228:231], v2 offset:9216
    v_mfma_f32_16x16x32_bf16 v[248:251], a[248:251], v[200:203], v[248:251]
    v_exp_f32 v244, v244
    v_mfma_f32_16x16x32_bf16 v[248:251], a[252:255], v[232:235], v[248:251]
    s_waitcnt lgkmcnt(2)
    ds_read_b128 a[232:235], v2 offset:10240
    ds_read_b128 a[236:239], v2 offset:11264
    v_mfma_f32_16x16x32_bf16 a[48:51], v[120:123], v[64:67], a[48:51]
    v_exp_f32 v245, v245
    v_mfma_f32_16x16x32_bf16 a[48:51], v[124:127], v[68:71], a[48:51]
    ds_read_b128 v[96:99], v2 offset:24576
    ds_read_b128 v[100:103], v2 offset:25600
    v_mfma_f32_16x16x32_bf16 a[52:55], v[120:123], v[72:75], a[52:55]
    v_exp_f32 v246, v246
    v_mfma_f32_16x16x32_bf16 a[52:55], v[124:127], v[76:79], a[52:55]
    v_exp_f32 v247, v247
    v_mfma_f32_16x16x32_bf16 v[252:255], a[240:243], v[140:143], v[156:159]
    v_cvt_pk_bf16_f32 v42, v244, v245
    v_cvt_pk_bf16_f32 v43, v246, v247
    v_mfma_f32_16x16x32_bf16 v[252:255], a[244:247], v[172:175], v[252:255]
    s_add_u32 s100, s77, 4096
    v_exp_f32 v248, v248
    v_mfma_f32_16x16x32_bf16 v[252:255], a[248:251], v[204:207], v[252:255]
    s_add_u32 m0, m0, 4096
    v_exp_f32 v249, v249
    v_mfma_f32_16x16x32_bf16 v[252:255], a[252:255], v[236:239], v[252:255]
    buffer_load_dwordx4 v1, s[36:39], s100 offen sc1 lds
    v_mfma_f32_16x16x32_bf16 a[56:59], v[120:123], v[80:83], a[56:59]
    v_exp_f32 v250, v250
    v_mfma_f32_16x16x32_bf16 a[56:59], v[124:127], v[84:87], a[56:59]
    v_exp_f32 v251, v251
    v_mfma_f32_16x16x32_bf16 a[60:63], v[120:123], v[88:91], a[60:63]
    v_cvt_pk_bf16_f32 v50, v248, v249
    v_cvt_pk_bf16_f32 v51, v250, v251
    v_mfma_f32_16x16x32_bf16 a[60:63], v[124:127], v[92:95], a[60:63]
    s_waitcnt lgkmcnt(0)
    v_exp_f32 v252, v252
    v_mfma_f32_16x16x32_bf16 v[240:243], a[224:227], v[128:131], v[184:187]
    v_exp_f32 v253, v253
    v_mfma_f32_16x16x32_bf16 v[240:243], a[228:231], v[160:163], v[240:243]
    v_exp_f32 v254, v254
    v_mfma_f32_16x16x32_bf16 v[240:243], a[232:235], v[192:195], v[240:243]
    v_exp_f32 v255, v255
    v_mfma_f32_16x16x32_bf16 v[240:243], a[236:239], v[224:227], v[240:243]
    v_cvt_pk_bf16_f32 v58, v252, v253
    v_cvt_pk_bf16_f32 v59, v254, v255
    v_mfma_f32_16x16x32_bf16 a[144:147], v[96:99], v[64:67], a[144:147]
    v_mfma_f32_16x16x32_bf16 a[144:147], v[100:103], v[68:71], a[144:147]
    ds_read_b128 v[104:107], v2 offset:26624
    ds_read_b128 v[108:111], v2 offset:27648
    v_mfma_f32_16x16x32_bf16 a[148:151], v[96:99], v[72:75], a[148:151]
    v_mfma_f32_16x16x32_bf16 a[148:151], v[100:103], v[76:79], a[148:151]
    buffer_load_dwordx4 v1, s[36:39], s100 offen offset:1024 sc1 lds
    v_mfma_f32_16x16x32_bf16 v[244:247], a[224:227], v[132:135], v[148:151]
    v_exp_f32 v240, v240
    v_mfma_f32_16x16x32_bf16 v[244:247], a[228:231], v[164:167], v[244:247]
    v_exp_f32 v241, v241
    v_mfma_f32_16x16x32_bf16 v[244:247], a[232:235], v[196:199], v[244:247]
    v_exp_f32 v242, v242
    v_mfma_f32_16x16x32_bf16 v[244:247], a[236:239], v[228:231], v[244:247]
    v_exp_f32 v243, v243
    v_mfma_f32_16x16x32_bf16 a[152:155], v[96:99], v[80:83], a[152:155]
    v_cvt_pk_bf16_f32 v36, v240, v241
    v_cvt_pk_bf16_f32 v37, v242, v243
    v_mfma_f32_16x16x32_bf16 a[152:155], v[100:103], v[84:87], a[152:155]
    v_mfma_f32_16x16x32_bf16 a[156:159], v[96:99], v[88:91], a[156:159]
    v_mfma_f32_16x16x32_bf16 a[156:159], v[100:103], v[92:95], a[156:159]
    v_mfma_f32_16x16x32_bf16 v[248:251], a[224:227], v[136:139], v[152:155]
    v_exp_f32 v244, v244
    v_mfma_f32_16x16x32_bf16 v[248:251], a[228:231], v[168:171], v[248:251]
    ds_read_b128 a[240:243], v2 offset:12288
    ds_read_b128 a[244:247], v2 offset:13312
    v_mfma_f32_16x16x32_bf16 v[248:251], a[232:235], v[200:203], v[248:251]
    v_exp_f32 v245, v245
    v_mfma_f32_16x16x32_bf16 v[248:251], a[236:239], v[232:235], v[248:251]
    s_waitcnt lgkmcnt(2)
    ds_read_b128 a[248:251], v2 offset:14336
    ds_read_b128 a[252:255], v2 offset:15360
    v_mfma_f32_16x16x32_bf16 a[160:163], v[104:107], v[64:67], a[160:163]
    buffer_load_dwordx4 v1, s[36:39], s100 offen offset:2048 sc1 lds
    v_mfma_f32_16x16x32_bf16 a[160:163], v[108:111], v[68:71], a[160:163]
    ds_read_b128 v[112:115], v2 offset:28672
    ds_read_b128 v[116:119], v2 offset:29696
    v_mfma_f32_16x16x32_bf16 a[164:167], v[104:107], v[72:75], a[164:167]
    v_exp_f32 v246, v246
    v_mfma_f32_16x16x32_bf16 a[164:167], v[108:111], v[76:79], a[164:167]
    v_exp_f32 v247, v247
    v_mfma_f32_16x16x32_bf16 v[252:255], a[224:227], v[140:143], v[156:159]
    v_cvt_pk_bf16_f32 v44, v244, v245
    v_cvt_pk_bf16_f32 v45, v246, v247
    v_mfma_f32_16x16x32_bf16 v[252:255], a[228:231], v[172:175], v[252:255]
    v_exp_f32 v248, v248
    v_mfma_f32_16x16x32_bf16 v[252:255], a[232:235], v[204:207], v[252:255]
    v_exp_f32 v249, v249
    v_mfma_f32_16x16x32_bf16 v[252:255], a[236:239], v[236:239], v[252:255]
    v_exp_f32 v250, v250
    v_mfma_f32_16x16x32_bf16 a[168:171], v[104:107], v[80:83], a[168:171]
    v_exp_f32 v251, v251
    v_mfma_f32_16x16x32_bf16 a[168:171], v[108:111], v[84:87], a[168:171]
    v_cvt_pk_bf16_f32 v52, v248, v249
    v_cvt_pk_bf16_f32 v53, v250, v251
    v_mfma_f32_16x16x32_bf16 a[172:175], v[104:107], v[88:91], a[172:175]
    v_mfma_f32_16x16x32_bf16 a[172:175], v[108:111], v[92:95], a[172:175]
    s_waitcnt lgkmcnt(0)
    v_exp_f32 v252, v252
    v_mfma_f32_16x16x32_bf16 v[240:243], a[240:243], v[128:131], v[188:191]
    v_exp_f32 v253, v253
    v_mfma_f32_16x16x32_bf16 v[240:243], a[244:247], v[160:163], v[240:243]
    buffer_load_dwordx4 v1, s[36:39], s100 offen offset:3072 sc1 lds
    v_mfma_f32_16x16x32_bf16 v[240:243], a[248:251], v[192:195], v[240:243]
    v_exp_f32 v254, v254
    v_mfma_f32_16x16x32_bf16 v[240:243], a[252:255], v[224:227], v[240:243]
    v_exp_f32 v255, v255
    v_mfma_f32_16x16x32_bf16 a[176:179], v[112:115], v[64:67], a[176:179]
    v_cvt_pk_bf16_f32 v60, v252, v253
    v_cvt_pk_bf16_f32 v61, v254, v255
    v_mfma_f32_16x16x32_bf16 a[176:179], v[116:119], v[68:71], a[176:179]
    ds_read_b128 v[120:123], v2 offset:30720
    ds_read_b128 v[124:127], v2 offset:31744
    v_mfma_f32_16x16x32_bf16 a[180:183], v[112:115], v[72:75], a[180:183]
    v_exp_f32 v240, v240
    v_mfma_f32_16x16x32_bf16 a[180:183], v[116:119], v[76:79], a[180:183]
    v_exp_f32 v241, v241
    v_mfma_f32_16x16x32_bf16 v[244:247], a[240:243], v[132:135], v[148:151]
    v_add_u32 v2, s82, v1
    v_cvt_pk_bf16_f32 v38, v240, v241
    v_mfma_f32_16x16x32_bf16 v[244:247], a[244:247], v[164:167], v[244:247]
    v_exp_f32 v242, v242
    v_mfma_f32_16x16x32_bf16 v[244:247], a[248:251], v[196:199], v[244:247]
    v_exp_f32 v243, v243
    v_mfma_f32_16x16x32_bf16 v[244:247], a[252:255], v[228:231], v[244:247]
    v_cvt_pk_bf16_f32 v39, v242, v243
    v_mfma_f32_16x16x32_bf16 a[184:187], v[112:115], v[80:83], a[184:187]
    v_mfma_f32_16x16x32_bf16 a[184:187], v[116:119], v[84:87], a[184:187]
    v_mfma_f32_16x16x32_bf16 a[188:191], v[112:115], v[88:91], a[188:191]
    s_add_u32 s77, s77, 32768
    v_mfma_f32_16x16x32_bf16 a[188:191], v[116:119], v[92:95], a[188:191]
    v_mfma_f32_16x16x32_bf16 v[248:251], a[240:243], v[136:139], v[152:155]
    v_mfma_f32_16x16x32_bf16 v[248:251], a[244:247], v[168:171], v[248:251]
    v_exp_f32 v244, v244
    v_mfma_f32_16x16x32_bf16 v[248:251], a[248:251], v[200:203], v[248:251]
    v_exp_f32 v245, v245
    v_mfma_f32_16x16x32_bf16 v[248:251], a[252:255], v[232:235], v[248:251]
    s_waitcnt lgkmcnt(0)
    v_exp_f32 v246, v246
    v_mfma_f32_16x16x32_bf16 a[192:195], v[120:123], v[64:67], a[192:195]
    v_exp_f32 v247, v247
    v_mfma_f32_16x16x32_bf16 a[192:195], v[124:127], v[68:71], a[192:195]
    v_cvt_pk_bf16_f32 v46, v244, v245
    v_cvt_pk_bf16_f32 v47, v246, v247
    v_mfma_f32_16x16x32_bf16 a[196:199], v[120:123], v[72:75], a[196:199]
    s_waitcnt vmcnt(8) lgkmcnt(0)
    v_exp_f32 v248, v248
    v_mfma_f32_16x16x32_bf16 a[196:199], v[124:127], v[76:79], a[196:199]
    s_barrier
    ds_read_b128 a[224:227], v2 offset:0
    ds_read_b128 a[228:231], v2 offset:1024
    v_mfma_f32_16x16x32_bf16 v[252:255], a[240:243], v[140:143], v[156:159]
    v_exp_f32 v249, v249
    v_mfma_f32_16x16x32_bf16 v[252:255], a[244:247], v[172:175], v[252:255]
    ds_read_b128 a[232:235], v2 offset:2048
    ds_read_b128 a[236:239], v2 offset:3072
    v_mfma_f32_16x16x32_bf16 v[252:255], a[248:251], v[204:207], v[252:255]
    ds_read_b128 v[96:99], v2 offset:16384
    v_cvt_pk_bf16_f32 v54, v248, v249
    v_mfma_f32_16x16x32_bf16 v[252:255], a[252:255], v[236:239], v[252:255]
    v_exp_f32 v250, v250
    v_mfma_f32_16x16x32_bf16 a[200:203], v[120:123], v[80:83], a[200:203]
    v_exp_f32 v251, v251
    v_mfma_f32_16x16x32_bf16 a[200:203], v[124:127], v[84:87], a[200:203]
    ds_read_b128 v[100:103], v2 offset:17408
    v_cvt_pk_bf16_f32 v55, v250, v251
    v_mfma_f32_16x16x32_bf16 a[204:207], v[120:123], v[88:91], a[204:207]
    v_mfma_f32_16x16x32_bf16 a[204:207], v[124:127], v[92:95], a[204:207]
    v_exp_f32 v252, v252
    v_smfmac_f32_16x16x64_bf16 a[208:211], a[136:139], v[64:71], v215
    v_smfmac_f32_16x16x64_bf16 a[212:215], a[136:139], v[72:79], v215
    s_sub_u32 s78, s78, 1
    v_smfmac_f32_16x16x64_bf16 a[216:219], a[136:139], v[80:87], v215
    s_cmp_lg_u32 s78, 0
    v_smfmac_f32_16x16x64_bf16 a[220:223], a[136:139], v[88:95], v215
    s_cbranch_scc1 K1_LB
K1_LB_END:
    v_add_f32 v212, s12, v148
    v_fma_f32 v176, v208, s8, v212
    v_fma_f32 v177, v209, s8, v212
    v_fma_f32 v178, v210, s8, v212
    v_fma_f32 v179, v211, s8, v212
    s_nop 1
    s_waitcnt lgkmcnt(0)
    v_mfma_f32_16x16x32_bf16 v[240:243], a[224:227], v[132:135], v[176:179]
    s_mov_b32 s7, 0
    ds_read_b128 v[104:107], v2 offset:18432
    ds_read_b128 v[108:111], v2 offset:19456
    v_mfma_f32_16x16x32_bf16 v[240:243], a[228:231], v[164:167], v[240:243]
    s_mov_b32 s99, s76
    buffer_load_dwordx4 v[64:67], v11, s[48:51], s7 offen nt
    v_mfma_f32_16x16x32_bf16 v[240:243], a[232:235], v[196:199], v[240:243]
    s_mov_b32 s7, 18432
    v_exp_f32 v253, v253
    v_mfma_f32_16x16x32_bf16 v[240:243], a[236:239], v[228:231], v[240:243]
    s_lshl_b32 s29, s6, 2
    v_exp_f32 v254, v254
    v_mfma_f32_16x16x32_bf16 a[0:3], v[96:99], v[32:35], a[0:3]
    s_lshr_b32 s29, 0x41302413, s29
    v_exp_f32 v255, v255
    v_mfma_f32_16x16x32_bf16 a[0:3], v[100:103], v[36:39], a[0:3]
    s_and_b32 s29, s29, 7
    buffer_load_dwordx4 v[68:71], v11, s[48:51], s7 offen nt
    v_mfma_f32_16x16x32_bf16 a[4:7], v[96:99], v[40:43], a[4:7]
    s_mov_b32 s7, 9216
    v_cvt_pk_bf16_f32 v62, v252, v253
    v_cvt_pk_bf16_f32 v63, v254, v255
    v_mfma_f32_16x16x32_bf16 a[4:7], v[100:103], v[44:47], a[4:7]
    s_lshl_b32 s29, s29, 15
    ds_read_b128 a[240:243], v2 offset:4096
    ds_read_b128 a[244:247], v2 offset:5120
    v_mfma_f32_16x16x32_bf16 v[244:247], a[224:227], v[136:139], v[152:155]
    s_add_u32 s44, s29, s75
    ds_read_b128 a[248:251], v2 offset:6144
    v_add_f32 v213, s13, v148
    v_mfma_f32_16x16x32_bf16 v[244:247], a[228:231], v[168:171], v[244:247]
    s_lshl_b32 s29, s6, 2
    buffer_load_dwordx4 v[20:23], v11, s[48:51], s7 offen nt
    v_mfma_f32_16x16x32_bf16 v[244:247], a[232:235], v[200:203], v[244:247]
    s_mov_b32 s7, 27648
    ds_read_b128 a[252:255], v2 offset:7168
    ds_read_b128 v[112:115], v2 offset:20480
    v_mfma_f32_16x16x32_bf16 v[244:247], a[236:239], v[232:235], v[244:247]
    s_lshr_b32 s29, 0x2413024, s29
    ds_read_b128 v[116:119], v2 offset:21504
    v_fma_f32 v180, v208, s9, v213
    v_mfma_f32_16x16x32_bf16 a[8:11], v[96:99], v[48:51], a[8:11]
    s_and_b32 s29, s29, 7
    v_fma_f32 v181, v209, s9, v213
    v_fma_f32 v182, v210, s9, v213
    v_mfma_f32_16x16x32_bf16 a[8:11], v[100:103], v[52:55], a[8:11]
    s_lshl_b32 s29, s29, 15
    buffer_load_dwordx4 v[24:27], v11, s[48:51], s7 offen nt
    v_mfma_f32_16x16x32_bf16 a[12:15], v[96:99], v[56:59], a[12:15]
    s_add_u32 s45, s29, s75
    v_fma_f32 v183, v211, s9, v213
    ds_read_b128 v[120:123], v2 offset:22528
    v_mfma_f32_16x16x32_bf16 a[12:15], v[100:103], v[60:63], a[12:15]
    s_lshl_b32 s29, s6, 2
    v_exp_f32 v240, v240
    s_waitcnt lgkmcnt(2)
    v_mfma_f32_16x16x32_bf16 a[16:19], v[104:107], v[32:35], a[16:19]
    s_lshr_b32 s29, 0x13024130, s29
    v_exp_f32 v241, v241
    v_mfma_f32_16x16x32_bf16 a[16:19], v[108:111], v[36:39], a[16:19]
    s_and_b32 s29, s29, 7
    buffer_load_dwordx4 v[144:147], v12, s[52:55], 0 offen nt
    v_mfma_f32_16x16x32_bf16 v[248:251], a[224:227], v[140:143], v[156:159]
    s_lshl_b32 s29, s29, 15
    v_exp_f32 v242, v242
    v_mfma_f32_16x16x32_bf16 v[248:251], a[228:231], v[172:175], v[248:251]
    s_add_u32 s46, s29, s75
    v_exp_f32 v243, v243
    v_mfma_f32_16x16x32_bf16 v[248:251], a[232:235], v[204:207], v[248:251]
    s_lshl_b32 s29, s6, 2
    v_cvt_pk_bf16_f32 v72, v240, v241
    v_cvt_pk_bf16_f32 v73, v242, v243
    v_mfma_f32_16x16x32_bf16 v[248:251], a[236:239], v[236:239], v[248:251]
    s_lshr_b32 s29, 0x24130241, s29
    buffer_load_dwordx4 a[140:143], v13, s[52:55], 0 offen nt
    v_mfma_f32_16x16x32_bf16 a[20:23], v[104:107], v[40:43], a[20:23]
    s_and_b32 s29, s29, 7
    ds_read_b128 v[124:127], v2 offset:23552
    ds_read_b128 a[224:227], v2 offset:8192
    v_mfma_f32_16x16x32_bf16 a[20:23], v[108:111], v[44:47], a[20:23]
    s_lshl_b32 s29, s29, 15
    v_exp_f32 v244, v244
    v_mfma_f32_16x16x32_bf16 a[24:27], v[104:107], v[48:51], a[24:27]
    s_add_u32 s47, s29, s75
    v_exp_f32 v245, v245
    v_mfma_f32_16x16x32_bf16 a[24:27], v[108:111], v[52:55], a[24:27]
    s_lshl_b32 s29, s6, 2
    v_exp_f32 v246, v246
    v_mfma_f32_16x16x32_bf16 a[28:31], v[104:107], v[56:59], a[28:31]
    s_lshr_b32 s29, 0x30241302, s29
    v_exp_f32 v247, v247
    v_mfma_f32_16x16x32_bf16 a[28:31], v[108:111], v[60:63], a[28:31]
    s_and_b32 s29, s29, 7
    v_cvt_pk_bf16_f32 v80, v244, v245
    v_cvt_pk_bf16_f32 v81, v246, v247
    v_mfma_f32_16x16x32_bf16 v[252:255], a[240:243], v[132:135], v[180:183]
    s_mov_b32 s98, 0x3fb8aa3b
    ds_read_b128 a[228:231], v2 offset:9216
    ds_read_b128 a[232:235], v2 offset:10240
    v_mfma_f32_16x16x32_bf16 v[252:255], a[244:247], v[164:167], v[252:255]
    s_lshr_b32 s61, s5, 3
    ds_read_b128 a[236:239], v2 offset:11264
    v_add_f32 v212, s14, v148
    v_mfma_f32_16x16x32_bf16 v[252:255], a[248:251], v[196:199], v[252:255]
    s_lshl_b32 s29, s29, 15
    ds_read_b128 v[96:99], v2 offset:24576
    v_fma_f32 v184, v208, s10, v212
    v_mfma_f32_16x16x32_bf16 v[252:255], a[252:255], v[228:231], v[252:255]
    s_add_u32 s79, s29, s75
    ds_read_b128 v[100:103], v2 offset:25600
    v_fma_f32 v185, v209, s10, v212
    v_mfma_f32_16x16x32_bf16 a[32:35], v[112:115], v[32:35], a[32:35]
    s_mul_i32 s71, s61, 6144
    v_exp_f32 v248, v248
    s_waitcnt lgkmcnt(5)
    v_mfma_f32_16x16x32_bf16 a[32:35], v[116:119], v[36:39], a[32:35]
    s_and_b32 s29, s5, 7
    v_exp_f32 v249, v249
    v_mfma_f32_16x16x32_bf16 a[36:39], v[112:115], v[40:43], a[36:39]
    s_add_u32 s3, s5, s6
    v_exp_f32 v250, v250
    v_mfma_f32_16x16x32_bf16 a[36:39], v[116:119], v[44:47], a[36:39]
    s_add_u32 s71, s71, 131072
    v_exp_f32 v251, v251
    v_mfma_f32_16x16x32_bf16 v[240:243], a[240:243], v[136:139], v[152:155]
    s_lshl_b32 s29, s29, 8
    v_fma_f32 v186, v210, s10, v212
    v_fma_f32 v187, v211, s10, v212
    v_mfma_f32_16x16x32_bf16 v[240:243], a[244:247], v[168:171], v[240:243]
    s_add_u32 s74, s4, 1
    v_cvt_pk_bf16_f32 v88, v248, v249
    v_cvt_pk_bf16_f32 v89, v250, v251
    v_mfma_f32_16x16x32_bf16 v[240:243], a[248:251], v[200:203], v[240:243]
    s_and_b32 s28, s5, 3
    v_exp_f32 v252, v252
    v_mfma_f32_16x16x32_bf16 v[240:243], a[252:255], v[232:235], v[240:243]
    s_and_b32 s3, s3, 1
    v_exp_f32 v253, v253
    v_mfma_f32_16x16x32_bf16 a[40:43], v[112:115], v[48:51], a[40:43]
    s_lshl2_add_u32 s66, s6, s61
    v_exp_f32 v254, v254
    v_mfma_f32_16x16x32_bf16 a[40:43], v[116:119], v[52:55], a[40:43]
    s_add_u32 s71, s71, s29
    v_exp_f32 v255, v255
    v_mfma_f32_16x16x32_bf16 a[44:47], v[112:115], v[56:59], a[44:47]
    s_lshl_b32 s74, s74, 15
    v_cvt_pk_bf16_f32 v74, v252, v253
    v_cvt_pk_bf16_f32 v75, v254, v255
    v_mfma_f32_16x16x32_bf16 a[44:47], v[116:119], v[60:63], a[44:47]
    s_mul_i32 s28, s28, 9216
    ds_read_b128 v[104:107], v2 offset:26624
    ds_read_b128 v[108:111], v2 offset:27648
    v_mfma_f32_16x16x32_bf16 a[48:51], v[120:123], v[32:35], a[48:51]
    s_lshl3_add_u32 s3, s61, s3
    v_exp_f32 v240, v240
    v_mfma_f32_16x16x32_bf16 a[48:51], v[124:127], v[36:39], a[48:51]
    s_lshl_b32 s66, s66, 10
    v_exp_f32 v241, v241
    v_mfma_f32_16x16x32_bf16 v[244:247], a[240:243], v[140:143], v[156:159]
    s_add_u32 s70, s71, 4096
    v_exp_f32 v242, v242
    v_mfma_f32_16x16x32_bf16 v[244:247], a[244:247], v[172:175], v[244:247]
    s_add_u32 s71, s71, s29
    v_exp_f32 v243, v243
    v_mfma_f32_16x16x32_bf16 v[244:247], a[248:251], v[204:207], v[244:247]
    s_add_u32 s74, s74, s101
    v_cvt_pk_bf16_f32 v82, v240, v241
    v_cvt_pk_bf16_f32 v83, v242, v243
    v_mfma_f32_16x16x32_bf16 v[244:247], a[252:255], v[236:239], v[244:247]
    ds_read_b128 a[240:243], v2 offset:12288
    ds_read_b128 a[244:247], v2 offset:13312
    v_mfma_f32_16x16x32_bf16 a[52:55], v[120:123], v[40:43], a[52:55]
    ds_read_b128 a[248:251], v2 offset:14336
    v_add_f32 v213, s15, v148
    v_mfma_f32_16x16x32_bf16 a[52:55], v[124:127], v[44:47], a[52:55]
    ds_read_b128 a[252:255], v2 offset:15360
    v_fma_f32 v188, v208, s11, v213
    v_mfma_f32_16x16x32_bf16 a[56:59], v[120:123], v[48:51], a[56:59]
    ds_read_b128 v[112:115], v2 offset:28672
    v_fma_f32 v189, v209, s11, v213
    v_mfma_f32_16x16x32_bf16 a[56:59], v[124:127], v[52:55], a[56:59]
    ds_read_b128 v[116:119], v2 offset:29696
    v_fma_f32 v190, v210, s11, v213
    v_mfma_f32_16x16x32_bf16 a[60:63], v[120:123], v[56:59], a[60:63]
    v_exp_f32 v244, v244
    v_mfma_f32_16x16x32_bf16 a[60:63], v[124:127], v[60:63], a[60:63]
    v_exp_f32 v245, v245
    v_mfma_f32_16x16x32_bf16 v[248:251], a[224:227], v[132:135], v[184:187]
    s_waitcnt lgkmcnt(2)
    v_exp_f32 v246, v246
    v_mfma_f32_16x16x32_bf16 v[248:251], a[228:231], v[164:167], v[248:251]
    v_exp_f32 v247, v247
    v_mfma_f32_16x16x32_bf16 v[248:251], a[232:235], v[196:199], v[248:251]
    v_fma_f32 v191, v211, s11, v213
    v_cvt_pk_bf16_f32 v90, v244, v245
    v_mfma_f32_16x16x32_bf16 v[248:251], a[236:239], v[228:231], v[248:251]
    s_add_u32 m0, s76, s75
    v_cvt_pk_bf16_f32 v91, v246, v247
    ds_read_b128 v[120:123], v2 offset:30720
    v_mfma_f32_16x16x32_bf16 a[144:147], v[96:99], v[32:35], a[144:147]
    s_mov_b32 s76, s60
    buffer_load_dwordx4 v1, s[36:39], s77 offen sc1 lds
    v_mfma_f32_16x16x32_bf16 a[144:147], v[100:103], v[36:39], a[144:147]
    s_mov_b32 s60, s82
    v_exp_f32 v248, v248
    v_mfma_f32_16x16x32_bf16 a[148:151], v[96:99], v[40:43], a[148:151]
    s_mov_b32 s82, s95
    v_exp_f32 v249, v249
    v_mfma_f32_16x16x32_bf16 a[148:151], v[100:103], v[44:47], a[148:151]
    s_mov_b32 s95, s93
    v_exp_f32 v250, v250
    v_mfma_f32_16x16x32_bf16 v[252:255], a[224:227], v[136:139], v[152:155]
    s_mov_b32 s93, s99
    v_exp_f32 v251, v251
    v_mfma_f32_16x16x32_bf16 v[252:255], a[228:231], v[168:171], v[252:255]
    v_cvt_pk_bf16_f32 v76, v248, v249
    v_cvt_pk_bf16_f32 v77, v250, v251
    v_mfma_f32_16x16x32_bf16 v[252:255], a[232:235], v[200:203], v[252:255]
    ds_read_b128 v[124:127], v2 offset:31744
    v_add_u32 v2, s82, v1
    v_mfma_f32_16x16x32_bf16 v[252:255], a[236:239], v[232:235], v[252:255]
    buffer_load_dwordx4 v1, s[36:39], s77 offen offset:1024 sc1 lds
    v_mfma_f32_16x16x32_bf16 a[152:155], v[96:99], v[48:51], a[152:155]
    v_bfe_u32 v8, v1, 2, 6
    v_accvgpr_read_b32 v4, a112
    v_mfma_f32_16x16x32_bf16 a[152:155], v[100:103], v[52:55], a[152:155]
    v_accvgpr_read_b32 v5, a116
    v_add_u32 v8, 192, v8
    v_mfma_f32_16x16x32_bf16 a[156:159], v[96:99], v[56:59], a[156:159]
    v_exp_f32 v252, v252
    v_mfma_f32_16x16x32_bf16 a[156:159], v[100:103], v[60:63], a[156:159]
    v_exp_f32 v253, v253
    v_mfma_f32_16x16x32_bf16 a[160:163], v[104:107], v[32:35], a[160:163]
    v_exp_f32 v254, v254
    v_mfma_f32_16x16x32_bf16 a[160:163], v[108:111], v[36:39], a[160:163]
    v_exp_f32 v255, v255
    v_mfma_f32_16x16x32_bf16 v[240:243], a[224:227], v[140:143], v[156:159]
    buffer_load_dwordx4 v1, s[36:39], s77 offen offset:2048 sc1 lds
    v_mfma_f32_16x16x32_bf16 v[240:243], a[228:231], v[172:175], v[240:243]
    v_cvt_pk_bf16_f32 v84, v252, v253
    v_cvt_pk_bf16_f32 v85, v254, v255
    v_mfma_f32_16x16x32_bf16 v[240:243], a[232:235], v[204:207], v[240:243]
    v_cvt_pk_bf16_f32 v4, 0, v4
    v_cvt_pk_bf16_f32 v5, 0, v5
    v_mfma_f32_16x16x32_bf16 v[240:243], a[236:239], v[236:239], v[240:243]
    v_lshrrev_b32 v15, 8, v1
    ds_bpermute_b32 v4, v8, v4
    v_mfma_f32_16x16x32_bf16 a[164:167], v[104:107], v[40:43], a[164:167]
    ds_bpermute_b32 v5, v8, v5
    ds_read_b128 a[224:227], v2 offset:0
    v_mfma_f32_16x16x32_bf16 a[164:167], v[108:111], v[44:47], a[164:167]
    ds_read_b128 a[228:231], v2 offset:1024
    v_bfe_u32 v14, v1, 4, 4
    v_mfma_f32_16x16x32_bf16 a[168:171], v[104:107], v[48:51], a[168:171]
    ds_read_b128 a[232:235], v2 offset:2048
    v_lshlrev_b32 v15, 3, v15
    v_mfma_f32_16x16x32_bf16 a[168:171], v[108:111], v[52:55], a[168:171]
    buffer_load_dwordx4 v1, s[36:39], s77 offen offset:3072 sc1 lds
    v_mfma_f32_16x16x32_bf16 a[172:175], v[104:107], v[56:59], a[172:175]
    ds_read_b128 a[236:239], v2 offset:3072
    ds_read_b128 v[96:99], v2 offset:16384
    v_mfma_f32_16x16x32_bf16 a[172:175], v[108:111], v[60:63], a[172:175]
    ds_read_b128 v[100:103], v2 offset:17408
    v_sub_u32 v14, v14, v15
    v_mfma_f32_16x16x32_bf16 v[244:247], a[240:243], v[132:135], v[188:191]
    v_exp_f32 v240, v240
    v_mfma_f32_16x16x32_bf16 v[244:247], a[244:247], v[164:167], v[244:247]
    v_exp_f32 v241, v241
    v_mfma_f32_16x16x32_bf16 v[244:247], a[248:251], v[196:199], v[244:247]
    v_exp_f32 v242, v242
    v_mfma_f32_16x16x32_bf16 v[244:247], a[252:255], v[228:231], v[244:247]
    s_add_u32 s100, s77, 4096
    v_exp_f32 v243, v243
    s_waitcnt lgkmcnt(1)
    v_mfma_f32_16x16x32_bf16 a[176:179], v[112:115], v[32:35], a[176:179]
    s_add_u32 m0, m0, 4096
    v_cvt_pk_bf16_f32 v92, v240, v241
    v_cvt_pk_bf16_f32 v93, v242, v243
    v_mfma_f32_16x16x32_bf16 a[176:179], v[116:119], v[36:39], a[176:179]
    buffer_load_dwordx4 v1, s[36:39], s100 offen sc1 lds
    v_mfma_f32_16x16x32_bf16 a[180:183], v[112:115], v[40:43], a[180:183]
    v_exp_f32 v244, v244
    v_mfma_f32_16x16x32_bf16 a[180:183], v[116:119], v[44:47], a[180:183]
    v_exp_f32 v245, v245
    v_mfma_f32_16x16x32_bf16 v[248:251], a[240:243], v[136:139], v[152:155]
    v_exp_f32 v246, v246
    v_mfma_f32_16x16x32_bf16 v[248:251], a[244:247], v[168:171], v[248:251]
    v_exp_f32 v247, v247
    v_mfma_f32_16x16x32_bf16 v[248:251], a[248:251], v[200:203], v[248:251]
    v_cvt_pk_bf16_f32 v78, v244, v245
    v_cvt_pk_bf16_f32 v79, v246, v247
    v_mfma_f32_16x16x32_bf16 v[248:251], a[252:255], v[232:235], v[248:251]
    buffer_load_dwordx4 v1, s[36:39], s100 offen offset:1024 sc1 lds
    v_mfma_f32_16x16x32_bf16 a[184:187], v[112:115], v[48:51], a[184:187]
    v_and_b32 v15, 16, v1
    v_mov_b32 v31, 0x3f80
    v_mfma_f32_16x16x32_bf16 a[184:187], v[116:119], v[52:55], a[184:187]
    v_ashrrev_i32 v14, 1, v14
    v_lshlrev_b32 v15, v15, v31
    v_mfma_f32_16x16x32_bf16 a[188:191], v[112:115], v[56:59], a[188:191]
    v_exp_f32 v248, v248
    v_mfma_f32_16x16x32_bf16 a[188:191], v[116:119], v[60:63], a[188:191]
    v_exp_f32 v249, v249
    v_mfma_f32_16x16x32_bf16 a[192:195], v[120:123], v[32:35], a[192:195]
    v_exp_f32 v250, v250
    v_mfma_f32_16x16x32_bf16 a[192:195], v[124:127], v[36:39], a[192:195]
    v_exp_f32 v251, v251
    v_mfma_f32_16x16x32_bf16 v[252:255], a[240:243], v[140:143], v[156:159]
    buffer_load_dwordx4 v1, s[36:39], s100 offen offset:2048 sc1 lds
    v_mfma_f32_16x16x32_bf16 v[252:255], a[244:247], v[172:175], v[252:255]
    v_cvt_pk_bf16_f32 v86, v248, v249
    v_cvt_pk_bf16_f32 v87, v250, v251
    v_mfma_f32_16x16x32_bf16 v[252:255], a[248:251], v[204:207], v[252:255]
    v_cmp_eq_i32 vcc, 0, v14
    v_mul_f32 v4, s98, v4
    v_mfma_f32_16x16x32_bf16 v[252:255], a[252:255], v[236:239], v[252:255]
    v_cndmask_b32 v216, 0, v15, vcc
    v_cmp_eq_i32 vcc, 1, v14
    v_mfma_f32_16x16x32_bf16 a[196:199], v[120:123], v[40:43], a[196:199]
    v_mul_f32 v5, s98, v5
    v_cndmask_b32 v217, 0, v15, vcc
    v_mfma_f32_16x16x32_bf16 a[196:199], v[124:127], v[44:47], a[196:199]
    v_cmp_eq_i32 vcc, 2, v14
    v_and_b32 v31, 512, v1
    v_mfma_f32_16x16x32_bf16 a[200:203], v[120:123], v[48:51], a[200:203]
    v_exp_f32 v252, v252
    v_mfma_f32_16x16x32_bf16 a[200:203], v[124:127], v[52:55], a[200:203]
    buffer_load_dwordx4 v1, s[36:39], s100 offen offset:3072 sc1 lds
    v_mfma_f32_16x16x32_bf16 a[204:207], v[120:123], v[56:59], a[204:207]
    v_cndmask_b32 v218, 0, v15, vcc
    v_cmp_eq_i32 vcc, 3, v14
    v_mfma_f32_16x16x32_bf16 a[204:207], v[124:127], v[60:63], a[204:207]
    v_exp_f32 v4, v4
    v_smfmac_f32_16x16x64_bf16 a[208:211], a[136:139], v[32:39], v215
    v_cndmask_b32 v219, 0, v15, vcc
    v_cmp_eq_i32 vcc, -8, v14
    v_smfmac_f32_16x16x64_bf16 a[212:215], a[136:139], v[40:47], v215
    v_exp_f32 v5, v5
    v_smfmac_f32_16x16x64_bf16 a[216:219], a[136:139], v[48:55], v215
    v_cndmask_b32 v220, 0, v15, vcc
    v_cmp_eq_i32 vcc, -7, v14
    v_smfmac_f32_16x16x64_bf16 a[220:223], a[136:139], v[56:63], v215
    s_add_u32 s77, s77, 32768
    v_cndmask_b32 v221, 0, v15, vcc
    v_cmp_eq_i32 vcc, -6, v14
    v_add_f32 v4, 1.0, v4
    v_add_f32 v5, 1.0, v5
    v_cndmask_b32 v222, 0, v15, vcc
    v_cmp_eq_i32 vcc, -5, v14
    v_rcp_f32 v4, v4
    v_rcp_f32 v5, v5
    v_cndmask_b32 v223, 0, v15, vcc
    v_mad_u32_u24 v31, v31, 17, v1
    s_cmp_eq_u32 s6, 7
    s_cselect_b32 s16, s8, 0
    s_cselect_b32 s17, s9, 0
    s_cselect_b32 s18, s10, 0
    s_cselect_b32 s19, s11, 0
    s_cselect_b32 s20, s12, 0
    s_cselect_b32 s21, s13, 0
    s_cselect_b32 s22, s14, 0
    s_cselect_b32 s23, s15, 0
    s_cbranch_scc1 K1_J7
K1_J7_BACK:
    v_add_f32 v212, s20, v152
    v_fma_f32 v176, v208, s16, v212
    v_fma_f32 v177, v209, s16, v212
    v_fma_f32 v178, v210, s16, v212
    v_fma_f32 v179, v211, s16, v212
    s_nop 1
    s_waitcnt lgkmcnt(0)
    v_mfma_f32_16x16x32_bf16 v[240:243], a[224:227], v[136:139], v[176:179]
    s_mov_b32 s99, s76
    ds_read_b128 v[104:107], v2 offset:18432
    ds_read_b128 v[108:111], v2 offset:19456
    v_mfma_f32_16x16x32_bf16 v[240:243], a[228:231], v[168:171], v[240:243]
    v_exp_f32 v253, v253
    v_mfma_f32_16x16x32_bf16 v[240:243], a[232:235], v[200:203], v[240:243]
    v_exp_f32 v254, v254
    v_mfma_f32_16x16x32_bf16 v[240:243], a[236:239], v[232:235], v[240:243]
    v_exp_f32 v255, v255
    v_mfma_f32_16x16x32_bf16 a[4:7], v[96:99], v[72:75], a[4:7]
    s_add_u32 m0, s76, s75
    v_cvt_pk_bf16_f32 v94, v252, v253
    v_cvt_pk_bf16_f32 v95, v254, v255
    v_mfma_f32_16x16x32_bf16 a[4:7], v[100:103], v[76:79], a[4:7]
    s_mov_b32 s76, s60
    buffer_load_dwordx4 v1, s[36:39], s77 offen sc1 lds
    v_mfma_f32_16x16x32_bf16 a[8:11], v[96:99], v[80:83], a[8:11]
    s_mov_b32 s60, s82
    ds_read_b128 a[240:243], v2 offset:4096
    ds_read_b128 a[244:247], v2 offset:5120
    v_mfma_f32_16x16x32_bf16 a[8:11], v[100:103], v[84:87], a[8:11]
    s_mov_b32 s82, s95
    ds_read_b128 a[248:251], v2 offset:6144
    v_add_f32 v213, s21, v152
    v_mfma_f32_16x16x32_bf16 a[12:15], v[96:99], v[88:91], a[12:15]
    s_mov_b32 s95, s93
    ds_read_b128 a[252:255], v2 offset:7168
    v_fma_f32 v180, v208, s17, v213
    v_mfma_f32_16x16x32_bf16 a[12:15], v[100:103], v[92:95], a[12:15]
    s_mov_b32 s93, s99
    ds_read_b128 v[112:115], v2 offset:20480
    v_fma_f32 v181, v209, s17, v213
    v_mfma_f32_16x16x32_bf16 v[244:247], a[224:227], v[140:143], v[156:159]
    ds_read_b128 v[116:119], v2 offset:21504
    v_fma_f32 v182, v210, s17, v213
    v_mfma_f32_16x16x32_bf16 v[244:247], a[228:231], v[172:175], v[244:247]
    v_fma_f32 v183, v211, s17, v213
    ds_read_b128 v[120:123], v2 offset:22528
    v_mfma_f32_16x16x32_bf16 v[244:247], a[232:235], v[204:207], v[244:247]
    ds_read_b128 v[124:127], v2 offset:23552
    v_add_f32 v212, s22, v152
    v_mfma_f32_16x16x32_bf16 v[244:247], a[236:239], v[236:239], v[244:247]
    s_waitcnt lgkmcnt(4)
    buffer_load_dwordx4 v1, s[36:39], s77 offen offset:1024 sc1 lds
    v_mfma_f32_16x16x32_bf16 a[20:23], v[104:107], v[72:75], a[20:23]
    ds_read_b128 a[224:227], v2 offset:8192
    ds_read_b128 a[228:231], v2 offset:9216
    v_mfma_f32_16x16x32_bf16 a[20:23], v[108:111], v[76:79], a[20:23]
    ds_read_b128 a[232:235], v2 offset:10240
    v_fma_f32 v184, v208, s18, v212
    v_mfma_f32_16x16x32_bf16 a[24:27], v[104:107], v[80:83], a[24:27]
    ds_read_b128 a[236:239], v2 offset:11264
    v_fma_f32 v185, v209, s18, v212
    v_mfma_f32_16x16x32_bf16 a[24:27], v[108:111], v[84:87], a[24:27]
    ds_read_b128 v[96:99], v2 offset:24576
    v_fma_f32 v186, v210, s18, v212
    v_mfma_f32_16x16x32_bf16 a[28:31], v[104:107], v[88:91], a[28:31]
    ds_read_b128 v[100:103], v2 offset:25600
    v_fma_f32 v187, v211, s18, v212
    v_mfma_f32_16x16x32_bf16 a[28:31], v[108:111], v[92:95], a[28:31]
    v_exp_f32 v240, v240
    v_mfma_f32_16x16x32_bf16 v[248:251], a[240:243], v[136:139], v[180:183]
    v_exp_f32 v241, v241
    v_mfma_f32_16x16x32_bf16 v[248:251], a[244:247], v[168:171], v[248:251]
    v_exp_f32 v242, v242
    v_mfma_f32_16x16x32_bf16 v[248:251], a[248:251], v[200:203], v[248:251]
    buffer_load_dwordx4 v1, s[36:39], s77 offen offset:2048 sc1 lds
    v_mfma_f32_16x16x32_bf16 v[248:251], a[252:255], v[232:235], v[248:251]
    s_waitcnt lgkmcnt(0)
    v_exp_f32 v243, v243
    v_mfma_f32_16x16x32_bf16 a[36:39], v[112:115], v[72:75], a[36:39]
    v_cvt_pk_bf16_f32 v48, v240, v241
    v_cvt_pk_bf16_f32 v49, v242, v243
    v_mfma_f32_16x16x32_bf16 a[36:39], v[116:119], v[76:79], a[36:39]
    ds_read_b128 v[104:107], v2 offset:26624
    ds_read_b128 v[108:111], v2 offset:27648
    v_mfma_f32_16x16x32_bf16 a[40:43], v[112:115], v[80:83], a[40:43]
    v_exp_f32 v244, v244
    v_mfma_f32_16x16x32_bf16 a[40:43], v[116:119], v[84:87], a[40:43]
    v_exp_f32 v245, v245
    v_mfma_f32_16x16x32_bf16 a[44:47], v[112:115], v[88:91], a[44:47]
    v_exp_f32 v246, v246
    v_mfma_f32_16x16x32_bf16 a[44:47], v[116:119], v[92:95], a[44:47]
    s_waitcnt vmcnt(11)
    v_exp_f32 v247, v247
    v_mfma_f32_16x16x32_bf16 v[12:15], v[64:67], v[216:219], 0
    buffer_load_dwordx4 v1, s[36:39], s77 offen offset:3072 sc1 lds
    v_mfma_f32_16x16x32_bf16 v[16:19], v[68:71], v[216:219], 0
    v_cvt_pk_bf16_f32 v56, v244, v245
    v_cvt_pk_bf16_f32 v57, v246, v247
    v_mfma_f32_16x16x32_bf16 v[252:255], a[240:243], v[140:143], v[156:159]
    ds_read_b128 a[240:243], v2 offset:12288
    ds_read_b128 v[112:115], v2 offset:28672
    v_mfma_f32_16x16x32_bf16 v[252:255], a[244:247], v[172:175], v[252:255]
    v_cvt_pk_bf16_f32 v12, v12, v13
    v_cvt_pk_bf16_f32 v13, v14, v15
    v_mfma_f32_16x16x32_bf16 v[252:255], a[248:251], v[204:207], v[252:255]
    v_cvt_pk_bf16_f32 v14, v16, v17
    v_cvt_pk_bf16_f32 v15, v18, v19
    v_mfma_f32_16x16x32_bf16 v[252:255], a[252:255], v[236:239], v[252:255]
    buffer_store_dwordx4 v[12:15], v31, s[56:59], s63 offen offset:0 sc1
    v_mfma_f32_16x16x32_bf16 a[52:55], v[120:123], v[72:75], a[52:55]
    ds_read_b128 a[244:247], v2 offset:13312
    ds_read_b128 a[248:251], v2 offset:14336
    v_mfma_f32_16x16x32_bf16 a[52:55], v[124:127], v[76:79], a[52:55]
    ds_read_b128 a[252:255], v2 offset:15360
    v_add_f32 v213, s23, v152
    v_mfma_f32_16x16x32_bf16 a[56:59], v[120:123], v[80:83], a[56:59]
    s_add_u32 s100, s77, 4096
    ds_read_b128 v[116:119], v2 offset:29696
    v_fma_f32 v188, v208, s19, v213
    v_mfma_f32_16x16x32_bf16 a[56:59], v[124:127], v[84:87], a[56:59]
    s_add_u32 m0, m0, 4096
    v_exp_f32 v248, v248
    v_mfma_f32_16x16x32_bf16 a[60:63], v[120:123], v[88:91], a[60:63]
    buffer_load_dwordx4 v1, s[36:39], s100 offen sc1 lds
    v_mfma_f32_16x16x32_bf16 a[60:63], v[124:127], v[92:95], a[60:63]
    v_exp_f32 v249, v249
    v_mfma_f32_16x16x32_bf16 v[12:15], v[64:67], v[220:223], 0
    v_exp_f32 v250, v250
    v_mfma_f32_16x16x32_bf16 v[16:19], v[68:71], v[220:223], 0
    v_exp_f32 v251, v251
    v_mfma_f32_16x16x32_bf16 v[240:243], a[224:227], v[136:139], v[184:187]
    v_fma_f32 v189, v209, s19, v213
    v_fma_f32 v190, v210, s19, v213
    v_mfma_f32_16x16x32_bf16 v[240:243], a[228:231], v[168:171], v[240:243]
    v_fma_f32 v191, v211, s19, v213
    v_cvt_pk_bf16_f32 v12, v12, v13
    v_mfma_f32_16x16x32_bf16 v[240:243], a[232:235], v[200:203], v[240:243]
    v_cvt_pk_bf16_f32 v13, v14, v15
    v_cvt_pk_bf16_f32 v14, v16, v17
    v_mfma_f32_16x16x32_bf16 v[240:243], a[236:239], v[232:235], v[240:243]
    v_cvt_pk_bf16_f32 v15, v18, v19
    v_cvt_pk_bf16_f32 v50, v248, v249
    v_mfma_f32_16x16x32_bf16 a[148:151], v[96:99], v[72:75], a[148:151]
    buffer_load_dwordx4 v1, s[36:39], s100 offen offset:1024 sc1 lds
    v_mfma_f32_16x16x32_bf16 a[148:151], v[100:103], v[76:79], a[148:151]
    buffer_store_dwordx4 v[12:15], v31, s[56:59], s63 offen offset:1024 sc1
    v_mfma_f32_16x16x32_bf16 a[152:155], v[96:99], v[80:83], a[152:155]
    v_cvt_pk_bf16_f32 v51, v250, v251
    ds_read_b128 v[120:123], v2 offset:30720
    v_mfma_f32_16x16x32_bf16 a[152:155], v[100:103], v[84:87], a[152:155]
    ds_read_b128 v[124:127], v2 offset:31744
    v_add_u32 v2, s82, v1
    v_mfma_f32_16x16x32_bf16 a[156:159], v[96:99], v[88:91], a[156:159]
    v_exp_f32 v252, v252
    v_mfma_f32_16x16x32_bf16 a[156:159], v[100:103], v[92:95], a[156:159]
    v_exp_f32 v253, v253
    v_mfma_f32_16x16x32_bf16 v[12:15], v[20:23], v[216:219], 0
    v_exp_f32 v254, v254
    v_mfma_f32_16x16x32_bf16 v[16:19], v[24:27], v[216:219], 0
    v_exp_f32 v255, v255
    v_mfma_f32_16x16x32_bf16 v[244:247], a[224:227], v[140:143], v[156:159]
    buffer_load_dwordx4 v1, s[36:39], s100 offen offset:2048 sc1 lds
    v_mfma_f32_16x16x32_bf16 v[244:247], a[228:231], v[172:175], v[244:247]
    v_cvt_pk_bf16_f32 v58, v252, v253
    v_cvt_pk_bf16_f32 v59, v254, v255
    v_mfma_f32_16x16x32_bf16 v[244:247], a[232:235], v[204:207], v[244:247]
    v_cvt_pk_bf16_f32 v12, v12, v13
    v_cvt_pk_bf16_f32 v13, v14, v15
    v_mfma_f32_16x16x32_bf16 v[244:247], a[236:239], v[236:239], v[244:247]
    s_waitcnt lgkmcnt(0)
    v_cvt_pk_bf16_f32 v14, v16, v17
    v_cvt_pk_bf16_f32 v15, v18, v19
    v_mfma_f32_16x16x32_bf16 a[164:167], v[104:107], v[72:75], a[164:167]
    buffer_store_dwordx4 v[12:15], v31, s[56:59], s63 offen offset:512 sc1
    v_mfma_f32_16x16x32_bf16 a[164:167], v[108:111], v[76:79], a[164:167]
    v_exp_f32 v240, v240
    v_mfma_f32_16x16x32_bf16 a[168:171], v[104:107], v[80:83], a[168:171]
    v_exp_f32 v241, v241
    v_mfma_f32_16x16x32_bf16 a[168:171], v[108:111], v[84:87], a[168:171]
    v_exp_f32 v242, v242
    v_mfma_f32_16x16x32_bf16 a[172:175], v[104:107], v[88:91], a[172:175]
    v_exp_f32 v243, v243
    v_mfma_f32_16x16x32_bf16 a[172:175], v[108:111], v[92:95], a[172:175]
    buffer_load_dwordx4 v1, s[36:39], s100 offen offset:3072 sc1 lds
    v_mfma_f32_16x16x32_bf16 v[12:15], v[20:23], v[220:223], 0
    v_exp_f32 v244, v244
    v_mfma_f32_16x16x32_bf16 v[16:19], v[24:27], v[220:223], 0
    v_exp_f32 v245, v245
    v_mfma_f32_16x16x32_bf16 v[248:251], a[240:243], v[136:139], v[188:191]
    v_exp_f32 v246, v246
    v_mfma_f32_16x16x32_bf16 v[248:251], a[244:247], v[168:171], v[248:251]
    v_exp_f32 v247, v247
    v_mfma_f32_16x16x32_bf16 v[248:251], a[248:251], v[200:203], v[248:251]
    v_cvt_pk_bf16_f32 v12, v12, v13
    v_cvt_pk_bf16_f32 v13, v14, v15
    v_mfma_f32_16x16x32_bf16 v[248:251], a[252:255], v[232:235], v[248:251]
    v_cvt_pk_bf16_f32 v14, v16, v17
    v_cvt_pk_bf16_f32 v15, v18, v19
    v_mfma_f32_16x16x32_bf16 a[180:183], v[112:115], v[72:75], a[180:183]
    buffer_store_dwordx4 v[12:15], v31, s[56:59], s63 offen offset:1536 sc1
    v_mfma_f32_16x16x32_bf16 a[180:183], v[116:119], v[76:79], a[180:183]
    s_add_u32 s77, s77, 32768
    v_cvt_pk_bf16_f32 v52, v240, v241
    v_cvt_pk_bf16_f32 v53, v242, v243
    v_mfma_f32_16x16x32_bf16 a[184:187], v[112:115], v[80:83], a[184:187]
    v_exp_f32 v248, v248
    v_mfma_f32_16x16x32_bf16 a[184:187], v[116:119], v[84:87], a[184:187]
    v_exp_f32 v249, v249
    v_mfma_f32_16x16x32_bf16 a[188:191], v[112:115], v[88:91], a[188:191]
    v_exp_f32 v250, v250
    v_mfma_f32_16x16x32_bf16 a[188:191], v[116:119], v[92:95], a[188:191]
    v_exp_f32 v251, v251
    v_mfma_f32_16x16x32_bf16 v[12:15], v[144:147], v[216:219], 0
    v_cvt_pk_bf16_f32 v60, v244, v245
    v_cvt_pk_bf16_f32 v61, v246, v247
    v_mfma_f32_16x16x32_bf16 v[16:19], a[140:143], v[216:219], 0
    v_cvt_pk_bf16_f32 v54, v248, v249
    v_cvt_pk_bf16_f32 v55, v250, v251
    v_mfma_f32_16x16x32_bf16 v[252:255], a[240:243], v[140:143], v[156:159]
    v_accvgpr_read_b32 v6, a120
    v_accvgpr_read_b32 v7, a124
    v_mfma_f32_16x16x32_bf16 v[252:255], a[244:247], v[172:175], v[252:255]
    v_cvt_pk_bf16_f32 v12, v12, v13
    v_cvt_pk_bf16_f32 v13, v14, v15
    v_mfma_f32_16x16x32_bf16 v[252:255], a[248:251], v[204:207], v[252:255]
    v_cvt_pk_bf16_f32 v14, v16, v17
    v_cvt_pk_bf16_f32 v15, v18, v19
    v_mfma_f32_16x16x32_bf16 v[252:255], a[252:255], v[236:239], v[252:255]
    buffer_store_dwordx4 v[12:15], v1, s[56:59], s64 offen offset:0 sc1
    v_mfma_f32_16x16x32_bf16 a[196:199], v[120:123], v[72:75], a[196:199]
    v_cvt_pk_bf16_f32 v6, 0, v6
    v_cvt_pk_bf16_f32 v7, 0, v7
    v_mfma_f32_16x16x32_bf16 a[196:199], v[124:127], v[76:79], a[196:199]
    ds_bpermute_b32 v6, v8, v6
    ds_bpermute_b32 v7, v8, v7
    s_waitcnt vmcnt(8) lgkmcnt(0)
    s_barrier
    v_mfma_f32_16x16x32_bf16 a[200:203], v[120:123], v[80:83], a[200:203]
    ds_read_b128 a[224:227], v2 offset:0
    ds_read_b128 a[228:231], v2 offset:1024
    v_mfma_f32_16x16x32_bf16 a[200:203], v[124:127], v[84:87], a[200:203]
    ds_read_b128 a[232:235], v2 offset:2048
    v_mul_f32 v6, s98, v6
    v_mfma_f32_16x16x32_bf16 a[204:207], v[120:123], v[88:91], a[204:207]
    ds_read_b128 a[236:239], v2 offset:3072
    v_mul_f32 v7, s98, v7
    v_mfma_f32_16x16x32_bf16 a[204:207], v[124:127], v[92:95], a[204:207]
    ds_read_b128 v[96:99], v2 offset:16384
    v_mfma_f32_16x16x32_bf16 v[12:15], v[144:147], v[220:223], 0
    ds_read_b128 v[100:103], v2 offset:17408
    v_mfma_f32_16x16x32_bf16 v[16:19], a[140:143], v[220:223], 0
    v_exp_f32 v252, v252
    v_smfmac_f32_16x16x64_bf16 a[212:215], a[136:139], v[72:79], v215
    v_exp_f32 v6, v6
    v_smfmac_f32_16x16x64_bf16 a[216:219], a[136:139], v[80:87], v215
    v_exp_f32 v7, v7
    v_smfmac_f32_16x16x64_bf16 a[220:223], a[136:139], v[88:95], v215
    v_cvt_pk_bf16_f32 v12, v12, v13
    v_cvt_pk_bf16_f32 v13, v14, v15
    v_add_f32 v6, 1.0, v6
    v_add_f32 v7, 1.0, v7
    v_cvt_pk_bf16_f32 v14, v16, v17
    v_cvt_pk_bf16_f32 v15, v18, v19
    v_rcp_f32 v6, v6
    v_rcp_f32 v7, v7
    buffer_store_dwordx4 v[12:15], v1, s[56:59], s62 offen offset:0 sc1
    s_nop 1
    v_accvgpr_read_b32 v9, a208
    v_accvgpr_read_b32 v10, a209
    v_add_f32 v9, v9, v10
    v_cmp_nge_f32 vcc, 0x71800000, v9
    v_rcp_f32 v10, v9
    s_nop 0
    s_or_b64 s[84:85], s[84:85], vcc
    v_mul_f32 v10, v10, v4
    v_accvgpr_read_b32 v12, a0
    v_accvgpr_read_b32 v13, a1
    v_accvgpr_read_b32 v14, a2
    v_accvgpr_read_b32 v15, a3
    v_accvgpr_read_b32 v16, a16
    v_accvgpr_read_b32 v17, a17
    v_accvgpr_read_b32 v18, a18
    v_accvgpr_read_b32 v19, a19
    v_pk_mul_f32 v[12:13], v[12:13], v[10:11] op_sel_hi:[1,0]
    v_pk_mul_f32 v[14:15], v[14:15], v[10:11] op_sel_hi:[1,0]
    v_pk_mul_f32 v[16:17], v[16:17], v[10:11] op_sel_hi:[1,0]
    v_pk_mul_f32 v[18:19], v[18:19], v[10:11] op_sel_hi:[1,0]
    v_cvt_pk_bf16_f32 v12, v12, v13
    v_cvt_pk_bf16_f32 v13, v14, v15
    v_cvt_pk_bf16_f32 v14, v16, v17
    v_cvt_pk_bf16_f32 v15, v18, v19
    buffer_store_dwordx4 v[12:15], v1, s[40:43], s80 offen offset:0 sc1
    v_accvgpr_read_b32 v20, a32
    v_accvgpr_read_b32 v21, a33
    v_accvgpr_read_b32 v22, a34
    v_accvgpr_read_b32 v23, a35
    v_accvgpr_read_b32 v24, a48
    v_accvgpr_read_b32 v25, a49
    v_accvgpr_read_b32 v26, a50
    v_accvgpr_read_b32 v27, a51
    v_pk_mul_f32 v[20:21], v[20:21], v[10:11] op_sel_hi:[1,0]
    v_pk_mul_f32 v[22:23], v[22:23], v[10:11] op_sel_hi:[1,0]
    v_pk_mul_f32 v[24:25], v[24:25], v[10:11] op_sel_hi:[1,0]
    v_pk_mul_f32 v[26:27], v[26:27], v[10:11] op_sel_hi:[1,0]
    v_cvt_pk_bf16_f32 v20, v20, v21
    v_cvt_pk_bf16_f32 v21, v22, v23
    v_cvt_pk_bf16_f32 v22, v24, v25
    v_cvt_pk_bf16_f32 v23, v26, v27
    buffer_store_dwordx4 v[20:23], v1, s[40:43], s80 offen offset:1024 sc1
    v_accvgpr_read_b32 v12, a144
    v_accvgpr_read_b32 v13, a145
    v_accvgpr_read_b32 v14, a146
    v_accvgpr_read_b32 v15, a147
    v_accvgpr_read_b32 v16, a160
    v_accvgpr_read_b32 v17, a161
    v_accvgpr_read_b32 v18, a162
    v_accvgpr_read_b32 v19, a163
    v_pk_mul_f32 v[12:13], v[12:13], v[10:11] op_sel_hi:[1,0]
    v_pk_mul_f32 v[14:15], v[14:15], v[10:11] op_sel_hi:[1,0]
    v_pk_mul_f32 v[16:17], v[16:17], v[10:11] op_sel_hi:[1,0]
    v_pk_mul_f32 v[18:19], v[18:19], v[10:11] op_sel_hi:[1,0]
    v_cvt_pk_bf16_f32 v12, v12, v13
    v_cvt_pk_bf16_f32 v13, v14, v15
    v_cvt_pk_bf16_f32 v14, v16, v17
    v_cvt_pk_bf16_f32 v15, v18, v19
    buffer_store_dwordx4 v[12:15], v1, s[40:43], s80 offen offset:2048 sc1
    v_accvgpr_read_b32 v20, a176
    v_accvgpr_read_b32 v21, a177
    v_accvgpr_read_b32 v22, a178
    v_accvgpr_read_b32 v23, a179
    v_accvgpr_read_b32 v24, a192
    v_accvgpr_read_b32 v25, a193
    v_accvgpr_read_b32 v26, a194
    v_accvgpr_read_b32 v27, a195
    v_pk_mul_f32 v[20:21], v[20:21], v[10:11] op_sel_hi:[1,0]
    v_pk_mul_f32 v[22:23], v[22:23], v[10:11] op_sel_hi:[1,0]
    v_pk_mul_f32 v[24:25], v[24:25], v[10:11] op_sel_hi:[1,0]
    v_pk_mul_f32 v[26:27], v[26:27], v[10:11] op_sel_hi:[1,0]
    v_cvt_pk_bf16_f32 v20, v20, v21
    v_cvt_pk_bf16_f32 v21, v22, v23
    v_cvt_pk_bf16_f32 v22, v24, v25
    v_cvt_pk_bf16_f32 v23, v26, v27
    buffer_store_dwordx4 v[20:23], v1, s[40:43], s80 offen offset:3072 sc1
    v_accvgpr_read_b32 v9, a212
    v_accvgpr_read_b32 v10, a213
    v_add_f32 v9, v9, v10
    v_cmp_nge_f32 vcc, 0x71800000, v9
    v_rcp_f32 v10, v9
    s_nop 0
    s_or_b64 s[84:85], s[84:85], vcc
    v_mul_f32 v10, v10, v5
    s_add_u32 s72, s80, 622592
    v_accvgpr_read_b32 v12, a4
    v_accvgpr_read_b32 v13, a5
    v_accvgpr_read_b32 v14, a6
    v_accvgpr_read_b32 v15, a7
    v_accvgpr_read_b32 v16, a20
    v_accvgpr_read_b32 v17, a21
    v_accvgpr_read_b32 v18, a22
    v_accvgpr_read_b32 v19, a23
    v_pk_mul_f32 v[12:13], v[12:13], v[10:11] op_sel_hi:[1,0]
    v_pk_mul_f32 v[14:15], v[14:15], v[10:11] op_sel_hi:[1,0]
    v_pk_mul_f32 v[16:17], v[16:17], v[10:11] op_sel_hi:[1,0]
    v_pk_mul_f32 v[18:19], v[18:19], v[10:11] op_sel_hi:[1,0]
    v_cvt_pk_bf16_f32 v12, v12, v13
    v_cvt_pk_bf16_f32 v13, v14, v15
    v_cvt_pk_bf16_f32 v14, v16, v17
    v_cvt_pk_bf16_f32 v15, v18, v19
    buffer_store_dwordx4 v[12:15], v1, s[40:43], s72 offen offset:0 sc1
    v_accvgpr_read_b32 v20, a36
    v_accvgpr_read_b32 v21, a37
    v_accvgpr_read_b32 v22, a38
    v_accvgpr_read_b32 v23, a39
    v_accvgpr_read_b32 v24, a52
    v_accvgpr_read_b32 v25, a53
    v_accvgpr_read_b32 v26, a54
    v_accvgpr_read_b32 v27, a55
    v_pk_mul_f32 v[20:21], v[20:21], v[10:11] op_sel_hi:[1,0]
    v_pk_mul_f32 v[22:23], v[22:23], v[10:11] op_sel_hi:[1,0]
    v_pk_mul_f32 v[24:25], v[24:25], v[10:11] op_sel_hi:[1,0]
    v_pk_mul_f32 v[26:27], v[26:27], v[10:11] op_sel_hi:[1,0]
    v_cvt_pk_bf16_f32 v20, v20, v21
    v_cvt_pk_bf16_f32 v21, v22, v23
    v_cvt_pk_bf16_f32 v22, v24, v25
    v_cvt_pk_bf16_f32 v23, v26, v27
    buffer_store_dwordx4 v[20:23], v1, s[40:43], s72 offen offset:1024 sc1
    v_accvgpr_read_b32 v12, a148
    v_accvgpr_read_b32 v13, a149
    v_accvgpr_read_b32 v14, a150
    v_accvgpr_read_b32 v15, a151
    v_accvgpr_read_b32 v16, a164
    v_accvgpr_read_b32 v17, a165
    v_accvgpr_read_b32 v18, a166
    v_accvgpr_read_b32 v19, a167
    v_pk_mul_f32 v[12:13], v[12:13], v[10:11] op_sel_hi:[1,0]
    v_pk_mul_f32 v[14:15], v[14:15], v[10:11] op_sel_hi:[1,0]
    v_pk_mul_f32 v[16:17], v[16:17], v[10:11] op_sel_hi:[1,0]
    v_pk_mul_f32 v[18:19], v[18:19], v[10:11] op_sel_hi:[1,0]
    v_cvt_pk_bf16_f32 v12, v12, v13
    v_cvt_pk_bf16_f32 v13, v14, v15
    v_cvt_pk_bf16_f32 v14, v16, v17
    v_cvt_pk_bf16_f32 v15, v18, v19
    buffer_store_dwordx4 v[12:15], v1, s[40:43], s72 offen offset:2048 sc1
    v_accvgpr_read_b32 v20, a180
    v_accvgpr_read_b32 v21, a181
    v_accvgpr_read_b32 v22, a182
    v_accvgpr_read_b32 v23, a183
    v_accvgpr_read_b32 v24, a196
    v_accvgpr_read_b32 v25, a197
    v_accvgpr_read_b32 v26, a198
    v_accvgpr_read_b32 v27, a199
    v_pk_mul_f32 v[20:21], v[20:21], v[10:11] op_sel_hi:[1,0]
    v_pk_mul_f32 v[22:23], v[22:23], v[10:11] op_sel_hi:[1,0]
    v_pk_mul_f32 v[24:25], v[24:25], v[10:11] op_sel_hi:[1,0]
    v_pk_mul_f32 v[26:27], v[26:27], v[10:11] op_sel_hi:[1,0]
    v_cvt_pk_bf16_f32 v20, v20, v21
    v_cvt_pk_bf16_f32 v21, v22, v23
    v_cvt_pk_bf16_f32 v22, v24, v25
    v_cvt_pk_bf16_f32 v23, v26, v27
    buffer_store_dwordx4 v[20:23], v1, s[40:43], s72 offen offset:3072 sc1
    v_mov_b32 v9, 1
    v_lshlrev_b32 v216, 20, v1
    s_lshl2_add_u32 s7, s4, s101
    s_add_u32 s7, s7, 163840
    s_waitcnt vmcnt(8)
    buffer_store_dword v9, v216, s[32:35], s7 offen sc1
    s_sub_u32 s78, 14, s6
    s_sub_u32 s78, s78, s6
    s_cmp_eq_u32 s78, 0
    s_cbranch_scc1 K1_LS_END
.p2align 3
K1_LS:
    s_waitcnt lgkmcnt(0)
    v_mfma_f32_16x16x32_bf16 v[240:243], a[224:227], v[136:139], v[176:179]
    s_mov_b32 s99, s76
    ds_read_b128 v[104:107], v2 offset:18432
    ds_read_b128 v[108:111], v2 offset:19456
    v_mfma_f32_16x16x32_bf16 v[240:243], a[228:231], v[168:171], v[240:243]
    v_exp_f32 v253, v253
    v_mfma_f32_16x16x32_bf16 v[240:243], a[232:235], v[200:203], v[240:243]
    v_exp_f32 v254, v254
    v_mfma_f32_16x16x32_bf16 v[240:243], a[236:239], v[232:235], v[240:243]
    v_exp_f32 v255, v255
    v_mfma_f32_16x16x32_bf16 a[8:11], v[96:99], v[48:51], a[8:11]
    s_add_u32 m0, s76, s75
    v_cvt_pk_bf16_f32 v62, v252, v253
    v_cvt_pk_bf16_f32 v63, v254, v255
    v_mfma_f32_16x16x32_bf16 a[8:11], v[100:103], v[52:55], a[8:11]
    s_mov_b32 s76, s60
    ds_read_b128 a[240:243], v2 offset:4096
    ds_read_b128 a[244:247], v2 offset:5120
    v_mfma_f32_16x16x32_bf16 a[12:15], v[96:99], v[56:59], a[12:15]
    s_mov_b32 s60, s82
    buffer_load_dwordx4 v1, s[36:39], s77 offen sc1 lds
    v_mfma_f32_16x16x32_bf16 a[12:15], v[100:103], v[60:63], a[12:15]
    s_mov_b32 s82, s95
    ds_read_b128 a[248:251], v2 offset:6144
    ds_read_b128 a[252:255], v2 offset:7168
    v_mfma_f32_16x16x32_bf16 v[244:247], a[224:227], v[140:143], v[156:159]
    s_mov_b32 s95, s93
    v_exp_f32 v240, v240
    v_mfma_f32_16x16x32_bf16 v[244:247], a[228:231], v[172:175], v[244:247]
    s_mov_b32 s93, s99
    ds_read_b128 v[112:115], v2 offset:20480
    ds_read_b128 v[116:119], v2 offset:21504
    v_mfma_f32_16x16x32_bf16 v[244:247], a[232:235], v[204:207], v[244:247]
    buffer_load_dwordx4 v1, s[36:39], s77 offen offset:1024 sc1 lds
    v_mfma_f32_16x16x32_bf16 v[244:247], a[236:239], v[236:239], v[244:247]
    s_waitcnt lgkmcnt(6)
    v_exp_f32 v241, v241
    v_mfma_f32_16x16x32_bf16 a[24:27], v[104:107], v[48:51], a[24:27]
    v_exp_f32 v242, v242
    v_mfma_f32_16x16x32_bf16 a[24:27], v[108:111], v[52:55], a[24:27]
    v_exp_f32 v243, v243
    v_mfma_f32_16x16x32_bf16 a[28:31], v[104:107], v[56:59], a[28:31]
    buffer_load_dwordx4 v1, s[36:39], s77 offen offset:2048 sc1 lds
    v_mfma_f32_16x16x32_bf16 a[28:31], v[108:111], v[60:63], a[28:31]
    s_waitcnt lgkmcnt(2)
    ds_read_b128 v[120:123], v2 offset:22528
    ds_read_b128 v[124:127], v2 offset:23552
    v_mfma_f32_16x16x32_bf16 v[248:251], a[240:243], v[136:139], v[180:183]
    v_cvt_pk_bf16_f32 v80, v240, v241
    v_cvt_pk_bf16_f32 v81, v242, v243
    v_mfma_f32_16x16x32_bf16 v[248:251], a[244:247], v[168:171], v[248:251]
    v_exp_f32 v244, v244
    v_mfma_f32_16x16x32_bf16 v[248:251], a[248:251], v[200:203], v[248:251]
    buffer_load_dwordx4 v1, s[36:39], s77 offen offset:3072 sc1 lds
    v_mfma_f32_16x16x32_bf16 v[248:251], a[252:255], v[232:235], v[248:251]
    s_waitcnt lgkmcnt(2)
    ds_read_b128 a[224:227], v2 offset:8192
    ds_read_b128 a[228:231], v2 offset:9216
    v_mfma_f32_16x16x32_bf16 a[40:43], v[112:115], v[48:51], a[40:43]
    v_exp_f32 v245, v245
    v_mfma_f32_16x16x32_bf16 a[40:43], v[116:119], v[52:55], a[40:43]
    ds_read_b128 a[232:235], v2 offset:10240
    ds_read_b128 a[236:239], v2 offset:11264
    v_mfma_f32_16x16x32_bf16 a[44:47], v[112:115], v[56:59], a[44:47]
    s_add_u32 s100, s77, 4096
    ds_read_b128 v[96:99], v2 offset:24576
    v_cvt_pk_bf16_f32 v88, v244, v245
    v_mfma_f32_16x16x32_bf16 a[44:47], v[116:119], v[60:63], a[44:47]
    s_add_u32 m0, m0, 4096
    v_exp_f32 v246, v246
    v_mfma_f32_16x16x32_bf16 v[252:255], a[240:243], v[140:143], v[156:159]
    buffer_load_dwordx4 v1, s[36:39], s100 offen sc1 lds
    v_mfma_f32_16x16x32_bf16 v[252:255], a[244:247], v[172:175], v[252:255]
    v_exp_f32 v247, v247
    v_mfma_f32_16x16x32_bf16 v[252:255], a[248:251], v[204:207], v[252:255]
    ds_read_b128 v[100:103], v2 offset:25600
    v_cvt_pk_bf16_f32 v89, v246, v247
    v_mfma_f32_16x16x32_bf16 v[252:255], a[252:255], v[236:239], v[252:255]
    s_waitcnt lgkmcnt(4)
    buffer_load_dwordx4 v1, s[36:39], s100 offen offset:1024 sc1 lds
    v_mfma_f32_16x16x32_bf16 a[56:59], v[120:123], v[48:51], a[56:59]
    v_exp_f32 v248, v248
    v_mfma_f32_16x16x32_bf16 a[56:59], v[124:127], v[52:55], a[56:59]
    v_exp_f32 v249, v249
    v_mfma_f32_16x16x32_bf16 a[60:63], v[120:123], v[56:59], a[60:63]
    ds_read_b128 v[104:107], v2 offset:26624
    ds_read_b128 v[108:111], v2 offset:27648
    v_mfma_f32_16x16x32_bf16 a[60:63], v[124:127], v[60:63], a[60:63]
    v_exp_f32 v250, v250
    v_mfma_f32_16x16x32_bf16 v[240:243], a[224:227], v[136:139], v[184:187]
    buffer_load_dwordx4 v1, s[36:39], s100 offen offset:2048 sc1 lds
    v_mfma_f32_16x16x32_bf16 v[240:243], a[228:231], v[168:171], v[240:243]
    s_waitcnt lgkmcnt(2)
    v_exp_f32 v251, v251
    v_mfma_f32_16x16x32_bf16 v[240:243], a[232:235], v[200:203], v[240:243]
    ds_read_b128 a[240:243], v2 offset:12288
    ds_read_b128 a[244:247], v2 offset:13312
    v_mfma_f32_16x16x32_bf16 v[240:243], a[236:239], v[232:235], v[240:243]
    ds_read_b128 a[248:251], v2 offset:14336
    v_cvt_pk_bf16_f32 v82, v248, v249
    v_mfma_f32_16x16x32_bf16 a[152:155], v[96:99], v[48:51], a[152:155]
    buffer_load_dwordx4 v1, s[36:39], s100 offen offset:3072 sc1 lds
    v_mfma_f32_16x16x32_bf16 a[152:155], v[100:103], v[52:55], a[152:155]
    ds_read_b128 a[252:255], v2 offset:15360
    v_cvt_pk_bf16_f32 v83, v250, v251
    v_mfma_f32_16x16x32_bf16 a[156:159], v[96:99], v[56:59], a[156:159]
    ds_read_b128 v[112:115], v2 offset:28672
    ds_read_b128 v[116:119], v2 offset:29696
    v_mfma_f32_16x16x32_bf16 a[156:159], v[100:103], v[60:63], a[156:159]
    v_exp_f32 v252, v252
    v_mfma_f32_16x16x32_bf16 v[244:247], a[224:227], v[140:143], v[156:159]
    s_add_u32 s77, s77, 32768
    v_exp_f32 v253, v253
    v_mfma_f32_16x16x32_bf16 v[244:247], a[228:231], v[172:175], v[244:247]
    v_exp_f32 v254, v254
    v_mfma_f32_16x16x32_bf16 v[244:247], a[232:235], v[204:207], v[244:247]
    v_exp_f32 v255, v255
    v_mfma_f32_16x16x32_bf16 v[244:247], a[236:239], v[236:239], v[244:247]
    s_waitcnt lgkmcnt(3)
    v_cvt_pk_bf16_f32 v90, v252, v253
    v_cvt_pk_bf16_f32 v91, v254, v255
    v_mfma_f32_16x16x32_bf16 a[168:171], v[104:107], v[48:51], a[168:171]
    v_exp_f32 v240, v240
    v_mfma_f32_16x16x32_bf16 a[168:171], v[108:111], v[52:55], a[168:171]
    v_exp_f32 v241, v241
    v_mfma_f32_16x16x32_bf16 a[172:175], v[104:107], v[56:59], a[172:175]
    ds_read_b128 v[120:123], v2 offset:30720
    ds_read_b128 v[124:127], v2 offset:31744
    v_mfma_f32_16x16x32_bf16 a[172:175], v[108:111], v[60:63], a[172:175]
    v_add_u32 v2, s82, v1
    v_cvt_pk_bf16_f32 v84, v240, v241
    v_mfma_f32_16x16x32_bf16 v[248:251], a[240:243], v[136:139], v[188:191]
    v_exp_f32 v242, v242
    v_mfma_f32_16x16x32_bf16 v[248:251], a[244:247], v[168:171], v[248:251]
    v_exp_f32 v243, v243
    v_mfma_f32_16x16x32_bf16 v[248:251], a[248:251], v[200:203], v[248:251]
    s_waitcnt lgkmcnt(2)
    v_exp_f32 v244, v244
    v_mfma_f32_16x16x32_bf16 v[248:251], a[252:255], v[232:235], v[248:251]
    v_exp_f32 v245, v245
    v_mfma_f32_16x16x32_bf16 a[184:187], v[112:115], v[48:51], a[184:187]
    ds_read_b128 a[224:227], v2 offset:0
    ds_read_b128 a[228:231], v2 offset:1024
    v_mfma_f32_16x16x32_bf16 a[184:187], v[116:119], v[52:55], a[184:187]
    ds_read_b128 a[232:235], v2 offset:2048
    v_cvt_pk_bf16_f32 v85, v242, v243
    v_mfma_f32_16x16x32_bf16 a[188:191], v[112:115], v[56:59], a[188:191]
    ds_read_b128 a[236:239], v2 offset:3072
    v_cvt_pk_bf16_f32 v92, v244, v245
    v_mfma_f32_16x16x32_bf16 a[188:191], v[116:119], v[60:63], a[188:191]
    v_exp_f32 v246, v246
    v_mfma_f32_16x16x32_bf16 v[252:255], a[240:243], v[140:143], v[156:159]
    ds_read_b128 v[96:99], v2 offset:16384
    ds_read_b128 v[100:103], v2 offset:17408
    v_mfma_f32_16x16x32_bf16 v[252:255], a[244:247], v[172:175], v[252:255]
    v_exp_f32 v247, v247
    v_mfma_f32_16x16x32_bf16 v[252:255], a[248:251], v[204:207], v[252:255]
    v_exp_f32 v248, v248
    v_mfma_f32_16x16x32_bf16 v[252:255], a[252:255], v[236:239], v[252:255]
    s_waitcnt lgkmcnt(4)
    v_exp_f32 v249, v249
    v_mfma_f32_16x16x32_bf16 a[200:203], v[120:123], v[48:51], a[200:203]
    v_exp_f32 v250, v250
    v_mfma_f32_16x16x32_bf16 a[200:203], v[124:127], v[52:55], a[200:203]
    v_exp_f32 v251, v251
    v_mfma_f32_16x16x32_bf16 a[204:207], v[120:123], v[56:59], a[204:207]
    v_cvt_pk_bf16_f32 v93, v246, v247
    v_cvt_pk_bf16_f32 v86, v248, v249
    v_mfma_f32_16x16x32_bf16 a[204:207], v[124:127], v[60:63], a[204:207]
    v_exp_f32 v252, v252
    v_smfmac_f32_16x16x64_bf16 a[216:219], a[136:139], v[48:55], v215
    s_cmp_le_u32 s78, 2
    v_cvt_pk_bf16_f32 v87, v250, v251
    v_smfmac_f32_16x16x64_bf16 a[220:223], a[136:139], v[56:63], v215
    s_cbranch_scc1 K1_LS_MASK
K1_LS_BACK:
    s_waitcnt lgkmcnt(0)
    v_mfma_f32_16x16x32_bf16 v[240:243], a[224:227], v[136:139], v[176:179]
    s_mov_b32 s99, s76
    ds_read_b128 v[104:107], v2 offset:18432
    ds_read_b128 v[108:111], v2 offset:19456
    v_mfma_f32_16x16x32_bf16 v[240:243], a[228:231], v[168:171], v[240:243]
    v_exp_f32 v253, v253
    v_mfma_f32_16x16x32_bf16 v[240:243], a[232:235], v[200:203], v[240:243]
    v_exp_f32 v254, v254
    v_mfma_f32_16x16x32_bf16 v[240:243], a[236:239], v[232:235], v[240:243]
    v_exp_f32 v255, v255
    v_mfma_f32_16x16x32_bf16 a[8:11], v[96:99], v[80:83], a[8:11]
    s_add_u32 m0, s76, s75
    v_cvt_pk_bf16_f32 v94, v252, v253
    v_cvt_pk_bf16_f32 v95, v254, v255
    v_mfma_f32_16x16x32_bf16 a[8:11], v[100:103], v[84:87], a[8:11]
    s_mov_b32 s76, s60
    ds_read_b128 a[240:243], v2 offset:4096
    ds_read_b128 a[244:247], v2 offset:5120
    v_mfma_f32_16x16x32_bf16 a[12:15], v[96:99], v[88:91], a[12:15]
    s_mov_b32 s60, s82
    buffer_load_dwordx4 v1, s[36:39], s77 offen sc1 lds
    v_mfma_f32_16x16x32_bf16 a[12:15], v[100:103], v[92:95], a[12:15]
    s_mov_b32 s82, s95
    ds_read_b128 a[248:251], v2 offset:6144
    ds_read_b128 a[252:255], v2 offset:7168
    v_mfma_f32_16x16x32_bf16 v[244:247], a[224:227], v[140:143], v[156:159]
    s_mov_b32 s95, s93
    v_exp_f32 v240, v240
    v_mfma_f32_16x16x32_bf16 v[244:247], a[228:231], v[172:175], v[244:247]
    s_mov_b32 s93, s99
    ds_read_b128 v[112:115], v2 offset:20480
    ds_read_b128 v[116:119], v2 offset:21504
    v_mfma_f32_16x16x32_bf16 v[244:247], a[232:235], v[204:207], v[244:247]
    buffer_load_dwordx4 v1, s[36:39], s77 offen offset:1024 sc1 lds
    v_mfma_f32_16x16x32_bf16 v[244:247], a[236:239], v[236:239], v[244:247]
    s_waitcnt lgkmcnt(6)
    v_exp_f32 v241, v241
    v_mfma_f32_16x16x32_bf16 a[24:27], v[104:107], v[80:83], a[24:27]
    v_exp_f32 v242, v242
    v_mfma_f32_16x16x32_bf16 a[24:27], v[108:111], v[84:87], a[24:27]
    v_exp_f32 v243, v243
    v_mfma_f32_16x16x32_bf16 a[28:31], v[104:107], v[88:91], a[28:31]
    buffer_load_dwordx4 v1, s[36:39], s77 offen offset:2048 sc1 lds
    v_mfma_f32_16x16x32_bf16 a[28:31], v[108:111], v[92:95], a[28:31]
    s_waitcnt lgkmcnt(2)
    ds_read_b128 v[120:123], v2 offset:22528
    ds_read_b128 v[124:127], v2 offset:23552
    v_mfma_f32_16x16x32_bf16 v[248:251], a[240:243], v[136:139], v[180:183]
    v_cvt_pk_bf16_f32 v48, v240, v241
    v_cvt_pk_bf16_f32 v49, v242, v243
    v_mfma_f32_16x16x32_bf16 v[248:251], a[244:247], v[168:171], v[248:251]
    v_exp_f32 v244, v244
    v_mfma_f32_16x16x32_bf16 v[248:251], a[248:251], v[200:203], v[248:251]
    buffer_load_dwordx4 v1, s[36:39], s77 offen offset:3072 sc1 lds
    v_mfma_f32_16x16x32_bf16 v[248:251], a[252:255], v[232:235], v[248:251]
    s_waitcnt lgkmcnt(2)
    ds_read_b128 a[224:227], v2 offset:8192
    ds_read_b128 a[228:231], v2 offset:9216
    v_mfma_f32_16x16x32_bf16 a[40:43], v[112:115], v[80:83], a[40:43]
    v_exp_f32 v245, v245
    v_mfma_f32_16x16x32_bf16 a[40:43], v[116:119], v[84:87], a[40:43]
    ds_read_b128 a[232:235], v2 offset:10240
    ds_read_b128 a[236:239], v2 offset:11264
    v_mfma_f32_16x16x32_bf16 a[44:47], v[112:115], v[88:91], a[44:47]
    s_add_u32 s100, s77, 4096
    ds_read_b128 v[96:99], v2 offset:24576
    v_cvt_pk_bf16_f32 v56, v244, v245
    v_mfma_f32_16x16x32_bf16 a[44:47], v[116:119], v[92:95], a[44:47]
    s_add_u32 m0, m0, 4096
    v_exp_f32 v246, v246
    v_mfma_f32_16x16x32_bf16 v[252:255], a[240:243], v[140:143], v[156:159]
    buffer_load_dwordx4 v1, s[36:39], s100 offen sc1 lds
    v_mfma_f32_16x16x32_bf16 v[252:255], a[244:247], v[172:175], v[252:255]
    v_exp_f32 v247, v247
    v_mfma_f32_16x16x32_bf16 v[252:255], a[248:251], v[204:207], v[252:255]
    ds_read_b128 v[100:103], v2 offset:25600
    v_cvt_pk_bf16_f32 v57, v246, v247
    v_mfma_f32_16x16x32_bf16 v[252:255], a[252:255], v[236:239], v[252:255]
    s_waitcnt lgkmcnt(4)
    buffer_load_dwordx4 v1, s[36:39], s100 offen offset:1024 sc1 lds
    v_mfma_f32_16x16x32_bf16 a[56:59], v[120:123], v[80:83], a[56:59]
    v_exp_f32 v248, v248
    v_mfma_f32_16x16x32_bf16 a[56:59], v[124:127], v[84:87], a[56:59]
    v_exp_f32 v249, v249
    v_mfma_f32_16x16x32_bf16 a[60:63], v[120:123], v[88:91], a[60:63]
    ds_read_b128 v[104:107], v2 offset:26624
    ds_read_b128 v[108:111], v2 offset:27648
    v_mfma_f32_16x16x32_bf16 a[60:63], v[124:127], v[92:95], a[60:63]
    v_exp_f32 v250, v250
    v_mfma_f32_16x16x32_bf16 v[240:243], a[224:227], v[136:139], v[184:187]
    buffer_load_dwordx4 v1, s[36:39], s100 offen offset:2048 sc1 lds
    v_mfma_f32_16x16x32_bf16 v[240:243], a[228:231], v[168:171], v[240:243]
    s_waitcnt lgkmcnt(2)
    v_exp_f32 v251, v251
    v_mfma_f32_16x16x32_bf16 v[240:243], a[232:235], v[200:203], v[240:243]
    ds_read_b128 a[240:243], v2 offset:12288
    ds_read_b128 a[244:247], v2 offset:13312
    v_mfma_f32_16x16x32_bf16 v[240:243], a[236:239], v[232:235], v[240:243]
    ds_read_b128 a[248:251], v2 offset:14336
    v_cvt_pk_bf16_f32 v50, v248, v249
    v_mfma_f32_16x16x32_bf16 a[152:155], v[96:99], v[80:83], a[152:155]
    buffer_load_dwordx4 v1, s[36:39], s100 offen offset:3072 sc1 lds
    v_mfma_f32_16x16x32_bf16 a[152:155], v[100:103], v[84:87], a[152:155]
    ds_read_b128 a[252:255], v2 offset:15360
    v_cvt_pk_bf16_f32 v51, v250, v251
    v_mfma_f32_16x16x32_bf16 a[156:159], v[96:99], v[88:91], a[156:159]
    ds_read_b128 v[112:115], v2 offset:28672
    ds_read_b128 v[116:119], v2 offset:29696
    v_mfma_f32_16x16x32_bf16 a[156:159], v[100:103], v[92:95], a[156:159]
    v_exp_f32 v252, v252
    v_mfma_f32_16x16x32_bf16 v[244:247], a[224:227], v[140:143], v[156:159]
    s_add_u32 s77, s77, 32768
    v_exp_f32 v253, v253
    v_mfma_f32_16x16x32_bf16 v[244:247], a[228:231], v[172:175], v[244:247]
    ds_read_b128 v[120:123], v2 offset:30720
    ds_read_b128 v[124:127], v2 offset:31744
    v_mfma_f32_16x16x32_bf16 v[244:247], a[232:235], v[204:207], v[244:247]
    v_add_u32 v2, s82, v1
    v_cvt_pk_bf16_f32 v58, v252, v253
    v_mfma_f32_16x16x32_bf16 v[244:247], a[236:239], v[236:239], v[244:247]
    s_waitcnt lgkmcnt(5)
    v_exp_f32 v254, v254
    v_mfma_f32_16x16x32_bf16 a[168:171], v[104:107], v[80:83], a[168:171]
    v_exp_f32 v255, v255
    v_mfma_f32_16x16x32_bf16 a[168:171], v[108:111], v[84:87], a[168:171]
    v_exp_f32 v240, v240
    v_mfma_f32_16x16x32_bf16 a[172:175], v[104:107], v[88:91], a[172:175]
    v_exp_f32 v241, v241
    v_mfma_f32_16x16x32_bf16 a[172:175], v[108:111], v[92:95], a[172:175]
    v_cvt_pk_bf16_f32 v59, v254, v255
    v_cvt_pk_bf16_f32 v52, v240, v241
    v_mfma_f32_16x16x32_bf16 v[248:251], a[240:243], v[136:139], v[188:191]
    v_exp_f32 v242, v242
    v_mfma_f32_16x16x32_bf16 v[248:251], a[244:247], v[168:171], v[248:251]
    v_exp_f32 v243, v243
    v_mfma_f32_16x16x32_bf16 v[248:251], a[248:251], v[200:203], v[248:251]
    s_waitcnt lgkmcnt(0)
    v_exp_f32 v244, v244
    v_mfma_f32_16x16x32_bf16 v[248:251], a[252:255], v[232:235], v[248:251]
    v_exp_f32 v245, v245
    v_mfma_f32_16x16x32_bf16 a[184:187], v[112:115], v[80:83], a[184:187]
    s_waitcnt vmcnt(8) lgkmcnt(0)
    v_exp_f32 v246, v246
    v_mfma_f32_16x16x32_bf16 a[184:187], v[116:119], v[84:87], a[184:187]
    s_barrier
    ds_read_b128 a[224:227], v2 offset:0
    ds_read_b128 a[228:231], v2 offset:1024
    v_mfma_f32_16x16x32_bf16 a[188:191], v[112:115], v[88:91], a[188:191]
    ds_read_b128 a[232:235], v2 offset:2048
    v_cvt_pk_bf16_f32 v53, v242, v243
    v_mfma_f32_16x16x32_bf16 a[188:191], v[116:119], v[92:95], a[188:191]
    ds_read_b128 a[236:239], v2 offset:3072
    v_cvt_pk_bf16_f32 v60, v244, v245
    v_mfma_f32_16x16x32_bf16 v[252:255], a[240:243], v[140:143], v[156:159]
    v_exp_f32 v247, v247
    v_mfma_f32_16x16x32_bf16 v[252:255], a[244:247], v[172:175], v[252:255]
    ds_read_b128 v[96:99], v2 offset:16384
    ds_read_b128 v[100:103], v2 offset:17408
    v_mfma_f32_16x16x32_bf16 v[252:255], a[248:251], v[204:207], v[252:255]
    v_exp_f32 v248, v248
    v_mfma_f32_16x16x32_bf16 v[252:255], a[252:255], v[236:239], v[252:255]
    v_exp_f32 v249, v249
    v_mfma_f32_16x16x32_bf16 a[200:203], v[120:123], v[80:83], a[200:203]
    v_exp_f32 v250, v250
    v_mfma_f32_16x16x32_bf16 a[200:203], v[124:127], v[84:87], a[200:203]
    v_exp_f32 v251, v251
    v_mfma_f32_16x16x32_bf16 a[204:207], v[120:123], v[88:91], a[204:207]
    v_cvt_pk_bf16_f32 v61, v246, v247
    v_cvt_pk_bf16_f32 v54, v248, v249
    v_mfma_f32_16x16x32_bf16 a[204:207], v[124:127], v[92:95], a[204:207]
    s_sub_u32 s78, s78, 1
    v_exp_f32 v252, v252
    v_smfmac_f32_16x16x64_bf16 a[216:219], a[136:139], v[80:87], v215
    s_cmp_lg_u32 s78, 0
    v_cvt_pk_bf16_f32 v55, v250, v251
    v_smfmac_f32_16x16x64_bf16 a[220:223], a[136:139], v[88:95], v215
    s_cbranch_scc1 K1_LS
K1_LS_END:
    v_add_f32 v212, s12, v156
    v_fma_f32 v176, v208, s8, v212
    v_fma_f32 v177, v209, s8, v212
    v_fma_f32 v178, v210, s8, v212
    v_fma_f32 v179, v211, s8, v212
    s_nop 1
    s_waitcnt lgkmcnt(0)
    v_mfma_f32_16x16x32_bf16 v[240:243], a[224:227], v[140:143], v[176:179]
    s_xor_b32 s21, s3, 1
    ds_read_b128 v[104:107], v2 offset:18432
    s_lshl2_add_u32 s21, s21, s4
    v_mfma_f32_16x16x32_bf16 v[240:243], a[228:231], v[172:175], v[240:243]
    s_mul_i32 s21, s21, 36864
    ds_read_b128 v[108:111], v2 offset:19456
    ds_read_b128 a[240:243], v2 offset:4096
    v_mfma_f32_16x16x32_bf16 v[240:243], a[232:235], v[204:207], v[240:243]
    s_add_u32 s21, s21, s28
    s_mov_b32 m0, s45
    ds_read_b128 a[244:247], v2 offset:5120
    v_mfma_f32_16x16x32_bf16 v[240:243], a[236:239], v[236:239], v[240:243]
    s_mul_i32 s86, s4, 34
    buffer_load_dwordx4 v1, s[56:59], s21 offen sc1 lds
    v_mfma_f32_16x16x32_bf16 a[8:11], v[96:99], v[48:51], a[8:11]
    s_add_u32 s86, s86, 8
    v_exp_f32 v253, v253
    v_mfma_f32_16x16x32_bf16 a[8:11], v[100:103], v[52:55], a[8:11]
    s_mov_b32 s99, s76
    v_exp_f32 v254, v254
    v_mfma_f32_16x16x32_bf16 a[12:15], v[96:99], v[56:59], a[12:15]
    s_mov_b32 s76, s60
    v_exp_f32 v255, v255
    v_cvt_pk_bf16_f32 v62, v252, v253
    v_cvt_pk_bf16_f32 v63, v254, v255
    s_nop 1
    v_mfma_f32_16x16x32_bf16 a[12:15], v[100:103], v[60:63], a[12:15]
    s_mov_b32 s60, s82
    ds_read_b128 a[248:251], v2 offset:6144
    ds_read_b128 a[252:255], v2 offset:7168
    s_waitcnt lgkmcnt(2)
    v_mfma_f32_16x16x32_bf16 a[24:27], v[104:107], v[48:51], a[24:27]
    s_mov_b32 s82, s95
    v_lshrrev_b32 v28, 4, v1
    ds_read_b128 v[112:115], v2 offset:20480
    v_mfma_f32_16x16x32_bf16 a[24:27], v[108:111], v[52:55], a[24:27]
    s_mov_b32 s95, s93
    v_min_u32 v28, 33, v28
    ds_read_b128 v[116:119], v2 offset:21504
    v_mfma_f32_16x16x32_bf16 a[28:31], v[104:107], v[56:59], a[28:31]
    s_mov_b32 s93, s99
    buffer_load_dwordx4 v1, s[56:59], s21 offen offset:1024 sc1 lds
    v_mfma_f32_16x16x32_bf16 a[28:31], v[108:111], v[60:63], a[28:31]
    s_and_b32 s62, s5, 4
    v_add_lshl_u32 v28, v28, s86, 7
    v_add_f32 v213, s13, v156
    v_fma_f32 v180, v208, s9, v213
    v_fma_f32 v181, v209, s9, v213
    v_fma_f32 v182, v210, s9, v213
    v_fma_f32 v183, v211, s9, v213
    s_nop 1
    v_mfma_f32_16x16x32_bf16 v[244:247], a[240:243], v[140:143], v[180:183]
    s_getpc_b64 s[86:87]
    global_load_dword v28, v28, s[86:87]
    v_mfma_f32_16x16x32_bf16 v[244:247], a[244:247], v[172:175], v[244:247]
    s_lshl_b32 s63, s3, 12
    ds_read_b128 v[120:123], v2 offset:22528
    ds_read_b128 v[124:127], v2 offset:23552
    s_waitcnt lgkmcnt(3)
    v_mfma_f32_16x16x32_bf16 v[244:247], a[248:251], v[204:207], v[244:247]
    s_sub_u32 s19, s74, s101
    buffer_load_dwordx4 v1, s[56:59], s21 offen offset:2048 sc1 lds
    v_mfma_f32_16x16x32_bf16 v[244:247], a[252:255], v[236:239], v[244:247]
    s_add_u32 s62, s62, s4
    ds_read_b128 a[224:227], v2 offset:8192
    ds_read_b128 a[228:231], v2 offset:9216
    v_mfma_f32_16x16x32_bf16 a[40:43], v[112:115], v[48:51], a[40:43]
    s_mov_b32 s20, s63
    ds_read_b128 a[232:235], v2 offset:10240
    v_add_f32 v212, s14, v156
    s_waitcnt lgkmcnt(5)
    v_mfma_f32_16x16x32_bf16 a[40:43], v[116:119], v[52:55], a[40:43]
    s_add_u32 s19, s66, s19
    ds_read_b128 a[236:239], v2 offset:11264
    v_fma_f32 v184, v208, s10, v212
    v_mfma_f32_16x16x32_bf16 a[44:47], v[112:115], v[56:59], a[44:47]
    s_mov_b32 s50, 9437184
    ds_read_b128 v[96:99], v2 offset:24576
    v_fma_f32 v185, v209, s10, v212
    v_mfma_f32_16x16x32_bf16 a[44:47], v[116:119], v[60:63], a[44:47]
    s_waitcnt lgkmcnt(5)
    ds_read_b128 v[100:103], v2 offset:25600
    v_fma_f32 v186, v210, s10, v212
    v_mfma_f32_16x16x32_bf16 a[56:59], v[120:123], v[48:51], a[56:59]
    buffer_load_dwordx4 v1, s[56:59], s21 offen offset:3072 sc1 lds
    v_mfma_f32_16x16x32_bf16 a[56:59], v[124:127], v[52:55], a[56:59]
    s_add_u32 s21, s21, 4096
    v_fma_f32 v187, v211, s10, v212
    ds_read_b128 v[104:107], v2 offset:26624
    v_mfma_f32_16x16x32_bf16 a[60:63], v[120:123], v[56:59], a[60:63]
    s_add_u32 m0, s45, 4096
    ds_read_b128 v[108:111], v2 offset:27648
    ds_read_b128 a[240:243], v2 offset:12288
    v_mfma_f32_16x16x32_bf16 a[60:63], v[124:127], v[60:63], a[60:63]
    s_waitcnt lgkmcnt(4)
    ds_read_b128 a[244:247], v2 offset:13312
    v_add_f32 v213, s15, v156
    v_mfma_f32_16x16x32_bf16 v[248:251], a[224:227], v[140:143], v[184:187]
    ds_read_b128 a[248:251], v2 offset:14336
    v_fma_f32 v188, v208, s11, v213
    v_mfma_f32_16x16x32_bf16 v[248:251], a[228:231], v[172:175], v[248:251]
    ds_read_b128 a[252:255], v2 offset:15360
    v_fma_f32 v189, v209, s11, v213
    v_mfma_f32_16x16x32_bf16 v[248:251], a[232:235], v[204:207], v[248:251]
    buffer_load_dwordx4 v1, s[56:59], s21 offen sc1 lds
    v_mfma_f32_16x16x32_bf16 v[248:251], a[236:239], v[236:239], v[248:251]
    ds_read_b128 v[112:115], v2 offset:28672
    ds_read_b128 v[116:119], v2 offset:29696
    v_mfma_f32_16x16x32_bf16 a[152:155], v[96:99], v[48:51], a[152:155]
    s_waitcnt lgkmcnt(4)
    v_fma_f32 v190, v210, s11, v213
    v_fma_f32 v191, v211, s11, v213
    v_mfma_f32_16x16x32_bf16 a[152:155], v[100:103], v[52:55], a[152:155]
    ds_read_b128 v[120:123], v2 offset:30720
    ds_read_b128 v[124:127], v2 offset:31744
    v_mfma_f32_16x16x32_bf16 a[156:159], v[96:99], v[56:59], a[156:159]
    v_add_u32 v2, s82, v1
    ds_read_b128 v[96:99], v2 offset:16384
    v_mfma_f32_16x16x32_bf16 a[156:159], v[100:103], v[60:63], a[156:159]
    ds_read_b128 v[100:103], v2 offset:17408
    v_bfe_u32 v217, v1, 4, 3
    v_mfma_f32_16x16x32_bf16 a[168:171], v[104:107], v[48:51], a[168:171]
    buffer_load_dwordx4 v1, s[56:59], s21 offen offset:1024 sc1 lds
    v_mfma_f32_16x16x32_bf16 a[168:171], v[108:111], v[52:55], a[168:171]
    v_exp_f32 v240, v240
    v_mfma_f32_16x16x32_bf16 a[172:175], v[104:107], v[56:59], a[172:175]
    ds_read_b128 v[104:107], v2 offset:18432
    v_lshlrev_b32 v217, 7, v217
    v_mfma_f32_16x16x32_bf16 a[172:175], v[108:111], v[60:63], a[172:175]
    v_exp_f32 v241, v241
    v_mfma_f32_16x16x32_bf16 v[252:255], a[240:243], v[140:143], v[188:191]
    ds_read_b128 v[108:111], v2 offset:19456
    v_cvt_pk_bf16_f32 v88, v240, v241
    v_mfma_f32_16x16x32_bf16 v[252:255], a[244:247], v[172:175], v[252:255]
    s_waitcnt lgkmcnt(2)
    v_exp_f32 v242, v242
    v_mfma_f32_16x16x32_bf16 v[252:255], a[248:251], v[204:207], v[252:255]
    buffer_load_dwordx4 v1, s[56:59], s21 offen offset:2048 sc1 lds
    v_mfma_f32_16x16x32_bf16 v[252:255], a[252:255], v[236:239], v[252:255]
    v_exp_f32 v243, v243
    v_mfma_f32_16x16x32_bf16 a[184:187], v[112:115], v[48:51], a[184:187]
    v_exp_f32 v244, v244
    v_mfma_f32_16x16x32_bf16 a[184:187], v[116:119], v[52:55], a[184:187]
    v_exp_f32 v245, v245
    v_mfma_f32_16x16x32_bf16 a[188:191], v[112:115], v[56:59], a[188:191]
    ds_read_b128 v[112:115], v2 offset:20480
    v_cvt_pk_bf16_f32 v89, v242, v243
    v_mfma_f32_16x16x32_bf16 a[188:191], v[116:119], v[60:63], a[188:191]
    v_exp_f32 v246, v246
    v_mfma_f32_16x16x32_bf16 a[200:203], v[120:123], v[48:51], a[200:203]
    v_exp_f32 v247, v247
    v_mfma_f32_16x16x32_bf16 a[200:203], v[124:127], v[52:55], a[200:203]
    v_exp_f32 v248, v248
    v_mfma_f32_16x16x32_bf16 a[204:207], v[120:123], v[56:59], a[204:207]
    v_exp_f32 v249, v249
    v_mfma_f32_16x16x32_bf16 a[204:207], v[124:127], v[60:63], a[204:207]
    v_exp_f32 v250, v250
    v_smfmac_f32_16x16x64_bf16 a[216:219], a[136:139], v[48:55], v215
    s_add_u32 s48, s32, 1048576
    s_addc_u32 s49, s33, 0
    ds_read_b128 v[116:119], v2 offset:21504
    v_smfmac_f32_16x16x64_bf16 a[220:223], a[136:139], v[56:63], v215
    v_exp_f32 v251, v251
    v_cvt_pk_bf16_f32 v90, v244, v245
    v_cvt_pk_bf16_f32 v91, v246, v247
    v_cvt_pk_bf16_f32 v92, v248, v249
    v_cvt_pk_bf16_f32 v93, v250, v251
    v_exp_f32 v252, v252
    s_cmp_eq_u32 s6, 7
    s_cbranch_scc1 K1_S7
K1_S7_BACK:
    s_waitcnt lgkmcnt(0)
    v_mfma_f32_16x16x32_bf16 a[12:15], v[96:99], v[88:91], a[12:15]
    ds_read_b128 v[120:123], v2 offset:22528
    v_exp_f32 v253, v253
    v_exp_f32 v254, v254
    v_exp_f32 v255, v255
    v_cvt_pk_bf16_f32 v94, v252, v253
    v_cvt_pk_bf16_f32 v95, v254, v255
    s_nop 1
    v_mfma_f32_16x16x32_bf16 a[12:15], v[100:103], v[92:95], a[12:15]
    ds_read_b128 v[124:127], v2 offset:23552
    ds_read_b128 v[96:99], v2 offset:24576
    v_accvgpr_read_b32 v12, a8
    v_accvgpr_read_b32 v13, a9
    v_accvgpr_read_b32 v14, a10
    v_mfma_f32_16x16x32_bf16 a[28:31], v[104:107], v[88:91], a[28:31]
    ds_read_b128 v[100:103], v2 offset:25600
    v_accvgpr_read_b32 v9, a216
    v_accvgpr_read_b32 v10, a217
    v_add_f32 v9, v9, v10
    v_accvgpr_read_b32 v15, a11
    v_mfma_f32_16x16x32_bf16 a[28:31], v[108:111], v[92:95], a[28:31]
    ds_read_b128 v[104:107], v2 offset:26624
    v_rcp_f32 v10, v9
    v_accvgpr_read_b32 v16, a24
    v_mul_f32 v10, v10, v6
    v_mfma_f32_16x16x32_bf16 a[44:47], v[112:115], v[88:91], a[44:47]
    ds_read_b128 v[108:111], v2 offset:27648
    v_accvgpr_read_b32 v17, a25
    v_accvgpr_read_b32 v18, a26
    v_accvgpr_read_b32 v19, a27
    v_accvgpr_read_b32 v20, a40
    v_mfma_f32_16x16x32_bf16 a[44:47], v[116:119], v[92:95], a[44:47]
    s_waitcnt lgkmcnt(5)
    ds_read_b128 v[112:115], v2 offset:28672
    v_accvgpr_read_b32 v21, a41
    v_accvgpr_read_b32 v22, a42
    v_accvgpr_read_b32 v23, a43
    v_accvgpr_read_b32 v24, a56
    v_mfma_f32_16x16x32_bf16 a[60:63], v[120:123], v[88:91], a[60:63]
    s_waitcnt lgkmcnt(3)
    ds_read_b128 v[116:119], v2 offset:29696
    v_accvgpr_read_b32 v25, a57
    v_accvgpr_read_b32 v26, a58
    v_accvgpr_read_b32 v27, a59
    v_mul_f32 v12, v10, v12
    v_mfma_f32_16x16x32_bf16 a[60:63], v[124:127], v[92:95], a[60:63]
    ds_read_b128 v[120:123], v2 offset:30720
    v_mul_f32 v13, v10, v13
    v_mul_f32 v14, v10, v14
    v_mul_f32 v15, v10, v15
    v_mul_f32 v16, v10, v16
    v_mfma_f32_16x16x32_bf16 a[156:159], v[96:99], v[88:91], a[156:159]
    ds_read_b128 v[124:127], v2 offset:31744
    v_mul_f32 v17, v10, v17
    v_mul_f32 v18, v10, v18
    v_mul_f32 v19, v10, v19
    v_mul_f32 v20, v10, v20
    v_mfma_f32_16x16x32_bf16 a[156:159], v[100:103], v[92:95], a[156:159]
    s_waitcnt lgkmcnt(3)
    v_mul_f32 v21, v10, v21
    v_mul_f32 v22, v10, v22
    v_mul_f32 v23, v10, v23
    v_mul_f32 v24, v10, v24
    v_mul_f32 v25, v10, v25
    v_mfma_f32_16x16x32_bf16 a[172:175], v[104:107], v[88:91], a[172:175]
    v_mul_f32 v26, v10, v26
    v_mul_f32 v27, v10, v27
    v_cvt_pk_bf16_f32 v12, v12, v13
    v_cvt_pk_bf16_f32 v13, v14, v15
    v_cvt_pk_bf16_f32 v14, v16, v17
    v_mfma_f32_16x16x32_bf16 a[172:175], v[108:111], v[92:95], a[172:175]
    v_cvt_pk_bf16_f32 v15, v18, v19
    v_cvt_pk_bf16_f32 v20, v20, v21
    v_cvt_pk_bf16_f32 v21, v22, v23
    v_cvt_pk_bf16_f32 v22, v24, v25
    v_cvt_pk_bf16_f32 v23, v26, v27
    v_mfma_f32_16x16x32_bf16 a[188:191], v[112:115], v[88:91], a[188:191]
    s_waitcnt lgkmcnt(1)
    buffer_store_dwordx4 v[12:15], v1, s[40:43], s81 offen offset:0 sc1
    buffer_store_dwordx4 v[20:23], v1, s[40:43], s81 offen offset:1024 sc1
    v_accvgpr_read_b32 v16, a168
    v_mfma_f32_16x16x32_bf16 a[188:191], v[116:119], v[92:95], a[188:191]
    v_accvgpr_read_b32 v12, a152
    v_accvgpr_read_b32 v13, a153
    v_accvgpr_read_b32 v14, a154
    v_accvgpr_read_b32 v15, a155
    v_accvgpr_read_b32 v17, a169
    v_mfma_f32_16x16x32_bf16 a[204:207], v[120:123], v[88:91], a[204:207]
    s_waitcnt lgkmcnt(0)
    v_accvgpr_read_b32 v18, a170
    v_accvgpr_read_b32 v19, a171
    v_accvgpr_read_b32 v20, a184
    v_accvgpr_read_b32 v21, a185
    v_accvgpr_read_b32 v22, a186
    v_mfma_f32_16x16x32_bf16 a[204:207], v[124:127], v[92:95], a[204:207]
    v_accvgpr_read_b32 v23, a187
    v_accvgpr_read_b32 v24, a200
    v_accvgpr_read_b32 v25, a201
    v_accvgpr_read_b32 v26, a202
    v_accvgpr_read_b32 v27, a203
    v_smfmac_f32_16x16x64_bf16 a[220:223], a[136:139], v[88:95], v215
    v_mul_f32 v12, v10, v12
    v_mul_f32 v13, v10, v13
    v_mul_f32 v14, v10, v14
    v_mul_f32 v15, v10, v15
    v_mul_f32 v16, v10, v16
    v_mul_f32 v17, v10, v17
    v_mul_f32 v18, v10, v18
    v_mul_f32 v19, v10, v19
    v_mul_f32 v20, v10, v20
    v_mul_f32 v21, v10, v21
    v_mul_f32 v22, v10, v22
    v_mul_f32 v23, v10, v23
    v_mul_f32 v24, v10, v24
    v_mul_f32 v25, v10, v25
    v_mul_f32 v26, v10, v26
    v_mul_f32 v27, v10, v27
    v_cmp_nge_f32 vcc, 0x71800000, v9
    v_cvt_pk_bf16_f32 v12, v12, v13
    v_cvt_pk_bf16_f32 v13, v14, v15
    v_cvt_pk_bf16_f32 v14, v16, v17
    v_cvt_pk_bf16_f32 v15, v18, v19
    v_cvt_pk_bf16_f32 v20, v20, v21
    v_cvt_pk_bf16_f32 v21, v22, v23
    v_cvt_pk_bf16_f32 v22, v24, v25
    v_cvt_pk_bf16_f32 v23, v26, v27
    s_or_b64 s[84:85], s[84:85], vcc
    buffer_store_dwordx4 v[12:15], v1, s[40:43], s81 offen offset:2048 sc1
    buffer_store_dwordx4 v[20:23], v1, s[40:43], s81 offen offset:3072 sc1
    s_nop 3
    v_accvgpr_read_b32 v9, a220
    v_accvgpr_read_b32 v10, a221
    v_add_f32 v9, v9, v10
    v_cmp_nge_f32 vcc, 0x71800000, v9
    v_rcp_f32 v10, v9
    s_nop 0
    s_or_b64 s[84:85], s[84:85], vcc
    v_mul_f32 v10, v10, v7
    s_add_u32 s72, s81, 622592
    v_accvgpr_read_b32 v12, a12
    v_accvgpr_read_b32 v13, a13
    v_accvgpr_read_b32 v14, a14
    v_accvgpr_read_b32 v15, a15
    v_accvgpr_read_b32 v16, a28
    v_accvgpr_read_b32 v17, a29
    v_accvgpr_read_b32 v18, a30
    v_accvgpr_read_b32 v19, a31
    v_pk_mul_f32 v[12:13], v[12:13], v[10:11] op_sel_hi:[1,0]
    v_pk_mul_f32 v[14:15], v[14:15], v[10:11] op_sel_hi:[1,0]
    v_pk_mul_f32 v[16:17], v[16:17], v[10:11] op_sel_hi:[1,0]
    v_pk_mul_f32 v[18:19], v[18:19], v[10:11] op_sel_hi:[1,0]
    v_cvt_pk_bf16_f32 v12, v12, v13
    v_cvt_pk_bf16_f32 v13, v14, v15
    v_cvt_pk_bf16_f32 v14, v16, v17
    v_cvt_pk_bf16_f32 v15, v18, v19
    buffer_store_dwordx4 v[12:15], v1, s[40:43], s72 offen offset:0 sc1
    v_accvgpr_read_b32 v20, a44
    v_accvgpr_read_b32 v21, a45
    v_accvgpr_read_b32 v22, a46
    v_accvgpr_read_b32 v23, a47
    v_accvgpr_read_b32 v24, a60
    v_accvgpr_read_b32 v25, a61
    v_accvgpr_read_b32 v26, a62
    v_accvgpr_read_b32 v27, a63
    v_pk_mul_f32 v[20:21], v[20:21], v[10:11] op_sel_hi:[1,0]
    v_pk_mul_f32 v[22:23], v[22:23], v[10:11] op_sel_hi:[1,0]
    v_pk_mul_f32 v[24:25], v[24:25], v[10:11] op_sel_hi:[1,0]
    v_pk_mul_f32 v[26:27], v[26:27], v[10:11] op_sel_hi:[1,0]
    v_cvt_pk_bf16_f32 v20, v20, v21
    v_cvt_pk_bf16_f32 v21, v22, v23
    v_cvt_pk_bf16_f32 v22, v24, v25
    v_cvt_pk_bf16_f32 v23, v26, v27
    buffer_store_dwordx4 v[20:23], v1, s[40:43], s72 offen offset:1024 sc1
    v_accvgpr_read_b32 v12, a156
    v_accvgpr_read_b32 v13, a157
    v_accvgpr_read_b32 v14, a158
    v_accvgpr_read_b32 v15, a159
    v_accvgpr_read_b32 v16, a172
    v_accvgpr_read_b32 v17, a173
    v_accvgpr_read_b32 v18, a174
    v_accvgpr_read_b32 v19, a175
    v_pk_mul_f32 v[12:13], v[12:13], v[10:11] op_sel_hi:[1,0]
    v_pk_mul_f32 v[14:15], v[14:15], v[10:11] op_sel_hi:[1,0]
    v_pk_mul_f32 v[16:17], v[16:17], v[10:11] op_sel_hi:[1,0]
    v_pk_mul_f32 v[18:19], v[18:19], v[10:11] op_sel_hi:[1,0]
    v_cvt_pk_bf16_f32 v12, v12, v13
    v_cvt_pk_bf16_f32 v13, v14, v15
    v_cvt_pk_bf16_f32 v14, v16, v17
    v_cvt_pk_bf16_f32 v15, v18, v19
    buffer_store_dwordx4 v[12:15], v1, s[40:43], s72 offen offset:2048 sc1
    v_accvgpr_read_b32 v20, a188
    v_accvgpr_read_b32 v21, a189
    v_accvgpr_read_b32 v22, a190
    v_accvgpr_read_b32 v23, a191
    v_accvgpr_read_b32 v24, a204
    v_accvgpr_read_b32 v25, a205
    v_accvgpr_read_b32 v26, a206
    v_accvgpr_read_b32 v27, a207
    v_pk_mul_f32 v[20:21], v[20:21], v[10:11] op_sel_hi:[1,0]
    v_pk_mul_f32 v[22:23], v[22:23], v[10:11] op_sel_hi:[1,0]
    v_pk_mul_f32 v[24:25], v[24:25], v[10:11] op_sel_hi:[1,0]
    v_pk_mul_f32 v[26:27], v[26:27], v[10:11] op_sel_hi:[1,0]
    v_cvt_pk_bf16_f32 v20, v20, v21
    v_cvt_pk_bf16_f32 v21, v22, v23
    v_cvt_pk_bf16_f32 v22, v24, v25
    v_cvt_pk_bf16_f32 v23, v26, v27
    buffer_store_dwordx4 v[20:23], v1, s[40:43], s72 offen offset:3072 sc1
    buffer_load_dword v3, v217, s[32:35], s19 offen sc1
    s_waitcnt lgkmcnt(0)
    s_barrier
    s_sub_u32 s30, s47, s75
    s_sub_u32 s31, s79, s75
    v_bfe_u32 v20, v1, 4, 4
    v_lshrrev_b32 v21, 8, v1
    s_lshl_b32 s98, s4, 4
    s_add_u32 s98, s98, 16
    v_add_u32 v22, s98, v20
    v_mul_u32_u24 v22, 144, v22
    v_add_u32 v22, s30, v22
    v_lshl_add_u32 v9, v21, 3, v22
    s_lshr_b32 s98, s73, 1
    v_add_u32 v8, s98, v9
    v_subrev_u32 v10, s98, v9
    s_sub_u32 s99, s31, s30
    v_add_u32 v24, s99, v8
    v_add_u32 v25, s99, v9
    v_add_u32 v26, s99, v10
    s_bitcmp1_b32 s4, 0
    s_cselect_b32 s99, s31, s30
    v_mul_u32_u24 v23, 144, v20
    v_lshl_add_u32 v23, v21, 3, v23
    v_add_u32 v13, s99, v23
    v_add_u32 v12, s98, v13
    v_accvgpr_read_b32 v32, a64
    v_accvgpr_read_b32 v33, a65
    v_accvgpr_read_b32 v34, a66
    v_accvgpr_read_b32 v35, a67
    v_cvt_pk_bf16_f32 v32, v32, v33
    v_cvt_pk_bf16_f32 v33, v34, v35
    ds_write_b64 v8, v[32:33] offset:0
    v_accvgpr_read_b32 v36, a68
    v_accvgpr_read_b32 v37, a69
    v_accvgpr_read_b32 v38, a70
    v_accvgpr_read_b32 v39, a71
    v_cvt_pk_bf16_f32 v36, v36, v37
    v_cvt_pk_bf16_f32 v37, v38, v39
    ds_write_b64 v8, v[36:37] offset:9216
    v_accvgpr_read_b32 v40, a72
    v_accvgpr_read_b32 v41, a73
    v_accvgpr_read_b32 v42, a74
    v_accvgpr_read_b32 v43, a75
    v_cvt_pk_bf16_f32 v40, v40, v41
    v_cvt_pk_bf16_f32 v41, v42, v43
    ds_write_b64 v24, v[40:41] offset:0
    v_accvgpr_read_b32 v44, a76
    v_accvgpr_read_b32 v45, a77
    v_accvgpr_read_b32 v46, a78
    v_accvgpr_read_b32 v47, a79
    v_cvt_pk_bf16_f32 v44, v44, v45
    v_cvt_pk_bf16_f32 v45, v46, v47
    ds_write_b64 v24, v[44:45] offset:9216
    v_accvgpr_read_b32 v32, a80
    v_accvgpr_read_b32 v33, a81
    v_accvgpr_read_b32 v34, a82
    v_accvgpr_read_b32 v35, a83
    v_cvt_pk_bf16_f32 v32, v32, v33
    v_cvt_pk_bf16_f32 v33, v34, v35
    ds_write_b64 v9, v[32:33] offset:32
    v_accvgpr_read_b32 v36, a84
    v_accvgpr_read_b32 v37, a85
    v_accvgpr_read_b32 v38, a86
    v_accvgpr_read_b32 v39, a87
    v_cvt_pk_bf16_f32 v36, v36, v37
    v_cvt_pk_bf16_f32 v37, v38, v39
    ds_write_b64 v9, v[36:37] offset:9248
    v_accvgpr_read_b32 v40, a88
    v_accvgpr_read_b32 v41, a89
    v_accvgpr_read_b32 v42, a90
    v_accvgpr_read_b32 v43, a91
    v_cvt_pk_bf16_f32 v40, v40, v41
    v_cvt_pk_bf16_f32 v41, v42, v43
    ds_write_b64 v25, v[40:41] offset:32
    v_accvgpr_read_b32 v44, a92
    v_accvgpr_read_b32 v45, a93
    v_accvgpr_read_b32 v46, a94
    v_accvgpr_read_b32 v47, a95
    v_cvt_pk_bf16_f32 v44, v44, v45
    v_cvt_pk_bf16_f32 v45, v46, v47
    ds_write_b64 v25, v[44:45] offset:9248
    v_accvgpr_read_b32 v32, a96
    v_accvgpr_read_b32 v33, a97
    v_accvgpr_read_b32 v34, a98
    v_accvgpr_read_b32 v35, a99
    v_cvt_pk_bf16_f32 v32, v32, v33
    v_cvt_pk_bf16_f32 v33, v34, v35
    ds_write_b64 v10, v[32:33] offset:64
    v_accvgpr_read_b32 v36, a100
    v_accvgpr_read_b32 v37, a101
    v_accvgpr_read_b32 v38, a102
    v_accvgpr_read_b32 v39, a103
    v_cvt_pk_bf16_f32 v36, v36, v37
    v_cvt_pk_bf16_f32 v37, v38, v39
    ds_write_b64 v10, v[36:37] offset:9280
    v_accvgpr_read_b32 v40, a104
    v_accvgpr_read_b32 v41, a105
    v_accvgpr_read_b32 v42, a106
    v_accvgpr_read_b32 v43, a107
    v_cvt_pk_bf16_f32 v40, v40, v41
    v_cvt_pk_bf16_f32 v41, v42, v43
    ds_write_b64 v26, v[40:41] offset:64
    v_accvgpr_read_b32 v44, a108
    v_accvgpr_read_b32 v45, a109
    v_accvgpr_read_b32 v46, a110
    v_accvgpr_read_b32 v47, a111
    v_cvt_pk_bf16_f32 v44, v44, v45
    v_cvt_pk_bf16_f32 v45, v46, v47
    ds_write_b64 v26, v[44:45] offset:9280
    v_mov_b32 v218, 2
    s_cmp_eq_u64 s[84:85], 0
    s_cselect_b32 s7, s74, 1073741824
    s_cmp_lg_u32 s83, 0
    s_cselect_b32 s7, s74, s7
    s_waitcnt vmcnt(1)
    buffer_store_dword v218, v216, s[32:35], s7 offen sc1
    s_xor_b32 s21, s3, 2
    s_lshl2_add_u32 s21, s21, s4
    s_mul_i32 s21, s21, 36864
    s_add_u32 s21, s21, s28
    s_mov_b32 m0, s46
    s_nop 0
    buffer_load_dwordx4 v1, s[56:59], s21 offen sc1 lds
    v_accvgpr_read_b32 v32, a112
    v_accvgpr_read_b32 v33, a113
    v_accvgpr_read_b32 v34, a114
    v_accvgpr_read_b32 v35, a115
    v_cvt_pk_bf16_f32 v32, v32, v33
    v_cvt_pk_bf16_f32 v33, v34, v35
    ds_write_b64 v9, v[32:33] offset:96
    v_accvgpr_read_b32 v36, a116
    v_accvgpr_read_b32 v37, a117
    v_accvgpr_read_b32 v38, a118
    v_accvgpr_read_b32 v39, a119
    v_cvt_pk_bf16_f32 v36, v36, v37
    buffer_load_dwordx4 v1, s[56:59], s21 offen offset:1024 sc1 lds
    v_cvt_pk_bf16_f32 v37, v38, v39
    ds_write_b64 v9, v[36:37] offset:9312
    v_accvgpr_read_b32 v40, a120
    v_accvgpr_read_b32 v41, a121
    v_accvgpr_read_b32 v42, a122
    v_accvgpr_read_b32 v43, a123
    v_cvt_pk_bf16_f32 v40, v40, v41
    v_cvt_pk_bf16_f32 v41, v42, v43
    ds_write_b64 v25, v[40:41] offset:96
    v_accvgpr_read_b32 v44, a124
    v_accvgpr_read_b32 v45, a125
    v_accvgpr_read_b32 v46, a126
    buffer_load_dwordx4 v1, s[56:59], s21 offen offset:2048 sc1 lds
    v_accvgpr_read_b32 v47, a127
    v_cvt_pk_bf16_f32 v44, v44, v45
    v_cvt_pk_bf16_f32 v45, v46, v47
    s_waitcnt lgkmcnt(3)
    ds_write_b64 v25, v[44:45] offset:9312
    v_accvgpr_read_b32 v32, a128
    v_accvgpr_read_b32 v33, a129
    v_accvgpr_read_b32 v34, a130
    v_accvgpr_read_b32 v35, a131
    v_cvt_pk_bf16_f32 v32, v32, v33
    v_cvt_pk_bf16_f32 v33, v34, v35
    ds_write_b64 v12, v[32:33] offset:0
    v_accvgpr_read_b32 v36, a132
    buffer_load_dwordx4 v1, s[56:59], s21 offen offset:3072 sc1 lds
    v_accvgpr_read_b32 v37, a133
    v_accvgpr_read_b32 v38, a134
    v_accvgpr_read_b32 v39, a135
    v_cvt_pk_bf16_f32 v36, v36, v37
    v_cvt_pk_bf16_f32 v37, v38, v39
    s_cmp_eq_u32 s73, 0
    s_cselect_b64 exec, -1, 0
    ds_write_b64 v13, v[36:37] offset:32
    s_mov_b64 exec, -1
    s_cmp_lg_u64 s[84:85], 0
    s_cselect_b32 s7, 1, 0
    v_mov_b32 v20, s7
    s_lshl2_add_u32 s98, s4, s30
    s_add_u32 s21, s21, 4096
    s_add_u32 m0, s46, 4096
    s_nop 0
    buffer_load_dwordx4 v1, s[56:59], s21 offen sc1 lds
    v_mov_b32 v21, s98
    ds_write_b32 v21, v20 offset:20736
    v_mov_b32 v21, s30
    s_and_b32 s98, s4, 1
    s_lshl_b32 s98, s98, 6
    v_lshrrev_b32 v14, 4, v1
    v_add_u32 v14, s98, v14
    s_sub_u32 s7, 15, s6
    s_cmp_lt_u32 s4, 2
    s_cselect_b32 s7, s6, s7
    s_cselect_b32 s99, s30, s31
    s_lshl_b32 s7, s7, 7
    buffer_load_dwordx4 v1, s[56:59], s21 offen offset:1024 sc1 lds
    v_add_u32 v2, 2, v14
    v_mul_u32_u24 v2, 144, v2
    v_add_u32 v2, s99, v2
    v_add_u32 v14, s7, v14
    v_lshrrev_b32 v15, 4, v14
    s_mov_b32 s98, 155648
    v_mul_lo_u32 v15, v15, s98
    v_and_b32 v23, 0xf0, v1
    v_add_u32 v15, v15, v23
    s_lshl3_add_u32 s98, s6, s62
    s_mul_i32 s98, s98, 155648
    v_add_u32 v4, s98, v1
    buffer_load_dwordx4 v1, s[56:59], s21 offen offset:2048 sc1 lds
    s_sub_u32 s98, 15, s6
    s_lshl3_add_u32 s98, s98, s62
    s_mul_i32 s98, s98, 155648
    v_add_u32 v5, s98, v1
    v_mov_b32 v19, v217
    v_subrev_u32 v23, s75, v1
    v_add_u32 v11, s44, v23
    v_add_u32 v12, s45, v23
    v_add_u32 v13, s46, v23
    v_add_u32 v6, s47, v23
    v_add_u32 v7, s79, v23
    s_mov_b32 s98, 0xbfb8aa3b
    s_mov_b32 s99, 0x3eae1a93
    s_waitcnt vmcnt(8) lgkmcnt(0)
    s_barrier
    ds_read_b128 v[24:27], v21 offset:20736
    ds_read_b128 v[32:35], v2 offset:2016
    ds_read_b128 v[36:39], v2 offset:2032
    ds_read_b128 v[40:43], v2 offset:2048
    ds_read_b128 v[44:47], v2 offset:1728
    ds_read_b128 v[48:51], v2 offset:1744
    ds_read_b128 v[52:55], v2 offset:1760
    s_waitcnt lgkmcnt(6)
    v_or3_b32 v24, v24, v25, v26
    v_or_b32 v24, v24, v27
    s_nop 0
    v_readfirstlane_b32 s7, v24
    s_nop 1
    s_andn2_b32 s7, s7, s83
    s_cbranch_scc1 K1_REDO
    buffer_load_dword v28, v29, s[32:35], s92 offen sc1
    v_cmp_gt_u32 vcc, 1, v3
    s_nop 1
    s_and_b64 vcc, vcc, exec
    s_cbranch_scc1 SPIN_SHORT
BACK_SHORT:
    buffer_load_dwordx4 a[0:3], v4, s[40:43], s63 offen offset:0 sc1
    ds_read_b128 v[128:131], v2 offset:2096
    ds_read_b128 v[132:135], v2 offset:2112
    ds_read_b128 v[136:139], v2 offset:2128
    ds_read_b128 v[56:59], v2 offset:1440
    ds_read_b128 v[60:63], v2 offset:1456
    ds_read_b128 v[64:67], v2 offset:1472
    ds_read_b128 v[68:71], v2 offset:1152
    ds_read_b128 v[72:75], v2 offset:1168
    ds_read_b128 v[76:79], v2 offset:1184
    s_waitcnt lgkmcnt(8)
    v_dot2_f32_bf16 v140, v128, v32, 0
    v_dot2_f32_bf16 v141, v128, v44, 0
    buffer_load_dwordx4 a[8:11], v4, s[40:43], s63 offen offset:1024 sc1
    ds_read_b128 v[80:83], v2 offset:864
    s_waitcnt lgkmcnt(6)
    v_dot2_f32_bf16 v142, v128, v56, 0
    s_waitcnt lgkmcnt(3)
    v_dot2_f32_bf16 v143, v128, v68, 0
    ds_read_b128 v[84:87], v2 offset:880
    v_dot2c_f32_bf16 v140, v129, v33
    v_dot2c_f32_bf16 v141, v129, v45
    ds_read_b128 v[88:91], v2 offset:896
    v_dot2c_f32_bf16 v142, v129, v57
    v_dot2c_f32_bf16 v143, v129, v69
    ds_read_b128 v[92:95], v2 offset:576
    v_dot2c_f32_bf16 v140, v130, v34
    buffer_load_dwordx4 a[16:19], v4, s[40:43], s63 offen offset:2048 sc1
    v_dot2c_f32_bf16 v141, v130, v46
    ds_read_b128 v[96:99], v2 offset:592
    v_dot2c_f32_bf16 v142, v130, v58
    v_dot2c_f32_bf16 v143, v130, v70
    ds_read_b128 v[100:103], v2 offset:608
    v_dot2c_f32_bf16 v140, v131, v35
    v_dot2c_f32_bf16 v141, v131, v47
    ds_read_b128 v[104:107], v2 offset:288
    v_dot2c_f32_bf16 v142, v131, v59
    v_dot2c_f32_bf16 v143, v131, v71
    ds_read_b128 v[108:111], v2 offset:304
    v_dot2c_f32_bf16 v140, v132, v36
    buffer_load_dwordx4 a[24:27], v4, s[40:43], s63 offen offset:3072 sc1
    v_dot2c_f32_bf16 v141, v132, v48
    ds_read_b128 v[112:115], v2 offset:320
    v_dot2c_f32_bf16 v142, v132, v60
    s_waitcnt lgkmcnt(8)
    v_dot2c_f32_bf16 v143, v132, v72
    ds_read_b128 v[116:119], v2 offset:0
    v_dot2c_f32_bf16 v140, v133, v37
    v_dot2c_f32_bf16 v141, v133, v49
    ds_read_b128 v[120:123], v2 offset:16
    v_dot2c_f32_bf16 v142, v133, v61
    v_dot2c_f32_bf16 v143, v133, v73
    ds_read_b128 v[124:127], v2 offset:32
    s_xor_b32 s63, s63, 4096
    buffer_load_dwordx4 a[32:35], v4, s[40:43], s63 offen offset:0 sc1
    v_dot2c_f32_bf16 v140, v134, v38
    v_dot2c_f32_bf16 v141, v134, v50
    v_dot2c_f32_bf16 v142, v134, v62
    v_dot2c_f32_bf16 v143, v134, v74
    v_dot2c_f32_bf16 v140, v135, v39
    v_dot2c_f32_bf16 v141, v135, v51
    v_dot2c_f32_bf16 v142, v135, v63
    v_dot2c_f32_bf16 v143, v135, v75
    v_dot2c_f32_bf16 v140, v136, v40
    v_dot2c_f32_bf16 v141, v136, v52
    v_dot2c_f32_bf16 v142, v136, v64
    buffer_load_dwordx4 a[40:43], v4, s[40:43], s63 offen offset:1024 sc1
    v_dot2c_f32_bf16 v143, v136, v76
    v_dot2_f32_bf16 v144, v128, v80, 0
    s_waitcnt lgkmcnt(4)
    v_dot2_f32_bf16 v145, v128, v92, 0
    ds_read_b128 v[32:35], v2 offset:2064
    v_dot2_f32_bf16 v146, v128, v104, 0
    s_waitcnt lgkmcnt(3)
    v_dot2_f32_bf16 v147, v128, v116, 0
    ds_read_b128 v[36:39], v2 offset:2080
    v_dot2c_f32_bf16 v144, v129, v81
    v_dot2c_f32_bf16 v145, v129, v93
    ds_read_b128 v[44:47], v2 offset:1776
    v_dot2c_f32_bf16 v146, v129, v105
    v_dot2c_f32_bf16 v147, v129, v117
    buffer_load_dwordx4 a[48:51], v4, s[40:43], s63 offen offset:2048 sc1
    ds_read_b128 v[48:51], v2 offset:1792
    v_dot2c_f32_bf16 v144, v130, v82
    v_dot2c_f32_bf16 v145, v130, v94
    ds_read_b128 v[56:59], v2 offset:1488
    v_dot2c_f32_bf16 v146, v130, v106
    v_dot2c_f32_bf16 v147, v130, v118
    ds_read_b128 v[60:63], v2 offset:1504
    v_dot2c_f32_bf16 v144, v131, v83
    v_dot2c_f32_bf16 v145, v131, v95
    ds_read_b128 v[68:71], v2 offset:1200
    v_dot2c_f32_bf16 v146, v131, v107
    buffer_load_dwordx4 a[56:59], v4, s[40:43], s63 offen offset:3072 sc1
    v_dot2c_f32_bf16 v147, v131, v119
    ds_read_b128 v[72:75], v2 offset:1216
    v_dot2c_f32_bf16 v144, v132, v84
    v_dot2c_f32_bf16 v145, v132, v96
    v_dot2c_f32_bf16 v146, v132, v108
    s_waitcnt lgkmcnt(8)
    v_dot2c_f32_bf16 v147, v132, v120
    v_dot2c_f32_bf16 v144, v133, v85
    v_dot2c_f32_bf16 v145, v133, v97
    v_dot2c_f32_bf16 v146, v133, v109
    v_dot2c_f32_bf16 v147, v133, v121
    v_dot2c_f32_bf16 v144, v134, v86
    s_xor_b32 s63, s63, 12288
    buffer_load_dwordx4 a[64:67], v4, s[40:43], s63 offen offset:0 sc1
    v_dot2c_f32_bf16 v145, v134, v98
    v_dot2c_f32_bf16 v146, v134, v110
    v_dot2c_f32_bf16 v147, v134, v122
    v_dot2c_f32_bf16 v144, v135, v87
    v_dot2c_f32_bf16 v145, v135, v99
    v_dot2c_f32_bf16 v146, v135, v111
    v_dot2c_f32_bf16 v147, v135, v123
    v_dot2c_f32_bf16 v144, v136, v88
    v_dot2c_f32_bf16 v145, v136, v100
    v_dot2c_f32_bf16 v146, v136, v112
    v_dot2c_f32_bf16 v147, v136, v124
    v_lshlrev_b32 v8, 16, v138
    buffer_load_dwordx4 a[72:75], v4, s[40:43], s63 offen offset:1024 sc1
    v_mul_f32 v8, s98, v8
    v_exp_f32 v8, v8
    s_or_b32 s7, s6, s4
    s_cbranch_scc0 K1_WMASK
K1_WMASK_BACK:
    v_max3_f32 v9, v140, v141, v142
    v_max3_f32 v10, v143, v144, v145
    v_max3_f32 v9, v9, v146, v147
    v_max_f32 v9, v9, v10
    v_mul_f32 v9, s99, v9
    v_add_f32 v8, 1.0, v8
    buffer_load_dwordx4 a[80:83], v4, s[40:43], s63 offen offset:2048 sc1
    v_fma_f32 v140, v140, s99, -v9
    ds_read_b128 v[80:83], v2 offset:912
    v_fma_f32 v141, v141, s99, -v9
    ds_read_b128 v[84:87], v2 offset:928
    v_fma_f32 v142, v142, s99, -v9
    ds_read_b128 v[92:95], v2 offset:624
    v_fma_f32 v143, v143, s99, -v9
    ds_read_b128 v[96:99], v2 offset:640
    v_fma_f32 v144, v144, s99, -v9
    ds_read_b128 v[104:107], v2 offset:336
    v_fma_f32 v145, v145, s99, -v9
    buffer_load_dwordx4 a[88:91], v4, s[40:43], s63 offen offset:3072 sc1
    s_xor_b32 s63, s63, 4096
    ds_read_b128 v[108:111], v2 offset:352
    v_fma_f32 v146, v146, s99, -v9
    ds_read_b128 v[116:119], v2 offset:48
    v_fma_f32 v147, v147, s99, -v9
    s_waitcnt lgkmcnt(7)
    ds_read_b128 v[120:123], v2 offset:64
    v_exp_f32 v140, v140
    v_exp_f32 v141, v141
    v_exp_f32 v142, v142
    v_exp_f32 v143, v143
    v_exp_f32 v144, v144
    v_exp_f32 v145, v145
    v_exp_f32 v146, v146
    buffer_load_dword v3, v217, s[32:35], s19 offen sc1
    buffer_load_dwordx4 a[96:99], v4, s[40:43], s63 offen offset:0 sc1
    v_exp_f32 v147, v147
    v_add_f32 v10, v140, v141
    v_add_f32 v10, v10, v142
    v_add_f32 v10, v10, v143
    v_add_f32 v10, v10, v144
    v_add_f32 v10, v10, v145
    buffer_load_dwordx4 a[104:107], v4, s[40:43], s63 offen offset:1024 sc1
    v_add_f32 v10, v10, v146
    v_add_f32 v10, v10, v147
    v_mul_f32 v10, v10, v8
    v_rcp_f32 v10, v10
    s_nop 0
    v_mul_f32 v140, v140, v10
    v_mul_f32 v141, v141, v10
    v_mul_f32 v142, v142, v10
    buffer_load_dwordx4 a[112:115], v4, s[40:43], s63 offen offset:2048 sc1
    v_mul_f32 v143, v143, v10
    v_mul_f32 v144, v144, v10
    v_mul_f32 v145, v145, v10
    v_mul_f32 v146, v146, v10
    v_mul_f32 v147, v147, v10
    v_cvt_pk_bf16_f32 v148, 0, v140
    buffer_load_dwordx4 a[120:123], v4, s[40:43], s63 offen offset:3072 sc1
    v_cvt_pk_bf16_f32 v149, 0, v141
    v_cvt_pk_bf16_f32 v150, 0, v142
    v_cvt_pk_bf16_f32 v151, 0, v143
    v_cvt_pk_bf16_f32 v152, 0, v144
    v_cvt_pk_bf16_f32 v153, 0, v145
    v_cvt_pk_bf16_f32 v154, 0, v146
    v_cvt_pk_bf16_f32 v155, 0, v147
    s_xor_b32 s63, s63, 28672
    buffer_load_dwordx4 a[128:131], v4, s[40:43], s63 offen offset:0 sc1
    v_lshrrev_b32 v140, 16, v148
    v_lshrrev_b32 v141, 16, v149
    v_lshrrev_b32 v142, 16, v150
    v_lshrrev_b32 v143, 16, v151
    v_lshrrev_b32 v144, 16, v152
    v_lshrrev_b32 v145, 16, v153
    v_lshrrev_b32 v146, 16, v154
    buffer_load_dwordx4 a[136:139], v4, s[40:43], s63 offen offset:1024 sc1
    v_lshrrev_b32 v147, 16, v155
    v_dot2_f32_bf16 v128, v42, v140, 0
    v_dot2_f32_bf16 v129, v42, v148, 0
    v_dot2_f32_bf16 v130, v43, v140, 0
    v_dot2_f32_bf16 v131, v43, v148, 0
    v_dot2_f32_bf16 v132, v32, v140, 0
    buffer_load_dwordx4 a[144:147], v4, s[40:43], s63 offen offset:2048 sc1
    v_dot2_f32_bf16 v133, v32, v148, 0
    v_dot2_f32_bf16 v134, v33, v140, 0
    v_dot2_f32_bf16 v135, v33, v148, 0
    v_dot2_f32_bf16 v136, v34, v140, 0
    v_dot2_f32_bf16 v137, v34, v148, 0
    v_dot2_f32_bf16 v138, v35, v140, 0
    v_dot2_f32_bf16 v139, v35, v148, 0
    buffer_load_dwordx4 a[152:155], v4, s[40:43], s63 offen offset:3072 sc1
    s_xor_b32 s63, s63, 4096
    v_dot2_f32_bf16 v156, v36, v140, 0
    v_dot2_f32_bf16 v157, v36, v148, 0
    v_dot2_f32_bf16 v158, v37, v140, 0
    v_dot2_f32_bf16 v159, v37, v148, 0
    v_dot2_f32_bf16 v17, v38, v140, 0
    v_dot2_f32_bf16 v18, v38, v148, 0
    v_dot2c_f32_bf16 v128, v54, v141
    s_waitcnt vmcnt(8)
    v_cmp_gt_u32 vcc, 2, v3
    s_nop 1
    s_and_b64 vcc, vcc, exec
    s_cbranch_scc1 SPIN_CTX
BACK_CTX:
    buffer_load_dwordx4 a[4:7], v5, s[40:43], s20 offen offset:0 sc1
    v_dot2c_f32_bf16 v129, v54, v149
    v_dot2c_f32_bf16 v130, v55, v141
    v_dot2c_f32_bf16 v131, v55, v149
    v_dot2c_f32_bf16 v132, v44, v141
    v_dot2c_f32_bf16 v133, v44, v149
    v_dot2c_f32_bf16 v134, v45, v141
    v_dot2c_f32_bf16 v135, v45, v149
    v_dot2c_f32_bf16 v136, v46, v141
    v_dot2c_f32_bf16 v137, v46, v149
    v_dot2c_f32_bf16 v138, v47, v141
    v_dot2c_f32_bf16 v139, v47, v149
    v_dot2c_f32_bf16 v156, v48, v141
    v_dot2c_f32_bf16 v157, v48, v149
    buffer_load_dwordx4 a[12:15], v5, s[40:43], s20 offen offset:1024 sc1
    v_dot2c_f32_bf16 v158, v49, v141
    v_dot2c_f32_bf16 v159, v49, v149
    v_dot2c_f32_bf16 v17, v50, v141
    v_dot2c_f32_bf16 v18, v50, v149
    v_dot2c_f32_bf16 v128, v66, v142
    v_dot2c_f32_bf16 v129, v66, v150
    v_dot2c_f32_bf16 v130, v67, v142
    v_dot2c_f32_bf16 v131, v67, v150
    v_dot2c_f32_bf16 v132, v56, v142
    v_dot2c_f32_bf16 v133, v56, v150
    v_dot2c_f32_bf16 v134, v57, v142
    v_dot2c_f32_bf16 v135, v57, v150
    v_dot2c_f32_bf16 v136, v58, v142
    v_dot2c_f32_bf16 v137, v58, v150
    buffer_load_dwordx4 a[20:23], v5, s[40:43], s20 offen offset:2048 sc1
    v_dot2c_f32_bf16 v138, v59, v142
    v_dot2c_f32_bf16 v139, v59, v150
    v_dot2c_f32_bf16 v156, v60, v142
    v_dot2c_f32_bf16 v157, v60, v150
    v_dot2c_f32_bf16 v158, v61, v142
    v_dot2c_f32_bf16 v159, v61, v150
    v_dot2c_f32_bf16 v17, v62, v142
    v_dot2c_f32_bf16 v18, v62, v150
    v_dot2c_f32_bf16 v128, v78, v143
    v_dot2c_f32_bf16 v129, v78, v151
    v_dot2c_f32_bf16 v130, v79, v143
    v_dot2c_f32_bf16 v131, v79, v151
    v_dot2c_f32_bf16 v132, v68, v143
    v_dot2c_f32_bf16 v133, v68, v151
    buffer_load_dwordx4 a[28:31], v5, s[40:43], s20 offen offset:3072 sc1
    v_dot2c_f32_bf16 v134, v69, v143
    v_dot2c_f32_bf16 v135, v69, v151
    v_dot2c_f32_bf16 v136, v70, v143
    v_dot2c_f32_bf16 v137, v70, v151
    v_dot2c_f32_bf16 v138, v71, v143
    v_dot2c_f32_bf16 v139, v71, v151
    v_dot2c_f32_bf16 v156, v72, v143
    v_dot2c_f32_bf16 v157, v72, v151
    v_dot2c_f32_bf16 v158, v73, v143
    v_dot2c_f32_bf16 v159, v73, v151
    v_dot2c_f32_bf16 v17, v74, v143
    v_dot2c_f32_bf16 v18, v74, v151
    v_dot2c_f32_bf16 v128, v90, v144
    v_dot2c_f32_bf16 v129, v90, v152
    s_xor_b32 s20, s20, 4096
    buffer_load_dwordx4 a[36:39], v5, s[40:43], s20 offen offset:0 sc1
    v_dot2c_f32_bf16 v130, v91, v144
    v_dot2c_f32_bf16 v131, v91, v152
    s_waitcnt lgkmcnt(0)
    v_dot2c_f32_bf16 v132, v80, v144
    v_dot2c_f32_bf16 v133, v80, v152
    v_dot2c_f32_bf16 v134, v81, v144
    v_dot2c_f32_bf16 v135, v81, v152
    v_dot2c_f32_bf16 v136, v82, v144
    v_dot2c_f32_bf16 v137, v82, v152
    v_dot2c_f32_bf16 v138, v83, v144
    v_dot2c_f32_bf16 v139, v83, v152
    v_dot2c_f32_bf16 v156, v84, v144
    v_dot2c_f32_bf16 v157, v84, v152
    v_dot2c_f32_bf16 v158, v85, v144
    buffer_load_dwordx4 a[44:47], v5, s[40:43], s20 offen offset:1024 sc1
    v_dot2c_f32_bf16 v159, v85, v152
    v_dot2c_f32_bf16 v17, v86, v144
    v_dot2c_f32_bf16 v18, v86, v152
    v_dot2c_f32_bf16 v128, v102, v145
    v_dot2c_f32_bf16 v129, v102, v153
    v_dot2c_f32_bf16 v130, v103, v145
    v_dot2c_f32_bf16 v131, v103, v153
    v_dot2c_f32_bf16 v132, v92, v145
    v_dot2c_f32_bf16 v133, v92, v153
    v_dot2c_f32_bf16 v134, v93, v145
    v_dot2c_f32_bf16 v135, v93, v153
    v_dot2c_f32_bf16 v136, v94, v145
    v_dot2c_f32_bf16 v137, v94, v153
    v_dot2c_f32_bf16 v138, v95, v145
    buffer_load_dwordx4 a[52:55], v5, s[40:43], s20 offen offset:2048 sc1
    v_dot2c_f32_bf16 v139, v95, v153
    v_dot2c_f32_bf16 v156, v96, v145
    v_dot2c_f32_bf16 v157, v96, v153
    v_dot2c_f32_bf16 v158, v97, v145
    v_dot2c_f32_bf16 v159, v97, v153
    v_dot2c_f32_bf16 v17, v98, v145
    v_dot2c_f32_bf16 v18, v98, v153
    v_dot2c_f32_bf16 v128, v114, v146
    v_dot2c_f32_bf16 v129, v114, v154
    v_dot2c_f32_bf16 v130, v115, v146
    v_dot2c_f32_bf16 v131, v115, v154
    v_dot2c_f32_bf16 v132, v104, v146
    v_dot2c_f32_bf16 v133, v104, v154
    v_dot2c_f32_bf16 v134, v105, v146
    buffer_load_dwordx4 a[60:63], v5, s[40:43], s20 offen offset:3072 sc1
    s_xor_b32 s20, s20, 12288
    v_dot2c_f32_bf16 v135, v105, v154
    v_dot2c_f32_bf16 v136, v106, v146
    v_dot2c_f32_bf16 v137, v106, v154
    v_dot2c_f32_bf16 v138, v107, v146
    v_dot2c_f32_bf16 v139, v107, v154
    v_dot2c_f32_bf16 v156, v108, v146
    v_dot2c_f32_bf16 v157, v108, v154
    v_dot2c_f32_bf16 v158, v109, v146
    v_dot2c_f32_bf16 v159, v109, v154
    v_dot2c_f32_bf16 v17, v110, v146
    v_dot2c_f32_bf16 v18, v110, v154
    v_dot2c_f32_bf16 v128, v126, v147
    v_dot2c_f32_bf16 v129, v126, v155
    v_dot2c_f32_bf16 v130, v127, v147
    v_dot2c_f32_bf16 v131, v127, v155
    v_dot2c_f32_bf16 v132, v116, v147
    v_dot2c_f32_bf16 v133, v116, v155
    v_dot2c_f32_bf16 v134, v117, v147
    v_dot2c_f32_bf16 v135, v117, v155
    v_dot2c_f32_bf16 v136, v118, v147
    v_dot2c_f32_bf16 v137, v118, v155
    v_dot2c_f32_bf16 v138, v119, v147
    v_dot2c_f32_bf16 v139, v119, v155
    v_dot2c_f32_bf16 v156, v120, v147
    v_dot2c_f32_bf16 v157, v120, v155
    v_dot2c_f32_bf16 v158, v121, v147
    v_dot2c_f32_bf16 v159, v121, v155
    v_dot2c_f32_bf16 v17, v122, v147
    v_dot2c_f32_bf16 v18, v122, v155
    v_mov_b32 v89, 0
    v_mov_b32 v90, 0
    v_mov_b32 v91, 0
    v_cvt_pk_bf16_f32 v80, v128, v129
    v_cvt_pk_bf16_f32 v81, v130, v131
    v_cvt_pk_bf16_f32 v82, v132, v133
    v_cvt_pk_bf16_f32 v83, v134, v135
    v_cvt_pk_bf16_f32 v84, v136, v137
    v_cvt_pk_bf16_f32 v85, v138, v139
    v_cvt_pk_bf16_f32 v86, v156, v157
    v_cvt_pk_bf16_f32 v87, v158, v159
    v_cvt_pk_bf16_f32 v88, v17, v18
    v_cmp_gt_u32 vcc, 1, v28
    s_nop 1
    s_and_b64 vcc, vcc, exec
    s_cbranch_scc1 SPIN_ALL
BACK_ALL:
    s_waitcnt vmcnt(4)
    s_barrier
    ds_read_b128 v[104:107], v11 offset:0
    ds_read_b128 v[108:111], v11 offset:8192
    ds_read_b128 v[112:115], v11 offset:16384
    ds_read_b128 v[116:119], v11 offset:24576
    s_waitcnt lgkmcnt(3)
    v_mfma_f32_16x16x32_bf16 v[176:179], v[104:107], a[0:3], 0
    s_lshl3_add_u32 s98, 1, s5
    ds_read_b128 v[120:123], v11 offset:1024
    ds_read_b128 v[124:127], v11 offset:9216
    s_waitcnt lgkmcnt(4)
    v_mfma_f32_16x16x32_bf16 v[176:179], v[108:111], a[8:11], v[176:179]
    s_and_b32 s98, s98, 31
    buffer_load_dwordx4 a[68:71], v5, s[40:43], s20 offen offset:0 sc1
    s_waitcnt lgkmcnt(3)
    v_mfma_f32_16x16x32_bf16 v[176:179], v[112:115], a[16:19], v[176:179]
    s_lshl_b32 s8, s6, 5
    ds_read_b128 v[128:131], v11 offset:17408
    ds_read_b128 v[132:135], v11 offset:25600
    s_waitcnt lgkmcnt(4)
    v_mfma_f32_16x16x32_bf16 v[176:179], v[116:119], a[24:27], v[176:179]
    s_add_u32 s98, s98, s8
    ds_read_b128 v[136:139], v11 offset:2048
    v_mov_b32 v16, 0x44444444
    v_mfma_f32_16x16x32_bf16 v[180:183], v[104:107], a[4:7], 0
    s_mul_i32 s98, s98, 3
    buffer_load_dwordx4 a[76:79], v5, s[40:43], s20 offen offset:1024 sc1
    v_mfma_f32_16x16x32_bf16 v[180:183], v[108:111], a[12:15], v[180:183]
    s_sub_u32 s98, s98, 1
    ds_read_b128 v[140:143], v11 offset:10240
    ds_read_b128 v[144:147], v11 offset:18432
    v_mfma_f32_16x16x32_bf16 v[180:183], v[112:115], a[20:23], v[180:183]
    s_add_u32 s98, s98, 3
    ds_read_b128 v[148:151], v11 offset:26624
    v_mfma_f32_16x16x32_bf16 v[180:183], v[116:119], a[28:31], v[180:183]
    s_lshl2_add_u32 s98, s98, s4
    ds_read_b128 v[104:107], v11 offset:3072
    s_waitcnt lgkmcnt(5)
    v_mfma_f32_16x16x32_bf16 v[184:187], v[120:123], a[0:3], 0
    s_mul_i32 s8, s98, 3072
    buffer_load_dwordx4 a[84:87], v5, s[40:43], s20 offen offset:2048 sc1
    v_mfma_f32_16x16x32_bf16 v[184:187], v[124:127], a[8:11], v[184:187]
    s_lshl3_add_u32 s98, 2, s5
    ds_read_b128 v[108:111], v11 offset:11264
    ds_read_b128 v[112:115], v11 offset:19456
    v_mfma_f32_16x16x32_bf16 v[184:187], v[128:131], a[16:19], v[184:187]
    s_and_b32 s98, s98, 31
    ds_read_b128 v[116:119], v11 offset:27648
    v_mfma_f32_16x16x32_bf16 v[184:187], v[132:135], a[24:27], v[184:187]
    s_lshl_b32 s9, s6, 5
    v_mfma_f32_16x16x32_bf16 v[188:191], v[120:123], a[4:7], 0
    s_add_u32 s98, s98, s9
    buffer_load_dwordx4 a[92:95], v5, s[40:43], s20 offen offset:3072 sc1
    v_mfma_f32_16x16x32_bf16 v[188:191], v[124:127], a[12:15], v[188:191]
    s_xor_b32 s20, s20, 4096
    ds_read_b128 v[120:123], v11 offset:4096
    ds_read_b128 v[124:127], v11 offset:12288
    v_mfma_f32_16x16x32_bf16 v[188:191], v[128:131], a[20:23], v[188:191]
    s_mul_i32 s98, s98, 3
    ds_read_b128 v[128:131], v11 offset:20480
    v_mfma_f32_16x16x32_bf16 v[188:191], v[132:135], a[28:31], v[188:191]
    s_sub_u32 s98, s98, 2
    ds_read_b128 v[132:135], v11 offset:28672
    s_waitcnt lgkmcnt(4)
    v_mfma_f32_16x16x32_bf16 v[192:195], v[136:139], a[0:3], 0
    s_add_u32 s98, s98, 3
    buffer_store_dwordx4 v[80:83], v15, s[40:43], s71 offen offset:0 sc1
    v_mfma_f32_16x16x32_bf16 v[192:195], v[140:143], a[8:11], v[192:195]
    s_lshl2_add_u32 s98, s98, s4
    v_mfma_f32_16x16x32_bf16 v[192:195], v[144:147], a[16:19], v[192:195]
    s_mul_i32 s9, s98, 3072
    v_mfma_f32_16x16x32_bf16 v[192:195], v[148:151], a[24:27], v[192:195]
    s_lshl3_add_u32 s98, 3, s5
    v_mfma_f32_16x16x32_bf16 v[196:199], v[136:139], a[4:7], 0
    s_and_b32 s98, s98, 31
    ds_read_b128 v[136:139], v11 offset:5120
    v_mfma_f32_16x16x32_bf16 v[196:199], v[140:143], a[12:15], v[196:199]
    s_lshl_b32 s10, s6, 5
    buffer_store_dwordx4 v[84:87], v15, s[40:43], s71 offen offset:256 sc1
    v_mfma_f32_16x16x32_bf16 v[196:199], v[144:147], a[20:23], v[196:199]
    s_add_u32 s98, s98, s10
    ds_read_b128 v[140:143], v11 offset:13312
    ds_read_b128 v[144:147], v11 offset:21504
    v_mfma_f32_16x16x32_bf16 v[196:199], v[148:151], a[28:31], v[196:199]
    s_mul_i32 s98, s98, 3
    ds_read_b128 v[148:151], v11 offset:29696
    v_mfma_f32_16x16x32_bf16 v[200:203], v[104:107], a[0:3], 0
    s_sub_u32 s98, s98, 3
    v_mfma_f32_16x16x32_bf16 v[200:203], v[108:111], a[8:11], v[200:203]
    s_add_u32 s98, s98, 3
    buffer_store_dwordx4 v[88:91], v15, s[40:43], s70 offen offset:0 sc1
    v_mfma_f32_16x16x32_bf16 v[200:203], v[112:115], a[16:19], v[200:203]
    s_xor_b32 s21, s3, 3
    v_mfma_f32_16x16x32_bf16 v[200:203], v[116:119], a[24:27], v[200:203]
    s_lshl2_add_u32 s21, s21, s4
    v_mfma_f32_16x16x32_bf16 v[204:207], v[104:107], a[4:7], 0
    s_mul_i32 s21, s21, 36864
    ds_read_b128 v[104:107], v11 offset:6144
    v_mfma_f32_16x16x32_bf16 v[204:207], v[108:111], a[12:15], v[204:207]
    s_add_u32 s21, s21, s28
    s_mov_b32 m0, s47
    ds_read_b128 v[108:111], v11 offset:14336
    v_mfma_f32_16x16x32_bf16 v[204:207], v[112:115], a[20:23], v[204:207]
    s_lshl2_add_u32 s98, s98, s4
    buffer_load_dwordx4 v1, s[56:59], s21 offen sc1 lds
    v_mfma_f32_16x16x32_bf16 v[204:207], v[116:119], a[28:31], v[204:207]
    s_mul_i32 s10, s98, 3072
    ds_read_b128 v[112:115], v11 offset:22528
    ds_read_b128 v[116:119], v11 offset:30720
    s_waitcnt lgkmcnt(4)
    v_mfma_f32_16x16x32_bf16 v[208:211], v[120:123], a[0:3], 0
    s_sub_u32 s99, s4, s61
    v_mfma_f32_16x16x32_bf16 v[208:211], v[124:127], a[8:11], v[208:211]
    s_and_b32 s99, s99, 3
    buffer_load_dwordx4 v1, s[56:59], s21 offen offset:1024 sc1 lds
    v_mfma_f32_16x16x32_bf16 v[208:211], v[128:131], a[16:19], v[208:211]
    s_lshl3_add_u32 s98, s99, s5
    v_mfma_f32_16x16x32_bf16 v[208:211], v[132:135], a[24:27], v[208:211]
    s_and_b32 s98, s98, 31
    v_mfma_f32_16x16x32_bf16 v[212:215], v[120:123], a[4:7], 0
    s_lshl_b32 s11, s6, 5
    ds_read_b128 v[120:123], v12 offset:0
    v_mfma_f32_16x16x32_bf16 v[212:215], v[124:127], a[12:15], v[212:215]
    s_add_u32 s98, s98, s11
    buffer_load_dwordx4 v1, s[56:59], s21 offen offset:2048 sc1 lds
    v_mfma_f32_16x16x32_bf16 v[212:215], v[128:131], a[20:23], v[212:215]
    s_mul_i32 s98, s98, 3
    ds_read_b128 v[124:127], v12 offset:8192
    ds_read_b128 v[128:131], v12 offset:16384
    v_mfma_f32_16x16x32_bf16 v[212:215], v[132:135], a[28:31], v[212:215]
    s_sub_u32 s98, s98, s99
    ds_read_b128 v[132:135], v12 offset:24576
    v_mfma_f32_16x16x32_bf16 v[216:219], v[136:139], a[0:3], 0
    s_add_u32 s98, s98, 3
    v_mfma_f32_16x16x32_bf16 v[216:219], v[140:143], a[8:11], v[216:219]
    s_lshl2_add_u32 s98, s98, s4
    v_mfma_f32_16x16x32_bf16 v[216:219], v[144:147], a[16:19], v[216:219]
    s_mul_i32 s11, s98, 3072
    buffer_load_dwordx4 v1, s[56:59], s21 offen offset:3072 sc1 lds
    v_mfma_f32_16x16x32_bf16 v[216:219], v[148:151], a[24:27], v[216:219]
    s_waitcnt vmcnt(11)
    v_mfma_f32_16x16x32_bf16 v[220:223], v[136:139], a[4:7], 0
    s_add_u32 s21, s21, 4096
    ds_read_b128 v[136:139], v12 offset:1024
    v_mfma_f32_16x16x32_bf16 v[220:223], v[140:143], a[12:15], v[220:223]
    s_add_u32 m0, s47, 4096
    ds_read_b128 v[140:143], v12 offset:9216
    v_mfma_f32_16x16x32_bf16 v[220:223], v[144:147], a[20:23], v[220:223]
    buffer_load_dwordx4 v1, s[56:59], s21 offen sc1 lds
    v_mfma_f32_16x16x32_bf16 v[220:223], v[148:151], a[28:31], v[220:223]
    s_waitcnt lgkmcnt(2)
    ds_read_b128 v[144:147], v12 offset:17408
    ds_read_b128 v[148:151], v12 offset:25600
    v_mfma_f32_16x16x32_bf16 v[224:227], v[104:107], a[0:3], 0
    s_cmp_eq_u32 s99, 0
    s_cselect_b32 s11, 1073741824, s11
    v_mfma_f32_16x16x32_bf16 v[224:227], v[108:111], a[8:11], v[224:227]
    v_mfma_f32_16x16x32_bf16 v[224:227], v[112:115], a[16:19], v[224:227]
    buffer_load_dwordx4 v1, s[56:59], s21 offen offset:1024 sc1 lds
    v_mfma_f32_16x16x32_bf16 v[224:227], v[116:119], a[24:27], v[224:227]
    v_mfma_f32_16x16x32_bf16 v[228:231], v[104:107], a[4:7], 0
    ds_read_b128 v[104:107], v12 offset:2048
    v_mfma_f32_16x16x32_bf16 v[228:231], v[108:111], a[12:15], v[228:231]
    ds_read_b128 v[108:111], v12 offset:10240
    v_mfma_f32_16x16x32_bf16 v[228:231], v[112:115], a[20:23], v[228:231]
    buffer_load_dwordx4 v1, s[56:59], s21 offen offset:2048 sc1 lds
    v_mfma_f32_16x16x32_bf16 v[228:231], v[116:119], a[28:31], v[228:231]
    ds_read_b128 v[112:115], v12 offset:18432
    ds_read_b128 v[116:119], v12 offset:26624
    v_mfma_f32_16x16x32_bf16 v[176:179], v[120:123], a[32:35], v[176:179]
    v_mfma_f32_16x16x32_bf16 v[176:179], v[124:127], a[40:43], v[176:179]
    v_mfma_f32_16x16x32_bf16 v[176:179], v[128:131], a[48:51], v[176:179]
    buffer_load_dwordx4 a[100:103], v5, s[40:43], s20 offen offset:0 sc1
    v_mfma_f32_16x16x32_bf16 v[176:179], v[132:135], a[56:59], v[176:179]
    v_mfma_f32_16x16x32_bf16 v[180:183], v[120:123], a[36:39], v[180:183]
    ds_read_b128 v[120:123], v12 offset:3072
    v_mfma_f32_16x16x32_bf16 v[180:183], v[124:127], a[44:47], v[180:183]
    ds_read_b128 v[124:127], v12 offset:11264
    v_mfma_f32_16x16x32_bf16 v[180:183], v[128:131], a[52:55], v[180:183]
    ds_read_b128 v[128:131], v12 offset:19456
    v_mfma_f32_16x16x32_bf16 v[180:183], v[132:135], a[60:63], v[180:183]
    s_waitcnt lgkmcnt(3)
    buffer_load_dwordx4 a[108:111], v5, s[40:43], s20 offen offset:1024 sc1
    v_mfma_f32_16x16x32_bf16 v[184:187], v[136:139], a[32:35], v[184:187]
    ds_read_b128 v[132:135], v12 offset:27648
    v_mfma_f32_16x16x32_bf16 v[184:187], v[140:143], a[40:43], v[184:187]
    v_mfma_f32_16x16x32_bf16 v[184:187], v[144:147], a[48:51], v[184:187]
    v_mfma_f32_16x16x32_bf16 v[184:187], v[148:151], a[56:59], v[184:187]
    buffer_load_dwordx4 a[116:119], v5, s[40:43], s20 offen offset:2048 sc1
    v_mfma_f32_16x16x32_bf16 v[188:191], v[136:139], a[36:39], v[188:191]
    ds_read_b128 v[136:139], v12 offset:4096
    v_mfma_f32_16x16x32_bf16 v[188:191], v[140:143], a[44:47], v[188:191]
    ds_read_b128 v[140:143], v12 offset:12288
    v_mfma_f32_16x16x32_bf16 v[188:191], v[144:147], a[52:55], v[188:191]
    ds_read_b128 v[144:147], v12 offset:20480
    v_mfma_f32_16x16x32_bf16 v[188:191], v[148:151], a[60:63], v[188:191]
    buffer_load_dwordx4 a[124:127], v5, s[40:43], s20 offen offset:3072 sc1
    v_mfma_f32_16x16x32_bf16 v[192:195], v[104:107], a[32:35], v[192:195]
    s_xor_b32 s21, s3, 4
    ds_read_b128 v[148:151], v12 offset:28672
    v_mfma_f32_16x16x32_bf16 v[192:195], v[108:111], a[40:43], v[192:195]
    s_lshl2_add_u32 s21, s21, s4
    v_mfma_f32_16x16x32_bf16 v[192:195], v[112:115], a[48:51], v[192:195]
    s_mul_i32 s21, s21, 36864
    v_mfma_f32_16x16x32_bf16 v[192:195], v[116:119], a[56:59], v[192:195]
    s_add_u32 s21, s21, s28
    s_mov_b32 m0, s79
    v_mfma_f32_16x16x32_bf16 v[196:199], v[104:107], a[36:39], v[196:199]
    s_xor_b32 s20, s20, 28672
    buffer_load_dwordx4 v1, s[56:59], s21 offen sc1 lds
    v_mfma_f32_16x16x32_bf16 v[196:199], v[108:111], a[44:47], v[196:199]
    ds_read_b128 v[104:107], v12 offset:5120
    ds_read_b128 v[108:111], v12 offset:13312
    v_mfma_f32_16x16x32_bf16 v[196:199], v[112:115], a[52:55], v[196:199]
    ds_read_b128 v[112:115], v12 offset:21504
    v_mfma_f32_16x16x32_bf16 v[196:199], v[116:119], a[60:63], v[196:199]
    s_waitcnt lgkmcnt(3)
    buffer_load_dwordx4 v1, s[56:59], s21 offen offset:1024 sc1 lds
    v_mfma_f32_16x16x32_bf16 v[200:203], v[120:123], a[32:35], v[200:203]
    ds_read_b128 v[116:119], v12 offset:29696
    v_mfma_f32_16x16x32_bf16 v[200:203], v[124:127], a[40:43], v[200:203]
    v_mfma_f32_16x16x32_bf16 v[200:203], v[128:131], a[48:51], v[200:203]
    v_mfma_f32_16x16x32_bf16 v[200:203], v[132:135], a[56:59], v[200:203]
    v_mfma_f32_16x16x32_bf16 v[204:207], v[120:123], a[36:39], v[204:207]
    buffer_load_dwordx4 v1, s[56:59], s21 offen offset:2048 sc1 lds
    v_mfma_f32_16x16x32_bf16 v[204:207], v[124:127], a[44:47], v[204:207]
    ds_read_b128 v[120:123], v12 offset:6144
    ds_read_b128 v[124:127], v12 offset:14336
    v_mfma_f32_16x16x32_bf16 v[204:207], v[128:131], a[52:55], v[204:207]
    ds_read_b128 v[128:131], v12 offset:22528
    v_mfma_f32_16x16x32_bf16 v[204:207], v[132:135], a[60:63], v[204:207]
    ds_read_b128 v[132:135], v12 offset:30720
    v_mfma_f32_16x16x32_bf16 v[208:211], v[136:139], a[32:35], v[208:211]
    buffer_load_dwordx4 v1, s[56:59], s21 offen offset:3072 sc1 lds
    v_mfma_f32_16x16x32_bf16 v[208:211], v[140:143], a[40:43], v[208:211]
    s_add_u32 s21, s21, 4096
    v_mfma_f32_16x16x32_bf16 v[208:211], v[144:147], a[48:51], v[208:211]
    s_add_u32 m0, s79, 4096
    v_mfma_f32_16x16x32_bf16 v[208:211], v[148:151], a[56:59], v[208:211]
    v_mfma_f32_16x16x32_bf16 v[212:215], v[136:139], a[36:39], v[212:215]
    buffer_load_dwordx4 v1, s[56:59], s21 offen sc1 lds
    v_mfma_f32_16x16x32_bf16 v[212:215], v[140:143], a[44:47], v[212:215]
    ds_read_b128 v[136:139], v13 offset:0
    ds_read_b128 v[140:143], v13 offset:8192
    v_mfma_f32_16x16x32_bf16 v[212:215], v[144:147], a[52:55], v[212:215]
    ds_read_b128 v[144:147], v13 offset:16384
    v_mfma_f32_16x16x32_bf16 v[212:215], v[148:151], a[60:63], v[212:215]
    s_waitcnt lgkmcnt(3)
    ds_read_b128 v[148:151], v13 offset:24576
    v_mfma_f32_16x16x32_bf16 v[216:219], v[104:107], a[32:35], v[216:219]
    buffer_load_dwordx4 v1, s[56:59], s21 offen offset:1024 sc1 lds
    v_mfma_f32_16x16x32_bf16 v[216:219], v[108:111], a[40:43], v[216:219]
    v_mfma_f32_16x16x32_bf16 v[216:219], v[112:115], a[48:51], v[216:219]
    v_mfma_f32_16x16x32_bf16 v[216:219], v[116:119], a[56:59], v[216:219]
    s_waitcnt vmcnt(20)
    s_barrier
    v_mfma_f32_16x16x32_bf16 v[220:223], v[104:107], a[36:39], v[220:223]
    buffer_load_dwordx4 v1, s[56:59], s21 offen offset:2048 sc1 lds
    v_mfma_f32_16x16x32_bf16 v[220:223], v[108:111], a[44:47], v[220:223]
    ds_read_b128 v[104:107], v13 offset:1024
    ds_read_b128 v[108:111], v13 offset:9216
    v_mfma_f32_16x16x32_bf16 v[220:223], v[112:115], a[52:55], v[220:223]
    ds_read_b128 v[112:115], v13 offset:17408
    v_mfma_f32_16x16x32_bf16 v[220:223], v[116:119], a[60:63], v[220:223]
    ds_read_b128 v[116:119], v13 offset:25600
    v_mfma_f32_16x16x32_bf16 v[224:227], v[120:123], a[32:35], v[224:227]
    v_mfma_f32_16x16x32_bf16 v[224:227], v[124:127], a[40:43], v[224:227]
    buffer_load_dwordx4 a[132:135], v5, s[40:43], s20 offen offset:0 sc1
    v_mfma_f32_16x16x32_bf16 v[224:227], v[128:131], a[48:51], v[224:227]
    v_mfma_f32_16x16x32_bf16 v[224:227], v[132:135], a[56:59], v[224:227]
    v_mfma_f32_16x16x32_bf16 v[228:231], v[120:123], a[36:39], v[228:231]
    ds_read_b128 v[120:123], v13 offset:2048
    v_mfma_f32_16x16x32_bf16 v[228:231], v[124:127], a[44:47], v[228:231]
    buffer_load_dwordx4 a[140:143], v5, s[40:43], s20 offen offset:1024 sc1
    v_mfma_f32_16x16x32_bf16 v[228:231], v[128:131], a[52:55], v[228:231]
    ds_read_b128 v[124:127], v13 offset:10240
    ds_read_b128 v[128:131], v13 offset:18432
    v_mfma_f32_16x16x32_bf16 v[228:231], v[132:135], a[60:63], v[228:231]
    s_waitcnt lgkmcnt(3)
    ds_read_b128 v[132:135], v13 offset:26624
    v_mfma_f32_16x16x32_bf16 v[176:179], v[136:139], a[64:67], v[176:179]
    v_mfma_f32_16x16x32_bf16 v[176:179], v[140:143], a[72:75], v[176:179]
    buffer_load_dwordx4 a[148:151], v5, s[40:43], s20 offen offset:2048 sc1
    v_mfma_f32_16x16x32_bf16 v[176:179], v[144:147], a[80:83], v[176:179]
    v_mfma_f32_16x16x32_bf16 v[176:179], v[148:151], a[88:91], v[176:179]
    v_mfma_f32_16x16x32_bf16 v[180:183], v[136:139], a[68:71], v[180:183]
    ds_read_b128 v[136:139], v13 offset:3072
    v_mfma_f32_16x16x32_bf16 v[180:183], v[140:143], a[76:79], v[180:183]
    buffer_load_dwordx4 a[156:159], v5, s[40:43], s20 offen offset:3072 sc1
    v_mfma_f32_16x16x32_bf16 v[180:183], v[144:147], a[84:87], v[180:183]
    s_xor_b32 s21, s3, 5
    ds_read_b128 v[140:143], v13 offset:11264
    ds_read_b128 v[144:147], v13 offset:19456
    v_mfma_f32_16x16x32_bf16 v[180:183], v[148:151], a[92:95], v[180:183]
    s_lshl2_add_u32 s21, s21, s4
    ds_read_b128 v[148:151], v13 offset:27648
    v_mfma_f32_16x16x32_bf16 v[184:187], v[104:107], a[64:67], v[184:187]
    s_mul_i32 s21, s21, 36864
    v_mfma_f32_16x16x32_bf16 v[184:187], v[108:111], a[72:75], v[184:187]
    s_add_u32 s21, s21, s28
    s_mov_b32 m0, s44
    v_mfma_f32_16x16x32_bf16 v[184:187], v[112:115], a[80:83], v[184:187]
    s_xor_b32 s20, s20, 4096
    buffer_load_dwordx4 v1, s[56:59], s21 offen sc1 lds
    v_mfma_f32_16x16x32_bf16 v[184:187], v[116:119], a[88:91], v[184:187]
    v_mfma_f32_16x16x32_bf16 v[188:191], v[104:107], a[68:71], v[188:191]
    ds_read_b128 v[104:107], v13 offset:4096
    v_mfma_f32_16x16x32_bf16 v[188:191], v[108:111], a[76:79], v[188:191]
    ds_read_b128 v[108:111], v13 offset:12288
    v_mfma_f32_16x16x32_bf16 v[188:191], v[112:115], a[84:87], v[188:191]
    buffer_load_dwordx4 v1, s[56:59], s21 offen offset:1024 sc1 lds
    v_mfma_f32_16x16x32_bf16 v[188:191], v[116:119], a[92:95], v[188:191]
    s_waitcnt lgkmcnt(2)
    ds_read_b128 v[112:115], v13 offset:20480
    ds_read_b128 v[116:119], v13 offset:28672
    v_mfma_f32_16x16x32_bf16 v[192:195], v[120:123], a[64:67], v[192:195]
    v_mfma_f32_16x16x32_bf16 v[192:195], v[124:127], a[72:75], v[192:195]
    v_mfma_f32_16x16x32_bf16 v[192:195], v[128:131], a[80:83], v[192:195]
    buffer_load_dwordx4 v1, s[56:59], s21 offen offset:2048 sc1 lds
    v_mfma_f32_16x16x32_bf16 v[192:195], v[132:135], a[88:91], v[192:195]
    v_mfma_f32_16x16x32_bf16 v[196:199], v[120:123], a[68:71], v[196:199]
    ds_read_b128 v[120:123], v13 offset:5120
    v_mfma_f32_16x16x32_bf16 v[196:199], v[124:127], a[76:79], v[196:199]
    ds_read_b128 v[124:127], v13 offset:13312
    v_mfma_f32_16x16x32_bf16 v[196:199], v[128:131], a[84:87], v[196:199]
    buffer_load_dwordx4 v1, s[56:59], s21 offen offset:3072 sc1 lds
    v_mfma_f32_16x16x32_bf16 v[196:199], v[132:135], a[92:95], v[196:199]
    s_add_u32 s21, s21, 4096
    ds_read_b128 v[128:131], v13 offset:21504
    ds_read_b128 v[132:135], v13 offset:29696
    v_mfma_f32_16x16x32_bf16 v[200:203], v[136:139], a[64:67], v[200:203]
    s_add_u32 m0, s44, 4096
    v_mfma_f32_16x16x32_bf16 v[200:203], v[140:143], a[72:75], v[200:203]
    v_mfma_f32_16x16x32_bf16 v[200:203], v[144:147], a[80:83], v[200:203]
    buffer_load_dwordx4 v1, s[56:59], s21 offen sc1 lds
    v_mfma_f32_16x16x32_bf16 v[200:203], v[148:151], a[88:91], v[200:203]
    v_mfma_f32_16x16x32_bf16 v[204:207], v[136:139], a[68:71], v[204:207]
    ds_read_b128 v[136:139], v13 offset:6144
    v_mfma_f32_16x16x32_bf16 v[204:207], v[140:143], a[76:79], v[204:207]
    ds_read_b128 v[140:143], v13 offset:14336
    v_mfma_f32_16x16x32_bf16 v[204:207], v[144:147], a[84:87], v[204:207]
    buffer_load_dwordx4 v1, s[56:59], s21 offen offset:1024 sc1 lds
    v_mfma_f32_16x16x32_bf16 v[204:207], v[148:151], a[92:95], v[204:207]
    s_waitcnt lgkmcnt(2)
    ds_read_b128 v[144:147], v13 offset:22528
    ds_read_b128 v[148:151], v13 offset:30720
    v_mfma_f32_16x16x32_bf16 v[208:211], v[104:107], a[64:67], v[208:211]
    v_mfma_f32_16x16x32_bf16 v[208:211], v[108:111], a[72:75], v[208:211]
    v_mfma_f32_16x16x32_bf16 v[208:211], v[112:115], a[80:83], v[208:211]
    v_mfma_f32_16x16x32_bf16 v[208:211], v[116:119], a[88:91], v[208:211]
    buffer_load_dwordx4 v1, s[56:59], s21 offen offset:2048 sc1 lds
    v_mfma_f32_16x16x32_bf16 v[212:215], v[104:107], a[68:71], v[212:215]
    v_mfma_f32_16x16x32_bf16 v[212:215], v[108:111], a[76:79], v[212:215]
    v_mfma_f32_16x16x32_bf16 v[212:215], v[112:115], a[84:87], v[212:215]
    v_mfma_f32_16x16x32_bf16 v[212:215], v[116:119], a[92:95], v[212:215]
    buffer_load_dwordx4 a[160:163], v4, s[40:43], s63 offen offset:0 sc1
    v_mfma_f32_16x16x32_bf16 v[216:219], v[120:123], a[64:67], v[216:219]
    v_mfma_f32_16x16x32_bf16 v[216:219], v[124:127], a[72:75], v[216:219]
    v_mfma_f32_16x16x32_bf16 v[216:219], v[128:131], a[80:83], v[216:219]
    v_mfma_f32_16x16x32_bf16 v[216:219], v[132:135], a[88:91], v[216:219]
    s_waitcnt vmcnt(19)
    s_barrier
    v_mov_b32 v31, 3
    v_mfma_f32_16x16x32_bf16 v[220:223], v[120:123], a[68:71], v[220:223]
    buffer_load_dwordx4 a[168:171], v4, s[40:43], s63 offen offset:1024 sc1
    v_mfma_f32_16x16x32_bf16 v[220:223], v[124:127], a[76:79], v[220:223]
    buffer_store_dword v31, v30, s[32:35], s101 offen sc1
    v_mfma_f32_16x16x32_bf16 v[220:223], v[128:131], a[84:87], v[220:223]
    ds_read_b128 v[104:107], v6 offset:0
    ds_read_b128 v[108:111], v6 offset:8192
    v_mfma_f32_16x16x32_bf16 v[220:223], v[132:135], a[92:95], v[220:223]
    s_waitcnt lgkmcnt(2)
    ds_read_b128 v[112:115], v6 offset:16384
    v_mfma_f32_16x16x32_bf16 v[224:227], v[136:139], a[64:67], v[224:227]
    buffer_load_dwordx4 a[176:179], v4, s[40:43], s63 offen offset:2048 sc1
    v_mfma_f32_16x16x32_bf16 v[224:227], v[140:143], a[72:75], v[224:227]
    ds_read_b128 v[116:119], v6 offset:24576
    ds_read_b128 v[120:123], v6 offset:1024
    v_mfma_f32_16x16x32_bf16 v[224:227], v[144:147], a[80:83], v[224:227]
    ds_read_b128 v[124:127], v6 offset:9216
    v_mfma_f32_16x16x32_bf16 v[224:227], v[148:151], a[88:91], v[224:227]
    ds_read_b128 v[128:131], v6 offset:17408
    v_mfma_f32_16x16x32_bf16 v[228:231], v[136:139], a[68:71], v[228:231]
    buffer_load_dwordx4 a[184:187], v4, s[40:43], s63 offen offset:3072 sc1
    v_mfma_f32_16x16x32_bf16 v[228:231], v[140:143], a[76:79], v[228:231]
    s_xor_b32 s63, s63, 12288
    ds_read_b128 v[132:135], v6 offset:25600
    ds_read_b128 v[136:139], v6 offset:2048
    v_mfma_f32_16x16x32_bf16 v[228:231], v[144:147], a[84:87], v[228:231]
    ds_read_b128 v[140:143], v6 offset:10240
    v_mfma_f32_16x16x32_bf16 v[228:231], v[148:151], a[92:95], v[228:231]
    s_waitcnt lgkmcnt(4)
    ds_read_b128 v[144:147], v6 offset:18432
    v_mfma_f32_16x16x32_bf16 v[176:179], v[104:107], a[96:99], v[176:179]
    buffer_load_dwordx4 a[164:167], v5, s[40:43], s20 offen offset:0 sc1
    v_mfma_f32_16x16x32_bf16 v[176:179], v[108:111], a[104:107], v[176:179]
    ds_read_b128 v[148:151], v6 offset:26624
    v_mfma_f32_16x16x32_bf16 v[176:179], v[112:115], a[112:115], v[176:179]
    v_mfma_f32_16x16x32_bf16 v[176:179], v[116:119], a[120:123], v[176:179]
    v_mfma_f32_16x16x32_bf16 v[180:183], v[104:107], a[100:103], v[180:183]
    buffer_load_dwordx4 a[172:175], v5, s[40:43], s20 offen offset:1024 sc1
    v_mfma_f32_16x16x32_bf16 v[180:183], v[108:111], a[108:111], v[180:183]
    ds_read_b128 v[104:107], v6 offset:3072
    ds_read_b128 v[108:111], v6 offset:11264
    v_mfma_f32_16x16x32_bf16 v[180:183], v[112:115], a[116:119], v[180:183]
    ds_read_b128 v[112:115], v6 offset:19456
    v_mfma_f32_16x16x32_bf16 v[180:183], v[116:119], a[124:127], v[180:183]
    ds_read_b128 v[116:119], v6 offset:27648
    v_mfma_f32_16x16x32_bf16 v[184:187], v[120:123], a[96:99], v[184:187]
    buffer_load_dwordx4 a[180:183], v5, s[40:43], s20 offen offset:2048 sc1
    v_mfma_f32_16x16x32_bf16 v[184:187], v[124:127], a[104:107], v[184:187]
    s_waitcnt lgkmcnt(4)
    v_mfma_f32_16x16x32_bf16 v[184:187], v[128:131], a[112:115], v[184:187]
    v_mfma_f32_16x16x32_bf16 v[184:187], v[132:135], a[120:123], v[184:187]
    v_mfma_f32_16x16x32_bf16 v[188:191], v[120:123], a[100:103], v[188:191]
    buffer_load_dwordx4 a[188:191], v5, s[40:43], s20 offen offset:3072 sc1
    v_mfma_f32_16x16x32_bf16 v[188:191], v[124:127], a[108:111], v[188:191]
    s_xor_b32 s21, s3, 6
    ds_read_b128 v[120:123], v6 offset:4096
    ds_read_b128 v[124:127], v6 offset:12288
    v_mfma_f32_16x16x32_bf16 v[188:191], v[128:131], a[116:119], v[188:191]
    s_lshl2_add_u32 s21, s21, s4
    ds_read_b128 v[128:131], v6 offset:20480
    v_mfma_f32_16x16x32_bf16 v[188:191], v[132:135], a[124:127], v[188:191]
    s_mul_i32 s21, s21, 36864
    ds_read_b128 v[132:135], v6 offset:28672
    v_mfma_f32_16x16x32_bf16 v[192:195], v[136:139], a[96:99], v[192:195]
    s_add_u32 s21, s21, s28
    s_mov_b32 m0, s45
    v_mfma_f32_16x16x32_bf16 v[192:195], v[140:143], a[104:107], v[192:195]
    s_xor_b32 s20, s20, 12288
    buffer_load_dwordx4 v1, s[56:59], s21 offen sc1 lds
    v_mfma_f32_16x16x32_bf16 v[192:195], v[144:147], a[112:115], v[192:195]
    v_mfma_f32_16x16x32_bf16 v[192:195], v[148:151], a[120:123], v[192:195]
    v_mfma_f32_16x16x32_bf16 v[196:199], v[136:139], a[100:103], v[196:199]
    buffer_load_dwordx4 v1, s[56:59], s21 offen offset:1024 sc1 lds
    v_mfma_f32_16x16x32_bf16 v[196:199], v[140:143], a[108:111], v[196:199]
    ds_read_b128 v[136:139], v6 offset:5120
    ds_read_b128 v[140:143], v6 offset:13312
    v_mfma_f32_16x16x32_bf16 v[196:199], v[144:147], a[116:119], v[196:199]
    ds_read_b128 v[144:147], v6 offset:21504
    v_mfma_f32_16x16x32_bf16 v[196:199], v[148:151], a[124:127], v[196:199]
    s_waitcnt lgkmcnt(3)
    ds_read_b128 v[148:151], v6 offset:29696
    v_mfma_f32_16x16x32_bf16 v[200:203], v[104:107], a[96:99], v[200:203]
    v_mfma_f32_16x16x32_bf16 v[200:203], v[108:111], a[104:107], v[200:203]
    buffer_load_dwordx4 v1, s[56:59], s21 offen offset:2048 sc1 lds
    v_mfma_f32_16x16x32_bf16 v[200:203], v[112:115], a[112:115], v[200:203]
    v_mfma_f32_16x16x32_bf16 v[200:203], v[116:119], a[120:123], v[200:203]
    v_mfma_f32_16x16x32_bf16 v[204:207], v[104:107], a[100:103], v[204:207]
    ds_read_b128 v[104:107], v6 offset:6144
    v_mfma_f32_16x16x32_bf16 v[204:207], v[108:111], a[108:111], v[204:207]
    buffer_load_dwordx4 v1, s[56:59], s21 offen offset:3072 sc1 lds
    v_mfma_f32_16x16x32_bf16 v[204:207], v[112:115], a[116:119], v[204:207]
    s_add_u32 s21, s21, 4096
    ds_read_b128 v[108:111], v6 offset:14336
    ds_read_b128 v[112:115], v6 offset:22528
    v_mfma_f32_16x16x32_bf16 v[204:207], v[116:119], a[124:127], v[204:207]
    s_add_u32 m0, s45, 4096
    ds_read_b128 v[116:119], v6 offset:30720
    v_mfma_f32_16x16x32_bf16 v[208:211], v[120:123], a[96:99], v[208:211]
    v_mfma_f32_16x16x32_bf16 v[208:211], v[124:127], a[104:107], v[208:211]
    buffer_load_dwordx4 v1, s[56:59], s21 offen sc1 lds
    v_mfma_f32_16x16x32_bf16 v[208:211], v[128:131], a[112:115], v[208:211]
    v_mfma_f32_16x16x32_bf16 v[208:211], v[132:135], a[120:123], v[208:211]
    v_mfma_f32_16x16x32_bf16 v[212:215], v[120:123], a[100:103], v[212:215]
    v_mfma_f32_16x16x32_bf16 v[212:215], v[124:127], a[108:111], v[212:215]
    buffer_load_dwordx4 v1, s[56:59], s21 offen offset:1024 sc1 lds
    v_mfma_f32_16x16x32_bf16 v[212:215], v[128:131], a[116:119], v[212:215]
    v_mfma_f32_16x16x32_bf16 v[212:215], v[132:135], a[124:127], v[212:215]
    s_waitcnt lgkmcnt(0)
    v_mfma_f32_16x16x32_bf16 v[216:219], v[136:139], a[96:99], v[216:219]
    v_mfma_f32_16x16x32_bf16 v[216:219], v[140:143], a[104:107], v[216:219]
    buffer_load_dwordx4 v1, s[56:59], s21 offen offset:2048 sc1 lds
    v_mfma_f32_16x16x32_bf16 v[216:219], v[144:147], a[112:115], v[216:219]
    v_mfma_f32_16x16x32_bf16 v[216:219], v[148:151], a[120:123], v[216:219]
    s_waitcnt vmcnt(23)
    s_barrier
    ds_read_b128 v[120:123], v7 offset:0
    v_mfma_f32_16x16x32_bf16 v[220:223], v[136:139], a[100:103], v[220:223]
    ds_read_b128 v[124:127], v7 offset:8192
    ds_read_b128 v[128:131], v7 offset:16384
    v_mfma_f32_16x16x32_bf16 v[220:223], v[140:143], a[108:111], v[220:223]
    ds_read_b128 v[132:135], v7 offset:24576
    v_mfma_f32_16x16x32_bf16 v[220:223], v[144:147], a[116:119], v[220:223]
    buffer_load_dwordx4 a[192:195], v4, s[40:43], s63 offen offset:0 sc1
    v_mfma_f32_16x16x32_bf16 v[220:223], v[148:151], a[124:127], v[220:223]
    ds_read_b128 v[136:139], v7 offset:1024
    ds_read_b128 v[140:143], v7 offset:9216
    v_mfma_f32_16x16x32_bf16 v[224:227], v[104:107], a[96:99], v[224:227]
    ds_read_b128 v[144:147], v7 offset:17408
    v_mfma_f32_16x16x32_bf16 v[224:227], v[108:111], a[104:107], v[224:227]
    ds_read_b128 v[148:151], v7 offset:25600
    v_mfma_f32_16x16x32_bf16 v[224:227], v[112:115], a[112:115], v[224:227]
    buffer_load_dwordx4 a[200:203], v4, s[40:43], s63 offen offset:1024 sc1
    v_mfma_f32_16x16x32_bf16 v[224:227], v[116:119], a[120:123], v[224:227]
    v_mfma_f32_16x16x32_bf16 v[228:231], v[104:107], a[100:103], v[228:231]
    ds_read_b128 v[104:107], v7 offset:2048
    v_mfma_f32_16x16x32_bf16 v[228:231], v[108:111], a[108:111], v[228:231]
    ds_read_b128 v[108:111], v7 offset:10240
    v_mfma_f32_16x16x32_bf16 v[228:231], v[112:115], a[116:119], v[228:231]
    buffer_load_dwordx4 a[208:211], v4, s[40:43], s63 offen offset:2048 sc1
    v_mfma_f32_16x16x32_bf16 v[228:231], v[116:119], a[124:127], v[228:231]
    s_waitcnt lgkmcnt(2)
    ds_read_b128 v[112:115], v7 offset:18432
    ds_read_b128 v[116:119], v7 offset:26624
    v_mfma_f32_16x16x32_bf16 v[176:179], v[120:123], a[128:131], v[176:179]
    v_mfma_f32_16x16x32_bf16 v[176:179], v[124:127], a[136:139], v[176:179]
    v_mfma_f32_16x16x32_bf16 v[176:179], v[128:131], a[144:147], v[176:179]
    buffer_load_dwordx4 a[216:219], v4, s[40:43], s63 offen offset:3072 sc1
    v_mfma_f32_16x16x32_bf16 v[176:179], v[132:135], a[152:155], v[176:179]
    s_xor_b32 s63, s63, 4096
    v_mfma_f32_16x16x32_bf16 v[180:183], v[120:123], a[132:135], v[180:183]
    ds_read_b128 v[120:123], v7 offset:3072
    v_mfma_f32_16x16x32_bf16 v[180:183], v[124:127], a[140:143], v[180:183]
    ds_read_b128 v[124:127], v7 offset:11264
    v_mfma_f32_16x16x32_bf16 v[180:183], v[128:131], a[148:151], v[180:183]
    buffer_load_dwordx4 a[196:199], v5, s[40:43], s20 offen offset:0 sc1
    v_mfma_f32_16x16x32_bf16 v[180:183], v[132:135], a[156:159], v[180:183]
    ds_read_b128 v[128:131], v7 offset:19456
    ds_read_b128 v[132:135], v7 offset:27648
    v_mfma_f32_16x16x32_bf16 v[184:187], v[136:139], a[128:131], v[184:187]
    v_mfma_f32_16x16x32_bf16 v[184:187], v[140:143], a[136:139], v[184:187]
    v_mfma_f32_16x16x32_bf16 v[184:187], v[144:147], a[144:147], v[184:187]
    v_mfma_f32_16x16x32_bf16 v[184:187], v[148:151], a[152:155], v[184:187]
    buffer_load_dwordx4 a[204:207], v5, s[40:43], s20 offen offset:1024 sc1
    v_mfma_f32_16x16x32_bf16 v[188:191], v[136:139], a[132:135], v[188:191]
    ds_read_b128 v[136:139], v7 offset:4096
    v_mfma_f32_16x16x32_bf16 v[188:191], v[140:143], a[140:143], v[188:191]
    ds_read_b128 v[140:143], v7 offset:12288
    v_mfma_f32_16x16x32_bf16 v[188:191], v[144:147], a[148:151], v[188:191]
    ds_read_b128 v[144:147], v7 offset:20480
    v_mfma_f32_16x16x32_bf16 v[188:191], v[148:151], a[156:159], v[188:191]
    s_waitcnt lgkmcnt(3)
    buffer_load_dwordx4 a[212:215], v5, s[40:43], s20 offen offset:2048 sc1
    v_mfma_f32_16x16x32_bf16 v[192:195], v[104:107], a[128:131], v[192:195]
    ds_read_b128 v[148:151], v7 offset:28672
    v_mfma_f32_16x16x32_bf16 v[192:195], v[108:111], a[136:139], v[192:195]
    v_mfma_f32_16x16x32_bf16 v[192:195], v[112:115], a[144:147], v[192:195]
    v_mfma_f32_16x16x32_bf16 v[192:195], v[116:119], a[152:155], v[192:195]
    buffer_load_dwordx4 a[220:223], v5, s[40:43], s20 offen offset:3072 sc1
    v_mfma_f32_16x16x32_bf16 v[196:199], v[104:107], a[132:135], v[196:199]
    s_xor_b32 s21, s3, 7
    ds_read_b128 v[104:107], v7 offset:5120
    v_mfma_f32_16x16x32_bf16 v[196:199], v[108:111], a[140:143], v[196:199]
    s_lshl2_add_u32 s21, s21, s4
    ds_read_b128 v[108:111], v7 offset:13312
    v_mfma_f32_16x16x32_bf16 v[196:199], v[112:115], a[148:151], v[196:199]
    s_mul_i32 s21, s21, 36864
    ds_read_b128 v[112:115], v7 offset:21504
    v_mfma_f32_16x16x32_bf16 v[196:199], v[116:119], a[156:159], v[196:199]
    s_add_u32 s21, s21, s28
    s_mov_b32 m0, s46
    ds_read_b128 v[116:119], v7 offset:29696
    v_mfma_f32_16x16x32_bf16 v[200:203], v[120:123], a[128:131], v[200:203]
    s_xor_b32 s20, s20, 4096
    buffer_load_dwordx4 v1, s[56:59], s21 offen sc1 lds
    v_mfma_f32_16x16x32_bf16 v[200:203], v[124:127], a[136:139], v[200:203]
    v_mfma_f32_16x16x32_bf16 v[200:203], v[128:131], a[144:147], v[200:203]
    v_mfma_f32_16x16x32_bf16 v[200:203], v[132:135], a[152:155], v[200:203]
    buffer_load_dwordx4 v1, s[56:59], s21 offen offset:1024 sc1 lds
    v_mfma_f32_16x16x32_bf16 v[204:207], v[120:123], a[132:135], v[204:207]
    ds_read_b128 v[120:123], v7 offset:6144
    v_mfma_f32_16x16x32_bf16 v[204:207], v[124:127], a[140:143], v[204:207]
    ds_read_b128 v[124:127], v7 offset:14336
    v_mfma_f32_16x16x32_bf16 v[204:207], v[128:131], a[148:151], v[204:207]
    buffer_load_dword v3, v19, s[32:35], s66 offen sc1
    v_mfma_f32_16x16x32_bf16 v[204:207], v[132:135], a[156:159], v[204:207]
    s_waitcnt lgkmcnt(2)
    ds_read_b128 v[128:131], v7 offset:22528
    ds_read_b128 v[132:135], v7 offset:30720
    v_mfma_f32_16x16x32_bf16 v[208:211], v[136:139], a[128:131], v[208:211]
    buffer_load_dwordx4 v1, s[56:59], s21 offen offset:2048 sc1 lds
    v_mfma_f32_16x16x32_bf16 v[208:211], v[140:143], a[136:139], v[208:211]
    v_mfma_f32_16x16x32_bf16 v[208:211], v[144:147], a[144:147], v[208:211]
    v_mfma_f32_16x16x32_bf16 v[208:211], v[148:151], a[152:155], v[208:211]
    v_mfma_f32_16x16x32_bf16 v[212:215], v[136:139], a[132:135], v[212:215]
    buffer_load_dwordx4 v1, s[56:59], s21 offen offset:3072 sc1 lds
    v_mfma_f32_16x16x32_bf16 v[212:215], v[140:143], a[140:143], v[212:215]
    s_add_u32 s21, s21, 4096
    v_mfma_f32_16x16x32_bf16 v[212:215], v[144:147], a[148:151], v[212:215]
    s_add_u32 m0, s46, 4096
    v_mfma_f32_16x16x32_bf16 v[212:215], v[148:151], a[156:159], v[212:215]
    v_mfma_f32_16x16x32_bf16 v[216:219], v[104:107], a[128:131], v[216:219]
    buffer_load_dwordx4 v1, s[56:59], s21 offen sc1 lds
    v_mfma_f32_16x16x32_bf16 v[216:219], v[108:111], a[136:139], v[216:219]
    v_mfma_f32_16x16x32_bf16 v[216:219], v[112:115], a[144:147], v[216:219]
    v_mfma_f32_16x16x32_bf16 v[216:219], v[116:119], a[152:155], v[216:219]
    s_waitcnt vmcnt(21)
    s_barrier
    ds_read_b128 v[136:139], v11 offset:0
    v_mfma_f32_16x16x32_bf16 v[220:223], v[104:107], a[132:135], v[220:223]
    buffer_load_dwordx4 v1, s[56:59], s21 offen offset:1024 sc1 lds
    v_mfma_f32_16x16x32_bf16 v[220:223], v[108:111], a[140:143], v[220:223]
    ds_read_b128 v[140:143], v11 offset:8192
    ds_read_b128 v[144:147], v11 offset:16384
    v_mfma_f32_16x16x32_bf16 v[220:223], v[112:115], a[148:151], v[220:223]
    ds_read_b128 v[148:151], v11 offset:24576
    v_mfma_f32_16x16x32_bf16 v[220:223], v[116:119], a[156:159], v[220:223]
    s_waitcnt lgkmcnt(4)
    ds_read_b128 v[104:107], v11 offset:1024
    v_mfma_f32_16x16x32_bf16 v[224:227], v[120:123], a[128:131], v[224:227]
    buffer_load_dwordx4 v1, s[56:59], s21 offen offset:2048 sc1 lds
    v_mfma_f32_16x16x32_bf16 v[224:227], v[124:127], a[136:139], v[224:227]
    ds_read_b128 v[108:111], v11 offset:9216
    ds_read_b128 v[112:115], v11 offset:17408
    v_mfma_f32_16x16x32_bf16 v[224:227], v[128:131], a[144:147], v[224:227]
    ds_read_b128 v[116:119], v11 offset:25600
    v_mfma_f32_16x16x32_bf16 v[224:227], v[132:135], a[152:155], v[224:227]
    v_mfma_f32_16x16x32_bf16 v[228:231], v[120:123], a[132:135], v[228:231]
    ds_read_b128 v[120:123], v11 offset:2048
    v_mfma_f32_16x16x32_bf16 v[228:231], v[124:127], a[140:143], v[228:231]
    buffer_load_dwordx4 a[224:227], v4, s[40:43], s63 offen offset:0 sc1
    v_mfma_f32_16x16x32_bf16 v[228:231], v[128:131], a[148:151], v[228:231]
    ds_read_b128 v[124:127], v11 offset:10240
    ds_read_b128 v[128:131], v11 offset:18432
    v_mfma_f32_16x16x32_bf16 v[228:231], v[132:135], a[156:159], v[228:231]
    s_waitcnt lgkmcnt(3)
    ds_read_b128 v[132:135], v11 offset:26624
    v_mfma_f32_16x16x32_bf16 v[176:179], v[136:139], a[160:163], v[176:179]
    v_mfma_f32_16x16x32_bf16 v[176:179], v[140:143], a[168:171], v[176:179]
    buffer_load_dwordx4 a[232:235], v4, s[40:43], s63 offen offset:1024 sc1
    v_mfma_f32_16x16x32_bf16 v[176:179], v[144:147], a[176:179], v[176:179]
    v_mfma_f32_16x16x32_bf16 v[176:179], v[148:151], a[184:187], v[176:179]
    v_mfma_f32_16x16x32_bf16 v[180:183], v[136:139], a[164:167], v[180:183]
    ds_read_b128 v[136:139], v11 offset:3072
    v_mfma_f32_16x16x32_bf16 v[180:183], v[140:143], a[172:175], v[180:183]
    buffer_load_dwordx4 a[240:243], v4, s[40:43], s63 offen offset:2048 sc1
    v_mfma_f32_16x16x32_bf16 v[180:183], v[144:147], a[180:183], v[180:183]
    ds_read_b128 v[140:143], v11 offset:11264
    ds_read_b128 v[144:147], v11 offset:19456
    v_mfma_f32_16x16x32_bf16 v[180:183], v[148:151], a[188:191], v[180:183]
    ds_read_b128 v[148:151], v11 offset:27648
    v_mfma_f32_16x16x32_bf16 v[184:187], v[104:107], a[160:163], v[184:187]
    v_mfma_f32_16x16x32_bf16 v[184:187], v[108:111], a[168:171], v[184:187]
    buffer_load_dwordx4 a[248:251], v4, s[40:43], s63 offen offset:3072 sc1
    v_mfma_f32_16x16x32_bf16 v[184:187], v[112:115], a[176:179], v[184:187]
    s_sub_u32 s63, s63, 4096
    v_mfma_f32_16x16x32_bf16 v[184:187], v[116:119], a[184:187], v[184:187]
    v_mfma_f32_16x16x32_bf16 v[188:191], v[104:107], a[164:167], v[188:191]
    ds_read_b128 v[104:107], v11 offset:4096
    v_mfma_f32_16x16x32_bf16 v[188:191], v[108:111], a[172:175], v[188:191]
    buffer_load_dwordx4 a[228:231], v5, s[40:43], s20 offen offset:0 sc1
    v_mfma_f32_16x16x32_bf16 v[188:191], v[112:115], a[180:183], v[188:191]
    ds_read_b128 v[108:111], v11 offset:12288
    ds_read_b128 v[112:115], v11 offset:20480
    v_mfma_f32_16x16x32_bf16 v[188:191], v[116:119], a[188:191], v[188:191]
    s_waitcnt lgkmcnt(3)
    ds_read_b128 v[116:119], v11 offset:28672
    v_mfma_f32_16x16x32_bf16 v[192:195], v[120:123], a[160:163], v[192:195]
    v_mfma_f32_16x16x32_bf16 v[192:195], v[124:127], a[168:171], v[192:195]
    v_mfma_f32_16x16x32_bf16 v[192:195], v[128:131], a[176:179], v[192:195]
    buffer_load_dwordx4 a[236:239], v5, s[40:43], s20 offen offset:1024 sc1
    v_mfma_f32_16x16x32_bf16 v[192:195], v[132:135], a[184:187], v[192:195]
    v_mfma_f32_16x16x32_bf16 v[196:199], v[120:123], a[164:167], v[196:199]
    ds_read_b128 v[120:123], v11 offset:5120
    v_mfma_f32_16x16x32_bf16 v[196:199], v[124:127], a[172:175], v[196:199]
    ds_read_b128 v[124:127], v11 offset:13312
    v_mfma_f32_16x16x32_bf16 v[196:199], v[128:131], a[180:183], v[196:199]
    buffer_load_dwordx4 a[244:247], v5, s[40:43], s20 offen offset:2048 sc1
    v_mfma_f32_16x16x32_bf16 v[196:199], v[132:135], a[188:191], v[196:199]
    ds_read_b128 v[128:131], v11 offset:21504
    ds_read_b128 v[132:135], v11 offset:29696
    v_mfma_f32_16x16x32_bf16 v[200:203], v[136:139], a[160:163], v[200:203]
    v_mfma_f32_16x16x32_bf16 v[200:203], v[140:143], a[168:171], v[200:203]
    v_mfma_f32_16x16x32_bf16 v[200:203], v[144:147], a[176:179], v[200:203]
    buffer_load_dwordx4 a[252:255], v5, s[40:43], s20 offen offset:3072 sc1
    v_mfma_f32_16x16x32_bf16 v[200:203], v[148:151], a[184:187], v[200:203]
    s_mul_i32 s21, s61, 6
    s_add_u32 s21, s21, 132
    v_mfma_f32_16x16x32_bf16 v[204:207], v[136:139], a[164:167], v[204:207]
    s_mul_i32 s21, s21, 36864
    ds_read_b128 v[136:139], v11 offset:6144
    v_mfma_f32_16x16x32_bf16 v[204:207], v[140:143], a[172:175], v[204:207]
    s_add_u32 s21, s21, s28
    ds_read_b128 v[140:143], v11 offset:14336
    v_mfma_f32_16x16x32_bf16 v[204:207], v[144:147], a[180:183], v[204:207]
    s_add_u32 s21, s21, s67
    s_mov_b32 m0, s47
    ds_read_b128 v[144:147], v11 offset:22528
    v_mfma_f32_16x16x32_bf16 v[204:207], v[148:151], a[188:191], v[204:207]
    s_sub_u32 s20, s20, 4096
    buffer_load_dwordx4 v1, s[56:59], s21 offen sc1 lds
    s_waitcnt lgkmcnt(3)
    v_mfma_f32_16x16x32_bf16 v[208:211], v[104:107], a[160:163], v[208:211]
    ds_read_b128 v[148:151], v11 offset:30720
    v_mfma_f32_16x16x32_bf16 v[208:211], v[108:111], a[168:171], v[208:211]
    v_mfma_f32_16x16x32_bf16 v[208:211], v[112:115], a[176:179], v[208:211]
    buffer_load_dwordx4 v1, s[56:59], s21 offen offset:1024 sc1 lds
    v_mfma_f32_16x16x32_bf16 v[208:211], v[116:119], a[184:187], v[208:211]
    v_mfma_f32_16x16x32_bf16 v[212:215], v[104:107], a[164:167], v[212:215]
    v_mfma_f32_16x16x32_bf16 v[212:215], v[108:111], a[172:175], v[212:215]
    v_mfma_f32_16x16x32_bf16 v[212:215], v[112:115], a[180:183], v[212:215]
    v_mfma_f32_16x16x32_bf16 v[212:215], v[116:119], a[188:191], v[212:215]
    v_mfma_f32_16x16x32_bf16 v[216:219], v[120:123], a[160:163], v[216:219]
    v_mfma_f32_16x16x32_bf16 v[216:219], v[124:127], a[168:171], v[216:219]
    s_mul_i32 s63, s61, 6144
    v_mfma_f32_16x16x32_bf16 v[216:219], v[128:131], a[176:179], v[216:219]
    s_add_u32 s63, s63, 135168
    v_mfma_f32_16x16x32_bf16 v[216:219], v[132:135], a[184:187], v[216:219]
    s_waitcnt vmcnt(15)
    v_cmp_gt_u32 vcc, 3, v3
    s_nop 1
    s_and_b64 vcc, vcc, exec
    s_cbranch_scc1 SPIN_OA
BACK_OA:
    s_barrier
    v_mfma_f32_16x16x32_bf16 v[220:223], v[120:123], a[164:167], v[220:223]
    buffer_load_dwordx4 v[64:67], v4, s[40:43], s63 offen offset:0 sc1
    v_mfma_f32_16x16x32_bf16 v[220:223], v[124:127], a[172:175], v[220:223]
    ds_read_b128 v[104:107], v12 offset:0
    ds_read_b128 v[108:111], v12 offset:8192
    v_mfma_f32_16x16x32_bf16 v[220:223], v[128:131], a[180:183], v[220:223]
    ds_read_b128 v[112:115], v12 offset:16384
    v_mfma_f32_16x16x32_bf16 v[220:223], v[132:135], a[188:191], v[220:223]
    s_waitcnt lgkmcnt(3)
    ds_read_b128 v[116:119], v12 offset:24576
    v_mfma_f32_16x16x32_bf16 v[224:227], v[136:139], a[160:163], v[224:227]
    buffer_load_dwordx4 v[68:71], v4, s[40:43], s63 offen offset:1024 sc1
    v_mfma_f32_16x16x32_bf16 v[224:227], v[140:143], a[168:171], v[224:227]
    s_mul_i32 s20, s61, 6144
    ds_read_b128 v[120:123], v12 offset:1024
    ds_read_b128 v[124:127], v12 offset:9216
    v_mfma_f32_16x16x32_bf16 v[224:227], v[144:147], a[176:179], v[224:227]
    s_add_u32 s20, s20, 135168
    ds_read_b128 v[128:131], v12 offset:17408
    v_mfma_f32_16x16x32_bf16 v[224:227], v[148:151], a[184:187], v[224:227]
    s_sub_u32 s63, s63, 4096
    ds_read_b128 v[132:135], v12 offset:25600
    v_mfma_f32_16x16x32_bf16 v[228:231], v[136:139], a[164:167], v[228:231]
    buffer_load_dwordx4 v[72:75], v5, s[40:43], s20 offen offset:0 sc1
    v_mfma_f32_16x16x32_bf16 v[228:231], v[140:143], a[172:175], v[228:231]
    ds_read_b128 v[136:139], v12 offset:2048
    ds_read_b128 v[140:143], v12 offset:10240
    v_mfma_f32_16x16x32_bf16 v[228:231], v[144:147], a[180:183], v[228:231]
    ds_read_b128 v[144:147], v12 offset:18432
    v_mfma_f32_16x16x32_bf16 v[228:231], v[148:151], a[188:191], v[228:231]
    s_waitcnt lgkmcnt(4)
    ds_read_b128 v[148:151], v12 offset:26624
    v_mfma_f32_16x16x32_bf16 v[176:179], v[104:107], a[192:195], v[176:179]
    buffer_load_dwordx4 v[76:79], v5, s[40:43], s20 offen offset:1024 sc1
    v_mfma_f32_16x16x32_bf16 v[176:179], v[108:111], a[200:203], v[176:179]
    s_mul_i32 s21, s61, 6
    s_add_u32 s21, s4, s21
    v_mfma_f32_16x16x32_bf16 v[176:179], v[112:115], a[208:211], v[176:179]
    s_add_u32 s21, s21, 128
    v_mfma_f32_16x16x32_bf16 v[176:179], v[116:119], a[216:219], v[176:179]
    s_mul_i32 s21, s21, 36864
    v_mfma_f32_16x16x32_bf16 v[180:183], v[104:107], a[196:199], v[180:183]
    s_add_u32 s21, s21, s28
    s_mov_b32 m0, s79
    ds_read_b128 v[104:107], v12 offset:3072
    v_mfma_f32_16x16x32_bf16 v[180:183], v[108:111], a[204:207], v[180:183]
    s_sub_u32 s20, s20, 4096
    buffer_load_dwordx4 v1, s[56:59], s21 offen sc1 lds
    v_mfma_f32_16x16x32_bf16 v[180:183], v[112:115], a[212:215], v[180:183]
    ds_read_b128 v[108:111], v12 offset:11264
    ds_read_b128 v[112:115], v12 offset:19456
    v_mfma_f32_16x16x32_bf16 v[180:183], v[116:119], a[220:223], v[180:183]
    ds_read_b128 v[116:119], v12 offset:27648
    v_mfma_f32_16x16x32_bf16 v[184:187], v[120:123], a[192:195], v[184:187]
    buffer_load_dwordx4 v1, s[56:59], s21 offen offset:1024 sc1 lds
    v_mfma_f32_16x16x32_bf16 v[184:187], v[124:127], a[200:203], v[184:187]
    v_mfma_f32_16x16x32_bf16 v[184:187], v[128:131], a[208:211], v[184:187]
    s_waitcnt lgkmcnt(3)
    v_mfma_f32_16x16x32_bf16 v[184:187], v[132:135], a[216:219], v[184:187]
    v_mfma_f32_16x16x32_bf16 v[188:191], v[120:123], a[196:199], v[188:191]
    ds_read_b128 v[120:123], v12 offset:4096
    v_mfma_f32_16x16x32_bf16 v[188:191], v[124:127], a[204:207], v[188:191]
    buffer_load_dwordx4 v1, s[56:59], s21 offen offset:2048 sc1 lds
    v_mfma_f32_16x16x32_bf16 v[188:191], v[128:131], a[212:215], v[188:191]
    ds_read_b128 v[124:127], v12 offset:12288
    ds_read_b128 v[128:131], v12 offset:20480
    v_mfma_f32_16x16x32_bf16 v[188:191], v[132:135], a[220:223], v[188:191]
    ds_read_b128 v[132:135], v12 offset:28672
    v_mfma_f32_16x16x32_bf16 v[192:195], v[136:139], a[192:195], v[192:195]
    v_mfma_f32_16x16x32_bf16 v[192:195], v[140:143], a[200:203], v[192:195]
    buffer_load_dwordx4 v1, s[56:59], s21 offen offset:3072 sc1 lds
    v_mfma_f32_16x16x32_bf16 v[192:195], v[144:147], a[208:211], v[192:195]
    s_add_u32 s21, s21, 4096
    v_mfma_f32_16x16x32_bf16 v[192:195], v[148:151], a[216:219], v[192:195]
    s_add_u32 m0, s79, 4096
    v_mfma_f32_16x16x32_bf16 v[196:199], v[136:139], a[196:199], v[196:199]
    ds_read_b128 v[136:139], v12 offset:5120
    v_mfma_f32_16x16x32_bf16 v[196:199], v[140:143], a[204:207], v[196:199]
    buffer_load_dwordx4 v1, s[56:59], s21 offen sc1 lds
    v_mfma_f32_16x16x32_bf16 v[196:199], v[144:147], a[212:215], v[196:199]
    ds_read_b128 v[140:143], v12 offset:13312
    ds_read_b128 v[144:147], v12 offset:21504
    v_mfma_f32_16x16x32_bf16 v[196:199], v[148:151], a[220:223], v[196:199]
    ds_read_b128 v[148:151], v12 offset:29696
    v_mfma_f32_16x16x32_bf16 v[200:203], v[104:107], a[192:195], v[200:203]
    s_waitcnt lgkmcnt(4)
    v_mfma_f32_16x16x32_bf16 v[200:203], v[108:111], a[200:203], v[200:203]
    buffer_load_dwordx4 v1, s[56:59], s21 offen offset:1024 sc1 lds
    v_mfma_f32_16x16x32_bf16 v[200:203], v[112:115], a[208:211], v[200:203]
    v_mfma_f32_16x16x32_bf16 v[200:203], v[116:119], a[216:219], v[200:203]
    v_mfma_f32_16x16x32_bf16 v[204:207], v[104:107], a[196:199], v[204:207]
    ds_read_b128 v[104:107], v12 offset:6144
    v_mfma_f32_16x16x32_bf16 v[204:207], v[108:111], a[204:207], v[204:207]
    buffer_load_dwordx4 v1, s[56:59], s21 offen offset:2048 sc1 lds
    v_mfma_f32_16x16x32_bf16 v[204:207], v[112:115], a[212:215], v[204:207]
    ds_read_b128 v[108:111], v12 offset:14336
    ds_read_b128 v[112:115], v12 offset:22528
    v_mfma_f32_16x16x32_bf16 v[204:207], v[116:119], a[220:223], v[204:207]
    ds_read_b128 v[116:119], v12 offset:30720
    v_mfma_f32_16x16x32_bf16 v[208:211], v[120:123], a[192:195], v[208:211]
    v_mfma_f32_16x16x32_bf16 v[208:211], v[124:127], a[200:203], v[208:211]
    v_mfma_f32_16x16x32_bf16 v[208:211], v[128:131], a[208:211], v[208:211]
    buffer_load_dwordx4 v[32:35], v4, s[40:43], s63 offen offset:0 sc1
    v_mfma_f32_16x16x32_bf16 v[208:211], v[132:135], a[216:219], v[208:211]
    v_mfma_f32_16x16x32_bf16 v[212:215], v[120:123], a[196:199], v[212:215]
    v_mfma_f32_16x16x32_bf16 v[212:215], v[124:127], a[204:207], v[212:215]
    v_mfma_f32_16x16x32_bf16 v[212:215], v[128:131], a[212:215], v[212:215]
    buffer_load_dwordx4 v[40:43], v4, s[40:43], s63 offen offset:1024 sc1
    v_mfma_f32_16x16x32_bf16 v[212:215], v[132:135], a[220:223], v[212:215]
    s_waitcnt lgkmcnt(0)
    v_mfma_f32_16x16x32_bf16 v[216:219], v[136:139], a[192:195], v[216:219]
    v_mfma_f32_16x16x32_bf16 v[216:219], v[140:143], a[200:203], v[216:219]
    v_mfma_f32_16x16x32_bf16 v[216:219], v[144:147], a[208:211], v[216:219]
    s_add_u32 s23, s5, 8
    buffer_load_dwordx4 v[48:51], v4, s[40:43], s63 offen offset:2048 sc1
    v_mfma_f32_16x16x32_bf16 v[216:219], v[148:151], a[216:219], v[216:219]
    s_waitcnt vmcnt(16)
    s_barrier
    ds_read_b128 v[120:123], v13 offset:0
    v_mfma_f32_16x16x32_bf16 v[220:223], v[136:139], a[196:199], v[220:223]
    s_and_b32 s65, s5, 3
    ds_read_b128 v[124:127], v13 offset:8192
    ds_read_b128 v[128:131], v13 offset:16384
    v_mfma_f32_16x16x32_bf16 v[220:223], v[140:143], a[204:207], v[220:223]
    s_mul_i32 s70, s4, 3072
    ds_read_b128 v[132:135], v13 offset:24576
    v_lshrrev_b32 v19, 4, v1
    v_mfma_f32_16x16x32_bf16 v[220:223], v[144:147], a[212:215], v[220:223]
    s_andn2_b32 s66, s74, 0xfff
    buffer_load_dwordx4 v[56:59], v4, s[40:43], s63 offen offset:3072 sc1
    v_mfma_f32_16x16x32_bf16 v[220:223], v[148:151], a[220:223], v[220:223]
    s_sub_u32 s63, s63, 4096
    ds_read_b128 v[136:139], v13 offset:1024
    ds_read_b128 v[140:143], v13 offset:9216
    v_mfma_f32_16x16x32_bf16 v[224:227], v[104:107], a[192:195], v[224:227]
    ds_read_b128 v[144:147], v13 offset:17408
    v_min_u32 v19, 2, v19
    v_mfma_f32_16x16x32_bf16 v[224:227], v[108:111], a[200:203], v[224:227]
    ds_read_b128 v[148:151], v13 offset:25600
    v_lshl_add_u32 v19, v19, 3, s23
    v_mfma_f32_16x16x32_bf16 v[224:227], v[112:115], a[208:211], v[224:227]
    s_lshl3_add_u32 s23, s6, s62
    buffer_load_dwordx4 v[36:39], v5, s[40:43], s20 offen offset:0 sc1
    v_mfma_f32_16x16x32_bf16 v[224:227], v[116:119], a[216:219], v[224:227]
    s_lshl_b32 s23, s23, 4
    v_bfe_u32 v20, v1, 4, 4
    v_add_u32 v20, s23, v20
    v_mfma_f32_16x16x32_bf16 v[228:231], v[104:107], a[196:199], v[228:231]
    s_mul_i32 s23, s6, 294912
    ds_read_b128 v[104:107], v13 offset:2048
    v_mul_u32_u24 v20, 1152, v20
    v_mfma_f32_16x16x32_bf16 v[228:231], v[108:111], a[204:207], v[228:231]
    s_sub_u32 s23, 2211840, s23
    ds_read_b128 v[108:111], v13 offset:10240
    v_lshrrev_b32 v21, 8, v1
    v_mfma_f32_16x16x32_bf16 v[228:231], v[112:115], a[212:215], v[228:231]
    ds_read_b128 v[112:115], v13 offset:18432
    v_lshl_add_u32 v20, v21, 3, v20
    v_mfma_f32_16x16x32_bf16 v[228:231], v[116:119], a[220:223], v[228:231]
    s_waitcnt lgkmcnt(3)
    buffer_load_dwordx4 v[44:47], v5, s[40:43], s20 offen offset:1024 sc1
    v_mfma_f32_16x16x32_bf16 v[176:179], v[120:123], a[224:227], v[176:179]
    ds_read_b128 v[116:119], v13 offset:26624
    v_add_u32 v21, s23, v20
    v_mfma_f32_16x16x32_bf16 v[176:179], v[124:127], a[232:235], v[176:179]
    s_mul_i32 s23, s101, 288
    v_and_b32 v19, 31, v19
    v_mov_b32 v31, 3
    v_mfma_f32_16x16x32_bf16 v[176:179], v[128:131], a[240:243], v[176:179]
    s_add_u32 s23, s23, s70
    v_lshlrev_b32 v23, 20, v1
    v_lshlrev_b32 v19, 7, v19
    v_mfma_f32_16x16x32_bf16 v[176:179], v[132:135], a[248:251], v[176:179]
    s_add_u32 s98, s23, 0
    buffer_load_dwordx4 v[52:55], v5, s[40:43], s20 offen offset:2048 sc1
    v_mfma_f32_16x16x32_bf16 v[180:183], v[120:123], a[228:231], v[180:183]
    ds_read_b128 v[120:123], v13 offset:3072
    v_bfe_u32 v92, v1, 6, 2
    v_mfma_f32_16x16x32_bf16 v[180:183], v[124:127], a[236:239], v[180:183]
    ds_read_b128 v[124:127], v13 offset:11264
    v_lshrrev_b32 v93, 8, v1
    v_mfma_f32_16x16x32_bf16 v[180:183], v[128:131], a[244:247], v[180:183]
    ds_read_b128 v[128:131], v13 offset:19456
    v_cmp_eq_u32 vcc, v92, v93
    v_mfma_f32_16x16x32_bf16 v[180:183], v[132:135], a[252:255], v[180:183]
    buffer_load_dwordx4 v[60:63], v5, s[40:43], s20 offen offset:3072 sc1
    v_mfma_f32_16x16x32_bf16 v[184:187], v[136:139], a[224:227], v[184:187]
    s_add_u32 s21, s4, 0
    s_xor_b32 s21, s21, s3
    s_lshl_b32 s21, s21, 2
    v_mfma_f32_16x16x32_bf16 v[184:187], v[140:143], a[232:235], v[184:187]
    s_mul_i32 s21, s21, 36864
    ds_read_b128 v[132:135], v13 offset:27648
    v_and_b32 v92, 16, v1
    v_mfma_f32_16x16x32_bf16 v[184:187], v[144:147], a[240:243], v[184:187]
    s_add_u32 s21, s21, s28
    v_mov_b32 v93, 0x3f80
    v_lshlrev_b32 v92, v92, v93
    v_mfma_f32_16x16x32_bf16 v[184:187], v[148:151], a[248:251], v[184:187]
    s_add_u32 s21, s21, 7168
    s_add_u32 m0, s44, 0
    v_and_b32 v93, 32, v1
    v_mfma_f32_16x16x32_bf16 v[188:191], v[136:139], a[228:231], v[188:191]
    s_sub_u32 s20, s20, 4096
    buffer_load_dwordx4 v1, s[56:59], s21 offen sc1 lds
    v_mfma_f32_16x16x32_bf16 v[188:191], v[140:143], a[236:239], v[188:191]
    ds_read_b128 v[136:139], v13 offset:4096
    ds_read_b128 v[140:143], v13 offset:12288
    v_mfma_f32_16x16x32_bf16 v[188:191], v[144:147], a[244:247], v[188:191]
    ds_read_b128 v[144:147], v13 offset:20480
    v_cndmask_b32 v92, 0, v92, vcc
    v_mfma_f32_16x16x32_bf16 v[188:191], v[148:151], a[252:255], v[188:191]
    s_waitcnt lgkmcnt(3)
    buffer_load_dwordx4 v1, s[56:59], s21 offen offset:1024 sc1 lds
    v_mfma_f32_16x16x32_bf16 v[192:195], v[104:107], a[224:227], v[192:195]
    ds_read_b128 v[148:151], v13 offset:28672
    v_cmp_eq_u32 vcc, 0, v93
    v_mfma_f32_16x16x32_bf16 v[192:195], v[108:111], a[232:235], v[192:195]
    s_add_u32 s21, s21, 36864
    v_cndmask_b32 v96, 0, v92, vcc
    v_cndmask_b32_e64 v97, v92, 0, vcc
    v_mfma_f32_16x16x32_bf16 v[192:195], v[112:115], a[240:243], v[192:195]
    s_add_u32 m0, s44, 2048
    v_mov_b32 v98, 0
    v_mov_b32 v99, 0
    v_mfma_f32_16x16x32_bf16 v[192:195], v[116:119], a[248:251], v[192:195]
    v_mov_b32 v100, v96
    v_mov_b32 v101, v97
    v_mfma_f32_16x16x32_bf16 v[196:199], v[104:107], a[228:231], v[196:199]
    buffer_load_dwordx4 v1, s[56:59], s21 offen sc1 lds
    v_mfma_f32_16x16x32_bf16 v[196:199], v[108:111], a[236:239], v[196:199]
    ds_read_b128 v[104:107], v13 offset:5120
    ds_read_b128 v[108:111], v13 offset:13312
    v_mfma_f32_16x16x32_bf16 v[196:199], v[112:115], a[244:247], v[196:199]
    ds_read_b128 v[112:115], v13 offset:21504
    v_mfma_f32_16x16x32_bf16 v[196:199], v[116:119], a[252:255], v[196:199]
    ds_read_b128 v[116:119], v13 offset:29696
    v_mfma_f32_16x16x32_bf16 v[200:203], v[120:123], a[224:227], v[200:203]
    buffer_load_dwordx4 v1, s[56:59], s21 offen offset:1024 sc1 lds
    v_mfma_f32_16x16x32_bf16 v[200:203], v[124:127], a[232:235], v[200:203]
    s_add_u32 s21, s21, 36864
    v_mfma_f32_16x16x32_bf16 v[200:203], v[128:131], a[240:243], v[200:203]
    s_add_u32 m0, s44, 4096
    v_mfma_f32_16x16x32_bf16 v[200:203], v[132:135], a[248:251], v[200:203]
    v_mfma_f32_16x16x32_bf16 v[204:207], v[120:123], a[228:231], v[204:207]
    buffer_load_dwordx4 v1, s[56:59], s21 offen sc1 lds
    v_mfma_f32_16x16x32_bf16 v[204:207], v[124:127], a[236:239], v[204:207]
    ds_read_b128 v[120:123], v13 offset:6144
    ds_read_b128 v[124:127], v13 offset:14336
    v_mfma_f32_16x16x32_bf16 v[204:207], v[128:131], a[244:247], v[204:207]
    ds_read_b128 v[128:131], v13 offset:22528
    v_mfma_f32_16x16x32_bf16 v[204:207], v[132:135], a[252:255], v[204:207]
    s_waitcnt lgkmcnt(3)
    ds_read_b128 v[132:135], v13 offset:30720
    v_mfma_f32_16x16x32_bf16 v[208:211], v[136:139], a[224:227], v[208:211]
    buffer_load_dwordx4 v1, s[56:59], s21 offen offset:1024 sc1 lds
    v_mfma_f32_16x16x32_bf16 v[208:211], v[140:143], a[232:235], v[208:211]
    s_add_u32 s21, s21, 36864
    v_mfma_f32_16x16x32_bf16 v[208:211], v[144:147], a[240:243], v[208:211]
    s_add_u32 m0, s44, 6144
    v_mfma_f32_16x16x32_bf16 v[208:211], v[148:151], a[248:251], v[208:211]
    v_mfma_f32_16x16x32_bf16 v[212:215], v[136:139], a[228:231], v[212:215]
    buffer_load_dwordx4 v1, s[56:59], s21 offen sc1 lds
    v_mfma_f32_16x16x32_bf16 v[212:215], v[140:143], a[236:239], v[212:215]
    v_mfma_f32_16x16x32_bf16 v[212:215], v[144:147], a[244:247], v[212:215]
    v_mfma_f32_16x16x32_bf16 v[212:215], v[148:151], a[252:255], v[212:215]
    v_mfma_f32_16x16x32_bf16 v[216:219], v[104:107], a[224:227], v[216:219]
    v_mfma_f32_16x16x32_bf16 v[216:219], v[108:111], a[232:235], v[216:219]
    buffer_load_dwordx4 v1, s[56:59], s21 offen offset:1024 sc1 lds
    v_mfma_f32_16x16x32_bf16 v[216:219], v[112:115], a[240:243], v[216:219]
    s_add_u32 s21, s21, 36864
    s_add_u32 s21, s4, 4
    s_xor_b32 s21, s21, s3
    v_mfma_f32_16x16x32_bf16 v[216:219], v[116:119], a[248:251], v[216:219]
    s_lshl_b32 s21, s21, 2
    s_waitcnt vmcnt(16)
    s_barrier
    v_mfma_f32_16x16x32_bf16 v[220:223], v[104:107], a[228:231], v[220:223]
    s_mul_i32 s21, s21, 36864
    s_add_u32 s21, s21, s28
    ds_read_b128 v[136:139], v6 offset:0
    v_mfma_f32_16x16x32_bf16 v[220:223], v[108:111], a[236:239], v[220:223]
    s_add_u32 s21, s21, 7168
    s_add_u32 m0, s45, 0
    ds_read_b128 v[140:143], v6 offset:1024
    v_mfma_f32_16x16x32_bf16 v[220:223], v[112:115], a[244:247], v[220:223]
    buffer_load_dwordx4 v1, s[56:59], s21 offen sc1 lds
    v_mfma_f32_16x16x32_bf16 v[220:223], v[116:119], a[252:255], v[220:223]
    s_waitcnt lgkmcnt(2)
    ds_read_b128 v[144:147], v6 offset:8192
    ds_read_b128 v[148:151], v6 offset:9216
    v_mfma_f32_16x16x32_bf16 v[224:227], v[120:123], a[224:227], v[224:227]
    ds_read_b128 v[104:107], v6 offset:16384
    v_mfma_f32_16x16x32_bf16 v[224:227], v[124:127], a[232:235], v[224:227]
    buffer_load_dwordx4 v1, s[56:59], s21 offen offset:1024 sc1 lds
    v_mfma_f32_16x16x32_bf16 v[224:227], v[128:131], a[240:243], v[224:227]
    s_add_u32 s21, s21, 36864
    ds_read_b128 v[108:111], v6 offset:17408
    ds_read_b128 v[112:115], v6 offset:24576
    v_mfma_f32_16x16x32_bf16 v[224:227], v[132:135], a[248:251], v[224:227]
    s_add_u32 m0, s45, 2048
    ds_read_b128 v[116:119], v7 offset:0
    v_mfma_f32_16x16x32_bf16 v[228:231], v[120:123], a[228:231], v[228:231]
    ds_read_b128 v[120:123], v7 offset:8192
    v_mfma_f32_16x16x32_bf16 v[228:231], v[124:127], a[236:239], v[228:231]
    buffer_load_dwordx4 v1, s[56:59], s21 offen sc1 lds
    v_mfma_f32_16x16x32_bf16 v[228:231], v[128:131], a[244:247], v[228:231]
    ds_read_b128 v[124:127], v7 offset:16384
    ds_read_b128 v[128:131], v7 offset:24576
    v_mfma_f32_16x16x32_bf16 v[228:231], v[132:135], a[252:255], v[228:231]
    s_waitcnt lgkmcnt(4)
    ds_read_b128 v[132:135], v7 offset:1024
    v_smfmac_f32_16x16x64_bf16 v[176:179], v[136:139], v[64:71], v16
    v_smfmac_f32_16x16x64_bf16 v[180:183], v[136:139], v[72:79], v16
    buffer_load_dwordx4 v1, s[56:59], s21 offen offset:1024 sc1 lds
    v_smfmac_f32_16x16x64_bf16 v[184:187], v[140:143], v[64:71], v16
    ds_read_b128 v[136:139], v7 offset:9216
    v_smfmac_f32_16x16x64_bf16 v[188:191], v[140:143], v[72:79], v16
    s_add_u32 s21, s21, 36864
    ds_read_b128 v[140:143], v7 offset:17408
    v_smfmac_f32_16x16x64_bf16 v[192:195], v[144:147], v[64:71], v16
    s_add_u32 m0, s45, 4096
    v_smfmac_f32_16x16x64_bf16 v[196:199], v[144:147], v[72:79], v16
    ds_read_b128 v[144:147], v7 offset:25600
    v_smfmac_f32_16x16x64_bf16 v[200:203], v[148:151], v[64:71], v16
    buffer_load_dwordx4 v1, s[56:59], s21 offen sc1 lds
    v_smfmac_f32_16x16x64_bf16 v[204:207], v[148:151], v[72:79], v16
    ds_read_b128 v[148:151], v7 offset:2048
    v_smfmac_f32_16x16x64_bf16 v[208:211], v[104:107], v[64:71], v16
    v_smfmac_f32_16x16x64_bf16 v[212:215], v[104:107], v[72:79], v16
    ds_read_b128 v[104:107], v7 offset:10240
    v_smfmac_f32_16x16x64_bf16 v[216:219], v[108:111], v[64:71], v16
    buffer_load_dwordx4 v1, s[56:59], s21 offen offset:1024 sc1 lds
    v_smfmac_f32_16x16x64_bf16 v[220:223], v[108:111], v[72:79], v16
    s_add_u32 s21, s21, 36864
    ds_read_b128 v[108:111], v7 offset:18432
    v_smfmac_f32_16x16x64_bf16 v[224:227], v[112:115], v[64:71], v16
    s_waitcnt vmcnt(14)
    v_smfmac_f32_16x16x64_bf16 v[228:231], v[112:115], v[72:79], v16
    s_add_u32 m0, s45, 6144
    ds_read_b128 v[112:115], v7 offset:26624
    s_waitcnt lgkmcnt(3)
    v_mfma_f32_16x16x32_bf16 v[176:179], v[116:119], v[32:35], v[176:179]
    buffer_load_dwordx4 v1, s[56:59], s21 offen sc1 lds
    v_mfma_f32_16x16x32_bf16 v[176:179], v[120:123], v[40:43], v[176:179]
    v_mfma_f32_16x16x32_bf16 v[176:179], v[124:127], v[48:51], v[176:179]
    v_mfma_f32_16x16x32_bf16 v[176:179], v[128:131], v[56:59], v[176:179]
    v_mfma_f32_16x16x32_bf16 v[180:183], v[116:119], v[36:39], v[180:183]
    buffer_load_dwordx4 v1, s[56:59], s21 offen offset:1024 sc1 lds
    v_mfma_f32_16x16x32_bf16 v[180:183], v[120:123], v[44:47], v[180:183]
    s_add_u32 s21, s21, 36864
    ds_read_b128 v[116:119], v7 offset:3072
    ds_read_b128 v[120:123], v7 offset:11264
    v_mfma_f32_16x16x32_bf16 v[180:183], v[124:127], v[52:55], v[180:183]
    ds_read_b128 v[124:127], v7 offset:19456
    v_cvt_pk_bf16_f32 v232, v176, v177
    v_mfma_f32_16x16x32_bf16 v[180:183], v[128:131], v[60:63], v[180:183]
    v_cvt_pk_bf16_f32 v233, v178, v179
    ds_read_b128 v[128:131], v7 offset:27648
    v_mfma_f32_16x16x32_bf16 v[184:187], v[132:135], v[32:35], v[184:187]
    v_mfma_f32_16x16x32_bf16 v[184:187], v[136:139], v[40:43], v[184:187]
    v_mfma_f32_16x16x32_bf16 v[184:187], v[140:143], v[48:51], v[184:187]
    v_mfma_f32_16x16x32_bf16 v[184:187], v[144:147], v[56:59], v[184:187]
    v_mfma_f32_16x16x32_bf16 v[188:191], v[132:135], v[36:39], v[188:191]
    ds_read_b128 v[132:135], v7 offset:4096
    v_cvt_pk_bf16_f32 v234, v180, v181
    v_mfma_f32_16x16x32_bf16 v[188:191], v[136:139], v[44:47], v[188:191]
    v_cvt_pk_bf16_f32 v235, v182, v183
    ds_read_b128 v[136:139], v7 offset:12288
    v_mfma_f32_16x16x32_bf16 v[188:191], v[140:143], v[52:55], v[188:191]
    buffer_store_dwordx4 v[232:235], v1, s[48:51], s8 offen offset:0 sc1
    v_mfma_f32_16x16x32_bf16 v[188:191], v[144:147], v[60:63], v[188:191]
    v_cvt_pk_bf16_f32 v236, v184, v185
    v_cvt_pk_bf16_f32 v237, v186, v187
    v_mfma_f32_16x16x32_bf16 v[192:195], v[148:151], v[32:35], v[192:195]
    s_waitcnt lgkmcnt(2)
    ds_read_b128 v[140:143], v7 offset:20480
    ds_read_b128 v[144:147], v7 offset:28672
    v_mfma_f32_16x16x32_bf16 v[192:195], v[104:107], v[40:43], v[192:195]
    v_mfma_f32_16x16x32_bf16 v[192:195], v[108:111], v[48:51], v[192:195]
    v_mfma_f32_16x16x32_bf16 v[192:195], v[112:115], v[56:59], v[192:195]
    v_cvt_pk_bf16_f32 v238, v188, v189
    v_cvt_pk_bf16_f32 v239, v190, v191
    v_mfma_f32_16x16x32_bf16 v[196:199], v[148:151], v[36:39], v[196:199]
    buffer_store_dwordx4 v[236:239], v1, s[48:51], s8 offen offset:1024 sc1
    v_mfma_f32_16x16x32_bf16 v[196:199], v[104:107], v[44:47], v[196:199]
    ds_read_b128 v[148:151], v7 offset:5120
    ds_read_b128 v[104:107], v7 offset:13312
    v_mfma_f32_16x16x32_bf16 v[196:199], v[108:111], v[52:55], v[196:199]
    v_cvt_pk_bf16_f32 v240, v192, v193
    v_cvt_pk_bf16_f32 v241, v194, v195
    v_mfma_f32_16x16x32_bf16 v[196:199], v[112:115], v[60:63], v[196:199]
    ds_read_b128 v[108:111], v7 offset:21504
    ds_read_b128 v[112:115], v7 offset:29696
    v_mfma_f32_16x16x32_bf16 v[200:203], v[116:119], v[32:35], v[200:203]
    v_mfma_f32_16x16x32_bf16 v[200:203], v[120:123], v[40:43], v[200:203]
    v_mfma_f32_16x16x32_bf16 v[200:203], v[124:127], v[48:51], v[200:203]
    v_mfma_f32_16x16x32_bf16 v[200:203], v[128:131], v[56:59], v[200:203]
    v_mfma_f32_16x16x32_bf16 v[204:207], v[116:119], v[36:39], v[204:207]
    ds_read_b128 v[116:119], v7 offset:6144
    v_cvt_pk_bf16_f32 v242, v196, v197
    v_mfma_f32_16x16x32_bf16 v[204:207], v[120:123], v[44:47], v[204:207]
    v_cvt_pk_bf16_f32 v243, v198, v199
    ds_read_b128 v[120:123], v7 offset:14336
    v_mfma_f32_16x16x32_bf16 v[204:207], v[124:127], v[52:55], v[204:207]
    buffer_store_dwordx4 v[240:243], v1, s[48:51], s9 offen offset:0 sc1
    v_mfma_f32_16x16x32_bf16 v[204:207], v[128:131], v[60:63], v[204:207]
    s_waitcnt lgkmcnt(2)
    v_cvt_pk_bf16_f32 v244, v200, v201
    v_cvt_pk_bf16_f32 v245, v202, v203
    v_mfma_f32_16x16x32_bf16 v[208:211], v[132:135], v[32:35], v[208:211]
    ds_read_b128 v[124:127], v7 offset:22528
    ds_read_b128 v[128:131], v7 offset:30720
    v_mfma_f32_16x16x32_bf16 v[208:211], v[136:139], v[40:43], v[208:211]
    v_mfma_f32_16x16x32_bf16 v[208:211], v[140:143], v[48:51], v[208:211]
    v_mfma_f32_16x16x32_bf16 v[208:211], v[144:147], v[56:59], v[208:211]
    v_cvt_pk_bf16_f32 v246, v204, v205
    v_cvt_pk_bf16_f32 v247, v206, v207
    v_mfma_f32_16x16x32_bf16 v[212:215], v[132:135], v[36:39], v[212:215]
    buffer_store_dwordx4 v[244:247], v1, s[48:51], s9 offen offset:1024 sc1
    v_mfma_f32_16x16x32_bf16 v[212:215], v[136:139], v[44:47], v[212:215]
    v_mfma_f32_16x16x32_bf16 v[212:215], v[140:143], v[52:55], v[212:215]
    v_mfma_f32_16x16x32_bf16 v[212:215], v[144:147], v[60:63], v[212:215]
    v_mfma_f32_16x16x32_bf16 v[216:219], v[148:151], v[32:35], v[216:219]
    v_cvt_pk_bf16_f32 v232, v208, v209
    v_cvt_pk_bf16_f32 v233, v210, v211
    v_mfma_f32_16x16x32_bf16 v[216:219], v[104:107], v[40:43], v[216:219]
    v_mfma_f32_16x16x32_bf16 v[216:219], v[108:111], v[48:51], v[216:219]
    v_mfma_f32_16x16x32_bf16 v[216:219], v[112:115], v[56:59], v[216:219]
    s_waitcnt vmcnt(12)
    s_barrier
    v_cvt_pk_bf16_f32 v234, v212, v213
    v_mfma_f32_16x16x32_bf16 v[220:223], v[148:151], v[36:39], v[220:223]
    v_cvt_pk_bf16_f32 v235, v214, v215
    ds_read_b128 v[132:135], v11 offset:0
    v_mfma_f32_16x16x32_bf16 v[220:223], v[104:107], v[44:47], v[220:223]
    buffer_store_dwordx4 v[232:235], v1, s[48:51], s10 offen offset:0 sc1
    v_mfma_f32_16x16x32_bf16 v[220:223], v[108:111], v[52:55], v[220:223]
    ds_read_b128 v[136:139], v11 offset:2048
    ds_read_b128 v[140:143], v11 offset:4096
    v_mfma_f32_16x16x32_bf16 v[220:223], v[112:115], v[60:63], v[220:223]
    s_waitcnt lgkmcnt(3)
    ds_read_b128 v[144:147], v11 offset:6144
    v_cvt_pk_bf16_f32 v236, v216, v217
    v_mfma_f32_16x16x32_bf16 v[224:227], v[116:119], v[32:35], v[224:227]
    v_cvt_pk_bf16_f32 v237, v218, v219
    ds_read_b128 v[148:151], v11 offset:1024
    v_mfma_f32_16x16x32_bf16 v[224:227], v[120:123], v[40:43], v[224:227]
    ds_read_b128 v[104:107], v11 offset:3072
    v_mfma_f32_16x16x32_bf16 v[224:227], v[124:127], v[48:51], v[224:227]
    v_cvt_pk_bf16_f32 v238, v220, v221
    v_cvt_pk_bf16_f32 v239, v222, v223
    v_mfma_f32_16x16x32_bf16 v[224:227], v[128:131], v[56:59], v[224:227]
    buffer_store_dwordx4 v[236:239], v1, s[48:51], s10 offen offset:1024 sc1
    v_mfma_f32_16x16x32_bf16 v[228:231], v[116:119], v[36:39], v[228:231]
    ds_read_b128 v[108:111], v11 offset:5120
    ds_read_b128 v[112:115], v11 offset:7168
    v_mfma_f32_16x16x32_bf16 v[228:231], v[120:123], v[44:47], v[228:231]
    ds_read_b128 v[116:119], v11 offset:8192
    v_mfma_f32_16x16x32_bf16 v[228:231], v[124:127], v[52:55], v[228:231]
    ds_read_b128 v[120:123], v11 offset:10240
    v_cvt_pk_bf16_f32 v240, v224, v225
    v_mfma_f32_16x16x32_bf16 v[228:231], v[128:131], v[60:63], v[228:231]
    s_waitcnt lgkmcnt(4)
    v_cvt_pk_bf16_f32 v241, v226, v227
    ds_read_b128 v[124:127], v11 offset:12288
    v_mfma_f32_16x16x32_bf16 v[160:163], v[132:135], a[0:3], 0
    ds_read_b128 v[128:131], v11 offset:14336
    v_mfma_f32_16x16x32_bf16 v[160:163], v[136:139], a[8:11], v[160:163]
    v_mfma_f32_16x16x32_bf16 v[160:163], v[140:143], a[16:19], v[160:163]
    v_mfma_f32_16x16x32_bf16 v[160:163], v[144:147], a[24:27], v[160:163]
    v_mfma_f32_16x16x32_bf16 v[164:167], v[132:135], a[4:7], 0
    v_cvt_pk_bf16_f32 v242, v228, v229
    v_cvt_pk_bf16_f32 v243, v230, v231
    v_mfma_f32_16x16x32_bf16 v[164:167], v[136:139], a[12:15], v[164:167]
    buffer_store_dwordx4 v[240:243], v1, s[48:51], s11 offen offset:2048 sc1
    v_mfma_f32_16x16x32_bf16 v[164:167], v[140:143], a[20:23], v[164:167]
    ds_read_b128 v[132:135], v11 offset:9216
    ds_read_b128 v[136:139], v11 offset:11264
    v_mfma_f32_16x16x32_bf16 v[164:167], v[144:147], a[28:31], v[164:167]
    ds_read_b128 v[140:143], v11 offset:13312
    v_mfma_f32_16x16x32_bf16 v[168:171], v[148:151], a[0:3], 0
    ds_read_b128 v[144:147], v11 offset:15360
    v_mfma_f32_16x16x32_bf16 v[168:171], v[104:107], a[8:11], v[168:171]
    s_waitcnt lgkmcnt(4)
    v_mfma_f32_16x16x32_bf16 v[168:171], v[108:111], a[16:19], v[168:171]
    v_mfma_f32_16x16x32_bf16 v[168:171], v[112:115], a[24:27], v[168:171]
    v_mfma_f32_16x16x32_bf16 v[172:175], v[148:151], a[4:7], 0
    ds_read_b128 v[148:151], v11 offset:16384
    v_mfma_f32_16x16x32_bf16 v[172:175], v[104:107], a[12:15], v[172:175]
    ds_read_b128 v[104:107], v11 offset:18432
    v_mfma_f32_16x16x32_bf16 v[172:175], v[108:111], a[20:23], v[172:175]
    ds_read_b128 v[108:111], v11 offset:20480
    v_mfma_f32_16x16x32_bf16 v[172:175], v[112:115], a[28:31], v[172:175]
    ds_read_b128 v[112:115], v11 offset:22528
    v_mfma_f32_16x16x32_bf16 v[160:163], v[116:119], a[32:35], v[160:163]
    v_mfma_f32_16x16x32_bf16 v[160:163], v[120:123], a[40:43], v[160:163]
    v_mfma_f32_16x16x32_bf16 v[160:163], v[124:127], a[48:51], v[160:163]
    v_mfma_f32_16x16x32_bf16 v[160:163], v[128:131], a[56:59], v[160:163]
    v_mfma_f32_16x16x32_bf16 v[164:167], v[116:119], a[36:39], v[164:167]
    ds_read_b128 v[116:119], v11 offset:17408
    v_mfma_f32_16x16x32_bf16 v[164:167], v[120:123], a[44:47], v[164:167]
    ds_read_b128 v[120:123], v11 offset:19456
    v_mfma_f32_16x16x32_bf16 v[164:167], v[124:127], a[52:55], v[164:167]
    ds_read_b128 v[124:127], v11 offset:21504
    v_mfma_f32_16x16x32_bf16 v[164:167], v[128:131], a[60:63], v[164:167]
    s_waitcnt lgkmcnt(3)
    ds_read_b128 v[128:131], v11 offset:23552
    v_mfma_f32_16x16x32_bf16 v[168:171], v[132:135], a[32:35], v[168:171]
    v_mfma_f32_16x16x32_bf16 v[168:171], v[136:139], a[40:43], v[168:171]
    v_mfma_f32_16x16x32_bf16 v[168:171], v[140:143], a[48:51], v[168:171]
    v_mfma_f32_16x16x32_bf16 v[168:171], v[144:147], a[56:59], v[168:171]
    v_mfma_f32_16x16x32_bf16 v[172:175], v[132:135], a[36:39], v[172:175]
    ds_read_b128 v[132:135], v11 offset:24576
    v_mfma_f32_16x16x32_bf16 v[172:175], v[136:139], a[44:47], v[172:175]
    ds_read_b128 v[136:139], v11 offset:26624
    v_mfma_f32_16x16x32_bf16 v[172:175], v[140:143], a[52:55], v[172:175]
    ds_read_b128 v[140:143], v11 offset:28672
    v_mfma_f32_16x16x32_bf16 v[172:175], v[144:147], a[60:63], v[172:175]
    ds_read_b128 v[144:147], v11 offset:30720
    v_mfma_f32_16x16x32_bf16 v[160:163], v[148:151], a[64:67], v[160:163]
    v_mfma_f32_16x16x32_bf16 v[160:163], v[104:107], a[72:75], v[160:163]
    v_mfma_f32_16x16x32_bf16 v[160:163], v[108:111], a[80:83], v[160:163]
    v_mfma_f32_16x16x32_bf16 v[160:163], v[112:115], a[88:91], v[160:163]
    v_mfma_f32_16x16x32_bf16 v[164:167], v[148:151], a[68:71], v[164:167]
    ds_read_b128 v[148:151], v11 offset:25600
    v_mfma_f32_16x16x32_bf16 v[164:167], v[104:107], a[76:79], v[164:167]
    ds_read_b128 v[104:107], v11 offset:27648
    v_mfma_f32_16x16x32_bf16 v[164:167], v[108:111], a[84:87], v[164:167]
    ds_read_b128 v[108:111], v11 offset:29696
    v_mfma_f32_16x16x32_bf16 v[164:167], v[112:115], a[92:95], v[164:167]
    s_waitcnt lgkmcnt(3)
    ds_read_b128 v[112:115], v11 offset:31744
    v_mfma_f32_16x16x32_bf16 v[168:171], v[116:119], a[64:67], v[168:171]
    v_mfma_f32_16x16x32_bf16 v[168:171], v[120:123], a[72:75], v[168:171]
    v_mfma_f32_16x16x32_bf16 v[168:171], v[124:127], a[80:83], v[168:171]
    v_mfma_f32_16x16x32_bf16 v[168:171], v[128:131], a[88:91], v[168:171]
    v_mfma_f32_16x16x32_bf16 v[172:175], v[116:119], a[68:71], v[172:175]
    v_mfma_f32_16x16x32_bf16 v[172:175], v[120:123], a[76:79], v[172:175]
    v_mfma_f32_16x16x32_bf16 v[172:175], v[124:127], a[84:87], v[172:175]
    v_mfma_f32_16x16x32_bf16 v[172:175], v[128:131], a[92:95], v[172:175]
    v_mfma_f32_16x16x32_bf16 v[160:163], v[132:135], a[96:99], v[160:163]
    v_mfma_f32_16x16x32_bf16 v[160:163], v[136:139], a[104:107], v[160:163]
    v_mfma_f32_16x16x32_bf16 v[160:163], v[140:143], a[112:115], v[160:163]
    s_waitcnt vmcnt(0)
    buffer_store_dword v31, v23, s[32:35], s74 offen sc1
    v_mfma_f32_16x16x32_bf16 v[160:163], v[144:147], a[120:123], v[160:163]
    s_waitcnt vmcnt(8)
    s_barrier
    ds_read_b128 v[116:119], v12 offset:0
    v_mfma_f32_16x16x32_bf16 v[164:167], v[132:135], a[100:103], v[164:167]
    ds_read_b128 v[120:123], v12 offset:2048
    ds_read_b128 v[124:127], v12 offset:4096
    v_mfma_f32_16x16x32_bf16 v[164:167], v[136:139], a[108:111], v[164:167]
    ds_read_b128 v[128:131], v12 offset:6144
    v_mfma_f32_16x16x32_bf16 v[164:167], v[140:143], a[116:119], v[164:167]
    ds_read_b128 v[132:135], v12 offset:1024
    v_mfma_f32_16x16x32_bf16 v[164:167], v[144:147], a[124:127], v[164:167]
    s_mul_i32 s21, s61, 6
    s_add_u32 s21, s4, s21
    s_add_u32 s21, s21, 128
    s_waitcnt lgkmcnt(5)
    v_mfma_f32_16x16x32_bf16 v[168:171], v[148:151], a[96:99], v[168:171]
    s_mul_i32 s21, s21, 36864
    s_add_u32 s21, s21, s28
    s_add_u32 s21, s21, 7168
    v_mfma_f32_16x16x32_bf16 v[168:171], v[104:107], a[104:107], v[168:171]
    s_mov_b32 m0, s46
    ds_read_b128 v[136:139], v12 offset:3072
    ds_read_b128 v[140:143], v12 offset:5120
    v_mfma_f32_16x16x32_bf16 v[168:171], v[108:111], a[112:115], v[168:171]
    buffer_load_dwordx4 v1, s[56:59], s21 offen sc1 lds
    v_mfma_f32_16x16x32_bf16 v[168:171], v[112:115], a[120:123], v[168:171]
    ds_read_b128 v[144:147], v12 offset:7168
    v_mfma_f32_16x16x32_bf16 v[172:175], v[148:151], a[100:103], v[172:175]
    ds_read_b128 v[148:151], v12 offset:8192
    v_mfma_f32_16x16x32_bf16 v[172:175], v[104:107], a[108:111], v[172:175]
    ds_read_b128 v[104:107], v12 offset:10240
    v_mfma_f32_16x16x32_bf16 v[172:175], v[108:111], a[116:119], v[172:175]
    buffer_load_dwordx4 v1, s[56:59], s21 offen offset:1024 sc1 lds
    v_mfma_f32_16x16x32_bf16 v[172:175], v[112:115], a[124:127], v[172:175]
    s_mul_i32 s21, s61, 6
    s_add_u32 s21, s21, 132
    s_mul_i32 s21, s21, 36864
    s_waitcnt lgkmcnt(3)
    v_mfma_f32_16x16x32_bf16 v[160:163], v[116:119], a[128:131], v[160:163]
    s_add_u32 s21, s21, s28
    s_add_u32 s21, s21, 7168
    s_and_b32 s64, s68, 1024
    v_mfma_f32_16x16x32_bf16 v[160:163], v[120:123], a[136:139], v[160:163]
    s_add_u32 s21, s21, s64
    ds_read_b128 v[108:111], v12 offset:12288
    ds_read_b128 v[112:115], v12 offset:14336
    v_mfma_f32_16x16x32_bf16 v[160:163], v[124:127], a[144:147], v[160:163]
    s_add_u32 m0, s46, 2048
    s_lshl2_add_u32 s64, s61, s65
    s_lshl_b32 s65, s65, 5
    v_mfma_f32_16x16x32_bf16 v[160:163], v[128:131], a[152:155], v[160:163]
    s_add_u32 s65, s65, 1024
    buffer_load_dwordx4 v1, s[56:59], s21 offen sc1 lds
    v_mfma_f32_16x16x32_bf16 v[164:167], v[116:119], a[132:135], v[164:167]
    s_lshl_b32 s64, s64, 6
    ds_read_b128 v[116:119], v12 offset:9216
    v_mfma_f32_16x16x32_bf16 v[164:167], v[120:123], a[140:143], v[164:167]
    s_cmp_eq_u32 s4, s61
    s_cselect_b32 s65, s65, 1073741824
    s_cselect_b32 s70, s23, 1073741824
    v_mfma_f32_16x16x32_bf16 v[164:167], v[124:127], a[148:151], v[164:167]
    ds_read_b128 v[120:123], v12 offset:11264
    ds_read_b128 v[124:127], v12 offset:13312
    v_mfma_f32_16x16x32_bf16 v[164:167], v[128:131], a[156:159], v[164:167]
    ds_read_b128 v[128:131], v12 offset:15360
    v_mfma_f32_16x16x32_bf16 v[168:171], v[132:135], a[128:131], v[168:171]
    v_mfma_f32_16x16x32_bf16 v[168:171], v[136:139], a[136:139], v[168:171]
    v_mfma_f32_16x16x32_bf16 v[168:171], v[140:143], a[144:147], v[168:171]
    s_waitcnt lgkmcnt(3)
    v_mfma_f32_16x16x32_bf16 v[168:171], v[144:147], a[152:155], v[168:171]
    v_mfma_f32_16x16x32_bf16 v[172:175], v[132:135], a[132:135], v[172:175]
    ds_read_b128 v[132:135], v12 offset:16384
    v_mfma_f32_16x16x32_bf16 v[172:175], v[136:139], a[140:143], v[172:175]
    ds_read_b128 v[136:139], v12 offset:18432
    v_mfma_f32_16x16x32_bf16 v[172:175], v[140:143], a[148:151], v[172:175]
    ds_read_b128 v[140:143], v12 offset:20480
    v_mfma_f32_16x16x32_bf16 v[172:175], v[144:147], a[156:159], v[172:175]
    ds_read_b128 v[144:147], v12 offset:22528
    v_mfma_f32_16x16x32_bf16 v[160:163], v[148:151], a[160:163], v[160:163]
    v_mfma_f32_16x16x32_bf16 v[160:163], v[104:107], a[168:171], v[160:163]
    v_mfma_f32_16x16x32_bf16 v[160:163], v[108:111], a[176:179], v[160:163]
    v_mfma_f32_16x16x32_bf16 v[160:163], v[112:115], a[184:187], v[160:163]
    v_mfma_f32_16x16x32_bf16 v[164:167], v[148:151], a[164:167], v[164:167]
    ds_read_b128 v[148:151], v12 offset:17408
    v_mfma_f32_16x16x32_bf16 v[164:167], v[104:107], a[172:175], v[164:167]
    buffer_load_dword v3, v19, s[32:35], s66 offen sc1
    v_mfma_f32_16x16x32_bf16 v[164:167], v[108:111], a[180:183], v[164:167]
    ds_read_b128 v[104:107], v12 offset:19456
    ds_read_b128 v[108:111], v12 offset:21504
    v_mfma_f32_16x16x32_bf16 v[164:167], v[112:115], a[188:191], v[164:167]
    ds_read_b128 v[112:115], v12 offset:23552
    v_mfma_f32_16x16x32_bf16 v[168:171], v[116:119], a[160:163], v[168:171]
    s_waitcnt lgkmcnt(4)
    v_mfma_f32_16x16x32_bf16 v[168:171], v[120:123], a[168:171], v[168:171]
    v_mfma_f32_16x16x32_bf16 v[168:171], v[124:127], a[176:179], v[168:171]
    v_mfma_f32_16x16x32_bf16 v[168:171], v[128:131], a[184:187], v[168:171]
    v_mfma_f32_16x16x32_bf16 v[172:175], v[116:119], a[164:167], v[172:175]
    ds_read_b128 v[116:119], v12 offset:24576
    v_mfma_f32_16x16x32_bf16 v[172:175], v[120:123], a[172:175], v[172:175]
    ds_read_b128 v[120:123], v12 offset:26624
    v_mfma_f32_16x16x32_bf16 v[172:175], v[124:127], a[180:183], v[172:175]
    ds_read_b128 v[124:127], v12 offset:28672
    v_mfma_f32_16x16x32_bf16 v[172:175], v[128:131], a[188:191], v[172:175]
    ds_read_b128 v[128:131], v12 offset:30720
    v_mfma_f32_16x16x32_bf16 v[160:163], v[132:135], a[192:195], v[160:163]
    v_mfma_f32_16x16x32_bf16 v[160:163], v[136:139], a[200:203], v[160:163]
    v_mfma_f32_16x16x32_bf16 v[160:163], v[140:143], a[208:211], v[160:163]
    v_mfma_f32_16x16x32_bf16 v[160:163], v[144:147], a[216:219], v[160:163]
    v_mfma_f32_16x16x32_bf16 v[164:167], v[132:135], a[196:199], v[164:167]
    ds_read_b128 v[132:135], v12 offset:25600
    v_mfma_f32_16x16x32_bf16 v[164:167], v[136:139], a[204:207], v[164:167]
    ds_read_b128 v[136:139], v12 offset:27648
    v_mfma_f32_16x16x32_bf16 v[164:167], v[140:143], a[212:215], v[164:167]
    ds_read_b128 v[140:143], v12 offset:29696
    v_mfma_f32_16x16x32_bf16 v[164:167], v[144:147], a[220:223], v[164:167]
    s_waitcnt lgkmcnt(3)
    ds_read_b128 v[144:147], v12 offset:31744
    v_mfma_f32_16x16x32_bf16 v[168:171], v[148:151], a[192:195], v[168:171]
    v_mfma_f32_16x16x32_bf16 v[168:171], v[104:107], a[200:203], v[168:171]
    v_mfma_f32_16x16x32_bf16 v[168:171], v[108:111], a[208:211], v[168:171]
    v_mfma_f32_16x16x32_bf16 v[168:171], v[112:115], a[216:219], v[168:171]
    v_mfma_f32_16x16x32_bf16 v[172:175], v[148:151], a[196:199], v[172:175]
    v_mfma_f32_16x16x32_bf16 v[172:175], v[104:107], a[204:207], v[172:175]
    v_mfma_f32_16x16x32_bf16 v[172:175], v[108:111], a[212:215], v[172:175]
    v_mfma_f32_16x16x32_bf16 v[172:175], v[112:115], a[220:223], v[172:175]
    v_mfma_f32_16x16x32_bf16 v[160:163], v[116:119], a[224:227], v[160:163]
    s_waitcnt vmcnt(0)
    v_cmp_gt_u32 vcc, 3, v3
    s_nop 1
    s_and_b64 vcc, vcc, exec
    s_cbranch_scc1 SPIN_X
BACK_X:
    v_mfma_f32_16x16x32_bf16 v[160:163], v[120:123], a[232:235], v[160:163]
    buffer_load_dwordx4 v[176:179], v1, s[48:51], s98 offen offset:0 sc1
    v_mfma_f32_16x16x32_bf16 v[160:163], v[124:127], a[240:243], v[160:163]
    s_add_u32 s98, s23, 12288
    buffer_load_dwordx4 v[180:183], v1, s[48:51], s98 offen offset:0 sc1
    v_mfma_f32_16x16x32_bf16 v[160:163], v[128:131], a[248:251], v[160:163]
    s_waitcnt vmcnt(3)
    s_barrier
    ds_read_b128 v[148:151], v13 offset:2048
    v_mfma_f32_16x16x32_bf16 v[164:167], v[116:119], a[228:231], v[164:167]
    s_add_u32 s98, s23, 24576
    ds_read_b128 v[104:107], v13 offset:1024
    ds_read_b128 v[108:111], v13 offset:9216
    v_mfma_f32_16x16x32_bf16 v[164:167], v[120:123], a[236:239], v[164:167]
    buffer_load_dwordx4 v[184:187], v1, s[48:51], s98 offen offset:0 sc1
    v_mfma_f32_16x16x32_bf16 v[164:167], v[124:127], a[244:247], v[164:167]
    s_add_u32 s98, s23, 0
    ds_read_b128 v[112:115], v13 offset:17408
    ds_read_b128 v[116:119], v13 offset:25600
    v_mfma_f32_16x16x32_bf16 v[164:167], v[128:131], a[252:255], v[164:167]
    s_waitcnt lgkmcnt(5)
    ds_read_b128 v[120:123], v13 offset:0
    v_mfma_f32_16x16x32_bf16 v[168:171], v[132:135], a[224:227], v[168:171]
    ds_read_b128 v[124:127], v13 offset:8192
    v_mfma_f32_16x16x32_bf16 v[168:171], v[136:139], a[232:235], v[168:171]
    buffer_load_dwordx4 v[188:191], v1, s[48:51], s98 offen offset:1024 sc1
    v_mfma_f32_16x16x32_bf16 v[168:171], v[140:143], a[240:243], v[168:171]
    s_add_u32 s98, s23, 12288
    ds_read_b128 v[128:131], v13 offset:16384
    v_mfma_f32_16x16x32_bf16 v[168:171], v[144:147], a[248:251], v[168:171]
    v_mfma_f32_16x16x32_bf16 v[172:175], v[132:135], a[228:231], v[172:175]
    ds_read_b128 v[132:135], v13 offset:24576
    v_mfma_f32_16x16x32_bf16 v[172:175], v[136:139], a[236:239], v[172:175]
    buffer_load_dwordx4 v[192:195], v1, s[48:51], s98 offen offset:1024 sc1
    v_mfma_f32_16x16x32_bf16 v[172:175], v[140:143], a[244:247], v[172:175]
    s_add_u32 s98, s23, 24576
    ds_read_b128 v[136:139], v13 offset:10240
    v_mfma_f32_16x16x32_bf16 v[172:175], v[144:147], a[252:255], v[172:175]
    s_waitcnt lgkmcnt(2)
    v_smfmac_f32_16x16x64_bf16 v[160:163], v[148:151], v[64:71], v16
    v_smfmac_f32_16x16x64_bf16 v[164:167], v[148:151], v[72:79], v16
    buffer_load_dwordx4 v[196:199], v1, s[48:51], s98 offen offset:1024 sc1
    v_mfma_f32_16x16x32_bf16 v[168:171], v[104:107], v[32:35], v[168:171]
    s_add_u32 s98, s70, 0
    v_mfma_f32_16x16x32_bf16 v[168:171], v[108:111], v[40:43], v[168:171]
    v_mfma_f32_16x16x32_bf16 v[168:171], v[112:115], v[48:51], v[168:171]
    v_mfma_f32_16x16x32_bf16 v[168:171], v[116:119], v[56:59], v[168:171]
    buffer_load_dwordx4 v[200:203], v1, s[48:51], s98 offen offset:2048 sc1
    v_mfma_f32_16x16x32_bf16 v[172:175], v[104:107], v[36:39], v[172:175]
    s_add_u32 s98, s70, 12288
    v_mfma_f32_16x16x32_bf16 v[172:175], v[108:111], v[44:47], v[172:175]
    v_mfma_f32_16x16x32_bf16 v[172:175], v[112:115], v[52:55], v[172:175]
    v_mfma_f32_16x16x32_bf16 v[172:175], v[116:119], v[60:63], v[172:175]
    buffer_load_dwordx4 v[204:207], v1, s[48:51], s98 offen offset:2048 sc1
    v_mfma_f32_16x16x32_bf16 v[160:163], v[120:123], v[32:35], v[160:163]
    s_add_u32 s98, s70, 24576
    v_mfma_f32_16x16x32_bf16 v[160:163], v[124:127], v[40:43], v[160:163]
    v_mfma_f32_16x16x32_bf16 v[160:163], v[128:131], v[48:51], v[160:163]
    s_waitcnt lgkmcnt(0)
    v_mfma_f32_16x16x32_bf16 v[160:163], v[132:135], v[56:59], v[160:163]
    buffer_load_dwordx4 v[208:211], v1, s[48:51], s98 offen offset:2048 sc1
    v_mfma_f32_16x16x32_bf16 v[164:167], v[120:123], v[36:39], v[164:167]
    v_mfma_f32_16x16x32_bf16 v[164:167], v[124:127], v[44:47], v[164:167]
    v_mfma_f32_16x16x32_bf16 v[164:167], v[128:131], v[52:55], v[164:167]
    v_mfma_f32_16x16x32_bf16 v[164:167], v[132:135], v[60:63], v[164:167]
    v_smfmac_f32_16x16x64_bf16 v[168:171], v[136:139], v[64:71], v16
    v_smfmac_f32_16x16x64_bf16 v[172:175], v[136:139], v[72:79], v16
    s_waitcnt vmcnt(6)
    v_mfma_f32_16x16x32_bf16 v[160:163], v[96:99], v[176:179], v[160:163]
    v_mfma_f32_16x16x32_bf16 v[160:163], v[96:99], v[180:183], v[160:163]
    v_mfma_f32_16x16x32_bf16 v[160:163], v[96:99], v[184:187], v[160:163]
    v_mfma_f32_16x16x32_bf16 v[164:167], v[98:101], v[176:179], v[164:167]
    v_mfma_f32_16x16x32_bf16 v[164:167], v[98:101], v[180:183], v[164:167]
    v_mfma_f32_16x16x32_bf16 v[164:167], v[98:101], v[184:187], v[164:167]
    s_waitcnt vmcnt(3)
    s_nop 0
    v_mfma_f32_16x16x32_bf16 v[168:171], v[96:99], v[188:191], v[168:171]
    v_mfma_f32_16x16x32_bf16 v[168:171], v[96:99], v[192:195], v[168:171]
    v_mfma_f32_16x16x32_bf16 v[168:171], v[96:99], v[196:199], v[168:171]
    v_mfma_f32_16x16x32_bf16 v[172:175], v[98:101], v[188:191], v[172:175]
    v_mfma_f32_16x16x32_bf16 v[172:175], v[98:101], v[192:195], v[172:175]
    v_mfma_f32_16x16x32_bf16 v[172:175], v[98:101], v[196:199], v[172:175]
    v_cvt_pk_bf16_f32 v160, v160, v161
    v_cvt_pk_bf16_f32 v161, v162, v163
    buffer_store_dwordx2 v[160:161], v20, s[24:27], s64 offen
    v_cvt_pk_bf16_f32 v164, v164, v165
    v_cvt_pk_bf16_f32 v165, v166, v167
    buffer_store_dwordx2 v[164:165], v21, s[24:27], s64 offen
    s_cmp_lg_u32 s4, s61
    s_cbranch_scc1 K1_X2
    s_waitcnt vmcnt(2)
    v_mfma_f32_16x16x32_bf16 v[224:227], v[96:99], v[200:203], v[224:227]
    v_mfma_f32_16x16x32_bf16 v[224:227], v[96:99], v[204:207], v[224:227]
    v_mfma_f32_16x16x32_bf16 v[224:227], v[96:99], v[208:211], v[224:227]
    v_mfma_f32_16x16x32_bf16 v[228:231], v[98:101], v[200:203], v[228:231]
    v_mfma_f32_16x16x32_bf16 v[228:231], v[98:101], v[204:207], v[228:231]
    v_mfma_f32_16x16x32_bf16 v[228:231], v[98:101], v[208:211], v[228:231]
    s_nop 4
    v_cvt_pk_bf16_f32 v224, v224, v225
    v_cvt_pk_bf16_f32 v225, v226, v227
    buffer_store_dwordx2 v[224:225], v20, s[24:27], s65 offen
    v_cvt_pk_bf16_f32 v228, v228, v229
    v_cvt_pk_bf16_f32 v229, v230, v231
    buffer_store_dwordx2 v[228:229], v21, s[24:27], s65 offen
K1_X2:
    v_cvt_pk_bf16_f32 v168, v168, v169
    v_cvt_pk_bf16_f32 v169, v170, v171
    buffer_store_dwordx2 v[168:169], v20, s[24:27], s64 offen offset:32
    v_cvt_pk_bf16_f32 v172, v172, v173
    v_cvt_pk_bf16_f32 v173, v174, v175
    buffer_store_dwordx2 v[172:173], v21, s[24:27], s64 offen offset:32
K1_END:
    s_endpgm
K1_LB_MASK:
    v_add_f32 v212, s12, v144
    v_fma_f32 v176, v208, s8, v212
    v_fma_f32 v177, v209, s8, v212
    v_fma_f32 v178, v210, s8, v212
    v_fma_f32 v179, v211, s8, v212
    v_add_f32 v213, s13, v144
    v_fma_f32 v180, v208, s9, v213
    v_fma_f32 v181, v209, s9, v213
    v_fma_f32 v182, v210, s9, v213
    v_fma_f32 v183, v211, s9, v213
    v_add_f32 v212, s14, v144
    v_fma_f32 v184, v208, s10, v212
    v_fma_f32 v185, v209, s10, v212
    v_fma_f32 v186, v210, s10, v212
    v_fma_f32 v187, v211, s10, v212
    v_add_f32 v213, s15, v144
    v_fma_f32 v188, v208, s11, v213
    v_fma_f32 v189, v209, s11, v213
    v_fma_f32 v190, v210, s11, v213
    v_fma_f32 v191, v211, s11, v213
    buffer_load_dword v3, v29, s[32:35], s92 offen sc1
    buffer_load_dword v28, off, s[32:35], s86 sc1
    s_branch K1_LB_BACK
K1_LS_MASK:
    s_cmp_eq_u32 s78, 1
    s_cbranch_scc1 K1_LS_LAST
    buffer_load_dword v3, v29, s[32:35], s92 offen sc1
    buffer_load_dword v28, off, s[32:35], s86 sc1
    v_mov_b32 v218, 1
    s_cmp_eq_u64 s[84:85], 0
    s_cselect_b32 s7, s74, 1073741824
    s_cmp_lg_u32 s83, 0
    s_cselect_b32 s7, s74, s7
    s_waitcnt vmcnt(10)
    buffer_store_dword v218, v216, s[32:35], s7 offen sc1
    s_branch K1_LS_BACK
K1_LS_LAST:
    v_add_f32 v212, s12, v152
    v_fma_f32 v176, v208, s8, v212
    v_fma_f32 v177, v209, s8, v212
    v_fma_f32 v178, v210, s8, v212
    v_fma_f32 v179, v211, s8, v212
    v_add_f32 v213, s13, v152
    v_fma_f32 v180, v208, s9, v213
    v_fma_f32 v181, v209, s9, v213
    v_fma_f32 v182, v210, s9, v213
    v_fma_f32 v183, v211, s9, v213
    v_add_f32 v212, s14, v152
    v_fma_f32 v184, v208, s10, v212
    v_fma_f32 v185, v209, s10, v212
    v_fma_f32 v186, v210, s10, v212
    v_fma_f32 v187, v211, s10, v212
    v_add_f32 v213, s15, v152
    v_fma_f32 v188, v208, s11, v213
    v_fma_f32 v189, v209, s11, v213
    v_fma_f32 v190, v210, s11, v213
    v_fma_f32 v191, v211, s11, v213
    v_cmp_gt_u32 vcc, 2, v28
    s_nop 1
    s_and_b64 vcc, vcc, exec
    s_cbranch_scc1 SPIN_W0H
BACK_W0H:
    s_lshl4_add_u32 s7, s73, s87
    buffer_load_dwordx4 a[128:131], v1, s[40:43], s7 offen sc1
    buffer_load_dwordx4 a[132:135], v1, s[40:43], s87 offen offset:1024 sc1
    v_cmp_gt_u32 vcc, 1, v3
    s_nop 1
    s_cmp_lg_u32 vcc_lo, 0
    s_cbranch_scc1 SPIN_W0
BACK_W0:
    s_mov_b64 s[36:37], s[56:57]
    s_mov_b32 s38, 5603328
    s_xor_b32 s77, s3, 0
    s_lshl2_add_u32 s77, s77, s4
    s_mul_i32 s77, s77, 36864
    s_add_u32 s77, s77, s28
    s_branch K1_LS_BACK
K1_WMASK:
    v_mov_b32 v9, 0xf149f2ca
    v_cmp_le_u32 vcc, 2, v14
    s_nop 1
    v_cndmask_b32 v141, v9, v141, vcc
    v_cmp_le_u32 vcc, 4, v14
    s_nop 1
    v_cndmask_b32 v142, v9, v142, vcc
    v_cmp_le_u32 vcc, 6, v14
    s_nop 1
    v_cndmask_b32 v143, v9, v143, vcc
    v_cmp_le_u32 vcc, 8, v14
    s_nop 1
    v_cndmask_b32 v144, v9, v144, vcc
    v_cmp_le_u32 vcc, 10, v14
    s_nop 1
    v_cndmask_b32 v145, v9, v145, vcc
    v_cmp_le_u32 vcc, 12, v14
    s_nop 1
    v_cndmask_b32 v146, v9, v146, vcc
    v_cmp_le_u32 vcc, 14, v14
    s_nop 1
    v_cndmask_b32 v147, v9, v147, vcc
    s_branch K1_WMASK_BACK
K1_S7:
    v_mov_b32 v218, 1
    s_cmp_eq_u64 s[84:85], 0
    s_cselect_b32 s7, s74, 1073741824
    s_cmp_lg_u32 s83, 0
    s_cselect_b32 s7, s74, s7
    s_waitcnt vmcnt(8)
    buffer_store_dword v218, v216, s[32:35], s7 offen sc1
    s_branch K1_S7_BACK
K1_J7:
    v_cmp_gt_u32 vcc, 2, v28
    s_nop 1
    s_and_b64 vcc, vcc, exec
    s_cbranch_scc1 SPIN_W7H
BACK_W7H:
    s_lshl4_add_u32 s7, s73, s87
    buffer_load_dwordx4 a[128:131], v1, s[40:43], s7 offen sc1
    buffer_load_dwordx4 a[132:135], v1, s[40:43], s87 offen offset:1024 sc1
    v_cmp_gt_u32 vcc, 1, v3
    s_nop 1
    s_cmp_lg_u32 vcc_lo, 0
    s_cbranch_scc1 SPIN_W7
BACK_W7:
    s_mov_b64 s[36:37], s[56:57]
    s_mov_b32 s38, 5603328
    s_xor_b32 s77, s3, 0
    s_lshl2_add_u32 s77, s77, s4
    s_mul_i32 s77, s77, 36864
    s_add_u32 s77, s77, s28
    s_branch K1_J7_BACK
K1_REDO:
    s_mov_b32 s83, 1
    s_mov_b32 s63, 1073741824
    s_mov_b32 s64, 1073741824
    s_mov_b32 s62, 1073741824
    s_mul_i32 s7, s5, 1081344
    s_sub_u32 s7, 56623104, s7
    s_sub_u32 s36, s56, s7
    s_subb_u32 s37, s57, 0
    s_mov_b32 s38, 1081344
    s_mov_b32 s50, 0
    s_mov_b32 s54, 0
    s_waitcnt vmcnt(0) lgkmcnt(0)
    s_barrier
    v_lshrrev_b32 v92, 4, v1
    v_and_b32 v64, 15, v92
    v_lshrrev_b32 v92, 4, v92
    v_lshlrev_b32 v92, 2, v92
    v_sub_u32 v92, v64, v92
    s_lshl_b32 s98, s4, 4
    v_add_u32 v92, s98, v92
    s_lshl_b32 s98, s6, 7
    s_sub_u32 s99, 1920, s98
    v_add_u32 v64, s98, v92
    v_add_u32 v65, 64, v64
    v_add_u32 v66, s99, v92
    v_add_u32 v67, 64, v66
    v_mov_b32 v93, 0xf149f2ca
    v_mov_b32 v68, v93
    v_mov_b32 v69, v93
    v_mov_b32 v70, v93
    v_mov_b32 v71, v93
    s_mov_b32 s78, 0
    s_add_u32 s99, s99, 128
K1_REDO_L:
    s_lshr_b32 s7, s78, 6
    s_lshl_b32 s7, s7, 15
    s_bfe_u32 s98, s78, 0x20004
    s_lshl_b32 s98, s98, 12
    s_add_u32 s7, s7, s98
    buffer_load_dwordx4 v[72:75], v1, s[36:39], s7 offen offset:0 sc1
    buffer_load_dwordx4 v[76:79], v1, s[36:39], s7 offen offset:1024 sc1
    buffer_load_dwordx4 v[80:83], v1, s[36:39], s7 offen offset:2048 sc1
    buffer_load_dwordx4 v[84:87], v1, s[36:39], s7 offen offset:3072 sc1
    s_waitcnt vmcnt(0)
    v_mfma_f32_16x16x32_bf16 v[88:91], v[72:75], v[128:131], 0
    v_mfma_f32_16x16x32_bf16 v[88:91], v[76:79], v[160:163], v[88:91]
    v_mfma_f32_16x16x32_bf16 v[88:91], v[80:83], v[192:195], v[88:91]
    v_mfma_f32_16x16x32_bf16 v[88:91], v[84:87], v[224:227], v[88:91]
    v_subrev_u32 v92, s78, v64
    v_cmp_le_i32 vcc, 0, v92
    s_nop 5
    v_cndmask_b32 v88, v93, v88, vcc
    v_max_f32 v68, v68, v88
    v_cmp_le_i32 vcc, 1, v92
    s_nop 1
    v_cndmask_b32 v89, v93, v89, vcc
    v_max_f32 v68, v68, v89
    v_cmp_le_i32 vcc, 2, v92
    s_nop 1
    v_cndmask_b32 v90, v93, v90, vcc
    v_max_f32 v68, v68, v90
    v_cmp_le_i32 vcc, 3, v92
    s_nop 1
    v_cndmask_b32 v91, v93, v91, vcc
    v_max_f32 v68, v68, v91
    v_mfma_f32_16x16x32_bf16 v[88:91], v[72:75], v[132:135], 0
    v_mfma_f32_16x16x32_bf16 v[88:91], v[76:79], v[164:167], v[88:91]
    v_mfma_f32_16x16x32_bf16 v[88:91], v[80:83], v[196:199], v[88:91]
    v_mfma_f32_16x16x32_bf16 v[88:91], v[84:87], v[228:231], v[88:91]
    v_subrev_u32 v92, s78, v65
    v_cmp_le_i32 vcc, 0, v92
    s_nop 5
    v_cndmask_b32 v88, v93, v88, vcc
    v_max_f32 v69, v69, v88
    v_cmp_le_i32 vcc, 1, v92
    s_nop 1
    v_cndmask_b32 v89, v93, v89, vcc
    v_max_f32 v69, v69, v89
    v_cmp_le_i32 vcc, 2, v92
    s_nop 1
    v_cndmask_b32 v90, v93, v90, vcc
    v_max_f32 v69, v69, v90
    v_cmp_le_i32 vcc, 3, v92
    s_nop 1
    v_cndmask_b32 v91, v93, v91, vcc
    v_max_f32 v69, v69, v91
    v_mfma_f32_16x16x32_bf16 v[88:91], v[72:75], v[136:139], 0
    v_mfma_f32_16x16x32_bf16 v[88:91], v[76:79], v[168:171], v[88:91]
    v_mfma_f32_16x16x32_bf16 v[88:91], v[80:83], v[200:203], v[88:91]
    v_mfma_f32_16x16x32_bf16 v[88:91], v[84:87], v[232:235], v[88:91]
    v_subrev_u32 v92, s78, v66
    v_cmp_le_i32 vcc, 0, v92
    s_nop 5
    v_cndmask_b32 v88, v93, v88, vcc
    v_max_f32 v70, v70, v88
    v_cmp_le_i32 vcc, 1, v92
    s_nop 1
    v_cndmask_b32 v89, v93, v89, vcc
    v_max_f32 v70, v70, v89
    v_cmp_le_i32 vcc, 2, v92
    s_nop 1
    v_cndmask_b32 v90, v93, v90, vcc
    v_max_f32 v70, v70, v90
    v_cmp_le_i32 vcc, 3, v92
    s_nop 1
    v_cndmask_b32 v91, v93, v91, vcc
    v_max_f32 v70, v70, v91
    v_mfma_f32_16x16x32_bf16 v[88:91], v[72:75], v[140:143], 0
    v_mfma_f32_16x16x32_bf16 v[88:91], v[76:79], v[172:175], v[88:91]
    v_mfma_f32_16x16x32_bf16 v[88:91], v[80:83], v[204:207], v[88:91]
    v_mfma_f32_16x16x32_bf16 v[88:91], v[84:87], v[236:239], v[88:91]
    v_subrev_u32 v92, s78, v67
    v_cmp_le_i32 vcc, 0, v92
    s_nop 5
    v_cndmask_b32 v88, v93, v88, vcc
    v_max_f32 v71, v71, v88
    v_cmp_le_i32 vcc, 1, v92
    s_nop 1
    v_cndmask_b32 v89, v93, v89, vcc
    v_max_f32 v71, v71, v89
    v_cmp_le_i32 vcc, 2, v92
    s_nop 1
    v_cndmask_b32 v90, v93, v90, vcc
    v_max_f32 v71, v71, v90
    v_cmp_le_i32 vcc, 3, v92
    s_nop 1
    v_cndmask_b32 v91, v93, v91, vcc
    v_max_f32 v71, v71, v91
    s_add_u32 s78, s78, 16
    s_cmp_lt_u32 s78, s99
    s_cbranch_scc1 K1_REDO_L
    v_mov_b32 v92, v68
    s_nop 1
    v_permlane32_swap_b32 v68, v92
    v_max_f32 v68, v68, v92
    v_mov_b32 v92, v68
    s_nop 1
    v_permlane16_swap_b32 v68, v92
    v_max_f32 v68, v68, v92
    v_sub_f32 v144, 0, v68
    v_sub_f32 v145, 0, v68
    v_sub_f32 v146, 0, v68
    v_sub_f32 v147, 0, v68
    v_mov_b32 v92, v69
    s_nop 1
    v_permlane32_swap_b32 v69, v92
    v_max_f32 v69, v69, v92
    v_mov_b32 v92, v69
    s_nop 1
    v_permlane16_swap_b32 v69, v92
    v_max_f32 v69, v69, v92
    v_sub_f32 v148, 0, v69
    v_sub_f32 v149, 0, v69
    v_sub_f32 v150, 0, v69
    v_sub_f32 v151, 0, v69
    v_mov_b32 v92, v70
    s_nop 1
    v_permlane32_swap_b32 v70, v92
    v_max_f32 v70, v70, v92
    v_mov_b32 v92, v70
    s_nop 1
    v_permlane16_swap_b32 v70, v92
    v_max_f32 v70, v70, v92
    v_sub_f32 v152, 0, v70
    v_sub_f32 v153, 0, v70
    v_sub_f32 v154, 0, v70
    v_sub_f32 v155, 0, v70
    v_mov_b32 v92, v71
    s_nop 1
    v_permlane32_swap_b32 v71, v92
    v_max_f32 v71, v71, v92
    v_mov_b32 v92, v71
    s_nop 1
    v_permlane16_swap_b32 v71, v92
    v_max_f32 v71, v71, v92
    v_sub_f32 v156, 0, v71
    v_sub_f32 v157, 0, v71
    v_sub_f32 v158, 0, v71
    v_sub_f32 v159, 0, v71
    v_accvgpr_write_b32 a0, 0
    v_accvgpr_write_b32 a1, 0
    v_accvgpr_write_b32 a2, 0
    v_accvgpr_write_b32 a3, 0
    v_accvgpr_write_b32 a4, 0
    v_accvgpr_write_b32 a5, 0
    v_accvgpr_write_b32 a6, 0
    v_accvgpr_write_b32 a7, 0
    v_accvgpr_write_b32 a8, 0
    v_accvgpr_write_b32 a9, 0
    v_accvgpr_write_b32 a10, 0
    v_accvgpr_write_b32 a11, 0
    v_accvgpr_write_b32 a12, 0
    v_accvgpr_write_b32 a13, 0
    v_accvgpr_write_b32 a14, 0
    v_accvgpr_write_b32 a15, 0
    v_accvgpr_write_b32 a16, 0
    v_accvgpr_write_b32 a17, 0
    v_accvgpr_write_b32 a18, 0
    v_accvgpr_write_b32 a19, 0
    v_accvgpr_write_b32 a20, 0
    v_accvgpr_write_b32 a21, 0
    v_accvgpr_write_b32 a22, 0
    v_accvgpr_write_b32 a23, 0
    v_accvgpr_write_b32 a24, 0
    v_accvgpr_write_b32 a25, 0
    v_accvgpr_write_b32 a26, 0
    v_accvgpr_write_b32 a27, 0
    v_accvgpr_write_b32 a28, 0
    v_accvgpr_write_b32 a29, 0
    v_accvgpr_write_b32 a30, 0
    v_accvgpr_write_b32 a31, 0
    v_accvgpr_write_b32 a32, 0
    v_accvgpr_write_b32 a33, 0
    v_accvgpr_write_b32 a34, 0
    v_accvgpr_write_b32 a35, 0
    v_accvgpr_write_b32 a36, 0
    v_accvgpr_write_b32 a37, 0
    v_accvgpr_write_b32 a38, 0
    v_accvgpr_write_b32 a39, 0
    v_accvgpr_write_b32 a40, 0
    v_accvgpr_write_b32 a41, 0
    v_accvgpr_write_b32 a42, 0
    v_accvgpr_write_b32 a43, 0
    v_accvgpr_write_b32 a44, 0
    v_accvgpr_write_b32 a45, 0
    v_accvgpr_write_b32 a46, 0
    v_accvgpr_write_b32 a47, 0
    v_accvgpr_write_b32 a48, 0
    v_accvgpr_write_b32 a49, 0
    v_accvgpr_write_b32 a50, 0
    v_accvgpr_write_b32 a51, 0
    v_accvgpr_write_b32 a52, 0
    v_accvgpr_write_b32 a53, 0
    v_accvgpr_write_b32 a54, 0
    v_accvgpr_write_b32 a55, 0
    v_accvgpr_write_b32 a56, 0
    v_accvgpr_write_b32 a57, 0
    v_accvgpr_write_b32 a58, 0
    v_accvgpr_write_b32 a59, 0
    v_accvgpr_write_b32 a60, 0
    v_accvgpr_write_b32 a61, 0
    v_accvgpr_write_b32 a62, 0
    v_accvgpr_write_b32 a63, 0
    v_accvgpr_write_b32 a144, 0
    v_accvgpr_write_b32 a145, 0
    v_accvgpr_write_b32 a146, 0
    v_accvgpr_write_b32 a147, 0
    v_accvgpr_write_b32 a148, 0
    v_accvgpr_write_b32 a149, 0
    v_accvgpr_write_b32 a150, 0
    v_accvgpr_write_b32 a151, 0
    v_accvgpr_write_b32 a152, 0
    v_accvgpr_write_b32 a153, 0
    v_accvgpr_write_b32 a154, 0
    v_accvgpr_write_b32 a155, 0
    v_accvgpr_write_b32 a156, 0
    v_accvgpr_write_b32 a157, 0
    v_accvgpr_write_b32 a158, 0
    v_accvgpr_write_b32 a159, 0
    v_accvgpr_write_b32 a160, 0
    v_accvgpr_write_b32 a161, 0
    v_accvgpr_write_b32 a162, 0
    v_accvgpr_write_b32 a163, 0
    v_accvgpr_write_b32 a164, 0
    v_accvgpr_write_b32 a165, 0
    v_accvgpr_write_b32 a166, 0
    v_accvgpr_write_b32 a167, 0
    v_accvgpr_write_b32 a168, 0
    v_accvgpr_write_b32 a169, 0
    v_accvgpr_write_b32 a170, 0
    v_accvgpr_write_b32 a171, 0
    v_accvgpr_write_b32 a172, 0
    v_accvgpr_write_b32 a173, 0
    v_accvgpr_write_b32 a174, 0
    v_accvgpr_write_b32 a175, 0
    v_accvgpr_write_b32 a176, 0
    v_accvgpr_write_b32 a177, 0
    v_accvgpr_write_b32 a178, 0
    v_accvgpr_write_b32 a179, 0
    v_accvgpr_write_b32 a180, 0
    v_accvgpr_write_b32 a181, 0
    v_accvgpr_write_b32 a182, 0
    v_accvgpr_write_b32 a183, 0
    v_accvgpr_write_b32 a184, 0
    v_accvgpr_write_b32 a185, 0
    v_accvgpr_write_b32 a186, 0
    v_accvgpr_write_b32 a187, 0
    v_accvgpr_write_b32 a188, 0
    v_accvgpr_write_b32 a189, 0
    v_accvgpr_write_b32 a190, 0
    v_accvgpr_write_b32 a191, 0
    v_accvgpr_write_b32 a192, 0
    v_accvgpr_write_b32 a193, 0
    v_accvgpr_write_b32 a194, 0
    v_accvgpr_write_b32 a195, 0
    v_accvgpr_write_b32 a196, 0
    v_accvgpr_write_b32 a197, 0
    v_accvgpr_write_b32 a198, 0
    v_accvgpr_write_b32 a199, 0
    v_accvgpr_write_b32 a200, 0
    v_accvgpr_write_b32 a201, 0
    v_accvgpr_write_b32 a202, 0
    v_accvgpr_write_b32 a203, 0
    v_accvgpr_write_b32 a204, 0
    v_accvgpr_write_b32 a205, 0
    v_accvgpr_write_b32 a206, 0
    v_accvgpr_write_b32 a207, 0
    v_accvgpr_write_b32 a208, 0
    v_accvgpr_write_b32 a209, 0
    v_accvgpr_write_b32 a210, 0
    v_accvgpr_write_b32 a211, 0
    v_accvgpr_write_b32 a212, 0
    v_accvgpr_write_b32 a213, 0
    v_accvgpr_write_b32 a214, 0
    v_accvgpr_write_b32 a215, 0
    v_accvgpr_write_b32 a216, 0
    v_accvgpr_write_b32 a217, 0
    v_accvgpr_write_b32 a218, 0
    v_accvgpr_write_b32 a219, 0
    v_accvgpr_write_b32 a220, 0
    v_accvgpr_write_b32 a221, 0
    v_accvgpr_write_b32 a222, 0
    v_accvgpr_write_b32 a223, 0
    v_bfe_u32 v92, v1, 4, 1
    v_sub_u32 v92, 0, v92
    v_and_b32 v92, 0xaaaaaaaa, v92
    v_or_b32 v215, 0x44444444, v92
    v_bfe_u32 v92, v1, 5, 1
    v_cmp_eq_u32 vcc, 0, v92
    v_mov_b32 v92, 0x3f803f80
    s_nop 0
    v_cndmask_b32 v92, 0, v92, vcc
    v_accvgpr_write_b32 a136, v92
    v_accvgpr_write_b32 a137, v92
    v_accvgpr_write_b32 a138, v92
    v_accvgpr_write_b32 a139, v92
    s_mov_b32 s77, s75
    s_mov_b32 s76, 0
    s_mov_b32 s38, 16384
    s_add_u32 m0, s76, s75
    s_nop 0
    buffer_load_dwordx4 v1, s[36:39], s77 offen sc1 lds
    buffer_load_dwordx4 v1, s[36:39], s77 offen offset:1024 sc1 lds
    buffer_load_dwordx4 v1, s[36:39], s77 offen offset:2048 sc1 lds
    buffer_load_dwordx4 v1, s[36:39], s77 offen offset:3072 sc1 lds
    s_add_u32 s100, s77, 4096
    s_add_u32 m0, m0, 4096
    s_nop 0
    buffer_load_dwordx4 v1, s[36:39], s100 offen sc1 lds
    buffer_load_dwordx4 v1, s[36:39], s100 offen offset:1024 sc1 lds
    buffer_load_dwordx4 v1, s[36:39], s100 offen offset:2048 sc1 lds
    buffer_load_dwordx4 v1, s[36:39], s100 offen offset:3072 sc1 lds
    s_add_u32 s77, s77, 32768
    s_add_u32 s76, s76, 32768
    s_lshr_b32 s82, s4, 1
    s_add_u32 s82, s82, 32
    s_sub_u32 s82, s82, s6
    s_sub_u32 s82, s82, s6
    s_lshl_b32 s38, s82, 15
    s_add_u32 m0, s76, s75
    s_nop 0
    buffer_load_dwordx4 v1, s[36:39], s77 offen sc1 lds
    buffer_load_dwordx4 v1, s[36:39], s77 offen offset:1024 sc1 lds
    buffer_load_dwordx4 v1, s[36:39], s77 offen offset:2048 sc1 lds
    buffer_load_dwordx4 v1, s[36:39], s77 offen offset:3072 sc1 lds
    s_add_u32 s100, s77, 4096
    s_add_u32 m0, m0, 4096
    s_nop 0
    buffer_load_dwordx4 v1, s[36:39], s100 offen sc1 lds
    buffer_load_dwordx4 v1, s[36:39], s100 offen offset:1024 sc1 lds
    buffer_load_dwordx4 v1, s[36:39], s100 offen offset:2048 sc1 lds
    buffer_load_dwordx4 v1, s[36:39], s100 offen offset:3072 sc1 lds
    s_add_u32 s77, s77, 32768
    s_add_u32 s76, s76, 32768
    s_add_u32 m0, s76, s75
    s_nop 0
    buffer_load_dwordx4 v1, s[36:39], s77 offen sc1 lds
    buffer_load_dwordx4 v1, s[36:39], s77 offen offset:1024 sc1 lds
    buffer_load_dwordx4 v1, s[36:39], s77 offen offset:2048 sc1 lds
    buffer_load_dwordx4 v1, s[36:39], s77 offen offset:3072 sc1 lds
    s_add_u32 s100, s77, 4096
    s_add_u32 m0, m0, 4096
    s_nop 0
    buffer_load_dwordx4 v1, s[36:39], s100 offen sc1 lds
    buffer_load_dwordx4 v1, s[36:39], s100 offen offset:1024 sc1 lds
    buffer_load_dwordx4 v1, s[36:39], s100 offen offset:2048 sc1 lds
    buffer_load_dwordx4 v1, s[36:39], s100 offen offset:3072 sc1 lds
    s_add_u32 s77, s77, 32768
    s_add_u32 s76, s76, 32768
    s_add_u32 s86, s101, 4096
    s_mov_b32 s87, 3072
    s_cmp_eq_u32 s6, 7
    s_cselect_b32 s86, s101, s86
    s_cselect_b32 s87, 0, s87
    s_sub_u32 s7, s101, 4096
    s_mov_b32 s98, 0
    s_cmp_eq_u32 s6, 0
    s_cselect_b32 s7, s101, s7
    s_cselect_b32 s98, 1073741824, s98
    s_bitcmp1_b32 s4, 0
    s_cselect_b32 s86, s86, s7
    s_cselect_b32 s87, s87, s98
    s_mul_i32 s7, s86, 48
    s_add_u32 s87, s87, s7
    s_add_u32 s87, s87, 19922944
    s_mov_b32 s82, 0
    s_mov_b32 s95, 32768
    s_mov_b32 s93, 65536
    s_mov_b32 s60, 131072
    v_mov_b32 v2, v1
    s_cmp_eq_u32 s6, 0
    s_cselect_b32 s16, s8, 0
    s_cselect_b32 s17, s9, 0
    s_cmp_eq_u32 s6, 0
    s_cselect_b32 s18, s10, 0
    s_cselect_b32 s19, s11, 0
    s_cmp_eq_u32 s6, 0
    s_cselect_b32 s20, s12, 0
    s_cselect_b32 s21, s13, 0
    s_cmp_eq_u32 s6, 0
    s_cselect_b32 s22, s14, 0
    s_cselect_b32 s23, s15, 0
    s_waitcnt vmcnt(16)
    s_barrier
    ds_read_b128 a[224:227], v2 offset:0
    ds_read_b128 a[228:231], v2 offset:1024
    ds_read_b128 a[232:235], v2 offset:2048
    ds_read_b128 a[236:239], v2 offset:3072
    s_waitcnt lgkmcnt(0)
    ds_read_b128 a[240:243], v2 offset:4096
    ds_read_b128 a[244:247], v2 offset:5120
    ds_read_b128 a[248:251], v2 offset:6144
    ds_read_b128 a[252:255], v2 offset:7168
    v_mul_f32 v176, s16, v208
    v_mul_f32 v177, s16, v209
    v_mul_f32 v178, s16, v210
    v_mul_f32 v179, s16, v211
    s_nop 1
    v_mfma_f32_16x16x32_bf16 v[240:243], a[224:227], v[128:131], v[176:179]
    v_mfma_f32_16x16x32_bf16 v[240:243], a[228:231], v[160:163], v[240:243]
    v_mfma_f32_16x16x32_bf16 v[240:243], a[232:235], v[192:195], v[240:243]
    v_mfma_f32_16x16x32_bf16 v[240:243], a[236:239], v[224:227], v[240:243]
    v_mfma_f32_16x16x32_bf16 v[244:247], a[224:227], v[132:135], 0
    v_mfma_f32_16x16x32_bf16 v[244:247], a[228:231], v[164:167], v[244:247]
    v_mfma_f32_16x16x32_bf16 v[244:247], a[232:235], v[196:199], v[244:247]
    v_mfma_f32_16x16x32_bf16 v[244:247], a[236:239], v[228:231], v[244:247]
    v_mfma_f32_16x16x32_bf16 v[248:251], a[224:227], v[136:139], 0
    v_mfma_f32_16x16x32_bf16 v[248:251], a[228:231], v[168:171], v[248:251]
    v_mfma_f32_16x16x32_bf16 v[248:251], a[232:235], v[200:203], v[248:251]
    v_mfma_f32_16x16x32_bf16 v[248:251], a[236:239], v[232:235], v[248:251]
    v_mfma_f32_16x16x32_bf16 v[252:255], a[224:227], v[140:143], 0
    v_mfma_f32_16x16x32_bf16 v[252:255], a[228:231], v[172:175], v[252:255]
    v_mfma_f32_16x16x32_bf16 v[252:255], a[232:235], v[204:207], v[252:255]
    v_mfma_f32_16x16x32_bf16 v[252:255], a[236:239], v[236:239], v[252:255]
    v_add_f32 v240, v240, v144
    v_exp_f32 v240, v240
    v_add_f32 v241, v241, v144
    v_exp_f32 v241, v241
    v_add_f32 v242, v242, v144
    v_exp_f32 v242, v242
    v_add_f32 v243, v243, v144
    v_exp_f32 v243, v243
    v_add_f32 v244, v244, v148
    v_exp_f32 v244, v244
    v_add_f32 v245, v245, v148
    v_exp_f32 v245, v245
    v_add_f32 v246, v246, v148
    v_exp_f32 v246, v246
    v_add_f32 v247, v247, v148
    v_exp_f32 v247, v247
    v_add_f32 v248, v248, v152
    v_exp_f32 v248, v248
    v_add_f32 v249, v249, v152
    v_exp_f32 v249, v249
    v_add_f32 v250, v250, v152
    v_exp_f32 v250, v250
    v_add_f32 v251, v251, v152
    v_exp_f32 v251, v251
    v_add_f32 v252, v252, v156
    v_exp_f32 v252, v252
    v_add_f32 v253, v253, v156
    v_exp_f32 v253, v253
    v_add_f32 v254, v254, v156
    v_exp_f32 v254, v254
    v_add_f32 v255, v255, v156
    v_exp_f32 v255, v255
    s_nop 1
    s_branch K1_ATT
SPIN_WA:
    s_mov_b32 s94, 0
SPIN_WA_L:
    s_sleep 2
    buffer_load_dword v7, v9, s[44:47], s69 offen sc1
    s_add_u32 s94, s94, 1
    s_cmp_ge_u32 s94, 0x40000
    s_waitcnt vmcnt(0)
    s_cbranch_scc1 BACK_WA
    v_cmp_gt_u32 vcc, 8, v7
    s_nop 1
    s_and_b64 vcc, vcc, s[86:87]
    s_cbranch_scc1 SPIN_WA_L
    s_branch BACK_WA
SPIN_KV:
    s_mov_b32 s94, 0
SPIN_KV_L:
    s_sleep 2
    buffer_load_dword v7, v8, s[32:35], s61 offen sc1
    s_add_u32 s94, s94, 1
    s_cmp_ge_u32 s94, 0x40000
    s_waitcnt vmcnt(0)
    s_cbranch_scc1 BACK_KV
    v_cmp_gt_u32 vcc, 1, v7
    s_nop 1
    s_and_b64 vcc, vcc, exec
    s_cbranch_scc1 SPIN_KV_L
    s_branch BACK_KV
SPIN_SHORT:
    s_mov_b32 s94, 0
SPIN_SHORT_L:
    s_sleep 2
    buffer_load_dword v3, v217, s[32:35], s19 offen sc1
    s_add_u32 s94, s94, 1
    s_cmp_ge_u32 s94, 0x40000
    s_waitcnt vmcnt(0)
    s_cbranch_scc1 BACK_SHORT
    v_cmp_gt_u32 vcc, 1, v3
    s_nop 1
    s_and_b64 vcc, vcc, exec
    s_cbranch_scc1 SPIN_SHORT_L
    s_branch BACK_SHORT
SPIN_CTX:
    s_mov_b32 s94, 0
SPIN_CTX_L:
    s_sleep 2
    buffer_load_dword v3, v217, s[32:35], s19 offen sc1
    s_add_u32 s94, s94, 1
    s_cmp_ge_u32 s94, 0x40000
    s_waitcnt vmcnt(0)
    s_cbranch_scc1 BACK_CTX
    v_cmp_gt_u32 vcc, 2, v3
    s_nop 1
    s_and_b64 vcc, vcc, exec
    s_cbranch_scc1 SPIN_CTX_L
    s_branch BACK_CTX
SPIN_ALL:
    s_mov_b32 s94, 0
SPIN_ALL_L:
    s_sleep 2
    buffer_load_dword v28, v29, s[32:35], s92 offen sc1
    s_add_u32 s94, s94, 1
    s_cmp_ge_u32 s94, 0x40000
    s_waitcnt vmcnt(0)
    s_cbranch_scc1 BACK_ALL
    v_cmp_gt_u32 vcc, 1, v28
    s_nop 1
    s_and_b64 vcc, vcc, exec
    s_cbranch_scc1 SPIN_ALL_L
    s_branch BACK_ALL
SPIN_OA:
    s_mov_b32 s94, 0
SPIN_OA_L:
    s_sleep 2
    buffer_load_dword v3, v19, s[32:35], s66 offen sc1
    s_add_u32 s94, s94, 1
    s_cmp_ge_u32 s94, 0x40000
    s_waitcnt vmcnt(0)
    s_cbranch_scc1 BACK_OA
    v_cmp_gt_u32 vcc, 3, v3
    s_nop 1
    s_and_b64 vcc, vcc, exec
    s_cbranch_scc1 SPIN_OA_L
    s_branch BACK_OA
SPIN_X:
    s_mov_b32 s94, 0
SPIN_X_L:
    s_sleep 2
    buffer_load_dword v3, v19, s[32:35], s66 offen sc1
    s_add_u32 s94, s94, 1
    s_cmp_ge_u32 s94, 0x40000
    s_waitcnt vmcnt(0)
    s_cbranch_scc1 BACK_X
    v_cmp_gt_u32 vcc, 3, v3
    s_nop 1
    s_and_b64 vcc, vcc, exec
    s_cbranch_scc1 SPIN_X_L
    s_branch BACK_X
SPIN_W0H:
    s_mov_b32 s94, 0
SPIN_W0H_L:
    s_sleep 2
    buffer_load_dword v28, off, s[32:35], s86 sc1
    s_add_u32 s94, s94, 1
    s_cmp_ge_u32 s94, 0x40000
    s_waitcnt vmcnt(0)
    s_cbranch_scc1 BACK_W0H
    v_cmp_gt_u32 vcc, 2, v28
    s_nop 1
    s_and_b64 vcc, vcc, exec
    s_cbranch_scc1 SPIN_W0H_L
    s_branch BACK_W0H
SPIN_W0:
    s_mov_b32 s94, 0
SPIN_W0_L:
    s_sleep 2
    buffer_load_dword v3, v29, s[32:35], s92 offen sc1
    s_add_u32 s94, s94, 1
    s_cmp_ge_u32 s94, 0x40000
    s_waitcnt vmcnt(0)
    s_cbranch_scc1 BACK_W0
    v_cmp_gt_u32 vcc, 1, v3
    s_nop 1
    s_cmp_lg_u32 vcc_lo, 0
    s_cbranch_scc1 SPIN_W0_L
    s_branch BACK_W0
SPIN_W7H:
    s_mov_b32 s94, 0
SPIN_W7H_L:
    s_sleep 2
    buffer_load_dword v28, off, s[32:35], s86 sc1
    s_add_u32 s94, s94, 1
    s_cmp_ge_u32 s94, 0x40000
    s_waitcnt vmcnt(0)
    s_cbranch_scc1 BACK_W7H
    v_cmp_gt_u32 vcc, 2, v28
    s_nop 1
    s_and_b64 vcc, vcc, exec
    s_cbranch_scc1 SPIN_W7H_L
    s_branch BACK_W7H
SPIN_W7:
    s_mov_b32 s94, 0
SPIN_W7_L:
    s_sleep 2
    buffer_load_dword v3, v29, s[32:35], s92 offen sc1
    s_add_u32 s94, s94, 1
    s_cmp_ge_u32 s94, 0x40000
    s_waitcnt vmcnt(0)
    s_cbranch_scc1 BACK_W7
    v_cmp_gt_u32 vcc, 1, v3
    s_nop 1
    s_cmp_lg_u32 vcc_lo, 0
    s_cbranch_scc1 SPIN_W7_L
    s_branch BACK_W7
.section .rodata,"a"
.p2align 6
.amdhsa_kernel gated_mix__sliding_local_dilated__compressed_kv_cla__prompt_kernel
.amdhsa_next_free_vgpr 512
.amdhsa_next_free_sgpr 102
.amdhsa_accum_offset 256
.amdhsa_group_segment_fixed_size 0
.amdhsa_kernarg_size 104
.amdhsa_user_sgpr_count 2
.amdhsa_user_sgpr_kernarg_segment_ptr 1
.amdhsa_system_sgpr_workgroup_id_x 1
.amdhsa_ieee_mode 0
.amdhsa_dx10_clamp 0
.end_amdhsa_kernel
```

```asm
; @launch grid=(256,1,1) block=(256,1,1) lds=163840
.amdgcn_target "amdgcn-amd-amdhsa--gfx950"
.text
.globl gated_mix__sliding_local_dilated__compressed_kv_cla__prompt_kernel
.p2align 8
.type gated_mix__sliding_local_dilated__compressed_kv_cla__prompt_kernel,@function
gated_mix__sliding_local_dilated__compressed_kv_cla__prompt_kernel:
    s_cmp_ge_u32 s2, 256
    s_cbranch_scc1 K1_END
    s_getpc_b64 s[94:95]
    s_load_dwordx8 s[36:43], s[0:1], 32
    v_min_u32 v74, 16, v0
    s_lshr_b32 s7, s2, 3
    s_mul_i32 s7, s7, 17
    v_add_lshl_u32 v74, v74, s7, 7
    global_load_dword v76, v74, s[94:95]
    v_lshrrev_b32 v64, 6, v0
    v_and_b32 v31, 63, v0
    v_readfirstlane_b32 s4, v64
    s_and_b32 s5, s2, 7
    s_lshl_b32 s5, s5, 2
    s_bfe_u32 s7, s2, 0x20003
    s_add_u32 s5, s5, s7
    s_lshr_b32 s6, s2, 5
    s_lshl_b32 s69, s4, 12
    s_mov_b32 s10, 2097152
    s_mov_b32 s11, 0x20000
    s_mov_b32 s14, 4194304
    s_mov_b32 s15, 0x20000
    s_mov_b32 s18, 4194304
    s_mov_b32 s19, 0x20000
    v_lshrrev_b32 v65, 3, v31
    v_and_b32 v66, 7, v31
    v_lshrrev_b32 v67, 1, v65
    v_xor_b32 v66, v66, v67
    v_lshlrev_b32 v66, 4, v66
    v_xor_b32 v67, 64, v66
    s_lshr_b32 s7, s4, 1
    s_lshl_b32 s73, s7, 7
    s_and_b32 s100, s4, 1
    s_lshl_b32 s98, s100, 5
    s_add_u32 s98, s98, s73
    v_add_lshl_u32 v68, v65, s98, 10
    v_add_u32 v6, v68, v66
    v_add_u32 v7, v68, v67
    v_add_u32 v7, 7168, v7
    v_add_u32 v8, v68, v66
    v_add_u32 v8, 14336, v8
    v_add_u32 v9, v68, v67
    v_add_u32 v9, 21504, v9
    v_lshrrev_b32 v69, 4, v31
    v_and_b32 v70, 15, v31
    v_lshlrev_b32 v71, 1, v69
    v_xor_b32 v71, v71, v70
    v_lshlrev_b32 v71, 4, v71
    v_xor_b32 v72, 128, v71
    s_lshl_b32 s98, s4, 4
    v_add_lshl_u32 v73, v69, s98, 13
    v_add_u32 v2, v73, v71
    v_add_u32 v3, v73, v71
    v_add_u32 v3, 31744, v3
    v_add_u32 v4, v73, v72
    v_add_u32 v4, 63488, v4
    v_add_u32 v5, v73, v72
    v_add_u32 v5, 95232, v5
    s_and_b32 s3, s2, 0
    s_lshl_b32 s66, s3, 7
    s_lshl_b32 s60, s3, 11
    s_add_u32 s60, s60, s5
    s_lshl_b32 s60, s60, 8
    s_lshl_b32 s61, s6, 18
    s_add_u32 s61, s61, s66
    s_add_u32 s62, s61, 65536
    s_waitcnt lgkmcnt(0)
    s_mov_b64 s[8:9], s[36:37]
    s_mov_b64 s[24:25], s[38:39]
    s_mov_b64 s[12:13], s[40:41]
    s_mov_b64 s[16:17], s[42:43]
    s_load_dwordx2 s[20:21], s[0:1], 0
    s_load_dwordx2 s[28:29], s[0:1], 8
    s_load_dwordx2 s[32:33], s[0:1], 72
    s_load_dwordx2 s[48:49], s[0:1], 64
    s_load_dwordx2 s[92:93], s[0:1], 16
    s_load_dwordx2 s[44:45], s[0:1], 88
    s_load_dwordx2 s[56:57], s[0:1], 96
    s_load_dwordx2 s[0:1], s[0:1], 80
    s_add_u32 m0, s69, 0
    s_nop 0
    buffer_load_dwordx4 v6, s[8:11], s61 offen lds
    buffer_load_dwordx4 v7, s[8:11], s61 offen offset:1024 lds
    buffer_load_dwordx4 v8, s[8:11], s61 offen offset:2048 lds
    buffer_load_dwordx4 v9, s[8:11], s61 offen offset:3072 lds
    s_xor_b32 s61, s61, 128
    s_add_u32 m0, s69, 16384
    s_nop 0
    buffer_load_dwordx4 v6, s[8:11], s62 offen lds
    buffer_load_dwordx4 v7, s[8:11], s62 offen offset:1024 lds
    buffer_load_dwordx4 v8, s[8:11], s62 offen offset:2048 lds
    buffer_load_dwordx4 v9, s[8:11], s62 offen offset:3072 lds
    s_xor_b32 s62, s62, 128
    s_add_u32 m0, s69, 32768
    s_nop 0
    buffer_load_dwordx4 v2, s[12:15], s60 offen nt lds
    buffer_load_dwordx4 v3, s[12:15], s60 offen offset:1024 nt lds
    buffer_load_dwordx4 v4, s[12:15], s60 offen offset:2048 nt lds
    buffer_load_dwordx4 v5, s[12:15], s60 offen offset:3072 nt lds
    s_add_u32 m0, s69, 49152
    s_nop 0
    buffer_load_dwordx4 v6, s[8:11], s61 offen lds
    buffer_load_dwordx4 v7, s[8:11], s61 offen offset:1024 lds
    buffer_load_dwordx4 v8, s[8:11], s61 offen offset:2048 lds
    buffer_load_dwordx4 v9, s[8:11], s61 offen offset:3072 lds
    s_xor_b32 s61, s61, 384
    v_min_u32 v74, 15, v31
    s_lshl2_add_u32 s98, s2, s4
    s_lshl_b32 s98, s98, 11
    v_lshlrev_b32 v74, 7, v74
    buffer_load_dword v117, v74, s[8:11], s98 offen
    s_waitcnt lgkmcnt(0)
    s_mov_b32 s22, 2359296
    s_mov_b32 s23, 0x20000
    s_mov_b32 s26, 4718592
    s_mov_b32 s27, 0x20000
    s_mov_b32 s50, 4718592
    s_mov_b32 s51, 0x20000
    s_mov_b32 s46, 256
    s_mov_b32 s47, 0x20000
    s_mov_b32 s30, 1990656
    s_mov_b32 s31, 0x20000
    s_mov_b32 s34, 1152
    s_mov_b32 s35, 0x20000
    s_mul_i32 s7, s5, 1081344
    s_add_u32 s36, s56, s7
    s_addc_u32 s37, s57, 0
    s_mov_b32 s38, 1081344
    s_mov_b32 s39, 0x20000
    s_cmp_eq_u32 s4, 0
    s_cselect_b32 s86, 0x55555555, 0
    s_cselect_b32 s87, 0x55555555, 0
    s_cselect_b32 s52, s48, s92
    s_cselect_b32 s53, s49, s93
    s_cselect_b32 s54, s50, 663552
    s_mov_b32 s55, 0x20000
    s_mul_i32 s63, s6, 147456
    s_sub_u32 s64, 2211840, s63
    s_add_u32 s63, s63, s66
    s_add_u32 s64, s64, s66
    s_lshl_b32 s67, s4, 11
    s_lshl_b32 s68, s4, 10
    s_lshl_b32 s75, s4, 13
    s_lshl_b32 s65, s3, 13
    s_add_u32 s65, s65, s67
    s_lshl_b32 s70, s6, 2
    s_lshl1_add_u32 s70, s100, s70
    s_lshl_b32 s70, s70, 15
    s_lshl_b32 s98, s73, 6
    s_add_u32 s71, s70, s98
    s_add_u32 s71, s71, 49152
    s_lshl_b32 s98, s73, 4
    s_add_u32 s70, s70, s98
    v_lshlrev_b32 v1, 4, v31
    v_mov_b32 v77, 1073741824
    v_cmp_eq_u32 vcc, 0, v0
    s_nop 1
    v_cndmask_b32_e64 v30, v77, 0, vcc
    v_lshlrev_b32 v103, 7, v31
    v_cmp_gt_u32 vcc, 9, v31
    s_nop 1
    v_cndmask_b32 v103, v77, v103, vcc
    s_lshl_b32 s98, s4, 5
    v_add_u32 v68, s98, v65
    v_mul_u32_u24 v68, 1152, v68
    v_add_u32 v10, v68, v66
    v_add_u32 v11, v68, v67
    v_add_u32 v11, 8192, v11
    v_add_u32 v12, v68, v66
    v_add_u32 v12, 16384, v12
    v_add_u32 v13, v68, v67
    v_add_u32 v13, 24576, v13
    v_lshrrev_b32 v71, 1, v70
    v_xor_b32 v71, v71, v69
    v_lshlrev_b32 v71, 4, v71
    v_lshl_add_u32 v71, v70, 7, v71
    s_add_u32 m0, s69, 65536
    s_nop 0
    buffer_load_dwordx4 v2, s[16:19], s60 offen nt lds
    v_xor_b32 v72, 64, v71
    s_lshl_b32 s98, s100, 13
    v_add_u32 v22, s98, v71
    v_add_u32 v23, s98, v72
    v_add_u32 v24, s67, v71
    v_add_u32 v25, s67, v72
    v_bfe_u32 v73, v31, 2, 2
    v_and_b32 v74, 3, v31
    v_lshl_add_u32 v75, v69, 3, v73
    v_and_b32 v78, 1, v69
    v_lshl_add_u32 v77, v78, 2, v73
    v_lshlrev_b32 v77, 5, v77
    v_lshl_add_u32 v77, v74, 3, v77
    v_lshl_add_u32 v77, v75, 8, v77
    v_xor_b32 v14, 0, v77
    v_xor_b32 v14, s73, v14
    buffer_load_dwordx4 v3, s[16:19], s60 offen offset:1024 nt lds
    v_xor_b32 v15, 32, v77
    v_xor_b32 v15, s73, v15
    v_xor_b32 v16, 64, v77
    v_xor_b32 v16, s73, v16
    v_xor_b32 v17, 96, v77
    v_xor_b32 v17, s73, v17
    v_xor_b32 v18, 128, v77
    v_xor_b32 v19, 160, v77
    v_xor_b32 v20, 192, v77
    v_xor_b32 v21, 224, v77
    v_lshrrev_b32 v77, 1, v73
    v_lshl_add_u32 v77, v78, 1, v77
    v_lshlrev_b32 v77, 5, v77
    v_lshl_add_u32 v77, v74, 3, v77
    v_lshl_add_u32 v77, v75, 7, v77
    s_lshr_b32 s98, s73, 1
    buffer_load_dwordx4 v4, s[16:19], s60 offen offset:2048 nt lds
    v_xor_b32 v26, 0, v77
    v_xor_b32 v26, s98, v26
    v_xor_b32 v27, 32, v77
    v_xor_b32 v28, 64, v77
    v_xor_b32 v28, s98, v28
    v_xor_b32 v29, 96, v77
    v_and_b32 v73, 7, v0
    v_lshrrev_b32 v74, 3, v0
    v_lshl_add_u32 v75, v73, 1, 0
    v_mul_u32_u24 v78, 52, v75
    v_lshrrev_b32 v78, 8, v78
    v_mul_u32_u24 v79, 5, v78
    v_sub_u32 v75, v75, v79
    v_add_u32 v78, 1, v78
    v_cmp_le_u32 vcc, 3, v78
    s_nop 1
    v_cndmask_b32_e64 v78, v78, 0, vcc
    buffer_load_dwordx4 v5, s[16:19], s60 offen offset:3072 nt lds
    s_xor_b32 s60, s60, 524288
    v_mul_u32_u24 v78, 1152, v78
    v_lshl_add_u32 v75, v75, 3, v78
    v_mad_u32_u24 v75, v74, 36, v75
    v_lshl_add_u32 v77, v73, 1, 1
    v_mul_u32_u24 v78, 52, v77
    v_lshrrev_b32 v78, 8, v78
    v_mul_u32_u24 v79, 5, v78
    v_sub_u32 v77, v77, v79
    v_add_u32 v78, 1, v78
    v_cmp_le_u32 vcc, 3, v78
    s_nop 1
    v_cndmask_b32_e64 v78, v78, 0, vcc
    v_mul_u32_u24 v78, 1152, v78
    v_lshl_add_u32 v77, v77, 3, v78
    v_mad_u32_u24 v77, v74, 36, v77
    s_mul_i32 s98, s2, 10368
    s_mul_i32 s99, s2, 6
    s_mov_b32 s7, 73728
    v_mul_lo_u32 v95, v74, s7
    v_lshl_add_u32 v95, v73, 4, v95
    v_cmp_eq_u32 s[92:93], 7, v73
    s_add_u32 s56, s56, 56623104
    s_addc_u32 s57, s57, 0
    s_mov_b32 s58, 5603328
    s_mov_b32 s59, 0x20000
    s_lshl_b32 s101, s6, 5
    s_add_u32 s101, s101, s5
    s_lshl_b32 s101, s101, 7
    v_mov_b32 v65, 0
    v_lshrrev_b32 v64, 2, v0
    v_lshlrev_b32 v64, 15, v64
    v_and_b32 v79, 3, v0
    v_lshl_add_u32 v64, v79, 2, v64
    s_mov_b32 s74, 0x3e0293ee
    s_lshl_b32 s95, s5, 3
    s_waitcnt vmcnt(5)
    s_barrier
    ds_read_b128 a[0:3], v22 offset:0
    ds_read_b64_tr_b16 v[40:41], v14 offset:32768
    ds_read_b64_tr_b16 v[42:43], v14 offset:33792
    ds_read_b128 a[4:7], v23 offset:0
    ds_read_b64_tr_b16 v[44:45], v14 offset:40960
    ds_read_b64_tr_b16 v[46:47], v14 offset:41984
    ds_read_b128 a[8:11], v22 offset:2048
    ds_read_b128 a[12:15], v23 offset:2048
    ds_read_b128 a[16:19], v22 offset:4096
    ds_read_b128 a[20:23], v23 offset:4096
    ds_read_b128 a[24:27], v22 offset:6144
    ds_read_b128 a[28:31], v23 offset:6144
    ds_read_b128 a[32:35], v22 offset:16384
    ds_read_b128 a[36:39], v23 offset:16384
    ds_read_b128 a[40:43], v22 offset:18432
    s_waitcnt lgkmcnt(14)
    ds_read_b128 a[44:47], v23 offset:18432
    s_waitcnt lgkmcnt(14)
    ds_read_b128 a[48:51], v22 offset:20480
    s_waitcnt lgkmcnt(14)
    ds_read_b128 a[52:55], v23 offset:20480
    s_waitcnt lgkmcnt(14)
    ds_read_b128 a[56:59], v22 offset:22528
    s_waitcnt lgkmcnt(14)
    ds_read_b128 a[60:63], v23 offset:22528
    v_mfma_f32_16x16x32_bf16 v[128:131], v[40:43], a[0:3], 0
    s_add_u32 m0, s69, 81920
    s_waitcnt lgkmcnt(14)
    ds_read_b64_tr_b16 v[48:49], v15 offset:32768
    s_waitcnt lgkmcnt(14)
    ds_read_b64_tr_b16 v[50:51], v15 offset:33792
    v_mfma_f32_16x16x32_bf16 v[128:131], v[44:47], a[4:7], v[128:131]
    s_mul_i32 s77, s2, 9216
    buffer_load_dwordx4 v6, s[8:11], s62 offen lds
    v_mfma_f32_16x16x32_bf16 v[132:135], v[40:43], a[8:11], 0
    s_mul_i32 s76, s4, 1152
    s_waitcnt lgkmcnt(14)
    ds_read_b128 a[64:67], v22 offset:49152
    s_waitcnt lgkmcnt(13)
    ds_read_b64_tr_b16 v[52:53], v15 offset:40960
    v_mfma_f32_16x16x32_bf16 v[132:135], v[44:47], a[12:15], v[132:135]
    s_add_u32 s77, s77, s76
    ds_read_b64_tr_b16 v[54:55], v15 offset:41984
    s_waitcnt lgkmcnt(10)
    ds_read_b64_tr_b16 v[56:57], v16 offset:32768
    v_mfma_f32_16x16x32_bf16 v[136:139], v[40:43], a[16:19], 0
    s_mul_i32 s76, s4, 1152
    buffer_load_dwordx4 v7, s[8:11], s62 offen offset:1024 lds
    v_mfma_f32_16x16x32_bf16 v[136:139], v[44:47], a[20:23], v[136:139]
    s_mul_i32 s72, s2, 3
    ds_read_b64_tr_b16 v[58:59], v16 offset:33792
    ds_read_b64_tr_b16 v[60:61], v16 offset:40960
    v_mfma_f32_16x16x32_bf16 v[140:143], v[40:43], a[24:27], 0
    s_add_u32 s72, s72, 0
    ds_read_b64_tr_b16 v[62:63], v16 offset:41984
    v_add_u32 v14, 0x10000, v14
    v_mfma_f32_16x16x32_bf16 v[140:143], v[44:47], a[28:31], v[140:143]
    s_mul_i32 s7, s5, 73728
    ds_read_b128 a[68:71], v23 offset:49152
    v_add_u32 v15, 0x10000, v15
    v_mfma_f32_16x16x32_bf16 v[144:147], v[40:43], a[32:35], 0
    s_and_b32 s100, s5, 1
    buffer_load_dwordx4 v8, s[8:11], s62 offen offset:2048 lds
    v_mfma_f32_16x16x32_bf16 v[144:147], v[44:47], a[36:39], v[144:147]
    s_mov_b32 s83, 0
    v_add_u32 v16, 0x10000, v16
    v_mov_b32 v31, 1
    v_mfma_f32_16x16x32_bf16 v[148:151], v[40:43], a[40:43], 0
    s_mov_b32 vcc_lo, 0x84848484
    s_mov_b32 vcc_hi, 0x84848484
    v_add_u32 v18, 0x10000, v18
    s_waitcnt lgkmcnt(2)
    v_mfma_f32_16x16x32_bf16 v[148:151], v[44:47], a[44:47], v[148:151]
    v_add_u32 v19, 0x10000, v19
    v_add_u32 v20, 0x10000, v20
    v_mfma_f32_16x16x32_bf16 v[152:155], v[40:43], a[48:51], 0
    buffer_load_dwordx4 v9, s[8:11], s62 offen offset:3072 lds
    v_mfma_f32_16x16x32_bf16 v[152:155], v[44:47], a[52:55], v[152:155]
    ds_read_b128 a[72:75], v22 offset:51200
    v_add_u32 v21, 0x10000, v21
    v_mfma_f32_16x16x32_bf16 v[156:159], v[40:43], a[56:59], 0
    s_add_u32 m0, s69, 98304
    ds_read_b64_tr_b16 v[40:41], v17 offset:32768
    ds_read_b64_tr_b16 v[42:43], v17 offset:33792
    v_mfma_f32_16x16x32_bf16 v[156:159], v[44:47], a[60:63], v[156:159]
    s_xor_b32 s62, s62, 384
    ds_read_b64_tr_b16 v[44:45], v17 offset:40960
    ds_read_b64_tr_b16 v[46:47], v17 offset:41984
    v_mfma_f32_16x16x32_bf16 v[160:163], v[48:51], a[0:3], 0
    buffer_load_dwordx4 v2, s[12:15], s60 offen nt lds
    v_mfma_f32_16x16x32_bf16 v[160:163], v[52:55], a[4:7], v[160:163]
    v_add_u32 v17, 0x10000, v17
    v_add_u32 v26, 0x10000, v26
    v_mfma_f32_16x16x32_bf16 v[164:167], v[48:51], a[8:11], 0
    ds_read_b128 a[76:79], v23 offset:51200
    v_add_u32 v27, 0x10000, v27
    v_mfma_f32_16x16x32_bf16 v[164:167], v[52:55], a[12:15], v[164:167]
    v_add_u32 v28, 0x10000, v28
    v_add_u32 v29, 0x10000, v29
    v_mfma_f32_16x16x32_bf16 v[168:171], v[48:51], a[16:19], 0
    buffer_load_dwordx4 v3, s[12:15], s60 offen offset:1024 nt lds
    v_mfma_f32_16x16x32_bf16 v[168:171], v[52:55], a[20:23], v[168:171]
    v_bfe_u32 v37, v1, 4, 4
    v_mul_u32_u24 v36, 1152, v37
    v_mfma_f32_16x16x32_bf16 v[172:175], v[48:51], a[24:27], 0
    v_lshrrev_b32 v38, 8, v1
    v_lshl_add_u32 v36, v38, 4, v36
    v_mfma_f32_16x16x32_bf16 v[172:175], v[52:55], a[28:31], v[172:175]
    v_lshrrev_b32 v39, 3, v37
    v_mul_u32_u24 v39, 9152, v39
    v_mfma_f32_16x16x32_bf16 v[176:179], v[48:51], a[32:35], 0
    buffer_load_dwordx4 v4, s[12:15], s60 offen offset:2048 nt lds
    v_mfma_f32_16x16x32_bf16 v[176:179], v[52:55], a[36:39], v[176:179]
    ds_read_b128 a[80:83], v22 offset:53248
    v_mfma_f32_16x16x32_bf16 v[180:183], v[48:51], a[40:43], 0
    v_mfma_f32_16x16x32_bf16 v[180:183], v[52:55], a[44:47], v[180:183]
    v_mfma_f32_16x16x32_bf16 v[184:187], v[48:51], a[48:51], 0
    buffer_load_dwordx4 v5, s[12:15], s60 offen offset:3072 nt lds
    v_mfma_f32_16x16x32_bf16 v[184:187], v[52:55], a[52:55], v[184:187]
    ds_read_b128 a[84:87], v23 offset:53248
    v_mfma_f32_16x16x32_bf16 v[188:191], v[48:51], a[56:59], 0
    s_add_u32 m0, s69, 114688
    v_mfma_f32_16x16x32_bf16 v[188:191], v[52:55], a[60:63], v[188:191]
    v_mfma_f32_16x16x32_bf16 v[192:195], v[56:59], a[0:3], 0
    s_waitcnt lgkmcnt(1)
    buffer_load_dwordx4 v6, s[8:11], s61 offen lds
    v_mfma_f32_16x16x32_bf16 v[192:195], v[60:63], a[4:7], v[192:195]
    v_mfma_f32_16x16x32_bf16 v[196:199], v[56:59], a[8:11], 0
    v_mfma_f32_16x16x32_bf16 v[196:199], v[60:63], a[12:15], v[196:199]
    ds_read_b128 a[88:91], v22 offset:55296
    v_mfma_f32_16x16x32_bf16 v[200:203], v[56:59], a[16:19], 0
    buffer_load_dwordx4 v7, s[8:11], s61 offen offset:1024 lds
    v_mfma_f32_16x16x32_bf16 v[200:203], v[60:63], a[20:23], v[200:203]
    v_mfma_f32_16x16x32_bf16 v[204:207], v[56:59], a[24:27], 0
    v_mfma_f32_16x16x32_bf16 v[204:207], v[60:63], a[28:31], v[204:207]
    v_mfma_f32_16x16x32_bf16 v[208:211], v[56:59], a[32:35], 0
    buffer_load_dwordx4 v8, s[8:11], s61 offen offset:2048 lds
    v_mfma_f32_16x16x32_bf16 v[208:211], v[60:63], a[36:39], v[208:211]
    ds_read_b128 a[92:95], v23 offset:55296
    v_mfma_f32_16x16x32_bf16 v[212:215], v[56:59], a[40:43], 0
    v_mfma_f32_16x16x32_bf16 v[212:215], v[60:63], a[44:47], v[212:215]
    v_mfma_f32_16x16x32_bf16 v[216:219], v[56:59], a[48:51], 0
    buffer_load_dwordx4 v9, s[8:11], s61 offen offset:3072 lds
    v_mfma_f32_16x16x32_bf16 v[216:219], v[60:63], a[52:55], v[216:219]
    v_mfma_f32_16x16x32_bf16 v[220:223], v[56:59], a[56:59], 0
    s_xor_b32 s61, s61, 128
    v_mfma_f32_16x16x32_bf16 v[220:223], v[60:63], a[60:63], v[220:223]
    s_add_u32 m0, s69, 131072
    v_mfma_f32_16x16x32_bf16 v[224:227], v[40:43], a[0:3], 0
    buffer_load_dwordx4 v2, s[16:19], s60 offen nt lds
    v_mfma_f32_16x16x32_bf16 v[224:227], v[44:47], a[4:7], v[224:227]
    v_mfma_f32_16x16x32_bf16 v[228:231], v[40:43], a[8:11], 0
    buffer_load_dword v104, v103, s[20:23], s77 offen
    v_mfma_f32_16x16x32_bf16 v[228:231], v[44:47], a[12:15], v[228:231]
    s_add_u32 s77, s77, 4608
    v_mfma_f32_16x16x32_bf16 v[232:235], v[40:43], a[16:19], 0
    v_mfma_f32_16x16x32_bf16 v[232:235], v[44:47], a[20:23], v[232:235]
    s_waitcnt vmcnt(10)
    s_barrier
    ds_read_b64_tr_b16 v[48:49], v14 offset:0
    v_mfma_f32_16x16x32_bf16 v[236:239], v[40:43], a[24:27], 0
    buffer_load_dwordx4 v3, s[16:19], s60 offen offset:1024 nt lds
    v_mfma_f32_16x16x32_bf16 v[236:239], v[44:47], a[28:31], v[236:239]
    ds_read_b64_tr_b16 v[50:51], v14 offset:1024
    ds_read_b64_tr_b16 v[52:53], v14 offset:8192
    v_mfma_f32_16x16x32_bf16 v[240:243], v[40:43], a[32:35], 0
    ds_read_b64_tr_b16 v[54:55], v14 offset:9216
    ds_read_b64_tr_b16 v[56:57], v15 offset:0
    v_mfma_f32_16x16x32_bf16 v[240:243], v[44:47], a[36:39], v[240:243]
    buffer_load_dwordx4 v4, s[16:19], s60 offen offset:2048 nt lds
    v_mfma_f32_16x16x32_bf16 v[244:247], v[40:43], a[40:43], 0
    ds_read_b64_tr_b16 v[58:59], v15 offset:1024
    ds_read_b64_tr_b16 v[60:61], v15 offset:8192
    v_mfma_f32_16x16x32_bf16 v[244:247], v[44:47], a[44:47], v[244:247]
    ds_read_b64_tr_b16 v[62:63], v15 offset:9216
    v_mfma_f32_16x16x32_bf16 v[248:251], v[40:43], a[48:51], 0
    v_mfma_f32_16x16x32_bf16 v[248:251], v[44:47], a[52:55], v[248:251]
    buffer_load_dwordx4 v5, s[16:19], s60 offen offset:3072 nt lds
    v_mfma_f32_16x16x32_bf16 v[252:255], v[40:43], a[56:59], 0
    ds_read_b64_tr_b16 v[40:41], v16 offset:0
    ds_read_b64_tr_b16 v[42:43], v16 offset:1024
    v_mfma_f32_16x16x32_bf16 v[252:255], v[44:47], a[60:63], v[252:255]
    s_waitcnt lgkmcnt(3)
    ds_read_b64_tr_b16 v[44:45], v16 offset:8192
    ds_read_b64_tr_b16 v[46:47], v16 offset:9216
    v_mfma_f32_16x16x32_bf16 a[128:131], a[0:3], v[48:51], 0
    v_mfma_f32_16x16x32_bf16 a[128:131], a[4:7], v[52:55], a[128:131]
    s_add_u32 m0, s69, 147456
    v_add_u32 v22, 0x10000, v22
    v_mfma_f32_16x16x32_bf16 a[132:135], a[8:11], v[48:51], 0
    s_xor_b32 s60, s60, 1572864
    buffer_load_dwordx4 v6, s[8:11], s62 offen lds
    v_mfma_f32_16x16x32_bf16 a[132:135], a[12:15], v[52:55], a[132:135]
    ds_read_b128 a[96:99], v22 offset:16384
    v_mfma_f32_16x16x32_bf16 a[136:139], a[16:19], v[48:51], 0
    v_mfma_f32_16x16x32_bf16 a[136:139], a[20:23], v[52:55], a[136:139]
    v_mfma_f32_16x16x32_bf16 a[140:143], a[24:27], v[48:51], 0
    buffer_load_dwordx4 v7, s[8:11], s62 offen offset:1024 lds
    v_mfma_f32_16x16x32_bf16 a[140:143], a[28:31], v[52:55], a[140:143]
    v_add_u32 v23, 0x10000, v23
    ds_read_b128 a[100:103], v23 offset:16384
    v_mfma_f32_16x16x32_bf16 a[144:147], a[32:35], v[48:51], 0
    v_mfma_f32_16x16x32_bf16 a[144:147], a[36:39], v[52:55], a[144:147]
    v_mfma_f32_16x16x32_bf16 a[148:151], a[40:43], v[48:51], 0
    v_mfma_f32_16x16x32_bf16 a[148:151], a[44:47], v[52:55], a[148:151]
    buffer_load_dwordx4 v8, s[8:11], s62 offen offset:2048 lds
    v_mfma_f32_16x16x32_bf16 a[152:155], a[48:51], v[48:51], 0
    v_mfma_f32_16x16x32_bf16 a[152:155], a[52:55], v[52:55], a[152:155]
    ds_read_b128 a[104:107], v22 offset:18432
    v_mfma_f32_16x16x32_bf16 a[156:159], a[56:59], v[48:51], 0
    ds_read_b64_tr_b16 v[48:49], v17 offset:0
    ds_read_b64_tr_b16 v[50:51], v17 offset:1024
    v_mfma_f32_16x16x32_bf16 a[156:159], a[60:63], v[52:55], a[156:159]
    buffer_load_dwordx4 v9, s[8:11], s62 offen offset:3072 lds
    v_mfma_f32_16x16x32_bf16 a[160:163], a[0:3], v[56:59], 0
    s_waitcnt lgkmcnt(3)
    ds_read_b64_tr_b16 v[52:53], v17 offset:8192
    ds_read_b64_tr_b16 v[54:55], v17 offset:9216
    v_mfma_f32_16x16x32_bf16 a[160:163], a[4:7], v[60:63], a[160:163]
    v_mfma_f32_16x16x32_bf16 a[164:167], a[8:11], v[56:59], 0
    ds_read_b128 a[108:111], v23 offset:18432
    v_mfma_f32_16x16x32_bf16 a[164:167], a[12:15], v[60:63], a[164:167]
    s_add_u32 m0, s69, 0
    v_mfma_f32_16x16x32_bf16 a[168:171], a[16:19], v[56:59], 0
    s_xor_b32 s62, s62, 128
    buffer_load_dwordx4 v2, s[12:15], s60 offen nt lds
    v_mfma_f32_16x16x32_bf16 a[168:171], a[20:23], v[60:63], a[168:171]
    v_mfma_f32_16x16x32_bf16 a[172:175], a[24:27], v[56:59], 0
    v_mfma_f32_16x16x32_bf16 a[172:175], a[28:31], v[60:63], a[172:175]
    v_mfma_f32_16x16x32_bf16 a[176:179], a[32:35], v[56:59], 0
    buffer_load_dwordx4 v3, s[12:15], s60 offen offset:1024 nt lds
    v_mfma_f32_16x16x32_bf16 a[176:179], a[36:39], v[60:63], a[176:179]
    ds_read_b128 a[112:115], v22 offset:20480
    v_mfma_f32_16x16x32_bf16 a[180:183], a[40:43], v[56:59], 0
    v_mfma_f32_16x16x32_bf16 a[180:183], a[44:47], v[60:63], a[180:183]
    v_mfma_f32_16x16x32_bf16 a[184:187], a[48:51], v[56:59], 0
    v_mfma_f32_16x16x32_bf16 a[184:187], a[52:55], v[60:63], a[184:187]
    buffer_load_dwordx4 v4, s[12:15], s60 offen offset:2048 nt lds
    v_mfma_f32_16x16x32_bf16 a[188:191], a[56:59], v[56:59], 0
    ds_read_b128 a[116:119], v23 offset:20480
    v_mfma_f32_16x16x32_bf16 a[188:191], a[60:63], v[60:63], a[188:191]
    v_mfma_f32_16x16x32_bf16 a[192:195], a[0:3], v[40:43], 0
    v_mfma_f32_16x16x32_bf16 a[192:195], a[4:7], v[44:47], a[192:195]
    buffer_load_dwordx4 v5, s[12:15], s60 offen offset:3072 nt lds
    v_mfma_f32_16x16x32_bf16 a[196:199], a[8:11], v[40:43], 0
    v_mfma_f32_16x16x32_bf16 a[196:199], a[12:15], v[44:47], a[196:199]
    ds_read_b128 a[120:123], v22 offset:22528
    v_mfma_f32_16x16x32_bf16 a[200:203], a[16:19], v[40:43], 0
    v_mfma_f32_16x16x32_bf16 a[200:203], a[20:23], v[44:47], a[200:203]
    s_add_u32 m0, s69, 16384
    v_mfma_f32_16x16x32_bf16 a[204:207], a[24:27], v[40:43], 0
    buffer_load_dwordx4 v6, s[8:11], s61 offen lds
    v_mfma_f32_16x16x32_bf16 a[204:207], a[28:31], v[44:47], a[204:207]
    v_mfma_f32_16x16x32_bf16 a[208:211], a[32:35], v[40:43], 0
    ds_read_b128 a[124:127], v23 offset:22528
    v_mfma_f32_16x16x32_bf16 a[208:211], a[36:39], v[44:47], a[208:211]
    v_mfma_f32_16x16x32_bf16 a[212:215], a[40:43], v[40:43], 0
    buffer_load_dwordx4 v7, s[8:11], s61 offen offset:1024 lds
    v_mfma_f32_16x16x32_bf16 a[212:215], a[44:47], v[44:47], a[212:215]
    v_mfma_f32_16x16x32_bf16 a[216:219], a[48:51], v[40:43], 0
    v_mfma_f32_16x16x32_bf16 a[216:219], a[52:55], v[44:47], a[216:219]
    v_mfma_f32_16x16x32_bf16 a[220:223], a[56:59], v[40:43], 0
    v_mfma_f32_16x16x32_bf16 a[220:223], a[60:63], v[44:47], a[220:223]
    s_waitcnt lgkmcnt(0)
    buffer_load_dwordx4 v8, s[8:11], s61 offen offset:2048 lds
    v_mfma_f32_16x16x32_bf16 a[224:227], a[0:3], v[48:51], 0
    v_mfma_f32_16x16x32_bf16 a[224:227], a[4:7], v[52:55], a[224:227]
    v_mfma_f32_16x16x32_bf16 a[228:231], a[8:11], v[48:51], 0
    v_mfma_f32_16x16x32_bf16 a[228:231], a[12:15], v[52:55], a[228:231]
    buffer_load_dwordx4 v9, s[8:11], s61 offen offset:3072 lds
    v_mfma_f32_16x16x32_bf16 a[232:235], a[16:19], v[48:51], 0
    v_mfma_f32_16x16x32_bf16 a[232:235], a[20:23], v[52:55], a[232:235]
    s_waitcnt vmcnt(8) lgkmcnt(0)
    s_barrier
    ds_read_b64_tr_b16 v[56:57], v14 offset:32768
    v_mfma_f32_16x16x32_bf16 a[236:239], a[24:27], v[48:51], 0
    s_add_u32 m0, s69, 32768
    ds_read_b64_tr_b16 v[58:59], v14 offset:33792
    ds_read_b64_tr_b16 v[60:61], v14 offset:40960
    v_mfma_f32_16x16x32_bf16 a[236:239], a[28:31], v[52:55], a[236:239]
    s_xor_b32 s61, s61, 896
    buffer_load_dwordx4 v2, s[16:19], s60 offen nt lds
    v_mfma_f32_16x16x32_bf16 a[240:243], a[32:35], v[48:51], 0
    ds_read_b64_tr_b16 v[62:63], v14 offset:41984
    ds_read_b64_tr_b16 v[40:41], v15 offset:32768
    v_mfma_f32_16x16x32_bf16 a[240:243], a[36:39], v[52:55], a[240:243]
    ds_read_b64_tr_b16 v[42:43], v15 offset:33792
    ds_read_b64_tr_b16 v[44:45], v15 offset:40960
    v_mfma_f32_16x16x32_bf16 a[244:247], a[40:43], v[48:51], 0
    ds_read_b64_tr_b16 v[46:47], v15 offset:41984
    v_add_u32 v14, 0x10000, v14
    v_mfma_f32_16x16x32_bf16 a[244:247], a[44:47], v[52:55], a[244:247]
    v_add_u32 v15, 0x10000, v15
    v_mfma_f32_16x16x32_bf16 a[248:251], a[48:51], v[48:51], 0
    v_mfma_f32_16x16x32_bf16 a[248:251], a[52:55], v[52:55], a[248:251]
    buffer_load_dwordx4 v3, s[16:19], s60 offen offset:1024 nt lds
    v_mfma_f32_16x16x32_bf16 a[252:255], a[56:59], v[48:51], 0
    ds_read_b64_tr_b16 v[48:49], v16 offset:32768
    ds_read_b64_tr_b16 v[50:51], v16 offset:33792
    v_mfma_f32_16x16x32_bf16 a[252:255], a[60:63], v[52:55], a[252:255]
    s_waitcnt lgkmcnt(2)
    ds_read_b64_tr_b16 v[52:53], v16 offset:40960
    ds_read_b64_tr_b16 v[54:55], v16 offset:41984
    v_mfma_f32_16x16x32_bf16 v[128:131], v[56:59], a[64:67], v[128:131]
    v_add_u32 v16, 0x10000, v16
    v_mfma_f32_16x16x32_bf16 v[128:131], v[60:63], a[68:71], v[128:131]
    v_mfma_f32_16x16x32_bf16 v[132:135], v[56:59], a[72:75], v[132:135]
    ds_read_b128 a[0:3], v22 offset:49152
    v_mfma_f32_16x16x32_bf16 v[132:135], v[60:63], a[76:79], v[132:135]
    v_mfma_f32_16x16x32_bf16 v[136:139], v[56:59], a[80:83], v[136:139]
    v_mfma_f32_16x16x32_bf16 v[136:139], v[60:63], a[84:87], v[136:139]
    buffer_load_dwordx4 v4, s[16:19], s60 offen offset:2048 nt lds
    v_mfma_f32_16x16x32_bf16 v[140:143], v[56:59], a[88:91], v[140:143]
    v_mfma_f32_16x16x32_bf16 v[140:143], v[60:63], a[92:95], v[140:143]
    ds_read_b128 a[4:7], v23 offset:49152
    v_mfma_f32_16x16x32_bf16 v[144:147], v[56:59], a[96:99], v[144:147]
    v_mfma_f32_16x16x32_bf16 v[144:147], v[60:63], a[100:103], v[144:147]
    v_mfma_f32_16x16x32_bf16 v[148:151], v[56:59], a[104:107], v[148:151]
    v_mfma_f32_16x16x32_bf16 v[148:151], v[60:63], a[108:111], v[148:151]
    v_mfma_f32_16x16x32_bf16 v[152:155], v[56:59], a[112:115], v[152:155]
    buffer_load_dwordx4 v5, s[16:19], s60 offen offset:3072 nt lds
    v_mfma_f32_16x16x32_bf16 v[152:155], v[60:63], a[116:119], v[152:155]
    ds_read_b128 a[8:11], v22 offset:51200
    v_mfma_f32_16x16x32_bf16 v[156:159], v[56:59], a[120:123], v[156:159]
    ds_read_b64_tr_b16 v[56:57], v17 offset:32768
    ds_read_b64_tr_b16 v[58:59], v17 offset:33792
    v_mfma_f32_16x16x32_bf16 v[156:159], v[60:63], a[124:127], v[156:159]
    ds_read_b64_tr_b16 v[60:61], v17 offset:40960
    ds_read_b64_tr_b16 v[62:63], v17 offset:41984
    v_mfma_f32_16x16x32_bf16 v[160:163], v[40:43], a[64:67], v[160:163]
    v_add_u32 v17, 0x10000, v17
    v_mfma_f32_16x16x32_bf16 v[160:163], v[44:47], a[68:71], v[160:163]
    v_mfma_f32_16x16x32_bf16 v[164:167], v[40:43], a[72:75], v[164:167]
    ds_read_b128 a[12:15], v23 offset:51200
    v_mfma_f32_16x16x32_bf16 v[164:167], v[44:47], a[76:79], v[164:167]
    s_add_u32 m0, s69, 49152
    v_mfma_f32_16x16x32_bf16 v[168:171], v[40:43], a[80:83], v[168:171]
    s_xor_b32 s60, s60, 524288
    buffer_load_dwordx4 v6, s[8:11], s62 offen lds
    v_mfma_f32_16x16x32_bf16 v[168:171], v[44:47], a[84:87], v[168:171]
    v_mfma_f32_16x16x32_bf16 v[172:175], v[40:43], a[88:91], v[172:175]
    v_mfma_f32_16x16x32_bf16 v[172:175], v[44:47], a[92:95], v[172:175]
    v_mfma_f32_16x16x32_bf16 v[176:179], v[40:43], a[96:99], v[176:179]
    ds_read_b128 a[16:19], v22 offset:53248
    v_mfma_f32_16x16x32_bf16 v[176:179], v[44:47], a[100:103], v[176:179]
    v_mfma_f32_16x16x32_bf16 v[180:183], v[40:43], a[104:107], v[180:183]
    v_mfma_f32_16x16x32_bf16 v[180:183], v[44:47], a[108:111], v[180:183]
    buffer_load_dwordx4 v7, s[8:11], s62 offen offset:1024 lds
    v_mfma_f32_16x16x32_bf16 v[184:187], v[40:43], a[112:115], v[184:187]
    v_mfma_f32_16x16x32_bf16 v[184:187], v[44:47], a[116:119], v[184:187]
    ds_read_b128 a[20:23], v23 offset:53248
    v_mfma_f32_16x16x32_bf16 v[188:191], v[40:43], a[120:123], v[188:191]
    s_waitcnt lgkmcnt(1)
    ds_read_b64_tr_b16 v[40:41], v14 offset:0
    ds_read_b64_tr_b16 v[42:43], v14 offset:1024
    v_mfma_f32_16x16x32_bf16 v[188:191], v[44:47], a[124:127], v[188:191]
    ds_read_b64_tr_b16 v[44:45], v14 offset:8192
    ds_read_b64_tr_b16 v[46:47], v14 offset:9216
    v_mfma_f32_16x16x32_bf16 v[192:195], v[48:51], a[64:67], v[192:195]
    v_add_u32 v14, 0xfffe0000, v14
    v_mfma_f32_16x16x32_bf16 v[192:195], v[52:55], a[68:71], v[192:195]
    v_mfma_f32_16x16x32_bf16 v[196:199], v[48:51], a[72:75], v[196:199]
    v_mfma_f32_16x16x32_bf16 v[196:199], v[52:55], a[76:79], v[196:199]
    buffer_load_dwordx4 v8, s[8:11], s62 offen offset:2048 lds
    v_mfma_f32_16x16x32_bf16 v[200:203], v[48:51], a[80:83], v[200:203]
    ds_read_b128 a[24:27], v22 offset:55296
    v_mfma_f32_16x16x32_bf16 v[200:203], v[52:55], a[84:87], v[200:203]
    v_mfma_f32_16x16x32_bf16 v[204:207], v[48:51], a[88:91], v[204:207]
    v_mfma_f32_16x16x32_bf16 v[204:207], v[52:55], a[92:95], v[204:207]
    v_mfma_f32_16x16x32_bf16 v[208:211], v[48:51], a[96:99], v[208:211]
    ds_read_b128 a[28:31], v23 offset:55296
    v_mfma_f32_16x16x32_bf16 v[208:211], v[52:55], a[100:103], v[208:211]
    v_mfma_f32_16x16x32_bf16 v[212:215], v[48:51], a[104:107], v[212:215]
    buffer_load_dwordx4 v9, s[8:11], s62 offen offset:3072 lds
    v_mfma_f32_16x16x32_bf16 v[212:215], v[52:55], a[108:111], v[212:215]
    v_mfma_f32_16x16x32_bf16 v[216:219], v[48:51], a[112:115], v[216:219]
    v_mfma_f32_16x16x32_bf16 v[216:219], v[52:55], a[116:119], v[216:219]
    v_mfma_f32_16x16x32_bf16 v[220:223], v[48:51], a[120:123], v[220:223]
    ds_read_b64_tr_b16 v[48:49], v15 offset:0
    ds_read_b64_tr_b16 v[50:51], v15 offset:1024
    v_mfma_f32_16x16x32_bf16 v[220:223], v[52:55], a[124:127], v[220:223]
    ds_read_b64_tr_b16 v[52:53], v15 offset:8192
    ds_read_b64_tr_b16 v[54:55], v15 offset:9216
    v_mfma_f32_16x16x32_bf16 v[224:227], v[56:59], a[64:67], v[224:227]
    buffer_load_dwordx2 v[80:81], v75, s[28:31], s98 offen nt
    v_mfma_f32_16x16x32_bf16 v[224:227], v[60:63], a[68:71], v[224:227]
    s_xor_b32 s62, s62, 896
    v_add_u32 v15, 0xfffe0000, v15
    v_mfma_f32_16x16x32_bf16 v[228:231], v[56:59], a[72:75], v[228:231]
    buffer_load_dword v105, v103, s[20:23], s77 offen
    v_mfma_f32_16x16x32_bf16 v[228:231], v[60:63], a[76:79], v[228:231]
    s_mul_i32 s77, s2, 18432
    v_mfma_f32_16x16x32_bf16 v[232:235], v[56:59], a[80:83], v[232:235]
    s_add_u32 s77, s77, s76
    buffer_load_dwordx2 v[82:83], v77, s[28:31], s98 offen nt
    v_mfma_f32_16x16x32_bf16 v[232:235], v[60:63], a[84:87], v[232:235]
    s_add_u32 s98, s98, 3456
    v_mfma_f32_16x16x32_bf16 v[236:239], v[56:59], a[88:91], v[236:239]
    s_add_u32 m0, s69, 65536
    v_mfma_f32_16x16x32_bf16 v[236:239], v[60:63], a[92:95], v[236:239]
    s_mov_b32 s76, 0
    v_mfma_f32_16x16x32_bf16 v[240:243], v[56:59], a[96:99], v[240:243]
    buffer_load_ushort v92, v65, s[32:35], s99 offen offset:0
    v_mfma_f32_16x16x32_bf16 v[240:243], v[60:63], a[100:103], v[240:243]
    v_mfma_f32_16x16x32_bf16 v[244:247], v[56:59], a[104:107], v[244:247]
    v_mfma_f32_16x16x32_bf16 v[244:247], v[60:63], a[108:111], v[244:247]
    v_mfma_f32_16x16x32_bf16 v[248:251], v[56:59], a[112:115], v[248:251]
    buffer_load_dwordx2 v[84:85], v75, s[28:31], s98 offen nt
    v_mfma_f32_16x16x32_bf16 v[248:251], v[60:63], a[116:119], v[248:251]
    v_mfma_f32_16x16x32_bf16 v[252:255], v[56:59], a[120:123], v[252:255]
    ds_read_b64_tr_b16 v[56:57], v16 offset:0
    ds_read_b64_tr_b16 v[58:59], v16 offset:1024
    v_mfma_f32_16x16x32_bf16 v[252:255], v[60:63], a[124:127], v[252:255]
    s_waitcnt lgkmcnt(2)
    ds_read_b64_tr_b16 v[60:61], v16 offset:8192
    ds_read_b64_tr_b16 v[62:63], v16 offset:9216
    v_mfma_f32_16x16x32_bf16 a[128:131], a[64:67], v[40:43], a[128:131]
    buffer_load_dwordx4 v2, s[12:15], s60 offen nt lds
    v_mfma_f32_16x16x32_bf16 a[128:131], a[68:71], v[44:47], a[128:131]
    v_add_u32 v22, 0x10000, v22
    v_add_u32 v16, 0xfffe0000, v16
    v_mfma_f32_16x16x32_bf16 a[132:135], a[72:75], v[40:43], a[132:135]
    ds_read_b128 a[32:35], v22 offset:16384
    v_mfma_f32_16x16x32_bf16 a[132:135], a[76:79], v[44:47], a[132:135]
    v_mfma_f32_16x16x32_bf16 a[136:139], a[80:83], v[40:43], a[136:139]
    buffer_load_dwordx2 v[86:87], v77, s[28:31], s98 offen nt
    v_mfma_f32_16x16x32_bf16 a[136:139], a[84:87], v[44:47], a[136:139]
    s_add_u32 s98, s98, 3456
    v_mfma_f32_16x16x32_bf16 a[140:143], a[88:91], v[40:43], a[140:143]
    v_add_u32 v23, 0x10000, v23
    v_mfma_f32_16x16x32_bf16 a[140:143], a[92:95], v[44:47], a[140:143]
    ds_read_b128 a[36:39], v23 offset:16384
    v_mfma_f32_16x16x32_bf16 a[144:147], a[96:99], v[40:43], a[144:147]
    buffer_load_ushort v93, v65, s[32:35], s99 offen offset:2
    v_mfma_f32_16x16x32_bf16 a[144:147], a[100:103], v[44:47], a[144:147]
    v_mfma_f32_16x16x32_bf16 a[148:151], a[104:107], v[40:43], a[148:151]
    v_mfma_f32_16x16x32_bf16 a[148:151], a[108:111], v[44:47], a[148:151]
    v_mfma_f32_16x16x32_bf16 a[152:155], a[112:115], v[40:43], a[152:155]
    buffer_load_dwordx2 v[88:89], v75, s[28:31], s98 offen nt
    v_mfma_f32_16x16x32_bf16 a[152:155], a[116:119], v[44:47], a[152:155]
    ds_read_b128 a[40:43], v22 offset:18432
    v_mfma_f32_16x16x32_bf16 a[156:159], a[120:123], v[40:43], a[156:159]
    ds_read_b64_tr_b16 v[40:41], v17 offset:0
    ds_read_b64_tr_b16 v[42:43], v17 offset:1024
    v_mfma_f32_16x16x32_bf16 a[156:159], a[124:127], v[44:47], a[156:159]
    ds_read_b64_tr_b16 v[44:45], v17 offset:8192
    ds_read_b64_tr_b16 v[46:47], v17 offset:9216
    v_mfma_f32_16x16x32_bf16 a[160:163], a[64:67], v[48:51], a[160:163]
    buffer_load_dwordx4 v3, s[12:15], s60 offen offset:1024 nt lds
    v_mfma_f32_16x16x32_bf16 a[160:163], a[68:71], v[52:55], a[160:163]
    v_add_u32 v17, 0xfffe0000, v17
    v_mfma_f32_16x16x32_bf16 a[164:167], a[72:75], v[48:51], a[164:167]
    ds_read_b128 a[44:47], v23 offset:18432
    v_mfma_f32_16x16x32_bf16 a[164:167], a[76:79], v[52:55], a[164:167]
    v_mfma_f32_16x16x32_bf16 a[168:171], a[80:83], v[48:51], a[168:171]
    buffer_load_dwordx2 v[90:91], v77, s[28:31], s98 offen nt
    v_mfma_f32_16x16x32_bf16 a[168:171], a[84:87], v[52:55], a[168:171]
    s_add_u32 s98, s98, 3456
    s_add_u32 s28, s56, 6291456
    s_addc_u32 s29, s57, 0
    v_mfma_f32_16x16x32_bf16 a[172:175], a[88:91], v[48:51], a[172:175]
    s_mov_b32 s30, 2359296
    v_mfma_f32_16x16x32_bf16 a[172:175], a[92:95], v[52:55], a[172:175]
    s_bfe_u32 s98, s72, 0x10001
    v_mfma_f32_16x16x32_bf16 a[176:179], a[96:99], v[48:51], a[176:179]
    buffer_load_ushort v94, v65, s[32:35], s99 offen offset:4
    v_mfma_f32_16x16x32_bf16 a[176:179], a[100:103], v[52:55], a[176:179]
    s_add_u32 s32, s56, 9437184
    s_addc_u32 s33, s57, 0
    s_mov_b32 s34, 196608
    v_mfma_f32_16x16x32_bf16 a[180:183], a[104:107], v[48:51], a[180:183]
    s_bfe_u32 s99, s72, 0x10003
    ds_read_b128 a[48:51], v22 offset:20480
    v_mfma_f32_16x16x32_bf16 a[180:183], a[108:111], v[52:55], a[180:183]
    s_lshl1_add_u32 s98, s99, s98
    v_mfma_f32_16x16x32_bf16 a[184:187], a[112:115], v[48:51], a[184:187]
    s_lshl_b32 s98, s98, 5
    buffer_store_dword v65, v64, s[32:35], s101 offen sc1
    v_mfma_f32_16x16x32_bf16 a[184:187], a[116:119], v[52:55], a[184:187]
    s_lshl_b32 s72, s72, 7
    ds_read_b128 a[52:55], v23 offset:20480
    v_mfma_f32_16x16x32_bf16 a[188:191], a[120:123], v[48:51], a[188:191]
    v_mfma_f32_16x16x32_bf16 a[188:191], a[124:127], v[52:55], a[188:191]
    s_waitcnt lgkmcnt(1)
    v_mfma_f32_16x16x32_bf16 a[192:195], a[64:67], v[56:59], a[192:195]
    buffer_load_dwordx4 v4, s[12:15], s60 offen offset:2048 nt lds
    v_mfma_f32_16x16x32_bf16 a[192:195], a[68:71], v[60:63], a[192:195]
    v_mfma_f32_16x16x32_bf16 a[196:199], a[72:75], v[56:59], a[196:199]
    v_mfma_f32_16x16x32_bf16 a[196:199], a[76:79], v[60:63], a[196:199]
    ds_read_b128 a[56:59], v22 offset:22528
    v_mfma_f32_16x16x32_bf16 a[200:203], a[80:83], v[56:59], a[200:203]
    buffer_load_dwordx4 v5, s[12:15], s60 offen offset:3072 nt lds
    v_mfma_f32_16x16x32_bf16 a[200:203], a[84:87], v[60:63], a[200:203]
    s_add_u32 m0, s69, 81920
    v_mfma_f32_16x16x32_bf16 a[204:207], a[88:91], v[56:59], a[204:207]
    v_mfma_f32_16x16x32_bf16 a[204:207], a[92:95], v[60:63], a[204:207]
    v_mfma_f32_16x16x32_bf16 a[208:211], a[96:99], v[56:59], a[208:211]
    buffer_load_dwordx4 v6, s[8:11], s61 offen lds
    v_mfma_f32_16x16x32_bf16 a[208:211], a[100:103], v[60:63], a[208:211]
    ds_read_b128 a[60:63], v23 offset:22528
    v_mfma_f32_16x16x32_bf16 a[212:215], a[104:107], v[56:59], a[212:215]
    v_mfma_f32_16x16x32_bf16 a[212:215], a[108:111], v[60:63], a[212:215]
    v_mfma_f32_16x16x32_bf16 a[216:219], a[112:115], v[56:59], a[216:219]
    buffer_load_dwordx4 v7, s[8:11], s61 offen offset:1024 lds
    v_mfma_f32_16x16x32_bf16 a[216:219], a[116:119], v[60:63], a[216:219]
    v_mfma_f32_16x16x32_bf16 a[220:223], a[120:123], v[56:59], a[220:223]
    v_mfma_f32_16x16x32_bf16 a[220:223], a[124:127], v[60:63], a[220:223]
    v_mfma_f32_16x16x32_bf16 a[224:227], a[64:67], v[40:43], a[224:227]
    buffer_load_dwordx4 v8, s[8:11], s61 offen offset:2048 lds
    v_mfma_f32_16x16x32_bf16 a[224:227], a[68:71], v[44:47], a[224:227]
    v_mfma_f32_16x16x32_bf16 a[228:231], a[72:75], v[40:43], a[228:231]
    v_mfma_f32_16x16x32_bf16 a[228:231], a[76:79], v[44:47], a[228:231]
    v_mfma_f32_16x16x32_bf16 a[232:235], a[80:83], v[40:43], a[232:235]
    buffer_load_dwordx4 v9, s[8:11], s61 offen offset:3072 lds
    v_mfma_f32_16x16x32_bf16 a[232:235], a[84:87], v[44:47], a[232:235]
    s_xor_b32 s61, s61, 128
    s_waitcnt vmcnt(19) lgkmcnt(0)
    s_barrier
    v_mfma_f32_16x16x32_bf16 a[236:239], a[88:91], v[40:43], a[236:239]
    s_add_u32 m0, s69, 98304
    ds_read_b64_tr_b16 v[48:49], v14 offset:0
    ds_read_b64_tr_b16 v[50:51], v14 offset:1024
    v_mfma_f32_16x16x32_bf16 a[236:239], a[92:95], v[44:47], a[236:239]
    ds_read_b64_tr_b16 v[52:53], v14 offset:8192
    ds_read_b64_tr_b16 v[54:55], v14 offset:9216
    v_mfma_f32_16x16x32_bf16 a[240:243], a[96:99], v[40:43], a[240:243]
    buffer_load_dwordx4 v2, s[16:19], s60 offen nt lds
    v_mfma_f32_16x16x32_bf16 a[240:243], a[100:103], v[44:47], a[240:243]
    ds_read_b64_tr_b16 v[56:57], v15 offset:0
    ds_read_b64_tr_b16 v[58:59], v15 offset:1024
    v_mfma_f32_16x16x32_bf16 a[244:247], a[104:107], v[40:43], a[244:247]
    ds_read_b64_tr_b16 v[60:61], v15 offset:8192
    ds_read_b64_tr_b16 v[62:63], v15 offset:9216
    v_mfma_f32_16x16x32_bf16 a[244:247], a[108:111], v[44:47], a[244:247]
    s_cmp_lt_u32 s2, 192
    s_cselect_b32 s72, s72, 1073741824
    v_mfma_f32_16x16x32_bf16 a[248:251], a[112:115], v[40:43], a[248:251]
    v_mfma_f32_16x16x32_bf16 a[248:251], a[116:119], v[44:47], a[248:251]
    buffer_load_dwordx4 v3, s[16:19], s60 offen offset:1024 nt lds
    v_mfma_f32_16x16x32_bf16 a[252:255], a[120:123], v[40:43], a[252:255]
    ds_read_b64_tr_b16 v[40:41], v16 offset:0
    ds_read_b64_tr_b16 v[42:43], v16 offset:1024
    v_mfma_f32_16x16x32_bf16 a[252:255], a[124:127], v[44:47], a[252:255]
    s_waitcnt lgkmcnt(2)
    ds_read_b64_tr_b16 v[44:45], v16 offset:8192
    ds_read_b64_tr_b16 v[46:47], v16 offset:9216
    v_mfma_f32_16x16x32_bf16 v[128:131], v[48:51], a[0:3], v[128:131]
    v_mfma_f32_16x16x32_bf16 v[128:131], v[52:55], a[4:7], v[128:131]
    v_add_u32 v22, 0xfffe0000, v22
    v_mfma_f32_16x16x32_bf16 v[132:135], v[48:51], a[8:11], v[132:135]
    ds_read_b128 a[64:67], v22 offset:16384
    v_mfma_f32_16x16x32_bf16 v[132:135], v[52:55], a[12:15], v[132:135]
    v_mfma_f32_16x16x32_bf16 v[136:139], v[48:51], a[16:19], v[136:139]
    v_mfma_f32_16x16x32_bf16 v[136:139], v[52:55], a[20:23], v[136:139]
    buffer_load_dwordx4 v4, s[16:19], s60 offen offset:2048 nt lds
    v_mfma_f32_16x16x32_bf16 v[140:143], v[48:51], a[24:27], v[140:143]
    v_add_u32 v23, 0xfffe0000, v23
    v_mfma_f32_16x16x32_bf16 v[140:143], v[52:55], a[28:31], v[140:143]
    ds_read_b128 a[68:71], v23 offset:16384
    v_mfma_f32_16x16x32_bf16 v[144:147], v[48:51], a[32:35], v[144:147]
    v_mfma_f32_16x16x32_bf16 v[144:147], v[52:55], a[36:39], v[144:147]
    v_mfma_f32_16x16x32_bf16 v[148:151], v[48:51], a[40:43], v[148:151]
    v_mfma_f32_16x16x32_bf16 v[148:151], v[52:55], a[44:47], v[148:151]
    v_mfma_f32_16x16x32_bf16 v[152:155], v[48:51], a[48:51], v[152:155]
    buffer_load_dwordx4 v5, s[16:19], s60 offen offset:3072 nt lds
    v_mfma_f32_16x16x32_bf16 v[152:155], v[52:55], a[52:55], v[152:155]
    ds_read_b128 a[72:75], v22 offset:18432
    v_mfma_f32_16x16x32_bf16 v[156:159], v[48:51], a[56:59], v[156:159]
    ds_read_b64_tr_b16 v[48:49], v17 offset:0
    ds_read_b64_tr_b16 v[50:51], v17 offset:1024
    v_mfma_f32_16x16x32_bf16 v[156:159], v[52:55], a[60:63], v[156:159]
    ds_read_b64_tr_b16 v[52:53], v17 offset:8192
    ds_read_b64_tr_b16 v[54:55], v17 offset:9216
    v_mfma_f32_16x16x32_bf16 v[160:163], v[56:59], a[0:3], v[160:163]
    v_mfma_f32_16x16x32_bf16 v[160:163], v[60:63], a[4:7], v[160:163]
    v_mfma_f32_16x16x32_bf16 v[164:167], v[56:59], a[8:11], v[164:167]
    ds_read_b128 a[76:79], v23 offset:18432
    v_mfma_f32_16x16x32_bf16 v[164:167], v[60:63], a[12:15], v[164:167]
    s_add_u32 m0, s69, 114688
    v_mfma_f32_16x16x32_bf16 v[168:171], v[56:59], a[16:19], v[168:171]
    s_xor_b32 s60, s60, 3670016
    buffer_load_dwordx4 v6, s[8:11], s62 offen lds
    v_mfma_f32_16x16x32_bf16 v[168:171], v[60:63], a[20:23], v[168:171]
    v_mfma_f32_16x16x32_bf16 v[172:175], v[56:59], a[24:27], v[172:175]
    v_mfma_f32_16x16x32_bf16 v[172:175], v[60:63], a[28:31], v[172:175]
    v_mfma_f32_16x16x32_bf16 v[176:179], v[56:59], a[32:35], v[176:179]
    ds_read_b128 a[80:83], v22 offset:20480
    v_mfma_f32_16x16x32_bf16 v[176:179], v[60:63], a[36:39], v[176:179]
    v_mfma_f32_16x16x32_bf16 v[180:183], v[56:59], a[40:43], v[180:183]
    v_mfma_f32_16x16x32_bf16 v[180:183], v[60:63], a[44:47], v[180:183]
    buffer_load_dwordx4 v7, s[8:11], s62 offen offset:1024 lds
    v_mfma_f32_16x16x32_bf16 v[184:187], v[56:59], a[48:51], v[184:187]
    v_mfma_f32_16x16x32_bf16 v[184:187], v[60:63], a[52:55], v[184:187]
    ds_read_b128 a[84:87], v23 offset:20480
    v_mfma_f32_16x16x32_bf16 v[188:191], v[56:59], a[56:59], v[188:191]
    s_waitcnt lgkmcnt(1)
    ds_read_b64_tr_b16 v[56:57], v14 offset:32768
    ds_read_b64_tr_b16 v[58:59], v14 offset:33792
    v_mfma_f32_16x16x32_bf16 v[188:191], v[60:63], a[60:63], v[188:191]
    ds_read_b64_tr_b16 v[60:61], v14 offset:40960
    ds_read_b64_tr_b16 v[62:63], v14 offset:41984
    v_mfma_f32_16x16x32_bf16 v[192:195], v[40:43], a[0:3], v[192:195]
    v_add_u32 v14, 0x10000, v14
    v_mfma_f32_16x16x32_bf16 v[192:195], v[44:47], a[4:7], v[192:195]
    v_mfma_f32_16x16x32_bf16 v[196:199], v[40:43], a[8:11], v[196:199]
    v_mfma_f32_16x16x32_bf16 v[196:199], v[44:47], a[12:15], v[196:199]
    buffer_load_dwordx4 v8, s[8:11], s62 offen offset:2048 lds
    v_mfma_f32_16x16x32_bf16 v[200:203], v[40:43], a[16:19], v[200:203]
    ds_read_b128 a[88:91], v22 offset:22528
    v_mfma_f32_16x16x32_bf16 v[200:203], v[44:47], a[20:23], v[200:203]
    v_mfma_f32_16x16x32_bf16 v[204:207], v[40:43], a[24:27], v[204:207]
    v_mfma_f32_16x16x32_bf16 v[204:207], v[44:47], a[28:31], v[204:207]
    v_mfma_f32_16x16x32_bf16 v[208:211], v[40:43], a[32:35], v[208:211]
    ds_read_b128 a[92:95], v23 offset:22528
    v_mfma_f32_16x16x32_bf16 v[208:211], v[44:47], a[36:39], v[208:211]
    v_mfma_f32_16x16x32_bf16 v[212:215], v[40:43], a[40:43], v[212:215]
    buffer_load_dwordx4 v9, s[8:11], s62 offen offset:3072 lds
    v_mfma_f32_16x16x32_bf16 v[212:215], v[44:47], a[44:47], v[212:215]
    v_mfma_f32_16x16x32_bf16 v[216:219], v[40:43], a[48:51], v[216:219]
    v_mfma_f32_16x16x32_bf16 v[216:219], v[44:47], a[52:55], v[216:219]
    v_mfma_f32_16x16x32_bf16 v[220:223], v[40:43], a[56:59], v[220:223]
    ds_read_b64_tr_b16 v[40:41], v15 offset:32768
    ds_read_b64_tr_b16 v[42:43], v15 offset:33792
    v_mfma_f32_16x16x32_bf16 v[220:223], v[44:47], a[60:63], v[220:223]
    ds_read_b64_tr_b16 v[44:45], v15 offset:40960
    ds_read_b64_tr_b16 v[46:47], v15 offset:41984
    v_mfma_f32_16x16x32_bf16 v[224:227], v[48:51], a[0:3], v[224:227]
    v_add_u32 v15, 0x10000, v15
    v_mfma_f32_16x16x32_bf16 v[224:227], v[52:55], a[4:7], v[224:227]
    s_xor_b32 s62, s62, 128
    v_mfma_f32_16x16x32_bf16 v[228:231], v[48:51], a[8:11], v[228:231]
    buffer_load_dword v106, v103, s[24:27], s77 offen
    v_mfma_f32_16x16x32_bf16 v[228:231], v[52:55], a[12:15], v[228:231]
    s_add_u32 s77, s77, 4608
    v_mfma_f32_16x16x32_bf16 v[232:235], v[48:51], a[16:19], v[232:235]
    v_mfma_f32_16x16x32_bf16 v[232:235], v[52:55], a[20:23], v[232:235]
    s_add_u32 m0, s69, 131072
    v_mfma_f32_16x16x32_bf16 v[236:239], v[48:51], a[24:27], v[236:239]
    buffer_load_dwordx4 v2, s[12:15], s60 offen nt lds
    v_mfma_f32_16x16x32_bf16 v[236:239], v[52:55], a[28:31], v[236:239]
    v_mfma_f32_16x16x32_bf16 v[240:243], v[48:51], a[32:35], v[240:243]
    v_mfma_f32_16x16x32_bf16 v[240:243], v[52:55], a[36:39], v[240:243]
    v_mfma_f32_16x16x32_bf16 v[244:247], v[48:51], a[40:43], v[244:247]
    v_mfma_f32_16x16x32_bf16 v[244:247], v[52:55], a[44:47], v[244:247]
    v_mfma_f32_16x16x32_bf16 v[248:251], v[48:51], a[48:51], v[248:251]
    v_mfma_f32_16x16x32_bf16 v[248:251], v[52:55], a[52:55], v[248:251]
    buffer_load_dwordx4 v3, s[12:15], s60 offen offset:1024 nt lds
    v_mfma_f32_16x16x32_bf16 v[252:255], v[48:51], a[56:59], v[252:255]
    ds_read_b64_tr_b16 v[48:49], v16 offset:32768
    ds_read_b64_tr_b16 v[50:51], v16 offset:33792
    v_mfma_f32_16x16x32_bf16 v[252:255], v[52:55], a[60:63], v[252:255]
    s_waitcnt lgkmcnt(2)
    ds_read_b64_tr_b16 v[52:53], v16 offset:40960
    ds_read_b64_tr_b16 v[54:55], v16 offset:41984
    v_mfma_f32_16x16x32_bf16 a[128:131], a[0:3], v[56:59], a[128:131]
    v_add_u32 v16, 0x10000, v16
    v_mfma_f32_16x16x32_bf16 a[128:131], a[4:7], v[60:63], a[128:131]
    v_mfma_f32_16x16x32_bf16 a[132:135], a[8:11], v[56:59], a[132:135]
    ds_read_b128 a[96:99], v22 offset:49152
    v_mfma_f32_16x16x32_bf16 a[132:135], a[12:15], v[60:63], a[132:135]
    v_mfma_f32_16x16x32_bf16 a[136:139], a[16:19], v[56:59], a[136:139]
    v_mfma_f32_16x16x32_bf16 a[136:139], a[20:23], v[60:63], a[136:139]
    buffer_load_dwordx4 v4, s[12:15], s60 offen offset:2048 nt lds
    v_mfma_f32_16x16x32_bf16 a[140:143], a[24:27], v[56:59], a[140:143]
    v_mfma_f32_16x16x32_bf16 a[140:143], a[28:31], v[60:63], a[140:143]
    ds_read_b128 a[100:103], v23 offset:49152
    v_mfma_f32_16x16x32_bf16 a[144:147], a[32:35], v[56:59], a[144:147]
    v_mfma_f32_16x16x32_bf16 a[144:147], a[36:39], v[60:63], a[144:147]
    v_mfma_f32_16x16x32_bf16 a[148:151], a[40:43], v[56:59], a[148:151]
    v_mfma_f32_16x16x32_bf16 a[148:151], a[44:47], v[60:63], a[148:151]
    v_mfma_f32_16x16x32_bf16 a[152:155], a[48:51], v[56:59], a[152:155]
    buffer_load_dwordx4 v5, s[12:15], s60 offen offset:3072 nt lds
    v_mfma_f32_16x16x32_bf16 a[152:155], a[52:55], v[60:63], a[152:155]
    ds_read_b128 a[104:107], v22 offset:51200
    v_mfma_f32_16x16x32_bf16 a[156:159], a[56:59], v[56:59], a[156:159]
    ds_read_b64_tr_b16 v[56:57], v17 offset:32768
    ds_read_b64_tr_b16 v[58:59], v17 offset:33792
    v_mfma_f32_16x16x32_bf16 a[156:159], a[60:63], v[60:63], a[156:159]
    ds_read_b64_tr_b16 v[60:61], v17 offset:40960
    ds_read_b64_tr_b16 v[62:63], v17 offset:41984
    v_mfma_f32_16x16x32_bf16 a[160:163], a[0:3], v[40:43], a[160:163]
    v_add_u32 v17, 0x10000, v17
    v_mfma_f32_16x16x32_bf16 a[160:163], a[4:7], v[44:47], a[160:163]
    v_mfma_f32_16x16x32_bf16 a[164:167], a[8:11], v[40:43], a[164:167]
    ds_read_b128 a[108:111], v23 offset:51200
    v_mfma_f32_16x16x32_bf16 a[164:167], a[12:15], v[44:47], a[164:167]
    s_add_u32 m0, s69, 147456
    v_mfma_f32_16x16x32_bf16 a[168:171], a[16:19], v[40:43], a[168:171]
    buffer_load_dwordx4 v6, s[8:11], s61 offen lds
    v_mfma_f32_16x16x32_bf16 a[168:171], a[20:23], v[44:47], a[168:171]
    v_mfma_f32_16x16x32_bf16 a[172:175], a[24:27], v[40:43], a[172:175]
    v_mfma_f32_16x16x32_bf16 a[172:175], a[28:31], v[44:47], a[172:175]
    v_mfma_f32_16x16x32_bf16 a[176:179], a[32:35], v[40:43], a[176:179]
    ds_read_b128 a[112:115], v22 offset:53248
    v_mfma_f32_16x16x32_bf16 a[176:179], a[36:39], v[44:47], a[176:179]
    v_mfma_f32_16x16x32_bf16 a[180:183], a[40:43], v[40:43], a[180:183]
    v_mfma_f32_16x16x32_bf16 a[180:183], a[44:47], v[44:47], a[180:183]
    buffer_load_dwordx4 v7, s[8:11], s61 offen offset:1024 lds
    v_mfma_f32_16x16x32_bf16 a[184:187], a[48:51], v[40:43], a[184:187]
    v_mfma_f32_16x16x32_bf16 a[184:187], a[52:55], v[44:47], a[184:187]
    ds_read_b128 a[116:119], v23 offset:53248
    v_mfma_f32_16x16x32_bf16 a[188:191], a[56:59], v[40:43], a[188:191]
    v_mfma_f32_16x16x32_bf16 a[188:191], a[60:63], v[44:47], a[188:191]
    s_waitcnt lgkmcnt(1)
    v_mfma_f32_16x16x32_bf16 a[192:195], a[0:3], v[48:51], a[192:195]
    v_mfma_f32_16x16x32_bf16 a[192:195], a[4:7], v[52:55], a[192:195]
    v_mfma_f32_16x16x32_bf16 a[196:199], a[8:11], v[48:51], a[196:199]
    v_mfma_f32_16x16x32_bf16 a[196:199], a[12:15], v[52:55], a[196:199]
    buffer_load_dwordx4 v8, s[8:11], s61 offen offset:2048 lds
    v_mfma_f32_16x16x32_bf16 a[200:203], a[16:19], v[48:51], a[200:203]
    ds_read_b128 a[120:123], v22 offset:55296
    v_mfma_f32_16x16x32_bf16 a[200:203], a[20:23], v[52:55], a[200:203]
    v_mfma_f32_16x16x32_bf16 a[204:207], a[24:27], v[48:51], a[204:207]
    v_mfma_f32_16x16x32_bf16 a[204:207], a[28:31], v[52:55], a[204:207]
    v_mfma_f32_16x16x32_bf16 a[208:211], a[32:35], v[48:51], a[208:211]
    ds_read_b128 a[124:127], v23 offset:55296
    v_mfma_f32_16x16x32_bf16 a[208:211], a[36:39], v[52:55], a[208:211]
    v_mfma_f32_16x16x32_bf16 a[212:215], a[40:43], v[48:51], a[212:215]
    buffer_load_dwordx4 v9, s[8:11], s61 offen offset:3072 lds
    v_mfma_f32_16x16x32_bf16 a[212:215], a[44:47], v[52:55], a[212:215]
    v_mfma_f32_16x16x32_bf16 a[216:219], a[48:51], v[48:51], a[216:219]
    v_mfma_f32_16x16x32_bf16 a[216:219], a[52:55], v[52:55], a[216:219]
    v_mfma_f32_16x16x32_bf16 a[220:223], a[56:59], v[48:51], a[220:223]
    v_mfma_f32_16x16x32_bf16 a[220:223], a[60:63], v[52:55], a[220:223]
    v_mfma_f32_16x16x32_bf16 a[224:227], a[0:3], v[56:59], a[224:227]
    v_mfma_f32_16x16x32_bf16 a[224:227], a[4:7], v[60:63], a[224:227]
    s_xor_b32 s61, s61, 384
    v_mfma_f32_16x16x32_bf16 a[228:231], a[8:11], v[56:59], a[228:231]
    v_mfma_f32_16x16x32_bf16 a[228:231], a[12:15], v[60:63], a[228:231]
    v_mfma_f32_16x16x32_bf16 a[232:235], a[16:19], v[56:59], a[232:235]
    v_mfma_f32_16x16x32_bf16 a[232:235], a[20:23], v[60:63], a[232:235]
    s_waitcnt vmcnt(9) lgkmcnt(0)
    s_barrier
    ds_read_b64_tr_b16 v[40:41], v14 offset:0
    v_mfma_f32_16x16x32_bf16 a[236:239], a[24:27], v[56:59], a[236:239]
    s_add_u32 m0, s69, 0
    ds_read_b64_tr_b16 v[42:43], v14 offset:1024
    ds_read_b64_tr_b16 v[44:45], v14 offset:8192
    v_mfma_f32_16x16x32_bf16 a[236:239], a[28:31], v[60:63], a[236:239]
    buffer_load_dwordx4 v2, s[16:19], s60 offen nt lds
    v_mfma_f32_16x16x32_bf16 a[240:243], a[32:35], v[56:59], a[240:243]
    ds_read_b64_tr_b16 v[46:47], v14 offset:9216
    v_cndmask_b32_e64 v83, v83, 0, s[92:93]
    v_mfma_f32_16x16x32_bf16 a[240:243], a[36:39], v[60:63], a[240:243]
    v_cndmask_b32_e64 v81, v81, 0, vcc
    v_cndmask_b32 v82, v82, v92, s[92:93]
    v_mfma_f32_16x16x32_bf16 a[244:247], a[40:43], v[56:59], a[244:247]
    s_mov_b32 vcc_lo, 0x10101010
    s_mov_b32 vcc_hi, 0x10101010
    v_cndmask_b32_e64 v83, v83, 0, vcc
    v_mfma_f32_16x16x32_bf16 a[244:247], a[44:47], v[60:63], a[244:247]
    v_xor_b32 v92, s98, v95
    ds_read_b64_tr_b16 v[48:49], v15 offset:0
    v_mfma_f32_16x16x32_bf16 a[248:251], a[48:51], v[56:59], a[248:251]
    buffer_store_dwordx4 v[80:83], v92, s[28:31], s72 offen sc1
    v_mfma_f32_16x16x32_bf16 a[248:251], a[52:55], v[60:63], a[248:251]
    s_mul_i32 s72, s2, 3
    buffer_load_dwordx4 v3, s[16:19], s60 offen offset:1024 nt lds
    v_mfma_f32_16x16x32_bf16 a[252:255], a[56:59], v[56:59], a[252:255]
    s_add_u32 s72, s72, 1
    ds_read_b64_tr_b16 v[50:51], v15 offset:1024
    ds_read_b64_tr_b16 v[52:53], v15 offset:8192
    v_mfma_f32_16x16x32_bf16 a[252:255], a[60:63], v[60:63], a[252:255]
    s_bfe_u32 s98, s72, 0x10001
    ds_read_b64_tr_b16 v[54:55], v15 offset:9216
    v_cndmask_b32_e64 v87, v87, 0, s[92:93]
    s_waitcnt lgkmcnt(4)
    v_mfma_f32_16x16x32_bf16 v[128:131], v[40:43], a[64:67], v[128:131]
    s_bfe_u32 s99, s72, 0x10003
    v_cndmask_b32 v86, v86, v93, s[92:93]
    v_cndmask_b32_e64 v91, v91, 0, s[92:93]
    v_mfma_f32_16x16x32_bf16 v[128:131], v[44:47], a[68:71], v[128:131]
    s_lshl1_add_u32 s98, s99, s98
    v_add_u32 v22, 0x10000, v22
    v_cndmask_b32 v90, v90, v94, s[92:93]
    v_mfma_f32_16x16x32_bf16 v[132:135], v[40:43], a[72:75], v[132:135]
    s_lshl_b32 s98, s98, 5
    ds_read_b128 a[0:3], v22 offset:16384
    v_xor_b32 v93, s98, v95
    v_mfma_f32_16x16x32_bf16 v[132:135], v[44:47], a[76:79], v[132:135]
    s_mov_b32 vcc_lo, 0x84848484
    s_mov_b32 vcc_hi, 0x84848484
    v_cndmask_b32_e64 v85, v85, 0, vcc
    v_mfma_f32_16x16x32_bf16 v[136:139], v[40:43], a[80:83], v[136:139]
    s_mov_b32 vcc_lo, 0x10101010
    s_mov_b32 vcc_hi, 0x10101010
    v_cndmask_b32_e64 v87, v87, 0, vcc
    v_mfma_f32_16x16x32_bf16 v[136:139], v[44:47], a[84:87], v[136:139]
    s_lshl_b32 s72, s72, 7
    buffer_load_dwordx4 v4, s[16:19], s60 offen offset:2048 nt lds
    v_mfma_f32_16x16x32_bf16 v[140:143], v[40:43], a[88:91], v[140:143]
    v_add_u32 v23, 0x10000, v23
    ds_read_b64_tr_b16 v[56:57], v16 offset:0
    v_mfma_f32_16x16x32_bf16 v[140:143], v[44:47], a[92:95], v[140:143]
    ds_read_b128 a[4:7], v23 offset:16384
    ds_read_b64_tr_b16 v[58:59], v16 offset:1024
    v_mfma_f32_16x16x32_bf16 v[144:147], v[40:43], a[96:99], v[144:147]
    s_cmp_lt_u32 s2, 192
    s_cselect_b32 s72, s72, 1073741824
    ds_read_b64_tr_b16 v[60:61], v16 offset:8192
    v_mfma_f32_16x16x32_bf16 v[144:147], v[44:47], a[100:103], v[144:147]
    buffer_store_dwordx4 v[84:87], v93, s[28:31], s72 offen sc1
    v_mfma_f32_16x16x32_bf16 v[148:151], v[40:43], a[104:107], v[148:151]
    s_mul_i32 s72, s2, 3
    ds_read_b64_tr_b16 v[62:63], v16 offset:9216
    v_mfma_f32_16x16x32_bf16 v[148:151], v[44:47], a[108:111], v[148:151]
    s_add_u32 s72, s72, 2
    v_mfma_f32_16x16x32_bf16 v[152:155], v[40:43], a[112:115], v[152:155]
    s_bfe_u32 s98, s72, 0x10001
    buffer_load_dwordx4 v5, s[16:19], s60 offen offset:3072 nt lds
    v_mfma_f32_16x16x32_bf16 v[152:155], v[44:47], a[116:119], v[152:155]
    s_bfe_u32 s99, s72, 0x10003
    ds_read_b128 a[8:11], v22 offset:18432
    v_mfma_f32_16x16x32_bf16 v[156:159], v[40:43], a[120:123], v[156:159]
    s_mov_b32 vcc_lo, 0x84848484
    s_mov_b32 vcc_hi, 0x84848484
    v_cndmask_b32_e64 v89, v89, 0, vcc
    v_mfma_f32_16x16x32_bf16 v[156:159], v[44:47], a[124:127], v[156:159]
    s_lshl1_add_u32 s98, s99, s98
    ds_read_b64_tr_b16 v[40:41], v17 offset:0
    ds_read_b64_tr_b16 v[42:43], v17 offset:1024
    s_waitcnt lgkmcnt(3)
    v_mfma_f32_16x16x32_bf16 v[160:163], v[48:51], a[64:67], v[160:163]
    s_mov_b32 vcc_lo, 0x10101010
    s_mov_b32 vcc_hi, 0x10101010
    v_cndmask_b32_e64 v91, v91, 0, vcc
    v_mfma_f32_16x16x32_bf16 v[160:163], v[52:55], a[68:71], v[160:163]
    s_lshl_b32 s98, s98, 5
    v_xor_b32 v94, s98, v95
    ds_read_b64_tr_b16 v[44:45], v17 offset:8192
    v_mfma_f32_16x16x32_bf16 v[164:167], v[48:51], a[72:75], v[164:167]
    s_lshl_b32 s72, s72, 7
    ds_read_b128 a[12:15], v23 offset:18432
    ds_read_b64_tr_b16 v[46:47], v17 offset:9216
    v_mfma_f32_16x16x32_bf16 v[164:167], v[52:55], a[76:79], v[164:167]
    s_add_u32 m0, s69, 16384
    v_mfma_f32_16x16x32_bf16 v[168:171], v[48:51], a[80:83], v[168:171]
    s_xor_b32 s60, s60, 524288
    buffer_load_dwordx4 v6, s[8:11], s62 offen lds
    v_mfma_f32_16x16x32_bf16 v[168:171], v[52:55], a[84:87], v[168:171]
    s_cmp_lt_u32 s2, 192
    s_cselect_b32 s72, s72, 1073741824
    v_mfma_f32_16x16x32_bf16 v[172:175], v[48:51], a[88:91], v[172:175]
    s_lshl2_add_u32 s99, s100, s4
    buffer_store_dwordx4 v[88:91], v94, s[28:31], s72 offen sc1
    v_mfma_f32_16x16x32_bf16 v[172:175], v[52:55], a[92:95], v[172:175]
    s_add_u32 s28, s28, s7
    s_addc_u32 s29, s29, 0
    v_mfma_f32_16x16x32_bf16 v[176:179], v[48:51], a[96:99], v[176:179]
    s_mov_b32 s30, 73728
    ds_read_b128 a[16:19], v22 offset:20480
    v_mfma_f32_16x16x32_bf16 v[176:179], v[52:55], a[100:103], v[176:179]
    s_lshl_b32 s99, s99, 7
    v_mfma_f32_16x16x32_bf16 v[180:183], v[48:51], a[104:107], v[180:183]
    v_mfma_f32_16x16x32_bf16 v[180:183], v[52:55], a[108:111], v[180:183]
    buffer_load_dwordx4 v7, s[8:11], s62 offen offset:1024 lds
    v_mfma_f32_16x16x32_bf16 v[184:187], v[48:51], a[112:115], v[184:187]
    v_mfma_f32_16x16x32_bf16 v[184:187], v[52:55], a[116:119], v[184:187]
    ds_read_b128 a[20:23], v23 offset:20480
    v_mfma_f32_16x16x32_bf16 v[188:191], v[48:51], a[120:123], v[188:191]
    ds_read_b64_tr_b16 v[48:49], v14 offset:32768
    ds_read_b64_tr_b16 v[50:51], v14 offset:33792
    v_mfma_f32_16x16x32_bf16 v[188:191], v[52:55], a[124:127], v[188:191]
    ds_read_b64_tr_b16 v[52:53], v14 offset:40960
    ds_read_b64_tr_b16 v[54:55], v14 offset:41984
    v_mfma_f32_16x16x32_bf16 v[192:195], v[56:59], a[64:67], v[192:195]
    v_add_u32 v14, 0x10000, v14
    v_mfma_f32_16x16x32_bf16 v[192:195], v[60:63], a[68:71], v[192:195]
    v_mfma_f32_16x16x32_bf16 v[196:199], v[56:59], a[72:75], v[196:199]
    v_mfma_f32_16x16x32_bf16 v[196:199], v[60:63], a[76:79], v[196:199]
    buffer_load_dwordx4 v8, s[8:11], s62 offen offset:2048 lds
    v_mfma_f32_16x16x32_bf16 v[200:203], v[56:59], a[80:83], v[200:203]
    ds_read_b128 a[24:27], v22 offset:22528
    v_mfma_f32_16x16x32_bf16 v[200:203], v[60:63], a[84:87], v[200:203]
    v_mfma_f32_16x16x32_bf16 v[204:207], v[56:59], a[88:91], v[204:207]
    v_mfma_f32_16x16x32_bf16 v[204:207], v[60:63], a[92:95], v[204:207]
    v_mfma_f32_16x16x32_bf16 v[208:211], v[56:59], a[96:99], v[208:211]
    ds_read_b128 a[28:31], v23 offset:22528
    v_mfma_f32_16x16x32_bf16 v[208:211], v[60:63], a[100:103], v[208:211]
    v_mfma_f32_16x16x32_bf16 v[212:215], v[56:59], a[104:107], v[212:215]
    buffer_load_dwordx4 v9, s[8:11], s62 offen offset:3072 lds
    v_mfma_f32_16x16x32_bf16 v[212:215], v[60:63], a[108:111], v[212:215]
    v_mfma_f32_16x16x32_bf16 v[216:219], v[56:59], a[112:115], v[216:219]
    v_mfma_f32_16x16x32_bf16 v[216:219], v[60:63], a[116:119], v[216:219]
    v_mfma_f32_16x16x32_bf16 v[220:223], v[56:59], a[120:123], v[220:223]
    s_waitcnt lgkmcnt(0)
    ds_read_b64_tr_b16 v[56:57], v15 offset:32768
    ds_read_b64_tr_b16 v[58:59], v15 offset:33792
    v_mfma_f32_16x16x32_bf16 v[220:223], v[60:63], a[124:127], v[220:223]
    ds_read_b64_tr_b16 v[60:61], v15 offset:40960
    ds_read_b64_tr_b16 v[62:63], v15 offset:41984
    v_mfma_f32_16x16x32_bf16 v[224:227], v[40:43], a[64:67], v[224:227]
    v_add_u32 v15, 0x10000, v15
    v_mfma_f32_16x16x32_bf16 v[224:227], v[44:47], a[68:71], v[224:227]
    s_xor_b32 s62, s62, 384
    v_mfma_f32_16x16x32_bf16 v[228:231], v[40:43], a[72:75], v[228:231]
    buffer_load_dword v107, v103, s[24:27], s77 offen
    v_mfma_f32_16x16x32_bf16 v[228:231], v[44:47], a[76:79], v[228:231]
    s_add_u32 s77, s77, 4608
    v_mfma_f32_16x16x32_bf16 v[232:235], v[40:43], a[80:83], v[232:235]
    v_mfma_f32_16x16x32_bf16 v[232:235], v[44:47], a[84:87], v[232:235]
    s_add_u32 m0, s69, 32768
    v_mfma_f32_16x16x32_bf16 v[236:239], v[40:43], a[88:91], v[236:239]
    buffer_load_dwordx4 v2, s[12:15], s60 offen nt lds
    v_mfma_f32_16x16x32_bf16 v[236:239], v[44:47], a[92:95], v[236:239]
    v_mfma_f32_16x16x32_bf16 v[240:243], v[40:43], a[96:99], v[240:243]
    v_mfma_f32_16x16x32_bf16 v[240:243], v[44:47], a[100:103], v[240:243]
    v_mfma_f32_16x16x32_bf16 v[244:247], v[40:43], a[104:107], v[244:247]
    v_mfma_f32_16x16x32_bf16 v[244:247], v[44:47], a[108:111], v[244:247]
    v_mfma_f32_16x16x32_bf16 v[248:251], v[40:43], a[112:115], v[248:251]
    v_mfma_f32_16x16x32_bf16 v[248:251], v[44:47], a[116:119], v[248:251]
    buffer_load_dwordx4 v3, s[12:15], s60 offen offset:1024 nt lds
    v_mfma_f32_16x16x32_bf16 v[252:255], v[40:43], a[120:123], v[252:255]
    ds_read_b64_tr_b16 v[40:41], v16 offset:32768
    ds_read_b64_tr_b16 v[42:43], v16 offset:33792
    v_mfma_f32_16x16x32_bf16 v[252:255], v[44:47], a[124:127], v[252:255]
    ds_read_b64_tr_b16 v[44:45], v16 offset:40960
    ds_read_b64_tr_b16 v[46:47], v16 offset:41984
    v_mfma_f32_16x16x32_bf16 a[128:131], a[64:67], v[48:51], a[128:131]
    v_add_u32 v16, 0x10000, v16
    v_mfma_f32_16x16x32_bf16 a[128:131], a[68:71], v[52:55], a[128:131]
    v_mfma_f32_16x16x32_bf16 a[132:135], a[72:75], v[48:51], a[132:135]
    ds_read_b128 a[32:35], v22 offset:49152
    v_mfma_f32_16x16x32_bf16 a[132:135], a[76:79], v[52:55], a[132:135]
    v_mfma_f32_16x16x32_bf16 a[136:139], a[80:83], v[48:51], a[136:139]
    v_mfma_f32_16x16x32_bf16 a[136:139], a[84:87], v[52:55], a[136:139]
    buffer_load_dwordx4 v4, s[12:15], s60 offen offset:2048 nt lds
    v_mfma_f32_16x16x32_bf16 a[140:143], a[88:91], v[48:51], a[140:143]
    v_mfma_f32_16x16x32_bf16 a[140:143], a[92:95], v[52:55], a[140:143]
    ds_read_b128 a[36:39], v23 offset:49152
    v_mfma_f32_16x16x32_bf16 a[144:147], a[96:99], v[48:51], a[144:147]
    v_mfma_f32_16x16x32_bf16 a[144:147], a[100:103], v[52:55], a[144:147]
    v_mfma_f32_16x16x32_bf16 a[148:151], a[104:107], v[48:51], a[148:151]
    v_mfma_f32_16x16x32_bf16 a[148:151], a[108:111], v[52:55], a[148:151]
    v_mfma_f32_16x16x32_bf16 a[152:155], a[112:115], v[48:51], a[152:155]
    buffer_load_dwordx4 v5, s[12:15], s60 offen offset:3072 nt lds
    v_mfma_f32_16x16x32_bf16 a[152:155], a[116:119], v[52:55], a[152:155]
    ds_read_b128 a[40:43], v22 offset:51200
    v_mfma_f32_16x16x32_bf16 a[156:159], a[120:123], v[48:51], a[156:159]
    ds_read_b64_tr_b16 v[48:49], v17 offset:32768
    ds_read_b64_tr_b16 v[50:51], v17 offset:33792
    v_mfma_f32_16x16x32_bf16 a[156:159], a[124:127], v[52:55], a[156:159]
    s_waitcnt lgkmcnt(3)
    ds_read_b64_tr_b16 v[52:53], v17 offset:40960
    ds_read_b64_tr_b16 v[54:55], v17 offset:41984
    v_mfma_f32_16x16x32_bf16 a[160:163], a[64:67], v[56:59], a[160:163]
    v_add_u32 v17, 0x10000, v17
    v_mfma_f32_16x16x32_bf16 a[160:163], a[68:71], v[60:63], a[160:163]
    v_mfma_f32_16x16x32_bf16 a[164:167], a[72:75], v[56:59], a[164:167]
    ds_read_b128 a[44:47], v23 offset:51200
    v_mfma_f32_16x16x32_bf16 a[164:167], a[76:79], v[60:63], a[164:167]
    s_add_u32 m0, s69, 49152
    v_mfma_f32_16x16x32_bf16 a[168:171], a[80:83], v[56:59], a[168:171]
    buffer_load_dwordx4 v6, s[8:11], s61 offen lds
    v_mfma_f32_16x16x32_bf16 a[168:171], a[84:87], v[60:63], a[168:171]
    v_mfma_f32_16x16x32_bf16 a[172:175], a[88:91], v[56:59], a[172:175]
    v_mfma_f32_16x16x32_bf16 a[172:175], a[92:95], v[60:63], a[172:175]
    v_mfma_f32_16x16x32_bf16 a[176:179], a[96:99], v[56:59], a[176:179]
    ds_read_b128 a[48:51], v22 offset:53248
    v_mfma_f32_16x16x32_bf16 a[176:179], a[100:103], v[60:63], a[176:179]
    v_mfma_f32_16x16x32_bf16 a[180:183], a[104:107], v[56:59], a[180:183]
    v_mfma_f32_16x16x32_bf16 a[180:183], a[108:111], v[60:63], a[180:183]
    buffer_load_dwordx4 v7, s[8:11], s61 offen offset:1024 lds
    v_mfma_f32_16x16x32_bf16 a[184:187], a[112:115], v[56:59], a[184:187]
    v_mfma_f32_16x16x32_bf16 a[184:187], a[116:119], v[60:63], a[184:187]
    ds_read_b128 a[52:55], v23 offset:53248
    v_mfma_f32_16x16x32_bf16 a[188:191], a[120:123], v[56:59], a[188:191]
    v_mfma_f32_16x16x32_bf16 a[188:191], a[124:127], v[60:63], a[188:191]
    v_mfma_f32_16x16x32_bf16 a[192:195], a[64:67], v[40:43], a[192:195]
    v_mfma_f32_16x16x32_bf16 a[192:195], a[68:71], v[44:47], a[192:195]
    v_mfma_f32_16x16x32_bf16 a[196:199], a[72:75], v[40:43], a[196:199]
    v_mfma_f32_16x16x32_bf16 a[196:199], a[76:79], v[44:47], a[196:199]
    buffer_load_dwordx4 v8, s[8:11], s61 offen offset:2048 lds
    v_mfma_f32_16x16x32_bf16 a[200:203], a[80:83], v[40:43], a[200:203]
    ds_read_b128 a[56:59], v22 offset:55296
    v_mfma_f32_16x16x32_bf16 a[200:203], a[84:87], v[44:47], a[200:203]
    v_mfma_f32_16x16x32_bf16 a[204:207], a[88:91], v[40:43], a[204:207]
    v_mfma_f32_16x16x32_bf16 a[204:207], a[92:95], v[44:47], a[204:207]
    v_mfma_f32_16x16x32_bf16 a[208:211], a[96:99], v[40:43], a[208:211]
    ds_read_b128 a[60:63], v23 offset:55296
    v_mfma_f32_16x16x32_bf16 a[208:211], a[100:103], v[44:47], a[208:211]
    v_mfma_f32_16x16x32_bf16 a[212:215], a[104:107], v[40:43], a[212:215]
    buffer_load_dwordx4 v9, s[8:11], s61 offen offset:3072 lds
    v_mfma_f32_16x16x32_bf16 a[212:215], a[108:111], v[44:47], a[212:215]
    v_mfma_f32_16x16x32_bf16 a[216:219], a[112:115], v[40:43], a[216:219]
    v_mfma_f32_16x16x32_bf16 a[216:219], a[116:119], v[44:47], a[216:219]
    v_mfma_f32_16x16x32_bf16 a[220:223], a[120:123], v[40:43], a[220:223]
    v_mfma_f32_16x16x32_bf16 a[220:223], a[124:127], v[44:47], a[220:223]
    s_waitcnt lgkmcnt(0)
    v_mfma_f32_16x16x32_bf16 a[224:227], a[64:67], v[48:51], a[224:227]
    v_mfma_f32_16x16x32_bf16 a[224:227], a[68:71], v[52:55], a[224:227]
    s_xor_b32 s61, s61, 128
    v_mfma_f32_16x16x32_bf16 a[228:231], a[72:75], v[48:51], a[228:231]
    v_mfma_f32_16x16x32_bf16 a[228:231], a[76:79], v[52:55], a[228:231]
    v_mfma_f32_16x16x32_bf16 a[232:235], a[80:83], v[48:51], a[232:235]
    v_mfma_f32_16x16x32_bf16 a[232:235], a[84:87], v[52:55], a[232:235]
    s_waitcnt vmcnt(9) lgkmcnt(0)
    s_barrier
    ds_read_b64_tr_b16 v[56:57], v14 offset:0
    v_mfma_f32_16x16x32_bf16 a[236:239], a[88:91], v[48:51], a[236:239]
    s_add_u32 m0, s69, 65536
    ds_read_b64_tr_b16 v[58:59], v14 offset:1024
    ds_read_b64_tr_b16 v[60:61], v14 offset:8192
    v_mfma_f32_16x16x32_bf16 a[236:239], a[92:95], v[52:55], a[236:239]
    buffer_load_dwordx4 v2, s[16:19], s60 offen nt lds
    v_mfma_f32_16x16x32_bf16 a[240:243], a[96:99], v[48:51], a[240:243]
    ds_read_b64_tr_b16 v[62:63], v14 offset:9216
    ds_read_b64_tr_b16 v[40:41], v15 offset:0
    v_mfma_f32_16x16x32_bf16 a[240:243], a[100:103], v[52:55], a[240:243]
    buffer_atomic_add v31, v30, s[44:47], s95 offen sc1
    v_mfma_f32_16x16x32_bf16 a[244:247], a[104:107], v[48:51], a[244:247]
    s_mov_b32 s95, 32768
    ds_read_b64_tr_b16 v[42:43], v15 offset:1024
    ds_read_b64_tr_b16 v[44:45], v15 offset:8192
    v_mfma_f32_16x16x32_bf16 a[244:247], a[108:111], v[52:55], a[244:247]
    ds_read_b64_tr_b16 v[46:47], v15 offset:9216
    v_add_u32 v14, 0xfffe0000, v14
    v_mfma_f32_16x16x32_bf16 a[248:251], a[112:115], v[48:51], a[248:251]
    v_add_u32 v15, 0xfffe0000, v15
    v_mfma_f32_16x16x32_bf16 a[248:251], a[116:119], v[52:55], a[248:251]
    buffer_load_dwordx4 v3, s[16:19], s60 offen offset:1024 nt lds
    v_mfma_f32_16x16x32_bf16 a[252:255], a[120:123], v[48:51], a[252:255]
    ds_read_b64_tr_b16 v[48:49], v16 offset:0
    ds_read_b64_tr_b16 v[50:51], v16 offset:1024
    v_mfma_f32_16x16x32_bf16 a[252:255], a[124:127], v[52:55], a[252:255]
    s_waitcnt lgkmcnt(3)
    ds_read_b64_tr_b16 v[52:53], v16 offset:8192
    ds_read_b64_tr_b16 v[54:55], v16 offset:9216
    v_mfma_f32_16x16x32_bf16 v[128:131], v[56:59], a[0:3], v[128:131]
    v_add_u32 v16, 0xfffe0000, v16
    v_mfma_f32_16x16x32_bf16 v[128:131], v[60:63], a[4:7], v[128:131]
    v_add_u32 v22, 0x10000, v22
    v_mfma_f32_16x16x32_bf16 v[132:135], v[56:59], a[8:11], v[132:135]
    ds_read_b128 a[64:67], v22 offset:16384
    v_mfma_f32_16x16x32_bf16 v[132:135], v[60:63], a[12:15], v[132:135]
    v_mfma_f32_16x16x32_bf16 v[136:139], v[56:59], a[16:19], v[136:139]
    v_mfma_f32_16x16x32_bf16 v[136:139], v[60:63], a[20:23], v[136:139]
    buffer_load_dwordx4 v4, s[16:19], s60 offen offset:2048 nt lds
    v_mfma_f32_16x16x32_bf16 v[140:143], v[56:59], a[24:27], v[140:143]
    v_add_u32 v23, 0x10000, v23
    v_mfma_f32_16x16x32_bf16 v[140:143], v[60:63], a[28:31], v[140:143]
    ds_read_b128 a[68:71], v23 offset:16384
    v_mfma_f32_16x16x32_bf16 v[144:147], v[56:59], a[32:35], v[144:147]
    v_mfma_f32_16x16x32_bf16 v[144:147], v[60:63], a[36:39], v[144:147]
    v_mfma_f32_16x16x32_bf16 v[148:151], v[56:59], a[40:43], v[148:151]
    v_mfma_f32_16x16x32_bf16 v[148:151], v[60:63], a[44:47], v[148:151]
    v_mfma_f32_16x16x32_bf16 v[152:155], v[56:59], a[48:51], v[152:155]
    buffer_load_dwordx4 v5, s[16:19], s60 offen offset:3072 nt lds
    v_mfma_f32_16x16x32_bf16 v[152:155], v[60:63], a[52:55], v[152:155]
    ds_read_b128 a[72:75], v22 offset:18432
    v_mfma_f32_16x16x32_bf16 v[156:159], v[56:59], a[56:59], v[156:159]
    ds_read_b64_tr_b16 v[56:57], v17 offset:0
    ds_read_b64_tr_b16 v[58:59], v17 offset:1024
    v_mfma_f32_16x16x32_bf16 v[156:159], v[60:63], a[60:63], v[156:159]
    ds_read_b64_tr_b16 v[60:61], v17 offset:8192
    ds_read_b64_tr_b16 v[62:63], v17 offset:9216
    v_mfma_f32_16x16x32_bf16 v[160:163], v[40:43], a[0:3], v[160:163]
    s_waitcnt lgkmcnt(5)
    v_add_u32 v17, 0xfffe0000, v17
    v_mfma_f32_16x16x32_bf16 v[160:163], v[44:47], a[4:7], v[160:163]
    v_mfma_f32_16x16x32_bf16 v[164:167], v[40:43], a[8:11], v[164:167]
    ds_read_b128 a[76:79], v23 offset:18432
    v_mfma_f32_16x16x32_bf16 v[164:167], v[44:47], a[12:15], v[164:167]
    s_add_u32 m0, s69, 81920
    v_mfma_f32_16x16x32_bf16 v[168:171], v[40:43], a[16:19], v[168:171]
    s_xor_b32 s60, s60, 1572864
    buffer_load_dwordx4 v6, s[8:11], s62 offen lds
    v_mfma_f32_16x16x32_bf16 v[168:171], v[44:47], a[20:23], v[168:171]
    v_mfma_f32_16x16x32_bf16 v[172:175], v[40:43], a[24:27], v[172:175]
    v_mfma_f32_16x16x32_bf16 v[172:175], v[44:47], a[28:31], v[172:175]
    v_mfma_f32_16x16x32_bf16 v[176:179], v[40:43], a[32:35], v[176:179]
    ds_read_b128 a[80:83], v22 offset:20480
    v_mfma_f32_16x16x32_bf16 v[176:179], v[44:47], a[36:39], v[176:179]
    v_mfma_f32_16x16x32_bf16 v[180:183], v[40:43], a[40:43], v[180:183]
    v_mfma_f32_16x16x32_bf16 v[180:183], v[44:47], a[44:47], v[180:183]
    buffer_load_dwordx4 v7, s[8:11], s62 offen offset:1024 lds
    v_mfma_f32_16x16x32_bf16 v[184:187], v[40:43], a[48:51], v[184:187]
    v_mfma_f32_16x16x32_bf16 v[184:187], v[44:47], a[52:55], v[184:187]
    ds_read_b128 a[84:87], v23 offset:20480
    v_mfma_f32_16x16x32_bf16 v[188:191], v[40:43], a[56:59], v[188:191]
    ds_read_b64_tr_b16 v[40:41], v14 offset:0
    ds_read_b64_tr_b16 v[42:43], v14 offset:1024
    v_mfma_f32_16x16x32_bf16 v[188:191], v[44:47], a[60:63], v[188:191]
    ds_read_b64_tr_b16 v[44:45], v14 offset:8192
    ds_read_b64_tr_b16 v[46:47], v14 offset:9216
    v_mfma_f32_16x16x32_bf16 v[192:195], v[48:51], a[0:3], v[192:195]
    v_mfma_f32_16x16x32_bf16 v[192:195], v[52:55], a[4:7], v[192:195]
    v_mfma_f32_16x16x32_bf16 v[196:199], v[48:51], a[8:11], v[196:199]
    v_mfma_f32_16x16x32_bf16 v[196:199], v[52:55], a[12:15], v[196:199]
    buffer_load_dwordx4 v8, s[8:11], s62 offen offset:2048 lds
    v_mfma_f32_16x16x32_bf16 v[200:203], v[48:51], a[16:19], v[200:203]
    ds_read_b128 a[88:91], v22 offset:22528
    v_mfma_f32_16x16x32_bf16 v[200:203], v[52:55], a[20:23], v[200:203]
    v_mfma_f32_16x16x32_bf16 v[204:207], v[48:51], a[24:27], v[204:207]
    v_mfma_f32_16x16x32_bf16 v[204:207], v[52:55], a[28:31], v[204:207]
    v_mfma_f32_16x16x32_bf16 v[208:211], v[48:51], a[32:35], v[208:211]
    ds_read_b128 a[92:95], v23 offset:22528
    v_mfma_f32_16x16x32_bf16 v[208:211], v[52:55], a[36:39], v[208:211]
    v_mfma_f32_16x16x32_bf16 v[212:215], v[48:51], a[40:43], v[212:215]
    buffer_load_dwordx4 v9, s[8:11], s62 offen offset:3072 lds
    v_mfma_f32_16x16x32_bf16 v[212:215], v[52:55], a[44:47], v[212:215]
    v_mfma_f32_16x16x32_bf16 v[216:219], v[48:51], a[48:51], v[216:219]
    v_mfma_f32_16x16x32_bf16 v[216:219], v[52:55], a[52:55], v[216:219]
    v_mfma_f32_16x16x32_bf16 v[220:223], v[48:51], a[56:59], v[220:223]
    s_waitcnt lgkmcnt(0)
    ds_read_b64_tr_b16 v[48:49], v15 offset:0
    ds_read_b64_tr_b16 v[50:51], v15 offset:1024
    v_mfma_f32_16x16x32_bf16 v[220:223], v[52:55], a[60:63], v[220:223]
    ds_read_b64_tr_b16 v[52:53], v15 offset:8192
    ds_read_b64_tr_b16 v[54:55], v15 offset:9216
    v_mfma_f32_16x16x32_bf16 v[224:227], v[56:59], a[0:3], v[224:227]
    v_mfma_f32_16x16x32_bf16 v[224:227], v[60:63], a[4:7], v[224:227]
    s_xor_b32 s62, s62, 128
    v_mfma_f32_16x16x32_bf16 v[228:231], v[56:59], a[8:11], v[228:231]
    buffer_load_dword v108, v103, s[24:27], s77 offen
    v_mfma_f32_16x16x32_bf16 v[228:231], v[60:63], a[12:15], v[228:231]
    s_add_u32 s77, s77, 4608
    v_mfma_f32_16x16x32_bf16 v[232:235], v[56:59], a[16:19], v[232:235]
    v_mfma_f32_16x16x32_bf16 v[232:235], v[60:63], a[20:23], v[232:235]
    s_add_u32 m0, s69, 98304
    v_mfma_f32_16x16x32_bf16 v[236:239], v[56:59], a[24:27], v[236:239]
    buffer_load_dwordx4 v2, s[12:15], s60 offen nt lds
    v_mfma_f32_16x16x32_bf16 v[236:239], v[60:63], a[28:31], v[236:239]
    v_mfma_f32_16x16x32_bf16 v[240:243], v[56:59], a[32:35], v[240:243]
    v_mfma_f32_16x16x32_bf16 v[240:243], v[60:63], a[36:39], v[240:243]
    v_mfma_f32_16x16x32_bf16 v[244:247], v[56:59], a[40:43], v[244:247]
    v_mfma_f32_16x16x32_bf16 v[244:247], v[60:63], a[44:47], v[244:247]
    v_mfma_f32_16x16x32_bf16 v[248:251], v[56:59], a[48:51], v[248:251]
    v_mfma_f32_16x16x32_bf16 v[248:251], v[60:63], a[52:55], v[248:251]
    buffer_load_dwordx4 v3, s[12:15], s60 offen offset:1024 nt lds
    v_mfma_f32_16x16x32_bf16 v[252:255], v[56:59], a[56:59], v[252:255]
    ds_read_b64_tr_b16 v[56:57], v16 offset:0
    ds_read_b64_tr_b16 v[58:59], v16 offset:1024
    v_mfma_f32_16x16x32_bf16 v[252:255], v[60:63], a[60:63], v[252:255]
    ds_read_b64_tr_b16 v[60:61], v16 offset:8192
    ds_read_b64_tr_b16 v[62:63], v16 offset:9216
    v_mfma_f32_16x16x32_bf16 a[128:131], a[0:3], v[40:43], a[128:131]
    v_mfma_f32_16x16x32_bf16 a[128:131], a[4:7], v[44:47], a[128:131]
    v_add_u32 v22, 0xfffe0000, v22
    v_mfma_f32_16x16x32_bf16 a[132:135], a[8:11], v[40:43], a[132:135]
    ds_read_b128 a[96:99], v22 offset:16384
    v_mfma_f32_16x16x32_bf16 a[132:135], a[12:15], v[44:47], a[132:135]
    v_mfma_f32_16x16x32_bf16 a[136:139], a[16:19], v[40:43], a[136:139]
    v_mfma_f32_16x16x32_bf16 a[136:139], a[20:23], v[44:47], a[136:139]
    buffer_load_dwordx4 v4, s[12:15], s60 offen offset:2048 nt lds
    v_mfma_f32_16x16x32_bf16 a[140:143], a[24:27], v[40:43], a[140:143]
    v_add_u32 v23, 0xfffe0000, v23
    v_mfma_f32_16x16x32_bf16 a[140:143], a[28:31], v[44:47], a[140:143]
    ds_read_b128 a[100:103], v23 offset:16384
    v_mfma_f32_16x16x32_bf16 a[144:147], a[32:35], v[40:43], a[144:147]
    v_mfma_f32_16x16x32_bf16 a[144:147], a[36:39], v[44:47], a[144:147]
    v_mfma_f32_16x16x32_bf16 a[148:151], a[40:43], v[40:43], a[148:151]
    v_mfma_f32_16x16x32_bf16 a[148:151], a[44:47], v[44:47], a[148:151]
    v_mfma_f32_16x16x32_bf16 a[152:155], a[48:51], v[40:43], a[152:155]
    buffer_load_dwordx4 v5, s[12:15], s60 offen offset:3072 nt lds
    v_mfma_f32_16x16x32_bf16 a[152:155], a[52:55], v[44:47], a[152:155]
    ds_read_b128 a[104:107], v22 offset:18432
    v_mfma_f32_16x16x32_bf16 a[156:159], a[56:59], v[40:43], a[156:159]
    ds_read_b64_tr_b16 v[40:41], v17 offset:0
    ds_read_b64_tr_b16 v[42:43], v17 offset:1024
    v_mfma_f32_16x16x32_bf16 a[156:159], a[60:63], v[44:47], a[156:159]
    s_waitcnt lgkmcnt(3)
    ds_read_b64_tr_b16 v[44:45], v17 offset:8192
    ds_read_b64_tr_b16 v[46:47], v17 offset:9216
    v_mfma_f32_16x16x32_bf16 a[160:163], a[0:3], v[48:51], a[160:163]
    v_mfma_f32_16x16x32_bf16 a[160:163], a[4:7], v[52:55], a[160:163]
    v_mfma_f32_16x16x32_bf16 a[164:167], a[8:11], v[48:51], a[164:167]
    ds_read_b128 a[108:111], v23 offset:18432
    v_mfma_f32_16x16x32_bf16 a[164:167], a[12:15], v[52:55], a[164:167]
    s_add_u32 m0, s69, 114688
    v_mfma_f32_16x16x32_bf16 a[168:171], a[16:19], v[48:51], a[168:171]
    s_xor_b32 s60, s60, 524288
    buffer_load_dwordx4 v6, s[8:11], s61 offen lds
    v_mfma_f32_16x16x32_bf16 a[168:171], a[20:23], v[52:55], a[168:171]
    v_mfma_f32_16x16x32_bf16 a[172:175], a[24:27], v[48:51], a[172:175]
    v_mfma_f32_16x16x32_bf16 a[172:175], a[28:31], v[52:55], a[172:175]
    v_mfma_f32_16x16x32_bf16 a[176:179], a[32:35], v[48:51], a[176:179]
    ds_read_b128 a[112:115], v22 offset:20480
    v_mfma_f32_16x16x32_bf16 a[176:179], a[36:39], v[52:55], a[176:179]
    v_mfma_f32_16x16x32_bf16 a[180:183], a[40:43], v[48:51], a[180:183]
    v_mfma_f32_16x16x32_bf16 a[180:183], a[44:47], v[52:55], a[180:183]
    buffer_load_dwordx4 v7, s[8:11], s61 offen offset:1024 lds
    v_mfma_f32_16x16x32_bf16 a[184:187], a[48:51], v[48:51], a[184:187]
    v_mfma_f32_16x16x32_bf16 a[184:187], a[52:55], v[52:55], a[184:187]
    ds_read_b128 a[116:119], v23 offset:20480
    v_mfma_f32_16x16x32_bf16 a[188:191], a[56:59], v[48:51], a[188:191]
    v_mfma_f32_16x16x32_bf16 a[188:191], a[60:63], v[52:55], a[188:191]
    v_mfma_f32_16x16x32_bf16 a[192:195], a[0:3], v[56:59], a[192:195]
    v_mfma_f32_16x16x32_bf16 a[192:195], a[4:7], v[60:63], a[192:195]
    v_mfma_f32_16x16x32_bf16 a[196:199], a[8:11], v[56:59], a[196:199]
    v_mfma_f32_16x16x32_bf16 a[196:199], a[12:15], v[60:63], a[196:199]
    buffer_load_dwordx4 v8, s[8:11], s61 offen offset:2048 lds
    v_mfma_f32_16x16x32_bf16 a[200:203], a[16:19], v[56:59], a[200:203]
    ds_read_b128 a[120:123], v22 offset:22528
    v_mfma_f32_16x16x32_bf16 a[200:203], a[20:23], v[60:63], a[200:203]
    v_mfma_f32_16x16x32_bf16 a[204:207], a[24:27], v[56:59], a[204:207]
    v_mfma_f32_16x16x32_bf16 a[204:207], a[28:31], v[60:63], a[204:207]
    v_mfma_f32_16x16x32_bf16 a[208:211], a[32:35], v[56:59], a[208:211]
    ds_read_b128 a[124:127], v23 offset:22528
    v_mfma_f32_16x16x32_bf16 a[208:211], a[36:39], v[60:63], a[208:211]
    v_mfma_f32_16x16x32_bf16 a[212:215], a[40:43], v[56:59], a[212:215]
    buffer_load_dwordx4 v9, s[8:11], s61 offen offset:3072 lds
    v_mfma_f32_16x16x32_bf16 a[212:215], a[44:47], v[60:63], a[212:215]
    v_mfma_f32_16x16x32_bf16 a[216:219], a[48:51], v[56:59], a[216:219]
    v_mfma_f32_16x16x32_bf16 a[216:219], a[52:55], v[60:63], a[216:219]
    v_mfma_f32_16x16x32_bf16 a[220:223], a[56:59], v[56:59], a[220:223]
    v_mfma_f32_16x16x32_bf16 a[220:223], a[60:63], v[60:63], a[220:223]
    s_waitcnt lgkmcnt(0)
    v_mfma_f32_16x16x32_bf16 a[224:227], a[0:3], v[40:43], a[224:227]
    v_mfma_f32_16x16x32_bf16 a[224:227], a[4:7], v[44:47], a[224:227]
    s_xor_b32 s61, s61, 1920
    v_mfma_f32_16x16x32_bf16 a[228:231], a[8:11], v[40:43], a[228:231]
    s_andn2_b32 s61, s61, 896
    v_mfma_f32_16x16x32_bf16 a[228:231], a[12:15], v[44:47], a[228:231]
    s_lshl_b32 s61, s5, 7
    v_mfma_f32_16x16x32_bf16 a[232:235], a[16:19], v[40:43], a[232:235]
    v_mfma_f32_16x16x32_bf16 a[232:235], a[20:23], v[44:47], a[232:235]
    s_waitcnt vmcnt(9) lgkmcnt(0)
    s_barrier
    ds_read_b64_tr_b16 v[48:49], v14 offset:32768
    v_mfma_f32_16x16x32_bf16 a[236:239], a[24:27], v[40:43], a[236:239]
    s_add_u32 m0, s69, 131072
    ds_read_b64_tr_b16 v[50:51], v14 offset:33792
    ds_read_b64_tr_b16 v[52:53], v14 offset:40960
    v_mfma_f32_16x16x32_bf16 a[236:239], a[28:31], v[44:47], a[236:239]
    buffer_load_dwordx4 v2, s[12:15], s60 offen nt lds
    v_mfma_f32_16x16x32_bf16 a[240:243], a[32:35], v[40:43], a[240:243]
    ds_read_b64_tr_b16 v[54:55], v14 offset:41984
    ds_read_b64_tr_b16 v[56:57], v15 offset:32768
    v_mfma_f32_16x16x32_bf16 a[240:243], a[36:39], v[44:47], a[240:243]
    ds_read_b64_tr_b16 v[58:59], v15 offset:33792
    ds_read_b64_tr_b16 v[60:61], v15 offset:40960
    v_mfma_f32_16x16x32_bf16 a[244:247], a[40:43], v[40:43], a[244:247]
    ds_read_b64_tr_b16 v[62:63], v15 offset:41984
    v_add_u32 v14, 0x10000, v14
    v_mfma_f32_16x16x32_bf16 a[244:247], a[44:47], v[44:47], a[244:247]
    v_add_u32 v15, 0x10000, v15
    v_mfma_f32_16x16x32_bf16 a[248:251], a[48:51], v[40:43], a[248:251]
    v_mfma_f32_16x16x32_bf16 a[248:251], a[52:55], v[44:47], a[248:251]
    buffer_load_dwordx4 v3, s[12:15], s60 offen offset:1024 nt lds
    v_mfma_f32_16x16x32_bf16 a[252:255], a[56:59], v[40:43], a[252:255]
    ds_read_b64_tr_b16 v[40:41], v16 offset:32768
    ds_read_b64_tr_b16 v[42:43], v16 offset:33792
    v_mfma_f32_16x16x32_bf16 a[252:255], a[60:63], v[44:47], a[252:255]
    s_waitcnt lgkmcnt(2)
    ds_read_b64_tr_b16 v[44:45], v16 offset:40960
    ds_read_b64_tr_b16 v[46:47], v16 offset:41984
    v_mfma_f32_16x16x32_bf16 v[128:131], v[48:51], a[64:67], v[128:131]
    v_add_u32 v16, 0x10000, v16
    v_mfma_f32_16x16x32_bf16 v[128:131], v[52:55], a[68:71], v[128:131]
    v_mfma_f32_16x16x32_bf16 v[132:135], v[48:51], a[72:75], v[132:135]
    ds_read_b128 a[0:3], v22 offset:49152
    v_mfma_f32_16x16x32_bf16 v[132:135], v[52:55], a[76:79], v[132:135]
    v_mfma_f32_16x16x32_bf16 v[136:139], v[48:51], a[80:83], v[136:139]
    v_mfma_f32_16x16x32_bf16 v[136:139], v[52:55], a[84:87], v[136:139]
    buffer_load_dwordx4 v4, s[12:15], s60 offen offset:2048 nt lds
    v_mfma_f32_16x16x32_bf16 v[140:143], v[48:51], a[88:91], v[140:143]
    v_mfma_f32_16x16x32_bf16 v[140:143], v[52:55], a[92:95], v[140:143]
    ds_read_b128 a[4:7], v23 offset:49152
    v_mfma_f32_16x16x32_bf16 v[144:147], v[48:51], a[96:99], v[144:147]
    v_mfma_f32_16x16x32_bf16 v[144:147], v[52:55], a[100:103], v[144:147]
    v_mfma_f32_16x16x32_bf16 v[148:151], v[48:51], a[104:107], v[148:151]
    v_mfma_f32_16x16x32_bf16 v[148:151], v[52:55], a[108:111], v[148:151]
    v_mfma_f32_16x16x32_bf16 v[152:155], v[48:51], a[112:115], v[152:155]
    buffer_load_dwordx4 v5, s[12:15], s60 offen offset:3072 nt lds
    v_mfma_f32_16x16x32_bf16 v[152:155], v[52:55], a[116:119], v[152:155]
    ds_read_b128 a[8:11], v22 offset:51200
    v_mfma_f32_16x16x32_bf16 v[156:159], v[48:51], a[120:123], v[156:159]
    ds_read_b64_tr_b16 v[48:49], v17 offset:32768
    ds_read_b64_tr_b16 v[50:51], v17 offset:33792
    v_mfma_f32_16x16x32_bf16 v[156:159], v[52:55], a[124:127], v[156:159]
    ds_read_b64_tr_b16 v[52:53], v17 offset:40960
    ds_read_b64_tr_b16 v[54:55], v17 offset:41984
    v_mfma_f32_16x16x32_bf16 v[160:163], v[56:59], a[64:67], v[160:163]
    v_add_u32 v17, 0x10000, v17
    v_mfma_f32_16x16x32_bf16 v[160:163], v[60:63], a[68:71], v[160:163]
    s_cmp_lt_u32 s4, 0
    s_cselect_b32 s12, 0xf149f2ca, 0
    v_mfma_f32_16x16x32_bf16 v[164:167], v[56:59], a[72:75], v[164:167]
    ds_read_b128 a[12:15], v23 offset:51200
    v_mfma_f32_16x16x32_bf16 v[164:167], v[60:63], a[76:79], v[164:167]
    s_add_u32 m0, s69, 147456
    v_mfma_f32_16x16x32_bf16 v[168:171], v[56:59], a[80:83], v[168:171]
    s_xor_b32 s60, s60, 524288
    buffer_load_dwordx4 v6, s[8:11], s62 offen lds
    v_mfma_f32_16x16x32_bf16 v[168:171], v[60:63], a[84:87], v[168:171]
    s_cmp_lt_u32 s4, 1
    s_cselect_b32 s13, 0xf149f2ca, 0
    v_mfma_f32_16x16x32_bf16 v[172:175], v[56:59], a[88:91], v[172:175]
    s_cmp_lt_u32 s4, 2
    s_cselect_b32 s14, 0xf149f2ca, 0
    v_mfma_f32_16x16x32_bf16 v[172:175], v[60:63], a[92:95], v[172:175]
    s_cmp_lt_u32 s4, 3
    s_cselect_b32 s15, 0xf149f2ca, 0
    v_mfma_f32_16x16x32_bf16 v[176:179], v[56:59], a[96:99], v[176:179]
    ds_read_b128 a[16:19], v22 offset:53248
    v_mfma_f32_16x16x32_bf16 v[176:179], v[60:63], a[100:103], v[176:179]
    v_mfma_f32_16x16x32_bf16 v[180:183], v[56:59], a[104:107], v[180:183]
    v_mfma_f32_16x16x32_bf16 v[180:183], v[60:63], a[108:111], v[180:183]
    buffer_load_dwordx4 v7, s[8:11], s62 offen offset:1024 lds
    v_mfma_f32_16x16x32_bf16 v[184:187], v[56:59], a[112:115], v[184:187]
    v_mfma_f32_16x16x32_bf16 v[184:187], v[60:63], a[116:119], v[184:187]
    ds_read_b128 a[20:23], v23 offset:53248
    v_mfma_f32_16x16x32_bf16 v[188:191], v[56:59], a[120:123], v[188:191]
    s_waitcnt lgkmcnt(1)
    ds_read_b64_tr_b16 v[56:57], v14 offset:0
    ds_read_b64_tr_b16 v[58:59], v14 offset:1024
    v_mfma_f32_16x16x32_bf16 v[188:191], v[60:63], a[124:127], v[188:191]
    ds_read_b64_tr_b16 v[60:61], v14 offset:8192
    ds_read_b64_tr_b16 v[62:63], v14 offset:9216
    v_mfma_f32_16x16x32_bf16 v[192:195], v[40:43], a[64:67], v[192:195]
    v_mfma_f32_16x16x32_bf16 v[192:195], v[44:47], a[68:71], v[192:195]
    v_mfma_f32_16x16x32_bf16 v[196:199], v[40:43], a[72:75], v[196:199]
    v_mfma_f32_16x16x32_bf16 v[196:199], v[44:47], a[76:79], v[196:199]
    buffer_load_dwordx4 v8, s[8:11], s62 offen offset:2048 lds
    v_mfma_f32_16x16x32_bf16 v[200:203], v[40:43], a[80:83], v[200:203]
    ds_read_b128 a[24:27], v22 offset:55296
    v_bfe_u32 v8, v1, 4, 3
    v_mfma_f32_16x16x32_bf16 v[200:203], v[44:47], a[84:87], v[200:203]
    v_lshlrev_b32 v8, 12, v8
    v_mfma_f32_16x16x32_bf16 v[204:207], v[40:43], a[88:91], v[204:207]
    v_mfma_f32_16x16x32_bf16 v[204:207], v[44:47], a[92:95], v[204:207]
    v_mfma_f32_16x16x32_bf16 v[208:211], v[40:43], a[96:99], v[208:211]
    ds_read_b128 a[28:31], v23 offset:55296
    v_mfma_f32_16x16x32_bf16 v[208:211], v[44:47], a[100:103], v[208:211]
    v_mfma_f32_16x16x32_bf16 v[212:215], v[40:43], a[104:107], v[212:215]
    buffer_load_dwordx4 v9, s[8:11], s62 offen offset:3072 lds
    v_mfma_f32_16x16x32_bf16 v[212:215], v[44:47], a[108:111], v[212:215]
    s_and_b32 s8, s5, 7
    v_lshrrev_b32 v9, 2, v1
    v_mfma_f32_16x16x32_bf16 v[216:219], v[40:43], a[112:115], v[216:219]
    s_lshl3_add_u32 s8, s6, s8
    v_mfma_f32_16x16x32_bf16 v[216:219], v[44:47], a[116:119], v[216:219]
    s_and_b32 s9, s5, 24
    v_mfma_f32_16x16x32_bf16 v[220:223], v[40:43], a[120:123], v[220:223]
    s_mul_i32 s10, s9, 18
    ds_read_b64_tr_b16 v[40:41], v15 offset:0
    ds_read_b64_tr_b16 v[42:43], v15 offset:1024
    v_mfma_f32_16x16x32_bf16 v[220:223], v[44:47], a[124:127], v[220:223]
    s_add_u32 s10, s10, 16
    ds_read_b64_tr_b16 v[44:45], v15 offset:8192
    ds_read_b64_tr_b16 v[46:47], v15 offset:9216
    v_mfma_f32_16x16x32_bf16 v[224:227], v[48:51], a[64:67], v[224:227]
    s_cmp_eq_u32 s4, 3
    s_cselect_b32 s11, 1.0, 0
    v_mfma_f32_16x16x32_bf16 v[224:227], v[52:55], a[68:71], v[224:227]
    s_xor_b32 s62, s62, 1920
    v_mfma_f32_16x16x32_bf16 v[228:231], v[48:51], a[72:75], v[228:231]
    s_andn2_b32 s62, s62, 896
    buffer_load_dword v109, v103, s[24:27], s77 offen
    v_mfma_f32_16x16x32_bf16 v[228:231], v[52:55], a[76:79], v[228:231]
    v_mfma_f32_16x16x32_bf16 v[232:235], v[48:51], a[80:83], v[232:235]
    v_mfma_f32_16x16x32_bf16 v[232:235], v[52:55], a[84:87], v[232:235]
    s_add_u32 m0, s69, 0
    v_mfma_f32_16x16x32_bf16 v[236:239], v[48:51], a[88:91], v[236:239]
    buffer_load_dwordx4 v2, s[16:19], s60 offen nt lds
    v_mfma_f32_16x16x32_bf16 v[236:239], v[52:55], a[92:95], v[236:239]
    v_mfma_f32_16x16x32_bf16 v[240:243], v[48:51], a[96:99], v[240:243]
    v_mfma_f32_16x16x32_bf16 v[240:243], v[52:55], a[100:103], v[240:243]
    v_mfma_f32_16x16x32_bf16 v[244:247], v[48:51], a[104:107], v[244:247]
    v_mfma_f32_16x16x32_bf16 v[244:247], v[52:55], a[108:111], v[244:247]
    v_mfma_f32_16x16x32_bf16 v[248:251], v[48:51], a[112:115], v[248:251]
    v_mfma_f32_16x16x32_bf16 v[248:251], v[52:55], a[116:119], v[248:251]
    buffer_load_dwordx4 v3, s[16:19], s60 offen offset:1024 nt lds
    v_mfma_f32_16x16x32_bf16 v[252:255], v[48:51], a[120:123], v[252:255]
    ds_read_b64_tr_b16 v[48:49], v16 offset:0
    ds_read_b64_tr_b16 v[50:51], v16 offset:1024
    v_mfma_f32_16x16x32_bf16 v[252:255], v[52:55], a[124:127], v[252:255]
    s_waitcnt lgkmcnt(2)
    ds_read_b64_tr_b16 v[52:53], v16 offset:8192
    ds_read_b64_tr_b16 v[54:55], v16 offset:9216
    v_mfma_f32_16x16x32_bf16 a[128:131], a[64:67], v[56:59], a[128:131]
    v_mfma_f32_16x16x32_bf16 a[128:131], a[68:71], v[60:63], a[128:131]
    v_add_u32 v22, 0x10000, v22
    v_mfma_f32_16x16x32_bf16 a[132:135], a[72:75], v[56:59], a[132:135]
    ds_read_b128 a[32:35], v22 offset:16384
    v_mfma_f32_16x16x32_bf16 a[132:135], a[76:79], v[60:63], a[132:135]
    v_mfma_f32_16x16x32_bf16 a[136:139], a[80:83], v[56:59], a[136:139]
    v_mfma_f32_16x16x32_bf16 a[136:139], a[84:87], v[60:63], a[136:139]
    buffer_load_dwordx4 v4, s[16:19], s60 offen offset:2048 nt lds
    v_mfma_f32_16x16x32_bf16 a[140:143], a[88:91], v[56:59], a[140:143]
    v_add_u32 v23, 0x10000, v23
    v_mfma_f32_16x16x32_bf16 a[140:143], a[92:95], v[60:63], a[140:143]
    ds_read_b128 a[36:39], v23 offset:16384
    v_mfma_f32_16x16x32_bf16 a[144:147], a[96:99], v[56:59], a[144:147]
    v_mfma_f32_16x16x32_bf16 a[144:147], a[100:103], v[60:63], a[144:147]
    v_mfma_f32_16x16x32_bf16 a[148:151], a[104:107], v[56:59], a[148:151]
    v_mfma_f32_16x16x32_bf16 a[148:151], a[108:111], v[60:63], a[148:151]
    v_mfma_f32_16x16x32_bf16 a[152:155], a[112:115], v[56:59], a[152:155]
    buffer_load_dwordx4 v5, s[16:19], s60 offen offset:3072 nt lds
    v_mfma_f32_16x16x32_bf16 a[152:155], a[116:119], v[60:63], a[152:155]
    ds_read_b128 a[40:43], v22 offset:18432
    v_mfma_f32_16x16x32_bf16 a[156:159], a[120:123], v[56:59], a[156:159]
    ds_read_b64_tr_b16 v[56:57], v17 offset:0
    ds_read_b64_tr_b16 v[58:59], v17 offset:1024
    v_mfma_f32_16x16x32_bf16 a[156:159], a[124:127], v[60:63], a[156:159]
    ds_read_b64_tr_b16 v[60:61], v17 offset:8192
    ds_read_b64_tr_b16 v[62:63], v17 offset:9216
    v_mfma_f32_16x16x32_bf16 a[160:163], a[64:67], v[40:43], a[160:163]
    v_mfma_f32_16x16x32_bf16 a[160:163], a[68:71], v[44:47], a[160:163]
    v_mfma_f32_16x16x32_bf16 a[164:167], a[72:75], v[40:43], a[164:167]
    ds_read_b128 a[44:47], v23 offset:18432
    v_mfma_f32_16x16x32_bf16 a[164:167], a[76:79], v[44:47], a[164:167]
    s_add_u32 m0, s69, 16384
    v_mfma_f32_16x16x32_bf16 a[168:171], a[80:83], v[40:43], a[168:171]
    s_xor_b32 s60, s60, 524288
    buffer_load_dwordx4 v10, s[20:23], s63 offen lds
    v_mfma_f32_16x16x32_bf16 a[168:171], a[84:87], v[44:47], a[168:171]
    v_mfma_f32_16x16x32_bf16 a[172:175], a[88:91], v[40:43], a[172:175]
    v_mfma_f32_16x16x32_bf16 a[172:175], a[92:95], v[44:47], a[172:175]
    v_mfma_f32_16x16x32_bf16 a[176:179], a[96:99], v[40:43], a[176:179]
    ds_read_b128 a[48:51], v22 offset:20480
    v_mfma_f32_16x16x32_bf16 a[176:179], a[100:103], v[44:47], a[176:179]
    v_mfma_f32_16x16x32_bf16 a[180:183], a[104:107], v[40:43], a[180:183]
    v_mfma_f32_16x16x32_bf16 a[180:183], a[108:111], v[44:47], a[180:183]
    buffer_load_dwordx4 v11, s[20:23], s63 offen offset:1024 lds
    v_mfma_f32_16x16x32_bf16 a[184:187], a[112:115], v[40:43], a[184:187]
    v_mfma_f32_16x16x32_bf16 a[184:187], a[116:119], v[44:47], a[184:187]
    ds_read_b128 a[52:55], v23 offset:20480
    v_mfma_f32_16x16x32_bf16 a[188:191], a[120:123], v[40:43], a[188:191]
    v_mfma_f32_16x16x32_bf16 a[188:191], a[124:127], v[44:47], a[188:191]
    s_waitcnt lgkmcnt(1)
    v_mfma_f32_16x16x32_bf16 a[192:195], a[64:67], v[48:51], a[192:195]
    v_mfma_f32_16x16x32_bf16 a[192:195], a[68:71], v[52:55], a[192:195]
    v_mfma_f32_16x16x32_bf16 a[196:199], a[72:75], v[48:51], a[196:199]
    v_mfma_f32_16x16x32_bf16 a[196:199], a[76:79], v[52:55], a[196:199]
    buffer_load_dwordx4 v12, s[20:23], s63 offen offset:2048 lds
    v_mfma_f32_16x16x32_bf16 a[200:203], a[80:83], v[48:51], a[200:203]
    ds_read_b128 a[56:59], v22 offset:22528
    v_mfma_f32_16x16x32_bf16 a[200:203], a[84:87], v[52:55], a[200:203]
    v_mfma_f32_16x16x32_bf16 a[204:207], a[88:91], v[48:51], a[204:207]
    v_mfma_f32_16x16x32_bf16 a[204:207], a[92:95], v[52:55], a[204:207]
    v_mfma_f32_16x16x32_bf16 a[208:211], a[96:99], v[48:51], a[208:211]
    ds_read_b128 a[60:63], v23 offset:22528
    v_mfma_f32_16x16x32_bf16 a[208:211], a[100:103], v[52:55], a[208:211]
    v_mfma_f32_16x16x32_bf16 a[212:215], a[104:107], v[48:51], a[212:215]
    buffer_load_dwordx4 v13, s[20:23], s63 offen offset:3072 lds
    v_mfma_f32_16x16x32_bf16 a[212:215], a[108:111], v[52:55], a[212:215]
    v_mfma_f32_16x16x32_bf16 a[216:219], a[112:115], v[48:51], a[216:219]
    v_mfma_f32_16x16x32_bf16 a[216:219], a[116:119], v[52:55], a[216:219]
    v_mfma_f32_16x16x32_bf16 a[220:223], a[120:123], v[48:51], a[220:223]
    v_mfma_f32_16x16x32_bf16 a[220:223], a[124:127], v[52:55], a[220:223]
    v_mfma_f32_16x16x32_bf16 a[224:227], a[64:67], v[56:59], a[224:227]
    v_mfma_f32_16x16x32_bf16 a[224:227], a[68:71], v[60:63], a[224:227]
    s_xor_b32 s63, s63, 128
    v_mfma_f32_16x16x32_bf16 a[228:231], a[72:75], v[56:59], a[228:231]
    v_mfma_f32_16x16x32_bf16 a[228:231], a[76:79], v[60:63], a[228:231]
    v_mfma_f32_16x16x32_bf16 a[232:235], a[80:83], v[56:59], a[232:235]
    v_mfma_f32_16x16x32_bf16 a[232:235], a[84:87], v[60:63], a[232:235]
    s_waitcnt vmcnt(9) lgkmcnt(0)
    s_barrier
    ds_read_b64_tr_b16 v[40:41], v14 offset:32768
    v_mfma_f32_16x16x32_bf16 a[236:239], a[88:91], v[56:59], a[236:239]
    s_add_u32 m0, s69, 32768
    ds_read_b64_tr_b16 v[42:43], v14 offset:33792
    ds_read_b64_tr_b16 v[44:45], v14 offset:40960
    v_mfma_f32_16x16x32_bf16 a[236:239], a[92:95], v[60:63], a[236:239]
    buffer_load_dwordx4 v2, s[16:19], s60 offen nt lds
    v_mfma_f32_16x16x32_bf16 a[240:243], a[96:99], v[56:59], a[240:243]
    ds_read_b64_tr_b16 v[46:47], v14 offset:41984
    ds_read_b64_tr_b16 v[48:49], v15 offset:32768
    v_mfma_f32_16x16x32_bf16 a[240:243], a[100:103], v[60:63], a[240:243]
    ds_read_b64_tr_b16 v[50:51], v15 offset:33792
    ds_read_b64_tr_b16 v[52:53], v15 offset:40960
    v_mfma_f32_16x16x32_bf16 a[244:247], a[104:107], v[56:59], a[244:247]
    ds_read_b64_tr_b16 v[54:55], v15 offset:41984
    v_add_u32 v14, 0x10000, v14
    v_mfma_f32_16x16x32_bf16 a[244:247], a[108:111], v[60:63], a[244:247]
    v_add_u32 v15, 0x10000, v15
    v_mfma_f32_16x16x32_bf16 a[248:251], a[112:115], v[56:59], a[248:251]
    v_mfma_f32_16x16x32_bf16 a[248:251], a[116:119], v[60:63], a[248:251]
    buffer_load_dwordx4 v3, s[16:19], s60 offen offset:1024 nt lds
    v_mfma_f32_16x16x32_bf16 a[252:255], a[120:123], v[56:59], a[252:255]
    ds_read_b64_tr_b16 v[56:57], v16 offset:32768
    ds_read_b64_tr_b16 v[58:59], v16 offset:33792
    v_mfma_f32_16x16x32_bf16 a[252:255], a[124:127], v[60:63], a[252:255]
    s_waitcnt lgkmcnt(2)
    ds_read_b64_tr_b16 v[60:61], v16 offset:40960
    ds_read_b64_tr_b16 v[62:63], v16 offset:41984
    v_mfma_f32_16x16x32_bf16 v[128:131], v[40:43], a[0:3], v[128:131]
    v_add_u32 v16, 0x10000, v16
    v_mfma_f32_16x16x32_bf16 v[128:131], v[44:47], a[4:7], v[128:131]
    ds_read_b128 a[64:67], v22 offset:49152
    v_mfma_f32_16x16x32_bf16 v[132:135], v[40:43], a[8:11], v[132:135]
    v_mfma_f32_16x16x32_bf16 v[132:135], v[44:47], a[12:15], v[132:135]
    v_mfma_f32_16x16x32_bf16 v[136:139], v[40:43], a[16:19], v[136:139]
    ds_read_b128 a[68:71], v23 offset:49152
    v_mfma_f32_16x16x32_bf16 v[136:139], v[44:47], a[20:23], v[136:139]
    buffer_load_dwordx4 v4, s[16:19], s60 offen offset:2048 nt lds
    v_mfma_f32_16x16x32_bf16 v[140:143], v[40:43], a[24:27], v[140:143]
    v_mfma_f32_16x16x32_bf16 v[140:143], v[44:47], a[28:31], v[140:143]
    ds_read_b128 a[72:75], v22 offset:51200
    v_mfma_f32_16x16x32_bf16 v[144:147], v[40:43], a[32:35], v[144:147]
    v_mfma_f32_16x16x32_bf16 v[144:147], v[44:47], a[36:39], v[144:147]
    v_mfma_f32_16x16x32_bf16 v[148:151], v[40:43], a[40:43], v[148:151]
    ds_read_b128 a[76:79], v23 offset:51200
    v_mfma_f32_16x16x32_bf16 v[148:151], v[44:47], a[44:47], v[148:151]
    v_mfma_f32_16x16x32_bf16 v[152:155], v[40:43], a[48:51], v[152:155]
    buffer_load_dwordx4 v5, s[16:19], s60 offen offset:3072 nt lds
    v_mfma_f32_16x16x32_bf16 v[152:155], v[44:47], a[52:55], v[152:155]
    v_mfma_f32_16x16x32_bf16 v[156:159], v[40:43], a[56:59], v[156:159]
    ds_read_b128 a[80:83], v22 offset:53248
    ds_read_b64_tr_b16 v[40:41], v17 offset:32768
    v_mfma_f32_16x16x32_bf16 v[156:159], v[44:47], a[60:63], v[156:159]
    ds_read_b64_tr_b16 v[42:43], v17 offset:33792
    ds_read_b64_tr_b16 v[44:45], v17 offset:40960
    v_mfma_f32_16x16x32_bf16 v[160:163], v[48:51], a[0:3], v[160:163]
    ds_read_b64_tr_b16 v[46:47], v17 offset:41984
    v_add_u32 v17, 0x10000, v17
    v_mfma_f32_16x16x32_bf16 v[160:163], v[52:55], a[4:7], v[160:163]
    ds_read_b128 a[84:87], v23 offset:53248
    v_mfma_f32_16x16x32_bf16 v[164:167], v[48:51], a[8:11], v[164:167]
    v_mfma_f32_16x16x32_bf16 v[164:167], v[52:55], a[12:15], v[164:167]
    s_add_u32 m0, s69, 49152
    buffer_load_dword v7, v9, s[44:47], s69 offen sc1
    v_mfma_f32_16x16x32_bf16 v[168:171], v[48:51], a[16:19], v[168:171]
    s_xor_b32 s60, s60, 3670016
    buffer_load_dwordx4 v10, s[20:23], s64 offen lds
    v_mfma_f32_16x16x32_bf16 v[168:171], v[52:55], a[20:23], v[168:171]
    ds_read_b128 a[88:91], v22 offset:55296
    v_mfma_f32_16x16x32_bf16 v[172:175], v[48:51], a[24:27], v[172:175]
    v_mfma_f32_16x16x32_bf16 v[172:175], v[52:55], a[28:31], v[172:175]
    s_waitcnt lgkmcnt(1)
    ds_read_b128 a[92:95], v23 offset:55296
    v_mfma_f32_16x16x32_bf16 v[176:179], v[48:51], a[32:35], v[176:179]
    v_mfma_f32_16x16x32_bf16 v[176:179], v[52:55], a[36:39], v[176:179]
    v_mfma_f32_16x16x32_bf16 v[180:183], v[48:51], a[40:43], v[180:183]
    v_mfma_f32_16x16x32_bf16 v[180:183], v[52:55], a[44:47], v[180:183]
    buffer_load_dwordx4 v11, s[20:23], s64 offen offset:1024 lds
    v_mfma_f32_16x16x32_bf16 v[184:187], v[48:51], a[48:51], v[184:187]
    v_add_u32 v22, 0x10000, v22
    ds_read_b128 a[96:99], v22 offset:16384
    v_mfma_f32_16x16x32_bf16 v[184:187], v[52:55], a[52:55], v[184:187]
    v_mfma_f32_16x16x32_bf16 v[188:191], v[48:51], a[56:59], v[188:191]
    v_add_u32 v23, 0x10000, v23
    ds_read_b64_tr_b16 v[48:49], v14 offset:0
    v_mfma_f32_16x16x32_bf16 v[188:191], v[52:55], a[60:63], v[188:191]
    ds_read_b128 a[100:103], v23 offset:16384
    ds_read_b64_tr_b16 v[50:51], v14 offset:1024
    v_mfma_f32_16x16x32_bf16 v[192:195], v[56:59], a[0:3], v[192:195]
    ds_read_b64_tr_b16 v[52:53], v14 offset:8192
    ds_read_b64_tr_b16 v[54:55], v14 offset:9216
    v_mfma_f32_16x16x32_bf16 v[192:195], v[60:63], a[4:7], v[192:195]
    v_add_u32 v14, 0xfffe0000, v14
    v_mfma_f32_16x16x32_bf16 v[196:199], v[56:59], a[8:11], v[196:199]
    ds_read_b128 a[104:107], v22 offset:18432
    v_mfma_f32_16x16x32_bf16 v[196:199], v[60:63], a[12:15], v[196:199]
    buffer_load_dwordx4 v12, s[20:23], s64 offen offset:2048 lds
    v_mfma_f32_16x16x32_bf16 v[200:203], v[56:59], a[16:19], v[200:203]
    v_mfma_f32_16x16x32_bf16 v[200:203], v[60:63], a[20:23], v[200:203]
    ds_read_b128 a[108:111], v23 offset:18432
    v_mfma_f32_16x16x32_bf16 v[204:207], v[56:59], a[24:27], v[204:207]
    v_mfma_f32_16x16x32_bf16 v[204:207], v[60:63], a[28:31], v[204:207]
    v_mfma_f32_16x16x32_bf16 v[208:211], v[56:59], a[32:35], v[208:211]
    v_mfma_f32_16x16x32_bf16 v[208:211], v[60:63], a[36:39], v[208:211]
    ds_read_b128 a[112:115], v22 offset:20480
    v_mfma_f32_16x16x32_bf16 v[212:215], v[56:59], a[40:43], v[212:215]
    buffer_load_dwordx4 v13, s[20:23], s64 offen offset:3072 lds
    v_mfma_f32_16x16x32_bf16 v[212:215], v[60:63], a[44:47], v[212:215]
    v_mfma_f32_16x16x32_bf16 v[216:219], v[56:59], a[48:51], v[216:219]
    ds_read_b128 a[116:119], v23 offset:20480
    v_mfma_f32_16x16x32_bf16 v[216:219], v[60:63], a[52:55], v[216:219]
    v_mfma_f32_16x16x32_bf16 v[220:223], v[56:59], a[56:59], v[220:223]
    ds_read_b64_tr_b16 v[56:57], v15 offset:0
    ds_read_b64_tr_b16 v[58:59], v15 offset:1024
    v_mfma_f32_16x16x32_bf16 v[220:223], v[60:63], a[60:63], v[220:223]
    s_waitcnt lgkmcnt(3)
    ds_read_b128 a[120:123], v22 offset:22528
    ds_read_b64_tr_b16 v[60:61], v15 offset:8192
    v_mfma_f32_16x16x32_bf16 v[224:227], v[40:43], a[0:3], v[224:227]
    ds_read_b64_tr_b16 v[62:63], v15 offset:9216
    v_add_u32 v15, 0xfffe0000, v15
    v_mfma_f32_16x16x32_bf16 v[224:227], v[44:47], a[4:7], v[224:227]
    s_xor_b32 s64, s64, 128
    v_mfma_f32_16x16x32_bf16 v[228:231], v[40:43], a[8:11], v[228:231]
    ds_read_b128 a[124:127], v23 offset:22528
    v_mfma_f32_16x16x32_bf16 v[228:231], v[44:47], a[12:15], v[228:231]
    v_mfma_f32_16x16x32_bf16 v[232:235], v[40:43], a[16:19], v[232:235]
    v_mfma_f32_16x16x32_bf16 v[232:235], v[44:47], a[20:23], v[232:235]
    s_add_u32 m0, s69, 65536
    v_mfma_f32_16x16x32_bf16 v[236:239], v[40:43], a[24:27], v[236:239]
    buffer_load_dwordx4 v2, s[24:27], s60 offen lds
    v_mfma_f32_16x16x32_bf16 v[236:239], v[44:47], a[28:31], v[236:239]
    v_mfma_f32_16x16x32_bf16 v[240:243], v[40:43], a[32:35], v[240:243]
    v_mfma_f32_16x16x32_bf16 v[240:243], v[44:47], a[36:39], v[240:243]
    v_mfma_f32_16x16x32_bf16 v[244:247], v[40:43], a[40:43], v[244:247]
    v_mfma_f32_16x16x32_bf16 v[244:247], v[44:47], a[44:47], v[244:247]
    v_mfma_f32_16x16x32_bf16 v[248:251], v[40:43], a[48:51], v[248:251]
    v_mfma_f32_16x16x32_bf16 v[248:251], v[44:47], a[52:55], v[248:251]
    buffer_load_dwordx4 v3, s[24:27], s60 offen offset:1024 lds
    v_mfma_f32_16x16x32_bf16 v[252:255], v[40:43], a[56:59], v[252:255]
    ds_read_b64_tr_b16 v[40:41], v16 offset:0
    ds_read_b64_tr_b16 v[42:43], v16 offset:1024
    v_mfma_f32_16x16x32_bf16 v[252:255], v[44:47], a[60:63], v[252:255]
    ds_read_b64_tr_b16 v[44:45], v16 offset:8192
    ds_read_b64_tr_b16 v[46:47], v16 offset:9216
    v_mfma_f32_16x16x32_bf16 v[128:131], v[48:51], a[64:67], v[128:131]
    v_add_u32 v16, 0xfffe0000, v16
    v_mfma_f32_16x16x32_bf16 v[128:131], v[52:55], a[68:71], v[128:131]
    v_mfma_f32_16x16x32_bf16 v[132:135], v[48:51], a[72:75], v[132:135]
    v_mfma_f32_16x16x32_bf16 v[132:135], v[52:55], a[76:79], v[132:135]
    v_mfma_f32_16x16x32_bf16 v[136:139], v[48:51], a[80:83], v[136:139]
    v_mfma_f32_16x16x32_bf16 v[136:139], v[52:55], a[84:87], v[136:139]
    buffer_load_dwordx4 v4, s[24:27], s60 offen offset:2048 lds
    v_mfma_f32_16x16x32_bf16 v[140:143], v[48:51], a[88:91], v[140:143]
    v_mfma_f32_16x16x32_bf16 v[140:143], v[52:55], a[92:95], v[140:143]
    v_mfma_f32_16x16x32_bf16 v[144:147], v[48:51], a[96:99], v[144:147]
    v_mul_f32 v128, s74, v128
    v_mul_f32 v129, s74, v129
    v_mfma_f32_16x16x32_bf16 v[144:147], v[52:55], a[100:103], v[144:147]
    v_mul_f32 v130, s74, v130
    v_mul_f32 v131, s74, v131
    v_mfma_f32_16x16x32_bf16 v[148:151], v[48:51], a[104:107], v[148:151]
    v_cvt_pk_bf16_f32 v128, v128, v129
    v_cvt_pk_bf16_f32 v129, v130, v131
    v_mfma_f32_16x16x32_bf16 v[148:151], v[52:55], a[108:111], v[148:151]
    v_mul_f32 v132, s74, v132
    v_mul_f32 v133, s74, v133
    v_mfma_f32_16x16x32_bf16 v[152:155], v[48:51], a[112:115], v[152:155]
    s_waitcnt lgkmcnt(0)
    buffer_load_dwordx4 v5, s[24:27], s60 offen offset:3072 lds
    v_mfma_f32_16x16x32_bf16 v[152:155], v[52:55], a[116:119], v[152:155]
    v_mul_f32 v134, s74, v134
    v_mul_f32 v135, s74, v135
    v_mfma_f32_16x16x32_bf16 v[156:159], v[48:51], a[120:123], v[156:159]
    ds_read_b64_tr_b16 v[48:49], v17 offset:0
    ds_read_b64_tr_b16 v[50:51], v17 offset:1024
    v_mfma_f32_16x16x32_bf16 v[156:159], v[52:55], a[124:127], v[156:159]
    ds_read_b64_tr_b16 v[52:53], v17 offset:8192
    ds_read_b64_tr_b16 v[54:55], v17 offset:9216
    v_mfma_f32_16x16x32_bf16 v[160:163], v[56:59], a[64:67], v[160:163]
    v_add_u32 v17, 0xfffe0000, v17
    v_cvt_pk_bf16_f32 v132, v132, v133
    v_mfma_f32_16x16x32_bf16 v[160:163], v[60:63], a[68:71], v[160:163]
    v_cvt_pk_bf16_f32 v133, v134, v135
    v_mul_f32 v136, s74, v136
    v_mfma_f32_16x16x32_bf16 v[164:167], v[56:59], a[72:75], v[164:167]
    v_mul_f32 v137, s74, v137
    v_mul_f32 v138, s74, v138
    v_mfma_f32_16x16x32_bf16 v[164:167], v[60:63], a[76:79], v[164:167]
    s_add_u32 m0, s69, 81920
    v_mul_f32 v139, s74, v139
    v_mul_f32 v160, s74, v160
    v_mfma_f32_16x16x32_bf16 v[168:171], v[56:59], a[80:83], v[168:171]
    s_xor_b32 s60, s60, 524288
    buffer_load_dwordx4 v10, s[20:23], s63 offen lds
    v_mfma_f32_16x16x32_bf16 v[168:171], v[60:63], a[84:87], v[168:171]
    v_mul_f32 v161, s74, v161
    v_mul_f32 v162, s74, v162
    v_mfma_f32_16x16x32_bf16 v[172:175], v[56:59], a[88:91], v[172:175]
    v_mul_f32 v163, s74, v163
    v_cvt_pk_bf16_f32 v130, v160, v161
    v_mfma_f32_16x16x32_bf16 v[172:175], v[60:63], a[92:95], v[172:175]
    v_cvt_pk_bf16_f32 v131, v162, v163
    v_mul_f32 v164, s74, v164
    v_mfma_f32_16x16x32_bf16 v[176:179], v[56:59], a[96:99], v[176:179]
    v_mul_f32 v165, s74, v165
    v_mul_f32 v166, s74, v166
    v_mfma_f32_16x16x32_bf16 v[176:179], v[60:63], a[100:103], v[176:179]
    v_mul_f32 v167, s74, v167
    v_cvt_pk_bf16_f32 v134, v164, v165
    v_mfma_f32_16x16x32_bf16 v[180:183], v[56:59], a[104:107], v[180:183]
    v_cvt_pk_bf16_f32 v135, v166, v167
    v_mul_f32 v168, s74, v168
    v_mfma_f32_16x16x32_bf16 v[180:183], v[60:63], a[108:111], v[180:183]
    buffer_load_dwordx4 v11, s[20:23], s63 offen offset:1024 lds
    v_mfma_f32_16x16x32_bf16 v[184:187], v[56:59], a[112:115], v[184:187]
    v_mul_f32 v169, s74, v169
    v_mul_f32 v170, s74, v170
    v_mfma_f32_16x16x32_bf16 v[184:187], v[60:63], a[116:119], v[184:187]
    v_mul_f32 v171, s74, v171
    v_cvt_pk_bf16_f32 v136, v136, v137
    v_mfma_f32_16x16x32_bf16 v[188:191], v[56:59], a[120:123], v[188:191]
    v_cvt_pk_bf16_f32 v137, v138, v139
    v_cvt_pk_bf16_f32 v138, v168, v169
    v_mfma_f32_16x16x32_bf16 v[188:191], v[60:63], a[124:127], v[188:191]
    v_cvt_pk_bf16_f32 v139, v170, v171
    v_mul_f32 v140, s74, v140
    v_mfma_f32_16x16x32_bf16 v[192:195], v[40:43], a[64:67], v[192:195]
    v_mul_f32 v141, s74, v141
    v_mul_f32 v142, s74, v142
    v_mfma_f32_16x16x32_bf16 v[192:195], v[44:47], a[68:71], v[192:195]
    v_mul_f32 v143, s74, v143
    v_mul_f32 v172, s74, v172
    v_mfma_f32_16x16x32_bf16 v[196:199], v[40:43], a[72:75], v[196:199]
    v_mul_f32 v173, s74, v173
    v_mul_f32 v174, s74, v174
    v_mfma_f32_16x16x32_bf16 v[196:199], v[44:47], a[76:79], v[196:199]
    buffer_load_dwordx4 v12, s[20:23], s63 offen offset:2048 lds
    v_mfma_f32_16x16x32_bf16 v[200:203], v[40:43], a[80:83], v[200:203]
    v_mul_f32 v175, s74, v175
    v_cvt_pk_bf16_f32 v140, v140, v141
    v_mfma_f32_16x16x32_bf16 v[200:203], v[44:47], a[84:87], v[200:203]
    v_cvt_pk_bf16_f32 v141, v142, v143
    v_cvt_pk_bf16_f32 v142, v172, v173
    v_mfma_f32_16x16x32_bf16 v[204:207], v[40:43], a[88:91], v[204:207]
    v_cvt_pk_bf16_f32 v143, v174, v175
    v_mul_f32 v144, s74, v144
    v_mfma_f32_16x16x32_bf16 v[204:207], v[44:47], a[92:95], v[204:207]
    v_mul_f32 v145, s74, v145
    v_mul_f32 v146, s74, v146
    v_mfma_f32_16x16x32_bf16 v[208:211], v[40:43], a[96:99], v[208:211]
    v_mul_f32 v147, s74, v147
    v_mul_f32 v176, s74, v176
    v_mfma_f32_16x16x32_bf16 v[208:211], v[44:47], a[100:103], v[208:211]
    v_mul_f32 v177, s74, v177
    v_mul_f32 v178, s74, v178
    v_mfma_f32_16x16x32_bf16 v[212:215], v[40:43], a[104:107], v[212:215]
    buffer_load_dwordx4 v13, s[20:23], s63 offen offset:3072 lds
    v_mfma_f32_16x16x32_bf16 v[212:215], v[44:47], a[108:111], v[212:215]
    v_mul_f32 v179, s74, v179
    v_cvt_pk_bf16_f32 v144, v144, v145
    v_mfma_f32_16x16x32_bf16 v[216:219], v[40:43], a[112:115], v[216:219]
    v_cvt_pk_bf16_f32 v145, v146, v147
    v_cvt_pk_bf16_f32 v146, v176, v177
    v_mfma_f32_16x16x32_bf16 v[216:219], v[44:47], a[116:119], v[216:219]
    v_cvt_pk_bf16_f32 v147, v178, v179
    v_mul_f32 v148, s74, v148
    v_mfma_f32_16x16x32_bf16 v[220:223], v[40:43], a[120:123], v[220:223]
    v_mul_f32 v149, s74, v149
    v_mul_f32 v150, s74, v150
    v_mfma_f32_16x16x32_bf16 v[220:223], v[44:47], a[124:127], v[220:223]
    s_add_u32 s72, s70, 0
    v_mul_f32 v151, s74, v151
    v_mul_f32 v180, s74, v180
    s_waitcnt lgkmcnt(0)
    v_mfma_f32_16x16x32_bf16 v[224:227], v[48:51], a[64:67], v[224:227]
    buffer_store_dwordx4 v[128:131], v1, s[36:39], s72 offen sc1
    v_mfma_f32_16x16x32_bf16 v[224:227], v[52:55], a[68:71], v[224:227]
    s_xor_b32 s63, s63, 384
    v_mul_f32 v181, s74, v181
    v_mul_f32 v182, s74, v182
    v_mfma_f32_16x16x32_bf16 v[228:231], v[48:51], a[72:75], v[228:231]
    v_mul_f32 v183, s74, v183
    v_cvt_pk_bf16_f32 v148, v148, v149
    v_mfma_f32_16x16x32_bf16 v[228:231], v[52:55], a[76:79], v[228:231]
    v_cvt_pk_bf16_f32 v149, v150, v151
    v_cvt_pk_bf16_f32 v150, v180, v181
    v_mfma_f32_16x16x32_bf16 v[232:235], v[48:51], a[80:83], v[232:235]
    v_cvt_pk_bf16_f32 v151, v182, v183
    v_mul_f32 v152, s74, v152
    v_mfma_f32_16x16x32_bf16 v[232:235], v[52:55], a[84:87], v[232:235]
    s_add_u32 m0, s67, 98304
    v_mul_f32 v153, s74, v153
    v_mul_f32 v154, s74, v154
    s_waitcnt vmcnt(9) lgkmcnt(0)
    v_cmp_gt_u32 vcc, 8, v7
    s_nop 1
    s_and_b64 vcc, vcc, s[86:87]
    s_cbranch_scc1 SPIN_WA
BACK_WA:
    s_barrier
    v_mfma_f32_16x16x32_bf16 v[236:239], v[48:51], a[88:91], v[236:239]
    buffer_load_dwordx4 v1, s[28:31], s65 offen sc1 lds
    v_mfma_f32_16x16x32_bf16 v[236:239], v[52:55], a[92:95], v[236:239]
    ds_read_b64_tr_b16 v[56:57], v14 offset:0
    ds_read_b64_tr_b16 v[58:59], v14 offset:1024
    v_mfma_f32_16x16x32_bf16 v[240:243], v[48:51], a[96:99], v[240:243]
    ds_read_b64_tr_b16 v[60:61], v14 offset:8192
    ds_read_b64_tr_b16 v[62:63], v14 offset:9216
    v_mfma_f32_16x16x32_bf16 v[240:243], v[52:55], a[100:103], v[240:243]
    ds_read_b64_tr_b16 v[40:41], v15 offset:0
    ds_read_b64_tr_b16 v[42:43], v15 offset:1024
    v_mfma_f32_16x16x32_bf16 v[244:247], v[48:51], a[104:107], v[244:247]
    ds_read_b64_tr_b16 v[44:45], v15 offset:8192
    ds_read_b64_tr_b16 v[46:47], v15 offset:9216
    v_mfma_f32_16x16x32_bf16 v[244:247], v[52:55], a[108:111], v[244:247]
    v_mul_f32 v155, s74, v155
    v_mul_f32 v184, s74, v184
    v_mfma_f32_16x16x32_bf16 v[248:251], v[48:51], a[112:115], v[248:251]
    v_mul_f32 v185, s74, v185
    v_mul_f32 v186, s74, v186
    v_mfma_f32_16x16x32_bf16 v[248:251], v[52:55], a[116:119], v[248:251]
    v_mul_f32 v187, s74, v187
    v_cvt_pk_bf16_f32 v152, v152, v153
    v_mfma_f32_16x16x32_bf16 v[252:255], v[48:51], a[120:123], v[252:255]
    s_lshr_b32 s92, s2, 3
    v_lshrrev_b32 v9, 4, v1
    v_min_u32 v9, 0, v9
    v_mfma_f32_16x16x32_bf16 v[252:255], v[52:55], a[124:127], v[252:255]
    s_lshl2_add_u32 s92, s92, s4
    ds_read_b64_tr_b16 v[48:49], v16 offset:0
    ds_read_b64_tr_b16 v[50:51], v16 offset:1024
    s_waitcnt lgkmcnt(2)
    v_mfma_f32_16x16x32_bf16 a[128:131], a[0:3], v[56:59], a[128:131]
    s_mul_i32 s92, s92, 1
    buffer_load_dwordx4 v1, s[28:31], s65 offen offset:1024 sc1 lds
    v_mfma_f32_16x16x32_bf16 a[128:131], a[4:7], v[60:63], a[128:131]
    s_add_u32 s92, s92, 32
    v_add_lshl_u32 v9, v9, s92, 7
    ds_read_b64_tr_b16 v[52:53], v16 offset:8192
    v_mfma_f32_16x16x32_bf16 a[132:135], a[8:11], v[56:59], a[132:135]
    s_getpc_b64 s[92:93]
    global_load_dword v9, v9, s[92:93]
    v_mfma_f32_16x16x32_bf16 a[132:135], a[12:15], v[60:63], a[132:135]
    ds_read_b128 v[64:67], v24 offset:16384
    ds_read_b64_tr_b16 v[54:55], v16 offset:9216
    v_mfma_f32_16x16x32_bf16 a[136:139], a[16:19], v[56:59], a[136:139]
    v_cvt_pk_bf16_f32 v153, v154, v155
    v_cvt_pk_bf16_f32 v154, v184, v185
    v_mfma_f32_16x16x32_bf16 a[136:139], a[20:23], v[60:63], a[136:139]
    v_cvt_pk_bf16_f32 v155, v186, v187
    v_mul_f32 v156, s74, v156
    v_mfma_f32_16x16x32_bf16 a[140:143], a[24:27], v[56:59], a[140:143]
    v_mul_f32 v157, s74, v157
    v_mul_f32 v158, s74, v158
    v_mfma_f32_16x16x32_bf16 a[140:143], a[28:31], v[60:63], a[140:143]
    s_add_u32 s72, s70, 4096
    v_mul_f32 v159, s74, v159
    v_mul_f32 v188, s74, v188
    v_mfma_f32_16x16x32_bf16 a[144:147], a[32:35], v[56:59], a[144:147]
    buffer_store_dwordx4 v[132:135], v1, s[36:39], s72 offen sc1
    v_mfma_f32_16x16x32_bf16 a[144:147], a[36:39], v[60:63], a[144:147]
    s_add_u32 m0, s69, 114688
    v_mul_f32 v189, s74, v189
    v_mul_f32 v190, s74, v190
    v_mfma_f32_16x16x32_bf16 a[148:151], a[40:43], v[56:59], a[148:151]
    s_xor_b32 s65, s65, 8192
    buffer_load_dwordx4 v10, s[20:23], s64 offen lds
    v_mfma_f32_16x16x32_bf16 a[148:151], a[44:47], v[60:63], a[148:151]
    v_mul_f32 v191, s74, v191
    v_cvt_pk_bf16_f32 v156, v156, v157
    v_mfma_f32_16x16x32_bf16 a[152:155], a[48:51], v[56:59], a[152:155]
    v_cvt_pk_bf16_f32 v157, v158, v159
    v_cvt_pk_bf16_f32 v158, v188, v189
    v_mfma_f32_16x16x32_bf16 a[152:155], a[52:55], v[60:63], a[152:155]
    ds_read_b128 v[68:71], v25 offset:16384
    v_cvt_pk_bf16_f32 v159, v190, v191
    v_mfma_f32_16x16x32_bf16 a[156:159], a[56:59], v[56:59], a[156:159]
    ds_read_b64_tr_b16 v[56:57], v17 offset:0
    ds_read_b64_tr_b16 v[58:59], v17 offset:1024
    v_mfma_f32_16x16x32_bf16 a[156:159], a[60:63], v[60:63], a[156:159]
    ds_read_b64_tr_b16 v[60:61], v17 offset:8192
    ds_read_b64_tr_b16 v[62:63], v17 offset:9216
    v_mfma_f32_16x16x32_bf16 a[160:163], a[0:3], v[40:43], a[160:163]
    v_mul_f32 v192, s74, v192
    v_mul_f32 v193, s74, v193
    v_mfma_f32_16x16x32_bf16 a[160:163], a[4:7], v[44:47], a[160:163]
    v_mul_f32 v194, s74, v194
    v_mul_f32 v195, s74, v195
    v_mfma_f32_16x16x32_bf16 a[164:167], a[8:11], v[40:43], a[164:167]
    v_mul_f32 v224, s74, v224
    v_mul_f32 v225, s74, v225
    v_mfma_f32_16x16x32_bf16 a[164:167], a[12:15], v[44:47], a[164:167]
    v_mul_f32 v226, s74, v226
    v_mul_f32 v227, s74, v227
    v_mfma_f32_16x16x32_bf16 a[168:171], a[16:19], v[40:43], a[168:171]
    buffer_load_dwordx4 v11, s[20:23], s64 offen offset:1024 lds
    v_mfma_f32_16x16x32_bf16 a[168:171], a[20:23], v[44:47], a[168:171]
    v_cvt_pk_bf16_f32 v192, v192, v193
    v_cvt_pk_bf16_f32 v193, v194, v195
    v_mfma_f32_16x16x32_bf16 a[172:175], a[24:27], v[40:43], a[172:175]
    v_cvt_pk_bf16_f32 v194, v224, v225
    v_cvt_pk_bf16_f32 v195, v226, v227
    v_mfma_f32_16x16x32_bf16 a[172:175], a[28:31], v[44:47], a[172:175]
    v_mul_f32 v196, s74, v196
    v_mul_f32 v197, s74, v197
    v_mfma_f32_16x16x32_bf16 a[176:179], a[32:35], v[40:43], a[176:179]
    ds_read_b128 v[72:75], v24 offset:24576
    v_mul_f32 v198, s74, v198
    v_mfma_f32_16x16x32_bf16 a[176:179], a[36:39], v[44:47], a[176:179]
    v_mul_f32 v199, s74, v199
    v_mul_f32 v228, s74, v228
    v_mfma_f32_16x16x32_bf16 a[180:183], a[40:43], v[40:43], a[180:183]
    v_mul_f32 v229, s74, v229
    v_mul_f32 v230, s74, v230
    v_mfma_f32_16x16x32_bf16 a[180:183], a[44:47], v[44:47], a[180:183]
    v_mul_f32 v231, s74, v231
    v_cvt_pk_bf16_f32 v196, v196, v197
    v_mfma_f32_16x16x32_bf16 a[184:187], a[48:51], v[40:43], a[184:187]
    v_cvt_pk_bf16_f32 v197, v198, v199
    v_cvt_pk_bf16_f32 v198, v228, v229
    v_mfma_f32_16x16x32_bf16 a[184:187], a[52:55], v[44:47], a[184:187]
    v_cvt_pk_bf16_f32 v199, v230, v231
    v_mul_f32 v200, s74, v200
    v_mfma_f32_16x16x32_bf16 a[188:191], a[56:59], v[40:43], a[188:191]
    buffer_load_dwordx4 v12, s[20:23], s64 offen offset:2048 lds
    v_mfma_f32_16x16x32_bf16 a[188:191], a[60:63], v[44:47], a[188:191]
    s_add_u32 s72, s70, 8192
    ds_read_b64_tr_b16 v[40:41], v14 offset:32768
    ds_read_b64_tr_b16 v[42:43], v14 offset:33792
    s_waitcnt lgkmcnt(2)
    v_mfma_f32_16x16x32_bf16 a[192:195], a[0:3], v[48:51], a[192:195]
    ds_read_b64_tr_b16 v[44:45], v14 offset:40960
    ds_read_b64_tr_b16 v[46:47], v14 offset:41984
    v_mfma_f32_16x16x32_bf16 a[192:195], a[4:7], v[52:55], a[192:195]
    v_xor_b32 v14, s73, v14
    v_add_u32 v14, 0x10000, v14
    v_mfma_f32_16x16x32_bf16 a[196:199], a[8:11], v[48:51], a[196:199]
    buffer_store_dwordx4 v[136:139], v1, s[36:39], s72 offen sc1
    v_mfma_f32_16x16x32_bf16 a[196:199], a[12:15], v[52:55], a[196:199]
    ds_read_b128 v[76:79], v25 offset:24576
    v_mul_f32 v201, s74, v201
    v_mfma_f32_16x16x32_bf16 a[200:203], a[16:19], v[48:51], a[200:203]
    v_mul_f32 v202, s74, v202
    v_mul_f32 v203, s74, v203
    v_mfma_f32_16x16x32_bf16 a[200:203], a[20:23], v[52:55], a[200:203]
    v_mul_f32 v232, s74, v232
    v_mul_f32 v233, s74, v233
    v_mfma_f32_16x16x32_bf16 a[204:207], a[24:27], v[48:51], a[204:207]
    v_mul_f32 v234, s74, v234
    v_mul_f32 v235, s74, v235
    v_mfma_f32_16x16x32_bf16 a[204:207], a[28:31], v[52:55], a[204:207]
    v_cvt_pk_bf16_f32 v200, v200, v201
    v_cvt_pk_bf16_f32 v201, v202, v203
    v_mfma_f32_16x16x32_bf16 a[208:211], a[32:35], v[48:51], a[208:211]
    buffer_load_dwordx4 v13, s[20:23], s64 offen offset:3072 lds
    v_mfma_f32_16x16x32_bf16 a[208:211], a[36:39], v[52:55], a[208:211]
    v_cvt_pk_bf16_f32 v202, v232, v233
    v_cvt_pk_bf16_f32 v203, v234, v235
    v_mfma_f32_16x16x32_bf16 a[212:215], a[40:43], v[48:51], a[212:215]
    v_mul_f32 v204, s74, v204
    v_mul_f32 v205, s74, v205
    v_mfma_f32_16x16x32_bf16 a[212:215], a[44:47], v[52:55], a[212:215]
    v_mul_f32 v206, s74, v206
    v_mul_f32 v207, s74, v207
    v_mfma_f32_16x16x32_bf16 a[216:219], a[48:51], v[48:51], a[216:219]
    v_mul_f32 v236, s74, v236
    v_mul_f32 v237, s74, v237
    v_mfma_f32_16x16x32_bf16 a[216:219], a[52:55], v[52:55], a[216:219]
    v_mul_f32 v238, s74, v238
    v_mul_f32 v239, s74, v239
    v_mfma_f32_16x16x32_bf16 a[220:223], a[56:59], v[48:51], a[220:223]
    ds_read_b64_tr_b16 v[48:49], v15 offset:32768
    ds_read_b64_tr_b16 v[50:51], v15 offset:33792
    v_mfma_f32_16x16x32_bf16 a[220:223], a[60:63], v[52:55], a[220:223]
    ds_read_b64_tr_b16 v[52:53], v15 offset:40960
    ds_read_b64_tr_b16 v[54:55], v15 offset:41984
    v_mfma_f32_16x16x32_bf16 a[224:227], a[0:3], v[56:59], a[224:227]
    v_xor_b32 v15, s73, v15
    v_add_u32 v15, 0x10000, v15
    v_mfma_f32_16x16x32_bf16 a[224:227], a[4:7], v[60:63], a[224:227]
    s_xor_b32 s64, s64, 384
    v_accvgpr_write_b32 a4, v192
    v_accvgpr_write_b32 a5, v193
    v_mfma_f32_16x16x32_bf16 a[228:231], a[8:11], v[56:59], a[228:231]
    v_accvgpr_write_b32 a6, v194
    v_accvgpr_write_b32 a7, v195
    v_mfma_f32_16x16x32_bf16 a[228:231], a[12:15], v[60:63], a[228:231]
    v_accvgpr_write_b32 a12, v196
    v_accvgpr_write_b32 a13, v197
    v_mfma_f32_16x16x32_bf16 a[232:235], a[16:19], v[56:59], a[232:235]
    v_accvgpr_write_b32 a14, v198
    v_accvgpr_write_b32 a15, v199
    v_mfma_f32_16x16x32_bf16 a[232:235], a[20:23], v[60:63], a[232:235]
    s_add_u32 m0, s69, 131072
    v_accvgpr_write_b32 a20, v200
    v_accvgpr_write_b32 a21, v201
    v_mfma_f32_16x16x32_bf16 a[236:239], a[24:27], v[56:59], a[236:239]
    buffer_load_dwordx4 v2, s[24:27], s60 offen lds
    v_mfma_f32_16x16x32_bf16 a[236:239], a[28:31], v[60:63], a[236:239]
    s_add_u32 s72, s70, 12288
    v_accvgpr_write_b32 a22, v202
    v_accvgpr_write_b32 a23, v203
    v_mfma_f32_16x16x32_bf16 a[240:243], a[32:35], v[56:59], a[240:243]
    buffer_store_dwordx4 v[140:143], v1, s[36:39], s72 offen sc1
    v_mfma_f32_16x16x32_bf16 a[240:243], a[36:39], v[60:63], a[240:243]
    v_cvt_pk_bf16_f32 v204, v204, v205
    v_cvt_pk_bf16_f32 v205, v206, v207
    v_mfma_f32_16x16x32_bf16 a[244:247], a[40:43], v[56:59], a[244:247]
    v_accvgpr_write_b32 a40, v148
    v_accvgpr_write_b32 a41, v149
    v_mfma_f32_16x16x32_bf16 a[244:247], a[44:47], v[60:63], a[244:247]
    v_accvgpr_write_b32 a42, v150
    v_accvgpr_write_b32 a43, v151
    v_mfma_f32_16x16x32_bf16 a[248:251], a[48:51], v[56:59], a[248:251]
    v_accvgpr_write_b32 a48, v152
    v_accvgpr_write_b32 a49, v153
    v_mfma_f32_16x16x32_bf16 a[248:251], a[52:55], v[60:63], a[248:251]
    buffer_load_dwordx4 v3, s[24:27], s60 offen offset:1024 lds
    v_mfma_f32_16x16x32_bf16 a[252:255], a[56:59], v[56:59], a[252:255]
    ds_read_b64_tr_b16 v[56:57], v16 offset:32768
    ds_read_b64_tr_b16 v[58:59], v16 offset:33792
    v_mfma_f32_16x16x32_bf16 a[252:255], a[60:63], v[60:63], a[252:255]
    s_waitcnt lgkmcnt(2)
    ds_read_b64_tr_b16 v[60:61], v16 offset:40960
    ds_read_b64_tr_b16 v[62:63], v16 offset:41984
    v_mfma_f32_16x16x32_bf16 a[128:131], a[64:67], v[40:43], a[128:131]
    v_xor_b32 v16, s73, v16
    v_add_u32 v16, 0x10000, v16
    v_mfma_f32_16x16x32_bf16 a[128:131], a[68:71], v[44:47], a[128:131]
    v_accvgpr_write_b32 a50, v154
    v_accvgpr_write_b32 a51, v155
    v_mfma_f32_16x16x32_bf16 a[132:135], a[72:75], v[40:43], a[132:135]
    ds_read_b128 v[80:83], v24 offset:49152
    v_accvgpr_write_b32 a56, v156
    v_mfma_f32_16x16x32_bf16 a[132:135], a[76:79], v[44:47], a[132:135]
    v_accvgpr_write_b32 a57, v157
    v_accvgpr_write_b32 a58, v158
    v_mfma_f32_16x16x32_bf16 a[136:139], a[80:83], v[40:43], a[136:139]
    v_accvgpr_write_b32 a59, v159
    v_cvt_pk_bf16_f32 v206, v236, v237
    v_mfma_f32_16x16x32_bf16 a[136:139], a[84:87], v[44:47], a[136:139]
    buffer_load_dwordx4 v4, s[24:27], s60 offen offset:2048 lds
    v_mfma_f32_16x16x32_bf16 a[140:143], a[88:91], v[40:43], a[140:143]
    v_cvt_pk_bf16_f32 v207, v238, v239
    v_mul_f32 v208, s74, v208
    v_mfma_f32_16x16x32_bf16 a[140:143], a[92:95], v[44:47], a[140:143]
    v_mul_f32 v209, s74, v209
    v_mul_f32 v210, s74, v210
    v_mfma_f32_16x16x32_bf16 a[144:147], a[96:99], v[40:43], a[144:147]
    v_mul_f32 v211, s74, v211
    v_mul_f32 v240, s74, v240
    v_mfma_f32_16x16x32_bf16 a[144:147], a[100:103], v[44:47], a[144:147]
    v_mul_f32 v241, s74, v241
    v_mul_f32 v242, s74, v242
    v_mfma_f32_16x16x32_bf16 a[148:151], a[104:107], v[40:43], a[148:151]
    v_mul_f32 v243, s74, v243
    v_accvgpr_write_b32 a28, v204
    v_mfma_f32_16x16x32_bf16 a[148:151], a[108:111], v[44:47], a[148:151]
    v_accvgpr_write_b32 a29, v205
    v_accvgpr_write_b32 a30, v206
    v_mfma_f32_16x16x32_bf16 a[152:155], a[112:115], v[40:43], a[152:155]
    buffer_load_dwordx4 v5, s[24:27], s60 offen offset:3072 lds
    v_mfma_f32_16x16x32_bf16 a[152:155], a[116:119], v[44:47], a[152:155]
    ds_read_b128 v[84:87], v25 offset:49152
    v_accvgpr_write_b32 a31, v207
    v_mfma_f32_16x16x32_bf16 a[156:159], a[120:123], v[40:43], a[156:159]
    ds_read_b64_tr_b16 v[40:41], v17 offset:32768
    ds_read_b64_tr_b16 v[42:43], v17 offset:33792
    v_mfma_f32_16x16x32_bf16 a[156:159], a[124:127], v[44:47], a[156:159]
    s_add_u32 s72, s70, 32768
    ds_read_b64_tr_b16 v[44:45], v17 offset:40960
    ds_read_b64_tr_b16 v[46:47], v17 offset:41984
    v_mfma_f32_16x16x32_bf16 a[160:163], a[64:67], v[48:51], a[160:163]
    v_xor_b32 v17, s73, v17
    v_add_u32 v17, 0x10000, v17
    v_mfma_f32_16x16x32_bf16 a[160:163], a[68:71], v[52:55], a[160:163]
    buffer_store_dwordx4 v[144:147], v1, s[36:39], s72 offen sc1
    v_mfma_f32_16x16x32_bf16 a[164:167], a[72:75], v[48:51], a[164:167]
    v_cvt_pk_bf16_f32 v208, v208, v209
    v_cvt_pk_bf16_f32 v209, v210, v211
    v_mfma_f32_16x16x32_bf16 a[164:167], a[76:79], v[52:55], a[164:167]
    s_add_u32 m0, s69, 147456
    v_cvt_pk_bf16_f32 v210, v240, v241
    v_cvt_pk_bf16_f32 v211, v242, v243
    v_mfma_f32_16x16x32_bf16 a[168:171], a[80:83], v[48:51], a[168:171]
    s_xor_b32 s60, s60, 1572864
    buffer_load_dwordx4 v10, s[20:23], s63 offen lds
    v_mfma_f32_16x16x32_bf16 a[168:171], a[84:87], v[52:55], a[168:171]
    v_mul_f32 v212, s74, v212
    v_mul_f32 v213, s74, v213
    v_mfma_f32_16x16x32_bf16 a[172:175], a[88:91], v[48:51], a[172:175]
    v_mul_f32 v214, s74, v214
    v_mul_f32 v215, s74, v215
    v_mfma_f32_16x16x32_bf16 a[172:175], a[92:95], v[52:55], a[172:175]
    v_mul_f32 v244, s74, v244
    v_mul_f32 v245, s74, v245
    v_mfma_f32_16x16x32_bf16 a[176:179], a[96:99], v[48:51], a[176:179]
    ds_read_b128 v[88:91], v24 offset:57344
    v_mul_f32 v246, s74, v246
    v_mfma_f32_16x16x32_bf16 a[176:179], a[100:103], v[52:55], a[176:179]
    v_mul_f32 v247, s74, v247
    v_accvgpr_write_b32 a36, v208
    v_mfma_f32_16x16x32_bf16 a[180:183], a[104:107], v[48:51], a[180:183]
    v_accvgpr_write_b32 a37, v209
    v_accvgpr_write_b32 a38, v210
    v_mfma_f32_16x16x32_bf16 a[180:183], a[108:111], v[52:55], a[180:183]
    buffer_load_dwordx4 v11, s[20:23], s63 offen offset:1024 lds
    v_mfma_f32_16x16x32_bf16 a[184:187], a[112:115], v[48:51], a[184:187]
    v_accvgpr_write_b32 a39, v211
    v_cvt_pk_bf16_f32 v212, v212, v213
    v_mfma_f32_16x16x32_bf16 a[184:187], a[116:119], v[52:55], a[184:187]
    v_cvt_pk_bf16_f32 v213, v214, v215
    v_cvt_pk_bf16_f32 v214, v244, v245
    v_mfma_f32_16x16x32_bf16 a[188:191], a[120:123], v[48:51], a[188:191]
    v_cvt_pk_bf16_f32 v215, v246, v247
    v_mul_f32 v216, s74, v216
    v_mfma_f32_16x16x32_bf16 a[188:191], a[124:127], v[52:55], a[188:191]
    s_waitcnt lgkmcnt(0)
    v_mul_f32 v217, s74, v217
    v_mul_f32 v218, s74, v218
    v_mfma_f32_16x16x32_bf16 a[192:195], a[64:67], v[56:59], a[192:195]
    v_mul_f32 v219, s74, v219
    v_mul_f32 v248, s74, v248
    v_mfma_f32_16x16x32_bf16 a[192:195], a[68:71], v[60:63], a[192:195]
    v_mul_f32 v249, s74, v249
    v_mul_f32 v250, s74, v250
    v_mfma_f32_16x16x32_bf16 a[196:199], a[72:75], v[56:59], a[196:199]
    v_mul_f32 v251, s74, v251
    v_accvgpr_write_b32 a44, v212
    v_mfma_f32_16x16x32_bf16 a[196:199], a[76:79], v[60:63], a[196:199]
    buffer_load_dwordx4 v12, s[20:23], s63 offen offset:2048 lds
    v_mfma_f32_16x16x32_bf16 a[200:203], a[80:83], v[56:59], a[200:203]
    ds_read_b128 v[92:95], v25 offset:57344
    v_accvgpr_write_b32 a45, v213
    v_mfma_f32_16x16x32_bf16 a[200:203], a[84:87], v[60:63], a[200:203]
    v_accvgpr_write_b32 a46, v214
    v_accvgpr_write_b32 a47, v215
    v_mfma_f32_16x16x32_bf16 a[204:207], a[88:91], v[56:59], a[204:207]
    v_cvt_pk_bf16_f32 v216, v216, v217
    v_cvt_pk_bf16_f32 v217, v218, v219
    v_mfma_f32_16x16x32_bf16 a[204:207], a[92:95], v[60:63], a[204:207]
    s_add_u32 s72, s70, 36864
    v_cvt_pk_bf16_f32 v218, v248, v249
    v_cvt_pk_bf16_f32 v219, v250, v251
    v_mfma_f32_16x16x32_bf16 a[208:211], a[96:99], v[56:59], a[208:211]
    buffer_store_dwordx4 a[40:43], v1, s[36:39], s72 offen sc1
    v_mfma_f32_16x16x32_bf16 a[208:211], a[100:103], v[60:63], a[208:211]
    v_mul_f32 v220, s74, v220
    v_mul_f32 v221, s74, v221
    v_mfma_f32_16x16x32_bf16 a[212:215], a[104:107], v[56:59], a[212:215]
    buffer_load_dwordx4 v13, s[20:23], s63 offen offset:3072 lds
    v_mfma_f32_16x16x32_bf16 a[212:215], a[108:111], v[60:63], a[212:215]
    v_mul_f32 v222, s74, v222
    v_mul_f32 v223, s74, v223
    v_mfma_f32_16x16x32_bf16 a[216:219], a[112:115], v[56:59], a[216:219]
    v_mul_f32 v252, s74, v252
    v_mul_f32 v253, s74, v253
    v_mfma_f32_16x16x32_bf16 a[216:219], a[116:119], v[60:63], a[216:219]
    v_mul_f32 v254, s74, v254
    v_mul_f32 v255, s74, v255
    v_mfma_f32_16x16x32_bf16 a[220:223], a[120:123], v[56:59], a[220:223]
    v_accvgpr_write_b32 a52, v216
    v_accvgpr_write_b32 a53, v217
    v_mfma_f32_16x16x32_bf16 a[220:223], a[124:127], v[60:63], a[220:223]
    v_accvgpr_write_b32 a54, v218
    v_accvgpr_write_b32 a55, v219
    v_mfma_f32_16x16x32_bf16 a[224:227], a[64:67], v[40:43], a[224:227]
    v_cvt_pk_bf16_f32 v220, v220, v221
    v_cvt_pk_bf16_f32 v221, v222, v223
    v_mfma_f32_16x16x32_bf16 a[224:227], a[68:71], v[44:47], a[224:227]
    s_xor_b32 s63, s63, 128
    v_cvt_pk_bf16_f32 v222, v252, v253
    v_cvt_pk_bf16_f32 v223, v254, v255
    v_mfma_f32_16x16x32_bf16 a[228:231], a[72:75], v[40:43], a[228:231]
    v_accvgpr_write_b32 a60, v220
    v_accvgpr_write_b32 a61, v221
    v_mfma_f32_16x16x32_bf16 a[228:231], a[76:79], v[44:47], a[228:231]
    v_accvgpr_write_b32 a62, v222
    v_accvgpr_write_b32 a63, v223
    v_mfma_f32_16x16x32_bf16 a[232:235], a[80:83], v[40:43], a[232:235]
    v_accvgpr_write_b32 a0, 0
    v_accvgpr_write_b32 a1, 0
    v_mfma_f32_16x16x32_bf16 a[232:235], a[84:87], v[44:47], a[232:235]
    s_waitcnt vmcnt(11) lgkmcnt(0)
    s_barrier
    ds_read_b64_tr_b16 v[48:49], v14 offset:0
    v_mfma_f32_16x16x32_bf16 a[236:239], a[88:91], v[40:43], a[236:239]
    s_add_u32 m0, s67, 0
    ds_read_b64_tr_b16 v[50:51], v14 offset:1024
    ds_read_b64_tr_b16 v[52:53], v14 offset:8192
    v_mfma_f32_16x16x32_bf16 a[236:239], a[92:95], v[44:47], a[236:239]
    buffer_load_dwordx4 v1, s[28:31], s65 offen sc1 lds
    v_mfma_f32_16x16x32_bf16 a[240:243], a[96:99], v[40:43], a[240:243]
    ds_read_b64_tr_b16 v[54:55], v14 offset:9216
    ds_read_b64_tr_b16 v[56:57], v15 offset:0
    v_mfma_f32_16x16x32_bf16 a[240:243], a[100:103], v[44:47], a[240:243]
    ds_read_b64_tr_b16 v[58:59], v15 offset:1024
    ds_read_b64_tr_b16 v[60:61], v15 offset:8192
    v_mfma_f32_16x16x32_bf16 a[244:247], a[104:107], v[40:43], a[244:247]
    ds_read_b64_tr_b16 v[62:63], v15 offset:9216
    v_add_u32 v14, 0x10000, v14
    v_mfma_f32_16x16x32_bf16 a[244:247], a[108:111], v[44:47], a[244:247]
    v_add_u32 v15, 0x10000, v15
    v_accvgpr_write_b32 a2, 0
    v_mfma_f32_16x16x32_bf16 a[248:251], a[112:115], v[40:43], a[248:251]
    v_accvgpr_write_b32 a3, 0
    v_accvgpr_write_b32 a8, 0
    v_mfma_f32_16x16x32_bf16 a[248:251], a[116:119], v[44:47], a[248:251]
    v_accvgpr_write_b32 a9, 0
    v_accvgpr_write_b32 a10, 0
    v_mfma_f32_16x16x32_bf16 a[252:255], a[120:123], v[40:43], a[252:255]
    ds_read_b64_tr_b16 v[40:41], v16 offset:0
    ds_read_b64_tr_b16 v[42:43], v16 offset:1024
    v_mfma_f32_16x16x32_bf16 a[252:255], a[124:127], v[44:47], a[252:255]
    s_add_u32 s72, s70, 40960
    ds_read_b64_tr_b16 v[44:45], v16 offset:8192
    ds_read_b64_tr_b16 v[46:47], v16 offset:9216
    s_waitcnt lgkmcnt(4)
    v_mfma_f32_16x16x32_bf16 v[128:131], v[48:51], v[64:67], 0
    buffer_load_dwordx4 v1, s[28:31], s65 offen offset:1024 sc1 lds
    v_mfma_f32_16x16x32_bf16 v[128:131], v[52:55], v[68:71], v[128:131]
    v_add_u32 v24, 0x10000, v24
    v_add_u32 v16, 0x10000, v16
    v_mfma_f32_16x16x32_bf16 v[132:135], v[48:51], v[72:75], 0
    ds_read_b128 v[96:99], v24 offset:16384
    v_accvgpr_write_b32 a11, 0
    v_mfma_f32_16x16x32_bf16 v[132:135], v[52:55], v[76:79], v[132:135]
    buffer_store_dwordx4 a[48:51], v1, s[36:39], s72 offen sc1
    v_mfma_f32_16x16x32_bf16 v[136:139], v[48:51], v[80:83], 0
    v_accvgpr_write_b32 a16, 0
    v_accvgpr_write_b32 a17, 0
    v_mfma_f32_16x16x32_bf16 v[136:139], v[52:55], v[84:87], v[136:139]
    v_accvgpr_write_b32 a18, 0
    v_accvgpr_write_b32 a19, 0
    v_mfma_f32_16x16x32_bf16 v[140:143], v[48:51], v[88:91], 0
    ds_read_b64_tr_b16 v[48:49], v17 offset:0
    ds_read_b64_tr_b16 v[50:51], v17 offset:1024
    v_mfma_f32_16x16x32_bf16 v[140:143], v[52:55], v[92:95], v[140:143]
    ds_read_b64_tr_b16 v[52:53], v17 offset:8192
    ds_read_b64_tr_b16 v[54:55], v17 offset:9216
    v_mfma_f32_16x16x32_bf16 v[144:147], v[56:59], v[64:67], 0
    v_add_u32 v17, 0x10000, v17
    v_accvgpr_write_b32 a24, 0
    v_mfma_f32_16x16x32_bf16 v[144:147], v[60:63], v[68:71], v[144:147]
    s_add_u32 m0, s69, 16384
    v_accvgpr_write_b32 a25, 0
    v_accvgpr_write_b32 a26, 0
    v_mfma_f32_16x16x32_bf16 v[148:151], v[56:59], v[72:75], 0
    s_xor_b32 s65, s65, 24576
    buffer_load_dwordx4 v10, s[20:23], s64 offen lds
    v_mfma_f32_16x16x32_bf16 v[148:151], v[60:63], v[76:79], v[148:151]
    v_accvgpr_write_b32 a27, 0
    v_accvgpr_write_b32 a32, 0
    v_mfma_f32_16x16x32_bf16 v[152:155], v[56:59], v[80:83], 0
    v_add_u32 v25, 0x10000, v25
    v_accvgpr_write_b32 a33, 0
    v_mfma_f32_16x16x32_bf16 v[152:155], v[60:63], v[84:87], v[152:155]
    ds_read_b128 v[100:103], v25 offset:16384
    v_accvgpr_write_b32 a34, 0
    v_mfma_f32_16x16x32_bf16 v[156:159], v[56:59], v[88:91], 0
    ds_read_b64_tr_b16 v[56:57], v18 offset:0
    ds_read_b64_tr_b16 v[58:59], v18 offset:1024
    v_mfma_f32_16x16x32_bf16 v[156:159], v[60:63], v[92:95], v[156:159]
    s_waitcnt lgkmcnt(3)
    ds_read_b64_tr_b16 v[60:61], v18 offset:8192
    ds_read_b64_tr_b16 v[62:63], v18 offset:9216
    v_mfma_f32_16x16x32_bf16 v[160:163], v[40:43], v[64:67], 0
    v_add_u32 v18, 0x10000, v18
    v_accvgpr_write_b32 a35, 0
    v_mfma_f32_16x16x32_bf16 v[160:163], v[44:47], v[68:71], v[160:163]
    v_accvgpr_write_b32 a40, 0
    v_accvgpr_write_b32 a41, 0
    v_mfma_f32_16x16x32_bf16 v[164:167], v[40:43], v[72:75], 0
    v_accvgpr_write_b32 a42, 0
    v_accvgpr_write_b32 a43, 0
    v_mfma_f32_16x16x32_bf16 v[164:167], v[44:47], v[76:79], v[164:167]
    v_accvgpr_write_b32 a48, 0
    v_accvgpr_write_b32 a49, 0
    v_mfma_f32_16x16x32_bf16 v[168:171], v[40:43], v[80:83], 0
    buffer_load_dwordx4 v11, s[20:23], s64 offen offset:1024 lds
    v_mfma_f32_16x16x32_bf16 v[168:171], v[44:47], v[84:87], v[168:171]
    v_accvgpr_write_b32 a50, 0
    v_accvgpr_write_b32 a51, 0
    v_mfma_f32_16x16x32_bf16 v[172:175], v[40:43], v[88:91], 0
    ds_read_b64_tr_b16 v[40:41], v19 offset:0
    ds_read_b64_tr_b16 v[42:43], v19 offset:1024
    v_mfma_f32_16x16x32_bf16 v[172:175], v[44:47], v[92:95], v[172:175]
    s_add_u32 s72, s70, 45056
    ds_read_b64_tr_b16 v[44:45], v19 offset:8192
    ds_read_b64_tr_b16 v[46:47], v19 offset:9216
    v_mfma_f32_16x16x32_bf16 v[176:179], v[48:51], v[64:67], 0
    ds_read_b128 v[104:107], v24 offset:24576
    v_add_u32 v19, 0x10000, v19
    v_mfma_f32_16x16x32_bf16 v[176:179], v[52:55], v[68:71], v[176:179]
    buffer_store_dwordx4 a[56:59], v1, s[36:39], s72 offen sc1
    v_mfma_f32_16x16x32_bf16 v[180:183], v[48:51], v[72:75], 0
    v_mfma_f32_16x16x32_bf16 v[180:183], v[52:55], v[76:79], v[180:183]
    v_accvgpr_write_b32 a56, 0
    v_accvgpr_write_b32 a57, 0
    v_mfma_f32_16x16x32_bf16 v[184:187], v[48:51], v[80:83], 0
    v_accvgpr_write_b32 a58, 0
    v_accvgpr_write_b32 a59, 0
    v_mfma_f32_16x16x32_bf16 v[184:187], v[52:55], v[84:87], v[184:187]
    v_mfma_f32_16x16x32_bf16 v[188:191], v[48:51], v[88:91], 0
    buffer_load_dwordx4 v12, s[20:23], s64 offen offset:2048 lds
    v_mfma_f32_16x16x32_bf16 v[188:191], v[52:55], v[92:95], v[188:191]
    s_waitcnt lgkmcnt(0)
    ds_read_b64_tr_b16 v[48:49], v20 offset:0
    ds_read_b64_tr_b16 v[50:51], v20 offset:1024
    v_mfma_f32_16x16x32_bf16 v[192:195], v[56:59], v[64:67], 0
    ds_read_b64_tr_b16 v[52:53], v20 offset:8192
    ds_read_b64_tr_b16 v[54:55], v20 offset:9216
    v_mfma_f32_16x16x32_bf16 v[192:195], v[60:63], v[68:71], v[192:195]
    v_add_u32 v20, 0x10000, v20
    v_mfma_f32_16x16x32_bf16 v[196:199], v[56:59], v[72:75], 0
    v_mfma_f32_16x16x32_bf16 v[196:199], v[60:63], v[76:79], v[196:199]
    ds_read_b128 v[108:111], v25 offset:24576
    v_mfma_f32_16x16x32_bf16 v[200:203], v[56:59], v[80:83], 0
    v_mfma_f32_16x16x32_bf16 v[200:203], v[60:63], v[84:87], v[200:203]
    v_mfma_f32_16x16x32_bf16 v[204:207], v[56:59], v[88:91], 0
    ds_read_b64_tr_b16 v[56:57], v21 offset:0
    ds_read_b64_tr_b16 v[58:59], v21 offset:1024
    v_mfma_f32_16x16x32_bf16 v[204:207], v[60:63], v[92:95], v[204:207]
    ds_read_b64_tr_b16 v[60:61], v21 offset:8192
    ds_read_b64_tr_b16 v[62:63], v21 offset:9216
    v_mfma_f32_16x16x32_bf16 v[208:211], v[40:43], v[64:67], 0
    buffer_load_dwordx4 v13, s[20:23], s64 offen offset:3072 lds
    v_mfma_f32_16x16x32_bf16 v[208:211], v[44:47], v[68:71], v[208:211]
    v_add_u32 v21, 0x10000, v21
    v_mfma_f32_16x16x32_bf16 v[212:215], v[40:43], v[72:75], 0
    v_mfma_f32_16x16x32_bf16 v[212:215], v[44:47], v[76:79], v[212:215]
    v_mfma_f32_16x16x32_bf16 v[216:219], v[40:43], v[80:83], 0
    v_mfma_f32_16x16x32_bf16 v[216:219], v[44:47], v[84:87], v[216:219]
    v_mfma_f32_16x16x32_bf16 v[220:223], v[40:43], v[88:91], 0
    ds_read_b64_tr_b16 v[40:41], v26 offset:32768
    ds_read_b64_tr_b16 v[42:43], v26 offset:33280
    v_mfma_f32_16x16x32_bf16 v[220:223], v[44:47], v[92:95], v[220:223]
    s_add_u32 s72, s70, 1024
    ds_read_b64_tr_b16 v[44:45], v26 offset:36864
    ds_read_b64_tr_b16 v[46:47], v26 offset:37376
    s_waitcnt lgkmcnt(4)
    v_mfma_f32_16x16x32_bf16 v[224:227], v[48:51], v[64:67], 0
    buffer_store_dwordx4 a[4:7], v1, s[36:39], s72 offen sc1
    v_mfma_f32_16x16x32_bf16 v[224:227], v[52:55], v[68:71], v[224:227]
    s_xor_b32 s64, s64, 128
    v_add_u32 v26, 0xffff0000, v26
    v_accvgpr_write_b32 a4, 0
    v_mfma_f32_16x16x32_bf16 v[228:231], v[48:51], v[72:75], 0
    v_accvgpr_write_b32 a5, 0
    v_accvgpr_write_b32 a6, 0
    v_mfma_f32_16x16x32_bf16 v[228:231], v[52:55], v[76:79], v[228:231]
    v_accvgpr_write_b32 a7, 0
    v_mfma_f32_16x16x32_bf16 v[232:235], v[48:51], v[80:83], 0
    v_mfma_f32_16x16x32_bf16 v[232:235], v[52:55], v[84:87], v[232:235]
    s_add_u32 m0, s69, 32768
    v_mfma_f32_16x16x32_bf16 v[236:239], v[48:51], v[88:91], 0
    buffer_load_dwordx4 v2, s[24:27], s60 offen lds
    v_mfma_f32_16x16x32_bf16 v[236:239], v[52:55], v[92:95], v[236:239]
    ds_read_b64_tr_b16 v[48:49], v27 offset:32768
    ds_read_b64_tr_b16 v[50:51], v27 offset:33280
    v_mfma_f32_16x16x32_bf16 v[240:243], v[56:59], v[64:67], 0
    ds_read_b64_tr_b16 v[52:53], v27 offset:36864
    ds_read_b64_tr_b16 v[54:55], v27 offset:37376
    v_mfma_f32_16x16x32_bf16 v[240:243], v[60:63], v[68:71], v[240:243]
    buffer_load_dwordx4 v3, s[24:27], s60 offen offset:1024 lds
    v_mfma_f32_16x16x32_bf16 v[244:247], v[56:59], v[72:75], 0
    v_add_u32 v27, 0xffff0000, v27
    v_mfma_f32_16x16x32_bf16 v[244:247], v[60:63], v[76:79], v[244:247]
    v_mfma_f32_16x16x32_bf16 v[248:251], v[56:59], v[80:83], 0
    v_mfma_f32_16x16x32_bf16 v[248:251], v[60:63], v[84:87], v[248:251]
    buffer_load_dwordx4 v4, s[24:27], s60 offen offset:2048 lds
    v_mfma_f32_16x16x32_bf16 v[252:255], v[56:59], v[88:91], 0
    ds_read_b64_tr_b16 v[56:57], v28 offset:32768
    ds_read_b64_tr_b16 v[58:59], v28 offset:33280
    v_mfma_f32_16x16x32_bf16 v[252:255], v[60:63], v[92:95], v[252:255]
    s_waitcnt lgkmcnt(2)
    ds_read_b64_tr_b16 v[60:61], v28 offset:36864
    ds_read_b64_tr_b16 v[62:63], v28 offset:37376
    v_mfma_f32_16x16x32_bf16 a[64:67], v[40:43], v[64:67], 0
    buffer_load_dwordx4 v5, s[24:27], s60 offen offset:3072 lds
    v_mfma_f32_16x16x32_bf16 a[64:67], v[44:47], v[68:71], a[64:67]
    v_add_u32 v28, 0xffff0000, v28
    v_mfma_f32_16x16x32_bf16 a[68:71], v[40:43], v[72:75], 0
    ds_read_b128 v[112:115], v24 offset:49152
    v_mfma_f32_16x16x32_bf16 a[68:71], v[44:47], v[76:79], a[68:71]
    s_add_u32 m0, s69, 49152
    v_mfma_f32_16x16x32_bf16 a[72:75], v[40:43], v[80:83], 0
    s_xor_b32 s60, s60, 524288
    buffer_load_dwordx4 v10, s[20:23], s63 offen lds
    v_mfma_f32_16x16x32_bf16 a[72:75], v[44:47], v[84:87], a[72:75]
    ds_read_b128 v[116:119], v25 offset:49152
    v_mfma_f32_16x16x32_bf16 a[76:79], v[40:43], v[88:91], 0
    ds_read_b64_tr_b16 v[40:41], v29 offset:32768
    ds_read_b64_tr_b16 v[42:43], v29 offset:33280
    v_mfma_f32_16x16x32_bf16 a[76:79], v[44:47], v[92:95], a[76:79]
    s_add_u32 s72, s70, 5120
    buffer_load_dwordx4 v11, s[20:23], s63 offen offset:1024 lds
    v_mfma_f32_16x16x32_bf16 a[80:83], v[48:51], v[64:67], 0
    ds_read_b128 v[120:123], v24 offset:57344
    ds_read_b64_tr_b16 v[44:45], v29 offset:36864
    v_mfma_f32_16x16x32_bf16 a[80:83], v[52:55], v[68:71], a[80:83]
    ds_read_b64_tr_b16 v[46:47], v29 offset:37376
    v_add_u32 v29, 0xffff0000, v29
    v_mfma_f32_16x16x32_bf16 a[84:87], v[48:51], v[72:75], 0
    buffer_store_dwordx4 a[12:15], v1, s[36:39], s72 offen sc1
    v_mfma_f32_16x16x32_bf16 a[84:87], v[52:55], v[76:79], a[84:87]
    ds_read_b128 v[124:127], v25 offset:57344
    v_accvgpr_write_b32 a12, 0
    v_mfma_f32_16x16x32_bf16 a[88:91], v[48:51], v[80:83], 0
    v_accvgpr_write_b32 a13, 0
    v_accvgpr_write_b32 a14, 0
    v_mfma_f32_16x16x32_bf16 a[88:91], v[52:55], v[84:87], a[88:91]
    v_accvgpr_write_b32 a15, 0
    v_mfma_f32_16x16x32_bf16 a[92:95], v[48:51], v[88:91], 0
    buffer_load_dwordx4 v12, s[20:23], s63 offen offset:2048 lds
    v_mfma_f32_16x16x32_bf16 a[92:95], v[52:55], v[92:95], a[92:95]
    s_waitcnt lgkmcnt(1)
    v_mfma_f32_16x16x32_bf16 a[96:99], v[56:59], v[64:67], 0
    v_mfma_f32_16x16x32_bf16 a[96:99], v[60:63], v[68:71], a[96:99]
    v_mfma_f32_16x16x32_bf16 a[100:103], v[56:59], v[72:75], 0
    buffer_load_dwordx4 v13, s[20:23], s63 offen offset:3072 lds
    v_mfma_f32_16x16x32_bf16 a[100:103], v[60:63], v[76:79], a[100:103]
    s_xor_b32 s63, s63, 896
    v_mfma_f32_16x16x32_bf16 a[104:107], v[56:59], v[80:83], 0
    v_mfma_f32_16x16x32_bf16 a[104:107], v[60:63], v[84:87], a[104:107]
    s_waitcnt vmcnt(10) lgkmcnt(0)
    s_barrier
    ds_read_b64_tr_b16 v[48:49], v14 offset:0
    v_mfma_f32_16x16x32_bf16 a[108:111], v[56:59], v[88:91], 0
    s_add_u32 m0, s67, 65536
    ds_read_b64_tr_b16 v[50:51], v14 offset:1024
    ds_read_b64_tr_b16 v[52:53], v14 offset:8192
    v_mfma_f32_16x16x32_bf16 a[108:111], v[60:63], v[92:95], a[108:111]
    buffer_load_dwordx4 v1, s[28:31], s65 offen sc1 lds
    v_mfma_f32_16x16x32_bf16 a[112:115], v[40:43], v[64:67], 0
    ds_read_b64_tr_b16 v[54:55], v14 offset:9216
    ds_read_b64_tr_b16 v[56:57], v15 offset:0
    v_mfma_f32_16x16x32_bf16 a[112:115], v[44:47], v[68:71], a[112:115]
    ds_read_b64_tr_b16 v[58:59], v15 offset:1024
    ds_read_b64_tr_b16 v[60:61], v15 offset:8192
    v_mfma_f32_16x16x32_bf16 a[116:119], v[40:43], v[72:75], 0
    ds_read_b64_tr_b16 v[62:63], v15 offset:9216
    v_add_u32 v14, 0xfffe0000, v14
    v_mfma_f32_16x16x32_bf16 a[116:119], v[44:47], v[76:79], a[116:119]
    v_add_u32 v15, 0xfffe0000, v15
    v_mfma_f32_16x16x32_bf16 a[120:123], v[40:43], v[80:83], 0
    v_mfma_f32_16x16x32_bf16 a[120:123], v[44:47], v[84:87], a[120:123]
    v_mfma_f32_16x16x32_bf16 a[124:127], v[40:43], v[88:91], 0
    ds_read_b64_tr_b16 v[40:41], v16 offset:0
    ds_read_b64_tr_b16 v[42:43], v16 offset:1024
    v_mfma_f32_16x16x32_bf16 a[124:127], v[44:47], v[92:95], a[124:127]
    s_add_u32 s72, s70, 9216
    ds_read_b64_tr_b16 v[44:45], v16 offset:8192
    ds_read_b64_tr_b16 v[46:47], v16 offset:9216
    s_waitcnt lgkmcnt(4)
    v_mfma_f32_16x16x32_bf16 v[128:131], v[48:51], v[96:99], v[128:131]
    buffer_load_dwordx4 v1, s[28:31], s65 offen offset:1024 sc1 lds
    v_mfma_f32_16x16x32_bf16 v[128:131], v[52:55], v[100:103], v[128:131]
    v_add_u32 v24, 0x10000, v24
    v_add_u32 v16, 0xfffe0000, v16
    v_mfma_f32_16x16x32_bf16 v[132:135], v[48:51], v[104:107], v[132:135]
    buffer_store_dwordx4 a[20:23], v1, s[36:39], s72 offen sc1
    v_mfma_f32_16x16x32_bf16 v[132:135], v[52:55], v[108:111], v[132:135]
    ds_read_b128 v[64:67], v24 offset:16384
    v_accvgpr_write_b32 a20, 0
    v_mfma_f32_16x16x32_bf16 v[136:139], v[48:51], v[112:115], v[136:139]
    v_accvgpr_write_b32 a21, 0
    v_accvgpr_write_b32 a22, 0
    v_mfma_f32_16x16x32_bf16 v[136:139], v[52:55], v[116:119], v[136:139]
    v_accvgpr_write_b32 a23, 0
    v_mfma_f32_16x16x32_bf16 v[140:143], v[48:51], v[120:123], v[140:143]
    ds_read_b64_tr_b16 v[48:49], v17 offset:0
    ds_read_b64_tr_b16 v[50:51], v17 offset:1024
    v_mfma_f32_16x16x32_bf16 v[140:143], v[52:55], v[124:127], v[140:143]
    ds_read_b64_tr_b16 v[52:53], v17 offset:8192
    ds_read_b64_tr_b16 v[54:55], v17 offset:9216
    v_mfma_f32_16x16x32_bf16 v[144:147], v[56:59], v[96:99], v[144:147]
    v_add_u32 v17, 0xfffe0000, v17
    v_mfma_f32_16x16x32_bf16 v[144:147], v[60:63], v[100:103], v[144:147]
    s_add_u32 m0, s69, 81920
    v_mfma_f32_16x16x32_bf16 v[148:151], v[56:59], v[104:107], v[148:151]
    s_xor_b32 s65, s65, 8192
    buffer_load_dwordx4 v10, s[20:23], s64 offen lds
    v_mfma_f32_16x16x32_bf16 v[148:151], v[60:63], v[108:111], v[148:151]
    v_mfma_f32_16x16x32_bf16 v[152:155], v[56:59], v[112:115], v[152:155]
    v_add_u32 v25, 0x10000, v25
    v_mfma_f32_16x16x32_bf16 v[152:155], v[60:63], v[116:119], v[152:155]
    ds_read_b128 v[68:71], v25 offset:16384
    v_mfma_f32_16x16x32_bf16 v[156:159], v[56:59], v[120:123], v[156:159]
    ds_read_b64_tr_b16 v[56:57], v18 offset:0
    ds_read_b64_tr_b16 v[58:59], v18 offset:1024
    v_mfma_f32_16x16x32_bf16 v[156:159], v[60:63], v[124:127], v[156:159]
    s_waitcnt lgkmcnt(3)
    ds_read_b64_tr_b16 v[60:61], v18 offset:8192
    ds_read_b64_tr_b16 v[62:63], v18 offset:9216
    v_mfma_f32_16x16x32_bf16 v[160:163], v[40:43], v[96:99], v[160:163]
    v_add_u32 v18, 0xfffe0000, v18
    v_mfma_f32_16x16x32_bf16 v[160:163], v[44:47], v[100:103], v[160:163]
    v_mfma_f32_16x16x32_bf16 v[164:167], v[40:43], v[104:107], v[164:167]
    v_mfma_f32_16x16x32_bf16 v[164:167], v[44:47], v[108:111], v[164:167]
    v_mfma_f32_16x16x32_bf16 v[168:171], v[40:43], v[112:115], v[168:171]
    buffer_load_dwordx4 v11, s[20:23], s64 offen offset:1024 lds
    v_mfma_f32_16x16x32_bf16 v[168:171], v[44:47], v[116:119], v[168:171]
    v_mfma_f32_16x16x32_bf16 v[172:175], v[40:43], v[120:123], v[172:175]
    ds_read_b64_tr_b16 v[40:41], v19 offset:0
    ds_read_b64_tr_b16 v[42:43], v19 offset:1024
    v_mfma_f32_16x16x32_bf16 v[172:175], v[44:47], v[124:127], v[172:175]
    s_add_u32 s72, s70, 13312
    ds_read_b64_tr_b16 v[44:45], v19 offset:8192
    ds_read_b64_tr_b16 v[46:47], v19 offset:9216
    v_mfma_f32_16x16x32_bf16 v[176:179], v[48:51], v[96:99], v[176:179]
    ds_read_b128 v[72:75], v24 offset:24576
    v_add_u32 v19, 0xfffe0000, v19
    v_mfma_f32_16x16x32_bf16 v[176:179], v[52:55], v[100:103], v[176:179]
    buffer_store_dwordx4 a[28:31], v1, s[36:39], s72 offen sc1
    v_mfma_f32_16x16x32_bf16 v[180:183], v[48:51], v[104:107], v[180:183]
    v_mfma_f32_16x16x32_bf16 v[180:183], v[52:55], v[108:111], v[180:183]
    v_accvgpr_write_b32 a28, 0
    v_accvgpr_write_b32 a29, 0
    v_mfma_f32_16x16x32_bf16 v[184:187], v[48:51], v[112:115], v[184:187]
    v_accvgpr_write_b32 a30, 0
    v_accvgpr_write_b32 a31, 0
    v_mfma_f32_16x16x32_bf16 v[184:187], v[52:55], v[116:119], v[184:187]
    v_mfma_f32_16x16x32_bf16 v[188:191], v[48:51], v[120:123], v[188:191]
    buffer_load_dwordx4 v12, s[20:23], s64 offen offset:2048 lds
    v_mfma_f32_16x16x32_bf16 v[188:191], v[52:55], v[124:127], v[188:191]
    s_waitcnt lgkmcnt(0)
    ds_read_b64_tr_b16 v[48:49], v20 offset:0
    ds_read_b64_tr_b16 v[50:51], v20 offset:1024
    v_mfma_f32_16x16x32_bf16 v[192:195], v[56:59], v[96:99], v[192:195]
    ds_read_b64_tr_b16 v[52:53], v20 offset:8192
    ds_read_b64_tr_b16 v[54:55], v20 offset:9216
    v_mfma_f32_16x16x32_bf16 v[192:195], v[60:63], v[100:103], v[192:195]
    v_add_u32 v20, 0xfffe0000, v20
    v_mfma_f32_16x16x32_bf16 v[196:199], v[56:59], v[104:107], v[196:199]
    v_mfma_f32_16x16x32_bf16 v[196:199], v[60:63], v[108:111], v[196:199]
    ds_read_b128 v[76:79], v25 offset:24576
    v_mfma_f32_16x16x32_bf16 v[200:203], v[56:59], v[112:115], v[200:203]
    v_mfma_f32_16x16x32_bf16 v[200:203], v[60:63], v[116:119], v[200:203]
    v_mfma_f32_16x16x32_bf16 v[204:207], v[56:59], v[120:123], v[204:207]
    ds_read_b64_tr_b16 v[56:57], v21 offset:0
    ds_read_b64_tr_b16 v[58:59], v21 offset:1024
    v_mfma_f32_16x16x32_bf16 v[204:207], v[60:63], v[124:127], v[204:207]
    ds_read_b64_tr_b16 v[60:61], v21 offset:8192
    ds_read_b64_tr_b16 v[62:63], v21 offset:9216
    v_mfma_f32_16x16x32_bf16 v[208:211], v[40:43], v[96:99], v[208:211]
    buffer_load_dwordx4 v13, s[20:23], s64 offen offset:3072 lds
    v_mfma_f32_16x16x32_bf16 v[208:211], v[44:47], v[100:103], v[208:211]
    v_add_u32 v21, 0xfffe0000, v21
    v_mfma_f32_16x16x32_bf16 v[212:215], v[40:43], v[104:107], v[212:215]
    v_mfma_f32_16x16x32_bf16 v[212:215], v[44:47], v[108:111], v[212:215]
    v_mfma_f32_16x16x32_bf16 v[216:219], v[40:43], v[112:115], v[216:219]
    v_mfma_f32_16x16x32_bf16 v[216:219], v[44:47], v[116:119], v[216:219]
    v_mfma_f32_16x16x32_bf16 v[220:223], v[40:43], v[120:123], v[220:223]
    ds_read_b64_tr_b16 v[40:41], v26 offset:0
    ds_read_b64_tr_b16 v[42:43], v26 offset:512
    v_mfma_f32_16x16x32_bf16 v[220:223], v[44:47], v[124:127], v[220:223]
    s_add_u32 s72, s70, 33792
    ds_read_b64_tr_b16 v[44:45], v26 offset:4096
    ds_read_b64_tr_b16 v[46:47], v26 offset:4608
    s_waitcnt lgkmcnt(4)
    v_mfma_f32_16x16x32_bf16 v[224:227], v[48:51], v[96:99], v[224:227]
    buffer_store_dwordx4 a[36:39], v1, s[36:39], s72 offen sc1
    v_mfma_f32_16x16x32_bf16 v[224:227], v[52:55], v[100:103], v[224:227]
    s_xor_b32 s64, s64, 896
    v_add_u32 v26, 0x10000, v26
    v_accvgpr_write_b32 a36, 0
    v_mfma_f32_16x16x32_bf16 v[228:231], v[48:51], v[104:107], v[228:231]
    v_accvgpr_write_b32 a37, 0
    v_accvgpr_write_b32 a38, 0
    v_mfma_f32_16x16x32_bf16 v[228:231], v[52:55], v[108:111], v[228:231]
    v_accvgpr_write_b32 a39, 0
    v_mfma_f32_16x16x32_bf16 v[232:235], v[48:51], v[112:115], v[232:235]
    v_mfma_f32_16x16x32_bf16 v[232:235], v[52:55], v[116:119], v[232:235]
    s_add_u32 m0, s69, 98304
    v_mfma_f32_16x16x32_bf16 v[236:239], v[48:51], v[120:123], v[236:239]
    buffer_load_dwordx4 v2, s[24:27], s60 offen lds
    v_mfma_f32_16x16x32_bf16 v[236:239], v[52:55], v[124:127], v[236:239]
    ds_read_b64_tr_b16 v[48:49], v27 offset:0
    ds_read_b64_tr_b16 v[50:51], v27 offset:512
    v_mfma_f32_16x16x32_bf16 v[240:243], v[56:59], v[96:99], v[240:243]
    ds_read_b64_tr_b16 v[52:53], v27 offset:4096
    ds_read_b64_tr_b16 v[54:55], v27 offset:4608
    v_mfma_f32_16x16x32_bf16 v[240:243], v[60:63], v[100:103], v[240:243]
    buffer_load_dwordx4 v3, s[24:27], s60 offen offset:1024 lds
    v_mfma_f32_16x16x32_bf16 v[244:247], v[56:59], v[104:107], v[244:247]
    v_add_u32 v27, 0x10000, v27
    v_mfma_f32_16x16x32_bf16 v[244:247], v[60:63], v[108:111], v[244:247]
    v_mfma_f32_16x16x32_bf16 v[248:251], v[56:59], v[112:115], v[248:251]
    v_mfma_f32_16x16x32_bf16 v[248:251], v[60:63], v[116:119], v[248:251]
    buffer_load_dwordx4 v4, s[24:27], s60 offen offset:2048 lds
    v_mfma_f32_16x16x32_bf16 v[252:255], v[56:59], v[120:123], v[252:255]
    ds_read_b64_tr_b16 v[56:57], v28 offset:0
    ds_read_b64_tr_b16 v[58:59], v28 offset:512
    v_mfma_f32_16x16x32_bf16 v[252:255], v[60:63], v[124:127], v[252:255]
    s_waitcnt lgkmcnt(2)
    ds_read_b64_tr_b16 v[60:61], v28 offset:4096
    ds_read_b64_tr_b16 v[62:63], v28 offset:4608
    v_mfma_f32_16x16x32_bf16 a[64:67], v[40:43], v[96:99], a[64:67]
    buffer_load_dwordx4 v5, s[24:27], s60 offen offset:3072 lds
    v_mfma_f32_16x16x32_bf16 a[64:67], v[44:47], v[100:103], a[64:67]
    v_add_u32 v24, 0xfffe0000, v24
    v_add_u32 v28, 0x10000, v28
    v_mfma_f32_16x16x32_bf16 a[68:71], v[40:43], v[104:107], a[68:71]
    ds_read_b128 v[80:83], v24 offset:16384
    v_mfma_f32_16x16x32_bf16 a[68:71], v[44:47], v[108:111], a[68:71]
    s_add_u32 m0, s69, 114688
    v_mfma_f32_16x16x32_bf16 a[72:75], v[40:43], v[112:115], a[72:75]
    s_xor_b32 s60, s60, 3670016
    buffer_load_dwordx4 v10, s[20:23], s63 offen lds
    v_mfma_f32_16x16x32_bf16 a[72:75], v[44:47], v[116:119], a[72:75]
    v_add_u32 v25, 0xfffe0000, v25
    ds_read_b128 v[84:87], v25 offset:16384
    v_mfma_f32_16x16x32_bf16 a[76:79], v[40:43], v[120:123], a[76:79]
    ds_read_b64_tr_b16 v[40:41], v29 offset:0
    ds_read_b64_tr_b16 v[42:43], v29 offset:512
    v_mfma_f32_16x16x32_bf16 a[76:79], v[44:47], v[124:127], a[76:79]
    s_add_u32 s72, s70, 37888
    buffer_load_dwordx4 v11, s[20:23], s63 offen offset:1024 lds
    v_mfma_f32_16x16x32_bf16 a[80:83], v[48:51], v[96:99], a[80:83]
    ds_read_b128 v[88:91], v24 offset:24576
    ds_read_b64_tr_b16 v[44:45], v29 offset:4096
    v_mfma_f32_16x16x32_bf16 a[80:83], v[52:55], v[100:103], a[80:83]
    ds_read_b64_tr_b16 v[46:47], v29 offset:4608
    v_add_u32 v29, 0x10000, v29
    v_mfma_f32_16x16x32_bf16 a[84:87], v[48:51], v[104:107], a[84:87]
    buffer_store_dwordx4 a[44:47], v1, s[36:39], s72 offen sc1
    v_mfma_f32_16x16x32_bf16 a[84:87], v[52:55], v[108:111], a[84:87]
    ds_read_b128 v[92:95], v25 offset:24576
    v_accvgpr_write_b32 a44, 0
    v_mfma_f32_16x16x32_bf16 a[88:91], v[48:51], v[112:115], a[88:91]
    v_accvgpr_write_b32 a45, 0
    v_accvgpr_write_b32 a46, 0
    v_mfma_f32_16x16x32_bf16 a[88:91], v[52:55], v[116:119], a[88:91]
    v_accvgpr_write_b32 a47, 0
    v_mfma_f32_16x16x32_bf16 a[92:95], v[48:51], v[120:123], a[92:95]
    buffer_load_dwordx4 v12, s[20:23], s63 offen offset:2048 lds
    v_mfma_f32_16x16x32_bf16 a[92:95], v[52:55], v[124:127], a[92:95]
    s_waitcnt lgkmcnt(1)
    v_mfma_f32_16x16x32_bf16 a[96:99], v[56:59], v[96:99], a[96:99]
    v_mfma_f32_16x16x32_bf16 a[96:99], v[60:63], v[100:103], a[96:99]
    v_mfma_f32_16x16x32_bf16 a[100:103], v[56:59], v[104:107], a[100:103]
    buffer_load_dwordx4 v13, s[20:23], s63 offen offset:3072 lds
    v_mfma_f32_16x16x32_bf16 a[100:103], v[60:63], v[108:111], a[100:103]
    s_xor_b32 s63, s63, 128
    v_mfma_f32_16x16x32_bf16 a[104:107], v[56:59], v[112:115], a[104:107]
    v_mfma_f32_16x16x32_bf16 a[104:107], v[60:63], v[116:119], a[104:107]
    s_waitcnt vmcnt(10) lgkmcnt(0)
    s_barrier
    ds_read_b64_tr_b16 v[48:49], v14 offset:32768
    v_mfma_f32_16x16x32_bf16 a[108:111], v[56:59], v[120:123], a[108:111]
    s_add_u32 m0, s67, 131072
    ds_read_b64_tr_b16 v[50:51], v14 offset:33792
    ds_read_b64_tr_b16 v[52:53], v14 offset:40960
    v_mfma_f32_16x16x32_bf16 a[108:111], v[60:63], v[124:127], a[108:111]
    buffer_load_dwordx4 v1, s[28:31], s65 offen sc1 lds
    v_mfma_f32_16x16x32_bf16 a[112:115], v[40:43], v[96:99], a[112:115]
    ds_read_b64_tr_b16 v[54:55], v14 offset:41984
    ds_read_b64_tr_b16 v[56:57], v15 offset:32768
    v_mfma_f32_16x16x32_bf16 a[112:115], v[44:47], v[100:103], a[112:115]
    ds_read_b64_tr_b16 v[58:59], v15 offset:33792
    ds_read_b64_tr_b16 v[60:61], v15 offset:40960
    v_mfma_f32_16x16x32_bf16 a[116:119], v[40:43], v[104:107], a[116:119]
    ds_read_b64_tr_b16 v[62:63], v15 offset:41984
    v_add_u32 v14, 0x10000, v14
    v_mfma_f32_16x16x32_bf16 a[116:119], v[44:47], v[108:111], a[116:119]
    v_add_u32 v15, 0x10000, v15
    v_mfma_f32_16x16x32_bf16 a[120:123], v[40:43], v[112:115], a[120:123]
    v_mfma_f32_16x16x32_bf16 a[120:123], v[44:47], v[116:119], a[120:123]
    v_mfma_f32_16x16x32_bf16 a[124:127], v[40:43], v[120:123], a[124:127]
    ds_read_b64_tr_b16 v[40:41], v16 offset:32768
    ds_read_b64_tr_b16 v[42:43], v16 offset:33792
    v_mfma_f32_16x16x32_bf16 a[124:127], v[44:47], v[124:127], a[124:127]
    s_add_u32 s72, s70, 41984
    ds_read_b64_tr_b16 v[44:45], v16 offset:40960
    ds_read_b64_tr_b16 v[46:47], v16 offset:41984
    s_waitcnt lgkmcnt(4)
    v_mfma_f32_16x16x32_bf16 v[128:131], v[48:51], v[64:67], v[128:131]
    buffer_load_dwordx4 v1, s[28:31], s65 offen offset:1024 sc1 lds
    v_mfma_f32_16x16x32_bf16 v[128:131], v[52:55], v[68:71], v[128:131]
    buffer_store_dwordx4 a[52:55], v1, s[36:39], s72 offen sc1
    v_mfma_f32_16x16x32_bf16 v[132:135], v[48:51], v[72:75], v[132:135]
    ds_read_b128 v[96:99], v24 offset:49152
    v_add_u32 v16, 0x10000, v16
    v_mfma_f32_16x16x32_bf16 v[132:135], v[52:55], v[76:79], v[132:135]
    v_accvgpr_write_b32 a52, 0
    v_accvgpr_write_b32 a53, 0
    v_mfma_f32_16x16x32_bf16 v[136:139], v[48:51], v[80:83], v[136:139]
    v_accvgpr_write_b32 a54, 0
    v_accvgpr_write_b32 a55, 0
    v_mfma_f32_16x16x32_bf16 v[136:139], v[52:55], v[84:87], v[136:139]
    v_mfma_f32_16x16x32_bf16 v[140:143], v[48:51], v[88:91], v[140:143]
    ds_read_b64_tr_b16 v[48:49], v17 offset:32768
    ds_read_b64_tr_b16 v[50:51], v17 offset:33792
    v_mfma_f32_16x16x32_bf16 v[140:143], v[52:55], v[92:95], v[140:143]
    ds_read_b64_tr_b16 v[52:53], v17 offset:40960
    ds_read_b64_tr_b16 v[54:55], v17 offset:41984
    v_mfma_f32_16x16x32_bf16 v[144:147], v[56:59], v[64:67], v[144:147]
    v_add_u32 v17, 0x10000, v17
    v_mfma_f32_16x16x32_bf16 v[144:147], v[60:63], v[68:71], v[144:147]
    s_add_u32 m0, s69, 147456
    v_mfma_f32_16x16x32_bf16 v[148:151], v[56:59], v[72:75], v[148:151]
    s_xor_b32 s65, s65, 57344
    buffer_load_dwordx4 v10, s[20:23], s64 offen lds
    v_mfma_f32_16x16x32_bf16 v[148:151], v[60:63], v[76:79], v[148:151]
    v_mfma_f32_16x16x32_bf16 v[152:155], v[56:59], v[80:83], v[152:155]
    v_mfma_f32_16x16x32_bf16 v[152:155], v[60:63], v[84:87], v[152:155]
    ds_read_b128 v[100:103], v25 offset:49152
    v_mfma_f32_16x16x32_bf16 v[156:159], v[56:59], v[88:91], v[156:159]
    ds_read_b64_tr_b16 v[56:57], v18 offset:32768
    ds_read_b64_tr_b16 v[58:59], v18 offset:33792
    v_mfma_f32_16x16x32_bf16 v[156:159], v[60:63], v[92:95], v[156:159]
    s_waitcnt lgkmcnt(3)
    ds_read_b64_tr_b16 v[60:61], v18 offset:40960
    ds_read_b64_tr_b16 v[62:63], v18 offset:41984
    v_mfma_f32_16x16x32_bf16 v[160:163], v[40:43], v[64:67], v[160:163]
    v_add_u32 v18, 0x10000, v18
    v_mfma_f32_16x16x32_bf16 v[160:163], v[44:47], v[68:71], v[160:163]
    v_mfma_f32_16x16x32_bf16 v[164:167], v[40:43], v[72:75], v[164:167]
    v_mfma_f32_16x16x32_bf16 v[164:167], v[44:47], v[76:79], v[164:167]
    v_mfma_f32_16x16x32_bf16 v[168:171], v[40:43], v[80:83], v[168:171]
    buffer_load_dwordx4 v11, s[20:23], s64 offen offset:1024 lds
    v_mfma_f32_16x16x32_bf16 v[168:171], v[44:47], v[84:87], v[168:171]
    v_mfma_f32_16x16x32_bf16 v[172:175], v[40:43], v[88:91], v[172:175]
    ds_read_b64_tr_b16 v[40:41], v19 offset:32768
    ds_read_b64_tr_b16 v[42:43], v19 offset:33792
    v_mfma_f32_16x16x32_bf16 v[172:175], v[44:47], v[92:95], v[172:175]
    s_add_u32 s72, s70, 46080
    ds_read_b64_tr_b16 v[44:45], v19 offset:40960
    ds_read_b64_tr_b16 v[46:47], v19 offset:41984
    v_mfma_f32_16x16x32_bf16 v[176:179], v[48:51], v[64:67], v[176:179]
    ds_read_b128 v[104:107], v24 offset:57344
    v_add_u32 v19, 0x10000, v19
    v_mfma_f32_16x16x32_bf16 v[176:179], v[52:55], v[68:71], v[176:179]
    buffer_store_dwordx4 a[60:63], v1, s[36:39], s72 offen sc1
    v_mfma_f32_16x16x32_bf16 v[180:183], v[48:51], v[72:75], v[180:183]
    v_mfma_f32_16x16x32_bf16 v[180:183], v[52:55], v[76:79], v[180:183]
    v_accvgpr_write_b32 a60, 0
    v_accvgpr_write_b32 a61, 0
    v_mfma_f32_16x16x32_bf16 v[184:187], v[48:51], v[80:83], v[184:187]
    v_accvgpr_write_b32 a62, 0
    v_accvgpr_write_b32 a63, 0
    v_mfma_f32_16x16x32_bf16 v[184:187], v[52:55], v[84:87], v[184:187]
    v_mfma_f32_16x16x32_bf16 v[188:191], v[48:51], v[88:91], v[188:191]
    buffer_load_dwordx4 v12, s[20:23], s64 offen offset:2048 lds
    v_mfma_f32_16x16x32_bf16 v[188:191], v[52:55], v[92:95], v[188:191]
    s_waitcnt lgkmcnt(0)
    ds_read_b64_tr_b16 v[48:49], v20 offset:32768
    ds_read_b64_tr_b16 v[50:51], v20 offset:33792
    v_mfma_f32_16x16x32_bf16 v[192:195], v[56:59], v[64:67], v[192:195]
    ds_read_b64_tr_b16 v[52:53], v20 offset:40960
    ds_read_b64_tr_b16 v[54:55], v20 offset:41984
    v_mfma_f32_16x16x32_bf16 v[192:195], v[60:63], v[68:71], v[192:195]
    v_add_u32 v20, 0x10000, v20
    v_mfma_f32_16x16x32_bf16 v[196:199], v[56:59], v[72:75], v[196:199]
    v_mfma_f32_16x16x32_bf16 v[196:199], v[60:63], v[76:79], v[196:199]
    ds_read_b128 v[108:111], v25 offset:57344
    v_mfma_f32_16x16x32_bf16 v[200:203], v[56:59], v[80:83], v[200:203]
    v_accvgpr_read_b32 v32, a128
    v_accvgpr_read_b32 v31, a129
    v_mfma_f32_16x16x32_bf16 v[200:203], v[60:63], v[84:87], v[200:203]
    v_cvt_pk_bf16_f32 v32, v32, v31
    v_accvgpr_read_b32 v33, a130
    v_mfma_f32_16x16x32_bf16 v[204:207], v[56:59], v[88:91], v[204:207]
    ds_read_b64_tr_b16 v[56:57], v21 offset:32768
    ds_read_b64_tr_b16 v[58:59], v21 offset:33792
    v_mfma_f32_16x16x32_bf16 v[204:207], v[60:63], v[92:95], v[204:207]
    ds_read_b64_tr_b16 v[60:61], v21 offset:40960
    ds_read_b64_tr_b16 v[62:63], v21 offset:41984
    v_mfma_f32_16x16x32_bf16 v[208:211], v[40:43], v[64:67], v[208:211]
    buffer_load_dwordx4 v13, s[20:23], s64 offen offset:3072 lds
    v_mfma_f32_16x16x32_bf16 v[208:211], v[44:47], v[68:71], v[208:211]
    v_add_u32 v21, 0x10000, v21
    v_accvgpr_read_b32 v31, a131
    v_mfma_f32_16x16x32_bf16 v[212:215], v[40:43], v[72:75], v[212:215]
    v_cvt_pk_bf16_f32 v33, v33, v31
    v_accvgpr_read_b32 v34, a132
    v_mfma_f32_16x16x32_bf16 v[212:215], v[44:47], v[76:79], v[212:215]
    v_accvgpr_read_b32 v31, a133
    v_cvt_pk_bf16_f32 v34, v34, v31
    v_mfma_f32_16x16x32_bf16 v[216:219], v[40:43], v[80:83], v[216:219]
    v_accvgpr_read_b32 v35, a134
    v_accvgpr_read_b32 v31, a135
    v_mfma_f32_16x16x32_bf16 v[216:219], v[44:47], v[84:87], v[216:219]
    v_cvt_pk_bf16_f32 v35, v35, v31
    v_mfma_f32_16x16x32_bf16 v[220:223], v[40:43], v[88:91], v[220:223]
    ds_read_b64_tr_b16 v[40:41], v26 offset:0
    ds_read_b64_tr_b16 v[42:43], v26 offset:512
    v_mfma_f32_16x16x32_bf16 v[220:223], v[44:47], v[92:95], v[220:223]
    s_add_u32 s72, s71, 0
    ds_read_b64_tr_b16 v[44:45], v26 offset:4096
    ds_read_b64_tr_b16 v[46:47], v26 offset:4608
    s_waitcnt lgkmcnt(4)
    v_mfma_f32_16x16x32_bf16 v[224:227], v[48:51], v[64:67], v[224:227]
    buffer_store_dwordx4 v[32:35], v1, s[36:39], s72 offen sc1
    v_mfma_f32_16x16x32_bf16 v[224:227], v[52:55], v[68:71], v[224:227]
    s_xor_b32 s64, s64, 128
    v_add_u32 v26, 0x10000, v26
    v_mfma_f32_16x16x32_bf16 v[228:231], v[48:51], v[72:75], v[228:231]
    v_mfma_f32_16x16x32_bf16 v[228:231], v[52:55], v[76:79], v[228:231]
    v_mfma_f32_16x16x32_bf16 v[232:235], v[48:51], v[80:83], v[232:235]
    v_mfma_f32_16x16x32_bf16 v[232:235], v[52:55], v[84:87], v[232:235]
    s_add_u32 m0, s69, 0
    v_mfma_f32_16x16x32_bf16 v[236:239], v[48:51], v[88:91], v[236:239]
    buffer_load_dwordx4 v2, s[24:27], s60 offen lds
    v_mfma_f32_16x16x32_bf16 v[236:239], v[52:55], v[92:95], v[236:239]
    ds_read_b64_tr_b16 v[48:49], v27 offset:0
    ds_read_b64_tr_b16 v[50:51], v27 offset:512
    v_mfma_f32_16x16x32_bf16 v[240:243], v[56:59], v[64:67], v[240:243]
    ds_read_b64_tr_b16 v[52:53], v27 offset:4096
    ds_read_b64_tr_b16 v[54:55], v27 offset:4608
    v_mfma_f32_16x16x32_bf16 v[240:243], v[60:63], v[68:71], v[240:243]
    buffer_load_dwordx4 v3, s[24:27], s60 offen offset:1024 lds
    v_mfma_f32_16x16x32_bf16 v[244:247], v[56:59], v[72:75], v[244:247]
    v_add_u32 v27, 0x10000, v27
    v_mfma_f32_16x16x32_bf16 v[244:247], v[60:63], v[76:79], v[244:247]
    v_mfma_f32_16x16x32_bf16 v[248:251], v[56:59], v[80:83], v[248:251]
    v_accvgpr_read_b32 v32, a136
    v_accvgpr_read_b32 v31, a137
    v_mfma_f32_16x16x32_bf16 v[248:251], v[60:63], v[84:87], v[248:251]
    buffer_load_dwordx4 v4, s[24:27], s60 offen offset:2048 lds
    v_mfma_f32_16x16x32_bf16 v[252:255], v[56:59], v[88:91], v[252:255]
    ds_read_b64_tr_b16 v[56:57], v28 offset:0
    ds_read_b64_tr_b16 v[58:59], v28 offset:512
    v_mfma_f32_16x16x32_bf16 v[252:255], v[60:63], v[92:95], v[252:255]
    s_waitcnt lgkmcnt(2)
    ds_read_b64_tr_b16 v[60:61], v28 offset:4096
    ds_read_b64_tr_b16 v[62:63], v28 offset:4608
    v_mfma_f32_16x16x32_bf16 a[64:67], v[40:43], v[64:67], a[64:67]
    buffer_load_dwordx4 v5, s[24:27], s60 offen offset:3072 lds
    v_mfma_f32_16x16x32_bf16 a[64:67], v[44:47], v[68:71], a[64:67]
    v_add_u32 v24, 0x10000, v24
    v_add_u32 v28, 0x10000, v28
    v_mfma_f32_16x16x32_bf16 a[68:71], v[40:43], v[72:75], a[68:71]
    ds_read_b128 v[112:115], v24 offset:16384
    v_cvt_pk_bf16_f32 v32, v32, v31
    v_mfma_f32_16x16x32_bf16 a[68:71], v[44:47], v[76:79], a[68:71]
    s_add_u32 m0, s69, 16384
    v_accvgpr_read_b32 v33, a138
    v_accvgpr_read_b32 v31, a139
    v_mfma_f32_16x16x32_bf16 a[72:75], v[40:43], v[80:83], a[72:75]
    s_xor_b32 s60, s60, 524288
    v_add_u32 v25, 0x10000, v25
    v_cvt_pk_bf16_f32 v33, v33, v31
    v_mfma_f32_16x16x32_bf16 a[72:75], v[44:47], v[84:87], a[72:75]
    buffer_load_dwordx4 v10, s[20:23], s63 offen lds
    v_mfma_f32_16x16x32_bf16 a[76:79], v[40:43], v[88:91], a[76:79]
    ds_read_b128 v[116:119], v25 offset:16384
    ds_read_b64_tr_b16 v[40:41], v29 offset:0
    v_mfma_f32_16x16x32_bf16 a[76:79], v[44:47], v[92:95], a[76:79]
    s_add_u32 s72, s71, 1024
    buffer_load_dwordx4 v11, s[20:23], s63 offen offset:1024 lds
    v_mfma_f32_16x16x32_bf16 a[80:83], v[48:51], v[64:67], a[80:83]
    ds_read_b128 v[120:123], v24 offset:24576
    ds_read_b64_tr_b16 v[42:43], v29 offset:512
    v_mfma_f32_16x16x32_bf16 a[80:83], v[52:55], v[68:71], a[80:83]
    ds_read_b64_tr_b16 v[44:45], v29 offset:4096
    ds_read_b64_tr_b16 v[46:47], v29 offset:4608
    v_mfma_f32_16x16x32_bf16 a[84:87], v[48:51], v[72:75], a[84:87]
    v_add_u32 v29, 0x10000, v29
    v_accvgpr_read_b32 v34, a140
    v_mfma_f32_16x16x32_bf16 a[84:87], v[52:55], v[76:79], a[84:87]
    buffer_load_dwordx4 v12, s[20:23], s63 offen offset:2048 lds
    v_mfma_f32_16x16x32_bf16 a[88:91], v[48:51], v[80:83], a[88:91]
    ds_read_b128 v[124:127], v25 offset:24576
    v_accvgpr_read_b32 v31, a141
    v_mfma_f32_16x16x32_bf16 a[88:91], v[52:55], v[84:87], a[88:91]
    v_cvt_pk_bf16_f32 v34, v34, v31
    v_accvgpr_read_b32 v35, a142
    v_mfma_f32_16x16x32_bf16 a[92:95], v[48:51], v[88:91], a[92:95]
    buffer_load_dwordx4 v13, s[20:23], s63 offen offset:3072 lds
    v_mfma_f32_16x16x32_bf16 a[92:95], v[52:55], v[92:95], a[92:95]
    s_waitcnt lgkmcnt(1)
    v_accvgpr_read_b32 v31, a143
    v_cvt_pk_bf16_f32 v35, v35, v31
    v_mfma_f32_16x16x32_bf16 a[96:99], v[56:59], v[64:67], a[96:99]
    v_mfma_f32_16x16x32_bf16 a[96:99], v[60:63], v[68:71], a[96:99]
    s_xor_b32 s63, s63, 384
    v_mfma_f32_16x16x32_bf16 a[100:103], v[56:59], v[72:75], a[100:103]
    buffer_store_dwordx4 v[32:35], v1, s[36:39], s72 offen sc1
    v_mfma_f32_16x16x32_bf16 a[100:103], v[60:63], v[76:79], a[100:103]
    v_mfma_f32_16x16x32_bf16 a[104:107], v[56:59], v[80:83], a[104:107]
    v_accvgpr_read_b32 v32, a144
    v_accvgpr_read_b32 v31, a145
    v_mfma_f32_16x16x32_bf16 a[104:107], v[60:63], v[84:87], a[104:107]
    s_waitcnt vmcnt(10) lgkmcnt(0)
    s_barrier
    ds_read_b64_tr_b16 v[48:49], v14 offset:32768
    v_mfma_f32_16x16x32_bf16 a[108:111], v[56:59], v[88:91], a[108:111]
    s_add_u32 m0, s67, 32768
    ds_read_b64_tr_b16 v[50:51], v14 offset:33792
    ds_read_b64_tr_b16 v[52:53], v14 offset:40960
    v_mfma_f32_16x16x32_bf16 a[108:111], v[60:63], v[92:95], a[108:111]
    buffer_load_dwordx4 v1, s[28:31], s65 offen sc1 lds
    v_mfma_f32_16x16x32_bf16 a[112:115], v[40:43], v[64:67], a[112:115]
    ds_read_b64_tr_b16 v[54:55], v14 offset:41984
    ds_read_b64_tr_b16 v[56:57], v15 offset:32768
    v_mfma_f32_16x16x32_bf16 a[112:115], v[44:47], v[68:71], a[112:115]
    ds_read_b64_tr_b16 v[58:59], v15 offset:33792
    ds_read_b64_tr_b16 v[60:61], v15 offset:40960
    v_mfma_f32_16x16x32_bf16 a[116:119], v[40:43], v[72:75], a[116:119]
    ds_read_b64_tr_b16 v[62:63], v15 offset:41984
    v_add_u32 v14, 0xffff0000, v14
    v_mfma_f32_16x16x32_bf16 a[116:119], v[44:47], v[76:79], a[116:119]
    v_add_u32 v15, 0xffff0000, v15
    v_cvt_pk_bf16_f32 v32, v32, v31
    v_mfma_f32_16x16x32_bf16 a[120:123], v[40:43], v[80:83], a[120:123]
    v_accvgpr_read_b32 v33, a146
    v_accvgpr_read_b32 v31, a147
    v_mfma_f32_16x16x32_bf16 a[120:123], v[44:47], v[84:87], a[120:123]
    v_cvt_pk_bf16_f32 v33, v33, v31
    v_accvgpr_read_b32 v34, a148
    v_mfma_f32_16x16x32_bf16 a[124:127], v[40:43], v[88:91], a[124:127]
    ds_read_b64_tr_b16 v[40:41], v16 offset:32768
    ds_read_b64_tr_b16 v[42:43], v16 offset:33792
    v_mfma_f32_16x16x32_bf16 a[124:127], v[44:47], v[92:95], a[124:127]
    s_add_u32 s72, s71, 32768
    ds_read_b64_tr_b16 v[44:45], v16 offset:40960
    ds_read_b64_tr_b16 v[46:47], v16 offset:41984
    s_waitcnt lgkmcnt(4)
    v_mfma_f32_16x16x32_bf16 v[128:131], v[48:51], v[96:99], v[128:131]
    buffer_load_dwordx4 v1, s[28:31], s65 offen offset:1024 sc1 lds
    v_mfma_f32_16x16x32_bf16 v[128:131], v[52:55], v[100:103], v[128:131]
    v_add_u32 v16, 0xffff0000, v16
    v_accvgpr_read_b32 v31, a149
    v_mfma_f32_16x16x32_bf16 v[132:135], v[48:51], v[104:107], v[132:135]
    ds_read_b128 v[64:67], v24 offset:49152
    v_cvt_pk_bf16_f32 v34, v34, v31
    v_mfma_f32_16x16x32_bf16 v[132:135], v[52:55], v[108:111], v[132:135]
    v_accvgpr_read_b32 v35, a150
    v_accvgpr_read_b32 v31, a151
    v_mfma_f32_16x16x32_bf16 v[136:139], v[48:51], v[112:115], v[136:139]
    v_cvt_pk_bf16_f32 v35, v35, v31
    v_accvgpr_write_b32 a144, 0
    v_mfma_f32_16x16x32_bf16 v[136:139], v[52:55], v[116:119], v[136:139]
    buffer_store_dwordx4 v[32:35], v1, s[36:39], s72 offen sc1
    v_mfma_f32_16x16x32_bf16 v[140:143], v[48:51], v[120:123], v[140:143]
    ds_read_b64_tr_b16 v[48:49], v17 offset:32768
    ds_read_b64_tr_b16 v[50:51], v17 offset:33792
    v_mfma_f32_16x16x32_bf16 v[140:143], v[52:55], v[124:127], v[140:143]
    ds_read_b64_tr_b16 v[52:53], v17 offset:40960
    ds_read_b64_tr_b16 v[54:55], v17 offset:41984
    v_mfma_f32_16x16x32_bf16 v[144:147], v[56:59], v[96:99], v[144:147]
    v_add_u32 v17, 0xffff0000, v17
    v_accvgpr_write_b32 a145, 0
    v_mfma_f32_16x16x32_bf16 v[144:147], v[60:63], v[100:103], v[144:147]
    s_add_u32 m0, s69, 49152
    v_accvgpr_write_b32 a146, 0
    v_accvgpr_write_b32 a147, 0
    v_mfma_f32_16x16x32_bf16 v[148:151], v[56:59], v[104:107], v[148:151]
    s_xor_b32 s65, s65, 8192
    buffer_load_dwordx4 v10, s[20:23], s64 offen lds
    v_mfma_f32_16x16x32_bf16 v[148:151], v[60:63], v[108:111], v[148:151]
    v_accvgpr_write_b32 a148, 0
    v_accvgpr_write_b32 a149, 0
    v_mfma_f32_16x16x32_bf16 v[152:155], v[56:59], v[112:115], v[152:155]
    v_accvgpr_read_b32 v32, a152
    v_accvgpr_read_b32 v31, a153
    v_mfma_f32_16x16x32_bf16 v[152:155], v[60:63], v[116:119], v[152:155]
    ds_read_b128 v[68:71], v25 offset:49152
    v_cvt_pk_bf16_f32 v32, v32, v31
    v_mfma_f32_16x16x32_bf16 v[156:159], v[56:59], v[120:123], v[156:159]
    ds_read_b64_tr_b16 v[56:57], v18 offset:32768
    ds_read_b64_tr_b16 v[58:59], v18 offset:33792
    v_mfma_f32_16x16x32_bf16 v[156:159], v[60:63], v[124:127], v[156:159]
    s_waitcnt lgkmcnt(3)
    ds_read_b64_tr_b16 v[60:61], v18 offset:40960
    ds_read_b64_tr_b16 v[62:63], v18 offset:41984
    v_mfma_f32_16x16x32_bf16 v[160:163], v[40:43], v[96:99], v[160:163]
    v_add_u32 v18, 0xffff0000, v18
    v_accvgpr_read_b32 v33, a154
    v_mfma_f32_16x16x32_bf16 v[160:163], v[44:47], v[100:103], v[160:163]
    v_accvgpr_read_b32 v31, a155
    v_cvt_pk_bf16_f32 v33, v33, v31
    v_mfma_f32_16x16x32_bf16 v[164:167], v[40:43], v[104:107], v[164:167]
    v_accvgpr_read_b32 v34, a156
    v_accvgpr_read_b32 v31, a157
    v_mfma_f32_16x16x32_bf16 v[164:167], v[44:47], v[108:111], v[164:167]
    v_cvt_pk_bf16_f32 v34, v34, v31
    v_accvgpr_read_b32 v35, a158
    v_mfma_f32_16x16x32_bf16 v[168:171], v[40:43], v[112:115], v[168:171]
    buffer_load_dwordx4 v11, s[20:23], s64 offen offset:1024 lds
    v_mfma_f32_16x16x32_bf16 v[168:171], v[44:47], v[116:119], v[168:171]
    v_accvgpr_read_b32 v31, a159
    v_cvt_pk_bf16_f32 v35, v35, v31
    v_mfma_f32_16x16x32_bf16 v[172:175], v[40:43], v[120:123], v[172:175]
    ds_read_b64_tr_b16 v[40:41], v19 offset:32768
    ds_read_b64_tr_b16 v[42:43], v19 offset:33792
    v_mfma_f32_16x16x32_bf16 v[172:175], v[44:47], v[124:127], v[172:175]
    s_add_u32 s72, s71, 33792
    ds_read_b64_tr_b16 v[44:45], v19 offset:40960
    ds_read_b64_tr_b16 v[46:47], v19 offset:41984
    v_mfma_f32_16x16x32_bf16 v[176:179], v[48:51], v[96:99], v[176:179]
    ds_read_b128 v[72:75], v24 offset:57344
    v_add_u32 v19, 0xffff0000, v19
    v_mfma_f32_16x16x32_bf16 v[176:179], v[52:55], v[100:103], v[176:179]
    buffer_store_dwordx4 v[32:35], v1, s[36:39], s72 offen sc1
    v_mfma_f32_16x16x32_bf16 v[180:183], v[48:51], v[104:107], v[180:183]
    v_accvgpr_write_b32 a150, 0
    v_accvgpr_write_b32 a151, 0
    v_mfma_f32_16x16x32_bf16 v[180:183], v[52:55], v[108:111], v[180:183]
    v_accvgpr_write_b32 a152, 0
    v_accvgpr_write_b32 a153, 0
    v_mfma_f32_16x16x32_bf16 v[184:187], v[48:51], v[112:115], v[184:187]
    v_accvgpr_write_b32 a154, 0
    v_accvgpr_write_b32 a155, 0
    v_mfma_f32_16x16x32_bf16 v[184:187], v[52:55], v[116:119], v[184:187]
    v_accvgpr_write_b32 a156, 0
    v_accvgpr_write_b32 a157, 0
    v_mfma_f32_16x16x32_bf16 v[188:191], v[48:51], v[120:123], v[188:191]
    buffer_load_dwordx4 v12, s[20:23], s64 offen offset:2048 lds
    v_mfma_f32_16x16x32_bf16 v[188:191], v[52:55], v[124:127], v[188:191]
    s_waitcnt lgkmcnt(0)
    ds_read_b64_tr_b16 v[48:49], v20 offset:32768
    ds_read_b64_tr_b16 v[50:51], v20 offset:33792
    v_mfma_f32_16x16x32_bf16 v[192:195], v[56:59], v[96:99], v[192:195]
    ds_read_b64_tr_b16 v[52:53], v20 offset:40960
    ds_read_b64_tr_b16 v[54:55], v20 offset:41984
    v_mfma_f32_16x16x32_bf16 v[192:195], v[60:63], v[100:103], v[192:195]
    v_add_u32 v20, 0xffff0000, v20
    v_accvgpr_write_b32 a158, 0
    v_mfma_f32_16x16x32_bf16 v[196:199], v[56:59], v[104:107], v[196:199]
    v_accvgpr_write_b32 a159, 0
    v_mfma_f32_16x16x32_bf16 v[196:199], v[60:63], v[108:111], v[196:199]
    ds_read_b128 v[76:79], v25 offset:57344
    v_mfma_f32_16x16x32_bf16 v[200:203], v[56:59], v[112:115], v[200:203]
    v_accvgpr_read_b32 v32, a160
    v_accvgpr_read_b32 v31, a161
    v_mfma_f32_16x16x32_bf16 v[200:203], v[60:63], v[116:119], v[200:203]
    v_cvt_pk_bf16_f32 v32, v32, v31
    v_accvgpr_read_b32 v33, a162
    v_mfma_f32_16x16x32_bf16 v[204:207], v[56:59], v[120:123], v[204:207]
    ds_read_b64_tr_b16 v[56:57], v21 offset:32768
    ds_read_b64_tr_b16 v[58:59], v21 offset:33792
    v_mfma_f32_16x16x32_bf16 v[204:207], v[60:63], v[124:127], v[204:207]
    ds_read_b64_tr_b16 v[60:61], v21 offset:40960
    ds_read_b64_tr_b16 v[62:63], v21 offset:41984
    v_mfma_f32_16x16x32_bf16 v[208:211], v[40:43], v[96:99], v[208:211]
    buffer_load_dwordx4 v13, s[20:23], s64 offen offset:3072 lds
    v_mfma_f32_16x16x32_bf16 v[208:211], v[44:47], v[100:103], v[208:211]
    v_add_u32 v21, 0xffff0000, v21
    v_accvgpr_read_b32 v31, a163
    v_mfma_f32_16x16x32_bf16 v[212:215], v[40:43], v[104:107], v[212:215]
    v_cvt_pk_bf16_f32 v33, v33, v31
    v_accvgpr_read_b32 v34, a164
    v_mfma_f32_16x16x32_bf16 v[212:215], v[44:47], v[108:111], v[212:215]
    v_accvgpr_read_b32 v31, a165
    v_cvt_pk_bf16_f32 v34, v34, v31
    v_mfma_f32_16x16x32_bf16 v[216:219], v[40:43], v[112:115], v[216:219]
    v_accvgpr_read_b32 v35, a166
    v_accvgpr_read_b32 v31, a167
    v_mfma_f32_16x16x32_bf16 v[216:219], v[44:47], v[116:119], v[216:219]
    v_cvt_pk_bf16_f32 v35, v35, v31
    v_accvgpr_write_b32 a160, 0
    v_mfma_f32_16x16x32_bf16 v[220:223], v[40:43], v[120:123], v[220:223]
    ds_read_b64_tr_b16 v[40:41], v26 offset:0
    ds_read_b64_tr_b16 v[42:43], v26 offset:512
    v_mfma_f32_16x16x32_bf16 v[220:223], v[44:47], v[124:127], v[220:223]
    s_add_u32 s72, s71, 2048
    ds_read_b64_tr_b16 v[44:45], v26 offset:4096
    ds_read_b64_tr_b16 v[46:47], v26 offset:4608
    s_waitcnt lgkmcnt(4)
    v_mfma_f32_16x16x32_bf16 v[224:227], v[48:51], v[96:99], v[224:227]
    v_add_u32 v26, 0xfffe0000, v26
    v_accvgpr_write_b32 a161, 0
    v_mfma_f32_16x16x32_bf16 v[224:227], v[52:55], v[100:103], v[224:227]
    s_xor_b32 s64, s64, 384
    buffer_store_dwordx4 v[32:35], v1, s[36:39], s72 offen sc1
    v_mfma_f32_16x16x32_bf16 v[228:231], v[48:51], v[104:107], v[228:231]
    v_accvgpr_write_b32 a162, 0
    v_accvgpr_write_b32 a163, 0
    v_mfma_f32_16x16x32_bf16 v[228:231], v[52:55], v[108:111], v[228:231]
    v_accvgpr_write_b32 a164, 0
    v_accvgpr_write_b32 a165, 0
    v_mfma_f32_16x16x32_bf16 v[232:235], v[48:51], v[112:115], v[232:235]
    v_accvgpr_write_b32 a166, 0
    v_accvgpr_write_b32 a167, 0
    v_mfma_f32_16x16x32_bf16 v[232:235], v[52:55], v[116:119], v[232:235]
    s_add_u32 m0, s69, 65536
    v_mfma_f32_16x16x32_bf16 v[236:239], v[48:51], v[120:123], v[236:239]
    buffer_load_dwordx4 v2, s[24:27], s60 offen lds
    v_mfma_f32_16x16x32_bf16 v[236:239], v[52:55], v[124:127], v[236:239]
    ds_read_b64_tr_b16 v[48:49], v27 offset:0
    ds_read_b64_tr_b16 v[50:51], v27 offset:512
    v_mfma_f32_16x16x32_bf16 v[240:243], v[56:59], v[96:99], v[240:243]
    ds_read_b64_tr_b16 v[52:53], v27 offset:4096
    ds_read_b64_tr_b16 v[54:55], v27 offset:4608
    v_mfma_f32_16x16x32_bf16 v[240:243], v[60:63], v[100:103], v[240:243]
    buffer_load_dwordx4 v3, s[24:27], s60 offen offset:1024 lds
    v_mfma_f32_16x16x32_bf16 v[244:247], v[56:59], v[104:107], v[244:247]
    v_add_u32 v27, 0xfffe0000, v27
    v_mfma_f32_16x16x32_bf16 v[244:247], v[60:63], v[108:111], v[244:247]
    v_mfma_f32_16x16x32_bf16 v[248:251], v[56:59], v[112:115], v[248:251]
    v_accvgpr_read_b32 v32, a168
    v_accvgpr_read_b32 v31, a169
    v_mfma_f32_16x16x32_bf16 v[248:251], v[60:63], v[116:119], v[248:251]
    buffer_load_dwordx4 v4, s[24:27], s60 offen offset:2048 lds
    v_mfma_f32_16x16x32_bf16 v[252:255], v[56:59], v[120:123], v[252:255]
    ds_read_b64_tr_b16 v[56:57], v28 offset:0
    ds_read_b64_tr_b16 v[58:59], v28 offset:512
    v_mfma_f32_16x16x32_bf16 v[252:255], v[60:63], v[124:127], v[252:255]
    s_waitcnt lgkmcnt(2)
    ds_read_b64_tr_b16 v[60:61], v28 offset:4096
    ds_read_b64_tr_b16 v[62:63], v28 offset:4608
    v_mfma_f32_16x16x32_bf16 a[64:67], v[40:43], v[96:99], a[64:67]
    buffer_load_dwordx4 v5, s[24:27], s60 offen offset:3072 lds
    v_mfma_f32_16x16x32_bf16 a[64:67], v[44:47], v[100:103], a[64:67]
    v_add_u32 v24, 0x10000, v24
    v_add_u32 v28, 0xfffe0000, v28
    v_mfma_f32_16x16x32_bf16 a[68:71], v[40:43], v[104:107], a[68:71]
    ds_read_b128 v[80:83], v24 offset:16384
    v_cvt_pk_bf16_f32 v32, v32, v31
    v_mfma_f32_16x16x32_bf16 a[68:71], v[44:47], v[108:111], a[68:71]
    s_add_u32 m0, s69, 81920
    v_accvgpr_read_b32 v33, a170
    v_accvgpr_read_b32 v31, a171
    v_mfma_f32_16x16x32_bf16 a[72:75], v[40:43], v[112:115], a[72:75]
    s_xor_b32 s60, s60, 1572864
    v_add_u32 v25, 0x10000, v25
    v_cvt_pk_bf16_f32 v33, v33, v31
    v_mfma_f32_16x16x32_bf16 a[72:75], v[44:47], v[116:119], a[72:75]
    buffer_load_dwordx4 v10, s[20:23], s63 offen lds
    v_mfma_f32_16x16x32_bf16 a[76:79], v[40:43], v[120:123], a[76:79]
    ds_read_b128 v[84:87], v25 offset:16384
    ds_read_b64_tr_b16 v[40:41], v29 offset:0
    v_mfma_f32_16x16x32_bf16 a[76:79], v[44:47], v[124:127], a[76:79]
    s_add_u32 s72, s71, 3072
    buffer_load_dwordx4 v11, s[20:23], s63 offen offset:1024 lds
    v_mfma_f32_16x16x32_bf16 a[80:83], v[48:51], v[96:99], a[80:83]
    ds_read_b128 v[88:91], v24 offset:24576
    ds_read_b64_tr_b16 v[42:43], v29 offset:512
    v_mfma_f32_16x16x32_bf16 a[80:83], v[52:55], v[100:103], a[80:83]
    ds_read_b64_tr_b16 v[44:45], v29 offset:4096
    ds_read_b64_tr_b16 v[46:47], v29 offset:4608
    v_mfma_f32_16x16x32_bf16 a[84:87], v[48:51], v[104:107], a[84:87]
    v_add_u32 v29, 0xfffe0000, v29
    v_accvgpr_read_b32 v34, a172
    v_mfma_f32_16x16x32_bf16 a[84:87], v[52:55], v[108:111], a[84:87]
    buffer_load_dwordx4 v12, s[20:23], s63 offen offset:2048 lds
    v_mfma_f32_16x16x32_bf16 a[88:91], v[48:51], v[112:115], a[88:91]
    ds_read_b128 v[92:95], v25 offset:24576
    v_accvgpr_read_b32 v31, a173
    v_mfma_f32_16x16x32_bf16 a[88:91], v[52:55], v[116:119], a[88:91]
    v_cvt_pk_bf16_f32 v34, v34, v31
    v_accvgpr_read_b32 v35, a174
    v_mfma_f32_16x16x32_bf16 a[92:95], v[48:51], v[120:123], a[92:95]
    buffer_load_dwordx4 v13, s[20:23], s63 offen offset:3072 lds
    v_mfma_f32_16x16x32_bf16 a[92:95], v[52:55], v[124:127], a[92:95]
    s_waitcnt lgkmcnt(1)
    v_accvgpr_read_b32 v31, a175
    v_cvt_pk_bf16_f32 v35, v35, v31
    v_mfma_f32_16x16x32_bf16 a[96:99], v[56:59], v[96:99], a[96:99]
    v_accvgpr_write_b32 a168, 0
    v_accvgpr_write_b32 a169, 0
    v_mfma_f32_16x16x32_bf16 a[96:99], v[60:63], v[100:103], a[96:99]
    s_xor_b32 s63, s63, 128
    v_accvgpr_write_b32 a170, 0
    v_accvgpr_write_b32 a171, 0
    v_mfma_f32_16x16x32_bf16 a[100:103], v[56:59], v[104:107], a[100:103]
    buffer_store_dwordx4 v[32:35], v1, s[36:39], s72 offen sc1
    v_mfma_f32_16x16x32_bf16 a[100:103], v[60:63], v[108:111], a[100:103]
    v_accvgpr_write_b32 a172, 0
    v_accvgpr_write_b32 a173, 0
    v_mfma_f32_16x16x32_bf16 a[104:107], v[56:59], v[112:115], a[104:107]
    v_accvgpr_read_b32 v32, a176
    v_accvgpr_read_b32 v31, a177
    v_mfma_f32_16x16x32_bf16 a[104:107], v[60:63], v[116:119], a[104:107]
    s_waitcnt vmcnt(10) lgkmcnt(0)
    s_barrier
    ds_read_b64_tr_b16 v[48:49], v14 offset:0
    v_mfma_f32_16x16x32_bf16 a[108:111], v[56:59], v[120:123], a[108:111]
    s_add_u32 m0, s67, 98304
    ds_read_b64_tr_b16 v[50:51], v14 offset:1024
    ds_read_b64_tr_b16 v[52:53], v14 offset:8192
    v_mfma_f32_16x16x32_bf16 a[108:111], v[60:63], v[124:127], a[108:111]
    buffer_load_dwordx4 v1, s[28:31], s65 offen sc1 lds
    v_mfma_f32_16x16x32_bf16 a[112:115], v[40:43], v[96:99], a[112:115]
    ds_read_b64_tr_b16 v[54:55], v14 offset:9216
    ds_read_b64_tr_b16 v[56:57], v15 offset:0
    v_mfma_f32_16x16x32_bf16 a[112:115], v[44:47], v[100:103], a[112:115]
    ds_read_b64_tr_b16 v[58:59], v15 offset:1024
    ds_read_b64_tr_b16 v[60:61], v15 offset:8192
    v_mfma_f32_16x16x32_bf16 a[116:119], v[40:43], v[104:107], a[116:119]
    ds_read_b64_tr_b16 v[62:63], v15 offset:9216
    v_add_u32 v14, 0x10000, v14
    v_mfma_f32_16x16x32_bf16 a[116:119], v[44:47], v[108:111], a[116:119]
    v_add_u32 v15, 0x10000, v15
    v_cvt_pk_bf16_f32 v32, v32, v31
    v_mfma_f32_16x16x32_bf16 a[120:123], v[40:43], v[112:115], a[120:123]
    v_accvgpr_read_b32 v33, a178
    v_accvgpr_read_b32 v31, a179
    v_mfma_f32_16x16x32_bf16 a[120:123], v[44:47], v[116:119], a[120:123]
    v_cvt_pk_bf16_f32 v33, v33, v31
    v_accvgpr_read_b32 v34, a180
    v_mfma_f32_16x16x32_bf16 a[124:127], v[40:43], v[120:123], a[124:127]
    ds_read_b64_tr_b16 v[40:41], v16 offset:0
    ds_read_b64_tr_b16 v[42:43], v16 offset:1024
    v_mfma_f32_16x16x32_bf16 a[124:127], v[44:47], v[124:127], a[124:127]
    s_add_u32 s72, s71, 34816
    ds_read_b64_tr_b16 v[44:45], v16 offset:8192
    ds_read_b64_tr_b16 v[46:47], v16 offset:9216
    s_waitcnt lgkmcnt(4)
    v_mfma_f32_16x16x32_bf16 v[128:131], v[48:51], v[64:67], v[128:131]
    s_add_u32 s86, s101, 4096
    buffer_load_dwordx4 v1, s[28:31], s65 offen offset:1024 sc1 lds
    v_mfma_f32_16x16x32_bf16 v[128:131], v[52:55], v[68:71], v[128:131]
    s_mov_b32 s87, 3072
    v_add_u32 v24, 0xfffe0000, v24
    v_add_u32 v16, 0x10000, v16
    v_mfma_f32_16x16x32_bf16 v[132:135], v[48:51], v[72:75], v[132:135]
    s_sub_u32 s7, s101, 4096
    ds_read_b128 v[96:99], v24 offset:16384
    v_accvgpr_read_b32 v31, a181
    v_mfma_f32_16x16x32_bf16 v[132:135], v[52:55], v[76:79], v[132:135]
    s_mov_b32 s98, 0
    v_cvt_pk_bf16_f32 v34, v34, v31
    v_accvgpr_read_b32 v35, a182
    v_mfma_f32_16x16x32_bf16 v[136:139], v[48:51], v[80:83], v[136:139]
    s_mul_i32 s84, s101, 48
    v_accvgpr_read_b32 v31, a183
    v_cvt_pk_bf16_f32 v35, v35, v31
    v_mfma_f32_16x16x32_bf16 v[136:139], v[52:55], v[84:87], v[136:139]
    s_add_u32 s84, s84, 19922944
    buffer_store_dwordx4 v[32:35], v1, s[36:39], s72 offen sc1
    v_mfma_f32_16x16x32_bf16 v[140:143], v[48:51], v[88:91], v[140:143]
    s_mov_b32 s42, 21495808
    ds_read_b64_tr_b16 v[48:49], v17 offset:0
    ds_read_b64_tr_b16 v[50:51], v17 offset:1024
    v_mfma_f32_16x16x32_bf16 v[140:143], v[52:55], v[92:95], v[140:143]
    s_mov_b32 s43, 0x20000
    ds_read_b64_tr_b16 v[52:53], v17 offset:8192
    ds_read_b64_tr_b16 v[54:55], v17 offset:9216
    v_mfma_f32_16x16x32_bf16 v[144:147], v[56:59], v[64:67], v[144:147]
    v_add_u32 v17, 0x10000, v17
    v_accvgpr_write_b32 a174, 0
    v_mfma_f32_16x16x32_bf16 v[144:147], v[60:63], v[68:71], v[144:147]
    s_add_u32 m0, s69, 114688
    v_accvgpr_write_b32 a175, 0
    v_accvgpr_write_b32 a176, 0
    v_mfma_f32_16x16x32_bf16 v[148:151], v[56:59], v[72:75], v[148:151]
    s_xor_b32 s65, s65, 24576
    buffer_load_dwordx4 v10, s[20:23], s64 offen lds
    v_mfma_f32_16x16x32_bf16 v[148:151], v[60:63], v[76:79], v[148:151]
    s_cmp_eq_u32 s6, 7
    s_cselect_b32 s86, s101, s86
    s_cselect_b32 s87, 0, s87
    v_mfma_f32_16x16x32_bf16 v[152:155], v[56:59], v[80:83], v[152:155]
    v_add_u32 v25, 0xfffe0000, v25
    v_accvgpr_read_b32 v32, a184
    v_mfma_f32_16x16x32_bf16 v[152:155], v[60:63], v[84:87], v[152:155]
    ds_read_b128 v[100:103], v25 offset:16384
    v_accvgpr_read_b32 v31, a185
    v_mfma_f32_16x16x32_bf16 v[156:159], v[56:59], v[88:91], v[156:159]
    ds_read_b64_tr_b16 v[56:57], v18 offset:0
    ds_read_b64_tr_b16 v[58:59], v18 offset:1024
    v_mfma_f32_16x16x32_bf16 v[156:159], v[60:63], v[92:95], v[156:159]
    s_waitcnt lgkmcnt(3)
    ds_read_b64_tr_b16 v[60:61], v18 offset:8192
    ds_read_b64_tr_b16 v[62:63], v18 offset:9216
    v_mfma_f32_16x16x32_bf16 v[160:163], v[40:43], v[64:67], v[160:163]
    v_add_u32 v18, 0x10000, v18
    v_cvt_pk_bf16_f32 v32, v32, v31
    v_mfma_f32_16x16x32_bf16 v[160:163], v[44:47], v[68:71], v[160:163]
    v_accvgpr_read_b32 v33, a186
    v_accvgpr_read_b32 v31, a187
    v_mfma_f32_16x16x32_bf16 v[164:167], v[40:43], v[72:75], v[164:167]
    v_cvt_pk_bf16_f32 v33, v33, v31
    v_accvgpr_read_b32 v34, a188
    v_mfma_f32_16x16x32_bf16 v[164:167], v[44:47], v[76:79], v[164:167]
    v_accvgpr_read_b32 v31, a189
    v_cvt_pk_bf16_f32 v34, v34, v31
    v_mfma_f32_16x16x32_bf16 v[168:171], v[40:43], v[80:83], v[168:171]
    buffer_load_dwordx4 v11, s[20:23], s64 offen offset:1024 lds
    v_mfma_f32_16x16x32_bf16 v[168:171], v[44:47], v[84:87], v[168:171]
    v_accvgpr_read_b32 v35, a190
    v_accvgpr_read_b32 v31, a191
    v_mfma_f32_16x16x32_bf16 v[172:175], v[40:43], v[88:91], v[172:175]
    ds_read_b64_tr_b16 v[40:41], v19 offset:0
    ds_read_b64_tr_b16 v[42:43], v19 offset:1024
    v_mfma_f32_16x16x32_bf16 v[172:175], v[44:47], v[92:95], v[172:175]
    s_add_u32 s72, s71, 35840
    ds_read_b64_tr_b16 v[44:45], v19 offset:8192
    ds_read_b64_tr_b16 v[46:47], v19 offset:9216
    v_mfma_f32_16x16x32_bf16 v[176:179], v[48:51], v[64:67], v[176:179]
    ds_read_b128 v[104:107], v24 offset:24576
    v_add_u32 v19, 0x10000, v19
    v_mfma_f32_16x16x32_bf16 v[176:179], v[52:55], v[68:71], v[176:179]
    v_cvt_pk_bf16_f32 v35, v35, v31
    v_accvgpr_write_b32 a177, 0
    v_mfma_f32_16x16x32_bf16 v[180:183], v[48:51], v[72:75], v[180:183]
    buffer_store_dwordx4 v[32:35], v1, s[36:39], s72 offen sc1
    v_mfma_f32_16x16x32_bf16 v[180:183], v[52:55], v[76:79], v[180:183]
    s_cmp_eq_u32 s6, 0
    s_cselect_b32 s7, s101, s7
    s_cselect_b32 s98, 1073741824, s98
    v_mfma_f32_16x16x32_bf16 v[184:187], v[48:51], v[80:83], v[184:187]
    s_bitcmp1_b32 s4, 0
    s_cselect_b32 s86, s86, s7
    s_cselect_b32 s87, s87, s98
    v_mfma_f32_16x16x32_bf16 v[184:187], v[52:55], v[84:87], v[184:187]
    s_mul_i32 s7, s86, 48
    v_accvgpr_write_b32 a178, 0
    v_accvgpr_write_b32 a179, 0
    v_mfma_f32_16x16x32_bf16 v[188:191], v[48:51], v[88:91], v[188:191]
    s_add_u32 s87, s87, s7
    buffer_load_dwordx4 v12, s[20:23], s64 offen offset:2048 lds
    v_mfma_f32_16x16x32_bf16 v[188:191], v[52:55], v[92:95], v[188:191]
    s_and_b32 s7, s5, 24
    ds_read_b64_tr_b16 v[48:49], v20 offset:0
    ds_read_b64_tr_b16 v[50:51], v20 offset:1024
    s_waitcnt lgkmcnt(2)
    v_mfma_f32_16x16x32_bf16 v[192:195], v[56:59], v[64:67], v[192:195]
    s_add_u32 s7, s7, s6
    ds_read_b64_tr_b16 v[52:53], v20 offset:8192
    ds_read_b64_tr_b16 v[54:55], v20 offset:9216
    v_mfma_f32_16x16x32_bf16 v[192:195], v[60:63], v[68:71], v[192:195]
    s_bfe_u32 s98, s5, 0x20001
    v_add_u32 v20, 0x10000, v20
    v_accvgpr_write_b32 a180, 0
    v_mfma_f32_16x16x32_bf16 v[196:199], v[56:59], v[72:75], v[196:199]
    s_lshl2_add_u32 s7, s7, s98
    v_accvgpr_write_b32 a181, 0
    v_accvgpr_write_b32 a182, 0
    v_mfma_f32_16x16x32_bf16 v[196:199], v[60:63], v[76:79], v[196:199]
    s_mul_i32 s98, s7, 36864
    ds_read_b128 v[108:111], v25 offset:24576
    v_add_u32 v36, s98, v36
    v_mfma_f32_16x16x32_bf16 v[200:203], v[56:59], v[80:83], v[200:203]
    s_mul_hi_u32 s98, s8, 715827883
    v_accvgpr_read_b32 v32, a192
    v_accvgpr_read_b32 v31, a193
    v_mfma_f32_16x16x32_bf16 v[200:203], v[60:63], v[84:87], v[200:203]
    s_add_u32 s87, s87, 19922944
    v_cvt_pk_bf16_f32 v32, v32, v31
    v_accvgpr_read_b32 v33, a194
    v_mfma_f32_16x16x32_bf16 v[204:207], v[56:59], v[88:91], v[204:207]
    ds_read_b64_tr_b16 v[56:57], v21 offset:0
    ds_read_b64_tr_b16 v[58:59], v21 offset:1024
    v_mfma_f32_16x16x32_bf16 v[204:207], v[60:63], v[92:95], v[204:207]
    ds_read_b64_tr_b16 v[60:61], v21 offset:8192
    ds_read_b64_tr_b16 v[62:63], v21 offset:9216
    v_mfma_f32_16x16x32_bf16 v[208:211], v[40:43], v[64:67], v[208:211]
    buffer_load_dwordx4 v13, s[20:23], s64 offen offset:3072 lds
    v_mfma_f32_16x16x32_bf16 v[208:211], v[44:47], v[68:71], v[208:211]
    v_add_u32 v21, 0x10000, v21
    v_accvgpr_read_b32 v31, a195
    v_mfma_f32_16x16x32_bf16 v[212:215], v[40:43], v[72:75], v[212:215]
    v_cvt_pk_bf16_f32 v33, v33, v31
    v_accvgpr_read_b32 v34, a196
    v_mfma_f32_16x16x32_bf16 v[212:215], v[44:47], v[76:79], v[212:215]
    v_accvgpr_read_b32 v31, a197
    v_cvt_pk_bf16_f32 v34, v34, v31
    v_mfma_f32_16x16x32_bf16 v[216:219], v[40:43], v[80:83], v[216:219]
    v_accvgpr_read_b32 v35, a198
    v_accvgpr_read_b32 v31, a199
    v_mfma_f32_16x16x32_bf16 v[216:219], v[44:47], v[84:87], v[216:219]
    v_cvt_pk_bf16_f32 v35, v35, v31
    v_sub_u32 v39, v36, v39
    v_mfma_f32_16x16x32_bf16 v[220:223], v[40:43], v[88:91], v[220:223]
    ds_read_b64_tr_b16 v[40:41], v26 offset:32768
    ds_read_b64_tr_b16 v[42:43], v26 offset:33280
    v_mfma_f32_16x16x32_bf16 v[220:223], v[44:47], v[92:95], v[220:223]
    s_add_u32 s72, s71, 4096
    ds_read_b64_tr_b16 v[44:45], v26 offset:36864
    ds_read_b64_tr_b16 v[46:47], v26 offset:37376
    s_waitcnt lgkmcnt(4)
    v_mfma_f32_16x16x32_bf16 v[224:227], v[48:51], v[64:67], v[224:227]
    v_add_u32 v26, 0x10000, v26
    v_lshl_add_u32 v36, s100, 6, v36
    v_mfma_f32_16x16x32_bf16 v[224:227], v[52:55], v[68:71], v[224:227]
    s_xor_b32 s64, s64, 128
    buffer_store_dwordx4 v[32:35], v1, s[36:39], s72 offen sc1
    v_mfma_f32_16x16x32_bf16 v[228:231], v[48:51], v[72:75], v[228:231]
    s_cmp_eq_u32 s4, 3
    s_cselect_b32 s84, s84, 1073741824
    v_accvgpr_write_b32 a183, 0
    v_mfma_f32_16x16x32_bf16 v[228:231], v[52:55], v[76:79], v[228:231]
    s_sub_u32 s40, s56, 22020096
    s_subb_u32 s41, s57, 0
    v_accvgpr_write_b32 a184, 0
    v_mfma_f32_16x16x32_bf16 v[232:235], v[48:51], v[80:83], v[232:235]
    s_add_u32 s85, s84, 3072
    v_accvgpr_write_b32 a185, 0
    v_accvgpr_write_b32 a186, 0
    v_mfma_f32_16x16x32_bf16 v[232:235], v[52:55], v[84:87], v[232:235]
    s_add_u32 m0, s69, 131072
    v_accvgpr_write_b32 a187, 0
    v_accvgpr_write_b32 a188, 0
    v_mfma_f32_16x16x32_bf16 v[236:239], v[48:51], v[88:91], v[236:239]
    buffer_load_dwordx4 v2, s[24:27], s60 offen lds
    v_mfma_f32_16x16x32_bf16 v[236:239], v[52:55], v[92:95], v[236:239]
    ds_read_b64_tr_b16 v[48:49], v27 offset:32768
    ds_read_b64_tr_b16 v[50:51], v27 offset:33280
    v_mfma_f32_16x16x32_bf16 v[240:243], v[56:59], v[64:67], v[240:243]
    ds_read_b64_tr_b16 v[52:53], v27 offset:36864
    ds_read_b64_tr_b16 v[54:55], v27 offset:37376
    v_mfma_f32_16x16x32_bf16 v[240:243], v[60:63], v[68:71], v[240:243]
    buffer_load_dwordx4 v3, s[24:27], s60 offen offset:1024 lds
    v_mfma_f32_16x16x32_bf16 v[244:247], v[56:59], v[72:75], v[244:247]
    v_add_u32 v27, 0x10000, v27
    v_accvgpr_write_b32 a189, 0
    v_mfma_f32_16x16x32_bf16 v[244:247], v[60:63], v[76:79], v[244:247]
    v_accvgpr_write_b32 a190, 0
    v_accvgpr_write_b32 a191, 0
    v_mfma_f32_16x16x32_bf16 v[248:251], v[56:59], v[80:83], v[248:251]
    v_accvgpr_read_b32 v32, a200
    v_accvgpr_read_b32 v31, a201
    v_mfma_f32_16x16x32_bf16 v[248:251], v[60:63], v[84:87], v[248:251]
    buffer_load_dwordx4 v4, s[24:27], s60 offen offset:2048 lds
    v_mfma_f32_16x16x32_bf16 v[252:255], v[56:59], v[88:91], v[252:255]
    ds_read_b64_tr_b16 v[56:57], v28 offset:32768
    ds_read_b64_tr_b16 v[58:59], v28 offset:33280
    v_mfma_f32_16x16x32_bf16 v[252:255], v[60:63], v[92:95], v[252:255]
    s_waitcnt lgkmcnt(2)
    ds_read_b64_tr_b16 v[60:61], v28 offset:36864
    ds_read_b64_tr_b16 v[62:63], v28 offset:37376
    v_mfma_f32_16x16x32_bf16 a[64:67], v[40:43], v[64:67], a[64:67]
    buffer_load_dwordx4 v5, s[24:27], s60 offen offset:3072 lds
    v_mfma_f32_16x16x32_bf16 a[64:67], v[44:47], v[68:71], a[64:67]
    v_add_u32 v28, 0x10000, v28
    v_cvt_pk_bf16_f32 v32, v32, v31
    v_mfma_f32_16x16x32_bf16 a[68:71], v[40:43], v[72:75], a[68:71]
    ds_read_b128 v[112:115], v24 offset:49152
    v_accvgpr_read_b32 v33, a202
    v_mfma_f32_16x16x32_bf16 a[68:71], v[44:47], v[76:79], a[68:71]
    s_add_u32 m0, s69, 147456
    v_accvgpr_read_b32 v31, a203
    v_cvt_pk_bf16_f32 v33, v33, v31
    v_mfma_f32_16x16x32_bf16 a[72:75], v[40:43], v[80:83], a[72:75]
    s_xor_b32 s60, s60, 524288
    buffer_load_dwordx4 v10, s[20:23], s63 offen lds
    v_mfma_f32_16x16x32_bf16 a[72:75], v[44:47], v[84:87], a[72:75]
    ds_read_b128 v[116:119], v25 offset:49152
    v_accvgpr_read_b32 v34, a204
    v_mfma_f32_16x16x32_bf16 a[76:79], v[40:43], v[88:91], a[76:79]
    ds_read_b64_tr_b16 v[40:41], v29 offset:32768
    ds_read_b64_tr_b16 v[42:43], v29 offset:33280
    v_mfma_f32_16x16x32_bf16 a[76:79], v[44:47], v[92:95], a[76:79]
    s_add_u32 s72, s71, 5120
    buffer_load_dwordx4 v11, s[20:23], s63 offen offset:1024 lds
    v_mfma_f32_16x16x32_bf16 a[80:83], v[48:51], v[64:67], a[80:83]
    ds_read_b128 v[120:123], v24 offset:57344
    ds_read_b64_tr_b16 v[44:45], v29 offset:36864
    v_mfma_f32_16x16x32_bf16 a[80:83], v[52:55], v[68:71], a[80:83]
    ds_read_b64_tr_b16 v[46:47], v29 offset:37376
    v_add_u32 v29, 0x10000, v29
    v_mfma_f32_16x16x32_bf16 a[84:87], v[48:51], v[72:75], a[84:87]
    v_accvgpr_read_b32 v31, a205
    v_cvt_pk_bf16_f32 v34, v34, v31
    v_mfma_f32_16x16x32_bf16 a[84:87], v[52:55], v[76:79], a[84:87]
    buffer_load_dwordx4 v12, s[20:23], s63 offen offset:2048 lds
    v_mfma_f32_16x16x32_bf16 a[88:91], v[48:51], v[80:83], a[88:91]
    ds_read_b128 v[124:127], v25 offset:57344
    v_accvgpr_read_b32 v35, a206
    v_mfma_f32_16x16x32_bf16 a[88:91], v[52:55], v[84:87], a[88:91]
    v_accvgpr_read_b32 v31, a207
    v_cvt_pk_bf16_f32 v35, v35, v31
    v_mfma_f32_16x16x32_bf16 a[92:95], v[48:51], v[88:91], a[92:95]
    buffer_load_dwordx4 v13, s[20:23], s63 offen offset:3072 lds
    v_mfma_f32_16x16x32_bf16 a[92:95], v[52:55], v[92:95], a[92:95]
    s_waitcnt lgkmcnt(1)
    v_accvgpr_write_b32 a192, 0
    v_accvgpr_write_b32 a193, 0
    v_mfma_f32_16x16x32_bf16 a[96:99], v[56:59], v[64:67], a[96:99]
    v_accvgpr_write_b32 a194, 0
    v_accvgpr_write_b32 a195, 0
    v_mfma_f32_16x16x32_bf16 a[96:99], v[60:63], v[68:71], a[96:99]
    s_xor_b32 s63, s63, 1920
    v_accvgpr_write_b32 a196, 0
    v_accvgpr_write_b32 a197, 0
    v_mfma_f32_16x16x32_bf16 a[100:103], v[56:59], v[72:75], a[100:103]
    s_andn2_b32 s63, s63, 896
    buffer_store_dwordx4 v[32:35], v1, s[36:39], s72 offen sc1
    v_mfma_f32_16x16x32_bf16 a[100:103], v[60:63], v[76:79], a[100:103]
    v_accvgpr_write_b32 a198, 0
    v_accvgpr_write_b32 a199, 0
    v_mfma_f32_16x16x32_bf16 a[104:107], v[56:59], v[80:83], a[104:107]
    v_accvgpr_read_b32 v32, a208
    v_accvgpr_read_b32 v31, a209
    v_mfma_f32_16x16x32_bf16 a[104:107], v[60:63], v[84:87], a[104:107]
    s_waitcnt vmcnt(10) lgkmcnt(0)
    s_barrier
    ds_read_b64_tr_b16 v[48:49], v14 offset:0
    v_mfma_f32_16x16x32_bf16 a[108:111], v[56:59], v[88:91], a[108:111]
    s_add_u32 m0, s67, 0
    ds_read_b64_tr_b16 v[50:51], v14 offset:1024
    ds_read_b64_tr_b16 v[52:53], v14 offset:8192
    v_mfma_f32_16x16x32_bf16 a[108:111], v[60:63], v[92:95], a[108:111]
    buffer_load_dwordx4 v1, s[28:31], s65 offen sc1 lds
    v_mfma_f32_16x16x32_bf16 a[112:115], v[40:43], v[64:67], a[112:115]
    ds_read_b64_tr_b16 v[54:55], v14 offset:9216
    ds_read_b64_tr_b16 v[56:57], v15 offset:0
    v_mfma_f32_16x16x32_bf16 a[112:115], v[44:47], v[68:71], a[112:115]
    ds_read_b64_tr_b16 v[58:59], v15 offset:1024
    ds_read_b64_tr_b16 v[60:61], v15 offset:8192
    v_mfma_f32_16x16x32_bf16 a[116:119], v[40:43], v[72:75], a[116:119]
    ds_read_b64_tr_b16 v[62:63], v15 offset:9216
    v_add_u32 v14, 0x10000, v14
    v_mfma_f32_16x16x32_bf16 a[116:119], v[44:47], v[76:79], a[116:119]
    v_add_u32 v15, 0x10000, v15
    v_cvt_pk_bf16_f32 v32, v32, v31
    v_mfma_f32_16x16x32_bf16 a[120:123], v[40:43], v[80:83], a[120:123]
    v_accvgpr_read_b32 v33, a210
    v_accvgpr_read_b32 v31, a211
    v_mfma_f32_16x16x32_bf16 a[120:123], v[44:47], v[84:87], a[120:123]
    v_cvt_pk_bf16_f32 v33, v33, v31
    v_accvgpr_read_b32 v34, a212
    v_mfma_f32_16x16x32_bf16 a[124:127], v[40:43], v[88:91], a[124:127]
    ds_read_b64_tr_b16 v[40:41], v16 offset:0
    ds_read_b64_tr_b16 v[42:43], v16 offset:1024
    v_mfma_f32_16x16x32_bf16 a[124:127], v[44:47], v[92:95], a[124:127]
    s_add_u32 s72, s71, 36864
    ds_read_b64_tr_b16 v[44:45], v16 offset:8192
    ds_read_b64_tr_b16 v[46:47], v16 offset:9216
    s_waitcnt lgkmcnt(4)
    v_mfma_f32_16x16x32_bf16 v[128:131], v[48:51], v[96:99], v[128:131]
    buffer_load_dwordx4 v1, s[28:31], s65 offen offset:1024 sc1 lds
    v_mfma_f32_16x16x32_bf16 v[128:131], v[52:55], v[100:103], v[128:131]
    v_add_u32 v24, 0x10000, v24
    v_add_u32 v16, 0x10000, v16
    v_mfma_f32_16x16x32_bf16 v[132:135], v[48:51], v[104:107], v[132:135]
    ds_read_b128 v[64:67], v24 offset:16384
    v_accvgpr_read_b32 v31, a213
    v_mfma_f32_16x16x32_bf16 v[132:135], v[52:55], v[108:111], v[132:135]
    v_cvt_pk_bf16_f32 v34, v34, v31
    v_accvgpr_read_b32 v35, a214
    v_mfma_f32_16x16x32_bf16 v[136:139], v[48:51], v[112:115], v[136:139]
    v_accvgpr_read_b32 v31, a215
    v_cvt_pk_bf16_f32 v35, v35, v31
    v_mfma_f32_16x16x32_bf16 v[136:139], v[52:55], v[116:119], v[136:139]
    buffer_store_dwordx4 v[32:35], v1, s[36:39], s72 offen sc1
    v_mfma_f32_16x16x32_bf16 v[140:143], v[48:51], v[120:123], v[140:143]
    ds_read_b64_tr_b16 v[48:49], v17 offset:0
    ds_read_b64_tr_b16 v[50:51], v17 offset:1024
    v_mfma_f32_16x16x32_bf16 v[140:143], v[52:55], v[124:127], v[140:143]
    ds_read_b64_tr_b16 v[52:53], v17 offset:8192
    ds_read_b64_tr_b16 v[54:55], v17 offset:9216
    v_mfma_f32_16x16x32_bf16 v[144:147], v[56:59], v[96:99], v[144:147]
    v_add_u32 v17, 0x10000, v17
    v_accvgpr_write_b32 a200, 0
    v_mfma_f32_16x16x32_bf16 v[144:147], v[60:63], v[100:103], v[144:147]
    s_add_u32 m0, s69, 16384
    v_accvgpr_write_b32 a201, 0
    v_accvgpr_write_b32 a202, 0
    v_mfma_f32_16x16x32_bf16 v[148:151], v[56:59], v[104:107], v[148:151]
    s_xor_b32 s65, s65, 8192
    buffer_load_dwordx4 v10, s[20:23], s64 offen lds
    v_mfma_f32_16x16x32_bf16 v[148:151], v[60:63], v[108:111], v[148:151]
    v_accvgpr_write_b32 a203, 0
    v_accvgpr_write_b32 a204, 0
    v_mfma_f32_16x16x32_bf16 v[152:155], v[56:59], v[112:115], v[152:155]
    v_add_u32 v25, 0x10000, v25
    v_accvgpr_read_b32 v32, a216
    v_mfma_f32_16x16x32_bf16 v[152:155], v[60:63], v[116:119], v[152:155]
    ds_read_b128 v[68:71], v25 offset:16384
    v_accvgpr_read_b32 v31, a217
    v_mfma_f32_16x16x32_bf16 v[156:159], v[56:59], v[120:123], v[156:159]
    ds_read_b64_tr_b16 v[56:57], v18 offset:0
    ds_read_b64_tr_b16 v[58:59], v18 offset:1024
    v_mfma_f32_16x16x32_bf16 v[156:159], v[60:63], v[124:127], v[156:159]
    s_waitcnt lgkmcnt(3)
    ds_read_b64_tr_b16 v[60:61], v18 offset:8192
    ds_read_b64_tr_b16 v[62:63], v18 offset:9216
    v_mfma_f32_16x16x32_bf16 v[160:163], v[40:43], v[96:99], v[160:163]
    v_add_u32 v18, 0x10000, v18
    v_cvt_pk_bf16_f32 v32, v32, v31
    v_mfma_f32_16x16x32_bf16 v[160:163], v[44:47], v[100:103], v[160:163]
    v_accvgpr_read_b32 v33, a218
    v_accvgpr_read_b32 v31, a219
    v_mfma_f32_16x16x32_bf16 v[164:167], v[40:43], v[104:107], v[164:167]
    v_cvt_pk_bf16_f32 v33, v33, v31
    v_accvgpr_read_b32 v34, a220
    v_mfma_f32_16x16x32_bf16 v[164:167], v[44:47], v[108:111], v[164:167]
    v_accvgpr_read_b32 v31, a221
    v_cvt_pk_bf16_f32 v34, v34, v31
    v_mfma_f32_16x16x32_bf16 v[168:171], v[40:43], v[112:115], v[168:171]
    buffer_load_dwordx4 v11, s[20:23], s64 offen offset:1024 lds
    v_mfma_f32_16x16x32_bf16 v[168:171], v[44:47], v[116:119], v[168:171]
    v_accvgpr_read_b32 v35, a222
    v_accvgpr_read_b32 v31, a223
    v_mfma_f32_16x16x32_bf16 v[172:175], v[40:43], v[120:123], v[172:175]
    ds_read_b64_tr_b16 v[40:41], v19 offset:0
    ds_read_b64_tr_b16 v[42:43], v19 offset:1024
    v_mfma_f32_16x16x32_bf16 v[172:175], v[44:47], v[124:127], v[172:175]
    s_add_u32 s72, s71, 37888
    ds_read_b64_tr_b16 v[44:45], v19 offset:8192
    ds_read_b64_tr_b16 v[46:47], v19 offset:9216
    v_mfma_f32_16x16x32_bf16 v[176:179], v[48:51], v[96:99], v[176:179]
    ds_read_b128 v[72:75], v24 offset:24576
    v_add_u32 v19, 0x10000, v19
    v_mfma_f32_16x16x32_bf16 v[176:179], v[52:55], v[100:103], v[176:179]
    v_cvt_pk_bf16_f32 v35, v35, v31
    v_accvgpr_write_b32 a205, 0
    v_mfma_f32_16x16x32_bf16 v[180:183], v[48:51], v[104:107], v[180:183]
    buffer_store_dwordx4 v[32:35], v1, s[36:39], s72 offen sc1
    v_mfma_f32_16x16x32_bf16 v[180:183], v[52:55], v[108:111], v[180:183]
    v_accvgpr_write_b32 a206, 0
    v_accvgpr_write_b32 a207, 0
    v_mfma_f32_16x16x32_bf16 v[184:187], v[48:51], v[112:115], v[184:187]
    v_accvgpr_write_b32 a208, 0
    v_accvgpr_write_b32 a209, 0
    v_mfma_f32_16x16x32_bf16 v[184:187], v[52:55], v[116:119], v[184:187]
    v_accvgpr_write_b32 a210, 0
    v_accvgpr_write_b32 a211, 0
    v_mfma_f32_16x16x32_bf16 v[188:191], v[48:51], v[120:123], v[188:191]
    buffer_load_dwordx4 v12, s[20:23], s64 offen offset:2048 lds
    v_mfma_f32_16x16x32_bf16 v[188:191], v[52:55], v[124:127], v[188:191]
    s_waitcnt lgkmcnt(0)
    ds_read_b64_tr_b16 v[48:49], v20 offset:0
    ds_read_b64_tr_b16 v[50:51], v20 offset:1024
    v_mfma_f32_16x16x32_bf16 v[192:195], v[56:59], v[96:99], v[192:195]
    ds_read_b64_tr_b16 v[52:53], v20 offset:8192
    ds_read_b64_tr_b16 v[54:55], v20 offset:9216
    v_mfma_f32_16x16x32_bf16 v[192:195], v[60:63], v[100:103], v[192:195]
    v_add_u32 v20, 0x10000, v20
    v_accvgpr_write_b32 a212, 0
    v_mfma_f32_16x16x32_bf16 v[196:199], v[56:59], v[104:107], v[196:199]
    v_accvgpr_write_b32 a213, 0
    v_accvgpr_write_b32 a214, 0
    v_mfma_f32_16x16x32_bf16 v[196:199], v[60:63], v[108:111], v[196:199]
    ds_read_b128 v[76:79], v25 offset:24576
    v_accvgpr_write_b32 a215, 0
    v_mfma_f32_16x16x32_bf16 v[200:203], v[56:59], v[112:115], v[200:203]
    v_accvgpr_read_b32 v32, a224
    v_accvgpr_read_b32 v31, a225
    v_mfma_f32_16x16x32_bf16 v[200:203], v[60:63], v[116:119], v[200:203]
    v_cvt_pk_bf16_f32 v32, v32, v31
    v_accvgpr_read_b32 v33, a226
    v_mfma_f32_16x16x32_bf16 v[204:207], v[56:59], v[120:123], v[204:207]
    ds_read_b64_tr_b16 v[56:57], v21 offset:0
    ds_read_b64_tr_b16 v[58:59], v21 offset:1024
    v_mfma_f32_16x16x32_bf16 v[204:207], v[60:63], v[124:127], v[204:207]
    ds_read_b64_tr_b16 v[60:61], v21 offset:8192
    ds_read_b64_tr_b16 v[62:63], v21 offset:9216
    v_mfma_f32_16x16x32_bf16 v[208:211], v[40:43], v[96:99], v[208:211]
    buffer_load_dwordx4 v13, s[20:23], s64 offen offset:3072 lds
    v_mfma_f32_16x16x32_bf16 v[208:211], v[44:47], v[100:103], v[208:211]
    v_add_u32 v21, 0x10000, v21
    v_accvgpr_read_b32 v31, a227
    v_mfma_f32_16x16x32_bf16 v[212:215], v[40:43], v[104:107], v[212:215]
    v_cvt_pk_bf16_f32 v33, v33, v31
    v_accvgpr_read_b32 v34, a228
    v_mfma_f32_16x16x32_bf16 v[212:215], v[44:47], v[108:111], v[212:215]
    v_accvgpr_read_b32 v31, a229
    v_cvt_pk_bf16_f32 v34, v34, v31
    v_mfma_f32_16x16x32_bf16 v[216:219], v[40:43], v[112:115], v[216:219]
    v_accvgpr_read_b32 v35, a230
    v_accvgpr_read_b32 v31, a231
    v_mfma_f32_16x16x32_bf16 v[216:219], v[44:47], v[116:119], v[216:219]
    v_cvt_pk_bf16_f32 v35, v35, v31
    v_accvgpr_write_b32 a216, 0
    v_mfma_f32_16x16x32_bf16 v[220:223], v[40:43], v[120:123], v[220:223]
    ds_read_b64_tr_b16 v[40:41], v26 offset:32768
    ds_read_b64_tr_b16 v[42:43], v26 offset:33280
    v_mfma_f32_16x16x32_bf16 v[220:223], v[44:47], v[124:127], v[220:223]
    s_add_u32 s72, s71, 6144
    ds_read_b64_tr_b16 v[44:45], v26 offset:36864
    ds_read_b64_tr_b16 v[46:47], v26 offset:37376
    s_waitcnt lgkmcnt(4)
    v_mfma_f32_16x16x32_bf16 v[224:227], v[48:51], v[96:99], v[224:227]
    v_add_u32 v26, 0xffff0000, v26
    v_accvgpr_write_b32 a217, 0
    v_mfma_f32_16x16x32_bf16 v[224:227], v[52:55], v[100:103], v[224:227]
    s_xor_b32 s64, s64, 1920
    buffer_store_dwordx4 v[32:35], v1, s[36:39], s72 offen sc1
    v_mfma_f32_16x16x32_bf16 v[228:231], v[48:51], v[104:107], v[228:231]
    s_andn2_b32 s64, s64, 896
    v_accvgpr_write_b32 a218, 0
    v_accvgpr_write_b32 a219, 0
    v_mfma_f32_16x16x32_bf16 v[228:231], v[52:55], v[108:111], v[228:231]
    v_accvgpr_write_b32 a220, 0
    v_accvgpr_write_b32 a221, 0
    v_mfma_f32_16x16x32_bf16 v[232:235], v[48:51], v[112:115], v[232:235]
    v_accvgpr_write_b32 a222, 0
    v_accvgpr_write_b32 a223, 0
    v_mfma_f32_16x16x32_bf16 v[232:235], v[52:55], v[116:119], v[232:235]
    s_add_u32 m0, s69, 32768
    v_mfma_f32_16x16x32_bf16 v[236:239], v[48:51], v[120:123], v[236:239]
    buffer_load_dwordx4 v2, s[24:27], s60 offen lds
    v_mfma_f32_16x16x32_bf16 v[236:239], v[52:55], v[124:127], v[236:239]
    ds_read_b64_tr_b16 v[48:49], v27 offset:32768
    ds_read_b64_tr_b16 v[50:51], v27 offset:33280
    v_mfma_f32_16x16x32_bf16 v[240:243], v[56:59], v[96:99], v[240:243]
    ds_read_b64_tr_b16 v[52:53], v27 offset:36864
    ds_read_b64_tr_b16 v[54:55], v27 offset:37376
    v_mfma_f32_16x16x32_bf16 v[240:243], v[60:63], v[100:103], v[240:243]
    buffer_load_dwordx4 v3, s[24:27], s60 offen offset:1024 lds
    v_mfma_f32_16x16x32_bf16 v[244:247], v[56:59], v[104:107], v[244:247]
    v_add_u32 v27, 0xffff0000, v27
    v_mfma_f32_16x16x32_bf16 v[244:247], v[60:63], v[108:111], v[244:247]
    v_mfma_f32_16x16x32_bf16 v[248:251], v[56:59], v[112:115], v[248:251]
    v_accvgpr_read_b32 v32, a232
    v_accvgpr_read_b32 v31, a233
    v_mfma_f32_16x16x32_bf16 v[248:251], v[60:63], v[116:119], v[248:251]
    buffer_load_dwordx4 v4, s[24:27], s60 offen offset:2048 lds
    v_mfma_f32_16x16x32_bf16 v[252:255], v[56:59], v[120:123], v[252:255]
    ds_read_b64_tr_b16 v[56:57], v28 offset:32768
    ds_read_b64_tr_b16 v[58:59], v28 offset:33280
    v_mfma_f32_16x16x32_bf16 v[252:255], v[60:63], v[124:127], v[252:255]
    s_waitcnt lgkmcnt(2)
    ds_read_b64_tr_b16 v[60:61], v28 offset:36864
    ds_read_b64_tr_b16 v[62:63], v28 offset:37376
    v_mfma_f32_16x16x32_bf16 a[64:67], v[40:43], v[96:99], a[64:67]
    buffer_load_dwordx4 v5, s[24:27], s60 offen offset:3072 lds
    v_mfma_f32_16x16x32_bf16 a[64:67], v[44:47], v[100:103], a[64:67]
    v_add_u32 v28, 0xffff0000, v28
    v_cvt_pk_bf16_f32 v32, v32, v31
    v_mfma_f32_16x16x32_bf16 a[68:71], v[40:43], v[104:107], a[68:71]
    ds_read_b128 v[80:83], v24 offset:49152
    v_accvgpr_read_b32 v33, a234
    v_mfma_f32_16x16x32_bf16 a[68:71], v[44:47], v[108:111], a[68:71]
    s_xor_b32 s60, s60, 7864320
    v_accvgpr_read_b32 v31, a235
    v_cvt_pk_bf16_f32 v33, v33, v31
    v_mfma_f32_16x16x32_bf16 a[72:75], v[40:43], v[112:115], a[72:75]
    s_add_u32 m0, s69, 49152
    v_accvgpr_read_b32 v34, a236
    v_accvgpr_read_b32 v31, a237
    v_mfma_f32_16x16x32_bf16 a[72:75], v[44:47], v[116:119], a[72:75]
    s_andn2_b32 s60, s60, 3670016
    buffer_load_dwordx4 v10, s[20:23], s63 offen lds
    v_mfma_f32_16x16x32_bf16 a[76:79], v[40:43], v[120:123], a[76:79]
    ds_read_b128 v[84:87], v25 offset:49152
    ds_read_b64_tr_b16 v[40:41], v29 offset:32768
    v_mfma_f32_16x16x32_bf16 a[76:79], v[44:47], v[124:127], a[76:79]
    s_add_u32 s72, s71, 7168
    buffer_load_dwordx4 v11, s[20:23], s63 offen offset:1024 lds
    v_mfma_f32_16x16x32_bf16 a[80:83], v[48:51], v[96:99], a[80:83]
    ds_read_b128 v[88:91], v24 offset:57344
    ds_read_b64_tr_b16 v[42:43], v29 offset:33280
    v_mfma_f32_16x16x32_bf16 a[80:83], v[52:55], v[100:103], a[80:83]
    ds_read_b64_tr_b16 v[44:45], v29 offset:36864
    ds_read_b64_tr_b16 v[46:47], v29 offset:37376
    v_mfma_f32_16x16x32_bf16 a[84:87], v[48:51], v[104:107], a[84:87]
    v_add_u32 v29, 0xffff0000, v29
    v_cvt_pk_bf16_f32 v34, v34, v31
    v_mfma_f32_16x16x32_bf16 a[84:87], v[52:55], v[108:111], a[84:87]
    buffer_load_dwordx4 v12, s[20:23], s63 offen offset:2048 lds
    v_mfma_f32_16x16x32_bf16 a[88:91], v[48:51], v[112:115], a[88:91]
    ds_read_b128 v[92:95], v25 offset:57344
    v_accvgpr_read_b32 v35, a238
    v_mfma_f32_16x16x32_bf16 a[88:91], v[52:55], v[116:119], a[88:91]
    v_accvgpr_read_b32 v31, a239
    v_cvt_pk_bf16_f32 v35, v35, v31
    v_mfma_f32_16x16x32_bf16 a[92:95], v[48:51], v[120:123], a[92:95]
    buffer_load_dwordx4 v13, s[20:23], s63 offen offset:3072 lds
    v_mfma_f32_16x16x32_bf16 a[92:95], v[52:55], v[124:127], a[92:95]
    s_waitcnt lgkmcnt(1)
    v_mfma_f32_16x16x32_bf16 a[96:99], v[56:59], v[96:99], a[96:99]
    v_mfma_f32_16x16x32_bf16 a[96:99], v[60:63], v[100:103], a[96:99]
    s_xor_b32 s63, s63, 128
    v_mfma_f32_16x16x32_bf16 a[100:103], v[56:59], v[104:107], a[100:103]
    buffer_store_dwordx4 v[32:35], v1, s[36:39], s72 offen sc1
    v_mfma_f32_16x16x32_bf16 a[100:103], v[60:63], v[108:111], a[100:103]
    v_mfma_f32_16x16x32_bf16 a[104:107], v[56:59], v[112:115], a[104:107]
    v_accvgpr_read_b32 v32, a240
    v_accvgpr_read_b32 v31, a241
    v_mfma_f32_16x16x32_bf16 a[104:107], v[60:63], v[116:119], a[104:107]
    s_waitcnt vmcnt(10) lgkmcnt(0)
    s_barrier
    ds_read_b64_tr_b16 v[48:49], v14 offset:0
    v_mfma_f32_16x16x32_bf16 a[108:111], v[56:59], v[120:123], a[108:111]
    s_add_u32 m0, s69, 65536
    ds_read_b64_tr_b16 v[50:51], v14 offset:1024
    ds_read_b64_tr_b16 v[52:53], v14 offset:8192
    v_mfma_f32_16x16x32_bf16 a[108:111], v[60:63], v[124:127], a[108:111]
    buffer_load_dwordx4 v2, s[24:27], s60 offen lds
    v_mfma_f32_16x16x32_bf16 a[112:115], v[40:43], v[96:99], a[112:115]
    ds_read_b64_tr_b16 v[54:55], v14 offset:9216
    ds_read_b64_tr_b16 v[56:57], v15 offset:0
    v_mfma_f32_16x16x32_bf16 a[112:115], v[44:47], v[100:103], a[112:115]
    ds_read_b64_tr_b16 v[58:59], v15 offset:1024
    ds_read_b64_tr_b16 v[60:61], v15 offset:8192
    v_mfma_f32_16x16x32_bf16 a[116:119], v[40:43], v[104:107], a[116:119]
    ds_read_b64_tr_b16 v[62:63], v15 offset:9216
    v_add_u32 v14, 0xfffe0000, v14
    v_mfma_f32_16x16x32_bf16 a[116:119], v[44:47], v[108:111], a[116:119]
    v_add_u32 v15, 0xfffe0000, v15
    v_cvt_pk_bf16_f32 v32, v32, v31
    v_mfma_f32_16x16x32_bf16 a[120:123], v[40:43], v[112:115], a[120:123]
    v_accvgpr_read_b32 v33, a242
    v_accvgpr_read_b32 v31, a243
    v_mfma_f32_16x16x32_bf16 a[120:123], v[44:47], v[116:119], a[120:123]
    buffer_load_dwordx4 v3, s[24:27], s60 offen offset:1024 lds
    v_mfma_f32_16x16x32_bf16 a[124:127], v[40:43], v[120:123], a[124:127]
    ds_read_b64_tr_b16 v[40:41], v16 offset:0
    ds_read_b64_tr_b16 v[42:43], v16 offset:1024
    v_mfma_f32_16x16x32_bf16 a[124:127], v[44:47], v[124:127], a[124:127]
    s_add_u32 s72, s71, 38912
    ds_read_b64_tr_b16 v[44:45], v16 offset:8192
    ds_read_b64_tr_b16 v[46:47], v16 offset:9216
    s_waitcnt lgkmcnt(4)
    v_mfma_f32_16x16x32_bf16 v[128:131], v[48:51], v[64:67], v[128:131]
    v_add_u32 v16, 0xfffe0000, v16
    v_cvt_pk_bf16_f32 v33, v33, v31
    v_mfma_f32_16x16x32_bf16 v[128:131], v[52:55], v[68:71], v[128:131]
    v_add_u32 v24, 0x10000, v24
    v_accvgpr_read_b32 v34, a244
    v_mfma_f32_16x16x32_bf16 v[132:135], v[48:51], v[72:75], v[132:135]
    ds_read_b128 v[96:99], v24 offset:16384
    v_accvgpr_read_b32 v31, a245
    v_mfma_f32_16x16x32_bf16 v[132:135], v[52:55], v[76:79], v[132:135]
    v_cvt_pk_bf16_f32 v34, v34, v31
    v_accvgpr_read_b32 v35, a246
    v_mfma_f32_16x16x32_bf16 v[136:139], v[48:51], v[80:83], v[136:139]
    v_accvgpr_read_b32 v31, a247
    v_cvt_pk_bf16_f32 v35, v35, v31
    v_mfma_f32_16x16x32_bf16 v[136:139], v[52:55], v[84:87], v[136:139]
    buffer_load_dwordx4 v4, s[24:27], s60 offen offset:2048 lds
    v_mfma_f32_16x16x32_bf16 v[140:143], v[48:51], v[88:91], v[140:143]
    ds_read_b64_tr_b16 v[48:49], v17 offset:0
    ds_read_b64_tr_b16 v[50:51], v17 offset:1024
    v_mfma_f32_16x16x32_bf16 v[140:143], v[52:55], v[92:95], v[140:143]
    ds_read_b64_tr_b16 v[52:53], v17 offset:8192
    ds_read_b64_tr_b16 v[54:55], v17 offset:9216
    v_mfma_f32_16x16x32_bf16 v[144:147], v[56:59], v[64:67], v[144:147]
    v_add_u32 v17, 0xfffe0000, v17
    v_mov_b32 v2, v1
    v_mfma_f32_16x16x32_bf16 v[144:147], v[60:63], v[68:71], v[144:147]
    buffer_store_dwordx4 v[32:35], v1, s[36:39], s72 offen sc1
    v_mfma_f32_16x16x32_bf16 v[148:151], v[56:59], v[72:75], v[148:151]
    v_mfma_f32_16x16x32_bf16 v[148:151], v[60:63], v[76:79], v[148:151]
    v_mfma_f32_16x16x32_bf16 v[152:155], v[56:59], v[80:83], v[152:155]
    v_add_u32 v25, 0x10000, v25
    v_accvgpr_read_b32 v32, a248
    v_mfma_f32_16x16x32_bf16 v[152:155], v[60:63], v[84:87], v[152:155]
    buffer_load_dwordx4 v5, s[24:27], s60 offen offset:3072 lds
    v_mfma_f32_16x16x32_bf16 v[156:159], v[56:59], v[88:91], v[156:159]
    ds_read_b128 v[100:103], v25 offset:16384
    ds_read_b64_tr_b16 v[56:57], v18 offset:0
    v_mfma_f32_16x16x32_bf16 v[156:159], v[60:63], v[92:95], v[156:159]
    s_waitcnt lgkmcnt(2)
    ds_read_b64_tr_b16 v[58:59], v18 offset:1024
    ds_read_b64_tr_b16 v[60:61], v18 offset:8192
    v_mfma_f32_16x16x32_bf16 v[160:163], v[40:43], v[64:67], v[160:163]
    ds_read_b64_tr_b16 v[62:63], v18 offset:9216
    v_add_u32 v18, 0xfffe0000, v18
    v_mfma_f32_16x16x32_bf16 v[160:163], v[44:47], v[68:71], v[160:163]
    v_accvgpr_read_b32 v31, a249
    v_cvt_pk_bf16_f32 v32, v32, v31
    v_mfma_f32_16x16x32_bf16 v[164:167], v[40:43], v[72:75], v[164:167]
    v_accvgpr_read_b32 v33, a250
    v_accvgpr_read_b32 v31, a251
    v_mfma_f32_16x16x32_bf16 v[164:167], v[44:47], v[76:79], v[164:167]
    s_add_u32 m0, s69, 81920
    v_cvt_pk_bf16_f32 v33, v33, v31
    v_accvgpr_read_b32 v34, a252
    v_mfma_f32_16x16x32_bf16 v[168:171], v[40:43], v[80:83], v[168:171]
    s_xor_b32 s60, s60, 524288
    buffer_load_dwordx4 v10, s[20:23], s64 offen lds
    v_mfma_f32_16x16x32_bf16 v[168:171], v[44:47], v[84:87], v[168:171]
    s_mov_b32 s60, 131072
    v_accvgpr_read_b32 v31, a253
    v_cvt_pk_bf16_f32 v34, v34, v31
    v_mfma_f32_16x16x32_bf16 v[172:175], v[40:43], v[88:91], v[172:175]
    ds_read_b64_tr_b16 v[40:41], v19 offset:0
    ds_read_b64_tr_b16 v[42:43], v19 offset:1024
    v_mfma_f32_16x16x32_bf16 v[172:175], v[44:47], v[92:95], v[172:175]
    s_add_u32 s72, s71, 39936
    ds_read_b64_tr_b16 v[44:45], v19 offset:8192
    ds_read_b64_tr_b16 v[46:47], v19 offset:9216
    v_mfma_f32_16x16x32_bf16 v[176:179], v[48:51], v[64:67], v[176:179]
    ds_read_b128 v[104:107], v24 offset:24576
    v_add_u32 v19, 0xfffe0000, v19
    v_mfma_f32_16x16x32_bf16 v[176:179], v[52:55], v[68:71], v[176:179]
    v_accvgpr_read_b32 v35, a254
    v_accvgpr_read_b32 v31, a255
    v_mfma_f32_16x16x32_bf16 v[180:183], v[48:51], v[72:75], v[180:183]
    v_cvt_pk_bf16_f32 v35, v35, v31
    v_mov_b32 v31, 1
    v_mfma_f32_16x16x32_bf16 v[180:183], v[52:55], v[76:79], v[180:183]
    buffer_load_dwordx4 v11, s[20:23], s64 offen offset:1024 lds
    v_mfma_f32_16x16x32_bf16 v[184:187], v[48:51], v[80:83], v[184:187]
    buffer_store_dwordx4 v[32:35], v1, s[36:39], s72 offen sc1
    v_mfma_f32_16x16x32_bf16 v[184:187], v[52:55], v[84:87], v[184:187]
    v_add_u32 v11, s99, v39
    v_mfma_f32_16x16x32_bf16 v[188:191], v[48:51], v[88:91], v[188:191]
    s_mul_i32 s99, s98, 6
    ds_read_b64_tr_b16 v[48:49], v20 offset:0
    ds_read_b64_tr_b16 v[50:51], v20 offset:1024
    v_mfma_f32_16x16x32_bf16 v[188:191], v[52:55], v[92:95], v[188:191]
    s_sub_u32 s99, s8, s99
    ds_read_b64_tr_b16 v[52:53], v20 offset:8192
    ds_read_b64_tr_b16 v[54:55], v20 offset:9216
    s_waitcnt lgkmcnt(4)
    v_mfma_f32_16x16x32_bf16 v[192:195], v[56:59], v[64:67], v[192:195]
    s_mul_i32 s99, s99, 6
    v_add_u32 v20, 0xfffe0000, v20
    v_mfma_f32_16x16x32_bf16 v[192:195], v[60:63], v[68:71], v[192:195]
    s_lshl1_add_u32 s99, s4, s99
    v_mfma_f32_16x16x32_bf16 v[196:199], v[56:59], v[72:75], v[196:199]
    s_sub_u32 s99, s99, 2
    v_mfma_f32_16x16x32_bf16 v[196:199], v[60:63], v[76:79], v[196:199]
    s_lshl_b32 s8, s99, 5
    buffer_load_dwordx4 v12, s[20:23], s64 offen offset:2048 lds
    v_mfma_f32_16x16x32_bf16 v[200:203], v[56:59], v[80:83], v[200:203]
    s_lshr_b32 s99, s99, 1
    ds_read_b128 v[108:111], v25 offset:24576
    v_lshl_add_u32 v10, v38, 4, s8
    v_mfma_f32_16x16x32_bf16 v[200:203], v[60:63], v[84:87], v[200:203]
    s_lshr_b32 s8, s5, 3
    v_lshrrev_b32 v38, 3, v37
    v_mul_u32_u24 v39, 18, v38
    v_mfma_f32_16x16x32_bf16 v[204:207], v[56:59], v[88:91], v[204:207]
    s_mul_i32 s8, s8, 6
    ds_read_b64_tr_b16 v[56:57], v21 offset:0
    ds_read_b64_tr_b16 v[58:59], v21 offset:1024
    v_mfma_f32_16x16x32_bf16 v[204:207], v[60:63], v[92:95], v[204:207]
    ds_read_b64_tr_b16 v[60:61], v21 offset:8192
    ds_read_b64_tr_b16 v[62:63], v21 offset:9216
    v_mfma_f32_16x16x32_bf16 v[208:211], v[40:43], v[64:67], v[208:211]
    v_add_u32 v21, 0xfffe0000, v21
    v_and_b32 v38, 4, v37
    v_mfma_f32_16x16x32_bf16 v[208:211], v[44:47], v[68:71], v[208:211]
    s_cmp_lt_u32 s98, 5
    s_cselect_b32 s98, s98, 40
    v_lshl_add_u32 v39, v38, 1, v39
    v_mfma_f32_16x16x32_bf16 v[212:215], v[40:43], v[72:75], v[212:215]
    s_lshl1_add_u32 s9, s98, s9
    buffer_load_dwordx4 v13, s[20:23], s64 offen offset:3072 lds
    v_mfma_f32_16x16x32_bf16 v[212:215], v[44:47], v[76:79], v[212:215]
    s_mul_i32 s9, s9, 18
    v_lshrrev_b32 v38, 2, v37
    v_mul_u32_u24 v38, 36, v38
    v_mfma_f32_16x16x32_bf16 v[216:219], v[40:43], v[80:83], v[216:219]
    v_add_u32 v39, s9, v39
    v_add_u32 v38, s10, v38
    v_mfma_f32_16x16x32_bf16 v[216:219], v[44:47], v[84:87], v[216:219]
    s_cmp_eq_u32 s98, 4
    s_cselect_b64 vcc, -1, 0
    v_and_b32 v37, 3, v37
    v_mfma_f32_16x16x32_bf16 v[220:223], v[40:43], v[88:91], v[220:223]
    ds_read_b64_tr_b16 v[40:41], v26 offset:0
    ds_read_b64_tr_b16 v[42:43], v26 offset:512
    v_mfma_f32_16x16x32_bf16 v[220:223], v[44:47], v[92:95], v[220:223]
    s_waitcnt lgkmcnt(2)
    ds_read_b64_tr_b16 v[44:45], v26 offset:4096
    ds_read_b64_tr_b16 v[46:47], v26 offset:4608
    v_mfma_f32_16x16x32_bf16 v[224:227], v[48:51], v[64:67], v[224:227]
    v_add_u32 v26, 0x10000, v26
    v_cndmask_b32 v39, v39, v38, vcc
    v_mfma_f32_16x16x32_bf16 v[224:227], v[52:55], v[68:71], v[224:227]
    s_xor_b32 s64, s64, 128
    v_add_u32 v39, v39, v37
    v_mul_u32_u24 v39, 1152, v39
    v_mfma_f32_16x16x32_bf16 v[228:231], v[48:51], v[72:75], v[228:231]
    s_cmp_eq_u32 s98, 4
    s_cselect_b32 s9, 18, 4
    s_cselect_b32 s10, 2, 4
    v_mfma_f32_16x16x32_bf16 v[228:231], v[52:55], v[76:79], v[228:231]
    s_mul_i32 s9, s9, 1152
    v_add_u32 v39, v39, v10
    v_mov_b32 v38, 1073741824
    v_mfma_f32_16x16x32_bf16 v[232:235], v[48:51], v[80:83], v[232:235]
    s_add_u32 s98, s98, s8
    v_cmp_gt_u32 vcc, s10, v37
    v_lshrrev_b32 v37, 8, v1
    v_mfma_f32_16x16x32_bf16 v[232:235], v[52:55], v[84:87], v[232:235]
    s_add_u32 m0, s67, 98304
    v_cndmask_b32 v12, v38, v39, vcc
    v_add_u32 v38, 1024, v36
    v_mfma_f32_16x16x32_bf16 v[236:239], v[48:51], v[88:91], v[236:239]
    s_add_u32 s98, s98, 128
    buffer_load_dwordx4 v1, s[28:31], s65 offen sc1 lds
    v_mfma_f32_16x16x32_bf16 v[236:239], v[52:55], v[92:95], v[236:239]
    s_add_u32 s8, s100, 16
    ds_read_b64_tr_b16 v[48:49], v27 offset:0
    ds_read_b64_tr_b16 v[50:51], v27 offset:512
    v_mfma_f32_16x16x32_bf16 v[240:243], v[56:59], v[64:67], v[240:243]
    s_lshr_b32 s10, s5, 3
    ds_read_b64_tr_b16 v[52:53], v27 offset:4096
    ds_read_b64_tr_b16 v[54:55], v27 offset:4608
    v_mfma_f32_16x16x32_bf16 v[240:243], v[60:63], v[68:71], v[240:243]
    v_add_u32 v27, 0x10000, v27
    v_add_u32 v13, s9, v12
    v_mfma_f32_16x16x32_bf16 v[244:247], v[56:59], v[72:75], v[244:247]
    s_cmp_eq_u32 s4, 0
    s_cselect_b64 vcc, -1, 0
    v_cndmask_b32 v12, v12, v38, vcc
    v_mfma_f32_16x16x32_bf16 v[244:247], v[60:63], v[76:79], v[244:247]
    v_add_u32 v38, 19456, v36
    v_bfe_u32 v36, v1, 4, 4
    v_mfma_f32_16x16x32_bf16 v[248:251], v[56:59], v[80:83], v[248:251]
    s_cmp_eq_u32 s4, 0
    s_cselect_b64 vcc, -1, 0
    v_cndmask_b32 v13, v13, v38, vcc
    v_mfma_f32_16x16x32_bf16 v[248:251], v[60:63], v[84:87], v[248:251]
    s_cmp_eq_u32 s4, 0
    s_cselect_b32 s98, s7, s98
    s_cselect_b32 s99, s8, s99
    v_mfma_f32_16x16x32_bf16 v[252:255], v[56:59], v[88:91], v[252:255]
    s_lshr_b32 s9, s99, 2
    ds_read_b64_tr_b16 v[56:57], v28 offset:0
    ds_read_b64_tr_b16 v[58:59], v28 offset:512
    v_mfma_f32_16x16x32_bf16 v[252:255], v[60:63], v[92:95], v[252:255]
    s_sub_u32 s9, s9, s10
    ds_read_b64_tr_b16 v[60:61], v28 offset:4096
    ds_read_b64_tr_b16 v[62:63], v28 offset:4608
    s_waitcnt lgkmcnt(4)
    v_mfma_f32_16x16x32_bf16 a[64:67], v[40:43], v[64:67], a[64:67]
    s_lshr_b32 s92, s2, 3
    v_lshrrev_b32 v9, 4, v1
    v_min_u32 v9, 0, v9
    v_mfma_f32_16x16x32_bf16 a[64:67], v[44:47], v[68:71], a[64:67]
    s_lshl2_add_u32 s92, s92, s4
    v_add_u32 v24, 0xfffe0000, v24
    v_add_u32 v28, 0x10000, v28
    v_mfma_f32_16x16x32_bf16 a[68:71], v[40:43], v[72:75], a[68:71]
    s_mul_i32 s92, s92, 1
    ds_read_b128 v[112:115], v24 offset:16384
    v_lshlrev_b32 v37, 2, v37
    v_mfma_f32_16x16x32_bf16 a[68:71], v[44:47], v[76:79], a[68:71]
    s_add_u32 s92, s92, 32
    v_add_lshl_u32 v9, v9, s92, 7
    v_sub_u32 v36, v36, v37
    v_mfma_f32_16x16x32_bf16 a[72:75], v[40:43], v[80:83], a[72:75]
    s_sub_u32 s9, s9, 1
    v_add_u32 v25, 0xfffe0000, v25
    v_mov_b32 v37, 0xf149f2ca
    v_mfma_f32_16x16x32_bf16 a[72:75], v[44:47], v[84:87], a[72:75]
    s_getpc_b64 s[92:93]
    global_load_dword v9, v9, s[92:93]
    v_mfma_f32_16x16x32_bf16 a[76:79], v[40:43], v[88:91], a[76:79]
    s_and_b32 s9, s9, 3
    buffer_load_dwordx4 v1, s[28:31], s65 offen offset:1024 sc1 lds
    v_mfma_f32_16x16x32_bf16 a[76:79], v[44:47], v[92:95], a[76:79]
    s_lshl_b32 s9, s9, 1
    ds_read_b128 v[116:119], v25 offset:16384
    ds_read_b64_tr_b16 v[40:41], v29 offset:0
    v_mfma_f32_16x16x32_bf16 a[80:83], v[48:51], v[64:67], a[80:83]
    s_and_b32 s10, s99, 3
    ds_read_b128 v[120:123], v24 offset:24576
    v_bfe_u32 v38, v1, 4, 1
    v_mfma_f32_16x16x32_bf16 a[80:83], v[52:55], v[68:71], a[80:83]
    s_mul_i32 s10, s10, 9
    ds_read_b64_tr_b16 v[42:43], v29 offset:512
    ds_read_b64_tr_b16 v[44:45], v29 offset:4096
    v_mfma_f32_16x16x32_bf16 a[84:87], v[48:51], v[72:75], a[84:87]
    s_mul_i32 s98, s98, 36864
    ds_read_b64_tr_b16 v[46:47], v29 offset:4608
    v_add_u32 v29, 0x10000, v29
    v_mfma_f32_16x16x32_bf16 a[84:87], v[52:55], v[76:79], a[84:87]
    s_mul_i32 s7, s7, 36864
    ds_read_b128 v[124:127], v25 offset:24576
    v_sub_u32 v38, 0, v38
    v_mfma_f32_16x16x32_bf16 a[88:91], v[48:51], v[80:83], a[88:91]
    s_cmp_eq_u32 s9, 6
    s_cselect_b32 s9, 7, s9
    v_and_b32 v38, 0xaaaaaaaa, v38
    v_mfma_f32_16x16x32_bf16 a[88:91], v[52:55], v[84:87], a[88:91]
    s_add_u32 s9, s9, s10
    v_and_b32 v39, 0x40, v1
    v_mfma_f32_16x16x32_bf16 a[92:95], v[48:51], v[88:91], a[92:95]
    s_lshl_b32 s64, s9, 10
    v_mfma_f32_16x16x32_bf16 a[92:95], v[52:55], v[92:95], a[92:95]
    s_sub_u32 s9, s99, 16
    s_waitcnt lgkmcnt(1)
    v_mfma_f32_16x16x32_bf16 a[96:99], v[56:59], v[64:67], a[96:99]
    s_mul_i32 s9, s9, 18432
    v_mfma_f32_16x16x32_bf16 a[96:99], v[60:63], v[68:71], a[96:99]
    s_xor_b32 s65, s65, 122880
    v_mfma_f32_16x16x32_bf16 a[100:103], v[56:59], v[72:75], a[100:103]
    s_andn2_b32 s65, s65, 57344
    v_mfma_f32_16x16x32_bf16 a[100:103], v[60:63], v[76:79], a[100:103]
    s_add_u32 s9, s9, 6144
    v_mfma_f32_16x16x32_bf16 a[104:107], v[56:59], v[80:83], a[104:107]
    s_mov_b32 s10, 1024
    v_mfma_f32_16x16x32_bf16 a[104:107], v[60:63], v[84:87], a[104:107]
    s_waitcnt vmcnt(3) lgkmcnt(0)
    s_barrier
    ds_read_b64_tr_b16 v[48:49], v14 offset:32768
    v_mfma_f32_16x16x32_bf16 a[108:111], v[56:59], v[88:91], a[108:111]
    s_add_u32 m0, s67, 131072
    buffer_store_dword v31, v30, s[32:35], s101 offen sc1
    v_mfma_f32_16x16x32_bf16 a[108:111], v[60:63], v[92:95], a[108:111]
    s_mov_b32 s93, 65536
    buffer_load_dwordx4 v1, s[28:31], s65 offen sc1 lds
    v_mfma_f32_16x16x32_bf16 a[112:115], v[40:43], v[64:67], a[112:115]
    ds_read_b64_tr_b16 v[50:51], v14 offset:33792
    ds_read_b64_tr_b16 v[52:53], v14 offset:40960
    v_mfma_f32_16x16x32_bf16 a[112:115], v[44:47], v[68:71], a[112:115]
    ds_read_b64_tr_b16 v[54:55], v14 offset:41984
    ds_read_b64_tr_b16 v[56:57], v15 offset:32768
    v_mfma_f32_16x16x32_bf16 a[116:119], v[40:43], v[72:75], a[116:119]
    ds_read_b64_tr_b16 v[58:59], v15 offset:33792
    ds_read_b64_tr_b16 v[60:61], v15 offset:40960
    v_mfma_f32_16x16x32_bf16 a[116:119], v[44:47], v[76:79], a[116:119]
    ds_read_b64_tr_b16 v[62:63], v15 offset:41984
    v_add_u32 v14, 0x10000, v14
    v_mfma_f32_16x16x32_bf16 a[120:123], v[40:43], v[80:83], a[120:123]
    v_add_u32 v15, 0x10000, v15
    v_mfma_f32_16x16x32_bf16 a[120:123], v[44:47], v[84:87], a[120:123]
    s_cmp_lt_u32 s99, 16
    s_cselect_b32 s64, s64, s9
    s_cselect_b32 s10, s10, 9216
    v_mfma_f32_16x16x32_bf16 a[124:127], v[40:43], v[88:91], a[124:127]
    s_lshl2_add_u32 s99, s100, s4
    ds_read_b64_tr_b16 v[40:41], v16 offset:32768
    ds_read_b64_tr_b16 v[42:43], v16 offset:33792
    v_mfma_f32_16x16x32_bf16 a[124:127], v[44:47], v[92:95], a[124:127]
    s_add_u32 s64, s64, s98
    ds_read_b64_tr_b16 v[44:45], v16 offset:40960
    ds_read_b64_tr_b16 v[46:47], v16 offset:41984
    s_waitcnt lgkmcnt(5)
    v_mfma_f32_16x16x32_bf16 v[128:131], v[48:51], v[96:99], v[128:131]
    s_lshl_b32 s99, s99, 1
    v_add_u32 v16, 0x10000, v16
    v_mfma_f32_16x16x32_bf16 v[128:131], v[52:55], v[100:103], v[128:131]
    s_add_u32 s62, s64, s10
    v_mfma_f32_16x16x32_bf16 v[132:135], v[48:51], v[104:107], v[132:135]
    s_lshr_b32 s9, s99, 2
    ds_read_b128 v[64:67], v24 offset:49152
    v_mfma_f32_16x16x32_bf16 v[132:135], v[52:55], v[108:111], v[132:135]
    s_lshr_b32 s10, s5, 3
    v_mfma_f32_16x16x32_bf16 v[136:139], v[48:51], v[112:115], v[136:139]
    s_sub_u32 s9, s9, s10
    v_mfma_f32_16x16x32_bf16 v[136:139], v[52:55], v[116:119], v[136:139]
    s_sub_u32 s9, s9, 1
    v_mfma_f32_16x16x32_bf16 v[140:143], v[48:51], v[120:123], v[140:143]
    s_and_b32 s9, s9, 3
    ds_read_b64_tr_b16 v[48:49], v17 offset:32768
    ds_read_b64_tr_b16 v[50:51], v17 offset:33792
    v_mfma_f32_16x16x32_bf16 v[140:143], v[52:55], v[124:127], v[140:143]
    s_lshl_b32 s9, s9, 1
    ds_read_b64_tr_b16 v[52:53], v17 offset:40960
    ds_read_b64_tr_b16 v[54:55], v17 offset:41984
    v_mfma_f32_16x16x32_bf16 v[144:147], v[56:59], v[96:99], v[144:147]
    s_and_b32 s10, s99, 3
    ds_read_b128 v[68:71], v25 offset:49152
    v_add_u32 v17, 0x10000, v17
    s_waitcnt lgkmcnt(5)
    v_mfma_f32_16x16x32_bf16 v[144:147], v[60:63], v[100:103], v[144:147]
    s_cmp_eq_u32 s9, 6
    s_cselect_b32 s9, 7, s9
    v_mfma_f32_16x16x32_bf16 v[148:151], v[56:59], v[104:107], v[148:151]
    s_mul_i32 s10, s10, 9
    v_mfma_f32_16x16x32_bf16 v[148:151], v[60:63], v[108:111], v[148:151]
    s_add_u32 s9, s9, s10
    v_mfma_f32_16x16x32_bf16 v[152:155], v[56:59], v[112:115], v[152:155]
    s_lshl_b32 s63, s9, 10
    v_mfma_f32_16x16x32_bf16 v[152:155], v[60:63], v[116:119], v[152:155]
    s_cmp_eq_u32 s4, 0
    s_cselect_b32 s8, 1.0, 0
    v_mfma_f32_16x16x32_bf16 v[156:159], v[56:59], v[120:123], v[156:159]
    s_add_u32 s63, s63, s7
    ds_read_b128 v[72:75], v24 offset:57344
    ds_read_b64_tr_b16 v[56:57], v18 offset:32768
    v_mfma_f32_16x16x32_bf16 v[156:159], v[60:63], v[124:127], v[156:159]
    ds_read_b64_tr_b16 v[58:59], v18 offset:33792
    ds_read_b64_tr_b16 v[60:61], v18 offset:40960
    v_mfma_f32_16x16x32_bf16 v[160:163], v[40:43], v[96:99], v[160:163]
    ds_read_b64_tr_b16 v[62:63], v18 offset:41984
    v_add_u32 v18, 0x10000, v18
    v_mfma_f32_16x16x32_bf16 v[160:163], v[44:47], v[100:103], v[160:163]
    s_cmp_eq_u32 s4, 1
    s_cselect_b32 s9, 1.0, 0
    v_mfma_f32_16x16x32_bf16 v[164:167], v[40:43], v[104:107], v[164:167]
    s_cmp_eq_u32 s6, 0
    s_cselect_b32 s16, s8, 0
    s_cselect_b32 s17, s9, 0
    v_mfma_f32_16x16x32_bf16 v[164:167], v[44:47], v[108:111], v[164:167]
    s_cmp_eq_u32 s4, 2
    s_cselect_b32 s10, 1.0, 0
    v_mfma_f32_16x16x32_bf16 v[168:171], v[40:43], v[112:115], v[168:171]
    buffer_load_dwordx4 v1, s[28:31], s65 offen offset:1024 sc1 lds
    v_mfma_f32_16x16x32_bf16 v[168:171], v[44:47], v[116:119], v[168:171]
    ds_read_b128 v[76:79], v25 offset:57344
    v_mfma_f32_16x16x32_bf16 v[172:175], v[40:43], v[120:123], v[172:175]
    ds_read_b64_tr_b16 v[40:41], v19 offset:32768
    ds_read_b64_tr_b16 v[42:43], v19 offset:33792
    v_mfma_f32_16x16x32_bf16 v[172:175], v[44:47], v[124:127], v[172:175]
    s_waitcnt lgkmcnt(3)
    ds_read_b64_tr_b16 v[44:45], v19 offset:40960
    ds_read_b64_tr_b16 v[46:47], v19 offset:41984
    v_mfma_f32_16x16x32_bf16 v[176:179], v[48:51], v[96:99], v[176:179]
    v_add_u32 v19, 0x10000, v19
    v_mfma_f32_16x16x32_bf16 v[176:179], v[52:55], v[100:103], v[176:179]
    s_cmp_eq_u32 s6, 0
    s_cselect_b32 s18, s10, 0
    s_cselect_b32 s19, s11, 0
    v_mfma_f32_16x16x32_bf16 v[180:183], v[48:51], v[104:107], v[180:183]
    s_cmp_eq_u32 s6, 0
    s_cselect_b32 s20, s12, 0
    s_cselect_b32 s21, s13, 0
    v_mfma_f32_16x16x32_bf16 v[180:183], v[52:55], v[108:111], v[180:183]
    v_add_u32 v24, 0x10000, v24
    v_mfma_f32_16x16x32_bf16 v[184:187], v[48:51], v[112:115], v[184:187]
    ds_read_b128 v[80:83], v24 offset:16384
    v_mfma_f32_16x16x32_bf16 v[184:187], v[52:55], v[116:119], v[184:187]
    s_cmp_eq_u32 s6, 0
    s_cselect_b32 s22, s14, 0
    s_cselect_b32 s23, s15, 0
    v_mfma_f32_16x16x32_bf16 v[188:191], v[48:51], v[120:123], v[188:191]
    ds_read_b64_tr_b16 v[48:49], v20 offset:32768
    ds_read_b64_tr_b16 v[50:51], v20 offset:33792
    v_mfma_f32_16x16x32_bf16 v[188:191], v[52:55], v[124:127], v[188:191]
    ds_read_b64_tr_b16 v[52:53], v20 offset:40960
    ds_read_b64_tr_b16 v[54:55], v20 offset:41984
    v_mfma_f32_16x16x32_bf16 v[192:195], v[56:59], v[96:99], v[192:195]
    v_add_u32 v20, 0x10000, v20
    v_mfma_f32_16x16x32_bf16 v[192:195], v[60:63], v[100:103], v[192:195]
    v_add_u32 v25, 0x10000, v25
    v_mfma_f32_16x16x32_bf16 v[196:199], v[56:59], v[104:107], v[196:199]
    ds_read_b128 v[84:87], v25 offset:16384
    v_mfma_f32_16x16x32_bf16 v[196:199], v[60:63], v[108:111], v[196:199]
    v_mfma_f32_16x16x32_bf16 v[200:203], v[56:59], v[112:115], v[200:203]
    v_mfma_f32_16x16x32_bf16 v[200:203], v[60:63], v[116:119], v[200:203]
    v_mfma_f32_16x16x32_bf16 v[204:207], v[56:59], v[120:123], v[204:207]
    ds_read_b64_tr_b16 v[56:57], v21 offset:32768
    ds_read_b64_tr_b16 v[58:59], v21 offset:33792
    v_mfma_f32_16x16x32_bf16 v[204:207], v[60:63], v[124:127], v[204:207]
    s_waitcnt lgkmcnt(2)
    ds_read_b64_tr_b16 v[60:61], v21 offset:40960
    ds_read_b64_tr_b16 v[62:63], v21 offset:41984
    v_mfma_f32_16x16x32_bf16 v[208:211], v[40:43], v[96:99], v[208:211]
    ds_read_b128 v[88:91], v24 offset:24576
    v_add_u32 v21, 0x10000, v21
    v_mfma_f32_16x16x32_bf16 v[208:211], v[44:47], v[100:103], v[208:211]
    v_mfma_f32_16x16x32_bf16 v[212:215], v[40:43], v[104:107], v[212:215]
    v_mfma_f32_16x16x32_bf16 v[212:215], v[44:47], v[108:111], v[212:215]
    v_mfma_f32_16x16x32_bf16 v[216:219], v[40:43], v[112:115], v[216:219]
    v_mfma_f32_16x16x32_bf16 v[216:219], v[44:47], v[116:119], v[216:219]
    v_mfma_f32_16x16x32_bf16 v[220:223], v[40:43], v[120:123], v[220:223]
    ds_read_b128 v[92:95], v25 offset:24576
    ds_read_b64_tr_b16 v[40:41], v14 offset:0
    v_mfma_f32_16x16x32_bf16 v[220:223], v[44:47], v[124:127], v[220:223]
    ds_read_b64_tr_b16 v[42:43], v14 offset:1024
    ds_read_b64_tr_b16 v[44:45], v14 offset:8192
    v_mfma_f32_16x16x32_bf16 v[224:227], v[48:51], v[96:99], v[224:227]
    ds_read_b64_tr_b16 v[46:47], v14 offset:9216
    v_mfma_f32_16x16x32_bf16 v[224:227], v[52:55], v[100:103], v[224:227]
    s_xor_b32 s65, s65, 8192
    v_mfma_f32_16x16x32_bf16 v[228:231], v[48:51], v[104:107], v[228:231]
    v_mfma_f32_16x16x32_bf16 v[228:231], v[52:55], v[108:111], v[228:231]
    v_mfma_f32_16x16x32_bf16 v[232:235], v[48:51], v[112:115], v[232:235]
    v_mfma_f32_16x16x32_bf16 v[232:235], v[52:55], v[116:119], v[232:235]
    v_mfma_f32_16x16x32_bf16 v[236:239], v[48:51], v[120:123], v[236:239]
    ds_read_b64_tr_b16 v[48:49], v15 offset:0
    ds_read_b64_tr_b16 v[50:51], v15 offset:1024
    v_mfma_f32_16x16x32_bf16 v[236:239], v[52:55], v[124:127], v[236:239]
    s_waitcnt lgkmcnt(2)
    ds_read_b64_tr_b16 v[52:53], v15 offset:8192
    ds_read_b64_tr_b16 v[54:55], v15 offset:9216
    v_mfma_f32_16x16x32_bf16 v[240:243], v[56:59], v[96:99], v[240:243]
    v_mfma_f32_16x16x32_bf16 v[240:243], v[60:63], v[100:103], v[240:243]
    v_mfma_f32_16x16x32_bf16 v[244:247], v[56:59], v[104:107], v[244:247]
    v_mfma_f32_16x16x32_bf16 v[244:247], v[60:63], v[108:111], v[244:247]
    v_mfma_f32_16x16x32_bf16 v[248:251], v[56:59], v[112:115], v[248:251]
    v_mfma_f32_16x16x32_bf16 v[248:251], v[60:63], v[116:119], v[248:251]
    v_mfma_f32_16x16x32_bf16 v[252:255], v[56:59], v[120:123], v[252:255]
    ds_read_b64_tr_b16 v[56:57], v16 offset:0
    ds_read_b64_tr_b16 v[58:59], v16 offset:1024
    v_mfma_f32_16x16x32_bf16 v[252:255], v[60:63], v[124:127], v[252:255]
    buffer_load_dword v7, v8, s[32:35], s61 offen sc1
    v_mfma_f32_16x16x32_bf16 v[128:131], v[40:43], v[64:67], v[128:131]
    ds_read_b64_tr_b16 v[60:61], v16 offset:8192
    ds_read_b64_tr_b16 v[62:63], v16 offset:9216
    v_mfma_f32_16x16x32_bf16 v[128:131], v[44:47], v[68:71], v[128:131]
    v_mfma_f32_16x16x32_bf16 v[132:135], v[40:43], v[72:75], v[132:135]
    v_mfma_f32_16x16x32_bf16 v[132:135], v[44:47], v[76:79], v[132:135]
    v_mfma_f32_16x16x32_bf16 v[136:139], v[40:43], v[80:83], v[136:139]
    v_mfma_f32_16x16x32_bf16 v[136:139], v[44:47], v[84:87], v[136:139]
    v_mfma_f32_16x16x32_bf16 v[140:143], v[40:43], v[88:91], v[140:143]
    ds_read_b64_tr_b16 v[40:41], v17 offset:0
    ds_read_b64_tr_b16 v[42:43], v17 offset:1024
    v_mfma_f32_16x16x32_bf16 v[140:143], v[44:47], v[92:95], v[140:143]
    s_waitcnt lgkmcnt(2)
    ds_read_b64_tr_b16 v[44:45], v17 offset:8192
    ds_read_b64_tr_b16 v[46:47], v17 offset:9216
    v_mfma_f32_16x16x32_bf16 v[144:147], v[48:51], v[64:67], v[144:147]
    v_cvt_pk_bf16_f32 v128, v128, v129
    v_cvt_pk_bf16_f32 v129, v130, v131
    v_mfma_f32_16x16x32_bf16 v[144:147], v[52:55], v[68:71], v[144:147]
    v_cvt_pk_bf16_f32 v132, v132, v133
    v_cvt_pk_bf16_f32 v133, v134, v135
    v_mfma_f32_16x16x32_bf16 v[148:151], v[48:51], v[72:75], v[148:151]
    v_cvt_pk_bf16_f32 v136, v136, v137
    v_cvt_pk_bf16_f32 v137, v138, v139
    v_mfma_f32_16x16x32_bf16 v[148:151], v[52:55], v[76:79], v[148:151]
    v_cvt_pk_bf16_f32 v140, v140, v141
    v_cvt_pk_bf16_f32 v141, v142, v143
    v_mfma_f32_16x16x32_bf16 v[152:155], v[48:51], v[80:83], v[152:155]
    v_cvt_pk_bf16_f32 v130, v144, v145
    v_cvt_pk_bf16_f32 v131, v146, v147
    v_mfma_f32_16x16x32_bf16 v[152:155], v[52:55], v[84:87], v[152:155]
    v_mfma_f32_16x16x32_bf16 v[156:159], v[48:51], v[88:91], v[156:159]
    ds_read_b64_tr_b16 v[48:49], v18 offset:0
    ds_read_b64_tr_b16 v[50:51], v18 offset:1024
    v_mfma_f32_16x16x32_bf16 v[156:159], v[52:55], v[92:95], v[156:159]
    ds_read_b64_tr_b16 v[52:53], v18 offset:8192
    ds_read_b64_tr_b16 v[54:55], v18 offset:9216
    v_mfma_f32_16x16x32_bf16 v[160:163], v[56:59], v[64:67], v[160:163]
    v_cvt_pk_bf16_f32 v134, v148, v149
    v_cvt_pk_bf16_f32 v135, v150, v151
    v_mfma_f32_16x16x32_bf16 v[160:163], v[60:63], v[68:71], v[160:163]
    v_cvt_pk_bf16_f32 v138, v152, v153
    v_cvt_pk_bf16_f32 v139, v154, v155
    v_mfma_f32_16x16x32_bf16 v[164:167], v[56:59], v[72:75], v[164:167]
    v_cvt_pk_bf16_f32 v142, v156, v157
    v_cvt_pk_bf16_f32 v143, v158, v159
    v_mfma_f32_16x16x32_bf16 v[164:167], v[60:63], v[76:79], v[164:167]
    v_mfma_f32_16x16x32_bf16 v[168:171], v[56:59], v[80:83], v[168:171]
    v_mfma_f32_16x16x32_bf16 v[168:171], v[60:63], v[84:87], v[168:171]
    v_cvt_pk_bf16_f32 v160, v160, v161
    v_cvt_pk_bf16_f32 v161, v162, v163
    v_mfma_f32_16x16x32_bf16 v[172:175], v[56:59], v[88:91], v[172:175]
    ds_read_b64_tr_b16 v[56:57], v19 offset:0
    ds_read_b64_tr_b16 v[58:59], v19 offset:1024
    v_mfma_f32_16x16x32_bf16 v[172:175], v[60:63], v[92:95], v[172:175]
    s_waitcnt lgkmcnt(2)
    ds_read_b64_tr_b16 v[60:61], v19 offset:8192
    ds_read_b64_tr_b16 v[62:63], v19 offset:9216
    v_mfma_f32_16x16x32_bf16 v[176:179], v[40:43], v[64:67], v[176:179]
    v_cvt_pk_bf16_f32 v164, v164, v165
    v_cvt_pk_bf16_f32 v165, v166, v167
    v_mfma_f32_16x16x32_bf16 v[176:179], v[44:47], v[68:71], v[176:179]
    v_cvt_pk_bf16_f32 v168, v168, v169
    v_cvt_pk_bf16_f32 v169, v170, v171
    v_mfma_f32_16x16x32_bf16 v[180:183], v[40:43], v[72:75], v[180:183]
    v_cvt_pk_bf16_f32 v172, v172, v173
    v_cvt_pk_bf16_f32 v173, v174, v175
    v_mfma_f32_16x16x32_bf16 v[180:183], v[44:47], v[76:79], v[180:183]
    v_mfma_f32_16x16x32_bf16 v[184:187], v[40:43], v[80:83], v[184:187]
    v_mfma_f32_16x16x32_bf16 v[184:187], v[44:47], v[84:87], v[184:187]
    v_cvt_pk_bf16_f32 v162, v176, v177
    v_cvt_pk_bf16_f32 v163, v178, v179
    v_mfma_f32_16x16x32_bf16 v[188:191], v[40:43], v[88:91], v[188:191]
    ds_read_b64_tr_b16 v[40:41], v20 offset:0
    ds_read_b64_tr_b16 v[42:43], v20 offset:1024
    v_mfma_f32_16x16x32_bf16 v[188:191], v[44:47], v[92:95], v[188:191]
    ds_read_b64_tr_b16 v[44:45], v20 offset:8192
    ds_read_b64_tr_b16 v[46:47], v20 offset:9216
    v_mfma_f32_16x16x32_bf16 v[192:195], v[48:51], v[64:67], v[192:195]
    v_cvt_pk_bf16_f32 v166, v180, v181
    v_cvt_pk_bf16_f32 v167, v182, v183
    v_mfma_f32_16x16x32_bf16 v[192:195], v[52:55], v[68:71], v[192:195]
    v_cvt_pk_bf16_f32 v170, v184, v185
    v_cvt_pk_bf16_f32 v171, v186, v187
    s_waitcnt vmcnt(0)
    v_cmp_gt_u32 vcc, 1, v7
    s_nop 1
    s_and_b64 vcc, vcc, exec
    s_cbranch_scc1 SPIN_KV
BACK_KV:
    v_mfma_f32_16x16x32_bf16 v[196:199], v[48:51], v[72:75], v[196:199]
    s_mov_b32 s77, s75
    buffer_load_dwordx4 a[224:227], v1, s[36:39], 0 offen offset:0 sc1
    v_mfma_f32_16x16x32_bf16 v[196:199], v[52:55], v[76:79], v[196:199]
    buffer_load_dwordx4 a[228:231], v1, s[36:39], 0 offen offset:1024 sc1
    v_mfma_f32_16x16x32_bf16 v[200:203], v[48:51], v[80:83], v[200:203]
    v_cmp_le_i32 vcc, 0, v36
    v_cvt_pk_bf16_f32 v192, v192, v193
    v_mfma_f32_16x16x32_bf16 v[200:203], v[52:55], v[84:87], v[200:203]
    v_cvt_pk_bf16_f32 v193, v194, v195
    v_cvt_pk_bf16_f32 v174, v188, v189
    v_mfma_f32_16x16x32_bf16 v[204:207], v[48:51], v[88:91], v[204:207]
    buffer_load_dwordx4 a[232:235], v1, s[36:39], 0 offen offset:2048 sc1
    v_mfma_f32_16x16x32_bf16 v[204:207], v[52:55], v[92:95], v[204:207]
    s_waitcnt lgkmcnt(0)
    ds_read_b64_tr_b16 v[48:49], v21 offset:0
    ds_read_b64_tr_b16 v[50:51], v21 offset:1024
    v_mfma_f32_16x16x32_bf16 v[208:211], v[56:59], v[64:67], v[208:211]
    ds_read_b64_tr_b16 v[52:53], v21 offset:8192
    ds_read_b64_tr_b16 v[54:55], v21 offset:9216
    v_mfma_f32_16x16x32_bf16 v[208:211], v[60:63], v[68:71], v[208:211]
    v_cvt_pk_bf16_f32 v196, v196, v197
    v_cvt_pk_bf16_f32 v197, v198, v199
    v_mfma_f32_16x16x32_bf16 v[212:215], v[56:59], v[72:75], v[212:215]
    buffer_load_dwordx4 a[236:239], v1, s[36:39], 0 offen offset:3072 sc1
    v_mfma_f32_16x16x32_bf16 v[212:215], v[60:63], v[76:79], v[212:215]
    v_cvt_pk_bf16_f32 v200, v200, v201
    v_cvt_pk_bf16_f32 v201, v202, v203
    v_mfma_f32_16x16x32_bf16 v[216:219], v[56:59], v[80:83], v[216:219]
    v_cvt_pk_bf16_f32 v194, v208, v209
    v_cndmask_b32_e64 v208, v37, 0, vcc
    v_mfma_f32_16x16x32_bf16 v[216:219], v[60:63], v[84:87], v[216:219]
    v_mul_f32 v176, s16, v208
    v_cmp_le_i32 vcc, 1, v36
    v_mfma_f32_16x16x32_bf16 v[220:223], v[56:59], v[88:91], v[220:223]
    v_cvt_pk_bf16_f32 v195, v210, v211
    v_cndmask_b32_e64 v209, v37, 0, vcc
    v_mfma_f32_16x16x32_bf16 v[220:223], v[60:63], v[92:95], v[220:223]
    v_mul_f32 v177, s16, v209
    v_cmp_le_i32 vcc, 2, v36
    v_mfma_f32_16x16x32_bf16 v[224:227], v[40:43], v[64:67], v[224:227]
    s_mov_b32 s38, 16384
    v_cndmask_b32_e64 v210, v37, 0, vcc
    v_mul_f32 v178, s16, v210
    v_mfma_f32_16x16x32_bf16 v[224:227], v[44:47], v[68:71], v[224:227]
    s_add_u32 m0, s76, s75
    v_cmp_le_i32 vcc, 3, v36
    v_cvt_pk_bf16_f32 v198, v212, v213
    v_mfma_f32_16x16x32_bf16 v[228:231], v[40:43], v[72:75], v[228:231]
    buffer_load_dwordx4 v1, s[36:39], s77 offen sc1 lds
    v_mfma_f32_16x16x32_bf16 v[228:231], v[44:47], v[76:79], v[228:231]
    v_cndmask_b32_e64 v211, v37, 0, vcc
    v_mul_f32 v179, s16, v211
    v_mfma_f32_16x16x32_bf16 v[232:235], v[40:43], v[80:83], v[232:235]
    v_cvt_pk_bf16_f32 v224, v224, v225
    v_cvt_pk_bf16_f32 v225, v226, v227
    v_mfma_f32_16x16x32_bf16 v[232:235], v[44:47], v[84:87], v[232:235]
    s_waitcnt vmcnt(6) lgkmcnt(0)
    s_barrier
    ds_read_b64_tr_b16 v[56:57], v26 offset:32768
    v_mfma_f32_16x16x32_bf16 v[236:239], v[40:43], v[88:91], v[236:239]
    buffer_load_dwordx4 v1, s[36:39], s77 offen offset:1024 sc1 lds
    v_mfma_f32_16x16x32_bf16 v[236:239], v[44:47], v[92:95], v[236:239]
    ds_read_b64_tr_b16 v[58:59], v26 offset:33280
    ds_read_b64_tr_b16 v[60:61], v26 offset:36864
    v_mfma_f32_16x16x32_bf16 v[240:243], v[48:51], v[64:67], v[240:243]
    ds_read_b64_tr_b16 v[62:63], v26 offset:37376
    ds_read_b64_tr_b16 v[40:41], v27 offset:32768
    v_mfma_f32_16x16x32_bf16 v[240:243], v[52:55], v[68:71], v[240:243]
    ds_read_b64_tr_b16 v[42:43], v27 offset:33280
    ds_read_b64_tr_b16 v[44:45], v27 offset:36864
    v_mfma_f32_16x16x32_bf16 v[244:247], v[48:51], v[72:75], v[244:247]
    buffer_load_dwordx4 v1, s[36:39], s77 offen offset:2048 sc1 lds
    v_mfma_f32_16x16x32_bf16 v[244:247], v[52:55], v[76:79], v[244:247]
    ds_read_b64_tr_b16 v[46:47], v27 offset:37376
    v_add_u32 v26, 0x10000, v26
    v_mfma_f32_16x16x32_bf16 v[248:251], v[48:51], v[80:83], v[248:251]
    v_add_u32 v27, 0x10000, v27
    v_cvt_pk_bf16_f32 v226, v240, v241
    v_mfma_f32_16x16x32_bf16 v[248:251], v[52:55], v[84:87], v[248:251]
    v_cvt_pk_bf16_f32 v227, v242, v243
    v_cvt_pk_bf16_f32 v228, v228, v229
    v_mfma_f32_16x16x32_bf16 v[252:255], v[48:51], v[88:91], v[252:255]
    buffer_load_dwordx4 v1, s[36:39], s77 offen offset:3072 sc1 lds
    v_mfma_f32_16x16x32_bf16 v[252:255], v[52:55], v[92:95], v[252:255]
    s_waitcnt lgkmcnt(1)
    ds_read_b64_tr_b16 v[48:49], v28 offset:32768
    ds_read_b64_tr_b16 v[50:51], v28 offset:33280
    v_mfma_f32_16x16x32_bf16 a[64:67], v[56:59], v[96:99], a[64:67]
    s_add_u32 s100, s77, 4096
    ds_read_b64_tr_b16 v[52:53], v28 offset:36864
    ds_read_b64_tr_b16 v[54:55], v28 offset:37376
    v_mfma_f32_16x16x32_bf16 a[64:67], v[60:63], v[100:103], a[64:67]
    s_add_u32 m0, m0, 4096
    v_add_u32 v28, 0x10000, v28
    v_cvt_pk_bf16_f32 v229, v230, v231
    v_mfma_f32_16x16x32_bf16 a[68:71], v[56:59], v[104:107], a[68:71]
    buffer_load_dwordx4 v1, s[36:39], s100 offen sc1 lds
    v_mfma_f32_16x16x32_bf16 a[68:71], v[60:63], v[108:111], a[68:71]
    v_cvt_pk_bf16_f32 v230, v244, v245
    v_cvt_pk_bf16_f32 v231, v246, v247
    v_mfma_f32_16x16x32_bf16 a[72:75], v[56:59], v[112:115], a[72:75]
    v_cvt_pk_bf16_f32 v199, v214, v215
    v_cvt_pk_bf16_f32 v232, v232, v233
    v_mfma_f32_16x16x32_bf16 a[72:75], v[60:63], v[116:119], a[72:75]
    v_cvt_pk_bf16_f32 v233, v234, v235
    v_cvt_pk_bf16_f32 v234, v248, v249
    v_mfma_f32_16x16x32_bf16 a[76:79], v[56:59], v[120:123], a[76:79]
    buffer_load_dwordx4 v1, s[36:39], s100 offen offset:1024 sc1 lds
    v_mfma_f32_16x16x32_bf16 a[76:79], v[60:63], v[124:127], a[76:79]
    ds_read_b64_tr_b16 v[56:57], v29 offset:32768
    ds_read_b64_tr_b16 v[58:59], v29 offset:33280
    v_mfma_f32_16x16x32_bf16 a[80:83], v[40:43], v[96:99], a[80:83]
    s_waitcnt lgkmcnt(2)
    ds_read_b64_tr_b16 v[60:61], v29 offset:36864
    ds_read_b64_tr_b16 v[62:63], v29 offset:37376
    v_mfma_f32_16x16x32_bf16 a[80:83], v[44:47], v[100:103], a[80:83]
    v_add_u32 v29, 0x10000, v29
    v_cvt_pk_bf16_f32 v235, v250, v251
    v_mfma_f32_16x16x32_bf16 a[84:87], v[40:43], v[104:107], a[84:87]
    buffer_load_dwordx4 v1, s[36:39], s100 offen offset:2048 sc1 lds
    v_mfma_f32_16x16x32_bf16 a[84:87], v[44:47], v[108:111], a[84:87]
    v_cvt_pk_bf16_f32 v202, v216, v217
    v_cvt_pk_bf16_f32 v203, v218, v219
    v_mfma_f32_16x16x32_bf16 a[88:91], v[40:43], v[112:115], a[88:91]
    v_cvt_pk_bf16_f32 v175, v190, v191
    v_cvt_pk_bf16_f32 v236, v236, v237
    v_mfma_f32_16x16x32_bf16 a[88:91], v[44:47], v[116:119], a[88:91]
    v_cvt_pk_bf16_f32 v237, v238, v239
    v_cvt_pk_bf16_f32 v238, v252, v253
    v_mfma_f32_16x16x32_bf16 a[92:95], v[40:43], v[120:123], a[92:95]
    buffer_load_dwordx4 v1, s[36:39], s100 offen offset:3072 sc1 lds
    v_mfma_f32_16x16x32_bf16 a[92:95], v[44:47], v[124:127], a[92:95]
    s_waitcnt vmcnt(8)
    ds_read_b64_tr_b16 v[40:41], v26 offset:0
    ds_read_b64_tr_b16 v[42:43], v26 offset:512
    v_mfma_f32_16x16x32_bf16 v[240:243], a[224:227], v[128:131], v[176:179]
    s_lshr_b32 s82, s4, 1
    s_add_u32 s82, s82, 32
    ds_read_b64_tr_b16 v[44:45], v26 offset:4096
    v_mfma_f32_16x16x32_bf16 v[240:243], a[228:231], v[160:163], v[240:243]
    s_sub_u32 s82, s82, s6
    ds_read_b64_tr_b16 v[46:47], v26 offset:4608
    v_cvt_pk_bf16_f32 v239, v254, v255
    v_mfma_f32_16x16x32_bf16 v[240:243], a[232:235], v[192:195], v[240:243]
    s_add_u32 s76, s76, 32768
    s_sub_u32 s82, s82, s6
    v_cvt_pk_bf16_f32 v204, v204, v205
    v_mfma_f32_16x16x32_bf16 v[240:243], a[236:239], v[224:227], v[240:243]
    s_add_u32 s77, s77, 32768
    s_lshl_b32 s38, s82, 15
    s_add_u32 m0, s76, s75
    v_mfma_f32_16x16x32_bf16 v[244:247], a[224:227], v[132:135], 0
    s_mov_b32 s82, 0
    buffer_load_dwordx4 v1, s[36:39], s77 offen sc1 lds
    v_mfma_f32_16x16x32_bf16 v[244:247], a[228:231], v[164:167], v[244:247]
    v_cvt_pk_bf16_f32 v205, v206, v207
    v_max3_f32 v147, v240, v241, v242
    v_mfma_f32_16x16x32_bf16 v[244:247], a[232:235], v[196:199], v[244:247]
    buffer_load_dwordx4 v1, s[36:39], s77 offen offset:1024 sc1 lds
    v_mfma_f32_16x16x32_bf16 v[244:247], a[236:239], v[228:231], v[244:247]
    v_max_f32 v147, v147, v243
    v_mov_b32 v146, v147
    v_mfma_f32_16x16x32_bf16 v[248:251], a[224:227], v[136:139], 0
    v_cvt_pk_bf16_f32 v206, v220, v221
    v_permlane32_swap_b32 v147, v146
    v_mfma_f32_16x16x32_bf16 v[248:251], a[228:231], v[168:171], v[248:251]
    v_max_f32 v147, v147, v146
    v_mov_b32 v146, v147
    v_mfma_f32_16x16x32_bf16 v[248:251], a[232:235], v[200:203], v[248:251]
    buffer_load_dwordx4 v1, s[36:39], s77 offen offset:2048 sc1 lds
    v_mfma_f32_16x16x32_bf16 v[248:251], a[236:239], v[232:235], v[248:251]
    v_max3_f32 v151, v244, v245, v246
    v_max_f32 v151, v151, v247
    v_mfma_f32_16x16x32_bf16 v[252:255], a[224:227], v[140:143], 0
    v_mov_b32 v150, v151
    v_permlane16_swap_b32 v147, v146
    v_mfma_f32_16x16x32_bf16 v[252:255], a[228:231], v[172:175], v[252:255]
    v_permlane32_swap_b32 v151, v150
    v_max_f32 v151, v151, v150
    v_cvt_pk_bf16_f32 v207, v222, v223
    s_nop 1
    v_mfma_f32_16x16x32_bf16 v[252:255], a[232:235], v[204:207], v[252:255]
    buffer_load_dwordx4 v1, s[36:39], s77 offen offset:3072 sc1 lds
    v_mfma_f32_16x16x32_bf16 v[252:255], a[236:239], v[236:239], v[252:255]
    v_max3_f32 v155, v248, v249, v250
    v_max_f32 v155, v155, v251
    v_mfma_f32_16x16x32_bf16 a[96:99], v[48:51], v[96:99], a[96:99]
    s_add_u32 s100, s77, 4096
    v_mov_b32 v154, v155
    v_mov_b32 v150, v151
    v_mfma_f32_16x16x32_bf16 a[96:99], v[52:55], v[100:103], a[96:99]
    s_add_u32 m0, m0, 4096
    v_max3_f32 v159, v252, v253, v254
    v_max_f32 v159, v159, v255
    v_mfma_f32_16x16x32_bf16 a[100:103], v[48:51], v[104:107], a[100:103]
    buffer_load_dwordx4 v1, s[36:39], s100 offen sc1 lds
    v_mfma_f32_16x16x32_bf16 a[100:103], v[52:55], v[108:111], a[100:103]
    v_mov_b32 v158, v159
    v_permlane32_swap_b32 v155, v154
    v_mfma_f32_16x16x32_bf16 a[104:107], v[48:51], v[112:115], a[104:107]
    v_permlane32_swap_b32 v159, v158
    v_max_f32 v155, v155, v154
    v_mfma_f32_16x16x32_bf16 a[104:107], v[52:55], v[116:119], a[104:107]
    v_max_f32 v159, v159, v158
    v_mov_b32 v154, v155
    v_mfma_f32_16x16x32_bf16 a[108:111], v[48:51], v[120:123], a[108:111]
    buffer_load_dwordx4 v1, s[36:39], s100 offen offset:1024 sc1 lds
    v_mfma_f32_16x16x32_bf16 a[108:111], v[52:55], v[124:127], a[108:111]
    s_waitcnt lgkmcnt(0)
    ds_read_b64_tr_b16 v[48:49], v27 offset:0
    ds_read_b64_tr_b16 v[50:51], v27 offset:512
    v_mfma_f32_16x16x32_bf16 a[112:115], v[56:59], v[96:99], a[112:115]
    ds_read_b64_tr_b16 v[52:53], v27 offset:4096
    ds_read_b64_tr_b16 v[54:55], v27 offset:4608
    v_mfma_f32_16x16x32_bf16 a[112:115], v[60:63], v[100:103], a[112:115]
    v_mov_b32 v158, v159
    v_permlane16_swap_b32 v151, v150
    v_mfma_f32_16x16x32_bf16 a[116:119], v[56:59], v[104:107], a[116:119]
    buffer_load_dwordx4 v1, s[36:39], s100 offen offset:2048 sc1 lds
    v_mfma_f32_16x16x32_bf16 a[116:119], v[60:63], v[108:111], a[116:119]
    v_permlane16_swap_b32 v155, v154
    v_permlane16_swap_b32 v159, v158
    v_mfma_f32_16x16x32_bf16 a[120:123], v[56:59], v[112:115], a[120:123]
    v_max_f32 v147, v147, v146
    v_max_f32 v151, v151, v150
    v_mfma_f32_16x16x32_bf16 a[120:123], v[60:63], v[116:119], a[120:123]
    v_max_f32 v155, v155, v154
    v_max_f32 v159, v159, v158
    v_mfma_f32_16x16x32_bf16 a[124:127], v[56:59], v[120:123], a[124:127]
    buffer_load_dwordx4 v1, s[36:39], s100 offen offset:3072 sc1 lds
    v_mfma_f32_16x16x32_bf16 a[124:127], v[60:63], v[124:127], a[124:127]
    ds_read_b64_tr_b16 v[56:57], v28 offset:0
    ds_read_b64_tr_b16 v[58:59], v28 offset:512
    v_mfma_f32_16x16x32_bf16 a[64:67], v[40:43], v[64:67], a[64:67]
    s_add_u32 s76, s76, 32768
    ds_read_b64_tr_b16 v[60:61], v28 offset:4096
    ds_read_b64_tr_b16 v[62:63], v28 offset:4608
    v_mfma_f32_16x16x32_bf16 a[64:67], v[44:47], v[68:71], a[64:67]
    s_add_u32 s77, s77, 32768
    v_sub_f32 v144, 0, v147
    v_sub_f32 v148, 0, v151
    v_mfma_f32_16x16x32_bf16 a[68:71], v[40:43], v[72:75], a[68:71]
    s_add_u32 m0, s76, s75
    v_sub_f32 v152, 0, v155
    v_sub_f32 v156, 0, v159
    v_mfma_f32_16x16x32_bf16 a[68:71], v[44:47], v[76:79], a[68:71]
    buffer_load_dwordx4 v1, s[36:39], s77 offen sc1 lds
    v_mfma_f32_16x16x32_bf16 a[72:75], v[40:43], v[80:83], a[72:75]
    v_sub_f32 v145, 0, v147
    v_sub_f32 v146, 0, v147
    v_mfma_f32_16x16x32_bf16 a[72:75], v[44:47], v[84:87], a[72:75]
    v_sub_f32 v147, 0, v147
    v_sub_f32 v149, 0, v151
    v_mfma_f32_16x16x32_bf16 a[76:79], v[40:43], v[88:91], a[76:79]
    buffer_load_dwordx4 v1, s[36:39], s77 offen offset:1024 sc1 lds
    v_mfma_f32_16x16x32_bf16 a[76:79], v[44:47], v[92:95], a[76:79]
    s_waitcnt lgkmcnt(0)
    ds_read_b64_tr_b16 v[40:41], v29 offset:0
    ds_read_b64_tr_b16 v[42:43], v29 offset:512
    v_mfma_f32_16x16x32_bf16 a[80:83], v[48:51], v[64:67], a[80:83]
    ds_read_b64_tr_b16 v[44:45], v29 offset:4096
    ds_read_b64_tr_b16 v[46:47], v29 offset:4608
    v_mfma_f32_16x16x32_bf16 a[80:83], v[52:55], v[68:71], a[80:83]
    v_sub_f32 v150, 0, v151
    v_sub_f32 v151, 0, v151
    v_mfma_f32_16x16x32_bf16 a[84:87], v[48:51], v[72:75], a[84:87]
    buffer_load_dwordx4 v1, s[36:39], s77 offen offset:2048 sc1 lds
    v_mfma_f32_16x16x32_bf16 a[84:87], v[52:55], v[76:79], a[84:87]
    v_sub_f32 v153, 0, v155
    v_sub_f32 v154, 0, v155
    v_mfma_f32_16x16x32_bf16 a[88:91], v[48:51], v[80:83], a[88:91]
    v_sub_f32 v155, 0, v155
    v_sub_f32 v157, 0, v159
    v_mfma_f32_16x16x32_bf16 a[88:91], v[52:55], v[84:87], a[88:91]
    v_sub_f32 v158, 0, v159
    v_sub_f32 v159, 0, v159
    v_mfma_f32_16x16x32_bf16 a[92:95], v[48:51], v[88:91], a[92:95]
    buffer_load_dwordx4 v1, s[36:39], s77 offen offset:3072 sc1 lds
    v_mfma_f32_16x16x32_bf16 a[92:95], v[52:55], v[92:95], a[92:95]
    v_or_b32 v215, 0x44444444, v38
    v_bfe_u32 v38, v1, 5, 1
    v_mfma_f32_16x16x32_bf16 a[96:99], v[56:59], v[64:67], a[96:99]
    s_add_u32 s100, s77, 4096
    v_cmp_eq_u32 vcc, 0, v38
    v_mov_b32 v38, 0x3f803f80
    v_mfma_f32_16x16x32_bf16 a[96:99], v[60:63], v[68:71], a[96:99]
    s_add_u32 m0, m0, 4096
    v_and_b32 v29, 0x380, v1
    v_cndmask_b32 v38, 0, v38, vcc
    v_mfma_f32_16x16x32_bf16 a[100:103], v[56:59], v[72:75], a[100:103]
    buffer_load_dwordx4 v1, s[36:39], s100 offen sc1 lds
    v_mfma_f32_16x16x32_bf16 a[100:103], v[60:63], v[76:79], a[100:103]
    v_add_f32 v240, v240, v144
    v_add_f32 v241, v241, v144
    v_mfma_f32_16x16x32_bf16 a[104:107], v[56:59], v[80:83], a[104:107]
    v_add_f32 v242, v242, v144
    v_add_f32 v243, v243, v144
    v_mfma_f32_16x16x32_bf16 a[104:107], v[60:63], v[84:87], a[104:107]
    s_waitcnt vmcnt(13) lgkmcnt(0)
    s_barrier
    ds_read_b128 a[240:243], v2 offset:4096
    v_mfma_f32_16x16x32_bf16 a[108:111], v[56:59], v[88:91], a[108:111]
    ds_read_b128 a[244:247], v2 offset:5120
    ds_read_b128 a[248:251], v2 offset:6144
    v_mfma_f32_16x16x32_bf16 a[108:111], v[60:63], v[92:95], a[108:111]
    buffer_load_dwordx4 v1, s[36:39], s100 offen offset:1024 sc1 lds
    v_mfma_f32_16x16x32_bf16 a[112:115], v[40:43], v[64:67], a[112:115]
    ds_read_b128 a[252:255], v2 offset:7168
    v_add_f32 v244, v244, v148
    v_mfma_f32_16x16x32_bf16 a[112:115], v[44:47], v[68:71], a[112:115]
    v_add_f32 v245, v245, v148
    v_add_f32 v246, v246, v148
    v_mfma_f32_16x16x32_bf16 a[116:119], v[40:43], v[72:75], a[116:119]
    buffer_load_dwordx4 v1, s[36:39], s100 offen offset:2048 sc1 lds
    v_mfma_f32_16x16x32_bf16 a[116:119], v[44:47], v[76:79], a[116:119]
    v_add_f32 v247, v247, v148
    v_add_f32 v248, v248, v152
    v_mfma_f32_16x16x32_bf16 a[120:123], v[40:43], v[80:83], a[120:123]
    v_add_f32 v249, v249, v152
    v_add_f32 v250, v250, v152
    v_mfma_f32_16x16x32_bf16 a[120:123], v[44:47], v[84:87], a[120:123]
    v_add_f32 v251, v251, v152
    v_add_f32 v252, v252, v156
    v_mfma_f32_16x16x32_bf16 a[124:127], v[40:43], v[88:91], a[124:127]
    buffer_load_dwordx4 v1, s[36:39], s100 offen offset:3072 sc1 lds
    v_mfma_f32_16x16x32_bf16 a[124:127], v[44:47], v[92:95], a[124:127]
    v_add_f32 v253, v253, v156
    v_add_f32 v254, v254, v156
    v_add_f32 v255, v255, v156
    v_lshl_add_u32 v29, v29, 4, v39
    v_bfe_u32 v39, v1, 2, 4
    v_accvgpr_write_b32 a136, v38
    v_accvgpr_write_b32 a137, v38
    v_accvgpr_write_b32 a138, v38
    v_accvgpr_write_b32 a139, v38
    v_exp_f32 v240, v240
    v_exp_f32 v241, v241
    v_exp_f32 v242, v242
    v_exp_f32 v243, v243
    v_exp_f32 v244, v244
    v_exp_f32 v245, v245
    v_exp_f32 v246, v246
    v_exp_f32 v247, v247
    v_exp_f32 v248, v248
    v_exp_f32 v249, v249
    v_exp_f32 v250, v250
    v_exp_f32 v251, v251
    v_exp_f32 v252, v252
    v_exp_f32 v253, v253
    v_exp_f32 v254, v254
    v_exp_f32 v255, v255
    buffer_store_dwordx4 a[68:71], v1, s[40:43], s84 offen offset:2048 sc1
    buffer_store_dwordx4 a[76:79], v1, s[40:43], s85 offen offset:2048 sc1
    buffer_store_dwordx4 a[84:87], v1, s[40:43], s84 offen offset:1024 sc1
    buffer_store_dwordx4 a[92:95], v1, s[40:43], s85 offen offset:1024 sc1
    buffer_store_dwordx4 a[100:103], v1, s[40:43], s84 offen offset:0 sc1
    buffer_store_dwordx4 a[108:111], v1, s[40:43], s85 offen offset:0 sc1
    v_lshl_add_u32 v29, v29, 1, v39
    s_add_u32 s77, s77, 32768
    s_add_u32 s76, s76, 32768
K1_ATT:
    v_cvt_pk_bf16_f32 v32, v240, v241
    v_cvt_pk_bf16_f32 v33, v242, v243
    v_add_f32 v213, s21, v144
    v_fma_f32 v180, v208, s17, v213
    v_fma_f32 v181, v209, s17, v213
    v_fma_f32 v182, v210, s17, v213
    v_fma_f32 v183, v211, s17, v213
    s_nop 1
    s_waitcnt lgkmcnt(0)
    v_mfma_f32_16x16x32_bf16 v[240:243], a[240:243], v[128:131], v[180:183]
    s_mov_b32 s99, s76
    v_cvt_pk_bf16_f32 v40, v244, v245
    v_cvt_pk_bf16_f32 v41, v246, v247
    v_mfma_f32_16x16x32_bf16 v[240:243], a[244:247], v[160:163], v[240:243]
    s_sub_u32 s7, 15, s6
    v_cvt_pk_bf16_f32 v48, v248, v249
    v_cvt_pk_bf16_f32 v49, v250, v251
    v_mfma_f32_16x16x32_bf16 v[240:243], a[248:251], v[192:195], v[240:243]
    s_lshl3_add_u32 s80, s6, s4
    ds_read_b128 a[224:227], v2 offset:8192
    ds_read_b128 a[228:231], v2 offset:9216
    v_mfma_f32_16x16x32_bf16 v[240:243], a[252:255], v[224:227], v[240:243]
    s_lshl3_add_u32 s81, s7, s4
    ds_read_b128 a[232:235], v2 offset:10240
    v_cvt_pk_bf16_f32 v56, v252, v253
    v_mfma_f32_16x16x32_bf16 v[244:247], a[240:243], v[132:135], v[148:151]
    s_add_u32 m0, s76, s75
    ds_read_b128 a[236:239], v2 offset:11264
    v_cvt_pk_bf16_f32 v57, v254, v255
    v_mfma_f32_16x16x32_bf16 v[244:247], a[244:247], v[164:167], v[244:247]
    s_mov_b32 s76, s60
    buffer_load_dwordx4 v1, s[36:39], s77 offen sc1 lds
    v_mfma_f32_16x16x32_bf16 v[244:247], a[248:251], v[196:199], v[244:247]
    s_mov_b32 s60, s82
    v_exp_f32 v240, v240
    v_mfma_f32_16x16x32_bf16 v[244:247], a[252:255], v[228:231], v[244:247]
    s_mov_b32 s82, s95
    buffer_load_dwordx4 v1, s[36:39], s77 offen offset:1024 sc1 lds
    v_mfma_f32_16x16x32_bf16 v[248:251], a[240:243], v[136:139], v[152:155]
    s_mov_b32 s95, s93
    v_exp_f32 v241, v241
    v_mfma_f32_16x16x32_bf16 v[248:251], a[244:247], v[168:171], v[248:251]
    s_mov_b32 s93, s99
    v_exp_f32 v242, v242
    v_mfma_f32_16x16x32_bf16 v[248:251], a[248:251], v[200:203], v[248:251]
    s_mul_i32 s80, s80, 155648
    buffer_load_dwordx4 v1, s[36:39], s77 offen offset:2048 sc1 lds
    v_mfma_f32_16x16x32_bf16 v[248:251], a[252:255], v[232:235], v[248:251]
    s_mul_i32 s81, s81, 155648
    v_exp_f32 v243, v243
    v_mfma_f32_16x16x32_bf16 v[252:255], a[240:243], v[140:143], v[156:159]
    s_lshl_b32 s7, s5, 12
    v_cvt_pk_bf16_f32 v34, v240, v241
    v_cvt_pk_bf16_f32 v35, v242, v243
    v_mfma_f32_16x16x32_bf16 v[252:255], a[244:247], v[172:175], v[252:255]
    s_add_u32 s80, s80, s7
    buffer_load_dwordx4 v1, s[36:39], s77 offen offset:3072 sc1 lds
    v_mfma_f32_16x16x32_bf16 v[252:255], a[248:251], v[204:207], v[252:255]
    s_add_u32 s81, s81, s7
    v_exp_f32 v244, v244
    v_mfma_f32_16x16x32_bf16 v[252:255], a[252:255], v[236:239], v[252:255]
    s_add_u32 s100, s77, 4096
    v_exp_f32 v245, v245
    v_add_f32 v212, s20, v144
    v_fma_f32 v176, v208, s16, v212
    v_fma_f32 v177, v209, s16, v212
    v_fma_f32 v178, v210, s16, v212
    v_fma_f32 v179, v211, s16, v212
    v_add_f32 v212, s22, v144
    v_fma_f32 v184, v208, s18, v212
    v_fma_f32 v185, v209, s18, v212
    v_fma_f32 v186, v210, s18, v212
    v_fma_f32 v187, v211, s18, v212
    s_nop 1
    s_waitcnt lgkmcnt(0)
    v_mfma_f32_16x16x32_bf16 v[240:243], a[224:227], v[128:131], v[184:187]
    s_add_u32 m0, m0, 4096
    v_exp_f32 v246, v246
    v_mfma_f32_16x16x32_bf16 v[240:243], a[228:231], v[160:163], v[240:243]
    s_lshr_b32 s7, s5, 3
    v_exp_f32 v247, v247
    v_mfma_f32_16x16x32_bf16 v[240:243], a[232:235], v[192:195], v[240:243]
    s_lshl2_add_u32 s7, s7, s4
    buffer_load_dwordx4 v1, s[36:39], s100 offen sc1 lds
    v_mfma_f32_16x16x32_bf16 v[240:243], a[236:239], v[224:227], v[240:243]
    s_lshl_b32 s7, s7, 8
    v_cvt_pk_bf16_f32 v42, v244, v245
    v_cvt_pk_bf16_f32 v43, v246, v247
    v_mfma_f32_16x16x32_bf16 v[244:247], a[224:227], v[132:135], v[148:151]
    s_mov_b64 s[84:85], 0
    v_exp_f32 v248, v248
    v_mfma_f32_16x16x32_bf16 v[244:247], a[228:231], v[164:167], v[244:247]
    s_add_u32 s92, s7, 163840
    buffer_load_dwordx4 v1, s[36:39], s100 offen offset:1024 sc1 lds
    v_mfma_f32_16x16x32_bf16 v[244:247], a[232:235], v[196:199], v[244:247]
    s_mov_b64 s[24:25], s[0:1]
    v_exp_f32 v249, v249
    v_mfma_f32_16x16x32_bf16 v[244:247], a[236:239], v[228:231], v[244:247]
    s_mov_b32 s78, s6
    v_exp_f32 v250, v250
    v_exp_f32 v251, v251
    v_cvt_pk_bf16_f32 v50, v248, v249
    v_cvt_pk_bf16_f32 v51, v250, v251
    v_mfma_f32_16x16x32_bf16 v[248:251], a[224:227], v[136:139], v[152:155]
    s_mov_b32 s26, 2359296
    ds_read_b128 a[240:243], v2 offset:12288
    ds_read_b128 a[244:247], v2 offset:13312
    v_mfma_f32_16x16x32_bf16 v[248:251], a[228:231], v[168:171], v[248:251]
    s_mov_b32 s27, 0x20000
    buffer_load_dwordx4 v1, s[36:39], s100 offen offset:2048 sc1 lds
    v_mfma_f32_16x16x32_bf16 v[248:251], a[232:235], v[200:203], v[248:251]
    s_add_u32 s77, s77, 32768
    ds_read_b128 a[248:251], v2 offset:14336
    ds_read_b128 a[252:255], v2 offset:15360
    v_mfma_f32_16x16x32_bf16 v[248:251], a[236:239], v[232:235], v[248:251]
    v_exp_f32 v252, v252
    v_exp_f32 v253, v253
    v_exp_f32 v254, v254
    v_exp_f32 v255, v255
    v_cvt_pk_bf16_f32 v58, v252, v253
    v_cvt_pk_bf16_f32 v59, v254, v255
    v_mfma_f32_16x16x32_bf16 v[252:255], a[224:227], v[140:143], v[156:159]
    v_add_f32 v213, s23, v144
    v_fma_f32 v188, v208, s19, v213
    v_mfma_f32_16x16x32_bf16 v[252:255], a[228:231], v[172:175], v[252:255]
    buffer_load_dwordx4 v1, s[36:39], s100 offen offset:3072 sc1 lds
    v_mfma_f32_16x16x32_bf16 v[252:255], a[232:235], v[204:207], v[252:255]
    v_exp_f32 v240, v240
    v_mfma_f32_16x16x32_bf16 v[252:255], a[236:239], v[236:239], v[252:255]
    s_waitcnt lgkmcnt(0)
    v_exp_f32 v241, v241
    v_exp_f32 v242, v242
    v_exp_f32 v243, v243
    v_fma_f32 v189, v209, s19, v213
    v_fma_f32 v190, v210, s19, v213
    v_fma_f32 v191, v211, s19, v213
    v_cvt_pk_bf16_f32 v36, v240, v241
    v_cvt_pk_bf16_f32 v37, v242, v243
    v_mfma_f32_16x16x32_bf16 v[240:243], a[240:243], v[128:131], v[188:191]
    v_exp_f32 v244, v244
    v_mfma_f32_16x16x32_bf16 v[240:243], a[244:247], v[160:163], v[240:243]
    v_exp_f32 v245, v245
    v_mfma_f32_16x16x32_bf16 v[240:243], a[248:251], v[192:195], v[240:243]
    s_waitcnt vmcnt(8) lgkmcnt(0)
    v_exp_f32 v246, v246
    v_mfma_f32_16x16x32_bf16 v[240:243], a[252:255], v[224:227], v[240:243]
    s_barrier
    v_exp_f32 v247, v247
    v_cvt_pk_bf16_f32 v44, v244, v245
    v_cvt_pk_bf16_f32 v45, v246, v247
    v_mfma_f32_16x16x32_bf16 v[244:247], a[240:243], v[132:135], v[148:151]
    v_add_u32 v2, s82, v1
    ds_read_b128 a[224:227], v2 offset:0
    v_mfma_f32_16x16x32_bf16 v[244:247], a[244:247], v[164:167], v[244:247]
    ds_read_b128 a[228:231], v2 offset:1024
    ds_read_b128 a[232:235], v2 offset:2048
    v_mfma_f32_16x16x32_bf16 v[244:247], a[248:251], v[196:199], v[244:247]
    v_exp_f32 v248, v248
    v_mfma_f32_16x16x32_bf16 v[244:247], a[252:255], v[228:231], v[244:247]
    v_exp_f32 v249, v249
    v_exp_f32 v250, v250
    v_exp_f32 v251, v251
    v_cvt_pk_bf16_f32 v52, v248, v249
    v_cvt_pk_bf16_f32 v53, v250, v251
    v_mfma_f32_16x16x32_bf16 v[248:251], a[240:243], v[136:139], v[152:155]
    ds_read_b128 a[236:239], v2 offset:3072
    ds_read_b128 v[96:99], v2 offset:16384
    v_mfma_f32_16x16x32_bf16 v[248:251], a[244:247], v[168:171], v[248:251]
    v_exp_f32 v252, v252
    v_mfma_f32_16x16x32_bf16 v[248:251], a[248:251], v[200:203], v[248:251]
    v_exp_f32 v253, v253
    v_mfma_f32_16x16x32_bf16 v[248:251], a[252:255], v[232:235], v[248:251]
    v_exp_f32 v254, v254
    v_exp_f32 v255, v255
    v_cvt_pk_bf16_f32 v60, v252, v253
    v_cvt_pk_bf16_f32 v61, v254, v255
    v_mfma_f32_16x16x32_bf16 v[252:255], a[240:243], v[140:143], v[156:159]
    ds_read_b128 v[100:103], v2 offset:17408
    v_mfma_f32_16x16x32_bf16 v[252:255], a[244:247], v[172:175], v[252:255]
    v_exp_f32 v240, v240
    v_mfma_f32_16x16x32_bf16 v[252:255], a[248:251], v[204:207], v[252:255]
    v_exp_f32 v241, v241
    v_mfma_f32_16x16x32_bf16 v[252:255], a[252:255], v[236:239], v[252:255]
    v_exp_f32 v242, v242
    v_exp_f32 v243, v243
    v_exp_f32 v244, v244
    v_exp_f32 v245, v245
    v_exp_f32 v246, v246
    v_exp_f32 v247, v247
    v_exp_f32 v248, v248
    v_exp_f32 v249, v249
    v_exp_f32 v250, v250
    v_exp_f32 v251, v251
    v_cvt_pk_bf16_f32 v38, v240, v241
    v_cvt_pk_bf16_f32 v39, v242, v243
    v_cvt_pk_bf16_f32 v46, v244, v245
    v_cvt_pk_bf16_f32 v47, v246, v247
    v_cvt_pk_bf16_f32 v54, v248, v249
    v_cvt_pk_bf16_f32 v55, v250, v251
    v_exp_f32 v252, v252
    v_mov_b32 v28, 2
    s_cmp_eq_u32 s4, 3
    s_cselect_b32 s7, s101, 1073741824
    v_lshlrev_b32 v31, 20, v1
    buffer_store_dword v28, v31, s[32:35], s7 offen sc1
    s_cmp_eq_u32 s78, 0
    s_cbranch_scc1 K1_LB_END
.p2align 3
K1_LB:
    s_waitcnt lgkmcnt(0)
    v_mfma_f32_16x16x32_bf16 v[240:243], a[224:227], v[128:131], v[176:179]
    s_mov_b32 s99, s76
    v_exp_f32 v253, v253
    v_mfma_f32_16x16x32_bf16 v[240:243], a[228:231], v[160:163], v[240:243]
    v_exp_f32 v254, v254
    v_mfma_f32_16x16x32_bf16 v[240:243], a[232:235], v[192:195], v[240:243]
    v_exp_f32 v255, v255
    v_mfma_f32_16x16x32_bf16 v[240:243], a[236:239], v[224:227], v[240:243]
    v_cvt_pk_bf16_f32 v62, v252, v253
    v_cvt_pk_bf16_f32 v63, v254, v255
    v_mfma_f32_16x16x32_bf16 a[0:3], v[96:99], v[32:35], a[0:3]
    s_add_u32 m0, s76, s75
    v_mfma_f32_16x16x32_bf16 a[0:3], v[100:103], v[36:39], a[0:3]
    s_mov_b32 s76, s60
    buffer_load_dwordx4 v1, s[36:39], s77 offen sc1 lds
    v_mfma_f32_16x16x32_bf16 a[4:7], v[96:99], v[40:43], a[4:7]
    s_mov_b32 s60, s82
    ds_read_b128 v[104:107], v2 offset:18432
    ds_read_b128 v[108:111], v2 offset:19456
    v_mfma_f32_16x16x32_bf16 a[4:7], v[100:103], v[44:47], a[4:7]
    s_mov_b32 s82, s95
    v_exp_f32 v240, v240
    v_mfma_f32_16x16x32_bf16 v[244:247], a[224:227], v[132:135], v[148:151]
    s_mov_b32 s95, s93
    v_exp_f32 v241, v241
    v_mfma_f32_16x16x32_bf16 v[244:247], a[228:231], v[164:167], v[244:247]
    s_mov_b32 s93, s99
    v_exp_f32 v242, v242
    v_mfma_f32_16x16x32_bf16 v[244:247], a[232:235], v[196:199], v[244:247]
    v_exp_f32 v243, v243
    v_mfma_f32_16x16x32_bf16 v[244:247], a[236:239], v[228:231], v[244:247]
    v_cvt_pk_bf16_f32 v64, v240, v241
    v_cvt_pk_bf16_f32 v65, v242, v243
    v_mfma_f32_16x16x32_bf16 a[8:11], v[96:99], v[48:51], a[8:11]
    v_mfma_f32_16x16x32_bf16 a[8:11], v[100:103], v[52:55], a[8:11]
    v_mfma_f32_16x16x32_bf16 a[12:15], v[96:99], v[56:59], a[12:15]
    v_mfma_f32_16x16x32_bf16 a[12:15], v[100:103], v[60:63], a[12:15]
    v_mfma_f32_16x16x32_bf16 v[248:251], a[224:227], v[136:139], v[152:155]
    v_mfma_f32_16x16x32_bf16 v[248:251], a[228:231], v[168:171], v[248:251]
    ds_read_b128 a[240:243], v2 offset:4096
    ds_read_b128 a[244:247], v2 offset:5120
    v_mfma_f32_16x16x32_bf16 v[248:251], a[232:235], v[200:203], v[248:251]
    buffer_load_dwordx4 v1, s[36:39], s77 offen offset:1024 sc1 lds
    v_mfma_f32_16x16x32_bf16 v[248:251], a[236:239], v[232:235], v[248:251]
    s_waitcnt lgkmcnt(2)
    ds_read_b128 a[248:251], v2 offset:6144
    ds_read_b128 a[252:255], v2 offset:7168
    v_mfma_f32_16x16x32_bf16 a[16:19], v[104:107], v[32:35], a[16:19]
    v_exp_f32 v244, v244
    v_mfma_f32_16x16x32_bf16 a[16:19], v[108:111], v[36:39], a[16:19]
    ds_read_b128 v[112:115], v2 offset:20480
    ds_read_b128 v[116:119], v2 offset:21504
    v_mfma_f32_16x16x32_bf16 a[20:23], v[104:107], v[40:43], a[20:23]
    v_exp_f32 v245, v245
    v_mfma_f32_16x16x32_bf16 a[20:23], v[108:111], v[44:47], a[20:23]
    v_exp_f32 v246, v246
    v_mfma_f32_16x16x32_bf16 v[252:255], a[224:227], v[140:143], v[156:159]
    v_exp_f32 v247, v247
    v_mfma_f32_16x16x32_bf16 v[252:255], a[228:231], v[172:175], v[252:255]
    v_cvt_pk_bf16_f32 v72, v244, v245
    v_cvt_pk_bf16_f32 v73, v246, v247
    v_mfma_f32_16x16x32_bf16 v[252:255], a[232:235], v[204:207], v[252:255]
    v_exp_f32 v248, v248
    v_mfma_f32_16x16x32_bf16 v[252:255], a[236:239], v[236:239], v[252:255]
    v_exp_f32 v249, v249
    v_mfma_f32_16x16x32_bf16 a[24:27], v[104:107], v[48:51], a[24:27]
    v_exp_f32 v250, v250
    v_mfma_f32_16x16x32_bf16 a[24:27], v[108:111], v[52:55], a[24:27]
    v_exp_f32 v251, v251
    v_mfma_f32_16x16x32_bf16 a[28:31], v[104:107], v[56:59], a[28:31]
    v_cvt_pk_bf16_f32 v80, v248, v249
    v_cvt_pk_bf16_f32 v81, v250, v251
    v_mfma_f32_16x16x32_bf16 a[28:31], v[108:111], v[60:63], a[28:31]
    s_waitcnt lgkmcnt(0)
    buffer_load_dwordx4 v1, s[36:39], s77 offen offset:2048 sc1 lds
    v_mfma_f32_16x16x32_bf16 v[240:243], a[240:243], v[128:131], v[180:183]
    v_exp_f32 v252, v252
    v_mfma_f32_16x16x32_bf16 v[240:243], a[244:247], v[160:163], v[240:243]
    v_exp_f32 v253, v253
    v_mfma_f32_16x16x32_bf16 v[240:243], a[248:251], v[192:195], v[240:243]
    v_exp_f32 v254, v254
    v_mfma_f32_16x16x32_bf16 v[240:243], a[252:255], v[224:227], v[240:243]
    v_exp_f32 v255, v255
    v_mfma_f32_16x16x32_bf16 a[32:35], v[112:115], v[32:35], a[32:35]
    v_cvt_pk_bf16_f32 v88, v252, v253
    v_cvt_pk_bf16_f32 v89, v254, v255
    v_mfma_f32_16x16x32_bf16 a[32:35], v[116:119], v[36:39], a[32:35]
    ds_read_b128 v[120:123], v2 offset:22528
    ds_read_b128 v[124:127], v2 offset:23552
    v_mfma_f32_16x16x32_bf16 a[36:39], v[112:115], v[40:43], a[36:39]
    v_exp_f32 v240, v240
    v_mfma_f32_16x16x32_bf16 a[36:39], v[116:119], v[44:47], a[36:39]
    v_exp_f32 v241, v241
    v_mfma_f32_16x16x32_bf16 v[244:247], a[240:243], v[132:135], v[148:151]
    v_exp_f32 v242, v242
    v_mfma_f32_16x16x32_bf16 v[244:247], a[244:247], v[164:167], v[244:247]
    v_exp_f32 v243, v243
    v_mfma_f32_16x16x32_bf16 v[244:247], a[248:251], v[196:199], v[244:247]
    v_cvt_pk_bf16_f32 v66, v240, v241
    v_cvt_pk_bf16_f32 v67, v242, v243
    v_mfma_f32_16x16x32_bf16 v[244:247], a[252:255], v[228:231], v[244:247]
    v_mfma_f32_16x16x32_bf16 a[40:43], v[112:115], v[48:51], a[40:43]
    buffer_load_dwordx4 v1, s[36:39], s77 offen offset:3072 sc1 lds
    v_mfma_f32_16x16x32_bf16 a[40:43], v[116:119], v[52:55], a[40:43]
    v_mfma_f32_16x16x32_bf16 a[44:47], v[112:115], v[56:59], a[44:47]
    v_mfma_f32_16x16x32_bf16 a[44:47], v[116:119], v[60:63], a[44:47]
    v_mfma_f32_16x16x32_bf16 v[248:251], a[240:243], v[136:139], v[152:155]
    v_mfma_f32_16x16x32_bf16 v[248:251], a[244:247], v[168:171], v[248:251]
    ds_read_b128 a[224:227], v2 offset:8192
    ds_read_b128 a[228:231], v2 offset:9216
    v_mfma_f32_16x16x32_bf16 v[248:251], a[248:251], v[200:203], v[248:251]
    v_exp_f32 v244, v244
    v_mfma_f32_16x16x32_bf16 v[248:251], a[252:255], v[232:235], v[248:251]
    s_waitcnt lgkmcnt(2)
    ds_read_b128 a[232:235], v2 offset:10240
    ds_read_b128 a[236:239], v2 offset:11264
    v_mfma_f32_16x16x32_bf16 a[48:51], v[120:123], v[32:35], a[48:51]
    v_exp_f32 v245, v245
    v_mfma_f32_16x16x32_bf16 a[48:51], v[124:127], v[36:39], a[48:51]
    ds_read_b128 v[96:99], v2 offset:24576
    ds_read_b128 v[100:103], v2 offset:25600
    v_mfma_f32_16x16x32_bf16 a[52:55], v[120:123], v[40:43], a[52:55]
    v_exp_f32 v246, v246
    v_mfma_f32_16x16x32_bf16 a[52:55], v[124:127], v[44:47], a[52:55]
    v_exp_f32 v247, v247
    v_mfma_f32_16x16x32_bf16 v[252:255], a[240:243], v[140:143], v[156:159]
    v_cvt_pk_bf16_f32 v74, v244, v245
    v_cvt_pk_bf16_f32 v75, v246, v247
    v_mfma_f32_16x16x32_bf16 v[252:255], a[244:247], v[172:175], v[252:255]
    s_add_u32 s100, s77, 4096
    v_exp_f32 v248, v248
    v_mfma_f32_16x16x32_bf16 v[252:255], a[248:251], v[204:207], v[252:255]
    s_add_u32 m0, m0, 4096
    v_exp_f32 v249, v249
    v_mfma_f32_16x16x32_bf16 v[252:255], a[252:255], v[236:239], v[252:255]
    buffer_load_dwordx4 v1, s[36:39], s100 offen sc1 lds
    v_mfma_f32_16x16x32_bf16 a[56:59], v[120:123], v[48:51], a[56:59]
    v_exp_f32 v250, v250
    v_mfma_f32_16x16x32_bf16 a[56:59], v[124:127], v[52:55], a[56:59]
    v_exp_f32 v251, v251
    v_mfma_f32_16x16x32_bf16 a[60:63], v[120:123], v[56:59], a[60:63]
    v_cvt_pk_bf16_f32 v82, v248, v249
    v_cvt_pk_bf16_f32 v83, v250, v251
    v_mfma_f32_16x16x32_bf16 a[60:63], v[124:127], v[60:63], a[60:63]
    s_waitcnt lgkmcnt(0)
    v_exp_f32 v252, v252
    v_mfma_f32_16x16x32_bf16 v[240:243], a[224:227], v[128:131], v[184:187]
    v_exp_f32 v253, v253
    v_mfma_f32_16x16x32_bf16 v[240:243], a[228:231], v[160:163], v[240:243]
    v_exp_f32 v254, v254
    v_mfma_f32_16x16x32_bf16 v[240:243], a[232:235], v[192:195], v[240:243]
    v_exp_f32 v255, v255
    v_mfma_f32_16x16x32_bf16 v[240:243], a[236:239], v[224:227], v[240:243]
    v_cvt_pk_bf16_f32 v90, v252, v253
    v_cvt_pk_bf16_f32 v91, v254, v255
    v_mfma_f32_16x16x32_bf16 a[144:147], v[96:99], v[32:35], a[144:147]
    v_mfma_f32_16x16x32_bf16 a[144:147], v[100:103], v[36:39], a[144:147]
    ds_read_b128 v[104:107], v2 offset:26624
    ds_read_b128 v[108:111], v2 offset:27648
    v_mfma_f32_16x16x32_bf16 a[148:151], v[96:99], v[40:43], a[148:151]
    v_mfma_f32_16x16x32_bf16 a[148:151], v[100:103], v[44:47], a[148:151]
    buffer_load_dwordx4 v1, s[36:39], s100 offen offset:1024 sc1 lds
    v_mfma_f32_16x16x32_bf16 v[244:247], a[224:227], v[132:135], v[148:151]
    v_exp_f32 v240, v240
    v_mfma_f32_16x16x32_bf16 v[244:247], a[228:231], v[164:167], v[244:247]
    v_exp_f32 v241, v241
    v_mfma_f32_16x16x32_bf16 v[244:247], a[232:235], v[196:199], v[244:247]
    v_exp_f32 v242, v242
    v_mfma_f32_16x16x32_bf16 v[244:247], a[236:239], v[228:231], v[244:247]
    v_exp_f32 v243, v243
    v_mfma_f32_16x16x32_bf16 a[152:155], v[96:99], v[48:51], a[152:155]
    v_cvt_pk_bf16_f32 v68, v240, v241
    v_cvt_pk_bf16_f32 v69, v242, v243
    v_mfma_f32_16x16x32_bf16 a[152:155], v[100:103], v[52:55], a[152:155]
    v_mfma_f32_16x16x32_bf16 a[156:159], v[96:99], v[56:59], a[156:159]
    v_mfma_f32_16x16x32_bf16 a[156:159], v[100:103], v[60:63], a[156:159]
    v_mfma_f32_16x16x32_bf16 v[248:251], a[224:227], v[136:139], v[152:155]
    v_exp_f32 v244, v244
    v_mfma_f32_16x16x32_bf16 v[248:251], a[228:231], v[168:171], v[248:251]
    ds_read_b128 a[240:243], v2 offset:12288
    ds_read_b128 a[244:247], v2 offset:13312
    v_mfma_f32_16x16x32_bf16 v[248:251], a[232:235], v[200:203], v[248:251]
    v_exp_f32 v245, v245
    v_mfma_f32_16x16x32_bf16 v[248:251], a[236:239], v[232:235], v[248:251]
    s_waitcnt lgkmcnt(2)
    ds_read_b128 a[248:251], v2 offset:14336
    ds_read_b128 a[252:255], v2 offset:15360
    v_mfma_f32_16x16x32_bf16 a[160:163], v[104:107], v[32:35], a[160:163]
    buffer_load_dwordx4 v1, s[36:39], s100 offen offset:2048 sc1 lds
    v_mfma_f32_16x16x32_bf16 a[160:163], v[108:111], v[36:39], a[160:163]
    ds_read_b128 v[112:115], v2 offset:28672
    ds_read_b128 v[116:119], v2 offset:29696
    v_mfma_f32_16x16x32_bf16 a[164:167], v[104:107], v[40:43], a[164:167]
    v_exp_f32 v246, v246
    v_mfma_f32_16x16x32_bf16 a[164:167], v[108:111], v[44:47], a[164:167]
    v_exp_f32 v247, v247
    v_mfma_f32_16x16x32_bf16 v[252:255], a[224:227], v[140:143], v[156:159]
    v_cvt_pk_bf16_f32 v76, v244, v245
    v_cvt_pk_bf16_f32 v77, v246, v247
    v_mfma_f32_16x16x32_bf16 v[252:255], a[228:231], v[172:175], v[252:255]
    v_exp_f32 v248, v248
    v_mfma_f32_16x16x32_bf16 v[252:255], a[232:235], v[204:207], v[252:255]
    v_exp_f32 v249, v249
    v_mfma_f32_16x16x32_bf16 v[252:255], a[236:239], v[236:239], v[252:255]
    v_exp_f32 v250, v250
    v_mfma_f32_16x16x32_bf16 a[168:171], v[104:107], v[48:51], a[168:171]
    v_exp_f32 v251, v251
    v_mfma_f32_16x16x32_bf16 a[168:171], v[108:111], v[52:55], a[168:171]
    v_cvt_pk_bf16_f32 v84, v248, v249
    v_cvt_pk_bf16_f32 v85, v250, v251
    v_mfma_f32_16x16x32_bf16 a[172:175], v[104:107], v[56:59], a[172:175]
    v_mfma_f32_16x16x32_bf16 a[172:175], v[108:111], v[60:63], a[172:175]
    s_waitcnt lgkmcnt(0)
    v_exp_f32 v252, v252
    v_mfma_f32_16x16x32_bf16 v[240:243], a[240:243], v[128:131], v[188:191]
    v_exp_f32 v253, v253
    v_mfma_f32_16x16x32_bf16 v[240:243], a[244:247], v[160:163], v[240:243]
    buffer_load_dwordx4 v1, s[36:39], s100 offen offset:3072 sc1 lds
    v_mfma_f32_16x16x32_bf16 v[240:243], a[248:251], v[192:195], v[240:243]
    v_exp_f32 v254, v254
    v_mfma_f32_16x16x32_bf16 v[240:243], a[252:255], v[224:227], v[240:243]
    v_exp_f32 v255, v255
    v_mfma_f32_16x16x32_bf16 a[176:179], v[112:115], v[32:35], a[176:179]
    v_cvt_pk_bf16_f32 v92, v252, v253
    v_cvt_pk_bf16_f32 v93, v254, v255
    v_mfma_f32_16x16x32_bf16 a[176:179], v[116:119], v[36:39], a[176:179]
    ds_read_b128 v[120:123], v2 offset:30720
    ds_read_b128 v[124:127], v2 offset:31744
    v_mfma_f32_16x16x32_bf16 a[180:183], v[112:115], v[40:43], a[180:183]
    v_exp_f32 v240, v240
    v_mfma_f32_16x16x32_bf16 a[180:183], v[116:119], v[44:47], a[180:183]
    v_exp_f32 v241, v241
    v_mfma_f32_16x16x32_bf16 v[244:247], a[240:243], v[132:135], v[148:151]
    v_add_u32 v2, s82, v1
    v_cvt_pk_bf16_f32 v70, v240, v241
    v_mfma_f32_16x16x32_bf16 v[244:247], a[244:247], v[164:167], v[244:247]
    v_exp_f32 v242, v242
    v_mfma_f32_16x16x32_bf16 v[244:247], a[248:251], v[196:199], v[244:247]
    v_exp_f32 v243, v243
    v_mfma_f32_16x16x32_bf16 v[244:247], a[252:255], v[228:231], v[244:247]
    v_cvt_pk_bf16_f32 v71, v242, v243
    v_mfma_f32_16x16x32_bf16 a[184:187], v[112:115], v[48:51], a[184:187]
    v_mfma_f32_16x16x32_bf16 a[184:187], v[116:119], v[52:55], a[184:187]
    v_mfma_f32_16x16x32_bf16 a[188:191], v[112:115], v[56:59], a[188:191]
    s_add_u32 s77, s77, 32768
    v_mfma_f32_16x16x32_bf16 a[188:191], v[116:119], v[60:63], a[188:191]
    v_mfma_f32_16x16x32_bf16 v[248:251], a[240:243], v[136:139], v[152:155]
    v_mfma_f32_16x16x32_bf16 v[248:251], a[244:247], v[168:171], v[248:251]
    v_exp_f32 v244, v244
    v_mfma_f32_16x16x32_bf16 v[248:251], a[248:251], v[200:203], v[248:251]
    v_exp_f32 v245, v245
    v_mfma_f32_16x16x32_bf16 v[248:251], a[252:255], v[232:235], v[248:251]
    s_waitcnt lgkmcnt(0)
    v_exp_f32 v246, v246
    v_mfma_f32_16x16x32_bf16 a[192:195], v[120:123], v[32:35], a[192:195]
    v_exp_f32 v247, v247
    v_mfma_f32_16x16x32_bf16 a[192:195], v[124:127], v[36:39], a[192:195]
    ds_read_b128 a[224:227], v2 offset:0
    ds_read_b128 a[228:231], v2 offset:1024
    v_mfma_f32_16x16x32_bf16 a[196:199], v[120:123], v[40:43], a[196:199]
    ds_read_b128 a[232:235], v2 offset:2048
    v_cvt_pk_bf16_f32 v78, v244, v245
    v_mfma_f32_16x16x32_bf16 a[196:199], v[124:127], v[44:47], a[196:199]
    ds_read_b128 a[236:239], v2 offset:3072
    v_cvt_pk_bf16_f32 v79, v246, v247
    v_mfma_f32_16x16x32_bf16 v[252:255], a[240:243], v[140:143], v[156:159]
    v_exp_f32 v248, v248
    v_mfma_f32_16x16x32_bf16 v[252:255], a[244:247], v[172:175], v[252:255]
    ds_read_b128 v[96:99], v2 offset:16384
    ds_read_b128 v[100:103], v2 offset:17408
    v_mfma_f32_16x16x32_bf16 v[252:255], a[248:251], v[204:207], v[252:255]
    v_exp_f32 v249, v249
    v_mfma_f32_16x16x32_bf16 v[252:255], a[252:255], v[236:239], v[252:255]
    v_exp_f32 v250, v250
    v_mfma_f32_16x16x32_bf16 a[200:203], v[120:123], v[48:51], a[200:203]
    v_exp_f32 v251, v251
    v_mfma_f32_16x16x32_bf16 a[200:203], v[124:127], v[52:55], a[200:203]
    v_cvt_pk_bf16_f32 v86, v248, v249
    v_cvt_pk_bf16_f32 v87, v250, v251
    v_mfma_f32_16x16x32_bf16 a[204:207], v[120:123], v[56:59], a[204:207]
    v_mfma_f32_16x16x32_bf16 a[204:207], v[124:127], v[60:63], a[204:207]
    v_exp_f32 v252, v252
    v_smfmac_f32_16x16x64_bf16 a[208:211], a[136:139], v[32:39], v215
    v_smfmac_f32_16x16x64_bf16 a[212:215], a[136:139], v[40:47], v215
    v_smfmac_f32_16x16x64_bf16 a[216:219], a[136:139], v[48:55], v215
    s_cmp_le_u32 s78, 1
    v_smfmac_f32_16x16x64_bf16 a[220:223], a[136:139], v[56:63], v215
    s_cbranch_scc1 K1_LB_MASK
K1_LB_BACK:
    s_waitcnt lgkmcnt(0)
    v_mfma_f32_16x16x32_bf16 v[240:243], a[224:227], v[128:131], v[176:179]
    s_mov_b32 s99, s76
    v_exp_f32 v253, v253
    v_mfma_f32_16x16x32_bf16 v[240:243], a[228:231], v[160:163], v[240:243]
    v_exp_f32 v254, v254
    v_mfma_f32_16x16x32_bf16 v[240:243], a[232:235], v[192:195], v[240:243]
    v_exp_f32 v255, v255
    v_mfma_f32_16x16x32_bf16 v[240:243], a[236:239], v[224:227], v[240:243]
    v_cvt_pk_bf16_f32 v94, v252, v253
    v_cvt_pk_bf16_f32 v95, v254, v255
    v_mfma_f32_16x16x32_bf16 a[0:3], v[96:99], v[64:67], a[0:3]
    s_add_u32 m0, s76, s75
    v_mfma_f32_16x16x32_bf16 a[0:3], v[100:103], v[68:71], a[0:3]
    s_mov_b32 s76, s60
    buffer_load_dwordx4 v1, s[36:39], s77 offen sc1 lds
    v_mfma_f32_16x16x32_bf16 a[4:7], v[96:99], v[72:75], a[4:7]
    s_mov_b32 s60, s82
    ds_read_b128 v[104:107], v2 offset:18432
    ds_read_b128 v[108:111], v2 offset:19456
    v_mfma_f32_16x16x32_bf16 a[4:7], v[100:103], v[76:79], a[4:7]
    s_mov_b32 s82, s95
    v_exp_f32 v240, v240
    v_mfma_f32_16x16x32_bf16 v[244:247], a[224:227], v[132:135], v[148:151]
    s_mov_b32 s95, s93
    v_exp_f32 v241, v241
    v_mfma_f32_16x16x32_bf16 v[244:247], a[228:231], v[164:167], v[244:247]
    s_mov_b32 s93, s99
    v_exp_f32 v242, v242
    v_mfma_f32_16x16x32_bf16 v[244:247], a[232:235], v[196:199], v[244:247]
    v_exp_f32 v243, v243
    v_mfma_f32_16x16x32_bf16 v[244:247], a[236:239], v[228:231], v[244:247]
    v_cvt_pk_bf16_f32 v32, v240, v241
    v_cvt_pk_bf16_f32 v33, v242, v243
    v_mfma_f32_16x16x32_bf16 a[8:11], v[96:99], v[80:83], a[8:11]
    v_mfma_f32_16x16x32_bf16 a[8:11], v[100:103], v[84:87], a[8:11]
    v_mfma_f32_16x16x32_bf16 a[12:15], v[96:99], v[88:91], a[12:15]
    v_mfma_f32_16x16x32_bf16 a[12:15], v[100:103], v[92:95], a[12:15]
    v_mfma_f32_16x16x32_bf16 v[248:251], a[224:227], v[136:139], v[152:155]
    v_mfma_f32_16x16x32_bf16 v[248:251], a[228:231], v[168:171], v[248:251]
    ds_read_b128 a[240:243], v2 offset:4096
    ds_read_b128 a[244:247], v2 offset:5120
    v_mfma_f32_16x16x32_bf16 v[248:251], a[232:235], v[200:203], v[248:251]
    buffer_load_dwordx4 v1, s[36:39], s77 offen offset:1024 sc1 lds
    v_mfma_f32_16x16x32_bf16 v[248:251], a[236:239], v[232:235], v[248:251]
    s_waitcnt lgkmcnt(2)
    ds_read_b128 a[248:251], v2 offset:6144
    ds_read_b128 a[252:255], v2 offset:7168
    v_mfma_f32_16x16x32_bf16 a[16:19], v[104:107], v[64:67], a[16:19]
    v_exp_f32 v244, v244
    v_mfma_f32_16x16x32_bf16 a[16:19], v[108:111], v[68:71], a[16:19]
    ds_read_b128 v[112:115], v2 offset:20480
    ds_read_b128 v[116:119], v2 offset:21504
    v_mfma_f32_16x16x32_bf16 a[20:23], v[104:107], v[72:75], a[20:23]
    v_exp_f32 v245, v245
    v_mfma_f32_16x16x32_bf16 a[20:23], v[108:111], v[76:79], a[20:23]
    v_exp_f32 v246, v246
    v_mfma_f32_16x16x32_bf16 v[252:255], a[224:227], v[140:143], v[156:159]
    v_exp_f32 v247, v247
    v_mfma_f32_16x16x32_bf16 v[252:255], a[228:231], v[172:175], v[252:255]
    v_cvt_pk_bf16_f32 v40, v244, v245
    v_cvt_pk_bf16_f32 v41, v246, v247
    v_mfma_f32_16x16x32_bf16 v[252:255], a[232:235], v[204:207], v[252:255]
    v_exp_f32 v248, v248
    v_mfma_f32_16x16x32_bf16 v[252:255], a[236:239], v[236:239], v[252:255]
    v_exp_f32 v249, v249
    v_mfma_f32_16x16x32_bf16 a[24:27], v[104:107], v[80:83], a[24:27]
    v_exp_f32 v250, v250
    v_mfma_f32_16x16x32_bf16 a[24:27], v[108:111], v[84:87], a[24:27]
    v_exp_f32 v251, v251
    v_mfma_f32_16x16x32_bf16 a[28:31], v[104:107], v[88:91], a[28:31]
    v_cvt_pk_bf16_f32 v48, v248, v249
    v_cvt_pk_bf16_f32 v49, v250, v251
    v_mfma_f32_16x16x32_bf16 a[28:31], v[108:111], v[92:95], a[28:31]
    s_waitcnt lgkmcnt(0)
    buffer_load_dwordx4 v1, s[36:39], s77 offen offset:2048 sc1 lds
    v_mfma_f32_16x16x32_bf16 v[240:243], a[240:243], v[128:131], v[180:183]
    v_exp_f32 v252, v252
    v_mfma_f32_16x16x32_bf16 v[240:243], a[244:247], v[160:163], v[240:243]
    v_exp_f32 v253, v253
    v_mfma_f32_16x16x32_bf16 v[240:243], a[248:251], v[192:195], v[240:243]
    v_exp_f32 v254, v254
    v_mfma_f32_16x16x32_bf16 v[240:243], a[252:255], v[224:227], v[240:243]
    v_exp_f32 v255, v255
    v_mfma_f32_16x16x32_bf16 a[32:35], v[112:115], v[64:67], a[32:35]
    v_cvt_pk_bf16_f32 v56, v252, v253
    v_cvt_pk_bf16_f32 v57, v254, v255
    v_mfma_f32_16x16x32_bf16 a[32:35], v[116:119], v[68:71], a[32:35]
    ds_read_b128 v[120:123], v2 offset:22528
    ds_read_b128 v[124:127], v2 offset:23552
    v_mfma_f32_16x16x32_bf16 a[36:39], v[112:115], v[72:75], a[36:39]
    v_exp_f32 v240, v240
    v_mfma_f32_16x16x32_bf16 a[36:39], v[116:119], v[76:79], a[36:39]
    v_exp_f32 v241, v241
    v_mfma_f32_16x16x32_bf16 v[244:247], a[240:243], v[132:135], v[148:151]
    v_exp_f32 v242, v242
    v_mfma_f32_16x16x32_bf16 v[244:247], a[244:247], v[164:167], v[244:247]
    v_exp_f32 v243, v243
    v_mfma_f32_16x16x32_bf16 v[244:247], a[248:251], v[196:199], v[244:247]
    v_cvt_pk_bf16_f32 v34, v240, v241
    v_cvt_pk_bf16_f32 v35, v242, v243
    v_mfma_f32_16x16x32_bf16 v[244:247], a[252:255], v[228:231], v[244:247]
    v_mfma_f32_16x16x32_bf16 a[40:43], v[112:115], v[80:83], a[40:43]
    buffer_load_dwordx4 v1, s[36:39], s77 offen offset:3072 sc1 lds
    v_mfma_f32_16x16x32_bf16 a[40:43], v[116:119], v[84:87], a[40:43]
    v_mfma_f32_16x16x32_bf16 a[44:47], v[112:115], v[88:91], a[44:47]
    v_mfma_f32_16x16x32_bf16 a[44:47], v[116:119], v[92:95], a[44:47]
    v_mfma_f32_16x16x32_bf16 v[248:251], a[240:243], v[136:139], v[152:155]
    v_mfma_f32_16x16x32_bf16 v[248:251], a[244:247], v[168:171], v[248:251]
    ds_read_b128 a[224:227], v2 offset:8192
    ds_read_b128 a[228:231], v2 offset:9216
    v_mfma_f32_16x16x32_bf16 v[248:251], a[248:251], v[200:203], v[248:251]
    v_exp_f32 v244, v244
    v_mfma_f32_16x16x32_bf16 v[248:251], a[252:255], v[232:235], v[248:251]
    s_waitcnt lgkmcnt(2)
    ds_read_b128 a[232:235], v2 offset:10240
    ds_read_b128 a[236:239], v2 offset:11264
    v_mfma_f32_16x16x32_bf16 a[48:51], v[120:123], v[64:67], a[48:51]
    v_exp_f32 v245, v245
    v_mfma_f32_16x16x32_bf16 a[48:51], v[124:127], v[68:71], a[48:51]
    ds_read_b128 v[96:99], v2 offset:24576
    ds_read_b128 v[100:103], v2 offset:25600
    v_mfma_f32_16x16x32_bf16 a[52:55], v[120:123], v[72:75], a[52:55]
    v_exp_f32 v246, v246
    v_mfma_f32_16x16x32_bf16 a[52:55], v[124:127], v[76:79], a[52:55]
    v_exp_f32 v247, v247
    v_mfma_f32_16x16x32_bf16 v[252:255], a[240:243], v[140:143], v[156:159]
    v_cvt_pk_bf16_f32 v42, v244, v245
    v_cvt_pk_bf16_f32 v43, v246, v247
    v_mfma_f32_16x16x32_bf16 v[252:255], a[244:247], v[172:175], v[252:255]
    s_add_u32 s100, s77, 4096
    v_exp_f32 v248, v248
    v_mfma_f32_16x16x32_bf16 v[252:255], a[248:251], v[204:207], v[252:255]
    s_add_u32 m0, m0, 4096
    v_exp_f32 v249, v249
    v_mfma_f32_16x16x32_bf16 v[252:255], a[252:255], v[236:239], v[252:255]
    buffer_load_dwordx4 v1, s[36:39], s100 offen sc1 lds
    v_mfma_f32_16x16x32_bf16 a[56:59], v[120:123], v[80:83], a[56:59]
    v_exp_f32 v250, v250
    v_mfma_f32_16x16x32_bf16 a[56:59], v[124:127], v[84:87], a[56:59]
    v_exp_f32 v251, v251
    v_mfma_f32_16x16x32_bf16 a[60:63], v[120:123], v[88:91], a[60:63]
    v_cvt_pk_bf16_f32 v50, v248, v249
    v_cvt_pk_bf16_f32 v51, v250, v251
    v_mfma_f32_16x16x32_bf16 a[60:63], v[124:127], v[92:95], a[60:63]
    s_waitcnt lgkmcnt(0)
    v_exp_f32 v252, v252
    v_mfma_f32_16x16x32_bf16 v[240:243], a[224:227], v[128:131], v[184:187]
    v_exp_f32 v253, v253
    v_mfma_f32_16x16x32_bf16 v[240:243], a[228:231], v[160:163], v[240:243]
    v_exp_f32 v254, v254
    v_mfma_f32_16x16x32_bf16 v[240:243], a[232:235], v[192:195], v[240:243]
    v_exp_f32 v255, v255
    v_mfma_f32_16x16x32_bf16 v[240:243], a[236:239], v[224:227], v[240:243]
    v_cvt_pk_bf16_f32 v58, v252, v253
    v_cvt_pk_bf16_f32 v59, v254, v255
    v_mfma_f32_16x16x32_bf16 a[144:147], v[96:99], v[64:67], a[144:147]
    v_mfma_f32_16x16x32_bf16 a[144:147], v[100:103], v[68:71], a[144:147]
    ds_read_b128 v[104:107], v2 offset:26624
    ds_read_b128 v[108:111], v2 offset:27648
    v_mfma_f32_16x16x32_bf16 a[148:151], v[96:99], v[72:75], a[148:151]
    v_mfma_f32_16x16x32_bf16 a[148:151], v[100:103], v[76:79], a[148:151]
    buffer_load_dwordx4 v1, s[36:39], s100 offen offset:1024 sc1 lds
    v_mfma_f32_16x16x32_bf16 v[244:247], a[224:227], v[132:135], v[148:151]
    v_exp_f32 v240, v240
    v_mfma_f32_16x16x32_bf16 v[244:247], a[228:231], v[164:167], v[244:247]
    v_exp_f32 v241, v241
    v_mfma_f32_16x16x32_bf16 v[244:247], a[232:235], v[196:199], v[244:247]
    v_exp_f32 v242, v242
    v_mfma_f32_16x16x32_bf16 v[244:247], a[236:239], v[228:231], v[244:247]
    v_exp_f32 v243, v243
    v_mfma_f32_16x16x32_bf16 a[152:155], v[96:99], v[80:83], a[152:155]
    v_cvt_pk_bf16_f32 v36, v240, v241
    v_cvt_pk_bf16_f32 v37, v242, v243
    v_mfma_f32_16x16x32_bf16 a[152:155], v[100:103], v[84:87], a[152:155]
    v_mfma_f32_16x16x32_bf16 a[156:159], v[96:99], v[88:91], a[156:159]
    v_mfma_f32_16x16x32_bf16 a[156:159], v[100:103], v[92:95], a[156:159]
    v_mfma_f32_16x16x32_bf16 v[248:251], a[224:227], v[136:139], v[152:155]
    v_exp_f32 v244, v244
    v_mfma_f32_16x16x32_bf16 v[248:251], a[228:231], v[168:171], v[248:251]
    ds_read_b128 a[240:243], v2 offset:12288
    ds_read_b128 a[244:247], v2 offset:13312
    v_mfma_f32_16x16x32_bf16 v[248:251], a[232:235], v[200:203], v[248:251]
    v_exp_f32 v245, v245
    v_mfma_f32_16x16x32_bf16 v[248:251], a[236:239], v[232:235], v[248:251]
    s_waitcnt lgkmcnt(2)
    ds_read_b128 a[248:251], v2 offset:14336
    ds_read_b128 a[252:255], v2 offset:15360
    v_mfma_f32_16x16x32_bf16 a[160:163], v[104:107], v[64:67], a[160:163]
    buffer_load_dwordx4 v1, s[36:39], s100 offen offset:2048 sc1 lds
    v_mfma_f32_16x16x32_bf16 a[160:163], v[108:111], v[68:71], a[160:163]
    ds_read_b128 v[112:115], v2 offset:28672
    ds_read_b128 v[116:119], v2 offset:29696
    v_mfma_f32_16x16x32_bf16 a[164:167], v[104:107], v[72:75], a[164:167]
    v_exp_f32 v246, v246
    v_mfma_f32_16x16x32_bf16 a[164:167], v[108:111], v[76:79], a[164:167]
    v_exp_f32 v247, v247
    v_mfma_f32_16x16x32_bf16 v[252:255], a[224:227], v[140:143], v[156:159]
    v_cvt_pk_bf16_f32 v44, v244, v245
    v_cvt_pk_bf16_f32 v45, v246, v247
    v_mfma_f32_16x16x32_bf16 v[252:255], a[228:231], v[172:175], v[252:255]
    v_exp_f32 v248, v248
    v_mfma_f32_16x16x32_bf16 v[252:255], a[232:235], v[204:207], v[252:255]
    v_exp_f32 v249, v249
    v_mfma_f32_16x16x32_bf16 v[252:255], a[236:239], v[236:239], v[252:255]
    v_exp_f32 v250, v250
    v_mfma_f32_16x16x32_bf16 a[168:171], v[104:107], v[80:83], a[168:171]
    v_exp_f32 v251, v251
    v_mfma_f32_16x16x32_bf16 a[168:171], v[108:111], v[84:87], a[168:171]
    v_cvt_pk_bf16_f32 v52, v248, v249
    v_cvt_pk_bf16_f32 v53, v250, v251
    v_mfma_f32_16x16x32_bf16 a[172:175], v[104:107], v[88:91], a[172:175]
    v_mfma_f32_16x16x32_bf16 a[172:175], v[108:111], v[92:95], a[172:175]
    s_waitcnt lgkmcnt(0)
    v_exp_f32 v252, v252
    v_mfma_f32_16x16x32_bf16 v[240:243], a[240:243], v[128:131], v[188:191]
    v_exp_f32 v253, v253
    v_mfma_f32_16x16x32_bf16 v[240:243], a[244:247], v[160:163], v[240:243]
    buffer_load_dwordx4 v1, s[36:39], s100 offen offset:3072 sc1 lds
    v_mfma_f32_16x16x32_bf16 v[240:243], a[248:251], v[192:195], v[240:243]
    v_exp_f32 v254, v254
    v_mfma_f32_16x16x32_bf16 v[240:243], a[252:255], v[224:227], v[240:243]
    v_exp_f32 v255, v255
    v_mfma_f32_16x16x32_bf16 a[176:179], v[112:115], v[64:67], a[176:179]
    v_cvt_pk_bf16_f32 v60, v252, v253
    v_cvt_pk_bf16_f32 v61, v254, v255
    v_mfma_f32_16x16x32_bf16 a[176:179], v[116:119], v[68:71], a[176:179]
    ds_read_b128 v[120:123], v2 offset:30720
    ds_read_b128 v[124:127], v2 offset:31744
    v_mfma_f32_16x16x32_bf16 a[180:183], v[112:115], v[72:75], a[180:183]
    v_exp_f32 v240, v240
    v_mfma_f32_16x16x32_bf16 a[180:183], v[116:119], v[76:79], a[180:183]
    v_exp_f32 v241, v241
    v_mfma_f32_16x16x32_bf16 v[244:247], a[240:243], v[132:135], v[148:151]
    v_add_u32 v2, s82, v1
    v_cvt_pk_bf16_f32 v38, v240, v241
    v_mfma_f32_16x16x32_bf16 v[244:247], a[244:247], v[164:167], v[244:247]
    v_exp_f32 v242, v242
    v_mfma_f32_16x16x32_bf16 v[244:247], a[248:251], v[196:199], v[244:247]
    v_exp_f32 v243, v243
    v_mfma_f32_16x16x32_bf16 v[244:247], a[252:255], v[228:231], v[244:247]
    v_cvt_pk_bf16_f32 v39, v242, v243
    v_mfma_f32_16x16x32_bf16 a[184:187], v[112:115], v[80:83], a[184:187]
    v_mfma_f32_16x16x32_bf16 a[184:187], v[116:119], v[84:87], a[184:187]
    v_mfma_f32_16x16x32_bf16 a[188:191], v[112:115], v[88:91], a[188:191]
    s_add_u32 s77, s77, 32768
    v_mfma_f32_16x16x32_bf16 a[188:191], v[116:119], v[92:95], a[188:191]
    v_mfma_f32_16x16x32_bf16 v[248:251], a[240:243], v[136:139], v[152:155]
    v_mfma_f32_16x16x32_bf16 v[248:251], a[244:247], v[168:171], v[248:251]
    v_exp_f32 v244, v244
    v_mfma_f32_16x16x32_bf16 v[248:251], a[248:251], v[200:203], v[248:251]
    v_exp_f32 v245, v245
    v_mfma_f32_16x16x32_bf16 v[248:251], a[252:255], v[232:235], v[248:251]
    s_waitcnt lgkmcnt(0)
    v_exp_f32 v246, v246
    v_mfma_f32_16x16x32_bf16 a[192:195], v[120:123], v[64:67], a[192:195]
    v_exp_f32 v247, v247
    v_mfma_f32_16x16x32_bf16 a[192:195], v[124:127], v[68:71], a[192:195]
    v_cvt_pk_bf16_f32 v46, v244, v245
    v_cvt_pk_bf16_f32 v47, v246, v247
    v_mfma_f32_16x16x32_bf16 a[196:199], v[120:123], v[72:75], a[196:199]
    s_waitcnt vmcnt(8) lgkmcnt(0)
    v_exp_f32 v248, v248
    v_mfma_f32_16x16x32_bf16 a[196:199], v[124:127], v[76:79], a[196:199]
    s_barrier
    ds_read_b128 a[224:227], v2 offset:0
    ds_read_b128 a[228:231], v2 offset:1024
    v_mfma_f32_16x16x32_bf16 v[252:255], a[240:243], v[140:143], v[156:159]
    v_exp_f32 v249, v249
    v_mfma_f32_16x16x32_bf16 v[252:255], a[244:247], v[172:175], v[252:255]
    ds_read_b128 a[232:235], v2 offset:2048
    ds_read_b128 a[236:239], v2 offset:3072
    v_mfma_f32_16x16x32_bf16 v[252:255], a[248:251], v[204:207], v[252:255]
    ds_read_b128 v[96:99], v2 offset:16384
    v_cvt_pk_bf16_f32 v54, v248, v249
    v_mfma_f32_16x16x32_bf16 v[252:255], a[252:255], v[236:239], v[252:255]
    v_exp_f32 v250, v250
    v_mfma_f32_16x16x32_bf16 a[200:203], v[120:123], v[80:83], a[200:203]
    v_exp_f32 v251, v251
    v_mfma_f32_16x16x32_bf16 a[200:203], v[124:127], v[84:87], a[200:203]
    ds_read_b128 v[100:103], v2 offset:17408
    v_cvt_pk_bf16_f32 v55, v250, v251
    v_mfma_f32_16x16x32_bf16 a[204:207], v[120:123], v[88:91], a[204:207]
    v_mfma_f32_16x16x32_bf16 a[204:207], v[124:127], v[92:95], a[204:207]
    v_exp_f32 v252, v252
    v_smfmac_f32_16x16x64_bf16 a[208:211], a[136:139], v[64:71], v215
    v_smfmac_f32_16x16x64_bf16 a[212:215], a[136:139], v[72:79], v215
    s_sub_u32 s78, s78, 1
    v_smfmac_f32_16x16x64_bf16 a[216:219], a[136:139], v[80:87], v215
    s_cmp_lg_u32 s78, 0
    v_smfmac_f32_16x16x64_bf16 a[220:223], a[136:139], v[88:95], v215
    s_cbranch_scc1 K1_LB
K1_LB_END:
    v_add_f32 v212, s12, v148
    v_fma_f32 v176, v208, s8, v212
    v_fma_f32 v177, v209, s8, v212
    v_fma_f32 v178, v210, s8, v212
    v_fma_f32 v179, v211, s8, v212
    s_nop 1
    s_waitcnt lgkmcnt(0)
    v_mfma_f32_16x16x32_bf16 v[240:243], a[224:227], v[132:135], v[176:179]
    s_mov_b32 s7, 0
    ds_read_b128 v[104:107], v2 offset:18432
    ds_read_b128 v[108:111], v2 offset:19456
    v_mfma_f32_16x16x32_bf16 v[240:243], a[228:231], v[164:167], v[240:243]
    s_mov_b32 s99, s76
    buffer_load_dwordx4 v[64:67], v11, s[48:51], s7 offen nt
    v_mfma_f32_16x16x32_bf16 v[240:243], a[232:235], v[196:199], v[240:243]
    s_mov_b32 s7, 18432
    v_exp_f32 v253, v253
    v_mfma_f32_16x16x32_bf16 v[240:243], a[236:239], v[228:231], v[240:243]
    s_lshl_b32 s29, s6, 2
    v_exp_f32 v254, v254
    v_mfma_f32_16x16x32_bf16 a[0:3], v[96:99], v[32:35], a[0:3]
    s_lshr_b32 s29, 0x41302413, s29
    v_exp_f32 v255, v255
    v_mfma_f32_16x16x32_bf16 a[0:3], v[100:103], v[36:39], a[0:3]
    s_and_b32 s29, s29, 7
    buffer_load_dwordx4 v[68:71], v11, s[48:51], s7 offen nt
    v_mfma_f32_16x16x32_bf16 a[4:7], v[96:99], v[40:43], a[4:7]
    s_mov_b32 s7, 9216
    v_cvt_pk_bf16_f32 v62, v252, v253
    v_cvt_pk_bf16_f32 v63, v254, v255
    v_mfma_f32_16x16x32_bf16 a[4:7], v[100:103], v[44:47], a[4:7]
    s_lshl_b32 s29, s29, 15
    ds_read_b128 a[240:243], v2 offset:4096
    ds_read_b128 a[244:247], v2 offset:5120
    v_mfma_f32_16x16x32_bf16 v[244:247], a[224:227], v[136:139], v[152:155]
    s_add_u32 s44, s29, s75
    ds_read_b128 a[248:251], v2 offset:6144
    v_add_f32 v213, s13, v148
    v_mfma_f32_16x16x32_bf16 v[244:247], a[228:231], v[168:171], v[244:247]
    s_lshl_b32 s29, s6, 2
    buffer_load_dwordx4 v[20:23], v11, s[48:51], s7 offen nt
    v_mfma_f32_16x16x32_bf16 v[244:247], a[232:235], v[200:203], v[244:247]
    s_mov_b32 s7, 27648
    ds_read_b128 a[252:255], v2 offset:7168
    ds_read_b128 v[112:115], v2 offset:20480
    v_mfma_f32_16x16x32_bf16 v[244:247], a[236:239], v[232:235], v[244:247]
    s_lshr_b32 s29, 0x2413024, s29
    ds_read_b128 v[116:119], v2 offset:21504
    v_fma_f32 v180, v208, s9, v213
    v_mfma_f32_16x16x32_bf16 a[8:11], v[96:99], v[48:51], a[8:11]
    s_and_b32 s29, s29, 7
    v_fma_f32 v181, v209, s9, v213
    v_fma_f32 v182, v210, s9, v213
    v_mfma_f32_16x16x32_bf16 a[8:11], v[100:103], v[52:55], a[8:11]
    s_lshl_b32 s29, s29, 15
    buffer_load_dwordx4 v[24:27], v11, s[48:51], s7 offen nt
    v_mfma_f32_16x16x32_bf16 a[12:15], v[96:99], v[56:59], a[12:15]
    s_add_u32 s45, s29, s75
    v_fma_f32 v183, v211, s9, v213
    ds_read_b128 v[120:123], v2 offset:22528
    v_mfma_f32_16x16x32_bf16 a[12:15], v[100:103], v[60:63], a[12:15]
    s_lshl_b32 s29, s6, 2
    v_exp_f32 v240, v240
    s_waitcnt lgkmcnt(2)
    v_mfma_f32_16x16x32_bf16 a[16:19], v[104:107], v[32:35], a[16:19]
    s_lshr_b32 s29, 0x13024130, s29
    v_exp_f32 v241, v241
    v_mfma_f32_16x16x32_bf16 a[16:19], v[108:111], v[36:39], a[16:19]
    s_and_b32 s29, s29, 7
    buffer_load_dwordx4 v[144:147], v12, s[52:55], 0 offen nt
    v_mfma_f32_16x16x32_bf16 v[248:251], a[224:227], v[140:143], v[156:159]
    s_lshl_b32 s29, s29, 15
    v_exp_f32 v242, v242
    v_mfma_f32_16x16x32_bf16 v[248:251], a[228:231], v[172:175], v[248:251]
    s_add_u32 s46, s29, s75
    v_exp_f32 v243, v243
    v_mfma_f32_16x16x32_bf16 v[248:251], a[232:235], v[204:207], v[248:251]
    s_lshl_b32 s29, s6, 2
    v_cvt_pk_bf16_f32 v72, v240, v241
    v_cvt_pk_bf16_f32 v73, v242, v243
    v_mfma_f32_16x16x32_bf16 v[248:251], a[236:239], v[236:239], v[248:251]
    s_lshr_b32 s29, 0x24130241, s29
    buffer_load_dwordx4 a[140:143], v13, s[52:55], 0 offen nt
    v_mfma_f32_16x16x32_bf16 a[20:23], v[104:107], v[40:43], a[20:23]
    s_and_b32 s29, s29, 7
    ds_read_b128 v[124:127], v2 offset:23552
    ds_read_b128 a[224:227], v2 offset:8192
    v_mfma_f32_16x16x32_bf16 a[20:23], v[108:111], v[44:47], a[20:23]
    s_lshl_b32 s29, s29, 15
    v_exp_f32 v244, v244
    v_mfma_f32_16x16x32_bf16 a[24:27], v[104:107], v[48:51], a[24:27]
    s_add_u32 s47, s29, s75
    v_exp_f32 v245, v245
    v_mfma_f32_16x16x32_bf16 a[24:27], v[108:111], v[52:55], a[24:27]
    s_lshl_b32 s29, s6, 2
    v_exp_f32 v246, v246
    v_mfma_f32_16x16x32_bf16 a[28:31], v[104:107], v[56:59], a[28:31]
    s_lshr_b32 s29, 0x30241302, s29
    v_exp_f32 v247, v247
    v_mfma_f32_16x16x32_bf16 a[28:31], v[108:111], v[60:63], a[28:31]
    s_and_b32 s29, s29, 7
    v_cvt_pk_bf16_f32 v80, v244, v245
    v_cvt_pk_bf16_f32 v81, v246, v247
    v_mfma_f32_16x16x32_bf16 v[252:255], a[240:243], v[132:135], v[180:183]
    s_mov_b32 s98, 0x3fb8aa3b
    ds_read_b128 a[228:231], v2 offset:9216
    ds_read_b128 a[232:235], v2 offset:10240
    v_mfma_f32_16x16x32_bf16 v[252:255], a[244:247], v[164:167], v[252:255]
    s_lshr_b32 s61, s5, 3
    ds_read_b128 a[236:239], v2 offset:11264
    v_add_f32 v212, s14, v148
    v_mfma_f32_16x16x32_bf16 v[252:255], a[248:251], v[196:199], v[252:255]
    s_lshl_b32 s29, s29, 15
    ds_read_b128 v[96:99], v2 offset:24576
    v_fma_f32 v184, v208, s10, v212
    v_mfma_f32_16x16x32_bf16 v[252:255], a[252:255], v[228:231], v[252:255]
    s_add_u32 s79, s29, s75
    ds_read_b128 v[100:103], v2 offset:25600
    v_fma_f32 v185, v209, s10, v212
    v_mfma_f32_16x16x32_bf16 a[32:35], v[112:115], v[32:35], a[32:35]
    s_mul_i32 s71, s61, 6144
    v_exp_f32 v248, v248
    s_waitcnt lgkmcnt(5)
    v_mfma_f32_16x16x32_bf16 a[32:35], v[116:119], v[36:39], a[32:35]
    s_and_b32 s29, s5, 7
    v_exp_f32 v249, v249
    v_mfma_f32_16x16x32_bf16 a[36:39], v[112:115], v[40:43], a[36:39]
    s_add_u32 s3, s5, s6
    v_exp_f32 v250, v250
    v_mfma_f32_16x16x32_bf16 a[36:39], v[116:119], v[44:47], a[36:39]
    s_add_u32 s71, s71, 131072
    v_exp_f32 v251, v251
    v_mfma_f32_16x16x32_bf16 v[240:243], a[240:243], v[136:139], v[152:155]
    s_lshl_b32 s29, s29, 8
    v_fma_f32 v186, v210, s10, v212
    v_fma_f32 v187, v211, s10, v212
    v_mfma_f32_16x16x32_bf16 v[240:243], a[244:247], v[168:171], v[240:243]
    s_add_u32 s74, s4, 1
    v_cvt_pk_bf16_f32 v88, v248, v249
    v_cvt_pk_bf16_f32 v89, v250, v251
    v_mfma_f32_16x16x32_bf16 v[240:243], a[248:251], v[200:203], v[240:243]
    s_and_b32 s28, s5, 3
    v_exp_f32 v252, v252
    v_mfma_f32_16x16x32_bf16 v[240:243], a[252:255], v[232:235], v[240:243]
    s_and_b32 s3, s3, 1
    v_exp_f32 v253, v253
    v_mfma_f32_16x16x32_bf16 a[40:43], v[112:115], v[48:51], a[40:43]
    s_lshl2_add_u32 s66, s6, s61
    v_exp_f32 v254, v254
    v_mfma_f32_16x16x32_bf16 a[40:43], v[116:119], v[52:55], a[40:43]
    s_add_u32 s71, s71, s29
    v_exp_f32 v255, v255
    v_mfma_f32_16x16x32_bf16 a[44:47], v[112:115], v[56:59], a[44:47]
    s_lshl_b32 s74, s74, 15
    v_cvt_pk_bf16_f32 v74, v252, v253
    v_cvt_pk_bf16_f32 v75, v254, v255
    v_mfma_f32_16x16x32_bf16 a[44:47], v[116:119], v[60:63], a[44:47]
    s_mul_i32 s28, s28, 9216
    ds_read_b128 v[104:107], v2 offset:26624
    ds_read_b128 v[108:111], v2 offset:27648
    v_mfma_f32_16x16x32_bf16 a[48:51], v[120:123], v[32:35], a[48:51]
    s_lshl3_add_u32 s3, s61, s3
    v_exp_f32 v240, v240
    v_mfma_f32_16x16x32_bf16 a[48:51], v[124:127], v[36:39], a[48:51]
    s_lshl_b32 s66, s66, 10
    v_exp_f32 v241, v241
    v_mfma_f32_16x16x32_bf16 v[244:247], a[240:243], v[140:143], v[156:159]
    s_add_u32 s70, s71, 4096
    v_exp_f32 v242, v242
    v_mfma_f32_16x16x32_bf16 v[244:247], a[244:247], v[172:175], v[244:247]
    s_add_u32 s71, s71, s29
    v_exp_f32 v243, v243
    v_mfma_f32_16x16x32_bf16 v[244:247], a[248:251], v[204:207], v[244:247]
    s_add_u32 s74, s74, s101
    v_cvt_pk_bf16_f32 v82, v240, v241
    v_cvt_pk_bf16_f32 v83, v242, v243
    v_mfma_f32_16x16x32_bf16 v[244:247], a[252:255], v[236:239], v[244:247]
    ds_read_b128 a[240:243], v2 offset:12288
    ds_read_b128 a[244:247], v2 offset:13312
    v_mfma_f32_16x16x32_bf16 a[52:55], v[120:123], v[40:43], a[52:55]
    ds_read_b128 a[248:251], v2 offset:14336
    v_add_f32 v213, s15, v148
    v_mfma_f32_16x16x32_bf16 a[52:55], v[124:127], v[44:47], a[52:55]
    ds_read_b128 a[252:255], v2 offset:15360
    v_fma_f32 v188, v208, s11, v213
    v_mfma_f32_16x16x32_bf16 a[56:59], v[120:123], v[48:51], a[56:59]
    ds_read_b128 v[112:115], v2 offset:28672
    v_fma_f32 v189, v209, s11, v213
    v_mfma_f32_16x16x32_bf16 a[56:59], v[124:127], v[52:55], a[56:59]
    ds_read_b128 v[116:119], v2 offset:29696
    v_fma_f32 v190, v210, s11, v213
    v_mfma_f32_16x16x32_bf16 a[60:63], v[120:123], v[56:59], a[60:63]
    v_exp_f32 v244, v244
    v_mfma_f32_16x16x32_bf16 a[60:63], v[124:127], v[60:63], a[60:63]
    v_exp_f32 v245, v245
    v_mfma_f32_16x16x32_bf16 v[248:251], a[224:227], v[132:135], v[184:187]
    s_waitcnt lgkmcnt(2)
    v_exp_f32 v246, v246
    v_mfma_f32_16x16x32_bf16 v[248:251], a[228:231], v[164:167], v[248:251]
    v_exp_f32 v247, v247
    v_mfma_f32_16x16x32_bf16 v[248:251], a[232:235], v[196:199], v[248:251]
    v_fma_f32 v191, v211, s11, v213
    v_cvt_pk_bf16_f32 v90, v244, v245
    v_mfma_f32_16x16x32_bf16 v[248:251], a[236:239], v[228:231], v[248:251]
    s_add_u32 m0, s76, s75
    v_cvt_pk_bf16_f32 v91, v246, v247
    ds_read_b128 v[120:123], v2 offset:30720
    v_mfma_f32_16x16x32_bf16 a[144:147], v[96:99], v[32:35], a[144:147]
    s_mov_b32 s76, s60
    buffer_load_dwordx4 v1, s[36:39], s77 offen sc1 lds
    v_mfma_f32_16x16x32_bf16 a[144:147], v[100:103], v[36:39], a[144:147]
    s_mov_b32 s60, s82
    v_exp_f32 v248, v248
    v_mfma_f32_16x16x32_bf16 a[148:151], v[96:99], v[40:43], a[148:151]
    s_mov_b32 s82, s95
    v_exp_f32 v249, v249
    v_mfma_f32_16x16x32_bf16 a[148:151], v[100:103], v[44:47], a[148:151]
    s_mov_b32 s95, s93
    v_exp_f32 v250, v250
    v_mfma_f32_16x16x32_bf16 v[252:255], a[224:227], v[136:139], v[152:155]
    s_mov_b32 s93, s99
    v_exp_f32 v251, v251
    v_mfma_f32_16x16x32_bf16 v[252:255], a[228:231], v[168:171], v[252:255]
    v_cvt_pk_bf16_f32 v76, v248, v249
    v_cvt_pk_bf16_f32 v77, v250, v251
    v_mfma_f32_16x16x32_bf16 v[252:255], a[232:235], v[200:203], v[252:255]
    ds_read_b128 v[124:127], v2 offset:31744
    v_add_u32 v2, s82, v1
    v_mfma_f32_16x16x32_bf16 v[252:255], a[236:239], v[232:235], v[252:255]
    buffer_load_dwordx4 v1, s[36:39], s77 offen offset:1024 sc1 lds
    v_mfma_f32_16x16x32_bf16 a[152:155], v[96:99], v[48:51], a[152:155]
    v_bfe_u32 v8, v1, 2, 6
    v_accvgpr_read_b32 v4, a112
    v_mfma_f32_16x16x32_bf16 a[152:155], v[100:103], v[52:55], a[152:155]
    v_accvgpr_read_b32 v5, a116
    v_add_u32 v8, 192, v8
    v_mfma_f32_16x16x32_bf16 a[156:159], v[96:99], v[56:59], a[156:159]
    v_exp_f32 v252, v252
    v_mfma_f32_16x16x32_bf16 a[156:159], v[100:103], v[60:63], a[156:159]
    v_exp_f32 v253, v253
    v_mfma_f32_16x16x32_bf16 a[160:163], v[104:107], v[32:35], a[160:163]
    v_exp_f32 v254, v254
    v_mfma_f32_16x16x32_bf16 a[160:163], v[108:111], v[36:39], a[160:163]
    v_exp_f32 v255, v255
    v_mfma_f32_16x16x32_bf16 v[240:243], a[224:227], v[140:143], v[156:159]
    buffer_load_dwordx4 v1, s[36:39], s77 offen offset:2048 sc1 lds
    v_mfma_f32_16x16x32_bf16 v[240:243], a[228:231], v[172:175], v[240:243]
    v_cvt_pk_bf16_f32 v84, v252, v253
    v_cvt_pk_bf16_f32 v85, v254, v255
    v_mfma_f32_16x16x32_bf16 v[240:243], a[232:235], v[204:207], v[240:243]
    v_cvt_pk_bf16_f32 v4, 0, v4
    v_cvt_pk_bf16_f32 v5, 0, v5
    v_mfma_f32_16x16x32_bf16 v[240:243], a[236:239], v[236:239], v[240:243]
    v_lshrrev_b32 v15, 8, v1
    ds_bpermute_b32 v4, v8, v4
    v_mfma_f32_16x16x32_bf16 a[164:167], v[104:107], v[40:43], a[164:167]
    ds_bpermute_b32 v5, v8, v5
    ds_read_b128 a[224:227], v2 offset:0
    v_mfma_f32_16x16x32_bf16 a[164:167], v[108:111], v[44:47], a[164:167]
    ds_read_b128 a[228:231], v2 offset:1024
    v_bfe_u32 v14, v1, 4, 4
    v_mfma_f32_16x16x32_bf16 a[168:171], v[104:107], v[48:51], a[168:171]
    ds_read_b128 a[232:235], v2 offset:2048
    v_lshlrev_b32 v15, 3, v15
    v_mfma_f32_16x16x32_bf16 a[168:171], v[108:111], v[52:55], a[168:171]
    buffer_load_dwordx4 v1, s[36:39], s77 offen offset:3072 sc1 lds
    v_mfma_f32_16x16x32_bf16 a[172:175], v[104:107], v[56:59], a[172:175]
    ds_read_b128 a[236:239], v2 offset:3072
    ds_read_b128 v[96:99], v2 offset:16384
    v_mfma_f32_16x16x32_bf16 a[172:175], v[108:111], v[60:63], a[172:175]
    ds_read_b128 v[100:103], v2 offset:17408
    v_sub_u32 v14, v14, v15
    v_mfma_f32_16x16x32_bf16 v[244:247], a[240:243], v[132:135], v[188:191]
    v_exp_f32 v240, v240
    v_mfma_f32_16x16x32_bf16 v[244:247], a[244:247], v[164:167], v[244:247]
    v_exp_f32 v241, v241
    v_mfma_f32_16x16x32_bf16 v[244:247], a[248:251], v[196:199], v[244:247]
    v_exp_f32 v242, v242
    v_mfma_f32_16x16x32_bf16 v[244:247], a[252:255], v[228:231], v[244:247]
    s_add_u32 s100, s77, 4096
    v_exp_f32 v243, v243
    s_waitcnt lgkmcnt(1)
    v_mfma_f32_16x16x32_bf16 a[176:179], v[112:115], v[32:35], a[176:179]
    s_add_u32 m0, m0, 4096
    v_cvt_pk_bf16_f32 v92, v240, v241
    v_cvt_pk_bf16_f32 v93, v242, v243
    v_mfma_f32_16x16x32_bf16 a[176:179], v[116:119], v[36:39], a[176:179]
    buffer_load_dwordx4 v1, s[36:39], s100 offen sc1 lds
    v_mfma_f32_16x16x32_bf16 a[180:183], v[112:115], v[40:43], a[180:183]
    v_exp_f32 v244, v244
    v_mfma_f32_16x16x32_bf16 a[180:183], v[116:119], v[44:47], a[180:183]
    v_exp_f32 v245, v245
    v_mfma_f32_16x16x32_bf16 v[248:251], a[240:243], v[136:139], v[152:155]
    v_exp_f32 v246, v246
    v_mfma_f32_16x16x32_bf16 v[248:251], a[244:247], v[168:171], v[248:251]
    v_exp_f32 v247, v247
    v_mfma_f32_16x16x32_bf16 v[248:251], a[248:251], v[200:203], v[248:251]
    v_cvt_pk_bf16_f32 v78, v244, v245
    v_cvt_pk_bf16_f32 v79, v246, v247
    v_mfma_f32_16x16x32_bf16 v[248:251], a[252:255], v[232:235], v[248:251]
    buffer_load_dwordx4 v1, s[36:39], s100 offen offset:1024 sc1 lds
    v_mfma_f32_16x16x32_bf16 a[184:187], v[112:115], v[48:51], a[184:187]
    v_and_b32 v15, 16, v1
    v_mov_b32 v31, 0x3f80
    v_mfma_f32_16x16x32_bf16 a[184:187], v[116:119], v[52:55], a[184:187]
    v_ashrrev_i32 v14, 1, v14
    v_lshlrev_b32 v15, v15, v31
    v_mfma_f32_16x16x32_bf16 a[188:191], v[112:115], v[56:59], a[188:191]
    v_exp_f32 v248, v248
    v_mfma_f32_16x16x32_bf16 a[188:191], v[116:119], v[60:63], a[188:191]
    v_exp_f32 v249, v249
    v_mfma_f32_16x16x32_bf16 a[192:195], v[120:123], v[32:35], a[192:195]
    v_exp_f32 v250, v250
    v_mfma_f32_16x16x32_bf16 a[192:195], v[124:127], v[36:39], a[192:195]
    v_exp_f32 v251, v251
    v_mfma_f32_16x16x32_bf16 v[252:255], a[240:243], v[140:143], v[156:159]
    buffer_load_dwordx4 v1, s[36:39], s100 offen offset:2048 sc1 lds
    v_mfma_f32_16x16x32_bf16 v[252:255], a[244:247], v[172:175], v[252:255]
    v_cvt_pk_bf16_f32 v86, v248, v249
    v_cvt_pk_bf16_f32 v87, v250, v251
    v_mfma_f32_16x16x32_bf16 v[252:255], a[248:251], v[204:207], v[252:255]
    v_cmp_eq_i32 vcc, 0, v14
    v_mul_f32 v4, s98, v4
    v_mfma_f32_16x16x32_bf16 v[252:255], a[252:255], v[236:239], v[252:255]
    v_cndmask_b32 v216, 0, v15, vcc
    v_cmp_eq_i32 vcc, 1, v14
    v_mfma_f32_16x16x32_bf16 a[196:199], v[120:123], v[40:43], a[196:199]
    v_mul_f32 v5, s98, v5
    v_cndmask_b32 v217, 0, v15, vcc
    v_mfma_f32_16x16x32_bf16 a[196:199], v[124:127], v[44:47], a[196:199]
    v_cmp_eq_i32 vcc, 2, v14
    v_and_b32 v31, 512, v1
    v_mfma_f32_16x16x32_bf16 a[200:203], v[120:123], v[48:51], a[200:203]
    v_exp_f32 v252, v252
    v_mfma_f32_16x16x32_bf16 a[200:203], v[124:127], v[52:55], a[200:203]
    buffer_load_dwordx4 v1, s[36:39], s100 offen offset:3072 sc1 lds
    v_mfma_f32_16x16x32_bf16 a[204:207], v[120:123], v[56:59], a[204:207]
    v_cndmask_b32 v218, 0, v15, vcc
    v_cmp_eq_i32 vcc, 3, v14
    v_mfma_f32_16x16x32_bf16 a[204:207], v[124:127], v[60:63], a[204:207]
    v_exp_f32 v4, v4
    v_smfmac_f32_16x16x64_bf16 a[208:211], a[136:139], v[32:39], v215
    v_cndmask_b32 v219, 0, v15, vcc
    v_cmp_eq_i32 vcc, -8, v14
    v_smfmac_f32_16x16x64_bf16 a[212:215], a[136:139], v[40:47], v215
    v_exp_f32 v5, v5
    v_smfmac_f32_16x16x64_bf16 a[216:219], a[136:139], v[48:55], v215
    v_cndmask_b32 v220, 0, v15, vcc
    v_cmp_eq_i32 vcc, -7, v14
    v_smfmac_f32_16x16x64_bf16 a[220:223], a[136:139], v[56:63], v215
    s_add_u32 s77, s77, 32768
    v_cndmask_b32 v221, 0, v15, vcc
    v_cmp_eq_i32 vcc, -6, v14
    v_add_f32 v4, 1.0, v4
    v_add_f32 v5, 1.0, v5
    v_cndmask_b32 v222, 0, v15, vcc
    v_cmp_eq_i32 vcc, -5, v14
    v_rcp_f32 v4, v4
    v_rcp_f32 v5, v5
    v_cndmask_b32 v223, 0, v15, vcc
    v_mad_u32_u24 v31, v31, 17, v1
    s_cmp_eq_u32 s6, 7
    s_cselect_b32 s16, s8, 0
    s_cselect_b32 s17, s9, 0
    s_cselect_b32 s18, s10, 0
    s_cselect_b32 s19, s11, 0
    s_cselect_b32 s20, s12, 0
    s_cselect_b32 s21, s13, 0
    s_cselect_b32 s22, s14, 0
    s_cselect_b32 s23, s15, 0
    s_cbranch_scc1 K1_J7
K1_J7_BACK:
    v_add_f32 v212, s20, v152
    v_fma_f32 v176, v208, s16, v212
    v_fma_f32 v177, v209, s16, v212
    v_fma_f32 v178, v210, s16, v212
    v_fma_f32 v179, v211, s16, v212
    s_nop 1
    s_waitcnt lgkmcnt(0)
    v_mfma_f32_16x16x32_bf16 v[240:243], a[224:227], v[136:139], v[176:179]
    s_mov_b32 s99, s76
    ds_read_b128 v[104:107], v2 offset:18432
    ds_read_b128 v[108:111], v2 offset:19456
    v_mfma_f32_16x16x32_bf16 v[240:243], a[228:231], v[168:171], v[240:243]
    v_exp_f32 v253, v253
    v_mfma_f32_16x16x32_bf16 v[240:243], a[232:235], v[200:203], v[240:243]
    v_exp_f32 v254, v254
    v_mfma_f32_16x16x32_bf16 v[240:243], a[236:239], v[232:235], v[240:243]
    v_exp_f32 v255, v255
    v_mfma_f32_16x16x32_bf16 a[4:7], v[96:99], v[72:75], a[4:7]
    s_add_u32 m0, s76, s75
    v_cvt_pk_bf16_f32 v94, v252, v253
    v_cvt_pk_bf16_f32 v95, v254, v255
    v_mfma_f32_16x16x32_bf16 a[4:7], v[100:103], v[76:79], a[4:7]
    s_mov_b32 s76, s60
    buffer_load_dwordx4 v1, s[36:39], s77 offen sc1 lds
    v_mfma_f32_16x16x32_bf16 a[8:11], v[96:99], v[80:83], a[8:11]
    s_mov_b32 s60, s82
    ds_read_b128 a[240:243], v2 offset:4096
    ds_read_b128 a[244:247], v2 offset:5120
    v_mfma_f32_16x16x32_bf16 a[8:11], v[100:103], v[84:87], a[8:11]
    s_mov_b32 s82, s95
    ds_read_b128 a[248:251], v2 offset:6144
    v_add_f32 v213, s21, v152
    v_mfma_f32_16x16x32_bf16 a[12:15], v[96:99], v[88:91], a[12:15]
    s_mov_b32 s95, s93
    ds_read_b128 a[252:255], v2 offset:7168
    v_fma_f32 v180, v208, s17, v213
    v_mfma_f32_16x16x32_bf16 a[12:15], v[100:103], v[92:95], a[12:15]
    s_mov_b32 s93, s99
    ds_read_b128 v[112:115], v2 offset:20480
    v_fma_f32 v181, v209, s17, v213
    v_mfma_f32_16x16x32_bf16 v[244:247], a[224:227], v[140:143], v[156:159]
    ds_read_b128 v[116:119], v2 offset:21504
    v_fma_f32 v182, v210, s17, v213
    v_mfma_f32_16x16x32_bf16 v[244:247], a[228:231], v[172:175], v[244:247]
    v_fma_f32 v183, v211, s17, v213
    ds_read_b128 v[120:123], v2 offset:22528
    v_mfma_f32_16x16x32_bf16 v[244:247], a[232:235], v[204:207], v[244:247]
    ds_read_b128 v[124:127], v2 offset:23552
    v_add_f32 v212, s22, v152
    v_mfma_f32_16x16x32_bf16 v[244:247], a[236:239], v[236:239], v[244:247]
    s_waitcnt lgkmcnt(4)
    buffer_load_dwordx4 v1, s[36:39], s77 offen offset:1024 sc1 lds
    v_mfma_f32_16x16x32_bf16 a[20:23], v[104:107], v[72:75], a[20:23]
    ds_read_b128 a[224:227], v2 offset:8192
    ds_read_b128 a[228:231], v2 offset:9216
    v_mfma_f32_16x16x32_bf16 a[20:23], v[108:111], v[76:79], a[20:23]
    ds_read_b128 a[232:235], v2 offset:10240
    v_fma_f32 v184, v208, s18, v212
    v_mfma_f32_16x16x32_bf16 a[24:27], v[104:107], v[80:83], a[24:27]
    ds_read_b128 a[236:239], v2 offset:11264
    v_fma_f32 v185, v209, s18, v212
    v_mfma_f32_16x16x32_bf16 a[24:27], v[108:111], v[84:87], a[24:27]
    ds_read_b128 v[96:99], v2 offset:24576
    v_fma_f32 v186, v210, s18, v212
    v_mfma_f32_16x16x32_bf16 a[28:31], v[104:107], v[88:91], a[28:31]
    ds_read_b128 v[100:103], v2 offset:25600
    v_fma_f32 v187, v211, s18, v212
    v_mfma_f32_16x16x32_bf16 a[28:31], v[108:111], v[92:95], a[28:31]
    v_exp_f32 v240, v240
    v_mfma_f32_16x16x32_bf16 v[248:251], a[240:243], v[136:139], v[180:183]
    v_exp_f32 v241, v241
    v_mfma_f32_16x16x32_bf16 v[248:251], a[244:247], v[168:171], v[248:251]
    v_exp_f32 v242, v242
    v_mfma_f32_16x16x32_bf16 v[248:251], a[248:251], v[200:203], v[248:251]
    buffer_load_dwordx4 v1, s[36:39], s77 offen offset:2048 sc1 lds
    v_mfma_f32_16x16x32_bf16 v[248:251], a[252:255], v[232:235], v[248:251]
    s_waitcnt lgkmcnt(0)
    v_exp_f32 v243, v243
    v_mfma_f32_16x16x32_bf16 a[36:39], v[112:115], v[72:75], a[36:39]
    v_cvt_pk_bf16_f32 v48, v240, v241
    v_cvt_pk_bf16_f32 v49, v242, v243
    v_mfma_f32_16x16x32_bf16 a[36:39], v[116:119], v[76:79], a[36:39]
    ds_read_b128 v[104:107], v2 offset:26624
    ds_read_b128 v[108:111], v2 offset:27648
    v_mfma_f32_16x16x32_bf16 a[40:43], v[112:115], v[80:83], a[40:43]
    v_exp_f32 v244, v244
    v_mfma_f32_16x16x32_bf16 a[40:43], v[116:119], v[84:87], a[40:43]
    v_exp_f32 v245, v245
    v_mfma_f32_16x16x32_bf16 a[44:47], v[112:115], v[88:91], a[44:47]
    v_exp_f32 v246, v246
    v_mfma_f32_16x16x32_bf16 a[44:47], v[116:119], v[92:95], a[44:47]
    s_waitcnt vmcnt(11)
    v_exp_f32 v247, v247
    v_mfma_f32_16x16x32_bf16 v[12:15], v[64:67], v[216:219], 0
    buffer_load_dwordx4 v1, s[36:39], s77 offen offset:3072 sc1 lds
    v_mfma_f32_16x16x32_bf16 v[16:19], v[68:71], v[216:219], 0
    v_cvt_pk_bf16_f32 v56, v244, v245
    v_cvt_pk_bf16_f32 v57, v246, v247
    v_mfma_f32_16x16x32_bf16 v[252:255], a[240:243], v[140:143], v[156:159]
    ds_read_b128 a[240:243], v2 offset:12288
    ds_read_b128 v[112:115], v2 offset:28672
    v_mfma_f32_16x16x32_bf16 v[252:255], a[244:247], v[172:175], v[252:255]
    v_cvt_pk_bf16_f32 v12, v12, v13
    v_cvt_pk_bf16_f32 v13, v14, v15
    v_mfma_f32_16x16x32_bf16 v[252:255], a[248:251], v[204:207], v[252:255]
    v_cvt_pk_bf16_f32 v14, v16, v17
    v_cvt_pk_bf16_f32 v15, v18, v19
    v_mfma_f32_16x16x32_bf16 v[252:255], a[252:255], v[236:239], v[252:255]
    buffer_store_dwordx4 v[12:15], v31, s[56:59], s63 offen offset:0 sc1
    v_mfma_f32_16x16x32_bf16 a[52:55], v[120:123], v[72:75], a[52:55]
    ds_read_b128 a[244:247], v2 offset:13312
    ds_read_b128 a[248:251], v2 offset:14336
    v_mfma_f32_16x16x32_bf16 a[52:55], v[124:127], v[76:79], a[52:55]
    ds_read_b128 a[252:255], v2 offset:15360
    v_add_f32 v213, s23, v152
    v_mfma_f32_16x16x32_bf16 a[56:59], v[120:123], v[80:83], a[56:59]
    s_add_u32 s100, s77, 4096
    ds_read_b128 v[116:119], v2 offset:29696
    v_fma_f32 v188, v208, s19, v213
    v_mfma_f32_16x16x32_bf16 a[56:59], v[124:127], v[84:87], a[56:59]
    s_add_u32 m0, m0, 4096
    v_exp_f32 v248, v248
    v_mfma_f32_16x16x32_bf16 a[60:63], v[120:123], v[88:91], a[60:63]
    buffer_load_dwordx4 v1, s[36:39], s100 offen sc1 lds
    v_mfma_f32_16x16x32_bf16 a[60:63], v[124:127], v[92:95], a[60:63]
    v_exp_f32 v249, v249
    v_mfma_f32_16x16x32_bf16 v[12:15], v[64:67], v[220:223], 0
    v_exp_f32 v250, v250
    v_mfma_f32_16x16x32_bf16 v[16:19], v[68:71], v[220:223], 0
    v_exp_f32 v251, v251
    v_mfma_f32_16x16x32_bf16 v[240:243], a[224:227], v[136:139], v[184:187]
    v_fma_f32 v189, v209, s19, v213
    v_fma_f32 v190, v210, s19, v213
    v_mfma_f32_16x16x32_bf16 v[240:243], a[228:231], v[168:171], v[240:243]
    v_fma_f32 v191, v211, s19, v213
    v_cvt_pk_bf16_f32 v12, v12, v13
    v_mfma_f32_16x16x32_bf16 v[240:243], a[232:235], v[200:203], v[240:243]
    v_cvt_pk_bf16_f32 v13, v14, v15
    v_cvt_pk_bf16_f32 v14, v16, v17
    v_mfma_f32_16x16x32_bf16 v[240:243], a[236:239], v[232:235], v[240:243]
    v_cvt_pk_bf16_f32 v15, v18, v19
    v_cvt_pk_bf16_f32 v50, v248, v249
    v_mfma_f32_16x16x32_bf16 a[148:151], v[96:99], v[72:75], a[148:151]
    buffer_load_dwordx4 v1, s[36:39], s100 offen offset:1024 sc1 lds
    v_mfma_f32_16x16x32_bf16 a[148:151], v[100:103], v[76:79], a[148:151]
    buffer_store_dwordx4 v[12:15], v31, s[56:59], s63 offen offset:1024 sc1
    v_mfma_f32_16x16x32_bf16 a[152:155], v[96:99], v[80:83], a[152:155]
    v_cvt_pk_bf16_f32 v51, v250, v251
    ds_read_b128 v[120:123], v2 offset:30720
    v_mfma_f32_16x16x32_bf16 a[152:155], v[100:103], v[84:87], a[152:155]
    ds_read_b128 v[124:127], v2 offset:31744
    v_add_u32 v2, s82, v1
    v_mfma_f32_16x16x32_bf16 a[156:159], v[96:99], v[88:91], a[156:159]
    v_exp_f32 v252, v252
    v_mfma_f32_16x16x32_bf16 a[156:159], v[100:103], v[92:95], a[156:159]
    v_exp_f32 v253, v253
    v_mfma_f32_16x16x32_bf16 v[12:15], v[20:23], v[216:219], 0
    v_exp_f32 v254, v254
    v_mfma_f32_16x16x32_bf16 v[16:19], v[24:27], v[216:219], 0
    v_exp_f32 v255, v255
    v_mfma_f32_16x16x32_bf16 v[244:247], a[224:227], v[140:143], v[156:159]
    buffer_load_dwordx4 v1, s[36:39], s100 offen offset:2048 sc1 lds
    v_mfma_f32_16x16x32_bf16 v[244:247], a[228:231], v[172:175], v[244:247]
    v_cvt_pk_bf16_f32 v58, v252, v253
    v_cvt_pk_bf16_f32 v59, v254, v255
    v_mfma_f32_16x16x32_bf16 v[244:247], a[232:235], v[204:207], v[244:247]
    v_cvt_pk_bf16_f32 v12, v12, v13
    v_cvt_pk_bf16_f32 v13, v14, v15
    v_mfma_f32_16x16x32_bf16 v[244:247], a[236:239], v[236:239], v[244:247]
    s_waitcnt lgkmcnt(0)
    v_cvt_pk_bf16_f32 v14, v16, v17
    v_cvt_pk_bf16_f32 v15, v18, v19
    v_mfma_f32_16x16x32_bf16 a[164:167], v[104:107], v[72:75], a[164:167]
    buffer_store_dwordx4 v[12:15], v31, s[56:59], s63 offen offset:512 sc1
    v_mfma_f32_16x16x32_bf16 a[164:167], v[108:111], v[76:79], a[164:167]
    v_exp_f32 v240, v240
    v_mfma_f32_16x16x32_bf16 a[168:171], v[104:107], v[80:83], a[168:171]
    v_exp_f32 v241, v241
    v_mfma_f32_16x16x32_bf16 a[168:171], v[108:111], v[84:87], a[168:171]
    v_exp_f32 v242, v242
    v_mfma_f32_16x16x32_bf16 a[172:175], v[104:107], v[88:91], a[172:175]
    v_exp_f32 v243, v243
    v_mfma_f32_16x16x32_bf16 a[172:175], v[108:111], v[92:95], a[172:175]
    buffer_load_dwordx4 v1, s[36:39], s100 offen offset:3072 sc1 lds
    v_mfma_f32_16x16x32_bf16 v[12:15], v[20:23], v[220:223], 0
    v_exp_f32 v244, v244
    v_mfma_f32_16x16x32_bf16 v[16:19], v[24:27], v[220:223], 0
    v_exp_f32 v245, v245
    v_mfma_f32_16x16x32_bf16 v[248:251], a[240:243], v[136:139], v[188:191]
    v_exp_f32 v246, v246
    v_mfma_f32_16x16x32_bf16 v[248:251], a[244:247], v[168:171], v[248:251]
    v_exp_f32 v247, v247
    v_mfma_f32_16x16x32_bf16 v[248:251], a[248:251], v[200:203], v[248:251]
    v_cvt_pk_bf16_f32 v12, v12, v13
    v_cvt_pk_bf16_f32 v13, v14, v15
    v_mfma_f32_16x16x32_bf16 v[248:251], a[252:255], v[232:235], v[248:251]
    v_cvt_pk_bf16_f32 v14, v16, v17
    v_cvt_pk_bf16_f32 v15, v18, v19
    v_mfma_f32_16x16x32_bf16 a[180:183], v[112:115], v[72:75], a[180:183]
    buffer_store_dwordx4 v[12:15], v31, s[56:59], s63 offen offset:1536 sc1
    v_mfma_f32_16x16x32_bf16 a[180:183], v[116:119], v[76:79], a[180:183]
    s_add_u32 s77, s77, 32768
    v_cvt_pk_bf16_f32 v52, v240, v241
    v_cvt_pk_bf16_f32 v53, v242, v243
    v_mfma_f32_16x16x32_bf16 a[184:187], v[112:115], v[80:83], a[184:187]
    v_exp_f32 v248, v248
    v_mfma_f32_16x16x32_bf16 a[184:187], v[116:119], v[84:87], a[184:187]
    v_exp_f32 v249, v249
    v_mfma_f32_16x16x32_bf16 a[188:191], v[112:115], v[88:91], a[188:191]
    v_exp_f32 v250, v250
    v_mfma_f32_16x16x32_bf16 a[188:191], v[116:119], v[92:95], a[188:191]
    v_exp_f32 v251, v251
    v_mfma_f32_16x16x32_bf16 v[12:15], v[144:147], v[216:219], 0
    v_cvt_pk_bf16_f32 v60, v244, v245
    v_cvt_pk_bf16_f32 v61, v246, v247
    v_mfma_f32_16x16x32_bf16 v[16:19], a[140:143], v[216:219], 0
    v_cvt_pk_bf16_f32 v54, v248, v249
    v_cvt_pk_bf16_f32 v55, v250, v251
    v_mfma_f32_16x16x32_bf16 v[252:255], a[240:243], v[140:143], v[156:159]
    v_accvgpr_read_b32 v6, a120
    v_accvgpr_read_b32 v7, a124
    v_mfma_f32_16x16x32_bf16 v[252:255], a[244:247], v[172:175], v[252:255]
    v_cvt_pk_bf16_f32 v12, v12, v13
    v_cvt_pk_bf16_f32 v13, v14, v15
    v_mfma_f32_16x16x32_bf16 v[252:255], a[248:251], v[204:207], v[252:255]
    v_cvt_pk_bf16_f32 v14, v16, v17
    v_cvt_pk_bf16_f32 v15, v18, v19
    v_mfma_f32_16x16x32_bf16 v[252:255], a[252:255], v[236:239], v[252:255]
    buffer_store_dwordx4 v[12:15], v1, s[56:59], s64 offen offset:0 sc1
    v_mfma_f32_16x16x32_bf16 a[196:199], v[120:123], v[72:75], a[196:199]
    v_cvt_pk_bf16_f32 v6, 0, v6
    v_cvt_pk_bf16_f32 v7, 0, v7
    v_mfma_f32_16x16x32_bf16 a[196:199], v[124:127], v[76:79], a[196:199]
    ds_bpermute_b32 v6, v8, v6
    ds_bpermute_b32 v7, v8, v7
    s_waitcnt vmcnt(8) lgkmcnt(0)
    s_barrier
    v_mfma_f32_16x16x32_bf16 a[200:203], v[120:123], v[80:83], a[200:203]
    ds_read_b128 a[224:227], v2 offset:0
    ds_read_b128 a[228:231], v2 offset:1024
    v_mfma_f32_16x16x32_bf16 a[200:203], v[124:127], v[84:87], a[200:203]
    ds_read_b128 a[232:235], v2 offset:2048
    v_mul_f32 v6, s98, v6
    v_mfma_f32_16x16x32_bf16 a[204:207], v[120:123], v[88:91], a[204:207]
    ds_read_b128 a[236:239], v2 offset:3072
    v_mul_f32 v7, s98, v7
    v_mfma_f32_16x16x32_bf16 a[204:207], v[124:127], v[92:95], a[204:207]
    ds_read_b128 v[96:99], v2 offset:16384
    v_mfma_f32_16x16x32_bf16 v[12:15], v[144:147], v[220:223], 0
    ds_read_b128 v[100:103], v2 offset:17408
    v_mfma_f32_16x16x32_bf16 v[16:19], a[140:143], v[220:223], 0
    v_exp_f32 v252, v252
    v_smfmac_f32_16x16x64_bf16 a[212:215], a[136:139], v[72:79], v215
    v_exp_f32 v6, v6
    v_smfmac_f32_16x16x64_bf16 a[216:219], a[136:139], v[80:87], v215
    v_exp_f32 v7, v7
    v_smfmac_f32_16x16x64_bf16 a[220:223], a[136:139], v[88:95], v215
    v_cvt_pk_bf16_f32 v12, v12, v13
    v_cvt_pk_bf16_f32 v13, v14, v15
    v_add_f32 v6, 1.0, v6
    v_add_f32 v7, 1.0, v7
    v_cvt_pk_bf16_f32 v14, v16, v17
    v_cvt_pk_bf16_f32 v15, v18, v19
    v_rcp_f32 v6, v6
    v_rcp_f32 v7, v7
    buffer_store_dwordx4 v[12:15], v1, s[56:59], s62 offen offset:0 sc1
    s_nop 1
    v_accvgpr_read_b32 v9, a208
    v_accvgpr_read_b32 v10, a209
    v_add_f32 v9, v9, v10
    v_cmp_nge_f32 vcc, 0x5f800000, v9
    v_rcp_f32 v10, v9
    s_nop 0
    s_or_b64 s[84:85], s[84:85], vcc
    v_mul_f32 v10, v10, v4
    v_accvgpr_read_b32 v12, a0
    v_accvgpr_read_b32 v13, a1
    v_accvgpr_read_b32 v14, a2
    v_accvgpr_read_b32 v15, a3
    v_accvgpr_read_b32 v16, a16
    v_accvgpr_read_b32 v17, a17
    v_accvgpr_read_b32 v18, a18
    v_accvgpr_read_b32 v19, a19
    v_pk_mul_f32 v[12:13], v[12:13], v[10:11] op_sel_hi:[1,0]
    v_pk_mul_f32 v[14:15], v[14:15], v[10:11] op_sel_hi:[1,0]
    v_pk_mul_f32 v[16:17], v[16:17], v[10:11] op_sel_hi:[1,0]
    v_pk_mul_f32 v[18:19], v[18:19], v[10:11] op_sel_hi:[1,0]
    v_cvt_pk_bf16_f32 v12, v12, v13
    v_cvt_pk_bf16_f32 v13, v14, v15
    v_cvt_pk_bf16_f32 v14, v16, v17
    v_cvt_pk_bf16_f32 v15, v18, v19
    buffer_store_dwordx4 v[12:15], v1, s[40:43], s80 offen offset:0 sc1
    v_accvgpr_read_b32 v20, a32
    v_accvgpr_read_b32 v21, a33
    v_accvgpr_read_b32 v22, a34
    v_accvgpr_read_b32 v23, a35
    v_accvgpr_read_b32 v24, a48
    v_accvgpr_read_b32 v25, a49
    v_accvgpr_read_b32 v26, a50
    v_accvgpr_read_b32 v27, a51
    v_pk_mul_f32 v[20:21], v[20:21], v[10:11] op_sel_hi:[1,0]
    v_pk_mul_f32 v[22:23], v[22:23], v[10:11] op_sel_hi:[1,0]
    v_pk_mul_f32 v[24:25], v[24:25], v[10:11] op_sel_hi:[1,0]
    v_pk_mul_f32 v[26:27], v[26:27], v[10:11] op_sel_hi:[1,0]
    v_cvt_pk_bf16_f32 v20, v20, v21
    v_cvt_pk_bf16_f32 v21, v22, v23
    v_cvt_pk_bf16_f32 v22, v24, v25
    v_cvt_pk_bf16_f32 v23, v26, v27
    buffer_store_dwordx4 v[20:23], v1, s[40:43], s80 offen offset:1024 sc1
    v_accvgpr_read_b32 v12, a144
    v_accvgpr_read_b32 v13, a145
    v_accvgpr_read_b32 v14, a146
    v_accvgpr_read_b32 v15, a147
    v_accvgpr_read_b32 v16, a160
    v_accvgpr_read_b32 v17, a161
    v_accvgpr_read_b32 v18, a162
    v_accvgpr_read_b32 v19, a163
    v_pk_mul_f32 v[12:13], v[12:13], v[10:11] op_sel_hi:[1,0]
    v_pk_mul_f32 v[14:15], v[14:15], v[10:11] op_sel_hi:[1,0]
    v_pk_mul_f32 v[16:17], v[16:17], v[10:11] op_sel_hi:[1,0]
    v_pk_mul_f32 v[18:19], v[18:19], v[10:11] op_sel_hi:[1,0]
    v_cvt_pk_bf16_f32 v12, v12, v13
    v_cvt_pk_bf16_f32 v13, v14, v15
    v_cvt_pk_bf16_f32 v14, v16, v17
    v_cvt_pk_bf16_f32 v15, v18, v19
    buffer_store_dwordx4 v[12:15], v1, s[40:43], s80 offen offset:2048 sc1
    v_accvgpr_read_b32 v20, a176
    v_accvgpr_read_b32 v21, a177
    v_accvgpr_read_b32 v22, a178
    v_accvgpr_read_b32 v23, a179
    v_accvgpr_read_b32 v24, a192
    v_accvgpr_read_b32 v25, a193
    v_accvgpr_read_b32 v26, a194
    v_accvgpr_read_b32 v27, a195
    v_pk_mul_f32 v[20:21], v[20:21], v[10:11] op_sel_hi:[1,0]
    v_pk_mul_f32 v[22:23], v[22:23], v[10:11] op_sel_hi:[1,0]
    v_pk_mul_f32 v[24:25], v[24:25], v[10:11] op_sel_hi:[1,0]
    v_pk_mul_f32 v[26:27], v[26:27], v[10:11] op_sel_hi:[1,0]
    v_cvt_pk_bf16_f32 v20, v20, v21
    v_cvt_pk_bf16_f32 v21, v22, v23
    v_cvt_pk_bf16_f32 v22, v24, v25
    v_cvt_pk_bf16_f32 v23, v26, v27
    buffer_store_dwordx4 v[20:23], v1, s[40:43], s80 offen offset:3072 sc1
    v_accvgpr_read_b32 v9, a212
    v_accvgpr_read_b32 v10, a213
    v_add_f32 v9, v9, v10
    v_cmp_nge_f32 vcc, 0x5f800000, v9
    v_rcp_f32 v10, v9
    s_nop 0
    s_or_b64 s[84:85], s[84:85], vcc
    v_mul_f32 v10, v10, v5
    s_add_u32 s72, s80, 622592
    v_accvgpr_read_b32 v12, a4
    v_accvgpr_read_b32 v13, a5
    v_accvgpr_read_b32 v14, a6
    v_accvgpr_read_b32 v15, a7
    v_accvgpr_read_b32 v16, a20
    v_accvgpr_read_b32 v17, a21
    v_accvgpr_read_b32 v18, a22
    v_accvgpr_read_b32 v19, a23
    v_pk_mul_f32 v[12:13], v[12:13], v[10:11] op_sel_hi:[1,0]
    v_pk_mul_f32 v[14:15], v[14:15], v[10:11] op_sel_hi:[1,0]
    v_pk_mul_f32 v[16:17], v[16:17], v[10:11] op_sel_hi:[1,0]
    v_pk_mul_f32 v[18:19], v[18:19], v[10:11] op_sel_hi:[1,0]
    v_cvt_pk_bf16_f32 v12, v12, v13
    v_cvt_pk_bf16_f32 v13, v14, v15
    v_cvt_pk_bf16_f32 v14, v16, v17
    v_cvt_pk_bf16_f32 v15, v18, v19
    buffer_store_dwordx4 v[12:15], v1, s[40:43], s72 offen offset:0 sc1
    v_accvgpr_read_b32 v20, a36
    v_accvgpr_read_b32 v21, a37
    v_accvgpr_read_b32 v22, a38
    v_accvgpr_read_b32 v23, a39
    v_accvgpr_read_b32 v24, a52
    v_accvgpr_read_b32 v25, a53
    v_accvgpr_read_b32 v26, a54
    v_accvgpr_read_b32 v27, a55
    v_pk_mul_f32 v[20:21], v[20:21], v[10:11] op_sel_hi:[1,0]
    v_pk_mul_f32 v[22:23], v[22:23], v[10:11] op_sel_hi:[1,0]
    v_pk_mul_f32 v[24:25], v[24:25], v[10:11] op_sel_hi:[1,0]
    v_pk_mul_f32 v[26:27], v[26:27], v[10:11] op_sel_hi:[1,0]
    v_cvt_pk_bf16_f32 v20, v20, v21
    v_cvt_pk_bf16_f32 v21, v22, v23
    v_cvt_pk_bf16_f32 v22, v24, v25
    v_cvt_pk_bf16_f32 v23, v26, v27
    buffer_store_dwordx4 v[20:23], v1, s[40:43], s72 offen offset:1024 sc1
    v_accvgpr_read_b32 v12, a148
    v_accvgpr_read_b32 v13, a149
    v_accvgpr_read_b32 v14, a150
    v_accvgpr_read_b32 v15, a151
    v_accvgpr_read_b32 v16, a164
    v_accvgpr_read_b32 v17, a165
    v_accvgpr_read_b32 v18, a166
    v_accvgpr_read_b32 v19, a167
    v_pk_mul_f32 v[12:13], v[12:13], v[10:11] op_sel_hi:[1,0]
    v_pk_mul_f32 v[14:15], v[14:15], v[10:11] op_sel_hi:[1,0]
    v_pk_mul_f32 v[16:17], v[16:17], v[10:11] op_sel_hi:[1,0]
    v_pk_mul_f32 v[18:19], v[18:19], v[10:11] op_sel_hi:[1,0]
    v_cvt_pk_bf16_f32 v12, v12, v13
    v_cvt_pk_bf16_f32 v13, v14, v15
    v_cvt_pk_bf16_f32 v14, v16, v17
    v_cvt_pk_bf16_f32 v15, v18, v19
    buffer_store_dwordx4 v[12:15], v1, s[40:43], s72 offen offset:2048 sc1
    v_accvgpr_read_b32 v20, a180
    v_accvgpr_read_b32 v21, a181
    v_accvgpr_read_b32 v22, a182
    v_accvgpr_read_b32 v23, a183
    v_accvgpr_read_b32 v24, a196
    v_accvgpr_read_b32 v25, a197
    v_accvgpr_read_b32 v26, a198
    v_accvgpr_read_b32 v27, a199
    v_pk_mul_f32 v[20:21], v[20:21], v[10:11] op_sel_hi:[1,0]
    v_pk_mul_f32 v[22:23], v[22:23], v[10:11] op_sel_hi:[1,0]
    v_pk_mul_f32 v[24:25], v[24:25], v[10:11] op_sel_hi:[1,0]
    v_pk_mul_f32 v[26:27], v[26:27], v[10:11] op_sel_hi:[1,0]
    v_cvt_pk_bf16_f32 v20, v20, v21
    v_cvt_pk_bf16_f32 v21, v22, v23
    v_cvt_pk_bf16_f32 v22, v24, v25
    v_cvt_pk_bf16_f32 v23, v26, v27
    buffer_store_dwordx4 v[20:23], v1, s[40:43], s72 offen offset:3072 sc1
    v_mov_b32 v9, 1
    v_lshlrev_b32 v216, 20, v1
    s_lshl2_add_u32 s7, s4, s101
    s_add_u32 s7, s7, 163840
    s_waitcnt vmcnt(8)
    buffer_store_dword v9, v216, s[32:35], s7 offen sc1
    s_sub_u32 s78, 14, s6
    s_sub_u32 s78, s78, s6
    s_cmp_eq_u32 s78, 0
    s_cbranch_scc1 K1_LS_END
.p2align 3
K1_LS:
    s_waitcnt lgkmcnt(0)
    v_mfma_f32_16x16x32_bf16 v[240:243], a[224:227], v[136:139], v[176:179]
    s_mov_b32 s99, s76
    ds_read_b128 v[104:107], v2 offset:18432
    ds_read_b128 v[108:111], v2 offset:19456
    v_mfma_f32_16x16x32_bf16 v[240:243], a[228:231], v[168:171], v[240:243]
    v_exp_f32 v253, v253
    v_mfma_f32_16x16x32_bf16 v[240:243], a[232:235], v[200:203], v[240:243]
    v_exp_f32 v254, v254
    v_mfma_f32_16x16x32_bf16 v[240:243], a[236:239], v[232:235], v[240:243]
    v_exp_f32 v255, v255
    v_mfma_f32_16x16x32_bf16 a[8:11], v[96:99], v[48:51], a[8:11]
    s_add_u32 m0, s76, s75
    v_cvt_pk_bf16_f32 v62, v252, v253
    v_cvt_pk_bf16_f32 v63, v254, v255
    v_mfma_f32_16x16x32_bf16 a[8:11], v[100:103], v[52:55], a[8:11]
    s_mov_b32 s76, s60
    ds_read_b128 a[240:243], v2 offset:4096
    ds_read_b128 a[244:247], v2 offset:5120
    v_mfma_f32_16x16x32_bf16 a[12:15], v[96:99], v[56:59], a[12:15]
    s_mov_b32 s60, s82
    buffer_load_dwordx4 v1, s[36:39], s77 offen sc1 lds
    v_mfma_f32_16x16x32_bf16 a[12:15], v[100:103], v[60:63], a[12:15]
    s_mov_b32 s82, s95
    ds_read_b128 a[248:251], v2 offset:6144
    ds_read_b128 a[252:255], v2 offset:7168
    v_mfma_f32_16x16x32_bf16 v[244:247], a[224:227], v[140:143], v[156:159]
    s_mov_b32 s95, s93
    v_exp_f32 v240, v240
    v_mfma_f32_16x16x32_bf16 v[244:247], a[228:231], v[172:175], v[244:247]
    s_mov_b32 s93, s99
    ds_read_b128 v[112:115], v2 offset:20480
    ds_read_b128 v[116:119], v2 offset:21504
    v_mfma_f32_16x16x32_bf16 v[244:247], a[232:235], v[204:207], v[244:247]
    buffer_load_dwordx4 v1, s[36:39], s77 offen offset:1024 sc1 lds
    v_mfma_f32_16x16x32_bf16 v[244:247], a[236:239], v[236:239], v[244:247]
    s_waitcnt lgkmcnt(6)
    v_exp_f32 v241, v241
    v_mfma_f32_16x16x32_bf16 a[24:27], v[104:107], v[48:51], a[24:27]
    v_exp_f32 v242, v242
    v_mfma_f32_16x16x32_bf16 a[24:27], v[108:111], v[52:55], a[24:27]
    v_exp_f32 v243, v243
    v_mfma_f32_16x16x32_bf16 a[28:31], v[104:107], v[56:59], a[28:31]
    buffer_load_dwordx4 v1, s[36:39], s77 offen offset:2048 sc1 lds
    v_mfma_f32_16x16x32_bf16 a[28:31], v[108:111], v[60:63], a[28:31]
    s_waitcnt lgkmcnt(2)
    ds_read_b128 v[120:123], v2 offset:22528
    ds_read_b128 v[124:127], v2 offset:23552
    v_mfma_f32_16x16x32_bf16 v[248:251], a[240:243], v[136:139], v[180:183]
    v_cvt_pk_bf16_f32 v80, v240, v241
    v_cvt_pk_bf16_f32 v81, v242, v243
    v_mfma_f32_16x16x32_bf16 v[248:251], a[244:247], v[168:171], v[248:251]
    v_exp_f32 v244, v244
    v_mfma_f32_16x16x32_bf16 v[248:251], a[248:251], v[200:203], v[248:251]
    buffer_load_dwordx4 v1, s[36:39], s77 offen offset:3072 sc1 lds
    v_mfma_f32_16x16x32_bf16 v[248:251], a[252:255], v[232:235], v[248:251]
    s_waitcnt lgkmcnt(2)
    ds_read_b128 a[224:227], v2 offset:8192
    ds_read_b128 a[228:231], v2 offset:9216
    v_mfma_f32_16x16x32_bf16 a[40:43], v[112:115], v[48:51], a[40:43]
    v_exp_f32 v245, v245
    v_mfma_f32_16x16x32_bf16 a[40:43], v[116:119], v[52:55], a[40:43]
    ds_read_b128 a[232:235], v2 offset:10240
    ds_read_b128 a[236:239], v2 offset:11264
    v_mfma_f32_16x16x32_bf16 a[44:47], v[112:115], v[56:59], a[44:47]
    s_add_u32 s100, s77, 4096
    ds_read_b128 v[96:99], v2 offset:24576
    v_cvt_pk_bf16_f32 v88, v244, v245
    v_mfma_f32_16x16x32_bf16 a[44:47], v[116:119], v[60:63], a[44:47]
    s_add_u32 m0, m0, 4096
    v_exp_f32 v246, v246
    v_mfma_f32_16x16x32_bf16 v[252:255], a[240:243], v[140:143], v[156:159]
    buffer_load_dwordx4 v1, s[36:39], s100 offen sc1 lds
    v_mfma_f32_16x16x32_bf16 v[252:255], a[244:247], v[172:175], v[252:255]
    v_exp_f32 v247, v247
    v_mfma_f32_16x16x32_bf16 v[252:255], a[248:251], v[204:207], v[252:255]
    ds_read_b128 v[100:103], v2 offset:25600
    v_cvt_pk_bf16_f32 v89, v246, v247
    v_mfma_f32_16x16x32_bf16 v[252:255], a[252:255], v[236:239], v[252:255]
    s_waitcnt lgkmcnt(4)
    buffer_load_dwordx4 v1, s[36:39], s100 offen offset:1024 sc1 lds
    v_mfma_f32_16x16x32_bf16 a[56:59], v[120:123], v[48:51], a[56:59]
    v_exp_f32 v248, v248
    v_mfma_f32_16x16x32_bf16 a[56:59], v[124:127], v[52:55], a[56:59]
    v_exp_f32 v249, v249
    v_mfma_f32_16x16x32_bf16 a[60:63], v[120:123], v[56:59], a[60:63]
    ds_read_b128 v[104:107], v2 offset:26624
    ds_read_b128 v[108:111], v2 offset:27648
    v_mfma_f32_16x16x32_bf16 a[60:63], v[124:127], v[60:63], a[60:63]
    v_exp_f32 v250, v250
    v_mfma_f32_16x16x32_bf16 v[240:243], a[224:227], v[136:139], v[184:187]
    buffer_load_dwordx4 v1, s[36:39], s100 offen offset:2048 sc1 lds
    v_mfma_f32_16x16x32_bf16 v[240:243], a[228:231], v[168:171], v[240:243]
    s_waitcnt lgkmcnt(2)
    v_exp_f32 v251, v251
    v_mfma_f32_16x16x32_bf16 v[240:243], a[232:235], v[200:203], v[240:243]
    ds_read_b128 a[240:243], v2 offset:12288
    ds_read_b128 a[244:247], v2 offset:13312
    v_mfma_f32_16x16x32_bf16 v[240:243], a[236:239], v[232:235], v[240:243]
    ds_read_b128 a[248:251], v2 offset:14336
    v_cvt_pk_bf16_f32 v82, v248, v249
    v_mfma_f32_16x16x32_bf16 a[152:155], v[96:99], v[48:51], a[152:155]
    buffer_load_dwordx4 v1, s[36:39], s100 offen offset:3072 sc1 lds
    v_mfma_f32_16x16x32_bf16 a[152:155], v[100:103], v[52:55], a[152:155]
    ds_read_b128 a[252:255], v2 offset:15360
    v_cvt_pk_bf16_f32 v83, v250, v251
    v_mfma_f32_16x16x32_bf16 a[156:159], v[96:99], v[56:59], a[156:159]
    ds_read_b128 v[112:115], v2 offset:28672
    ds_read_b128 v[116:119], v2 offset:29696
    v_mfma_f32_16x16x32_bf16 a[156:159], v[100:103], v[60:63], a[156:159]
    v_exp_f32 v252, v252
    v_mfma_f32_16x16x32_bf16 v[244:247], a[224:227], v[140:143], v[156:159]
    s_add_u32 s77, s77, 32768
    v_exp_f32 v253, v253
    v_mfma_f32_16x16x32_bf16 v[244:247], a[228:231], v[172:175], v[244:247]
    v_exp_f32 v254, v254
    v_mfma_f32_16x16x32_bf16 v[244:247], a[232:235], v[204:207], v[244:247]
    v_exp_f32 v255, v255
    v_mfma_f32_16x16x32_bf16 v[244:247], a[236:239], v[236:239], v[244:247]
    s_waitcnt lgkmcnt(3)
    v_cvt_pk_bf16_f32 v90, v252, v253
    v_cvt_pk_bf16_f32 v91, v254, v255
    v_mfma_f32_16x16x32_bf16 a[168:171], v[104:107], v[48:51], a[168:171]
    v_exp_f32 v240, v240
    v_mfma_f32_16x16x32_bf16 a[168:171], v[108:111], v[52:55], a[168:171]
    v_exp_f32 v241, v241
    v_mfma_f32_16x16x32_bf16 a[172:175], v[104:107], v[56:59], a[172:175]
    ds_read_b128 v[120:123], v2 offset:30720
    ds_read_b128 v[124:127], v2 offset:31744
    v_mfma_f32_16x16x32_bf16 a[172:175], v[108:111], v[60:63], a[172:175]
    v_add_u32 v2, s82, v1
    v_cvt_pk_bf16_f32 v84, v240, v241
    v_mfma_f32_16x16x32_bf16 v[248:251], a[240:243], v[136:139], v[188:191]
    v_exp_f32 v242, v242
    v_mfma_f32_16x16x32_bf16 v[248:251], a[244:247], v[168:171], v[248:251]
    v_exp_f32 v243, v243
    v_mfma_f32_16x16x32_bf16 v[248:251], a[248:251], v[200:203], v[248:251]
    s_waitcnt lgkmcnt(2)
    v_exp_f32 v244, v244
    v_mfma_f32_16x16x32_bf16 v[248:251], a[252:255], v[232:235], v[248:251]
    v_exp_f32 v245, v245
    v_mfma_f32_16x16x32_bf16 a[184:187], v[112:115], v[48:51], a[184:187]
    ds_read_b128 a[224:227], v2 offset:0
    ds_read_b128 a[228:231], v2 offset:1024
    v_mfma_f32_16x16x32_bf16 a[184:187], v[116:119], v[52:55], a[184:187]
    ds_read_b128 a[232:235], v2 offset:2048
    v_cvt_pk_bf16_f32 v85, v242, v243
    v_mfma_f32_16x16x32_bf16 a[188:191], v[112:115], v[56:59], a[188:191]
    ds_read_b128 a[236:239], v2 offset:3072
    v_cvt_pk_bf16_f32 v92, v244, v245
    v_mfma_f32_16x16x32_bf16 a[188:191], v[116:119], v[60:63], a[188:191]
    v_exp_f32 v246, v246
    v_mfma_f32_16x16x32_bf16 v[252:255], a[240:243], v[140:143], v[156:159]
    ds_read_b128 v[96:99], v2 offset:16384
    ds_read_b128 v[100:103], v2 offset:17408
    v_mfma_f32_16x16x32_bf16 v[252:255], a[244:247], v[172:175], v[252:255]
    v_exp_f32 v247, v247
    v_mfma_f32_16x16x32_bf16 v[252:255], a[248:251], v[204:207], v[252:255]
    v_exp_f32 v248, v248
    v_mfma_f32_16x16x32_bf16 v[252:255], a[252:255], v[236:239], v[252:255]
    s_waitcnt lgkmcnt(4)
    v_exp_f32 v249, v249
    v_mfma_f32_16x16x32_bf16 a[200:203], v[120:123], v[48:51], a[200:203]
    v_exp_f32 v250, v250
    v_mfma_f32_16x16x32_bf16 a[200:203], v[124:127], v[52:55], a[200:203]
    v_exp_f32 v251, v251
    v_mfma_f32_16x16x32_bf16 a[204:207], v[120:123], v[56:59], a[204:207]
    v_cvt_pk_bf16_f32 v93, v246, v247
    v_cvt_pk_bf16_f32 v86, v248, v249
    v_mfma_f32_16x16x32_bf16 a[204:207], v[124:127], v[60:63], a[204:207]
    v_exp_f32 v252, v252
    v_smfmac_f32_16x16x64_bf16 a[216:219], a[136:139], v[48:55], v215
    s_cmp_le_u32 s78, 2
    v_cvt_pk_bf16_f32 v87, v250, v251
    v_smfmac_f32_16x16x64_bf16 a[220:223], a[136:139], v[56:63], v215
    s_cbranch_scc1 K1_LS_MASK
K1_LS_BACK:
    s_waitcnt lgkmcnt(0)
    v_mfma_f32_16x16x32_bf16 v[240:243], a[224:227], v[136:139], v[176:179]
    s_mov_b32 s99, s76
    ds_read_b128 v[104:107], v2 offset:18432
    ds_read_b128 v[108:111], v2 offset:19456
    v_mfma_f32_16x16x32_bf16 v[240:243], a[228:231], v[168:171], v[240:243]
    v_exp_f32 v253, v253
    v_mfma_f32_16x16x32_bf16 v[240:243], a[232:235], v[200:203], v[240:243]
    v_exp_f32 v254, v254
    v_mfma_f32_16x16x32_bf16 v[240:243], a[236:239], v[232:235], v[240:243]
    v_exp_f32 v255, v255
    v_mfma_f32_16x16x32_bf16 a[8:11], v[96:99], v[80:83], a[8:11]
    s_add_u32 m0, s76, s75
    v_cvt_pk_bf16_f32 v94, v252, v253
    v_cvt_pk_bf16_f32 v95, v254, v255
    v_mfma_f32_16x16x32_bf16 a[8:11], v[100:103], v[84:87], a[8:11]
    s_mov_b32 s76, s60
    ds_read_b128 a[240:243], v2 offset:4096
    ds_read_b128 a[244:247], v2 offset:5120
    v_mfma_f32_16x16x32_bf16 a[12:15], v[96:99], v[88:91], a[12:15]
    s_mov_b32 s60, s82
    buffer_load_dwordx4 v1, s[36:39], s77 offen sc1 lds
    v_mfma_f32_16x16x32_bf16 a[12:15], v[100:103], v[92:95], a[12:15]
    s_mov_b32 s82, s95
    ds_read_b128 a[248:251], v2 offset:6144
    ds_read_b128 a[252:255], v2 offset:7168
    v_mfma_f32_16x16x32_bf16 v[244:247], a[224:227], v[140:143], v[156:159]
    s_mov_b32 s95, s93
    v_exp_f32 v240, v240
    v_mfma_f32_16x16x32_bf16 v[244:247], a[228:231], v[172:175], v[244:247]
    s_mov_b32 s93, s99
    ds_read_b128 v[112:115], v2 offset:20480
    ds_read_b128 v[116:119], v2 offset:21504
    v_mfma_f32_16x16x32_bf16 v[244:247], a[232:235], v[204:207], v[244:247]
    buffer_load_dwordx4 v1, s[36:39], s77 offen offset:1024 sc1 lds
    v_mfma_f32_16x16x32_bf16 v[244:247], a[236:239], v[236:239], v[244:247]
    s_waitcnt lgkmcnt(6)
    v_exp_f32 v241, v241
    v_mfma_f32_16x16x32_bf16 a[24:27], v[104:107], v[80:83], a[24:27]
    v_exp_f32 v242, v242
    v_mfma_f32_16x16x32_bf16 a[24:27], v[108:111], v[84:87], a[24:27]
    v_exp_f32 v243, v243
    v_mfma_f32_16x16x32_bf16 a[28:31], v[104:107], v[88:91], a[28:31]
    buffer_load_dwordx4 v1, s[36:39], s77 offen offset:2048 sc1 lds
    v_mfma_f32_16x16x32_bf16 a[28:31], v[108:111], v[92:95], a[28:31]
    s_waitcnt lgkmcnt(2)
    ds_read_b128 v[120:123], v2 offset:22528
    ds_read_b128 v[124:127], v2 offset:23552
    v_mfma_f32_16x16x32_bf16 v[248:251], a[240:243], v[136:139], v[180:183]
    v_cvt_pk_bf16_f32 v48, v240, v241
    v_cvt_pk_bf16_f32 v49, v242, v243
    v_mfma_f32_16x16x32_bf16 v[248:251], a[244:247], v[168:171], v[248:251]
    v_exp_f32 v244, v244
    v_mfma_f32_16x16x32_bf16 v[248:251], a[248:251], v[200:203], v[248:251]
    buffer_load_dwordx4 v1, s[36:39], s77 offen offset:3072 sc1 lds
    v_mfma_f32_16x16x32_bf16 v[248:251], a[252:255], v[232:235], v[248:251]
    s_waitcnt lgkmcnt(2)
    ds_read_b128 a[224:227], v2 offset:8192
    ds_read_b128 a[228:231], v2 offset:9216
    v_mfma_f32_16x16x32_bf16 a[40:43], v[112:115], v[80:83], a[40:43]
    v_exp_f32 v245, v245
    v_mfma_f32_16x16x32_bf16 a[40:43], v[116:119], v[84:87], a[40:43]
    ds_read_b128 a[232:235], v2 offset:10240
    ds_read_b128 a[236:239], v2 offset:11264
    v_mfma_f32_16x16x32_bf16 a[44:47], v[112:115], v[88:91], a[44:47]
    s_add_u32 s100, s77, 4096
    ds_read_b128 v[96:99], v2 offset:24576
    v_cvt_pk_bf16_f32 v56, v244, v245
    v_mfma_f32_16x16x32_bf16 a[44:47], v[116:119], v[92:95], a[44:47]
    s_add_u32 m0, m0, 4096
    v_exp_f32 v246, v246
    v_mfma_f32_16x16x32_bf16 v[252:255], a[240:243], v[140:143], v[156:159]
    buffer_load_dwordx4 v1, s[36:39], s100 offen sc1 lds
    v_mfma_f32_16x16x32_bf16 v[252:255], a[244:247], v[172:175], v[252:255]
    v_exp_f32 v247, v247
    v_mfma_f32_16x16x32_bf16 v[252:255], a[248:251], v[204:207], v[252:255]
    ds_read_b128 v[100:103], v2 offset:25600
    v_cvt_pk_bf16_f32 v57, v246, v247
    v_mfma_f32_16x16x32_bf16 v[252:255], a[252:255], v[236:239], v[252:255]
    s_waitcnt lgkmcnt(4)
    buffer_load_dwordx4 v1, s[36:39], s100 offen offset:1024 sc1 lds
    v_mfma_f32_16x16x32_bf16 a[56:59], v[120:123], v[80:83], a[56:59]
    v_exp_f32 v248, v248
    v_mfma_f32_16x16x32_bf16 a[56:59], v[124:127], v[84:87], a[56:59]
    v_exp_f32 v249, v249
    v_mfma_f32_16x16x32_bf16 a[60:63], v[120:123], v[88:91], a[60:63]
    ds_read_b128 v[104:107], v2 offset:26624
    ds_read_b128 v[108:111], v2 offset:27648
    v_mfma_f32_16x16x32_bf16 a[60:63], v[124:127], v[92:95], a[60:63]
    v_exp_f32 v250, v250
    v_mfma_f32_16x16x32_bf16 v[240:243], a[224:227], v[136:139], v[184:187]
    buffer_load_dwordx4 v1, s[36:39], s100 offen offset:2048 sc1 lds
    v_mfma_f32_16x16x32_bf16 v[240:243], a[228:231], v[168:171], v[240:243]
    s_waitcnt lgkmcnt(2)
    v_exp_f32 v251, v251
    v_mfma_f32_16x16x32_bf16 v[240:243], a[232:235], v[200:203], v[240:243]
    ds_read_b128 a[240:243], v2 offset:12288
    ds_read_b128 a[244:247], v2 offset:13312
    v_mfma_f32_16x16x32_bf16 v[240:243], a[236:239], v[232:235], v[240:243]
    ds_read_b128 a[248:251], v2 offset:14336
    v_cvt_pk_bf16_f32 v50, v248, v249
    v_mfma_f32_16x16x32_bf16 a[152:155], v[96:99], v[80:83], a[152:155]
    buffer_load_dwordx4 v1, s[36:39], s100 offen offset:3072 sc1 lds
    v_mfma_f32_16x16x32_bf16 a[152:155], v[100:103], v[84:87], a[152:155]
    ds_read_b128 a[252:255], v2 offset:15360
    v_cvt_pk_bf16_f32 v51, v250, v251
    v_mfma_f32_16x16x32_bf16 a[156:159], v[96:99], v[88:91], a[156:159]
    ds_read_b128 v[112:115], v2 offset:28672
    ds_read_b128 v[116:119], v2 offset:29696
    v_mfma_f32_16x16x32_bf16 a[156:159], v[100:103], v[92:95], a[156:159]
    v_exp_f32 v252, v252
    v_mfma_f32_16x16x32_bf16 v[244:247], a[224:227], v[140:143], v[156:159]
    s_add_u32 s77, s77, 32768
    v_exp_f32 v253, v253
    v_mfma_f32_16x16x32_bf16 v[244:247], a[228:231], v[172:175], v[244:247]
    ds_read_b128 v[120:123], v2 offset:30720
    ds_read_b128 v[124:127], v2 offset:31744
    v_mfma_f32_16x16x32_bf16 v[244:247], a[232:235], v[204:207], v[244:247]
    v_add_u32 v2, s82, v1
    v_cvt_pk_bf16_f32 v58, v252, v253
    v_mfma_f32_16x16x32_bf16 v[244:247], a[236:239], v[236:239], v[244:247]
    s_waitcnt lgkmcnt(5)
    v_exp_f32 v254, v254
    v_mfma_f32_16x16x32_bf16 a[168:171], v[104:107], v[80:83], a[168:171]
    v_exp_f32 v255, v255
    v_mfma_f32_16x16x32_bf16 a[168:171], v[108:111], v[84:87], a[168:171]
    v_exp_f32 v240, v240
    v_mfma_f32_16x16x32_bf16 a[172:175], v[104:107], v[88:91], a[172:175]
    v_exp_f32 v241, v241
    v_mfma_f32_16x16x32_bf16 a[172:175], v[108:111], v[92:95], a[172:175]
    v_cvt_pk_bf16_f32 v59, v254, v255
    v_cvt_pk_bf16_f32 v52, v240, v241
    v_mfma_f32_16x16x32_bf16 v[248:251], a[240:243], v[136:139], v[188:191]
    v_exp_f32 v242, v242
    v_mfma_f32_16x16x32_bf16 v[248:251], a[244:247], v[168:171], v[248:251]
    v_exp_f32 v243, v243
    v_mfma_f32_16x16x32_bf16 v[248:251], a[248:251], v[200:203], v[248:251]
    s_waitcnt lgkmcnt(0)
    v_exp_f32 v244, v244
    v_mfma_f32_16x16x32_bf16 v[248:251], a[252:255], v[232:235], v[248:251]
    v_exp_f32 v245, v245
    v_mfma_f32_16x16x32_bf16 a[184:187], v[112:115], v[80:83], a[184:187]
    s_waitcnt vmcnt(8) lgkmcnt(0)
    v_exp_f32 v246, v246
    v_mfma_f32_16x16x32_bf16 a[184:187], v[116:119], v[84:87], a[184:187]
    s_barrier
    ds_read_b128 a[224:227], v2 offset:0
    ds_read_b128 a[228:231], v2 offset:1024
    v_mfma_f32_16x16x32_bf16 a[188:191], v[112:115], v[88:91], a[188:191]
    ds_read_b128 a[232:235], v2 offset:2048
    v_cvt_pk_bf16_f32 v53, v242, v243
    v_mfma_f32_16x16x32_bf16 a[188:191], v[116:119], v[92:95], a[188:191]
    ds_read_b128 a[236:239], v2 offset:3072
    v_cvt_pk_bf16_f32 v60, v244, v245
    v_mfma_f32_16x16x32_bf16 v[252:255], a[240:243], v[140:143], v[156:159]
    v_exp_f32 v247, v247
    v_mfma_f32_16x16x32_bf16 v[252:255], a[244:247], v[172:175], v[252:255]
    ds_read_b128 v[96:99], v2 offset:16384
    ds_read_b128 v[100:103], v2 offset:17408
    v_mfma_f32_16x16x32_bf16 v[252:255], a[248:251], v[204:207], v[252:255]
    v_exp_f32 v248, v248
    v_mfma_f32_16x16x32_bf16 v[252:255], a[252:255], v[236:239], v[252:255]
    v_exp_f32 v249, v249
    v_mfma_f32_16x16x32_bf16 a[200:203], v[120:123], v[80:83], a[200:203]
    v_exp_f32 v250, v250
    v_mfma_f32_16x16x32_bf16 a[200:203], v[124:127], v[84:87], a[200:203]
    v_exp_f32 v251, v251
    v_mfma_f32_16x16x32_bf16 a[204:207], v[120:123], v[88:91], a[204:207]
    v_cvt_pk_bf16_f32 v61, v246, v247
    v_cvt_pk_bf16_f32 v54, v248, v249
    v_mfma_f32_16x16x32_bf16 a[204:207], v[124:127], v[92:95], a[204:207]
    s_sub_u32 s78, s78, 1
    v_exp_f32 v252, v252
    v_smfmac_f32_16x16x64_bf16 a[216:219], a[136:139], v[80:87], v215
    s_cmp_lg_u32 s78, 0
    v_cvt_pk_bf16_f32 v55, v250, v251
    v_smfmac_f32_16x16x64_bf16 a[220:223], a[136:139], v[88:95], v215
    s_cbranch_scc1 K1_LS
K1_LS_END:
    v_add_f32 v212, s12, v156
    v_fma_f32 v176, v208, s8, v212
    v_fma_f32 v177, v209, s8, v212
    v_fma_f32 v178, v210, s8, v212
    v_fma_f32 v179, v211, s8, v212
    s_nop 1
    s_waitcnt lgkmcnt(0)
    v_mfma_f32_16x16x32_bf16 v[240:243], a[224:227], v[140:143], v[176:179]
    s_xor_b32 s21, s3, 1
    ds_read_b128 v[104:107], v2 offset:18432
    s_lshl2_add_u32 s21, s21, s4
    v_mfma_f32_16x16x32_bf16 v[240:243], a[228:231], v[172:175], v[240:243]
    s_mul_i32 s21, s21, 36864
    ds_read_b128 v[108:111], v2 offset:19456
    ds_read_b128 a[240:243], v2 offset:4096
    v_mfma_f32_16x16x32_bf16 v[240:243], a[232:235], v[204:207], v[240:243]
    s_add_u32 s21, s21, s28
    s_mov_b32 m0, s45
    ds_read_b128 a[244:247], v2 offset:5120
    v_mfma_f32_16x16x32_bf16 v[240:243], a[236:239], v[236:239], v[240:243]
    s_mul_i32 s86, s4, 34
    buffer_load_dwordx4 v1, s[56:59], s21 offen sc1 lds
    v_mfma_f32_16x16x32_bf16 a[8:11], v[96:99], v[48:51], a[8:11]
    s_add_u32 s86, s86, 8
    v_exp_f32 v253, v253
    v_mfma_f32_16x16x32_bf16 a[8:11], v[100:103], v[52:55], a[8:11]
    s_mov_b32 s99, s76
    v_exp_f32 v254, v254
    v_mfma_f32_16x16x32_bf16 a[12:15], v[96:99], v[56:59], a[12:15]
    s_mov_b32 s76, s60
    v_exp_f32 v255, v255
    v_cvt_pk_bf16_f32 v62, v252, v253
    v_cvt_pk_bf16_f32 v63, v254, v255
    s_nop 1
    v_mfma_f32_16x16x32_bf16 a[12:15], v[100:103], v[60:63], a[12:15]
    s_mov_b32 s60, s82
    ds_read_b128 a[248:251], v2 offset:6144
    ds_read_b128 a[252:255], v2 offset:7168
    s_waitcnt lgkmcnt(2)
    v_mfma_f32_16x16x32_bf16 a[24:27], v[104:107], v[48:51], a[24:27]
    s_mov_b32 s82, s95
    v_lshrrev_b32 v28, 4, v1
    ds_read_b128 v[112:115], v2 offset:20480
    v_mfma_f32_16x16x32_bf16 a[24:27], v[108:111], v[52:55], a[24:27]
    s_mov_b32 s95, s93
    v_min_u32 v28, 33, v28
    ds_read_b128 v[116:119], v2 offset:21504
    v_mfma_f32_16x16x32_bf16 a[28:31], v[104:107], v[56:59], a[28:31]
    s_mov_b32 s93, s99
    buffer_load_dwordx4 v1, s[56:59], s21 offen offset:1024 sc1 lds
    v_mfma_f32_16x16x32_bf16 a[28:31], v[108:111], v[60:63], a[28:31]
    s_and_b32 s62, s5, 4
    v_add_lshl_u32 v28, v28, s86, 7
    v_add_f32 v213, s13, v156
    v_fma_f32 v180, v208, s9, v213
    v_fma_f32 v181, v209, s9, v213
    v_fma_f32 v182, v210, s9, v213
    v_fma_f32 v183, v211, s9, v213
    s_nop 1
    v_mfma_f32_16x16x32_bf16 v[244:247], a[240:243], v[140:143], v[180:183]
    s_getpc_b64 s[86:87]
    global_load_dword v28, v28, s[86:87]
    v_mfma_f32_16x16x32_bf16 v[244:247], a[244:247], v[172:175], v[244:247]
    s_lshl_b32 s63, s3, 12
    ds_read_b128 v[120:123], v2 offset:22528
    ds_read_b128 v[124:127], v2 offset:23552
    s_waitcnt lgkmcnt(3)
    v_mfma_f32_16x16x32_bf16 v[244:247], a[248:251], v[204:207], v[244:247]
    s_sub_u32 s19, s74, s101
    buffer_load_dwordx4 v1, s[56:59], s21 offen offset:2048 sc1 lds
    v_mfma_f32_16x16x32_bf16 v[244:247], a[252:255], v[236:239], v[244:247]
    s_add_u32 s62, s62, s4
    ds_read_b128 a[224:227], v2 offset:8192
    ds_read_b128 a[228:231], v2 offset:9216
    v_mfma_f32_16x16x32_bf16 a[40:43], v[112:115], v[48:51], a[40:43]
    s_mov_b32 s20, s63
    ds_read_b128 a[232:235], v2 offset:10240
    v_add_f32 v212, s14, v156
    s_waitcnt lgkmcnt(5)
    v_mfma_f32_16x16x32_bf16 a[40:43], v[116:119], v[52:55], a[40:43]
    s_add_u32 s19, s66, s19
    ds_read_b128 a[236:239], v2 offset:11264
    v_fma_f32 v184, v208, s10, v212
    v_mfma_f32_16x16x32_bf16 a[44:47], v[112:115], v[56:59], a[44:47]
    s_mov_b32 s50, 9437184
    ds_read_b128 v[96:99], v2 offset:24576
    v_fma_f32 v185, v209, s10, v212
    v_mfma_f32_16x16x32_bf16 a[44:47], v[116:119], v[60:63], a[44:47]
    s_waitcnt lgkmcnt(5)
    ds_read_b128 v[100:103], v2 offset:25600
    v_fma_f32 v186, v210, s10, v212
    v_mfma_f32_16x16x32_bf16 a[56:59], v[120:123], v[48:51], a[56:59]
    buffer_load_dwordx4 v1, s[56:59], s21 offen offset:3072 sc1 lds
    v_mfma_f32_16x16x32_bf16 a[56:59], v[124:127], v[52:55], a[56:59]
    s_add_u32 s21, s21, 4096
    v_fma_f32 v187, v211, s10, v212
    ds_read_b128 v[104:107], v2 offset:26624
    v_mfma_f32_16x16x32_bf16 a[60:63], v[120:123], v[56:59], a[60:63]
    s_add_u32 m0, s45, 4096
    ds_read_b128 v[108:111], v2 offset:27648
    ds_read_b128 a[240:243], v2 offset:12288
    v_mfma_f32_16x16x32_bf16 a[60:63], v[124:127], v[60:63], a[60:63]
    s_waitcnt lgkmcnt(4)
    ds_read_b128 a[244:247], v2 offset:13312
    v_add_f32 v213, s15, v156
    v_mfma_f32_16x16x32_bf16 v[248:251], a[224:227], v[140:143], v[184:187]
    ds_read_b128 a[248:251], v2 offset:14336
    v_fma_f32 v188, v208, s11, v213
    v_mfma_f32_16x16x32_bf16 v[248:251], a[228:231], v[172:175], v[248:251]
    ds_read_b128 a[252:255], v2 offset:15360
    v_fma_f32 v189, v209, s11, v213
    v_mfma_f32_16x16x32_bf16 v[248:251], a[232:235], v[204:207], v[248:251]
    buffer_load_dwordx4 v1, s[56:59], s21 offen sc1 lds
    v_mfma_f32_16x16x32_bf16 v[248:251], a[236:239], v[236:239], v[248:251]
    ds_read_b128 v[112:115], v2 offset:28672
    ds_read_b128 v[116:119], v2 offset:29696
    v_mfma_f32_16x16x32_bf16 a[152:155], v[96:99], v[48:51], a[152:155]
    s_waitcnt lgkmcnt(4)
    v_fma_f32 v190, v210, s11, v213
    v_fma_f32 v191, v211, s11, v213
    v_mfma_f32_16x16x32_bf16 a[152:155], v[100:103], v[52:55], a[152:155]
    ds_read_b128 v[120:123], v2 offset:30720
    ds_read_b128 v[124:127], v2 offset:31744
    v_mfma_f32_16x16x32_bf16 a[156:159], v[96:99], v[56:59], a[156:159]
    v_add_u32 v2, s82, v1
    ds_read_b128 v[96:99], v2 offset:16384
    v_mfma_f32_16x16x32_bf16 a[156:159], v[100:103], v[60:63], a[156:159]
    ds_read_b128 v[100:103], v2 offset:17408
    v_bfe_u32 v217, v1, 4, 3
    v_mfma_f32_16x16x32_bf16 a[168:171], v[104:107], v[48:51], a[168:171]
    buffer_load_dwordx4 v1, s[56:59], s21 offen offset:1024 sc1 lds
    v_mfma_f32_16x16x32_bf16 a[168:171], v[108:111], v[52:55], a[168:171]
    v_exp_f32 v240, v240
    v_mfma_f32_16x16x32_bf16 a[172:175], v[104:107], v[56:59], a[172:175]
    ds_read_b128 v[104:107], v2 offset:18432
    v_lshlrev_b32 v217, 7, v217
    v_mfma_f32_16x16x32_bf16 a[172:175], v[108:111], v[60:63], a[172:175]
    v_exp_f32 v241, v241
    v_mfma_f32_16x16x32_bf16 v[252:255], a[240:243], v[140:143], v[188:191]
    ds_read_b128 v[108:111], v2 offset:19456
    v_cvt_pk_bf16_f32 v88, v240, v241
    v_mfma_f32_16x16x32_bf16 v[252:255], a[244:247], v[172:175], v[252:255]
    s_waitcnt lgkmcnt(2)
    v_exp_f32 v242, v242
    v_mfma_f32_16x16x32_bf16 v[252:255], a[248:251], v[204:207], v[252:255]
    buffer_load_dwordx4 v1, s[56:59], s21 offen offset:2048 sc1 lds
    v_mfma_f32_16x16x32_bf16 v[252:255], a[252:255], v[236:239], v[252:255]
    v_exp_f32 v243, v243
    v_mfma_f32_16x16x32_bf16 a[184:187], v[112:115], v[48:51], a[184:187]
    v_exp_f32 v244, v244
    v_mfma_f32_16x16x32_bf16 a[184:187], v[116:119], v[52:55], a[184:187]
    v_exp_f32 v245, v245
    v_mfma_f32_16x16x32_bf16 a[188:191], v[112:115], v[56:59], a[188:191]
    ds_read_b128 v[112:115], v2 offset:20480
    v_cvt_pk_bf16_f32 v89, v242, v243
    v_mfma_f32_16x16x32_bf16 a[188:191], v[116:119], v[60:63], a[188:191]
    v_exp_f32 v246, v246
    v_mfma_f32_16x16x32_bf16 a[200:203], v[120:123], v[48:51], a[200:203]
    v_exp_f32 v247, v247
    v_mfma_f32_16x16x32_bf16 a[200:203], v[124:127], v[52:55], a[200:203]
    v_exp_f32 v248, v248
    v_mfma_f32_16x16x32_bf16 a[204:207], v[120:123], v[56:59], a[204:207]
    v_exp_f32 v249, v249
    v_mfma_f32_16x16x32_bf16 a[204:207], v[124:127], v[60:63], a[204:207]
    v_exp_f32 v250, v250
    v_smfmac_f32_16x16x64_bf16 a[216:219], a[136:139], v[48:55], v215
    s_add_u32 s48, s32, 1048576
    s_addc_u32 s49, s33, 0
    ds_read_b128 v[116:119], v2 offset:21504
    v_smfmac_f32_16x16x64_bf16 a[220:223], a[136:139], v[56:63], v215
    v_exp_f32 v251, v251
    v_cvt_pk_bf16_f32 v90, v244, v245
    v_cvt_pk_bf16_f32 v91, v246, v247
    v_cvt_pk_bf16_f32 v92, v248, v249
    v_cvt_pk_bf16_f32 v93, v250, v251
    v_exp_f32 v252, v252
    s_cmp_eq_u32 s6, 7
    s_cbranch_scc1 K1_S7
K1_S7_BACK:
    s_waitcnt lgkmcnt(0)
    v_mfma_f32_16x16x32_bf16 a[12:15], v[96:99], v[88:91], a[12:15]
    ds_read_b128 v[120:123], v2 offset:22528
    v_exp_f32 v253, v253
    v_exp_f32 v254, v254
    v_exp_f32 v255, v255
    v_cvt_pk_bf16_f32 v94, v252, v253
    v_cvt_pk_bf16_f32 v95, v254, v255
    s_nop 1
    v_mfma_f32_16x16x32_bf16 a[12:15], v[100:103], v[92:95], a[12:15]
    ds_read_b128 v[124:127], v2 offset:23552
    ds_read_b128 v[96:99], v2 offset:24576
    v_accvgpr_read_b32 v12, a8
    v_accvgpr_read_b32 v13, a9
    v_accvgpr_read_b32 v14, a10
    v_mfma_f32_16x16x32_bf16 a[28:31], v[104:107], v[88:91], a[28:31]
    ds_read_b128 v[100:103], v2 offset:25600
    v_accvgpr_read_b32 v9, a216
    v_accvgpr_read_b32 v10, a217
    v_add_f32 v9, v9, v10
    v_accvgpr_read_b32 v15, a11
    v_mfma_f32_16x16x32_bf16 a[28:31], v[108:111], v[92:95], a[28:31]
    ds_read_b128 v[104:107], v2 offset:26624
    v_rcp_f32 v10, v9
    v_accvgpr_read_b32 v16, a24
    v_mul_f32 v10, v10, v6
    v_mfma_f32_16x16x32_bf16 a[44:47], v[112:115], v[88:91], a[44:47]
    ds_read_b128 v[108:111], v2 offset:27648
    v_accvgpr_read_b32 v17, a25
    v_accvgpr_read_b32 v18, a26
    v_accvgpr_read_b32 v19, a27
    v_accvgpr_read_b32 v20, a40
    v_mfma_f32_16x16x32_bf16 a[44:47], v[116:119], v[92:95], a[44:47]
    s_waitcnt lgkmcnt(5)
    ds_read_b128 v[112:115], v2 offset:28672
    v_accvgpr_read_b32 v21, a41
    v_accvgpr_read_b32 v22, a42
    v_accvgpr_read_b32 v23, a43
    v_accvgpr_read_b32 v24, a56
    v_mfma_f32_16x16x32_bf16 a[60:63], v[120:123], v[88:91], a[60:63]
    s_waitcnt lgkmcnt(3)
    ds_read_b128 v[116:119], v2 offset:29696
    v_accvgpr_read_b32 v25, a57
    v_accvgpr_read_b32 v26, a58
    v_accvgpr_read_b32 v27, a59
    v_mul_f32 v12, v10, v12
    v_mfma_f32_16x16x32_bf16 a[60:63], v[124:127], v[92:95], a[60:63]
    ds_read_b128 v[120:123], v2 offset:30720
    v_mul_f32 v13, v10, v13
    v_mul_f32 v14, v10, v14
    v_mul_f32 v15, v10, v15
    v_mul_f32 v16, v10, v16
    v_mfma_f32_16x16x32_bf16 a[156:159], v[96:99], v[88:91], a[156:159]
    ds_read_b128 v[124:127], v2 offset:31744
    v_mul_f32 v17, v10, v17
    v_mul_f32 v18, v10, v18
    v_mul_f32 v19, v10, v19
    v_mul_f32 v20, v10, v20
    v_mfma_f32_16x16x32_bf16 a[156:159], v[100:103], v[92:95], a[156:159]
    s_waitcnt lgkmcnt(3)
    v_mul_f32 v21, v10, v21
    v_mul_f32 v22, v10, v22
    v_mul_f32 v23, v10, v23
    v_mul_f32 v24, v10, v24
    v_mul_f32 v25, v10, v25
    v_mfma_f32_16x16x32_bf16 a[172:175], v[104:107], v[88:91], a[172:175]
    v_mul_f32 v26, v10, v26
    v_mul_f32 v27, v10, v27
    v_cvt_pk_bf16_f32 v12, v12, v13
    v_cvt_pk_bf16_f32 v13, v14, v15
    v_cvt_pk_bf16_f32 v14, v16, v17
    v_mfma_f32_16x16x32_bf16 a[172:175], v[108:111], v[92:95], a[172:175]
    v_cvt_pk_bf16_f32 v15, v18, v19
    v_cvt_pk_bf16_f32 v20, v20, v21
    v_cvt_pk_bf16_f32 v21, v22, v23
    v_cvt_pk_bf16_f32 v22, v24, v25
    v_cvt_pk_bf16_f32 v23, v26, v27
    v_mfma_f32_16x16x32_bf16 a[188:191], v[112:115], v[88:91], a[188:191]
    s_waitcnt lgkmcnt(1)
    buffer_store_dwordx4 v[12:15], v1, s[40:43], s81 offen offset:0 sc1
    buffer_store_dwordx4 v[20:23], v1, s[40:43], s81 offen offset:1024 sc1
    v_accvgpr_read_b32 v16, a168
    v_mfma_f32_16x16x32_bf16 a[188:191], v[116:119], v[92:95], a[188:191]
    v_accvgpr_read_b32 v12, a152
    v_accvgpr_read_b32 v13, a153
    v_accvgpr_read_b32 v14, a154
    v_accvgpr_read_b32 v15, a155
    v_accvgpr_read_b32 v17, a169
    v_mfma_f32_16x16x32_bf16 a[204:207], v[120:123], v[88:91], a[204:207]
    s_waitcnt lgkmcnt(0)
    v_accvgpr_read_b32 v18, a170
    v_accvgpr_read_b32 v19, a171
    v_accvgpr_read_b32 v20, a184
    v_accvgpr_read_b32 v21, a185
    v_accvgpr_read_b32 v22, a186
    v_mfma_f32_16x16x32_bf16 a[204:207], v[124:127], v[92:95], a[204:207]
    v_accvgpr_read_b32 v23, a187
    v_accvgpr_read_b32 v24, a200
    v_accvgpr_read_b32 v25, a201
    v_accvgpr_read_b32 v26, a202
    v_accvgpr_read_b32 v27, a203
    v_smfmac_f32_16x16x64_bf16 a[220:223], a[136:139], v[88:95], v215
    v_mul_f32 v12, v10, v12
    v_mul_f32 v13, v10, v13
    v_mul_f32 v14, v10, v14
    v_mul_f32 v15, v10, v15
    v_mul_f32 v16, v10, v16
    v_mul_f32 v17, v10, v17
    v_mul_f32 v18, v10, v18
    v_mul_f32 v19, v10, v19
    v_mul_f32 v20, v10, v20
    v_mul_f32 v21, v10, v21
    v_mul_f32 v22, v10, v22
    v_mul_f32 v23, v10, v23
    v_mul_f32 v24, v10, v24
    v_mul_f32 v25, v10, v25
    v_mul_f32 v26, v10, v26
    v_mul_f32 v27, v10, v27
    v_cmp_nge_f32 vcc, 0x5f800000, v9
    v_cvt_pk_bf16_f32 v12, v12, v13
    v_cvt_pk_bf16_f32 v13, v14, v15
    v_cvt_pk_bf16_f32 v14, v16, v17
    v_cvt_pk_bf16_f32 v15, v18, v19
    v_cvt_pk_bf16_f32 v20, v20, v21
    v_cvt_pk_bf16_f32 v21, v22, v23
    v_cvt_pk_bf16_f32 v22, v24, v25
    v_cvt_pk_bf16_f32 v23, v26, v27
    s_or_b64 s[84:85], s[84:85], vcc
    buffer_store_dwordx4 v[12:15], v1, s[40:43], s81 offen offset:2048 sc1
    buffer_store_dwordx4 v[20:23], v1, s[40:43], s81 offen offset:3072 sc1
    s_nop 3
    v_accvgpr_read_b32 v9, a220
    v_accvgpr_read_b32 v10, a221
    v_add_f32 v9, v9, v10
    v_cmp_nge_f32 vcc, 0x5f800000, v9
    v_rcp_f32 v10, v9
    s_nop 0
    s_or_b64 s[84:85], s[84:85], vcc
    v_mul_f32 v10, v10, v7
    s_add_u32 s72, s81, 622592
    v_accvgpr_read_b32 v12, a12
    v_accvgpr_read_b32 v13, a13
    v_accvgpr_read_b32 v14, a14
    v_accvgpr_read_b32 v15, a15
    v_accvgpr_read_b32 v16, a28
    v_accvgpr_read_b32 v17, a29
    v_accvgpr_read_b32 v18, a30
    v_accvgpr_read_b32 v19, a31
    v_pk_mul_f32 v[12:13], v[12:13], v[10:11] op_sel_hi:[1,0]
    v_pk_mul_f32 v[14:15], v[14:15], v[10:11] op_sel_hi:[1,0]
    v_pk_mul_f32 v[16:17], v[16:17], v[10:11] op_sel_hi:[1,0]
    v_pk_mul_f32 v[18:19], v[18:19], v[10:11] op_sel_hi:[1,0]
    v_cvt_pk_bf16_f32 v12, v12, v13
    v_cvt_pk_bf16_f32 v13, v14, v15
    v_cvt_pk_bf16_f32 v14, v16, v17
    v_cvt_pk_bf16_f32 v15, v18, v19
    buffer_store_dwordx4 v[12:15], v1, s[40:43], s72 offen offset:0 sc1
    v_accvgpr_read_b32 v20, a44
    v_accvgpr_read_b32 v21, a45
    v_accvgpr_read_b32 v22, a46
    v_accvgpr_read_b32 v23, a47
    v_accvgpr_read_b32 v24, a60
    v_accvgpr_read_b32 v25, a61
    v_accvgpr_read_b32 v26, a62
    v_accvgpr_read_b32 v27, a63
    v_pk_mul_f32 v[20:21], v[20:21], v[10:11] op_sel_hi:[1,0]
    v_pk_mul_f32 v[22:23], v[22:23], v[10:11] op_sel_hi:[1,0]
    v_pk_mul_f32 v[24:25], v[24:25], v[10:11] op_sel_hi:[1,0]
    v_pk_mul_f32 v[26:27], v[26:27], v[10:11] op_sel_hi:[1,0]
    v_cvt_pk_bf16_f32 v20, v20, v21
    v_cvt_pk_bf16_f32 v21, v22, v23
    v_cvt_pk_bf16_f32 v22, v24, v25
    v_cvt_pk_bf16_f32 v23, v26, v27
    buffer_store_dwordx4 v[20:23], v1, s[40:43], s72 offen offset:1024 sc1
    v_accvgpr_read_b32 v12, a156
    v_accvgpr_read_b32 v13, a157
    v_accvgpr_read_b32 v14, a158
    v_accvgpr_read_b32 v15, a159
    v_accvgpr_read_b32 v16, a172
    v_accvgpr_read_b32 v17, a173
    v_accvgpr_read_b32 v18, a174
    v_accvgpr_read_b32 v19, a175
    v_pk_mul_f32 v[12:13], v[12:13], v[10:11] op_sel_hi:[1,0]
    v_pk_mul_f32 v[14:15], v[14:15], v[10:11] op_sel_hi:[1,0]
    v_pk_mul_f32 v[16:17], v[16:17], v[10:11] op_sel_hi:[1,0]
    v_pk_mul_f32 v[18:19], v[18:19], v[10:11] op_sel_hi:[1,0]
    v_cvt_pk_bf16_f32 v12, v12, v13
    v_cvt_pk_bf16_f32 v13, v14, v15
    v_cvt_pk_bf16_f32 v14, v16, v17
    v_cvt_pk_bf16_f32 v15, v18, v19
    buffer_store_dwordx4 v[12:15], v1, s[40:43], s72 offen offset:2048 sc1
    v_accvgpr_read_b32 v20, a188
    v_accvgpr_read_b32 v21, a189
    v_accvgpr_read_b32 v22, a190
    v_accvgpr_read_b32 v23, a191
    v_accvgpr_read_b32 v24, a204
    v_accvgpr_read_b32 v25, a205
    v_accvgpr_read_b32 v26, a206
    v_accvgpr_read_b32 v27, a207
    v_pk_mul_f32 v[20:21], v[20:21], v[10:11] op_sel_hi:[1,0]
    v_pk_mul_f32 v[22:23], v[22:23], v[10:11] op_sel_hi:[1,0]
    v_pk_mul_f32 v[24:25], v[24:25], v[10:11] op_sel_hi:[1,0]
    v_pk_mul_f32 v[26:27], v[26:27], v[10:11] op_sel_hi:[1,0]
    v_cvt_pk_bf16_f32 v20, v20, v21
    v_cvt_pk_bf16_f32 v21, v22, v23
    v_cvt_pk_bf16_f32 v22, v24, v25
    v_cvt_pk_bf16_f32 v23, v26, v27
    buffer_store_dwordx4 v[20:23], v1, s[40:43], s72 offen offset:3072 sc1
    buffer_load_dword v3, v217, s[32:35], s19 offen sc1
    s_waitcnt lgkmcnt(0)
    s_barrier
    s_sub_u32 s30, s47, s75
    s_sub_u32 s31, s79, s75
    v_bfe_u32 v20, v1, 4, 4
    v_lshrrev_b32 v21, 8, v1
    s_lshl_b32 s98, s4, 4
    s_add_u32 s98, s98, 16
    v_add_u32 v22, s98, v20
    v_mul_u32_u24 v22, 144, v22
    v_add_u32 v22, s30, v22
    v_lshl_add_u32 v9, v21, 3, v22
    s_lshr_b32 s98, s73, 1
    v_add_u32 v8, s98, v9
    v_subrev_u32 v10, s98, v9
    s_sub_u32 s99, s31, s30
    v_add_u32 v24, s99, v8
    v_add_u32 v25, s99, v9
    v_add_u32 v26, s99, v10
    s_bitcmp1_b32 s4, 0
    s_cselect_b32 s99, s31, s30
    v_mul_u32_u24 v23, 144, v20
    v_lshl_add_u32 v23, v21, 3, v23
    v_add_u32 v13, s99, v23
    v_add_u32 v12, s98, v13
    v_accvgpr_read_b32 v32, a64
    v_accvgpr_read_b32 v33, a65
    v_accvgpr_read_b32 v34, a66
    v_accvgpr_read_b32 v35, a67
    v_cvt_pk_bf16_f32 v32, v32, v33
    v_cvt_pk_bf16_f32 v33, v34, v35
    ds_write_b64 v8, v[32:33] offset:0
    v_accvgpr_read_b32 v36, a68
    v_accvgpr_read_b32 v37, a69
    v_accvgpr_read_b32 v38, a70
    v_accvgpr_read_b32 v39, a71
    v_cvt_pk_bf16_f32 v36, v36, v37
    v_cvt_pk_bf16_f32 v37, v38, v39
    ds_write_b64 v8, v[36:37] offset:9216
    v_accvgpr_read_b32 v40, a72
    v_accvgpr_read_b32 v41, a73
    v_accvgpr_read_b32 v42, a74
    v_accvgpr_read_b32 v43, a75
    v_cvt_pk_bf16_f32 v40, v40, v41
    v_cvt_pk_bf16_f32 v41, v42, v43
    ds_write_b64 v24, v[40:41] offset:0
    v_accvgpr_read_b32 v44, a76
    v_accvgpr_read_b32 v45, a77
    v_accvgpr_read_b32 v46, a78
    v_accvgpr_read_b32 v47, a79
    v_cvt_pk_bf16_f32 v44, v44, v45
    v_cvt_pk_bf16_f32 v45, v46, v47
    ds_write_b64 v24, v[44:45] offset:9216
    v_accvgpr_read_b32 v32, a80
    v_accvgpr_read_b32 v33, a81
    v_accvgpr_read_b32 v34, a82
    v_accvgpr_read_b32 v35, a83
    v_cvt_pk_bf16_f32 v32, v32, v33
    v_cvt_pk_bf16_f32 v33, v34, v35
    ds_write_b64 v9, v[32:33] offset:32
    v_accvgpr_read_b32 v36, a84
    v_accvgpr_read_b32 v37, a85
    v_accvgpr_read_b32 v38, a86
    v_accvgpr_read_b32 v39, a87
    v_cvt_pk_bf16_f32 v36, v36, v37
    v_cvt_pk_bf16_f32 v37, v38, v39
    ds_write_b64 v9, v[36:37] offset:9248
    v_accvgpr_read_b32 v40, a88
    v_accvgpr_read_b32 v41, a89
    v_accvgpr_read_b32 v42, a90
    v_accvgpr_read_b32 v43, a91
    v_cvt_pk_bf16_f32 v40, v40, v41
    v_cvt_pk_bf16_f32 v41, v42, v43
    ds_write_b64 v25, v[40:41] offset:32
    v_accvgpr_read_b32 v44, a92
    v_accvgpr_read_b32 v45, a93
    v_accvgpr_read_b32 v46, a94
    v_accvgpr_read_b32 v47, a95
    v_cvt_pk_bf16_f32 v44, v44, v45
    v_cvt_pk_bf16_f32 v45, v46, v47
    ds_write_b64 v25, v[44:45] offset:9248
    v_accvgpr_read_b32 v32, a96
    v_accvgpr_read_b32 v33, a97
    v_accvgpr_read_b32 v34, a98
    v_accvgpr_read_b32 v35, a99
    v_cvt_pk_bf16_f32 v32, v32, v33
    v_cvt_pk_bf16_f32 v33, v34, v35
    ds_write_b64 v10, v[32:33] offset:64
    v_accvgpr_read_b32 v36, a100
    v_accvgpr_read_b32 v37, a101
    v_accvgpr_read_b32 v38, a102
    v_accvgpr_read_b32 v39, a103
    v_cvt_pk_bf16_f32 v36, v36, v37
    v_cvt_pk_bf16_f32 v37, v38, v39
    ds_write_b64 v10, v[36:37] offset:9280
    v_accvgpr_read_b32 v40, a104
    v_accvgpr_read_b32 v41, a105
    v_accvgpr_read_b32 v42, a106
    v_accvgpr_read_b32 v43, a107
    v_cvt_pk_bf16_f32 v40, v40, v41
    v_cvt_pk_bf16_f32 v41, v42, v43
    ds_write_b64 v26, v[40:41] offset:64
    v_accvgpr_read_b32 v44, a108
    v_accvgpr_read_b32 v45, a109
    v_accvgpr_read_b32 v46, a110
    v_accvgpr_read_b32 v47, a111
    v_cvt_pk_bf16_f32 v44, v44, v45
    v_cvt_pk_bf16_f32 v45, v46, v47
    ds_write_b64 v26, v[44:45] offset:9280
    v_mov_b32 v218, 2
    s_cmp_eq_u64 s[84:85], 0
    s_cselect_b32 s7, s74, 1073741824
    s_cmp_lg_u32 s83, 0
    s_cselect_b32 s7, s74, s7
    s_waitcnt vmcnt(1)
    buffer_store_dword v218, v216, s[32:35], s7 offen sc1
    s_xor_b32 s21, s3, 2
    s_lshl2_add_u32 s21, s21, s4
    s_mul_i32 s21, s21, 36864
    s_add_u32 s21, s21, s28
    s_mov_b32 m0, s46
    s_nop 0
    buffer_load_dwordx4 v1, s[56:59], s21 offen sc1 lds
    v_accvgpr_read_b32 v32, a112
    v_accvgpr_read_b32 v33, a113
    v_accvgpr_read_b32 v34, a114
    v_accvgpr_read_b32 v35, a115
    v_cvt_pk_bf16_f32 v32, v32, v33
    v_cvt_pk_bf16_f32 v33, v34, v35
    ds_write_b64 v9, v[32:33] offset:96
    v_accvgpr_read_b32 v36, a116
    v_accvgpr_read_b32 v37, a117
    v_accvgpr_read_b32 v38, a118
    v_accvgpr_read_b32 v39, a119
    v_cvt_pk_bf16_f32 v36, v36, v37
    buffer_load_dwordx4 v1, s[56:59], s21 offen offset:1024 sc1 lds
    v_cvt_pk_bf16_f32 v37, v38, v39
    ds_write_b64 v9, v[36:37] offset:9312
    v_accvgpr_read_b32 v40, a120
    v_accvgpr_read_b32 v41, a121
    v_accvgpr_read_b32 v42, a122
    v_accvgpr_read_b32 v43, a123
    v_cvt_pk_bf16_f32 v40, v40, v41
    v_cvt_pk_bf16_f32 v41, v42, v43
    ds_write_b64 v25, v[40:41] offset:96
    v_accvgpr_read_b32 v44, a124
    v_accvgpr_read_b32 v45, a125
    v_accvgpr_read_b32 v46, a126
    buffer_load_dwordx4 v1, s[56:59], s21 offen offset:2048 sc1 lds
    v_accvgpr_read_b32 v47, a127
    v_cvt_pk_bf16_f32 v44, v44, v45
    v_cvt_pk_bf16_f32 v45, v46, v47
    s_waitcnt lgkmcnt(3)
    ds_write_b64 v25, v[44:45] offset:9312
    v_accvgpr_read_b32 v32, a128
    v_accvgpr_read_b32 v33, a129
    v_accvgpr_read_b32 v34, a130
    v_accvgpr_read_b32 v35, a131
    v_cvt_pk_bf16_f32 v32, v32, v33
    v_cvt_pk_bf16_f32 v33, v34, v35
    ds_write_b64 v12, v[32:33] offset:0
    v_accvgpr_read_b32 v36, a132
    buffer_load_dwordx4 v1, s[56:59], s21 offen offset:3072 sc1 lds
    v_accvgpr_read_b32 v37, a133
    v_accvgpr_read_b32 v38, a134
    v_accvgpr_read_b32 v39, a135
    v_cvt_pk_bf16_f32 v36, v36, v37
    v_cvt_pk_bf16_f32 v37, v38, v39
    s_cmp_eq_u32 s73, 0
    s_cselect_b64 exec, -1, 0
    ds_write_b64 v13, v[36:37] offset:32
    s_mov_b64 exec, -1
    s_cmp_lg_u64 s[84:85], 0
    s_cselect_b32 s7, 1, 0
    v_mov_b32 v20, s7
    s_lshl2_add_u32 s98, s4, s30
    s_add_u32 s21, s21, 4096
    s_add_u32 m0, s46, 4096
    s_nop 0
    buffer_load_dwordx4 v1, s[56:59], s21 offen sc1 lds
    v_mov_b32 v21, s98
    ds_write_b32 v21, v20 offset:20736
    v_mov_b32 v21, s30
    s_and_b32 s98, s4, 1
    s_lshl_b32 s98, s98, 6
    v_lshrrev_b32 v14, 4, v1
    v_add_u32 v14, s98, v14
    s_sub_u32 s7, 15, s6
    s_cmp_lt_u32 s4, 2
    s_cselect_b32 s7, s6, s7
    s_cselect_b32 s99, s30, s31
    s_lshl_b32 s7, s7, 7
    buffer_load_dwordx4 v1, s[56:59], s21 offen offset:1024 sc1 lds
    v_add_u32 v2, 2, v14
    v_mul_u32_u24 v2, 144, v2
    v_add_u32 v2, s99, v2
    v_add_u32 v14, s7, v14
    v_lshrrev_b32 v15, 4, v14
    s_mov_b32 s98, 155648
    v_mul_lo_u32 v15, v15, s98
    v_and_b32 v23, 0xf0, v1
    v_add_u32 v15, v15, v23
    s_lshl3_add_u32 s98, s6, s62
    s_mul_i32 s98, s98, 155648
    v_add_u32 v4, s98, v1
    buffer_load_dwordx4 v1, s[56:59], s21 offen offset:2048 sc1 lds
    s_sub_u32 s98, 15, s6
    s_lshl3_add_u32 s98, s98, s62
    s_mul_i32 s98, s98, 155648
    v_add_u32 v5, s98, v1
    v_mov_b32 v19, v217
    v_subrev_u32 v23, s75, v1
    v_add_u32 v11, s44, v23
    v_add_u32 v12, s45, v23
    v_add_u32 v13, s46, v23
    v_add_u32 v6, s47, v23
    v_add_u32 v7, s79, v23
    s_mov_b32 s98, 0xbfb8aa3b
    s_mov_b32 s99, 0x3eae1a93
    s_waitcnt vmcnt(8) lgkmcnt(0)
    s_barrier
    ds_read_b128 v[24:27], v21 offset:20736
    ds_read_b128 v[32:35], v2 offset:2016
    ds_read_b128 v[36:39], v2 offset:2032
    ds_read_b128 v[40:43], v2 offset:2048
    ds_read_b128 v[44:47], v2 offset:1728
    ds_read_b128 v[48:51], v2 offset:1744
    ds_read_b128 v[52:55], v2 offset:1760
    s_waitcnt lgkmcnt(6)
    v_or3_b32 v24, v24, v25, v26
    v_or_b32 v24, v24, v27
    s_nop 0
    v_readfirstlane_b32 s7, v24
    s_nop 1
    s_andn2_b32 s7, s7, s83
    s_cbranch_scc1 K1_REDO
    buffer_load_dword v28, v29, s[32:35], s92 offen sc1
    v_cmp_gt_u32 vcc, 1, v3
    s_nop 1
    s_and_b64 vcc, vcc, exec
    s_cbranch_scc1 SPIN_SHORT
BACK_SHORT:
    buffer_load_dwordx4 a[0:3], v4, s[40:43], s63 offen offset:0 sc1
    ds_read_b128 v[128:131], v2 offset:2096
    ds_read_b128 v[132:135], v2 offset:2112
    ds_read_b128 v[136:139], v2 offset:2128
    ds_read_b128 v[56:59], v2 offset:1440
    ds_read_b128 v[60:63], v2 offset:1456
    ds_read_b128 v[64:67], v2 offset:1472
    ds_read_b128 v[68:71], v2 offset:1152
    ds_read_b128 v[72:75], v2 offset:1168
    ds_read_b128 v[76:79], v2 offset:1184
    s_waitcnt lgkmcnt(8)
    v_dot2_f32_bf16 v140, v128, v32, 0
    v_dot2_f32_bf16 v141, v128, v44, 0
    buffer_load_dwordx4 a[8:11], v4, s[40:43], s63 offen offset:1024 sc1
    ds_read_b128 v[80:83], v2 offset:864
    s_waitcnt lgkmcnt(6)
    v_dot2_f32_bf16 v142, v128, v56, 0
    s_waitcnt lgkmcnt(3)
    v_dot2_f32_bf16 v143, v128, v68, 0
    ds_read_b128 v[84:87], v2 offset:880
    v_dot2c_f32_bf16 v140, v129, v33
    v_dot2c_f32_bf16 v141, v129, v45
    ds_read_b128 v[88:91], v2 offset:896
    v_dot2c_f32_bf16 v142, v129, v57
    v_dot2c_f32_bf16 v143, v129, v69
    ds_read_b128 v[92:95], v2 offset:576
    v_dot2c_f32_bf16 v140, v130, v34
    buffer_load_dwordx4 a[16:19], v4, s[40:43], s63 offen offset:2048 sc1
    v_dot2c_f32_bf16 v141, v130, v46
    ds_read_b128 v[96:99], v2 offset:592
    v_dot2c_f32_bf16 v142, v130, v58
    v_dot2c_f32_bf16 v143, v130, v70
    ds_read_b128 v[100:103], v2 offset:608
    v_dot2c_f32_bf16 v140, v131, v35
    v_dot2c_f32_bf16 v141, v131, v47
    ds_read_b128 v[104:107], v2 offset:288
    v_dot2c_f32_bf16 v142, v131, v59
    v_dot2c_f32_bf16 v143, v131, v71
    ds_read_b128 v[108:111], v2 offset:304
    v_dot2c_f32_bf16 v140, v132, v36
    buffer_load_dwordx4 a[24:27], v4, s[40:43], s63 offen offset:3072 sc1
    v_dot2c_f32_bf16 v141, v132, v48
    ds_read_b128 v[112:115], v2 offset:320
    v_dot2c_f32_bf16 v142, v132, v60
    s_waitcnt lgkmcnt(8)
    v_dot2c_f32_bf16 v143, v132, v72
    ds_read_b128 v[116:119], v2 offset:0
    v_dot2c_f32_bf16 v140, v133, v37
    v_dot2c_f32_bf16 v141, v133, v49
    ds_read_b128 v[120:123], v2 offset:16
    v_dot2c_f32_bf16 v142, v133, v61
    v_dot2c_f32_bf16 v143, v133, v73
    ds_read_b128 v[124:127], v2 offset:32
    s_xor_b32 s63, s63, 4096
    buffer_load_dwordx4 a[32:35], v4, s[40:43], s63 offen offset:0 sc1
    v_dot2c_f32_bf16 v140, v134, v38
    v_dot2c_f32_bf16 v141, v134, v50
    v_dot2c_f32_bf16 v142, v134, v62
    v_dot2c_f32_bf16 v143, v134, v74
    v_dot2c_f32_bf16 v140, v135, v39
    v_dot2c_f32_bf16 v141, v135, v51
    v_dot2c_f32_bf16 v142, v135, v63
    v_dot2c_f32_bf16 v143, v135, v75
    v_dot2c_f32_bf16 v140, v136, v40
    v_dot2c_f32_bf16 v141, v136, v52
    v_dot2c_f32_bf16 v142, v136, v64
    buffer_load_dwordx4 a[40:43], v4, s[40:43], s63 offen offset:1024 sc1
    v_dot2c_f32_bf16 v143, v136, v76
    v_dot2_f32_bf16 v144, v128, v80, 0
    s_waitcnt lgkmcnt(4)
    v_dot2_f32_bf16 v145, v128, v92, 0
    ds_read_b128 v[32:35], v2 offset:2064
    v_dot2_f32_bf16 v146, v128, v104, 0
    s_waitcnt lgkmcnt(3)
    v_dot2_f32_bf16 v147, v128, v116, 0
    ds_read_b128 v[36:39], v2 offset:2080
    v_dot2c_f32_bf16 v144, v129, v81
    v_dot2c_f32_bf16 v145, v129, v93
    ds_read_b128 v[44:47], v2 offset:1776
    v_dot2c_f32_bf16 v146, v129, v105
    v_dot2c_f32_bf16 v147, v129, v117
    buffer_load_dwordx4 a[48:51], v4, s[40:43], s63 offen offset:2048 sc1
    ds_read_b128 v[48:51], v2 offset:1792
    v_dot2c_f32_bf16 v144, v130, v82
    v_dot2c_f32_bf16 v145, v130, v94
    ds_read_b128 v[56:59], v2 offset:1488
    v_dot2c_f32_bf16 v146, v130, v106
    v_dot2c_f32_bf16 v147, v130, v118
    ds_read_b128 v[60:63], v2 offset:1504
    v_dot2c_f32_bf16 v144, v131, v83
    v_dot2c_f32_bf16 v145, v131, v95
    ds_read_b128 v[68:71], v2 offset:1200
    v_dot2c_f32_bf16 v146, v131, v107
    buffer_load_dwordx4 a[56:59], v4, s[40:43], s63 offen offset:3072 sc1
    v_dot2c_f32_bf16 v147, v131, v119
    ds_read_b128 v[72:75], v2 offset:1216
    v_dot2c_f32_bf16 v144, v132, v84
    v_dot2c_f32_bf16 v145, v132, v96
    v_dot2c_f32_bf16 v146, v132, v108
    s_waitcnt lgkmcnt(8)
    v_dot2c_f32_bf16 v147, v132, v120
    v_dot2c_f32_bf16 v144, v133, v85
    v_dot2c_f32_bf16 v145, v133, v97
    v_dot2c_f32_bf16 v146, v133, v109
    v_dot2c_f32_bf16 v147, v133, v121
    v_dot2c_f32_bf16 v144, v134, v86
    s_xor_b32 s63, s63, 12288
    buffer_load_dwordx4 a[64:67], v4, s[40:43], s63 offen offset:0 sc1
    v_dot2c_f32_bf16 v145, v134, v98
    v_dot2c_f32_bf16 v146, v134, v110
    v_dot2c_f32_bf16 v147, v134, v122
    v_dot2c_f32_bf16 v144, v135, v87
    v_dot2c_f32_bf16 v145, v135, v99
    v_dot2c_f32_bf16 v146, v135, v111
    v_dot2c_f32_bf16 v147, v135, v123
    v_dot2c_f32_bf16 v144, v136, v88
    v_dot2c_f32_bf16 v145, v136, v100
    v_dot2c_f32_bf16 v146, v136, v112
    v_dot2c_f32_bf16 v147, v136, v124
    v_lshlrev_b32 v8, 16, v138
    buffer_load_dwordx4 a[72:75], v4, s[40:43], s63 offen offset:1024 sc1
    v_mul_f32 v8, s98, v8
    v_exp_f32 v8, v8
    s_or_b32 s7, s6, s4
    s_cbranch_scc0 K1_WMASK
K1_WMASK_BACK:
    v_max3_f32 v9, v140, v141, v142
    v_max3_f32 v10, v143, v144, v145
    v_max3_f32 v9, v9, v146, v147
    v_max_f32 v9, v9, v10
    v_mul_f32 v9, s99, v9
    v_add_f32 v8, 1.0, v8
    buffer_load_dwordx4 a[80:83], v4, s[40:43], s63 offen offset:2048 sc1
    v_fma_f32 v140, v140, s99, -v9
    ds_read_b128 v[80:83], v2 offset:912
    v_fma_f32 v141, v141, s99, -v9
    ds_read_b128 v[84:87], v2 offset:928
    v_fma_f32 v142, v142, s99, -v9
    ds_read_b128 v[92:95], v2 offset:624
    v_fma_f32 v143, v143, s99, -v9
    ds_read_b128 v[96:99], v2 offset:640
    v_fma_f32 v144, v144, s99, -v9
    ds_read_b128 v[104:107], v2 offset:336
    v_fma_f32 v145, v145, s99, -v9
    buffer_load_dwordx4 a[88:91], v4, s[40:43], s63 offen offset:3072 sc1
    s_xor_b32 s63, s63, 4096
    ds_read_b128 v[108:111], v2 offset:352
    v_fma_f32 v146, v146, s99, -v9
    ds_read_b128 v[116:119], v2 offset:48
    v_fma_f32 v147, v147, s99, -v9
    s_waitcnt lgkmcnt(7)
    ds_read_b128 v[120:123], v2 offset:64
    v_exp_f32 v140, v140
    v_exp_f32 v141, v141
    v_exp_f32 v142, v142
    v_exp_f32 v143, v143
    v_exp_f32 v144, v144
    v_exp_f32 v145, v145
    v_exp_f32 v146, v146
    buffer_load_dword v3, v217, s[32:35], s19 offen sc1
    buffer_load_dwordx4 a[96:99], v4, s[40:43], s63 offen offset:0 sc1
    v_exp_f32 v147, v147
    v_add_f32 v10, v140, v141
    v_add_f32 v10, v10, v142
    v_add_f32 v10, v10, v143
    v_add_f32 v10, v10, v144
    v_add_f32 v10, v10, v145
    buffer_load_dwordx4 a[104:107], v4, s[40:43], s63 offen offset:1024 sc1
    v_add_f32 v10, v10, v146
    v_add_f32 v10, v10, v147
    v_mul_f32 v10, v10, v8
    v_rcp_f32 v10, v10
    s_nop 0
    v_mul_f32 v140, v140, v10
    v_mul_f32 v141, v141, v10
    v_mul_f32 v142, v142, v10
    buffer_load_dwordx4 a[112:115], v4, s[40:43], s63 offen offset:2048 sc1
    v_mul_f32 v143, v143, v10
    v_mul_f32 v144, v144, v10
    v_mul_f32 v145, v145, v10
    v_mul_f32 v146, v146, v10
    v_mul_f32 v147, v147, v10
    v_cvt_pk_bf16_f32 v148, 0, v140
    buffer_load_dwordx4 a[120:123], v4, s[40:43], s63 offen offset:3072 sc1
    v_cvt_pk_bf16_f32 v149, 0, v141
    v_cvt_pk_bf16_f32 v150, 0, v142
    v_cvt_pk_bf16_f32 v151, 0, v143
    v_cvt_pk_bf16_f32 v152, 0, v144
    v_cvt_pk_bf16_f32 v153, 0, v145
    v_cvt_pk_bf16_f32 v154, 0, v146
    v_cvt_pk_bf16_f32 v155, 0, v147
    s_xor_b32 s63, s63, 28672
    buffer_load_dwordx4 a[128:131], v4, s[40:43], s63 offen offset:0 sc1
    v_lshrrev_b32 v140, 16, v148
    v_lshrrev_b32 v141, 16, v149
    v_lshrrev_b32 v142, 16, v150
    v_lshrrev_b32 v143, 16, v151
    v_lshrrev_b32 v144, 16, v152
    v_lshrrev_b32 v145, 16, v153
    v_lshrrev_b32 v146, 16, v154
    buffer_load_dwordx4 a[136:139], v4, s[40:43], s63 offen offset:1024 sc1
    v_lshrrev_b32 v147, 16, v155
    v_dot2_f32_bf16 v128, v42, v140, 0
    v_dot2_f32_bf16 v129, v42, v148, 0
    v_dot2_f32_bf16 v130, v43, v140, 0
    v_dot2_f32_bf16 v131, v43, v148, 0
    v_dot2_f32_bf16 v132, v32, v140, 0
    buffer_load_dwordx4 a[144:147], v4, s[40:43], s63 offen offset:2048 sc1
    v_dot2_f32_bf16 v133, v32, v148, 0
    v_dot2_f32_bf16 v134, v33, v140, 0
    v_dot2_f32_bf16 v135, v33, v148, 0
    v_dot2_f32_bf16 v136, v34, v140, 0
    v_dot2_f32_bf16 v137, v34, v148, 0
    v_dot2_f32_bf16 v138, v35, v140, 0
    v_dot2_f32_bf16 v139, v35, v148, 0
    buffer_load_dwordx4 a[152:155], v4, s[40:43], s63 offen offset:3072 sc1
    s_xor_b32 s63, s63, 4096
    v_dot2_f32_bf16 v156, v36, v140, 0
    v_dot2_f32_bf16 v157, v36, v148, 0
    v_dot2_f32_bf16 v158, v37, v140, 0
    v_dot2_f32_bf16 v159, v37, v148, 0
    v_dot2_f32_bf16 v17, v38, v140, 0
    v_dot2_f32_bf16 v18, v38, v148, 0
    v_dot2c_f32_bf16 v128, v54, v141
    s_waitcnt vmcnt(8)
    v_cmp_gt_u32 vcc, 2, v3
    s_nop 1
    s_and_b64 vcc, vcc, exec
    s_cbranch_scc1 SPIN_CTX
BACK_CTX:
    buffer_load_dwordx4 a[4:7], v5, s[40:43], s20 offen offset:0 sc1
    v_dot2c_f32_bf16 v129, v54, v149
    v_dot2c_f32_bf16 v130, v55, v141
    v_dot2c_f32_bf16 v131, v55, v149
    v_dot2c_f32_bf16 v132, v44, v141
    v_dot2c_f32_bf16 v133, v44, v149
    v_dot2c_f32_bf16 v134, v45, v141
    v_dot2c_f32_bf16 v135, v45, v149
    v_dot2c_f32_bf16 v136, v46, v141
    v_dot2c_f32_bf16 v137, v46, v149
    v_dot2c_f32_bf16 v138, v47, v141
    v_dot2c_f32_bf16 v139, v47, v149
    v_dot2c_f32_bf16 v156, v48, v141
    v_dot2c_f32_bf16 v157, v48, v149
    buffer_load_dwordx4 a[12:15], v5, s[40:43], s20 offen offset:1024 sc1
    v_dot2c_f32_bf16 v158, v49, v141
    v_dot2c_f32_bf16 v159, v49, v149
    v_dot2c_f32_bf16 v17, v50, v141
    v_dot2c_f32_bf16 v18, v50, v149
    v_dot2c_f32_bf16 v128, v66, v142
    v_dot2c_f32_bf16 v129, v66, v150
    v_dot2c_f32_bf16 v130, v67, v142
    v_dot2c_f32_bf16 v131, v67, v150
    v_dot2c_f32_bf16 v132, v56, v142
    v_dot2c_f32_bf16 v133, v56, v150
    v_dot2c_f32_bf16 v134, v57, v142
    v_dot2c_f32_bf16 v135, v57, v150
    v_dot2c_f32_bf16 v136, v58, v142
    v_dot2c_f32_bf16 v137, v58, v150
    buffer_load_dwordx4 a[20:23], v5, s[40:43], s20 offen offset:2048 sc1
    v_dot2c_f32_bf16 v138, v59, v142
    v_dot2c_f32_bf16 v139, v59, v150
    v_dot2c_f32_bf16 v156, v60, v142
    v_dot2c_f32_bf16 v157, v60, v150
    v_dot2c_f32_bf16 v158, v61, v142
    v_dot2c_f32_bf16 v159, v61, v150
    v_dot2c_f32_bf16 v17, v62, v142
    v_dot2c_f32_bf16 v18, v62, v150
    v_dot2c_f32_bf16 v128, v78, v143
    v_dot2c_f32_bf16 v129, v78, v151
    v_dot2c_f32_bf16 v130, v79, v143
    v_dot2c_f32_bf16 v131, v79, v151
    v_dot2c_f32_bf16 v132, v68, v143
    v_dot2c_f32_bf16 v133, v68, v151
    buffer_load_dwordx4 a[28:31], v5, s[40:43], s20 offen offset:3072 sc1
    v_dot2c_f32_bf16 v134, v69, v143
    v_dot2c_f32_bf16 v135, v69, v151
    v_dot2c_f32_bf16 v136, v70, v143
    v_dot2c_f32_bf16 v137, v70, v151
    v_dot2c_f32_bf16 v138, v71, v143
    v_dot2c_f32_bf16 v139, v71, v151
    v_dot2c_f32_bf16 v156, v72, v143
    v_dot2c_f32_bf16 v157, v72, v151
    v_dot2c_f32_bf16 v158, v73, v143
    v_dot2c_f32_bf16 v159, v73, v151
    v_dot2c_f32_bf16 v17, v74, v143
    v_dot2c_f32_bf16 v18, v74, v151
    v_dot2c_f32_bf16 v128, v90, v144
    v_dot2c_f32_bf16 v129, v90, v152
    s_xor_b32 s20, s20, 4096
    buffer_load_dwordx4 a[36:39], v5, s[40:43], s20 offen offset:0 sc1
    v_dot2c_f32_bf16 v130, v91, v144
    v_dot2c_f32_bf16 v131, v91, v152
    s_waitcnt lgkmcnt(0)
    v_dot2c_f32_bf16 v132, v80, v144
    v_dot2c_f32_bf16 v133, v80, v152
    v_dot2c_f32_bf16 v134, v81, v144
    v_dot2c_f32_bf16 v135, v81, v152
    v_dot2c_f32_bf16 v136, v82, v144
    v_dot2c_f32_bf16 v137, v82, v152
    v_dot2c_f32_bf16 v138, v83, v144
    v_dot2c_f32_bf16 v139, v83, v152
    v_dot2c_f32_bf16 v156, v84, v144
    v_dot2c_f32_bf16 v157, v84, v152
    v_dot2c_f32_bf16 v158, v85, v144
    buffer_load_dwordx4 a[44:47], v5, s[40:43], s20 offen offset:1024 sc1
    v_dot2c_f32_bf16 v159, v85, v152
    v_dot2c_f32_bf16 v17, v86, v144
    v_dot2c_f32_bf16 v18, v86, v152
    v_dot2c_f32_bf16 v128, v102, v145
    v_dot2c_f32_bf16 v129, v102, v153
    v_dot2c_f32_bf16 v130, v103, v145
    v_dot2c_f32_bf16 v131, v103, v153
    v_dot2c_f32_bf16 v132, v92, v145
    v_dot2c_f32_bf16 v133, v92, v153
    v_dot2c_f32_bf16 v134, v93, v145
    v_dot2c_f32_bf16 v135, v93, v153
    v_dot2c_f32_bf16 v136, v94, v145
    v_dot2c_f32_bf16 v137, v94, v153
    v_dot2c_f32_bf16 v138, v95, v145
    buffer_load_dwordx4 a[52:55], v5, s[40:43], s20 offen offset:2048 sc1
    v_dot2c_f32_bf16 v139, v95, v153
    v_dot2c_f32_bf16 v156, v96, v145
    v_dot2c_f32_bf16 v157, v96, v153
    v_dot2c_f32_bf16 v158, v97, v145
    v_dot2c_f32_bf16 v159, v97, v153
    v_dot2c_f32_bf16 v17, v98, v145
    v_dot2c_f32_bf16 v18, v98, v153
    v_dot2c_f32_bf16 v128, v114, v146
    v_dot2c_f32_bf16 v129, v114, v154
    v_dot2c_f32_bf16 v130, v115, v146
    v_dot2c_f32_bf16 v131, v115, v154
    v_dot2c_f32_bf16 v132, v104, v146
    v_dot2c_f32_bf16 v133, v104, v154
    v_dot2c_f32_bf16 v134, v105, v146
    buffer_load_dwordx4 a[60:63], v5, s[40:43], s20 offen offset:3072 sc1
    s_xor_b32 s20, s20, 12288
    v_dot2c_f32_bf16 v135, v105, v154
    v_dot2c_f32_bf16 v136, v106, v146
    v_dot2c_f32_bf16 v137, v106, v154
    v_dot2c_f32_bf16 v138, v107, v146
    v_dot2c_f32_bf16 v139, v107, v154
    v_dot2c_f32_bf16 v156, v108, v146
    v_dot2c_f32_bf16 v157, v108, v154
    v_dot2c_f32_bf16 v158, v109, v146
    v_dot2c_f32_bf16 v159, v109, v154
    v_dot2c_f32_bf16 v17, v110, v146
    v_dot2c_f32_bf16 v18, v110, v154
    v_dot2c_f32_bf16 v128, v126, v147
    v_dot2c_f32_bf16 v129, v126, v155
    v_dot2c_f32_bf16 v130, v127, v147
    v_dot2c_f32_bf16 v131, v127, v155
    v_dot2c_f32_bf16 v132, v116, v147
    v_dot2c_f32_bf16 v133, v116, v155
    v_dot2c_f32_bf16 v134, v117, v147
    v_dot2c_f32_bf16 v135, v117, v155
    v_dot2c_f32_bf16 v136, v118, v147
    v_dot2c_f32_bf16 v137, v118, v155
    v_dot2c_f32_bf16 v138, v119, v147
    v_dot2c_f32_bf16 v139, v119, v155
    v_dot2c_f32_bf16 v156, v120, v147
    v_dot2c_f32_bf16 v157, v120, v155
    v_dot2c_f32_bf16 v158, v121, v147
    v_dot2c_f32_bf16 v159, v121, v155
    v_dot2c_f32_bf16 v17, v122, v147
    v_dot2c_f32_bf16 v18, v122, v155
    v_mov_b32 v89, 0
    v_mov_b32 v90, 0
    v_mov_b32 v91, 0
    v_cvt_pk_bf16_f32 v80, v128, v129
    v_cvt_pk_bf16_f32 v81, v130, v131
    v_cvt_pk_bf16_f32 v82, v132, v133
    v_cvt_pk_bf16_f32 v83, v134, v135
    v_cvt_pk_bf16_f32 v84, v136, v137
    v_cvt_pk_bf16_f32 v85, v138, v139
    v_cvt_pk_bf16_f32 v86, v156, v157
    v_cvt_pk_bf16_f32 v87, v158, v159
    v_cvt_pk_bf16_f32 v88, v17, v18
    v_cmp_gt_u32 vcc, 1, v28
    s_nop 1
    s_and_b64 vcc, vcc, exec
    s_cbranch_scc1 SPIN_ALL
BACK_ALL:
    s_waitcnt vmcnt(4)
    s_barrier
    ds_read_b128 v[104:107], v11 offset:0
    ds_read_b128 v[108:111], v11 offset:8192
    ds_read_b128 v[112:115], v11 offset:16384
    ds_read_b128 v[116:119], v11 offset:24576
    s_waitcnt lgkmcnt(3)
    v_mfma_f32_16x16x32_bf16 v[176:179], v[104:107], a[0:3], 0
    s_lshl3_add_u32 s98, 1, s5
    ds_read_b128 v[120:123], v11 offset:1024
    ds_read_b128 v[124:127], v11 offset:9216
    s_waitcnt lgkmcnt(4)
    v_mfma_f32_16x16x32_bf16 v[176:179], v[108:111], a[8:11], v[176:179]
    s_and_b32 s98, s98, 31
    buffer_load_dwordx4 a[68:71], v5, s[40:43], s20 offen offset:0 sc1
    s_waitcnt lgkmcnt(3)
    v_mfma_f32_16x16x32_bf16 v[176:179], v[112:115], a[16:19], v[176:179]
    s_lshl_b32 s8, s6, 5
    ds_read_b128 v[128:131], v11 offset:17408
    ds_read_b128 v[132:135], v11 offset:25600
    s_waitcnt lgkmcnt(4)
    v_mfma_f32_16x16x32_bf16 v[176:179], v[116:119], a[24:27], v[176:179]
    s_add_u32 s98, s98, s8
    ds_read_b128 v[136:139], v11 offset:2048
    v_mov_b32 v16, 0x44444444
    v_mfma_f32_16x16x32_bf16 v[180:183], v[104:107], a[4:7], 0
    s_mul_i32 s98, s98, 3
    buffer_load_dwordx4 a[76:79], v5, s[40:43], s20 offen offset:1024 sc1
    v_mfma_f32_16x16x32_bf16 v[180:183], v[108:111], a[12:15], v[180:183]
    s_sub_u32 s98, s98, 1
    ds_read_b128 v[140:143], v11 offset:10240
    ds_read_b128 v[144:147], v11 offset:18432
    v_mfma_f32_16x16x32_bf16 v[180:183], v[112:115], a[20:23], v[180:183]
    s_add_u32 s98, s98, 3
    ds_read_b128 v[148:151], v11 offset:26624
    v_mfma_f32_16x16x32_bf16 v[180:183], v[116:119], a[28:31], v[180:183]
    s_lshl2_add_u32 s98, s98, s4
    ds_read_b128 v[104:107], v11 offset:3072
    s_waitcnt lgkmcnt(5)
    v_mfma_f32_16x16x32_bf16 v[184:187], v[120:123], a[0:3], 0
    s_mul_i32 s8, s98, 3072
    buffer_load_dwordx4 a[84:87], v5, s[40:43], s20 offen offset:2048 sc1
    v_mfma_f32_16x16x32_bf16 v[184:187], v[124:127], a[8:11], v[184:187]
    s_lshl3_add_u32 s98, 2, s5
    ds_read_b128 v[108:111], v11 offset:11264
    ds_read_b128 v[112:115], v11 offset:19456
    v_mfma_f32_16x16x32_bf16 v[184:187], v[128:131], a[16:19], v[184:187]
    s_and_b32 s98, s98, 31
    ds_read_b128 v[116:119], v11 offset:27648
    v_mfma_f32_16x16x32_bf16 v[184:187], v[132:135], a[24:27], v[184:187]
    s_lshl_b32 s9, s6, 5
    v_mfma_f32_16x16x32_bf16 v[188:191], v[120:123], a[4:7], 0
    s_add_u32 s98, s98, s9
    buffer_load_dwordx4 a[92:95], v5, s[40:43], s20 offen offset:3072 sc1
    v_mfma_f32_16x16x32_bf16 v[188:191], v[124:127], a[12:15], v[188:191]
    s_xor_b32 s20, s20, 4096
    ds_read_b128 v[120:123], v11 offset:4096
    ds_read_b128 v[124:127], v11 offset:12288
    v_mfma_f32_16x16x32_bf16 v[188:191], v[128:131], a[20:23], v[188:191]
    s_mul_i32 s98, s98, 3
    ds_read_b128 v[128:131], v11 offset:20480
    v_mfma_f32_16x16x32_bf16 v[188:191], v[132:135], a[28:31], v[188:191]
    s_sub_u32 s98, s98, 2
    ds_read_b128 v[132:135], v11 offset:28672
    s_waitcnt lgkmcnt(4)
    v_mfma_f32_16x16x32_bf16 v[192:195], v[136:139], a[0:3], 0
    s_add_u32 s98, s98, 3
    buffer_store_dwordx4 v[80:83], v15, s[40:43], s71 offen offset:0 sc1
    v_mfma_f32_16x16x32_bf16 v[192:195], v[140:143], a[8:11], v[192:195]
    s_lshl2_add_u32 s98, s98, s4
    v_mfma_f32_16x16x32_bf16 v[192:195], v[144:147], a[16:19], v[192:195]
    s_mul_i32 s9, s98, 3072
    v_mfma_f32_16x16x32_bf16 v[192:195], v[148:151], a[24:27], v[192:195]
    s_lshl3_add_u32 s98, 3, s5
    v_mfma_f32_16x16x32_bf16 v[196:199], v[136:139], a[4:7], 0
    s_and_b32 s98, s98, 31
    ds_read_b128 v[136:139], v11 offset:5120
    v_mfma_f32_16x16x32_bf16 v[196:199], v[140:143], a[12:15], v[196:199]
    s_lshl_b32 s10, s6, 5
    buffer_store_dwordx4 v[84:87], v15, s[40:43], s71 offen offset:256 sc1
    v_mfma_f32_16x16x32_bf16 v[196:199], v[144:147], a[20:23], v[196:199]
    s_add_u32 s98, s98, s10
    ds_read_b128 v[140:143], v11 offset:13312
    ds_read_b128 v[144:147], v11 offset:21504
    v_mfma_f32_16x16x32_bf16 v[196:199], v[148:151], a[28:31], v[196:199]
    s_mul_i32 s98, s98, 3
    ds_read_b128 v[148:151], v11 offset:29696
    v_mfma_f32_16x16x32_bf16 v[200:203], v[104:107], a[0:3], 0
    s_sub_u32 s98, s98, 3
    v_mfma_f32_16x16x32_bf16 v[200:203], v[108:111], a[8:11], v[200:203]
    s_add_u32 s98, s98, 3
    buffer_store_dwordx4 v[88:91], v15, s[40:43], s70 offen offset:0 sc1
    v_mfma_f32_16x16x32_bf16 v[200:203], v[112:115], a[16:19], v[200:203]
    s_xor_b32 s21, s3, 3
    v_mfma_f32_16x16x32_bf16 v[200:203], v[116:119], a[24:27], v[200:203]
    s_lshl2_add_u32 s21, s21, s4
    v_mfma_f32_16x16x32_bf16 v[204:207], v[104:107], a[4:7], 0
    s_mul_i32 s21, s21, 36864
    ds_read_b128 v[104:107], v11 offset:6144
    v_mfma_f32_16x16x32_bf16 v[204:207], v[108:111], a[12:15], v[204:207]
    s_add_u32 s21, s21, s28
    s_mov_b32 m0, s47
    ds_read_b128 v[108:111], v11 offset:14336
    v_mfma_f32_16x16x32_bf16 v[204:207], v[112:115], a[20:23], v[204:207]
    s_lshl2_add_u32 s98, s98, s4
    buffer_load_dwordx4 v1, s[56:59], s21 offen sc1 lds
    v_mfma_f32_16x16x32_bf16 v[204:207], v[116:119], a[28:31], v[204:207]
    s_mul_i32 s10, s98, 3072
    ds_read_b128 v[112:115], v11 offset:22528
    ds_read_b128 v[116:119], v11 offset:30720
    s_waitcnt lgkmcnt(4)
    v_mfma_f32_16x16x32_bf16 v[208:211], v[120:123], a[0:3], 0
    s_sub_u32 s99, s4, s61
    v_mfma_f32_16x16x32_bf16 v[208:211], v[124:127], a[8:11], v[208:211]
    s_and_b32 s99, s99, 3
    buffer_load_dwordx4 v1, s[56:59], s21 offen offset:1024 sc1 lds
    v_mfma_f32_16x16x32_bf16 v[208:211], v[128:131], a[16:19], v[208:211]
    s_lshl3_add_u32 s98, s99, s5
    v_mfma_f32_16x16x32_bf16 v[208:211], v[132:135], a[24:27], v[208:211]
    s_and_b32 s98, s98, 31
    v_mfma_f32_16x16x32_bf16 v[212:215], v[120:123], a[4:7], 0
    s_lshl_b32 s11, s6, 5
    ds_read_b128 v[120:123], v12 offset:0
    v_mfma_f32_16x16x32_bf16 v[212:215], v[124:127], a[12:15], v[212:215]
    s_add_u32 s98, s98, s11
    buffer_load_dwordx4 v1, s[56:59], s21 offen offset:2048 sc1 lds
    v_mfma_f32_16x16x32_bf16 v[212:215], v[128:131], a[20:23], v[212:215]
    s_mul_i32 s98, s98, 3
    ds_read_b128 v[124:127], v12 offset:8192
    ds_read_b128 v[128:131], v12 offset:16384
    v_mfma_f32_16x16x32_bf16 v[212:215], v[132:135], a[28:31], v[212:215]
    s_sub_u32 s98, s98, s99
    ds_read_b128 v[132:135], v12 offset:24576
    v_mfma_f32_16x16x32_bf16 v[216:219], v[136:139], a[0:3], 0
    s_add_u32 s98, s98, 3
    v_mfma_f32_16x16x32_bf16 v[216:219], v[140:143], a[8:11], v[216:219]
    s_lshl2_add_u32 s98, s98, s4
    v_mfma_f32_16x16x32_bf16 v[216:219], v[144:147], a[16:19], v[216:219]
    s_mul_i32 s11, s98, 3072
    buffer_load_dwordx4 v1, s[56:59], s21 offen offset:3072 sc1 lds
    v_mfma_f32_16x16x32_bf16 v[216:219], v[148:151], a[24:27], v[216:219]
    s_waitcnt vmcnt(11)
    v_mfma_f32_16x16x32_bf16 v[220:223], v[136:139], a[4:7], 0
    s_add_u32 s21, s21, 4096
    ds_read_b128 v[136:139], v12 offset:1024
    v_mfma_f32_16x16x32_bf16 v[220:223], v[140:143], a[12:15], v[220:223]
    s_add_u32 m0, s47, 4096
    ds_read_b128 v[140:143], v12 offset:9216
    v_mfma_f32_16x16x32_bf16 v[220:223], v[144:147], a[20:23], v[220:223]
    buffer_load_dwordx4 v1, s[56:59], s21 offen sc1 lds
    v_mfma_f32_16x16x32_bf16 v[220:223], v[148:151], a[28:31], v[220:223]
    s_waitcnt lgkmcnt(2)
    ds_read_b128 v[144:147], v12 offset:17408
    ds_read_b128 v[148:151], v12 offset:25600
    v_mfma_f32_16x16x32_bf16 v[224:227], v[104:107], a[0:3], 0
    s_cmp_eq_u32 s99, 0
    s_cselect_b32 s11, 1073741824, s11
    v_mfma_f32_16x16x32_bf16 v[224:227], v[108:111], a[8:11], v[224:227]
    v_mfma_f32_16x16x32_bf16 v[224:227], v[112:115], a[16:19], v[224:227]
    buffer_load_dwordx4 v1, s[56:59], s21 offen offset:1024 sc1 lds
    v_mfma_f32_16x16x32_bf16 v[224:227], v[116:119], a[24:27], v[224:227]
    v_mfma_f32_16x16x32_bf16 v[228:231], v[104:107], a[4:7], 0
    ds_read_b128 v[104:107], v12 offset:2048
    v_mfma_f32_16x16x32_bf16 v[228:231], v[108:111], a[12:15], v[228:231]
    ds_read_b128 v[108:111], v12 offset:10240
    v_mfma_f32_16x16x32_bf16 v[228:231], v[112:115], a[20:23], v[228:231]
    buffer_load_dwordx4 v1, s[56:59], s21 offen offset:2048 sc1 lds
    v_mfma_f32_16x16x32_bf16 v[228:231], v[116:119], a[28:31], v[228:231]
    ds_read_b128 v[112:115], v12 offset:18432
    ds_read_b128 v[116:119], v12 offset:26624
    v_mfma_f32_16x16x32_bf16 v[176:179], v[120:123], a[32:35], v[176:179]
    v_mfma_f32_16x16x32_bf16 v[176:179], v[124:127], a[40:43], v[176:179]
    v_mfma_f32_16x16x32_bf16 v[176:179], v[128:131], a[48:51], v[176:179]
    buffer_load_dwordx4 a[100:103], v5, s[40:43], s20 offen offset:0 sc1
    v_mfma_f32_16x16x32_bf16 v[176:179], v[132:135], a[56:59], v[176:179]
    v_mfma_f32_16x16x32_bf16 v[180:183], v[120:123], a[36:39], v[180:183]
    ds_read_b128 v[120:123], v12 offset:3072
    v_mfma_f32_16x16x32_bf16 v[180:183], v[124:127], a[44:47], v[180:183]
    ds_read_b128 v[124:127], v12 offset:11264
    v_mfma_f32_16x16x32_bf16 v[180:183], v[128:131], a[52:55], v[180:183]
    ds_read_b128 v[128:131], v12 offset:19456
    v_mfma_f32_16x16x32_bf16 v[180:183], v[132:135], a[60:63], v[180:183]
    s_waitcnt lgkmcnt(3)
    buffer_load_dwordx4 a[108:111], v5, s[40:43], s20 offen offset:1024 sc1
    v_mfma_f32_16x16x32_bf16 v[184:187], v[136:139], a[32:35], v[184:187]
    ds_read_b128 v[132:135], v12 offset:27648
    v_mfma_f32_16x16x32_bf16 v[184:187], v[140:143], a[40:43], v[184:187]
    v_mfma_f32_16x16x32_bf16 v[184:187], v[144:147], a[48:51], v[184:187]
    v_mfma_f32_16x16x32_bf16 v[184:187], v[148:151], a[56:59], v[184:187]
    buffer_load_dwordx4 a[116:119], v5, s[40:43], s20 offen offset:2048 sc1
    v_mfma_f32_16x16x32_bf16 v[188:191], v[136:139], a[36:39], v[188:191]
    ds_read_b128 v[136:139], v12 offset:4096
    v_mfma_f32_16x16x32_bf16 v[188:191], v[140:143], a[44:47], v[188:191]
    ds_read_b128 v[140:143], v12 offset:12288
    v_mfma_f32_16x16x32_bf16 v[188:191], v[144:147], a[52:55], v[188:191]
    ds_read_b128 v[144:147], v12 offset:20480
    v_mfma_f32_16x16x32_bf16 v[188:191], v[148:151], a[60:63], v[188:191]
    buffer_load_dwordx4 a[124:127], v5, s[40:43], s20 offen offset:3072 sc1
    v_mfma_f32_16x16x32_bf16 v[192:195], v[104:107], a[32:35], v[192:195]
    s_xor_b32 s21, s3, 4
    ds_read_b128 v[148:151], v12 offset:28672
    v_mfma_f32_16x16x32_bf16 v[192:195], v[108:111], a[40:43], v[192:195]
    s_lshl2_add_u32 s21, s21, s4
    v_mfma_f32_16x16x32_bf16 v[192:195], v[112:115], a[48:51], v[192:195]
    s_mul_i32 s21, s21, 36864
    v_mfma_f32_16x16x32_bf16 v[192:195], v[116:119], a[56:59], v[192:195]
    s_add_u32 s21, s21, s28
    s_mov_b32 m0, s79
    v_mfma_f32_16x16x32_bf16 v[196:199], v[104:107], a[36:39], v[196:199]
    s_xor_b32 s20, s20, 28672
    buffer_load_dwordx4 v1, s[56:59], s21 offen sc1 lds
    v_mfma_f32_16x16x32_bf16 v[196:199], v[108:111], a[44:47], v[196:199]
    ds_read_b128 v[104:107], v12 offset:5120
    ds_read_b128 v[108:111], v12 offset:13312
    v_mfma_f32_16x16x32_bf16 v[196:199], v[112:115], a[52:55], v[196:199]
    ds_read_b128 v[112:115], v12 offset:21504
    v_mfma_f32_16x16x32_bf16 v[196:199], v[116:119], a[60:63], v[196:199]
    s_waitcnt lgkmcnt(3)
    buffer_load_dwordx4 v1, s[56:59], s21 offen offset:1024 sc1 lds
    v_mfma_f32_16x16x32_bf16 v[200:203], v[120:123], a[32:35], v[200:203]
    ds_read_b128 v[116:119], v12 offset:29696
    v_mfma_f32_16x16x32_bf16 v[200:203], v[124:127], a[40:43], v[200:203]
    v_mfma_f32_16x16x32_bf16 v[200:203], v[128:131], a[48:51], v[200:203]
    v_mfma_f32_16x16x32_bf16 v[200:203], v[132:135], a[56:59], v[200:203]
    v_mfma_f32_16x16x32_bf16 v[204:207], v[120:123], a[36:39], v[204:207]
    buffer_load_dwordx4 v1, s[56:59], s21 offen offset:2048 sc1 lds
    v_mfma_f32_16x16x32_bf16 v[204:207], v[124:127], a[44:47], v[204:207]
    ds_read_b128 v[120:123], v12 offset:6144
    ds_read_b128 v[124:127], v12 offset:14336
    v_mfma_f32_16x16x32_bf16 v[204:207], v[128:131], a[52:55], v[204:207]
    ds_read_b128 v[128:131], v12 offset:22528
    v_mfma_f32_16x16x32_bf16 v[204:207], v[132:135], a[60:63], v[204:207]
    ds_read_b128 v[132:135], v12 offset:30720
    v_mfma_f32_16x16x32_bf16 v[208:211], v[136:139], a[32:35], v[208:211]
    buffer_load_dwordx4 v1, s[56:59], s21 offen offset:3072 sc1 lds
    v_mfma_f32_16x16x32_bf16 v[208:211], v[140:143], a[40:43], v[208:211]
    s_add_u32 s21, s21, 4096
    v_mfma_f32_16x16x32_bf16 v[208:211], v[144:147], a[48:51], v[208:211]
    s_add_u32 m0, s79, 4096
    v_mfma_f32_16x16x32_bf16 v[208:211], v[148:151], a[56:59], v[208:211]
    v_mfma_f32_16x16x32_bf16 v[212:215], v[136:139], a[36:39], v[212:215]
    buffer_load_dwordx4 v1, s[56:59], s21 offen sc1 lds
    v_mfma_f32_16x16x32_bf16 v[212:215], v[140:143], a[44:47], v[212:215]
    ds_read_b128 v[136:139], v13 offset:0
    ds_read_b128 v[140:143], v13 offset:8192
    v_mfma_f32_16x16x32_bf16 v[212:215], v[144:147], a[52:55], v[212:215]
    ds_read_b128 v[144:147], v13 offset:16384
    v_mfma_f32_16x16x32_bf16 v[212:215], v[148:151], a[60:63], v[212:215]
    s_waitcnt lgkmcnt(3)
    ds_read_b128 v[148:151], v13 offset:24576
    v_mfma_f32_16x16x32_bf16 v[216:219], v[104:107], a[32:35], v[216:219]
    buffer_load_dwordx4 v1, s[56:59], s21 offen offset:1024 sc1 lds
    v_mfma_f32_16x16x32_bf16 v[216:219], v[108:111], a[40:43], v[216:219]
    v_mfma_f32_16x16x32_bf16 v[216:219], v[112:115], a[48:51], v[216:219]
    v_mfma_f32_16x16x32_bf16 v[216:219], v[116:119], a[56:59], v[216:219]
    s_waitcnt vmcnt(20)
    s_barrier
    v_mfma_f32_16x16x32_bf16 v[220:223], v[104:107], a[36:39], v[220:223]
    buffer_load_dwordx4 v1, s[56:59], s21 offen offset:2048 sc1 lds
    v_mfma_f32_16x16x32_bf16 v[220:223], v[108:111], a[44:47], v[220:223]
    ds_read_b128 v[104:107], v13 offset:1024
    ds_read_b128 v[108:111], v13 offset:9216
    v_mfma_f32_16x16x32_bf16 v[220:223], v[112:115], a[52:55], v[220:223]
    ds_read_b128 v[112:115], v13 offset:17408
    v_mfma_f32_16x16x32_bf16 v[220:223], v[116:119], a[60:63], v[220:223]
    ds_read_b128 v[116:119], v13 offset:25600
    v_mfma_f32_16x16x32_bf16 v[224:227], v[120:123], a[32:35], v[224:227]
    v_mfma_f32_16x16x32_bf16 v[224:227], v[124:127], a[40:43], v[224:227]
    buffer_load_dwordx4 a[132:135], v5, s[40:43], s20 offen offset:0 sc1
    v_mfma_f32_16x16x32_bf16 v[224:227], v[128:131], a[48:51], v[224:227]
    v_mfma_f32_16x16x32_bf16 v[224:227], v[132:135], a[56:59], v[224:227]
    v_mfma_f32_16x16x32_bf16 v[228:231], v[120:123], a[36:39], v[228:231]
    ds_read_b128 v[120:123], v13 offset:2048
    v_mfma_f32_16x16x32_bf16 v[228:231], v[124:127], a[44:47], v[228:231]
    buffer_load_dwordx4 a[140:143], v5, s[40:43], s20 offen offset:1024 sc1
    v_mfma_f32_16x16x32_bf16 v[228:231], v[128:131], a[52:55], v[228:231]
    ds_read_b128 v[124:127], v13 offset:10240
    ds_read_b128 v[128:131], v13 offset:18432
    v_mfma_f32_16x16x32_bf16 v[228:231], v[132:135], a[60:63], v[228:231]
    s_waitcnt lgkmcnt(3)
    ds_read_b128 v[132:135], v13 offset:26624
    v_mfma_f32_16x16x32_bf16 v[176:179], v[136:139], a[64:67], v[176:179]
    v_mfma_f32_16x16x32_bf16 v[176:179], v[140:143], a[72:75], v[176:179]
    buffer_load_dwordx4 a[148:151], v5, s[40:43], s20 offen offset:2048 sc1
    v_mfma_f32_16x16x32_bf16 v[176:179], v[144:147], a[80:83], v[176:179]
    v_mfma_f32_16x16x32_bf16 v[176:179], v[148:151], a[88:91], v[176:179]
    v_mfma_f32_16x16x32_bf16 v[180:183], v[136:139], a[68:71], v[180:183]
    ds_read_b128 v[136:139], v13 offset:3072
    v_mfma_f32_16x16x32_bf16 v[180:183], v[140:143], a[76:79], v[180:183]
    buffer_load_dwordx4 a[156:159], v5, s[40:43], s20 offen offset:3072 sc1
    v_mfma_f32_16x16x32_bf16 v[180:183], v[144:147], a[84:87], v[180:183]
    s_xor_b32 s21, s3, 5
    ds_read_b128 v[140:143], v13 offset:11264
    ds_read_b128 v[144:147], v13 offset:19456
    v_mfma_f32_16x16x32_bf16 v[180:183], v[148:151], a[92:95], v[180:183]
    s_lshl2_add_u32 s21, s21, s4
    ds_read_b128 v[148:151], v13 offset:27648
    v_mfma_f32_16x16x32_bf16 v[184:187], v[104:107], a[64:67], v[184:187]
    s_mul_i32 s21, s21, 36864
    v_mfma_f32_16x16x32_bf16 v[184:187], v[108:111], a[72:75], v[184:187]
    s_add_u32 s21, s21, s28
    s_mov_b32 m0, s44
    v_mfma_f32_16x16x32_bf16 v[184:187], v[112:115], a[80:83], v[184:187]
    s_xor_b32 s20, s20, 4096
    buffer_load_dwordx4 v1, s[56:59], s21 offen sc1 lds
    v_mfma_f32_16x16x32_bf16 v[184:187], v[116:119], a[88:91], v[184:187]
    v_mfma_f32_16x16x32_bf16 v[188:191], v[104:107], a[68:71], v[188:191]
    ds_read_b128 v[104:107], v13 offset:4096
    v_mfma_f32_16x16x32_bf16 v[188:191], v[108:111], a[76:79], v[188:191]
    ds_read_b128 v[108:111], v13 offset:12288
    v_mfma_f32_16x16x32_bf16 v[188:191], v[112:115], a[84:87], v[188:191]
    buffer_load_dwordx4 v1, s[56:59], s21 offen offset:1024 sc1 lds
    v_mfma_f32_16x16x32_bf16 v[188:191], v[116:119], a[92:95], v[188:191]
    s_waitcnt lgkmcnt(2)
    ds_read_b128 v[112:115], v13 offset:20480
    ds_read_b128 v[116:119], v13 offset:28672
    v_mfma_f32_16x16x32_bf16 v[192:195], v[120:123], a[64:67], v[192:195]
    v_mfma_f32_16x16x32_bf16 v[192:195], v[124:127], a[72:75], v[192:195]
    v_mfma_f32_16x16x32_bf16 v[192:195], v[128:131], a[80:83], v[192:195]
    buffer_load_dwordx4 v1, s[56:59], s21 offen offset:2048 sc1 lds
    v_mfma_f32_16x16x32_bf16 v[192:195], v[132:135], a[88:91], v[192:195]
    v_mfma_f32_16x16x32_bf16 v[196:199], v[120:123], a[68:71], v[196:199]
    ds_read_b128 v[120:123], v13 offset:5120
    v_mfma_f32_16x16x32_bf16 v[196:199], v[124:127], a[76:79], v[196:199]
    ds_read_b128 v[124:127], v13 offset:13312
    v_mfma_f32_16x16x32_bf16 v[196:199], v[128:131], a[84:87], v[196:199]
    buffer_load_dwordx4 v1, s[56:59], s21 offen offset:3072 sc1 lds
    v_mfma_f32_16x16x32_bf16 v[196:199], v[132:135], a[92:95], v[196:199]
    s_add_u32 s21, s21, 4096
    ds_read_b128 v[128:131], v13 offset:21504
    ds_read_b128 v[132:135], v13 offset:29696
    v_mfma_f32_16x16x32_bf16 v[200:203], v[136:139], a[64:67], v[200:203]
    s_add_u32 m0, s44, 4096
    v_mfma_f32_16x16x32_bf16 v[200:203], v[140:143], a[72:75], v[200:203]
    v_mfma_f32_16x16x32_bf16 v[200:203], v[144:147], a[80:83], v[200:203]
    buffer_load_dwordx4 v1, s[56:59], s21 offen sc1 lds
    v_mfma_f32_16x16x32_bf16 v[200:203], v[148:151], a[88:91], v[200:203]
    v_mfma_f32_16x16x32_bf16 v[204:207], v[136:139], a[68:71], v[204:207]
    ds_read_b128 v[136:139], v13 offset:6144
    v_mfma_f32_16x16x32_bf16 v[204:207], v[140:143], a[76:79], v[204:207]
    ds_read_b128 v[140:143], v13 offset:14336
    v_mfma_f32_16x16x32_bf16 v[204:207], v[144:147], a[84:87], v[204:207]
    buffer_load_dwordx4 v1, s[56:59], s21 offen offset:1024 sc1 lds
    v_mfma_f32_16x16x32_bf16 v[204:207], v[148:151], a[92:95], v[204:207]
    s_waitcnt lgkmcnt(2)
    ds_read_b128 v[144:147], v13 offset:22528
    ds_read_b128 v[148:151], v13 offset:30720
    v_mfma_f32_16x16x32_bf16 v[208:211], v[104:107], a[64:67], v[208:211]
    v_mfma_f32_16x16x32_bf16 v[208:211], v[108:111], a[72:75], v[208:211]
    v_mfma_f32_16x16x32_bf16 v[208:211], v[112:115], a[80:83], v[208:211]
    v_mfma_f32_16x16x32_bf16 v[208:211], v[116:119], a[88:91], v[208:211]
    buffer_load_dwordx4 v1, s[56:59], s21 offen offset:2048 sc1 lds
    v_mfma_f32_16x16x32_bf16 v[212:215], v[104:107], a[68:71], v[212:215]
    v_mfma_f32_16x16x32_bf16 v[212:215], v[108:111], a[76:79], v[212:215]
    v_mfma_f32_16x16x32_bf16 v[212:215], v[112:115], a[84:87], v[212:215]
    v_mfma_f32_16x16x32_bf16 v[212:215], v[116:119], a[92:95], v[212:215]
    buffer_load_dwordx4 a[160:163], v4, s[40:43], s63 offen offset:0 sc1
    v_mfma_f32_16x16x32_bf16 v[216:219], v[120:123], a[64:67], v[216:219]
    v_mfma_f32_16x16x32_bf16 v[216:219], v[124:127], a[72:75], v[216:219]
    v_mfma_f32_16x16x32_bf16 v[216:219], v[128:131], a[80:83], v[216:219]
    v_mfma_f32_16x16x32_bf16 v[216:219], v[132:135], a[88:91], v[216:219]
    s_waitcnt vmcnt(19)
    s_barrier
    v_mov_b32 v31, 3
    v_mfma_f32_16x16x32_bf16 v[220:223], v[120:123], a[68:71], v[220:223]
    buffer_load_dwordx4 a[168:171], v4, s[40:43], s63 offen offset:1024 sc1
    v_mfma_f32_16x16x32_bf16 v[220:223], v[124:127], a[76:79], v[220:223]
    buffer_store_dword v31, v30, s[32:35], s101 offen sc1
    v_mfma_f32_16x16x32_bf16 v[220:223], v[128:131], a[84:87], v[220:223]
    ds_read_b128 v[104:107], v6 offset:0
    ds_read_b128 v[108:111], v6 offset:8192
    v_mfma_f32_16x16x32_bf16 v[220:223], v[132:135], a[92:95], v[220:223]
    s_waitcnt lgkmcnt(2)
    ds_read_b128 v[112:115], v6 offset:16384
    v_mfma_f32_16x16x32_bf16 v[224:227], v[136:139], a[64:67], v[224:227]
    buffer_load_dwordx4 a[176:179], v4, s[40:43], s63 offen offset:2048 sc1
    v_mfma_f32_16x16x32_bf16 v[224:227], v[140:143], a[72:75], v[224:227]
    ds_read_b128 v[116:119], v6 offset:24576
    ds_read_b128 v[120:123], v6 offset:1024
    v_mfma_f32_16x16x32_bf16 v[224:227], v[144:147], a[80:83], v[224:227]
    ds_read_b128 v[124:127], v6 offset:9216
    v_mfma_f32_16x16x32_bf16 v[224:227], v[148:151], a[88:91], v[224:227]
    ds_read_b128 v[128:131], v6 offset:17408
    v_mfma_f32_16x16x32_bf16 v[228:231], v[136:139], a[68:71], v[228:231]
    buffer_load_dwordx4 a[184:187], v4, s[40:43], s63 offen offset:3072 sc1
    v_mfma_f32_16x16x32_bf16 v[228:231], v[140:143], a[76:79], v[228:231]
    s_xor_b32 s63, s63, 12288
    ds_read_b128 v[132:135], v6 offset:25600
    ds_read_b128 v[136:139], v6 offset:2048
    v_mfma_f32_16x16x32_bf16 v[228:231], v[144:147], a[84:87], v[228:231]
    ds_read_b128 v[140:143], v6 offset:10240
    v_mfma_f32_16x16x32_bf16 v[228:231], v[148:151], a[92:95], v[228:231]
    s_waitcnt lgkmcnt(4)
    ds_read_b128 v[144:147], v6 offset:18432
    v_mfma_f32_16x16x32_bf16 v[176:179], v[104:107], a[96:99], v[176:179]
    buffer_load_dwordx4 a[164:167], v5, s[40:43], s20 offen offset:0 sc1
    v_mfma_f32_16x16x32_bf16 v[176:179], v[108:111], a[104:107], v[176:179]
    ds_read_b128 v[148:151], v6 offset:26624
    v_mfma_f32_16x16x32_bf16 v[176:179], v[112:115], a[112:115], v[176:179]
    v_mfma_f32_16x16x32_bf16 v[176:179], v[116:119], a[120:123], v[176:179]
    v_mfma_f32_16x16x32_bf16 v[180:183], v[104:107], a[100:103], v[180:183]
    buffer_load_dwordx4 a[172:175], v5, s[40:43], s20 offen offset:1024 sc1
    v_mfma_f32_16x16x32_bf16 v[180:183], v[108:111], a[108:111], v[180:183]
    ds_read_b128 v[104:107], v6 offset:3072
    ds_read_b128 v[108:111], v6 offset:11264
    v_mfma_f32_16x16x32_bf16 v[180:183], v[112:115], a[116:119], v[180:183]
    ds_read_b128 v[112:115], v6 offset:19456
    v_mfma_f32_16x16x32_bf16 v[180:183], v[116:119], a[124:127], v[180:183]
    ds_read_b128 v[116:119], v6 offset:27648
    v_mfma_f32_16x16x32_bf16 v[184:187], v[120:123], a[96:99], v[184:187]
    buffer_load_dwordx4 a[180:183], v5, s[40:43], s20 offen offset:2048 sc1
    v_mfma_f32_16x16x32_bf16 v[184:187], v[124:127], a[104:107], v[184:187]
    s_waitcnt lgkmcnt(4)
    v_mfma_f32_16x16x32_bf16 v[184:187], v[128:131], a[112:115], v[184:187]
    v_mfma_f32_16x16x32_bf16 v[184:187], v[132:135], a[120:123], v[184:187]
    v_mfma_f32_16x16x32_bf16 v[188:191], v[120:123], a[100:103], v[188:191]
    buffer_load_dwordx4 a[188:191], v5, s[40:43], s20 offen offset:3072 sc1
    v_mfma_f32_16x16x32_bf16 v[188:191], v[124:127], a[108:111], v[188:191]
    s_xor_b32 s21, s3, 6
    ds_read_b128 v[120:123], v6 offset:4096
    ds_read_b128 v[124:127], v6 offset:12288
    v_mfma_f32_16x16x32_bf16 v[188:191], v[128:131], a[116:119], v[188:191]
    s_lshl2_add_u32 s21, s21, s4
    ds_read_b128 v[128:131], v6 offset:20480
    v_mfma_f32_16x16x32_bf16 v[188:191], v[132:135], a[124:127], v[188:191]
    s_mul_i32 s21, s21, 36864
    ds_read_b128 v[132:135], v6 offset:28672
    v_mfma_f32_16x16x32_bf16 v[192:195], v[136:139], a[96:99], v[192:195]
    s_add_u32 s21, s21, s28
    s_mov_b32 m0, s45
    v_mfma_f32_16x16x32_bf16 v[192:195], v[140:143], a[104:107], v[192:195]
    s_xor_b32 s20, s20, 12288
    buffer_load_dwordx4 v1, s[56:59], s21 offen sc1 lds
    v_mfma_f32_16x16x32_bf16 v[192:195], v[144:147], a[112:115], v[192:195]
    v_mfma_f32_16x16x32_bf16 v[192:195], v[148:151], a[120:123], v[192:195]
    v_mfma_f32_16x16x32_bf16 v[196:199], v[136:139], a[100:103], v[196:199]
    buffer_load_dwordx4 v1, s[56:59], s21 offen offset:1024 sc1 lds
    v_mfma_f32_16x16x32_bf16 v[196:199], v[140:143], a[108:111], v[196:199]
    ds_read_b128 v[136:139], v6 offset:5120
    ds_read_b128 v[140:143], v6 offset:13312
    v_mfma_f32_16x16x32_bf16 v[196:199], v[144:147], a[116:119], v[196:199]
    ds_read_b128 v[144:147], v6 offset:21504
    v_mfma_f32_16x16x32_bf16 v[196:199], v[148:151], a[124:127], v[196:199]
    s_waitcnt lgkmcnt(3)
    ds_read_b128 v[148:151], v6 offset:29696
    v_mfma_f32_16x16x32_bf16 v[200:203], v[104:107], a[96:99], v[200:203]
    v_mfma_f32_16x16x32_bf16 v[200:203], v[108:111], a[104:107], v[200:203]
    buffer_load_dwordx4 v1, s[56:59], s21 offen offset:2048 sc1 lds
    v_mfma_f32_16x16x32_bf16 v[200:203], v[112:115], a[112:115], v[200:203]
    v_mfma_f32_16x16x32_bf16 v[200:203], v[116:119], a[120:123], v[200:203]
    v_mfma_f32_16x16x32_bf16 v[204:207], v[104:107], a[100:103], v[204:207]
    ds_read_b128 v[104:107], v6 offset:6144
    v_mfma_f32_16x16x32_bf16 v[204:207], v[108:111], a[108:111], v[204:207]
    buffer_load_dwordx4 v1, s[56:59], s21 offen offset:3072 sc1 lds
    v_mfma_f32_16x16x32_bf16 v[204:207], v[112:115], a[116:119], v[204:207]
    s_add_u32 s21, s21, 4096
    ds_read_b128 v[108:111], v6 offset:14336
    ds_read_b128 v[112:115], v6 offset:22528
    v_mfma_f32_16x16x32_bf16 v[204:207], v[116:119], a[124:127], v[204:207]
    s_add_u32 m0, s45, 4096
    ds_read_b128 v[116:119], v6 offset:30720
    v_mfma_f32_16x16x32_bf16 v[208:211], v[120:123], a[96:99], v[208:211]
    v_mfma_f32_16x16x32_bf16 v[208:211], v[124:127], a[104:107], v[208:211]
    buffer_load_dwordx4 v1, s[56:59], s21 offen sc1 lds
    v_mfma_f32_16x16x32_bf16 v[208:211], v[128:131], a[112:115], v[208:211]
    v_mfma_f32_16x16x32_bf16 v[208:211], v[132:135], a[120:123], v[208:211]
    v_mfma_f32_16x16x32_bf16 v[212:215], v[120:123], a[100:103], v[212:215]
    v_mfma_f32_16x16x32_bf16 v[212:215], v[124:127], a[108:111], v[212:215]
    buffer_load_dwordx4 v1, s[56:59], s21 offen offset:1024 sc1 lds
    v_mfma_f32_16x16x32_bf16 v[212:215], v[128:131], a[116:119], v[212:215]
    v_mfma_f32_16x16x32_bf16 v[212:215], v[132:135], a[124:127], v[212:215]
    s_waitcnt lgkmcnt(0)
    v_mfma_f32_16x16x32_bf16 v[216:219], v[136:139], a[96:99], v[216:219]
    v_mfma_f32_16x16x32_bf16 v[216:219], v[140:143], a[104:107], v[216:219]
    buffer_load_dwordx4 v1, s[56:59], s21 offen offset:2048 sc1 lds
    v_mfma_f32_16x16x32_bf16 v[216:219], v[144:147], a[112:115], v[216:219]
    v_mfma_f32_16x16x32_bf16 v[216:219], v[148:151], a[120:123], v[216:219]
    s_waitcnt vmcnt(23)
    s_barrier
    ds_read_b128 v[120:123], v7 offset:0
    v_mfma_f32_16x16x32_bf16 v[220:223], v[136:139], a[100:103], v[220:223]
    ds_read_b128 v[124:127], v7 offset:8192
    ds_read_b128 v[128:131], v7 offset:16384
    v_mfma_f32_16x16x32_bf16 v[220:223], v[140:143], a[108:111], v[220:223]
    ds_read_b128 v[132:135], v7 offset:24576
    v_mfma_f32_16x16x32_bf16 v[220:223], v[144:147], a[116:119], v[220:223]
    buffer_load_dwordx4 a[192:195], v4, s[40:43], s63 offen offset:0 sc1
    v_mfma_f32_16x16x32_bf16 v[220:223], v[148:151], a[124:127], v[220:223]
    ds_read_b128 v[136:139], v7 offset:1024
    ds_read_b128 v[140:143], v7 offset:9216
    v_mfma_f32_16x16x32_bf16 v[224:227], v[104:107], a[96:99], v[224:227]
    ds_read_b128 v[144:147], v7 offset:17408
    v_mfma_f32_16x16x32_bf16 v[224:227], v[108:111], a[104:107], v[224:227]
    ds_read_b128 v[148:151], v7 offset:25600
    v_mfma_f32_16x16x32_bf16 v[224:227], v[112:115], a[112:115], v[224:227]
    buffer_load_dwordx4 a[200:203], v4, s[40:43], s63 offen offset:1024 sc1
    v_mfma_f32_16x16x32_bf16 v[224:227], v[116:119], a[120:123], v[224:227]
    v_mfma_f32_16x16x32_bf16 v[228:231], v[104:107], a[100:103], v[228:231]
    ds_read_b128 v[104:107], v7 offset:2048
    v_mfma_f32_16x16x32_bf16 v[228:231], v[108:111], a[108:111], v[228:231]
    ds_read_b128 v[108:111], v7 offset:10240
    v_mfma_f32_16x16x32_bf16 v[228:231], v[112:115], a[116:119], v[228:231]
    buffer_load_dwordx4 a[208:211], v4, s[40:43], s63 offen offset:2048 sc1
    v_mfma_f32_16x16x32_bf16 v[228:231], v[116:119], a[124:127], v[228:231]
    s_waitcnt lgkmcnt(2)
    ds_read_b128 v[112:115], v7 offset:18432
    ds_read_b128 v[116:119], v7 offset:26624
    v_mfma_f32_16x16x32_bf16 v[176:179], v[120:123], a[128:131], v[176:179]
    v_mfma_f32_16x16x32_bf16 v[176:179], v[124:127], a[136:139], v[176:179]
    v_mfma_f32_16x16x32_bf16 v[176:179], v[128:131], a[144:147], v[176:179]
    buffer_load_dwordx4 a[216:219], v4, s[40:43], s63 offen offset:3072 sc1
    v_mfma_f32_16x16x32_bf16 v[176:179], v[132:135], a[152:155], v[176:179]
    s_xor_b32 s63, s63, 4096
    v_mfma_f32_16x16x32_bf16 v[180:183], v[120:123], a[132:135], v[180:183]
    ds_read_b128 v[120:123], v7 offset:3072
    v_mfma_f32_16x16x32_bf16 v[180:183], v[124:127], a[140:143], v[180:183]
    ds_read_b128 v[124:127], v7 offset:11264
    v_mfma_f32_16x16x32_bf16 v[180:183], v[128:131], a[148:151], v[180:183]
    buffer_load_dwordx4 a[196:199], v5, s[40:43], s20 offen offset:0 sc1
    v_mfma_f32_16x16x32_bf16 v[180:183], v[132:135], a[156:159], v[180:183]
    ds_read_b128 v[128:131], v7 offset:19456
    ds_read_b128 v[132:135], v7 offset:27648
    v_mfma_f32_16x16x32_bf16 v[184:187], v[136:139], a[128:131], v[184:187]
    v_mfma_f32_16x16x32_bf16 v[184:187], v[140:143], a[136:139], v[184:187]
    v_mfma_f32_16x16x32_bf16 v[184:187], v[144:147], a[144:147], v[184:187]
    v_mfma_f32_16x16x32_bf16 v[184:187], v[148:151], a[152:155], v[184:187]
    buffer_load_dwordx4 a[204:207], v5, s[40:43], s20 offen offset:1024 sc1
    v_mfma_f32_16x16x32_bf16 v[188:191], v[136:139], a[132:135], v[188:191]
    ds_read_b128 v[136:139], v7 offset:4096
    v_mfma_f32_16x16x32_bf16 v[188:191], v[140:143], a[140:143], v[188:191]
    ds_read_b128 v[140:143], v7 offset:12288
    v_mfma_f32_16x16x32_bf16 v[188:191], v[144:147], a[148:151], v[188:191]
    ds_read_b128 v[144:147], v7 offset:20480
    v_mfma_f32_16x16x32_bf16 v[188:191], v[148:151], a[156:159], v[188:191]
    s_waitcnt lgkmcnt(3)
    buffer_load_dwordx4 a[212:215], v5, s[40:43], s20 offen offset:2048 sc1
    v_mfma_f32_16x16x32_bf16 v[192:195], v[104:107], a[128:131], v[192:195]
    ds_read_b128 v[148:151], v7 offset:28672
    v_mfma_f32_16x16x32_bf16 v[192:195], v[108:111], a[136:139], v[192:195]
    v_mfma_f32_16x16x32_bf16 v[192:195], v[112:115], a[144:147], v[192:195]
    v_mfma_f32_16x16x32_bf16 v[192:195], v[116:119], a[152:155], v[192:195]
    buffer_load_dwordx4 a[220:223], v5, s[40:43], s20 offen offset:3072 sc1
    v_mfma_f32_16x16x32_bf16 v[196:199], v[104:107], a[132:135], v[196:199]
    s_xor_b32 s21, s3, 7
    ds_read_b128 v[104:107], v7 offset:5120
    v_mfma_f32_16x16x32_bf16 v[196:199], v[108:111], a[140:143], v[196:199]
    s_lshl2_add_u32 s21, s21, s4
    ds_read_b128 v[108:111], v7 offset:13312
    v_mfma_f32_16x16x32_bf16 v[196:199], v[112:115], a[148:151], v[196:199]
    s_mul_i32 s21, s21, 36864
    ds_read_b128 v[112:115], v7 offset:21504
    v_mfma_f32_16x16x32_bf16 v[196:199], v[116:119], a[156:159], v[196:199]
    s_add_u32 s21, s21, s28
    s_mov_b32 m0, s46
    ds_read_b128 v[116:119], v7 offset:29696
    v_mfma_f32_16x16x32_bf16 v[200:203], v[120:123], a[128:131], v[200:203]
    s_xor_b32 s20, s20, 4096
    buffer_load_dwordx4 v1, s[56:59], s21 offen sc1 lds
    v_mfma_f32_16x16x32_bf16 v[200:203], v[124:127], a[136:139], v[200:203]
    v_mfma_f32_16x16x32_bf16 v[200:203], v[128:131], a[144:147], v[200:203]
    v_mfma_f32_16x16x32_bf16 v[200:203], v[132:135], a[152:155], v[200:203]
    buffer_load_dwordx4 v1, s[56:59], s21 offen offset:1024 sc1 lds
    v_mfma_f32_16x16x32_bf16 v[204:207], v[120:123], a[132:135], v[204:207]
    ds_read_b128 v[120:123], v7 offset:6144
    v_mfma_f32_16x16x32_bf16 v[204:207], v[124:127], a[140:143], v[204:207]
    ds_read_b128 v[124:127], v7 offset:14336
    v_mfma_f32_16x16x32_bf16 v[204:207], v[128:131], a[148:151], v[204:207]
    buffer_load_dword v3, v19, s[32:35], s66 offen sc1
    v_mfma_f32_16x16x32_bf16 v[204:207], v[132:135], a[156:159], v[204:207]
    s_waitcnt lgkmcnt(2)
    ds_read_b128 v[128:131], v7 offset:22528
    ds_read_b128 v[132:135], v7 offset:30720
    v_mfma_f32_16x16x32_bf16 v[208:211], v[136:139], a[128:131], v[208:211]
    buffer_load_dwordx4 v1, s[56:59], s21 offen offset:2048 sc1 lds
    v_mfma_f32_16x16x32_bf16 v[208:211], v[140:143], a[136:139], v[208:211]
    v_mfma_f32_16x16x32_bf16 v[208:211], v[144:147], a[144:147], v[208:211]
    v_mfma_f32_16x16x32_bf16 v[208:211], v[148:151], a[152:155], v[208:211]
    v_mfma_f32_16x16x32_bf16 v[212:215], v[136:139], a[132:135], v[212:215]
    buffer_load_dwordx4 v1, s[56:59], s21 offen offset:3072 sc1 lds
    v_mfma_f32_16x16x32_bf16 v[212:215], v[140:143], a[140:143], v[212:215]
    s_add_u32 s21, s21, 4096
    v_mfma_f32_16x16x32_bf16 v[212:215], v[144:147], a[148:151], v[212:215]
    s_add_u32 m0, s46, 4096
    v_mfma_f32_16x16x32_bf16 v[212:215], v[148:151], a[156:159], v[212:215]
    v_mfma_f32_16x16x32_bf16 v[216:219], v[104:107], a[128:131], v[216:219]
    buffer_load_dwordx4 v1, s[56:59], s21 offen sc1 lds
    v_mfma_f32_16x16x32_bf16 v[216:219], v[108:111], a[136:139], v[216:219]
    v_mfma_f32_16x16x32_bf16 v[216:219], v[112:115], a[144:147], v[216:219]
    v_mfma_f32_16x16x32_bf16 v[216:219], v[116:119], a[152:155], v[216:219]
    s_waitcnt vmcnt(21)
    s_barrier
    ds_read_b128 v[136:139], v11 offset:0
    v_mfma_f32_16x16x32_bf16 v[220:223], v[104:107], a[132:135], v[220:223]
    buffer_load_dwordx4 v1, s[56:59], s21 offen offset:1024 sc1 lds
    v_mfma_f32_16x16x32_bf16 v[220:223], v[108:111], a[140:143], v[220:223]
    ds_read_b128 v[140:143], v11 offset:8192
    ds_read_b128 v[144:147], v11 offset:16384
    v_mfma_f32_16x16x32_bf16 v[220:223], v[112:115], a[148:151], v[220:223]
    ds_read_b128 v[148:151], v11 offset:24576
    v_mfma_f32_16x16x32_bf16 v[220:223], v[116:119], a[156:159], v[220:223]
    s_waitcnt lgkmcnt(4)
    ds_read_b128 v[104:107], v11 offset:1024
    v_mfma_f32_16x16x32_bf16 v[224:227], v[120:123], a[128:131], v[224:227]
    buffer_load_dwordx4 v1, s[56:59], s21 offen offset:2048 sc1 lds
    v_mfma_f32_16x16x32_bf16 v[224:227], v[124:127], a[136:139], v[224:227]
    ds_read_b128 v[108:111], v11 offset:9216
    ds_read_b128 v[112:115], v11 offset:17408
    v_mfma_f32_16x16x32_bf16 v[224:227], v[128:131], a[144:147], v[224:227]
    ds_read_b128 v[116:119], v11 offset:25600
    v_mfma_f32_16x16x32_bf16 v[224:227], v[132:135], a[152:155], v[224:227]
    v_mfma_f32_16x16x32_bf16 v[228:231], v[120:123], a[132:135], v[228:231]
    ds_read_b128 v[120:123], v11 offset:2048
    v_mfma_f32_16x16x32_bf16 v[228:231], v[124:127], a[140:143], v[228:231]
    buffer_load_dwordx4 a[224:227], v4, s[40:43], s63 offen offset:0 sc1
    v_mfma_f32_16x16x32_bf16 v[228:231], v[128:131], a[148:151], v[228:231]
    ds_read_b128 v[124:127], v11 offset:10240
    ds_read_b128 v[128:131], v11 offset:18432
    v_mfma_f32_16x16x32_bf16 v[228:231], v[132:135], a[156:159], v[228:231]
    s_waitcnt lgkmcnt(3)
    ds_read_b128 v[132:135], v11 offset:26624
    v_mfma_f32_16x16x32_bf16 v[176:179], v[136:139], a[160:163], v[176:179]
    v_mfma_f32_16x16x32_bf16 v[176:179], v[140:143], a[168:171], v[176:179]
    buffer_load_dwordx4 a[232:235], v4, s[40:43], s63 offen offset:1024 sc1
    v_mfma_f32_16x16x32_bf16 v[176:179], v[144:147], a[176:179], v[176:179]
    v_mfma_f32_16x16x32_bf16 v[176:179], v[148:151], a[184:187], v[176:179]
    v_mfma_f32_16x16x32_bf16 v[180:183], v[136:139], a[164:167], v[180:183]
    ds_read_b128 v[136:139], v11 offset:3072
    v_mfma_f32_16x16x32_bf16 v[180:183], v[140:143], a[172:175], v[180:183]
    buffer_load_dwordx4 a[240:243], v4, s[40:43], s63 offen offset:2048 sc1
    v_mfma_f32_16x16x32_bf16 v[180:183], v[144:147], a[180:183], v[180:183]
    ds_read_b128 v[140:143], v11 offset:11264
    ds_read_b128 v[144:147], v11 offset:19456
    v_mfma_f32_16x16x32_bf16 v[180:183], v[148:151], a[188:191], v[180:183]
    ds_read_b128 v[148:151], v11 offset:27648
    v_mfma_f32_16x16x32_bf16 v[184:187], v[104:107], a[160:163], v[184:187]
    v_mfma_f32_16x16x32_bf16 v[184:187], v[108:111], a[168:171], v[184:187]
    buffer_load_dwordx4 a[248:251], v4, s[40:43], s63 offen offset:3072 sc1
    v_mfma_f32_16x16x32_bf16 v[184:187], v[112:115], a[176:179], v[184:187]
    s_sub_u32 s63, s63, 4096
    v_mfma_f32_16x16x32_bf16 v[184:187], v[116:119], a[184:187], v[184:187]
    v_mfma_f32_16x16x32_bf16 v[188:191], v[104:107], a[164:167], v[188:191]
    ds_read_b128 v[104:107], v11 offset:4096
    v_mfma_f32_16x16x32_bf16 v[188:191], v[108:111], a[172:175], v[188:191]
    buffer_load_dwordx4 a[228:231], v5, s[40:43], s20 offen offset:0 sc1
    v_mfma_f32_16x16x32_bf16 v[188:191], v[112:115], a[180:183], v[188:191]
    ds_read_b128 v[108:111], v11 offset:12288
    ds_read_b128 v[112:115], v11 offset:20480
    v_mfma_f32_16x16x32_bf16 v[188:191], v[116:119], a[188:191], v[188:191]
    s_waitcnt lgkmcnt(3)
    ds_read_b128 v[116:119], v11 offset:28672
    v_mfma_f32_16x16x32_bf16 v[192:195], v[120:123], a[160:163], v[192:195]
    v_mfma_f32_16x16x32_bf16 v[192:195], v[124:127], a[168:171], v[192:195]
    v_mfma_f32_16x16x32_bf16 v[192:195], v[128:131], a[176:179], v[192:195]
    buffer_load_dwordx4 a[236:239], v5, s[40:43], s20 offen offset:1024 sc1
    v_mfma_f32_16x16x32_bf16 v[192:195], v[132:135], a[184:187], v[192:195]
    v_mfma_f32_16x16x32_bf16 v[196:199], v[120:123], a[164:167], v[196:199]
    ds_read_b128 v[120:123], v11 offset:5120
    v_mfma_f32_16x16x32_bf16 v[196:199], v[124:127], a[172:175], v[196:199]
    ds_read_b128 v[124:127], v11 offset:13312
    v_mfma_f32_16x16x32_bf16 v[196:199], v[128:131], a[180:183], v[196:199]
    buffer_load_dwordx4 a[244:247], v5, s[40:43], s20 offen offset:2048 sc1
    v_mfma_f32_16x16x32_bf16 v[196:199], v[132:135], a[188:191], v[196:199]
    ds_read_b128 v[128:131], v11 offset:21504
    ds_read_b128 v[132:135], v11 offset:29696
    v_mfma_f32_16x16x32_bf16 v[200:203], v[136:139], a[160:163], v[200:203]
    v_mfma_f32_16x16x32_bf16 v[200:203], v[140:143], a[168:171], v[200:203]
    v_mfma_f32_16x16x32_bf16 v[200:203], v[144:147], a[176:179], v[200:203]
    buffer_load_dwordx4 a[252:255], v5, s[40:43], s20 offen offset:3072 sc1
    v_mfma_f32_16x16x32_bf16 v[200:203], v[148:151], a[184:187], v[200:203]
    s_mul_i32 s21, s61, 6
    s_add_u32 s21, s21, 132
    v_mfma_f32_16x16x32_bf16 v[204:207], v[136:139], a[164:167], v[204:207]
    s_mul_i32 s21, s21, 36864
    ds_read_b128 v[136:139], v11 offset:6144
    v_mfma_f32_16x16x32_bf16 v[204:207], v[140:143], a[172:175], v[204:207]
    s_add_u32 s21, s21, s28
    ds_read_b128 v[140:143], v11 offset:14336
    v_mfma_f32_16x16x32_bf16 v[204:207], v[144:147], a[180:183], v[204:207]
    s_add_u32 s21, s21, s67
    s_mov_b32 m0, s47
    ds_read_b128 v[144:147], v11 offset:22528
    v_mfma_f32_16x16x32_bf16 v[204:207], v[148:151], a[188:191], v[204:207]
    s_sub_u32 s20, s20, 4096
    buffer_load_dwordx4 v1, s[56:59], s21 offen sc1 lds
    s_waitcnt lgkmcnt(3)
    v_mfma_f32_16x16x32_bf16 v[208:211], v[104:107], a[160:163], v[208:211]
    ds_read_b128 v[148:151], v11 offset:30720
    v_mfma_f32_16x16x32_bf16 v[208:211], v[108:111], a[168:171], v[208:211]
    v_mfma_f32_16x16x32_bf16 v[208:211], v[112:115], a[176:179], v[208:211]
    buffer_load_dwordx4 v1, s[56:59], s21 offen offset:1024 sc1 lds
    v_mfma_f32_16x16x32_bf16 v[208:211], v[116:119], a[184:187], v[208:211]
    v_mfma_f32_16x16x32_bf16 v[212:215], v[104:107], a[164:167], v[212:215]
    v_mfma_f32_16x16x32_bf16 v[212:215], v[108:111], a[172:175], v[212:215]
    v_mfma_f32_16x16x32_bf16 v[212:215], v[112:115], a[180:183], v[212:215]
    v_mfma_f32_16x16x32_bf16 v[212:215], v[116:119], a[188:191], v[212:215]
    v_mfma_f32_16x16x32_bf16 v[216:219], v[120:123], a[160:163], v[216:219]
    v_mfma_f32_16x16x32_bf16 v[216:219], v[124:127], a[168:171], v[216:219]
    s_mul_i32 s63, s61, 6144
    v_mfma_f32_16x16x32_bf16 v[216:219], v[128:131], a[176:179], v[216:219]
    s_add_u32 s63, s63, 135168
    v_mfma_f32_16x16x32_bf16 v[216:219], v[132:135], a[184:187], v[216:219]
    s_waitcnt vmcnt(15)
    v_cmp_gt_u32 vcc, 3, v3
    s_nop 1
    s_and_b64 vcc, vcc, exec
    s_cbranch_scc1 SPIN_OA
BACK_OA:
    s_barrier
    v_mfma_f32_16x16x32_bf16 v[220:223], v[120:123], a[164:167], v[220:223]
    buffer_load_dwordx4 v[64:67], v4, s[40:43], s63 offen offset:0 sc1
    v_mfma_f32_16x16x32_bf16 v[220:223], v[124:127], a[172:175], v[220:223]
    ds_read_b128 v[104:107], v12 offset:0
    ds_read_b128 v[108:111], v12 offset:8192
    v_mfma_f32_16x16x32_bf16 v[220:223], v[128:131], a[180:183], v[220:223]
    ds_read_b128 v[112:115], v12 offset:16384
    v_mfma_f32_16x16x32_bf16 v[220:223], v[132:135], a[188:191], v[220:223]
    s_waitcnt lgkmcnt(3)
    ds_read_b128 v[116:119], v12 offset:24576
    v_mfma_f32_16x16x32_bf16 v[224:227], v[136:139], a[160:163], v[224:227]
    buffer_load_dwordx4 v[68:71], v4, s[40:43], s63 offen offset:1024 sc1
    v_mfma_f32_16x16x32_bf16 v[224:227], v[140:143], a[168:171], v[224:227]
    s_mul_i32 s20, s61, 6144
    ds_read_b128 v[120:123], v12 offset:1024
    ds_read_b128 v[124:127], v12 offset:9216
    v_mfma_f32_16x16x32_bf16 v[224:227], v[144:147], a[176:179], v[224:227]
    s_add_u32 s20, s20, 135168
    ds_read_b128 v[128:131], v12 offset:17408
    v_mfma_f32_16x16x32_bf16 v[224:227], v[148:151], a[184:187], v[224:227]
    s_sub_u32 s63, s63, 4096
    ds_read_b128 v[132:135], v12 offset:25600
    v_mfma_f32_16x16x32_bf16 v[228:231], v[136:139], a[164:167], v[228:231]
    buffer_load_dwordx4 v[72:75], v5, s[40:43], s20 offen offset:0 sc1
    v_mfma_f32_16x16x32_bf16 v[228:231], v[140:143], a[172:175], v[228:231]
    ds_read_b128 v[136:139], v12 offset:2048
    ds_read_b128 v[140:143], v12 offset:10240
    v_mfma_f32_16x16x32_bf16 v[228:231], v[144:147], a[180:183], v[228:231]
    ds_read_b128 v[144:147], v12 offset:18432
    v_mfma_f32_16x16x32_bf16 v[228:231], v[148:151], a[188:191], v[228:231]
    s_waitcnt lgkmcnt(4)
    ds_read_b128 v[148:151], v12 offset:26624
    v_mfma_f32_16x16x32_bf16 v[176:179], v[104:107], a[192:195], v[176:179]
    buffer_load_dwordx4 v[76:79], v5, s[40:43], s20 offen offset:1024 sc1
    v_mfma_f32_16x16x32_bf16 v[176:179], v[108:111], a[200:203], v[176:179]
    s_mul_i32 s21, s61, 6
    s_add_u32 s21, s4, s21
    v_mfma_f32_16x16x32_bf16 v[176:179], v[112:115], a[208:211], v[176:179]
    s_add_u32 s21, s21, 128
    v_mfma_f32_16x16x32_bf16 v[176:179], v[116:119], a[216:219], v[176:179]
    s_mul_i32 s21, s21, 36864
    v_mfma_f32_16x16x32_bf16 v[180:183], v[104:107], a[196:199], v[180:183]
    s_add_u32 s21, s21, s28
    s_mov_b32 m0, s79
    ds_read_b128 v[104:107], v12 offset:3072
    v_mfma_f32_16x16x32_bf16 v[180:183], v[108:111], a[204:207], v[180:183]
    s_sub_u32 s20, s20, 4096
    buffer_load_dwordx4 v1, s[56:59], s21 offen sc1 lds
    v_mfma_f32_16x16x32_bf16 v[180:183], v[112:115], a[212:215], v[180:183]
    ds_read_b128 v[108:111], v12 offset:11264
    ds_read_b128 v[112:115], v12 offset:19456
    v_mfma_f32_16x16x32_bf16 v[180:183], v[116:119], a[220:223], v[180:183]
    ds_read_b128 v[116:119], v12 offset:27648
    v_mfma_f32_16x16x32_bf16 v[184:187], v[120:123], a[192:195], v[184:187]
    buffer_load_dwordx4 v1, s[56:59], s21 offen offset:1024 sc1 lds
    v_mfma_f32_16x16x32_bf16 v[184:187], v[124:127], a[200:203], v[184:187]
    v_mfma_f32_16x16x32_bf16 v[184:187], v[128:131], a[208:211], v[184:187]
    s_waitcnt lgkmcnt(3)
    v_mfma_f32_16x16x32_bf16 v[184:187], v[132:135], a[216:219], v[184:187]
    v_mfma_f32_16x16x32_bf16 v[188:191], v[120:123], a[196:199], v[188:191]
    ds_read_b128 v[120:123], v12 offset:4096
    v_mfma_f32_16x16x32_bf16 v[188:191], v[124:127], a[204:207], v[188:191]
    buffer_load_dwordx4 v1, s[56:59], s21 offen offset:2048 sc1 lds
    v_mfma_f32_16x16x32_bf16 v[188:191], v[128:131], a[212:215], v[188:191]
    ds_read_b128 v[124:127], v12 offset:12288
    ds_read_b128 v[128:131], v12 offset:20480
    v_mfma_f32_16x16x32_bf16 v[188:191], v[132:135], a[220:223], v[188:191]
    ds_read_b128 v[132:135], v12 offset:28672
    v_mfma_f32_16x16x32_bf16 v[192:195], v[136:139], a[192:195], v[192:195]
    v_mfma_f32_16x16x32_bf16 v[192:195], v[140:143], a[200:203], v[192:195]
    buffer_load_dwordx4 v1, s[56:59], s21 offen offset:3072 sc1 lds
    v_mfma_f32_16x16x32_bf16 v[192:195], v[144:147], a[208:211], v[192:195]
    s_add_u32 s21, s21, 4096
    v_mfma_f32_16x16x32_bf16 v[192:195], v[148:151], a[216:219], v[192:195]
    s_add_u32 m0, s79, 4096
    v_mfma_f32_16x16x32_bf16 v[196:199], v[136:139], a[196:199], v[196:199]
    ds_read_b128 v[136:139], v12 offset:5120
    v_mfma_f32_16x16x32_bf16 v[196:199], v[140:143], a[204:207], v[196:199]
    buffer_load_dwordx4 v1, s[56:59], s21 offen sc1 lds
    v_mfma_f32_16x16x32_bf16 v[196:199], v[144:147], a[212:215], v[196:199]
    ds_read_b128 v[140:143], v12 offset:13312
    ds_read_b128 v[144:147], v12 offset:21504
    v_mfma_f32_16x16x32_bf16 v[196:199], v[148:151], a[220:223], v[196:199]
    ds_read_b128 v[148:151], v12 offset:29696
    v_mfma_f32_16x16x32_bf16 v[200:203], v[104:107], a[192:195], v[200:203]
    s_waitcnt lgkmcnt(4)
    v_mfma_f32_16x16x32_bf16 v[200:203], v[108:111], a[200:203], v[200:203]
    buffer_load_dwordx4 v1, s[56:59], s21 offen offset:1024 sc1 lds
    v_mfma_f32_16x16x32_bf16 v[200:203], v[112:115], a[208:211], v[200:203]
    v_mfma_f32_16x16x32_bf16 v[200:203], v[116:119], a[216:219], v[200:203]
    v_mfma_f32_16x16x32_bf16 v[204:207], v[104:107], a[196:199], v[204:207]
    ds_read_b128 v[104:107], v12 offset:6144
    v_mfma_f32_16x16x32_bf16 v[204:207], v[108:111], a[204:207], v[204:207]
    buffer_load_dwordx4 v1, s[56:59], s21 offen offset:2048 sc1 lds
    v_mfma_f32_16x16x32_bf16 v[204:207], v[112:115], a[212:215], v[204:207]
    ds_read_b128 v[108:111], v12 offset:14336
    ds_read_b128 v[112:115], v12 offset:22528
    v_mfma_f32_16x16x32_bf16 v[204:207], v[116:119], a[220:223], v[204:207]
    ds_read_b128 v[116:119], v12 offset:30720
    v_mfma_f32_16x16x32_bf16 v[208:211], v[120:123], a[192:195], v[208:211]
    v_mfma_f32_16x16x32_bf16 v[208:211], v[124:127], a[200:203], v[208:211]
    v_mfma_f32_16x16x32_bf16 v[208:211], v[128:131], a[208:211], v[208:211]
    buffer_load_dwordx4 v[32:35], v4, s[40:43], s63 offen offset:0 sc1
    v_mfma_f32_16x16x32_bf16 v[208:211], v[132:135], a[216:219], v[208:211]
    v_mfma_f32_16x16x32_bf16 v[212:215], v[120:123], a[196:199], v[212:215]
    v_mfma_f32_16x16x32_bf16 v[212:215], v[124:127], a[204:207], v[212:215]
    v_mfma_f32_16x16x32_bf16 v[212:215], v[128:131], a[212:215], v[212:215]
    buffer_load_dwordx4 v[40:43], v4, s[40:43], s63 offen offset:1024 sc1
    v_mfma_f32_16x16x32_bf16 v[212:215], v[132:135], a[220:223], v[212:215]
    s_waitcnt lgkmcnt(0)
    v_mfma_f32_16x16x32_bf16 v[216:219], v[136:139], a[192:195], v[216:219]
    v_mfma_f32_16x16x32_bf16 v[216:219], v[140:143], a[200:203], v[216:219]
    v_mfma_f32_16x16x32_bf16 v[216:219], v[144:147], a[208:211], v[216:219]
    s_add_u32 s23, s5, 8
    buffer_load_dwordx4 v[48:51], v4, s[40:43], s63 offen offset:2048 sc1
    v_mfma_f32_16x16x32_bf16 v[216:219], v[148:151], a[216:219], v[216:219]
    s_waitcnt vmcnt(16)
    s_barrier
    ds_read_b128 v[120:123], v13 offset:0
    v_mfma_f32_16x16x32_bf16 v[220:223], v[136:139], a[196:199], v[220:223]
    s_and_b32 s65, s5, 3
    ds_read_b128 v[124:127], v13 offset:8192
    ds_read_b128 v[128:131], v13 offset:16384
    v_mfma_f32_16x16x32_bf16 v[220:223], v[140:143], a[204:207], v[220:223]
    s_mul_i32 s70, s4, 3072
    ds_read_b128 v[132:135], v13 offset:24576
    v_lshrrev_b32 v19, 4, v1
    v_mfma_f32_16x16x32_bf16 v[220:223], v[144:147], a[212:215], v[220:223]
    s_andn2_b32 s66, s74, 0xfff
    buffer_load_dwordx4 v[56:59], v4, s[40:43], s63 offen offset:3072 sc1
    v_mfma_f32_16x16x32_bf16 v[220:223], v[148:151], a[220:223], v[220:223]
    s_sub_u32 s63, s63, 4096
    ds_read_b128 v[136:139], v13 offset:1024
    ds_read_b128 v[140:143], v13 offset:9216
    v_mfma_f32_16x16x32_bf16 v[224:227], v[104:107], a[192:195], v[224:227]
    ds_read_b128 v[144:147], v13 offset:17408
    v_min_u32 v19, 2, v19
    v_mfma_f32_16x16x32_bf16 v[224:227], v[108:111], a[200:203], v[224:227]
    ds_read_b128 v[148:151], v13 offset:25600
    v_lshl_add_u32 v19, v19, 3, s23
    v_mfma_f32_16x16x32_bf16 v[224:227], v[112:115], a[208:211], v[224:227]
    s_lshl3_add_u32 s23, s6, s62
    buffer_load_dwordx4 v[36:39], v5, s[40:43], s20 offen offset:0 sc1
    v_mfma_f32_16x16x32_bf16 v[224:227], v[116:119], a[216:219], v[224:227]
    s_lshl_b32 s23, s23, 4
    v_bfe_u32 v20, v1, 4, 4
    v_add_u32 v20, s23, v20
    v_mfma_f32_16x16x32_bf16 v[228:231], v[104:107], a[196:199], v[228:231]
    s_mul_i32 s23, s6, 294912
    ds_read_b128 v[104:107], v13 offset:2048
    v_mul_u32_u24 v20, 1152, v20
    v_mfma_f32_16x16x32_bf16 v[228:231], v[108:111], a[204:207], v[228:231]
    s_sub_u32 s23, 2211840, s23
    ds_read_b128 v[108:111], v13 offset:10240
    v_lshrrev_b32 v21, 8, v1
    v_mfma_f32_16x16x32_bf16 v[228:231], v[112:115], a[212:215], v[228:231]
    ds_read_b128 v[112:115], v13 offset:18432
    v_lshl_add_u32 v20, v21, 3, v20
    v_mfma_f32_16x16x32_bf16 v[228:231], v[116:119], a[220:223], v[228:231]
    s_waitcnt lgkmcnt(3)
    buffer_load_dwordx4 v[44:47], v5, s[40:43], s20 offen offset:1024 sc1
    v_mfma_f32_16x16x32_bf16 v[176:179], v[120:123], a[224:227], v[176:179]
    ds_read_b128 v[116:119], v13 offset:26624
    v_add_u32 v21, s23, v20
    v_mfma_f32_16x16x32_bf16 v[176:179], v[124:127], a[232:235], v[176:179]
    s_mul_i32 s23, s101, 288
    v_and_b32 v19, 31, v19
    v_mov_b32 v31, 3
    v_mfma_f32_16x16x32_bf16 v[176:179], v[128:131], a[240:243], v[176:179]
    s_add_u32 s23, s23, s70
    v_lshlrev_b32 v23, 20, v1
    v_lshlrev_b32 v19, 7, v19
    v_mfma_f32_16x16x32_bf16 v[176:179], v[132:135], a[248:251], v[176:179]
    s_add_u32 s98, s23, 0
    buffer_load_dwordx4 v[52:55], v5, s[40:43], s20 offen offset:2048 sc1
    v_mfma_f32_16x16x32_bf16 v[180:183], v[120:123], a[228:231], v[180:183]
    ds_read_b128 v[120:123], v13 offset:3072
    v_bfe_u32 v92, v1, 6, 2
    v_mfma_f32_16x16x32_bf16 v[180:183], v[124:127], a[236:239], v[180:183]
    ds_read_b128 v[124:127], v13 offset:11264
    v_lshrrev_b32 v93, 8, v1
    v_mfma_f32_16x16x32_bf16 v[180:183], v[128:131], a[244:247], v[180:183]
    ds_read_b128 v[128:131], v13 offset:19456
    v_cmp_eq_u32 vcc, v92, v93
    v_mfma_f32_16x16x32_bf16 v[180:183], v[132:135], a[252:255], v[180:183]
    buffer_load_dwordx4 v[60:63], v5, s[40:43], s20 offen offset:3072 sc1
    v_mfma_f32_16x16x32_bf16 v[184:187], v[136:139], a[224:227], v[184:187]
    s_add_u32 s21, s4, 0
    s_xor_b32 s21, s21, s3
    s_lshl_b32 s21, s21, 2
    v_mfma_f32_16x16x32_bf16 v[184:187], v[140:143], a[232:235], v[184:187]
    s_mul_i32 s21, s21, 36864
    ds_read_b128 v[132:135], v13 offset:27648
    v_and_b32 v92, 16, v1
    v_mfma_f32_16x16x32_bf16 v[184:187], v[144:147], a[240:243], v[184:187]
    s_add_u32 s21, s21, s28
    v_mov_b32 v93, 0x3f80
    v_lshlrev_b32 v92, v92, v93
    v_mfma_f32_16x16x32_bf16 v[184:187], v[148:151], a[248:251], v[184:187]
    s_add_u32 s21, s21, 7168
    s_add_u32 m0, s44, 0
    v_and_b32 v93, 32, v1
    v_mfma_f32_16x16x32_bf16 v[188:191], v[136:139], a[228:231], v[188:191]
    s_sub_u32 s20, s20, 4096
    buffer_load_dwordx4 v1, s[56:59], s21 offen sc1 lds
    v_mfma_f32_16x16x32_bf16 v[188:191], v[140:143], a[236:239], v[188:191]
    ds_read_b128 v[136:139], v13 offset:4096
    ds_read_b128 v[140:143], v13 offset:12288
    v_mfma_f32_16x16x32_bf16 v[188:191], v[144:147], a[244:247], v[188:191]
    ds_read_b128 v[144:147], v13 offset:20480
    v_cndmask_b32 v92, 0, v92, vcc
    v_mfma_f32_16x16x32_bf16 v[188:191], v[148:151], a[252:255], v[188:191]
    s_waitcnt lgkmcnt(3)
    buffer_load_dwordx4 v1, s[56:59], s21 offen offset:1024 sc1 lds
    v_mfma_f32_16x16x32_bf16 v[192:195], v[104:107], a[224:227], v[192:195]
    ds_read_b128 v[148:151], v13 offset:28672
    v_cmp_eq_u32 vcc, 0, v93
    v_mfma_f32_16x16x32_bf16 v[192:195], v[108:111], a[232:235], v[192:195]
    s_add_u32 s21, s21, 36864
    v_cndmask_b32 v96, 0, v92, vcc
    v_cndmask_b32_e64 v97, v92, 0, vcc
    v_mfma_f32_16x16x32_bf16 v[192:195], v[112:115], a[240:243], v[192:195]
    s_add_u32 m0, s44, 2048
    v_mov_b32 v98, 0
    v_mov_b32 v99, 0
    v_mfma_f32_16x16x32_bf16 v[192:195], v[116:119], a[248:251], v[192:195]
    v_mov_b32 v100, v96
    v_mov_b32 v101, v97
    v_mfma_f32_16x16x32_bf16 v[196:199], v[104:107], a[228:231], v[196:199]
    buffer_load_dwordx4 v1, s[56:59], s21 offen sc1 lds
    v_mfma_f32_16x16x32_bf16 v[196:199], v[108:111], a[236:239], v[196:199]
    ds_read_b128 v[104:107], v13 offset:5120
    ds_read_b128 v[108:111], v13 offset:13312
    v_mfma_f32_16x16x32_bf16 v[196:199], v[112:115], a[244:247], v[196:199]
    ds_read_b128 v[112:115], v13 offset:21504
    v_mfma_f32_16x16x32_bf16 v[196:199], v[116:119], a[252:255], v[196:199]
    ds_read_b128 v[116:119], v13 offset:29696
    v_mfma_f32_16x16x32_bf16 v[200:203], v[120:123], a[224:227], v[200:203]
    buffer_load_dwordx4 v1, s[56:59], s21 offen offset:1024 sc1 lds
    v_mfma_f32_16x16x32_bf16 v[200:203], v[124:127], a[232:235], v[200:203]
    s_add_u32 s21, s21, 36864
    v_mfma_f32_16x16x32_bf16 v[200:203], v[128:131], a[240:243], v[200:203]
    s_add_u32 m0, s44, 4096
    v_mfma_f32_16x16x32_bf16 v[200:203], v[132:135], a[248:251], v[200:203]
    v_mfma_f32_16x16x32_bf16 v[204:207], v[120:123], a[228:231], v[204:207]
    buffer_load_dwordx4 v1, s[56:59], s21 offen sc1 lds
    v_mfma_f32_16x16x32_bf16 v[204:207], v[124:127], a[236:239], v[204:207]
    ds_read_b128 v[120:123], v13 offset:6144
    ds_read_b128 v[124:127], v13 offset:14336
    v_mfma_f32_16x16x32_bf16 v[204:207], v[128:131], a[244:247], v[204:207]
    ds_read_b128 v[128:131], v13 offset:22528
    v_mfma_f32_16x16x32_bf16 v[204:207], v[132:135], a[252:255], v[204:207]
    s_waitcnt lgkmcnt(3)
    ds_read_b128 v[132:135], v13 offset:30720
    v_mfma_f32_16x16x32_bf16 v[208:211], v[136:139], a[224:227], v[208:211]
    buffer_load_dwordx4 v1, s[56:59], s21 offen offset:1024 sc1 lds
    v_mfma_f32_16x16x32_bf16 v[208:211], v[140:143], a[232:235], v[208:211]
    s_add_u32 s21, s21, 36864
    v_mfma_f32_16x16x32_bf16 v[208:211], v[144:147], a[240:243], v[208:211]
    s_add_u32 m0, s44, 6144
    v_mfma_f32_16x16x32_bf16 v[208:211], v[148:151], a[248:251], v[208:211]
    v_mfma_f32_16x16x32_bf16 v[212:215], v[136:139], a[228:231], v[212:215]
    buffer_load_dwordx4 v1, s[56:59], s21 offen sc1 lds
    v_mfma_f32_16x16x32_bf16 v[212:215], v[140:143], a[236:239], v[212:215]
    v_mfma_f32_16x16x32_bf16 v[212:215], v[144:147], a[244:247], v[212:215]
    v_mfma_f32_16x16x32_bf16 v[212:215], v[148:151], a[252:255], v[212:215]
    v_mfma_f32_16x16x32_bf16 v[216:219], v[104:107], a[224:227], v[216:219]
    v_mfma_f32_16x16x32_bf16 v[216:219], v[108:111], a[232:235], v[216:219]
    buffer_load_dwordx4 v1, s[56:59], s21 offen offset:1024 sc1 lds
    v_mfma_f32_16x16x32_bf16 v[216:219], v[112:115], a[240:243], v[216:219]
    s_add_u32 s21, s21, 36864
    s_add_u32 s21, s4, 4
    s_xor_b32 s21, s21, s3
    v_mfma_f32_16x16x32_bf16 v[216:219], v[116:119], a[248:251], v[216:219]
    s_lshl_b32 s21, s21, 2
    s_waitcnt vmcnt(16)
    s_barrier
    v_mfma_f32_16x16x32_bf16 v[220:223], v[104:107], a[228:231], v[220:223]
    s_mul_i32 s21, s21, 36864
    s_add_u32 s21, s21, s28
    ds_read_b128 v[136:139], v6 offset:0
    v_mfma_f32_16x16x32_bf16 v[220:223], v[108:111], a[236:239], v[220:223]
    s_add_u32 s21, s21, 7168
    s_add_u32 m0, s45, 0
    ds_read_b128 v[140:143], v6 offset:1024
    v_mfma_f32_16x16x32_bf16 v[220:223], v[112:115], a[244:247], v[220:223]
    buffer_load_dwordx4 v1, s[56:59], s21 offen sc1 lds
    v_mfma_f32_16x16x32_bf16 v[220:223], v[116:119], a[252:255], v[220:223]
    s_waitcnt lgkmcnt(2)
    ds_read_b128 v[144:147], v6 offset:8192
    ds_read_b128 v[148:151], v6 offset:9216
    v_mfma_f32_16x16x32_bf16 v[224:227], v[120:123], a[224:227], v[224:227]
    ds_read_b128 v[104:107], v6 offset:16384
    v_mfma_f32_16x16x32_bf16 v[224:227], v[124:127], a[232:235], v[224:227]
    buffer_load_dwordx4 v1, s[56:59], s21 offen offset:1024 sc1 lds
    v_mfma_f32_16x16x32_bf16 v[224:227], v[128:131], a[240:243], v[224:227]
    s_add_u32 s21, s21, 36864
    ds_read_b128 v[108:111], v6 offset:17408
    ds_read_b128 v[112:115], v6 offset:24576
    v_mfma_f32_16x16x32_bf16 v[224:227], v[132:135], a[248:251], v[224:227]
    s_add_u32 m0, s45, 2048
    ds_read_b128 v[116:119], v7 offset:0
    v_mfma_f32_16x16x32_bf16 v[228:231], v[120:123], a[228:231], v[228:231]
    ds_read_b128 v[120:123], v7 offset:8192
    v_mfma_f32_16x16x32_bf16 v[228:231], v[124:127], a[236:239], v[228:231]
    buffer_load_dwordx4 v1, s[56:59], s21 offen sc1 lds
    v_mfma_f32_16x16x32_bf16 v[228:231], v[128:131], a[244:247], v[228:231]
    ds_read_b128 v[124:127], v7 offset:16384
    ds_read_b128 v[128:131], v7 offset:24576
    v_mfma_f32_16x16x32_bf16 v[228:231], v[132:135], a[252:255], v[228:231]
    s_waitcnt lgkmcnt(4)
    ds_read_b128 v[132:135], v7 offset:1024
    v_smfmac_f32_16x16x64_bf16 v[176:179], v[136:139], v[64:71], v16
    v_smfmac_f32_16x16x64_bf16 v[180:183], v[136:139], v[72:79], v16
    buffer_load_dwordx4 v1, s[56:59], s21 offen offset:1024 sc1 lds
    v_smfmac_f32_16x16x64_bf16 v[184:187], v[140:143], v[64:71], v16
    ds_read_b128 v[136:139], v7 offset:9216
    v_smfmac_f32_16x16x64_bf16 v[188:191], v[140:143], v[72:79], v16
    s_add_u32 s21, s21, 36864
    ds_read_b128 v[140:143], v7 offset:17408
    v_smfmac_f32_16x16x64_bf16 v[192:195], v[144:147], v[64:71], v16
    s_add_u32 m0, s45, 4096
    v_smfmac_f32_16x16x64_bf16 v[196:199], v[144:147], v[72:79], v16
    ds_read_b128 v[144:147], v7 offset:25600
    v_smfmac_f32_16x16x64_bf16 v[200:203], v[148:151], v[64:71], v16
    buffer_load_dwordx4 v1, s[56:59], s21 offen sc1 lds
    v_smfmac_f32_16x16x64_bf16 v[204:207], v[148:151], v[72:79], v16
    ds_read_b128 v[148:151], v7 offset:2048
    v_smfmac_f32_16x16x64_bf16 v[208:211], v[104:107], v[64:71], v16
    v_smfmac_f32_16x16x64_bf16 v[212:215], v[104:107], v[72:79], v16
    ds_read_b128 v[104:107], v7 offset:10240
    v_smfmac_f32_16x16x64_bf16 v[216:219], v[108:111], v[64:71], v16
    buffer_load_dwordx4 v1, s[56:59], s21 offen offset:1024 sc1 lds
    v_smfmac_f32_16x16x64_bf16 v[220:223], v[108:111], v[72:79], v16
    s_add_u32 s21, s21, 36864
    ds_read_b128 v[108:111], v7 offset:18432
    v_smfmac_f32_16x16x64_bf16 v[224:227], v[112:115], v[64:71], v16
    s_waitcnt vmcnt(14)
    v_smfmac_f32_16x16x64_bf16 v[228:231], v[112:115], v[72:79], v16
    s_add_u32 m0, s45, 6144
    ds_read_b128 v[112:115], v7 offset:26624
    s_waitcnt lgkmcnt(3)
    v_mfma_f32_16x16x32_bf16 v[176:179], v[116:119], v[32:35], v[176:179]
    buffer_load_dwordx4 v1, s[56:59], s21 offen sc1 lds
    v_mfma_f32_16x16x32_bf16 v[176:179], v[120:123], v[40:43], v[176:179]
    v_mfma_f32_16x16x32_bf16 v[176:179], v[124:127], v[48:51], v[176:179]
    v_mfma_f32_16x16x32_bf16 v[176:179], v[128:131], v[56:59], v[176:179]
    v_mfma_f32_16x16x32_bf16 v[180:183], v[116:119], v[36:39], v[180:183]
    buffer_load_dwordx4 v1, s[56:59], s21 offen offset:1024 sc1 lds
    v_mfma_f32_16x16x32_bf16 v[180:183], v[120:123], v[44:47], v[180:183]
    s_add_u32 s21, s21, 36864
    ds_read_b128 v[116:119], v7 offset:3072
    ds_read_b128 v[120:123], v7 offset:11264
    v_mfma_f32_16x16x32_bf16 v[180:183], v[124:127], v[52:55], v[180:183]
    ds_read_b128 v[124:127], v7 offset:19456
    v_cvt_pk_bf16_f32 v232, v176, v177
    v_mfma_f32_16x16x32_bf16 v[180:183], v[128:131], v[60:63], v[180:183]
    v_cvt_pk_bf16_f32 v233, v178, v179
    ds_read_b128 v[128:131], v7 offset:27648
    v_mfma_f32_16x16x32_bf16 v[184:187], v[132:135], v[32:35], v[184:187]
    v_mfma_f32_16x16x32_bf16 v[184:187], v[136:139], v[40:43], v[184:187]
    v_mfma_f32_16x16x32_bf16 v[184:187], v[140:143], v[48:51], v[184:187]
    v_mfma_f32_16x16x32_bf16 v[184:187], v[144:147], v[56:59], v[184:187]
    v_mfma_f32_16x16x32_bf16 v[188:191], v[132:135], v[36:39], v[188:191]
    ds_read_b128 v[132:135], v7 offset:4096
    v_cvt_pk_bf16_f32 v234, v180, v181
    v_mfma_f32_16x16x32_bf16 v[188:191], v[136:139], v[44:47], v[188:191]
    v_cvt_pk_bf16_f32 v235, v182, v183
    ds_read_b128 v[136:139], v7 offset:12288
    v_mfma_f32_16x16x32_bf16 v[188:191], v[140:143], v[52:55], v[188:191]
    buffer_store_dwordx4 v[232:235], v1, s[48:51], s8 offen offset:0 sc1
    v_mfma_f32_16x16x32_bf16 v[188:191], v[144:147], v[60:63], v[188:191]
    v_cvt_pk_bf16_f32 v236, v184, v185
    v_cvt_pk_bf16_f32 v237, v186, v187
    v_mfma_f32_16x16x32_bf16 v[192:195], v[148:151], v[32:35], v[192:195]
    s_waitcnt lgkmcnt(2)
    ds_read_b128 v[140:143], v7 offset:20480
    ds_read_b128 v[144:147], v7 offset:28672
    v_mfma_f32_16x16x32_bf16 v[192:195], v[104:107], v[40:43], v[192:195]
    v_mfma_f32_16x16x32_bf16 v[192:195], v[108:111], v[48:51], v[192:195]
    v_mfma_f32_16x16x32_bf16 v[192:195], v[112:115], v[56:59], v[192:195]
    v_cvt_pk_bf16_f32 v238, v188, v189
    v_cvt_pk_bf16_f32 v239, v190, v191
    v_mfma_f32_16x16x32_bf16 v[196:199], v[148:151], v[36:39], v[196:199]
    buffer_store_dwordx4 v[236:239], v1, s[48:51], s8 offen offset:1024 sc1
    v_mfma_f32_16x16x32_bf16 v[196:199], v[104:107], v[44:47], v[196:199]
    ds_read_b128 v[148:151], v7 offset:5120
    ds_read_b128 v[104:107], v7 offset:13312
    v_mfma_f32_16x16x32_bf16 v[196:199], v[108:111], v[52:55], v[196:199]
    v_cvt_pk_bf16_f32 v240, v192, v193
    v_cvt_pk_bf16_f32 v241, v194, v195
    v_mfma_f32_16x16x32_bf16 v[196:199], v[112:115], v[60:63], v[196:199]
    ds_read_b128 v[108:111], v7 offset:21504
    ds_read_b128 v[112:115], v7 offset:29696
    v_mfma_f32_16x16x32_bf16 v[200:203], v[116:119], v[32:35], v[200:203]
    v_mfma_f32_16x16x32_bf16 v[200:203], v[120:123], v[40:43], v[200:203]
    v_mfma_f32_16x16x32_bf16 v[200:203], v[124:127], v[48:51], v[200:203]
    v_mfma_f32_16x16x32_bf16 v[200:203], v[128:131], v[56:59], v[200:203]
    v_mfma_f32_16x16x32_bf16 v[204:207], v[116:119], v[36:39], v[204:207]
    ds_read_b128 v[116:119], v7 offset:6144
    v_cvt_pk_bf16_f32 v242, v196, v197
    v_mfma_f32_16x16x32_bf16 v[204:207], v[120:123], v[44:47], v[204:207]
    v_cvt_pk_bf16_f32 v243, v198, v199
    ds_read_b128 v[120:123], v7 offset:14336
    v_mfma_f32_16x16x32_bf16 v[204:207], v[124:127], v[52:55], v[204:207]
    buffer_store_dwordx4 v[240:243], v1, s[48:51], s9 offen offset:0 sc1
    v_mfma_f32_16x16x32_bf16 v[204:207], v[128:131], v[60:63], v[204:207]
    s_waitcnt lgkmcnt(2)
    v_cvt_pk_bf16_f32 v244, v200, v201
    v_cvt_pk_bf16_f32 v245, v202, v203
    v_mfma_f32_16x16x32_bf16 v[208:211], v[132:135], v[32:35], v[208:211]
    ds_read_b128 v[124:127], v7 offset:22528
    ds_read_b128 v[128:131], v7 offset:30720
    v_mfma_f32_16x16x32_bf16 v[208:211], v[136:139], v[40:43], v[208:211]
    v_mfma_f32_16x16x32_bf16 v[208:211], v[140:143], v[48:51], v[208:211]
    v_mfma_f32_16x16x32_bf16 v[208:211], v[144:147], v[56:59], v[208:211]
    v_cvt_pk_bf16_f32 v246, v204, v205
    v_cvt_pk_bf16_f32 v247, v206, v207
    v_mfma_f32_16x16x32_bf16 v[212:215], v[132:135], v[36:39], v[212:215]
    buffer_store_dwordx4 v[244:247], v1, s[48:51], s9 offen offset:1024 sc1
    v_mfma_f32_16x16x32_bf16 v[212:215], v[136:139], v[44:47], v[212:215]
    v_mfma_f32_16x16x32_bf16 v[212:215], v[140:143], v[52:55], v[212:215]
    v_mfma_f32_16x16x32_bf16 v[212:215], v[144:147], v[60:63], v[212:215]
    v_mfma_f32_16x16x32_bf16 v[216:219], v[148:151], v[32:35], v[216:219]
    v_cvt_pk_bf16_f32 v232, v208, v209
    v_cvt_pk_bf16_f32 v233, v210, v211
    v_mfma_f32_16x16x32_bf16 v[216:219], v[104:107], v[40:43], v[216:219]
    v_mfma_f32_16x16x32_bf16 v[216:219], v[108:111], v[48:51], v[216:219]
    v_mfma_f32_16x16x32_bf16 v[216:219], v[112:115], v[56:59], v[216:219]
    s_waitcnt vmcnt(12)
    s_barrier
    v_cvt_pk_bf16_f32 v234, v212, v213
    v_mfma_f32_16x16x32_bf16 v[220:223], v[148:151], v[36:39], v[220:223]
    v_cvt_pk_bf16_f32 v235, v214, v215
    ds_read_b128 v[132:135], v11 offset:0
    v_mfma_f32_16x16x32_bf16 v[220:223], v[104:107], v[44:47], v[220:223]
    buffer_store_dwordx4 v[232:235], v1, s[48:51], s10 offen offset:0 sc1
    v_mfma_f32_16x16x32_bf16 v[220:223], v[108:111], v[52:55], v[220:223]
    ds_read_b128 v[136:139], v11 offset:2048
    ds_read_b128 v[140:143], v11 offset:4096
    v_mfma_f32_16x16x32_bf16 v[220:223], v[112:115], v[60:63], v[220:223]
    s_waitcnt lgkmcnt(3)
    ds_read_b128 v[144:147], v11 offset:6144
    v_cvt_pk_bf16_f32 v236, v216, v217
    v_mfma_f32_16x16x32_bf16 v[224:227], v[116:119], v[32:35], v[224:227]
    v_cvt_pk_bf16_f32 v237, v218, v219
    ds_read_b128 v[148:151], v11 offset:1024
    v_mfma_f32_16x16x32_bf16 v[224:227], v[120:123], v[40:43], v[224:227]
    ds_read_b128 v[104:107], v11 offset:3072
    v_mfma_f32_16x16x32_bf16 v[224:227], v[124:127], v[48:51], v[224:227]
    v_cvt_pk_bf16_f32 v238, v220, v221
    v_cvt_pk_bf16_f32 v239, v222, v223
    v_mfma_f32_16x16x32_bf16 v[224:227], v[128:131], v[56:59], v[224:227]
    buffer_store_dwordx4 v[236:239], v1, s[48:51], s10 offen offset:1024 sc1
    v_mfma_f32_16x16x32_bf16 v[228:231], v[116:119], v[36:39], v[228:231]
    ds_read_b128 v[108:111], v11 offset:5120
    ds_read_b128 v[112:115], v11 offset:7168
    v_mfma_f32_16x16x32_bf16 v[228:231], v[120:123], v[44:47], v[228:231]
    ds_read_b128 v[116:119], v11 offset:8192
    v_mfma_f32_16x16x32_bf16 v[228:231], v[124:127], v[52:55], v[228:231]
    ds_read_b128 v[120:123], v11 offset:10240
    v_cvt_pk_bf16_f32 v240, v224, v225
    v_mfma_f32_16x16x32_bf16 v[228:231], v[128:131], v[60:63], v[228:231]
    s_waitcnt lgkmcnt(4)
    v_cvt_pk_bf16_f32 v241, v226, v227
    ds_read_b128 v[124:127], v11 offset:12288
    v_mfma_f32_16x16x32_bf16 v[160:163], v[132:135], a[0:3], 0
    ds_read_b128 v[128:131], v11 offset:14336
    v_mfma_f32_16x16x32_bf16 v[160:163], v[136:139], a[8:11], v[160:163]
    v_mfma_f32_16x16x32_bf16 v[160:163], v[140:143], a[16:19], v[160:163]
    v_mfma_f32_16x16x32_bf16 v[160:163], v[144:147], a[24:27], v[160:163]
    v_mfma_f32_16x16x32_bf16 v[164:167], v[132:135], a[4:7], 0
    v_cvt_pk_bf16_f32 v242, v228, v229
    v_cvt_pk_bf16_f32 v243, v230, v231
    v_mfma_f32_16x16x32_bf16 v[164:167], v[136:139], a[12:15], v[164:167]
    buffer_store_dwordx4 v[240:243], v1, s[48:51], s11 offen offset:2048 sc1
    v_mfma_f32_16x16x32_bf16 v[164:167], v[140:143], a[20:23], v[164:167]
    ds_read_b128 v[132:135], v11 offset:9216
    ds_read_b128 v[136:139], v11 offset:11264
    v_mfma_f32_16x16x32_bf16 v[164:167], v[144:147], a[28:31], v[164:167]
    ds_read_b128 v[140:143], v11 offset:13312
    v_mfma_f32_16x16x32_bf16 v[168:171], v[148:151], a[0:3], 0
    ds_read_b128 v[144:147], v11 offset:15360
    v_mfma_f32_16x16x32_bf16 v[168:171], v[104:107], a[8:11], v[168:171]
    s_waitcnt lgkmcnt(4)
    v_mfma_f32_16x16x32_bf16 v[168:171], v[108:111], a[16:19], v[168:171]
    v_mfma_f32_16x16x32_bf16 v[168:171], v[112:115], a[24:27], v[168:171]
    v_mfma_f32_16x16x32_bf16 v[172:175], v[148:151], a[4:7], 0
    ds_read_b128 v[148:151], v11 offset:16384
    v_mfma_f32_16x16x32_bf16 v[172:175], v[104:107], a[12:15], v[172:175]
    ds_read_b128 v[104:107], v11 offset:18432
    v_mfma_f32_16x16x32_bf16 v[172:175], v[108:111], a[20:23], v[172:175]
    ds_read_b128 v[108:111], v11 offset:20480
    v_mfma_f32_16x16x32_bf16 v[172:175], v[112:115], a[28:31], v[172:175]
    ds_read_b128 v[112:115], v11 offset:22528
    v_mfma_f32_16x16x32_bf16 v[160:163], v[116:119], a[32:35], v[160:163]
    v_mfma_f32_16x16x32_bf16 v[160:163], v[120:123], a[40:43], v[160:163]
    v_mfma_f32_16x16x32_bf16 v[160:163], v[124:127], a[48:51], v[160:163]
    v_mfma_f32_16x16x32_bf16 v[160:163], v[128:131], a[56:59], v[160:163]
    v_mfma_f32_16x16x32_bf16 v[164:167], v[116:119], a[36:39], v[164:167]
    ds_read_b128 v[116:119], v11 offset:17408
    v_mfma_f32_16x16x32_bf16 v[164:167], v[120:123], a[44:47], v[164:167]
    ds_read_b128 v[120:123], v11 offset:19456
    v_mfma_f32_16x16x32_bf16 v[164:167], v[124:127], a[52:55], v[164:167]
    ds_read_b128 v[124:127], v11 offset:21504
    v_mfma_f32_16x16x32_bf16 v[164:167], v[128:131], a[60:63], v[164:167]
    s_waitcnt lgkmcnt(3)
    ds_read_b128 v[128:131], v11 offset:23552
    v_mfma_f32_16x16x32_bf16 v[168:171], v[132:135], a[32:35], v[168:171]
    v_mfma_f32_16x16x32_bf16 v[168:171], v[136:139], a[40:43], v[168:171]
    v_mfma_f32_16x16x32_bf16 v[168:171], v[140:143], a[48:51], v[168:171]
    v_mfma_f32_16x16x32_bf16 v[168:171], v[144:147], a[56:59], v[168:171]
    v_mfma_f32_16x16x32_bf16 v[172:175], v[132:135], a[36:39], v[172:175]
    ds_read_b128 v[132:135], v11 offset:24576
    v_mfma_f32_16x16x32_bf16 v[172:175], v[136:139], a[44:47], v[172:175]
    ds_read_b128 v[136:139], v11 offset:26624
    v_mfma_f32_16x16x32_bf16 v[172:175], v[140:143], a[52:55], v[172:175]
    ds_read_b128 v[140:143], v11 offset:28672
    v_mfma_f32_16x16x32_bf16 v[172:175], v[144:147], a[60:63], v[172:175]
    ds_read_b128 v[144:147], v11 offset:30720
    v_mfma_f32_16x16x32_bf16 v[160:163], v[148:151], a[64:67], v[160:163]
    v_mfma_f32_16x16x32_bf16 v[160:163], v[104:107], a[72:75], v[160:163]
    v_mfma_f32_16x16x32_bf16 v[160:163], v[108:111], a[80:83], v[160:163]
    v_mfma_f32_16x16x32_bf16 v[160:163], v[112:115], a[88:91], v[160:163]
    v_mfma_f32_16x16x32_bf16 v[164:167], v[148:151], a[68:71], v[164:167]
    ds_read_b128 v[148:151], v11 offset:25600
    v_mfma_f32_16x16x32_bf16 v[164:167], v[104:107], a[76:79], v[164:167]
    ds_read_b128 v[104:107], v11 offset:27648
    v_mfma_f32_16x16x32_bf16 v[164:167], v[108:111], a[84:87], v[164:167]
    ds_read_b128 v[108:111], v11 offset:29696
    v_mfma_f32_16x16x32_bf16 v[164:167], v[112:115], a[92:95], v[164:167]
    s_waitcnt lgkmcnt(3)
    ds_read_b128 v[112:115], v11 offset:31744
    v_mfma_f32_16x16x32_bf16 v[168:171], v[116:119], a[64:67], v[168:171]
    v_mfma_f32_16x16x32_bf16 v[168:171], v[120:123], a[72:75], v[168:171]
    v_mfma_f32_16x16x32_bf16 v[168:171], v[124:127], a[80:83], v[168:171]
    v_mfma_f32_16x16x32_bf16 v[168:171], v[128:131], a[88:91], v[168:171]
    v_mfma_f32_16x16x32_bf16 v[172:175], v[116:119], a[68:71], v[172:175]
    v_mfma_f32_16x16x32_bf16 v[172:175], v[120:123], a[76:79], v[172:175]
    v_mfma_f32_16x16x32_bf16 v[172:175], v[124:127], a[84:87], v[172:175]
    v_mfma_f32_16x16x32_bf16 v[172:175], v[128:131], a[92:95], v[172:175]
    v_mfma_f32_16x16x32_bf16 v[160:163], v[132:135], a[96:99], v[160:163]
    v_mfma_f32_16x16x32_bf16 v[160:163], v[136:139], a[104:107], v[160:163]
    v_mfma_f32_16x16x32_bf16 v[160:163], v[140:143], a[112:115], v[160:163]
    s_waitcnt vmcnt(0)
    buffer_store_dword v31, v23, s[32:35], s74 offen sc1
    v_mfma_f32_16x16x32_bf16 v[160:163], v[144:147], a[120:123], v[160:163]
    s_waitcnt vmcnt(8)
    s_barrier
    ds_read_b128 v[116:119], v12 offset:0
    v_mfma_f32_16x16x32_bf16 v[164:167], v[132:135], a[100:103], v[164:167]
    ds_read_b128 v[120:123], v12 offset:2048
    ds_read_b128 v[124:127], v12 offset:4096
    v_mfma_f32_16x16x32_bf16 v[164:167], v[136:139], a[108:111], v[164:167]
    ds_read_b128 v[128:131], v12 offset:6144
    v_mfma_f32_16x16x32_bf16 v[164:167], v[140:143], a[116:119], v[164:167]
    ds_read_b128 v[132:135], v12 offset:1024
    v_mfma_f32_16x16x32_bf16 v[164:167], v[144:147], a[124:127], v[164:167]
    s_mul_i32 s21, s61, 6
    s_add_u32 s21, s4, s21
    s_add_u32 s21, s21, 128
    s_waitcnt lgkmcnt(5)
    v_mfma_f32_16x16x32_bf16 v[168:171], v[148:151], a[96:99], v[168:171]
    s_mul_i32 s21, s21, 36864
    s_add_u32 s21, s21, s28
    s_add_u32 s21, s21, 7168
    v_mfma_f32_16x16x32_bf16 v[168:171], v[104:107], a[104:107], v[168:171]
    s_mov_b32 m0, s46
    ds_read_b128 v[136:139], v12 offset:3072
    ds_read_b128 v[140:143], v12 offset:5120
    v_mfma_f32_16x16x32_bf16 v[168:171], v[108:111], a[112:115], v[168:171]
    buffer_load_dwordx4 v1, s[56:59], s21 offen sc1 lds
    v_mfma_f32_16x16x32_bf16 v[168:171], v[112:115], a[120:123], v[168:171]
    ds_read_b128 v[144:147], v12 offset:7168
    v_mfma_f32_16x16x32_bf16 v[172:175], v[148:151], a[100:103], v[172:175]
    ds_read_b128 v[148:151], v12 offset:8192
    v_mfma_f32_16x16x32_bf16 v[172:175], v[104:107], a[108:111], v[172:175]
    ds_read_b128 v[104:107], v12 offset:10240
    v_mfma_f32_16x16x32_bf16 v[172:175], v[108:111], a[116:119], v[172:175]
    buffer_load_dwordx4 v1, s[56:59], s21 offen offset:1024 sc1 lds
    v_mfma_f32_16x16x32_bf16 v[172:175], v[112:115], a[124:127], v[172:175]
    s_mul_i32 s21, s61, 6
    s_add_u32 s21, s21, 132
    s_mul_i32 s21, s21, 36864
    s_waitcnt lgkmcnt(3)
    v_mfma_f32_16x16x32_bf16 v[160:163], v[116:119], a[128:131], v[160:163]
    s_add_u32 s21, s21, s28
    s_add_u32 s21, s21, 7168
    s_and_b32 s64, s68, 1024
    v_mfma_f32_16x16x32_bf16 v[160:163], v[120:123], a[136:139], v[160:163]
    s_add_u32 s21, s21, s64
    ds_read_b128 v[108:111], v12 offset:12288
    ds_read_b128 v[112:115], v12 offset:14336
    v_mfma_f32_16x16x32_bf16 v[160:163], v[124:127], a[144:147], v[160:163]
    s_add_u32 m0, s46, 2048
    s_lshl2_add_u32 s64, s61, s65
    s_lshl_b32 s65, s65, 5
    v_mfma_f32_16x16x32_bf16 v[160:163], v[128:131], a[152:155], v[160:163]
    s_add_u32 s65, s65, 1024
    buffer_load_dwordx4 v1, s[56:59], s21 offen sc1 lds
    v_mfma_f32_16x16x32_bf16 v[164:167], v[116:119], a[132:135], v[164:167]
    s_lshl_b32 s64, s64, 6
    ds_read_b128 v[116:119], v12 offset:9216
    v_mfma_f32_16x16x32_bf16 v[164:167], v[120:123], a[140:143], v[164:167]
    s_cmp_eq_u32 s4, s61
    s_cselect_b32 s65, s65, 1073741824
    s_cselect_b32 s70, s23, 1073741824
    v_mfma_f32_16x16x32_bf16 v[164:167], v[124:127], a[148:151], v[164:167]
    ds_read_b128 v[120:123], v12 offset:11264
    ds_read_b128 v[124:127], v12 offset:13312
    v_mfma_f32_16x16x32_bf16 v[164:167], v[128:131], a[156:159], v[164:167]
    ds_read_b128 v[128:131], v12 offset:15360
    v_mfma_f32_16x16x32_bf16 v[168:171], v[132:135], a[128:131], v[168:171]
    v_mfma_f32_16x16x32_bf16 v[168:171], v[136:139], a[136:139], v[168:171]
    v_mfma_f32_16x16x32_bf16 v[168:171], v[140:143], a[144:147], v[168:171]
    s_waitcnt lgkmcnt(3)
    v_mfma_f32_16x16x32_bf16 v[168:171], v[144:147], a[152:155], v[168:171]
    v_mfma_f32_16x16x32_bf16 v[172:175], v[132:135], a[132:135], v[172:175]
    ds_read_b128 v[132:135], v12 offset:16384
    v_mfma_f32_16x16x32_bf16 v[172:175], v[136:139], a[140:143], v[172:175]
    ds_read_b128 v[136:139], v12 offset:18432
    v_mfma_f32_16x16x32_bf16 v[172:175], v[140:143], a[148:151], v[172:175]
    ds_read_b128 v[140:143], v12 offset:20480
    v_mfma_f32_16x16x32_bf16 v[172:175], v[144:147], a[156:159], v[172:175]
    ds_read_b128 v[144:147], v12 offset:22528
    v_mfma_f32_16x16x32_bf16 v[160:163], v[148:151], a[160:163], v[160:163]
    v_mfma_f32_16x16x32_bf16 v[160:163], v[104:107], a[168:171], v[160:163]
    v_mfma_f32_16x16x32_bf16 v[160:163], v[108:111], a[176:179], v[160:163]
    v_mfma_f32_16x16x32_bf16 v[160:163], v[112:115], a[184:187], v[160:163]
    v_mfma_f32_16x16x32_bf16 v[164:167], v[148:151], a[164:167], v[164:167]
    ds_read_b128 v[148:151], v12 offset:17408
    v_mfma_f32_16x16x32_bf16 v[164:167], v[104:107], a[172:175], v[164:167]
    buffer_load_dword v3, v19, s[32:35], s66 offen sc1
    v_mfma_f32_16x16x32_bf16 v[164:167], v[108:111], a[180:183], v[164:167]
    ds_read_b128 v[104:107], v12 offset:19456
    ds_read_b128 v[108:111], v12 offset:21504
    v_mfma_f32_16x16x32_bf16 v[164:167], v[112:115], a[188:191], v[164:167]
    ds_read_b128 v[112:115], v12 offset:23552
    v_mfma_f32_16x16x32_bf16 v[168:171], v[116:119], a[160:163], v[168:171]
    s_waitcnt lgkmcnt(4)
    v_mfma_f32_16x16x32_bf16 v[168:171], v[120:123], a[168:171], v[168:171]
    v_mfma_f32_16x16x32_bf16 v[168:171], v[124:127], a[176:179], v[168:171]
    v_mfma_f32_16x16x32_bf16 v[168:171], v[128:131], a[184:187], v[168:171]
    v_mfma_f32_16x16x32_bf16 v[172:175], v[116:119], a[164:167], v[172:175]
    ds_read_b128 v[116:119], v12 offset:24576
    v_mfma_f32_16x16x32_bf16 v[172:175], v[120:123], a[172:175], v[172:175]
    ds_read_b128 v[120:123], v12 offset:26624
    v_mfma_f32_16x16x32_bf16 v[172:175], v[124:127], a[180:183], v[172:175]
    ds_read_b128 v[124:127], v12 offset:28672
    v_mfma_f32_16x16x32_bf16 v[172:175], v[128:131], a[188:191], v[172:175]
    ds_read_b128 v[128:131], v12 offset:30720
    v_mfma_f32_16x16x32_bf16 v[160:163], v[132:135], a[192:195], v[160:163]
    v_mfma_f32_16x16x32_bf16 v[160:163], v[136:139], a[200:203], v[160:163]
    v_mfma_f32_16x16x32_bf16 v[160:163], v[140:143], a[208:211], v[160:163]
    v_mfma_f32_16x16x32_bf16 v[160:163], v[144:147], a[216:219], v[160:163]
    v_mfma_f32_16x16x32_bf16 v[164:167], v[132:135], a[196:199], v[164:167]
    ds_read_b128 v[132:135], v12 offset:25600
    v_mfma_f32_16x16x32_bf16 v[164:167], v[136:139], a[204:207], v[164:167]
    ds_read_b128 v[136:139], v12 offset:27648
    v_mfma_f32_16x16x32_bf16 v[164:167], v[140:143], a[212:215], v[164:167]
    ds_read_b128 v[140:143], v12 offset:29696
    v_mfma_f32_16x16x32_bf16 v[164:167], v[144:147], a[220:223], v[164:167]
    s_waitcnt lgkmcnt(3)
    ds_read_b128 v[144:147], v12 offset:31744
    v_mfma_f32_16x16x32_bf16 v[168:171], v[148:151], a[192:195], v[168:171]
    v_mfma_f32_16x16x32_bf16 v[168:171], v[104:107], a[200:203], v[168:171]
    v_mfma_f32_16x16x32_bf16 v[168:171], v[108:111], a[208:211], v[168:171]
    v_mfma_f32_16x16x32_bf16 v[168:171], v[112:115], a[216:219], v[168:171]
    v_mfma_f32_16x16x32_bf16 v[172:175], v[148:151], a[196:199], v[172:175]
    v_mfma_f32_16x16x32_bf16 v[172:175], v[104:107], a[204:207], v[172:175]
    v_mfma_f32_16x16x32_bf16 v[172:175], v[108:111], a[212:215], v[172:175]
    v_mfma_f32_16x16x32_bf16 v[172:175], v[112:115], a[220:223], v[172:175]
    v_mfma_f32_16x16x32_bf16 v[160:163], v[116:119], a[224:227], v[160:163]
    s_waitcnt vmcnt(0)
    v_cmp_gt_u32 vcc, 3, v3
    s_nop 1
    s_and_b64 vcc, vcc, exec
    s_cbranch_scc1 SPIN_X
BACK_X:
    v_mfma_f32_16x16x32_bf16 v[160:163], v[120:123], a[232:235], v[160:163]
    buffer_load_dwordx4 v[176:179], v1, s[48:51], s98 offen offset:0 sc1
    v_mfma_f32_16x16x32_bf16 v[160:163], v[124:127], a[240:243], v[160:163]
    s_add_u32 s98, s23, 12288
    buffer_load_dwordx4 v[180:183], v1, s[48:51], s98 offen offset:0 sc1
    v_mfma_f32_16x16x32_bf16 v[160:163], v[128:131], a[248:251], v[160:163]
    s_waitcnt vmcnt(3)
    s_barrier
    ds_read_b128 v[148:151], v13 offset:2048
    v_mfma_f32_16x16x32_bf16 v[164:167], v[116:119], a[228:231], v[164:167]
    s_add_u32 s98, s23, 24576
    ds_read_b128 v[104:107], v13 offset:1024
    ds_read_b128 v[108:111], v13 offset:9216
    v_mfma_f32_16x16x32_bf16 v[164:167], v[120:123], a[236:239], v[164:167]
    buffer_load_dwordx4 v[184:187], v1, s[48:51], s98 offen offset:0 sc1
    v_mfma_f32_16x16x32_bf16 v[164:167], v[124:127], a[244:247], v[164:167]
    s_add_u32 s98, s23, 0
    ds_read_b128 v[112:115], v13 offset:17408
    ds_read_b128 v[116:119], v13 offset:25600
    v_mfma_f32_16x16x32_bf16 v[164:167], v[128:131], a[252:255], v[164:167]
    s_waitcnt lgkmcnt(5)
    ds_read_b128 v[120:123], v13 offset:0
    v_mfma_f32_16x16x32_bf16 v[168:171], v[132:135], a[224:227], v[168:171]
    ds_read_b128 v[124:127], v13 offset:8192
    v_mfma_f32_16x16x32_bf16 v[168:171], v[136:139], a[232:235], v[168:171]
    buffer_load_dwordx4 v[188:191], v1, s[48:51], s98 offen offset:1024 sc1
    v_mfma_f32_16x16x32_bf16 v[168:171], v[140:143], a[240:243], v[168:171]
    s_add_u32 s98, s23, 12288
    ds_read_b128 v[128:131], v13 offset:16384
    v_mfma_f32_16x16x32_bf16 v[168:171], v[144:147], a[248:251], v[168:171]
    v_mfma_f32_16x16x32_bf16 v[172:175], v[132:135], a[228:231], v[172:175]
    ds_read_b128 v[132:135], v13 offset:24576
    v_mfma_f32_16x16x32_bf16 v[172:175], v[136:139], a[236:239], v[172:175]
    buffer_load_dwordx4 v[192:195], v1, s[48:51], s98 offen offset:1024 sc1
    v_mfma_f32_16x16x32_bf16 v[172:175], v[140:143], a[244:247], v[172:175]
    s_add_u32 s98, s23, 24576
    ds_read_b128 v[136:139], v13 offset:10240
    v_mfma_f32_16x16x32_bf16 v[172:175], v[144:147], a[252:255], v[172:175]
    s_waitcnt lgkmcnt(2)
    v_smfmac_f32_16x16x64_bf16 v[160:163], v[148:151], v[64:71], v16
    v_smfmac_f32_16x16x64_bf16 v[164:167], v[148:151], v[72:79], v16
    buffer_load_dwordx4 v[196:199], v1, s[48:51], s98 offen offset:1024 sc1
    v_mfma_f32_16x16x32_bf16 v[168:171], v[104:107], v[32:35], v[168:171]
    s_add_u32 s98, s70, 0
    v_mfma_f32_16x16x32_bf16 v[168:171], v[108:111], v[40:43], v[168:171]
    v_mfma_f32_16x16x32_bf16 v[168:171], v[112:115], v[48:51], v[168:171]
    v_mfma_f32_16x16x32_bf16 v[168:171], v[116:119], v[56:59], v[168:171]
    buffer_load_dwordx4 v[200:203], v1, s[48:51], s98 offen offset:2048 sc1
    v_mfma_f32_16x16x32_bf16 v[172:175], v[104:107], v[36:39], v[172:175]
    s_add_u32 s98, s70, 12288
    v_mfma_f32_16x16x32_bf16 v[172:175], v[108:111], v[44:47], v[172:175]
    v_mfma_f32_16x16x32_bf16 v[172:175], v[112:115], v[52:55], v[172:175]
    v_mfma_f32_16x16x32_bf16 v[172:175], v[116:119], v[60:63], v[172:175]
    buffer_load_dwordx4 v[204:207], v1, s[48:51], s98 offen offset:2048 sc1
    v_mfma_f32_16x16x32_bf16 v[160:163], v[120:123], v[32:35], v[160:163]
    s_add_u32 s98, s70, 24576
    v_mfma_f32_16x16x32_bf16 v[160:163], v[124:127], v[40:43], v[160:163]
    v_mfma_f32_16x16x32_bf16 v[160:163], v[128:131], v[48:51], v[160:163]
    s_waitcnt lgkmcnt(0)
    v_mfma_f32_16x16x32_bf16 v[160:163], v[132:135], v[56:59], v[160:163]
    buffer_load_dwordx4 v[208:211], v1, s[48:51], s98 offen offset:2048 sc1
    v_mfma_f32_16x16x32_bf16 v[164:167], v[120:123], v[36:39], v[164:167]
    v_mfma_f32_16x16x32_bf16 v[164:167], v[124:127], v[44:47], v[164:167]
    v_mfma_f32_16x16x32_bf16 v[164:167], v[128:131], v[52:55], v[164:167]
    v_mfma_f32_16x16x32_bf16 v[164:167], v[132:135], v[60:63], v[164:167]
    v_smfmac_f32_16x16x64_bf16 v[168:171], v[136:139], v[64:71], v16
    v_smfmac_f32_16x16x64_bf16 v[172:175], v[136:139], v[72:79], v16
    s_waitcnt vmcnt(6)
    v_mfma_f32_16x16x32_bf16 v[160:163], v[96:99], v[176:179], v[160:163]
    v_mfma_f32_16x16x32_bf16 v[160:163], v[96:99], v[180:183], v[160:163]
    v_mfma_f32_16x16x32_bf16 v[160:163], v[96:99], v[184:187], v[160:163]
    v_mfma_f32_16x16x32_bf16 v[164:167], v[98:101], v[176:179], v[164:167]
    v_mfma_f32_16x16x32_bf16 v[164:167], v[98:101], v[180:183], v[164:167]
    v_mfma_f32_16x16x32_bf16 v[164:167], v[98:101], v[184:187], v[164:167]
    s_waitcnt vmcnt(3)
    s_nop 0
    v_mfma_f32_16x16x32_bf16 v[168:171], v[96:99], v[188:191], v[168:171]
    v_mfma_f32_16x16x32_bf16 v[168:171], v[96:99], v[192:195], v[168:171]
    v_mfma_f32_16x16x32_bf16 v[168:171], v[96:99], v[196:199], v[168:171]
    v_mfma_f32_16x16x32_bf16 v[172:175], v[98:101], v[188:191], v[172:175]
    v_mfma_f32_16x16x32_bf16 v[172:175], v[98:101], v[192:195], v[172:175]
    v_mfma_f32_16x16x32_bf16 v[172:175], v[98:101], v[196:199], v[172:175]
    v_cvt_pk_bf16_f32 v160, v160, v161
    v_cvt_pk_bf16_f32 v161, v162, v163
    buffer_store_dwordx2 v[160:161], v20, s[24:27], s64 offen
    v_cvt_pk_bf16_f32 v164, v164, v165
    v_cvt_pk_bf16_f32 v165, v166, v167
    buffer_store_dwordx2 v[164:165], v21, s[24:27], s64 offen
    s_cmp_lg_u32 s4, s61
    s_cbranch_scc1 K1_X2
    s_waitcnt vmcnt(2)
    v_mfma_f32_16x16x32_bf16 v[224:227], v[96:99], v[200:203], v[224:227]
    v_mfma_f32_16x16x32_bf16 v[224:227], v[96:99], v[204:207], v[224:227]
    v_mfma_f32_16x16x32_bf16 v[224:227], v[96:99], v[208:211], v[224:227]
    v_mfma_f32_16x16x32_bf16 v[228:231], v[98:101], v[200:203], v[228:231]
    v_mfma_f32_16x16x32_bf16 v[228:231], v[98:101], v[204:207], v[228:231]
    v_mfma_f32_16x16x32_bf16 v[228:231], v[98:101], v[208:211], v[228:231]
    s_nop 4
    v_cvt_pk_bf16_f32 v224, v224, v225
    v_cvt_pk_bf16_f32 v225, v226, v227
    buffer_store_dwordx2 v[224:225], v20, s[24:27], s65 offen
    v_cvt_pk_bf16_f32 v228, v228, v229
    v_cvt_pk_bf16_f32 v229, v230, v231
    buffer_store_dwordx2 v[228:229], v21, s[24:27], s65 offen
K1_X2:
    v_cvt_pk_bf16_f32 v168, v168, v169
    v_cvt_pk_bf16_f32 v169, v170, v171
    buffer_store_dwordx2 v[168:169], v20, s[24:27], s64 offen offset:32
    v_cvt_pk_bf16_f32 v172, v172, v173
    v_cvt_pk_bf16_f32 v173, v174, v175
    buffer_store_dwordx2 v[172:173], v21, s[24:27], s64 offen offset:32
K1_END:
    s_endpgm
K1_LB_MASK:
    v_add_f32 v212, s12, v144
    v_fma_f32 v176, v208, s8, v212
    v_fma_f32 v177, v209, s8, v212
    v_fma_f32 v178, v210, s8, v212
    v_fma_f32 v179, v211, s8, v212
    v_add_f32 v213, s13, v144
    v_fma_f32 v180, v208, s9, v213
    v_fma_f32 v181, v209, s9, v213
    v_fma_f32 v182, v210, s9, v213
    v_fma_f32 v183, v211, s9, v213
    v_add_f32 v212, s14, v144
    v_fma_f32 v184, v208, s10, v212
    v_fma_f32 v185, v209, s10, v212
    v_fma_f32 v186, v210, s10, v212
    v_fma_f32 v187, v211, s10, v212
    v_add_f32 v213, s15, v144
    v_fma_f32 v188, v208, s11, v213
    v_fma_f32 v189, v209, s11, v213
    v_fma_f32 v190, v210, s11, v213
    v_fma_f32 v191, v211, s11, v213
    buffer_load_dword v3, v29, s[32:35], s92 offen sc1
    buffer_load_dword v28, off, s[32:35], s86 sc1
    s_branch K1_LB_BACK
K1_LS_MASK:
    s_cmp_eq_u32 s78, 1
    s_cbranch_scc1 K1_LS_LAST
    buffer_load_dword v3, v29, s[32:35], s92 offen sc1
    buffer_load_dword v28, off, s[32:35], s86 sc1
    v_mov_b32 v218, 1
    s_cmp_eq_u64 s[84:85], 0
    s_cselect_b32 s7, s74, 1073741824
    s_cmp_lg_u32 s83, 0
    s_cselect_b32 s7, s74, s7
    s_waitcnt vmcnt(10)
    buffer_store_dword v218, v216, s[32:35], s7 offen sc1
    s_branch K1_LS_BACK
K1_LS_LAST:
    v_add_f32 v212, s12, v152
    v_fma_f32 v176, v208, s8, v212
    v_fma_f32 v177, v209, s8, v212
    v_fma_f32 v178, v210, s8, v212
    v_fma_f32 v179, v211, s8, v212
    v_add_f32 v213, s13, v152
    v_fma_f32 v180, v208, s9, v213
    v_fma_f32 v181, v209, s9, v213
    v_fma_f32 v182, v210, s9, v213
    v_fma_f32 v183, v211, s9, v213
    v_add_f32 v212, s14, v152
    v_fma_f32 v184, v208, s10, v212
    v_fma_f32 v185, v209, s10, v212
    v_fma_f32 v186, v210, s10, v212
    v_fma_f32 v187, v211, s10, v212
    v_add_f32 v213, s15, v152
    v_fma_f32 v188, v208, s11, v213
    v_fma_f32 v189, v209, s11, v213
    v_fma_f32 v190, v210, s11, v213
    v_fma_f32 v191, v211, s11, v213
    v_cmp_gt_u32 vcc, 2, v28
    s_nop 1
    s_and_b64 vcc, vcc, exec
    s_cbranch_scc1 SPIN_W0H
BACK_W0H:
    s_lshl4_add_u32 s7, s73, s87
    buffer_load_dwordx4 a[128:131], v1, s[40:43], s7 offen sc1
    buffer_load_dwordx4 a[132:135], v1, s[40:43], s87 offen offset:1024 sc1
    v_cmp_gt_u32 vcc, 1, v3
    s_nop 1
    s_cmp_lg_u32 vcc_lo, 0
    s_cbranch_scc1 SPIN_W0
BACK_W0:
    s_mov_b64 s[36:37], s[56:57]
    s_mov_b32 s38, 5603328
    s_xor_b32 s77, s3, 0
    s_lshl2_add_u32 s77, s77, s4
    s_mul_i32 s77, s77, 36864
    s_add_u32 s77, s77, s28
    s_branch K1_LS_BACK
K1_WMASK:
    v_mov_b32 v9, 0xf149f2ca
    v_cmp_le_u32 vcc, 2, v14
    s_nop 1
    v_cndmask_b32 v141, v9, v141, vcc
    v_cmp_le_u32 vcc, 4, v14
    s_nop 1
    v_cndmask_b32 v142, v9, v142, vcc
    v_cmp_le_u32 vcc, 6, v14
    s_nop 1
    v_cndmask_b32 v143, v9, v143, vcc
    v_cmp_le_u32 vcc, 8, v14
    s_nop 1
    v_cndmask_b32 v144, v9, v144, vcc
    v_cmp_le_u32 vcc, 10, v14
    s_nop 1
    v_cndmask_b32 v145, v9, v145, vcc
    v_cmp_le_u32 vcc, 12, v14
    s_nop 1
    v_cndmask_b32 v146, v9, v146, vcc
    v_cmp_le_u32 vcc, 14, v14
    s_nop 1
    v_cndmask_b32 v147, v9, v147, vcc
    s_branch K1_WMASK_BACK
K1_S7:
    v_mov_b32 v218, 1
    s_cmp_eq_u64 s[84:85], 0
    s_cselect_b32 s7, s74, 1073741824
    s_cmp_lg_u32 s83, 0
    s_cselect_b32 s7, s74, s7
    s_waitcnt vmcnt(8)
    buffer_store_dword v218, v216, s[32:35], s7 offen sc1
    s_branch K1_S7_BACK
K1_J7:
    v_cmp_gt_u32 vcc, 2, v28
    s_nop 1
    s_and_b64 vcc, vcc, exec
    s_cbranch_scc1 SPIN_W7H
BACK_W7H:
    s_lshl4_add_u32 s7, s73, s87
    buffer_load_dwordx4 a[128:131], v1, s[40:43], s7 offen sc1
    buffer_load_dwordx4 a[132:135], v1, s[40:43], s87 offen offset:1024 sc1
    v_cmp_gt_u32 vcc, 1, v3
    s_nop 1
    s_cmp_lg_u32 vcc_lo, 0
    s_cbranch_scc1 SPIN_W7
BACK_W7:
    s_mov_b64 s[36:37], s[56:57]
    s_mov_b32 s38, 5603328
    s_xor_b32 s77, s3, 0
    s_lshl2_add_u32 s77, s77, s4
    s_mul_i32 s77, s77, 36864
    s_add_u32 s77, s77, s28
    s_branch K1_J7_BACK
K1_REDO:
    s_mov_b32 s83, 1
    s_mov_b32 s63, 1073741824
    s_mov_b32 s64, 1073741824
    s_mov_b32 s62, 1073741824
    s_mul_i32 s7, s5, 1081344
    s_sub_u32 s7, 56623104, s7
    s_sub_u32 s36, s56, s7
    s_subb_u32 s37, s57, 0
    s_mov_b32 s38, 1081344
    s_mov_b32 s50, 0
    s_mov_b32 s54, 0
    s_waitcnt vmcnt(0) lgkmcnt(0)
    s_barrier
    v_lshrrev_b32 v92, 4, v1
    v_and_b32 v64, 15, v92
    v_lshrrev_b32 v92, 4, v92
    v_lshlrev_b32 v92, 2, v92
    v_sub_u32 v92, v64, v92
    s_lshl_b32 s98, s4, 4
    v_add_u32 v92, s98, v92
    s_lshl_b32 s98, s6, 7
    s_sub_u32 s99, 1920, s98
    v_add_u32 v64, s98, v92
    v_add_u32 v65, 64, v64
    v_add_u32 v66, s99, v92
    v_add_u32 v67, 64, v66
    v_mov_b32 v93, 0xf149f2ca
    v_mov_b32 v68, v93
    v_mov_b32 v69, v93
    v_mov_b32 v70, v93
    v_mov_b32 v71, v93
    s_mov_b32 s78, 0
    s_add_u32 s99, s99, 128
K1_REDO_L:
    s_lshr_b32 s7, s78, 6
    s_lshl_b32 s7, s7, 15
    s_bfe_u32 s98, s78, 0x20004
    s_lshl_b32 s98, s98, 12
    s_add_u32 s7, s7, s98
    buffer_load_dwordx4 v[72:75], v1, s[36:39], s7 offen offset:0 sc1
    buffer_load_dwordx4 v[76:79], v1, s[36:39], s7 offen offset:1024 sc1
    buffer_load_dwordx4 v[80:83], v1, s[36:39], s7 offen offset:2048 sc1
    buffer_load_dwordx4 v[84:87], v1, s[36:39], s7 offen offset:3072 sc1
    s_waitcnt vmcnt(0)
    v_mfma_f32_16x16x32_bf16 v[88:91], v[72:75], v[128:131], 0
    v_mfma_f32_16x16x32_bf16 v[88:91], v[76:79], v[160:163], v[88:91]
    v_mfma_f32_16x16x32_bf16 v[88:91], v[80:83], v[192:195], v[88:91]
    v_mfma_f32_16x16x32_bf16 v[88:91], v[84:87], v[224:227], v[88:91]
    v_subrev_u32 v92, s78, v64
    v_cmp_le_i32 vcc, 0, v92
    s_nop 5
    v_cndmask_b32 v88, v93, v88, vcc
    v_max_f32 v68, v68, v88
    v_cmp_le_i32 vcc, 1, v92
    s_nop 1
    v_cndmask_b32 v89, v93, v89, vcc
    v_max_f32 v68, v68, v89
    v_cmp_le_i32 vcc, 2, v92
    s_nop 1
    v_cndmask_b32 v90, v93, v90, vcc
    v_max_f32 v68, v68, v90
    v_cmp_le_i32 vcc, 3, v92
    s_nop 1
    v_cndmask_b32 v91, v93, v91, vcc
    v_max_f32 v68, v68, v91
    v_mfma_f32_16x16x32_bf16 v[88:91], v[72:75], v[132:135], 0
    v_mfma_f32_16x16x32_bf16 v[88:91], v[76:79], v[164:167], v[88:91]
    v_mfma_f32_16x16x32_bf16 v[88:91], v[80:83], v[196:199], v[88:91]
    v_mfma_f32_16x16x32_bf16 v[88:91], v[84:87], v[228:231], v[88:91]
    v_subrev_u32 v92, s78, v65
    v_cmp_le_i32 vcc, 0, v92
    s_nop 5
    v_cndmask_b32 v88, v93, v88, vcc
    v_max_f32 v69, v69, v88
    v_cmp_le_i32 vcc, 1, v92
    s_nop 1
    v_cndmask_b32 v89, v93, v89, vcc
    v_max_f32 v69, v69, v89
    v_cmp_le_i32 vcc, 2, v92
    s_nop 1
    v_cndmask_b32 v90, v93, v90, vcc
    v_max_f32 v69, v69, v90
    v_cmp_le_i32 vcc, 3, v92
    s_nop 1
    v_cndmask_b32 v91, v93, v91, vcc
    v_max_f32 v69, v69, v91
    v_mfma_f32_16x16x32_bf16 v[88:91], v[72:75], v[136:139], 0
    v_mfma_f32_16x16x32_bf16 v[88:91], v[76:79], v[168:171], v[88:91]
    v_mfma_f32_16x16x32_bf16 v[88:91], v[80:83], v[200:203], v[88:91]
    v_mfma_f32_16x16x32_bf16 v[88:91], v[84:87], v[232:235], v[88:91]
    v_subrev_u32 v92, s78, v66
    v_cmp_le_i32 vcc, 0, v92
    s_nop 5
    v_cndmask_b32 v88, v93, v88, vcc
    v_max_f32 v70, v70, v88
    v_cmp_le_i32 vcc, 1, v92
    s_nop 1
    v_cndmask_b32 v89, v93, v89, vcc
    v_max_f32 v70, v70, v89
    v_cmp_le_i32 vcc, 2, v92
    s_nop 1
    v_cndmask_b32 v90, v93, v90, vcc
    v_max_f32 v70, v70, v90
    v_cmp_le_i32 vcc, 3, v92
    s_nop 1
    v_cndmask_b32 v91, v93, v91, vcc
    v_max_f32 v70, v70, v91
    v_mfma_f32_16x16x32_bf16 v[88:91], v[72:75], v[140:143], 0
    v_mfma_f32_16x16x32_bf16 v[88:91], v[76:79], v[172:175], v[88:91]
    v_mfma_f32_16x16x32_bf16 v[88:91], v[80:83], v[204:207], v[88:91]
    v_mfma_f32_16x16x32_bf16 v[88:91], v[84:87], v[236:239], v[88:91]
    v_subrev_u32 v92, s78, v67
    v_cmp_le_i32 vcc, 0, v92
    s_nop 5
    v_cndmask_b32 v88, v93, v88, vcc
    v_max_f32 v71, v71, v88
    v_cmp_le_i32 vcc, 1, v92
    s_nop 1
    v_cndmask_b32 v89, v93, v89, vcc
    v_max_f32 v71, v71, v89
    v_cmp_le_i32 vcc, 2, v92
    s_nop 1
    v_cndmask_b32 v90, v93, v90, vcc
    v_max_f32 v71, v71, v90
    v_cmp_le_i32 vcc, 3, v92
    s_nop 1
    v_cndmask_b32 v91, v93, v91, vcc
    v_max_f32 v71, v71, v91
    s_add_u32 s78, s78, 16
    s_cmp_lt_u32 s78, s99
    s_cbranch_scc1 K1_REDO_L
    v_mov_b32 v92, v68
    s_nop 1
    v_permlane32_swap_b32 v68, v92
    v_max_f32 v68, v68, v92
    v_mov_b32 v92, v68
    s_nop 1
    v_permlane16_swap_b32 v68, v92
    v_max_f32 v68, v68, v92
    v_sub_f32 v144, 0, v68
    v_sub_f32 v145, 0, v68
    v_sub_f32 v146, 0, v68
    v_sub_f32 v147, 0, v68
    v_mov_b32 v92, v69
    s_nop 1
    v_permlane32_swap_b32 v69, v92
    v_max_f32 v69, v69, v92
    v_mov_b32 v92, v69
    s_nop 1
    v_permlane16_swap_b32 v69, v92
    v_max_f32 v69, v69, v92
    v_sub_f32 v148, 0, v69
    v_sub_f32 v149, 0, v69
    v_sub_f32 v150, 0, v69
    v_sub_f32 v151, 0, v69
    v_mov_b32 v92, v70
    s_nop 1
    v_permlane32_swap_b32 v70, v92
    v_max_f32 v70, v70, v92
    v_mov_b32 v92, v70
    s_nop 1
    v_permlane16_swap_b32 v70, v92
    v_max_f32 v70, v70, v92
    v_sub_f32 v152, 0, v70
    v_sub_f32 v153, 0, v70
    v_sub_f32 v154, 0, v70
    v_sub_f32 v155, 0, v70
    v_mov_b32 v92, v71
    s_nop 1
    v_permlane32_swap_b32 v71, v92
    v_max_f32 v71, v71, v92
    v_mov_b32 v92, v71
    s_nop 1
    v_permlane16_swap_b32 v71, v92
    v_max_f32 v71, v71, v92
    v_sub_f32 v156, 0, v71
    v_sub_f32 v157, 0, v71
    v_sub_f32 v158, 0, v71
    v_sub_f32 v159, 0, v71
    v_accvgpr_write_b32 a0, 0
    v_accvgpr_write_b32 a1, 0
    v_accvgpr_write_b32 a2, 0
    v_accvgpr_write_b32 a3, 0
    v_accvgpr_write_b32 a4, 0
    v_accvgpr_write_b32 a5, 0
    v_accvgpr_write_b32 a6, 0
    v_accvgpr_write_b32 a7, 0
    v_accvgpr_write_b32 a8, 0
    v_accvgpr_write_b32 a9, 0
    v_accvgpr_write_b32 a10, 0
    v_accvgpr_write_b32 a11, 0
    v_accvgpr_write_b32 a12, 0
    v_accvgpr_write_b32 a13, 0
    v_accvgpr_write_b32 a14, 0
    v_accvgpr_write_b32 a15, 0
    v_accvgpr_write_b32 a16, 0
    v_accvgpr_write_b32 a17, 0
    v_accvgpr_write_b32 a18, 0
    v_accvgpr_write_b32 a19, 0
    v_accvgpr_write_b32 a20, 0
    v_accvgpr_write_b32 a21, 0
    v_accvgpr_write_b32 a22, 0
    v_accvgpr_write_b32 a23, 0
    v_accvgpr_write_b32 a24, 0
    v_accvgpr_write_b32 a25, 0
    v_accvgpr_write_b32 a26, 0
    v_accvgpr_write_b32 a27, 0
    v_accvgpr_write_b32 a28, 0
    v_accvgpr_write_b32 a29, 0
    v_accvgpr_write_b32 a30, 0
    v_accvgpr_write_b32 a31, 0
    v_accvgpr_write_b32 a32, 0
    v_accvgpr_write_b32 a33, 0
    v_accvgpr_write_b32 a34, 0
    v_accvgpr_write_b32 a35, 0
    v_accvgpr_write_b32 a36, 0
    v_accvgpr_write_b32 a37, 0
    v_accvgpr_write_b32 a38, 0
    v_accvgpr_write_b32 a39, 0
    v_accvgpr_write_b32 a40, 0
    v_accvgpr_write_b32 a41, 0
    v_accvgpr_write_b32 a42, 0
    v_accvgpr_write_b32 a43, 0
    v_accvgpr_write_b32 a44, 0
    v_accvgpr_write_b32 a45, 0
    v_accvgpr_write_b32 a46, 0
    v_accvgpr_write_b32 a47, 0
    v_accvgpr_write_b32 a48, 0
    v_accvgpr_write_b32 a49, 0
    v_accvgpr_write_b32 a50, 0
    v_accvgpr_write_b32 a51, 0
    v_accvgpr_write_b32 a52, 0
    v_accvgpr_write_b32 a53, 0
    v_accvgpr_write_b32 a54, 0
    v_accvgpr_write_b32 a55, 0
    v_accvgpr_write_b32 a56, 0
    v_accvgpr_write_b32 a57, 0
    v_accvgpr_write_b32 a58, 0
    v_accvgpr_write_b32 a59, 0
    v_accvgpr_write_b32 a60, 0
    v_accvgpr_write_b32 a61, 0
    v_accvgpr_write_b32 a62, 0
    v_accvgpr_write_b32 a63, 0
    v_accvgpr_write_b32 a144, 0
    v_accvgpr_write_b32 a145, 0
    v_accvgpr_write_b32 a146, 0
    v_accvgpr_write_b32 a147, 0
    v_accvgpr_write_b32 a148, 0
    v_accvgpr_write_b32 a149, 0
    v_accvgpr_write_b32 a150, 0
    v_accvgpr_write_b32 a151, 0
    v_accvgpr_write_b32 a152, 0
    v_accvgpr_write_b32 a153, 0
    v_accvgpr_write_b32 a154, 0
    v_accvgpr_write_b32 a155, 0
    v_accvgpr_write_b32 a156, 0
    v_accvgpr_write_b32 a157, 0
    v_accvgpr_write_b32 a158, 0
    v_accvgpr_write_b32 a159, 0
    v_accvgpr_write_b32 a160, 0
    v_accvgpr_write_b32 a161, 0
    v_accvgpr_write_b32 a162, 0
    v_accvgpr_write_b32 a163, 0
    v_accvgpr_write_b32 a164, 0
    v_accvgpr_write_b32 a165, 0
    v_accvgpr_write_b32 a166, 0
    v_accvgpr_write_b32 a167, 0
    v_accvgpr_write_b32 a168, 0
    v_accvgpr_write_b32 a169, 0
    v_accvgpr_write_b32 a170, 0
    v_accvgpr_write_b32 a171, 0
    v_accvgpr_write_b32 a172, 0
    v_accvgpr_write_b32 a173, 0
    v_accvgpr_write_b32 a174, 0
    v_accvgpr_write_b32 a175, 0
    v_accvgpr_write_b32 a176, 0
    v_accvgpr_write_b32 a177, 0
    v_accvgpr_write_b32 a178, 0
    v_accvgpr_write_b32 a179, 0
    v_accvgpr_write_b32 a180, 0
    v_accvgpr_write_b32 a181, 0
    v_accvgpr_write_b32 a182, 0
    v_accvgpr_write_b32 a183, 0
    v_accvgpr_write_b32 a184, 0
    v_accvgpr_write_b32 a185, 0
    v_accvgpr_write_b32 a186, 0
    v_accvgpr_write_b32 a187, 0
    v_accvgpr_write_b32 a188, 0
    v_accvgpr_write_b32 a189, 0
    v_accvgpr_write_b32 a190, 0
    v_accvgpr_write_b32 a191, 0
    v_accvgpr_write_b32 a192, 0
    v_accvgpr_write_b32 a193, 0
    v_accvgpr_write_b32 a194, 0
    v_accvgpr_write_b32 a195, 0
    v_accvgpr_write_b32 a196, 0
    v_accvgpr_write_b32 a197, 0
    v_accvgpr_write_b32 a198, 0
    v_accvgpr_write_b32 a199, 0
    v_accvgpr_write_b32 a200, 0
    v_accvgpr_write_b32 a201, 0
    v_accvgpr_write_b32 a202, 0
    v_accvgpr_write_b32 a203, 0
    v_accvgpr_write_b32 a204, 0
    v_accvgpr_write_b32 a205, 0
    v_accvgpr_write_b32 a206, 0
    v_accvgpr_write_b32 a207, 0
    v_accvgpr_write_b32 a208, 0
    v_accvgpr_write_b32 a209, 0
    v_accvgpr_write_b32 a210, 0
    v_accvgpr_write_b32 a211, 0
    v_accvgpr_write_b32 a212, 0
    v_accvgpr_write_b32 a213, 0
    v_accvgpr_write_b32 a214, 0
    v_accvgpr_write_b32 a215, 0
    v_accvgpr_write_b32 a216, 0
    v_accvgpr_write_b32 a217, 0
    v_accvgpr_write_b32 a218, 0
    v_accvgpr_write_b32 a219, 0
    v_accvgpr_write_b32 a220, 0
    v_accvgpr_write_b32 a221, 0
    v_accvgpr_write_b32 a222, 0
    v_accvgpr_write_b32 a223, 0
    v_bfe_u32 v92, v1, 4, 1
    v_sub_u32 v92, 0, v92
    v_and_b32 v92, 0xaaaaaaaa, v92
    v_or_b32 v215, 0x44444444, v92
    v_bfe_u32 v92, v1, 5, 1
    v_cmp_eq_u32 vcc, 0, v92
    v_mov_b32 v92, 0x3f803f80
    s_nop 0
    v_cndmask_b32 v92, 0, v92, vcc
    v_accvgpr_write_b32 a136, v92
    v_accvgpr_write_b32 a137, v92
    v_accvgpr_write_b32 a138, v92
    v_accvgpr_write_b32 a139, v92
    s_mov_b32 s77, s75
    s_mov_b32 s76, 0
    s_mov_b32 s38, 16384
    s_add_u32 m0, s76, s75
    s_nop 0
    buffer_load_dwordx4 v1, s[36:39], s77 offen sc1 lds
    buffer_load_dwordx4 v1, s[36:39], s77 offen offset:1024 sc1 lds
    buffer_load_dwordx4 v1, s[36:39], s77 offen offset:2048 sc1 lds
    buffer_load_dwordx4 v1, s[36:39], s77 offen offset:3072 sc1 lds
    s_add_u32 s100, s77, 4096
    s_add_u32 m0, m0, 4096
    s_nop 0
    buffer_load_dwordx4 v1, s[36:39], s100 offen sc1 lds
    buffer_load_dwordx4 v1, s[36:39], s100 offen offset:1024 sc1 lds
    buffer_load_dwordx4 v1, s[36:39], s100 offen offset:2048 sc1 lds
    buffer_load_dwordx4 v1, s[36:39], s100 offen offset:3072 sc1 lds
    s_add_u32 s77, s77, 32768
    s_add_u32 s76, s76, 32768
    s_lshr_b32 s82, s4, 1
    s_add_u32 s82, s82, 32
    s_sub_u32 s82, s82, s6
    s_sub_u32 s82, s82, s6
    s_lshl_b32 s38, s82, 15
    s_add_u32 m0, s76, s75
    s_nop 0
    buffer_load_dwordx4 v1, s[36:39], s77 offen sc1 lds
    buffer_load_dwordx4 v1, s[36:39], s77 offen offset:1024 sc1 lds
    buffer_load_dwordx4 v1, s[36:39], s77 offen offset:2048 sc1 lds
    buffer_load_dwordx4 v1, s[36:39], s77 offen offset:3072 sc1 lds
    s_add_u32 s100, s77, 4096
    s_add_u32 m0, m0, 4096
    s_nop 0
    buffer_load_dwordx4 v1, s[36:39], s100 offen sc1 lds
    buffer_load_dwordx4 v1, s[36:39], s100 offen offset:1024 sc1 lds
    buffer_load_dwordx4 v1, s[36:39], s100 offen offset:2048 sc1 lds
    buffer_load_dwordx4 v1, s[36:39], s100 offen offset:3072 sc1 lds
    s_add_u32 s77, s77, 32768
    s_add_u32 s76, s76, 32768
    s_add_u32 m0, s76, s75
    s_nop 0
    buffer_load_dwordx4 v1, s[36:39], s77 offen sc1 lds
    buffer_load_dwordx4 v1, s[36:39], s77 offen offset:1024 sc1 lds
    buffer_load_dwordx4 v1, s[36:39], s77 offen offset:2048 sc1 lds
    buffer_load_dwordx4 v1, s[36:39], s77 offen offset:3072 sc1 lds
    s_add_u32 s100, s77, 4096
    s_add_u32 m0, m0, 4096
    s_nop 0
    buffer_load_dwordx4 v1, s[36:39], s100 offen sc1 lds
    buffer_load_dwordx4 v1, s[36:39], s100 offen offset:1024 sc1 lds
    buffer_load_dwordx4 v1, s[36:39], s100 offen offset:2048 sc1 lds
    buffer_load_dwordx4 v1, s[36:39], s100 offen offset:3072 sc1 lds
    s_add_u32 s77, s77, 32768
    s_add_u32 s76, s76, 32768
    s_add_u32 s86, s101, 4096
    s_mov_b32 s87, 3072
    s_cmp_eq_u32 s6, 7
    s_cselect_b32 s86, s101, s86
    s_cselect_b32 s87, 0, s87
    s_sub_u32 s7, s101, 4096
    s_mov_b32 s98, 0
    s_cmp_eq_u32 s6, 0
    s_cselect_b32 s7, s101, s7
    s_cselect_b32 s98, 1073741824, s98
    s_bitcmp1_b32 s4, 0
    s_cselect_b32 s86, s86, s7
    s_cselect_b32 s87, s87, s98
    s_mul_i32 s7, s86, 48
    s_add_u32 s87, s87, s7
    s_add_u32 s87, s87, 19922944
    s_mov_b32 s82, 0
    s_mov_b32 s95, 32768
    s_mov_b32 s93, 65536
    s_mov_b32 s60, 131072
    v_mov_b32 v2, v1
    s_cmp_eq_u32 s6, 0
    s_cselect_b32 s16, s8, 0
    s_cselect_b32 s17, s9, 0
    s_cmp_eq_u32 s6, 0
    s_cselect_b32 s18, s10, 0
    s_cselect_b32 s19, s11, 0
    s_cmp_eq_u32 s6, 0
    s_cselect_b32 s20, s12, 0
    s_cselect_b32 s21, s13, 0
    s_cmp_eq_u32 s6, 0
    s_cselect_b32 s22, s14, 0
    s_cselect_b32 s23, s15, 0
    s_waitcnt vmcnt(16)
    s_barrier
    ds_read_b128 a[224:227], v2 offset:0
    ds_read_b128 a[228:231], v2 offset:1024
    ds_read_b128 a[232:235], v2 offset:2048
    ds_read_b128 a[236:239], v2 offset:3072
    s_waitcnt lgkmcnt(0)
    ds_read_b128 a[240:243], v2 offset:4096
    ds_read_b128 a[244:247], v2 offset:5120
    ds_read_b128 a[248:251], v2 offset:6144
    ds_read_b128 a[252:255], v2 offset:7168
    v_mul_f32 v176, s16, v208
    v_mul_f32 v177, s16, v209
    v_mul_f32 v178, s16, v210
    v_mul_f32 v179, s16, v211
    s_nop 1
    v_mfma_f32_16x16x32_bf16 v[240:243], a[224:227], v[128:131], v[176:179]
    v_mfma_f32_16x16x32_bf16 v[240:243], a[228:231], v[160:163], v[240:243]
    v_mfma_f32_16x16x32_bf16 v[240:243], a[232:235], v[192:195], v[240:243]
    v_mfma_f32_16x16x32_bf16 v[240:243], a[236:239], v[224:227], v[240:243]
    v_mfma_f32_16x16x32_bf16 v[244:247], a[224:227], v[132:135], 0
    v_mfma_f32_16x16x32_bf16 v[244:247], a[228:231], v[164:167], v[244:247]
    v_mfma_f32_16x16x32_bf16 v[244:247], a[232:235], v[196:199], v[244:247]
    v_mfma_f32_16x16x32_bf16 v[244:247], a[236:239], v[228:231], v[244:247]
    v_mfma_f32_16x16x32_bf16 v[248:251], a[224:227], v[136:139], 0
    v_mfma_f32_16x16x32_bf16 v[248:251], a[228:231], v[168:171], v[248:251]
    v_mfma_f32_16x16x32_bf16 v[248:251], a[232:235], v[200:203], v[248:251]
    v_mfma_f32_16x16x32_bf16 v[248:251], a[236:239], v[232:235], v[248:251]
    v_mfma_f32_16x16x32_bf16 v[252:255], a[224:227], v[140:143], 0
    v_mfma_f32_16x16x32_bf16 v[252:255], a[228:231], v[172:175], v[252:255]
    v_mfma_f32_16x16x32_bf16 v[252:255], a[232:235], v[204:207], v[252:255]
    v_mfma_f32_16x16x32_bf16 v[252:255], a[236:239], v[236:239], v[252:255]
    v_add_f32 v240, v240, v144
    v_exp_f32 v240, v240
    v_add_f32 v241, v241, v144
    v_exp_f32 v241, v241
    v_add_f32 v242, v242, v144
    v_exp_f32 v242, v242
    v_add_f32 v243, v243, v144
    v_exp_f32 v243, v243
    v_add_f32 v244, v244, v148
    v_exp_f32 v244, v244
    v_add_f32 v245, v245, v148
    v_exp_f32 v245, v245
    v_add_f32 v246, v246, v148
    v_exp_f32 v246, v246
    v_add_f32 v247, v247, v148
    v_exp_f32 v247, v247
    v_add_f32 v248, v248, v152
    v_exp_f32 v248, v248
    v_add_f32 v249, v249, v152
    v_exp_f32 v249, v249
    v_add_f32 v250, v250, v152
    v_exp_f32 v250, v250
    v_add_f32 v251, v251, v152
    v_exp_f32 v251, v251
    v_add_f32 v252, v252, v156
    v_exp_f32 v252, v252
    v_add_f32 v253, v253, v156
    v_exp_f32 v253, v253
    v_add_f32 v254, v254, v156
    v_exp_f32 v254, v254
    v_add_f32 v255, v255, v156
    v_exp_f32 v255, v255
    s_nop 1
    s_branch K1_ATT
SPIN_WA:
    s_mov_b32 s94, 0
SPIN_WA_L:
    s_sleep 2
    buffer_load_dword v7, v9, s[44:47], s69 offen sc1
    s_add_u32 s94, s94, 1
    s_cmp_ge_u32 s94, 0x40000
    s_waitcnt vmcnt(0)
    s_cbranch_scc1 BACK_WA
    v_cmp_gt_u32 vcc, 8, v7
    s_nop 1
    s_and_b64 vcc, vcc, s[86:87]
    s_cbranch_scc1 SPIN_WA_L
    s_branch BACK_WA
SPIN_KV:
    s_mov_b32 s94, 0
SPIN_KV_L:
    s_sleep 2
    buffer_load_dword v7, v8, s[32:35], s61 offen sc1
    s_add_u32 s94, s94, 1
    s_cmp_ge_u32 s94, 0x40000
    s_waitcnt vmcnt(0)
    s_cbranch_scc1 BACK_KV
    v_cmp_gt_u32 vcc, 1, v7
    s_nop 1
    s_and_b64 vcc, vcc, exec
    s_cbranch_scc1 SPIN_KV_L
    s_branch BACK_KV
SPIN_SHORT:
    s_mov_b32 s94, 0
SPIN_SHORT_L:
    s_sleep 2
    buffer_load_dword v3, v217, s[32:35], s19 offen sc1
    s_add_u32 s94, s94, 1
    s_cmp_ge_u32 s94, 0x40000
    s_waitcnt vmcnt(0)
    s_cbranch_scc1 BACK_SHORT
    v_cmp_gt_u32 vcc, 1, v3
    s_nop 1
    s_and_b64 vcc, vcc, exec
    s_cbranch_scc1 SPIN_SHORT_L
    s_branch BACK_SHORT
SPIN_CTX:
    s_mov_b32 s94, 0
SPIN_CTX_L:
    s_sleep 2
    buffer_load_dword v3, v217, s[32:35], s19 offen sc1
    s_add_u32 s94, s94, 1
    s_cmp_ge_u32 s94, 0x40000
    s_waitcnt vmcnt(0)
    s_cbranch_scc1 BACK_CTX
    v_cmp_gt_u32 vcc, 2, v3
    s_nop 1
    s_and_b64 vcc, vcc, exec
    s_cbranch_scc1 SPIN_CTX_L
    s_branch BACK_CTX
SPIN_ALL:
    s_mov_b32 s94, 0
SPIN_ALL_L:
    s_sleep 2
    buffer_load_dword v28, v29, s[32:35], s92 offen sc1
    s_add_u32 s94, s94, 1
    s_cmp_ge_u32 s94, 0x40000
    s_waitcnt vmcnt(0)
    s_cbranch_scc1 BACK_ALL
    v_cmp_gt_u32 vcc, 1, v28
    s_nop 1
    s_and_b64 vcc, vcc, exec
    s_cbranch_scc1 SPIN_ALL_L
    s_branch BACK_ALL
SPIN_OA:
    s_mov_b32 s94, 0
SPIN_OA_L:
    s_sleep 2
    buffer_load_dword v3, v19, s[32:35], s66 offen sc1
    s_add_u32 s94, s94, 1
    s_cmp_ge_u32 s94, 0x40000
    s_waitcnt vmcnt(0)
    s_cbranch_scc1 BACK_OA
    v_cmp_gt_u32 vcc, 3, v3
    s_nop 1
    s_and_b64 vcc, vcc, exec
    s_cbranch_scc1 SPIN_OA_L
    s_branch BACK_OA
SPIN_X:
    s_mov_b32 s94, 0
SPIN_X_L:
    s_sleep 2
    buffer_load_dword v3, v19, s[32:35], s66 offen sc1
    s_add_u32 s94, s94, 1
    s_cmp_ge_u32 s94, 0x40000
    s_waitcnt vmcnt(0)
    s_cbranch_scc1 BACK_X
    v_cmp_gt_u32 vcc, 3, v3
    s_nop 1
    s_and_b64 vcc, vcc, exec
    s_cbranch_scc1 SPIN_X_L
    s_branch BACK_X
SPIN_W0H:
    s_mov_b32 s94, 0
SPIN_W0H_L:
    s_sleep 2
    buffer_load_dword v28, off, s[32:35], s86 sc1
    s_add_u32 s94, s94, 1
    s_cmp_ge_u32 s94, 0x40000
    s_waitcnt vmcnt(0)
    s_cbranch_scc1 BACK_W0H
    v_cmp_gt_u32 vcc, 2, v28
    s_nop 1
    s_and_b64 vcc, vcc, exec
    s_cbranch_scc1 SPIN_W0H_L
    s_branch BACK_W0H
SPIN_W0:
    s_mov_b32 s94, 0
SPIN_W0_L:
    s_sleep 2
    buffer_load_dword v3, v29, s[32:35], s92 offen sc1
    s_add_u32 s94, s94, 1
    s_cmp_ge_u32 s94, 0x40000
    s_waitcnt vmcnt(0)
    s_cbranch_scc1 BACK_W0
    v_cmp_gt_u32 vcc, 1, v3
    s_nop 1
    s_cmp_lg_u32 vcc_lo, 0
    s_cbranch_scc1 SPIN_W0_L
    s_branch BACK_W0
SPIN_W7H:
    s_mov_b32 s94, 0
SPIN_W7H_L:
    s_sleep 2
    buffer_load_dword v28, off, s[32:35], s86 sc1
    s_add_u32 s94, s94, 1
    s_cmp_ge_u32 s94, 0x40000
    s_waitcnt vmcnt(0)
    s_cbranch_scc1 BACK_W7H
    v_cmp_gt_u32 vcc, 2, v28
    s_nop 1
    s_and_b64 vcc, vcc, exec
    s_cbranch_scc1 SPIN_W7H_L
    s_branch BACK_W7H
SPIN_W7:
    s_mov_b32 s94, 0
SPIN_W7_L:
    s_sleep 2
    buffer_load_dword v3, v29, s[32:35], s92 offen sc1
    s_add_u32 s94, s94, 1
    s_cmp_ge_u32 s94, 0x40000
    s_waitcnt vmcnt(0)
    s_cbranch_scc1 BACK_W7
    v_cmp_gt_u32 vcc, 1, v3
    s_nop 1
    s_cmp_lg_u32 vcc_lo, 0
    s_cbranch_scc1 SPIN_W7_L
    s_branch BACK_W7
.section .rodata,"a"
.p2align 6
.amdhsa_kernel gated_mix__sliding_local_dilated__compressed_kv_cla__prompt_kernel
.amdhsa_next_free_vgpr 512
.amdhsa_next_free_sgpr 102
.amdhsa_accum_offset 256
.amdhsa_group_segment_fixed_size 0
.amdhsa_kernarg_size 104
.amdhsa_user_sgpr_count 2
.amdhsa_user_sgpr_kernarg_segment_ptr 1
.amdhsa_system_sgpr_workgroup_id_x 1
.amdhsa_ieee_mode 0
.amdhsa_dx10_clamp 0
.end_amdhsa_kernel
```

```asm
; @launch grid=(256,1,1) block=(256,1,1) lds=163840
.amdgcn_target "amdgcn-amd-amdhsa--gfx950"
.text
.globl gated_mix__sliding_local_dilated__compressed_kv_cla__prompt_kernel
.p2align 8
.type gated_mix__sliding_local_dilated__compressed_kv_cla__prompt_kernel,@function
gated_mix__sliding_local_dilated__compressed_kv_cla__prompt_kernel:
    s_cmp_ge_u32 s2, 256
    s_cbranch_scc1 K1_END
    s_getpc_b64 s[94:95]
    s_load_dwordx8 s[36:43], s[0:1], 32
    v_min_u32 v74, 16, v0
    s_lshr_b32 s7, s2, 3
    s_mul_i32 s7, s7, 17
    v_add_lshl_u32 v74, v74, s7, 7
    global_load_dword v76, v74, s[94:95]
    v_lshrrev_b32 v64, 6, v0
    v_and_b32 v31, 63, v0
    v_readfirstlane_b32 s4, v64
    s_and_b32 s5, s2, 7
    s_lshl_b32 s5, s5, 2
    s_bfe_u32 s7, s2, 0x20003
    s_add_u32 s5, s5, s7
    s_lshr_b32 s6, s2, 5
    s_lshl_b32 s69, s4, 12
    s_mov_b32 s10, 2097152
    s_mov_b32 s11, 0x20000
    s_mov_b32 s14, 4194304
    s_mov_b32 s15, 0x20000
    s_mov_b32 s18, 4194304
    s_mov_b32 s19, 0x20000
    v_lshrrev_b32 v65, 3, v31
    v_and_b32 v66, 7, v31
    v_lshrrev_b32 v67, 1, v65
    v_xor_b32 v66, v66, v67
    v_lshlrev_b32 v66, 4, v66
    v_xor_b32 v67, 64, v66
    s_lshr_b32 s7, s4, 1
    s_lshl_b32 s73, s7, 7
    s_and_b32 s100, s4, 1
    s_lshl_b32 s98, s100, 5
    s_add_u32 s98, s98, s73
    v_add_lshl_u32 v68, v65, s98, 10
    v_add_u32 v6, v68, v66
    v_add_u32 v7, v68, v67
    v_add_u32 v7, 7168, v7
    v_add_u32 v8, v68, v66
    v_add_u32 v8, 14336, v8
    v_add_u32 v9, v68, v67
    v_add_u32 v9, 21504, v9
    v_lshrrev_b32 v69, 4, v31
    v_and_b32 v70, 15, v31
    v_lshlrev_b32 v71, 1, v69
    v_xor_b32 v71, v71, v70
    v_lshlrev_b32 v71, 4, v71
    v_xor_b32 v72, 128, v71
    s_lshl_b32 s98, s4, 4
    v_add_lshl_u32 v73, v69, s98, 13
    v_add_u32 v2, v73, v71
    v_add_u32 v3, v73, v71
    v_add_u32 v3, 31744, v3
    v_add_u32 v4, v73, v72
    v_add_u32 v4, 63488, v4
    v_add_u32 v5, v73, v72
    v_add_u32 v5, 95232, v5
    s_and_b32 s3, s2, 0
    s_lshl_b32 s66, s3, 7
    s_lshl_b32 s60, s3, 11
    s_add_u32 s60, s60, s5
    s_lshl_b32 s60, s60, 8
    s_lshl_b32 s61, s6, 18
    s_add_u32 s61, s61, s66
    s_add_u32 s62, s61, 65536
    s_waitcnt lgkmcnt(0)
    s_mov_b64 s[8:9], s[36:37]
    s_mov_b64 s[24:25], s[38:39]
    s_mov_b64 s[12:13], s[40:41]
    s_mov_b64 s[16:17], s[42:43]
    s_load_dwordx2 s[20:21], s[0:1], 0
    s_load_dwordx2 s[28:29], s[0:1], 8
    s_load_dwordx2 s[32:33], s[0:1], 72
    s_load_dwordx2 s[48:49], s[0:1], 64
    s_load_dwordx2 s[92:93], s[0:1], 16
    s_load_dwordx2 s[44:45], s[0:1], 88
    s_load_dwordx2 s[56:57], s[0:1], 96
    s_load_dwordx2 s[0:1], s[0:1], 80
    s_add_u32 m0, s69, 0
    s_nop 0
    buffer_load_dwordx4 v6, s[8:11], s61 offen lds
    buffer_load_dwordx4 v7, s[8:11], s61 offen offset:1024 lds
    buffer_load_dwordx4 v8, s[8:11], s61 offen offset:2048 lds
    buffer_load_dwordx4 v9, s[8:11], s61 offen offset:3072 lds
    s_xor_b32 s61, s61, 128
    s_add_u32 m0, s69, 16384
    s_nop 0
    buffer_load_dwordx4 v6, s[8:11], s62 offen lds
    buffer_load_dwordx4 v7, s[8:11], s62 offen offset:1024 lds
    buffer_load_dwordx4 v8, s[8:11], s62 offen offset:2048 lds
    buffer_load_dwordx4 v9, s[8:11], s62 offen offset:3072 lds
    s_xor_b32 s62, s62, 128
    s_add_u32 m0, s69, 32768
    s_nop 0
    buffer_load_dwordx4 v2, s[12:15], s60 offen nt lds
    buffer_load_dwordx4 v3, s[12:15], s60 offen offset:1024 nt lds
    buffer_load_dwordx4 v4, s[12:15], s60 offen offset:2048 nt lds
    buffer_load_dwordx4 v5, s[12:15], s60 offen offset:3072 nt lds
    s_add_u32 m0, s69, 49152
    s_nop 0
    buffer_load_dwordx4 v6, s[8:11], s61 offen lds
    buffer_load_dwordx4 v7, s[8:11], s61 offen offset:1024 lds
    buffer_load_dwordx4 v8, s[8:11], s61 offen offset:2048 lds
    buffer_load_dwordx4 v9, s[8:11], s61 offen offset:3072 lds
    s_xor_b32 s61, s61, 384
    s_waitcnt lgkmcnt(0)
    s_mov_b32 s22, 2359296
    s_mov_b32 s23, 0x20000
    s_mov_b32 s26, 4718592
    s_mov_b32 s27, 0x20000
    s_mov_b32 s50, 4718592
    s_mov_b32 s51, 0x20000
    s_mov_b32 s46, 256
    s_mov_b32 s47, 0x20000
    s_mov_b32 s30, 1990656
    s_mov_b32 s31, 0x20000
    s_mov_b32 s34, 1152
    s_mov_b32 s35, 0x20000
    s_mul_i32 s7, s5, 1081344
    s_add_u32 s36, s56, s7
    s_addc_u32 s37, s57, 0
    s_mov_b32 s38, 1081344
    s_mov_b32 s39, 0x20000
    s_cmp_eq_u32 s4, 0
    s_cselect_b32 s86, 0x55555555, 0
    s_cselect_b32 s87, 0x55555555, 0
    s_cselect_b32 s52, s48, s92
    s_cselect_b32 s53, s49, s93
    s_cselect_b32 s54, s50, 663552
    s_mov_b32 s55, 0x20000
    s_mul_i32 s63, s6, 147456
    s_sub_u32 s64, 2211840, s63
    s_add_u32 s63, s63, s66
    s_add_u32 s64, s64, s66
    s_lshl_b32 s67, s4, 11
    s_lshl_b32 s68, s4, 10
    s_lshl_b32 s75, s4, 13
    s_lshl_b32 s65, s3, 13
    s_add_u32 s65, s65, s67
    s_lshl_b32 s70, s6, 2
    s_lshl1_add_u32 s70, s100, s70
    s_lshl_b32 s70, s70, 15
    s_lshl_b32 s98, s73, 6
    s_add_u32 s71, s70, s98
    s_add_u32 s71, s71, 49152
    s_lshl_b32 s98, s73, 4
    s_add_u32 s70, s70, s98
    v_lshlrev_b32 v1, 4, v31
    v_mov_b32 v77, 1073741824
    v_cmp_eq_u32 vcc, 0, v0
    s_nop 1
    v_cndmask_b32_e64 v30, v77, 0, vcc
    v_lshlrev_b32 v103, 7, v31
    v_cmp_gt_u32 vcc, 9, v31
    s_nop 1
    v_cndmask_b32 v103, v77, v103, vcc
    s_lshl_b32 s98, s4, 5
    v_add_u32 v68, s98, v65
    v_mul_u32_u24 v68, 1152, v68
    v_add_u32 v10, v68, v66
    v_add_u32 v11, v68, v67
    v_add_u32 v11, 8192, v11
    v_add_u32 v12, v68, v66
    v_add_u32 v12, 16384, v12
    v_add_u32 v13, v68, v67
    v_add_u32 v13, 24576, v13
    v_lshrrev_b32 v71, 1, v70
    v_xor_b32 v71, v71, v69
    v_lshlrev_b32 v71, 4, v71
    v_lshl_add_u32 v71, v70, 7, v71
    s_add_u32 m0, s69, 65536
    s_nop 0
    buffer_load_dwordx4 v2, s[16:19], s60 offen nt lds
    v_xor_b32 v72, 64, v71
    s_lshl_b32 s98, s100, 13
    v_add_u32 v22, s98, v71
    v_add_u32 v23, s98, v72
    v_add_u32 v24, s67, v71
    v_add_u32 v25, s67, v72
    v_bfe_u32 v73, v31, 2, 2
    v_and_b32 v74, 3, v31
    v_lshl_add_u32 v75, v69, 3, v73
    v_and_b32 v78, 1, v69
    v_lshl_add_u32 v77, v78, 2, v73
    v_lshlrev_b32 v77, 5, v77
    v_lshl_add_u32 v77, v74, 3, v77
    v_lshl_add_u32 v77, v75, 8, v77
    v_xor_b32 v14, 0, v77
    v_xor_b32 v14, s73, v14
    buffer_load_dwordx4 v3, s[16:19], s60 offen offset:1024 nt lds
    v_xor_b32 v15, 32, v77
    v_xor_b32 v15, s73, v15
    v_xor_b32 v16, 64, v77
    v_xor_b32 v16, s73, v16
    v_xor_b32 v17, 96, v77
    v_xor_b32 v17, s73, v17
    v_xor_b32 v18, 128, v77
    v_xor_b32 v19, 160, v77
    v_xor_b32 v20, 192, v77
    v_xor_b32 v21, 224, v77
    v_lshrrev_b32 v77, 1, v73
    v_lshl_add_u32 v77, v78, 1, v77
    v_lshlrev_b32 v77, 5, v77
    v_lshl_add_u32 v77, v74, 3, v77
    v_lshl_add_u32 v77, v75, 7, v77
    s_lshr_b32 s98, s73, 1
    buffer_load_dwordx4 v4, s[16:19], s60 offen offset:2048 nt lds
    v_xor_b32 v26, 0, v77
    v_xor_b32 v26, s98, v26
    v_xor_b32 v27, 32, v77
    v_xor_b32 v28, 64, v77
    v_xor_b32 v28, s98, v28
    v_xor_b32 v29, 96, v77
    v_and_b32 v73, 7, v0
    v_lshrrev_b32 v74, 3, v0
    v_lshl_add_u32 v75, v73, 1, 0
    v_mul_u32_u24 v78, 52, v75
    v_lshrrev_b32 v78, 8, v78
    v_mul_u32_u24 v79, 5, v78
    v_sub_u32 v75, v75, v79
    v_add_u32 v78, 1, v78
    v_cmp_le_u32 vcc, 3, v78
    s_nop 1
    v_cndmask_b32_e64 v78, v78, 0, vcc
    buffer_load_dwordx4 v5, s[16:19], s60 offen offset:3072 nt lds
    s_xor_b32 s60, s60, 524288
    v_mul_u32_u24 v78, 1152, v78
    v_lshl_add_u32 v75, v75, 3, v78
    v_mad_u32_u24 v75, v74, 36, v75
    v_lshl_add_u32 v77, v73, 1, 1
    v_mul_u32_u24 v78, 52, v77
    v_lshrrev_b32 v78, 8, v78
    v_mul_u32_u24 v79, 5, v78
    v_sub_u32 v77, v77, v79
    v_add_u32 v78, 1, v78
    v_cmp_le_u32 vcc, 3, v78
    s_nop 1
    v_cndmask_b32_e64 v78, v78, 0, vcc
    v_mul_u32_u24 v78, 1152, v78
    v_lshl_add_u32 v77, v77, 3, v78
    v_mad_u32_u24 v77, v74, 36, v77
    s_mul_i32 s98, s2, 10368
    s_mul_i32 s99, s2, 6
    s_mov_b32 s7, 73728
    v_mul_lo_u32 v95, v74, s7
    v_lshl_add_u32 v95, v73, 4, v95
    v_cmp_eq_u32 s[92:93], 7, v73
    s_add_u32 s56, s56, 56623104
    s_addc_u32 s57, s57, 0
    s_mov_b32 s58, 5603328
    s_mov_b32 s59, 0x20000
    s_lshl_b32 s101, s6, 5
    s_add_u32 s101, s101, s5
    s_lshl_b32 s101, s101, 7
    v_mov_b32 v65, 0
    v_lshrrev_b32 v64, 2, v0
    v_lshlrev_b32 v64, 15, v64
    v_and_b32 v79, 3, v0
    v_lshl_add_u32 v64, v79, 2, v64
    s_mov_b32 s74, 0x3e0293ee
    s_lshl_b32 s95, s5, 3
    s_waitcnt vmcnt(8)
    s_barrier
    ds_read_b128 a[0:3], v22 offset:0
    ds_read_b64_tr_b16 v[40:41], v14 offset:32768
    ds_read_b64_tr_b16 v[42:43], v14 offset:33792
    ds_read_b128 a[4:7], v23 offset:0
    ds_read_b64_tr_b16 v[44:45], v14 offset:40960
    ds_read_b64_tr_b16 v[46:47], v14 offset:41984
    ds_read_b128 a[8:11], v22 offset:2048
    ds_read_b128 a[12:15], v23 offset:2048
    ds_read_b128 a[16:19], v22 offset:4096
    ds_read_b128 a[20:23], v23 offset:4096
    ds_read_b128 a[24:27], v22 offset:6144
    ds_read_b128 a[28:31], v23 offset:6144
    ds_read_b128 a[32:35], v22 offset:16384
    ds_read_b128 a[36:39], v23 offset:16384
    ds_read_b128 a[40:43], v22 offset:18432
    s_waitcnt lgkmcnt(14)
    ds_read_b128 a[44:47], v23 offset:18432
    s_waitcnt lgkmcnt(14)
    ds_read_b128 a[48:51], v22 offset:20480
    s_waitcnt lgkmcnt(14)
    ds_read_b128 a[52:55], v23 offset:20480
    s_waitcnt lgkmcnt(14)
    ds_read_b128 a[56:59], v22 offset:22528
    s_waitcnt lgkmcnt(14)
    ds_read_b128 a[60:63], v23 offset:22528
    v_mfma_f32_16x16x32_bf16 v[128:131], v[40:43], a[0:3], 0
    s_add_u32 m0, s69, 81920
    s_waitcnt lgkmcnt(14)
    ds_read_b64_tr_b16 v[48:49], v15 offset:32768
    s_waitcnt lgkmcnt(14)
    ds_read_b64_tr_b16 v[50:51], v15 offset:33792
    v_mfma_f32_16x16x32_bf16 v[128:131], v[44:47], a[4:7], v[128:131]
    s_mul_i32 s77, s2, 9216
    buffer_load_dwordx4 v6, s[8:11], s62 offen lds
    v_mfma_f32_16x16x32_bf16 v[132:135], v[40:43], a[8:11], 0
    s_mul_i32 s76, s4, 1152
    s_waitcnt lgkmcnt(14)
    ds_read_b64_tr_b16 v[52:53], v15 offset:40960
    s_waitcnt lgkmcnt(13)
    ds_read_b64_tr_b16 v[54:55], v15 offset:41984
    v_mfma_f32_16x16x32_bf16 v[132:135], v[44:47], a[12:15], v[132:135]
    s_add_u32 s77, s77, s76
    ds_read_b64_tr_b16 v[56:57], v16 offset:32768
    s_waitcnt lgkmcnt(10)
    ds_read_b64_tr_b16 v[58:59], v16 offset:33792
    v_mfma_f32_16x16x32_bf16 v[136:139], v[40:43], a[16:19], 0
    s_mul_i32 s76, s4, 1152
    buffer_load_dwordx4 v7, s[8:11], s62 offen offset:1024 lds
    v_mfma_f32_16x16x32_bf16 v[136:139], v[44:47], a[20:23], v[136:139]
    s_mul_i32 s72, s2, 3
    ds_read_b64_tr_b16 v[60:61], v16 offset:40960
    ds_read_b64_tr_b16 v[62:63], v16 offset:41984
    v_mfma_f32_16x16x32_bf16 v[140:143], v[40:43], a[24:27], 0
    s_add_u32 s72, s72, 0
    v_add_u32 v14, 0x10000, v14
    v_add_u32 v15, 0x10000, v15
    v_mfma_f32_16x16x32_bf16 v[140:143], v[44:47], a[28:31], v[140:143]
    s_mul_i32 s7, s5, 73728
    v_add_u32 v16, 0x10000, v16
    v_mov_b32 v31, 1
    v_mfma_f32_16x16x32_bf16 v[144:147], v[40:43], a[32:35], 0
    s_and_b32 s100, s5, 1
    buffer_load_dwordx4 v8, s[8:11], s62 offen offset:2048 lds
    v_mfma_f32_16x16x32_bf16 v[144:147], v[44:47], a[36:39], v[144:147]
    s_mov_b32 vcc_lo, 0x84848484
    s_mov_b32 vcc_hi, 0x84848484
    v_add_u32 v18, 0x10000, v18
    v_mfma_f32_16x16x32_bf16 v[148:151], v[40:43], a[40:43], 0
    s_mov_b32 s83, 0
    v_add_u32 v19, 0x10000, v19
    v_add_u32 v20, 0x10000, v20
    s_waitcnt lgkmcnt(0)
    v_mfma_f32_16x16x32_bf16 v[148:151], v[44:47], a[44:47], v[148:151]
    v_add_u32 v21, 0x10000, v21
    v_add_u32 v26, 0x10000, v26
    v_mfma_f32_16x16x32_bf16 v[152:155], v[40:43], a[48:51], 0
    buffer_load_dwordx4 v9, s[8:11], s62 offen offset:3072 lds
    v_mfma_f32_16x16x32_bf16 v[152:155], v[44:47], a[52:55], v[152:155]
    v_add_u32 v27, 0x10000, v27
    v_add_u32 v28, 0x10000, v28
    v_mfma_f32_16x16x32_bf16 v[156:159], v[40:43], a[56:59], 0
    s_add_u32 m0, s69, 98304
    ds_read_b64_tr_b16 v[40:41], v17 offset:32768
    ds_read_b64_tr_b16 v[42:43], v17 offset:33792
    v_mfma_f32_16x16x32_bf16 v[156:159], v[44:47], a[60:63], v[156:159]
    s_xor_b32 s62, s62, 384
    ds_read_b64_tr_b16 v[44:45], v17 offset:40960
    ds_read_b64_tr_b16 v[46:47], v17 offset:41984
    v_mfma_f32_16x16x32_bf16 v[160:163], v[48:51], a[0:3], 0
    buffer_load_dwordx4 v2, s[12:15], s60 offen nt lds
    v_mfma_f32_16x16x32_bf16 v[160:163], v[52:55], a[4:7], v[160:163]
    v_add_u32 v17, 0x10000, v17
    v_add_u32 v29, 0x10000, v29
    v_mfma_f32_16x16x32_bf16 v[164:167], v[48:51], a[8:11], 0
    v_bfe_u32 v37, v1, 4, 4
    v_mul_u32_u24 v36, 1152, v37
    v_mfma_f32_16x16x32_bf16 v[164:167], v[52:55], a[12:15], v[164:167]
    v_lshrrev_b32 v38, 8, v1
    v_lshl_add_u32 v36, v38, 4, v36
    v_mfma_f32_16x16x32_bf16 v[168:171], v[48:51], a[16:19], 0
    buffer_load_dwordx4 v3, s[12:15], s60 offen offset:1024 nt lds
    v_mfma_f32_16x16x32_bf16 v[168:171], v[52:55], a[20:23], v[168:171]
    v_lshrrev_b32 v39, 3, v37
    v_mul_u32_u24 v39, 9152, v39
    v_mfma_f32_16x16x32_bf16 v[172:175], v[48:51], a[24:27], 0
    v_mfma_f32_16x16x32_bf16 v[172:175], v[52:55], a[28:31], v[172:175]
    v_mfma_f32_16x16x32_bf16 v[176:179], v[48:51], a[32:35], 0
    buffer_load_dwordx4 v4, s[12:15], s60 offen offset:2048 nt lds
    v_mfma_f32_16x16x32_bf16 v[176:179], v[52:55], a[36:39], v[176:179]
    v_mfma_f32_16x16x32_bf16 v[180:183], v[48:51], a[40:43], 0
    v_mfma_f32_16x16x32_bf16 v[180:183], v[52:55], a[44:47], v[180:183]
    v_mfma_f32_16x16x32_bf16 v[184:187], v[48:51], a[48:51], 0
    buffer_load_dwordx4 v5, s[12:15], s60 offen offset:3072 nt lds
    v_mfma_f32_16x16x32_bf16 v[184:187], v[52:55], a[52:55], v[184:187]
    v_mfma_f32_16x16x32_bf16 v[188:191], v[48:51], a[56:59], 0
    s_waitcnt vmcnt(12)
    s_barrier
    v_mfma_f32_16x16x32_bf16 v[188:191], v[52:55], a[60:63], v[188:191]
    s_add_u32 m0, s69, 114688
    ds_read_b128 a[64:67], v22 offset:49152
    v_mfma_f32_16x16x32_bf16 v[192:195], v[56:59], a[0:3], 0
    buffer_load_dwordx4 v6, s[8:11], s61 offen lds
    v_mfma_f32_16x16x32_bf16 v[192:195], v[60:63], a[4:7], v[192:195]
    v_mfma_f32_16x16x32_bf16 v[196:199], v[56:59], a[8:11], 0
    ds_read_b128 a[68:71], v23 offset:49152
    v_mfma_f32_16x16x32_bf16 v[196:199], v[60:63], a[12:15], v[196:199]
    v_mfma_f32_16x16x32_bf16 v[200:203], v[56:59], a[16:19], 0
    buffer_load_dwordx4 v7, s[8:11], s61 offen offset:1024 lds
    v_mfma_f32_16x16x32_bf16 v[200:203], v[60:63], a[20:23], v[200:203]
    v_mfma_f32_16x16x32_bf16 v[204:207], v[56:59], a[24:27], 0
    ds_read_b128 a[72:75], v22 offset:51200
    v_mfma_f32_16x16x32_bf16 v[204:207], v[60:63], a[28:31], v[204:207]
    v_mfma_f32_16x16x32_bf16 v[208:211], v[56:59], a[32:35], 0
    buffer_load_dwordx4 v8, s[8:11], s61 offen offset:2048 lds
    v_mfma_f32_16x16x32_bf16 v[208:211], v[60:63], a[36:39], v[208:211]
    ds_read_b128 a[76:79], v23 offset:51200
    v_mfma_f32_16x16x32_bf16 v[212:215], v[56:59], a[40:43], 0
    v_mfma_f32_16x16x32_bf16 v[212:215], v[60:63], a[44:47], v[212:215]
    v_mfma_f32_16x16x32_bf16 v[216:219], v[56:59], a[48:51], 0
    buffer_load_dwordx4 v9, s[8:11], s61 offen offset:3072 lds
    v_mfma_f32_16x16x32_bf16 v[216:219], v[60:63], a[52:55], v[216:219]
    ds_read_b128 a[80:83], v22 offset:53248
    v_mfma_f32_16x16x32_bf16 v[220:223], v[56:59], a[56:59], 0
    s_xor_b32 s61, s61, 128
    v_mfma_f32_16x16x32_bf16 v[220:223], v[60:63], a[60:63], v[220:223]
    s_add_u32 m0, s69, 131072
    s_waitcnt lgkmcnt(1)
    v_mfma_f32_16x16x32_bf16 v[224:227], v[40:43], a[0:3], 0
    buffer_load_dwordx4 v2, s[16:19], s60 offen nt lds
    v_mfma_f32_16x16x32_bf16 v[224:227], v[44:47], a[4:7], v[224:227]
    ds_read_b128 a[84:87], v23 offset:53248
    v_mfma_f32_16x16x32_bf16 v[228:231], v[40:43], a[8:11], 0
    buffer_load_dword v104, v103, s[20:23], s77 offen
    v_mfma_f32_16x16x32_bf16 v[228:231], v[44:47], a[12:15], v[228:231]
    s_add_u32 s77, s77, 4608
    v_mfma_f32_16x16x32_bf16 v[232:235], v[40:43], a[16:19], 0
    ds_read_b128 a[88:91], v22 offset:55296
    v_mfma_f32_16x16x32_bf16 v[232:235], v[44:47], a[20:23], v[232:235]
    s_waitcnt vmcnt(10)
    s_barrier
    ds_read_b64_tr_b16 v[48:49], v14 offset:0
    v_mfma_f32_16x16x32_bf16 v[236:239], v[40:43], a[24:27], 0
    buffer_load_dwordx4 v3, s[16:19], s60 offen offset:1024 nt lds
    v_mfma_f32_16x16x32_bf16 v[236:239], v[44:47], a[28:31], v[236:239]
    ds_read_b64_tr_b16 v[50:51], v14 offset:1024
    ds_read_b64_tr_b16 v[52:53], v14 offset:8192
    v_mfma_f32_16x16x32_bf16 v[240:243], v[40:43], a[32:35], 0
    ds_read_b64_tr_b16 v[54:55], v14 offset:9216
    ds_read_b128 a[92:95], v23 offset:55296
    v_mfma_f32_16x16x32_bf16 v[240:243], v[44:47], a[36:39], v[240:243]
    buffer_load_dwordx4 v4, s[16:19], s60 offen offset:2048 nt lds
    v_mfma_f32_16x16x32_bf16 v[244:247], v[40:43], a[40:43], 0
    ds_read_b64_tr_b16 v[56:57], v15 offset:0
    ds_read_b64_tr_b16 v[58:59], v15 offset:1024
    v_mfma_f32_16x16x32_bf16 v[244:247], v[44:47], a[44:47], v[244:247]
    ds_read_b64_tr_b16 v[60:61], v15 offset:8192
    ds_read_b64_tr_b16 v[62:63], v15 offset:9216
    v_mfma_f32_16x16x32_bf16 v[248:251], v[40:43], a[48:51], 0
    v_mfma_f32_16x16x32_bf16 v[248:251], v[44:47], a[52:55], v[248:251]
    buffer_load_dwordx4 v5, s[16:19], s60 offen offset:3072 nt lds
    v_mfma_f32_16x16x32_bf16 v[252:255], v[40:43], a[56:59], 0
    ds_read_b64_tr_b16 v[40:41], v16 offset:0
    ds_read_b64_tr_b16 v[42:43], v16 offset:1024
    v_mfma_f32_16x16x32_bf16 v[252:255], v[44:47], a[60:63], v[252:255]
    s_waitcnt lgkmcnt(4)
    ds_read_b64_tr_b16 v[44:45], v16 offset:8192
    ds_read_b64_tr_b16 v[46:47], v16 offset:9216
    v_mfma_f32_16x16x32_bf16 a[128:131], a[0:3], v[48:51], 0
    v_mfma_f32_16x16x32_bf16 a[128:131], a[4:7], v[52:55], a[128:131]
    s_add_u32 m0, s69, 147456
    v_add_u32 v22, 0x10000, v22
    v_mfma_f32_16x16x32_bf16 a[132:135], a[8:11], v[48:51], 0
    s_xor_b32 s60, s60, 1572864
    buffer_load_dwordx4 v6, s[8:11], s62 offen lds
    v_mfma_f32_16x16x32_bf16 a[132:135], a[12:15], v[52:55], a[132:135]
    ds_read_b128 a[96:99], v22 offset:16384
    v_mfma_f32_16x16x32_bf16 a[136:139], a[16:19], v[48:51], 0
    v_mfma_f32_16x16x32_bf16 a[136:139], a[20:23], v[52:55], a[136:139]
    v_mfma_f32_16x16x32_bf16 a[140:143], a[24:27], v[48:51], 0
    buffer_load_dwordx4 v7, s[8:11], s62 offen offset:1024 lds
    v_mfma_f32_16x16x32_bf16 a[140:143], a[28:31], v[52:55], a[140:143]
    v_add_u32 v23, 0x10000, v23
    ds_read_b128 a[100:103], v23 offset:16384
    v_mfma_f32_16x16x32_bf16 a[144:147], a[32:35], v[48:51], 0
    v_mfma_f32_16x16x32_bf16 a[144:147], a[36:39], v[52:55], a[144:147]
    v_mfma_f32_16x16x32_bf16 a[148:151], a[40:43], v[48:51], 0
    v_mfma_f32_16x16x32_bf16 a[148:151], a[44:47], v[52:55], a[148:151]
    buffer_load_dwordx4 v8, s[8:11], s62 offen offset:2048 lds
    v_mfma_f32_16x16x32_bf16 a[152:155], a[48:51], v[48:51], 0
    v_mfma_f32_16x16x32_bf16 a[152:155], a[52:55], v[52:55], a[152:155]
    ds_read_b128 a[104:107], v22 offset:18432
    v_mfma_f32_16x16x32_bf16 a[156:159], a[56:59], v[48:51], 0
    ds_read_b64_tr_b16 v[48:49], v17 offset:0
    ds_read_b64_tr_b16 v[50:51], v17 offset:1024
    v_mfma_f32_16x16x32_bf16 a[156:159], a[60:63], v[52:55], a[156:159]
    buffer_load_dwordx4 v9, s[8:11], s62 offen offset:3072 lds
    v_mfma_f32_16x16x32_bf16 a[160:163], a[0:3], v[56:59], 0
    s_waitcnt lgkmcnt(3)
    ds_read_b64_tr_b16 v[52:53], v17 offset:8192
    ds_read_b64_tr_b16 v[54:55], v17 offset:9216
    v_mfma_f32_16x16x32_bf16 a[160:163], a[4:7], v[60:63], a[160:163]
    v_mfma_f32_16x16x32_bf16 a[164:167], a[8:11], v[56:59], 0
    ds_read_b128 a[108:111], v23 offset:18432
    v_mfma_f32_16x16x32_bf16 a[164:167], a[12:15], v[60:63], a[164:167]
    s_add_u32 m0, s69, 0
    v_mfma_f32_16x16x32_bf16 a[168:171], a[16:19], v[56:59], 0
    s_xor_b32 s62, s62, 128
    buffer_load_dwordx4 v2, s[12:15], s60 offen nt lds
    v_mfma_f32_16x16x32_bf16 a[168:171], a[20:23], v[60:63], a[168:171]
    v_mfma_f32_16x16x32_bf16 a[172:175], a[24:27], v[56:59], 0
    v_mfma_f32_16x16x32_bf16 a[172:175], a[28:31], v[60:63], a[172:175]
    v_mfma_f32_16x16x32_bf16 a[176:179], a[32:35], v[56:59], 0
    buffer_load_dwordx4 v3, s[12:15], s60 offen offset:1024 nt lds
    v_mfma_f32_16x16x32_bf16 a[176:179], a[36:39], v[60:63], a[176:179]
    ds_read_b128 a[112:115], v22 offset:20480
    v_mfma_f32_16x16x32_bf16 a[180:183], a[40:43], v[56:59], 0
    v_mfma_f32_16x16x32_bf16 a[180:183], a[44:47], v[60:63], a[180:183]
    v_mfma_f32_16x16x32_bf16 a[184:187], a[48:51], v[56:59], 0
    v_mfma_f32_16x16x32_bf16 a[184:187], a[52:55], v[60:63], a[184:187]
    buffer_load_dwordx4 v4, s[12:15], s60 offen offset:2048 nt lds
    v_mfma_f32_16x16x32_bf16 a[188:191], a[56:59], v[56:59], 0
    ds_read_b128 a[116:119], v23 offset:20480
    v_mfma_f32_16x16x32_bf16 a[188:191], a[60:63], v[60:63], a[188:191]
    v_mfma_f32_16x16x32_bf16 a[192:195], a[0:3], v[40:43], 0
    v_mfma_f32_16x16x32_bf16 a[192:195], a[4:7], v[44:47], a[192:195]
    buffer_load_dwordx4 v5, s[12:15], s60 offen offset:3072 nt lds
    v_mfma_f32_16x16x32_bf16 a[196:199], a[8:11], v[40:43], 0
    v_mfma_f32_16x16x32_bf16 a[196:199], a[12:15], v[44:47], a[196:199]
    ds_read_b128 a[120:123], v22 offset:22528
    v_mfma_f32_16x16x32_bf16 a[200:203], a[16:19], v[40:43], 0
    v_mfma_f32_16x16x32_bf16 a[200:203], a[20:23], v[44:47], a[200:203]
    s_add_u32 m0, s69, 16384
    v_mfma_f32_16x16x32_bf16 a[204:207], a[24:27], v[40:43], 0
    buffer_load_dwordx4 v6, s[8:11], s61 offen lds
    v_mfma_f32_16x16x32_bf16 a[204:207], a[28:31], v[44:47], a[204:207]
    v_mfma_f32_16x16x32_bf16 a[208:211], a[32:35], v[40:43], 0
    ds_read_b128 a[124:127], v23 offset:22528
    v_mfma_f32_16x16x32_bf16 a[208:211], a[36:39], v[44:47], a[208:211]
    v_mfma_f32_16x16x32_bf16 a[212:215], a[40:43], v[40:43], 0
    buffer_load_dwordx4 v7, s[8:11], s61 offen offset:1024 lds
    v_mfma_f32_16x16x32_bf16 a[212:215], a[44:47], v[44:47], a[212:215]
    v_mfma_f32_16x16x32_bf16 a[216:219], a[48:51], v[40:43], 0
    v_mfma_f32_16x16x32_bf16 a[216:219], a[52:55], v[44:47], a[216:219]
    v_mfma_f32_16x16x32_bf16 a[220:223], a[56:59], v[40:43], 0
    buffer_load_dwordx2 v[80:81], v75, s[28:31], s98 offen nt
    v_mfma_f32_16x16x32_bf16 a[220:223], a[60:63], v[44:47], a[220:223]
    s_waitcnt lgkmcnt(0)
    buffer_load_dwordx4 v8, s[8:11], s61 offen offset:2048 lds
    v_mfma_f32_16x16x32_bf16 a[224:227], a[0:3], v[48:51], 0
    v_mfma_f32_16x16x32_bf16 a[224:227], a[4:7], v[52:55], a[224:227]
    v_mfma_f32_16x16x32_bf16 a[228:231], a[8:11], v[48:51], 0
    v_mfma_f32_16x16x32_bf16 a[228:231], a[12:15], v[52:55], a[228:231]
    buffer_load_dwordx4 v9, s[8:11], s61 offen offset:3072 lds
    v_mfma_f32_16x16x32_bf16 a[232:235], a[16:19], v[48:51], 0
    v_mfma_f32_16x16x32_bf16 a[232:235], a[20:23], v[52:55], a[232:235]
    s_waitcnt vmcnt(9) lgkmcnt(0)
    s_barrier
    ds_read_b64_tr_b16 v[56:57], v14 offset:32768
    v_mfma_f32_16x16x32_bf16 a[236:239], a[24:27], v[48:51], 0
    s_add_u32 m0, s69, 32768
    buffer_load_dwordx2 v[82:83], v77, s[28:31], s98 offen nt
    v_mfma_f32_16x16x32_bf16 a[236:239], a[28:31], v[52:55], a[236:239]
    s_xor_b32 s61, s61, 896
    ds_read_b64_tr_b16 v[58:59], v14 offset:33792
    ds_read_b64_tr_b16 v[60:61], v14 offset:40960
    v_mfma_f32_16x16x32_bf16 a[240:243], a[32:35], v[48:51], 0
    ds_read_b64_tr_b16 v[62:63], v14 offset:41984
    ds_read_b64_tr_b16 v[40:41], v15 offset:32768
    v_mfma_f32_16x16x32_bf16 a[240:243], a[36:39], v[52:55], a[240:243]
    ds_read_b64_tr_b16 v[42:43], v15 offset:33792
    ds_read_b64_tr_b16 v[44:45], v15 offset:40960
    v_mfma_f32_16x16x32_bf16 a[244:247], a[40:43], v[48:51], 0
    buffer_load_dwordx4 v2, s[16:19], s60 offen nt lds
    v_mfma_f32_16x16x32_bf16 a[244:247], a[44:47], v[52:55], a[244:247]
    ds_read_b64_tr_b16 v[46:47], v15 offset:41984
    v_add_u32 v14, 0x10000, v14
    v_mfma_f32_16x16x32_bf16 a[248:251], a[48:51], v[48:51], 0
    v_add_u32 v15, 0x10000, v15
    v_mfma_f32_16x16x32_bf16 a[248:251], a[52:55], v[52:55], a[248:251]
    v_mfma_f32_16x16x32_bf16 a[252:255], a[56:59], v[48:51], 0
    s_add_u32 s98, s98, 3456
    buffer_load_ushort v92, v65, s[32:35], s99 offen offset:0
    v_mfma_f32_16x16x32_bf16 a[252:255], a[60:63], v[52:55], a[252:255]
    s_waitcnt lgkmcnt(1)
    ds_read_b64_tr_b16 v[48:49], v16 offset:32768
    ds_read_b64_tr_b16 v[50:51], v16 offset:33792
    v_mfma_f32_16x16x32_bf16 v[128:131], v[56:59], a[64:67], v[128:131]
    ds_read_b64_tr_b16 v[52:53], v16 offset:40960
    ds_read_b64_tr_b16 v[54:55], v16 offset:41984
    v_mfma_f32_16x16x32_bf16 v[128:131], v[60:63], a[68:71], v[128:131]
    v_add_u32 v16, 0x10000, v16
    v_mfma_f32_16x16x32_bf16 v[132:135], v[56:59], a[72:75], v[132:135]
    buffer_load_dwordx4 v3, s[16:19], s60 offen offset:1024 nt lds
    v_mfma_f32_16x16x32_bf16 v[132:135], v[60:63], a[76:79], v[132:135]
    ds_read_b128 a[0:3], v22 offset:49152
    v_mfma_f32_16x16x32_bf16 v[136:139], v[56:59], a[80:83], v[136:139]
    v_mfma_f32_16x16x32_bf16 v[136:139], v[60:63], a[84:87], v[136:139]
    v_mfma_f32_16x16x32_bf16 v[140:143], v[56:59], a[88:91], v[140:143]
    buffer_load_dwordx2 v[84:85], v75, s[28:31], s98 offen nt
    v_mfma_f32_16x16x32_bf16 v[140:143], v[60:63], a[92:95], v[140:143]
    ds_read_b128 a[4:7], v23 offset:49152
    v_mfma_f32_16x16x32_bf16 v[144:147], v[56:59], a[96:99], v[144:147]
    v_mfma_f32_16x16x32_bf16 v[144:147], v[60:63], a[100:103], v[144:147]
    v_mfma_f32_16x16x32_bf16 v[148:151], v[56:59], a[104:107], v[148:151]
    buffer_load_dwordx4 v4, s[16:19], s60 offen offset:2048 nt lds
    v_mfma_f32_16x16x32_bf16 v[148:151], v[60:63], a[108:111], v[148:151]
    v_mfma_f32_16x16x32_bf16 v[152:155], v[56:59], a[112:115], v[152:155]
    v_mfma_f32_16x16x32_bf16 v[152:155], v[60:63], a[116:119], v[152:155]
    ds_read_b128 a[8:11], v22 offset:51200
    v_mfma_f32_16x16x32_bf16 v[156:159], v[56:59], a[120:123], v[156:159]
    buffer_load_dwordx2 v[86:87], v77, s[28:31], s98 offen nt
    v_mfma_f32_16x16x32_bf16 v[156:159], v[60:63], a[124:127], v[156:159]
    ds_read_b64_tr_b16 v[56:57], v17 offset:32768
    ds_read_b64_tr_b16 v[58:59], v17 offset:33792
    v_mfma_f32_16x16x32_bf16 v[160:163], v[40:43], a[64:67], v[160:163]
    s_add_u32 s98, s98, 3456
    ds_read_b64_tr_b16 v[60:61], v17 offset:40960
    ds_read_b64_tr_b16 v[62:63], v17 offset:41984
    s_waitcnt lgkmcnt(5)
    v_mfma_f32_16x16x32_bf16 v[160:163], v[44:47], a[68:71], v[160:163]
    v_add_u32 v17, 0x10000, v17
    v_mfma_f32_16x16x32_bf16 v[164:167], v[40:43], a[72:75], v[164:167]
    buffer_load_ushort v93, v65, s[32:35], s99 offen offset:2
    v_mfma_f32_16x16x32_bf16 v[164:167], v[44:47], a[76:79], v[164:167]
    ds_read_b128 a[12:15], v23 offset:51200
    v_mfma_f32_16x16x32_bf16 v[168:171], v[40:43], a[80:83], v[168:171]
    v_mfma_f32_16x16x32_bf16 v[168:171], v[44:47], a[84:87], v[168:171]
    v_mfma_f32_16x16x32_bf16 v[172:175], v[40:43], a[88:91], v[172:175]
    buffer_load_dwordx4 v5, s[16:19], s60 offen offset:3072 nt lds
    v_mfma_f32_16x16x32_bf16 v[172:175], v[44:47], a[92:95], v[172:175]
    s_add_u32 m0, s69, 49152
    s_xor_b32 s60, s60, 524288
    v_mfma_f32_16x16x32_bf16 v[176:179], v[40:43], a[96:99], v[176:179]
    ds_read_b128 a[16:19], v22 offset:53248
    v_mfma_f32_16x16x32_bf16 v[176:179], v[44:47], a[100:103], v[176:179]
    v_mfma_f32_16x16x32_bf16 v[180:183], v[40:43], a[104:107], v[180:183]
    buffer_load_dwordx2 v[88:89], v75, s[28:31], s98 offen nt
    v_mfma_f32_16x16x32_bf16 v[180:183], v[44:47], a[108:111], v[180:183]
    v_mfma_f32_16x16x32_bf16 v[184:187], v[40:43], a[112:115], v[184:187]
    v_mfma_f32_16x16x32_bf16 v[184:187], v[44:47], a[116:119], v[184:187]
    ds_read_b128 a[20:23], v23 offset:53248
    v_mfma_f32_16x16x32_bf16 v[188:191], v[40:43], a[120:123], v[188:191]
    buffer_load_dwordx4 v6, s[8:11], s62 offen lds
    v_mfma_f32_16x16x32_bf16 v[188:191], v[44:47], a[124:127], v[188:191]
    ds_read_b64_tr_b16 v[40:41], v14 offset:0
    ds_read_b64_tr_b16 v[42:43], v14 offset:1024
    v_mfma_f32_16x16x32_bf16 v[192:195], v[48:51], a[64:67], v[192:195]
    ds_read_b64_tr_b16 v[44:45], v14 offset:8192
    ds_read_b64_tr_b16 v[46:47], v14 offset:9216
    v_mfma_f32_16x16x32_bf16 v[192:195], v[52:55], a[68:71], v[192:195]
    v_add_u32 v14, 0xfffe0000, v14
    v_mfma_f32_16x16x32_bf16 v[196:199], v[48:51], a[72:75], v[196:199]
    buffer_load_dword v105, v103, s[20:23], s77 offen
    v_mfma_f32_16x16x32_bf16 v[196:199], v[52:55], a[76:79], v[196:199]
    s_mul_i32 s77, s2, 18432
    ds_read_b128 a[24:27], v22 offset:55296
    v_mfma_f32_16x16x32_bf16 v[200:203], v[48:51], a[80:83], v[200:203]
    s_add_u32 s77, s77, s76
    v_mfma_f32_16x16x32_bf16 v[200:203], v[52:55], a[84:87], v[200:203]
    s_mov_b32 s76, 0
    v_mfma_f32_16x16x32_bf16 v[204:207], v[48:51], a[88:91], v[204:207]
    buffer_load_dwordx2 v[90:91], v77, s[28:31], s98 offen nt
    v_mfma_f32_16x16x32_bf16 v[204:207], v[52:55], a[92:95], v[204:207]
    s_add_u32 s98, s98, 3456
    s_add_u32 s28, s56, 6291456
    s_addc_u32 s29, s57, 0
    v_mfma_f32_16x16x32_bf16 v[208:211], v[48:51], a[96:99], v[208:211]
    s_mov_b32 s30, 2359296
    ds_read_b128 a[28:31], v23 offset:55296
    v_mfma_f32_16x16x32_bf16 v[208:211], v[52:55], a[100:103], v[208:211]
    s_bfe_u32 s98, s72, 0x10001
    v_mfma_f32_16x16x32_bf16 v[212:215], v[48:51], a[104:107], v[212:215]
    buffer_load_dwordx4 v7, s[8:11], s62 offen offset:1024 lds
    v_mfma_f32_16x16x32_bf16 v[212:215], v[52:55], a[108:111], v[212:215]
    v_mfma_f32_16x16x32_bf16 v[216:219], v[48:51], a[112:115], v[216:219]
    v_mfma_f32_16x16x32_bf16 v[216:219], v[52:55], a[116:119], v[216:219]
    v_mfma_f32_16x16x32_bf16 v[220:223], v[48:51], a[120:123], v[220:223]
    buffer_load_ushort v94, v65, s[32:35], s99 offen offset:4
    v_mfma_f32_16x16x32_bf16 v[220:223], v[52:55], a[124:127], v[220:223]
    s_add_u32 s32, s56, 9437184
    s_addc_u32 s33, s57, 0
    s_mov_b32 s34, 196608
    s_waitcnt lgkmcnt(0)
    v_mfma_f32_16x16x32_bf16 v[224:227], v[56:59], a[64:67], v[224:227]
    s_bfe_u32 s99, s72, 0x10003
    ds_read_b64_tr_b16 v[48:49], v15 offset:0
    ds_read_b64_tr_b16 v[50:51], v15 offset:1024
    v_mfma_f32_16x16x32_bf16 v[224:227], v[60:63], a[68:71], v[224:227]
    s_lshl1_add_u32 s98, s99, s98
    ds_read_b64_tr_b16 v[52:53], v15 offset:8192
    ds_read_b64_tr_b16 v[54:55], v15 offset:9216
    v_mfma_f32_16x16x32_bf16 v[228:231], v[56:59], a[72:75], v[228:231]
    s_lshl_b32 s98, s98, 5
    buffer_load_dwordx4 v8, s[8:11], s62 offen offset:2048 lds
    v_mfma_f32_16x16x32_bf16 v[228:231], v[60:63], a[76:79], v[228:231]
    s_lshl_b32 s72, s72, 7
    v_add_u32 v15, 0xfffe0000, v15
    v_mfma_f32_16x16x32_bf16 v[232:235], v[56:59], a[80:83], v[232:235]
    v_mfma_f32_16x16x32_bf16 v[232:235], v[60:63], a[84:87], v[232:235]
    v_mfma_f32_16x16x32_bf16 v[236:239], v[56:59], a[88:91], v[236:239]
    buffer_store_dword v65, v64, s[32:35], s101 offen sc1
    v_mfma_f32_16x16x32_bf16 v[236:239], v[60:63], a[92:95], v[236:239]
    v_mfma_f32_16x16x32_bf16 v[240:243], v[56:59], a[96:99], v[240:243]
    v_mfma_f32_16x16x32_bf16 v[240:243], v[60:63], a[100:103], v[240:243]
    v_mfma_f32_16x16x32_bf16 v[244:247], v[56:59], a[104:107], v[244:247]
    buffer_load_dwordx4 v9, s[8:11], s62 offen offset:3072 lds
    v_mfma_f32_16x16x32_bf16 v[244:247], v[60:63], a[108:111], v[244:247]
    s_xor_b32 s62, s62, 896
    s_add_u32 m0, s69, 65536
    v_mfma_f32_16x16x32_bf16 v[248:251], v[56:59], a[112:115], v[248:251]
    v_mfma_f32_16x16x32_bf16 v[248:251], v[60:63], a[116:119], v[248:251]
    v_mfma_f32_16x16x32_bf16 v[252:255], v[56:59], a[120:123], v[252:255]
    buffer_load_dwordx4 v2, s[12:15], s60 offen nt lds
    v_mfma_f32_16x16x32_bf16 v[252:255], v[60:63], a[124:127], v[252:255]
    ds_read_b64_tr_b16 v[56:57], v16 offset:0
    ds_read_b64_tr_b16 v[58:59], v16 offset:1024
    v_mfma_f32_16x16x32_bf16 a[128:131], a[64:67], v[40:43], a[128:131]
    ds_read_b64_tr_b16 v[60:61], v16 offset:8192
    ds_read_b64_tr_b16 v[62:63], v16 offset:9216
    v_mfma_f32_16x16x32_bf16 a[128:131], a[68:71], v[44:47], a[128:131]
    v_add_u32 v22, 0x10000, v22
    v_add_u32 v16, 0xfffe0000, v16
    v_mfma_f32_16x16x32_bf16 a[132:135], a[72:75], v[40:43], a[132:135]
    buffer_load_dwordx4 v3, s[12:15], s60 offen offset:1024 nt lds
    v_mfma_f32_16x16x32_bf16 a[132:135], a[76:79], v[44:47], a[132:135]
    ds_read_b128 a[32:35], v22 offset:16384
    v_mfma_f32_16x16x32_bf16 a[136:139], a[80:83], v[40:43], a[136:139]
    s_cmp_lt_u32 s2, 192
    s_cselect_b32 s72, s72, 1073741824
    v_mfma_f32_16x16x32_bf16 a[136:139], a[84:87], v[44:47], a[136:139]
    v_mfma_f32_16x16x32_bf16 a[140:143], a[88:91], v[40:43], a[140:143]
    buffer_load_dwordx4 v4, s[12:15], s60 offen offset:2048 nt lds
    v_mfma_f32_16x16x32_bf16 a[140:143], a[92:95], v[44:47], a[140:143]
    v_add_u32 v23, 0x10000, v23
    ds_read_b128 a[36:39], v23 offset:16384
    v_mfma_f32_16x16x32_bf16 a[144:147], a[96:99], v[40:43], a[144:147]
    v_mfma_f32_16x16x32_bf16 a[144:147], a[100:103], v[44:47], a[144:147]
    v_mfma_f32_16x16x32_bf16 a[148:151], a[104:107], v[40:43], a[148:151]
    v_mfma_f32_16x16x32_bf16 a[148:151], a[108:111], v[44:47], a[148:151]
    v_mfma_f32_16x16x32_bf16 a[152:155], a[112:115], v[40:43], a[152:155]
    buffer_load_dwordx4 v5, s[12:15], s60 offen offset:3072 nt lds
    v_mfma_f32_16x16x32_bf16 a[152:155], a[116:119], v[44:47], a[152:155]
    ds_read_b128 a[40:43], v22 offset:18432
    v_mfma_f32_16x16x32_bf16 a[156:159], a[120:123], v[40:43], a[156:159]
    ds_read_b64_tr_b16 v[40:41], v17 offset:0
    ds_read_b64_tr_b16 v[42:43], v17 offset:1024
    v_mfma_f32_16x16x32_bf16 a[156:159], a[124:127], v[44:47], a[156:159]
    s_waitcnt lgkmcnt(3)
    ds_read_b64_tr_b16 v[44:45], v17 offset:8192
    ds_read_b64_tr_b16 v[46:47], v17 offset:9216
    v_mfma_f32_16x16x32_bf16 a[160:163], a[64:67], v[48:51], a[160:163]
    v_add_u32 v17, 0xfffe0000, v17
    v_mfma_f32_16x16x32_bf16 a[160:163], a[68:71], v[52:55], a[160:163]
    v_mfma_f32_16x16x32_bf16 a[164:167], a[72:75], v[48:51], a[164:167]
    ds_read_b128 a[44:47], v23 offset:18432
    v_mfma_f32_16x16x32_bf16 a[164:167], a[76:79], v[52:55], a[164:167]
    s_add_u32 m0, s69, 81920
    v_mfma_f32_16x16x32_bf16 a[168:171], a[80:83], v[48:51], a[168:171]
    buffer_load_dwordx4 v6, s[8:11], s61 offen lds
    v_mfma_f32_16x16x32_bf16 a[168:171], a[84:87], v[52:55], a[168:171]
    v_mfma_f32_16x16x32_bf16 a[172:175], a[88:91], v[48:51], a[172:175]
    v_mfma_f32_16x16x32_bf16 a[172:175], a[92:95], v[52:55], a[172:175]
    v_mfma_f32_16x16x32_bf16 a[176:179], a[96:99], v[48:51], a[176:179]
    ds_read_b128 a[48:51], v22 offset:20480
    v_mfma_f32_16x16x32_bf16 a[176:179], a[100:103], v[52:55], a[176:179]
    v_mfma_f32_16x16x32_bf16 a[180:183], a[104:107], v[48:51], a[180:183]
    v_mfma_f32_16x16x32_bf16 a[180:183], a[108:111], v[52:55], a[180:183]
    buffer_load_dwordx4 v7, s[8:11], s61 offen offset:1024 lds
    v_mfma_f32_16x16x32_bf16 a[184:187], a[112:115], v[48:51], a[184:187]
    v_mfma_f32_16x16x32_bf16 a[184:187], a[116:119], v[52:55], a[184:187]
    ds_read_b128 a[52:55], v23 offset:20480
    v_mfma_f32_16x16x32_bf16 a[188:191], a[120:123], v[48:51], a[188:191]
    v_mfma_f32_16x16x32_bf16 a[188:191], a[124:127], v[52:55], a[188:191]
    v_mfma_f32_16x16x32_bf16 a[192:195], a[64:67], v[56:59], a[192:195]
    v_mfma_f32_16x16x32_bf16 a[192:195], a[68:71], v[60:63], a[192:195]
    v_mfma_f32_16x16x32_bf16 a[196:199], a[72:75], v[56:59], a[196:199]
    v_mfma_f32_16x16x32_bf16 a[196:199], a[76:79], v[60:63], a[196:199]
    buffer_load_dwordx4 v8, s[8:11], s61 offen offset:2048 lds
    v_mfma_f32_16x16x32_bf16 a[200:203], a[80:83], v[56:59], a[200:203]
    ds_read_b128 a[56:59], v22 offset:22528
    v_mfma_f32_16x16x32_bf16 a[200:203], a[84:87], v[60:63], a[200:203]
    v_mfma_f32_16x16x32_bf16 a[204:207], a[88:91], v[56:59], a[204:207]
    v_mfma_f32_16x16x32_bf16 a[204:207], a[92:95], v[60:63], a[204:207]
    v_mfma_f32_16x16x32_bf16 a[208:211], a[96:99], v[56:59], a[208:211]
    ds_read_b128 a[60:63], v23 offset:22528
    v_mfma_f32_16x16x32_bf16 a[208:211], a[100:103], v[60:63], a[208:211]
    v_mfma_f32_16x16x32_bf16 a[212:215], a[104:107], v[56:59], a[212:215]
    buffer_load_dwordx4 v9, s[8:11], s61 offen offset:3072 lds
    v_mfma_f32_16x16x32_bf16 a[212:215], a[108:111], v[60:63], a[212:215]
    v_mfma_f32_16x16x32_bf16 a[216:219], a[112:115], v[56:59], a[216:219]
    v_mfma_f32_16x16x32_bf16 a[216:219], a[116:119], v[60:63], a[216:219]
    v_mfma_f32_16x16x32_bf16 a[220:223], a[120:123], v[56:59], a[220:223]
    v_mfma_f32_16x16x32_bf16 a[220:223], a[124:127], v[60:63], a[220:223]
    s_waitcnt lgkmcnt(0)
    v_mfma_f32_16x16x32_bf16 a[224:227], a[64:67], v[40:43], a[224:227]
    v_mfma_f32_16x16x32_bf16 a[224:227], a[68:71], v[44:47], a[224:227]
    s_xor_b32 s61, s61, 128
    v_mfma_f32_16x16x32_bf16 a[228:231], a[72:75], v[40:43], a[228:231]
    v_mfma_f32_16x16x32_bf16 a[228:231], a[76:79], v[44:47], a[228:231]
    v_mfma_f32_16x16x32_bf16 a[232:235], a[80:83], v[40:43], a[232:235]
    v_mfma_f32_16x16x32_bf16 a[232:235], a[84:87], v[44:47], a[232:235]
    s_waitcnt vmcnt(8) lgkmcnt(0)
    s_barrier
    ds_read_b64_tr_b16 v[48:49], v14 offset:0
    v_mfma_f32_16x16x32_bf16 a[236:239], a[88:91], v[40:43], a[236:239]
    s_add_u32 m0, s69, 98304
    ds_read_b64_tr_b16 v[50:51], v14 offset:1024
    ds_read_b64_tr_b16 v[52:53], v14 offset:8192
    v_mfma_f32_16x16x32_bf16 a[236:239], a[92:95], v[44:47], a[236:239]
    buffer_load_dwordx4 v2, s[16:19], s60 offen nt lds
    v_mfma_f32_16x16x32_bf16 a[240:243], a[96:99], v[40:43], a[240:243]
    ds_read_b64_tr_b16 v[54:55], v14 offset:9216
    ds_read_b64_tr_b16 v[56:57], v15 offset:0
    v_mfma_f32_16x16x32_bf16 a[240:243], a[100:103], v[44:47], a[240:243]
    ds_read_b64_tr_b16 v[58:59], v15 offset:1024
    ds_read_b64_tr_b16 v[60:61], v15 offset:8192
    v_mfma_f32_16x16x32_bf16 a[244:247], a[104:107], v[40:43], a[244:247]
    ds_read_b64_tr_b16 v[62:63], v15 offset:9216
    v_mfma_f32_16x16x32_bf16 a[244:247], a[108:111], v[44:47], a[244:247]
    v_mfma_f32_16x16x32_bf16 a[248:251], a[112:115], v[40:43], a[248:251]
    v_mfma_f32_16x16x32_bf16 a[248:251], a[116:119], v[44:47], a[248:251]
    buffer_load_dwordx4 v3, s[16:19], s60 offen offset:1024 nt lds
    v_mfma_f32_16x16x32_bf16 a[252:255], a[120:123], v[40:43], a[252:255]
    buffer_load_dword v106, v103, s[24:27], s77 offen
    v_mfma_f32_16x16x32_bf16 a[252:255], a[124:127], v[44:47], a[252:255]
    s_add_u32 s77, s77, 4608
    ds_read_b64_tr_b16 v[40:41], v16 offset:0
    ds_read_b64_tr_b16 v[42:43], v16 offset:1024
    s_waitcnt lgkmcnt(2)
    v_mfma_f32_16x16x32_bf16 v[128:131], v[48:51], a[0:3], v[128:131]
    ds_read_b64_tr_b16 v[44:45], v16 offset:8192
    ds_read_b64_tr_b16 v[46:47], v16 offset:9216
    v_mfma_f32_16x16x32_bf16 v[128:131], v[52:55], a[4:7], v[128:131]
    v_add_u32 v22, 0xfffe0000, v22
    v_mfma_f32_16x16x32_bf16 v[132:135], v[48:51], a[8:11], v[132:135]
    ds_read_b128 a[64:67], v22 offset:16384
    v_mfma_f32_16x16x32_bf16 v[132:135], v[52:55], a[12:15], v[132:135]
    v_mfma_f32_16x16x32_bf16 v[136:139], v[48:51], a[16:19], v[136:139]
    v_mfma_f32_16x16x32_bf16 v[136:139], v[52:55], a[20:23], v[136:139]
    buffer_load_dwordx4 v4, s[16:19], s60 offen offset:2048 nt lds
    v_mfma_f32_16x16x32_bf16 v[140:143], v[48:51], a[24:27], v[140:143]
    v_add_u32 v23, 0xfffe0000, v23
    v_mfma_f32_16x16x32_bf16 v[140:143], v[52:55], a[28:31], v[140:143]
    ds_read_b128 a[68:71], v23 offset:16384
    v_mfma_f32_16x16x32_bf16 v[144:147], v[48:51], a[32:35], v[144:147]
    v_mfma_f32_16x16x32_bf16 v[144:147], v[52:55], a[36:39], v[144:147]
    v_mfma_f32_16x16x32_bf16 v[148:151], v[48:51], a[40:43], v[148:151]
    v_mfma_f32_16x16x32_bf16 v[148:151], v[52:55], a[44:47], v[148:151]
    v_mfma_f32_16x16x32_bf16 v[152:155], v[48:51], a[48:51], v[152:155]
    buffer_load_dwordx4 v5, s[16:19], s60 offen offset:3072 nt lds
    v_mfma_f32_16x16x32_bf16 v[152:155], v[52:55], a[52:55], v[152:155]
    ds_read_b128 a[72:75], v22 offset:18432
    v_mfma_f32_16x16x32_bf16 v[156:159], v[48:51], a[56:59], v[156:159]
    ds_read_b64_tr_b16 v[48:49], v17 offset:0
    ds_read_b64_tr_b16 v[50:51], v17 offset:1024
    v_mfma_f32_16x16x32_bf16 v[156:159], v[52:55], a[60:63], v[156:159]
    ds_read_b64_tr_b16 v[52:53], v17 offset:8192
    ds_read_b64_tr_b16 v[54:55], v17 offset:9216
    v_mfma_f32_16x16x32_bf16 v[160:163], v[56:59], a[0:3], v[160:163]
    v_mfma_f32_16x16x32_bf16 v[160:163], v[60:63], a[4:7], v[160:163]
    v_mfma_f32_16x16x32_bf16 v[164:167], v[56:59], a[8:11], v[164:167]
    ds_read_b128 a[76:79], v23 offset:18432
    v_mfma_f32_16x16x32_bf16 v[164:167], v[60:63], a[12:15], v[164:167]
    s_add_u32 m0, s69, 114688
    v_mfma_f32_16x16x32_bf16 v[168:171], v[56:59], a[16:19], v[168:171]
    s_xor_b32 s60, s60, 3670016
    buffer_load_dwordx4 v6, s[8:11], s62 offen lds
    v_mfma_f32_16x16x32_bf16 v[168:171], v[60:63], a[20:23], v[168:171]
    v_mfma_f32_16x16x32_bf16 v[172:175], v[56:59], a[24:27], v[172:175]
    v_mfma_f32_16x16x32_bf16 v[172:175], v[60:63], a[28:31], v[172:175]
    v_mfma_f32_16x16x32_bf16 v[176:179], v[56:59], a[32:35], v[176:179]
    ds_read_b128 a[80:83], v22 offset:20480
    v_mfma_f32_16x16x32_bf16 v[176:179], v[60:63], a[36:39], v[176:179]
    v_mfma_f32_16x16x32_bf16 v[180:183], v[56:59], a[40:43], v[180:183]
    v_mfma_f32_16x16x32_bf16 v[180:183], v[60:63], a[44:47], v[180:183]
    buffer_load_dwordx4 v7, s[8:11], s62 offen offset:1024 lds
    v_mfma_f32_16x16x32_bf16 v[184:187], v[56:59], a[48:51], v[184:187]
    v_mfma_f32_16x16x32_bf16 v[184:187], v[60:63], a[52:55], v[184:187]
    ds_read_b128 a[84:87], v23 offset:20480
    v_mfma_f32_16x16x32_bf16 v[188:191], v[56:59], a[56:59], v[188:191]
    s_waitcnt lgkmcnt(1)
    ds_read_b64_tr_b16 v[56:57], v14 offset:32768
    ds_read_b64_tr_b16 v[58:59], v14 offset:33792
    v_mfma_f32_16x16x32_bf16 v[188:191], v[60:63], a[60:63], v[188:191]
    ds_read_b64_tr_b16 v[60:61], v14 offset:40960
    ds_read_b64_tr_b16 v[62:63], v14 offset:41984
    v_mfma_f32_16x16x32_bf16 v[192:195], v[40:43], a[0:3], v[192:195]
    v_add_u32 v14, 0x10000, v14
    v_mfma_f32_16x16x32_bf16 v[192:195], v[44:47], a[4:7], v[192:195]
    v_mfma_f32_16x16x32_bf16 v[196:199], v[40:43], a[8:11], v[196:199]
    v_mfma_f32_16x16x32_bf16 v[196:199], v[44:47], a[12:15], v[196:199]
    buffer_load_dwordx4 v8, s[8:11], s62 offen offset:2048 lds
    v_mfma_f32_16x16x32_bf16 v[200:203], v[40:43], a[16:19], v[200:203]
    ds_read_b128 a[88:91], v22 offset:22528
    v_mfma_f32_16x16x32_bf16 v[200:203], v[44:47], a[20:23], v[200:203]
    v_mfma_f32_16x16x32_bf16 v[204:207], v[40:43], a[24:27], v[204:207]
    v_mfma_f32_16x16x32_bf16 v[204:207], v[44:47], a[28:31], v[204:207]
    v_mfma_f32_16x16x32_bf16 v[208:211], v[40:43], a[32:35], v[208:211]
    ds_read_b128 a[92:95], v23 offset:22528
    v_mfma_f32_16x16x32_bf16 v[208:211], v[44:47], a[36:39], v[208:211]
    v_mfma_f32_16x16x32_bf16 v[212:215], v[40:43], a[40:43], v[212:215]
    buffer_load_dwordx4 v9, s[8:11], s62 offen offset:3072 lds
    v_mfma_f32_16x16x32_bf16 v[212:215], v[44:47], a[44:47], v[212:215]
    v_mfma_f32_16x16x32_bf16 v[216:219], v[40:43], a[48:51], v[216:219]
    v_mfma_f32_16x16x32_bf16 v[216:219], v[44:47], a[52:55], v[216:219]
    v_mfma_f32_16x16x32_bf16 v[220:223], v[40:43], a[56:59], v[220:223]
    ds_read_b64_tr_b16 v[40:41], v15 offset:32768
    ds_read_b64_tr_b16 v[42:43], v15 offset:33792
    v_mfma_f32_16x16x32_bf16 v[220:223], v[44:47], a[60:63], v[220:223]
    ds_read_b64_tr_b16 v[44:45], v15 offset:40960
    ds_read_b64_tr_b16 v[46:47], v15 offset:41984
    v_mfma_f32_16x16x32_bf16 v[224:227], v[48:51], a[0:3], v[224:227]
    v_add_u32 v15, 0x10000, v15
    v_mfma_f32_16x16x32_bf16 v[224:227], v[52:55], a[4:7], v[224:227]
    s_xor_b32 s62, s62, 128
    v_mfma_f32_16x16x32_bf16 v[228:231], v[48:51], a[8:11], v[228:231]
    v_mfma_f32_16x16x32_bf16 v[228:231], v[52:55], a[12:15], v[228:231]
    v_mfma_f32_16x16x32_bf16 v[232:235], v[48:51], a[16:19], v[232:235]
    v_mfma_f32_16x16x32_bf16 v[232:235], v[52:55], a[20:23], v[232:235]
    s_add_u32 m0, s69, 131072
    v_mfma_f32_16x16x32_bf16 v[236:239], v[48:51], a[24:27], v[236:239]
    buffer_load_dwordx4 v2, s[12:15], s60 offen nt lds
    v_mfma_f32_16x16x32_bf16 v[236:239], v[52:55], a[28:31], v[236:239]
    v_mfma_f32_16x16x32_bf16 v[240:243], v[48:51], a[32:35], v[240:243]
    v_mfma_f32_16x16x32_bf16 v[240:243], v[52:55], a[36:39], v[240:243]
    v_mfma_f32_16x16x32_bf16 v[244:247], v[48:51], a[40:43], v[244:247]
    v_mfma_f32_16x16x32_bf16 v[244:247], v[52:55], a[44:47], v[244:247]
    v_mfma_f32_16x16x32_bf16 v[248:251], v[48:51], a[48:51], v[248:251]
    v_mfma_f32_16x16x32_bf16 v[248:251], v[52:55], a[52:55], v[248:251]
    buffer_load_dwordx4 v3, s[12:15], s60 offen offset:1024 nt lds
    v_mfma_f32_16x16x32_bf16 v[252:255], v[48:51], a[56:59], v[252:255]
    ds_read_b64_tr_b16 v[48:49], v16 offset:32768
    ds_read_b64_tr_b16 v[50:51], v16 offset:33792
    v_mfma_f32_16x16x32_bf16 v[252:255], v[52:55], a[60:63], v[252:255]
    s_waitcnt lgkmcnt(2)
    ds_read_b64_tr_b16 v[52:53], v16 offset:40960
    ds_read_b64_tr_b16 v[54:55], v16 offset:41984
    v_mfma_f32_16x16x32_bf16 a[128:131], a[0:3], v[56:59], a[128:131]
    v_add_u32 v16, 0x10000, v16
    v_mfma_f32_16x16x32_bf16 a[128:131], a[4:7], v[60:63], a[128:131]
    v_mfma_f32_16x16x32_bf16 a[132:135], a[8:11], v[56:59], a[132:135]
    ds_read_b128 a[96:99], v22 offset:49152
    v_mfma_f32_16x16x32_bf16 a[132:135], a[12:15], v[60:63], a[132:135]
    v_mfma_f32_16x16x32_bf16 a[136:139], a[16:19], v[56:59], a[136:139]
    v_mfma_f32_16x16x32_bf16 a[136:139], a[20:23], v[60:63], a[136:139]
    buffer_load_dwordx4 v4, s[12:15], s60 offen offset:2048 nt lds
    v_mfma_f32_16x16x32_bf16 a[140:143], a[24:27], v[56:59], a[140:143]
    v_mfma_f32_16x16x32_bf16 a[140:143], a[28:31], v[60:63], a[140:143]
    ds_read_b128 a[100:103], v23 offset:49152
    v_mfma_f32_16x16x32_bf16 a[144:147], a[32:35], v[56:59], a[144:147]
    v_mfma_f32_16x16x32_bf16 a[144:147], a[36:39], v[60:63], a[144:147]
    v_mfma_f32_16x16x32_bf16 a[148:151], a[40:43], v[56:59], a[148:151]
    v_mfma_f32_16x16x32_bf16 a[148:151], a[44:47], v[60:63], a[148:151]
    v_mfma_f32_16x16x32_bf16 a[152:155], a[48:51], v[56:59], a[152:155]
    buffer_load_dwordx4 v5, s[12:15], s60 offen offset:3072 nt lds
    v_mfma_f32_16x16x32_bf16 a[152:155], a[52:55], v[60:63], a[152:155]
    ds_read_b128 a[104:107], v22 offset:51200
    v_mfma_f32_16x16x32_bf16 a[156:159], a[56:59], v[56:59], a[156:159]
    ds_read_b64_tr_b16 v[56:57], v17 offset:32768
    ds_read_b64_tr_b16 v[58:59], v17 offset:33792
    v_mfma_f32_16x16x32_bf16 a[156:159], a[60:63], v[60:63], a[156:159]
    ds_read_b64_tr_b16 v[60:61], v17 offset:40960
    ds_read_b64_tr_b16 v[62:63], v17 offset:41984
    v_mfma_f32_16x16x32_bf16 a[160:163], a[0:3], v[40:43], a[160:163]
    v_add_u32 v17, 0x10000, v17
    v_mfma_f32_16x16x32_bf16 a[160:163], a[4:7], v[44:47], a[160:163]
    v_mfma_f32_16x16x32_bf16 a[164:167], a[8:11], v[40:43], a[164:167]
    ds_read_b128 a[108:111], v23 offset:51200
    v_mfma_f32_16x16x32_bf16 a[164:167], a[12:15], v[44:47], a[164:167]
    s_add_u32 m0, s69, 147456
    v_mfma_f32_16x16x32_bf16 a[168:171], a[16:19], v[40:43], a[168:171]
    buffer_load_dwordx4 v6, s[8:11], s61 offen lds
    v_mfma_f32_16x16x32_bf16 a[168:171], a[20:23], v[44:47], a[168:171]
    v_mfma_f32_16x16x32_bf16 a[172:175], a[24:27], v[40:43], a[172:175]
    v_mfma_f32_16x16x32_bf16 a[172:175], a[28:31], v[44:47], a[172:175]
    v_mfma_f32_16x16x32_bf16 a[176:179], a[32:35], v[40:43], a[176:179]
    ds_read_b128 a[112:115], v22 offset:53248
    v_mfma_f32_16x16x32_bf16 a[176:179], a[36:39], v[44:47], a[176:179]
    v_mfma_f32_16x16x32_bf16 a[180:183], a[40:43], v[40:43], a[180:183]
    v_mfma_f32_16x16x32_bf16 a[180:183], a[44:47], v[44:47], a[180:183]
    buffer_load_dwordx4 v7, s[8:11], s61 offen offset:1024 lds
    v_mfma_f32_16x16x32_bf16 a[184:187], a[48:51], v[40:43], a[184:187]
    v_mfma_f32_16x16x32_bf16 a[184:187], a[52:55], v[44:47], a[184:187]
    ds_read_b128 a[116:119], v23 offset:53248
    v_mfma_f32_16x16x32_bf16 a[188:191], a[56:59], v[40:43], a[188:191]
    v_mfma_f32_16x16x32_bf16 a[188:191], a[60:63], v[44:47], a[188:191]
    s_waitcnt lgkmcnt(1)
    v_mfma_f32_16x16x32_bf16 a[192:195], a[0:3], v[48:51], a[192:195]
    v_mfma_f32_16x16x32_bf16 a[192:195], a[4:7], v[52:55], a[192:195]
    v_mfma_f32_16x16x32_bf16 a[196:199], a[8:11], v[48:51], a[196:199]
    v_mfma_f32_16x16x32_bf16 a[196:199], a[12:15], v[52:55], a[196:199]
    buffer_load_dwordx4 v8, s[8:11], s61 offen offset:2048 lds
    v_mfma_f32_16x16x32_bf16 a[200:203], a[16:19], v[48:51], a[200:203]
    ds_read_b128 a[120:123], v22 offset:55296
    v_mfma_f32_16x16x32_bf16 a[200:203], a[20:23], v[52:55], a[200:203]
    buffer_load_dword v107, v103, s[24:27], s77 offen
    v_mfma_f32_16x16x32_bf16 a[204:207], a[24:27], v[48:51], a[204:207]
    s_add_u32 s77, s77, 4608
    v_mfma_f32_16x16x32_bf16 a[204:207], a[28:31], v[52:55], a[204:207]
    v_mfma_f32_16x16x32_bf16 a[208:211], a[32:35], v[48:51], a[208:211]
    ds_read_b128 a[124:127], v23 offset:55296
    v_mfma_f32_16x16x32_bf16 a[208:211], a[36:39], v[52:55], a[208:211]
    v_mfma_f32_16x16x32_bf16 a[212:215], a[40:43], v[48:51], a[212:215]
    buffer_load_dwordx4 v9, s[8:11], s61 offen offset:3072 lds
    v_mfma_f32_16x16x32_bf16 a[212:215], a[44:47], v[52:55], a[212:215]
    v_mfma_f32_16x16x32_bf16 a[216:219], a[48:51], v[48:51], a[216:219]
    v_mfma_f32_16x16x32_bf16 a[216:219], a[52:55], v[52:55], a[216:219]
    v_mfma_f32_16x16x32_bf16 a[220:223], a[56:59], v[48:51], a[220:223]
    v_mfma_f32_16x16x32_bf16 a[220:223], a[60:63], v[52:55], a[220:223]
    v_mfma_f32_16x16x32_bf16 a[224:227], a[0:3], v[56:59], a[224:227]
    v_mfma_f32_16x16x32_bf16 a[224:227], a[4:7], v[60:63], a[224:227]
    s_xor_b32 s61, s61, 384
    v_mfma_f32_16x16x32_bf16 a[228:231], a[8:11], v[56:59], a[228:231]
    v_mfma_f32_16x16x32_bf16 a[228:231], a[12:15], v[60:63], a[228:231]
    v_mfma_f32_16x16x32_bf16 a[232:235], a[16:19], v[56:59], a[232:235]
    v_mfma_f32_16x16x32_bf16 a[232:235], a[20:23], v[60:63], a[232:235]
    s_waitcnt vmcnt(9) lgkmcnt(0)
    s_barrier
    ds_read_b64_tr_b16 v[40:41], v14 offset:0
    v_mfma_f32_16x16x32_bf16 a[236:239], a[24:27], v[56:59], a[236:239]
    s_add_u32 m0, s69, 0
    ds_read_b64_tr_b16 v[42:43], v14 offset:1024
    ds_read_b64_tr_b16 v[44:45], v14 offset:8192
    v_mfma_f32_16x16x32_bf16 a[236:239], a[28:31], v[60:63], a[236:239]
    buffer_load_dwordx4 v2, s[16:19], s60 offen nt lds
    v_mfma_f32_16x16x32_bf16 a[240:243], a[32:35], v[56:59], a[240:243]
    ds_read_b64_tr_b16 v[46:47], v14 offset:9216
    v_cndmask_b32_e64 v83, v83, 0, s[92:93]
    v_mfma_f32_16x16x32_bf16 a[240:243], a[36:39], v[60:63], a[240:243]
    v_cndmask_b32_e64 v81, v81, 0, vcc
    v_cndmask_b32 v82, v82, v92, s[92:93]
    v_mfma_f32_16x16x32_bf16 a[244:247], a[40:43], v[56:59], a[244:247]
    s_mov_b32 vcc_lo, 0x10101010
    s_mov_b32 vcc_hi, 0x10101010
    v_cndmask_b32_e64 v83, v83, 0, vcc
    v_mfma_f32_16x16x32_bf16 a[244:247], a[44:47], v[60:63], a[244:247]
    v_xor_b32 v92, s98, v95
    ds_read_b64_tr_b16 v[48:49], v15 offset:0
    v_mfma_f32_16x16x32_bf16 a[248:251], a[48:51], v[56:59], a[248:251]
    buffer_store_dwordx4 v[80:83], v92, s[28:31], s72 offen sc1
    v_mfma_f32_16x16x32_bf16 a[248:251], a[52:55], v[60:63], a[248:251]
    s_mul_i32 s72, s2, 3
    buffer_load_dwordx4 v3, s[16:19], s60 offen offset:1024 nt lds
    v_mfma_f32_16x16x32_bf16 a[252:255], a[56:59], v[56:59], a[252:255]
    s_add_u32 s72, s72, 1
    ds_read_b64_tr_b16 v[50:51], v15 offset:1024
    ds_read_b64_tr_b16 v[52:53], v15 offset:8192
    v_mfma_f32_16x16x32_bf16 a[252:255], a[60:63], v[60:63], a[252:255]
    s_bfe_u32 s98, s72, 0x10001
    ds_read_b64_tr_b16 v[54:55], v15 offset:9216
    v_cndmask_b32_e64 v87, v87, 0, s[92:93]
    s_waitcnt lgkmcnt(4)
    v_mfma_f32_16x16x32_bf16 v[128:131], v[40:43], a[64:67], v[128:131]
    s_bfe_u32 s99, s72, 0x10003
    v_cndmask_b32 v86, v86, v93, s[92:93]
    v_cndmask_b32_e64 v91, v91, 0, s[92:93]
    v_mfma_f32_16x16x32_bf16 v[128:131], v[44:47], a[68:71], v[128:131]
    s_lshl1_add_u32 s98, s99, s98
    v_add_u32 v22, 0x10000, v22
    v_cndmask_b32 v90, v90, v94, s[92:93]
    v_mfma_f32_16x16x32_bf16 v[132:135], v[40:43], a[72:75], v[132:135]
    s_lshl_b32 s98, s98, 5
    ds_read_b128 a[0:3], v22 offset:16384
    v_xor_b32 v93, s98, v95
    v_mfma_f32_16x16x32_bf16 v[132:135], v[44:47], a[76:79], v[132:135]
    s_mov_b32 vcc_lo, 0x84848484
    s_mov_b32 vcc_hi, 0x84848484
    v_cndmask_b32_e64 v85, v85, 0, vcc
    v_mfma_f32_16x16x32_bf16 v[136:139], v[40:43], a[80:83], v[136:139]
    s_mov_b32 vcc_lo, 0x10101010
    s_mov_b32 vcc_hi, 0x10101010
    v_cndmask_b32_e64 v87, v87, 0, vcc
    v_mfma_f32_16x16x32_bf16 v[136:139], v[44:47], a[84:87], v[136:139]
    s_lshl_b32 s72, s72, 7
    buffer_load_dwordx4 v4, s[16:19], s60 offen offset:2048 nt lds
    v_mfma_f32_16x16x32_bf16 v[140:143], v[40:43], a[88:91], v[140:143]
    v_add_u32 v23, 0x10000, v23
    ds_read_b64_tr_b16 v[56:57], v16 offset:0
    v_mfma_f32_16x16x32_bf16 v[140:143], v[44:47], a[92:95], v[140:143]
    ds_read_b128 a[4:7], v23 offset:16384
    ds_read_b64_tr_b16 v[58:59], v16 offset:1024
    v_mfma_f32_16x16x32_bf16 v[144:147], v[40:43], a[96:99], v[144:147]
    s_cmp_lt_u32 s2, 192
    s_cselect_b32 s72, s72, 1073741824
    ds_read_b64_tr_b16 v[60:61], v16 offset:8192
    v_mfma_f32_16x16x32_bf16 v[144:147], v[44:47], a[100:103], v[144:147]
    buffer_store_dwordx4 v[84:87], v93, s[28:31], s72 offen sc1
    v_mfma_f32_16x16x32_bf16 v[148:151], v[40:43], a[104:107], v[148:151]
    s_mul_i32 s72, s2, 3
    ds_read_b64_tr_b16 v[62:63], v16 offset:9216
    v_mfma_f32_16x16x32_bf16 v[148:151], v[44:47], a[108:111], v[148:151]
    s_add_u32 s72, s72, 2
    v_mfma_f32_16x16x32_bf16 v[152:155], v[40:43], a[112:115], v[152:155]
    s_bfe_u32 s98, s72, 0x10001
    buffer_load_dwordx4 v5, s[16:19], s60 offen offset:3072 nt lds
    v_mfma_f32_16x16x32_bf16 v[152:155], v[44:47], a[116:119], v[152:155]
    s_bfe_u32 s99, s72, 0x10003
    ds_read_b128 a[8:11], v22 offset:18432
    v_mfma_f32_16x16x32_bf16 v[156:159], v[40:43], a[120:123], v[156:159]
    s_mov_b32 vcc_lo, 0x84848484
    s_mov_b32 vcc_hi, 0x84848484
    v_cndmask_b32_e64 v89, v89, 0, vcc
    v_mfma_f32_16x16x32_bf16 v[156:159], v[44:47], a[124:127], v[156:159]
    s_lshl1_add_u32 s98, s99, s98
    ds_read_b64_tr_b16 v[40:41], v17 offset:0
    ds_read_b64_tr_b16 v[42:43], v17 offset:1024
    s_waitcnt lgkmcnt(3)
    v_mfma_f32_16x16x32_bf16 v[160:163], v[48:51], a[64:67], v[160:163]
    s_mov_b32 vcc_lo, 0x10101010
    s_mov_b32 vcc_hi, 0x10101010
    v_cndmask_b32_e64 v91, v91, 0, vcc
    v_mfma_f32_16x16x32_bf16 v[160:163], v[52:55], a[68:71], v[160:163]
    s_lshl_b32 s98, s98, 5
    v_xor_b32 v94, s98, v95
    ds_read_b64_tr_b16 v[44:45], v17 offset:8192
    v_mfma_f32_16x16x32_bf16 v[164:167], v[48:51], a[72:75], v[164:167]
    s_lshl_b32 s72, s72, 7
    ds_read_b128 a[12:15], v23 offset:18432
    ds_read_b64_tr_b16 v[46:47], v17 offset:9216
    v_mfma_f32_16x16x32_bf16 v[164:167], v[52:55], a[76:79], v[164:167]
    s_add_u32 m0, s69, 16384
    v_mfma_f32_16x16x32_bf16 v[168:171], v[48:51], a[80:83], v[168:171]
    s_xor_b32 s60, s60, 524288
    buffer_load_dwordx4 v6, s[8:11], s62 offen lds
    v_mfma_f32_16x16x32_bf16 v[168:171], v[52:55], a[84:87], v[168:171]
    s_cmp_lt_u32 s2, 192
    s_cselect_b32 s72, s72, 1073741824
    v_mfma_f32_16x16x32_bf16 v[172:175], v[48:51], a[88:91], v[172:175]
    s_lshl2_add_u32 s99, s100, s4
    buffer_store_dwordx4 v[88:91], v94, s[28:31], s72 offen sc1
    v_mfma_f32_16x16x32_bf16 v[172:175], v[52:55], a[92:95], v[172:175]
    s_add_u32 s28, s28, s7
    s_addc_u32 s29, s29, 0
    v_mfma_f32_16x16x32_bf16 v[176:179], v[48:51], a[96:99], v[176:179]
    s_mov_b32 s30, 73728
    ds_read_b128 a[16:19], v22 offset:20480
    v_mfma_f32_16x16x32_bf16 v[176:179], v[52:55], a[100:103], v[176:179]
    s_lshl_b32 s99, s99, 7
    v_mfma_f32_16x16x32_bf16 v[180:183], v[48:51], a[104:107], v[180:183]
    v_mfma_f32_16x16x32_bf16 v[180:183], v[52:55], a[108:111], v[180:183]
    buffer_load_dwordx4 v7, s[8:11], s62 offen offset:1024 lds
    v_mfma_f32_16x16x32_bf16 v[184:187], v[48:51], a[112:115], v[184:187]
    v_mfma_f32_16x16x32_bf16 v[184:187], v[52:55], a[116:119], v[184:187]
    ds_read_b128 a[20:23], v23 offset:20480
    v_mfma_f32_16x16x32_bf16 v[188:191], v[48:51], a[120:123], v[188:191]
    ds_read_b64_tr_b16 v[48:49], v14 offset:32768
    ds_read_b64_tr_b16 v[50:51], v14 offset:33792
    v_mfma_f32_16x16x32_bf16 v[188:191], v[52:55], a[124:127], v[188:191]
    ds_read_b64_tr_b16 v[52:53], v14 offset:40960
    ds_read_b64_tr_b16 v[54:55], v14 offset:41984
    v_mfma_f32_16x16x32_bf16 v[192:195], v[56:59], a[64:67], v[192:195]
    v_add_u32 v14, 0x10000, v14
    v_mfma_f32_16x16x32_bf16 v[192:195], v[60:63], a[68:71], v[192:195]
    v_mfma_f32_16x16x32_bf16 v[196:199], v[56:59], a[72:75], v[196:199]
    v_mfma_f32_16x16x32_bf16 v[196:199], v[60:63], a[76:79], v[196:199]
    buffer_load_dwordx4 v8, s[8:11], s62 offen offset:2048 lds
    v_mfma_f32_16x16x32_bf16 v[200:203], v[56:59], a[80:83], v[200:203]
    ds_read_b128 a[24:27], v22 offset:22528
    v_mfma_f32_16x16x32_bf16 v[200:203], v[60:63], a[84:87], v[200:203]
    v_mfma_f32_16x16x32_bf16 v[204:207], v[56:59], a[88:91], v[204:207]
    v_mfma_f32_16x16x32_bf16 v[204:207], v[60:63], a[92:95], v[204:207]
    v_mfma_f32_16x16x32_bf16 v[208:211], v[56:59], a[96:99], v[208:211]
    ds_read_b128 a[28:31], v23 offset:22528
    v_mfma_f32_16x16x32_bf16 v[208:211], v[60:63], a[100:103], v[208:211]
    v_mfma_f32_16x16x32_bf16 v[212:215], v[56:59], a[104:107], v[212:215]
    buffer_load_dwordx4 v9, s[8:11], s62 offen offset:3072 lds
    v_mfma_f32_16x16x32_bf16 v[212:215], v[60:63], a[108:111], v[212:215]
    v_mfma_f32_16x16x32_bf16 v[216:219], v[56:59], a[112:115], v[216:219]
    v_mfma_f32_16x16x32_bf16 v[216:219], v[60:63], a[116:119], v[216:219]
    v_mfma_f32_16x16x32_bf16 v[220:223], v[56:59], a[120:123], v[220:223]
    s_waitcnt lgkmcnt(0)
    ds_read_b64_tr_b16 v[56:57], v15 offset:32768
    ds_read_b64_tr_b16 v[58:59], v15 offset:33792
    v_mfma_f32_16x16x32_bf16 v[220:223], v[60:63], a[124:127], v[220:223]
    ds_read_b64_tr_b16 v[60:61], v15 offset:40960
    ds_read_b64_tr_b16 v[62:63], v15 offset:41984
    v_mfma_f32_16x16x32_bf16 v[224:227], v[40:43], a[64:67], v[224:227]
    v_add_u32 v15, 0x10000, v15
    v_mfma_f32_16x16x32_bf16 v[224:227], v[44:47], a[68:71], v[224:227]
    s_xor_b32 s62, s62, 384
    v_mfma_f32_16x16x32_bf16 v[228:231], v[40:43], a[72:75], v[228:231]
    v_mfma_f32_16x16x32_bf16 v[228:231], v[44:47], a[76:79], v[228:231]
    v_mfma_f32_16x16x32_bf16 v[232:235], v[40:43], a[80:83], v[232:235]
    v_mfma_f32_16x16x32_bf16 v[232:235], v[44:47], a[84:87], v[232:235]
    s_add_u32 m0, s69, 32768
    v_mfma_f32_16x16x32_bf16 v[236:239], v[40:43], a[88:91], v[236:239]
    buffer_load_dwordx4 v2, s[12:15], s60 offen nt lds
    v_mfma_f32_16x16x32_bf16 v[236:239], v[44:47], a[92:95], v[236:239]
    v_mfma_f32_16x16x32_bf16 v[240:243], v[40:43], a[96:99], v[240:243]
    v_mfma_f32_16x16x32_bf16 v[240:243], v[44:47], a[100:103], v[240:243]
    v_mfma_f32_16x16x32_bf16 v[244:247], v[40:43], a[104:107], v[244:247]
    v_mfma_f32_16x16x32_bf16 v[244:247], v[44:47], a[108:111], v[244:247]
    v_mfma_f32_16x16x32_bf16 v[248:251], v[40:43], a[112:115], v[248:251]
    v_mfma_f32_16x16x32_bf16 v[248:251], v[44:47], a[116:119], v[248:251]
    buffer_load_dwordx4 v3, s[12:15], s60 offen offset:1024 nt lds
    v_mfma_f32_16x16x32_bf16 v[252:255], v[40:43], a[120:123], v[252:255]
    ds_read_b64_tr_b16 v[40:41], v16 offset:32768
    ds_read_b64_tr_b16 v[42:43], v16 offset:33792
    v_mfma_f32_16x16x32_bf16 v[252:255], v[44:47], a[124:127], v[252:255]
    ds_read_b64_tr_b16 v[44:45], v16 offset:40960
    ds_read_b64_tr_b16 v[46:47], v16 offset:41984
    v_mfma_f32_16x16x32_bf16 a[128:131], a[64:67], v[48:51], a[128:131]
    v_add_u32 v16, 0x10000, v16
    v_mfma_f32_16x16x32_bf16 a[128:131], a[68:71], v[52:55], a[128:131]
    v_mfma_f32_16x16x32_bf16 a[132:135], a[72:75], v[48:51], a[132:135]
    ds_read_b128 a[32:35], v22 offset:49152
    v_mfma_f32_16x16x32_bf16 a[132:135], a[76:79], v[52:55], a[132:135]
    v_mfma_f32_16x16x32_bf16 a[136:139], a[80:83], v[48:51], a[136:139]
    v_mfma_f32_16x16x32_bf16 a[136:139], a[84:87], v[52:55], a[136:139]
    buffer_load_dwordx4 v4, s[12:15], s60 offen offset:2048 nt lds
    v_mfma_f32_16x16x32_bf16 a[140:143], a[88:91], v[48:51], a[140:143]
    v_mfma_f32_16x16x32_bf16 a[140:143], a[92:95], v[52:55], a[140:143]
    ds_read_b128 a[36:39], v23 offset:49152
    v_mfma_f32_16x16x32_bf16 a[144:147], a[96:99], v[48:51], a[144:147]
    v_mfma_f32_16x16x32_bf16 a[144:147], a[100:103], v[52:55], a[144:147]
    v_mfma_f32_16x16x32_bf16 a[148:151], a[104:107], v[48:51], a[148:151]
    v_mfma_f32_16x16x32_bf16 a[148:151], a[108:111], v[52:55], a[148:151]
    buffer_load_dword v108, v103, s[24:27], s77 offen
    v_mfma_f32_16x16x32_bf16 a[152:155], a[112:115], v[48:51], a[152:155]
    s_add_u32 s77, s77, 4608
    buffer_load_dwordx4 v5, s[12:15], s60 offen offset:3072 nt lds
    v_mfma_f32_16x16x32_bf16 a[152:155], a[116:119], v[52:55], a[152:155]
    ds_read_b128 a[40:43], v22 offset:51200
    v_mfma_f32_16x16x32_bf16 a[156:159], a[120:123], v[48:51], a[156:159]
    ds_read_b64_tr_b16 v[48:49], v17 offset:32768
    ds_read_b64_tr_b16 v[50:51], v17 offset:33792
    v_mfma_f32_16x16x32_bf16 a[156:159], a[124:127], v[52:55], a[156:159]
    s_waitcnt lgkmcnt(3)
    ds_read_b64_tr_b16 v[52:53], v17 offset:40960
    ds_read_b64_tr_b16 v[54:55], v17 offset:41984
    v_mfma_f32_16x16x32_bf16 a[160:163], a[64:67], v[56:59], a[160:163]
    v_add_u32 v17, 0x10000, v17
    v_mfma_f32_16x16x32_bf16 a[160:163], a[68:71], v[60:63], a[160:163]
    v_mfma_f32_16x16x32_bf16 a[164:167], a[72:75], v[56:59], a[164:167]
    ds_read_b128 a[44:47], v23 offset:51200
    v_mfma_f32_16x16x32_bf16 a[164:167], a[76:79], v[60:63], a[164:167]
    s_add_u32 m0, s69, 49152
    v_mfma_f32_16x16x32_bf16 a[168:171], a[80:83], v[56:59], a[168:171]
    buffer_load_dwordx4 v6, s[8:11], s61 offen lds
    v_mfma_f32_16x16x32_bf16 a[168:171], a[84:87], v[60:63], a[168:171]
    v_mfma_f32_16x16x32_bf16 a[172:175], a[88:91], v[56:59], a[172:175]
    v_mfma_f32_16x16x32_bf16 a[172:175], a[92:95], v[60:63], a[172:175]
    v_mfma_f32_16x16x32_bf16 a[176:179], a[96:99], v[56:59], a[176:179]
    ds_read_b128 a[48:51], v22 offset:53248
    v_mfma_f32_16x16x32_bf16 a[176:179], a[100:103], v[60:63], a[176:179]
    v_mfma_f32_16x16x32_bf16 a[180:183], a[104:107], v[56:59], a[180:183]
    v_mfma_f32_16x16x32_bf16 a[180:183], a[108:111], v[60:63], a[180:183]
    buffer_load_dwordx4 v7, s[8:11], s61 offen offset:1024 lds
    v_mfma_f32_16x16x32_bf16 a[184:187], a[112:115], v[56:59], a[184:187]
    v_mfma_f32_16x16x32_bf16 a[184:187], a[116:119], v[60:63], a[184:187]
    ds_read_b128 a[52:55], v23 offset:53248
    v_mfma_f32_16x16x32_bf16 a[188:191], a[120:123], v[56:59], a[188:191]
    v_mfma_f32_16x16x32_bf16 a[188:191], a[124:127], v[60:63], a[188:191]
    v_mfma_f32_16x16x32_bf16 a[192:195], a[64:67], v[40:43], a[192:195]
    v_mfma_f32_16x16x32_bf16 a[192:195], a[68:71], v[44:47], a[192:195]
    v_mfma_f32_16x16x32_bf16 a[196:199], a[72:75], v[40:43], a[196:199]
    v_mfma_f32_16x16x32_bf16 a[196:199], a[76:79], v[44:47], a[196:199]
    buffer_load_dwordx4 v8, s[8:11], s61 offen offset:2048 lds
    v_mfma_f32_16x16x32_bf16 a[200:203], a[80:83], v[40:43], a[200:203]
    ds_read_b128 a[56:59], v22 offset:55296
    v_mfma_f32_16x16x32_bf16 a[200:203], a[84:87], v[44:47], a[200:203]
    v_mfma_f32_16x16x32_bf16 a[204:207], a[88:91], v[40:43], a[204:207]
    v_mfma_f32_16x16x32_bf16 a[204:207], a[92:95], v[44:47], a[204:207]
    v_mfma_f32_16x16x32_bf16 a[208:211], a[96:99], v[40:43], a[208:211]
    ds_read_b128 a[60:63], v23 offset:55296
    v_mfma_f32_16x16x32_bf16 a[208:211], a[100:103], v[44:47], a[208:211]
    v_mfma_f32_16x16x32_bf16 a[212:215], a[104:107], v[40:43], a[212:215]
    buffer_load_dwordx4 v9, s[8:11], s61 offen offset:3072 lds
    v_mfma_f32_16x16x32_bf16 a[212:215], a[108:111], v[44:47], a[212:215]
    v_mfma_f32_16x16x32_bf16 a[216:219], a[112:115], v[40:43], a[216:219]
    v_mfma_f32_16x16x32_bf16 a[216:219], a[116:119], v[44:47], a[216:219]
    v_mfma_f32_16x16x32_bf16 a[220:223], a[120:123], v[40:43], a[220:223]
    v_mfma_f32_16x16x32_bf16 a[220:223], a[124:127], v[44:47], a[220:223]
    s_waitcnt lgkmcnt(0)
    v_mfma_f32_16x16x32_bf16 a[224:227], a[64:67], v[48:51], a[224:227]
    v_mfma_f32_16x16x32_bf16 a[224:227], a[68:71], v[52:55], a[224:227]
    s_xor_b32 s61, s61, 128
    v_mfma_f32_16x16x32_bf16 a[228:231], a[72:75], v[48:51], a[228:231]
    v_mfma_f32_16x16x32_bf16 a[228:231], a[76:79], v[52:55], a[228:231]
    v_mfma_f32_16x16x32_bf16 a[232:235], a[80:83], v[48:51], a[232:235]
    v_mfma_f32_16x16x32_bf16 a[232:235], a[84:87], v[52:55], a[232:235]
    s_waitcnt vmcnt(9) lgkmcnt(0)
    s_barrier
    ds_read_b64_tr_b16 v[56:57], v14 offset:0
    v_mfma_f32_16x16x32_bf16 a[236:239], a[88:91], v[48:51], a[236:239]
    s_add_u32 m0, s69, 65536
    ds_read_b64_tr_b16 v[58:59], v14 offset:1024
    ds_read_b64_tr_b16 v[60:61], v14 offset:8192
    v_mfma_f32_16x16x32_bf16 a[236:239], a[92:95], v[52:55], a[236:239]
    buffer_load_dwordx4 v2, s[16:19], s60 offen nt lds
    v_mfma_f32_16x16x32_bf16 a[240:243], a[96:99], v[48:51], a[240:243]
    ds_read_b64_tr_b16 v[62:63], v14 offset:9216
    ds_read_b64_tr_b16 v[40:41], v15 offset:0
    v_mfma_f32_16x16x32_bf16 a[240:243], a[100:103], v[52:55], a[240:243]
    buffer_atomic_add v31, v30, s[44:47], s95 offen sc1
    v_mfma_f32_16x16x32_bf16 a[244:247], a[104:107], v[48:51], a[244:247]
    s_mov_b32 s95, 32768
    ds_read_b64_tr_b16 v[42:43], v15 offset:1024
    ds_read_b64_tr_b16 v[44:45], v15 offset:8192
    v_mfma_f32_16x16x32_bf16 a[244:247], a[108:111], v[52:55], a[244:247]
    ds_read_b64_tr_b16 v[46:47], v15 offset:9216
    v_add_u32 v14, 0xfffe0000, v14
    v_mfma_f32_16x16x32_bf16 a[248:251], a[112:115], v[48:51], a[248:251]
    v_add_u32 v15, 0xfffe0000, v15
    v_mfma_f32_16x16x32_bf16 a[248:251], a[116:119], v[52:55], a[248:251]
    buffer_load_dwordx4 v3, s[16:19], s60 offen offset:1024 nt lds
    v_mfma_f32_16x16x32_bf16 a[252:255], a[120:123], v[48:51], a[252:255]
    ds_read_b64_tr_b16 v[48:49], v16 offset:0
    ds_read_b64_tr_b16 v[50:51], v16 offset:1024
    v_mfma_f32_16x16x32_bf16 a[252:255], a[124:127], v[52:55], a[252:255]
    s_waitcnt lgkmcnt(3)
    ds_read_b64_tr_b16 v[52:53], v16 offset:8192
    ds_read_b64_tr_b16 v[54:55], v16 offset:9216
    v_mfma_f32_16x16x32_bf16 v[128:131], v[56:59], a[0:3], v[128:131]
    v_add_u32 v16, 0xfffe0000, v16
    v_mfma_f32_16x16x32_bf16 v[128:131], v[60:63], a[4:7], v[128:131]
    v_add_u32 v22, 0x10000, v22
    v_mfma_f32_16x16x32_bf16 v[132:135], v[56:59], a[8:11], v[132:135]
    ds_read_b128 a[64:67], v22 offset:16384
    v_mfma_f32_16x16x32_bf16 v[132:135], v[60:63], a[12:15], v[132:135]
    v_mfma_f32_16x16x32_bf16 v[136:139], v[56:59], a[16:19], v[136:139]
    v_mfma_f32_16x16x32_bf16 v[136:139], v[60:63], a[20:23], v[136:139]
    buffer_load_dwordx4 v4, s[16:19], s60 offen offset:2048 nt lds
    v_mfma_f32_16x16x32_bf16 v[140:143], v[56:59], a[24:27], v[140:143]
    v_add_u32 v23, 0x10000, v23
    v_mfma_f32_16x16x32_bf16 v[140:143], v[60:63], a[28:31], v[140:143]
    ds_read_b128 a[68:71], v23 offset:16384
    v_mfma_f32_16x16x32_bf16 v[144:147], v[56:59], a[32:35], v[144:147]
    v_mfma_f32_16x16x32_bf16 v[144:147], v[60:63], a[36:39], v[144:147]
    v_mfma_f32_16x16x32_bf16 v[148:151], v[56:59], a[40:43], v[148:151]
    v_mfma_f32_16x16x32_bf16 v[148:151], v[60:63], a[44:47], v[148:151]
    v_mfma_f32_16x16x32_bf16 v[152:155], v[56:59], a[48:51], v[152:155]
    buffer_load_dwordx4 v5, s[16:19], s60 offen offset:3072 nt lds
    v_mfma_f32_16x16x32_bf16 v[152:155], v[60:63], a[52:55], v[152:155]
    ds_read_b128 a[72:75], v22 offset:18432
    v_mfma_f32_16x16x32_bf16 v[156:159], v[56:59], a[56:59], v[156:159]
    ds_read_b64_tr_b16 v[56:57], v17 offset:0
    ds_read_b64_tr_b16 v[58:59], v17 offset:1024
    v_mfma_f32_16x16x32_bf16 v[156:159], v[60:63], a[60:63], v[156:159]
    ds_read_b64_tr_b16 v[60:61], v17 offset:8192
    ds_read_b64_tr_b16 v[62:63], v17 offset:9216
    v_mfma_f32_16x16x32_bf16 v[160:163], v[40:43], a[0:3], v[160:163]
    s_waitcnt lgkmcnt(5)
    v_add_u32 v17, 0xfffe0000, v17
    v_mfma_f32_16x16x32_bf16 v[160:163], v[44:47], a[4:7], v[160:163]
    v_mfma_f32_16x16x32_bf16 v[164:167], v[40:43], a[8:11], v[164:167]
    ds_read_b128 a[76:79], v23 offset:18432
    v_mfma_f32_16x16x32_bf16 v[164:167], v[44:47], a[12:15], v[164:167]
    s_add_u32 m0, s69, 81920
    v_mfma_f32_16x16x32_bf16 v[168:171], v[40:43], a[16:19], v[168:171]
    s_xor_b32 s60, s60, 1572864
    buffer_load_dwordx4 v6, s[8:11], s62 offen lds
    v_mfma_f32_16x16x32_bf16 v[168:171], v[44:47], a[20:23], v[168:171]
    v_mfma_f32_16x16x32_bf16 v[172:175], v[40:43], a[24:27], v[172:175]
    v_mfma_f32_16x16x32_bf16 v[172:175], v[44:47], a[28:31], v[172:175]
    v_mfma_f32_16x16x32_bf16 v[176:179], v[40:43], a[32:35], v[176:179]
    ds_read_b128 a[80:83], v22 offset:20480
    v_mfma_f32_16x16x32_bf16 v[176:179], v[44:47], a[36:39], v[176:179]
    v_mfma_f32_16x16x32_bf16 v[180:183], v[40:43], a[40:43], v[180:183]
    v_mfma_f32_16x16x32_bf16 v[180:183], v[44:47], a[44:47], v[180:183]
    buffer_load_dwordx4 v7, s[8:11], s62 offen offset:1024 lds
    v_mfma_f32_16x16x32_bf16 v[184:187], v[40:43], a[48:51], v[184:187]
    v_mfma_f32_16x16x32_bf16 v[184:187], v[44:47], a[52:55], v[184:187]
    ds_read_b128 a[84:87], v23 offset:20480
    v_mfma_f32_16x16x32_bf16 v[188:191], v[40:43], a[56:59], v[188:191]
    ds_read_b64_tr_b16 v[40:41], v14 offset:0
    ds_read_b64_tr_b16 v[42:43], v14 offset:1024
    v_mfma_f32_16x16x32_bf16 v[188:191], v[44:47], a[60:63], v[188:191]
    ds_read_b64_tr_b16 v[44:45], v14 offset:8192
    ds_read_b64_tr_b16 v[46:47], v14 offset:9216
    v_mfma_f32_16x16x32_bf16 v[192:195], v[48:51], a[0:3], v[192:195]
    v_mfma_f32_16x16x32_bf16 v[192:195], v[52:55], a[4:7], v[192:195]
    v_mfma_f32_16x16x32_bf16 v[196:199], v[48:51], a[8:11], v[196:199]
    v_mfma_f32_16x16x32_bf16 v[196:199], v[52:55], a[12:15], v[196:199]
    buffer_load_dwordx4 v8, s[8:11], s62 offen offset:2048 lds
    v_mfma_f32_16x16x32_bf16 v[200:203], v[48:51], a[16:19], v[200:203]
    ds_read_b128 a[88:91], v22 offset:22528
    v_mfma_f32_16x16x32_bf16 v[200:203], v[52:55], a[20:23], v[200:203]
    v_mfma_f32_16x16x32_bf16 v[204:207], v[48:51], a[24:27], v[204:207]
    v_mfma_f32_16x16x32_bf16 v[204:207], v[52:55], a[28:31], v[204:207]
    v_mfma_f32_16x16x32_bf16 v[208:211], v[48:51], a[32:35], v[208:211]
    ds_read_b128 a[92:95], v23 offset:22528
    v_mfma_f32_16x16x32_bf16 v[208:211], v[52:55], a[36:39], v[208:211]
    v_mfma_f32_16x16x32_bf16 v[212:215], v[48:51], a[40:43], v[212:215]
    buffer_load_dwordx4 v9, s[8:11], s62 offen offset:3072 lds
    v_mfma_f32_16x16x32_bf16 v[212:215], v[52:55], a[44:47], v[212:215]
    v_mfma_f32_16x16x32_bf16 v[216:219], v[48:51], a[48:51], v[216:219]
    v_mfma_f32_16x16x32_bf16 v[216:219], v[52:55], a[52:55], v[216:219]
    v_mfma_f32_16x16x32_bf16 v[220:223], v[48:51], a[56:59], v[220:223]
    s_waitcnt lgkmcnt(0)
    ds_read_b64_tr_b16 v[48:49], v15 offset:0
    ds_read_b64_tr_b16 v[50:51], v15 offset:1024
    v_mfma_f32_16x16x32_bf16 v[220:223], v[52:55], a[60:63], v[220:223]
    ds_read_b64_tr_b16 v[52:53], v15 offset:8192
    ds_read_b64_tr_b16 v[54:55], v15 offset:9216
    v_mfma_f32_16x16x32_bf16 v[224:227], v[56:59], a[0:3], v[224:227]
    v_mfma_f32_16x16x32_bf16 v[224:227], v[60:63], a[4:7], v[224:227]
    s_xor_b32 s62, s62, 128
    v_mfma_f32_16x16x32_bf16 v[228:231], v[56:59], a[8:11], v[228:231]
    buffer_load_dword v109, v103, s[24:27], s77 offen
    v_mfma_f32_16x16x32_bf16 v[228:231], v[60:63], a[12:15], v[228:231]
    v_mfma_f32_16x16x32_bf16 v[232:235], v[56:59], a[16:19], v[232:235]
    v_mfma_f32_16x16x32_bf16 v[232:235], v[60:63], a[20:23], v[232:235]
    s_add_u32 m0, s69, 98304
    v_mfma_f32_16x16x32_bf16 v[236:239], v[56:59], a[24:27], v[236:239]
    buffer_load_dwordx4 v2, s[12:15], s60 offen nt lds
    v_mfma_f32_16x16x32_bf16 v[236:239], v[60:63], a[28:31], v[236:239]
    v_mfma_f32_16x16x32_bf16 v[240:243], v[56:59], a[32:35], v[240:243]
    v_mfma_f32_16x16x32_bf16 v[240:243], v[60:63], a[36:39], v[240:243]
    v_mfma_f32_16x16x32_bf16 v[244:247], v[56:59], a[40:43], v[244:247]
    v_mfma_f32_16x16x32_bf16 v[244:247], v[60:63], a[44:47], v[244:247]
    v_mfma_f32_16x16x32_bf16 v[248:251], v[56:59], a[48:51], v[248:251]
    v_mfma_f32_16x16x32_bf16 v[248:251], v[60:63], a[52:55], v[248:251]
    buffer_load_dwordx4 v3, s[12:15], s60 offen offset:1024 nt lds
    v_mfma_f32_16x16x32_bf16 v[252:255], v[56:59], a[56:59], v[252:255]
    ds_read_b64_tr_b16 v[56:57], v16 offset:0
    ds_read_b64_tr_b16 v[58:59], v16 offset:1024
    v_mfma_f32_16x16x32_bf16 v[252:255], v[60:63], a[60:63], v[252:255]
    ds_read_b64_tr_b16 v[60:61], v16 offset:8192
    ds_read_b64_tr_b16 v[62:63], v16 offset:9216
    v_mfma_f32_16x16x32_bf16 a[128:131], a[0:3], v[40:43], a[128:131]
    v_mfma_f32_16x16x32_bf16 a[128:131], a[4:7], v[44:47], a[128:131]
    v_add_u32 v22, 0xfffe0000, v22
    v_mfma_f32_16x16x32_bf16 a[132:135], a[8:11], v[40:43], a[132:135]
    ds_read_b128 a[96:99], v22 offset:16384
    v_mfma_f32_16x16x32_bf16 a[132:135], a[12:15], v[44:47], a[132:135]
    v_mfma_f32_16x16x32_bf16 a[136:139], a[16:19], v[40:43], a[136:139]
    v_mfma_f32_16x16x32_bf16 a[136:139], a[20:23], v[44:47], a[136:139]
    buffer_load_dwordx4 v4, s[12:15], s60 offen offset:2048 nt lds
    v_mfma_f32_16x16x32_bf16 a[140:143], a[24:27], v[40:43], a[140:143]
    v_add_u32 v23, 0xfffe0000, v23
    v_mfma_f32_16x16x32_bf16 a[140:143], a[28:31], v[44:47], a[140:143]
    ds_read_b128 a[100:103], v23 offset:16384
    v_mfma_f32_16x16x32_bf16 a[144:147], a[32:35], v[40:43], a[144:147]
    v_mfma_f32_16x16x32_bf16 a[144:147], a[36:39], v[44:47], a[144:147]
    v_mfma_f32_16x16x32_bf16 a[148:151], a[40:43], v[40:43], a[148:151]
    v_mfma_f32_16x16x32_bf16 a[148:151], a[44:47], v[44:47], a[148:151]
    v_mfma_f32_16x16x32_bf16 a[152:155], a[48:51], v[40:43], a[152:155]
    buffer_load_dwordx4 v5, s[12:15], s60 offen offset:3072 nt lds
    v_mfma_f32_16x16x32_bf16 a[152:155], a[52:55], v[44:47], a[152:155]
    ds_read_b128 a[104:107], v22 offset:18432
    v_mfma_f32_16x16x32_bf16 a[156:159], a[56:59], v[40:43], a[156:159]
    ds_read_b64_tr_b16 v[40:41], v17 offset:0
    ds_read_b64_tr_b16 v[42:43], v17 offset:1024
    v_mfma_f32_16x16x32_bf16 a[156:159], a[60:63], v[44:47], a[156:159]
    s_waitcnt lgkmcnt(3)
    ds_read_b64_tr_b16 v[44:45], v17 offset:8192
    ds_read_b64_tr_b16 v[46:47], v17 offset:9216
    v_mfma_f32_16x16x32_bf16 a[160:163], a[0:3], v[48:51], a[160:163]
    v_mfma_f32_16x16x32_bf16 a[160:163], a[4:7], v[52:55], a[160:163]
    v_mfma_f32_16x16x32_bf16 a[164:167], a[8:11], v[48:51], a[164:167]
    ds_read_b128 a[108:111], v23 offset:18432
    v_mfma_f32_16x16x32_bf16 a[164:167], a[12:15], v[52:55], a[164:167]
    s_add_u32 m0, s69, 114688
    v_mfma_f32_16x16x32_bf16 a[168:171], a[16:19], v[48:51], a[168:171]
    s_xor_b32 s60, s60, 524288
    buffer_load_dwordx4 v6, s[8:11], s61 offen lds
    v_mfma_f32_16x16x32_bf16 a[168:171], a[20:23], v[52:55], a[168:171]
    v_mfma_f32_16x16x32_bf16 a[172:175], a[24:27], v[48:51], a[172:175]
    v_mfma_f32_16x16x32_bf16 a[172:175], a[28:31], v[52:55], a[172:175]
    v_mfma_f32_16x16x32_bf16 a[176:179], a[32:35], v[48:51], a[176:179]
    ds_read_b128 a[112:115], v22 offset:20480
    v_mfma_f32_16x16x32_bf16 a[176:179], a[36:39], v[52:55], a[176:179]
    v_mfma_f32_16x16x32_bf16 a[180:183], a[40:43], v[48:51], a[180:183]
    v_mfma_f32_16x16x32_bf16 a[180:183], a[44:47], v[52:55], a[180:183]
    buffer_load_dwordx4 v7, s[8:11], s61 offen offset:1024 lds
    v_mfma_f32_16x16x32_bf16 a[184:187], a[48:51], v[48:51], a[184:187]
    v_mfma_f32_16x16x32_bf16 a[184:187], a[52:55], v[52:55], a[184:187]
    ds_read_b128 a[116:119], v23 offset:20480
    v_mfma_f32_16x16x32_bf16 a[188:191], a[56:59], v[48:51], a[188:191]
    v_mfma_f32_16x16x32_bf16 a[188:191], a[60:63], v[52:55], a[188:191]
    v_mfma_f32_16x16x32_bf16 a[192:195], a[0:3], v[56:59], a[192:195]
    v_mfma_f32_16x16x32_bf16 a[192:195], a[4:7], v[60:63], a[192:195]
    v_mfma_f32_16x16x32_bf16 a[196:199], a[8:11], v[56:59], a[196:199]
    v_mfma_f32_16x16x32_bf16 a[196:199], a[12:15], v[60:63], a[196:199]
    buffer_load_dwordx4 v8, s[8:11], s61 offen offset:2048 lds
    v_mfma_f32_16x16x32_bf16 a[200:203], a[16:19], v[56:59], a[200:203]
    ds_read_b128 a[120:123], v22 offset:22528
    v_mfma_f32_16x16x32_bf16 a[200:203], a[20:23], v[60:63], a[200:203]
    v_mfma_f32_16x16x32_bf16 a[204:207], a[24:27], v[56:59], a[204:207]
    v_mfma_f32_16x16x32_bf16 a[204:207], a[28:31], v[60:63], a[204:207]
    v_mfma_f32_16x16x32_bf16 a[208:211], a[32:35], v[56:59], a[208:211]
    ds_read_b128 a[124:127], v23 offset:22528
    v_mfma_f32_16x16x32_bf16 a[208:211], a[36:39], v[60:63], a[208:211]
    v_mfma_f32_16x16x32_bf16 a[212:215], a[40:43], v[56:59], a[212:215]
    buffer_load_dwordx4 v9, s[8:11], s61 offen offset:3072 lds
    v_mfma_f32_16x16x32_bf16 a[212:215], a[44:47], v[60:63], a[212:215]
    v_mfma_f32_16x16x32_bf16 a[216:219], a[48:51], v[56:59], a[216:219]
    v_mfma_f32_16x16x32_bf16 a[216:219], a[52:55], v[60:63], a[216:219]
    v_mfma_f32_16x16x32_bf16 a[220:223], a[56:59], v[56:59], a[220:223]
    v_mfma_f32_16x16x32_bf16 a[220:223], a[60:63], v[60:63], a[220:223]
    s_waitcnt lgkmcnt(0)
    v_mfma_f32_16x16x32_bf16 a[224:227], a[0:3], v[40:43], a[224:227]
    v_mfma_f32_16x16x32_bf16 a[224:227], a[4:7], v[44:47], a[224:227]
    s_xor_b32 s61, s61, 1920
    v_mfma_f32_16x16x32_bf16 a[228:231], a[8:11], v[40:43], a[228:231]
    s_andn2_b32 s61, s61, 896
    v_mfma_f32_16x16x32_bf16 a[228:231], a[12:15], v[44:47], a[228:231]
    s_lshl_b32 s61, s5, 7
    v_mfma_f32_16x16x32_bf16 a[232:235], a[16:19], v[40:43], a[232:235]
    v_mfma_f32_16x16x32_bf16 a[232:235], a[20:23], v[44:47], a[232:235]
    s_waitcnt vmcnt(9) lgkmcnt(0)
    s_barrier
    ds_read_b64_tr_b16 v[48:49], v14 offset:32768
    v_mfma_f32_16x16x32_bf16 a[236:239], a[24:27], v[40:43], a[236:239]
    s_add_u32 m0, s69, 131072
    ds_read_b64_tr_b16 v[50:51], v14 offset:33792
    ds_read_b64_tr_b16 v[52:53], v14 offset:40960
    v_mfma_f32_16x16x32_bf16 a[236:239], a[28:31], v[44:47], a[236:239]
    buffer_load_dwordx4 v2, s[12:15], s60 offen nt lds
    v_mfma_f32_16x16x32_bf16 a[240:243], a[32:35], v[40:43], a[240:243]
    ds_read_b64_tr_b16 v[54:55], v14 offset:41984
    ds_read_b64_tr_b16 v[56:57], v15 offset:32768
    v_mfma_f32_16x16x32_bf16 a[240:243], a[36:39], v[44:47], a[240:243]
    ds_read_b64_tr_b16 v[58:59], v15 offset:33792
    ds_read_b64_tr_b16 v[60:61], v15 offset:40960
    v_mfma_f32_16x16x32_bf16 a[244:247], a[40:43], v[40:43], a[244:247]
    ds_read_b64_tr_b16 v[62:63], v15 offset:41984
    v_add_u32 v14, 0x10000, v14
    v_mfma_f32_16x16x32_bf16 a[244:247], a[44:47], v[44:47], a[244:247]
    v_add_u32 v15, 0x10000, v15
    v_mfma_f32_16x16x32_bf16 a[248:251], a[48:51], v[40:43], a[248:251]
    v_mfma_f32_16x16x32_bf16 a[248:251], a[52:55], v[44:47], a[248:251]
    buffer_load_dwordx4 v3, s[12:15], s60 offen offset:1024 nt lds
    v_mfma_f32_16x16x32_bf16 a[252:255], a[56:59], v[40:43], a[252:255]
    ds_read_b64_tr_b16 v[40:41], v16 offset:32768
    ds_read_b64_tr_b16 v[42:43], v16 offset:33792
    v_mfma_f32_16x16x32_bf16 a[252:255], a[60:63], v[44:47], a[252:255]
    s_waitcnt lgkmcnt(2)
    ds_read_b64_tr_b16 v[44:45], v16 offset:40960
    ds_read_b64_tr_b16 v[46:47], v16 offset:41984
    v_mfma_f32_16x16x32_bf16 v[128:131], v[48:51], a[64:67], v[128:131]
    v_add_u32 v16, 0x10000, v16
    v_mfma_f32_16x16x32_bf16 v[128:131], v[52:55], a[68:71], v[128:131]
    v_mfma_f32_16x16x32_bf16 v[132:135], v[48:51], a[72:75], v[132:135]
    ds_read_b128 a[0:3], v22 offset:49152
    v_mfma_f32_16x16x32_bf16 v[132:135], v[52:55], a[76:79], v[132:135]
    v_mfma_f32_16x16x32_bf16 v[136:139], v[48:51], a[80:83], v[136:139]
    v_mfma_f32_16x16x32_bf16 v[136:139], v[52:55], a[84:87], v[136:139]
    buffer_load_dwordx4 v4, s[12:15], s60 offen offset:2048 nt lds
    v_mfma_f32_16x16x32_bf16 v[140:143], v[48:51], a[88:91], v[140:143]
    v_mfma_f32_16x16x32_bf16 v[140:143], v[52:55], a[92:95], v[140:143]
    ds_read_b128 a[4:7], v23 offset:49152
    v_mfma_f32_16x16x32_bf16 v[144:147], v[48:51], a[96:99], v[144:147]
    v_mfma_f32_16x16x32_bf16 v[144:147], v[52:55], a[100:103], v[144:147]
    v_mfma_f32_16x16x32_bf16 v[148:151], v[48:51], a[104:107], v[148:151]
    v_mfma_f32_16x16x32_bf16 v[148:151], v[52:55], a[108:111], v[148:151]
    v_mfma_f32_16x16x32_bf16 v[152:155], v[48:51], a[112:115], v[152:155]
    buffer_load_dwordx4 v5, s[12:15], s60 offen offset:3072 nt lds
    v_mfma_f32_16x16x32_bf16 v[152:155], v[52:55], a[116:119], v[152:155]
    ds_read_b128 a[8:11], v22 offset:51200
    v_mfma_f32_16x16x32_bf16 v[156:159], v[48:51], a[120:123], v[156:159]
    ds_read_b64_tr_b16 v[48:49], v17 offset:32768
    ds_read_b64_tr_b16 v[50:51], v17 offset:33792
    v_mfma_f32_16x16x32_bf16 v[156:159], v[52:55], a[124:127], v[156:159]
    ds_read_b64_tr_b16 v[52:53], v17 offset:40960
    ds_read_b64_tr_b16 v[54:55], v17 offset:41984
    v_mfma_f32_16x16x32_bf16 v[160:163], v[56:59], a[64:67], v[160:163]
    v_add_u32 v17, 0x10000, v17
    v_mfma_f32_16x16x32_bf16 v[160:163], v[60:63], a[68:71], v[160:163]
    s_cmp_lt_u32 s4, 0
    s_cselect_b32 s12, 0xf149f2ca, 0
    v_mfma_f32_16x16x32_bf16 v[164:167], v[56:59], a[72:75], v[164:167]
    ds_read_b128 a[12:15], v23 offset:51200
    v_mfma_f32_16x16x32_bf16 v[164:167], v[60:63], a[76:79], v[164:167]
    s_add_u32 m0, s69, 147456
    v_mfma_f32_16x16x32_bf16 v[168:171], v[56:59], a[80:83], v[168:171]
    s_xor_b32 s60, s60, 524288
    buffer_load_dwordx4 v6, s[8:11], s62 offen lds
    v_mfma_f32_16x16x32_bf16 v[168:171], v[60:63], a[84:87], v[168:171]
    s_cmp_lt_u32 s4, 1
    s_cselect_b32 s13, 0xf149f2ca, 0
    v_mfma_f32_16x16x32_bf16 v[172:175], v[56:59], a[88:91], v[172:175]
    s_cmp_lt_u32 s4, 2
    s_cselect_b32 s14, 0xf149f2ca, 0
    v_mfma_f32_16x16x32_bf16 v[172:175], v[60:63], a[92:95], v[172:175]
    s_cmp_lt_u32 s4, 3
    s_cselect_b32 s15, 0xf149f2ca, 0
    v_mfma_f32_16x16x32_bf16 v[176:179], v[56:59], a[96:99], v[176:179]
    ds_read_b128 a[16:19], v22 offset:53248
    v_mfma_f32_16x16x32_bf16 v[176:179], v[60:63], a[100:103], v[176:179]
    v_mfma_f32_16x16x32_bf16 v[180:183], v[56:59], a[104:107], v[180:183]
    v_mfma_f32_16x16x32_bf16 v[180:183], v[60:63], a[108:111], v[180:183]
    buffer_load_dwordx4 v7, s[8:11], s62 offen offset:1024 lds
    v_mfma_f32_16x16x32_bf16 v[184:187], v[56:59], a[112:115], v[184:187]
    v_mfma_f32_16x16x32_bf16 v[184:187], v[60:63], a[116:119], v[184:187]
    ds_read_b128 a[20:23], v23 offset:53248
    v_mfma_f32_16x16x32_bf16 v[188:191], v[56:59], a[120:123], v[188:191]
    s_waitcnt lgkmcnt(1)
    ds_read_b64_tr_b16 v[56:57], v14 offset:0
    ds_read_b64_tr_b16 v[58:59], v14 offset:1024
    v_mfma_f32_16x16x32_bf16 v[188:191], v[60:63], a[124:127], v[188:191]
    ds_read_b64_tr_b16 v[60:61], v14 offset:8192
    ds_read_b64_tr_b16 v[62:63], v14 offset:9216
    v_mfma_f32_16x16x32_bf16 v[192:195], v[40:43], a[64:67], v[192:195]
    v_mfma_f32_16x16x32_bf16 v[192:195], v[44:47], a[68:71], v[192:195]
    v_mfma_f32_16x16x32_bf16 v[196:199], v[40:43], a[72:75], v[196:199]
    v_mfma_f32_16x16x32_bf16 v[196:199], v[44:47], a[76:79], v[196:199]
    buffer_load_dwordx4 v8, s[8:11], s62 offen offset:2048 lds
    v_mfma_f32_16x16x32_bf16 v[200:203], v[40:43], a[80:83], v[200:203]
    ds_read_b128 a[24:27], v22 offset:55296
    v_bfe_u32 v8, v1, 4, 3
    v_mfma_f32_16x16x32_bf16 v[200:203], v[44:47], a[84:87], v[200:203]
    v_lshlrev_b32 v8, 12, v8
    v_mfma_f32_16x16x32_bf16 v[204:207], v[40:43], a[88:91], v[204:207]
    v_mfma_f32_16x16x32_bf16 v[204:207], v[44:47], a[92:95], v[204:207]
    v_mfma_f32_16x16x32_bf16 v[208:211], v[40:43], a[96:99], v[208:211]
    ds_read_b128 a[28:31], v23 offset:55296
    v_mfma_f32_16x16x32_bf16 v[208:211], v[44:47], a[100:103], v[208:211]
    v_mfma_f32_16x16x32_bf16 v[212:215], v[40:43], a[104:107], v[212:215]
    buffer_load_dwordx4 v9, s[8:11], s62 offen offset:3072 lds
    v_mfma_f32_16x16x32_bf16 v[212:215], v[44:47], a[108:111], v[212:215]
    s_and_b32 s8, s5, 7
    v_lshrrev_b32 v9, 2, v1
    v_mfma_f32_16x16x32_bf16 v[216:219], v[40:43], a[112:115], v[216:219]
    s_lshl3_add_u32 s8, s6, s8
    v_mfma_f32_16x16x32_bf16 v[216:219], v[44:47], a[116:119], v[216:219]
    s_and_b32 s9, s5, 24
    v_mfma_f32_16x16x32_bf16 v[220:223], v[40:43], a[120:123], v[220:223]
    s_mul_i32 s10, s9, 18
    ds_read_b64_tr_b16 v[40:41], v15 offset:0
    ds_read_b64_tr_b16 v[42:43], v15 offset:1024
    v_mfma_f32_16x16x32_bf16 v[220:223], v[44:47], a[124:127], v[220:223]
    s_add_u32 s10, s10, 16
    ds_read_b64_tr_b16 v[44:45], v15 offset:8192
    ds_read_b64_tr_b16 v[46:47], v15 offset:9216
    v_mfma_f32_16x16x32_bf16 v[224:227], v[48:51], a[64:67], v[224:227]
    s_cmp_eq_u32 s4, 3
    s_cselect_b32 s11, 1.0, 0
    v_mfma_f32_16x16x32_bf16 v[224:227], v[52:55], a[68:71], v[224:227]
    s_xor_b32 s62, s62, 1920
    v_mfma_f32_16x16x32_bf16 v[228:231], v[48:51], a[72:75], v[228:231]
    s_andn2_b32 s62, s62, 896
    v_mfma_f32_16x16x32_bf16 v[228:231], v[52:55], a[76:79], v[228:231]
    v_mfma_f32_16x16x32_bf16 v[232:235], v[48:51], a[80:83], v[232:235]
    v_mfma_f32_16x16x32_bf16 v[232:235], v[52:55], a[84:87], v[232:235]
    s_add_u32 m0, s69, 0
    v_mfma_f32_16x16x32_bf16 v[236:239], v[48:51], a[88:91], v[236:239]
    buffer_load_dwordx4 v2, s[16:19], s60 offen nt lds
    v_mfma_f32_16x16x32_bf16 v[236:239], v[52:55], a[92:95], v[236:239]
    v_mfma_f32_16x16x32_bf16 v[240:243], v[48:51], a[96:99], v[240:243]
    v_mfma_f32_16x16x32_bf16 v[240:243], v[52:55], a[100:103], v[240:243]
    v_mfma_f32_16x16x32_bf16 v[244:247], v[48:51], a[104:107], v[244:247]
    v_mfma_f32_16x16x32_bf16 v[244:247], v[52:55], a[108:111], v[244:247]
    v_mfma_f32_16x16x32_bf16 v[248:251], v[48:51], a[112:115], v[248:251]
    v_mfma_f32_16x16x32_bf16 v[248:251], v[52:55], a[116:119], v[248:251]
    buffer_load_dwordx4 v3, s[16:19], s60 offen offset:1024 nt lds
    v_mfma_f32_16x16x32_bf16 v[252:255], v[48:51], a[120:123], v[252:255]
    ds_read_b64_tr_b16 v[48:49], v16 offset:0
    ds_read_b64_tr_b16 v[50:51], v16 offset:1024
    v_mfma_f32_16x16x32_bf16 v[252:255], v[52:55], a[124:127], v[252:255]
    s_waitcnt lgkmcnt(2)
    ds_read_b64_tr_b16 v[52:53], v16 offset:8192
    ds_read_b64_tr_b16 v[54:55], v16 offset:9216
    v_mfma_f32_16x16x32_bf16 a[128:131], a[64:67], v[56:59], a[128:131]
    v_mfma_f32_16x16x32_bf16 a[128:131], a[68:71], v[60:63], a[128:131]
    v_add_u32 v22, 0x10000, v22
    v_mfma_f32_16x16x32_bf16 a[132:135], a[72:75], v[56:59], a[132:135]
    ds_read_b128 a[32:35], v22 offset:16384
    v_mfma_f32_16x16x32_bf16 a[132:135], a[76:79], v[60:63], a[132:135]
    v_mfma_f32_16x16x32_bf16 a[136:139], a[80:83], v[56:59], a[136:139]
    v_mfma_f32_16x16x32_bf16 a[136:139], a[84:87], v[60:63], a[136:139]
    buffer_load_dwordx4 v4, s[16:19], s60 offen offset:2048 nt lds
    v_mfma_f32_16x16x32_bf16 a[140:143], a[88:91], v[56:59], a[140:143]
    v_add_u32 v23, 0x10000, v23
    v_mfma_f32_16x16x32_bf16 a[140:143], a[92:95], v[60:63], a[140:143]
    ds_read_b128 a[36:39], v23 offset:16384
    v_mfma_f32_16x16x32_bf16 a[144:147], a[96:99], v[56:59], a[144:147]
    v_mfma_f32_16x16x32_bf16 a[144:147], a[100:103], v[60:63], a[144:147]
    v_mfma_f32_16x16x32_bf16 a[148:151], a[104:107], v[56:59], a[148:151]
    v_mfma_f32_16x16x32_bf16 a[148:151], a[108:111], v[60:63], a[148:151]
    v_mfma_f32_16x16x32_bf16 a[152:155], a[112:115], v[56:59], a[152:155]
    buffer_load_dwordx4 v5, s[16:19], s60 offen offset:3072 nt lds
    v_mfma_f32_16x16x32_bf16 a[152:155], a[116:119], v[60:63], a[152:155]
    ds_read_b128 a[40:43], v22 offset:18432
    v_mfma_f32_16x16x32_bf16 a[156:159], a[120:123], v[56:59], a[156:159]
    ds_read_b64_tr_b16 v[56:57], v17 offset:0
    ds_read_b64_tr_b16 v[58:59], v17 offset:1024
    v_mfma_f32_16x16x32_bf16 a[156:159], a[124:127], v[60:63], a[156:159]
    ds_read_b64_tr_b16 v[60:61], v17 offset:8192
    ds_read_b64_tr_b16 v[62:63], v17 offset:9216
    v_mfma_f32_16x16x32_bf16 a[160:163], a[64:67], v[40:43], a[160:163]
    v_mfma_f32_16x16x32_bf16 a[160:163], a[68:71], v[44:47], a[160:163]
    v_mfma_f32_16x16x32_bf16 a[164:167], a[72:75], v[40:43], a[164:167]
    ds_read_b128 a[44:47], v23 offset:18432
    v_mfma_f32_16x16x32_bf16 a[164:167], a[76:79], v[44:47], a[164:167]
    s_add_u32 m0, s69, 16384
    v_mfma_f32_16x16x32_bf16 a[168:171], a[80:83], v[40:43], a[168:171]
    s_xor_b32 s60, s60, 524288
    buffer_load_dwordx4 v10, s[20:23], s63 offen lds
    v_mfma_f32_16x16x32_bf16 a[168:171], a[84:87], v[44:47], a[168:171]
    v_mfma_f32_16x16x32_bf16 a[172:175], a[88:91], v[40:43], a[172:175]
    v_mfma_f32_16x16x32_bf16 a[172:175], a[92:95], v[44:47], a[172:175]
    v_mfma_f32_16x16x32_bf16 a[176:179], a[96:99], v[40:43], a[176:179]
    ds_read_b128 a[48:51], v22 offset:20480
    v_mfma_f32_16x16x32_bf16 a[176:179], a[100:103], v[44:47], a[176:179]
    v_mfma_f32_16x16x32_bf16 a[180:183], a[104:107], v[40:43], a[180:183]
    v_mfma_f32_16x16x32_bf16 a[180:183], a[108:111], v[44:47], a[180:183]
    buffer_load_dwordx4 v11, s[20:23], s63 offen offset:1024 lds
    v_mfma_f32_16x16x32_bf16 a[184:187], a[112:115], v[40:43], a[184:187]
    v_mfma_f32_16x16x32_bf16 a[184:187], a[116:119], v[44:47], a[184:187]
    ds_read_b128 a[52:55], v23 offset:20480
    v_mfma_f32_16x16x32_bf16 a[188:191], a[120:123], v[40:43], a[188:191]
    v_mfma_f32_16x16x32_bf16 a[188:191], a[124:127], v[44:47], a[188:191]
    s_waitcnt lgkmcnt(1)
    v_mfma_f32_16x16x32_bf16 a[192:195], a[64:67], v[48:51], a[192:195]
    v_mfma_f32_16x16x32_bf16 a[192:195], a[68:71], v[52:55], a[192:195]
    v_mfma_f32_16x16x32_bf16 a[196:199], a[72:75], v[48:51], a[196:199]
    v_mfma_f32_16x16x32_bf16 a[196:199], a[76:79], v[52:55], a[196:199]
    buffer_load_dwordx4 v12, s[20:23], s63 offen offset:2048 lds
    v_mfma_f32_16x16x32_bf16 a[200:203], a[80:83], v[48:51], a[200:203]
    ds_read_b128 a[56:59], v22 offset:22528
    v_mfma_f32_16x16x32_bf16 a[200:203], a[84:87], v[52:55], a[200:203]
    v_mfma_f32_16x16x32_bf16 a[204:207], a[88:91], v[48:51], a[204:207]
    v_mfma_f32_16x16x32_bf16 a[204:207], a[92:95], v[52:55], a[204:207]
    v_mfma_f32_16x16x32_bf16 a[208:211], a[96:99], v[48:51], a[208:211]
    ds_read_b128 a[60:63], v23 offset:22528
    v_mfma_f32_16x16x32_bf16 a[208:211], a[100:103], v[52:55], a[208:211]
    v_mfma_f32_16x16x32_bf16 a[212:215], a[104:107], v[48:51], a[212:215]
    buffer_load_dwordx4 v13, s[20:23], s63 offen offset:3072 lds
    v_mfma_f32_16x16x32_bf16 a[212:215], a[108:111], v[52:55], a[212:215]
    v_mfma_f32_16x16x32_bf16 a[216:219], a[112:115], v[48:51], a[216:219]
    v_mfma_f32_16x16x32_bf16 a[216:219], a[116:119], v[52:55], a[216:219]
    v_mfma_f32_16x16x32_bf16 a[220:223], a[120:123], v[48:51], a[220:223]
    v_mfma_f32_16x16x32_bf16 a[220:223], a[124:127], v[52:55], a[220:223]
    v_mfma_f32_16x16x32_bf16 a[224:227], a[64:67], v[56:59], a[224:227]
    v_mfma_f32_16x16x32_bf16 a[224:227], a[68:71], v[60:63], a[224:227]
    s_xor_b32 s63, s63, 128
    v_mfma_f32_16x16x32_bf16 a[228:231], a[72:75], v[56:59], a[228:231]
    v_mfma_f32_16x16x32_bf16 a[228:231], a[76:79], v[60:63], a[228:231]
    v_mfma_f32_16x16x32_bf16 a[232:235], a[80:83], v[56:59], a[232:235]
    v_mfma_f32_16x16x32_bf16 a[232:235], a[84:87], v[60:63], a[232:235]
    s_waitcnt vmcnt(8) lgkmcnt(0)
    s_barrier
    ds_read_b64_tr_b16 v[40:41], v14 offset:32768
    v_mfma_f32_16x16x32_bf16 a[236:239], a[88:91], v[56:59], a[236:239]
    s_add_u32 m0, s69, 32768
    ds_read_b64_tr_b16 v[42:43], v14 offset:33792
    ds_read_b64_tr_b16 v[44:45], v14 offset:40960
    v_mfma_f32_16x16x32_bf16 a[236:239], a[92:95], v[60:63], a[236:239]
    buffer_load_dwordx4 v2, s[16:19], s60 offen nt lds
    v_mfma_f32_16x16x32_bf16 a[240:243], a[96:99], v[56:59], a[240:243]
    ds_read_b64_tr_b16 v[46:47], v14 offset:41984
    ds_read_b64_tr_b16 v[48:49], v15 offset:32768
    v_mfma_f32_16x16x32_bf16 a[240:243], a[100:103], v[60:63], a[240:243]
    ds_read_b64_tr_b16 v[50:51], v15 offset:33792
    ds_read_b64_tr_b16 v[52:53], v15 offset:40960
    v_mfma_f32_16x16x32_bf16 a[244:247], a[104:107], v[56:59], a[244:247]
    ds_read_b64_tr_b16 v[54:55], v15 offset:41984
    v_add_u32 v14, 0x10000, v14
    v_mfma_f32_16x16x32_bf16 a[244:247], a[108:111], v[60:63], a[244:247]
    v_add_u32 v15, 0x10000, v15
    v_mfma_f32_16x16x32_bf16 a[248:251], a[112:115], v[56:59], a[248:251]
    v_mfma_f32_16x16x32_bf16 a[248:251], a[116:119], v[60:63], a[248:251]
    buffer_load_dwordx4 v3, s[16:19], s60 offen offset:1024 nt lds
    v_mfma_f32_16x16x32_bf16 a[252:255], a[120:123], v[56:59], a[252:255]
    ds_read_b64_tr_b16 v[56:57], v16 offset:32768
    ds_read_b64_tr_b16 v[58:59], v16 offset:33792
    v_mfma_f32_16x16x32_bf16 a[252:255], a[124:127], v[60:63], a[252:255]
    s_waitcnt lgkmcnt(2)
    ds_read_b64_tr_b16 v[60:61], v16 offset:40960
    ds_read_b64_tr_b16 v[62:63], v16 offset:41984
    v_mfma_f32_16x16x32_bf16 v[128:131], v[40:43], a[0:3], v[128:131]
    v_add_u32 v16, 0x10000, v16
    v_mfma_f32_16x16x32_bf16 v[128:131], v[44:47], a[4:7], v[128:131]
    ds_read_b128 a[64:67], v22 offset:49152
    v_mfma_f32_16x16x32_bf16 v[132:135], v[40:43], a[8:11], v[132:135]
    v_mfma_f32_16x16x32_bf16 v[132:135], v[44:47], a[12:15], v[132:135]
    v_mfma_f32_16x16x32_bf16 v[136:139], v[40:43], a[16:19], v[136:139]
    ds_read_b128 a[68:71], v23 offset:49152
    v_mfma_f32_16x16x32_bf16 v[136:139], v[44:47], a[20:23], v[136:139]
    buffer_load_dwordx4 v4, s[16:19], s60 offen offset:2048 nt lds
    v_mfma_f32_16x16x32_bf16 v[140:143], v[40:43], a[24:27], v[140:143]
    v_mfma_f32_16x16x32_bf16 v[140:143], v[44:47], a[28:31], v[140:143]
    ds_read_b128 a[72:75], v22 offset:51200
    v_mfma_f32_16x16x32_bf16 v[144:147], v[40:43], a[32:35], v[144:147]
    v_mfma_f32_16x16x32_bf16 v[144:147], v[44:47], a[36:39], v[144:147]
    v_mfma_f32_16x16x32_bf16 v[148:151], v[40:43], a[40:43], v[148:151]
    ds_read_b128 a[76:79], v23 offset:51200
    v_mfma_f32_16x16x32_bf16 v[148:151], v[44:47], a[44:47], v[148:151]
    v_mfma_f32_16x16x32_bf16 v[152:155], v[40:43], a[48:51], v[152:155]
    buffer_load_dwordx4 v5, s[16:19], s60 offen offset:3072 nt lds
    v_mfma_f32_16x16x32_bf16 v[152:155], v[44:47], a[52:55], v[152:155]
    v_mfma_f32_16x16x32_bf16 v[156:159], v[40:43], a[56:59], v[156:159]
    ds_read_b128 a[80:83], v22 offset:53248
    ds_read_b64_tr_b16 v[40:41], v17 offset:32768
    v_mfma_f32_16x16x32_bf16 v[156:159], v[44:47], a[60:63], v[156:159]
    ds_read_b64_tr_b16 v[42:43], v17 offset:33792
    ds_read_b64_tr_b16 v[44:45], v17 offset:40960
    v_mfma_f32_16x16x32_bf16 v[160:163], v[48:51], a[0:3], v[160:163]
    ds_read_b64_tr_b16 v[46:47], v17 offset:41984
    v_add_u32 v17, 0x10000, v17
    v_mfma_f32_16x16x32_bf16 v[160:163], v[52:55], a[4:7], v[160:163]
    ds_read_b128 a[84:87], v23 offset:53248
    v_mfma_f32_16x16x32_bf16 v[164:167], v[48:51], a[8:11], v[164:167]
    v_mfma_f32_16x16x32_bf16 v[164:167], v[52:55], a[12:15], v[164:167]
    s_add_u32 m0, s69, 49152
    buffer_load_dword v7, v9, s[44:47], s69 offen sc1
    v_mfma_f32_16x16x32_bf16 v[168:171], v[48:51], a[16:19], v[168:171]
    s_xor_b32 s60, s60, 3670016
    buffer_load_dwordx4 v10, s[20:23], s64 offen lds
    v_mfma_f32_16x16x32_bf16 v[168:171], v[52:55], a[20:23], v[168:171]
    ds_read_b128 a[88:91], v22 offset:55296
    v_mfma_f32_16x16x32_bf16 v[172:175], v[48:51], a[24:27], v[172:175]
    v_mfma_f32_16x16x32_bf16 v[172:175], v[52:55], a[28:31], v[172:175]
    s_waitcnt lgkmcnt(1)
    ds_read_b128 a[92:95], v23 offset:55296
    v_mfma_f32_16x16x32_bf16 v[176:179], v[48:51], a[32:35], v[176:179]
    v_mfma_f32_16x16x32_bf16 v[176:179], v[52:55], a[36:39], v[176:179]
    v_mfma_f32_16x16x32_bf16 v[180:183], v[48:51], a[40:43], v[180:183]
    v_mfma_f32_16x16x32_bf16 v[180:183], v[52:55], a[44:47], v[180:183]
    buffer_load_dwordx4 v11, s[20:23], s64 offen offset:1024 lds
    v_mfma_f32_16x16x32_bf16 v[184:187], v[48:51], a[48:51], v[184:187]
    v_add_u32 v22, 0x10000, v22
    ds_read_b128 a[96:99], v22 offset:16384
    v_mfma_f32_16x16x32_bf16 v[184:187], v[52:55], a[52:55], v[184:187]
    v_mfma_f32_16x16x32_bf16 v[188:191], v[48:51], a[56:59], v[188:191]
    v_add_u32 v23, 0x10000, v23
    ds_read_b64_tr_b16 v[48:49], v14 offset:0
    v_mfma_f32_16x16x32_bf16 v[188:191], v[52:55], a[60:63], v[188:191]
    ds_read_b128 a[100:103], v23 offset:16384
    ds_read_b64_tr_b16 v[50:51], v14 offset:1024
    v_mfma_f32_16x16x32_bf16 v[192:195], v[56:59], a[0:3], v[192:195]
    ds_read_b64_tr_b16 v[52:53], v14 offset:8192
    ds_read_b64_tr_b16 v[54:55], v14 offset:9216
    v_mfma_f32_16x16x32_bf16 v[192:195], v[60:63], a[4:7], v[192:195]
    v_add_u32 v14, 0xfffe0000, v14
    v_mfma_f32_16x16x32_bf16 v[196:199], v[56:59], a[8:11], v[196:199]
    ds_read_b128 a[104:107], v22 offset:18432
    v_mfma_f32_16x16x32_bf16 v[196:199], v[60:63], a[12:15], v[196:199]
    buffer_load_dwordx4 v12, s[20:23], s64 offen offset:2048 lds
    v_mfma_f32_16x16x32_bf16 v[200:203], v[56:59], a[16:19], v[200:203]
    v_mfma_f32_16x16x32_bf16 v[200:203], v[60:63], a[20:23], v[200:203]
    ds_read_b128 a[108:111], v23 offset:18432
    v_mfma_f32_16x16x32_bf16 v[204:207], v[56:59], a[24:27], v[204:207]
    v_mfma_f32_16x16x32_bf16 v[204:207], v[60:63], a[28:31], v[204:207]
    v_mfma_f32_16x16x32_bf16 v[208:211], v[56:59], a[32:35], v[208:211]
    v_mfma_f32_16x16x32_bf16 v[208:211], v[60:63], a[36:39], v[208:211]
    ds_read_b128 a[112:115], v22 offset:20480
    v_mfma_f32_16x16x32_bf16 v[212:215], v[56:59], a[40:43], v[212:215]
    buffer_load_dwordx4 v13, s[20:23], s64 offen offset:3072 lds
    v_mfma_f32_16x16x32_bf16 v[212:215], v[60:63], a[44:47], v[212:215]
    v_mfma_f32_16x16x32_bf16 v[216:219], v[56:59], a[48:51], v[216:219]
    ds_read_b128 a[116:119], v23 offset:20480
    v_mfma_f32_16x16x32_bf16 v[216:219], v[60:63], a[52:55], v[216:219]
    v_mfma_f32_16x16x32_bf16 v[220:223], v[56:59], a[56:59], v[220:223]
    ds_read_b64_tr_b16 v[56:57], v15 offset:0
    ds_read_b64_tr_b16 v[58:59], v15 offset:1024
    v_mfma_f32_16x16x32_bf16 v[220:223], v[60:63], a[60:63], v[220:223]
    s_waitcnt lgkmcnt(3)
    ds_read_b128 a[120:123], v22 offset:22528
    ds_read_b64_tr_b16 v[60:61], v15 offset:8192
    v_mfma_f32_16x16x32_bf16 v[224:227], v[40:43], a[0:3], v[224:227]
    ds_read_b64_tr_b16 v[62:63], v15 offset:9216
    v_add_u32 v15, 0xfffe0000, v15
    v_mfma_f32_16x16x32_bf16 v[224:227], v[44:47], a[4:7], v[224:227]
    s_xor_b32 s64, s64, 128
    v_mfma_f32_16x16x32_bf16 v[228:231], v[40:43], a[8:11], v[228:231]
    ds_read_b128 a[124:127], v23 offset:22528
    v_mfma_f32_16x16x32_bf16 v[228:231], v[44:47], a[12:15], v[228:231]
    v_mfma_f32_16x16x32_bf16 v[232:235], v[40:43], a[16:19], v[232:235]
    v_mfma_f32_16x16x32_bf16 v[232:235], v[44:47], a[20:23], v[232:235]
    s_add_u32 m0, s69, 65536
    v_mfma_f32_16x16x32_bf16 v[236:239], v[40:43], a[24:27], v[236:239]
    buffer_load_dwordx4 v2, s[24:27], s60 offen lds
    v_mfma_f32_16x16x32_bf16 v[236:239], v[44:47], a[28:31], v[236:239]
    v_mfma_f32_16x16x32_bf16 v[240:243], v[40:43], a[32:35], v[240:243]
    v_mfma_f32_16x16x32_bf16 v[240:243], v[44:47], a[36:39], v[240:243]
    v_mfma_f32_16x16x32_bf16 v[244:247], v[40:43], a[40:43], v[244:247]
    v_mfma_f32_16x16x32_bf16 v[244:247], v[44:47], a[44:47], v[244:247]
    v_mfma_f32_16x16x32_bf16 v[248:251], v[40:43], a[48:51], v[248:251]
    v_mfma_f32_16x16x32_bf16 v[248:251], v[44:47], a[52:55], v[248:251]
    buffer_load_dwordx4 v3, s[24:27], s60 offen offset:1024 lds
    v_mfma_f32_16x16x32_bf16 v[252:255], v[40:43], a[56:59], v[252:255]
    ds_read_b64_tr_b16 v[40:41], v16 offset:0
    ds_read_b64_tr_b16 v[42:43], v16 offset:1024
    v_mfma_f32_16x16x32_bf16 v[252:255], v[44:47], a[60:63], v[252:255]
    ds_read_b64_tr_b16 v[44:45], v16 offset:8192
    ds_read_b64_tr_b16 v[46:47], v16 offset:9216
    v_mfma_f32_16x16x32_bf16 v[128:131], v[48:51], a[64:67], v[128:131]
    v_add_u32 v16, 0xfffe0000, v16
    v_mfma_f32_16x16x32_bf16 v[128:131], v[52:55], a[68:71], v[128:131]
    v_mfma_f32_16x16x32_bf16 v[132:135], v[48:51], a[72:75], v[132:135]
    v_mfma_f32_16x16x32_bf16 v[132:135], v[52:55], a[76:79], v[132:135]
    v_mfma_f32_16x16x32_bf16 v[136:139], v[48:51], a[80:83], v[136:139]
    v_mfma_f32_16x16x32_bf16 v[136:139], v[52:55], a[84:87], v[136:139]
    buffer_load_dwordx4 v4, s[24:27], s60 offen offset:2048 lds
    v_mfma_f32_16x16x32_bf16 v[140:143], v[48:51], a[88:91], v[140:143]
    v_mfma_f32_16x16x32_bf16 v[140:143], v[52:55], a[92:95], v[140:143]
    v_mfma_f32_16x16x32_bf16 v[144:147], v[48:51], a[96:99], v[144:147]
    v_mul_f32 v128, s74, v128
    v_mul_f32 v129, s74, v129
    v_mfma_f32_16x16x32_bf16 v[144:147], v[52:55], a[100:103], v[144:147]
    v_mul_f32 v130, s74, v130
    v_mul_f32 v131, s74, v131
    v_mfma_f32_16x16x32_bf16 v[148:151], v[48:51], a[104:107], v[148:151]
    v_cvt_pk_bf16_f32 v128, v128, v129
    v_cvt_pk_bf16_f32 v129, v130, v131
    v_mfma_f32_16x16x32_bf16 v[148:151], v[52:55], a[108:111], v[148:151]
    v_mul_f32 v132, s74, v132
    v_mul_f32 v133, s74, v133
    v_mfma_f32_16x16x32_bf16 v[152:155], v[48:51], a[112:115], v[152:155]
    s_waitcnt lgkmcnt(0)
    buffer_load_dwordx4 v5, s[24:27], s60 offen offset:3072 lds
    v_mfma_f32_16x16x32_bf16 v[152:155], v[52:55], a[116:119], v[152:155]
    v_mul_f32 v134, s74, v134
    v_mul_f32 v135, s74, v135
    v_mfma_f32_16x16x32_bf16 v[156:159], v[48:51], a[120:123], v[156:159]
    ds_read_b64_tr_b16 v[48:49], v17 offset:0
    ds_read_b64_tr_b16 v[50:51], v17 offset:1024
    v_mfma_f32_16x16x32_bf16 v[156:159], v[52:55], a[124:127], v[156:159]
    ds_read_b64_tr_b16 v[52:53], v17 offset:8192
    ds_read_b64_tr_b16 v[54:55], v17 offset:9216
    v_mfma_f32_16x16x32_bf16 v[160:163], v[56:59], a[64:67], v[160:163]
    v_add_u32 v17, 0xfffe0000, v17
    v_cvt_pk_bf16_f32 v132, v132, v133
    v_mfma_f32_16x16x32_bf16 v[160:163], v[60:63], a[68:71], v[160:163]
    v_cvt_pk_bf16_f32 v133, v134, v135
    v_mul_f32 v136, s74, v136
    v_mfma_f32_16x16x32_bf16 v[164:167], v[56:59], a[72:75], v[164:167]
    v_mul_f32 v137, s74, v137
    v_mul_f32 v138, s74, v138
    v_mfma_f32_16x16x32_bf16 v[164:167], v[60:63], a[76:79], v[164:167]
    s_add_u32 m0, s69, 81920
    v_mul_f32 v139, s74, v139
    v_mul_f32 v160, s74, v160
    v_mfma_f32_16x16x32_bf16 v[168:171], v[56:59], a[80:83], v[168:171]
    s_xor_b32 s60, s60, 524288
    buffer_load_dwordx4 v10, s[20:23], s63 offen lds
    v_mfma_f32_16x16x32_bf16 v[168:171], v[60:63], a[84:87], v[168:171]
    v_mul_f32 v161, s74, v161
    v_mul_f32 v162, s74, v162
    v_mfma_f32_16x16x32_bf16 v[172:175], v[56:59], a[88:91], v[172:175]
    v_mul_f32 v163, s74, v163
    v_cvt_pk_bf16_f32 v130, v160, v161
    v_mfma_f32_16x16x32_bf16 v[172:175], v[60:63], a[92:95], v[172:175]
    v_cvt_pk_bf16_f32 v131, v162, v163
    v_mul_f32 v164, s74, v164
    v_mfma_f32_16x16x32_bf16 v[176:179], v[56:59], a[96:99], v[176:179]
    v_mul_f32 v165, s74, v165
    v_mul_f32 v166, s74, v166
    v_mfma_f32_16x16x32_bf16 v[176:179], v[60:63], a[100:103], v[176:179]
    v_mul_f32 v167, s74, v167
    v_cvt_pk_bf16_f32 v134, v164, v165
    v_mfma_f32_16x16x32_bf16 v[180:183], v[56:59], a[104:107], v[180:183]
    v_cvt_pk_bf16_f32 v135, v166, v167
    v_mul_f32 v168, s74, v168
    v_mfma_f32_16x16x32_bf16 v[180:183], v[60:63], a[108:111], v[180:183]
    buffer_load_dwordx4 v11, s[20:23], s63 offen offset:1024 lds
    v_mfma_f32_16x16x32_bf16 v[184:187], v[56:59], a[112:115], v[184:187]
    v_mul_f32 v169, s74, v169
    v_mul_f32 v170, s74, v170
    v_mfma_f32_16x16x32_bf16 v[184:187], v[60:63], a[116:119], v[184:187]
    v_mul_f32 v171, s74, v171
    v_cvt_pk_bf16_f32 v136, v136, v137
    v_mfma_f32_16x16x32_bf16 v[188:191], v[56:59], a[120:123], v[188:191]
    v_cvt_pk_bf16_f32 v137, v138, v139
    v_cvt_pk_bf16_f32 v138, v168, v169
    v_mfma_f32_16x16x32_bf16 v[188:191], v[60:63], a[124:127], v[188:191]
    v_cvt_pk_bf16_f32 v139, v170, v171
    v_mul_f32 v140, s74, v140
    v_mfma_f32_16x16x32_bf16 v[192:195], v[40:43], a[64:67], v[192:195]
    v_mul_f32 v141, s74, v141
    v_mul_f32 v142, s74, v142
    v_mfma_f32_16x16x32_bf16 v[192:195], v[44:47], a[68:71], v[192:195]
    v_mul_f32 v143, s74, v143
    v_mul_f32 v172, s74, v172
    v_mfma_f32_16x16x32_bf16 v[196:199], v[40:43], a[72:75], v[196:199]
    v_mul_f32 v173, s74, v173
    v_mul_f32 v174, s74, v174
    v_mfma_f32_16x16x32_bf16 v[196:199], v[44:47], a[76:79], v[196:199]
    buffer_load_dwordx4 v12, s[20:23], s63 offen offset:2048 lds
    v_mfma_f32_16x16x32_bf16 v[200:203], v[40:43], a[80:83], v[200:203]
    v_mul_f32 v175, s74, v175
    v_cvt_pk_bf16_f32 v140, v140, v141
    v_mfma_f32_16x16x32_bf16 v[200:203], v[44:47], a[84:87], v[200:203]
    v_cvt_pk_bf16_f32 v141, v142, v143
    v_cvt_pk_bf16_f32 v142, v172, v173
    v_mfma_f32_16x16x32_bf16 v[204:207], v[40:43], a[88:91], v[204:207]
    v_cvt_pk_bf16_f32 v143, v174, v175
    v_mul_f32 v144, s74, v144
    v_mfma_f32_16x16x32_bf16 v[204:207], v[44:47], a[92:95], v[204:207]
    v_mul_f32 v145, s74, v145
    v_mul_f32 v146, s74, v146
    v_mfma_f32_16x16x32_bf16 v[208:211], v[40:43], a[96:99], v[208:211]
    v_mul_f32 v147, s74, v147
    v_mul_f32 v176, s74, v176
    v_mfma_f32_16x16x32_bf16 v[208:211], v[44:47], a[100:103], v[208:211]
    v_mul_f32 v177, s74, v177
    v_mul_f32 v178, s74, v178
    v_mfma_f32_16x16x32_bf16 v[212:215], v[40:43], a[104:107], v[212:215]
    buffer_load_dwordx4 v13, s[20:23], s63 offen offset:3072 lds
    v_mfma_f32_16x16x32_bf16 v[212:215], v[44:47], a[108:111], v[212:215]
    v_mul_f32 v179, s74, v179
    v_cvt_pk_bf16_f32 v144, v144, v145
    v_mfma_f32_16x16x32_bf16 v[216:219], v[40:43], a[112:115], v[216:219]
    v_cvt_pk_bf16_f32 v145, v146, v147
    v_cvt_pk_bf16_f32 v146, v176, v177
    v_mfma_f32_16x16x32_bf16 v[216:219], v[44:47], a[116:119], v[216:219]
    v_cvt_pk_bf16_f32 v147, v178, v179
    v_mul_f32 v148, s74, v148
    v_mfma_f32_16x16x32_bf16 v[220:223], v[40:43], a[120:123], v[220:223]
    v_mul_f32 v149, s74, v149
    v_mul_f32 v150, s74, v150
    v_mfma_f32_16x16x32_bf16 v[220:223], v[44:47], a[124:127], v[220:223]
    s_add_u32 s72, s70, 0
    v_mul_f32 v151, s74, v151
    v_mul_f32 v180, s74, v180
    s_waitcnt lgkmcnt(0)
    v_mfma_f32_16x16x32_bf16 v[224:227], v[48:51], a[64:67], v[224:227]
    buffer_store_dwordx4 v[128:131], v1, s[36:39], s72 offen sc1
    v_mfma_f32_16x16x32_bf16 v[224:227], v[52:55], a[68:71], v[224:227]
    s_xor_b32 s63, s63, 384
    v_mul_f32 v181, s74, v181
    v_mul_f32 v182, s74, v182
    v_mfma_f32_16x16x32_bf16 v[228:231], v[48:51], a[72:75], v[228:231]
    v_mul_f32 v183, s74, v183
    v_cvt_pk_bf16_f32 v148, v148, v149
    v_mfma_f32_16x16x32_bf16 v[228:231], v[52:55], a[76:79], v[228:231]
    v_cvt_pk_bf16_f32 v149, v150, v151
    v_cvt_pk_bf16_f32 v150, v180, v181
    v_mfma_f32_16x16x32_bf16 v[232:235], v[48:51], a[80:83], v[232:235]
    v_cvt_pk_bf16_f32 v151, v182, v183
    v_mul_f32 v152, s74, v152
    v_mfma_f32_16x16x32_bf16 v[232:235], v[52:55], a[84:87], v[232:235]
    s_add_u32 m0, s67, 98304
    v_mul_f32 v153, s74, v153
    v_mul_f32 v154, s74, v154
    s_waitcnt vmcnt(9) lgkmcnt(0)
    v_cmp_gt_u32 vcc, 8, v7
    s_nop 1
    s_and_b64 vcc, vcc, s[86:87]
    s_cbranch_scc1 SPIN_WA
BACK_WA:
    s_barrier
    v_mfma_f32_16x16x32_bf16 v[236:239], v[48:51], a[88:91], v[236:239]
    buffer_load_dwordx4 v1, s[28:31], s65 offen sc1 lds
    v_mfma_f32_16x16x32_bf16 v[236:239], v[52:55], a[92:95], v[236:239]
    ds_read_b64_tr_b16 v[56:57], v14 offset:0
    ds_read_b64_tr_b16 v[58:59], v14 offset:1024
    v_mfma_f32_16x16x32_bf16 v[240:243], v[48:51], a[96:99], v[240:243]
    ds_read_b64_tr_b16 v[60:61], v14 offset:8192
    ds_read_b64_tr_b16 v[62:63], v14 offset:9216
    v_mfma_f32_16x16x32_bf16 v[240:243], v[52:55], a[100:103], v[240:243]
    ds_read_b64_tr_b16 v[40:41], v15 offset:0
    ds_read_b64_tr_b16 v[42:43], v15 offset:1024
    v_mfma_f32_16x16x32_bf16 v[244:247], v[48:51], a[104:107], v[244:247]
    ds_read_b64_tr_b16 v[44:45], v15 offset:8192
    ds_read_b64_tr_b16 v[46:47], v15 offset:9216
    v_mfma_f32_16x16x32_bf16 v[244:247], v[52:55], a[108:111], v[244:247]
    v_mul_f32 v155, s74, v155
    v_mul_f32 v184, s74, v184
    v_mfma_f32_16x16x32_bf16 v[248:251], v[48:51], a[112:115], v[248:251]
    v_mul_f32 v185, s74, v185
    v_mul_f32 v186, s74, v186
    v_mfma_f32_16x16x32_bf16 v[248:251], v[52:55], a[116:119], v[248:251]
    v_mul_f32 v187, s74, v187
    v_cvt_pk_bf16_f32 v152, v152, v153
    v_mfma_f32_16x16x32_bf16 v[252:255], v[48:51], a[120:123], v[252:255]
    s_lshr_b32 s92, s2, 3
    v_lshrrev_b32 v9, 4, v1
    v_min_u32 v9, 0, v9
    v_mfma_f32_16x16x32_bf16 v[252:255], v[52:55], a[124:127], v[252:255]
    s_lshl2_add_u32 s92, s92, s4
    ds_read_b64_tr_b16 v[48:49], v16 offset:0
    ds_read_b64_tr_b16 v[50:51], v16 offset:1024
    s_waitcnt lgkmcnt(2)
    v_mfma_f32_16x16x32_bf16 a[128:131], a[0:3], v[56:59], a[128:131]
    s_mul_i32 s92, s92, 1
    buffer_load_dwordx4 v1, s[28:31], s65 offen offset:1024 sc1 lds
    v_mfma_f32_16x16x32_bf16 a[128:131], a[4:7], v[60:63], a[128:131]
    s_add_u32 s92, s92, 32
    v_add_lshl_u32 v9, v9, s92, 7
    ds_read_b64_tr_b16 v[52:53], v16 offset:8192
    v_mfma_f32_16x16x32_bf16 a[132:135], a[8:11], v[56:59], a[132:135]
    s_getpc_b64 s[92:93]
    global_load_dword v9, v9, s[92:93]
    v_mfma_f32_16x16x32_bf16 a[132:135], a[12:15], v[60:63], a[132:135]
    ds_read_b128 v[64:67], v24 offset:16384
    ds_read_b64_tr_b16 v[54:55], v16 offset:9216
    v_mfma_f32_16x16x32_bf16 a[136:139], a[16:19], v[56:59], a[136:139]
    v_cvt_pk_bf16_f32 v153, v154, v155
    v_cvt_pk_bf16_f32 v154, v184, v185
    v_mfma_f32_16x16x32_bf16 a[136:139], a[20:23], v[60:63], a[136:139]
    v_cvt_pk_bf16_f32 v155, v186, v187
    v_mul_f32 v156, s74, v156
    v_mfma_f32_16x16x32_bf16 a[140:143], a[24:27], v[56:59], a[140:143]
    v_mul_f32 v157, s74, v157
    v_mul_f32 v158, s74, v158
    v_mfma_f32_16x16x32_bf16 a[140:143], a[28:31], v[60:63], a[140:143]
    s_add_u32 s72, s70, 4096
    v_mul_f32 v159, s74, v159
    v_mul_f32 v188, s74, v188
    v_mfma_f32_16x16x32_bf16 a[144:147], a[32:35], v[56:59], a[144:147]
    buffer_store_dwordx4 v[132:135], v1, s[36:39], s72 offen sc1
    v_mfma_f32_16x16x32_bf16 a[144:147], a[36:39], v[60:63], a[144:147]
    s_add_u32 m0, s69, 114688
    v_mul_f32 v189, s74, v189
    v_mul_f32 v190, s74, v190
    v_mfma_f32_16x16x32_bf16 a[148:151], a[40:43], v[56:59], a[148:151]
    s_xor_b32 s65, s65, 8192
    buffer_load_dwordx4 v10, s[20:23], s64 offen lds
    v_mfma_f32_16x16x32_bf16 a[148:151], a[44:47], v[60:63], a[148:151]
    v_mul_f32 v191, s74, v191
    v_cvt_pk_bf16_f32 v156, v156, v157
    v_mfma_f32_16x16x32_bf16 a[152:155], a[48:51], v[56:59], a[152:155]
    v_cvt_pk_bf16_f32 v157, v158, v159
    v_cvt_pk_bf16_f32 v158, v188, v189
    v_mfma_f32_16x16x32_bf16 a[152:155], a[52:55], v[60:63], a[152:155]
    ds_read_b128 v[68:71], v25 offset:16384
    v_cvt_pk_bf16_f32 v159, v190, v191
    v_mfma_f32_16x16x32_bf16 a[156:159], a[56:59], v[56:59], a[156:159]
    ds_read_b64_tr_b16 v[56:57], v17 offset:0
    ds_read_b64_tr_b16 v[58:59], v17 offset:1024
    v_mfma_f32_16x16x32_bf16 a[156:159], a[60:63], v[60:63], a[156:159]
    ds_read_b64_tr_b16 v[60:61], v17 offset:8192
    ds_read_b64_tr_b16 v[62:63], v17 offset:9216
    v_mfma_f32_16x16x32_bf16 a[160:163], a[0:3], v[40:43], a[160:163]
    v_mul_f32 v192, s74, v192
    v_mul_f32 v193, s74, v193
    v_mfma_f32_16x16x32_bf16 a[160:163], a[4:7], v[44:47], a[160:163]
    v_mul_f32 v194, s74, v194
    v_mul_f32 v195, s74, v195
    v_mfma_f32_16x16x32_bf16 a[164:167], a[8:11], v[40:43], a[164:167]
    v_mul_f32 v224, s74, v224
    v_mul_f32 v225, s74, v225
    v_mfma_f32_16x16x32_bf16 a[164:167], a[12:15], v[44:47], a[164:167]
    v_mul_f32 v226, s74, v226
    v_mul_f32 v227, s74, v227
    v_mfma_f32_16x16x32_bf16 a[168:171], a[16:19], v[40:43], a[168:171]
    buffer_load_dwordx4 v11, s[20:23], s64 offen offset:1024 lds
    v_mfma_f32_16x16x32_bf16 a[168:171], a[20:23], v[44:47], a[168:171]
    v_cvt_pk_bf16_f32 v192, v192, v193
    v_cvt_pk_bf16_f32 v193, v194, v195
    v_mfma_f32_16x16x32_bf16 a[172:175], a[24:27], v[40:43], a[172:175]
    v_cvt_pk_bf16_f32 v194, v224, v225
    v_cvt_pk_bf16_f32 v195, v226, v227
    v_mfma_f32_16x16x32_bf16 a[172:175], a[28:31], v[44:47], a[172:175]
    v_mul_f32 v196, s74, v196
    v_mul_f32 v197, s74, v197
    v_mfma_f32_16x16x32_bf16 a[176:179], a[32:35], v[40:43], a[176:179]
    ds_read_b128 v[72:75], v24 offset:24576
    v_mul_f32 v198, s74, v198
    v_mfma_f32_16x16x32_bf16 a[176:179], a[36:39], v[44:47], a[176:179]
    v_mul_f32 v199, s74, v199
    v_mul_f32 v228, s74, v228
    v_mfma_f32_16x16x32_bf16 a[180:183], a[40:43], v[40:43], a[180:183]
    v_mul_f32 v229, s74, v229
    v_mul_f32 v230, s74, v230
    v_mfma_f32_16x16x32_bf16 a[180:183], a[44:47], v[44:47], a[180:183]
    v_mul_f32 v231, s74, v231
    v_cvt_pk_bf16_f32 v196, v196, v197
    v_mfma_f32_16x16x32_bf16 a[184:187], a[48:51], v[40:43], a[184:187]
    v_cvt_pk_bf16_f32 v197, v198, v199
    v_cvt_pk_bf16_f32 v198, v228, v229
    v_mfma_f32_16x16x32_bf16 a[184:187], a[52:55], v[44:47], a[184:187]
    v_cvt_pk_bf16_f32 v199, v230, v231
    v_mul_f32 v200, s74, v200
    v_mfma_f32_16x16x32_bf16 a[188:191], a[56:59], v[40:43], a[188:191]
    buffer_load_dwordx4 v12, s[20:23], s64 offen offset:2048 lds
    v_mfma_f32_16x16x32_bf16 a[188:191], a[60:63], v[44:47], a[188:191]
    s_add_u32 s72, s70, 8192
    ds_read_b64_tr_b16 v[40:41], v14 offset:32768
    ds_read_b64_tr_b16 v[42:43], v14 offset:33792
    s_waitcnt lgkmcnt(2)
    v_mfma_f32_16x16x32_bf16 a[192:195], a[0:3], v[48:51], a[192:195]
    ds_read_b64_tr_b16 v[44:45], v14 offset:40960
    ds_read_b64_tr_b16 v[46:47], v14 offset:41984
    v_mfma_f32_16x16x32_bf16 a[192:195], a[4:7], v[52:55], a[192:195]
    v_xor_b32 v14, s73, v14
    v_add_u32 v14, 0x10000, v14
    v_mfma_f32_16x16x32_bf16 a[196:199], a[8:11], v[48:51], a[196:199]
    buffer_store_dwordx4 v[136:139], v1, s[36:39], s72 offen sc1
    v_mfma_f32_16x16x32_bf16 a[196:199], a[12:15], v[52:55], a[196:199]
    ds_read_b128 v[76:79], v25 offset:24576
    v_mul_f32 v201, s74, v201
    v_mfma_f32_16x16x32_bf16 a[200:203], a[16:19], v[48:51], a[200:203]
    v_mul_f32 v202, s74, v202
    v_mul_f32 v203, s74, v203
    v_mfma_f32_16x16x32_bf16 a[200:203], a[20:23], v[52:55], a[200:203]
    v_mul_f32 v232, s74, v232
    v_mul_f32 v233, s74, v233
    v_mfma_f32_16x16x32_bf16 a[204:207], a[24:27], v[48:51], a[204:207]
    v_mul_f32 v234, s74, v234
    v_mul_f32 v235, s74, v235
    v_mfma_f32_16x16x32_bf16 a[204:207], a[28:31], v[52:55], a[204:207]
    v_cvt_pk_bf16_f32 v200, v200, v201
    v_cvt_pk_bf16_f32 v201, v202, v203
    v_mfma_f32_16x16x32_bf16 a[208:211], a[32:35], v[48:51], a[208:211]
    buffer_load_dwordx4 v13, s[20:23], s64 offen offset:3072 lds
    v_mfma_f32_16x16x32_bf16 a[208:211], a[36:39], v[52:55], a[208:211]
    v_cvt_pk_bf16_f32 v202, v232, v233
    v_cvt_pk_bf16_f32 v203, v234, v235
    v_mfma_f32_16x16x32_bf16 a[212:215], a[40:43], v[48:51], a[212:215]
    v_mul_f32 v204, s74, v204
    v_mul_f32 v205, s74, v205
    v_mfma_f32_16x16x32_bf16 a[212:215], a[44:47], v[52:55], a[212:215]
    v_mul_f32 v206, s74, v206
    v_mul_f32 v207, s74, v207
    v_mfma_f32_16x16x32_bf16 a[216:219], a[48:51], v[48:51], a[216:219]
    v_mul_f32 v236, s74, v236
    v_mul_f32 v237, s74, v237
    v_mfma_f32_16x16x32_bf16 a[216:219], a[52:55], v[52:55], a[216:219]
    v_mul_f32 v238, s74, v238
    v_mul_f32 v239, s74, v239
    v_mfma_f32_16x16x32_bf16 a[220:223], a[56:59], v[48:51], a[220:223]
    ds_read_b64_tr_b16 v[48:49], v15 offset:32768
    ds_read_b64_tr_b16 v[50:51], v15 offset:33792
    v_mfma_f32_16x16x32_bf16 a[220:223], a[60:63], v[52:55], a[220:223]
    ds_read_b64_tr_b16 v[52:53], v15 offset:40960
    ds_read_b64_tr_b16 v[54:55], v15 offset:41984
    v_mfma_f32_16x16x32_bf16 a[224:227], a[0:3], v[56:59], a[224:227]
    v_xor_b32 v15, s73, v15
    v_add_u32 v15, 0x10000, v15
    v_mfma_f32_16x16x32_bf16 a[224:227], a[4:7], v[60:63], a[224:227]
    s_xor_b32 s64, s64, 384
    v_accvgpr_write_b32 a4, v192
    v_accvgpr_write_b32 a5, v193
    v_mfma_f32_16x16x32_bf16 a[228:231], a[8:11], v[56:59], a[228:231]
    v_accvgpr_write_b32 a6, v194
    v_accvgpr_write_b32 a7, v195
    v_mfma_f32_16x16x32_bf16 a[228:231], a[12:15], v[60:63], a[228:231]
    v_accvgpr_write_b32 a12, v196
    v_accvgpr_write_b32 a13, v197
    v_mfma_f32_16x16x32_bf16 a[232:235], a[16:19], v[56:59], a[232:235]
    v_accvgpr_write_b32 a14, v198
    v_accvgpr_write_b32 a15, v199
    v_mfma_f32_16x16x32_bf16 a[232:235], a[20:23], v[60:63], a[232:235]
    s_add_u32 m0, s69, 131072
    v_accvgpr_write_b32 a20, v200
    v_accvgpr_write_b32 a21, v201
    v_mfma_f32_16x16x32_bf16 a[236:239], a[24:27], v[56:59], a[236:239]
    buffer_load_dwordx4 v2, s[24:27], s60 offen lds
    v_mfma_f32_16x16x32_bf16 a[236:239], a[28:31], v[60:63], a[236:239]
    s_add_u32 s72, s70, 12288
    v_accvgpr_write_b32 a22, v202
    v_accvgpr_write_b32 a23, v203
    v_mfma_f32_16x16x32_bf16 a[240:243], a[32:35], v[56:59], a[240:243]
    buffer_store_dwordx4 v[140:143], v1, s[36:39], s72 offen sc1
    v_mfma_f32_16x16x32_bf16 a[240:243], a[36:39], v[60:63], a[240:243]
    v_cvt_pk_bf16_f32 v204, v204, v205
    v_cvt_pk_bf16_f32 v205, v206, v207
    v_mfma_f32_16x16x32_bf16 a[244:247], a[40:43], v[56:59], a[244:247]
    v_accvgpr_write_b32 a40, v148
    v_accvgpr_write_b32 a41, v149
    v_mfma_f32_16x16x32_bf16 a[244:247], a[44:47], v[60:63], a[244:247]
    v_accvgpr_write_b32 a42, v150
    v_accvgpr_write_b32 a43, v151
    v_mfma_f32_16x16x32_bf16 a[248:251], a[48:51], v[56:59], a[248:251]
    v_accvgpr_write_b32 a48, v152
    v_accvgpr_write_b32 a49, v153
    v_mfma_f32_16x16x32_bf16 a[248:251], a[52:55], v[60:63], a[248:251]
    buffer_load_dwordx4 v3, s[24:27], s60 offen offset:1024 lds
    v_mfma_f32_16x16x32_bf16 a[252:255], a[56:59], v[56:59], a[252:255]
    ds_read_b64_tr_b16 v[56:57], v16 offset:32768
    ds_read_b64_tr_b16 v[58:59], v16 offset:33792
    v_mfma_f32_16x16x32_bf16 a[252:255], a[60:63], v[60:63], a[252:255]
    s_waitcnt lgkmcnt(2)
    ds_read_b64_tr_b16 v[60:61], v16 offset:40960
    ds_read_b64_tr_b16 v[62:63], v16 offset:41984
    v_mfma_f32_16x16x32_bf16 a[128:131], a[64:67], v[40:43], a[128:131]
    v_xor_b32 v16, s73, v16
    v_add_u32 v16, 0x10000, v16
    v_mfma_f32_16x16x32_bf16 a[128:131], a[68:71], v[44:47], a[128:131]
    v_accvgpr_write_b32 a50, v154
    v_accvgpr_write_b32 a51, v155
    v_mfma_f32_16x16x32_bf16 a[132:135], a[72:75], v[40:43], a[132:135]
    ds_read_b128 v[80:83], v24 offset:49152
    v_accvgpr_write_b32 a56, v156
    v_mfma_f32_16x16x32_bf16 a[132:135], a[76:79], v[44:47], a[132:135]
    v_accvgpr_write_b32 a57, v157
    v_accvgpr_write_b32 a58, v158
    v_mfma_f32_16x16x32_bf16 a[136:139], a[80:83], v[40:43], a[136:139]
    v_accvgpr_write_b32 a59, v159
    v_cvt_pk_bf16_f32 v206, v236, v237
    v_mfma_f32_16x16x32_bf16 a[136:139], a[84:87], v[44:47], a[136:139]
    buffer_load_dwordx4 v4, s[24:27], s60 offen offset:2048 lds
    v_mfma_f32_16x16x32_bf16 a[140:143], a[88:91], v[40:43], a[140:143]
    v_cvt_pk_bf16_f32 v207, v238, v239
    v_mul_f32 v208, s74, v208
    v_mfma_f32_16x16x32_bf16 a[140:143], a[92:95], v[44:47], a[140:143]
    v_mul_f32 v209, s74, v209
    v_mul_f32 v210, s74, v210
    v_mfma_f32_16x16x32_bf16 a[144:147], a[96:99], v[40:43], a[144:147]
    v_mul_f32 v211, s74, v211
    v_mul_f32 v240, s74, v240
    v_mfma_f32_16x16x32_bf16 a[144:147], a[100:103], v[44:47], a[144:147]
    v_mul_f32 v241, s74, v241
    v_mul_f32 v242, s74, v242
    v_mfma_f32_16x16x32_bf16 a[148:151], a[104:107], v[40:43], a[148:151]
    v_mul_f32 v243, s74, v243
    v_accvgpr_write_b32 a28, v204
    v_mfma_f32_16x16x32_bf16 a[148:151], a[108:111], v[44:47], a[148:151]
    v_accvgpr_write_b32 a29, v205
    v_accvgpr_write_b32 a30, v206
    v_mfma_f32_16x16x32_bf16 a[152:155], a[112:115], v[40:43], a[152:155]
    buffer_load_dwordx4 v5, s[24:27], s60 offen offset:3072 lds
    v_mfma_f32_16x16x32_bf16 a[152:155], a[116:119], v[44:47], a[152:155]
    ds_read_b128 v[84:87], v25 offset:49152
    v_accvgpr_write_b32 a31, v207
    v_mfma_f32_16x16x32_bf16 a[156:159], a[120:123], v[40:43], a[156:159]
    ds_read_b64_tr_b16 v[40:41], v17 offset:32768
    ds_read_b64_tr_b16 v[42:43], v17 offset:33792
    v_mfma_f32_16x16x32_bf16 a[156:159], a[124:127], v[44:47], a[156:159]
    s_add_u32 s72, s70, 32768
    ds_read_b64_tr_b16 v[44:45], v17 offset:40960
    ds_read_b64_tr_b16 v[46:47], v17 offset:41984
    v_mfma_f32_16x16x32_bf16 a[160:163], a[64:67], v[48:51], a[160:163]
    v_xor_b32 v17, s73, v17
    v_add_u32 v17, 0x10000, v17
    v_mfma_f32_16x16x32_bf16 a[160:163], a[68:71], v[52:55], a[160:163]
    buffer_store_dwordx4 v[144:147], v1, s[36:39], s72 offen sc1
    v_mfma_f32_16x16x32_bf16 a[164:167], a[72:75], v[48:51], a[164:167]
    v_cvt_pk_bf16_f32 v208, v208, v209
    v_cvt_pk_bf16_f32 v209, v210, v211
    v_mfma_f32_16x16x32_bf16 a[164:167], a[76:79], v[52:55], a[164:167]
    s_add_u32 m0, s69, 147456
    v_cvt_pk_bf16_f32 v210, v240, v241
    v_cvt_pk_bf16_f32 v211, v242, v243
    v_mfma_f32_16x16x32_bf16 a[168:171], a[80:83], v[48:51], a[168:171]
    s_xor_b32 s60, s60, 1572864
    buffer_load_dwordx4 v10, s[20:23], s63 offen lds
    v_mfma_f32_16x16x32_bf16 a[168:171], a[84:87], v[52:55], a[168:171]
    v_mul_f32 v212, s74, v212
    v_mul_f32 v213, s74, v213
    v_mfma_f32_16x16x32_bf16 a[172:175], a[88:91], v[48:51], a[172:175]
    v_mul_f32 v214, s74, v214
    v_mul_f32 v215, s74, v215
    v_mfma_f32_16x16x32_bf16 a[172:175], a[92:95], v[52:55], a[172:175]
    v_mul_f32 v244, s74, v244
    v_mul_f32 v245, s74, v245
    v_mfma_f32_16x16x32_bf16 a[176:179], a[96:99], v[48:51], a[176:179]
    ds_read_b128 v[88:91], v24 offset:57344
    v_mul_f32 v246, s74, v246
    v_mfma_f32_16x16x32_bf16 a[176:179], a[100:103], v[52:55], a[176:179]
    v_mul_f32 v247, s74, v247
    v_accvgpr_write_b32 a36, v208
    v_mfma_f32_16x16x32_bf16 a[180:183], a[104:107], v[48:51], a[180:183]
    v_accvgpr_write_b32 a37, v209
    v_accvgpr_write_b32 a38, v210
    v_mfma_f32_16x16x32_bf16 a[180:183], a[108:111], v[52:55], a[180:183]
    buffer_load_dwordx4 v11, s[20:23], s63 offen offset:1024 lds
    v_mfma_f32_16x16x32_bf16 a[184:187], a[112:115], v[48:51], a[184:187]
    v_accvgpr_write_b32 a39, v211
    v_cvt_pk_bf16_f32 v212, v212, v213
    v_mfma_f32_16x16x32_bf16 a[184:187], a[116:119], v[52:55], a[184:187]
    v_cvt_pk_bf16_f32 v213, v214, v215
    v_cvt_pk_bf16_f32 v214, v244, v245
    v_mfma_f32_16x16x32_bf16 a[188:191], a[120:123], v[48:51], a[188:191]
    v_cvt_pk_bf16_f32 v215, v246, v247
    v_mul_f32 v216, s74, v216
    v_mfma_f32_16x16x32_bf16 a[188:191], a[124:127], v[52:55], a[188:191]
    s_waitcnt lgkmcnt(0)
    v_mul_f32 v217, s74, v217
    v_mul_f32 v218, s74, v218
    v_mfma_f32_16x16x32_bf16 a[192:195], a[64:67], v[56:59], a[192:195]
    v_mul_f32 v219, s74, v219
    v_mul_f32 v248, s74, v248
    v_mfma_f32_16x16x32_bf16 a[192:195], a[68:71], v[60:63], a[192:195]
    v_mul_f32 v249, s74, v249
    v_mul_f32 v250, s74, v250
    v_mfma_f32_16x16x32_bf16 a[196:199], a[72:75], v[56:59], a[196:199]
    v_mul_f32 v251, s74, v251
    v_accvgpr_write_b32 a44, v212
    v_mfma_f32_16x16x32_bf16 a[196:199], a[76:79], v[60:63], a[196:199]
    buffer_load_dwordx4 v12, s[20:23], s63 offen offset:2048 lds
    v_mfma_f32_16x16x32_bf16 a[200:203], a[80:83], v[56:59], a[200:203]
    ds_read_b128 v[92:95], v25 offset:57344
    v_accvgpr_write_b32 a45, v213
    v_mfma_f32_16x16x32_bf16 a[200:203], a[84:87], v[60:63], a[200:203]
    v_accvgpr_write_b32 a46, v214
    v_accvgpr_write_b32 a47, v215
    v_mfma_f32_16x16x32_bf16 a[204:207], a[88:91], v[56:59], a[204:207]
    v_cvt_pk_bf16_f32 v216, v216, v217
    v_cvt_pk_bf16_f32 v217, v218, v219
    v_mfma_f32_16x16x32_bf16 a[204:207], a[92:95], v[60:63], a[204:207]
    s_add_u32 s72, s70, 36864
    v_cvt_pk_bf16_f32 v218, v248, v249
    v_cvt_pk_bf16_f32 v219, v250, v251
    v_mfma_f32_16x16x32_bf16 a[208:211], a[96:99], v[56:59], a[208:211]
    buffer_store_dwordx4 a[40:43], v1, s[36:39], s72 offen sc1
    v_mfma_f32_16x16x32_bf16 a[208:211], a[100:103], v[60:63], a[208:211]
    v_mul_f32 v220, s74, v220
    v_mul_f32 v221, s74, v221
    v_mfma_f32_16x16x32_bf16 a[212:215], a[104:107], v[56:59], a[212:215]
    buffer_load_dwordx4 v13, s[20:23], s63 offen offset:3072 lds
    v_mfma_f32_16x16x32_bf16 a[212:215], a[108:111], v[60:63], a[212:215]
    v_mul_f32 v222, s74, v222
    v_mul_f32 v223, s74, v223
    v_mfma_f32_16x16x32_bf16 a[216:219], a[112:115], v[56:59], a[216:219]
    v_mul_f32 v252, s74, v252
    v_mul_f32 v253, s74, v253
    v_mfma_f32_16x16x32_bf16 a[216:219], a[116:119], v[60:63], a[216:219]
    v_mul_f32 v254, s74, v254
    v_mul_f32 v255, s74, v255
    v_mfma_f32_16x16x32_bf16 a[220:223], a[120:123], v[56:59], a[220:223]
    v_accvgpr_write_b32 a52, v216
    v_accvgpr_write_b32 a53, v217
    v_mfma_f32_16x16x32_bf16 a[220:223], a[124:127], v[60:63], a[220:223]
    v_accvgpr_write_b32 a54, v218
    v_accvgpr_write_b32 a55, v219
    v_mfma_f32_16x16x32_bf16 a[224:227], a[64:67], v[40:43], a[224:227]
    v_cvt_pk_bf16_f32 v220, v220, v221
    v_cvt_pk_bf16_f32 v221, v222, v223
    v_mfma_f32_16x16x32_bf16 a[224:227], a[68:71], v[44:47], a[224:227]
    s_xor_b32 s63, s63, 128
    v_cvt_pk_bf16_f32 v222, v252, v253
    v_cvt_pk_bf16_f32 v223, v254, v255
    v_mfma_f32_16x16x32_bf16 a[228:231], a[72:75], v[40:43], a[228:231]
    v_accvgpr_write_b32 a60, v220
    v_accvgpr_write_b32 a61, v221
    v_mfma_f32_16x16x32_bf16 a[228:231], a[76:79], v[44:47], a[228:231]
    v_accvgpr_write_b32 a62, v222
    v_accvgpr_write_b32 a63, v223
    v_mfma_f32_16x16x32_bf16 a[232:235], a[80:83], v[40:43], a[232:235]
    v_accvgpr_write_b32 a0, 0
    v_accvgpr_write_b32 a1, 0
    v_mfma_f32_16x16x32_bf16 a[232:235], a[84:87], v[44:47], a[232:235]
    s_waitcnt vmcnt(11) lgkmcnt(0)
    s_barrier
    ds_read_b64_tr_b16 v[48:49], v14 offset:0
    v_mfma_f32_16x16x32_bf16 a[236:239], a[88:91], v[40:43], a[236:239]
    s_add_u32 m0, s67, 0
    ds_read_b64_tr_b16 v[50:51], v14 offset:1024
    ds_read_b64_tr_b16 v[52:53], v14 offset:8192
    v_mfma_f32_16x16x32_bf16 a[236:239], a[92:95], v[44:47], a[236:239]
    buffer_load_dwordx4 v1, s[28:31], s65 offen sc1 lds
    v_mfma_f32_16x16x32_bf16 a[240:243], a[96:99], v[40:43], a[240:243]
    ds_read_b64_tr_b16 v[54:55], v14 offset:9216
    ds_read_b64_tr_b16 v[56:57], v15 offset:0
    v_mfma_f32_16x16x32_bf16 a[240:243], a[100:103], v[44:47], a[240:243]
    ds_read_b64_tr_b16 v[58:59], v15 offset:1024
    ds_read_b64_tr_b16 v[60:61], v15 offset:8192
    v_mfma_f32_16x16x32_bf16 a[244:247], a[104:107], v[40:43], a[244:247]
    ds_read_b64_tr_b16 v[62:63], v15 offset:9216
    v_add_u32 v14, 0x10000, v14
    v_mfma_f32_16x16x32_bf16 a[244:247], a[108:111], v[44:47], a[244:247]
    v_add_u32 v15, 0x10000, v15
    v_accvgpr_write_b32 a2, 0
    v_mfma_f32_16x16x32_bf16 a[248:251], a[112:115], v[40:43], a[248:251]
    v_accvgpr_write_b32 a3, 0
    v_accvgpr_write_b32 a8, 0
    v_mfma_f32_16x16x32_bf16 a[248:251], a[116:119], v[44:47], a[248:251]
    v_accvgpr_write_b32 a9, 0
    v_accvgpr_write_b32 a10, 0
    v_mfma_f32_16x16x32_bf16 a[252:255], a[120:123], v[40:43], a[252:255]
    ds_read_b64_tr_b16 v[40:41], v16 offset:0
    ds_read_b64_tr_b16 v[42:43], v16 offset:1024
    v_mfma_f32_16x16x32_bf16 a[252:255], a[124:127], v[44:47], a[252:255]
    s_add_u32 s72, s70, 40960
    ds_read_b64_tr_b16 v[44:45], v16 offset:8192
    ds_read_b64_tr_b16 v[46:47], v16 offset:9216
    s_waitcnt lgkmcnt(4)
    v_mfma_f32_16x16x32_bf16 v[128:131], v[48:51], v[64:67], 0
    buffer_load_dwordx4 v1, s[28:31], s65 offen offset:1024 sc1 lds
    v_mfma_f32_16x16x32_bf16 v[128:131], v[52:55], v[68:71], v[128:131]
    v_add_u32 v24, 0x10000, v24
    v_add_u32 v16, 0x10000, v16
    v_mfma_f32_16x16x32_bf16 v[132:135], v[48:51], v[72:75], 0
    ds_read_b128 v[96:99], v24 offset:16384
    v_accvgpr_write_b32 a11, 0
    v_mfma_f32_16x16x32_bf16 v[132:135], v[52:55], v[76:79], v[132:135]
    buffer_store_dwordx4 a[48:51], v1, s[36:39], s72 offen sc1
    v_mfma_f32_16x16x32_bf16 v[136:139], v[48:51], v[80:83], 0
    v_accvgpr_write_b32 a16, 0
    v_accvgpr_write_b32 a17, 0
    v_mfma_f32_16x16x32_bf16 v[136:139], v[52:55], v[84:87], v[136:139]
    v_accvgpr_write_b32 a18, 0
    v_accvgpr_write_b32 a19, 0
    v_mfma_f32_16x16x32_bf16 v[140:143], v[48:51], v[88:91], 0
    ds_read_b64_tr_b16 v[48:49], v17 offset:0
    ds_read_b64_tr_b16 v[50:51], v17 offset:1024
    v_mfma_f32_16x16x32_bf16 v[140:143], v[52:55], v[92:95], v[140:143]
    ds_read_b64_tr_b16 v[52:53], v17 offset:8192
    ds_read_b64_tr_b16 v[54:55], v17 offset:9216
    v_mfma_f32_16x16x32_bf16 v[144:147], v[56:59], v[64:67], 0
    v_add_u32 v17, 0x10000, v17
    v_accvgpr_write_b32 a24, 0
    v_mfma_f32_16x16x32_bf16 v[144:147], v[60:63], v[68:71], v[144:147]
    s_add_u32 m0, s69, 16384
    v_accvgpr_write_b32 a25, 0
    v_accvgpr_write_b32 a26, 0
    v_mfma_f32_16x16x32_bf16 v[148:151], v[56:59], v[72:75], 0
    s_xor_b32 s65, s65, 24576
    buffer_load_dwordx4 v10, s[20:23], s64 offen lds
    v_mfma_f32_16x16x32_bf16 v[148:151], v[60:63], v[76:79], v[148:151]
    v_accvgpr_write_b32 a27, 0
    v_accvgpr_write_b32 a32, 0
    v_mfma_f32_16x16x32_bf16 v[152:155], v[56:59], v[80:83], 0
    v_add_u32 v25, 0x10000, v25
    v_accvgpr_write_b32 a33, 0
    v_mfma_f32_16x16x32_bf16 v[152:155], v[60:63], v[84:87], v[152:155]
    ds_read_b128 v[100:103], v25 offset:16384
    v_accvgpr_write_b32 a34, 0
    v_mfma_f32_16x16x32_bf16 v[156:159], v[56:59], v[88:91], 0
    ds_read_b64_tr_b16 v[56:57], v18 offset:0
    ds_read_b64_tr_b16 v[58:59], v18 offset:1024
    v_mfma_f32_16x16x32_bf16 v[156:159], v[60:63], v[92:95], v[156:159]
    s_waitcnt lgkmcnt(3)
    ds_read_b64_tr_b16 v[60:61], v18 offset:8192
    ds_read_b64_tr_b16 v[62:63], v18 offset:9216
    v_mfma_f32_16x16x32_bf16 v[160:163], v[40:43], v[64:67], 0
    v_add_u32 v18, 0x10000, v18
    v_accvgpr_write_b32 a35, 0
    v_mfma_f32_16x16x32_bf16 v[160:163], v[44:47], v[68:71], v[160:163]
    v_accvgpr_write_b32 a40, 0
    v_accvgpr_write_b32 a41, 0
    v_mfma_f32_16x16x32_bf16 v[164:167], v[40:43], v[72:75], 0
    v_accvgpr_write_b32 a42, 0
    v_accvgpr_write_b32 a43, 0
    v_mfma_f32_16x16x32_bf16 v[164:167], v[44:47], v[76:79], v[164:167]
    v_accvgpr_write_b32 a48, 0
    v_accvgpr_write_b32 a49, 0
    v_mfma_f32_16x16x32_bf16 v[168:171], v[40:43], v[80:83], 0
    buffer_load_dwordx4 v11, s[20:23], s64 offen offset:1024 lds
    v_mfma_f32_16x16x32_bf16 v[168:171], v[44:47], v[84:87], v[168:171]
    v_accvgpr_write_b32 a50, 0
    v_accvgpr_write_b32 a51, 0
    v_mfma_f32_16x16x32_bf16 v[172:175], v[40:43], v[88:91], 0
    ds_read_b64_tr_b16 v[40:41], v19 offset:0
    ds_read_b64_tr_b16 v[42:43], v19 offset:1024
    v_mfma_f32_16x16x32_bf16 v[172:175], v[44:47], v[92:95], v[172:175]
    s_add_u32 s72, s70, 45056
    ds_read_b64_tr_b16 v[44:45], v19 offset:8192
    ds_read_b64_tr_b16 v[46:47], v19 offset:9216
    v_mfma_f32_16x16x32_bf16 v[176:179], v[48:51], v[64:67], 0
    ds_read_b128 v[104:107], v24 offset:24576
    v_add_u32 v19, 0x10000, v19
    v_mfma_f32_16x16x32_bf16 v[176:179], v[52:55], v[68:71], v[176:179]
    buffer_store_dwordx4 a[56:59], v1, s[36:39], s72 offen sc1
    v_mfma_f32_16x16x32_bf16 v[180:183], v[48:51], v[72:75], 0
    v_mfma_f32_16x16x32_bf16 v[180:183], v[52:55], v[76:79], v[180:183]
    v_accvgpr_write_b32 a56, 0
    v_accvgpr_write_b32 a57, 0
    v_mfma_f32_16x16x32_bf16 v[184:187], v[48:51], v[80:83], 0
    v_accvgpr_write_b32 a58, 0
    v_accvgpr_write_b32 a59, 0
    v_mfma_f32_16x16x32_bf16 v[184:187], v[52:55], v[84:87], v[184:187]
    v_mfma_f32_16x16x32_bf16 v[188:191], v[48:51], v[88:91], 0
    buffer_load_dwordx4 v12, s[20:23], s64 offen offset:2048 lds
    v_mfma_f32_16x16x32_bf16 v[188:191], v[52:55], v[92:95], v[188:191]
    s_waitcnt lgkmcnt(0)
    ds_read_b64_tr_b16 v[48:49], v20 offset:0
    ds_read_b64_tr_b16 v[50:51], v20 offset:1024
    v_mfma_f32_16x16x32_bf16 v[192:195], v[56:59], v[64:67], 0
    ds_read_b64_tr_b16 v[52:53], v20 offset:8192
    ds_read_b64_tr_b16 v[54:55], v20 offset:9216
    v_mfma_f32_16x16x32_bf16 v[192:195], v[60:63], v[68:71], v[192:195]
    v_add_u32 v20, 0x10000, v20
    v_mfma_f32_16x16x32_bf16 v[196:199], v[56:59], v[72:75], 0
    v_mfma_f32_16x16x32_bf16 v[196:199], v[60:63], v[76:79], v[196:199]
    ds_read_b128 v[108:111], v25 offset:24576
    v_mfma_f32_16x16x32_bf16 v[200:203], v[56:59], v[80:83], 0
    v_mfma_f32_16x16x32_bf16 v[200:203], v[60:63], v[84:87], v[200:203]
    v_mfma_f32_16x16x32_bf16 v[204:207], v[56:59], v[88:91], 0
    ds_read_b64_tr_b16 v[56:57], v21 offset:0
    ds_read_b64_tr_b16 v[58:59], v21 offset:1024
    v_mfma_f32_16x16x32_bf16 v[204:207], v[60:63], v[92:95], v[204:207]
    ds_read_b64_tr_b16 v[60:61], v21 offset:8192
    ds_read_b64_tr_b16 v[62:63], v21 offset:9216
    v_mfma_f32_16x16x32_bf16 v[208:211], v[40:43], v[64:67], 0
    buffer_load_dwordx4 v13, s[20:23], s64 offen offset:3072 lds
    v_mfma_f32_16x16x32_bf16 v[208:211], v[44:47], v[68:71], v[208:211]
    v_add_u32 v21, 0x10000, v21
    v_mfma_f32_16x16x32_bf16 v[212:215], v[40:43], v[72:75], 0
    v_mfma_f32_16x16x32_bf16 v[212:215], v[44:47], v[76:79], v[212:215]
    v_mfma_f32_16x16x32_bf16 v[216:219], v[40:43], v[80:83], 0
    v_mfma_f32_16x16x32_bf16 v[216:219], v[44:47], v[84:87], v[216:219]
    v_mfma_f32_16x16x32_bf16 v[220:223], v[40:43], v[88:91], 0
    ds_read_b64_tr_b16 v[40:41], v26 offset:32768
    ds_read_b64_tr_b16 v[42:43], v26 offset:33280
    v_mfma_f32_16x16x32_bf16 v[220:223], v[44:47], v[92:95], v[220:223]
    s_add_u32 s72, s70, 1024
    ds_read_b64_tr_b16 v[44:45], v26 offset:36864
    ds_read_b64_tr_b16 v[46:47], v26 offset:37376
    s_waitcnt lgkmcnt(4)
    v_mfma_f32_16x16x32_bf16 v[224:227], v[48:51], v[64:67], 0
    buffer_store_dwordx4 a[4:7], v1, s[36:39], s72 offen sc1
    v_mfma_f32_16x16x32_bf16 v[224:227], v[52:55], v[68:71], v[224:227]
    s_xor_b32 s64, s64, 128
    v_add_u32 v26, 0xffff0000, v26
    v_accvgpr_write_b32 a4, 0
    v_mfma_f32_16x16x32_bf16 v[228:231], v[48:51], v[72:75], 0
    v_accvgpr_write_b32 a5, 0
    v_accvgpr_write_b32 a6, 0
    v_mfma_f32_16x16x32_bf16 v[228:231], v[52:55], v[76:79], v[228:231]
    v_accvgpr_write_b32 a7, 0
    v_mfma_f32_16x16x32_bf16 v[232:235], v[48:51], v[80:83], 0
    v_mfma_f32_16x16x32_bf16 v[232:235], v[52:55], v[84:87], v[232:235]
    s_add_u32 m0, s69, 32768
    v_mfma_f32_16x16x32_bf16 v[236:239], v[48:51], v[88:91], 0
    buffer_load_dwordx4 v2, s[24:27], s60 offen lds
    v_mfma_f32_16x16x32_bf16 v[236:239], v[52:55], v[92:95], v[236:239]
    ds_read_b64_tr_b16 v[48:49], v27 offset:32768
    ds_read_b64_tr_b16 v[50:51], v27 offset:33280
    v_mfma_f32_16x16x32_bf16 v[240:243], v[56:59], v[64:67], 0
    ds_read_b64_tr_b16 v[52:53], v27 offset:36864
    ds_read_b64_tr_b16 v[54:55], v27 offset:37376
    v_mfma_f32_16x16x32_bf16 v[240:243], v[60:63], v[68:71], v[240:243]
    buffer_load_dwordx4 v3, s[24:27], s60 offen offset:1024 lds
    v_mfma_f32_16x16x32_bf16 v[244:247], v[56:59], v[72:75], 0
    v_add_u32 v27, 0xffff0000, v27
    v_mfma_f32_16x16x32_bf16 v[244:247], v[60:63], v[76:79], v[244:247]
    v_mfma_f32_16x16x32_bf16 v[248:251], v[56:59], v[80:83], 0
    v_mfma_f32_16x16x32_bf16 v[248:251], v[60:63], v[84:87], v[248:251]
    buffer_load_dwordx4 v4, s[24:27], s60 offen offset:2048 lds
    v_mfma_f32_16x16x32_bf16 v[252:255], v[56:59], v[88:91], 0
    ds_read_b64_tr_b16 v[56:57], v28 offset:32768
    ds_read_b64_tr_b16 v[58:59], v28 offset:33280
    v_mfma_f32_16x16x32_bf16 v[252:255], v[60:63], v[92:95], v[252:255]
    s_waitcnt lgkmcnt(2)
    ds_read_b64_tr_b16 v[60:61], v28 offset:36864
    ds_read_b64_tr_b16 v[62:63], v28 offset:37376
    v_mfma_f32_16x16x32_bf16 a[64:67], v[40:43], v[64:67], 0
    buffer_load_dwordx4 v5, s[24:27], s60 offen offset:3072 lds
    v_mfma_f32_16x16x32_bf16 a[64:67], v[44:47], v[68:71], a[64:67]
    v_add_u32 v28, 0xffff0000, v28
    v_mfma_f32_16x16x32_bf16 a[68:71], v[40:43], v[72:75], 0
    ds_read_b128 v[112:115], v24 offset:49152
    v_mfma_f32_16x16x32_bf16 a[68:71], v[44:47], v[76:79], a[68:71]
    s_add_u32 m0, s69, 49152
    v_mfma_f32_16x16x32_bf16 a[72:75], v[40:43], v[80:83], 0
    s_xor_b32 s60, s60, 524288
    buffer_load_dwordx4 v10, s[20:23], s63 offen lds
    v_mfma_f32_16x16x32_bf16 a[72:75], v[44:47], v[84:87], a[72:75]
    ds_read_b128 v[116:119], v25 offset:49152
    v_mfma_f32_16x16x32_bf16 a[76:79], v[40:43], v[88:91], 0
    ds_read_b64_tr_b16 v[40:41], v29 offset:32768
    ds_read_b64_tr_b16 v[42:43], v29 offset:33280
    v_mfma_f32_16x16x32_bf16 a[76:79], v[44:47], v[92:95], a[76:79]
    s_add_u32 s72, s70, 5120
    buffer_load_dwordx4 v11, s[20:23], s63 offen offset:1024 lds
    v_mfma_f32_16x16x32_bf16 a[80:83], v[48:51], v[64:67], 0
    ds_read_b128 v[120:123], v24 offset:57344
    ds_read_b64_tr_b16 v[44:45], v29 offset:36864
    v_mfma_f32_16x16x32_bf16 a[80:83], v[52:55], v[68:71], a[80:83]
    ds_read_b64_tr_b16 v[46:47], v29 offset:37376
    v_add_u32 v29, 0xffff0000, v29
    v_mfma_f32_16x16x32_bf16 a[84:87], v[48:51], v[72:75], 0
    buffer_store_dwordx4 a[12:15], v1, s[36:39], s72 offen sc1
    v_mfma_f32_16x16x32_bf16 a[84:87], v[52:55], v[76:79], a[84:87]
    ds_read_b128 v[124:127], v25 offset:57344
    v_accvgpr_write_b32 a12, 0
    v_mfma_f32_16x16x32_bf16 a[88:91], v[48:51], v[80:83], 0
    v_accvgpr_write_b32 a13, 0
    v_accvgpr_write_b32 a14, 0
    v_mfma_f32_16x16x32_bf16 a[88:91], v[52:55], v[84:87], a[88:91]
    v_accvgpr_write_b32 a15, 0
    v_mfma_f32_16x16x32_bf16 a[92:95], v[48:51], v[88:91], 0
    buffer_load_dwordx4 v12, s[20:23], s63 offen offset:2048 lds
    v_mfma_f32_16x16x32_bf16 a[92:95], v[52:55], v[92:95], a[92:95]
    s_waitcnt lgkmcnt(1)
    v_mfma_f32_16x16x32_bf16 a[96:99], v[56:59], v[64:67], 0
    v_mfma_f32_16x16x32_bf16 a[96:99], v[60:63], v[68:71], a[96:99]
    v_mfma_f32_16x16x32_bf16 a[100:103], v[56:59], v[72:75], 0
    buffer_load_dwordx4 v13, s[20:23], s63 offen offset:3072 lds
    v_mfma_f32_16x16x32_bf16 a[100:103], v[60:63], v[76:79], a[100:103]
    s_xor_b32 s63, s63, 896
    v_mfma_f32_16x16x32_bf16 a[104:107], v[56:59], v[80:83], 0
    v_mfma_f32_16x16x32_bf16 a[104:107], v[60:63], v[84:87], a[104:107]
    s_waitcnt vmcnt(10) lgkmcnt(0)
    s_barrier
    ds_read_b64_tr_b16 v[48:49], v14 offset:0
    v_mfma_f32_16x16x32_bf16 a[108:111], v[56:59], v[88:91], 0
    s_add_u32 m0, s67, 65536
    ds_read_b64_tr_b16 v[50:51], v14 offset:1024
    ds_read_b64_tr_b16 v[52:53], v14 offset:8192
    v_mfma_f32_16x16x32_bf16 a[108:111], v[60:63], v[92:95], a[108:111]
    buffer_load_dwordx4 v1, s[28:31], s65 offen sc1 lds
    v_mfma_f32_16x16x32_bf16 a[112:115], v[40:43], v[64:67], 0
    ds_read_b64_tr_b16 v[54:55], v14 offset:9216
    ds_read_b64_tr_b16 v[56:57], v15 offset:0
    v_mfma_f32_16x16x32_bf16 a[112:115], v[44:47], v[68:71], a[112:115]
    ds_read_b64_tr_b16 v[58:59], v15 offset:1024
    ds_read_b64_tr_b16 v[60:61], v15 offset:8192
    v_mfma_f32_16x16x32_bf16 a[116:119], v[40:43], v[72:75], 0
    ds_read_b64_tr_b16 v[62:63], v15 offset:9216
    v_add_u32 v14, 0xfffe0000, v14
    v_mfma_f32_16x16x32_bf16 a[116:119], v[44:47], v[76:79], a[116:119]
    v_add_u32 v15, 0xfffe0000, v15
    v_mfma_f32_16x16x32_bf16 a[120:123], v[40:43], v[80:83], 0
    v_mfma_f32_16x16x32_bf16 a[120:123], v[44:47], v[84:87], a[120:123]
    v_mfma_f32_16x16x32_bf16 a[124:127], v[40:43], v[88:91], 0
    ds_read_b64_tr_b16 v[40:41], v16 offset:0
    ds_read_b64_tr_b16 v[42:43], v16 offset:1024
    v_mfma_f32_16x16x32_bf16 a[124:127], v[44:47], v[92:95], a[124:127]
    s_add_u32 s72, s70, 9216
    ds_read_b64_tr_b16 v[44:45], v16 offset:8192
    ds_read_b64_tr_b16 v[46:47], v16 offset:9216
    s_waitcnt lgkmcnt(4)
    v_mfma_f32_16x16x32_bf16 v[128:131], v[48:51], v[96:99], v[128:131]
    buffer_load_dwordx4 v1, s[28:31], s65 offen offset:1024 sc1 lds
    v_mfma_f32_16x16x32_bf16 v[128:131], v[52:55], v[100:103], v[128:131]
    v_add_u32 v24, 0x10000, v24
    v_add_u32 v16, 0xfffe0000, v16
    v_mfma_f32_16x16x32_bf16 v[132:135], v[48:51], v[104:107], v[132:135]
    buffer_store_dwordx4 a[20:23], v1, s[36:39], s72 offen sc1
    v_mfma_f32_16x16x32_bf16 v[132:135], v[52:55], v[108:111], v[132:135]
    ds_read_b128 v[64:67], v24 offset:16384
    v_accvgpr_write_b32 a20, 0
    v_mfma_f32_16x16x32_bf16 v[136:139], v[48:51], v[112:115], v[136:139]
    v_accvgpr_write_b32 a21, 0
    v_accvgpr_write_b32 a22, 0
    v_mfma_f32_16x16x32_bf16 v[136:139], v[52:55], v[116:119], v[136:139]
    v_accvgpr_write_b32 a23, 0
    v_mfma_f32_16x16x32_bf16 v[140:143], v[48:51], v[120:123], v[140:143]
    ds_read_b64_tr_b16 v[48:49], v17 offset:0
    ds_read_b64_tr_b16 v[50:51], v17 offset:1024
    v_mfma_f32_16x16x32_bf16 v[140:143], v[52:55], v[124:127], v[140:143]
    ds_read_b64_tr_b16 v[52:53], v17 offset:8192
    ds_read_b64_tr_b16 v[54:55], v17 offset:9216
    v_mfma_f32_16x16x32_bf16 v[144:147], v[56:59], v[96:99], v[144:147]
    v_add_u32 v17, 0xfffe0000, v17
    v_mfma_f32_16x16x32_bf16 v[144:147], v[60:63], v[100:103], v[144:147]
    s_add_u32 m0, s69, 81920
    v_mfma_f32_16x16x32_bf16 v[148:151], v[56:59], v[104:107], v[148:151]
    s_xor_b32 s65, s65, 8192
    buffer_load_dwordx4 v10, s[20:23], s64 offen lds
    v_mfma_f32_16x16x32_bf16 v[148:151], v[60:63], v[108:111], v[148:151]
    v_mfma_f32_16x16x32_bf16 v[152:155], v[56:59], v[112:115], v[152:155]
    v_add_u32 v25, 0x10000, v25
    v_mfma_f32_16x16x32_bf16 v[152:155], v[60:63], v[116:119], v[152:155]
    ds_read_b128 v[68:71], v25 offset:16384
    v_mfma_f32_16x16x32_bf16 v[156:159], v[56:59], v[120:123], v[156:159]
    ds_read_b64_tr_b16 v[56:57], v18 offset:0
    ds_read_b64_tr_b16 v[58:59], v18 offset:1024
    v_mfma_f32_16x16x32_bf16 v[156:159], v[60:63], v[124:127], v[156:159]
    s_waitcnt lgkmcnt(3)
    ds_read_b64_tr_b16 v[60:61], v18 offset:8192
    ds_read_b64_tr_b16 v[62:63], v18 offset:9216
    v_mfma_f32_16x16x32_bf16 v[160:163], v[40:43], v[96:99], v[160:163]
    v_add_u32 v18, 0xfffe0000, v18
    v_mfma_f32_16x16x32_bf16 v[160:163], v[44:47], v[100:103], v[160:163]
    v_mfma_f32_16x16x32_bf16 v[164:167], v[40:43], v[104:107], v[164:167]
    v_mfma_f32_16x16x32_bf16 v[164:167], v[44:47], v[108:111], v[164:167]
    v_mfma_f32_16x16x32_bf16 v[168:171], v[40:43], v[112:115], v[168:171]
    buffer_load_dwordx4 v11, s[20:23], s64 offen offset:1024 lds
    v_mfma_f32_16x16x32_bf16 v[168:171], v[44:47], v[116:119], v[168:171]
    v_mfma_f32_16x16x32_bf16 v[172:175], v[40:43], v[120:123], v[172:175]
    ds_read_b64_tr_b16 v[40:41], v19 offset:0
    ds_read_b64_tr_b16 v[42:43], v19 offset:1024
    v_mfma_f32_16x16x32_bf16 v[172:175], v[44:47], v[124:127], v[172:175]
    s_add_u32 s72, s70, 13312
    ds_read_b64_tr_b16 v[44:45], v19 offset:8192
    ds_read_b64_tr_b16 v[46:47], v19 offset:9216
    v_mfma_f32_16x16x32_bf16 v[176:179], v[48:51], v[96:99], v[176:179]
    ds_read_b128 v[72:75], v24 offset:24576
    v_add_u32 v19, 0xfffe0000, v19
    v_mfma_f32_16x16x32_bf16 v[176:179], v[52:55], v[100:103], v[176:179]
    buffer_store_dwordx4 a[28:31], v1, s[36:39], s72 offen sc1
    v_mfma_f32_16x16x32_bf16 v[180:183], v[48:51], v[104:107], v[180:183]
    v_mfma_f32_16x16x32_bf16 v[180:183], v[52:55], v[108:111], v[180:183]
    v_accvgpr_write_b32 a28, 0
    v_accvgpr_write_b32 a29, 0
    v_mfma_f32_16x16x32_bf16 v[184:187], v[48:51], v[112:115], v[184:187]
    v_accvgpr_write_b32 a30, 0
    v_accvgpr_write_b32 a31, 0
    v_mfma_f32_16x16x32_bf16 v[184:187], v[52:55], v[116:119], v[184:187]
    v_mfma_f32_16x16x32_bf16 v[188:191], v[48:51], v[120:123], v[188:191]
    buffer_load_dwordx4 v12, s[20:23], s64 offen offset:2048 lds
    v_mfma_f32_16x16x32_bf16 v[188:191], v[52:55], v[124:127], v[188:191]
    s_waitcnt lgkmcnt(0)
    ds_read_b64_tr_b16 v[48:49], v20 offset:0
    ds_read_b64_tr_b16 v[50:51], v20 offset:1024
    v_mfma_f32_16x16x32_bf16 v[192:195], v[56:59], v[96:99], v[192:195]
    ds_read_b64_tr_b16 v[52:53], v20 offset:8192
    ds_read_b64_tr_b16 v[54:55], v20 offset:9216
    v_mfma_f32_16x16x32_bf16 v[192:195], v[60:63], v[100:103], v[192:195]
    v_add_u32 v20, 0xfffe0000, v20
    v_mfma_f32_16x16x32_bf16 v[196:199], v[56:59], v[104:107], v[196:199]
    v_mfma_f32_16x16x32_bf16 v[196:199], v[60:63], v[108:111], v[196:199]
    ds_read_b128 v[76:79], v25 offset:24576
    v_mfma_f32_16x16x32_bf16 v[200:203], v[56:59], v[112:115], v[200:203]
    v_mfma_f32_16x16x32_bf16 v[200:203], v[60:63], v[116:119], v[200:203]
    v_mfma_f32_16x16x32_bf16 v[204:207], v[56:59], v[120:123], v[204:207]
    ds_read_b64_tr_b16 v[56:57], v21 offset:0
    ds_read_b64_tr_b16 v[58:59], v21 offset:1024
    v_mfma_f32_16x16x32_bf16 v[204:207], v[60:63], v[124:127], v[204:207]
    ds_read_b64_tr_b16 v[60:61], v21 offset:8192
    ds_read_b64_tr_b16 v[62:63], v21 offset:9216
    v_mfma_f32_16x16x32_bf16 v[208:211], v[40:43], v[96:99], v[208:211]
    buffer_load_dwordx4 v13, s[20:23], s64 offen offset:3072 lds
    v_mfma_f32_16x16x32_bf16 v[208:211], v[44:47], v[100:103], v[208:211]
    v_add_u32 v21, 0xfffe0000, v21
    v_mfma_f32_16x16x32_bf16 v[212:215], v[40:43], v[104:107], v[212:215]
    v_mfma_f32_16x16x32_bf16 v[212:215], v[44:47], v[108:111], v[212:215]
    v_mfma_f32_16x16x32_bf16 v[216:219], v[40:43], v[112:115], v[216:219]
    v_mfma_f32_16x16x32_bf16 v[216:219], v[44:47], v[116:119], v[216:219]
    v_mfma_f32_16x16x32_bf16 v[220:223], v[40:43], v[120:123], v[220:223]
    ds_read_b64_tr_b16 v[40:41], v26 offset:0
    ds_read_b64_tr_b16 v[42:43], v26 offset:512
    v_mfma_f32_16x16x32_bf16 v[220:223], v[44:47], v[124:127], v[220:223]
    s_add_u32 s72, s70, 33792
    ds_read_b64_tr_b16 v[44:45], v26 offset:4096
    ds_read_b64_tr_b16 v[46:47], v26 offset:4608
    s_waitcnt lgkmcnt(4)
    v_mfma_f32_16x16x32_bf16 v[224:227], v[48:51], v[96:99], v[224:227]
    buffer_store_dwordx4 a[36:39], v1, s[36:39], s72 offen sc1
    v_mfma_f32_16x16x32_bf16 v[224:227], v[52:55], v[100:103], v[224:227]
    s_xor_b32 s64, s64, 896
    v_add_u32 v26, 0x10000, v26
    v_accvgpr_write_b32 a36, 0
    v_mfma_f32_16x16x32_bf16 v[228:231], v[48:51], v[104:107], v[228:231]
    v_accvgpr_write_b32 a37, 0
    v_accvgpr_write_b32 a38, 0
    v_mfma_f32_16x16x32_bf16 v[228:231], v[52:55], v[108:111], v[228:231]
    v_accvgpr_write_b32 a39, 0
    v_mfma_f32_16x16x32_bf16 v[232:235], v[48:51], v[112:115], v[232:235]
    v_mfma_f32_16x16x32_bf16 v[232:235], v[52:55], v[116:119], v[232:235]
    s_add_u32 m0, s69, 98304
    v_mfma_f32_16x16x32_bf16 v[236:239], v[48:51], v[120:123], v[236:239]
    buffer_load_dwordx4 v2, s[24:27], s60 offen lds
    v_mfma_f32_16x16x32_bf16 v[236:239], v[52:55], v[124:127], v[236:239]
    ds_read_b64_tr_b16 v[48:49], v27 offset:0
    ds_read_b64_tr_b16 v[50:51], v27 offset:512
    v_mfma_f32_16x16x32_bf16 v[240:243], v[56:59], v[96:99], v[240:243]
    ds_read_b64_tr_b16 v[52:53], v27 offset:4096
    ds_read_b64_tr_b16 v[54:55], v27 offset:4608
    v_mfma_f32_16x16x32_bf16 v[240:243], v[60:63], v[100:103], v[240:243]
    buffer_load_dwordx4 v3, s[24:27], s60 offen offset:1024 lds
    v_mfma_f32_16x16x32_bf16 v[244:247], v[56:59], v[104:107], v[244:247]
    v_add_u32 v27, 0x10000, v27
    v_mfma_f32_16x16x32_bf16 v[244:247], v[60:63], v[108:111], v[244:247]
    v_mfma_f32_16x16x32_bf16 v[248:251], v[56:59], v[112:115], v[248:251]
    v_mfma_f32_16x16x32_bf16 v[248:251], v[60:63], v[116:119], v[248:251]
    buffer_load_dwordx4 v4, s[24:27], s60 offen offset:2048 lds
    v_mfma_f32_16x16x32_bf16 v[252:255], v[56:59], v[120:123], v[252:255]
    ds_read_b64_tr_b16 v[56:57], v28 offset:0
    ds_read_b64_tr_b16 v[58:59], v28 offset:512
    v_mfma_f32_16x16x32_bf16 v[252:255], v[60:63], v[124:127], v[252:255]
    s_waitcnt lgkmcnt(2)
    ds_read_b64_tr_b16 v[60:61], v28 offset:4096
    ds_read_b64_tr_b16 v[62:63], v28 offset:4608
    v_mfma_f32_16x16x32_bf16 a[64:67], v[40:43], v[96:99], a[64:67]
    buffer_load_dwordx4 v5, s[24:27], s60 offen offset:3072 lds
    v_mfma_f32_16x16x32_bf16 a[64:67], v[44:47], v[100:103], a[64:67]
    v_add_u32 v24, 0xfffe0000, v24
    v_add_u32 v28, 0x10000, v28
    v_mfma_f32_16x16x32_bf16 a[68:71], v[40:43], v[104:107], a[68:71]
    ds_read_b128 v[80:83], v24 offset:16384
    v_mfma_f32_16x16x32_bf16 a[68:71], v[44:47], v[108:111], a[68:71]
    s_add_u32 m0, s69, 114688
    v_mfma_f32_16x16x32_bf16 a[72:75], v[40:43], v[112:115], a[72:75]
    s_xor_b32 s60, s60, 3670016
    buffer_load_dwordx4 v10, s[20:23], s63 offen lds
    v_mfma_f32_16x16x32_bf16 a[72:75], v[44:47], v[116:119], a[72:75]
    v_add_u32 v25, 0xfffe0000, v25
    ds_read_b128 v[84:87], v25 offset:16384
    v_mfma_f32_16x16x32_bf16 a[76:79], v[40:43], v[120:123], a[76:79]
    ds_read_b64_tr_b16 v[40:41], v29 offset:0
    ds_read_b64_tr_b16 v[42:43], v29 offset:512
    v_mfma_f32_16x16x32_bf16 a[76:79], v[44:47], v[124:127], a[76:79]
    s_add_u32 s72, s70, 37888
    buffer_load_dwordx4 v11, s[20:23], s63 offen offset:1024 lds
    v_mfma_f32_16x16x32_bf16 a[80:83], v[48:51], v[96:99], a[80:83]
    ds_read_b128 v[88:91], v24 offset:24576
    ds_read_b64_tr_b16 v[44:45], v29 offset:4096
    v_mfma_f32_16x16x32_bf16 a[80:83], v[52:55], v[100:103], a[80:83]
    ds_read_b64_tr_b16 v[46:47], v29 offset:4608
    v_add_u32 v29, 0x10000, v29
    v_mfma_f32_16x16x32_bf16 a[84:87], v[48:51], v[104:107], a[84:87]
    buffer_store_dwordx4 a[44:47], v1, s[36:39], s72 offen sc1
    v_mfma_f32_16x16x32_bf16 a[84:87], v[52:55], v[108:111], a[84:87]
    ds_read_b128 v[92:95], v25 offset:24576
    v_accvgpr_write_b32 a44, 0
    v_mfma_f32_16x16x32_bf16 a[88:91], v[48:51], v[112:115], a[88:91]
    v_accvgpr_write_b32 a45, 0
    v_accvgpr_write_b32 a46, 0
    v_mfma_f32_16x16x32_bf16 a[88:91], v[52:55], v[116:119], a[88:91]
    v_accvgpr_write_b32 a47, 0
    v_mfma_f32_16x16x32_bf16 a[92:95], v[48:51], v[120:123], a[92:95]
    buffer_load_dwordx4 v12, s[20:23], s63 offen offset:2048 lds
    v_mfma_f32_16x16x32_bf16 a[92:95], v[52:55], v[124:127], a[92:95]
    s_waitcnt lgkmcnt(1)
    v_mfma_f32_16x16x32_bf16 a[96:99], v[56:59], v[96:99], a[96:99]
    v_mfma_f32_16x16x32_bf16 a[96:99], v[60:63], v[100:103], a[96:99]
    v_mfma_f32_16x16x32_bf16 a[100:103], v[56:59], v[104:107], a[100:103]
    buffer_load_dwordx4 v13, s[20:23], s63 offen offset:3072 lds
    v_mfma_f32_16x16x32_bf16 a[100:103], v[60:63], v[108:111], a[100:103]
    s_xor_b32 s63, s63, 128
    v_mfma_f32_16x16x32_bf16 a[104:107], v[56:59], v[112:115], a[104:107]
    v_mfma_f32_16x16x32_bf16 a[104:107], v[60:63], v[116:119], a[104:107]
    s_waitcnt vmcnt(10) lgkmcnt(0)
    s_barrier
    ds_read_b64_tr_b16 v[48:49], v14 offset:32768
    v_mfma_f32_16x16x32_bf16 a[108:111], v[56:59], v[120:123], a[108:111]
    s_add_u32 m0, s67, 131072
    ds_read_b64_tr_b16 v[50:51], v14 offset:33792
    ds_read_b64_tr_b16 v[52:53], v14 offset:40960
    v_mfma_f32_16x16x32_bf16 a[108:111], v[60:63], v[124:127], a[108:111]
    buffer_load_dwordx4 v1, s[28:31], s65 offen sc1 lds
    v_mfma_f32_16x16x32_bf16 a[112:115], v[40:43], v[96:99], a[112:115]
    ds_read_b64_tr_b16 v[54:55], v14 offset:41984
    ds_read_b64_tr_b16 v[56:57], v15 offset:32768
    v_mfma_f32_16x16x32_bf16 a[112:115], v[44:47], v[100:103], a[112:115]
    ds_read_b64_tr_b16 v[58:59], v15 offset:33792
    ds_read_b64_tr_b16 v[60:61], v15 offset:40960
    v_mfma_f32_16x16x32_bf16 a[116:119], v[40:43], v[104:107], a[116:119]
    ds_read_b64_tr_b16 v[62:63], v15 offset:41984
    v_add_u32 v14, 0x10000, v14
    v_mfma_f32_16x16x32_bf16 a[116:119], v[44:47], v[108:111], a[116:119]
    v_add_u32 v15, 0x10000, v15
    v_mfma_f32_16x16x32_bf16 a[120:123], v[40:43], v[112:115], a[120:123]
    v_mfma_f32_16x16x32_bf16 a[120:123], v[44:47], v[116:119], a[120:123]
    v_mfma_f32_16x16x32_bf16 a[124:127], v[40:43], v[120:123], a[124:127]
    ds_read_b64_tr_b16 v[40:41], v16 offset:32768
    ds_read_b64_tr_b16 v[42:43], v16 offset:33792
    v_mfma_f32_16x16x32_bf16 a[124:127], v[44:47], v[124:127], a[124:127]
    s_add_u32 s72, s70, 41984
    ds_read_b64_tr_b16 v[44:45], v16 offset:40960
    ds_read_b64_tr_b16 v[46:47], v16 offset:41984
    s_waitcnt lgkmcnt(4)
    v_mfma_f32_16x16x32_bf16 v[128:131], v[48:51], v[64:67], v[128:131]
    buffer_load_dwordx4 v1, s[28:31], s65 offen offset:1024 sc1 lds
    v_mfma_f32_16x16x32_bf16 v[128:131], v[52:55], v[68:71], v[128:131]
    buffer_store_dwordx4 a[52:55], v1, s[36:39], s72 offen sc1
    v_mfma_f32_16x16x32_bf16 v[132:135], v[48:51], v[72:75], v[132:135]
    ds_read_b128 v[96:99], v24 offset:49152
    v_add_u32 v16, 0x10000, v16
    v_mfma_f32_16x16x32_bf16 v[132:135], v[52:55], v[76:79], v[132:135]
    v_accvgpr_write_b32 a52, 0
    v_accvgpr_write_b32 a53, 0
    v_mfma_f32_16x16x32_bf16 v[136:139], v[48:51], v[80:83], v[136:139]
    v_accvgpr_write_b32 a54, 0
    v_accvgpr_write_b32 a55, 0
    v_mfma_f32_16x16x32_bf16 v[136:139], v[52:55], v[84:87], v[136:139]
    v_mfma_f32_16x16x32_bf16 v[140:143], v[48:51], v[88:91], v[140:143]
    ds_read_b64_tr_b16 v[48:49], v17 offset:32768
    ds_read_b64_tr_b16 v[50:51], v17 offset:33792
    v_mfma_f32_16x16x32_bf16 v[140:143], v[52:55], v[92:95], v[140:143]
    ds_read_b64_tr_b16 v[52:53], v17 offset:40960
    ds_read_b64_tr_b16 v[54:55], v17 offset:41984
    v_mfma_f32_16x16x32_bf16 v[144:147], v[56:59], v[64:67], v[144:147]
    v_add_u32 v17, 0x10000, v17
    v_mfma_f32_16x16x32_bf16 v[144:147], v[60:63], v[68:71], v[144:147]
    s_add_u32 m0, s69, 147456
    v_mfma_f32_16x16x32_bf16 v[148:151], v[56:59], v[72:75], v[148:151]
    s_xor_b32 s65, s65, 57344
    buffer_load_dwordx4 v10, s[20:23], s64 offen lds
    v_mfma_f32_16x16x32_bf16 v[148:151], v[60:63], v[76:79], v[148:151]
    v_mfma_f32_16x16x32_bf16 v[152:155], v[56:59], v[80:83], v[152:155]
    v_mfma_f32_16x16x32_bf16 v[152:155], v[60:63], v[84:87], v[152:155]
    ds_read_b128 v[100:103], v25 offset:49152
    v_mfma_f32_16x16x32_bf16 v[156:159], v[56:59], v[88:91], v[156:159]
    ds_read_b64_tr_b16 v[56:57], v18 offset:32768
    ds_read_b64_tr_b16 v[58:59], v18 offset:33792
    v_mfma_f32_16x16x32_bf16 v[156:159], v[60:63], v[92:95], v[156:159]
    s_waitcnt lgkmcnt(3)
    ds_read_b64_tr_b16 v[60:61], v18 offset:40960
    ds_read_b64_tr_b16 v[62:63], v18 offset:41984
    v_mfma_f32_16x16x32_bf16 v[160:163], v[40:43], v[64:67], v[160:163]
    v_add_u32 v18, 0x10000, v18
    v_mfma_f32_16x16x32_bf16 v[160:163], v[44:47], v[68:71], v[160:163]
    v_mfma_f32_16x16x32_bf16 v[164:167], v[40:43], v[72:75], v[164:167]
    v_mfma_f32_16x16x32_bf16 v[164:167], v[44:47], v[76:79], v[164:167]
    v_mfma_f32_16x16x32_bf16 v[168:171], v[40:43], v[80:83], v[168:171]
    buffer_load_dwordx4 v11, s[20:23], s64 offen offset:1024 lds
    v_mfma_f32_16x16x32_bf16 v[168:171], v[44:47], v[84:87], v[168:171]
    v_mfma_f32_16x16x32_bf16 v[172:175], v[40:43], v[88:91], v[172:175]
    ds_read_b64_tr_b16 v[40:41], v19 offset:32768
    ds_read_b64_tr_b16 v[42:43], v19 offset:33792
    v_mfma_f32_16x16x32_bf16 v[172:175], v[44:47], v[92:95], v[172:175]
    s_add_u32 s72, s70, 46080
    ds_read_b64_tr_b16 v[44:45], v19 offset:40960
    ds_read_b64_tr_b16 v[46:47], v19 offset:41984
    v_mfma_f32_16x16x32_bf16 v[176:179], v[48:51], v[64:67], v[176:179]
    ds_read_b128 v[104:107], v24 offset:57344
    v_add_u32 v19, 0x10000, v19
    v_mfma_f32_16x16x32_bf16 v[176:179], v[52:55], v[68:71], v[176:179]
    buffer_store_dwordx4 a[60:63], v1, s[36:39], s72 offen sc1
    v_mfma_f32_16x16x32_bf16 v[180:183], v[48:51], v[72:75], v[180:183]
    v_mfma_f32_16x16x32_bf16 v[180:183], v[52:55], v[76:79], v[180:183]
    v_accvgpr_write_b32 a60, 0
    v_accvgpr_write_b32 a61, 0
    v_mfma_f32_16x16x32_bf16 v[184:187], v[48:51], v[80:83], v[184:187]
    v_accvgpr_write_b32 a62, 0
    v_accvgpr_write_b32 a63, 0
    v_mfma_f32_16x16x32_bf16 v[184:187], v[52:55], v[84:87], v[184:187]
    v_mfma_f32_16x16x32_bf16 v[188:191], v[48:51], v[88:91], v[188:191]
    buffer_load_dwordx4 v12, s[20:23], s64 offen offset:2048 lds
    v_mfma_f32_16x16x32_bf16 v[188:191], v[52:55], v[92:95], v[188:191]
    s_waitcnt lgkmcnt(0)
    ds_read_b64_tr_b16 v[48:49], v20 offset:32768
    ds_read_b64_tr_b16 v[50:51], v20 offset:33792
    v_mfma_f32_16x16x32_bf16 v[192:195], v[56:59], v[64:67], v[192:195]
    ds_read_b64_tr_b16 v[52:53], v20 offset:40960
    ds_read_b64_tr_b16 v[54:55], v20 offset:41984
    v_mfma_f32_16x16x32_bf16 v[192:195], v[60:63], v[68:71], v[192:195]
    v_add_u32 v20, 0x10000, v20
    v_mfma_f32_16x16x32_bf16 v[196:199], v[56:59], v[72:75], v[196:199]
    v_mfma_f32_16x16x32_bf16 v[196:199], v[60:63], v[76:79], v[196:199]
    ds_read_b128 v[108:111], v25 offset:57344
    v_mfma_f32_16x16x32_bf16 v[200:203], v[56:59], v[80:83], v[200:203]
    v_accvgpr_read_b32 v32, a128
    v_accvgpr_read_b32 v31, a129
    v_mfma_f32_16x16x32_bf16 v[200:203], v[60:63], v[84:87], v[200:203]
    v_cvt_pk_bf16_f32 v32, v32, v31
    v_accvgpr_read_b32 v33, a130
    v_mfma_f32_16x16x32_bf16 v[204:207], v[56:59], v[88:91], v[204:207]
    ds_read_b64_tr_b16 v[56:57], v21 offset:32768
    ds_read_b64_tr_b16 v[58:59], v21 offset:33792
    v_mfma_f32_16x16x32_bf16 v[204:207], v[60:63], v[92:95], v[204:207]
    ds_read_b64_tr_b16 v[60:61], v21 offset:40960
    ds_read_b64_tr_b16 v[62:63], v21 offset:41984
    v_mfma_f32_16x16x32_bf16 v[208:211], v[40:43], v[64:67], v[208:211]
    buffer_load_dwordx4 v13, s[20:23], s64 offen offset:3072 lds
    v_mfma_f32_16x16x32_bf16 v[208:211], v[44:47], v[68:71], v[208:211]
    v_add_u32 v21, 0x10000, v21
    v_accvgpr_read_b32 v31, a131
    v_mfma_f32_16x16x32_bf16 v[212:215], v[40:43], v[72:75], v[212:215]
    v_cvt_pk_bf16_f32 v33, v33, v31
    v_accvgpr_read_b32 v34, a132
    v_mfma_f32_16x16x32_bf16 v[212:215], v[44:47], v[76:79], v[212:215]
    v_accvgpr_read_b32 v31, a133
    v_cvt_pk_bf16_f32 v34, v34, v31
    v_mfma_f32_16x16x32_bf16 v[216:219], v[40:43], v[80:83], v[216:219]
    v_accvgpr_read_b32 v35, a134
    v_accvgpr_read_b32 v31, a135
    v_mfma_f32_16x16x32_bf16 v[216:219], v[44:47], v[84:87], v[216:219]
    v_cvt_pk_bf16_f32 v35, v35, v31
    v_mfma_f32_16x16x32_bf16 v[220:223], v[40:43], v[88:91], v[220:223]
    ds_read_b64_tr_b16 v[40:41], v26 offset:0
    ds_read_b64_tr_b16 v[42:43], v26 offset:512
    v_mfma_f32_16x16x32_bf16 v[220:223], v[44:47], v[92:95], v[220:223]
    s_add_u32 s72, s71, 0
    ds_read_b64_tr_b16 v[44:45], v26 offset:4096
    ds_read_b64_tr_b16 v[46:47], v26 offset:4608
    s_waitcnt lgkmcnt(4)
    v_mfma_f32_16x16x32_bf16 v[224:227], v[48:51], v[64:67], v[224:227]
    buffer_store_dwordx4 v[32:35], v1, s[36:39], s72 offen sc1
    v_mfma_f32_16x16x32_bf16 v[224:227], v[52:55], v[68:71], v[224:227]
    s_xor_b32 s64, s64, 128
    v_add_u32 v26, 0x10000, v26
    v_mfma_f32_16x16x32_bf16 v[228:231], v[48:51], v[72:75], v[228:231]
    v_mfma_f32_16x16x32_bf16 v[228:231], v[52:55], v[76:79], v[228:231]
    v_mfma_f32_16x16x32_bf16 v[232:235], v[48:51], v[80:83], v[232:235]
    v_mfma_f32_16x16x32_bf16 v[232:235], v[52:55], v[84:87], v[232:235]
    s_add_u32 m0, s69, 0
    v_mfma_f32_16x16x32_bf16 v[236:239], v[48:51], v[88:91], v[236:239]
    buffer_load_dwordx4 v2, s[24:27], s60 offen lds
    v_mfma_f32_16x16x32_bf16 v[236:239], v[52:55], v[92:95], v[236:239]
    ds_read_b64_tr_b16 v[48:49], v27 offset:0
    ds_read_b64_tr_b16 v[50:51], v27 offset:512
    v_mfma_f32_16x16x32_bf16 v[240:243], v[56:59], v[64:67], v[240:243]
    ds_read_b64_tr_b16 v[52:53], v27 offset:4096
    ds_read_b64_tr_b16 v[54:55], v27 offset:4608
    v_mfma_f32_16x16x32_bf16 v[240:243], v[60:63], v[68:71], v[240:243]
    buffer_load_dwordx4 v3, s[24:27], s60 offen offset:1024 lds
    v_mfma_f32_16x16x32_bf16 v[244:247], v[56:59], v[72:75], v[244:247]
    v_add_u32 v27, 0x10000, v27
    v_mfma_f32_16x16x32_bf16 v[244:247], v[60:63], v[76:79], v[244:247]
    v_mfma_f32_16x16x32_bf16 v[248:251], v[56:59], v[80:83], v[248:251]
    v_accvgpr_read_b32 v32, a136
    v_accvgpr_read_b32 v31, a137
    v_mfma_f32_16x16x32_bf16 v[248:251], v[60:63], v[84:87], v[248:251]
    buffer_load_dwordx4 v4, s[24:27], s60 offen offset:2048 lds
    v_mfma_f32_16x16x32_bf16 v[252:255], v[56:59], v[88:91], v[252:255]
    ds_read_b64_tr_b16 v[56:57], v28 offset:0
    ds_read_b64_tr_b16 v[58:59], v28 offset:512
    v_mfma_f32_16x16x32_bf16 v[252:255], v[60:63], v[92:95], v[252:255]
    s_waitcnt lgkmcnt(2)
    ds_read_b64_tr_b16 v[60:61], v28 offset:4096
    ds_read_b64_tr_b16 v[62:63], v28 offset:4608
    v_mfma_f32_16x16x32_bf16 a[64:67], v[40:43], v[64:67], a[64:67]
    buffer_load_dwordx4 v5, s[24:27], s60 offen offset:3072 lds
    v_mfma_f32_16x16x32_bf16 a[64:67], v[44:47], v[68:71], a[64:67]
    v_add_u32 v24, 0x10000, v24
    v_add_u32 v28, 0x10000, v28
    v_mfma_f32_16x16x32_bf16 a[68:71], v[40:43], v[72:75], a[68:71]
    ds_read_b128 v[112:115], v24 offset:16384
    v_cvt_pk_bf16_f32 v32, v32, v31
    v_mfma_f32_16x16x32_bf16 a[68:71], v[44:47], v[76:79], a[68:71]
    s_add_u32 m0, s69, 16384
    v_accvgpr_read_b32 v33, a138
    v_accvgpr_read_b32 v31, a139
    v_mfma_f32_16x16x32_bf16 a[72:75], v[40:43], v[80:83], a[72:75]
    s_xor_b32 s60, s60, 524288
    v_add_u32 v25, 0x10000, v25
    v_cvt_pk_bf16_f32 v33, v33, v31
    v_mfma_f32_16x16x32_bf16 a[72:75], v[44:47], v[84:87], a[72:75]
    buffer_load_dwordx4 v10, s[20:23], s63 offen lds
    v_mfma_f32_16x16x32_bf16 a[76:79], v[40:43], v[88:91], a[76:79]
    ds_read_b128 v[116:119], v25 offset:16384
    ds_read_b64_tr_b16 v[40:41], v29 offset:0
    v_mfma_f32_16x16x32_bf16 a[76:79], v[44:47], v[92:95], a[76:79]
    s_add_u32 s72, s71, 1024
    buffer_load_dwordx4 v11, s[20:23], s63 offen offset:1024 lds
    v_mfma_f32_16x16x32_bf16 a[80:83], v[48:51], v[64:67], a[80:83]
    ds_read_b128 v[120:123], v24 offset:24576
    ds_read_b64_tr_b16 v[42:43], v29 offset:512
    v_mfma_f32_16x16x32_bf16 a[80:83], v[52:55], v[68:71], a[80:83]
    ds_read_b64_tr_b16 v[44:45], v29 offset:4096
    ds_read_b64_tr_b16 v[46:47], v29 offset:4608
    v_mfma_f32_16x16x32_bf16 a[84:87], v[48:51], v[72:75], a[84:87]
    v_add_u32 v29, 0x10000, v29
    v_accvgpr_read_b32 v34, a140
    v_mfma_f32_16x16x32_bf16 a[84:87], v[52:55], v[76:79], a[84:87]
    buffer_load_dwordx4 v12, s[20:23], s63 offen offset:2048 lds
    v_mfma_f32_16x16x32_bf16 a[88:91], v[48:51], v[80:83], a[88:91]
    ds_read_b128 v[124:127], v25 offset:24576
    v_accvgpr_read_b32 v31, a141
    v_mfma_f32_16x16x32_bf16 a[88:91], v[52:55], v[84:87], a[88:91]
    v_cvt_pk_bf16_f32 v34, v34, v31
    v_accvgpr_read_b32 v35, a142
    v_mfma_f32_16x16x32_bf16 a[92:95], v[48:51], v[88:91], a[92:95]
    buffer_load_dwordx4 v13, s[20:23], s63 offen offset:3072 lds
    v_mfma_f32_16x16x32_bf16 a[92:95], v[52:55], v[92:95], a[92:95]
    s_waitcnt lgkmcnt(1)
    v_accvgpr_read_b32 v31, a143
    v_cvt_pk_bf16_f32 v35, v35, v31
    v_mfma_f32_16x16x32_bf16 a[96:99], v[56:59], v[64:67], a[96:99]
    v_mfma_f32_16x16x32_bf16 a[96:99], v[60:63], v[68:71], a[96:99]
    s_xor_b32 s63, s63, 384
    v_mfma_f32_16x16x32_bf16 a[100:103], v[56:59], v[72:75], a[100:103]
    buffer_store_dwordx4 v[32:35], v1, s[36:39], s72 offen sc1
    v_mfma_f32_16x16x32_bf16 a[100:103], v[60:63], v[76:79], a[100:103]
    v_mfma_f32_16x16x32_bf16 a[104:107], v[56:59], v[80:83], a[104:107]
    v_accvgpr_read_b32 v32, a144
    v_accvgpr_read_b32 v31, a145
    v_mfma_f32_16x16x32_bf16 a[104:107], v[60:63], v[84:87], a[104:107]
    s_waitcnt vmcnt(10) lgkmcnt(0)
    s_barrier
    ds_read_b64_tr_b16 v[48:49], v14 offset:32768
    v_mfma_f32_16x16x32_bf16 a[108:111], v[56:59], v[88:91], a[108:111]
    s_add_u32 m0, s67, 32768
    ds_read_b64_tr_b16 v[50:51], v14 offset:33792
    ds_read_b64_tr_b16 v[52:53], v14 offset:40960
    v_mfma_f32_16x16x32_bf16 a[108:111], v[60:63], v[92:95], a[108:111]
    buffer_load_dwordx4 v1, s[28:31], s65 offen sc1 lds
    v_mfma_f32_16x16x32_bf16 a[112:115], v[40:43], v[64:67], a[112:115]
    ds_read_b64_tr_b16 v[54:55], v14 offset:41984
    ds_read_b64_tr_b16 v[56:57], v15 offset:32768
    v_mfma_f32_16x16x32_bf16 a[112:115], v[44:47], v[68:71], a[112:115]
    ds_read_b64_tr_b16 v[58:59], v15 offset:33792
    ds_read_b64_tr_b16 v[60:61], v15 offset:40960
    v_mfma_f32_16x16x32_bf16 a[116:119], v[40:43], v[72:75], a[116:119]
    ds_read_b64_tr_b16 v[62:63], v15 offset:41984
    v_add_u32 v14, 0xffff0000, v14
    v_mfma_f32_16x16x32_bf16 a[116:119], v[44:47], v[76:79], a[116:119]
    v_add_u32 v15, 0xffff0000, v15
    v_cvt_pk_bf16_f32 v32, v32, v31
    v_mfma_f32_16x16x32_bf16 a[120:123], v[40:43], v[80:83], a[120:123]
    v_accvgpr_read_b32 v33, a146
    v_accvgpr_read_b32 v31, a147
    v_mfma_f32_16x16x32_bf16 a[120:123], v[44:47], v[84:87], a[120:123]
    v_cvt_pk_bf16_f32 v33, v33, v31
    v_accvgpr_read_b32 v34, a148
    v_mfma_f32_16x16x32_bf16 a[124:127], v[40:43], v[88:91], a[124:127]
    ds_read_b64_tr_b16 v[40:41], v16 offset:32768
    ds_read_b64_tr_b16 v[42:43], v16 offset:33792
    v_mfma_f32_16x16x32_bf16 a[124:127], v[44:47], v[92:95], a[124:127]
    s_add_u32 s72, s71, 32768
    ds_read_b64_tr_b16 v[44:45], v16 offset:40960
    ds_read_b64_tr_b16 v[46:47], v16 offset:41984
    s_waitcnt lgkmcnt(4)
    v_mfma_f32_16x16x32_bf16 v[128:131], v[48:51], v[96:99], v[128:131]
    buffer_load_dwordx4 v1, s[28:31], s65 offen offset:1024 sc1 lds
    v_mfma_f32_16x16x32_bf16 v[128:131], v[52:55], v[100:103], v[128:131]
    v_add_u32 v16, 0xffff0000, v16
    v_accvgpr_read_b32 v31, a149
    v_mfma_f32_16x16x32_bf16 v[132:135], v[48:51], v[104:107], v[132:135]
    ds_read_b128 v[64:67], v24 offset:49152
    v_cvt_pk_bf16_f32 v34, v34, v31
    v_mfma_f32_16x16x32_bf16 v[132:135], v[52:55], v[108:111], v[132:135]
    v_accvgpr_read_b32 v35, a150
    v_accvgpr_read_b32 v31, a151
    v_mfma_f32_16x16x32_bf16 v[136:139], v[48:51], v[112:115], v[136:139]
    v_cvt_pk_bf16_f32 v35, v35, v31
    v_accvgpr_write_b32 a144, 0
    v_mfma_f32_16x16x32_bf16 v[136:139], v[52:55], v[116:119], v[136:139]
    buffer_store_dwordx4 v[32:35], v1, s[36:39], s72 offen sc1
    v_mfma_f32_16x16x32_bf16 v[140:143], v[48:51], v[120:123], v[140:143]
    ds_read_b64_tr_b16 v[48:49], v17 offset:32768
    ds_read_b64_tr_b16 v[50:51], v17 offset:33792
    v_mfma_f32_16x16x32_bf16 v[140:143], v[52:55], v[124:127], v[140:143]
    ds_read_b64_tr_b16 v[52:53], v17 offset:40960
    ds_read_b64_tr_b16 v[54:55], v17 offset:41984
    v_mfma_f32_16x16x32_bf16 v[144:147], v[56:59], v[96:99], v[144:147]
    v_add_u32 v17, 0xffff0000, v17
    v_accvgpr_write_b32 a145, 0
    v_mfma_f32_16x16x32_bf16 v[144:147], v[60:63], v[100:103], v[144:147]
    s_add_u32 m0, s69, 49152
    v_accvgpr_write_b32 a146, 0
    v_accvgpr_write_b32 a147, 0
    v_mfma_f32_16x16x32_bf16 v[148:151], v[56:59], v[104:107], v[148:151]
    s_xor_b32 s65, s65, 8192
    buffer_load_dwordx4 v10, s[20:23], s64 offen lds
    v_mfma_f32_16x16x32_bf16 v[148:151], v[60:63], v[108:111], v[148:151]
    v_accvgpr_write_b32 a148, 0
    v_accvgpr_write_b32 a149, 0
    v_mfma_f32_16x16x32_bf16 v[152:155], v[56:59], v[112:115], v[152:155]
    v_accvgpr_read_b32 v32, a152
    v_accvgpr_read_b32 v31, a153
    v_mfma_f32_16x16x32_bf16 v[152:155], v[60:63], v[116:119], v[152:155]
    ds_read_b128 v[68:71], v25 offset:49152
    v_cvt_pk_bf16_f32 v32, v32, v31
    v_mfma_f32_16x16x32_bf16 v[156:159], v[56:59], v[120:123], v[156:159]
    ds_read_b64_tr_b16 v[56:57], v18 offset:32768
    ds_read_b64_tr_b16 v[58:59], v18 offset:33792
    v_mfma_f32_16x16x32_bf16 v[156:159], v[60:63], v[124:127], v[156:159]
    s_waitcnt lgkmcnt(3)
    ds_read_b64_tr_b16 v[60:61], v18 offset:40960
    ds_read_b64_tr_b16 v[62:63], v18 offset:41984
    v_mfma_f32_16x16x32_bf16 v[160:163], v[40:43], v[96:99], v[160:163]
    v_add_u32 v18, 0xffff0000, v18
    v_accvgpr_read_b32 v33, a154
    v_mfma_f32_16x16x32_bf16 v[160:163], v[44:47], v[100:103], v[160:163]
    v_accvgpr_read_b32 v31, a155
    v_cvt_pk_bf16_f32 v33, v33, v31
    v_mfma_f32_16x16x32_bf16 v[164:167], v[40:43], v[104:107], v[164:167]
    v_accvgpr_read_b32 v34, a156
    v_accvgpr_read_b32 v31, a157
    v_mfma_f32_16x16x32_bf16 v[164:167], v[44:47], v[108:111], v[164:167]
    v_cvt_pk_bf16_f32 v34, v34, v31
    v_accvgpr_read_b32 v35, a158
    v_mfma_f32_16x16x32_bf16 v[168:171], v[40:43], v[112:115], v[168:171]
    buffer_load_dwordx4 v11, s[20:23], s64 offen offset:1024 lds
    v_mfma_f32_16x16x32_bf16 v[168:171], v[44:47], v[116:119], v[168:171]
    v_accvgpr_read_b32 v31, a159
    v_cvt_pk_bf16_f32 v35, v35, v31
    v_mfma_f32_16x16x32_bf16 v[172:175], v[40:43], v[120:123], v[172:175]
    ds_read_b64_tr_b16 v[40:41], v19 offset:32768
    ds_read_b64_tr_b16 v[42:43], v19 offset:33792
    v_mfma_f32_16x16x32_bf16 v[172:175], v[44:47], v[124:127], v[172:175]
    s_add_u32 s72, s71, 33792
    ds_read_b64_tr_b16 v[44:45], v19 offset:40960
    ds_read_b64_tr_b16 v[46:47], v19 offset:41984
    v_mfma_f32_16x16x32_bf16 v[176:179], v[48:51], v[96:99], v[176:179]
    ds_read_b128 v[72:75], v24 offset:57344
    v_add_u32 v19, 0xffff0000, v19
    v_mfma_f32_16x16x32_bf16 v[176:179], v[52:55], v[100:103], v[176:179]
    buffer_store_dwordx4 v[32:35], v1, s[36:39], s72 offen sc1
    v_mfma_f32_16x16x32_bf16 v[180:183], v[48:51], v[104:107], v[180:183]
    v_accvgpr_write_b32 a150, 0
    v_accvgpr_write_b32 a151, 0
    v_mfma_f32_16x16x32_bf16 v[180:183], v[52:55], v[108:111], v[180:183]
    v_accvgpr_write_b32 a152, 0
    v_accvgpr_write_b32 a153, 0
    v_mfma_f32_16x16x32_bf16 v[184:187], v[48:51], v[112:115], v[184:187]
    v_accvgpr_write_b32 a154, 0
    v_accvgpr_write_b32 a155, 0
    v_mfma_f32_16x16x32_bf16 v[184:187], v[52:55], v[116:119], v[184:187]
    v_accvgpr_write_b32 a156, 0
    v_accvgpr_write_b32 a157, 0
    v_mfma_f32_16x16x32_bf16 v[188:191], v[48:51], v[120:123], v[188:191]
    buffer_load_dwordx4 v12, s[20:23], s64 offen offset:2048 lds
    v_mfma_f32_16x16x32_bf16 v[188:191], v[52:55], v[124:127], v[188:191]
    s_waitcnt lgkmcnt(0)
    ds_read_b64_tr_b16 v[48:49], v20 offset:32768
    ds_read_b64_tr_b16 v[50:51], v20 offset:33792
    v_mfma_f32_16x16x32_bf16 v[192:195], v[56:59], v[96:99], v[192:195]
    ds_read_b64_tr_b16 v[52:53], v20 offset:40960
    ds_read_b64_tr_b16 v[54:55], v20 offset:41984
    v_mfma_f32_16x16x32_bf16 v[192:195], v[60:63], v[100:103], v[192:195]
    v_add_u32 v20, 0xffff0000, v20
    v_accvgpr_write_b32 a158, 0
    v_mfma_f32_16x16x32_bf16 v[196:199], v[56:59], v[104:107], v[196:199]
    v_accvgpr_write_b32 a159, 0
    v_mfma_f32_16x16x32_bf16 v[196:199], v[60:63], v[108:111], v[196:199]
    ds_read_b128 v[76:79], v25 offset:57344
    v_mfma_f32_16x16x32_bf16 v[200:203], v[56:59], v[112:115], v[200:203]
    v_accvgpr_read_b32 v32, a160
    v_accvgpr_read_b32 v31, a161
    v_mfma_f32_16x16x32_bf16 v[200:203], v[60:63], v[116:119], v[200:203]
    v_cvt_pk_bf16_f32 v32, v32, v31
    v_accvgpr_read_b32 v33, a162
    v_mfma_f32_16x16x32_bf16 v[204:207], v[56:59], v[120:123], v[204:207]
    ds_read_b64_tr_b16 v[56:57], v21 offset:32768
    ds_read_b64_tr_b16 v[58:59], v21 offset:33792
    v_mfma_f32_16x16x32_bf16 v[204:207], v[60:63], v[124:127], v[204:207]
    ds_read_b64_tr_b16 v[60:61], v21 offset:40960
    ds_read_b64_tr_b16 v[62:63], v21 offset:41984
    v_mfma_f32_16x16x32_bf16 v[208:211], v[40:43], v[96:99], v[208:211]
    buffer_load_dwordx4 v13, s[20:23], s64 offen offset:3072 lds
    v_mfma_f32_16x16x32_bf16 v[208:211], v[44:47], v[100:103], v[208:211]
    v_add_u32 v21, 0xffff0000, v21
    v_accvgpr_read_b32 v31, a163
    v_mfma_f32_16x16x32_bf16 v[212:215], v[40:43], v[104:107], v[212:215]
    v_cvt_pk_bf16_f32 v33, v33, v31
    v_accvgpr_read_b32 v34, a164
    v_mfma_f32_16x16x32_bf16 v[212:215], v[44:47], v[108:111], v[212:215]
    v_accvgpr_read_b32 v31, a165
    v_cvt_pk_bf16_f32 v34, v34, v31
    v_mfma_f32_16x16x32_bf16 v[216:219], v[40:43], v[112:115], v[216:219]
    v_accvgpr_read_b32 v35, a166
    v_accvgpr_read_b32 v31, a167
    v_mfma_f32_16x16x32_bf16 v[216:219], v[44:47], v[116:119], v[216:219]
    v_cvt_pk_bf16_f32 v35, v35, v31
    v_accvgpr_write_b32 a160, 0
    v_mfma_f32_16x16x32_bf16 v[220:223], v[40:43], v[120:123], v[220:223]
    ds_read_b64_tr_b16 v[40:41], v26 offset:0
    ds_read_b64_tr_b16 v[42:43], v26 offset:512
    v_mfma_f32_16x16x32_bf16 v[220:223], v[44:47], v[124:127], v[220:223]
    s_add_u32 s72, s71, 2048
    ds_read_b64_tr_b16 v[44:45], v26 offset:4096
    ds_read_b64_tr_b16 v[46:47], v26 offset:4608
    s_waitcnt lgkmcnt(4)
    v_mfma_f32_16x16x32_bf16 v[224:227], v[48:51], v[96:99], v[224:227]
    v_add_u32 v26, 0xfffe0000, v26
    v_accvgpr_write_b32 a161, 0
    v_mfma_f32_16x16x32_bf16 v[224:227], v[52:55], v[100:103], v[224:227]
    s_xor_b32 s64, s64, 384
    buffer_store_dwordx4 v[32:35], v1, s[36:39], s72 offen sc1
    v_mfma_f32_16x16x32_bf16 v[228:231], v[48:51], v[104:107], v[228:231]
    v_accvgpr_write_b32 a162, 0
    v_accvgpr_write_b32 a163, 0
    v_mfma_f32_16x16x32_bf16 v[228:231], v[52:55], v[108:111], v[228:231]
    v_accvgpr_write_b32 a164, 0
    v_accvgpr_write_b32 a165, 0
    v_mfma_f32_16x16x32_bf16 v[232:235], v[48:51], v[112:115], v[232:235]
    v_accvgpr_write_b32 a166, 0
    v_accvgpr_write_b32 a167, 0
    v_mfma_f32_16x16x32_bf16 v[232:235], v[52:55], v[116:119], v[232:235]
    s_add_u32 m0, s69, 65536
    v_mfma_f32_16x16x32_bf16 v[236:239], v[48:51], v[120:123], v[236:239]
    buffer_load_dwordx4 v2, s[24:27], s60 offen lds
    v_mfma_f32_16x16x32_bf16 v[236:239], v[52:55], v[124:127], v[236:239]
    ds_read_b64_tr_b16 v[48:49], v27 offset:0
    ds_read_b64_tr_b16 v[50:51], v27 offset:512
    v_mfma_f32_16x16x32_bf16 v[240:243], v[56:59], v[96:99], v[240:243]
    ds_read_b64_tr_b16 v[52:53], v27 offset:4096
    ds_read_b64_tr_b16 v[54:55], v27 offset:4608
    v_mfma_f32_16x16x32_bf16 v[240:243], v[60:63], v[100:103], v[240:243]
    buffer_load_dwordx4 v3, s[24:27], s60 offen offset:1024 lds
    v_mfma_f32_16x16x32_bf16 v[244:247], v[56:59], v[104:107], v[244:247]
    v_add_u32 v27, 0xfffe0000, v27
    v_mfma_f32_16x16x32_bf16 v[244:247], v[60:63], v[108:111], v[244:247]
    v_mfma_f32_16x16x32_bf16 v[248:251], v[56:59], v[112:115], v[248:251]
    v_accvgpr_read_b32 v32, a168
    v_accvgpr_read_b32 v31, a169
    v_mfma_f32_16x16x32_bf16 v[248:251], v[60:63], v[116:119], v[248:251]
    buffer_load_dwordx4 v4, s[24:27], s60 offen offset:2048 lds
    v_mfma_f32_16x16x32_bf16 v[252:255], v[56:59], v[120:123], v[252:255]
    ds_read_b64_tr_b16 v[56:57], v28 offset:0
    ds_read_b64_tr_b16 v[58:59], v28 offset:512
    v_mfma_f32_16x16x32_bf16 v[252:255], v[60:63], v[124:127], v[252:255]
    s_waitcnt lgkmcnt(2)
    ds_read_b64_tr_b16 v[60:61], v28 offset:4096
    ds_read_b64_tr_b16 v[62:63], v28 offset:4608
    v_mfma_f32_16x16x32_bf16 a[64:67], v[40:43], v[96:99], a[64:67]
    buffer_load_dwordx4 v5, s[24:27], s60 offen offset:3072 lds
    v_mfma_f32_16x16x32_bf16 a[64:67], v[44:47], v[100:103], a[64:67]
    v_add_u32 v24, 0x10000, v24
    v_add_u32 v28, 0xfffe0000, v28
    v_mfma_f32_16x16x32_bf16 a[68:71], v[40:43], v[104:107], a[68:71]
    ds_read_b128 v[80:83], v24 offset:16384
    v_cvt_pk_bf16_f32 v32, v32, v31
    v_mfma_f32_16x16x32_bf16 a[68:71], v[44:47], v[108:111], a[68:71]
    s_add_u32 m0, s69, 81920
    v_accvgpr_read_b32 v33, a170
    v_accvgpr_read_b32 v31, a171
    v_mfma_f32_16x16x32_bf16 a[72:75], v[40:43], v[112:115], a[72:75]
    s_xor_b32 s60, s60, 1572864
    v_add_u32 v25, 0x10000, v25
    v_cvt_pk_bf16_f32 v33, v33, v31
    v_mfma_f32_16x16x32_bf16 a[72:75], v[44:47], v[116:119], a[72:75]
    buffer_load_dwordx4 v10, s[20:23], s63 offen lds
    v_mfma_f32_16x16x32_bf16 a[76:79], v[40:43], v[120:123], a[76:79]
    ds_read_b128 v[84:87], v25 offset:16384
    ds_read_b64_tr_b16 v[40:41], v29 offset:0
    v_mfma_f32_16x16x32_bf16 a[76:79], v[44:47], v[124:127], a[76:79]
    s_add_u32 s72, s71, 3072
    buffer_load_dwordx4 v11, s[20:23], s63 offen offset:1024 lds
    v_mfma_f32_16x16x32_bf16 a[80:83], v[48:51], v[96:99], a[80:83]
    ds_read_b128 v[88:91], v24 offset:24576
    ds_read_b64_tr_b16 v[42:43], v29 offset:512
    v_mfma_f32_16x16x32_bf16 a[80:83], v[52:55], v[100:103], a[80:83]
    ds_read_b64_tr_b16 v[44:45], v29 offset:4096
    ds_read_b64_tr_b16 v[46:47], v29 offset:4608
    v_mfma_f32_16x16x32_bf16 a[84:87], v[48:51], v[104:107], a[84:87]
    v_add_u32 v29, 0xfffe0000, v29
    v_accvgpr_read_b32 v34, a172
    v_mfma_f32_16x16x32_bf16 a[84:87], v[52:55], v[108:111], a[84:87]
    buffer_load_dwordx4 v12, s[20:23], s63 offen offset:2048 lds
    v_mfma_f32_16x16x32_bf16 a[88:91], v[48:51], v[112:115], a[88:91]
    ds_read_b128 v[92:95], v25 offset:24576
    v_accvgpr_read_b32 v31, a173
    v_mfma_f32_16x16x32_bf16 a[88:91], v[52:55], v[116:119], a[88:91]
    v_cvt_pk_bf16_f32 v34, v34, v31
    v_accvgpr_read_b32 v35, a174
    v_mfma_f32_16x16x32_bf16 a[92:95], v[48:51], v[120:123], a[92:95]
    buffer_load_dwordx4 v13, s[20:23], s63 offen offset:3072 lds
    v_mfma_f32_16x16x32_bf16 a[92:95], v[52:55], v[124:127], a[92:95]
    s_waitcnt lgkmcnt(1)
    v_accvgpr_read_b32 v31, a175
    v_cvt_pk_bf16_f32 v35, v35, v31
    v_mfma_f32_16x16x32_bf16 a[96:99], v[56:59], v[96:99], a[96:99]
    v_accvgpr_write_b32 a168, 0
    v_accvgpr_write_b32 a169, 0
    v_mfma_f32_16x16x32_bf16 a[96:99], v[60:63], v[100:103], a[96:99]
    s_xor_b32 s63, s63, 128
    v_accvgpr_write_b32 a170, 0
    v_accvgpr_write_b32 a171, 0
    v_mfma_f32_16x16x32_bf16 a[100:103], v[56:59], v[104:107], a[100:103]
    buffer_store_dwordx4 v[32:35], v1, s[36:39], s72 offen sc1
    v_mfma_f32_16x16x32_bf16 a[100:103], v[60:63], v[108:111], a[100:103]
    v_accvgpr_write_b32 a172, 0
    v_accvgpr_write_b32 a173, 0
    v_mfma_f32_16x16x32_bf16 a[104:107], v[56:59], v[112:115], a[104:107]
    v_accvgpr_read_b32 v32, a176
    v_accvgpr_read_b32 v31, a177
    v_mfma_f32_16x16x32_bf16 a[104:107], v[60:63], v[116:119], a[104:107]
    s_waitcnt vmcnt(10) lgkmcnt(0)
    s_barrier
    ds_read_b64_tr_b16 v[48:49], v14 offset:0
    v_mfma_f32_16x16x32_bf16 a[108:111], v[56:59], v[120:123], a[108:111]
    s_add_u32 m0, s67, 98304
    ds_read_b64_tr_b16 v[50:51], v14 offset:1024
    ds_read_b64_tr_b16 v[52:53], v14 offset:8192
    v_mfma_f32_16x16x32_bf16 a[108:111], v[60:63], v[124:127], a[108:111]
    buffer_load_dwordx4 v1, s[28:31], s65 offen sc1 lds
    v_mfma_f32_16x16x32_bf16 a[112:115], v[40:43], v[96:99], a[112:115]
    ds_read_b64_tr_b16 v[54:55], v14 offset:9216
    ds_read_b64_tr_b16 v[56:57], v15 offset:0
    v_mfma_f32_16x16x32_bf16 a[112:115], v[44:47], v[100:103], a[112:115]
    ds_read_b64_tr_b16 v[58:59], v15 offset:1024
    ds_read_b64_tr_b16 v[60:61], v15 offset:8192
    v_mfma_f32_16x16x32_bf16 a[116:119], v[40:43], v[104:107], a[116:119]
    ds_read_b64_tr_b16 v[62:63], v15 offset:9216
    v_add_u32 v14, 0x10000, v14
    v_mfma_f32_16x16x32_bf16 a[116:119], v[44:47], v[108:111], a[116:119]
    v_add_u32 v15, 0x10000, v15
    v_cvt_pk_bf16_f32 v32, v32, v31
    v_mfma_f32_16x16x32_bf16 a[120:123], v[40:43], v[112:115], a[120:123]
    v_accvgpr_read_b32 v33, a178
    v_accvgpr_read_b32 v31, a179
    v_mfma_f32_16x16x32_bf16 a[120:123], v[44:47], v[116:119], a[120:123]
    v_cvt_pk_bf16_f32 v33, v33, v31
    v_accvgpr_read_b32 v34, a180
    v_mfma_f32_16x16x32_bf16 a[124:127], v[40:43], v[120:123], a[124:127]
    ds_read_b64_tr_b16 v[40:41], v16 offset:0
    ds_read_b64_tr_b16 v[42:43], v16 offset:1024
    v_mfma_f32_16x16x32_bf16 a[124:127], v[44:47], v[124:127], a[124:127]
    s_add_u32 s72, s71, 34816
    ds_read_b64_tr_b16 v[44:45], v16 offset:8192
    ds_read_b64_tr_b16 v[46:47], v16 offset:9216
    s_waitcnt lgkmcnt(4)
    v_mfma_f32_16x16x32_bf16 v[128:131], v[48:51], v[64:67], v[128:131]
    s_add_u32 s86, s101, 4096
    buffer_load_dwordx4 v1, s[28:31], s65 offen offset:1024 sc1 lds
    v_mfma_f32_16x16x32_bf16 v[128:131], v[52:55], v[68:71], v[128:131]
    s_mov_b32 s87, 3072
    v_add_u32 v24, 0xfffe0000, v24
    v_add_u32 v16, 0x10000, v16
    v_mfma_f32_16x16x32_bf16 v[132:135], v[48:51], v[72:75], v[132:135]
    s_sub_u32 s7, s101, 4096
    ds_read_b128 v[96:99], v24 offset:16384
    v_accvgpr_read_b32 v31, a181
    v_mfma_f32_16x16x32_bf16 v[132:135], v[52:55], v[76:79], v[132:135]
    s_mov_b32 s98, 0
    v_cvt_pk_bf16_f32 v34, v34, v31
    v_accvgpr_read_b32 v35, a182
    v_mfma_f32_16x16x32_bf16 v[136:139], v[48:51], v[80:83], v[136:139]
    s_mul_i32 s84, s101, 48
    v_accvgpr_read_b32 v31, a183
    v_cvt_pk_bf16_f32 v35, v35, v31
    v_mfma_f32_16x16x32_bf16 v[136:139], v[52:55], v[84:87], v[136:139]
    s_add_u32 s84, s84, 19922944
    buffer_store_dwordx4 v[32:35], v1, s[36:39], s72 offen sc1
    v_mfma_f32_16x16x32_bf16 v[140:143], v[48:51], v[88:91], v[140:143]
    s_mov_b32 s42, 21495808
    ds_read_b64_tr_b16 v[48:49], v17 offset:0
    ds_read_b64_tr_b16 v[50:51], v17 offset:1024
    v_mfma_f32_16x16x32_bf16 v[140:143], v[52:55], v[92:95], v[140:143]
    s_mov_b32 s43, 0x20000
    ds_read_b64_tr_b16 v[52:53], v17 offset:8192
    ds_read_b64_tr_b16 v[54:55], v17 offset:9216
    v_mfma_f32_16x16x32_bf16 v[144:147], v[56:59], v[64:67], v[144:147]
    v_add_u32 v17, 0x10000, v17
    v_accvgpr_write_b32 a174, 0
    v_mfma_f32_16x16x32_bf16 v[144:147], v[60:63], v[68:71], v[144:147]
    s_add_u32 m0, s69, 114688
    v_accvgpr_write_b32 a175, 0
    v_accvgpr_write_b32 a176, 0
    v_mfma_f32_16x16x32_bf16 v[148:151], v[56:59], v[72:75], v[148:151]
    s_xor_b32 s65, s65, 24576
    buffer_load_dwordx4 v10, s[20:23], s64 offen lds
    v_mfma_f32_16x16x32_bf16 v[148:151], v[60:63], v[76:79], v[148:151]
    s_cmp_eq_u32 s6, 7
    s_cselect_b32 s86, s101, s86
    s_cselect_b32 s87, 0, s87
    v_mfma_f32_16x16x32_bf16 v[152:155], v[56:59], v[80:83], v[152:155]
    v_add_u32 v25, 0xfffe0000, v25
    v_accvgpr_read_b32 v32, a184
    v_mfma_f32_16x16x32_bf16 v[152:155], v[60:63], v[84:87], v[152:155]
    ds_read_b128 v[100:103], v25 offset:16384
    v_accvgpr_read_b32 v31, a185
    v_mfma_f32_16x16x32_bf16 v[156:159], v[56:59], v[88:91], v[156:159]
    ds_read_b64_tr_b16 v[56:57], v18 offset:0
    ds_read_b64_tr_b16 v[58:59], v18 offset:1024
    v_mfma_f32_16x16x32_bf16 v[156:159], v[60:63], v[92:95], v[156:159]
    s_waitcnt lgkmcnt(3)
    ds_read_b64_tr_b16 v[60:61], v18 offset:8192
    ds_read_b64_tr_b16 v[62:63], v18 offset:9216
    v_mfma_f32_16x16x32_bf16 v[160:163], v[40:43], v[64:67], v[160:163]
    v_add_u32 v18, 0x10000, v18
    v_cvt_pk_bf16_f32 v32, v32, v31
    v_mfma_f32_16x16x32_bf16 v[160:163], v[44:47], v[68:71], v[160:163]
    v_accvgpr_read_b32 v33, a186
    v_accvgpr_read_b32 v31, a187
    v_mfma_f32_16x16x32_bf16 v[164:167], v[40:43], v[72:75], v[164:167]
    v_cvt_pk_bf16_f32 v33, v33, v31
    v_accvgpr_read_b32 v34, a188
    v_mfma_f32_16x16x32_bf16 v[164:167], v[44:47], v[76:79], v[164:167]
    v_accvgpr_read_b32 v31, a189
    v_cvt_pk_bf16_f32 v34, v34, v31
    v_mfma_f32_16x16x32_bf16 v[168:171], v[40:43], v[80:83], v[168:171]
    buffer_load_dwordx4 v11, s[20:23], s64 offen offset:1024 lds
    v_mfma_f32_16x16x32_bf16 v[168:171], v[44:47], v[84:87], v[168:171]
    v_accvgpr_read_b32 v35, a190
    v_accvgpr_read_b32 v31, a191
    v_mfma_f32_16x16x32_bf16 v[172:175], v[40:43], v[88:91], v[172:175]
    ds_read_b64_tr_b16 v[40:41], v19 offset:0
    ds_read_b64_tr_b16 v[42:43], v19 offset:1024
    v_mfma_f32_16x16x32_bf16 v[172:175], v[44:47], v[92:95], v[172:175]
    s_add_u32 s72, s71, 35840
    ds_read_b64_tr_b16 v[44:45], v19 offset:8192
    ds_read_b64_tr_b16 v[46:47], v19 offset:9216
    v_mfma_f32_16x16x32_bf16 v[176:179], v[48:51], v[64:67], v[176:179]
    ds_read_b128 v[104:107], v24 offset:24576
    v_add_u32 v19, 0x10000, v19
    v_mfma_f32_16x16x32_bf16 v[176:179], v[52:55], v[68:71], v[176:179]
    v_cvt_pk_bf16_f32 v35, v35, v31
    v_accvgpr_write_b32 a177, 0
    v_mfma_f32_16x16x32_bf16 v[180:183], v[48:51], v[72:75], v[180:183]
    buffer_store_dwordx4 v[32:35], v1, s[36:39], s72 offen sc1
    v_mfma_f32_16x16x32_bf16 v[180:183], v[52:55], v[76:79], v[180:183]
    s_cmp_eq_u32 s6, 0
    s_cselect_b32 s7, s101, s7
    s_cselect_b32 s98, 1073741824, s98
    v_mfma_f32_16x16x32_bf16 v[184:187], v[48:51], v[80:83], v[184:187]
    s_bitcmp1_b32 s4, 0
    s_cselect_b32 s86, s86, s7
    s_cselect_b32 s87, s87, s98
    v_mfma_f32_16x16x32_bf16 v[184:187], v[52:55], v[84:87], v[184:187]
    s_mul_i32 s7, s86, 48
    v_accvgpr_write_b32 a178, 0
    v_accvgpr_write_b32 a179, 0
    v_mfma_f32_16x16x32_bf16 v[188:191], v[48:51], v[88:91], v[188:191]
    s_add_u32 s87, s87, s7
    buffer_load_dwordx4 v12, s[20:23], s64 offen offset:2048 lds
    v_mfma_f32_16x16x32_bf16 v[188:191], v[52:55], v[92:95], v[188:191]
    s_and_b32 s7, s5, 24
    ds_read_b64_tr_b16 v[48:49], v20 offset:0
    ds_read_b64_tr_b16 v[50:51], v20 offset:1024
    s_waitcnt lgkmcnt(2)
    v_mfma_f32_16x16x32_bf16 v[192:195], v[56:59], v[64:67], v[192:195]
    s_add_u32 s7, s7, s6
    ds_read_b64_tr_b16 v[52:53], v20 offset:8192
    ds_read_b64_tr_b16 v[54:55], v20 offset:9216
    v_mfma_f32_16x16x32_bf16 v[192:195], v[60:63], v[68:71], v[192:195]
    s_bfe_u32 s98, s5, 0x20001
    v_add_u32 v20, 0x10000, v20
    v_accvgpr_write_b32 a180, 0
    v_mfma_f32_16x16x32_bf16 v[196:199], v[56:59], v[72:75], v[196:199]
    s_lshl2_add_u32 s7, s7, s98
    v_accvgpr_write_b32 a181, 0
    v_accvgpr_write_b32 a182, 0
    v_mfma_f32_16x16x32_bf16 v[196:199], v[60:63], v[76:79], v[196:199]
    s_mul_i32 s98, s7, 36864
    ds_read_b128 v[108:111], v25 offset:24576
    v_add_u32 v36, s98, v36
    v_mfma_f32_16x16x32_bf16 v[200:203], v[56:59], v[80:83], v[200:203]
    s_mul_hi_u32 s98, s8, 715827883
    v_accvgpr_read_b32 v32, a192
    v_accvgpr_read_b32 v31, a193
    v_mfma_f32_16x16x32_bf16 v[200:203], v[60:63], v[84:87], v[200:203]
    s_add_u32 s87, s87, 19922944
    v_cvt_pk_bf16_f32 v32, v32, v31
    v_accvgpr_read_b32 v33, a194
    v_mfma_f32_16x16x32_bf16 v[204:207], v[56:59], v[88:91], v[204:207]
    ds_read_b64_tr_b16 v[56:57], v21 offset:0
    ds_read_b64_tr_b16 v[58:59], v21 offset:1024
    v_mfma_f32_16x16x32_bf16 v[204:207], v[60:63], v[92:95], v[204:207]
    ds_read_b64_tr_b16 v[60:61], v21 offset:8192
    ds_read_b64_tr_b16 v[62:63], v21 offset:9216
    v_mfma_f32_16x16x32_bf16 v[208:211], v[40:43], v[64:67], v[208:211]
    buffer_load_dwordx4 v13, s[20:23], s64 offen offset:3072 lds
    v_mfma_f32_16x16x32_bf16 v[208:211], v[44:47], v[68:71], v[208:211]
    v_add_u32 v21, 0x10000, v21
    v_accvgpr_read_b32 v31, a195
    v_mfma_f32_16x16x32_bf16 v[212:215], v[40:43], v[72:75], v[212:215]
    v_cvt_pk_bf16_f32 v33, v33, v31
    v_accvgpr_read_b32 v34, a196
    v_mfma_f32_16x16x32_bf16 v[212:215], v[44:47], v[76:79], v[212:215]
    v_accvgpr_read_b32 v31, a197
    v_cvt_pk_bf16_f32 v34, v34, v31
    v_mfma_f32_16x16x32_bf16 v[216:219], v[40:43], v[80:83], v[216:219]
    v_accvgpr_read_b32 v35, a198
    v_accvgpr_read_b32 v31, a199
    v_mfma_f32_16x16x32_bf16 v[216:219], v[44:47], v[84:87], v[216:219]
    v_cvt_pk_bf16_f32 v35, v35, v31
    v_sub_u32 v39, v36, v39
    v_mfma_f32_16x16x32_bf16 v[220:223], v[40:43], v[88:91], v[220:223]
    ds_read_b64_tr_b16 v[40:41], v26 offset:32768
    ds_read_b64_tr_b16 v[42:43], v26 offset:33280
    v_mfma_f32_16x16x32_bf16 v[220:223], v[44:47], v[92:95], v[220:223]
    s_add_u32 s72, s71, 4096
    ds_read_b64_tr_b16 v[44:45], v26 offset:36864
    ds_read_b64_tr_b16 v[46:47], v26 offset:37376
    s_waitcnt lgkmcnt(4)
    v_mfma_f32_16x16x32_bf16 v[224:227], v[48:51], v[64:67], v[224:227]
    v_add_u32 v26, 0x10000, v26
    v_lshl_add_u32 v36, s100, 6, v36
    v_mfma_f32_16x16x32_bf16 v[224:227], v[52:55], v[68:71], v[224:227]
    s_xor_b32 s64, s64, 128
    buffer_store_dwordx4 v[32:35], v1, s[36:39], s72 offen sc1
    v_mfma_f32_16x16x32_bf16 v[228:231], v[48:51], v[72:75], v[228:231]
    s_cmp_eq_u32 s4, 3
    s_cselect_b32 s84, s84, 1073741824
    v_accvgpr_write_b32 a183, 0
    v_mfma_f32_16x16x32_bf16 v[228:231], v[52:55], v[76:79], v[228:231]
    s_sub_u32 s40, s56, 22020096
    s_subb_u32 s41, s57, 0
    v_accvgpr_write_b32 a184, 0
    v_mfma_f32_16x16x32_bf16 v[232:235], v[48:51], v[80:83], v[232:235]
    s_add_u32 s85, s84, 3072
    v_accvgpr_write_b32 a185, 0
    v_accvgpr_write_b32 a186, 0
    v_mfma_f32_16x16x32_bf16 v[232:235], v[52:55], v[84:87], v[232:235]
    s_add_u32 m0, s69, 131072
    v_accvgpr_write_b32 a187, 0
    v_accvgpr_write_b32 a188, 0
    v_mfma_f32_16x16x32_bf16 v[236:239], v[48:51], v[88:91], v[236:239]
    buffer_load_dwordx4 v2, s[24:27], s60 offen lds
    v_mfma_f32_16x16x32_bf16 v[236:239], v[52:55], v[92:95], v[236:239]
    ds_read_b64_tr_b16 v[48:49], v27 offset:32768
    ds_read_b64_tr_b16 v[50:51], v27 offset:33280
    v_mfma_f32_16x16x32_bf16 v[240:243], v[56:59], v[64:67], v[240:243]
    ds_read_b64_tr_b16 v[52:53], v27 offset:36864
    ds_read_b64_tr_b16 v[54:55], v27 offset:37376
    v_mfma_f32_16x16x32_bf16 v[240:243], v[60:63], v[68:71], v[240:243]
    buffer_load_dwordx4 v3, s[24:27], s60 offen offset:1024 lds
    v_mfma_f32_16x16x32_bf16 v[244:247], v[56:59], v[72:75], v[244:247]
    v_add_u32 v27, 0x10000, v27
    v_accvgpr_write_b32 a189, 0
    v_mfma_f32_16x16x32_bf16 v[244:247], v[60:63], v[76:79], v[244:247]
    v_accvgpr_write_b32 a190, 0
    v_accvgpr_write_b32 a191, 0
    v_mfma_f32_16x16x32_bf16 v[248:251], v[56:59], v[80:83], v[248:251]
    v_accvgpr_read_b32 v32, a200
    v_accvgpr_read_b32 v31, a201
    v_mfma_f32_16x16x32_bf16 v[248:251], v[60:63], v[84:87], v[248:251]
    buffer_load_dwordx4 v4, s[24:27], s60 offen offset:2048 lds
    v_mfma_f32_16x16x32_bf16 v[252:255], v[56:59], v[88:91], v[252:255]
    ds_read_b64_tr_b16 v[56:57], v28 offset:32768
    ds_read_b64_tr_b16 v[58:59], v28 offset:33280
    v_mfma_f32_16x16x32_bf16 v[252:255], v[60:63], v[92:95], v[252:255]
    s_waitcnt lgkmcnt(2)
    ds_read_b64_tr_b16 v[60:61], v28 offset:36864
    ds_read_b64_tr_b16 v[62:63], v28 offset:37376
    v_mfma_f32_16x16x32_bf16 a[64:67], v[40:43], v[64:67], a[64:67]
    buffer_load_dwordx4 v5, s[24:27], s60 offen offset:3072 lds
    v_mfma_f32_16x16x32_bf16 a[64:67], v[44:47], v[68:71], a[64:67]
    v_add_u32 v28, 0x10000, v28
    v_cvt_pk_bf16_f32 v32, v32, v31
    v_mfma_f32_16x16x32_bf16 a[68:71], v[40:43], v[72:75], a[68:71]
    ds_read_b128 v[112:115], v24 offset:49152
    v_accvgpr_read_b32 v33, a202
    v_mfma_f32_16x16x32_bf16 a[68:71], v[44:47], v[76:79], a[68:71]
    s_add_u32 m0, s69, 147456
    v_accvgpr_read_b32 v31, a203
    v_cvt_pk_bf16_f32 v33, v33, v31
    v_mfma_f32_16x16x32_bf16 a[72:75], v[40:43], v[80:83], a[72:75]
    s_xor_b32 s60, s60, 524288
    buffer_load_dwordx4 v10, s[20:23], s63 offen lds
    v_mfma_f32_16x16x32_bf16 a[72:75], v[44:47], v[84:87], a[72:75]
    ds_read_b128 v[116:119], v25 offset:49152
    v_accvgpr_read_b32 v34, a204
    v_mfma_f32_16x16x32_bf16 a[76:79], v[40:43], v[88:91], a[76:79]
    ds_read_b64_tr_b16 v[40:41], v29 offset:32768
    ds_read_b64_tr_b16 v[42:43], v29 offset:33280
    v_mfma_f32_16x16x32_bf16 a[76:79], v[44:47], v[92:95], a[76:79]
    s_add_u32 s72, s71, 5120
    buffer_load_dwordx4 v11, s[20:23], s63 offen offset:1024 lds
    v_mfma_f32_16x16x32_bf16 a[80:83], v[48:51], v[64:67], a[80:83]
    ds_read_b128 v[120:123], v24 offset:57344
    ds_read_b64_tr_b16 v[44:45], v29 offset:36864
    v_mfma_f32_16x16x32_bf16 a[80:83], v[52:55], v[68:71], a[80:83]
    ds_read_b64_tr_b16 v[46:47], v29 offset:37376
    v_add_u32 v29, 0x10000, v29
    v_mfma_f32_16x16x32_bf16 a[84:87], v[48:51], v[72:75], a[84:87]
    v_accvgpr_read_b32 v31, a205
    v_cvt_pk_bf16_f32 v34, v34, v31
    v_mfma_f32_16x16x32_bf16 a[84:87], v[52:55], v[76:79], a[84:87]
    buffer_load_dwordx4 v12, s[20:23], s63 offen offset:2048 lds
    v_mfma_f32_16x16x32_bf16 a[88:91], v[48:51], v[80:83], a[88:91]
    ds_read_b128 v[124:127], v25 offset:57344
    v_accvgpr_read_b32 v35, a206
    v_mfma_f32_16x16x32_bf16 a[88:91], v[52:55], v[84:87], a[88:91]
    v_accvgpr_read_b32 v31, a207
    v_cvt_pk_bf16_f32 v35, v35, v31
    v_mfma_f32_16x16x32_bf16 a[92:95], v[48:51], v[88:91], a[92:95]
    buffer_load_dwordx4 v13, s[20:23], s63 offen offset:3072 lds
    v_mfma_f32_16x16x32_bf16 a[92:95], v[52:55], v[92:95], a[92:95]
    s_waitcnt lgkmcnt(1)
    v_accvgpr_write_b32 a192, 0
    v_accvgpr_write_b32 a193, 0
    v_mfma_f32_16x16x32_bf16 a[96:99], v[56:59], v[64:67], a[96:99]
    v_accvgpr_write_b32 a194, 0
    v_accvgpr_write_b32 a195, 0
    v_mfma_f32_16x16x32_bf16 a[96:99], v[60:63], v[68:71], a[96:99]
    s_xor_b32 s63, s63, 1920
    v_accvgpr_write_b32 a196, 0
    v_accvgpr_write_b32 a197, 0
    v_mfma_f32_16x16x32_bf16 a[100:103], v[56:59], v[72:75], a[100:103]
    s_andn2_b32 s63, s63, 896
    buffer_store_dwordx4 v[32:35], v1, s[36:39], s72 offen sc1
    v_mfma_f32_16x16x32_bf16 a[100:103], v[60:63], v[76:79], a[100:103]
    v_accvgpr_write_b32 a198, 0
    v_accvgpr_write_b32 a199, 0
    v_mfma_f32_16x16x32_bf16 a[104:107], v[56:59], v[80:83], a[104:107]
    v_accvgpr_read_b32 v32, a208
    v_accvgpr_read_b32 v31, a209
    v_mfma_f32_16x16x32_bf16 a[104:107], v[60:63], v[84:87], a[104:107]
    s_waitcnt vmcnt(10) lgkmcnt(0)
    s_barrier
    ds_read_b64_tr_b16 v[48:49], v14 offset:0
    v_mfma_f32_16x16x32_bf16 a[108:111], v[56:59], v[88:91], a[108:111]
    s_add_u32 m0, s67, 0
    ds_read_b64_tr_b16 v[50:51], v14 offset:1024
    ds_read_b64_tr_b16 v[52:53], v14 offset:8192
    v_mfma_f32_16x16x32_bf16 a[108:111], v[60:63], v[92:95], a[108:111]
    buffer_load_dwordx4 v1, s[28:31], s65 offen sc1 lds
    v_mfma_f32_16x16x32_bf16 a[112:115], v[40:43], v[64:67], a[112:115]
    ds_read_b64_tr_b16 v[54:55], v14 offset:9216
    ds_read_b64_tr_b16 v[56:57], v15 offset:0
    v_mfma_f32_16x16x32_bf16 a[112:115], v[44:47], v[68:71], a[112:115]
    ds_read_b64_tr_b16 v[58:59], v15 offset:1024
    ds_read_b64_tr_b16 v[60:61], v15 offset:8192
    v_mfma_f32_16x16x32_bf16 a[116:119], v[40:43], v[72:75], a[116:119]
    ds_read_b64_tr_b16 v[62:63], v15 offset:9216
    v_add_u32 v14, 0x10000, v14
    v_mfma_f32_16x16x32_bf16 a[116:119], v[44:47], v[76:79], a[116:119]
    v_add_u32 v15, 0x10000, v15
    v_cvt_pk_bf16_f32 v32, v32, v31
    v_mfma_f32_16x16x32_bf16 a[120:123], v[40:43], v[80:83], a[120:123]
    v_accvgpr_read_b32 v33, a210
    v_accvgpr_read_b32 v31, a211
    v_mfma_f32_16x16x32_bf16 a[120:123], v[44:47], v[84:87], a[120:123]
    v_cvt_pk_bf16_f32 v33, v33, v31
    v_accvgpr_read_b32 v34, a212
    v_mfma_f32_16x16x32_bf16 a[124:127], v[40:43], v[88:91], a[124:127]
    ds_read_b64_tr_b16 v[40:41], v16 offset:0
    ds_read_b64_tr_b16 v[42:43], v16 offset:1024
    v_mfma_f32_16x16x32_bf16 a[124:127], v[44:47], v[92:95], a[124:127]
    s_add_u32 s72, s71, 36864
    ds_read_b64_tr_b16 v[44:45], v16 offset:8192
    ds_read_b64_tr_b16 v[46:47], v16 offset:9216
    s_waitcnt lgkmcnt(4)
    v_mfma_f32_16x16x32_bf16 v[128:131], v[48:51], v[96:99], v[128:131]
    buffer_load_dwordx4 v1, s[28:31], s65 offen offset:1024 sc1 lds
    v_mfma_f32_16x16x32_bf16 v[128:131], v[52:55], v[100:103], v[128:131]
    v_add_u32 v24, 0x10000, v24
    v_add_u32 v16, 0x10000, v16
    v_mfma_f32_16x16x32_bf16 v[132:135], v[48:51], v[104:107], v[132:135]
    ds_read_b128 v[64:67], v24 offset:16384
    v_accvgpr_read_b32 v31, a213
    v_mfma_f32_16x16x32_bf16 v[132:135], v[52:55], v[108:111], v[132:135]
    v_cvt_pk_bf16_f32 v34, v34, v31
    v_accvgpr_read_b32 v35, a214
    v_mfma_f32_16x16x32_bf16 v[136:139], v[48:51], v[112:115], v[136:139]
    v_accvgpr_read_b32 v31, a215
    v_cvt_pk_bf16_f32 v35, v35, v31
    v_mfma_f32_16x16x32_bf16 v[136:139], v[52:55], v[116:119], v[136:139]
    buffer_store_dwordx4 v[32:35], v1, s[36:39], s72 offen sc1
    v_mfma_f32_16x16x32_bf16 v[140:143], v[48:51], v[120:123], v[140:143]
    ds_read_b64_tr_b16 v[48:49], v17 offset:0
    ds_read_b64_tr_b16 v[50:51], v17 offset:1024
    v_mfma_f32_16x16x32_bf16 v[140:143], v[52:55], v[124:127], v[140:143]
    ds_read_b64_tr_b16 v[52:53], v17 offset:8192
    ds_read_b64_tr_b16 v[54:55], v17 offset:9216
    v_mfma_f32_16x16x32_bf16 v[144:147], v[56:59], v[96:99], v[144:147]
    v_add_u32 v17, 0x10000, v17
    v_accvgpr_write_b32 a200, 0
    v_mfma_f32_16x16x32_bf16 v[144:147], v[60:63], v[100:103], v[144:147]
    s_add_u32 m0, s69, 16384
    v_accvgpr_write_b32 a201, 0
    v_accvgpr_write_b32 a202, 0
    v_mfma_f32_16x16x32_bf16 v[148:151], v[56:59], v[104:107], v[148:151]
    s_xor_b32 s65, s65, 8192
    buffer_load_dwordx4 v10, s[20:23], s64 offen lds
    v_mfma_f32_16x16x32_bf16 v[148:151], v[60:63], v[108:111], v[148:151]
    v_accvgpr_write_b32 a203, 0
    v_accvgpr_write_b32 a204, 0
    v_mfma_f32_16x16x32_bf16 v[152:155], v[56:59], v[112:115], v[152:155]
    v_add_u32 v25, 0x10000, v25
    v_accvgpr_read_b32 v32, a216
    v_mfma_f32_16x16x32_bf16 v[152:155], v[60:63], v[116:119], v[152:155]
    ds_read_b128 v[68:71], v25 offset:16384
    v_accvgpr_read_b32 v31, a217
    v_mfma_f32_16x16x32_bf16 v[156:159], v[56:59], v[120:123], v[156:159]
    ds_read_b64_tr_b16 v[56:57], v18 offset:0
    ds_read_b64_tr_b16 v[58:59], v18 offset:1024
    v_mfma_f32_16x16x32_bf16 v[156:159], v[60:63], v[124:127], v[156:159]
    s_waitcnt lgkmcnt(3)
    ds_read_b64_tr_b16 v[60:61], v18 offset:8192
    ds_read_b64_tr_b16 v[62:63], v18 offset:9216
    v_mfma_f32_16x16x32_bf16 v[160:163], v[40:43], v[96:99], v[160:163]
    v_add_u32 v18, 0x10000, v18
    v_cvt_pk_bf16_f32 v32, v32, v31
    v_mfma_f32_16x16x32_bf16 v[160:163], v[44:47], v[100:103], v[160:163]
    v_accvgpr_read_b32 v33, a218
    v_accvgpr_read_b32 v31, a219
    v_mfma_f32_16x16x32_bf16 v[164:167], v[40:43], v[104:107], v[164:167]
    v_cvt_pk_bf16_f32 v33, v33, v31
    v_accvgpr_read_b32 v34, a220
    v_mfma_f32_16x16x32_bf16 v[164:167], v[44:47], v[108:111], v[164:167]
    v_accvgpr_read_b32 v31, a221
    v_cvt_pk_bf16_f32 v34, v34, v31
    v_mfma_f32_16x16x32_bf16 v[168:171], v[40:43], v[112:115], v[168:171]
    buffer_load_dwordx4 v11, s[20:23], s64 offen offset:1024 lds
    v_mfma_f32_16x16x32_bf16 v[168:171], v[44:47], v[116:119], v[168:171]
    v_accvgpr_read_b32 v35, a222
    v_accvgpr_read_b32 v31, a223
    v_mfma_f32_16x16x32_bf16 v[172:175], v[40:43], v[120:123], v[172:175]
    ds_read_b64_tr_b16 v[40:41], v19 offset:0
    ds_read_b64_tr_b16 v[42:43], v19 offset:1024
    v_mfma_f32_16x16x32_bf16 v[172:175], v[44:47], v[124:127], v[172:175]
    s_add_u32 s72, s71, 37888
    ds_read_b64_tr_b16 v[44:45], v19 offset:8192
    ds_read_b64_tr_b16 v[46:47], v19 offset:9216
    v_mfma_f32_16x16x32_bf16 v[176:179], v[48:51], v[96:99], v[176:179]
    ds_read_b128 v[72:75], v24 offset:24576
    v_add_u32 v19, 0x10000, v19
    v_mfma_f32_16x16x32_bf16 v[176:179], v[52:55], v[100:103], v[176:179]
    v_cvt_pk_bf16_f32 v35, v35, v31
    v_accvgpr_write_b32 a205, 0
    v_mfma_f32_16x16x32_bf16 v[180:183], v[48:51], v[104:107], v[180:183]
    buffer_store_dwordx4 v[32:35], v1, s[36:39], s72 offen sc1
    v_mfma_f32_16x16x32_bf16 v[180:183], v[52:55], v[108:111], v[180:183]
    v_accvgpr_write_b32 a206, 0
    v_accvgpr_write_b32 a207, 0
    v_mfma_f32_16x16x32_bf16 v[184:187], v[48:51], v[112:115], v[184:187]
    v_accvgpr_write_b32 a208, 0
    v_accvgpr_write_b32 a209, 0
    v_mfma_f32_16x16x32_bf16 v[184:187], v[52:55], v[116:119], v[184:187]
    v_accvgpr_write_b32 a210, 0
    v_accvgpr_write_b32 a211, 0
    v_mfma_f32_16x16x32_bf16 v[188:191], v[48:51], v[120:123], v[188:191]
    buffer_load_dwordx4 v12, s[20:23], s64 offen offset:2048 lds
    v_mfma_f32_16x16x32_bf16 v[188:191], v[52:55], v[124:127], v[188:191]
    s_waitcnt lgkmcnt(0)
    ds_read_b64_tr_b16 v[48:49], v20 offset:0
    ds_read_b64_tr_b16 v[50:51], v20 offset:1024
    v_mfma_f32_16x16x32_bf16 v[192:195], v[56:59], v[96:99], v[192:195]
    ds_read_b64_tr_b16 v[52:53], v20 offset:8192
    ds_read_b64_tr_b16 v[54:55], v20 offset:9216
    v_mfma_f32_16x16x32_bf16 v[192:195], v[60:63], v[100:103], v[192:195]
    v_add_u32 v20, 0x10000, v20
    v_accvgpr_write_b32 a212, 0
    v_mfma_f32_16x16x32_bf16 v[196:199], v[56:59], v[104:107], v[196:199]
    v_accvgpr_write_b32 a213, 0
    v_accvgpr_write_b32 a214, 0
    v_mfma_f32_16x16x32_bf16 v[196:199], v[60:63], v[108:111], v[196:199]
    ds_read_b128 v[76:79], v25 offset:24576
    v_accvgpr_write_b32 a215, 0
    v_mfma_f32_16x16x32_bf16 v[200:203], v[56:59], v[112:115], v[200:203]
    v_accvgpr_read_b32 v32, a224
    v_accvgpr_read_b32 v31, a225
    v_mfma_f32_16x16x32_bf16 v[200:203], v[60:63], v[116:119], v[200:203]
    v_cvt_pk_bf16_f32 v32, v32, v31
    v_accvgpr_read_b32 v33, a226
    v_mfma_f32_16x16x32_bf16 v[204:207], v[56:59], v[120:123], v[204:207]
    ds_read_b64_tr_b16 v[56:57], v21 offset:0
    ds_read_b64_tr_b16 v[58:59], v21 offset:1024
    v_mfma_f32_16x16x32_bf16 v[204:207], v[60:63], v[124:127], v[204:207]
    ds_read_b64_tr_b16 v[60:61], v21 offset:8192
    ds_read_b64_tr_b16 v[62:63], v21 offset:9216
    v_mfma_f32_16x16x32_bf16 v[208:211], v[40:43], v[96:99], v[208:211]
    buffer_load_dwordx4 v13, s[20:23], s64 offen offset:3072 lds
    v_mfma_f32_16x16x32_bf16 v[208:211], v[44:47], v[100:103], v[208:211]
    v_add_u32 v21, 0x10000, v21
    v_accvgpr_read_b32 v31, a227
    v_mfma_f32_16x16x32_bf16 v[212:215], v[40:43], v[104:107], v[212:215]
    v_cvt_pk_bf16_f32 v33, v33, v31
    v_accvgpr_read_b32 v34, a228
    v_mfma_f32_16x16x32_bf16 v[212:215], v[44:47], v[108:111], v[212:215]
    v_accvgpr_read_b32 v31, a229
    v_cvt_pk_bf16_f32 v34, v34, v31
    v_mfma_f32_16x16x32_bf16 v[216:219], v[40:43], v[112:115], v[216:219]
    v_accvgpr_read_b32 v35, a230
    v_accvgpr_read_b32 v31, a231
    v_mfma_f32_16x16x32_bf16 v[216:219], v[44:47], v[116:119], v[216:219]
    v_cvt_pk_bf16_f32 v35, v35, v31
    v_accvgpr_write_b32 a216, 0
    v_mfma_f32_16x16x32_bf16 v[220:223], v[40:43], v[120:123], v[220:223]
    ds_read_b64_tr_b16 v[40:41], v26 offset:32768
    ds_read_b64_tr_b16 v[42:43], v26 offset:33280
    v_mfma_f32_16x16x32_bf16 v[220:223], v[44:47], v[124:127], v[220:223]
    s_add_u32 s72, s71, 6144
    ds_read_b64_tr_b16 v[44:45], v26 offset:36864
    ds_read_b64_tr_b16 v[46:47], v26 offset:37376
    s_waitcnt lgkmcnt(4)
    v_mfma_f32_16x16x32_bf16 v[224:227], v[48:51], v[96:99], v[224:227]
    v_add_u32 v26, 0xffff0000, v26
    v_accvgpr_write_b32 a217, 0
    v_mfma_f32_16x16x32_bf16 v[224:227], v[52:55], v[100:103], v[224:227]
    s_xor_b32 s64, s64, 1920
    buffer_store_dwordx4 v[32:35], v1, s[36:39], s72 offen sc1
    v_mfma_f32_16x16x32_bf16 v[228:231], v[48:51], v[104:107], v[228:231]
    s_andn2_b32 s64, s64, 896
    v_accvgpr_write_b32 a218, 0
    v_accvgpr_write_b32 a219, 0
    v_mfma_f32_16x16x32_bf16 v[228:231], v[52:55], v[108:111], v[228:231]
    v_accvgpr_write_b32 a220, 0
    v_accvgpr_write_b32 a221, 0
    v_mfma_f32_16x16x32_bf16 v[232:235], v[48:51], v[112:115], v[232:235]
    v_accvgpr_write_b32 a222, 0
    v_accvgpr_write_b32 a223, 0
    v_mfma_f32_16x16x32_bf16 v[232:235], v[52:55], v[116:119], v[232:235]
    s_add_u32 m0, s69, 32768
    v_mfma_f32_16x16x32_bf16 v[236:239], v[48:51], v[120:123], v[236:239]
    buffer_load_dwordx4 v2, s[24:27], s60 offen lds
    v_mfma_f32_16x16x32_bf16 v[236:239], v[52:55], v[124:127], v[236:239]
    ds_read_b64_tr_b16 v[48:49], v27 offset:32768
    ds_read_b64_tr_b16 v[50:51], v27 offset:33280
    v_mfma_f32_16x16x32_bf16 v[240:243], v[56:59], v[96:99], v[240:243]
    ds_read_b64_tr_b16 v[52:53], v27 offset:36864
    ds_read_b64_tr_b16 v[54:55], v27 offset:37376
    v_mfma_f32_16x16x32_bf16 v[240:243], v[60:63], v[100:103], v[240:243]
    buffer_load_dwordx4 v3, s[24:27], s60 offen offset:1024 lds
    v_mfma_f32_16x16x32_bf16 v[244:247], v[56:59], v[104:107], v[244:247]
    v_add_u32 v27, 0xffff0000, v27
    v_mfma_f32_16x16x32_bf16 v[244:247], v[60:63], v[108:111], v[244:247]
    v_mfma_f32_16x16x32_bf16 v[248:251], v[56:59], v[112:115], v[248:251]
    v_accvgpr_read_b32 v32, a232
    v_accvgpr_read_b32 v31, a233
    v_mfma_f32_16x16x32_bf16 v[248:251], v[60:63], v[116:119], v[248:251]
    buffer_load_dwordx4 v4, s[24:27], s60 offen offset:2048 lds
    v_mfma_f32_16x16x32_bf16 v[252:255], v[56:59], v[120:123], v[252:255]
    ds_read_b64_tr_b16 v[56:57], v28 offset:32768
    ds_read_b64_tr_b16 v[58:59], v28 offset:33280
    v_mfma_f32_16x16x32_bf16 v[252:255], v[60:63], v[124:127], v[252:255]
    s_waitcnt lgkmcnt(2)
    ds_read_b64_tr_b16 v[60:61], v28 offset:36864
    ds_read_b64_tr_b16 v[62:63], v28 offset:37376
    v_mfma_f32_16x16x32_bf16 a[64:67], v[40:43], v[96:99], a[64:67]
    buffer_load_dwordx4 v5, s[24:27], s60 offen offset:3072 lds
    v_mfma_f32_16x16x32_bf16 a[64:67], v[44:47], v[100:103], a[64:67]
    v_add_u32 v28, 0xffff0000, v28
    v_cvt_pk_bf16_f32 v32, v32, v31
    v_mfma_f32_16x16x32_bf16 a[68:71], v[40:43], v[104:107], a[68:71]
    ds_read_b128 v[80:83], v24 offset:49152
    v_accvgpr_read_b32 v33, a234
    v_mfma_f32_16x16x32_bf16 a[68:71], v[44:47], v[108:111], a[68:71]
    s_xor_b32 s60, s60, 7864320
    v_accvgpr_read_b32 v31, a235
    v_cvt_pk_bf16_f32 v33, v33, v31
    v_mfma_f32_16x16x32_bf16 a[72:75], v[40:43], v[112:115], a[72:75]
    s_add_u32 m0, s69, 49152
    v_accvgpr_read_b32 v34, a236
    v_accvgpr_read_b32 v31, a237
    v_mfma_f32_16x16x32_bf16 a[72:75], v[44:47], v[116:119], a[72:75]
    s_andn2_b32 s60, s60, 3670016
    buffer_load_dwordx4 v10, s[20:23], s63 offen lds
    v_mfma_f32_16x16x32_bf16 a[76:79], v[40:43], v[120:123], a[76:79]
    ds_read_b128 v[84:87], v25 offset:49152
    ds_read_b64_tr_b16 v[40:41], v29 offset:32768
    v_mfma_f32_16x16x32_bf16 a[76:79], v[44:47], v[124:127], a[76:79]
    s_add_u32 s72, s71, 7168
    buffer_load_dwordx4 v11, s[20:23], s63 offen offset:1024 lds
    v_mfma_f32_16x16x32_bf16 a[80:83], v[48:51], v[96:99], a[80:83]
    ds_read_b128 v[88:91], v24 offset:57344
    ds_read_b64_tr_b16 v[42:43], v29 offset:33280
    v_mfma_f32_16x16x32_bf16 a[80:83], v[52:55], v[100:103], a[80:83]
    ds_read_b64_tr_b16 v[44:45], v29 offset:36864
    ds_read_b64_tr_b16 v[46:47], v29 offset:37376
    v_mfma_f32_16x16x32_bf16 a[84:87], v[48:51], v[104:107], a[84:87]
    v_add_u32 v29, 0xffff0000, v29
    v_cvt_pk_bf16_f32 v34, v34, v31
    v_mfma_f32_16x16x32_bf16 a[84:87], v[52:55], v[108:111], a[84:87]
    buffer_load_dwordx4 v12, s[20:23], s63 offen offset:2048 lds
    v_mfma_f32_16x16x32_bf16 a[88:91], v[48:51], v[112:115], a[88:91]
    ds_read_b128 v[92:95], v25 offset:57344
    v_accvgpr_read_b32 v35, a238
    v_mfma_f32_16x16x32_bf16 a[88:91], v[52:55], v[116:119], a[88:91]
    v_accvgpr_read_b32 v31, a239
    v_cvt_pk_bf16_f32 v35, v35, v31
    v_mfma_f32_16x16x32_bf16 a[92:95], v[48:51], v[120:123], a[92:95]
    buffer_load_dwordx4 v13, s[20:23], s63 offen offset:3072 lds
    v_mfma_f32_16x16x32_bf16 a[92:95], v[52:55], v[124:127], a[92:95]
    s_waitcnt lgkmcnt(1)
    v_mfma_f32_16x16x32_bf16 a[96:99], v[56:59], v[96:99], a[96:99]
    v_mfma_f32_16x16x32_bf16 a[96:99], v[60:63], v[100:103], a[96:99]
    s_xor_b32 s63, s63, 128
    v_mfma_f32_16x16x32_bf16 a[100:103], v[56:59], v[104:107], a[100:103]
    buffer_store_dwordx4 v[32:35], v1, s[36:39], s72 offen sc1
    v_mfma_f32_16x16x32_bf16 a[100:103], v[60:63], v[108:111], a[100:103]
    v_mfma_f32_16x16x32_bf16 a[104:107], v[56:59], v[112:115], a[104:107]
    v_accvgpr_read_b32 v32, a240
    v_accvgpr_read_b32 v31, a241
    v_mfma_f32_16x16x32_bf16 a[104:107], v[60:63], v[116:119], a[104:107]
    s_waitcnt vmcnt(10) lgkmcnt(0)
    s_barrier
    ds_read_b64_tr_b16 v[48:49], v14 offset:0
    v_mfma_f32_16x16x32_bf16 a[108:111], v[56:59], v[120:123], a[108:111]
    s_add_u32 m0, s69, 65536
    ds_read_b64_tr_b16 v[50:51], v14 offset:1024
    ds_read_b64_tr_b16 v[52:53], v14 offset:8192
    v_mfma_f32_16x16x32_bf16 a[108:111], v[60:63], v[124:127], a[108:111]
    buffer_load_dwordx4 v2, s[24:27], s60 offen lds
    v_mfma_f32_16x16x32_bf16 a[112:115], v[40:43], v[96:99], a[112:115]
    ds_read_b64_tr_b16 v[54:55], v14 offset:9216
    ds_read_b64_tr_b16 v[56:57], v15 offset:0
    v_mfma_f32_16x16x32_bf16 a[112:115], v[44:47], v[100:103], a[112:115]
    ds_read_b64_tr_b16 v[58:59], v15 offset:1024
    ds_read_b64_tr_b16 v[60:61], v15 offset:8192
    v_mfma_f32_16x16x32_bf16 a[116:119], v[40:43], v[104:107], a[116:119]
    ds_read_b64_tr_b16 v[62:63], v15 offset:9216
    v_add_u32 v14, 0xfffe0000, v14
    v_mfma_f32_16x16x32_bf16 a[116:119], v[44:47], v[108:111], a[116:119]
    v_add_u32 v15, 0xfffe0000, v15
    v_cvt_pk_bf16_f32 v32, v32, v31
    v_mfma_f32_16x16x32_bf16 a[120:123], v[40:43], v[112:115], a[120:123]
    v_accvgpr_read_b32 v33, a242
    v_accvgpr_read_b32 v31, a243
    v_mfma_f32_16x16x32_bf16 a[120:123], v[44:47], v[116:119], a[120:123]
    buffer_load_dwordx4 v3, s[24:27], s60 offen offset:1024 lds
    v_mfma_f32_16x16x32_bf16 a[124:127], v[40:43], v[120:123], a[124:127]
    ds_read_b64_tr_b16 v[40:41], v16 offset:0
    ds_read_b64_tr_b16 v[42:43], v16 offset:1024
    v_mfma_f32_16x16x32_bf16 a[124:127], v[44:47], v[124:127], a[124:127]
    s_add_u32 s72, s71, 38912
    ds_read_b64_tr_b16 v[44:45], v16 offset:8192
    ds_read_b64_tr_b16 v[46:47], v16 offset:9216
    s_waitcnt lgkmcnt(4)
    v_mfma_f32_16x16x32_bf16 v[128:131], v[48:51], v[64:67], v[128:131]
    v_add_u32 v16, 0xfffe0000, v16
    v_cvt_pk_bf16_f32 v33, v33, v31
    v_mfma_f32_16x16x32_bf16 v[128:131], v[52:55], v[68:71], v[128:131]
    v_add_u32 v24, 0x10000, v24
    v_accvgpr_read_b32 v34, a244
    v_mfma_f32_16x16x32_bf16 v[132:135], v[48:51], v[72:75], v[132:135]
    ds_read_b128 v[96:99], v24 offset:16384
    v_accvgpr_read_b32 v31, a245
    v_mfma_f32_16x16x32_bf16 v[132:135], v[52:55], v[76:79], v[132:135]
    v_cvt_pk_bf16_f32 v34, v34, v31
    v_accvgpr_read_b32 v35, a246
    v_mfma_f32_16x16x32_bf16 v[136:139], v[48:51], v[80:83], v[136:139]
    v_accvgpr_read_b32 v31, a247
    v_cvt_pk_bf16_f32 v35, v35, v31
    v_mfma_f32_16x16x32_bf16 v[136:139], v[52:55], v[84:87], v[136:139]
    buffer_load_dwordx4 v4, s[24:27], s60 offen offset:2048 lds
    v_mfma_f32_16x16x32_bf16 v[140:143], v[48:51], v[88:91], v[140:143]
    ds_read_b64_tr_b16 v[48:49], v17 offset:0
    ds_read_b64_tr_b16 v[50:51], v17 offset:1024
    v_mfma_f32_16x16x32_bf16 v[140:143], v[52:55], v[92:95], v[140:143]
    ds_read_b64_tr_b16 v[52:53], v17 offset:8192
    ds_read_b64_tr_b16 v[54:55], v17 offset:9216
    v_mfma_f32_16x16x32_bf16 v[144:147], v[56:59], v[64:67], v[144:147]
    v_add_u32 v17, 0xfffe0000, v17
    v_mov_b32 v2, v1
    v_mfma_f32_16x16x32_bf16 v[144:147], v[60:63], v[68:71], v[144:147]
    buffer_store_dwordx4 v[32:35], v1, s[36:39], s72 offen sc1
    v_mfma_f32_16x16x32_bf16 v[148:151], v[56:59], v[72:75], v[148:151]
    v_mfma_f32_16x16x32_bf16 v[148:151], v[60:63], v[76:79], v[148:151]
    v_mfma_f32_16x16x32_bf16 v[152:155], v[56:59], v[80:83], v[152:155]
    v_add_u32 v25, 0x10000, v25
    v_accvgpr_read_b32 v32, a248
    v_mfma_f32_16x16x32_bf16 v[152:155], v[60:63], v[84:87], v[152:155]
    buffer_load_dwordx4 v5, s[24:27], s60 offen offset:3072 lds
    v_mfma_f32_16x16x32_bf16 v[156:159], v[56:59], v[88:91], v[156:159]
    ds_read_b128 v[100:103], v25 offset:16384
    ds_read_b64_tr_b16 v[56:57], v18 offset:0
    v_mfma_f32_16x16x32_bf16 v[156:159], v[60:63], v[92:95], v[156:159]
    s_waitcnt lgkmcnt(2)
    ds_read_b64_tr_b16 v[58:59], v18 offset:1024
    ds_read_b64_tr_b16 v[60:61], v18 offset:8192
    v_mfma_f32_16x16x32_bf16 v[160:163], v[40:43], v[64:67], v[160:163]
    ds_read_b64_tr_b16 v[62:63], v18 offset:9216
    v_add_u32 v18, 0xfffe0000, v18
    v_mfma_f32_16x16x32_bf16 v[160:163], v[44:47], v[68:71], v[160:163]
    v_accvgpr_read_b32 v31, a249
    v_cvt_pk_bf16_f32 v32, v32, v31
    v_mfma_f32_16x16x32_bf16 v[164:167], v[40:43], v[72:75], v[164:167]
    v_accvgpr_read_b32 v33, a250
    v_accvgpr_read_b32 v31, a251
    v_mfma_f32_16x16x32_bf16 v[164:167], v[44:47], v[76:79], v[164:167]
    s_add_u32 m0, s69, 81920
    v_cvt_pk_bf16_f32 v33, v33, v31
    v_accvgpr_read_b32 v34, a252
    v_mfma_f32_16x16x32_bf16 v[168:171], v[40:43], v[80:83], v[168:171]
    s_xor_b32 s60, s60, 524288
    buffer_load_dwordx4 v10, s[20:23], s64 offen lds
    v_mfma_f32_16x16x32_bf16 v[168:171], v[44:47], v[84:87], v[168:171]
    s_mov_b32 s60, 131072
    v_accvgpr_read_b32 v31, a253
    v_cvt_pk_bf16_f32 v34, v34, v31
    v_mfma_f32_16x16x32_bf16 v[172:175], v[40:43], v[88:91], v[172:175]
    ds_read_b64_tr_b16 v[40:41], v19 offset:0
    ds_read_b64_tr_b16 v[42:43], v19 offset:1024
    v_mfma_f32_16x16x32_bf16 v[172:175], v[44:47], v[92:95], v[172:175]
    s_add_u32 s72, s71, 39936
    ds_read_b64_tr_b16 v[44:45], v19 offset:8192
    ds_read_b64_tr_b16 v[46:47], v19 offset:9216
    v_mfma_f32_16x16x32_bf16 v[176:179], v[48:51], v[64:67], v[176:179]
    ds_read_b128 v[104:107], v24 offset:24576
    v_add_u32 v19, 0xfffe0000, v19
    v_mfma_f32_16x16x32_bf16 v[176:179], v[52:55], v[68:71], v[176:179]
    v_accvgpr_read_b32 v35, a254
    v_accvgpr_read_b32 v31, a255
    v_mfma_f32_16x16x32_bf16 v[180:183], v[48:51], v[72:75], v[180:183]
    v_cvt_pk_bf16_f32 v35, v35, v31
    v_mov_b32 v31, 1
    v_mfma_f32_16x16x32_bf16 v[180:183], v[52:55], v[76:79], v[180:183]
    buffer_load_dwordx4 v11, s[20:23], s64 offen offset:1024 lds
    v_mfma_f32_16x16x32_bf16 v[184:187], v[48:51], v[80:83], v[184:187]
    buffer_store_dwordx4 v[32:35], v1, s[36:39], s72 offen sc1
    v_mfma_f32_16x16x32_bf16 v[184:187], v[52:55], v[84:87], v[184:187]
    v_add_u32 v11, s99, v39
    v_mfma_f32_16x16x32_bf16 v[188:191], v[48:51], v[88:91], v[188:191]
    s_mul_i32 s99, s98, 6
    ds_read_b64_tr_b16 v[48:49], v20 offset:0
    ds_read_b64_tr_b16 v[50:51], v20 offset:1024
    v_mfma_f32_16x16x32_bf16 v[188:191], v[52:55], v[92:95], v[188:191]
    s_sub_u32 s99, s8, s99
    ds_read_b64_tr_b16 v[52:53], v20 offset:8192
    ds_read_b64_tr_b16 v[54:55], v20 offset:9216
    s_waitcnt lgkmcnt(4)
    v_mfma_f32_16x16x32_bf16 v[192:195], v[56:59], v[64:67], v[192:195]
    s_mul_i32 s99, s99, 6
    v_add_u32 v20, 0xfffe0000, v20
    v_mfma_f32_16x16x32_bf16 v[192:195], v[60:63], v[68:71], v[192:195]
    s_lshl1_add_u32 s99, s4, s99
    v_mfma_f32_16x16x32_bf16 v[196:199], v[56:59], v[72:75], v[196:199]
    s_sub_u32 s99, s99, 2
    v_mfma_f32_16x16x32_bf16 v[196:199], v[60:63], v[76:79], v[196:199]
    s_lshl_b32 s8, s99, 5
    buffer_load_dwordx4 v12, s[20:23], s64 offen offset:2048 lds
    v_mfma_f32_16x16x32_bf16 v[200:203], v[56:59], v[80:83], v[200:203]
    s_lshr_b32 s99, s99, 1
    ds_read_b128 v[108:111], v25 offset:24576
    v_lshl_add_u32 v10, v38, 4, s8
    v_mfma_f32_16x16x32_bf16 v[200:203], v[60:63], v[84:87], v[200:203]
    s_lshr_b32 s8, s5, 3
    v_lshrrev_b32 v38, 3, v37
    v_mul_u32_u24 v39, 18, v38
    v_mfma_f32_16x16x32_bf16 v[204:207], v[56:59], v[88:91], v[204:207]
    s_mul_i32 s8, s8, 6
    ds_read_b64_tr_b16 v[56:57], v21 offset:0
    ds_read_b64_tr_b16 v[58:59], v21 offset:1024
    v_mfma_f32_16x16x32_bf16 v[204:207], v[60:63], v[92:95], v[204:207]
    ds_read_b64_tr_b16 v[60:61], v21 offset:8192
    ds_read_b64_tr_b16 v[62:63], v21 offset:9216
    v_mfma_f32_16x16x32_bf16 v[208:211], v[40:43], v[64:67], v[208:211]
    v_add_u32 v21, 0xfffe0000, v21
    v_and_b32 v38, 4, v37
    v_mfma_f32_16x16x32_bf16 v[208:211], v[44:47], v[68:71], v[208:211]
    s_cmp_lt_u32 s98, 5
    s_cselect_b32 s98, s98, 40
    v_lshl_add_u32 v39, v38, 1, v39
    v_mfma_f32_16x16x32_bf16 v[212:215], v[40:43], v[72:75], v[212:215]
    s_lshl1_add_u32 s9, s98, s9
    buffer_load_dwordx4 v13, s[20:23], s64 offen offset:3072 lds
    v_mfma_f32_16x16x32_bf16 v[212:215], v[44:47], v[76:79], v[212:215]
    s_mul_i32 s9, s9, 18
    v_lshrrev_b32 v38, 2, v37
    v_mul_u32_u24 v38, 36, v38
    v_mfma_f32_16x16x32_bf16 v[216:219], v[40:43], v[80:83], v[216:219]
    v_add_u32 v39, s9, v39
    v_add_u32 v38, s10, v38
    v_mfma_f32_16x16x32_bf16 v[216:219], v[44:47], v[84:87], v[216:219]
    s_cmp_eq_u32 s98, 4
    s_cselect_b64 vcc, -1, 0
    v_and_b32 v37, 3, v37
    v_mfma_f32_16x16x32_bf16 v[220:223], v[40:43], v[88:91], v[220:223]
    ds_read_b64_tr_b16 v[40:41], v26 offset:0
    ds_read_b64_tr_b16 v[42:43], v26 offset:512
    v_mfma_f32_16x16x32_bf16 v[220:223], v[44:47], v[92:95], v[220:223]
    s_waitcnt lgkmcnt(2)
    ds_read_b64_tr_b16 v[44:45], v26 offset:4096
    ds_read_b64_tr_b16 v[46:47], v26 offset:4608
    v_mfma_f32_16x16x32_bf16 v[224:227], v[48:51], v[64:67], v[224:227]
    v_add_u32 v26, 0x10000, v26
    v_cndmask_b32 v39, v39, v38, vcc
    v_mfma_f32_16x16x32_bf16 v[224:227], v[52:55], v[68:71], v[224:227]
    s_xor_b32 s64, s64, 128
    v_add_u32 v39, v39, v37
    v_mul_u32_u24 v39, 1152, v39
    v_mfma_f32_16x16x32_bf16 v[228:231], v[48:51], v[72:75], v[228:231]
    s_cmp_eq_u32 s98, 4
    s_cselect_b32 s9, 18, 4
    s_cselect_b32 s10, 2, 4
    v_mfma_f32_16x16x32_bf16 v[228:231], v[52:55], v[76:79], v[228:231]
    s_mul_i32 s9, s9, 1152
    v_add_u32 v39, v39, v10
    v_mov_b32 v38, 1073741824
    v_mfma_f32_16x16x32_bf16 v[232:235], v[48:51], v[80:83], v[232:235]
    s_add_u32 s98, s98, s8
    v_cmp_gt_u32 vcc, s10, v37
    v_lshrrev_b32 v37, 8, v1
    v_mfma_f32_16x16x32_bf16 v[232:235], v[52:55], v[84:87], v[232:235]
    s_add_u32 m0, s67, 98304
    v_cndmask_b32 v12, v38, v39, vcc
    v_add_u32 v38, 1024, v36
    v_mfma_f32_16x16x32_bf16 v[236:239], v[48:51], v[88:91], v[236:239]
    s_add_u32 s98, s98, 128
    buffer_load_dwordx4 v1, s[28:31], s65 offen sc1 lds
    v_mfma_f32_16x16x32_bf16 v[236:239], v[52:55], v[92:95], v[236:239]
    s_add_u32 s8, s100, 16
    ds_read_b64_tr_b16 v[48:49], v27 offset:0
    ds_read_b64_tr_b16 v[50:51], v27 offset:512
    v_mfma_f32_16x16x32_bf16 v[240:243], v[56:59], v[64:67], v[240:243]
    s_lshr_b32 s10, s5, 3
    ds_read_b64_tr_b16 v[52:53], v27 offset:4096
    ds_read_b64_tr_b16 v[54:55], v27 offset:4608
    v_mfma_f32_16x16x32_bf16 v[240:243], v[60:63], v[68:71], v[240:243]
    v_add_u32 v27, 0x10000, v27
    v_add_u32 v13, s9, v12
    v_mfma_f32_16x16x32_bf16 v[244:247], v[56:59], v[72:75], v[244:247]
    s_cmp_eq_u32 s4, 0
    s_cselect_b64 vcc, -1, 0
    v_cndmask_b32 v12, v12, v38, vcc
    v_mfma_f32_16x16x32_bf16 v[244:247], v[60:63], v[76:79], v[244:247]
    v_add_u32 v38, 19456, v36
    v_bfe_u32 v36, v1, 4, 4
    v_mfma_f32_16x16x32_bf16 v[248:251], v[56:59], v[80:83], v[248:251]
    s_cmp_eq_u32 s4, 0
    s_cselect_b64 vcc, -1, 0
    v_cndmask_b32 v13, v13, v38, vcc
    v_mfma_f32_16x16x32_bf16 v[248:251], v[60:63], v[84:87], v[248:251]
    s_cmp_eq_u32 s4, 0
    s_cselect_b32 s98, s7, s98
    s_cselect_b32 s99, s8, s99
    v_mfma_f32_16x16x32_bf16 v[252:255], v[56:59], v[88:91], v[252:255]
    s_lshr_b32 s9, s99, 2
    ds_read_b64_tr_b16 v[56:57], v28 offset:0
    ds_read_b64_tr_b16 v[58:59], v28 offset:512
    v_mfma_f32_16x16x32_bf16 v[252:255], v[60:63], v[92:95], v[252:255]
    s_sub_u32 s9, s9, s10
    ds_read_b64_tr_b16 v[60:61], v28 offset:4096
    ds_read_b64_tr_b16 v[62:63], v28 offset:4608
    s_waitcnt lgkmcnt(4)
    v_mfma_f32_16x16x32_bf16 a[64:67], v[40:43], v[64:67], a[64:67]
    s_lshr_b32 s92, s2, 3
    v_lshrrev_b32 v9, 4, v1
    v_min_u32 v9, 0, v9
    v_mfma_f32_16x16x32_bf16 a[64:67], v[44:47], v[68:71], a[64:67]
    s_lshl2_add_u32 s92, s92, s4
    v_add_u32 v24, 0xfffe0000, v24
    v_add_u32 v28, 0x10000, v28
    v_mfma_f32_16x16x32_bf16 a[68:71], v[40:43], v[72:75], a[68:71]
    s_mul_i32 s92, s92, 1
    ds_read_b128 v[112:115], v24 offset:16384
    v_lshlrev_b32 v37, 2, v37
    v_mfma_f32_16x16x32_bf16 a[68:71], v[44:47], v[76:79], a[68:71]
    s_add_u32 s92, s92, 32
    v_add_lshl_u32 v9, v9, s92, 7
    v_sub_u32 v36, v36, v37
    v_mfma_f32_16x16x32_bf16 a[72:75], v[40:43], v[80:83], a[72:75]
    s_sub_u32 s9, s9, 1
    v_add_u32 v25, 0xfffe0000, v25
    v_mov_b32 v37, 0xf149f2ca
    v_mfma_f32_16x16x32_bf16 a[72:75], v[44:47], v[84:87], a[72:75]
    s_getpc_b64 s[92:93]
    global_load_dword v9, v9, s[92:93]
    v_mfma_f32_16x16x32_bf16 a[76:79], v[40:43], v[88:91], a[76:79]
    s_and_b32 s9, s9, 3
    buffer_load_dwordx4 v1, s[28:31], s65 offen offset:1024 sc1 lds
    v_mfma_f32_16x16x32_bf16 a[76:79], v[44:47], v[92:95], a[76:79]
    s_lshl_b32 s9, s9, 1
    ds_read_b128 v[116:119], v25 offset:16384
    ds_read_b64_tr_b16 v[40:41], v29 offset:0
    v_mfma_f32_16x16x32_bf16 a[80:83], v[48:51], v[64:67], a[80:83]
    s_and_b32 s10, s99, 3
    ds_read_b128 v[120:123], v24 offset:24576
    v_bfe_u32 v38, v1, 4, 1
    v_mfma_f32_16x16x32_bf16 a[80:83], v[52:55], v[68:71], a[80:83]
    s_mul_i32 s10, s10, 9
    ds_read_b64_tr_b16 v[42:43], v29 offset:512
    ds_read_b64_tr_b16 v[44:45], v29 offset:4096
    v_mfma_f32_16x16x32_bf16 a[84:87], v[48:51], v[72:75], a[84:87]
    s_mul_i32 s98, s98, 36864
    ds_read_b64_tr_b16 v[46:47], v29 offset:4608
    v_add_u32 v29, 0x10000, v29
    v_mfma_f32_16x16x32_bf16 a[84:87], v[52:55], v[76:79], a[84:87]
    s_mul_i32 s7, s7, 36864
    ds_read_b128 v[124:127], v25 offset:24576
    v_sub_u32 v38, 0, v38
    v_mfma_f32_16x16x32_bf16 a[88:91], v[48:51], v[80:83], a[88:91]
    s_cmp_eq_u32 s9, 6
    s_cselect_b32 s9, 7, s9
    v_and_b32 v38, 0xaaaaaaaa, v38
    v_mfma_f32_16x16x32_bf16 a[88:91], v[52:55], v[84:87], a[88:91]
    s_add_u32 s9, s9, s10
    v_and_b32 v39, 0x40, v1
    v_mfma_f32_16x16x32_bf16 a[92:95], v[48:51], v[88:91], a[92:95]
    s_lshl_b32 s64, s9, 10
    v_mfma_f32_16x16x32_bf16 a[92:95], v[52:55], v[92:95], a[92:95]
    s_sub_u32 s9, s99, 16
    s_waitcnt lgkmcnt(1)
    v_mfma_f32_16x16x32_bf16 a[96:99], v[56:59], v[64:67], a[96:99]
    s_mul_i32 s9, s9, 18432
    v_mfma_f32_16x16x32_bf16 a[96:99], v[60:63], v[68:71], a[96:99]
    s_xor_b32 s65, s65, 122880
    v_mfma_f32_16x16x32_bf16 a[100:103], v[56:59], v[72:75], a[100:103]
    s_andn2_b32 s65, s65, 57344
    v_mfma_f32_16x16x32_bf16 a[100:103], v[60:63], v[76:79], a[100:103]
    s_add_u32 s9, s9, 6144
    v_mfma_f32_16x16x32_bf16 a[104:107], v[56:59], v[80:83], a[104:107]
    s_mov_b32 s10, 1024
    v_mfma_f32_16x16x32_bf16 a[104:107], v[60:63], v[84:87], a[104:107]
    s_waitcnt vmcnt(3) lgkmcnt(0)
    s_barrier
    ds_read_b64_tr_b16 v[48:49], v14 offset:32768
    v_mfma_f32_16x16x32_bf16 a[108:111], v[56:59], v[88:91], a[108:111]
    s_add_u32 m0, s67, 131072
    buffer_store_dword v31, v30, s[32:35], s101 offen sc1
    v_mfma_f32_16x16x32_bf16 a[108:111], v[60:63], v[92:95], a[108:111]
    s_mov_b32 s93, 65536
    buffer_load_dwordx4 v1, s[28:31], s65 offen sc1 lds
    v_mfma_f32_16x16x32_bf16 a[112:115], v[40:43], v[64:67], a[112:115]
    ds_read_b64_tr_b16 v[50:51], v14 offset:33792
    ds_read_b64_tr_b16 v[52:53], v14 offset:40960
    v_mfma_f32_16x16x32_bf16 a[112:115], v[44:47], v[68:71], a[112:115]
    ds_read_b64_tr_b16 v[54:55], v14 offset:41984
    ds_read_b64_tr_b16 v[56:57], v15 offset:32768
    v_mfma_f32_16x16x32_bf16 a[116:119], v[40:43], v[72:75], a[116:119]
    ds_read_b64_tr_b16 v[58:59], v15 offset:33792
    ds_read_b64_tr_b16 v[60:61], v15 offset:40960
    v_mfma_f32_16x16x32_bf16 a[116:119], v[44:47], v[76:79], a[116:119]
    ds_read_b64_tr_b16 v[62:63], v15 offset:41984
    v_add_u32 v14, 0x10000, v14
    v_mfma_f32_16x16x32_bf16 a[120:123], v[40:43], v[80:83], a[120:123]
    v_add_u32 v15, 0x10000, v15
    v_mfma_f32_16x16x32_bf16 a[120:123], v[44:47], v[84:87], a[120:123]
    s_cmp_lt_u32 s99, 16
    s_cselect_b32 s64, s64, s9
    s_cselect_b32 s10, s10, 9216
    v_mfma_f32_16x16x32_bf16 a[124:127], v[40:43], v[88:91], a[124:127]
    s_lshl2_add_u32 s99, s100, s4
    ds_read_b64_tr_b16 v[40:41], v16 offset:32768
    ds_read_b64_tr_b16 v[42:43], v16 offset:33792
    v_mfma_f32_16x16x32_bf16 a[124:127], v[44:47], v[92:95], a[124:127]
    s_add_u32 s64, s64, s98
    ds_read_b64_tr_b16 v[44:45], v16 offset:40960
    ds_read_b64_tr_b16 v[46:47], v16 offset:41984
    s_waitcnt lgkmcnt(5)
    v_mfma_f32_16x16x32_bf16 v[128:131], v[48:51], v[96:99], v[128:131]
    s_lshl_b32 s99, s99, 1
    v_add_u32 v16, 0x10000, v16
    v_mfma_f32_16x16x32_bf16 v[128:131], v[52:55], v[100:103], v[128:131]
    s_add_u32 s62, s64, s10
    v_mfma_f32_16x16x32_bf16 v[132:135], v[48:51], v[104:107], v[132:135]
    s_lshr_b32 s9, s99, 2
    ds_read_b128 v[64:67], v24 offset:49152
    v_mfma_f32_16x16x32_bf16 v[132:135], v[52:55], v[108:111], v[132:135]
    s_lshr_b32 s10, s5, 3
    v_mfma_f32_16x16x32_bf16 v[136:139], v[48:51], v[112:115], v[136:139]
    s_sub_u32 s9, s9, s10
    v_mfma_f32_16x16x32_bf16 v[136:139], v[52:55], v[116:119], v[136:139]
    s_sub_u32 s9, s9, 1
    v_mfma_f32_16x16x32_bf16 v[140:143], v[48:51], v[120:123], v[140:143]
    s_and_b32 s9, s9, 3
    ds_read_b64_tr_b16 v[48:49], v17 offset:32768
    ds_read_b64_tr_b16 v[50:51], v17 offset:33792
    v_mfma_f32_16x16x32_bf16 v[140:143], v[52:55], v[124:127], v[140:143]
    s_lshl_b32 s9, s9, 1
    ds_read_b64_tr_b16 v[52:53], v17 offset:40960
    ds_read_b64_tr_b16 v[54:55], v17 offset:41984
    v_mfma_f32_16x16x32_bf16 v[144:147], v[56:59], v[96:99], v[144:147]
    s_and_b32 s10, s99, 3
    ds_read_b128 v[68:71], v25 offset:49152
    v_add_u32 v17, 0x10000, v17
    s_waitcnt lgkmcnt(5)
    v_mfma_f32_16x16x32_bf16 v[144:147], v[60:63], v[100:103], v[144:147]
    s_cmp_eq_u32 s9, 6
    s_cselect_b32 s9, 7, s9
    v_mfma_f32_16x16x32_bf16 v[148:151], v[56:59], v[104:107], v[148:151]
    s_mul_i32 s10, s10, 9
    v_mfma_f32_16x16x32_bf16 v[148:151], v[60:63], v[108:111], v[148:151]
    s_add_u32 s9, s9, s10
    v_mfma_f32_16x16x32_bf16 v[152:155], v[56:59], v[112:115], v[152:155]
    s_lshl_b32 s63, s9, 10
    v_mfma_f32_16x16x32_bf16 v[152:155], v[60:63], v[116:119], v[152:155]
    s_cmp_eq_u32 s4, 0
    s_cselect_b32 s8, 1.0, 0
    v_mfma_f32_16x16x32_bf16 v[156:159], v[56:59], v[120:123], v[156:159]
    s_add_u32 s63, s63, s7
    ds_read_b128 v[72:75], v24 offset:57344
    ds_read_b64_tr_b16 v[56:57], v18 offset:32768
    v_mfma_f32_16x16x32_bf16 v[156:159], v[60:63], v[124:127], v[156:159]
    ds_read_b64_tr_b16 v[58:59], v18 offset:33792
    ds_read_b64_tr_b16 v[60:61], v18 offset:40960
    v_mfma_f32_16x16x32_bf16 v[160:163], v[40:43], v[96:99], v[160:163]
    ds_read_b64_tr_b16 v[62:63], v18 offset:41984
    v_add_u32 v18, 0x10000, v18
    v_mfma_f32_16x16x32_bf16 v[160:163], v[44:47], v[100:103], v[160:163]
    s_cmp_eq_u32 s4, 1
    s_cselect_b32 s9, 1.0, 0
    v_mfma_f32_16x16x32_bf16 v[164:167], v[40:43], v[104:107], v[164:167]
    s_cmp_eq_u32 s6, 0
    s_cselect_b32 s16, s8, 0
    s_cselect_b32 s17, s9, 0
    v_mfma_f32_16x16x32_bf16 v[164:167], v[44:47], v[108:111], v[164:167]
    s_cmp_eq_u32 s4, 2
    s_cselect_b32 s10, 1.0, 0
    v_mfma_f32_16x16x32_bf16 v[168:171], v[40:43], v[112:115], v[168:171]
    buffer_load_dwordx4 v1, s[28:31], s65 offen offset:1024 sc1 lds
    v_mfma_f32_16x16x32_bf16 v[168:171], v[44:47], v[116:119], v[168:171]
    ds_read_b128 v[76:79], v25 offset:57344
    v_mfma_f32_16x16x32_bf16 v[172:175], v[40:43], v[120:123], v[172:175]
    ds_read_b64_tr_b16 v[40:41], v19 offset:32768
    ds_read_b64_tr_b16 v[42:43], v19 offset:33792
    v_mfma_f32_16x16x32_bf16 v[172:175], v[44:47], v[124:127], v[172:175]
    s_waitcnt lgkmcnt(3)
    ds_read_b64_tr_b16 v[44:45], v19 offset:40960
    ds_read_b64_tr_b16 v[46:47], v19 offset:41984
    v_mfma_f32_16x16x32_bf16 v[176:179], v[48:51], v[96:99], v[176:179]
    v_add_u32 v19, 0x10000, v19
    v_mfma_f32_16x16x32_bf16 v[176:179], v[52:55], v[100:103], v[176:179]
    s_cmp_eq_u32 s6, 0
    s_cselect_b32 s18, s10, 0
    s_cselect_b32 s19, s11, 0
    v_mfma_f32_16x16x32_bf16 v[180:183], v[48:51], v[104:107], v[180:183]
    s_cmp_eq_u32 s6, 0
    s_cselect_b32 s20, s12, 0
    s_cselect_b32 s21, s13, 0
    v_mfma_f32_16x16x32_bf16 v[180:183], v[52:55], v[108:111], v[180:183]
    v_add_u32 v24, 0x10000, v24
    v_mfma_f32_16x16x32_bf16 v[184:187], v[48:51], v[112:115], v[184:187]
    ds_read_b128 v[80:83], v24 offset:16384
    v_mfma_f32_16x16x32_bf16 v[184:187], v[52:55], v[116:119], v[184:187]
    s_cmp_eq_u32 s6, 0
    s_cselect_b32 s22, s14, 0
    s_cselect_b32 s23, s15, 0
    v_mfma_f32_16x16x32_bf16 v[188:191], v[48:51], v[120:123], v[188:191]
    ds_read_b64_tr_b16 v[48:49], v20 offset:32768
    ds_read_b64_tr_b16 v[50:51], v20 offset:33792
    v_mfma_f32_16x16x32_bf16 v[188:191], v[52:55], v[124:127], v[188:191]
    ds_read_b64_tr_b16 v[52:53], v20 offset:40960
    ds_read_b64_tr_b16 v[54:55], v20 offset:41984
    v_mfma_f32_16x16x32_bf16 v[192:195], v[56:59], v[96:99], v[192:195]
    v_add_u32 v20, 0x10000, v20
    v_mfma_f32_16x16x32_bf16 v[192:195], v[60:63], v[100:103], v[192:195]
    v_add_u32 v25, 0x10000, v25
    v_mfma_f32_16x16x32_bf16 v[196:199], v[56:59], v[104:107], v[196:199]
    ds_read_b128 v[84:87], v25 offset:16384
    v_mfma_f32_16x16x32_bf16 v[196:199], v[60:63], v[108:111], v[196:199]
    v_mfma_f32_16x16x32_bf16 v[200:203], v[56:59], v[112:115], v[200:203]
    v_mfma_f32_16x16x32_bf16 v[200:203], v[60:63], v[116:119], v[200:203]
    v_mfma_f32_16x16x32_bf16 v[204:207], v[56:59], v[120:123], v[204:207]
    ds_read_b64_tr_b16 v[56:57], v21 offset:32768
    ds_read_b64_tr_b16 v[58:59], v21 offset:33792
    v_mfma_f32_16x16x32_bf16 v[204:207], v[60:63], v[124:127], v[204:207]
    s_waitcnt lgkmcnt(2)
    ds_read_b64_tr_b16 v[60:61], v21 offset:40960
    ds_read_b64_tr_b16 v[62:63], v21 offset:41984
    v_mfma_f32_16x16x32_bf16 v[208:211], v[40:43], v[96:99], v[208:211]
    ds_read_b128 v[88:91], v24 offset:24576
    v_add_u32 v21, 0x10000, v21
    v_mfma_f32_16x16x32_bf16 v[208:211], v[44:47], v[100:103], v[208:211]
    v_mfma_f32_16x16x32_bf16 v[212:215], v[40:43], v[104:107], v[212:215]
    v_mfma_f32_16x16x32_bf16 v[212:215], v[44:47], v[108:111], v[212:215]
    v_mfma_f32_16x16x32_bf16 v[216:219], v[40:43], v[112:115], v[216:219]
    v_mfma_f32_16x16x32_bf16 v[216:219], v[44:47], v[116:119], v[216:219]
    v_mfma_f32_16x16x32_bf16 v[220:223], v[40:43], v[120:123], v[220:223]
    ds_read_b128 v[92:95], v25 offset:24576
    ds_read_b64_tr_b16 v[40:41], v14 offset:0
    v_mfma_f32_16x16x32_bf16 v[220:223], v[44:47], v[124:127], v[220:223]
    ds_read_b64_tr_b16 v[42:43], v14 offset:1024
    ds_read_b64_tr_b16 v[44:45], v14 offset:8192
    v_mfma_f32_16x16x32_bf16 v[224:227], v[48:51], v[96:99], v[224:227]
    ds_read_b64_tr_b16 v[46:47], v14 offset:9216
    v_mfma_f32_16x16x32_bf16 v[224:227], v[52:55], v[100:103], v[224:227]
    s_xor_b32 s65, s65, 8192
    v_mfma_f32_16x16x32_bf16 v[228:231], v[48:51], v[104:107], v[228:231]
    v_mfma_f32_16x16x32_bf16 v[228:231], v[52:55], v[108:111], v[228:231]
    v_mfma_f32_16x16x32_bf16 v[232:235], v[48:51], v[112:115], v[232:235]
    v_mfma_f32_16x16x32_bf16 v[232:235], v[52:55], v[116:119], v[232:235]
    v_mfma_f32_16x16x32_bf16 v[236:239], v[48:51], v[120:123], v[236:239]
    ds_read_b64_tr_b16 v[48:49], v15 offset:0
    ds_read_b64_tr_b16 v[50:51], v15 offset:1024
    v_mfma_f32_16x16x32_bf16 v[236:239], v[52:55], v[124:127], v[236:239]
    s_waitcnt lgkmcnt(2)
    ds_read_b64_tr_b16 v[52:53], v15 offset:8192
    ds_read_b64_tr_b16 v[54:55], v15 offset:9216
    v_mfma_f32_16x16x32_bf16 v[240:243], v[56:59], v[96:99], v[240:243]
    v_mfma_f32_16x16x32_bf16 v[240:243], v[60:63], v[100:103], v[240:243]
    v_mfma_f32_16x16x32_bf16 v[244:247], v[56:59], v[104:107], v[244:247]
    v_mfma_f32_16x16x32_bf16 v[244:247], v[60:63], v[108:111], v[244:247]
    v_mfma_f32_16x16x32_bf16 v[248:251], v[56:59], v[112:115], v[248:251]
    v_mfma_f32_16x16x32_bf16 v[248:251], v[60:63], v[116:119], v[248:251]
    v_mfma_f32_16x16x32_bf16 v[252:255], v[56:59], v[120:123], v[252:255]
    ds_read_b64_tr_b16 v[56:57], v16 offset:0
    ds_read_b64_tr_b16 v[58:59], v16 offset:1024
    v_mfma_f32_16x16x32_bf16 v[252:255], v[60:63], v[124:127], v[252:255]
    buffer_load_dword v7, v8, s[32:35], s61 offen sc1
    v_mfma_f32_16x16x32_bf16 v[128:131], v[40:43], v[64:67], v[128:131]
    ds_read_b64_tr_b16 v[60:61], v16 offset:8192
    ds_read_b64_tr_b16 v[62:63], v16 offset:9216
    v_mfma_f32_16x16x32_bf16 v[128:131], v[44:47], v[68:71], v[128:131]
    v_mfma_f32_16x16x32_bf16 v[132:135], v[40:43], v[72:75], v[132:135]
    v_mfma_f32_16x16x32_bf16 v[132:135], v[44:47], v[76:79], v[132:135]
    v_mfma_f32_16x16x32_bf16 v[136:139], v[40:43], v[80:83], v[136:139]
    v_mfma_f32_16x16x32_bf16 v[136:139], v[44:47], v[84:87], v[136:139]
    v_mfma_f32_16x16x32_bf16 v[140:143], v[40:43], v[88:91], v[140:143]
    ds_read_b64_tr_b16 v[40:41], v17 offset:0
    ds_read_b64_tr_b16 v[42:43], v17 offset:1024
    v_mfma_f32_16x16x32_bf16 v[140:143], v[44:47], v[92:95], v[140:143]
    s_waitcnt lgkmcnt(2)
    ds_read_b64_tr_b16 v[44:45], v17 offset:8192
    ds_read_b64_tr_b16 v[46:47], v17 offset:9216
    v_mfma_f32_16x16x32_bf16 v[144:147], v[48:51], v[64:67], v[144:147]
    v_cvt_pk_bf16_f32 v128, v128, v129
    v_cvt_pk_bf16_f32 v129, v130, v131
    v_mfma_f32_16x16x32_bf16 v[144:147], v[52:55], v[68:71], v[144:147]
    v_cvt_pk_bf16_f32 v132, v132, v133
    v_cvt_pk_bf16_f32 v133, v134, v135
    v_mfma_f32_16x16x32_bf16 v[148:151], v[48:51], v[72:75], v[148:151]
    v_cvt_pk_bf16_f32 v136, v136, v137
    v_cvt_pk_bf16_f32 v137, v138, v139
    v_mfma_f32_16x16x32_bf16 v[148:151], v[52:55], v[76:79], v[148:151]
    v_cvt_pk_bf16_f32 v140, v140, v141
    v_cvt_pk_bf16_f32 v141, v142, v143
    v_mfma_f32_16x16x32_bf16 v[152:155], v[48:51], v[80:83], v[152:155]
    v_cvt_pk_bf16_f32 v130, v144, v145
    v_cvt_pk_bf16_f32 v131, v146, v147
    v_mfma_f32_16x16x32_bf16 v[152:155], v[52:55], v[84:87], v[152:155]
    v_mfma_f32_16x16x32_bf16 v[156:159], v[48:51], v[88:91], v[156:159]
    ds_read_b64_tr_b16 v[48:49], v18 offset:0
    ds_read_b64_tr_b16 v[50:51], v18 offset:1024
    v_mfma_f32_16x16x32_bf16 v[156:159], v[52:55], v[92:95], v[156:159]
    ds_read_b64_tr_b16 v[52:53], v18 offset:8192
    ds_read_b64_tr_b16 v[54:55], v18 offset:9216
    v_mfma_f32_16x16x32_bf16 v[160:163], v[56:59], v[64:67], v[160:163]
    v_cvt_pk_bf16_f32 v134, v148, v149
    v_cvt_pk_bf16_f32 v135, v150, v151
    v_mfma_f32_16x16x32_bf16 v[160:163], v[60:63], v[68:71], v[160:163]
    v_cvt_pk_bf16_f32 v138, v152, v153
    v_cvt_pk_bf16_f32 v139, v154, v155
    v_mfma_f32_16x16x32_bf16 v[164:167], v[56:59], v[72:75], v[164:167]
    v_cvt_pk_bf16_f32 v142, v156, v157
    v_cvt_pk_bf16_f32 v143, v158, v159
    v_mfma_f32_16x16x32_bf16 v[164:167], v[60:63], v[76:79], v[164:167]
    v_mfma_f32_16x16x32_bf16 v[168:171], v[56:59], v[80:83], v[168:171]
    v_mfma_f32_16x16x32_bf16 v[168:171], v[60:63], v[84:87], v[168:171]
    v_cvt_pk_bf16_f32 v160, v160, v161
    v_cvt_pk_bf16_f32 v161, v162, v163
    v_mfma_f32_16x16x32_bf16 v[172:175], v[56:59], v[88:91], v[172:175]
    ds_read_b64_tr_b16 v[56:57], v19 offset:0
    ds_read_b64_tr_b16 v[58:59], v19 offset:1024
    v_mfma_f32_16x16x32_bf16 v[172:175], v[60:63], v[92:95], v[172:175]
    s_waitcnt lgkmcnt(2)
    ds_read_b64_tr_b16 v[60:61], v19 offset:8192
    ds_read_b64_tr_b16 v[62:63], v19 offset:9216
    v_mfma_f32_16x16x32_bf16 v[176:179], v[40:43], v[64:67], v[176:179]
    v_cvt_pk_bf16_f32 v164, v164, v165
    v_cvt_pk_bf16_f32 v165, v166, v167
    v_mfma_f32_16x16x32_bf16 v[176:179], v[44:47], v[68:71], v[176:179]
    v_cvt_pk_bf16_f32 v168, v168, v169
    v_cvt_pk_bf16_f32 v169, v170, v171
    v_mfma_f32_16x16x32_bf16 v[180:183], v[40:43], v[72:75], v[180:183]
    v_cvt_pk_bf16_f32 v172, v172, v173
    v_cvt_pk_bf16_f32 v173, v174, v175
    v_mfma_f32_16x16x32_bf16 v[180:183], v[44:47], v[76:79], v[180:183]
    v_mfma_f32_16x16x32_bf16 v[184:187], v[40:43], v[80:83], v[184:187]
    v_mfma_f32_16x16x32_bf16 v[184:187], v[44:47], v[84:87], v[184:187]
    v_cvt_pk_bf16_f32 v162, v176, v177
    v_cvt_pk_bf16_f32 v163, v178, v179
    v_mfma_f32_16x16x32_bf16 v[188:191], v[40:43], v[88:91], v[188:191]
    ds_read_b64_tr_b16 v[40:41], v20 offset:0
    ds_read_b64_tr_b16 v[42:43], v20 offset:1024
    v_mfma_f32_16x16x32_bf16 v[188:191], v[44:47], v[92:95], v[188:191]
    ds_read_b64_tr_b16 v[44:45], v20 offset:8192
    ds_read_b64_tr_b16 v[46:47], v20 offset:9216
    v_mfma_f32_16x16x32_bf16 v[192:195], v[48:51], v[64:67], v[192:195]
    v_cvt_pk_bf16_f32 v166, v180, v181
    v_cvt_pk_bf16_f32 v167, v182, v183
    v_mfma_f32_16x16x32_bf16 v[192:195], v[52:55], v[68:71], v[192:195]
    v_cvt_pk_bf16_f32 v170, v184, v185
    v_cvt_pk_bf16_f32 v171, v186, v187
    s_waitcnt vmcnt(0)
    v_cmp_gt_u32 vcc, 1, v7
    s_nop 1
    s_and_b64 vcc, vcc, exec
    s_cbranch_scc1 SPIN_KV
BACK_KV:
    v_mfma_f32_16x16x32_bf16 v[196:199], v[48:51], v[72:75], v[196:199]
    s_mov_b32 s77, s75
    buffer_load_dwordx4 a[224:227], v1, s[36:39], 0 offen offset:0 sc1
    v_mfma_f32_16x16x32_bf16 v[196:199], v[52:55], v[76:79], v[196:199]
    buffer_load_dwordx4 a[228:231], v1, s[36:39], 0 offen offset:1024 sc1
    v_mfma_f32_16x16x32_bf16 v[200:203], v[48:51], v[80:83], v[200:203]
    v_cmp_le_i32 vcc, 0, v36
    v_cvt_pk_bf16_f32 v192, v192, v193
    v_mfma_f32_16x16x32_bf16 v[200:203], v[52:55], v[84:87], v[200:203]
    v_cvt_pk_bf16_f32 v193, v194, v195
    v_cvt_pk_bf16_f32 v174, v188, v189
    v_mfma_f32_16x16x32_bf16 v[204:207], v[48:51], v[88:91], v[204:207]
    buffer_load_dwordx4 a[232:235], v1, s[36:39], 0 offen offset:2048 sc1
    v_mfma_f32_16x16x32_bf16 v[204:207], v[52:55], v[92:95], v[204:207]
    s_waitcnt lgkmcnt(0)
    ds_read_b64_tr_b16 v[48:49], v21 offset:0
    ds_read_b64_tr_b16 v[50:51], v21 offset:1024
    v_mfma_f32_16x16x32_bf16 v[208:211], v[56:59], v[64:67], v[208:211]
    ds_read_b64_tr_b16 v[52:53], v21 offset:8192
    ds_read_b64_tr_b16 v[54:55], v21 offset:9216
    v_mfma_f32_16x16x32_bf16 v[208:211], v[60:63], v[68:71], v[208:211]
    v_cvt_pk_bf16_f32 v196, v196, v197
    v_cvt_pk_bf16_f32 v197, v198, v199
    v_mfma_f32_16x16x32_bf16 v[212:215], v[56:59], v[72:75], v[212:215]
    buffer_load_dwordx4 a[236:239], v1, s[36:39], 0 offen offset:3072 sc1
    v_mfma_f32_16x16x32_bf16 v[212:215], v[60:63], v[76:79], v[212:215]
    v_cvt_pk_bf16_f32 v200, v200, v201
    v_cvt_pk_bf16_f32 v201, v202, v203
    v_mfma_f32_16x16x32_bf16 v[216:219], v[56:59], v[80:83], v[216:219]
    v_cvt_pk_bf16_f32 v194, v208, v209
    v_cndmask_b32_e64 v208, v37, 0, vcc
    v_mfma_f32_16x16x32_bf16 v[216:219], v[60:63], v[84:87], v[216:219]
    v_mul_f32 v176, s16, v208
    v_cmp_le_i32 vcc, 1, v36
    v_mfma_f32_16x16x32_bf16 v[220:223], v[56:59], v[88:91], v[220:223]
    v_cvt_pk_bf16_f32 v195, v210, v211
    v_cndmask_b32_e64 v209, v37, 0, vcc
    v_mfma_f32_16x16x32_bf16 v[220:223], v[60:63], v[92:95], v[220:223]
    v_mul_f32 v177, s16, v209
    v_cmp_le_i32 vcc, 2, v36
    v_mfma_f32_16x16x32_bf16 v[224:227], v[40:43], v[64:67], v[224:227]
    s_mov_b32 s38, 16384
    v_cndmask_b32_e64 v210, v37, 0, vcc
    v_mul_f32 v178, s16, v210
    v_mfma_f32_16x16x32_bf16 v[224:227], v[44:47], v[68:71], v[224:227]
    s_add_u32 m0, s76, s75
    v_cmp_le_i32 vcc, 3, v36
    v_cvt_pk_bf16_f32 v198, v212, v213
    v_mfma_f32_16x16x32_bf16 v[228:231], v[40:43], v[72:75], v[228:231]
    buffer_load_dwordx4 v1, s[36:39], s77 offen sc1 lds
    v_mfma_f32_16x16x32_bf16 v[228:231], v[44:47], v[76:79], v[228:231]
    v_cndmask_b32_e64 v211, v37, 0, vcc
    v_mul_f32 v179, s16, v211
    v_mfma_f32_16x16x32_bf16 v[232:235], v[40:43], v[80:83], v[232:235]
    v_cvt_pk_bf16_f32 v224, v224, v225
    v_cvt_pk_bf16_f32 v225, v226, v227
    v_mfma_f32_16x16x32_bf16 v[232:235], v[44:47], v[84:87], v[232:235]
    s_waitcnt vmcnt(6) lgkmcnt(0)
    s_barrier
    ds_read_b64_tr_b16 v[56:57], v26 offset:32768
    v_mfma_f32_16x16x32_bf16 v[236:239], v[40:43], v[88:91], v[236:239]
    buffer_load_dwordx4 v1, s[36:39], s77 offen offset:1024 sc1 lds
    v_mfma_f32_16x16x32_bf16 v[236:239], v[44:47], v[92:95], v[236:239]
    ds_read_b64_tr_b16 v[58:59], v26 offset:33280
    ds_read_b64_tr_b16 v[60:61], v26 offset:36864
    v_mfma_f32_16x16x32_bf16 v[240:243], v[48:51], v[64:67], v[240:243]
    ds_read_b64_tr_b16 v[62:63], v26 offset:37376
    ds_read_b64_tr_b16 v[40:41], v27 offset:32768
    v_mfma_f32_16x16x32_bf16 v[240:243], v[52:55], v[68:71], v[240:243]
    ds_read_b64_tr_b16 v[42:43], v27 offset:33280
    ds_read_b64_tr_b16 v[44:45], v27 offset:36864
    v_mfma_f32_16x16x32_bf16 v[244:247], v[48:51], v[72:75], v[244:247]
    buffer_load_dwordx4 v1, s[36:39], s77 offen offset:2048 sc1 lds
    v_mfma_f32_16x16x32_bf16 v[244:247], v[52:55], v[76:79], v[244:247]
    ds_read_b64_tr_b16 v[46:47], v27 offset:37376
    v_add_u32 v26, 0x10000, v26
    v_mfma_f32_16x16x32_bf16 v[248:251], v[48:51], v[80:83], v[248:251]
    v_add_u32 v27, 0x10000, v27
    v_cvt_pk_bf16_f32 v226, v240, v241
    v_mfma_f32_16x16x32_bf16 v[248:251], v[52:55], v[84:87], v[248:251]
    v_cvt_pk_bf16_f32 v227, v242, v243
    v_cvt_pk_bf16_f32 v228, v228, v229
    v_mfma_f32_16x16x32_bf16 v[252:255], v[48:51], v[88:91], v[252:255]
    buffer_load_dwordx4 v1, s[36:39], s77 offen offset:3072 sc1 lds
    v_mfma_f32_16x16x32_bf16 v[252:255], v[52:55], v[92:95], v[252:255]
    s_waitcnt lgkmcnt(1)
    ds_read_b64_tr_b16 v[48:49], v28 offset:32768
    ds_read_b64_tr_b16 v[50:51], v28 offset:33280
    v_mfma_f32_16x16x32_bf16 a[64:67], v[56:59], v[96:99], a[64:67]
    s_add_u32 s100, s77, 4096
    ds_read_b64_tr_b16 v[52:53], v28 offset:36864
    ds_read_b64_tr_b16 v[54:55], v28 offset:37376
    v_mfma_f32_16x16x32_bf16 a[64:67], v[60:63], v[100:103], a[64:67]
    s_add_u32 m0, m0, 4096
    v_add_u32 v28, 0x10000, v28
    v_cvt_pk_bf16_f32 v229, v230, v231
    v_mfma_f32_16x16x32_bf16 a[68:71], v[56:59], v[104:107], a[68:71]
    buffer_load_dwordx4 v1, s[36:39], s100 offen sc1 lds
    v_mfma_f32_16x16x32_bf16 a[68:71], v[60:63], v[108:111], a[68:71]
    v_cvt_pk_bf16_f32 v230, v244, v245
    v_cvt_pk_bf16_f32 v231, v246, v247
    v_mfma_f32_16x16x32_bf16 a[72:75], v[56:59], v[112:115], a[72:75]
    v_cvt_pk_bf16_f32 v199, v214, v215
    v_cvt_pk_bf16_f32 v232, v232, v233
    v_mfma_f32_16x16x32_bf16 a[72:75], v[60:63], v[116:119], a[72:75]
    v_cvt_pk_bf16_f32 v233, v234, v235
    v_cvt_pk_bf16_f32 v234, v248, v249
    v_mfma_f32_16x16x32_bf16 a[76:79], v[56:59], v[120:123], a[76:79]
    buffer_load_dwordx4 v1, s[36:39], s100 offen offset:1024 sc1 lds
    v_mfma_f32_16x16x32_bf16 a[76:79], v[60:63], v[124:127], a[76:79]
    ds_read_b64_tr_b16 v[56:57], v29 offset:32768
    ds_read_b64_tr_b16 v[58:59], v29 offset:33280
    v_mfma_f32_16x16x32_bf16 a[80:83], v[40:43], v[96:99], a[80:83]
    s_waitcnt lgkmcnt(2)
    ds_read_b64_tr_b16 v[60:61], v29 offset:36864
    ds_read_b64_tr_b16 v[62:63], v29 offset:37376
    v_mfma_f32_16x16x32_bf16 a[80:83], v[44:47], v[100:103], a[80:83]
    v_add_u32 v29, 0x10000, v29
    v_cvt_pk_bf16_f32 v235, v250, v251
    v_mfma_f32_16x16x32_bf16 a[84:87], v[40:43], v[104:107], a[84:87]
    buffer_load_dwordx4 v1, s[36:39], s100 offen offset:2048 sc1 lds
    v_mfma_f32_16x16x32_bf16 a[84:87], v[44:47], v[108:111], a[84:87]
    v_cvt_pk_bf16_f32 v202, v216, v217
    v_cvt_pk_bf16_f32 v203, v218, v219
    v_mfma_f32_16x16x32_bf16 a[88:91], v[40:43], v[112:115], a[88:91]
    v_cvt_pk_bf16_f32 v175, v190, v191
    v_cvt_pk_bf16_f32 v236, v236, v237
    v_mfma_f32_16x16x32_bf16 a[88:91], v[44:47], v[116:119], a[88:91]
    v_cvt_pk_bf16_f32 v237, v238, v239
    v_cvt_pk_bf16_f32 v238, v252, v253
    v_mfma_f32_16x16x32_bf16 a[92:95], v[40:43], v[120:123], a[92:95]
    buffer_load_dwordx4 v1, s[36:39], s100 offen offset:3072 sc1 lds
    v_mfma_f32_16x16x32_bf16 a[92:95], v[44:47], v[124:127], a[92:95]
    s_waitcnt vmcnt(8)
    ds_read_b64_tr_b16 v[40:41], v26 offset:0
    ds_read_b64_tr_b16 v[42:43], v26 offset:512
    v_mfma_f32_16x16x32_bf16 v[240:243], a[224:227], v[128:131], v[176:179]
    s_lshr_b32 s82, s4, 1
    s_add_u32 s82, s82, 32
    ds_read_b64_tr_b16 v[44:45], v26 offset:4096
    v_mfma_f32_16x16x32_bf16 v[240:243], a[228:231], v[160:163], v[240:243]
    s_sub_u32 s82, s82, s6
    ds_read_b64_tr_b16 v[46:47], v26 offset:4608
    v_cvt_pk_bf16_f32 v239, v254, v255
    v_mfma_f32_16x16x32_bf16 v[240:243], a[232:235], v[192:195], v[240:243]
    s_add_u32 s76, s76, 32768
    s_sub_u32 s82, s82, s6
    v_cvt_pk_bf16_f32 v204, v204, v205
    v_mfma_f32_16x16x32_bf16 v[240:243], a[236:239], v[224:227], v[240:243]
    s_add_u32 s77, s77, 32768
    s_lshl_b32 s38, s82, 15
    s_add_u32 m0, s76, s75
    v_mfma_f32_16x16x32_bf16 v[244:247], a[224:227], v[132:135], 0
    s_mov_b32 s82, 0
    buffer_load_dwordx4 v1, s[36:39], s77 offen sc1 lds
    v_mfma_f32_16x16x32_bf16 v[244:247], a[228:231], v[164:167], v[244:247]
    v_cvt_pk_bf16_f32 v205, v206, v207
    v_max3_f32 v147, v240, v241, v242
    v_mfma_f32_16x16x32_bf16 v[244:247], a[232:235], v[196:199], v[244:247]
    buffer_load_dwordx4 v1, s[36:39], s77 offen offset:1024 sc1 lds
    v_mfma_f32_16x16x32_bf16 v[244:247], a[236:239], v[228:231], v[244:247]
    v_max_f32 v147, v147, v243
    v_mov_b32 v146, v147
    v_mfma_f32_16x16x32_bf16 v[248:251], a[224:227], v[136:139], 0
    v_cvt_pk_bf16_f32 v206, v220, v221
    v_permlane32_swap_b32 v147, v146
    v_mfma_f32_16x16x32_bf16 v[248:251], a[228:231], v[168:171], v[248:251]
    v_max_f32 v147, v147, v146
    v_mov_b32 v146, v147
    v_mfma_f32_16x16x32_bf16 v[248:251], a[232:235], v[200:203], v[248:251]
    buffer_load_dwordx4 v1, s[36:39], s77 offen offset:2048 sc1 lds
    v_mfma_f32_16x16x32_bf16 v[248:251], a[236:239], v[232:235], v[248:251]
    v_max3_f32 v151, v244, v245, v246
    v_max_f32 v151, v151, v247
    v_mfma_f32_16x16x32_bf16 v[252:255], a[224:227], v[140:143], 0
    v_mov_b32 v150, v151
    v_permlane16_swap_b32 v147, v146
    v_mfma_f32_16x16x32_bf16 v[252:255], a[228:231], v[172:175], v[252:255]
    v_permlane32_swap_b32 v151, v150
    v_max_f32 v151, v151, v150
    v_cvt_pk_bf16_f32 v207, v222, v223
    s_nop 1
    v_mfma_f32_16x16x32_bf16 v[252:255], a[232:235], v[204:207], v[252:255]
    buffer_load_dwordx4 v1, s[36:39], s77 offen offset:3072 sc1 lds
    v_mfma_f32_16x16x32_bf16 v[252:255], a[236:239], v[236:239], v[252:255]
    v_max3_f32 v155, v248, v249, v250
    v_max_f32 v155, v155, v251
    v_mfma_f32_16x16x32_bf16 a[96:99], v[48:51], v[96:99], a[96:99]
    s_add_u32 s100, s77, 4096
    v_mov_b32 v154, v155
    v_mov_b32 v150, v151
    v_mfma_f32_16x16x32_bf16 a[96:99], v[52:55], v[100:103], a[96:99]
    s_add_u32 m0, m0, 4096
    v_max3_f32 v159, v252, v253, v254
    v_max_f32 v159, v159, v255
    v_mfma_f32_16x16x32_bf16 a[100:103], v[48:51], v[104:107], a[100:103]
    buffer_load_dwordx4 v1, s[36:39], s100 offen sc1 lds
    v_mfma_f32_16x16x32_bf16 a[100:103], v[52:55], v[108:111], a[100:103]
    v_mov_b32 v158, v159
    v_permlane32_swap_b32 v155, v154
    v_mfma_f32_16x16x32_bf16 a[104:107], v[48:51], v[112:115], a[104:107]
    v_permlane32_swap_b32 v159, v158
    v_max_f32 v155, v155, v154
    v_mfma_f32_16x16x32_bf16 a[104:107], v[52:55], v[116:119], a[104:107]
    v_max_f32 v159, v159, v158
    v_mov_b32 v154, v155
    v_mfma_f32_16x16x32_bf16 a[108:111], v[48:51], v[120:123], a[108:111]
    buffer_load_dwordx4 v1, s[36:39], s100 offen offset:1024 sc1 lds
    v_mfma_f32_16x16x32_bf16 a[108:111], v[52:55], v[124:127], a[108:111]
    s_waitcnt lgkmcnt(0)
    ds_read_b64_tr_b16 v[48:49], v27 offset:0
    ds_read_b64_tr_b16 v[50:51], v27 offset:512
    v_mfma_f32_16x16x32_bf16 a[112:115], v[56:59], v[96:99], a[112:115]
    ds_read_b64_tr_b16 v[52:53], v27 offset:4096
    ds_read_b64_tr_b16 v[54:55], v27 offset:4608
    v_mfma_f32_16x16x32_bf16 a[112:115], v[60:63], v[100:103], a[112:115]
    v_mov_b32 v158, v159
    v_permlane16_swap_b32 v151, v150
    v_mfma_f32_16x16x32_bf16 a[116:119], v[56:59], v[104:107], a[116:119]
    buffer_load_dwordx4 v1, s[36:39], s100 offen offset:2048 sc1 lds
    v_mfma_f32_16x16x32_bf16 a[116:119], v[60:63], v[108:111], a[116:119]
    v_permlane16_swap_b32 v155, v154
    v_permlane16_swap_b32 v159, v158
    v_mfma_f32_16x16x32_bf16 a[120:123], v[56:59], v[112:115], a[120:123]
    v_max_f32 v147, v147, v146
    v_max_f32 v151, v151, v150
    v_mfma_f32_16x16x32_bf16 a[120:123], v[60:63], v[116:119], a[120:123]
    v_max_f32 v155, v155, v154
    v_max_f32 v159, v159, v158
    v_mfma_f32_16x16x32_bf16 a[124:127], v[56:59], v[120:123], a[124:127]
    buffer_load_dwordx4 v1, s[36:39], s100 offen offset:3072 sc1 lds
    v_mfma_f32_16x16x32_bf16 a[124:127], v[60:63], v[124:127], a[124:127]
    ds_read_b64_tr_b16 v[56:57], v28 offset:0
    ds_read_b64_tr_b16 v[58:59], v28 offset:512
    v_mfma_f32_16x16x32_bf16 a[64:67], v[40:43], v[64:67], a[64:67]
    s_add_u32 s76, s76, 32768
    ds_read_b64_tr_b16 v[60:61], v28 offset:4096
    ds_read_b64_tr_b16 v[62:63], v28 offset:4608
    v_mfma_f32_16x16x32_bf16 a[64:67], v[44:47], v[68:71], a[64:67]
    s_add_u32 s77, s77, 32768
    v_sub_f32 v144, 0, v147
    v_sub_f32 v148, 0, v151
    v_mfma_f32_16x16x32_bf16 a[68:71], v[40:43], v[72:75], a[68:71]
    s_add_u32 m0, s76, s75
    v_sub_f32 v152, 0, v155
    v_sub_f32 v156, 0, v159
    v_mfma_f32_16x16x32_bf16 a[68:71], v[44:47], v[76:79], a[68:71]
    buffer_load_dwordx4 v1, s[36:39], s77 offen sc1 lds
    v_mfma_f32_16x16x32_bf16 a[72:75], v[40:43], v[80:83], a[72:75]
    v_sub_f32 v145, 0, v147
    v_sub_f32 v146, 0, v147
    v_mfma_f32_16x16x32_bf16 a[72:75], v[44:47], v[84:87], a[72:75]
    v_sub_f32 v147, 0, v147
    v_sub_f32 v149, 0, v151
    v_mfma_f32_16x16x32_bf16 a[76:79], v[40:43], v[88:91], a[76:79]
    buffer_load_dwordx4 v1, s[36:39], s77 offen offset:1024 sc1 lds
    v_mfma_f32_16x16x32_bf16 a[76:79], v[44:47], v[92:95], a[76:79]
    s_waitcnt lgkmcnt(0)
    ds_read_b64_tr_b16 v[40:41], v29 offset:0
    ds_read_b64_tr_b16 v[42:43], v29 offset:512
    v_mfma_f32_16x16x32_bf16 a[80:83], v[48:51], v[64:67], a[80:83]
    ds_read_b64_tr_b16 v[44:45], v29 offset:4096
    ds_read_b64_tr_b16 v[46:47], v29 offset:4608
    v_mfma_f32_16x16x32_bf16 a[80:83], v[52:55], v[68:71], a[80:83]
    v_sub_f32 v150, 0, v151
    v_sub_f32 v151, 0, v151
    v_mfma_f32_16x16x32_bf16 a[84:87], v[48:51], v[72:75], a[84:87]
    buffer_load_dwordx4 v1, s[36:39], s77 offen offset:2048 sc1 lds
    v_mfma_f32_16x16x32_bf16 a[84:87], v[52:55], v[76:79], a[84:87]
    v_sub_f32 v153, 0, v155
    v_sub_f32 v154, 0, v155
    v_mfma_f32_16x16x32_bf16 a[88:91], v[48:51], v[80:83], a[88:91]
    v_sub_f32 v155, 0, v155
    v_sub_f32 v157, 0, v159
    v_mfma_f32_16x16x32_bf16 a[88:91], v[52:55], v[84:87], a[88:91]
    v_sub_f32 v158, 0, v159
    v_sub_f32 v159, 0, v159
    v_mfma_f32_16x16x32_bf16 a[92:95], v[48:51], v[88:91], a[92:95]
    buffer_load_dwordx4 v1, s[36:39], s77 offen offset:3072 sc1 lds
    v_mfma_f32_16x16x32_bf16 a[92:95], v[52:55], v[92:95], a[92:95]
    v_or_b32 v215, 0x44444444, v38
    v_bfe_u32 v38, v1, 5, 1
    v_mfma_f32_16x16x32_bf16 a[96:99], v[56:59], v[64:67], a[96:99]
    s_add_u32 s100, s77, 4096
    v_cmp_eq_u32 vcc, 0, v38
    v_mov_b32 v38, 0x3f803f80
    v_mfma_f32_16x16x32_bf16 a[96:99], v[60:63], v[68:71], a[96:99]
    s_add_u32 m0, m0, 4096
    v_and_b32 v29, 0x380, v1
    v_cndmask_b32 v38, 0, v38, vcc
    v_mfma_f32_16x16x32_bf16 a[100:103], v[56:59], v[72:75], a[100:103]
    buffer_load_dwordx4 v1, s[36:39], s100 offen sc1 lds
    v_mfma_f32_16x16x32_bf16 a[100:103], v[60:63], v[76:79], a[100:103]
    v_add_f32 v240, v240, v144
    v_add_f32 v241, v241, v144
    v_mfma_f32_16x16x32_bf16 a[104:107], v[56:59], v[80:83], a[104:107]
    v_add_f32 v242, v242, v144
    v_add_f32 v243, v243, v144
    v_mfma_f32_16x16x32_bf16 a[104:107], v[60:63], v[84:87], a[104:107]
    s_waitcnt vmcnt(13) lgkmcnt(0)
    s_barrier
    ds_read_b128 a[240:243], v2 offset:4096
    v_mfma_f32_16x16x32_bf16 a[108:111], v[56:59], v[88:91], a[108:111]
    ds_read_b128 a[244:247], v2 offset:5120
    ds_read_b128 a[248:251], v2 offset:6144
    v_mfma_f32_16x16x32_bf16 a[108:111], v[60:63], v[92:95], a[108:111]
    buffer_load_dwordx4 v1, s[36:39], s100 offen offset:1024 sc1 lds
    v_mfma_f32_16x16x32_bf16 a[112:115], v[40:43], v[64:67], a[112:115]
    ds_read_b128 a[252:255], v2 offset:7168
    v_add_f32 v244, v244, v148
    v_mfma_f32_16x16x32_bf16 a[112:115], v[44:47], v[68:71], a[112:115]
    v_add_f32 v245, v245, v148
    v_add_f32 v246, v246, v148
    v_mfma_f32_16x16x32_bf16 a[116:119], v[40:43], v[72:75], a[116:119]
    buffer_load_dwordx4 v1, s[36:39], s100 offen offset:2048 sc1 lds
    v_mfma_f32_16x16x32_bf16 a[116:119], v[44:47], v[76:79], a[116:119]
    v_add_f32 v247, v247, v148
    v_add_f32 v248, v248, v152
    v_mfma_f32_16x16x32_bf16 a[120:123], v[40:43], v[80:83], a[120:123]
    v_add_f32 v249, v249, v152
    v_add_f32 v250, v250, v152
    v_mfma_f32_16x16x32_bf16 a[120:123], v[44:47], v[84:87], a[120:123]
    v_add_f32 v251, v251, v152
    v_add_f32 v252, v252, v156
    v_mfma_f32_16x16x32_bf16 a[124:127], v[40:43], v[88:91], a[124:127]
    buffer_load_dwordx4 v1, s[36:39], s100 offen offset:3072 sc1 lds
    v_mfma_f32_16x16x32_bf16 a[124:127], v[44:47], v[92:95], a[124:127]
    v_add_f32 v253, v253, v156
    v_add_f32 v254, v254, v156
    v_add_f32 v255, v255, v156
    v_lshl_add_u32 v29, v29, 4, v39
    v_bfe_u32 v39, v1, 2, 4
    v_accvgpr_write_b32 a136, v38
    v_accvgpr_write_b32 a137, v38
    v_accvgpr_write_b32 a138, v38
    v_accvgpr_write_b32 a139, v38
    v_exp_f32 v240, v240
    v_exp_f32 v241, v241
    v_exp_f32 v242, v242
    v_exp_f32 v243, v243
    v_exp_f32 v244, v244
    v_exp_f32 v245, v245
    v_exp_f32 v246, v246
    v_exp_f32 v247, v247
    v_exp_f32 v248, v248
    v_exp_f32 v249, v249
    v_exp_f32 v250, v250
    v_exp_f32 v251, v251
    v_exp_f32 v252, v252
    v_exp_f32 v253, v253
    v_exp_f32 v254, v254
    v_exp_f32 v255, v255
    buffer_store_dwordx4 a[68:71], v1, s[40:43], s84 offen offset:2048 sc1
    buffer_store_dwordx4 a[76:79], v1, s[40:43], s85 offen offset:2048 sc1
    buffer_store_dwordx4 a[84:87], v1, s[40:43], s84 offen offset:1024 sc1
    buffer_store_dwordx4 a[92:95], v1, s[40:43], s85 offen offset:1024 sc1
    buffer_store_dwordx4 a[100:103], v1, s[40:43], s84 offen offset:0 sc1
    buffer_store_dwordx4 a[108:111], v1, s[40:43], s85 offen offset:0 sc1
    v_lshl_add_u32 v29, v29, 1, v39
    s_add_u32 s77, s77, 32768
    s_add_u32 s76, s76, 32768
K1_ATT:
    v_cvt_pk_bf16_f32 v32, v240, v241
    v_cvt_pk_bf16_f32 v33, v242, v243
    v_add_f32 v213, s21, v144
    v_fma_f32 v180, v208, s17, v213
    v_fma_f32 v181, v209, s17, v213
    v_fma_f32 v182, v210, s17, v213
    v_fma_f32 v183, v211, s17, v213
    s_nop 1
    s_waitcnt lgkmcnt(0)
    v_mfma_f32_16x16x32_bf16 v[240:243], a[240:243], v[128:131], v[180:183]
    s_mov_b32 s99, s76
    v_cvt_pk_bf16_f32 v40, v244, v245
    v_cvt_pk_bf16_f32 v41, v246, v247
    v_mfma_f32_16x16x32_bf16 v[240:243], a[244:247], v[160:163], v[240:243]
    s_sub_u32 s7, 15, s6
    v_cvt_pk_bf16_f32 v48, v248, v249
    v_cvt_pk_bf16_f32 v49, v250, v251
    v_mfma_f32_16x16x32_bf16 v[240:243], a[248:251], v[192:195], v[240:243]
    s_lshl3_add_u32 s80, s6, s4
    ds_read_b128 a[224:227], v2 offset:8192
    ds_read_b128 a[228:231], v2 offset:9216
    v_mfma_f32_16x16x32_bf16 v[240:243], a[252:255], v[224:227], v[240:243]
    s_lshl3_add_u32 s81, s7, s4
    ds_read_b128 a[232:235], v2 offset:10240
    v_cvt_pk_bf16_f32 v56, v252, v253
    v_mfma_f32_16x16x32_bf16 v[244:247], a[240:243], v[132:135], v[148:151]
    s_add_u32 m0, s76, s75
    ds_read_b128 a[236:239], v2 offset:11264
    v_cvt_pk_bf16_f32 v57, v254, v255
    v_mfma_f32_16x16x32_bf16 v[244:247], a[244:247], v[164:167], v[244:247]
    s_mov_b32 s76, s60
    buffer_load_dwordx4 v1, s[36:39], s77 offen sc1 lds
    v_mfma_f32_16x16x32_bf16 v[244:247], a[248:251], v[196:199], v[244:247]
    s_mov_b32 s60, s82
    v_exp_f32 v240, v240
    v_mfma_f32_16x16x32_bf16 v[244:247], a[252:255], v[228:231], v[244:247]
    s_mov_b32 s82, s95
    buffer_load_dwordx4 v1, s[36:39], s77 offen offset:1024 sc1 lds
    v_mfma_f32_16x16x32_bf16 v[248:251], a[240:243], v[136:139], v[152:155]
    s_mov_b32 s95, s93
    v_exp_f32 v241, v241
    v_mfma_f32_16x16x32_bf16 v[248:251], a[244:247], v[168:171], v[248:251]
    s_mov_b32 s93, s99
    v_exp_f32 v242, v242
    v_mfma_f32_16x16x32_bf16 v[248:251], a[248:251], v[200:203], v[248:251]
    s_mul_i32 s80, s80, 155648
    buffer_load_dwordx4 v1, s[36:39], s77 offen offset:2048 sc1 lds
    v_mfma_f32_16x16x32_bf16 v[248:251], a[252:255], v[232:235], v[248:251]
    s_mul_i32 s81, s81, 155648
    v_exp_f32 v243, v243
    v_mfma_f32_16x16x32_bf16 v[252:255], a[240:243], v[140:143], v[156:159]
    s_lshl_b32 s7, s5, 12
    v_cvt_pk_bf16_f32 v34, v240, v241
    v_cvt_pk_bf16_f32 v35, v242, v243
    v_mfma_f32_16x16x32_bf16 v[252:255], a[244:247], v[172:175], v[252:255]
    s_add_u32 s80, s80, s7
    buffer_load_dwordx4 v1, s[36:39], s77 offen offset:3072 sc1 lds
    v_mfma_f32_16x16x32_bf16 v[252:255], a[248:251], v[204:207], v[252:255]
    s_add_u32 s81, s81, s7
    v_exp_f32 v244, v244
    v_mfma_f32_16x16x32_bf16 v[252:255], a[252:255], v[236:239], v[252:255]
    s_add_u32 s100, s77, 4096
    v_exp_f32 v245, v245
    v_add_f32 v212, s20, v144
    v_fma_f32 v176, v208, s16, v212
    v_fma_f32 v177, v209, s16, v212
    v_fma_f32 v178, v210, s16, v212
    v_fma_f32 v179, v211, s16, v212
    v_add_f32 v212, s22, v144
    v_fma_f32 v184, v208, s18, v212
    v_fma_f32 v185, v209, s18, v212
    v_fma_f32 v186, v210, s18, v212
    v_fma_f32 v187, v211, s18, v212
    s_nop 1
    s_waitcnt lgkmcnt(0)
    v_mfma_f32_16x16x32_bf16 v[240:243], a[224:227], v[128:131], v[184:187]
    s_add_u32 m0, m0, 4096
    v_exp_f32 v246, v246
    v_mfma_f32_16x16x32_bf16 v[240:243], a[228:231], v[160:163], v[240:243]
    s_lshr_b32 s7, s5, 3
    v_exp_f32 v247, v247
    v_mfma_f32_16x16x32_bf16 v[240:243], a[232:235], v[192:195], v[240:243]
    s_lshl2_add_u32 s7, s7, s4
    buffer_load_dwordx4 v1, s[36:39], s100 offen sc1 lds
    v_mfma_f32_16x16x32_bf16 v[240:243], a[236:239], v[224:227], v[240:243]
    s_lshl_b32 s7, s7, 8
    v_cvt_pk_bf16_f32 v42, v244, v245
    v_cvt_pk_bf16_f32 v43, v246, v247
    v_mfma_f32_16x16x32_bf16 v[244:247], a[224:227], v[132:135], v[148:151]
    s_mov_b64 s[84:85], 0
    v_exp_f32 v248, v248
    v_mfma_f32_16x16x32_bf16 v[244:247], a[228:231], v[164:167], v[244:247]
    s_add_u32 s92, s7, 163840
    buffer_load_dwordx4 v1, s[36:39], s100 offen offset:1024 sc1 lds
    v_mfma_f32_16x16x32_bf16 v[244:247], a[232:235], v[196:199], v[244:247]
    s_mov_b64 s[24:25], s[0:1]
    v_exp_f32 v249, v249
    v_mfma_f32_16x16x32_bf16 v[244:247], a[236:239], v[228:231], v[244:247]
    s_mov_b32 s78, s6
    v_exp_f32 v250, v250
    v_exp_f32 v251, v251
    v_cvt_pk_bf16_f32 v50, v248, v249
    v_cvt_pk_bf16_f32 v51, v250, v251
    v_mfma_f32_16x16x32_bf16 v[248:251], a[224:227], v[136:139], v[152:155]
    s_mov_b32 s26, 2359296
    ds_read_b128 a[240:243], v2 offset:12288
    ds_read_b128 a[244:247], v2 offset:13312
    v_mfma_f32_16x16x32_bf16 v[248:251], a[228:231], v[168:171], v[248:251]
    s_mov_b32 s27, 0x20000
    buffer_load_dwordx4 v1, s[36:39], s100 offen offset:2048 sc1 lds
    v_mfma_f32_16x16x32_bf16 v[248:251], a[232:235], v[200:203], v[248:251]
    s_add_u32 s77, s77, 32768
    ds_read_b128 a[248:251], v2 offset:14336
    ds_read_b128 a[252:255], v2 offset:15360
    v_mfma_f32_16x16x32_bf16 v[248:251], a[236:239], v[232:235], v[248:251]
    v_exp_f32 v252, v252
    v_exp_f32 v253, v253
    v_exp_f32 v254, v254
    v_exp_f32 v255, v255
    v_cvt_pk_bf16_f32 v58, v252, v253
    v_cvt_pk_bf16_f32 v59, v254, v255
    v_mfma_f32_16x16x32_bf16 v[252:255], a[224:227], v[140:143], v[156:159]
    v_add_f32 v213, s23, v144
    v_fma_f32 v188, v208, s19, v213
    v_mfma_f32_16x16x32_bf16 v[252:255], a[228:231], v[172:175], v[252:255]
    buffer_load_dwordx4 v1, s[36:39], s100 offen offset:3072 sc1 lds
    v_mfma_f32_16x16x32_bf16 v[252:255], a[232:235], v[204:207], v[252:255]
    v_exp_f32 v240, v240
    v_mfma_f32_16x16x32_bf16 v[252:255], a[236:239], v[236:239], v[252:255]
    s_waitcnt lgkmcnt(0)
    v_exp_f32 v241, v241
    v_exp_f32 v242, v242
    v_exp_f32 v243, v243
    v_fma_f32 v189, v209, s19, v213
    v_fma_f32 v190, v210, s19, v213
    v_fma_f32 v191, v211, s19, v213
    v_cvt_pk_bf16_f32 v36, v240, v241
    v_cvt_pk_bf16_f32 v37, v242, v243
    v_mfma_f32_16x16x32_bf16 v[240:243], a[240:243], v[128:131], v[188:191]
    v_exp_f32 v244, v244
    v_mfma_f32_16x16x32_bf16 v[240:243], a[244:247], v[160:163], v[240:243]
    v_exp_f32 v245, v245
    v_mfma_f32_16x16x32_bf16 v[240:243], a[248:251], v[192:195], v[240:243]
    s_waitcnt vmcnt(8) lgkmcnt(0)
    v_exp_f32 v246, v246
    v_mfma_f32_16x16x32_bf16 v[240:243], a[252:255], v[224:227], v[240:243]
    s_barrier
    v_exp_f32 v247, v247
    v_cvt_pk_bf16_f32 v44, v244, v245
    v_cvt_pk_bf16_f32 v45, v246, v247
    v_mfma_f32_16x16x32_bf16 v[244:247], a[240:243], v[132:135], v[148:151]
    v_add_u32 v2, s82, v1
    ds_read_b128 a[224:227], v2 offset:0
    v_mfma_f32_16x16x32_bf16 v[244:247], a[244:247], v[164:167], v[244:247]
    ds_read_b128 a[228:231], v2 offset:1024
    ds_read_b128 a[232:235], v2 offset:2048
    v_mfma_f32_16x16x32_bf16 v[244:247], a[248:251], v[196:199], v[244:247]
    v_exp_f32 v248, v248
    v_mfma_f32_16x16x32_bf16 v[244:247], a[252:255], v[228:231], v[244:247]
    v_exp_f32 v249, v249
    v_exp_f32 v250, v250
    v_exp_f32 v251, v251
    v_cvt_pk_bf16_f32 v52, v248, v249
    v_cvt_pk_bf16_f32 v53, v250, v251
    v_mfma_f32_16x16x32_bf16 v[248:251], a[240:243], v[136:139], v[152:155]
    ds_read_b128 a[236:239], v2 offset:3072
    ds_read_b128 v[96:99], v2 offset:16384
    v_mfma_f32_16x16x32_bf16 v[248:251], a[244:247], v[168:171], v[248:251]
    v_exp_f32 v252, v252
    v_mfma_f32_16x16x32_bf16 v[248:251], a[248:251], v[200:203], v[248:251]
    v_exp_f32 v253, v253
    v_mfma_f32_16x16x32_bf16 v[248:251], a[252:255], v[232:235], v[248:251]
    v_exp_f32 v254, v254
    v_exp_f32 v255, v255
    v_cvt_pk_bf16_f32 v60, v252, v253
    v_cvt_pk_bf16_f32 v61, v254, v255
    v_mfma_f32_16x16x32_bf16 v[252:255], a[240:243], v[140:143], v[156:159]
    ds_read_b128 v[100:103], v2 offset:17408
    v_mfma_f32_16x16x32_bf16 v[252:255], a[244:247], v[172:175], v[252:255]
    v_exp_f32 v240, v240
    v_mfma_f32_16x16x32_bf16 v[252:255], a[248:251], v[204:207], v[252:255]
    v_exp_f32 v241, v241
    v_mfma_f32_16x16x32_bf16 v[252:255], a[252:255], v[236:239], v[252:255]
    v_exp_f32 v242, v242
    v_exp_f32 v243, v243
    v_exp_f32 v244, v244
    v_exp_f32 v245, v245
    v_exp_f32 v246, v246
    v_exp_f32 v247, v247
    v_exp_f32 v248, v248
    v_exp_f32 v249, v249
    v_exp_f32 v250, v250
    v_exp_f32 v251, v251
    v_cvt_pk_bf16_f32 v38, v240, v241
    v_cvt_pk_bf16_f32 v39, v242, v243
    v_cvt_pk_bf16_f32 v46, v244, v245
    v_cvt_pk_bf16_f32 v47, v246, v247
    v_cvt_pk_bf16_f32 v54, v248, v249
    v_cvt_pk_bf16_f32 v55, v250, v251
    v_exp_f32 v252, v252
    v_mov_b32 v28, 2
    s_cmp_eq_u32 s4, 3
    s_cselect_b32 s7, s101, 1073741824
    v_lshlrev_b32 v31, 20, v1
    buffer_store_dword v28, v31, s[32:35], s7 offen sc1
    s_cmp_eq_u32 s78, 0
    s_cbranch_scc1 K1_LB_END
.p2align 3
K1_LB:
    s_waitcnt lgkmcnt(0)
    v_mfma_f32_16x16x32_bf16 v[240:243], a[224:227], v[128:131], v[176:179]
    s_mov_b32 s99, s76
    v_exp_f32 v253, v253
    v_mfma_f32_16x16x32_bf16 v[240:243], a[228:231], v[160:163], v[240:243]
    v_exp_f32 v254, v254
    v_mfma_f32_16x16x32_bf16 v[240:243], a[232:235], v[192:195], v[240:243]
    v_exp_f32 v255, v255
    v_mfma_f32_16x16x32_bf16 v[240:243], a[236:239], v[224:227], v[240:243]
    v_cvt_pk_bf16_f32 v62, v252, v253
    v_cvt_pk_bf16_f32 v63, v254, v255
    v_mfma_f32_16x16x32_bf16 a[0:3], v[96:99], v[32:35], a[0:3]
    s_add_u32 m0, s76, s75
    v_mfma_f32_16x16x32_bf16 a[0:3], v[100:103], v[36:39], a[0:3]
    s_mov_b32 s76, s60
    buffer_load_dwordx4 v1, s[36:39], s77 offen sc1 lds
    v_mfma_f32_16x16x32_bf16 a[4:7], v[96:99], v[40:43], a[4:7]
    s_mov_b32 s60, s82
    ds_read_b128 v[104:107], v2 offset:18432
    ds_read_b128 v[108:111], v2 offset:19456
    v_mfma_f32_16x16x32_bf16 a[4:7], v[100:103], v[44:47], a[4:7]
    s_mov_b32 s82, s95
    v_exp_f32 v240, v240
    v_mfma_f32_16x16x32_bf16 v[244:247], a[224:227], v[132:135], v[148:151]
    s_mov_b32 s95, s93
    v_exp_f32 v241, v241
    v_mfma_f32_16x16x32_bf16 v[244:247], a[228:231], v[164:167], v[244:247]
    s_mov_b32 s93, s99
    v_exp_f32 v242, v242
    v_mfma_f32_16x16x32_bf16 v[244:247], a[232:235], v[196:199], v[244:247]
    v_exp_f32 v243, v243
    v_mfma_f32_16x16x32_bf16 v[244:247], a[236:239], v[228:231], v[244:247]
    v_cvt_pk_bf16_f32 v64, v240, v241
    v_cvt_pk_bf16_f32 v65, v242, v243
    v_mfma_f32_16x16x32_bf16 a[8:11], v[96:99], v[48:51], a[8:11]
    v_mfma_f32_16x16x32_bf16 a[8:11], v[100:103], v[52:55], a[8:11]
    v_mfma_f32_16x16x32_bf16 a[12:15], v[96:99], v[56:59], a[12:15]
    v_mfma_f32_16x16x32_bf16 a[12:15], v[100:103], v[60:63], a[12:15]
    v_mfma_f32_16x16x32_bf16 v[248:251], a[224:227], v[136:139], v[152:155]
    v_mfma_f32_16x16x32_bf16 v[248:251], a[228:231], v[168:171], v[248:251]
    ds_read_b128 a[240:243], v2 offset:4096
    ds_read_b128 a[244:247], v2 offset:5120
    v_mfma_f32_16x16x32_bf16 v[248:251], a[232:235], v[200:203], v[248:251]
    buffer_load_dwordx4 v1, s[36:39], s77 offen offset:1024 sc1 lds
    v_mfma_f32_16x16x32_bf16 v[248:251], a[236:239], v[232:235], v[248:251]
    s_waitcnt lgkmcnt(2)
    ds_read_b128 a[248:251], v2 offset:6144
    ds_read_b128 a[252:255], v2 offset:7168
    v_mfma_f32_16x16x32_bf16 a[16:19], v[104:107], v[32:35], a[16:19]
    v_exp_f32 v244, v244
    v_mfma_f32_16x16x32_bf16 a[16:19], v[108:111], v[36:39], a[16:19]
    ds_read_b128 v[112:115], v2 offset:20480
    ds_read_b128 v[116:119], v2 offset:21504
    v_mfma_f32_16x16x32_bf16 a[20:23], v[104:107], v[40:43], a[20:23]
    v_exp_f32 v245, v245
    v_mfma_f32_16x16x32_bf16 a[20:23], v[108:111], v[44:47], a[20:23]
    v_exp_f32 v246, v246
    v_mfma_f32_16x16x32_bf16 v[252:255], a[224:227], v[140:143], v[156:159]
    v_exp_f32 v247, v247
    v_mfma_f32_16x16x32_bf16 v[252:255], a[228:231], v[172:175], v[252:255]
    v_cvt_pk_bf16_f32 v72, v244, v245
    v_cvt_pk_bf16_f32 v73, v246, v247
    v_mfma_f32_16x16x32_bf16 v[252:255], a[232:235], v[204:207], v[252:255]
    v_exp_f32 v248, v248
    v_mfma_f32_16x16x32_bf16 v[252:255], a[236:239], v[236:239], v[252:255]
    v_exp_f32 v249, v249
    v_mfma_f32_16x16x32_bf16 a[24:27], v[104:107], v[48:51], a[24:27]
    v_exp_f32 v250, v250
    v_mfma_f32_16x16x32_bf16 a[24:27], v[108:111], v[52:55], a[24:27]
    v_exp_f32 v251, v251
    v_mfma_f32_16x16x32_bf16 a[28:31], v[104:107], v[56:59], a[28:31]
    v_cvt_pk_bf16_f32 v80, v248, v249
    v_cvt_pk_bf16_f32 v81, v250, v251
    v_mfma_f32_16x16x32_bf16 a[28:31], v[108:111], v[60:63], a[28:31]
    s_waitcnt lgkmcnt(0)
    buffer_load_dwordx4 v1, s[36:39], s77 offen offset:2048 sc1 lds
    v_mfma_f32_16x16x32_bf16 v[240:243], a[240:243], v[128:131], v[180:183]
    v_exp_f32 v252, v252
    v_mfma_f32_16x16x32_bf16 v[240:243], a[244:247], v[160:163], v[240:243]
    v_exp_f32 v253, v253
    v_mfma_f32_16x16x32_bf16 v[240:243], a[248:251], v[192:195], v[240:243]
    v_exp_f32 v254, v254
    v_mfma_f32_16x16x32_bf16 v[240:243], a[252:255], v[224:227], v[240:243]
    v_exp_f32 v255, v255
    v_mfma_f32_16x16x32_bf16 a[32:35], v[112:115], v[32:35], a[32:35]
    v_cvt_pk_bf16_f32 v88, v252, v253
    v_cvt_pk_bf16_f32 v89, v254, v255
    v_mfma_f32_16x16x32_bf16 a[32:35], v[116:119], v[36:39], a[32:35]
    ds_read_b128 v[120:123], v2 offset:22528
    ds_read_b128 v[124:127], v2 offset:23552
    v_mfma_f32_16x16x32_bf16 a[36:39], v[112:115], v[40:43], a[36:39]
    v_exp_f32 v240, v240
    v_mfma_f32_16x16x32_bf16 a[36:39], v[116:119], v[44:47], a[36:39]
    v_exp_f32 v241, v241
    v_mfma_f32_16x16x32_bf16 v[244:247], a[240:243], v[132:135], v[148:151]
    v_exp_f32 v242, v242
    v_mfma_f32_16x16x32_bf16 v[244:247], a[244:247], v[164:167], v[244:247]
    v_exp_f32 v243, v243
    v_mfma_f32_16x16x32_bf16 v[244:247], a[248:251], v[196:199], v[244:247]
    v_cvt_pk_bf16_f32 v66, v240, v241
    v_cvt_pk_bf16_f32 v67, v242, v243
    v_mfma_f32_16x16x32_bf16 v[244:247], a[252:255], v[228:231], v[244:247]
    v_mfma_f32_16x16x32_bf16 a[40:43], v[112:115], v[48:51], a[40:43]
    buffer_load_dwordx4 v1, s[36:39], s77 offen offset:3072 sc1 lds
    v_mfma_f32_16x16x32_bf16 a[40:43], v[116:119], v[52:55], a[40:43]
    v_mfma_f32_16x16x32_bf16 a[44:47], v[112:115], v[56:59], a[44:47]
    v_mfma_f32_16x16x32_bf16 a[44:47], v[116:119], v[60:63], a[44:47]
    v_mfma_f32_16x16x32_bf16 v[248:251], a[240:243], v[136:139], v[152:155]
    v_mfma_f32_16x16x32_bf16 v[248:251], a[244:247], v[168:171], v[248:251]
    ds_read_b128 a[224:227], v2 offset:8192
    ds_read_b128 a[228:231], v2 offset:9216
    v_mfma_f32_16x16x32_bf16 v[248:251], a[248:251], v[200:203], v[248:251]
    v_exp_f32 v244, v244
    v_mfma_f32_16x16x32_bf16 v[248:251], a[252:255], v[232:235], v[248:251]
    s_waitcnt lgkmcnt(2)
    ds_read_b128 a[232:235], v2 offset:10240
    ds_read_b128 a[236:239], v2 offset:11264
    v_mfma_f32_16x16x32_bf16 a[48:51], v[120:123], v[32:35], a[48:51]
    v_exp_f32 v245, v245
    v_mfma_f32_16x16x32_bf16 a[48:51], v[124:127], v[36:39], a[48:51]
    ds_read_b128 v[96:99], v2 offset:24576
    ds_read_b128 v[100:103], v2 offset:25600
    v_mfma_f32_16x16x32_bf16 a[52:55], v[120:123], v[40:43], a[52:55]
    v_exp_f32 v246, v246
    v_mfma_f32_16x16x32_bf16 a[52:55], v[124:127], v[44:47], a[52:55]
    v_exp_f32 v247, v247
    v_mfma_f32_16x16x32_bf16 v[252:255], a[240:243], v[140:143], v[156:159]
    v_cvt_pk_bf16_f32 v74, v244, v245
    v_cvt_pk_bf16_f32 v75, v246, v247
    v_mfma_f32_16x16x32_bf16 v[252:255], a[244:247], v[172:175], v[252:255]
    s_add_u32 s100, s77, 4096
    v_exp_f32 v248, v248
    v_mfma_f32_16x16x32_bf16 v[252:255], a[248:251], v[204:207], v[252:255]
    s_add_u32 m0, m0, 4096
    v_exp_f32 v249, v249
    v_mfma_f32_16x16x32_bf16 v[252:255], a[252:255], v[236:239], v[252:255]
    buffer_load_dwordx4 v1, s[36:39], s100 offen sc1 lds
    v_mfma_f32_16x16x32_bf16 a[56:59], v[120:123], v[48:51], a[56:59]
    v_exp_f32 v250, v250
    v_mfma_f32_16x16x32_bf16 a[56:59], v[124:127], v[52:55], a[56:59]
    v_exp_f32 v251, v251
    v_mfma_f32_16x16x32_bf16 a[60:63], v[120:123], v[56:59], a[60:63]
    v_cvt_pk_bf16_f32 v82, v248, v249
    v_cvt_pk_bf16_f32 v83, v250, v251
    v_mfma_f32_16x16x32_bf16 a[60:63], v[124:127], v[60:63], a[60:63]
    s_waitcnt lgkmcnt(0)
    v_exp_f32 v252, v252
    v_mfma_f32_16x16x32_bf16 v[240:243], a[224:227], v[128:131], v[184:187]
    v_exp_f32 v253, v253
    v_mfma_f32_16x16x32_bf16 v[240:243], a[228:231], v[160:163], v[240:243]
    v_exp_f32 v254, v254
    v_mfma_f32_16x16x32_bf16 v[240:243], a[232:235], v[192:195], v[240:243]
    v_exp_f32 v255, v255
    v_mfma_f32_16x16x32_bf16 v[240:243], a[236:239], v[224:227], v[240:243]
    v_cvt_pk_bf16_f32 v90, v252, v253
    v_cvt_pk_bf16_f32 v91, v254, v255
    v_mfma_f32_16x16x32_bf16 a[144:147], v[96:99], v[32:35], a[144:147]
    v_mfma_f32_16x16x32_bf16 a[144:147], v[100:103], v[36:39], a[144:147]
    ds_read_b128 v[104:107], v2 offset:26624
    ds_read_b128 v[108:111], v2 offset:27648
    v_mfma_f32_16x16x32_bf16 a[148:151], v[96:99], v[40:43], a[148:151]
    v_mfma_f32_16x16x32_bf16 a[148:151], v[100:103], v[44:47], a[148:151]
    buffer_load_dwordx4 v1, s[36:39], s100 offen offset:1024 sc1 lds
    v_mfma_f32_16x16x32_bf16 v[244:247], a[224:227], v[132:135], v[148:151]
    v_exp_f32 v240, v240
    v_mfma_f32_16x16x32_bf16 v[244:247], a[228:231], v[164:167], v[244:247]
    v_exp_f32 v241, v241
    v_mfma_f32_16x16x32_bf16 v[244:247], a[232:235], v[196:199], v[244:247]
    v_exp_f32 v242, v242
    v_mfma_f32_16x16x32_bf16 v[244:247], a[236:239], v[228:231], v[244:247]
    v_exp_f32 v243, v243
    v_mfma_f32_16x16x32_bf16 a[152:155], v[96:99], v[48:51], a[152:155]
    v_cvt_pk_bf16_f32 v68, v240, v241
    v_cvt_pk_bf16_f32 v69, v242, v243
    v_mfma_f32_16x16x32_bf16 a[152:155], v[100:103], v[52:55], a[152:155]
    v_mfma_f32_16x16x32_bf16 a[156:159], v[96:99], v[56:59], a[156:159]
    v_mfma_f32_16x16x32_bf16 a[156:159], v[100:103], v[60:63], a[156:159]
    v_mfma_f32_16x16x32_bf16 v[248:251], a[224:227], v[136:139], v[152:155]
    v_exp_f32 v244, v244
    v_mfma_f32_16x16x32_bf16 v[248:251], a[228:231], v[168:171], v[248:251]
    ds_read_b128 a[240:243], v2 offset:12288
    ds_read_b128 a[244:247], v2 offset:13312
    v_mfma_f32_16x16x32_bf16 v[248:251], a[232:235], v[200:203], v[248:251]
    v_exp_f32 v245, v245
    v_mfma_f32_16x16x32_bf16 v[248:251], a[236:239], v[232:235], v[248:251]
    s_waitcnt lgkmcnt(2)
    ds_read_b128 a[248:251], v2 offset:14336
    ds_read_b128 a[252:255], v2 offset:15360
    v_mfma_f32_16x16x32_bf16 a[160:163], v[104:107], v[32:35], a[160:163]
    buffer_load_dwordx4 v1, s[36:39], s100 offen offset:2048 sc1 lds
    v_mfma_f32_16x16x32_bf16 a[160:163], v[108:111], v[36:39], a[160:163]
    ds_read_b128 v[112:115], v2 offset:28672
    ds_read_b128 v[116:119], v2 offset:29696
    v_mfma_f32_16x16x32_bf16 a[164:167], v[104:107], v[40:43], a[164:167]
    v_exp_f32 v246, v246
    v_mfma_f32_16x16x32_bf16 a[164:167], v[108:111], v[44:47], a[164:167]
    v_exp_f32 v247, v247
    v_mfma_f32_16x16x32_bf16 v[252:255], a[224:227], v[140:143], v[156:159]
    v_cvt_pk_bf16_f32 v76, v244, v245
    v_cvt_pk_bf16_f32 v77, v246, v247
    v_mfma_f32_16x16x32_bf16 v[252:255], a[228:231], v[172:175], v[252:255]
    v_exp_f32 v248, v248
    v_mfma_f32_16x16x32_bf16 v[252:255], a[232:235], v[204:207], v[252:255]
    v_exp_f32 v249, v249
    v_mfma_f32_16x16x32_bf16 v[252:255], a[236:239], v[236:239], v[252:255]
    v_exp_f32 v250, v250
    v_mfma_f32_16x16x32_bf16 a[168:171], v[104:107], v[48:51], a[168:171]
    v_exp_f32 v251, v251
    v_mfma_f32_16x16x32_bf16 a[168:171], v[108:111], v[52:55], a[168:171]
    v_cvt_pk_bf16_f32 v84, v248, v249
    v_cvt_pk_bf16_f32 v85, v250, v251
    v_mfma_f32_16x16x32_bf16 a[172:175], v[104:107], v[56:59], a[172:175]
    v_mfma_f32_16x16x32_bf16 a[172:175], v[108:111], v[60:63], a[172:175]
    s_waitcnt lgkmcnt(0)
    v_exp_f32 v252, v252
    v_mfma_f32_16x16x32_bf16 v[240:243], a[240:243], v[128:131], v[188:191]
    v_exp_f32 v253, v253
    v_mfma_f32_16x16x32_bf16 v[240:243], a[244:247], v[160:163], v[240:243]
    buffer_load_dwordx4 v1, s[36:39], s100 offen offset:3072 sc1 lds
    v_mfma_f32_16x16x32_bf16 v[240:243], a[248:251], v[192:195], v[240:243]
    v_exp_f32 v254, v254
    v_mfma_f32_16x16x32_bf16 v[240:243], a[252:255], v[224:227], v[240:243]
    v_exp_f32 v255, v255
    v_mfma_f32_16x16x32_bf16 a[176:179], v[112:115], v[32:35], a[176:179]
    v_cvt_pk_bf16_f32 v92, v252, v253
    v_cvt_pk_bf16_f32 v93, v254, v255
    v_mfma_f32_16x16x32_bf16 a[176:179], v[116:119], v[36:39], a[176:179]
    ds_read_b128 v[120:123], v2 offset:30720
    ds_read_b128 v[124:127], v2 offset:31744
    v_mfma_f32_16x16x32_bf16 a[180:183], v[112:115], v[40:43], a[180:183]
    v_exp_f32 v240, v240
    v_mfma_f32_16x16x32_bf16 a[180:183], v[116:119], v[44:47], a[180:183]
    v_exp_f32 v241, v241
    v_mfma_f32_16x16x32_bf16 v[244:247], a[240:243], v[132:135], v[148:151]
    v_add_u32 v2, s82, v1
    v_cvt_pk_bf16_f32 v70, v240, v241
    v_mfma_f32_16x16x32_bf16 v[244:247], a[244:247], v[164:167], v[244:247]
    v_exp_f32 v242, v242
    v_mfma_f32_16x16x32_bf16 v[244:247], a[248:251], v[196:199], v[244:247]
    v_exp_f32 v243, v243
    v_mfma_f32_16x16x32_bf16 v[244:247], a[252:255], v[228:231], v[244:247]
    v_cvt_pk_bf16_f32 v71, v242, v243
    v_mfma_f32_16x16x32_bf16 a[184:187], v[112:115], v[48:51], a[184:187]
    v_mfma_f32_16x16x32_bf16 a[184:187], v[116:119], v[52:55], a[184:187]
    v_mfma_f32_16x16x32_bf16 a[188:191], v[112:115], v[56:59], a[188:191]
    s_add_u32 s77, s77, 32768
    v_mfma_f32_16x16x32_bf16 a[188:191], v[116:119], v[60:63], a[188:191]
    v_mfma_f32_16x16x32_bf16 v[248:251], a[240:243], v[136:139], v[152:155]
    v_mfma_f32_16x16x32_bf16 v[248:251], a[244:247], v[168:171], v[248:251]
    v_exp_f32 v244, v244
    v_mfma_f32_16x16x32_bf16 v[248:251], a[248:251], v[200:203], v[248:251]
    v_exp_f32 v245, v245
    v_mfma_f32_16x16x32_bf16 v[248:251], a[252:255], v[232:235], v[248:251]
    s_waitcnt lgkmcnt(0)
    v_exp_f32 v246, v246
    v_mfma_f32_16x16x32_bf16 a[192:195], v[120:123], v[32:35], a[192:195]
    v_exp_f32 v247, v247
    v_mfma_f32_16x16x32_bf16 a[192:195], v[124:127], v[36:39], a[192:195]
    ds_read_b128 a[224:227], v2 offset:0
    ds_read_b128 a[228:231], v2 offset:1024
    v_mfma_f32_16x16x32_bf16 a[196:199], v[120:123], v[40:43], a[196:199]
    ds_read_b128 a[232:235], v2 offset:2048
    v_cvt_pk_bf16_f32 v78, v244, v245
    v_mfma_f32_16x16x32_bf16 a[196:199], v[124:127], v[44:47], a[196:199]
    ds_read_b128 a[236:239], v2 offset:3072
    v_cvt_pk_bf16_f32 v79, v246, v247
    v_mfma_f32_16x16x32_bf16 v[252:255], a[240:243], v[140:143], v[156:159]
    v_exp_f32 v248, v248
    v_mfma_f32_16x16x32_bf16 v[252:255], a[244:247], v[172:175], v[252:255]
    ds_read_b128 v[96:99], v2 offset:16384
    ds_read_b128 v[100:103], v2 offset:17408
    v_mfma_f32_16x16x32_bf16 v[252:255], a[248:251], v[204:207], v[252:255]
    v_exp_f32 v249, v249
    v_mfma_f32_16x16x32_bf16 v[252:255], a[252:255], v[236:239], v[252:255]
    v_exp_f32 v250, v250
    v_mfma_f32_16x16x32_bf16 a[200:203], v[120:123], v[48:51], a[200:203]
    v_exp_f32 v251, v251
    v_mfma_f32_16x16x32_bf16 a[200:203], v[124:127], v[52:55], a[200:203]
    v_cvt_pk_bf16_f32 v86, v248, v249
    v_cvt_pk_bf16_f32 v87, v250, v251
    v_mfma_f32_16x16x32_bf16 a[204:207], v[120:123], v[56:59], a[204:207]
    v_mfma_f32_16x16x32_bf16 a[204:207], v[124:127], v[60:63], a[204:207]
    v_exp_f32 v252, v252
    v_smfmac_f32_16x16x64_bf16 a[208:211], a[136:139], v[32:39], v215
    v_smfmac_f32_16x16x64_bf16 a[212:215], a[136:139], v[40:47], v215
    v_smfmac_f32_16x16x64_bf16 a[216:219], a[136:139], v[48:55], v215
    s_cmp_le_u32 s78, 1
    v_smfmac_f32_16x16x64_bf16 a[220:223], a[136:139], v[56:63], v215
    s_cbranch_scc1 K1_LB_MASK
K1_LB_BACK:
    s_waitcnt lgkmcnt(0)
    v_mfma_f32_16x16x32_bf16 v[240:243], a[224:227], v[128:131], v[176:179]
    s_mov_b32 s99, s76
    v_exp_f32 v253, v253
    v_mfma_f32_16x16x32_bf16 v[240:243], a[228:231], v[160:163], v[240:243]
    v_exp_f32 v254, v254
    v_mfma_f32_16x16x32_bf16 v[240:243], a[232:235], v[192:195], v[240:243]
    v_exp_f32 v255, v255
    v_mfma_f32_16x16x32_bf16 v[240:243], a[236:239], v[224:227], v[240:243]
    v_cvt_pk_bf16_f32 v94, v252, v253
    v_cvt_pk_bf16_f32 v95, v254, v255
    v_mfma_f32_16x16x32_bf16 a[0:3], v[96:99], v[64:67], a[0:3]
    s_add_u32 m0, s76, s75
    v_mfma_f32_16x16x32_bf16 a[0:3], v[100:103], v[68:71], a[0:3]
    s_mov_b32 s76, s60
    buffer_load_dwordx4 v1, s[36:39], s77 offen sc1 lds
    v_mfma_f32_16x16x32_bf16 a[4:7], v[96:99], v[72:75], a[4:7]
    s_mov_b32 s60, s82
    ds_read_b128 v[104:107], v2 offset:18432
    ds_read_b128 v[108:111], v2 offset:19456
    v_mfma_f32_16x16x32_bf16 a[4:7], v[100:103], v[76:79], a[4:7]
    s_mov_b32 s82, s95
    v_exp_f32 v240, v240
    v_mfma_f32_16x16x32_bf16 v[244:247], a[224:227], v[132:135], v[148:151]
    s_mov_b32 s95, s93
    v_exp_f32 v241, v241
    v_mfma_f32_16x16x32_bf16 v[244:247], a[228:231], v[164:167], v[244:247]
    s_mov_b32 s93, s99
    v_exp_f32 v242, v242
    v_mfma_f32_16x16x32_bf16 v[244:247], a[232:235], v[196:199], v[244:247]
    v_exp_f32 v243, v243
    v_mfma_f32_16x16x32_bf16 v[244:247], a[236:239], v[228:231], v[244:247]
    v_cvt_pk_bf16_f32 v32, v240, v241
    v_cvt_pk_bf16_f32 v33, v242, v243
    v_mfma_f32_16x16x32_bf16 a[8:11], v[96:99], v[80:83], a[8:11]
    v_mfma_f32_16x16x32_bf16 a[8:11], v[100:103], v[84:87], a[8:11]
    v_mfma_f32_16x16x32_bf16 a[12:15], v[96:99], v[88:91], a[12:15]
    v_mfma_f32_16x16x32_bf16 a[12:15], v[100:103], v[92:95], a[12:15]
    v_mfma_f32_16x16x32_bf16 v[248:251], a[224:227], v[136:139], v[152:155]
    v_mfma_f32_16x16x32_bf16 v[248:251], a[228:231], v[168:171], v[248:251]
    ds_read_b128 a[240:243], v2 offset:4096
    ds_read_b128 a[244:247], v2 offset:5120
    v_mfma_f32_16x16x32_bf16 v[248:251], a[232:235], v[200:203], v[248:251]
    buffer_load_dwordx4 v1, s[36:39], s77 offen offset:1024 sc1 lds
    v_mfma_f32_16x16x32_bf16 v[248:251], a[236:239], v[232:235], v[248:251]
    s_waitcnt lgkmcnt(2)
    ds_read_b128 a[248:251], v2 offset:6144
    ds_read_b128 a[252:255], v2 offset:7168
    v_mfma_f32_16x16x32_bf16 a[16:19], v[104:107], v[64:67], a[16:19]
    v_exp_f32 v244, v244
    v_mfma_f32_16x16x32_bf16 a[16:19], v[108:111], v[68:71], a[16:19]
    ds_read_b128 v[112:115], v2 offset:20480
    ds_read_b128 v[116:119], v2 offset:21504
    v_mfma_f32_16x16x32_bf16 a[20:23], v[104:107], v[72:75], a[20:23]
    v_exp_f32 v245, v245
    v_mfma_f32_16x16x32_bf16 a[20:23], v[108:111], v[76:79], a[20:23]
    v_exp_f32 v246, v246
    v_mfma_f32_16x16x32_bf16 v[252:255], a[224:227], v[140:143], v[156:159]
    v_exp_f32 v247, v247
    v_mfma_f32_16x16x32_bf16 v[252:255], a[228:231], v[172:175], v[252:255]
    v_cvt_pk_bf16_f32 v40, v244, v245
    v_cvt_pk_bf16_f32 v41, v246, v247
    v_mfma_f32_16x16x32_bf16 v[252:255], a[232:235], v[204:207], v[252:255]
    v_exp_f32 v248, v248
    v_mfma_f32_16x16x32_bf16 v[252:255], a[236:239], v[236:239], v[252:255]
    v_exp_f32 v249, v249
    v_mfma_f32_16x16x32_bf16 a[24:27], v[104:107], v[80:83], a[24:27]
    v_exp_f32 v250, v250
    v_mfma_f32_16x16x32_bf16 a[24:27], v[108:111], v[84:87], a[24:27]
    v_exp_f32 v251, v251
    v_mfma_f32_16x16x32_bf16 a[28:31], v[104:107], v[88:91], a[28:31]
    v_cvt_pk_bf16_f32 v48, v248, v249
    v_cvt_pk_bf16_f32 v49, v250, v251
    v_mfma_f32_16x16x32_bf16 a[28:31], v[108:111], v[92:95], a[28:31]
    s_waitcnt lgkmcnt(0)
    buffer_load_dwordx4 v1, s[36:39], s77 offen offset:2048 sc1 lds
    v_mfma_f32_16x16x32_bf16 v[240:243], a[240:243], v[128:131], v[180:183]
    v_exp_f32 v252, v252
    v_mfma_f32_16x16x32_bf16 v[240:243], a[244:247], v[160:163], v[240:243]
    v_exp_f32 v253, v253
    v_mfma_f32_16x16x32_bf16 v[240:243], a[248:251], v[192:195], v[240:243]
    v_exp_f32 v254, v254
    v_mfma_f32_16x16x32_bf16 v[240:243], a[252:255], v[224:227], v[240:243]
    v_exp_f32 v255, v255
    v_mfma_f32_16x16x32_bf16 a[32:35], v[112:115], v[64:67], a[32:35]
    v_cvt_pk_bf16_f32 v56, v252, v253
    v_cvt_pk_bf16_f32 v57, v254, v255
    v_mfma_f32_16x16x32_bf16 a[32:35], v[116:119], v[68:71], a[32:35]
    ds_read_b128 v[120:123], v2 offset:22528
    ds_read_b128 v[124:127], v2 offset:23552
    v_mfma_f32_16x16x32_bf16 a[36:39], v[112:115], v[72:75], a[36:39]
    v_exp_f32 v240, v240
    v_mfma_f32_16x16x32_bf16 a[36:39], v[116:119], v[76:79], a[36:39]
    v_exp_f32 v241, v241
    v_mfma_f32_16x16x32_bf16 v[244:247], a[240:243], v[132:135], v[148:151]
    v_exp_f32 v242, v242
    v_mfma_f32_16x16x32_bf16 v[244:247], a[244:247], v[164:167], v[244:247]
    v_exp_f32 v243, v243
    v_mfma_f32_16x16x32_bf16 v[244:247], a[248:251], v[196:199], v[244:247]
    v_cvt_pk_bf16_f32 v34, v240, v241
    v_cvt_pk_bf16_f32 v35, v242, v243
    v_mfma_f32_16x16x32_bf16 v[244:247], a[252:255], v[228:231], v[244:247]
    v_mfma_f32_16x16x32_bf16 a[40:43], v[112:115], v[80:83], a[40:43]
    buffer_load_dwordx4 v1, s[36:39], s77 offen offset:3072 sc1 lds
    v_mfma_f32_16x16x32_bf16 a[40:43], v[116:119], v[84:87], a[40:43]
    v_mfma_f32_16x16x32_bf16 a[44:47], v[112:115], v[88:91], a[44:47]
    v_mfma_f32_16x16x32_bf16 a[44:47], v[116:119], v[92:95], a[44:47]
    v_mfma_f32_16x16x32_bf16 v[248:251], a[240:243], v[136:139], v[152:155]
    v_mfma_f32_16x16x32_bf16 v[248:251], a[244:247], v[168:171], v[248:251]
    ds_read_b128 a[224:227], v2 offset:8192
    ds_read_b128 a[228:231], v2 offset:9216
    v_mfma_f32_16x16x32_bf16 v[248:251], a[248:251], v[200:203], v[248:251]
    v_exp_f32 v244, v244
    v_mfma_f32_16x16x32_bf16 v[248:251], a[252:255], v[232:235], v[248:251]
    s_waitcnt lgkmcnt(2)
    ds_read_b128 a[232:235], v2 offset:10240
    ds_read_b128 a[236:239], v2 offset:11264
    v_mfma_f32_16x16x32_bf16 a[48:51], v[120:123], v[64:67], a[48:51]
    v_exp_f32 v245, v245
    v_mfma_f32_16x16x32_bf16 a[48:51], v[124:127], v[68:71], a[48:51]
    ds_read_b128 v[96:99], v2 offset:24576
    ds_read_b128 v[100:103], v2 offset:25600
    v_mfma_f32_16x16x32_bf16 a[52:55], v[120:123], v[72:75], a[52:55]
    v_exp_f32 v246, v246
    v_mfma_f32_16x16x32_bf16 a[52:55], v[124:127], v[76:79], a[52:55]
    v_exp_f32 v247, v247
    v_mfma_f32_16x16x32_bf16 v[252:255], a[240:243], v[140:143], v[156:159]
    v_cvt_pk_bf16_f32 v42, v244, v245
    v_cvt_pk_bf16_f32 v43, v246, v247
    v_mfma_f32_16x16x32_bf16 v[252:255], a[244:247], v[172:175], v[252:255]
    s_add_u32 s100, s77, 4096
    v_exp_f32 v248, v248
    v_mfma_f32_16x16x32_bf16 v[252:255], a[248:251], v[204:207], v[252:255]
    s_add_u32 m0, m0, 4096
    v_exp_f32 v249, v249
    v_mfma_f32_16x16x32_bf16 v[252:255], a[252:255], v[236:239], v[252:255]
    buffer_load_dwordx4 v1, s[36:39], s100 offen sc1 lds
    v_mfma_f32_16x16x32_bf16 a[56:59], v[120:123], v[80:83], a[56:59]
    v_exp_f32 v250, v250
    v_mfma_f32_16x16x32_bf16 a[56:59], v[124:127], v[84:87], a[56:59]
    v_exp_f32 v251, v251
    v_mfma_f32_16x16x32_bf16 a[60:63], v[120:123], v[88:91], a[60:63]
    v_cvt_pk_bf16_f32 v50, v248, v249
    v_cvt_pk_bf16_f32 v51, v250, v251
    v_mfma_f32_16x16x32_bf16 a[60:63], v[124:127], v[92:95], a[60:63]
    s_waitcnt lgkmcnt(0)
    v_exp_f32 v252, v252
    v_mfma_f32_16x16x32_bf16 v[240:243], a[224:227], v[128:131], v[184:187]
    v_exp_f32 v253, v253
    v_mfma_f32_16x16x32_bf16 v[240:243], a[228:231], v[160:163], v[240:243]
    v_exp_f32 v254, v254
    v_mfma_f32_16x16x32_bf16 v[240:243], a[232:235], v[192:195], v[240:243]
    v_exp_f32 v255, v255
    v_mfma_f32_16x16x32_bf16 v[240:243], a[236:239], v[224:227], v[240:243]
    v_cvt_pk_bf16_f32 v58, v252, v253
    v_cvt_pk_bf16_f32 v59, v254, v255
    v_mfma_f32_16x16x32_bf16 a[144:147], v[96:99], v[64:67], a[144:147]
    v_mfma_f32_16x16x32_bf16 a[144:147], v[100:103], v[68:71], a[144:147]
    ds_read_b128 v[104:107], v2 offset:26624
    ds_read_b128 v[108:111], v2 offset:27648
    v_mfma_f32_16x16x32_bf16 a[148:151], v[96:99], v[72:75], a[148:151]
    v_mfma_f32_16x16x32_bf16 a[148:151], v[100:103], v[76:79], a[148:151]
    buffer_load_dwordx4 v1, s[36:39], s100 offen offset:1024 sc1 lds
    v_mfma_f32_16x16x32_bf16 v[244:247], a[224:227], v[132:135], v[148:151]
    v_exp_f32 v240, v240
    v_mfma_f32_16x16x32_bf16 v[244:247], a[228:231], v[164:167], v[244:247]
    v_exp_f32 v241, v241
    v_mfma_f32_16x16x32_bf16 v[244:247], a[232:235], v[196:199], v[244:247]
    v_exp_f32 v242, v242
    v_mfma_f32_16x16x32_bf16 v[244:247], a[236:239], v[228:231], v[244:247]
    v_exp_f32 v243, v243
    v_mfma_f32_16x16x32_bf16 a[152:155], v[96:99], v[80:83], a[152:155]
    v_cvt_pk_bf16_f32 v36, v240, v241
    v_cvt_pk_bf16_f32 v37, v242, v243
    v_mfma_f32_16x16x32_bf16 a[152:155], v[100:103], v[84:87], a[152:155]
    v_mfma_f32_16x16x32_bf16 a[156:159], v[96:99], v[88:91], a[156:159]
    v_mfma_f32_16x16x32_bf16 a[156:159], v[100:103], v[92:95], a[156:159]
    v_mfma_f32_16x16x32_bf16 v[248:251], a[224:227], v[136:139], v[152:155]
    v_exp_f32 v244, v244
    v_mfma_f32_16x16x32_bf16 v[248:251], a[228:231], v[168:171], v[248:251]
    ds_read_b128 a[240:243], v2 offset:12288
    ds_read_b128 a[244:247], v2 offset:13312
    v_mfma_f32_16x16x32_bf16 v[248:251], a[232:235], v[200:203], v[248:251]
    v_exp_f32 v245, v245
    v_mfma_f32_16x16x32_bf16 v[248:251], a[236:239], v[232:235], v[248:251]
    s_waitcnt lgkmcnt(2)
    ds_read_b128 a[248:251], v2 offset:14336
    ds_read_b128 a[252:255], v2 offset:15360
    v_mfma_f32_16x16x32_bf16 a[160:163], v[104:107], v[64:67], a[160:163]
    buffer_load_dwordx4 v1, s[36:39], s100 offen offset:2048 sc1 lds
    v_mfma_f32_16x16x32_bf16 a[160:163], v[108:111], v[68:71], a[160:163]
    ds_read_b128 v[112:115], v2 offset:28672
    ds_read_b128 v[116:119], v2 offset:29696
    v_mfma_f32_16x16x32_bf16 a[164:167], v[104:107], v[72:75], a[164:167]
    v_exp_f32 v246, v246
    v_mfma_f32_16x16x32_bf16 a[164:167], v[108:111], v[76:79], a[164:167]
    v_exp_f32 v247, v247
    v_mfma_f32_16x16x32_bf16 v[252:255], a[224:227], v[140:143], v[156:159]
    v_cvt_pk_bf16_f32 v44, v244, v245
    v_cvt_pk_bf16_f32 v45, v246, v247
    v_mfma_f32_16x16x32_bf16 v[252:255], a[228:231], v[172:175], v[252:255]
    v_exp_f32 v248, v248
    v_mfma_f32_16x16x32_bf16 v[252:255], a[232:235], v[204:207], v[252:255]
    v_exp_f32 v249, v249
    v_mfma_f32_16x16x32_bf16 v[252:255], a[236:239], v[236:239], v[252:255]
    v_exp_f32 v250, v250
    v_mfma_f32_16x16x32_bf16 a[168:171], v[104:107], v[80:83], a[168:171]
    v_exp_f32 v251, v251
    v_mfma_f32_16x16x32_bf16 a[168:171], v[108:111], v[84:87], a[168:171]
    v_cvt_pk_bf16_f32 v52, v248, v249
    v_cvt_pk_bf16_f32 v53, v250, v251
    v_mfma_f32_16x16x32_bf16 a[172:175], v[104:107], v[88:91], a[172:175]
    v_mfma_f32_16x16x32_bf16 a[172:175], v[108:111], v[92:95], a[172:175]
    s_waitcnt lgkmcnt(0)
    v_exp_f32 v252, v252
    v_mfma_f32_16x16x32_bf16 v[240:243], a[240:243], v[128:131], v[188:191]
    v_exp_f32 v253, v253
    v_mfma_f32_16x16x32_bf16 v[240:243], a[244:247], v[160:163], v[240:243]
    buffer_load_dwordx4 v1, s[36:39], s100 offen offset:3072 sc1 lds
    v_mfma_f32_16x16x32_bf16 v[240:243], a[248:251], v[192:195], v[240:243]
    v_exp_f32 v254, v254
    v_mfma_f32_16x16x32_bf16 v[240:243], a[252:255], v[224:227], v[240:243]
    v_exp_f32 v255, v255
    v_mfma_f32_16x16x32_bf16 a[176:179], v[112:115], v[64:67], a[176:179]
    v_cvt_pk_bf16_f32 v60, v252, v253
    v_cvt_pk_bf16_f32 v61, v254, v255
    v_mfma_f32_16x16x32_bf16 a[176:179], v[116:119], v[68:71], a[176:179]
    ds_read_b128 v[120:123], v2 offset:30720
    ds_read_b128 v[124:127], v2 offset:31744
    v_mfma_f32_16x16x32_bf16 a[180:183], v[112:115], v[72:75], a[180:183]
    v_exp_f32 v240, v240
    v_mfma_f32_16x16x32_bf16 a[180:183], v[116:119], v[76:79], a[180:183]
    v_exp_f32 v241, v241
    v_mfma_f32_16x16x32_bf16 v[244:247], a[240:243], v[132:135], v[148:151]
    v_add_u32 v2, s82, v1
    v_cvt_pk_bf16_f32 v38, v240, v241
    v_mfma_f32_16x16x32_bf16 v[244:247], a[244:247], v[164:167], v[244:247]
    v_exp_f32 v242, v242
    v_mfma_f32_16x16x32_bf16 v[244:247], a[248:251], v[196:199], v[244:247]
    v_exp_f32 v243, v243
    v_mfma_f32_16x16x32_bf16 v[244:247], a[252:255], v[228:231], v[244:247]
    v_cvt_pk_bf16_f32 v39, v242, v243
    v_mfma_f32_16x16x32_bf16 a[184:187], v[112:115], v[80:83], a[184:187]
    v_mfma_f32_16x16x32_bf16 a[184:187], v[116:119], v[84:87], a[184:187]
    v_mfma_f32_16x16x32_bf16 a[188:191], v[112:115], v[88:91], a[188:191]
    s_add_u32 s77, s77, 32768
    v_mfma_f32_16x16x32_bf16 a[188:191], v[116:119], v[92:95], a[188:191]
    v_mfma_f32_16x16x32_bf16 v[248:251], a[240:243], v[136:139], v[152:155]
    v_mfma_f32_16x16x32_bf16 v[248:251], a[244:247], v[168:171], v[248:251]
    v_exp_f32 v244, v244
    v_mfma_f32_16x16x32_bf16 v[248:251], a[248:251], v[200:203], v[248:251]
    v_exp_f32 v245, v245
    v_mfma_f32_16x16x32_bf16 v[248:251], a[252:255], v[232:235], v[248:251]
    s_waitcnt lgkmcnt(0)
    v_exp_f32 v246, v246
    v_mfma_f32_16x16x32_bf16 a[192:195], v[120:123], v[64:67], a[192:195]
    v_exp_f32 v247, v247
    v_mfma_f32_16x16x32_bf16 a[192:195], v[124:127], v[68:71], a[192:195]
    v_cvt_pk_bf16_f32 v46, v244, v245
    v_cvt_pk_bf16_f32 v47, v246, v247
    v_mfma_f32_16x16x32_bf16 a[196:199], v[120:123], v[72:75], a[196:199]
    s_waitcnt vmcnt(8) lgkmcnt(0)
    v_exp_f32 v248, v248
    v_mfma_f32_16x16x32_bf16 a[196:199], v[124:127], v[76:79], a[196:199]
    s_barrier
    ds_read_b128 a[224:227], v2 offset:0
    ds_read_b128 a[228:231], v2 offset:1024
    v_mfma_f32_16x16x32_bf16 v[252:255], a[240:243], v[140:143], v[156:159]
    v_exp_f32 v249, v249
    v_mfma_f32_16x16x32_bf16 v[252:255], a[244:247], v[172:175], v[252:255]
    ds_read_b128 a[232:235], v2 offset:2048
    ds_read_b128 a[236:239], v2 offset:3072
    v_mfma_f32_16x16x32_bf16 v[252:255], a[248:251], v[204:207], v[252:255]
    ds_read_b128 v[96:99], v2 offset:16384
    v_cvt_pk_bf16_f32 v54, v248, v249
    v_mfma_f32_16x16x32_bf16 v[252:255], a[252:255], v[236:239], v[252:255]
    v_exp_f32 v250, v250
    v_mfma_f32_16x16x32_bf16 a[200:203], v[120:123], v[80:83], a[200:203]
    v_exp_f32 v251, v251
    v_mfma_f32_16x16x32_bf16 a[200:203], v[124:127], v[84:87], a[200:203]
    ds_read_b128 v[100:103], v2 offset:17408
    v_cvt_pk_bf16_f32 v55, v250, v251
    v_mfma_f32_16x16x32_bf16 a[204:207], v[120:123], v[88:91], a[204:207]
    v_mfma_f32_16x16x32_bf16 a[204:207], v[124:127], v[92:95], a[204:207]
    v_exp_f32 v252, v252
    v_smfmac_f32_16x16x64_bf16 a[208:211], a[136:139], v[64:71], v215
    v_smfmac_f32_16x16x64_bf16 a[212:215], a[136:139], v[72:79], v215
    s_sub_u32 s78, s78, 1
    v_smfmac_f32_16x16x64_bf16 a[216:219], a[136:139], v[80:87], v215
    s_cmp_lg_u32 s78, 0
    v_smfmac_f32_16x16x64_bf16 a[220:223], a[136:139], v[88:95], v215
    s_cbranch_scc1 K1_LB
K1_LB_END:
    v_add_f32 v212, s12, v148
    v_fma_f32 v176, v208, s8, v212
    v_fma_f32 v177, v209, s8, v212
    v_fma_f32 v178, v210, s8, v212
    v_fma_f32 v179, v211, s8, v212
    s_nop 1
    s_waitcnt lgkmcnt(0)
    v_mfma_f32_16x16x32_bf16 v[240:243], a[224:227], v[132:135], v[176:179]
    s_mov_b32 s7, 0
    ds_read_b128 v[104:107], v2 offset:18432
    ds_read_b128 v[108:111], v2 offset:19456
    v_mfma_f32_16x16x32_bf16 v[240:243], a[228:231], v[164:167], v[240:243]
    s_mov_b32 s99, s76
    buffer_load_dwordx4 v[64:67], v11, s[48:51], s7 offen nt
    v_mfma_f32_16x16x32_bf16 v[240:243], a[232:235], v[196:199], v[240:243]
    s_mov_b32 s7, 18432
    v_exp_f32 v253, v253
    v_mfma_f32_16x16x32_bf16 v[240:243], a[236:239], v[228:231], v[240:243]
    s_lshl_b32 s29, s6, 2
    v_exp_f32 v254, v254
    v_mfma_f32_16x16x32_bf16 a[0:3], v[96:99], v[32:35], a[0:3]
    s_lshr_b32 s29, 0x41302413, s29
    v_exp_f32 v255, v255
    v_mfma_f32_16x16x32_bf16 a[0:3], v[100:103], v[36:39], a[0:3]
    s_and_b32 s29, s29, 7
    buffer_load_dwordx4 v[68:71], v11, s[48:51], s7 offen nt
    v_mfma_f32_16x16x32_bf16 a[4:7], v[96:99], v[40:43], a[4:7]
    s_mov_b32 s7, 9216
    v_cvt_pk_bf16_f32 v62, v252, v253
    v_cvt_pk_bf16_f32 v63, v254, v255
    v_mfma_f32_16x16x32_bf16 a[4:7], v[100:103], v[44:47], a[4:7]
    s_lshl_b32 s29, s29, 15
    ds_read_b128 a[240:243], v2 offset:4096
    ds_read_b128 a[244:247], v2 offset:5120
    v_mfma_f32_16x16x32_bf16 v[244:247], a[224:227], v[136:139], v[152:155]
    s_add_u32 s44, s29, s75
    ds_read_b128 a[248:251], v2 offset:6144
    v_add_f32 v213, s13, v148
    v_mfma_f32_16x16x32_bf16 v[244:247], a[228:231], v[168:171], v[244:247]
    s_lshl_b32 s29, s6, 2
    buffer_load_dwordx4 v[20:23], v11, s[48:51], s7 offen nt
    v_mfma_f32_16x16x32_bf16 v[244:247], a[232:235], v[200:203], v[244:247]
    s_mov_b32 s7, 27648
    ds_read_b128 a[252:255], v2 offset:7168
    ds_read_b128 v[112:115], v2 offset:20480
    v_mfma_f32_16x16x32_bf16 v[244:247], a[236:239], v[232:235], v[244:247]
    s_lshr_b32 s29, 0x2413024, s29
    ds_read_b128 v[116:119], v2 offset:21504
    v_fma_f32 v180, v208, s9, v213
    v_mfma_f32_16x16x32_bf16 a[8:11], v[96:99], v[48:51], a[8:11]
    s_and_b32 s29, s29, 7
    v_fma_f32 v181, v209, s9, v213
    v_fma_f32 v182, v210, s9, v213
    v_mfma_f32_16x16x32_bf16 a[8:11], v[100:103], v[52:55], a[8:11]
    s_lshl_b32 s29, s29, 15
    buffer_load_dwordx4 v[24:27], v11, s[48:51], s7 offen nt
    v_mfma_f32_16x16x32_bf16 a[12:15], v[96:99], v[56:59], a[12:15]
    s_add_u32 s45, s29, s75
    v_fma_f32 v183, v211, s9, v213
    ds_read_b128 v[120:123], v2 offset:22528
    v_mfma_f32_16x16x32_bf16 a[12:15], v[100:103], v[60:63], a[12:15]
    s_lshl_b32 s29, s6, 2
    v_exp_f32 v240, v240
    s_waitcnt lgkmcnt(2)
    v_mfma_f32_16x16x32_bf16 a[16:19], v[104:107], v[32:35], a[16:19]
    s_lshr_b32 s29, 0x13024130, s29
    v_exp_f32 v241, v241
    v_mfma_f32_16x16x32_bf16 a[16:19], v[108:111], v[36:39], a[16:19]
    s_and_b32 s29, s29, 7
    buffer_load_dwordx4 v[144:147], v12, s[52:55], 0 offen nt
    v_mfma_f32_16x16x32_bf16 v[248:251], a[224:227], v[140:143], v[156:159]
    s_lshl_b32 s29, s29, 15
    v_exp_f32 v242, v242
    v_mfma_f32_16x16x32_bf16 v[248:251], a[228:231], v[172:175], v[248:251]
    s_add_u32 s46, s29, s75
    v_exp_f32 v243, v243
    v_mfma_f32_16x16x32_bf16 v[248:251], a[232:235], v[204:207], v[248:251]
    s_lshl_b32 s29, s6, 2
    v_cvt_pk_bf16_f32 v72, v240, v241
    v_cvt_pk_bf16_f32 v73, v242, v243
    v_mfma_f32_16x16x32_bf16 v[248:251], a[236:239], v[236:239], v[248:251]
    s_lshr_b32 s29, 0x24130241, s29
    buffer_load_dwordx4 a[140:143], v13, s[52:55], 0 offen nt
    v_mfma_f32_16x16x32_bf16 a[20:23], v[104:107], v[40:43], a[20:23]
    s_and_b32 s29, s29, 7
    ds_read_b128 v[124:127], v2 offset:23552
    ds_read_b128 a[224:227], v2 offset:8192
    v_mfma_f32_16x16x32_bf16 a[20:23], v[108:111], v[44:47], a[20:23]
    s_lshl_b32 s29, s29, 15
    v_exp_f32 v244, v244
    v_mfma_f32_16x16x32_bf16 a[24:27], v[104:107], v[48:51], a[24:27]
    s_add_u32 s47, s29, s75
    v_exp_f32 v245, v245
    v_mfma_f32_16x16x32_bf16 a[24:27], v[108:111], v[52:55], a[24:27]
    s_lshl_b32 s29, s6, 2
    v_exp_f32 v246, v246
    v_mfma_f32_16x16x32_bf16 a[28:31], v[104:107], v[56:59], a[28:31]
    s_lshr_b32 s29, 0x30241302, s29
    v_exp_f32 v247, v247
    v_mfma_f32_16x16x32_bf16 a[28:31], v[108:111], v[60:63], a[28:31]
    s_and_b32 s29, s29, 7
    v_cvt_pk_bf16_f32 v80, v244, v245
    v_cvt_pk_bf16_f32 v81, v246, v247
    v_mfma_f32_16x16x32_bf16 v[252:255], a[240:243], v[132:135], v[180:183]
    s_mov_b32 s98, 0x3fb8aa3b
    ds_read_b128 a[228:231], v2 offset:9216
    ds_read_b128 a[232:235], v2 offset:10240
    v_mfma_f32_16x16x32_bf16 v[252:255], a[244:247], v[164:167], v[252:255]
    s_lshr_b32 s61, s5, 3
    ds_read_b128 a[236:239], v2 offset:11264
    v_add_f32 v212, s14, v148
    v_mfma_f32_16x16x32_bf16 v[252:255], a[248:251], v[196:199], v[252:255]
    s_lshl_b32 s29, s29, 15
    ds_read_b128 v[96:99], v2 offset:24576
    v_fma_f32 v184, v208, s10, v212
    v_mfma_f32_16x16x32_bf16 v[252:255], a[252:255], v[228:231], v[252:255]
    s_add_u32 s79, s29, s75
    ds_read_b128 v[100:103], v2 offset:25600
    v_fma_f32 v185, v209, s10, v212
    v_mfma_f32_16x16x32_bf16 a[32:35], v[112:115], v[32:35], a[32:35]
    s_mul_i32 s71, s61, 6144
    v_exp_f32 v248, v248
    s_waitcnt lgkmcnt(5)
    v_mfma_f32_16x16x32_bf16 a[32:35], v[116:119], v[36:39], a[32:35]
    s_and_b32 s29, s5, 7
    v_exp_f32 v249, v249
    v_mfma_f32_16x16x32_bf16 a[36:39], v[112:115], v[40:43], a[36:39]
    s_add_u32 s3, s5, s6
    v_exp_f32 v250, v250
    v_mfma_f32_16x16x32_bf16 a[36:39], v[116:119], v[44:47], a[36:39]
    s_add_u32 s71, s71, 131072
    v_exp_f32 v251, v251
    v_mfma_f32_16x16x32_bf16 v[240:243], a[240:243], v[136:139], v[152:155]
    s_lshl_b32 s29, s29, 8
    v_fma_f32 v186, v210, s10, v212
    v_fma_f32 v187, v211, s10, v212
    v_mfma_f32_16x16x32_bf16 v[240:243], a[244:247], v[168:171], v[240:243]
    s_add_u32 s74, s4, 1
    v_cvt_pk_bf16_f32 v88, v248, v249
    v_cvt_pk_bf16_f32 v89, v250, v251
    v_mfma_f32_16x16x32_bf16 v[240:243], a[248:251], v[200:203], v[240:243]
    s_and_b32 s28, s5, 3
    v_exp_f32 v252, v252
    v_mfma_f32_16x16x32_bf16 v[240:243], a[252:255], v[232:235], v[240:243]
    s_and_b32 s3, s3, 1
    v_exp_f32 v253, v253
    v_mfma_f32_16x16x32_bf16 a[40:43], v[112:115], v[48:51], a[40:43]
    s_lshl2_add_u32 s66, s6, s61
    v_exp_f32 v254, v254
    v_mfma_f32_16x16x32_bf16 a[40:43], v[116:119], v[52:55], a[40:43]
    s_add_u32 s71, s71, s29
    v_exp_f32 v255, v255
    v_mfma_f32_16x16x32_bf16 a[44:47], v[112:115], v[56:59], a[44:47]
    s_lshl_b32 s74, s74, 15
    v_cvt_pk_bf16_f32 v74, v252, v253
    v_cvt_pk_bf16_f32 v75, v254, v255
    v_mfma_f32_16x16x32_bf16 a[44:47], v[116:119], v[60:63], a[44:47]
    s_mul_i32 s28, s28, 9216
    ds_read_b128 v[104:107], v2 offset:26624
    ds_read_b128 v[108:111], v2 offset:27648
    v_mfma_f32_16x16x32_bf16 a[48:51], v[120:123], v[32:35], a[48:51]
    s_lshl3_add_u32 s3, s61, s3
    v_exp_f32 v240, v240
    v_mfma_f32_16x16x32_bf16 a[48:51], v[124:127], v[36:39], a[48:51]
    s_lshl_b32 s66, s66, 10
    v_exp_f32 v241, v241
    v_mfma_f32_16x16x32_bf16 v[244:247], a[240:243], v[140:143], v[156:159]
    s_add_u32 s70, s71, 4096
    v_exp_f32 v242, v242
    v_mfma_f32_16x16x32_bf16 v[244:247], a[244:247], v[172:175], v[244:247]
    s_add_u32 s71, s71, s29
    v_exp_f32 v243, v243
    v_mfma_f32_16x16x32_bf16 v[244:247], a[248:251], v[204:207], v[244:247]
    s_add_u32 s74, s74, s101
    v_cvt_pk_bf16_f32 v82, v240, v241
    v_cvt_pk_bf16_f32 v83, v242, v243
    v_mfma_f32_16x16x32_bf16 v[244:247], a[252:255], v[236:239], v[244:247]
    ds_read_b128 a[240:243], v2 offset:12288
    ds_read_b128 a[244:247], v2 offset:13312
    v_mfma_f32_16x16x32_bf16 a[52:55], v[120:123], v[40:43], a[52:55]
    ds_read_b128 a[248:251], v2 offset:14336
    v_add_f32 v213, s15, v148
    v_mfma_f32_16x16x32_bf16 a[52:55], v[124:127], v[44:47], a[52:55]
    ds_read_b128 a[252:255], v2 offset:15360
    v_fma_f32 v188, v208, s11, v213
    v_mfma_f32_16x16x32_bf16 a[56:59], v[120:123], v[48:51], a[56:59]
    ds_read_b128 v[112:115], v2 offset:28672
    v_fma_f32 v189, v209, s11, v213
    v_mfma_f32_16x16x32_bf16 a[56:59], v[124:127], v[52:55], a[56:59]
    ds_read_b128 v[116:119], v2 offset:29696
    v_fma_f32 v190, v210, s11, v213
    v_mfma_f32_16x16x32_bf16 a[60:63], v[120:123], v[56:59], a[60:63]
    v_exp_f32 v244, v244
    v_mfma_f32_16x16x32_bf16 a[60:63], v[124:127], v[60:63], a[60:63]
    v_exp_f32 v245, v245
    v_mfma_f32_16x16x32_bf16 v[248:251], a[224:227], v[132:135], v[184:187]
    s_waitcnt lgkmcnt(2)
    v_exp_f32 v246, v246
    v_mfma_f32_16x16x32_bf16 v[248:251], a[228:231], v[164:167], v[248:251]
    v_exp_f32 v247, v247
    v_mfma_f32_16x16x32_bf16 v[248:251], a[232:235], v[196:199], v[248:251]
    v_fma_f32 v191, v211, s11, v213
    v_cvt_pk_bf16_f32 v90, v244, v245
    v_mfma_f32_16x16x32_bf16 v[248:251], a[236:239], v[228:231], v[248:251]
    s_add_u32 m0, s76, s75
    v_cvt_pk_bf16_f32 v91, v246, v247
    ds_read_b128 v[120:123], v2 offset:30720
    v_mfma_f32_16x16x32_bf16 a[144:147], v[96:99], v[32:35], a[144:147]
    s_mov_b32 s76, s60
    buffer_load_dwordx4 v1, s[36:39], s77 offen sc1 lds
    v_mfma_f32_16x16x32_bf16 a[144:147], v[100:103], v[36:39], a[144:147]
    s_mov_b32 s60, s82
    v_exp_f32 v248, v248
    v_mfma_f32_16x16x32_bf16 a[148:151], v[96:99], v[40:43], a[148:151]
    s_mov_b32 s82, s95
    v_exp_f32 v249, v249
    v_mfma_f32_16x16x32_bf16 a[148:151], v[100:103], v[44:47], a[148:151]
    s_mov_b32 s95, s93
    v_exp_f32 v250, v250
    v_mfma_f32_16x16x32_bf16 v[252:255], a[224:227], v[136:139], v[152:155]
    s_mov_b32 s93, s99
    v_exp_f32 v251, v251
    v_mfma_f32_16x16x32_bf16 v[252:255], a[228:231], v[168:171], v[252:255]
    v_cvt_pk_bf16_f32 v76, v248, v249
    v_cvt_pk_bf16_f32 v77, v250, v251
    v_mfma_f32_16x16x32_bf16 v[252:255], a[232:235], v[200:203], v[252:255]
    ds_read_b128 v[124:127], v2 offset:31744
    v_add_u32 v2, s82, v1
    v_mfma_f32_16x16x32_bf16 v[252:255], a[236:239], v[232:235], v[252:255]
    buffer_load_dwordx4 v1, s[36:39], s77 offen offset:1024 sc1 lds
    v_mfma_f32_16x16x32_bf16 a[152:155], v[96:99], v[48:51], a[152:155]
    v_bfe_u32 v8, v1, 2, 6
    v_accvgpr_read_b32 v4, a112
    v_mfma_f32_16x16x32_bf16 a[152:155], v[100:103], v[52:55], a[152:155]
    v_accvgpr_read_b32 v5, a116
    v_add_u32 v8, 192, v8
    v_mfma_f32_16x16x32_bf16 a[156:159], v[96:99], v[56:59], a[156:159]
    v_exp_f32 v252, v252
    v_mfma_f32_16x16x32_bf16 a[156:159], v[100:103], v[60:63], a[156:159]
    v_exp_f32 v253, v253
    v_mfma_f32_16x16x32_bf16 a[160:163], v[104:107], v[32:35], a[160:163]
    v_exp_f32 v254, v254
    v_mfma_f32_16x16x32_bf16 a[160:163], v[108:111], v[36:39], a[160:163]
    v_exp_f32 v255, v255
    v_mfma_f32_16x16x32_bf16 v[240:243], a[224:227], v[140:143], v[156:159]
    buffer_load_dwordx4 v1, s[36:39], s77 offen offset:2048 sc1 lds
    v_mfma_f32_16x16x32_bf16 v[240:243], a[228:231], v[172:175], v[240:243]
    v_cvt_pk_bf16_f32 v84, v252, v253
    v_cvt_pk_bf16_f32 v85, v254, v255
    v_mfma_f32_16x16x32_bf16 v[240:243], a[232:235], v[204:207], v[240:243]
    v_cvt_pk_bf16_f32 v4, 0, v4
    v_cvt_pk_bf16_f32 v5, 0, v5
    v_mfma_f32_16x16x32_bf16 v[240:243], a[236:239], v[236:239], v[240:243]
    v_lshrrev_b32 v15, 8, v1
    ds_bpermute_b32 v4, v8, v4
    v_mfma_f32_16x16x32_bf16 a[164:167], v[104:107], v[40:43], a[164:167]
    ds_bpermute_b32 v5, v8, v5
    ds_read_b128 a[224:227], v2 offset:0
    v_mfma_f32_16x16x32_bf16 a[164:167], v[108:111], v[44:47], a[164:167]
    ds_read_b128 a[228:231], v2 offset:1024
    v_bfe_u32 v14, v1, 4, 4
    v_mfma_f32_16x16x32_bf16 a[168:171], v[104:107], v[48:51], a[168:171]
    ds_read_b128 a[232:235], v2 offset:2048
    v_lshlrev_b32 v15, 3, v15
    v_mfma_f32_16x16x32_bf16 a[168:171], v[108:111], v[52:55], a[168:171]
    buffer_load_dwordx4 v1, s[36:39], s77 offen offset:3072 sc1 lds
    v_mfma_f32_16x16x32_bf16 a[172:175], v[104:107], v[56:59], a[172:175]
    ds_read_b128 a[236:239], v2 offset:3072
    ds_read_b128 v[96:99], v2 offset:16384
    v_mfma_f32_16x16x32_bf16 a[172:175], v[108:111], v[60:63], a[172:175]
    ds_read_b128 v[100:103], v2 offset:17408
    v_sub_u32 v14, v14, v15
    v_mfma_f32_16x16x32_bf16 v[244:247], a[240:243], v[132:135], v[188:191]
    v_exp_f32 v240, v240
    v_mfma_f32_16x16x32_bf16 v[244:247], a[244:247], v[164:167], v[244:247]
    v_exp_f32 v241, v241
    v_mfma_f32_16x16x32_bf16 v[244:247], a[248:251], v[196:199], v[244:247]
    v_exp_f32 v242, v242
    v_mfma_f32_16x16x32_bf16 v[244:247], a[252:255], v[228:231], v[244:247]
    s_add_u32 s100, s77, 4096
    v_exp_f32 v243, v243
    s_waitcnt lgkmcnt(1)
    v_mfma_f32_16x16x32_bf16 a[176:179], v[112:115], v[32:35], a[176:179]
    s_add_u32 m0, m0, 4096
    v_cvt_pk_bf16_f32 v92, v240, v241
    v_cvt_pk_bf16_f32 v93, v242, v243
    v_mfma_f32_16x16x32_bf16 a[176:179], v[116:119], v[36:39], a[176:179]
    buffer_load_dwordx4 v1, s[36:39], s100 offen sc1 lds
    v_mfma_f32_16x16x32_bf16 a[180:183], v[112:115], v[40:43], a[180:183]
    v_exp_f32 v244, v244
    v_mfma_f32_16x16x32_bf16 a[180:183], v[116:119], v[44:47], a[180:183]
    v_exp_f32 v245, v245
    v_mfma_f32_16x16x32_bf16 v[248:251], a[240:243], v[136:139], v[152:155]
    v_exp_f32 v246, v246
    v_mfma_f32_16x16x32_bf16 v[248:251], a[244:247], v[168:171], v[248:251]
    v_exp_f32 v247, v247
    v_mfma_f32_16x16x32_bf16 v[248:251], a[248:251], v[200:203], v[248:251]
    v_cvt_pk_bf16_f32 v78, v244, v245
    v_cvt_pk_bf16_f32 v79, v246, v247
    v_mfma_f32_16x16x32_bf16 v[248:251], a[252:255], v[232:235], v[248:251]
    buffer_load_dwordx4 v1, s[36:39], s100 offen offset:1024 sc1 lds
    v_mfma_f32_16x16x32_bf16 a[184:187], v[112:115], v[48:51], a[184:187]
    v_and_b32 v15, 16, v1
    v_mov_b32 v31, 0x3f80
    v_mfma_f32_16x16x32_bf16 a[184:187], v[116:119], v[52:55], a[184:187]
    v_ashrrev_i32 v14, 1, v14
    v_lshlrev_b32 v15, v15, v31
    v_mfma_f32_16x16x32_bf16 a[188:191], v[112:115], v[56:59], a[188:191]
    v_exp_f32 v248, v248
    v_mfma_f32_16x16x32_bf16 a[188:191], v[116:119], v[60:63], a[188:191]
    v_exp_f32 v249, v249
    v_mfma_f32_16x16x32_bf16 a[192:195], v[120:123], v[32:35], a[192:195]
    v_exp_f32 v250, v250
    v_mfma_f32_16x16x32_bf16 a[192:195], v[124:127], v[36:39], a[192:195]
    v_exp_f32 v251, v251
    v_mfma_f32_16x16x32_bf16 v[252:255], a[240:243], v[140:143], v[156:159]
    buffer_load_dwordx4 v1, s[36:39], s100 offen offset:2048 sc1 lds
    v_mfma_f32_16x16x32_bf16 v[252:255], a[244:247], v[172:175], v[252:255]
    v_cvt_pk_bf16_f32 v86, v248, v249
    v_cvt_pk_bf16_f32 v87, v250, v251
    v_mfma_f32_16x16x32_bf16 v[252:255], a[248:251], v[204:207], v[252:255]
    v_cmp_eq_i32 vcc, 0, v14
    v_mul_f32 v4, s98, v4
    v_mfma_f32_16x16x32_bf16 v[252:255], a[252:255], v[236:239], v[252:255]
    v_cndmask_b32 v216, 0, v15, vcc
    v_cmp_eq_i32 vcc, 1, v14
    v_mfma_f32_16x16x32_bf16 a[196:199], v[120:123], v[40:43], a[196:199]
    v_mul_f32 v5, s98, v5
    v_cndmask_b32 v217, 0, v15, vcc
    v_mfma_f32_16x16x32_bf16 a[196:199], v[124:127], v[44:47], a[196:199]
    v_cmp_eq_i32 vcc, 2, v14
    v_and_b32 v31, 512, v1
    v_mfma_f32_16x16x32_bf16 a[200:203], v[120:123], v[48:51], a[200:203]
    v_exp_f32 v252, v252
    v_mfma_f32_16x16x32_bf16 a[200:203], v[124:127], v[52:55], a[200:203]
    buffer_load_dwordx4 v1, s[36:39], s100 offen offset:3072 sc1 lds
    v_mfma_f32_16x16x32_bf16 a[204:207], v[120:123], v[56:59], a[204:207]
    v_cndmask_b32 v218, 0, v15, vcc
    v_cmp_eq_i32 vcc, 3, v14
    v_mfma_f32_16x16x32_bf16 a[204:207], v[124:127], v[60:63], a[204:207]
    v_exp_f32 v4, v4
    v_smfmac_f32_16x16x64_bf16 a[208:211], a[136:139], v[32:39], v215
    v_cndmask_b32 v219, 0, v15, vcc
    v_cmp_eq_i32 vcc, -8, v14
    v_smfmac_f32_16x16x64_bf16 a[212:215], a[136:139], v[40:47], v215
    v_exp_f32 v5, v5
    v_smfmac_f32_16x16x64_bf16 a[216:219], a[136:139], v[48:55], v215
    v_cndmask_b32 v220, 0, v15, vcc
    v_cmp_eq_i32 vcc, -7, v14
    v_smfmac_f32_16x16x64_bf16 a[220:223], a[136:139], v[56:63], v215
    s_add_u32 s77, s77, 32768
    v_cndmask_b32 v221, 0, v15, vcc
    v_cmp_eq_i32 vcc, -6, v14
    v_add_f32 v4, 1.0, v4
    v_add_f32 v5, 1.0, v5
    v_cndmask_b32 v222, 0, v15, vcc
    v_cmp_eq_i32 vcc, -5, v14
    v_rcp_f32 v4, v4
    v_rcp_f32 v5, v5
    v_cndmask_b32 v223, 0, v15, vcc
    v_mad_u32_u24 v31, v31, 17, v1
    s_cmp_eq_u32 s6, 7
    s_cselect_b32 s16, s8, 0
    s_cselect_b32 s17, s9, 0
    s_cselect_b32 s18, s10, 0
    s_cselect_b32 s19, s11, 0
    s_cselect_b32 s20, s12, 0
    s_cselect_b32 s21, s13, 0
    s_cselect_b32 s22, s14, 0
    s_cselect_b32 s23, s15, 0
    s_cbranch_scc1 K1_J7
K1_J7_BACK:
    v_add_f32 v212, s20, v152
    v_fma_f32 v176, v208, s16, v212
    v_fma_f32 v177, v209, s16, v212
    v_fma_f32 v178, v210, s16, v212
    v_fma_f32 v179, v211, s16, v212
    s_nop 1
    s_waitcnt lgkmcnt(0)
    v_mfma_f32_16x16x32_bf16 v[240:243], a[224:227], v[136:139], v[176:179]
    s_mov_b32 s99, s76
    ds_read_b128 v[104:107], v2 offset:18432
    ds_read_b128 v[108:111], v2 offset:19456
    v_mfma_f32_16x16x32_bf16 v[240:243], a[228:231], v[168:171], v[240:243]
    v_exp_f32 v253, v253
    v_mfma_f32_16x16x32_bf16 v[240:243], a[232:235], v[200:203], v[240:243]
    v_exp_f32 v254, v254
    v_mfma_f32_16x16x32_bf16 v[240:243], a[236:239], v[232:235], v[240:243]
    v_exp_f32 v255, v255
    v_mfma_f32_16x16x32_bf16 a[4:7], v[96:99], v[72:75], a[4:7]
    s_add_u32 m0, s76, s75
    v_cvt_pk_bf16_f32 v94, v252, v253
    v_cvt_pk_bf16_f32 v95, v254, v255
    v_mfma_f32_16x16x32_bf16 a[4:7], v[100:103], v[76:79], a[4:7]
    s_mov_b32 s76, s60
    buffer_load_dwordx4 v1, s[36:39], s77 offen sc1 lds
    v_mfma_f32_16x16x32_bf16 a[8:11], v[96:99], v[80:83], a[8:11]
    s_mov_b32 s60, s82
    ds_read_b128 a[240:243], v2 offset:4096
    ds_read_b128 a[244:247], v2 offset:5120
    v_mfma_f32_16x16x32_bf16 a[8:11], v[100:103], v[84:87], a[8:11]
    s_mov_b32 s82, s95
    ds_read_b128 a[248:251], v2 offset:6144
    v_add_f32 v213, s21, v152
    v_mfma_f32_16x16x32_bf16 a[12:15], v[96:99], v[88:91], a[12:15]
    s_mov_b32 s95, s93
    ds_read_b128 a[252:255], v2 offset:7168
    v_fma_f32 v180, v208, s17, v213
    v_mfma_f32_16x16x32_bf16 a[12:15], v[100:103], v[92:95], a[12:15]
    s_mov_b32 s93, s99
    ds_read_b128 v[112:115], v2 offset:20480
    v_fma_f32 v181, v209, s17, v213
    v_mfma_f32_16x16x32_bf16 v[244:247], a[224:227], v[140:143], v[156:159]
    ds_read_b128 v[116:119], v2 offset:21504
    v_fma_f32 v182, v210, s17, v213
    v_mfma_f32_16x16x32_bf16 v[244:247], a[228:231], v[172:175], v[244:247]
    v_fma_f32 v183, v211, s17, v213
    ds_read_b128 v[120:123], v2 offset:22528
    v_mfma_f32_16x16x32_bf16 v[244:247], a[232:235], v[204:207], v[244:247]
    ds_read_b128 v[124:127], v2 offset:23552
    v_add_f32 v212, s22, v152
    v_mfma_f32_16x16x32_bf16 v[244:247], a[236:239], v[236:239], v[244:247]
    s_waitcnt lgkmcnt(4)
    buffer_load_dwordx4 v1, s[36:39], s77 offen offset:1024 sc1 lds
    v_mfma_f32_16x16x32_bf16 a[20:23], v[104:107], v[72:75], a[20:23]
    ds_read_b128 a[224:227], v2 offset:8192
    ds_read_b128 a[228:231], v2 offset:9216
    v_mfma_f32_16x16x32_bf16 a[20:23], v[108:111], v[76:79], a[20:23]
    ds_read_b128 a[232:235], v2 offset:10240
    v_fma_f32 v184, v208, s18, v212
    v_mfma_f32_16x16x32_bf16 a[24:27], v[104:107], v[80:83], a[24:27]
    ds_read_b128 a[236:239], v2 offset:11264
    v_fma_f32 v185, v209, s18, v212
    v_mfma_f32_16x16x32_bf16 a[24:27], v[108:111], v[84:87], a[24:27]
    ds_read_b128 v[96:99], v2 offset:24576
    v_fma_f32 v186, v210, s18, v212
    v_mfma_f32_16x16x32_bf16 a[28:31], v[104:107], v[88:91], a[28:31]
    ds_read_b128 v[100:103], v2 offset:25600
    v_fma_f32 v187, v211, s18, v212
    v_mfma_f32_16x16x32_bf16 a[28:31], v[108:111], v[92:95], a[28:31]
    v_exp_f32 v240, v240
    v_mfma_f32_16x16x32_bf16 v[248:251], a[240:243], v[136:139], v[180:183]
    v_exp_f32 v241, v241
    v_mfma_f32_16x16x32_bf16 v[248:251], a[244:247], v[168:171], v[248:251]
    v_exp_f32 v242, v242
    v_mfma_f32_16x16x32_bf16 v[248:251], a[248:251], v[200:203], v[248:251]
    buffer_load_dwordx4 v1, s[36:39], s77 offen offset:2048 sc1 lds
    v_mfma_f32_16x16x32_bf16 v[248:251], a[252:255], v[232:235], v[248:251]
    s_waitcnt lgkmcnt(0)
    v_exp_f32 v243, v243
    v_mfma_f32_16x16x32_bf16 a[36:39], v[112:115], v[72:75], a[36:39]
    v_cvt_pk_bf16_f32 v48, v240, v241
    v_cvt_pk_bf16_f32 v49, v242, v243
    v_mfma_f32_16x16x32_bf16 a[36:39], v[116:119], v[76:79], a[36:39]
    ds_read_b128 v[104:107], v2 offset:26624
    ds_read_b128 v[108:111], v2 offset:27648
    v_mfma_f32_16x16x32_bf16 a[40:43], v[112:115], v[80:83], a[40:43]
    v_exp_f32 v244, v244
    v_mfma_f32_16x16x32_bf16 a[40:43], v[116:119], v[84:87], a[40:43]
    v_exp_f32 v245, v245
    v_mfma_f32_16x16x32_bf16 a[44:47], v[112:115], v[88:91], a[44:47]
    v_exp_f32 v246, v246
    v_mfma_f32_16x16x32_bf16 a[44:47], v[116:119], v[92:95], a[44:47]
    s_waitcnt vmcnt(11)
    v_exp_f32 v247, v247
    v_mfma_f32_16x16x32_bf16 v[12:15], v[64:67], v[216:219], 0
    buffer_load_dwordx4 v1, s[36:39], s77 offen offset:3072 sc1 lds
    v_mfma_f32_16x16x32_bf16 v[16:19], v[68:71], v[216:219], 0
    v_cvt_pk_bf16_f32 v56, v244, v245
    v_cvt_pk_bf16_f32 v57, v246, v247
    v_mfma_f32_16x16x32_bf16 v[252:255], a[240:243], v[140:143], v[156:159]
    ds_read_b128 a[240:243], v2 offset:12288
    ds_read_b128 v[112:115], v2 offset:28672
    v_mfma_f32_16x16x32_bf16 v[252:255], a[244:247], v[172:175], v[252:255]
    v_cvt_pk_bf16_f32 v12, v12, v13
    v_cvt_pk_bf16_f32 v13, v14, v15
    v_mfma_f32_16x16x32_bf16 v[252:255], a[248:251], v[204:207], v[252:255]
    v_cvt_pk_bf16_f32 v14, v16, v17
    v_cvt_pk_bf16_f32 v15, v18, v19
    v_mfma_f32_16x16x32_bf16 v[252:255], a[252:255], v[236:239], v[252:255]
    buffer_store_dwordx4 v[12:15], v31, s[56:59], s63 offen offset:0 sc1
    v_mfma_f32_16x16x32_bf16 a[52:55], v[120:123], v[72:75], a[52:55]
    ds_read_b128 a[244:247], v2 offset:13312
    ds_read_b128 a[248:251], v2 offset:14336
    v_mfma_f32_16x16x32_bf16 a[52:55], v[124:127], v[76:79], a[52:55]
    ds_read_b128 a[252:255], v2 offset:15360
    v_add_f32 v213, s23, v152
    v_mfma_f32_16x16x32_bf16 a[56:59], v[120:123], v[80:83], a[56:59]
    s_add_u32 s100, s77, 4096
    ds_read_b128 v[116:119], v2 offset:29696
    v_fma_f32 v188, v208, s19, v213
    v_mfma_f32_16x16x32_bf16 a[56:59], v[124:127], v[84:87], a[56:59]
    s_add_u32 m0, m0, 4096
    v_exp_f32 v248, v248
    v_mfma_f32_16x16x32_bf16 a[60:63], v[120:123], v[88:91], a[60:63]
    buffer_load_dwordx4 v1, s[36:39], s100 offen sc1 lds
    v_mfma_f32_16x16x32_bf16 a[60:63], v[124:127], v[92:95], a[60:63]
    v_exp_f32 v249, v249
    v_mfma_f32_16x16x32_bf16 v[12:15], v[64:67], v[220:223], 0
    v_exp_f32 v250, v250
    v_mfma_f32_16x16x32_bf16 v[16:19], v[68:71], v[220:223], 0
    v_exp_f32 v251, v251
    v_mfma_f32_16x16x32_bf16 v[240:243], a[224:227], v[136:139], v[184:187]
    v_fma_f32 v189, v209, s19, v213
    v_fma_f32 v190, v210, s19, v213
    v_mfma_f32_16x16x32_bf16 v[240:243], a[228:231], v[168:171], v[240:243]
    v_fma_f32 v191, v211, s19, v213
    v_cvt_pk_bf16_f32 v12, v12, v13
    v_mfma_f32_16x16x32_bf16 v[240:243], a[232:235], v[200:203], v[240:243]
    v_cvt_pk_bf16_f32 v13, v14, v15
    v_cvt_pk_bf16_f32 v14, v16, v17
    v_mfma_f32_16x16x32_bf16 v[240:243], a[236:239], v[232:235], v[240:243]
    v_cvt_pk_bf16_f32 v15, v18, v19
    v_cvt_pk_bf16_f32 v50, v248, v249
    v_mfma_f32_16x16x32_bf16 a[148:151], v[96:99], v[72:75], a[148:151]
    buffer_load_dwordx4 v1, s[36:39], s100 offen offset:1024 sc1 lds
    v_mfma_f32_16x16x32_bf16 a[148:151], v[100:103], v[76:79], a[148:151]
    buffer_store_dwordx4 v[12:15], v31, s[56:59], s63 offen offset:1024 sc1
    v_mfma_f32_16x16x32_bf16 a[152:155], v[96:99], v[80:83], a[152:155]
    v_cvt_pk_bf16_f32 v51, v250, v251
    ds_read_b128 v[120:123], v2 offset:30720
    v_mfma_f32_16x16x32_bf16 a[152:155], v[100:103], v[84:87], a[152:155]
    ds_read_b128 v[124:127], v2 offset:31744
    v_add_u32 v2, s82, v1
    v_mfma_f32_16x16x32_bf16 a[156:159], v[96:99], v[88:91], a[156:159]
    v_exp_f32 v252, v252
    v_mfma_f32_16x16x32_bf16 a[156:159], v[100:103], v[92:95], a[156:159]
    v_exp_f32 v253, v253
    v_mfma_f32_16x16x32_bf16 v[12:15], v[20:23], v[216:219], 0
    v_exp_f32 v254, v254
    v_mfma_f32_16x16x32_bf16 v[16:19], v[24:27], v[216:219], 0
    v_exp_f32 v255, v255
    v_mfma_f32_16x16x32_bf16 v[244:247], a[224:227], v[140:143], v[156:159]
    buffer_load_dwordx4 v1, s[36:39], s100 offen offset:2048 sc1 lds
    v_mfma_f32_16x16x32_bf16 v[244:247], a[228:231], v[172:175], v[244:247]
    v_cvt_pk_bf16_f32 v58, v252, v253
    v_cvt_pk_bf16_f32 v59, v254, v255
    v_mfma_f32_16x16x32_bf16 v[244:247], a[232:235], v[204:207], v[244:247]
    v_cvt_pk_bf16_f32 v12, v12, v13
    v_cvt_pk_bf16_f32 v13, v14, v15
    v_mfma_f32_16x16x32_bf16 v[244:247], a[236:239], v[236:239], v[244:247]
    s_waitcnt lgkmcnt(0)
    v_cvt_pk_bf16_f32 v14, v16, v17
    v_cvt_pk_bf16_f32 v15, v18, v19
    v_mfma_f32_16x16x32_bf16 a[164:167], v[104:107], v[72:75], a[164:167]
    buffer_store_dwordx4 v[12:15], v31, s[56:59], s63 offen offset:512 sc1
    v_mfma_f32_16x16x32_bf16 a[164:167], v[108:111], v[76:79], a[164:167]
    v_exp_f32 v240, v240
    v_mfma_f32_16x16x32_bf16 a[168:171], v[104:107], v[80:83], a[168:171]
    v_exp_f32 v241, v241
    v_mfma_f32_16x16x32_bf16 a[168:171], v[108:111], v[84:87], a[168:171]
    v_exp_f32 v242, v242
    v_mfma_f32_16x16x32_bf16 a[172:175], v[104:107], v[88:91], a[172:175]
    v_exp_f32 v243, v243
    v_mfma_f32_16x16x32_bf16 a[172:175], v[108:111], v[92:95], a[172:175]
    buffer_load_dwordx4 v1, s[36:39], s100 offen offset:3072 sc1 lds
    v_mfma_f32_16x16x32_bf16 v[12:15], v[20:23], v[220:223], 0
    v_exp_f32 v244, v244
    v_mfma_f32_16x16x32_bf16 v[16:19], v[24:27], v[220:223], 0
    v_exp_f32 v245, v245
    v_mfma_f32_16x16x32_bf16 v[248:251], a[240:243], v[136:139], v[188:191]
    v_exp_f32 v246, v246
    v_mfma_f32_16x16x32_bf16 v[248:251], a[244:247], v[168:171], v[248:251]
    v_exp_f32 v247, v247
    v_mfma_f32_16x16x32_bf16 v[248:251], a[248:251], v[200:203], v[248:251]
    v_cvt_pk_bf16_f32 v12, v12, v13
    v_cvt_pk_bf16_f32 v13, v14, v15
    v_mfma_f32_16x16x32_bf16 v[248:251], a[252:255], v[232:235], v[248:251]
    v_cvt_pk_bf16_f32 v14, v16, v17
    v_cvt_pk_bf16_f32 v15, v18, v19
    v_mfma_f32_16x16x32_bf16 a[180:183], v[112:115], v[72:75], a[180:183]
    buffer_store_dwordx4 v[12:15], v31, s[56:59], s63 offen offset:1536 sc1
    v_mfma_f32_16x16x32_bf16 a[180:183], v[116:119], v[76:79], a[180:183]
    s_add_u32 s77, s77, 32768
    v_cvt_pk_bf16_f32 v52, v240, v241
    v_cvt_pk_bf16_f32 v53, v242, v243
    v_mfma_f32_16x16x32_bf16 a[184:187], v[112:115], v[80:83], a[184:187]
    v_exp_f32 v248, v248
    v_mfma_f32_16x16x32_bf16 a[184:187], v[116:119], v[84:87], a[184:187]
    v_exp_f32 v249, v249
    v_mfma_f32_16x16x32_bf16 a[188:191], v[112:115], v[88:91], a[188:191]
    v_exp_f32 v250, v250
    v_mfma_f32_16x16x32_bf16 a[188:191], v[116:119], v[92:95], a[188:191]
    v_exp_f32 v251, v251
    v_mfma_f32_16x16x32_bf16 v[12:15], v[144:147], v[216:219], 0
    v_cvt_pk_bf16_f32 v60, v244, v245
    v_cvt_pk_bf16_f32 v61, v246, v247
    v_mfma_f32_16x16x32_bf16 v[16:19], a[140:143], v[216:219], 0
    v_cvt_pk_bf16_f32 v54, v248, v249
    v_cvt_pk_bf16_f32 v55, v250, v251
    v_mfma_f32_16x16x32_bf16 v[252:255], a[240:243], v[140:143], v[156:159]
    v_accvgpr_read_b32 v6, a120
    v_accvgpr_read_b32 v7, a124
    v_mfma_f32_16x16x32_bf16 v[252:255], a[244:247], v[172:175], v[252:255]
    v_cvt_pk_bf16_f32 v12, v12, v13
    v_cvt_pk_bf16_f32 v13, v14, v15
    v_mfma_f32_16x16x32_bf16 v[252:255], a[248:251], v[204:207], v[252:255]
    v_cvt_pk_bf16_f32 v14, v16, v17
    v_cvt_pk_bf16_f32 v15, v18, v19
    v_mfma_f32_16x16x32_bf16 v[252:255], a[252:255], v[236:239], v[252:255]
    buffer_store_dwordx4 v[12:15], v1, s[56:59], s64 offen offset:0 sc1
    v_mfma_f32_16x16x32_bf16 a[196:199], v[120:123], v[72:75], a[196:199]
    v_cvt_pk_bf16_f32 v6, 0, v6
    v_cvt_pk_bf16_f32 v7, 0, v7
    v_mfma_f32_16x16x32_bf16 a[196:199], v[124:127], v[76:79], a[196:199]
    ds_bpermute_b32 v6, v8, v6
    ds_bpermute_b32 v7, v8, v7
    s_waitcnt vmcnt(8) lgkmcnt(0)
    s_barrier
    v_mfma_f32_16x16x32_bf16 a[200:203], v[120:123], v[80:83], a[200:203]
    ds_read_b128 a[224:227], v2 offset:0
    ds_read_b128 a[228:231], v2 offset:1024
    v_mfma_f32_16x16x32_bf16 a[200:203], v[124:127], v[84:87], a[200:203]
    ds_read_b128 a[232:235], v2 offset:2048
    v_mul_f32 v6, s98, v6
    v_mfma_f32_16x16x32_bf16 a[204:207], v[120:123], v[88:91], a[204:207]
    ds_read_b128 a[236:239], v2 offset:3072
    v_mul_f32 v7, s98, v7
    v_mfma_f32_16x16x32_bf16 a[204:207], v[124:127], v[92:95], a[204:207]
    ds_read_b128 v[96:99], v2 offset:16384
    v_mfma_f32_16x16x32_bf16 v[12:15], v[144:147], v[220:223], 0
    ds_read_b128 v[100:103], v2 offset:17408
    v_mfma_f32_16x16x32_bf16 v[16:19], a[140:143], v[220:223], 0
    v_exp_f32 v252, v252
    v_smfmac_f32_16x16x64_bf16 a[212:215], a[136:139], v[72:79], v215
    v_exp_f32 v6, v6
    v_smfmac_f32_16x16x64_bf16 a[216:219], a[136:139], v[80:87], v215
    v_exp_f32 v7, v7
    v_smfmac_f32_16x16x64_bf16 a[220:223], a[136:139], v[88:95], v215
    v_cvt_pk_bf16_f32 v12, v12, v13
    v_cvt_pk_bf16_f32 v13, v14, v15
    v_add_f32 v6, 1.0, v6
    v_add_f32 v7, 1.0, v7
    v_cvt_pk_bf16_f32 v14, v16, v17
    v_cvt_pk_bf16_f32 v15, v18, v19
    v_rcp_f32 v6, v6
    v_rcp_f32 v7, v7
    buffer_store_dwordx4 v[12:15], v1, s[56:59], s62 offen offset:0 sc1
    s_nop 1
    v_accvgpr_read_b32 v9, a208
    v_accvgpr_read_b32 v10, a209
    v_add_f32 v9, v9, v10
    v_cmp_nge_f32 vcc, 0x5f800000, v9
    v_rcp_f32 v10, v9
    s_nop 0
    s_or_b64 s[84:85], s[84:85], vcc
    v_mul_f32 v10, v10, v4
    v_accvgpr_read_b32 v12, a0
    v_accvgpr_read_b32 v13, a1
    v_accvgpr_read_b32 v14, a2
    v_accvgpr_read_b32 v15, a3
    v_accvgpr_read_b32 v16, a16
    v_accvgpr_read_b32 v17, a17
    v_accvgpr_read_b32 v18, a18
    v_accvgpr_read_b32 v19, a19
    v_pk_mul_f32 v[12:13], v[12:13], v[10:11] op_sel_hi:[1,0]
    v_pk_mul_f32 v[14:15], v[14:15], v[10:11] op_sel_hi:[1,0]
    v_pk_mul_f32 v[16:17], v[16:17], v[10:11] op_sel_hi:[1,0]
    v_pk_mul_f32 v[18:19], v[18:19], v[10:11] op_sel_hi:[1,0]
    v_cvt_pk_bf16_f32 v12, v12, v13
    v_cvt_pk_bf16_f32 v13, v14, v15
    v_cvt_pk_bf16_f32 v14, v16, v17
    v_cvt_pk_bf16_f32 v15, v18, v19
    buffer_store_dwordx4 v[12:15], v1, s[40:43], s80 offen offset:0 sc1
    v_accvgpr_read_b32 v20, a32
    v_accvgpr_read_b32 v21, a33
    v_accvgpr_read_b32 v22, a34
    v_accvgpr_read_b32 v23, a35
    v_accvgpr_read_b32 v24, a48
    v_accvgpr_read_b32 v25, a49
    v_accvgpr_read_b32 v26, a50
    v_accvgpr_read_b32 v27, a51
    v_pk_mul_f32 v[20:21], v[20:21], v[10:11] op_sel_hi:[1,0]
    v_pk_mul_f32 v[22:23], v[22:23], v[10:11] op_sel_hi:[1,0]
    v_pk_mul_f32 v[24:25], v[24:25], v[10:11] op_sel_hi:[1,0]
    v_pk_mul_f32 v[26:27], v[26:27], v[10:11] op_sel_hi:[1,0]
    v_cvt_pk_bf16_f32 v20, v20, v21
    v_cvt_pk_bf16_f32 v21, v22, v23
    v_cvt_pk_bf16_f32 v22, v24, v25
    v_cvt_pk_bf16_f32 v23, v26, v27
    buffer_store_dwordx4 v[20:23], v1, s[40:43], s80 offen offset:1024 sc1
    v_accvgpr_read_b32 v12, a144
    v_accvgpr_read_b32 v13, a145
    v_accvgpr_read_b32 v14, a146
    v_accvgpr_read_b32 v15, a147
    v_accvgpr_read_b32 v16, a160
    v_accvgpr_read_b32 v17, a161
    v_accvgpr_read_b32 v18, a162
    v_accvgpr_read_b32 v19, a163
    v_pk_mul_f32 v[12:13], v[12:13], v[10:11] op_sel_hi:[1,0]
    v_pk_mul_f32 v[14:15], v[14:15], v[10:11] op_sel_hi:[1,0]
    v_pk_mul_f32 v[16:17], v[16:17], v[10:11] op_sel_hi:[1,0]
    v_pk_mul_f32 v[18:19], v[18:19], v[10:11] op_sel_hi:[1,0]
    v_cvt_pk_bf16_f32 v12, v12, v13
    v_cvt_pk_bf16_f32 v13, v14, v15
    v_cvt_pk_bf16_f32 v14, v16, v17
    v_cvt_pk_bf16_f32 v15, v18, v19
    buffer_store_dwordx4 v[12:15], v1, s[40:43], s80 offen offset:2048 sc1
    v_accvgpr_read_b32 v20, a176
    v_accvgpr_read_b32 v21, a177
    v_accvgpr_read_b32 v22, a178
    v_accvgpr_read_b32 v23, a179
    v_accvgpr_read_b32 v24, a192
    v_accvgpr_read_b32 v25, a193
    v_accvgpr_read_b32 v26, a194
    v_accvgpr_read_b32 v27, a195
    v_pk_mul_f32 v[20:21], v[20:21], v[10:11] op_sel_hi:[1,0]
    v_pk_mul_f32 v[22:23], v[22:23], v[10:11] op_sel_hi:[1,0]
    v_pk_mul_f32 v[24:25], v[24:25], v[10:11] op_sel_hi:[1,0]
    v_pk_mul_f32 v[26:27], v[26:27], v[10:11] op_sel_hi:[1,0]
    v_cvt_pk_bf16_f32 v20, v20, v21
    v_cvt_pk_bf16_f32 v21, v22, v23
    v_cvt_pk_bf16_f32 v22, v24, v25
    v_cvt_pk_bf16_f32 v23, v26, v27
    buffer_store_dwordx4 v[20:23], v1, s[40:43], s80 offen offset:3072 sc1
    v_accvgpr_read_b32 v9, a212
    v_accvgpr_read_b32 v10, a213
    v_add_f32 v9, v9, v10
    v_cmp_nge_f32 vcc, 0x5f800000, v9
    v_rcp_f32 v10, v9
    s_nop 0
    s_or_b64 s[84:85], s[84:85], vcc
    v_mul_f32 v10, v10, v5
    s_add_u32 s72, s80, 622592
    v_accvgpr_read_b32 v12, a4
    v_accvgpr_read_b32 v13, a5
    v_accvgpr_read_b32 v14, a6
    v_accvgpr_read_b32 v15, a7
    v_accvgpr_read_b32 v16, a20
    v_accvgpr_read_b32 v17, a21
    v_accvgpr_read_b32 v18, a22
    v_accvgpr_read_b32 v19, a23
    v_pk_mul_f32 v[12:13], v[12:13], v[10:11] op_sel_hi:[1,0]
    v_pk_mul_f32 v[14:15], v[14:15], v[10:11] op_sel_hi:[1,0]
    v_pk_mul_f32 v[16:17], v[16:17], v[10:11] op_sel_hi:[1,0]
    v_pk_mul_f32 v[18:19], v[18:19], v[10:11] op_sel_hi:[1,0]
    v_cvt_pk_bf16_f32 v12, v12, v13
    v_cvt_pk_bf16_f32 v13, v14, v15
    v_cvt_pk_bf16_f32 v14, v16, v17
    v_cvt_pk_bf16_f32 v15, v18, v19
    buffer_store_dwordx4 v[12:15], v1, s[40:43], s72 offen offset:0 sc1
    v_accvgpr_read_b32 v20, a36
    v_accvgpr_read_b32 v21, a37
    v_accvgpr_read_b32 v22, a38
    v_accvgpr_read_b32 v23, a39
    v_accvgpr_read_b32 v24, a52
    v_accvgpr_read_b32 v25, a53
    v_accvgpr_read_b32 v26, a54
    v_accvgpr_read_b32 v27, a55
    v_pk_mul_f32 v[20:21], v[20:21], v[10:11] op_sel_hi:[1,0]
    v_pk_mul_f32 v[22:23], v[22:23], v[10:11] op_sel_hi:[1,0]
    v_pk_mul_f32 v[24:25], v[24:25], v[10:11] op_sel_hi:[1,0]
    v_pk_mul_f32 v[26:27], v[26:27], v[10:11] op_sel_hi:[1,0]
    v_cvt_pk_bf16_f32 v20, v20, v21
    v_cvt_pk_bf16_f32 v21, v22, v23
    v_cvt_pk_bf16_f32 v22, v24, v25
    v_cvt_pk_bf16_f32 v23, v26, v27
    buffer_store_dwordx4 v[20:23], v1, s[40:43], s72 offen offset:1024 sc1
    v_accvgpr_read_b32 v12, a148
    v_accvgpr_read_b32 v13, a149
    v_accvgpr_read_b32 v14, a150
    v_accvgpr_read_b32 v15, a151
    v_accvgpr_read_b32 v16, a164
    v_accvgpr_read_b32 v17, a165
    v_accvgpr_read_b32 v18, a166
    v_accvgpr_read_b32 v19, a167
    v_pk_mul_f32 v[12:13], v[12:13], v[10:11] op_sel_hi:[1,0]
    v_pk_mul_f32 v[14:15], v[14:15], v[10:11] op_sel_hi:[1,0]
    v_pk_mul_f32 v[16:17], v[16:17], v[10:11] op_sel_hi:[1,0]
    v_pk_mul_f32 v[18:19], v[18:19], v[10:11] op_sel_hi:[1,0]
    v_cvt_pk_bf16_f32 v12, v12, v13
    v_cvt_pk_bf16_f32 v13, v14, v15
    v_cvt_pk_bf16_f32 v14, v16, v17
    v_cvt_pk_bf16_f32 v15, v18, v19
    buffer_store_dwordx4 v[12:15], v1, s[40:43], s72 offen offset:2048 sc1
    v_accvgpr_read_b32 v20, a180
    v_accvgpr_read_b32 v21, a181
    v_accvgpr_read_b32 v22, a182
    v_accvgpr_read_b32 v23, a183
    v_accvgpr_read_b32 v24, a196
    v_accvgpr_read_b32 v25, a197
    v_accvgpr_read_b32 v26, a198
    v_accvgpr_read_b32 v27, a199
    v_pk_mul_f32 v[20:21], v[20:21], v[10:11] op_sel_hi:[1,0]
    v_pk_mul_f32 v[22:23], v[22:23], v[10:11] op_sel_hi:[1,0]
    v_pk_mul_f32 v[24:25], v[24:25], v[10:11] op_sel_hi:[1,0]
    v_pk_mul_f32 v[26:27], v[26:27], v[10:11] op_sel_hi:[1,0]
    v_cvt_pk_bf16_f32 v20, v20, v21
    v_cvt_pk_bf16_f32 v21, v22, v23
    v_cvt_pk_bf16_f32 v22, v24, v25
    v_cvt_pk_bf16_f32 v23, v26, v27
    buffer_store_dwordx4 v[20:23], v1, s[40:43], s72 offen offset:3072 sc1
    v_mov_b32 v9, 1
    v_lshlrev_b32 v216, 20, v1
    s_lshl2_add_u32 s7, s4, s101
    s_add_u32 s7, s7, 163840
    s_waitcnt vmcnt(8)
    buffer_store_dword v9, v216, s[32:35], s7 offen sc1
    s_sub_u32 s78, 14, s6
    s_sub_u32 s78, s78, s6
    s_cmp_eq_u32 s78, 0
    s_cbranch_scc1 K1_LS_END
.p2align 3
K1_LS:
    s_waitcnt lgkmcnt(0)
    v_mfma_f32_16x16x32_bf16 v[240:243], a[224:227], v[136:139], v[176:179]
    s_mov_b32 s99, s76
    ds_read_b128 v[104:107], v2 offset:18432
    ds_read_b128 v[108:111], v2 offset:19456
    v_mfma_f32_16x16x32_bf16 v[240:243], a[228:231], v[168:171], v[240:243]
    v_exp_f32 v253, v253
    v_mfma_f32_16x16x32_bf16 v[240:243], a[232:235], v[200:203], v[240:243]
    v_exp_f32 v254, v254
    v_mfma_f32_16x16x32_bf16 v[240:243], a[236:239], v[232:235], v[240:243]
    v_exp_f32 v255, v255
    v_mfma_f32_16x16x32_bf16 a[8:11], v[96:99], v[48:51], a[8:11]
    s_add_u32 m0, s76, s75
    v_cvt_pk_bf16_f32 v62, v252, v253
    v_cvt_pk_bf16_f32 v63, v254, v255
    v_mfma_f32_16x16x32_bf16 a[8:11], v[100:103], v[52:55], a[8:11]
    s_mov_b32 s76, s60
    ds_read_b128 a[240:243], v2 offset:4096
    ds_read_b128 a[244:247], v2 offset:5120
    v_mfma_f32_16x16x32_bf16 a[12:15], v[96:99], v[56:59], a[12:15]
    s_mov_b32 s60, s82
    buffer_load_dwordx4 v1, s[36:39], s77 offen sc1 lds
    v_mfma_f32_16x16x32_bf16 a[12:15], v[100:103], v[60:63], a[12:15]
    s_mov_b32 s82, s95
    ds_read_b128 a[248:251], v2 offset:6144
    ds_read_b128 a[252:255], v2 offset:7168
    v_mfma_f32_16x16x32_bf16 v[244:247], a[224:227], v[140:143], v[156:159]
    s_mov_b32 s95, s93
    v_exp_f32 v240, v240
    v_mfma_f32_16x16x32_bf16 v[244:247], a[228:231], v[172:175], v[244:247]
    s_mov_b32 s93, s99
    ds_read_b128 v[112:115], v2 offset:20480
    ds_read_b128 v[116:119], v2 offset:21504
    v_mfma_f32_16x16x32_bf16 v[244:247], a[232:235], v[204:207], v[244:247]
    buffer_load_dwordx4 v1, s[36:39], s77 offen offset:1024 sc1 lds
    v_mfma_f32_16x16x32_bf16 v[244:247], a[236:239], v[236:239], v[244:247]
    s_waitcnt lgkmcnt(6)
    v_exp_f32 v241, v241
    v_mfma_f32_16x16x32_bf16 a[24:27], v[104:107], v[48:51], a[24:27]
    v_exp_f32 v242, v242
    v_mfma_f32_16x16x32_bf16 a[24:27], v[108:111], v[52:55], a[24:27]
    v_exp_f32 v243, v243
    v_mfma_f32_16x16x32_bf16 a[28:31], v[104:107], v[56:59], a[28:31]
    buffer_load_dwordx4 v1, s[36:39], s77 offen offset:2048 sc1 lds
    v_mfma_f32_16x16x32_bf16 a[28:31], v[108:111], v[60:63], a[28:31]
    s_waitcnt lgkmcnt(2)
    ds_read_b128 v[120:123], v2 offset:22528
    ds_read_b128 v[124:127], v2 offset:23552
    v_mfma_f32_16x16x32_bf16 v[248:251], a[240:243], v[136:139], v[180:183]
    v_cvt_pk_bf16_f32 v80, v240, v241
    v_cvt_pk_bf16_f32 v81, v242, v243
    v_mfma_f32_16x16x32_bf16 v[248:251], a[244:247], v[168:171], v[248:251]
    v_exp_f32 v244, v244
    v_mfma_f32_16x16x32_bf16 v[248:251], a[248:251], v[200:203], v[248:251]
    buffer_load_dwordx4 v1, s[36:39], s77 offen offset:3072 sc1 lds
    v_mfma_f32_16x16x32_bf16 v[248:251], a[252:255], v[232:235], v[248:251]
    s_waitcnt lgkmcnt(2)
    ds_read_b128 a[224:227], v2 offset:8192
    ds_read_b128 a[228:231], v2 offset:9216
    v_mfma_f32_16x16x32_bf16 a[40:43], v[112:115], v[48:51], a[40:43]
    v_exp_f32 v245, v245
    v_mfma_f32_16x16x32_bf16 a[40:43], v[116:119], v[52:55], a[40:43]
    ds_read_b128 a[232:235], v2 offset:10240
    ds_read_b128 a[236:239], v2 offset:11264
    v_mfma_f32_16x16x32_bf16 a[44:47], v[112:115], v[56:59], a[44:47]
    s_add_u32 s100, s77, 4096
    ds_read_b128 v[96:99], v2 offset:24576
    v_cvt_pk_bf16_f32 v88, v244, v245
    v_mfma_f32_16x16x32_bf16 a[44:47], v[116:119], v[60:63], a[44:47]
    s_add_u32 m0, m0, 4096
    v_exp_f32 v246, v246
    v_mfma_f32_16x16x32_bf16 v[252:255], a[240:243], v[140:143], v[156:159]
    buffer_load_dwordx4 v1, s[36:39], s100 offen sc1 lds
    v_mfma_f32_16x16x32_bf16 v[252:255], a[244:247], v[172:175], v[252:255]
    v_exp_f32 v247, v247
    v_mfma_f32_16x16x32_bf16 v[252:255], a[248:251], v[204:207], v[252:255]
    ds_read_b128 v[100:103], v2 offset:25600
    v_cvt_pk_bf16_f32 v89, v246, v247
    v_mfma_f32_16x16x32_bf16 v[252:255], a[252:255], v[236:239], v[252:255]
    s_waitcnt lgkmcnt(4)
    buffer_load_dwordx4 v1, s[36:39], s100 offen offset:1024 sc1 lds
    v_mfma_f32_16x16x32_bf16 a[56:59], v[120:123], v[48:51], a[56:59]
    v_exp_f32 v248, v248
    v_mfma_f32_16x16x32_bf16 a[56:59], v[124:127], v[52:55], a[56:59]
    v_exp_f32 v249, v249
    v_mfma_f32_16x16x32_bf16 a[60:63], v[120:123], v[56:59], a[60:63]
    ds_read_b128 v[104:107], v2 offset:26624
    ds_read_b128 v[108:111], v2 offset:27648
    v_mfma_f32_16x16x32_bf16 a[60:63], v[124:127], v[60:63], a[60:63]
    v_exp_f32 v250, v250
    v_mfma_f32_16x16x32_bf16 v[240:243], a[224:227], v[136:139], v[184:187]
    buffer_load_dwordx4 v1, s[36:39], s100 offen offset:2048 sc1 lds
    v_mfma_f32_16x16x32_bf16 v[240:243], a[228:231], v[168:171], v[240:243]
    s_waitcnt lgkmcnt(2)
    v_exp_f32 v251, v251
    v_mfma_f32_16x16x32_bf16 v[240:243], a[232:235], v[200:203], v[240:243]
    ds_read_b128 a[240:243], v2 offset:12288
    ds_read_b128 a[244:247], v2 offset:13312
    v_mfma_f32_16x16x32_bf16 v[240:243], a[236:239], v[232:235], v[240:243]
    ds_read_b128 a[248:251], v2 offset:14336
    v_cvt_pk_bf16_f32 v82, v248, v249
    v_mfma_f32_16x16x32_bf16 a[152:155], v[96:99], v[48:51], a[152:155]
    buffer_load_dwordx4 v1, s[36:39], s100 offen offset:3072 sc1 lds
    v_mfma_f32_16x16x32_bf16 a[152:155], v[100:103], v[52:55], a[152:155]
    ds_read_b128 a[252:255], v2 offset:15360
    v_cvt_pk_bf16_f32 v83, v250, v251
    v_mfma_f32_16x16x32_bf16 a[156:159], v[96:99], v[56:59], a[156:159]
    ds_read_b128 v[112:115], v2 offset:28672
    ds_read_b128 v[116:119], v2 offset:29696
    v_mfma_f32_16x16x32_bf16 a[156:159], v[100:103], v[60:63], a[156:159]
    v_exp_f32 v252, v252
    v_mfma_f32_16x16x32_bf16 v[244:247], a[224:227], v[140:143], v[156:159]
    s_add_u32 s77, s77, 32768
    v_exp_f32 v253, v253
    v_mfma_f32_16x16x32_bf16 v[244:247], a[228:231], v[172:175], v[244:247]
    v_exp_f32 v254, v254
    v_mfma_f32_16x16x32_bf16 v[244:247], a[232:235], v[204:207], v[244:247]
    v_exp_f32 v255, v255
    v_mfma_f32_16x16x32_bf16 v[244:247], a[236:239], v[236:239], v[244:247]
    s_waitcnt lgkmcnt(3)
    v_cvt_pk_bf16_f32 v90, v252, v253
    v_cvt_pk_bf16_f32 v91, v254, v255
    v_mfma_f32_16x16x32_bf16 a[168:171], v[104:107], v[48:51], a[168:171]
    v_exp_f32 v240, v240
    v_mfma_f32_16x16x32_bf16 a[168:171], v[108:111], v[52:55], a[168:171]
    v_exp_f32 v241, v241
    v_mfma_f32_16x16x32_bf16 a[172:175], v[104:107], v[56:59], a[172:175]
    ds_read_b128 v[120:123], v2 offset:30720
    ds_read_b128 v[124:127], v2 offset:31744
    v_mfma_f32_16x16x32_bf16 a[172:175], v[108:111], v[60:63], a[172:175]
    v_add_u32 v2, s82, v1
    v_cvt_pk_bf16_f32 v84, v240, v241
    v_mfma_f32_16x16x32_bf16 v[248:251], a[240:243], v[136:139], v[188:191]
    v_exp_f32 v242, v242
    v_mfma_f32_16x16x32_bf16 v[248:251], a[244:247], v[168:171], v[248:251]
    v_exp_f32 v243, v243
    v_mfma_f32_16x16x32_bf16 v[248:251], a[248:251], v[200:203], v[248:251]
    s_waitcnt lgkmcnt(2)
    v_exp_f32 v244, v244
    v_mfma_f32_16x16x32_bf16 v[248:251], a[252:255], v[232:235], v[248:251]
    v_exp_f32 v245, v245
    v_mfma_f32_16x16x32_bf16 a[184:187], v[112:115], v[48:51], a[184:187]
    ds_read_b128 a[224:227], v2 offset:0
    ds_read_b128 a[228:231], v2 offset:1024
    v_mfma_f32_16x16x32_bf16 a[184:187], v[116:119], v[52:55], a[184:187]
    ds_read_b128 a[232:235], v2 offset:2048
    v_cvt_pk_bf16_f32 v85, v242, v243
    v_mfma_f32_16x16x32_bf16 a[188:191], v[112:115], v[56:59], a[188:191]
    ds_read_b128 a[236:239], v2 offset:3072
    v_cvt_pk_bf16_f32 v92, v244, v245
    v_mfma_f32_16x16x32_bf16 a[188:191], v[116:119], v[60:63], a[188:191]
    v_exp_f32 v246, v246
    v_mfma_f32_16x16x32_bf16 v[252:255], a[240:243], v[140:143], v[156:159]
    ds_read_b128 v[96:99], v2 offset:16384
    ds_read_b128 v[100:103], v2 offset:17408
    v_mfma_f32_16x16x32_bf16 v[252:255], a[244:247], v[172:175], v[252:255]
    v_exp_f32 v247, v247
    v_mfma_f32_16x16x32_bf16 v[252:255], a[248:251], v[204:207], v[252:255]
    v_exp_f32 v248, v248
    v_mfma_f32_16x16x32_bf16 v[252:255], a[252:255], v[236:239], v[252:255]
    s_waitcnt lgkmcnt(4)
    v_exp_f32 v249, v249
    v_mfma_f32_16x16x32_bf16 a[200:203], v[120:123], v[48:51], a[200:203]
    v_exp_f32 v250, v250
    v_mfma_f32_16x16x32_bf16 a[200:203], v[124:127], v[52:55], a[200:203]
    v_exp_f32 v251, v251
    v_mfma_f32_16x16x32_bf16 a[204:207], v[120:123], v[56:59], a[204:207]
    v_cvt_pk_bf16_f32 v93, v246, v247
    v_cvt_pk_bf16_f32 v86, v248, v249
    v_mfma_f32_16x16x32_bf16 a[204:207], v[124:127], v[60:63], a[204:207]
    v_exp_f32 v252, v252
    v_smfmac_f32_16x16x64_bf16 a[216:219], a[136:139], v[48:55], v215
    s_cmp_le_u32 s78, 2
    v_cvt_pk_bf16_f32 v87, v250, v251
    v_smfmac_f32_16x16x64_bf16 a[220:223], a[136:139], v[56:63], v215
    s_cbranch_scc1 K1_LS_MASK
K1_LS_BACK:
    s_waitcnt lgkmcnt(0)
    v_mfma_f32_16x16x32_bf16 v[240:243], a[224:227], v[136:139], v[176:179]
    s_mov_b32 s99, s76
    ds_read_b128 v[104:107], v2 offset:18432
    ds_read_b128 v[108:111], v2 offset:19456
    v_mfma_f32_16x16x32_bf16 v[240:243], a[228:231], v[168:171], v[240:243]
    v_exp_f32 v253, v253
    v_mfma_f32_16x16x32_bf16 v[240:243], a[232:235], v[200:203], v[240:243]
    v_exp_f32 v254, v254
    v_mfma_f32_16x16x32_bf16 v[240:243], a[236:239], v[232:235], v[240:243]
    v_exp_f32 v255, v255
    v_mfma_f32_16x16x32_bf16 a[8:11], v[96:99], v[80:83], a[8:11]
    s_add_u32 m0, s76, s75
    v_cvt_pk_bf16_f32 v94, v252, v253
    v_cvt_pk_bf16_f32 v95, v254, v255
    v_mfma_f32_16x16x32_bf16 a[8:11], v[100:103], v[84:87], a[8:11]
    s_mov_b32 s76, s60
    ds_read_b128 a[240:243], v2 offset:4096
    ds_read_b128 a[244:247], v2 offset:5120
    v_mfma_f32_16x16x32_bf16 a[12:15], v[96:99], v[88:91], a[12:15]
    s_mov_b32 s60, s82
    buffer_load_dwordx4 v1, s[36:39], s77 offen sc1 lds
    v_mfma_f32_16x16x32_bf16 a[12:15], v[100:103], v[92:95], a[12:15]
    s_mov_b32 s82, s95
    ds_read_b128 a[248:251], v2 offset:6144
    ds_read_b128 a[252:255], v2 offset:7168
    v_mfma_f32_16x16x32_bf16 v[244:247], a[224:227], v[140:143], v[156:159]
    s_mov_b32 s95, s93
    v_exp_f32 v240, v240
    v_mfma_f32_16x16x32_bf16 v[244:247], a[228:231], v[172:175], v[244:247]
    s_mov_b32 s93, s99
    ds_read_b128 v[112:115], v2 offset:20480
    ds_read_b128 v[116:119], v2 offset:21504
    v_mfma_f32_16x16x32_bf16 v[244:247], a[232:235], v[204:207], v[244:247]
    buffer_load_dwordx4 v1, s[36:39], s77 offen offset:1024 sc1 lds
    v_mfma_f32_16x16x32_bf16 v[244:247], a[236:239], v[236:239], v[244:247]
    s_waitcnt lgkmcnt(6)
    v_exp_f32 v241, v241
    v_mfma_f32_16x16x32_bf16 a[24:27], v[104:107], v[80:83], a[24:27]
    v_exp_f32 v242, v242
    v_mfma_f32_16x16x32_bf16 a[24:27], v[108:111], v[84:87], a[24:27]
    v_exp_f32 v243, v243
    v_mfma_f32_16x16x32_bf16 a[28:31], v[104:107], v[88:91], a[28:31]
    buffer_load_dwordx4 v1, s[36:39], s77 offen offset:2048 sc1 lds
    v_mfma_f32_16x16x32_bf16 a[28:31], v[108:111], v[92:95], a[28:31]
    s_waitcnt lgkmcnt(2)
    ds_read_b128 v[120:123], v2 offset:22528
    ds_read_b128 v[124:127], v2 offset:23552
    v_mfma_f32_16x16x32_bf16 v[248:251], a[240:243], v[136:139], v[180:183]
    v_cvt_pk_bf16_f32 v48, v240, v241
    v_cvt_pk_bf16_f32 v49, v242, v243
    v_mfma_f32_16x16x32_bf16 v[248:251], a[244:247], v[168:171], v[248:251]
    v_exp_f32 v244, v244
    v_mfma_f32_16x16x32_bf16 v[248:251], a[248:251], v[200:203], v[248:251]
    buffer_load_dwordx4 v1, s[36:39], s77 offen offset:3072 sc1 lds
    v_mfma_f32_16x16x32_bf16 v[248:251], a[252:255], v[232:235], v[248:251]
    s_waitcnt lgkmcnt(2)
    ds_read_b128 a[224:227], v2 offset:8192
    ds_read_b128 a[228:231], v2 offset:9216
    v_mfma_f32_16x16x32_bf16 a[40:43], v[112:115], v[80:83], a[40:43]
    v_exp_f32 v245, v245
    v_mfma_f32_16x16x32_bf16 a[40:43], v[116:119], v[84:87], a[40:43]
    ds_read_b128 a[232:235], v2 offset:10240
    ds_read_b128 a[236:239], v2 offset:11264
    v_mfma_f32_16x16x32_bf16 a[44:47], v[112:115], v[88:91], a[44:47]
    s_add_u32 s100, s77, 4096
    ds_read_b128 v[96:99], v2 offset:24576
    v_cvt_pk_bf16_f32 v56, v244, v245
    v_mfma_f32_16x16x32_bf16 a[44:47], v[116:119], v[92:95], a[44:47]
    s_add_u32 m0, m0, 4096
    v_exp_f32 v246, v246
    v_mfma_f32_16x16x32_bf16 v[252:255], a[240:243], v[140:143], v[156:159]
    buffer_load_dwordx4 v1, s[36:39], s100 offen sc1 lds
    v_mfma_f32_16x16x32_bf16 v[252:255], a[244:247], v[172:175], v[252:255]
    v_exp_f32 v247, v247
    v_mfma_f32_16x16x32_bf16 v[252:255], a[248:251], v[204:207], v[252:255]
    ds_read_b128 v[100:103], v2 offset:25600
    v_cvt_pk_bf16_f32 v57, v246, v247
    v_mfma_f32_16x16x32_bf16 v[252:255], a[252:255], v[236:239], v[252:255]
    s_waitcnt lgkmcnt(4)
    buffer_load_dwordx4 v1, s[36:39], s100 offen offset:1024 sc1 lds
    v_mfma_f32_16x16x32_bf16 a[56:59], v[120:123], v[80:83], a[56:59]
    v_exp_f32 v248, v248
    v_mfma_f32_16x16x32_bf16 a[56:59], v[124:127], v[84:87], a[56:59]
    v_exp_f32 v249, v249
    v_mfma_f32_16x16x32_bf16 a[60:63], v[120:123], v[88:91], a[60:63]
    ds_read_b128 v[104:107], v2 offset:26624
    ds_read_b128 v[108:111], v2 offset:27648
    v_mfma_f32_16x16x32_bf16 a[60:63], v[124:127], v[92:95], a[60:63]
    v_exp_f32 v250, v250
    v_mfma_f32_16x16x32_bf16 v[240:243], a[224:227], v[136:139], v[184:187]
    buffer_load_dwordx4 v1, s[36:39], s100 offen offset:2048 sc1 lds
    v_mfma_f32_16x16x32_bf16 v[240:243], a[228:231], v[168:171], v[240:243]
    s_waitcnt lgkmcnt(2)
    v_exp_f32 v251, v251
    v_mfma_f32_16x16x32_bf16 v[240:243], a[232:235], v[200:203], v[240:243]
    ds_read_b128 a[240:243], v2 offset:12288
    ds_read_b128 a[244:247], v2 offset:13312
    v_mfma_f32_16x16x32_bf16 v[240:243], a[236:239], v[232:235], v[240:243]
    ds_read_b128 a[248:251], v2 offset:14336
    v_cvt_pk_bf16_f32 v50, v248, v249
    v_mfma_f32_16x16x32_bf16 a[152:155], v[96:99], v[80:83], a[152:155]
    buffer_load_dwordx4 v1, s[36:39], s100 offen offset:3072 sc1 lds
    v_mfma_f32_16x16x32_bf16 a[152:155], v[100:103], v[84:87], a[152:155]
    ds_read_b128 a[252:255], v2 offset:15360
    v_cvt_pk_bf16_f32 v51, v250, v251
    v_mfma_f32_16x16x32_bf16 a[156:159], v[96:99], v[88:91], a[156:159]
    ds_read_b128 v[112:115], v2 offset:28672
    ds_read_b128 v[116:119], v2 offset:29696
    v_mfma_f32_16x16x32_bf16 a[156:159], v[100:103], v[92:95], a[156:159]
    v_exp_f32 v252, v252
    v_mfma_f32_16x16x32_bf16 v[244:247], a[224:227], v[140:143], v[156:159]
    s_add_u32 s77, s77, 32768
    v_exp_f32 v253, v253
    v_mfma_f32_16x16x32_bf16 v[244:247], a[228:231], v[172:175], v[244:247]
    ds_read_b128 v[120:123], v2 offset:30720
    ds_read_b128 v[124:127], v2 offset:31744
    v_mfma_f32_16x16x32_bf16 v[244:247], a[232:235], v[204:207], v[244:247]
    v_add_u32 v2, s82, v1
    v_cvt_pk_bf16_f32 v58, v252, v253
    v_mfma_f32_16x16x32_bf16 v[244:247], a[236:239], v[236:239], v[244:247]
    s_waitcnt lgkmcnt(5)
    v_exp_f32 v254, v254
    v_mfma_f32_16x16x32_bf16 a[168:171], v[104:107], v[80:83], a[168:171]
    v_exp_f32 v255, v255
    v_mfma_f32_16x16x32_bf16 a[168:171], v[108:111], v[84:87], a[168:171]
    v_exp_f32 v240, v240
    v_mfma_f32_16x16x32_bf16 a[172:175], v[104:107], v[88:91], a[172:175]
    v_exp_f32 v241, v241
    v_mfma_f32_16x16x32_bf16 a[172:175], v[108:111], v[92:95], a[172:175]
    v_cvt_pk_bf16_f32 v59, v254, v255
    v_cvt_pk_bf16_f32 v52, v240, v241
    v_mfma_f32_16x16x32_bf16 v[248:251], a[240:243], v[136:139], v[188:191]
    v_exp_f32 v242, v242
    v_mfma_f32_16x16x32_bf16 v[248:251], a[244:247], v[168:171], v[248:251]
    v_exp_f32 v243, v243
    v_mfma_f32_16x16x32_bf16 v[248:251], a[248:251], v[200:203], v[248:251]
    s_waitcnt lgkmcnt(0)
    v_exp_f32 v244, v244
    v_mfma_f32_16x16x32_bf16 v[248:251], a[252:255], v[232:235], v[248:251]
    v_exp_f32 v245, v245
    v_mfma_f32_16x16x32_bf16 a[184:187], v[112:115], v[80:83], a[184:187]
    s_waitcnt vmcnt(8) lgkmcnt(0)
    v_exp_f32 v246, v246
    v_mfma_f32_16x16x32_bf16 a[184:187], v[116:119], v[84:87], a[184:187]
    s_barrier
    ds_read_b128 a[224:227], v2 offset:0
    ds_read_b128 a[228:231], v2 offset:1024
    v_mfma_f32_16x16x32_bf16 a[188:191], v[112:115], v[88:91], a[188:191]
    ds_read_b128 a[232:235], v2 offset:2048
    v_cvt_pk_bf16_f32 v53, v242, v243
    v_mfma_f32_16x16x32_bf16 a[188:191], v[116:119], v[92:95], a[188:191]
    ds_read_b128 a[236:239], v2 offset:3072
    v_cvt_pk_bf16_f32 v60, v244, v245
    v_mfma_f32_16x16x32_bf16 v[252:255], a[240:243], v[140:143], v[156:159]
    v_exp_f32 v247, v247
    v_mfma_f32_16x16x32_bf16 v[252:255], a[244:247], v[172:175], v[252:255]
    ds_read_b128 v[96:99], v2 offset:16384
    ds_read_b128 v[100:103], v2 offset:17408
    v_mfma_f32_16x16x32_bf16 v[252:255], a[248:251], v[204:207], v[252:255]
    v_exp_f32 v248, v248
    v_mfma_f32_16x16x32_bf16 v[252:255], a[252:255], v[236:239], v[252:255]
    v_exp_f32 v249, v249
    v_mfma_f32_16x16x32_bf16 a[200:203], v[120:123], v[80:83], a[200:203]
    v_exp_f32 v250, v250
    v_mfma_f32_16x16x32_bf16 a[200:203], v[124:127], v[84:87], a[200:203]
    v_exp_f32 v251, v251
    v_mfma_f32_16x16x32_bf16 a[204:207], v[120:123], v[88:91], a[204:207]
    v_cvt_pk_bf16_f32 v61, v246, v247
    v_cvt_pk_bf16_f32 v54, v248, v249
    v_mfma_f32_16x16x32_bf16 a[204:207], v[124:127], v[92:95], a[204:207]
    s_sub_u32 s78, s78, 1
    v_exp_f32 v252, v252
    v_smfmac_f32_16x16x64_bf16 a[216:219], a[136:139], v[80:87], v215
    s_cmp_lg_u32 s78, 0
    v_cvt_pk_bf16_f32 v55, v250, v251
    v_smfmac_f32_16x16x64_bf16 a[220:223], a[136:139], v[88:95], v215
    s_cbranch_scc1 K1_LS
K1_LS_END:
    v_add_f32 v212, s12, v156
    v_fma_f32 v176, v208, s8, v212
    v_fma_f32 v177, v209, s8, v212
    v_fma_f32 v178, v210, s8, v212
    v_fma_f32 v179, v211, s8, v212
    s_nop 1
    s_waitcnt lgkmcnt(0)
    v_mfma_f32_16x16x32_bf16 v[240:243], a[224:227], v[140:143], v[176:179]
    s_xor_b32 s21, s3, 1
    ds_read_b128 v[104:107], v2 offset:18432
    s_lshl2_add_u32 s21, s21, s4
    v_mfma_f32_16x16x32_bf16 v[240:243], a[228:231], v[172:175], v[240:243]
    s_mul_i32 s21, s21, 36864
    ds_read_b128 v[108:111], v2 offset:19456
    ds_read_b128 a[240:243], v2 offset:4096
    v_mfma_f32_16x16x32_bf16 v[240:243], a[232:235], v[204:207], v[240:243]
    s_add_u32 s21, s21, s28
    s_mov_b32 m0, s45
    ds_read_b128 a[244:247], v2 offset:5120
    v_mfma_f32_16x16x32_bf16 v[240:243], a[236:239], v[236:239], v[240:243]
    s_mul_i32 s86, s4, 34
    buffer_load_dwordx4 v1, s[56:59], s21 offen sc1 lds
    v_mfma_f32_16x16x32_bf16 a[8:11], v[96:99], v[48:51], a[8:11]
    s_add_u32 s86, s86, 8
    v_exp_f32 v253, v253
    v_mfma_f32_16x16x32_bf16 a[8:11], v[100:103], v[52:55], a[8:11]
    s_mov_b32 s99, s76
    v_exp_f32 v254, v254
    v_mfma_f32_16x16x32_bf16 a[12:15], v[96:99], v[56:59], a[12:15]
    s_mov_b32 s76, s60
    v_exp_f32 v255, v255
    v_cvt_pk_bf16_f32 v62, v252, v253
    v_cvt_pk_bf16_f32 v63, v254, v255
    s_nop 1
    v_mfma_f32_16x16x32_bf16 a[12:15], v[100:103], v[60:63], a[12:15]
    s_mov_b32 s60, s82
    ds_read_b128 a[248:251], v2 offset:6144
    ds_read_b128 a[252:255], v2 offset:7168
    s_waitcnt lgkmcnt(2)
    v_mfma_f32_16x16x32_bf16 a[24:27], v[104:107], v[48:51], a[24:27]
    s_mov_b32 s82, s95
    v_lshrrev_b32 v28, 4, v1
    ds_read_b128 v[112:115], v2 offset:20480
    v_mfma_f32_16x16x32_bf16 a[24:27], v[108:111], v[52:55], a[24:27]
    s_mov_b32 s95, s93
    v_min_u32 v28, 33, v28
    ds_read_b128 v[116:119], v2 offset:21504
    v_mfma_f32_16x16x32_bf16 a[28:31], v[104:107], v[56:59], a[28:31]
    s_mov_b32 s93, s99
    buffer_load_dwordx4 v1, s[56:59], s21 offen offset:1024 sc1 lds
    v_mfma_f32_16x16x32_bf16 a[28:31], v[108:111], v[60:63], a[28:31]
    s_and_b32 s62, s5, 4
    v_add_lshl_u32 v28, v28, s86, 7
    v_add_f32 v213, s13, v156
    v_fma_f32 v180, v208, s9, v213
    v_fma_f32 v181, v209, s9, v213
    v_fma_f32 v182, v210, s9, v213
    v_fma_f32 v183, v211, s9, v213
    s_nop 1
    v_mfma_f32_16x16x32_bf16 v[244:247], a[240:243], v[140:143], v[180:183]
    s_getpc_b64 s[86:87]
    global_load_dword v28, v28, s[86:87]
    v_mfma_f32_16x16x32_bf16 v[244:247], a[244:247], v[172:175], v[244:247]
    s_lshl_b32 s63, s3, 12
    ds_read_b128 v[120:123], v2 offset:22528
    ds_read_b128 v[124:127], v2 offset:23552
    s_waitcnt lgkmcnt(3)
    v_mfma_f32_16x16x32_bf16 v[244:247], a[248:251], v[204:207], v[244:247]
    s_sub_u32 s19, s74, s101
    buffer_load_dwordx4 v1, s[56:59], s21 offen offset:2048 sc1 lds
    v_mfma_f32_16x16x32_bf16 v[244:247], a[252:255], v[236:239], v[244:247]
    s_add_u32 s62, s62, s4
    ds_read_b128 a[224:227], v2 offset:8192
    ds_read_b128 a[228:231], v2 offset:9216
    v_mfma_f32_16x16x32_bf16 a[40:43], v[112:115], v[48:51], a[40:43]
    s_mov_b32 s20, s63
    ds_read_b128 a[232:235], v2 offset:10240
    v_add_f32 v212, s14, v156
    s_waitcnt lgkmcnt(5)
    v_mfma_f32_16x16x32_bf16 a[40:43], v[116:119], v[52:55], a[40:43]
    s_add_u32 s19, s66, s19
    ds_read_b128 a[236:239], v2 offset:11264
    v_fma_f32 v184, v208, s10, v212
    v_mfma_f32_16x16x32_bf16 a[44:47], v[112:115], v[56:59], a[44:47]
    s_mov_b32 s50, 9437184
    ds_read_b128 v[96:99], v2 offset:24576
    v_fma_f32 v185, v209, s10, v212
    v_mfma_f32_16x16x32_bf16 a[44:47], v[116:119], v[60:63], a[44:47]
    s_waitcnt lgkmcnt(5)
    ds_read_b128 v[100:103], v2 offset:25600
    v_fma_f32 v186, v210, s10, v212
    v_mfma_f32_16x16x32_bf16 a[56:59], v[120:123], v[48:51], a[56:59]
    buffer_load_dwordx4 v1, s[56:59], s21 offen offset:3072 sc1 lds
    v_mfma_f32_16x16x32_bf16 a[56:59], v[124:127], v[52:55], a[56:59]
    s_add_u32 s21, s21, 4096
    v_fma_f32 v187, v211, s10, v212
    ds_read_b128 v[104:107], v2 offset:26624
    v_mfma_f32_16x16x32_bf16 a[60:63], v[120:123], v[56:59], a[60:63]
    s_add_u32 m0, s45, 4096
    ds_read_b128 v[108:111], v2 offset:27648
    ds_read_b128 a[240:243], v2 offset:12288
    v_mfma_f32_16x16x32_bf16 a[60:63], v[124:127], v[60:63], a[60:63]
    s_waitcnt lgkmcnt(4)
    ds_read_b128 a[244:247], v2 offset:13312
    v_add_f32 v213, s15, v156
    v_mfma_f32_16x16x32_bf16 v[248:251], a[224:227], v[140:143], v[184:187]
    ds_read_b128 a[248:251], v2 offset:14336
    v_fma_f32 v188, v208, s11, v213
    v_mfma_f32_16x16x32_bf16 v[248:251], a[228:231], v[172:175], v[248:251]
    ds_read_b128 a[252:255], v2 offset:15360
    v_fma_f32 v189, v209, s11, v213
    v_mfma_f32_16x16x32_bf16 v[248:251], a[232:235], v[204:207], v[248:251]
    buffer_load_dwordx4 v1, s[56:59], s21 offen sc1 lds
    v_mfma_f32_16x16x32_bf16 v[248:251], a[236:239], v[236:239], v[248:251]
    ds_read_b128 v[112:115], v2 offset:28672
    ds_read_b128 v[116:119], v2 offset:29696
    v_mfma_f32_16x16x32_bf16 a[152:155], v[96:99], v[48:51], a[152:155]
    s_waitcnt lgkmcnt(4)
    v_fma_f32 v190, v210, s11, v213
    v_fma_f32 v191, v211, s11, v213
    v_mfma_f32_16x16x32_bf16 a[152:155], v[100:103], v[52:55], a[152:155]
    ds_read_b128 v[120:123], v2 offset:30720
    ds_read_b128 v[124:127], v2 offset:31744
    v_mfma_f32_16x16x32_bf16 a[156:159], v[96:99], v[56:59], a[156:159]
    v_add_u32 v2, s82, v1
    ds_read_b128 v[96:99], v2 offset:16384
    v_mfma_f32_16x16x32_bf16 a[156:159], v[100:103], v[60:63], a[156:159]
    ds_read_b128 v[100:103], v2 offset:17408
    v_bfe_u32 v217, v1, 4, 3
    v_mfma_f32_16x16x32_bf16 a[168:171], v[104:107], v[48:51], a[168:171]
    buffer_load_dwordx4 v1, s[56:59], s21 offen offset:1024 sc1 lds
    v_mfma_f32_16x16x32_bf16 a[168:171], v[108:111], v[52:55], a[168:171]
    v_exp_f32 v240, v240
    v_mfma_f32_16x16x32_bf16 a[172:175], v[104:107], v[56:59], a[172:175]
    ds_read_b128 v[104:107], v2 offset:18432
    v_lshlrev_b32 v217, 7, v217
    v_mfma_f32_16x16x32_bf16 a[172:175], v[108:111], v[60:63], a[172:175]
    v_exp_f32 v241, v241
    v_mfma_f32_16x16x32_bf16 v[252:255], a[240:243], v[140:143], v[188:191]
    ds_read_b128 v[108:111], v2 offset:19456
    v_cvt_pk_bf16_f32 v88, v240, v241
    v_mfma_f32_16x16x32_bf16 v[252:255], a[244:247], v[172:175], v[252:255]
    s_waitcnt lgkmcnt(2)
    v_exp_f32 v242, v242
    v_mfma_f32_16x16x32_bf16 v[252:255], a[248:251], v[204:207], v[252:255]
    buffer_load_dwordx4 v1, s[56:59], s21 offen offset:2048 sc1 lds
    v_mfma_f32_16x16x32_bf16 v[252:255], a[252:255], v[236:239], v[252:255]
    v_exp_f32 v243, v243
    v_mfma_f32_16x16x32_bf16 a[184:187], v[112:115], v[48:51], a[184:187]
    v_exp_f32 v244, v244
    v_mfma_f32_16x16x32_bf16 a[184:187], v[116:119], v[52:55], a[184:187]
    v_exp_f32 v245, v245
    v_mfma_f32_16x16x32_bf16 a[188:191], v[112:115], v[56:59], a[188:191]
    ds_read_b128 v[112:115], v2 offset:20480
    v_cvt_pk_bf16_f32 v89, v242, v243
    v_mfma_f32_16x16x32_bf16 a[188:191], v[116:119], v[60:63], a[188:191]
    v_exp_f32 v246, v246
    v_mfma_f32_16x16x32_bf16 a[200:203], v[120:123], v[48:51], a[200:203]
    v_exp_f32 v247, v247
    v_mfma_f32_16x16x32_bf16 a[200:203], v[124:127], v[52:55], a[200:203]
    v_exp_f32 v248, v248
    v_mfma_f32_16x16x32_bf16 a[204:207], v[120:123], v[56:59], a[204:207]
    v_exp_f32 v249, v249
    v_mfma_f32_16x16x32_bf16 a[204:207], v[124:127], v[60:63], a[204:207]
    v_exp_f32 v250, v250
    v_smfmac_f32_16x16x64_bf16 a[216:219], a[136:139], v[48:55], v215
    s_add_u32 s48, s32, 1048576
    s_addc_u32 s49, s33, 0
    ds_read_b128 v[116:119], v2 offset:21504
    v_smfmac_f32_16x16x64_bf16 a[220:223], a[136:139], v[56:63], v215
    v_exp_f32 v251, v251
    v_cvt_pk_bf16_f32 v90, v244, v245
    v_cvt_pk_bf16_f32 v91, v246, v247
    v_cvt_pk_bf16_f32 v92, v248, v249
    v_cvt_pk_bf16_f32 v93, v250, v251
    v_exp_f32 v252, v252
    s_cmp_eq_u32 s6, 7
    s_cbranch_scc1 K1_S7
K1_S7_BACK:
    s_waitcnt lgkmcnt(0)
    v_mfma_f32_16x16x32_bf16 a[12:15], v[96:99], v[88:91], a[12:15]
    ds_read_b128 v[120:123], v2 offset:22528
    v_exp_f32 v253, v253
    v_exp_f32 v254, v254
    v_exp_f32 v255, v255
    v_cvt_pk_bf16_f32 v94, v252, v253
    v_cvt_pk_bf16_f32 v95, v254, v255
    s_nop 1
    v_mfma_f32_16x16x32_bf16 a[12:15], v[100:103], v[92:95], a[12:15]
    ds_read_b128 v[124:127], v2 offset:23552
    ds_read_b128 v[96:99], v2 offset:24576
    v_accvgpr_read_b32 v12, a8
    v_accvgpr_read_b32 v13, a9
    v_accvgpr_read_b32 v14, a10
    v_mfma_f32_16x16x32_bf16 a[28:31], v[104:107], v[88:91], a[28:31]
    ds_read_b128 v[100:103], v2 offset:25600
    v_accvgpr_read_b32 v9, a216
    v_accvgpr_read_b32 v10, a217
    v_add_f32 v9, v9, v10
    v_accvgpr_read_b32 v15, a11
    v_mfma_f32_16x16x32_bf16 a[28:31], v[108:111], v[92:95], a[28:31]
    ds_read_b128 v[104:107], v2 offset:26624
    v_rcp_f32 v10, v9
    v_accvgpr_read_b32 v16, a24
    v_mul_f32 v10, v10, v6
    v_mfma_f32_16x16x32_bf16 a[44:47], v[112:115], v[88:91], a[44:47]
    ds_read_b128 v[108:111], v2 offset:27648
    v_accvgpr_read_b32 v17, a25
    v_accvgpr_read_b32 v18, a26
    v_accvgpr_read_b32 v19, a27
    v_accvgpr_read_b32 v20, a40
    v_mfma_f32_16x16x32_bf16 a[44:47], v[116:119], v[92:95], a[44:47]
    s_waitcnt lgkmcnt(5)
    ds_read_b128 v[112:115], v2 offset:28672
    v_accvgpr_read_b32 v21, a41
    v_accvgpr_read_b32 v22, a42
    v_accvgpr_read_b32 v23, a43
    v_accvgpr_read_b32 v24, a56
    v_mfma_f32_16x16x32_bf16 a[60:63], v[120:123], v[88:91], a[60:63]
    s_waitcnt lgkmcnt(3)
    ds_read_b128 v[116:119], v2 offset:29696
    v_accvgpr_read_b32 v25, a57
    v_accvgpr_read_b32 v26, a58
    v_accvgpr_read_b32 v27, a59
    v_mul_f32 v12, v10, v12
    v_mfma_f32_16x16x32_bf16 a[60:63], v[124:127], v[92:95], a[60:63]
    ds_read_b128 v[120:123], v2 offset:30720
    v_mul_f32 v13, v10, v13
    v_mul_f32 v14, v10, v14
    v_mul_f32 v15, v10, v15
    v_mul_f32 v16, v10, v16
    v_mfma_f32_16x16x32_bf16 a[156:159], v[96:99], v[88:91], a[156:159]
    ds_read_b128 v[124:127], v2 offset:31744
    v_mul_f32 v17, v10, v17
    v_mul_f32 v18, v10, v18
    v_mul_f32 v19, v10, v19
    v_mul_f32 v20, v10, v20
    v_mfma_f32_16x16x32_bf16 a[156:159], v[100:103], v[92:95], a[156:159]
    s_waitcnt lgkmcnt(3)
    v_mul_f32 v21, v10, v21
    v_mul_f32 v22, v10, v22
    v_mul_f32 v23, v10, v23
    v_mul_f32 v24, v10, v24
    v_mul_f32 v25, v10, v25
    v_mfma_f32_16x16x32_bf16 a[172:175], v[104:107], v[88:91], a[172:175]
    v_mul_f32 v26, v10, v26
    v_mul_f32 v27, v10, v27
    v_cvt_pk_bf16_f32 v12, v12, v13
    v_cvt_pk_bf16_f32 v13, v14, v15
    v_cvt_pk_bf16_f32 v14, v16, v17
    v_mfma_f32_16x16x32_bf16 a[172:175], v[108:111], v[92:95], a[172:175]
    v_cvt_pk_bf16_f32 v15, v18, v19
    v_cvt_pk_bf16_f32 v20, v20, v21
    v_cvt_pk_bf16_f32 v21, v22, v23
    v_cvt_pk_bf16_f32 v22, v24, v25
    v_cvt_pk_bf16_f32 v23, v26, v27
    v_mfma_f32_16x16x32_bf16 a[188:191], v[112:115], v[88:91], a[188:191]
    s_waitcnt lgkmcnt(1)
    buffer_store_dwordx4 v[12:15], v1, s[40:43], s81 offen offset:0 sc1
    buffer_store_dwordx4 v[20:23], v1, s[40:43], s81 offen offset:1024 sc1
    v_accvgpr_read_b32 v16, a168
    v_mfma_f32_16x16x32_bf16 a[188:191], v[116:119], v[92:95], a[188:191]
    v_accvgpr_read_b32 v12, a152
    v_accvgpr_read_b32 v13, a153
    v_accvgpr_read_b32 v14, a154
    v_accvgpr_read_b32 v15, a155
    v_accvgpr_read_b32 v17, a169
    v_mfma_f32_16x16x32_bf16 a[204:207], v[120:123], v[88:91], a[204:207]
    s_waitcnt lgkmcnt(0)
    v_accvgpr_read_b32 v18, a170
    v_accvgpr_read_b32 v19, a171
    v_accvgpr_read_b32 v20, a184
    v_accvgpr_read_b32 v21, a185
    v_accvgpr_read_b32 v22, a186
    v_mfma_f32_16x16x32_bf16 a[204:207], v[124:127], v[92:95], a[204:207]
    v_accvgpr_read_b32 v23, a187
    v_accvgpr_read_b32 v24, a200
    v_accvgpr_read_b32 v25, a201
    v_accvgpr_read_b32 v26, a202
    v_accvgpr_read_b32 v27, a203
    v_smfmac_f32_16x16x64_bf16 a[220:223], a[136:139], v[88:95], v215
    v_mul_f32 v12, v10, v12
    v_mul_f32 v13, v10, v13
    v_mul_f32 v14, v10, v14
    v_mul_f32 v15, v10, v15
    v_mul_f32 v16, v10, v16
    v_mul_f32 v17, v10, v17
    v_mul_f32 v18, v10, v18
    v_mul_f32 v19, v10, v19
    v_mul_f32 v20, v10, v20
    v_mul_f32 v21, v10, v21
    v_mul_f32 v22, v10, v22
    v_mul_f32 v23, v10, v23
    v_mul_f32 v24, v10, v24
    v_mul_f32 v25, v10, v25
    v_mul_f32 v26, v10, v26
    v_mul_f32 v27, v10, v27
    v_cmp_nge_f32 vcc, 0x5f800000, v9
    v_cvt_pk_bf16_f32 v12, v12, v13
    v_cvt_pk_bf16_f32 v13, v14, v15
    v_cvt_pk_bf16_f32 v14, v16, v17
    v_cvt_pk_bf16_f32 v15, v18, v19
    v_cvt_pk_bf16_f32 v20, v20, v21
    v_cvt_pk_bf16_f32 v21, v22, v23
    v_cvt_pk_bf16_f32 v22, v24, v25
    v_cvt_pk_bf16_f32 v23, v26, v27
    s_or_b64 s[84:85], s[84:85], vcc
    buffer_store_dwordx4 v[12:15], v1, s[40:43], s81 offen offset:2048 sc1
    buffer_store_dwordx4 v[20:23], v1, s[40:43], s81 offen offset:3072 sc1
    s_nop 3
    v_accvgpr_read_b32 v9, a220
    v_accvgpr_read_b32 v10, a221
    v_add_f32 v9, v9, v10
    v_cmp_nge_f32 vcc, 0x5f800000, v9
    v_rcp_f32 v10, v9
    s_nop 0
    s_or_b64 s[84:85], s[84:85], vcc
    v_mul_f32 v10, v10, v7
    s_add_u32 s72, s81, 622592
    v_accvgpr_read_b32 v12, a12
    v_accvgpr_read_b32 v13, a13
    v_accvgpr_read_b32 v14, a14
    v_accvgpr_read_b32 v15, a15
    v_accvgpr_read_b32 v16, a28
    v_accvgpr_read_b32 v17, a29
    v_accvgpr_read_b32 v18, a30
    v_accvgpr_read_b32 v19, a31
    v_pk_mul_f32 v[12:13], v[12:13], v[10:11] op_sel_hi:[1,0]
    v_pk_mul_f32 v[14:15], v[14:15], v[10:11] op_sel_hi:[1,0]
    v_pk_mul_f32 v[16:17], v[16:17], v[10:11] op_sel_hi:[1,0]
    v_pk_mul_f32 v[18:19], v[18:19], v[10:11] op_sel_hi:[1,0]
    v_cvt_pk_bf16_f32 v12, v12, v13
    v_cvt_pk_bf16_f32 v13, v14, v15
    v_cvt_pk_bf16_f32 v14, v16, v17
    v_cvt_pk_bf16_f32 v15, v18, v19
    buffer_store_dwordx4 v[12:15], v1, s[40:43], s72 offen offset:0 sc1
    v_accvgpr_read_b32 v20, a44
    v_accvgpr_read_b32 v21, a45
    v_accvgpr_read_b32 v22, a46
    v_accvgpr_read_b32 v23, a47
    v_accvgpr_read_b32 v24, a60
    v_accvgpr_read_b32 v25, a61
    v_accvgpr_read_b32 v26, a62
    v_accvgpr_read_b32 v27, a63
    v_pk_mul_f32 v[20:21], v[20:21], v[10:11] op_sel_hi:[1,0]
    v_pk_mul_f32 v[22:23], v[22:23], v[10:11] op_sel_hi:[1,0]
    v_pk_mul_f32 v[24:25], v[24:25], v[10:11] op_sel_hi:[1,0]
    v_pk_mul_f32 v[26:27], v[26:27], v[10:11] op_sel_hi:[1,0]
    v_cvt_pk_bf16_f32 v20, v20, v21
    v_cvt_pk_bf16_f32 v21, v22, v23
    v_cvt_pk_bf16_f32 v22, v24, v25
    v_cvt_pk_bf16_f32 v23, v26, v27
    buffer_store_dwordx4 v[20:23], v1, s[40:43], s72 offen offset:1024 sc1
    v_accvgpr_read_b32 v12, a156
    v_accvgpr_read_b32 v13, a157
    v_accvgpr_read_b32 v14, a158
    v_accvgpr_read_b32 v15, a159
    v_accvgpr_read_b32 v16, a172
    v_accvgpr_read_b32 v17, a173
    v_accvgpr_read_b32 v18, a174
    v_accvgpr_read_b32 v19, a175
    v_pk_mul_f32 v[12:13], v[12:13], v[10:11] op_sel_hi:[1,0]
    v_pk_mul_f32 v[14:15], v[14:15], v[10:11] op_sel_hi:[1,0]
    v_pk_mul_f32 v[16:17], v[16:17], v[10:11] op_sel_hi:[1,0]
    v_pk_mul_f32 v[18:19], v[18:19], v[10:11] op_sel_hi:[1,0]
    v_cvt_pk_bf16_f32 v12, v12, v13
    v_cvt_pk_bf16_f32 v13, v14, v15
    v_cvt_pk_bf16_f32 v14, v16, v17
    v_cvt_pk_bf16_f32 v15, v18, v19
    buffer_store_dwordx4 v[12:15], v1, s[40:43], s72 offen offset:2048 sc1
    v_accvgpr_read_b32 v20, a188
    v_accvgpr_read_b32 v21, a189
    v_accvgpr_read_b32 v22, a190
    v_accvgpr_read_b32 v23, a191
    v_accvgpr_read_b32 v24, a204
    v_accvgpr_read_b32 v25, a205
    v_accvgpr_read_b32 v26, a206
    v_accvgpr_read_b32 v27, a207
    v_pk_mul_f32 v[20:21], v[20:21], v[10:11] op_sel_hi:[1,0]
    v_pk_mul_f32 v[22:23], v[22:23], v[10:11] op_sel_hi:[1,0]
    v_pk_mul_f32 v[24:25], v[24:25], v[10:11] op_sel_hi:[1,0]
    v_pk_mul_f32 v[26:27], v[26:27], v[10:11] op_sel_hi:[1,0]
    v_cvt_pk_bf16_f32 v20, v20, v21
    v_cvt_pk_bf16_f32 v21, v22, v23
    v_cvt_pk_bf16_f32 v22, v24, v25
    v_cvt_pk_bf16_f32 v23, v26, v27
    buffer_store_dwordx4 v[20:23], v1, s[40:43], s72 offen offset:3072 sc1
    buffer_load_dword v3, v217, s[32:35], s19 offen sc1
    s_waitcnt lgkmcnt(0)
    s_barrier
    s_sub_u32 s30, s47, s75
    s_sub_u32 s31, s79, s75
    v_bfe_u32 v20, v1, 4, 4
    v_lshrrev_b32 v21, 8, v1
    s_lshl_b32 s98, s4, 4
    s_add_u32 s98, s98, 16
    v_add_u32 v22, s98, v20
    v_mul_u32_u24 v22, 144, v22
    v_add_u32 v22, s30, v22
    v_lshl_add_u32 v9, v21, 3, v22
    s_lshr_b32 s98, s73, 1
    v_add_u32 v8, s98, v9
    v_subrev_u32 v10, s98, v9
    s_sub_u32 s99, s31, s30
    v_add_u32 v24, s99, v8
    v_add_u32 v25, s99, v9
    v_add_u32 v26, s99, v10
    s_bitcmp1_b32 s4, 0
    s_cselect_b32 s99, s31, s30
    v_mul_u32_u24 v23, 144, v20
    v_lshl_add_u32 v23, v21, 3, v23
    v_add_u32 v13, s99, v23
    v_add_u32 v12, s98, v13
    v_accvgpr_read_b32 v32, a64
    v_accvgpr_read_b32 v33, a65
    v_accvgpr_read_b32 v34, a66
    v_accvgpr_read_b32 v35, a67
    v_cvt_pk_bf16_f32 v32, v32, v33
    v_cvt_pk_bf16_f32 v33, v34, v35
    ds_write_b64 v8, v[32:33] offset:0
    v_accvgpr_read_b32 v36, a68
    v_accvgpr_read_b32 v37, a69
    v_accvgpr_read_b32 v38, a70
    v_accvgpr_read_b32 v39, a71
    v_cvt_pk_bf16_f32 v36, v36, v37
    v_cvt_pk_bf16_f32 v37, v38, v39
    ds_write_b64 v8, v[36:37] offset:9216
    v_accvgpr_read_b32 v40, a72
    v_accvgpr_read_b32 v41, a73
    v_accvgpr_read_b32 v42, a74
    v_accvgpr_read_b32 v43, a75
    v_cvt_pk_bf16_f32 v40, v40, v41
    v_cvt_pk_bf16_f32 v41, v42, v43
    ds_write_b64 v24, v[40:41] offset:0
    v_accvgpr_read_b32 v44, a76
    v_accvgpr_read_b32 v45, a77
    v_accvgpr_read_b32 v46, a78
    v_accvgpr_read_b32 v47, a79
    v_cvt_pk_bf16_f32 v44, v44, v45
    v_cvt_pk_bf16_f32 v45, v46, v47
    ds_write_b64 v24, v[44:45] offset:9216
    v_accvgpr_read_b32 v32, a80
    v_accvgpr_read_b32 v33, a81
    v_accvgpr_read_b32 v34, a82
    v_accvgpr_read_b32 v35, a83
    v_cvt_pk_bf16_f32 v32, v32, v33
    v_cvt_pk_bf16_f32 v33, v34, v35
    ds_write_b64 v9, v[32:33] offset:32
    v_accvgpr_read_b32 v36, a84
    v_accvgpr_read_b32 v37, a85
    v_accvgpr_read_b32 v38, a86
    v_accvgpr_read_b32 v39, a87
    v_cvt_pk_bf16_f32 v36, v36, v37
    v_cvt_pk_bf16_f32 v37, v38, v39
    ds_write_b64 v9, v[36:37] offset:9248
    v_accvgpr_read_b32 v40, a88
    v_accvgpr_read_b32 v41, a89
    v_accvgpr_read_b32 v42, a90
    v_accvgpr_read_b32 v43, a91
    v_cvt_pk_bf16_f32 v40, v40, v41
    v_cvt_pk_bf16_f32 v41, v42, v43
    ds_write_b64 v25, v[40:41] offset:32
    v_accvgpr_read_b32 v44, a92
    v_accvgpr_read_b32 v45, a93
    v_accvgpr_read_b32 v46, a94
    v_accvgpr_read_b32 v47, a95
    v_cvt_pk_bf16_f32 v44, v44, v45
    v_cvt_pk_bf16_f32 v45, v46, v47
    ds_write_b64 v25, v[44:45] offset:9248
    v_accvgpr_read_b32 v32, a96
    v_accvgpr_read_b32 v33, a97
    v_accvgpr_read_b32 v34, a98
    v_accvgpr_read_b32 v35, a99
    v_cvt_pk_bf16_f32 v32, v32, v33
    v_cvt_pk_bf16_f32 v33, v34, v35
    ds_write_b64 v10, v[32:33] offset:64
    v_accvgpr_read_b32 v36, a100
    v_accvgpr_read_b32 v37, a101
    v_accvgpr_read_b32 v38, a102
    v_accvgpr_read_b32 v39, a103
    v_cvt_pk_bf16_f32 v36, v36, v37
    v_cvt_pk_bf16_f32 v37, v38, v39
    ds_write_b64 v10, v[36:37] offset:9280
    v_accvgpr_read_b32 v40, a104
    v_accvgpr_read_b32 v41, a105
    v_accvgpr_read_b32 v42, a106
    v_accvgpr_read_b32 v43, a107
    v_cvt_pk_bf16_f32 v40, v40, v41
    v_cvt_pk_bf16_f32 v41, v42, v43
    ds_write_b64 v26, v[40:41] offset:64
    v_accvgpr_read_b32 v44, a108
    v_accvgpr_read_b32 v45, a109
    v_accvgpr_read_b32 v46, a110
    v_accvgpr_read_b32 v47, a111
    v_cvt_pk_bf16_f32 v44, v44, v45
    v_cvt_pk_bf16_f32 v45, v46, v47
    ds_write_b64 v26, v[44:45] offset:9280
    v_mov_b32 v218, 2
    s_cmp_eq_u64 s[84:85], 0
    s_cselect_b32 s7, s74, 1073741824
    s_cmp_lg_u32 s83, 0
    s_cselect_b32 s7, s74, s7
    s_waitcnt vmcnt(1)
    buffer_store_dword v218, v216, s[32:35], s7 offen sc1
    s_xor_b32 s21, s3, 2
    s_lshl2_add_u32 s21, s21, s4
    s_mul_i32 s21, s21, 36864
    s_add_u32 s21, s21, s28
    s_mov_b32 m0, s46
    s_nop 0
    buffer_load_dwordx4 v1, s[56:59], s21 offen sc1 lds
    v_accvgpr_read_b32 v32, a112
    v_accvgpr_read_b32 v33, a113
    v_accvgpr_read_b32 v34, a114
    v_accvgpr_read_b32 v35, a115
    v_cvt_pk_bf16_f32 v32, v32, v33
    v_cvt_pk_bf16_f32 v33, v34, v35
    ds_write_b64 v9, v[32:33] offset:96
    v_accvgpr_read_b32 v36, a116
    v_accvgpr_read_b32 v37, a117
    v_accvgpr_read_b32 v38, a118
    v_accvgpr_read_b32 v39, a119
    v_cvt_pk_bf16_f32 v36, v36, v37
    buffer_load_dwordx4 v1, s[56:59], s21 offen offset:1024 sc1 lds
    v_cvt_pk_bf16_f32 v37, v38, v39
    ds_write_b64 v9, v[36:37] offset:9312
    v_accvgpr_read_b32 v40, a120
    v_accvgpr_read_b32 v41, a121
    v_accvgpr_read_b32 v42, a122
    v_accvgpr_read_b32 v43, a123
    v_cvt_pk_bf16_f32 v40, v40, v41
    v_cvt_pk_bf16_f32 v41, v42, v43
    ds_write_b64 v25, v[40:41] offset:96
    v_accvgpr_read_b32 v44, a124
    v_accvgpr_read_b32 v45, a125
    v_accvgpr_read_b32 v46, a126
    buffer_load_dwordx4 v1, s[56:59], s21 offen offset:2048 sc1 lds
    v_accvgpr_read_b32 v47, a127
    v_cvt_pk_bf16_f32 v44, v44, v45
    v_cvt_pk_bf16_f32 v45, v46, v47
    s_waitcnt lgkmcnt(3)
    ds_write_b64 v25, v[44:45] offset:9312
    v_accvgpr_read_b32 v32, a128
    v_accvgpr_read_b32 v33, a129
    v_accvgpr_read_b32 v34, a130
    v_accvgpr_read_b32 v35, a131
    v_cvt_pk_bf16_f32 v32, v32, v33
    v_cvt_pk_bf16_f32 v33, v34, v35
    ds_write_b64 v12, v[32:33] offset:0
    v_accvgpr_read_b32 v36, a132
    buffer_load_dwordx4 v1, s[56:59], s21 offen offset:3072 sc1 lds
    v_accvgpr_read_b32 v37, a133
    v_accvgpr_read_b32 v38, a134
    v_accvgpr_read_b32 v39, a135
    v_cvt_pk_bf16_f32 v36, v36, v37
    v_cvt_pk_bf16_f32 v37, v38, v39
    s_cmp_eq_u32 s73, 0
    s_cselect_b64 exec, -1, 0
    ds_write_b64 v13, v[36:37] offset:32
    s_mov_b64 exec, -1
    s_cmp_lg_u64 s[84:85], 0
    s_cselect_b32 s7, 1, 0
    v_mov_b32 v20, s7
    s_lshl2_add_u32 s98, s4, s30
    s_add_u32 s21, s21, 4096
    s_add_u32 m0, s46, 4096
    s_nop 0
    buffer_load_dwordx4 v1, s[56:59], s21 offen sc1 lds
    v_mov_b32 v21, s98
    ds_write_b32 v21, v20 offset:20736
    v_mov_b32 v21, s30
    s_and_b32 s98, s4, 1
    s_lshl_b32 s98, s98, 6
    v_lshrrev_b32 v14, 4, v1
    v_add_u32 v14, s98, v14
    s_sub_u32 s7, 15, s6
    s_cmp_lt_u32 s4, 2
    s_cselect_b32 s7, s6, s7
    s_cselect_b32 s99, s30, s31
    s_lshl_b32 s7, s7, 7
    buffer_load_dwordx4 v1, s[56:59], s21 offen offset:1024 sc1 lds
    v_add_u32 v2, 2, v14
    v_mul_u32_u24 v2, 144, v2
    v_add_u32 v2, s99, v2
    v_add_u32 v14, s7, v14
    v_lshrrev_b32 v15, 4, v14
    s_mov_b32 s98, 155648
    v_mul_lo_u32 v15, v15, s98
    v_and_b32 v23, 0xf0, v1
    v_add_u32 v15, v15, v23
    s_lshl3_add_u32 s98, s6, s62
    s_mul_i32 s98, s98, 155648
    v_add_u32 v4, s98, v1
    buffer_load_dwordx4 v1, s[56:59], s21 offen offset:2048 sc1 lds
    s_sub_u32 s98, 15, s6
    s_lshl3_add_u32 s98, s98, s62
    s_mul_i32 s98, s98, 155648
    v_add_u32 v5, s98, v1
    v_mov_b32 v19, v217
    v_subrev_u32 v23, s75, v1
    v_add_u32 v11, s44, v23
    v_add_u32 v12, s45, v23
    v_add_u32 v13, s46, v23
    v_add_u32 v6, s47, v23
    v_add_u32 v7, s79, v23
    s_mov_b32 s98, 0xbfb8aa3b
    s_mov_b32 s99, 0x3eae1a93
    s_waitcnt vmcnt(8) lgkmcnt(0)
    s_barrier
    ds_read_b128 v[24:27], v21 offset:20736
    ds_read_b128 v[32:35], v2 offset:2016
    ds_read_b128 v[36:39], v2 offset:2032
    ds_read_b128 v[40:43], v2 offset:2048
    ds_read_b128 v[44:47], v2 offset:1728
    ds_read_b128 v[48:51], v2 offset:1744
    ds_read_b128 v[52:55], v2 offset:1760
    s_waitcnt lgkmcnt(6)
    v_or3_b32 v24, v24, v25, v26
    v_or_b32 v24, v24, v27
    s_nop 0
    v_readfirstlane_b32 s7, v24
    s_nop 1
    s_andn2_b32 s7, s7, s83
    s_cbranch_scc1 K1_REDO
    buffer_load_dword v28, v29, s[32:35], s92 offen sc1
    v_cmp_gt_u32 vcc, 1, v3
    s_nop 1
    s_and_b64 vcc, vcc, exec
    s_cbranch_scc1 SPIN_SHORT
BACK_SHORT:
    buffer_load_dwordx4 a[0:3], v4, s[40:43], s63 offen offset:0 sc1
    ds_read_b128 v[128:131], v2 offset:2096
    ds_read_b128 v[132:135], v2 offset:2112
    ds_read_b128 v[136:139], v2 offset:2128
    ds_read_b128 v[56:59], v2 offset:1440
    ds_read_b128 v[60:63], v2 offset:1456
    ds_read_b128 v[64:67], v2 offset:1472
    ds_read_b128 v[68:71], v2 offset:1152
    ds_read_b128 v[72:75], v2 offset:1168
    ds_read_b128 v[76:79], v2 offset:1184
    s_waitcnt lgkmcnt(8)
    v_dot2_f32_bf16 v140, v128, v32, 0
    v_dot2_f32_bf16 v141, v128, v44, 0
    ds_read_b128 v[80:83], v2 offset:864
    s_waitcnt lgkmcnt(6)
    v_dot2_f32_bf16 v142, v128, v56, 0
    s_waitcnt lgkmcnt(3)
    v_dot2_f32_bf16 v143, v128, v68, 0
    ds_read_b128 v[84:87], v2 offset:880
    v_dot2c_f32_bf16 v140, v129, v33
    v_dot2c_f32_bf16 v141, v129, v45
    buffer_load_dwordx4 a[8:11], v4, s[40:43], s63 offen offset:1024 sc1
    ds_read_b128 v[88:91], v2 offset:896
    v_dot2c_f32_bf16 v142, v129, v57
    v_dot2c_f32_bf16 v143, v129, v69
    ds_read_b128 v[92:95], v2 offset:576
    v_dot2c_f32_bf16 v140, v130, v34
    v_dot2c_f32_bf16 v141, v130, v46
    ds_read_b128 v[96:99], v2 offset:592
    v_dot2c_f32_bf16 v142, v130, v58
    v_dot2c_f32_bf16 v143, v130, v70
    ds_read_b128 v[100:103], v2 offset:608
    v_dot2c_f32_bf16 v140, v131, v35
    v_dot2c_f32_bf16 v141, v131, v47
    ds_read_b128 v[104:107], v2 offset:288
    v_dot2c_f32_bf16 v142, v131, v59
    v_dot2c_f32_bf16 v143, v131, v71
    ds_read_b128 v[108:111], v2 offset:304
    v_dot2c_f32_bf16 v140, v132, v36
    buffer_load_dwordx4 a[16:19], v4, s[40:43], s63 offen offset:2048 sc1
    v_dot2c_f32_bf16 v141, v132, v48
    ds_read_b128 v[112:115], v2 offset:320
    v_dot2c_f32_bf16 v142, v132, v60
    s_waitcnt lgkmcnt(8)
    v_dot2c_f32_bf16 v143, v132, v72
    ds_read_b128 v[116:119], v2 offset:0
    v_dot2c_f32_bf16 v140, v133, v37
    v_dot2c_f32_bf16 v141, v133, v49
    ds_read_b128 v[120:123], v2 offset:16
    v_dot2c_f32_bf16 v142, v133, v61
    v_dot2c_f32_bf16 v143, v133, v73
    ds_read_b128 v[124:127], v2 offset:32
    v_dot2c_f32_bf16 v140, v134, v38
    v_dot2c_f32_bf16 v141, v134, v50
    v_dot2c_f32_bf16 v142, v134, v62
    v_dot2c_f32_bf16 v143, v134, v74
    v_dot2c_f32_bf16 v140, v135, v39
    v_dot2c_f32_bf16 v141, v135, v51
    buffer_load_dwordx4 a[24:27], v4, s[40:43], s63 offen offset:3072 sc1
    v_dot2c_f32_bf16 v142, v135, v63
    v_dot2c_f32_bf16 v143, v135, v75
    v_dot2c_f32_bf16 v140, v136, v40
    v_dot2c_f32_bf16 v141, v136, v52
    v_dot2c_f32_bf16 v142, v136, v64
    v_dot2c_f32_bf16 v143, v136, v76
    v_dot2_f32_bf16 v144, v128, v80, 0
    s_waitcnt lgkmcnt(4)
    v_dot2_f32_bf16 v145, v128, v92, 0
    ds_read_b128 v[32:35], v2 offset:2064
    v_dot2_f32_bf16 v146, v128, v104, 0
    s_waitcnt lgkmcnt(3)
    v_dot2_f32_bf16 v147, v128, v116, 0
    ds_read_b128 v[36:39], v2 offset:2080
    v_dot2c_f32_bf16 v144, v129, v81
    v_dot2c_f32_bf16 v145, v129, v93
    ds_read_b128 v[44:47], v2 offset:1776
    v_dot2c_f32_bf16 v146, v129, v105
    v_dot2c_f32_bf16 v147, v129, v117
    s_xor_b32 s63, s63, 4096
    buffer_load_dwordx4 a[32:35], v4, s[40:43], s63 offen offset:0 sc1
    ds_read_b128 v[48:51], v2 offset:1792
    v_dot2c_f32_bf16 v144, v130, v82
    v_dot2c_f32_bf16 v145, v130, v94
    ds_read_b128 v[56:59], v2 offset:1488
    v_dot2c_f32_bf16 v146, v130, v106
    v_dot2c_f32_bf16 v147, v130, v118
    ds_read_b128 v[60:63], v2 offset:1504
    v_dot2c_f32_bf16 v144, v131, v83
    v_dot2c_f32_bf16 v145, v131, v95
    ds_read_b128 v[68:71], v2 offset:1200
    v_dot2c_f32_bf16 v146, v131, v107
    v_dot2c_f32_bf16 v147, v131, v119
    ds_read_b128 v[72:75], v2 offset:1216
    v_dot2c_f32_bf16 v144, v132, v84
    v_dot2c_f32_bf16 v145, v132, v96
    v_dot2c_f32_bf16 v146, v132, v108
    s_waitcnt lgkmcnt(8)
    v_dot2c_f32_bf16 v147, v132, v120
    buffer_load_dwordx4 a[40:43], v4, s[40:43], s63 offen offset:1024 sc1
    v_dot2c_f32_bf16 v144, v133, v85
    v_dot2c_f32_bf16 v145, v133, v97
    v_dot2c_f32_bf16 v146, v133, v109
    v_dot2c_f32_bf16 v147, v133, v121
    v_dot2c_f32_bf16 v144, v134, v86
    v_dot2c_f32_bf16 v145, v134, v98
    v_dot2c_f32_bf16 v146, v134, v110
    v_dot2c_f32_bf16 v147, v134, v122
    v_dot2c_f32_bf16 v144, v135, v87
    v_dot2c_f32_bf16 v145, v135, v99
    v_dot2c_f32_bf16 v146, v135, v111
    v_dot2c_f32_bf16 v147, v135, v123
    v_dot2c_f32_bf16 v144, v136, v88
    v_dot2c_f32_bf16 v145, v136, v100
    v_dot2c_f32_bf16 v146, v136, v112
    v_dot2c_f32_bf16 v147, v136, v124
    v_lshlrev_b32 v8, 16, v138
    buffer_load_dwordx4 a[48:51], v4, s[40:43], s63 offen offset:2048 sc1
    v_mul_f32 v8, s98, v8
    v_exp_f32 v8, v8
    s_or_b32 s7, s6, s4
    s_cbranch_scc0 K1_WMASK
K1_WMASK_BACK:
    v_max3_f32 v9, v140, v141, v142
    v_max3_f32 v10, v143, v144, v145
    v_max3_f32 v9, v9, v146, v147
    v_max_f32 v9, v9, v10
    v_mul_f32 v9, s99, v9
    v_add_f32 v8, 1.0, v8
    v_fma_f32 v140, v140, s99, -v9
    ds_read_b128 v[80:83], v2 offset:912
    v_fma_f32 v141, v141, s99, -v9
    ds_read_b128 v[84:87], v2 offset:928
    v_fma_f32 v142, v142, s99, -v9
    ds_read_b128 v[92:95], v2 offset:624
    buffer_load_dwordx4 a[56:59], v4, s[40:43], s63 offen offset:3072 sc1
    s_xor_b32 s63, s63, 12288
    v_fma_f32 v143, v143, s99, -v9
    ds_read_b128 v[96:99], v2 offset:640
    v_fma_f32 v144, v144, s99, -v9
    ds_read_b128 v[104:107], v2 offset:336
    v_fma_f32 v145, v145, s99, -v9
    ds_read_b128 v[108:111], v2 offset:352
    v_fma_f32 v146, v146, s99, -v9
    ds_read_b128 v[116:119], v2 offset:48
    v_fma_f32 v147, v147, s99, -v9
    s_waitcnt lgkmcnt(7)
    ds_read_b128 v[120:123], v2 offset:64
    v_exp_f32 v140, v140
    v_exp_f32 v141, v141
    v_exp_f32 v142, v142
    v_exp_f32 v143, v143
    v_exp_f32 v144, v144
    v_exp_f32 v145, v145
    v_exp_f32 v146, v146
    buffer_load_dword v3, v217, s[32:35], s19 offen sc1
    buffer_load_dwordx4 a[64:67], v4, s[40:43], s63 offen offset:0 sc1
    v_exp_f32 v147, v147
    v_add_f32 v10, v140, v141
    v_add_f32 v10, v10, v142
    v_add_f32 v10, v10, v143
    v_add_f32 v10, v10, v144
    v_add_f32 v10, v10, v145
    v_add_f32 v10, v10, v146
    v_add_f32 v10, v10, v147
    v_mul_f32 v10, v10, v8
    v_rcp_f32 v10, v10
    s_nop 0
    v_mul_f32 v140, v140, v10
    v_mul_f32 v141, v141, v10
    v_mul_f32 v142, v142, v10
    buffer_load_dwordx4 a[72:75], v4, s[40:43], s63 offen offset:1024 sc1
    v_mul_f32 v143, v143, v10
    v_mul_f32 v144, v144, v10
    v_mul_f32 v145, v145, v10
    v_mul_f32 v146, v146, v10
    v_mul_f32 v147, v147, v10
    v_cvt_pk_bf16_f32 v148, 0, v140
    v_cvt_pk_bf16_f32 v149, 0, v141
    v_cvt_pk_bf16_f32 v150, 0, v142
    v_cvt_pk_bf16_f32 v151, 0, v143
    v_cvt_pk_bf16_f32 v152, 0, v144
    v_cvt_pk_bf16_f32 v153, 0, v145
    v_cvt_pk_bf16_f32 v154, 0, v146
    v_cvt_pk_bf16_f32 v155, 0, v147
    buffer_load_dwordx4 a[80:83], v4, s[40:43], s63 offen offset:2048 sc1
    v_lshrrev_b32 v140, 16, v148
    v_lshrrev_b32 v141, 16, v149
    v_lshrrev_b32 v142, 16, v150
    v_lshrrev_b32 v143, 16, v151
    v_lshrrev_b32 v144, 16, v152
    v_lshrrev_b32 v145, 16, v153
    v_lshrrev_b32 v146, 16, v154
    v_lshrrev_b32 v147, 16, v155
    v_dot2_f32_bf16 v128, v42, v140, 0
    v_dot2_f32_bf16 v129, v42, v148, 0
    v_dot2_f32_bf16 v130, v43, v140, 0
    v_dot2_f32_bf16 v131, v43, v148, 0
    v_dot2_f32_bf16 v132, v32, v140, 0
    buffer_load_dwordx4 a[88:91], v4, s[40:43], s63 offen offset:3072 sc1
    s_xor_b32 s63, s63, 4096
    v_dot2_f32_bf16 v133, v32, v148, 0
    v_dot2_f32_bf16 v134, v33, v140, 0
    v_dot2_f32_bf16 v135, v33, v148, 0
    v_dot2_f32_bf16 v136, v34, v140, 0
    v_dot2_f32_bf16 v137, v34, v148, 0
    v_dot2_f32_bf16 v138, v35, v140, 0
    v_dot2_f32_bf16 v139, v35, v148, 0
    v_dot2_f32_bf16 v156, v36, v140, 0
    v_dot2_f32_bf16 v157, v36, v148, 0
    v_dot2_f32_bf16 v158, v37, v140, 0
    v_dot2_f32_bf16 v159, v37, v148, 0
    v_dot2_f32_bf16 v17, v38, v140, 0
    v_dot2_f32_bf16 v18, v38, v148, 0
    v_dot2c_f32_bf16 v128, v54, v141
    s_waitcnt vmcnt(4)
    v_cmp_gt_u32 vcc, 2, v3
    s_nop 1
    s_and_b64 vcc, vcc, exec
    s_cbranch_scc1 SPIN_CTX
BACK_CTX:
    buffer_load_dwordx4 a[4:7], v5, s[40:43], s20 offen offset:0 sc1
    v_dot2c_f32_bf16 v129, v54, v149
    v_dot2c_f32_bf16 v130, v55, v141
    v_dot2c_f32_bf16 v131, v55, v149
    v_dot2c_f32_bf16 v132, v44, v141
    v_dot2c_f32_bf16 v133, v44, v149
    v_dot2c_f32_bf16 v134, v45, v141
    v_dot2c_f32_bf16 v135, v45, v149
    v_dot2c_f32_bf16 v136, v46, v141
    v_dot2c_f32_bf16 v137, v46, v149
    v_dot2c_f32_bf16 v138, v47, v141
    v_dot2c_f32_bf16 v139, v47, v149
    v_dot2c_f32_bf16 v156, v48, v141
    v_dot2c_f32_bf16 v157, v48, v149
    buffer_load_dwordx4 a[12:15], v5, s[40:43], s20 offen offset:1024 sc1
    v_dot2c_f32_bf16 v158, v49, v141
    v_dot2c_f32_bf16 v159, v49, v149
    v_dot2c_f32_bf16 v17, v50, v141
    v_dot2c_f32_bf16 v18, v50, v149
    v_dot2c_f32_bf16 v128, v66, v142
    v_dot2c_f32_bf16 v129, v66, v150
    v_dot2c_f32_bf16 v130, v67, v142
    v_dot2c_f32_bf16 v131, v67, v150
    v_dot2c_f32_bf16 v132, v56, v142
    v_dot2c_f32_bf16 v133, v56, v150
    v_dot2c_f32_bf16 v134, v57, v142
    v_dot2c_f32_bf16 v135, v57, v150
    v_dot2c_f32_bf16 v136, v58, v142
    v_dot2c_f32_bf16 v137, v58, v150
    buffer_load_dwordx4 a[20:23], v5, s[40:43], s20 offen offset:2048 sc1
    v_dot2c_f32_bf16 v138, v59, v142
    v_dot2c_f32_bf16 v139, v59, v150
    v_dot2c_f32_bf16 v156, v60, v142
    v_dot2c_f32_bf16 v157, v60, v150
    v_dot2c_f32_bf16 v158, v61, v142
    v_dot2c_f32_bf16 v159, v61, v150
    v_dot2c_f32_bf16 v17, v62, v142
    v_dot2c_f32_bf16 v18, v62, v150
    v_dot2c_f32_bf16 v128, v78, v143
    v_dot2c_f32_bf16 v129, v78, v151
    v_dot2c_f32_bf16 v130, v79, v143
    v_dot2c_f32_bf16 v131, v79, v151
    v_dot2c_f32_bf16 v132, v68, v143
    v_dot2c_f32_bf16 v133, v68, v151
    buffer_load_dwordx4 a[28:31], v5, s[40:43], s20 offen offset:3072 sc1
    s_xor_b32 s20, s20, 4096
    v_dot2c_f32_bf16 v134, v69, v143
    v_dot2c_f32_bf16 v135, v69, v151
    v_dot2c_f32_bf16 v136, v70, v143
    v_dot2c_f32_bf16 v137, v70, v151
    v_dot2c_f32_bf16 v138, v71, v143
    v_dot2c_f32_bf16 v139, v71, v151
    v_dot2c_f32_bf16 v156, v72, v143
    v_dot2c_f32_bf16 v157, v72, v151
    v_dot2c_f32_bf16 v158, v73, v143
    v_dot2c_f32_bf16 v159, v73, v151
    v_dot2c_f32_bf16 v17, v74, v143
    v_dot2c_f32_bf16 v18, v74, v151
    v_dot2c_f32_bf16 v128, v90, v144
    v_dot2c_f32_bf16 v129, v90, v152
    v_dot2c_f32_bf16 v130, v91, v144
    v_dot2c_f32_bf16 v131, v91, v152
    s_waitcnt lgkmcnt(0)
    v_dot2c_f32_bf16 v132, v80, v144
    v_dot2c_f32_bf16 v133, v80, v152
    v_dot2c_f32_bf16 v134, v81, v144
    v_dot2c_f32_bf16 v135, v81, v152
    v_dot2c_f32_bf16 v136, v82, v144
    v_dot2c_f32_bf16 v137, v82, v152
    v_dot2c_f32_bf16 v138, v83, v144
    v_dot2c_f32_bf16 v139, v83, v152
    v_dot2c_f32_bf16 v156, v84, v144
    v_dot2c_f32_bf16 v157, v84, v152
    v_dot2c_f32_bf16 v158, v85, v144
    v_dot2c_f32_bf16 v159, v85, v152
    v_dot2c_f32_bf16 v17, v86, v144
    v_dot2c_f32_bf16 v18, v86, v152
    v_dot2c_f32_bf16 v128, v102, v145
    v_dot2c_f32_bf16 v129, v102, v153
    v_dot2c_f32_bf16 v130, v103, v145
    v_dot2c_f32_bf16 v131, v103, v153
    v_dot2c_f32_bf16 v132, v92, v145
    v_dot2c_f32_bf16 v133, v92, v153
    v_dot2c_f32_bf16 v134, v93, v145
    v_dot2c_f32_bf16 v135, v93, v153
    v_dot2c_f32_bf16 v136, v94, v145
    v_dot2c_f32_bf16 v137, v94, v153
    v_dot2c_f32_bf16 v138, v95, v145
    v_dot2c_f32_bf16 v139, v95, v153
    v_dot2c_f32_bf16 v156, v96, v145
    v_dot2c_f32_bf16 v157, v96, v153
    v_dot2c_f32_bf16 v158, v97, v145
    v_dot2c_f32_bf16 v159, v97, v153
    v_dot2c_f32_bf16 v17, v98, v145
    v_dot2c_f32_bf16 v18, v98, v153
    v_dot2c_f32_bf16 v128, v114, v146
    v_dot2c_f32_bf16 v129, v114, v154
    v_dot2c_f32_bf16 v130, v115, v146
    v_dot2c_f32_bf16 v131, v115, v154
    v_dot2c_f32_bf16 v132, v104, v146
    v_dot2c_f32_bf16 v133, v104, v154
    v_dot2c_f32_bf16 v134, v105, v146
    v_dot2c_f32_bf16 v135, v105, v154
    v_dot2c_f32_bf16 v136, v106, v146
    v_dot2c_f32_bf16 v137, v106, v154
    v_dot2c_f32_bf16 v138, v107, v146
    v_dot2c_f32_bf16 v139, v107, v154
    v_dot2c_f32_bf16 v156, v108, v146
    v_dot2c_f32_bf16 v157, v108, v154
    v_dot2c_f32_bf16 v158, v109, v146
    v_dot2c_f32_bf16 v159, v109, v154
    v_dot2c_f32_bf16 v17, v110, v146
    v_dot2c_f32_bf16 v18, v110, v154
    v_dot2c_f32_bf16 v128, v126, v147
    v_dot2c_f32_bf16 v129, v126, v155
    v_dot2c_f32_bf16 v130, v127, v147
    v_dot2c_f32_bf16 v131, v127, v155
    v_dot2c_f32_bf16 v132, v116, v147
    v_dot2c_f32_bf16 v133, v116, v155
    v_dot2c_f32_bf16 v134, v117, v147
    v_dot2c_f32_bf16 v135, v117, v155
    v_dot2c_f32_bf16 v136, v118, v147
    v_dot2c_f32_bf16 v137, v118, v155
    v_dot2c_f32_bf16 v138, v119, v147
    v_dot2c_f32_bf16 v139, v119, v155
    v_dot2c_f32_bf16 v156, v120, v147
    v_dot2c_f32_bf16 v157, v120, v155
    v_dot2c_f32_bf16 v158, v121, v147
    v_dot2c_f32_bf16 v159, v121, v155
    v_dot2c_f32_bf16 v17, v122, v147
    v_dot2c_f32_bf16 v18, v122, v155
    v_mov_b32 v89, 0
    v_mov_b32 v90, 0
    v_mov_b32 v91, 0
    v_cvt_pk_bf16_f32 v80, v128, v129
    v_cvt_pk_bf16_f32 v81, v130, v131
    v_cvt_pk_bf16_f32 v82, v132, v133
    v_cvt_pk_bf16_f32 v83, v134, v135
    v_cvt_pk_bf16_f32 v84, v136, v137
    v_cvt_pk_bf16_f32 v85, v138, v139
    v_cvt_pk_bf16_f32 v86, v156, v157
    v_cvt_pk_bf16_f32 v87, v158, v159
    v_cvt_pk_bf16_f32 v88, v17, v18
    v_cmp_gt_u32 vcc, 1, v28
    s_nop 1
    s_and_b64 vcc, vcc, exec
    s_cbranch_scc1 SPIN_ALL
BACK_ALL:
    s_waitcnt vmcnt(0)
    s_barrier
    ds_read_b128 v[104:107], v11 offset:0
    ds_read_b128 v[108:111], v11 offset:8192
    ds_read_b128 v[112:115], v11 offset:16384
    ds_read_b128 v[116:119], v11 offset:24576
    s_waitcnt lgkmcnt(3)
    v_mfma_f32_16x16x32_bf16 v[176:179], v[104:107], a[0:3], 0
    s_lshl3_add_u32 s98, 1, s5
    ds_read_b128 v[120:123], v11 offset:1024
    ds_read_b128 v[124:127], v11 offset:9216
    s_waitcnt lgkmcnt(4)
    v_mfma_f32_16x16x32_bf16 v[176:179], v[108:111], a[8:11], v[176:179]
    s_and_b32 s98, s98, 31
    buffer_load_dwordx4 a[36:39], v5, s[40:43], s20 offen offset:0 sc1
    s_waitcnt lgkmcnt(3)
    v_mfma_f32_16x16x32_bf16 v[176:179], v[112:115], a[16:19], v[176:179]
    s_lshl_b32 s8, s6, 5
    ds_read_b128 v[128:131], v11 offset:17408
    ds_read_b128 v[132:135], v11 offset:25600
    s_waitcnt lgkmcnt(4)
    v_mfma_f32_16x16x32_bf16 v[176:179], v[116:119], a[24:27], v[176:179]
    s_add_u32 s98, s98, s8
    buffer_load_dwordx4 a[44:47], v5, s[40:43], s20 offen offset:1024 sc1
    v_mfma_f32_16x16x32_bf16 v[180:183], v[104:107], a[4:7], 0
    s_mul_i32 s98, s98, 3
    ds_read_b128 v[136:139], v11 offset:2048
    ds_read_b128 v[140:143], v11 offset:10240
    v_mfma_f32_16x16x32_bf16 v[180:183], v[108:111], a[12:15], v[180:183]
    s_sub_u32 s98, s98, 1
    ds_read_b128 v[144:147], v11 offset:18432
    v_mov_b32 v16, 0x44444444
    v_mfma_f32_16x16x32_bf16 v[180:183], v[112:115], a[20:23], v[180:183]
    s_add_u32 s98, s98, 3
    ds_read_b128 v[148:151], v11 offset:26624
    v_mfma_f32_16x16x32_bf16 v[180:183], v[116:119], a[28:31], v[180:183]
    s_lshl2_add_u32 s98, s98, s4
    buffer_load_dwordx4 a[52:55], v5, s[40:43], s20 offen offset:2048 sc1
    s_waitcnt lgkmcnt(4)
    v_mfma_f32_16x16x32_bf16 v[184:187], v[120:123], a[0:3], 0
    s_mul_i32 s8, s98, 3072
    ds_read_b128 v[104:107], v11 offset:3072
    ds_read_b128 v[108:111], v11 offset:11264
    v_mfma_f32_16x16x32_bf16 v[184:187], v[124:127], a[8:11], v[184:187]
    s_lshl3_add_u32 s98, 2, s5
    ds_read_b128 v[112:115], v11 offset:19456
    v_mfma_f32_16x16x32_bf16 v[184:187], v[128:131], a[16:19], v[184:187]
    s_and_b32 s98, s98, 31
    ds_read_b128 v[116:119], v11 offset:27648
    v_mfma_f32_16x16x32_bf16 v[184:187], v[132:135], a[24:27], v[184:187]
    s_lshl_b32 s9, s6, 5
    buffer_load_dwordx4 a[60:63], v5, s[40:43], s20 offen offset:3072 sc1
    v_mfma_f32_16x16x32_bf16 v[188:191], v[120:123], a[4:7], 0
    s_xor_b32 s20, s20, 12288
    ds_read_b128 v[120:123], v11 offset:4096
    v_mfma_f32_16x16x32_bf16 v[188:191], v[124:127], a[12:15], v[188:191]
    s_add_u32 s98, s98, s9
    ds_read_b128 v[124:127], v11 offset:12288
    v_mfma_f32_16x16x32_bf16 v[188:191], v[128:131], a[20:23], v[188:191]
    s_mul_i32 s98, s98, 3
    ds_read_b128 v[128:131], v11 offset:20480
    v_mfma_f32_16x16x32_bf16 v[188:191], v[132:135], a[28:31], v[188:191]
    s_sub_u32 s98, s98, 2
    buffer_load_dwordx4 a[68:71], v5, s[40:43], s20 offen offset:0 sc1
    s_waitcnt lgkmcnt(3)
    v_mfma_f32_16x16x32_bf16 v[192:195], v[136:139], a[0:3], 0
    s_add_u32 s98, s98, 3
    ds_read_b128 v[132:135], v11 offset:28672
    v_mfma_f32_16x16x32_bf16 v[192:195], v[140:143], a[8:11], v[192:195]
    s_lshl2_add_u32 s98, s98, s4
    v_mfma_f32_16x16x32_bf16 v[192:195], v[144:147], a[16:19], v[192:195]
    s_mul_i32 s9, s98, 3072
    buffer_load_dwordx4 a[76:79], v5, s[40:43], s20 offen offset:1024 sc1
    v_mfma_f32_16x16x32_bf16 v[192:195], v[148:151], a[24:27], v[192:195]
    s_lshl3_add_u32 s98, 3, s5
    v_mfma_f32_16x16x32_bf16 v[196:199], v[136:139], a[4:7], 0
    s_and_b32 s98, s98, 31
    ds_read_b128 v[136:139], v11 offset:5120
    v_mfma_f32_16x16x32_bf16 v[196:199], v[140:143], a[12:15], v[196:199]
    s_lshl_b32 s10, s6, 5
    ds_read_b128 v[140:143], v11 offset:13312
    v_mfma_f32_16x16x32_bf16 v[196:199], v[144:147], a[20:23], v[196:199]
    s_add_u32 s98, s98, s10
    buffer_load_dwordx4 a[84:87], v5, s[40:43], s20 offen offset:2048 sc1
    v_mfma_f32_16x16x32_bf16 v[196:199], v[148:151], a[28:31], v[196:199]
    s_mul_i32 s98, s98, 3
    ds_read_b128 v[144:147], v11 offset:21504
    ds_read_b128 v[148:151], v11 offset:29696
    v_mfma_f32_16x16x32_bf16 v[200:203], v[104:107], a[0:3], 0
    s_sub_u32 s98, s98, 3
    v_mfma_f32_16x16x32_bf16 v[200:203], v[108:111], a[8:11], v[200:203]
    s_add_u32 s98, s98, 3
    v_mfma_f32_16x16x32_bf16 v[200:203], v[112:115], a[16:19], v[200:203]
    s_lshl2_add_u32 s98, s98, s4
    buffer_load_dwordx4 a[92:95], v5, s[40:43], s20 offen offset:3072 sc1
    v_mfma_f32_16x16x32_bf16 v[200:203], v[116:119], a[24:27], v[200:203]
    s_xor_b32 s20, s20, 4096
    v_mfma_f32_16x16x32_bf16 v[204:207], v[104:107], a[4:7], 0
    s_mul_i32 s10, s98, 3072
    ds_read_b128 v[104:107], v11 offset:6144
    v_mfma_f32_16x16x32_bf16 v[204:207], v[108:111], a[12:15], v[204:207]
    s_sub_u32 s99, s4, s61
    ds_read_b128 v[108:111], v11 offset:14336
    v_mfma_f32_16x16x32_bf16 v[204:207], v[112:115], a[20:23], v[204:207]
    s_and_b32 s99, s99, 3
    buffer_store_dwordx4 v[80:83], v15, s[40:43], s71 offen offset:0 sc1
    v_mfma_f32_16x16x32_bf16 v[204:207], v[116:119], a[28:31], v[204:207]
    s_lshl3_add_u32 s98, s99, s5
    ds_read_b128 v[112:115], v11 offset:22528
    ds_read_b128 v[116:119], v11 offset:30720
    s_waitcnt lgkmcnt(4)
    v_mfma_f32_16x16x32_bf16 v[208:211], v[120:123], a[0:3], 0
    s_and_b32 s98, s98, 31
    v_mfma_f32_16x16x32_bf16 v[208:211], v[124:127], a[8:11], v[208:211]
    s_lshl_b32 s11, s6, 5
    v_mfma_f32_16x16x32_bf16 v[208:211], v[128:131], a[16:19], v[208:211]
    s_add_u32 s98, s98, s11
    buffer_store_dwordx4 v[84:87], v15, s[40:43], s71 offen offset:256 sc1
    v_mfma_f32_16x16x32_bf16 v[208:211], v[132:135], a[24:27], v[208:211]
    s_mul_i32 s98, s98, 3
    v_mfma_f32_16x16x32_bf16 v[212:215], v[120:123], a[4:7], 0
    s_sub_u32 s98, s98, s99
    ds_read_b128 v[120:123], v12 offset:0
    v_mfma_f32_16x16x32_bf16 v[212:215], v[124:127], a[12:15], v[212:215]
    s_add_u32 s98, s98, 3
    buffer_store_dwordx4 v[88:91], v15, s[40:43], s70 offen offset:0 sc1
    v_mfma_f32_16x16x32_bf16 v[212:215], v[128:131], a[20:23], v[212:215]
    s_xor_b32 s21, s3, 3
    ds_read_b128 v[124:127], v12 offset:8192
    ds_read_b128 v[128:131], v12 offset:16384
    v_mfma_f32_16x16x32_bf16 v[212:215], v[132:135], a[28:31], v[212:215]
    s_lshl2_add_u32 s21, s21, s4
    ds_read_b128 v[132:135], v12 offset:24576
    v_mfma_f32_16x16x32_bf16 v[216:219], v[136:139], a[0:3], 0
    s_mul_i32 s21, s21, 36864
    v_mfma_f32_16x16x32_bf16 v[216:219], v[140:143], a[8:11], v[216:219]
    s_add_u32 s21, s21, s28
    s_mov_b32 m0, s47
    v_mfma_f32_16x16x32_bf16 v[216:219], v[144:147], a[16:19], v[216:219]
    s_lshl2_add_u32 s98, s98, s4
    buffer_load_dwordx4 v1, s[56:59], s21 offen sc1 lds
    v_mfma_f32_16x16x32_bf16 v[216:219], v[148:151], a[24:27], v[216:219]
    s_waitcnt vmcnt(8)
    v_mfma_f32_16x16x32_bf16 v[220:223], v[136:139], a[4:7], 0
    s_mul_i32 s11, s98, 3072
    ds_read_b128 v[136:139], v12 offset:1024
    v_mfma_f32_16x16x32_bf16 v[220:223], v[140:143], a[12:15], v[220:223]
    buffer_load_dwordx4 v1, s[56:59], s21 offen offset:1024 sc1 lds
    v_mfma_f32_16x16x32_bf16 v[220:223], v[144:147], a[20:23], v[220:223]
    ds_read_b128 v[140:143], v12 offset:9216
    ds_read_b128 v[144:147], v12 offset:17408
    v_mfma_f32_16x16x32_bf16 v[220:223], v[148:151], a[28:31], v[220:223]
    s_waitcnt lgkmcnt(3)
    ds_read_b128 v[148:151], v12 offset:25600
    v_mfma_f32_16x16x32_bf16 v[224:227], v[104:107], a[0:3], 0
    s_cmp_eq_u32 s99, 0
    s_cselect_b32 s11, 1073741824, s11
    v_mfma_f32_16x16x32_bf16 v[224:227], v[108:111], a[8:11], v[224:227]
    buffer_load_dwordx4 v1, s[56:59], s21 offen offset:2048 sc1 lds
    v_mfma_f32_16x16x32_bf16 v[224:227], v[112:115], a[16:19], v[224:227]
    v_mfma_f32_16x16x32_bf16 v[224:227], v[116:119], a[24:27], v[224:227]
    v_mfma_f32_16x16x32_bf16 v[228:231], v[104:107], a[4:7], 0
    ds_read_b128 v[104:107], v12 offset:2048
    v_mfma_f32_16x16x32_bf16 v[228:231], v[108:111], a[12:15], v[228:231]
    buffer_load_dwordx4 v1, s[56:59], s21 offen offset:3072 sc1 lds
    v_mfma_f32_16x16x32_bf16 v[228:231], v[112:115], a[20:23], v[228:231]
    s_add_u32 s21, s21, 4096
    ds_read_b128 v[108:111], v12 offset:10240
    ds_read_b128 v[112:115], v12 offset:18432
    v_mfma_f32_16x16x32_bf16 v[228:231], v[116:119], a[28:31], v[228:231]
    s_add_u32 m0, s47, 4096
    ds_read_b128 v[116:119], v12 offset:26624
    v_mfma_f32_16x16x32_bf16 v[176:179], v[120:123], a[32:35], v[176:179]
    buffer_load_dwordx4 v1, s[56:59], s21 offen sc1 lds
    v_mfma_f32_16x16x32_bf16 v[176:179], v[124:127], a[40:43], v[176:179]
    v_mfma_f32_16x16x32_bf16 v[176:179], v[128:131], a[48:51], v[176:179]
    v_mfma_f32_16x16x32_bf16 v[176:179], v[132:135], a[56:59], v[176:179]
    v_mfma_f32_16x16x32_bf16 v[180:183], v[120:123], a[36:39], v[180:183]
    buffer_load_dwordx4 v1, s[56:59], s21 offen offset:1024 sc1 lds
    v_mfma_f32_16x16x32_bf16 v[180:183], v[124:127], a[44:47], v[180:183]
    ds_read_b128 v[120:123], v12 offset:3072
    ds_read_b128 v[124:127], v12 offset:11264
    v_mfma_f32_16x16x32_bf16 v[180:183], v[128:131], a[52:55], v[180:183]
    ds_read_b128 v[128:131], v12 offset:19456
    v_mfma_f32_16x16x32_bf16 v[180:183], v[132:135], a[60:63], v[180:183]
    s_waitcnt lgkmcnt(3)
    ds_read_b128 v[132:135], v12 offset:27648
    v_mfma_f32_16x16x32_bf16 v[184:187], v[136:139], a[32:35], v[184:187]
    buffer_load_dwordx4 v1, s[56:59], s21 offen offset:2048 sc1 lds
    v_mfma_f32_16x16x32_bf16 v[184:187], v[140:143], a[40:43], v[184:187]
    v_mfma_f32_16x16x32_bf16 v[184:187], v[144:147], a[48:51], v[184:187]
    v_mfma_f32_16x16x32_bf16 v[184:187], v[148:151], a[56:59], v[184:187]
    v_mfma_f32_16x16x32_bf16 v[188:191], v[136:139], a[36:39], v[188:191]
    buffer_load_dwordx4 a[96:99], v4, s[40:43], s63 offen offset:0 sc1
    v_mfma_f32_16x16x32_bf16 v[188:191], v[140:143], a[44:47], v[188:191]
    ds_read_b128 v[136:139], v12 offset:4096
    ds_read_b128 v[140:143], v12 offset:12288
    v_mfma_f32_16x16x32_bf16 v[188:191], v[144:147], a[52:55], v[188:191]
    ds_read_b128 v[144:147], v12 offset:20480
    v_mfma_f32_16x16x32_bf16 v[188:191], v[148:151], a[60:63], v[188:191]
    ds_read_b128 v[148:151], v12 offset:28672
    v_mfma_f32_16x16x32_bf16 v[192:195], v[104:107], a[32:35], v[192:195]
    buffer_load_dwordx4 a[104:107], v4, s[40:43], s63 offen offset:1024 sc1
    v_mfma_f32_16x16x32_bf16 v[192:195], v[108:111], a[40:43], v[192:195]
    v_mfma_f32_16x16x32_bf16 v[192:195], v[112:115], a[48:51], v[192:195]
    v_mfma_f32_16x16x32_bf16 v[192:195], v[116:119], a[56:59], v[192:195]
    buffer_load_dwordx4 a[112:115], v4, s[40:43], s63 offen offset:2048 sc1
    v_mfma_f32_16x16x32_bf16 v[196:199], v[104:107], a[36:39], v[196:199]
    ds_read_b128 v[104:107], v12 offset:5120
    v_mfma_f32_16x16x32_bf16 v[196:199], v[108:111], a[44:47], v[196:199]
    ds_read_b128 v[108:111], v12 offset:13312
    v_mfma_f32_16x16x32_bf16 v[196:199], v[112:115], a[52:55], v[196:199]
    ds_read_b128 v[112:115], v12 offset:21504
    v_mfma_f32_16x16x32_bf16 v[196:199], v[116:119], a[60:63], v[196:199]
    s_waitcnt lgkmcnt(3)
    buffer_load_dwordx4 a[120:123], v4, s[40:43], s63 offen offset:3072 sc1
    v_mfma_f32_16x16x32_bf16 v[200:203], v[120:123], a[32:35], v[200:203]
    s_xor_b32 s63, s63, 28672
    ds_read_b128 v[116:119], v12 offset:29696
    v_mfma_f32_16x16x32_bf16 v[200:203], v[124:127], a[40:43], v[200:203]
    v_mfma_f32_16x16x32_bf16 v[200:203], v[128:131], a[48:51], v[200:203]
    v_mfma_f32_16x16x32_bf16 v[200:203], v[132:135], a[56:59], v[200:203]
    buffer_load_dwordx4 a[100:103], v5, s[40:43], s20 offen offset:0 sc1
    v_mfma_f32_16x16x32_bf16 v[204:207], v[120:123], a[36:39], v[204:207]
    ds_read_b128 v[120:123], v12 offset:6144
    v_mfma_f32_16x16x32_bf16 v[204:207], v[124:127], a[44:47], v[204:207]
    ds_read_b128 v[124:127], v12 offset:14336
    v_mfma_f32_16x16x32_bf16 v[204:207], v[128:131], a[52:55], v[204:207]
    ds_read_b128 v[128:131], v12 offset:22528
    v_mfma_f32_16x16x32_bf16 v[204:207], v[132:135], a[60:63], v[204:207]
    buffer_load_dwordx4 a[108:111], v5, s[40:43], s20 offen offset:1024 sc1
    v_mfma_f32_16x16x32_bf16 v[208:211], v[136:139], a[32:35], v[208:211]
    ds_read_b128 v[132:135], v12 offset:30720
    v_mfma_f32_16x16x32_bf16 v[208:211], v[140:143], a[40:43], v[208:211]
    v_mfma_f32_16x16x32_bf16 v[208:211], v[144:147], a[48:51], v[208:211]
    v_mfma_f32_16x16x32_bf16 v[208:211], v[148:151], a[56:59], v[208:211]
    buffer_load_dwordx4 a[116:119], v5, s[40:43], s20 offen offset:2048 sc1
    v_mfma_f32_16x16x32_bf16 v[212:215], v[136:139], a[36:39], v[212:215]
    ds_read_b128 v[136:139], v13 offset:0
    v_mfma_f32_16x16x32_bf16 v[212:215], v[140:143], a[44:47], v[212:215]
    ds_read_b128 v[140:143], v13 offset:8192
    v_mfma_f32_16x16x32_bf16 v[212:215], v[144:147], a[52:55], v[212:215]
    buffer_load_dwordx4 a[124:127], v5, s[40:43], s20 offen offset:3072 sc1
    v_mfma_f32_16x16x32_bf16 v[212:215], v[148:151], a[60:63], v[212:215]
    s_xor_b32 s21, s3, 4
    ds_read_b128 v[144:147], v13 offset:16384
    ds_read_b128 v[148:151], v13 offset:24576
    s_waitcnt lgkmcnt(4)
    v_mfma_f32_16x16x32_bf16 v[216:219], v[104:107], a[32:35], v[216:219]
    s_lshl2_add_u32 s21, s21, s4
    v_mfma_f32_16x16x32_bf16 v[216:219], v[108:111], a[40:43], v[216:219]
    s_mul_i32 s21, s21, 36864
    v_mfma_f32_16x16x32_bf16 v[216:219], v[112:115], a[48:51], v[216:219]
    s_add_u32 s21, s21, s28
    s_mov_b32 m0, s79
    v_mfma_f32_16x16x32_bf16 v[216:219], v[116:119], a[56:59], v[216:219]
    s_xor_b32 s20, s20, 28672
    buffer_load_dwordx4 v1, s[56:59], s21 offen sc1 lds
    s_waitcnt vmcnt(19)
    s_barrier
    v_mfma_f32_16x16x32_bf16 v[220:223], v[104:107], a[36:39], v[220:223]
    ds_read_b128 v[104:107], v13 offset:1024
    v_mfma_f32_16x16x32_bf16 v[220:223], v[108:111], a[44:47], v[220:223]
    ds_read_b128 v[108:111], v13 offset:9216
    v_mfma_f32_16x16x32_bf16 v[220:223], v[112:115], a[52:55], v[220:223]
    buffer_load_dwordx4 v1, s[56:59], s21 offen offset:1024 sc1 lds
    v_mfma_f32_16x16x32_bf16 v[220:223], v[116:119], a[60:63], v[220:223]
    ds_read_b128 v[112:115], v13 offset:17408
    ds_read_b128 v[116:119], v13 offset:25600
    v_mfma_f32_16x16x32_bf16 v[224:227], v[120:123], a[32:35], v[224:227]
    v_mfma_f32_16x16x32_bf16 v[224:227], v[124:127], a[40:43], v[224:227]
    v_mfma_f32_16x16x32_bf16 v[224:227], v[128:131], a[48:51], v[224:227]
    buffer_load_dwordx4 v1, s[56:59], s21 offen offset:2048 sc1 lds
    v_mfma_f32_16x16x32_bf16 v[224:227], v[132:135], a[56:59], v[224:227]
    v_mfma_f32_16x16x32_bf16 v[228:231], v[120:123], a[36:39], v[228:231]
    ds_read_b128 v[120:123], v13 offset:2048
    v_mfma_f32_16x16x32_bf16 v[228:231], v[124:127], a[44:47], v[228:231]
    ds_read_b128 v[124:127], v13 offset:10240
    v_mfma_f32_16x16x32_bf16 v[228:231], v[128:131], a[52:55], v[228:231]
    buffer_load_dwordx4 v1, s[56:59], s21 offen offset:3072 sc1 lds
    v_mfma_f32_16x16x32_bf16 v[228:231], v[132:135], a[60:63], v[228:231]
    s_add_u32 s21, s21, 4096
    ds_read_b128 v[128:131], v13 offset:18432
    ds_read_b128 v[132:135], v13 offset:26624
    s_waitcnt lgkmcnt(4)
    v_mfma_f32_16x16x32_bf16 v[176:179], v[136:139], a[64:67], v[176:179]
    s_add_u32 m0, s79, 4096
    v_mfma_f32_16x16x32_bf16 v[176:179], v[140:143], a[72:75], v[176:179]
    buffer_load_dwordx4 v1, s[56:59], s21 offen sc1 lds
    v_mfma_f32_16x16x32_bf16 v[176:179], v[144:147], a[80:83], v[176:179]
    v_mfma_f32_16x16x32_bf16 v[176:179], v[148:151], a[88:91], v[176:179]
    v_mfma_f32_16x16x32_bf16 v[180:183], v[136:139], a[68:71], v[180:183]
    ds_read_b128 v[136:139], v13 offset:3072
    v_mfma_f32_16x16x32_bf16 v[180:183], v[140:143], a[76:79], v[180:183]
    buffer_load_dwordx4 v1, s[56:59], s21 offen offset:1024 sc1 lds
    v_mfma_f32_16x16x32_bf16 v[180:183], v[144:147], a[84:87], v[180:183]
    ds_read_b128 v[140:143], v13 offset:11264
    ds_read_b128 v[144:147], v13 offset:19456
    v_mfma_f32_16x16x32_bf16 v[180:183], v[148:151], a[92:95], v[180:183]
    ds_read_b128 v[148:151], v13 offset:27648
    v_mfma_f32_16x16x32_bf16 v[184:187], v[104:107], a[64:67], v[184:187]
    v_mfma_f32_16x16x32_bf16 v[184:187], v[108:111], a[72:75], v[184:187]
    buffer_load_dwordx4 v1, s[56:59], s21 offen offset:2048 sc1 lds
    v_mfma_f32_16x16x32_bf16 v[184:187], v[112:115], a[80:83], v[184:187]
    v_mfma_f32_16x16x32_bf16 v[184:187], v[116:119], a[88:91], v[184:187]
    v_mfma_f32_16x16x32_bf16 v[188:191], v[104:107], a[68:71], v[188:191]
    ds_read_b128 v[104:107], v13 offset:4096
    v_mfma_f32_16x16x32_bf16 v[188:191], v[108:111], a[76:79], v[188:191]
    buffer_load_dwordx4 a[128:131], v4, s[40:43], s63 offen offset:0 sc1
    v_mfma_f32_16x16x32_bf16 v[188:191], v[112:115], a[84:87], v[188:191]
    ds_read_b128 v[108:111], v13 offset:12288
    ds_read_b128 v[112:115], v13 offset:20480
    v_mfma_f32_16x16x32_bf16 v[188:191], v[116:119], a[92:95], v[188:191]
    s_waitcnt lgkmcnt(3)
    ds_read_b128 v[116:119], v13 offset:28672
    v_mfma_f32_16x16x32_bf16 v[192:195], v[120:123], a[64:67], v[192:195]
    v_mfma_f32_16x16x32_bf16 v[192:195], v[124:127], a[72:75], v[192:195]
    buffer_load_dwordx4 a[136:139], v4, s[40:43], s63 offen offset:1024 sc1
    v_mfma_f32_16x16x32_bf16 v[192:195], v[128:131], a[80:83], v[192:195]
    v_mfma_f32_16x16x32_bf16 v[192:195], v[132:135], a[88:91], v[192:195]
    v_mfma_f32_16x16x32_bf16 v[196:199], v[120:123], a[68:71], v[196:199]
    buffer_load_dwordx4 a[144:147], v4, s[40:43], s63 offen offset:2048 sc1
    v_mfma_f32_16x16x32_bf16 v[196:199], v[124:127], a[76:79], v[196:199]
    ds_read_b128 v[120:123], v13 offset:5120
    ds_read_b128 v[124:127], v13 offset:13312
    v_mfma_f32_16x16x32_bf16 v[196:199], v[128:131], a[84:87], v[196:199]
    ds_read_b128 v[128:131], v13 offset:21504
    v_mfma_f32_16x16x32_bf16 v[196:199], v[132:135], a[92:95], v[196:199]
    ds_read_b128 v[132:135], v13 offset:29696
    v_mfma_f32_16x16x32_bf16 v[200:203], v[136:139], a[64:67], v[200:203]
    buffer_load_dwordx4 a[152:155], v4, s[40:43], s63 offen offset:3072 sc1
    v_mfma_f32_16x16x32_bf16 v[200:203], v[140:143], a[72:75], v[200:203]
    s_xor_b32 s63, s63, 4096
    v_mfma_f32_16x16x32_bf16 v[200:203], v[144:147], a[80:83], v[200:203]
    v_mfma_f32_16x16x32_bf16 v[200:203], v[148:151], a[88:91], v[200:203]
    v_mfma_f32_16x16x32_bf16 v[204:207], v[136:139], a[68:71], v[204:207]
    buffer_load_dwordx4 a[132:135], v5, s[40:43], s20 offen offset:0 sc1
    v_mfma_f32_16x16x32_bf16 v[204:207], v[140:143], a[76:79], v[204:207]
    ds_read_b128 v[136:139], v13 offset:6144
    ds_read_b128 v[140:143], v13 offset:14336
    v_mfma_f32_16x16x32_bf16 v[204:207], v[144:147], a[84:87], v[204:207]
    ds_read_b128 v[144:147], v13 offset:22528
    v_mfma_f32_16x16x32_bf16 v[204:207], v[148:151], a[92:95], v[204:207]
    s_waitcnt lgkmcnt(3)
    ds_read_b128 v[148:151], v13 offset:30720
    v_mfma_f32_16x16x32_bf16 v[208:211], v[104:107], a[64:67], v[208:211]
    buffer_load_dwordx4 a[140:143], v5, s[40:43], s20 offen offset:1024 sc1
    v_mfma_f32_16x16x32_bf16 v[208:211], v[108:111], a[72:75], v[208:211]
    v_mfma_f32_16x16x32_bf16 v[208:211], v[112:115], a[80:83], v[208:211]
    v_mfma_f32_16x16x32_bf16 v[208:211], v[116:119], a[88:91], v[208:211]
    v_mfma_f32_16x16x32_bf16 v[212:215], v[104:107], a[68:71], v[212:215]
    buffer_load_dwordx4 a[148:151], v5, s[40:43], s20 offen offset:2048 sc1
    v_mfma_f32_16x16x32_bf16 v[212:215], v[108:111], a[76:79], v[212:215]
    v_mfma_f32_16x16x32_bf16 v[212:215], v[112:115], a[84:87], v[212:215]
    v_mfma_f32_16x16x32_bf16 v[212:215], v[116:119], a[92:95], v[212:215]
    buffer_load_dwordx4 a[156:159], v5, s[40:43], s20 offen offset:3072 sc1
    v_mfma_f32_16x16x32_bf16 v[216:219], v[120:123], a[64:67], v[216:219]
    s_xor_b32 s21, s3, 5
    v_mfma_f32_16x16x32_bf16 v[216:219], v[124:127], a[72:75], v[216:219]
    s_lshl2_add_u32 s21, s21, s4
    v_mfma_f32_16x16x32_bf16 v[216:219], v[128:131], a[80:83], v[216:219]
    s_mul_i32 s21, s21, 36864
    v_mfma_f32_16x16x32_bf16 v[216:219], v[132:135], a[88:91], v[216:219]
    s_add_u32 s21, s21, s28
    s_mov_b32 m0, s44
    s_waitcnt vmcnt(15)
    s_barrier
    v_mfma_f32_16x16x32_bf16 v[220:223], v[120:123], a[68:71], v[220:223]
    s_xor_b32 s20, s20, 4096
    buffer_load_dwordx4 v1, s[56:59], s21 offen sc1 lds
    v_mfma_f32_16x16x32_bf16 v[220:223], v[124:127], a[76:79], v[220:223]
    v_mov_b32 v31, 3
    ds_read_b128 v[104:107], v6 offset:0
    v_mfma_f32_16x16x32_bf16 v[220:223], v[128:131], a[84:87], v[220:223]
    buffer_store_dword v31, v30, s[32:35], s101 offen sc1
    v_mfma_f32_16x16x32_bf16 v[220:223], v[132:135], a[92:95], v[220:223]
    s_waitcnt lgkmcnt(1)
    ds_read_b128 v[108:111], v6 offset:8192
    ds_read_b128 v[112:115], v6 offset:16384
    v_mfma_f32_16x16x32_bf16 v[224:227], v[136:139], a[64:67], v[224:227]
    buffer_load_dwordx4 v1, s[56:59], s21 offen offset:1024 sc1 lds
    v_mfma_f32_16x16x32_bf16 v[224:227], v[140:143], a[72:75], v[224:227]
    ds_read_b128 v[116:119], v6 offset:24576
    ds_read_b128 v[120:123], v6 offset:1024
    v_mfma_f32_16x16x32_bf16 v[224:227], v[144:147], a[80:83], v[224:227]
    ds_read_b128 v[124:127], v6 offset:9216
    v_mfma_f32_16x16x32_bf16 v[224:227], v[148:151], a[88:91], v[224:227]
    buffer_load_dwordx4 v1, s[56:59], s21 offen offset:2048 sc1 lds
    v_mfma_f32_16x16x32_bf16 v[228:231], v[136:139], a[68:71], v[228:231]
    ds_read_b128 v[128:131], v6 offset:17408
    ds_read_b128 v[132:135], v6 offset:25600
    v_mfma_f32_16x16x32_bf16 v[228:231], v[140:143], a[76:79], v[228:231]
    ds_read_b128 v[136:139], v6 offset:2048
    v_mfma_f32_16x16x32_bf16 v[228:231], v[144:147], a[84:87], v[228:231]
    ds_read_b128 v[140:143], v6 offset:10240
    v_mfma_f32_16x16x32_bf16 v[228:231], v[148:151], a[92:95], v[228:231]
    s_waitcnt lgkmcnt(4)
    buffer_load_dwordx4 v1, s[56:59], s21 offen offset:3072 sc1 lds
    v_mfma_f32_16x16x32_bf16 v[176:179], v[104:107], a[96:99], v[176:179]
    s_add_u32 s21, s21, 4096
    ds_read_b128 v[144:147], v6 offset:18432
    ds_read_b128 v[148:151], v6 offset:26624
    v_mfma_f32_16x16x32_bf16 v[176:179], v[108:111], a[104:107], v[176:179]
    s_add_u32 m0, s44, 4096
    v_mfma_f32_16x16x32_bf16 v[176:179], v[112:115], a[112:115], v[176:179]
    v_mfma_f32_16x16x32_bf16 v[176:179], v[116:119], a[120:123], v[176:179]
    buffer_load_dwordx4 v1, s[56:59], s21 offen sc1 lds
    v_mfma_f32_16x16x32_bf16 v[180:183], v[104:107], a[100:103], v[180:183]
    ds_read_b128 v[104:107], v6 offset:3072
    v_mfma_f32_16x16x32_bf16 v[180:183], v[108:111], a[108:111], v[180:183]
    ds_read_b128 v[108:111], v6 offset:11264
    v_mfma_f32_16x16x32_bf16 v[180:183], v[112:115], a[116:119], v[180:183]
    buffer_load_dwordx4 v1, s[56:59], s21 offen offset:1024 sc1 lds
    v_mfma_f32_16x16x32_bf16 v[180:183], v[116:119], a[124:127], v[180:183]
    ds_read_b128 v[112:115], v6 offset:19456
    ds_read_b128 v[116:119], v6 offset:27648
    v_mfma_f32_16x16x32_bf16 v[184:187], v[120:123], a[96:99], v[184:187]
    v_mfma_f32_16x16x32_bf16 v[184:187], v[124:127], a[104:107], v[184:187]
    s_waitcnt lgkmcnt(3)
    v_mfma_f32_16x16x32_bf16 v[184:187], v[128:131], a[112:115], v[184:187]
    buffer_load_dwordx4 v1, s[56:59], s21 offen offset:2048 sc1 lds
    v_mfma_f32_16x16x32_bf16 v[184:187], v[132:135], a[120:123], v[184:187]
    v_mfma_f32_16x16x32_bf16 v[188:191], v[120:123], a[100:103], v[188:191]
    ds_read_b128 v[120:123], v6 offset:4096
    v_mfma_f32_16x16x32_bf16 v[188:191], v[124:127], a[108:111], v[188:191]
    ds_read_b128 v[124:127], v6 offset:12288
    v_mfma_f32_16x16x32_bf16 v[188:191], v[128:131], a[116:119], v[188:191]
    buffer_load_dwordx4 a[160:163], v4, s[40:43], s63 offen offset:0 sc1
    v_mfma_f32_16x16x32_bf16 v[188:191], v[132:135], a[124:127], v[188:191]
    ds_read_b128 v[128:131], v6 offset:20480
    ds_read_b128 v[132:135], v6 offset:28672
    v_mfma_f32_16x16x32_bf16 v[192:195], v[136:139], a[96:99], v[192:195]
    v_mfma_f32_16x16x32_bf16 v[192:195], v[140:143], a[104:107], v[192:195]
    v_mfma_f32_16x16x32_bf16 v[192:195], v[144:147], a[112:115], v[192:195]
    buffer_load_dwordx4 a[168:171], v4, s[40:43], s63 offen offset:1024 sc1
    v_mfma_f32_16x16x32_bf16 v[192:195], v[148:151], a[120:123], v[192:195]
    v_mfma_f32_16x16x32_bf16 v[196:199], v[136:139], a[100:103], v[196:199]
    ds_read_b128 v[136:139], v6 offset:5120
    v_mfma_f32_16x16x32_bf16 v[196:199], v[140:143], a[108:111], v[196:199]
    buffer_load_dwordx4 a[176:179], v4, s[40:43], s63 offen offset:2048 sc1
    v_mfma_f32_16x16x32_bf16 v[196:199], v[144:147], a[116:119], v[196:199]
    ds_read_b128 v[140:143], v6 offset:13312
    ds_read_b128 v[144:147], v6 offset:21504
    v_mfma_f32_16x16x32_bf16 v[196:199], v[148:151], a[124:127], v[196:199]
    ds_read_b128 v[148:151], v6 offset:29696
    v_mfma_f32_16x16x32_bf16 v[200:203], v[104:107], a[96:99], v[200:203]
    s_waitcnt lgkmcnt(4)
    v_mfma_f32_16x16x32_bf16 v[200:203], v[108:111], a[104:107], v[200:203]
    buffer_load_dwordx4 a[184:187], v4, s[40:43], s63 offen offset:3072 sc1
    v_mfma_f32_16x16x32_bf16 v[200:203], v[112:115], a[112:115], v[200:203]
    s_xor_b32 s63, s63, 12288
    v_mfma_f32_16x16x32_bf16 v[200:203], v[116:119], a[120:123], v[200:203]
    v_mfma_f32_16x16x32_bf16 v[204:207], v[104:107], a[100:103], v[204:207]
    ds_read_b128 v[104:107], v6 offset:6144
    v_mfma_f32_16x16x32_bf16 v[204:207], v[108:111], a[108:111], v[204:207]
    buffer_load_dwordx4 a[164:167], v5, s[40:43], s20 offen offset:0 sc1
    v_mfma_f32_16x16x32_bf16 v[204:207], v[112:115], a[116:119], v[204:207]
    ds_read_b128 v[108:111], v6 offset:14336
    ds_read_b128 v[112:115], v6 offset:22528
    v_mfma_f32_16x16x32_bf16 v[204:207], v[116:119], a[124:127], v[204:207]
    ds_read_b128 v[116:119], v6 offset:30720
    v_mfma_f32_16x16x32_bf16 v[208:211], v[120:123], a[96:99], v[208:211]
    v_mfma_f32_16x16x32_bf16 v[208:211], v[124:127], a[104:107], v[208:211]
    buffer_load_dwordx4 a[172:175], v5, s[40:43], s20 offen offset:1024 sc1
    v_mfma_f32_16x16x32_bf16 v[208:211], v[128:131], a[112:115], v[208:211]
    v_mfma_f32_16x16x32_bf16 v[208:211], v[132:135], a[120:123], v[208:211]
    v_mfma_f32_16x16x32_bf16 v[212:215], v[120:123], a[100:103], v[212:215]
    v_mfma_f32_16x16x32_bf16 v[212:215], v[124:127], a[108:111], v[212:215]
    buffer_load_dwordx4 a[180:183], v5, s[40:43], s20 offen offset:2048 sc1
    v_mfma_f32_16x16x32_bf16 v[212:215], v[128:131], a[116:119], v[212:215]
    v_mfma_f32_16x16x32_bf16 v[212:215], v[132:135], a[124:127], v[212:215]
    s_waitcnt lgkmcnt(0)
    v_mfma_f32_16x16x32_bf16 v[216:219], v[136:139], a[96:99], v[216:219]
    buffer_load_dwordx4 a[188:191], v5, s[40:43], s20 offen offset:3072 sc1
    v_mfma_f32_16x16x32_bf16 v[216:219], v[140:143], a[104:107], v[216:219]
    s_xor_b32 s21, s3, 6
    v_mfma_f32_16x16x32_bf16 v[216:219], v[144:147], a[112:115], v[216:219]
    s_lshl2_add_u32 s21, s21, s4
    v_mfma_f32_16x16x32_bf16 v[216:219], v[148:151], a[120:123], v[216:219]
    s_mul_i32 s21, s21, 36864
    s_waitcnt vmcnt(16)
    s_barrier
    v_mfma_f32_16x16x32_bf16 v[220:223], v[136:139], a[100:103], v[220:223]
    s_add_u32 s21, s21, s28
    s_mov_b32 m0, s45
    ds_read_b128 v[120:123], v7 offset:0
    v_mfma_f32_16x16x32_bf16 v[220:223], v[140:143], a[108:111], v[220:223]
    s_xor_b32 s20, s20, 12288
    buffer_load_dwordx4 v1, s[56:59], s21 offen sc1 lds
    v_mfma_f32_16x16x32_bf16 v[220:223], v[144:147], a[116:119], v[220:223]
    ds_read_b128 v[124:127], v7 offset:8192
    ds_read_b128 v[128:131], v7 offset:16384
    v_mfma_f32_16x16x32_bf16 v[220:223], v[148:151], a[124:127], v[220:223]
    ds_read_b128 v[132:135], v7 offset:24576
    v_mfma_f32_16x16x32_bf16 v[224:227], v[104:107], a[96:99], v[224:227]
    buffer_load_dwordx4 v1, s[56:59], s21 offen offset:1024 sc1 lds
    v_mfma_f32_16x16x32_bf16 v[224:227], v[108:111], a[104:107], v[224:227]
    ds_read_b128 v[136:139], v7 offset:1024
    ds_read_b128 v[140:143], v7 offset:9216
    v_mfma_f32_16x16x32_bf16 v[224:227], v[112:115], a[112:115], v[224:227]
    ds_read_b128 v[144:147], v7 offset:17408
    v_mfma_f32_16x16x32_bf16 v[224:227], v[116:119], a[120:123], v[224:227]
    ds_read_b128 v[148:151], v7 offset:25600
    v_mfma_f32_16x16x32_bf16 v[228:231], v[104:107], a[100:103], v[228:231]
    buffer_load_dwordx4 v1, s[56:59], s21 offen offset:2048 sc1 lds
    v_mfma_f32_16x16x32_bf16 v[228:231], v[108:111], a[108:111], v[228:231]
    ds_read_b128 v[104:107], v7 offset:2048
    ds_read_b128 v[108:111], v7 offset:10240
    v_mfma_f32_16x16x32_bf16 v[228:231], v[112:115], a[116:119], v[228:231]
    ds_read_b128 v[112:115], v7 offset:18432
    v_mfma_f32_16x16x32_bf16 v[228:231], v[116:119], a[124:127], v[228:231]
    s_waitcnt lgkmcnt(4)
    buffer_load_dwordx4 v1, s[56:59], s21 offen offset:3072 sc1 lds
    v_mfma_f32_16x16x32_bf16 v[176:179], v[120:123], a[128:131], v[176:179]
    s_add_u32 s21, s21, 4096
    ds_read_b128 v[116:119], v7 offset:26624
    v_mfma_f32_16x16x32_bf16 v[176:179], v[124:127], a[136:139], v[176:179]
    s_add_u32 m0, s45, 4096
    v_mfma_f32_16x16x32_bf16 v[176:179], v[128:131], a[144:147], v[176:179]
    v_mfma_f32_16x16x32_bf16 v[176:179], v[132:135], a[152:155], v[176:179]
    buffer_load_dwordx4 v1, s[56:59], s21 offen sc1 lds
    v_mfma_f32_16x16x32_bf16 v[180:183], v[120:123], a[132:135], v[180:183]
    ds_read_b128 v[120:123], v7 offset:3072
    v_mfma_f32_16x16x32_bf16 v[180:183], v[124:127], a[140:143], v[180:183]
    ds_read_b128 v[124:127], v7 offset:11264
    v_mfma_f32_16x16x32_bf16 v[180:183], v[128:131], a[148:151], v[180:183]
    ds_read_b128 v[128:131], v7 offset:19456
    v_mfma_f32_16x16x32_bf16 v[180:183], v[132:135], a[156:159], v[180:183]
    buffer_load_dwordx4 v1, s[56:59], s21 offen offset:1024 sc1 lds
    v_mfma_f32_16x16x32_bf16 v[184:187], v[136:139], a[128:131], v[184:187]
    ds_read_b128 v[132:135], v7 offset:27648
    v_mfma_f32_16x16x32_bf16 v[184:187], v[140:143], a[136:139], v[184:187]
    v_mfma_f32_16x16x32_bf16 v[184:187], v[144:147], a[144:147], v[184:187]
    s_waitcnt lgkmcnt(2)
    v_mfma_f32_16x16x32_bf16 v[184:187], v[148:151], a[152:155], v[184:187]
    buffer_load_dwordx4 v1, s[56:59], s21 offen offset:2048 sc1 lds
    v_mfma_f32_16x16x32_bf16 v[188:191], v[136:139], a[132:135], v[188:191]
    ds_read_b128 v[136:139], v7 offset:4096
    v_mfma_f32_16x16x32_bf16 v[188:191], v[140:143], a[140:143], v[188:191]
    ds_read_b128 v[140:143], v7 offset:12288
    v_mfma_f32_16x16x32_bf16 v[188:191], v[144:147], a[148:151], v[188:191]
    ds_read_b128 v[144:147], v7 offset:20480
    v_mfma_f32_16x16x32_bf16 v[188:191], v[148:151], a[156:159], v[188:191]
    buffer_load_dwordx4 a[192:195], v4, s[40:43], s63 offen offset:0 sc1
    v_mfma_f32_16x16x32_bf16 v[192:195], v[104:107], a[128:131], v[192:195]
    ds_read_b128 v[148:151], v7 offset:28672
    v_mfma_f32_16x16x32_bf16 v[192:195], v[108:111], a[136:139], v[192:195]
    v_mfma_f32_16x16x32_bf16 v[192:195], v[112:115], a[144:147], v[192:195]
    buffer_load_dwordx4 a[200:203], v4, s[40:43], s63 offen offset:1024 sc1
    v_mfma_f32_16x16x32_bf16 v[192:195], v[116:119], a[152:155], v[192:195]
    v_mfma_f32_16x16x32_bf16 v[196:199], v[104:107], a[132:135], v[196:199]
    ds_read_b128 v[104:107], v7 offset:5120
    v_mfma_f32_16x16x32_bf16 v[196:199], v[108:111], a[140:143], v[196:199]
    ds_read_b128 v[108:111], v7 offset:13312
    v_mfma_f32_16x16x32_bf16 v[196:199], v[112:115], a[148:151], v[196:199]
    buffer_load_dwordx4 a[208:211], v4, s[40:43], s63 offen offset:2048 sc1
    v_mfma_f32_16x16x32_bf16 v[196:199], v[116:119], a[156:159], v[196:199]
    ds_read_b128 v[112:115], v7 offset:21504
    ds_read_b128 v[116:119], v7 offset:29696
    v_mfma_f32_16x16x32_bf16 v[200:203], v[120:123], a[128:131], v[200:203]
    v_mfma_f32_16x16x32_bf16 v[200:203], v[124:127], a[136:139], v[200:203]
    s_waitcnt lgkmcnt(3)
    v_mfma_f32_16x16x32_bf16 v[200:203], v[128:131], a[144:147], v[200:203]
    buffer_load_dwordx4 a[216:219], v4, s[40:43], s63 offen offset:3072 sc1
    v_mfma_f32_16x16x32_bf16 v[200:203], v[132:135], a[152:155], v[200:203]
    s_xor_b32 s63, s63, 4096
    v_mfma_f32_16x16x32_bf16 v[204:207], v[120:123], a[132:135], v[204:207]
    ds_read_b128 v[120:123], v7 offset:6144
    v_mfma_f32_16x16x32_bf16 v[204:207], v[124:127], a[140:143], v[204:207]
    ds_read_b128 v[124:127], v7 offset:14336
    v_mfma_f32_16x16x32_bf16 v[204:207], v[128:131], a[148:151], v[204:207]
    buffer_load_dwordx4 a[196:199], v5, s[40:43], s20 offen offset:0 sc1
    v_mfma_f32_16x16x32_bf16 v[204:207], v[132:135], a[156:159], v[204:207]
    buffer_load_dword v3, v19, s[32:35], s66 offen sc1
    v_mfma_f32_16x16x32_bf16 v[208:211], v[136:139], a[128:131], v[208:211]
    ds_read_b128 v[128:131], v7 offset:22528
    ds_read_b128 v[132:135], v7 offset:30720
    v_mfma_f32_16x16x32_bf16 v[208:211], v[140:143], a[136:139], v[208:211]
    v_mfma_f32_16x16x32_bf16 v[208:211], v[144:147], a[144:147], v[208:211]
    buffer_load_dwordx4 a[204:207], v5, s[40:43], s20 offen offset:1024 sc1
    v_mfma_f32_16x16x32_bf16 v[208:211], v[148:151], a[152:155], v[208:211]
    v_mfma_f32_16x16x32_bf16 v[212:215], v[136:139], a[132:135], v[212:215]
    v_mfma_f32_16x16x32_bf16 v[212:215], v[140:143], a[140:143], v[212:215]
    buffer_load_dwordx4 a[212:215], v5, s[40:43], s20 offen offset:2048 sc1
    v_mfma_f32_16x16x32_bf16 v[212:215], v[144:147], a[148:151], v[212:215]
    v_mfma_f32_16x16x32_bf16 v[212:215], v[148:151], a[156:159], v[212:215]
    v_mfma_f32_16x16x32_bf16 v[216:219], v[104:107], a[128:131], v[216:219]
    s_waitcnt lgkmcnt(0)
    v_mfma_f32_16x16x32_bf16 v[216:219], v[108:111], a[136:139], v[216:219]
    buffer_load_dwordx4 a[220:223], v5, s[40:43], s20 offen offset:3072 sc1
    v_mfma_f32_16x16x32_bf16 v[216:219], v[112:115], a[144:147], v[216:219]
    s_xor_b32 s21, s3, 7
    v_mfma_f32_16x16x32_bf16 v[216:219], v[116:119], a[152:155], v[216:219]
    s_lshl2_add_u32 s21, s21, s4
    s_waitcnt vmcnt(16)
    s_barrier
    v_mfma_f32_16x16x32_bf16 v[220:223], v[104:107], a[132:135], v[220:223]
    s_mul_i32 s21, s21, 36864
    ds_read_b128 v[136:139], v11 offset:0
    ds_read_b128 v[140:143], v11 offset:8192
    v_mfma_f32_16x16x32_bf16 v[220:223], v[108:111], a[140:143], v[220:223]
    s_add_u32 s21, s21, s28
    s_mov_b32 m0, s46
    ds_read_b128 v[144:147], v11 offset:16384
    v_mfma_f32_16x16x32_bf16 v[220:223], v[112:115], a[148:151], v[220:223]
    s_xor_b32 s20, s20, 4096
    buffer_load_dwordx4 v1, s[56:59], s21 offen sc1 lds
    v_mfma_f32_16x16x32_bf16 v[220:223], v[116:119], a[156:159], v[220:223]
    ds_read_b128 v[148:151], v11 offset:24576
    ds_read_b128 v[104:107], v11 offset:1024
    v_mfma_f32_16x16x32_bf16 v[224:227], v[120:123], a[128:131], v[224:227]
    ds_read_b128 v[108:111], v11 offset:9216
    v_mfma_f32_16x16x32_bf16 v[224:227], v[124:127], a[136:139], v[224:227]
    buffer_load_dwordx4 v1, s[56:59], s21 offen offset:1024 sc1 lds
    v_mfma_f32_16x16x32_bf16 v[224:227], v[128:131], a[144:147], v[224:227]
    ds_read_b128 v[112:115], v11 offset:17408
    ds_read_b128 v[116:119], v11 offset:25600
    v_mfma_f32_16x16x32_bf16 v[224:227], v[132:135], a[152:155], v[224:227]
    v_mfma_f32_16x16x32_bf16 v[228:231], v[120:123], a[132:135], v[228:231]
    ds_read_b128 v[120:123], v11 offset:2048
    v_mfma_f32_16x16x32_bf16 v[228:231], v[124:127], a[140:143], v[228:231]
    buffer_load_dwordx4 v1, s[56:59], s21 offen offset:2048 sc1 lds
    v_mfma_f32_16x16x32_bf16 v[228:231], v[128:131], a[148:151], v[228:231]
    ds_read_b128 v[124:127], v11 offset:10240
    ds_read_b128 v[128:131], v11 offset:18432
    v_mfma_f32_16x16x32_bf16 v[228:231], v[132:135], a[156:159], v[228:231]
    s_waitcnt lgkmcnt(3)
    ds_read_b128 v[132:135], v11 offset:26624
    v_mfma_f32_16x16x32_bf16 v[176:179], v[136:139], a[160:163], v[176:179]
    buffer_load_dwordx4 v1, s[56:59], s21 offen offset:3072 sc1 lds
    v_mfma_f32_16x16x32_bf16 v[176:179], v[140:143], a[168:171], v[176:179]
    s_add_u32 s21, s21, 4096
    v_mfma_f32_16x16x32_bf16 v[176:179], v[144:147], a[176:179], v[176:179]
    s_add_u32 m0, s46, 4096
    v_mfma_f32_16x16x32_bf16 v[176:179], v[148:151], a[184:187], v[176:179]
    v_mfma_f32_16x16x32_bf16 v[180:183], v[136:139], a[164:167], v[180:183]
    buffer_load_dwordx4 v1, s[56:59], s21 offen sc1 lds
    v_mfma_f32_16x16x32_bf16 v[180:183], v[140:143], a[172:175], v[180:183]
    ds_read_b128 v[136:139], v11 offset:3072
    ds_read_b128 v[140:143], v11 offset:11264
    v_mfma_f32_16x16x32_bf16 v[180:183], v[144:147], a[180:183], v[180:183]
    ds_read_b128 v[144:147], v11 offset:19456
    v_mfma_f32_16x16x32_bf16 v[180:183], v[148:151], a[188:191], v[180:183]
    ds_read_b128 v[148:151], v11 offset:27648
    v_mfma_f32_16x16x32_bf16 v[184:187], v[104:107], a[160:163], v[184:187]
    buffer_load_dwordx4 v1, s[56:59], s21 offen offset:1024 sc1 lds
    v_mfma_f32_16x16x32_bf16 v[184:187], v[108:111], a[168:171], v[184:187]
    v_mfma_f32_16x16x32_bf16 v[184:187], v[112:115], a[176:179], v[184:187]
    v_mfma_f32_16x16x32_bf16 v[184:187], v[116:119], a[184:187], v[184:187]
    v_mfma_f32_16x16x32_bf16 v[188:191], v[104:107], a[164:167], v[188:191]
    buffer_load_dwordx4 v1, s[56:59], s21 offen offset:2048 sc1 lds
    v_mfma_f32_16x16x32_bf16 v[188:191], v[108:111], a[172:175], v[188:191]
    ds_read_b128 v[104:107], v11 offset:4096
    ds_read_b128 v[108:111], v11 offset:12288
    v_mfma_f32_16x16x32_bf16 v[188:191], v[112:115], a[180:183], v[188:191]
    ds_read_b128 v[112:115], v11 offset:20480
    v_mfma_f32_16x16x32_bf16 v[188:191], v[116:119], a[188:191], v[188:191]
    s_waitcnt lgkmcnt(3)
    ds_read_b128 v[116:119], v11 offset:28672
    v_mfma_f32_16x16x32_bf16 v[192:195], v[120:123], a[160:163], v[192:195]
    buffer_load_dwordx4 a[224:227], v4, s[40:43], s63 offen offset:0 sc1
    v_mfma_f32_16x16x32_bf16 v[192:195], v[124:127], a[168:171], v[192:195]
    v_mfma_f32_16x16x32_bf16 v[192:195], v[128:131], a[176:179], v[192:195]
    v_mfma_f32_16x16x32_bf16 v[192:195], v[132:135], a[184:187], v[192:195]
    buffer_load_dwordx4 a[232:235], v4, s[40:43], s63 offen offset:1024 sc1
    v_mfma_f32_16x16x32_bf16 v[196:199], v[120:123], a[164:167], v[196:199]
    ds_read_b128 v[120:123], v11 offset:5120
    v_mfma_f32_16x16x32_bf16 v[196:199], v[124:127], a[172:175], v[196:199]
    ds_read_b128 v[124:127], v11 offset:13312
    v_mfma_f32_16x16x32_bf16 v[196:199], v[128:131], a[180:183], v[196:199]
    ds_read_b128 v[128:131], v11 offset:21504
    v_mfma_f32_16x16x32_bf16 v[196:199], v[132:135], a[188:191], v[196:199]
    buffer_load_dwordx4 a[240:243], v4, s[40:43], s63 offen offset:2048 sc1
    v_mfma_f32_16x16x32_bf16 v[200:203], v[136:139], a[160:163], v[200:203]
    ds_read_b128 v[132:135], v11 offset:29696
    v_mfma_f32_16x16x32_bf16 v[200:203], v[140:143], a[168:171], v[200:203]
    v_mfma_f32_16x16x32_bf16 v[200:203], v[144:147], a[176:179], v[200:203]
    v_mfma_f32_16x16x32_bf16 v[200:203], v[148:151], a[184:187], v[200:203]
    buffer_load_dwordx4 a[248:251], v4, s[40:43], s63 offen offset:3072 sc1
    v_mfma_f32_16x16x32_bf16 v[204:207], v[136:139], a[164:167], v[204:207]
    s_sub_u32 s63, s63, 4096
    ds_read_b128 v[136:139], v11 offset:6144
    v_mfma_f32_16x16x32_bf16 v[204:207], v[140:143], a[172:175], v[204:207]
    ds_read_b128 v[140:143], v11 offset:14336
    v_mfma_f32_16x16x32_bf16 v[204:207], v[144:147], a[180:183], v[204:207]
    ds_read_b128 v[144:147], v11 offset:22528
    v_mfma_f32_16x16x32_bf16 v[204:207], v[148:151], a[188:191], v[204:207]
    s_waitcnt lgkmcnt(3)
    buffer_load_dwordx4 a[228:231], v5, s[40:43], s20 offen offset:0 sc1
    v_mfma_f32_16x16x32_bf16 v[208:211], v[104:107], a[160:163], v[208:211]
    ds_read_b128 v[148:151], v11 offset:30720
    v_mfma_f32_16x16x32_bf16 v[208:211], v[108:111], a[168:171], v[208:211]
    v_mfma_f32_16x16x32_bf16 v[208:211], v[112:115], a[176:179], v[208:211]
    v_mfma_f32_16x16x32_bf16 v[208:211], v[116:119], a[184:187], v[208:211]
    buffer_load_dwordx4 a[236:239], v5, s[40:43], s20 offen offset:1024 sc1
    v_mfma_f32_16x16x32_bf16 v[212:215], v[104:107], a[164:167], v[212:215]
    v_mfma_f32_16x16x32_bf16 v[212:215], v[108:111], a[172:175], v[212:215]
    v_mfma_f32_16x16x32_bf16 v[212:215], v[112:115], a[180:183], v[212:215]
    buffer_load_dwordx4 a[244:247], v5, s[40:43], s20 offen offset:2048 sc1
    v_mfma_f32_16x16x32_bf16 v[212:215], v[116:119], a[188:191], v[212:215]
    v_mfma_f32_16x16x32_bf16 v[216:219], v[120:123], a[160:163], v[216:219]
    v_mfma_f32_16x16x32_bf16 v[216:219], v[124:127], a[168:171], v[216:219]
    v_mfma_f32_16x16x32_bf16 v[216:219], v[128:131], a[176:179], v[216:219]
    buffer_load_dwordx4 a[252:255], v5, s[40:43], s20 offen offset:3072 sc1
    v_mfma_f32_16x16x32_bf16 v[216:219], v[132:135], a[184:187], v[216:219]
    s_mul_i32 s21, s61, 6
    s_add_u32 s21, s21, 132
    s_waitcnt vmcnt(15)
    v_cmp_gt_u32 vcc, 3, v3
    s_nop 1
    s_and_b64 vcc, vcc, exec
    s_cbranch_scc1 SPIN_OA
BACK_OA:
    s_barrier
    v_mfma_f32_16x16x32_bf16 v[220:223], v[120:123], a[164:167], v[220:223]
    s_mul_i32 s21, s21, 36864
    ds_read_b128 v[104:107], v12 offset:0
    ds_read_b128 v[108:111], v12 offset:8192
    v_mfma_f32_16x16x32_bf16 v[220:223], v[124:127], a[172:175], v[220:223]
    s_add_u32 s21, s21, s28
    ds_read_b128 v[112:115], v12 offset:16384
    v_mfma_f32_16x16x32_bf16 v[220:223], v[128:131], a[180:183], v[220:223]
    s_add_u32 s21, s21, s67
    s_mov_b32 m0, s47
    ds_read_b128 v[116:119], v12 offset:24576
    v_mfma_f32_16x16x32_bf16 v[220:223], v[132:135], a[188:191], v[220:223]
    s_sub_u32 s20, s20, 4096
    buffer_load_dwordx4 v1, s[56:59], s21 offen sc1 lds
    s_waitcnt lgkmcnt(4)
    v_mfma_f32_16x16x32_bf16 v[224:227], v[136:139], a[160:163], v[224:227]
    ds_read_b128 v[120:123], v12 offset:1024
    ds_read_b128 v[124:127], v12 offset:9216
    v_mfma_f32_16x16x32_bf16 v[224:227], v[140:143], a[168:171], v[224:227]
    ds_read_b128 v[128:131], v12 offset:17408
    v_mfma_f32_16x16x32_bf16 v[224:227], v[144:147], a[176:179], v[224:227]
    buffer_load_dwordx4 v1, s[56:59], s21 offen offset:1024 sc1 lds
    v_mfma_f32_16x16x32_bf16 v[224:227], v[148:151], a[184:187], v[224:227]
    s_mul_i32 s63, s61, 6144
    ds_read_b128 v[132:135], v12 offset:25600
    v_mfma_f32_16x16x32_bf16 v[228:231], v[136:139], a[164:167], v[228:231]
    s_add_u32 s63, s63, 135168
    ds_read_b128 v[136:139], v12 offset:2048
    v_mfma_f32_16x16x32_bf16 v[228:231], v[140:143], a[172:175], v[228:231]
    ds_read_b128 v[140:143], v12 offset:10240
    v_mfma_f32_16x16x32_bf16 v[228:231], v[144:147], a[180:183], v[228:231]
    buffer_load_dwordx4 v[64:67], v4, s[40:43], s63 offen offset:0 sc1
    v_mfma_f32_16x16x32_bf16 v[228:231], v[148:151], a[188:191], v[228:231]
    s_waitcnt lgkmcnt(3)
    ds_read_b128 v[144:147], v12 offset:18432
    ds_read_b128 v[148:151], v12 offset:26624
    v_mfma_f32_16x16x32_bf16 v[176:179], v[104:107], a[192:195], v[176:179]
    v_mfma_f32_16x16x32_bf16 v[176:179], v[108:111], a[200:203], v[176:179]
    buffer_load_dwordx4 v[68:71], v4, s[40:43], s63 offen offset:1024 sc1
    v_mfma_f32_16x16x32_bf16 v[176:179], v[112:115], a[208:211], v[176:179]
    s_mul_i32 s20, s61, 6144
    v_mfma_f32_16x16x32_bf16 v[176:179], v[116:119], a[216:219], v[176:179]
    s_add_u32 s20, s20, 135168
    v_mfma_f32_16x16x32_bf16 v[180:183], v[104:107], a[196:199], v[180:183]
    s_sub_u32 s63, s63, 4096
    ds_read_b128 v[104:107], v12 offset:3072
    v_mfma_f32_16x16x32_bf16 v[180:183], v[108:111], a[204:207], v[180:183]
    buffer_load_dwordx4 v[72:75], v5, s[40:43], s20 offen offset:0 sc1
    v_mfma_f32_16x16x32_bf16 v[180:183], v[112:115], a[212:215], v[180:183]
    ds_read_b128 v[108:111], v12 offset:11264
    ds_read_b128 v[112:115], v12 offset:19456
    v_mfma_f32_16x16x32_bf16 v[180:183], v[116:119], a[220:223], v[180:183]
    ds_read_b128 v[116:119], v12 offset:27648
    v_mfma_f32_16x16x32_bf16 v[184:187], v[120:123], a[192:195], v[184:187]
    v_mfma_f32_16x16x32_bf16 v[184:187], v[124:127], a[200:203], v[184:187]
    buffer_load_dwordx4 v[76:79], v5, s[40:43], s20 offen offset:1024 sc1
    v_mfma_f32_16x16x32_bf16 v[184:187], v[128:131], a[208:211], v[184:187]
    s_mul_i32 s21, s61, 6
    s_add_u32 s21, s4, s21
    s_waitcnt lgkmcnt(3)
    v_mfma_f32_16x16x32_bf16 v[184:187], v[132:135], a[216:219], v[184:187]
    s_add_u32 s21, s21, 128
    v_mfma_f32_16x16x32_bf16 v[188:191], v[120:123], a[196:199], v[188:191]
    s_mul_i32 s21, s21, 36864
    ds_read_b128 v[120:123], v12 offset:4096
    v_mfma_f32_16x16x32_bf16 v[188:191], v[124:127], a[204:207], v[188:191]
    s_add_u32 s21, s21, s28
    s_mov_b32 m0, s79
    ds_read_b128 v[124:127], v12 offset:12288
    v_mfma_f32_16x16x32_bf16 v[188:191], v[128:131], a[212:215], v[188:191]
    s_sub_u32 s20, s20, 4096
    buffer_load_dwordx4 v1, s[56:59], s21 offen sc1 lds
    v_mfma_f32_16x16x32_bf16 v[188:191], v[132:135], a[220:223], v[188:191]
    ds_read_b128 v[128:131], v12 offset:20480
    ds_read_b128 v[132:135], v12 offset:28672
    v_mfma_f32_16x16x32_bf16 v[192:195], v[136:139], a[192:195], v[192:195]
    v_mfma_f32_16x16x32_bf16 v[192:195], v[140:143], a[200:203], v[192:195]
    buffer_load_dwordx4 v1, s[56:59], s21 offen offset:1024 sc1 lds
    v_mfma_f32_16x16x32_bf16 v[192:195], v[144:147], a[208:211], v[192:195]
    v_mfma_f32_16x16x32_bf16 v[192:195], v[148:151], a[216:219], v[192:195]
    v_mfma_f32_16x16x32_bf16 v[196:199], v[136:139], a[196:199], v[196:199]
    buffer_load_dwordx4 v1, s[56:59], s21 offen offset:2048 sc1 lds
    v_mfma_f32_16x16x32_bf16 v[196:199], v[140:143], a[204:207], v[196:199]
    ds_read_b128 v[136:139], v12 offset:5120
    ds_read_b128 v[140:143], v12 offset:13312
    v_mfma_f32_16x16x32_bf16 v[196:199], v[144:147], a[212:215], v[196:199]
    ds_read_b128 v[144:147], v12 offset:21504
    v_mfma_f32_16x16x32_bf16 v[196:199], v[148:151], a[220:223], v[196:199]
    ds_read_b128 v[148:151], v12 offset:29696
    v_mfma_f32_16x16x32_bf16 v[200:203], v[104:107], a[192:195], v[200:203]
    s_waitcnt lgkmcnt(4)
    buffer_load_dwordx4 v1, s[56:59], s21 offen offset:3072 sc1 lds
    v_mfma_f32_16x16x32_bf16 v[200:203], v[108:111], a[200:203], v[200:203]
    s_add_u32 s21, s21, 4096
    v_mfma_f32_16x16x32_bf16 v[200:203], v[112:115], a[208:211], v[200:203]
    s_add_u32 m0, s79, 4096
    v_mfma_f32_16x16x32_bf16 v[200:203], v[116:119], a[216:219], v[200:203]
    v_mfma_f32_16x16x32_bf16 v[204:207], v[104:107], a[196:199], v[204:207]
    buffer_load_dwordx4 v1, s[56:59], s21 offen sc1 lds
    v_mfma_f32_16x16x32_bf16 v[204:207], v[108:111], a[204:207], v[204:207]
    ds_read_b128 v[104:107], v12 offset:6144
    ds_read_b128 v[108:111], v12 offset:14336
    v_mfma_f32_16x16x32_bf16 v[204:207], v[112:115], a[212:215], v[204:207]
    ds_read_b128 v[112:115], v12 offset:22528
    v_mfma_f32_16x16x32_bf16 v[204:207], v[116:119], a[220:223], v[204:207]
    ds_read_b128 v[116:119], v12 offset:30720
    v_mfma_f32_16x16x32_bf16 v[208:211], v[120:123], a[192:195], v[208:211]
    buffer_load_dwordx4 v1, s[56:59], s21 offen offset:1024 sc1 lds
    v_mfma_f32_16x16x32_bf16 v[208:211], v[124:127], a[200:203], v[208:211]
    v_mfma_f32_16x16x32_bf16 v[208:211], v[128:131], a[208:211], v[208:211]
    v_mfma_f32_16x16x32_bf16 v[208:211], v[132:135], a[216:219], v[208:211]
    v_mfma_f32_16x16x32_bf16 v[212:215], v[120:123], a[196:199], v[212:215]
    buffer_load_dwordx4 v1, s[56:59], s21 offen offset:2048 sc1 lds
    v_mfma_f32_16x16x32_bf16 v[212:215], v[124:127], a[204:207], v[212:215]
    v_mfma_f32_16x16x32_bf16 v[212:215], v[128:131], a[212:215], v[212:215]
    v_mfma_f32_16x16x32_bf16 v[212:215], v[132:135], a[220:223], v[212:215]
    s_waitcnt lgkmcnt(0)
    buffer_load_dwordx4 v[32:35], v4, s[40:43], s63 offen offset:0 sc1
    v_mfma_f32_16x16x32_bf16 v[216:219], v[136:139], a[192:195], v[216:219]
    v_mfma_f32_16x16x32_bf16 v[216:219], v[140:143], a[200:203], v[216:219]
    v_mfma_f32_16x16x32_bf16 v[216:219], v[144:147], a[208:211], v[216:219]
    s_add_u32 s23, s5, 8
    v_lshrrev_b32 v19, 4, v1
    v_min_u32 v19, 2, v19
    v_mfma_f32_16x16x32_bf16 v[216:219], v[148:151], a[216:219], v[216:219]
    s_waitcnt vmcnt(14)
    s_barrier
    ds_read_b128 v[120:123], v13 offset:0
    v_mfma_f32_16x16x32_bf16 v[220:223], v[136:139], a[196:199], v[220:223]
    s_and_b32 s65, s5, 3
    buffer_load_dwordx4 v[40:43], v4, s[40:43], s63 offen offset:1024 sc1
    v_mfma_f32_16x16x32_bf16 v[220:223], v[140:143], a[204:207], v[220:223]
    s_mul_i32 s70, s4, 3072
    ds_read_b128 v[124:127], v13 offset:8192
    ds_read_b128 v[128:131], v13 offset:16384
    v_mfma_f32_16x16x32_bf16 v[220:223], v[144:147], a[212:215], v[220:223]
    s_andn2_b32 s66, s74, 0xfff
    ds_read_b128 v[132:135], v13 offset:24576
    v_lshl_add_u32 v19, v19, 3, s23
    v_mfma_f32_16x16x32_bf16 v[220:223], v[148:151], a[220:223], v[220:223]
    s_lshl3_add_u32 s23, s6, s62
    buffer_load_dwordx4 v[48:51], v4, s[40:43], s63 offen offset:2048 sc1
    v_mfma_f32_16x16x32_bf16 v[224:227], v[104:107], a[192:195], v[224:227]
    s_lshl_b32 s23, s23, 4
    ds_read_b128 v[136:139], v13 offset:1024
    ds_read_b128 v[140:143], v13 offset:9216
    v_mfma_f32_16x16x32_bf16 v[224:227], v[108:111], a[200:203], v[224:227]
    ds_read_b128 v[144:147], v13 offset:17408
    v_bfe_u32 v20, v1, 4, 4
    v_mfma_f32_16x16x32_bf16 v[224:227], v[112:115], a[208:211], v[224:227]
    ds_read_b128 v[148:151], v13 offset:25600
    v_add_u32 v20, s23, v20
    v_mfma_f32_16x16x32_bf16 v[224:227], v[116:119], a[216:219], v[224:227]
    s_mul_i32 s23, s6, 294912
    buffer_load_dwordx4 v[56:59], v4, s[40:43], s63 offen offset:3072 sc1
    v_mfma_f32_16x16x32_bf16 v[228:231], v[104:107], a[196:199], v[228:231]
    s_sub_u32 s63, s63, 4096
    ds_read_b128 v[104:107], v13 offset:2048
    v_mul_u32_u24 v20, 1152, v20
    v_mfma_f32_16x16x32_bf16 v[228:231], v[108:111], a[204:207], v[228:231]
    s_sub_u32 s23, 2211840, s23
    ds_read_b128 v[108:111], v13 offset:10240
    v_lshrrev_b32 v21, 8, v1
    v_mfma_f32_16x16x32_bf16 v[228:231], v[112:115], a[212:215], v[228:231]
    ds_read_b128 v[112:115], v13 offset:18432
    v_lshl_add_u32 v20, v21, 3, v20
    v_mfma_f32_16x16x32_bf16 v[228:231], v[116:119], a[220:223], v[228:231]
    s_waitcnt lgkmcnt(3)
    buffer_load_dwordx4 v[36:39], v5, s[40:43], s20 offen offset:0 sc1
    v_mfma_f32_16x16x32_bf16 v[176:179], v[120:123], a[224:227], v[176:179]
    ds_read_b128 v[116:119], v13 offset:26624
    v_add_u32 v21, s23, v20
    v_mfma_f32_16x16x32_bf16 v[176:179], v[124:127], a[232:235], v[176:179]
    s_mul_i32 s23, s101, 288
    v_and_b32 v19, 31, v19
    v_mov_b32 v31, 3
    v_mfma_f32_16x16x32_bf16 v[176:179], v[128:131], a[240:243], v[176:179]
    s_add_u32 s23, s23, s70
    buffer_load_dwordx4 v[44:47], v5, s[40:43], s20 offen offset:1024 sc1
    v_mfma_f32_16x16x32_bf16 v[176:179], v[132:135], a[248:251], v[176:179]
    s_add_u32 s98, s23, 0
    v_lshlrev_b32 v23, 20, v1
    v_lshlrev_b32 v19, 7, v19
    v_mfma_f32_16x16x32_bf16 v[180:183], v[120:123], a[228:231], v[180:183]
    ds_read_b128 v[120:123], v13 offset:3072
    v_bfe_u32 v92, v1, 6, 2
    v_mfma_f32_16x16x32_bf16 v[180:183], v[124:127], a[236:239], v[180:183]
    ds_read_b128 v[124:127], v13 offset:11264
    v_lshrrev_b32 v93, 8, v1
    v_mfma_f32_16x16x32_bf16 v[180:183], v[128:131], a[244:247], v[180:183]
    buffer_load_dwordx4 v[52:55], v5, s[40:43], s20 offen offset:2048 sc1
    v_mfma_f32_16x16x32_bf16 v[180:183], v[132:135], a[252:255], v[180:183]
    ds_read_b128 v[128:131], v13 offset:19456
    ds_read_b128 v[132:135], v13 offset:27648
    v_mfma_f32_16x16x32_bf16 v[184:187], v[136:139], a[224:227], v[184:187]
    v_cmp_eq_u32 vcc, v92, v93
    v_and_b32 v92, 16, v1
    v_mfma_f32_16x16x32_bf16 v[184:187], v[140:143], a[232:235], v[184:187]
    v_mov_b32 v93, 0x3f80
    v_lshlrev_b32 v92, v92, v93
    v_mfma_f32_16x16x32_bf16 v[184:187], v[144:147], a[240:243], v[184:187]
    buffer_load_dwordx4 v[60:63], v5, s[40:43], s20 offen offset:3072 sc1
    v_mfma_f32_16x16x32_bf16 v[184:187], v[148:151], a[248:251], v[184:187]
    s_add_u32 s21, s4, 0
    s_xor_b32 s21, s21, s3
    s_lshl_b32 s21, s21, 2
    v_mfma_f32_16x16x32_bf16 v[188:191], v[136:139], a[228:231], v[188:191]
    s_mul_i32 s21, s21, 36864
    ds_read_b128 v[136:139], v13 offset:4096
    v_and_b32 v93, 32, v1
    v_mfma_f32_16x16x32_bf16 v[188:191], v[140:143], a[236:239], v[188:191]
    s_add_u32 s21, s21, s28
    ds_read_b128 v[140:143], v13 offset:12288
    v_cndmask_b32 v92, 0, v92, vcc
    v_mfma_f32_16x16x32_bf16 v[188:191], v[144:147], a[244:247], v[188:191]
    s_add_u32 s21, s21, 7168
    s_add_u32 m0, s44, 0
    ds_read_b128 v[144:147], v13 offset:20480
    v_mfma_f32_16x16x32_bf16 v[188:191], v[148:151], a[252:255], v[188:191]
    s_sub_u32 s20, s20, 4096
    buffer_load_dwordx4 v1, s[56:59], s21 offen sc1 lds
    s_waitcnt lgkmcnt(3)
    v_mfma_f32_16x16x32_bf16 v[192:195], v[104:107], a[224:227], v[192:195]
    ds_read_b128 v[148:151], v13 offset:28672
    v_cmp_eq_u32 vcc, 0, v93
    v_mfma_f32_16x16x32_bf16 v[192:195], v[108:111], a[232:235], v[192:195]
    v_mov_b32 v98, 0
    v_cndmask_b32 v96, 0, v92, vcc
    v_mfma_f32_16x16x32_bf16 v[192:195], v[112:115], a[240:243], v[192:195]
    buffer_load_dwordx4 v1, s[56:59], s21 offen offset:1024 sc1 lds
    v_mfma_f32_16x16x32_bf16 v[192:195], v[116:119], a[248:251], v[192:195]
    s_add_u32 s21, s21, 36864
    v_cndmask_b32_e64 v97, v92, 0, vcc
    v_mov_b32 v99, 0
    v_mfma_f32_16x16x32_bf16 v[196:199], v[104:107], a[228:231], v[196:199]
    s_add_u32 m0, s44, 2048
    ds_read_b128 v[104:107], v13 offset:5120
    v_mov_b32 v100, v96
    v_mfma_f32_16x16x32_bf16 v[196:199], v[108:111], a[236:239], v[196:199]
    buffer_load_dwordx4 v1, s[56:59], s21 offen sc1 lds
    v_mfma_f32_16x16x32_bf16 v[196:199], v[112:115], a[244:247], v[196:199]
    ds_read_b128 v[108:111], v13 offset:13312
    ds_read_b128 v[112:115], v13 offset:21504
    v_mfma_f32_16x16x32_bf16 v[196:199], v[116:119], a[252:255], v[196:199]
    ds_read_b128 v[116:119], v13 offset:29696
    v_mov_b32 v101, v97
    v_mfma_f32_16x16x32_bf16 v[200:203], v[120:123], a[224:227], v[200:203]
    v_mfma_f32_16x16x32_bf16 v[200:203], v[124:127], a[232:235], v[200:203]
    buffer_load_dwordx4 v1, s[56:59], s21 offen offset:1024 sc1 lds
    v_mfma_f32_16x16x32_bf16 v[200:203], v[128:131], a[240:243], v[200:203]
    s_add_u32 s21, s21, 36864
    v_mfma_f32_16x16x32_bf16 v[200:203], v[132:135], a[248:251], v[200:203]
    s_add_u32 m0, s44, 4096
    v_mfma_f32_16x16x32_bf16 v[204:207], v[120:123], a[228:231], v[204:207]
    ds_read_b128 v[120:123], v13 offset:6144
    v_mfma_f32_16x16x32_bf16 v[204:207], v[124:127], a[236:239], v[204:207]
    buffer_load_dwordx4 v1, s[56:59], s21 offen sc1 lds
    v_mfma_f32_16x16x32_bf16 v[204:207], v[128:131], a[244:247], v[204:207]
    ds_read_b128 v[124:127], v13 offset:14336
    ds_read_b128 v[128:131], v13 offset:22528
    v_mfma_f32_16x16x32_bf16 v[204:207], v[132:135], a[252:255], v[204:207]
    s_waitcnt lgkmcnt(3)
    ds_read_b128 v[132:135], v13 offset:30720
    v_mfma_f32_16x16x32_bf16 v[208:211], v[136:139], a[224:227], v[208:211]
    v_mfma_f32_16x16x32_bf16 v[208:211], v[140:143], a[232:235], v[208:211]
    buffer_load_dwordx4 v1, s[56:59], s21 offen offset:1024 sc1 lds
    v_mfma_f32_16x16x32_bf16 v[208:211], v[144:147], a[240:243], v[208:211]
    s_add_u32 s21, s21, 36864
    v_mfma_f32_16x16x32_bf16 v[208:211], v[148:151], a[248:251], v[208:211]
    s_add_u32 m0, s44, 6144
    v_mfma_f32_16x16x32_bf16 v[212:215], v[136:139], a[228:231], v[212:215]
    buffer_load_dwordx4 v1, s[56:59], s21 offen sc1 lds
    v_mfma_f32_16x16x32_bf16 v[212:215], v[140:143], a[236:239], v[212:215]
    v_mfma_f32_16x16x32_bf16 v[212:215], v[144:147], a[244:247], v[212:215]
    v_mfma_f32_16x16x32_bf16 v[212:215], v[148:151], a[252:255], v[212:215]
    v_mfma_f32_16x16x32_bf16 v[216:219], v[104:107], a[224:227], v[216:219]
    buffer_load_dwordx4 v1, s[56:59], s21 offen offset:1024 sc1 lds
    v_mfma_f32_16x16x32_bf16 v[216:219], v[108:111], a[232:235], v[216:219]
    s_add_u32 s21, s21, 36864
    s_add_u32 s21, s4, 4
    s_xor_b32 s21, s21, s3
    v_mfma_f32_16x16x32_bf16 v[216:219], v[112:115], a[240:243], v[216:219]
    s_lshl_b32 s21, s21, 2
    s_mul_i32 s21, s21, 36864
    v_mfma_f32_16x16x32_bf16 v[216:219], v[116:119], a[248:251], v[216:219]
    s_waitcnt vmcnt(16)
    s_barrier
    s_add_u32 s21, s21, s28
    v_mfma_f32_16x16x32_bf16 v[220:223], v[104:107], a[228:231], v[220:223]
    s_add_u32 s21, s21, 7168
    s_add_u32 m0, s45, 0
    ds_read_b128 v[136:139], v6 offset:0
    v_mfma_f32_16x16x32_bf16 v[220:223], v[108:111], a[236:239], v[220:223]
    buffer_load_dwordx4 v1, s[56:59], s21 offen sc1 lds
    v_mfma_f32_16x16x32_bf16 v[220:223], v[112:115], a[244:247], v[220:223]
    ds_read_b128 v[140:143], v6 offset:1024
    ds_read_b128 v[144:147], v6 offset:8192
    v_mfma_f32_16x16x32_bf16 v[220:223], v[116:119], a[252:255], v[220:223]
    s_waitcnt lgkmcnt(3)
    ds_read_b128 v[148:151], v6 offset:9216
    v_mfma_f32_16x16x32_bf16 v[224:227], v[120:123], a[224:227], v[224:227]
    buffer_load_dwordx4 v1, s[56:59], s21 offen offset:1024 sc1 lds
    v_mfma_f32_16x16x32_bf16 v[224:227], v[124:127], a[232:235], v[224:227]
    s_add_u32 s21, s21, 36864
    ds_read_b128 v[104:107], v6 offset:16384
    ds_read_b128 v[108:111], v6 offset:17408
    v_mfma_f32_16x16x32_bf16 v[224:227], v[128:131], a[240:243], v[224:227]
    s_add_u32 m0, s45, 2048
    ds_read_b128 v[112:115], v6 offset:24576
    v_mfma_f32_16x16x32_bf16 v[224:227], v[132:135], a[248:251], v[224:227]
    ds_read_b128 v[116:119], v7 offset:0
    v_mfma_f32_16x16x32_bf16 v[228:231], v[120:123], a[228:231], v[228:231]
    buffer_load_dwordx4 v1, s[56:59], s21 offen sc1 lds
    v_mfma_f32_16x16x32_bf16 v[228:231], v[124:127], a[236:239], v[228:231]
    ds_read_b128 v[120:123], v7 offset:8192
    ds_read_b128 v[124:127], v7 offset:16384
    v_mfma_f32_16x16x32_bf16 v[228:231], v[128:131], a[244:247], v[228:231]
    ds_read_b128 v[128:131], v7 offset:24576
    v_mfma_f32_16x16x32_bf16 v[228:231], v[132:135], a[252:255], v[228:231]
    s_waitcnt lgkmcnt(4)
    buffer_load_dwordx4 v1, s[56:59], s21 offen offset:1024 sc1 lds
    v_smfmac_f32_16x16x64_bf16 v[176:179], v[136:139], v[64:71], v16
    s_add_u32 s21, s21, 36864
    ds_read_b128 v[132:135], v7 offset:1024
    v_smfmac_f32_16x16x64_bf16 v[180:183], v[136:139], v[72:79], v16
    s_add_u32 m0, s45, 4096
    ds_read_b128 v[136:139], v7 offset:9216
    v_smfmac_f32_16x16x64_bf16 v[184:187], v[140:143], v[64:71], v16
    v_smfmac_f32_16x16x64_bf16 v[188:191], v[140:143], v[72:79], v16
    buffer_load_dwordx4 v1, s[56:59], s21 offen sc1 lds
    v_smfmac_f32_16x16x64_bf16 v[192:195], v[144:147], v[64:71], v16
    ds_read_b128 v[140:143], v7 offset:17408
    v_smfmac_f32_16x16x64_bf16 v[196:199], v[144:147], v[72:79], v16
    ds_read_b128 v[144:147], v7 offset:25600
    v_smfmac_f32_16x16x64_bf16 v[200:203], v[148:151], v[64:71], v16
    v_smfmac_f32_16x16x64_bf16 v[204:207], v[148:151], v[72:79], v16
    buffer_load_dwordx4 v1, s[56:59], s21 offen offset:1024 sc1 lds
    v_smfmac_f32_16x16x64_bf16 v[208:211], v[104:107], v[64:71], v16
    s_add_u32 s21, s21, 36864
    ds_read_b128 v[148:151], v7 offset:2048
    v_smfmac_f32_16x16x64_bf16 v[212:215], v[104:107], v[72:79], v16
    s_add_u32 m0, s45, 6144
    ds_read_b128 v[104:107], v7 offset:10240
    v_smfmac_f32_16x16x64_bf16 v[216:219], v[108:111], v[64:71], v16
    v_smfmac_f32_16x16x64_bf16 v[220:223], v[108:111], v[72:79], v16
    buffer_load_dwordx4 v1, s[56:59], s21 offen sc1 lds
    v_smfmac_f32_16x16x64_bf16 v[224:227], v[112:115], v[64:71], v16
    s_waitcnt vmcnt(15)
    ds_read_b128 v[108:111], v7 offset:18432
    v_smfmac_f32_16x16x64_bf16 v[228:231], v[112:115], v[72:79], v16
    s_waitcnt lgkmcnt(2)
    ds_read_b128 v[112:115], v7 offset:26624
    v_mfma_f32_16x16x32_bf16 v[176:179], v[116:119], v[32:35], v[176:179]
    v_mfma_f32_16x16x32_bf16 v[176:179], v[120:123], v[40:43], v[176:179]
    buffer_load_dwordx4 v1, s[56:59], s21 offen offset:1024 sc1 lds
    v_mfma_f32_16x16x32_bf16 v[176:179], v[124:127], v[48:51], v[176:179]
    s_add_u32 s21, s21, 36864
    v_mfma_f32_16x16x32_bf16 v[176:179], v[128:131], v[56:59], v[176:179]
    v_mfma_f32_16x16x32_bf16 v[180:183], v[116:119], v[36:39], v[180:183]
    ds_read_b128 v[116:119], v7 offset:3072
    v_mfma_f32_16x16x32_bf16 v[180:183], v[120:123], v[44:47], v[180:183]
    ds_read_b128 v[120:123], v7 offset:11264
    v_mfma_f32_16x16x32_bf16 v[180:183], v[124:127], v[52:55], v[180:183]
    ds_read_b128 v[124:127], v7 offset:19456
    v_mfma_f32_16x16x32_bf16 v[180:183], v[128:131], v[60:63], v[180:183]
    ds_read_b128 v[128:131], v7 offset:27648
    v_cvt_pk_bf16_f32 v232, v176, v177
    v_mfma_f32_16x16x32_bf16 v[184:187], v[132:135], v[32:35], v[184:187]
    v_cvt_pk_bf16_f32 v233, v178, v179
    v_mfma_f32_16x16x32_bf16 v[184:187], v[136:139], v[40:43], v[184:187]
    v_mfma_f32_16x16x32_bf16 v[184:187], v[140:143], v[48:51], v[184:187]
    v_mfma_f32_16x16x32_bf16 v[184:187], v[144:147], v[56:59], v[184:187]
    v_mfma_f32_16x16x32_bf16 v[188:191], v[132:135], v[36:39], v[188:191]
    v_cvt_pk_bf16_f32 v234, v180, v181
    v_cvt_pk_bf16_f32 v235, v182, v183
    v_mfma_f32_16x16x32_bf16 v[188:191], v[136:139], v[44:47], v[188:191]
    buffer_store_dwordx4 v[232:235], v1, s[48:51], s8 offen offset:0 sc1
    v_mfma_f32_16x16x32_bf16 v[188:191], v[140:143], v[52:55], v[188:191]
    ds_read_b128 v[132:135], v7 offset:4096
    ds_read_b128 v[136:139], v7 offset:12288
    v_mfma_f32_16x16x32_bf16 v[188:191], v[144:147], v[60:63], v[188:191]
    v_cvt_pk_bf16_f32 v236, v184, v185
    v_cvt_pk_bf16_f32 v237, v186, v187
    v_mfma_f32_16x16x32_bf16 v[192:195], v[148:151], v[32:35], v[192:195]
    s_waitcnt lgkmcnt(2)
    ds_read_b128 v[140:143], v7 offset:20480
    ds_read_b128 v[144:147], v7 offset:28672
    v_mfma_f32_16x16x32_bf16 v[192:195], v[104:107], v[40:43], v[192:195]
    v_mfma_f32_16x16x32_bf16 v[192:195], v[108:111], v[48:51], v[192:195]
    v_mfma_f32_16x16x32_bf16 v[192:195], v[112:115], v[56:59], v[192:195]
    v_cvt_pk_bf16_f32 v238, v188, v189
    v_cvt_pk_bf16_f32 v239, v190, v191
    v_mfma_f32_16x16x32_bf16 v[196:199], v[148:151], v[36:39], v[196:199]
    buffer_store_dwordx4 v[236:239], v1, s[48:51], s8 offen offset:1024 sc1
    v_mfma_f32_16x16x32_bf16 v[196:199], v[104:107], v[44:47], v[196:199]
    ds_read_b128 v[148:151], v7 offset:5120
    ds_read_b128 v[104:107], v7 offset:13312
    v_mfma_f32_16x16x32_bf16 v[196:199], v[108:111], v[52:55], v[196:199]
    v_cvt_pk_bf16_f32 v240, v192, v193
    v_cvt_pk_bf16_f32 v241, v194, v195
    v_mfma_f32_16x16x32_bf16 v[196:199], v[112:115], v[60:63], v[196:199]
    ds_read_b128 v[108:111], v7 offset:21504
    ds_read_b128 v[112:115], v7 offset:29696
    v_mfma_f32_16x16x32_bf16 v[200:203], v[116:119], v[32:35], v[200:203]
    v_mfma_f32_16x16x32_bf16 v[200:203], v[120:123], v[40:43], v[200:203]
    v_mfma_f32_16x16x32_bf16 v[200:203], v[124:127], v[48:51], v[200:203]
    v_mfma_f32_16x16x32_bf16 v[200:203], v[128:131], v[56:59], v[200:203]
    v_mfma_f32_16x16x32_bf16 v[204:207], v[116:119], v[36:39], v[204:207]
    ds_read_b128 v[116:119], v7 offset:6144
    v_cvt_pk_bf16_f32 v242, v196, v197
    v_mfma_f32_16x16x32_bf16 v[204:207], v[120:123], v[44:47], v[204:207]
    v_cvt_pk_bf16_f32 v243, v198, v199
    ds_read_b128 v[120:123], v7 offset:14336
    v_mfma_f32_16x16x32_bf16 v[204:207], v[124:127], v[52:55], v[204:207]
    buffer_store_dwordx4 v[240:243], v1, s[48:51], s9 offen offset:0 sc1
    v_mfma_f32_16x16x32_bf16 v[204:207], v[128:131], v[60:63], v[204:207]
    s_waitcnt lgkmcnt(2)
    v_cvt_pk_bf16_f32 v244, v200, v201
    v_cvt_pk_bf16_f32 v245, v202, v203
    v_mfma_f32_16x16x32_bf16 v[208:211], v[132:135], v[32:35], v[208:211]
    ds_read_b128 v[124:127], v7 offset:22528
    ds_read_b128 v[128:131], v7 offset:30720
    v_mfma_f32_16x16x32_bf16 v[208:211], v[136:139], v[40:43], v[208:211]
    v_mfma_f32_16x16x32_bf16 v[208:211], v[140:143], v[48:51], v[208:211]
    v_mfma_f32_16x16x32_bf16 v[208:211], v[144:147], v[56:59], v[208:211]
    v_cvt_pk_bf16_f32 v246, v204, v205
    v_cvt_pk_bf16_f32 v247, v206, v207
    v_mfma_f32_16x16x32_bf16 v[212:215], v[132:135], v[36:39], v[212:215]
    buffer_store_dwordx4 v[244:247], v1, s[48:51], s9 offen offset:1024 sc1
    v_mfma_f32_16x16x32_bf16 v[212:215], v[136:139], v[44:47], v[212:215]
    v_mfma_f32_16x16x32_bf16 v[212:215], v[140:143], v[52:55], v[212:215]
    v_mfma_f32_16x16x32_bf16 v[212:215], v[144:147], v[60:63], v[212:215]
    v_mfma_f32_16x16x32_bf16 v[216:219], v[148:151], v[32:35], v[216:219]
    v_cvt_pk_bf16_f32 v232, v208, v209
    v_cvt_pk_bf16_f32 v233, v210, v211
    v_mfma_f32_16x16x32_bf16 v[216:219], v[104:107], v[40:43], v[216:219]
    v_mfma_f32_16x16x32_bf16 v[216:219], v[108:111], v[48:51], v[216:219]
    v_mfma_f32_16x16x32_bf16 v[216:219], v[112:115], v[56:59], v[216:219]
    s_waitcnt vmcnt(12)
    s_barrier
    v_cvt_pk_bf16_f32 v234, v212, v213
    v_mfma_f32_16x16x32_bf16 v[220:223], v[148:151], v[36:39], v[220:223]
    v_cvt_pk_bf16_f32 v235, v214, v215
    ds_read_b128 v[132:135], v11 offset:0
    v_mfma_f32_16x16x32_bf16 v[220:223], v[104:107], v[44:47], v[220:223]
    buffer_store_dwordx4 v[232:235], v1, s[48:51], s10 offen offset:0 sc1
    v_mfma_f32_16x16x32_bf16 v[220:223], v[108:111], v[52:55], v[220:223]
    ds_read_b128 v[136:139], v11 offset:2048
    ds_read_b128 v[140:143], v11 offset:4096
    v_mfma_f32_16x16x32_bf16 v[220:223], v[112:115], v[60:63], v[220:223]
    s_waitcnt lgkmcnt(3)
    ds_read_b128 v[144:147], v11 offset:6144
    v_cvt_pk_bf16_f32 v236, v216, v217
    v_mfma_f32_16x16x32_bf16 v[224:227], v[116:119], v[32:35], v[224:227]
    v_cvt_pk_bf16_f32 v237, v218, v219
    ds_read_b128 v[148:151], v11 offset:1024
    v_mfma_f32_16x16x32_bf16 v[224:227], v[120:123], v[40:43], v[224:227]
    ds_read_b128 v[104:107], v11 offset:3072
    v_mfma_f32_16x16x32_bf16 v[224:227], v[124:127], v[48:51], v[224:227]
    v_cvt_pk_bf16_f32 v238, v220, v221
    v_cvt_pk_bf16_f32 v239, v222, v223
    v_mfma_f32_16x16x32_bf16 v[224:227], v[128:131], v[56:59], v[224:227]
    buffer_store_dwordx4 v[236:239], v1, s[48:51], s10 offen offset:1024 sc1
    v_mfma_f32_16x16x32_bf16 v[228:231], v[116:119], v[36:39], v[228:231]
    ds_read_b128 v[108:111], v11 offset:5120
    ds_read_b128 v[112:115], v11 offset:7168
    v_mfma_f32_16x16x32_bf16 v[228:231], v[120:123], v[44:47], v[228:231]
    ds_read_b128 v[116:119], v11 offset:8192
    v_mfma_f32_16x16x32_bf16 v[228:231], v[124:127], v[52:55], v[228:231]
    ds_read_b128 v[120:123], v11 offset:10240
    v_cvt_pk_bf16_f32 v240, v224, v225
    v_mfma_f32_16x16x32_bf16 v[228:231], v[128:131], v[60:63], v[228:231]
    s_waitcnt lgkmcnt(4)
    v_cvt_pk_bf16_f32 v241, v226, v227
    ds_read_b128 v[124:127], v11 offset:12288
    v_mfma_f32_16x16x32_bf16 v[160:163], v[132:135], a[0:3], 0
    ds_read_b128 v[128:131], v11 offset:14336
    v_mfma_f32_16x16x32_bf16 v[160:163], v[136:139], a[8:11], v[160:163]
    v_mfma_f32_16x16x32_bf16 v[160:163], v[140:143], a[16:19], v[160:163]
    v_mfma_f32_16x16x32_bf16 v[160:163], v[144:147], a[24:27], v[160:163]
    v_mfma_f32_16x16x32_bf16 v[164:167], v[132:135], a[4:7], 0
    v_cvt_pk_bf16_f32 v242, v228, v229
    v_cvt_pk_bf16_f32 v243, v230, v231
    v_mfma_f32_16x16x32_bf16 v[164:167], v[136:139], a[12:15], v[164:167]
    buffer_store_dwordx4 v[240:243], v1, s[48:51], s11 offen offset:2048 sc1
    v_mfma_f32_16x16x32_bf16 v[164:167], v[140:143], a[20:23], v[164:167]
    ds_read_b128 v[132:135], v11 offset:9216
    ds_read_b128 v[136:139], v11 offset:11264
    v_mfma_f32_16x16x32_bf16 v[164:167], v[144:147], a[28:31], v[164:167]
    ds_read_b128 v[140:143], v11 offset:13312
    v_mfma_f32_16x16x32_bf16 v[168:171], v[148:151], a[0:3], 0
    ds_read_b128 v[144:147], v11 offset:15360
    v_mfma_f32_16x16x32_bf16 v[168:171], v[104:107], a[8:11], v[168:171]
    s_waitcnt lgkmcnt(4)
    v_mfma_f32_16x16x32_bf16 v[168:171], v[108:111], a[16:19], v[168:171]
    v_mfma_f32_16x16x32_bf16 v[168:171], v[112:115], a[24:27], v[168:171]
    v_mfma_f32_16x16x32_bf16 v[172:175], v[148:151], a[4:7], 0
    ds_read_b128 v[148:151], v11 offset:16384
    v_mfma_f32_16x16x32_bf16 v[172:175], v[104:107], a[12:15], v[172:175]
    ds_read_b128 v[104:107], v11 offset:18432
    v_mfma_f32_16x16x32_bf16 v[172:175], v[108:111], a[20:23], v[172:175]
    ds_read_b128 v[108:111], v11 offset:20480
    v_mfma_f32_16x16x32_bf16 v[172:175], v[112:115], a[28:31], v[172:175]
    ds_read_b128 v[112:115], v11 offset:22528
    v_mfma_f32_16x16x32_bf16 v[160:163], v[116:119], a[32:35], v[160:163]
    v_mfma_f32_16x16x32_bf16 v[160:163], v[120:123], a[40:43], v[160:163]
    v_mfma_f32_16x16x32_bf16 v[160:163], v[124:127], a[48:51], v[160:163]
    v_mfma_f32_16x16x32_bf16 v[160:163], v[128:131], a[56:59], v[160:163]
    v_mfma_f32_16x16x32_bf16 v[164:167], v[116:119], a[36:39], v[164:167]
    ds_read_b128 v[116:119], v11 offset:17408
    v_mfma_f32_16x16x32_bf16 v[164:167], v[120:123], a[44:47], v[164:167]
    ds_read_b128 v[120:123], v11 offset:19456
    v_mfma_f32_16x16x32_bf16 v[164:167], v[124:127], a[52:55], v[164:167]
    ds_read_b128 v[124:127], v11 offset:21504
    v_mfma_f32_16x16x32_bf16 v[164:167], v[128:131], a[60:63], v[164:167]
    s_waitcnt lgkmcnt(3)
    ds_read_b128 v[128:131], v11 offset:23552
    v_mfma_f32_16x16x32_bf16 v[168:171], v[132:135], a[32:35], v[168:171]
    v_mfma_f32_16x16x32_bf16 v[168:171], v[136:139], a[40:43], v[168:171]
    v_mfma_f32_16x16x32_bf16 v[168:171], v[140:143], a[48:51], v[168:171]
    v_mfma_f32_16x16x32_bf16 v[168:171], v[144:147], a[56:59], v[168:171]
    v_mfma_f32_16x16x32_bf16 v[172:175], v[132:135], a[36:39], v[172:175]
    ds_read_b128 v[132:135], v11 offset:24576
    v_mfma_f32_16x16x32_bf16 v[172:175], v[136:139], a[44:47], v[172:175]
    ds_read_b128 v[136:139], v11 offset:26624
    v_mfma_f32_16x16x32_bf16 v[172:175], v[140:143], a[52:55], v[172:175]
    ds_read_b128 v[140:143], v11 offset:28672
    v_mfma_f32_16x16x32_bf16 v[172:175], v[144:147], a[60:63], v[172:175]
    ds_read_b128 v[144:147], v11 offset:30720
    v_mfma_f32_16x16x32_bf16 v[160:163], v[148:151], a[64:67], v[160:163]
    v_mfma_f32_16x16x32_bf16 v[160:163], v[104:107], a[72:75], v[160:163]
    v_mfma_f32_16x16x32_bf16 v[160:163], v[108:111], a[80:83], v[160:163]
    v_mfma_f32_16x16x32_bf16 v[160:163], v[112:115], a[88:91], v[160:163]
    v_mfma_f32_16x16x32_bf16 v[164:167], v[148:151], a[68:71], v[164:167]
    ds_read_b128 v[148:151], v11 offset:25600
    v_mfma_f32_16x16x32_bf16 v[164:167], v[104:107], a[76:79], v[164:167]
    ds_read_b128 v[104:107], v11 offset:27648
    v_mfma_f32_16x16x32_bf16 v[164:167], v[108:111], a[84:87], v[164:167]
    ds_read_b128 v[108:111], v11 offset:29696
    v_mfma_f32_16x16x32_bf16 v[164:167], v[112:115], a[92:95], v[164:167]
    s_waitcnt lgkmcnt(3)
    ds_read_b128 v[112:115], v11 offset:31744
    v_mfma_f32_16x16x32_bf16 v[168:171], v[116:119], a[64:67], v[168:171]
    v_mfma_f32_16x16x32_bf16 v[168:171], v[120:123], a[72:75], v[168:171]
    v_mfma_f32_16x16x32_bf16 v[168:171], v[124:127], a[80:83], v[168:171]
    v_mfma_f32_16x16x32_bf16 v[168:171], v[128:131], a[88:91], v[168:171]
    v_mfma_f32_16x16x32_bf16 v[172:175], v[116:119], a[68:71], v[172:175]
    v_mfma_f32_16x16x32_bf16 v[172:175], v[120:123], a[76:79], v[172:175]
    v_mfma_f32_16x16x32_bf16 v[172:175], v[124:127], a[84:87], v[172:175]
    v_mfma_f32_16x16x32_bf16 v[172:175], v[128:131], a[92:95], v[172:175]
    v_mfma_f32_16x16x32_bf16 v[160:163], v[132:135], a[96:99], v[160:163]
    v_mfma_f32_16x16x32_bf16 v[160:163], v[136:139], a[104:107], v[160:163]
    v_mfma_f32_16x16x32_bf16 v[160:163], v[140:143], a[112:115], v[160:163]
    s_waitcnt vmcnt(0)
    buffer_store_dword v31, v23, s[32:35], s74 offen sc1
    v_mfma_f32_16x16x32_bf16 v[160:163], v[144:147], a[120:123], v[160:163]
    s_waitcnt vmcnt(8)
    s_barrier
    ds_read_b128 v[116:119], v12 offset:0
    v_mfma_f32_16x16x32_bf16 v[164:167], v[132:135], a[100:103], v[164:167]
    ds_read_b128 v[120:123], v12 offset:2048
    ds_read_b128 v[124:127], v12 offset:4096
    v_mfma_f32_16x16x32_bf16 v[164:167], v[136:139], a[108:111], v[164:167]
    ds_read_b128 v[128:131], v12 offset:6144
    v_mfma_f32_16x16x32_bf16 v[164:167], v[140:143], a[116:119], v[164:167]
    ds_read_b128 v[132:135], v12 offset:1024
    v_mfma_f32_16x16x32_bf16 v[164:167], v[144:147], a[124:127], v[164:167]
    s_mul_i32 s21, s61, 6
    s_add_u32 s21, s4, s21
    s_add_u32 s21, s21, 128
    s_waitcnt lgkmcnt(5)
    v_mfma_f32_16x16x32_bf16 v[168:171], v[148:151], a[96:99], v[168:171]
    s_mul_i32 s21, s21, 36864
    s_add_u32 s21, s21, s28
    s_add_u32 s21, s21, 7168
    v_mfma_f32_16x16x32_bf16 v[168:171], v[104:107], a[104:107], v[168:171]
    s_mov_b32 m0, s46
    ds_read_b128 v[136:139], v12 offset:3072
    ds_read_b128 v[140:143], v12 offset:5120
    v_mfma_f32_16x16x32_bf16 v[168:171], v[108:111], a[112:115], v[168:171]
    buffer_load_dwordx4 v1, s[56:59], s21 offen sc1 lds
    v_mfma_f32_16x16x32_bf16 v[168:171], v[112:115], a[120:123], v[168:171]
    ds_read_b128 v[144:147], v12 offset:7168
    v_mfma_f32_16x16x32_bf16 v[172:175], v[148:151], a[100:103], v[172:175]
    ds_read_b128 v[148:151], v12 offset:8192
    v_mfma_f32_16x16x32_bf16 v[172:175], v[104:107], a[108:111], v[172:175]
    buffer_load_dwordx4 v1, s[56:59], s21 offen offset:1024 sc1 lds
    v_mfma_f32_16x16x32_bf16 v[172:175], v[108:111], a[116:119], v[172:175]
    s_mul_i32 s21, s61, 6
    s_add_u32 s21, s21, 132
    s_mul_i32 s21, s21, 36864
    v_mfma_f32_16x16x32_bf16 v[172:175], v[112:115], a[124:127], v[172:175]
    s_add_u32 s21, s21, s28
    s_add_u32 s21, s21, 7168
    s_and_b32 s64, s68, 1024
    s_waitcnt lgkmcnt(2)
    v_mfma_f32_16x16x32_bf16 v[160:163], v[116:119], a[128:131], v[160:163]
    s_add_u32 s21, s21, s64
    ds_read_b128 v[104:107], v12 offset:10240
    ds_read_b128 v[108:111], v12 offset:12288
    v_mfma_f32_16x16x32_bf16 v[160:163], v[120:123], a[136:139], v[160:163]
    s_add_u32 m0, s46, 2048
    ds_read_b128 v[112:115], v12 offset:14336
    s_lshl2_add_u32 s64, s61, s65
    v_mfma_f32_16x16x32_bf16 v[160:163], v[124:127], a[144:147], v[160:163]
    s_lshl_b32 s65, s65, 5
    buffer_load_dwordx4 v1, s[56:59], s21 offen sc1 lds
    v_mfma_f32_16x16x32_bf16 v[160:163], v[128:131], a[152:155], v[160:163]
    s_add_u32 s65, s65, 1024
    s_lshl_b32 s64, s64, 6
    v_mfma_f32_16x16x32_bf16 v[164:167], v[116:119], a[132:135], v[164:167]
    s_cmp_eq_u32 s4, s61
    s_cselect_b32 s65, s65, 1073741824
    s_cselect_b32 s70, s23, 1073741824
    v_mfma_f32_16x16x32_bf16 v[164:167], v[120:123], a[140:143], v[164:167]
    ds_read_b128 v[116:119], v12 offset:9216
    ds_read_b128 v[120:123], v12 offset:11264
    v_mfma_f32_16x16x32_bf16 v[164:167], v[124:127], a[148:151], v[164:167]
    ds_read_b128 v[124:127], v12 offset:13312
    v_mfma_f32_16x16x32_bf16 v[164:167], v[128:131], a[156:159], v[164:167]
    ds_read_b128 v[128:131], v12 offset:15360
    v_mfma_f32_16x16x32_bf16 v[168:171], v[132:135], a[128:131], v[168:171]
    v_mfma_f32_16x16x32_bf16 v[168:171], v[136:139], a[136:139], v[168:171]
    v_mfma_f32_16x16x32_bf16 v[168:171], v[140:143], a[144:147], v[168:171]
    s_waitcnt lgkmcnt(2)
    v_mfma_f32_16x16x32_bf16 v[168:171], v[144:147], a[152:155], v[168:171]
    v_mfma_f32_16x16x32_bf16 v[172:175], v[132:135], a[132:135], v[172:175]
    ds_read_b128 v[132:135], v12 offset:16384
    v_mfma_f32_16x16x32_bf16 v[172:175], v[136:139], a[140:143], v[172:175]
    ds_read_b128 v[136:139], v12 offset:18432
    v_mfma_f32_16x16x32_bf16 v[172:175], v[140:143], a[148:151], v[172:175]
    ds_read_b128 v[140:143], v12 offset:20480
    v_mfma_f32_16x16x32_bf16 v[172:175], v[144:147], a[156:159], v[172:175]
    ds_read_b128 v[144:147], v12 offset:22528
    v_mfma_f32_16x16x32_bf16 v[160:163], v[148:151], a[160:163], v[160:163]
    v_mfma_f32_16x16x32_bf16 v[160:163], v[104:107], a[168:171], v[160:163]
    v_mfma_f32_16x16x32_bf16 v[160:163], v[108:111], a[176:179], v[160:163]
    v_mfma_f32_16x16x32_bf16 v[160:163], v[112:115], a[184:187], v[160:163]
    v_mfma_f32_16x16x32_bf16 v[164:167], v[148:151], a[164:167], v[164:167]
    ds_read_b128 v[148:151], v12 offset:17408
    v_mfma_f32_16x16x32_bf16 v[164:167], v[104:107], a[172:175], v[164:167]
    buffer_load_dword v3, v19, s[32:35], s66 offen sc1
    v_mfma_f32_16x16x32_bf16 v[164:167], v[108:111], a[180:183], v[164:167]
    ds_read_b128 v[104:107], v12 offset:19456
    ds_read_b128 v[108:111], v12 offset:21504
    v_mfma_f32_16x16x32_bf16 v[164:167], v[112:115], a[188:191], v[164:167]
    ds_read_b128 v[112:115], v12 offset:23552
    v_mfma_f32_16x16x32_bf16 v[168:171], v[116:119], a[160:163], v[168:171]
    v_mfma_f32_16x16x32_bf16 v[168:171], v[120:123], a[168:171], v[168:171]
    s_waitcnt lgkmcnt(3)
    v_mfma_f32_16x16x32_bf16 v[168:171], v[124:127], a[176:179], v[168:171]
    v_mfma_f32_16x16x32_bf16 v[168:171], v[128:131], a[184:187], v[168:171]
    v_mfma_f32_16x16x32_bf16 v[172:175], v[116:119], a[164:167], v[172:175]
    ds_read_b128 v[116:119], v12 offset:24576
    v_mfma_f32_16x16x32_bf16 v[172:175], v[120:123], a[172:175], v[172:175]
    ds_read_b128 v[120:123], v12 offset:26624
    v_mfma_f32_16x16x32_bf16 v[172:175], v[124:127], a[180:183], v[172:175]
    ds_read_b128 v[124:127], v12 offset:28672
    v_mfma_f32_16x16x32_bf16 v[172:175], v[128:131], a[188:191], v[172:175]
    ds_read_b128 v[128:131], v12 offset:30720
    v_mfma_f32_16x16x32_bf16 v[160:163], v[132:135], a[192:195], v[160:163]
    v_mfma_f32_16x16x32_bf16 v[160:163], v[136:139], a[200:203], v[160:163]
    v_mfma_f32_16x16x32_bf16 v[160:163], v[140:143], a[208:211], v[160:163]
    v_mfma_f32_16x16x32_bf16 v[160:163], v[144:147], a[216:219], v[160:163]
    v_mfma_f32_16x16x32_bf16 v[164:167], v[132:135], a[196:199], v[164:167]
    ds_read_b128 v[132:135], v12 offset:25600
    v_mfma_f32_16x16x32_bf16 v[164:167], v[136:139], a[204:207], v[164:167]
    ds_read_b128 v[136:139], v12 offset:27648
    v_mfma_f32_16x16x32_bf16 v[164:167], v[140:143], a[212:215], v[164:167]
    ds_read_b128 v[140:143], v12 offset:29696
    v_mfma_f32_16x16x32_bf16 v[164:167], v[144:147], a[220:223], v[164:167]
    ds_read_b128 v[144:147], v12 offset:31744
    v_mfma_f32_16x16x32_bf16 v[168:171], v[148:151], a[192:195], v[168:171]
    s_waitcnt lgkmcnt(4)
    v_mfma_f32_16x16x32_bf16 v[168:171], v[104:107], a[200:203], v[168:171]
    v_mfma_f32_16x16x32_bf16 v[168:171], v[108:111], a[208:211], v[168:171]
    v_mfma_f32_16x16x32_bf16 v[168:171], v[112:115], a[216:219], v[168:171]
    v_mfma_f32_16x16x32_bf16 v[172:175], v[148:151], a[196:199], v[172:175]
    v_mfma_f32_16x16x32_bf16 v[172:175], v[104:107], a[204:207], v[172:175]
    v_mfma_f32_16x16x32_bf16 v[172:175], v[108:111], a[212:215], v[172:175]
    v_mfma_f32_16x16x32_bf16 v[172:175], v[112:115], a[220:223], v[172:175]
    v_mfma_f32_16x16x32_bf16 v[160:163], v[116:119], a[224:227], v[160:163]
    s_waitcnt vmcnt(0)
    v_cmp_gt_u32 vcc, 3, v3
    s_nop 1
    s_and_b64 vcc, vcc, exec
    s_cbranch_scc1 SPIN_X
BACK_X:
    v_mfma_f32_16x16x32_bf16 v[160:163], v[120:123], a[232:235], v[160:163]
    buffer_load_dwordx4 v[176:179], v1, s[48:51], s98 offen offset:0 sc1
    v_mfma_f32_16x16x32_bf16 v[160:163], v[124:127], a[240:243], v[160:163]
    s_add_u32 s98, s23, 12288
    buffer_load_dwordx4 v[180:183], v1, s[48:51], s98 offen offset:0 sc1
    v_mfma_f32_16x16x32_bf16 v[160:163], v[128:131], a[248:251], v[160:163]
    s_waitcnt vmcnt(3)
    s_barrier
    ds_read_b128 v[148:151], v13 offset:2048
    v_mfma_f32_16x16x32_bf16 v[164:167], v[116:119], a[228:231], v[164:167]
    s_add_u32 s98, s23, 24576
    ds_read_b128 v[104:107], v13 offset:1024
    ds_read_b128 v[108:111], v13 offset:9216
    v_mfma_f32_16x16x32_bf16 v[164:167], v[120:123], a[236:239], v[164:167]
    buffer_load_dwordx4 v[184:187], v1, s[48:51], s98 offen offset:0 sc1
    v_mfma_f32_16x16x32_bf16 v[164:167], v[124:127], a[244:247], v[164:167]
    s_add_u32 s98, s23, 0
    ds_read_b128 v[112:115], v13 offset:17408
    ds_read_b128 v[116:119], v13 offset:25600
    v_mfma_f32_16x16x32_bf16 v[164:167], v[128:131], a[252:255], v[164:167]
    s_waitcnt lgkmcnt(5)
    ds_read_b128 v[120:123], v13 offset:0
    v_mfma_f32_16x16x32_bf16 v[168:171], v[132:135], a[224:227], v[168:171]
    buffer_load_dwordx4 v[188:191], v1, s[48:51], s98 offen offset:1024 sc1
    v_mfma_f32_16x16x32_bf16 v[168:171], v[136:139], a[232:235], v[168:171]
    s_add_u32 s98, s23, 12288
    ds_read_b128 v[124:127], v13 offset:8192
    ds_read_b128 v[128:131], v13 offset:16384
    v_mfma_f32_16x16x32_bf16 v[168:171], v[140:143], a[240:243], v[168:171]
    v_mfma_f32_16x16x32_bf16 v[168:171], v[144:147], a[248:251], v[168:171]
    v_mfma_f32_16x16x32_bf16 v[172:175], v[132:135], a[228:231], v[172:175]
    buffer_load_dwordx4 v[192:195], v1, s[48:51], s98 offen offset:1024 sc1
    v_mfma_f32_16x16x32_bf16 v[172:175], v[136:139], a[236:239], v[172:175]
    s_add_u32 s98, s23, 24576
    ds_read_b128 v[132:135], v13 offset:24576
    ds_read_b128 v[136:139], v13 offset:10240
    v_mfma_f32_16x16x32_bf16 v[172:175], v[140:143], a[244:247], v[172:175]
    v_mfma_f32_16x16x32_bf16 v[172:175], v[144:147], a[252:255], v[172:175]
    s_waitcnt lgkmcnt(2)
    v_smfmac_f32_16x16x64_bf16 v[160:163], v[148:151], v[64:71], v16
    buffer_load_dwordx4 v[196:199], v1, s[48:51], s98 offen offset:1024 sc1
    v_smfmac_f32_16x16x64_bf16 v[164:167], v[148:151], v[72:79], v16
    s_add_u32 s98, s70, 0
    v_mfma_f32_16x16x32_bf16 v[168:171], v[104:107], v[32:35], v[168:171]
    v_mfma_f32_16x16x32_bf16 v[168:171], v[108:111], v[40:43], v[168:171]
    buffer_load_dwordx4 v[200:203], v1, s[48:51], s98 offen offset:2048 sc1
    v_mfma_f32_16x16x32_bf16 v[168:171], v[112:115], v[48:51], v[168:171]
    s_add_u32 s98, s70, 12288
    v_mfma_f32_16x16x32_bf16 v[168:171], v[116:119], v[56:59], v[168:171]
    v_mfma_f32_16x16x32_bf16 v[172:175], v[104:107], v[36:39], v[172:175]
    v_mfma_f32_16x16x32_bf16 v[172:175], v[108:111], v[44:47], v[172:175]
    buffer_load_dwordx4 v[204:207], v1, s[48:51], s98 offen offset:2048 sc1
    v_mfma_f32_16x16x32_bf16 v[172:175], v[112:115], v[52:55], v[172:175]
    s_add_u32 s98, s70, 24576
    v_mfma_f32_16x16x32_bf16 v[172:175], v[116:119], v[60:63], v[172:175]
    v_mfma_f32_16x16x32_bf16 v[160:163], v[120:123], v[32:35], v[160:163]
    buffer_load_dwordx4 v[208:211], v1, s[48:51], s98 offen offset:2048 sc1
    v_mfma_f32_16x16x32_bf16 v[160:163], v[124:127], v[40:43], v[160:163]
    v_mfma_f32_16x16x32_bf16 v[160:163], v[128:131], v[48:51], v[160:163]
    s_waitcnt lgkmcnt(0)
    v_mfma_f32_16x16x32_bf16 v[160:163], v[132:135], v[56:59], v[160:163]
    v_mfma_f32_16x16x32_bf16 v[164:167], v[120:123], v[36:39], v[164:167]
    v_mfma_f32_16x16x32_bf16 v[164:167], v[124:127], v[44:47], v[164:167]
    v_mfma_f32_16x16x32_bf16 v[164:167], v[128:131], v[52:55], v[164:167]
    v_mfma_f32_16x16x32_bf16 v[164:167], v[132:135], v[60:63], v[164:167]
    v_smfmac_f32_16x16x64_bf16 v[168:171], v[136:139], v[64:71], v16
    v_smfmac_f32_16x16x64_bf16 v[172:175], v[136:139], v[72:79], v16
    s_waitcnt vmcnt(6)
    v_mfma_f32_16x16x32_bf16 v[160:163], v[96:99], v[176:179], v[160:163]
    v_mfma_f32_16x16x32_bf16 v[160:163], v[96:99], v[180:183], v[160:163]
    v_mfma_f32_16x16x32_bf16 v[160:163], v[96:99], v[184:187], v[160:163]
    v_mfma_f32_16x16x32_bf16 v[164:167], v[98:101], v[176:179], v[164:167]
    v_mfma_f32_16x16x32_bf16 v[164:167], v[98:101], v[180:183], v[164:167]
    v_mfma_f32_16x16x32_bf16 v[164:167], v[98:101], v[184:187], v[164:167]
    s_waitcnt vmcnt(3)
    s_nop 0
    v_mfma_f32_16x16x32_bf16 v[168:171], v[96:99], v[188:191], v[168:171]
    v_mfma_f32_16x16x32_bf16 v[168:171], v[96:99], v[192:195], v[168:171]
    v_mfma_f32_16x16x32_bf16 v[168:171], v[96:99], v[196:199], v[168:171]
    v_mfma_f32_16x16x32_bf16 v[172:175], v[98:101], v[188:191], v[172:175]
    v_mfma_f32_16x16x32_bf16 v[172:175], v[98:101], v[192:195], v[172:175]
    v_mfma_f32_16x16x32_bf16 v[172:175], v[98:101], v[196:199], v[172:175]
    v_cvt_pk_bf16_f32 v160, v160, v161
    v_cvt_pk_bf16_f32 v161, v162, v163
    buffer_store_dwordx2 v[160:161], v20, s[24:27], s64 offen
    v_cvt_pk_bf16_f32 v164, v164, v165
    v_cvt_pk_bf16_f32 v165, v166, v167
    buffer_store_dwordx2 v[164:165], v21, s[24:27], s64 offen
    s_cmp_lg_u32 s4, s61
    s_cbranch_scc1 K1_X2
    s_waitcnt vmcnt(2)
    v_mfma_f32_16x16x32_bf16 v[224:227], v[96:99], v[200:203], v[224:227]
    v_mfma_f32_16x16x32_bf16 v[224:227], v[96:99], v[204:207], v[224:227]
    v_mfma_f32_16x16x32_bf16 v[224:227], v[96:99], v[208:211], v[224:227]
    v_mfma_f32_16x16x32_bf16 v[228:231], v[98:101], v[200:203], v[228:231]
    v_mfma_f32_16x16x32_bf16 v[228:231], v[98:101], v[204:207], v[228:231]
    v_mfma_f32_16x16x32_bf16 v[228:231], v[98:101], v[208:211], v[228:231]
    s_nop 4
    v_cvt_pk_bf16_f32 v224, v224, v225
    v_cvt_pk_bf16_f32 v225, v226, v227
    buffer_store_dwordx2 v[224:225], v20, s[24:27], s65 offen
    v_cvt_pk_bf16_f32 v228, v228, v229
    v_cvt_pk_bf16_f32 v229, v230, v231
    buffer_store_dwordx2 v[228:229], v21, s[24:27], s65 offen
K1_X2:
    v_cvt_pk_bf16_f32 v168, v168, v169
    v_cvt_pk_bf16_f32 v169, v170, v171
    buffer_store_dwordx2 v[168:169], v20, s[24:27], s64 offen offset:32
    v_cvt_pk_bf16_f32 v172, v172, v173
    v_cvt_pk_bf16_f32 v173, v174, v175
    buffer_store_dwordx2 v[172:173], v21, s[24:27], s64 offen offset:32
K1_END:
    s_endpgm
K1_LB_MASK:
    v_add_f32 v212, s12, v144
    v_fma_f32 v176, v208, s8, v212
    v_fma_f32 v177, v209, s8, v212
    v_fma_f32 v178, v210, s8, v212
    v_fma_f32 v179, v211, s8, v212
    v_add_f32 v213, s13, v144
    v_fma_f32 v180, v208, s9, v213
    v_fma_f32 v181, v209, s9, v213
    v_fma_f32 v182, v210, s9, v213
    v_fma_f32 v183, v211, s9, v213
    v_add_f32 v212, s14, v144
    v_fma_f32 v184, v208, s10, v212
    v_fma_f32 v185, v209, s10, v212
    v_fma_f32 v186, v210, s10, v212
    v_fma_f32 v187, v211, s10, v212
    v_add_f32 v213, s15, v144
    v_fma_f32 v188, v208, s11, v213
    v_fma_f32 v189, v209, s11, v213
    v_fma_f32 v190, v210, s11, v213
    v_fma_f32 v191, v211, s11, v213
    buffer_load_dword v3, v29, s[32:35], s92 offen sc1
    buffer_load_dword v28, off, s[32:35], s86 sc1
    s_branch K1_LB_BACK
K1_LS_MASK:
    s_cmp_eq_u32 s78, 1
    s_cbranch_scc1 K1_LS_LAST
    buffer_load_dword v3, v29, s[32:35], s92 offen sc1
    buffer_load_dword v28, off, s[32:35], s86 sc1
    v_mov_b32 v218, 1
    s_cmp_eq_u64 s[84:85], 0
    s_cselect_b32 s7, s74, 1073741824
    s_cmp_lg_u32 s83, 0
    s_cselect_b32 s7, s74, s7
    s_waitcnt vmcnt(10)
    buffer_store_dword v218, v216, s[32:35], s7 offen sc1
    s_branch K1_LS_BACK
K1_LS_LAST:
    v_add_f32 v212, s12, v152
    v_fma_f32 v176, v208, s8, v212
    v_fma_f32 v177, v209, s8, v212
    v_fma_f32 v178, v210, s8, v212
    v_fma_f32 v179, v211, s8, v212
    v_add_f32 v213, s13, v152
    v_fma_f32 v180, v208, s9, v213
    v_fma_f32 v181, v209, s9, v213
    v_fma_f32 v182, v210, s9, v213
    v_fma_f32 v183, v211, s9, v213
    v_add_f32 v212, s14, v152
    v_fma_f32 v184, v208, s10, v212
    v_fma_f32 v185, v209, s10, v212
    v_fma_f32 v186, v210, s10, v212
    v_fma_f32 v187, v211, s10, v212
    v_add_f32 v213, s15, v152
    v_fma_f32 v188, v208, s11, v213
    v_fma_f32 v189, v209, s11, v213
    v_fma_f32 v190, v210, s11, v213
    v_fma_f32 v191, v211, s11, v213
    v_cmp_gt_u32 vcc, 2, v28
    s_nop 1
    s_and_b64 vcc, vcc, exec
    s_cbranch_scc1 SPIN_W0H
BACK_W0H:
    s_lshl4_add_u32 s7, s73, s87
    buffer_load_dwordx4 a[128:131], v1, s[40:43], s7 offen sc1
    buffer_load_dwordx4 a[132:135], v1, s[40:43], s87 offen offset:1024 sc1
    v_cmp_gt_u32 vcc, 1, v3
    s_nop 1
    s_cmp_lg_u32 vcc_lo, 0
    s_cbranch_scc1 SPIN_W0
BACK_W0:
    s_mov_b64 s[36:37], s[56:57]
    s_mov_b32 s38, 5603328
    s_xor_b32 s77, s3, 0
    s_lshl2_add_u32 s77, s77, s4
    s_mul_i32 s77, s77, 36864
    s_add_u32 s77, s77, s28
    s_branch K1_LS_BACK
K1_WMASK:
    v_mov_b32 v9, 0xf149f2ca
    v_cmp_le_u32 vcc, 2, v14
    s_nop 1
    v_cndmask_b32 v141, v9, v141, vcc
    v_cmp_le_u32 vcc, 4, v14
    s_nop 1
    v_cndmask_b32 v142, v9, v142, vcc
    v_cmp_le_u32 vcc, 6, v14
    s_nop 1
    v_cndmask_b32 v143, v9, v143, vcc
    v_cmp_le_u32 vcc, 8, v14
    s_nop 1
    v_cndmask_b32 v144, v9, v144, vcc
    v_cmp_le_u32 vcc, 10, v14
    s_nop 1
    v_cndmask_b32 v145, v9, v145, vcc
    v_cmp_le_u32 vcc, 12, v14
    s_nop 1
    v_cndmask_b32 v146, v9, v146, vcc
    v_cmp_le_u32 vcc, 14, v14
    s_nop 1
    v_cndmask_b32 v147, v9, v147, vcc
    s_branch K1_WMASK_BACK
K1_S7:
    v_mov_b32 v218, 1
    s_cmp_eq_u64 s[84:85], 0
    s_cselect_b32 s7, s74, 1073741824
    s_cmp_lg_u32 s83, 0
    s_cselect_b32 s7, s74, s7
    s_waitcnt vmcnt(8)
    buffer_store_dword v218, v216, s[32:35], s7 offen sc1
    s_branch K1_S7_BACK
K1_J7:
    v_cmp_gt_u32 vcc, 2, v28
    s_nop 1
    s_and_b64 vcc, vcc, exec
    s_cbranch_scc1 SPIN_W7H
BACK_W7H:
    s_lshl4_add_u32 s7, s73, s87
    buffer_load_dwordx4 a[128:131], v1, s[40:43], s7 offen sc1
    buffer_load_dwordx4 a[132:135], v1, s[40:43], s87 offen offset:1024 sc1
    v_cmp_gt_u32 vcc, 1, v3
    s_nop 1
    s_cmp_lg_u32 vcc_lo, 0
    s_cbranch_scc1 SPIN_W7
BACK_W7:
    s_mov_b64 s[36:37], s[56:57]
    s_mov_b32 s38, 5603328
    s_xor_b32 s77, s3, 0
    s_lshl2_add_u32 s77, s77, s4
    s_mul_i32 s77, s77, 36864
    s_add_u32 s77, s77, s28
    s_branch K1_J7_BACK
K1_REDO:
    s_mov_b32 s83, 1
    s_mov_b32 s63, 1073741824
    s_mov_b32 s64, 1073741824
    s_mov_b32 s62, 1073741824
    s_mul_i32 s7, s5, 1081344
    s_sub_u32 s7, 56623104, s7
    s_sub_u32 s36, s56, s7
    s_subb_u32 s37, s57, 0
    s_mov_b32 s38, 1081344
    s_mov_b32 s50, 0
    s_mov_b32 s54, 0
    s_waitcnt vmcnt(0) lgkmcnt(0)
    s_barrier
    v_lshrrev_b32 v92, 4, v1
    v_and_b32 v64, 15, v92
    v_lshrrev_b32 v92, 4, v92
    v_lshlrev_b32 v92, 2, v92
    v_sub_u32 v92, v64, v92
    s_lshl_b32 s98, s4, 4
    v_add_u32 v92, s98, v92
    s_lshl_b32 s98, s6, 7
    s_sub_u32 s99, 1920, s98
    v_add_u32 v64, s98, v92
    v_add_u32 v65, 64, v64
    v_add_u32 v66, s99, v92
    v_add_u32 v67, 64, v66
    v_mov_b32 v93, 0xf149f2ca
    v_mov_b32 v68, v93
    v_mov_b32 v69, v93
    v_mov_b32 v70, v93
    v_mov_b32 v71, v93
    s_mov_b32 s78, 0
    s_add_u32 s99, s99, 128
K1_REDO_L:
    s_lshr_b32 s7, s78, 6
    s_lshl_b32 s7, s7, 15
    s_bfe_u32 s98, s78, 0x20004
    s_lshl_b32 s98, s98, 12
    s_add_u32 s7, s7, s98
    buffer_load_dwordx4 v[72:75], v1, s[36:39], s7 offen offset:0 sc1
    buffer_load_dwordx4 v[76:79], v1, s[36:39], s7 offen offset:1024 sc1
    buffer_load_dwordx4 v[80:83], v1, s[36:39], s7 offen offset:2048 sc1
    buffer_load_dwordx4 v[84:87], v1, s[36:39], s7 offen offset:3072 sc1
    s_waitcnt vmcnt(0)
    v_mfma_f32_16x16x32_bf16 v[88:91], v[72:75], v[128:131], 0
    v_mfma_f32_16x16x32_bf16 v[88:91], v[76:79], v[160:163], v[88:91]
    v_mfma_f32_16x16x32_bf16 v[88:91], v[80:83], v[192:195], v[88:91]
    v_mfma_f32_16x16x32_bf16 v[88:91], v[84:87], v[224:227], v[88:91]
    v_subrev_u32 v92, s78, v64
    v_cmp_le_i32 vcc, 0, v92
    s_nop 5
    v_cndmask_b32 v88, v93, v88, vcc
    v_max_f32 v68, v68, v88
    v_cmp_le_i32 vcc, 1, v92
    s_nop 1
    v_cndmask_b32 v89, v93, v89, vcc
    v_max_f32 v68, v68, v89
    v_cmp_le_i32 vcc, 2, v92
    s_nop 1
    v_cndmask_b32 v90, v93, v90, vcc
    v_max_f32 v68, v68, v90
    v_cmp_le_i32 vcc, 3, v92
    s_nop 1
    v_cndmask_b32 v91, v93, v91, vcc
    v_max_f32 v68, v68, v91
    v_mfma_f32_16x16x32_bf16 v[88:91], v[72:75], v[132:135], 0
    v_mfma_f32_16x16x32_bf16 v[88:91], v[76:79], v[164:167], v[88:91]
    v_mfma_f32_16x16x32_bf16 v[88:91], v[80:83], v[196:199], v[88:91]
    v_mfma_f32_16x16x32_bf16 v[88:91], v[84:87], v[228:231], v[88:91]
    v_subrev_u32 v92, s78, v65
    v_cmp_le_i32 vcc, 0, v92
    s_nop 5
    v_cndmask_b32 v88, v93, v88, vcc
    v_max_f32 v69, v69, v88
    v_cmp_le_i32 vcc, 1, v92
    s_nop 1
    v_cndmask_b32 v89, v93, v89, vcc
    v_max_f32 v69, v69, v89
    v_cmp_le_i32 vcc, 2, v92
    s_nop 1
    v_cndmask_b32 v90, v93, v90, vcc
    v_max_f32 v69, v69, v90
    v_cmp_le_i32 vcc, 3, v92
    s_nop 1
    v_cndmask_b32 v91, v93, v91, vcc
    v_max_f32 v69, v69, v91
    v_mfma_f32_16x16x32_bf16 v[88:91], v[72:75], v[136:139], 0
    v_mfma_f32_16x16x32_bf16 v[88:91], v[76:79], v[168:171], v[88:91]
    v_mfma_f32_16x16x32_bf16 v[88:91], v[80:83], v[200:203], v[88:91]
    v_mfma_f32_16x16x32_bf16 v[88:91], v[84:87], v[232:235], v[88:91]
    v_subrev_u32 v92, s78, v66
    v_cmp_le_i32 vcc, 0, v92
    s_nop 5
    v_cndmask_b32 v88, v93, v88, vcc
    v_max_f32 v70, v70, v88
    v_cmp_le_i32 vcc, 1, v92
    s_nop 1
    v_cndmask_b32 v89, v93, v89, vcc
    v_max_f32 v70, v70, v89
    v_cmp_le_i32 vcc, 2, v92
    s_nop 1
    v_cndmask_b32 v90, v93, v90, vcc
    v_max_f32 v70, v70, v90
    v_cmp_le_i32 vcc, 3, v92
    s_nop 1
    v_cndmask_b32 v91, v93, v91, vcc
    v_max_f32 v70, v70, v91
    v_mfma_f32_16x16x32_bf16 v[88:91], v[72:75], v[140:143], 0
    v_mfma_f32_16x16x32_bf16 v[88:91], v[76:79], v[172:175], v[88:91]
    v_mfma_f32_16x16x32_bf16 v[88:91], v[80:83], v[204:207], v[88:91]
    v_mfma_f32_16x16x32_bf16 v[88:91], v[84:87], v[236:239], v[88:91]
    v_subrev_u32 v92, s78, v67
    v_cmp_le_i32 vcc, 0, v92
    s_nop 5
    v_cndmask_b32 v88, v93, v88, vcc
    v_max_f32 v71, v71, v88
    v_cmp_le_i32 vcc, 1, v92
    s_nop 1
    v_cndmask_b32 v89, v93, v89, vcc
    v_max_f32 v71, v71, v89
    v_cmp_le_i32 vcc, 2, v92
    s_nop 1
    v_cndmask_b32 v90, v93, v90, vcc
    v_max_f32 v71, v71, v90
    v_cmp_le_i32 vcc, 3, v92
    s_nop 1
    v_cndmask_b32 v91, v93, v91, vcc
    v_max_f32 v71, v71, v91
    s_add_u32 s78, s78, 16
    s_cmp_lt_u32 s78, s99
    s_cbranch_scc1 K1_REDO_L
    v_mov_b32 v92, v68
    s_nop 1
    v_permlane32_swap_b32 v68, v92
    v_max_f32 v68, v68, v92
    v_mov_b32 v92, v68
    s_nop 1
    v_permlane16_swap_b32 v68, v92
    v_max_f32 v68, v68, v92
    v_sub_f32 v144, 0, v68
    v_sub_f32 v145, 0, v68
    v_sub_f32 v146, 0, v68
    v_sub_f32 v147, 0, v68
    v_mov_b32 v92, v69
    s_nop 1
    v_permlane32_swap_b32 v69, v92
    v_max_f32 v69, v69, v92
    v_mov_b32 v92, v69
    s_nop 1
    v_permlane16_swap_b32 v69, v92
    v_max_f32 v69, v69, v92
    v_sub_f32 v148, 0, v69
    v_sub_f32 v149, 0, v69
    v_sub_f32 v150, 0, v69
    v_sub_f32 v151, 0, v69
    v_mov_b32 v92, v70
    s_nop 1
    v_permlane32_swap_b32 v70, v92
    v_max_f32 v70, v70, v92
    v_mov_b32 v92, v70
    s_nop 1
    v_permlane16_swap_b32 v70, v92
    v_max_f32 v70, v70, v92
    v_sub_f32 v152, 0, v70
    v_sub_f32 v153, 0, v70
    v_sub_f32 v154, 0, v70
    v_sub_f32 v155, 0, v70
    v_mov_b32 v92, v71
    s_nop 1
    v_permlane32_swap_b32 v71, v92
    v_max_f32 v71, v71, v92
    v_mov_b32 v92, v71
    s_nop 1
    v_permlane16_swap_b32 v71, v92
    v_max_f32 v71, v71, v92
    v_sub_f32 v156, 0, v71
    v_sub_f32 v157, 0, v71
    v_sub_f32 v158, 0, v71
    v_sub_f32 v159, 0, v71
    v_accvgpr_write_b32 a0, 0
    v_accvgpr_write_b32 a1, 0
    v_accvgpr_write_b32 a2, 0
    v_accvgpr_write_b32 a3, 0
    v_accvgpr_write_b32 a4, 0
    v_accvgpr_write_b32 a5, 0
    v_accvgpr_write_b32 a6, 0
    v_accvgpr_write_b32 a7, 0
    v_accvgpr_write_b32 a8, 0
    v_accvgpr_write_b32 a9, 0
    v_accvgpr_write_b32 a10, 0
    v_accvgpr_write_b32 a11, 0
    v_accvgpr_write_b32 a12, 0
    v_accvgpr_write_b32 a13, 0
    v_accvgpr_write_b32 a14, 0
    v_accvgpr_write_b32 a15, 0
    v_accvgpr_write_b32 a16, 0
    v_accvgpr_write_b32 a17, 0
    v_accvgpr_write_b32 a18, 0
    v_accvgpr_write_b32 a19, 0
    v_accvgpr_write_b32 a20, 0
    v_accvgpr_write_b32 a21, 0
    v_accvgpr_write_b32 a22, 0
    v_accvgpr_write_b32 a23, 0
    v_accvgpr_write_b32 a24, 0
    v_accvgpr_write_b32 a25, 0
    v_accvgpr_write_b32 a26, 0
    v_accvgpr_write_b32 a27, 0
    v_accvgpr_write_b32 a28, 0
    v_accvgpr_write_b32 a29, 0
    v_accvgpr_write_b32 a30, 0
    v_accvgpr_write_b32 a31, 0
    v_accvgpr_write_b32 a32, 0
    v_accvgpr_write_b32 a33, 0
    v_accvgpr_write_b32 a34, 0
    v_accvgpr_write_b32 a35, 0
    v_accvgpr_write_b32 a36, 0
    v_accvgpr_write_b32 a37, 0
    v_accvgpr_write_b32 a38, 0
    v_accvgpr_write_b32 a39, 0
    v_accvgpr_write_b32 a40, 0
    v_accvgpr_write_b32 a41, 0
    v_accvgpr_write_b32 a42, 0
    v_accvgpr_write_b32 a43, 0
    v_accvgpr_write_b32 a44, 0
    v_accvgpr_write_b32 a45, 0
    v_accvgpr_write_b32 a46, 0
    v_accvgpr_write_b32 a47, 0
    v_accvgpr_write_b32 a48, 0
    v_accvgpr_write_b32 a49, 0
    v_accvgpr_write_b32 a50, 0
    v_accvgpr_write_b32 a51, 0
    v_accvgpr_write_b32 a52, 0
    v_accvgpr_write_b32 a53, 0
    v_accvgpr_write_b32 a54, 0
    v_accvgpr_write_b32 a55, 0
    v_accvgpr_write_b32 a56, 0
    v_accvgpr_write_b32 a57, 0
    v_accvgpr_write_b32 a58, 0
    v_accvgpr_write_b32 a59, 0
    v_accvgpr_write_b32 a60, 0
    v_accvgpr_write_b32 a61, 0
    v_accvgpr_write_b32 a62, 0
    v_accvgpr_write_b32 a63, 0
    v_accvgpr_write_b32 a144, 0
    v_accvgpr_write_b32 a145, 0
    v_accvgpr_write_b32 a146, 0
    v_accvgpr_write_b32 a147, 0
    v_accvgpr_write_b32 a148, 0
    v_accvgpr_write_b32 a149, 0
    v_accvgpr_write_b32 a150, 0
    v_accvgpr_write_b32 a151, 0
    v_accvgpr_write_b32 a152, 0
    v_accvgpr_write_b32 a153, 0
    v_accvgpr_write_b32 a154, 0
    v_accvgpr_write_b32 a155, 0
    v_accvgpr_write_b32 a156, 0
    v_accvgpr_write_b32 a157, 0
    v_accvgpr_write_b32 a158, 0
    v_accvgpr_write_b32 a159, 0
    v_accvgpr_write_b32 a160, 0
    v_accvgpr_write_b32 a161, 0
    v_accvgpr_write_b32 a162, 0
    v_accvgpr_write_b32 a163, 0
    v_accvgpr_write_b32 a164, 0
    v_accvgpr_write_b32 a165, 0
    v_accvgpr_write_b32 a166, 0
    v_accvgpr_write_b32 a167, 0
    v_accvgpr_write_b32 a168, 0
    v_accvgpr_write_b32 a169, 0
    v_accvgpr_write_b32 a170, 0
    v_accvgpr_write_b32 a171, 0
    v_accvgpr_write_b32 a172, 0
    v_accvgpr_write_b32 a173, 0
    v_accvgpr_write_b32 a174, 0
    v_accvgpr_write_b32 a175, 0
    v_accvgpr_write_b32 a176, 0
    v_accvgpr_write_b32 a177, 0
    v_accvgpr_write_b32 a178, 0
    v_accvgpr_write_b32 a179, 0
    v_accvgpr_write_b32 a180, 0
    v_accvgpr_write_b32 a181, 0
    v_accvgpr_write_b32 a182, 0
    v_accvgpr_write_b32 a183, 0
    v_accvgpr_write_b32 a184, 0
    v_accvgpr_write_b32 a185, 0
    v_accvgpr_write_b32 a186, 0
    v_accvgpr_write_b32 a187, 0
    v_accvgpr_write_b32 a188, 0
    v_accvgpr_write_b32 a189, 0
    v_accvgpr_write_b32 a190, 0
    v_accvgpr_write_b32 a191, 0
    v_accvgpr_write_b32 a192, 0
    v_accvgpr_write_b32 a193, 0
    v_accvgpr_write_b32 a194, 0
    v_accvgpr_write_b32 a195, 0
    v_accvgpr_write_b32 a196, 0
    v_accvgpr_write_b32 a197, 0
    v_accvgpr_write_b32 a198, 0
    v_accvgpr_write_b32 a199, 0
    v_accvgpr_write_b32 a200, 0
    v_accvgpr_write_b32 a201, 0
    v_accvgpr_write_b32 a202, 0
    v_accvgpr_write_b32 a203, 0
    v_accvgpr_write_b32 a204, 0
    v_accvgpr_write_b32 a205, 0
    v_accvgpr_write_b32 a206, 0
    v_accvgpr_write_b32 a207, 0
    v_accvgpr_write_b32 a208, 0
    v_accvgpr_write_b32 a209, 0
    v_accvgpr_write_b32 a210, 0
    v_accvgpr_write_b32 a211, 0
    v_accvgpr_write_b32 a212, 0
    v_accvgpr_write_b32 a213, 0
    v_accvgpr_write_b32 a214, 0
    v_accvgpr_write_b32 a215, 0
    v_accvgpr_write_b32 a216, 0
    v_accvgpr_write_b32 a217, 0
    v_accvgpr_write_b32 a218, 0
    v_accvgpr_write_b32 a219, 0
    v_accvgpr_write_b32 a220, 0
    v_accvgpr_write_b32 a221, 0
    v_accvgpr_write_b32 a222, 0
    v_accvgpr_write_b32 a223, 0
    v_bfe_u32 v92, v1, 4, 1
    v_sub_u32 v92, 0, v92
    v_and_b32 v92, 0xaaaaaaaa, v92
    v_or_b32 v215, 0x44444444, v92
    v_bfe_u32 v92, v1, 5, 1
    v_cmp_eq_u32 vcc, 0, v92
    v_mov_b32 v92, 0x3f803f80
    s_nop 0
    v_cndmask_b32 v92, 0, v92, vcc
    v_accvgpr_write_b32 a136, v92
    v_accvgpr_write_b32 a137, v92
    v_accvgpr_write_b32 a138, v92
    v_accvgpr_write_b32 a139, v92
    s_mov_b32 s77, s75
    s_mov_b32 s76, 0
    s_mov_b32 s38, 16384
    s_add_u32 m0, s76, s75
    s_nop 0
    buffer_load_dwordx4 v1, s[36:39], s77 offen sc1 lds
    buffer_load_dwordx4 v1, s[36:39], s77 offen offset:1024 sc1 lds
    buffer_load_dwordx4 v1, s[36:39], s77 offen offset:2048 sc1 lds
    buffer_load_dwordx4 v1, s[36:39], s77 offen offset:3072 sc1 lds
    s_add_u32 s100, s77, 4096
    s_add_u32 m0, m0, 4096
    s_nop 0
    buffer_load_dwordx4 v1, s[36:39], s100 offen sc1 lds
    buffer_load_dwordx4 v1, s[36:39], s100 offen offset:1024 sc1 lds
    buffer_load_dwordx4 v1, s[36:39], s100 offen offset:2048 sc1 lds
    buffer_load_dwordx4 v1, s[36:39], s100 offen offset:3072 sc1 lds
    s_add_u32 s77, s77, 32768
    s_add_u32 s76, s76, 32768
    s_lshr_b32 s82, s4, 1
    s_add_u32 s82, s82, 32
    s_sub_u32 s82, s82, s6
    s_sub_u32 s82, s82, s6
    s_lshl_b32 s38, s82, 15
    s_add_u32 m0, s76, s75
    s_nop 0
    buffer_load_dwordx4 v1, s[36:39], s77 offen sc1 lds
    buffer_load_dwordx4 v1, s[36:39], s77 offen offset:1024 sc1 lds
    buffer_load_dwordx4 v1, s[36:39], s77 offen offset:2048 sc1 lds
    buffer_load_dwordx4 v1, s[36:39], s77 offen offset:3072 sc1 lds
    s_add_u32 s100, s77, 4096
    s_add_u32 m0, m0, 4096
    s_nop 0
    buffer_load_dwordx4 v1, s[36:39], s100 offen sc1 lds
    buffer_load_dwordx4 v1, s[36:39], s100 offen offset:1024 sc1 lds
    buffer_load_dwordx4 v1, s[36:39], s100 offen offset:2048 sc1 lds
    buffer_load_dwordx4 v1, s[36:39], s100 offen offset:3072 sc1 lds
    s_add_u32 s77, s77, 32768
    s_add_u32 s76, s76, 32768
    s_add_u32 m0, s76, s75
    s_nop 0
    buffer_load_dwordx4 v1, s[36:39], s77 offen sc1 lds
    buffer_load_dwordx4 v1, s[36:39], s77 offen offset:1024 sc1 lds
    buffer_load_dwordx4 v1, s[36:39], s77 offen offset:2048 sc1 lds
    buffer_load_dwordx4 v1, s[36:39], s77 offen offset:3072 sc1 lds
    s_add_u32 s100, s77, 4096
    s_add_u32 m0, m0, 4096
    s_nop 0
    buffer_load_dwordx4 v1, s[36:39], s100 offen sc1 lds
    buffer_load_dwordx4 v1, s[36:39], s100 offen offset:1024 sc1 lds
    buffer_load_dwordx4 v1, s[36:39], s100 offen offset:2048 sc1 lds
    buffer_load_dwordx4 v1, s[36:39], s100 offen offset:3072 sc1 lds
    s_add_u32 s77, s77, 32768
    s_add_u32 s76, s76, 32768
    s_add_u32 s86, s101, 4096
    s_mov_b32 s87, 3072
    s_cmp_eq_u32 s6, 7
    s_cselect_b32 s86, s101, s86
    s_cselect_b32 s87, 0, s87
    s_sub_u32 s7, s101, 4096
    s_mov_b32 s98, 0
    s_cmp_eq_u32 s6, 0
    s_cselect_b32 s7, s101, s7
    s_cselect_b32 s98, 1073741824, s98
    s_bitcmp1_b32 s4, 0
    s_cselect_b32 s86, s86, s7
    s_cselect_b32 s87, s87, s98
    s_mul_i32 s7, s86, 48
    s_add_u32 s87, s87, s7
    s_add_u32 s87, s87, 19922944
    s_mov_b32 s82, 0
    s_mov_b32 s95, 32768
    s_mov_b32 s93, 65536
    s_mov_b32 s60, 131072
    v_mov_b32 v2, v1
    s_cmp_eq_u32 s6, 0
    s_cselect_b32 s16, s8, 0
    s_cselect_b32 s17, s9, 0
    s_cmp_eq_u32 s6, 0
    s_cselect_b32 s18, s10, 0
    s_cselect_b32 s19, s11, 0
    s_cmp_eq_u32 s6, 0
    s_cselect_b32 s20, s12, 0
    s_cselect_b32 s21, s13, 0
    s_cmp_eq_u32 s6, 0
    s_cselect_b32 s22, s14, 0
    s_cselect_b32 s23, s15, 0
    s_waitcnt vmcnt(16)
    s_barrier
    ds_read_b128 a[224:227], v2 offset:0
    ds_read_b128 a[228:231], v2 offset:1024
    ds_read_b128 a[232:235], v2 offset:2048
    ds_read_b128 a[236:239], v2 offset:3072
    s_waitcnt lgkmcnt(0)
    ds_read_b128 a[240:243], v2 offset:4096
    ds_read_b128 a[244:247], v2 offset:5120
    ds_read_b128 a[248:251], v2 offset:6144
    ds_read_b128 a[252:255], v2 offset:7168
    v_mul_f32 v176, s16, v208
    v_mul_f32 v177, s16, v209
    v_mul_f32 v178, s16, v210
    v_mul_f32 v179, s16, v211
    s_nop 1
    v_mfma_f32_16x16x32_bf16 v[240:243], a[224:227], v[128:131], v[176:179]
    v_mfma_f32_16x16x32_bf16 v[240:243], a[228:231], v[160:163], v[240:243]
    v_mfma_f32_16x16x32_bf16 v[240:243], a[232:235], v[192:195], v[240:243]
    v_mfma_f32_16x16x32_bf16 v[240:243], a[236:239], v[224:227], v[240:243]
    v_mfma_f32_16x16x32_bf16 v[244:247], a[224:227], v[132:135], 0
    v_mfma_f32_16x16x32_bf16 v[244:247], a[228:231], v[164:167], v[244:247]
    v_mfma_f32_16x16x32_bf16 v[244:247], a[232:235], v[196:199], v[244:247]
    v_mfma_f32_16x16x32_bf16 v[244:247], a[236:239], v[228:231], v[244:247]
    v_mfma_f32_16x16x32_bf16 v[248:251], a[224:227], v[136:139], 0
    v_mfma_f32_16x16x32_bf16 v[248:251], a[228:231], v[168:171], v[248:251]
    v_mfma_f32_16x16x32_bf16 v[248:251], a[232:235], v[200:203], v[248:251]
    v_mfma_f32_16x16x32_bf16 v[248:251], a[236:239], v[232:235], v[248:251]
    v_mfma_f32_16x16x32_bf16 v[252:255], a[224:227], v[140:143], 0
    v_mfma_f32_16x16x32_bf16 v[252:255], a[228:231], v[172:175], v[252:255]
    v_mfma_f32_16x16x32_bf16 v[252:255], a[232:235], v[204:207], v[252:255]
    v_mfma_f32_16x16x32_bf16 v[252:255], a[236:239], v[236:239], v[252:255]
    v_add_f32 v240, v240, v144
    v_exp_f32 v240, v240
    v_add_f32 v241, v241, v144
    v_exp_f32 v241, v241
    v_add_f32 v242, v242, v144
    v_exp_f32 v242, v242
    v_add_f32 v243, v243, v144
    v_exp_f32 v243, v243
    v_add_f32 v244, v244, v148
    v_exp_f32 v244, v244
    v_add_f32 v245, v245, v148
    v_exp_f32 v245, v245
    v_add_f32 v246, v246, v148
    v_exp_f32 v246, v246
    v_add_f32 v247, v247, v148
    v_exp_f32 v247, v247
    v_add_f32 v248, v248, v152
    v_exp_f32 v248, v248
    v_add_f32 v249, v249, v152
    v_exp_f32 v249, v249
    v_add_f32 v250, v250, v152
    v_exp_f32 v250, v250
    v_add_f32 v251, v251, v152
    v_exp_f32 v251, v251
    v_add_f32 v252, v252, v156
    v_exp_f32 v252, v252
    v_add_f32 v253, v253, v156
    v_exp_f32 v253, v253
    v_add_f32 v254, v254, v156
    v_exp_f32 v254, v254
    v_add_f32 v255, v255, v156
    v_exp_f32 v255, v255
    s_nop 1
    s_branch K1_ATT
SPIN_WA:
    s_mov_b32 s94, 0
SPIN_WA_L:
    s_sleep 2
    buffer_load_dword v7, v9, s[44:47], s69 offen sc1
    s_add_u32 s94, s94, 1
    s_cmp_ge_u32 s94, 0x40000
    s_waitcnt vmcnt(0)
    s_cbranch_scc1 BACK_WA
    v_cmp_gt_u32 vcc, 8, v7
    s_nop 1
    s_and_b64 vcc, vcc, s[86:87]
    s_cbranch_scc1 SPIN_WA_L
    s_branch BACK_WA
SPIN_KV:
    s_mov_b32 s94, 0
SPIN_KV_L:
    s_sleep 2
    buffer_load_dword v7, v8, s[32:35], s61 offen sc1
    s_add_u32 s94, s94, 1
    s_cmp_ge_u32 s94, 0x40000
    s_waitcnt vmcnt(0)
    s_cbranch_scc1 BACK_KV
    v_cmp_gt_u32 vcc, 1, v7
    s_nop 1
    s_and_b64 vcc, vcc, exec
    s_cbranch_scc1 SPIN_KV_L
    s_branch BACK_KV
SPIN_SHORT:
    s_mov_b32 s94, 0
SPIN_SHORT_L:
    s_sleep 2
    buffer_load_dword v3, v217, s[32:35], s19 offen sc1
    s_add_u32 s94, s94, 1
    s_cmp_ge_u32 s94, 0x40000
    s_waitcnt vmcnt(0)
    s_cbranch_scc1 BACK_SHORT
    v_cmp_gt_u32 vcc, 1, v3
    s_nop 1
    s_and_b64 vcc, vcc, exec
    s_cbranch_scc1 SPIN_SHORT_L
    s_branch BACK_SHORT
SPIN_CTX:
    s_mov_b32 s94, 0
SPIN_CTX_L:
    s_sleep 2
    buffer_load_dword v3, v217, s[32:35], s19 offen sc1
    s_add_u32 s94, s94, 1
    s_cmp_ge_u32 s94, 0x40000
    s_waitcnt vmcnt(0)
    s_cbranch_scc1 BACK_CTX
    v_cmp_gt_u32 vcc, 2, v3
    s_nop 1
    s_and_b64 vcc, vcc, exec
    s_cbranch_scc1 SPIN_CTX_L
    s_branch BACK_CTX
SPIN_ALL:
    s_mov_b32 s94, 0
SPIN_ALL_L:
    s_sleep 2
    buffer_load_dword v28, v29, s[32:35], s92 offen sc1
    s_add_u32 s94, s94, 1
    s_cmp_ge_u32 s94, 0x40000
    s_waitcnt vmcnt(0)
    s_cbranch_scc1 BACK_ALL
    v_cmp_gt_u32 vcc, 1, v28
    s_nop 1
    s_and_b64 vcc, vcc, exec
    s_cbranch_scc1 SPIN_ALL_L
    s_branch BACK_ALL
SPIN_OA:
    s_mov_b32 s94, 0
SPIN_OA_L:
    s_sleep 2
    buffer_load_dword v3, v19, s[32:35], s66 offen sc1
    s_add_u32 s94, s94, 1
    s_cmp_ge_u32 s94, 0x40000
    s_waitcnt vmcnt(0)
    s_cbranch_scc1 BACK_OA
    v_cmp_gt_u32 vcc, 3, v3
    s_nop 1
    s_and_b64 vcc, vcc, exec
    s_cbranch_scc1 SPIN_OA_L
    s_branch BACK_OA
SPIN_X:
    s_mov_b32 s94, 0
SPIN_X_L:
    s_sleep 2
    buffer_load_dword v3, v19, s[32:35], s66 offen sc1
    s_add_u32 s94, s94, 1
    s_cmp_ge_u32 s94, 0x40000
    s_waitcnt vmcnt(0)
    s_cbranch_scc1 BACK_X
    v_cmp_gt_u32 vcc, 3, v3
    s_nop 1
    s_and_b64 vcc, vcc, exec
    s_cbranch_scc1 SPIN_X_L
    s_branch BACK_X
SPIN_W0H:
    s_mov_b32 s94, 0
SPIN_W0H_L:
    s_sleep 2
    buffer_load_dword v28, off, s[32:35], s86 sc1
    s_add_u32 s94, s94, 1
    s_cmp_ge_u32 s94, 0x40000
    s_waitcnt vmcnt(0)
    s_cbranch_scc1 BACK_W0H
    v_cmp_gt_u32 vcc, 2, v28
    s_nop 1
    s_and_b64 vcc, vcc, exec
    s_cbranch_scc1 SPIN_W0H_L
    s_branch BACK_W0H
SPIN_W0:
    s_mov_b32 s94, 0
SPIN_W0_L:
    s_sleep 2
    buffer_load_dword v3, v29, s[32:35], s92 offen sc1
    s_add_u32 s94, s94, 1
    s_cmp_ge_u32 s94, 0x40000
    s_waitcnt vmcnt(0)
    s_cbranch_scc1 BACK_W0
    v_cmp_gt_u32 vcc, 1, v3
    s_nop 1
    s_cmp_lg_u32 vcc_lo, 0
    s_cbranch_scc1 SPIN_W0_L
    s_branch BACK_W0
SPIN_W7H:
    s_mov_b32 s94, 0
SPIN_W7H_L:
    s_sleep 2
    buffer_load_dword v28, off, s[32:35], s86 sc1
    s_add_u32 s94, s94, 1
    s_cmp_ge_u32 s94, 0x40000
    s_waitcnt vmcnt(0)
    s_cbranch_scc1 BACK_W7H
    v_cmp_gt_u32 vcc, 2, v28
    s_nop 1
    s_and_b64 vcc, vcc, exec
    s_cbranch_scc1 SPIN_W7H_L
    s_branch BACK_W7H
SPIN_W7:
    s_mov_b32 s94, 0
SPIN_W7_L:
    s_sleep 2
    buffer_load_dword v3, v29, s[32:35], s92 offen sc1
    s_add_u32 s94, s94, 1
    s_cmp_ge_u32 s94, 0x40000
    s_waitcnt vmcnt(0)
    s_cbranch_scc1 BACK_W7
    v_cmp_gt_u32 vcc, 1, v3
    s_nop 1
    s_cmp_lg_u32 vcc_lo, 0
    s_cbranch_scc1 SPIN_W7_L
    s_branch BACK_W7
.section .rodata,"a"
.p2align 6
.amdhsa_kernel gated_mix__sliding_local_dilated__compressed_kv_cla__prompt_kernel
.amdhsa_next_free_vgpr 512
.amdhsa_next_free_sgpr 102
.amdhsa_accum_offset 256
.amdhsa_group_segment_fixed_size 0
.amdhsa_kernarg_size 104
.amdhsa_user_sgpr_count 2
.amdhsa_user_sgpr_kernarg_segment_ptr 1
.amdhsa_system_sgpr_workgroup_id_x 1
.amdhsa_ieee_mode 0
.amdhsa_dx10_clamp 0
.end_amdhsa_kernel
```

```asm
; @launch grid=(256,1,1) block=(256,1,1) lds=163840
.amdgcn_target "amdgcn-amd-amdhsa--gfx950"
.text
.globl gated_mix__sliding_local_dilated__compressed_kv_cla__prompt_kernel
.p2align 8
.type gated_mix__sliding_local_dilated__compressed_kv_cla__prompt_kernel,@function
gated_mix__sliding_local_dilated__compressed_kv_cla__prompt_kernel:
    s_cmp_ge_u32 s2, 256
    s_cbranch_scc1 K1_END
    s_getpc_b64 s[94:95]
    s_load_dwordx8 s[36:43], s[0:1], 32
    v_min_u32 v74, 16, v0
    s_lshr_b32 s7, s2, 3
    s_mul_i32 s7, s7, 17
    v_add_lshl_u32 v74, v74, s7, 7
    global_load_dword v76, v74, s[94:95]
    v_lshrrev_b32 v64, 6, v0
    v_and_b32 v31, 63, v0
    v_readfirstlane_b32 s4, v64
    s_and_b32 s5, s2, 7
    s_lshl_b32 s5, s5, 2
    s_bfe_u32 s7, s2, 0x20003
    s_add_u32 s5, s5, s7
    s_lshr_b32 s6, s2, 5
    s_lshl_b32 s69, s4, 12
    s_mov_b32 s10, 2097152
    s_mov_b32 s11, 0x20000
    s_mov_b32 s14, 4194304
    s_mov_b32 s15, 0x20000
    s_mov_b32 s18, 4194304
    s_mov_b32 s19, 0x20000
    v_lshrrev_b32 v65, 3, v31
    v_and_b32 v66, 7, v31
    v_lshrrev_b32 v67, 1, v65
    v_xor_b32 v66, v66, v67
    v_lshlrev_b32 v66, 4, v66
    v_xor_b32 v67, 64, v66
    s_lshr_b32 s7, s4, 1
    s_lshl_b32 s73, s7, 7
    s_and_b32 s100, s4, 1
    s_lshl_b32 s98, s100, 5
    s_add_u32 s98, s98, s73
    v_add_lshl_u32 v68, v65, s98, 10
    v_add_u32 v6, v68, v66
    v_add_u32 v7, v68, v67
    v_add_u32 v7, 7168, v7
    v_add_u32 v8, v68, v66
    v_add_u32 v8, 14336, v8
    v_add_u32 v9, v68, v67
    v_add_u32 v9, 21504, v9
    v_lshrrev_b32 v69, 4, v31
    v_and_b32 v70, 15, v31
    v_lshlrev_b32 v71, 1, v69
    v_xor_b32 v71, v71, v70
    v_lshlrev_b32 v71, 4, v71
    v_xor_b32 v72, 128, v71
    s_lshl_b32 s98, s4, 4
    v_add_lshl_u32 v73, v69, s98, 13
    v_add_u32 v2, v73, v71
    v_add_u32 v3, v73, v71
    v_add_u32 v3, 31744, v3
    v_add_u32 v4, v73, v72
    v_add_u32 v4, 63488, v4
    v_add_u32 v5, v73, v72
    v_add_u32 v5, 95232, v5
    s_and_b32 s3, s2, 0
    s_lshl_b32 s66, s3, 7
    s_lshl_b32 s60, s3, 11
    s_add_u32 s60, s60, s5
    s_lshl_b32 s60, s60, 8
    s_lshl_b32 s61, s6, 18
    s_add_u32 s61, s61, s66
    s_add_u32 s62, s61, 65536
    s_waitcnt lgkmcnt(0)
    s_mov_b64 s[8:9], s[36:37]
    s_mov_b64 s[24:25], s[38:39]
    s_mov_b64 s[12:13], s[40:41]
    s_mov_b64 s[16:17], s[42:43]
    s_load_dwordx2 s[20:21], s[0:1], 0
    s_load_dwordx2 s[28:29], s[0:1], 8
    s_load_dwordx2 s[32:33], s[0:1], 72
    s_load_dwordx2 s[48:49], s[0:1], 64
    s_load_dwordx2 s[92:93], s[0:1], 16
    s_load_dwordx2 s[44:45], s[0:1], 88
    s_load_dwordx2 s[56:57], s[0:1], 96
    s_load_dwordx2 s[0:1], s[0:1], 80
    s_add_u32 m0, s69, 0
    s_nop 0
    buffer_load_dwordx4 v6, s[8:11], s61 offen lds
    buffer_load_dwordx4 v7, s[8:11], s61 offen offset:1024 lds
    buffer_load_dwordx4 v8, s[8:11], s61 offen offset:2048 lds
    buffer_load_dwordx4 v9, s[8:11], s61 offen offset:3072 lds
    s_xor_b32 s61, s61, 128
    s_add_u32 m0, s69, 16384
    s_nop 0
    buffer_load_dwordx4 v6, s[8:11], s62 offen lds
    buffer_load_dwordx4 v7, s[8:11], s62 offen offset:1024 lds
    buffer_load_dwordx4 v8, s[8:11], s62 offen offset:2048 lds
    buffer_load_dwordx4 v9, s[8:11], s62 offen offset:3072 lds
    s_xor_b32 s62, s62, 128
    s_add_u32 m0, s69, 32768
    s_nop 0
    buffer_load_dwordx4 v2, s[12:15], s60 offen nt lds
    buffer_load_dwordx4 v3, s[12:15], s60 offen offset:1024 nt lds
    buffer_load_dwordx4 v4, s[12:15], s60 offen offset:2048 nt lds
    buffer_load_dwordx4 v5, s[12:15], s60 offen offset:3072 nt lds
    s_add_u32 m0, s69, 49152
    s_nop 0
    buffer_load_dwordx4 v6, s[8:11], s61 offen lds
    buffer_load_dwordx4 v7, s[8:11], s61 offen offset:1024 lds
    buffer_load_dwordx4 v8, s[8:11], s61 offen offset:2048 lds
    buffer_load_dwordx4 v9, s[8:11], s61 offen offset:3072 lds
    s_xor_b32 s61, s61, 384
    s_waitcnt lgkmcnt(0)
    s_mov_b32 s22, 2359296
    s_mov_b32 s23, 0x20000
    s_mov_b32 s26, 4718592
    s_mov_b32 s27, 0x20000
    s_mov_b32 s50, 4718592
    s_mov_b32 s51, 0x20000
    s_mov_b32 s46, 256
    s_mov_b32 s47, 0x20000
    s_mov_b32 s30, 1990656
    s_mov_b32 s31, 0x20000
    s_mov_b32 s34, 1152
    s_mov_b32 s35, 0x20000
    s_mul_i32 s7, s5, 1081344
    s_add_u32 s36, s56, s7
    s_addc_u32 s37, s57, 0
    s_mov_b32 s38, 1081344
    s_mov_b32 s39, 0x20000
    s_cmp_eq_u32 s4, 0
    s_cselect_b32 s86, 0x55555555, 0
    s_cselect_b32 s87, 0x55555555, 0
    s_cselect_b32 s52, s48, s92
    s_cselect_b32 s53, s49, s93
    s_cselect_b32 s54, s50, 663552
    s_mov_b32 s55, 0x20000
    s_mul_i32 s63, s6, 147456
    s_sub_u32 s64, 2211840, s63
    s_add_u32 s63, s63, s66
    s_add_u32 s64, s64, s66
    s_lshl_b32 s67, s4, 11
    s_lshl_b32 s68, s4, 10
    s_lshl_b32 s75, s4, 13
    s_lshl_b32 s65, s3, 13
    s_add_u32 s65, s65, s67
    s_lshl_b32 s70, s6, 2
    s_lshl1_add_u32 s70, s100, s70
    s_lshl_b32 s70, s70, 15
    s_lshl_b32 s98, s73, 6
    s_add_u32 s71, s70, s98
    s_add_u32 s71, s71, 49152
    s_lshl_b32 s98, s73, 4
    s_add_u32 s70, s70, s98
    v_lshlrev_b32 v1, 4, v31
    v_mov_b32 v77, 1073741824
    v_cmp_eq_u32 vcc, 0, v0
    s_nop 1
    v_cndmask_b32_e64 v30, v77, 0, vcc
    v_lshlrev_b32 v103, 7, v31
    v_cmp_gt_u32 vcc, 9, v31
    s_nop 1
    v_cndmask_b32 v103, v77, v103, vcc
    s_lshl_b32 s98, s4, 5
    v_add_u32 v68, s98, v65
    v_mul_u32_u24 v68, 1152, v68
    v_add_u32 v10, v68, v66
    v_add_u32 v11, v68, v67
    v_add_u32 v11, 8192, v11
    v_add_u32 v12, v68, v66
    v_add_u32 v12, 16384, v12
    v_add_u32 v13, v68, v67
    v_add_u32 v13, 24576, v13
    v_lshrrev_b32 v71, 1, v70
    v_xor_b32 v71, v71, v69
    v_lshlrev_b32 v71, 4, v71
    v_lshl_add_u32 v71, v70, 7, v71
    s_add_u32 m0, s69, 65536
    s_nop 0
    buffer_load_dwordx4 v2, s[16:19], s60 offen nt lds
    v_xor_b32 v72, 64, v71
    s_lshl_b32 s98, s100, 13
    v_add_u32 v22, s98, v71
    v_add_u32 v23, s98, v72
    v_add_u32 v24, s67, v71
    v_add_u32 v25, s67, v72
    v_bfe_u32 v73, v31, 2, 2
    v_and_b32 v74, 3, v31
    v_lshl_add_u32 v75, v69, 3, v73
    v_and_b32 v78, 1, v69
    v_lshl_add_u32 v77, v78, 2, v73
    v_lshlrev_b32 v77, 5, v77
    v_lshl_add_u32 v77, v74, 3, v77
    v_lshl_add_u32 v77, v75, 8, v77
    v_xor_b32 v14, 0, v77
    v_xor_b32 v14, s73, v14
    buffer_load_dwordx4 v3, s[16:19], s60 offen offset:1024 nt lds
    v_xor_b32 v15, 32, v77
    v_xor_b32 v15, s73, v15
    v_xor_b32 v16, 64, v77
    v_xor_b32 v16, s73, v16
    v_xor_b32 v17, 96, v77
    v_xor_b32 v17, s73, v17
    v_xor_b32 v18, 128, v77
    v_xor_b32 v19, 160, v77
    v_xor_b32 v20, 192, v77
    v_xor_b32 v21, 224, v77
    v_lshrrev_b32 v77, 1, v73
    v_lshl_add_u32 v77, v78, 1, v77
    v_lshlrev_b32 v77, 5, v77
    v_lshl_add_u32 v77, v74, 3, v77
    v_lshl_add_u32 v77, v75, 7, v77
    s_lshr_b32 s98, s73, 1
    buffer_load_dwordx4 v4, s[16:19], s60 offen offset:2048 nt lds
    v_xor_b32 v26, 0, v77
    v_xor_b32 v26, s98, v26
    v_xor_b32 v27, 32, v77
    v_xor_b32 v28, 64, v77
    v_xor_b32 v28, s98, v28
    v_xor_b32 v29, 96, v77
    v_and_b32 v73, 7, v0
    v_lshrrev_b32 v74, 3, v0
    v_lshl_add_u32 v75, v73, 1, 0
    v_mul_u32_u24 v78, 52, v75
    v_lshrrev_b32 v78, 8, v78
    v_mul_u32_u24 v79, 5, v78
    v_sub_u32 v75, v75, v79
    v_add_u32 v78, 1, v78
    v_cmp_le_u32 vcc, 3, v78
    s_nop 1
    v_cndmask_b32_e64 v78, v78, 0, vcc
    buffer_load_dwordx4 v5, s[16:19], s60 offen offset:3072 nt lds
    s_xor_b32 s60, s60, 524288
    v_mul_u32_u24 v78, 1152, v78
    v_lshl_add_u32 v75, v75, 3, v78
    v_mad_u32_u24 v75, v74, 36, v75
    v_lshl_add_u32 v77, v73, 1, 1
    v_mul_u32_u24 v78, 52, v77
    v_lshrrev_b32 v78, 8, v78
    v_mul_u32_u24 v79, 5, v78
    v_sub_u32 v77, v77, v79
    v_add_u32 v78, 1, v78
    v_cmp_le_u32 vcc, 3, v78
    s_nop 1
    v_cndmask_b32_e64 v78, v78, 0, vcc
    v_mul_u32_u24 v78, 1152, v78
    v_lshl_add_u32 v77, v77, 3, v78
    v_mad_u32_u24 v77, v74, 36, v77
    s_mul_i32 s98, s2, 10368
    s_mul_i32 s99, s2, 6
    s_mov_b32 s7, 73728
    v_mul_lo_u32 v95, v74, s7
    v_lshl_add_u32 v95, v73, 4, v95
    v_cmp_eq_u32 s[92:93], 7, v73
    s_add_u32 s56, s56, 56623104
    s_addc_u32 s57, s57, 0
    s_mov_b32 s58, 5603328
    s_mov_b32 s59, 0x20000
    s_lshl_b32 s101, s6, 5
    s_add_u32 s101, s101, s5
    s_lshl_b32 s101, s101, 7
    v_mov_b32 v65, 0
    v_lshrrev_b32 v64, 2, v0
    v_lshlrev_b32 v64, 15, v64
    v_and_b32 v79, 3, v0
    v_lshl_add_u32 v64, v79, 2, v64
    s_mov_b32 s74, 0x3e0293ee
    s_lshl_b32 s95, s5, 3
    s_waitcnt vmcnt(8)
    s_barrier
    ds_read_b128 a[0:3], v22 offset:0
    ds_read_b64_tr_b16 v[40:41], v14 offset:32768
    ds_read_b64_tr_b16 v[42:43], v14 offset:33792
    ds_read_b128 a[4:7], v23 offset:0
    ds_read_b64_tr_b16 v[44:45], v14 offset:40960
    ds_read_b64_tr_b16 v[46:47], v14 offset:41984
    ds_read_b128 a[8:11], v22 offset:2048
    ds_read_b128 a[12:15], v23 offset:2048
    ds_read_b128 a[16:19], v22 offset:4096
    ds_read_b128 a[20:23], v23 offset:4096
    ds_read_b128 a[24:27], v22 offset:6144
    ds_read_b128 a[28:31], v23 offset:6144
    ds_read_b128 a[32:35], v22 offset:16384
    ds_read_b128 a[36:39], v23 offset:16384
    ds_read_b128 a[40:43], v22 offset:18432
    s_waitcnt lgkmcnt(14)
    ds_read_b128 a[44:47], v23 offset:18432
    s_waitcnt lgkmcnt(14)
    ds_read_b128 a[48:51], v22 offset:20480
    s_waitcnt lgkmcnt(14)
    ds_read_b128 a[52:55], v23 offset:20480
    s_waitcnt lgkmcnt(14)
    ds_read_b128 a[56:59], v22 offset:22528
    s_waitcnt lgkmcnt(14)
    ds_read_b128 a[60:63], v23 offset:22528
    v_mfma_f32_16x16x32_bf16 v[128:131], v[40:43], a[0:3], 0
    s_add_u32 m0, s69, 81920
    s_waitcnt lgkmcnt(14)
    ds_read_b64_tr_b16 v[48:49], v15 offset:32768
    s_waitcnt lgkmcnt(14)
    ds_read_b64_tr_b16 v[50:51], v15 offset:33792
    v_mfma_f32_16x16x32_bf16 v[128:131], v[44:47], a[4:7], v[128:131]
    s_mul_i32 s77, s2, 9216
    buffer_load_dwordx4 v6, s[8:11], s62 offen lds
    v_mfma_f32_16x16x32_bf16 v[132:135], v[40:43], a[8:11], 0
    s_mul_i32 s76, s4, 1152
    s_waitcnt lgkmcnt(14)
    ds_read_b64_tr_b16 v[52:53], v15 offset:40960
    s_waitcnt lgkmcnt(13)
    ds_read_b64_tr_b16 v[54:55], v15 offset:41984
    v_mfma_f32_16x16x32_bf16 v[132:135], v[44:47], a[12:15], v[132:135]
    s_add_u32 s77, s77, s76
    ds_read_b64_tr_b16 v[56:57], v16 offset:32768
    s_waitcnt lgkmcnt(10)
    ds_read_b64_tr_b16 v[58:59], v16 offset:33792
    v_mfma_f32_16x16x32_bf16 v[136:139], v[40:43], a[16:19], 0
    s_mul_i32 s76, s4, 1152
    buffer_load_dwordx4 v7, s[8:11], s62 offen offset:1024 lds
    v_mfma_f32_16x16x32_bf16 v[136:139], v[44:47], a[20:23], v[136:139]
    s_mul_i32 s72, s2, 3
    ds_read_b64_tr_b16 v[60:61], v16 offset:40960
    ds_read_b64_tr_b16 v[62:63], v16 offset:41984
    v_mfma_f32_16x16x32_bf16 v[140:143], v[40:43], a[24:27], 0
    s_add_u32 s72, s72, 0
    v_add_u32 v14, 0x10000, v14
    v_add_u32 v15, 0x10000, v15
    v_mfma_f32_16x16x32_bf16 v[140:143], v[44:47], a[28:31], v[140:143]
    s_mul_i32 s7, s5, 73728
    v_add_u32 v16, 0x10000, v16
    v_mov_b32 v31, 1
    v_mfma_f32_16x16x32_bf16 v[144:147], v[40:43], a[32:35], 0
    s_and_b32 s100, s5, 1
    buffer_load_dwordx4 v8, s[8:11], s62 offen offset:2048 lds
    v_mfma_f32_16x16x32_bf16 v[144:147], v[44:47], a[36:39], v[144:147]
    s_mov_b32 vcc_lo, 0x84848484
    s_mov_b32 vcc_hi, 0x84848484
    v_add_u32 v18, 0x10000, v18
    v_mfma_f32_16x16x32_bf16 v[148:151], v[40:43], a[40:43], 0
    s_mov_b32 s83, 0
    v_add_u32 v19, 0x10000, v19
    v_add_u32 v20, 0x10000, v20
    s_waitcnt lgkmcnt(0)
    v_mfma_f32_16x16x32_bf16 v[148:151], v[44:47], a[44:47], v[148:151]
    v_add_u32 v21, 0x10000, v21
    v_add_u32 v26, 0x10000, v26
    v_mfma_f32_16x16x32_bf16 v[152:155], v[40:43], a[48:51], 0
    buffer_load_dwordx4 v9, s[8:11], s62 offen offset:3072 lds
    v_mfma_f32_16x16x32_bf16 v[152:155], v[44:47], a[52:55], v[152:155]
    v_add_u32 v27, 0x10000, v27
    v_add_u32 v28, 0x10000, v28
    v_mfma_f32_16x16x32_bf16 v[156:159], v[40:43], a[56:59], 0
    s_add_u32 m0, s69, 98304
    ds_read_b64_tr_b16 v[40:41], v17 offset:32768
    ds_read_b64_tr_b16 v[42:43], v17 offset:33792
    v_mfma_f32_16x16x32_bf16 v[156:159], v[44:47], a[60:63], v[156:159]
    s_xor_b32 s62, s62, 384
    ds_read_b64_tr_b16 v[44:45], v17 offset:40960
    ds_read_b64_tr_b16 v[46:47], v17 offset:41984
    v_mfma_f32_16x16x32_bf16 v[160:163], v[48:51], a[0:3], 0
    buffer_load_dwordx4 v2, s[12:15], s60 offen nt lds
    v_mfma_f32_16x16x32_bf16 v[160:163], v[52:55], a[4:7], v[160:163]
    v_add_u32 v17, 0x10000, v17
    v_add_u32 v29, 0x10000, v29
    v_mfma_f32_16x16x32_bf16 v[164:167], v[48:51], a[8:11], 0
    v_bfe_u32 v37, v1, 4, 4
    v_mul_u32_u24 v36, 1152, v37
    v_mfma_f32_16x16x32_bf16 v[164:167], v[52:55], a[12:15], v[164:167]
    v_lshrrev_b32 v38, 8, v1
    v_lshl_add_u32 v36, v38, 4, v36
    v_mfma_f32_16x16x32_bf16 v[168:171], v[48:51], a[16:19], 0
    buffer_load_dwordx4 v3, s[12:15], s60 offen offset:1024 nt lds
    v_mfma_f32_16x16x32_bf16 v[168:171], v[52:55], a[20:23], v[168:171]
    v_lshrrev_b32 v39, 3, v37
    v_mul_u32_u24 v39, 9152, v39
    v_mfma_f32_16x16x32_bf16 v[172:175], v[48:51], a[24:27], 0
    v_mfma_f32_16x16x32_bf16 v[172:175], v[52:55], a[28:31], v[172:175]
    v_mfma_f32_16x16x32_bf16 v[176:179], v[48:51], a[32:35], 0
    buffer_load_dwordx4 v4, s[12:15], s60 offen offset:2048 nt lds
    v_mfma_f32_16x16x32_bf16 v[176:179], v[52:55], a[36:39], v[176:179]
    v_mfma_f32_16x16x32_bf16 v[180:183], v[48:51], a[40:43], 0
    v_mfma_f32_16x16x32_bf16 v[180:183], v[52:55], a[44:47], v[180:183]
    v_mfma_f32_16x16x32_bf16 v[184:187], v[48:51], a[48:51], 0
    buffer_load_dwordx4 v5, s[12:15], s60 offen offset:3072 nt lds
    v_mfma_f32_16x16x32_bf16 v[184:187], v[52:55], a[52:55], v[184:187]
    v_mfma_f32_16x16x32_bf16 v[188:191], v[48:51], a[56:59], 0
    s_waitcnt vmcnt(12)
    s_barrier
    v_mfma_f32_16x16x32_bf16 v[188:191], v[52:55], a[60:63], v[188:191]
    s_add_u32 m0, s69, 114688
    ds_read_b128 a[64:67], v22 offset:49152
    v_mfma_f32_16x16x32_bf16 v[192:195], v[56:59], a[0:3], 0
    buffer_load_dwordx4 v6, s[8:11], s61 offen lds
    v_mfma_f32_16x16x32_bf16 v[192:195], v[60:63], a[4:7], v[192:195]
    v_mfma_f32_16x16x32_bf16 v[196:199], v[56:59], a[8:11], 0
    ds_read_b128 a[68:71], v23 offset:49152
    v_mfma_f32_16x16x32_bf16 v[196:199], v[60:63], a[12:15], v[196:199]
    v_mfma_f32_16x16x32_bf16 v[200:203], v[56:59], a[16:19], 0
    buffer_load_dwordx4 v7, s[8:11], s61 offen offset:1024 lds
    v_mfma_f32_16x16x32_bf16 v[200:203], v[60:63], a[20:23], v[200:203]
    v_mfma_f32_16x16x32_bf16 v[204:207], v[56:59], a[24:27], 0
    ds_read_b128 a[72:75], v22 offset:51200
    v_mfma_f32_16x16x32_bf16 v[204:207], v[60:63], a[28:31], v[204:207]
    v_mfma_f32_16x16x32_bf16 v[208:211], v[56:59], a[32:35], 0
    buffer_load_dwordx4 v8, s[8:11], s61 offen offset:2048 lds
    v_mfma_f32_16x16x32_bf16 v[208:211], v[60:63], a[36:39], v[208:211]
    ds_read_b128 a[76:79], v23 offset:51200
    v_mfma_f32_16x16x32_bf16 v[212:215], v[56:59], a[40:43], 0
    v_mfma_f32_16x16x32_bf16 v[212:215], v[60:63], a[44:47], v[212:215]
    v_mfma_f32_16x16x32_bf16 v[216:219], v[56:59], a[48:51], 0
    buffer_load_dwordx4 v9, s[8:11], s61 offen offset:3072 lds
    v_mfma_f32_16x16x32_bf16 v[216:219], v[60:63], a[52:55], v[216:219]
    ds_read_b128 a[80:83], v22 offset:53248
    v_mfma_f32_16x16x32_bf16 v[220:223], v[56:59], a[56:59], 0
    s_xor_b32 s61, s61, 128
    v_mfma_f32_16x16x32_bf16 v[220:223], v[60:63], a[60:63], v[220:223]
    s_add_u32 m0, s69, 131072
    s_waitcnt lgkmcnt(1)
    v_mfma_f32_16x16x32_bf16 v[224:227], v[40:43], a[0:3], 0
    buffer_load_dwordx4 v2, s[16:19], s60 offen nt lds
    v_mfma_f32_16x16x32_bf16 v[224:227], v[44:47], a[4:7], v[224:227]
    ds_read_b128 a[84:87], v23 offset:53248
    v_mfma_f32_16x16x32_bf16 v[228:231], v[40:43], a[8:11], 0
    buffer_load_dword v104, v103, s[20:23], s77 offen
    v_mfma_f32_16x16x32_bf16 v[228:231], v[44:47], a[12:15], v[228:231]
    s_add_u32 s77, s77, 4608
    v_mfma_f32_16x16x32_bf16 v[232:235], v[40:43], a[16:19], 0
    ds_read_b128 a[88:91], v22 offset:55296
    v_mfma_f32_16x16x32_bf16 v[232:235], v[44:47], a[20:23], v[232:235]
    s_waitcnt vmcnt(10)
    s_barrier
    ds_read_b64_tr_b16 v[48:49], v14 offset:0
    v_mfma_f32_16x16x32_bf16 v[236:239], v[40:43], a[24:27], 0
    buffer_load_dwordx4 v3, s[16:19], s60 offen offset:1024 nt lds
    v_mfma_f32_16x16x32_bf16 v[236:239], v[44:47], a[28:31], v[236:239]
    ds_read_b64_tr_b16 v[50:51], v14 offset:1024
    ds_read_b64_tr_b16 v[52:53], v14 offset:8192
    v_mfma_f32_16x16x32_bf16 v[240:243], v[40:43], a[32:35], 0
    ds_read_b64_tr_b16 v[54:55], v14 offset:9216
    ds_read_b128 a[92:95], v23 offset:55296
    v_mfma_f32_16x16x32_bf16 v[240:243], v[44:47], a[36:39], v[240:243]
    buffer_load_dwordx4 v4, s[16:19], s60 offen offset:2048 nt lds
    v_mfma_f32_16x16x32_bf16 v[244:247], v[40:43], a[40:43], 0
    ds_read_b64_tr_b16 v[56:57], v15 offset:0
    ds_read_b64_tr_b16 v[58:59], v15 offset:1024
    v_mfma_f32_16x16x32_bf16 v[244:247], v[44:47], a[44:47], v[244:247]
    ds_read_b64_tr_b16 v[60:61], v15 offset:8192
    ds_read_b64_tr_b16 v[62:63], v15 offset:9216
    v_mfma_f32_16x16x32_bf16 v[248:251], v[40:43], a[48:51], 0
    v_mfma_f32_16x16x32_bf16 v[248:251], v[44:47], a[52:55], v[248:251]
    buffer_load_dwordx4 v5, s[16:19], s60 offen offset:3072 nt lds
    v_mfma_f32_16x16x32_bf16 v[252:255], v[40:43], a[56:59], 0
    ds_read_b64_tr_b16 v[40:41], v16 offset:0
    ds_read_b64_tr_b16 v[42:43], v16 offset:1024
    v_mfma_f32_16x16x32_bf16 v[252:255], v[44:47], a[60:63], v[252:255]
    s_waitcnt lgkmcnt(4)
    ds_read_b64_tr_b16 v[44:45], v16 offset:8192
    ds_read_b64_tr_b16 v[46:47], v16 offset:9216
    v_mfma_f32_16x16x32_bf16 a[128:131], a[0:3], v[48:51], 0
    v_mfma_f32_16x16x32_bf16 a[128:131], a[4:7], v[52:55], a[128:131]
    s_add_u32 m0, s69, 147456
    v_add_u32 v22, 0x10000, v22
    v_mfma_f32_16x16x32_bf16 a[132:135], a[8:11], v[48:51], 0
    s_xor_b32 s60, s60, 1572864
    buffer_load_dwordx4 v6, s[8:11], s62 offen lds
    v_mfma_f32_16x16x32_bf16 a[132:135], a[12:15], v[52:55], a[132:135]
    ds_read_b128 a[96:99], v22 offset:16384
    v_mfma_f32_16x16x32_bf16 a[136:139], a[16:19], v[48:51], 0
    v_mfma_f32_16x16x32_bf16 a[136:139], a[20:23], v[52:55], a[136:139]
    v_mfma_f32_16x16x32_bf16 a[140:143], a[24:27], v[48:51], 0
    buffer_load_dwordx4 v7, s[8:11], s62 offen offset:1024 lds
    v_mfma_f32_16x16x32_bf16 a[140:143], a[28:31], v[52:55], a[140:143]
    v_add_u32 v23, 0x10000, v23
    ds_read_b128 a[100:103], v23 offset:16384
    v_mfma_f32_16x16x32_bf16 a[144:147], a[32:35], v[48:51], 0
    v_mfma_f32_16x16x32_bf16 a[144:147], a[36:39], v[52:55], a[144:147]
    v_mfma_f32_16x16x32_bf16 a[148:151], a[40:43], v[48:51], 0
    v_mfma_f32_16x16x32_bf16 a[148:151], a[44:47], v[52:55], a[148:151]
    buffer_load_dwordx4 v8, s[8:11], s62 offen offset:2048 lds
    v_mfma_f32_16x16x32_bf16 a[152:155], a[48:51], v[48:51], 0
    v_mfma_f32_16x16x32_bf16 a[152:155], a[52:55], v[52:55], a[152:155]
    ds_read_b128 a[104:107], v22 offset:18432
    v_mfma_f32_16x16x32_bf16 a[156:159], a[56:59], v[48:51], 0
    ds_read_b64_tr_b16 v[48:49], v17 offset:0
    ds_read_b64_tr_b16 v[50:51], v17 offset:1024
    v_mfma_f32_16x16x32_bf16 a[156:159], a[60:63], v[52:55], a[156:159]
    buffer_load_dwordx4 v9, s[8:11], s62 offen offset:3072 lds
    v_mfma_f32_16x16x32_bf16 a[160:163], a[0:3], v[56:59], 0
    s_waitcnt lgkmcnt(3)
    ds_read_b64_tr_b16 v[52:53], v17 offset:8192
    ds_read_b64_tr_b16 v[54:55], v17 offset:9216
    v_mfma_f32_16x16x32_bf16 a[160:163], a[4:7], v[60:63], a[160:163]
    v_mfma_f32_16x16x32_bf16 a[164:167], a[8:11], v[56:59], 0
    ds_read_b128 a[108:111], v23 offset:18432
    v_mfma_f32_16x16x32_bf16 a[164:167], a[12:15], v[60:63], a[164:167]
    s_add_u32 m0, s69, 0
    v_mfma_f32_16x16x32_bf16 a[168:171], a[16:19], v[56:59], 0
    s_xor_b32 s62, s62, 128
    buffer_load_dwordx4 v2, s[12:15], s60 offen nt lds
    v_mfma_f32_16x16x32_bf16 a[168:171], a[20:23], v[60:63], a[168:171]
    v_mfma_f32_16x16x32_bf16 a[172:175], a[24:27], v[56:59], 0
    v_mfma_f32_16x16x32_bf16 a[172:175], a[28:31], v[60:63], a[172:175]
    v_mfma_f32_16x16x32_bf16 a[176:179], a[32:35], v[56:59], 0
    buffer_load_dwordx4 v3, s[12:15], s60 offen offset:1024 nt lds
    v_mfma_f32_16x16x32_bf16 a[176:179], a[36:39], v[60:63], a[176:179]
    ds_read_b128 a[112:115], v22 offset:20480
    v_mfma_f32_16x16x32_bf16 a[180:183], a[40:43], v[56:59], 0
    v_mfma_f32_16x16x32_bf16 a[180:183], a[44:47], v[60:63], a[180:183]
    v_mfma_f32_16x16x32_bf16 a[184:187], a[48:51], v[56:59], 0
    v_mfma_f32_16x16x32_bf16 a[184:187], a[52:55], v[60:63], a[184:187]
    buffer_load_dwordx4 v4, s[12:15], s60 offen offset:2048 nt lds
    v_mfma_f32_16x16x32_bf16 a[188:191], a[56:59], v[56:59], 0
    ds_read_b128 a[116:119], v23 offset:20480
    v_mfma_f32_16x16x32_bf16 a[188:191], a[60:63], v[60:63], a[188:191]
    v_mfma_f32_16x16x32_bf16 a[192:195], a[0:3], v[40:43], 0
    v_mfma_f32_16x16x32_bf16 a[192:195], a[4:7], v[44:47], a[192:195]
    buffer_load_dwordx4 v5, s[12:15], s60 offen offset:3072 nt lds
    v_mfma_f32_16x16x32_bf16 a[196:199], a[8:11], v[40:43], 0
    v_mfma_f32_16x16x32_bf16 a[196:199], a[12:15], v[44:47], a[196:199]
    ds_read_b128 a[120:123], v22 offset:22528
    v_mfma_f32_16x16x32_bf16 a[200:203], a[16:19], v[40:43], 0
    v_mfma_f32_16x16x32_bf16 a[200:203], a[20:23], v[44:47], a[200:203]
    s_add_u32 m0, s69, 16384
    v_mfma_f32_16x16x32_bf16 a[204:207], a[24:27], v[40:43], 0
    buffer_load_dwordx4 v6, s[8:11], s61 offen lds
    v_mfma_f32_16x16x32_bf16 a[204:207], a[28:31], v[44:47], a[204:207]
    v_mfma_f32_16x16x32_bf16 a[208:211], a[32:35], v[40:43], 0
    ds_read_b128 a[124:127], v23 offset:22528
    v_mfma_f32_16x16x32_bf16 a[208:211], a[36:39], v[44:47], a[208:211]
    v_mfma_f32_16x16x32_bf16 a[212:215], a[40:43], v[40:43], 0
    buffer_load_dwordx4 v7, s[8:11], s61 offen offset:1024 lds
    v_mfma_f32_16x16x32_bf16 a[212:215], a[44:47], v[44:47], a[212:215]
    v_mfma_f32_16x16x32_bf16 a[216:219], a[48:51], v[40:43], 0
    v_mfma_f32_16x16x32_bf16 a[216:219], a[52:55], v[44:47], a[216:219]
    v_mfma_f32_16x16x32_bf16 a[220:223], a[56:59], v[40:43], 0
    buffer_load_dwordx2 v[80:81], v75, s[28:31], s98 offen nt
    v_mfma_f32_16x16x32_bf16 a[220:223], a[60:63], v[44:47], a[220:223]
    s_waitcnt lgkmcnt(0)
    buffer_load_dwordx4 v8, s[8:11], s61 offen offset:2048 lds
    v_mfma_f32_16x16x32_bf16 a[224:227], a[0:3], v[48:51], 0
    v_mfma_f32_16x16x32_bf16 a[224:227], a[4:7], v[52:55], a[224:227]
    v_mfma_f32_16x16x32_bf16 a[228:231], a[8:11], v[48:51], 0
    v_mfma_f32_16x16x32_bf16 a[228:231], a[12:15], v[52:55], a[228:231]
    buffer_load_dwordx4 v9, s[8:11], s61 offen offset:3072 lds
    v_mfma_f32_16x16x32_bf16 a[232:235], a[16:19], v[48:51], 0
    v_mfma_f32_16x16x32_bf16 a[232:235], a[20:23], v[52:55], a[232:235]
    s_waitcnt vmcnt(9) lgkmcnt(0)
    s_barrier
    ds_read_b64_tr_b16 v[56:57], v14 offset:32768
    v_mfma_f32_16x16x32_bf16 a[236:239], a[24:27], v[48:51], 0
    s_add_u32 m0, s69, 32768
    buffer_load_dwordx2 v[82:83], v77, s[28:31], s98 offen nt
    v_mfma_f32_16x16x32_bf16 a[236:239], a[28:31], v[52:55], a[236:239]
    s_xor_b32 s61, s61, 896
    ds_read_b64_tr_b16 v[58:59], v14 offset:33792
    ds_read_b64_tr_b16 v[60:61], v14 offset:40960
    v_mfma_f32_16x16x32_bf16 a[240:243], a[32:35], v[48:51], 0
    ds_read_b64_tr_b16 v[62:63], v14 offset:41984
    ds_read_b64_tr_b16 v[40:41], v15 offset:32768
    v_mfma_f32_16x16x32_bf16 a[240:243], a[36:39], v[52:55], a[240:243]
    ds_read_b64_tr_b16 v[42:43], v15 offset:33792
    ds_read_b64_tr_b16 v[44:45], v15 offset:40960
    v_mfma_f32_16x16x32_bf16 a[244:247], a[40:43], v[48:51], 0
    buffer_load_dwordx4 v2, s[16:19], s60 offen nt lds
    v_mfma_f32_16x16x32_bf16 a[244:247], a[44:47], v[52:55], a[244:247]
    ds_read_b64_tr_b16 v[46:47], v15 offset:41984
    v_add_u32 v14, 0x10000, v14
    v_mfma_f32_16x16x32_bf16 a[248:251], a[48:51], v[48:51], 0
    v_add_u32 v15, 0x10000, v15
    v_mfma_f32_16x16x32_bf16 a[248:251], a[52:55], v[52:55], a[248:251]
    v_mfma_f32_16x16x32_bf16 a[252:255], a[56:59], v[48:51], 0
    s_add_u32 s98, s98, 3456
    buffer_load_ushort v92, v65, s[32:35], s99 offen offset:0
    v_mfma_f32_16x16x32_bf16 a[252:255], a[60:63], v[52:55], a[252:255]
    s_waitcnt lgkmcnt(1)
    ds_read_b64_tr_b16 v[48:49], v16 offset:32768
    ds_read_b64_tr_b16 v[50:51], v16 offset:33792
    v_mfma_f32_16x16x32_bf16 v[128:131], v[56:59], a[64:67], v[128:131]
    ds_read_b64_tr_b16 v[52:53], v16 offset:40960
    ds_read_b64_tr_b16 v[54:55], v16 offset:41984
    v_mfma_f32_16x16x32_bf16 v[128:131], v[60:63], a[68:71], v[128:131]
    v_add_u32 v16, 0x10000, v16
    v_mfma_f32_16x16x32_bf16 v[132:135], v[56:59], a[72:75], v[132:135]
    buffer_load_dwordx4 v3, s[16:19], s60 offen offset:1024 nt lds
    v_mfma_f32_16x16x32_bf16 v[132:135], v[60:63], a[76:79], v[132:135]
    ds_read_b128 a[0:3], v22 offset:49152
    v_mfma_f32_16x16x32_bf16 v[136:139], v[56:59], a[80:83], v[136:139]
    v_mfma_f32_16x16x32_bf16 v[136:139], v[60:63], a[84:87], v[136:139]
    v_mfma_f32_16x16x32_bf16 v[140:143], v[56:59], a[88:91], v[140:143]
    buffer_load_dwordx2 v[84:85], v75, s[28:31], s98 offen nt
    v_mfma_f32_16x16x32_bf16 v[140:143], v[60:63], a[92:95], v[140:143]
    ds_read_b128 a[4:7], v23 offset:49152
    v_mfma_f32_16x16x32_bf16 v[144:147], v[56:59], a[96:99], v[144:147]
    v_mfma_f32_16x16x32_bf16 v[144:147], v[60:63], a[100:103], v[144:147]
    v_mfma_f32_16x16x32_bf16 v[148:151], v[56:59], a[104:107], v[148:151]
    buffer_load_dwordx4 v4, s[16:19], s60 offen offset:2048 nt lds
    v_mfma_f32_16x16x32_bf16 v[148:151], v[60:63], a[108:111], v[148:151]
    v_mfma_f32_16x16x32_bf16 v[152:155], v[56:59], a[112:115], v[152:155]
    v_mfma_f32_16x16x32_bf16 v[152:155], v[60:63], a[116:119], v[152:155]
    ds_read_b128 a[8:11], v22 offset:51200
    v_mfma_f32_16x16x32_bf16 v[156:159], v[56:59], a[120:123], v[156:159]
    buffer_load_dwordx2 v[86:87], v77, s[28:31], s98 offen nt
    v_mfma_f32_16x16x32_bf16 v[156:159], v[60:63], a[124:127], v[156:159]
    ds_read_b64_tr_b16 v[56:57], v17 offset:32768
    ds_read_b64_tr_b16 v[58:59], v17 offset:33792
    v_mfma_f32_16x16x32_bf16 v[160:163], v[40:43], a[64:67], v[160:163]
    s_add_u32 s98, s98, 3456
    ds_read_b64_tr_b16 v[60:61], v17 offset:40960
    ds_read_b64_tr_b16 v[62:63], v17 offset:41984
    s_waitcnt lgkmcnt(5)
    v_mfma_f32_16x16x32_bf16 v[160:163], v[44:47], a[68:71], v[160:163]
    v_add_u32 v17, 0x10000, v17
    v_mfma_f32_16x16x32_bf16 v[164:167], v[40:43], a[72:75], v[164:167]
    buffer_load_dword v105, v103, s[20:23], s77 offen
    v_mfma_f32_16x16x32_bf16 v[164:167], v[44:47], a[76:79], v[164:167]
    s_mul_i32 s77, s2, 18432
    ds_read_b128 a[12:15], v23 offset:51200
    v_mfma_f32_16x16x32_bf16 v[168:171], v[40:43], a[80:83], v[168:171]
    s_add_u32 s77, s77, s76
    v_mfma_f32_16x16x32_bf16 v[168:171], v[44:47], a[84:87], v[168:171]
    s_mov_b32 s76, 0
    v_mfma_f32_16x16x32_bf16 v[172:175], v[40:43], a[88:91], v[172:175]
    buffer_load_ushort v93, v65, s[32:35], s99 offen offset:2
    v_mfma_f32_16x16x32_bf16 v[172:175], v[44:47], a[92:95], v[172:175]
    v_mfma_f32_16x16x32_bf16 v[176:179], v[40:43], a[96:99], v[176:179]
    ds_read_b128 a[16:19], v22 offset:53248
    v_mfma_f32_16x16x32_bf16 v[176:179], v[44:47], a[100:103], v[176:179]
    v_mfma_f32_16x16x32_bf16 v[180:183], v[40:43], a[104:107], v[180:183]
    buffer_load_dwordx4 v5, s[16:19], s60 offen offset:3072 nt lds
    v_mfma_f32_16x16x32_bf16 v[180:183], v[44:47], a[108:111], v[180:183]
    s_add_u32 m0, s69, 49152
    s_xor_b32 s60, s60, 524288
    v_mfma_f32_16x16x32_bf16 v[184:187], v[40:43], a[112:115], v[184:187]
    v_mfma_f32_16x16x32_bf16 v[184:187], v[44:47], a[116:119], v[184:187]
    ds_read_b128 a[20:23], v23 offset:53248
    v_mfma_f32_16x16x32_bf16 v[188:191], v[40:43], a[120:123], v[188:191]
    buffer_load_dwordx2 v[88:89], v75, s[28:31], s98 offen nt
    v_mfma_f32_16x16x32_bf16 v[188:191], v[44:47], a[124:127], v[188:191]
    ds_read_b64_tr_b16 v[40:41], v14 offset:0
    ds_read_b64_tr_b16 v[42:43], v14 offset:1024
    v_mfma_f32_16x16x32_bf16 v[192:195], v[48:51], a[64:67], v[192:195]
    ds_read_b64_tr_b16 v[44:45], v14 offset:8192
    ds_read_b64_tr_b16 v[46:47], v14 offset:9216
    v_mfma_f32_16x16x32_bf16 v[192:195], v[52:55], a[68:71], v[192:195]
    v_add_u32 v14, 0xfffe0000, v14
    v_mfma_f32_16x16x32_bf16 v[196:199], v[48:51], a[72:75], v[196:199]
    buffer_load_dwordx4 v6, s[8:11], s62 offen lds
    v_mfma_f32_16x16x32_bf16 v[196:199], v[52:55], a[76:79], v[196:199]
    ds_read_b128 a[24:27], v22 offset:55296
    v_mfma_f32_16x16x32_bf16 v[200:203], v[48:51], a[80:83], v[200:203]
    v_mfma_f32_16x16x32_bf16 v[200:203], v[52:55], a[84:87], v[200:203]
    v_mfma_f32_16x16x32_bf16 v[204:207], v[48:51], a[88:91], v[204:207]
    buffer_load_dwordx2 v[90:91], v77, s[28:31], s98 offen nt
    v_mfma_f32_16x16x32_bf16 v[204:207], v[52:55], a[92:95], v[204:207]
    s_add_u32 s98, s98, 3456
    s_add_u32 s28, s56, 6291456
    s_addc_u32 s29, s57, 0
    v_mfma_f32_16x16x32_bf16 v[208:211], v[48:51], a[96:99], v[208:211]
    s_mov_b32 s30, 2359296
    ds_read_b128 a[28:31], v23 offset:55296
    v_mfma_f32_16x16x32_bf16 v[208:211], v[52:55], a[100:103], v[208:211]
    s_bfe_u32 s98, s72, 0x10001
    v_mfma_f32_16x16x32_bf16 v[212:215], v[48:51], a[104:107], v[212:215]
    buffer_load_dwordx4 v7, s[8:11], s62 offen offset:1024 lds
    v_mfma_f32_16x16x32_bf16 v[212:215], v[52:55], a[108:111], v[212:215]
    v_mfma_f32_16x16x32_bf16 v[216:219], v[48:51], a[112:115], v[216:219]
    v_mfma_f32_16x16x32_bf16 v[216:219], v[52:55], a[116:119], v[216:219]
    v_mfma_f32_16x16x32_bf16 v[220:223], v[48:51], a[120:123], v[220:223]
    buffer_load_ushort v94, v65, s[32:35], s99 offen offset:4
    v_mfma_f32_16x16x32_bf16 v[220:223], v[52:55], a[124:127], v[220:223]
    s_add_u32 s32, s56, 9437184
    s_addc_u32 s33, s57, 0
    s_mov_b32 s34, 196608
    s_waitcnt lgkmcnt(0)
    v_mfma_f32_16x16x32_bf16 v[224:227], v[56:59], a[64:67], v[224:227]
    s_bfe_u32 s99, s72, 0x10003
    ds_read_b64_tr_b16 v[48:49], v15 offset:0
    ds_read_b64_tr_b16 v[50:51], v15 offset:1024
    v_mfma_f32_16x16x32_bf16 v[224:227], v[60:63], a[68:71], v[224:227]
    s_lshl1_add_u32 s98, s99, s98
    ds_read_b64_tr_b16 v[52:53], v15 offset:8192
    ds_read_b64_tr_b16 v[54:55], v15 offset:9216
    v_mfma_f32_16x16x32_bf16 v[228:231], v[56:59], a[72:75], v[228:231]
    s_lshl_b32 s98, s98, 5
    buffer_load_dwordx4 v8, s[8:11], s62 offen offset:2048 lds
    v_mfma_f32_16x16x32_bf16 v[228:231], v[60:63], a[76:79], v[228:231]
    s_lshl_b32 s72, s72, 7
    v_add_u32 v15, 0xfffe0000, v15
    v_mfma_f32_16x16x32_bf16 v[232:235], v[56:59], a[80:83], v[232:235]
    v_mfma_f32_16x16x32_bf16 v[232:235], v[60:63], a[84:87], v[232:235]
    v_mfma_f32_16x16x32_bf16 v[236:239], v[56:59], a[88:91], v[236:239]
    buffer_store_dword v65, v64, s[32:35], s101 offen sc1
    v_mfma_f32_16x16x32_bf16 v[236:239], v[60:63], a[92:95], v[236:239]
    v_mfma_f32_16x16x32_bf16 v[240:243], v[56:59], a[96:99], v[240:243]
    v_mfma_f32_16x16x32_bf16 v[240:243], v[60:63], a[100:103], v[240:243]
    v_mfma_f32_16x16x32_bf16 v[244:247], v[56:59], a[104:107], v[244:247]
    buffer_load_dwordx4 v9, s[8:11], s62 offen offset:3072 lds
    v_mfma_f32_16x16x32_bf16 v[244:247], v[60:63], a[108:111], v[244:247]
    s_xor_b32 s62, s62, 896
    s_add_u32 m0, s69, 65536
    v_mfma_f32_16x16x32_bf16 v[248:251], v[56:59], a[112:115], v[248:251]
    v_mfma_f32_16x16x32_bf16 v[248:251], v[60:63], a[116:119], v[248:251]
    v_mfma_f32_16x16x32_bf16 v[252:255], v[56:59], a[120:123], v[252:255]
    buffer_load_dwordx4 v2, s[12:15], s60 offen nt lds
    v_mfma_f32_16x16x32_bf16 v[252:255], v[60:63], a[124:127], v[252:255]
    ds_read_b64_tr_b16 v[56:57], v16 offset:0
    ds_read_b64_tr_b16 v[58:59], v16 offset:1024
    v_mfma_f32_16x16x32_bf16 a[128:131], a[64:67], v[40:43], a[128:131]
    ds_read_b64_tr_b16 v[60:61], v16 offset:8192
    ds_read_b64_tr_b16 v[62:63], v16 offset:9216
    v_mfma_f32_16x16x32_bf16 a[128:131], a[68:71], v[44:47], a[128:131]
    v_add_u32 v22, 0x10000, v22
    v_add_u32 v16, 0xfffe0000, v16
    v_mfma_f32_16x16x32_bf16 a[132:135], a[72:75], v[40:43], a[132:135]
    buffer_load_dwordx4 v3, s[12:15], s60 offen offset:1024 nt lds
    v_mfma_f32_16x16x32_bf16 a[132:135], a[76:79], v[44:47], a[132:135]
    ds_read_b128 a[32:35], v22 offset:16384
    v_mfma_f32_16x16x32_bf16 a[136:139], a[80:83], v[40:43], a[136:139]
    s_cmp_lt_u32 s2, 192
    s_cselect_b32 s72, s72, 1073741824
    v_mfma_f32_16x16x32_bf16 a[136:139], a[84:87], v[44:47], a[136:139]
    v_mfma_f32_16x16x32_bf16 a[140:143], a[88:91], v[40:43], a[140:143]
    buffer_load_dwordx4 v4, s[12:15], s60 offen offset:2048 nt lds
    v_mfma_f32_16x16x32_bf16 a[140:143], a[92:95], v[44:47], a[140:143]
    v_add_u32 v23, 0x10000, v23
    ds_read_b128 a[36:39], v23 offset:16384
    v_mfma_f32_16x16x32_bf16 a[144:147], a[96:99], v[40:43], a[144:147]
    v_mfma_f32_16x16x32_bf16 a[144:147], a[100:103], v[44:47], a[144:147]
    v_mfma_f32_16x16x32_bf16 a[148:151], a[104:107], v[40:43], a[148:151]
    v_mfma_f32_16x16x32_bf16 a[148:151], a[108:111], v[44:47], a[148:151]
    v_mfma_f32_16x16x32_bf16 a[152:155], a[112:115], v[40:43], a[152:155]
    buffer_load_dwordx4 v5, s[12:15], s60 offen offset:3072 nt lds
    v_mfma_f32_16x16x32_bf16 a[152:155], a[116:119], v[44:47], a[152:155]
    ds_read_b128 a[40:43], v22 offset:18432
    v_mfma_f32_16x16x32_bf16 a[156:159], a[120:123], v[40:43], a[156:159]
    ds_read_b64_tr_b16 v[40:41], v17 offset:0
    ds_read_b64_tr_b16 v[42:43], v17 offset:1024
    v_mfma_f32_16x16x32_bf16 a[156:159], a[124:127], v[44:47], a[156:159]
    s_waitcnt lgkmcnt(3)
    ds_read_b64_tr_b16 v[44:45], v17 offset:8192
    ds_read_b64_tr_b16 v[46:47], v17 offset:9216
    v_mfma_f32_16x16x32_bf16 a[160:163], a[64:67], v[48:51], a[160:163]
    v_add_u32 v17, 0xfffe0000, v17
    v_mfma_f32_16x16x32_bf16 a[160:163], a[68:71], v[52:55], a[160:163]
    v_mfma_f32_16x16x32_bf16 a[164:167], a[72:75], v[48:51], a[164:167]
    ds_read_b128 a[44:47], v23 offset:18432
    v_mfma_f32_16x16x32_bf16 a[164:167], a[76:79], v[52:55], a[164:167]
    s_add_u32 m0, s69, 81920
    v_mfma_f32_16x16x32_bf16 a[168:171], a[80:83], v[48:51], a[168:171]
    buffer_load_dwordx4 v6, s[8:11], s61 offen lds
    v_mfma_f32_16x16x32_bf16 a[168:171], a[84:87], v[52:55], a[168:171]
    v_mfma_f32_16x16x32_bf16 a[172:175], a[88:91], v[48:51], a[172:175]
    v_mfma_f32_16x16x32_bf16 a[172:175], a[92:95], v[52:55], a[172:175]
    v_mfma_f32_16x16x32_bf16 a[176:179], a[96:99], v[48:51], a[176:179]
    ds_read_b128 a[48:51], v22 offset:20480
    v_mfma_f32_16x16x32_bf16 a[176:179], a[100:103], v[52:55], a[176:179]
    v_mfma_f32_16x16x32_bf16 a[180:183], a[104:107], v[48:51], a[180:183]
    v_mfma_f32_16x16x32_bf16 a[180:183], a[108:111], v[52:55], a[180:183]
    buffer_load_dwordx4 v7, s[8:11], s61 offen offset:1024 lds
    v_mfma_f32_16x16x32_bf16 a[184:187], a[112:115], v[48:51], a[184:187]
    v_mfma_f32_16x16x32_bf16 a[184:187], a[116:119], v[52:55], a[184:187]
    ds_read_b128 a[52:55], v23 offset:20480
    v_mfma_f32_16x16x32_bf16 a[188:191], a[120:123], v[48:51], a[188:191]
    v_mfma_f32_16x16x32_bf16 a[188:191], a[124:127], v[52:55], a[188:191]
    v_mfma_f32_16x16x32_bf16 a[192:195], a[64:67], v[56:59], a[192:195]
    v_mfma_f32_16x16x32_bf16 a[192:195], a[68:71], v[60:63], a[192:195]
    v_mfma_f32_16x16x32_bf16 a[196:199], a[72:75], v[56:59], a[196:199]
    v_mfma_f32_16x16x32_bf16 a[196:199], a[76:79], v[60:63], a[196:199]
    buffer_load_dwordx4 v8, s[8:11], s61 offen offset:2048 lds
    v_mfma_f32_16x16x32_bf16 a[200:203], a[80:83], v[56:59], a[200:203]
    ds_read_b128 a[56:59], v22 offset:22528
    v_mfma_f32_16x16x32_bf16 a[200:203], a[84:87], v[60:63], a[200:203]
    buffer_load_dword v106, v103, s[24:27], s77 offen
    v_mfma_f32_16x16x32_bf16 a[204:207], a[88:91], v[56:59], a[204:207]
    s_add_u32 s77, s77, 4608
    v_mfma_f32_16x16x32_bf16 a[204:207], a[92:95], v[60:63], a[204:207]
    v_mfma_f32_16x16x32_bf16 a[208:211], a[96:99], v[56:59], a[208:211]
    ds_read_b128 a[60:63], v23 offset:22528
    v_mfma_f32_16x16x32_bf16 a[208:211], a[100:103], v[60:63], a[208:211]
    v_mfma_f32_16x16x32_bf16 a[212:215], a[104:107], v[56:59], a[212:215]
    buffer_load_dwordx4 v9, s[8:11], s61 offen offset:3072 lds
    v_mfma_f32_16x16x32_bf16 a[212:215], a[108:111], v[60:63], a[212:215]
    v_mfma_f32_16x16x32_bf16 a[216:219], a[112:115], v[56:59], a[216:219]
    v_mfma_f32_16x16x32_bf16 a[216:219], a[116:119], v[60:63], a[216:219]
    v_mfma_f32_16x16x32_bf16 a[220:223], a[120:123], v[56:59], a[220:223]
    v_mfma_f32_16x16x32_bf16 a[220:223], a[124:127], v[60:63], a[220:223]
    s_waitcnt lgkmcnt(0)
    v_mfma_f32_16x16x32_bf16 a[224:227], a[64:67], v[40:43], a[224:227]
    v_mfma_f32_16x16x32_bf16 a[224:227], a[68:71], v[44:47], a[224:227]
    s_xor_b32 s61, s61, 128
    v_mfma_f32_16x16x32_bf16 a[228:231], a[72:75], v[40:43], a[228:231]
    v_mfma_f32_16x16x32_bf16 a[228:231], a[76:79], v[44:47], a[228:231]
    v_mfma_f32_16x16x32_bf16 a[232:235], a[80:83], v[40:43], a[232:235]
    v_mfma_f32_16x16x32_bf16 a[232:235], a[84:87], v[44:47], a[232:235]
    s_waitcnt vmcnt(9) lgkmcnt(0)
    s_barrier
    ds_read_b64_tr_b16 v[48:49], v14 offset:0
    v_mfma_f32_16x16x32_bf16 a[236:239], a[88:91], v[40:43], a[236:239]
    s_add_u32 m0, s69, 98304
    ds_read_b64_tr_b16 v[50:51], v14 offset:1024
    ds_read_b64_tr_b16 v[52:53], v14 offset:8192
    v_mfma_f32_16x16x32_bf16 a[236:239], a[92:95], v[44:47], a[236:239]
    buffer_load_dwordx4 v2, s[16:19], s60 offen nt lds
    v_mfma_f32_16x16x32_bf16 a[240:243], a[96:99], v[40:43], a[240:243]
    ds_read_b64_tr_b16 v[54:55], v14 offset:9216
    ds_read_b64_tr_b16 v[56:57], v15 offset:0
    v_mfma_f32_16x16x32_bf16 a[240:243], a[100:103], v[44:47], a[240:243]
    ds_read_b64_tr_b16 v[58:59], v15 offset:1024
    ds_read_b64_tr_b16 v[60:61], v15 offset:8192
    v_mfma_f32_16x16x32_bf16 a[244:247], a[104:107], v[40:43], a[244:247]
    ds_read_b64_tr_b16 v[62:63], v15 offset:9216
    v_mfma_f32_16x16x32_bf16 a[244:247], a[108:111], v[44:47], a[244:247]
    v_mfma_f32_16x16x32_bf16 a[248:251], a[112:115], v[40:43], a[248:251]
    v_mfma_f32_16x16x32_bf16 a[248:251], a[116:119], v[44:47], a[248:251]
    buffer_load_dwordx4 v3, s[16:19], s60 offen offset:1024 nt lds
    v_mfma_f32_16x16x32_bf16 a[252:255], a[120:123], v[40:43], a[252:255]
    ds_read_b64_tr_b16 v[40:41], v16 offset:0
    ds_read_b64_tr_b16 v[42:43], v16 offset:1024
    v_mfma_f32_16x16x32_bf16 a[252:255], a[124:127], v[44:47], a[252:255]
    s_waitcnt lgkmcnt(2)
    ds_read_b64_tr_b16 v[44:45], v16 offset:8192
    ds_read_b64_tr_b16 v[46:47], v16 offset:9216
    v_mfma_f32_16x16x32_bf16 v[128:131], v[48:51], a[0:3], v[128:131]
    v_mfma_f32_16x16x32_bf16 v[128:131], v[52:55], a[4:7], v[128:131]
    v_add_u32 v22, 0xfffe0000, v22
    v_mfma_f32_16x16x32_bf16 v[132:135], v[48:51], a[8:11], v[132:135]
    ds_read_b128 a[64:67], v22 offset:16384
    v_mfma_f32_16x16x32_bf16 v[132:135], v[52:55], a[12:15], v[132:135]
    v_mfma_f32_16x16x32_bf16 v[136:139], v[48:51], a[16:19], v[136:139]
    v_mfma_f32_16x16x32_bf16 v[136:139], v[52:55], a[20:23], v[136:139]
    buffer_load_dwordx4 v4, s[16:19], s60 offen offset:2048 nt lds
    v_mfma_f32_16x16x32_bf16 v[140:143], v[48:51], a[24:27], v[140:143]
    v_add_u32 v23, 0xfffe0000, v23
    v_mfma_f32_16x16x32_bf16 v[140:143], v[52:55], a[28:31], v[140:143]
    ds_read_b128 a[68:71], v23 offset:16384
    v_mfma_f32_16x16x32_bf16 v[144:147], v[48:51], a[32:35], v[144:147]
    v_mfma_f32_16x16x32_bf16 v[144:147], v[52:55], a[36:39], v[144:147]
    v_mfma_f32_16x16x32_bf16 v[148:151], v[48:51], a[40:43], v[148:151]
    v_mfma_f32_16x16x32_bf16 v[148:151], v[52:55], a[44:47], v[148:151]
    v_mfma_f32_16x16x32_bf16 v[152:155], v[48:51], a[48:51], v[152:155]
    buffer_load_dwordx4 v5, s[16:19], s60 offen offset:3072 nt lds
    v_mfma_f32_16x16x32_bf16 v[152:155], v[52:55], a[52:55], v[152:155]
    ds_read_b128 a[72:75], v22 offset:18432
    v_mfma_f32_16x16x32_bf16 v[156:159], v[48:51], a[56:59], v[156:159]
    ds_read_b64_tr_b16 v[48:49], v17 offset:0
    ds_read_b64_tr_b16 v[50:51], v17 offset:1024
    v_mfma_f32_16x16x32_bf16 v[156:159], v[52:55], a[60:63], v[156:159]
    ds_read_b64_tr_b16 v[52:53], v17 offset:8192
    ds_read_b64_tr_b16 v[54:55], v17 offset:9216
    v_mfma_f32_16x16x32_bf16 v[160:163], v[56:59], a[0:3], v[160:163]
    v_mfma_f32_16x16x32_bf16 v[160:163], v[60:63], a[4:7], v[160:163]
    v_mfma_f32_16x16x32_bf16 v[164:167], v[56:59], a[8:11], v[164:167]
    ds_read_b128 a[76:79], v23 offset:18432
    v_mfma_f32_16x16x32_bf16 v[164:167], v[60:63], a[12:15], v[164:167]
    s_add_u32 m0, s69, 114688
    v_mfma_f32_16x16x32_bf16 v[168:171], v[56:59], a[16:19], v[168:171]
    s_xor_b32 s60, s60, 3670016
    buffer_load_dwordx4 v6, s[8:11], s62 offen lds
    v_mfma_f32_16x16x32_bf16 v[168:171], v[60:63], a[20:23], v[168:171]
    v_mfma_f32_16x16x32_bf16 v[172:175], v[56:59], a[24:27], v[172:175]
    v_mfma_f32_16x16x32_bf16 v[172:175], v[60:63], a[28:31], v[172:175]
    v_mfma_f32_16x16x32_bf16 v[176:179], v[56:59], a[32:35], v[176:179]
    ds_read_b128 a[80:83], v22 offset:20480
    v_mfma_f32_16x16x32_bf16 v[176:179], v[60:63], a[36:39], v[176:179]
    v_mfma_f32_16x16x32_bf16 v[180:183], v[56:59], a[40:43], v[180:183]
    v_mfma_f32_16x16x32_bf16 v[180:183], v[60:63], a[44:47], v[180:183]
    buffer_load_dwordx4 v7, s[8:11], s62 offen offset:1024 lds
    v_mfma_f32_16x16x32_bf16 v[184:187], v[56:59], a[48:51], v[184:187]
    v_mfma_f32_16x16x32_bf16 v[184:187], v[60:63], a[52:55], v[184:187]
    ds_read_b128 a[84:87], v23 offset:20480
    v_mfma_f32_16x16x32_bf16 v[188:191], v[56:59], a[56:59], v[188:191]
    s_waitcnt lgkmcnt(1)
    ds_read_b64_tr_b16 v[56:57], v14 offset:32768
    ds_read_b64_tr_b16 v[58:59], v14 offset:33792
    v_mfma_f32_16x16x32_bf16 v[188:191], v[60:63], a[60:63], v[188:191]
    ds_read_b64_tr_b16 v[60:61], v14 offset:40960
    ds_read_b64_tr_b16 v[62:63], v14 offset:41984
    v_mfma_f32_16x16x32_bf16 v[192:195], v[40:43], a[0:3], v[192:195]
    v_add_u32 v14, 0x10000, v14
    v_mfma_f32_16x16x32_bf16 v[192:195], v[44:47], a[4:7], v[192:195]
    v_mfma_f32_16x16x32_bf16 v[196:199], v[40:43], a[8:11], v[196:199]
    v_mfma_f32_16x16x32_bf16 v[196:199], v[44:47], a[12:15], v[196:199]
    buffer_load_dwordx4 v8, s[8:11], s62 offen offset:2048 lds
    v_mfma_f32_16x16x32_bf16 v[200:203], v[40:43], a[16:19], v[200:203]
    ds_read_b128 a[88:91], v22 offset:22528
    v_mfma_f32_16x16x32_bf16 v[200:203], v[44:47], a[20:23], v[200:203]
    v_mfma_f32_16x16x32_bf16 v[204:207], v[40:43], a[24:27], v[204:207]
    v_mfma_f32_16x16x32_bf16 v[204:207], v[44:47], a[28:31], v[204:207]
    v_mfma_f32_16x16x32_bf16 v[208:211], v[40:43], a[32:35], v[208:211]
    ds_read_b128 a[92:95], v23 offset:22528
    v_mfma_f32_16x16x32_bf16 v[208:211], v[44:47], a[36:39], v[208:211]
    v_mfma_f32_16x16x32_bf16 v[212:215], v[40:43], a[40:43], v[212:215]
    buffer_load_dwordx4 v9, s[8:11], s62 offen offset:3072 lds
    v_mfma_f32_16x16x32_bf16 v[212:215], v[44:47], a[44:47], v[212:215]
    v_mfma_f32_16x16x32_bf16 v[216:219], v[40:43], a[48:51], v[216:219]
    v_mfma_f32_16x16x32_bf16 v[216:219], v[44:47], a[52:55], v[216:219]
    v_mfma_f32_16x16x32_bf16 v[220:223], v[40:43], a[56:59], v[220:223]
    ds_read_b64_tr_b16 v[40:41], v15 offset:32768
    ds_read_b64_tr_b16 v[42:43], v15 offset:33792
    v_mfma_f32_16x16x32_bf16 v[220:223], v[44:47], a[60:63], v[220:223]
    ds_read_b64_tr_b16 v[44:45], v15 offset:40960
    ds_read_b64_tr_b16 v[46:47], v15 offset:41984
    v_mfma_f32_16x16x32_bf16 v[224:227], v[48:51], a[0:3], v[224:227]
    v_add_u32 v15, 0x10000, v15
    v_mfma_f32_16x16x32_bf16 v[224:227], v[52:55], a[4:7], v[224:227]
    s_xor_b32 s62, s62, 128
    v_mfma_f32_16x16x32_bf16 v[228:231], v[48:51], a[8:11], v[228:231]
    v_mfma_f32_16x16x32_bf16 v[228:231], v[52:55], a[12:15], v[228:231]
    v_mfma_f32_16x16x32_bf16 v[232:235], v[48:51], a[16:19], v[232:235]
    v_mfma_f32_16x16x32_bf16 v[232:235], v[52:55], a[20:23], v[232:235]
    s_add_u32 m0, s69, 131072
    v_mfma_f32_16x16x32_bf16 v[236:239], v[48:51], a[24:27], v[236:239]
    buffer_load_dwordx4 v2, s[12:15], s60 offen nt lds
    v_mfma_f32_16x16x32_bf16 v[236:239], v[52:55], a[28:31], v[236:239]
    v_mfma_f32_16x16x32_bf16 v[240:243], v[48:51], a[32:35], v[240:243]
    v_mfma_f32_16x16x32_bf16 v[240:243], v[52:55], a[36:39], v[240:243]
    v_mfma_f32_16x16x32_bf16 v[244:247], v[48:51], a[40:43], v[244:247]
    v_mfma_f32_16x16x32_bf16 v[244:247], v[52:55], a[44:47], v[244:247]
    v_mfma_f32_16x16x32_bf16 v[248:251], v[48:51], a[48:51], v[248:251]
    v_mfma_f32_16x16x32_bf16 v[248:251], v[52:55], a[52:55], v[248:251]
    buffer_load_dwordx4 v3, s[12:15], s60 offen offset:1024 nt lds
    v_mfma_f32_16x16x32_bf16 v[252:255], v[48:51], a[56:59], v[252:255]
    buffer_load_dword v107, v103, s[24:27], s77 offen
    v_mfma_f32_16x16x32_bf16 v[252:255], v[52:55], a[60:63], v[252:255]
    s_add_u32 s77, s77, 4608
    ds_read_b64_tr_b16 v[48:49], v16 offset:32768
    ds_read_b64_tr_b16 v[50:51], v16 offset:33792
    s_waitcnt lgkmcnt(2)
    v_mfma_f32_16x16x32_bf16 a[128:131], a[0:3], v[56:59], a[128:131]
    ds_read_b64_tr_b16 v[52:53], v16 offset:40960
    ds_read_b64_tr_b16 v[54:55], v16 offset:41984
    v_mfma_f32_16x16x32_bf16 a[128:131], a[4:7], v[60:63], a[128:131]
    v_add_u32 v16, 0x10000, v16
    v_mfma_f32_16x16x32_bf16 a[132:135], a[8:11], v[56:59], a[132:135]
    ds_read_b128 a[96:99], v22 offset:49152
    v_mfma_f32_16x16x32_bf16 a[132:135], a[12:15], v[60:63], a[132:135]
    v_mfma_f32_16x16x32_bf16 a[136:139], a[16:19], v[56:59], a[136:139]
    v_mfma_f32_16x16x32_bf16 a[136:139], a[20:23], v[60:63], a[136:139]
    buffer_load_dwordx4 v4, s[12:15], s60 offen offset:2048 nt lds
    v_mfma_f32_16x16x32_bf16 a[140:143], a[24:27], v[56:59], a[140:143]
    v_mfma_f32_16x16x32_bf16 a[140:143], a[28:31], v[60:63], a[140:143]
    ds_read_b128 a[100:103], v23 offset:49152
    v_mfma_f32_16x16x32_bf16 a[144:147], a[32:35], v[56:59], a[144:147]
    v_mfma_f32_16x16x32_bf16 a[144:147], a[36:39], v[60:63], a[144:147]
    v_mfma_f32_16x16x32_bf16 a[148:151], a[40:43], v[56:59], a[148:151]
    v_mfma_f32_16x16x32_bf16 a[148:151], a[44:47], v[60:63], a[148:151]
    v_mfma_f32_16x16x32_bf16 a[152:155], a[48:51], v[56:59], a[152:155]
    buffer_load_dwordx4 v5, s[12:15], s60 offen offset:3072 nt lds
    v_mfma_f32_16x16x32_bf16 a[152:155], a[52:55], v[60:63], a[152:155]
    ds_read_b128 a[104:107], v22 offset:51200
    v_mfma_f32_16x16x32_bf16 a[156:159], a[56:59], v[56:59], a[156:159]
    ds_read_b64_tr_b16 v[56:57], v17 offset:32768
    ds_read_b64_tr_b16 v[58:59], v17 offset:33792
    v_mfma_f32_16x16x32_bf16 a[156:159], a[60:63], v[60:63], a[156:159]
    ds_read_b64_tr_b16 v[60:61], v17 offset:40960
    ds_read_b64_tr_b16 v[62:63], v17 offset:41984
    v_mfma_f32_16x16x32_bf16 a[160:163], a[0:3], v[40:43], a[160:163]
    v_add_u32 v17, 0x10000, v17
    v_mfma_f32_16x16x32_bf16 a[160:163], a[4:7], v[44:47], a[160:163]
    v_mfma_f32_16x16x32_bf16 a[164:167], a[8:11], v[40:43], a[164:167]
    ds_read_b128 a[108:111], v23 offset:51200
    v_mfma_f32_16x16x32_bf16 a[164:167], a[12:15], v[44:47], a[164:167]
    s_add_u32 m0, s69, 147456
    v_mfma_f32_16x16x32_bf16 a[168:171], a[16:19], v[40:43], a[168:171]
    buffer_load_dwordx4 v6, s[8:11], s61 offen lds
    v_mfma_f32_16x16x32_bf16 a[168:171], a[20:23], v[44:47], a[168:171]
    v_mfma_f32_16x16x32_bf16 a[172:175], a[24:27], v[40:43], a[172:175]
    v_mfma_f32_16x16x32_bf16 a[172:175], a[28:31], v[44:47], a[172:175]
    v_mfma_f32_16x16x32_bf16 a[176:179], a[32:35], v[40:43], a[176:179]
    ds_read_b128 a[112:115], v22 offset:53248
    v_mfma_f32_16x16x32_bf16 a[176:179], a[36:39], v[44:47], a[176:179]
    v_mfma_f32_16x16x32_bf16 a[180:183], a[40:43], v[40:43], a[180:183]
    v_mfma_f32_16x16x32_bf16 a[180:183], a[44:47], v[44:47], a[180:183]
    buffer_load_dwordx4 v7, s[8:11], s61 offen offset:1024 lds
    v_mfma_f32_16x16x32_bf16 a[184:187], a[48:51], v[40:43], a[184:187]
    v_mfma_f32_16x16x32_bf16 a[184:187], a[52:55], v[44:47], a[184:187]
    ds_read_b128 a[116:119], v23 offset:53248
    v_mfma_f32_16x16x32_bf16 a[188:191], a[56:59], v[40:43], a[188:191]
    v_mfma_f32_16x16x32_bf16 a[188:191], a[60:63], v[44:47], a[188:191]
    s_waitcnt lgkmcnt(1)
    v_mfma_f32_16x16x32_bf16 a[192:195], a[0:3], v[48:51], a[192:195]
    v_mfma_f32_16x16x32_bf16 a[192:195], a[4:7], v[52:55], a[192:195]
    v_mfma_f32_16x16x32_bf16 a[196:199], a[8:11], v[48:51], a[196:199]
    v_mfma_f32_16x16x32_bf16 a[196:199], a[12:15], v[52:55], a[196:199]
    buffer_load_dwordx4 v8, s[8:11], s61 offen offset:2048 lds
    v_mfma_f32_16x16x32_bf16 a[200:203], a[16:19], v[48:51], a[200:203]
    ds_read_b128 a[120:123], v22 offset:55296
    v_mfma_f32_16x16x32_bf16 a[200:203], a[20:23], v[52:55], a[200:203]
    v_mfma_f32_16x16x32_bf16 a[204:207], a[24:27], v[48:51], a[204:207]
    v_mfma_f32_16x16x32_bf16 a[204:207], a[28:31], v[52:55], a[204:207]
    v_mfma_f32_16x16x32_bf16 a[208:211], a[32:35], v[48:51], a[208:211]
    ds_read_b128 a[124:127], v23 offset:55296
    v_mfma_f32_16x16x32_bf16 a[208:211], a[36:39], v[52:55], a[208:211]
    v_mfma_f32_16x16x32_bf16 a[212:215], a[40:43], v[48:51], a[212:215]
    buffer_load_dwordx4 v9, s[8:11], s61 offen offset:3072 lds
    v_mfma_f32_16x16x32_bf16 a[212:215], a[44:47], v[52:55], a[212:215]
    v_mfma_f32_16x16x32_bf16 a[216:219], a[48:51], v[48:51], a[216:219]
    v_mfma_f32_16x16x32_bf16 a[216:219], a[52:55], v[52:55], a[216:219]
    v_mfma_f32_16x16x32_bf16 a[220:223], a[56:59], v[48:51], a[220:223]
    v_mfma_f32_16x16x32_bf16 a[220:223], a[60:63], v[52:55], a[220:223]
    v_mfma_f32_16x16x32_bf16 a[224:227], a[0:3], v[56:59], a[224:227]
    v_mfma_f32_16x16x32_bf16 a[224:227], a[4:7], v[60:63], a[224:227]
    s_xor_b32 s61, s61, 384
    v_mfma_f32_16x16x32_bf16 a[228:231], a[8:11], v[56:59], a[228:231]
    v_mfma_f32_16x16x32_bf16 a[228:231], a[12:15], v[60:63], a[228:231]
    v_mfma_f32_16x16x32_bf16 a[232:235], a[16:19], v[56:59], a[232:235]
    v_mfma_f32_16x16x32_bf16 a[232:235], a[20:23], v[60:63], a[232:235]
    s_waitcnt vmcnt(9) lgkmcnt(0)
    s_barrier
    ds_read_b64_tr_b16 v[40:41], v14 offset:0
    v_mfma_f32_16x16x32_bf16 a[236:239], a[24:27], v[56:59], a[236:239]
    s_add_u32 m0, s69, 0
    ds_read_b64_tr_b16 v[42:43], v14 offset:1024
    ds_read_b64_tr_b16 v[44:45], v14 offset:8192
    v_mfma_f32_16x16x32_bf16 a[236:239], a[28:31], v[60:63], a[236:239]
    buffer_load_dwordx4 v2, s[16:19], s60 offen nt lds
    v_mfma_f32_16x16x32_bf16 a[240:243], a[32:35], v[56:59], a[240:243]
    ds_read_b64_tr_b16 v[46:47], v14 offset:9216
    v_cndmask_b32_e64 v83, v83, 0, s[92:93]
    v_mfma_f32_16x16x32_bf16 a[240:243], a[36:39], v[60:63], a[240:243]
    v_cndmask_b32_e64 v81, v81, 0, vcc
    v_cndmask_b32 v82, v82, v92, s[92:93]
    v_mfma_f32_16x16x32_bf16 a[244:247], a[40:43], v[56:59], a[244:247]
    s_mov_b32 vcc_lo, 0x10101010
    s_mov_b32 vcc_hi, 0x10101010
    v_cndmask_b32_e64 v83, v83, 0, vcc
    v_mfma_f32_16x16x32_bf16 a[244:247], a[44:47], v[60:63], a[244:247]
    v_xor_b32 v92, s98, v95
    ds_read_b64_tr_b16 v[48:49], v15 offset:0
    v_mfma_f32_16x16x32_bf16 a[248:251], a[48:51], v[56:59], a[248:251]
    buffer_store_dwordx4 v[80:83], v92, s[28:31], s72 offen sc1
    v_mfma_f32_16x16x32_bf16 a[248:251], a[52:55], v[60:63], a[248:251]
    s_mul_i32 s72, s2, 3
    buffer_load_dwordx4 v3, s[16:19], s60 offen offset:1024 nt lds
    v_mfma_f32_16x16x32_bf16 a[252:255], a[56:59], v[56:59], a[252:255]
    s_add_u32 s72, s72, 1
    ds_read_b64_tr_b16 v[50:51], v15 offset:1024
    ds_read_b64_tr_b16 v[52:53], v15 offset:8192
    v_mfma_f32_16x16x32_bf16 a[252:255], a[60:63], v[60:63], a[252:255]
    s_bfe_u32 s98, s72, 0x10001
    ds_read_b64_tr_b16 v[54:55], v15 offset:9216
    v_cndmask_b32_e64 v87, v87, 0, s[92:93]
    s_waitcnt lgkmcnt(4)
    v_mfma_f32_16x16x32_bf16 v[128:131], v[40:43], a[64:67], v[128:131]
    s_bfe_u32 s99, s72, 0x10003
    v_cndmask_b32 v86, v86, v93, s[92:93]
    v_cndmask_b32_e64 v91, v91, 0, s[92:93]
    v_mfma_f32_16x16x32_bf16 v[128:131], v[44:47], a[68:71], v[128:131]
    s_lshl1_add_u32 s98, s99, s98
    v_add_u32 v22, 0x10000, v22
    v_cndmask_b32 v90, v90, v94, s[92:93]
    v_mfma_f32_16x16x32_bf16 v[132:135], v[40:43], a[72:75], v[132:135]
    s_lshl_b32 s98, s98, 5
    ds_read_b128 a[0:3], v22 offset:16384
    v_xor_b32 v93, s98, v95
    v_mfma_f32_16x16x32_bf16 v[132:135], v[44:47], a[76:79], v[132:135]
    s_mov_b32 vcc_lo, 0x84848484
    s_mov_b32 vcc_hi, 0x84848484
    v_cndmask_b32_e64 v85, v85, 0, vcc
    v_mfma_f32_16x16x32_bf16 v[136:139], v[40:43], a[80:83], v[136:139]
    s_mov_b32 vcc_lo, 0x10101010
    s_mov_b32 vcc_hi, 0x10101010
    v_cndmask_b32_e64 v87, v87, 0, vcc
    v_mfma_f32_16x16x32_bf16 v[136:139], v[44:47], a[84:87], v[136:139]
    s_lshl_b32 s72, s72, 7
    buffer_load_dwordx4 v4, s[16:19], s60 offen offset:2048 nt lds
    v_mfma_f32_16x16x32_bf16 v[140:143], v[40:43], a[88:91], v[140:143]
    v_add_u32 v23, 0x10000, v23
    ds_read_b64_tr_b16 v[56:57], v16 offset:0
    v_mfma_f32_16x16x32_bf16 v[140:143], v[44:47], a[92:95], v[140:143]
    ds_read_b128 a[4:7], v23 offset:16384
    ds_read_b64_tr_b16 v[58:59], v16 offset:1024
    v_mfma_f32_16x16x32_bf16 v[144:147], v[40:43], a[96:99], v[144:147]
    s_cmp_lt_u32 s2, 192
    s_cselect_b32 s72, s72, 1073741824
    ds_read_b64_tr_b16 v[60:61], v16 offset:8192
    v_mfma_f32_16x16x32_bf16 v[144:147], v[44:47], a[100:103], v[144:147]
    buffer_store_dwordx4 v[84:87], v93, s[28:31], s72 offen sc1
    v_mfma_f32_16x16x32_bf16 v[148:151], v[40:43], a[104:107], v[148:151]
    s_mul_i32 s72, s2, 3
    ds_read_b64_tr_b16 v[62:63], v16 offset:9216
    v_mfma_f32_16x16x32_bf16 v[148:151], v[44:47], a[108:111], v[148:151]
    s_add_u32 s72, s72, 2
    v_mfma_f32_16x16x32_bf16 v[152:155], v[40:43], a[112:115], v[152:155]
    s_bfe_u32 s98, s72, 0x10001
    buffer_load_dwordx4 v5, s[16:19], s60 offen offset:3072 nt lds
    v_mfma_f32_16x16x32_bf16 v[152:155], v[44:47], a[116:119], v[152:155]
    s_bfe_u32 s99, s72, 0x10003
    ds_read_b128 a[8:11], v22 offset:18432
    v_mfma_f32_16x16x32_bf16 v[156:159], v[40:43], a[120:123], v[156:159]
    s_mov_b32 vcc_lo, 0x84848484
    s_mov_b32 vcc_hi, 0x84848484
    v_cndmask_b32_e64 v89, v89, 0, vcc
    v_mfma_f32_16x16x32_bf16 v[156:159], v[44:47], a[124:127], v[156:159]
    s_lshl1_add_u32 s98, s99, s98
    ds_read_b64_tr_b16 v[40:41], v17 offset:0
    ds_read_b64_tr_b16 v[42:43], v17 offset:1024
    s_waitcnt lgkmcnt(3)
    v_mfma_f32_16x16x32_bf16 v[160:163], v[48:51], a[64:67], v[160:163]
    s_mov_b32 vcc_lo, 0x10101010
    s_mov_b32 vcc_hi, 0x10101010
    v_cndmask_b32_e64 v91, v91, 0, vcc
    v_mfma_f32_16x16x32_bf16 v[160:163], v[52:55], a[68:71], v[160:163]
    s_lshl_b32 s98, s98, 5
    v_xor_b32 v94, s98, v95
    ds_read_b64_tr_b16 v[44:45], v17 offset:8192
    v_mfma_f32_16x16x32_bf16 v[164:167], v[48:51], a[72:75], v[164:167]
    s_lshl_b32 s72, s72, 7
    ds_read_b128 a[12:15], v23 offset:18432
    ds_read_b64_tr_b16 v[46:47], v17 offset:9216
    v_mfma_f32_16x16x32_bf16 v[164:167], v[52:55], a[76:79], v[164:167]
    s_add_u32 m0, s69, 16384
    v_mfma_f32_16x16x32_bf16 v[168:171], v[48:51], a[80:83], v[168:171]
    s_xor_b32 s60, s60, 524288
    buffer_load_dwordx4 v6, s[8:11], s62 offen lds
    v_mfma_f32_16x16x32_bf16 v[168:171], v[52:55], a[84:87], v[168:171]
    s_cmp_lt_u32 s2, 192
    s_cselect_b32 s72, s72, 1073741824
    v_mfma_f32_16x16x32_bf16 v[172:175], v[48:51], a[88:91], v[172:175]
    s_lshl2_add_u32 s99, s100, s4
    buffer_store_dwordx4 v[88:91], v94, s[28:31], s72 offen sc1
    v_mfma_f32_16x16x32_bf16 v[172:175], v[52:55], a[92:95], v[172:175]
    s_add_u32 s28, s28, s7
    s_addc_u32 s29, s29, 0
    v_mfma_f32_16x16x32_bf16 v[176:179], v[48:51], a[96:99], v[176:179]
    s_mov_b32 s30, 73728
    buffer_load_dword v108, v103, s[24:27], s77 offen
    v_mfma_f32_16x16x32_bf16 v[176:179], v[52:55], a[100:103], v[176:179]
    s_add_u32 s77, s77, 4608
    ds_read_b128 a[16:19], v22 offset:20480
    v_mfma_f32_16x16x32_bf16 v[180:183], v[48:51], a[104:107], v[180:183]
    s_lshl_b32 s99, s99, 7
    v_mfma_f32_16x16x32_bf16 v[180:183], v[52:55], a[108:111], v[180:183]
    v_mfma_f32_16x16x32_bf16 v[184:187], v[48:51], a[112:115], v[184:187]
    buffer_load_dwordx4 v7, s[8:11], s62 offen offset:1024 lds
    v_mfma_f32_16x16x32_bf16 v[184:187], v[52:55], a[116:119], v[184:187]
    ds_read_b128 a[20:23], v23 offset:20480
    v_mfma_f32_16x16x32_bf16 v[188:191], v[48:51], a[120:123], v[188:191]
    ds_read_b64_tr_b16 v[48:49], v14 offset:32768
    ds_read_b64_tr_b16 v[50:51], v14 offset:33792
    v_mfma_f32_16x16x32_bf16 v[188:191], v[52:55], a[124:127], v[188:191]
    ds_read_b64_tr_b16 v[52:53], v14 offset:40960
    ds_read_b64_tr_b16 v[54:55], v14 offset:41984
    v_mfma_f32_16x16x32_bf16 v[192:195], v[56:59], a[64:67], v[192:195]
    v_add_u32 v14, 0x10000, v14
    v_mfma_f32_16x16x32_bf16 v[192:195], v[60:63], a[68:71], v[192:195]
    v_mfma_f32_16x16x32_bf16 v[196:199], v[56:59], a[72:75], v[196:199]
    v_mfma_f32_16x16x32_bf16 v[196:199], v[60:63], a[76:79], v[196:199]
    buffer_load_dwordx4 v8, s[8:11], s62 offen offset:2048 lds
    v_mfma_f32_16x16x32_bf16 v[200:203], v[56:59], a[80:83], v[200:203]
    ds_read_b128 a[24:27], v22 offset:22528
    v_mfma_f32_16x16x32_bf16 v[200:203], v[60:63], a[84:87], v[200:203]
    v_mfma_f32_16x16x32_bf16 v[204:207], v[56:59], a[88:91], v[204:207]
    v_mfma_f32_16x16x32_bf16 v[204:207], v[60:63], a[92:95], v[204:207]
    v_mfma_f32_16x16x32_bf16 v[208:211], v[56:59], a[96:99], v[208:211]
    ds_read_b128 a[28:31], v23 offset:22528
    v_mfma_f32_16x16x32_bf16 v[208:211], v[60:63], a[100:103], v[208:211]
    v_mfma_f32_16x16x32_bf16 v[212:215], v[56:59], a[104:107], v[212:215]
    buffer_load_dwordx4 v9, s[8:11], s62 offen offset:3072 lds
    v_mfma_f32_16x16x32_bf16 v[212:215], v[60:63], a[108:111], v[212:215]
    v_mfma_f32_16x16x32_bf16 v[216:219], v[56:59], a[112:115], v[216:219]
    v_mfma_f32_16x16x32_bf16 v[216:219], v[60:63], a[116:119], v[216:219]
    v_mfma_f32_16x16x32_bf16 v[220:223], v[56:59], a[120:123], v[220:223]
    s_waitcnt lgkmcnt(0)
    ds_read_b64_tr_b16 v[56:57], v15 offset:32768
    ds_read_b64_tr_b16 v[58:59], v15 offset:33792
    v_mfma_f32_16x16x32_bf16 v[220:223], v[60:63], a[124:127], v[220:223]
    ds_read_b64_tr_b16 v[60:61], v15 offset:40960
    ds_read_b64_tr_b16 v[62:63], v15 offset:41984
    v_mfma_f32_16x16x32_bf16 v[224:227], v[40:43], a[64:67], v[224:227]
    v_add_u32 v15, 0x10000, v15
    v_mfma_f32_16x16x32_bf16 v[224:227], v[44:47], a[68:71], v[224:227]
    s_xor_b32 s62, s62, 384
    v_mfma_f32_16x16x32_bf16 v[228:231], v[40:43], a[72:75], v[228:231]
    v_mfma_f32_16x16x32_bf16 v[228:231], v[44:47], a[76:79], v[228:231]
    v_mfma_f32_16x16x32_bf16 v[232:235], v[40:43], a[80:83], v[232:235]
    v_mfma_f32_16x16x32_bf16 v[232:235], v[44:47], a[84:87], v[232:235]
    s_add_u32 m0, s69, 32768
    v_mfma_f32_16x16x32_bf16 v[236:239], v[40:43], a[88:91], v[236:239]
    buffer_load_dwordx4 v2, s[12:15], s60 offen nt lds
    v_mfma_f32_16x16x32_bf16 v[236:239], v[44:47], a[92:95], v[236:239]
    v_mfma_f32_16x16x32_bf16 v[240:243], v[40:43], a[96:99], v[240:243]
    v_mfma_f32_16x16x32_bf16 v[240:243], v[44:47], a[100:103], v[240:243]
    v_mfma_f32_16x16x32_bf16 v[244:247], v[40:43], a[104:107], v[244:247]
    v_mfma_f32_16x16x32_bf16 v[244:247], v[44:47], a[108:111], v[244:247]
    v_mfma_f32_16x16x32_bf16 v[248:251], v[40:43], a[112:115], v[248:251]
    v_mfma_f32_16x16x32_bf16 v[248:251], v[44:47], a[116:119], v[248:251]
    buffer_load_dwordx4 v3, s[12:15], s60 offen offset:1024 nt lds
    v_mfma_f32_16x16x32_bf16 v[252:255], v[40:43], a[120:123], v[252:255]
    ds_read_b64_tr_b16 v[40:41], v16 offset:32768
    ds_read_b64_tr_b16 v[42:43], v16 offset:33792
    v_mfma_f32_16x16x32_bf16 v[252:255], v[44:47], a[124:127], v[252:255]
    ds_read_b64_tr_b16 v[44:45], v16 offset:40960
    ds_read_b64_tr_b16 v[46:47], v16 offset:41984
    v_mfma_f32_16x16x32_bf16 a[128:131], a[64:67], v[48:51], a[128:131]
    v_add_u32 v16, 0x10000, v16
    v_mfma_f32_16x16x32_bf16 a[128:131], a[68:71], v[52:55], a[128:131]
    v_mfma_f32_16x16x32_bf16 a[132:135], a[72:75], v[48:51], a[132:135]
    ds_read_b128 a[32:35], v22 offset:49152
    v_mfma_f32_16x16x32_bf16 a[132:135], a[76:79], v[52:55], a[132:135]
    v_mfma_f32_16x16x32_bf16 a[136:139], a[80:83], v[48:51], a[136:139]
    v_mfma_f32_16x16x32_bf16 a[136:139], a[84:87], v[52:55], a[136:139]
    buffer_load_dwordx4 v4, s[12:15], s60 offen offset:2048 nt lds
    v_mfma_f32_16x16x32_bf16 a[140:143], a[88:91], v[48:51], a[140:143]
    v_mfma_f32_16x16x32_bf16 a[140:143], a[92:95], v[52:55], a[140:143]
    ds_read_b128 a[36:39], v23 offset:49152
    v_mfma_f32_16x16x32_bf16 a[144:147], a[96:99], v[48:51], a[144:147]
    v_mfma_f32_16x16x32_bf16 a[144:147], a[100:103], v[52:55], a[144:147]
    v_mfma_f32_16x16x32_bf16 a[148:151], a[104:107], v[48:51], a[148:151]
    v_mfma_f32_16x16x32_bf16 a[148:151], a[108:111], v[52:55], a[148:151]
    v_mfma_f32_16x16x32_bf16 a[152:155], a[112:115], v[48:51], a[152:155]
    buffer_load_dwordx4 v5, s[12:15], s60 offen offset:3072 nt lds
    v_mfma_f32_16x16x32_bf16 a[152:155], a[116:119], v[52:55], a[152:155]
    ds_read_b128 a[40:43], v22 offset:51200
    v_mfma_f32_16x16x32_bf16 a[156:159], a[120:123], v[48:51], a[156:159]
    ds_read_b64_tr_b16 v[48:49], v17 offset:32768
    ds_read_b64_tr_b16 v[50:51], v17 offset:33792
    v_mfma_f32_16x16x32_bf16 a[156:159], a[124:127], v[52:55], a[156:159]
    s_waitcnt lgkmcnt(3)
    ds_read_b64_tr_b16 v[52:53], v17 offset:40960
    ds_read_b64_tr_b16 v[54:55], v17 offset:41984
    v_mfma_f32_16x16x32_bf16 a[160:163], a[64:67], v[56:59], a[160:163]
    v_add_u32 v17, 0x10000, v17
    v_mfma_f32_16x16x32_bf16 a[160:163], a[68:71], v[60:63], a[160:163]
    v_mfma_f32_16x16x32_bf16 a[164:167], a[72:75], v[56:59], a[164:167]
    ds_read_b128 a[44:47], v23 offset:51200
    v_mfma_f32_16x16x32_bf16 a[164:167], a[76:79], v[60:63], a[164:167]
    s_add_u32 m0, s69, 49152
    v_mfma_f32_16x16x32_bf16 a[168:171], a[80:83], v[56:59], a[168:171]
    buffer_load_dwordx4 v6, s[8:11], s61 offen lds
    v_mfma_f32_16x16x32_bf16 a[168:171], a[84:87], v[60:63], a[168:171]
    v_mfma_f32_16x16x32_bf16 a[172:175], a[88:91], v[56:59], a[172:175]
    v_mfma_f32_16x16x32_bf16 a[172:175], a[92:95], v[60:63], a[172:175]
    v_mfma_f32_16x16x32_bf16 a[176:179], a[96:99], v[56:59], a[176:179]
    ds_read_b128 a[48:51], v22 offset:53248
    v_mfma_f32_16x16x32_bf16 a[176:179], a[100:103], v[60:63], a[176:179]
    v_mfma_f32_16x16x32_bf16 a[180:183], a[104:107], v[56:59], a[180:183]
    v_mfma_f32_16x16x32_bf16 a[180:183], a[108:111], v[60:63], a[180:183]
    buffer_load_dwordx4 v7, s[8:11], s61 offen offset:1024 lds
    v_mfma_f32_16x16x32_bf16 a[184:187], a[112:115], v[56:59], a[184:187]
    v_mfma_f32_16x16x32_bf16 a[184:187], a[116:119], v[60:63], a[184:187]
    ds_read_b128 a[52:55], v23 offset:53248
    v_mfma_f32_16x16x32_bf16 a[188:191], a[120:123], v[56:59], a[188:191]
    v_mfma_f32_16x16x32_bf16 a[188:191], a[124:127], v[60:63], a[188:191]
    v_mfma_f32_16x16x32_bf16 a[192:195], a[64:67], v[40:43], a[192:195]
    v_mfma_f32_16x16x32_bf16 a[192:195], a[68:71], v[44:47], a[192:195]
    v_mfma_f32_16x16x32_bf16 a[196:199], a[72:75], v[40:43], a[196:199]
    v_mfma_f32_16x16x32_bf16 a[196:199], a[76:79], v[44:47], a[196:199]
    buffer_load_dwordx4 v8, s[8:11], s61 offen offset:2048 lds
    v_mfma_f32_16x16x32_bf16 a[200:203], a[80:83], v[40:43], a[200:203]
    ds_read_b128 a[56:59], v22 offset:55296
    v_mfma_f32_16x16x32_bf16 a[200:203], a[84:87], v[44:47], a[200:203]
    v_mfma_f32_16x16x32_bf16 a[204:207], a[88:91], v[40:43], a[204:207]
    v_mfma_f32_16x16x32_bf16 a[204:207], a[92:95], v[44:47], a[204:207]
    v_mfma_f32_16x16x32_bf16 a[208:211], a[96:99], v[40:43], a[208:211]
    ds_read_b128 a[60:63], v23 offset:55296
    v_mfma_f32_16x16x32_bf16 a[208:211], a[100:103], v[44:47], a[208:211]
    v_mfma_f32_16x16x32_bf16 a[212:215], a[104:107], v[40:43], a[212:215]
    buffer_load_dwordx4 v9, s[8:11], s61 offen offset:3072 lds
    v_mfma_f32_16x16x32_bf16 a[212:215], a[108:111], v[44:47], a[212:215]
    v_mfma_f32_16x16x32_bf16 a[216:219], a[112:115], v[40:43], a[216:219]
    v_mfma_f32_16x16x32_bf16 a[216:219], a[116:119], v[44:47], a[216:219]
    v_mfma_f32_16x16x32_bf16 a[220:223], a[120:123], v[40:43], a[220:223]
    v_mfma_f32_16x16x32_bf16 a[220:223], a[124:127], v[44:47], a[220:223]
    s_waitcnt lgkmcnt(0)
    v_mfma_f32_16x16x32_bf16 a[224:227], a[64:67], v[48:51], a[224:227]
    v_mfma_f32_16x16x32_bf16 a[224:227], a[68:71], v[52:55], a[224:227]
    s_xor_b32 s61, s61, 128
    v_mfma_f32_16x16x32_bf16 a[228:231], a[72:75], v[48:51], a[228:231]
    buffer_load_dword v109, v103, s[24:27], s77 offen
    v_mfma_f32_16x16x32_bf16 a[228:231], a[76:79], v[52:55], a[228:231]
    v_mfma_f32_16x16x32_bf16 a[232:235], a[80:83], v[48:51], a[232:235]
    v_mfma_f32_16x16x32_bf16 a[232:235], a[84:87], v[52:55], a[232:235]
    s_waitcnt vmcnt(9) lgkmcnt(0)
    s_barrier
    ds_read_b64_tr_b16 v[56:57], v14 offset:0
    v_mfma_f32_16x16x32_bf16 a[236:239], a[88:91], v[48:51], a[236:239]
    s_add_u32 m0, s69, 65536
    ds_read_b64_tr_b16 v[58:59], v14 offset:1024
    ds_read_b64_tr_b16 v[60:61], v14 offset:8192
    v_mfma_f32_16x16x32_bf16 a[236:239], a[92:95], v[52:55], a[236:239]
    buffer_load_dwordx4 v2, s[16:19], s60 offen nt lds
    v_mfma_f32_16x16x32_bf16 a[240:243], a[96:99], v[48:51], a[240:243]
    ds_read_b64_tr_b16 v[62:63], v14 offset:9216
    ds_read_b64_tr_b16 v[40:41], v15 offset:0
    v_mfma_f32_16x16x32_bf16 a[240:243], a[100:103], v[52:55], a[240:243]
    buffer_atomic_add v31, v30, s[44:47], s95 offen sc1
    v_mfma_f32_16x16x32_bf16 a[244:247], a[104:107], v[48:51], a[244:247]
    s_mov_b32 s95, 32768
    ds_read_b64_tr_b16 v[42:43], v15 offset:1024
    ds_read_b64_tr_b16 v[44:45], v15 offset:8192
    v_mfma_f32_16x16x32_bf16 a[244:247], a[108:111], v[52:55], a[244:247]
    ds_read_b64_tr_b16 v[46:47], v15 offset:9216
    v_add_u32 v14, 0xfffe0000, v14
    v_mfma_f32_16x16x32_bf16 a[248:251], a[112:115], v[48:51], a[248:251]
    v_add_u32 v15, 0xfffe0000, v15
    v_mfma_f32_16x16x32_bf16 a[248:251], a[116:119], v[52:55], a[248:251]
    buffer_load_dwordx4 v3, s[16:19], s60 offen offset:1024 nt lds
    v_mfma_f32_16x16x32_bf16 a[252:255], a[120:123], v[48:51], a[252:255]
    ds_read_b64_tr_b16 v[48:49], v16 offset:0
    ds_read_b64_tr_b16 v[50:51], v16 offset:1024
    v_mfma_f32_16x16x32_bf16 a[252:255], a[124:127], v[52:55], a[252:255]
    s_waitcnt lgkmcnt(3)
    ds_read_b64_tr_b16 v[52:53], v16 offset:8192
    ds_read_b64_tr_b16 v[54:55], v16 offset:9216
    v_mfma_f32_16x16x32_bf16 v[128:131], v[56:59], a[0:3], v[128:131]
    v_add_u32 v16, 0xfffe0000, v16
    v_mfma_f32_16x16x32_bf16 v[128:131], v[60:63], a[4:7], v[128:131]
    v_add_u32 v22, 0x10000, v22
    v_mfma_f32_16x16x32_bf16 v[132:135], v[56:59], a[8:11], v[132:135]
    ds_read_b128 a[64:67], v22 offset:16384
    v_mfma_f32_16x16x32_bf16 v[132:135], v[60:63], a[12:15], v[132:135]
    v_mfma_f32_16x16x32_bf16 v[136:139], v[56:59], a[16:19], v[136:139]
    v_mfma_f32_16x16x32_bf16 v[136:139], v[60:63], a[20:23], v[136:139]
    buffer_load_dwordx4 v4, s[16:19], s60 offen offset:2048 nt lds
    v_mfma_f32_16x16x32_bf16 v[140:143], v[56:59], a[24:27], v[140:143]
    v_add_u32 v23, 0x10000, v23
    v_mfma_f32_16x16x32_bf16 v[140:143], v[60:63], a[28:31], v[140:143]
    ds_read_b128 a[68:71], v23 offset:16384
    v_mfma_f32_16x16x32_bf16 v[144:147], v[56:59], a[32:35], v[144:147]
    v_mfma_f32_16x16x32_bf16 v[144:147], v[60:63], a[36:39], v[144:147]
    v_mfma_f32_16x16x32_bf16 v[148:151], v[56:59], a[40:43], v[148:151]
    v_mfma_f32_16x16x32_bf16 v[148:151], v[60:63], a[44:47], v[148:151]
    v_mfma_f32_16x16x32_bf16 v[152:155], v[56:59], a[48:51], v[152:155]
    buffer_load_dwordx4 v5, s[16:19], s60 offen offset:3072 nt lds
    v_mfma_f32_16x16x32_bf16 v[152:155], v[60:63], a[52:55], v[152:155]
    ds_read_b128 a[72:75], v22 offset:18432
    v_mfma_f32_16x16x32_bf16 v[156:159], v[56:59], a[56:59], v[156:159]
    ds_read_b64_tr_b16 v[56:57], v17 offset:0
    ds_read_b64_tr_b16 v[58:59], v17 offset:1024
    v_mfma_f32_16x16x32_bf16 v[156:159], v[60:63], a[60:63], v[156:159]
    ds_read_b64_tr_b16 v[60:61], v17 offset:8192
    ds_read_b64_tr_b16 v[62:63], v17 offset:9216
    v_mfma_f32_16x16x32_bf16 v[160:163], v[40:43], a[0:3], v[160:163]
    s_waitcnt lgkmcnt(5)
    v_add_u32 v17, 0xfffe0000, v17
    v_mfma_f32_16x16x32_bf16 v[160:163], v[44:47], a[4:7], v[160:163]
    v_mfma_f32_16x16x32_bf16 v[164:167], v[40:43], a[8:11], v[164:167]
    ds_read_b128 a[76:79], v23 offset:18432
    v_mfma_f32_16x16x32_bf16 v[164:167], v[44:47], a[12:15], v[164:167]
    s_add_u32 m0, s69, 81920
    v_mfma_f32_16x16x32_bf16 v[168:171], v[40:43], a[16:19], v[168:171]
    s_xor_b32 s60, s60, 1572864
    buffer_load_dwordx4 v6, s[8:11], s62 offen lds
    v_mfma_f32_16x16x32_bf16 v[168:171], v[44:47], a[20:23], v[168:171]
    v_mfma_f32_16x16x32_bf16 v[172:175], v[40:43], a[24:27], v[172:175]
    v_mfma_f32_16x16x32_bf16 v[172:175], v[44:47], a[28:31], v[172:175]
    v_mfma_f32_16x16x32_bf16 v[176:179], v[40:43], a[32:35], v[176:179]
    ds_read_b128 a[80:83], v22 offset:20480
    v_mfma_f32_16x16x32_bf16 v[176:179], v[44:47], a[36:39], v[176:179]
    v_mfma_f32_16x16x32_bf16 v[180:183], v[40:43], a[40:43], v[180:183]
    v_mfma_f32_16x16x32_bf16 v[180:183], v[44:47], a[44:47], v[180:183]
    buffer_load_dwordx4 v7, s[8:11], s62 offen offset:1024 lds
    v_mfma_f32_16x16x32_bf16 v[184:187], v[40:43], a[48:51], v[184:187]
    v_mfma_f32_16x16x32_bf16 v[184:187], v[44:47], a[52:55], v[184:187]
    ds_read_b128 a[84:87], v23 offset:20480
    v_mfma_f32_16x16x32_bf16 v[188:191], v[40:43], a[56:59], v[188:191]
    ds_read_b64_tr_b16 v[40:41], v14 offset:0
    ds_read_b64_tr_b16 v[42:43], v14 offset:1024
    v_mfma_f32_16x16x32_bf16 v[188:191], v[44:47], a[60:63], v[188:191]
    ds_read_b64_tr_b16 v[44:45], v14 offset:8192
    ds_read_b64_tr_b16 v[46:47], v14 offset:9216
    v_mfma_f32_16x16x32_bf16 v[192:195], v[48:51], a[0:3], v[192:195]
    v_mfma_f32_16x16x32_bf16 v[192:195], v[52:55], a[4:7], v[192:195]
    v_mfma_f32_16x16x32_bf16 v[196:199], v[48:51], a[8:11], v[196:199]
    v_mfma_f32_16x16x32_bf16 v[196:199], v[52:55], a[12:15], v[196:199]
    buffer_load_dwordx4 v8, s[8:11], s62 offen offset:2048 lds
    v_mfma_f32_16x16x32_bf16 v[200:203], v[48:51], a[16:19], v[200:203]
    ds_read_b128 a[88:91], v22 offset:22528
    v_mfma_f32_16x16x32_bf16 v[200:203], v[52:55], a[20:23], v[200:203]
    v_mfma_f32_16x16x32_bf16 v[204:207], v[48:51], a[24:27], v[204:207]
    v_mfma_f32_16x16x32_bf16 v[204:207], v[52:55], a[28:31], v[204:207]
    v_mfma_f32_16x16x32_bf16 v[208:211], v[48:51], a[32:35], v[208:211]
    ds_read_b128 a[92:95], v23 offset:22528
    v_mfma_f32_16x16x32_bf16 v[208:211], v[52:55], a[36:39], v[208:211]
    v_mfma_f32_16x16x32_bf16 v[212:215], v[48:51], a[40:43], v[212:215]
    buffer_load_dwordx4 v9, s[8:11], s62 offen offset:3072 lds
    v_mfma_f32_16x16x32_bf16 v[212:215], v[52:55], a[44:47], v[212:215]
    v_mfma_f32_16x16x32_bf16 v[216:219], v[48:51], a[48:51], v[216:219]
    v_mfma_f32_16x16x32_bf16 v[216:219], v[52:55], a[52:55], v[216:219]
    v_mfma_f32_16x16x32_bf16 v[220:223], v[48:51], a[56:59], v[220:223]
    s_waitcnt lgkmcnt(0)
    ds_read_b64_tr_b16 v[48:49], v15 offset:0
    ds_read_b64_tr_b16 v[50:51], v15 offset:1024
    v_mfma_f32_16x16x32_bf16 v[220:223], v[52:55], a[60:63], v[220:223]
    ds_read_b64_tr_b16 v[52:53], v15 offset:8192
    ds_read_b64_tr_b16 v[54:55], v15 offset:9216
    v_mfma_f32_16x16x32_bf16 v[224:227], v[56:59], a[0:3], v[224:227]
    v_mfma_f32_16x16x32_bf16 v[224:227], v[60:63], a[4:7], v[224:227]
    s_xor_b32 s62, s62, 128
    v_mfma_f32_16x16x32_bf16 v[228:231], v[56:59], a[8:11], v[228:231]
    v_mfma_f32_16x16x32_bf16 v[228:231], v[60:63], a[12:15], v[228:231]
    v_mfma_f32_16x16x32_bf16 v[232:235], v[56:59], a[16:19], v[232:235]
    v_mfma_f32_16x16x32_bf16 v[232:235], v[60:63], a[20:23], v[232:235]
    s_add_u32 m0, s69, 98304
    v_mfma_f32_16x16x32_bf16 v[236:239], v[56:59], a[24:27], v[236:239]
    buffer_load_dwordx4 v2, s[12:15], s60 offen nt lds
    v_mfma_f32_16x16x32_bf16 v[236:239], v[60:63], a[28:31], v[236:239]
    v_mfma_f32_16x16x32_bf16 v[240:243], v[56:59], a[32:35], v[240:243]
    v_mfma_f32_16x16x32_bf16 v[240:243], v[60:63], a[36:39], v[240:243]
    v_mfma_f32_16x16x32_bf16 v[244:247], v[56:59], a[40:43], v[244:247]
    v_mfma_f32_16x16x32_bf16 v[244:247], v[60:63], a[44:47], v[244:247]
    v_mfma_f32_16x16x32_bf16 v[248:251], v[56:59], a[48:51], v[248:251]
    v_mfma_f32_16x16x32_bf16 v[248:251], v[60:63], a[52:55], v[248:251]
    buffer_load_dwordx4 v3, s[12:15], s60 offen offset:1024 nt lds
    v_mfma_f32_16x16x32_bf16 v[252:255], v[56:59], a[56:59], v[252:255]
    ds_read_b64_tr_b16 v[56:57], v16 offset:0
    ds_read_b64_tr_b16 v[58:59], v16 offset:1024
    v_mfma_f32_16x16x32_bf16 v[252:255], v[60:63], a[60:63], v[252:255]
    ds_read_b64_tr_b16 v[60:61], v16 offset:8192
    ds_read_b64_tr_b16 v[62:63], v16 offset:9216
    v_mfma_f32_16x16x32_bf16 a[128:131], a[0:3], v[40:43], a[128:131]
    v_mfma_f32_16x16x32_bf16 a[128:131], a[4:7], v[44:47], a[128:131]
    v_add_u32 v22, 0xfffe0000, v22
    v_mfma_f32_16x16x32_bf16 a[132:135], a[8:11], v[40:43], a[132:135]
    ds_read_b128 a[96:99], v22 offset:16384
    v_mfma_f32_16x16x32_bf16 a[132:135], a[12:15], v[44:47], a[132:135]
    v_mfma_f32_16x16x32_bf16 a[136:139], a[16:19], v[40:43], a[136:139]
    v_mfma_f32_16x16x32_bf16 a[136:139], a[20:23], v[44:47], a[136:139]
    buffer_load_dwordx4 v4, s[12:15], s60 offen offset:2048 nt lds
    v_mfma_f32_16x16x32_bf16 a[140:143], a[24:27], v[40:43], a[140:143]
    v_add_u32 v23, 0xfffe0000, v23
    v_mfma_f32_16x16x32_bf16 a[140:143], a[28:31], v[44:47], a[140:143]
    ds_read_b128 a[100:103], v23 offset:16384
    v_mfma_f32_16x16x32_bf16 a[144:147], a[32:35], v[40:43], a[144:147]
    v_mfma_f32_16x16x32_bf16 a[144:147], a[36:39], v[44:47], a[144:147]
    v_mfma_f32_16x16x32_bf16 a[148:151], a[40:43], v[40:43], a[148:151]
    v_mfma_f32_16x16x32_bf16 a[148:151], a[44:47], v[44:47], a[148:151]
    v_mfma_f32_16x16x32_bf16 a[152:155], a[48:51], v[40:43], a[152:155]
    buffer_load_dwordx4 v5, s[12:15], s60 offen offset:3072 nt lds
    v_mfma_f32_16x16x32_bf16 a[152:155], a[52:55], v[44:47], a[152:155]
    ds_read_b128 a[104:107], v22 offset:18432
    v_mfma_f32_16x16x32_bf16 a[156:159], a[56:59], v[40:43], a[156:159]
    ds_read_b64_tr_b16 v[40:41], v17 offset:0
    ds_read_b64_tr_b16 v[42:43], v17 offset:1024
    v_mfma_f32_16x16x32_bf16 a[156:159], a[60:63], v[44:47], a[156:159]
    s_waitcnt lgkmcnt(3)
    ds_read_b64_tr_b16 v[44:45], v17 offset:8192
    ds_read_b64_tr_b16 v[46:47], v17 offset:9216
    v_mfma_f32_16x16x32_bf16 a[160:163], a[0:3], v[48:51], a[160:163]
    v_mfma_f32_16x16x32_bf16 a[160:163], a[4:7], v[52:55], a[160:163]
    v_mfma_f32_16x16x32_bf16 a[164:167], a[8:11], v[48:51], a[164:167]
    ds_read_b128 a[108:111], v23 offset:18432
    v_mfma_f32_16x16x32_bf16 a[164:167], a[12:15], v[52:55], a[164:167]
    s_add_u32 m0, s69, 114688
    v_mfma_f32_16x16x32_bf16 a[168:171], a[16:19], v[48:51], a[168:171]
    s_xor_b32 s60, s60, 524288
    buffer_load_dwordx4 v6, s[8:11], s61 offen lds
    v_mfma_f32_16x16x32_bf16 a[168:171], a[20:23], v[52:55], a[168:171]
    v_mfma_f32_16x16x32_bf16 a[172:175], a[24:27], v[48:51], a[172:175]
    v_mfma_f32_16x16x32_bf16 a[172:175], a[28:31], v[52:55], a[172:175]
    v_mfma_f32_16x16x32_bf16 a[176:179], a[32:35], v[48:51], a[176:179]
    ds_read_b128 a[112:115], v22 offset:20480
    v_mfma_f32_16x16x32_bf16 a[176:179], a[36:39], v[52:55], a[176:179]
    v_mfma_f32_16x16x32_bf16 a[180:183], a[40:43], v[48:51], a[180:183]
    v_mfma_f32_16x16x32_bf16 a[180:183], a[44:47], v[52:55], a[180:183]
    buffer_load_dwordx4 v7, s[8:11], s61 offen offset:1024 lds
    v_mfma_f32_16x16x32_bf16 a[184:187], a[48:51], v[48:51], a[184:187]
    v_mfma_f32_16x16x32_bf16 a[184:187], a[52:55], v[52:55], a[184:187]
    ds_read_b128 a[116:119], v23 offset:20480
    v_mfma_f32_16x16x32_bf16 a[188:191], a[56:59], v[48:51], a[188:191]
    v_mfma_f32_16x16x32_bf16 a[188:191], a[60:63], v[52:55], a[188:191]
    v_mfma_f32_16x16x32_bf16 a[192:195], a[0:3], v[56:59], a[192:195]
    v_mfma_f32_16x16x32_bf16 a[192:195], a[4:7], v[60:63], a[192:195]
    v_mfma_f32_16x16x32_bf16 a[196:199], a[8:11], v[56:59], a[196:199]
    v_mfma_f32_16x16x32_bf16 a[196:199], a[12:15], v[60:63], a[196:199]
    buffer_load_dwordx4 v8, s[8:11], s61 offen offset:2048 lds
    v_mfma_f32_16x16x32_bf16 a[200:203], a[16:19], v[56:59], a[200:203]
    ds_read_b128 a[120:123], v22 offset:22528
    v_mfma_f32_16x16x32_bf16 a[200:203], a[20:23], v[60:63], a[200:203]
    v_mfma_f32_16x16x32_bf16 a[204:207], a[24:27], v[56:59], a[204:207]
    v_mfma_f32_16x16x32_bf16 a[204:207], a[28:31], v[60:63], a[204:207]
    v_mfma_f32_16x16x32_bf16 a[208:211], a[32:35], v[56:59], a[208:211]
    ds_read_b128 a[124:127], v23 offset:22528
    v_mfma_f32_16x16x32_bf16 a[208:211], a[36:39], v[60:63], a[208:211]
    v_mfma_f32_16x16x32_bf16 a[212:215], a[40:43], v[56:59], a[212:215]
    buffer_load_dwordx4 v9, s[8:11], s61 offen offset:3072 lds
    v_mfma_f32_16x16x32_bf16 a[212:215], a[44:47], v[60:63], a[212:215]
    v_mfma_f32_16x16x32_bf16 a[216:219], a[48:51], v[56:59], a[216:219]
    v_mfma_f32_16x16x32_bf16 a[216:219], a[52:55], v[60:63], a[216:219]
    v_mfma_f32_16x16x32_bf16 a[220:223], a[56:59], v[56:59], a[220:223]
    v_mfma_f32_16x16x32_bf16 a[220:223], a[60:63], v[60:63], a[220:223]
    s_waitcnt lgkmcnt(0)
    v_mfma_f32_16x16x32_bf16 a[224:227], a[0:3], v[40:43], a[224:227]
    v_mfma_f32_16x16x32_bf16 a[224:227], a[4:7], v[44:47], a[224:227]
    s_xor_b32 s61, s61, 1920
    v_mfma_f32_16x16x32_bf16 a[228:231], a[8:11], v[40:43], a[228:231]
    s_andn2_b32 s61, s61, 896
    v_mfma_f32_16x16x32_bf16 a[228:231], a[12:15], v[44:47], a[228:231]
    s_lshl_b32 s61, s5, 7
    v_mfma_f32_16x16x32_bf16 a[232:235], a[16:19], v[40:43], a[232:235]
    v_mfma_f32_16x16x32_bf16 a[232:235], a[20:23], v[44:47], a[232:235]
    s_waitcnt vmcnt(8) lgkmcnt(0)
    s_barrier
    ds_read_b64_tr_b16 v[48:49], v14 offset:32768
    v_mfma_f32_16x16x32_bf16 a[236:239], a[24:27], v[40:43], a[236:239]
    s_add_u32 m0, s69, 131072
    ds_read_b64_tr_b16 v[50:51], v14 offset:33792
    ds_read_b64_tr_b16 v[52:53], v14 offset:40960
    v_mfma_f32_16x16x32_bf16 a[236:239], a[28:31], v[44:47], a[236:239]
    buffer_load_dwordx4 v2, s[12:15], s60 offen nt lds
    v_mfma_f32_16x16x32_bf16 a[240:243], a[32:35], v[40:43], a[240:243]
    ds_read_b64_tr_b16 v[54:55], v14 offset:41984
    ds_read_b64_tr_b16 v[56:57], v15 offset:32768
    v_mfma_f32_16x16x32_bf16 a[240:243], a[36:39], v[44:47], a[240:243]
    ds_read_b64_tr_b16 v[58:59], v15 offset:33792
    ds_read_b64_tr_b16 v[60:61], v15 offset:40960
    v_mfma_f32_16x16x32_bf16 a[244:247], a[40:43], v[40:43], a[244:247]
    ds_read_b64_tr_b16 v[62:63], v15 offset:41984
    v_add_u32 v14, 0x10000, v14
    v_mfma_f32_16x16x32_bf16 a[244:247], a[44:47], v[44:47], a[244:247]
    v_add_u32 v15, 0x10000, v15
    v_mfma_f32_16x16x32_bf16 a[248:251], a[48:51], v[40:43], a[248:251]
    v_mfma_f32_16x16x32_bf16 a[248:251], a[52:55], v[44:47], a[248:251]
    buffer_load_dwordx4 v3, s[12:15], s60 offen offset:1024 nt lds
    v_mfma_f32_16x16x32_bf16 a[252:255], a[56:59], v[40:43], a[252:255]
    ds_read_b64_tr_b16 v[40:41], v16 offset:32768
    ds_read_b64_tr_b16 v[42:43], v16 offset:33792
    v_mfma_f32_16x16x32_bf16 a[252:255], a[60:63], v[44:47], a[252:255]
    s_waitcnt lgkmcnt(2)
    ds_read_b64_tr_b16 v[44:45], v16 offset:40960
    ds_read_b64_tr_b16 v[46:47], v16 offset:41984
    v_mfma_f32_16x16x32_bf16 v[128:131], v[48:51], a[64:67], v[128:131]
    v_add_u32 v16, 0x10000, v16
    v_mfma_f32_16x16x32_bf16 v[128:131], v[52:55], a[68:71], v[128:131]
    v_mfma_f32_16x16x32_bf16 v[132:135], v[48:51], a[72:75], v[132:135]
    ds_read_b128 a[0:3], v22 offset:49152
    v_mfma_f32_16x16x32_bf16 v[132:135], v[52:55], a[76:79], v[132:135]
    v_mfma_f32_16x16x32_bf16 v[136:139], v[48:51], a[80:83], v[136:139]
    v_mfma_f32_16x16x32_bf16 v[136:139], v[52:55], a[84:87], v[136:139]
    buffer_load_dwordx4 v4, s[12:15], s60 offen offset:2048 nt lds
    v_mfma_f32_16x16x32_bf16 v[140:143], v[48:51], a[88:91], v[140:143]
    v_mfma_f32_16x16x32_bf16 v[140:143], v[52:55], a[92:95], v[140:143]
    ds_read_b128 a[4:7], v23 offset:49152
    v_mfma_f32_16x16x32_bf16 v[144:147], v[48:51], a[96:99], v[144:147]
    v_mfma_f32_16x16x32_bf16 v[144:147], v[52:55], a[100:103], v[144:147]
    v_mfma_f32_16x16x32_bf16 v[148:151], v[48:51], a[104:107], v[148:151]
    v_mfma_f32_16x16x32_bf16 v[148:151], v[52:55], a[108:111], v[148:151]
    v_mfma_f32_16x16x32_bf16 v[152:155], v[48:51], a[112:115], v[152:155]
    buffer_load_dwordx4 v5, s[12:15], s60 offen offset:3072 nt lds
    v_mfma_f32_16x16x32_bf16 v[152:155], v[52:55], a[116:119], v[152:155]
    ds_read_b128 a[8:11], v22 offset:51200
    v_mfma_f32_16x16x32_bf16 v[156:159], v[48:51], a[120:123], v[156:159]
    ds_read_b64_tr_b16 v[48:49], v17 offset:32768
    ds_read_b64_tr_b16 v[50:51], v17 offset:33792
    v_mfma_f32_16x16x32_bf16 v[156:159], v[52:55], a[124:127], v[156:159]
    ds_read_b64_tr_b16 v[52:53], v17 offset:40960
    ds_read_b64_tr_b16 v[54:55], v17 offset:41984
    v_mfma_f32_16x16x32_bf16 v[160:163], v[56:59], a[64:67], v[160:163]
    v_add_u32 v17, 0x10000, v17
    v_mfma_f32_16x16x32_bf16 v[160:163], v[60:63], a[68:71], v[160:163]
    s_cmp_lt_u32 s4, 0
    s_cselect_b32 s12, 0xf149f2ca, 0
    v_mfma_f32_16x16x32_bf16 v[164:167], v[56:59], a[72:75], v[164:167]
    ds_read_b128 a[12:15], v23 offset:51200
    v_mfma_f32_16x16x32_bf16 v[164:167], v[60:63], a[76:79], v[164:167]
    s_add_u32 m0, s69, 147456
    v_mfma_f32_16x16x32_bf16 v[168:171], v[56:59], a[80:83], v[168:171]
    s_xor_b32 s60, s60, 524288
    buffer_load_dwordx4 v6, s[8:11], s62 offen lds
    v_mfma_f32_16x16x32_bf16 v[168:171], v[60:63], a[84:87], v[168:171]
    s_cmp_lt_u32 s4, 1
    s_cselect_b32 s13, 0xf149f2ca, 0
    v_mfma_f32_16x16x32_bf16 v[172:175], v[56:59], a[88:91], v[172:175]
    s_cmp_lt_u32 s4, 2
    s_cselect_b32 s14, 0xf149f2ca, 0
    v_mfma_f32_16x16x32_bf16 v[172:175], v[60:63], a[92:95], v[172:175]
    s_cmp_lt_u32 s4, 3
    s_cselect_b32 s15, 0xf149f2ca, 0
    v_mfma_f32_16x16x32_bf16 v[176:179], v[56:59], a[96:99], v[176:179]
    ds_read_b128 a[16:19], v22 offset:53248
    v_mfma_f32_16x16x32_bf16 v[176:179], v[60:63], a[100:103], v[176:179]
    v_mfma_f32_16x16x32_bf16 v[180:183], v[56:59], a[104:107], v[180:183]
    v_mfma_f32_16x16x32_bf16 v[180:183], v[60:63], a[108:111], v[180:183]
    buffer_load_dwordx4 v7, s[8:11], s62 offen offset:1024 lds
    v_mfma_f32_16x16x32_bf16 v[184:187], v[56:59], a[112:115], v[184:187]
    v_mfma_f32_16x16x32_bf16 v[184:187], v[60:63], a[116:119], v[184:187]
    ds_read_b128 a[20:23], v23 offset:53248
    v_mfma_f32_16x16x32_bf16 v[188:191], v[56:59], a[120:123], v[188:191]
    s_waitcnt lgkmcnt(1)
    ds_read_b64_tr_b16 v[56:57], v14 offset:0
    ds_read_b64_tr_b16 v[58:59], v14 offset:1024
    v_mfma_f32_16x16x32_bf16 v[188:191], v[60:63], a[124:127], v[188:191]
    ds_read_b64_tr_b16 v[60:61], v14 offset:8192
    ds_read_b64_tr_b16 v[62:63], v14 offset:9216
    v_mfma_f32_16x16x32_bf16 v[192:195], v[40:43], a[64:67], v[192:195]
    v_mfma_f32_16x16x32_bf16 v[192:195], v[44:47], a[68:71], v[192:195]
    v_mfma_f32_16x16x32_bf16 v[196:199], v[40:43], a[72:75], v[196:199]
    v_mfma_f32_16x16x32_bf16 v[196:199], v[44:47], a[76:79], v[196:199]
    buffer_load_dwordx4 v8, s[8:11], s62 offen offset:2048 lds
    v_mfma_f32_16x16x32_bf16 v[200:203], v[40:43], a[80:83], v[200:203]
    ds_read_b128 a[24:27], v22 offset:55296
    v_bfe_u32 v8, v1, 4, 3
    v_mfma_f32_16x16x32_bf16 v[200:203], v[44:47], a[84:87], v[200:203]
    v_lshlrev_b32 v8, 12, v8
    v_mfma_f32_16x16x32_bf16 v[204:207], v[40:43], a[88:91], v[204:207]
    v_mfma_f32_16x16x32_bf16 v[204:207], v[44:47], a[92:95], v[204:207]
    v_mfma_f32_16x16x32_bf16 v[208:211], v[40:43], a[96:99], v[208:211]
    ds_read_b128 a[28:31], v23 offset:55296
    v_mfma_f32_16x16x32_bf16 v[208:211], v[44:47], a[100:103], v[208:211]
    v_mfma_f32_16x16x32_bf16 v[212:215], v[40:43], a[104:107], v[212:215]
    buffer_load_dwordx4 v9, s[8:11], s62 offen offset:3072 lds
    v_mfma_f32_16x16x32_bf16 v[212:215], v[44:47], a[108:111], v[212:215]
    s_and_b32 s8, s5, 7
    v_lshrrev_b32 v9, 2, v1
    v_mfma_f32_16x16x32_bf16 v[216:219], v[40:43], a[112:115], v[216:219]
    s_lshl3_add_u32 s8, s6, s8
    v_mfma_f32_16x16x32_bf16 v[216:219], v[44:47], a[116:119], v[216:219]
    s_and_b32 s9, s5, 24
    v_mfma_f32_16x16x32_bf16 v[220:223], v[40:43], a[120:123], v[220:223]
    s_mul_i32 s10, s9, 18
    ds_read_b64_tr_b16 v[40:41], v15 offset:0
    ds_read_b64_tr_b16 v[42:43], v15 offset:1024
    v_mfma_f32_16x16x32_bf16 v[220:223], v[44:47], a[124:127], v[220:223]
    s_add_u32 s10, s10, 16
    ds_read_b64_tr_b16 v[44:45], v15 offset:8192
    ds_read_b64_tr_b16 v[46:47], v15 offset:9216
    v_mfma_f32_16x16x32_bf16 v[224:227], v[48:51], a[64:67], v[224:227]
    s_cmp_eq_u32 s4, 3
    s_cselect_b32 s11, 1.0, 0
    v_mfma_f32_16x16x32_bf16 v[224:227], v[52:55], a[68:71], v[224:227]
    s_xor_b32 s62, s62, 1920
    v_mfma_f32_16x16x32_bf16 v[228:231], v[48:51], a[72:75], v[228:231]
    s_andn2_b32 s62, s62, 896
    v_mfma_f32_16x16x32_bf16 v[228:231], v[52:55], a[76:79], v[228:231]
    v_mfma_f32_16x16x32_bf16 v[232:235], v[48:51], a[80:83], v[232:235]
    v_mfma_f32_16x16x32_bf16 v[232:235], v[52:55], a[84:87], v[232:235]
    s_add_u32 m0, s69, 0
    v_mfma_f32_16x16x32_bf16 v[236:239], v[48:51], a[88:91], v[236:239]
    buffer_load_dwordx4 v2, s[16:19], s60 offen nt lds
    v_mfma_f32_16x16x32_bf16 v[236:239], v[52:55], a[92:95], v[236:239]
    v_mfma_f32_16x16x32_bf16 v[240:243], v[48:51], a[96:99], v[240:243]
    v_mfma_f32_16x16x32_bf16 v[240:243], v[52:55], a[100:103], v[240:243]
    v_mfma_f32_16x16x32_bf16 v[244:247], v[48:51], a[104:107], v[244:247]
    v_mfma_f32_16x16x32_bf16 v[244:247], v[52:55], a[108:111], v[244:247]
    v_mfma_f32_16x16x32_bf16 v[248:251], v[48:51], a[112:115], v[248:251]
    v_mfma_f32_16x16x32_bf16 v[248:251], v[52:55], a[116:119], v[248:251]
    buffer_load_dwordx4 v3, s[16:19], s60 offen offset:1024 nt lds
    v_mfma_f32_16x16x32_bf16 v[252:255], v[48:51], a[120:123], v[252:255]
    ds_read_b64_tr_b16 v[48:49], v16 offset:0
    ds_read_b64_tr_b16 v[50:51], v16 offset:1024
    v_mfma_f32_16x16x32_bf16 v[252:255], v[52:55], a[124:127], v[252:255]
    s_waitcnt lgkmcnt(2)
    ds_read_b64_tr_b16 v[52:53], v16 offset:8192
    ds_read_b64_tr_b16 v[54:55], v16 offset:9216
    v_mfma_f32_16x16x32_bf16 a[128:131], a[64:67], v[56:59], a[128:131]
    v_mfma_f32_16x16x32_bf16 a[128:131], a[68:71], v[60:63], a[128:131]
    v_add_u32 v22, 0x10000, v22
    v_mfma_f32_16x16x32_bf16 a[132:135], a[72:75], v[56:59], a[132:135]
    ds_read_b128 a[32:35], v22 offset:16384
    v_mfma_f32_16x16x32_bf16 a[132:135], a[76:79], v[60:63], a[132:135]
    v_mfma_f32_16x16x32_bf16 a[136:139], a[80:83], v[56:59], a[136:139]
    v_mfma_f32_16x16x32_bf16 a[136:139], a[84:87], v[60:63], a[136:139]
    buffer_load_dwordx4 v4, s[16:19], s60 offen offset:2048 nt lds
    v_mfma_f32_16x16x32_bf16 a[140:143], a[88:91], v[56:59], a[140:143]
    v_add_u32 v23, 0x10000, v23
    v_mfma_f32_16x16x32_bf16 a[140:143], a[92:95], v[60:63], a[140:143]
    ds_read_b128 a[36:39], v23 offset:16384
    v_mfma_f32_16x16x32_bf16 a[144:147], a[96:99], v[56:59], a[144:147]
    v_mfma_f32_16x16x32_bf16 a[144:147], a[100:103], v[60:63], a[144:147]
    v_mfma_f32_16x16x32_bf16 a[148:151], a[104:107], v[56:59], a[148:151]
    v_mfma_f32_16x16x32_bf16 a[148:151], a[108:111], v[60:63], a[148:151]
    v_mfma_f32_16x16x32_bf16 a[152:155], a[112:115], v[56:59], a[152:155]
    buffer_load_dwordx4 v5, s[16:19], s60 offen offset:3072 nt lds
    v_mfma_f32_16x16x32_bf16 a[152:155], a[116:119], v[60:63], a[152:155]
    ds_read_b128 a[40:43], v22 offset:18432
    v_mfma_f32_16x16x32_bf16 a[156:159], a[120:123], v[56:59], a[156:159]
    ds_read_b64_tr_b16 v[56:57], v17 offset:0
    ds_read_b64_tr_b16 v[58:59], v17 offset:1024
    v_mfma_f32_16x16x32_bf16 a[156:159], a[124:127], v[60:63], a[156:159]
    ds_read_b64_tr_b16 v[60:61], v17 offset:8192
    ds_read_b64_tr_b16 v[62:63], v17 offset:9216
    v_mfma_f32_16x16x32_bf16 a[160:163], a[64:67], v[40:43], a[160:163]
    v_mfma_f32_16x16x32_bf16 a[160:163], a[68:71], v[44:47], a[160:163]
    v_mfma_f32_16x16x32_bf16 a[164:167], a[72:75], v[40:43], a[164:167]
    ds_read_b128 a[44:47], v23 offset:18432
    v_mfma_f32_16x16x32_bf16 a[164:167], a[76:79], v[44:47], a[164:167]
    s_add_u32 m0, s69, 16384
    v_mfma_f32_16x16x32_bf16 a[168:171], a[80:83], v[40:43], a[168:171]
    s_xor_b32 s60, s60, 524288
    buffer_load_dwordx4 v10, s[20:23], s63 offen lds
    v_mfma_f32_16x16x32_bf16 a[168:171], a[84:87], v[44:47], a[168:171]
    v_mfma_f32_16x16x32_bf16 a[172:175], a[88:91], v[40:43], a[172:175]
    v_mfma_f32_16x16x32_bf16 a[172:175], a[92:95], v[44:47], a[172:175]
    v_mfma_f32_16x16x32_bf16 a[176:179], a[96:99], v[40:43], a[176:179]
    ds_read_b128 a[48:51], v22 offset:20480
    v_mfma_f32_16x16x32_bf16 a[176:179], a[100:103], v[44:47], a[176:179]
    v_mfma_f32_16x16x32_bf16 a[180:183], a[104:107], v[40:43], a[180:183]
    v_mfma_f32_16x16x32_bf16 a[180:183], a[108:111], v[44:47], a[180:183]
    buffer_load_dwordx4 v11, s[20:23], s63 offen offset:1024 lds
    v_mfma_f32_16x16x32_bf16 a[184:187], a[112:115], v[40:43], a[184:187]
    v_mfma_f32_16x16x32_bf16 a[184:187], a[116:119], v[44:47], a[184:187]
    ds_read_b128 a[52:55], v23 offset:20480
    v_mfma_f32_16x16x32_bf16 a[188:191], a[120:123], v[40:43], a[188:191]
    v_mfma_f32_16x16x32_bf16 a[188:191], a[124:127], v[44:47], a[188:191]
    s_waitcnt lgkmcnt(1)
    v_mfma_f32_16x16x32_bf16 a[192:195], a[64:67], v[48:51], a[192:195]
    v_mfma_f32_16x16x32_bf16 a[192:195], a[68:71], v[52:55], a[192:195]
    v_mfma_f32_16x16x32_bf16 a[196:199], a[72:75], v[48:51], a[196:199]
    v_mfma_f32_16x16x32_bf16 a[196:199], a[76:79], v[52:55], a[196:199]
    buffer_load_dwordx4 v12, s[20:23], s63 offen offset:2048 lds
    v_mfma_f32_16x16x32_bf16 a[200:203], a[80:83], v[48:51], a[200:203]
    ds_read_b128 a[56:59], v22 offset:22528
    v_mfma_f32_16x16x32_bf16 a[200:203], a[84:87], v[52:55], a[200:203]
    v_mfma_f32_16x16x32_bf16 a[204:207], a[88:91], v[48:51], a[204:207]
    v_mfma_f32_16x16x32_bf16 a[204:207], a[92:95], v[52:55], a[204:207]
    v_mfma_f32_16x16x32_bf16 a[208:211], a[96:99], v[48:51], a[208:211]
    ds_read_b128 a[60:63], v23 offset:22528
    v_mfma_f32_16x16x32_bf16 a[208:211], a[100:103], v[52:55], a[208:211]
    v_mfma_f32_16x16x32_bf16 a[212:215], a[104:107], v[48:51], a[212:215]
    buffer_load_dwordx4 v13, s[20:23], s63 offen offset:3072 lds
    v_mfma_f32_16x16x32_bf16 a[212:215], a[108:111], v[52:55], a[212:215]
    v_mfma_f32_16x16x32_bf16 a[216:219], a[112:115], v[48:51], a[216:219]
    v_mfma_f32_16x16x32_bf16 a[216:219], a[116:119], v[52:55], a[216:219]
    v_mfma_f32_16x16x32_bf16 a[220:223], a[120:123], v[48:51], a[220:223]
    v_mfma_f32_16x16x32_bf16 a[220:223], a[124:127], v[52:55], a[220:223]
    v_mfma_f32_16x16x32_bf16 a[224:227], a[64:67], v[56:59], a[224:227]
    v_mfma_f32_16x16x32_bf16 a[224:227], a[68:71], v[60:63], a[224:227]
    s_xor_b32 s63, s63, 128
    v_mfma_f32_16x16x32_bf16 a[228:231], a[72:75], v[56:59], a[228:231]
    v_mfma_f32_16x16x32_bf16 a[228:231], a[76:79], v[60:63], a[228:231]
    v_mfma_f32_16x16x32_bf16 a[232:235], a[80:83], v[56:59], a[232:235]
    v_mfma_f32_16x16x32_bf16 a[232:235], a[84:87], v[60:63], a[232:235]
    s_waitcnt vmcnt(8) lgkmcnt(0)
    s_barrier
    ds_read_b64_tr_b16 v[40:41], v14 offset:32768
    v_mfma_f32_16x16x32_bf16 a[236:239], a[88:91], v[56:59], a[236:239]
    s_add_u32 m0, s69, 32768
    ds_read_b64_tr_b16 v[42:43], v14 offset:33792
    ds_read_b64_tr_b16 v[44:45], v14 offset:40960
    v_mfma_f32_16x16x32_bf16 a[236:239], a[92:95], v[60:63], a[236:239]
    buffer_load_dwordx4 v2, s[16:19], s60 offen nt lds
    v_mfma_f32_16x16x32_bf16 a[240:243], a[96:99], v[56:59], a[240:243]
    ds_read_b64_tr_b16 v[46:47], v14 offset:41984
    ds_read_b64_tr_b16 v[48:49], v15 offset:32768
    v_mfma_f32_16x16x32_bf16 a[240:243], a[100:103], v[60:63], a[240:243]
    ds_read_b64_tr_b16 v[50:51], v15 offset:33792
    ds_read_b64_tr_b16 v[52:53], v15 offset:40960
    v_mfma_f32_16x16x32_bf16 a[244:247], a[104:107], v[56:59], a[244:247]
    ds_read_b64_tr_b16 v[54:55], v15 offset:41984
    v_add_u32 v14, 0x10000, v14
    v_mfma_f32_16x16x32_bf16 a[244:247], a[108:111], v[60:63], a[244:247]
    v_add_u32 v15, 0x10000, v15
    v_mfma_f32_16x16x32_bf16 a[248:251], a[112:115], v[56:59], a[248:251]
    v_mfma_f32_16x16x32_bf16 a[248:251], a[116:119], v[60:63], a[248:251]
    buffer_load_dwordx4 v3, s[16:19], s60 offen offset:1024 nt lds
    v_mfma_f32_16x16x32_bf16 a[252:255], a[120:123], v[56:59], a[252:255]
    ds_read_b64_tr_b16 v[56:57], v16 offset:32768
    ds_read_b64_tr_b16 v[58:59], v16 offset:33792
    v_mfma_f32_16x16x32_bf16 a[252:255], a[124:127], v[60:63], a[252:255]
    s_waitcnt lgkmcnt(2)
    ds_read_b64_tr_b16 v[60:61], v16 offset:40960
    ds_read_b64_tr_b16 v[62:63], v16 offset:41984
    v_mfma_f32_16x16x32_bf16 v[128:131], v[40:43], a[0:3], v[128:131]
    v_add_u32 v16, 0x10000, v16
    v_mfma_f32_16x16x32_bf16 v[128:131], v[44:47], a[4:7], v[128:131]
    ds_read_b128 a[64:67], v22 offset:49152
    v_mfma_f32_16x16x32_bf16 v[132:135], v[40:43], a[8:11], v[132:135]
    v_mfma_f32_16x16x32_bf16 v[132:135], v[44:47], a[12:15], v[132:135]
    v_mfma_f32_16x16x32_bf16 v[136:139], v[40:43], a[16:19], v[136:139]
    ds_read_b128 a[68:71], v23 offset:49152
    v_mfma_f32_16x16x32_bf16 v[136:139], v[44:47], a[20:23], v[136:139]
    buffer_load_dwordx4 v4, s[16:19], s60 offen offset:2048 nt lds
    v_mfma_f32_16x16x32_bf16 v[140:143], v[40:43], a[24:27], v[140:143]
    v_mfma_f32_16x16x32_bf16 v[140:143], v[44:47], a[28:31], v[140:143]
    ds_read_b128 a[72:75], v22 offset:51200
    v_mfma_f32_16x16x32_bf16 v[144:147], v[40:43], a[32:35], v[144:147]
    v_mfma_f32_16x16x32_bf16 v[144:147], v[44:47], a[36:39], v[144:147]
    v_mfma_f32_16x16x32_bf16 v[148:151], v[40:43], a[40:43], v[148:151]
    ds_read_b128 a[76:79], v23 offset:51200
    v_mfma_f32_16x16x32_bf16 v[148:151], v[44:47], a[44:47], v[148:151]
    v_mfma_f32_16x16x32_bf16 v[152:155], v[40:43], a[48:51], v[152:155]
    buffer_load_dwordx4 v5, s[16:19], s60 offen offset:3072 nt lds
    v_mfma_f32_16x16x32_bf16 v[152:155], v[44:47], a[52:55], v[152:155]
    v_mfma_f32_16x16x32_bf16 v[156:159], v[40:43], a[56:59], v[156:159]
    ds_read_b128 a[80:83], v22 offset:53248
    ds_read_b64_tr_b16 v[40:41], v17 offset:32768
    v_mfma_f32_16x16x32_bf16 v[156:159], v[44:47], a[60:63], v[156:159]
    ds_read_b64_tr_b16 v[42:43], v17 offset:33792
    ds_read_b64_tr_b16 v[44:45], v17 offset:40960
    v_mfma_f32_16x16x32_bf16 v[160:163], v[48:51], a[0:3], v[160:163]
    ds_read_b64_tr_b16 v[46:47], v17 offset:41984
    v_add_u32 v17, 0x10000, v17
    v_mfma_f32_16x16x32_bf16 v[160:163], v[52:55], a[4:7], v[160:163]
    ds_read_b128 a[84:87], v23 offset:53248
    v_mfma_f32_16x16x32_bf16 v[164:167], v[48:51], a[8:11], v[164:167]
    v_mfma_f32_16x16x32_bf16 v[164:167], v[52:55], a[12:15], v[164:167]
    s_add_u32 m0, s69, 49152
    buffer_load_dword v7, v9, s[44:47], s69 offen sc1
    v_mfma_f32_16x16x32_bf16 v[168:171], v[48:51], a[16:19], v[168:171]
    s_xor_b32 s60, s60, 3670016
    buffer_load_dwordx4 v10, s[20:23], s64 offen lds
    v_mfma_f32_16x16x32_bf16 v[168:171], v[52:55], a[20:23], v[168:171]
    ds_read_b128 a[88:91], v22 offset:55296
    v_mfma_f32_16x16x32_bf16 v[172:175], v[48:51], a[24:27], v[172:175]
    v_mfma_f32_16x16x32_bf16 v[172:175], v[52:55], a[28:31], v[172:175]
    s_waitcnt lgkmcnt(1)
    ds_read_b128 a[92:95], v23 offset:55296
    v_mfma_f32_16x16x32_bf16 v[176:179], v[48:51], a[32:35], v[176:179]
    v_mfma_f32_16x16x32_bf16 v[176:179], v[52:55], a[36:39], v[176:179]
    v_mfma_f32_16x16x32_bf16 v[180:183], v[48:51], a[40:43], v[180:183]
    v_mfma_f32_16x16x32_bf16 v[180:183], v[52:55], a[44:47], v[180:183]
    buffer_load_dwordx4 v11, s[20:23], s64 offen offset:1024 lds
    v_mfma_f32_16x16x32_bf16 v[184:187], v[48:51], a[48:51], v[184:187]
    v_add_u32 v22, 0x10000, v22
    ds_read_b128 a[96:99], v22 offset:16384
    v_mfma_f32_16x16x32_bf16 v[184:187], v[52:55], a[52:55], v[184:187]
    v_mfma_f32_16x16x32_bf16 v[188:191], v[48:51], a[56:59], v[188:191]
    v_add_u32 v23, 0x10000, v23
    ds_read_b64_tr_b16 v[48:49], v14 offset:0
    v_mfma_f32_16x16x32_bf16 v[188:191], v[52:55], a[60:63], v[188:191]
    ds_read_b128 a[100:103], v23 offset:16384
    ds_read_b64_tr_b16 v[50:51], v14 offset:1024
    v_mfma_f32_16x16x32_bf16 v[192:195], v[56:59], a[0:3], v[192:195]
    ds_read_b64_tr_b16 v[52:53], v14 offset:8192
    ds_read_b64_tr_b16 v[54:55], v14 offset:9216
    v_mfma_f32_16x16x32_bf16 v[192:195], v[60:63], a[4:7], v[192:195]
    v_add_u32 v14, 0xfffe0000, v14
    v_mfma_f32_16x16x32_bf16 v[196:199], v[56:59], a[8:11], v[196:199]
    ds_read_b128 a[104:107], v22 offset:18432
    v_mfma_f32_16x16x32_bf16 v[196:199], v[60:63], a[12:15], v[196:199]
    buffer_load_dwordx4 v12, s[20:23], s64 offen offset:2048 lds
    v_mfma_f32_16x16x32_bf16 v[200:203], v[56:59], a[16:19], v[200:203]
    v_mfma_f32_16x16x32_bf16 v[200:203], v[60:63], a[20:23], v[200:203]
    ds_read_b128 a[108:111], v23 offset:18432
    v_mfma_f32_16x16x32_bf16 v[204:207], v[56:59], a[24:27], v[204:207]
    v_mfma_f32_16x16x32_bf16 v[204:207], v[60:63], a[28:31], v[204:207]
    v_mfma_f32_16x16x32_bf16 v[208:211], v[56:59], a[32:35], v[208:211]
    v_mfma_f32_16x16x32_bf16 v[208:211], v[60:63], a[36:39], v[208:211]
    ds_read_b128 a[112:115], v22 offset:20480
    v_mfma_f32_16x16x32_bf16 v[212:215], v[56:59], a[40:43], v[212:215]
    buffer_load_dwordx4 v13, s[20:23], s64 offen offset:3072 lds
    v_mfma_f32_16x16x32_bf16 v[212:215], v[60:63], a[44:47], v[212:215]
    v_mfma_f32_16x16x32_bf16 v[216:219], v[56:59], a[48:51], v[216:219]
    ds_read_b128 a[116:119], v23 offset:20480
    v_mfma_f32_16x16x32_bf16 v[216:219], v[60:63], a[52:55], v[216:219]
    v_mfma_f32_16x16x32_bf16 v[220:223], v[56:59], a[56:59], v[220:223]
    ds_read_b64_tr_b16 v[56:57], v15 offset:0
    ds_read_b64_tr_b16 v[58:59], v15 offset:1024
    v_mfma_f32_16x16x32_bf16 v[220:223], v[60:63], a[60:63], v[220:223]
    s_waitcnt lgkmcnt(3)
    ds_read_b128 a[120:123], v22 offset:22528
    ds_read_b64_tr_b16 v[60:61], v15 offset:8192
    v_mfma_f32_16x16x32_bf16 v[224:227], v[40:43], a[0:3], v[224:227]
    ds_read_b64_tr_b16 v[62:63], v15 offset:9216
    v_add_u32 v15, 0xfffe0000, v15
    v_mfma_f32_16x16x32_bf16 v[224:227], v[44:47], a[4:7], v[224:227]
    s_xor_b32 s64, s64, 128
    v_mfma_f32_16x16x32_bf16 v[228:231], v[40:43], a[8:11], v[228:231]
    ds_read_b128 a[124:127], v23 offset:22528
    v_mfma_f32_16x16x32_bf16 v[228:231], v[44:47], a[12:15], v[228:231]
    v_mfma_f32_16x16x32_bf16 v[232:235], v[40:43], a[16:19], v[232:235]
    v_mfma_f32_16x16x32_bf16 v[232:235], v[44:47], a[20:23], v[232:235]
    s_add_u32 m0, s69, 65536
    v_mfma_f32_16x16x32_bf16 v[236:239], v[40:43], a[24:27], v[236:239]
    buffer_load_dwordx4 v2, s[24:27], s60 offen lds
    v_mfma_f32_16x16x32_bf16 v[236:239], v[44:47], a[28:31], v[236:239]
    v_mfma_f32_16x16x32_bf16 v[240:243], v[40:43], a[32:35], v[240:243]
    v_mfma_f32_16x16x32_bf16 v[240:243], v[44:47], a[36:39], v[240:243]
    v_mfma_f32_16x16x32_bf16 v[244:247], v[40:43], a[40:43], v[244:247]
    v_mfma_f32_16x16x32_bf16 v[244:247], v[44:47], a[44:47], v[244:247]
    v_mfma_f32_16x16x32_bf16 v[248:251], v[40:43], a[48:51], v[248:251]
    v_mfma_f32_16x16x32_bf16 v[248:251], v[44:47], a[52:55], v[248:251]
    buffer_load_dwordx4 v3, s[24:27], s60 offen offset:1024 lds
    v_mfma_f32_16x16x32_bf16 v[252:255], v[40:43], a[56:59], v[252:255]
    ds_read_b64_tr_b16 v[40:41], v16 offset:0
    ds_read_b64_tr_b16 v[42:43], v16 offset:1024
    v_mfma_f32_16x16x32_bf16 v[252:255], v[44:47], a[60:63], v[252:255]
    ds_read_b64_tr_b16 v[44:45], v16 offset:8192
    ds_read_b64_tr_b16 v[46:47], v16 offset:9216
    v_mfma_f32_16x16x32_bf16 v[128:131], v[48:51], a[64:67], v[128:131]
    v_add_u32 v16, 0xfffe0000, v16
    v_mfma_f32_16x16x32_bf16 v[128:131], v[52:55], a[68:71], v[128:131]
    v_mfma_f32_16x16x32_bf16 v[132:135], v[48:51], a[72:75], v[132:135]
    v_mfma_f32_16x16x32_bf16 v[132:135], v[52:55], a[76:79], v[132:135]
    v_mfma_f32_16x16x32_bf16 v[136:139], v[48:51], a[80:83], v[136:139]
    v_mfma_f32_16x16x32_bf16 v[136:139], v[52:55], a[84:87], v[136:139]
    buffer_load_dwordx4 v4, s[24:27], s60 offen offset:2048 lds
    v_mfma_f32_16x16x32_bf16 v[140:143], v[48:51], a[88:91], v[140:143]
    v_mfma_f32_16x16x32_bf16 v[140:143], v[52:55], a[92:95], v[140:143]
    v_mfma_f32_16x16x32_bf16 v[144:147], v[48:51], a[96:99], v[144:147]
    v_mul_f32 v128, s74, v128
    v_mul_f32 v129, s74, v129
    v_mfma_f32_16x16x32_bf16 v[144:147], v[52:55], a[100:103], v[144:147]
    v_mul_f32 v130, s74, v130
    v_mul_f32 v131, s74, v131
    v_mfma_f32_16x16x32_bf16 v[148:151], v[48:51], a[104:107], v[148:151]
    v_cvt_pk_bf16_f32 v128, v128, v129
    v_cvt_pk_bf16_f32 v129, v130, v131
    v_mfma_f32_16x16x32_bf16 v[148:151], v[52:55], a[108:111], v[148:151]
    v_mul_f32 v132, s74, v132
    v_mul_f32 v133, s74, v133
    v_mfma_f32_16x16x32_bf16 v[152:155], v[48:51], a[112:115], v[152:155]
    s_waitcnt lgkmcnt(0)
    buffer_load_dwordx4 v5, s[24:27], s60 offen offset:3072 lds
    v_mfma_f32_16x16x32_bf16 v[152:155], v[52:55], a[116:119], v[152:155]
    v_mul_f32 v134, s74, v134
    v_mul_f32 v135, s74, v135
    v_mfma_f32_16x16x32_bf16 v[156:159], v[48:51], a[120:123], v[156:159]
    ds_read_b64_tr_b16 v[48:49], v17 offset:0
    ds_read_b64_tr_b16 v[50:51], v17 offset:1024
    v_mfma_f32_16x16x32_bf16 v[156:159], v[52:55], a[124:127], v[156:159]
    ds_read_b64_tr_b16 v[52:53], v17 offset:8192
    ds_read_b64_tr_b16 v[54:55], v17 offset:9216
    v_mfma_f32_16x16x32_bf16 v[160:163], v[56:59], a[64:67], v[160:163]
    v_add_u32 v17, 0xfffe0000, v17
    v_cvt_pk_bf16_f32 v132, v132, v133
    v_mfma_f32_16x16x32_bf16 v[160:163], v[60:63], a[68:71], v[160:163]
    v_cvt_pk_bf16_f32 v133, v134, v135
    v_mul_f32 v136, s74, v136
    v_mfma_f32_16x16x32_bf16 v[164:167], v[56:59], a[72:75], v[164:167]
    v_mul_f32 v137, s74, v137
    v_mul_f32 v138, s74, v138
    v_mfma_f32_16x16x32_bf16 v[164:167], v[60:63], a[76:79], v[164:167]
    s_add_u32 m0, s69, 81920
    v_mul_f32 v139, s74, v139
    v_mul_f32 v160, s74, v160
    v_mfma_f32_16x16x32_bf16 v[168:171], v[56:59], a[80:83], v[168:171]
    s_xor_b32 s60, s60, 524288
    buffer_load_dwordx4 v10, s[20:23], s63 offen lds
    v_mfma_f32_16x16x32_bf16 v[168:171], v[60:63], a[84:87], v[168:171]
    v_mul_f32 v161, s74, v161
    v_mul_f32 v162, s74, v162
    v_mfma_f32_16x16x32_bf16 v[172:175], v[56:59], a[88:91], v[172:175]
    v_mul_f32 v163, s74, v163
    v_cvt_pk_bf16_f32 v130, v160, v161
    v_mfma_f32_16x16x32_bf16 v[172:175], v[60:63], a[92:95], v[172:175]
    v_cvt_pk_bf16_f32 v131, v162, v163
    v_mul_f32 v164, s74, v164
    v_mfma_f32_16x16x32_bf16 v[176:179], v[56:59], a[96:99], v[176:179]
    v_mul_f32 v165, s74, v165
    v_mul_f32 v166, s74, v166
    v_mfma_f32_16x16x32_bf16 v[176:179], v[60:63], a[100:103], v[176:179]
    v_mul_f32 v167, s74, v167
    v_cvt_pk_bf16_f32 v134, v164, v165
    v_mfma_f32_16x16x32_bf16 v[180:183], v[56:59], a[104:107], v[180:183]
    v_cvt_pk_bf16_f32 v135, v166, v167
    v_mul_f32 v168, s74, v168
    v_mfma_f32_16x16x32_bf16 v[180:183], v[60:63], a[108:111], v[180:183]
    buffer_load_dwordx4 v11, s[20:23], s63 offen offset:1024 lds
    v_mfma_f32_16x16x32_bf16 v[184:187], v[56:59], a[112:115], v[184:187]
    v_mul_f32 v169, s74, v169
    v_mul_f32 v170, s74, v170
    v_mfma_f32_16x16x32_bf16 v[184:187], v[60:63], a[116:119], v[184:187]
    v_mul_f32 v171, s74, v171
    v_cvt_pk_bf16_f32 v136, v136, v137
    v_mfma_f32_16x16x32_bf16 v[188:191], v[56:59], a[120:123], v[188:191]
    v_cvt_pk_bf16_f32 v137, v138, v139
    v_cvt_pk_bf16_f32 v138, v168, v169
    v_mfma_f32_16x16x32_bf16 v[188:191], v[60:63], a[124:127], v[188:191]
    v_cvt_pk_bf16_f32 v139, v170, v171
    v_mul_f32 v140, s74, v140
    v_mfma_f32_16x16x32_bf16 v[192:195], v[40:43], a[64:67], v[192:195]
    v_mul_f32 v141, s74, v141
    v_mul_f32 v142, s74, v142
    v_mfma_f32_16x16x32_bf16 v[192:195], v[44:47], a[68:71], v[192:195]
    v_mul_f32 v143, s74, v143
    v_mul_f32 v172, s74, v172
    v_mfma_f32_16x16x32_bf16 v[196:199], v[40:43], a[72:75], v[196:199]
    v_mul_f32 v173, s74, v173
    v_mul_f32 v174, s74, v174
    v_mfma_f32_16x16x32_bf16 v[196:199], v[44:47], a[76:79], v[196:199]
    buffer_load_dwordx4 v12, s[20:23], s63 offen offset:2048 lds
    v_mfma_f32_16x16x32_bf16 v[200:203], v[40:43], a[80:83], v[200:203]
    v_mul_f32 v175, s74, v175
    v_cvt_pk_bf16_f32 v140, v140, v141
    v_mfma_f32_16x16x32_bf16 v[200:203], v[44:47], a[84:87], v[200:203]
    v_cvt_pk_bf16_f32 v141, v142, v143
    v_cvt_pk_bf16_f32 v142, v172, v173
    v_mfma_f32_16x16x32_bf16 v[204:207], v[40:43], a[88:91], v[204:207]
    v_cvt_pk_bf16_f32 v143, v174, v175
    v_mul_f32 v144, s74, v144
    v_mfma_f32_16x16x32_bf16 v[204:207], v[44:47], a[92:95], v[204:207]
    v_mul_f32 v145, s74, v145
    v_mul_f32 v146, s74, v146
    v_mfma_f32_16x16x32_bf16 v[208:211], v[40:43], a[96:99], v[208:211]
    v_mul_f32 v147, s74, v147
    v_mul_f32 v176, s74, v176
    v_mfma_f32_16x16x32_bf16 v[208:211], v[44:47], a[100:103], v[208:211]
    v_mul_f32 v177, s74, v177
    v_mul_f32 v178, s74, v178
    v_mfma_f32_16x16x32_bf16 v[212:215], v[40:43], a[104:107], v[212:215]
    buffer_load_dwordx4 v13, s[20:23], s63 offen offset:3072 lds
    v_mfma_f32_16x16x32_bf16 v[212:215], v[44:47], a[108:111], v[212:215]
    v_mul_f32 v179, s74, v179
    v_cvt_pk_bf16_f32 v144, v144, v145
    v_mfma_f32_16x16x32_bf16 v[216:219], v[40:43], a[112:115], v[216:219]
    v_cvt_pk_bf16_f32 v145, v146, v147
    v_cvt_pk_bf16_f32 v146, v176, v177
    v_mfma_f32_16x16x32_bf16 v[216:219], v[44:47], a[116:119], v[216:219]
    v_cvt_pk_bf16_f32 v147, v178, v179
    v_mul_f32 v148, s74, v148
    v_mfma_f32_16x16x32_bf16 v[220:223], v[40:43], a[120:123], v[220:223]
    v_mul_f32 v149, s74, v149
    v_mul_f32 v150, s74, v150
    v_mfma_f32_16x16x32_bf16 v[220:223], v[44:47], a[124:127], v[220:223]
    s_add_u32 s72, s70, 0
    v_mul_f32 v151, s74, v151
    v_mul_f32 v180, s74, v180
    s_waitcnt lgkmcnt(0)
    v_mfma_f32_16x16x32_bf16 v[224:227], v[48:51], a[64:67], v[224:227]
    buffer_store_dwordx4 v[128:131], v1, s[36:39], s72 offen sc1
    v_mfma_f32_16x16x32_bf16 v[224:227], v[52:55], a[68:71], v[224:227]
    s_xor_b32 s63, s63, 384
    v_mul_f32 v181, s74, v181
    v_mul_f32 v182, s74, v182
    v_mfma_f32_16x16x32_bf16 v[228:231], v[48:51], a[72:75], v[228:231]
    v_mul_f32 v183, s74, v183
    v_cvt_pk_bf16_f32 v148, v148, v149
    v_mfma_f32_16x16x32_bf16 v[228:231], v[52:55], a[76:79], v[228:231]
    v_cvt_pk_bf16_f32 v149, v150, v151
    v_cvt_pk_bf16_f32 v150, v180, v181
    v_mfma_f32_16x16x32_bf16 v[232:235], v[48:51], a[80:83], v[232:235]
    v_cvt_pk_bf16_f32 v151, v182, v183
    v_mul_f32 v152, s74, v152
    v_mfma_f32_16x16x32_bf16 v[232:235], v[52:55], a[84:87], v[232:235]
    s_add_u32 m0, s67, 98304
    v_mul_f32 v153, s74, v153
    v_mul_f32 v154, s74, v154
    s_waitcnt vmcnt(9) lgkmcnt(0)
    v_cmp_gt_u32 vcc, 8, v7
    s_nop 1
    s_and_b64 vcc, vcc, s[86:87]
    s_cbranch_scc1 SPIN_WA
BACK_WA:
    s_barrier
    v_mfma_f32_16x16x32_bf16 v[236:239], v[48:51], a[88:91], v[236:239]
    buffer_load_dwordx4 v1, s[28:31], s65 offen sc1 lds
    v_mfma_f32_16x16x32_bf16 v[236:239], v[52:55], a[92:95], v[236:239]
    ds_read_b64_tr_b16 v[56:57], v14 offset:0
    ds_read_b64_tr_b16 v[58:59], v14 offset:1024
    v_mfma_f32_16x16x32_bf16 v[240:243], v[48:51], a[96:99], v[240:243]
    ds_read_b64_tr_b16 v[60:61], v14 offset:8192
    ds_read_b64_tr_b16 v[62:63], v14 offset:9216
    v_mfma_f32_16x16x32_bf16 v[240:243], v[52:55], a[100:103], v[240:243]
    ds_read_b64_tr_b16 v[40:41], v15 offset:0
    ds_read_b64_tr_b16 v[42:43], v15 offset:1024
    v_mfma_f32_16x16x32_bf16 v[244:247], v[48:51], a[104:107], v[244:247]
    ds_read_b64_tr_b16 v[44:45], v15 offset:8192
    ds_read_b64_tr_b16 v[46:47], v15 offset:9216
    v_mfma_f32_16x16x32_bf16 v[244:247], v[52:55], a[108:111], v[244:247]
    v_mul_f32 v155, s74, v155
    v_mul_f32 v184, s74, v184
    v_mfma_f32_16x16x32_bf16 v[248:251], v[48:51], a[112:115], v[248:251]
    v_mul_f32 v185, s74, v185
    v_mul_f32 v186, s74, v186
    v_mfma_f32_16x16x32_bf16 v[248:251], v[52:55], a[116:119], v[248:251]
    v_mul_f32 v187, s74, v187
    v_cvt_pk_bf16_f32 v152, v152, v153
    v_mfma_f32_16x16x32_bf16 v[252:255], v[48:51], a[120:123], v[252:255]
    s_lshr_b32 s92, s2, 3
    v_lshrrev_b32 v9, 4, v1
    v_min_u32 v9, 0, v9
    v_mfma_f32_16x16x32_bf16 v[252:255], v[52:55], a[124:127], v[252:255]
    s_lshl2_add_u32 s92, s92, s4
    ds_read_b64_tr_b16 v[48:49], v16 offset:0
    ds_read_b64_tr_b16 v[50:51], v16 offset:1024
    s_waitcnt lgkmcnt(2)
    v_mfma_f32_16x16x32_bf16 a[128:131], a[0:3], v[56:59], a[128:131]
    s_mul_i32 s92, s92, 1
    buffer_load_dwordx4 v1, s[28:31], s65 offen offset:1024 sc1 lds
    v_mfma_f32_16x16x32_bf16 a[128:131], a[4:7], v[60:63], a[128:131]
    s_add_u32 s92, s92, 32
    v_add_lshl_u32 v9, v9, s92, 7
    ds_read_b64_tr_b16 v[52:53], v16 offset:8192
    v_mfma_f32_16x16x32_bf16 a[132:135], a[8:11], v[56:59], a[132:135]
    s_getpc_b64 s[92:93]
    global_load_dword v9, v9, s[92:93]
    v_mfma_f32_16x16x32_bf16 a[132:135], a[12:15], v[60:63], a[132:135]
    ds_read_b128 v[64:67], v24 offset:16384
    ds_read_b64_tr_b16 v[54:55], v16 offset:9216
    v_mfma_f32_16x16x32_bf16 a[136:139], a[16:19], v[56:59], a[136:139]
    v_cvt_pk_bf16_f32 v153, v154, v155
    v_cvt_pk_bf16_f32 v154, v184, v185
    v_mfma_f32_16x16x32_bf16 a[136:139], a[20:23], v[60:63], a[136:139]
    v_cvt_pk_bf16_f32 v155, v186, v187
    v_mul_f32 v156, s74, v156
    v_mfma_f32_16x16x32_bf16 a[140:143], a[24:27], v[56:59], a[140:143]
    v_mul_f32 v157, s74, v157
    v_mul_f32 v158, s74, v158
    v_mfma_f32_16x16x32_bf16 a[140:143], a[28:31], v[60:63], a[140:143]
    s_add_u32 s72, s70, 4096
    v_mul_f32 v159, s74, v159
    v_mul_f32 v188, s74, v188
    v_mfma_f32_16x16x32_bf16 a[144:147], a[32:35], v[56:59], a[144:147]
    buffer_store_dwordx4 v[132:135], v1, s[36:39], s72 offen sc1
    v_mfma_f32_16x16x32_bf16 a[144:147], a[36:39], v[60:63], a[144:147]
    s_add_u32 m0, s69, 114688
    v_mul_f32 v189, s74, v189
    v_mul_f32 v190, s74, v190
    v_mfma_f32_16x16x32_bf16 a[148:151], a[40:43], v[56:59], a[148:151]
    s_xor_b32 s65, s65, 8192
    buffer_load_dwordx4 v10, s[20:23], s64 offen lds
    v_mfma_f32_16x16x32_bf16 a[148:151], a[44:47], v[60:63], a[148:151]
    v_mul_f32 v191, s74, v191
    v_cvt_pk_bf16_f32 v156, v156, v157
    v_mfma_f32_16x16x32_bf16 a[152:155], a[48:51], v[56:59], a[152:155]
    v_cvt_pk_bf16_f32 v157, v158, v159
    v_cvt_pk_bf16_f32 v158, v188, v189
    v_mfma_f32_16x16x32_bf16 a[152:155], a[52:55], v[60:63], a[152:155]
    ds_read_b128 v[68:71], v25 offset:16384
    v_cvt_pk_bf16_f32 v159, v190, v191
    v_mfma_f32_16x16x32_bf16 a[156:159], a[56:59], v[56:59], a[156:159]
    ds_read_b64_tr_b16 v[56:57], v17 offset:0
    ds_read_b64_tr_b16 v[58:59], v17 offset:1024
    v_mfma_f32_16x16x32_bf16 a[156:159], a[60:63], v[60:63], a[156:159]
    ds_read_b64_tr_b16 v[60:61], v17 offset:8192
    ds_read_b64_tr_b16 v[62:63], v17 offset:9216
    v_mfma_f32_16x16x32_bf16 a[160:163], a[0:3], v[40:43], a[160:163]
    v_mul_f32 v192, s74, v192
    v_mul_f32 v193, s74, v193
    v_mfma_f32_16x16x32_bf16 a[160:163], a[4:7], v[44:47], a[160:163]
    v_mul_f32 v194, s74, v194
    v_mul_f32 v195, s74, v195
    v_mfma_f32_16x16x32_bf16 a[164:167], a[8:11], v[40:43], a[164:167]
    v_mul_f32 v224, s74, v224
    v_mul_f32 v225, s74, v225
    v_mfma_f32_16x16x32_bf16 a[164:167], a[12:15], v[44:47], a[164:167]
    v_mul_f32 v226, s74, v226
    v_mul_f32 v227, s74, v227
    v_mfma_f32_16x16x32_bf16 a[168:171], a[16:19], v[40:43], a[168:171]
    buffer_load_dwordx4 v11, s[20:23], s64 offen offset:1024 lds
    v_mfma_f32_16x16x32_bf16 a[168:171], a[20:23], v[44:47], a[168:171]
    v_cvt_pk_bf16_f32 v192, v192, v193
    v_cvt_pk_bf16_f32 v193, v194, v195
    v_mfma_f32_16x16x32_bf16 a[172:175], a[24:27], v[40:43], a[172:175]
    v_cvt_pk_bf16_f32 v194, v224, v225
    v_cvt_pk_bf16_f32 v195, v226, v227
    v_mfma_f32_16x16x32_bf16 a[172:175], a[28:31], v[44:47], a[172:175]
    v_mul_f32 v196, s74, v196
    v_mul_f32 v197, s74, v197
    v_mfma_f32_16x16x32_bf16 a[176:179], a[32:35], v[40:43], a[176:179]
    ds_read_b128 v[72:75], v24 offset:24576
    v_mul_f32 v198, s74, v198
    v_mfma_f32_16x16x32_bf16 a[176:179], a[36:39], v[44:47], a[176:179]
    v_mul_f32 v199, s74, v199
    v_mul_f32 v228, s74, v228
    v_mfma_f32_16x16x32_bf16 a[180:183], a[40:43], v[40:43], a[180:183]
    v_mul_f32 v229, s74, v229
    v_mul_f32 v230, s74, v230
    v_mfma_f32_16x16x32_bf16 a[180:183], a[44:47], v[44:47], a[180:183]
    v_mul_f32 v231, s74, v231
    v_cvt_pk_bf16_f32 v196, v196, v197
    v_mfma_f32_16x16x32_bf16 a[184:187], a[48:51], v[40:43], a[184:187]
    v_cvt_pk_bf16_f32 v197, v198, v199
    v_cvt_pk_bf16_f32 v198, v228, v229
    v_mfma_f32_16x16x32_bf16 a[184:187], a[52:55], v[44:47], a[184:187]
    v_cvt_pk_bf16_f32 v199, v230, v231
    v_mul_f32 v200, s74, v200
    v_mfma_f32_16x16x32_bf16 a[188:191], a[56:59], v[40:43], a[188:191]
    buffer_load_dwordx4 v12, s[20:23], s64 offen offset:2048 lds
    v_mfma_f32_16x16x32_bf16 a[188:191], a[60:63], v[44:47], a[188:191]
    s_add_u32 s72, s70, 8192
    ds_read_b64_tr_b16 v[40:41], v14 offset:32768
    ds_read_b64_tr_b16 v[42:43], v14 offset:33792
    s_waitcnt lgkmcnt(2)
    v_mfma_f32_16x16x32_bf16 a[192:195], a[0:3], v[48:51], a[192:195]
    ds_read_b64_tr_b16 v[44:45], v14 offset:40960
    ds_read_b64_tr_b16 v[46:47], v14 offset:41984
    v_mfma_f32_16x16x32_bf16 a[192:195], a[4:7], v[52:55], a[192:195]
    v_xor_b32 v14, s73, v14
    v_add_u32 v14, 0x10000, v14
    v_mfma_f32_16x16x32_bf16 a[196:199], a[8:11], v[48:51], a[196:199]
    buffer_store_dwordx4 v[136:139], v1, s[36:39], s72 offen sc1
    v_mfma_f32_16x16x32_bf16 a[196:199], a[12:15], v[52:55], a[196:199]
    ds_read_b128 v[76:79], v25 offset:24576
    v_mul_f32 v201, s74, v201
    v_mfma_f32_16x16x32_bf16 a[200:203], a[16:19], v[48:51], a[200:203]
    v_mul_f32 v202, s74, v202
    v_mul_f32 v203, s74, v203
    v_mfma_f32_16x16x32_bf16 a[200:203], a[20:23], v[52:55], a[200:203]
    v_mul_f32 v232, s74, v232
    v_mul_f32 v233, s74, v233
    v_mfma_f32_16x16x32_bf16 a[204:207], a[24:27], v[48:51], a[204:207]
    v_mul_f32 v234, s74, v234
    v_mul_f32 v235, s74, v235
    v_mfma_f32_16x16x32_bf16 a[204:207], a[28:31], v[52:55], a[204:207]
    v_cvt_pk_bf16_f32 v200, v200, v201
    v_cvt_pk_bf16_f32 v201, v202, v203
    v_mfma_f32_16x16x32_bf16 a[208:211], a[32:35], v[48:51], a[208:211]
    buffer_load_dwordx4 v13, s[20:23], s64 offen offset:3072 lds
    v_mfma_f32_16x16x32_bf16 a[208:211], a[36:39], v[52:55], a[208:211]
    v_cvt_pk_bf16_f32 v202, v232, v233
    v_cvt_pk_bf16_f32 v203, v234, v235
    v_mfma_f32_16x16x32_bf16 a[212:215], a[40:43], v[48:51], a[212:215]
    v_mul_f32 v204, s74, v204
    v_mul_f32 v205, s74, v205
    v_mfma_f32_16x16x32_bf16 a[212:215], a[44:47], v[52:55], a[212:215]
    v_mul_f32 v206, s74, v206
    v_mul_f32 v207, s74, v207
    v_mfma_f32_16x16x32_bf16 a[216:219], a[48:51], v[48:51], a[216:219]
    v_mul_f32 v236, s74, v236
    v_mul_f32 v237, s74, v237
    v_mfma_f32_16x16x32_bf16 a[216:219], a[52:55], v[52:55], a[216:219]
    v_mul_f32 v238, s74, v238
    v_mul_f32 v239, s74, v239
    v_mfma_f32_16x16x32_bf16 a[220:223], a[56:59], v[48:51], a[220:223]
    ds_read_b64_tr_b16 v[48:49], v15 offset:32768
    ds_read_b64_tr_b16 v[50:51], v15 offset:33792
    v_mfma_f32_16x16x32_bf16 a[220:223], a[60:63], v[52:55], a[220:223]
    ds_read_b64_tr_b16 v[52:53], v15 offset:40960
    ds_read_b64_tr_b16 v[54:55], v15 offset:41984
    v_mfma_f32_16x16x32_bf16 a[224:227], a[0:3], v[56:59], a[224:227]
    v_xor_b32 v15, s73, v15
    v_add_u32 v15, 0x10000, v15
    v_mfma_f32_16x16x32_bf16 a[224:227], a[4:7], v[60:63], a[224:227]
    s_xor_b32 s64, s64, 384
    v_accvgpr_write_b32 a4, v192
    v_accvgpr_write_b32 a5, v193
    v_mfma_f32_16x16x32_bf16 a[228:231], a[8:11], v[56:59], a[228:231]
    v_accvgpr_write_b32 a6, v194
    v_accvgpr_write_b32 a7, v195
    v_mfma_f32_16x16x32_bf16 a[228:231], a[12:15], v[60:63], a[228:231]
    v_accvgpr_write_b32 a12, v196
    v_accvgpr_write_b32 a13, v197
    v_mfma_f32_16x16x32_bf16 a[232:235], a[16:19], v[56:59], a[232:235]
    v_accvgpr_write_b32 a14, v198
    v_accvgpr_write_b32 a15, v199
    v_mfma_f32_16x16x32_bf16 a[232:235], a[20:23], v[60:63], a[232:235]
    s_add_u32 m0, s69, 131072
    v_accvgpr_write_b32 a20, v200
    v_accvgpr_write_b32 a21, v201
    v_mfma_f32_16x16x32_bf16 a[236:239], a[24:27], v[56:59], a[236:239]
    buffer_load_dwordx4 v2, s[24:27], s60 offen lds
    v_mfma_f32_16x16x32_bf16 a[236:239], a[28:31], v[60:63], a[236:239]
    s_add_u32 s72, s70, 12288
    v_accvgpr_write_b32 a22, v202
    v_accvgpr_write_b32 a23, v203
    v_mfma_f32_16x16x32_bf16 a[240:243], a[32:35], v[56:59], a[240:243]
    buffer_store_dwordx4 v[140:143], v1, s[36:39], s72 offen sc1
    v_mfma_f32_16x16x32_bf16 a[240:243], a[36:39], v[60:63], a[240:243]
    v_cvt_pk_bf16_f32 v204, v204, v205
    v_cvt_pk_bf16_f32 v205, v206, v207
    v_mfma_f32_16x16x32_bf16 a[244:247], a[40:43], v[56:59], a[244:247]
    v_accvgpr_write_b32 a40, v148
    v_accvgpr_write_b32 a41, v149
    v_mfma_f32_16x16x32_bf16 a[244:247], a[44:47], v[60:63], a[244:247]
    v_accvgpr_write_b32 a42, v150
    v_accvgpr_write_b32 a43, v151
    v_mfma_f32_16x16x32_bf16 a[248:251], a[48:51], v[56:59], a[248:251]
    v_accvgpr_write_b32 a48, v152
    v_accvgpr_write_b32 a49, v153
    v_mfma_f32_16x16x32_bf16 a[248:251], a[52:55], v[60:63], a[248:251]
    buffer_load_dwordx4 v3, s[24:27], s60 offen offset:1024 lds
    v_mfma_f32_16x16x32_bf16 a[252:255], a[56:59], v[56:59], a[252:255]
    ds_read_b64_tr_b16 v[56:57], v16 offset:32768
    ds_read_b64_tr_b16 v[58:59], v16 offset:33792
    v_mfma_f32_16x16x32_bf16 a[252:255], a[60:63], v[60:63], a[252:255]
    s_waitcnt lgkmcnt(2)
    ds_read_b64_tr_b16 v[60:61], v16 offset:40960
    ds_read_b64_tr_b16 v[62:63], v16 offset:41984
    v_mfma_f32_16x16x32_bf16 a[128:131], a[64:67], v[40:43], a[128:131]
    v_xor_b32 v16, s73, v16
    v_add_u32 v16, 0x10000, v16
    v_mfma_f32_16x16x32_bf16 a[128:131], a[68:71], v[44:47], a[128:131]
    v_accvgpr_write_b32 a50, v154
    v_accvgpr_write_b32 a51, v155
    v_mfma_f32_16x16x32_bf16 a[132:135], a[72:75], v[40:43], a[132:135]
    ds_read_b128 v[80:83], v24 offset:49152
    v_accvgpr_write_b32 a56, v156
    v_mfma_f32_16x16x32_bf16 a[132:135], a[76:79], v[44:47], a[132:135]
    v_accvgpr_write_b32 a57, v157
    v_accvgpr_write_b32 a58, v158
    v_mfma_f32_16x16x32_bf16 a[136:139], a[80:83], v[40:43], a[136:139]
    v_accvgpr_write_b32 a59, v159
    v_cvt_pk_bf16_f32 v206, v236, v237
    v_mfma_f32_16x16x32_bf16 a[136:139], a[84:87], v[44:47], a[136:139]
    buffer_load_dwordx4 v4, s[24:27], s60 offen offset:2048 lds
    v_mfma_f32_16x16x32_bf16 a[140:143], a[88:91], v[40:43], a[140:143]
    v_cvt_pk_bf16_f32 v207, v238, v239
    v_mul_f32 v208, s74, v208
    v_mfma_f32_16x16x32_bf16 a[140:143], a[92:95], v[44:47], a[140:143]
    v_mul_f32 v209, s74, v209
    v_mul_f32 v210, s74, v210
    v_mfma_f32_16x16x32_bf16 a[144:147], a[96:99], v[40:43], a[144:147]
    v_mul_f32 v211, s74, v211
    v_mul_f32 v240, s74, v240
    v_mfma_f32_16x16x32_bf16 a[144:147], a[100:103], v[44:47], a[144:147]
    v_mul_f32 v241, s74, v241
    v_mul_f32 v242, s74, v242
    v_mfma_f32_16x16x32_bf16 a[148:151], a[104:107], v[40:43], a[148:151]
    v_mul_f32 v243, s74, v243
    v_accvgpr_write_b32 a28, v204
    v_mfma_f32_16x16x32_bf16 a[148:151], a[108:111], v[44:47], a[148:151]
    v_accvgpr_write_b32 a29, v205
    v_accvgpr_write_b32 a30, v206
    v_mfma_f32_16x16x32_bf16 a[152:155], a[112:115], v[40:43], a[152:155]
    buffer_load_dwordx4 v5, s[24:27], s60 offen offset:3072 lds
    v_mfma_f32_16x16x32_bf16 a[152:155], a[116:119], v[44:47], a[152:155]
    ds_read_b128 v[84:87], v25 offset:49152
    v_accvgpr_write_b32 a31, v207
    v_mfma_f32_16x16x32_bf16 a[156:159], a[120:123], v[40:43], a[156:159]
    ds_read_b64_tr_b16 v[40:41], v17 offset:32768
    ds_read_b64_tr_b16 v[42:43], v17 offset:33792
    v_mfma_f32_16x16x32_bf16 a[156:159], a[124:127], v[44:47], a[156:159]
    s_add_u32 s72, s70, 32768
    ds_read_b64_tr_b16 v[44:45], v17 offset:40960
    ds_read_b64_tr_b16 v[46:47], v17 offset:41984
    v_mfma_f32_16x16x32_bf16 a[160:163], a[64:67], v[48:51], a[160:163]
    v_xor_b32 v17, s73, v17
    v_add_u32 v17, 0x10000, v17
    v_mfma_f32_16x16x32_bf16 a[160:163], a[68:71], v[52:55], a[160:163]
    buffer_store_dwordx4 v[144:147], v1, s[36:39], s72 offen sc1
    v_mfma_f32_16x16x32_bf16 a[164:167], a[72:75], v[48:51], a[164:167]
    v_cvt_pk_bf16_f32 v208, v208, v209
    v_cvt_pk_bf16_f32 v209, v210, v211
    v_mfma_f32_16x16x32_bf16 a[164:167], a[76:79], v[52:55], a[164:167]
    s_add_u32 m0, s69, 147456
    v_cvt_pk_bf16_f32 v210, v240, v241
    v_cvt_pk_bf16_f32 v211, v242, v243
    v_mfma_f32_16x16x32_bf16 a[168:171], a[80:83], v[48:51], a[168:171]
    s_xor_b32 s60, s60, 1572864
    buffer_load_dwordx4 v10, s[20:23], s63 offen lds
    v_mfma_f32_16x16x32_bf16 a[168:171], a[84:87], v[52:55], a[168:171]
    v_mul_f32 v212, s74, v212
    v_mul_f32 v213, s74, v213
    v_mfma_f32_16x16x32_bf16 a[172:175], a[88:91], v[48:51], a[172:175]
    v_mul_f32 v214, s74, v214
    v_mul_f32 v215, s74, v215
    v_mfma_f32_16x16x32_bf16 a[172:175], a[92:95], v[52:55], a[172:175]
    v_mul_f32 v244, s74, v244
    v_mul_f32 v245, s74, v245
    v_mfma_f32_16x16x32_bf16 a[176:179], a[96:99], v[48:51], a[176:179]
    ds_read_b128 v[88:91], v24 offset:57344
    v_mul_f32 v246, s74, v246
    v_mfma_f32_16x16x32_bf16 a[176:179], a[100:103], v[52:55], a[176:179]
    v_mul_f32 v247, s74, v247
    v_accvgpr_write_b32 a36, v208
    v_mfma_f32_16x16x32_bf16 a[180:183], a[104:107], v[48:51], a[180:183]
    v_accvgpr_write_b32 a37, v209
    v_accvgpr_write_b32 a38, v210
    v_mfma_f32_16x16x32_bf16 a[180:183], a[108:111], v[52:55], a[180:183]
    buffer_load_dwordx4 v11, s[20:23], s63 offen offset:1024 lds
    v_mfma_f32_16x16x32_bf16 a[184:187], a[112:115], v[48:51], a[184:187]
    v_accvgpr_write_b32 a39, v211
    v_cvt_pk_bf16_f32 v212, v212, v213
    v_mfma_f32_16x16x32_bf16 a[184:187], a[116:119], v[52:55], a[184:187]
    v_cvt_pk_bf16_f32 v213, v214, v215
    v_cvt_pk_bf16_f32 v214, v244, v245
    v_mfma_f32_16x16x32_bf16 a[188:191], a[120:123], v[48:51], a[188:191]
    v_cvt_pk_bf16_f32 v215, v246, v247
    v_mul_f32 v216, s74, v216
    v_mfma_f32_16x16x32_bf16 a[188:191], a[124:127], v[52:55], a[188:191]
    s_waitcnt lgkmcnt(0)
    v_mul_f32 v217, s74, v217
    v_mul_f32 v218, s74, v218
    v_mfma_f32_16x16x32_bf16 a[192:195], a[64:67], v[56:59], a[192:195]
    v_mul_f32 v219, s74, v219
    v_mul_f32 v248, s74, v248
    v_mfma_f32_16x16x32_bf16 a[192:195], a[68:71], v[60:63], a[192:195]
    v_mul_f32 v249, s74, v249
    v_mul_f32 v250, s74, v250
    v_mfma_f32_16x16x32_bf16 a[196:199], a[72:75], v[56:59], a[196:199]
    v_mul_f32 v251, s74, v251
    v_accvgpr_write_b32 a44, v212
    v_mfma_f32_16x16x32_bf16 a[196:199], a[76:79], v[60:63], a[196:199]
    buffer_load_dwordx4 v12, s[20:23], s63 offen offset:2048 lds
    v_mfma_f32_16x16x32_bf16 a[200:203], a[80:83], v[56:59], a[200:203]
    ds_read_b128 v[92:95], v25 offset:57344
    v_accvgpr_write_b32 a45, v213
    v_mfma_f32_16x16x32_bf16 a[200:203], a[84:87], v[60:63], a[200:203]
    v_accvgpr_write_b32 a46, v214
    v_accvgpr_write_b32 a47, v215
    v_mfma_f32_16x16x32_bf16 a[204:207], a[88:91], v[56:59], a[204:207]
    v_cvt_pk_bf16_f32 v216, v216, v217
    v_cvt_pk_bf16_f32 v217, v218, v219
    v_mfma_f32_16x16x32_bf16 a[204:207], a[92:95], v[60:63], a[204:207]
    s_add_u32 s72, s70, 36864
    v_cvt_pk_bf16_f32 v218, v248, v249
    v_cvt_pk_bf16_f32 v219, v250, v251
    v_mfma_f32_16x16x32_bf16 a[208:211], a[96:99], v[56:59], a[208:211]
    buffer_store_dwordx4 a[40:43], v1, s[36:39], s72 offen sc1
    v_mfma_f32_16x16x32_bf16 a[208:211], a[100:103], v[60:63], a[208:211]
    v_mul_f32 v220, s74, v220
    v_mul_f32 v221, s74, v221
    v_mfma_f32_16x16x32_bf16 a[212:215], a[104:107], v[56:59], a[212:215]
    buffer_load_dwordx4 v13, s[20:23], s63 offen offset:3072 lds
    v_mfma_f32_16x16x32_bf16 a[212:215], a[108:111], v[60:63], a[212:215]
    v_mul_f32 v222, s74, v222
    v_mul_f32 v223, s74, v223
    v_mfma_f32_16x16x32_bf16 a[216:219], a[112:115], v[56:59], a[216:219]
    v_mul_f32 v252, s74, v252
    v_mul_f32 v253, s74, v253
    v_mfma_f32_16x16x32_bf16 a[216:219], a[116:119], v[60:63], a[216:219]
    v_mul_f32 v254, s74, v254
    v_mul_f32 v255, s74, v255
    v_mfma_f32_16x16x32_bf16 a[220:223], a[120:123], v[56:59], a[220:223]
    v_accvgpr_write_b32 a52, v216
    v_accvgpr_write_b32 a53, v217
    v_mfma_f32_16x16x32_bf16 a[220:223], a[124:127], v[60:63], a[220:223]
    v_accvgpr_write_b32 a54, v218
    v_accvgpr_write_b32 a55, v219
    v_mfma_f32_16x16x32_bf16 a[224:227], a[64:67], v[40:43], a[224:227]
    v_cvt_pk_bf16_f32 v220, v220, v221
    v_cvt_pk_bf16_f32 v221, v222, v223
    v_mfma_f32_16x16x32_bf16 a[224:227], a[68:71], v[44:47], a[224:227]
    s_xor_b32 s63, s63, 128
    v_cvt_pk_bf16_f32 v222, v252, v253
    v_cvt_pk_bf16_f32 v223, v254, v255
    v_mfma_f32_16x16x32_bf16 a[228:231], a[72:75], v[40:43], a[228:231]
    v_accvgpr_write_b32 a60, v220
    v_accvgpr_write_b32 a61, v221
    v_mfma_f32_16x16x32_bf16 a[228:231], a[76:79], v[44:47], a[228:231]
    v_accvgpr_write_b32 a62, v222
    v_accvgpr_write_b32 a63, v223
    v_mfma_f32_16x16x32_bf16 a[232:235], a[80:83], v[40:43], a[232:235]
    v_accvgpr_write_b32 a0, 0
    v_accvgpr_write_b32 a1, 0
    v_mfma_f32_16x16x32_bf16 a[232:235], a[84:87], v[44:47], a[232:235]
    s_waitcnt vmcnt(11) lgkmcnt(0)
    s_barrier
    ds_read_b64_tr_b16 v[48:49], v14 offset:0
    v_mfma_f32_16x16x32_bf16 a[236:239], a[88:91], v[40:43], a[236:239]
    s_add_u32 m0, s67, 0
    ds_read_b64_tr_b16 v[50:51], v14 offset:1024
    ds_read_b64_tr_b16 v[52:53], v14 offset:8192
    v_mfma_f32_16x16x32_bf16 a[236:239], a[92:95], v[44:47], a[236:239]
    buffer_load_dwordx4 v1, s[28:31], s65 offen sc1 lds
    v_mfma_f32_16x16x32_bf16 a[240:243], a[96:99], v[40:43], a[240:243]
    ds_read_b64_tr_b16 v[54:55], v14 offset:9216
    ds_read_b64_tr_b16 v[56:57], v15 offset:0
    v_mfma_f32_16x16x32_bf16 a[240:243], a[100:103], v[44:47], a[240:243]
    ds_read_b64_tr_b16 v[58:59], v15 offset:1024
    ds_read_b64_tr_b16 v[60:61], v15 offset:8192
    v_mfma_f32_16x16x32_bf16 a[244:247], a[104:107], v[40:43], a[244:247]
    ds_read_b64_tr_b16 v[62:63], v15 offset:9216
    v_add_u32 v14, 0x10000, v14
    v_mfma_f32_16x16x32_bf16 a[244:247], a[108:111], v[44:47], a[244:247]
    v_add_u32 v15, 0x10000, v15
    v_accvgpr_write_b32 a2, 0
    v_mfma_f32_16x16x32_bf16 a[248:251], a[112:115], v[40:43], a[248:251]
    v_accvgpr_write_b32 a3, 0
    v_accvgpr_write_b32 a8, 0
    v_mfma_f32_16x16x32_bf16 a[248:251], a[116:119], v[44:47], a[248:251]
    v_accvgpr_write_b32 a9, 0
    v_accvgpr_write_b32 a10, 0
    v_mfma_f32_16x16x32_bf16 a[252:255], a[120:123], v[40:43], a[252:255]
    ds_read_b64_tr_b16 v[40:41], v16 offset:0
    ds_read_b64_tr_b16 v[42:43], v16 offset:1024
    v_mfma_f32_16x16x32_bf16 a[252:255], a[124:127], v[44:47], a[252:255]
    s_add_u32 s72, s70, 40960
    ds_read_b64_tr_b16 v[44:45], v16 offset:8192
    ds_read_b64_tr_b16 v[46:47], v16 offset:9216
    s_waitcnt lgkmcnt(4)
    v_mfma_f32_16x16x32_bf16 v[128:131], v[48:51], v[64:67], 0
    buffer_load_dwordx4 v1, s[28:31], s65 offen offset:1024 sc1 lds
    v_mfma_f32_16x16x32_bf16 v[128:131], v[52:55], v[68:71], v[128:131]
    v_add_u32 v24, 0x10000, v24
    v_add_u32 v16, 0x10000, v16
    v_mfma_f32_16x16x32_bf16 v[132:135], v[48:51], v[72:75], 0
    ds_read_b128 v[96:99], v24 offset:16384
    v_accvgpr_write_b32 a11, 0
    v_mfma_f32_16x16x32_bf16 v[132:135], v[52:55], v[76:79], v[132:135]
    buffer_store_dwordx4 a[48:51], v1, s[36:39], s72 offen sc1
    v_mfma_f32_16x16x32_bf16 v[136:139], v[48:51], v[80:83], 0
    v_accvgpr_write_b32 a16, 0
    v_accvgpr_write_b32 a17, 0
    v_mfma_f32_16x16x32_bf16 v[136:139], v[52:55], v[84:87], v[136:139]
    v_accvgpr_write_b32 a18, 0
    v_accvgpr_write_b32 a19, 0
    v_mfma_f32_16x16x32_bf16 v[140:143], v[48:51], v[88:91], 0
    ds_read_b64_tr_b16 v[48:49], v17 offset:0
    ds_read_b64_tr_b16 v[50:51], v17 offset:1024
    v_mfma_f32_16x16x32_bf16 v[140:143], v[52:55], v[92:95], v[140:143]
    ds_read_b64_tr_b16 v[52:53], v17 offset:8192
    ds_read_b64_tr_b16 v[54:55], v17 offset:9216
    v_mfma_f32_16x16x32_bf16 v[144:147], v[56:59], v[64:67], 0
    v_add_u32 v17, 0x10000, v17
    v_accvgpr_write_b32 a24, 0
    v_mfma_f32_16x16x32_bf16 v[144:147], v[60:63], v[68:71], v[144:147]
    s_add_u32 m0, s69, 16384
    v_accvgpr_write_b32 a25, 0
    v_accvgpr_write_b32 a26, 0
    v_mfma_f32_16x16x32_bf16 v[148:151], v[56:59], v[72:75], 0
    s_xor_b32 s65, s65, 24576
    buffer_load_dwordx4 v10, s[20:23], s64 offen lds
    v_mfma_f32_16x16x32_bf16 v[148:151], v[60:63], v[76:79], v[148:151]
    v_accvgpr_write_b32 a27, 0
    v_accvgpr_write_b32 a32, 0
    v_mfma_f32_16x16x32_bf16 v[152:155], v[56:59], v[80:83], 0
    v_add_u32 v25, 0x10000, v25
    v_accvgpr_write_b32 a33, 0
    v_mfma_f32_16x16x32_bf16 v[152:155], v[60:63], v[84:87], v[152:155]
    ds_read_b128 v[100:103], v25 offset:16384
    v_accvgpr_write_b32 a34, 0
    v_mfma_f32_16x16x32_bf16 v[156:159], v[56:59], v[88:91], 0
    ds_read_b64_tr_b16 v[56:57], v18 offset:0
    ds_read_b64_tr_b16 v[58:59], v18 offset:1024
    v_mfma_f32_16x16x32_bf16 v[156:159], v[60:63], v[92:95], v[156:159]
    s_waitcnt lgkmcnt(3)
    ds_read_b64_tr_b16 v[60:61], v18 offset:8192
    ds_read_b64_tr_b16 v[62:63], v18 offset:9216
    v_mfma_f32_16x16x32_bf16 v[160:163], v[40:43], v[64:67], 0
    v_add_u32 v18, 0x10000, v18
    v_accvgpr_write_b32 a35, 0
    v_mfma_f32_16x16x32_bf16 v[160:163], v[44:47], v[68:71], v[160:163]
    v_accvgpr_write_b32 a40, 0
    v_accvgpr_write_b32 a41, 0
    v_mfma_f32_16x16x32_bf16 v[164:167], v[40:43], v[72:75], 0
    v_accvgpr_write_b32 a42, 0
    v_accvgpr_write_b32 a43, 0
    v_mfma_f32_16x16x32_bf16 v[164:167], v[44:47], v[76:79], v[164:167]
    v_accvgpr_write_b32 a48, 0
    v_accvgpr_write_b32 a49, 0
    v_mfma_f32_16x16x32_bf16 v[168:171], v[40:43], v[80:83], 0
    buffer_load_dwordx4 v11, s[20:23], s64 offen offset:1024 lds
    v_mfma_f32_16x16x32_bf16 v[168:171], v[44:47], v[84:87], v[168:171]
    v_accvgpr_write_b32 a50, 0
    v_accvgpr_write_b32 a51, 0
    v_mfma_f32_16x16x32_bf16 v[172:175], v[40:43], v[88:91], 0
    ds_read_b64_tr_b16 v[40:41], v19 offset:0
    ds_read_b64_tr_b16 v[42:43], v19 offset:1024
    v_mfma_f32_16x16x32_bf16 v[172:175], v[44:47], v[92:95], v[172:175]
    s_add_u32 s72, s70, 45056
    ds_read_b64_tr_b16 v[44:45], v19 offset:8192
    ds_read_b64_tr_b16 v[46:47], v19 offset:9216
    v_mfma_f32_16x16x32_bf16 v[176:179], v[48:51], v[64:67], 0
    ds_read_b128 v[104:107], v24 offset:24576
    v_add_u32 v19, 0x10000, v19
    v_mfma_f32_16x16x32_bf16 v[176:179], v[52:55], v[68:71], v[176:179]
    buffer_store_dwordx4 a[56:59], v1, s[36:39], s72 offen sc1
    v_mfma_f32_16x16x32_bf16 v[180:183], v[48:51], v[72:75], 0
    v_mfma_f32_16x16x32_bf16 v[180:183], v[52:55], v[76:79], v[180:183]
    v_accvgpr_write_b32 a56, 0
    v_accvgpr_write_b32 a57, 0
    v_mfma_f32_16x16x32_bf16 v[184:187], v[48:51], v[80:83], 0
    v_accvgpr_write_b32 a58, 0
    v_accvgpr_write_b32 a59, 0
    v_mfma_f32_16x16x32_bf16 v[184:187], v[52:55], v[84:87], v[184:187]
    v_mfma_f32_16x16x32_bf16 v[188:191], v[48:51], v[88:91], 0
    buffer_load_dwordx4 v12, s[20:23], s64 offen offset:2048 lds
    v_mfma_f32_16x16x32_bf16 v[188:191], v[52:55], v[92:95], v[188:191]
    s_waitcnt lgkmcnt(0)
    ds_read_b64_tr_b16 v[48:49], v20 offset:0
    ds_read_b64_tr_b16 v[50:51], v20 offset:1024
    v_mfma_f32_16x16x32_bf16 v[192:195], v[56:59], v[64:67], 0
    ds_read_b64_tr_b16 v[52:53], v20 offset:8192
    ds_read_b64_tr_b16 v[54:55], v20 offset:9216
    v_mfma_f32_16x16x32_bf16 v[192:195], v[60:63], v[68:71], v[192:195]
    v_add_u32 v20, 0x10000, v20
    v_mfma_f32_16x16x32_bf16 v[196:199], v[56:59], v[72:75], 0
    v_mfma_f32_16x16x32_bf16 v[196:199], v[60:63], v[76:79], v[196:199]
    ds_read_b128 v[108:111], v25 offset:24576
    v_mfma_f32_16x16x32_bf16 v[200:203], v[56:59], v[80:83], 0
    v_mfma_f32_16x16x32_bf16 v[200:203], v[60:63], v[84:87], v[200:203]
    v_mfma_f32_16x16x32_bf16 v[204:207], v[56:59], v[88:91], 0
    ds_read_b64_tr_b16 v[56:57], v21 offset:0
    ds_read_b64_tr_b16 v[58:59], v21 offset:1024
    v_mfma_f32_16x16x32_bf16 v[204:207], v[60:63], v[92:95], v[204:207]
    ds_read_b64_tr_b16 v[60:61], v21 offset:8192
    ds_read_b64_tr_b16 v[62:63], v21 offset:9216
    v_mfma_f32_16x16x32_bf16 v[208:211], v[40:43], v[64:67], 0
    buffer_load_dwordx4 v13, s[20:23], s64 offen offset:3072 lds
    v_mfma_f32_16x16x32_bf16 v[208:211], v[44:47], v[68:71], v[208:211]
    v_add_u32 v21, 0x10000, v21
    v_mfma_f32_16x16x32_bf16 v[212:215], v[40:43], v[72:75], 0
    v_mfma_f32_16x16x32_bf16 v[212:215], v[44:47], v[76:79], v[212:215]
    v_mfma_f32_16x16x32_bf16 v[216:219], v[40:43], v[80:83], 0
    v_mfma_f32_16x16x32_bf16 v[216:219], v[44:47], v[84:87], v[216:219]
    v_mfma_f32_16x16x32_bf16 v[220:223], v[40:43], v[88:91], 0
    ds_read_b64_tr_b16 v[40:41], v26 offset:32768
    ds_read_b64_tr_b16 v[42:43], v26 offset:33280
    v_mfma_f32_16x16x32_bf16 v[220:223], v[44:47], v[92:95], v[220:223]
    s_add_u32 s72, s70, 1024
    ds_read_b64_tr_b16 v[44:45], v26 offset:36864
    ds_read_b64_tr_b16 v[46:47], v26 offset:37376
    s_waitcnt lgkmcnt(4)
    v_mfma_f32_16x16x32_bf16 v[224:227], v[48:51], v[64:67], 0
    buffer_store_dwordx4 a[4:7], v1, s[36:39], s72 offen sc1
    v_mfma_f32_16x16x32_bf16 v[224:227], v[52:55], v[68:71], v[224:227]
    s_xor_b32 s64, s64, 128
    v_add_u32 v26, 0xffff0000, v26
    v_accvgpr_write_b32 a4, 0
    v_mfma_f32_16x16x32_bf16 v[228:231], v[48:51], v[72:75], 0
    v_accvgpr_write_b32 a5, 0
    v_accvgpr_write_b32 a6, 0
    v_mfma_f32_16x16x32_bf16 v[228:231], v[52:55], v[76:79], v[228:231]
    v_accvgpr_write_b32 a7, 0
    v_mfma_f32_16x16x32_bf16 v[232:235], v[48:51], v[80:83], 0
    v_mfma_f32_16x16x32_bf16 v[232:235], v[52:55], v[84:87], v[232:235]
    s_add_u32 m0, s69, 32768
    v_mfma_f32_16x16x32_bf16 v[236:239], v[48:51], v[88:91], 0
    buffer_load_dwordx4 v2, s[24:27], s60 offen lds
    v_mfma_f32_16x16x32_bf16 v[236:239], v[52:55], v[92:95], v[236:239]
    ds_read_b64_tr_b16 v[48:49], v27 offset:32768
    ds_read_b64_tr_b16 v[50:51], v27 offset:33280
    v_mfma_f32_16x16x32_bf16 v[240:243], v[56:59], v[64:67], 0
    ds_read_b64_tr_b16 v[52:53], v27 offset:36864
    ds_read_b64_tr_b16 v[54:55], v27 offset:37376
    v_mfma_f32_16x16x32_bf16 v[240:243], v[60:63], v[68:71], v[240:243]
    buffer_load_dwordx4 v3, s[24:27], s60 offen offset:1024 lds
    v_mfma_f32_16x16x32_bf16 v[244:247], v[56:59], v[72:75], 0
    v_add_u32 v27, 0xffff0000, v27
    v_mfma_f32_16x16x32_bf16 v[244:247], v[60:63], v[76:79], v[244:247]
    v_mfma_f32_16x16x32_bf16 v[248:251], v[56:59], v[80:83], 0
    v_mfma_f32_16x16x32_bf16 v[248:251], v[60:63], v[84:87], v[248:251]
    buffer_load_dwordx4 v4, s[24:27], s60 offen offset:2048 lds
    v_mfma_f32_16x16x32_bf16 v[252:255], v[56:59], v[88:91], 0
    ds_read_b64_tr_b16 v[56:57], v28 offset:32768
    ds_read_b64_tr_b16 v[58:59], v28 offset:33280
    v_mfma_f32_16x16x32_bf16 v[252:255], v[60:63], v[92:95], v[252:255]
    s_waitcnt lgkmcnt(2)
    ds_read_b64_tr_b16 v[60:61], v28 offset:36864
    ds_read_b64_tr_b16 v[62:63], v28 offset:37376
    v_mfma_f32_16x16x32_bf16 a[64:67], v[40:43], v[64:67], 0
    buffer_load_dwordx4 v5, s[24:27], s60 offen offset:3072 lds
    v_mfma_f32_16x16x32_bf16 a[64:67], v[44:47], v[68:71], a[64:67]
    v_add_u32 v28, 0xffff0000, v28
    v_mfma_f32_16x16x32_bf16 a[68:71], v[40:43], v[72:75], 0
    ds_read_b128 v[112:115], v24 offset:49152
    v_mfma_f32_16x16x32_bf16 a[68:71], v[44:47], v[76:79], a[68:71]
    s_add_u32 m0, s69, 49152
    v_mfma_f32_16x16x32_bf16 a[72:75], v[40:43], v[80:83], 0
    s_xor_b32 s60, s60, 524288
    buffer_load_dwordx4 v10, s[20:23], s63 offen lds
    v_mfma_f32_16x16x32_bf16 a[72:75], v[44:47], v[84:87], a[72:75]
    ds_read_b128 v[116:119], v25 offset:49152
    v_mfma_f32_16x16x32_bf16 a[76:79], v[40:43], v[88:91], 0
    ds_read_b64_tr_b16 v[40:41], v29 offset:32768
    ds_read_b64_tr_b16 v[42:43], v29 offset:33280
    v_mfma_f32_16x16x32_bf16 a[76:79], v[44:47], v[92:95], a[76:79]
    s_add_u32 s72, s70, 5120
    buffer_load_dwordx4 v11, s[20:23], s63 offen offset:1024 lds
    v_mfma_f32_16x16x32_bf16 a[80:83], v[48:51], v[64:67], 0
    ds_read_b128 v[120:123], v24 offset:57344
    ds_read_b64_tr_b16 v[44:45], v29 offset:36864
    v_mfma_f32_16x16x32_bf16 a[80:83], v[52:55], v[68:71], a[80:83]
    ds_read_b64_tr_b16 v[46:47], v29 offset:37376
    v_add_u32 v29, 0xffff0000, v29
    v_mfma_f32_16x16x32_bf16 a[84:87], v[48:51], v[72:75], 0
    buffer_store_dwordx4 a[12:15], v1, s[36:39], s72 offen sc1
    v_mfma_f32_16x16x32_bf16 a[84:87], v[52:55], v[76:79], a[84:87]
    ds_read_b128 v[124:127], v25 offset:57344
    v_accvgpr_write_b32 a12, 0
    v_mfma_f32_16x16x32_bf16 a[88:91], v[48:51], v[80:83], 0
    v_accvgpr_write_b32 a13, 0
    v_accvgpr_write_b32 a14, 0
    v_mfma_f32_16x16x32_bf16 a[88:91], v[52:55], v[84:87], a[88:91]
    v_accvgpr_write_b32 a15, 0
    v_mfma_f32_16x16x32_bf16 a[92:95], v[48:51], v[88:91], 0
    buffer_load_dwordx4 v12, s[20:23], s63 offen offset:2048 lds
    v_mfma_f32_16x16x32_bf16 a[92:95], v[52:55], v[92:95], a[92:95]
    s_waitcnt lgkmcnt(1)
    v_mfma_f32_16x16x32_bf16 a[96:99], v[56:59], v[64:67], 0
    v_mfma_f32_16x16x32_bf16 a[96:99], v[60:63], v[68:71], a[96:99]
    v_mfma_f32_16x16x32_bf16 a[100:103], v[56:59], v[72:75], 0
    buffer_load_dwordx4 v13, s[20:23], s63 offen offset:3072 lds
    v_mfma_f32_16x16x32_bf16 a[100:103], v[60:63], v[76:79], a[100:103]
    s_xor_b32 s63, s63, 896
    v_mfma_f32_16x16x32_bf16 a[104:107], v[56:59], v[80:83], 0
    v_mfma_f32_16x16x32_bf16 a[104:107], v[60:63], v[84:87], a[104:107]
    s_waitcnt vmcnt(10) lgkmcnt(0)
    s_barrier
    ds_read_b64_tr_b16 v[48:49], v14 offset:0
    v_mfma_f32_16x16x32_bf16 a[108:111], v[56:59], v[88:91], 0
    s_add_u32 m0, s67, 65536
    ds_read_b64_tr_b16 v[50:51], v14 offset:1024
    ds_read_b64_tr_b16 v[52:53], v14 offset:8192
    v_mfma_f32_16x16x32_bf16 a[108:111], v[60:63], v[92:95], a[108:111]
    buffer_load_dwordx4 v1, s[28:31], s65 offen sc1 lds
    v_mfma_f32_16x16x32_bf16 a[112:115], v[40:43], v[64:67], 0
    ds_read_b64_tr_b16 v[54:55], v14 offset:9216
    ds_read_b64_tr_b16 v[56:57], v15 offset:0
    v_mfma_f32_16x16x32_bf16 a[112:115], v[44:47], v[68:71], a[112:115]
    ds_read_b64_tr_b16 v[58:59], v15 offset:1024
    ds_read_b64_tr_b16 v[60:61], v15 offset:8192
    v_mfma_f32_16x16x32_bf16 a[116:119], v[40:43], v[72:75], 0
    ds_read_b64_tr_b16 v[62:63], v15 offset:9216
    v_add_u32 v14, 0xfffe0000, v14
    v_mfma_f32_16x16x32_bf16 a[116:119], v[44:47], v[76:79], a[116:119]
    v_add_u32 v15, 0xfffe0000, v15
    v_mfma_f32_16x16x32_bf16 a[120:123], v[40:43], v[80:83], 0
    v_mfma_f32_16x16x32_bf16 a[120:123], v[44:47], v[84:87], a[120:123]
    v_mfma_f32_16x16x32_bf16 a[124:127], v[40:43], v[88:91], 0
    ds_read_b64_tr_b16 v[40:41], v16 offset:0
    ds_read_b64_tr_b16 v[42:43], v16 offset:1024
    v_mfma_f32_16x16x32_bf16 a[124:127], v[44:47], v[92:95], a[124:127]
    s_add_u32 s72, s70, 9216
    ds_read_b64_tr_b16 v[44:45], v16 offset:8192
    ds_read_b64_tr_b16 v[46:47], v16 offset:9216
    s_waitcnt lgkmcnt(4)
    v_mfma_f32_16x16x32_bf16 v[128:131], v[48:51], v[96:99], v[128:131]
    buffer_load_dwordx4 v1, s[28:31], s65 offen offset:1024 sc1 lds
    v_mfma_f32_16x16x32_bf16 v[128:131], v[52:55], v[100:103], v[128:131]
    v_add_u32 v24, 0x10000, v24
    v_add_u32 v16, 0xfffe0000, v16
    v_mfma_f32_16x16x32_bf16 v[132:135], v[48:51], v[104:107], v[132:135]
    buffer_store_dwordx4 a[20:23], v1, s[36:39], s72 offen sc1
    v_mfma_f32_16x16x32_bf16 v[132:135], v[52:55], v[108:111], v[132:135]
    ds_read_b128 v[64:67], v24 offset:16384
    v_accvgpr_write_b32 a20, 0
    v_mfma_f32_16x16x32_bf16 v[136:139], v[48:51], v[112:115], v[136:139]
    v_accvgpr_write_b32 a21, 0
    v_accvgpr_write_b32 a22, 0
    v_mfma_f32_16x16x32_bf16 v[136:139], v[52:55], v[116:119], v[136:139]
    v_accvgpr_write_b32 a23, 0
    v_mfma_f32_16x16x32_bf16 v[140:143], v[48:51], v[120:123], v[140:143]
    ds_read_b64_tr_b16 v[48:49], v17 offset:0
    ds_read_b64_tr_b16 v[50:51], v17 offset:1024
    v_mfma_f32_16x16x32_bf16 v[140:143], v[52:55], v[124:127], v[140:143]
    ds_read_b64_tr_b16 v[52:53], v17 offset:8192
    ds_read_b64_tr_b16 v[54:55], v17 offset:9216
    v_mfma_f32_16x16x32_bf16 v[144:147], v[56:59], v[96:99], v[144:147]
    v_add_u32 v17, 0xfffe0000, v17
    v_mfma_f32_16x16x32_bf16 v[144:147], v[60:63], v[100:103], v[144:147]
    s_add_u32 m0, s69, 81920
    v_mfma_f32_16x16x32_bf16 v[148:151], v[56:59], v[104:107], v[148:151]
    s_xor_b32 s65, s65, 8192
    buffer_load_dwordx4 v10, s[20:23], s64 offen lds
    v_mfma_f32_16x16x32_bf16 v[148:151], v[60:63], v[108:111], v[148:151]
    v_mfma_f32_16x16x32_bf16 v[152:155], v[56:59], v[112:115], v[152:155]
    v_add_u32 v25, 0x10000, v25
    v_mfma_f32_16x16x32_bf16 v[152:155], v[60:63], v[116:119], v[152:155]
    ds_read_b128 v[68:71], v25 offset:16384
    v_mfma_f32_16x16x32_bf16 v[156:159], v[56:59], v[120:123], v[156:159]
    ds_read_b64_tr_b16 v[56:57], v18 offset:0
    ds_read_b64_tr_b16 v[58:59], v18 offset:1024
    v_mfma_f32_16x16x32_bf16 v[156:159], v[60:63], v[124:127], v[156:159]
    s_waitcnt lgkmcnt(3)
    ds_read_b64_tr_b16 v[60:61], v18 offset:8192
    ds_read_b64_tr_b16 v[62:63], v18 offset:9216
    v_mfma_f32_16x16x32_bf16 v[160:163], v[40:43], v[96:99], v[160:163]
    v_add_u32 v18, 0xfffe0000, v18
    v_mfma_f32_16x16x32_bf16 v[160:163], v[44:47], v[100:103], v[160:163]
    v_mfma_f32_16x16x32_bf16 v[164:167], v[40:43], v[104:107], v[164:167]
    v_mfma_f32_16x16x32_bf16 v[164:167], v[44:47], v[108:111], v[164:167]
    v_mfma_f32_16x16x32_bf16 v[168:171], v[40:43], v[112:115], v[168:171]
    buffer_load_dwordx4 v11, s[20:23], s64 offen offset:1024 lds
    v_mfma_f32_16x16x32_bf16 v[168:171], v[44:47], v[116:119], v[168:171]
    v_mfma_f32_16x16x32_bf16 v[172:175], v[40:43], v[120:123], v[172:175]
    ds_read_b64_tr_b16 v[40:41], v19 offset:0
    ds_read_b64_tr_b16 v[42:43], v19 offset:1024
    v_mfma_f32_16x16x32_bf16 v[172:175], v[44:47], v[124:127], v[172:175]
    s_add_u32 s72, s70, 13312
    ds_read_b64_tr_b16 v[44:45], v19 offset:8192
    ds_read_b64_tr_b16 v[46:47], v19 offset:9216
    v_mfma_f32_16x16x32_bf16 v[176:179], v[48:51], v[96:99], v[176:179]
    ds_read_b128 v[72:75], v24 offset:24576
    v_add_u32 v19, 0xfffe0000, v19
    v_mfma_f32_16x16x32_bf16 v[176:179], v[52:55], v[100:103], v[176:179]
    buffer_store_dwordx4 a[28:31], v1, s[36:39], s72 offen sc1
    v_mfma_f32_16x16x32_bf16 v[180:183], v[48:51], v[104:107], v[180:183]
    v_mfma_f32_16x16x32_bf16 v[180:183], v[52:55], v[108:111], v[180:183]
    v_accvgpr_write_b32 a28, 0
    v_accvgpr_write_b32 a29, 0
    v_mfma_f32_16x16x32_bf16 v[184:187], v[48:51], v[112:115], v[184:187]
    v_accvgpr_write_b32 a30, 0
    v_accvgpr_write_b32 a31, 0
    v_mfma_f32_16x16x32_bf16 v[184:187], v[52:55], v[116:119], v[184:187]
    v_mfma_f32_16x16x32_bf16 v[188:191], v[48:51], v[120:123], v[188:191]
    buffer_load_dwordx4 v12, s[20:23], s64 offen offset:2048 lds
    v_mfma_f32_16x16x32_bf16 v[188:191], v[52:55], v[124:127], v[188:191]
    s_waitcnt lgkmcnt(0)
    ds_read_b64_tr_b16 v[48:49], v20 offset:0
    ds_read_b64_tr_b16 v[50:51], v20 offset:1024
    v_mfma_f32_16x16x32_bf16 v[192:195], v[56:59], v[96:99], v[192:195]
    ds_read_b64_tr_b16 v[52:53], v20 offset:8192
    ds_read_b64_tr_b16 v[54:55], v20 offset:9216
    v_mfma_f32_16x16x32_bf16 v[192:195], v[60:63], v[100:103], v[192:195]
    v_add_u32 v20, 0xfffe0000, v20
    v_mfma_f32_16x16x32_bf16 v[196:199], v[56:59], v[104:107], v[196:199]
    v_mfma_f32_16x16x32_bf16 v[196:199], v[60:63], v[108:111], v[196:199]
    ds_read_b128 v[76:79], v25 offset:24576
    v_mfma_f32_16x16x32_bf16 v[200:203], v[56:59], v[112:115], v[200:203]
    v_mfma_f32_16x16x32_bf16 v[200:203], v[60:63], v[116:119], v[200:203]
    v_mfma_f32_16x16x32_bf16 v[204:207], v[56:59], v[120:123], v[204:207]
    ds_read_b64_tr_b16 v[56:57], v21 offset:0
    ds_read_b64_tr_b16 v[58:59], v21 offset:1024
    v_mfma_f32_16x16x32_bf16 v[204:207], v[60:63], v[124:127], v[204:207]
    ds_read_b64_tr_b16 v[60:61], v21 offset:8192
    ds_read_b64_tr_b16 v[62:63], v21 offset:9216
    v_mfma_f32_16x16x32_bf16 v[208:211], v[40:43], v[96:99], v[208:211]
    buffer_load_dwordx4 v13, s[20:23], s64 offen offset:3072 lds
    v_mfma_f32_16x16x32_bf16 v[208:211], v[44:47], v[100:103], v[208:211]
    v_add_u32 v21, 0xfffe0000, v21
    v_mfma_f32_16x16x32_bf16 v[212:215], v[40:43], v[104:107], v[212:215]
    v_mfma_f32_16x16x32_bf16 v[212:215], v[44:47], v[108:111], v[212:215]
    v_mfma_f32_16x16x32_bf16 v[216:219], v[40:43], v[112:115], v[216:219]
    v_mfma_f32_16x16x32_bf16 v[216:219], v[44:47], v[116:119], v[216:219]
    v_mfma_f32_16x16x32_bf16 v[220:223], v[40:43], v[120:123], v[220:223]
    ds_read_b64_tr_b16 v[40:41], v26 offset:0
    ds_read_b64_tr_b16 v[42:43], v26 offset:512
    v_mfma_f32_16x16x32_bf16 v[220:223], v[44:47], v[124:127], v[220:223]
    s_add_u32 s72, s70, 33792
    ds_read_b64_tr_b16 v[44:45], v26 offset:4096
    ds_read_b64_tr_b16 v[46:47], v26 offset:4608
    s_waitcnt lgkmcnt(4)
    v_mfma_f32_16x16x32_bf16 v[224:227], v[48:51], v[96:99], v[224:227]
    buffer_store_dwordx4 a[36:39], v1, s[36:39], s72 offen sc1
    v_mfma_f32_16x16x32_bf16 v[224:227], v[52:55], v[100:103], v[224:227]
    s_xor_b32 s64, s64, 896
    v_add_u32 v26, 0x10000, v26
    v_accvgpr_write_b32 a36, 0
    v_mfma_f32_16x16x32_bf16 v[228:231], v[48:51], v[104:107], v[228:231]
    v_accvgpr_write_b32 a37, 0
    v_accvgpr_write_b32 a38, 0
    v_mfma_f32_16x16x32_bf16 v[228:231], v[52:55], v[108:111], v[228:231]
    v_accvgpr_write_b32 a39, 0
    v_mfma_f32_16x16x32_bf16 v[232:235], v[48:51], v[112:115], v[232:235]
    v_mfma_f32_16x16x32_bf16 v[232:235], v[52:55], v[116:119], v[232:235]
    s_add_u32 m0, s69, 98304
    v_mfma_f32_16x16x32_bf16 v[236:239], v[48:51], v[120:123], v[236:239]
    buffer_load_dwordx4 v2, s[24:27], s60 offen lds
    v_mfma_f32_16x16x32_bf16 v[236:239], v[52:55], v[124:127], v[236:239]
    ds_read_b64_tr_b16 v[48:49], v27 offset:0
    ds_read_b64_tr_b16 v[50:51], v27 offset:512
    v_mfma_f32_16x16x32_bf16 v[240:243], v[56:59], v[96:99], v[240:243]
    ds_read_b64_tr_b16 v[52:53], v27 offset:4096
    ds_read_b64_tr_b16 v[54:55], v27 offset:4608
    v_mfma_f32_16x16x32_bf16 v[240:243], v[60:63], v[100:103], v[240:243]
    buffer_load_dwordx4 v3, s[24:27], s60 offen offset:1024 lds
    v_mfma_f32_16x16x32_bf16 v[244:247], v[56:59], v[104:107], v[244:247]
    v_add_u32 v27, 0x10000, v27
    v_mfma_f32_16x16x32_bf16 v[244:247], v[60:63], v[108:111], v[244:247]
    v_mfma_f32_16x16x32_bf16 v[248:251], v[56:59], v[112:115], v[248:251]
    v_mfma_f32_16x16x32_bf16 v[248:251], v[60:63], v[116:119], v[248:251]
    buffer_load_dwordx4 v4, s[24:27], s60 offen offset:2048 lds
    v_mfma_f32_16x16x32_bf16 v[252:255], v[56:59], v[120:123], v[252:255]
    ds_read_b64_tr_b16 v[56:57], v28 offset:0
    ds_read_b64_tr_b16 v[58:59], v28 offset:512
    v_mfma_f32_16x16x32_bf16 v[252:255], v[60:63], v[124:127], v[252:255]
    s_waitcnt lgkmcnt(2)
    ds_read_b64_tr_b16 v[60:61], v28 offset:4096
    ds_read_b64_tr_b16 v[62:63], v28 offset:4608
    v_mfma_f32_16x16x32_bf16 a[64:67], v[40:43], v[96:99], a[64:67]
    buffer_load_dwordx4 v5, s[24:27], s60 offen offset:3072 lds
    v_mfma_f32_16x16x32_bf16 a[64:67], v[44:47], v[100:103], a[64:67]
    v_add_u32 v24, 0xfffe0000, v24
    v_add_u32 v28, 0x10000, v28
    v_mfma_f32_16x16x32_bf16 a[68:71], v[40:43], v[104:107], a[68:71]
    ds_read_b128 v[80:83], v24 offset:16384
    v_mfma_f32_16x16x32_bf16 a[68:71], v[44:47], v[108:111], a[68:71]
    s_add_u32 m0, s69, 114688
    v_mfma_f32_16x16x32_bf16 a[72:75], v[40:43], v[112:115], a[72:75]
    s_xor_b32 s60, s60, 3670016
    buffer_load_dwordx4 v10, s[20:23], s63 offen lds
    v_mfma_f32_16x16x32_bf16 a[72:75], v[44:47], v[116:119], a[72:75]
    v_add_u32 v25, 0xfffe0000, v25
    ds_read_b128 v[84:87], v25 offset:16384
    v_mfma_f32_16x16x32_bf16 a[76:79], v[40:43], v[120:123], a[76:79]
    ds_read_b64_tr_b16 v[40:41], v29 offset:0
    ds_read_b64_tr_b16 v[42:43], v29 offset:512
    v_mfma_f32_16x16x32_bf16 a[76:79], v[44:47], v[124:127], a[76:79]
    s_add_u32 s72, s70, 37888
    buffer_load_dwordx4 v11, s[20:23], s63 offen offset:1024 lds
    v_mfma_f32_16x16x32_bf16 a[80:83], v[48:51], v[96:99], a[80:83]
    ds_read_b128 v[88:91], v24 offset:24576
    ds_read_b64_tr_b16 v[44:45], v29 offset:4096
    v_mfma_f32_16x16x32_bf16 a[80:83], v[52:55], v[100:103], a[80:83]
    ds_read_b64_tr_b16 v[46:47], v29 offset:4608
    v_add_u32 v29, 0x10000, v29
    v_mfma_f32_16x16x32_bf16 a[84:87], v[48:51], v[104:107], a[84:87]
    buffer_store_dwordx4 a[44:47], v1, s[36:39], s72 offen sc1
    v_mfma_f32_16x16x32_bf16 a[84:87], v[52:55], v[108:111], a[84:87]
    ds_read_b128 v[92:95], v25 offset:24576
    v_accvgpr_write_b32 a44, 0
    v_mfma_f32_16x16x32_bf16 a[88:91], v[48:51], v[112:115], a[88:91]
    v_accvgpr_write_b32 a45, 0
    v_accvgpr_write_b32 a46, 0
    v_mfma_f32_16x16x32_bf16 a[88:91], v[52:55], v[116:119], a[88:91]
    v_accvgpr_write_b32 a47, 0
    v_mfma_f32_16x16x32_bf16 a[92:95], v[48:51], v[120:123], a[92:95]
    buffer_load_dwordx4 v12, s[20:23], s63 offen offset:2048 lds
    v_mfma_f32_16x16x32_bf16 a[92:95], v[52:55], v[124:127], a[92:95]
    s_waitcnt lgkmcnt(1)
    v_mfma_f32_16x16x32_bf16 a[96:99], v[56:59], v[96:99], a[96:99]
    v_mfma_f32_16x16x32_bf16 a[96:99], v[60:63], v[100:103], a[96:99]
    v_mfma_f32_16x16x32_bf16 a[100:103], v[56:59], v[104:107], a[100:103]
    buffer_load_dwordx4 v13, s[20:23], s63 offen offset:3072 lds
    v_mfma_f32_16x16x32_bf16 a[100:103], v[60:63], v[108:111], a[100:103]
    s_xor_b32 s63, s63, 128
    v_mfma_f32_16x16x32_bf16 a[104:107], v[56:59], v[112:115], a[104:107]
    v_mfma_f32_16x16x32_bf16 a[104:107], v[60:63], v[116:119], a[104:107]
    s_waitcnt vmcnt(10) lgkmcnt(0)
    s_barrier
    ds_read_b64_tr_b16 v[48:49], v14 offset:32768
    v_mfma_f32_16x16x32_bf16 a[108:111], v[56:59], v[120:123], a[108:111]
    s_add_u32 m0, s67, 131072
    ds_read_b64_tr_b16 v[50:51], v14 offset:33792
    ds_read_b64_tr_b16 v[52:53], v14 offset:40960
    v_mfma_f32_16x16x32_bf16 a[108:111], v[60:63], v[124:127], a[108:111]
    buffer_load_dwordx4 v1, s[28:31], s65 offen sc1 lds
    v_mfma_f32_16x16x32_bf16 a[112:115], v[40:43], v[96:99], a[112:115]
    ds_read_b64_tr_b16 v[54:55], v14 offset:41984
    ds_read_b64_tr_b16 v[56:57], v15 offset:32768
    v_mfma_f32_16x16x32_bf16 a[112:115], v[44:47], v[100:103], a[112:115]
    ds_read_b64_tr_b16 v[58:59], v15 offset:33792
    ds_read_b64_tr_b16 v[60:61], v15 offset:40960
    v_mfma_f32_16x16x32_bf16 a[116:119], v[40:43], v[104:107], a[116:119]
    ds_read_b64_tr_b16 v[62:63], v15 offset:41984
    v_add_u32 v14, 0x10000, v14
    v_mfma_f32_16x16x32_bf16 a[116:119], v[44:47], v[108:111], a[116:119]
    v_add_u32 v15, 0x10000, v15
    v_mfma_f32_16x16x32_bf16 a[120:123], v[40:43], v[112:115], a[120:123]
    v_mfma_f32_16x16x32_bf16 a[120:123], v[44:47], v[116:119], a[120:123]
    v_mfma_f32_16x16x32_bf16 a[124:127], v[40:43], v[120:123], a[124:127]
    ds_read_b64_tr_b16 v[40:41], v16 offset:32768
    ds_read_b64_tr_b16 v[42:43], v16 offset:33792
    v_mfma_f32_16x16x32_bf16 a[124:127], v[44:47], v[124:127], a[124:127]
    s_add_u32 s72, s70, 41984
    ds_read_b64_tr_b16 v[44:45], v16 offset:40960
    ds_read_b64_tr_b16 v[46:47], v16 offset:41984
    s_waitcnt lgkmcnt(4)
    v_mfma_f32_16x16x32_bf16 v[128:131], v[48:51], v[64:67], v[128:131]
    buffer_load_dwordx4 v1, s[28:31], s65 offen offset:1024 sc1 lds
    v_mfma_f32_16x16x32_bf16 v[128:131], v[52:55], v[68:71], v[128:131]
    buffer_store_dwordx4 a[52:55], v1, s[36:39], s72 offen sc1
    v_mfma_f32_16x16x32_bf16 v[132:135], v[48:51], v[72:75], v[132:135]
    ds_read_b128 v[96:99], v24 offset:49152
    v_add_u32 v16, 0x10000, v16
    v_mfma_f32_16x16x32_bf16 v[132:135], v[52:55], v[76:79], v[132:135]
    v_accvgpr_write_b32 a52, 0
    v_accvgpr_write_b32 a53, 0
    v_mfma_f32_16x16x32_bf16 v[136:139], v[48:51], v[80:83], v[136:139]
    v_accvgpr_write_b32 a54, 0
    v_accvgpr_write_b32 a55, 0
    v_mfma_f32_16x16x32_bf16 v[136:139], v[52:55], v[84:87], v[136:139]
    v_mfma_f32_16x16x32_bf16 v[140:143], v[48:51], v[88:91], v[140:143]
    ds_read_b64_tr_b16 v[48:49], v17 offset:32768
    ds_read_b64_tr_b16 v[50:51], v17 offset:33792
    v_mfma_f32_16x16x32_bf16 v[140:143], v[52:55], v[92:95], v[140:143]
    ds_read_b64_tr_b16 v[52:53], v17 offset:40960
    ds_read_b64_tr_b16 v[54:55], v17 offset:41984
    v_mfma_f32_16x16x32_bf16 v[144:147], v[56:59], v[64:67], v[144:147]
    v_add_u32 v17, 0x10000, v17
    v_mfma_f32_16x16x32_bf16 v[144:147], v[60:63], v[68:71], v[144:147]
    s_add_u32 m0, s69, 147456
    v_mfma_f32_16x16x32_bf16 v[148:151], v[56:59], v[72:75], v[148:151]
    s_xor_b32 s65, s65, 57344
    buffer_load_dwordx4 v10, s[20:23], s64 offen lds
    v_mfma_f32_16x16x32_bf16 v[148:151], v[60:63], v[76:79], v[148:151]
    v_mfma_f32_16x16x32_bf16 v[152:155], v[56:59], v[80:83], v[152:155]
    v_mfma_f32_16x16x32_bf16 v[152:155], v[60:63], v[84:87], v[152:155]
    ds_read_b128 v[100:103], v25 offset:49152
    v_mfma_f32_16x16x32_bf16 v[156:159], v[56:59], v[88:91], v[156:159]
    ds_read_b64_tr_b16 v[56:57], v18 offset:32768
    ds_read_b64_tr_b16 v[58:59], v18 offset:33792
    v_mfma_f32_16x16x32_bf16 v[156:159], v[60:63], v[92:95], v[156:159]
    s_waitcnt lgkmcnt(3)
    ds_read_b64_tr_b16 v[60:61], v18 offset:40960
    ds_read_b64_tr_b16 v[62:63], v18 offset:41984
    v_mfma_f32_16x16x32_bf16 v[160:163], v[40:43], v[64:67], v[160:163]
    v_add_u32 v18, 0x10000, v18
    v_mfma_f32_16x16x32_bf16 v[160:163], v[44:47], v[68:71], v[160:163]
    v_mfma_f32_16x16x32_bf16 v[164:167], v[40:43], v[72:75], v[164:167]
    v_mfma_f32_16x16x32_bf16 v[164:167], v[44:47], v[76:79], v[164:167]
    v_mfma_f32_16x16x32_bf16 v[168:171], v[40:43], v[80:83], v[168:171]
    buffer_load_dwordx4 v11, s[20:23], s64 offen offset:1024 lds
    v_mfma_f32_16x16x32_bf16 v[168:171], v[44:47], v[84:87], v[168:171]
    v_mfma_f32_16x16x32_bf16 v[172:175], v[40:43], v[88:91], v[172:175]
    ds_read_b64_tr_b16 v[40:41], v19 offset:32768
    ds_read_b64_tr_b16 v[42:43], v19 offset:33792
    v_mfma_f32_16x16x32_bf16 v[172:175], v[44:47], v[92:95], v[172:175]
    s_add_u32 s72, s70, 46080
    ds_read_b64_tr_b16 v[44:45], v19 offset:40960
    ds_read_b64_tr_b16 v[46:47], v19 offset:41984
    v_mfma_f32_16x16x32_bf16 v[176:179], v[48:51], v[64:67], v[176:179]
    ds_read_b128 v[104:107], v24 offset:57344
    v_add_u32 v19, 0x10000, v19
    v_mfma_f32_16x16x32_bf16 v[176:179], v[52:55], v[68:71], v[176:179]
    buffer_store_dwordx4 a[60:63], v1, s[36:39], s72 offen sc1
    v_mfma_f32_16x16x32_bf16 v[180:183], v[48:51], v[72:75], v[180:183]
    v_mfma_f32_16x16x32_bf16 v[180:183], v[52:55], v[76:79], v[180:183]
    v_accvgpr_write_b32 a60, 0
    v_accvgpr_write_b32 a61, 0
    v_mfma_f32_16x16x32_bf16 v[184:187], v[48:51], v[80:83], v[184:187]
    v_accvgpr_write_b32 a62, 0
    v_accvgpr_write_b32 a63, 0
    v_mfma_f32_16x16x32_bf16 v[184:187], v[52:55], v[84:87], v[184:187]
    v_mfma_f32_16x16x32_bf16 v[188:191], v[48:51], v[88:91], v[188:191]
    buffer_load_dwordx4 v12, s[20:23], s64 offen offset:2048 lds
    v_mfma_f32_16x16x32_bf16 v[188:191], v[52:55], v[92:95], v[188:191]
    s_waitcnt lgkmcnt(0)
    ds_read_b64_tr_b16 v[48:49], v20 offset:32768
    ds_read_b64_tr_b16 v[50:51], v20 offset:33792
    v_mfma_f32_16x16x32_bf16 v[192:195], v[56:59], v[64:67], v[192:195]
    ds_read_b64_tr_b16 v[52:53], v20 offset:40960
    ds_read_b64_tr_b16 v[54:55], v20 offset:41984
    v_mfma_f32_16x16x32_bf16 v[192:195], v[60:63], v[68:71], v[192:195]
    v_add_u32 v20, 0x10000, v20
    v_mfma_f32_16x16x32_bf16 v[196:199], v[56:59], v[72:75], v[196:199]
    v_mfma_f32_16x16x32_bf16 v[196:199], v[60:63], v[76:79], v[196:199]
    ds_read_b128 v[108:111], v25 offset:57344
    v_mfma_f32_16x16x32_bf16 v[200:203], v[56:59], v[80:83], v[200:203]
    v_accvgpr_read_b32 v32, a128
    v_accvgpr_read_b32 v31, a129
    v_mfma_f32_16x16x32_bf16 v[200:203], v[60:63], v[84:87], v[200:203]
    v_cvt_pk_bf16_f32 v32, v32, v31
    v_accvgpr_read_b32 v33, a130
    v_mfma_f32_16x16x32_bf16 v[204:207], v[56:59], v[88:91], v[204:207]
    ds_read_b64_tr_b16 v[56:57], v21 offset:32768
    ds_read_b64_tr_b16 v[58:59], v21 offset:33792
    v_mfma_f32_16x16x32_bf16 v[204:207], v[60:63], v[92:95], v[204:207]
    ds_read_b64_tr_b16 v[60:61], v21 offset:40960
    ds_read_b64_tr_b16 v[62:63], v21 offset:41984
    v_mfma_f32_16x16x32_bf16 v[208:211], v[40:43], v[64:67], v[208:211]
    buffer_load_dwordx4 v13, s[20:23], s64 offen offset:3072 lds
    v_mfma_f32_16x16x32_bf16 v[208:211], v[44:47], v[68:71], v[208:211]
    v_add_u32 v21, 0x10000, v21
    v_accvgpr_read_b32 v31, a131
    v_mfma_f32_16x16x32_bf16 v[212:215], v[40:43], v[72:75], v[212:215]
    v_cvt_pk_bf16_f32 v33, v33, v31
    v_accvgpr_read_b32 v34, a132
    v_mfma_f32_16x16x32_bf16 v[212:215], v[44:47], v[76:79], v[212:215]
    v_accvgpr_read_b32 v31, a133
    v_cvt_pk_bf16_f32 v34, v34, v31
    v_mfma_f32_16x16x32_bf16 v[216:219], v[40:43], v[80:83], v[216:219]
    v_accvgpr_read_b32 v35, a134
    v_accvgpr_read_b32 v31, a135
    v_mfma_f32_16x16x32_bf16 v[216:219], v[44:47], v[84:87], v[216:219]
    v_cvt_pk_bf16_f32 v35, v35, v31
    v_mfma_f32_16x16x32_bf16 v[220:223], v[40:43], v[88:91], v[220:223]
    ds_read_b64_tr_b16 v[40:41], v26 offset:0
    ds_read_b64_tr_b16 v[42:43], v26 offset:512
    v_mfma_f32_16x16x32_bf16 v[220:223], v[44:47], v[92:95], v[220:223]
    s_add_u32 s72, s71, 0
    ds_read_b64_tr_b16 v[44:45], v26 offset:4096
    ds_read_b64_tr_b16 v[46:47], v26 offset:4608
    s_waitcnt lgkmcnt(4)
    v_mfma_f32_16x16x32_bf16 v[224:227], v[48:51], v[64:67], v[224:227]
    buffer_store_dwordx4 v[32:35], v1, s[36:39], s72 offen sc1
    v_mfma_f32_16x16x32_bf16 v[224:227], v[52:55], v[68:71], v[224:227]
    s_xor_b32 s64, s64, 128
    v_add_u32 v26, 0x10000, v26
    v_mfma_f32_16x16x32_bf16 v[228:231], v[48:51], v[72:75], v[228:231]
    v_mfma_f32_16x16x32_bf16 v[228:231], v[52:55], v[76:79], v[228:231]
    v_mfma_f32_16x16x32_bf16 v[232:235], v[48:51], v[80:83], v[232:235]
    v_mfma_f32_16x16x32_bf16 v[232:235], v[52:55], v[84:87], v[232:235]
    s_add_u32 m0, s69, 0
    v_mfma_f32_16x16x32_bf16 v[236:239], v[48:51], v[88:91], v[236:239]
    buffer_load_dwordx4 v2, s[24:27], s60 offen lds
    v_mfma_f32_16x16x32_bf16 v[236:239], v[52:55], v[92:95], v[236:239]
    ds_read_b64_tr_b16 v[48:49], v27 offset:0
    ds_read_b64_tr_b16 v[50:51], v27 offset:512
    v_mfma_f32_16x16x32_bf16 v[240:243], v[56:59], v[64:67], v[240:243]
    ds_read_b64_tr_b16 v[52:53], v27 offset:4096
    ds_read_b64_tr_b16 v[54:55], v27 offset:4608
    v_mfma_f32_16x16x32_bf16 v[240:243], v[60:63], v[68:71], v[240:243]
    buffer_load_dwordx4 v3, s[24:27], s60 offen offset:1024 lds
    v_mfma_f32_16x16x32_bf16 v[244:247], v[56:59], v[72:75], v[244:247]
    v_add_u32 v27, 0x10000, v27
    v_mfma_f32_16x16x32_bf16 v[244:247], v[60:63], v[76:79], v[244:247]
    v_mfma_f32_16x16x32_bf16 v[248:251], v[56:59], v[80:83], v[248:251]
    v_accvgpr_read_b32 v32, a136
    v_accvgpr_read_b32 v31, a137
    v_mfma_f32_16x16x32_bf16 v[248:251], v[60:63], v[84:87], v[248:251]
    buffer_load_dwordx4 v4, s[24:27], s60 offen offset:2048 lds
    v_mfma_f32_16x16x32_bf16 v[252:255], v[56:59], v[88:91], v[252:255]
    ds_read_b64_tr_b16 v[56:57], v28 offset:0
    ds_read_b64_tr_b16 v[58:59], v28 offset:512
    v_mfma_f32_16x16x32_bf16 v[252:255], v[60:63], v[92:95], v[252:255]
    s_waitcnt lgkmcnt(2)
    ds_read_b64_tr_b16 v[60:61], v28 offset:4096
    ds_read_b64_tr_b16 v[62:63], v28 offset:4608
    v_mfma_f32_16x16x32_bf16 a[64:67], v[40:43], v[64:67], a[64:67]
    buffer_load_dwordx4 v5, s[24:27], s60 offen offset:3072 lds
    v_mfma_f32_16x16x32_bf16 a[64:67], v[44:47], v[68:71], a[64:67]
    v_add_u32 v24, 0x10000, v24
    v_add_u32 v28, 0x10000, v28
    v_mfma_f32_16x16x32_bf16 a[68:71], v[40:43], v[72:75], a[68:71]
    ds_read_b128 v[112:115], v24 offset:16384
    v_cvt_pk_bf16_f32 v32, v32, v31
    v_mfma_f32_16x16x32_bf16 a[68:71], v[44:47], v[76:79], a[68:71]
    s_add_u32 m0, s69, 16384
    v_accvgpr_read_b32 v33, a138
    v_accvgpr_read_b32 v31, a139
    v_mfma_f32_16x16x32_bf16 a[72:75], v[40:43], v[80:83], a[72:75]
    s_xor_b32 s60, s60, 524288
    v_add_u32 v25, 0x10000, v25
    v_cvt_pk_bf16_f32 v33, v33, v31
    v_mfma_f32_16x16x32_bf16 a[72:75], v[44:47], v[84:87], a[72:75]
    buffer_load_dwordx4 v10, s[20:23], s63 offen lds
    v_mfma_f32_16x16x32_bf16 a[76:79], v[40:43], v[88:91], a[76:79]
    ds_read_b128 v[116:119], v25 offset:16384
    ds_read_b64_tr_b16 v[40:41], v29 offset:0
    v_mfma_f32_16x16x32_bf16 a[76:79], v[44:47], v[92:95], a[76:79]
    s_add_u32 s72, s71, 1024
    buffer_load_dwordx4 v11, s[20:23], s63 offen offset:1024 lds
    v_mfma_f32_16x16x32_bf16 a[80:83], v[48:51], v[64:67], a[80:83]
    ds_read_b128 v[120:123], v24 offset:24576
    ds_read_b64_tr_b16 v[42:43], v29 offset:512
    v_mfma_f32_16x16x32_bf16 a[80:83], v[52:55], v[68:71], a[80:83]
    ds_read_b64_tr_b16 v[44:45], v29 offset:4096
    ds_read_b64_tr_b16 v[46:47], v29 offset:4608
    v_mfma_f32_16x16x32_bf16 a[84:87], v[48:51], v[72:75], a[84:87]
    v_add_u32 v29, 0x10000, v29
    v_accvgpr_read_b32 v34, a140
    v_mfma_f32_16x16x32_bf16 a[84:87], v[52:55], v[76:79], a[84:87]
    buffer_load_dwordx4 v12, s[20:23], s63 offen offset:2048 lds
    v_mfma_f32_16x16x32_bf16 a[88:91], v[48:51], v[80:83], a[88:91]
    ds_read_b128 v[124:127], v25 offset:24576
    v_accvgpr_read_b32 v31, a141
    v_mfma_f32_16x16x32_bf16 a[88:91], v[52:55], v[84:87], a[88:91]
    v_cvt_pk_bf16_f32 v34, v34, v31
    v_accvgpr_read_b32 v35, a142
    v_mfma_f32_16x16x32_bf16 a[92:95], v[48:51], v[88:91], a[92:95]
    buffer_load_dwordx4 v13, s[20:23], s63 offen offset:3072 lds
    v_mfma_f32_16x16x32_bf16 a[92:95], v[52:55], v[92:95], a[92:95]
    s_waitcnt lgkmcnt(1)
    v_accvgpr_read_b32 v31, a143
    v_cvt_pk_bf16_f32 v35, v35, v31
    v_mfma_f32_16x16x32_bf16 a[96:99], v[56:59], v[64:67], a[96:99]
    v_mfma_f32_16x16x32_bf16 a[96:99], v[60:63], v[68:71], a[96:99]
    s_xor_b32 s63, s63, 384
    v_mfma_f32_16x16x32_bf16 a[100:103], v[56:59], v[72:75], a[100:103]
    buffer_store_dwordx4 v[32:35], v1, s[36:39], s72 offen sc1
    v_mfma_f32_16x16x32_bf16 a[100:103], v[60:63], v[76:79], a[100:103]
    v_mfma_f32_16x16x32_bf16 a[104:107], v[56:59], v[80:83], a[104:107]
    v_accvgpr_read_b32 v32, a144
    v_accvgpr_read_b32 v31, a145
    v_mfma_f32_16x16x32_bf16 a[104:107], v[60:63], v[84:87], a[104:107]
    s_waitcnt vmcnt(10) lgkmcnt(0)
    s_barrier
    ds_read_b64_tr_b16 v[48:49], v14 offset:32768
    v_mfma_f32_16x16x32_bf16 a[108:111], v[56:59], v[88:91], a[108:111]
    s_add_u32 m0, s67, 32768
    ds_read_b64_tr_b16 v[50:51], v14 offset:33792
    ds_read_b64_tr_b16 v[52:53], v14 offset:40960
    v_mfma_f32_16x16x32_bf16 a[108:111], v[60:63], v[92:95], a[108:111]
    buffer_load_dwordx4 v1, s[28:31], s65 offen sc1 lds
    v_mfma_f32_16x16x32_bf16 a[112:115], v[40:43], v[64:67], a[112:115]
    ds_read_b64_tr_b16 v[54:55], v14 offset:41984
    ds_read_b64_tr_b16 v[56:57], v15 offset:32768
    v_mfma_f32_16x16x32_bf16 a[112:115], v[44:47], v[68:71], a[112:115]
    ds_read_b64_tr_b16 v[58:59], v15 offset:33792
    ds_read_b64_tr_b16 v[60:61], v15 offset:40960
    v_mfma_f32_16x16x32_bf16 a[116:119], v[40:43], v[72:75], a[116:119]
    ds_read_b64_tr_b16 v[62:63], v15 offset:41984
    v_add_u32 v14, 0xffff0000, v14
    v_mfma_f32_16x16x32_bf16 a[116:119], v[44:47], v[76:79], a[116:119]
    v_add_u32 v15, 0xffff0000, v15
    v_cvt_pk_bf16_f32 v32, v32, v31
    v_mfma_f32_16x16x32_bf16 a[120:123], v[40:43], v[80:83], a[120:123]
    v_accvgpr_read_b32 v33, a146
    v_accvgpr_read_b32 v31, a147
    v_mfma_f32_16x16x32_bf16 a[120:123], v[44:47], v[84:87], a[120:123]
    v_cvt_pk_bf16_f32 v33, v33, v31
    v_accvgpr_read_b32 v34, a148
    v_mfma_f32_16x16x32_bf16 a[124:127], v[40:43], v[88:91], a[124:127]
    ds_read_b64_tr_b16 v[40:41], v16 offset:32768
    ds_read_b64_tr_b16 v[42:43], v16 offset:33792
    v_mfma_f32_16x16x32_bf16 a[124:127], v[44:47], v[92:95], a[124:127]
    s_add_u32 s72, s71, 32768
    ds_read_b64_tr_b16 v[44:45], v16 offset:40960
    ds_read_b64_tr_b16 v[46:47], v16 offset:41984
    s_waitcnt lgkmcnt(4)
    v_mfma_f32_16x16x32_bf16 v[128:131], v[48:51], v[96:99], v[128:131]
    buffer_load_dwordx4 v1, s[28:31], s65 offen offset:1024 sc1 lds
    v_mfma_f32_16x16x32_bf16 v[128:131], v[52:55], v[100:103], v[128:131]
    v_add_u32 v16, 0xffff0000, v16
    v_accvgpr_read_b32 v31, a149
    v_mfma_f32_16x16x32_bf16 v[132:135], v[48:51], v[104:107], v[132:135]
    ds_read_b128 v[64:67], v24 offset:49152
    v_cvt_pk_bf16_f32 v34, v34, v31
    v_mfma_f32_16x16x32_bf16 v[132:135], v[52:55], v[108:111], v[132:135]
    v_accvgpr_read_b32 v35, a150
    v_accvgpr_read_b32 v31, a151
    v_mfma_f32_16x16x32_bf16 v[136:139], v[48:51], v[112:115], v[136:139]
    v_cvt_pk_bf16_f32 v35, v35, v31
    v_accvgpr_write_b32 a144, 0
    v_mfma_f32_16x16x32_bf16 v[136:139], v[52:55], v[116:119], v[136:139]
    buffer_store_dwordx4 v[32:35], v1, s[36:39], s72 offen sc1
    v_mfma_f32_16x16x32_bf16 v[140:143], v[48:51], v[120:123], v[140:143]
    ds_read_b64_tr_b16 v[48:49], v17 offset:32768
    ds_read_b64_tr_b16 v[50:51], v17 offset:33792
    v_mfma_f32_16x16x32_bf16 v[140:143], v[52:55], v[124:127], v[140:143]
    ds_read_b64_tr_b16 v[52:53], v17 offset:40960
    ds_read_b64_tr_b16 v[54:55], v17 offset:41984
    v_mfma_f32_16x16x32_bf16 v[144:147], v[56:59], v[96:99], v[144:147]
    v_add_u32 v17, 0xffff0000, v17
    v_accvgpr_write_b32 a145, 0
    v_mfma_f32_16x16x32_bf16 v[144:147], v[60:63], v[100:103], v[144:147]
    s_add_u32 m0, s69, 49152
    v_accvgpr_write_b32 a146, 0
    v_accvgpr_write_b32 a147, 0
    v_mfma_f32_16x16x32_bf16 v[148:151], v[56:59], v[104:107], v[148:151]
    s_xor_b32 s65, s65, 8192
    buffer_load_dwordx4 v10, s[20:23], s64 offen lds
    v_mfma_f32_16x16x32_bf16 v[148:151], v[60:63], v[108:111], v[148:151]
    v_accvgpr_write_b32 a148, 0
    v_accvgpr_write_b32 a149, 0
    v_mfma_f32_16x16x32_bf16 v[152:155], v[56:59], v[112:115], v[152:155]
    v_accvgpr_read_b32 v32, a152
    v_accvgpr_read_b32 v31, a153
    v_mfma_f32_16x16x32_bf16 v[152:155], v[60:63], v[116:119], v[152:155]
    ds_read_b128 v[68:71], v25 offset:49152
    v_cvt_pk_bf16_f32 v32, v32, v31
    v_mfma_f32_16x16x32_bf16 v[156:159], v[56:59], v[120:123], v[156:159]
    ds_read_b64_tr_b16 v[56:57], v18 offset:32768
    ds_read_b64_tr_b16 v[58:59], v18 offset:33792
    v_mfma_f32_16x16x32_bf16 v[156:159], v[60:63], v[124:127], v[156:159]
    s_waitcnt lgkmcnt(3)
    ds_read_b64_tr_b16 v[60:61], v18 offset:40960
    ds_read_b64_tr_b16 v[62:63], v18 offset:41984
    v_mfma_f32_16x16x32_bf16 v[160:163], v[40:43], v[96:99], v[160:163]
    v_add_u32 v18, 0xffff0000, v18
    v_accvgpr_read_b32 v33, a154
    v_mfma_f32_16x16x32_bf16 v[160:163], v[44:47], v[100:103], v[160:163]
    v_accvgpr_read_b32 v31, a155
    v_cvt_pk_bf16_f32 v33, v33, v31
    v_mfma_f32_16x16x32_bf16 v[164:167], v[40:43], v[104:107], v[164:167]
    v_accvgpr_read_b32 v34, a156
    v_accvgpr_read_b32 v31, a157
    v_mfma_f32_16x16x32_bf16 v[164:167], v[44:47], v[108:111], v[164:167]
    v_cvt_pk_bf16_f32 v34, v34, v31
    v_accvgpr_read_b32 v35, a158
    v_mfma_f32_16x16x32_bf16 v[168:171], v[40:43], v[112:115], v[168:171]
    buffer_load_dwordx4 v11, s[20:23], s64 offen offset:1024 lds
    v_mfma_f32_16x16x32_bf16 v[168:171], v[44:47], v[116:119], v[168:171]
    v_accvgpr_read_b32 v31, a159
    v_cvt_pk_bf16_f32 v35, v35, v31
    v_mfma_f32_16x16x32_bf16 v[172:175], v[40:43], v[120:123], v[172:175]
    ds_read_b64_tr_b16 v[40:41], v19 offset:32768
    ds_read_b64_tr_b16 v[42:43], v19 offset:33792
    v_mfma_f32_16x16x32_bf16 v[172:175], v[44:47], v[124:127], v[172:175]
    s_add_u32 s72, s71, 33792
    ds_read_b64_tr_b16 v[44:45], v19 offset:40960
    ds_read_b64_tr_b16 v[46:47], v19 offset:41984
    v_mfma_f32_16x16x32_bf16 v[176:179], v[48:51], v[96:99], v[176:179]
    ds_read_b128 v[72:75], v24 offset:57344
    v_add_u32 v19, 0xffff0000, v19
    v_mfma_f32_16x16x32_bf16 v[176:179], v[52:55], v[100:103], v[176:179]
    buffer_store_dwordx4 v[32:35], v1, s[36:39], s72 offen sc1
    v_mfma_f32_16x16x32_bf16 v[180:183], v[48:51], v[104:107], v[180:183]
    v_accvgpr_write_b32 a150, 0
    v_accvgpr_write_b32 a151, 0
    v_mfma_f32_16x16x32_bf16 v[180:183], v[52:55], v[108:111], v[180:183]
    v_accvgpr_write_b32 a152, 0
    v_accvgpr_write_b32 a153, 0
    v_mfma_f32_16x16x32_bf16 v[184:187], v[48:51], v[112:115], v[184:187]
    v_accvgpr_write_b32 a154, 0
    v_accvgpr_write_b32 a155, 0
    v_mfma_f32_16x16x32_bf16 v[184:187], v[52:55], v[116:119], v[184:187]
    v_accvgpr_write_b32 a156, 0
    v_accvgpr_write_b32 a157, 0
    v_mfma_f32_16x16x32_bf16 v[188:191], v[48:51], v[120:123], v[188:191]
    buffer_load_dwordx4 v12, s[20:23], s64 offen offset:2048 lds
    v_mfma_f32_16x16x32_bf16 v[188:191], v[52:55], v[124:127], v[188:191]
    s_waitcnt lgkmcnt(0)
    ds_read_b64_tr_b16 v[48:49], v20 offset:32768
    ds_read_b64_tr_b16 v[50:51], v20 offset:33792
    v_mfma_f32_16x16x32_bf16 v[192:195], v[56:59], v[96:99], v[192:195]
    ds_read_b64_tr_b16 v[52:53], v20 offset:40960
    ds_read_b64_tr_b16 v[54:55], v20 offset:41984
    v_mfma_f32_16x16x32_bf16 v[192:195], v[60:63], v[100:103], v[192:195]
    v_add_u32 v20, 0xffff0000, v20
    v_accvgpr_write_b32 a158, 0
    v_mfma_f32_16x16x32_bf16 v[196:199], v[56:59], v[104:107], v[196:199]
    v_accvgpr_write_b32 a159, 0
    v_mfma_f32_16x16x32_bf16 v[196:199], v[60:63], v[108:111], v[196:199]
    ds_read_b128 v[76:79], v25 offset:57344
    v_mfma_f32_16x16x32_bf16 v[200:203], v[56:59], v[112:115], v[200:203]
    v_accvgpr_read_b32 v32, a160
    v_accvgpr_read_b32 v31, a161
    v_mfma_f32_16x16x32_bf16 v[200:203], v[60:63], v[116:119], v[200:203]
    v_cvt_pk_bf16_f32 v32, v32, v31
    v_accvgpr_read_b32 v33, a162
    v_mfma_f32_16x16x32_bf16 v[204:207], v[56:59], v[120:123], v[204:207]
    ds_read_b64_tr_b16 v[56:57], v21 offset:32768
    ds_read_b64_tr_b16 v[58:59], v21 offset:33792
    v_mfma_f32_16x16x32_bf16 v[204:207], v[60:63], v[124:127], v[204:207]
    ds_read_b64_tr_b16 v[60:61], v21 offset:40960
    ds_read_b64_tr_b16 v[62:63], v21 offset:41984
    v_mfma_f32_16x16x32_bf16 v[208:211], v[40:43], v[96:99], v[208:211]
    buffer_load_dwordx4 v13, s[20:23], s64 offen offset:3072 lds
    v_mfma_f32_16x16x32_bf16 v[208:211], v[44:47], v[100:103], v[208:211]
    v_add_u32 v21, 0xffff0000, v21
    v_accvgpr_read_b32 v31, a163
    v_mfma_f32_16x16x32_bf16 v[212:215], v[40:43], v[104:107], v[212:215]
    v_cvt_pk_bf16_f32 v33, v33, v31
    v_accvgpr_read_b32 v34, a164
    v_mfma_f32_16x16x32_bf16 v[212:215], v[44:47], v[108:111], v[212:215]
    v_accvgpr_read_b32 v31, a165
    v_cvt_pk_bf16_f32 v34, v34, v31
    v_mfma_f32_16x16x32_bf16 v[216:219], v[40:43], v[112:115], v[216:219]
    v_accvgpr_read_b32 v35, a166
    v_accvgpr_read_b32 v31, a167
    v_mfma_f32_16x16x32_bf16 v[216:219], v[44:47], v[116:119], v[216:219]
    v_cvt_pk_bf16_f32 v35, v35, v31
    v_accvgpr_write_b32 a160, 0
    v_mfma_f32_16x16x32_bf16 v[220:223], v[40:43], v[120:123], v[220:223]
    ds_read_b64_tr_b16 v[40:41], v26 offset:0
    ds_read_b64_tr_b16 v[42:43], v26 offset:512
    v_mfma_f32_16x16x32_bf16 v[220:223], v[44:47], v[124:127], v[220:223]
    s_add_u32 s72, s71, 2048
    ds_read_b64_tr_b16 v[44:45], v26 offset:4096
    ds_read_b64_tr_b16 v[46:47], v26 offset:4608
    s_waitcnt lgkmcnt(4)
    v_mfma_f32_16x16x32_bf16 v[224:227], v[48:51], v[96:99], v[224:227]
    v_add_u32 v26, 0xfffe0000, v26
    v_accvgpr_write_b32 a161, 0
    v_mfma_f32_16x16x32_bf16 v[224:227], v[52:55], v[100:103], v[224:227]
    s_xor_b32 s64, s64, 384
    buffer_store_dwordx4 v[32:35], v1, s[36:39], s72 offen sc1
    v_mfma_f32_16x16x32_bf16 v[228:231], v[48:51], v[104:107], v[228:231]
    v_accvgpr_write_b32 a162, 0
    v_accvgpr_write_b32 a163, 0
    v_mfma_f32_16x16x32_bf16 v[228:231], v[52:55], v[108:111], v[228:231]
    v_accvgpr_write_b32 a164, 0
    v_accvgpr_write_b32 a165, 0
    v_mfma_f32_16x16x32_bf16 v[232:235], v[48:51], v[112:115], v[232:235]
    v_accvgpr_write_b32 a166, 0
    v_accvgpr_write_b32 a167, 0
    v_mfma_f32_16x16x32_bf16 v[232:235], v[52:55], v[116:119], v[232:235]
    s_add_u32 m0, s69, 65536
    v_mfma_f32_16x16x32_bf16 v[236:239], v[48:51], v[120:123], v[236:239]
    buffer_load_dwordx4 v2, s[24:27], s60 offen lds
    v_mfma_f32_16x16x32_bf16 v[236:239], v[52:55], v[124:127], v[236:239]
    ds_read_b64_tr_b16 v[48:49], v27 offset:0
    ds_read_b64_tr_b16 v[50:51], v27 offset:512
    v_mfma_f32_16x16x32_bf16 v[240:243], v[56:59], v[96:99], v[240:243]
    ds_read_b64_tr_b16 v[52:53], v27 offset:4096
    ds_read_b64_tr_b16 v[54:55], v27 offset:4608
    v_mfma_f32_16x16x32_bf16 v[240:243], v[60:63], v[100:103], v[240:243]
    buffer_load_dwordx4 v3, s[24:27], s60 offen offset:1024 lds
    v_mfma_f32_16x16x32_bf16 v[244:247], v[56:59], v[104:107], v[244:247]
    v_add_u32 v27, 0xfffe0000, v27
    v_mfma_f32_16x16x32_bf16 v[244:247], v[60:63], v[108:111], v[244:247]
    v_mfma_f32_16x16x32_bf16 v[248:251], v[56:59], v[112:115], v[248:251]
    v_accvgpr_read_b32 v32, a168
    v_accvgpr_read_b32 v31, a169
    v_mfma_f32_16x16x32_bf16 v[248:251], v[60:63], v[116:119], v[248:251]
    buffer_load_dwordx4 v4, s[24:27], s60 offen offset:2048 lds
    v_mfma_f32_16x16x32_bf16 v[252:255], v[56:59], v[120:123], v[252:255]
    ds_read_b64_tr_b16 v[56:57], v28 offset:0
    ds_read_b64_tr_b16 v[58:59], v28 offset:512
    v_mfma_f32_16x16x32_bf16 v[252:255], v[60:63], v[124:127], v[252:255]
    s_waitcnt lgkmcnt(2)
    ds_read_b64_tr_b16 v[60:61], v28 offset:4096
    ds_read_b64_tr_b16 v[62:63], v28 offset:4608
    v_mfma_f32_16x16x32_bf16 a[64:67], v[40:43], v[96:99], a[64:67]
    buffer_load_dwordx4 v5, s[24:27], s60 offen offset:3072 lds
    v_mfma_f32_16x16x32_bf16 a[64:67], v[44:47], v[100:103], a[64:67]
    v_add_u32 v24, 0x10000, v24
    v_add_u32 v28, 0xfffe0000, v28
    v_mfma_f32_16x16x32_bf16 a[68:71], v[40:43], v[104:107], a[68:71]
    ds_read_b128 v[80:83], v24 offset:16384
    v_cvt_pk_bf16_f32 v32, v32, v31
    v_mfma_f32_16x16x32_bf16 a[68:71], v[44:47], v[108:111], a[68:71]
    s_add_u32 m0, s69, 81920
    v_accvgpr_read_b32 v33, a170
    v_accvgpr_read_b32 v31, a171
    v_mfma_f32_16x16x32_bf16 a[72:75], v[40:43], v[112:115], a[72:75]
    s_xor_b32 s60, s60, 1572864
    v_add_u32 v25, 0x10000, v25
    v_cvt_pk_bf16_f32 v33, v33, v31
    v_mfma_f32_16x16x32_bf16 a[72:75], v[44:47], v[116:119], a[72:75]
    buffer_load_dwordx4 v10, s[20:23], s63 offen lds
    v_mfma_f32_16x16x32_bf16 a[76:79], v[40:43], v[120:123], a[76:79]
    ds_read_b128 v[84:87], v25 offset:16384
    ds_read_b64_tr_b16 v[40:41], v29 offset:0
    v_mfma_f32_16x16x32_bf16 a[76:79], v[44:47], v[124:127], a[76:79]
    s_add_u32 s72, s71, 3072
    buffer_load_dwordx4 v11, s[20:23], s63 offen offset:1024 lds
    v_mfma_f32_16x16x32_bf16 a[80:83], v[48:51], v[96:99], a[80:83]
    ds_read_b128 v[88:91], v24 offset:24576
    ds_read_b64_tr_b16 v[42:43], v29 offset:512
    v_mfma_f32_16x16x32_bf16 a[80:83], v[52:55], v[100:103], a[80:83]
    ds_read_b64_tr_b16 v[44:45], v29 offset:4096
    ds_read_b64_tr_b16 v[46:47], v29 offset:4608
    v_mfma_f32_16x16x32_bf16 a[84:87], v[48:51], v[104:107], a[84:87]
    v_add_u32 v29, 0xfffe0000, v29
    v_accvgpr_read_b32 v34, a172
    v_mfma_f32_16x16x32_bf16 a[84:87], v[52:55], v[108:111], a[84:87]
    buffer_load_dwordx4 v12, s[20:23], s63 offen offset:2048 lds
    v_mfma_f32_16x16x32_bf16 a[88:91], v[48:51], v[112:115], a[88:91]
    ds_read_b128 v[92:95], v25 offset:24576
    v_accvgpr_read_b32 v31, a173
    v_mfma_f32_16x16x32_bf16 a[88:91], v[52:55], v[116:119], a[88:91]
    v_cvt_pk_bf16_f32 v34, v34, v31
    v_accvgpr_read_b32 v35, a174
    v_mfma_f32_16x16x32_bf16 a[92:95], v[48:51], v[120:123], a[92:95]
    buffer_load_dwordx4 v13, s[20:23], s63 offen offset:3072 lds
    v_mfma_f32_16x16x32_bf16 a[92:95], v[52:55], v[124:127], a[92:95]
    s_waitcnt lgkmcnt(1)
    v_accvgpr_read_b32 v31, a175
    v_cvt_pk_bf16_f32 v35, v35, v31
    v_mfma_f32_16x16x32_bf16 a[96:99], v[56:59], v[96:99], a[96:99]
    v_accvgpr_write_b32 a168, 0
    v_accvgpr_write_b32 a169, 0
    v_mfma_f32_16x16x32_bf16 a[96:99], v[60:63], v[100:103], a[96:99]
    s_xor_b32 s63, s63, 128
    v_accvgpr_write_b32 a170, 0
    v_accvgpr_write_b32 a171, 0
    v_mfma_f32_16x16x32_bf16 a[100:103], v[56:59], v[104:107], a[100:103]
    buffer_store_dwordx4 v[32:35], v1, s[36:39], s72 offen sc1
    v_mfma_f32_16x16x32_bf16 a[100:103], v[60:63], v[108:111], a[100:103]
    v_accvgpr_write_b32 a172, 0
    v_accvgpr_write_b32 a173, 0
    v_mfma_f32_16x16x32_bf16 a[104:107], v[56:59], v[112:115], a[104:107]
    v_accvgpr_read_b32 v32, a176
    v_accvgpr_read_b32 v31, a177
    v_mfma_f32_16x16x32_bf16 a[104:107], v[60:63], v[116:119], a[104:107]
    s_waitcnt vmcnt(10) lgkmcnt(0)
    s_barrier
    ds_read_b64_tr_b16 v[48:49], v14 offset:0
    v_mfma_f32_16x16x32_bf16 a[108:111], v[56:59], v[120:123], a[108:111]
    s_add_u32 m0, s67, 98304
    ds_read_b64_tr_b16 v[50:51], v14 offset:1024
    ds_read_b64_tr_b16 v[52:53], v14 offset:8192
    v_mfma_f32_16x16x32_bf16 a[108:111], v[60:63], v[124:127], a[108:111]
    buffer_load_dwordx4 v1, s[28:31], s65 offen sc1 lds
    v_mfma_f32_16x16x32_bf16 a[112:115], v[40:43], v[96:99], a[112:115]
    ds_read_b64_tr_b16 v[54:55], v14 offset:9216
    ds_read_b64_tr_b16 v[56:57], v15 offset:0
    v_mfma_f32_16x16x32_bf16 a[112:115], v[44:47], v[100:103], a[112:115]
    ds_read_b64_tr_b16 v[58:59], v15 offset:1024
    ds_read_b64_tr_b16 v[60:61], v15 offset:8192
    v_mfma_f32_16x16x32_bf16 a[116:119], v[40:43], v[104:107], a[116:119]
    ds_read_b64_tr_b16 v[62:63], v15 offset:9216
    v_add_u32 v14, 0x10000, v14
    v_mfma_f32_16x16x32_bf16 a[116:119], v[44:47], v[108:111], a[116:119]
    v_add_u32 v15, 0x10000, v15
    v_cvt_pk_bf16_f32 v32, v32, v31
    v_mfma_f32_16x16x32_bf16 a[120:123], v[40:43], v[112:115], a[120:123]
    v_accvgpr_read_b32 v33, a178
    v_accvgpr_read_b32 v31, a179
    v_mfma_f32_16x16x32_bf16 a[120:123], v[44:47], v[116:119], a[120:123]
    v_cvt_pk_bf16_f32 v33, v33, v31
    v_accvgpr_read_b32 v34, a180
    v_mfma_f32_16x16x32_bf16 a[124:127], v[40:43], v[120:123], a[124:127]
    ds_read_b64_tr_b16 v[40:41], v16 offset:0
    ds_read_b64_tr_b16 v[42:43], v16 offset:1024
    v_mfma_f32_16x16x32_bf16 a[124:127], v[44:47], v[124:127], a[124:127]
    s_add_u32 s72, s71, 34816
    ds_read_b64_tr_b16 v[44:45], v16 offset:8192
    ds_read_b64_tr_b16 v[46:47], v16 offset:9216
    s_waitcnt lgkmcnt(4)
    v_mfma_f32_16x16x32_bf16 v[128:131], v[48:51], v[64:67], v[128:131]
    s_add_u32 s86, s101, 4096
    buffer_load_dwordx4 v1, s[28:31], s65 offen offset:1024 sc1 lds
    v_mfma_f32_16x16x32_bf16 v[128:131], v[52:55], v[68:71], v[128:131]
    s_mov_b32 s87, 3072
    v_add_u32 v24, 0xfffe0000, v24
    v_add_u32 v16, 0x10000, v16
    v_mfma_f32_16x16x32_bf16 v[132:135], v[48:51], v[72:75], v[132:135]
    s_sub_u32 s7, s101, 4096
    ds_read_b128 v[96:99], v24 offset:16384
    v_accvgpr_read_b32 v31, a181
    v_mfma_f32_16x16x32_bf16 v[132:135], v[52:55], v[76:79], v[132:135]
    s_mov_b32 s98, 0
    v_cvt_pk_bf16_f32 v34, v34, v31
    v_accvgpr_read_b32 v35, a182
    v_mfma_f32_16x16x32_bf16 v[136:139], v[48:51], v[80:83], v[136:139]
    s_mul_i32 s84, s101, 48
    v_accvgpr_read_b32 v31, a183
    v_cvt_pk_bf16_f32 v35, v35, v31
    v_mfma_f32_16x16x32_bf16 v[136:139], v[52:55], v[84:87], v[136:139]
    s_add_u32 s84, s84, 19922944
    buffer_store_dwordx4 v[32:35], v1, s[36:39], s72 offen sc1
    v_mfma_f32_16x16x32_bf16 v[140:143], v[48:51], v[88:91], v[140:143]
    s_mov_b32 s42, 21495808
    ds_read_b64_tr_b16 v[48:49], v17 offset:0
    ds_read_b64_tr_b16 v[50:51], v17 offset:1024
    v_mfma_f32_16x16x32_bf16 v[140:143], v[52:55], v[92:95], v[140:143]
    s_mov_b32 s43, 0x20000
    ds_read_b64_tr_b16 v[52:53], v17 offset:8192
    ds_read_b64_tr_b16 v[54:55], v17 offset:9216
    v_mfma_f32_16x16x32_bf16 v[144:147], v[56:59], v[64:67], v[144:147]
    v_add_u32 v17, 0x10000, v17
    v_accvgpr_write_b32 a174, 0
    v_mfma_f32_16x16x32_bf16 v[144:147], v[60:63], v[68:71], v[144:147]
    s_add_u32 m0, s69, 114688
    v_accvgpr_write_b32 a175, 0
    v_accvgpr_write_b32 a176, 0
    v_mfma_f32_16x16x32_bf16 v[148:151], v[56:59], v[72:75], v[148:151]
    s_xor_b32 s65, s65, 24576
    buffer_load_dwordx4 v10, s[20:23], s64 offen lds
    v_mfma_f32_16x16x32_bf16 v[148:151], v[60:63], v[76:79], v[148:151]
    s_cmp_eq_u32 s6, 7
    s_cselect_b32 s86, s101, s86
    s_cselect_b32 s87, 0, s87
    v_mfma_f32_16x16x32_bf16 v[152:155], v[56:59], v[80:83], v[152:155]
    v_add_u32 v25, 0xfffe0000, v25
    v_accvgpr_read_b32 v32, a184
    v_mfma_f32_16x16x32_bf16 v[152:155], v[60:63], v[84:87], v[152:155]
    ds_read_b128 v[100:103], v25 offset:16384
    v_accvgpr_read_b32 v31, a185
    v_mfma_f32_16x16x32_bf16 v[156:159], v[56:59], v[88:91], v[156:159]
    ds_read_b64_tr_b16 v[56:57], v18 offset:0
    ds_read_b64_tr_b16 v[58:59], v18 offset:1024
    v_mfma_f32_16x16x32_bf16 v[156:159], v[60:63], v[92:95], v[156:159]
    s_waitcnt lgkmcnt(3)
    ds_read_b64_tr_b16 v[60:61], v18 offset:8192
    ds_read_b64_tr_b16 v[62:63], v18 offset:9216
    v_mfma_f32_16x16x32_bf16 v[160:163], v[40:43], v[64:67], v[160:163]
    v_add_u32 v18, 0x10000, v18
    v_cvt_pk_bf16_f32 v32, v32, v31
    v_mfma_f32_16x16x32_bf16 v[160:163], v[44:47], v[68:71], v[160:163]
    v_accvgpr_read_b32 v33, a186
    v_accvgpr_read_b32 v31, a187
    v_mfma_f32_16x16x32_bf16 v[164:167], v[40:43], v[72:75], v[164:167]
    v_cvt_pk_bf16_f32 v33, v33, v31
    v_accvgpr_read_b32 v34, a188
    v_mfma_f32_16x16x32_bf16 v[164:167], v[44:47], v[76:79], v[164:167]
    v_accvgpr_read_b32 v31, a189
    v_cvt_pk_bf16_f32 v34, v34, v31
    v_mfma_f32_16x16x32_bf16 v[168:171], v[40:43], v[80:83], v[168:171]
    buffer_load_dwordx4 v11, s[20:23], s64 offen offset:1024 lds
    v_mfma_f32_16x16x32_bf16 v[168:171], v[44:47], v[84:87], v[168:171]
    v_accvgpr_read_b32 v35, a190
    v_accvgpr_read_b32 v31, a191
    v_mfma_f32_16x16x32_bf16 v[172:175], v[40:43], v[88:91], v[172:175]
    ds_read_b64_tr_b16 v[40:41], v19 offset:0
    ds_read_b64_tr_b16 v[42:43], v19 offset:1024
    v_mfma_f32_16x16x32_bf16 v[172:175], v[44:47], v[92:95], v[172:175]
    s_add_u32 s72, s71, 35840
    ds_read_b64_tr_b16 v[44:45], v19 offset:8192
    ds_read_b64_tr_b16 v[46:47], v19 offset:9216
    v_mfma_f32_16x16x32_bf16 v[176:179], v[48:51], v[64:67], v[176:179]
    ds_read_b128 v[104:107], v24 offset:24576
    v_add_u32 v19, 0x10000, v19
    v_mfma_f32_16x16x32_bf16 v[176:179], v[52:55], v[68:71], v[176:179]
    v_cvt_pk_bf16_f32 v35, v35, v31
    v_accvgpr_write_b32 a177, 0
    v_mfma_f32_16x16x32_bf16 v[180:183], v[48:51], v[72:75], v[180:183]
    buffer_store_dwordx4 v[32:35], v1, s[36:39], s72 offen sc1
    v_mfma_f32_16x16x32_bf16 v[180:183], v[52:55], v[76:79], v[180:183]
    s_cmp_eq_u32 s6, 0
    s_cselect_b32 s7, s101, s7
    s_cselect_b32 s98, 1073741824, s98
    v_mfma_f32_16x16x32_bf16 v[184:187], v[48:51], v[80:83], v[184:187]
    s_bitcmp1_b32 s4, 0
    s_cselect_b32 s86, s86, s7
    s_cselect_b32 s87, s87, s98
    v_mfma_f32_16x16x32_bf16 v[184:187], v[52:55], v[84:87], v[184:187]
    s_mul_i32 s7, s86, 48
    v_accvgpr_write_b32 a178, 0
    v_accvgpr_write_b32 a179, 0
    v_mfma_f32_16x16x32_bf16 v[188:191], v[48:51], v[88:91], v[188:191]
    s_add_u32 s87, s87, s7
    buffer_load_dwordx4 v12, s[20:23], s64 offen offset:2048 lds
    v_mfma_f32_16x16x32_bf16 v[188:191], v[52:55], v[92:95], v[188:191]
    s_and_b32 s7, s5, 24
    ds_read_b64_tr_b16 v[48:49], v20 offset:0
    ds_read_b64_tr_b16 v[50:51], v20 offset:1024
    s_waitcnt lgkmcnt(2)
    v_mfma_f32_16x16x32_bf16 v[192:195], v[56:59], v[64:67], v[192:195]
    s_add_u32 s7, s7, s6
    ds_read_b64_tr_b16 v[52:53], v20 offset:8192
    ds_read_b64_tr_b16 v[54:55], v20 offset:9216
    v_mfma_f32_16x16x32_bf16 v[192:195], v[60:63], v[68:71], v[192:195]
    s_bfe_u32 s98, s5, 0x20001
    v_add_u32 v20, 0x10000, v20
    v_accvgpr_write_b32 a180, 0
    v_mfma_f32_16x16x32_bf16 v[196:199], v[56:59], v[72:75], v[196:199]
    s_lshl2_add_u32 s7, s7, s98
    v_accvgpr_write_b32 a181, 0
    v_accvgpr_write_b32 a182, 0
    v_mfma_f32_16x16x32_bf16 v[196:199], v[60:63], v[76:79], v[196:199]
    s_mul_i32 s98, s7, 36864
    ds_read_b128 v[108:111], v25 offset:24576
    v_add_u32 v36, s98, v36
    v_mfma_f32_16x16x32_bf16 v[200:203], v[56:59], v[80:83], v[200:203]
    s_mul_hi_u32 s98, s8, 715827883
    v_accvgpr_read_b32 v32, a192
    v_accvgpr_read_b32 v31, a193
    v_mfma_f32_16x16x32_bf16 v[200:203], v[60:63], v[84:87], v[200:203]
    s_add_u32 s87, s87, 19922944
    v_cvt_pk_bf16_f32 v32, v32, v31
    v_accvgpr_read_b32 v33, a194
    v_mfma_f32_16x16x32_bf16 v[204:207], v[56:59], v[88:91], v[204:207]
    ds_read_b64_tr_b16 v[56:57], v21 offset:0
    ds_read_b64_tr_b16 v[58:59], v21 offset:1024
    v_mfma_f32_16x16x32_bf16 v[204:207], v[60:63], v[92:95], v[204:207]
    ds_read_b64_tr_b16 v[60:61], v21 offset:8192
    ds_read_b64_tr_b16 v[62:63], v21 offset:9216
    v_mfma_f32_16x16x32_bf16 v[208:211], v[40:43], v[64:67], v[208:211]
    buffer_load_dwordx4 v13, s[20:23], s64 offen offset:3072 lds
    v_mfma_f32_16x16x32_bf16 v[208:211], v[44:47], v[68:71], v[208:211]
    v_add_u32 v21, 0x10000, v21
    v_accvgpr_read_b32 v31, a195
    v_mfma_f32_16x16x32_bf16 v[212:215], v[40:43], v[72:75], v[212:215]
    v_cvt_pk_bf16_f32 v33, v33, v31
    v_accvgpr_read_b32 v34, a196
    v_mfma_f32_16x16x32_bf16 v[212:215], v[44:47], v[76:79], v[212:215]
    v_accvgpr_read_b32 v31, a197
    v_cvt_pk_bf16_f32 v34, v34, v31
    v_mfma_f32_16x16x32_bf16 v[216:219], v[40:43], v[80:83], v[216:219]
    v_accvgpr_read_b32 v35, a198
    v_accvgpr_read_b32 v31, a199
    v_mfma_f32_16x16x32_bf16 v[216:219], v[44:47], v[84:87], v[216:219]
    v_cvt_pk_bf16_f32 v35, v35, v31
    v_sub_u32 v39, v36, v39
    v_mfma_f32_16x16x32_bf16 v[220:223], v[40:43], v[88:91], v[220:223]
    ds_read_b64_tr_b16 v[40:41], v26 offset:32768
    ds_read_b64_tr_b16 v[42:43], v26 offset:33280
    v_mfma_f32_16x16x32_bf16 v[220:223], v[44:47], v[92:95], v[220:223]
    s_add_u32 s72, s71, 4096
    ds_read_b64_tr_b16 v[44:45], v26 offset:36864
    ds_read_b64_tr_b16 v[46:47], v26 offset:37376
    s_waitcnt lgkmcnt(4)
    v_mfma_f32_16x16x32_bf16 v[224:227], v[48:51], v[64:67], v[224:227]
    v_add_u32 v26, 0x10000, v26
    v_lshl_add_u32 v36, s100, 6, v36
    v_mfma_f32_16x16x32_bf16 v[224:227], v[52:55], v[68:71], v[224:227]
    s_xor_b32 s64, s64, 128
    buffer_store_dwordx4 v[32:35], v1, s[36:39], s72 offen sc1
    v_mfma_f32_16x16x32_bf16 v[228:231], v[48:51], v[72:75], v[228:231]
    s_cmp_eq_u32 s4, 3
    s_cselect_b32 s84, s84, 1073741824
    v_accvgpr_write_b32 a183, 0
    v_mfma_f32_16x16x32_bf16 v[228:231], v[52:55], v[76:79], v[228:231]
    s_sub_u32 s40, s56, 22020096
    s_subb_u32 s41, s57, 0
    v_accvgpr_write_b32 a184, 0
    v_mfma_f32_16x16x32_bf16 v[232:235], v[48:51], v[80:83], v[232:235]
    s_add_u32 s85, s84, 3072
    v_accvgpr_write_b32 a185, 0
    v_accvgpr_write_b32 a186, 0
    v_mfma_f32_16x16x32_bf16 v[232:235], v[52:55], v[84:87], v[232:235]
    s_add_u32 m0, s69, 131072
    v_accvgpr_write_b32 a187, 0
    v_accvgpr_write_b32 a188, 0
    v_mfma_f32_16x16x32_bf16 v[236:239], v[48:51], v[88:91], v[236:239]
    buffer_load_dwordx4 v2, s[24:27], s60 offen lds
    v_mfma_f32_16x16x32_bf16 v[236:239], v[52:55], v[92:95], v[236:239]
    ds_read_b64_tr_b16 v[48:49], v27 offset:32768
    ds_read_b64_tr_b16 v[50:51], v27 offset:33280
    v_mfma_f32_16x16x32_bf16 v[240:243], v[56:59], v[64:67], v[240:243]
    ds_read_b64_tr_b16 v[52:53], v27 offset:36864
    ds_read_b64_tr_b16 v[54:55], v27 offset:37376
    v_mfma_f32_16x16x32_bf16 v[240:243], v[60:63], v[68:71], v[240:243]
    buffer_load_dwordx4 v3, s[24:27], s60 offen offset:1024 lds
    v_mfma_f32_16x16x32_bf16 v[244:247], v[56:59], v[72:75], v[244:247]
    v_add_u32 v27, 0x10000, v27
    v_accvgpr_write_b32 a189, 0
    v_mfma_f32_16x16x32_bf16 v[244:247], v[60:63], v[76:79], v[244:247]
    v_accvgpr_write_b32 a190, 0
    v_accvgpr_write_b32 a191, 0
    v_mfma_f32_16x16x32_bf16 v[248:251], v[56:59], v[80:83], v[248:251]
    v_accvgpr_read_b32 v32, a200
    v_accvgpr_read_b32 v31, a201
    v_mfma_f32_16x16x32_bf16 v[248:251], v[60:63], v[84:87], v[248:251]
    buffer_load_dwordx4 v4, s[24:27], s60 offen offset:2048 lds
    v_mfma_f32_16x16x32_bf16 v[252:255], v[56:59], v[88:91], v[252:255]
    ds_read_b64_tr_b16 v[56:57], v28 offset:32768
    ds_read_b64_tr_b16 v[58:59], v28 offset:33280
    v_mfma_f32_16x16x32_bf16 v[252:255], v[60:63], v[92:95], v[252:255]
    s_waitcnt lgkmcnt(2)
    ds_read_b64_tr_b16 v[60:61], v28 offset:36864
    ds_read_b64_tr_b16 v[62:63], v28 offset:37376
    v_mfma_f32_16x16x32_bf16 a[64:67], v[40:43], v[64:67], a[64:67]
    buffer_load_dwordx4 v5, s[24:27], s60 offen offset:3072 lds
    v_mfma_f32_16x16x32_bf16 a[64:67], v[44:47], v[68:71], a[64:67]
    v_add_u32 v28, 0x10000, v28
    v_cvt_pk_bf16_f32 v32, v32, v31
    v_mfma_f32_16x16x32_bf16 a[68:71], v[40:43], v[72:75], a[68:71]
    ds_read_b128 v[112:115], v24 offset:49152
    v_accvgpr_read_b32 v33, a202
    v_mfma_f32_16x16x32_bf16 a[68:71], v[44:47], v[76:79], a[68:71]
    s_add_u32 m0, s69, 147456
    v_accvgpr_read_b32 v31, a203
    v_cvt_pk_bf16_f32 v33, v33, v31
    v_mfma_f32_16x16x32_bf16 a[72:75], v[40:43], v[80:83], a[72:75]
    s_xor_b32 s60, s60, 524288
    buffer_load_dwordx4 v10, s[20:23], s63 offen lds
    v_mfma_f32_16x16x32_bf16 a[72:75], v[44:47], v[84:87], a[72:75]
    ds_read_b128 v[116:119], v25 offset:49152
    v_accvgpr_read_b32 v34, a204
    v_mfma_f32_16x16x32_bf16 a[76:79], v[40:43], v[88:91], a[76:79]
    ds_read_b64_tr_b16 v[40:41], v29 offset:32768
    ds_read_b64_tr_b16 v[42:43], v29 offset:33280
    v_mfma_f32_16x16x32_bf16 a[76:79], v[44:47], v[92:95], a[76:79]
    s_add_u32 s72, s71, 5120
    buffer_load_dwordx4 v11, s[20:23], s63 offen offset:1024 lds
    v_mfma_f32_16x16x32_bf16 a[80:83], v[48:51], v[64:67], a[80:83]
    ds_read_b128 v[120:123], v24 offset:57344
    ds_read_b64_tr_b16 v[44:45], v29 offset:36864
    v_mfma_f32_16x16x32_bf16 a[80:83], v[52:55], v[68:71], a[80:83]
    ds_read_b64_tr_b16 v[46:47], v29 offset:37376
    v_add_u32 v29, 0x10000, v29
    v_mfma_f32_16x16x32_bf16 a[84:87], v[48:51], v[72:75], a[84:87]
    v_accvgpr_read_b32 v31, a205
    v_cvt_pk_bf16_f32 v34, v34, v31
    v_mfma_f32_16x16x32_bf16 a[84:87], v[52:55], v[76:79], a[84:87]
    buffer_load_dwordx4 v12, s[20:23], s63 offen offset:2048 lds
    v_mfma_f32_16x16x32_bf16 a[88:91], v[48:51], v[80:83], a[88:91]
    ds_read_b128 v[124:127], v25 offset:57344
    v_accvgpr_read_b32 v35, a206
    v_mfma_f32_16x16x32_bf16 a[88:91], v[52:55], v[84:87], a[88:91]
    v_accvgpr_read_b32 v31, a207
    v_cvt_pk_bf16_f32 v35, v35, v31
    v_mfma_f32_16x16x32_bf16 a[92:95], v[48:51], v[88:91], a[92:95]
    buffer_load_dwordx4 v13, s[20:23], s63 offen offset:3072 lds
    v_mfma_f32_16x16x32_bf16 a[92:95], v[52:55], v[92:95], a[92:95]
    s_waitcnt lgkmcnt(1)
    v_accvgpr_write_b32 a192, 0
    v_accvgpr_write_b32 a193, 0
    v_mfma_f32_16x16x32_bf16 a[96:99], v[56:59], v[64:67], a[96:99]
    v_accvgpr_write_b32 a194, 0
    v_accvgpr_write_b32 a195, 0
    v_mfma_f32_16x16x32_bf16 a[96:99], v[60:63], v[68:71], a[96:99]
    s_xor_b32 s63, s63, 1920
    v_accvgpr_write_b32 a196, 0
    v_accvgpr_write_b32 a197, 0
    v_mfma_f32_16x16x32_bf16 a[100:103], v[56:59], v[72:75], a[100:103]
    s_andn2_b32 s63, s63, 896
    buffer_store_dwordx4 v[32:35], v1, s[36:39], s72 offen sc1
    v_mfma_f32_16x16x32_bf16 a[100:103], v[60:63], v[76:79], a[100:103]
    v_accvgpr_write_b32 a198, 0
    v_accvgpr_write_b32 a199, 0
    v_mfma_f32_16x16x32_bf16 a[104:107], v[56:59], v[80:83], a[104:107]
    v_accvgpr_read_b32 v32, a208
    v_accvgpr_read_b32 v31, a209
    v_mfma_f32_16x16x32_bf16 a[104:107], v[60:63], v[84:87], a[104:107]
    s_waitcnt vmcnt(10) lgkmcnt(0)
    s_barrier
    ds_read_b64_tr_b16 v[48:49], v14 offset:0
    v_mfma_f32_16x16x32_bf16 a[108:111], v[56:59], v[88:91], a[108:111]
    s_add_u32 m0, s67, 0
    ds_read_b64_tr_b16 v[50:51], v14 offset:1024
    ds_read_b64_tr_b16 v[52:53], v14 offset:8192
    v_mfma_f32_16x16x32_bf16 a[108:111], v[60:63], v[92:95], a[108:111]
    buffer_load_dwordx4 v1, s[28:31], s65 offen sc1 lds
    v_mfma_f32_16x16x32_bf16 a[112:115], v[40:43], v[64:67], a[112:115]
    ds_read_b64_tr_b16 v[54:55], v14 offset:9216
    ds_read_b64_tr_b16 v[56:57], v15 offset:0
    v_mfma_f32_16x16x32_bf16 a[112:115], v[44:47], v[68:71], a[112:115]
    ds_read_b64_tr_b16 v[58:59], v15 offset:1024
    ds_read_b64_tr_b16 v[60:61], v15 offset:8192
    v_mfma_f32_16x16x32_bf16 a[116:119], v[40:43], v[72:75], a[116:119]
    ds_read_b64_tr_b16 v[62:63], v15 offset:9216
    v_add_u32 v14, 0x10000, v14
    v_mfma_f32_16x16x32_bf16 a[116:119], v[44:47], v[76:79], a[116:119]
    v_add_u32 v15, 0x10000, v15
    v_cvt_pk_bf16_f32 v32, v32, v31
    v_mfma_f32_16x16x32_bf16 a[120:123], v[40:43], v[80:83], a[120:123]
    v_accvgpr_read_b32 v33, a210
    v_accvgpr_read_b32 v31, a211
    v_mfma_f32_16x16x32_bf16 a[120:123], v[44:47], v[84:87], a[120:123]
    v_cvt_pk_bf16_f32 v33, v33, v31
    v_accvgpr_read_b32 v34, a212
    v_mfma_f32_16x16x32_bf16 a[124:127], v[40:43], v[88:91], a[124:127]
    ds_read_b64_tr_b16 v[40:41], v16 offset:0
    ds_read_b64_tr_b16 v[42:43], v16 offset:1024
    v_mfma_f32_16x16x32_bf16 a[124:127], v[44:47], v[92:95], a[124:127]
    s_add_u32 s72, s71, 36864
    ds_read_b64_tr_b16 v[44:45], v16 offset:8192
    ds_read_b64_tr_b16 v[46:47], v16 offset:9216
    s_waitcnt lgkmcnt(4)
    v_mfma_f32_16x16x32_bf16 v[128:131], v[48:51], v[96:99], v[128:131]
    buffer_load_dwordx4 v1, s[28:31], s65 offen offset:1024 sc1 lds
    v_mfma_f32_16x16x32_bf16 v[128:131], v[52:55], v[100:103], v[128:131]
    v_add_u32 v24, 0x10000, v24
    v_add_u32 v16, 0x10000, v16
    v_mfma_f32_16x16x32_bf16 v[132:135], v[48:51], v[104:107], v[132:135]
    ds_read_b128 v[64:67], v24 offset:16384
    v_accvgpr_read_b32 v31, a213
    v_mfma_f32_16x16x32_bf16 v[132:135], v[52:55], v[108:111], v[132:135]
    v_cvt_pk_bf16_f32 v34, v34, v31
    v_accvgpr_read_b32 v35, a214
    v_mfma_f32_16x16x32_bf16 v[136:139], v[48:51], v[112:115], v[136:139]
    v_accvgpr_read_b32 v31, a215
    v_cvt_pk_bf16_f32 v35, v35, v31
    v_mfma_f32_16x16x32_bf16 v[136:139], v[52:55], v[116:119], v[136:139]
    buffer_store_dwordx4 v[32:35], v1, s[36:39], s72 offen sc1
    v_mfma_f32_16x16x32_bf16 v[140:143], v[48:51], v[120:123], v[140:143]
    ds_read_b64_tr_b16 v[48:49], v17 offset:0
    ds_read_b64_tr_b16 v[50:51], v17 offset:1024
    v_mfma_f32_16x16x32_bf16 v[140:143], v[52:55], v[124:127], v[140:143]
    ds_read_b64_tr_b16 v[52:53], v17 offset:8192
    ds_read_b64_tr_b16 v[54:55], v17 offset:9216
    v_mfma_f32_16x16x32_bf16 v[144:147], v[56:59], v[96:99], v[144:147]
    v_add_u32 v17, 0x10000, v17
    v_accvgpr_write_b32 a200, 0
    v_mfma_f32_16x16x32_bf16 v[144:147], v[60:63], v[100:103], v[144:147]
    s_add_u32 m0, s69, 16384
    v_accvgpr_write_b32 a201, 0
    v_accvgpr_write_b32 a202, 0
    v_mfma_f32_16x16x32_bf16 v[148:151], v[56:59], v[104:107], v[148:151]
    s_xor_b32 s65, s65, 8192
    buffer_load_dwordx4 v10, s[20:23], s64 offen lds
    v_mfma_f32_16x16x32_bf16 v[148:151], v[60:63], v[108:111], v[148:151]
    v_accvgpr_write_b32 a203, 0
    v_accvgpr_write_b32 a204, 0
    v_mfma_f32_16x16x32_bf16 v[152:155], v[56:59], v[112:115], v[152:155]
    v_add_u32 v25, 0x10000, v25
    v_accvgpr_read_b32 v32, a216
    v_mfma_f32_16x16x32_bf16 v[152:155], v[60:63], v[116:119], v[152:155]
    ds_read_b128 v[68:71], v25 offset:16384
    v_accvgpr_read_b32 v31, a217
    v_mfma_f32_16x16x32_bf16 v[156:159], v[56:59], v[120:123], v[156:159]
    ds_read_b64_tr_b16 v[56:57], v18 offset:0
    ds_read_b64_tr_b16 v[58:59], v18 offset:1024
    v_mfma_f32_16x16x32_bf16 v[156:159], v[60:63], v[124:127], v[156:159]
    s_waitcnt lgkmcnt(3)
    ds_read_b64_tr_b16 v[60:61], v18 offset:8192
    ds_read_b64_tr_b16 v[62:63], v18 offset:9216
    v_mfma_f32_16x16x32_bf16 v[160:163], v[40:43], v[96:99], v[160:163]
    v_add_u32 v18, 0x10000, v18
    v_cvt_pk_bf16_f32 v32, v32, v31
    v_mfma_f32_16x16x32_bf16 v[160:163], v[44:47], v[100:103], v[160:163]
    v_accvgpr_read_b32 v33, a218
    v_accvgpr_read_b32 v31, a219
    v_mfma_f32_16x16x32_bf16 v[164:167], v[40:43], v[104:107], v[164:167]
    v_cvt_pk_bf16_f32 v33, v33, v31
    v_accvgpr_read_b32 v34, a220
    v_mfma_f32_16x16x32_bf16 v[164:167], v[44:47], v[108:111], v[164:167]
    v_accvgpr_read_b32 v31, a221
    v_cvt_pk_bf16_f32 v34, v34, v31
    v_mfma_f32_16x16x32_bf16 v[168:171], v[40:43], v[112:115], v[168:171]
    buffer_load_dwordx4 v11, s[20:23], s64 offen offset:1024 lds
    v_mfma_f32_16x16x32_bf16 v[168:171], v[44:47], v[116:119], v[168:171]
    v_accvgpr_read_b32 v35, a222
    v_accvgpr_read_b32 v31, a223
    v_mfma_f32_16x16x32_bf16 v[172:175], v[40:43], v[120:123], v[172:175]
    ds_read_b64_tr_b16 v[40:41], v19 offset:0
    ds_read_b64_tr_b16 v[42:43], v19 offset:1024
    v_mfma_f32_16x16x32_bf16 v[172:175], v[44:47], v[124:127], v[172:175]
    s_add_u32 s72, s71, 37888
    ds_read_b64_tr_b16 v[44:45], v19 offset:8192
    ds_read_b64_tr_b16 v[46:47], v19 offset:9216
    v_mfma_f32_16x16x32_bf16 v[176:179], v[48:51], v[96:99], v[176:179]
    ds_read_b128 v[72:75], v24 offset:24576
    v_add_u32 v19, 0x10000, v19
    v_mfma_f32_16x16x32_bf16 v[176:179], v[52:55], v[100:103], v[176:179]
    v_cvt_pk_bf16_f32 v35, v35, v31
    v_accvgpr_write_b32 a205, 0
    v_mfma_f32_16x16x32_bf16 v[180:183], v[48:51], v[104:107], v[180:183]
    buffer_store_dwordx4 v[32:35], v1, s[36:39], s72 offen sc1
    v_mfma_f32_16x16x32_bf16 v[180:183], v[52:55], v[108:111], v[180:183]
    v_accvgpr_write_b32 a206, 0
    v_accvgpr_write_b32 a207, 0
    v_mfma_f32_16x16x32_bf16 v[184:187], v[48:51], v[112:115], v[184:187]
    v_accvgpr_write_b32 a208, 0
    v_accvgpr_write_b32 a209, 0
    v_mfma_f32_16x16x32_bf16 v[184:187], v[52:55], v[116:119], v[184:187]
    v_accvgpr_write_b32 a210, 0
    v_accvgpr_write_b32 a211, 0
    v_mfma_f32_16x16x32_bf16 v[188:191], v[48:51], v[120:123], v[188:191]
    buffer_load_dwordx4 v12, s[20:23], s64 offen offset:2048 lds
    v_mfma_f32_16x16x32_bf16 v[188:191], v[52:55], v[124:127], v[188:191]
    s_waitcnt lgkmcnt(0)
    ds_read_b64_tr_b16 v[48:49], v20 offset:0
    ds_read_b64_tr_b16 v[50:51], v20 offset:1024
    v_mfma_f32_16x16x32_bf16 v[192:195], v[56:59], v[96:99], v[192:195]
    ds_read_b64_tr_b16 v[52:53], v20 offset:8192
    ds_read_b64_tr_b16 v[54:55], v20 offset:9216
    v_mfma_f32_16x16x32_bf16 v[192:195], v[60:63], v[100:103], v[192:195]
    v_add_u32 v20, 0x10000, v20
    v_accvgpr_write_b32 a212, 0
    v_mfma_f32_16x16x32_bf16 v[196:199], v[56:59], v[104:107], v[196:199]
    v_accvgpr_write_b32 a213, 0
    v_accvgpr_write_b32 a214, 0
    v_mfma_f32_16x16x32_bf16 v[196:199], v[60:63], v[108:111], v[196:199]
    ds_read_b128 v[76:79], v25 offset:24576
    v_accvgpr_write_b32 a215, 0
    v_mfma_f32_16x16x32_bf16 v[200:203], v[56:59], v[112:115], v[200:203]
    v_accvgpr_read_b32 v32, a224
    v_accvgpr_read_b32 v31, a225
    v_mfma_f32_16x16x32_bf16 v[200:203], v[60:63], v[116:119], v[200:203]
    v_cvt_pk_bf16_f32 v32, v32, v31
    v_accvgpr_read_b32 v33, a226
    v_mfma_f32_16x16x32_bf16 v[204:207], v[56:59], v[120:123], v[204:207]
    ds_read_b64_tr_b16 v[56:57], v21 offset:0
    ds_read_b64_tr_b16 v[58:59], v21 offset:1024
    v_mfma_f32_16x16x32_bf16 v[204:207], v[60:63], v[124:127], v[204:207]
    ds_read_b64_tr_b16 v[60:61], v21 offset:8192
    ds_read_b64_tr_b16 v[62:63], v21 offset:9216
    v_mfma_f32_16x16x32_bf16 v[208:211], v[40:43], v[96:99], v[208:211]
    buffer_load_dwordx4 v13, s[20:23], s64 offen offset:3072 lds
    v_mfma_f32_16x16x32_bf16 v[208:211], v[44:47], v[100:103], v[208:211]
    v_add_u32 v21, 0x10000, v21
    v_accvgpr_read_b32 v31, a227
    v_mfma_f32_16x16x32_bf16 v[212:215], v[40:43], v[104:107], v[212:215]
    v_cvt_pk_bf16_f32 v33, v33, v31
    v_accvgpr_read_b32 v34, a228
    v_mfma_f32_16x16x32_bf16 v[212:215], v[44:47], v[108:111], v[212:215]
    v_accvgpr_read_b32 v31, a229
    v_cvt_pk_bf16_f32 v34, v34, v31
    v_mfma_f32_16x16x32_bf16 v[216:219], v[40:43], v[112:115], v[216:219]
    v_accvgpr_read_b32 v35, a230
    v_accvgpr_read_b32 v31, a231
    v_mfma_f32_16x16x32_bf16 v[216:219], v[44:47], v[116:119], v[216:219]
    v_cvt_pk_bf16_f32 v35, v35, v31
    v_accvgpr_write_b32 a216, 0
    v_mfma_f32_16x16x32_bf16 v[220:223], v[40:43], v[120:123], v[220:223]
    ds_read_b64_tr_b16 v[40:41], v26 offset:32768
    ds_read_b64_tr_b16 v[42:43], v26 offset:33280
    v_mfma_f32_16x16x32_bf16 v[220:223], v[44:47], v[124:127], v[220:223]
    s_add_u32 s72, s71, 6144
    ds_read_b64_tr_b16 v[44:45], v26 offset:36864
    ds_read_b64_tr_b16 v[46:47], v26 offset:37376
    s_waitcnt lgkmcnt(4)
    v_mfma_f32_16x16x32_bf16 v[224:227], v[48:51], v[96:99], v[224:227]
    v_add_u32 v26, 0xffff0000, v26
    v_accvgpr_write_b32 a217, 0
    v_mfma_f32_16x16x32_bf16 v[224:227], v[52:55], v[100:103], v[224:227]
    s_xor_b32 s64, s64, 1920
    buffer_store_dwordx4 v[32:35], v1, s[36:39], s72 offen sc1
    v_mfma_f32_16x16x32_bf16 v[228:231], v[48:51], v[104:107], v[228:231]
    s_andn2_b32 s64, s64, 896
    v_accvgpr_write_b32 a218, 0
    v_accvgpr_write_b32 a219, 0
    v_mfma_f32_16x16x32_bf16 v[228:231], v[52:55], v[108:111], v[228:231]
    v_accvgpr_write_b32 a220, 0
    v_accvgpr_write_b32 a221, 0
    v_mfma_f32_16x16x32_bf16 v[232:235], v[48:51], v[112:115], v[232:235]
    v_accvgpr_write_b32 a222, 0
    v_accvgpr_write_b32 a223, 0
    v_mfma_f32_16x16x32_bf16 v[232:235], v[52:55], v[116:119], v[232:235]
    s_add_u32 m0, s69, 32768
    v_mfma_f32_16x16x32_bf16 v[236:239], v[48:51], v[120:123], v[236:239]
    buffer_load_dwordx4 v2, s[24:27], s60 offen lds
    v_mfma_f32_16x16x32_bf16 v[236:239], v[52:55], v[124:127], v[236:239]
    ds_read_b64_tr_b16 v[48:49], v27 offset:32768
    ds_read_b64_tr_b16 v[50:51], v27 offset:33280
    v_mfma_f32_16x16x32_bf16 v[240:243], v[56:59], v[96:99], v[240:243]
    ds_read_b64_tr_b16 v[52:53], v27 offset:36864
    ds_read_b64_tr_b16 v[54:55], v27 offset:37376
    v_mfma_f32_16x16x32_bf16 v[240:243], v[60:63], v[100:103], v[240:243]
    buffer_load_dwordx4 v3, s[24:27], s60 offen offset:1024 lds
    v_mfma_f32_16x16x32_bf16 v[244:247], v[56:59], v[104:107], v[244:247]
    v_add_u32 v27, 0xffff0000, v27
    v_mfma_f32_16x16x32_bf16 v[244:247], v[60:63], v[108:111], v[244:247]
    v_mfma_f32_16x16x32_bf16 v[248:251], v[56:59], v[112:115], v[248:251]
    v_accvgpr_read_b32 v32, a232
    v_accvgpr_read_b32 v31, a233
    v_mfma_f32_16x16x32_bf16 v[248:251], v[60:63], v[116:119], v[248:251]
    buffer_load_dwordx4 v4, s[24:27], s60 offen offset:2048 lds
    v_mfma_f32_16x16x32_bf16 v[252:255], v[56:59], v[120:123], v[252:255]
    ds_read_b64_tr_b16 v[56:57], v28 offset:32768
    ds_read_b64_tr_b16 v[58:59], v28 offset:33280
    v_mfma_f32_16x16x32_bf16 v[252:255], v[60:63], v[124:127], v[252:255]
    s_waitcnt lgkmcnt(2)
    ds_read_b64_tr_b16 v[60:61], v28 offset:36864
    ds_read_b64_tr_b16 v[62:63], v28 offset:37376
    v_mfma_f32_16x16x32_bf16 a[64:67], v[40:43], v[96:99], a[64:67]
    buffer_load_dwordx4 v5, s[24:27], s60 offen offset:3072 lds
    v_mfma_f32_16x16x32_bf16 a[64:67], v[44:47], v[100:103], a[64:67]
    v_add_u32 v28, 0xffff0000, v28
    v_cvt_pk_bf16_f32 v32, v32, v31
    v_mfma_f32_16x16x32_bf16 a[68:71], v[40:43], v[104:107], a[68:71]
    ds_read_b128 v[80:83], v24 offset:49152
    v_accvgpr_read_b32 v33, a234
    v_mfma_f32_16x16x32_bf16 a[68:71], v[44:47], v[108:111], a[68:71]
    s_xor_b32 s60, s60, 7864320
    v_accvgpr_read_b32 v31, a235
    v_cvt_pk_bf16_f32 v33, v33, v31
    v_mfma_f32_16x16x32_bf16 a[72:75], v[40:43], v[112:115], a[72:75]
    s_add_u32 m0, s69, 49152
    v_accvgpr_read_b32 v34, a236
    v_accvgpr_read_b32 v31, a237
    v_mfma_f32_16x16x32_bf16 a[72:75], v[44:47], v[116:119], a[72:75]
    s_andn2_b32 s60, s60, 3670016
    buffer_load_dwordx4 v10, s[20:23], s63 offen lds
    v_mfma_f32_16x16x32_bf16 a[76:79], v[40:43], v[120:123], a[76:79]
    ds_read_b128 v[84:87], v25 offset:49152
    ds_read_b64_tr_b16 v[40:41], v29 offset:32768
    v_mfma_f32_16x16x32_bf16 a[76:79], v[44:47], v[124:127], a[76:79]
    s_add_u32 s72, s71, 7168
    buffer_load_dwordx4 v11, s[20:23], s63 offen offset:1024 lds
    v_mfma_f32_16x16x32_bf16 a[80:83], v[48:51], v[96:99], a[80:83]
    ds_read_b128 v[88:91], v24 offset:57344
    ds_read_b64_tr_b16 v[42:43], v29 offset:33280
    v_mfma_f32_16x16x32_bf16 a[80:83], v[52:55], v[100:103], a[80:83]
    ds_read_b64_tr_b16 v[44:45], v29 offset:36864
    ds_read_b64_tr_b16 v[46:47], v29 offset:37376
    v_mfma_f32_16x16x32_bf16 a[84:87], v[48:51], v[104:107], a[84:87]
    v_add_u32 v29, 0xffff0000, v29
    v_cvt_pk_bf16_f32 v34, v34, v31
    v_mfma_f32_16x16x32_bf16 a[84:87], v[52:55], v[108:111], a[84:87]
    buffer_load_dwordx4 v12, s[20:23], s63 offen offset:2048 lds
    v_mfma_f32_16x16x32_bf16 a[88:91], v[48:51], v[112:115], a[88:91]
    ds_read_b128 v[92:95], v25 offset:57344
    v_accvgpr_read_b32 v35, a238
    v_mfma_f32_16x16x32_bf16 a[88:91], v[52:55], v[116:119], a[88:91]
    v_accvgpr_read_b32 v31, a239
    v_cvt_pk_bf16_f32 v35, v35, v31
    v_mfma_f32_16x16x32_bf16 a[92:95], v[48:51], v[120:123], a[92:95]
    buffer_load_dwordx4 v13, s[20:23], s63 offen offset:3072 lds
    v_mfma_f32_16x16x32_bf16 a[92:95], v[52:55], v[124:127], a[92:95]
    s_waitcnt lgkmcnt(1)
    v_mfma_f32_16x16x32_bf16 a[96:99], v[56:59], v[96:99], a[96:99]
    v_mfma_f32_16x16x32_bf16 a[96:99], v[60:63], v[100:103], a[96:99]
    s_xor_b32 s63, s63, 128
    v_mfma_f32_16x16x32_bf16 a[100:103], v[56:59], v[104:107], a[100:103]
    buffer_store_dwordx4 v[32:35], v1, s[36:39], s72 offen sc1
    v_mfma_f32_16x16x32_bf16 a[100:103], v[60:63], v[108:111], a[100:103]
    v_mfma_f32_16x16x32_bf16 a[104:107], v[56:59], v[112:115], a[104:107]
    v_accvgpr_read_b32 v32, a240
    v_accvgpr_read_b32 v31, a241
    v_mfma_f32_16x16x32_bf16 a[104:107], v[60:63], v[116:119], a[104:107]
    s_waitcnt vmcnt(10) lgkmcnt(0)
    s_barrier
    ds_read_b64_tr_b16 v[48:49], v14 offset:0
    v_mfma_f32_16x16x32_bf16 a[108:111], v[56:59], v[120:123], a[108:111]
    s_add_u32 m0, s69, 65536
    ds_read_b64_tr_b16 v[50:51], v14 offset:1024
    ds_read_b64_tr_b16 v[52:53], v14 offset:8192
    v_mfma_f32_16x16x32_bf16 a[108:111], v[60:63], v[124:127], a[108:111]
    buffer_load_dwordx4 v2, s[24:27], s60 offen lds
    v_mfma_f32_16x16x32_bf16 a[112:115], v[40:43], v[96:99], a[112:115]
    ds_read_b64_tr_b16 v[54:55], v14 offset:9216
    ds_read_b64_tr_b16 v[56:57], v15 offset:0
    v_mfma_f32_16x16x32_bf16 a[112:115], v[44:47], v[100:103], a[112:115]
    ds_read_b64_tr_b16 v[58:59], v15 offset:1024
    ds_read_b64_tr_b16 v[60:61], v15 offset:8192
    v_mfma_f32_16x16x32_bf16 a[116:119], v[40:43], v[104:107], a[116:119]
    ds_read_b64_tr_b16 v[62:63], v15 offset:9216
    v_add_u32 v14, 0xfffe0000, v14
    v_mfma_f32_16x16x32_bf16 a[116:119], v[44:47], v[108:111], a[116:119]
    v_add_u32 v15, 0xfffe0000, v15
    v_cvt_pk_bf16_f32 v32, v32, v31
    v_mfma_f32_16x16x32_bf16 a[120:123], v[40:43], v[112:115], a[120:123]
    v_accvgpr_read_b32 v33, a242
    v_accvgpr_read_b32 v31, a243
    v_mfma_f32_16x16x32_bf16 a[120:123], v[44:47], v[116:119], a[120:123]
    buffer_load_dwordx4 v3, s[24:27], s60 offen offset:1024 lds
    v_mfma_f32_16x16x32_bf16 a[124:127], v[40:43], v[120:123], a[124:127]
    ds_read_b64_tr_b16 v[40:41], v16 offset:0
    ds_read_b64_tr_b16 v[42:43], v16 offset:1024
    v_mfma_f32_16x16x32_bf16 a[124:127], v[44:47], v[124:127], a[124:127]
    s_add_u32 s72, s71, 38912
    ds_read_b64_tr_b16 v[44:45], v16 offset:8192
    ds_read_b64_tr_b16 v[46:47], v16 offset:9216
    s_waitcnt lgkmcnt(4)
    v_mfma_f32_16x16x32_bf16 v[128:131], v[48:51], v[64:67], v[128:131]
    v_add_u32 v16, 0xfffe0000, v16
    v_cvt_pk_bf16_f32 v33, v33, v31
    v_mfma_f32_16x16x32_bf16 v[128:131], v[52:55], v[68:71], v[128:131]
    v_add_u32 v24, 0x10000, v24
    v_accvgpr_read_b32 v34, a244
    v_mfma_f32_16x16x32_bf16 v[132:135], v[48:51], v[72:75], v[132:135]
    ds_read_b128 v[96:99], v24 offset:16384
    v_accvgpr_read_b32 v31, a245
    v_mfma_f32_16x16x32_bf16 v[132:135], v[52:55], v[76:79], v[132:135]
    v_cvt_pk_bf16_f32 v34, v34, v31
    v_accvgpr_read_b32 v35, a246
    v_mfma_f32_16x16x32_bf16 v[136:139], v[48:51], v[80:83], v[136:139]
    v_accvgpr_read_b32 v31, a247
    v_cvt_pk_bf16_f32 v35, v35, v31
    v_mfma_f32_16x16x32_bf16 v[136:139], v[52:55], v[84:87], v[136:139]
    buffer_load_dwordx4 v4, s[24:27], s60 offen offset:2048 lds
    v_mfma_f32_16x16x32_bf16 v[140:143], v[48:51], v[88:91], v[140:143]
    ds_read_b64_tr_b16 v[48:49], v17 offset:0
    ds_read_b64_tr_b16 v[50:51], v17 offset:1024
    v_mfma_f32_16x16x32_bf16 v[140:143], v[52:55], v[92:95], v[140:143]
    ds_read_b64_tr_b16 v[52:53], v17 offset:8192
    ds_read_b64_tr_b16 v[54:55], v17 offset:9216
    v_mfma_f32_16x16x32_bf16 v[144:147], v[56:59], v[64:67], v[144:147]
    v_add_u32 v17, 0xfffe0000, v17
    v_mov_b32 v2, v1
    v_mfma_f32_16x16x32_bf16 v[144:147], v[60:63], v[68:71], v[144:147]
    buffer_store_dwordx4 v[32:35], v1, s[36:39], s72 offen sc1
    v_mfma_f32_16x16x32_bf16 v[148:151], v[56:59], v[72:75], v[148:151]
    v_mfma_f32_16x16x32_bf16 v[148:151], v[60:63], v[76:79], v[148:151]
    v_mfma_f32_16x16x32_bf16 v[152:155], v[56:59], v[80:83], v[152:155]
    v_add_u32 v25, 0x10000, v25
    v_accvgpr_read_b32 v32, a248
    v_mfma_f32_16x16x32_bf16 v[152:155], v[60:63], v[84:87], v[152:155]
    buffer_load_dwordx4 v5, s[24:27], s60 offen offset:3072 lds
    v_mfma_f32_16x16x32_bf16 v[156:159], v[56:59], v[88:91], v[156:159]
    ds_read_b128 v[100:103], v25 offset:16384
    ds_read_b64_tr_b16 v[56:57], v18 offset:0
    v_mfma_f32_16x16x32_bf16 v[156:159], v[60:63], v[92:95], v[156:159]
    s_waitcnt lgkmcnt(2)
    ds_read_b64_tr_b16 v[58:59], v18 offset:1024
    ds_read_b64_tr_b16 v[60:61], v18 offset:8192
    v_mfma_f32_16x16x32_bf16 v[160:163], v[40:43], v[64:67], v[160:163]
    ds_read_b64_tr_b16 v[62:63], v18 offset:9216
    v_add_u32 v18, 0xfffe0000, v18
    v_mfma_f32_16x16x32_bf16 v[160:163], v[44:47], v[68:71], v[160:163]
    v_accvgpr_read_b32 v31, a249
    v_cvt_pk_bf16_f32 v32, v32, v31
    v_mfma_f32_16x16x32_bf16 v[164:167], v[40:43], v[72:75], v[164:167]
    v_accvgpr_read_b32 v33, a250
    v_accvgpr_read_b32 v31, a251
    v_mfma_f32_16x16x32_bf16 v[164:167], v[44:47], v[76:79], v[164:167]
    s_add_u32 m0, s69, 81920
    v_cvt_pk_bf16_f32 v33, v33, v31
    v_accvgpr_read_b32 v34, a252
    v_mfma_f32_16x16x32_bf16 v[168:171], v[40:43], v[80:83], v[168:171]
    s_xor_b32 s60, s60, 524288
    buffer_load_dwordx4 v10, s[20:23], s64 offen lds
    v_mfma_f32_16x16x32_bf16 v[168:171], v[44:47], v[84:87], v[168:171]
    s_mov_b32 s60, 131072
    v_accvgpr_read_b32 v31, a253
    v_cvt_pk_bf16_f32 v34, v34, v31
    v_mfma_f32_16x16x32_bf16 v[172:175], v[40:43], v[88:91], v[172:175]
    ds_read_b64_tr_b16 v[40:41], v19 offset:0
    ds_read_b64_tr_b16 v[42:43], v19 offset:1024
    v_mfma_f32_16x16x32_bf16 v[172:175], v[44:47], v[92:95], v[172:175]
    s_add_u32 s72, s71, 39936
    ds_read_b64_tr_b16 v[44:45], v19 offset:8192
    ds_read_b64_tr_b16 v[46:47], v19 offset:9216
    v_mfma_f32_16x16x32_bf16 v[176:179], v[48:51], v[64:67], v[176:179]
    ds_read_b128 v[104:107], v24 offset:24576
    v_add_u32 v19, 0xfffe0000, v19
    v_mfma_f32_16x16x32_bf16 v[176:179], v[52:55], v[68:71], v[176:179]
    v_accvgpr_read_b32 v35, a254
    v_accvgpr_read_b32 v31, a255
    v_mfma_f32_16x16x32_bf16 v[180:183], v[48:51], v[72:75], v[180:183]
    v_cvt_pk_bf16_f32 v35, v35, v31
    v_mov_b32 v31, 1
    v_mfma_f32_16x16x32_bf16 v[180:183], v[52:55], v[76:79], v[180:183]
    buffer_load_dwordx4 v11, s[20:23], s64 offen offset:1024 lds
    v_mfma_f32_16x16x32_bf16 v[184:187], v[48:51], v[80:83], v[184:187]
    buffer_store_dwordx4 v[32:35], v1, s[36:39], s72 offen sc1
    v_mfma_f32_16x16x32_bf16 v[184:187], v[52:55], v[84:87], v[184:187]
    v_add_u32 v11, s99, v39
    v_mfma_f32_16x16x32_bf16 v[188:191], v[48:51], v[88:91], v[188:191]
    s_mul_i32 s99, s98, 6
    ds_read_b64_tr_b16 v[48:49], v20 offset:0
    ds_read_b64_tr_b16 v[50:51], v20 offset:1024
    v_mfma_f32_16x16x32_bf16 v[188:191], v[52:55], v[92:95], v[188:191]
    s_sub_u32 s99, s8, s99
    ds_read_b64_tr_b16 v[52:53], v20 offset:8192
    ds_read_b64_tr_b16 v[54:55], v20 offset:9216
    s_waitcnt lgkmcnt(4)
    v_mfma_f32_16x16x32_bf16 v[192:195], v[56:59], v[64:67], v[192:195]
    s_mul_i32 s99, s99, 6
    v_add_u32 v20, 0xfffe0000, v20
    v_mfma_f32_16x16x32_bf16 v[192:195], v[60:63], v[68:71], v[192:195]
    s_lshl1_add_u32 s99, s4, s99
    v_mfma_f32_16x16x32_bf16 v[196:199], v[56:59], v[72:75], v[196:199]
    s_sub_u32 s99, s99, 2
    v_mfma_f32_16x16x32_bf16 v[196:199], v[60:63], v[76:79], v[196:199]
    s_lshl_b32 s8, s99, 5
    buffer_load_dwordx4 v12, s[20:23], s64 offen offset:2048 lds
    v_mfma_f32_16x16x32_bf16 v[200:203], v[56:59], v[80:83], v[200:203]
    s_lshr_b32 s99, s99, 1
    ds_read_b128 v[108:111], v25 offset:24576
    v_lshl_add_u32 v10, v38, 4, s8
    v_mfma_f32_16x16x32_bf16 v[200:203], v[60:63], v[84:87], v[200:203]
    s_lshr_b32 s8, s5, 3
    v_lshrrev_b32 v38, 3, v37
    v_mul_u32_u24 v39, 18, v38
    v_mfma_f32_16x16x32_bf16 v[204:207], v[56:59], v[88:91], v[204:207]
    s_mul_i32 s8, s8, 6
    ds_read_b64_tr_b16 v[56:57], v21 offset:0
    ds_read_b64_tr_b16 v[58:59], v21 offset:1024
    v_mfma_f32_16x16x32_bf16 v[204:207], v[60:63], v[92:95], v[204:207]
    ds_read_b64_tr_b16 v[60:61], v21 offset:8192
    ds_read_b64_tr_b16 v[62:63], v21 offset:9216
    v_mfma_f32_16x16x32_bf16 v[208:211], v[40:43], v[64:67], v[208:211]
    v_add_u32 v21, 0xfffe0000, v21
    v_and_b32 v38, 4, v37
    v_mfma_f32_16x16x32_bf16 v[208:211], v[44:47], v[68:71], v[208:211]
    s_cmp_lt_u32 s98, 5
    s_cselect_b32 s98, s98, 40
    v_lshl_add_u32 v39, v38, 1, v39
    v_mfma_f32_16x16x32_bf16 v[212:215], v[40:43], v[72:75], v[212:215]
    s_lshl1_add_u32 s9, s98, s9
    buffer_load_dwordx4 v13, s[20:23], s64 offen offset:3072 lds
    v_mfma_f32_16x16x32_bf16 v[212:215], v[44:47], v[76:79], v[212:215]
    s_mul_i32 s9, s9, 18
    v_lshrrev_b32 v38, 2, v37
    v_mul_u32_u24 v38, 36, v38
    v_mfma_f32_16x16x32_bf16 v[216:219], v[40:43], v[80:83], v[216:219]
    v_add_u32 v39, s9, v39
    v_add_u32 v38, s10, v38
    v_mfma_f32_16x16x32_bf16 v[216:219], v[44:47], v[84:87], v[216:219]
    s_cmp_eq_u32 s98, 4
    s_cselect_b64 vcc, -1, 0
    v_and_b32 v37, 3, v37
    v_mfma_f32_16x16x32_bf16 v[220:223], v[40:43], v[88:91], v[220:223]
    ds_read_b64_tr_b16 v[40:41], v26 offset:0
    ds_read_b64_tr_b16 v[42:43], v26 offset:512
    v_mfma_f32_16x16x32_bf16 v[220:223], v[44:47], v[92:95], v[220:223]
    s_waitcnt lgkmcnt(2)
    ds_read_b64_tr_b16 v[44:45], v26 offset:4096
    ds_read_b64_tr_b16 v[46:47], v26 offset:4608
    v_mfma_f32_16x16x32_bf16 v[224:227], v[48:51], v[64:67], v[224:227]
    v_add_u32 v26, 0x10000, v26
    v_cndmask_b32 v39, v39, v38, vcc
    v_mfma_f32_16x16x32_bf16 v[224:227], v[52:55], v[68:71], v[224:227]
    s_xor_b32 s64, s64, 128
    v_add_u32 v39, v39, v37
    v_mul_u32_u24 v39, 1152, v39
    v_mfma_f32_16x16x32_bf16 v[228:231], v[48:51], v[72:75], v[228:231]
    s_cmp_eq_u32 s98, 4
    s_cselect_b32 s9, 18, 4
    s_cselect_b32 s10, 2, 4
    v_mfma_f32_16x16x32_bf16 v[228:231], v[52:55], v[76:79], v[228:231]
    s_mul_i32 s9, s9, 1152
    v_add_u32 v39, v39, v10
    v_mov_b32 v38, 1073741824
    v_mfma_f32_16x16x32_bf16 v[232:235], v[48:51], v[80:83], v[232:235]
    s_add_u32 s98, s98, s8
    v_cmp_gt_u32 vcc, s10, v37
    v_lshrrev_b32 v37, 8, v1
    v_mfma_f32_16x16x32_bf16 v[232:235], v[52:55], v[84:87], v[232:235]
    s_add_u32 m0, s67, 98304
    v_cndmask_b32 v12, v38, v39, vcc
    v_add_u32 v38, 1024, v36
    v_mfma_f32_16x16x32_bf16 v[236:239], v[48:51], v[88:91], v[236:239]
    s_add_u32 s98, s98, 128
    buffer_load_dwordx4 v1, s[28:31], s65 offen sc1 lds
    v_mfma_f32_16x16x32_bf16 v[236:239], v[52:55], v[92:95], v[236:239]
    s_add_u32 s8, s100, 16
    ds_read_b64_tr_b16 v[48:49], v27 offset:0
    ds_read_b64_tr_b16 v[50:51], v27 offset:512
    v_mfma_f32_16x16x32_bf16 v[240:243], v[56:59], v[64:67], v[240:243]
    s_lshr_b32 s10, s5, 3
    ds_read_b64_tr_b16 v[52:53], v27 offset:4096
    ds_read_b64_tr_b16 v[54:55], v27 offset:4608
    v_mfma_f32_16x16x32_bf16 v[240:243], v[60:63], v[68:71], v[240:243]
    v_add_u32 v27, 0x10000, v27
    v_add_u32 v13, s9, v12
    v_mfma_f32_16x16x32_bf16 v[244:247], v[56:59], v[72:75], v[244:247]
    s_cmp_eq_u32 s4, 0
    s_cselect_b64 vcc, -1, 0
    v_cndmask_b32 v12, v12, v38, vcc
    v_mfma_f32_16x16x32_bf16 v[244:247], v[60:63], v[76:79], v[244:247]
    v_add_u32 v38, 19456, v36
    v_bfe_u32 v36, v1, 4, 4
    v_mfma_f32_16x16x32_bf16 v[248:251], v[56:59], v[80:83], v[248:251]
    s_cmp_eq_u32 s4, 0
    s_cselect_b64 vcc, -1, 0
    v_cndmask_b32 v13, v13, v38, vcc
    v_mfma_f32_16x16x32_bf16 v[248:251], v[60:63], v[84:87], v[248:251]
    s_cmp_eq_u32 s4, 0
    s_cselect_b32 s98, s7, s98
    s_cselect_b32 s99, s8, s99
    v_mfma_f32_16x16x32_bf16 v[252:255], v[56:59], v[88:91], v[252:255]
    s_lshr_b32 s9, s99, 2
    ds_read_b64_tr_b16 v[56:57], v28 offset:0
    ds_read_b64_tr_b16 v[58:59], v28 offset:512
    v_mfma_f32_16x16x32_bf16 v[252:255], v[60:63], v[92:95], v[252:255]
    s_sub_u32 s9, s9, s10
    ds_read_b64_tr_b16 v[60:61], v28 offset:4096
    ds_read_b64_tr_b16 v[62:63], v28 offset:4608
    s_waitcnt lgkmcnt(4)
    v_mfma_f32_16x16x32_bf16 a[64:67], v[40:43], v[64:67], a[64:67]
    s_lshr_b32 s92, s2, 3
    v_lshrrev_b32 v9, 4, v1
    v_min_u32 v9, 0, v9
    v_mfma_f32_16x16x32_bf16 a[64:67], v[44:47], v[68:71], a[64:67]
    s_lshl2_add_u32 s92, s92, s4
    v_add_u32 v24, 0xfffe0000, v24
    v_add_u32 v28, 0x10000, v28
    v_mfma_f32_16x16x32_bf16 a[68:71], v[40:43], v[72:75], a[68:71]
    s_mul_i32 s92, s92, 1
    ds_read_b128 v[112:115], v24 offset:16384
    v_lshlrev_b32 v37, 2, v37
    v_mfma_f32_16x16x32_bf16 a[68:71], v[44:47], v[76:79], a[68:71]
    s_add_u32 s92, s92, 32
    v_add_lshl_u32 v9, v9, s92, 7
    v_sub_u32 v36, v36, v37
    v_mfma_f32_16x16x32_bf16 a[72:75], v[40:43], v[80:83], a[72:75]
    s_sub_u32 s9, s9, 1
    v_add_u32 v25, 0xfffe0000, v25
    v_mov_b32 v37, 0xf149f2ca
    v_mfma_f32_16x16x32_bf16 a[72:75], v[44:47], v[84:87], a[72:75]
    s_getpc_b64 s[92:93]
    global_load_dword v9, v9, s[92:93]
    v_mfma_f32_16x16x32_bf16 a[76:79], v[40:43], v[88:91], a[76:79]
    s_and_b32 s9, s9, 3
    buffer_load_dwordx4 v1, s[28:31], s65 offen offset:1024 sc1 lds
    v_mfma_f32_16x16x32_bf16 a[76:79], v[44:47], v[92:95], a[76:79]
    s_lshl_b32 s9, s9, 1
    ds_read_b128 v[116:119], v25 offset:16384
    ds_read_b64_tr_b16 v[40:41], v29 offset:0
    v_mfma_f32_16x16x32_bf16 a[80:83], v[48:51], v[64:67], a[80:83]
    s_and_b32 s10, s99, 3
    ds_read_b128 v[120:123], v24 offset:24576
    v_bfe_u32 v38, v1, 4, 1
    v_mfma_f32_16x16x32_bf16 a[80:83], v[52:55], v[68:71], a[80:83]
    s_mul_i32 s10, s10, 9
    ds_read_b64_tr_b16 v[42:43], v29 offset:512
    ds_read_b64_tr_b16 v[44:45], v29 offset:4096
    v_mfma_f32_16x16x32_bf16 a[84:87], v[48:51], v[72:75], a[84:87]
    s_mul_i32 s98, s98, 36864
    ds_read_b64_tr_b16 v[46:47], v29 offset:4608
    v_add_u32 v29, 0x10000, v29
    v_mfma_f32_16x16x32_bf16 a[84:87], v[52:55], v[76:79], a[84:87]
    s_mul_i32 s7, s7, 36864
    ds_read_b128 v[124:127], v25 offset:24576
    v_sub_u32 v38, 0, v38
    v_mfma_f32_16x16x32_bf16 a[88:91], v[48:51], v[80:83], a[88:91]
    s_cmp_eq_u32 s9, 6
    s_cselect_b32 s9, 7, s9
    v_and_b32 v38, 0xaaaaaaaa, v38
    v_mfma_f32_16x16x32_bf16 a[88:91], v[52:55], v[84:87], a[88:91]
    s_add_u32 s9, s9, s10
    v_and_b32 v39, 0x40, v1
    v_mfma_f32_16x16x32_bf16 a[92:95], v[48:51], v[88:91], a[92:95]
    s_lshl_b32 s64, s9, 10
    v_mfma_f32_16x16x32_bf16 a[92:95], v[52:55], v[92:95], a[92:95]
    s_sub_u32 s9, s99, 16
    s_waitcnt lgkmcnt(1)
    v_mfma_f32_16x16x32_bf16 a[96:99], v[56:59], v[64:67], a[96:99]
    s_mul_i32 s9, s9, 18432
    v_mfma_f32_16x16x32_bf16 a[96:99], v[60:63], v[68:71], a[96:99]
    s_xor_b32 s65, s65, 122880
    v_mfma_f32_16x16x32_bf16 a[100:103], v[56:59], v[72:75], a[100:103]
    s_andn2_b32 s65, s65, 57344
    v_mfma_f32_16x16x32_bf16 a[100:103], v[60:63], v[76:79], a[100:103]
    s_add_u32 s9, s9, 6144
    v_mfma_f32_16x16x32_bf16 a[104:107], v[56:59], v[80:83], a[104:107]
    s_mov_b32 s10, 1024
    v_mfma_f32_16x16x32_bf16 a[104:107], v[60:63], v[84:87], a[104:107]
    s_waitcnt vmcnt(3) lgkmcnt(0)
    s_barrier
    ds_read_b64_tr_b16 v[48:49], v14 offset:32768
    v_mfma_f32_16x16x32_bf16 a[108:111], v[56:59], v[88:91], a[108:111]
    s_add_u32 m0, s67, 131072
    buffer_store_dword v31, v30, s[32:35], s101 offen sc1
    v_mfma_f32_16x16x32_bf16 a[108:111], v[60:63], v[92:95], a[108:111]
    s_mov_b32 s93, 65536
    buffer_load_dwordx4 v1, s[28:31], s65 offen sc1 lds
    v_mfma_f32_16x16x32_bf16 a[112:115], v[40:43], v[64:67], a[112:115]
    ds_read_b64_tr_b16 v[50:51], v14 offset:33792
    ds_read_b64_tr_b16 v[52:53], v14 offset:40960
    v_mfma_f32_16x16x32_bf16 a[112:115], v[44:47], v[68:71], a[112:115]
    ds_read_b64_tr_b16 v[54:55], v14 offset:41984
    ds_read_b64_tr_b16 v[56:57], v15 offset:32768
    v_mfma_f32_16x16x32_bf16 a[116:119], v[40:43], v[72:75], a[116:119]
    ds_read_b64_tr_b16 v[58:59], v15 offset:33792
    ds_read_b64_tr_b16 v[60:61], v15 offset:40960
    v_mfma_f32_16x16x32_bf16 a[116:119], v[44:47], v[76:79], a[116:119]
    ds_read_b64_tr_b16 v[62:63], v15 offset:41984
    v_add_u32 v14, 0x10000, v14
    v_mfma_f32_16x16x32_bf16 a[120:123], v[40:43], v[80:83], a[120:123]
    v_add_u32 v15, 0x10000, v15
    v_mfma_f32_16x16x32_bf16 a[120:123], v[44:47], v[84:87], a[120:123]
    s_cmp_lt_u32 s99, 16
    s_cselect_b32 s64, s64, s9
    s_cselect_b32 s10, s10, 9216
    v_mfma_f32_16x16x32_bf16 a[124:127], v[40:43], v[88:91], a[124:127]
    s_lshl2_add_u32 s99, s100, s4
    ds_read_b64_tr_b16 v[40:41], v16 offset:32768
    ds_read_b64_tr_b16 v[42:43], v16 offset:33792
    v_mfma_f32_16x16x32_bf16 a[124:127], v[44:47], v[92:95], a[124:127]
    s_add_u32 s64, s64, s98
    ds_read_b64_tr_b16 v[44:45], v16 offset:40960
    ds_read_b64_tr_b16 v[46:47], v16 offset:41984
    s_waitcnt lgkmcnt(5)
    v_mfma_f32_16x16x32_bf16 v[128:131], v[48:51], v[96:99], v[128:131]
    s_lshl_b32 s99, s99, 1
    v_add_u32 v16, 0x10000, v16
    v_mfma_f32_16x16x32_bf16 v[128:131], v[52:55], v[100:103], v[128:131]
    s_add_u32 s62, s64, s10
    v_mfma_f32_16x16x32_bf16 v[132:135], v[48:51], v[104:107], v[132:135]
    s_lshr_b32 s9, s99, 2
    ds_read_b128 v[64:67], v24 offset:49152
    v_mfma_f32_16x16x32_bf16 v[132:135], v[52:55], v[108:111], v[132:135]
    s_lshr_b32 s10, s5, 3
    v_mfma_f32_16x16x32_bf16 v[136:139], v[48:51], v[112:115], v[136:139]
    s_sub_u32 s9, s9, s10
    v_mfma_f32_16x16x32_bf16 v[136:139], v[52:55], v[116:119], v[136:139]
    s_sub_u32 s9, s9, 1
    v_mfma_f32_16x16x32_bf16 v[140:143], v[48:51], v[120:123], v[140:143]
    s_and_b32 s9, s9, 3
    ds_read_b64_tr_b16 v[48:49], v17 offset:32768
    ds_read_b64_tr_b16 v[50:51], v17 offset:33792
    v_mfma_f32_16x16x32_bf16 v[140:143], v[52:55], v[124:127], v[140:143]
    s_lshl_b32 s9, s9, 1
    ds_read_b64_tr_b16 v[52:53], v17 offset:40960
    ds_read_b64_tr_b16 v[54:55], v17 offset:41984
    v_mfma_f32_16x16x32_bf16 v[144:147], v[56:59], v[96:99], v[144:147]
    s_and_b32 s10, s99, 3
    ds_read_b128 v[68:71], v25 offset:49152
    v_add_u32 v17, 0x10000, v17
    s_waitcnt lgkmcnt(5)
    v_mfma_f32_16x16x32_bf16 v[144:147], v[60:63], v[100:103], v[144:147]
    s_cmp_eq_u32 s9, 6
    s_cselect_b32 s9, 7, s9
    v_mfma_f32_16x16x32_bf16 v[148:151], v[56:59], v[104:107], v[148:151]
    s_mul_i32 s10, s10, 9
    v_mfma_f32_16x16x32_bf16 v[148:151], v[60:63], v[108:111], v[148:151]
    s_add_u32 s9, s9, s10
    v_mfma_f32_16x16x32_bf16 v[152:155], v[56:59], v[112:115], v[152:155]
    s_lshl_b32 s63, s9, 10
    v_mfma_f32_16x16x32_bf16 v[152:155], v[60:63], v[116:119], v[152:155]
    s_cmp_eq_u32 s4, 0
    s_cselect_b32 s8, 1.0, 0
    v_mfma_f32_16x16x32_bf16 v[156:159], v[56:59], v[120:123], v[156:159]
    s_add_u32 s63, s63, s7
    ds_read_b128 v[72:75], v24 offset:57344
    ds_read_b64_tr_b16 v[56:57], v18 offset:32768
    v_mfma_f32_16x16x32_bf16 v[156:159], v[60:63], v[124:127], v[156:159]
    ds_read_b64_tr_b16 v[58:59], v18 offset:33792
    ds_read_b64_tr_b16 v[60:61], v18 offset:40960
    v_mfma_f32_16x16x32_bf16 v[160:163], v[40:43], v[96:99], v[160:163]
    ds_read_b64_tr_b16 v[62:63], v18 offset:41984
    v_add_u32 v18, 0x10000, v18
    v_mfma_f32_16x16x32_bf16 v[160:163], v[44:47], v[100:103], v[160:163]
    s_cmp_eq_u32 s4, 1
    s_cselect_b32 s9, 1.0, 0
    v_mfma_f32_16x16x32_bf16 v[164:167], v[40:43], v[104:107], v[164:167]
    s_cmp_eq_u32 s6, 0
    s_cselect_b32 s16, s8, 0
    s_cselect_b32 s17, s9, 0
    v_mfma_f32_16x16x32_bf16 v[164:167], v[44:47], v[108:111], v[164:167]
    s_cmp_eq_u32 s4, 2
    s_cselect_b32 s10, 1.0, 0
    v_mfma_f32_16x16x32_bf16 v[168:171], v[40:43], v[112:115], v[168:171]
    buffer_load_dwordx4 v1, s[28:31], s65 offen offset:1024 sc1 lds
    v_mfma_f32_16x16x32_bf16 v[168:171], v[44:47], v[116:119], v[168:171]
    ds_read_b128 v[76:79], v25 offset:57344
    v_mfma_f32_16x16x32_bf16 v[172:175], v[40:43], v[120:123], v[172:175]
    ds_read_b64_tr_b16 v[40:41], v19 offset:32768
    ds_read_b64_tr_b16 v[42:43], v19 offset:33792
    v_mfma_f32_16x16x32_bf16 v[172:175], v[44:47], v[124:127], v[172:175]
    s_waitcnt lgkmcnt(3)
    ds_read_b64_tr_b16 v[44:45], v19 offset:40960
    ds_read_b64_tr_b16 v[46:47], v19 offset:41984
    v_mfma_f32_16x16x32_bf16 v[176:179], v[48:51], v[96:99], v[176:179]
    v_add_u32 v19, 0x10000, v19
    v_mfma_f32_16x16x32_bf16 v[176:179], v[52:55], v[100:103], v[176:179]
    s_cmp_eq_u32 s6, 0
    s_cselect_b32 s18, s10, 0
    s_cselect_b32 s19, s11, 0
    v_mfma_f32_16x16x32_bf16 v[180:183], v[48:51], v[104:107], v[180:183]
    s_cmp_eq_u32 s6, 0
    s_cselect_b32 s20, s12, 0
    s_cselect_b32 s21, s13, 0
    v_mfma_f32_16x16x32_bf16 v[180:183], v[52:55], v[108:111], v[180:183]
    v_add_u32 v24, 0x10000, v24
    v_mfma_f32_16x16x32_bf16 v[184:187], v[48:51], v[112:115], v[184:187]
    ds_read_b128 v[80:83], v24 offset:16384
    v_mfma_f32_16x16x32_bf16 v[184:187], v[52:55], v[116:119], v[184:187]
    s_cmp_eq_u32 s6, 0
    s_cselect_b32 s22, s14, 0
    s_cselect_b32 s23, s15, 0
    v_mfma_f32_16x16x32_bf16 v[188:191], v[48:51], v[120:123], v[188:191]
    ds_read_b64_tr_b16 v[48:49], v20 offset:32768
    ds_read_b64_tr_b16 v[50:51], v20 offset:33792
    v_mfma_f32_16x16x32_bf16 v[188:191], v[52:55], v[124:127], v[188:191]
    ds_read_b64_tr_b16 v[52:53], v20 offset:40960
    ds_read_b64_tr_b16 v[54:55], v20 offset:41984
    v_mfma_f32_16x16x32_bf16 v[192:195], v[56:59], v[96:99], v[192:195]
    v_add_u32 v20, 0x10000, v20
    v_mfma_f32_16x16x32_bf16 v[192:195], v[60:63], v[100:103], v[192:195]
    v_add_u32 v25, 0x10000, v25
    v_mfma_f32_16x16x32_bf16 v[196:199], v[56:59], v[104:107], v[196:199]
    ds_read_b128 v[84:87], v25 offset:16384
    v_mfma_f32_16x16x32_bf16 v[196:199], v[60:63], v[108:111], v[196:199]
    v_mfma_f32_16x16x32_bf16 v[200:203], v[56:59], v[112:115], v[200:203]
    v_mfma_f32_16x16x32_bf16 v[200:203], v[60:63], v[116:119], v[200:203]
    v_mfma_f32_16x16x32_bf16 v[204:207], v[56:59], v[120:123], v[204:207]
    ds_read_b64_tr_b16 v[56:57], v21 offset:32768
    ds_read_b64_tr_b16 v[58:59], v21 offset:33792
    v_mfma_f32_16x16x32_bf16 v[204:207], v[60:63], v[124:127], v[204:207]
    s_waitcnt lgkmcnt(2)
    ds_read_b64_tr_b16 v[60:61], v21 offset:40960
    ds_read_b64_tr_b16 v[62:63], v21 offset:41984
    v_mfma_f32_16x16x32_bf16 v[208:211], v[40:43], v[96:99], v[208:211]
    ds_read_b128 v[88:91], v24 offset:24576
    v_add_u32 v21, 0x10000, v21
    v_mfma_f32_16x16x32_bf16 v[208:211], v[44:47], v[100:103], v[208:211]
    v_mfma_f32_16x16x32_bf16 v[212:215], v[40:43], v[104:107], v[212:215]
    v_mfma_f32_16x16x32_bf16 v[212:215], v[44:47], v[108:111], v[212:215]
    v_mfma_f32_16x16x32_bf16 v[216:219], v[40:43], v[112:115], v[216:219]
    v_mfma_f32_16x16x32_bf16 v[216:219], v[44:47], v[116:119], v[216:219]
    v_mfma_f32_16x16x32_bf16 v[220:223], v[40:43], v[120:123], v[220:223]
    ds_read_b128 v[92:95], v25 offset:24576
    ds_read_b64_tr_b16 v[40:41], v14 offset:0
    v_mfma_f32_16x16x32_bf16 v[220:223], v[44:47], v[124:127], v[220:223]
    ds_read_b64_tr_b16 v[42:43], v14 offset:1024
    ds_read_b64_tr_b16 v[44:45], v14 offset:8192
    v_mfma_f32_16x16x32_bf16 v[224:227], v[48:51], v[96:99], v[224:227]
    ds_read_b64_tr_b16 v[46:47], v14 offset:9216
    v_mfma_f32_16x16x32_bf16 v[224:227], v[52:55], v[100:103], v[224:227]
    s_xor_b32 s65, s65, 8192
    v_mfma_f32_16x16x32_bf16 v[228:231], v[48:51], v[104:107], v[228:231]
    v_mfma_f32_16x16x32_bf16 v[228:231], v[52:55], v[108:111], v[228:231]
    v_mfma_f32_16x16x32_bf16 v[232:235], v[48:51], v[112:115], v[232:235]
    v_mfma_f32_16x16x32_bf16 v[232:235], v[52:55], v[116:119], v[232:235]
    v_mfma_f32_16x16x32_bf16 v[236:239], v[48:51], v[120:123], v[236:239]
    ds_read_b64_tr_b16 v[48:49], v15 offset:0
    ds_read_b64_tr_b16 v[50:51], v15 offset:1024
    v_mfma_f32_16x16x32_bf16 v[236:239], v[52:55], v[124:127], v[236:239]
    s_waitcnt lgkmcnt(2)
    ds_read_b64_tr_b16 v[52:53], v15 offset:8192
    ds_read_b64_tr_b16 v[54:55], v15 offset:9216
    v_mfma_f32_16x16x32_bf16 v[240:243], v[56:59], v[96:99], v[240:243]
    v_mfma_f32_16x16x32_bf16 v[240:243], v[60:63], v[100:103], v[240:243]
    v_mfma_f32_16x16x32_bf16 v[244:247], v[56:59], v[104:107], v[244:247]
    v_mfma_f32_16x16x32_bf16 v[244:247], v[60:63], v[108:111], v[244:247]
    v_mfma_f32_16x16x32_bf16 v[248:251], v[56:59], v[112:115], v[248:251]
    v_mfma_f32_16x16x32_bf16 v[248:251], v[60:63], v[116:119], v[248:251]
    v_mfma_f32_16x16x32_bf16 v[252:255], v[56:59], v[120:123], v[252:255]
    ds_read_b64_tr_b16 v[56:57], v16 offset:0
    ds_read_b64_tr_b16 v[58:59], v16 offset:1024
    v_mfma_f32_16x16x32_bf16 v[252:255], v[60:63], v[124:127], v[252:255]
    buffer_load_dword v7, v8, s[32:35], s61 offen sc1
    v_mfma_f32_16x16x32_bf16 v[128:131], v[40:43], v[64:67], v[128:131]
    ds_read_b64_tr_b16 v[60:61], v16 offset:8192
    ds_read_b64_tr_b16 v[62:63], v16 offset:9216
    v_mfma_f32_16x16x32_bf16 v[128:131], v[44:47], v[68:71], v[128:131]
    v_mfma_f32_16x16x32_bf16 v[132:135], v[40:43], v[72:75], v[132:135]
    v_mfma_f32_16x16x32_bf16 v[132:135], v[44:47], v[76:79], v[132:135]
    v_mfma_f32_16x16x32_bf16 v[136:139], v[40:43], v[80:83], v[136:139]
    v_mfma_f32_16x16x32_bf16 v[136:139], v[44:47], v[84:87], v[136:139]
    v_mfma_f32_16x16x32_bf16 v[140:143], v[40:43], v[88:91], v[140:143]
    ds_read_b64_tr_b16 v[40:41], v17 offset:0
    ds_read_b64_tr_b16 v[42:43], v17 offset:1024
    v_mfma_f32_16x16x32_bf16 v[140:143], v[44:47], v[92:95], v[140:143]
    s_waitcnt lgkmcnt(2)
    ds_read_b64_tr_b16 v[44:45], v17 offset:8192
    ds_read_b64_tr_b16 v[46:47], v17 offset:9216
    v_mfma_f32_16x16x32_bf16 v[144:147], v[48:51], v[64:67], v[144:147]
    v_cvt_pk_bf16_f32 v128, v128, v129
    v_cvt_pk_bf16_f32 v129, v130, v131
    v_mfma_f32_16x16x32_bf16 v[144:147], v[52:55], v[68:71], v[144:147]
    v_cvt_pk_bf16_f32 v132, v132, v133
    v_cvt_pk_bf16_f32 v133, v134, v135
    v_mfma_f32_16x16x32_bf16 v[148:151], v[48:51], v[72:75], v[148:151]
    v_cvt_pk_bf16_f32 v136, v136, v137
    v_cvt_pk_bf16_f32 v137, v138, v139
    v_mfma_f32_16x16x32_bf16 v[148:151], v[52:55], v[76:79], v[148:151]
    v_cvt_pk_bf16_f32 v140, v140, v141
    v_cvt_pk_bf16_f32 v141, v142, v143
    v_mfma_f32_16x16x32_bf16 v[152:155], v[48:51], v[80:83], v[152:155]
    v_cvt_pk_bf16_f32 v130, v144, v145
    v_cvt_pk_bf16_f32 v131, v146, v147
    v_mfma_f32_16x16x32_bf16 v[152:155], v[52:55], v[84:87], v[152:155]
    v_mfma_f32_16x16x32_bf16 v[156:159], v[48:51], v[88:91], v[156:159]
    ds_read_b64_tr_b16 v[48:49], v18 offset:0
    ds_read_b64_tr_b16 v[50:51], v18 offset:1024
    v_mfma_f32_16x16x32_bf16 v[156:159], v[52:55], v[92:95], v[156:159]
    ds_read_b64_tr_b16 v[52:53], v18 offset:8192
    ds_read_b64_tr_b16 v[54:55], v18 offset:9216
    v_mfma_f32_16x16x32_bf16 v[160:163], v[56:59], v[64:67], v[160:163]
    v_cvt_pk_bf16_f32 v134, v148, v149
    v_cvt_pk_bf16_f32 v135, v150, v151
    v_mfma_f32_16x16x32_bf16 v[160:163], v[60:63], v[68:71], v[160:163]
    v_cvt_pk_bf16_f32 v138, v152, v153
    v_cvt_pk_bf16_f32 v139, v154, v155
    v_mfma_f32_16x16x32_bf16 v[164:167], v[56:59], v[72:75], v[164:167]
    v_cvt_pk_bf16_f32 v142, v156, v157
    v_cvt_pk_bf16_f32 v143, v158, v159
    v_mfma_f32_16x16x32_bf16 v[164:167], v[60:63], v[76:79], v[164:167]
    v_mfma_f32_16x16x32_bf16 v[168:171], v[56:59], v[80:83], v[168:171]
    v_mfma_f32_16x16x32_bf16 v[168:171], v[60:63], v[84:87], v[168:171]
    v_cvt_pk_bf16_f32 v160, v160, v161
    v_cvt_pk_bf16_f32 v161, v162, v163
    v_mfma_f32_16x16x32_bf16 v[172:175], v[56:59], v[88:91], v[172:175]
    ds_read_b64_tr_b16 v[56:57], v19 offset:0
    ds_read_b64_tr_b16 v[58:59], v19 offset:1024
    v_mfma_f32_16x16x32_bf16 v[172:175], v[60:63], v[92:95], v[172:175]
    s_waitcnt lgkmcnt(2)
    ds_read_b64_tr_b16 v[60:61], v19 offset:8192
    ds_read_b64_tr_b16 v[62:63], v19 offset:9216
    v_mfma_f32_16x16x32_bf16 v[176:179], v[40:43], v[64:67], v[176:179]
    v_cvt_pk_bf16_f32 v164, v164, v165
    v_cvt_pk_bf16_f32 v165, v166, v167
    v_mfma_f32_16x16x32_bf16 v[176:179], v[44:47], v[68:71], v[176:179]
    v_cvt_pk_bf16_f32 v168, v168, v169
    v_cvt_pk_bf16_f32 v169, v170, v171
    v_mfma_f32_16x16x32_bf16 v[180:183], v[40:43], v[72:75], v[180:183]
    v_cvt_pk_bf16_f32 v172, v172, v173
    v_cvt_pk_bf16_f32 v173, v174, v175
    v_mfma_f32_16x16x32_bf16 v[180:183], v[44:47], v[76:79], v[180:183]
    v_mfma_f32_16x16x32_bf16 v[184:187], v[40:43], v[80:83], v[184:187]
    v_mfma_f32_16x16x32_bf16 v[184:187], v[44:47], v[84:87], v[184:187]
    v_cvt_pk_bf16_f32 v162, v176, v177
    v_cvt_pk_bf16_f32 v163, v178, v179
    v_mfma_f32_16x16x32_bf16 v[188:191], v[40:43], v[88:91], v[188:191]
    ds_read_b64_tr_b16 v[40:41], v20 offset:0
    ds_read_b64_tr_b16 v[42:43], v20 offset:1024
    v_mfma_f32_16x16x32_bf16 v[188:191], v[44:47], v[92:95], v[188:191]
    ds_read_b64_tr_b16 v[44:45], v20 offset:8192
    ds_read_b64_tr_b16 v[46:47], v20 offset:9216
    v_mfma_f32_16x16x32_bf16 v[192:195], v[48:51], v[64:67], v[192:195]
    v_cvt_pk_bf16_f32 v166, v180, v181
    v_cvt_pk_bf16_f32 v167, v182, v183
    v_mfma_f32_16x16x32_bf16 v[192:195], v[52:55], v[68:71], v[192:195]
    v_cvt_pk_bf16_f32 v170, v184, v185
    v_cvt_pk_bf16_f32 v171, v186, v187
    s_waitcnt vmcnt(0)
    v_cmp_gt_u32 vcc, 1, v7
    s_nop 1
    s_and_b64 vcc, vcc, exec
    s_cbranch_scc1 SPIN_KV
BACK_KV:
    v_mfma_f32_16x16x32_bf16 v[196:199], v[48:51], v[72:75], v[196:199]
    s_mov_b32 s77, s75
    buffer_load_dwordx4 a[224:227], v1, s[36:39], 0 offen offset:0 sc1
    v_mfma_f32_16x16x32_bf16 v[196:199], v[52:55], v[76:79], v[196:199]
    buffer_load_dwordx4 a[228:231], v1, s[36:39], 0 offen offset:1024 sc1
    v_mfma_f32_16x16x32_bf16 v[200:203], v[48:51], v[80:83], v[200:203]
    v_cmp_le_i32 vcc, 0, v36
    v_cvt_pk_bf16_f32 v192, v192, v193
    v_mfma_f32_16x16x32_bf16 v[200:203], v[52:55], v[84:87], v[200:203]
    v_cvt_pk_bf16_f32 v193, v194, v195
    v_cvt_pk_bf16_f32 v174, v188, v189
    v_mfma_f32_16x16x32_bf16 v[204:207], v[48:51], v[88:91], v[204:207]
    buffer_load_dwordx4 a[232:235], v1, s[36:39], 0 offen offset:2048 sc1
    v_mfma_f32_16x16x32_bf16 v[204:207], v[52:55], v[92:95], v[204:207]
    s_waitcnt lgkmcnt(0)
    ds_read_b64_tr_b16 v[48:49], v21 offset:0
    ds_read_b64_tr_b16 v[50:51], v21 offset:1024
    v_mfma_f32_16x16x32_bf16 v[208:211], v[56:59], v[64:67], v[208:211]
    ds_read_b64_tr_b16 v[52:53], v21 offset:8192
    ds_read_b64_tr_b16 v[54:55], v21 offset:9216
    v_mfma_f32_16x16x32_bf16 v[208:211], v[60:63], v[68:71], v[208:211]
    v_cvt_pk_bf16_f32 v196, v196, v197
    v_cvt_pk_bf16_f32 v197, v198, v199
    v_mfma_f32_16x16x32_bf16 v[212:215], v[56:59], v[72:75], v[212:215]
    buffer_load_dwordx4 a[236:239], v1, s[36:39], 0 offen offset:3072 sc1
    v_mfma_f32_16x16x32_bf16 v[212:215], v[60:63], v[76:79], v[212:215]
    v_cvt_pk_bf16_f32 v200, v200, v201
    v_cvt_pk_bf16_f32 v201, v202, v203
    v_mfma_f32_16x16x32_bf16 v[216:219], v[56:59], v[80:83], v[216:219]
    v_cvt_pk_bf16_f32 v194, v208, v209
    v_cndmask_b32_e64 v208, v37, 0, vcc
    v_mfma_f32_16x16x32_bf16 v[216:219], v[60:63], v[84:87], v[216:219]
    v_mul_f32 v176, s16, v208
    v_cmp_le_i32 vcc, 1, v36
    v_mfma_f32_16x16x32_bf16 v[220:223], v[56:59], v[88:91], v[220:223]
    v_cvt_pk_bf16_f32 v195, v210, v211
    v_cndmask_b32_e64 v209, v37, 0, vcc
    v_mfma_f32_16x16x32_bf16 v[220:223], v[60:63], v[92:95], v[220:223]
    v_mul_f32 v177, s16, v209
    v_cmp_le_i32 vcc, 2, v36
    v_mfma_f32_16x16x32_bf16 v[224:227], v[40:43], v[64:67], v[224:227]
    s_mov_b32 s38, 16384
    v_cndmask_b32_e64 v210, v37, 0, vcc
    v_mul_f32 v178, s16, v210
    v_mfma_f32_16x16x32_bf16 v[224:227], v[44:47], v[68:71], v[224:227]
    s_add_u32 m0, s76, s75
    v_cmp_le_i32 vcc, 3, v36
    v_cvt_pk_bf16_f32 v198, v212, v213
    v_mfma_f32_16x16x32_bf16 v[228:231], v[40:43], v[72:75], v[228:231]
    buffer_load_dwordx4 v1, s[36:39], s77 offen sc1 lds
    v_mfma_f32_16x16x32_bf16 v[228:231], v[44:47], v[76:79], v[228:231]
    v_cndmask_b32_e64 v211, v37, 0, vcc
    v_mul_f32 v179, s16, v211
    v_mfma_f32_16x16x32_bf16 v[232:235], v[40:43], v[80:83], v[232:235]
    v_cvt_pk_bf16_f32 v224, v224, v225
    v_cvt_pk_bf16_f32 v225, v226, v227
    v_mfma_f32_16x16x32_bf16 v[232:235], v[44:47], v[84:87], v[232:235]
    s_waitcnt vmcnt(6) lgkmcnt(0)
    s_barrier
    ds_read_b64_tr_b16 v[56:57], v26 offset:32768
    v_mfma_f32_16x16x32_bf16 v[236:239], v[40:43], v[88:91], v[236:239]
    buffer_load_dwordx4 v1, s[36:39], s77 offen offset:1024 sc1 lds
    v_mfma_f32_16x16x32_bf16 v[236:239], v[44:47], v[92:95], v[236:239]
    ds_read_b64_tr_b16 v[58:59], v26 offset:33280
    ds_read_b64_tr_b16 v[60:61], v26 offset:36864
    v_mfma_f32_16x16x32_bf16 v[240:243], v[48:51], v[64:67], v[240:243]
    ds_read_b64_tr_b16 v[62:63], v26 offset:37376
    ds_read_b64_tr_b16 v[40:41], v27 offset:32768
    v_mfma_f32_16x16x32_bf16 v[240:243], v[52:55], v[68:71], v[240:243]
    ds_read_b64_tr_b16 v[42:43], v27 offset:33280
    ds_read_b64_tr_b16 v[44:45], v27 offset:36864
    v_mfma_f32_16x16x32_bf16 v[244:247], v[48:51], v[72:75], v[244:247]
    buffer_load_dwordx4 v1, s[36:39], s77 offen offset:2048 sc1 lds
    v_mfma_f32_16x16x32_bf16 v[244:247], v[52:55], v[76:79], v[244:247]
    ds_read_b64_tr_b16 v[46:47], v27 offset:37376
    v_add_u32 v26, 0x10000, v26
    v_mfma_f32_16x16x32_bf16 v[248:251], v[48:51], v[80:83], v[248:251]
    v_add_u32 v27, 0x10000, v27
    v_cvt_pk_bf16_f32 v226, v240, v241
    v_mfma_f32_16x16x32_bf16 v[248:251], v[52:55], v[84:87], v[248:251]
    v_cvt_pk_bf16_f32 v227, v242, v243
    v_cvt_pk_bf16_f32 v228, v228, v229
    v_mfma_f32_16x16x32_bf16 v[252:255], v[48:51], v[88:91], v[252:255]
    buffer_load_dwordx4 v1, s[36:39], s77 offen offset:3072 sc1 lds
    v_mfma_f32_16x16x32_bf16 v[252:255], v[52:55], v[92:95], v[252:255]
    s_waitcnt lgkmcnt(1)
    ds_read_b64_tr_b16 v[48:49], v28 offset:32768
    ds_read_b64_tr_b16 v[50:51], v28 offset:33280
    v_mfma_f32_16x16x32_bf16 a[64:67], v[56:59], v[96:99], a[64:67]
    s_add_u32 s100, s77, 4096
    ds_read_b64_tr_b16 v[52:53], v28 offset:36864
    ds_read_b64_tr_b16 v[54:55], v28 offset:37376
    v_mfma_f32_16x16x32_bf16 a[64:67], v[60:63], v[100:103], a[64:67]
    s_add_u32 m0, m0, 4096
    v_add_u32 v28, 0x10000, v28
    v_cvt_pk_bf16_f32 v229, v230, v231
    v_mfma_f32_16x16x32_bf16 a[68:71], v[56:59], v[104:107], a[68:71]
    buffer_load_dwordx4 v1, s[36:39], s100 offen sc1 lds
    v_mfma_f32_16x16x32_bf16 a[68:71], v[60:63], v[108:111], a[68:71]
    v_cvt_pk_bf16_f32 v230, v244, v245
    v_cvt_pk_bf16_f32 v231, v246, v247
    v_mfma_f32_16x16x32_bf16 a[72:75], v[56:59], v[112:115], a[72:75]
    v_cvt_pk_bf16_f32 v199, v214, v215
    v_cvt_pk_bf16_f32 v232, v232, v233
    v_mfma_f32_16x16x32_bf16 a[72:75], v[60:63], v[116:119], a[72:75]
    v_cvt_pk_bf16_f32 v233, v234, v235
    v_cvt_pk_bf16_f32 v234, v248, v249
    v_mfma_f32_16x16x32_bf16 a[76:79], v[56:59], v[120:123], a[76:79]
    buffer_load_dwordx4 v1, s[36:39], s100 offen offset:1024 sc1 lds
    v_mfma_f32_16x16x32_bf16 a[76:79], v[60:63], v[124:127], a[76:79]
    ds_read_b64_tr_b16 v[56:57], v29 offset:32768
    ds_read_b64_tr_b16 v[58:59], v29 offset:33280
    v_mfma_f32_16x16x32_bf16 a[80:83], v[40:43], v[96:99], a[80:83]
    s_waitcnt lgkmcnt(2)
    ds_read_b64_tr_b16 v[60:61], v29 offset:36864
    ds_read_b64_tr_b16 v[62:63], v29 offset:37376
    v_mfma_f32_16x16x32_bf16 a[80:83], v[44:47], v[100:103], a[80:83]
    v_add_u32 v29, 0x10000, v29
    v_cvt_pk_bf16_f32 v235, v250, v251
    v_mfma_f32_16x16x32_bf16 a[84:87], v[40:43], v[104:107], a[84:87]
    buffer_load_dwordx4 v1, s[36:39], s100 offen offset:2048 sc1 lds
    v_mfma_f32_16x16x32_bf16 a[84:87], v[44:47], v[108:111], a[84:87]
    v_cvt_pk_bf16_f32 v202, v216, v217
    v_cvt_pk_bf16_f32 v203, v218, v219
    v_mfma_f32_16x16x32_bf16 a[88:91], v[40:43], v[112:115], a[88:91]
    v_cvt_pk_bf16_f32 v175, v190, v191
    v_cvt_pk_bf16_f32 v236, v236, v237
    v_mfma_f32_16x16x32_bf16 a[88:91], v[44:47], v[116:119], a[88:91]
    v_cvt_pk_bf16_f32 v237, v238, v239
    v_cvt_pk_bf16_f32 v238, v252, v253
    v_mfma_f32_16x16x32_bf16 a[92:95], v[40:43], v[120:123], a[92:95]
    buffer_load_dwordx4 v1, s[36:39], s100 offen offset:3072 sc1 lds
    v_mfma_f32_16x16x32_bf16 a[92:95], v[44:47], v[124:127], a[92:95]
    s_waitcnt vmcnt(8)
    ds_read_b64_tr_b16 v[40:41], v26 offset:0
    ds_read_b64_tr_b16 v[42:43], v26 offset:512
    v_mfma_f32_16x16x32_bf16 v[240:243], a[224:227], v[128:131], v[176:179]
    s_lshr_b32 s82, s4, 1
    s_add_u32 s82, s82, 32
    ds_read_b64_tr_b16 v[44:45], v26 offset:4096
    v_mfma_f32_16x16x32_bf16 v[240:243], a[228:231], v[160:163], v[240:243]
    s_sub_u32 s82, s82, s6
    ds_read_b64_tr_b16 v[46:47], v26 offset:4608
    v_cvt_pk_bf16_f32 v239, v254, v255
    v_mfma_f32_16x16x32_bf16 v[240:243], a[232:235], v[192:195], v[240:243]
    s_add_u32 s76, s76, 32768
    s_sub_u32 s82, s82, s6
    v_cvt_pk_bf16_f32 v204, v204, v205
    v_mfma_f32_16x16x32_bf16 v[240:243], a[236:239], v[224:227], v[240:243]
    s_add_u32 s77, s77, 32768
    s_lshl_b32 s38, s82, 15
    s_add_u32 m0, s76, s75
    v_mfma_f32_16x16x32_bf16 v[244:247], a[224:227], v[132:135], 0
    s_mov_b32 s82, 0
    buffer_load_dwordx4 v1, s[36:39], s77 offen sc1 lds
    v_mfma_f32_16x16x32_bf16 v[244:247], a[228:231], v[164:167], v[244:247]
    v_cvt_pk_bf16_f32 v205, v206, v207
    v_max3_f32 v147, v240, v241, v242
    v_mfma_f32_16x16x32_bf16 v[244:247], a[232:235], v[196:199], v[244:247]
    buffer_load_dwordx4 v1, s[36:39], s77 offen offset:1024 sc1 lds
    v_mfma_f32_16x16x32_bf16 v[244:247], a[236:239], v[228:231], v[244:247]
    v_max_f32 v147, v147, v243
    v_mov_b32 v146, v147
    v_mfma_f32_16x16x32_bf16 v[248:251], a[224:227], v[136:139], 0
    v_cvt_pk_bf16_f32 v206, v220, v221
    v_permlane32_swap_b32 v147, v146
    v_mfma_f32_16x16x32_bf16 v[248:251], a[228:231], v[168:171], v[248:251]
    v_max_f32 v147, v147, v146
    v_mov_b32 v146, v147
    v_mfma_f32_16x16x32_bf16 v[248:251], a[232:235], v[200:203], v[248:251]
    buffer_load_dwordx4 v1, s[36:39], s77 offen offset:2048 sc1 lds
    v_mfma_f32_16x16x32_bf16 v[248:251], a[236:239], v[232:235], v[248:251]
    v_max3_f32 v151, v244, v245, v246
    v_max_f32 v151, v151, v247
    v_mfma_f32_16x16x32_bf16 v[252:255], a[224:227], v[140:143], 0
    v_mov_b32 v150, v151
    v_permlane16_swap_b32 v147, v146
    v_mfma_f32_16x16x32_bf16 v[252:255], a[228:231], v[172:175], v[252:255]
    v_permlane32_swap_b32 v151, v150
    v_max_f32 v151, v151, v150
    v_cvt_pk_bf16_f32 v207, v222, v223
    s_nop 1
    v_mfma_f32_16x16x32_bf16 v[252:255], a[232:235], v[204:207], v[252:255]
    buffer_load_dwordx4 v1, s[36:39], s77 offen offset:3072 sc1 lds
    v_mfma_f32_16x16x32_bf16 v[252:255], a[236:239], v[236:239], v[252:255]
    v_max3_f32 v155, v248, v249, v250
    v_max_f32 v155, v155, v251
    v_mfma_f32_16x16x32_bf16 a[96:99], v[48:51], v[96:99], a[96:99]
    s_add_u32 s100, s77, 4096
    v_mov_b32 v154, v155
    v_mov_b32 v150, v151
    v_mfma_f32_16x16x32_bf16 a[96:99], v[52:55], v[100:103], a[96:99]
    s_add_u32 m0, m0, 4096
    v_max3_f32 v159, v252, v253, v254
    v_max_f32 v159, v159, v255
    v_mfma_f32_16x16x32_bf16 a[100:103], v[48:51], v[104:107], a[100:103]
    buffer_load_dwordx4 v1, s[36:39], s100 offen sc1 lds
    v_mfma_f32_16x16x32_bf16 a[100:103], v[52:55], v[108:111], a[100:103]
    v_mov_b32 v158, v159
    v_permlane32_swap_b32 v155, v154
    v_mfma_f32_16x16x32_bf16 a[104:107], v[48:51], v[112:115], a[104:107]
    v_permlane32_swap_b32 v159, v158
    v_max_f32 v155, v155, v154
    v_mfma_f32_16x16x32_bf16 a[104:107], v[52:55], v[116:119], a[104:107]
    v_max_f32 v159, v159, v158
    v_mov_b32 v154, v155
    v_mfma_f32_16x16x32_bf16 a[108:111], v[48:51], v[120:123], a[108:111]
    buffer_load_dwordx4 v1, s[36:39], s100 offen offset:1024 sc1 lds
    v_mfma_f32_16x16x32_bf16 a[108:111], v[52:55], v[124:127], a[108:111]
    s_waitcnt lgkmcnt(0)
    ds_read_b64_tr_b16 v[48:49], v27 offset:0
    ds_read_b64_tr_b16 v[50:51], v27 offset:512
    v_mfma_f32_16x16x32_bf16 a[112:115], v[56:59], v[96:99], a[112:115]
    ds_read_b64_tr_b16 v[52:53], v27 offset:4096
    ds_read_b64_tr_b16 v[54:55], v27 offset:4608
    v_mfma_f32_16x16x32_bf16 a[112:115], v[60:63], v[100:103], a[112:115]
    v_mov_b32 v158, v159
    v_permlane16_swap_b32 v151, v150
    v_mfma_f32_16x16x32_bf16 a[116:119], v[56:59], v[104:107], a[116:119]
    buffer_load_dwordx4 v1, s[36:39], s100 offen offset:2048 sc1 lds
    v_mfma_f32_16x16x32_bf16 a[116:119], v[60:63], v[108:111], a[116:119]
    v_permlane16_swap_b32 v155, v154
    v_permlane16_swap_b32 v159, v158
    v_mfma_f32_16x16x32_bf16 a[120:123], v[56:59], v[112:115], a[120:123]
    v_max_f32 v147, v147, v146
    v_max_f32 v151, v151, v150
    v_mfma_f32_16x16x32_bf16 a[120:123], v[60:63], v[116:119], a[120:123]
    v_max_f32 v155, v155, v154
    v_max_f32 v159, v159, v158
    v_mfma_f32_16x16x32_bf16 a[124:127], v[56:59], v[120:123], a[124:127]
    buffer_load_dwordx4 v1, s[36:39], s100 offen offset:3072 sc1 lds
    v_mfma_f32_16x16x32_bf16 a[124:127], v[60:63], v[124:127], a[124:127]
    ds_read_b64_tr_b16 v[56:57], v28 offset:0
    ds_read_b64_tr_b16 v[58:59], v28 offset:512
    v_mfma_f32_16x16x32_bf16 a[64:67], v[40:43], v[64:67], a[64:67]
    s_add_u32 s76, s76, 32768
    ds_read_b64_tr_b16 v[60:61], v28 offset:4096
    ds_read_b64_tr_b16 v[62:63], v28 offset:4608
    v_mfma_f32_16x16x32_bf16 a[64:67], v[44:47], v[68:71], a[64:67]
    s_add_u32 s77, s77, 32768
    v_sub_f32 v144, 0, v147
    v_sub_f32 v148, 0, v151
    v_mfma_f32_16x16x32_bf16 a[68:71], v[40:43], v[72:75], a[68:71]
    s_add_u32 m0, s76, s75
    v_sub_f32 v152, 0, v155
    v_sub_f32 v156, 0, v159
    v_mfma_f32_16x16x32_bf16 a[68:71], v[44:47], v[76:79], a[68:71]
    buffer_load_dwordx4 v1, s[36:39], s77 offen sc1 lds
    v_mfma_f32_16x16x32_bf16 a[72:75], v[40:43], v[80:83], a[72:75]
    v_sub_f32 v145, 0, v147
    v_sub_f32 v146, 0, v147
    v_mfma_f32_16x16x32_bf16 a[72:75], v[44:47], v[84:87], a[72:75]
    v_sub_f32 v147, 0, v147
    v_sub_f32 v149, 0, v151
    v_mfma_f32_16x16x32_bf16 a[76:79], v[40:43], v[88:91], a[76:79]
    buffer_load_dwordx4 v1, s[36:39], s77 offen offset:1024 sc1 lds
    v_mfma_f32_16x16x32_bf16 a[76:79], v[44:47], v[92:95], a[76:79]
    s_waitcnt lgkmcnt(0)
    ds_read_b64_tr_b16 v[40:41], v29 offset:0
    ds_read_b64_tr_b16 v[42:43], v29 offset:512
    v_mfma_f32_16x16x32_bf16 a[80:83], v[48:51], v[64:67], a[80:83]
    ds_read_b64_tr_b16 v[44:45], v29 offset:4096
    ds_read_b64_tr_b16 v[46:47], v29 offset:4608
    v_mfma_f32_16x16x32_bf16 a[80:83], v[52:55], v[68:71], a[80:83]
    v_sub_f32 v150, 0, v151
    v_sub_f32 v151, 0, v151
    v_mfma_f32_16x16x32_bf16 a[84:87], v[48:51], v[72:75], a[84:87]
    buffer_load_dwordx4 v1, s[36:39], s77 offen offset:2048 sc1 lds
    v_mfma_f32_16x16x32_bf16 a[84:87], v[52:55], v[76:79], a[84:87]
    v_sub_f32 v153, 0, v155
    v_sub_f32 v154, 0, v155
    v_mfma_f32_16x16x32_bf16 a[88:91], v[48:51], v[80:83], a[88:91]
    v_sub_f32 v155, 0, v155
    v_sub_f32 v157, 0, v159
    v_mfma_f32_16x16x32_bf16 a[88:91], v[52:55], v[84:87], a[88:91]
    v_sub_f32 v158, 0, v159
    v_sub_f32 v159, 0, v159
    v_mfma_f32_16x16x32_bf16 a[92:95], v[48:51], v[88:91], a[92:95]
    buffer_load_dwordx4 v1, s[36:39], s77 offen offset:3072 sc1 lds
    v_mfma_f32_16x16x32_bf16 a[92:95], v[52:55], v[92:95], a[92:95]
    v_or_b32 v215, 0x44444444, v38
    v_bfe_u32 v38, v1, 5, 1
    v_mfma_f32_16x16x32_bf16 a[96:99], v[56:59], v[64:67], a[96:99]
    s_add_u32 s100, s77, 4096
    v_cmp_eq_u32 vcc, 0, v38
    v_mov_b32 v38, 0x3f803f80
    v_mfma_f32_16x16x32_bf16 a[96:99], v[60:63], v[68:71], a[96:99]
    s_add_u32 m0, m0, 4096
    v_and_b32 v29, 0x380, v1
    v_cndmask_b32 v38, 0, v38, vcc
    v_mfma_f32_16x16x32_bf16 a[100:103], v[56:59], v[72:75], a[100:103]
    buffer_load_dwordx4 v1, s[36:39], s100 offen sc1 lds
    v_mfma_f32_16x16x32_bf16 a[100:103], v[60:63], v[76:79], a[100:103]
    v_add_f32 v240, v240, v144
    v_add_f32 v241, v241, v144
    v_mfma_f32_16x16x32_bf16 a[104:107], v[56:59], v[80:83], a[104:107]
    v_add_f32 v242, v242, v144
    v_add_f32 v243, v243, v144
    v_mfma_f32_16x16x32_bf16 a[104:107], v[60:63], v[84:87], a[104:107]
    s_waitcnt vmcnt(13) lgkmcnt(0)
    s_barrier
    ds_read_b128 a[240:243], v2 offset:4096
    v_mfma_f32_16x16x32_bf16 a[108:111], v[56:59], v[88:91], a[108:111]
    ds_read_b128 a[244:247], v2 offset:5120
    ds_read_b128 a[248:251], v2 offset:6144
    v_mfma_f32_16x16x32_bf16 a[108:111], v[60:63], v[92:95], a[108:111]
    buffer_load_dwordx4 v1, s[36:39], s100 offen offset:1024 sc1 lds
    v_mfma_f32_16x16x32_bf16 a[112:115], v[40:43], v[64:67], a[112:115]
    ds_read_b128 a[252:255], v2 offset:7168
    v_add_f32 v244, v244, v148
    v_mfma_f32_16x16x32_bf16 a[112:115], v[44:47], v[68:71], a[112:115]
    v_add_f32 v245, v245, v148
    v_add_f32 v246, v246, v148
    v_mfma_f32_16x16x32_bf16 a[116:119], v[40:43], v[72:75], a[116:119]
    buffer_load_dwordx4 v1, s[36:39], s100 offen offset:2048 sc1 lds
    v_mfma_f32_16x16x32_bf16 a[116:119], v[44:47], v[76:79], a[116:119]
    v_add_f32 v247, v247, v148
    v_add_f32 v248, v248, v152
    v_mfma_f32_16x16x32_bf16 a[120:123], v[40:43], v[80:83], a[120:123]
    v_add_f32 v249, v249, v152
    v_add_f32 v250, v250, v152
    v_mfma_f32_16x16x32_bf16 a[120:123], v[44:47], v[84:87], a[120:123]
    v_add_f32 v251, v251, v152
    v_add_f32 v252, v252, v156
    v_mfma_f32_16x16x32_bf16 a[124:127], v[40:43], v[88:91], a[124:127]
    buffer_load_dwordx4 v1, s[36:39], s100 offen offset:3072 sc1 lds
    v_mfma_f32_16x16x32_bf16 a[124:127], v[44:47], v[92:95], a[124:127]
    v_add_f32 v253, v253, v156
    v_add_f32 v254, v254, v156
    v_add_f32 v255, v255, v156
    v_lshl_add_u32 v29, v29, 4, v39
    v_bfe_u32 v39, v1, 2, 4
    v_accvgpr_write_b32 a136, v38
    v_accvgpr_write_b32 a137, v38
    v_accvgpr_write_b32 a138, v38
    v_accvgpr_write_b32 a139, v38
    v_exp_f32 v240, v240
    v_exp_f32 v241, v241
    v_exp_f32 v242, v242
    v_exp_f32 v243, v243
    v_exp_f32 v244, v244
    v_exp_f32 v245, v245
    v_exp_f32 v246, v246
    v_exp_f32 v247, v247
    v_exp_f32 v248, v248
    v_exp_f32 v249, v249
    v_exp_f32 v250, v250
    v_exp_f32 v251, v251
    v_exp_f32 v252, v252
    v_exp_f32 v253, v253
    v_exp_f32 v254, v254
    v_exp_f32 v255, v255
    buffer_store_dwordx4 a[68:71], v1, s[40:43], s84 offen offset:2048 sc1
    buffer_store_dwordx4 a[76:79], v1, s[40:43], s85 offen offset:2048 sc1
    buffer_store_dwordx4 a[84:87], v1, s[40:43], s84 offen offset:1024 sc1
    buffer_store_dwordx4 a[92:95], v1, s[40:43], s85 offen offset:1024 sc1
    buffer_store_dwordx4 a[100:103], v1, s[40:43], s84 offen offset:0 sc1
    buffer_store_dwordx4 a[108:111], v1, s[40:43], s85 offen offset:0 sc1
    v_lshl_add_u32 v29, v29, 1, v39
    s_add_u32 s77, s77, 32768
    s_add_u32 s76, s76, 32768
K1_ATT:
    v_cvt_pk_bf16_f32 v32, v240, v241
    v_cvt_pk_bf16_f32 v33, v242, v243
    v_add_f32 v213, s21, v144
    v_fma_f32 v180, v208, s17, v213
    v_fma_f32 v181, v209, s17, v213
    v_fma_f32 v182, v210, s17, v213
    v_fma_f32 v183, v211, s17, v213
    s_nop 1
    s_waitcnt lgkmcnt(0)
    v_mfma_f32_16x16x32_bf16 v[240:243], a[240:243], v[128:131], v[180:183]
    s_mov_b32 s99, s76
    v_cvt_pk_bf16_f32 v40, v244, v245
    v_cvt_pk_bf16_f32 v41, v246, v247
    v_mfma_f32_16x16x32_bf16 v[240:243], a[244:247], v[160:163], v[240:243]
    s_sub_u32 s7, 15, s6
    v_cvt_pk_bf16_f32 v48, v248, v249
    v_cvt_pk_bf16_f32 v49, v250, v251
    v_mfma_f32_16x16x32_bf16 v[240:243], a[248:251], v[192:195], v[240:243]
    s_lshl3_add_u32 s80, s6, s4
    ds_read_b128 a[224:227], v2 offset:8192
    ds_read_b128 a[228:231], v2 offset:9216
    v_mfma_f32_16x16x32_bf16 v[240:243], a[252:255], v[224:227], v[240:243]
    s_lshl3_add_u32 s81, s7, s4
    ds_read_b128 a[232:235], v2 offset:10240
    v_cvt_pk_bf16_f32 v56, v252, v253
    v_mfma_f32_16x16x32_bf16 v[244:247], a[240:243], v[132:135], v[148:151]
    s_add_u32 m0, s76, s75
    ds_read_b128 a[236:239], v2 offset:11264
    v_cvt_pk_bf16_f32 v57, v254, v255
    v_mfma_f32_16x16x32_bf16 v[244:247], a[244:247], v[164:167], v[244:247]
    s_mov_b32 s76, s60
    buffer_load_dwordx4 v1, s[36:39], s77 offen sc1 lds
    v_mfma_f32_16x16x32_bf16 v[244:247], a[248:251], v[196:199], v[244:247]
    s_mov_b32 s60, s82
    v_exp_f32 v240, v240
    v_mfma_f32_16x16x32_bf16 v[244:247], a[252:255], v[228:231], v[244:247]
    s_mov_b32 s82, s95
    buffer_load_dwordx4 v1, s[36:39], s77 offen offset:1024 sc1 lds
    v_mfma_f32_16x16x32_bf16 v[248:251], a[240:243], v[136:139], v[152:155]
    s_mov_b32 s95, s93
    v_exp_f32 v241, v241
    v_mfma_f32_16x16x32_bf16 v[248:251], a[244:247], v[168:171], v[248:251]
    s_mov_b32 s93, s99
    v_exp_f32 v242, v242
    v_mfma_f32_16x16x32_bf16 v[248:251], a[248:251], v[200:203], v[248:251]
    s_mul_i32 s80, s80, 155648
    buffer_load_dwordx4 v1, s[36:39], s77 offen offset:2048 sc1 lds
    v_mfma_f32_16x16x32_bf16 v[248:251], a[252:255], v[232:235], v[248:251]
    s_mul_i32 s81, s81, 155648
    v_exp_f32 v243, v243
    v_mfma_f32_16x16x32_bf16 v[252:255], a[240:243], v[140:143], v[156:159]
    s_lshl_b32 s7, s5, 12
    v_cvt_pk_bf16_f32 v34, v240, v241
    v_cvt_pk_bf16_f32 v35, v242, v243
    v_mfma_f32_16x16x32_bf16 v[252:255], a[244:247], v[172:175], v[252:255]
    s_add_u32 s80, s80, s7
    buffer_load_dwordx4 v1, s[36:39], s77 offen offset:3072 sc1 lds
    v_mfma_f32_16x16x32_bf16 v[252:255], a[248:251], v[204:207], v[252:255]
    s_add_u32 s81, s81, s7
    v_exp_f32 v244, v244
    v_mfma_f32_16x16x32_bf16 v[252:255], a[252:255], v[236:239], v[252:255]
    s_add_u32 s100, s77, 4096
    v_exp_f32 v245, v245
    v_add_f32 v212, s20, v144
    v_fma_f32 v176, v208, s16, v212
    v_fma_f32 v177, v209, s16, v212
    v_fma_f32 v178, v210, s16, v212
    v_fma_f32 v179, v211, s16, v212
    v_add_f32 v212, s22, v144
    v_fma_f32 v184, v208, s18, v212
    v_fma_f32 v185, v209, s18, v212
    v_fma_f32 v186, v210, s18, v212
    v_fma_f32 v187, v211, s18, v212
    s_nop 1
    s_waitcnt lgkmcnt(0)
    v_mfma_f32_16x16x32_bf16 v[240:243], a[224:227], v[128:131], v[184:187]
    s_add_u32 m0, m0, 4096
    v_exp_f32 v246, v246
    v_mfma_f32_16x16x32_bf16 v[240:243], a[228:231], v[160:163], v[240:243]
    s_lshr_b32 s7, s5, 3
    v_exp_f32 v247, v247
    v_mfma_f32_16x16x32_bf16 v[240:243], a[232:235], v[192:195], v[240:243]
    s_lshl2_add_u32 s7, s7, s4
    buffer_load_dwordx4 v1, s[36:39], s100 offen sc1 lds
    v_mfma_f32_16x16x32_bf16 v[240:243], a[236:239], v[224:227], v[240:243]
    s_lshl_b32 s7, s7, 8
    v_cvt_pk_bf16_f32 v42, v244, v245
    v_cvt_pk_bf16_f32 v43, v246, v247
    v_mfma_f32_16x16x32_bf16 v[244:247], a[224:227], v[132:135], v[148:151]
    s_mov_b64 s[84:85], 0
    v_exp_f32 v248, v248
    v_mfma_f32_16x16x32_bf16 v[244:247], a[228:231], v[164:167], v[244:247]
    s_add_u32 s92, s7, 163840
    buffer_load_dwordx4 v1, s[36:39], s100 offen offset:1024 sc1 lds
    v_mfma_f32_16x16x32_bf16 v[244:247], a[232:235], v[196:199], v[244:247]
    s_mov_b64 s[24:25], s[0:1]
    v_exp_f32 v249, v249
    v_mfma_f32_16x16x32_bf16 v[244:247], a[236:239], v[228:231], v[244:247]
    s_mov_b32 s78, s6
    v_exp_f32 v250, v250
    v_exp_f32 v251, v251
    v_cvt_pk_bf16_f32 v50, v248, v249
    v_cvt_pk_bf16_f32 v51, v250, v251
    v_mfma_f32_16x16x32_bf16 v[248:251], a[224:227], v[136:139], v[152:155]
    s_mov_b32 s26, 2359296
    ds_read_b128 a[240:243], v2 offset:12288
    ds_read_b128 a[244:247], v2 offset:13312
    v_mfma_f32_16x16x32_bf16 v[248:251], a[228:231], v[168:171], v[248:251]
    s_mov_b32 s27, 0x20000
    buffer_load_dwordx4 v1, s[36:39], s100 offen offset:2048 sc1 lds
    v_mfma_f32_16x16x32_bf16 v[248:251], a[232:235], v[200:203], v[248:251]
    s_add_u32 s77, s77, 32768
    ds_read_b128 a[248:251], v2 offset:14336
    ds_read_b128 a[252:255], v2 offset:15360
    v_mfma_f32_16x16x32_bf16 v[248:251], a[236:239], v[232:235], v[248:251]
    v_exp_f32 v252, v252
    v_exp_f32 v253, v253
    v_exp_f32 v254, v254
    v_exp_f32 v255, v255
    v_cvt_pk_bf16_f32 v58, v252, v253
    v_cvt_pk_bf16_f32 v59, v254, v255
    v_mfma_f32_16x16x32_bf16 v[252:255], a[224:227], v[140:143], v[156:159]
    v_add_f32 v213, s23, v144
    v_fma_f32 v188, v208, s19, v213
    v_mfma_f32_16x16x32_bf16 v[252:255], a[228:231], v[172:175], v[252:255]
    buffer_load_dwordx4 v1, s[36:39], s100 offen offset:3072 sc1 lds
    v_mfma_f32_16x16x32_bf16 v[252:255], a[232:235], v[204:207], v[252:255]
    v_exp_f32 v240, v240
    v_mfma_f32_16x16x32_bf16 v[252:255], a[236:239], v[236:239], v[252:255]
    s_waitcnt lgkmcnt(0)
    v_exp_f32 v241, v241
    v_exp_f32 v242, v242
    v_exp_f32 v243, v243
    v_fma_f32 v189, v209, s19, v213
    v_fma_f32 v190, v210, s19, v213
    v_fma_f32 v191, v211, s19, v213
    v_cvt_pk_bf16_f32 v36, v240, v241
    v_cvt_pk_bf16_f32 v37, v242, v243
    v_mfma_f32_16x16x32_bf16 v[240:243], a[240:243], v[128:131], v[188:191]
    v_exp_f32 v244, v244
    v_mfma_f32_16x16x32_bf16 v[240:243], a[244:247], v[160:163], v[240:243]
    v_exp_f32 v245, v245
    v_mfma_f32_16x16x32_bf16 v[240:243], a[248:251], v[192:195], v[240:243]
    s_waitcnt vmcnt(8) lgkmcnt(0)
    v_exp_f32 v246, v246
    v_mfma_f32_16x16x32_bf16 v[240:243], a[252:255], v[224:227], v[240:243]
    s_barrier
    v_exp_f32 v247, v247
    v_cvt_pk_bf16_f32 v44, v244, v245
    v_cvt_pk_bf16_f32 v45, v246, v247
    v_mfma_f32_16x16x32_bf16 v[244:247], a[240:243], v[132:135], v[148:151]
    v_add_u32 v2, s82, v1
    ds_read_b128 a[224:227], v2 offset:0
    v_mfma_f32_16x16x32_bf16 v[244:247], a[244:247], v[164:167], v[244:247]
    ds_read_b128 a[228:231], v2 offset:1024
    ds_read_b128 a[232:235], v2 offset:2048
    v_mfma_f32_16x16x32_bf16 v[244:247], a[248:251], v[196:199], v[244:247]
    v_exp_f32 v248, v248
    v_mfma_f32_16x16x32_bf16 v[244:247], a[252:255], v[228:231], v[244:247]
    v_exp_f32 v249, v249
    v_exp_f32 v250, v250
    v_exp_f32 v251, v251
    v_cvt_pk_bf16_f32 v52, v248, v249
    v_cvt_pk_bf16_f32 v53, v250, v251
    v_mfma_f32_16x16x32_bf16 v[248:251], a[240:243], v[136:139], v[152:155]
    ds_read_b128 a[236:239], v2 offset:3072
    ds_read_b128 v[96:99], v2 offset:16384
    v_mfma_f32_16x16x32_bf16 v[248:251], a[244:247], v[168:171], v[248:251]
    v_exp_f32 v252, v252
    v_mfma_f32_16x16x32_bf16 v[248:251], a[248:251], v[200:203], v[248:251]
    v_exp_f32 v253, v253
    v_mfma_f32_16x16x32_bf16 v[248:251], a[252:255], v[232:235], v[248:251]
    v_exp_f32 v254, v254
    v_exp_f32 v255, v255
    v_cvt_pk_bf16_f32 v60, v252, v253
    v_cvt_pk_bf16_f32 v61, v254, v255
    v_mfma_f32_16x16x32_bf16 v[252:255], a[240:243], v[140:143], v[156:159]
    ds_read_b128 v[100:103], v2 offset:17408
    v_mfma_f32_16x16x32_bf16 v[252:255], a[244:247], v[172:175], v[252:255]
    v_exp_f32 v240, v240
    v_mfma_f32_16x16x32_bf16 v[252:255], a[248:251], v[204:207], v[252:255]
    v_exp_f32 v241, v241
    v_mfma_f32_16x16x32_bf16 v[252:255], a[252:255], v[236:239], v[252:255]
    v_exp_f32 v242, v242
    v_exp_f32 v243, v243
    v_exp_f32 v244, v244
    v_exp_f32 v245, v245
    v_exp_f32 v246, v246
    v_exp_f32 v247, v247
    v_exp_f32 v248, v248
    v_exp_f32 v249, v249
    v_exp_f32 v250, v250
    v_exp_f32 v251, v251
    v_cvt_pk_bf16_f32 v38, v240, v241
    v_cvt_pk_bf16_f32 v39, v242, v243
    v_cvt_pk_bf16_f32 v46, v244, v245
    v_cvt_pk_bf16_f32 v47, v246, v247
    v_cvt_pk_bf16_f32 v54, v248, v249
    v_cvt_pk_bf16_f32 v55, v250, v251
    v_exp_f32 v252, v252
    v_mov_b32 v28, 2
    s_cmp_eq_u32 s4, 3
    s_cselect_b32 s7, s101, 1073741824
    v_lshlrev_b32 v31, 20, v1
    buffer_store_dword v28, v31, s[32:35], s7 offen sc1
    s_cmp_eq_u32 s78, 0
    s_cbranch_scc1 K1_LB_END
.p2align 3
K1_LB:
    s_waitcnt lgkmcnt(0)
    v_mfma_f32_16x16x32_bf16 v[240:243], a[224:227], v[128:131], v[176:179]
    s_mov_b32 s99, s76
    v_exp_f32 v253, v253
    v_mfma_f32_16x16x32_bf16 v[240:243], a[228:231], v[160:163], v[240:243]
    v_exp_f32 v254, v254
    v_mfma_f32_16x16x32_bf16 v[240:243], a[232:235], v[192:195], v[240:243]
    v_exp_f32 v255, v255
    v_mfma_f32_16x16x32_bf16 v[240:243], a[236:239], v[224:227], v[240:243]
    v_cvt_pk_bf16_f32 v62, v252, v253
    v_cvt_pk_bf16_f32 v63, v254, v255
    v_mfma_f32_16x16x32_bf16 a[0:3], v[96:99], v[32:35], a[0:3]
    s_add_u32 m0, s76, s75
    v_mfma_f32_16x16x32_bf16 a[0:3], v[100:103], v[36:39], a[0:3]
    s_mov_b32 s76, s60
    buffer_load_dwordx4 v1, s[36:39], s77 offen sc1 lds
    v_mfma_f32_16x16x32_bf16 a[4:7], v[96:99], v[40:43], a[4:7]
    s_mov_b32 s60, s82
    ds_read_b128 v[104:107], v2 offset:18432
    ds_read_b128 v[108:111], v2 offset:19456
    v_mfma_f32_16x16x32_bf16 a[4:7], v[100:103], v[44:47], a[4:7]
    s_mov_b32 s82, s95
    v_exp_f32 v240, v240
    v_mfma_f32_16x16x32_bf16 v[244:247], a[224:227], v[132:135], v[148:151]
    s_mov_b32 s95, s93
    v_exp_f32 v241, v241
    v_mfma_f32_16x16x32_bf16 v[244:247], a[228:231], v[164:167], v[244:247]
    s_mov_b32 s93, s99
    v_exp_f32 v242, v242
    v_mfma_f32_16x16x32_bf16 v[244:247], a[232:235], v[196:199], v[244:247]
    v_exp_f32 v243, v243
    v_mfma_f32_16x16x32_bf16 v[244:247], a[236:239], v[228:231], v[244:247]
    v_cvt_pk_bf16_f32 v64, v240, v241
    v_cvt_pk_bf16_f32 v65, v242, v243
    v_mfma_f32_16x16x32_bf16 a[8:11], v[96:99], v[48:51], a[8:11]
    v_mfma_f32_16x16x32_bf16 a[8:11], v[100:103], v[52:55], a[8:11]
    v_mfma_f32_16x16x32_bf16 a[12:15], v[96:99], v[56:59], a[12:15]
    v_mfma_f32_16x16x32_bf16 a[12:15], v[100:103], v[60:63], a[12:15]
    v_mfma_f32_16x16x32_bf16 v[248:251], a[224:227], v[136:139], v[152:155]
    v_mfma_f32_16x16x32_bf16 v[248:251], a[228:231], v[168:171], v[248:251]
    ds_read_b128 a[240:243], v2 offset:4096
    ds_read_b128 a[244:247], v2 offset:5120
    v_mfma_f32_16x16x32_bf16 v[248:251], a[232:235], v[200:203], v[248:251]
    buffer_load_dwordx4 v1, s[36:39], s77 offen offset:1024 sc1 lds
    v_mfma_f32_16x16x32_bf16 v[248:251], a[236:239], v[232:235], v[248:251]
    s_waitcnt lgkmcnt(2)
    ds_read_b128 a[248:251], v2 offset:6144
    ds_read_b128 a[252:255], v2 offset:7168
    v_mfma_f32_16x16x32_bf16 a[16:19], v[104:107], v[32:35], a[16:19]
    v_exp_f32 v244, v244
    v_mfma_f32_16x16x32_bf16 a[16:19], v[108:111], v[36:39], a[16:19]
    ds_read_b128 v[112:115], v2 offset:20480
    ds_read_b128 v[116:119], v2 offset:21504
    v_mfma_f32_16x16x32_bf16 a[20:23], v[104:107], v[40:43], a[20:23]
    v_exp_f32 v245, v245
    v_mfma_f32_16x16x32_bf16 a[20:23], v[108:111], v[44:47], a[20:23]
    v_exp_f32 v246, v246
    v_mfma_f32_16x16x32_bf16 v[252:255], a[224:227], v[140:143], v[156:159]
    v_exp_f32 v247, v247
    v_mfma_f32_16x16x32_bf16 v[252:255], a[228:231], v[172:175], v[252:255]
    v_cvt_pk_bf16_f32 v72, v244, v245
    v_cvt_pk_bf16_f32 v73, v246, v247
    v_mfma_f32_16x16x32_bf16 v[252:255], a[232:235], v[204:207], v[252:255]
    v_exp_f32 v248, v248
    v_mfma_f32_16x16x32_bf16 v[252:255], a[236:239], v[236:239], v[252:255]
    v_exp_f32 v249, v249
    v_mfma_f32_16x16x32_bf16 a[24:27], v[104:107], v[48:51], a[24:27]
    v_exp_f32 v250, v250
    v_mfma_f32_16x16x32_bf16 a[24:27], v[108:111], v[52:55], a[24:27]
    v_exp_f32 v251, v251
    v_mfma_f32_16x16x32_bf16 a[28:31], v[104:107], v[56:59], a[28:31]
    v_cvt_pk_bf16_f32 v80, v248, v249
    v_cvt_pk_bf16_f32 v81, v250, v251
    v_mfma_f32_16x16x32_bf16 a[28:31], v[108:111], v[60:63], a[28:31]
    s_waitcnt lgkmcnt(0)
    buffer_load_dwordx4 v1, s[36:39], s77 offen offset:2048 sc1 lds
    v_mfma_f32_16x16x32_bf16 v[240:243], a[240:243], v[128:131], v[180:183]
    v_exp_f32 v252, v252
    v_mfma_f32_16x16x32_bf16 v[240:243], a[244:247], v[160:163], v[240:243]
    v_exp_f32 v253, v253
    v_mfma_f32_16x16x32_bf16 v[240:243], a[248:251], v[192:195], v[240:243]
    v_exp_f32 v254, v254
    v_mfma_f32_16x16x32_bf16 v[240:243], a[252:255], v[224:227], v[240:243]
    v_exp_f32 v255, v255
    v_mfma_f32_16x16x32_bf16 a[32:35], v[112:115], v[32:35], a[32:35]
    v_cvt_pk_bf16_f32 v88, v252, v253
    v_cvt_pk_bf16_f32 v89, v254, v255
    v_mfma_f32_16x16x32_bf16 a[32:35], v[116:119], v[36:39], a[32:35]
    ds_read_b128 v[120:123], v2 offset:22528
    ds_read_b128 v[124:127], v2 offset:23552
    v_mfma_f32_16x16x32_bf16 a[36:39], v[112:115], v[40:43], a[36:39]
    v_exp_f32 v240, v240
    v_mfma_f32_16x16x32_bf16 a[36:39], v[116:119], v[44:47], a[36:39]
    v_exp_f32 v241, v241
    v_mfma_f32_16x16x32_bf16 v[244:247], a[240:243], v[132:135], v[148:151]
    v_exp_f32 v242, v242
    v_mfma_f32_16x16x32_bf16 v[244:247], a[244:247], v[164:167], v[244:247]
    v_exp_f32 v243, v243
    v_mfma_f32_16x16x32_bf16 v[244:247], a[248:251], v[196:199], v[244:247]
    v_cvt_pk_bf16_f32 v66, v240, v241
    v_cvt_pk_bf16_f32 v67, v242, v243
    v_mfma_f32_16x16x32_bf16 v[244:247], a[252:255], v[228:231], v[244:247]
    v_mfma_f32_16x16x32_bf16 a[40:43], v[112:115], v[48:51], a[40:43]
    buffer_load_dwordx4 v1, s[36:39], s77 offen offset:3072 sc1 lds
    v_mfma_f32_16x16x32_bf16 a[40:43], v[116:119], v[52:55], a[40:43]
    v_mfma_f32_16x16x32_bf16 a[44:47], v[112:115], v[56:59], a[44:47]
    v_mfma_f32_16x16x32_bf16 a[44:47], v[116:119], v[60:63], a[44:47]
    v_mfma_f32_16x16x32_bf16 v[248:251], a[240:243], v[136:139], v[152:155]
    v_mfma_f32_16x16x32_bf16 v[248:251], a[244:247], v[168:171], v[248:251]
    ds_read_b128 a[224:227], v2 offset:8192
    ds_read_b128 a[228:231], v2 offset:9216
    v_mfma_f32_16x16x32_bf16 v[248:251], a[248:251], v[200:203], v[248:251]
    v_exp_f32 v244, v244
    v_mfma_f32_16x16x32_bf16 v[248:251], a[252:255], v[232:235], v[248:251]
    s_waitcnt lgkmcnt(2)
    ds_read_b128 a[232:235], v2 offset:10240
    ds_read_b128 a[236:239], v2 offset:11264
    v_mfma_f32_16x16x32_bf16 a[48:51], v[120:123], v[32:35], a[48:51]
    v_exp_f32 v245, v245
    v_mfma_f32_16x16x32_bf16 a[48:51], v[124:127], v[36:39], a[48:51]
    ds_read_b128 v[96:99], v2 offset:24576
    ds_read_b128 v[100:103], v2 offset:25600
    v_mfma_f32_16x16x32_bf16 a[52:55], v[120:123], v[40:43], a[52:55]
    v_exp_f32 v246, v246
    v_mfma_f32_16x16x32_bf16 a[52:55], v[124:127], v[44:47], a[52:55]
    v_exp_f32 v247, v247
    v_mfma_f32_16x16x32_bf16 v[252:255], a[240:243], v[140:143], v[156:159]
    v_cvt_pk_bf16_f32 v74, v244, v245
    v_cvt_pk_bf16_f32 v75, v246, v247
    v_mfma_f32_16x16x32_bf16 v[252:255], a[244:247], v[172:175], v[252:255]
    s_add_u32 s100, s77, 4096
    v_exp_f32 v248, v248
    v_mfma_f32_16x16x32_bf16 v[252:255], a[248:251], v[204:207], v[252:255]
    s_add_u32 m0, m0, 4096
    v_exp_f32 v249, v249
    v_mfma_f32_16x16x32_bf16 v[252:255], a[252:255], v[236:239], v[252:255]
    buffer_load_dwordx4 v1, s[36:39], s100 offen sc1 lds
    v_mfma_f32_16x16x32_bf16 a[56:59], v[120:123], v[48:51], a[56:59]
    v_exp_f32 v250, v250
    v_mfma_f32_16x16x32_bf16 a[56:59], v[124:127], v[52:55], a[56:59]
    v_exp_f32 v251, v251
    v_mfma_f32_16x16x32_bf16 a[60:63], v[120:123], v[56:59], a[60:63]
    v_cvt_pk_bf16_f32 v82, v248, v249
    v_cvt_pk_bf16_f32 v83, v250, v251
    v_mfma_f32_16x16x32_bf16 a[60:63], v[124:127], v[60:63], a[60:63]
    s_waitcnt lgkmcnt(0)
    v_exp_f32 v252, v252
    v_mfma_f32_16x16x32_bf16 v[240:243], a[224:227], v[128:131], v[184:187]
    v_exp_f32 v253, v253
    v_mfma_f32_16x16x32_bf16 v[240:243], a[228:231], v[160:163], v[240:243]
    v_exp_f32 v254, v254
    v_mfma_f32_16x16x32_bf16 v[240:243], a[232:235], v[192:195], v[240:243]
    v_exp_f32 v255, v255
    v_mfma_f32_16x16x32_bf16 v[240:243], a[236:239], v[224:227], v[240:243]
    v_cvt_pk_bf16_f32 v90, v252, v253
    v_cvt_pk_bf16_f32 v91, v254, v255
    v_mfma_f32_16x16x32_bf16 a[144:147], v[96:99], v[32:35], a[144:147]
    v_mfma_f32_16x16x32_bf16 a[144:147], v[100:103], v[36:39], a[144:147]
    ds_read_b128 v[104:107], v2 offset:26624
    ds_read_b128 v[108:111], v2 offset:27648
    v_mfma_f32_16x16x32_bf16 a[148:151], v[96:99], v[40:43], a[148:151]
    v_mfma_f32_16x16x32_bf16 a[148:151], v[100:103], v[44:47], a[148:151]
    buffer_load_dwordx4 v1, s[36:39], s100 offen offset:1024 sc1 lds
    v_mfma_f32_16x16x32_bf16 v[244:247], a[224:227], v[132:135], v[148:151]
    v_exp_f32 v240, v240
    v_mfma_f32_16x16x32_bf16 v[244:247], a[228:231], v[164:167], v[244:247]
    v_exp_f32 v241, v241
    v_mfma_f32_16x16x32_bf16 v[244:247], a[232:235], v[196:199], v[244:247]
    v_exp_f32 v242, v242
    v_mfma_f32_16x16x32_bf16 v[244:247], a[236:239], v[228:231], v[244:247]
    v_exp_f32 v243, v243
    v_mfma_f32_16x16x32_bf16 a[152:155], v[96:99], v[48:51], a[152:155]
    v_cvt_pk_bf16_f32 v68, v240, v241
    v_cvt_pk_bf16_f32 v69, v242, v243
    v_mfma_f32_16x16x32_bf16 a[152:155], v[100:103], v[52:55], a[152:155]
    v_mfma_f32_16x16x32_bf16 a[156:159], v[96:99], v[56:59], a[156:159]
    v_mfma_f32_16x16x32_bf16 a[156:159], v[100:103], v[60:63], a[156:159]
    v_mfma_f32_16x16x32_bf16 v[248:251], a[224:227], v[136:139], v[152:155]
    v_exp_f32 v244, v244
    v_mfma_f32_16x16x32_bf16 v[248:251], a[228:231], v[168:171], v[248:251]
    ds_read_b128 a[240:243], v2 offset:12288
    ds_read_b128 a[244:247], v2 offset:13312
    v_mfma_f32_16x16x32_bf16 v[248:251], a[232:235], v[200:203], v[248:251]
    v_exp_f32 v245, v245
    v_mfma_f32_16x16x32_bf16 v[248:251], a[236:239], v[232:235], v[248:251]
    s_waitcnt lgkmcnt(2)
    ds_read_b128 a[248:251], v2 offset:14336
    ds_read_b128 a[252:255], v2 offset:15360
    v_mfma_f32_16x16x32_bf16 a[160:163], v[104:107], v[32:35], a[160:163]
    buffer_load_dwordx4 v1, s[36:39], s100 offen offset:2048 sc1 lds
    v_mfma_f32_16x16x32_bf16 a[160:163], v[108:111], v[36:39], a[160:163]
    ds_read_b128 v[112:115], v2 offset:28672
    ds_read_b128 v[116:119], v2 offset:29696
    v_mfma_f32_16x16x32_bf16 a[164:167], v[104:107], v[40:43], a[164:167]
    v_exp_f32 v246, v246
    v_mfma_f32_16x16x32_bf16 a[164:167], v[108:111], v[44:47], a[164:167]
    v_exp_f32 v247, v247
    v_mfma_f32_16x16x32_bf16 v[252:255], a[224:227], v[140:143], v[156:159]
    v_cvt_pk_bf16_f32 v76, v244, v245
    v_cvt_pk_bf16_f32 v77, v246, v247
    v_mfma_f32_16x16x32_bf16 v[252:255], a[228:231], v[172:175], v[252:255]
    v_exp_f32 v248, v248
    v_mfma_f32_16x16x32_bf16 v[252:255], a[232:235], v[204:207], v[252:255]
    v_exp_f32 v249, v249
    v_mfma_f32_16x16x32_bf16 v[252:255], a[236:239], v[236:239], v[252:255]
    v_exp_f32 v250, v250
    v_mfma_f32_16x16x32_bf16 a[168:171], v[104:107], v[48:51], a[168:171]
    v_exp_f32 v251, v251
    v_mfma_f32_16x16x32_bf16 a[168:171], v[108:111], v[52:55], a[168:171]
    v_cvt_pk_bf16_f32 v84, v248, v249
    v_cvt_pk_bf16_f32 v85, v250, v251
    v_mfma_f32_16x16x32_bf16 a[172:175], v[104:107], v[56:59], a[172:175]
    v_mfma_f32_16x16x32_bf16 a[172:175], v[108:111], v[60:63], a[172:175]
    s_waitcnt lgkmcnt(0)
    v_exp_f32 v252, v252
    v_mfma_f32_16x16x32_bf16 v[240:243], a[240:243], v[128:131], v[188:191]
    v_exp_f32 v253, v253
    v_mfma_f32_16x16x32_bf16 v[240:243], a[244:247], v[160:163], v[240:243]
    buffer_load_dwordx4 v1, s[36:39], s100 offen offset:3072 sc1 lds
    v_mfma_f32_16x16x32_bf16 v[240:243], a[248:251], v[192:195], v[240:243]
    v_exp_f32 v254, v254
    v_mfma_f32_16x16x32_bf16 v[240:243], a[252:255], v[224:227], v[240:243]
    v_exp_f32 v255, v255
    v_mfma_f32_16x16x32_bf16 a[176:179], v[112:115], v[32:35], a[176:179]
    v_cvt_pk_bf16_f32 v92, v252, v253
    v_cvt_pk_bf16_f32 v93, v254, v255
    v_mfma_f32_16x16x32_bf16 a[176:179], v[116:119], v[36:39], a[176:179]
    ds_read_b128 v[120:123], v2 offset:30720
    ds_read_b128 v[124:127], v2 offset:31744
    v_mfma_f32_16x16x32_bf16 a[180:183], v[112:115], v[40:43], a[180:183]
    v_exp_f32 v240, v240
    v_mfma_f32_16x16x32_bf16 a[180:183], v[116:119], v[44:47], a[180:183]
    v_exp_f32 v241, v241
    v_mfma_f32_16x16x32_bf16 v[244:247], a[240:243], v[132:135], v[148:151]
    v_add_u32 v2, s82, v1
    v_cvt_pk_bf16_f32 v70, v240, v241
    v_mfma_f32_16x16x32_bf16 v[244:247], a[244:247], v[164:167], v[244:247]
    v_exp_f32 v242, v242
    v_mfma_f32_16x16x32_bf16 v[244:247], a[248:251], v[196:199], v[244:247]
    v_exp_f32 v243, v243
    v_mfma_f32_16x16x32_bf16 v[244:247], a[252:255], v[228:231], v[244:247]
    v_cvt_pk_bf16_f32 v71, v242, v243
    v_mfma_f32_16x16x32_bf16 a[184:187], v[112:115], v[48:51], a[184:187]
    v_mfma_f32_16x16x32_bf16 a[184:187], v[116:119], v[52:55], a[184:187]
    v_mfma_f32_16x16x32_bf16 a[188:191], v[112:115], v[56:59], a[188:191]
    s_add_u32 s77, s77, 32768
    v_mfma_f32_16x16x32_bf16 a[188:191], v[116:119], v[60:63], a[188:191]
    v_mfma_f32_16x16x32_bf16 v[248:251], a[240:243], v[136:139], v[152:155]
    v_mfma_f32_16x16x32_bf16 v[248:251], a[244:247], v[168:171], v[248:251]
    v_exp_f32 v244, v244
    v_mfma_f32_16x16x32_bf16 v[248:251], a[248:251], v[200:203], v[248:251]
    v_exp_f32 v245, v245
    v_mfma_f32_16x16x32_bf16 v[248:251], a[252:255], v[232:235], v[248:251]
    s_waitcnt lgkmcnt(0)
    v_exp_f32 v246, v246
    v_mfma_f32_16x16x32_bf16 a[192:195], v[120:123], v[32:35], a[192:195]
    v_exp_f32 v247, v247
    v_mfma_f32_16x16x32_bf16 a[192:195], v[124:127], v[36:39], a[192:195]
    ds_read_b128 a[224:227], v2 offset:0
    ds_read_b128 a[228:231], v2 offset:1024
    v_mfma_f32_16x16x32_bf16 a[196:199], v[120:123], v[40:43], a[196:199]
    ds_read_b128 a[232:235], v2 offset:2048
    v_cvt_pk_bf16_f32 v78, v244, v245
    v_mfma_f32_16x16x32_bf16 a[196:199], v[124:127], v[44:47], a[196:199]
    ds_read_b128 a[236:239], v2 offset:3072
    v_cvt_pk_bf16_f32 v79, v246, v247
    v_mfma_f32_16x16x32_bf16 v[252:255], a[240:243], v[140:143], v[156:159]
    v_exp_f32 v248, v248
    v_mfma_f32_16x16x32_bf16 v[252:255], a[244:247], v[172:175], v[252:255]
    ds_read_b128 v[96:99], v2 offset:16384
    ds_read_b128 v[100:103], v2 offset:17408
    v_mfma_f32_16x16x32_bf16 v[252:255], a[248:251], v[204:207], v[252:255]
    v_exp_f32 v249, v249
    v_mfma_f32_16x16x32_bf16 v[252:255], a[252:255], v[236:239], v[252:255]
    v_exp_f32 v250, v250
    v_mfma_f32_16x16x32_bf16 a[200:203], v[120:123], v[48:51], a[200:203]
    v_exp_f32 v251, v251
    v_mfma_f32_16x16x32_bf16 a[200:203], v[124:127], v[52:55], a[200:203]
    v_cvt_pk_bf16_f32 v86, v248, v249
    v_cvt_pk_bf16_f32 v87, v250, v251
    v_mfma_f32_16x16x32_bf16 a[204:207], v[120:123], v[56:59], a[204:207]
    v_mfma_f32_16x16x32_bf16 a[204:207], v[124:127], v[60:63], a[204:207]
    v_exp_f32 v252, v252
    v_smfmac_f32_16x16x64_bf16 a[208:211], a[136:139], v[32:39], v215
    v_smfmac_f32_16x16x64_bf16 a[212:215], a[136:139], v[40:47], v215
    v_smfmac_f32_16x16x64_bf16 a[216:219], a[136:139], v[48:55], v215
    s_cmp_le_u32 s78, 1
    v_smfmac_f32_16x16x64_bf16 a[220:223], a[136:139], v[56:63], v215
    s_cbranch_scc1 K1_LB_MASK
K1_LB_BACK:
    s_waitcnt lgkmcnt(0)
    v_mfma_f32_16x16x32_bf16 v[240:243], a[224:227], v[128:131], v[176:179]
    s_mov_b32 s99, s76
    v_exp_f32 v253, v253
    v_mfma_f32_16x16x32_bf16 v[240:243], a[228:231], v[160:163], v[240:243]
    v_exp_f32 v254, v254
    v_mfma_f32_16x16x32_bf16 v[240:243], a[232:235], v[192:195], v[240:243]
    v_exp_f32 v255, v255
    v_mfma_f32_16x16x32_bf16 v[240:243], a[236:239], v[224:227], v[240:243]
    v_cvt_pk_bf16_f32 v94, v252, v253
    v_cvt_pk_bf16_f32 v95, v254, v255
    v_mfma_f32_16x16x32_bf16 a[0:3], v[96:99], v[64:67], a[0:3]
    s_add_u32 m0, s76, s75
    v_mfma_f32_16x16x32_bf16 a[0:3], v[100:103], v[68:71], a[0:3]
    s_mov_b32 s76, s60
    buffer_load_dwordx4 v1, s[36:39], s77 offen sc1 lds
    v_mfma_f32_16x16x32_bf16 a[4:7], v[96:99], v[72:75], a[4:7]
    s_mov_b32 s60, s82
    ds_read_b128 v[104:107], v2 offset:18432
    ds_read_b128 v[108:111], v2 offset:19456
    v_mfma_f32_16x16x32_bf16 a[4:7], v[100:103], v[76:79], a[4:7]
    s_mov_b32 s82, s95
    v_exp_f32 v240, v240
    v_mfma_f32_16x16x32_bf16 v[244:247], a[224:227], v[132:135], v[148:151]
    s_mov_b32 s95, s93
    v_exp_f32 v241, v241
    v_mfma_f32_16x16x32_bf16 v[244:247], a[228:231], v[164:167], v[244:247]
    s_mov_b32 s93, s99
    v_exp_f32 v242, v242
    v_mfma_f32_16x16x32_bf16 v[244:247], a[232:235], v[196:199], v[244:247]
    v_exp_f32 v243, v243
    v_mfma_f32_16x16x32_bf16 v[244:247], a[236:239], v[228:231], v[244:247]
    v_cvt_pk_bf16_f32 v32, v240, v241
    v_cvt_pk_bf16_f32 v33, v242, v243
    v_mfma_f32_16x16x32_bf16 a[8:11], v[96:99], v[80:83], a[8:11]
    v_mfma_f32_16x16x32_bf16 a[8:11], v[100:103], v[84:87], a[8:11]
    v_mfma_f32_16x16x32_bf16 a[12:15], v[96:99], v[88:91], a[12:15]
    v_mfma_f32_16x16x32_bf16 a[12:15], v[100:103], v[92:95], a[12:15]
    v_mfma_f32_16x16x32_bf16 v[248:251], a[224:227], v[136:139], v[152:155]
    v_mfma_f32_16x16x32_bf16 v[248:251], a[228:231], v[168:171], v[248:251]
    ds_read_b128 a[240:243], v2 offset:4096
    ds_read_b128 a[244:247], v2 offset:5120
    v_mfma_f32_16x16x32_bf16 v[248:251], a[232:235], v[200:203], v[248:251]
    buffer_load_dwordx4 v1, s[36:39], s77 offen offset:1024 sc1 lds
    v_mfma_f32_16x16x32_bf16 v[248:251], a[236:239], v[232:235], v[248:251]
    s_waitcnt lgkmcnt(2)
    ds_read_b128 a[248:251], v2 offset:6144
    ds_read_b128 a[252:255], v2 offset:7168
    v_mfma_f32_16x16x32_bf16 a[16:19], v[104:107], v[64:67], a[16:19]
    v_exp_f32 v244, v244
    v_mfma_f32_16x16x32_bf16 a[16:19], v[108:111], v[68:71], a[16:19]
    ds_read_b128 v[112:115], v2 offset:20480
    ds_read_b128 v[116:119], v2 offset:21504
    v_mfma_f32_16x16x32_bf16 a[20:23], v[104:107], v[72:75], a[20:23]
    v_exp_f32 v245, v245
    v_mfma_f32_16x16x32_bf16 a[20:23], v[108:111], v[76:79], a[20:23]
    v_exp_f32 v246, v246
    v_mfma_f32_16x16x32_bf16 v[252:255], a[224:227], v[140:143], v[156:159]
    v_exp_f32 v247, v247
    v_mfma_f32_16x16x32_bf16 v[252:255], a[228:231], v[172:175], v[252:255]
    v_cvt_pk_bf16_f32 v40, v244, v245
    v_cvt_pk_bf16_f32 v41, v246, v247
    v_mfma_f32_16x16x32_bf16 v[252:255], a[232:235], v[204:207], v[252:255]
    v_exp_f32 v248, v248
    v_mfma_f32_16x16x32_bf16 v[252:255], a[236:239], v[236:239], v[252:255]
    v_exp_f32 v249, v249
    v_mfma_f32_16x16x32_bf16 a[24:27], v[104:107], v[80:83], a[24:27]
    v_exp_f32 v250, v250
    v_mfma_f32_16x16x32_bf16 a[24:27], v[108:111], v[84:87], a[24:27]
    v_exp_f32 v251, v251
    v_mfma_f32_16x16x32_bf16 a[28:31], v[104:107], v[88:91], a[28:31]
    v_cvt_pk_bf16_f32 v48, v248, v249
    v_cvt_pk_bf16_f32 v49, v250, v251
    v_mfma_f32_16x16x32_bf16 a[28:31], v[108:111], v[92:95], a[28:31]
    s_waitcnt lgkmcnt(0)
    buffer_load_dwordx4 v1, s[36:39], s77 offen offset:2048 sc1 lds
    v_mfma_f32_16x16x32_bf16 v[240:243], a[240:243], v[128:131], v[180:183]
    v_exp_f32 v252, v252
    v_mfma_f32_16x16x32_bf16 v[240:243], a[244:247], v[160:163], v[240:243]
    v_exp_f32 v253, v253
    v_mfma_f32_16x16x32_bf16 v[240:243], a[248:251], v[192:195], v[240:243]
    v_exp_f32 v254, v254
    v_mfma_f32_16x16x32_bf16 v[240:243], a[252:255], v[224:227], v[240:243]
    v_exp_f32 v255, v255
    v_mfma_f32_16x16x32_bf16 a[32:35], v[112:115], v[64:67], a[32:35]
    v_cvt_pk_bf16_f32 v56, v252, v253
    v_cvt_pk_bf16_f32 v57, v254, v255
    v_mfma_f32_16x16x32_bf16 a[32:35], v[116:119], v[68:71], a[32:35]
    ds_read_b128 v[120:123], v2 offset:22528
    ds_read_b128 v[124:127], v2 offset:23552
    v_mfma_f32_16x16x32_bf16 a[36:39], v[112:115], v[72:75], a[36:39]
    v_exp_f32 v240, v240
    v_mfma_f32_16x16x32_bf16 a[36:39], v[116:119], v[76:79], a[36:39]
    v_exp_f32 v241, v241
    v_mfma_f32_16x16x32_bf16 v[244:247], a[240:243], v[132:135], v[148:151]
    v_exp_f32 v242, v242
    v_mfma_f32_16x16x32_bf16 v[244:247], a[244:247], v[164:167], v[244:247]
    v_exp_f32 v243, v243
    v_mfma_f32_16x16x32_bf16 v[244:247], a[248:251], v[196:199], v[244:247]
    v_cvt_pk_bf16_f32 v34, v240, v241
    v_cvt_pk_bf16_f32 v35, v242, v243
    v_mfma_f32_16x16x32_bf16 v[244:247], a[252:255], v[228:231], v[244:247]
    v_mfma_f32_16x16x32_bf16 a[40:43], v[112:115], v[80:83], a[40:43]
    buffer_load_dwordx4 v1, s[36:39], s77 offen offset:3072 sc1 lds
    v_mfma_f32_16x16x32_bf16 a[40:43], v[116:119], v[84:87], a[40:43]
    v_mfma_f32_16x16x32_bf16 a[44:47], v[112:115], v[88:91], a[44:47]
    v_mfma_f32_16x16x32_bf16 a[44:47], v[116:119], v[92:95], a[44:47]
    v_mfma_f32_16x16x32_bf16 v[248:251], a[240:243], v[136:139], v[152:155]
    v_mfma_f32_16x16x32_bf16 v[248:251], a[244:247], v[168:171], v[248:251]
    ds_read_b128 a[224:227], v2 offset:8192
    ds_read_b128 a[228:231], v2 offset:9216
    v_mfma_f32_16x16x32_bf16 v[248:251], a[248:251], v[200:203], v[248:251]
    v_exp_f32 v244, v244
    v_mfma_f32_16x16x32_bf16 v[248:251], a[252:255], v[232:235], v[248:251]
    s_waitcnt lgkmcnt(2)
    ds_read_b128 a[232:235], v2 offset:10240
    ds_read_b128 a[236:239], v2 offset:11264
    v_mfma_f32_16x16x32_bf16 a[48:51], v[120:123], v[64:67], a[48:51]
    v_exp_f32 v245, v245
    v_mfma_f32_16x16x32_bf16 a[48:51], v[124:127], v[68:71], a[48:51]
    ds_read_b128 v[96:99], v2 offset:24576
    ds_read_b128 v[100:103], v2 offset:25600
    v_mfma_f32_16x16x32_bf16 a[52:55], v[120:123], v[72:75], a[52:55]
    v_exp_f32 v246, v246
    v_mfma_f32_16x16x32_bf16 a[52:55], v[124:127], v[76:79], a[52:55]
    v_exp_f32 v247, v247
    v_mfma_f32_16x16x32_bf16 v[252:255], a[240:243], v[140:143], v[156:159]
    v_cvt_pk_bf16_f32 v42, v244, v245
    v_cvt_pk_bf16_f32 v43, v246, v247
    v_mfma_f32_16x16x32_bf16 v[252:255], a[244:247], v[172:175], v[252:255]
    s_add_u32 s100, s77, 4096
    v_exp_f32 v248, v248
    v_mfma_f32_16x16x32_bf16 v[252:255], a[248:251], v[204:207], v[252:255]
    s_add_u32 m0, m0, 4096
    v_exp_f32 v249, v249
    v_mfma_f32_16x16x32_bf16 v[252:255], a[252:255], v[236:239], v[252:255]
    buffer_load_dwordx4 v1, s[36:39], s100 offen sc1 lds
    v_mfma_f32_16x16x32_bf16 a[56:59], v[120:123], v[80:83], a[56:59]
    v_exp_f32 v250, v250
    v_mfma_f32_16x16x32_bf16 a[56:59], v[124:127], v[84:87], a[56:59]
    v_exp_f32 v251, v251
    v_mfma_f32_16x16x32_bf16 a[60:63], v[120:123], v[88:91], a[60:63]
    v_cvt_pk_bf16_f32 v50, v248, v249
    v_cvt_pk_bf16_f32 v51, v250, v251
    v_mfma_f32_16x16x32_bf16 a[60:63], v[124:127], v[92:95], a[60:63]
    s_waitcnt lgkmcnt(0)
    v_exp_f32 v252, v252
    v_mfma_f32_16x16x32_bf16 v[240:243], a[224:227], v[128:131], v[184:187]
    v_exp_f32 v253, v253
    v_mfma_f32_16x16x32_bf16 v[240:243], a[228:231], v[160:163], v[240:243]
    v_exp_f32 v254, v254
    v_mfma_f32_16x16x32_bf16 v[240:243], a[232:235], v[192:195], v[240:243]
    v_exp_f32 v255, v255
    v_mfma_f32_16x16x32_bf16 v[240:243], a[236:239], v[224:227], v[240:243]
    v_cvt_pk_bf16_f32 v58, v252, v253
    v_cvt_pk_bf16_f32 v59, v254, v255
    v_mfma_f32_16x16x32_bf16 a[144:147], v[96:99], v[64:67], a[144:147]
    v_mfma_f32_16x16x32_bf16 a[144:147], v[100:103], v[68:71], a[144:147]
    ds_read_b128 v[104:107], v2 offset:26624
    ds_read_b128 v[108:111], v2 offset:27648
    v_mfma_f32_16x16x32_bf16 a[148:151], v[96:99], v[72:75], a[148:151]
    v_mfma_f32_16x16x32_bf16 a[148:151], v[100:103], v[76:79], a[148:151]
    buffer_load_dwordx4 v1, s[36:39], s100 offen offset:1024 sc1 lds
    v_mfma_f32_16x16x32_bf16 v[244:247], a[224:227], v[132:135], v[148:151]
    v_exp_f32 v240, v240
    v_mfma_f32_16x16x32_bf16 v[244:247], a[228:231], v[164:167], v[244:247]
    v_exp_f32 v241, v241
    v_mfma_f32_16x16x32_bf16 v[244:247], a[232:235], v[196:199], v[244:247]
    v_exp_f32 v242, v242
    v_mfma_f32_16x16x32_bf16 v[244:247], a[236:239], v[228:231], v[244:247]
    v_exp_f32 v243, v243
    v_mfma_f32_16x16x32_bf16 a[152:155], v[96:99], v[80:83], a[152:155]
    v_cvt_pk_bf16_f32 v36, v240, v241
    v_cvt_pk_bf16_f32 v37, v242, v243
    v_mfma_f32_16x16x32_bf16 a[152:155], v[100:103], v[84:87], a[152:155]
    v_mfma_f32_16x16x32_bf16 a[156:159], v[96:99], v[88:91], a[156:159]
    v_mfma_f32_16x16x32_bf16 a[156:159], v[100:103], v[92:95], a[156:159]
    v_mfma_f32_16x16x32_bf16 v[248:251], a[224:227], v[136:139], v[152:155]
    v_exp_f32 v244, v244
    v_mfma_f32_16x16x32_bf16 v[248:251], a[228:231], v[168:171], v[248:251]
    ds_read_b128 a[240:243], v2 offset:12288
    ds_read_b128 a[244:247], v2 offset:13312
    v_mfma_f32_16x16x32_bf16 v[248:251], a[232:235], v[200:203], v[248:251]
    v_exp_f32 v245, v245
    v_mfma_f32_16x16x32_bf16 v[248:251], a[236:239], v[232:235], v[248:251]
    s_waitcnt lgkmcnt(2)
    ds_read_b128 a[248:251], v2 offset:14336
    ds_read_b128 a[252:255], v2 offset:15360
    v_mfma_f32_16x16x32_bf16 a[160:163], v[104:107], v[64:67], a[160:163]
    buffer_load_dwordx4 v1, s[36:39], s100 offen offset:2048 sc1 lds
    v_mfma_f32_16x16x32_bf16 a[160:163], v[108:111], v[68:71], a[160:163]
    ds_read_b128 v[112:115], v2 offset:28672
    ds_read_b128 v[116:119], v2 offset:29696
    v_mfma_f32_16x16x32_bf16 a[164:167], v[104:107], v[72:75], a[164:167]
    v_exp_f32 v246, v246
    v_mfma_f32_16x16x32_bf16 a[164:167], v[108:111], v[76:79], a[164:167]
    v_exp_f32 v247, v247
    v_mfma_f32_16x16x32_bf16 v[252:255], a[224:227], v[140:143], v[156:159]
    v_cvt_pk_bf16_f32 v44, v244, v245
    v_cvt_pk_bf16_f32 v45, v246, v247
    v_mfma_f32_16x16x32_bf16 v[252:255], a[228:231], v[172:175], v[252:255]
    v_exp_f32 v248, v248
    v_mfma_f32_16x16x32_bf16 v[252:255], a[232:235], v[204:207], v[252:255]
    v_exp_f32 v249, v249
    v_mfma_f32_16x16x32_bf16 v[252:255], a[236:239], v[236:239], v[252:255]
    v_exp_f32 v250, v250
    v_mfma_f32_16x16x32_bf16 a[168:171], v[104:107], v[80:83], a[168:171]
    v_exp_f32 v251, v251
    v_mfma_f32_16x16x32_bf16 a[168:171], v[108:111], v[84:87], a[168:171]
    v_cvt_pk_bf16_f32 v52, v248, v249
    v_cvt_pk_bf16_f32 v53, v250, v251
    v_mfma_f32_16x16x32_bf16 a[172:175], v[104:107], v[88:91], a[172:175]
    v_mfma_f32_16x16x32_bf16 a[172:175], v[108:111], v[92:95], a[172:175]
    s_waitcnt lgkmcnt(0)
    v_exp_f32 v252, v252
    v_mfma_f32_16x16x32_bf16 v[240:243], a[240:243], v[128:131], v[188:191]
    v_exp_f32 v253, v253
    v_mfma_f32_16x16x32_bf16 v[240:243], a[244:247], v[160:163], v[240:243]
    buffer_load_dwordx4 v1, s[36:39], s100 offen offset:3072 sc1 lds
    v_mfma_f32_16x16x32_bf16 v[240:243], a[248:251], v[192:195], v[240:243]
    v_exp_f32 v254, v254
    v_mfma_f32_16x16x32_bf16 v[240:243], a[252:255], v[224:227], v[240:243]
    v_exp_f32 v255, v255
    v_mfma_f32_16x16x32_bf16 a[176:179], v[112:115], v[64:67], a[176:179]
    v_cvt_pk_bf16_f32 v60, v252, v253
    v_cvt_pk_bf16_f32 v61, v254, v255
    v_mfma_f32_16x16x32_bf16 a[176:179], v[116:119], v[68:71], a[176:179]
    ds_read_b128 v[120:123], v2 offset:30720
    ds_read_b128 v[124:127], v2 offset:31744
    v_mfma_f32_16x16x32_bf16 a[180:183], v[112:115], v[72:75], a[180:183]
    v_exp_f32 v240, v240
    v_mfma_f32_16x16x32_bf16 a[180:183], v[116:119], v[76:79], a[180:183]
    v_exp_f32 v241, v241
    v_mfma_f32_16x16x32_bf16 v[244:247], a[240:243], v[132:135], v[148:151]
    v_add_u32 v2, s82, v1
    v_cvt_pk_bf16_f32 v38, v240, v241
    v_mfma_f32_16x16x32_bf16 v[244:247], a[244:247], v[164:167], v[244:247]
    v_exp_f32 v242, v242
    v_mfma_f32_16x16x32_bf16 v[244:247], a[248:251], v[196:199], v[244:247]
    v_exp_f32 v243, v243
    v_mfma_f32_16x16x32_bf16 v[244:247], a[252:255], v[228:231], v[244:247]
    v_cvt_pk_bf16_f32 v39, v242, v243
    v_mfma_f32_16x16x32_bf16 a[184:187], v[112:115], v[80:83], a[184:187]
    v_mfma_f32_16x16x32_bf16 a[184:187], v[116:119], v[84:87], a[184:187]
    v_mfma_f32_16x16x32_bf16 a[188:191], v[112:115], v[88:91], a[188:191]
    s_add_u32 s77, s77, 32768
    v_mfma_f32_16x16x32_bf16 a[188:191], v[116:119], v[92:95], a[188:191]
    v_mfma_f32_16x16x32_bf16 v[248:251], a[240:243], v[136:139], v[152:155]
    v_mfma_f32_16x16x32_bf16 v[248:251], a[244:247], v[168:171], v[248:251]
    v_exp_f32 v244, v244
    v_mfma_f32_16x16x32_bf16 v[248:251], a[248:251], v[200:203], v[248:251]
    v_exp_f32 v245, v245
    v_mfma_f32_16x16x32_bf16 v[248:251], a[252:255], v[232:235], v[248:251]
    s_waitcnt lgkmcnt(0)
    v_exp_f32 v246, v246
    v_mfma_f32_16x16x32_bf16 a[192:195], v[120:123], v[64:67], a[192:195]
    v_exp_f32 v247, v247
    v_mfma_f32_16x16x32_bf16 a[192:195], v[124:127], v[68:71], a[192:195]
    v_cvt_pk_bf16_f32 v46, v244, v245
    v_cvt_pk_bf16_f32 v47, v246, v247
    v_mfma_f32_16x16x32_bf16 a[196:199], v[120:123], v[72:75], a[196:199]
    s_waitcnt vmcnt(8) lgkmcnt(0)
    v_exp_f32 v248, v248
    v_mfma_f32_16x16x32_bf16 a[196:199], v[124:127], v[76:79], a[196:199]
    s_barrier
    ds_read_b128 a[224:227], v2 offset:0
    ds_read_b128 a[228:231], v2 offset:1024
    v_mfma_f32_16x16x32_bf16 v[252:255], a[240:243], v[140:143], v[156:159]
    v_exp_f32 v249, v249
    v_mfma_f32_16x16x32_bf16 v[252:255], a[244:247], v[172:175], v[252:255]
    ds_read_b128 a[232:235], v2 offset:2048
    ds_read_b128 a[236:239], v2 offset:3072
    v_mfma_f32_16x16x32_bf16 v[252:255], a[248:251], v[204:207], v[252:255]
    ds_read_b128 v[96:99], v2 offset:16384
    v_cvt_pk_bf16_f32 v54, v248, v249
    v_mfma_f32_16x16x32_bf16 v[252:255], a[252:255], v[236:239], v[252:255]
    v_exp_f32 v250, v250
    v_mfma_f32_16x16x32_bf16 a[200:203], v[120:123], v[80:83], a[200:203]
    v_exp_f32 v251, v251
    v_mfma_f32_16x16x32_bf16 a[200:203], v[124:127], v[84:87], a[200:203]
    ds_read_b128 v[100:103], v2 offset:17408
    v_cvt_pk_bf16_f32 v55, v250, v251
    v_mfma_f32_16x16x32_bf16 a[204:207], v[120:123], v[88:91], a[204:207]
    v_mfma_f32_16x16x32_bf16 a[204:207], v[124:127], v[92:95], a[204:207]
    v_exp_f32 v252, v252
    v_smfmac_f32_16x16x64_bf16 a[208:211], a[136:139], v[64:71], v215
    v_smfmac_f32_16x16x64_bf16 a[212:215], a[136:139], v[72:79], v215
    s_sub_u32 s78, s78, 1
    v_smfmac_f32_16x16x64_bf16 a[216:219], a[136:139], v[80:87], v215
    s_cmp_lg_u32 s78, 0
    v_smfmac_f32_16x16x64_bf16 a[220:223], a[136:139], v[88:95], v215
    s_cbranch_scc1 K1_LB
K1_LB_END:
    v_add_f32 v212, s12, v148
    v_fma_f32 v176, v208, s8, v212
    v_fma_f32 v177, v209, s8, v212
    v_fma_f32 v178, v210, s8, v212
    v_fma_f32 v179, v211, s8, v212
    s_nop 1
    s_waitcnt lgkmcnt(0)
    v_mfma_f32_16x16x32_bf16 v[240:243], a[224:227], v[132:135], v[176:179]
    s_mov_b32 s7, 0
    ds_read_b128 v[104:107], v2 offset:18432
    ds_read_b128 v[108:111], v2 offset:19456
    v_mfma_f32_16x16x32_bf16 v[240:243], a[228:231], v[164:167], v[240:243]
    s_mov_b32 s99, s76
    buffer_load_dwordx4 v[64:67], v11, s[48:51], s7 offen nt
    v_mfma_f32_16x16x32_bf16 v[240:243], a[232:235], v[196:199], v[240:243]
    s_mov_b32 s7, 18432
    v_exp_f32 v253, v253
    v_mfma_f32_16x16x32_bf16 v[240:243], a[236:239], v[228:231], v[240:243]
    s_lshl_b32 s29, s6, 2
    v_exp_f32 v254, v254
    v_mfma_f32_16x16x32_bf16 a[0:3], v[96:99], v[32:35], a[0:3]
    s_lshr_b32 s29, 0x41302413, s29
    v_exp_f32 v255, v255
    v_mfma_f32_16x16x32_bf16 a[0:3], v[100:103], v[36:39], a[0:3]
    s_and_b32 s29, s29, 7
    buffer_load_dwordx4 v[68:71], v11, s[48:51], s7 offen nt
    v_mfma_f32_16x16x32_bf16 a[4:7], v[96:99], v[40:43], a[4:7]
    s_mov_b32 s7, 9216
    v_cvt_pk_bf16_f32 v62, v252, v253
    v_cvt_pk_bf16_f32 v63, v254, v255
    v_mfma_f32_16x16x32_bf16 a[4:7], v[100:103], v[44:47], a[4:7]
    s_lshl_b32 s29, s29, 15
    ds_read_b128 a[240:243], v2 offset:4096
    ds_read_b128 a[244:247], v2 offset:5120
    v_mfma_f32_16x16x32_bf16 v[244:247], a[224:227], v[136:139], v[152:155]
    s_add_u32 s44, s29, s75
    ds_read_b128 a[248:251], v2 offset:6144
    v_add_f32 v213, s13, v148
    v_mfma_f32_16x16x32_bf16 v[244:247], a[228:231], v[168:171], v[244:247]
    s_lshl_b32 s29, s6, 2
    buffer_load_dwordx4 v[20:23], v11, s[48:51], s7 offen nt
    v_mfma_f32_16x16x32_bf16 v[244:247], a[232:235], v[200:203], v[244:247]
    s_mov_b32 s7, 27648
    ds_read_b128 a[252:255], v2 offset:7168
    ds_read_b128 v[112:115], v2 offset:20480
    v_mfma_f32_16x16x32_bf16 v[244:247], a[236:239], v[232:235], v[244:247]
    s_lshr_b32 s29, 0x2413024, s29
    ds_read_b128 v[116:119], v2 offset:21504
    v_fma_f32 v180, v208, s9, v213
    v_mfma_f32_16x16x32_bf16 a[8:11], v[96:99], v[48:51], a[8:11]
    s_and_b32 s29, s29, 7
    v_fma_f32 v181, v209, s9, v213
    v_fma_f32 v182, v210, s9, v213
    v_mfma_f32_16x16x32_bf16 a[8:11], v[100:103], v[52:55], a[8:11]
    s_lshl_b32 s29, s29, 15
    buffer_load_dwordx4 v[24:27], v11, s[48:51], s7 offen nt
    v_mfma_f32_16x16x32_bf16 a[12:15], v[96:99], v[56:59], a[12:15]
    s_add_u32 s45, s29, s75
    v_fma_f32 v183, v211, s9, v213
    ds_read_b128 v[120:123], v2 offset:22528
    v_mfma_f32_16x16x32_bf16 a[12:15], v[100:103], v[60:63], a[12:15]
    s_lshl_b32 s29, s6, 2
    v_exp_f32 v240, v240
    s_waitcnt lgkmcnt(2)
    v_mfma_f32_16x16x32_bf16 a[16:19], v[104:107], v[32:35], a[16:19]
    s_lshr_b32 s29, 0x13024130, s29
    v_exp_f32 v241, v241
    v_mfma_f32_16x16x32_bf16 a[16:19], v[108:111], v[36:39], a[16:19]
    s_and_b32 s29, s29, 7
    buffer_load_dwordx4 v[144:147], v12, s[52:55], 0 offen nt
    v_mfma_f32_16x16x32_bf16 v[248:251], a[224:227], v[140:143], v[156:159]
    s_lshl_b32 s29, s29, 15
    v_exp_f32 v242, v242
    v_mfma_f32_16x16x32_bf16 v[248:251], a[228:231], v[172:175], v[248:251]
    s_add_u32 s46, s29, s75
    v_exp_f32 v243, v243
    v_mfma_f32_16x16x32_bf16 v[248:251], a[232:235], v[204:207], v[248:251]
    s_lshl_b32 s29, s6, 2
    v_cvt_pk_bf16_f32 v72, v240, v241
    v_cvt_pk_bf16_f32 v73, v242, v243
    v_mfma_f32_16x16x32_bf16 v[248:251], a[236:239], v[236:239], v[248:251]
    s_lshr_b32 s29, 0x24130241, s29
    buffer_load_dwordx4 a[140:143], v13, s[52:55], 0 offen nt
    v_mfma_f32_16x16x32_bf16 a[20:23], v[104:107], v[40:43], a[20:23]
    s_and_b32 s29, s29, 7
    ds_read_b128 v[124:127], v2 offset:23552
    ds_read_b128 a[224:227], v2 offset:8192
    v_mfma_f32_16x16x32_bf16 a[20:23], v[108:111], v[44:47], a[20:23]
    s_lshl_b32 s29, s29, 15
    v_exp_f32 v244, v244
    v_mfma_f32_16x16x32_bf16 a[24:27], v[104:107], v[48:51], a[24:27]
    s_add_u32 s47, s29, s75
    v_exp_f32 v245, v245
    v_mfma_f32_16x16x32_bf16 a[24:27], v[108:111], v[52:55], a[24:27]
    s_lshl_b32 s29, s6, 2
    v_exp_f32 v246, v246
    v_mfma_f32_16x16x32_bf16 a[28:31], v[104:107], v[56:59], a[28:31]
    s_lshr_b32 s29, 0x30241302, s29
    v_exp_f32 v247, v247
    v_mfma_f32_16x16x32_bf16 a[28:31], v[108:111], v[60:63], a[28:31]
    s_and_b32 s29, s29, 7
    v_cvt_pk_bf16_f32 v80, v244, v245
    v_cvt_pk_bf16_f32 v81, v246, v247
    v_mfma_f32_16x16x32_bf16 v[252:255], a[240:243], v[132:135], v[180:183]
    s_mov_b32 s98, 0x3fb8aa3b
    ds_read_b128 a[228:231], v2 offset:9216
    ds_read_b128 a[232:235], v2 offset:10240
    v_mfma_f32_16x16x32_bf16 v[252:255], a[244:247], v[164:167], v[252:255]
    s_lshr_b32 s61, s5, 3
    ds_read_b128 a[236:239], v2 offset:11264
    v_add_f32 v212, s14, v148
    v_mfma_f32_16x16x32_bf16 v[252:255], a[248:251], v[196:199], v[252:255]
    s_lshl_b32 s29, s29, 15
    ds_read_b128 v[96:99], v2 offset:24576
    v_fma_f32 v184, v208, s10, v212
    v_mfma_f32_16x16x32_bf16 v[252:255], a[252:255], v[228:231], v[252:255]
    s_add_u32 s79, s29, s75
    ds_read_b128 v[100:103], v2 offset:25600
    v_fma_f32 v185, v209, s10, v212
    v_mfma_f32_16x16x32_bf16 a[32:35], v[112:115], v[32:35], a[32:35]
    s_mul_i32 s71, s61, 6144
    v_exp_f32 v248, v248
    s_waitcnt lgkmcnt(5)
    v_mfma_f32_16x16x32_bf16 a[32:35], v[116:119], v[36:39], a[32:35]
    s_and_b32 s29, s5, 7
    v_exp_f32 v249, v249
    v_mfma_f32_16x16x32_bf16 a[36:39], v[112:115], v[40:43], a[36:39]
    s_add_u32 s3, s5, s6
    v_exp_f32 v250, v250
    v_mfma_f32_16x16x32_bf16 a[36:39], v[116:119], v[44:47], a[36:39]
    s_add_u32 s71, s71, 131072
    v_exp_f32 v251, v251
    v_mfma_f32_16x16x32_bf16 v[240:243], a[240:243], v[136:139], v[152:155]
    s_lshl_b32 s29, s29, 8
    v_fma_f32 v186, v210, s10, v212
    v_fma_f32 v187, v211, s10, v212
    v_mfma_f32_16x16x32_bf16 v[240:243], a[244:247], v[168:171], v[240:243]
    s_add_u32 s74, s4, 1
    v_cvt_pk_bf16_f32 v88, v248, v249
    v_cvt_pk_bf16_f32 v89, v250, v251
    v_mfma_f32_16x16x32_bf16 v[240:243], a[248:251], v[200:203], v[240:243]
    s_and_b32 s28, s5, 3
    v_exp_f32 v252, v252
    v_mfma_f32_16x16x32_bf16 v[240:243], a[252:255], v[232:235], v[240:243]
    s_and_b32 s3, s3, 1
    v_exp_f32 v253, v253
    v_mfma_f32_16x16x32_bf16 a[40:43], v[112:115], v[48:51], a[40:43]
    s_lshl2_add_u32 s66, s6, s61
    v_exp_f32 v254, v254
    v_mfma_f32_16x16x32_bf16 a[40:43], v[116:119], v[52:55], a[40:43]
    s_add_u32 s71, s71, s29
    v_exp_f32 v255, v255
    v_mfma_f32_16x16x32_bf16 a[44:47], v[112:115], v[56:59], a[44:47]
    s_lshl_b32 s74, s74, 15
    v_cvt_pk_bf16_f32 v74, v252, v253
    v_cvt_pk_bf16_f32 v75, v254, v255
    v_mfma_f32_16x16x32_bf16 a[44:47], v[116:119], v[60:63], a[44:47]
    s_mul_i32 s28, s28, 9216
    ds_read_b128 v[104:107], v2 offset:26624
    ds_read_b128 v[108:111], v2 offset:27648
    v_mfma_f32_16x16x32_bf16 a[48:51], v[120:123], v[32:35], a[48:51]
    s_lshl3_add_u32 s3, s61, s3
    v_exp_f32 v240, v240
    v_mfma_f32_16x16x32_bf16 a[48:51], v[124:127], v[36:39], a[48:51]
    s_lshl_b32 s66, s66, 10
    v_exp_f32 v241, v241
    v_mfma_f32_16x16x32_bf16 v[244:247], a[240:243], v[140:143], v[156:159]
    s_add_u32 s70, s71, 4096
    v_exp_f32 v242, v242
    v_mfma_f32_16x16x32_bf16 v[244:247], a[244:247], v[172:175], v[244:247]
    s_add_u32 s71, s71, s29
    v_exp_f32 v243, v243
    v_mfma_f32_16x16x32_bf16 v[244:247], a[248:251], v[204:207], v[244:247]
    s_add_u32 s74, s74, s101
    v_cvt_pk_bf16_f32 v82, v240, v241
    v_cvt_pk_bf16_f32 v83, v242, v243
    v_mfma_f32_16x16x32_bf16 v[244:247], a[252:255], v[236:239], v[244:247]
    ds_read_b128 a[240:243], v2 offset:12288
    ds_read_b128 a[244:247], v2 offset:13312
    v_mfma_f32_16x16x32_bf16 a[52:55], v[120:123], v[40:43], a[52:55]
    ds_read_b128 a[248:251], v2 offset:14336
    v_add_f32 v213, s15, v148
    v_mfma_f32_16x16x32_bf16 a[52:55], v[124:127], v[44:47], a[52:55]
    ds_read_b128 a[252:255], v2 offset:15360
    v_fma_f32 v188, v208, s11, v213
    v_mfma_f32_16x16x32_bf16 a[56:59], v[120:123], v[48:51], a[56:59]
    ds_read_b128 v[112:115], v2 offset:28672
    v_fma_f32 v189, v209, s11, v213
    v_mfma_f32_16x16x32_bf16 a[56:59], v[124:127], v[52:55], a[56:59]
    ds_read_b128 v[116:119], v2 offset:29696
    v_fma_f32 v190, v210, s11, v213
    v_mfma_f32_16x16x32_bf16 a[60:63], v[120:123], v[56:59], a[60:63]
    v_exp_f32 v244, v244
    v_mfma_f32_16x16x32_bf16 a[60:63], v[124:127], v[60:63], a[60:63]
    v_exp_f32 v245, v245
    v_mfma_f32_16x16x32_bf16 v[248:251], a[224:227], v[132:135], v[184:187]
    s_waitcnt lgkmcnt(2)
    v_exp_f32 v246, v246
    v_mfma_f32_16x16x32_bf16 v[248:251], a[228:231], v[164:167], v[248:251]
    v_exp_f32 v247, v247
    v_mfma_f32_16x16x32_bf16 v[248:251], a[232:235], v[196:199], v[248:251]
    v_fma_f32 v191, v211, s11, v213
    v_cvt_pk_bf16_f32 v90, v244, v245
    v_mfma_f32_16x16x32_bf16 v[248:251], a[236:239], v[228:231], v[248:251]
    s_add_u32 m0, s76, s75
    v_cvt_pk_bf16_f32 v91, v246, v247
    ds_read_b128 v[120:123], v2 offset:30720
    v_mfma_f32_16x16x32_bf16 a[144:147], v[96:99], v[32:35], a[144:147]
    s_mov_b32 s76, s60
    buffer_load_dwordx4 v1, s[36:39], s77 offen sc1 lds
    v_mfma_f32_16x16x32_bf16 a[144:147], v[100:103], v[36:39], a[144:147]
    s_mov_b32 s60, s82
    v_exp_f32 v248, v248
    v_mfma_f32_16x16x32_bf16 a[148:151], v[96:99], v[40:43], a[148:151]
    s_mov_b32 s82, s95
    v_exp_f32 v249, v249
    v_mfma_f32_16x16x32_bf16 a[148:151], v[100:103], v[44:47], a[148:151]
    s_mov_b32 s95, s93
    v_exp_f32 v250, v250
    v_mfma_f32_16x16x32_bf16 v[252:255], a[224:227], v[136:139], v[152:155]
    s_mov_b32 s93, s99
    v_exp_f32 v251, v251
    v_mfma_f32_16x16x32_bf16 v[252:255], a[228:231], v[168:171], v[252:255]
    v_cvt_pk_bf16_f32 v76, v248, v249
    v_cvt_pk_bf16_f32 v77, v250, v251
    v_mfma_f32_16x16x32_bf16 v[252:255], a[232:235], v[200:203], v[252:255]
    ds_read_b128 v[124:127], v2 offset:31744
    v_add_u32 v2, s82, v1
    v_mfma_f32_16x16x32_bf16 v[252:255], a[236:239], v[232:235], v[252:255]
    buffer_load_dwordx4 v1, s[36:39], s77 offen offset:1024 sc1 lds
    v_mfma_f32_16x16x32_bf16 a[152:155], v[96:99], v[48:51], a[152:155]
    v_bfe_u32 v8, v1, 2, 6
    v_accvgpr_read_b32 v4, a112
    v_mfma_f32_16x16x32_bf16 a[152:155], v[100:103], v[52:55], a[152:155]
    v_accvgpr_read_b32 v5, a116
    v_add_u32 v8, 192, v8
    v_mfma_f32_16x16x32_bf16 a[156:159], v[96:99], v[56:59], a[156:159]
    v_exp_f32 v252, v252
    v_mfma_f32_16x16x32_bf16 a[156:159], v[100:103], v[60:63], a[156:159]
    v_exp_f32 v253, v253
    v_mfma_f32_16x16x32_bf16 a[160:163], v[104:107], v[32:35], a[160:163]
    v_exp_f32 v254, v254
    v_mfma_f32_16x16x32_bf16 a[160:163], v[108:111], v[36:39], a[160:163]
    v_exp_f32 v255, v255
    v_mfma_f32_16x16x32_bf16 v[240:243], a[224:227], v[140:143], v[156:159]
    buffer_load_dwordx4 v1, s[36:39], s77 offen offset:2048 sc1 lds
    v_mfma_f32_16x16x32_bf16 v[240:243], a[228:231], v[172:175], v[240:243]
    v_cvt_pk_bf16_f32 v84, v252, v253
    v_cvt_pk_bf16_f32 v85, v254, v255
    v_mfma_f32_16x16x32_bf16 v[240:243], a[232:235], v[204:207], v[240:243]
    v_cvt_pk_bf16_f32 v4, 0, v4
    v_cvt_pk_bf16_f32 v5, 0, v5
    v_mfma_f32_16x16x32_bf16 v[240:243], a[236:239], v[236:239], v[240:243]
    v_lshrrev_b32 v15, 8, v1
    ds_bpermute_b32 v4, v8, v4
    v_mfma_f32_16x16x32_bf16 a[164:167], v[104:107], v[40:43], a[164:167]
    ds_bpermute_b32 v5, v8, v5
    ds_read_b128 a[224:227], v2 offset:0
    v_mfma_f32_16x16x32_bf16 a[164:167], v[108:111], v[44:47], a[164:167]
    ds_read_b128 a[228:231], v2 offset:1024
    v_bfe_u32 v14, v1, 4, 4
    v_mfma_f32_16x16x32_bf16 a[168:171], v[104:107], v[48:51], a[168:171]
    ds_read_b128 a[232:235], v2 offset:2048
    v_lshlrev_b32 v15, 3, v15
    v_mfma_f32_16x16x32_bf16 a[168:171], v[108:111], v[52:55], a[168:171]
    buffer_load_dwordx4 v1, s[36:39], s77 offen offset:3072 sc1 lds
    v_mfma_f32_16x16x32_bf16 a[172:175], v[104:107], v[56:59], a[172:175]
    ds_read_b128 a[236:239], v2 offset:3072
    ds_read_b128 v[96:99], v2 offset:16384
    v_mfma_f32_16x16x32_bf16 a[172:175], v[108:111], v[60:63], a[172:175]
    ds_read_b128 v[100:103], v2 offset:17408
    v_sub_u32 v14, v14, v15
    v_mfma_f32_16x16x32_bf16 v[244:247], a[240:243], v[132:135], v[188:191]
    v_exp_f32 v240, v240
    v_mfma_f32_16x16x32_bf16 v[244:247], a[244:247], v[164:167], v[244:247]
    v_exp_f32 v241, v241
    v_mfma_f32_16x16x32_bf16 v[244:247], a[248:251], v[196:199], v[244:247]
    v_exp_f32 v242, v242
    v_mfma_f32_16x16x32_bf16 v[244:247], a[252:255], v[228:231], v[244:247]
    s_add_u32 s100, s77, 4096
    v_exp_f32 v243, v243
    s_waitcnt lgkmcnt(1)
    v_mfma_f32_16x16x32_bf16 a[176:179], v[112:115], v[32:35], a[176:179]
    s_add_u32 m0, m0, 4096
    v_cvt_pk_bf16_f32 v92, v240, v241
    v_cvt_pk_bf16_f32 v93, v242, v243
    v_mfma_f32_16x16x32_bf16 a[176:179], v[116:119], v[36:39], a[176:179]
    buffer_load_dwordx4 v1, s[36:39], s100 offen sc1 lds
    v_mfma_f32_16x16x32_bf16 a[180:183], v[112:115], v[40:43], a[180:183]
    v_exp_f32 v244, v244
    v_mfma_f32_16x16x32_bf16 a[180:183], v[116:119], v[44:47], a[180:183]
    v_exp_f32 v245, v245
    v_mfma_f32_16x16x32_bf16 v[248:251], a[240:243], v[136:139], v[152:155]
    v_exp_f32 v246, v246
    v_mfma_f32_16x16x32_bf16 v[248:251], a[244:247], v[168:171], v[248:251]
    v_exp_f32 v247, v247
    v_mfma_f32_16x16x32_bf16 v[248:251], a[248:251], v[200:203], v[248:251]
    v_cvt_pk_bf16_f32 v78, v244, v245
    v_cvt_pk_bf16_f32 v79, v246, v247
    v_mfma_f32_16x16x32_bf16 v[248:251], a[252:255], v[232:235], v[248:251]
    buffer_load_dwordx4 v1, s[36:39], s100 offen offset:1024 sc1 lds
    v_mfma_f32_16x16x32_bf16 a[184:187], v[112:115], v[48:51], a[184:187]
    v_and_b32 v15, 16, v1
    v_mov_b32 v31, 0x3f80
    v_mfma_f32_16x16x32_bf16 a[184:187], v[116:119], v[52:55], a[184:187]
    v_ashrrev_i32 v14, 1, v14
    v_lshlrev_b32 v15, v15, v31
    v_mfma_f32_16x16x32_bf16 a[188:191], v[112:115], v[56:59], a[188:191]
    v_exp_f32 v248, v248
    v_mfma_f32_16x16x32_bf16 a[188:191], v[116:119], v[60:63], a[188:191]
    v_exp_f32 v249, v249
    v_mfma_f32_16x16x32_bf16 a[192:195], v[120:123], v[32:35], a[192:195]
    v_exp_f32 v250, v250
    v_mfma_f32_16x16x32_bf16 a[192:195], v[124:127], v[36:39], a[192:195]
    v_exp_f32 v251, v251
    v_mfma_f32_16x16x32_bf16 v[252:255], a[240:243], v[140:143], v[156:159]
    buffer_load_dwordx4 v1, s[36:39], s100 offen offset:2048 sc1 lds
    v_mfma_f32_16x16x32_bf16 v[252:255], a[244:247], v[172:175], v[252:255]
    v_cvt_pk_bf16_f32 v86, v248, v249
    v_cvt_pk_bf16_f32 v87, v250, v251
    v_mfma_f32_16x16x32_bf16 v[252:255], a[248:251], v[204:207], v[252:255]
    v_cmp_eq_i32 vcc, 0, v14
    v_mul_f32 v4, s98, v4
    v_mfma_f32_16x16x32_bf16 v[252:255], a[252:255], v[236:239], v[252:255]
    v_cndmask_b32 v216, 0, v15, vcc
    v_cmp_eq_i32 vcc, 1, v14
    v_mfma_f32_16x16x32_bf16 a[196:199], v[120:123], v[40:43], a[196:199]
    v_mul_f32 v5, s98, v5
    v_cndmask_b32 v217, 0, v15, vcc
    v_mfma_f32_16x16x32_bf16 a[196:199], v[124:127], v[44:47], a[196:199]
    v_cmp_eq_i32 vcc, 2, v14
    v_and_b32 v31, 512, v1
    v_mfma_f32_16x16x32_bf16 a[200:203], v[120:123], v[48:51], a[200:203]
    v_exp_f32 v252, v252
    v_mfma_f32_16x16x32_bf16 a[200:203], v[124:127], v[52:55], a[200:203]
    buffer_load_dwordx4 v1, s[36:39], s100 offen offset:3072 sc1 lds
    v_mfma_f32_16x16x32_bf16 a[204:207], v[120:123], v[56:59], a[204:207]
    v_cndmask_b32 v218, 0, v15, vcc
    v_cmp_eq_i32 vcc, 3, v14
    v_mfma_f32_16x16x32_bf16 a[204:207], v[124:127], v[60:63], a[204:207]
    v_exp_f32 v4, v4
    v_smfmac_f32_16x16x64_bf16 a[208:211], a[136:139], v[32:39], v215
    v_cndmask_b32 v219, 0, v15, vcc
    v_cmp_eq_i32 vcc, -8, v14
    v_smfmac_f32_16x16x64_bf16 a[212:215], a[136:139], v[40:47], v215
    v_exp_f32 v5, v5
    v_smfmac_f32_16x16x64_bf16 a[216:219], a[136:139], v[48:55], v215
    v_cndmask_b32 v220, 0, v15, vcc
    v_cmp_eq_i32 vcc, -7, v14
    v_smfmac_f32_16x16x64_bf16 a[220:223], a[136:139], v[56:63], v215
    s_add_u32 s77, s77, 32768
    v_cndmask_b32 v221, 0, v15, vcc
    v_cmp_eq_i32 vcc, -6, v14
    v_add_f32 v4, 1.0, v4
    v_add_f32 v5, 1.0, v5
    v_cndmask_b32 v222, 0, v15, vcc
    v_cmp_eq_i32 vcc, -5, v14
    v_rcp_f32 v4, v4
    v_rcp_f32 v5, v5
    v_cndmask_b32 v223, 0, v15, vcc
    v_mad_u32_u24 v31, v31, 17, v1
    s_cmp_eq_u32 s6, 7
    s_cselect_b32 s16, s8, 0
    s_cselect_b32 s17, s9, 0
    s_cselect_b32 s18, s10, 0
    s_cselect_b32 s19, s11, 0
    s_cselect_b32 s20, s12, 0
    s_cselect_b32 s21, s13, 0
    s_cselect_b32 s22, s14, 0
    s_cselect_b32 s23, s15, 0
    s_cbranch_scc1 K1_J7
K1_J7_BACK:
    v_add_f32 v212, s20, v152
    v_fma_f32 v176, v208, s16, v212
    v_fma_f32 v177, v209, s16, v212
    v_fma_f32 v178, v210, s16, v212
    v_fma_f32 v179, v211, s16, v212
    s_nop 1
    s_waitcnt lgkmcnt(0)
    v_mfma_f32_16x16x32_bf16 v[240:243], a[224:227], v[136:139], v[176:179]
    s_mov_b32 s99, s76
    ds_read_b128 v[104:107], v2 offset:18432
    ds_read_b128 v[108:111], v2 offset:19456
    v_mfma_f32_16x16x32_bf16 v[240:243], a[228:231], v[168:171], v[240:243]
    v_exp_f32 v253, v253
    v_mfma_f32_16x16x32_bf16 v[240:243], a[232:235], v[200:203], v[240:243]
    v_exp_f32 v254, v254
    v_mfma_f32_16x16x32_bf16 v[240:243], a[236:239], v[232:235], v[240:243]
    v_exp_f32 v255, v255
    v_mfma_f32_16x16x32_bf16 a[4:7], v[96:99], v[72:75], a[4:7]
    s_add_u32 m0, s76, s75
    v_cvt_pk_bf16_f32 v94, v252, v253
    v_cvt_pk_bf16_f32 v95, v254, v255
    v_mfma_f32_16x16x32_bf16 a[4:7], v[100:103], v[76:79], a[4:7]
    s_mov_b32 s76, s60
    buffer_load_dwordx4 v1, s[36:39], s77 offen sc1 lds
    v_mfma_f32_16x16x32_bf16 a[8:11], v[96:99], v[80:83], a[8:11]
    s_mov_b32 s60, s82
    ds_read_b128 a[240:243], v2 offset:4096
    ds_read_b128 a[244:247], v2 offset:5120
    v_mfma_f32_16x16x32_bf16 a[8:11], v[100:103], v[84:87], a[8:11]
    s_mov_b32 s82, s95
    ds_read_b128 a[248:251], v2 offset:6144
    v_add_f32 v213, s21, v152
    v_mfma_f32_16x16x32_bf16 a[12:15], v[96:99], v[88:91], a[12:15]
    s_mov_b32 s95, s93
    ds_read_b128 a[252:255], v2 offset:7168
    v_fma_f32 v180, v208, s17, v213
    v_mfma_f32_16x16x32_bf16 a[12:15], v[100:103], v[92:95], a[12:15]
    s_mov_b32 s93, s99
    ds_read_b128 v[112:115], v2 offset:20480
    v_fma_f32 v181, v209, s17, v213
    v_mfma_f32_16x16x32_bf16 v[244:247], a[224:227], v[140:143], v[156:159]
    ds_read_b128 v[116:119], v2 offset:21504
    v_fma_f32 v182, v210, s17, v213
    v_mfma_f32_16x16x32_bf16 v[244:247], a[228:231], v[172:175], v[244:247]
    v_fma_f32 v183, v211, s17, v213
    ds_read_b128 v[120:123], v2 offset:22528
    v_mfma_f32_16x16x32_bf16 v[244:247], a[232:235], v[204:207], v[244:247]
    ds_read_b128 v[124:127], v2 offset:23552
    v_add_f32 v212, s22, v152
    v_mfma_f32_16x16x32_bf16 v[244:247], a[236:239], v[236:239], v[244:247]
    s_waitcnt lgkmcnt(4)
    buffer_load_dwordx4 v1, s[36:39], s77 offen offset:1024 sc1 lds
    v_mfma_f32_16x16x32_bf16 a[20:23], v[104:107], v[72:75], a[20:23]
    ds_read_b128 a[224:227], v2 offset:8192
    ds_read_b128 a[228:231], v2 offset:9216
    v_mfma_f32_16x16x32_bf16 a[20:23], v[108:111], v[76:79], a[20:23]
    ds_read_b128 a[232:235], v2 offset:10240
    v_fma_f32 v184, v208, s18, v212
    v_mfma_f32_16x16x32_bf16 a[24:27], v[104:107], v[80:83], a[24:27]
    ds_read_b128 a[236:239], v2 offset:11264
    v_fma_f32 v185, v209, s18, v212
    v_mfma_f32_16x16x32_bf16 a[24:27], v[108:111], v[84:87], a[24:27]
    ds_read_b128 v[96:99], v2 offset:24576
    v_fma_f32 v186, v210, s18, v212
    v_mfma_f32_16x16x32_bf16 a[28:31], v[104:107], v[88:91], a[28:31]
    ds_read_b128 v[100:103], v2 offset:25600
    v_fma_f32 v187, v211, s18, v212
    v_mfma_f32_16x16x32_bf16 a[28:31], v[108:111], v[92:95], a[28:31]
    v_exp_f32 v240, v240
    v_mfma_f32_16x16x32_bf16 v[248:251], a[240:243], v[136:139], v[180:183]
    v_exp_f32 v241, v241
    v_mfma_f32_16x16x32_bf16 v[248:251], a[244:247], v[168:171], v[248:251]
    v_exp_f32 v242, v242
    v_mfma_f32_16x16x32_bf16 v[248:251], a[248:251], v[200:203], v[248:251]
    buffer_load_dwordx4 v1, s[36:39], s77 offen offset:2048 sc1 lds
    v_mfma_f32_16x16x32_bf16 v[248:251], a[252:255], v[232:235], v[248:251]
    s_waitcnt lgkmcnt(0)
    v_exp_f32 v243, v243
    v_mfma_f32_16x16x32_bf16 a[36:39], v[112:115], v[72:75], a[36:39]
    v_cvt_pk_bf16_f32 v48, v240, v241
    v_cvt_pk_bf16_f32 v49, v242, v243
    v_mfma_f32_16x16x32_bf16 a[36:39], v[116:119], v[76:79], a[36:39]
    ds_read_b128 v[104:107], v2 offset:26624
    ds_read_b128 v[108:111], v2 offset:27648
    v_mfma_f32_16x16x32_bf16 a[40:43], v[112:115], v[80:83], a[40:43]
    v_exp_f32 v244, v244
    v_mfma_f32_16x16x32_bf16 a[40:43], v[116:119], v[84:87], a[40:43]
    v_exp_f32 v245, v245
    v_mfma_f32_16x16x32_bf16 a[44:47], v[112:115], v[88:91], a[44:47]
    v_exp_f32 v246, v246
    v_mfma_f32_16x16x32_bf16 a[44:47], v[116:119], v[92:95], a[44:47]
    s_waitcnt vmcnt(11)
    v_exp_f32 v247, v247
    v_mfma_f32_16x16x32_bf16 v[12:15], v[64:67], v[216:219], 0
    buffer_load_dwordx4 v1, s[36:39], s77 offen offset:3072 sc1 lds
    v_mfma_f32_16x16x32_bf16 v[16:19], v[68:71], v[216:219], 0
    v_cvt_pk_bf16_f32 v56, v244, v245
    v_cvt_pk_bf16_f32 v57, v246, v247
    v_mfma_f32_16x16x32_bf16 v[252:255], a[240:243], v[140:143], v[156:159]
    ds_read_b128 a[240:243], v2 offset:12288
    ds_read_b128 v[112:115], v2 offset:28672
    v_mfma_f32_16x16x32_bf16 v[252:255], a[244:247], v[172:175], v[252:255]
    v_cvt_pk_bf16_f32 v12, v12, v13
    v_cvt_pk_bf16_f32 v13, v14, v15
    v_mfma_f32_16x16x32_bf16 v[252:255], a[248:251], v[204:207], v[252:255]
    v_cvt_pk_bf16_f32 v14, v16, v17
    v_cvt_pk_bf16_f32 v15, v18, v19
    v_mfma_f32_16x16x32_bf16 v[252:255], a[252:255], v[236:239], v[252:255]
    buffer_store_dwordx4 v[12:15], v31, s[56:59], s63 offen offset:0 sc1
    v_mfma_f32_16x16x32_bf16 a[52:55], v[120:123], v[72:75], a[52:55]
    ds_read_b128 a[244:247], v2 offset:13312
    ds_read_b128 a[248:251], v2 offset:14336
    v_mfma_f32_16x16x32_bf16 a[52:55], v[124:127], v[76:79], a[52:55]
    ds_read_b128 a[252:255], v2 offset:15360
    v_add_f32 v213, s23, v152
    v_mfma_f32_16x16x32_bf16 a[56:59], v[120:123], v[80:83], a[56:59]
    s_add_u32 s100, s77, 4096
    ds_read_b128 v[116:119], v2 offset:29696
    v_fma_f32 v188, v208, s19, v213
    v_mfma_f32_16x16x32_bf16 a[56:59], v[124:127], v[84:87], a[56:59]
    s_add_u32 m0, m0, 4096
    v_exp_f32 v248, v248
    v_mfma_f32_16x16x32_bf16 a[60:63], v[120:123], v[88:91], a[60:63]
    buffer_load_dwordx4 v1, s[36:39], s100 offen sc1 lds
    v_mfma_f32_16x16x32_bf16 a[60:63], v[124:127], v[92:95], a[60:63]
    v_exp_f32 v249, v249
    v_mfma_f32_16x16x32_bf16 v[12:15], v[64:67], v[220:223], 0
    v_exp_f32 v250, v250
    v_mfma_f32_16x16x32_bf16 v[16:19], v[68:71], v[220:223], 0
    v_exp_f32 v251, v251
    v_mfma_f32_16x16x32_bf16 v[240:243], a[224:227], v[136:139], v[184:187]
    v_fma_f32 v189, v209, s19, v213
    v_fma_f32 v190, v210, s19, v213
    v_mfma_f32_16x16x32_bf16 v[240:243], a[228:231], v[168:171], v[240:243]
    v_fma_f32 v191, v211, s19, v213
    v_cvt_pk_bf16_f32 v12, v12, v13
    v_mfma_f32_16x16x32_bf16 v[240:243], a[232:235], v[200:203], v[240:243]
    v_cvt_pk_bf16_f32 v13, v14, v15
    v_cvt_pk_bf16_f32 v14, v16, v17
    v_mfma_f32_16x16x32_bf16 v[240:243], a[236:239], v[232:235], v[240:243]
    v_cvt_pk_bf16_f32 v15, v18, v19
    v_cvt_pk_bf16_f32 v50, v248, v249
    v_mfma_f32_16x16x32_bf16 a[148:151], v[96:99], v[72:75], a[148:151]
    buffer_load_dwordx4 v1, s[36:39], s100 offen offset:1024 sc1 lds
    v_mfma_f32_16x16x32_bf16 a[148:151], v[100:103], v[76:79], a[148:151]
    buffer_store_dwordx4 v[12:15], v31, s[56:59], s63 offen offset:1024 sc1
    v_mfma_f32_16x16x32_bf16 a[152:155], v[96:99], v[80:83], a[152:155]
    v_cvt_pk_bf16_f32 v51, v250, v251
    ds_read_b128 v[120:123], v2 offset:30720
    v_mfma_f32_16x16x32_bf16 a[152:155], v[100:103], v[84:87], a[152:155]
    ds_read_b128 v[124:127], v2 offset:31744
    v_add_u32 v2, s82, v1
    v_mfma_f32_16x16x32_bf16 a[156:159], v[96:99], v[88:91], a[156:159]
    v_exp_f32 v252, v252
    v_mfma_f32_16x16x32_bf16 a[156:159], v[100:103], v[92:95], a[156:159]
    v_exp_f32 v253, v253
    v_mfma_f32_16x16x32_bf16 v[12:15], v[20:23], v[216:219], 0
    v_exp_f32 v254, v254
    v_mfma_f32_16x16x32_bf16 v[16:19], v[24:27], v[216:219], 0
    v_exp_f32 v255, v255
    v_mfma_f32_16x16x32_bf16 v[244:247], a[224:227], v[140:143], v[156:159]
    buffer_load_dwordx4 v1, s[36:39], s100 offen offset:2048 sc1 lds
    v_mfma_f32_16x16x32_bf16 v[244:247], a[228:231], v[172:175], v[244:247]
    v_cvt_pk_bf16_f32 v58, v252, v253
    v_cvt_pk_bf16_f32 v59, v254, v255
    v_mfma_f32_16x16x32_bf16 v[244:247], a[232:235], v[204:207], v[244:247]
    v_cvt_pk_bf16_f32 v12, v12, v13
    v_cvt_pk_bf16_f32 v13, v14, v15
    v_mfma_f32_16x16x32_bf16 v[244:247], a[236:239], v[236:239], v[244:247]
    s_waitcnt lgkmcnt(0)
    v_cvt_pk_bf16_f32 v14, v16, v17
    v_cvt_pk_bf16_f32 v15, v18, v19
    v_mfma_f32_16x16x32_bf16 a[164:167], v[104:107], v[72:75], a[164:167]
    buffer_store_dwordx4 v[12:15], v31, s[56:59], s63 offen offset:512 sc1
    v_mfma_f32_16x16x32_bf16 a[164:167], v[108:111], v[76:79], a[164:167]
    v_exp_f32 v240, v240
    v_mfma_f32_16x16x32_bf16 a[168:171], v[104:107], v[80:83], a[168:171]
    v_exp_f32 v241, v241
    v_mfma_f32_16x16x32_bf16 a[168:171], v[108:111], v[84:87], a[168:171]
    v_exp_f32 v242, v242
    v_mfma_f32_16x16x32_bf16 a[172:175], v[104:107], v[88:91], a[172:175]
    v_exp_f32 v243, v243
    v_mfma_f32_16x16x32_bf16 a[172:175], v[108:111], v[92:95], a[172:175]
    buffer_load_dwordx4 v1, s[36:39], s100 offen offset:3072 sc1 lds
    v_mfma_f32_16x16x32_bf16 v[12:15], v[20:23], v[220:223], 0
    v_exp_f32 v244, v244
    v_mfma_f32_16x16x32_bf16 v[16:19], v[24:27], v[220:223], 0
    v_exp_f32 v245, v245
    v_mfma_f32_16x16x32_bf16 v[248:251], a[240:243], v[136:139], v[188:191]
    v_exp_f32 v246, v246
    v_mfma_f32_16x16x32_bf16 v[248:251], a[244:247], v[168:171], v[248:251]
    v_exp_f32 v247, v247
    v_mfma_f32_16x16x32_bf16 v[248:251], a[248:251], v[200:203], v[248:251]
    v_cvt_pk_bf16_f32 v12, v12, v13
    v_cvt_pk_bf16_f32 v13, v14, v15
    v_mfma_f32_16x16x32_bf16 v[248:251], a[252:255], v[232:235], v[248:251]
    v_cvt_pk_bf16_f32 v14, v16, v17
    v_cvt_pk_bf16_f32 v15, v18, v19
    v_mfma_f32_16x16x32_bf16 a[180:183], v[112:115], v[72:75], a[180:183]
    buffer_store_dwordx4 v[12:15], v31, s[56:59], s63 offen offset:1536 sc1
    v_mfma_f32_16x16x32_bf16 a[180:183], v[116:119], v[76:79], a[180:183]
    s_add_u32 s77, s77, 32768
    v_cvt_pk_bf16_f32 v52, v240, v241
    v_cvt_pk_bf16_f32 v53, v242, v243
    v_mfma_f32_16x16x32_bf16 a[184:187], v[112:115], v[80:83], a[184:187]
    v_exp_f32 v248, v248
    v_mfma_f32_16x16x32_bf16 a[184:187], v[116:119], v[84:87], a[184:187]
    v_exp_f32 v249, v249
    v_mfma_f32_16x16x32_bf16 a[188:191], v[112:115], v[88:91], a[188:191]
    v_exp_f32 v250, v250
    v_mfma_f32_16x16x32_bf16 a[188:191], v[116:119], v[92:95], a[188:191]
    v_exp_f32 v251, v251
    v_mfma_f32_16x16x32_bf16 v[12:15], v[144:147], v[216:219], 0
    v_cvt_pk_bf16_f32 v60, v244, v245
    v_cvt_pk_bf16_f32 v61, v246, v247
    v_mfma_f32_16x16x32_bf16 v[16:19], a[140:143], v[216:219], 0
    v_cvt_pk_bf16_f32 v54, v248, v249
    v_cvt_pk_bf16_f32 v55, v250, v251
    v_mfma_f32_16x16x32_bf16 v[252:255], a[240:243], v[140:143], v[156:159]
    v_accvgpr_read_b32 v6, a120
    v_accvgpr_read_b32 v7, a124
    v_mfma_f32_16x16x32_bf16 v[252:255], a[244:247], v[172:175], v[252:255]
    v_cvt_pk_bf16_f32 v12, v12, v13
    v_cvt_pk_bf16_f32 v13, v14, v15
    v_mfma_f32_16x16x32_bf16 v[252:255], a[248:251], v[204:207], v[252:255]
    v_cvt_pk_bf16_f32 v14, v16, v17
    v_cvt_pk_bf16_f32 v15, v18, v19
    v_mfma_f32_16x16x32_bf16 v[252:255], a[252:255], v[236:239], v[252:255]
    buffer_store_dwordx4 v[12:15], v1, s[56:59], s64 offen offset:0 sc1
    v_mfma_f32_16x16x32_bf16 a[196:199], v[120:123], v[72:75], a[196:199]
    v_cvt_pk_bf16_f32 v6, 0, v6
    v_cvt_pk_bf16_f32 v7, 0, v7
    v_mfma_f32_16x16x32_bf16 a[196:199], v[124:127], v[76:79], a[196:199]
    ds_bpermute_b32 v6, v8, v6
    ds_bpermute_b32 v7, v8, v7
    s_waitcnt vmcnt(8) lgkmcnt(0)
    s_barrier
    v_mfma_f32_16x16x32_bf16 a[200:203], v[120:123], v[80:83], a[200:203]
    ds_read_b128 a[224:227], v2 offset:0
    ds_read_b128 a[228:231], v2 offset:1024
    v_mfma_f32_16x16x32_bf16 a[200:203], v[124:127], v[84:87], a[200:203]
    ds_read_b128 a[232:235], v2 offset:2048
    v_mul_f32 v6, s98, v6
    v_mfma_f32_16x16x32_bf16 a[204:207], v[120:123], v[88:91], a[204:207]
    ds_read_b128 a[236:239], v2 offset:3072
    v_mul_f32 v7, s98, v7
    v_mfma_f32_16x16x32_bf16 a[204:207], v[124:127], v[92:95], a[204:207]
    ds_read_b128 v[96:99], v2 offset:16384
    v_mfma_f32_16x16x32_bf16 v[12:15], v[144:147], v[220:223], 0
    ds_read_b128 v[100:103], v2 offset:17408
    v_mfma_f32_16x16x32_bf16 v[16:19], a[140:143], v[220:223], 0
    v_exp_f32 v252, v252
    v_smfmac_f32_16x16x64_bf16 a[212:215], a[136:139], v[72:79], v215
    v_exp_f32 v6, v6
    v_smfmac_f32_16x16x64_bf16 a[216:219], a[136:139], v[80:87], v215
    v_exp_f32 v7, v7
    v_smfmac_f32_16x16x64_bf16 a[220:223], a[136:139], v[88:95], v215
    v_cvt_pk_bf16_f32 v12, v12, v13
    v_cvt_pk_bf16_f32 v13, v14, v15
    v_add_f32 v6, 1.0, v6
    v_add_f32 v7, 1.0, v7
    v_cvt_pk_bf16_f32 v14, v16, v17
    v_cvt_pk_bf16_f32 v15, v18, v19
    v_rcp_f32 v6, v6
    v_rcp_f32 v7, v7
    buffer_store_dwordx4 v[12:15], v1, s[56:59], s62 offen offset:0 sc1
    s_nop 1
    v_accvgpr_read_b32 v9, a208
    v_accvgpr_read_b32 v10, a209
    v_add_f32 v9, v9, v10
    v_cmp_nge_f32 vcc, 0x5f800000, v9
    v_rcp_f32 v10, v9
    s_nop 0
    s_or_b64 s[84:85], s[84:85], vcc
    v_mul_f32 v10, v10, v4
    v_accvgpr_read_b32 v12, a0
    v_accvgpr_read_b32 v13, a1
    v_accvgpr_read_b32 v14, a2
    v_accvgpr_read_b32 v15, a3
    v_accvgpr_read_b32 v16, a16
    v_accvgpr_read_b32 v17, a17
    v_accvgpr_read_b32 v18, a18
    v_accvgpr_read_b32 v19, a19
    v_pk_mul_f32 v[12:13], v[12:13], v[10:11] op_sel_hi:[1,0]
    v_pk_mul_f32 v[14:15], v[14:15], v[10:11] op_sel_hi:[1,0]
    v_pk_mul_f32 v[16:17], v[16:17], v[10:11] op_sel_hi:[1,0]
    v_pk_mul_f32 v[18:19], v[18:19], v[10:11] op_sel_hi:[1,0]
    v_cvt_pk_bf16_f32 v12, v12, v13
    v_cvt_pk_bf16_f32 v13, v14, v15
    v_cvt_pk_bf16_f32 v14, v16, v17
    v_cvt_pk_bf16_f32 v15, v18, v19
    buffer_store_dwordx4 v[12:15], v1, s[40:43], s80 offen offset:0 sc1
    v_accvgpr_read_b32 v20, a32
    v_accvgpr_read_b32 v21, a33
    v_accvgpr_read_b32 v22, a34
    v_accvgpr_read_b32 v23, a35
    v_accvgpr_read_b32 v24, a48
    v_accvgpr_read_b32 v25, a49
    v_accvgpr_read_b32 v26, a50
    v_accvgpr_read_b32 v27, a51
    v_pk_mul_f32 v[20:21], v[20:21], v[10:11] op_sel_hi:[1,0]
    v_pk_mul_f32 v[22:23], v[22:23], v[10:11] op_sel_hi:[1,0]
    v_pk_mul_f32 v[24:25], v[24:25], v[10:11] op_sel_hi:[1,0]
    v_pk_mul_f32 v[26:27], v[26:27], v[10:11] op_sel_hi:[1,0]
    v_cvt_pk_bf16_f32 v20, v20, v21
    v_cvt_pk_bf16_f32 v21, v22, v23
    v_cvt_pk_bf16_f32 v22, v24, v25
    v_cvt_pk_bf16_f32 v23, v26, v27
    buffer_store_dwordx4 v[20:23], v1, s[40:43], s80 offen offset:1024 sc1
    v_accvgpr_read_b32 v12, a144
    v_accvgpr_read_b32 v13, a145
    v_accvgpr_read_b32 v14, a146
    v_accvgpr_read_b32 v15, a147
    v_accvgpr_read_b32 v16, a160
    v_accvgpr_read_b32 v17, a161
    v_accvgpr_read_b32 v18, a162
    v_accvgpr_read_b32 v19, a163
    v_pk_mul_f32 v[12:13], v[12:13], v[10:11] op_sel_hi:[1,0]
    v_pk_mul_f32 v[14:15], v[14:15], v[10:11] op_sel_hi:[1,0]
    v_pk_mul_f32 v[16:17], v[16:17], v[10:11] op_sel_hi:[1,0]
    v_pk_mul_f32 v[18:19], v[18:19], v[10:11] op_sel_hi:[1,0]
    v_cvt_pk_bf16_f32 v12, v12, v13
    v_cvt_pk_bf16_f32 v13, v14, v15
    v_cvt_pk_bf16_f32 v14, v16, v17
    v_cvt_pk_bf16_f32 v15, v18, v19
    buffer_store_dwordx4 v[12:15], v1, s[40:43], s80 offen offset:2048 sc1
    v_accvgpr_read_b32 v20, a176
    v_accvgpr_read_b32 v21, a177
    v_accvgpr_read_b32 v22, a178
    v_accvgpr_read_b32 v23, a179
    v_accvgpr_read_b32 v24, a192
    v_accvgpr_read_b32 v25, a193
    v_accvgpr_read_b32 v26, a194
    v_accvgpr_read_b32 v27, a195
    v_pk_mul_f32 v[20:21], v[20:21], v[10:11] op_sel_hi:[1,0]
    v_pk_mul_f32 v[22:23], v[22:23], v[10:11] op_sel_hi:[1,0]
    v_pk_mul_f32 v[24:25], v[24:25], v[10:11] op_sel_hi:[1,0]
    v_pk_mul_f32 v[26:27], v[26:27], v[10:11] op_sel_hi:[1,0]
    v_cvt_pk_bf16_f32 v20, v20, v21
    v_cvt_pk_bf16_f32 v21, v22, v23
    v_cvt_pk_bf16_f32 v22, v24, v25
    v_cvt_pk_bf16_f32 v23, v26, v27
    buffer_store_dwordx4 v[20:23], v1, s[40:43], s80 offen offset:3072 sc1
    v_accvgpr_read_b32 v9, a212
    v_accvgpr_read_b32 v10, a213
    v_add_f32 v9, v9, v10
    v_cmp_nge_f32 vcc, 0x5f800000, v9
    v_rcp_f32 v10, v9
    s_nop 0
    s_or_b64 s[84:85], s[84:85], vcc
    v_mul_f32 v10, v10, v5
    s_add_u32 s72, s80, 622592
    v_accvgpr_read_b32 v12, a4
    v_accvgpr_read_b32 v13, a5
    v_accvgpr_read_b32 v14, a6
    v_accvgpr_read_b32 v15, a7
    v_accvgpr_read_b32 v16, a20
    v_accvgpr_read_b32 v17, a21
    v_accvgpr_read_b32 v18, a22
    v_accvgpr_read_b32 v19, a23
    v_pk_mul_f32 v[12:13], v[12:13], v[10:11] op_sel_hi:[1,0]
    v_pk_mul_f32 v[14:15], v[14:15], v[10:11] op_sel_hi:[1,0]
    v_pk_mul_f32 v[16:17], v[16:17], v[10:11] op_sel_hi:[1,0]
    v_pk_mul_f32 v[18:19], v[18:19], v[10:11] op_sel_hi:[1,0]
    v_cvt_pk_bf16_f32 v12, v12, v13
    v_cvt_pk_bf16_f32 v13, v14, v15
    v_cvt_pk_bf16_f32 v14, v16, v17
    v_cvt_pk_bf16_f32 v15, v18, v19
    buffer_store_dwordx4 v[12:15], v1, s[40:43], s72 offen offset:0 sc1
    v_accvgpr_read_b32 v20, a36
    v_accvgpr_read_b32 v21, a37
    v_accvgpr_read_b32 v22, a38
    v_accvgpr_read_b32 v23, a39
    v_accvgpr_read_b32 v24, a52
    v_accvgpr_read_b32 v25, a53
    v_accvgpr_read_b32 v26, a54
    v_accvgpr_read_b32 v27, a55
    v_pk_mul_f32 v[20:21], v[20:21], v[10:11] op_sel_hi:[1,0]
    v_pk_mul_f32 v[22:23], v[22:23], v[10:11] op_sel_hi:[1,0]
    v_pk_mul_f32 v[24:25], v[24:25], v[10:11] op_sel_hi:[1,0]
    v_pk_mul_f32 v[26:27], v[26:27], v[10:11] op_sel_hi:[1,0]
    v_cvt_pk_bf16_f32 v20, v20, v21
    v_cvt_pk_bf16_f32 v21, v22, v23
    v_cvt_pk_bf16_f32 v22, v24, v25
    v_cvt_pk_bf16_f32 v23, v26, v27
    buffer_store_dwordx4 v[20:23], v1, s[40:43], s72 offen offset:1024 sc1
    v_accvgpr_read_b32 v12, a148
    v_accvgpr_read_b32 v13, a149
    v_accvgpr_read_b32 v14, a150
    v_accvgpr_read_b32 v15, a151
    v_accvgpr_read_b32 v16, a164
    v_accvgpr_read_b32 v17, a165
    v_accvgpr_read_b32 v18, a166
    v_accvgpr_read_b32 v19, a167
    v_pk_mul_f32 v[12:13], v[12:13], v[10:11] op_sel_hi:[1,0]
    v_pk_mul_f32 v[14:15], v[14:15], v[10:11] op_sel_hi:[1,0]
    v_pk_mul_f32 v[16:17], v[16:17], v[10:11] op_sel_hi:[1,0]
    v_pk_mul_f32 v[18:19], v[18:19], v[10:11] op_sel_hi:[1,0]
    v_cvt_pk_bf16_f32 v12, v12, v13
    v_cvt_pk_bf16_f32 v13, v14, v15
    v_cvt_pk_bf16_f32 v14, v16, v17
    v_cvt_pk_bf16_f32 v15, v18, v19
    buffer_store_dwordx4 v[12:15], v1, s[40:43], s72 offen offset:2048 sc1
    v_accvgpr_read_b32 v20, a180
    v_accvgpr_read_b32 v21, a181
    v_accvgpr_read_b32 v22, a182
    v_accvgpr_read_b32 v23, a183
    v_accvgpr_read_b32 v24, a196
    v_accvgpr_read_b32 v25, a197
    v_accvgpr_read_b32 v26, a198
    v_accvgpr_read_b32 v27, a199
    v_pk_mul_f32 v[20:21], v[20:21], v[10:11] op_sel_hi:[1,0]
    v_pk_mul_f32 v[22:23], v[22:23], v[10:11] op_sel_hi:[1,0]
    v_pk_mul_f32 v[24:25], v[24:25], v[10:11] op_sel_hi:[1,0]
    v_pk_mul_f32 v[26:27], v[26:27], v[10:11] op_sel_hi:[1,0]
    v_cvt_pk_bf16_f32 v20, v20, v21
    v_cvt_pk_bf16_f32 v21, v22, v23
    v_cvt_pk_bf16_f32 v22, v24, v25
    v_cvt_pk_bf16_f32 v23, v26, v27
    buffer_store_dwordx4 v[20:23], v1, s[40:43], s72 offen offset:3072 sc1
    v_mov_b32 v9, 1
    v_lshlrev_b32 v216, 20, v1
    s_lshl2_add_u32 s7, s4, s101
    s_add_u32 s7, s7, 163840
    s_waitcnt vmcnt(8)
    buffer_store_dword v9, v216, s[32:35], s7 offen sc1
    s_sub_u32 s78, 14, s6
    s_sub_u32 s78, s78, s6
    s_cmp_eq_u32 s78, 0
    s_cbranch_scc1 K1_LS_END
.p2align 3
K1_LS:
    s_waitcnt lgkmcnt(0)
    v_mfma_f32_16x16x32_bf16 v[240:243], a[224:227], v[136:139], v[176:179]
    s_mov_b32 s99, s76
    ds_read_b128 v[104:107], v2 offset:18432
    ds_read_b128 v[108:111], v2 offset:19456
    v_mfma_f32_16x16x32_bf16 v[240:243], a[228:231], v[168:171], v[240:243]
    v_exp_f32 v253, v253
    v_mfma_f32_16x16x32_bf16 v[240:243], a[232:235], v[200:203], v[240:243]
    v_exp_f32 v254, v254
    v_mfma_f32_16x16x32_bf16 v[240:243], a[236:239], v[232:235], v[240:243]
    v_exp_f32 v255, v255
    v_mfma_f32_16x16x32_bf16 a[8:11], v[96:99], v[48:51], a[8:11]
    s_add_u32 m0, s76, s75
    v_cvt_pk_bf16_f32 v62, v252, v253
    v_cvt_pk_bf16_f32 v63, v254, v255
    v_mfma_f32_16x16x32_bf16 a[8:11], v[100:103], v[52:55], a[8:11]
    s_mov_b32 s76, s60
    ds_read_b128 a[240:243], v2 offset:4096
    ds_read_b128 a[244:247], v2 offset:5120
    v_mfma_f32_16x16x32_bf16 a[12:15], v[96:99], v[56:59], a[12:15]
    s_mov_b32 s60, s82
    buffer_load_dwordx4 v1, s[36:39], s77 offen sc1 lds
    v_mfma_f32_16x16x32_bf16 a[12:15], v[100:103], v[60:63], a[12:15]
    s_mov_b32 s82, s95
    ds_read_b128 a[248:251], v2 offset:6144
    ds_read_b128 a[252:255], v2 offset:7168
    v_mfma_f32_16x16x32_bf16 v[244:247], a[224:227], v[140:143], v[156:159]
    s_mov_b32 s95, s93
    v_exp_f32 v240, v240
    v_mfma_f32_16x16x32_bf16 v[244:247], a[228:231], v[172:175], v[244:247]
    s_mov_b32 s93, s99
    ds_read_b128 v[112:115], v2 offset:20480
    ds_read_b128 v[116:119], v2 offset:21504
    v_mfma_f32_16x16x32_bf16 v[244:247], a[232:235], v[204:207], v[244:247]
    buffer_load_dwordx4 v1, s[36:39], s77 offen offset:1024 sc1 lds
    v_mfma_f32_16x16x32_bf16 v[244:247], a[236:239], v[236:239], v[244:247]
    s_waitcnt lgkmcnt(6)
    v_exp_f32 v241, v241
    v_mfma_f32_16x16x32_bf16 a[24:27], v[104:107], v[48:51], a[24:27]
    v_exp_f32 v242, v242
    v_mfma_f32_16x16x32_bf16 a[24:27], v[108:111], v[52:55], a[24:27]
    v_exp_f32 v243, v243
    v_mfma_f32_16x16x32_bf16 a[28:31], v[104:107], v[56:59], a[28:31]
    buffer_load_dwordx4 v1, s[36:39], s77 offen offset:2048 sc1 lds
    v_mfma_f32_16x16x32_bf16 a[28:31], v[108:111], v[60:63], a[28:31]
    s_waitcnt lgkmcnt(2)
    ds_read_b128 v[120:123], v2 offset:22528
    ds_read_b128 v[124:127], v2 offset:23552
    v_mfma_f32_16x16x32_bf16 v[248:251], a[240:243], v[136:139], v[180:183]
    v_cvt_pk_bf16_f32 v80, v240, v241
    v_cvt_pk_bf16_f32 v81, v242, v243
    v_mfma_f32_16x16x32_bf16 v[248:251], a[244:247], v[168:171], v[248:251]
    v_exp_f32 v244, v244
    v_mfma_f32_16x16x32_bf16 v[248:251], a[248:251], v[200:203], v[248:251]
    buffer_load_dwordx4 v1, s[36:39], s77 offen offset:3072 sc1 lds
    v_mfma_f32_16x16x32_bf16 v[248:251], a[252:255], v[232:235], v[248:251]
    s_waitcnt lgkmcnt(2)
    ds_read_b128 a[224:227], v2 offset:8192
    ds_read_b128 a[228:231], v2 offset:9216
    v_mfma_f32_16x16x32_bf16 a[40:43], v[112:115], v[48:51], a[40:43]
    v_exp_f32 v245, v245
    v_mfma_f32_16x16x32_bf16 a[40:43], v[116:119], v[52:55], a[40:43]
    ds_read_b128 a[232:235], v2 offset:10240
    ds_read_b128 a[236:239], v2 offset:11264
    v_mfma_f32_16x16x32_bf16 a[44:47], v[112:115], v[56:59], a[44:47]
    s_add_u32 s100, s77, 4096
    ds_read_b128 v[96:99], v2 offset:24576
    v_cvt_pk_bf16_f32 v88, v244, v245
    v_mfma_f32_16x16x32_bf16 a[44:47], v[116:119], v[60:63], a[44:47]
    s_add_u32 m0, m0, 4096
    v_exp_f32 v246, v246
    v_mfma_f32_16x16x32_bf16 v[252:255], a[240:243], v[140:143], v[156:159]
    buffer_load_dwordx4 v1, s[36:39], s100 offen sc1 lds
    v_mfma_f32_16x16x32_bf16 v[252:255], a[244:247], v[172:175], v[252:255]
    v_exp_f32 v247, v247
    v_mfma_f32_16x16x32_bf16 v[252:255], a[248:251], v[204:207], v[252:255]
    ds_read_b128 v[100:103], v2 offset:25600
    v_cvt_pk_bf16_f32 v89, v246, v247
    v_mfma_f32_16x16x32_bf16 v[252:255], a[252:255], v[236:239], v[252:255]
    s_waitcnt lgkmcnt(4)
    buffer_load_dwordx4 v1, s[36:39], s100 offen offset:1024 sc1 lds
    v_mfma_f32_16x16x32_bf16 a[56:59], v[120:123], v[48:51], a[56:59]
    v_exp_f32 v248, v248
    v_mfma_f32_16x16x32_bf16 a[56:59], v[124:127], v[52:55], a[56:59]
    v_exp_f32 v249, v249
    v_mfma_f32_16x16x32_bf16 a[60:63], v[120:123], v[56:59], a[60:63]
    ds_read_b128 v[104:107], v2 offset:26624
    ds_read_b128 v[108:111], v2 offset:27648
    v_mfma_f32_16x16x32_bf16 a[60:63], v[124:127], v[60:63], a[60:63]
    v_exp_f32 v250, v250
    v_mfma_f32_16x16x32_bf16 v[240:243], a[224:227], v[136:139], v[184:187]
    buffer_load_dwordx4 v1, s[36:39], s100 offen offset:2048 sc1 lds
    v_mfma_f32_16x16x32_bf16 v[240:243], a[228:231], v[168:171], v[240:243]
    s_waitcnt lgkmcnt(2)
    v_exp_f32 v251, v251
    v_mfma_f32_16x16x32_bf16 v[240:243], a[232:235], v[200:203], v[240:243]
    ds_read_b128 a[240:243], v2 offset:12288
    ds_read_b128 a[244:247], v2 offset:13312
    v_mfma_f32_16x16x32_bf16 v[240:243], a[236:239], v[232:235], v[240:243]
    ds_read_b128 a[248:251], v2 offset:14336
    v_cvt_pk_bf16_f32 v82, v248, v249
    v_mfma_f32_16x16x32_bf16 a[152:155], v[96:99], v[48:51], a[152:155]
    buffer_load_dwordx4 v1, s[36:39], s100 offen offset:3072 sc1 lds
    v_mfma_f32_16x16x32_bf16 a[152:155], v[100:103], v[52:55], a[152:155]
    ds_read_b128 a[252:255], v2 offset:15360
    v_cvt_pk_bf16_f32 v83, v250, v251
    v_mfma_f32_16x16x32_bf16 a[156:159], v[96:99], v[56:59], a[156:159]
    ds_read_b128 v[112:115], v2 offset:28672
    ds_read_b128 v[116:119], v2 offset:29696
    v_mfma_f32_16x16x32_bf16 a[156:159], v[100:103], v[60:63], a[156:159]
    v_exp_f32 v252, v252
    v_mfma_f32_16x16x32_bf16 v[244:247], a[224:227], v[140:143], v[156:159]
    s_add_u32 s77, s77, 32768
    v_exp_f32 v253, v253
    v_mfma_f32_16x16x32_bf16 v[244:247], a[228:231], v[172:175], v[244:247]
    v_exp_f32 v254, v254
    v_mfma_f32_16x16x32_bf16 v[244:247], a[232:235], v[204:207], v[244:247]
    v_exp_f32 v255, v255
    v_mfma_f32_16x16x32_bf16 v[244:247], a[236:239], v[236:239], v[244:247]
    s_waitcnt lgkmcnt(3)
    v_cvt_pk_bf16_f32 v90, v252, v253
    v_cvt_pk_bf16_f32 v91, v254, v255
    v_mfma_f32_16x16x32_bf16 a[168:171], v[104:107], v[48:51], a[168:171]
    v_exp_f32 v240, v240
    v_mfma_f32_16x16x32_bf16 a[168:171], v[108:111], v[52:55], a[168:171]
    v_exp_f32 v241, v241
    v_mfma_f32_16x16x32_bf16 a[172:175], v[104:107], v[56:59], a[172:175]
    ds_read_b128 v[120:123], v2 offset:30720
    ds_read_b128 v[124:127], v2 offset:31744
    v_mfma_f32_16x16x32_bf16 a[172:175], v[108:111], v[60:63], a[172:175]
    v_add_u32 v2, s82, v1
    v_cvt_pk_bf16_f32 v84, v240, v241
    v_mfma_f32_16x16x32_bf16 v[248:251], a[240:243], v[136:139], v[188:191]
    v_exp_f32 v242, v242
    v_mfma_f32_16x16x32_bf16 v[248:251], a[244:247], v[168:171], v[248:251]
    v_exp_f32 v243, v243
    v_mfma_f32_16x16x32_bf16 v[248:251], a[248:251], v[200:203], v[248:251]
    s_waitcnt lgkmcnt(2)
    v_exp_f32 v244, v244
    v_mfma_f32_16x16x32_bf16 v[248:251], a[252:255], v[232:235], v[248:251]
    v_exp_f32 v245, v245
    v_mfma_f32_16x16x32_bf16 a[184:187], v[112:115], v[48:51], a[184:187]
    ds_read_b128 a[224:227], v2 offset:0
    ds_read_b128 a[228:231], v2 offset:1024
    v_mfma_f32_16x16x32_bf16 a[184:187], v[116:119], v[52:55], a[184:187]
    ds_read_b128 a[232:235], v2 offset:2048
    v_cvt_pk_bf16_f32 v85, v242, v243
    v_mfma_f32_16x16x32_bf16 a[188:191], v[112:115], v[56:59], a[188:191]
    ds_read_b128 a[236:239], v2 offset:3072
    v_cvt_pk_bf16_f32 v92, v244, v245
    v_mfma_f32_16x16x32_bf16 a[188:191], v[116:119], v[60:63], a[188:191]
    v_exp_f32 v246, v246
    v_mfma_f32_16x16x32_bf16 v[252:255], a[240:243], v[140:143], v[156:159]
    ds_read_b128 v[96:99], v2 offset:16384
    ds_read_b128 v[100:103], v2 offset:17408
    v_mfma_f32_16x16x32_bf16 v[252:255], a[244:247], v[172:175], v[252:255]
    v_exp_f32 v247, v247
    v_mfma_f32_16x16x32_bf16 v[252:255], a[248:251], v[204:207], v[252:255]
    v_exp_f32 v248, v248
    v_mfma_f32_16x16x32_bf16 v[252:255], a[252:255], v[236:239], v[252:255]
    s_waitcnt lgkmcnt(4)
    v_exp_f32 v249, v249
    v_mfma_f32_16x16x32_bf16 a[200:203], v[120:123], v[48:51], a[200:203]
    v_exp_f32 v250, v250
    v_mfma_f32_16x16x32_bf16 a[200:203], v[124:127], v[52:55], a[200:203]
    v_exp_f32 v251, v251
    v_mfma_f32_16x16x32_bf16 a[204:207], v[120:123], v[56:59], a[204:207]
    v_cvt_pk_bf16_f32 v93, v246, v247
    v_cvt_pk_bf16_f32 v86, v248, v249
    v_mfma_f32_16x16x32_bf16 a[204:207], v[124:127], v[60:63], a[204:207]
    v_exp_f32 v252, v252
    v_smfmac_f32_16x16x64_bf16 a[216:219], a[136:139], v[48:55], v215
    s_cmp_le_u32 s78, 2
    v_cvt_pk_bf16_f32 v87, v250, v251
    v_smfmac_f32_16x16x64_bf16 a[220:223], a[136:139], v[56:63], v215
    s_cbranch_scc1 K1_LS_MASK
K1_LS_BACK:
    s_waitcnt lgkmcnt(0)
    v_mfma_f32_16x16x32_bf16 v[240:243], a[224:227], v[136:139], v[176:179]
    s_mov_b32 s99, s76
    ds_read_b128 v[104:107], v2 offset:18432
    ds_read_b128 v[108:111], v2 offset:19456
    v_mfma_f32_16x16x32_bf16 v[240:243], a[228:231], v[168:171], v[240:243]
    v_exp_f32 v253, v253
    v_mfma_f32_16x16x32_bf16 v[240:243], a[232:235], v[200:203], v[240:243]
    v_exp_f32 v254, v254
    v_mfma_f32_16x16x32_bf16 v[240:243], a[236:239], v[232:235], v[240:243]
    v_exp_f32 v255, v255
    v_mfma_f32_16x16x32_bf16 a[8:11], v[96:99], v[80:83], a[8:11]
    s_add_u32 m0, s76, s75
    v_cvt_pk_bf16_f32 v94, v252, v253
    v_cvt_pk_bf16_f32 v95, v254, v255
    v_mfma_f32_16x16x32_bf16 a[8:11], v[100:103], v[84:87], a[8:11]
    s_mov_b32 s76, s60
    ds_read_b128 a[240:243], v2 offset:4096
    ds_read_b128 a[244:247], v2 offset:5120
    v_mfma_f32_16x16x32_bf16 a[12:15], v[96:99], v[88:91], a[12:15]
    s_mov_b32 s60, s82
    buffer_load_dwordx4 v1, s[36:39], s77 offen sc1 lds
    v_mfma_f32_16x16x32_bf16 a[12:15], v[100:103], v[92:95], a[12:15]
    s_mov_b32 s82, s95
    ds_read_b128 a[248:251], v2 offset:6144
    ds_read_b128 a[252:255], v2 offset:7168
    v_mfma_f32_16x16x32_bf16 v[244:247], a[224:227], v[140:143], v[156:159]
    s_mov_b32 s95, s93
    v_exp_f32 v240, v240
    v_mfma_f32_16x16x32_bf16 v[244:247], a[228:231], v[172:175], v[244:247]
    s_mov_b32 s93, s99
    ds_read_b128 v[112:115], v2 offset:20480
    ds_read_b128 v[116:119], v2 offset:21504
    v_mfma_f32_16x16x32_bf16 v[244:247], a[232:235], v[204:207], v[244:247]
    buffer_load_dwordx4 v1, s[36:39], s77 offen offset:1024 sc1 lds
    v_mfma_f32_16x16x32_bf16 v[244:247], a[236:239], v[236:239], v[244:247]
    s_waitcnt lgkmcnt(6)
    v_exp_f32 v241, v241
    v_mfma_f32_16x16x32_bf16 a[24:27], v[104:107], v[80:83], a[24:27]
    v_exp_f32 v242, v242
    v_mfma_f32_16x16x32_bf16 a[24:27], v[108:111], v[84:87], a[24:27]
    v_exp_f32 v243, v243
    v_mfma_f32_16x16x32_bf16 a[28:31], v[104:107], v[88:91], a[28:31]
    buffer_load_dwordx4 v1, s[36:39], s77 offen offset:2048 sc1 lds
    v_mfma_f32_16x16x32_bf16 a[28:31], v[108:111], v[92:95], a[28:31]
    s_waitcnt lgkmcnt(2)
    ds_read_b128 v[120:123], v2 offset:22528
    ds_read_b128 v[124:127], v2 offset:23552
    v_mfma_f32_16x16x32_bf16 v[248:251], a[240:243], v[136:139], v[180:183]
    v_cvt_pk_bf16_f32 v48, v240, v241
    v_cvt_pk_bf16_f32 v49, v242, v243
    v_mfma_f32_16x16x32_bf16 v[248:251], a[244:247], v[168:171], v[248:251]
    v_exp_f32 v244, v244
    v_mfma_f32_16x16x32_bf16 v[248:251], a[248:251], v[200:203], v[248:251]
    buffer_load_dwordx4 v1, s[36:39], s77 offen offset:3072 sc1 lds
    v_mfma_f32_16x16x32_bf16 v[248:251], a[252:255], v[232:235], v[248:251]
    s_waitcnt lgkmcnt(2)
    ds_read_b128 a[224:227], v2 offset:8192
    ds_read_b128 a[228:231], v2 offset:9216
    v_mfma_f32_16x16x32_bf16 a[40:43], v[112:115], v[80:83], a[40:43]
    v_exp_f32 v245, v245
    v_mfma_f32_16x16x32_bf16 a[40:43], v[116:119], v[84:87], a[40:43]
    ds_read_b128 a[232:235], v2 offset:10240
    ds_read_b128 a[236:239], v2 offset:11264
    v_mfma_f32_16x16x32_bf16 a[44:47], v[112:115], v[88:91], a[44:47]
    s_add_u32 s100, s77, 4096
    ds_read_b128 v[96:99], v2 offset:24576
    v_cvt_pk_bf16_f32 v56, v244, v245
    v_mfma_f32_16x16x32_bf16 a[44:47], v[116:119], v[92:95], a[44:47]
    s_add_u32 m0, m0, 4096
    v_exp_f32 v246, v246
    v_mfma_f32_16x16x32_bf16 v[252:255], a[240:243], v[140:143], v[156:159]
    buffer_load_dwordx4 v1, s[36:39], s100 offen sc1 lds
    v_mfma_f32_16x16x32_bf16 v[252:255], a[244:247], v[172:175], v[252:255]
    v_exp_f32 v247, v247
    v_mfma_f32_16x16x32_bf16 v[252:255], a[248:251], v[204:207], v[252:255]
    ds_read_b128 v[100:103], v2 offset:25600
    v_cvt_pk_bf16_f32 v57, v246, v247
    v_mfma_f32_16x16x32_bf16 v[252:255], a[252:255], v[236:239], v[252:255]
    s_waitcnt lgkmcnt(4)
    buffer_load_dwordx4 v1, s[36:39], s100 offen offset:1024 sc1 lds
    v_mfma_f32_16x16x32_bf16 a[56:59], v[120:123], v[80:83], a[56:59]
    v_exp_f32 v248, v248
    v_mfma_f32_16x16x32_bf16 a[56:59], v[124:127], v[84:87], a[56:59]
    v_exp_f32 v249, v249
    v_mfma_f32_16x16x32_bf16 a[60:63], v[120:123], v[88:91], a[60:63]
    ds_read_b128 v[104:107], v2 offset:26624
    ds_read_b128 v[108:111], v2 offset:27648
    v_mfma_f32_16x16x32_bf16 a[60:63], v[124:127], v[92:95], a[60:63]
    v_exp_f32 v250, v250
    v_mfma_f32_16x16x32_bf16 v[240:243], a[224:227], v[136:139], v[184:187]
    buffer_load_dwordx4 v1, s[36:39], s100 offen offset:2048 sc1 lds
    v_mfma_f32_16x16x32_bf16 v[240:243], a[228:231], v[168:171], v[240:243]
    s_waitcnt lgkmcnt(2)
    v_exp_f32 v251, v251
    v_mfma_f32_16x16x32_bf16 v[240:243], a[232:235], v[200:203], v[240:243]
    ds_read_b128 a[240:243], v2 offset:12288
    ds_read_b128 a[244:247], v2 offset:13312
    v_mfma_f32_16x16x32_bf16 v[240:243], a[236:239], v[232:235], v[240:243]
    ds_read_b128 a[248:251], v2 offset:14336
    v_cvt_pk_bf16_f32 v50, v248, v249
    v_mfma_f32_16x16x32_bf16 a[152:155], v[96:99], v[80:83], a[152:155]
    buffer_load_dwordx4 v1, s[36:39], s100 offen offset:3072 sc1 lds
    v_mfma_f32_16x16x32_bf16 a[152:155], v[100:103], v[84:87], a[152:155]
    ds_read_b128 a[252:255], v2 offset:15360
    v_cvt_pk_bf16_f32 v51, v250, v251
    v_mfma_f32_16x16x32_bf16 a[156:159], v[96:99], v[88:91], a[156:159]
    ds_read_b128 v[112:115], v2 offset:28672
    ds_read_b128 v[116:119], v2 offset:29696
    v_mfma_f32_16x16x32_bf16 a[156:159], v[100:103], v[92:95], a[156:159]
    v_exp_f32 v252, v252
    v_mfma_f32_16x16x32_bf16 v[244:247], a[224:227], v[140:143], v[156:159]
    s_add_u32 s77, s77, 32768
    v_exp_f32 v253, v253
    v_mfma_f32_16x16x32_bf16 v[244:247], a[228:231], v[172:175], v[244:247]
    ds_read_b128 v[120:123], v2 offset:30720
    ds_read_b128 v[124:127], v2 offset:31744
    v_mfma_f32_16x16x32_bf16 v[244:247], a[232:235], v[204:207], v[244:247]
    v_add_u32 v2, s82, v1
    v_cvt_pk_bf16_f32 v58, v252, v253
    v_mfma_f32_16x16x32_bf16 v[244:247], a[236:239], v[236:239], v[244:247]
    s_waitcnt lgkmcnt(5)
    v_exp_f32 v254, v254
    v_mfma_f32_16x16x32_bf16 a[168:171], v[104:107], v[80:83], a[168:171]
    v_exp_f32 v255, v255
    v_mfma_f32_16x16x32_bf16 a[168:171], v[108:111], v[84:87], a[168:171]
    v_exp_f32 v240, v240
    v_mfma_f32_16x16x32_bf16 a[172:175], v[104:107], v[88:91], a[172:175]
    v_exp_f32 v241, v241
    v_mfma_f32_16x16x32_bf16 a[172:175], v[108:111], v[92:95], a[172:175]
    v_cvt_pk_bf16_f32 v59, v254, v255
    v_cvt_pk_bf16_f32 v52, v240, v241
    v_mfma_f32_16x16x32_bf16 v[248:251], a[240:243], v[136:139], v[188:191]
    v_exp_f32 v242, v242
    v_mfma_f32_16x16x32_bf16 v[248:251], a[244:247], v[168:171], v[248:251]
    v_exp_f32 v243, v243
    v_mfma_f32_16x16x32_bf16 v[248:251], a[248:251], v[200:203], v[248:251]
    s_waitcnt lgkmcnt(0)
    v_exp_f32 v244, v244
    v_mfma_f32_16x16x32_bf16 v[248:251], a[252:255], v[232:235], v[248:251]
    v_exp_f32 v245, v245
    v_mfma_f32_16x16x32_bf16 a[184:187], v[112:115], v[80:83], a[184:187]
    s_waitcnt vmcnt(8) lgkmcnt(0)
    v_exp_f32 v246, v246
    v_mfma_f32_16x16x32_bf16 a[184:187], v[116:119], v[84:87], a[184:187]
    s_barrier
    ds_read_b128 a[224:227], v2 offset:0
    ds_read_b128 a[228:231], v2 offset:1024
    v_mfma_f32_16x16x32_bf16 a[188:191], v[112:115], v[88:91], a[188:191]
    ds_read_b128 a[232:235], v2 offset:2048
    v_cvt_pk_bf16_f32 v53, v242, v243
    v_mfma_f32_16x16x32_bf16 a[188:191], v[116:119], v[92:95], a[188:191]
    ds_read_b128 a[236:239], v2 offset:3072
    v_cvt_pk_bf16_f32 v60, v244, v245
    v_mfma_f32_16x16x32_bf16 v[252:255], a[240:243], v[140:143], v[156:159]
    v_exp_f32 v247, v247
    v_mfma_f32_16x16x32_bf16 v[252:255], a[244:247], v[172:175], v[252:255]
    ds_read_b128 v[96:99], v2 offset:16384
    ds_read_b128 v[100:103], v2 offset:17408
    v_mfma_f32_16x16x32_bf16 v[252:255], a[248:251], v[204:207], v[252:255]
    v_exp_f32 v248, v248
    v_mfma_f32_16x16x32_bf16 v[252:255], a[252:255], v[236:239], v[252:255]
    v_exp_f32 v249, v249
    v_mfma_f32_16x16x32_bf16 a[200:203], v[120:123], v[80:83], a[200:203]
    v_exp_f32 v250, v250
    v_mfma_f32_16x16x32_bf16 a[200:203], v[124:127], v[84:87], a[200:203]
    v_exp_f32 v251, v251
    v_mfma_f32_16x16x32_bf16 a[204:207], v[120:123], v[88:91], a[204:207]
    v_cvt_pk_bf16_f32 v61, v246, v247
    v_cvt_pk_bf16_f32 v54, v248, v249
    v_mfma_f32_16x16x32_bf16 a[204:207], v[124:127], v[92:95], a[204:207]
    s_sub_u32 s78, s78, 1
    v_exp_f32 v252, v252
    v_smfmac_f32_16x16x64_bf16 a[216:219], a[136:139], v[80:87], v215
    s_cmp_lg_u32 s78, 0
    v_cvt_pk_bf16_f32 v55, v250, v251
    v_smfmac_f32_16x16x64_bf16 a[220:223], a[136:139], v[88:95], v215
    s_cbranch_scc1 K1_LS
K1_LS_END:
    v_add_f32 v212, s12, v156
    v_fma_f32 v176, v208, s8, v212
    v_fma_f32 v177, v209, s8, v212
    v_fma_f32 v178, v210, s8, v212
    v_fma_f32 v179, v211, s8, v212
    s_nop 1
    s_waitcnt lgkmcnt(0)
    v_mfma_f32_16x16x32_bf16 v[240:243], a[224:227], v[140:143], v[176:179]
    s_xor_b32 s21, s3, 1
    ds_read_b128 v[104:107], v2 offset:18432
    s_lshl2_add_u32 s21, s21, s4
    v_mfma_f32_16x16x32_bf16 v[240:243], a[228:231], v[172:175], v[240:243]
    s_mul_i32 s21, s21, 36864
    ds_read_b128 v[108:111], v2 offset:19456
    ds_read_b128 a[240:243], v2 offset:4096
    v_mfma_f32_16x16x32_bf16 v[240:243], a[232:235], v[204:207], v[240:243]
    s_add_u32 s21, s21, s28
    s_mov_b32 m0, s45
    ds_read_b128 a[244:247], v2 offset:5120
    v_mfma_f32_16x16x32_bf16 v[240:243], a[236:239], v[236:239], v[240:243]
    s_mul_i32 s86, s4, 34
    buffer_load_dwordx4 v1, s[56:59], s21 offen sc1 lds
    v_mfma_f32_16x16x32_bf16 a[8:11], v[96:99], v[48:51], a[8:11]
    s_add_u32 s86, s86, 8
    v_exp_f32 v253, v253
    v_mfma_f32_16x16x32_bf16 a[8:11], v[100:103], v[52:55], a[8:11]
    s_mov_b32 s99, s76
    v_exp_f32 v254, v254
    v_mfma_f32_16x16x32_bf16 a[12:15], v[96:99], v[56:59], a[12:15]
    s_mov_b32 s76, s60
    v_exp_f32 v255, v255
    v_cvt_pk_bf16_f32 v62, v252, v253
    v_cvt_pk_bf16_f32 v63, v254, v255
    s_nop 1
    v_mfma_f32_16x16x32_bf16 a[12:15], v[100:103], v[60:63], a[12:15]
    s_mov_b32 s60, s82
    ds_read_b128 a[248:251], v2 offset:6144
    ds_read_b128 a[252:255], v2 offset:7168
    s_waitcnt lgkmcnt(2)
    v_mfma_f32_16x16x32_bf16 a[24:27], v[104:107], v[48:51], a[24:27]
    s_mov_b32 s82, s95
    v_lshrrev_b32 v28, 4, v1
    ds_read_b128 v[112:115], v2 offset:20480
    v_mfma_f32_16x16x32_bf16 a[24:27], v[108:111], v[52:55], a[24:27]
    s_mov_b32 s95, s93
    v_min_u32 v28, 33, v28
    ds_read_b128 v[116:119], v2 offset:21504
    v_mfma_f32_16x16x32_bf16 a[28:31], v[104:107], v[56:59], a[28:31]
    s_mov_b32 s93, s99
    buffer_load_dwordx4 v1, s[56:59], s21 offen offset:1024 sc1 lds
    v_mfma_f32_16x16x32_bf16 a[28:31], v[108:111], v[60:63], a[28:31]
    s_and_b32 s62, s5, 4
    v_add_lshl_u32 v28, v28, s86, 7
    v_add_f32 v213, s13, v156
    v_fma_f32 v180, v208, s9, v213
    v_fma_f32 v181, v209, s9, v213
    v_fma_f32 v182, v210, s9, v213
    v_fma_f32 v183, v211, s9, v213
    s_nop 1
    v_mfma_f32_16x16x32_bf16 v[244:247], a[240:243], v[140:143], v[180:183]
    s_getpc_b64 s[86:87]
    global_load_dword v28, v28, s[86:87]
    v_mfma_f32_16x16x32_bf16 v[244:247], a[244:247], v[172:175], v[244:247]
    s_lshl_b32 s63, s3, 12
    ds_read_b128 v[120:123], v2 offset:22528
    ds_read_b128 v[124:127], v2 offset:23552
    s_waitcnt lgkmcnt(3)
    v_mfma_f32_16x16x32_bf16 v[244:247], a[248:251], v[204:207], v[244:247]
    s_sub_u32 s19, s74, s101
    buffer_load_dwordx4 v1, s[56:59], s21 offen offset:2048 sc1 lds
    v_mfma_f32_16x16x32_bf16 v[244:247], a[252:255], v[236:239], v[244:247]
    s_add_u32 s62, s62, s4
    ds_read_b128 a[224:227], v2 offset:8192
    ds_read_b128 a[228:231], v2 offset:9216
    v_mfma_f32_16x16x32_bf16 a[40:43], v[112:115], v[48:51], a[40:43]
    s_mov_b32 s20, s63
    ds_read_b128 a[232:235], v2 offset:10240
    v_add_f32 v212, s14, v156
    s_waitcnt lgkmcnt(5)
    v_mfma_f32_16x16x32_bf16 a[40:43], v[116:119], v[52:55], a[40:43]
    s_add_u32 s19, s66, s19
    ds_read_b128 a[236:239], v2 offset:11264
    v_fma_f32 v184, v208, s10, v212
    v_mfma_f32_16x16x32_bf16 a[44:47], v[112:115], v[56:59], a[44:47]
    s_mov_b32 s50, 9437184
    ds_read_b128 v[96:99], v2 offset:24576
    v_fma_f32 v185, v209, s10, v212
    v_mfma_f32_16x16x32_bf16 a[44:47], v[116:119], v[60:63], a[44:47]
    s_waitcnt lgkmcnt(5)
    ds_read_b128 v[100:103], v2 offset:25600
    v_fma_f32 v186, v210, s10, v212
    v_mfma_f32_16x16x32_bf16 a[56:59], v[120:123], v[48:51], a[56:59]
    buffer_load_dwordx4 v1, s[56:59], s21 offen offset:3072 sc1 lds
    v_mfma_f32_16x16x32_bf16 a[56:59], v[124:127], v[52:55], a[56:59]
    s_add_u32 s21, s21, 4096
    v_fma_f32 v187, v211, s10, v212
    ds_read_b128 v[104:107], v2 offset:26624
    v_mfma_f32_16x16x32_bf16 a[60:63], v[120:123], v[56:59], a[60:63]
    s_add_u32 m0, s45, 4096
    ds_read_b128 v[108:111], v2 offset:27648
    ds_read_b128 a[240:243], v2 offset:12288
    v_mfma_f32_16x16x32_bf16 a[60:63], v[124:127], v[60:63], a[60:63]
    s_waitcnt lgkmcnt(4)
    ds_read_b128 a[244:247], v2 offset:13312
    v_add_f32 v213, s15, v156
    v_mfma_f32_16x16x32_bf16 v[248:251], a[224:227], v[140:143], v[184:187]
    ds_read_b128 a[248:251], v2 offset:14336
    v_fma_f32 v188, v208, s11, v213
    v_mfma_f32_16x16x32_bf16 v[248:251], a[228:231], v[172:175], v[248:251]
    ds_read_b128 a[252:255], v2 offset:15360
    v_fma_f32 v189, v209, s11, v213
    v_mfma_f32_16x16x32_bf16 v[248:251], a[232:235], v[204:207], v[248:251]
    buffer_load_dwordx4 v1, s[56:59], s21 offen sc1 lds
    v_mfma_f32_16x16x32_bf16 v[248:251], a[236:239], v[236:239], v[248:251]
    ds_read_b128 v[112:115], v2 offset:28672
    ds_read_b128 v[116:119], v2 offset:29696
    v_mfma_f32_16x16x32_bf16 a[152:155], v[96:99], v[48:51], a[152:155]
    s_waitcnt lgkmcnt(4)
    v_fma_f32 v190, v210, s11, v213
    v_fma_f32 v191, v211, s11, v213
    v_mfma_f32_16x16x32_bf16 a[152:155], v[100:103], v[52:55], a[152:155]
    ds_read_b128 v[120:123], v2 offset:30720
    ds_read_b128 v[124:127], v2 offset:31744
    v_mfma_f32_16x16x32_bf16 a[156:159], v[96:99], v[56:59], a[156:159]
    v_add_u32 v2, s82, v1
    ds_read_b128 v[96:99], v2 offset:16384
    v_mfma_f32_16x16x32_bf16 a[156:159], v[100:103], v[60:63], a[156:159]
    ds_read_b128 v[100:103], v2 offset:17408
    v_bfe_u32 v217, v1, 4, 3
    v_mfma_f32_16x16x32_bf16 a[168:171], v[104:107], v[48:51], a[168:171]
    buffer_load_dwordx4 v1, s[56:59], s21 offen offset:1024 sc1 lds
    v_mfma_f32_16x16x32_bf16 a[168:171], v[108:111], v[52:55], a[168:171]
    v_exp_f32 v240, v240
    v_mfma_f32_16x16x32_bf16 a[172:175], v[104:107], v[56:59], a[172:175]
    ds_read_b128 v[104:107], v2 offset:18432
    v_lshlrev_b32 v217, 7, v217
    v_mfma_f32_16x16x32_bf16 a[172:175], v[108:111], v[60:63], a[172:175]
    v_exp_f32 v241, v241
    v_mfma_f32_16x16x32_bf16 v[252:255], a[240:243], v[140:143], v[188:191]
    ds_read_b128 v[108:111], v2 offset:19456
    v_cvt_pk_bf16_f32 v88, v240, v241
    v_mfma_f32_16x16x32_bf16 v[252:255], a[244:247], v[172:175], v[252:255]
    s_waitcnt lgkmcnt(2)
    v_exp_f32 v242, v242
    v_mfma_f32_16x16x32_bf16 v[252:255], a[248:251], v[204:207], v[252:255]
    buffer_load_dwordx4 v1, s[56:59], s21 offen offset:2048 sc1 lds
    v_mfma_f32_16x16x32_bf16 v[252:255], a[252:255], v[236:239], v[252:255]
    v_exp_f32 v243, v243
    v_mfma_f32_16x16x32_bf16 a[184:187], v[112:115], v[48:51], a[184:187]
    v_exp_f32 v244, v244
    v_mfma_f32_16x16x32_bf16 a[184:187], v[116:119], v[52:55], a[184:187]
    v_exp_f32 v245, v245
    v_mfma_f32_16x16x32_bf16 a[188:191], v[112:115], v[56:59], a[188:191]
    ds_read_b128 v[112:115], v2 offset:20480
    v_cvt_pk_bf16_f32 v89, v242, v243
    v_mfma_f32_16x16x32_bf16 a[188:191], v[116:119], v[60:63], a[188:191]
    v_exp_f32 v246, v246
    v_mfma_f32_16x16x32_bf16 a[200:203], v[120:123], v[48:51], a[200:203]
    v_exp_f32 v247, v247
    v_mfma_f32_16x16x32_bf16 a[200:203], v[124:127], v[52:55], a[200:203]
    v_exp_f32 v248, v248
    v_mfma_f32_16x16x32_bf16 a[204:207], v[120:123], v[56:59], a[204:207]
    v_exp_f32 v249, v249
    v_mfma_f32_16x16x32_bf16 a[204:207], v[124:127], v[60:63], a[204:207]
    v_exp_f32 v250, v250
    v_smfmac_f32_16x16x64_bf16 a[216:219], a[136:139], v[48:55], v215
    s_add_u32 s48, s32, 1048576
    s_addc_u32 s49, s33, 0
    ds_read_b128 v[116:119], v2 offset:21504
    v_smfmac_f32_16x16x64_bf16 a[220:223], a[136:139], v[56:63], v215
    v_exp_f32 v251, v251
    v_cvt_pk_bf16_f32 v90, v244, v245
    v_cvt_pk_bf16_f32 v91, v246, v247
    v_cvt_pk_bf16_f32 v92, v248, v249
    v_cvt_pk_bf16_f32 v93, v250, v251
    v_exp_f32 v252, v252
    s_cmp_eq_u32 s6, 7
    s_cbranch_scc1 K1_S7
K1_S7_BACK:
    s_waitcnt lgkmcnt(0)
    v_mfma_f32_16x16x32_bf16 a[12:15], v[96:99], v[88:91], a[12:15]
    ds_read_b128 v[120:123], v2 offset:22528
    v_exp_f32 v253, v253
    v_exp_f32 v254, v254
    v_exp_f32 v255, v255
    v_cvt_pk_bf16_f32 v94, v252, v253
    v_cvt_pk_bf16_f32 v95, v254, v255
    s_nop 1
    v_mfma_f32_16x16x32_bf16 a[12:15], v[100:103], v[92:95], a[12:15]
    ds_read_b128 v[124:127], v2 offset:23552
    ds_read_b128 v[96:99], v2 offset:24576
    v_accvgpr_read_b32 v12, a8
    v_accvgpr_read_b32 v13, a9
    v_accvgpr_read_b32 v14, a10
    v_mfma_f32_16x16x32_bf16 a[28:31], v[104:107], v[88:91], a[28:31]
    ds_read_b128 v[100:103], v2 offset:25600
    v_accvgpr_read_b32 v9, a216
    v_accvgpr_read_b32 v10, a217
    v_add_f32 v9, v9, v10
    v_accvgpr_read_b32 v15, a11
    v_mfma_f32_16x16x32_bf16 a[28:31], v[108:111], v[92:95], a[28:31]
    ds_read_b128 v[104:107], v2 offset:26624
    v_rcp_f32 v10, v9
    v_accvgpr_read_b32 v16, a24
    v_mul_f32 v10, v10, v6
    v_mfma_f32_16x16x32_bf16 a[44:47], v[112:115], v[88:91], a[44:47]
    ds_read_b128 v[108:111], v2 offset:27648
    v_accvgpr_read_b32 v17, a25
    v_accvgpr_read_b32 v18, a26
    v_accvgpr_read_b32 v19, a27
    v_accvgpr_read_b32 v20, a40
    v_mfma_f32_16x16x32_bf16 a[44:47], v[116:119], v[92:95], a[44:47]
    s_waitcnt lgkmcnt(5)
    ds_read_b128 v[112:115], v2 offset:28672
    v_accvgpr_read_b32 v21, a41
    v_accvgpr_read_b32 v22, a42
    v_accvgpr_read_b32 v23, a43
    v_accvgpr_read_b32 v24, a56
    v_mfma_f32_16x16x32_bf16 a[60:63], v[120:123], v[88:91], a[60:63]
    s_waitcnt lgkmcnt(3)
    ds_read_b128 v[116:119], v2 offset:29696
    v_accvgpr_read_b32 v25, a57
    v_accvgpr_read_b32 v26, a58
    v_accvgpr_read_b32 v27, a59
    v_mul_f32 v12, v10, v12
    v_mfma_f32_16x16x32_bf16 a[60:63], v[124:127], v[92:95], a[60:63]
    ds_read_b128 v[120:123], v2 offset:30720
    v_mul_f32 v13, v10, v13
    v_mul_f32 v14, v10, v14
    v_mul_f32 v15, v10, v15
    v_mul_f32 v16, v10, v16
    v_mfma_f32_16x16x32_bf16 a[156:159], v[96:99], v[88:91], a[156:159]
    ds_read_b128 v[124:127], v2 offset:31744
    v_mul_f32 v17, v10, v17
    v_mul_f32 v18, v10, v18
    v_mul_f32 v19, v10, v19
    v_mul_f32 v20, v10, v20
    v_mfma_f32_16x16x32_bf16 a[156:159], v[100:103], v[92:95], a[156:159]
    s_waitcnt lgkmcnt(3)
    v_mul_f32 v21, v10, v21
    v_mul_f32 v22, v10, v22
    v_mul_f32 v23, v10, v23
    v_mul_f32 v24, v10, v24
    v_mul_f32 v25, v10, v25
    v_mfma_f32_16x16x32_bf16 a[172:175], v[104:107], v[88:91], a[172:175]
    v_mul_f32 v26, v10, v26
    v_mul_f32 v27, v10, v27
    v_cvt_pk_bf16_f32 v12, v12, v13
    v_cvt_pk_bf16_f32 v13, v14, v15
    v_cvt_pk_bf16_f32 v14, v16, v17
    v_mfma_f32_16x16x32_bf16 a[172:175], v[108:111], v[92:95], a[172:175]
    v_cvt_pk_bf16_f32 v15, v18, v19
    v_cvt_pk_bf16_f32 v20, v20, v21
    v_cvt_pk_bf16_f32 v21, v22, v23
    v_cvt_pk_bf16_f32 v22, v24, v25
    v_cvt_pk_bf16_f32 v23, v26, v27
    v_mfma_f32_16x16x32_bf16 a[188:191], v[112:115], v[88:91], a[188:191]
    s_waitcnt lgkmcnt(1)
    buffer_store_dwordx4 v[12:15], v1, s[40:43], s81 offen offset:0 sc1
    buffer_store_dwordx4 v[20:23], v1, s[40:43], s81 offen offset:1024 sc1
    v_accvgpr_read_b32 v16, a168
    v_mfma_f32_16x16x32_bf16 a[188:191], v[116:119], v[92:95], a[188:191]
    v_accvgpr_read_b32 v12, a152
    v_accvgpr_read_b32 v13, a153
    v_accvgpr_read_b32 v14, a154
    v_accvgpr_read_b32 v15, a155
    v_accvgpr_read_b32 v17, a169
    v_mfma_f32_16x16x32_bf16 a[204:207], v[120:123], v[88:91], a[204:207]
    s_waitcnt lgkmcnt(0)
    v_accvgpr_read_b32 v18, a170
    v_accvgpr_read_b32 v19, a171
    v_accvgpr_read_b32 v20, a184
    v_accvgpr_read_b32 v21, a185
    v_accvgpr_read_b32 v22, a186
    v_mfma_f32_16x16x32_bf16 a[204:207], v[124:127], v[92:95], a[204:207]
    v_accvgpr_read_b32 v23, a187
    v_accvgpr_read_b32 v24, a200
    v_accvgpr_read_b32 v25, a201
    v_accvgpr_read_b32 v26, a202
    v_accvgpr_read_b32 v27, a203
    v_smfmac_f32_16x16x64_bf16 a[220:223], a[136:139], v[88:95], v215
    v_mul_f32 v12, v10, v12
    v_mul_f32 v13, v10, v13
    v_mul_f32 v14, v10, v14
    v_mul_f32 v15, v10, v15
    v_mul_f32 v16, v10, v16
    v_mul_f32 v17, v10, v17
    v_mul_f32 v18, v10, v18
    v_mul_f32 v19, v10, v19
    v_mul_f32 v20, v10, v20
    v_mul_f32 v21, v10, v21
    v_mul_f32 v22, v10, v22
    v_mul_f32 v23, v10, v23
    v_mul_f32 v24, v10, v24
    v_mul_f32 v25, v10, v25
    v_mul_f32 v26, v10, v26
    v_mul_f32 v27, v10, v27
    v_cmp_nge_f32 vcc, 0x5f800000, v9
    v_cvt_pk_bf16_f32 v12, v12, v13
    v_cvt_pk_bf16_f32 v13, v14, v15
    v_cvt_pk_bf16_f32 v14, v16, v17
    v_cvt_pk_bf16_f32 v15, v18, v19
    v_cvt_pk_bf16_f32 v20, v20, v21
    v_cvt_pk_bf16_f32 v21, v22, v23
    v_cvt_pk_bf16_f32 v22, v24, v25
    v_cvt_pk_bf16_f32 v23, v26, v27
    s_or_b64 s[84:85], s[84:85], vcc
    buffer_store_dwordx4 v[12:15], v1, s[40:43], s81 offen offset:2048 sc1
    buffer_store_dwordx4 v[20:23], v1, s[40:43], s81 offen offset:3072 sc1
    s_nop 3
    v_accvgpr_read_b32 v9, a220
    v_accvgpr_read_b32 v10, a221
    v_add_f32 v9, v9, v10
    v_cmp_nge_f32 vcc, 0x5f800000, v9
    v_rcp_f32 v10, v9
    s_nop 0
    s_or_b64 s[84:85], s[84:85], vcc
    v_mul_f32 v10, v10, v7
    s_add_u32 s72, s81, 622592
    v_accvgpr_read_b32 v12, a12
    v_accvgpr_read_b32 v13, a13
    v_accvgpr_read_b32 v14, a14
    v_accvgpr_read_b32 v15, a15
    v_accvgpr_read_b32 v16, a28
    v_accvgpr_read_b32 v17, a29
    v_accvgpr_read_b32 v18, a30
    v_accvgpr_read_b32 v19, a31
    v_pk_mul_f32 v[12:13], v[12:13], v[10:11] op_sel_hi:[1,0]
    v_pk_mul_f32 v[14:15], v[14:15], v[10:11] op_sel_hi:[1,0]
    v_pk_mul_f32 v[16:17], v[16:17], v[10:11] op_sel_hi:[1,0]
    v_pk_mul_f32 v[18:19], v[18:19], v[10:11] op_sel_hi:[1,0]
    v_cvt_pk_bf16_f32 v12, v12, v13
    v_cvt_pk_bf16_f32 v13, v14, v15
    v_cvt_pk_bf16_f32 v14, v16, v17
    v_cvt_pk_bf16_f32 v15, v18, v19
    buffer_store_dwordx4 v[12:15], v1, s[40:43], s72 offen offset:0 sc1
    v_accvgpr_read_b32 v20, a44
    v_accvgpr_read_b32 v21, a45
    v_accvgpr_read_b32 v22, a46
    v_accvgpr_read_b32 v23, a47
    v_accvgpr_read_b32 v24, a60
    v_accvgpr_read_b32 v25, a61
    v_accvgpr_read_b32 v26, a62
    v_accvgpr_read_b32 v27, a63
    v_pk_mul_f32 v[20:21], v[20:21], v[10:11] op_sel_hi:[1,0]
    v_pk_mul_f32 v[22:23], v[22:23], v[10:11] op_sel_hi:[1,0]
    v_pk_mul_f32 v[24:25], v[24:25], v[10:11] op_sel_hi:[1,0]
    v_pk_mul_f32 v[26:27], v[26:27], v[10:11] op_sel_hi:[1,0]
    v_cvt_pk_bf16_f32 v20, v20, v21
    v_cvt_pk_bf16_f32 v21, v22, v23
    v_cvt_pk_bf16_f32 v22, v24, v25
    v_cvt_pk_bf16_f32 v23, v26, v27
    buffer_store_dwordx4 v[20:23], v1, s[40:43], s72 offen offset:1024 sc1
    v_accvgpr_read_b32 v12, a156
    v_accvgpr_read_b32 v13, a157
    v_accvgpr_read_b32 v14, a158
    v_accvgpr_read_b32 v15, a159
    v_accvgpr_read_b32 v16, a172
    v_accvgpr_read_b32 v17, a173
    v_accvgpr_read_b32 v18, a174
    v_accvgpr_read_b32 v19, a175
    v_pk_mul_f32 v[12:13], v[12:13], v[10:11] op_sel_hi:[1,0]
    v_pk_mul_f32 v[14:15], v[14:15], v[10:11] op_sel_hi:[1,0]
    v_pk_mul_f32 v[16:17], v[16:17], v[10:11] op_sel_hi:[1,0]
    v_pk_mul_f32 v[18:19], v[18:19], v[10:11] op_sel_hi:[1,0]
    v_cvt_pk_bf16_f32 v12, v12, v13
    v_cvt_pk_bf16_f32 v13, v14, v15
    v_cvt_pk_bf16_f32 v14, v16, v17
    v_cvt_pk_bf16_f32 v15, v18, v19
    buffer_store_dwordx4 v[12:15], v1, s[40:43], s72 offen offset:2048 sc1
    v_accvgpr_read_b32 v20, a188
    v_accvgpr_read_b32 v21, a189
    v_accvgpr_read_b32 v22, a190
    v_accvgpr_read_b32 v23, a191
    v_accvgpr_read_b32 v24, a204
    v_accvgpr_read_b32 v25, a205
    v_accvgpr_read_b32 v26, a206
    v_accvgpr_read_b32 v27, a207
    v_pk_mul_f32 v[20:21], v[20:21], v[10:11] op_sel_hi:[1,0]
    v_pk_mul_f32 v[22:23], v[22:23], v[10:11] op_sel_hi:[1,0]
    v_pk_mul_f32 v[24:25], v[24:25], v[10:11] op_sel_hi:[1,0]
    v_pk_mul_f32 v[26:27], v[26:27], v[10:11] op_sel_hi:[1,0]
    v_cvt_pk_bf16_f32 v20, v20, v21
    v_cvt_pk_bf16_f32 v21, v22, v23
    v_cvt_pk_bf16_f32 v22, v24, v25
    v_cvt_pk_bf16_f32 v23, v26, v27
    buffer_store_dwordx4 v[20:23], v1, s[40:43], s72 offen offset:3072 sc1
    buffer_load_dword v3, v217, s[32:35], s19 offen sc1
    s_waitcnt lgkmcnt(0)
    s_barrier
    s_sub_u32 s30, s47, s75
    s_sub_u32 s31, s79, s75
    v_bfe_u32 v20, v1, 4, 4
    v_lshrrev_b32 v21, 8, v1
    s_lshl_b32 s98, s4, 4
    s_add_u32 s98, s98, 16
    v_add_u32 v22, s98, v20
    v_mul_u32_u24 v22, 144, v22
    v_add_u32 v22, s30, v22
    v_lshl_add_u32 v9, v21, 3, v22
    s_lshr_b32 s98, s73, 1
    v_add_u32 v8, s98, v9
    v_subrev_u32 v10, s98, v9
    s_sub_u32 s99, s31, s30
    v_add_u32 v24, s99, v8
    v_add_u32 v25, s99, v9
    v_add_u32 v26, s99, v10
    s_bitcmp1_b32 s4, 0
    s_cselect_b32 s99, s31, s30
    v_mul_u32_u24 v23, 144, v20
    v_lshl_add_u32 v23, v21, 3, v23
    v_add_u32 v13, s99, v23
    v_add_u32 v12, s98, v13
    v_accvgpr_read_b32 v32, a64
    v_accvgpr_read_b32 v33, a65
    v_accvgpr_read_b32 v34, a66
    v_accvgpr_read_b32 v35, a67
    v_cvt_pk_bf16_f32 v32, v32, v33
    v_cvt_pk_bf16_f32 v33, v34, v35
    ds_write_b64 v8, v[32:33] offset:0
    v_accvgpr_read_b32 v36, a68
    v_accvgpr_read_b32 v37, a69
    v_accvgpr_read_b32 v38, a70
    v_accvgpr_read_b32 v39, a71
    v_cvt_pk_bf16_f32 v36, v36, v37
    v_cvt_pk_bf16_f32 v37, v38, v39
    ds_write_b64 v8, v[36:37] offset:9216
    v_accvgpr_read_b32 v40, a72
    v_accvgpr_read_b32 v41, a73
    v_accvgpr_read_b32 v42, a74
    v_accvgpr_read_b32 v43, a75
    v_cvt_pk_bf16_f32 v40, v40, v41
    v_cvt_pk_bf16_f32 v41, v42, v43
    ds_write_b64 v24, v[40:41] offset:0
    v_accvgpr_read_b32 v44, a76
    v_accvgpr_read_b32 v45, a77
    v_accvgpr_read_b32 v46, a78
    v_accvgpr_read_b32 v47, a79
    v_cvt_pk_bf16_f32 v44, v44, v45
    v_cvt_pk_bf16_f32 v45, v46, v47
    ds_write_b64 v24, v[44:45] offset:9216
    v_accvgpr_read_b32 v32, a80
    v_accvgpr_read_b32 v33, a81
    v_accvgpr_read_b32 v34, a82
    v_accvgpr_read_b32 v35, a83
    v_cvt_pk_bf16_f32 v32, v32, v33
    v_cvt_pk_bf16_f32 v33, v34, v35
    ds_write_b64 v9, v[32:33] offset:32
    v_accvgpr_read_b32 v36, a84
    v_accvgpr_read_b32 v37, a85
    v_accvgpr_read_b32 v38, a86
    v_accvgpr_read_b32 v39, a87
    v_cvt_pk_bf16_f32 v36, v36, v37
    v_cvt_pk_bf16_f32 v37, v38, v39
    ds_write_b64 v9, v[36:37] offset:9248
    v_accvgpr_read_b32 v40, a88
    v_accvgpr_read_b32 v41, a89
    v_accvgpr_read_b32 v42, a90
    v_accvgpr_read_b32 v43, a91
    v_cvt_pk_bf16_f32 v40, v40, v41
    v_cvt_pk_bf16_f32 v41, v42, v43
    ds_write_b64 v25, v[40:41] offset:32
    v_accvgpr_read_b32 v44, a92
    v_accvgpr_read_b32 v45, a93
    v_accvgpr_read_b32 v46, a94
    v_accvgpr_read_b32 v47, a95
    v_cvt_pk_bf16_f32 v44, v44, v45
    v_cvt_pk_bf16_f32 v45, v46, v47
    ds_write_b64 v25, v[44:45] offset:9248
    v_accvgpr_read_b32 v32, a96
    v_accvgpr_read_b32 v33, a97
    v_accvgpr_read_b32 v34, a98
    v_accvgpr_read_b32 v35, a99
    v_cvt_pk_bf16_f32 v32, v32, v33
    v_cvt_pk_bf16_f32 v33, v34, v35
    ds_write_b64 v10, v[32:33] offset:64
    v_accvgpr_read_b32 v36, a100
    v_accvgpr_read_b32 v37, a101
    v_accvgpr_read_b32 v38, a102
    v_accvgpr_read_b32 v39, a103
    v_cvt_pk_bf16_f32 v36, v36, v37
    v_cvt_pk_bf16_f32 v37, v38, v39
    ds_write_b64 v10, v[36:37] offset:9280
    v_accvgpr_read_b32 v40, a104
    v_accvgpr_read_b32 v41, a105
    v_accvgpr_read_b32 v42, a106
    v_accvgpr_read_b32 v43, a107
    v_cvt_pk_bf16_f32 v40, v40, v41
    v_cvt_pk_bf16_f32 v41, v42, v43
    ds_write_b64 v26, v[40:41] offset:64
    v_accvgpr_read_b32 v44, a108
    v_accvgpr_read_b32 v45, a109
    v_accvgpr_read_b32 v46, a110
    v_accvgpr_read_b32 v47, a111
    v_cvt_pk_bf16_f32 v44, v44, v45
    v_cvt_pk_bf16_f32 v45, v46, v47
    ds_write_b64 v26, v[44:45] offset:9280
    v_mov_b32 v218, 2
    s_cmp_eq_u64 s[84:85], 0
    s_cselect_b32 s7, s74, 1073741824
    s_cmp_lg_u32 s83, 0
    s_cselect_b32 s7, s74, s7
    s_waitcnt vmcnt(1)
    buffer_store_dword v218, v216, s[32:35], s7 offen sc1
    s_xor_b32 s21, s3, 2
    s_lshl2_add_u32 s21, s21, s4
    s_mul_i32 s21, s21, 36864
    s_add_u32 s21, s21, s28
    s_mov_b32 m0, s46
    s_nop 0
    buffer_load_dwordx4 v1, s[56:59], s21 offen sc1 lds
    v_accvgpr_read_b32 v32, a112
    v_accvgpr_read_b32 v33, a113
    v_accvgpr_read_b32 v34, a114
    v_accvgpr_read_b32 v35, a115
    v_cvt_pk_bf16_f32 v32, v32, v33
    v_cvt_pk_bf16_f32 v33, v34, v35
    ds_write_b64 v9, v[32:33] offset:96
    v_accvgpr_read_b32 v36, a116
    v_accvgpr_read_b32 v37, a117
    v_accvgpr_read_b32 v38, a118
    v_accvgpr_read_b32 v39, a119
    v_cvt_pk_bf16_f32 v36, v36, v37
    buffer_load_dwordx4 v1, s[56:59], s21 offen offset:1024 sc1 lds
    v_cvt_pk_bf16_f32 v37, v38, v39
    ds_write_b64 v9, v[36:37] offset:9312
    v_accvgpr_read_b32 v40, a120
    v_accvgpr_read_b32 v41, a121
    v_accvgpr_read_b32 v42, a122
    v_accvgpr_read_b32 v43, a123
    v_cvt_pk_bf16_f32 v40, v40, v41
    v_cvt_pk_bf16_f32 v41, v42, v43
    ds_write_b64 v25, v[40:41] offset:96
    v_accvgpr_read_b32 v44, a124
    v_accvgpr_read_b32 v45, a125
    v_accvgpr_read_b32 v46, a126
    buffer_load_dwordx4 v1, s[56:59], s21 offen offset:2048 sc1 lds
    v_accvgpr_read_b32 v47, a127
    v_cvt_pk_bf16_f32 v44, v44, v45
    v_cvt_pk_bf16_f32 v45, v46, v47
    s_waitcnt lgkmcnt(3)
    ds_write_b64 v25, v[44:45] offset:9312
    v_accvgpr_read_b32 v32, a128
    v_accvgpr_read_b32 v33, a129
    v_accvgpr_read_b32 v34, a130
    v_accvgpr_read_b32 v35, a131
    v_cvt_pk_bf16_f32 v32, v32, v33
    v_cvt_pk_bf16_f32 v33, v34, v35
    ds_write_b64 v12, v[32:33] offset:0
    v_accvgpr_read_b32 v36, a132
    buffer_load_dwordx4 v1, s[56:59], s21 offen offset:3072 sc1 lds
    v_accvgpr_read_b32 v37, a133
    v_accvgpr_read_b32 v38, a134
    v_accvgpr_read_b32 v39, a135
    v_cvt_pk_bf16_f32 v36, v36, v37
    v_cvt_pk_bf16_f32 v37, v38, v39
    s_cmp_eq_u32 s73, 0
    s_cselect_b64 exec, -1, 0
    ds_write_b64 v13, v[36:37] offset:32
    s_mov_b64 exec, -1
    s_cmp_lg_u64 s[84:85], 0
    s_cselect_b32 s7, 1, 0
    v_mov_b32 v20, s7
    s_lshl2_add_u32 s98, s4, s30
    s_add_u32 s21, s21, 4096
    s_add_u32 m0, s46, 4096
    s_nop 0
    buffer_load_dwordx4 v1, s[56:59], s21 offen sc1 lds
    v_mov_b32 v21, s98
    ds_write_b32 v21, v20 offset:20736
    v_mov_b32 v21, s30
    s_and_b32 s98, s4, 1
    s_lshl_b32 s98, s98, 6
    v_lshrrev_b32 v14, 4, v1
    v_add_u32 v14, s98, v14
    s_sub_u32 s7, 15, s6
    s_cmp_lt_u32 s4, 2
    s_cselect_b32 s7, s6, s7
    s_cselect_b32 s99, s30, s31
    s_lshl_b32 s7, s7, 7
    buffer_load_dwordx4 v1, s[56:59], s21 offen offset:1024 sc1 lds
    v_add_u32 v2, 2, v14
    v_mul_u32_u24 v2, 144, v2
    v_add_u32 v2, s99, v2
    v_add_u32 v14, s7, v14
    v_lshrrev_b32 v15, 4, v14
    s_mov_b32 s98, 155648
    v_mul_lo_u32 v15, v15, s98
    v_and_b32 v23, 0xf0, v1
    v_add_u32 v15, v15, v23
    s_lshl3_add_u32 s98, s6, s62
    s_mul_i32 s98, s98, 155648
    v_add_u32 v4, s98, v1
    buffer_load_dwordx4 v1, s[56:59], s21 offen offset:2048 sc1 lds
    s_sub_u32 s98, 15, s6
    s_lshl3_add_u32 s98, s98, s62
    s_mul_i32 s98, s98, 155648
    v_add_u32 v5, s98, v1
    v_mov_b32 v19, v217
    v_subrev_u32 v23, s75, v1
    v_add_u32 v11, s44, v23
    v_add_u32 v12, s45, v23
    v_add_u32 v13, s46, v23
    v_add_u32 v6, s47, v23
    v_add_u32 v7, s79, v23
    s_mov_b32 s98, 0xbfb8aa3b
    s_mov_b32 s99, 0x3eae1a93
    s_waitcnt vmcnt(8) lgkmcnt(0)
    s_barrier
    ds_read_b128 v[24:27], v21 offset:20736
    ds_read_b128 v[32:35], v2 offset:2016
    ds_read_b128 v[36:39], v2 offset:2032
    ds_read_b128 v[40:43], v2 offset:2048
    ds_read_b128 v[44:47], v2 offset:1728
    ds_read_b128 v[48:51], v2 offset:1744
    ds_read_b128 v[52:55], v2 offset:1760
    s_waitcnt lgkmcnt(6)
    v_or3_b32 v24, v24, v25, v26
    v_or_b32 v24, v24, v27
    s_nop 0
    v_readfirstlane_b32 s7, v24
    s_nop 1
    s_andn2_b32 s7, s7, s83
    s_cbranch_scc1 K1_REDO
    buffer_load_dword v28, v29, s[32:35], s92 offen sc1
    v_cmp_gt_u32 vcc, 1, v3
    s_nop 1
    s_and_b64 vcc, vcc, exec
    s_cbranch_scc1 SPIN_SHORT
BACK_SHORT:
    buffer_load_dwordx4 a[0:3], v4, s[40:43], s63 offen offset:0 sc1
    ds_read_b128 v[128:131], v2 offset:2096
    ds_read_b128 v[132:135], v2 offset:2112
    ds_read_b128 v[136:139], v2 offset:2128
    ds_read_b128 v[56:59], v2 offset:1440
    ds_read_b128 v[60:63], v2 offset:1456
    ds_read_b128 v[64:67], v2 offset:1472
    ds_read_b128 v[68:71], v2 offset:1152
    ds_read_b128 v[72:75], v2 offset:1168
    ds_read_b128 v[76:79], v2 offset:1184
    s_waitcnt lgkmcnt(8)
    v_dot2_f32_bf16 v140, v128, v32, 0
    v_dot2_f32_bf16 v141, v128, v44, 0
    ds_read_b128 v[80:83], v2 offset:864
    s_waitcnt lgkmcnt(6)
    v_dot2_f32_bf16 v142, v128, v56, 0
    s_waitcnt lgkmcnt(3)
    v_dot2_f32_bf16 v143, v128, v68, 0
    ds_read_b128 v[84:87], v2 offset:880
    v_dot2c_f32_bf16 v140, v129, v33
    v_dot2c_f32_bf16 v141, v129, v45
    buffer_load_dwordx4 a[8:11], v4, s[40:43], s63 offen offset:1024 sc1
    ds_read_b128 v[88:91], v2 offset:896
    v_dot2c_f32_bf16 v142, v129, v57
    v_dot2c_f32_bf16 v143, v129, v69
    ds_read_b128 v[92:95], v2 offset:576
    v_dot2c_f32_bf16 v140, v130, v34
    v_dot2c_f32_bf16 v141, v130, v46
    ds_read_b128 v[96:99], v2 offset:592
    v_dot2c_f32_bf16 v142, v130, v58
    v_dot2c_f32_bf16 v143, v130, v70
    ds_read_b128 v[100:103], v2 offset:608
    v_dot2c_f32_bf16 v140, v131, v35
    v_dot2c_f32_bf16 v141, v131, v47
    ds_read_b128 v[104:107], v2 offset:288
    v_dot2c_f32_bf16 v142, v131, v59
    v_dot2c_f32_bf16 v143, v131, v71
    ds_read_b128 v[108:111], v2 offset:304
    v_dot2c_f32_bf16 v140, v132, v36
    buffer_load_dwordx4 a[16:19], v4, s[40:43], s63 offen offset:2048 sc1
    v_dot2c_f32_bf16 v141, v132, v48
    ds_read_b128 v[112:115], v2 offset:320
    v_dot2c_f32_bf16 v142, v132, v60
    s_waitcnt lgkmcnt(8)
    v_dot2c_f32_bf16 v143, v132, v72
    ds_read_b128 v[116:119], v2 offset:0
    v_dot2c_f32_bf16 v140, v133, v37
    v_dot2c_f32_bf16 v141, v133, v49
    ds_read_b128 v[120:123], v2 offset:16
    v_dot2c_f32_bf16 v142, v133, v61
    v_dot2c_f32_bf16 v143, v133, v73
    ds_read_b128 v[124:127], v2 offset:32
    v_dot2c_f32_bf16 v140, v134, v38
    v_dot2c_f32_bf16 v141, v134, v50
    v_dot2c_f32_bf16 v142, v134, v62
    v_dot2c_f32_bf16 v143, v134, v74
    v_dot2c_f32_bf16 v140, v135, v39
    v_dot2c_f32_bf16 v141, v135, v51
    buffer_load_dwordx4 a[24:27], v4, s[40:43], s63 offen offset:3072 sc1
    v_dot2c_f32_bf16 v142, v135, v63
    v_dot2c_f32_bf16 v143, v135, v75
    v_dot2c_f32_bf16 v140, v136, v40
    v_dot2c_f32_bf16 v141, v136, v52
    v_dot2c_f32_bf16 v142, v136, v64
    v_dot2c_f32_bf16 v143, v136, v76
    v_dot2_f32_bf16 v144, v128, v80, 0
    s_waitcnt lgkmcnt(4)
    v_dot2_f32_bf16 v145, v128, v92, 0
    ds_read_b128 v[32:35], v2 offset:2064
    v_dot2_f32_bf16 v146, v128, v104, 0
    s_waitcnt lgkmcnt(3)
    v_dot2_f32_bf16 v147, v128, v116, 0
    ds_read_b128 v[36:39], v2 offset:2080
    v_dot2c_f32_bf16 v144, v129, v81
    v_dot2c_f32_bf16 v145, v129, v93
    ds_read_b128 v[44:47], v2 offset:1776
    v_dot2c_f32_bf16 v146, v129, v105
    v_dot2c_f32_bf16 v147, v129, v117
    s_xor_b32 s63, s63, 4096
    buffer_load_dwordx4 a[32:35], v4, s[40:43], s63 offen offset:0 sc1
    ds_read_b128 v[48:51], v2 offset:1792
    v_dot2c_f32_bf16 v144, v130, v82
    v_dot2c_f32_bf16 v145, v130, v94
    ds_read_b128 v[56:59], v2 offset:1488
    v_dot2c_f32_bf16 v146, v130, v106
    v_dot2c_f32_bf16 v147, v130, v118
    ds_read_b128 v[60:63], v2 offset:1504
    v_dot2c_f32_bf16 v144, v131, v83
    v_dot2c_f32_bf16 v145, v131, v95
    ds_read_b128 v[68:71], v2 offset:1200
    v_dot2c_f32_bf16 v146, v131, v107
    v_dot2c_f32_bf16 v147, v131, v119
    ds_read_b128 v[72:75], v2 offset:1216
    v_dot2c_f32_bf16 v144, v132, v84
    v_dot2c_f32_bf16 v145, v132, v96
    v_dot2c_f32_bf16 v146, v132, v108
    s_waitcnt lgkmcnt(8)
    v_dot2c_f32_bf16 v147, v132, v120
    buffer_load_dwordx4 a[40:43], v4, s[40:43], s63 offen offset:1024 sc1
    v_dot2c_f32_bf16 v144, v133, v85
    v_dot2c_f32_bf16 v145, v133, v97
    v_dot2c_f32_bf16 v146, v133, v109
    v_dot2c_f32_bf16 v147, v133, v121
    v_dot2c_f32_bf16 v144, v134, v86
    v_dot2c_f32_bf16 v145, v134, v98
    v_dot2c_f32_bf16 v146, v134, v110
    v_dot2c_f32_bf16 v147, v134, v122
    v_dot2c_f32_bf16 v144, v135, v87
    v_dot2c_f32_bf16 v145, v135, v99
    v_dot2c_f32_bf16 v146, v135, v111
    v_dot2c_f32_bf16 v147, v135, v123
    v_dot2c_f32_bf16 v144, v136, v88
    v_dot2c_f32_bf16 v145, v136, v100
    v_dot2c_f32_bf16 v146, v136, v112
    v_dot2c_f32_bf16 v147, v136, v124
    v_lshlrev_b32 v8, 16, v138
    buffer_load_dwordx4 a[48:51], v4, s[40:43], s63 offen offset:2048 sc1
    v_mul_f32 v8, s98, v8
    v_exp_f32 v8, v8
    s_or_b32 s7, s6, s4
    s_cbranch_scc0 K1_WMASK
K1_WMASK_BACK:
    v_max3_f32 v9, v140, v141, v142
    v_max3_f32 v10, v143, v144, v145
    v_max3_f32 v9, v9, v146, v147
    v_max_f32 v9, v9, v10
    v_mul_f32 v9, s99, v9
    v_add_f32 v8, 1.0, v8
    v_fma_f32 v140, v140, s99, -v9
    ds_read_b128 v[80:83], v2 offset:912
    v_fma_f32 v141, v141, s99, -v9
    ds_read_b128 v[84:87], v2 offset:928
    v_fma_f32 v142, v142, s99, -v9
    ds_read_b128 v[92:95], v2 offset:624
    buffer_load_dwordx4 a[56:59], v4, s[40:43], s63 offen offset:3072 sc1
    s_xor_b32 s63, s63, 12288
    v_fma_f32 v143, v143, s99, -v9
    ds_read_b128 v[96:99], v2 offset:640
    v_fma_f32 v144, v144, s99, -v9
    ds_read_b128 v[104:107], v2 offset:336
    v_fma_f32 v145, v145, s99, -v9
    ds_read_b128 v[108:111], v2 offset:352
    v_fma_f32 v146, v146, s99, -v9
    ds_read_b128 v[116:119], v2 offset:48
    v_fma_f32 v147, v147, s99, -v9
    s_waitcnt lgkmcnt(7)
    ds_read_b128 v[120:123], v2 offset:64
    v_exp_f32 v140, v140
    v_exp_f32 v141, v141
    v_exp_f32 v142, v142
    v_exp_f32 v143, v143
    v_exp_f32 v144, v144
    v_exp_f32 v145, v145
    v_exp_f32 v146, v146
    buffer_load_dword v3, v217, s[32:35], s19 offen sc1
    buffer_load_dwordx4 a[64:67], v4, s[40:43], s63 offen offset:0 sc1
    v_exp_f32 v147, v147
    v_add_f32 v10, v140, v141
    v_add_f32 v10, v10, v142
    v_add_f32 v10, v10, v143
    v_add_f32 v10, v10, v144
    v_add_f32 v10, v10, v145
    v_add_f32 v10, v10, v146
    v_add_f32 v10, v10, v147
    v_mul_f32 v10, v10, v8
    v_rcp_f32 v10, v10
    s_nop 0
    v_mul_f32 v140, v140, v10
    v_mul_f32 v141, v141, v10
    v_mul_f32 v142, v142, v10
    buffer_load_dwordx4 a[72:75], v4, s[40:43], s63 offen offset:1024 sc1
    v_mul_f32 v143, v143, v10
    v_mul_f32 v144, v144, v10
    v_mul_f32 v145, v145, v10
    v_mul_f32 v146, v146, v10
    v_mul_f32 v147, v147, v10
    v_cvt_pk_bf16_f32 v148, 0, v140
    v_cvt_pk_bf16_f32 v149, 0, v141
    v_cvt_pk_bf16_f32 v150, 0, v142
    v_cvt_pk_bf16_f32 v151, 0, v143
    v_cvt_pk_bf16_f32 v152, 0, v144
    v_cvt_pk_bf16_f32 v153, 0, v145
    v_cvt_pk_bf16_f32 v154, 0, v146
    v_cvt_pk_bf16_f32 v155, 0, v147
    buffer_load_dwordx4 a[80:83], v4, s[40:43], s63 offen offset:2048 sc1
    v_lshrrev_b32 v140, 16, v148
    v_lshrrev_b32 v141, 16, v149
    v_lshrrev_b32 v142, 16, v150
    v_lshrrev_b32 v143, 16, v151
    v_lshrrev_b32 v144, 16, v152
    v_lshrrev_b32 v145, 16, v153
    v_lshrrev_b32 v146, 16, v154
    v_lshrrev_b32 v147, 16, v155
    v_dot2_f32_bf16 v128, v42, v140, 0
    v_dot2_f32_bf16 v129, v42, v148, 0
    v_dot2_f32_bf16 v130, v43, v140, 0
    v_dot2_f32_bf16 v131, v43, v148, 0
    v_dot2_f32_bf16 v132, v32, v140, 0
    buffer_load_dwordx4 a[88:91], v4, s[40:43], s63 offen offset:3072 sc1
    s_xor_b32 s63, s63, 4096
    v_dot2_f32_bf16 v133, v32, v148, 0
    v_dot2_f32_bf16 v134, v33, v140, 0
    v_dot2_f32_bf16 v135, v33, v148, 0
    v_dot2_f32_bf16 v136, v34, v140, 0
    v_dot2_f32_bf16 v137, v34, v148, 0
    v_dot2_f32_bf16 v138, v35, v140, 0
    v_dot2_f32_bf16 v139, v35, v148, 0
    v_dot2_f32_bf16 v156, v36, v140, 0
    v_dot2_f32_bf16 v157, v36, v148, 0
    v_dot2_f32_bf16 v158, v37, v140, 0
    v_dot2_f32_bf16 v159, v37, v148, 0
    v_dot2_f32_bf16 v17, v38, v140, 0
    v_dot2_f32_bf16 v18, v38, v148, 0
    v_dot2c_f32_bf16 v128, v54, v141
    s_waitcnt vmcnt(4)
    v_cmp_gt_u32 vcc, 2, v3
    s_nop 1
    s_and_b64 vcc, vcc, exec
    s_cbranch_scc1 SPIN_CTX
BACK_CTX:
    buffer_load_dwordx4 a[4:7], v5, s[40:43], s20 offen offset:0 sc1
    v_dot2c_f32_bf16 v129, v54, v149
    v_dot2c_f32_bf16 v130, v55, v141
    v_dot2c_f32_bf16 v131, v55, v149
    v_dot2c_f32_bf16 v132, v44, v141
    v_dot2c_f32_bf16 v133, v44, v149
    v_dot2c_f32_bf16 v134, v45, v141
    v_dot2c_f32_bf16 v135, v45, v149
    v_dot2c_f32_bf16 v136, v46, v141
    v_dot2c_f32_bf16 v137, v46, v149
    v_dot2c_f32_bf16 v138, v47, v141
    v_dot2c_f32_bf16 v139, v47, v149
    v_dot2c_f32_bf16 v156, v48, v141
    v_dot2c_f32_bf16 v157, v48, v149
    buffer_load_dwordx4 a[12:15], v5, s[40:43], s20 offen offset:1024 sc1
    v_dot2c_f32_bf16 v158, v49, v141
    v_dot2c_f32_bf16 v159, v49, v149
    v_dot2c_f32_bf16 v17, v50, v141
    v_dot2c_f32_bf16 v18, v50, v149
    v_dot2c_f32_bf16 v128, v66, v142
    v_dot2c_f32_bf16 v129, v66, v150
    v_dot2c_f32_bf16 v130, v67, v142
    v_dot2c_f32_bf16 v131, v67, v150
    v_dot2c_f32_bf16 v132, v56, v142
    v_dot2c_f32_bf16 v133, v56, v150
    v_dot2c_f32_bf16 v134, v57, v142
    v_dot2c_f32_bf16 v135, v57, v150
    v_dot2c_f32_bf16 v136, v58, v142
    v_dot2c_f32_bf16 v137, v58, v150
    buffer_load_dwordx4 a[20:23], v5, s[40:43], s20 offen offset:2048 sc1
    v_dot2c_f32_bf16 v138, v59, v142
    v_dot2c_f32_bf16 v139, v59, v150
    v_dot2c_f32_bf16 v156, v60, v142
    v_dot2c_f32_bf16 v157, v60, v150
    v_dot2c_f32_bf16 v158, v61, v142
    v_dot2c_f32_bf16 v159, v61, v150
    v_dot2c_f32_bf16 v17, v62, v142
    v_dot2c_f32_bf16 v18, v62, v150
    v_dot2c_f32_bf16 v128, v78, v143
    v_dot2c_f32_bf16 v129, v78, v151
    v_dot2c_f32_bf16 v130, v79, v143
    v_dot2c_f32_bf16 v131, v79, v151
    v_dot2c_f32_bf16 v132, v68, v143
    v_dot2c_f32_bf16 v133, v68, v151
    buffer_load_dwordx4 a[28:31], v5, s[40:43], s20 offen offset:3072 sc1
    s_xor_b32 s20, s20, 4096
    v_dot2c_f32_bf16 v134, v69, v143
    v_dot2c_f32_bf16 v135, v69, v151
    v_dot2c_f32_bf16 v136, v70, v143
    v_dot2c_f32_bf16 v137, v70, v151
    v_dot2c_f32_bf16 v138, v71, v143
    v_dot2c_f32_bf16 v139, v71, v151
    v_dot2c_f32_bf16 v156, v72, v143
    v_dot2c_f32_bf16 v157, v72, v151
    v_dot2c_f32_bf16 v158, v73, v143
    v_dot2c_f32_bf16 v159, v73, v151
    v_dot2c_f32_bf16 v17, v74, v143
    v_dot2c_f32_bf16 v18, v74, v151
    v_dot2c_f32_bf16 v128, v90, v144
    v_dot2c_f32_bf16 v129, v90, v152
    v_dot2c_f32_bf16 v130, v91, v144
    v_dot2c_f32_bf16 v131, v91, v152
    s_waitcnt lgkmcnt(0)
    v_dot2c_f32_bf16 v132, v80, v144
    v_dot2c_f32_bf16 v133, v80, v152
    v_dot2c_f32_bf16 v134, v81, v144
    v_dot2c_f32_bf16 v135, v81, v152
    v_dot2c_f32_bf16 v136, v82, v144
    v_dot2c_f32_bf16 v137, v82, v152
    v_dot2c_f32_bf16 v138, v83, v144
    v_dot2c_f32_bf16 v139, v83, v152
    v_dot2c_f32_bf16 v156, v84, v144
    v_dot2c_f32_bf16 v157, v84, v152
    v_dot2c_f32_bf16 v158, v85, v144
    v_dot2c_f32_bf16 v159, v85, v152
    v_dot2c_f32_bf16 v17, v86, v144
    v_dot2c_f32_bf16 v18, v86, v152
    v_dot2c_f32_bf16 v128, v102, v145
    v_dot2c_f32_bf16 v129, v102, v153
    v_dot2c_f32_bf16 v130, v103, v145
    v_dot2c_f32_bf16 v131, v103, v153
    v_dot2c_f32_bf16 v132, v92, v145
    v_dot2c_f32_bf16 v133, v92, v153
    v_dot2c_f32_bf16 v134, v93, v145
    v_dot2c_f32_bf16 v135, v93, v153
    v_dot2c_f32_bf16 v136, v94, v145
    v_dot2c_f32_bf16 v137, v94, v153
    v_dot2c_f32_bf16 v138, v95, v145
    v_dot2c_f32_bf16 v139, v95, v153
    v_dot2c_f32_bf16 v156, v96, v145
    v_dot2c_f32_bf16 v157, v96, v153
    v_dot2c_f32_bf16 v158, v97, v145
    v_dot2c_f32_bf16 v159, v97, v153
    v_dot2c_f32_bf16 v17, v98, v145
    v_dot2c_f32_bf16 v18, v98, v153
    v_dot2c_f32_bf16 v128, v114, v146
    v_dot2c_f32_bf16 v129, v114, v154
    v_dot2c_f32_bf16 v130, v115, v146
    v_dot2c_f32_bf16 v131, v115, v154
    v_dot2c_f32_bf16 v132, v104, v146
    v_dot2c_f32_bf16 v133, v104, v154
    v_dot2c_f32_bf16 v134, v105, v146
    v_dot2c_f32_bf16 v135, v105, v154
    v_dot2c_f32_bf16 v136, v106, v146
    v_dot2c_f32_bf16 v137, v106, v154
    v_dot2c_f32_bf16 v138, v107, v146
    v_dot2c_f32_bf16 v139, v107, v154
    v_dot2c_f32_bf16 v156, v108, v146
    v_dot2c_f32_bf16 v157, v108, v154
    v_dot2c_f32_bf16 v158, v109, v146
    v_dot2c_f32_bf16 v159, v109, v154
    v_dot2c_f32_bf16 v17, v110, v146
    v_dot2c_f32_bf16 v18, v110, v154
    v_dot2c_f32_bf16 v128, v126, v147
    v_dot2c_f32_bf16 v129, v126, v155
    v_dot2c_f32_bf16 v130, v127, v147
    v_dot2c_f32_bf16 v131, v127, v155
    v_dot2c_f32_bf16 v132, v116, v147
    v_dot2c_f32_bf16 v133, v116, v155
    v_dot2c_f32_bf16 v134, v117, v147
    v_dot2c_f32_bf16 v135, v117, v155
    v_dot2c_f32_bf16 v136, v118, v147
    v_dot2c_f32_bf16 v137, v118, v155
    v_dot2c_f32_bf16 v138, v119, v147
    v_dot2c_f32_bf16 v139, v119, v155
    v_dot2c_f32_bf16 v156, v120, v147
    v_dot2c_f32_bf16 v157, v120, v155
    v_dot2c_f32_bf16 v158, v121, v147
    v_dot2c_f32_bf16 v159, v121, v155
    v_dot2c_f32_bf16 v17, v122, v147
    v_dot2c_f32_bf16 v18, v122, v155
    v_mov_b32 v89, 0
    v_mov_b32 v90, 0
    v_mov_b32 v91, 0
    v_cvt_pk_bf16_f32 v80, v128, v129
    v_cvt_pk_bf16_f32 v81, v130, v131
    v_cvt_pk_bf16_f32 v82, v132, v133
    v_cvt_pk_bf16_f32 v83, v134, v135
    v_cvt_pk_bf16_f32 v84, v136, v137
    v_cvt_pk_bf16_f32 v85, v138, v139
    v_cvt_pk_bf16_f32 v86, v156, v157
    v_cvt_pk_bf16_f32 v87, v158, v159
    v_cvt_pk_bf16_f32 v88, v17, v18
    v_cmp_gt_u32 vcc, 1, v28
    s_nop 1
    s_and_b64 vcc, vcc, exec
    s_cbranch_scc1 SPIN_ALL
BACK_ALL:
    s_waitcnt vmcnt(0)
    s_barrier
    ds_read_b128 v[104:107], v11 offset:0
    ds_read_b128 v[108:111], v11 offset:8192
    ds_read_b128 v[112:115], v11 offset:16384
    ds_read_b128 v[116:119], v11 offset:24576
    s_waitcnt lgkmcnt(3)
    v_mfma_f32_16x16x32_bf16 v[176:179], v[104:107], a[0:3], 0
    s_lshl3_add_u32 s98, 1, s5
    ds_read_b128 v[120:123], v11 offset:1024
    ds_read_b128 v[124:127], v11 offset:9216
    s_waitcnt lgkmcnt(4)
    v_mfma_f32_16x16x32_bf16 v[176:179], v[108:111], a[8:11], v[176:179]
    s_and_b32 s98, s98, 31
    buffer_load_dwordx4 a[36:39], v5, s[40:43], s20 offen offset:0 sc1
    s_waitcnt lgkmcnt(3)
    v_mfma_f32_16x16x32_bf16 v[176:179], v[112:115], a[16:19], v[176:179]
    s_lshl_b32 s8, s6, 5
    ds_read_b128 v[128:131], v11 offset:17408
    ds_read_b128 v[132:135], v11 offset:25600
    s_waitcnt lgkmcnt(4)
    v_mfma_f32_16x16x32_bf16 v[176:179], v[116:119], a[24:27], v[176:179]
    s_add_u32 s98, s98, s8
    buffer_load_dwordx4 a[44:47], v5, s[40:43], s20 offen offset:1024 sc1
    v_mfma_f32_16x16x32_bf16 v[180:183], v[104:107], a[4:7], 0
    s_mul_i32 s98, s98, 3
    ds_read_b128 v[136:139], v11 offset:2048
    ds_read_b128 v[140:143], v11 offset:10240
    v_mfma_f32_16x16x32_bf16 v[180:183], v[108:111], a[12:15], v[180:183]
    s_sub_u32 s98, s98, 1
    ds_read_b128 v[144:147], v11 offset:18432
    v_mov_b32 v16, 0x44444444
    v_mfma_f32_16x16x32_bf16 v[180:183], v[112:115], a[20:23], v[180:183]
    s_add_u32 s98, s98, 3
    ds_read_b128 v[148:151], v11 offset:26624
    v_mfma_f32_16x16x32_bf16 v[180:183], v[116:119], a[28:31], v[180:183]
    s_lshl2_add_u32 s98, s98, s4
    buffer_load_dwordx4 a[52:55], v5, s[40:43], s20 offen offset:2048 sc1
    s_waitcnt lgkmcnt(4)
    v_mfma_f32_16x16x32_bf16 v[184:187], v[120:123], a[0:3], 0
    s_mul_i32 s8, s98, 3072
    ds_read_b128 v[104:107], v11 offset:3072
    ds_read_b128 v[108:111], v11 offset:11264
    v_mfma_f32_16x16x32_bf16 v[184:187], v[124:127], a[8:11], v[184:187]
    s_lshl3_add_u32 s98, 2, s5
    ds_read_b128 v[112:115], v11 offset:19456
    v_mfma_f32_16x16x32_bf16 v[184:187], v[128:131], a[16:19], v[184:187]
    s_and_b32 s98, s98, 31
    ds_read_b128 v[116:119], v11 offset:27648
    v_mfma_f32_16x16x32_bf16 v[184:187], v[132:135], a[24:27], v[184:187]
    s_lshl_b32 s9, s6, 5
    buffer_load_dwordx4 a[60:63], v5, s[40:43], s20 offen offset:3072 sc1
    v_mfma_f32_16x16x32_bf16 v[188:191], v[120:123], a[4:7], 0
    s_xor_b32 s20, s20, 12288
    ds_read_b128 v[120:123], v11 offset:4096
    v_mfma_f32_16x16x32_bf16 v[188:191], v[124:127], a[12:15], v[188:191]
    s_add_u32 s98, s98, s9
    ds_read_b128 v[124:127], v11 offset:12288
    v_mfma_f32_16x16x32_bf16 v[188:191], v[128:131], a[20:23], v[188:191]
    s_mul_i32 s98, s98, 3
    ds_read_b128 v[128:131], v11 offset:20480
    v_mfma_f32_16x16x32_bf16 v[188:191], v[132:135], a[28:31], v[188:191]
    s_sub_u32 s98, s98, 2
    buffer_load_dwordx4 a[68:71], v5, s[40:43], s20 offen offset:0 sc1
    s_waitcnt lgkmcnt(3)
    v_mfma_f32_16x16x32_bf16 v[192:195], v[136:139], a[0:3], 0
    s_add_u32 s98, s98, 3
    ds_read_b128 v[132:135], v11 offset:28672
    v_mfma_f32_16x16x32_bf16 v[192:195], v[140:143], a[8:11], v[192:195]
    s_lshl2_add_u32 s98, s98, s4
    v_mfma_f32_16x16x32_bf16 v[192:195], v[144:147], a[16:19], v[192:195]
    s_mul_i32 s9, s98, 3072
    buffer_load_dwordx4 a[76:79], v5, s[40:43], s20 offen offset:1024 sc1
    v_mfma_f32_16x16x32_bf16 v[192:195], v[148:151], a[24:27], v[192:195]
    s_lshl3_add_u32 s98, 3, s5
    v_mfma_f32_16x16x32_bf16 v[196:199], v[136:139], a[4:7], 0
    s_and_b32 s98, s98, 31
    ds_read_b128 v[136:139], v11 offset:5120
    v_mfma_f32_16x16x32_bf16 v[196:199], v[140:143], a[12:15], v[196:199]
    s_lshl_b32 s10, s6, 5
    ds_read_b128 v[140:143], v11 offset:13312
    v_mfma_f32_16x16x32_bf16 v[196:199], v[144:147], a[20:23], v[196:199]
    s_add_u32 s98, s98, s10
    buffer_load_dwordx4 a[84:87], v5, s[40:43], s20 offen offset:2048 sc1
    v_mfma_f32_16x16x32_bf16 v[196:199], v[148:151], a[28:31], v[196:199]
    s_mul_i32 s98, s98, 3
    ds_read_b128 v[144:147], v11 offset:21504
    ds_read_b128 v[148:151], v11 offset:29696
    v_mfma_f32_16x16x32_bf16 v[200:203], v[104:107], a[0:3], 0
    s_sub_u32 s98, s98, 3
    v_mfma_f32_16x16x32_bf16 v[200:203], v[108:111], a[8:11], v[200:203]
    s_add_u32 s98, s98, 3
    v_mfma_f32_16x16x32_bf16 v[200:203], v[112:115], a[16:19], v[200:203]
    s_lshl2_add_u32 s98, s98, s4
    buffer_load_dwordx4 a[92:95], v5, s[40:43], s20 offen offset:3072 sc1
    v_mfma_f32_16x16x32_bf16 v[200:203], v[116:119], a[24:27], v[200:203]
    s_xor_b32 s20, s20, 4096
    v_mfma_f32_16x16x32_bf16 v[204:207], v[104:107], a[4:7], 0
    s_mul_i32 s10, s98, 3072
    ds_read_b128 v[104:107], v11 offset:6144
    v_mfma_f32_16x16x32_bf16 v[204:207], v[108:111], a[12:15], v[204:207]
    s_sub_u32 s99, s4, s61
    ds_read_b128 v[108:111], v11 offset:14336
    v_mfma_f32_16x16x32_bf16 v[204:207], v[112:115], a[20:23], v[204:207]
    s_and_b32 s99, s99, 3
    buffer_store_dwordx4 v[80:83], v15, s[40:43], s71 offen offset:0 sc1
    v_mfma_f32_16x16x32_bf16 v[204:207], v[116:119], a[28:31], v[204:207]
    s_lshl3_add_u32 s98, s99, s5
    ds_read_b128 v[112:115], v11 offset:22528
    ds_read_b128 v[116:119], v11 offset:30720
    s_waitcnt lgkmcnt(4)
    v_mfma_f32_16x16x32_bf16 v[208:211], v[120:123], a[0:3], 0
    s_and_b32 s98, s98, 31
    v_mfma_f32_16x16x32_bf16 v[208:211], v[124:127], a[8:11], v[208:211]
    s_lshl_b32 s11, s6, 5
    v_mfma_f32_16x16x32_bf16 v[208:211], v[128:131], a[16:19], v[208:211]
    s_add_u32 s98, s98, s11
    buffer_store_dwordx4 v[84:87], v15, s[40:43], s71 offen offset:256 sc1
    v_mfma_f32_16x16x32_bf16 v[208:211], v[132:135], a[24:27], v[208:211]
    s_mul_i32 s98, s98, 3
    v_mfma_f32_16x16x32_bf16 v[212:215], v[120:123], a[4:7], 0
    s_sub_u32 s98, s98, s99
    ds_read_b128 v[120:123], v12 offset:0
    v_mfma_f32_16x16x32_bf16 v[212:215], v[124:127], a[12:15], v[212:215]
    s_add_u32 s98, s98, 3
    buffer_store_dwordx4 v[88:91], v15, s[40:43], s70 offen offset:0 sc1
    v_mfma_f32_16x16x32_bf16 v[212:215], v[128:131], a[20:23], v[212:215]
    s_xor_b32 s21, s3, 3
    ds_read_b128 v[124:127], v12 offset:8192
    ds_read_b128 v[128:131], v12 offset:16384
    v_mfma_f32_16x16x32_bf16 v[212:215], v[132:135], a[28:31], v[212:215]
    s_lshl2_add_u32 s21, s21, s4
    ds_read_b128 v[132:135], v12 offset:24576
    v_mfma_f32_16x16x32_bf16 v[216:219], v[136:139], a[0:3], 0
    s_mul_i32 s21, s21, 36864
    v_mfma_f32_16x16x32_bf16 v[216:219], v[140:143], a[8:11], v[216:219]
    s_add_u32 s21, s21, s28
    s_mov_b32 m0, s47
    v_mfma_f32_16x16x32_bf16 v[216:219], v[144:147], a[16:19], v[216:219]
    s_lshl2_add_u32 s98, s98, s4
    buffer_load_dwordx4 v1, s[56:59], s21 offen sc1 lds
    v_mfma_f32_16x16x32_bf16 v[216:219], v[148:151], a[24:27], v[216:219]
    s_waitcnt vmcnt(8)
    v_mfma_f32_16x16x32_bf16 v[220:223], v[136:139], a[4:7], 0
    s_mul_i32 s11, s98, 3072
    ds_read_b128 v[136:139], v12 offset:1024
    v_mfma_f32_16x16x32_bf16 v[220:223], v[140:143], a[12:15], v[220:223]
    buffer_load_dwordx4 v1, s[56:59], s21 offen offset:1024 sc1 lds
    v_mfma_f32_16x16x32_bf16 v[220:223], v[144:147], a[20:23], v[220:223]
    ds_read_b128 v[140:143], v12 offset:9216
    ds_read_b128 v[144:147], v12 offset:17408
    v_mfma_f32_16x16x32_bf16 v[220:223], v[148:151], a[28:31], v[220:223]
    s_waitcnt lgkmcnt(3)
    ds_read_b128 v[148:151], v12 offset:25600
    v_mfma_f32_16x16x32_bf16 v[224:227], v[104:107], a[0:3], 0
    s_cmp_eq_u32 s99, 0
    s_cselect_b32 s11, 1073741824, s11
    v_mfma_f32_16x16x32_bf16 v[224:227], v[108:111], a[8:11], v[224:227]
    buffer_load_dwordx4 v1, s[56:59], s21 offen offset:2048 sc1 lds
    v_mfma_f32_16x16x32_bf16 v[224:227], v[112:115], a[16:19], v[224:227]
    v_mfma_f32_16x16x32_bf16 v[224:227], v[116:119], a[24:27], v[224:227]
    v_mfma_f32_16x16x32_bf16 v[228:231], v[104:107], a[4:7], 0
    ds_read_b128 v[104:107], v12 offset:2048
    v_mfma_f32_16x16x32_bf16 v[228:231], v[108:111], a[12:15], v[228:231]
    buffer_load_dwordx4 v1, s[56:59], s21 offen offset:3072 sc1 lds
    v_mfma_f32_16x16x32_bf16 v[228:231], v[112:115], a[20:23], v[228:231]
    s_add_u32 s21, s21, 4096
    ds_read_b128 v[108:111], v12 offset:10240
    ds_read_b128 v[112:115], v12 offset:18432
    v_mfma_f32_16x16x32_bf16 v[228:231], v[116:119], a[28:31], v[228:231]
    s_add_u32 m0, s47, 4096
    ds_read_b128 v[116:119], v12 offset:26624
    v_mfma_f32_16x16x32_bf16 v[176:179], v[120:123], a[32:35], v[176:179]
    buffer_load_dwordx4 v1, s[56:59], s21 offen sc1 lds
    v_mfma_f32_16x16x32_bf16 v[176:179], v[124:127], a[40:43], v[176:179]
    v_mfma_f32_16x16x32_bf16 v[176:179], v[128:131], a[48:51], v[176:179]
    v_mfma_f32_16x16x32_bf16 v[176:179], v[132:135], a[56:59], v[176:179]
    v_mfma_f32_16x16x32_bf16 v[180:183], v[120:123], a[36:39], v[180:183]
    buffer_load_dwordx4 v1, s[56:59], s21 offen offset:1024 sc1 lds
    v_mfma_f32_16x16x32_bf16 v[180:183], v[124:127], a[44:47], v[180:183]
    ds_read_b128 v[120:123], v12 offset:3072
    ds_read_b128 v[124:127], v12 offset:11264
    v_mfma_f32_16x16x32_bf16 v[180:183], v[128:131], a[52:55], v[180:183]
    ds_read_b128 v[128:131], v12 offset:19456
    v_mfma_f32_16x16x32_bf16 v[180:183], v[132:135], a[60:63], v[180:183]
    s_waitcnt lgkmcnt(3)
    ds_read_b128 v[132:135], v12 offset:27648
    v_mfma_f32_16x16x32_bf16 v[184:187], v[136:139], a[32:35], v[184:187]
    buffer_load_dwordx4 v1, s[56:59], s21 offen offset:2048 sc1 lds
    v_mfma_f32_16x16x32_bf16 v[184:187], v[140:143], a[40:43], v[184:187]
    v_mfma_f32_16x16x32_bf16 v[184:187], v[144:147], a[48:51], v[184:187]
    v_mfma_f32_16x16x32_bf16 v[184:187], v[148:151], a[56:59], v[184:187]
    v_mfma_f32_16x16x32_bf16 v[188:191], v[136:139], a[36:39], v[188:191]
    buffer_load_dwordx4 a[96:99], v4, s[40:43], s63 offen offset:0 sc1
    v_mfma_f32_16x16x32_bf16 v[188:191], v[140:143], a[44:47], v[188:191]
    ds_read_b128 v[136:139], v12 offset:4096
    ds_read_b128 v[140:143], v12 offset:12288
    v_mfma_f32_16x16x32_bf16 v[188:191], v[144:147], a[52:55], v[188:191]
    ds_read_b128 v[144:147], v12 offset:20480
    v_mfma_f32_16x16x32_bf16 v[188:191], v[148:151], a[60:63], v[188:191]
    ds_read_b128 v[148:151], v12 offset:28672
    v_mfma_f32_16x16x32_bf16 v[192:195], v[104:107], a[32:35], v[192:195]
    buffer_load_dwordx4 a[104:107], v4, s[40:43], s63 offen offset:1024 sc1
    v_mfma_f32_16x16x32_bf16 v[192:195], v[108:111], a[40:43], v[192:195]
    v_mfma_f32_16x16x32_bf16 v[192:195], v[112:115], a[48:51], v[192:195]
    v_mfma_f32_16x16x32_bf16 v[192:195], v[116:119], a[56:59], v[192:195]
    buffer_load_dwordx4 a[112:115], v4, s[40:43], s63 offen offset:2048 sc1
    v_mfma_f32_16x16x32_bf16 v[196:199], v[104:107], a[36:39], v[196:199]
    ds_read_b128 v[104:107], v12 offset:5120
    v_mfma_f32_16x16x32_bf16 v[196:199], v[108:111], a[44:47], v[196:199]
    ds_read_b128 v[108:111], v12 offset:13312
    v_mfma_f32_16x16x32_bf16 v[196:199], v[112:115], a[52:55], v[196:199]
    ds_read_b128 v[112:115], v12 offset:21504
    v_mfma_f32_16x16x32_bf16 v[196:199], v[116:119], a[60:63], v[196:199]
    s_waitcnt lgkmcnt(3)
    buffer_load_dwordx4 a[120:123], v4, s[40:43], s63 offen offset:3072 sc1
    v_mfma_f32_16x16x32_bf16 v[200:203], v[120:123], a[32:35], v[200:203]
    s_xor_b32 s63, s63, 28672
    ds_read_b128 v[116:119], v12 offset:29696
    v_mfma_f32_16x16x32_bf16 v[200:203], v[124:127], a[40:43], v[200:203]
    v_mfma_f32_16x16x32_bf16 v[200:203], v[128:131], a[48:51], v[200:203]
    v_mfma_f32_16x16x32_bf16 v[200:203], v[132:135], a[56:59], v[200:203]
    buffer_load_dwordx4 a[100:103], v5, s[40:43], s20 offen offset:0 sc1
    v_mfma_f32_16x16x32_bf16 v[204:207], v[120:123], a[36:39], v[204:207]
    ds_read_b128 v[120:123], v12 offset:6144
    v_mfma_f32_16x16x32_bf16 v[204:207], v[124:127], a[44:47], v[204:207]
    ds_read_b128 v[124:127], v12 offset:14336
    v_mfma_f32_16x16x32_bf16 v[204:207], v[128:131], a[52:55], v[204:207]
    ds_read_b128 v[128:131], v12 offset:22528
    v_mfma_f32_16x16x32_bf16 v[204:207], v[132:135], a[60:63], v[204:207]
    buffer_load_dwordx4 a[108:111], v5, s[40:43], s20 offen offset:1024 sc1
    v_mfma_f32_16x16x32_bf16 v[208:211], v[136:139], a[32:35], v[208:211]
    ds_read_b128 v[132:135], v12 offset:30720
    v_mfma_f32_16x16x32_bf16 v[208:211], v[140:143], a[40:43], v[208:211]
    v_mfma_f32_16x16x32_bf16 v[208:211], v[144:147], a[48:51], v[208:211]
    v_mfma_f32_16x16x32_bf16 v[208:211], v[148:151], a[56:59], v[208:211]
    buffer_load_dwordx4 a[116:119], v5, s[40:43], s20 offen offset:2048 sc1
    v_mfma_f32_16x16x32_bf16 v[212:215], v[136:139], a[36:39], v[212:215]
    ds_read_b128 v[136:139], v13 offset:0
    v_mfma_f32_16x16x32_bf16 v[212:215], v[140:143], a[44:47], v[212:215]
    ds_read_b128 v[140:143], v13 offset:8192
    v_mfma_f32_16x16x32_bf16 v[212:215], v[144:147], a[52:55], v[212:215]
    buffer_load_dwordx4 a[124:127], v5, s[40:43], s20 offen offset:3072 sc1
    v_mfma_f32_16x16x32_bf16 v[212:215], v[148:151], a[60:63], v[212:215]
    s_xor_b32 s21, s3, 4
    ds_read_b128 v[144:147], v13 offset:16384
    ds_read_b128 v[148:151], v13 offset:24576
    s_waitcnt lgkmcnt(4)
    v_mfma_f32_16x16x32_bf16 v[216:219], v[104:107], a[32:35], v[216:219]
    s_lshl2_add_u32 s21, s21, s4
    v_mfma_f32_16x16x32_bf16 v[216:219], v[108:111], a[40:43], v[216:219]
    s_mul_i32 s21, s21, 36864
    v_mfma_f32_16x16x32_bf16 v[216:219], v[112:115], a[48:51], v[216:219]
    s_add_u32 s21, s21, s28
    s_mov_b32 m0, s79
    v_mfma_f32_16x16x32_bf16 v[216:219], v[116:119], a[56:59], v[216:219]
    s_xor_b32 s20, s20, 28672
    buffer_load_dwordx4 v1, s[56:59], s21 offen sc1 lds
    s_waitcnt vmcnt(19)
    s_barrier
    v_mfma_f32_16x16x32_bf16 v[220:223], v[104:107], a[36:39], v[220:223]
    ds_read_b128 v[104:107], v13 offset:1024
    v_mfma_f32_16x16x32_bf16 v[220:223], v[108:111], a[44:47], v[220:223]
    ds_read_b128 v[108:111], v13 offset:9216
    v_mfma_f32_16x16x32_bf16 v[220:223], v[112:115], a[52:55], v[220:223]
    buffer_load_dwordx4 v1, s[56:59], s21 offen offset:1024 sc1 lds
    v_mfma_f32_16x16x32_bf16 v[220:223], v[116:119], a[60:63], v[220:223]
    ds_read_b128 v[112:115], v13 offset:17408
    ds_read_b128 v[116:119], v13 offset:25600
    v_mfma_f32_16x16x32_bf16 v[224:227], v[120:123], a[32:35], v[224:227]
    v_mfma_f32_16x16x32_bf16 v[224:227], v[124:127], a[40:43], v[224:227]
    v_mfma_f32_16x16x32_bf16 v[224:227], v[128:131], a[48:51], v[224:227]
    buffer_load_dwordx4 v1, s[56:59], s21 offen offset:2048 sc1 lds
    v_mfma_f32_16x16x32_bf16 v[224:227], v[132:135], a[56:59], v[224:227]
    v_mfma_f32_16x16x32_bf16 v[228:231], v[120:123], a[36:39], v[228:231]
    ds_read_b128 v[120:123], v13 offset:2048
    v_mfma_f32_16x16x32_bf16 v[228:231], v[124:127], a[44:47], v[228:231]
    ds_read_b128 v[124:127], v13 offset:10240
    v_mfma_f32_16x16x32_bf16 v[228:231], v[128:131], a[52:55], v[228:231]
    buffer_load_dwordx4 v1, s[56:59], s21 offen offset:3072 sc1 lds
    v_mfma_f32_16x16x32_bf16 v[228:231], v[132:135], a[60:63], v[228:231]
    s_add_u32 s21, s21, 4096
    ds_read_b128 v[128:131], v13 offset:18432
    ds_read_b128 v[132:135], v13 offset:26624
    s_waitcnt lgkmcnt(4)
    v_mfma_f32_16x16x32_bf16 v[176:179], v[136:139], a[64:67], v[176:179]
    s_add_u32 m0, s79, 4096
    v_mfma_f32_16x16x32_bf16 v[176:179], v[140:143], a[72:75], v[176:179]
    buffer_load_dwordx4 v1, s[56:59], s21 offen sc1 lds
    v_mfma_f32_16x16x32_bf16 v[176:179], v[144:147], a[80:83], v[176:179]
    v_mfma_f32_16x16x32_bf16 v[176:179], v[148:151], a[88:91], v[176:179]
    v_mfma_f32_16x16x32_bf16 v[180:183], v[136:139], a[68:71], v[180:183]
    ds_read_b128 v[136:139], v13 offset:3072
    v_mfma_f32_16x16x32_bf16 v[180:183], v[140:143], a[76:79], v[180:183]
    buffer_load_dwordx4 v1, s[56:59], s21 offen offset:1024 sc1 lds
    v_mfma_f32_16x16x32_bf16 v[180:183], v[144:147], a[84:87], v[180:183]
    ds_read_b128 v[140:143], v13 offset:11264
    ds_read_b128 v[144:147], v13 offset:19456
    v_mfma_f32_16x16x32_bf16 v[180:183], v[148:151], a[92:95], v[180:183]
    ds_read_b128 v[148:151], v13 offset:27648
    v_mfma_f32_16x16x32_bf16 v[184:187], v[104:107], a[64:67], v[184:187]
    v_mfma_f32_16x16x32_bf16 v[184:187], v[108:111], a[72:75], v[184:187]
    buffer_load_dwordx4 v1, s[56:59], s21 offen offset:2048 sc1 lds
    v_mfma_f32_16x16x32_bf16 v[184:187], v[112:115], a[80:83], v[184:187]
    v_mfma_f32_16x16x32_bf16 v[184:187], v[116:119], a[88:91], v[184:187]
    v_mfma_f32_16x16x32_bf16 v[188:191], v[104:107], a[68:71], v[188:191]
    ds_read_b128 v[104:107], v13 offset:4096
    v_mfma_f32_16x16x32_bf16 v[188:191], v[108:111], a[76:79], v[188:191]
    buffer_load_dwordx4 a[128:131], v4, s[40:43], s63 offen offset:0 sc1
    v_mfma_f32_16x16x32_bf16 v[188:191], v[112:115], a[84:87], v[188:191]
    ds_read_b128 v[108:111], v13 offset:12288
    ds_read_b128 v[112:115], v13 offset:20480
    v_mfma_f32_16x16x32_bf16 v[188:191], v[116:119], a[92:95], v[188:191]
    s_waitcnt lgkmcnt(3)
    ds_read_b128 v[116:119], v13 offset:28672
    v_mfma_f32_16x16x32_bf16 v[192:195], v[120:123], a[64:67], v[192:195]
    v_mfma_f32_16x16x32_bf16 v[192:195], v[124:127], a[72:75], v[192:195]
    buffer_load_dwordx4 a[136:139], v4, s[40:43], s63 offen offset:1024 sc1
    v_mfma_f32_16x16x32_bf16 v[192:195], v[128:131], a[80:83], v[192:195]
    v_mfma_f32_16x16x32_bf16 v[192:195], v[132:135], a[88:91], v[192:195]
    v_mfma_f32_16x16x32_bf16 v[196:199], v[120:123], a[68:71], v[196:199]
    buffer_load_dwordx4 a[144:147], v4, s[40:43], s63 offen offset:2048 sc1
    v_mfma_f32_16x16x32_bf16 v[196:199], v[124:127], a[76:79], v[196:199]
    ds_read_b128 v[120:123], v13 offset:5120
    ds_read_b128 v[124:127], v13 offset:13312
    v_mfma_f32_16x16x32_bf16 v[196:199], v[128:131], a[84:87], v[196:199]
    ds_read_b128 v[128:131], v13 offset:21504
    v_mfma_f32_16x16x32_bf16 v[196:199], v[132:135], a[92:95], v[196:199]
    ds_read_b128 v[132:135], v13 offset:29696
    v_mfma_f32_16x16x32_bf16 v[200:203], v[136:139], a[64:67], v[200:203]
    buffer_load_dwordx4 a[152:155], v4, s[40:43], s63 offen offset:3072 sc1
    v_mfma_f32_16x16x32_bf16 v[200:203], v[140:143], a[72:75], v[200:203]
    s_xor_b32 s63, s63, 4096
    v_mfma_f32_16x16x32_bf16 v[200:203], v[144:147], a[80:83], v[200:203]
    v_mfma_f32_16x16x32_bf16 v[200:203], v[148:151], a[88:91], v[200:203]
    v_mfma_f32_16x16x32_bf16 v[204:207], v[136:139], a[68:71], v[204:207]
    buffer_load_dwordx4 a[132:135], v5, s[40:43], s20 offen offset:0 sc1
    v_mfma_f32_16x16x32_bf16 v[204:207], v[140:143], a[76:79], v[204:207]
    ds_read_b128 v[136:139], v13 offset:6144
    ds_read_b128 v[140:143], v13 offset:14336
    v_mfma_f32_16x16x32_bf16 v[204:207], v[144:147], a[84:87], v[204:207]
    ds_read_b128 v[144:147], v13 offset:22528
    v_mfma_f32_16x16x32_bf16 v[204:207], v[148:151], a[92:95], v[204:207]
    s_waitcnt lgkmcnt(3)
    ds_read_b128 v[148:151], v13 offset:30720
    v_mfma_f32_16x16x32_bf16 v[208:211], v[104:107], a[64:67], v[208:211]
    buffer_load_dwordx4 a[140:143], v5, s[40:43], s20 offen offset:1024 sc1
    v_mfma_f32_16x16x32_bf16 v[208:211], v[108:111], a[72:75], v[208:211]
    v_mfma_f32_16x16x32_bf16 v[208:211], v[112:115], a[80:83], v[208:211]
    v_mfma_f32_16x16x32_bf16 v[208:211], v[116:119], a[88:91], v[208:211]
    v_mfma_f32_16x16x32_bf16 v[212:215], v[104:107], a[68:71], v[212:215]
    buffer_load_dwordx4 a[148:151], v5, s[40:43], s20 offen offset:2048 sc1
    v_mfma_f32_16x16x32_bf16 v[212:215], v[108:111], a[76:79], v[212:215]
    v_mfma_f32_16x16x32_bf16 v[212:215], v[112:115], a[84:87], v[212:215]
    v_mfma_f32_16x16x32_bf16 v[212:215], v[116:119], a[92:95], v[212:215]
    buffer_load_dwordx4 a[156:159], v5, s[40:43], s20 offen offset:3072 sc1
    v_mfma_f32_16x16x32_bf16 v[216:219], v[120:123], a[64:67], v[216:219]
    s_xor_b32 s21, s3, 5
    v_mfma_f32_16x16x32_bf16 v[216:219], v[124:127], a[72:75], v[216:219]
    s_lshl2_add_u32 s21, s21, s4
    v_mfma_f32_16x16x32_bf16 v[216:219], v[128:131], a[80:83], v[216:219]
    s_mul_i32 s21, s21, 36864
    v_mfma_f32_16x16x32_bf16 v[216:219], v[132:135], a[88:91], v[216:219]
    s_add_u32 s21, s21, s28
    s_mov_b32 m0, s44
    s_waitcnt vmcnt(15)
    s_barrier
    v_mfma_f32_16x16x32_bf16 v[220:223], v[120:123], a[68:71], v[220:223]
    s_xor_b32 s20, s20, 4096
    buffer_load_dwordx4 v1, s[56:59], s21 offen sc1 lds
    v_mfma_f32_16x16x32_bf16 v[220:223], v[124:127], a[76:79], v[220:223]
    v_mov_b32 v31, 3
    ds_read_b128 v[104:107], v6 offset:0
    v_mfma_f32_16x16x32_bf16 v[220:223], v[128:131], a[84:87], v[220:223]
    buffer_store_dword v31, v30, s[32:35], s101 offen sc1
    v_mfma_f32_16x16x32_bf16 v[220:223], v[132:135], a[92:95], v[220:223]
    s_waitcnt lgkmcnt(1)
    ds_read_b128 v[108:111], v6 offset:8192
    ds_read_b128 v[112:115], v6 offset:16384
    v_mfma_f32_16x16x32_bf16 v[224:227], v[136:139], a[64:67], v[224:227]
    buffer_load_dwordx4 v1, s[56:59], s21 offen offset:1024 sc1 lds
    v_mfma_f32_16x16x32_bf16 v[224:227], v[140:143], a[72:75], v[224:227]
    ds_read_b128 v[116:119], v6 offset:24576
    ds_read_b128 v[120:123], v6 offset:1024
    v_mfma_f32_16x16x32_bf16 v[224:227], v[144:147], a[80:83], v[224:227]
    ds_read_b128 v[124:127], v6 offset:9216
    v_mfma_f32_16x16x32_bf16 v[224:227], v[148:151], a[88:91], v[224:227]
    buffer_load_dwordx4 v1, s[56:59], s21 offen offset:2048 sc1 lds
    v_mfma_f32_16x16x32_bf16 v[228:231], v[136:139], a[68:71], v[228:231]
    ds_read_b128 v[128:131], v6 offset:17408
    ds_read_b128 v[132:135], v6 offset:25600
    v_mfma_f32_16x16x32_bf16 v[228:231], v[140:143], a[76:79], v[228:231]
    ds_read_b128 v[136:139], v6 offset:2048
    v_mfma_f32_16x16x32_bf16 v[228:231], v[144:147], a[84:87], v[228:231]
    ds_read_b128 v[140:143], v6 offset:10240
    v_mfma_f32_16x16x32_bf16 v[228:231], v[148:151], a[92:95], v[228:231]
    s_waitcnt lgkmcnt(4)
    buffer_load_dwordx4 v1, s[56:59], s21 offen offset:3072 sc1 lds
    v_mfma_f32_16x16x32_bf16 v[176:179], v[104:107], a[96:99], v[176:179]
    s_add_u32 s21, s21, 4096
    ds_read_b128 v[144:147], v6 offset:18432
    ds_read_b128 v[148:151], v6 offset:26624
    v_mfma_f32_16x16x32_bf16 v[176:179], v[108:111], a[104:107], v[176:179]
    s_add_u32 m0, s44, 4096
    v_mfma_f32_16x16x32_bf16 v[176:179], v[112:115], a[112:115], v[176:179]
    v_mfma_f32_16x16x32_bf16 v[176:179], v[116:119], a[120:123], v[176:179]
    buffer_load_dwordx4 v1, s[56:59], s21 offen sc1 lds
    v_mfma_f32_16x16x32_bf16 v[180:183], v[104:107], a[100:103], v[180:183]
    ds_read_b128 v[104:107], v6 offset:3072
    v_mfma_f32_16x16x32_bf16 v[180:183], v[108:111], a[108:111], v[180:183]
    ds_read_b128 v[108:111], v6 offset:11264
    v_mfma_f32_16x16x32_bf16 v[180:183], v[112:115], a[116:119], v[180:183]
    buffer_load_dwordx4 v1, s[56:59], s21 offen offset:1024 sc1 lds
    v_mfma_f32_16x16x32_bf16 v[180:183], v[116:119], a[124:127], v[180:183]
    ds_read_b128 v[112:115], v6 offset:19456
    ds_read_b128 v[116:119], v6 offset:27648
    v_mfma_f32_16x16x32_bf16 v[184:187], v[120:123], a[96:99], v[184:187]
    v_mfma_f32_16x16x32_bf16 v[184:187], v[124:127], a[104:107], v[184:187]
    s_waitcnt lgkmcnt(3)
    v_mfma_f32_16x16x32_bf16 v[184:187], v[128:131], a[112:115], v[184:187]
    buffer_load_dwordx4 v1, s[56:59], s21 offen offset:2048 sc1 lds
    v_mfma_f32_16x16x32_bf16 v[184:187], v[132:135], a[120:123], v[184:187]
    v_mfma_f32_16x16x32_bf16 v[188:191], v[120:123], a[100:103], v[188:191]
    ds_read_b128 v[120:123], v6 offset:4096
    v_mfma_f32_16x16x32_bf16 v[188:191], v[124:127], a[108:111], v[188:191]
    ds_read_b128 v[124:127], v6 offset:12288
    v_mfma_f32_16x16x32_bf16 v[188:191], v[128:131], a[116:119], v[188:191]
    buffer_load_dwordx4 a[160:163], v4, s[40:43], s63 offen offset:0 sc1
    v_mfma_f32_16x16x32_bf16 v[188:191], v[132:135], a[124:127], v[188:191]
    ds_read_b128 v[128:131], v6 offset:20480
    ds_read_b128 v[132:135], v6 offset:28672
    v_mfma_f32_16x16x32_bf16 v[192:195], v[136:139], a[96:99], v[192:195]
    v_mfma_f32_16x16x32_bf16 v[192:195], v[140:143], a[104:107], v[192:195]
    v_mfma_f32_16x16x32_bf16 v[192:195], v[144:147], a[112:115], v[192:195]
    buffer_load_dwordx4 a[168:171], v4, s[40:43], s63 offen offset:1024 sc1
    v_mfma_f32_16x16x32_bf16 v[192:195], v[148:151], a[120:123], v[192:195]
    v_mfma_f32_16x16x32_bf16 v[196:199], v[136:139], a[100:103], v[196:199]
    ds_read_b128 v[136:139], v6 offset:5120
    v_mfma_f32_16x16x32_bf16 v[196:199], v[140:143], a[108:111], v[196:199]
    buffer_load_dwordx4 a[176:179], v4, s[40:43], s63 offen offset:2048 sc1
    v_mfma_f32_16x16x32_bf16 v[196:199], v[144:147], a[116:119], v[196:199]
    ds_read_b128 v[140:143], v6 offset:13312
    ds_read_b128 v[144:147], v6 offset:21504
    v_mfma_f32_16x16x32_bf16 v[196:199], v[148:151], a[124:127], v[196:199]
    ds_read_b128 v[148:151], v6 offset:29696
    v_mfma_f32_16x16x32_bf16 v[200:203], v[104:107], a[96:99], v[200:203]
    s_waitcnt lgkmcnt(4)
    v_mfma_f32_16x16x32_bf16 v[200:203], v[108:111], a[104:107], v[200:203]
    buffer_load_dwordx4 a[184:187], v4, s[40:43], s63 offen offset:3072 sc1
    v_mfma_f32_16x16x32_bf16 v[200:203], v[112:115], a[112:115], v[200:203]
    s_xor_b32 s63, s63, 12288
    v_mfma_f32_16x16x32_bf16 v[200:203], v[116:119], a[120:123], v[200:203]
    v_mfma_f32_16x16x32_bf16 v[204:207], v[104:107], a[100:103], v[204:207]
    ds_read_b128 v[104:107], v6 offset:6144
    v_mfma_f32_16x16x32_bf16 v[204:207], v[108:111], a[108:111], v[204:207]
    buffer_load_dwordx4 a[164:167], v5, s[40:43], s20 offen offset:0 sc1
    v_mfma_f32_16x16x32_bf16 v[204:207], v[112:115], a[116:119], v[204:207]
    ds_read_b128 v[108:111], v6 offset:14336
    ds_read_b128 v[112:115], v6 offset:22528
    v_mfma_f32_16x16x32_bf16 v[204:207], v[116:119], a[124:127], v[204:207]
    ds_read_b128 v[116:119], v6 offset:30720
    v_mfma_f32_16x16x32_bf16 v[208:211], v[120:123], a[96:99], v[208:211]
    v_mfma_f32_16x16x32_bf16 v[208:211], v[124:127], a[104:107], v[208:211]
    buffer_load_dwordx4 a[172:175], v5, s[40:43], s20 offen offset:1024 sc1
    v_mfma_f32_16x16x32_bf16 v[208:211], v[128:131], a[112:115], v[208:211]
    v_mfma_f32_16x16x32_bf16 v[208:211], v[132:135], a[120:123], v[208:211]
    v_mfma_f32_16x16x32_bf16 v[212:215], v[120:123], a[100:103], v[212:215]
    v_mfma_f32_16x16x32_bf16 v[212:215], v[124:127], a[108:111], v[212:215]
    buffer_load_dwordx4 a[180:183], v5, s[40:43], s20 offen offset:2048 sc1
    v_mfma_f32_16x16x32_bf16 v[212:215], v[128:131], a[116:119], v[212:215]
    v_mfma_f32_16x16x32_bf16 v[212:215], v[132:135], a[124:127], v[212:215]
    s_waitcnt lgkmcnt(0)
    v_mfma_f32_16x16x32_bf16 v[216:219], v[136:139], a[96:99], v[216:219]
    buffer_load_dwordx4 a[188:191], v5, s[40:43], s20 offen offset:3072 sc1
    v_mfma_f32_16x16x32_bf16 v[216:219], v[140:143], a[104:107], v[216:219]
    s_xor_b32 s21, s3, 6
    v_mfma_f32_16x16x32_bf16 v[216:219], v[144:147], a[112:115], v[216:219]
    s_lshl2_add_u32 s21, s21, s4
    v_mfma_f32_16x16x32_bf16 v[216:219], v[148:151], a[120:123], v[216:219]
    s_mul_i32 s21, s21, 36864
    s_waitcnt vmcnt(16)
    s_barrier
    v_mfma_f32_16x16x32_bf16 v[220:223], v[136:139], a[100:103], v[220:223]
    s_add_u32 s21, s21, s28
    s_mov_b32 m0, s45
    ds_read_b128 v[120:123], v7 offset:0
    v_mfma_f32_16x16x32_bf16 v[220:223], v[140:143], a[108:111], v[220:223]
    s_xor_b32 s20, s20, 12288
    buffer_load_dwordx4 v1, s[56:59], s21 offen sc1 lds
    v_mfma_f32_16x16x32_bf16 v[220:223], v[144:147], a[116:119], v[220:223]
    ds_read_b128 v[124:127], v7 offset:8192
    ds_read_b128 v[128:131], v7 offset:16384
    v_mfma_f32_16x16x32_bf16 v[220:223], v[148:151], a[124:127], v[220:223]
    ds_read_b128 v[132:135], v7 offset:24576
    v_mfma_f32_16x16x32_bf16 v[224:227], v[104:107], a[96:99], v[224:227]
    buffer_load_dwordx4 v1, s[56:59], s21 offen offset:1024 sc1 lds
    v_mfma_f32_16x16x32_bf16 v[224:227], v[108:111], a[104:107], v[224:227]
    ds_read_b128 v[136:139], v7 offset:1024
    ds_read_b128 v[140:143], v7 offset:9216
    v_mfma_f32_16x16x32_bf16 v[224:227], v[112:115], a[112:115], v[224:227]
    ds_read_b128 v[144:147], v7 offset:17408
    v_mfma_f32_16x16x32_bf16 v[224:227], v[116:119], a[120:123], v[224:227]
    ds_read_b128 v[148:151], v7 offset:25600
    v_mfma_f32_16x16x32_bf16 v[228:231], v[104:107], a[100:103], v[228:231]
    buffer_load_dwordx4 v1, s[56:59], s21 offen offset:2048 sc1 lds
    v_mfma_f32_16x16x32_bf16 v[228:231], v[108:111], a[108:111], v[228:231]
    ds_read_b128 v[104:107], v7 offset:2048
    ds_read_b128 v[108:111], v7 offset:10240
    v_mfma_f32_16x16x32_bf16 v[228:231], v[112:115], a[116:119], v[228:231]
    ds_read_b128 v[112:115], v7 offset:18432
    v_mfma_f32_16x16x32_bf16 v[228:231], v[116:119], a[124:127], v[228:231]
    s_waitcnt lgkmcnt(4)
    buffer_load_dwordx4 v1, s[56:59], s21 offen offset:3072 sc1 lds
    v_mfma_f32_16x16x32_bf16 v[176:179], v[120:123], a[128:131], v[176:179]
    s_add_u32 s21, s21, 4096
    ds_read_b128 v[116:119], v7 offset:26624
    v_mfma_f32_16x16x32_bf16 v[176:179], v[124:127], a[136:139], v[176:179]
    s_add_u32 m0, s45, 4096
    v_mfma_f32_16x16x32_bf16 v[176:179], v[128:131], a[144:147], v[176:179]
    v_mfma_f32_16x16x32_bf16 v[176:179], v[132:135], a[152:155], v[176:179]
    buffer_load_dwordx4 v1, s[56:59], s21 offen sc1 lds
    v_mfma_f32_16x16x32_bf16 v[180:183], v[120:123], a[132:135], v[180:183]
    ds_read_b128 v[120:123], v7 offset:3072
    v_mfma_f32_16x16x32_bf16 v[180:183], v[124:127], a[140:143], v[180:183]
    ds_read_b128 v[124:127], v7 offset:11264
    v_mfma_f32_16x16x32_bf16 v[180:183], v[128:131], a[148:151], v[180:183]
    ds_read_b128 v[128:131], v7 offset:19456
    v_mfma_f32_16x16x32_bf16 v[180:183], v[132:135], a[156:159], v[180:183]
    buffer_load_dwordx4 v1, s[56:59], s21 offen offset:1024 sc1 lds
    v_mfma_f32_16x16x32_bf16 v[184:187], v[136:139], a[128:131], v[184:187]
    ds_read_b128 v[132:135], v7 offset:27648
    v_mfma_f32_16x16x32_bf16 v[184:187], v[140:143], a[136:139], v[184:187]
    v_mfma_f32_16x16x32_bf16 v[184:187], v[144:147], a[144:147], v[184:187]
    s_waitcnt lgkmcnt(2)
    v_mfma_f32_16x16x32_bf16 v[184:187], v[148:151], a[152:155], v[184:187]
    buffer_load_dwordx4 v1, s[56:59], s21 offen offset:2048 sc1 lds
    v_mfma_f32_16x16x32_bf16 v[188:191], v[136:139], a[132:135], v[188:191]
    ds_read_b128 v[136:139], v7 offset:4096
    v_mfma_f32_16x16x32_bf16 v[188:191], v[140:143], a[140:143], v[188:191]
    ds_read_b128 v[140:143], v7 offset:12288
    v_mfma_f32_16x16x32_bf16 v[188:191], v[144:147], a[148:151], v[188:191]
    ds_read_b128 v[144:147], v7 offset:20480
    v_mfma_f32_16x16x32_bf16 v[188:191], v[148:151], a[156:159], v[188:191]
    buffer_load_dwordx4 a[192:195], v4, s[40:43], s63 offen offset:0 sc1
    v_mfma_f32_16x16x32_bf16 v[192:195], v[104:107], a[128:131], v[192:195]
    ds_read_b128 v[148:151], v7 offset:28672
    v_mfma_f32_16x16x32_bf16 v[192:195], v[108:111], a[136:139], v[192:195]
    v_mfma_f32_16x16x32_bf16 v[192:195], v[112:115], a[144:147], v[192:195]
    buffer_load_dwordx4 a[200:203], v4, s[40:43], s63 offen offset:1024 sc1
    v_mfma_f32_16x16x32_bf16 v[192:195], v[116:119], a[152:155], v[192:195]
    v_mfma_f32_16x16x32_bf16 v[196:199], v[104:107], a[132:135], v[196:199]
    ds_read_b128 v[104:107], v7 offset:5120
    v_mfma_f32_16x16x32_bf16 v[196:199], v[108:111], a[140:143], v[196:199]
    ds_read_b128 v[108:111], v7 offset:13312
    v_mfma_f32_16x16x32_bf16 v[196:199], v[112:115], a[148:151], v[196:199]
    buffer_load_dwordx4 a[208:211], v4, s[40:43], s63 offen offset:2048 sc1
    v_mfma_f32_16x16x32_bf16 v[196:199], v[116:119], a[156:159], v[196:199]
    ds_read_b128 v[112:115], v7 offset:21504
    ds_read_b128 v[116:119], v7 offset:29696
    v_mfma_f32_16x16x32_bf16 v[200:203], v[120:123], a[128:131], v[200:203]
    v_mfma_f32_16x16x32_bf16 v[200:203], v[124:127], a[136:139], v[200:203]
    s_waitcnt lgkmcnt(3)
    v_mfma_f32_16x16x32_bf16 v[200:203], v[128:131], a[144:147], v[200:203]
    buffer_load_dwordx4 a[216:219], v4, s[40:43], s63 offen offset:3072 sc1
    v_mfma_f32_16x16x32_bf16 v[200:203], v[132:135], a[152:155], v[200:203]
    s_xor_b32 s63, s63, 4096
    v_mfma_f32_16x16x32_bf16 v[204:207], v[120:123], a[132:135], v[204:207]
    ds_read_b128 v[120:123], v7 offset:6144
    v_mfma_f32_16x16x32_bf16 v[204:207], v[124:127], a[140:143], v[204:207]
    ds_read_b128 v[124:127], v7 offset:14336
    v_mfma_f32_16x16x32_bf16 v[204:207], v[128:131], a[148:151], v[204:207]
    buffer_load_dwordx4 a[196:199], v5, s[40:43], s20 offen offset:0 sc1
    v_mfma_f32_16x16x32_bf16 v[204:207], v[132:135], a[156:159], v[204:207]
    buffer_load_dword v3, v19, s[32:35], s66 offen sc1
    v_mfma_f32_16x16x32_bf16 v[208:211], v[136:139], a[128:131], v[208:211]
    ds_read_b128 v[128:131], v7 offset:22528
    ds_read_b128 v[132:135], v7 offset:30720
    v_mfma_f32_16x16x32_bf16 v[208:211], v[140:143], a[136:139], v[208:211]
    v_mfma_f32_16x16x32_bf16 v[208:211], v[144:147], a[144:147], v[208:211]
    buffer_load_dwordx4 a[204:207], v5, s[40:43], s20 offen offset:1024 sc1
    v_mfma_f32_16x16x32_bf16 v[208:211], v[148:151], a[152:155], v[208:211]
    v_mfma_f32_16x16x32_bf16 v[212:215], v[136:139], a[132:135], v[212:215]
    v_mfma_f32_16x16x32_bf16 v[212:215], v[140:143], a[140:143], v[212:215]
    buffer_load_dwordx4 a[212:215], v5, s[40:43], s20 offen offset:2048 sc1
    v_mfma_f32_16x16x32_bf16 v[212:215], v[144:147], a[148:151], v[212:215]
    v_mfma_f32_16x16x32_bf16 v[212:215], v[148:151], a[156:159], v[212:215]
    v_mfma_f32_16x16x32_bf16 v[216:219], v[104:107], a[128:131], v[216:219]
    s_waitcnt lgkmcnt(0)
    v_mfma_f32_16x16x32_bf16 v[216:219], v[108:111], a[136:139], v[216:219]
    buffer_load_dwordx4 a[220:223], v5, s[40:43], s20 offen offset:3072 sc1
    v_mfma_f32_16x16x32_bf16 v[216:219], v[112:115], a[144:147], v[216:219]
    s_xor_b32 s21, s3, 7
    v_mfma_f32_16x16x32_bf16 v[216:219], v[116:119], a[152:155], v[216:219]
    s_lshl2_add_u32 s21, s21, s4
    s_waitcnt vmcnt(16)
    s_barrier
    v_mfma_f32_16x16x32_bf16 v[220:223], v[104:107], a[132:135], v[220:223]
    s_mul_i32 s21, s21, 36864
    ds_read_b128 v[136:139], v11 offset:0
    ds_read_b128 v[140:143], v11 offset:8192
    v_mfma_f32_16x16x32_bf16 v[220:223], v[108:111], a[140:143], v[220:223]
    s_add_u32 s21, s21, s28
    s_mov_b32 m0, s46
    ds_read_b128 v[144:147], v11 offset:16384
    v_mfma_f32_16x16x32_bf16 v[220:223], v[112:115], a[148:151], v[220:223]
    s_xor_b32 s20, s20, 4096
    buffer_load_dwordx4 v1, s[56:59], s21 offen sc1 lds
    v_mfma_f32_16x16x32_bf16 v[220:223], v[116:119], a[156:159], v[220:223]
    ds_read_b128 v[148:151], v11 offset:24576
    ds_read_b128 v[104:107], v11 offset:1024
    v_mfma_f32_16x16x32_bf16 v[224:227], v[120:123], a[128:131], v[224:227]
    ds_read_b128 v[108:111], v11 offset:9216
    v_mfma_f32_16x16x32_bf16 v[224:227], v[124:127], a[136:139], v[224:227]
    buffer_load_dwordx4 v1, s[56:59], s21 offen offset:1024 sc1 lds
    v_mfma_f32_16x16x32_bf16 v[224:227], v[128:131], a[144:147], v[224:227]
    ds_read_b128 v[112:115], v11 offset:17408
    ds_read_b128 v[116:119], v11 offset:25600
    v_mfma_f32_16x16x32_bf16 v[224:227], v[132:135], a[152:155], v[224:227]
    v_mfma_f32_16x16x32_bf16 v[228:231], v[120:123], a[132:135], v[228:231]
    ds_read_b128 v[120:123], v11 offset:2048
    v_mfma_f32_16x16x32_bf16 v[228:231], v[124:127], a[140:143], v[228:231]
    buffer_load_dwordx4 v1, s[56:59], s21 offen offset:2048 sc1 lds
    v_mfma_f32_16x16x32_bf16 v[228:231], v[128:131], a[148:151], v[228:231]
    ds_read_b128 v[124:127], v11 offset:10240
    ds_read_b128 v[128:131], v11 offset:18432
    v_mfma_f32_16x16x32_bf16 v[228:231], v[132:135], a[156:159], v[228:231]
    s_waitcnt lgkmcnt(3)
    ds_read_b128 v[132:135], v11 offset:26624
    v_mfma_f32_16x16x32_bf16 v[176:179], v[136:139], a[160:163], v[176:179]
    buffer_load_dwordx4 v1, s[56:59], s21 offen offset:3072 sc1 lds
    v_mfma_f32_16x16x32_bf16 v[176:179], v[140:143], a[168:171], v[176:179]
    s_add_u32 s21, s21, 4096
    v_mfma_f32_16x16x32_bf16 v[176:179], v[144:147], a[176:179], v[176:179]
    s_add_u32 m0, s46, 4096
    v_mfma_f32_16x16x32_bf16 v[176:179], v[148:151], a[184:187], v[176:179]
    v_mfma_f32_16x16x32_bf16 v[180:183], v[136:139], a[164:167], v[180:183]
    buffer_load_dwordx4 v1, s[56:59], s21 offen sc1 lds
    v_mfma_f32_16x16x32_bf16 v[180:183], v[140:143], a[172:175], v[180:183]
    ds_read_b128 v[136:139], v11 offset:3072
    ds_read_b128 v[140:143], v11 offset:11264
    v_mfma_f32_16x16x32_bf16 v[180:183], v[144:147], a[180:183], v[180:183]
    ds_read_b128 v[144:147], v11 offset:19456
    v_mfma_f32_16x16x32_bf16 v[180:183], v[148:151], a[188:191], v[180:183]
    ds_read_b128 v[148:151], v11 offset:27648
    v_mfma_f32_16x16x32_bf16 v[184:187], v[104:107], a[160:163], v[184:187]
    buffer_load_dwordx4 v1, s[56:59], s21 offen offset:1024 sc1 lds
    v_mfma_f32_16x16x32_bf16 v[184:187], v[108:111], a[168:171], v[184:187]
    v_mfma_f32_16x16x32_bf16 v[184:187], v[112:115], a[176:179], v[184:187]
    v_mfma_f32_16x16x32_bf16 v[184:187], v[116:119], a[184:187], v[184:187]
    v_mfma_f32_16x16x32_bf16 v[188:191], v[104:107], a[164:167], v[188:191]
    buffer_load_dwordx4 v1, s[56:59], s21 offen offset:2048 sc1 lds
    v_mfma_f32_16x16x32_bf16 v[188:191], v[108:111], a[172:175], v[188:191]
    ds_read_b128 v[104:107], v11 offset:4096
    ds_read_b128 v[108:111], v11 offset:12288
    v_mfma_f32_16x16x32_bf16 v[188:191], v[112:115], a[180:183], v[188:191]
    ds_read_b128 v[112:115], v11 offset:20480
    v_mfma_f32_16x16x32_bf16 v[188:191], v[116:119], a[188:191], v[188:191]
    s_waitcnt lgkmcnt(3)
    ds_read_b128 v[116:119], v11 offset:28672
    v_mfma_f32_16x16x32_bf16 v[192:195], v[120:123], a[160:163], v[192:195]
    buffer_load_dwordx4 a[224:227], v4, s[40:43], s63 offen offset:0 sc1
    v_mfma_f32_16x16x32_bf16 v[192:195], v[124:127], a[168:171], v[192:195]
    v_mfma_f32_16x16x32_bf16 v[192:195], v[128:131], a[176:179], v[192:195]
    v_mfma_f32_16x16x32_bf16 v[192:195], v[132:135], a[184:187], v[192:195]
    buffer_load_dwordx4 a[232:235], v4, s[40:43], s63 offen offset:1024 sc1
    v_mfma_f32_16x16x32_bf16 v[196:199], v[120:123], a[164:167], v[196:199]
    ds_read_b128 v[120:123], v11 offset:5120
    v_mfma_f32_16x16x32_bf16 v[196:199], v[124:127], a[172:175], v[196:199]
    ds_read_b128 v[124:127], v11 offset:13312
    v_mfma_f32_16x16x32_bf16 v[196:199], v[128:131], a[180:183], v[196:199]
    ds_read_b128 v[128:131], v11 offset:21504
    v_mfma_f32_16x16x32_bf16 v[196:199], v[132:135], a[188:191], v[196:199]
    buffer_load_dwordx4 a[240:243], v4, s[40:43], s63 offen offset:2048 sc1
    v_mfma_f32_16x16x32_bf16 v[200:203], v[136:139], a[160:163], v[200:203]
    ds_read_b128 v[132:135], v11 offset:29696
    v_mfma_f32_16x16x32_bf16 v[200:203], v[140:143], a[168:171], v[200:203]
    v_mfma_f32_16x16x32_bf16 v[200:203], v[144:147], a[176:179], v[200:203]
    v_mfma_f32_16x16x32_bf16 v[200:203], v[148:151], a[184:187], v[200:203]
    buffer_load_dwordx4 a[248:251], v4, s[40:43], s63 offen offset:3072 sc1
    v_mfma_f32_16x16x32_bf16 v[204:207], v[136:139], a[164:167], v[204:207]
    s_sub_u32 s63, s63, 4096
    ds_read_b128 v[136:139], v11 offset:6144
    v_mfma_f32_16x16x32_bf16 v[204:207], v[140:143], a[172:175], v[204:207]
    ds_read_b128 v[140:143], v11 offset:14336
    v_mfma_f32_16x16x32_bf16 v[204:207], v[144:147], a[180:183], v[204:207]
    ds_read_b128 v[144:147], v11 offset:22528
    v_mfma_f32_16x16x32_bf16 v[204:207], v[148:151], a[188:191], v[204:207]
    s_waitcnt lgkmcnt(3)
    buffer_load_dwordx4 a[228:231], v5, s[40:43], s20 offen offset:0 sc1
    v_mfma_f32_16x16x32_bf16 v[208:211], v[104:107], a[160:163], v[208:211]
    ds_read_b128 v[148:151], v11 offset:30720
    v_mfma_f32_16x16x32_bf16 v[208:211], v[108:111], a[168:171], v[208:211]
    v_mfma_f32_16x16x32_bf16 v[208:211], v[112:115], a[176:179], v[208:211]
    v_mfma_f32_16x16x32_bf16 v[208:211], v[116:119], a[184:187], v[208:211]
    buffer_load_dwordx4 a[236:239], v5, s[40:43], s20 offen offset:1024 sc1
    v_mfma_f32_16x16x32_bf16 v[212:215], v[104:107], a[164:167], v[212:215]
    v_mfma_f32_16x16x32_bf16 v[212:215], v[108:111], a[172:175], v[212:215]
    v_mfma_f32_16x16x32_bf16 v[212:215], v[112:115], a[180:183], v[212:215]
    buffer_load_dwordx4 a[244:247], v5, s[40:43], s20 offen offset:2048 sc1
    v_mfma_f32_16x16x32_bf16 v[212:215], v[116:119], a[188:191], v[212:215]
    v_mfma_f32_16x16x32_bf16 v[216:219], v[120:123], a[160:163], v[216:219]
    v_mfma_f32_16x16x32_bf16 v[216:219], v[124:127], a[168:171], v[216:219]
    v_mfma_f32_16x16x32_bf16 v[216:219], v[128:131], a[176:179], v[216:219]
    buffer_load_dwordx4 a[252:255], v5, s[40:43], s20 offen offset:3072 sc1
    v_mfma_f32_16x16x32_bf16 v[216:219], v[132:135], a[184:187], v[216:219]
    s_mul_i32 s21, s61, 6
    s_add_u32 s21, s21, 132
    s_waitcnt vmcnt(15)
    v_cmp_gt_u32 vcc, 3, v3
    s_nop 1
    s_and_b64 vcc, vcc, exec
    s_cbranch_scc1 SPIN_OA
BACK_OA:
    s_barrier
    v_mfma_f32_16x16x32_bf16 v[220:223], v[120:123], a[164:167], v[220:223]
    s_mul_i32 s21, s21, 36864
    ds_read_b128 v[104:107], v12 offset:0
    ds_read_b128 v[108:111], v12 offset:8192
    v_mfma_f32_16x16x32_bf16 v[220:223], v[124:127], a[172:175], v[220:223]
    s_add_u32 s21, s21, s28
    ds_read_b128 v[112:115], v12 offset:16384
    v_mfma_f32_16x16x32_bf16 v[220:223], v[128:131], a[180:183], v[220:223]
    s_add_u32 s21, s21, s67
    s_mov_b32 m0, s47
    ds_read_b128 v[116:119], v12 offset:24576
    v_mfma_f32_16x16x32_bf16 v[220:223], v[132:135], a[188:191], v[220:223]
    s_sub_u32 s20, s20, 4096
    buffer_load_dwordx4 v1, s[56:59], s21 offen sc1 lds
    s_waitcnt lgkmcnt(4)
    v_mfma_f32_16x16x32_bf16 v[224:227], v[136:139], a[160:163], v[224:227]
    ds_read_b128 v[120:123], v12 offset:1024
    ds_read_b128 v[124:127], v12 offset:9216
    v_mfma_f32_16x16x32_bf16 v[224:227], v[140:143], a[168:171], v[224:227]
    ds_read_b128 v[128:131], v12 offset:17408
    v_mfma_f32_16x16x32_bf16 v[224:227], v[144:147], a[176:179], v[224:227]
    buffer_load_dwordx4 v1, s[56:59], s21 offen offset:1024 sc1 lds
    v_mfma_f32_16x16x32_bf16 v[224:227], v[148:151], a[184:187], v[224:227]
    s_mul_i32 s63, s61, 6144
    ds_read_b128 v[132:135], v12 offset:25600
    v_mfma_f32_16x16x32_bf16 v[228:231], v[136:139], a[164:167], v[228:231]
    s_add_u32 s63, s63, 135168
    ds_read_b128 v[136:139], v12 offset:2048
    v_mfma_f32_16x16x32_bf16 v[228:231], v[140:143], a[172:175], v[228:231]
    ds_read_b128 v[140:143], v12 offset:10240
    v_mfma_f32_16x16x32_bf16 v[228:231], v[144:147], a[180:183], v[228:231]
    buffer_load_dwordx4 v[64:67], v4, s[40:43], s63 offen offset:0 sc1
    v_mfma_f32_16x16x32_bf16 v[228:231], v[148:151], a[188:191], v[228:231]
    s_waitcnt lgkmcnt(3)
    ds_read_b128 v[144:147], v12 offset:18432
    ds_read_b128 v[148:151], v12 offset:26624
    v_mfma_f32_16x16x32_bf16 v[176:179], v[104:107], a[192:195], v[176:179]
    v_mfma_f32_16x16x32_bf16 v[176:179], v[108:111], a[200:203], v[176:179]
    buffer_load_dwordx4 v[68:71], v4, s[40:43], s63 offen offset:1024 sc1
    v_mfma_f32_16x16x32_bf16 v[176:179], v[112:115], a[208:211], v[176:179]
    s_mul_i32 s20, s61, 6144
    v_mfma_f32_16x16x32_bf16 v[176:179], v[116:119], a[216:219], v[176:179]
    s_add_u32 s20, s20, 135168
    v_mfma_f32_16x16x32_bf16 v[180:183], v[104:107], a[196:199], v[180:183]
    s_sub_u32 s63, s63, 4096
    ds_read_b128 v[104:107], v12 offset:3072
    v_mfma_f32_16x16x32_bf16 v[180:183], v[108:111], a[204:207], v[180:183]
    buffer_load_dwordx4 v[72:75], v5, s[40:43], s20 offen offset:0 sc1
    v_mfma_f32_16x16x32_bf16 v[180:183], v[112:115], a[212:215], v[180:183]
    ds_read_b128 v[108:111], v12 offset:11264
    ds_read_b128 v[112:115], v12 offset:19456
    v_mfma_f32_16x16x32_bf16 v[180:183], v[116:119], a[220:223], v[180:183]
    ds_read_b128 v[116:119], v12 offset:27648
    v_mfma_f32_16x16x32_bf16 v[184:187], v[120:123], a[192:195], v[184:187]
    v_mfma_f32_16x16x32_bf16 v[184:187], v[124:127], a[200:203], v[184:187]
    buffer_load_dwordx4 v[76:79], v5, s[40:43], s20 offen offset:1024 sc1
    v_mfma_f32_16x16x32_bf16 v[184:187], v[128:131], a[208:211], v[184:187]
    s_mul_i32 s21, s61, 6
    s_add_u32 s21, s4, s21
    s_waitcnt lgkmcnt(3)
    v_mfma_f32_16x16x32_bf16 v[184:187], v[132:135], a[216:219], v[184:187]
    s_add_u32 s21, s21, 128
    v_mfma_f32_16x16x32_bf16 v[188:191], v[120:123], a[196:199], v[188:191]
    s_mul_i32 s21, s21, 36864
    ds_read_b128 v[120:123], v12 offset:4096
    v_mfma_f32_16x16x32_bf16 v[188:191], v[124:127], a[204:207], v[188:191]
    s_add_u32 s21, s21, s28
    s_mov_b32 m0, s79
    ds_read_b128 v[124:127], v12 offset:12288
    v_mfma_f32_16x16x32_bf16 v[188:191], v[128:131], a[212:215], v[188:191]
    s_sub_u32 s20, s20, 4096
    buffer_load_dwordx4 v1, s[56:59], s21 offen sc1 lds
    v_mfma_f32_16x16x32_bf16 v[188:191], v[132:135], a[220:223], v[188:191]
    ds_read_b128 v[128:131], v12 offset:20480
    ds_read_b128 v[132:135], v12 offset:28672
    v_mfma_f32_16x16x32_bf16 v[192:195], v[136:139], a[192:195], v[192:195]
    v_mfma_f32_16x16x32_bf16 v[192:195], v[140:143], a[200:203], v[192:195]
    buffer_load_dwordx4 v1, s[56:59], s21 offen offset:1024 sc1 lds
    v_mfma_f32_16x16x32_bf16 v[192:195], v[144:147], a[208:211], v[192:195]
    v_mfma_f32_16x16x32_bf16 v[192:195], v[148:151], a[216:219], v[192:195]
    v_mfma_f32_16x16x32_bf16 v[196:199], v[136:139], a[196:199], v[196:199]
    buffer_load_dwordx4 v1, s[56:59], s21 offen offset:2048 sc1 lds
    v_mfma_f32_16x16x32_bf16 v[196:199], v[140:143], a[204:207], v[196:199]
    ds_read_b128 v[136:139], v12 offset:5120
    ds_read_b128 v[140:143], v12 offset:13312
    v_mfma_f32_16x16x32_bf16 v[196:199], v[144:147], a[212:215], v[196:199]
    ds_read_b128 v[144:147], v12 offset:21504
    v_mfma_f32_16x16x32_bf16 v[196:199], v[148:151], a[220:223], v[196:199]
    ds_read_b128 v[148:151], v12 offset:29696
    v_mfma_f32_16x16x32_bf16 v[200:203], v[104:107], a[192:195], v[200:203]
    s_waitcnt lgkmcnt(4)
    buffer_load_dwordx4 v1, s[56:59], s21 offen offset:3072 sc1 lds
    v_mfma_f32_16x16x32_bf16 v[200:203], v[108:111], a[200:203], v[200:203]
    s_add_u32 s21, s21, 4096
    v_mfma_f32_16x16x32_bf16 v[200:203], v[112:115], a[208:211], v[200:203]
    s_add_u32 m0, s79, 4096
    v_mfma_f32_16x16x32_bf16 v[200:203], v[116:119], a[216:219], v[200:203]
    v_mfma_f32_16x16x32_bf16 v[204:207], v[104:107], a[196:199], v[204:207]
    buffer_load_dwordx4 v1, s[56:59], s21 offen sc1 lds
    v_mfma_f32_16x16x32_bf16 v[204:207], v[108:111], a[204:207], v[204:207]
    ds_read_b128 v[104:107], v12 offset:6144
    ds_read_b128 v[108:111], v12 offset:14336
    v_mfma_f32_16x16x32_bf16 v[204:207], v[112:115], a[212:215], v[204:207]
    ds_read_b128 v[112:115], v12 offset:22528
    v_mfma_f32_16x16x32_bf16 v[204:207], v[116:119], a[220:223], v[204:207]
    ds_read_b128 v[116:119], v12 offset:30720
    v_mfma_f32_16x16x32_bf16 v[208:211], v[120:123], a[192:195], v[208:211]
    buffer_load_dwordx4 v1, s[56:59], s21 offen offset:1024 sc1 lds
    v_mfma_f32_16x16x32_bf16 v[208:211], v[124:127], a[200:203], v[208:211]
    v_mfma_f32_16x16x32_bf16 v[208:211], v[128:131], a[208:211], v[208:211]
    v_mfma_f32_16x16x32_bf16 v[208:211], v[132:135], a[216:219], v[208:211]
    v_mfma_f32_16x16x32_bf16 v[212:215], v[120:123], a[196:199], v[212:215]
    buffer_load_dwordx4 v1, s[56:59], s21 offen offset:2048 sc1 lds
    v_mfma_f32_16x16x32_bf16 v[212:215], v[124:127], a[204:207], v[212:215]
    v_mfma_f32_16x16x32_bf16 v[212:215], v[128:131], a[212:215], v[212:215]
    v_mfma_f32_16x16x32_bf16 v[212:215], v[132:135], a[220:223], v[212:215]
    s_waitcnt lgkmcnt(0)
    buffer_load_dwordx4 v[32:35], v4, s[40:43], s63 offen offset:0 sc1
    v_mfma_f32_16x16x32_bf16 v[216:219], v[136:139], a[192:195], v[216:219]
    v_mfma_f32_16x16x32_bf16 v[216:219], v[140:143], a[200:203], v[216:219]
    v_mfma_f32_16x16x32_bf16 v[216:219], v[144:147], a[208:211], v[216:219]
    s_add_u32 s23, s5, 8
    v_lshrrev_b32 v19, 4, v1
    v_min_u32 v19, 2, v19
    v_mfma_f32_16x16x32_bf16 v[216:219], v[148:151], a[216:219], v[216:219]
    s_waitcnt vmcnt(14)
    s_barrier
    ds_read_b128 v[120:123], v13 offset:0
    v_mfma_f32_16x16x32_bf16 v[220:223], v[136:139], a[196:199], v[220:223]
    s_and_b32 s65, s5, 3
    buffer_load_dwordx4 v[40:43], v4, s[40:43], s63 offen offset:1024 sc1
    v_mfma_f32_16x16x32_bf16 v[220:223], v[140:143], a[204:207], v[220:223]
    s_mul_i32 s70, s4, 3072
    ds_read_b128 v[124:127], v13 offset:8192
    ds_read_b128 v[128:131], v13 offset:16384
    v_mfma_f32_16x16x32_bf16 v[220:223], v[144:147], a[212:215], v[220:223]
    s_andn2_b32 s66, s74, 0xfff
    ds_read_b128 v[132:135], v13 offset:24576
    v_lshl_add_u32 v19, v19, 3, s23
    v_mfma_f32_16x16x32_bf16 v[220:223], v[148:151], a[220:223], v[220:223]
    s_lshl3_add_u32 s23, s6, s62
    buffer_load_dwordx4 v[48:51], v4, s[40:43], s63 offen offset:2048 sc1
    v_mfma_f32_16x16x32_bf16 v[224:227], v[104:107], a[192:195], v[224:227]
    s_lshl_b32 s23, s23, 4
    ds_read_b128 v[136:139], v13 offset:1024
    ds_read_b128 v[140:143], v13 offset:9216
    v_mfma_f32_16x16x32_bf16 v[224:227], v[108:111], a[200:203], v[224:227]
    ds_read_b128 v[144:147], v13 offset:17408
    v_bfe_u32 v20, v1, 4, 4
    v_mfma_f32_16x16x32_bf16 v[224:227], v[112:115], a[208:211], v[224:227]
    ds_read_b128 v[148:151], v13 offset:25600
    v_add_u32 v20, s23, v20
    v_mfma_f32_16x16x32_bf16 v[224:227], v[116:119], a[216:219], v[224:227]
    s_mul_i32 s23, s6, 294912
    buffer_load_dwordx4 v[56:59], v4, s[40:43], s63 offen offset:3072 sc1
    v_mfma_f32_16x16x32_bf16 v[228:231], v[104:107], a[196:199], v[228:231]
    s_sub_u32 s63, s63, 4096
    ds_read_b128 v[104:107], v13 offset:2048
    v_mul_u32_u24 v20, 1152, v20
    v_mfma_f32_16x16x32_bf16 v[228:231], v[108:111], a[204:207], v[228:231]
    s_sub_u32 s23, 2211840, s23
    ds_read_b128 v[108:111], v13 offset:10240
    v_lshrrev_b32 v21, 8, v1
    v_mfma_f32_16x16x32_bf16 v[228:231], v[112:115], a[212:215], v[228:231]
    ds_read_b128 v[112:115], v13 offset:18432
    v_lshl_add_u32 v20, v21, 3, v20
    v_mfma_f32_16x16x32_bf16 v[228:231], v[116:119], a[220:223], v[228:231]
    s_waitcnt lgkmcnt(3)
    buffer_load_dwordx4 v[36:39], v5, s[40:43], s20 offen offset:0 sc1
    v_mfma_f32_16x16x32_bf16 v[176:179], v[120:123], a[224:227], v[176:179]
    ds_read_b128 v[116:119], v13 offset:26624
    v_add_u32 v21, s23, v20
    v_mfma_f32_16x16x32_bf16 v[176:179], v[124:127], a[232:235], v[176:179]
    s_mul_i32 s23, s101, 288
    v_and_b32 v19, 31, v19
    v_mov_b32 v31, 3
    v_mfma_f32_16x16x32_bf16 v[176:179], v[128:131], a[240:243], v[176:179]
    s_add_u32 s23, s23, s70
    buffer_load_dwordx4 v[44:47], v5, s[40:43], s20 offen offset:1024 sc1
    v_mfma_f32_16x16x32_bf16 v[176:179], v[132:135], a[248:251], v[176:179]
    s_add_u32 s98, s23, 0
    v_lshlrev_b32 v23, 20, v1
    v_lshlrev_b32 v19, 7, v19
    v_mfma_f32_16x16x32_bf16 v[180:183], v[120:123], a[228:231], v[180:183]
    ds_read_b128 v[120:123], v13 offset:3072
    v_bfe_u32 v92, v1, 6, 2
    v_mfma_f32_16x16x32_bf16 v[180:183], v[124:127], a[236:239], v[180:183]
    ds_read_b128 v[124:127], v13 offset:11264
    v_lshrrev_b32 v93, 8, v1
    v_mfma_f32_16x16x32_bf16 v[180:183], v[128:131], a[244:247], v[180:183]
    buffer_load_dwordx4 v[52:55], v5, s[40:43], s20 offen offset:2048 sc1
    v_mfma_f32_16x16x32_bf16 v[180:183], v[132:135], a[252:255], v[180:183]
    ds_read_b128 v[128:131], v13 offset:19456
    ds_read_b128 v[132:135], v13 offset:27648
    v_mfma_f32_16x16x32_bf16 v[184:187], v[136:139], a[224:227], v[184:187]
    v_cmp_eq_u32 vcc, v92, v93
    v_and_b32 v92, 16, v1
    v_mfma_f32_16x16x32_bf16 v[184:187], v[140:143], a[232:235], v[184:187]
    v_mov_b32 v93, 0x3f80
    v_lshlrev_b32 v92, v92, v93
    v_mfma_f32_16x16x32_bf16 v[184:187], v[144:147], a[240:243], v[184:187]
    buffer_load_dwordx4 v[60:63], v5, s[40:43], s20 offen offset:3072 sc1
    v_mfma_f32_16x16x32_bf16 v[184:187], v[148:151], a[248:251], v[184:187]
    s_add_u32 s21, s4, 0
    s_xor_b32 s21, s21, s3
    s_lshl_b32 s21, s21, 2
    v_mfma_f32_16x16x32_bf16 v[188:191], v[136:139], a[228:231], v[188:191]
    s_mul_i32 s21, s21, 36864
    ds_read_b128 v[136:139], v13 offset:4096
    v_and_b32 v93, 32, v1
    v_mfma_f32_16x16x32_bf16 v[188:191], v[140:143], a[236:239], v[188:191]
    s_add_u32 s21, s21, s28
    ds_read_b128 v[140:143], v13 offset:12288
    v_cndmask_b32 v92, 0, v92, vcc
    v_mfma_f32_16x16x32_bf16 v[188:191], v[144:147], a[244:247], v[188:191]
    s_add_u32 s21, s21, 7168
    s_add_u32 m0, s44, 0
    ds_read_b128 v[144:147], v13 offset:20480
    v_mfma_f32_16x16x32_bf16 v[188:191], v[148:151], a[252:255], v[188:191]
    s_sub_u32 s20, s20, 4096
    buffer_load_dwordx4 v1, s[56:59], s21 offen sc1 lds
    s_waitcnt lgkmcnt(3)
    v_mfma_f32_16x16x32_bf16 v[192:195], v[104:107], a[224:227], v[192:195]
    ds_read_b128 v[148:151], v13 offset:28672
    v_cmp_eq_u32 vcc, 0, v93
    v_mfma_f32_16x16x32_bf16 v[192:195], v[108:111], a[232:235], v[192:195]
    v_mov_b32 v98, 0
    v_cndmask_b32 v96, 0, v92, vcc
    v_mfma_f32_16x16x32_bf16 v[192:195], v[112:115], a[240:243], v[192:195]
    buffer_load_dwordx4 v1, s[56:59], s21 offen offset:1024 sc1 lds
    v_mfma_f32_16x16x32_bf16 v[192:195], v[116:119], a[248:251], v[192:195]
    s_add_u32 s21, s21, 36864
    v_cndmask_b32_e64 v97, v92, 0, vcc
    v_mov_b32 v99, 0
    v_mfma_f32_16x16x32_bf16 v[196:199], v[104:107], a[228:231], v[196:199]
    s_add_u32 m0, s44, 2048
    ds_read_b128 v[104:107], v13 offset:5120
    v_mov_b32 v100, v96
    v_mfma_f32_16x16x32_bf16 v[196:199], v[108:111], a[236:239], v[196:199]
    buffer_load_dwordx4 v1, s[56:59], s21 offen sc1 lds
    v_mfma_f32_16x16x32_bf16 v[196:199], v[112:115], a[244:247], v[196:199]
    ds_read_b128 v[108:111], v13 offset:13312
    ds_read_b128 v[112:115], v13 offset:21504
    v_mfma_f32_16x16x32_bf16 v[196:199], v[116:119], a[252:255], v[196:199]
    ds_read_b128 v[116:119], v13 offset:29696
    v_mov_b32 v101, v97
    v_mfma_f32_16x16x32_bf16 v[200:203], v[120:123], a[224:227], v[200:203]
    v_mfma_f32_16x16x32_bf16 v[200:203], v[124:127], a[232:235], v[200:203]
    buffer_load_dwordx4 v1, s[56:59], s21 offen offset:1024 sc1 lds
    v_mfma_f32_16x16x32_bf16 v[200:203], v[128:131], a[240:243], v[200:203]
    s_add_u32 s21, s21, 36864
    v_mfma_f32_16x16x32_bf16 v[200:203], v[132:135], a[248:251], v[200:203]
    s_add_u32 m0, s44, 4096
    v_mfma_f32_16x16x32_bf16 v[204:207], v[120:123], a[228:231], v[204:207]
    ds_read_b128 v[120:123], v13 offset:6144
    v_mfma_f32_16x16x32_bf16 v[204:207], v[124:127], a[236:239], v[204:207]
    buffer_load_dwordx4 v1, s[56:59], s21 offen sc1 lds
    v_mfma_f32_16x16x32_bf16 v[204:207], v[128:131], a[244:247], v[204:207]
    ds_read_b128 v[124:127], v13 offset:14336
    ds_read_b128 v[128:131], v13 offset:22528
    v_mfma_f32_16x16x32_bf16 v[204:207], v[132:135], a[252:255], v[204:207]
    s_waitcnt lgkmcnt(3)
    ds_read_b128 v[132:135], v13 offset:30720
    v_mfma_f32_16x16x32_bf16 v[208:211], v[136:139], a[224:227], v[208:211]
    v_mfma_f32_16x16x32_bf16 v[208:211], v[140:143], a[232:235], v[208:211]
    buffer_load_dwordx4 v1, s[56:59], s21 offen offset:1024 sc1 lds
    v_mfma_f32_16x16x32_bf16 v[208:211], v[144:147], a[240:243], v[208:211]
    s_add_u32 s21, s21, 36864
    v_mfma_f32_16x16x32_bf16 v[208:211], v[148:151], a[248:251], v[208:211]
    s_add_u32 m0, s44, 6144
    v_mfma_f32_16x16x32_bf16 v[212:215], v[136:139], a[228:231], v[212:215]
    buffer_load_dwordx4 v1, s[56:59], s21 offen sc1 lds
    v_mfma_f32_16x16x32_bf16 v[212:215], v[140:143], a[236:239], v[212:215]
    v_mfma_f32_16x16x32_bf16 v[212:215], v[144:147], a[244:247], v[212:215]
    v_mfma_f32_16x16x32_bf16 v[212:215], v[148:151], a[252:255], v[212:215]
    v_mfma_f32_16x16x32_bf16 v[216:219], v[104:107], a[224:227], v[216:219]
    buffer_load_dwordx4 v1, s[56:59], s21 offen offset:1024 sc1 lds
    v_mfma_f32_16x16x32_bf16 v[216:219], v[108:111], a[232:235], v[216:219]
    s_add_u32 s21, s21, 36864
    s_add_u32 s21, s4, 4
    s_xor_b32 s21, s21, s3
    v_mfma_f32_16x16x32_bf16 v[216:219], v[112:115], a[240:243], v[216:219]
    s_lshl_b32 s21, s21, 2
    s_mul_i32 s21, s21, 36864
    v_mfma_f32_16x16x32_bf16 v[216:219], v[116:119], a[248:251], v[216:219]
    s_waitcnt vmcnt(16)
    s_barrier
    s_add_u32 s21, s21, s28
    v_mfma_f32_16x16x32_bf16 v[220:223], v[104:107], a[228:231], v[220:223]
    s_add_u32 s21, s21, 7168
    s_add_u32 m0, s45, 0
    ds_read_b128 v[136:139], v6 offset:0
    v_mfma_f32_16x16x32_bf16 v[220:223], v[108:111], a[236:239], v[220:223]
    buffer_load_dwordx4 v1, s[56:59], s21 offen sc1 lds
    v_mfma_f32_16x16x32_bf16 v[220:223], v[112:115], a[244:247], v[220:223]
    ds_read_b128 v[140:143], v6 offset:1024
    ds_read_b128 v[144:147], v6 offset:8192
    v_mfma_f32_16x16x32_bf16 v[220:223], v[116:119], a[252:255], v[220:223]
    s_waitcnt lgkmcnt(3)
    ds_read_b128 v[148:151], v6 offset:9216
    v_mfma_f32_16x16x32_bf16 v[224:227], v[120:123], a[224:227], v[224:227]
    buffer_load_dwordx4 v1, s[56:59], s21 offen offset:1024 sc1 lds
    v_mfma_f32_16x16x32_bf16 v[224:227], v[124:127], a[232:235], v[224:227]
    s_add_u32 s21, s21, 36864
    ds_read_b128 v[104:107], v6 offset:16384
    ds_read_b128 v[108:111], v6 offset:17408
    v_mfma_f32_16x16x32_bf16 v[224:227], v[128:131], a[240:243], v[224:227]
    s_add_u32 m0, s45, 2048
    ds_read_b128 v[112:115], v6 offset:24576
    v_mfma_f32_16x16x32_bf16 v[224:227], v[132:135], a[248:251], v[224:227]
    ds_read_b128 v[116:119], v7 offset:0
    v_mfma_f32_16x16x32_bf16 v[228:231], v[120:123], a[228:231], v[228:231]
    buffer_load_dwordx4 v1, s[56:59], s21 offen sc1 lds
    v_mfma_f32_16x16x32_bf16 v[228:231], v[124:127], a[236:239], v[228:231]
    ds_read_b128 v[120:123], v7 offset:8192
    ds_read_b128 v[124:127], v7 offset:16384
    v_mfma_f32_16x16x32_bf16 v[228:231], v[128:131], a[244:247], v[228:231]
    ds_read_b128 v[128:131], v7 offset:24576
    v_mfma_f32_16x16x32_bf16 v[228:231], v[132:135], a[252:255], v[228:231]
    s_waitcnt lgkmcnt(4)
    buffer_load_dwordx4 v1, s[56:59], s21 offen offset:1024 sc1 lds
    v_smfmac_f32_16x16x64_bf16 v[176:179], v[136:139], v[64:71], v16
    s_add_u32 s21, s21, 36864
    ds_read_b128 v[132:135], v7 offset:1024
    v_smfmac_f32_16x16x64_bf16 v[180:183], v[136:139], v[72:79], v16
    s_add_u32 m0, s45, 4096
    ds_read_b128 v[136:139], v7 offset:9216
    v_smfmac_f32_16x16x64_bf16 v[184:187], v[140:143], v[64:71], v16
    v_smfmac_f32_16x16x64_bf16 v[188:191], v[140:143], v[72:79], v16
    buffer_load_dwordx4 v1, s[56:59], s21 offen sc1 lds
    v_smfmac_f32_16x16x64_bf16 v[192:195], v[144:147], v[64:71], v16
    ds_read_b128 v[140:143], v7 offset:17408
    v_smfmac_f32_16x16x64_bf16 v[196:199], v[144:147], v[72:79], v16
    ds_read_b128 v[144:147], v7 offset:25600
    v_smfmac_f32_16x16x64_bf16 v[200:203], v[148:151], v[64:71], v16
    v_smfmac_f32_16x16x64_bf16 v[204:207], v[148:151], v[72:79], v16
    buffer_load_dwordx4 v1, s[56:59], s21 offen offset:1024 sc1 lds
    v_smfmac_f32_16x16x64_bf16 v[208:211], v[104:107], v[64:71], v16
    s_add_u32 s21, s21, 36864
    ds_read_b128 v[148:151], v7 offset:2048
    v_smfmac_f32_16x16x64_bf16 v[212:215], v[104:107], v[72:79], v16
    s_add_u32 m0, s45, 6144
    ds_read_b128 v[104:107], v7 offset:10240
    v_smfmac_f32_16x16x64_bf16 v[216:219], v[108:111], v[64:71], v16
    v_smfmac_f32_16x16x64_bf16 v[220:223], v[108:111], v[72:79], v16
    buffer_load_dwordx4 v1, s[56:59], s21 offen sc1 lds
    v_smfmac_f32_16x16x64_bf16 v[224:227], v[112:115], v[64:71], v16
    s_waitcnt vmcnt(15)
    ds_read_b128 v[108:111], v7 offset:18432
    v_smfmac_f32_16x16x64_bf16 v[228:231], v[112:115], v[72:79], v16
    s_waitcnt lgkmcnt(2)
    ds_read_b128 v[112:115], v7 offset:26624
    v_mfma_f32_16x16x32_bf16 v[176:179], v[116:119], v[32:35], v[176:179]
    v_mfma_f32_16x16x32_bf16 v[176:179], v[120:123], v[40:43], v[176:179]
    buffer_load_dwordx4 v1, s[56:59], s21 offen offset:1024 sc1 lds
    v_mfma_f32_16x16x32_bf16 v[176:179], v[124:127], v[48:51], v[176:179]
    s_add_u32 s21, s21, 36864
    v_mfma_f32_16x16x32_bf16 v[176:179], v[128:131], v[56:59], v[176:179]
    v_mfma_f32_16x16x32_bf16 v[180:183], v[116:119], v[36:39], v[180:183]
    ds_read_b128 v[116:119], v7 offset:3072
    v_mfma_f32_16x16x32_bf16 v[180:183], v[120:123], v[44:47], v[180:183]
    ds_read_b128 v[120:123], v7 offset:11264
    v_mfma_f32_16x16x32_bf16 v[180:183], v[124:127], v[52:55], v[180:183]
    ds_read_b128 v[124:127], v7 offset:19456
    v_mfma_f32_16x16x32_bf16 v[180:183], v[128:131], v[60:63], v[180:183]
    ds_read_b128 v[128:131], v7 offset:27648
    v_cvt_pk_bf16_f32 v232, v176, v177
    v_mfma_f32_16x16x32_bf16 v[184:187], v[132:135], v[32:35], v[184:187]
    v_cvt_pk_bf16_f32 v233, v178, v179
    v_mfma_f32_16x16x32_bf16 v[184:187], v[136:139], v[40:43], v[184:187]
    v_mfma_f32_16x16x32_bf16 v[184:187], v[140:143], v[48:51], v[184:187]
    v_mfma_f32_16x16x32_bf16 v[184:187], v[144:147], v[56:59], v[184:187]
    v_mfma_f32_16x16x32_bf16 v[188:191], v[132:135], v[36:39], v[188:191]
    v_cvt_pk_bf16_f32 v234, v180, v181
    v_cvt_pk_bf16_f32 v235, v182, v183
    v_mfma_f32_16x16x32_bf16 v[188:191], v[136:139], v[44:47], v[188:191]
    buffer_store_dwordx4 v[232:235], v1, s[48:51], s8 offen offset:0 sc1
    v_mfma_f32_16x16x32_bf16 v[188:191], v[140:143], v[52:55], v[188:191]
    ds_read_b128 v[132:135], v7 offset:4096
    ds_read_b128 v[136:139], v7 offset:12288
    v_mfma_f32_16x16x32_bf16 v[188:191], v[144:147], v[60:63], v[188:191]
    v_cvt_pk_bf16_f32 v236, v184, v185
    v_cvt_pk_bf16_f32 v237, v186, v187
    v_mfma_f32_16x16x32_bf16 v[192:195], v[148:151], v[32:35], v[192:195]
    s_waitcnt lgkmcnt(2)
    ds_read_b128 v[140:143], v7 offset:20480
    ds_read_b128 v[144:147], v7 offset:28672
    v_mfma_f32_16x16x32_bf16 v[192:195], v[104:107], v[40:43], v[192:195]
    v_mfma_f32_16x16x32_bf16 v[192:195], v[108:111], v[48:51], v[192:195]
    v_mfma_f32_16x16x32_bf16 v[192:195], v[112:115], v[56:59], v[192:195]
    v_cvt_pk_bf16_f32 v238, v188, v189
    v_cvt_pk_bf16_f32 v239, v190, v191
    v_mfma_f32_16x16x32_bf16 v[196:199], v[148:151], v[36:39], v[196:199]
    buffer_store_dwordx4 v[236:239], v1, s[48:51], s8 offen offset:1024 sc1
    v_mfma_f32_16x16x32_bf16 v[196:199], v[104:107], v[44:47], v[196:199]
    ds_read_b128 v[148:151], v7 offset:5120
    ds_read_b128 v[104:107], v7 offset:13312
    v_mfma_f32_16x16x32_bf16 v[196:199], v[108:111], v[52:55], v[196:199]
    v_cvt_pk_bf16_f32 v240, v192, v193
    v_cvt_pk_bf16_f32 v241, v194, v195
    v_mfma_f32_16x16x32_bf16 v[196:199], v[112:115], v[60:63], v[196:199]
    ds_read_b128 v[108:111], v7 offset:21504
    ds_read_b128 v[112:115], v7 offset:29696
    v_mfma_f32_16x16x32_bf16 v[200:203], v[116:119], v[32:35], v[200:203]
    v_mfma_f32_16x16x32_bf16 v[200:203], v[120:123], v[40:43], v[200:203]
    v_mfma_f32_16x16x32_bf16 v[200:203], v[124:127], v[48:51], v[200:203]
    v_mfma_f32_16x16x32_bf16 v[200:203], v[128:131], v[56:59], v[200:203]
    v_mfma_f32_16x16x32_bf16 v[204:207], v[116:119], v[36:39], v[204:207]
    ds_read_b128 v[116:119], v7 offset:6144
    v_cvt_pk_bf16_f32 v242, v196, v197
    v_mfma_f32_16x16x32_bf16 v[204:207], v[120:123], v[44:47], v[204:207]
    v_cvt_pk_bf16_f32 v243, v198, v199
    ds_read_b128 v[120:123], v7 offset:14336
    v_mfma_f32_16x16x32_bf16 v[204:207], v[124:127], v[52:55], v[204:207]
    buffer_store_dwordx4 v[240:243], v1, s[48:51], s9 offen offset:0 sc1
    v_mfma_f32_16x16x32_bf16 v[204:207], v[128:131], v[60:63], v[204:207]
    s_waitcnt lgkmcnt(2)
    v_cvt_pk_bf16_f32 v244, v200, v201
    v_cvt_pk_bf16_f32 v245, v202, v203
    v_mfma_f32_16x16x32_bf16 v[208:211], v[132:135], v[32:35], v[208:211]
    ds_read_b128 v[124:127], v7 offset:22528
    ds_read_b128 v[128:131], v7 offset:30720
    v_mfma_f32_16x16x32_bf16 v[208:211], v[136:139], v[40:43], v[208:211]
    v_mfma_f32_16x16x32_bf16 v[208:211], v[140:143], v[48:51], v[208:211]
    v_mfma_f32_16x16x32_bf16 v[208:211], v[144:147], v[56:59], v[208:211]
    v_cvt_pk_bf16_f32 v246, v204, v205
    v_cvt_pk_bf16_f32 v247, v206, v207
    v_mfma_f32_16x16x32_bf16 v[212:215], v[132:135], v[36:39], v[212:215]
    buffer_store_dwordx4 v[244:247], v1, s[48:51], s9 offen offset:1024 sc1
    v_mfma_f32_16x16x32_bf16 v[212:215], v[136:139], v[44:47], v[212:215]
    v_mfma_f32_16x16x32_bf16 v[212:215], v[140:143], v[52:55], v[212:215]
    v_mfma_f32_16x16x32_bf16 v[212:215], v[144:147], v[60:63], v[212:215]
    v_mfma_f32_16x16x32_bf16 v[216:219], v[148:151], v[32:35], v[216:219]
    v_cvt_pk_bf16_f32 v232, v208, v209
    v_cvt_pk_bf16_f32 v233, v210, v211
    v_mfma_f32_16x16x32_bf16 v[216:219], v[104:107], v[40:43], v[216:219]
    v_mfma_f32_16x16x32_bf16 v[216:219], v[108:111], v[48:51], v[216:219]
    v_mfma_f32_16x16x32_bf16 v[216:219], v[112:115], v[56:59], v[216:219]
    s_waitcnt vmcnt(12)
    s_barrier
    v_cvt_pk_bf16_f32 v234, v212, v213
    v_mfma_f32_16x16x32_bf16 v[220:223], v[148:151], v[36:39], v[220:223]
    v_cvt_pk_bf16_f32 v235, v214, v215
    ds_read_b128 v[132:135], v11 offset:0
    v_mfma_f32_16x16x32_bf16 v[220:223], v[104:107], v[44:47], v[220:223]
    buffer_store_dwordx4 v[232:235], v1, s[48:51], s10 offen offset:0 sc1
    v_mfma_f32_16x16x32_bf16 v[220:223], v[108:111], v[52:55], v[220:223]
    ds_read_b128 v[136:139], v11 offset:2048
    ds_read_b128 v[140:143], v11 offset:4096
    v_mfma_f32_16x16x32_bf16 v[220:223], v[112:115], v[60:63], v[220:223]
    s_waitcnt lgkmcnt(3)
    ds_read_b128 v[144:147], v11 offset:6144
    v_cvt_pk_bf16_f32 v236, v216, v217
    v_mfma_f32_16x16x32_bf16 v[224:227], v[116:119], v[32:35], v[224:227]
    v_cvt_pk_bf16_f32 v237, v218, v219
    ds_read_b128 v[148:151], v11 offset:1024
    v_mfma_f32_16x16x32_bf16 v[224:227], v[120:123], v[40:43], v[224:227]
    ds_read_b128 v[104:107], v11 offset:3072
    v_mfma_f32_16x16x32_bf16 v[224:227], v[124:127], v[48:51], v[224:227]
    v_cvt_pk_bf16_f32 v238, v220, v221
    v_cvt_pk_bf16_f32 v239, v222, v223
    v_mfma_f32_16x16x32_bf16 v[224:227], v[128:131], v[56:59], v[224:227]
    buffer_store_dwordx4 v[236:239], v1, s[48:51], s10 offen offset:1024 sc1
    v_mfma_f32_16x16x32_bf16 v[228:231], v[116:119], v[36:39], v[228:231]
    ds_read_b128 v[108:111], v11 offset:5120
    ds_read_b128 v[112:115], v11 offset:7168
    v_mfma_f32_16x16x32_bf16 v[228:231], v[120:123], v[44:47], v[228:231]
    ds_read_b128 v[116:119], v11 offset:8192
    v_mfma_f32_16x16x32_bf16 v[228:231], v[124:127], v[52:55], v[228:231]
    ds_read_b128 v[120:123], v11 offset:10240
    v_cvt_pk_bf16_f32 v240, v224, v225
    v_mfma_f32_16x16x32_bf16 v[228:231], v[128:131], v[60:63], v[228:231]
    s_waitcnt lgkmcnt(4)
    v_cvt_pk_bf16_f32 v241, v226, v227
    ds_read_b128 v[124:127], v11 offset:12288
    v_mfma_f32_16x16x32_bf16 v[160:163], v[132:135], a[0:3], 0
    ds_read_b128 v[128:131], v11 offset:14336
    v_mfma_f32_16x16x32_bf16 v[160:163], v[136:139], a[8:11], v[160:163]
    v_mfma_f32_16x16x32_bf16 v[160:163], v[140:143], a[16:19], v[160:163]
    v_mfma_f32_16x16x32_bf16 v[160:163], v[144:147], a[24:27], v[160:163]
    v_mfma_f32_16x16x32_bf16 v[164:167], v[132:135], a[4:7], 0
    v_cvt_pk_bf16_f32 v242, v228, v229
    v_cvt_pk_bf16_f32 v243, v230, v231
    v_mfma_f32_16x16x32_bf16 v[164:167], v[136:139], a[12:15], v[164:167]
    buffer_store_dwordx4 v[240:243], v1, s[48:51], s11 offen offset:2048 sc1
    v_mfma_f32_16x16x32_bf16 v[164:167], v[140:143], a[20:23], v[164:167]
    ds_read_b128 v[132:135], v11 offset:9216
    ds_read_b128 v[136:139], v11 offset:11264
    v_mfma_f32_16x16x32_bf16 v[164:167], v[144:147], a[28:31], v[164:167]
    ds_read_b128 v[140:143], v11 offset:13312
    v_mfma_f32_16x16x32_bf16 v[168:171], v[148:151], a[0:3], 0
    ds_read_b128 v[144:147], v11 offset:15360
    v_mfma_f32_16x16x32_bf16 v[168:171], v[104:107], a[8:11], v[168:171]
    s_waitcnt lgkmcnt(4)
    v_mfma_f32_16x16x32_bf16 v[168:171], v[108:111], a[16:19], v[168:171]
    v_mfma_f32_16x16x32_bf16 v[168:171], v[112:115], a[24:27], v[168:171]
    v_mfma_f32_16x16x32_bf16 v[172:175], v[148:151], a[4:7], 0
    ds_read_b128 v[148:151], v11 offset:16384
    v_mfma_f32_16x16x32_bf16 v[172:175], v[104:107], a[12:15], v[172:175]
    ds_read_b128 v[104:107], v11 offset:18432
    v_mfma_f32_16x16x32_bf16 v[172:175], v[108:111], a[20:23], v[172:175]
    ds_read_b128 v[108:111], v11 offset:20480
    v_mfma_f32_16x16x32_bf16 v[172:175], v[112:115], a[28:31], v[172:175]
    ds_read_b128 v[112:115], v11 offset:22528
    v_mfma_f32_16x16x32_bf16 v[160:163], v[116:119], a[32:35], v[160:163]
    v_mfma_f32_16x16x32_bf16 v[160:163], v[120:123], a[40:43], v[160:163]
    v_mfma_f32_16x16x32_bf16 v[160:163], v[124:127], a[48:51], v[160:163]
    v_mfma_f32_16x16x32_bf16 v[160:163], v[128:131], a[56:59], v[160:163]
    v_mfma_f32_16x16x32_bf16 v[164:167], v[116:119], a[36:39], v[164:167]
    ds_read_b128 v[116:119], v11 offset:17408
    v_mfma_f32_16x16x32_bf16 v[164:167], v[120:123], a[44:47], v[164:167]
    ds_read_b128 v[120:123], v11 offset:19456
    v_mfma_f32_16x16x32_bf16 v[164:167], v[124:127], a[52:55], v[164:167]
    ds_read_b128 v[124:127], v11 offset:21504
    v_mfma_f32_16x16x32_bf16 v[164:167], v[128:131], a[60:63], v[164:167]
    s_waitcnt lgkmcnt(3)
    ds_read_b128 v[128:131], v11 offset:23552
    v_mfma_f32_16x16x32_bf16 v[168:171], v[132:135], a[32:35], v[168:171]
    v_mfma_f32_16x16x32_bf16 v[168:171], v[136:139], a[40:43], v[168:171]
    v_mfma_f32_16x16x32_bf16 v[168:171], v[140:143], a[48:51], v[168:171]
    v_mfma_f32_16x16x32_bf16 v[168:171], v[144:147], a[56:59], v[168:171]
    v_mfma_f32_16x16x32_bf16 v[172:175], v[132:135], a[36:39], v[172:175]
    ds_read_b128 v[132:135], v11 offset:24576
    v_mfma_f32_16x16x32_bf16 v[172:175], v[136:139], a[44:47], v[172:175]
    ds_read_b128 v[136:139], v11 offset:26624
    v_mfma_f32_16x16x32_bf16 v[172:175], v[140:143], a[52:55], v[172:175]
    ds_read_b128 v[140:143], v11 offset:28672
    v_mfma_f32_16x16x32_bf16 v[172:175], v[144:147], a[60:63], v[172:175]
    ds_read_b128 v[144:147], v11 offset:30720
    v_mfma_f32_16x16x32_bf16 v[160:163], v[148:151], a[64:67], v[160:163]
    v_mfma_f32_16x16x32_bf16 v[160:163], v[104:107], a[72:75], v[160:163]
    v_mfma_f32_16x16x32_bf16 v[160:163], v[108:111], a[80:83], v[160:163]
    v_mfma_f32_16x16x32_bf16 v[160:163], v[112:115], a[88:91], v[160:163]
    v_mfma_f32_16x16x32_bf16 v[164:167], v[148:151], a[68:71], v[164:167]
    ds_read_b128 v[148:151], v11 offset:25600
    v_mfma_f32_16x16x32_bf16 v[164:167], v[104:107], a[76:79], v[164:167]
    ds_read_b128 v[104:107], v11 offset:27648
    v_mfma_f32_16x16x32_bf16 v[164:167], v[108:111], a[84:87], v[164:167]
    ds_read_b128 v[108:111], v11 offset:29696
    v_mfma_f32_16x16x32_bf16 v[164:167], v[112:115], a[92:95], v[164:167]
    s_waitcnt lgkmcnt(3)
    ds_read_b128 v[112:115], v11 offset:31744
    v_mfma_f32_16x16x32_bf16 v[168:171], v[116:119], a[64:67], v[168:171]
    v_mfma_f32_16x16x32_bf16 v[168:171], v[120:123], a[72:75], v[168:171]
    v_mfma_f32_16x16x32_bf16 v[168:171], v[124:127], a[80:83], v[168:171]
    v_mfma_f32_16x16x32_bf16 v[168:171], v[128:131], a[88:91], v[168:171]
    v_mfma_f32_16x16x32_bf16 v[172:175], v[116:119], a[68:71], v[172:175]
    v_mfma_f32_16x16x32_bf16 v[172:175], v[120:123], a[76:79], v[172:175]
    v_mfma_f32_16x16x32_bf16 v[172:175], v[124:127], a[84:87], v[172:175]
    v_mfma_f32_16x16x32_bf16 v[172:175], v[128:131], a[92:95], v[172:175]
    v_mfma_f32_16x16x32_bf16 v[160:163], v[132:135], a[96:99], v[160:163]
    v_mfma_f32_16x16x32_bf16 v[160:163], v[136:139], a[104:107], v[160:163]
    v_mfma_f32_16x16x32_bf16 v[160:163], v[140:143], a[112:115], v[160:163]
    s_waitcnt vmcnt(0)
    buffer_store_dword v31, v23, s[32:35], s74 offen sc1
    v_mfma_f32_16x16x32_bf16 v[160:163], v[144:147], a[120:123], v[160:163]
    s_waitcnt vmcnt(8)
    s_barrier
    ds_read_b128 v[116:119], v12 offset:0
    v_mfma_f32_16x16x32_bf16 v[164:167], v[132:135], a[100:103], v[164:167]
    ds_read_b128 v[120:123], v12 offset:2048
    ds_read_b128 v[124:127], v12 offset:4096
    v_mfma_f32_16x16x32_bf16 v[164:167], v[136:139], a[108:111], v[164:167]
    ds_read_b128 v[128:131], v12 offset:6144
    v_mfma_f32_16x16x32_bf16 v[164:167], v[140:143], a[116:119], v[164:167]
    ds_read_b128 v[132:135], v12 offset:1024
    v_mfma_f32_16x16x32_bf16 v[164:167], v[144:147], a[124:127], v[164:167]
    s_mul_i32 s21, s61, 6
    s_add_u32 s21, s4, s21
    s_add_u32 s21, s21, 128
    s_waitcnt lgkmcnt(5)
    v_mfma_f32_16x16x32_bf16 v[168:171], v[148:151], a[96:99], v[168:171]
    s_mul_i32 s21, s21, 36864
    s_add_u32 s21, s21, s28
    s_add_u32 s21, s21, 7168
    v_mfma_f32_16x16x32_bf16 v[168:171], v[104:107], a[104:107], v[168:171]
    s_mov_b32 m0, s46
    ds_read_b128 v[136:139], v12 offset:3072
    ds_read_b128 v[140:143], v12 offset:5120
    v_mfma_f32_16x16x32_bf16 v[168:171], v[108:111], a[112:115], v[168:171]
    buffer_load_dwordx4 v1, s[56:59], s21 offen sc1 lds
    v_mfma_f32_16x16x32_bf16 v[168:171], v[112:115], a[120:123], v[168:171]
    ds_read_b128 v[144:147], v12 offset:7168
    v_mfma_f32_16x16x32_bf16 v[172:175], v[148:151], a[100:103], v[172:175]
    ds_read_b128 v[148:151], v12 offset:8192
    v_mfma_f32_16x16x32_bf16 v[172:175], v[104:107], a[108:111], v[172:175]
    buffer_load_dwordx4 v1, s[56:59], s21 offen offset:1024 sc1 lds
    v_mfma_f32_16x16x32_bf16 v[172:175], v[108:111], a[116:119], v[172:175]
    s_mul_i32 s21, s61, 6
    s_add_u32 s21, s21, 132
    s_mul_i32 s21, s21, 36864
    v_mfma_f32_16x16x32_bf16 v[172:175], v[112:115], a[124:127], v[172:175]
    s_add_u32 s21, s21, s28
    s_add_u32 s21, s21, 7168
    s_and_b32 s64, s68, 1024
    s_waitcnt lgkmcnt(2)
    v_mfma_f32_16x16x32_bf16 v[160:163], v[116:119], a[128:131], v[160:163]
    s_add_u32 s21, s21, s64
    ds_read_b128 v[104:107], v12 offset:10240
    ds_read_b128 v[108:111], v12 offset:12288
    v_mfma_f32_16x16x32_bf16 v[160:163], v[120:123], a[136:139], v[160:163]
    s_add_u32 m0, s46, 2048
    ds_read_b128 v[112:115], v12 offset:14336
    s_lshl2_add_u32 s64, s61, s65
    v_mfma_f32_16x16x32_bf16 v[160:163], v[124:127], a[144:147], v[160:163]
    s_lshl_b32 s65, s65, 5
    buffer_load_dwordx4 v1, s[56:59], s21 offen sc1 lds
    v_mfma_f32_16x16x32_bf16 v[160:163], v[128:131], a[152:155], v[160:163]
    s_add_u32 s65, s65, 1024
    s_lshl_b32 s64, s64, 6
    v_mfma_f32_16x16x32_bf16 v[164:167], v[116:119], a[132:135], v[164:167]
    s_cmp_eq_u32 s4, s61
    s_cselect_b32 s65, s65, 1073741824
    s_cselect_b32 s70, s23, 1073741824
    v_mfma_f32_16x16x32_bf16 v[164:167], v[120:123], a[140:143], v[164:167]
    ds_read_b128 v[116:119], v12 offset:9216
    ds_read_b128 v[120:123], v12 offset:11264
    v_mfma_f32_16x16x32_bf16 v[164:167], v[124:127], a[148:151], v[164:167]
    ds_read_b128 v[124:127], v12 offset:13312
    v_mfma_f32_16x16x32_bf16 v[164:167], v[128:131], a[156:159], v[164:167]
    ds_read_b128 v[128:131], v12 offset:15360
    v_mfma_f32_16x16x32_bf16 v[168:171], v[132:135], a[128:131], v[168:171]
    v_mfma_f32_16x16x32_bf16 v[168:171], v[136:139], a[136:139], v[168:171]
    v_mfma_f32_16x16x32_bf16 v[168:171], v[140:143], a[144:147], v[168:171]
    s_waitcnt lgkmcnt(2)
    v_mfma_f32_16x16x32_bf16 v[168:171], v[144:147], a[152:155], v[168:171]
    v_mfma_f32_16x16x32_bf16 v[172:175], v[132:135], a[132:135], v[172:175]
    ds_read_b128 v[132:135], v12 offset:16384
    v_mfma_f32_16x16x32_bf16 v[172:175], v[136:139], a[140:143], v[172:175]
    ds_read_b128 v[136:139], v12 offset:18432
    v_mfma_f32_16x16x32_bf16 v[172:175], v[140:143], a[148:151], v[172:175]
    ds_read_b128 v[140:143], v12 offset:20480
    v_mfma_f32_16x16x32_bf16 v[172:175], v[144:147], a[156:159], v[172:175]
    ds_read_b128 v[144:147], v12 offset:22528
    v_mfma_f32_16x16x32_bf16 v[160:163], v[148:151], a[160:163], v[160:163]
    v_mfma_f32_16x16x32_bf16 v[160:163], v[104:107], a[168:171], v[160:163]
    v_mfma_f32_16x16x32_bf16 v[160:163], v[108:111], a[176:179], v[160:163]
    v_mfma_f32_16x16x32_bf16 v[160:163], v[112:115], a[184:187], v[160:163]
    v_mfma_f32_16x16x32_bf16 v[164:167], v[148:151], a[164:167], v[164:167]
    ds_read_b128 v[148:151], v12 offset:17408
    v_mfma_f32_16x16x32_bf16 v[164:167], v[104:107], a[172:175], v[164:167]
    buffer_load_dword v3, v19, s[32:35], s66 offen sc1
    v_mfma_f32_16x16x32_bf16 v[164:167], v[108:111], a[180:183], v[164:167]
    ds_read_b128 v[104:107], v12 offset:19456
    ds_read_b128 v[108:111], v12 offset:21504
    v_mfma_f32_16x16x32_bf16 v[164:167], v[112:115], a[188:191], v[164:167]
    ds_read_b128 v[112:115], v12 offset:23552
    v_mfma_f32_16x16x32_bf16 v[168:171], v[116:119], a[160:163], v[168:171]
    v_mfma_f32_16x16x32_bf16 v[168:171], v[120:123], a[168:171], v[168:171]
    s_waitcnt lgkmcnt(3)
    v_mfma_f32_16x16x32_bf16 v[168:171], v[124:127], a[176:179], v[168:171]
    v_mfma_f32_16x16x32_bf16 v[168:171], v[128:131], a[184:187], v[168:171]
    v_mfma_f32_16x16x32_bf16 v[172:175], v[116:119], a[164:167], v[172:175]
    ds_read_b128 v[116:119], v12 offset:24576
    v_mfma_f32_16x16x32_bf16 v[172:175], v[120:123], a[172:175], v[172:175]
    ds_read_b128 v[120:123], v12 offset:26624
    v_mfma_f32_16x16x32_bf16 v[172:175], v[124:127], a[180:183], v[172:175]
    ds_read_b128 v[124:127], v12 offset:28672
    v_mfma_f32_16x16x32_bf16 v[172:175], v[128:131], a[188:191], v[172:175]
    ds_read_b128 v[128:131], v12 offset:30720
    v_mfma_f32_16x16x32_bf16 v[160:163], v[132:135], a[192:195], v[160:163]
    v_mfma_f32_16x16x32_bf16 v[160:163], v[136:139], a[200:203], v[160:163]
    v_mfma_f32_16x16x32_bf16 v[160:163], v[140:143], a[208:211], v[160:163]
    v_mfma_f32_16x16x32_bf16 v[160:163], v[144:147], a[216:219], v[160:163]
    v_mfma_f32_16x16x32_bf16 v[164:167], v[132:135], a[196:199], v[164:167]
    ds_read_b128 v[132:135], v12 offset:25600
    v_mfma_f32_16x16x32_bf16 v[164:167], v[136:139], a[204:207], v[164:167]
    ds_read_b128 v[136:139], v12 offset:27648
    v_mfma_f32_16x16x32_bf16 v[164:167], v[140:143], a[212:215], v[164:167]
    ds_read_b128 v[140:143], v12 offset:29696
    v_mfma_f32_16x16x32_bf16 v[164:167], v[144:147], a[220:223], v[164:167]
    ds_read_b128 v[144:147], v12 offset:31744
    v_mfma_f32_16x16x32_bf16 v[168:171], v[148:151], a[192:195], v[168:171]
    s_waitcnt lgkmcnt(4)
    v_mfma_f32_16x16x32_bf16 v[168:171], v[104:107], a[200:203], v[168:171]
    v_mfma_f32_16x16x32_bf16 v[168:171], v[108:111], a[208:211], v[168:171]
    v_mfma_f32_16x16x32_bf16 v[168:171], v[112:115], a[216:219], v[168:171]
    v_mfma_f32_16x16x32_bf16 v[172:175], v[148:151], a[196:199], v[172:175]
    v_mfma_f32_16x16x32_bf16 v[172:175], v[104:107], a[204:207], v[172:175]
    v_mfma_f32_16x16x32_bf16 v[172:175], v[108:111], a[212:215], v[172:175]
    v_mfma_f32_16x16x32_bf16 v[172:175], v[112:115], a[220:223], v[172:175]
    v_mfma_f32_16x16x32_bf16 v[160:163], v[116:119], a[224:227], v[160:163]
    s_waitcnt vmcnt(0)
    v_cmp_gt_u32 vcc, 3, v3
    s_nop 1
    s_and_b64 vcc, vcc, exec
    s_cbranch_scc1 SPIN_X
BACK_X:
    v_mfma_f32_16x16x32_bf16 v[160:163], v[120:123], a[232:235], v[160:163]
    buffer_load_dwordx4 v[176:179], v1, s[48:51], s98 offen offset:0 sc1
    v_mfma_f32_16x16x32_bf16 v[160:163], v[124:127], a[240:243], v[160:163]
    s_add_u32 s98, s23, 12288
    buffer_load_dwordx4 v[180:183], v1, s[48:51], s98 offen offset:0 sc1
    v_mfma_f32_16x16x32_bf16 v[160:163], v[128:131], a[248:251], v[160:163]
    s_waitcnt vmcnt(3)
    s_barrier
    ds_read_b128 v[148:151], v13 offset:2048
    v_mfma_f32_16x16x32_bf16 v[164:167], v[116:119], a[228:231], v[164:167]
    s_add_u32 s98, s23, 24576
    ds_read_b128 v[104:107], v13 offset:1024
    ds_read_b128 v[108:111], v13 offset:9216
    v_mfma_f32_16x16x32_bf16 v[164:167], v[120:123], a[236:239], v[164:167]
    buffer_load_dwordx4 v[184:187], v1, s[48:51], s98 offen offset:0 sc1
    v_mfma_f32_16x16x32_bf16 v[164:167], v[124:127], a[244:247], v[164:167]
    s_add_u32 s98, s23, 0
    ds_read_b128 v[112:115], v13 offset:17408
    ds_read_b128 v[116:119], v13 offset:25600
    v_mfma_f32_16x16x32_bf16 v[164:167], v[128:131], a[252:255], v[164:167]
    s_waitcnt lgkmcnt(5)
    ds_read_b128 v[120:123], v13 offset:0
    v_mfma_f32_16x16x32_bf16 v[168:171], v[132:135], a[224:227], v[168:171]
    buffer_load_dwordx4 v[188:191], v1, s[48:51], s98 offen offset:1024 sc1
    v_mfma_f32_16x16x32_bf16 v[168:171], v[136:139], a[232:235], v[168:171]
    s_add_u32 s98, s23, 12288
    ds_read_b128 v[124:127], v13 offset:8192
    ds_read_b128 v[128:131], v13 offset:16384
    v_mfma_f32_16x16x32_bf16 v[168:171], v[140:143], a[240:243], v[168:171]
    v_mfma_f32_16x16x32_bf16 v[168:171], v[144:147], a[248:251], v[168:171]
    v_mfma_f32_16x16x32_bf16 v[172:175], v[132:135], a[228:231], v[172:175]
    buffer_load_dwordx4 v[192:195], v1, s[48:51], s98 offen offset:1024 sc1
    v_mfma_f32_16x16x32_bf16 v[172:175], v[136:139], a[236:239], v[172:175]
    s_add_u32 s98, s23, 24576
    ds_read_b128 v[132:135], v13 offset:24576
    ds_read_b128 v[136:139], v13 offset:10240
    v_mfma_f32_16x16x32_bf16 v[172:175], v[140:143], a[244:247], v[172:175]
    v_mfma_f32_16x16x32_bf16 v[172:175], v[144:147], a[252:255], v[172:175]
    s_waitcnt lgkmcnt(2)
    v_smfmac_f32_16x16x64_bf16 v[160:163], v[148:151], v[64:71], v16
    buffer_load_dwordx4 v[196:199], v1, s[48:51], s98 offen offset:1024 sc1
    v_smfmac_f32_16x16x64_bf16 v[164:167], v[148:151], v[72:79], v16
    s_add_u32 s98, s70, 0
    v_mfma_f32_16x16x32_bf16 v[168:171], v[104:107], v[32:35], v[168:171]
    v_mfma_f32_16x16x32_bf16 v[168:171], v[108:111], v[40:43], v[168:171]
    buffer_load_dwordx4 v[200:203], v1, s[48:51], s98 offen offset:2048 sc1
    v_mfma_f32_16x16x32_bf16 v[168:171], v[112:115], v[48:51], v[168:171]
    s_add_u32 s98, s70, 12288
    v_mfma_f32_16x16x32_bf16 v[168:171], v[116:119], v[56:59], v[168:171]
    v_mfma_f32_16x16x32_bf16 v[172:175], v[104:107], v[36:39], v[172:175]
    v_mfma_f32_16x16x32_bf16 v[172:175], v[108:111], v[44:47], v[172:175]
    buffer_load_dwordx4 v[204:207], v1, s[48:51], s98 offen offset:2048 sc1
    v_mfma_f32_16x16x32_bf16 v[172:175], v[112:115], v[52:55], v[172:175]
    s_add_u32 s98, s70, 24576
    v_mfma_f32_16x16x32_bf16 v[172:175], v[116:119], v[60:63], v[172:175]
    v_mfma_f32_16x16x32_bf16 v[160:163], v[120:123], v[32:35], v[160:163]
    buffer_load_dwordx4 v[208:211], v1, s[48:51], s98 offen offset:2048 sc1
    v_mfma_f32_16x16x32_bf16 v[160:163], v[124:127], v[40:43], v[160:163]
    v_mfma_f32_16x16x32_bf16 v[160:163], v[128:131], v[48:51], v[160:163]
    s_waitcnt lgkmcnt(0)
    v_mfma_f32_16x16x32_bf16 v[160:163], v[132:135], v[56:59], v[160:163]
    v_mfma_f32_16x16x32_bf16 v[164:167], v[120:123], v[36:39], v[164:167]
    v_mfma_f32_16x16x32_bf16 v[164:167], v[124:127], v[44:47], v[164:167]
    v_mfma_f32_16x16x32_bf16 v[164:167], v[128:131], v[52:55], v[164:167]
    v_mfma_f32_16x16x32_bf16 v[164:167], v[132:135], v[60:63], v[164:167]
    v_smfmac_f32_16x16x64_bf16 v[168:171], v[136:139], v[64:71], v16
    v_smfmac_f32_16x16x64_bf16 v[172:175], v[136:139], v[72:79], v16
    s_waitcnt vmcnt(6)
    v_mfma_f32_16x16x32_bf16 v[160:163], v[96:99], v[176:179], v[160:163]
    v_mfma_f32_16x16x32_bf16 v[160:163], v[96:99], v[180:183], v[160:163]
    v_mfma_f32_16x16x32_bf16 v[160:163], v[96:99], v[184:187], v[160:163]
    v_mfma_f32_16x16x32_bf16 v[164:167], v[98:101], v[176:179], v[164:167]
    v_mfma_f32_16x16x32_bf16 v[164:167], v[98:101], v[180:183], v[164:167]
    v_mfma_f32_16x16x32_bf16 v[164:167], v[98:101], v[184:187], v[164:167]
    s_waitcnt vmcnt(3)
    s_nop 0
    v_mfma_f32_16x16x32_bf16 v[168:171], v[96:99], v[188:191], v[168:171]
    v_mfma_f32_16x16x32_bf16 v[168:171], v[96:99], v[192:195], v[168:171]
    v_mfma_f32_16x16x32_bf16 v[168:171], v[96:99], v[196:199], v[168:171]
    v_mfma_f32_16x16x32_bf16 v[172:175], v[98:101], v[188:191], v[172:175]
    v_mfma_f32_16x16x32_bf16 v[172:175], v[98:101], v[192:195], v[172:175]
    v_mfma_f32_16x16x32_bf16 v[172:175], v[98:101], v[196:199], v[172:175]
    v_cvt_pk_bf16_f32 v160, v160, v161
    v_cvt_pk_bf16_f32 v161, v162, v163
    buffer_store_dwordx2 v[160:161], v20, s[24:27], s64 offen
    v_cvt_pk_bf16_f32 v164, v164, v165
    v_cvt_pk_bf16_f32 v165, v166, v167
    buffer_store_dwordx2 v[164:165], v21, s[24:27], s64 offen
    s_cmp_lg_u32 s4, s61
    s_cbranch_scc1 K1_X2
    s_waitcnt vmcnt(2)
    v_mfma_f32_16x16x32_bf16 v[224:227], v[96:99], v[200:203], v[224:227]
    v_mfma_f32_16x16x32_bf16 v[224:227], v[96:99], v[204:207], v[224:227]
    v_mfma_f32_16x16x32_bf16 v[224:227], v[96:99], v[208:211], v[224:227]
    v_mfma_f32_16x16x32_bf16 v[228:231], v[98:101], v[200:203], v[228:231]
    v_mfma_f32_16x16x32_bf16 v[228:231], v[98:101], v[204:207], v[228:231]
    v_mfma_f32_16x16x32_bf16 v[228:231], v[98:101], v[208:211], v[228:231]
    s_nop 4
    v_cvt_pk_bf16_f32 v224, v224, v225
    v_cvt_pk_bf16_f32 v225, v226, v227
    buffer_store_dwordx2 v[224:225], v20, s[24:27], s65 offen
    v_cvt_pk_bf16_f32 v228, v228, v229
    v_cvt_pk_bf16_f32 v229, v230, v231
    buffer_store_dwordx2 v[228:229], v21, s[24:27], s65 offen
K1_X2:
    v_cvt_pk_bf16_f32 v168, v168, v169
    v_cvt_pk_bf16_f32 v169, v170, v171
    buffer_store_dwordx2 v[168:169], v20, s[24:27], s64 offen offset:32
    v_cvt_pk_bf16_f32 v172, v172, v173
    v_cvt_pk_bf16_f32 v173, v174, v175
    buffer_store_dwordx2 v[172:173], v21, s[24:27], s64 offen offset:32
K1_END:
    s_endpgm
K1_LB_MASK:
    v_add_f32 v212, s12, v144
    v_fma_f32 v176, v208, s8, v212
    v_fma_f32 v177, v209, s8, v212
    v_fma_f32 v178, v210, s8, v212
    v_fma_f32 v179, v211, s8, v212
    v_add_f32 v213, s13, v144
    v_fma_f32 v180, v208, s9, v213
    v_fma_f32 v181, v209, s9, v213
    v_fma_f32 v182, v210, s9, v213
    v_fma_f32 v183, v211, s9, v213
    v_add_f32 v212, s14, v144
    v_fma_f32 v184, v208, s10, v212
    v_fma_f32 v185, v209, s10, v212
    v_fma_f32 v186, v210, s10, v212
    v_fma_f32 v187, v211, s10, v212
    v_add_f32 v213, s15, v144
    v_fma_f32 v188, v208, s11, v213
    v_fma_f32 v189, v209, s11, v213
    v_fma_f32 v190, v210, s11, v213
    v_fma_f32 v191, v211, s11, v213
    buffer_load_dword v3, v29, s[32:35], s92 offen sc1
    buffer_load_dword v28, off, s[32:35], s86 sc1
    s_branch K1_LB_BACK
K1_LS_MASK:
    s_cmp_eq_u32 s78, 1
    s_cbranch_scc1 K1_LS_LAST
    buffer_load_dword v3, v29, s[32:35], s92 offen sc1
    buffer_load_dword v28, off, s[32:35], s86 sc1
    v_mov_b32 v218, 1
    s_cmp_eq_u64 s[84:85], 0
    s_cselect_b32 s7, s74, 1073741824
    s_cmp_lg_u32 s83, 0
    s_cselect_b32 s7, s74, s7
    s_waitcnt vmcnt(10)
    buffer_store_dword v218, v216, s[32:35], s7 offen sc1
    s_branch K1_LS_BACK
K1_LS_LAST:
    v_add_f32 v212, s12, v152
    v_fma_f32 v176, v208, s8, v212
    v_fma_f32 v177, v209, s8, v212
    v_fma_f32 v178, v210, s8, v212
    v_fma_f32 v179, v211, s8, v212
    v_add_f32 v213, s13, v152
    v_fma_f32 v180, v208, s9, v213
    v_fma_f32 v181, v209, s9, v213
    v_fma_f32 v182, v210, s9, v213
    v_fma_f32 v183, v211, s9, v213
    v_add_f32 v212, s14, v152
    v_fma_f32 v184, v208, s10, v212
    v_fma_f32 v185, v209, s10, v212
    v_fma_f32 v186, v210, s10, v212
    v_fma_f32 v187, v211, s10, v212
    v_add_f32 v213, s15, v152
    v_fma_f32 v188, v208, s11, v213
    v_fma_f32 v189, v209, s11, v213
    v_fma_f32 v190, v210, s11, v213
    v_fma_f32 v191, v211, s11, v213
    v_cmp_gt_u32 vcc, 2, v28
    s_nop 1
    s_and_b64 vcc, vcc, exec
    s_cbranch_scc1 SPIN_W0H
BACK_W0H:
    s_lshl4_add_u32 s7, s73, s87
    buffer_load_dwordx4 a[128:131], v1, s[40:43], s7 offen sc1
    buffer_load_dwordx4 a[132:135], v1, s[40:43], s87 offen offset:1024 sc1
    v_cmp_gt_u32 vcc, 1, v3
    s_nop 1
    s_cmp_lg_u32 vcc_lo, 0
    s_cbranch_scc1 SPIN_W0
BACK_W0:
    s_mov_b64 s[36:37], s[56:57]
    s_mov_b32 s38, 5603328
    s_xor_b32 s77, s3, 0
    s_lshl2_add_u32 s77, s77, s4
    s_mul_i32 s77, s77, 36864
    s_add_u32 s77, s77, s28
    s_branch K1_LS_BACK
K1_WMASK:
    v_mov_b32 v9, 0xf149f2ca
    v_cmp_le_u32 vcc, 2, v14
    s_nop 1
    v_cndmask_b32 v141, v9, v141, vcc
    v_cmp_le_u32 vcc, 4, v14
    s_nop 1
    v_cndmask_b32 v142, v9, v142, vcc
    v_cmp_le_u32 vcc, 6, v14
    s_nop 1
    v_cndmask_b32 v143, v9, v143, vcc
    v_cmp_le_u32 vcc, 8, v14
    s_nop 1
    v_cndmask_b32 v144, v9, v144, vcc
    v_cmp_le_u32 vcc, 10, v14
    s_nop 1
    v_cndmask_b32 v145, v9, v145, vcc
    v_cmp_le_u32 vcc, 12, v14
    s_nop 1
    v_cndmask_b32 v146, v9, v146, vcc
    v_cmp_le_u32 vcc, 14, v14
    s_nop 1
    v_cndmask_b32 v147, v9, v147, vcc
    s_branch K1_WMASK_BACK
K1_S7:
    v_mov_b32 v218, 1
    s_cmp_eq_u64 s[84:85], 0
    s_cselect_b32 s7, s74, 1073741824
    s_cmp_lg_u32 s83, 0
    s_cselect_b32 s7, s74, s7
    s_waitcnt vmcnt(8)
    buffer_store_dword v218, v216, s[32:35], s7 offen sc1
    s_branch K1_S7_BACK
K1_J7:
    v_cmp_gt_u32 vcc, 2, v28
    s_nop 1
    s_and_b64 vcc, vcc, exec
    s_cbranch_scc1 SPIN_W7H
BACK_W7H:
    s_lshl4_add_u32 s7, s73, s87
    buffer_load_dwordx4 a[128:131], v1, s[40:43], s7 offen sc1
    buffer_load_dwordx4 a[132:135], v1, s[40:43], s87 offen offset:1024 sc1
    v_cmp_gt_u32 vcc, 1, v3
    s_nop 1
    s_cmp_lg_u32 vcc_lo, 0
    s_cbranch_scc1 SPIN_W7
BACK_W7:
    s_mov_b64 s[36:37], s[56:57]
    s_mov_b32 s38, 5603328
    s_xor_b32 s77, s3, 0
    s_lshl2_add_u32 s77, s77, s4
    s_mul_i32 s77, s77, 36864
    s_add_u32 s77, s77, s28
    s_branch K1_J7_BACK
K1_REDO:
    s_mov_b32 s83, 1
    s_mov_b32 s63, 1073741824
    s_mov_b32 s64, 1073741824
    s_mov_b32 s62, 1073741824
    s_mul_i32 s7, s5, 1081344
    s_sub_u32 s7, 56623104, s7
    s_sub_u32 s36, s56, s7
    s_subb_u32 s37, s57, 0
    s_mov_b32 s38, 1081344
    s_mov_b32 s50, 0
    s_mov_b32 s54, 0
    s_waitcnt vmcnt(0) lgkmcnt(0)
    s_barrier
    v_lshrrev_b32 v92, 4, v1
    v_and_b32 v64, 15, v92
    v_lshrrev_b32 v92, 4, v92
    v_lshlrev_b32 v92, 2, v92
    v_sub_u32 v92, v64, v92
    s_lshl_b32 s98, s4, 4
    v_add_u32 v92, s98, v92
    s_lshl_b32 s98, s6, 7
    s_sub_u32 s99, 1920, s98
    v_add_u32 v64, s98, v92
    v_add_u32 v65, 64, v64
    v_add_u32 v66, s99, v92
    v_add_u32 v67, 64, v66
    v_mov_b32 v93, 0xf149f2ca
    v_mov_b32 v68, v93
    v_mov_b32 v69, v93
    v_mov_b32 v70, v93
    v_mov_b32 v71, v93
    s_mov_b32 s78, 0
    s_add_u32 s99, s99, 128
K1_REDO_L:
    s_lshr_b32 s7, s78, 6
    s_lshl_b32 s7, s7, 15
    s_bfe_u32 s98, s78, 0x20004
    s_lshl_b32 s98, s98, 12
    s_add_u32 s7, s7, s98
    buffer_load_dwordx4 v[72:75], v1, s[36:39], s7 offen offset:0 sc1
    buffer_load_dwordx4 v[76:79], v1, s[36:39], s7 offen offset:1024 sc1
    buffer_load_dwordx4 v[80:83], v1, s[36:39], s7 offen offset:2048 sc1
    buffer_load_dwordx4 v[84:87], v1, s[36:39], s7 offen offset:3072 sc1
    s_waitcnt vmcnt(0)
    v_mfma_f32_16x16x32_bf16 v[88:91], v[72:75], v[128:131], 0
    v_mfma_f32_16x16x32_bf16 v[88:91], v[76:79], v[160:163], v[88:91]
    v_mfma_f32_16x16x32_bf16 v[88:91], v[80:83], v[192:195], v[88:91]
    v_mfma_f32_16x16x32_bf16 v[88:91], v[84:87], v[224:227], v[88:91]
    v_subrev_u32 v92, s78, v64
    v_cmp_le_i32 vcc, 0, v92
    s_nop 5
    v_cndmask_b32 v88, v93, v88, vcc
    v_max_f32 v68, v68, v88
    v_cmp_le_i32 vcc, 1, v92
    s_nop 1
    v_cndmask_b32 v89, v93, v89, vcc
    v_max_f32 v68, v68, v89
    v_cmp_le_i32 vcc, 2, v92
    s_nop 1
    v_cndmask_b32 v90, v93, v90, vcc
    v_max_f32 v68, v68, v90
    v_cmp_le_i32 vcc, 3, v92
    s_nop 1
    v_cndmask_b32 v91, v93, v91, vcc
    v_max_f32 v68, v68, v91
    v_mfma_f32_16x16x32_bf16 v[88:91], v[72:75], v[132:135], 0
    v_mfma_f32_16x16x32_bf16 v[88:91], v[76:79], v[164:167], v[88:91]
    v_mfma_f32_16x16x32_bf16 v[88:91], v[80:83], v[196:199], v[88:91]
    v_mfma_f32_16x16x32_bf16 v[88:91], v[84:87], v[228:231], v[88:91]
    v_subrev_u32 v92, s78, v65
    v_cmp_le_i32 vcc, 0, v92
    s_nop 5
    v_cndmask_b32 v88, v93, v88, vcc
    v_max_f32 v69, v69, v88
    v_cmp_le_i32 vcc, 1, v92
    s_nop 1
    v_cndmask_b32 v89, v93, v89, vcc
    v_max_f32 v69, v69, v89
    v_cmp_le_i32 vcc, 2, v92
    s_nop 1
    v_cndmask_b32 v90, v93, v90, vcc
    v_max_f32 v69, v69, v90
    v_cmp_le_i32 vcc, 3, v92
    s_nop 1
    v_cndmask_b32 v91, v93, v91, vcc
    v_max_f32 v69, v69, v91
    v_mfma_f32_16x16x32_bf16 v[88:91], v[72:75], v[136:139], 0
    v_mfma_f32_16x16x32_bf16 v[88:91], v[76:79], v[168:171], v[88:91]
    v_mfma_f32_16x16x32_bf16 v[88:91], v[80:83], v[200:203], v[88:91]
    v_mfma_f32_16x16x32_bf16 v[88:91], v[84:87], v[232:235], v[88:91]
    v_subrev_u32 v92, s78, v66
    v_cmp_le_i32 vcc, 0, v92
    s_nop 5
    v_cndmask_b32 v88, v93, v88, vcc
    v_max_f32 v70, v70, v88
    v_cmp_le_i32 vcc, 1, v92
    s_nop 1
    v_cndmask_b32 v89, v93, v89, vcc
    v_max_f32 v70, v70, v89
    v_cmp_le_i32 vcc, 2, v92
    s_nop 1
    v_cndmask_b32 v90, v93, v90, vcc
    v_max_f32 v70, v70, v90
    v_cmp_le_i32 vcc, 3, v92
    s_nop 1
    v_cndmask_b32 v91, v93, v91, vcc
    v_max_f32 v70, v70, v91
    v_mfma_f32_16x16x32_bf16 v[88:91], v[72:75], v[140:143], 0
    v_mfma_f32_16x16x32_bf16 v[88:91], v[76:79], v[172:175], v[88:91]
    v_mfma_f32_16x16x32_bf16 v[88:91], v[80:83], v[204:207], v[88:91]
    v_mfma_f32_16x16x32_bf16 v[88:91], v[84:87], v[236:239], v[88:91]
    v_subrev_u32 v92, s78, v67
    v_cmp_le_i32 vcc, 0, v92
    s_nop 5
    v_cndmask_b32 v88, v93, v88, vcc
    v_max_f32 v71, v71, v88
    v_cmp_le_i32 vcc, 1, v92
    s_nop 1
    v_cndmask_b32 v89, v93, v89, vcc
    v_max_f32 v71, v71, v89
    v_cmp_le_i32 vcc, 2, v92
    s_nop 1
    v_cndmask_b32 v90, v93, v90, vcc
    v_max_f32 v71, v71, v90
    v_cmp_le_i32 vcc, 3, v92
    s_nop 1
    v_cndmask_b32 v91, v93, v91, vcc
    v_max_f32 v71, v71, v91
    s_add_u32 s78, s78, 16
    s_cmp_lt_u32 s78, s99
    s_cbranch_scc1 K1_REDO_L
    v_mov_b32 v92, v68
    s_nop 1
    v_permlane32_swap_b32 v68, v92
    v_max_f32 v68, v68, v92
    v_mov_b32 v92, v68
    s_nop 1
    v_permlane16_swap_b32 v68, v92
    v_max_f32 v68, v68, v92
    v_sub_f32 v144, 0, v68
    v_sub_f32 v145, 0, v68
    v_sub_f32 v146, 0, v68
    v_sub_f32 v147, 0, v68
    v_mov_b32 v92, v69
    s_nop 1
    v_permlane32_swap_b32 v69, v92
    v_max_f32 v69, v69, v92
    v_mov_b32 v92, v69
    s_nop 1
    v_permlane16_swap_b32 v69, v92
    v_max_f32 v69, v69, v92
    v_sub_f32 v148, 0, v69
    v_sub_f32 v149, 0, v69
    v_sub_f32 v150, 0, v69
    v_sub_f32 v151, 0, v69
    v_mov_b32 v92, v70
    s_nop 1
    v_permlane32_swap_b32 v70, v92
    v_max_f32 v70, v70, v92
    v_mov_b32 v92, v70
    s_nop 1
    v_permlane16_swap_b32 v70, v92
    v_max_f32 v70, v70, v92
    v_sub_f32 v152, 0, v70
    v_sub_f32 v153, 0, v70
    v_sub_f32 v154, 0, v70
    v_sub_f32 v155, 0, v70
    v_mov_b32 v92, v71
    s_nop 1
    v_permlane32_swap_b32 v71, v92
    v_max_f32 v71, v71, v92
    v_mov_b32 v92, v71
    s_nop 1
    v_permlane16_swap_b32 v71, v92
    v_max_f32 v71, v71, v92
    v_sub_f32 v156, 0, v71
    v_sub_f32 v157, 0, v71
    v_sub_f32 v158, 0, v71
    v_sub_f32 v159, 0, v71
    v_accvgpr_write_b32 a0, 0
    v_accvgpr_write_b32 a1, 0
    v_accvgpr_write_b32 a2, 0
    v_accvgpr_write_b32 a3, 0
    v_accvgpr_write_b32 a4, 0
    v_accvgpr_write_b32 a5, 0
    v_accvgpr_write_b32 a6, 0
    v_accvgpr_write_b32 a7, 0
    v_accvgpr_write_b32 a8, 0
    v_accvgpr_write_b32 a9, 0
    v_accvgpr_write_b32 a10, 0
    v_accvgpr_write_b32 a11, 0
    v_accvgpr_write_b32 a12, 0
    v_accvgpr_write_b32 a13, 0
    v_accvgpr_write_b32 a14, 0
    v_accvgpr_write_b32 a15, 0
    v_accvgpr_write_b32 a16, 0
    v_accvgpr_write_b32 a17, 0
    v_accvgpr_write_b32 a18, 0
    v_accvgpr_write_b32 a19, 0
    v_accvgpr_write_b32 a20, 0
    v_accvgpr_write_b32 a21, 0
    v_accvgpr_write_b32 a22, 0
    v_accvgpr_write_b32 a23, 0
    v_accvgpr_write_b32 a24, 0
    v_accvgpr_write_b32 a25, 0
    v_accvgpr_write_b32 a26, 0
    v_accvgpr_write_b32 a27, 0
    v_accvgpr_write_b32 a28, 0
    v_accvgpr_write_b32 a29, 0
    v_accvgpr_write_b32 a30, 0
    v_accvgpr_write_b32 a31, 0
    v_accvgpr_write_b32 a32, 0
    v_accvgpr_write_b32 a33, 0
    v_accvgpr_write_b32 a34, 0
    v_accvgpr_write_b32 a35, 0
    v_accvgpr_write_b32 a36, 0
    v_accvgpr_write_b32 a37, 0
    v_accvgpr_write_b32 a38, 0
    v_accvgpr_write_b32 a39, 0
    v_accvgpr_write_b32 a40, 0
    v_accvgpr_write_b32 a41, 0
    v_accvgpr_write_b32 a42, 0
    v_accvgpr_write_b32 a43, 0
    v_accvgpr_write_b32 a44, 0
    v_accvgpr_write_b32 a45, 0
    v_accvgpr_write_b32 a46, 0
    v_accvgpr_write_b32 a47, 0
    v_accvgpr_write_b32 a48, 0
    v_accvgpr_write_b32 a49, 0
    v_accvgpr_write_b32 a50, 0
    v_accvgpr_write_b32 a51, 0
    v_accvgpr_write_b32 a52, 0
    v_accvgpr_write_b32 a53, 0
    v_accvgpr_write_b32 a54, 0
    v_accvgpr_write_b32 a55, 0
    v_accvgpr_write_b32 a56, 0
    v_accvgpr_write_b32 a57, 0
    v_accvgpr_write_b32 a58, 0
    v_accvgpr_write_b32 a59, 0
    v_accvgpr_write_b32 a60, 0
    v_accvgpr_write_b32 a61, 0
    v_accvgpr_write_b32 a62, 0
    v_accvgpr_write_b32 a63, 0
    v_accvgpr_write_b32 a144, 0
    v_accvgpr_write_b32 a145, 0
    v_accvgpr_write_b32 a146, 0
    v_accvgpr_write_b32 a147, 0
    v_accvgpr_write_b32 a148, 0
    v_accvgpr_write_b32 a149, 0
    v_accvgpr_write_b32 a150, 0
    v_accvgpr_write_b32 a151, 0
    v_accvgpr_write_b32 a152, 0
    v_accvgpr_write_b32 a153, 0
    v_accvgpr_write_b32 a154, 0
    v_accvgpr_write_b32 a155, 0
    v_accvgpr_write_b32 a156, 0
    v_accvgpr_write_b32 a157, 0
    v_accvgpr_write_b32 a158, 0
    v_accvgpr_write_b32 a159, 0
    v_accvgpr_write_b32 a160, 0
    v_accvgpr_write_b32 a161, 0
    v_accvgpr_write_b32 a162, 0
    v_accvgpr_write_b32 a163, 0
    v_accvgpr_write_b32 a164, 0
    v_accvgpr_write_b32 a165, 0
    v_accvgpr_write_b32 a166, 0
    v_accvgpr_write_b32 a167, 0
    v_accvgpr_write_b32 a168, 0
    v_accvgpr_write_b32 a169, 0
    v_accvgpr_write_b32 a170, 0
    v_accvgpr_write_b32 a171, 0
    v_accvgpr_write_b32 a172, 0
    v_accvgpr_write_b32 a173, 0
    v_accvgpr_write_b32 a174, 0
    v_accvgpr_write_b32 a175, 0
    v_accvgpr_write_b32 a176, 0
    v_accvgpr_write_b32 a177, 0
    v_accvgpr_write_b32 a178, 0
    v_accvgpr_write_b32 a179, 0
    v_accvgpr_write_b32 a180, 0
    v_accvgpr_write_b32 a181, 0
    v_accvgpr_write_b32 a182, 0
    v_accvgpr_write_b32 a183, 0
    v_accvgpr_write_b32 a184, 0
    v_accvgpr_write_b32 a185, 0
    v_accvgpr_write_b32 a186, 0
    v_accvgpr_write_b32 a187, 0
    v_accvgpr_write_b32 a188, 0
    v_accvgpr_write_b32 a189, 0
    v_accvgpr_write_b32 a190, 0
    v_accvgpr_write_b32 a191, 0
    v_accvgpr_write_b32 a192, 0
    v_accvgpr_write_b32 a193, 0
    v_accvgpr_write_b32 a194, 0
    v_accvgpr_write_b32 a195, 0
    v_accvgpr_write_b32 a196, 0
    v_accvgpr_write_b32 a197, 0
    v_accvgpr_write_b32 a198, 0
    v_accvgpr_write_b32 a199, 0
    v_accvgpr_write_b32 a200, 0
    v_accvgpr_write_b32 a201, 0
    v_accvgpr_write_b32 a202, 0
    v_accvgpr_write_b32 a203, 0
    v_accvgpr_write_b32 a204, 0
    v_accvgpr_write_b32 a205, 0
    v_accvgpr_write_b32 a206, 0
    v_accvgpr_write_b32 a207, 0
    v_accvgpr_write_b32 a208, 0
    v_accvgpr_write_b32 a209, 0
    v_accvgpr_write_b32 a210, 0
    v_accvgpr_write_b32 a211, 0
    v_accvgpr_write_b32 a212, 0
    v_accvgpr_write_b32 a213, 0
    v_accvgpr_write_b32 a214, 0
    v_accvgpr_write_b32 a215, 0
    v_accvgpr_write_b32 a216, 0
    v_accvgpr_write_b32 a217, 0
    v_accvgpr_write_b32 a218, 0
    v_accvgpr_write_b32 a219, 0
    v_accvgpr_write_b32 a220, 0
    v_accvgpr_write_b32 a221, 0
    v_accvgpr_write_b32 a222, 0
    v_accvgpr_write_b32 a223, 0
    v_bfe_u32 v92, v1, 4, 1
    v_sub_u32 v92, 0, v92
    v_and_b32 v92, 0xaaaaaaaa, v92
    v_or_b32 v215, 0x44444444, v92
    v_bfe_u32 v92, v1, 5, 1
    v_cmp_eq_u32 vcc, 0, v92
    v_mov_b32 v92, 0x3f803f80
    s_nop 0
    v_cndmask_b32 v92, 0, v92, vcc
    v_accvgpr_write_b32 a136, v92
    v_accvgpr_write_b32 a137, v92
    v_accvgpr_write_b32 a138, v92
    v_accvgpr_write_b32 a139, v92
    s_mov_b32 s77, s75
    s_mov_b32 s76, 0
    s_mov_b32 s38, 16384
    s_add_u32 m0, s76, s75
    s_nop 0
    buffer_load_dwordx4 v1, s[36:39], s77 offen sc1 lds
    buffer_load_dwordx4 v1, s[36:39], s77 offen offset:1024 sc1 lds
    buffer_load_dwordx4 v1, s[36:39], s77 offen offset:2048 sc1 lds
    buffer_load_dwordx4 v1, s[36:39], s77 offen offset:3072 sc1 lds
    s_add_u32 s100, s77, 4096
    s_add_u32 m0, m0, 4096
    s_nop 0
    buffer_load_dwordx4 v1, s[36:39], s100 offen sc1 lds
    buffer_load_dwordx4 v1, s[36:39], s100 offen offset:1024 sc1 lds
    buffer_load_dwordx4 v1, s[36:39], s100 offen offset:2048 sc1 lds
    buffer_load_dwordx4 v1, s[36:39], s100 offen offset:3072 sc1 lds
    s_add_u32 s77, s77, 32768
    s_add_u32 s76, s76, 32768
    s_lshr_b32 s82, s4, 1
    s_add_u32 s82, s82, 32
    s_sub_u32 s82, s82, s6
    s_sub_u32 s82, s82, s6
    s_lshl_b32 s38, s82, 15
    s_add_u32 m0, s76, s75
    s_nop 0
    buffer_load_dwordx4 v1, s[36:39], s77 offen sc1 lds
    buffer_load_dwordx4 v1, s[36:39], s77 offen offset:1024 sc1 lds
    buffer_load_dwordx4 v1, s[36:39], s77 offen offset:2048 sc1 lds
    buffer_load_dwordx4 v1, s[36:39], s77 offen offset:3072 sc1 lds
    s_add_u32 s100, s77, 4096
    s_add_u32 m0, m0, 4096
    s_nop 0
    buffer_load_dwordx4 v1, s[36:39], s100 offen sc1 lds
    buffer_load_dwordx4 v1, s[36:39], s100 offen offset:1024 sc1 lds
    buffer_load_dwordx4 v1, s[36:39], s100 offen offset:2048 sc1 lds
    buffer_load_dwordx4 v1, s[36:39], s100 offen offset:3072 sc1 lds
    s_add_u32 s77, s77, 32768
    s_add_u32 s76, s76, 32768
    s_add_u32 m0, s76, s75
    s_nop 0
    buffer_load_dwordx4 v1, s[36:39], s77 offen sc1 lds
    buffer_load_dwordx4 v1, s[36:39], s77 offen offset:1024 sc1 lds
    buffer_load_dwordx4 v1, s[36:39], s77 offen offset:2048 sc1 lds
    buffer_load_dwordx4 v1, s[36:39], s77 offen offset:3072 sc1 lds
    s_add_u32 s100, s77, 4096
    s_add_u32 m0, m0, 4096
    s_nop 0
    buffer_load_dwordx4 v1, s[36:39], s100 offen sc1 lds
    buffer_load_dwordx4 v1, s[36:39], s100 offen offset:1024 sc1 lds
    buffer_load_dwordx4 v1, s[36:39], s100 offen offset:2048 sc1 lds
    buffer_load_dwordx4 v1, s[36:39], s100 offen offset:3072 sc1 lds
    s_add_u32 s77, s77, 32768
    s_add_u32 s76, s76, 32768
    s_add_u32 s86, s101, 4096
    s_mov_b32 s87, 3072
    s_cmp_eq_u32 s6, 7
    s_cselect_b32 s86, s101, s86
    s_cselect_b32 s87, 0, s87
    s_sub_u32 s7, s101, 4096
    s_mov_b32 s98, 0
    s_cmp_eq_u32 s6, 0
    s_cselect_b32 s7, s101, s7
    s_cselect_b32 s98, 1073741824, s98
    s_bitcmp1_b32 s4, 0
    s_cselect_b32 s86, s86, s7
    s_cselect_b32 s87, s87, s98
    s_mul_i32 s7, s86, 48
    s_add_u32 s87, s87, s7
    s_add_u32 s87, s87, 19922944
    s_mov_b32 s82, 0
    s_mov_b32 s95, 32768
    s_mov_b32 s93, 65536
    s_mov_b32 s60, 131072
    v_mov_b32 v2, v1
    s_cmp_eq_u32 s6, 0
    s_cselect_b32 s16, s8, 0
    s_cselect_b32 s17, s9, 0
    s_cmp_eq_u32 s6, 0
    s_cselect_b32 s18, s10, 0
    s_cselect_b32 s19, s11, 0
    s_cmp_eq_u32 s6, 0
    s_cselect_b32 s20, s12, 0
    s_cselect_b32 s21, s13, 0
    s_cmp_eq_u32 s6, 0
    s_cselect_b32 s22, s14, 0
    s_cselect_b32 s23, s15, 0
    s_waitcnt vmcnt(16)
    s_barrier
    ds_read_b128 a[224:227], v2 offset:0
    ds_read_b128 a[228:231], v2 offset:1024
    ds_read_b128 a[232:235], v2 offset:2048
    ds_read_b128 a[236:239], v2 offset:3072
    s_waitcnt lgkmcnt(0)
    ds_read_b128 a[240:243], v2 offset:4096
    ds_read_b128 a[244:247], v2 offset:5120
    ds_read_b128 a[248:251], v2 offset:6144
    ds_read_b128 a[252:255], v2 offset:7168
    v_mul_f32 v176, s16, v208
    v_mul_f32 v177, s16, v209
    v_mul_f32 v178, s16, v210
    v_mul_f32 v179, s16, v211
    s_nop 1
    v_mfma_f32_16x16x32_bf16 v[240:243], a[224:227], v[128:131], v[176:179]
    v_mfma_f32_16x16x32_bf16 v[240:243], a[228:231], v[160:163], v[240:243]
    v_mfma_f32_16x16x32_bf16 v[240:243], a[232:235], v[192:195], v[240:243]
    v_mfma_f32_16x16x32_bf16 v[240:243], a[236:239], v[224:227], v[240:243]
    v_mfma_f32_16x16x32_bf16 v[244:247], a[224:227], v[132:135], 0
    v_mfma_f32_16x16x32_bf16 v[244:247], a[228:231], v[164:167], v[244:247]
    v_mfma_f32_16x16x32_bf16 v[244:247], a[232:235], v[196:199], v[244:247]
    v_mfma_f32_16x16x32_bf16 v[244:247], a[236:239], v[228:231], v[244:247]
    v_mfma_f32_16x16x32_bf16 v[248:251], a[224:227], v[136:139], 0
    v_mfma_f32_16x16x32_bf16 v[248:251], a[228:231], v[168:171], v[248:251]
    v_mfma_f32_16x16x32_bf16 v[248:251], a[232:235], v[200:203], v[248:251]
    v_mfma_f32_16x16x32_bf16 v[248:251], a[236:239], v[232:235], v[248:251]
    v_mfma_f32_16x16x32_bf16 v[252:255], a[224:227], v[140:143], 0
    v_mfma_f32_16x16x32_bf16 v[252:255], a[228:231], v[172:175], v[252:255]
    v_mfma_f32_16x16x32_bf16 v[252:255], a[232:235], v[204:207], v[252:255]
    v_mfma_f32_16x16x32_bf16 v[252:255], a[236:239], v[236:239], v[252:255]
    v_add_f32 v240, v240, v144
    v_exp_f32 v240, v240
    v_add_f32 v241, v241, v144
    v_exp_f32 v241, v241
    v_add_f32 v242, v242, v144
    v_exp_f32 v242, v242
    v_add_f32 v243, v243, v144
    v_exp_f32 v243, v243
    v_add_f32 v244, v244, v148
    v_exp_f32 v244, v244
    v_add_f32 v245, v245, v148
    v_exp_f32 v245, v245
    v_add_f32 v246, v246, v148
    v_exp_f32 v246, v246
    v_add_f32 v247, v247, v148
    v_exp_f32 v247, v247
    v_add_f32 v248, v248, v152
    v_exp_f32 v248, v248
    v_add_f32 v249, v249, v152
    v_exp_f32 v249, v249
    v_add_f32 v250, v250, v152
    v_exp_f32 v250, v250
    v_add_f32 v251, v251, v152
    v_exp_f32 v251, v251
    v_add_f32 v252, v252, v156
    v_exp_f32 v252, v252
    v_add_f32 v253, v253, v156
    v_exp_f32 v253, v253
    v_add_f32 v254, v254, v156
    v_exp_f32 v254, v254
    v_add_f32 v255, v255, v156
    v_exp_f32 v255, v255
    s_nop 1
    s_branch K1_ATT
SPIN_WA:
    s_mov_b32 s94, 0
SPIN_WA_L:
    s_sleep 2
    buffer_load_dword v7, v9, s[44:47], s69 offen sc1
    s_add_u32 s94, s94, 1
    s_cmp_ge_u32 s94, 0x40000
    s_waitcnt vmcnt(0)
    s_cbranch_scc1 BACK_WA
    v_cmp_gt_u32 vcc, 8, v7
    s_nop 1
    s_and_b64 vcc, vcc, s[86:87]
    s_cbranch_scc1 SPIN_WA_L
    s_branch BACK_WA
SPIN_KV:
    s_mov_b32 s94, 0
SPIN_KV_L:
    s_sleep 2
    buffer_load_dword v7, v8, s[32:35], s61 offen sc1
    s_add_u32 s94, s94, 1
    s_cmp_ge_u32 s94, 0x40000
    s_waitcnt vmcnt(0)
    s_cbranch_scc1 BACK_KV
    v_cmp_gt_u32 vcc, 1, v7
    s_nop 1
    s_and_b64 vcc, vcc, exec
    s_cbranch_scc1 SPIN_KV_L
    s_branch BACK_KV
SPIN_SHORT:
    s_mov_b32 s94, 0
SPIN_SHORT_L:
    s_sleep 2
    buffer_load_dword v3, v217, s[32:35], s19 offen sc1
    s_add_u32 s94, s94, 1
    s_cmp_ge_u32 s94, 0x40000
    s_waitcnt vmcnt(0)
    s_cbranch_scc1 BACK_SHORT
    v_cmp_gt_u32 vcc, 1, v3
    s_nop 1
    s_and_b64 vcc, vcc, exec
    s_cbranch_scc1 SPIN_SHORT_L
    s_branch BACK_SHORT
SPIN_CTX:
    s_mov_b32 s94, 0
SPIN_CTX_L:
    s_sleep 2
    buffer_load_dword v3, v217, s[32:35], s19 offen sc1
    s_add_u32 s94, s94, 1
    s_cmp_ge_u32 s94, 0x40000
    s_waitcnt vmcnt(0)
    s_cbranch_scc1 BACK_CTX
    v_cmp_gt_u32 vcc, 2, v3
    s_nop 1
    s_and_b64 vcc, vcc, exec
    s_cbranch_scc1 SPIN_CTX_L
    s_branch BACK_CTX
SPIN_ALL:
    s_mov_b32 s94, 0
SPIN_ALL_L:
    s_sleep 2
    buffer_load_dword v28, v29, s[32:35], s92 offen sc1
    s_add_u32 s94, s94, 1
    s_cmp_ge_u32 s94, 0x40000
    s_waitcnt vmcnt(0)
    s_cbranch_scc1 BACK_ALL
    v_cmp_gt_u32 vcc, 1, v28
    s_nop 1
    s_and_b64 vcc, vcc, exec
    s_cbranch_scc1 SPIN_ALL_L
    s_branch BACK_ALL
SPIN_OA:
    s_mov_b32 s94, 0
SPIN_OA_L:
    s_sleep 2
    buffer_load_dword v3, v19, s[32:35], s66 offen sc1
    s_add_u32 s94, s94, 1
    s_cmp_ge_u32 s94, 0x40000
    s_waitcnt vmcnt(0)
    s_cbranch_scc1 BACK_OA
    v_cmp_gt_u32 vcc, 3, v3
    s_nop 1
    s_and_b64 vcc, vcc, exec
    s_cbranch_scc1 SPIN_OA_L
    s_branch BACK_OA
SPIN_X:
    s_mov_b32 s94, 0
SPIN_X_L:
    s_sleep 2
    buffer_load_dword v3, v19, s[32:35], s66 offen sc1
    s_add_u32 s94, s94, 1
    s_cmp_ge_u32 s94, 0x40000
    s_waitcnt vmcnt(0)
    s_cbranch_scc1 BACK_X
    v_cmp_gt_u32 vcc, 3, v3
    s_nop 1
    s_and_b64 vcc, vcc, exec
    s_cbranch_scc1 SPIN_X_L
    s_branch BACK_X
SPIN_W0H:
    s_mov_b32 s94, 0
SPIN_W0H_L:
    s_sleep 2
    buffer_load_dword v28, off, s[32:35], s86 sc1
    s_add_u32 s94, s94, 1
    s_cmp_ge_u32 s94, 0x40000
    s_waitcnt vmcnt(0)
    s_cbranch_scc1 BACK_W0H
    v_cmp_gt_u32 vcc, 2, v28
    s_nop 1
    s_and_b64 vcc, vcc, exec
    s_cbranch_scc1 SPIN_W0H_L
    s_branch BACK_W0H
SPIN_W0:
    s_mov_b32 s94, 0
SPIN_W0_L:
    s_sleep 2
    buffer_load_dword v3, v29, s[32:35], s92 offen sc1
    s_add_u32 s94, s94, 1
    s_cmp_ge_u32 s94, 0x40000
    s_waitcnt vmcnt(0)
    s_cbranch_scc1 BACK_W0
    v_cmp_gt_u32 vcc, 1, v3
    s_nop 1
    s_cmp_lg_u32 vcc_lo, 0
    s_cbranch_scc1 SPIN_W0_L
    s_branch BACK_W0
SPIN_W7H:
    s_mov_b32 s94, 0
SPIN_W7H_L:
    s_sleep 2
    buffer_load_dword v28, off, s[32:35], s86 sc1
    s_add_u32 s94, s94, 1
    s_cmp_ge_u32 s94, 0x40000
    s_waitcnt vmcnt(0)
    s_cbranch_scc1 BACK_W7H
    v_cmp_gt_u32 vcc, 2, v28
    s_nop 1
    s_and_b64 vcc, vcc, exec
    s_cbranch_scc1 SPIN_W7H_L
    s_branch BACK_W7H
SPIN_W7:
    s_mov_b32 s94, 0
SPIN_W7_L:
    s_sleep 2
    buffer_load_dword v3, v29, s[32:35], s92 offen sc1
    s_add_u32 s94, s94, 1
    s_cmp_ge_u32 s94, 0x40000
    s_waitcnt vmcnt(0)
    s_cbranch_scc1 BACK_W7
    v_cmp_gt_u32 vcc, 1, v3
    s_nop 1
    s_cmp_lg_u32 vcc_lo, 0
    s_cbranch_scc1 SPIN_W7_L
    s_branch BACK_W7
.section .rodata,"a"
.p2align 6
.amdhsa_kernel gated_mix__sliding_local_dilated__compressed_kv_cla__prompt_kernel
.amdhsa_next_free_vgpr 512
.amdhsa_next_free_sgpr 102
.amdhsa_accum_offset 256
.amdhsa_group_segment_fixed_size 0
.amdhsa_kernarg_size 104
.amdhsa_user_sgpr_count 2
.amdhsa_user_sgpr_kernarg_segment_ptr 1
.amdhsa_system_sgpr_workgroup_id_x 1
.amdhsa_ieee_mode 0
.amdhsa_dx10_clamp 0
.end_amdhsa_kernel
```

```asm
; @launch grid=(256,1,1) block=(256,1,1) lds=163840
.amdgcn_target "amdgcn-amd-amdhsa--gfx950"
.text
.globl gated_mix__sliding_local_dilated__compressed_kv_cla__prompt_kernel
.p2align 8
.type gated_mix__sliding_local_dilated__compressed_kv_cla__prompt_kernel,@function
gated_mix__sliding_local_dilated__compressed_kv_cla__prompt_kernel:
    s_cmp_ge_u32 s2, 256
    s_cbranch_scc1 K1_END
    s_getpc_b64 s[94:95]
    s_load_dwordx8 s[36:43], s[0:1], 32
    v_min_u32 v74, 16, v0
    s_lshr_b32 s7, s2, 3
    s_mul_i32 s7, s7, 17
    v_add_lshl_u32 v74, v74, s7, 7
    global_load_dword v76, v74, s[94:95]
    v_lshrrev_b32 v64, 6, v0
    v_and_b32 v31, 63, v0
    v_readfirstlane_b32 s4, v64
    s_and_b32 s5, s2, 7
    s_lshl_b32 s5, s5, 2
    s_bfe_u32 s7, s2, 0x20003
    s_add_u32 s5, s5, s7
    s_lshr_b32 s6, s2, 5
    s_lshl_b32 s69, s4, 12
    s_mov_b32 s10, 2097152
    s_mov_b32 s11, 0x20000
    s_mov_b32 s14, 4194304
    s_mov_b32 s15, 0x20000
    s_mov_b32 s18, 4194304
    s_mov_b32 s19, 0x20000
    v_lshrrev_b32 v65, 3, v31
    v_and_b32 v66, 7, v31
    v_lshrrev_b32 v67, 1, v65
    v_xor_b32 v66, v66, v67
    v_lshlrev_b32 v66, 4, v66
    v_xor_b32 v67, 64, v66
    s_lshr_b32 s7, s4, 1
    s_lshl_b32 s73, s7, 7
    s_and_b32 s100, s4, 1
    s_lshl_b32 s98, s100, 5
    s_add_u32 s98, s98, s73
    v_add_lshl_u32 v68, v65, s98, 10
    v_add_u32 v6, v68, v66
    v_add_u32 v7, v68, v67
    v_add_u32 v7, 7168, v7
    v_add_u32 v8, v68, v66
    v_add_u32 v8, 14336, v8
    v_add_u32 v9, v68, v67
    v_add_u32 v9, 21504, v9
    v_lshrrev_b32 v69, 4, v31
    v_and_b32 v70, 15, v31
    v_lshlrev_b32 v71, 1, v69
    v_xor_b32 v71, v71, v70
    v_lshlrev_b32 v71, 4, v71
    v_xor_b32 v72, 128, v71
    s_lshl_b32 s98, s4, 4
    v_add_lshl_u32 v73, v69, s98, 13
    v_add_u32 v2, v73, v71
    v_add_u32 v3, v73, v71
    v_add_u32 v3, 31744, v3
    v_add_u32 v4, v73, v72
    v_add_u32 v4, 63488, v4
    v_add_u32 v5, v73, v72
    v_add_u32 v5, 95232, v5
    s_and_b32 s3, s2, 0
    s_lshl_b32 s66, s3, 7
    s_lshl_b32 s60, s3, 11
    s_add_u32 s60, s60, s5
    s_lshl_b32 s60, s60, 8
    s_lshl_b32 s61, s6, 18
    s_add_u32 s61, s61, s66
    s_add_u32 s62, s61, 65536
    s_waitcnt lgkmcnt(0)
    s_mov_b64 s[8:9], s[36:37]
    s_mov_b64 s[24:25], s[38:39]
    s_mov_b64 s[12:13], s[40:41]
    s_mov_b64 s[16:17], s[42:43]
    s_load_dwordx2 s[20:21], s[0:1], 0
    s_load_dwordx2 s[28:29], s[0:1], 8
    s_load_dwordx2 s[32:33], s[0:1], 72
    s_load_dwordx2 s[48:49], s[0:1], 64
    s_load_dwordx2 s[92:93], s[0:1], 16
    s_load_dwordx2 s[44:45], s[0:1], 88
    s_load_dwordx2 s[56:57], s[0:1], 96
    s_load_dwordx2 s[0:1], s[0:1], 80
    s_add_u32 m0, s69, 0
    s_nop 0
    buffer_load_dwordx4 v6, s[8:11], s61 offen lds
    buffer_load_dwordx4 v7, s[8:11], s61 offen offset:1024 lds
    buffer_load_dwordx4 v8, s[8:11], s61 offen offset:2048 lds
    buffer_load_dwordx4 v9, s[8:11], s61 offen offset:3072 lds
    s_xor_b32 s61, s61, 128
    s_add_u32 m0, s69, 16384
    s_nop 0
    buffer_load_dwordx4 v6, s[8:11], s62 offen lds
    buffer_load_dwordx4 v7, s[8:11], s62 offen offset:1024 lds
    buffer_load_dwordx4 v8, s[8:11], s62 offen offset:2048 lds
    buffer_load_dwordx4 v9, s[8:11], s62 offen offset:3072 lds
    s_xor_b32 s62, s62, 128
    s_add_u32 m0, s69, 32768
    s_nop 0
    buffer_load_dwordx4 v2, s[12:15], s60 offen nt lds
    buffer_load_dwordx4 v3, s[12:15], s60 offen offset:1024 nt lds
    buffer_load_dwordx4 v4, s[12:15], s60 offen offset:2048 nt lds
    buffer_load_dwordx4 v5, s[12:15], s60 offen offset:3072 nt lds
    s_add_u32 m0, s69, 49152
    s_nop 0
    buffer_load_dwordx4 v6, s[8:11], s61 offen lds
    buffer_load_dwordx4 v7, s[8:11], s61 offen offset:1024 lds
    buffer_load_dwordx4 v8, s[8:11], s61 offen offset:2048 lds
    buffer_load_dwordx4 v9, s[8:11], s61 offen offset:3072 lds
    s_xor_b32 s61, s61, 384
    s_waitcnt lgkmcnt(0)
    s_mov_b32 s22, 2359296
    s_mov_b32 s23, 0x20000
    s_mov_b32 s26, 4718592
    s_mov_b32 s27, 0x20000
    s_mov_b32 s50, 4718592
    s_mov_b32 s51, 0x20000
    s_mov_b32 s46, 256
    s_mov_b32 s47, 0x20000
    s_mov_b32 s30, 1990656
    s_mov_b32 s31, 0x20000
    s_mov_b32 s34, 1152
    s_mov_b32 s35, 0x20000
    s_mul_i32 s7, s5, 1081344
    s_add_u32 s36, s56, s7
    s_addc_u32 s37, s57, 0
    s_mov_b32 s38, 1081344
    s_mov_b32 s39, 0x20000
    s_cmp_eq_u32 s4, 0
    s_cselect_b32 s86, 0x55555555, 0
    s_cselect_b32 s87, 0x55555555, 0
    s_cselect_b32 s52, s48, s92
    s_cselect_b32 s53, s49, s93
    s_cselect_b32 s54, s50, 663552
    s_mov_b32 s55, 0x20000
    s_mul_i32 s63, s6, 147456
    s_sub_u32 s64, 2211840, s63
    s_add_u32 s63, s63, s66
    s_add_u32 s64, s64, s66
    s_lshl_b32 s67, s4, 11
    s_lshl_b32 s68, s4, 10
    s_lshl_b32 s75, s4, 13
    s_lshl_b32 s65, s3, 13
    s_add_u32 s65, s65, s67
    s_lshl_b32 s70, s6, 2
    s_lshl1_add_u32 s70, s100, s70
    s_lshl_b32 s70, s70, 15
    s_lshl_b32 s98, s73, 6
    s_add_u32 s71, s70, s98
    s_add_u32 s71, s71, 49152
    s_lshl_b32 s98, s73, 4
    s_add_u32 s70, s70, s98
    v_lshlrev_b32 v1, 4, v31
    v_mov_b32 v77, 1073741824
    v_cmp_eq_u32 vcc, 0, v0
    s_nop 1
    v_cndmask_b32_e64 v30, v77, 0, vcc
    v_lshlrev_b32 v103, 7, v31
    v_cmp_gt_u32 vcc, 9, v31
    s_nop 1
    v_cndmask_b32 v103, v77, v103, vcc
    s_lshl_b32 s98, s4, 5
    v_add_u32 v68, s98, v65
    v_mul_u32_u24 v68, 1152, v68
    v_add_u32 v10, v68, v66
    v_add_u32 v11, v68, v67
    v_add_u32 v11, 8192, v11
    v_add_u32 v12, v68, v66
    v_add_u32 v12, 16384, v12
    v_add_u32 v13, v68, v67
    v_add_u32 v13, 24576, v13
    v_lshrrev_b32 v71, 1, v70
    v_xor_b32 v71, v71, v69
    v_lshlrev_b32 v71, 4, v71
    v_lshl_add_u32 v71, v70, 7, v71
    s_add_u32 m0, s69, 65536
    s_nop 0
    buffer_load_dwordx4 v2, s[16:19], s60 offen nt lds
    v_xor_b32 v72, 64, v71
    s_lshl_b32 s98, s100, 13
    v_add_u32 v22, s98, v71
    v_add_u32 v23, s98, v72
    v_add_u32 v24, s67, v71
    v_add_u32 v25, s67, v72
    v_bfe_u32 v73, v31, 2, 2
    v_and_b32 v74, 3, v31
    v_lshl_add_u32 v75, v69, 3, v73
    v_and_b32 v78, 1, v69
    v_lshl_add_u32 v77, v78, 2, v73
    v_lshlrev_b32 v77, 5, v77
    v_lshl_add_u32 v77, v74, 3, v77
    v_lshl_add_u32 v77, v75, 8, v77
    v_xor_b32 v14, 0, v77
    v_xor_b32 v14, s73, v14
    buffer_load_dwordx4 v3, s[16:19], s60 offen offset:1024 nt lds
    v_xor_b32 v15, 32, v77
    v_xor_b32 v15, s73, v15
    v_xor_b32 v16, 64, v77
    v_xor_b32 v16, s73, v16
    v_xor_b32 v17, 96, v77
    v_xor_b32 v17, s73, v17
    v_xor_b32 v18, 128, v77
    v_xor_b32 v19, 160, v77
    v_xor_b32 v20, 192, v77
    v_xor_b32 v21, 224, v77
    v_lshrrev_b32 v77, 1, v73
    v_lshl_add_u32 v77, v78, 1, v77
    v_lshlrev_b32 v77, 5, v77
    v_lshl_add_u32 v77, v74, 3, v77
    v_lshl_add_u32 v77, v75, 7, v77
    s_lshr_b32 s98, s73, 1
    buffer_load_dwordx4 v4, s[16:19], s60 offen offset:2048 nt lds
    v_xor_b32 v26, 0, v77
    v_xor_b32 v26, s98, v26
    v_xor_b32 v27, 32, v77
    v_xor_b32 v28, 64, v77
    v_xor_b32 v28, s98, v28
    v_xor_b32 v29, 96, v77
    v_and_b32 v73, 7, v0
    v_lshrrev_b32 v74, 3, v0
    v_lshl_add_u32 v75, v73, 1, 0
    v_mul_u32_u24 v78, 52, v75
    v_lshrrev_b32 v78, 8, v78
    v_mul_u32_u24 v79, 5, v78
    v_sub_u32 v75, v75, v79
    v_add_u32 v78, 1, v78
    v_cmp_le_u32 vcc, 3, v78
    s_nop 1
    v_cndmask_b32_e64 v78, v78, 0, vcc
    buffer_load_dwordx4 v5, s[16:19], s60 offen offset:3072 nt lds
    s_xor_b32 s60, s60, 524288
    v_mul_u32_u24 v78, 1152, v78
    v_lshl_add_u32 v75, v75, 3, v78
    v_mad_u32_u24 v75, v74, 36, v75
    v_lshl_add_u32 v77, v73, 1, 1
    v_mul_u32_u24 v78, 52, v77
    v_lshrrev_b32 v78, 8, v78
    v_mul_u32_u24 v79, 5, v78
    v_sub_u32 v77, v77, v79
    v_add_u32 v78, 1, v78
    v_cmp_le_u32 vcc, 3, v78
    s_nop 1
    v_cndmask_b32_e64 v78, v78, 0, vcc
    v_mul_u32_u24 v78, 1152, v78
    v_lshl_add_u32 v77, v77, 3, v78
    v_mad_u32_u24 v77, v74, 36, v77
    s_mul_i32 s98, s2, 10368
    s_mul_i32 s99, s2, 6
    s_mov_b32 s7, 73728
    v_mul_lo_u32 v95, v74, s7
    v_lshl_add_u32 v95, v73, 4, v95
    v_cmp_eq_u32 s[92:93], 7, v73
    s_add_u32 s56, s56, 56623104
    s_addc_u32 s57, s57, 0
    s_mov_b32 s58, 5603328
    s_mov_b32 s59, 0x20000
    s_lshl_b32 s101, s6, 5
    s_add_u32 s101, s101, s5
    s_lshl_b32 s101, s101, 7
    v_mov_b32 v65, 0
    v_lshrrev_b32 v64, 2, v0
    v_lshlrev_b32 v64, 15, v64
    v_and_b32 v79, 3, v0
    v_lshl_add_u32 v64, v79, 2, v64
    s_mov_b32 s74, 0x3e0293ee
    s_lshl_b32 s95, s5, 3
    s_waitcnt vmcnt(8)
    s_barrier
    ds_read_b128 a[0:3], v22 offset:0
    ds_read_b64_tr_b16 v[40:41], v14 offset:32768
    ds_read_b64_tr_b16 v[42:43], v14 offset:33792
    ds_read_b128 a[4:7], v23 offset:0
    ds_read_b64_tr_b16 v[44:45], v14 offset:40960
    ds_read_b64_tr_b16 v[46:47], v14 offset:41984
    ds_read_b128 a[8:11], v22 offset:2048
    ds_read_b128 a[12:15], v23 offset:2048
    ds_read_b128 a[16:19], v22 offset:4096
    ds_read_b128 a[20:23], v23 offset:4096
    ds_read_b128 a[24:27], v22 offset:6144
    ds_read_b128 a[28:31], v23 offset:6144
    ds_read_b128 a[32:35], v22 offset:16384
    ds_read_b128 a[36:39], v23 offset:16384
    ds_read_b128 a[40:43], v22 offset:18432
    s_waitcnt lgkmcnt(14)
    ds_read_b128 a[44:47], v23 offset:18432
    s_waitcnt lgkmcnt(14)
    ds_read_b128 a[48:51], v22 offset:20480
    s_waitcnt lgkmcnt(14)
    ds_read_b128 a[52:55], v23 offset:20480
    s_waitcnt lgkmcnt(14)
    ds_read_b128 a[56:59], v22 offset:22528
    s_waitcnt lgkmcnt(14)
    ds_read_b128 a[60:63], v23 offset:22528
    v_mfma_f32_16x16x32_bf16 v[128:131], v[40:43], a[0:3], 0
    s_add_u32 m0, s69, 81920
    s_waitcnt lgkmcnt(14)
    ds_read_b64_tr_b16 v[48:49], v15 offset:32768
    s_waitcnt lgkmcnt(14)
    ds_read_b64_tr_b16 v[50:51], v15 offset:33792
    v_mfma_f32_16x16x32_bf16 v[128:131], v[44:47], a[4:7], v[128:131]
    s_mul_i32 s77, s2, 9216
    buffer_load_dwordx4 v6, s[8:11], s62 offen lds
    v_mfma_f32_16x16x32_bf16 v[132:135], v[40:43], a[8:11], 0
    s_mul_i32 s76, s4, 1152
    s_waitcnt lgkmcnt(14)
    ds_read_b64_tr_b16 v[52:53], v15 offset:40960
    s_waitcnt lgkmcnt(13)
    ds_read_b64_tr_b16 v[54:55], v15 offset:41984
    v_mfma_f32_16x16x32_bf16 v[132:135], v[44:47], a[12:15], v[132:135]
    s_add_u32 s77, s77, s76
    ds_read_b64_tr_b16 v[56:57], v16 offset:32768
    s_waitcnt lgkmcnt(10)
    ds_read_b64_tr_b16 v[58:59], v16 offset:33792
    v_mfma_f32_16x16x32_bf16 v[136:139], v[40:43], a[16:19], 0
    s_mul_i32 s76, s4, 1152
    buffer_load_dwordx4 v7, s[8:11], s62 offen offset:1024 lds
    v_mfma_f32_16x16x32_bf16 v[136:139], v[44:47], a[20:23], v[136:139]
    s_mul_i32 s72, s2, 3
    ds_read_b64_tr_b16 v[60:61], v16 offset:40960
    ds_read_b64_tr_b16 v[62:63], v16 offset:41984
    v_mfma_f32_16x16x32_bf16 v[140:143], v[40:43], a[24:27], 0
    s_add_u32 s72, s72, 0
    v_add_u32 v14, 0x10000, v14
    v_add_u32 v15, 0x10000, v15
    v_mfma_f32_16x16x32_bf16 v[140:143], v[44:47], a[28:31], v[140:143]
    s_mul_i32 s7, s5, 73728
    v_add_u32 v16, 0x10000, v16
    v_mov_b32 v31, 1
    v_mfma_f32_16x16x32_bf16 v[144:147], v[40:43], a[32:35], 0
    s_and_b32 s100, s5, 1
    buffer_load_dwordx4 v8, s[8:11], s62 offen offset:2048 lds
    v_mfma_f32_16x16x32_bf16 v[144:147], v[44:47], a[36:39], v[144:147]
    s_mov_b32 vcc_lo, 0x84848484
    s_mov_b32 vcc_hi, 0x84848484
    v_add_u32 v18, 0x10000, v18
    v_mfma_f32_16x16x32_bf16 v[148:151], v[40:43], a[40:43], 0
    s_mov_b32 s83, 0
    v_add_u32 v19, 0x10000, v19
    v_add_u32 v20, 0x10000, v20
    s_waitcnt lgkmcnt(0)
    v_mfma_f32_16x16x32_bf16 v[148:151], v[44:47], a[44:47], v[148:151]
    v_add_u32 v21, 0x10000, v21
    v_add_u32 v26, 0x10000, v26
    v_mfma_f32_16x16x32_bf16 v[152:155], v[40:43], a[48:51], 0
    buffer_load_dwordx4 v9, s[8:11], s62 offen offset:3072 lds
    v_mfma_f32_16x16x32_bf16 v[152:155], v[44:47], a[52:55], v[152:155]
    v_add_u32 v27, 0x10000, v27
    v_add_u32 v28, 0x10000, v28
    v_mfma_f32_16x16x32_bf16 v[156:159], v[40:43], a[56:59], 0
    s_add_u32 m0, s69, 98304
    ds_read_b64_tr_b16 v[40:41], v17 offset:32768
    ds_read_b64_tr_b16 v[42:43], v17 offset:33792
    v_mfma_f32_16x16x32_bf16 v[156:159], v[44:47], a[60:63], v[156:159]
    s_xor_b32 s62, s62, 384
    ds_read_b64_tr_b16 v[44:45], v17 offset:40960
    ds_read_b64_tr_b16 v[46:47], v17 offset:41984
    v_mfma_f32_16x16x32_bf16 v[160:163], v[48:51], a[0:3], 0
    buffer_load_dwordx4 v2, s[12:15], s60 offen nt lds
    v_mfma_f32_16x16x32_bf16 v[160:163], v[52:55], a[4:7], v[160:163]
    v_add_u32 v17, 0x10000, v17
    v_add_u32 v29, 0x10000, v29
    v_mfma_f32_16x16x32_bf16 v[164:167], v[48:51], a[8:11], 0
    v_bfe_u32 v37, v1, 4, 4
    v_mul_u32_u24 v36, 1152, v37
    v_mfma_f32_16x16x32_bf16 v[164:167], v[52:55], a[12:15], v[164:167]
    v_lshrrev_b32 v38, 8, v1
    v_lshl_add_u32 v36, v38, 4, v36
    v_mfma_f32_16x16x32_bf16 v[168:171], v[48:51], a[16:19], 0
    buffer_load_dwordx4 v3, s[12:15], s60 offen offset:1024 nt lds
    v_mfma_f32_16x16x32_bf16 v[168:171], v[52:55], a[20:23], v[168:171]
    v_lshrrev_b32 v39, 3, v37
    v_mul_u32_u24 v39, 9152, v39
    v_mfma_f32_16x16x32_bf16 v[172:175], v[48:51], a[24:27], 0
    v_mfma_f32_16x16x32_bf16 v[172:175], v[52:55], a[28:31], v[172:175]
    v_mfma_f32_16x16x32_bf16 v[176:179], v[48:51], a[32:35], 0
    buffer_load_dwordx4 v4, s[12:15], s60 offen offset:2048 nt lds
    v_mfma_f32_16x16x32_bf16 v[176:179], v[52:55], a[36:39], v[176:179]
    v_mfma_f32_16x16x32_bf16 v[180:183], v[48:51], a[40:43], 0
    v_mfma_f32_16x16x32_bf16 v[180:183], v[52:55], a[44:47], v[180:183]
    v_mfma_f32_16x16x32_bf16 v[184:187], v[48:51], a[48:51], 0
    buffer_load_dwordx4 v5, s[12:15], s60 offen offset:3072 nt lds
    v_mfma_f32_16x16x32_bf16 v[184:187], v[52:55], a[52:55], v[184:187]
    v_mfma_f32_16x16x32_bf16 v[188:191], v[48:51], a[56:59], 0
    s_waitcnt vmcnt(12)
    s_barrier
    v_mfma_f32_16x16x32_bf16 v[188:191], v[52:55], a[60:63], v[188:191]
    s_add_u32 m0, s69, 114688
    ds_read_b128 a[64:67], v22 offset:49152
    v_mfma_f32_16x16x32_bf16 v[192:195], v[56:59], a[0:3], 0
    buffer_load_dwordx4 v6, s[8:11], s61 offen lds
    v_mfma_f32_16x16x32_bf16 v[192:195], v[60:63], a[4:7], v[192:195]
    v_mfma_f32_16x16x32_bf16 v[196:199], v[56:59], a[8:11], 0
    ds_read_b128 a[68:71], v23 offset:49152
    v_mfma_f32_16x16x32_bf16 v[196:199], v[60:63], a[12:15], v[196:199]
    v_mfma_f32_16x16x32_bf16 v[200:203], v[56:59], a[16:19], 0
    buffer_load_dwordx4 v7, s[8:11], s61 offen offset:1024 lds
    v_mfma_f32_16x16x32_bf16 v[200:203], v[60:63], a[20:23], v[200:203]
    v_mfma_f32_16x16x32_bf16 v[204:207], v[56:59], a[24:27], 0
    ds_read_b128 a[72:75], v22 offset:51200
    v_mfma_f32_16x16x32_bf16 v[204:207], v[60:63], a[28:31], v[204:207]
    v_mfma_f32_16x16x32_bf16 v[208:211], v[56:59], a[32:35], 0
    buffer_load_dwordx4 v8, s[8:11], s61 offen offset:2048 lds
    v_mfma_f32_16x16x32_bf16 v[208:211], v[60:63], a[36:39], v[208:211]
    ds_read_b128 a[76:79], v23 offset:51200
    v_mfma_f32_16x16x32_bf16 v[212:215], v[56:59], a[40:43], 0
    v_mfma_f32_16x16x32_bf16 v[212:215], v[60:63], a[44:47], v[212:215]
    v_mfma_f32_16x16x32_bf16 v[216:219], v[56:59], a[48:51], 0
    buffer_load_dwordx4 v9, s[8:11], s61 offen offset:3072 lds
    v_mfma_f32_16x16x32_bf16 v[216:219], v[60:63], a[52:55], v[216:219]
    ds_read_b128 a[80:83], v22 offset:53248
    v_mfma_f32_16x16x32_bf16 v[220:223], v[56:59], a[56:59], 0
    s_xor_b32 s61, s61, 128
    v_mfma_f32_16x16x32_bf16 v[220:223], v[60:63], a[60:63], v[220:223]
    s_add_u32 m0, s69, 131072
    s_waitcnt lgkmcnt(1)
    v_mfma_f32_16x16x32_bf16 v[224:227], v[40:43], a[0:3], 0
    buffer_load_dwordx4 v2, s[16:19], s60 offen nt lds
    v_mfma_f32_16x16x32_bf16 v[224:227], v[44:47], a[4:7], v[224:227]
    ds_read_b128 a[84:87], v23 offset:53248
    v_mfma_f32_16x16x32_bf16 v[228:231], v[40:43], a[8:11], 0
    buffer_load_dword v104, v103, s[20:23], s77 offen
    v_mfma_f32_16x16x32_bf16 v[228:231], v[44:47], a[12:15], v[228:231]
    s_add_u32 s77, s77, 4608
    v_mfma_f32_16x16x32_bf16 v[232:235], v[40:43], a[16:19], 0
    ds_read_b128 a[88:91], v22 offset:55296
    v_mfma_f32_16x16x32_bf16 v[232:235], v[44:47], a[20:23], v[232:235]
    s_waitcnt vmcnt(10)
    s_barrier
    ds_read_b64_tr_b16 v[48:49], v14 offset:0
    v_mfma_f32_16x16x32_bf16 v[236:239], v[40:43], a[24:27], 0
    buffer_load_dwordx4 v3, s[16:19], s60 offen offset:1024 nt lds
    v_mfma_f32_16x16x32_bf16 v[236:239], v[44:47], a[28:31], v[236:239]
    ds_read_b64_tr_b16 v[50:51], v14 offset:1024
    ds_read_b64_tr_b16 v[52:53], v14 offset:8192
    v_mfma_f32_16x16x32_bf16 v[240:243], v[40:43], a[32:35], 0
    ds_read_b64_tr_b16 v[54:55], v14 offset:9216
    ds_read_b128 a[92:95], v23 offset:55296
    v_mfma_f32_16x16x32_bf16 v[240:243], v[44:47], a[36:39], v[240:243]
    buffer_load_dwordx4 v4, s[16:19], s60 offen offset:2048 nt lds
    v_mfma_f32_16x16x32_bf16 v[244:247], v[40:43], a[40:43], 0
    ds_read_b64_tr_b16 v[56:57], v15 offset:0
    ds_read_b64_tr_b16 v[58:59], v15 offset:1024
    v_mfma_f32_16x16x32_bf16 v[244:247], v[44:47], a[44:47], v[244:247]
    ds_read_b64_tr_b16 v[60:61], v15 offset:8192
    ds_read_b64_tr_b16 v[62:63], v15 offset:9216
    v_mfma_f32_16x16x32_bf16 v[248:251], v[40:43], a[48:51], 0
    v_mfma_f32_16x16x32_bf16 v[248:251], v[44:47], a[52:55], v[248:251]
    buffer_load_dwordx4 v5, s[16:19], s60 offen offset:3072 nt lds
    v_mfma_f32_16x16x32_bf16 v[252:255], v[40:43], a[56:59], 0
    ds_read_b64_tr_b16 v[40:41], v16 offset:0
    ds_read_b64_tr_b16 v[42:43], v16 offset:1024
    v_mfma_f32_16x16x32_bf16 v[252:255], v[44:47], a[60:63], v[252:255]
    s_waitcnt lgkmcnt(4)
    ds_read_b64_tr_b16 v[44:45], v16 offset:8192
    ds_read_b64_tr_b16 v[46:47], v16 offset:9216
    v_mfma_f32_16x16x32_bf16 a[128:131], a[0:3], v[48:51], 0
    v_mfma_f32_16x16x32_bf16 a[128:131], a[4:7], v[52:55], a[128:131]
    s_add_u32 m0, s69, 147456
    v_add_u32 v22, 0x10000, v22
    v_mfma_f32_16x16x32_bf16 a[132:135], a[8:11], v[48:51], 0
    s_xor_b32 s60, s60, 1572864
    buffer_load_dwordx4 v6, s[8:11], s62 offen lds
    v_mfma_f32_16x16x32_bf16 a[132:135], a[12:15], v[52:55], a[132:135]
    ds_read_b128 a[96:99], v22 offset:16384
    v_mfma_f32_16x16x32_bf16 a[136:139], a[16:19], v[48:51], 0
    v_mfma_f32_16x16x32_bf16 a[136:139], a[20:23], v[52:55], a[136:139]
    v_mfma_f32_16x16x32_bf16 a[140:143], a[24:27], v[48:51], 0
    buffer_load_dwordx4 v7, s[8:11], s62 offen offset:1024 lds
    v_mfma_f32_16x16x32_bf16 a[140:143], a[28:31], v[52:55], a[140:143]
    v_add_u32 v23, 0x10000, v23
    ds_read_b128 a[100:103], v23 offset:16384
    v_mfma_f32_16x16x32_bf16 a[144:147], a[32:35], v[48:51], 0
    v_mfma_f32_16x16x32_bf16 a[144:147], a[36:39], v[52:55], a[144:147]
    v_mfma_f32_16x16x32_bf16 a[148:151], a[40:43], v[48:51], 0
    v_mfma_f32_16x16x32_bf16 a[148:151], a[44:47], v[52:55], a[148:151]
    buffer_load_dwordx4 v8, s[8:11], s62 offen offset:2048 lds
    v_mfma_f32_16x16x32_bf16 a[152:155], a[48:51], v[48:51], 0
    v_mfma_f32_16x16x32_bf16 a[152:155], a[52:55], v[52:55], a[152:155]
    ds_read_b128 a[104:107], v22 offset:18432
    v_mfma_f32_16x16x32_bf16 a[156:159], a[56:59], v[48:51], 0
    ds_read_b64_tr_b16 v[48:49], v17 offset:0
    ds_read_b64_tr_b16 v[50:51], v17 offset:1024
    v_mfma_f32_16x16x32_bf16 a[156:159], a[60:63], v[52:55], a[156:159]
    buffer_load_dwordx4 v9, s[8:11], s62 offen offset:3072 lds
    v_mfma_f32_16x16x32_bf16 a[160:163], a[0:3], v[56:59], 0
    s_waitcnt lgkmcnt(3)
    ds_read_b64_tr_b16 v[52:53], v17 offset:8192
    ds_read_b64_tr_b16 v[54:55], v17 offset:9216
    v_mfma_f32_16x16x32_bf16 a[160:163], a[4:7], v[60:63], a[160:163]
    v_mfma_f32_16x16x32_bf16 a[164:167], a[8:11], v[56:59], 0
    ds_read_b128 a[108:111], v23 offset:18432
    v_mfma_f32_16x16x32_bf16 a[164:167], a[12:15], v[60:63], a[164:167]
    s_add_u32 m0, s69, 0
    v_mfma_f32_16x16x32_bf16 a[168:171], a[16:19], v[56:59], 0
    s_xor_b32 s62, s62, 128
    buffer_load_dwordx4 v2, s[12:15], s60 offen nt lds
    v_mfma_f32_16x16x32_bf16 a[168:171], a[20:23], v[60:63], a[168:171]
    v_mfma_f32_16x16x32_bf16 a[172:175], a[24:27], v[56:59], 0
    v_mfma_f32_16x16x32_bf16 a[172:175], a[28:31], v[60:63], a[172:175]
    v_mfma_f32_16x16x32_bf16 a[176:179], a[32:35], v[56:59], 0
    buffer_load_dwordx4 v3, s[12:15], s60 offen offset:1024 nt lds
    v_mfma_f32_16x16x32_bf16 a[176:179], a[36:39], v[60:63], a[176:179]
    ds_read_b128 a[112:115], v22 offset:20480
    v_mfma_f32_16x16x32_bf16 a[180:183], a[40:43], v[56:59], 0
    v_mfma_f32_16x16x32_bf16 a[180:183], a[44:47], v[60:63], a[180:183]
    v_mfma_f32_16x16x32_bf16 a[184:187], a[48:51], v[56:59], 0
    v_mfma_f32_16x16x32_bf16 a[184:187], a[52:55], v[60:63], a[184:187]
    buffer_load_dwordx4 v4, s[12:15], s60 offen offset:2048 nt lds
    v_mfma_f32_16x16x32_bf16 a[188:191], a[56:59], v[56:59], 0
    ds_read_b128 a[116:119], v23 offset:20480
    v_mfma_f32_16x16x32_bf16 a[188:191], a[60:63], v[60:63], a[188:191]
    v_mfma_f32_16x16x32_bf16 a[192:195], a[0:3], v[40:43], 0
    v_mfma_f32_16x16x32_bf16 a[192:195], a[4:7], v[44:47], a[192:195]
    buffer_load_dwordx4 v5, s[12:15], s60 offen offset:3072 nt lds
    v_mfma_f32_16x16x32_bf16 a[196:199], a[8:11], v[40:43], 0
    v_mfma_f32_16x16x32_bf16 a[196:199], a[12:15], v[44:47], a[196:199]
    ds_read_b128 a[120:123], v22 offset:22528
    v_mfma_f32_16x16x32_bf16 a[200:203], a[16:19], v[40:43], 0
    v_mfma_f32_16x16x32_bf16 a[200:203], a[20:23], v[44:47], a[200:203]
    s_add_u32 m0, s69, 16384
    v_mfma_f32_16x16x32_bf16 a[204:207], a[24:27], v[40:43], 0
    buffer_load_dwordx4 v6, s[8:11], s61 offen lds
    v_mfma_f32_16x16x32_bf16 a[204:207], a[28:31], v[44:47], a[204:207]
    v_mfma_f32_16x16x32_bf16 a[208:211], a[32:35], v[40:43], 0
    ds_read_b128 a[124:127], v23 offset:22528
    v_mfma_f32_16x16x32_bf16 a[208:211], a[36:39], v[44:47], a[208:211]
    v_mfma_f32_16x16x32_bf16 a[212:215], a[40:43], v[40:43], 0
    buffer_load_dwordx4 v7, s[8:11], s61 offen offset:1024 lds
    v_mfma_f32_16x16x32_bf16 a[212:215], a[44:47], v[44:47], a[212:215]
    v_mfma_f32_16x16x32_bf16 a[216:219], a[48:51], v[40:43], 0
    v_mfma_f32_16x16x32_bf16 a[216:219], a[52:55], v[44:47], a[216:219]
    v_mfma_f32_16x16x32_bf16 a[220:223], a[56:59], v[40:43], 0
    v_mfma_f32_16x16x32_bf16 a[220:223], a[60:63], v[44:47], a[220:223]
    s_waitcnt lgkmcnt(0)
    buffer_load_dwordx4 v8, s[8:11], s61 offen offset:2048 lds
    v_mfma_f32_16x16x32_bf16 a[224:227], a[0:3], v[48:51], 0
    v_mfma_f32_16x16x32_bf16 a[224:227], a[4:7], v[52:55], a[224:227]
    v_mfma_f32_16x16x32_bf16 a[228:231], a[8:11], v[48:51], 0
    v_mfma_f32_16x16x32_bf16 a[228:231], a[12:15], v[52:55], a[228:231]
    buffer_load_dwordx4 v9, s[8:11], s61 offen offset:3072 lds
    v_mfma_f32_16x16x32_bf16 a[232:235], a[16:19], v[48:51], 0
    v_mfma_f32_16x16x32_bf16 a[232:235], a[20:23], v[52:55], a[232:235]
    s_waitcnt vmcnt(8) lgkmcnt(0)
    s_barrier
    ds_read_b64_tr_b16 v[56:57], v14 offset:32768
    v_mfma_f32_16x16x32_bf16 a[236:239], a[24:27], v[48:51], 0
    s_add_u32 m0, s69, 32768
    ds_read_b64_tr_b16 v[58:59], v14 offset:33792
    ds_read_b64_tr_b16 v[60:61], v14 offset:40960
    v_mfma_f32_16x16x32_bf16 a[236:239], a[28:31], v[52:55], a[236:239]
    s_xor_b32 s61, s61, 896
    buffer_load_dwordx4 v2, s[16:19], s60 offen nt lds
    v_mfma_f32_16x16x32_bf16 a[240:243], a[32:35], v[48:51], 0
    ds_read_b64_tr_b16 v[62:63], v14 offset:41984
    ds_read_b64_tr_b16 v[40:41], v15 offset:32768
    v_mfma_f32_16x16x32_bf16 a[240:243], a[36:39], v[52:55], a[240:243]
    ds_read_b64_tr_b16 v[42:43], v15 offset:33792
    ds_read_b64_tr_b16 v[44:45], v15 offset:40960
    v_mfma_f32_16x16x32_bf16 a[244:247], a[40:43], v[48:51], 0
    ds_read_b64_tr_b16 v[46:47], v15 offset:41984
    v_add_u32 v14, 0x10000, v14
    v_mfma_f32_16x16x32_bf16 a[244:247], a[44:47], v[52:55], a[244:247]
    v_add_u32 v15, 0x10000, v15
    v_mfma_f32_16x16x32_bf16 a[248:251], a[48:51], v[48:51], 0
    v_mfma_f32_16x16x32_bf16 a[248:251], a[52:55], v[52:55], a[248:251]
    buffer_load_dwordx4 v3, s[16:19], s60 offen offset:1024 nt lds
    v_mfma_f32_16x16x32_bf16 a[252:255], a[56:59], v[48:51], 0
    ds_read_b64_tr_b16 v[48:49], v16 offset:32768
    ds_read_b64_tr_b16 v[50:51], v16 offset:33792
    v_mfma_f32_16x16x32_bf16 a[252:255], a[60:63], v[52:55], a[252:255]
    s_waitcnt lgkmcnt(2)
    ds_read_b64_tr_b16 v[52:53], v16 offset:40960
    ds_read_b64_tr_b16 v[54:55], v16 offset:41984
    v_mfma_f32_16x16x32_bf16 v[128:131], v[56:59], a[64:67], v[128:131]
    v_add_u32 v16, 0x10000, v16
    v_mfma_f32_16x16x32_bf16 v[128:131], v[60:63], a[68:71], v[128:131]
    v_mfma_f32_16x16x32_bf16 v[132:135], v[56:59], a[72:75], v[132:135]
    ds_read_b128 a[0:3], v22 offset:49152
    v_mfma_f32_16x16x32_bf16 v[132:135], v[60:63], a[76:79], v[132:135]
    v_mfma_f32_16x16x32_bf16 v[136:139], v[56:59], a[80:83], v[136:139]
    v_mfma_f32_16x16x32_bf16 v[136:139], v[60:63], a[84:87], v[136:139]
    buffer_load_dwordx4 v4, s[16:19], s60 offen offset:2048 nt lds
    v_mfma_f32_16x16x32_bf16 v[140:143], v[56:59], a[88:91], v[140:143]
    v_mfma_f32_16x16x32_bf16 v[140:143], v[60:63], a[92:95], v[140:143]
    ds_read_b128 a[4:7], v23 offset:49152
    v_mfma_f32_16x16x32_bf16 v[144:147], v[56:59], a[96:99], v[144:147]
    v_mfma_f32_16x16x32_bf16 v[144:147], v[60:63], a[100:103], v[144:147]
    v_mfma_f32_16x16x32_bf16 v[148:151], v[56:59], a[104:107], v[148:151]
    v_mfma_f32_16x16x32_bf16 v[148:151], v[60:63], a[108:111], v[148:151]
    v_mfma_f32_16x16x32_bf16 v[152:155], v[56:59], a[112:115], v[152:155]
    buffer_load_dwordx4 v5, s[16:19], s60 offen offset:3072 nt lds
    v_mfma_f32_16x16x32_bf16 v[152:155], v[60:63], a[116:119], v[152:155]
    ds_read_b128 a[8:11], v22 offset:51200
    v_mfma_f32_16x16x32_bf16 v[156:159], v[56:59], a[120:123], v[156:159]
    ds_read_b64_tr_b16 v[56:57], v17 offset:32768
    ds_read_b64_tr_b16 v[58:59], v17 offset:33792
    v_mfma_f32_16x16x32_bf16 v[156:159], v[60:63], a[124:127], v[156:159]
    ds_read_b64_tr_b16 v[60:61], v17 offset:40960
    ds_read_b64_tr_b16 v[62:63], v17 offset:41984
    v_mfma_f32_16x16x32_bf16 v[160:163], v[40:43], a[64:67], v[160:163]
    v_add_u32 v17, 0x10000, v17
    v_mfma_f32_16x16x32_bf16 v[160:163], v[44:47], a[68:71], v[160:163]
    v_mfma_f32_16x16x32_bf16 v[164:167], v[40:43], a[72:75], v[164:167]
    ds_read_b128 a[12:15], v23 offset:51200
    v_mfma_f32_16x16x32_bf16 v[164:167], v[44:47], a[76:79], v[164:167]
    s_add_u32 m0, s69, 49152
    v_mfma_f32_16x16x32_bf16 v[168:171], v[40:43], a[80:83], v[168:171]
    s_xor_b32 s60, s60, 524288
    buffer_load_dwordx4 v6, s[8:11], s62 offen lds
    v_mfma_f32_16x16x32_bf16 v[168:171], v[44:47], a[84:87], v[168:171]
    v_mfma_f32_16x16x32_bf16 v[172:175], v[40:43], a[88:91], v[172:175]
    v_mfma_f32_16x16x32_bf16 v[172:175], v[44:47], a[92:95], v[172:175]
    v_mfma_f32_16x16x32_bf16 v[176:179], v[40:43], a[96:99], v[176:179]
    ds_read_b128 a[16:19], v22 offset:53248
    v_mfma_f32_16x16x32_bf16 v[176:179], v[44:47], a[100:103], v[176:179]
    v_mfma_f32_16x16x32_bf16 v[180:183], v[40:43], a[104:107], v[180:183]
    v_mfma_f32_16x16x32_bf16 v[180:183], v[44:47], a[108:111], v[180:183]
    buffer_load_dwordx4 v7, s[8:11], s62 offen offset:1024 lds
    v_mfma_f32_16x16x32_bf16 v[184:187], v[40:43], a[112:115], v[184:187]
    v_mfma_f32_16x16x32_bf16 v[184:187], v[44:47], a[116:119], v[184:187]
    ds_read_b128 a[20:23], v23 offset:53248
    v_mfma_f32_16x16x32_bf16 v[188:191], v[40:43], a[120:123], v[188:191]
    s_waitcnt lgkmcnt(1)
    ds_read_b64_tr_b16 v[40:41], v14 offset:0
    ds_read_b64_tr_b16 v[42:43], v14 offset:1024
    v_mfma_f32_16x16x32_bf16 v[188:191], v[44:47], a[124:127], v[188:191]
    ds_read_b64_tr_b16 v[44:45], v14 offset:8192
    ds_read_b64_tr_b16 v[46:47], v14 offset:9216
    v_mfma_f32_16x16x32_bf16 v[192:195], v[48:51], a[64:67], v[192:195]
    v_add_u32 v14, 0xfffe0000, v14
    v_mfma_f32_16x16x32_bf16 v[192:195], v[52:55], a[68:71], v[192:195]
    v_mfma_f32_16x16x32_bf16 v[196:199], v[48:51], a[72:75], v[196:199]
    v_mfma_f32_16x16x32_bf16 v[196:199], v[52:55], a[76:79], v[196:199]
    buffer_load_dwordx4 v8, s[8:11], s62 offen offset:2048 lds
    v_mfma_f32_16x16x32_bf16 v[200:203], v[48:51], a[80:83], v[200:203]
    ds_read_b128 a[24:27], v22 offset:55296
    v_mfma_f32_16x16x32_bf16 v[200:203], v[52:55], a[84:87], v[200:203]
    v_mfma_f32_16x16x32_bf16 v[204:207], v[48:51], a[88:91], v[204:207]
    v_mfma_f32_16x16x32_bf16 v[204:207], v[52:55], a[92:95], v[204:207]
    v_mfma_f32_16x16x32_bf16 v[208:211], v[48:51], a[96:99], v[208:211]
    ds_read_b128 a[28:31], v23 offset:55296
    v_mfma_f32_16x16x32_bf16 v[208:211], v[52:55], a[100:103], v[208:211]
    v_mfma_f32_16x16x32_bf16 v[212:215], v[48:51], a[104:107], v[212:215]
    buffer_load_dwordx4 v9, s[8:11], s62 offen offset:3072 lds
    v_mfma_f32_16x16x32_bf16 v[212:215], v[52:55], a[108:111], v[212:215]
    v_mfma_f32_16x16x32_bf16 v[216:219], v[48:51], a[112:115], v[216:219]
    v_mfma_f32_16x16x32_bf16 v[216:219], v[52:55], a[116:119], v[216:219]
    v_mfma_f32_16x16x32_bf16 v[220:223], v[48:51], a[120:123], v[220:223]
    ds_read_b64_tr_b16 v[48:49], v15 offset:0
    ds_read_b64_tr_b16 v[50:51], v15 offset:1024
    v_mfma_f32_16x16x32_bf16 v[220:223], v[52:55], a[124:127], v[220:223]
    ds_read_b64_tr_b16 v[52:53], v15 offset:8192
    ds_read_b64_tr_b16 v[54:55], v15 offset:9216
    v_mfma_f32_16x16x32_bf16 v[224:227], v[56:59], a[64:67], v[224:227]
    buffer_load_dwordx2 v[80:81], v75, s[28:31], s98 offen nt
    v_mfma_f32_16x16x32_bf16 v[224:227], v[60:63], a[68:71], v[224:227]
    s_xor_b32 s62, s62, 896
    v_add_u32 v15, 0xfffe0000, v15
    v_mfma_f32_16x16x32_bf16 v[228:231], v[56:59], a[72:75], v[228:231]
    buffer_load_dword v105, v103, s[20:23], s77 offen
    v_mfma_f32_16x16x32_bf16 v[228:231], v[60:63], a[76:79], v[228:231]
    s_mul_i32 s77, s2, 18432
    v_mfma_f32_16x16x32_bf16 v[232:235], v[56:59], a[80:83], v[232:235]
    s_add_u32 s77, s77, s76
    buffer_load_dwordx2 v[82:83], v77, s[28:31], s98 offen nt
    v_mfma_f32_16x16x32_bf16 v[232:235], v[60:63], a[84:87], v[232:235]
    s_add_u32 s98, s98, 3456
    v_mfma_f32_16x16x32_bf16 v[236:239], v[56:59], a[88:91], v[236:239]
    s_add_u32 m0, s69, 65536
    v_mfma_f32_16x16x32_bf16 v[236:239], v[60:63], a[92:95], v[236:239]
    s_mov_b32 s76, 0
    v_mfma_f32_16x16x32_bf16 v[240:243], v[56:59], a[96:99], v[240:243]
    buffer_load_ushort v92, v65, s[32:35], s99 offen offset:0
    v_mfma_f32_16x16x32_bf16 v[240:243], v[60:63], a[100:103], v[240:243]
    v_mfma_f32_16x16x32_bf16 v[244:247], v[56:59], a[104:107], v[244:247]
    v_mfma_f32_16x16x32_bf16 v[244:247], v[60:63], a[108:111], v[244:247]
    v_mfma_f32_16x16x32_bf16 v[248:251], v[56:59], a[112:115], v[248:251]
    buffer_load_dwordx2 v[84:85], v75, s[28:31], s98 offen nt
    v_mfma_f32_16x16x32_bf16 v[248:251], v[60:63], a[116:119], v[248:251]
    v_mfma_f32_16x16x32_bf16 v[252:255], v[56:59], a[120:123], v[252:255]
    ds_read_b64_tr_b16 v[56:57], v16 offset:0
    ds_read_b64_tr_b16 v[58:59], v16 offset:1024
    v_mfma_f32_16x16x32_bf16 v[252:255], v[60:63], a[124:127], v[252:255]
    s_waitcnt lgkmcnt(2)
    ds_read_b64_tr_b16 v[60:61], v16 offset:8192
    ds_read_b64_tr_b16 v[62:63], v16 offset:9216
    v_mfma_f32_16x16x32_bf16 a[128:131], a[64:67], v[40:43], a[128:131]
    buffer_load_dwordx4 v2, s[12:15], s60 offen nt lds
    v_mfma_f32_16x16x32_bf16 a[128:131], a[68:71], v[44:47], a[128:131]
    v_add_u32 v22, 0x10000, v22
    v_add_u32 v16, 0xfffe0000, v16
    v_mfma_f32_16x16x32_bf16 a[132:135], a[72:75], v[40:43], a[132:135]
    ds_read_b128 a[32:35], v22 offset:16384
    v_mfma_f32_16x16x32_bf16 a[132:135], a[76:79], v[44:47], a[132:135]
    v_mfma_f32_16x16x32_bf16 a[136:139], a[80:83], v[40:43], a[136:139]
    buffer_load_dwordx2 v[86:87], v77, s[28:31], s98 offen nt
    v_mfma_f32_16x16x32_bf16 a[136:139], a[84:87], v[44:47], a[136:139]
    s_add_u32 s98, s98, 3456
    v_mfma_f32_16x16x32_bf16 a[140:143], a[88:91], v[40:43], a[140:143]
    v_add_u32 v23, 0x10000, v23
    v_mfma_f32_16x16x32_bf16 a[140:143], a[92:95], v[44:47], a[140:143]
    ds_read_b128 a[36:39], v23 offset:16384
    v_mfma_f32_16x16x32_bf16 a[144:147], a[96:99], v[40:43], a[144:147]
    buffer_load_ushort v93, v65, s[32:35], s99 offen offset:2
    v_mfma_f32_16x16x32_bf16 a[144:147], a[100:103], v[44:47], a[144:147]
    v_mfma_f32_16x16x32_bf16 a[148:151], a[104:107], v[40:43], a[148:151]
    v_mfma_f32_16x16x32_bf16 a[148:151], a[108:111], v[44:47], a[148:151]
    v_mfma_f32_16x16x32_bf16 a[152:155], a[112:115], v[40:43], a[152:155]
    buffer_load_dwordx2 v[88:89], v75, s[28:31], s98 offen nt
    v_mfma_f32_16x16x32_bf16 a[152:155], a[116:119], v[44:47], a[152:155]
    ds_read_b128 a[40:43], v22 offset:18432
    v_mfma_f32_16x16x32_bf16 a[156:159], a[120:123], v[40:43], a[156:159]
    ds_read_b64_tr_b16 v[40:41], v17 offset:0
    ds_read_b64_tr_b16 v[42:43], v17 offset:1024
    v_mfma_f32_16x16x32_bf16 a[156:159], a[124:127], v[44:47], a[156:159]
    ds_read_b64_tr_b16 v[44:45], v17 offset:8192
    ds_read_b64_tr_b16 v[46:47], v17 offset:9216
    v_mfma_f32_16x16x32_bf16 a[160:163], a[64:67], v[48:51], a[160:163]
    buffer_load_dwordx4 v3, s[12:15], s60 offen offset:1024 nt lds
    v_mfma_f32_16x16x32_bf16 a[160:163], a[68:71], v[52:55], a[160:163]
    v_add_u32 v17, 0xfffe0000, v17
    v_mfma_f32_16x16x32_bf16 a[164:167], a[72:75], v[48:51], a[164:167]
    ds_read_b128 a[44:47], v23 offset:18432
    v_mfma_f32_16x16x32_bf16 a[164:167], a[76:79], v[52:55], a[164:167]
    v_mfma_f32_16x16x32_bf16 a[168:171], a[80:83], v[48:51], a[168:171]
    buffer_load_dwordx2 v[90:91], v77, s[28:31], s98 offen nt
    v_mfma_f32_16x16x32_bf16 a[168:171], a[84:87], v[52:55], a[168:171]
    s_add_u32 s98, s98, 3456
    s_add_u32 s28, s56, 6291456
    s_addc_u32 s29, s57, 0
    v_mfma_f32_16x16x32_bf16 a[172:175], a[88:91], v[48:51], a[172:175]
    s_mov_b32 s30, 2359296
    v_mfma_f32_16x16x32_bf16 a[172:175], a[92:95], v[52:55], a[172:175]
    s_bfe_u32 s98, s72, 0x10001
    v_mfma_f32_16x16x32_bf16 a[176:179], a[96:99], v[48:51], a[176:179]
    buffer_load_ushort v94, v65, s[32:35], s99 offen offset:4
    v_mfma_f32_16x16x32_bf16 a[176:179], a[100:103], v[52:55], a[176:179]
    s_add_u32 s32, s56, 9437184
    s_addc_u32 s33, s57, 0
    s_mov_b32 s34, 196608
    v_mfma_f32_16x16x32_bf16 a[180:183], a[104:107], v[48:51], a[180:183]
    s_bfe_u32 s99, s72, 0x10003
    ds_read_b128 a[48:51], v22 offset:20480
    v_mfma_f32_16x16x32_bf16 a[180:183], a[108:111], v[52:55], a[180:183]
    s_lshl1_add_u32 s98, s99, s98
    v_mfma_f32_16x16x32_bf16 a[184:187], a[112:115], v[48:51], a[184:187]
    s_lshl_b32 s98, s98, 5
    buffer_store_dword v65, v64, s[32:35], s101 offen sc1
    v_mfma_f32_16x16x32_bf16 a[184:187], a[116:119], v[52:55], a[184:187]
    s_lshl_b32 s72, s72, 7
    ds_read_b128 a[52:55], v23 offset:20480
    v_mfma_f32_16x16x32_bf16 a[188:191], a[120:123], v[48:51], a[188:191]
    v_mfma_f32_16x16x32_bf16 a[188:191], a[124:127], v[52:55], a[188:191]
    s_waitcnt lgkmcnt(1)
    v_mfma_f32_16x16x32_bf16 a[192:195], a[64:67], v[56:59], a[192:195]
    buffer_load_dwordx4 v4, s[12:15], s60 offen offset:2048 nt lds
    v_mfma_f32_16x16x32_bf16 a[192:195], a[68:71], v[60:63], a[192:195]
    v_mfma_f32_16x16x32_bf16 a[196:199], a[72:75], v[56:59], a[196:199]
    v_mfma_f32_16x16x32_bf16 a[196:199], a[76:79], v[60:63], a[196:199]
    ds_read_b128 a[56:59], v22 offset:22528
    v_mfma_f32_16x16x32_bf16 a[200:203], a[80:83], v[56:59], a[200:203]
    buffer_load_dwordx4 v5, s[12:15], s60 offen offset:3072 nt lds
    v_mfma_f32_16x16x32_bf16 a[200:203], a[84:87], v[60:63], a[200:203]
    s_add_u32 m0, s69, 81920
    v_mfma_f32_16x16x32_bf16 a[204:207], a[88:91], v[56:59], a[204:207]
    v_mfma_f32_16x16x32_bf16 a[204:207], a[92:95], v[60:63], a[204:207]
    v_mfma_f32_16x16x32_bf16 a[208:211], a[96:99], v[56:59], a[208:211]
    buffer_load_dwordx4 v6, s[8:11], s61 offen lds
    v_mfma_f32_16x16x32_bf16 a[208:211], a[100:103], v[60:63], a[208:211]
    ds_read_b128 a[60:63], v23 offset:22528
    v_mfma_f32_16x16x32_bf16 a[212:215], a[104:107], v[56:59], a[212:215]
    v_mfma_f32_16x16x32_bf16 a[212:215], a[108:111], v[60:63], a[212:215]
    v_mfma_f32_16x16x32_bf16 a[216:219], a[112:115], v[56:59], a[216:219]
    buffer_load_dwordx4 v7, s[8:11], s61 offen offset:1024 lds
    v_mfma_f32_16x16x32_bf16 a[216:219], a[116:119], v[60:63], a[216:219]
    v_mfma_f32_16x16x32_bf16 a[220:223], a[120:123], v[56:59], a[220:223]
    v_mfma_f32_16x16x32_bf16 a[220:223], a[124:127], v[60:63], a[220:223]
    v_mfma_f32_16x16x32_bf16 a[224:227], a[64:67], v[40:43], a[224:227]
    buffer_load_dwordx4 v8, s[8:11], s61 offen offset:2048 lds
    v_mfma_f32_16x16x32_bf16 a[224:227], a[68:71], v[44:47], a[224:227]
    v_mfma_f32_16x16x32_bf16 a[228:231], a[72:75], v[40:43], a[228:231]
    v_mfma_f32_16x16x32_bf16 a[228:231], a[76:79], v[44:47], a[228:231]
    v_mfma_f32_16x16x32_bf16 a[232:235], a[80:83], v[40:43], a[232:235]
    buffer_load_dwordx4 v9, s[8:11], s61 offen offset:3072 lds
    v_mfma_f32_16x16x32_bf16 a[232:235], a[84:87], v[44:47], a[232:235]
    s_xor_b32 s61, s61, 128
    s_waitcnt vmcnt(19) lgkmcnt(0)
    s_barrier
    v_mfma_f32_16x16x32_bf16 a[236:239], a[88:91], v[40:43], a[236:239]
    s_add_u32 m0, s69, 98304
    ds_read_b64_tr_b16 v[48:49], v14 offset:0
    ds_read_b64_tr_b16 v[50:51], v14 offset:1024
    v_mfma_f32_16x16x32_bf16 a[236:239], a[92:95], v[44:47], a[236:239]
    ds_read_b64_tr_b16 v[52:53], v14 offset:8192
    ds_read_b64_tr_b16 v[54:55], v14 offset:9216
    v_mfma_f32_16x16x32_bf16 a[240:243], a[96:99], v[40:43], a[240:243]
    buffer_load_dwordx4 v2, s[16:19], s60 offen nt lds
    v_mfma_f32_16x16x32_bf16 a[240:243], a[100:103], v[44:47], a[240:243]
    ds_read_b64_tr_b16 v[56:57], v15 offset:0
    ds_read_b64_tr_b16 v[58:59], v15 offset:1024
    v_mfma_f32_16x16x32_bf16 a[244:247], a[104:107], v[40:43], a[244:247]
    ds_read_b64_tr_b16 v[60:61], v15 offset:8192
    ds_read_b64_tr_b16 v[62:63], v15 offset:9216
    v_mfma_f32_16x16x32_bf16 a[244:247], a[108:111], v[44:47], a[244:247]
    s_cmp_lt_u32 s2, 192
    s_cselect_b32 s72, s72, 1073741824
    v_mfma_f32_16x16x32_bf16 a[248:251], a[112:115], v[40:43], a[248:251]
    v_mfma_f32_16x16x32_bf16 a[248:251], a[116:119], v[44:47], a[248:251]
    buffer_load_dwordx4 v3, s[16:19], s60 offen offset:1024 nt lds
    v_mfma_f32_16x16x32_bf16 a[252:255], a[120:123], v[40:43], a[252:255]
    ds_read_b64_tr_b16 v[40:41], v16 offset:0
    ds_read_b64_tr_b16 v[42:43], v16 offset:1024
    v_mfma_f32_16x16x32_bf16 a[252:255], a[124:127], v[44:47], a[252:255]
    s_waitcnt lgkmcnt(2)
    ds_read_b64_tr_b16 v[44:45], v16 offset:8192
    ds_read_b64_tr_b16 v[46:47], v16 offset:9216
    v_mfma_f32_16x16x32_bf16 v[128:131], v[48:51], a[0:3], v[128:131]
    v_mfma_f32_16x16x32_bf16 v[128:131], v[52:55], a[4:7], v[128:131]
    v_add_u32 v22, 0xfffe0000, v22
    v_mfma_f32_16x16x32_bf16 v[132:135], v[48:51], a[8:11], v[132:135]
    ds_read_b128 a[64:67], v22 offset:16384
    v_mfma_f32_16x16x32_bf16 v[132:135], v[52:55], a[12:15], v[132:135]
    v_mfma_f32_16x16x32_bf16 v[136:139], v[48:51], a[16:19], v[136:139]
    v_mfma_f32_16x16x32_bf16 v[136:139], v[52:55], a[20:23], v[136:139]
    buffer_load_dwordx4 v4, s[16:19], s60 offen offset:2048 nt lds
    v_mfma_f32_16x16x32_bf16 v[140:143], v[48:51], a[24:27], v[140:143]
    v_add_u32 v23, 0xfffe0000, v23
    v_mfma_f32_16x16x32_bf16 v[140:143], v[52:55], a[28:31], v[140:143]
    ds_read_b128 a[68:71], v23 offset:16384
    v_mfma_f32_16x16x32_bf16 v[144:147], v[48:51], a[32:35], v[144:147]
    v_mfma_f32_16x16x32_bf16 v[144:147], v[52:55], a[36:39], v[144:147]
    v_mfma_f32_16x16x32_bf16 v[148:151], v[48:51], a[40:43], v[148:151]
    v_mfma_f32_16x16x32_bf16 v[148:151], v[52:55], a[44:47], v[148:151]
    v_mfma_f32_16x16x32_bf16 v[152:155], v[48:51], a[48:51], v[152:155]
    buffer_load_dwordx4 v5, s[16:19], s60 offen offset:3072 nt lds
    v_mfma_f32_16x16x32_bf16 v[152:155], v[52:55], a[52:55], v[152:155]
    ds_read_b128 a[72:75], v22 offset:18432
    v_mfma_f32_16x16x32_bf16 v[156:159], v[48:51], a[56:59], v[156:159]
    ds_read_b64_tr_b16 v[48:49], v17 offset:0
    ds_read_b64_tr_b16 v[50:51], v17 offset:1024
    v_mfma_f32_16x16x32_bf16 v[156:159], v[52:55], a[60:63], v[156:159]
    ds_read_b64_tr_b16 v[52:53], v17 offset:8192
    ds_read_b64_tr_b16 v[54:55], v17 offset:9216
    v_mfma_f32_16x16x32_bf16 v[160:163], v[56:59], a[0:3], v[160:163]
    v_mfma_f32_16x16x32_bf16 v[160:163], v[60:63], a[4:7], v[160:163]
    v_mfma_f32_16x16x32_bf16 v[164:167], v[56:59], a[8:11], v[164:167]
    ds_read_b128 a[76:79], v23 offset:18432
    v_mfma_f32_16x16x32_bf16 v[164:167], v[60:63], a[12:15], v[164:167]
    s_add_u32 m0, s69, 114688
    v_mfma_f32_16x16x32_bf16 v[168:171], v[56:59], a[16:19], v[168:171]
    s_xor_b32 s60, s60, 3670016
    buffer_load_dwordx4 v6, s[8:11], s62 offen lds
    v_mfma_f32_16x16x32_bf16 v[168:171], v[60:63], a[20:23], v[168:171]
    v_mfma_f32_16x16x32_bf16 v[172:175], v[56:59], a[24:27], v[172:175]
    v_mfma_f32_16x16x32_bf16 v[172:175], v[60:63], a[28:31], v[172:175]
    v_mfma_f32_16x16x32_bf16 v[176:179], v[56:59], a[32:35], v[176:179]
    ds_read_b128 a[80:83], v22 offset:20480
    v_mfma_f32_16x16x32_bf16 v[176:179], v[60:63], a[36:39], v[176:179]
    v_mfma_f32_16x16x32_bf16 v[180:183], v[56:59], a[40:43], v[180:183]
    v_mfma_f32_16x16x32_bf16 v[180:183], v[60:63], a[44:47], v[180:183]
    buffer_load_dwordx4 v7, s[8:11], s62 offen offset:1024 lds
    v_mfma_f32_16x16x32_bf16 v[184:187], v[56:59], a[48:51], v[184:187]
    v_mfma_f32_16x16x32_bf16 v[184:187], v[60:63], a[52:55], v[184:187]
    ds_read_b128 a[84:87], v23 offset:20480
    v_mfma_f32_16x16x32_bf16 v[188:191], v[56:59], a[56:59], v[188:191]
    s_waitcnt lgkmcnt(1)
    ds_read_b64_tr_b16 v[56:57], v14 offset:32768
    ds_read_b64_tr_b16 v[58:59], v14 offset:33792
    v_mfma_f32_16x16x32_bf16 v[188:191], v[60:63], a[60:63], v[188:191]
    ds_read_b64_tr_b16 v[60:61], v14 offset:40960
    ds_read_b64_tr_b16 v[62:63], v14 offset:41984
    v_mfma_f32_16x16x32_bf16 v[192:195], v[40:43], a[0:3], v[192:195]
    v_add_u32 v14, 0x10000, v14
    v_mfma_f32_16x16x32_bf16 v[192:195], v[44:47], a[4:7], v[192:195]
    v_mfma_f32_16x16x32_bf16 v[196:199], v[40:43], a[8:11], v[196:199]
    v_mfma_f32_16x16x32_bf16 v[196:199], v[44:47], a[12:15], v[196:199]
    buffer_load_dwordx4 v8, s[8:11], s62 offen offset:2048 lds
    v_mfma_f32_16x16x32_bf16 v[200:203], v[40:43], a[16:19], v[200:203]
    ds_read_b128 a[88:91], v22 offset:22528
    v_mfma_f32_16x16x32_bf16 v[200:203], v[44:47], a[20:23], v[200:203]
    v_mfma_f32_16x16x32_bf16 v[204:207], v[40:43], a[24:27], v[204:207]
    v_mfma_f32_16x16x32_bf16 v[204:207], v[44:47], a[28:31], v[204:207]
    v_mfma_f32_16x16x32_bf16 v[208:211], v[40:43], a[32:35], v[208:211]
    ds_read_b128 a[92:95], v23 offset:22528
    v_mfma_f32_16x16x32_bf16 v[208:211], v[44:47], a[36:39], v[208:211]
    v_mfma_f32_16x16x32_bf16 v[212:215], v[40:43], a[40:43], v[212:215]
    buffer_load_dwordx4 v9, s[8:11], s62 offen offset:3072 lds
    v_mfma_f32_16x16x32_bf16 v[212:215], v[44:47], a[44:47], v[212:215]
    v_mfma_f32_16x16x32_bf16 v[216:219], v[40:43], a[48:51], v[216:219]
    v_mfma_f32_16x16x32_bf16 v[216:219], v[44:47], a[52:55], v[216:219]
    v_mfma_f32_16x16x32_bf16 v[220:223], v[40:43], a[56:59], v[220:223]
    ds_read_b64_tr_b16 v[40:41], v15 offset:32768
    ds_read_b64_tr_b16 v[42:43], v15 offset:33792
    v_mfma_f32_16x16x32_bf16 v[220:223], v[44:47], a[60:63], v[220:223]
    ds_read_b64_tr_b16 v[44:45], v15 offset:40960
    ds_read_b64_tr_b16 v[46:47], v15 offset:41984
    v_mfma_f32_16x16x32_bf16 v[224:227], v[48:51], a[0:3], v[224:227]
    v_add_u32 v15, 0x10000, v15
    v_mfma_f32_16x16x32_bf16 v[224:227], v[52:55], a[4:7], v[224:227]
    s_xor_b32 s62, s62, 128
    v_mfma_f32_16x16x32_bf16 v[228:231], v[48:51], a[8:11], v[228:231]
    buffer_load_dword v106, v103, s[24:27], s77 offen
    v_mfma_f32_16x16x32_bf16 v[228:231], v[52:55], a[12:15], v[228:231]
    s_add_u32 s77, s77, 4608
    v_mfma_f32_16x16x32_bf16 v[232:235], v[48:51], a[16:19], v[232:235]
    v_mfma_f32_16x16x32_bf16 v[232:235], v[52:55], a[20:23], v[232:235]
    s_add_u32 m0, s69, 131072
    v_mfma_f32_16x16x32_bf16 v[236:239], v[48:51], a[24:27], v[236:239]
    buffer_load_dwordx4 v2, s[12:15], s60 offen nt lds
    v_mfma_f32_16x16x32_bf16 v[236:239], v[52:55], a[28:31], v[236:239]
    v_mfma_f32_16x16x32_bf16 v[240:243], v[48:51], a[32:35], v[240:243]
    v_mfma_f32_16x16x32_bf16 v[240:243], v[52:55], a[36:39], v[240:243]
    v_mfma_f32_16x16x32_bf16 v[244:247], v[48:51], a[40:43], v[244:247]
    v_mfma_f32_16x16x32_bf16 v[244:247], v[52:55], a[44:47], v[244:247]
    v_mfma_f32_16x16x32_bf16 v[248:251], v[48:51], a[48:51], v[248:251]
    v_mfma_f32_16x16x32_bf16 v[248:251], v[52:55], a[52:55], v[248:251]
    buffer_load_dwordx4 v3, s[12:15], s60 offen offset:1024 nt lds
    v_mfma_f32_16x16x32_bf16 v[252:255], v[48:51], a[56:59], v[252:255]
    ds_read_b64_tr_b16 v[48:49], v16 offset:32768
    ds_read_b64_tr_b16 v[50:51], v16 offset:33792
    v_mfma_f32_16x16x32_bf16 v[252:255], v[52:55], a[60:63], v[252:255]
    s_waitcnt lgkmcnt(2)
    ds_read_b64_tr_b16 v[52:53], v16 offset:40960
    ds_read_b64_tr_b16 v[54:55], v16 offset:41984
    v_mfma_f32_16x16x32_bf16 a[128:131], a[0:3], v[56:59], a[128:131]
    v_add_u32 v16, 0x10000, v16
    v_mfma_f32_16x16x32_bf16 a[128:131], a[4:7], v[60:63], a[128:131]
    v_mfma_f32_16x16x32_bf16 a[132:135], a[8:11], v[56:59], a[132:135]
    ds_read_b128 a[96:99], v22 offset:49152
    v_mfma_f32_16x16x32_bf16 a[132:135], a[12:15], v[60:63], a[132:135]
    v_mfma_f32_16x16x32_bf16 a[136:139], a[16:19], v[56:59], a[136:139]
    v_mfma_f32_16x16x32_bf16 a[136:139], a[20:23], v[60:63], a[136:139]
    buffer_load_dwordx4 v4, s[12:15], s60 offen offset:2048 nt lds
    v_mfma_f32_16x16x32_bf16 a[140:143], a[24:27], v[56:59], a[140:143]
    v_mfma_f32_16x16x32_bf16 a[140:143], a[28:31], v[60:63], a[140:143]
    ds_read_b128 a[100:103], v23 offset:49152
    v_mfma_f32_16x16x32_bf16 a[144:147], a[32:35], v[56:59], a[144:147]
    v_mfma_f32_16x16x32_bf16 a[144:147], a[36:39], v[60:63], a[144:147]
    v_mfma_f32_16x16x32_bf16 a[148:151], a[40:43], v[56:59], a[148:151]
    v_mfma_f32_16x16x32_bf16 a[148:151], a[44:47], v[60:63], a[148:151]
    v_mfma_f32_16x16x32_bf16 a[152:155], a[48:51], v[56:59], a[152:155]
    buffer_load_dwordx4 v5, s[12:15], s60 offen offset:3072 nt lds
    v_mfma_f32_16x16x32_bf16 a[152:155], a[52:55], v[60:63], a[152:155]
    ds_read_b128 a[104:107], v22 offset:51200
    v_mfma_f32_16x16x32_bf16 a[156:159], a[56:59], v[56:59], a[156:159]
    ds_read_b64_tr_b16 v[56:57], v17 offset:32768
    ds_read_b64_tr_b16 v[58:59], v17 offset:33792
    v_mfma_f32_16x16x32_bf16 a[156:159], a[60:63], v[60:63], a[156:159]
    ds_read_b64_tr_b16 v[60:61], v17 offset:40960
    ds_read_b64_tr_b16 v[62:63], v17 offset:41984
    v_mfma_f32_16x16x32_bf16 a[160:163], a[0:3], v[40:43], a[160:163]
    v_add_u32 v17, 0x10000, v17
    v_mfma_f32_16x16x32_bf16 a[160:163], a[4:7], v[44:47], a[160:163]
    v_mfma_f32_16x16x32_bf16 a[164:167], a[8:11], v[40:43], a[164:167]
    ds_read_b128 a[108:111], v23 offset:51200
    v_mfma_f32_16x16x32_bf16 a[164:167], a[12:15], v[44:47], a[164:167]
    s_add_u32 m0, s69, 147456
    v_mfma_f32_16x16x32_bf16 a[168:171], a[16:19], v[40:43], a[168:171]
    buffer_load_dwordx4 v6, s[8:11], s61 offen lds
    v_mfma_f32_16x16x32_bf16 a[168:171], a[20:23], v[44:47], a[168:171]
    v_mfma_f32_16x16x32_bf16 a[172:175], a[24:27], v[40:43], a[172:175]
    v_mfma_f32_16x16x32_bf16 a[172:175], a[28:31], v[44:47], a[172:175]
    v_mfma_f32_16x16x32_bf16 a[176:179], a[32:35], v[40:43], a[176:179]
    ds_read_b128 a[112:115], v22 offset:53248
    v_mfma_f32_16x16x32_bf16 a[176:179], a[36:39], v[44:47], a[176:179]
    v_mfma_f32_16x16x32_bf16 a[180:183], a[40:43], v[40:43], a[180:183]
    v_mfma_f32_16x16x32_bf16 a[180:183], a[44:47], v[44:47], a[180:183]
    buffer_load_dwordx4 v7, s[8:11], s61 offen offset:1024 lds
    v_mfma_f32_16x16x32_bf16 a[184:187], a[48:51], v[40:43], a[184:187]
    v_mfma_f32_16x16x32_bf16 a[184:187], a[52:55], v[44:47], a[184:187]
    ds_read_b128 a[116:119], v23 offset:53248
    v_mfma_f32_16x16x32_bf16 a[188:191], a[56:59], v[40:43], a[188:191]
    v_mfma_f32_16x16x32_bf16 a[188:191], a[60:63], v[44:47], a[188:191]
    s_waitcnt lgkmcnt(1)
    v_mfma_f32_16x16x32_bf16 a[192:195], a[0:3], v[48:51], a[192:195]
    v_mfma_f32_16x16x32_bf16 a[192:195], a[4:7], v[52:55], a[192:195]
    v_mfma_f32_16x16x32_bf16 a[196:199], a[8:11], v[48:51], a[196:199]
    v_mfma_f32_16x16x32_bf16 a[196:199], a[12:15], v[52:55], a[196:199]
    buffer_load_dwordx4 v8, s[8:11], s61 offen offset:2048 lds
    v_mfma_f32_16x16x32_bf16 a[200:203], a[16:19], v[48:51], a[200:203]
    ds_read_b128 a[120:123], v22 offset:55296
    v_mfma_f32_16x16x32_bf16 a[200:203], a[20:23], v[52:55], a[200:203]
    v_mfma_f32_16x16x32_bf16 a[204:207], a[24:27], v[48:51], a[204:207]
    v_mfma_f32_16x16x32_bf16 a[204:207], a[28:31], v[52:55], a[204:207]
    v_mfma_f32_16x16x32_bf16 a[208:211], a[32:35], v[48:51], a[208:211]
    ds_read_b128 a[124:127], v23 offset:55296
    v_mfma_f32_16x16x32_bf16 a[208:211], a[36:39], v[52:55], a[208:211]
    v_mfma_f32_16x16x32_bf16 a[212:215], a[40:43], v[48:51], a[212:215]
    buffer_load_dwordx4 v9, s[8:11], s61 offen offset:3072 lds
    v_mfma_f32_16x16x32_bf16 a[212:215], a[44:47], v[52:55], a[212:215]
    v_mfma_f32_16x16x32_bf16 a[216:219], a[48:51], v[48:51], a[216:219]
    v_mfma_f32_16x16x32_bf16 a[216:219], a[52:55], v[52:55], a[216:219]
    v_mfma_f32_16x16x32_bf16 a[220:223], a[56:59], v[48:51], a[220:223]
    v_mfma_f32_16x16x32_bf16 a[220:223], a[60:63], v[52:55], a[220:223]
    v_mfma_f32_16x16x32_bf16 a[224:227], a[0:3], v[56:59], a[224:227]
    v_mfma_f32_16x16x32_bf16 a[224:227], a[4:7], v[60:63], a[224:227]
    s_xor_b32 s61, s61, 384
    v_mfma_f32_16x16x32_bf16 a[228:231], a[8:11], v[56:59], a[228:231]
    v_mfma_f32_16x16x32_bf16 a[228:231], a[12:15], v[60:63], a[228:231]
    v_mfma_f32_16x16x32_bf16 a[232:235], a[16:19], v[56:59], a[232:235]
    v_mfma_f32_16x16x32_bf16 a[232:235], a[20:23], v[60:63], a[232:235]
    s_waitcnt vmcnt(9) lgkmcnt(0)
    s_barrier
    ds_read_b64_tr_b16 v[40:41], v14 offset:0
    v_mfma_f32_16x16x32_bf16 a[236:239], a[24:27], v[56:59], a[236:239]
    s_add_u32 m0, s69, 0
    ds_read_b64_tr_b16 v[42:43], v14 offset:1024
    ds_read_b64_tr_b16 v[44:45], v14 offset:8192
    v_mfma_f32_16x16x32_bf16 a[236:239], a[28:31], v[60:63], a[236:239]
    buffer_load_dwordx4 v2, s[16:19], s60 offen nt lds
    v_mfma_f32_16x16x32_bf16 a[240:243], a[32:35], v[56:59], a[240:243]
    ds_read_b64_tr_b16 v[46:47], v14 offset:9216
    v_cndmask_b32_e64 v83, v83, 0, s[92:93]
    v_mfma_f32_16x16x32_bf16 a[240:243], a[36:39], v[60:63], a[240:243]
    v_cndmask_b32_e64 v81, v81, 0, vcc
    v_cndmask_b32 v82, v82, v92, s[92:93]
    v_mfma_f32_16x16x32_bf16 a[244:247], a[40:43], v[56:59], a[244:247]
    s_mov_b32 vcc_lo, 0x10101010
    s_mov_b32 vcc_hi, 0x10101010
    v_cndmask_b32_e64 v83, v83, 0, vcc
    v_mfma_f32_16x16x32_bf16 a[244:247], a[44:47], v[60:63], a[244:247]
    v_xor_b32 v92, s98, v95
    ds_read_b64_tr_b16 v[48:49], v15 offset:0
    v_mfma_f32_16x16x32_bf16 a[248:251], a[48:51], v[56:59], a[248:251]
    buffer_store_dwordx4 v[80:83], v92, s[28:31], s72 offen sc1
    v_mfma_f32_16x16x32_bf16 a[248:251], a[52:55], v[60:63], a[248:251]
    s_mul_i32 s72, s2, 3
    buffer_load_dwordx4 v3, s[16:19], s60 offen offset:1024 nt lds
    v_mfma_f32_16x16x32_bf16 a[252:255], a[56:59], v[56:59], a[252:255]
    s_add_u32 s72, s72, 1
    ds_read_b64_tr_b16 v[50:51], v15 offset:1024
    ds_read_b64_tr_b16 v[52:53], v15 offset:8192
    v_mfma_f32_16x16x32_bf16 a[252:255], a[60:63], v[60:63], a[252:255]
    s_bfe_u32 s98, s72, 0x10001
    ds_read_b64_tr_b16 v[54:55], v15 offset:9216
    v_cndmask_b32_e64 v87, v87, 0, s[92:93]
    s_waitcnt lgkmcnt(4)
    v_mfma_f32_16x16x32_bf16 v[128:131], v[40:43], a[64:67], v[128:131]
    s_bfe_u32 s99, s72, 0x10003
    v_cndmask_b32 v86, v86, v93, s[92:93]
    v_cndmask_b32_e64 v91, v91, 0, s[92:93]
    v_mfma_f32_16x16x32_bf16 v[128:131], v[44:47], a[68:71], v[128:131]
    s_lshl1_add_u32 s98, s99, s98
    v_add_u32 v22, 0x10000, v22
    v_cndmask_b32 v90, v90, v94, s[92:93]
    v_mfma_f32_16x16x32_bf16 v[132:135], v[40:43], a[72:75], v[132:135]
    s_lshl_b32 s98, s98, 5
    ds_read_b128 a[0:3], v22 offset:16384
    v_xor_b32 v93, s98, v95
    v_mfma_f32_16x16x32_bf16 v[132:135], v[44:47], a[76:79], v[132:135]
    s_mov_b32 vcc_lo, 0x84848484
    s_mov_b32 vcc_hi, 0x84848484
    v_cndmask_b32_e64 v85, v85, 0, vcc
    v_mfma_f32_16x16x32_bf16 v[136:139], v[40:43], a[80:83], v[136:139]
    s_mov_b32 vcc_lo, 0x10101010
    s_mov_b32 vcc_hi, 0x10101010
    v_cndmask_b32_e64 v87, v87, 0, vcc
    v_mfma_f32_16x16x32_bf16 v[136:139], v[44:47], a[84:87], v[136:139]
    s_lshl_b32 s72, s72, 7
    buffer_load_dwordx4 v4, s[16:19], s60 offen offset:2048 nt lds
    v_mfma_f32_16x16x32_bf16 v[140:143], v[40:43], a[88:91], v[140:143]
    v_add_u32 v23, 0x10000, v23
    ds_read_b64_tr_b16 v[56:57], v16 offset:0
    v_mfma_f32_16x16x32_bf16 v[140:143], v[44:47], a[92:95], v[140:143]
    ds_read_b128 a[4:7], v23 offset:16384
    ds_read_b64_tr_b16 v[58:59], v16 offset:1024
    v_mfma_f32_16x16x32_bf16 v[144:147], v[40:43], a[96:99], v[144:147]
    s_cmp_lt_u32 s2, 192
    s_cselect_b32 s72, s72, 1073741824
    ds_read_b64_tr_b16 v[60:61], v16 offset:8192
    v_mfma_f32_16x16x32_bf16 v[144:147], v[44:47], a[100:103], v[144:147]
    buffer_store_dwordx4 v[84:87], v93, s[28:31], s72 offen sc1
    v_mfma_f32_16x16x32_bf16 v[148:151], v[40:43], a[104:107], v[148:151]
    s_mul_i32 s72, s2, 3
    ds_read_b64_tr_b16 v[62:63], v16 offset:9216
    v_mfma_f32_16x16x32_bf16 v[148:151], v[44:47], a[108:111], v[148:151]
    s_add_u32 s72, s72, 2
    v_mfma_f32_16x16x32_bf16 v[152:155], v[40:43], a[112:115], v[152:155]
    s_bfe_u32 s98, s72, 0x10001
    buffer_load_dwordx4 v5, s[16:19], s60 offen offset:3072 nt lds
    v_mfma_f32_16x16x32_bf16 v[152:155], v[44:47], a[116:119], v[152:155]
    s_bfe_u32 s99, s72, 0x10003
    ds_read_b128 a[8:11], v22 offset:18432
    v_mfma_f32_16x16x32_bf16 v[156:159], v[40:43], a[120:123], v[156:159]
    s_mov_b32 vcc_lo, 0x84848484
    s_mov_b32 vcc_hi, 0x84848484
    v_cndmask_b32_e64 v89, v89, 0, vcc
    v_mfma_f32_16x16x32_bf16 v[156:159], v[44:47], a[124:127], v[156:159]
    s_lshl1_add_u32 s98, s99, s98
    ds_read_b64_tr_b16 v[40:41], v17 offset:0
    ds_read_b64_tr_b16 v[42:43], v17 offset:1024
    s_waitcnt lgkmcnt(3)
    v_mfma_f32_16x16x32_bf16 v[160:163], v[48:51], a[64:67], v[160:163]
    s_mov_b32 vcc_lo, 0x10101010
    s_mov_b32 vcc_hi, 0x10101010
    v_cndmask_b32_e64 v91, v91, 0, vcc
    v_mfma_f32_16x16x32_bf16 v[160:163], v[52:55], a[68:71], v[160:163]
    s_lshl_b32 s98, s98, 5
    v_xor_b32 v94, s98, v95
    ds_read_b64_tr_b16 v[44:45], v17 offset:8192
    v_mfma_f32_16x16x32_bf16 v[164:167], v[48:51], a[72:75], v[164:167]
    s_lshl_b32 s72, s72, 7
    ds_read_b128 a[12:15], v23 offset:18432
    ds_read_b64_tr_b16 v[46:47], v17 offset:9216
    v_mfma_f32_16x16x32_bf16 v[164:167], v[52:55], a[76:79], v[164:167]
    s_add_u32 m0, s69, 16384
    v_mfma_f32_16x16x32_bf16 v[168:171], v[48:51], a[80:83], v[168:171]
    s_xor_b32 s60, s60, 524288
    buffer_load_dwordx4 v6, s[8:11], s62 offen lds
    v_mfma_f32_16x16x32_bf16 v[168:171], v[52:55], a[84:87], v[168:171]
    s_cmp_lt_u32 s2, 192
    s_cselect_b32 s72, s72, 1073741824
    v_mfma_f32_16x16x32_bf16 v[172:175], v[48:51], a[88:91], v[172:175]
    s_lshl2_add_u32 s99, s100, s4
    buffer_store_dwordx4 v[88:91], v94, s[28:31], s72 offen sc1
    v_mfma_f32_16x16x32_bf16 v[172:175], v[52:55], a[92:95], v[172:175]
    s_add_u32 s28, s28, s7
    s_addc_u32 s29, s29, 0
    v_mfma_f32_16x16x32_bf16 v[176:179], v[48:51], a[96:99], v[176:179]
    s_mov_b32 s30, 73728
    ds_read_b128 a[16:19], v22 offset:20480
    v_mfma_f32_16x16x32_bf16 v[176:179], v[52:55], a[100:103], v[176:179]
    s_lshl_b32 s99, s99, 7
    v_mfma_f32_16x16x32_bf16 v[180:183], v[48:51], a[104:107], v[180:183]
    v_mfma_f32_16x16x32_bf16 v[180:183], v[52:55], a[108:111], v[180:183]
    buffer_load_dwordx4 v7, s[8:11], s62 offen offset:1024 lds
    v_mfma_f32_16x16x32_bf16 v[184:187], v[48:51], a[112:115], v[184:187]
    v_mfma_f32_16x16x32_bf16 v[184:187], v[52:55], a[116:119], v[184:187]
    ds_read_b128 a[20:23], v23 offset:20480
    v_mfma_f32_16x16x32_bf16 v[188:191], v[48:51], a[120:123], v[188:191]
    ds_read_b64_tr_b16 v[48:49], v14 offset:32768
    ds_read_b64_tr_b16 v[50:51], v14 offset:33792
    v_mfma_f32_16x16x32_bf16 v[188:191], v[52:55], a[124:127], v[188:191]
    ds_read_b64_tr_b16 v[52:53], v14 offset:40960
    ds_read_b64_tr_b16 v[54:55], v14 offset:41984
    v_mfma_f32_16x16x32_bf16 v[192:195], v[56:59], a[64:67], v[192:195]
    v_add_u32 v14, 0x10000, v14
    v_mfma_f32_16x16x32_bf16 v[192:195], v[60:63], a[68:71], v[192:195]
    v_mfma_f32_16x16x32_bf16 v[196:199], v[56:59], a[72:75], v[196:199]
    v_mfma_f32_16x16x32_bf16 v[196:199], v[60:63], a[76:79], v[196:199]
    buffer_load_dwordx4 v8, s[8:11], s62 offen offset:2048 lds
    v_mfma_f32_16x16x32_bf16 v[200:203], v[56:59], a[80:83], v[200:203]
    ds_read_b128 a[24:27], v22 offset:22528
    v_mfma_f32_16x16x32_bf16 v[200:203], v[60:63], a[84:87], v[200:203]
    v_mfma_f32_16x16x32_bf16 v[204:207], v[56:59], a[88:91], v[204:207]
    v_mfma_f32_16x16x32_bf16 v[204:207], v[60:63], a[92:95], v[204:207]
    v_mfma_f32_16x16x32_bf16 v[208:211], v[56:59], a[96:99], v[208:211]
    ds_read_b128 a[28:31], v23 offset:22528
    v_mfma_f32_16x16x32_bf16 v[208:211], v[60:63], a[100:103], v[208:211]
    v_mfma_f32_16x16x32_bf16 v[212:215], v[56:59], a[104:107], v[212:215]
    buffer_load_dwordx4 v9, s[8:11], s62 offen offset:3072 lds
    v_mfma_f32_16x16x32_bf16 v[212:215], v[60:63], a[108:111], v[212:215]
    v_mfma_f32_16x16x32_bf16 v[216:219], v[56:59], a[112:115], v[216:219]
    v_mfma_f32_16x16x32_bf16 v[216:219], v[60:63], a[116:119], v[216:219]
    v_mfma_f32_16x16x32_bf16 v[220:223], v[56:59], a[120:123], v[220:223]
    s_waitcnt lgkmcnt(0)
    ds_read_b64_tr_b16 v[56:57], v15 offset:32768
    ds_read_b64_tr_b16 v[58:59], v15 offset:33792
    v_mfma_f32_16x16x32_bf16 v[220:223], v[60:63], a[124:127], v[220:223]
    ds_read_b64_tr_b16 v[60:61], v15 offset:40960
    ds_read_b64_tr_b16 v[62:63], v15 offset:41984
    v_mfma_f32_16x16x32_bf16 v[224:227], v[40:43], a[64:67], v[224:227]
    v_add_u32 v15, 0x10000, v15
    v_mfma_f32_16x16x32_bf16 v[224:227], v[44:47], a[68:71], v[224:227]
    s_xor_b32 s62, s62, 384
    v_mfma_f32_16x16x32_bf16 v[228:231], v[40:43], a[72:75], v[228:231]
    buffer_load_dword v107, v103, s[24:27], s77 offen
    v_mfma_f32_16x16x32_bf16 v[228:231], v[44:47], a[76:79], v[228:231]
    s_add_u32 s77, s77, 4608
    v_mfma_f32_16x16x32_bf16 v[232:235], v[40:43], a[80:83], v[232:235]
    v_mfma_f32_16x16x32_bf16 v[232:235], v[44:47], a[84:87], v[232:235]
    s_add_u32 m0, s69, 32768
    v_mfma_f32_16x16x32_bf16 v[236:239], v[40:43], a[88:91], v[236:239]
    buffer_load_dwordx4 v2, s[12:15], s60 offen nt lds
    v_mfma_f32_16x16x32_bf16 v[236:239], v[44:47], a[92:95], v[236:239]
    v_mfma_f32_16x16x32_bf16 v[240:243], v[40:43], a[96:99], v[240:243]
    v_mfma_f32_16x16x32_bf16 v[240:243], v[44:47], a[100:103], v[240:243]
    v_mfma_f32_16x16x32_bf16 v[244:247], v[40:43], a[104:107], v[244:247]
    v_mfma_f32_16x16x32_bf16 v[244:247], v[44:47], a[108:111], v[244:247]
    v_mfma_f32_16x16x32_bf16 v[248:251], v[40:43], a[112:115], v[248:251]
    v_mfma_f32_16x16x32_bf16 v[248:251], v[44:47], a[116:119], v[248:251]
    buffer_load_dwordx4 v3, s[12:15], s60 offen offset:1024 nt lds
    v_mfma_f32_16x16x32_bf16 v[252:255], v[40:43], a[120:123], v[252:255]
    ds_read_b64_tr_b16 v[40:41], v16 offset:32768
    ds_read_b64_tr_b16 v[42:43], v16 offset:33792
    v_mfma_f32_16x16x32_bf16 v[252:255], v[44:47], a[124:127], v[252:255]
    ds_read_b64_tr_b16 v[44:45], v16 offset:40960
    ds_read_b64_tr_b16 v[46:47], v16 offset:41984
    v_mfma_f32_16x16x32_bf16 a[128:131], a[64:67], v[48:51], a[128:131]
    v_add_u32 v16, 0x10000, v16
    v_mfma_f32_16x16x32_bf16 a[128:131], a[68:71], v[52:55], a[128:131]
    v_mfma_f32_16x16x32_bf16 a[132:135], a[72:75], v[48:51], a[132:135]
    ds_read_b128 a[32:35], v22 offset:49152
    v_mfma_f32_16x16x32_bf16 a[132:135], a[76:79], v[52:55], a[132:135]
    v_mfma_f32_16x16x32_bf16 a[136:139], a[80:83], v[48:51], a[136:139]
    v_mfma_f32_16x16x32_bf16 a[136:139], a[84:87], v[52:55], a[136:139]
    buffer_load_dwordx4 v4, s[12:15], s60 offen offset:2048 nt lds
    v_mfma_f32_16x16x32_bf16 a[140:143], a[88:91], v[48:51], a[140:143]
    v_mfma_f32_16x16x32_bf16 a[140:143], a[92:95], v[52:55], a[140:143]
    ds_read_b128 a[36:39], v23 offset:49152
    v_mfma_f32_16x16x32_bf16 a[144:147], a[96:99], v[48:51], a[144:147]
    v_mfma_f32_16x16x32_bf16 a[144:147], a[100:103], v[52:55], a[144:147]
    v_mfma_f32_16x16x32_bf16 a[148:151], a[104:107], v[48:51], a[148:151]
    v_mfma_f32_16x16x32_bf16 a[148:151], a[108:111], v[52:55], a[148:151]
    v_mfma_f32_16x16x32_bf16 a[152:155], a[112:115], v[48:51], a[152:155]
    buffer_load_dwordx4 v5, s[12:15], s60 offen offset:3072 nt lds
    v_mfma_f32_16x16x32_bf16 a[152:155], a[116:119], v[52:55], a[152:155]
    ds_read_b128 a[40:43], v22 offset:51200
    v_mfma_f32_16x16x32_bf16 a[156:159], a[120:123], v[48:51], a[156:159]
    ds_read_b64_tr_b16 v[48:49], v17 offset:32768
    ds_read_b64_tr_b16 v[50:51], v17 offset:33792
    v_mfma_f32_16x16x32_bf16 a[156:159], a[124:127], v[52:55], a[156:159]
    s_waitcnt lgkmcnt(3)
    ds_read_b64_tr_b16 v[52:53], v17 offset:40960
    ds_read_b64_tr_b16 v[54:55], v17 offset:41984
    v_mfma_f32_16x16x32_bf16 a[160:163], a[64:67], v[56:59], a[160:163]
    v_add_u32 v17, 0x10000, v17
    v_mfma_f32_16x16x32_bf16 a[160:163], a[68:71], v[60:63], a[160:163]
    v_mfma_f32_16x16x32_bf16 a[164:167], a[72:75], v[56:59], a[164:167]
    ds_read_b128 a[44:47], v23 offset:51200
    v_mfma_f32_16x16x32_bf16 a[164:167], a[76:79], v[60:63], a[164:167]
    s_add_u32 m0, s69, 49152
    v_mfma_f32_16x16x32_bf16 a[168:171], a[80:83], v[56:59], a[168:171]
    buffer_load_dwordx4 v6, s[8:11], s61 offen lds
    v_mfma_f32_16x16x32_bf16 a[168:171], a[84:87], v[60:63], a[168:171]
    v_mfma_f32_16x16x32_bf16 a[172:175], a[88:91], v[56:59], a[172:175]
    v_mfma_f32_16x16x32_bf16 a[172:175], a[92:95], v[60:63], a[172:175]
    v_mfma_f32_16x16x32_bf16 a[176:179], a[96:99], v[56:59], a[176:179]
    ds_read_b128 a[48:51], v22 offset:53248
    v_mfma_f32_16x16x32_bf16 a[176:179], a[100:103], v[60:63], a[176:179]
    v_mfma_f32_16x16x32_bf16 a[180:183], a[104:107], v[56:59], a[180:183]
    v_mfma_f32_16x16x32_bf16 a[180:183], a[108:111], v[60:63], a[180:183]
    buffer_load_dwordx4 v7, s[8:11], s61 offen offset:1024 lds
    v_mfma_f32_16x16x32_bf16 a[184:187], a[112:115], v[56:59], a[184:187]
    v_mfma_f32_16x16x32_bf16 a[184:187], a[116:119], v[60:63], a[184:187]
    ds_read_b128 a[52:55], v23 offset:53248
    v_mfma_f32_16x16x32_bf16 a[188:191], a[120:123], v[56:59], a[188:191]
    v_mfma_f32_16x16x32_bf16 a[188:191], a[124:127], v[60:63], a[188:191]
    v_mfma_f32_16x16x32_bf16 a[192:195], a[64:67], v[40:43], a[192:195]
    v_mfma_f32_16x16x32_bf16 a[192:195], a[68:71], v[44:47], a[192:195]
    v_mfma_f32_16x16x32_bf16 a[196:199], a[72:75], v[40:43], a[196:199]
    v_mfma_f32_16x16x32_bf16 a[196:199], a[76:79], v[44:47], a[196:199]
    buffer_load_dwordx4 v8, s[8:11], s61 offen offset:2048 lds
    v_mfma_f32_16x16x32_bf16 a[200:203], a[80:83], v[40:43], a[200:203]
    ds_read_b128 a[56:59], v22 offset:55296
    v_mfma_f32_16x16x32_bf16 a[200:203], a[84:87], v[44:47], a[200:203]
    v_mfma_f32_16x16x32_bf16 a[204:207], a[88:91], v[40:43], a[204:207]
    v_mfma_f32_16x16x32_bf16 a[204:207], a[92:95], v[44:47], a[204:207]
    v_mfma_f32_16x16x32_bf16 a[208:211], a[96:99], v[40:43], a[208:211]
    ds_read_b128 a[60:63], v23 offset:55296
    v_mfma_f32_16x16x32_bf16 a[208:211], a[100:103], v[44:47], a[208:211]
    v_mfma_f32_16x16x32_bf16 a[212:215], a[104:107], v[40:43], a[212:215]
    buffer_load_dwordx4 v9, s[8:11], s61 offen offset:3072 lds
    v_mfma_f32_16x16x32_bf16 a[212:215], a[108:111], v[44:47], a[212:215]
    v_mfma_f32_16x16x32_bf16 a[216:219], a[112:115], v[40:43], a[216:219]
    v_mfma_f32_16x16x32_bf16 a[216:219], a[116:119], v[44:47], a[216:219]
    v_mfma_f32_16x16x32_bf16 a[220:223], a[120:123], v[40:43], a[220:223]
    v_mfma_f32_16x16x32_bf16 a[220:223], a[124:127], v[44:47], a[220:223]
    s_waitcnt lgkmcnt(0)
    v_mfma_f32_16x16x32_bf16 a[224:227], a[64:67], v[48:51], a[224:227]
    v_mfma_f32_16x16x32_bf16 a[224:227], a[68:71], v[52:55], a[224:227]
    s_xor_b32 s61, s61, 128
    v_mfma_f32_16x16x32_bf16 a[228:231], a[72:75], v[48:51], a[228:231]
    v_mfma_f32_16x16x32_bf16 a[228:231], a[76:79], v[52:55], a[228:231]
    v_mfma_f32_16x16x32_bf16 a[232:235], a[80:83], v[48:51], a[232:235]
    v_mfma_f32_16x16x32_bf16 a[232:235], a[84:87], v[52:55], a[232:235]
    s_waitcnt vmcnt(9) lgkmcnt(0)
    s_barrier
    ds_read_b64_tr_b16 v[56:57], v14 offset:0
    v_mfma_f32_16x16x32_bf16 a[236:239], a[88:91], v[48:51], a[236:239]
    s_add_u32 m0, s69, 65536
    ds_read_b64_tr_b16 v[58:59], v14 offset:1024
    ds_read_b64_tr_b16 v[60:61], v14 offset:8192
    v_mfma_f32_16x16x32_bf16 a[236:239], a[92:95], v[52:55], a[236:239]
    buffer_load_dwordx4 v2, s[16:19], s60 offen nt lds
    v_mfma_f32_16x16x32_bf16 a[240:243], a[96:99], v[48:51], a[240:243]
    ds_read_b64_tr_b16 v[62:63], v14 offset:9216
    ds_read_b64_tr_b16 v[40:41], v15 offset:0
    v_mfma_f32_16x16x32_bf16 a[240:243], a[100:103], v[52:55], a[240:243]
    buffer_atomic_add v31, v30, s[44:47], s95 offen sc1
    v_mfma_f32_16x16x32_bf16 a[244:247], a[104:107], v[48:51], a[244:247]
    s_mov_b32 s95, 32768
    ds_read_b64_tr_b16 v[42:43], v15 offset:1024
    ds_read_b64_tr_b16 v[44:45], v15 offset:8192
    v_mfma_f32_16x16x32_bf16 a[244:247], a[108:111], v[52:55], a[244:247]
    ds_read_b64_tr_b16 v[46:47], v15 offset:9216
    v_add_u32 v14, 0xfffe0000, v14
    v_mfma_f32_16x16x32_bf16 a[248:251], a[112:115], v[48:51], a[248:251]
    v_add_u32 v15, 0xfffe0000, v15
    v_mfma_f32_16x16x32_bf16 a[248:251], a[116:119], v[52:55], a[248:251]
    buffer_load_dwordx4 v3, s[16:19], s60 offen offset:1024 nt lds
    v_mfma_f32_16x16x32_bf16 a[252:255], a[120:123], v[48:51], a[252:255]
    ds_read_b64_tr_b16 v[48:49], v16 offset:0
    ds_read_b64_tr_b16 v[50:51], v16 offset:1024
    v_mfma_f32_16x16x32_bf16 a[252:255], a[124:127], v[52:55], a[252:255]
    s_waitcnt lgkmcnt(3)
    ds_read_b64_tr_b16 v[52:53], v16 offset:8192
    ds_read_b64_tr_b16 v[54:55], v16 offset:9216
    v_mfma_f32_16x16x32_bf16 v[128:131], v[56:59], a[0:3], v[128:131]
    v_add_u32 v16, 0xfffe0000, v16
    v_mfma_f32_16x16x32_bf16 v[128:131], v[60:63], a[4:7], v[128:131]
    v_add_u32 v22, 0x10000, v22
    v_mfma_f32_16x16x32_bf16 v[132:135], v[56:59], a[8:11], v[132:135]
    ds_read_b128 a[64:67], v22 offset:16384
    v_mfma_f32_16x16x32_bf16 v[132:135], v[60:63], a[12:15], v[132:135]
    v_mfma_f32_16x16x32_bf16 v[136:139], v[56:59], a[16:19], v[136:139]
    v_mfma_f32_16x16x32_bf16 v[136:139], v[60:63], a[20:23], v[136:139]
    buffer_load_dwordx4 v4, s[16:19], s60 offen offset:2048 nt lds
    v_mfma_f32_16x16x32_bf16 v[140:143], v[56:59], a[24:27], v[140:143]
    v_add_u32 v23, 0x10000, v23
    v_mfma_f32_16x16x32_bf16 v[140:143], v[60:63], a[28:31], v[140:143]
    ds_read_b128 a[68:71], v23 offset:16384
    v_mfma_f32_16x16x32_bf16 v[144:147], v[56:59], a[32:35], v[144:147]
    v_mfma_f32_16x16x32_bf16 v[144:147], v[60:63], a[36:39], v[144:147]
    v_mfma_f32_16x16x32_bf16 v[148:151], v[56:59], a[40:43], v[148:151]
    v_mfma_f32_16x16x32_bf16 v[148:151], v[60:63], a[44:47], v[148:151]
    v_mfma_f32_16x16x32_bf16 v[152:155], v[56:59], a[48:51], v[152:155]
    buffer_load_dwordx4 v5, s[16:19], s60 offen offset:3072 nt lds
    v_mfma_f32_16x16x32_bf16 v[152:155], v[60:63], a[52:55], v[152:155]
    ds_read_b128 a[72:75], v22 offset:18432
    v_mfma_f32_16x16x32_bf16 v[156:159], v[56:59], a[56:59], v[156:159]
    ds_read_b64_tr_b16 v[56:57], v17 offset:0
    ds_read_b64_tr_b16 v[58:59], v17 offset:1024
    v_mfma_f32_16x16x32_bf16 v[156:159], v[60:63], a[60:63], v[156:159]
    ds_read_b64_tr_b16 v[60:61], v17 offset:8192
    ds_read_b64_tr_b16 v[62:63], v17 offset:9216
    v_mfma_f32_16x16x32_bf16 v[160:163], v[40:43], a[0:3], v[160:163]
    s_waitcnt lgkmcnt(5)
    v_add_u32 v17, 0xfffe0000, v17
    v_mfma_f32_16x16x32_bf16 v[160:163], v[44:47], a[4:7], v[160:163]
    v_mfma_f32_16x16x32_bf16 v[164:167], v[40:43], a[8:11], v[164:167]
    ds_read_b128 a[76:79], v23 offset:18432
    v_mfma_f32_16x16x32_bf16 v[164:167], v[44:47], a[12:15], v[164:167]
    s_add_u32 m0, s69, 81920
    v_mfma_f32_16x16x32_bf16 v[168:171], v[40:43], a[16:19], v[168:171]
    s_xor_b32 s60, s60, 1572864
    buffer_load_dwordx4 v6, s[8:11], s62 offen lds
    v_mfma_f32_16x16x32_bf16 v[168:171], v[44:47], a[20:23], v[168:171]
    v_mfma_f32_16x16x32_bf16 v[172:175], v[40:43], a[24:27], v[172:175]
    v_mfma_f32_16x16x32_bf16 v[172:175], v[44:47], a[28:31], v[172:175]
    v_mfma_f32_16x16x32_bf16 v[176:179], v[40:43], a[32:35], v[176:179]
    ds_read_b128 a[80:83], v22 offset:20480
    v_mfma_f32_16x16x32_bf16 v[176:179], v[44:47], a[36:39], v[176:179]
    v_mfma_f32_16x16x32_bf16 v[180:183], v[40:43], a[40:43], v[180:183]
    v_mfma_f32_16x16x32_bf16 v[180:183], v[44:47], a[44:47], v[180:183]
    buffer_load_dwordx4 v7, s[8:11], s62 offen offset:1024 lds
    v_mfma_f32_16x16x32_bf16 v[184:187], v[40:43], a[48:51], v[184:187]
    v_mfma_f32_16x16x32_bf16 v[184:187], v[44:47], a[52:55], v[184:187]
    ds_read_b128 a[84:87], v23 offset:20480
    v_mfma_f32_16x16x32_bf16 v[188:191], v[40:43], a[56:59], v[188:191]
    ds_read_b64_tr_b16 v[40:41], v14 offset:0
    ds_read_b64_tr_b16 v[42:43], v14 offset:1024
    v_mfma_f32_16x16x32_bf16 v[188:191], v[44:47], a[60:63], v[188:191]
    ds_read_b64_tr_b16 v[44:45], v14 offset:8192
    ds_read_b64_tr_b16 v[46:47], v14 offset:9216
    v_mfma_f32_16x16x32_bf16 v[192:195], v[48:51], a[0:3], v[192:195]
    v_mfma_f32_16x16x32_bf16 v[192:195], v[52:55], a[4:7], v[192:195]
    v_mfma_f32_16x16x32_bf16 v[196:199], v[48:51], a[8:11], v[196:199]
    v_mfma_f32_16x16x32_bf16 v[196:199], v[52:55], a[12:15], v[196:199]
    buffer_load_dwordx4 v8, s[8:11], s62 offen offset:2048 lds
    v_mfma_f32_16x16x32_bf16 v[200:203], v[48:51], a[16:19], v[200:203]
    ds_read_b128 a[88:91], v22 offset:22528
    v_mfma_f32_16x16x32_bf16 v[200:203], v[52:55], a[20:23], v[200:203]
    v_mfma_f32_16x16x32_bf16 v[204:207], v[48:51], a[24:27], v[204:207]
    v_mfma_f32_16x16x32_bf16 v[204:207], v[52:55], a[28:31], v[204:207]
    v_mfma_f32_16x16x32_bf16 v[208:211], v[48:51], a[32:35], v[208:211]
    ds_read_b128 a[92:95], v23 offset:22528
    v_mfma_f32_16x16x32_bf16 v[208:211], v[52:55], a[36:39], v[208:211]
    v_mfma_f32_16x16x32_bf16 v[212:215], v[48:51], a[40:43], v[212:215]
    buffer_load_dwordx4 v9, s[8:11], s62 offen offset:3072 lds
    v_mfma_f32_16x16x32_bf16 v[212:215], v[52:55], a[44:47], v[212:215]
    v_mfma_f32_16x16x32_bf16 v[216:219], v[48:51], a[48:51], v[216:219]
    v_mfma_f32_16x16x32_bf16 v[216:219], v[52:55], a[52:55], v[216:219]
    v_mfma_f32_16x16x32_bf16 v[220:223], v[48:51], a[56:59], v[220:223]
    s_waitcnt lgkmcnt(0)
    ds_read_b64_tr_b16 v[48:49], v15 offset:0
    ds_read_b64_tr_b16 v[50:51], v15 offset:1024
    v_mfma_f32_16x16x32_bf16 v[220:223], v[52:55], a[60:63], v[220:223]
    ds_read_b64_tr_b16 v[52:53], v15 offset:8192
    ds_read_b64_tr_b16 v[54:55], v15 offset:9216
    v_mfma_f32_16x16x32_bf16 v[224:227], v[56:59], a[0:3], v[224:227]
    v_mfma_f32_16x16x32_bf16 v[224:227], v[60:63], a[4:7], v[224:227]
    s_xor_b32 s62, s62, 128
    v_mfma_f32_16x16x32_bf16 v[228:231], v[56:59], a[8:11], v[228:231]
    buffer_load_dword v108, v103, s[24:27], s77 offen
    v_mfma_f32_16x16x32_bf16 v[228:231], v[60:63], a[12:15], v[228:231]
    s_add_u32 s77, s77, 4608
    v_mfma_f32_16x16x32_bf16 v[232:235], v[56:59], a[16:19], v[232:235]
    v_mfma_f32_16x16x32_bf16 v[232:235], v[60:63], a[20:23], v[232:235]
    s_add_u32 m0, s69, 98304
    v_mfma_f32_16x16x32_bf16 v[236:239], v[56:59], a[24:27], v[236:239]
    buffer_load_dwordx4 v2, s[12:15], s60 offen nt lds
    v_mfma_f32_16x16x32_bf16 v[236:239], v[60:63], a[28:31], v[236:239]
    v_mfma_f32_16x16x32_bf16 v[240:243], v[56:59], a[32:35], v[240:243]
    v_mfma_f32_16x16x32_bf16 v[240:243], v[60:63], a[36:39], v[240:243]
    v_mfma_f32_16x16x32_bf16 v[244:247], v[56:59], a[40:43], v[244:247]
    v_mfma_f32_16x16x32_bf16 v[244:247], v[60:63], a[44:47], v[244:247]
    v_mfma_f32_16x16x32_bf16 v[248:251], v[56:59], a[48:51], v[248:251]
    v_mfma_f32_16x16x32_bf16 v[248:251], v[60:63], a[52:55], v[248:251]
    buffer_load_dwordx4 v3, s[12:15], s60 offen offset:1024 nt lds
    v_mfma_f32_16x16x32_bf16 v[252:255], v[56:59], a[56:59], v[252:255]
    ds_read_b64_tr_b16 v[56:57], v16 offset:0
    ds_read_b64_tr_b16 v[58:59], v16 offset:1024
    v_mfma_f32_16x16x32_bf16 v[252:255], v[60:63], a[60:63], v[252:255]
    ds_read_b64_tr_b16 v[60:61], v16 offset:8192
    ds_read_b64_tr_b16 v[62:63], v16 offset:9216
    v_mfma_f32_16x16x32_bf16 a[128:131], a[0:3], v[40:43], a[128:131]
    v_mfma_f32_16x16x32_bf16 a[128:131], a[4:7], v[44:47], a[128:131]
    v_add_u32 v22, 0xfffe0000, v22
    v_mfma_f32_16x16x32_bf16 a[132:135], a[8:11], v[40:43], a[132:135]
    ds_read_b128 a[96:99], v22 offset:16384
    v_mfma_f32_16x16x32_bf16 a[132:135], a[12:15], v[44:47], a[132:135]
    v_mfma_f32_16x16x32_bf16 a[136:139], a[16:19], v[40:43], a[136:139]
    v_mfma_f32_16x16x32_bf16 a[136:139], a[20:23], v[44:47], a[136:139]
    buffer_load_dwordx4 v4, s[12:15], s60 offen offset:2048 nt lds
    v_mfma_f32_16x16x32_bf16 a[140:143], a[24:27], v[40:43], a[140:143]
    v_add_u32 v23, 0xfffe0000, v23
    v_mfma_f32_16x16x32_bf16 a[140:143], a[28:31], v[44:47], a[140:143]
    ds_read_b128 a[100:103], v23 offset:16384
    v_mfma_f32_16x16x32_bf16 a[144:147], a[32:35], v[40:43], a[144:147]
    v_mfma_f32_16x16x32_bf16 a[144:147], a[36:39], v[44:47], a[144:147]
    v_mfma_f32_16x16x32_bf16 a[148:151], a[40:43], v[40:43], a[148:151]
    v_mfma_f32_16x16x32_bf16 a[148:151], a[44:47], v[44:47], a[148:151]
    v_mfma_f32_16x16x32_bf16 a[152:155], a[48:51], v[40:43], a[152:155]
    buffer_load_dwordx4 v5, s[12:15], s60 offen offset:3072 nt lds
    v_mfma_f32_16x16x32_bf16 a[152:155], a[52:55], v[44:47], a[152:155]
    ds_read_b128 a[104:107], v22 offset:18432
    v_mfma_f32_16x16x32_bf16 a[156:159], a[56:59], v[40:43], a[156:159]
    ds_read_b64_tr_b16 v[40:41], v17 offset:0
    ds_read_b64_tr_b16 v[42:43], v17 offset:1024
    v_mfma_f32_16x16x32_bf16 a[156:159], a[60:63], v[44:47], a[156:159]
    s_waitcnt lgkmcnt(3)
    ds_read_b64_tr_b16 v[44:45], v17 offset:8192
    ds_read_b64_tr_b16 v[46:47], v17 offset:9216
    v_mfma_f32_16x16x32_bf16 a[160:163], a[0:3], v[48:51], a[160:163]
    v_mfma_f32_16x16x32_bf16 a[160:163], a[4:7], v[52:55], a[160:163]
    v_mfma_f32_16x16x32_bf16 a[164:167], a[8:11], v[48:51], a[164:167]
    ds_read_b128 a[108:111], v23 offset:18432
    v_mfma_f32_16x16x32_bf16 a[164:167], a[12:15], v[52:55], a[164:167]
    s_add_u32 m0, s69, 114688
    v_mfma_f32_16x16x32_bf16 a[168:171], a[16:19], v[48:51], a[168:171]
    s_xor_b32 s60, s60, 524288
    buffer_load_dwordx4 v6, s[8:11], s61 offen lds
    v_mfma_f32_16x16x32_bf16 a[168:171], a[20:23], v[52:55], a[168:171]
    v_mfma_f32_16x16x32_bf16 a[172:175], a[24:27], v[48:51], a[172:175]
    v_mfma_f32_16x16x32_bf16 a[172:175], a[28:31], v[52:55], a[172:175]
    v_mfma_f32_16x16x32_bf16 a[176:179], a[32:35], v[48:51], a[176:179]
    ds_read_b128 a[112:115], v22 offset:20480
    v_mfma_f32_16x16x32_bf16 a[176:179], a[36:39], v[52:55], a[176:179]
    v_mfma_f32_16x16x32_bf16 a[180:183], a[40:43], v[48:51], a[180:183]
    v_mfma_f32_16x16x32_bf16 a[180:183], a[44:47], v[52:55], a[180:183]
    buffer_load_dwordx4 v7, s[8:11], s61 offen offset:1024 lds
    v_mfma_f32_16x16x32_bf16 a[184:187], a[48:51], v[48:51], a[184:187]
    v_mfma_f32_16x16x32_bf16 a[184:187], a[52:55], v[52:55], a[184:187]
    ds_read_b128 a[116:119], v23 offset:20480
    v_mfma_f32_16x16x32_bf16 a[188:191], a[56:59], v[48:51], a[188:191]
    v_mfma_f32_16x16x32_bf16 a[188:191], a[60:63], v[52:55], a[188:191]
    v_mfma_f32_16x16x32_bf16 a[192:195], a[0:3], v[56:59], a[192:195]
    v_mfma_f32_16x16x32_bf16 a[192:195], a[4:7], v[60:63], a[192:195]
    v_mfma_f32_16x16x32_bf16 a[196:199], a[8:11], v[56:59], a[196:199]
    v_mfma_f32_16x16x32_bf16 a[196:199], a[12:15], v[60:63], a[196:199]
    buffer_load_dwordx4 v8, s[8:11], s61 offen offset:2048 lds
    v_mfma_f32_16x16x32_bf16 a[200:203], a[16:19], v[56:59], a[200:203]
    ds_read_b128 a[120:123], v22 offset:22528
    v_mfma_f32_16x16x32_bf16 a[200:203], a[20:23], v[60:63], a[200:203]
    v_mfma_f32_16x16x32_bf16 a[204:207], a[24:27], v[56:59], a[204:207]
    v_mfma_f32_16x16x32_bf16 a[204:207], a[28:31], v[60:63], a[204:207]
    v_mfma_f32_16x16x32_bf16 a[208:211], a[32:35], v[56:59], a[208:211]
    ds_read_b128 a[124:127], v23 offset:22528
    v_mfma_f32_16x16x32_bf16 a[208:211], a[36:39], v[60:63], a[208:211]
    v_mfma_f32_16x16x32_bf16 a[212:215], a[40:43], v[56:59], a[212:215]
    buffer_load_dwordx4 v9, s[8:11], s61 offen offset:3072 lds
    v_mfma_f32_16x16x32_bf16 a[212:215], a[44:47], v[60:63], a[212:215]
    v_mfma_f32_16x16x32_bf16 a[216:219], a[48:51], v[56:59], a[216:219]
    v_mfma_f32_16x16x32_bf16 a[216:219], a[52:55], v[60:63], a[216:219]
    v_mfma_f32_16x16x32_bf16 a[220:223], a[56:59], v[56:59], a[220:223]
    v_mfma_f32_16x16x32_bf16 a[220:223], a[60:63], v[60:63], a[220:223]
    s_waitcnt lgkmcnt(0)
    v_mfma_f32_16x16x32_bf16 a[224:227], a[0:3], v[40:43], a[224:227]
    v_mfma_f32_16x16x32_bf16 a[224:227], a[4:7], v[44:47], a[224:227]
    s_xor_b32 s61, s61, 1920
    v_mfma_f32_16x16x32_bf16 a[228:231], a[8:11], v[40:43], a[228:231]
    s_andn2_b32 s61, s61, 896
    v_mfma_f32_16x16x32_bf16 a[228:231], a[12:15], v[44:47], a[228:231]
    s_lshl_b32 s61, s5, 7
    v_mfma_f32_16x16x32_bf16 a[232:235], a[16:19], v[40:43], a[232:235]
    v_mfma_f32_16x16x32_bf16 a[232:235], a[20:23], v[44:47], a[232:235]
    s_waitcnt vmcnt(9) lgkmcnt(0)
    s_barrier
    ds_read_b64_tr_b16 v[48:49], v14 offset:32768
    v_mfma_f32_16x16x32_bf16 a[236:239], a[24:27], v[40:43], a[236:239]
    s_add_u32 m0, s69, 131072
    ds_read_b64_tr_b16 v[50:51], v14 offset:33792
    ds_read_b64_tr_b16 v[52:53], v14 offset:40960
    v_mfma_f32_16x16x32_bf16 a[236:239], a[28:31], v[44:47], a[236:239]
    buffer_load_dwordx4 v2, s[12:15], s60 offen nt lds
    v_mfma_f32_16x16x32_bf16 a[240:243], a[32:35], v[40:43], a[240:243]
    ds_read_b64_tr_b16 v[54:55], v14 offset:41984
    ds_read_b64_tr_b16 v[56:57], v15 offset:32768
    v_mfma_f32_16x16x32_bf16 a[240:243], a[36:39], v[44:47], a[240:243]
    ds_read_b64_tr_b16 v[58:59], v15 offset:33792
    ds_read_b64_tr_b16 v[60:61], v15 offset:40960
    v_mfma_f32_16x16x32_bf16 a[244:247], a[40:43], v[40:43], a[244:247]
    ds_read_b64_tr_b16 v[62:63], v15 offset:41984
    v_add_u32 v14, 0x10000, v14
    v_mfma_f32_16x16x32_bf16 a[244:247], a[44:47], v[44:47], a[244:247]
    v_add_u32 v15, 0x10000, v15
    v_mfma_f32_16x16x32_bf16 a[248:251], a[48:51], v[40:43], a[248:251]
    v_mfma_f32_16x16x32_bf16 a[248:251], a[52:55], v[44:47], a[248:251]
    buffer_load_dwordx4 v3, s[12:15], s60 offen offset:1024 nt lds
    v_mfma_f32_16x16x32_bf16 a[252:255], a[56:59], v[40:43], a[252:255]
    ds_read_b64_tr_b16 v[40:41], v16 offset:32768
    ds_read_b64_tr_b16 v[42:43], v16 offset:33792
    v_mfma_f32_16x16x32_bf16 a[252:255], a[60:63], v[44:47], a[252:255]
    s_waitcnt lgkmcnt(2)
    ds_read_b64_tr_b16 v[44:45], v16 offset:40960
    ds_read_b64_tr_b16 v[46:47], v16 offset:41984
    v_mfma_f32_16x16x32_bf16 v[128:131], v[48:51], a[64:67], v[128:131]
    v_add_u32 v16, 0x10000, v16
    v_mfma_f32_16x16x32_bf16 v[128:131], v[52:55], a[68:71], v[128:131]
    v_mfma_f32_16x16x32_bf16 v[132:135], v[48:51], a[72:75], v[132:135]
    ds_read_b128 a[0:3], v22 offset:49152
    v_mfma_f32_16x16x32_bf16 v[132:135], v[52:55], a[76:79], v[132:135]
    v_mfma_f32_16x16x32_bf16 v[136:139], v[48:51], a[80:83], v[136:139]
    v_mfma_f32_16x16x32_bf16 v[136:139], v[52:55], a[84:87], v[136:139]
    buffer_load_dwordx4 v4, s[12:15], s60 offen offset:2048 nt lds
    v_mfma_f32_16x16x32_bf16 v[140:143], v[48:51], a[88:91], v[140:143]
    v_mfma_f32_16x16x32_bf16 v[140:143], v[52:55], a[92:95], v[140:143]
    ds_read_b128 a[4:7], v23 offset:49152
    v_mfma_f32_16x16x32_bf16 v[144:147], v[48:51], a[96:99], v[144:147]
    v_mfma_f32_16x16x32_bf16 v[144:147], v[52:55], a[100:103], v[144:147]
    v_mfma_f32_16x16x32_bf16 v[148:151], v[48:51], a[104:107], v[148:151]
    v_mfma_f32_16x16x32_bf16 v[148:151], v[52:55], a[108:111], v[148:151]
    v_mfma_f32_16x16x32_bf16 v[152:155], v[48:51], a[112:115], v[152:155]
    buffer_load_dwordx4 v5, s[12:15], s60 offen offset:3072 nt lds
    v_mfma_f32_16x16x32_bf16 v[152:155], v[52:55], a[116:119], v[152:155]
    ds_read_b128 a[8:11], v22 offset:51200
    v_mfma_f32_16x16x32_bf16 v[156:159], v[48:51], a[120:123], v[156:159]
    ds_read_b64_tr_b16 v[48:49], v17 offset:32768
    ds_read_b64_tr_b16 v[50:51], v17 offset:33792
    v_mfma_f32_16x16x32_bf16 v[156:159], v[52:55], a[124:127], v[156:159]
    ds_read_b64_tr_b16 v[52:53], v17 offset:40960
    ds_read_b64_tr_b16 v[54:55], v17 offset:41984
    v_mfma_f32_16x16x32_bf16 v[160:163], v[56:59], a[64:67], v[160:163]
    v_add_u32 v17, 0x10000, v17
    v_mfma_f32_16x16x32_bf16 v[160:163], v[60:63], a[68:71], v[160:163]
    s_cmp_lt_u32 s4, 0
    s_cselect_b32 s12, 0xf149f2ca, 0
    v_mfma_f32_16x16x32_bf16 v[164:167], v[56:59], a[72:75], v[164:167]
    ds_read_b128 a[12:15], v23 offset:51200
    v_mfma_f32_16x16x32_bf16 v[164:167], v[60:63], a[76:79], v[164:167]
    s_add_u32 m0, s69, 147456
    v_mfma_f32_16x16x32_bf16 v[168:171], v[56:59], a[80:83], v[168:171]
    s_xor_b32 s60, s60, 524288
    buffer_load_dwordx4 v6, s[8:11], s62 offen lds
    v_mfma_f32_16x16x32_bf16 v[168:171], v[60:63], a[84:87], v[168:171]
    s_cmp_lt_u32 s4, 1
    s_cselect_b32 s13, 0xf149f2ca, 0
    v_mfma_f32_16x16x32_bf16 v[172:175], v[56:59], a[88:91], v[172:175]
    s_cmp_lt_u32 s4, 2
    s_cselect_b32 s14, 0xf149f2ca, 0
    v_mfma_f32_16x16x32_bf16 v[172:175], v[60:63], a[92:95], v[172:175]
    s_cmp_lt_u32 s4, 3
    s_cselect_b32 s15, 0xf149f2ca, 0
    v_mfma_f32_16x16x32_bf16 v[176:179], v[56:59], a[96:99], v[176:179]
    ds_read_b128 a[16:19], v22 offset:53248
    v_mfma_f32_16x16x32_bf16 v[176:179], v[60:63], a[100:103], v[176:179]
    v_mfma_f32_16x16x32_bf16 v[180:183], v[56:59], a[104:107], v[180:183]
    v_mfma_f32_16x16x32_bf16 v[180:183], v[60:63], a[108:111], v[180:183]
    buffer_load_dwordx4 v7, s[8:11], s62 offen offset:1024 lds
    v_mfma_f32_16x16x32_bf16 v[184:187], v[56:59], a[112:115], v[184:187]
    v_mfma_f32_16x16x32_bf16 v[184:187], v[60:63], a[116:119], v[184:187]
    ds_read_b128 a[20:23], v23 offset:53248
    v_mfma_f32_16x16x32_bf16 v[188:191], v[56:59], a[120:123], v[188:191]
    s_waitcnt lgkmcnt(1)
    ds_read_b64_tr_b16 v[56:57], v14 offset:0
    ds_read_b64_tr_b16 v[58:59], v14 offset:1024
    v_mfma_f32_16x16x32_bf16 v[188:191], v[60:63], a[124:127], v[188:191]
    ds_read_b64_tr_b16 v[60:61], v14 offset:8192
    ds_read_b64_tr_b16 v[62:63], v14 offset:9216
    v_mfma_f32_16x16x32_bf16 v[192:195], v[40:43], a[64:67], v[192:195]
    v_mfma_f32_16x16x32_bf16 v[192:195], v[44:47], a[68:71], v[192:195]
    v_mfma_f32_16x16x32_bf16 v[196:199], v[40:43], a[72:75], v[196:199]
    v_mfma_f32_16x16x32_bf16 v[196:199], v[44:47], a[76:79], v[196:199]
    buffer_load_dwordx4 v8, s[8:11], s62 offen offset:2048 lds
    v_mfma_f32_16x16x32_bf16 v[200:203], v[40:43], a[80:83], v[200:203]
    ds_read_b128 a[24:27], v22 offset:55296
    v_bfe_u32 v8, v1, 4, 3
    v_mfma_f32_16x16x32_bf16 v[200:203], v[44:47], a[84:87], v[200:203]
    v_lshlrev_b32 v8, 12, v8
    v_mfma_f32_16x16x32_bf16 v[204:207], v[40:43], a[88:91], v[204:207]
    v_mfma_f32_16x16x32_bf16 v[204:207], v[44:47], a[92:95], v[204:207]
    v_mfma_f32_16x16x32_bf16 v[208:211], v[40:43], a[96:99], v[208:211]
    ds_read_b128 a[28:31], v23 offset:55296
    v_mfma_f32_16x16x32_bf16 v[208:211], v[44:47], a[100:103], v[208:211]
    v_mfma_f32_16x16x32_bf16 v[212:215], v[40:43], a[104:107], v[212:215]
    buffer_load_dwordx4 v9, s[8:11], s62 offen offset:3072 lds
    v_mfma_f32_16x16x32_bf16 v[212:215], v[44:47], a[108:111], v[212:215]
    s_and_b32 s8, s5, 7
    v_lshrrev_b32 v9, 2, v1
    v_mfma_f32_16x16x32_bf16 v[216:219], v[40:43], a[112:115], v[216:219]
    s_lshl3_add_u32 s8, s6, s8
    v_mfma_f32_16x16x32_bf16 v[216:219], v[44:47], a[116:119], v[216:219]
    s_and_b32 s9, s5, 24
    v_mfma_f32_16x16x32_bf16 v[220:223], v[40:43], a[120:123], v[220:223]
    s_mul_i32 s10, s9, 18
    ds_read_b64_tr_b16 v[40:41], v15 offset:0
    ds_read_b64_tr_b16 v[42:43], v15 offset:1024
    v_mfma_f32_16x16x32_bf16 v[220:223], v[44:47], a[124:127], v[220:223]
    s_add_u32 s10, s10, 16
    ds_read_b64_tr_b16 v[44:45], v15 offset:8192
    ds_read_b64_tr_b16 v[46:47], v15 offset:9216
    v_mfma_f32_16x16x32_bf16 v[224:227], v[48:51], a[64:67], v[224:227]
    s_cmp_eq_u32 s4, 3
    s_cselect_b32 s11, 1.0, 0
    v_mfma_f32_16x16x32_bf16 v[224:227], v[52:55], a[68:71], v[224:227]
    s_xor_b32 s62, s62, 1920
    v_mfma_f32_16x16x32_bf16 v[228:231], v[48:51], a[72:75], v[228:231]
    s_andn2_b32 s62, s62, 896
    buffer_load_dword v109, v103, s[24:27], s77 offen
    v_mfma_f32_16x16x32_bf16 v[228:231], v[52:55], a[76:79], v[228:231]
    v_mfma_f32_16x16x32_bf16 v[232:235], v[48:51], a[80:83], v[232:235]
    v_mfma_f32_16x16x32_bf16 v[232:235], v[52:55], a[84:87], v[232:235]
    s_add_u32 m0, s69, 0
    v_mfma_f32_16x16x32_bf16 v[236:239], v[48:51], a[88:91], v[236:239]
    buffer_load_dwordx4 v2, s[16:19], s60 offen nt lds
    v_mfma_f32_16x16x32_bf16 v[236:239], v[52:55], a[92:95], v[236:239]
    v_mfma_f32_16x16x32_bf16 v[240:243], v[48:51], a[96:99], v[240:243]
    v_mfma_f32_16x16x32_bf16 v[240:243], v[52:55], a[100:103], v[240:243]
    v_mfma_f32_16x16x32_bf16 v[244:247], v[48:51], a[104:107], v[244:247]
    v_mfma_f32_16x16x32_bf16 v[244:247], v[52:55], a[108:111], v[244:247]
    v_mfma_f32_16x16x32_bf16 v[248:251], v[48:51], a[112:115], v[248:251]
    v_mfma_f32_16x16x32_bf16 v[248:251], v[52:55], a[116:119], v[248:251]
    buffer_load_dwordx4 v3, s[16:19], s60 offen offset:1024 nt lds
    v_mfma_f32_16x16x32_bf16 v[252:255], v[48:51], a[120:123], v[252:255]
    ds_read_b64_tr_b16 v[48:49], v16 offset:0
    ds_read_b64_tr_b16 v[50:51], v16 offset:1024
    v_mfma_f32_16x16x32_bf16 v[252:255], v[52:55], a[124:127], v[252:255]
    s_waitcnt lgkmcnt(2)
    ds_read_b64_tr_b16 v[52:53], v16 offset:8192
    ds_read_b64_tr_b16 v[54:55], v16 offset:9216
    v_mfma_f32_16x16x32_bf16 a[128:131], a[64:67], v[56:59], a[128:131]
    v_mfma_f32_16x16x32_bf16 a[128:131], a[68:71], v[60:63], a[128:131]
    v_add_u32 v22, 0x10000, v22
    v_mfma_f32_16x16x32_bf16 a[132:135], a[72:75], v[56:59], a[132:135]
    ds_read_b128 a[32:35], v22 offset:16384
    v_mfma_f32_16x16x32_bf16 a[132:135], a[76:79], v[60:63], a[132:135]
    v_mfma_f32_16x16x32_bf16 a[136:139], a[80:83], v[56:59], a[136:139]
    v_mfma_f32_16x16x32_bf16 a[136:139], a[84:87], v[60:63], a[136:139]
    buffer_load_dwordx4 v4, s[16:19], s60 offen offset:2048 nt lds
    v_mfma_f32_16x16x32_bf16 a[140:143], a[88:91], v[56:59], a[140:143]
    v_add_u32 v23, 0x10000, v23
    v_mfma_f32_16x16x32_bf16 a[140:143], a[92:95], v[60:63], a[140:143]
    ds_read_b128 a[36:39], v23 offset:16384
    v_mfma_f32_16x16x32_bf16 a[144:147], a[96:99], v[56:59], a[144:147]
    v_mfma_f32_16x16x32_bf16 a[144:147], a[100:103], v[60:63], a[144:147]
    v_mfma_f32_16x16x32_bf16 a[148:151], a[104:107], v[56:59], a[148:151]
    v_mfma_f32_16x16x32_bf16 a[148:151], a[108:111], v[60:63], a[148:151]
    v_mfma_f32_16x16x32_bf16 a[152:155], a[112:115], v[56:59], a[152:155]
    buffer_load_dwordx4 v5, s[16:19], s60 offen offset:3072 nt lds
    v_mfma_f32_16x16x32_bf16 a[152:155], a[116:119], v[60:63], a[152:155]
    ds_read_b128 a[40:43], v22 offset:18432
    v_mfma_f32_16x16x32_bf16 a[156:159], a[120:123], v[56:59], a[156:159]
    ds_read_b64_tr_b16 v[56:57], v17 offset:0
    ds_read_b64_tr_b16 v[58:59], v17 offset:1024
    v_mfma_f32_16x16x32_bf16 a[156:159], a[124:127], v[60:63], a[156:159]
    ds_read_b64_tr_b16 v[60:61], v17 offset:8192
    ds_read_b64_tr_b16 v[62:63], v17 offset:9216
    v_mfma_f32_16x16x32_bf16 a[160:163], a[64:67], v[40:43], a[160:163]
    v_mfma_f32_16x16x32_bf16 a[160:163], a[68:71], v[44:47], a[160:163]
    v_mfma_f32_16x16x32_bf16 a[164:167], a[72:75], v[40:43], a[164:167]
    ds_read_b128 a[44:47], v23 offset:18432
    v_mfma_f32_16x16x32_bf16 a[164:167], a[76:79], v[44:47], a[164:167]
    s_add_u32 m0, s69, 16384
    v_mfma_f32_16x16x32_bf16 a[168:171], a[80:83], v[40:43], a[168:171]
    s_xor_b32 s60, s60, 524288
    buffer_load_dwordx4 v10, s[20:23], s63 offen lds
    v_mfma_f32_16x16x32_bf16 a[168:171], a[84:87], v[44:47], a[168:171]
    v_mfma_f32_16x16x32_bf16 a[172:175], a[88:91], v[40:43], a[172:175]
    v_mfma_f32_16x16x32_bf16 a[172:175], a[92:95], v[44:47], a[172:175]
    v_mfma_f32_16x16x32_bf16 a[176:179], a[96:99], v[40:43], a[176:179]
    ds_read_b128 a[48:51], v22 offset:20480
    v_mfma_f32_16x16x32_bf16 a[176:179], a[100:103], v[44:47], a[176:179]
    v_mfma_f32_16x16x32_bf16 a[180:183], a[104:107], v[40:43], a[180:183]
    v_mfma_f32_16x16x32_bf16 a[180:183], a[108:111], v[44:47], a[180:183]
    buffer_load_dwordx4 v11, s[20:23], s63 offen offset:1024 lds
    v_mfma_f32_16x16x32_bf16 a[184:187], a[112:115], v[40:43], a[184:187]
    v_mfma_f32_16x16x32_bf16 a[184:187], a[116:119], v[44:47], a[184:187]
    ds_read_b128 a[52:55], v23 offset:20480
    v_mfma_f32_16x16x32_bf16 a[188:191], a[120:123], v[40:43], a[188:191]
    v_mfma_f32_16x16x32_bf16 a[188:191], a[124:127], v[44:47], a[188:191]
    s_waitcnt lgkmcnt(1)
    v_mfma_f32_16x16x32_bf16 a[192:195], a[64:67], v[48:51], a[192:195]
    v_mfma_f32_16x16x32_bf16 a[192:195], a[68:71], v[52:55], a[192:195]
    v_mfma_f32_16x16x32_bf16 a[196:199], a[72:75], v[48:51], a[196:199]
    v_mfma_f32_16x16x32_bf16 a[196:199], a[76:79], v[52:55], a[196:199]
    buffer_load_dwordx4 v12, s[20:23], s63 offen offset:2048 lds
    v_mfma_f32_16x16x32_bf16 a[200:203], a[80:83], v[48:51], a[200:203]
    ds_read_b128 a[56:59], v22 offset:22528
    v_mfma_f32_16x16x32_bf16 a[200:203], a[84:87], v[52:55], a[200:203]
    v_mfma_f32_16x16x32_bf16 a[204:207], a[88:91], v[48:51], a[204:207]
    v_mfma_f32_16x16x32_bf16 a[204:207], a[92:95], v[52:55], a[204:207]
    v_mfma_f32_16x16x32_bf16 a[208:211], a[96:99], v[48:51], a[208:211]
    ds_read_b128 a[60:63], v23 offset:22528
    v_mfma_f32_16x16x32_bf16 a[208:211], a[100:103], v[52:55], a[208:211]
    v_mfma_f32_16x16x32_bf16 a[212:215], a[104:107], v[48:51], a[212:215]
    buffer_load_dwordx4 v13, s[20:23], s63 offen offset:3072 lds
    v_mfma_f32_16x16x32_bf16 a[212:215], a[108:111], v[52:55], a[212:215]
    v_mfma_f32_16x16x32_bf16 a[216:219], a[112:115], v[48:51], a[216:219]
    v_mfma_f32_16x16x32_bf16 a[216:219], a[116:119], v[52:55], a[216:219]
    v_mfma_f32_16x16x32_bf16 a[220:223], a[120:123], v[48:51], a[220:223]
    v_mfma_f32_16x16x32_bf16 a[220:223], a[124:127], v[52:55], a[220:223]
    v_mfma_f32_16x16x32_bf16 a[224:227], a[64:67], v[56:59], a[224:227]
    v_mfma_f32_16x16x32_bf16 a[224:227], a[68:71], v[60:63], a[224:227]
    s_xor_b32 s63, s63, 128
    v_mfma_f32_16x16x32_bf16 a[228:231], a[72:75], v[56:59], a[228:231]
    v_mfma_f32_16x16x32_bf16 a[228:231], a[76:79], v[60:63], a[228:231]
    v_mfma_f32_16x16x32_bf16 a[232:235], a[80:83], v[56:59], a[232:235]
    v_mfma_f32_16x16x32_bf16 a[232:235], a[84:87], v[60:63], a[232:235]
    s_waitcnt vmcnt(9) lgkmcnt(0)
    s_barrier
    ds_read_b64_tr_b16 v[40:41], v14 offset:32768
    v_mfma_f32_16x16x32_bf16 a[236:239], a[88:91], v[56:59], a[236:239]
    s_add_u32 m0, s69, 32768
    ds_read_b64_tr_b16 v[42:43], v14 offset:33792
    ds_read_b64_tr_b16 v[44:45], v14 offset:40960
    v_mfma_f32_16x16x32_bf16 a[236:239], a[92:95], v[60:63], a[236:239]
    buffer_load_dwordx4 v2, s[16:19], s60 offen nt lds
    v_mfma_f32_16x16x32_bf16 a[240:243], a[96:99], v[56:59], a[240:243]
    ds_read_b64_tr_b16 v[46:47], v14 offset:41984
    ds_read_b64_tr_b16 v[48:49], v15 offset:32768
    v_mfma_f32_16x16x32_bf16 a[240:243], a[100:103], v[60:63], a[240:243]
    ds_read_b64_tr_b16 v[50:51], v15 offset:33792
    ds_read_b64_tr_b16 v[52:53], v15 offset:40960
    v_mfma_f32_16x16x32_bf16 a[244:247], a[104:107], v[56:59], a[244:247]
    ds_read_b64_tr_b16 v[54:55], v15 offset:41984
    v_add_u32 v14, 0x10000, v14
    v_mfma_f32_16x16x32_bf16 a[244:247], a[108:111], v[60:63], a[244:247]
    v_add_u32 v15, 0x10000, v15
    v_mfma_f32_16x16x32_bf16 a[248:251], a[112:115], v[56:59], a[248:251]
    v_mfma_f32_16x16x32_bf16 a[248:251], a[116:119], v[60:63], a[248:251]
    buffer_load_dwordx4 v3, s[16:19], s60 offen offset:1024 nt lds
    v_mfma_f32_16x16x32_bf16 a[252:255], a[120:123], v[56:59], a[252:255]
    ds_read_b64_tr_b16 v[56:57], v16 offset:32768
    ds_read_b64_tr_b16 v[58:59], v16 offset:33792
    v_mfma_f32_16x16x32_bf16 a[252:255], a[124:127], v[60:63], a[252:255]
    s_waitcnt lgkmcnt(2)
    ds_read_b64_tr_b16 v[60:61], v16 offset:40960
    ds_read_b64_tr_b16 v[62:63], v16 offset:41984
    v_mfma_f32_16x16x32_bf16 v[128:131], v[40:43], a[0:3], v[128:131]
    v_add_u32 v16, 0x10000, v16
    v_mfma_f32_16x16x32_bf16 v[128:131], v[44:47], a[4:7], v[128:131]
    ds_read_b128 a[64:67], v22 offset:49152
    v_mfma_f32_16x16x32_bf16 v[132:135], v[40:43], a[8:11], v[132:135]
    v_mfma_f32_16x16x32_bf16 v[132:135], v[44:47], a[12:15], v[132:135]
    v_mfma_f32_16x16x32_bf16 v[136:139], v[40:43], a[16:19], v[136:139]
    ds_read_b128 a[68:71], v23 offset:49152
    v_mfma_f32_16x16x32_bf16 v[136:139], v[44:47], a[20:23], v[136:139]
    buffer_load_dwordx4 v4, s[16:19], s60 offen offset:2048 nt lds
    v_mfma_f32_16x16x32_bf16 v[140:143], v[40:43], a[24:27], v[140:143]
    v_mfma_f32_16x16x32_bf16 v[140:143], v[44:47], a[28:31], v[140:143]
    ds_read_b128 a[72:75], v22 offset:51200
    v_mfma_f32_16x16x32_bf16 v[144:147], v[40:43], a[32:35], v[144:147]
    v_mfma_f32_16x16x32_bf16 v[144:147], v[44:47], a[36:39], v[144:147]
    v_mfma_f32_16x16x32_bf16 v[148:151], v[40:43], a[40:43], v[148:151]
    ds_read_b128 a[76:79], v23 offset:51200
    v_mfma_f32_16x16x32_bf16 v[148:151], v[44:47], a[44:47], v[148:151]
    v_mfma_f32_16x16x32_bf16 v[152:155], v[40:43], a[48:51], v[152:155]
    buffer_load_dwordx4 v5, s[16:19], s60 offen offset:3072 nt lds
    v_mfma_f32_16x16x32_bf16 v[152:155], v[44:47], a[52:55], v[152:155]
    v_mfma_f32_16x16x32_bf16 v[156:159], v[40:43], a[56:59], v[156:159]
    ds_read_b128 a[80:83], v22 offset:53248
    ds_read_b64_tr_b16 v[40:41], v17 offset:32768
    v_mfma_f32_16x16x32_bf16 v[156:159], v[44:47], a[60:63], v[156:159]
    ds_read_b64_tr_b16 v[42:43], v17 offset:33792
    ds_read_b64_tr_b16 v[44:45], v17 offset:40960
    v_mfma_f32_16x16x32_bf16 v[160:163], v[48:51], a[0:3], v[160:163]
    ds_read_b64_tr_b16 v[46:47], v17 offset:41984
    v_add_u32 v17, 0x10000, v17
    v_mfma_f32_16x16x32_bf16 v[160:163], v[52:55], a[4:7], v[160:163]
    ds_read_b128 a[84:87], v23 offset:53248
    v_mfma_f32_16x16x32_bf16 v[164:167], v[48:51], a[8:11], v[164:167]
    v_mfma_f32_16x16x32_bf16 v[164:167], v[52:55], a[12:15], v[164:167]
    s_add_u32 m0, s69, 49152
    buffer_load_dword v7, v9, s[44:47], s69 offen sc1
    v_mfma_f32_16x16x32_bf16 v[168:171], v[48:51], a[16:19], v[168:171]
    s_xor_b32 s60, s60, 3670016
    buffer_load_dwordx4 v10, s[20:23], s64 offen lds
    v_mfma_f32_16x16x32_bf16 v[168:171], v[52:55], a[20:23], v[168:171]
    ds_read_b128 a[88:91], v22 offset:55296
    v_mfma_f32_16x16x32_bf16 v[172:175], v[48:51], a[24:27], v[172:175]
    v_mfma_f32_16x16x32_bf16 v[172:175], v[52:55], a[28:31], v[172:175]
    s_waitcnt lgkmcnt(1)
    ds_read_b128 a[92:95], v23 offset:55296
    v_mfma_f32_16x16x32_bf16 v[176:179], v[48:51], a[32:35], v[176:179]
    v_mfma_f32_16x16x32_bf16 v[176:179], v[52:55], a[36:39], v[176:179]
    v_mfma_f32_16x16x32_bf16 v[180:183], v[48:51], a[40:43], v[180:183]
    v_mfma_f32_16x16x32_bf16 v[180:183], v[52:55], a[44:47], v[180:183]
    buffer_load_dwordx4 v11, s[20:23], s64 offen offset:1024 lds
    v_mfma_f32_16x16x32_bf16 v[184:187], v[48:51], a[48:51], v[184:187]
    v_add_u32 v22, 0x10000, v22
    ds_read_b128 a[96:99], v22 offset:16384
    v_mfma_f32_16x16x32_bf16 v[184:187], v[52:55], a[52:55], v[184:187]
    v_mfma_f32_16x16x32_bf16 v[188:191], v[48:51], a[56:59], v[188:191]
    v_add_u32 v23, 0x10000, v23
    ds_read_b64_tr_b16 v[48:49], v14 offset:0
    v_mfma_f32_16x16x32_bf16 v[188:191], v[52:55], a[60:63], v[188:191]
    ds_read_b128 a[100:103], v23 offset:16384
    ds_read_b64_tr_b16 v[50:51], v14 offset:1024
    v_mfma_f32_16x16x32_bf16 v[192:195], v[56:59], a[0:3], v[192:195]
    ds_read_b64_tr_b16 v[52:53], v14 offset:8192
    ds_read_b64_tr_b16 v[54:55], v14 offset:9216
    v_mfma_f32_16x16x32_bf16 v[192:195], v[60:63], a[4:7], v[192:195]
    v_add_u32 v14, 0xfffe0000, v14
    v_mfma_f32_16x16x32_bf16 v[196:199], v[56:59], a[8:11], v[196:199]
    ds_read_b128 a[104:107], v22 offset:18432
    v_mfma_f32_16x16x32_bf16 v[196:199], v[60:63], a[12:15], v[196:199]
    buffer_load_dwordx4 v12, s[20:23], s64 offen offset:2048 lds
    v_mfma_f32_16x16x32_bf16 v[200:203], v[56:59], a[16:19], v[200:203]
    v_mfma_f32_16x16x32_bf16 v[200:203], v[60:63], a[20:23], v[200:203]
    ds_read_b128 a[108:111], v23 offset:18432
    v_mfma_f32_16x16x32_bf16 v[204:207], v[56:59], a[24:27], v[204:207]
    v_mfma_f32_16x16x32_bf16 v[204:207], v[60:63], a[28:31], v[204:207]
    v_mfma_f32_16x16x32_bf16 v[208:211], v[56:59], a[32:35], v[208:211]
    v_mfma_f32_16x16x32_bf16 v[208:211], v[60:63], a[36:39], v[208:211]
    ds_read_b128 a[112:115], v22 offset:20480
    v_mfma_f32_16x16x32_bf16 v[212:215], v[56:59], a[40:43], v[212:215]
    buffer_load_dwordx4 v13, s[20:23], s64 offen offset:3072 lds
    v_mfma_f32_16x16x32_bf16 v[212:215], v[60:63], a[44:47], v[212:215]
    v_mfma_f32_16x16x32_bf16 v[216:219], v[56:59], a[48:51], v[216:219]
    ds_read_b128 a[116:119], v23 offset:20480
    v_mfma_f32_16x16x32_bf16 v[216:219], v[60:63], a[52:55], v[216:219]
    v_mfma_f32_16x16x32_bf16 v[220:223], v[56:59], a[56:59], v[220:223]
    ds_read_b64_tr_b16 v[56:57], v15 offset:0
    ds_read_b64_tr_b16 v[58:59], v15 offset:1024
    v_mfma_f32_16x16x32_bf16 v[220:223], v[60:63], a[60:63], v[220:223]
    s_waitcnt lgkmcnt(3)
    ds_read_b128 a[120:123], v22 offset:22528
    ds_read_b64_tr_b16 v[60:61], v15 offset:8192
    v_mfma_f32_16x16x32_bf16 v[224:227], v[40:43], a[0:3], v[224:227]
    ds_read_b64_tr_b16 v[62:63], v15 offset:9216
    v_add_u32 v15, 0xfffe0000, v15
    v_mfma_f32_16x16x32_bf16 v[224:227], v[44:47], a[4:7], v[224:227]
    s_xor_b32 s64, s64, 128
    v_mfma_f32_16x16x32_bf16 v[228:231], v[40:43], a[8:11], v[228:231]
    ds_read_b128 a[124:127], v23 offset:22528
    v_mfma_f32_16x16x32_bf16 v[228:231], v[44:47], a[12:15], v[228:231]
    v_mfma_f32_16x16x32_bf16 v[232:235], v[40:43], a[16:19], v[232:235]
    v_mfma_f32_16x16x32_bf16 v[232:235], v[44:47], a[20:23], v[232:235]
    s_add_u32 m0, s69, 65536
    v_mfma_f32_16x16x32_bf16 v[236:239], v[40:43], a[24:27], v[236:239]
    buffer_load_dwordx4 v2, s[24:27], s60 offen lds
    v_mfma_f32_16x16x32_bf16 v[236:239], v[44:47], a[28:31], v[236:239]
    v_mfma_f32_16x16x32_bf16 v[240:243], v[40:43], a[32:35], v[240:243]
    v_mfma_f32_16x16x32_bf16 v[240:243], v[44:47], a[36:39], v[240:243]
    v_mfma_f32_16x16x32_bf16 v[244:247], v[40:43], a[40:43], v[244:247]
    v_mfma_f32_16x16x32_bf16 v[244:247], v[44:47], a[44:47], v[244:247]
    v_mfma_f32_16x16x32_bf16 v[248:251], v[40:43], a[48:51], v[248:251]
    v_mfma_f32_16x16x32_bf16 v[248:251], v[44:47], a[52:55], v[248:251]
    buffer_load_dwordx4 v3, s[24:27], s60 offen offset:1024 lds
    v_mfma_f32_16x16x32_bf16 v[252:255], v[40:43], a[56:59], v[252:255]
    ds_read_b64_tr_b16 v[40:41], v16 offset:0
    ds_read_b64_tr_b16 v[42:43], v16 offset:1024
    v_mfma_f32_16x16x32_bf16 v[252:255], v[44:47], a[60:63], v[252:255]
    ds_read_b64_tr_b16 v[44:45], v16 offset:8192
    ds_read_b64_tr_b16 v[46:47], v16 offset:9216
    v_mfma_f32_16x16x32_bf16 v[128:131], v[48:51], a[64:67], v[128:131]
    v_add_u32 v16, 0xfffe0000, v16
    v_mfma_f32_16x16x32_bf16 v[128:131], v[52:55], a[68:71], v[128:131]
    v_mfma_f32_16x16x32_bf16 v[132:135], v[48:51], a[72:75], v[132:135]
    v_mfma_f32_16x16x32_bf16 v[132:135], v[52:55], a[76:79], v[132:135]
    v_mfma_f32_16x16x32_bf16 v[136:139], v[48:51], a[80:83], v[136:139]
    v_mfma_f32_16x16x32_bf16 v[136:139], v[52:55], a[84:87], v[136:139]
    buffer_load_dwordx4 v4, s[24:27], s60 offen offset:2048 lds
    v_mfma_f32_16x16x32_bf16 v[140:143], v[48:51], a[88:91], v[140:143]
    v_mfma_f32_16x16x32_bf16 v[140:143], v[52:55], a[92:95], v[140:143]
    v_mfma_f32_16x16x32_bf16 v[144:147], v[48:51], a[96:99], v[144:147]
    v_mul_f32 v128, s74, v128
    v_mul_f32 v129, s74, v129
    v_mfma_f32_16x16x32_bf16 v[144:147], v[52:55], a[100:103], v[144:147]
    v_mul_f32 v130, s74, v130
    v_mul_f32 v131, s74, v131
    v_mfma_f32_16x16x32_bf16 v[148:151], v[48:51], a[104:107], v[148:151]
    v_cvt_pk_bf16_f32 v128, v128, v129
    v_cvt_pk_bf16_f32 v129, v130, v131
    v_mfma_f32_16x16x32_bf16 v[148:151], v[52:55], a[108:111], v[148:151]
    v_mul_f32 v132, s74, v132
    v_mul_f32 v133, s74, v133
    v_mfma_f32_16x16x32_bf16 v[152:155], v[48:51], a[112:115], v[152:155]
    s_waitcnt lgkmcnt(0)
    buffer_load_dwordx4 v5, s[24:27], s60 offen offset:3072 lds
    v_mfma_f32_16x16x32_bf16 v[152:155], v[52:55], a[116:119], v[152:155]
    v_mul_f32 v134, s74, v134
    v_mul_f32 v135, s74, v135
    v_mfma_f32_16x16x32_bf16 v[156:159], v[48:51], a[120:123], v[156:159]
    ds_read_b64_tr_b16 v[48:49], v17 offset:0
    ds_read_b64_tr_b16 v[50:51], v17 offset:1024
    v_mfma_f32_16x16x32_bf16 v[156:159], v[52:55], a[124:127], v[156:159]
    ds_read_b64_tr_b16 v[52:53], v17 offset:8192
    ds_read_b64_tr_b16 v[54:55], v17 offset:9216
    v_mfma_f32_16x16x32_bf16 v[160:163], v[56:59], a[64:67], v[160:163]
    v_add_u32 v17, 0xfffe0000, v17
    v_cvt_pk_bf16_f32 v132, v132, v133
    v_mfma_f32_16x16x32_bf16 v[160:163], v[60:63], a[68:71], v[160:163]
    v_cvt_pk_bf16_f32 v133, v134, v135
    v_mul_f32 v136, s74, v136
    v_mfma_f32_16x16x32_bf16 v[164:167], v[56:59], a[72:75], v[164:167]
    v_mul_f32 v137, s74, v137
    v_mul_f32 v138, s74, v138
    v_mfma_f32_16x16x32_bf16 v[164:167], v[60:63], a[76:79], v[164:167]
    s_add_u32 m0, s69, 81920
    v_mul_f32 v139, s74, v139
    v_mul_f32 v160, s74, v160
    v_mfma_f32_16x16x32_bf16 v[168:171], v[56:59], a[80:83], v[168:171]
    s_xor_b32 s60, s60, 524288
    buffer_load_dwordx4 v10, s[20:23], s63 offen lds
    v_mfma_f32_16x16x32_bf16 v[168:171], v[60:63], a[84:87], v[168:171]
    v_mul_f32 v161, s74, v161
    v_mul_f32 v162, s74, v162
    v_mfma_f32_16x16x32_bf16 v[172:175], v[56:59], a[88:91], v[172:175]
    v_mul_f32 v163, s74, v163
    v_cvt_pk_bf16_f32 v130, v160, v161
    v_mfma_f32_16x16x32_bf16 v[172:175], v[60:63], a[92:95], v[172:175]
    v_cvt_pk_bf16_f32 v131, v162, v163
    v_mul_f32 v164, s74, v164
    v_mfma_f32_16x16x32_bf16 v[176:179], v[56:59], a[96:99], v[176:179]
    v_mul_f32 v165, s74, v165
    v_mul_f32 v166, s74, v166
    v_mfma_f32_16x16x32_bf16 v[176:179], v[60:63], a[100:103], v[176:179]
    v_mul_f32 v167, s74, v167
    v_cvt_pk_bf16_f32 v134, v164, v165
    v_mfma_f32_16x16x32_bf16 v[180:183], v[56:59], a[104:107], v[180:183]
    v_cvt_pk_bf16_f32 v135, v166, v167
    v_mul_f32 v168, s74, v168
    v_mfma_f32_16x16x32_bf16 v[180:183], v[60:63], a[108:111], v[180:183]
    buffer_load_dwordx4 v11, s[20:23], s63 offen offset:1024 lds
    v_mfma_f32_16x16x32_bf16 v[184:187], v[56:59], a[112:115], v[184:187]
    v_mul_f32 v169, s74, v169
    v_mul_f32 v170, s74, v170
    v_mfma_f32_16x16x32_bf16 v[184:187], v[60:63], a[116:119], v[184:187]
    v_mul_f32 v171, s74, v171
    v_cvt_pk_bf16_f32 v136, v136, v137
    v_mfma_f32_16x16x32_bf16 v[188:191], v[56:59], a[120:123], v[188:191]
    v_cvt_pk_bf16_f32 v137, v138, v139
    v_cvt_pk_bf16_f32 v138, v168, v169
    v_mfma_f32_16x16x32_bf16 v[188:191], v[60:63], a[124:127], v[188:191]
    v_cvt_pk_bf16_f32 v139, v170, v171
    v_mul_f32 v140, s74, v140
    v_mfma_f32_16x16x32_bf16 v[192:195], v[40:43], a[64:67], v[192:195]
    v_mul_f32 v141, s74, v141
    v_mul_f32 v142, s74, v142
    v_mfma_f32_16x16x32_bf16 v[192:195], v[44:47], a[68:71], v[192:195]
    v_mul_f32 v143, s74, v143
    v_mul_f32 v172, s74, v172
    v_mfma_f32_16x16x32_bf16 v[196:199], v[40:43], a[72:75], v[196:199]
    v_mul_f32 v173, s74, v173
    v_mul_f32 v174, s74, v174
    v_mfma_f32_16x16x32_bf16 v[196:199], v[44:47], a[76:79], v[196:199]
    buffer_load_dwordx4 v12, s[20:23], s63 offen offset:2048 lds
    v_mfma_f32_16x16x32_bf16 v[200:203], v[40:43], a[80:83], v[200:203]
    v_mul_f32 v175, s74, v175
    v_cvt_pk_bf16_f32 v140, v140, v141
    v_mfma_f32_16x16x32_bf16 v[200:203], v[44:47], a[84:87], v[200:203]
    v_cvt_pk_bf16_f32 v141, v142, v143
    v_cvt_pk_bf16_f32 v142, v172, v173
    v_mfma_f32_16x16x32_bf16 v[204:207], v[40:43], a[88:91], v[204:207]
    v_cvt_pk_bf16_f32 v143, v174, v175
    v_mul_f32 v144, s74, v144
    v_mfma_f32_16x16x32_bf16 v[204:207], v[44:47], a[92:95], v[204:207]
    v_mul_f32 v145, s74, v145
    v_mul_f32 v146, s74, v146
    v_mfma_f32_16x16x32_bf16 v[208:211], v[40:43], a[96:99], v[208:211]
    v_mul_f32 v147, s74, v147
    v_mul_f32 v176, s74, v176
    v_mfma_f32_16x16x32_bf16 v[208:211], v[44:47], a[100:103], v[208:211]
    v_mul_f32 v177, s74, v177
    v_mul_f32 v178, s74, v178
    v_mfma_f32_16x16x32_bf16 v[212:215], v[40:43], a[104:107], v[212:215]
    buffer_load_dwordx4 v13, s[20:23], s63 offen offset:3072 lds
    v_mfma_f32_16x16x32_bf16 v[212:215], v[44:47], a[108:111], v[212:215]
    v_mul_f32 v179, s74, v179
    v_cvt_pk_bf16_f32 v144, v144, v145
    v_mfma_f32_16x16x32_bf16 v[216:219], v[40:43], a[112:115], v[216:219]
    v_cvt_pk_bf16_f32 v145, v146, v147
    v_cvt_pk_bf16_f32 v146, v176, v177
    v_mfma_f32_16x16x32_bf16 v[216:219], v[44:47], a[116:119], v[216:219]
    v_cvt_pk_bf16_f32 v147, v178, v179
    v_mul_f32 v148, s74, v148
    v_mfma_f32_16x16x32_bf16 v[220:223], v[40:43], a[120:123], v[220:223]
    v_mul_f32 v149, s74, v149
    v_mul_f32 v150, s74, v150
    v_mfma_f32_16x16x32_bf16 v[220:223], v[44:47], a[124:127], v[220:223]
    s_add_u32 s72, s70, 0
    v_mul_f32 v151, s74, v151
    v_mul_f32 v180, s74, v180
    s_waitcnt lgkmcnt(0)
    v_mfma_f32_16x16x32_bf16 v[224:227], v[48:51], a[64:67], v[224:227]
    buffer_store_dwordx4 v[128:131], v1, s[36:39], s72 offen sc1
    v_mfma_f32_16x16x32_bf16 v[224:227], v[52:55], a[68:71], v[224:227]
    s_xor_b32 s63, s63, 384
    v_mul_f32 v181, s74, v181
    v_mul_f32 v182, s74, v182
    v_mfma_f32_16x16x32_bf16 v[228:231], v[48:51], a[72:75], v[228:231]
    v_mul_f32 v183, s74, v183
    v_cvt_pk_bf16_f32 v148, v148, v149
    v_mfma_f32_16x16x32_bf16 v[228:231], v[52:55], a[76:79], v[228:231]
    v_cvt_pk_bf16_f32 v149, v150, v151
    v_cvt_pk_bf16_f32 v150, v180, v181
    v_mfma_f32_16x16x32_bf16 v[232:235], v[48:51], a[80:83], v[232:235]
    v_cvt_pk_bf16_f32 v151, v182, v183
    v_mul_f32 v152, s74, v152
    v_mfma_f32_16x16x32_bf16 v[232:235], v[52:55], a[84:87], v[232:235]
    s_add_u32 m0, s67, 98304
    v_mul_f32 v153, s74, v153
    v_mul_f32 v154, s74, v154
    s_waitcnt vmcnt(9) lgkmcnt(0)
    v_cmp_gt_u32 vcc, 8, v7
    s_nop 1
    s_and_b64 vcc, vcc, s[86:87]
    s_cbranch_scc1 SPIN_WA
BACK_WA:
    s_barrier
    v_mfma_f32_16x16x32_bf16 v[236:239], v[48:51], a[88:91], v[236:239]
    buffer_load_dwordx4 v1, s[28:31], s65 offen sc1 lds
    v_mfma_f32_16x16x32_bf16 v[236:239], v[52:55], a[92:95], v[236:239]
    ds_read_b64_tr_b16 v[56:57], v14 offset:0
    ds_read_b64_tr_b16 v[58:59], v14 offset:1024
    v_mfma_f32_16x16x32_bf16 v[240:243], v[48:51], a[96:99], v[240:243]
    ds_read_b64_tr_b16 v[60:61], v14 offset:8192
    ds_read_b64_tr_b16 v[62:63], v14 offset:9216
    v_mfma_f32_16x16x32_bf16 v[240:243], v[52:55], a[100:103], v[240:243]
    ds_read_b64_tr_b16 v[40:41], v15 offset:0
    ds_read_b64_tr_b16 v[42:43], v15 offset:1024
    v_mfma_f32_16x16x32_bf16 v[244:247], v[48:51], a[104:107], v[244:247]
    ds_read_b64_tr_b16 v[44:45], v15 offset:8192
    ds_read_b64_tr_b16 v[46:47], v15 offset:9216
    v_mfma_f32_16x16x32_bf16 v[244:247], v[52:55], a[108:111], v[244:247]
    v_mul_f32 v155, s74, v155
    v_mul_f32 v184, s74, v184
    v_mfma_f32_16x16x32_bf16 v[248:251], v[48:51], a[112:115], v[248:251]
    v_mul_f32 v185, s74, v185
    v_mul_f32 v186, s74, v186
    v_mfma_f32_16x16x32_bf16 v[248:251], v[52:55], a[116:119], v[248:251]
    v_mul_f32 v187, s74, v187
    v_cvt_pk_bf16_f32 v152, v152, v153
    v_mfma_f32_16x16x32_bf16 v[252:255], v[48:51], a[120:123], v[252:255]
    s_lshr_b32 s92, s2, 3
    v_lshrrev_b32 v9, 4, v1
    v_min_u32 v9, 0, v9
    v_mfma_f32_16x16x32_bf16 v[252:255], v[52:55], a[124:127], v[252:255]
    s_lshl2_add_u32 s92, s92, s4
    ds_read_b64_tr_b16 v[48:49], v16 offset:0
    ds_read_b64_tr_b16 v[50:51], v16 offset:1024
    s_waitcnt lgkmcnt(2)
    v_mfma_f32_16x16x32_bf16 a[128:131], a[0:3], v[56:59], a[128:131]
    s_mul_i32 s92, s92, 1
    buffer_load_dwordx4 v1, s[28:31], s65 offen offset:1024 sc1 lds
    v_mfma_f32_16x16x32_bf16 a[128:131], a[4:7], v[60:63], a[128:131]
    s_add_u32 s92, s92, 32
    v_add_lshl_u32 v9, v9, s92, 7
    ds_read_b64_tr_b16 v[52:53], v16 offset:8192
    v_mfma_f32_16x16x32_bf16 a[132:135], a[8:11], v[56:59], a[132:135]
    s_getpc_b64 s[92:93]
    global_load_dword v9, v9, s[92:93]
    v_mfma_f32_16x16x32_bf16 a[132:135], a[12:15], v[60:63], a[132:135]
    ds_read_b128 v[64:67], v24 offset:16384
    ds_read_b64_tr_b16 v[54:55], v16 offset:9216
    v_mfma_f32_16x16x32_bf16 a[136:139], a[16:19], v[56:59], a[136:139]
    v_cvt_pk_bf16_f32 v153, v154, v155
    v_cvt_pk_bf16_f32 v154, v184, v185
    v_mfma_f32_16x16x32_bf16 a[136:139], a[20:23], v[60:63], a[136:139]
    v_cvt_pk_bf16_f32 v155, v186, v187
    v_mul_f32 v156, s74, v156
    v_mfma_f32_16x16x32_bf16 a[140:143], a[24:27], v[56:59], a[140:143]
    v_mul_f32 v157, s74, v157
    v_mul_f32 v158, s74, v158
    v_mfma_f32_16x16x32_bf16 a[140:143], a[28:31], v[60:63], a[140:143]
    s_add_u32 s72, s70, 4096
    v_mul_f32 v159, s74, v159
    v_mul_f32 v188, s74, v188
    v_mfma_f32_16x16x32_bf16 a[144:147], a[32:35], v[56:59], a[144:147]
    buffer_store_dwordx4 v[132:135], v1, s[36:39], s72 offen sc1
    v_mfma_f32_16x16x32_bf16 a[144:147], a[36:39], v[60:63], a[144:147]
    s_add_u32 m0, s69, 114688
    v_mul_f32 v189, s74, v189
    v_mul_f32 v190, s74, v190
    v_mfma_f32_16x16x32_bf16 a[148:151], a[40:43], v[56:59], a[148:151]
    s_xor_b32 s65, s65, 8192
    buffer_load_dwordx4 v10, s[20:23], s64 offen lds
    v_mfma_f32_16x16x32_bf16 a[148:151], a[44:47], v[60:63], a[148:151]
    v_mul_f32 v191, s74, v191
    v_cvt_pk_bf16_f32 v156, v156, v157
    v_mfma_f32_16x16x32_bf16 a[152:155], a[48:51], v[56:59], a[152:155]
    v_cvt_pk_bf16_f32 v157, v158, v159
    v_cvt_pk_bf16_f32 v158, v188, v189
    v_mfma_f32_16x16x32_bf16 a[152:155], a[52:55], v[60:63], a[152:155]
    ds_read_b128 v[68:71], v25 offset:16384
    v_cvt_pk_bf16_f32 v159, v190, v191
    v_mfma_f32_16x16x32_bf16 a[156:159], a[56:59], v[56:59], a[156:159]
    ds_read_b64_tr_b16 v[56:57], v17 offset:0
    ds_read_b64_tr_b16 v[58:59], v17 offset:1024
    v_mfma_f32_16x16x32_bf16 a[156:159], a[60:63], v[60:63], a[156:159]
    ds_read_b64_tr_b16 v[60:61], v17 offset:8192
    ds_read_b64_tr_b16 v[62:63], v17 offset:9216
    v_mfma_f32_16x16x32_bf16 a[160:163], a[0:3], v[40:43], a[160:163]
    v_mul_f32 v192, s74, v192
    v_mul_f32 v193, s74, v193
    v_mfma_f32_16x16x32_bf16 a[160:163], a[4:7], v[44:47], a[160:163]
    v_mul_f32 v194, s74, v194
    v_mul_f32 v195, s74, v195
    v_mfma_f32_16x16x32_bf16 a[164:167], a[8:11], v[40:43], a[164:167]
    v_mul_f32 v224, s74, v224
    v_mul_f32 v225, s74, v225
    v_mfma_f32_16x16x32_bf16 a[164:167], a[12:15], v[44:47], a[164:167]
    v_mul_f32 v226, s74, v226
    v_mul_f32 v227, s74, v227
    v_mfma_f32_16x16x32_bf16 a[168:171], a[16:19], v[40:43], a[168:171]
    buffer_load_dwordx4 v11, s[20:23], s64 offen offset:1024 lds
    v_mfma_f32_16x16x32_bf16 a[168:171], a[20:23], v[44:47], a[168:171]
    v_cvt_pk_bf16_f32 v192, v192, v193
    v_cvt_pk_bf16_f32 v193, v194, v195
    v_mfma_f32_16x16x32_bf16 a[172:175], a[24:27], v[40:43], a[172:175]
    v_cvt_pk_bf16_f32 v194, v224, v225
    v_cvt_pk_bf16_f32 v195, v226, v227
    v_mfma_f32_16x16x32_bf16 a[172:175], a[28:31], v[44:47], a[172:175]
    v_mul_f32 v196, s74, v196
    v_mul_f32 v197, s74, v197
    v_mfma_f32_16x16x32_bf16 a[176:179], a[32:35], v[40:43], a[176:179]
    ds_read_b128 v[72:75], v24 offset:24576
    v_mul_f32 v198, s74, v198
    v_mfma_f32_16x16x32_bf16 a[176:179], a[36:39], v[44:47], a[176:179]
    v_mul_f32 v199, s74, v199
    v_mul_f32 v228, s74, v228
    v_mfma_f32_16x16x32_bf16 a[180:183], a[40:43], v[40:43], a[180:183]
    v_mul_f32 v229, s74, v229
    v_mul_f32 v230, s74, v230
    v_mfma_f32_16x16x32_bf16 a[180:183], a[44:47], v[44:47], a[180:183]
    v_mul_f32 v231, s74, v231
    v_cvt_pk_bf16_f32 v196, v196, v197
    v_mfma_f32_16x16x32_bf16 a[184:187], a[48:51], v[40:43], a[184:187]
    v_cvt_pk_bf16_f32 v197, v198, v199
    v_cvt_pk_bf16_f32 v198, v228, v229
    v_mfma_f32_16x16x32_bf16 a[184:187], a[52:55], v[44:47], a[184:187]
    v_cvt_pk_bf16_f32 v199, v230, v231
    v_mul_f32 v200, s74, v200
    v_mfma_f32_16x16x32_bf16 a[188:191], a[56:59], v[40:43], a[188:191]
    buffer_load_dwordx4 v12, s[20:23], s64 offen offset:2048 lds
    v_mfma_f32_16x16x32_bf16 a[188:191], a[60:63], v[44:47], a[188:191]
    s_add_u32 s72, s70, 8192
    ds_read_b64_tr_b16 v[40:41], v14 offset:32768
    ds_read_b64_tr_b16 v[42:43], v14 offset:33792
    s_waitcnt lgkmcnt(2)
    v_mfma_f32_16x16x32_bf16 a[192:195], a[0:3], v[48:51], a[192:195]
    ds_read_b64_tr_b16 v[44:45], v14 offset:40960
    ds_read_b64_tr_b16 v[46:47], v14 offset:41984
    v_mfma_f32_16x16x32_bf16 a[192:195], a[4:7], v[52:55], a[192:195]
    v_xor_b32 v14, s73, v14
    v_add_u32 v14, 0x10000, v14
    v_mfma_f32_16x16x32_bf16 a[196:199], a[8:11], v[48:51], a[196:199]
    buffer_store_dwordx4 v[136:139], v1, s[36:39], s72 offen sc1
    v_mfma_f32_16x16x32_bf16 a[196:199], a[12:15], v[52:55], a[196:199]
    ds_read_b128 v[76:79], v25 offset:24576
    v_mul_f32 v201, s74, v201
    v_mfma_f32_16x16x32_bf16 a[200:203], a[16:19], v[48:51], a[200:203]
    v_mul_f32 v202, s74, v202
    v_mul_f32 v203, s74, v203
    v_mfma_f32_16x16x32_bf16 a[200:203], a[20:23], v[52:55], a[200:203]
    v_mul_f32 v232, s74, v232
    v_mul_f32 v233, s74, v233
    v_mfma_f32_16x16x32_bf16 a[204:207], a[24:27], v[48:51], a[204:207]
    v_mul_f32 v234, s74, v234
    v_mul_f32 v235, s74, v235
    v_mfma_f32_16x16x32_bf16 a[204:207], a[28:31], v[52:55], a[204:207]
    v_cvt_pk_bf16_f32 v200, v200, v201
    v_cvt_pk_bf16_f32 v201, v202, v203
    v_mfma_f32_16x16x32_bf16 a[208:211], a[32:35], v[48:51], a[208:211]
    buffer_load_dwordx4 v13, s[20:23], s64 offen offset:3072 lds
    v_mfma_f32_16x16x32_bf16 a[208:211], a[36:39], v[52:55], a[208:211]
    v_cvt_pk_bf16_f32 v202, v232, v233
    v_cvt_pk_bf16_f32 v203, v234, v235
    v_mfma_f32_16x16x32_bf16 a[212:215], a[40:43], v[48:51], a[212:215]
    v_mul_f32 v204, s74, v204
    v_mul_f32 v205, s74, v205
    v_mfma_f32_16x16x32_bf16 a[212:215], a[44:47], v[52:55], a[212:215]
    v_mul_f32 v206, s74, v206
    v_mul_f32 v207, s74, v207
    v_mfma_f32_16x16x32_bf16 a[216:219], a[48:51], v[48:51], a[216:219]
    v_mul_f32 v236, s74, v236
    v_mul_f32 v237, s74, v237
    v_mfma_f32_16x16x32_bf16 a[216:219], a[52:55], v[52:55], a[216:219]
    v_mul_f32 v238, s74, v238
    v_mul_f32 v239, s74, v239
    v_mfma_f32_16x16x32_bf16 a[220:223], a[56:59], v[48:51], a[220:223]
    ds_read_b64_tr_b16 v[48:49], v15 offset:32768
    ds_read_b64_tr_b16 v[50:51], v15 offset:33792
    v_mfma_f32_16x16x32_bf16 a[220:223], a[60:63], v[52:55], a[220:223]
    ds_read_b64_tr_b16 v[52:53], v15 offset:40960
    ds_read_b64_tr_b16 v[54:55], v15 offset:41984
    v_mfma_f32_16x16x32_bf16 a[224:227], a[0:3], v[56:59], a[224:227]
    v_xor_b32 v15, s73, v15
    v_add_u32 v15, 0x10000, v15
    v_mfma_f32_16x16x32_bf16 a[224:227], a[4:7], v[60:63], a[224:227]
    s_xor_b32 s64, s64, 384
    v_accvgpr_write_b32 a4, v192
    v_accvgpr_write_b32 a5, v193
    v_mfma_f32_16x16x32_bf16 a[228:231], a[8:11], v[56:59], a[228:231]
    v_accvgpr_write_b32 a6, v194
    v_accvgpr_write_b32 a7, v195
    v_mfma_f32_16x16x32_bf16 a[228:231], a[12:15], v[60:63], a[228:231]
    v_accvgpr_write_b32 a12, v196
    v_accvgpr_write_b32 a13, v197
    v_mfma_f32_16x16x32_bf16 a[232:235], a[16:19], v[56:59], a[232:235]
    v_accvgpr_write_b32 a14, v198
    v_accvgpr_write_b32 a15, v199
    v_mfma_f32_16x16x32_bf16 a[232:235], a[20:23], v[60:63], a[232:235]
    s_add_u32 m0, s69, 131072
    v_accvgpr_write_b32 a20, v200
    v_accvgpr_write_b32 a21, v201
    v_mfma_f32_16x16x32_bf16 a[236:239], a[24:27], v[56:59], a[236:239]
    buffer_load_dwordx4 v2, s[24:27], s60 offen lds
    v_mfma_f32_16x16x32_bf16 a[236:239], a[28:31], v[60:63], a[236:239]
    s_add_u32 s72, s70, 12288
    v_accvgpr_write_b32 a22, v202
    v_accvgpr_write_b32 a23, v203
    v_mfma_f32_16x16x32_bf16 a[240:243], a[32:35], v[56:59], a[240:243]
    buffer_store_dwordx4 v[140:143], v1, s[36:39], s72 offen sc1
    v_mfma_f32_16x16x32_bf16 a[240:243], a[36:39], v[60:63], a[240:243]
    v_cvt_pk_bf16_f32 v204, v204, v205
    v_cvt_pk_bf16_f32 v205, v206, v207
    v_mfma_f32_16x16x32_bf16 a[244:247], a[40:43], v[56:59], a[244:247]
    v_accvgpr_write_b32 a40, v148
    v_accvgpr_write_b32 a41, v149
    v_mfma_f32_16x16x32_bf16 a[244:247], a[44:47], v[60:63], a[244:247]
    v_accvgpr_write_b32 a42, v150
    v_accvgpr_write_b32 a43, v151
    v_mfma_f32_16x16x32_bf16 a[248:251], a[48:51], v[56:59], a[248:251]
    v_accvgpr_write_b32 a48, v152
    v_accvgpr_write_b32 a49, v153
    v_mfma_f32_16x16x32_bf16 a[248:251], a[52:55], v[60:63], a[248:251]
    buffer_load_dwordx4 v3, s[24:27], s60 offen offset:1024 lds
    v_mfma_f32_16x16x32_bf16 a[252:255], a[56:59], v[56:59], a[252:255]
    ds_read_b64_tr_b16 v[56:57], v16 offset:32768
    ds_read_b64_tr_b16 v[58:59], v16 offset:33792
    v_mfma_f32_16x16x32_bf16 a[252:255], a[60:63], v[60:63], a[252:255]
    s_waitcnt lgkmcnt(2)
    ds_read_b64_tr_b16 v[60:61], v16 offset:40960
    ds_read_b64_tr_b16 v[62:63], v16 offset:41984
    v_mfma_f32_16x16x32_bf16 a[128:131], a[64:67], v[40:43], a[128:131]
    v_xor_b32 v16, s73, v16
    v_add_u32 v16, 0x10000, v16
    v_mfma_f32_16x16x32_bf16 a[128:131], a[68:71], v[44:47], a[128:131]
    v_accvgpr_write_b32 a50, v154
    v_accvgpr_write_b32 a51, v155
    v_mfma_f32_16x16x32_bf16 a[132:135], a[72:75], v[40:43], a[132:135]
    ds_read_b128 v[80:83], v24 offset:49152
    v_accvgpr_write_b32 a56, v156
    v_mfma_f32_16x16x32_bf16 a[132:135], a[76:79], v[44:47], a[132:135]
    v_accvgpr_write_b32 a57, v157
    v_accvgpr_write_b32 a58, v158
    v_mfma_f32_16x16x32_bf16 a[136:139], a[80:83], v[40:43], a[136:139]
    v_accvgpr_write_b32 a59, v159
    v_cvt_pk_bf16_f32 v206, v236, v237
    v_mfma_f32_16x16x32_bf16 a[136:139], a[84:87], v[44:47], a[136:139]
    buffer_load_dwordx4 v4, s[24:27], s60 offen offset:2048 lds
    v_mfma_f32_16x16x32_bf16 a[140:143], a[88:91], v[40:43], a[140:143]
    v_cvt_pk_bf16_f32 v207, v238, v239
    v_mul_f32 v208, s74, v208
    v_mfma_f32_16x16x32_bf16 a[140:143], a[92:95], v[44:47], a[140:143]
    v_mul_f32 v209, s74, v209
    v_mul_f32 v210, s74, v210
    v_mfma_f32_16x16x32_bf16 a[144:147], a[96:99], v[40:43], a[144:147]
    v_mul_f32 v211, s74, v211
    v_mul_f32 v240, s74, v240
    v_mfma_f32_16x16x32_bf16 a[144:147], a[100:103], v[44:47], a[144:147]
    v_mul_f32 v241, s74, v241
    v_mul_f32 v242, s74, v242
    v_mfma_f32_16x16x32_bf16 a[148:151], a[104:107], v[40:43], a[148:151]
    v_mul_f32 v243, s74, v243
    v_accvgpr_write_b32 a28, v204
    v_mfma_f32_16x16x32_bf16 a[148:151], a[108:111], v[44:47], a[148:151]
    v_accvgpr_write_b32 a29, v205
    v_accvgpr_write_b32 a30, v206
    v_mfma_f32_16x16x32_bf16 a[152:155], a[112:115], v[40:43], a[152:155]
    buffer_load_dwordx4 v5, s[24:27], s60 offen offset:3072 lds
    v_mfma_f32_16x16x32_bf16 a[152:155], a[116:119], v[44:47], a[152:155]
    ds_read_b128 v[84:87], v25 offset:49152
    v_accvgpr_write_b32 a31, v207
    v_mfma_f32_16x16x32_bf16 a[156:159], a[120:123], v[40:43], a[156:159]
    ds_read_b64_tr_b16 v[40:41], v17 offset:32768
    ds_read_b64_tr_b16 v[42:43], v17 offset:33792
    v_mfma_f32_16x16x32_bf16 a[156:159], a[124:127], v[44:47], a[156:159]
    s_add_u32 s72, s70, 32768
    ds_read_b64_tr_b16 v[44:45], v17 offset:40960
    ds_read_b64_tr_b16 v[46:47], v17 offset:41984
    v_mfma_f32_16x16x32_bf16 a[160:163], a[64:67], v[48:51], a[160:163]
    v_xor_b32 v17, s73, v17
    v_add_u32 v17, 0x10000, v17
    v_mfma_f32_16x16x32_bf16 a[160:163], a[68:71], v[52:55], a[160:163]
    buffer_store_dwordx4 v[144:147], v1, s[36:39], s72 offen sc1
    v_mfma_f32_16x16x32_bf16 a[164:167], a[72:75], v[48:51], a[164:167]
    v_cvt_pk_bf16_f32 v208, v208, v209
    v_cvt_pk_bf16_f32 v209, v210, v211
    v_mfma_f32_16x16x32_bf16 a[164:167], a[76:79], v[52:55], a[164:167]
    s_add_u32 m0, s69, 147456
    v_cvt_pk_bf16_f32 v210, v240, v241
    v_cvt_pk_bf16_f32 v211, v242, v243
    v_mfma_f32_16x16x32_bf16 a[168:171], a[80:83], v[48:51], a[168:171]
    s_xor_b32 s60, s60, 1572864
    buffer_load_dwordx4 v10, s[20:23], s63 offen lds
    v_mfma_f32_16x16x32_bf16 a[168:171], a[84:87], v[52:55], a[168:171]
    v_mul_f32 v212, s74, v212
    v_mul_f32 v213, s74, v213
    v_mfma_f32_16x16x32_bf16 a[172:175], a[88:91], v[48:51], a[172:175]
    v_mul_f32 v214, s74, v214
    v_mul_f32 v215, s74, v215
    v_mfma_f32_16x16x32_bf16 a[172:175], a[92:95], v[52:55], a[172:175]
    v_mul_f32 v244, s74, v244
    v_mul_f32 v245, s74, v245
    v_mfma_f32_16x16x32_bf16 a[176:179], a[96:99], v[48:51], a[176:179]
    ds_read_b128 v[88:91], v24 offset:57344
    v_mul_f32 v246, s74, v246
    v_mfma_f32_16x16x32_bf16 a[176:179], a[100:103], v[52:55], a[176:179]
    v_mul_f32 v247, s74, v247
    v_accvgpr_write_b32 a36, v208
    v_mfma_f32_16x16x32_bf16 a[180:183], a[104:107], v[48:51], a[180:183]
    v_accvgpr_write_b32 a37, v209
    v_accvgpr_write_b32 a38, v210
    v_mfma_f32_16x16x32_bf16 a[180:183], a[108:111], v[52:55], a[180:183]
    buffer_load_dwordx4 v11, s[20:23], s63 offen offset:1024 lds
    v_mfma_f32_16x16x32_bf16 a[184:187], a[112:115], v[48:51], a[184:187]
    v_accvgpr_write_b32 a39, v211
    v_cvt_pk_bf16_f32 v212, v212, v213
    v_mfma_f32_16x16x32_bf16 a[184:187], a[116:119], v[52:55], a[184:187]
    v_cvt_pk_bf16_f32 v213, v214, v215
    v_cvt_pk_bf16_f32 v214, v244, v245
    v_mfma_f32_16x16x32_bf16 a[188:191], a[120:123], v[48:51], a[188:191]
    v_cvt_pk_bf16_f32 v215, v246, v247
    v_mul_f32 v216, s74, v216
    v_mfma_f32_16x16x32_bf16 a[188:191], a[124:127], v[52:55], a[188:191]
    s_waitcnt lgkmcnt(0)
    v_mul_f32 v217, s74, v217
    v_mul_f32 v218, s74, v218
    v_mfma_f32_16x16x32_bf16 a[192:195], a[64:67], v[56:59], a[192:195]
    v_mul_f32 v219, s74, v219
    v_mul_f32 v248, s74, v248
    v_mfma_f32_16x16x32_bf16 a[192:195], a[68:71], v[60:63], a[192:195]
    v_mul_f32 v249, s74, v249
    v_mul_f32 v250, s74, v250
    v_mfma_f32_16x16x32_bf16 a[196:199], a[72:75], v[56:59], a[196:199]
    v_mul_f32 v251, s74, v251
    v_accvgpr_write_b32 a44, v212
    v_mfma_f32_16x16x32_bf16 a[196:199], a[76:79], v[60:63], a[196:199]
    buffer_load_dwordx4 v12, s[20:23], s63 offen offset:2048 lds
    v_mfma_f32_16x16x32_bf16 a[200:203], a[80:83], v[56:59], a[200:203]
    ds_read_b128 v[92:95], v25 offset:57344
    v_accvgpr_write_b32 a45, v213
    v_mfma_f32_16x16x32_bf16 a[200:203], a[84:87], v[60:63], a[200:203]
    v_accvgpr_write_b32 a46, v214
    v_accvgpr_write_b32 a47, v215
    v_mfma_f32_16x16x32_bf16 a[204:207], a[88:91], v[56:59], a[204:207]
    v_cvt_pk_bf16_f32 v216, v216, v217
    v_cvt_pk_bf16_f32 v217, v218, v219
    v_mfma_f32_16x16x32_bf16 a[204:207], a[92:95], v[60:63], a[204:207]
    s_add_u32 s72, s70, 36864
    v_cvt_pk_bf16_f32 v218, v248, v249
    v_cvt_pk_bf16_f32 v219, v250, v251
    v_mfma_f32_16x16x32_bf16 a[208:211], a[96:99], v[56:59], a[208:211]
    buffer_store_dwordx4 a[40:43], v1, s[36:39], s72 offen sc1
    v_mfma_f32_16x16x32_bf16 a[208:211], a[100:103], v[60:63], a[208:211]
    v_mul_f32 v220, s74, v220
    v_mul_f32 v221, s74, v221
    v_mfma_f32_16x16x32_bf16 a[212:215], a[104:107], v[56:59], a[212:215]
    buffer_load_dwordx4 v13, s[20:23], s63 offen offset:3072 lds
    v_mfma_f32_16x16x32_bf16 a[212:215], a[108:111], v[60:63], a[212:215]
    v_mul_f32 v222, s74, v222
    v_mul_f32 v223, s74, v223
    v_mfma_f32_16x16x32_bf16 a[216:219], a[112:115], v[56:59], a[216:219]
    v_mul_f32 v252, s74, v252
    v_mul_f32 v253, s74, v253
    v_mfma_f32_16x16x32_bf16 a[216:219], a[116:119], v[60:63], a[216:219]
    v_mul_f32 v254, s74, v254
    v_mul_f32 v255, s74, v255
    v_mfma_f32_16x16x32_bf16 a[220:223], a[120:123], v[56:59], a[220:223]
    v_accvgpr_write_b32 a52, v216
    v_accvgpr_write_b32 a53, v217
    v_mfma_f32_16x16x32_bf16 a[220:223], a[124:127], v[60:63], a[220:223]
    v_accvgpr_write_b32 a54, v218
    v_accvgpr_write_b32 a55, v219
    v_mfma_f32_16x16x32_bf16 a[224:227], a[64:67], v[40:43], a[224:227]
    v_cvt_pk_bf16_f32 v220, v220, v221
    v_cvt_pk_bf16_f32 v221, v222, v223
    v_mfma_f32_16x16x32_bf16 a[224:227], a[68:71], v[44:47], a[224:227]
    s_xor_b32 s63, s63, 128
    v_cvt_pk_bf16_f32 v222, v252, v253
    v_cvt_pk_bf16_f32 v223, v254, v255
    v_mfma_f32_16x16x32_bf16 a[228:231], a[72:75], v[40:43], a[228:231]
    v_accvgpr_write_b32 a60, v220
    v_accvgpr_write_b32 a61, v221
    v_mfma_f32_16x16x32_bf16 a[228:231], a[76:79], v[44:47], a[228:231]
    v_accvgpr_write_b32 a62, v222
    v_accvgpr_write_b32 a63, v223
    v_mfma_f32_16x16x32_bf16 a[232:235], a[80:83], v[40:43], a[232:235]
    v_accvgpr_write_b32 a0, 0
    v_accvgpr_write_b32 a1, 0
    v_mfma_f32_16x16x32_bf16 a[232:235], a[84:87], v[44:47], a[232:235]
    s_waitcnt vmcnt(11) lgkmcnt(0)
    s_barrier
    ds_read_b64_tr_b16 v[48:49], v14 offset:0
    v_mfma_f32_16x16x32_bf16 a[236:239], a[88:91], v[40:43], a[236:239]
    s_add_u32 m0, s67, 0
    ds_read_b64_tr_b16 v[50:51], v14 offset:1024
    ds_read_b64_tr_b16 v[52:53], v14 offset:8192
    v_mfma_f32_16x16x32_bf16 a[236:239], a[92:95], v[44:47], a[236:239]
    buffer_load_dwordx4 v1, s[28:31], s65 offen sc1 lds
    v_mfma_f32_16x16x32_bf16 a[240:243], a[96:99], v[40:43], a[240:243]
    ds_read_b64_tr_b16 v[54:55], v14 offset:9216
    ds_read_b64_tr_b16 v[56:57], v15 offset:0
    v_mfma_f32_16x16x32_bf16 a[240:243], a[100:103], v[44:47], a[240:243]
    ds_read_b64_tr_b16 v[58:59], v15 offset:1024
    ds_read_b64_tr_b16 v[60:61], v15 offset:8192
    v_mfma_f32_16x16x32_bf16 a[244:247], a[104:107], v[40:43], a[244:247]
    ds_read_b64_tr_b16 v[62:63], v15 offset:9216
    v_add_u32 v14, 0x10000, v14
    v_mfma_f32_16x16x32_bf16 a[244:247], a[108:111], v[44:47], a[244:247]
    v_add_u32 v15, 0x10000, v15
    v_accvgpr_write_b32 a2, 0
    v_mfma_f32_16x16x32_bf16 a[248:251], a[112:115], v[40:43], a[248:251]
    v_accvgpr_write_b32 a3, 0
    v_accvgpr_write_b32 a8, 0
    v_mfma_f32_16x16x32_bf16 a[248:251], a[116:119], v[44:47], a[248:251]
    v_accvgpr_write_b32 a9, 0
    v_accvgpr_write_b32 a10, 0
    v_mfma_f32_16x16x32_bf16 a[252:255], a[120:123], v[40:43], a[252:255]
    ds_read_b64_tr_b16 v[40:41], v16 offset:0
    ds_read_b64_tr_b16 v[42:43], v16 offset:1024
    v_mfma_f32_16x16x32_bf16 a[252:255], a[124:127], v[44:47], a[252:255]
    s_add_u32 s72, s70, 40960
    ds_read_b64_tr_b16 v[44:45], v16 offset:8192
    ds_read_b64_tr_b16 v[46:47], v16 offset:9216
    s_waitcnt lgkmcnt(4)
    v_mfma_f32_16x16x32_bf16 v[128:131], v[48:51], v[64:67], 0
    buffer_load_dwordx4 v1, s[28:31], s65 offen offset:1024 sc1 lds
    v_mfma_f32_16x16x32_bf16 v[128:131], v[52:55], v[68:71], v[128:131]
    v_add_u32 v24, 0x10000, v24
    v_add_u32 v16, 0x10000, v16
    v_mfma_f32_16x16x32_bf16 v[132:135], v[48:51], v[72:75], 0
    ds_read_b128 v[96:99], v24 offset:16384
    v_accvgpr_write_b32 a11, 0
    v_mfma_f32_16x16x32_bf16 v[132:135], v[52:55], v[76:79], v[132:135]
    buffer_store_dwordx4 a[48:51], v1, s[36:39], s72 offen sc1
    v_mfma_f32_16x16x32_bf16 v[136:139], v[48:51], v[80:83], 0
    v_accvgpr_write_b32 a16, 0
    v_accvgpr_write_b32 a17, 0
    v_mfma_f32_16x16x32_bf16 v[136:139], v[52:55], v[84:87], v[136:139]
    v_accvgpr_write_b32 a18, 0
    v_accvgpr_write_b32 a19, 0
    v_mfma_f32_16x16x32_bf16 v[140:143], v[48:51], v[88:91], 0
    ds_read_b64_tr_b16 v[48:49], v17 offset:0
    ds_read_b64_tr_b16 v[50:51], v17 offset:1024
    v_mfma_f32_16x16x32_bf16 v[140:143], v[52:55], v[92:95], v[140:143]
    ds_read_b64_tr_b16 v[52:53], v17 offset:8192
    ds_read_b64_tr_b16 v[54:55], v17 offset:9216
    v_mfma_f32_16x16x32_bf16 v[144:147], v[56:59], v[64:67], 0
    v_add_u32 v17, 0x10000, v17
    v_accvgpr_write_b32 a24, 0
    v_mfma_f32_16x16x32_bf16 v[144:147], v[60:63], v[68:71], v[144:147]
    s_add_u32 m0, s69, 16384
    v_accvgpr_write_b32 a25, 0
    v_accvgpr_write_b32 a26, 0
    v_mfma_f32_16x16x32_bf16 v[148:151], v[56:59], v[72:75], 0
    s_xor_b32 s65, s65, 24576
    buffer_load_dwordx4 v10, s[20:23], s64 offen lds
    v_mfma_f32_16x16x32_bf16 v[148:151], v[60:63], v[76:79], v[148:151]
    v_accvgpr_write_b32 a27, 0
    v_accvgpr_write_b32 a32, 0
    v_mfma_f32_16x16x32_bf16 v[152:155], v[56:59], v[80:83], 0
    v_add_u32 v25, 0x10000, v25
    v_accvgpr_write_b32 a33, 0
    v_mfma_f32_16x16x32_bf16 v[152:155], v[60:63], v[84:87], v[152:155]
    ds_read_b128 v[100:103], v25 offset:16384
    v_accvgpr_write_b32 a34, 0
    v_mfma_f32_16x16x32_bf16 v[156:159], v[56:59], v[88:91], 0
    ds_read_b64_tr_b16 v[56:57], v18 offset:0
    ds_read_b64_tr_b16 v[58:59], v18 offset:1024
    v_mfma_f32_16x16x32_bf16 v[156:159], v[60:63], v[92:95], v[156:159]
    s_waitcnt lgkmcnt(3)
    ds_read_b64_tr_b16 v[60:61], v18 offset:8192
    ds_read_b64_tr_b16 v[62:63], v18 offset:9216
    v_mfma_f32_16x16x32_bf16 v[160:163], v[40:43], v[64:67], 0
    v_add_u32 v18, 0x10000, v18
    v_accvgpr_write_b32 a35, 0
    v_mfma_f32_16x16x32_bf16 v[160:163], v[44:47], v[68:71], v[160:163]
    v_accvgpr_write_b32 a40, 0
    v_accvgpr_write_b32 a41, 0
    v_mfma_f32_16x16x32_bf16 v[164:167], v[40:43], v[72:75], 0
    v_accvgpr_write_b32 a42, 0
    v_accvgpr_write_b32 a43, 0
    v_mfma_f32_16x16x32_bf16 v[164:167], v[44:47], v[76:79], v[164:167]
    v_accvgpr_write_b32 a48, 0
    v_accvgpr_write_b32 a49, 0
    v_mfma_f32_16x16x32_bf16 v[168:171], v[40:43], v[80:83], 0
    buffer_load_dwordx4 v11, s[20:23], s64 offen offset:1024 lds
    v_mfma_f32_16x16x32_bf16 v[168:171], v[44:47], v[84:87], v[168:171]
    v_accvgpr_write_b32 a50, 0
    v_accvgpr_write_b32 a51, 0
    v_mfma_f32_16x16x32_bf16 v[172:175], v[40:43], v[88:91], 0
    ds_read_b64_tr_b16 v[40:41], v19 offset:0
    ds_read_b64_tr_b16 v[42:43], v19 offset:1024
    v_mfma_f32_16x16x32_bf16 v[172:175], v[44:47], v[92:95], v[172:175]
    s_add_u32 s72, s70, 45056
    ds_read_b64_tr_b16 v[44:45], v19 offset:8192
    ds_read_b64_tr_b16 v[46:47], v19 offset:9216
    v_mfma_f32_16x16x32_bf16 v[176:179], v[48:51], v[64:67], 0
    ds_read_b128 v[104:107], v24 offset:24576
    v_add_u32 v19, 0x10000, v19
    v_mfma_f32_16x16x32_bf16 v[176:179], v[52:55], v[68:71], v[176:179]
    buffer_store_dwordx4 a[56:59], v1, s[36:39], s72 offen sc1
    v_mfma_f32_16x16x32_bf16 v[180:183], v[48:51], v[72:75], 0
    v_mfma_f32_16x16x32_bf16 v[180:183], v[52:55], v[76:79], v[180:183]
    v_accvgpr_write_b32 a56, 0
    v_accvgpr_write_b32 a57, 0
    v_mfma_f32_16x16x32_bf16 v[184:187], v[48:51], v[80:83], 0
    v_accvgpr_write_b32 a58, 0
    v_accvgpr_write_b32 a59, 0
    v_mfma_f32_16x16x32_bf16 v[184:187], v[52:55], v[84:87], v[184:187]
    v_mfma_f32_16x16x32_bf16 v[188:191], v[48:51], v[88:91], 0
    buffer_load_dwordx4 v12, s[20:23], s64 offen offset:2048 lds
    v_mfma_f32_16x16x32_bf16 v[188:191], v[52:55], v[92:95], v[188:191]
    s_waitcnt lgkmcnt(0)
    ds_read_b64_tr_b16 v[48:49], v20 offset:0
    ds_read_b64_tr_b16 v[50:51], v20 offset:1024
    v_mfma_f32_16x16x32_bf16 v[192:195], v[56:59], v[64:67], 0
    ds_read_b64_tr_b16 v[52:53], v20 offset:8192
    ds_read_b64_tr_b16 v[54:55], v20 offset:9216
    v_mfma_f32_16x16x32_bf16 v[192:195], v[60:63], v[68:71], v[192:195]
    v_add_u32 v20, 0x10000, v20
    v_mfma_f32_16x16x32_bf16 v[196:199], v[56:59], v[72:75], 0
    v_mfma_f32_16x16x32_bf16 v[196:199], v[60:63], v[76:79], v[196:199]
    ds_read_b128 v[108:111], v25 offset:24576
    v_mfma_f32_16x16x32_bf16 v[200:203], v[56:59], v[80:83], 0
    v_mfma_f32_16x16x32_bf16 v[200:203], v[60:63], v[84:87], v[200:203]
    v_mfma_f32_16x16x32_bf16 v[204:207], v[56:59], v[88:91], 0
    ds_read_b64_tr_b16 v[56:57], v21 offset:0
    ds_read_b64_tr_b16 v[58:59], v21 offset:1024
    v_mfma_f32_16x16x32_bf16 v[204:207], v[60:63], v[92:95], v[204:207]
    ds_read_b64_tr_b16 v[60:61], v21 offset:8192
    ds_read_b64_tr_b16 v[62:63], v21 offset:9216
    v_mfma_f32_16x16x32_bf16 v[208:211], v[40:43], v[64:67], 0
    buffer_load_dwordx4 v13, s[20:23], s64 offen offset:3072 lds
    v_mfma_f32_16x16x32_bf16 v[208:211], v[44:47], v[68:71], v[208:211]
    v_add_u32 v21, 0x10000, v21
    v_mfma_f32_16x16x32_bf16 v[212:215], v[40:43], v[72:75], 0
    v_mfma_f32_16x16x32_bf16 v[212:215], v[44:47], v[76:79], v[212:215]
    v_mfma_f32_16x16x32_bf16 v[216:219], v[40:43], v[80:83], 0
    v_mfma_f32_16x16x32_bf16 v[216:219], v[44:47], v[84:87], v[216:219]
    v_mfma_f32_16x16x32_bf16 v[220:223], v[40:43], v[88:91], 0
    ds_read_b64_tr_b16 v[40:41], v26 offset:32768
    ds_read_b64_tr_b16 v[42:43], v26 offset:33280
    v_mfma_f32_16x16x32_bf16 v[220:223], v[44:47], v[92:95], v[220:223]
    s_add_u32 s72, s70, 1024
    ds_read_b64_tr_b16 v[44:45], v26 offset:36864
    ds_read_b64_tr_b16 v[46:47], v26 offset:37376
    s_waitcnt lgkmcnt(4)
    v_mfma_f32_16x16x32_bf16 v[224:227], v[48:51], v[64:67], 0
    buffer_store_dwordx4 a[4:7], v1, s[36:39], s72 offen sc1
    v_mfma_f32_16x16x32_bf16 v[224:227], v[52:55], v[68:71], v[224:227]
    s_xor_b32 s64, s64, 128
    v_add_u32 v26, 0xffff0000, v26
    v_accvgpr_write_b32 a4, 0
    v_mfma_f32_16x16x32_bf16 v[228:231], v[48:51], v[72:75], 0
    v_accvgpr_write_b32 a5, 0
    v_accvgpr_write_b32 a6, 0
    v_mfma_f32_16x16x32_bf16 v[228:231], v[52:55], v[76:79], v[228:231]
    v_accvgpr_write_b32 a7, 0
    v_mfma_f32_16x16x32_bf16 v[232:235], v[48:51], v[80:83], 0
    v_mfma_f32_16x16x32_bf16 v[232:235], v[52:55], v[84:87], v[232:235]
    s_add_u32 m0, s69, 32768
    v_mfma_f32_16x16x32_bf16 v[236:239], v[48:51], v[88:91], 0
    buffer_load_dwordx4 v2, s[24:27], s60 offen lds
    v_mfma_f32_16x16x32_bf16 v[236:239], v[52:55], v[92:95], v[236:239]
    ds_read_b64_tr_b16 v[48:49], v27 offset:32768
    ds_read_b64_tr_b16 v[50:51], v27 offset:33280
    v_mfma_f32_16x16x32_bf16 v[240:243], v[56:59], v[64:67], 0
    ds_read_b64_tr_b16 v[52:53], v27 offset:36864
    ds_read_b64_tr_b16 v[54:55], v27 offset:37376
    v_mfma_f32_16x16x32_bf16 v[240:243], v[60:63], v[68:71], v[240:243]
    buffer_load_dwordx4 v3, s[24:27], s60 offen offset:1024 lds
    v_mfma_f32_16x16x32_bf16 v[244:247], v[56:59], v[72:75], 0
    v_add_u32 v27, 0xffff0000, v27
    v_mfma_f32_16x16x32_bf16 v[244:247], v[60:63], v[76:79], v[244:247]
    v_mfma_f32_16x16x32_bf16 v[248:251], v[56:59], v[80:83], 0
    v_mfma_f32_16x16x32_bf16 v[248:251], v[60:63], v[84:87], v[248:251]
    buffer_load_dwordx4 v4, s[24:27], s60 offen offset:2048 lds
    v_mfma_f32_16x16x32_bf16 v[252:255], v[56:59], v[88:91], 0
    ds_read_b64_tr_b16 v[56:57], v28 offset:32768
    ds_read_b64_tr_b16 v[58:59], v28 offset:33280
    v_mfma_f32_16x16x32_bf16 v[252:255], v[60:63], v[92:95], v[252:255]
    s_waitcnt lgkmcnt(2)
    ds_read_b64_tr_b16 v[60:61], v28 offset:36864
    ds_read_b64_tr_b16 v[62:63], v28 offset:37376
    v_mfma_f32_16x16x32_bf16 a[64:67], v[40:43], v[64:67], 0
    buffer_load_dwordx4 v5, s[24:27], s60 offen offset:3072 lds
    v_mfma_f32_16x16x32_bf16 a[64:67], v[44:47], v[68:71], a[64:67]
    v_add_u32 v28, 0xffff0000, v28
    v_mfma_f32_16x16x32_bf16 a[68:71], v[40:43], v[72:75], 0
    ds_read_b128 v[112:115], v24 offset:49152
    v_mfma_f32_16x16x32_bf16 a[68:71], v[44:47], v[76:79], a[68:71]
    s_add_u32 m0, s69, 49152
    v_mfma_f32_16x16x32_bf16 a[72:75], v[40:43], v[80:83], 0
    s_xor_b32 s60, s60, 524288
    buffer_load_dwordx4 v10, s[20:23], s63 offen lds
    v_mfma_f32_16x16x32_bf16 a[72:75], v[44:47], v[84:87], a[72:75]
    ds_read_b128 v[116:119], v25 offset:49152
    v_mfma_f32_16x16x32_bf16 a[76:79], v[40:43], v[88:91], 0
    ds_read_b64_tr_b16 v[40:41], v29 offset:32768
    ds_read_b64_tr_b16 v[42:43], v29 offset:33280
    v_mfma_f32_16x16x32_bf16 a[76:79], v[44:47], v[92:95], a[76:79]
    s_add_u32 s72, s70, 5120
    buffer_load_dwordx4 v11, s[20:23], s63 offen offset:1024 lds
    v_mfma_f32_16x16x32_bf16 a[80:83], v[48:51], v[64:67], 0
    ds_read_b128 v[120:123], v24 offset:57344
    ds_read_b64_tr_b16 v[44:45], v29 offset:36864
    v_mfma_f32_16x16x32_bf16 a[80:83], v[52:55], v[68:71], a[80:83]
    ds_read_b64_tr_b16 v[46:47], v29 offset:37376
    v_add_u32 v29, 0xffff0000, v29
    v_mfma_f32_16x16x32_bf16 a[84:87], v[48:51], v[72:75], 0
    buffer_store_dwordx4 a[12:15], v1, s[36:39], s72 offen sc1
    v_mfma_f32_16x16x32_bf16 a[84:87], v[52:55], v[76:79], a[84:87]
    ds_read_b128 v[124:127], v25 offset:57344
    v_accvgpr_write_b32 a12, 0
    v_mfma_f32_16x16x32_bf16 a[88:91], v[48:51], v[80:83], 0
    v_accvgpr_write_b32 a13, 0
    v_accvgpr_write_b32 a14, 0
    v_mfma_f32_16x16x32_bf16 a[88:91], v[52:55], v[84:87], a[88:91]
    v_accvgpr_write_b32 a15, 0
    v_mfma_f32_16x16x32_bf16 a[92:95], v[48:51], v[88:91], 0
    buffer_load_dwordx4 v12, s[20:23], s63 offen offset:2048 lds
    v_mfma_f32_16x16x32_bf16 a[92:95], v[52:55], v[92:95], a[92:95]
    s_waitcnt lgkmcnt(1)
    v_mfma_f32_16x16x32_bf16 a[96:99], v[56:59], v[64:67], 0
    v_mfma_f32_16x16x32_bf16 a[96:99], v[60:63], v[68:71], a[96:99]
    v_mfma_f32_16x16x32_bf16 a[100:103], v[56:59], v[72:75], 0
    buffer_load_dwordx4 v13, s[20:23], s63 offen offset:3072 lds
    v_mfma_f32_16x16x32_bf16 a[100:103], v[60:63], v[76:79], a[100:103]
    s_xor_b32 s63, s63, 896
    v_mfma_f32_16x16x32_bf16 a[104:107], v[56:59], v[80:83], 0
    v_mfma_f32_16x16x32_bf16 a[104:107], v[60:63], v[84:87], a[104:107]
    s_waitcnt vmcnt(10) lgkmcnt(0)
    s_barrier
    ds_read_b64_tr_b16 v[48:49], v14 offset:0
    v_mfma_f32_16x16x32_bf16 a[108:111], v[56:59], v[88:91], 0
    s_add_u32 m0, s67, 65536
    ds_read_b64_tr_b16 v[50:51], v14 offset:1024
    ds_read_b64_tr_b16 v[52:53], v14 offset:8192
    v_mfma_f32_16x16x32_bf16 a[108:111], v[60:63], v[92:95], a[108:111]
    buffer_load_dwordx4 v1, s[28:31], s65 offen sc1 lds
    v_mfma_f32_16x16x32_bf16 a[112:115], v[40:43], v[64:67], 0
    ds_read_b64_tr_b16 v[54:55], v14 offset:9216
    ds_read_b64_tr_b16 v[56:57], v15 offset:0
    v_mfma_f32_16x16x32_bf16 a[112:115], v[44:47], v[68:71], a[112:115]
    ds_read_b64_tr_b16 v[58:59], v15 offset:1024
    ds_read_b64_tr_b16 v[60:61], v15 offset:8192
    v_mfma_f32_16x16x32_bf16 a[116:119], v[40:43], v[72:75], 0
    ds_read_b64_tr_b16 v[62:63], v15 offset:9216
    v_add_u32 v14, 0xfffe0000, v14
    v_mfma_f32_16x16x32_bf16 a[116:119], v[44:47], v[76:79], a[116:119]
    v_add_u32 v15, 0xfffe0000, v15
    v_mfma_f32_16x16x32_bf16 a[120:123], v[40:43], v[80:83], 0
    v_mfma_f32_16x16x32_bf16 a[120:123], v[44:47], v[84:87], a[120:123]
    v_mfma_f32_16x16x32_bf16 a[124:127], v[40:43], v[88:91], 0
    ds_read_b64_tr_b16 v[40:41], v16 offset:0
    ds_read_b64_tr_b16 v[42:43], v16 offset:1024
    v_mfma_f32_16x16x32_bf16 a[124:127], v[44:47], v[92:95], a[124:127]
    s_add_u32 s72, s70, 9216
    ds_read_b64_tr_b16 v[44:45], v16 offset:8192
    ds_read_b64_tr_b16 v[46:47], v16 offset:9216
    s_waitcnt lgkmcnt(4)
    v_mfma_f32_16x16x32_bf16 v[128:131], v[48:51], v[96:99], v[128:131]
    buffer_load_dwordx4 v1, s[28:31], s65 offen offset:1024 sc1 lds
    v_mfma_f32_16x16x32_bf16 v[128:131], v[52:55], v[100:103], v[128:131]
    v_add_u32 v24, 0x10000, v24
    v_add_u32 v16, 0xfffe0000, v16
    v_mfma_f32_16x16x32_bf16 v[132:135], v[48:51], v[104:107], v[132:135]
    buffer_store_dwordx4 a[20:23], v1, s[36:39], s72 offen sc1
    v_mfma_f32_16x16x32_bf16 v[132:135], v[52:55], v[108:111], v[132:135]
    ds_read_b128 v[64:67], v24 offset:16384
    v_accvgpr_write_b32 a20, 0
    v_mfma_f32_16x16x32_bf16 v[136:139], v[48:51], v[112:115], v[136:139]
    v_accvgpr_write_b32 a21, 0
    v_accvgpr_write_b32 a22, 0
    v_mfma_f32_16x16x32_bf16 v[136:139], v[52:55], v[116:119], v[136:139]
    v_accvgpr_write_b32 a23, 0
    v_mfma_f32_16x16x32_bf16 v[140:143], v[48:51], v[120:123], v[140:143]
    ds_read_b64_tr_b16 v[48:49], v17 offset:0
    ds_read_b64_tr_b16 v[50:51], v17 offset:1024
    v_mfma_f32_16x16x32_bf16 v[140:143], v[52:55], v[124:127], v[140:143]
    ds_read_b64_tr_b16 v[52:53], v17 offset:8192
    ds_read_b64_tr_b16 v[54:55], v17 offset:9216
    v_mfma_f32_16x16x32_bf16 v[144:147], v[56:59], v[96:99], v[144:147]
    v_add_u32 v17, 0xfffe0000, v17
    v_mfma_f32_16x16x32_bf16 v[144:147], v[60:63], v[100:103], v[144:147]
    s_add_u32 m0, s69, 81920
    v_mfma_f32_16x16x32_bf16 v[148:151], v[56:59], v[104:107], v[148:151]
    s_xor_b32 s65, s65, 8192
    buffer_load_dwordx4 v10, s[20:23], s64 offen lds
    v_mfma_f32_16x16x32_bf16 v[148:151], v[60:63], v[108:111], v[148:151]
    v_mfma_f32_16x16x32_bf16 v[152:155], v[56:59], v[112:115], v[152:155]
    v_add_u32 v25, 0x10000, v25
    v_mfma_f32_16x16x32_bf16 v[152:155], v[60:63], v[116:119], v[152:155]
    ds_read_b128 v[68:71], v25 offset:16384
    v_mfma_f32_16x16x32_bf16 v[156:159], v[56:59], v[120:123], v[156:159]
    ds_read_b64_tr_b16 v[56:57], v18 offset:0
    ds_read_b64_tr_b16 v[58:59], v18 offset:1024
    v_mfma_f32_16x16x32_bf16 v[156:159], v[60:63], v[124:127], v[156:159]
    s_waitcnt lgkmcnt(3)
    ds_read_b64_tr_b16 v[60:61], v18 offset:8192
    ds_read_b64_tr_b16 v[62:63], v18 offset:9216
    v_mfma_f32_16x16x32_bf16 v[160:163], v[40:43], v[96:99], v[160:163]
    v_add_u32 v18, 0xfffe0000, v18
    v_mfma_f32_16x16x32_bf16 v[160:163], v[44:47], v[100:103], v[160:163]
    v_mfma_f32_16x16x32_bf16 v[164:167], v[40:43], v[104:107], v[164:167]
    v_mfma_f32_16x16x32_bf16 v[164:167], v[44:47], v[108:111], v[164:167]
    v_mfma_f32_16x16x32_bf16 v[168:171], v[40:43], v[112:115], v[168:171]
    buffer_load_dwordx4 v11, s[20:23], s64 offen offset:1024 lds
    v_mfma_f32_16x16x32_bf16 v[168:171], v[44:47], v[116:119], v[168:171]
    v_mfma_f32_16x16x32_bf16 v[172:175], v[40:43], v[120:123], v[172:175]
    ds_read_b64_tr_b16 v[40:41], v19 offset:0
    ds_read_b64_tr_b16 v[42:43], v19 offset:1024
    v_mfma_f32_16x16x32_bf16 v[172:175], v[44:47], v[124:127], v[172:175]
    s_add_u32 s72, s70, 13312
    ds_read_b64_tr_b16 v[44:45], v19 offset:8192
    ds_read_b64_tr_b16 v[46:47], v19 offset:9216
    v_mfma_f32_16x16x32_bf16 v[176:179], v[48:51], v[96:99], v[176:179]
    ds_read_b128 v[72:75], v24 offset:24576
    v_add_u32 v19, 0xfffe0000, v19
    v_mfma_f32_16x16x32_bf16 v[176:179], v[52:55], v[100:103], v[176:179]
    buffer_store_dwordx4 a[28:31], v1, s[36:39], s72 offen sc1
    v_mfma_f32_16x16x32_bf16 v[180:183], v[48:51], v[104:107], v[180:183]
    v_mfma_f32_16x16x32_bf16 v[180:183], v[52:55], v[108:111], v[180:183]
    v_accvgpr_write_b32 a28, 0
    v_accvgpr_write_b32 a29, 0
    v_mfma_f32_16x16x32_bf16 v[184:187], v[48:51], v[112:115], v[184:187]
    v_accvgpr_write_b32 a30, 0
    v_accvgpr_write_b32 a31, 0
    v_mfma_f32_16x16x32_bf16 v[184:187], v[52:55], v[116:119], v[184:187]
    v_mfma_f32_16x16x32_bf16 v[188:191], v[48:51], v[120:123], v[188:191]
    buffer_load_dwordx4 v12, s[20:23], s64 offen offset:2048 lds
    v_mfma_f32_16x16x32_bf16 v[188:191], v[52:55], v[124:127], v[188:191]
    s_waitcnt lgkmcnt(0)
    ds_read_b64_tr_b16 v[48:49], v20 offset:0
    ds_read_b64_tr_b16 v[50:51], v20 offset:1024
    v_mfma_f32_16x16x32_bf16 v[192:195], v[56:59], v[96:99], v[192:195]
    ds_read_b64_tr_b16 v[52:53], v20 offset:8192
    ds_read_b64_tr_b16 v[54:55], v20 offset:9216
    v_mfma_f32_16x16x32_bf16 v[192:195], v[60:63], v[100:103], v[192:195]
    v_add_u32 v20, 0xfffe0000, v20
    v_mfma_f32_16x16x32_bf16 v[196:199], v[56:59], v[104:107], v[196:199]
    v_mfma_f32_16x16x32_bf16 v[196:199], v[60:63], v[108:111], v[196:199]
    ds_read_b128 v[76:79], v25 offset:24576
    v_mfma_f32_16x16x32_bf16 v[200:203], v[56:59], v[112:115], v[200:203]
    v_mfma_f32_16x16x32_bf16 v[200:203], v[60:63], v[116:119], v[200:203]
    v_mfma_f32_16x16x32_bf16 v[204:207], v[56:59], v[120:123], v[204:207]
    ds_read_b64_tr_b16 v[56:57], v21 offset:0
    ds_read_b64_tr_b16 v[58:59], v21 offset:1024
    v_mfma_f32_16x16x32_bf16 v[204:207], v[60:63], v[124:127], v[204:207]
    ds_read_b64_tr_b16 v[60:61], v21 offset:8192
    ds_read_b64_tr_b16 v[62:63], v21 offset:9216
    v_mfma_f32_16x16x32_bf16 v[208:211], v[40:43], v[96:99], v[208:211]
    buffer_load_dwordx4 v13, s[20:23], s64 offen offset:3072 lds
    v_mfma_f32_16x16x32_bf16 v[208:211], v[44:47], v[100:103], v[208:211]
    v_add_u32 v21, 0xfffe0000, v21
    v_mfma_f32_16x16x32_bf16 v[212:215], v[40:43], v[104:107], v[212:215]
    v_mfma_f32_16x16x32_bf16 v[212:215], v[44:47], v[108:111], v[212:215]
    v_mfma_f32_16x16x32_bf16 v[216:219], v[40:43], v[112:115], v[216:219]
    v_mfma_f32_16x16x32_bf16 v[216:219], v[44:47], v[116:119], v[216:219]
    v_mfma_f32_16x16x32_bf16 v[220:223], v[40:43], v[120:123], v[220:223]
    ds_read_b64_tr_b16 v[40:41], v26 offset:0
    ds_read_b64_tr_b16 v[42:43], v26 offset:512
    v_mfma_f32_16x16x32_bf16 v[220:223], v[44:47], v[124:127], v[220:223]
    s_add_u32 s72, s70, 33792
    ds_read_b64_tr_b16 v[44:45], v26 offset:4096
    ds_read_b64_tr_b16 v[46:47], v26 offset:4608
    s_waitcnt lgkmcnt(4)
    v_mfma_f32_16x16x32_bf16 v[224:227], v[48:51], v[96:99], v[224:227]
    buffer_store_dwordx4 a[36:39], v1, s[36:39], s72 offen sc1
    v_mfma_f32_16x16x32_bf16 v[224:227], v[52:55], v[100:103], v[224:227]
    s_xor_b32 s64, s64, 896
    v_add_u32 v26, 0x10000, v26
    v_accvgpr_write_b32 a36, 0
    v_mfma_f32_16x16x32_bf16 v[228:231], v[48:51], v[104:107], v[228:231]
    v_accvgpr_write_b32 a37, 0
    v_accvgpr_write_b32 a38, 0
    v_mfma_f32_16x16x32_bf16 v[228:231], v[52:55], v[108:111], v[228:231]
    v_accvgpr_write_b32 a39, 0
    v_mfma_f32_16x16x32_bf16 v[232:235], v[48:51], v[112:115], v[232:235]
    v_mfma_f32_16x16x32_bf16 v[232:235], v[52:55], v[116:119], v[232:235]
    s_add_u32 m0, s69, 98304
    v_mfma_f32_16x16x32_bf16 v[236:239], v[48:51], v[120:123], v[236:239]
    buffer_load_dwordx4 v2, s[24:27], s60 offen lds
    v_mfma_f32_16x16x32_bf16 v[236:239], v[52:55], v[124:127], v[236:239]
    ds_read_b64_tr_b16 v[48:49], v27 offset:0
    ds_read_b64_tr_b16 v[50:51], v27 offset:512
    v_mfma_f32_16x16x32_bf16 v[240:243], v[56:59], v[96:99], v[240:243]
    ds_read_b64_tr_b16 v[52:53], v27 offset:4096
    ds_read_b64_tr_b16 v[54:55], v27 offset:4608
    v_mfma_f32_16x16x32_bf16 v[240:243], v[60:63], v[100:103], v[240:243]
    buffer_load_dwordx4 v3, s[24:27], s60 offen offset:1024 lds
    v_mfma_f32_16x16x32_bf16 v[244:247], v[56:59], v[104:107], v[244:247]
    v_add_u32 v27, 0x10000, v27
    v_mfma_f32_16x16x32_bf16 v[244:247], v[60:63], v[108:111], v[244:247]
    v_mfma_f32_16x16x32_bf16 v[248:251], v[56:59], v[112:115], v[248:251]
    v_mfma_f32_16x16x32_bf16 v[248:251], v[60:63], v[116:119], v[248:251]
    buffer_load_dwordx4 v4, s[24:27], s60 offen offset:2048 lds
    v_mfma_f32_16x16x32_bf16 v[252:255], v[56:59], v[120:123], v[252:255]
    ds_read_b64_tr_b16 v[56:57], v28 offset:0
    ds_read_b64_tr_b16 v[58:59], v28 offset:512
    v_mfma_f32_16x16x32_bf16 v[252:255], v[60:63], v[124:127], v[252:255]
    s_waitcnt lgkmcnt(2)
    ds_read_b64_tr_b16 v[60:61], v28 offset:4096
    ds_read_b64_tr_b16 v[62:63], v28 offset:4608
    v_mfma_f32_16x16x32_bf16 a[64:67], v[40:43], v[96:99], a[64:67]
    buffer_load_dwordx4 v5, s[24:27], s60 offen offset:3072 lds
    v_mfma_f32_16x16x32_bf16 a[64:67], v[44:47], v[100:103], a[64:67]
    v_add_u32 v24, 0xfffe0000, v24
    v_add_u32 v28, 0x10000, v28
    v_mfma_f32_16x16x32_bf16 a[68:71], v[40:43], v[104:107], a[68:71]
    ds_read_b128 v[80:83], v24 offset:16384
    v_mfma_f32_16x16x32_bf16 a[68:71], v[44:47], v[108:111], a[68:71]
    s_add_u32 m0, s69, 114688
    v_mfma_f32_16x16x32_bf16 a[72:75], v[40:43], v[112:115], a[72:75]
    s_xor_b32 s60, s60, 3670016
    buffer_load_dwordx4 v10, s[20:23], s63 offen lds
    v_mfma_f32_16x16x32_bf16 a[72:75], v[44:47], v[116:119], a[72:75]
    v_add_u32 v25, 0xfffe0000, v25
    ds_read_b128 v[84:87], v25 offset:16384
    v_mfma_f32_16x16x32_bf16 a[76:79], v[40:43], v[120:123], a[76:79]
    ds_read_b64_tr_b16 v[40:41], v29 offset:0
    ds_read_b64_tr_b16 v[42:43], v29 offset:512
    v_mfma_f32_16x16x32_bf16 a[76:79], v[44:47], v[124:127], a[76:79]
    s_add_u32 s72, s70, 37888
    buffer_load_dwordx4 v11, s[20:23], s63 offen offset:1024 lds
    v_mfma_f32_16x16x32_bf16 a[80:83], v[48:51], v[96:99], a[80:83]
    ds_read_b128 v[88:91], v24 offset:24576
    ds_read_b64_tr_b16 v[44:45], v29 offset:4096
    v_mfma_f32_16x16x32_bf16 a[80:83], v[52:55], v[100:103], a[80:83]
    ds_read_b64_tr_b16 v[46:47], v29 offset:4608
    v_add_u32 v29, 0x10000, v29
    v_mfma_f32_16x16x32_bf16 a[84:87], v[48:51], v[104:107], a[84:87]
    buffer_store_dwordx4 a[44:47], v1, s[36:39], s72 offen sc1
    v_mfma_f32_16x16x32_bf16 a[84:87], v[52:55], v[108:111], a[84:87]
    ds_read_b128 v[92:95], v25 offset:24576
    v_accvgpr_write_b32 a44, 0
    v_mfma_f32_16x16x32_bf16 a[88:91], v[48:51], v[112:115], a[88:91]
    v_accvgpr_write_b32 a45, 0
    v_accvgpr_write_b32 a46, 0
    v_mfma_f32_16x16x32_bf16 a[88:91], v[52:55], v[116:119], a[88:91]
    v_accvgpr_write_b32 a47, 0
    v_mfma_f32_16x16x32_bf16 a[92:95], v[48:51], v[120:123], a[92:95]
    buffer_load_dwordx4 v12, s[20:23], s63 offen offset:2048 lds
    v_mfma_f32_16x16x32_bf16 a[92:95], v[52:55], v[124:127], a[92:95]
    s_waitcnt lgkmcnt(1)
    v_mfma_f32_16x16x32_bf16 a[96:99], v[56:59], v[96:99], a[96:99]
    v_mfma_f32_16x16x32_bf16 a[96:99], v[60:63], v[100:103], a[96:99]
    v_mfma_f32_16x16x32_bf16 a[100:103], v[56:59], v[104:107], a[100:103]
    buffer_load_dwordx4 v13, s[20:23], s63 offen offset:3072 lds
    v_mfma_f32_16x16x32_bf16 a[100:103], v[60:63], v[108:111], a[100:103]
    s_xor_b32 s63, s63, 128
    v_mfma_f32_16x16x32_bf16 a[104:107], v[56:59], v[112:115], a[104:107]
    v_mfma_f32_16x16x32_bf16 a[104:107], v[60:63], v[116:119], a[104:107]
    s_waitcnt vmcnt(10) lgkmcnt(0)
    s_barrier
    ds_read_b64_tr_b16 v[48:49], v14 offset:32768
    v_mfma_f32_16x16x32_bf16 a[108:111], v[56:59], v[120:123], a[108:111]
    s_add_u32 m0, s67, 131072
    ds_read_b64_tr_b16 v[50:51], v14 offset:33792
    ds_read_b64_tr_b16 v[52:53], v14 offset:40960
    v_mfma_f32_16x16x32_bf16 a[108:111], v[60:63], v[124:127], a[108:111]
    buffer_load_dwordx4 v1, s[28:31], s65 offen sc1 lds
    v_mfma_f32_16x16x32_bf16 a[112:115], v[40:43], v[96:99], a[112:115]
    ds_read_b64_tr_b16 v[54:55], v14 offset:41984
    ds_read_b64_tr_b16 v[56:57], v15 offset:32768
    v_mfma_f32_16x16x32_bf16 a[112:115], v[44:47], v[100:103], a[112:115]
    ds_read_b64_tr_b16 v[58:59], v15 offset:33792
    ds_read_b64_tr_b16 v[60:61], v15 offset:40960
    v_mfma_f32_16x16x32_bf16 a[116:119], v[40:43], v[104:107], a[116:119]
    ds_read_b64_tr_b16 v[62:63], v15 offset:41984
    v_add_u32 v14, 0x10000, v14
    v_mfma_f32_16x16x32_bf16 a[116:119], v[44:47], v[108:111], a[116:119]
    v_add_u32 v15, 0x10000, v15
    v_mfma_f32_16x16x32_bf16 a[120:123], v[40:43], v[112:115], a[120:123]
    v_mfma_f32_16x16x32_bf16 a[120:123], v[44:47], v[116:119], a[120:123]
    v_mfma_f32_16x16x32_bf16 a[124:127], v[40:43], v[120:123], a[124:127]
    ds_read_b64_tr_b16 v[40:41], v16 offset:32768
    ds_read_b64_tr_b16 v[42:43], v16 offset:33792
    v_mfma_f32_16x16x32_bf16 a[124:127], v[44:47], v[124:127], a[124:127]
    s_add_u32 s72, s70, 41984
    ds_read_b64_tr_b16 v[44:45], v16 offset:40960
    ds_read_b64_tr_b16 v[46:47], v16 offset:41984
    s_waitcnt lgkmcnt(4)
    v_mfma_f32_16x16x32_bf16 v[128:131], v[48:51], v[64:67], v[128:131]
    buffer_load_dwordx4 v1, s[28:31], s65 offen offset:1024 sc1 lds
    v_mfma_f32_16x16x32_bf16 v[128:131], v[52:55], v[68:71], v[128:131]
    buffer_store_dwordx4 a[52:55], v1, s[36:39], s72 offen sc1
    v_mfma_f32_16x16x32_bf16 v[132:135], v[48:51], v[72:75], v[132:135]
    ds_read_b128 v[96:99], v24 offset:49152
    v_add_u32 v16, 0x10000, v16
    v_mfma_f32_16x16x32_bf16 v[132:135], v[52:55], v[76:79], v[132:135]
    v_accvgpr_write_b32 a52, 0
    v_accvgpr_write_b32 a53, 0
    v_mfma_f32_16x16x32_bf16 v[136:139], v[48:51], v[80:83], v[136:139]
    v_accvgpr_write_b32 a54, 0
    v_accvgpr_write_b32 a55, 0
    v_mfma_f32_16x16x32_bf16 v[136:139], v[52:55], v[84:87], v[136:139]
    v_mfma_f32_16x16x32_bf16 v[140:143], v[48:51], v[88:91], v[140:143]
    ds_read_b64_tr_b16 v[48:49], v17 offset:32768
    ds_read_b64_tr_b16 v[50:51], v17 offset:33792
    v_mfma_f32_16x16x32_bf16 v[140:143], v[52:55], v[92:95], v[140:143]
    ds_read_b64_tr_b16 v[52:53], v17 offset:40960
    ds_read_b64_tr_b16 v[54:55], v17 offset:41984
    v_mfma_f32_16x16x32_bf16 v[144:147], v[56:59], v[64:67], v[144:147]
    v_add_u32 v17, 0x10000, v17
    v_mfma_f32_16x16x32_bf16 v[144:147], v[60:63], v[68:71], v[144:147]
    s_add_u32 m0, s69, 147456
    v_mfma_f32_16x16x32_bf16 v[148:151], v[56:59], v[72:75], v[148:151]
    s_xor_b32 s65, s65, 57344
    buffer_load_dwordx4 v10, s[20:23], s64 offen lds
    v_mfma_f32_16x16x32_bf16 v[148:151], v[60:63], v[76:79], v[148:151]
    v_mfma_f32_16x16x32_bf16 v[152:155], v[56:59], v[80:83], v[152:155]
    v_mfma_f32_16x16x32_bf16 v[152:155], v[60:63], v[84:87], v[152:155]
    ds_read_b128 v[100:103], v25 offset:49152
    v_mfma_f32_16x16x32_bf16 v[156:159], v[56:59], v[88:91], v[156:159]
    ds_read_b64_tr_b16 v[56:57], v18 offset:32768
    ds_read_b64_tr_b16 v[58:59], v18 offset:33792
    v_mfma_f32_16x16x32_bf16 v[156:159], v[60:63], v[92:95], v[156:159]
    s_waitcnt lgkmcnt(3)
    ds_read_b64_tr_b16 v[60:61], v18 offset:40960
    ds_read_b64_tr_b16 v[62:63], v18 offset:41984
    v_mfma_f32_16x16x32_bf16 v[160:163], v[40:43], v[64:67], v[160:163]
    v_add_u32 v18, 0x10000, v18
    v_mfma_f32_16x16x32_bf16 v[160:163], v[44:47], v[68:71], v[160:163]
    v_mfma_f32_16x16x32_bf16 v[164:167], v[40:43], v[72:75], v[164:167]
    v_mfma_f32_16x16x32_bf16 v[164:167], v[44:47], v[76:79], v[164:167]
    v_mfma_f32_16x16x32_bf16 v[168:171], v[40:43], v[80:83], v[168:171]
    buffer_load_dwordx4 v11, s[20:23], s64 offen offset:1024 lds
    v_mfma_f32_16x16x32_bf16 v[168:171], v[44:47], v[84:87], v[168:171]
    v_mfma_f32_16x16x32_bf16 v[172:175], v[40:43], v[88:91], v[172:175]
    ds_read_b64_tr_b16 v[40:41], v19 offset:32768
    ds_read_b64_tr_b16 v[42:43], v19 offset:33792
    v_mfma_f32_16x16x32_bf16 v[172:175], v[44:47], v[92:95], v[172:175]
    s_add_u32 s72, s70, 46080
    ds_read_b64_tr_b16 v[44:45], v19 offset:40960
    ds_read_b64_tr_b16 v[46:47], v19 offset:41984
    v_mfma_f32_16x16x32_bf16 v[176:179], v[48:51], v[64:67], v[176:179]
    ds_read_b128 v[104:107], v24 offset:57344
    v_add_u32 v19, 0x10000, v19
    v_mfma_f32_16x16x32_bf16 v[176:179], v[52:55], v[68:71], v[176:179]
    buffer_store_dwordx4 a[60:63], v1, s[36:39], s72 offen sc1
    v_mfma_f32_16x16x32_bf16 v[180:183], v[48:51], v[72:75], v[180:183]
    v_mfma_f32_16x16x32_bf16 v[180:183], v[52:55], v[76:79], v[180:183]
    v_accvgpr_write_b32 a60, 0
    v_accvgpr_write_b32 a61, 0
    v_mfma_f32_16x16x32_bf16 v[184:187], v[48:51], v[80:83], v[184:187]
    v_accvgpr_write_b32 a62, 0
    v_accvgpr_write_b32 a63, 0
    v_mfma_f32_16x16x32_bf16 v[184:187], v[52:55], v[84:87], v[184:187]
    v_mfma_f32_16x16x32_bf16 v[188:191], v[48:51], v[88:91], v[188:191]
    buffer_load_dwordx4 v12, s[20:23], s64 offen offset:2048 lds
    v_mfma_f32_16x16x32_bf16 v[188:191], v[52:55], v[92:95], v[188:191]
    s_waitcnt lgkmcnt(0)
    ds_read_b64_tr_b16 v[48:49], v20 offset:32768
    ds_read_b64_tr_b16 v[50:51], v20 offset:33792
    v_mfma_f32_16x16x32_bf16 v[192:195], v[56:59], v[64:67], v[192:195]
    ds_read_b64_tr_b16 v[52:53], v20 offset:40960
    ds_read_b64_tr_b16 v[54:55], v20 offset:41984
    v_mfma_f32_16x16x32_bf16 v[192:195], v[60:63], v[68:71], v[192:195]
    v_add_u32 v20, 0x10000, v20
    v_mfma_f32_16x16x32_bf16 v[196:199], v[56:59], v[72:75], v[196:199]
    v_mfma_f32_16x16x32_bf16 v[196:199], v[60:63], v[76:79], v[196:199]
    ds_read_b128 v[108:111], v25 offset:57344
    v_mfma_f32_16x16x32_bf16 v[200:203], v[56:59], v[80:83], v[200:203]
    v_accvgpr_read_b32 v32, a128
    v_accvgpr_read_b32 v31, a129
    v_mfma_f32_16x16x32_bf16 v[200:203], v[60:63], v[84:87], v[200:203]
    v_cvt_pk_bf16_f32 v32, v32, v31
    v_accvgpr_read_b32 v33, a130
    v_mfma_f32_16x16x32_bf16 v[204:207], v[56:59], v[88:91], v[204:207]
    ds_read_b64_tr_b16 v[56:57], v21 offset:32768
    ds_read_b64_tr_b16 v[58:59], v21 offset:33792
    v_mfma_f32_16x16x32_bf16 v[204:207], v[60:63], v[92:95], v[204:207]
    ds_read_b64_tr_b16 v[60:61], v21 offset:40960
    ds_read_b64_tr_b16 v[62:63], v21 offset:41984
    v_mfma_f32_16x16x32_bf16 v[208:211], v[40:43], v[64:67], v[208:211]
    buffer_load_dwordx4 v13, s[20:23], s64 offen offset:3072 lds
    v_mfma_f32_16x16x32_bf16 v[208:211], v[44:47], v[68:71], v[208:211]
    v_add_u32 v21, 0x10000, v21
    v_accvgpr_read_b32 v31, a131
    v_mfma_f32_16x16x32_bf16 v[212:215], v[40:43], v[72:75], v[212:215]
    v_cvt_pk_bf16_f32 v33, v33, v31
    v_accvgpr_read_b32 v34, a132
    v_mfma_f32_16x16x32_bf16 v[212:215], v[44:47], v[76:79], v[212:215]
    v_accvgpr_read_b32 v31, a133
    v_cvt_pk_bf16_f32 v34, v34, v31
    v_mfma_f32_16x16x32_bf16 v[216:219], v[40:43], v[80:83], v[216:219]
    v_accvgpr_read_b32 v35, a134
    v_accvgpr_read_b32 v31, a135
    v_mfma_f32_16x16x32_bf16 v[216:219], v[44:47], v[84:87], v[216:219]
    v_cvt_pk_bf16_f32 v35, v35, v31
    v_mfma_f32_16x16x32_bf16 v[220:223], v[40:43], v[88:91], v[220:223]
    ds_read_b64_tr_b16 v[40:41], v26 offset:0
    ds_read_b64_tr_b16 v[42:43], v26 offset:512
    v_mfma_f32_16x16x32_bf16 v[220:223], v[44:47], v[92:95], v[220:223]
    s_add_u32 s72, s71, 0
    ds_read_b64_tr_b16 v[44:45], v26 offset:4096
    ds_read_b64_tr_b16 v[46:47], v26 offset:4608
    s_waitcnt lgkmcnt(4)
    v_mfma_f32_16x16x32_bf16 v[224:227], v[48:51], v[64:67], v[224:227]
    buffer_store_dwordx4 v[32:35], v1, s[36:39], s72 offen sc1
    v_mfma_f32_16x16x32_bf16 v[224:227], v[52:55], v[68:71], v[224:227]
    s_xor_b32 s64, s64, 128
    v_add_u32 v26, 0x10000, v26
    v_mfma_f32_16x16x32_bf16 v[228:231], v[48:51], v[72:75], v[228:231]
    v_mfma_f32_16x16x32_bf16 v[228:231], v[52:55], v[76:79], v[228:231]
    v_mfma_f32_16x16x32_bf16 v[232:235], v[48:51], v[80:83], v[232:235]
    v_mfma_f32_16x16x32_bf16 v[232:235], v[52:55], v[84:87], v[232:235]
    s_add_u32 m0, s69, 0
    v_mfma_f32_16x16x32_bf16 v[236:239], v[48:51], v[88:91], v[236:239]
    buffer_load_dwordx4 v2, s[24:27], s60 offen lds
    v_mfma_f32_16x16x32_bf16 v[236:239], v[52:55], v[92:95], v[236:239]
    ds_read_b64_tr_b16 v[48:49], v27 offset:0
    ds_read_b64_tr_b16 v[50:51], v27 offset:512
    v_mfma_f32_16x16x32_bf16 v[240:243], v[56:59], v[64:67], v[240:243]
    ds_read_b64_tr_b16 v[52:53], v27 offset:4096
    ds_read_b64_tr_b16 v[54:55], v27 offset:4608
    v_mfma_f32_16x16x32_bf16 v[240:243], v[60:63], v[68:71], v[240:243]
    buffer_load_dwordx4 v3, s[24:27], s60 offen offset:1024 lds
    v_mfma_f32_16x16x32_bf16 v[244:247], v[56:59], v[72:75], v[244:247]
    v_add_u32 v27, 0x10000, v27
    v_mfma_f32_16x16x32_bf16 v[244:247], v[60:63], v[76:79], v[244:247]
    v_mfma_f32_16x16x32_bf16 v[248:251], v[56:59], v[80:83], v[248:251]
    v_accvgpr_read_b32 v32, a136
    v_accvgpr_read_b32 v31, a137
    v_mfma_f32_16x16x32_bf16 v[248:251], v[60:63], v[84:87], v[248:251]
    buffer_load_dwordx4 v4, s[24:27], s60 offen offset:2048 lds
    v_mfma_f32_16x16x32_bf16 v[252:255], v[56:59], v[88:91], v[252:255]
    ds_read_b64_tr_b16 v[56:57], v28 offset:0
    ds_read_b64_tr_b16 v[58:59], v28 offset:512
    v_mfma_f32_16x16x32_bf16 v[252:255], v[60:63], v[92:95], v[252:255]
    s_waitcnt lgkmcnt(2)
    ds_read_b64_tr_b16 v[60:61], v28 offset:4096
    ds_read_b64_tr_b16 v[62:63], v28 offset:4608
    v_mfma_f32_16x16x32_bf16 a[64:67], v[40:43], v[64:67], a[64:67]
    buffer_load_dwordx4 v5, s[24:27], s60 offen offset:3072 lds
    v_mfma_f32_16x16x32_bf16 a[64:67], v[44:47], v[68:71], a[64:67]
    v_add_u32 v24, 0x10000, v24
    v_add_u32 v28, 0x10000, v28
    v_mfma_f32_16x16x32_bf16 a[68:71], v[40:43], v[72:75], a[68:71]
    ds_read_b128 v[112:115], v24 offset:16384
    v_cvt_pk_bf16_f32 v32, v32, v31
    v_mfma_f32_16x16x32_bf16 a[68:71], v[44:47], v[76:79], a[68:71]
    s_add_u32 m0, s69, 16384
    v_accvgpr_read_b32 v33, a138
    v_accvgpr_read_b32 v31, a139
    v_mfma_f32_16x16x32_bf16 a[72:75], v[40:43], v[80:83], a[72:75]
    s_xor_b32 s60, s60, 524288
    v_add_u32 v25, 0x10000, v25
    v_cvt_pk_bf16_f32 v33, v33, v31
    v_mfma_f32_16x16x32_bf16 a[72:75], v[44:47], v[84:87], a[72:75]
    buffer_load_dwordx4 v10, s[20:23], s63 offen lds
    v_mfma_f32_16x16x32_bf16 a[76:79], v[40:43], v[88:91], a[76:79]
    ds_read_b128 v[116:119], v25 offset:16384
    ds_read_b64_tr_b16 v[40:41], v29 offset:0
    v_mfma_f32_16x16x32_bf16 a[76:79], v[44:47], v[92:95], a[76:79]
    s_add_u32 s72, s71, 1024
    buffer_load_dwordx4 v11, s[20:23], s63 offen offset:1024 lds
    v_mfma_f32_16x16x32_bf16 a[80:83], v[48:51], v[64:67], a[80:83]
    ds_read_b128 v[120:123], v24 offset:24576
    ds_read_b64_tr_b16 v[42:43], v29 offset:512
    v_mfma_f32_16x16x32_bf16 a[80:83], v[52:55], v[68:71], a[80:83]
    ds_read_b64_tr_b16 v[44:45], v29 offset:4096
    ds_read_b64_tr_b16 v[46:47], v29 offset:4608
    v_mfma_f32_16x16x32_bf16 a[84:87], v[48:51], v[72:75], a[84:87]
    v_add_u32 v29, 0x10000, v29
    v_accvgpr_read_b32 v34, a140
    v_mfma_f32_16x16x32_bf16 a[84:87], v[52:55], v[76:79], a[84:87]
    buffer_load_dwordx4 v12, s[20:23], s63 offen offset:2048 lds
    v_mfma_f32_16x16x32_bf16 a[88:91], v[48:51], v[80:83], a[88:91]
    ds_read_b128 v[124:127], v25 offset:24576
    v_accvgpr_read_b32 v31, a141
    v_mfma_f32_16x16x32_bf16 a[88:91], v[52:55], v[84:87], a[88:91]
    v_cvt_pk_bf16_f32 v34, v34, v31
    v_accvgpr_read_b32 v35, a142
    v_mfma_f32_16x16x32_bf16 a[92:95], v[48:51], v[88:91], a[92:95]
    buffer_load_dwordx4 v13, s[20:23], s63 offen offset:3072 lds
    v_mfma_f32_16x16x32_bf16 a[92:95], v[52:55], v[92:95], a[92:95]
    s_waitcnt lgkmcnt(1)
    v_accvgpr_read_b32 v31, a143
    v_cvt_pk_bf16_f32 v35, v35, v31
    v_mfma_f32_16x16x32_bf16 a[96:99], v[56:59], v[64:67], a[96:99]
    v_mfma_f32_16x16x32_bf16 a[96:99], v[60:63], v[68:71], a[96:99]
    s_xor_b32 s63, s63, 384
    v_mfma_f32_16x16x32_bf16 a[100:103], v[56:59], v[72:75], a[100:103]
    buffer_store_dwordx4 v[32:35], v1, s[36:39], s72 offen sc1
    v_mfma_f32_16x16x32_bf16 a[100:103], v[60:63], v[76:79], a[100:103]
    v_mfma_f32_16x16x32_bf16 a[104:107], v[56:59], v[80:83], a[104:107]
    v_accvgpr_read_b32 v32, a144
    v_accvgpr_read_b32 v31, a145
    v_mfma_f32_16x16x32_bf16 a[104:107], v[60:63], v[84:87], a[104:107]
    s_waitcnt vmcnt(10) lgkmcnt(0)
    s_barrier
    ds_read_b64_tr_b16 v[48:49], v14 offset:32768
    v_mfma_f32_16x16x32_bf16 a[108:111], v[56:59], v[88:91], a[108:111]
    s_add_u32 m0, s67, 32768
    ds_read_b64_tr_b16 v[50:51], v14 offset:33792
    ds_read_b64_tr_b16 v[52:53], v14 offset:40960
    v_mfma_f32_16x16x32_bf16 a[108:111], v[60:63], v[92:95], a[108:111]
    buffer_load_dwordx4 v1, s[28:31], s65 offen sc1 lds
    v_mfma_f32_16x16x32_bf16 a[112:115], v[40:43], v[64:67], a[112:115]
    ds_read_b64_tr_b16 v[54:55], v14 offset:41984
    ds_read_b64_tr_b16 v[56:57], v15 offset:32768
    v_mfma_f32_16x16x32_bf16 a[112:115], v[44:47], v[68:71], a[112:115]
    ds_read_b64_tr_b16 v[58:59], v15 offset:33792
    ds_read_b64_tr_b16 v[60:61], v15 offset:40960
    v_mfma_f32_16x16x32_bf16 a[116:119], v[40:43], v[72:75], a[116:119]
    ds_read_b64_tr_b16 v[62:63], v15 offset:41984
    v_add_u32 v14, 0xffff0000, v14
    v_mfma_f32_16x16x32_bf16 a[116:119], v[44:47], v[76:79], a[116:119]
    v_add_u32 v15, 0xffff0000, v15
    v_cvt_pk_bf16_f32 v32, v32, v31
    v_mfma_f32_16x16x32_bf16 a[120:123], v[40:43], v[80:83], a[120:123]
    v_accvgpr_read_b32 v33, a146
    v_accvgpr_read_b32 v31, a147
    v_mfma_f32_16x16x32_bf16 a[120:123], v[44:47], v[84:87], a[120:123]
    v_cvt_pk_bf16_f32 v33, v33, v31
    v_accvgpr_read_b32 v34, a148
    v_mfma_f32_16x16x32_bf16 a[124:127], v[40:43], v[88:91], a[124:127]
    ds_read_b64_tr_b16 v[40:41], v16 offset:32768
    ds_read_b64_tr_b16 v[42:43], v16 offset:33792
    v_mfma_f32_16x16x32_bf16 a[124:127], v[44:47], v[92:95], a[124:127]
    s_add_u32 s72, s71, 32768
    ds_read_b64_tr_b16 v[44:45], v16 offset:40960
    ds_read_b64_tr_b16 v[46:47], v16 offset:41984
    s_waitcnt lgkmcnt(4)
    v_mfma_f32_16x16x32_bf16 v[128:131], v[48:51], v[96:99], v[128:131]
    buffer_load_dwordx4 v1, s[28:31], s65 offen offset:1024 sc1 lds
    v_mfma_f32_16x16x32_bf16 v[128:131], v[52:55], v[100:103], v[128:131]
    v_add_u32 v16, 0xffff0000, v16
    v_accvgpr_read_b32 v31, a149
    v_mfma_f32_16x16x32_bf16 v[132:135], v[48:51], v[104:107], v[132:135]
    ds_read_b128 v[64:67], v24 offset:49152
    v_cvt_pk_bf16_f32 v34, v34, v31
    v_mfma_f32_16x16x32_bf16 v[132:135], v[52:55], v[108:111], v[132:135]
    v_accvgpr_read_b32 v35, a150
    v_accvgpr_read_b32 v31, a151
    v_mfma_f32_16x16x32_bf16 v[136:139], v[48:51], v[112:115], v[136:139]
    v_cvt_pk_bf16_f32 v35, v35, v31
    v_accvgpr_write_b32 a144, 0
    v_mfma_f32_16x16x32_bf16 v[136:139], v[52:55], v[116:119], v[136:139]
    buffer_store_dwordx4 v[32:35], v1, s[36:39], s72 offen sc1
    v_mfma_f32_16x16x32_bf16 v[140:143], v[48:51], v[120:123], v[140:143]
    ds_read_b64_tr_b16 v[48:49], v17 offset:32768
    ds_read_b64_tr_b16 v[50:51], v17 offset:33792
    v_mfma_f32_16x16x32_bf16 v[140:143], v[52:55], v[124:127], v[140:143]
    ds_read_b64_tr_b16 v[52:53], v17 offset:40960
    ds_read_b64_tr_b16 v[54:55], v17 offset:41984
    v_mfma_f32_16x16x32_bf16 v[144:147], v[56:59], v[96:99], v[144:147]
    v_add_u32 v17, 0xffff0000, v17
    v_accvgpr_write_b32 a145, 0
    v_mfma_f32_16x16x32_bf16 v[144:147], v[60:63], v[100:103], v[144:147]
    s_add_u32 m0, s69, 49152
    v_accvgpr_write_b32 a146, 0
    v_accvgpr_write_b32 a147, 0
    v_mfma_f32_16x16x32_bf16 v[148:151], v[56:59], v[104:107], v[148:151]
    s_xor_b32 s65, s65, 8192
    buffer_load_dwordx4 v10, s[20:23], s64 offen lds
    v_mfma_f32_16x16x32_bf16 v[148:151], v[60:63], v[108:111], v[148:151]
    v_accvgpr_write_b32 a148, 0
    v_accvgpr_write_b32 a149, 0
    v_mfma_f32_16x16x32_bf16 v[152:155], v[56:59], v[112:115], v[152:155]
    v_accvgpr_read_b32 v32, a152
    v_accvgpr_read_b32 v31, a153
    v_mfma_f32_16x16x32_bf16 v[152:155], v[60:63], v[116:119], v[152:155]
    ds_read_b128 v[68:71], v25 offset:49152
    v_cvt_pk_bf16_f32 v32, v32, v31
    v_mfma_f32_16x16x32_bf16 v[156:159], v[56:59], v[120:123], v[156:159]
    ds_read_b64_tr_b16 v[56:57], v18 offset:32768
    ds_read_b64_tr_b16 v[58:59], v18 offset:33792
    v_mfma_f32_16x16x32_bf16 v[156:159], v[60:63], v[124:127], v[156:159]
    s_waitcnt lgkmcnt(3)
    ds_read_b64_tr_b16 v[60:61], v18 offset:40960
    ds_read_b64_tr_b16 v[62:63], v18 offset:41984
    v_mfma_f32_16x16x32_bf16 v[160:163], v[40:43], v[96:99], v[160:163]
    v_add_u32 v18, 0xffff0000, v18
    v_accvgpr_read_b32 v33, a154
    v_mfma_f32_16x16x32_bf16 v[160:163], v[44:47], v[100:103], v[160:163]
    v_accvgpr_read_b32 v31, a155
    v_cvt_pk_bf16_f32 v33, v33, v31
    v_mfma_f32_16x16x32_bf16 v[164:167], v[40:43], v[104:107], v[164:167]
    v_accvgpr_read_b32 v34, a156
    v_accvgpr_read_b32 v31, a157
    v_mfma_f32_16x16x32_bf16 v[164:167], v[44:47], v[108:111], v[164:167]
    v_cvt_pk_bf16_f32 v34, v34, v31
    v_accvgpr_read_b32 v35, a158
    v_mfma_f32_16x16x32_bf16 v[168:171], v[40:43], v[112:115], v[168:171]
    buffer_load_dwordx4 v11, s[20:23], s64 offen offset:1024 lds
    v_mfma_f32_16x16x32_bf16 v[168:171], v[44:47], v[116:119], v[168:171]
    v_accvgpr_read_b32 v31, a159
    v_cvt_pk_bf16_f32 v35, v35, v31
    v_mfma_f32_16x16x32_bf16 v[172:175], v[40:43], v[120:123], v[172:175]
    ds_read_b64_tr_b16 v[40:41], v19 offset:32768
    ds_read_b64_tr_b16 v[42:43], v19 offset:33792
    v_mfma_f32_16x16x32_bf16 v[172:175], v[44:47], v[124:127], v[172:175]
    s_add_u32 s72, s71, 33792
    ds_read_b64_tr_b16 v[44:45], v19 offset:40960
    ds_read_b64_tr_b16 v[46:47], v19 offset:41984
    v_mfma_f32_16x16x32_bf16 v[176:179], v[48:51], v[96:99], v[176:179]
    ds_read_b128 v[72:75], v24 offset:57344
    v_add_u32 v19, 0xffff0000, v19
    v_mfma_f32_16x16x32_bf16 v[176:179], v[52:55], v[100:103], v[176:179]
    buffer_store_dwordx4 v[32:35], v1, s[36:39], s72 offen sc1
    v_mfma_f32_16x16x32_bf16 v[180:183], v[48:51], v[104:107], v[180:183]
    v_accvgpr_write_b32 a150, 0
    v_accvgpr_write_b32 a151, 0
    v_mfma_f32_16x16x32_bf16 v[180:183], v[52:55], v[108:111], v[180:183]
    v_accvgpr_write_b32 a152, 0
    v_accvgpr_write_b32 a153, 0
    v_mfma_f32_16x16x32_bf16 v[184:187], v[48:51], v[112:115], v[184:187]
    v_accvgpr_write_b32 a154, 0
    v_accvgpr_write_b32 a155, 0
    v_mfma_f32_16x16x32_bf16 v[184:187], v[52:55], v[116:119], v[184:187]
    v_accvgpr_write_b32 a156, 0
    v_accvgpr_write_b32 a157, 0
    v_mfma_f32_16x16x32_bf16 v[188:191], v[48:51], v[120:123], v[188:191]
    buffer_load_dwordx4 v12, s[20:23], s64 offen offset:2048 lds
    v_mfma_f32_16x16x32_bf16 v[188:191], v[52:55], v[124:127], v[188:191]
    s_waitcnt lgkmcnt(0)
    ds_read_b64_tr_b16 v[48:49], v20 offset:32768
    ds_read_b64_tr_b16 v[50:51], v20 offset:33792
    v_mfma_f32_16x16x32_bf16 v[192:195], v[56:59], v[96:99], v[192:195]
    ds_read_b64_tr_b16 v[52:53], v20 offset:40960
    ds_read_b64_tr_b16 v[54:55], v20 offset:41984
    v_mfma_f32_16x16x32_bf16 v[192:195], v[60:63], v[100:103], v[192:195]
    v_add_u32 v20, 0xffff0000, v20
    v_accvgpr_write_b32 a158, 0
    v_mfma_f32_16x16x32_bf16 v[196:199], v[56:59], v[104:107], v[196:199]
    v_accvgpr_write_b32 a159, 0
    v_mfma_f32_16x16x32_bf16 v[196:199], v[60:63], v[108:111], v[196:199]
    ds_read_b128 v[76:79], v25 offset:57344
    v_mfma_f32_16x16x32_bf16 v[200:203], v[56:59], v[112:115], v[200:203]
    v_accvgpr_read_b32 v32, a160
    v_accvgpr_read_b32 v31, a161
    v_mfma_f32_16x16x32_bf16 v[200:203], v[60:63], v[116:119], v[200:203]
    v_cvt_pk_bf16_f32 v32, v32, v31
    v_accvgpr_read_b32 v33, a162
    v_mfma_f32_16x16x32_bf16 v[204:207], v[56:59], v[120:123], v[204:207]
    ds_read_b64_tr_b16 v[56:57], v21 offset:32768
    ds_read_b64_tr_b16 v[58:59], v21 offset:33792
    v_mfma_f32_16x16x32_bf16 v[204:207], v[60:63], v[124:127], v[204:207]
    ds_read_b64_tr_b16 v[60:61], v21 offset:40960
    ds_read_b64_tr_b16 v[62:63], v21 offset:41984
    v_mfma_f32_16x16x32_bf16 v[208:211], v[40:43], v[96:99], v[208:211]
    buffer_load_dwordx4 v13, s[20:23], s64 offen offset:3072 lds
    v_mfma_f32_16x16x32_bf16 v[208:211], v[44:47], v[100:103], v[208:211]
    v_add_u32 v21, 0xffff0000, v21
    v_accvgpr_read_b32 v31, a163
    v_mfma_f32_16x16x32_bf16 v[212:215], v[40:43], v[104:107], v[212:215]
    v_cvt_pk_bf16_f32 v33, v33, v31
    v_accvgpr_read_b32 v34, a164
    v_mfma_f32_16x16x32_bf16 v[212:215], v[44:47], v[108:111], v[212:215]
    v_accvgpr_read_b32 v31, a165
    v_cvt_pk_bf16_f32 v34, v34, v31
    v_mfma_f32_16x16x32_bf16 v[216:219], v[40:43], v[112:115], v[216:219]
    v_accvgpr_read_b32 v35, a166
    v_accvgpr_read_b32 v31, a167
    v_mfma_f32_16x16x32_bf16 v[216:219], v[44:47], v[116:119], v[216:219]
    v_cvt_pk_bf16_f32 v35, v35, v31
    v_accvgpr_write_b32 a160, 0
    v_mfma_f32_16x16x32_bf16 v[220:223], v[40:43], v[120:123], v[220:223]
    ds_read_b64_tr_b16 v[40:41], v26 offset:0
    ds_read_b64_tr_b16 v[42:43], v26 offset:512
    v_mfma_f32_16x16x32_bf16 v[220:223], v[44:47], v[124:127], v[220:223]
    s_add_u32 s72, s71, 2048
    ds_read_b64_tr_b16 v[44:45], v26 offset:4096
    ds_read_b64_tr_b16 v[46:47], v26 offset:4608
    s_waitcnt lgkmcnt(4)
    v_mfma_f32_16x16x32_bf16 v[224:227], v[48:51], v[96:99], v[224:227]
    v_add_u32 v26, 0xfffe0000, v26
    v_accvgpr_write_b32 a161, 0
    v_mfma_f32_16x16x32_bf16 v[224:227], v[52:55], v[100:103], v[224:227]
    s_xor_b32 s64, s64, 384
    buffer_store_dwordx4 v[32:35], v1, s[36:39], s72 offen sc1
    v_mfma_f32_16x16x32_bf16 v[228:231], v[48:51], v[104:107], v[228:231]
    v_accvgpr_write_b32 a162, 0
    v_accvgpr_write_b32 a163, 0
    v_mfma_f32_16x16x32_bf16 v[228:231], v[52:55], v[108:111], v[228:231]
    v_accvgpr_write_b32 a164, 0
    v_accvgpr_write_b32 a165, 0
    v_mfma_f32_16x16x32_bf16 v[232:235], v[48:51], v[112:115], v[232:235]
    v_accvgpr_write_b32 a166, 0
    v_accvgpr_write_b32 a167, 0
    v_mfma_f32_16x16x32_bf16 v[232:235], v[52:55], v[116:119], v[232:235]
    s_add_u32 m0, s69, 65536
    v_mfma_f32_16x16x32_bf16 v[236:239], v[48:51], v[120:123], v[236:239]
    buffer_load_dwordx4 v2, s[24:27], s60 offen lds
    v_mfma_f32_16x16x32_bf16 v[236:239], v[52:55], v[124:127], v[236:239]
    ds_read_b64_tr_b16 v[48:49], v27 offset:0
    ds_read_b64_tr_b16 v[50:51], v27 offset:512
    v_mfma_f32_16x16x32_bf16 v[240:243], v[56:59], v[96:99], v[240:243]
    ds_read_b64_tr_b16 v[52:53], v27 offset:4096
    ds_read_b64_tr_b16 v[54:55], v27 offset:4608
    v_mfma_f32_16x16x32_bf16 v[240:243], v[60:63], v[100:103], v[240:243]
    buffer_load_dwordx4 v3, s[24:27], s60 offen offset:1024 lds
    v_mfma_f32_16x16x32_bf16 v[244:247], v[56:59], v[104:107], v[244:247]
    v_add_u32 v27, 0xfffe0000, v27
    v_mfma_f32_16x16x32_bf16 v[244:247], v[60:63], v[108:111], v[244:247]
    v_mfma_f32_16x16x32_bf16 v[248:251], v[56:59], v[112:115], v[248:251]
    v_accvgpr_read_b32 v32, a168
    v_accvgpr_read_b32 v31, a169
    v_mfma_f32_16x16x32_bf16 v[248:251], v[60:63], v[116:119], v[248:251]
    buffer_load_dwordx4 v4, s[24:27], s60 offen offset:2048 lds
    v_mfma_f32_16x16x32_bf16 v[252:255], v[56:59], v[120:123], v[252:255]
    ds_read_b64_tr_b16 v[56:57], v28 offset:0
    ds_read_b64_tr_b16 v[58:59], v28 offset:512
    v_mfma_f32_16x16x32_bf16 v[252:255], v[60:63], v[124:127], v[252:255]
    s_waitcnt lgkmcnt(2)
    ds_read_b64_tr_b16 v[60:61], v28 offset:4096
    ds_read_b64_tr_b16 v[62:63], v28 offset:4608
    v_mfma_f32_16x16x32_bf16 a[64:67], v[40:43], v[96:99], a[64:67]
    buffer_load_dwordx4 v5, s[24:27], s60 offen offset:3072 lds
    v_mfma_f32_16x16x32_bf16 a[64:67], v[44:47], v[100:103], a[64:67]
    v_add_u32 v24, 0x10000, v24
    v_add_u32 v28, 0xfffe0000, v28
    v_mfma_f32_16x16x32_bf16 a[68:71], v[40:43], v[104:107], a[68:71]
    ds_read_b128 v[80:83], v24 offset:16384
    v_cvt_pk_bf16_f32 v32, v32, v31
    v_mfma_f32_16x16x32_bf16 a[68:71], v[44:47], v[108:111], a[68:71]
    s_add_u32 m0, s69, 81920
    v_accvgpr_read_b32 v33, a170
    v_accvgpr_read_b32 v31, a171
    v_mfma_f32_16x16x32_bf16 a[72:75], v[40:43], v[112:115], a[72:75]
    s_xor_b32 s60, s60, 1572864
    v_add_u32 v25, 0x10000, v25
    v_cvt_pk_bf16_f32 v33, v33, v31
    v_mfma_f32_16x16x32_bf16 a[72:75], v[44:47], v[116:119], a[72:75]
    buffer_load_dwordx4 v10, s[20:23], s63 offen lds
    v_mfma_f32_16x16x32_bf16 a[76:79], v[40:43], v[120:123], a[76:79]
    ds_read_b128 v[84:87], v25 offset:16384
    ds_read_b64_tr_b16 v[40:41], v29 offset:0
    v_mfma_f32_16x16x32_bf16 a[76:79], v[44:47], v[124:127], a[76:79]
    s_add_u32 s72, s71, 3072
    buffer_load_dwordx4 v11, s[20:23], s63 offen offset:1024 lds
    v_mfma_f32_16x16x32_bf16 a[80:83], v[48:51], v[96:99], a[80:83]
    ds_read_b128 v[88:91], v24 offset:24576
    ds_read_b64_tr_b16 v[42:43], v29 offset:512
    v_mfma_f32_16x16x32_bf16 a[80:83], v[52:55], v[100:103], a[80:83]
    ds_read_b64_tr_b16 v[44:45], v29 offset:4096
    ds_read_b64_tr_b16 v[46:47], v29 offset:4608
    v_mfma_f32_16x16x32_bf16 a[84:87], v[48:51], v[104:107], a[84:87]
    v_add_u32 v29, 0xfffe0000, v29
    v_accvgpr_read_b32 v34, a172
    v_mfma_f32_16x16x32_bf16 a[84:87], v[52:55], v[108:111], a[84:87]
    buffer_load_dwordx4 v12, s[20:23], s63 offen offset:2048 lds
    v_mfma_f32_16x16x32_bf16 a[88:91], v[48:51], v[112:115], a[88:91]
    ds_read_b128 v[92:95], v25 offset:24576
    v_accvgpr_read_b32 v31, a173
    v_mfma_f32_16x16x32_bf16 a[88:91], v[52:55], v[116:119], a[88:91]
    v_cvt_pk_bf16_f32 v34, v34, v31
    v_accvgpr_read_b32 v35, a174
    v_mfma_f32_16x16x32_bf16 a[92:95], v[48:51], v[120:123], a[92:95]
    buffer_load_dwordx4 v13, s[20:23], s63 offen offset:3072 lds
    v_mfma_f32_16x16x32_bf16 a[92:95], v[52:55], v[124:127], a[92:95]
    s_waitcnt lgkmcnt(1)
    v_accvgpr_read_b32 v31, a175
    v_cvt_pk_bf16_f32 v35, v35, v31
    v_mfma_f32_16x16x32_bf16 a[96:99], v[56:59], v[96:99], a[96:99]
    v_accvgpr_write_b32 a168, 0
    v_accvgpr_write_b32 a169, 0
    v_mfma_f32_16x16x32_bf16 a[96:99], v[60:63], v[100:103], a[96:99]
    s_xor_b32 s63, s63, 128
    v_accvgpr_write_b32 a170, 0
    v_accvgpr_write_b32 a171, 0
    v_mfma_f32_16x16x32_bf16 a[100:103], v[56:59], v[104:107], a[100:103]
    buffer_store_dwordx4 v[32:35], v1, s[36:39], s72 offen sc1
    v_mfma_f32_16x16x32_bf16 a[100:103], v[60:63], v[108:111], a[100:103]
    v_accvgpr_write_b32 a172, 0
    v_accvgpr_write_b32 a173, 0
    v_mfma_f32_16x16x32_bf16 a[104:107], v[56:59], v[112:115], a[104:107]
    v_accvgpr_read_b32 v32, a176
    v_accvgpr_read_b32 v31, a177
    v_mfma_f32_16x16x32_bf16 a[104:107], v[60:63], v[116:119], a[104:107]
    s_waitcnt vmcnt(10) lgkmcnt(0)
    s_barrier
    ds_read_b64_tr_b16 v[48:49], v14 offset:0
    v_mfma_f32_16x16x32_bf16 a[108:111], v[56:59], v[120:123], a[108:111]
    s_add_u32 m0, s67, 98304
    ds_read_b64_tr_b16 v[50:51], v14 offset:1024
    ds_read_b64_tr_b16 v[52:53], v14 offset:8192
    v_mfma_f32_16x16x32_bf16 a[108:111], v[60:63], v[124:127], a[108:111]
    buffer_load_dwordx4 v1, s[28:31], s65 offen sc1 lds
    v_mfma_f32_16x16x32_bf16 a[112:115], v[40:43], v[96:99], a[112:115]
    ds_read_b64_tr_b16 v[54:55], v14 offset:9216
    ds_read_b64_tr_b16 v[56:57], v15 offset:0
    v_mfma_f32_16x16x32_bf16 a[112:115], v[44:47], v[100:103], a[112:115]
    ds_read_b64_tr_b16 v[58:59], v15 offset:1024
    ds_read_b64_tr_b16 v[60:61], v15 offset:8192
    v_mfma_f32_16x16x32_bf16 a[116:119], v[40:43], v[104:107], a[116:119]
    ds_read_b64_tr_b16 v[62:63], v15 offset:9216
    v_add_u32 v14, 0x10000, v14
    v_mfma_f32_16x16x32_bf16 a[116:119], v[44:47], v[108:111], a[116:119]
    v_add_u32 v15, 0x10000, v15
    v_cvt_pk_bf16_f32 v32, v32, v31
    v_mfma_f32_16x16x32_bf16 a[120:123], v[40:43], v[112:115], a[120:123]
    v_accvgpr_read_b32 v33, a178
    v_accvgpr_read_b32 v31, a179
    v_mfma_f32_16x16x32_bf16 a[120:123], v[44:47], v[116:119], a[120:123]
    v_cvt_pk_bf16_f32 v33, v33, v31
    v_accvgpr_read_b32 v34, a180
    v_mfma_f32_16x16x32_bf16 a[124:127], v[40:43], v[120:123], a[124:127]
    ds_read_b64_tr_b16 v[40:41], v16 offset:0
    ds_read_b64_tr_b16 v[42:43], v16 offset:1024
    v_mfma_f32_16x16x32_bf16 a[124:127], v[44:47], v[124:127], a[124:127]
    s_add_u32 s72, s71, 34816
    ds_read_b64_tr_b16 v[44:45], v16 offset:8192
    ds_read_b64_tr_b16 v[46:47], v16 offset:9216
    s_waitcnt lgkmcnt(4)
    v_mfma_f32_16x16x32_bf16 v[128:131], v[48:51], v[64:67], v[128:131]
    s_add_u32 s86, s101, 4096
    buffer_load_dwordx4 v1, s[28:31], s65 offen offset:1024 sc1 lds
    v_mfma_f32_16x16x32_bf16 v[128:131], v[52:55], v[68:71], v[128:131]
    s_mov_b32 s87, 3072
    v_add_u32 v24, 0xfffe0000, v24
    v_add_u32 v16, 0x10000, v16
    v_mfma_f32_16x16x32_bf16 v[132:135], v[48:51], v[72:75], v[132:135]
    s_sub_u32 s7, s101, 4096
    ds_read_b128 v[96:99], v24 offset:16384
    v_accvgpr_read_b32 v31, a181
    v_mfma_f32_16x16x32_bf16 v[132:135], v[52:55], v[76:79], v[132:135]
    s_mov_b32 s98, 0
    v_cvt_pk_bf16_f32 v34, v34, v31
    v_accvgpr_read_b32 v35, a182
    v_mfma_f32_16x16x32_bf16 v[136:139], v[48:51], v[80:83], v[136:139]
    s_mul_i32 s84, s101, 48
    v_accvgpr_read_b32 v31, a183
    v_cvt_pk_bf16_f32 v35, v35, v31
    v_mfma_f32_16x16x32_bf16 v[136:139], v[52:55], v[84:87], v[136:139]
    s_add_u32 s84, s84, 19922944
    buffer_store_dwordx4 v[32:35], v1, s[36:39], s72 offen sc1
    v_mfma_f32_16x16x32_bf16 v[140:143], v[48:51], v[88:91], v[140:143]
    s_mov_b32 s42, 21495808
    ds_read_b64_tr_b16 v[48:49], v17 offset:0
    ds_read_b64_tr_b16 v[50:51], v17 offset:1024
    v_mfma_f32_16x16x32_bf16 v[140:143], v[52:55], v[92:95], v[140:143]
    s_mov_b32 s43, 0x20000
    ds_read_b64_tr_b16 v[52:53], v17 offset:8192
    ds_read_b64_tr_b16 v[54:55], v17 offset:9216
    v_mfma_f32_16x16x32_bf16 v[144:147], v[56:59], v[64:67], v[144:147]
    v_add_u32 v17, 0x10000, v17
    v_accvgpr_write_b32 a174, 0
    v_mfma_f32_16x16x32_bf16 v[144:147], v[60:63], v[68:71], v[144:147]
    s_add_u32 m0, s69, 114688
    v_accvgpr_write_b32 a175, 0
    v_accvgpr_write_b32 a176, 0
    v_mfma_f32_16x16x32_bf16 v[148:151], v[56:59], v[72:75], v[148:151]
    s_xor_b32 s65, s65, 24576
    buffer_load_dwordx4 v10, s[20:23], s64 offen lds
    v_mfma_f32_16x16x32_bf16 v[148:151], v[60:63], v[76:79], v[148:151]
    s_cmp_eq_u32 s6, 7
    s_cselect_b32 s86, s101, s86
    s_cselect_b32 s87, 0, s87
    v_mfma_f32_16x16x32_bf16 v[152:155], v[56:59], v[80:83], v[152:155]
    v_add_u32 v25, 0xfffe0000, v25
    v_accvgpr_read_b32 v32, a184
    v_mfma_f32_16x16x32_bf16 v[152:155], v[60:63], v[84:87], v[152:155]
    ds_read_b128 v[100:103], v25 offset:16384
    v_accvgpr_read_b32 v31, a185
    v_mfma_f32_16x16x32_bf16 v[156:159], v[56:59], v[88:91], v[156:159]
    ds_read_b64_tr_b16 v[56:57], v18 offset:0
    ds_read_b64_tr_b16 v[58:59], v18 offset:1024
    v_mfma_f32_16x16x32_bf16 v[156:159], v[60:63], v[92:95], v[156:159]
    s_waitcnt lgkmcnt(3)
    ds_read_b64_tr_b16 v[60:61], v18 offset:8192
    ds_read_b64_tr_b16 v[62:63], v18 offset:9216
    v_mfma_f32_16x16x32_bf16 v[160:163], v[40:43], v[64:67], v[160:163]
    v_add_u32 v18, 0x10000, v18
    v_cvt_pk_bf16_f32 v32, v32, v31
    v_mfma_f32_16x16x32_bf16 v[160:163], v[44:47], v[68:71], v[160:163]
    v_accvgpr_read_b32 v33, a186
    v_accvgpr_read_b32 v31, a187
    v_mfma_f32_16x16x32_bf16 v[164:167], v[40:43], v[72:75], v[164:167]
    v_cvt_pk_bf16_f32 v33, v33, v31
    v_accvgpr_read_b32 v34, a188
    v_mfma_f32_16x16x32_bf16 v[164:167], v[44:47], v[76:79], v[164:167]
    v_accvgpr_read_b32 v31, a189
    v_cvt_pk_bf16_f32 v34, v34, v31
    v_mfma_f32_16x16x32_bf16 v[168:171], v[40:43], v[80:83], v[168:171]
    buffer_load_dwordx4 v11, s[20:23], s64 offen offset:1024 lds
    v_mfma_f32_16x16x32_bf16 v[168:171], v[44:47], v[84:87], v[168:171]
    v_accvgpr_read_b32 v35, a190
    v_accvgpr_read_b32 v31, a191
    v_mfma_f32_16x16x32_bf16 v[172:175], v[40:43], v[88:91], v[172:175]
    ds_read_b64_tr_b16 v[40:41], v19 offset:0
    ds_read_b64_tr_b16 v[42:43], v19 offset:1024
    v_mfma_f32_16x16x32_bf16 v[172:175], v[44:47], v[92:95], v[172:175]
    s_add_u32 s72, s71, 35840
    ds_read_b64_tr_b16 v[44:45], v19 offset:8192
    ds_read_b64_tr_b16 v[46:47], v19 offset:9216
    v_mfma_f32_16x16x32_bf16 v[176:179], v[48:51], v[64:67], v[176:179]
    ds_read_b128 v[104:107], v24 offset:24576
    v_add_u32 v19, 0x10000, v19
    v_mfma_f32_16x16x32_bf16 v[176:179], v[52:55], v[68:71], v[176:179]
    v_cvt_pk_bf16_f32 v35, v35, v31
    v_accvgpr_write_b32 a177, 0
    v_mfma_f32_16x16x32_bf16 v[180:183], v[48:51], v[72:75], v[180:183]
    buffer_store_dwordx4 v[32:35], v1, s[36:39], s72 offen sc1
    v_mfma_f32_16x16x32_bf16 v[180:183], v[52:55], v[76:79], v[180:183]
    s_cmp_eq_u32 s6, 0
    s_cselect_b32 s7, s101, s7
    s_cselect_b32 s98, 1073741824, s98
    v_mfma_f32_16x16x32_bf16 v[184:187], v[48:51], v[80:83], v[184:187]
    s_bitcmp1_b32 s4, 0
    s_cselect_b32 s86, s86, s7
    s_cselect_b32 s87, s87, s98
    v_mfma_f32_16x16x32_bf16 v[184:187], v[52:55], v[84:87], v[184:187]
    s_mul_i32 s7, s86, 48
    v_accvgpr_write_b32 a178, 0
    v_accvgpr_write_b32 a179, 0
    v_mfma_f32_16x16x32_bf16 v[188:191], v[48:51], v[88:91], v[188:191]
    s_add_u32 s87, s87, s7
    buffer_load_dwordx4 v12, s[20:23], s64 offen offset:2048 lds
    v_mfma_f32_16x16x32_bf16 v[188:191], v[52:55], v[92:95], v[188:191]
    s_and_b32 s7, s5, 24
    ds_read_b64_tr_b16 v[48:49], v20 offset:0
    ds_read_b64_tr_b16 v[50:51], v20 offset:1024
    s_waitcnt lgkmcnt(2)
    v_mfma_f32_16x16x32_bf16 v[192:195], v[56:59], v[64:67], v[192:195]
    s_add_u32 s7, s7, s6
    ds_read_b64_tr_b16 v[52:53], v20 offset:8192
    ds_read_b64_tr_b16 v[54:55], v20 offset:9216
    v_mfma_f32_16x16x32_bf16 v[192:195], v[60:63], v[68:71], v[192:195]
    s_bfe_u32 s98, s5, 0x20001
    v_add_u32 v20, 0x10000, v20
    v_accvgpr_write_b32 a180, 0
    v_mfma_f32_16x16x32_bf16 v[196:199], v[56:59], v[72:75], v[196:199]
    s_lshl2_add_u32 s7, s7, s98
    v_accvgpr_write_b32 a181, 0
    v_accvgpr_write_b32 a182, 0
    v_mfma_f32_16x16x32_bf16 v[196:199], v[60:63], v[76:79], v[196:199]
    s_mul_i32 s98, s7, 36864
    ds_read_b128 v[108:111], v25 offset:24576
    v_add_u32 v36, s98, v36
    v_mfma_f32_16x16x32_bf16 v[200:203], v[56:59], v[80:83], v[200:203]
    s_mul_hi_u32 s98, s8, 715827883
    v_accvgpr_read_b32 v32, a192
    v_accvgpr_read_b32 v31, a193
    v_mfma_f32_16x16x32_bf16 v[200:203], v[60:63], v[84:87], v[200:203]
    s_add_u32 s87, s87, 19922944
    v_cvt_pk_bf16_f32 v32, v32, v31
    v_accvgpr_read_b32 v33, a194
    v_mfma_f32_16x16x32_bf16 v[204:207], v[56:59], v[88:91], v[204:207]
    ds_read_b64_tr_b16 v[56:57], v21 offset:0
    ds_read_b64_tr_b16 v[58:59], v21 offset:1024
    v_mfma_f32_16x16x32_bf16 v[204:207], v[60:63], v[92:95], v[204:207]
    ds_read_b64_tr_b16 v[60:61], v21 offset:8192
    ds_read_b64_tr_b16 v[62:63], v21 offset:9216
    v_mfma_f32_16x16x32_bf16 v[208:211], v[40:43], v[64:67], v[208:211]
    buffer_load_dwordx4 v13, s[20:23], s64 offen offset:3072 lds
    v_mfma_f32_16x16x32_bf16 v[208:211], v[44:47], v[68:71], v[208:211]
    v_add_u32 v21, 0x10000, v21
    v_accvgpr_read_b32 v31, a195
    v_mfma_f32_16x16x32_bf16 v[212:215], v[40:43], v[72:75], v[212:215]
    v_cvt_pk_bf16_f32 v33, v33, v31
    v_accvgpr_read_b32 v34, a196
    v_mfma_f32_16x16x32_bf16 v[212:215], v[44:47], v[76:79], v[212:215]
    v_accvgpr_read_b32 v31, a197
    v_cvt_pk_bf16_f32 v34, v34, v31
    v_mfma_f32_16x16x32_bf16 v[216:219], v[40:43], v[80:83], v[216:219]
    v_accvgpr_read_b32 v35, a198
    v_accvgpr_read_b32 v31, a199
    v_mfma_f32_16x16x32_bf16 v[216:219], v[44:47], v[84:87], v[216:219]
    v_cvt_pk_bf16_f32 v35, v35, v31
    v_sub_u32 v39, v36, v39
    v_mfma_f32_16x16x32_bf16 v[220:223], v[40:43], v[88:91], v[220:223]
    ds_read_b64_tr_b16 v[40:41], v26 offset:32768
    ds_read_b64_tr_b16 v[42:43], v26 offset:33280
    v_mfma_f32_16x16x32_bf16 v[220:223], v[44:47], v[92:95], v[220:223]
    s_add_u32 s72, s71, 4096
    ds_read_b64_tr_b16 v[44:45], v26 offset:36864
    ds_read_b64_tr_b16 v[46:47], v26 offset:37376
    s_waitcnt lgkmcnt(4)
    v_mfma_f32_16x16x32_bf16 v[224:227], v[48:51], v[64:67], v[224:227]
    v_add_u32 v26, 0x10000, v26
    v_lshl_add_u32 v36, s100, 6, v36
    v_mfma_f32_16x16x32_bf16 v[224:227], v[52:55], v[68:71], v[224:227]
    s_xor_b32 s64, s64, 128
    buffer_store_dwordx4 v[32:35], v1, s[36:39], s72 offen sc1
    v_mfma_f32_16x16x32_bf16 v[228:231], v[48:51], v[72:75], v[228:231]
    s_cmp_eq_u32 s4, 3
    s_cselect_b32 s84, s84, 1073741824
    v_accvgpr_write_b32 a183, 0
    v_mfma_f32_16x16x32_bf16 v[228:231], v[52:55], v[76:79], v[228:231]
    s_sub_u32 s40, s56, 22020096
    s_subb_u32 s41, s57, 0
    v_accvgpr_write_b32 a184, 0
    v_mfma_f32_16x16x32_bf16 v[232:235], v[48:51], v[80:83], v[232:235]
    s_add_u32 s85, s84, 3072
    v_accvgpr_write_b32 a185, 0
    v_accvgpr_write_b32 a186, 0
    v_mfma_f32_16x16x32_bf16 v[232:235], v[52:55], v[84:87], v[232:235]
    s_add_u32 m0, s69, 131072
    v_accvgpr_write_b32 a187, 0
    v_accvgpr_write_b32 a188, 0
    v_mfma_f32_16x16x32_bf16 v[236:239], v[48:51], v[88:91], v[236:239]
    buffer_load_dwordx4 v2, s[24:27], s60 offen lds
    v_mfma_f32_16x16x32_bf16 v[236:239], v[52:55], v[92:95], v[236:239]
    ds_read_b64_tr_b16 v[48:49], v27 offset:32768
    ds_read_b64_tr_b16 v[50:51], v27 offset:33280
    v_mfma_f32_16x16x32_bf16 v[240:243], v[56:59], v[64:67], v[240:243]
    ds_read_b64_tr_b16 v[52:53], v27 offset:36864
    ds_read_b64_tr_b16 v[54:55], v27 offset:37376
    v_mfma_f32_16x16x32_bf16 v[240:243], v[60:63], v[68:71], v[240:243]
    buffer_load_dwordx4 v3, s[24:27], s60 offen offset:1024 lds
    v_mfma_f32_16x16x32_bf16 v[244:247], v[56:59], v[72:75], v[244:247]
    v_add_u32 v27, 0x10000, v27
    v_accvgpr_write_b32 a189, 0
    v_mfma_f32_16x16x32_bf16 v[244:247], v[60:63], v[76:79], v[244:247]
    v_accvgpr_write_b32 a190, 0
    v_accvgpr_write_b32 a191, 0
    v_mfma_f32_16x16x32_bf16 v[248:251], v[56:59], v[80:83], v[248:251]
    v_accvgpr_read_b32 v32, a200
    v_accvgpr_read_b32 v31, a201
    v_mfma_f32_16x16x32_bf16 v[248:251], v[60:63], v[84:87], v[248:251]
    buffer_load_dwordx4 v4, s[24:27], s60 offen offset:2048 lds
    v_mfma_f32_16x16x32_bf16 v[252:255], v[56:59], v[88:91], v[252:255]
    ds_read_b64_tr_b16 v[56:57], v28 offset:32768
    ds_read_b64_tr_b16 v[58:59], v28 offset:33280
    v_mfma_f32_16x16x32_bf16 v[252:255], v[60:63], v[92:95], v[252:255]
    s_waitcnt lgkmcnt(2)
    ds_read_b64_tr_b16 v[60:61], v28 offset:36864
    ds_read_b64_tr_b16 v[62:63], v28 offset:37376
    v_mfma_f32_16x16x32_bf16 a[64:67], v[40:43], v[64:67], a[64:67]
    buffer_load_dwordx4 v5, s[24:27], s60 offen offset:3072 lds
    v_mfma_f32_16x16x32_bf16 a[64:67], v[44:47], v[68:71], a[64:67]
    v_add_u32 v28, 0x10000, v28
    v_cvt_pk_bf16_f32 v32, v32, v31
    v_mfma_f32_16x16x32_bf16 a[68:71], v[40:43], v[72:75], a[68:71]
    ds_read_b128 v[112:115], v24 offset:49152
    v_accvgpr_read_b32 v33, a202
    v_mfma_f32_16x16x32_bf16 a[68:71], v[44:47], v[76:79], a[68:71]
    s_add_u32 m0, s69, 147456
    v_accvgpr_read_b32 v31, a203
    v_cvt_pk_bf16_f32 v33, v33, v31
    v_mfma_f32_16x16x32_bf16 a[72:75], v[40:43], v[80:83], a[72:75]
    s_xor_b32 s60, s60, 524288
    buffer_load_dwordx4 v10, s[20:23], s63 offen lds
    v_mfma_f32_16x16x32_bf16 a[72:75], v[44:47], v[84:87], a[72:75]
    ds_read_b128 v[116:119], v25 offset:49152
    v_accvgpr_read_b32 v34, a204
    v_mfma_f32_16x16x32_bf16 a[76:79], v[40:43], v[88:91], a[76:79]
    ds_read_b64_tr_b16 v[40:41], v29 offset:32768
    ds_read_b64_tr_b16 v[42:43], v29 offset:33280
    v_mfma_f32_16x16x32_bf16 a[76:79], v[44:47], v[92:95], a[76:79]
    s_add_u32 s72, s71, 5120
    buffer_load_dwordx4 v11, s[20:23], s63 offen offset:1024 lds
    v_mfma_f32_16x16x32_bf16 a[80:83], v[48:51], v[64:67], a[80:83]
    ds_read_b128 v[120:123], v24 offset:57344
    ds_read_b64_tr_b16 v[44:45], v29 offset:36864
    v_mfma_f32_16x16x32_bf16 a[80:83], v[52:55], v[68:71], a[80:83]
    ds_read_b64_tr_b16 v[46:47], v29 offset:37376
    v_add_u32 v29, 0x10000, v29
    v_mfma_f32_16x16x32_bf16 a[84:87], v[48:51], v[72:75], a[84:87]
    v_accvgpr_read_b32 v31, a205
    v_cvt_pk_bf16_f32 v34, v34, v31
    v_mfma_f32_16x16x32_bf16 a[84:87], v[52:55], v[76:79], a[84:87]
    buffer_load_dwordx4 v12, s[20:23], s63 offen offset:2048 lds
    v_mfma_f32_16x16x32_bf16 a[88:91], v[48:51], v[80:83], a[88:91]
    ds_read_b128 v[124:127], v25 offset:57344
    v_accvgpr_read_b32 v35, a206
    v_mfma_f32_16x16x32_bf16 a[88:91], v[52:55], v[84:87], a[88:91]
    v_accvgpr_read_b32 v31, a207
    v_cvt_pk_bf16_f32 v35, v35, v31
    v_mfma_f32_16x16x32_bf16 a[92:95], v[48:51], v[88:91], a[92:95]
    buffer_load_dwordx4 v13, s[20:23], s63 offen offset:3072 lds
    v_mfma_f32_16x16x32_bf16 a[92:95], v[52:55], v[92:95], a[92:95]
    s_waitcnt lgkmcnt(1)
    v_accvgpr_write_b32 a192, 0
    v_accvgpr_write_b32 a193, 0
    v_mfma_f32_16x16x32_bf16 a[96:99], v[56:59], v[64:67], a[96:99]
    v_accvgpr_write_b32 a194, 0
    v_accvgpr_write_b32 a195, 0
    v_mfma_f32_16x16x32_bf16 a[96:99], v[60:63], v[68:71], a[96:99]
    s_xor_b32 s63, s63, 1920
    v_accvgpr_write_b32 a196, 0
    v_accvgpr_write_b32 a197, 0
    v_mfma_f32_16x16x32_bf16 a[100:103], v[56:59], v[72:75], a[100:103]
    s_andn2_b32 s63, s63, 896
    buffer_store_dwordx4 v[32:35], v1, s[36:39], s72 offen sc1
    v_mfma_f32_16x16x32_bf16 a[100:103], v[60:63], v[76:79], a[100:103]
    v_accvgpr_write_b32 a198, 0
    v_accvgpr_write_b32 a199, 0
    v_mfma_f32_16x16x32_bf16 a[104:107], v[56:59], v[80:83], a[104:107]
    v_accvgpr_read_b32 v32, a208
    v_accvgpr_read_b32 v31, a209
    v_mfma_f32_16x16x32_bf16 a[104:107], v[60:63], v[84:87], a[104:107]
    s_waitcnt vmcnt(10) lgkmcnt(0)
    s_barrier
    ds_read_b64_tr_b16 v[48:49], v14 offset:0
    v_mfma_f32_16x16x32_bf16 a[108:111], v[56:59], v[88:91], a[108:111]
    s_add_u32 m0, s67, 0
    ds_read_b64_tr_b16 v[50:51], v14 offset:1024
    ds_read_b64_tr_b16 v[52:53], v14 offset:8192
    v_mfma_f32_16x16x32_bf16 a[108:111], v[60:63], v[92:95], a[108:111]
    buffer_load_dwordx4 v1, s[28:31], s65 offen sc1 lds
    v_mfma_f32_16x16x32_bf16 a[112:115], v[40:43], v[64:67], a[112:115]
    ds_read_b64_tr_b16 v[54:55], v14 offset:9216
    ds_read_b64_tr_b16 v[56:57], v15 offset:0
    v_mfma_f32_16x16x32_bf16 a[112:115], v[44:47], v[68:71], a[112:115]
    ds_read_b64_tr_b16 v[58:59], v15 offset:1024
    ds_read_b64_tr_b16 v[60:61], v15 offset:8192
    v_mfma_f32_16x16x32_bf16 a[116:119], v[40:43], v[72:75], a[116:119]
    ds_read_b64_tr_b16 v[62:63], v15 offset:9216
    v_add_u32 v14, 0x10000, v14
    v_mfma_f32_16x16x32_bf16 a[116:119], v[44:47], v[76:79], a[116:119]
    v_add_u32 v15, 0x10000, v15
    v_cvt_pk_bf16_f32 v32, v32, v31
    v_mfma_f32_16x16x32_bf16 a[120:123], v[40:43], v[80:83], a[120:123]
    v_accvgpr_read_b32 v33, a210
    v_accvgpr_read_b32 v31, a211
    v_mfma_f32_16x16x32_bf16 a[120:123], v[44:47], v[84:87], a[120:123]
    v_cvt_pk_bf16_f32 v33, v33, v31
    v_accvgpr_read_b32 v34, a212
    v_mfma_f32_16x16x32_bf16 a[124:127], v[40:43], v[88:91], a[124:127]
    ds_read_b64_tr_b16 v[40:41], v16 offset:0
    ds_read_b64_tr_b16 v[42:43], v16 offset:1024
    v_mfma_f32_16x16x32_bf16 a[124:127], v[44:47], v[92:95], a[124:127]
    s_add_u32 s72, s71, 36864
    ds_read_b64_tr_b16 v[44:45], v16 offset:8192
    ds_read_b64_tr_b16 v[46:47], v16 offset:9216
    s_waitcnt lgkmcnt(4)
    v_mfma_f32_16x16x32_bf16 v[128:131], v[48:51], v[96:99], v[128:131]
    buffer_load_dwordx4 v1, s[28:31], s65 offen offset:1024 sc1 lds
    v_mfma_f32_16x16x32_bf16 v[128:131], v[52:55], v[100:103], v[128:131]
    v_add_u32 v24, 0x10000, v24
    v_add_u32 v16, 0x10000, v16
    v_mfma_f32_16x16x32_bf16 v[132:135], v[48:51], v[104:107], v[132:135]
    ds_read_b128 v[64:67], v24 offset:16384
    v_accvgpr_read_b32 v31, a213
    v_mfma_f32_16x16x32_bf16 v[132:135], v[52:55], v[108:111], v[132:135]
    v_cvt_pk_bf16_f32 v34, v34, v31
    v_accvgpr_read_b32 v35, a214
    v_mfma_f32_16x16x32_bf16 v[136:139], v[48:51], v[112:115], v[136:139]
    v_accvgpr_read_b32 v31, a215
    v_cvt_pk_bf16_f32 v35, v35, v31
    v_mfma_f32_16x16x32_bf16 v[136:139], v[52:55], v[116:119], v[136:139]
    buffer_store_dwordx4 v[32:35], v1, s[36:39], s72 offen sc1
    v_mfma_f32_16x16x32_bf16 v[140:143], v[48:51], v[120:123], v[140:143]
    ds_read_b64_tr_b16 v[48:49], v17 offset:0
    ds_read_b64_tr_b16 v[50:51], v17 offset:1024
    v_mfma_f32_16x16x32_bf16 v[140:143], v[52:55], v[124:127], v[140:143]
    ds_read_b64_tr_b16 v[52:53], v17 offset:8192
    ds_read_b64_tr_b16 v[54:55], v17 offset:9216
    v_mfma_f32_16x16x32_bf16 v[144:147], v[56:59], v[96:99], v[144:147]
    v_add_u32 v17, 0x10000, v17
    v_accvgpr_write_b32 a200, 0
    v_mfma_f32_16x16x32_bf16 v[144:147], v[60:63], v[100:103], v[144:147]
    s_add_u32 m0, s69, 16384
    v_accvgpr_write_b32 a201, 0
    v_accvgpr_write_b32 a202, 0
    v_mfma_f32_16x16x32_bf16 v[148:151], v[56:59], v[104:107], v[148:151]
    s_xor_b32 s65, s65, 8192
    buffer_load_dwordx4 v10, s[20:23], s64 offen lds
    v_mfma_f32_16x16x32_bf16 v[148:151], v[60:63], v[108:111], v[148:151]
    v_accvgpr_write_b32 a203, 0
    v_accvgpr_write_b32 a204, 0
    v_mfma_f32_16x16x32_bf16 v[152:155], v[56:59], v[112:115], v[152:155]
    v_add_u32 v25, 0x10000, v25
    v_accvgpr_read_b32 v32, a216
    v_mfma_f32_16x16x32_bf16 v[152:155], v[60:63], v[116:119], v[152:155]
    ds_read_b128 v[68:71], v25 offset:16384
    v_accvgpr_read_b32 v31, a217
    v_mfma_f32_16x16x32_bf16 v[156:159], v[56:59], v[120:123], v[156:159]
    ds_read_b64_tr_b16 v[56:57], v18 offset:0
    ds_read_b64_tr_b16 v[58:59], v18 offset:1024
    v_mfma_f32_16x16x32_bf16 v[156:159], v[60:63], v[124:127], v[156:159]
    s_waitcnt lgkmcnt(3)
    ds_read_b64_tr_b16 v[60:61], v18 offset:8192
    ds_read_b64_tr_b16 v[62:63], v18 offset:9216
    v_mfma_f32_16x16x32_bf16 v[160:163], v[40:43], v[96:99], v[160:163]
    v_add_u32 v18, 0x10000, v18
    v_cvt_pk_bf16_f32 v32, v32, v31
    v_mfma_f32_16x16x32_bf16 v[160:163], v[44:47], v[100:103], v[160:163]
    v_accvgpr_read_b32 v33, a218
    v_accvgpr_read_b32 v31, a219
    v_mfma_f32_16x16x32_bf16 v[164:167], v[40:43], v[104:107], v[164:167]
    v_cvt_pk_bf16_f32 v33, v33, v31
    v_accvgpr_read_b32 v34, a220
    v_mfma_f32_16x16x32_bf16 v[164:167], v[44:47], v[108:111], v[164:167]
    v_accvgpr_read_b32 v31, a221
    v_cvt_pk_bf16_f32 v34, v34, v31
    v_mfma_f32_16x16x32_bf16 v[168:171], v[40:43], v[112:115], v[168:171]
    buffer_load_dwordx4 v11, s[20:23], s64 offen offset:1024 lds
    v_mfma_f32_16x16x32_bf16 v[168:171], v[44:47], v[116:119], v[168:171]
    v_accvgpr_read_b32 v35, a222
    v_accvgpr_read_b32 v31, a223
    v_mfma_f32_16x16x32_bf16 v[172:175], v[40:43], v[120:123], v[172:175]
    ds_read_b64_tr_b16 v[40:41], v19 offset:0
    ds_read_b64_tr_b16 v[42:43], v19 offset:1024
    v_mfma_f32_16x16x32_bf16 v[172:175], v[44:47], v[124:127], v[172:175]
    s_add_u32 s72, s71, 37888
    ds_read_b64_tr_b16 v[44:45], v19 offset:8192
    ds_read_b64_tr_b16 v[46:47], v19 offset:9216
    v_mfma_f32_16x16x32_bf16 v[176:179], v[48:51], v[96:99], v[176:179]
    ds_read_b128 v[72:75], v24 offset:24576
    v_add_u32 v19, 0x10000, v19
    v_mfma_f32_16x16x32_bf16 v[176:179], v[52:55], v[100:103], v[176:179]
    v_cvt_pk_bf16_f32 v35, v35, v31
    v_accvgpr_write_b32 a205, 0
    v_mfma_f32_16x16x32_bf16 v[180:183], v[48:51], v[104:107], v[180:183]
    buffer_store_dwordx4 v[32:35], v1, s[36:39], s72 offen sc1
    v_mfma_f32_16x16x32_bf16 v[180:183], v[52:55], v[108:111], v[180:183]
    v_accvgpr_write_b32 a206, 0
    v_accvgpr_write_b32 a207, 0
    v_mfma_f32_16x16x32_bf16 v[184:187], v[48:51], v[112:115], v[184:187]
    v_accvgpr_write_b32 a208, 0
    v_accvgpr_write_b32 a209, 0
    v_mfma_f32_16x16x32_bf16 v[184:187], v[52:55], v[116:119], v[184:187]
    v_accvgpr_write_b32 a210, 0
    v_accvgpr_write_b32 a211, 0
    v_mfma_f32_16x16x32_bf16 v[188:191], v[48:51], v[120:123], v[188:191]
    buffer_load_dwordx4 v12, s[20:23], s64 offen offset:2048 lds
    v_mfma_f32_16x16x32_bf16 v[188:191], v[52:55], v[124:127], v[188:191]
    s_waitcnt lgkmcnt(0)
    ds_read_b64_tr_b16 v[48:49], v20 offset:0
    ds_read_b64_tr_b16 v[50:51], v20 offset:1024
    v_mfma_f32_16x16x32_bf16 v[192:195], v[56:59], v[96:99], v[192:195]
    ds_read_b64_tr_b16 v[52:53], v20 offset:8192
    ds_read_b64_tr_b16 v[54:55], v20 offset:9216
    v_mfma_f32_16x16x32_bf16 v[192:195], v[60:63], v[100:103], v[192:195]
    v_add_u32 v20, 0x10000, v20
    v_accvgpr_write_b32 a212, 0
    v_mfma_f32_16x16x32_bf16 v[196:199], v[56:59], v[104:107], v[196:199]
    v_accvgpr_write_b32 a213, 0
    v_accvgpr_write_b32 a214, 0
    v_mfma_f32_16x16x32_bf16 v[196:199], v[60:63], v[108:111], v[196:199]
    ds_read_b128 v[76:79], v25 offset:24576
    v_accvgpr_write_b32 a215, 0
    v_mfma_f32_16x16x32_bf16 v[200:203], v[56:59], v[112:115], v[200:203]
    v_accvgpr_read_b32 v32, a224
    v_accvgpr_read_b32 v31, a225
    v_mfma_f32_16x16x32_bf16 v[200:203], v[60:63], v[116:119], v[200:203]
    v_cvt_pk_bf16_f32 v32, v32, v31
    v_accvgpr_read_b32 v33, a226
    v_mfma_f32_16x16x32_bf16 v[204:207], v[56:59], v[120:123], v[204:207]
    ds_read_b64_tr_b16 v[56:57], v21 offset:0
    ds_read_b64_tr_b16 v[58:59], v21 offset:1024
    v_mfma_f32_16x16x32_bf16 v[204:207], v[60:63], v[124:127], v[204:207]
    ds_read_b64_tr_b16 v[60:61], v21 offset:8192
    ds_read_b64_tr_b16 v[62:63], v21 offset:9216
    v_mfma_f32_16x16x32_bf16 v[208:211], v[40:43], v[96:99], v[208:211]
    buffer_load_dwordx4 v13, s[20:23], s64 offen offset:3072 lds
    v_mfma_f32_16x16x32_bf16 v[208:211], v[44:47], v[100:103], v[208:211]
    v_add_u32 v21, 0x10000, v21
    v_accvgpr_read_b32 v31, a227
    v_mfma_f32_16x16x32_bf16 v[212:215], v[40:43], v[104:107], v[212:215]
    v_cvt_pk_bf16_f32 v33, v33, v31
    v_accvgpr_read_b32 v34, a228
    v_mfma_f32_16x16x32_bf16 v[212:215], v[44:47], v[108:111], v[212:215]
    v_accvgpr_read_b32 v31, a229
    v_cvt_pk_bf16_f32 v34, v34, v31
    v_mfma_f32_16x16x32_bf16 v[216:219], v[40:43], v[112:115], v[216:219]
    v_accvgpr_read_b32 v35, a230
    v_accvgpr_read_b32 v31, a231
    v_mfma_f32_16x16x32_bf16 v[216:219], v[44:47], v[116:119], v[216:219]
    v_cvt_pk_bf16_f32 v35, v35, v31
    v_accvgpr_write_b32 a216, 0
    v_mfma_f32_16x16x32_bf16 v[220:223], v[40:43], v[120:123], v[220:223]
    ds_read_b64_tr_b16 v[40:41], v26 offset:32768
    ds_read_b64_tr_b16 v[42:43], v26 offset:33280
    v_mfma_f32_16x16x32_bf16 v[220:223], v[44:47], v[124:127], v[220:223]
    s_add_u32 s72, s71, 6144
    ds_read_b64_tr_b16 v[44:45], v26 offset:36864
    ds_read_b64_tr_b16 v[46:47], v26 offset:37376
    s_waitcnt lgkmcnt(4)
    v_mfma_f32_16x16x32_bf16 v[224:227], v[48:51], v[96:99], v[224:227]
    v_add_u32 v26, 0xffff0000, v26
    v_accvgpr_write_b32 a217, 0
    v_mfma_f32_16x16x32_bf16 v[224:227], v[52:55], v[100:103], v[224:227]
    s_xor_b32 s64, s64, 1920
    buffer_store_dwordx4 v[32:35], v1, s[36:39], s72 offen sc1
    v_mfma_f32_16x16x32_bf16 v[228:231], v[48:51], v[104:107], v[228:231]
    s_andn2_b32 s64, s64, 896
    v_accvgpr_write_b32 a218, 0
    v_accvgpr_write_b32 a219, 0
    v_mfma_f32_16x16x32_bf16 v[228:231], v[52:55], v[108:111], v[228:231]
    v_accvgpr_write_b32 a220, 0
    v_accvgpr_write_b32 a221, 0
    v_mfma_f32_16x16x32_bf16 v[232:235], v[48:51], v[112:115], v[232:235]
    v_accvgpr_write_b32 a222, 0
    v_accvgpr_write_b32 a223, 0
    v_mfma_f32_16x16x32_bf16 v[232:235], v[52:55], v[116:119], v[232:235]
    s_add_u32 m0, s69, 32768
    v_mfma_f32_16x16x32_bf16 v[236:239], v[48:51], v[120:123], v[236:239]
    buffer_load_dwordx4 v2, s[24:27], s60 offen lds
    v_mfma_f32_16x16x32_bf16 v[236:239], v[52:55], v[124:127], v[236:239]
    ds_read_b64_tr_b16 v[48:49], v27 offset:32768
    ds_read_b64_tr_b16 v[50:51], v27 offset:33280
    v_mfma_f32_16x16x32_bf16 v[240:243], v[56:59], v[96:99], v[240:243]
    ds_read_b64_tr_b16 v[52:53], v27 offset:36864
    ds_read_b64_tr_b16 v[54:55], v27 offset:37376
    v_mfma_f32_16x16x32_bf16 v[240:243], v[60:63], v[100:103], v[240:243]
    buffer_load_dwordx4 v3, s[24:27], s60 offen offset:1024 lds
    v_mfma_f32_16x16x32_bf16 v[244:247], v[56:59], v[104:107], v[244:247]
    v_add_u32 v27, 0xffff0000, v27
    v_mfma_f32_16x16x32_bf16 v[244:247], v[60:63], v[108:111], v[244:247]
    v_mfma_f32_16x16x32_bf16 v[248:251], v[56:59], v[112:115], v[248:251]
    v_accvgpr_read_b32 v32, a232
    v_accvgpr_read_b32 v31, a233
    v_mfma_f32_16x16x32_bf16 v[248:251], v[60:63], v[116:119], v[248:251]
    buffer_load_dwordx4 v4, s[24:27], s60 offen offset:2048 lds
    v_mfma_f32_16x16x32_bf16 v[252:255], v[56:59], v[120:123], v[252:255]
    ds_read_b64_tr_b16 v[56:57], v28 offset:32768
    ds_read_b64_tr_b16 v[58:59], v28 offset:33280
    v_mfma_f32_16x16x32_bf16 v[252:255], v[60:63], v[124:127], v[252:255]
    s_waitcnt lgkmcnt(2)
    ds_read_b64_tr_b16 v[60:61], v28 offset:36864
    ds_read_b64_tr_b16 v[62:63], v28 offset:37376
    v_mfma_f32_16x16x32_bf16 a[64:67], v[40:43], v[96:99], a[64:67]
    buffer_load_dwordx4 v5, s[24:27], s60 offen offset:3072 lds
    v_mfma_f32_16x16x32_bf16 a[64:67], v[44:47], v[100:103], a[64:67]
    v_add_u32 v28, 0xffff0000, v28
    v_cvt_pk_bf16_f32 v32, v32, v31
    v_mfma_f32_16x16x32_bf16 a[68:71], v[40:43], v[104:107], a[68:71]
    ds_read_b128 v[80:83], v24 offset:49152
    v_accvgpr_read_b32 v33, a234
    v_mfma_f32_16x16x32_bf16 a[68:71], v[44:47], v[108:111], a[68:71]
    s_xor_b32 s60, s60, 7864320
    v_accvgpr_read_b32 v31, a235
    v_cvt_pk_bf16_f32 v33, v33, v31
    v_mfma_f32_16x16x32_bf16 a[72:75], v[40:43], v[112:115], a[72:75]
    s_add_u32 m0, s69, 49152
    v_accvgpr_read_b32 v34, a236
    v_accvgpr_read_b32 v31, a237
    v_mfma_f32_16x16x32_bf16 a[72:75], v[44:47], v[116:119], a[72:75]
    s_andn2_b32 s60, s60, 3670016
    buffer_load_dwordx4 v10, s[20:23], s63 offen lds
    v_mfma_f32_16x16x32_bf16 a[76:79], v[40:43], v[120:123], a[76:79]
    ds_read_b128 v[84:87], v25 offset:49152
    ds_read_b64_tr_b16 v[40:41], v29 offset:32768
    v_mfma_f32_16x16x32_bf16 a[76:79], v[44:47], v[124:127], a[76:79]
    s_add_u32 s72, s71, 7168
    buffer_load_dwordx4 v11, s[20:23], s63 offen offset:1024 lds
    v_mfma_f32_16x16x32_bf16 a[80:83], v[48:51], v[96:99], a[80:83]
    ds_read_b128 v[88:91], v24 offset:57344
    ds_read_b64_tr_b16 v[42:43], v29 offset:33280
    v_mfma_f32_16x16x32_bf16 a[80:83], v[52:55], v[100:103], a[80:83]
    ds_read_b64_tr_b16 v[44:45], v29 offset:36864
    ds_read_b64_tr_b16 v[46:47], v29 offset:37376
    v_mfma_f32_16x16x32_bf16 a[84:87], v[48:51], v[104:107], a[84:87]
    v_add_u32 v29, 0xffff0000, v29
    v_cvt_pk_bf16_f32 v34, v34, v31
    v_mfma_f32_16x16x32_bf16 a[84:87], v[52:55], v[108:111], a[84:87]
    buffer_load_dwordx4 v12, s[20:23], s63 offen offset:2048 lds
    v_mfma_f32_16x16x32_bf16 a[88:91], v[48:51], v[112:115], a[88:91]
    ds_read_b128 v[92:95], v25 offset:57344
    v_accvgpr_read_b32 v35, a238
    v_mfma_f32_16x16x32_bf16 a[88:91], v[52:55], v[116:119], a[88:91]
    v_accvgpr_read_b32 v31, a239
    v_cvt_pk_bf16_f32 v35, v35, v31
    v_mfma_f32_16x16x32_bf16 a[92:95], v[48:51], v[120:123], a[92:95]
    buffer_load_dwordx4 v13, s[20:23], s63 offen offset:3072 lds
    v_mfma_f32_16x16x32_bf16 a[92:95], v[52:55], v[124:127], a[92:95]
    s_waitcnt lgkmcnt(1)
    v_mfma_f32_16x16x32_bf16 a[96:99], v[56:59], v[96:99], a[96:99]
    v_mfma_f32_16x16x32_bf16 a[96:99], v[60:63], v[100:103], a[96:99]
    s_xor_b32 s63, s63, 128
    v_mfma_f32_16x16x32_bf16 a[100:103], v[56:59], v[104:107], a[100:103]
    buffer_store_dwordx4 v[32:35], v1, s[36:39], s72 offen sc1
    v_mfma_f32_16x16x32_bf16 a[100:103], v[60:63], v[108:111], a[100:103]
    v_mfma_f32_16x16x32_bf16 a[104:107], v[56:59], v[112:115], a[104:107]
    v_accvgpr_read_b32 v32, a240
    v_accvgpr_read_b32 v31, a241
    v_mfma_f32_16x16x32_bf16 a[104:107], v[60:63], v[116:119], a[104:107]
    s_waitcnt vmcnt(10) lgkmcnt(0)
    s_barrier
    ds_read_b64_tr_b16 v[48:49], v14 offset:0
    v_mfma_f32_16x16x32_bf16 a[108:111], v[56:59], v[120:123], a[108:111]
    s_add_u32 m0, s69, 65536
    ds_read_b64_tr_b16 v[50:51], v14 offset:1024
    ds_read_b64_tr_b16 v[52:53], v14 offset:8192
    v_mfma_f32_16x16x32_bf16 a[108:111], v[60:63], v[124:127], a[108:111]
    buffer_load_dwordx4 v2, s[24:27], s60 offen lds
    v_mfma_f32_16x16x32_bf16 a[112:115], v[40:43], v[96:99], a[112:115]
    ds_read_b64_tr_b16 v[54:55], v14 offset:9216
    ds_read_b64_tr_b16 v[56:57], v15 offset:0
    v_mfma_f32_16x16x32_bf16 a[112:115], v[44:47], v[100:103], a[112:115]
    ds_read_b64_tr_b16 v[58:59], v15 offset:1024
    ds_read_b64_tr_b16 v[60:61], v15 offset:8192
    v_mfma_f32_16x16x32_bf16 a[116:119], v[40:43], v[104:107], a[116:119]
    ds_read_b64_tr_b16 v[62:63], v15 offset:9216
    v_add_u32 v14, 0xfffe0000, v14
    v_mfma_f32_16x16x32_bf16 a[116:119], v[44:47], v[108:111], a[116:119]
    v_add_u32 v15, 0xfffe0000, v15
    v_cvt_pk_bf16_f32 v32, v32, v31
    v_mfma_f32_16x16x32_bf16 a[120:123], v[40:43], v[112:115], a[120:123]
    v_accvgpr_read_b32 v33, a242
    v_accvgpr_read_b32 v31, a243
    v_mfma_f32_16x16x32_bf16 a[120:123], v[44:47], v[116:119], a[120:123]
    buffer_load_dwordx4 v3, s[24:27], s60 offen offset:1024 lds
    v_mfma_f32_16x16x32_bf16 a[124:127], v[40:43], v[120:123], a[124:127]
    ds_read_b64_tr_b16 v[40:41], v16 offset:0
    ds_read_b64_tr_b16 v[42:43], v16 offset:1024
    v_mfma_f32_16x16x32_bf16 a[124:127], v[44:47], v[124:127], a[124:127]
    s_add_u32 s72, s71, 38912
    ds_read_b64_tr_b16 v[44:45], v16 offset:8192
    ds_read_b64_tr_b16 v[46:47], v16 offset:9216
    s_waitcnt lgkmcnt(4)
    v_mfma_f32_16x16x32_bf16 v[128:131], v[48:51], v[64:67], v[128:131]
    v_add_u32 v16, 0xfffe0000, v16
    v_cvt_pk_bf16_f32 v33, v33, v31
    v_mfma_f32_16x16x32_bf16 v[128:131], v[52:55], v[68:71], v[128:131]
    v_add_u32 v24, 0x10000, v24
    v_accvgpr_read_b32 v34, a244
    v_mfma_f32_16x16x32_bf16 v[132:135], v[48:51], v[72:75], v[132:135]
    ds_read_b128 v[96:99], v24 offset:16384
    v_accvgpr_read_b32 v31, a245
    v_mfma_f32_16x16x32_bf16 v[132:135], v[52:55], v[76:79], v[132:135]
    v_cvt_pk_bf16_f32 v34, v34, v31
    v_accvgpr_read_b32 v35, a246
    v_mfma_f32_16x16x32_bf16 v[136:139], v[48:51], v[80:83], v[136:139]
    v_accvgpr_read_b32 v31, a247
    v_cvt_pk_bf16_f32 v35, v35, v31
    v_mfma_f32_16x16x32_bf16 v[136:139], v[52:55], v[84:87], v[136:139]
    buffer_load_dwordx4 v4, s[24:27], s60 offen offset:2048 lds
    v_mfma_f32_16x16x32_bf16 v[140:143], v[48:51], v[88:91], v[140:143]
    ds_read_b64_tr_b16 v[48:49], v17 offset:0
    ds_read_b64_tr_b16 v[50:51], v17 offset:1024
    v_mfma_f32_16x16x32_bf16 v[140:143], v[52:55], v[92:95], v[140:143]
    ds_read_b64_tr_b16 v[52:53], v17 offset:8192
    ds_read_b64_tr_b16 v[54:55], v17 offset:9216
    v_mfma_f32_16x16x32_bf16 v[144:147], v[56:59], v[64:67], v[144:147]
    v_add_u32 v17, 0xfffe0000, v17
    v_mov_b32 v2, v1
    v_mfma_f32_16x16x32_bf16 v[144:147], v[60:63], v[68:71], v[144:147]
    buffer_store_dwordx4 v[32:35], v1, s[36:39], s72 offen sc1
    v_mfma_f32_16x16x32_bf16 v[148:151], v[56:59], v[72:75], v[148:151]
    v_mfma_f32_16x16x32_bf16 v[148:151], v[60:63], v[76:79], v[148:151]
    v_mfma_f32_16x16x32_bf16 v[152:155], v[56:59], v[80:83], v[152:155]
    v_add_u32 v25, 0x10000, v25
    v_accvgpr_read_b32 v32, a248
    v_mfma_f32_16x16x32_bf16 v[152:155], v[60:63], v[84:87], v[152:155]
    buffer_load_dwordx4 v5, s[24:27], s60 offen offset:3072 lds
    v_mfma_f32_16x16x32_bf16 v[156:159], v[56:59], v[88:91], v[156:159]
    ds_read_b128 v[100:103], v25 offset:16384
    ds_read_b64_tr_b16 v[56:57], v18 offset:0
    v_mfma_f32_16x16x32_bf16 v[156:159], v[60:63], v[92:95], v[156:159]
    s_waitcnt lgkmcnt(2)
    ds_read_b64_tr_b16 v[58:59], v18 offset:1024
    ds_read_b64_tr_b16 v[60:61], v18 offset:8192
    v_mfma_f32_16x16x32_bf16 v[160:163], v[40:43], v[64:67], v[160:163]
    ds_read_b64_tr_b16 v[62:63], v18 offset:9216
    v_add_u32 v18, 0xfffe0000, v18
    v_mfma_f32_16x16x32_bf16 v[160:163], v[44:47], v[68:71], v[160:163]
    v_accvgpr_read_b32 v31, a249
    v_cvt_pk_bf16_f32 v32, v32, v31
    v_mfma_f32_16x16x32_bf16 v[164:167], v[40:43], v[72:75], v[164:167]
    v_accvgpr_read_b32 v33, a250
    v_accvgpr_read_b32 v31, a251
    v_mfma_f32_16x16x32_bf16 v[164:167], v[44:47], v[76:79], v[164:167]
    s_add_u32 m0, s69, 81920
    v_cvt_pk_bf16_f32 v33, v33, v31
    v_accvgpr_read_b32 v34, a252
    v_mfma_f32_16x16x32_bf16 v[168:171], v[40:43], v[80:83], v[168:171]
    s_xor_b32 s60, s60, 524288
    buffer_load_dwordx4 v10, s[20:23], s64 offen lds
    v_mfma_f32_16x16x32_bf16 v[168:171], v[44:47], v[84:87], v[168:171]
    s_mov_b32 s60, 131072
    v_accvgpr_read_b32 v31, a253
    v_cvt_pk_bf16_f32 v34, v34, v31
    v_mfma_f32_16x16x32_bf16 v[172:175], v[40:43], v[88:91], v[172:175]
    ds_read_b64_tr_b16 v[40:41], v19 offset:0
    ds_read_b64_tr_b16 v[42:43], v19 offset:1024
    v_mfma_f32_16x16x32_bf16 v[172:175], v[44:47], v[92:95], v[172:175]
    s_add_u32 s72, s71, 39936
    ds_read_b64_tr_b16 v[44:45], v19 offset:8192
    ds_read_b64_tr_b16 v[46:47], v19 offset:9216
    v_mfma_f32_16x16x32_bf16 v[176:179], v[48:51], v[64:67], v[176:179]
    ds_read_b128 v[104:107], v24 offset:24576
    v_add_u32 v19, 0xfffe0000, v19
    v_mfma_f32_16x16x32_bf16 v[176:179], v[52:55], v[68:71], v[176:179]
    v_accvgpr_read_b32 v35, a254
    v_accvgpr_read_b32 v31, a255
    v_mfma_f32_16x16x32_bf16 v[180:183], v[48:51], v[72:75], v[180:183]
    v_cvt_pk_bf16_f32 v35, v35, v31
    v_mov_b32 v31, 1
    v_mfma_f32_16x16x32_bf16 v[180:183], v[52:55], v[76:79], v[180:183]
    buffer_load_dwordx4 v11, s[20:23], s64 offen offset:1024 lds
    v_mfma_f32_16x16x32_bf16 v[184:187], v[48:51], v[80:83], v[184:187]
    buffer_store_dwordx4 v[32:35], v1, s[36:39], s72 offen sc1
    v_mfma_f32_16x16x32_bf16 v[184:187], v[52:55], v[84:87], v[184:187]
    v_add_u32 v11, s99, v39
    v_mfma_f32_16x16x32_bf16 v[188:191], v[48:51], v[88:91], v[188:191]
    s_mul_i32 s99, s98, 6
    ds_read_b64_tr_b16 v[48:49], v20 offset:0
    ds_read_b64_tr_b16 v[50:51], v20 offset:1024
    v_mfma_f32_16x16x32_bf16 v[188:191], v[52:55], v[92:95], v[188:191]
    s_sub_u32 s99, s8, s99
    ds_read_b64_tr_b16 v[52:53], v20 offset:8192
    ds_read_b64_tr_b16 v[54:55], v20 offset:9216
    s_waitcnt lgkmcnt(4)
    v_mfma_f32_16x16x32_bf16 v[192:195], v[56:59], v[64:67], v[192:195]
    s_mul_i32 s99, s99, 6
    v_add_u32 v20, 0xfffe0000, v20
    v_mfma_f32_16x16x32_bf16 v[192:195], v[60:63], v[68:71], v[192:195]
    s_lshl1_add_u32 s99, s4, s99
    v_mfma_f32_16x16x32_bf16 v[196:199], v[56:59], v[72:75], v[196:199]
    s_sub_u32 s99, s99, 2
    v_mfma_f32_16x16x32_bf16 v[196:199], v[60:63], v[76:79], v[196:199]
    s_lshl_b32 s8, s99, 5
    buffer_load_dwordx4 v12, s[20:23], s64 offen offset:2048 lds
    v_mfma_f32_16x16x32_bf16 v[200:203], v[56:59], v[80:83], v[200:203]
    s_lshr_b32 s99, s99, 1
    ds_read_b128 v[108:111], v25 offset:24576
    v_lshl_add_u32 v10, v38, 4, s8
    v_mfma_f32_16x16x32_bf16 v[200:203], v[60:63], v[84:87], v[200:203]
    s_lshr_b32 s8, s5, 3
    v_lshrrev_b32 v38, 3, v37
    v_mul_u32_u24 v39, 18, v38
    v_mfma_f32_16x16x32_bf16 v[204:207], v[56:59], v[88:91], v[204:207]
    s_mul_i32 s8, s8, 6
    ds_read_b64_tr_b16 v[56:57], v21 offset:0
    ds_read_b64_tr_b16 v[58:59], v21 offset:1024
    v_mfma_f32_16x16x32_bf16 v[204:207], v[60:63], v[92:95], v[204:207]
    ds_read_b64_tr_b16 v[60:61], v21 offset:8192
    ds_read_b64_tr_b16 v[62:63], v21 offset:9216
    v_mfma_f32_16x16x32_bf16 v[208:211], v[40:43], v[64:67], v[208:211]
    v_add_u32 v21, 0xfffe0000, v21
    v_and_b32 v38, 4, v37
    v_mfma_f32_16x16x32_bf16 v[208:211], v[44:47], v[68:71], v[208:211]
    s_cmp_lt_u32 s98, 5
    s_cselect_b32 s98, s98, 40
    v_lshl_add_u32 v39, v38, 1, v39
    v_mfma_f32_16x16x32_bf16 v[212:215], v[40:43], v[72:75], v[212:215]
    s_lshl1_add_u32 s9, s98, s9
    buffer_load_dwordx4 v13, s[20:23], s64 offen offset:3072 lds
    v_mfma_f32_16x16x32_bf16 v[212:215], v[44:47], v[76:79], v[212:215]
    s_mul_i32 s9, s9, 18
    v_lshrrev_b32 v38, 2, v37
    v_mul_u32_u24 v38, 36, v38
    v_mfma_f32_16x16x32_bf16 v[216:219], v[40:43], v[80:83], v[216:219]
    v_add_u32 v39, s9, v39
    v_add_u32 v38, s10, v38
    v_mfma_f32_16x16x32_bf16 v[216:219], v[44:47], v[84:87], v[216:219]
    s_cmp_eq_u32 s98, 4
    s_cselect_b64 vcc, -1, 0
    v_and_b32 v37, 3, v37
    v_mfma_f32_16x16x32_bf16 v[220:223], v[40:43], v[88:91], v[220:223]
    ds_read_b64_tr_b16 v[40:41], v26 offset:0
    ds_read_b64_tr_b16 v[42:43], v26 offset:512
    v_mfma_f32_16x16x32_bf16 v[220:223], v[44:47], v[92:95], v[220:223]
    s_waitcnt lgkmcnt(2)
    ds_read_b64_tr_b16 v[44:45], v26 offset:4096
    ds_read_b64_tr_b16 v[46:47], v26 offset:4608
    v_mfma_f32_16x16x32_bf16 v[224:227], v[48:51], v[64:67], v[224:227]
    v_add_u32 v26, 0x10000, v26
    v_cndmask_b32 v39, v39, v38, vcc
    v_mfma_f32_16x16x32_bf16 v[224:227], v[52:55], v[68:71], v[224:227]
    s_xor_b32 s64, s64, 128
    v_add_u32 v39, v39, v37
    v_mul_u32_u24 v39, 1152, v39
    v_mfma_f32_16x16x32_bf16 v[228:231], v[48:51], v[72:75], v[228:231]
    s_cmp_eq_u32 s98, 4
    s_cselect_b32 s9, 18, 4
    s_cselect_b32 s10, 2, 4
    v_mfma_f32_16x16x32_bf16 v[228:231], v[52:55], v[76:79], v[228:231]
    s_mul_i32 s9, s9, 1152
    v_add_u32 v39, v39, v10
    v_mov_b32 v38, 1073741824
    v_mfma_f32_16x16x32_bf16 v[232:235], v[48:51], v[80:83], v[232:235]
    s_add_u32 s98, s98, s8
    v_cmp_gt_u32 vcc, s10, v37
    v_lshrrev_b32 v37, 8, v1
    v_mfma_f32_16x16x32_bf16 v[232:235], v[52:55], v[84:87], v[232:235]
    s_add_u32 m0, s67, 98304
    v_cndmask_b32 v12, v38, v39, vcc
    v_add_u32 v38, 1024, v36
    v_mfma_f32_16x16x32_bf16 v[236:239], v[48:51], v[88:91], v[236:239]
    s_add_u32 s98, s98, 128
    buffer_load_dwordx4 v1, s[28:31], s65 offen sc1 lds
    v_mfma_f32_16x16x32_bf16 v[236:239], v[52:55], v[92:95], v[236:239]
    s_add_u32 s8, s100, 16
    ds_read_b64_tr_b16 v[48:49], v27 offset:0
    ds_read_b64_tr_b16 v[50:51], v27 offset:512
    v_mfma_f32_16x16x32_bf16 v[240:243], v[56:59], v[64:67], v[240:243]
    s_lshr_b32 s10, s5, 3
    ds_read_b64_tr_b16 v[52:53], v27 offset:4096
    ds_read_b64_tr_b16 v[54:55], v27 offset:4608
    v_mfma_f32_16x16x32_bf16 v[240:243], v[60:63], v[68:71], v[240:243]
    v_add_u32 v27, 0x10000, v27
    v_add_u32 v13, s9, v12
    v_mfma_f32_16x16x32_bf16 v[244:247], v[56:59], v[72:75], v[244:247]
    s_cmp_eq_u32 s4, 0
    s_cselect_b64 vcc, -1, 0
    v_cndmask_b32 v12, v12, v38, vcc
    v_mfma_f32_16x16x32_bf16 v[244:247], v[60:63], v[76:79], v[244:247]
    v_add_u32 v38, 19456, v36
    v_bfe_u32 v36, v1, 4, 4
    v_mfma_f32_16x16x32_bf16 v[248:251], v[56:59], v[80:83], v[248:251]
    s_cmp_eq_u32 s4, 0
    s_cselect_b64 vcc, -1, 0
    v_cndmask_b32 v13, v13, v38, vcc
    v_mfma_f32_16x16x32_bf16 v[248:251], v[60:63], v[84:87], v[248:251]
    s_cmp_eq_u32 s4, 0
    s_cselect_b32 s98, s7, s98
    s_cselect_b32 s99, s8, s99
    v_mfma_f32_16x16x32_bf16 v[252:255], v[56:59], v[88:91], v[252:255]
    s_lshr_b32 s9, s99, 2
    ds_read_b64_tr_b16 v[56:57], v28 offset:0
    ds_read_b64_tr_b16 v[58:59], v28 offset:512
    v_mfma_f32_16x16x32_bf16 v[252:255], v[60:63], v[92:95], v[252:255]
    s_sub_u32 s9, s9, s10
    ds_read_b64_tr_b16 v[60:61], v28 offset:4096
    ds_read_b64_tr_b16 v[62:63], v28 offset:4608
    s_waitcnt lgkmcnt(4)
    v_mfma_f32_16x16x32_bf16 a[64:67], v[40:43], v[64:67], a[64:67]
    s_lshr_b32 s92, s2, 3
    v_lshrrev_b32 v9, 4, v1
    v_min_u32 v9, 0, v9
    v_mfma_f32_16x16x32_bf16 a[64:67], v[44:47], v[68:71], a[64:67]
    s_lshl2_add_u32 s92, s92, s4
    v_add_u32 v24, 0xfffe0000, v24
    v_add_u32 v28, 0x10000, v28
    v_mfma_f32_16x16x32_bf16 a[68:71], v[40:43], v[72:75], a[68:71]
    s_mul_i32 s92, s92, 1
    ds_read_b128 v[112:115], v24 offset:16384
    v_lshlrev_b32 v37, 2, v37
    v_mfma_f32_16x16x32_bf16 a[68:71], v[44:47], v[76:79], a[68:71]
    s_add_u32 s92, s92, 32
    v_add_lshl_u32 v9, v9, s92, 7
    v_sub_u32 v36, v36, v37
    v_mfma_f32_16x16x32_bf16 a[72:75], v[40:43], v[80:83], a[72:75]
    s_sub_u32 s9, s9, 1
    v_add_u32 v25, 0xfffe0000, v25
    v_mov_b32 v37, 0xf149f2ca
    v_mfma_f32_16x16x32_bf16 a[72:75], v[44:47], v[84:87], a[72:75]
    s_getpc_b64 s[92:93]
    global_load_dword v9, v9, s[92:93]
    v_mfma_f32_16x16x32_bf16 a[76:79], v[40:43], v[88:91], a[76:79]
    s_and_b32 s9, s9, 3
    buffer_load_dwordx4 v1, s[28:31], s65 offen offset:1024 sc1 lds
    v_mfma_f32_16x16x32_bf16 a[76:79], v[44:47], v[92:95], a[76:79]
    s_lshl_b32 s9, s9, 1
    ds_read_b128 v[116:119], v25 offset:16384
    ds_read_b64_tr_b16 v[40:41], v29 offset:0
    v_mfma_f32_16x16x32_bf16 a[80:83], v[48:51], v[64:67], a[80:83]
    s_and_b32 s10, s99, 3
    ds_read_b128 v[120:123], v24 offset:24576
    v_bfe_u32 v38, v1, 4, 1
    v_mfma_f32_16x16x32_bf16 a[80:83], v[52:55], v[68:71], a[80:83]
    s_mul_i32 s10, s10, 9
    ds_read_b64_tr_b16 v[42:43], v29 offset:512
    ds_read_b64_tr_b16 v[44:45], v29 offset:4096
    v_mfma_f32_16x16x32_bf16 a[84:87], v[48:51], v[72:75], a[84:87]
    s_mul_i32 s98, s98, 36864
    ds_read_b64_tr_b16 v[46:47], v29 offset:4608
    v_add_u32 v29, 0x10000, v29
    v_mfma_f32_16x16x32_bf16 a[84:87], v[52:55], v[76:79], a[84:87]
    s_mul_i32 s7, s7, 36864
    ds_read_b128 v[124:127], v25 offset:24576
    v_sub_u32 v38, 0, v38
    v_mfma_f32_16x16x32_bf16 a[88:91], v[48:51], v[80:83], a[88:91]
    s_cmp_eq_u32 s9, 6
    s_cselect_b32 s9, 7, s9
    v_and_b32 v38, 0xaaaaaaaa, v38
    v_mfma_f32_16x16x32_bf16 a[88:91], v[52:55], v[84:87], a[88:91]
    s_add_u32 s9, s9, s10
    v_and_b32 v39, 0x40, v1
    v_mfma_f32_16x16x32_bf16 a[92:95], v[48:51], v[88:91], a[92:95]
    s_lshl_b32 s64, s9, 10
    v_mfma_f32_16x16x32_bf16 a[92:95], v[52:55], v[92:95], a[92:95]
    s_sub_u32 s9, s99, 16
    s_waitcnt lgkmcnt(1)
    v_mfma_f32_16x16x32_bf16 a[96:99], v[56:59], v[64:67], a[96:99]
    s_mul_i32 s9, s9, 18432
    v_mfma_f32_16x16x32_bf16 a[96:99], v[60:63], v[68:71], a[96:99]
    s_xor_b32 s65, s65, 122880
    v_mfma_f32_16x16x32_bf16 a[100:103], v[56:59], v[72:75], a[100:103]
    s_andn2_b32 s65, s65, 57344
    v_mfma_f32_16x16x32_bf16 a[100:103], v[60:63], v[76:79], a[100:103]
    s_add_u32 s9, s9, 6144
    v_mfma_f32_16x16x32_bf16 a[104:107], v[56:59], v[80:83], a[104:107]
    s_mov_b32 s10, 1024
    v_mfma_f32_16x16x32_bf16 a[104:107], v[60:63], v[84:87], a[104:107]
    s_waitcnt vmcnt(3) lgkmcnt(0)
    s_barrier
    ds_read_b64_tr_b16 v[48:49], v14 offset:32768
    v_mfma_f32_16x16x32_bf16 a[108:111], v[56:59], v[88:91], a[108:111]
    s_add_u32 m0, s67, 131072
    buffer_store_dword v31, v30, s[32:35], s101 offen sc1
    v_mfma_f32_16x16x32_bf16 a[108:111], v[60:63], v[92:95], a[108:111]
    s_mov_b32 s93, 65536
    buffer_load_dwordx4 v1, s[28:31], s65 offen sc1 lds
    v_mfma_f32_16x16x32_bf16 a[112:115], v[40:43], v[64:67], a[112:115]
    ds_read_b64_tr_b16 v[50:51], v14 offset:33792
    ds_read_b64_tr_b16 v[52:53], v14 offset:40960
    v_mfma_f32_16x16x32_bf16 a[112:115], v[44:47], v[68:71], a[112:115]
    ds_read_b64_tr_b16 v[54:55], v14 offset:41984
    ds_read_b64_tr_b16 v[56:57], v15 offset:32768
    v_mfma_f32_16x16x32_bf16 a[116:119], v[40:43], v[72:75], a[116:119]
    ds_read_b64_tr_b16 v[58:59], v15 offset:33792
    ds_read_b64_tr_b16 v[60:61], v15 offset:40960
    v_mfma_f32_16x16x32_bf16 a[116:119], v[44:47], v[76:79], a[116:119]
    ds_read_b64_tr_b16 v[62:63], v15 offset:41984
    v_add_u32 v14, 0x10000, v14
    v_mfma_f32_16x16x32_bf16 a[120:123], v[40:43], v[80:83], a[120:123]
    v_add_u32 v15, 0x10000, v15
    v_mfma_f32_16x16x32_bf16 a[120:123], v[44:47], v[84:87], a[120:123]
    s_cmp_lt_u32 s99, 16
    s_cselect_b32 s64, s64, s9
    s_cselect_b32 s10, s10, 9216
    v_mfma_f32_16x16x32_bf16 a[124:127], v[40:43], v[88:91], a[124:127]
    s_lshl2_add_u32 s99, s100, s4
    ds_read_b64_tr_b16 v[40:41], v16 offset:32768
    ds_read_b64_tr_b16 v[42:43], v16 offset:33792
    v_mfma_f32_16x16x32_bf16 a[124:127], v[44:47], v[92:95], a[124:127]
    s_add_u32 s64, s64, s98
    ds_read_b64_tr_b16 v[44:45], v16 offset:40960
    ds_read_b64_tr_b16 v[46:47], v16 offset:41984
    s_waitcnt lgkmcnt(5)
    v_mfma_f32_16x16x32_bf16 v[128:131], v[48:51], v[96:99], v[128:131]
    s_lshl_b32 s99, s99, 1
    v_add_u32 v16, 0x10000, v16
    v_mfma_f32_16x16x32_bf16 v[128:131], v[52:55], v[100:103], v[128:131]
    s_add_u32 s62, s64, s10
    v_mfma_f32_16x16x32_bf16 v[132:135], v[48:51], v[104:107], v[132:135]
    s_lshr_b32 s9, s99, 2
    ds_read_b128 v[64:67], v24 offset:49152
    v_mfma_f32_16x16x32_bf16 v[132:135], v[52:55], v[108:111], v[132:135]
    s_lshr_b32 s10, s5, 3
    v_mfma_f32_16x16x32_bf16 v[136:139], v[48:51], v[112:115], v[136:139]
    s_sub_u32 s9, s9, s10
    v_mfma_f32_16x16x32_bf16 v[136:139], v[52:55], v[116:119], v[136:139]
    s_sub_u32 s9, s9, 1
    v_mfma_f32_16x16x32_bf16 v[140:143], v[48:51], v[120:123], v[140:143]
    s_and_b32 s9, s9, 3
    ds_read_b64_tr_b16 v[48:49], v17 offset:32768
    ds_read_b64_tr_b16 v[50:51], v17 offset:33792
    v_mfma_f32_16x16x32_bf16 v[140:143], v[52:55], v[124:127], v[140:143]
    s_lshl_b32 s9, s9, 1
    ds_read_b64_tr_b16 v[52:53], v17 offset:40960
    ds_read_b64_tr_b16 v[54:55], v17 offset:41984
    v_mfma_f32_16x16x32_bf16 v[144:147], v[56:59], v[96:99], v[144:147]
    s_and_b32 s10, s99, 3
    ds_read_b128 v[68:71], v25 offset:49152
    v_add_u32 v17, 0x10000, v17
    s_waitcnt lgkmcnt(5)
    v_mfma_f32_16x16x32_bf16 v[144:147], v[60:63], v[100:103], v[144:147]
    s_cmp_eq_u32 s9, 6
    s_cselect_b32 s9, 7, s9
    v_mfma_f32_16x16x32_bf16 v[148:151], v[56:59], v[104:107], v[148:151]
    s_mul_i32 s10, s10, 9
    v_mfma_f32_16x16x32_bf16 v[148:151], v[60:63], v[108:111], v[148:151]
    s_add_u32 s9, s9, s10
    v_mfma_f32_16x16x32_bf16 v[152:155], v[56:59], v[112:115], v[152:155]
    s_lshl_b32 s63, s9, 10
    v_mfma_f32_16x16x32_bf16 v[152:155], v[60:63], v[116:119], v[152:155]
    s_cmp_eq_u32 s4, 0
    s_cselect_b32 s8, 1.0, 0
    v_mfma_f32_16x16x32_bf16 v[156:159], v[56:59], v[120:123], v[156:159]
    s_add_u32 s63, s63, s7
    ds_read_b128 v[72:75], v24 offset:57344
    ds_read_b64_tr_b16 v[56:57], v18 offset:32768
    v_mfma_f32_16x16x32_bf16 v[156:159], v[60:63], v[124:127], v[156:159]
    ds_read_b64_tr_b16 v[58:59], v18 offset:33792
    ds_read_b64_tr_b16 v[60:61], v18 offset:40960
    v_mfma_f32_16x16x32_bf16 v[160:163], v[40:43], v[96:99], v[160:163]
    ds_read_b64_tr_b16 v[62:63], v18 offset:41984
    v_add_u32 v18, 0x10000, v18
    v_mfma_f32_16x16x32_bf16 v[160:163], v[44:47], v[100:103], v[160:163]
    s_cmp_eq_u32 s4, 1
    s_cselect_b32 s9, 1.0, 0
    v_mfma_f32_16x16x32_bf16 v[164:167], v[40:43], v[104:107], v[164:167]
    s_cmp_eq_u32 s6, 0
    s_cselect_b32 s16, s8, 0
    s_cselect_b32 s17, s9, 0
    v_mfma_f32_16x16x32_bf16 v[164:167], v[44:47], v[108:111], v[164:167]
    s_cmp_eq_u32 s4, 2
    s_cselect_b32 s10, 1.0, 0
    v_mfma_f32_16x16x32_bf16 v[168:171], v[40:43], v[112:115], v[168:171]
    buffer_load_dwordx4 v1, s[28:31], s65 offen offset:1024 sc1 lds
    v_mfma_f32_16x16x32_bf16 v[168:171], v[44:47], v[116:119], v[168:171]
    ds_read_b128 v[76:79], v25 offset:57344
    v_mfma_f32_16x16x32_bf16 v[172:175], v[40:43], v[120:123], v[172:175]
    ds_read_b64_tr_b16 v[40:41], v19 offset:32768
    ds_read_b64_tr_b16 v[42:43], v19 offset:33792
    v_mfma_f32_16x16x32_bf16 v[172:175], v[44:47], v[124:127], v[172:175]
    s_waitcnt lgkmcnt(3)
    ds_read_b64_tr_b16 v[44:45], v19 offset:40960
    ds_read_b64_tr_b16 v[46:47], v19 offset:41984
    v_mfma_f32_16x16x32_bf16 v[176:179], v[48:51], v[96:99], v[176:179]
    v_add_u32 v19, 0x10000, v19
    v_mfma_f32_16x16x32_bf16 v[176:179], v[52:55], v[100:103], v[176:179]
    s_cmp_eq_u32 s6, 0
    s_cselect_b32 s18, s10, 0
    s_cselect_b32 s19, s11, 0
    v_mfma_f32_16x16x32_bf16 v[180:183], v[48:51], v[104:107], v[180:183]
    s_cmp_eq_u32 s6, 0
    s_cselect_b32 s20, s12, 0
    s_cselect_b32 s21, s13, 0
    v_mfma_f32_16x16x32_bf16 v[180:183], v[52:55], v[108:111], v[180:183]
    v_add_u32 v24, 0x10000, v24
    v_mfma_f32_16x16x32_bf16 v[184:187], v[48:51], v[112:115], v[184:187]
    ds_read_b128 v[80:83], v24 offset:16384
    v_mfma_f32_16x16x32_bf16 v[184:187], v[52:55], v[116:119], v[184:187]
    s_cmp_eq_u32 s6, 0
    s_cselect_b32 s22, s14, 0
    s_cselect_b32 s23, s15, 0
    v_mfma_f32_16x16x32_bf16 v[188:191], v[48:51], v[120:123], v[188:191]
    ds_read_b64_tr_b16 v[48:49], v20 offset:32768
    ds_read_b64_tr_b16 v[50:51], v20 offset:33792
    v_mfma_f32_16x16x32_bf16 v[188:191], v[52:55], v[124:127], v[188:191]
    ds_read_b64_tr_b16 v[52:53], v20 offset:40960
    ds_read_b64_tr_b16 v[54:55], v20 offset:41984
    v_mfma_f32_16x16x32_bf16 v[192:195], v[56:59], v[96:99], v[192:195]
    v_add_u32 v20, 0x10000, v20
    v_mfma_f32_16x16x32_bf16 v[192:195], v[60:63], v[100:103], v[192:195]
    v_add_u32 v25, 0x10000, v25
    v_mfma_f32_16x16x32_bf16 v[196:199], v[56:59], v[104:107], v[196:199]
    ds_read_b128 v[84:87], v25 offset:16384
    v_mfma_f32_16x16x32_bf16 v[196:199], v[60:63], v[108:111], v[196:199]
    v_mfma_f32_16x16x32_bf16 v[200:203], v[56:59], v[112:115], v[200:203]
    v_mfma_f32_16x16x32_bf16 v[200:203], v[60:63], v[116:119], v[200:203]
    v_mfma_f32_16x16x32_bf16 v[204:207], v[56:59], v[120:123], v[204:207]
    ds_read_b64_tr_b16 v[56:57], v21 offset:32768
    ds_read_b64_tr_b16 v[58:59], v21 offset:33792
    v_mfma_f32_16x16x32_bf16 v[204:207], v[60:63], v[124:127], v[204:207]
    s_waitcnt lgkmcnt(2)
    ds_read_b64_tr_b16 v[60:61], v21 offset:40960
    ds_read_b64_tr_b16 v[62:63], v21 offset:41984
    v_mfma_f32_16x16x32_bf16 v[208:211], v[40:43], v[96:99], v[208:211]
    ds_read_b128 v[88:91], v24 offset:24576
    v_add_u32 v21, 0x10000, v21
    v_mfma_f32_16x16x32_bf16 v[208:211], v[44:47], v[100:103], v[208:211]
    v_mfma_f32_16x16x32_bf16 v[212:215], v[40:43], v[104:107], v[212:215]
    v_mfma_f32_16x16x32_bf16 v[212:215], v[44:47], v[108:111], v[212:215]
    v_mfma_f32_16x16x32_bf16 v[216:219], v[40:43], v[112:115], v[216:219]
    v_mfma_f32_16x16x32_bf16 v[216:219], v[44:47], v[116:119], v[216:219]
    v_mfma_f32_16x16x32_bf16 v[220:223], v[40:43], v[120:123], v[220:223]
    ds_read_b128 v[92:95], v25 offset:24576
    ds_read_b64_tr_b16 v[40:41], v14 offset:0
    v_mfma_f32_16x16x32_bf16 v[220:223], v[44:47], v[124:127], v[220:223]
    ds_read_b64_tr_b16 v[42:43], v14 offset:1024
    ds_read_b64_tr_b16 v[44:45], v14 offset:8192
    v_mfma_f32_16x16x32_bf16 v[224:227], v[48:51], v[96:99], v[224:227]
    ds_read_b64_tr_b16 v[46:47], v14 offset:9216
    v_mfma_f32_16x16x32_bf16 v[224:227], v[52:55], v[100:103], v[224:227]
    s_xor_b32 s65, s65, 8192
    v_mfma_f32_16x16x32_bf16 v[228:231], v[48:51], v[104:107], v[228:231]
    v_mfma_f32_16x16x32_bf16 v[228:231], v[52:55], v[108:111], v[228:231]
    v_mfma_f32_16x16x32_bf16 v[232:235], v[48:51], v[112:115], v[232:235]
    v_mfma_f32_16x16x32_bf16 v[232:235], v[52:55], v[116:119], v[232:235]
    v_mfma_f32_16x16x32_bf16 v[236:239], v[48:51], v[120:123], v[236:239]
    ds_read_b64_tr_b16 v[48:49], v15 offset:0
    ds_read_b64_tr_b16 v[50:51], v15 offset:1024
    v_mfma_f32_16x16x32_bf16 v[236:239], v[52:55], v[124:127], v[236:239]
    s_waitcnt lgkmcnt(2)
    ds_read_b64_tr_b16 v[52:53], v15 offset:8192
    ds_read_b64_tr_b16 v[54:55], v15 offset:9216
    v_mfma_f32_16x16x32_bf16 v[240:243], v[56:59], v[96:99], v[240:243]
    v_mfma_f32_16x16x32_bf16 v[240:243], v[60:63], v[100:103], v[240:243]
    v_mfma_f32_16x16x32_bf16 v[244:247], v[56:59], v[104:107], v[244:247]
    v_mfma_f32_16x16x32_bf16 v[244:247], v[60:63], v[108:111], v[244:247]
    v_mfma_f32_16x16x32_bf16 v[248:251], v[56:59], v[112:115], v[248:251]
    v_mfma_f32_16x16x32_bf16 v[248:251], v[60:63], v[116:119], v[248:251]
    v_mfma_f32_16x16x32_bf16 v[252:255], v[56:59], v[120:123], v[252:255]
    ds_read_b64_tr_b16 v[56:57], v16 offset:0
    ds_read_b64_tr_b16 v[58:59], v16 offset:1024
    v_mfma_f32_16x16x32_bf16 v[252:255], v[60:63], v[124:127], v[252:255]
    buffer_load_dword v7, v8, s[32:35], s61 offen sc1
    v_mfma_f32_16x16x32_bf16 v[128:131], v[40:43], v[64:67], v[128:131]
    ds_read_b64_tr_b16 v[60:61], v16 offset:8192
    ds_read_b64_tr_b16 v[62:63], v16 offset:9216
    v_mfma_f32_16x16x32_bf16 v[128:131], v[44:47], v[68:71], v[128:131]
    v_mfma_f32_16x16x32_bf16 v[132:135], v[40:43], v[72:75], v[132:135]
    v_mfma_f32_16x16x32_bf16 v[132:135], v[44:47], v[76:79], v[132:135]
    v_mfma_f32_16x16x32_bf16 v[136:139], v[40:43], v[80:83], v[136:139]
    v_mfma_f32_16x16x32_bf16 v[136:139], v[44:47], v[84:87], v[136:139]
    v_mfma_f32_16x16x32_bf16 v[140:143], v[40:43], v[88:91], v[140:143]
    ds_read_b64_tr_b16 v[40:41], v17 offset:0
    ds_read_b64_tr_b16 v[42:43], v17 offset:1024
    v_mfma_f32_16x16x32_bf16 v[140:143], v[44:47], v[92:95], v[140:143]
    s_waitcnt lgkmcnt(2)
    ds_read_b64_tr_b16 v[44:45], v17 offset:8192
    ds_read_b64_tr_b16 v[46:47], v17 offset:9216
    v_mfma_f32_16x16x32_bf16 v[144:147], v[48:51], v[64:67], v[144:147]
    v_cvt_pk_bf16_f32 v128, v128, v129
    v_cvt_pk_bf16_f32 v129, v130, v131
    v_mfma_f32_16x16x32_bf16 v[144:147], v[52:55], v[68:71], v[144:147]
    v_cvt_pk_bf16_f32 v132, v132, v133
    v_cvt_pk_bf16_f32 v133, v134, v135
    v_mfma_f32_16x16x32_bf16 v[148:151], v[48:51], v[72:75], v[148:151]
    v_cvt_pk_bf16_f32 v136, v136, v137
    v_cvt_pk_bf16_f32 v137, v138, v139
    v_mfma_f32_16x16x32_bf16 v[148:151], v[52:55], v[76:79], v[148:151]
    v_cvt_pk_bf16_f32 v140, v140, v141
    v_cvt_pk_bf16_f32 v141, v142, v143
    v_mfma_f32_16x16x32_bf16 v[152:155], v[48:51], v[80:83], v[152:155]
    v_cvt_pk_bf16_f32 v130, v144, v145
    v_cvt_pk_bf16_f32 v131, v146, v147
    v_mfma_f32_16x16x32_bf16 v[152:155], v[52:55], v[84:87], v[152:155]
    v_mfma_f32_16x16x32_bf16 v[156:159], v[48:51], v[88:91], v[156:159]
    ds_read_b64_tr_b16 v[48:49], v18 offset:0
    ds_read_b64_tr_b16 v[50:51], v18 offset:1024
    v_mfma_f32_16x16x32_bf16 v[156:159], v[52:55], v[92:95], v[156:159]
    ds_read_b64_tr_b16 v[52:53], v18 offset:8192
    ds_read_b64_tr_b16 v[54:55], v18 offset:9216
    v_mfma_f32_16x16x32_bf16 v[160:163], v[56:59], v[64:67], v[160:163]
    v_cvt_pk_bf16_f32 v134, v148, v149
    v_cvt_pk_bf16_f32 v135, v150, v151
    v_mfma_f32_16x16x32_bf16 v[160:163], v[60:63], v[68:71], v[160:163]
    v_cvt_pk_bf16_f32 v138, v152, v153
    v_cvt_pk_bf16_f32 v139, v154, v155
    v_mfma_f32_16x16x32_bf16 v[164:167], v[56:59], v[72:75], v[164:167]
    v_cvt_pk_bf16_f32 v142, v156, v157
    v_cvt_pk_bf16_f32 v143, v158, v159
    v_mfma_f32_16x16x32_bf16 v[164:167], v[60:63], v[76:79], v[164:167]
    v_mfma_f32_16x16x32_bf16 v[168:171], v[56:59], v[80:83], v[168:171]
    v_mfma_f32_16x16x32_bf16 v[168:171], v[60:63], v[84:87], v[168:171]
    v_cvt_pk_bf16_f32 v160, v160, v161
    v_cvt_pk_bf16_f32 v161, v162, v163
    v_mfma_f32_16x16x32_bf16 v[172:175], v[56:59], v[88:91], v[172:175]
    ds_read_b64_tr_b16 v[56:57], v19 offset:0
    ds_read_b64_tr_b16 v[58:59], v19 offset:1024
    v_mfma_f32_16x16x32_bf16 v[172:175], v[60:63], v[92:95], v[172:175]
    s_waitcnt lgkmcnt(2)
    ds_read_b64_tr_b16 v[60:61], v19 offset:8192
    ds_read_b64_tr_b16 v[62:63], v19 offset:9216
    v_mfma_f32_16x16x32_bf16 v[176:179], v[40:43], v[64:67], v[176:179]
    v_cvt_pk_bf16_f32 v164, v164, v165
    v_cvt_pk_bf16_f32 v165, v166, v167
    v_mfma_f32_16x16x32_bf16 v[176:179], v[44:47], v[68:71], v[176:179]
    v_cvt_pk_bf16_f32 v168, v168, v169
    v_cvt_pk_bf16_f32 v169, v170, v171
    v_mfma_f32_16x16x32_bf16 v[180:183], v[40:43], v[72:75], v[180:183]
    v_cvt_pk_bf16_f32 v172, v172, v173
    v_cvt_pk_bf16_f32 v173, v174, v175
    v_mfma_f32_16x16x32_bf16 v[180:183], v[44:47], v[76:79], v[180:183]
    v_mfma_f32_16x16x32_bf16 v[184:187], v[40:43], v[80:83], v[184:187]
    v_mfma_f32_16x16x32_bf16 v[184:187], v[44:47], v[84:87], v[184:187]
    v_cvt_pk_bf16_f32 v162, v176, v177
    v_cvt_pk_bf16_f32 v163, v178, v179
    v_mfma_f32_16x16x32_bf16 v[188:191], v[40:43], v[88:91], v[188:191]
    ds_read_b64_tr_b16 v[40:41], v20 offset:0
    ds_read_b64_tr_b16 v[42:43], v20 offset:1024
    v_mfma_f32_16x16x32_bf16 v[188:191], v[44:47], v[92:95], v[188:191]
    ds_read_b64_tr_b16 v[44:45], v20 offset:8192
    ds_read_b64_tr_b16 v[46:47], v20 offset:9216
    v_mfma_f32_16x16x32_bf16 v[192:195], v[48:51], v[64:67], v[192:195]
    v_cvt_pk_bf16_f32 v166, v180, v181
    v_cvt_pk_bf16_f32 v167, v182, v183
    v_mfma_f32_16x16x32_bf16 v[192:195], v[52:55], v[68:71], v[192:195]
    v_cvt_pk_bf16_f32 v170, v184, v185
    v_cvt_pk_bf16_f32 v171, v186, v187
    s_waitcnt vmcnt(0)
    v_cmp_gt_u32 vcc, 1, v7
    s_nop 1
    s_and_b64 vcc, vcc, exec
    s_cbranch_scc1 SPIN_KV
BACK_KV:
    v_mfma_f32_16x16x32_bf16 v[196:199], v[48:51], v[72:75], v[196:199]
    s_mov_b32 s77, s75
    buffer_load_dwordx4 a[224:227], v1, s[36:39], 0 offen offset:0 sc1
    v_mfma_f32_16x16x32_bf16 v[196:199], v[52:55], v[76:79], v[196:199]
    buffer_load_dwordx4 a[228:231], v1, s[36:39], 0 offen offset:1024 sc1
    v_mfma_f32_16x16x32_bf16 v[200:203], v[48:51], v[80:83], v[200:203]
    v_cmp_le_i32 vcc, 0, v36
    v_cvt_pk_bf16_f32 v192, v192, v193
    v_mfma_f32_16x16x32_bf16 v[200:203], v[52:55], v[84:87], v[200:203]
    v_cvt_pk_bf16_f32 v193, v194, v195
    v_cvt_pk_bf16_f32 v174, v188, v189
    v_mfma_f32_16x16x32_bf16 v[204:207], v[48:51], v[88:91], v[204:207]
    buffer_load_dwordx4 a[232:235], v1, s[36:39], 0 offen offset:2048 sc1
    v_mfma_f32_16x16x32_bf16 v[204:207], v[52:55], v[92:95], v[204:207]
    s_waitcnt lgkmcnt(0)
    ds_read_b64_tr_b16 v[48:49], v21 offset:0
    ds_read_b64_tr_b16 v[50:51], v21 offset:1024
    v_mfma_f32_16x16x32_bf16 v[208:211], v[56:59], v[64:67], v[208:211]
    ds_read_b64_tr_b16 v[52:53], v21 offset:8192
    ds_read_b64_tr_b16 v[54:55], v21 offset:9216
    v_mfma_f32_16x16x32_bf16 v[208:211], v[60:63], v[68:71], v[208:211]
    v_cvt_pk_bf16_f32 v196, v196, v197
    v_cvt_pk_bf16_f32 v197, v198, v199
    v_mfma_f32_16x16x32_bf16 v[212:215], v[56:59], v[72:75], v[212:215]
    buffer_load_dwordx4 a[236:239], v1, s[36:39], 0 offen offset:3072 sc1
    v_mfma_f32_16x16x32_bf16 v[212:215], v[60:63], v[76:79], v[212:215]
    v_cvt_pk_bf16_f32 v200, v200, v201
    v_cvt_pk_bf16_f32 v201, v202, v203
    v_mfma_f32_16x16x32_bf16 v[216:219], v[56:59], v[80:83], v[216:219]
    v_cvt_pk_bf16_f32 v194, v208, v209
    v_cndmask_b32_e64 v208, v37, 0, vcc
    v_mfma_f32_16x16x32_bf16 v[216:219], v[60:63], v[84:87], v[216:219]
    v_mul_f32 v176, s16, v208
    v_cmp_le_i32 vcc, 1, v36
    v_mfma_f32_16x16x32_bf16 v[220:223], v[56:59], v[88:91], v[220:223]
    v_cvt_pk_bf16_f32 v195, v210, v211
    v_cndmask_b32_e64 v209, v37, 0, vcc
    v_mfma_f32_16x16x32_bf16 v[220:223], v[60:63], v[92:95], v[220:223]
    v_mul_f32 v177, s16, v209
    v_cmp_le_i32 vcc, 2, v36
    v_mfma_f32_16x16x32_bf16 v[224:227], v[40:43], v[64:67], v[224:227]
    s_mov_b32 s38, 16384
    v_cndmask_b32_e64 v210, v37, 0, vcc
    v_mul_f32 v178, s16, v210
    v_mfma_f32_16x16x32_bf16 v[224:227], v[44:47], v[68:71], v[224:227]
    s_add_u32 m0, s76, s75
    v_cmp_le_i32 vcc, 3, v36
    v_cvt_pk_bf16_f32 v198, v212, v213
    v_mfma_f32_16x16x32_bf16 v[228:231], v[40:43], v[72:75], v[228:231]
    buffer_load_dwordx4 v1, s[36:39], s77 offen sc1 lds
    v_mfma_f32_16x16x32_bf16 v[228:231], v[44:47], v[76:79], v[228:231]
    v_cndmask_b32_e64 v211, v37, 0, vcc
    v_mul_f32 v179, s16, v211
    v_mfma_f32_16x16x32_bf16 v[232:235], v[40:43], v[80:83], v[232:235]
    v_cvt_pk_bf16_f32 v224, v224, v225
    v_cvt_pk_bf16_f32 v225, v226, v227
    v_mfma_f32_16x16x32_bf16 v[232:235], v[44:47], v[84:87], v[232:235]
    s_waitcnt vmcnt(6) lgkmcnt(0)
    s_barrier
    ds_read_b64_tr_b16 v[56:57], v26 offset:32768
    v_mfma_f32_16x16x32_bf16 v[236:239], v[40:43], v[88:91], v[236:239]
    buffer_load_dwordx4 v1, s[36:39], s77 offen offset:1024 sc1 lds
    v_mfma_f32_16x16x32_bf16 v[236:239], v[44:47], v[92:95], v[236:239]
    ds_read_b64_tr_b16 v[58:59], v26 offset:33280
    ds_read_b64_tr_b16 v[60:61], v26 offset:36864
    v_mfma_f32_16x16x32_bf16 v[240:243], v[48:51], v[64:67], v[240:243]
    ds_read_b64_tr_b16 v[62:63], v26 offset:37376
    ds_read_b64_tr_b16 v[40:41], v27 offset:32768
    v_mfma_f32_16x16x32_bf16 v[240:243], v[52:55], v[68:71], v[240:243]
    ds_read_b64_tr_b16 v[42:43], v27 offset:33280
    ds_read_b64_tr_b16 v[44:45], v27 offset:36864
    v_mfma_f32_16x16x32_bf16 v[244:247], v[48:51], v[72:75], v[244:247]
    buffer_load_dwordx4 v1, s[36:39], s77 offen offset:2048 sc1 lds
    v_mfma_f32_16x16x32_bf16 v[244:247], v[52:55], v[76:79], v[244:247]
    ds_read_b64_tr_b16 v[46:47], v27 offset:37376
    v_add_u32 v26, 0x10000, v26
    v_mfma_f32_16x16x32_bf16 v[248:251], v[48:51], v[80:83], v[248:251]
    v_add_u32 v27, 0x10000, v27
    v_cvt_pk_bf16_f32 v226, v240, v241
    v_mfma_f32_16x16x32_bf16 v[248:251], v[52:55], v[84:87], v[248:251]
    v_cvt_pk_bf16_f32 v227, v242, v243
    v_cvt_pk_bf16_f32 v228, v228, v229
    v_mfma_f32_16x16x32_bf16 v[252:255], v[48:51], v[88:91], v[252:255]
    buffer_load_dwordx4 v1, s[36:39], s77 offen offset:3072 sc1 lds
    v_mfma_f32_16x16x32_bf16 v[252:255], v[52:55], v[92:95], v[252:255]
    s_waitcnt lgkmcnt(1)
    ds_read_b64_tr_b16 v[48:49], v28 offset:32768
    ds_read_b64_tr_b16 v[50:51], v28 offset:33280
    v_mfma_f32_16x16x32_bf16 a[64:67], v[56:59], v[96:99], a[64:67]
    s_add_u32 s100, s77, 4096
    ds_read_b64_tr_b16 v[52:53], v28 offset:36864
    ds_read_b64_tr_b16 v[54:55], v28 offset:37376
    v_mfma_f32_16x16x32_bf16 a[64:67], v[60:63], v[100:103], a[64:67]
    s_add_u32 m0, m0, 4096
    v_add_u32 v28, 0x10000, v28
    v_cvt_pk_bf16_f32 v229, v230, v231
    v_mfma_f32_16x16x32_bf16 a[68:71], v[56:59], v[104:107], a[68:71]
    buffer_load_dwordx4 v1, s[36:39], s100 offen sc1 lds
    v_mfma_f32_16x16x32_bf16 a[68:71], v[60:63], v[108:111], a[68:71]
    v_cvt_pk_bf16_f32 v230, v244, v245
    v_cvt_pk_bf16_f32 v231, v246, v247
    v_mfma_f32_16x16x32_bf16 a[72:75], v[56:59], v[112:115], a[72:75]
    v_cvt_pk_bf16_f32 v199, v214, v215
    v_cvt_pk_bf16_f32 v232, v232, v233
    v_mfma_f32_16x16x32_bf16 a[72:75], v[60:63], v[116:119], a[72:75]
    v_cvt_pk_bf16_f32 v233, v234, v235
    v_cvt_pk_bf16_f32 v234, v248, v249
    v_mfma_f32_16x16x32_bf16 a[76:79], v[56:59], v[120:123], a[76:79]
    buffer_load_dwordx4 v1, s[36:39], s100 offen offset:1024 sc1 lds
    v_mfma_f32_16x16x32_bf16 a[76:79], v[60:63], v[124:127], a[76:79]
    ds_read_b64_tr_b16 v[56:57], v29 offset:32768
    ds_read_b64_tr_b16 v[58:59], v29 offset:33280
    v_mfma_f32_16x16x32_bf16 a[80:83], v[40:43], v[96:99], a[80:83]
    s_waitcnt lgkmcnt(2)
    ds_read_b64_tr_b16 v[60:61], v29 offset:36864
    ds_read_b64_tr_b16 v[62:63], v29 offset:37376
    v_mfma_f32_16x16x32_bf16 a[80:83], v[44:47], v[100:103], a[80:83]
    v_add_u32 v29, 0x10000, v29
    v_cvt_pk_bf16_f32 v235, v250, v251
    v_mfma_f32_16x16x32_bf16 a[84:87], v[40:43], v[104:107], a[84:87]
    buffer_load_dwordx4 v1, s[36:39], s100 offen offset:2048 sc1 lds
    v_mfma_f32_16x16x32_bf16 a[84:87], v[44:47], v[108:111], a[84:87]
    v_cvt_pk_bf16_f32 v202, v216, v217
    v_cvt_pk_bf16_f32 v203, v218, v219
    v_mfma_f32_16x16x32_bf16 a[88:91], v[40:43], v[112:115], a[88:91]
    v_cvt_pk_bf16_f32 v175, v190, v191
    v_cvt_pk_bf16_f32 v236, v236, v237
    v_mfma_f32_16x16x32_bf16 a[88:91], v[44:47], v[116:119], a[88:91]
    v_cvt_pk_bf16_f32 v237, v238, v239
    v_cvt_pk_bf16_f32 v238, v252, v253
    v_mfma_f32_16x16x32_bf16 a[92:95], v[40:43], v[120:123], a[92:95]
    buffer_load_dwordx4 v1, s[36:39], s100 offen offset:3072 sc1 lds
    v_mfma_f32_16x16x32_bf16 a[92:95], v[44:47], v[124:127], a[92:95]
    s_waitcnt vmcnt(8)
    ds_read_b64_tr_b16 v[40:41], v26 offset:0
    ds_read_b64_tr_b16 v[42:43], v26 offset:512
    v_mfma_f32_16x16x32_bf16 v[240:243], a[224:227], v[128:131], v[176:179]
    s_lshr_b32 s82, s4, 1
    s_add_u32 s82, s82, 32
    ds_read_b64_tr_b16 v[44:45], v26 offset:4096
    v_mfma_f32_16x16x32_bf16 v[240:243], a[228:231], v[160:163], v[240:243]
    s_sub_u32 s82, s82, s6
    ds_read_b64_tr_b16 v[46:47], v26 offset:4608
    v_cvt_pk_bf16_f32 v239, v254, v255
    v_mfma_f32_16x16x32_bf16 v[240:243], a[232:235], v[192:195], v[240:243]
    s_add_u32 s76, s76, 32768
    s_sub_u32 s82, s82, s6
    v_cvt_pk_bf16_f32 v204, v204, v205
    v_mfma_f32_16x16x32_bf16 v[240:243], a[236:239], v[224:227], v[240:243]
    s_add_u32 s77, s77, 32768
    s_lshl_b32 s38, s82, 15
    s_add_u32 m0, s76, s75
    v_mfma_f32_16x16x32_bf16 v[244:247], a[224:227], v[132:135], 0
    s_mov_b32 s82, 0
    buffer_load_dwordx4 v1, s[36:39], s77 offen sc1 lds
    v_mfma_f32_16x16x32_bf16 v[244:247], a[228:231], v[164:167], v[244:247]
    v_cvt_pk_bf16_f32 v205, v206, v207
    v_max3_f32 v147, v240, v241, v242
    v_mfma_f32_16x16x32_bf16 v[244:247], a[232:235], v[196:199], v[244:247]
    buffer_load_dwordx4 v1, s[36:39], s77 offen offset:1024 sc1 lds
    v_mfma_f32_16x16x32_bf16 v[244:247], a[236:239], v[228:231], v[244:247]
    v_max_f32 v147, v147, v243
    v_mov_b32 v146, v147
    v_mfma_f32_16x16x32_bf16 v[248:251], a[224:227], v[136:139], 0
    v_cvt_pk_bf16_f32 v206, v220, v221
    v_permlane32_swap_b32 v147, v146
    v_mfma_f32_16x16x32_bf16 v[248:251], a[228:231], v[168:171], v[248:251]
    v_max_f32 v147, v147, v146
    v_mov_b32 v146, v147
    v_mfma_f32_16x16x32_bf16 v[248:251], a[232:235], v[200:203], v[248:251]
    buffer_load_dwordx4 v1, s[36:39], s77 offen offset:2048 sc1 lds
    v_mfma_f32_16x16x32_bf16 v[248:251], a[236:239], v[232:235], v[248:251]
    v_max3_f32 v151, v244, v245, v246
    v_max_f32 v151, v151, v247
    v_mfma_f32_16x16x32_bf16 v[252:255], a[224:227], v[140:143], 0
    v_mov_b32 v150, v151
    v_permlane16_swap_b32 v147, v146
    v_mfma_f32_16x16x32_bf16 v[252:255], a[228:231], v[172:175], v[252:255]
    v_permlane32_swap_b32 v151, v150
    v_max_f32 v151, v151, v150
    v_cvt_pk_bf16_f32 v207, v222, v223
    s_nop 1
    v_mfma_f32_16x16x32_bf16 v[252:255], a[232:235], v[204:207], v[252:255]
    buffer_load_dwordx4 v1, s[36:39], s77 offen offset:3072 sc1 lds
    v_mfma_f32_16x16x32_bf16 v[252:255], a[236:239], v[236:239], v[252:255]
    v_max3_f32 v155, v248, v249, v250
    v_max_f32 v155, v155, v251
    v_mfma_f32_16x16x32_bf16 a[96:99], v[48:51], v[96:99], a[96:99]
    s_add_u32 s100, s77, 4096
    v_mov_b32 v154, v155
    v_mov_b32 v150, v151
    v_mfma_f32_16x16x32_bf16 a[96:99], v[52:55], v[100:103], a[96:99]
    s_add_u32 m0, m0, 4096
    v_max3_f32 v159, v252, v253, v254
    v_max_f32 v159, v159, v255
    v_mfma_f32_16x16x32_bf16 a[100:103], v[48:51], v[104:107], a[100:103]
    buffer_load_dwordx4 v1, s[36:39], s100 offen sc1 lds
    v_mfma_f32_16x16x32_bf16 a[100:103], v[52:55], v[108:111], a[100:103]
    v_mov_b32 v158, v159
    v_permlane32_swap_b32 v155, v154
    v_mfma_f32_16x16x32_bf16 a[104:107], v[48:51], v[112:115], a[104:107]
    v_permlane32_swap_b32 v159, v158
    v_max_f32 v155, v155, v154
    v_mfma_f32_16x16x32_bf16 a[104:107], v[52:55], v[116:119], a[104:107]
    v_max_f32 v159, v159, v158
    v_mov_b32 v154, v155
    v_mfma_f32_16x16x32_bf16 a[108:111], v[48:51], v[120:123], a[108:111]
    buffer_load_dwordx4 v1, s[36:39], s100 offen offset:1024 sc1 lds
    v_mfma_f32_16x16x32_bf16 a[108:111], v[52:55], v[124:127], a[108:111]
    s_waitcnt lgkmcnt(0)
    ds_read_b64_tr_b16 v[48:49], v27 offset:0
    ds_read_b64_tr_b16 v[50:51], v27 offset:512
    v_mfma_f32_16x16x32_bf16 a[112:115], v[56:59], v[96:99], a[112:115]
    ds_read_b64_tr_b16 v[52:53], v27 offset:4096
    ds_read_b64_tr_b16 v[54:55], v27 offset:4608
    v_mfma_f32_16x16x32_bf16 a[112:115], v[60:63], v[100:103], a[112:115]
    v_mov_b32 v158, v159
    v_permlane16_swap_b32 v151, v150
    v_mfma_f32_16x16x32_bf16 a[116:119], v[56:59], v[104:107], a[116:119]
    buffer_load_dwordx4 v1, s[36:39], s100 offen offset:2048 sc1 lds
    v_mfma_f32_16x16x32_bf16 a[116:119], v[60:63], v[108:111], a[116:119]
    v_permlane16_swap_b32 v155, v154
    v_permlane16_swap_b32 v159, v158
    v_mfma_f32_16x16x32_bf16 a[120:123], v[56:59], v[112:115], a[120:123]
    v_max_f32 v147, v147, v146
    v_max_f32 v151, v151, v150
    v_mfma_f32_16x16x32_bf16 a[120:123], v[60:63], v[116:119], a[120:123]
    v_max_f32 v155, v155, v154
    v_max_f32 v159, v159, v158
    v_mfma_f32_16x16x32_bf16 a[124:127], v[56:59], v[120:123], a[124:127]
    buffer_load_dwordx4 v1, s[36:39], s100 offen offset:3072 sc1 lds
    v_mfma_f32_16x16x32_bf16 a[124:127], v[60:63], v[124:127], a[124:127]
    ds_read_b64_tr_b16 v[56:57], v28 offset:0
    ds_read_b64_tr_b16 v[58:59], v28 offset:512
    v_mfma_f32_16x16x32_bf16 a[64:67], v[40:43], v[64:67], a[64:67]
    s_add_u32 s76, s76, 32768
    ds_read_b64_tr_b16 v[60:61], v28 offset:4096
    ds_read_b64_tr_b16 v[62:63], v28 offset:4608
    v_mfma_f32_16x16x32_bf16 a[64:67], v[44:47], v[68:71], a[64:67]
    s_add_u32 s77, s77, 32768
    v_sub_f32 v144, 0, v147
    v_sub_f32 v148, 0, v151
    v_mfma_f32_16x16x32_bf16 a[68:71], v[40:43], v[72:75], a[68:71]
    s_add_u32 m0, s76, s75
    v_sub_f32 v152, 0, v155
    v_sub_f32 v156, 0, v159
    v_mfma_f32_16x16x32_bf16 a[68:71], v[44:47], v[76:79], a[68:71]
    buffer_load_dwordx4 v1, s[36:39], s77 offen sc1 lds
    v_mfma_f32_16x16x32_bf16 a[72:75], v[40:43], v[80:83], a[72:75]
    v_sub_f32 v145, 0, v147
    v_sub_f32 v146, 0, v147
    v_mfma_f32_16x16x32_bf16 a[72:75], v[44:47], v[84:87], a[72:75]
    v_sub_f32 v147, 0, v147
    v_sub_f32 v149, 0, v151
    v_mfma_f32_16x16x32_bf16 a[76:79], v[40:43], v[88:91], a[76:79]
    buffer_load_dwordx4 v1, s[36:39], s77 offen offset:1024 sc1 lds
    v_mfma_f32_16x16x32_bf16 a[76:79], v[44:47], v[92:95], a[76:79]
    s_waitcnt lgkmcnt(0)
    ds_read_b64_tr_b16 v[40:41], v29 offset:0
    ds_read_b64_tr_b16 v[42:43], v29 offset:512
    v_mfma_f32_16x16x32_bf16 a[80:83], v[48:51], v[64:67], a[80:83]
    ds_read_b64_tr_b16 v[44:45], v29 offset:4096
    ds_read_b64_tr_b16 v[46:47], v29 offset:4608
    v_mfma_f32_16x16x32_bf16 a[80:83], v[52:55], v[68:71], a[80:83]
    v_sub_f32 v150, 0, v151
    v_sub_f32 v151, 0, v151
    v_mfma_f32_16x16x32_bf16 a[84:87], v[48:51], v[72:75], a[84:87]
    buffer_load_dwordx4 v1, s[36:39], s77 offen offset:2048 sc1 lds
    v_mfma_f32_16x16x32_bf16 a[84:87], v[52:55], v[76:79], a[84:87]
    v_sub_f32 v153, 0, v155
    v_sub_f32 v154, 0, v155
    v_mfma_f32_16x16x32_bf16 a[88:91], v[48:51], v[80:83], a[88:91]
    v_sub_f32 v155, 0, v155
    v_sub_f32 v157, 0, v159
    v_mfma_f32_16x16x32_bf16 a[88:91], v[52:55], v[84:87], a[88:91]
    v_sub_f32 v158, 0, v159
    v_sub_f32 v159, 0, v159
    v_mfma_f32_16x16x32_bf16 a[92:95], v[48:51], v[88:91], a[92:95]
    buffer_load_dwordx4 v1, s[36:39], s77 offen offset:3072 sc1 lds
    v_mfma_f32_16x16x32_bf16 a[92:95], v[52:55], v[92:95], a[92:95]
    v_or_b32 v215, 0x44444444, v38
    v_bfe_u32 v38, v1, 5, 1
    v_mfma_f32_16x16x32_bf16 a[96:99], v[56:59], v[64:67], a[96:99]
    s_add_u32 s100, s77, 4096
    v_cmp_eq_u32 vcc, 0, v38
    v_mov_b32 v38, 0x3f803f80
    v_mfma_f32_16x16x32_bf16 a[96:99], v[60:63], v[68:71], a[96:99]
    s_add_u32 m0, m0, 4096
    v_and_b32 v29, 0x380, v1
    v_cndmask_b32 v38, 0, v38, vcc
    v_mfma_f32_16x16x32_bf16 a[100:103], v[56:59], v[72:75], a[100:103]
    buffer_load_dwordx4 v1, s[36:39], s100 offen sc1 lds
    v_mfma_f32_16x16x32_bf16 a[100:103], v[60:63], v[76:79], a[100:103]
    v_add_f32 v240, v240, v144
    v_add_f32 v241, v241, v144
    v_mfma_f32_16x16x32_bf16 a[104:107], v[56:59], v[80:83], a[104:107]
    v_add_f32 v242, v242, v144
    v_add_f32 v243, v243, v144
    v_mfma_f32_16x16x32_bf16 a[104:107], v[60:63], v[84:87], a[104:107]
    s_waitcnt vmcnt(13) lgkmcnt(0)
    s_barrier
    ds_read_b128 a[240:243], v2 offset:4096
    v_mfma_f32_16x16x32_bf16 a[108:111], v[56:59], v[88:91], a[108:111]
    ds_read_b128 a[244:247], v2 offset:5120
    ds_read_b128 a[248:251], v2 offset:6144
    v_mfma_f32_16x16x32_bf16 a[108:111], v[60:63], v[92:95], a[108:111]
    buffer_load_dwordx4 v1, s[36:39], s100 offen offset:1024 sc1 lds
    v_mfma_f32_16x16x32_bf16 a[112:115], v[40:43], v[64:67], a[112:115]
    ds_read_b128 a[252:255], v2 offset:7168
    v_add_f32 v244, v244, v148
    v_mfma_f32_16x16x32_bf16 a[112:115], v[44:47], v[68:71], a[112:115]
    v_add_f32 v245, v245, v148
    v_add_f32 v246, v246, v148
    v_mfma_f32_16x16x32_bf16 a[116:119], v[40:43], v[72:75], a[116:119]
    buffer_load_dwordx4 v1, s[36:39], s100 offen offset:2048 sc1 lds
    v_mfma_f32_16x16x32_bf16 a[116:119], v[44:47], v[76:79], a[116:119]
    v_add_f32 v247, v247, v148
    v_add_f32 v248, v248, v152
    v_mfma_f32_16x16x32_bf16 a[120:123], v[40:43], v[80:83], a[120:123]
    v_add_f32 v249, v249, v152
    v_add_f32 v250, v250, v152
    v_mfma_f32_16x16x32_bf16 a[120:123], v[44:47], v[84:87], a[120:123]
    v_add_f32 v251, v251, v152
    v_add_f32 v252, v252, v156
    v_mfma_f32_16x16x32_bf16 a[124:127], v[40:43], v[88:91], a[124:127]
    buffer_load_dwordx4 v1, s[36:39], s100 offen offset:3072 sc1 lds
    v_mfma_f32_16x16x32_bf16 a[124:127], v[44:47], v[92:95], a[124:127]
    v_add_f32 v253, v253, v156
    v_add_f32 v254, v254, v156
    v_add_f32 v255, v255, v156
    v_lshl_add_u32 v29, v29, 4, v39
    v_bfe_u32 v39, v1, 2, 4
    v_accvgpr_write_b32 a136, v38
    v_accvgpr_write_b32 a137, v38
    v_accvgpr_write_b32 a138, v38
    v_accvgpr_write_b32 a139, v38
    v_exp_f32 v240, v240
    v_exp_f32 v241, v241
    v_exp_f32 v242, v242
    v_exp_f32 v243, v243
    v_exp_f32 v244, v244
    v_exp_f32 v245, v245
    v_exp_f32 v246, v246
    v_exp_f32 v247, v247
    v_exp_f32 v248, v248
    v_exp_f32 v249, v249
    v_exp_f32 v250, v250
    v_exp_f32 v251, v251
    v_exp_f32 v252, v252
    v_exp_f32 v253, v253
    v_exp_f32 v254, v254
    v_exp_f32 v255, v255
    buffer_store_dwordx4 a[68:71], v1, s[40:43], s84 offen offset:2048 sc1
    buffer_store_dwordx4 a[76:79], v1, s[40:43], s85 offen offset:2048 sc1
    buffer_store_dwordx4 a[84:87], v1, s[40:43], s84 offen offset:1024 sc1
    buffer_store_dwordx4 a[92:95], v1, s[40:43], s85 offen offset:1024 sc1
    buffer_store_dwordx4 a[100:103], v1, s[40:43], s84 offen offset:0 sc1
    buffer_store_dwordx4 a[108:111], v1, s[40:43], s85 offen offset:0 sc1
    v_lshl_add_u32 v29, v29, 1, v39
    s_add_u32 s77, s77, 32768
    s_add_u32 s76, s76, 32768
K1_ATT:
    v_cvt_pk_bf16_f32 v32, v240, v241
    v_cvt_pk_bf16_f32 v33, v242, v243
    v_add_f32 v213, s21, v144
    v_fma_f32 v180, v208, s17, v213
    v_fma_f32 v181, v209, s17, v213
    v_fma_f32 v182, v210, s17, v213
    v_fma_f32 v183, v211, s17, v213
    s_nop 1
    s_waitcnt lgkmcnt(0)
    v_mfma_f32_16x16x32_bf16 v[240:243], a[240:243], v[128:131], v[180:183]
    s_mov_b32 s99, s76
    v_cvt_pk_bf16_f32 v40, v244, v245
    v_cvt_pk_bf16_f32 v41, v246, v247
    v_mfma_f32_16x16x32_bf16 v[240:243], a[244:247], v[160:163], v[240:243]
    s_sub_u32 s7, 15, s6
    v_cvt_pk_bf16_f32 v48, v248, v249
    v_cvt_pk_bf16_f32 v49, v250, v251
    v_mfma_f32_16x16x32_bf16 v[240:243], a[248:251], v[192:195], v[240:243]
    s_lshl3_add_u32 s80, s6, s4
    ds_read_b128 a[224:227], v2 offset:8192
    ds_read_b128 a[228:231], v2 offset:9216
    v_mfma_f32_16x16x32_bf16 v[240:243], a[252:255], v[224:227], v[240:243]
    s_lshl3_add_u32 s81, s7, s4
    ds_read_b128 a[232:235], v2 offset:10240
    v_cvt_pk_bf16_f32 v56, v252, v253
    v_mfma_f32_16x16x32_bf16 v[244:247], a[240:243], v[132:135], v[148:151]
    s_add_u32 m0, s76, s75
    ds_read_b128 a[236:239], v2 offset:11264
    v_cvt_pk_bf16_f32 v57, v254, v255
    v_mfma_f32_16x16x32_bf16 v[244:247], a[244:247], v[164:167], v[244:247]
    s_mov_b32 s76, s60
    buffer_load_dwordx4 v1, s[36:39], s77 offen sc1 lds
    v_mfma_f32_16x16x32_bf16 v[244:247], a[248:251], v[196:199], v[244:247]
    s_mov_b32 s60, s82
    v_exp_f32 v240, v240
    v_mfma_f32_16x16x32_bf16 v[244:247], a[252:255], v[228:231], v[244:247]
    s_mov_b32 s82, s95
    buffer_load_dwordx4 v1, s[36:39], s77 offen offset:1024 sc1 lds
    v_mfma_f32_16x16x32_bf16 v[248:251], a[240:243], v[136:139], v[152:155]
    s_mov_b32 s95, s93
    v_exp_f32 v241, v241
    v_mfma_f32_16x16x32_bf16 v[248:251], a[244:247], v[168:171], v[248:251]
    s_mov_b32 s93, s99
    v_exp_f32 v242, v242
    v_mfma_f32_16x16x32_bf16 v[248:251], a[248:251], v[200:203], v[248:251]
    s_mul_i32 s80, s80, 155648
    buffer_load_dwordx4 v1, s[36:39], s77 offen offset:2048 sc1 lds
    v_mfma_f32_16x16x32_bf16 v[248:251], a[252:255], v[232:235], v[248:251]
    s_mul_i32 s81, s81, 155648
    v_exp_f32 v243, v243
    v_mfma_f32_16x16x32_bf16 v[252:255], a[240:243], v[140:143], v[156:159]
    s_lshl_b32 s7, s5, 12
    v_cvt_pk_bf16_f32 v34, v240, v241
    v_cvt_pk_bf16_f32 v35, v242, v243
    v_mfma_f32_16x16x32_bf16 v[252:255], a[244:247], v[172:175], v[252:255]
    s_add_u32 s80, s80, s7
    buffer_load_dwordx4 v1, s[36:39], s77 offen offset:3072 sc1 lds
    v_mfma_f32_16x16x32_bf16 v[252:255], a[248:251], v[204:207], v[252:255]
    s_add_u32 s81, s81, s7
    v_exp_f32 v244, v244
    v_mfma_f32_16x16x32_bf16 v[252:255], a[252:255], v[236:239], v[252:255]
    s_add_u32 s100, s77, 4096
    v_exp_f32 v245, v245
    v_add_f32 v212, s20, v144
    v_fma_f32 v176, v208, s16, v212
    v_fma_f32 v177, v209, s16, v212
    v_fma_f32 v178, v210, s16, v212
    v_fma_f32 v179, v211, s16, v212
    v_add_f32 v212, s22, v144
    v_fma_f32 v184, v208, s18, v212
    v_fma_f32 v185, v209, s18, v212
    v_fma_f32 v186, v210, s18, v212
    v_fma_f32 v187, v211, s18, v212
    s_nop 1
    s_waitcnt lgkmcnt(0)
    v_mfma_f32_16x16x32_bf16 v[240:243], a[224:227], v[128:131], v[184:187]
    s_add_u32 m0, m0, 4096
    v_exp_f32 v246, v246
    v_mfma_f32_16x16x32_bf16 v[240:243], a[228:231], v[160:163], v[240:243]
    s_lshr_b32 s7, s5, 3
    v_exp_f32 v247, v247
    v_mfma_f32_16x16x32_bf16 v[240:243], a[232:235], v[192:195], v[240:243]
    s_lshl2_add_u32 s7, s7, s4
    buffer_load_dwordx4 v1, s[36:39], s100 offen sc1 lds
    v_mfma_f32_16x16x32_bf16 v[240:243], a[236:239], v[224:227], v[240:243]
    s_lshl_b32 s7, s7, 8
    v_cvt_pk_bf16_f32 v42, v244, v245
    v_cvt_pk_bf16_f32 v43, v246, v247
    v_mfma_f32_16x16x32_bf16 v[244:247], a[224:227], v[132:135], v[148:151]
    s_mov_b64 s[84:85], 0
    v_exp_f32 v248, v248
    v_mfma_f32_16x16x32_bf16 v[244:247], a[228:231], v[164:167], v[244:247]
    s_add_u32 s92, s7, 163840
    buffer_load_dwordx4 v1, s[36:39], s100 offen offset:1024 sc1 lds
    v_mfma_f32_16x16x32_bf16 v[244:247], a[232:235], v[196:199], v[244:247]
    s_mov_b64 s[24:25], s[0:1]
    v_exp_f32 v249, v249
    v_mfma_f32_16x16x32_bf16 v[244:247], a[236:239], v[228:231], v[244:247]
    s_mov_b32 s78, s6
    v_exp_f32 v250, v250
    v_exp_f32 v251, v251
    v_cvt_pk_bf16_f32 v50, v248, v249
    v_cvt_pk_bf16_f32 v51, v250, v251
    v_mfma_f32_16x16x32_bf16 v[248:251], a[224:227], v[136:139], v[152:155]
    s_mov_b32 s26, 2359296
    ds_read_b128 a[240:243], v2 offset:12288
    ds_read_b128 a[244:247], v2 offset:13312
    v_mfma_f32_16x16x32_bf16 v[248:251], a[228:231], v[168:171], v[248:251]
    s_mov_b32 s27, 0x20000
    buffer_load_dwordx4 v1, s[36:39], s100 offen offset:2048 sc1 lds
    v_mfma_f32_16x16x32_bf16 v[248:251], a[232:235], v[200:203], v[248:251]
    s_add_u32 s77, s77, 32768
    ds_read_b128 a[248:251], v2 offset:14336
    ds_read_b128 a[252:255], v2 offset:15360
    v_mfma_f32_16x16x32_bf16 v[248:251], a[236:239], v[232:235], v[248:251]
    v_exp_f32 v252, v252
    v_exp_f32 v253, v253
    v_exp_f32 v254, v254
    v_exp_f32 v255, v255
    v_cvt_pk_bf16_f32 v58, v252, v253
    v_cvt_pk_bf16_f32 v59, v254, v255
    v_mfma_f32_16x16x32_bf16 v[252:255], a[224:227], v[140:143], v[156:159]
    v_add_f32 v213, s23, v144
    v_fma_f32 v188, v208, s19, v213
    v_mfma_f32_16x16x32_bf16 v[252:255], a[228:231], v[172:175], v[252:255]
    buffer_load_dwordx4 v1, s[36:39], s100 offen offset:3072 sc1 lds
    v_mfma_f32_16x16x32_bf16 v[252:255], a[232:235], v[204:207], v[252:255]
    v_exp_f32 v240, v240
    v_mfma_f32_16x16x32_bf16 v[252:255], a[236:239], v[236:239], v[252:255]
    s_waitcnt lgkmcnt(0)
    v_exp_f32 v241, v241
    v_exp_f32 v242, v242
    v_exp_f32 v243, v243
    v_fma_f32 v189, v209, s19, v213
    v_fma_f32 v190, v210, s19, v213
    v_fma_f32 v191, v211, s19, v213
    v_cvt_pk_bf16_f32 v36, v240, v241
    v_cvt_pk_bf16_f32 v37, v242, v243
    v_mfma_f32_16x16x32_bf16 v[240:243], a[240:243], v[128:131], v[188:191]
    v_exp_f32 v244, v244
    v_mfma_f32_16x16x32_bf16 v[240:243], a[244:247], v[160:163], v[240:243]
    v_exp_f32 v245, v245
    v_mfma_f32_16x16x32_bf16 v[240:243], a[248:251], v[192:195], v[240:243]
    s_waitcnt vmcnt(8) lgkmcnt(0)
    v_exp_f32 v246, v246
    v_mfma_f32_16x16x32_bf16 v[240:243], a[252:255], v[224:227], v[240:243]
    s_barrier
    v_exp_f32 v247, v247
    v_cvt_pk_bf16_f32 v44, v244, v245
    v_cvt_pk_bf16_f32 v45, v246, v247
    v_mfma_f32_16x16x32_bf16 v[244:247], a[240:243], v[132:135], v[148:151]
    v_add_u32 v2, s82, v1
    ds_read_b128 a[224:227], v2 offset:0
    v_mfma_f32_16x16x32_bf16 v[244:247], a[244:247], v[164:167], v[244:247]
    ds_read_b128 a[228:231], v2 offset:1024
    ds_read_b128 a[232:235], v2 offset:2048
    v_mfma_f32_16x16x32_bf16 v[244:247], a[248:251], v[196:199], v[244:247]
    v_exp_f32 v248, v248
    v_mfma_f32_16x16x32_bf16 v[244:247], a[252:255], v[228:231], v[244:247]
    v_exp_f32 v249, v249
    v_exp_f32 v250, v250
    v_exp_f32 v251, v251
    v_cvt_pk_bf16_f32 v52, v248, v249
    v_cvt_pk_bf16_f32 v53, v250, v251
    v_mfma_f32_16x16x32_bf16 v[248:251], a[240:243], v[136:139], v[152:155]
    ds_read_b128 a[236:239], v2 offset:3072
    ds_read_b128 v[96:99], v2 offset:16384
    v_mfma_f32_16x16x32_bf16 v[248:251], a[244:247], v[168:171], v[248:251]
    v_exp_f32 v252, v252
    v_mfma_f32_16x16x32_bf16 v[248:251], a[248:251], v[200:203], v[248:251]
    v_exp_f32 v253, v253
    v_mfma_f32_16x16x32_bf16 v[248:251], a[252:255], v[232:235], v[248:251]
    v_exp_f32 v254, v254
    v_exp_f32 v255, v255
    v_cvt_pk_bf16_f32 v60, v252, v253
    v_cvt_pk_bf16_f32 v61, v254, v255
    v_mfma_f32_16x16x32_bf16 v[252:255], a[240:243], v[140:143], v[156:159]
    ds_read_b128 v[100:103], v2 offset:17408
    v_mfma_f32_16x16x32_bf16 v[252:255], a[244:247], v[172:175], v[252:255]
    v_exp_f32 v240, v240
    v_mfma_f32_16x16x32_bf16 v[252:255], a[248:251], v[204:207], v[252:255]
    v_exp_f32 v241, v241
    v_mfma_f32_16x16x32_bf16 v[252:255], a[252:255], v[236:239], v[252:255]
    v_exp_f32 v242, v242
    v_exp_f32 v243, v243
    v_exp_f32 v244, v244
    v_exp_f32 v245, v245
    v_exp_f32 v246, v246
    v_exp_f32 v247, v247
    v_exp_f32 v248, v248
    v_exp_f32 v249, v249
    v_exp_f32 v250, v250
    v_exp_f32 v251, v251
    v_cvt_pk_bf16_f32 v38, v240, v241
    v_cvt_pk_bf16_f32 v39, v242, v243
    v_cvt_pk_bf16_f32 v46, v244, v245
    v_cvt_pk_bf16_f32 v47, v246, v247
    v_cvt_pk_bf16_f32 v54, v248, v249
    v_cvt_pk_bf16_f32 v55, v250, v251
    v_exp_f32 v252, v252
    v_mov_b32 v28, 2
    s_cmp_eq_u32 s4, 3
    s_cselect_b32 s7, s101, 1073741824
    v_lshlrev_b32 v31, 20, v1
    buffer_store_dword v28, v31, s[32:35], s7 offen sc1
    s_cmp_eq_u32 s78, 0
    s_cbranch_scc1 K1_LB_END
.p2align 3
K1_LB:
    s_waitcnt lgkmcnt(0)
    v_mfma_f32_16x16x32_bf16 v[240:243], a[224:227], v[128:131], v[176:179]
    s_mov_b32 s99, s76
    v_exp_f32 v253, v253
    v_mfma_f32_16x16x32_bf16 v[240:243], a[228:231], v[160:163], v[240:243]
    v_exp_f32 v254, v254
    v_mfma_f32_16x16x32_bf16 v[240:243], a[232:235], v[192:195], v[240:243]
    v_exp_f32 v255, v255
    v_mfma_f32_16x16x32_bf16 v[240:243], a[236:239], v[224:227], v[240:243]
    v_cvt_pk_bf16_f32 v62, v252, v253
    v_cvt_pk_bf16_f32 v63, v254, v255
    v_mfma_f32_16x16x32_bf16 a[0:3], v[96:99], v[32:35], a[0:3]
    s_add_u32 m0, s76, s75
    v_mfma_f32_16x16x32_bf16 a[0:3], v[100:103], v[36:39], a[0:3]
    s_mov_b32 s76, s60
    buffer_load_dwordx4 v1, s[36:39], s77 offen sc1 lds
    v_mfma_f32_16x16x32_bf16 a[4:7], v[96:99], v[40:43], a[4:7]
    s_mov_b32 s60, s82
    ds_read_b128 v[104:107], v2 offset:18432
    ds_read_b128 v[108:111], v2 offset:19456
    v_mfma_f32_16x16x32_bf16 a[4:7], v[100:103], v[44:47], a[4:7]
    s_mov_b32 s82, s95
    v_exp_f32 v240, v240
    v_mfma_f32_16x16x32_bf16 v[244:247], a[224:227], v[132:135], v[148:151]
    s_mov_b32 s95, s93
    v_exp_f32 v241, v241
    v_mfma_f32_16x16x32_bf16 v[244:247], a[228:231], v[164:167], v[244:247]
    s_mov_b32 s93, s99
    v_exp_f32 v242, v242
    v_mfma_f32_16x16x32_bf16 v[244:247], a[232:235], v[196:199], v[244:247]
    v_exp_f32 v243, v243
    v_mfma_f32_16x16x32_bf16 v[244:247], a[236:239], v[228:231], v[244:247]
    v_cvt_pk_bf16_f32 v64, v240, v241
    v_cvt_pk_bf16_f32 v65, v242, v243
    v_mfma_f32_16x16x32_bf16 a[8:11], v[96:99], v[48:51], a[8:11]
    v_mfma_f32_16x16x32_bf16 a[8:11], v[100:103], v[52:55], a[8:11]
    v_mfma_f32_16x16x32_bf16 a[12:15], v[96:99], v[56:59], a[12:15]
    v_mfma_f32_16x16x32_bf16 a[12:15], v[100:103], v[60:63], a[12:15]
    v_mfma_f32_16x16x32_bf16 v[248:251], a[224:227], v[136:139], v[152:155]
    v_mfma_f32_16x16x32_bf16 v[248:251], a[228:231], v[168:171], v[248:251]
    ds_read_b128 a[240:243], v2 offset:4096
    ds_read_b128 a[244:247], v2 offset:5120
    v_mfma_f32_16x16x32_bf16 v[248:251], a[232:235], v[200:203], v[248:251]
    buffer_load_dwordx4 v1, s[36:39], s77 offen offset:1024 sc1 lds
    v_mfma_f32_16x16x32_bf16 v[248:251], a[236:239], v[232:235], v[248:251]
    s_waitcnt lgkmcnt(2)
    ds_read_b128 a[248:251], v2 offset:6144
    ds_read_b128 a[252:255], v2 offset:7168
    v_mfma_f32_16x16x32_bf16 a[16:19], v[104:107], v[32:35], a[16:19]
    v_exp_f32 v244, v244
    v_mfma_f32_16x16x32_bf16 a[16:19], v[108:111], v[36:39], a[16:19]
    ds_read_b128 v[112:115], v2 offset:20480
    ds_read_b128 v[116:119], v2 offset:21504
    v_mfma_f32_16x16x32_bf16 a[20:23], v[104:107], v[40:43], a[20:23]
    v_exp_f32 v245, v245
    v_mfma_f32_16x16x32_bf16 a[20:23], v[108:111], v[44:47], a[20:23]
    v_exp_f32 v246, v246
    v_mfma_f32_16x16x32_bf16 v[252:255], a[224:227], v[140:143], v[156:159]
    v_exp_f32 v247, v247
    v_mfma_f32_16x16x32_bf16 v[252:255], a[228:231], v[172:175], v[252:255]
    v_cvt_pk_bf16_f32 v72, v244, v245
    v_cvt_pk_bf16_f32 v73, v246, v247
    v_mfma_f32_16x16x32_bf16 v[252:255], a[232:235], v[204:207], v[252:255]
    v_exp_f32 v248, v248
    v_mfma_f32_16x16x32_bf16 v[252:255], a[236:239], v[236:239], v[252:255]
    v_exp_f32 v249, v249
    v_mfma_f32_16x16x32_bf16 a[24:27], v[104:107], v[48:51], a[24:27]
    v_exp_f32 v250, v250
    v_mfma_f32_16x16x32_bf16 a[24:27], v[108:111], v[52:55], a[24:27]
    v_exp_f32 v251, v251
    v_mfma_f32_16x16x32_bf16 a[28:31], v[104:107], v[56:59], a[28:31]
    v_cvt_pk_bf16_f32 v80, v248, v249
    v_cvt_pk_bf16_f32 v81, v250, v251
    v_mfma_f32_16x16x32_bf16 a[28:31], v[108:111], v[60:63], a[28:31]
    s_waitcnt lgkmcnt(0)
    buffer_load_dwordx4 v1, s[36:39], s77 offen offset:2048 sc1 lds
    v_mfma_f32_16x16x32_bf16 v[240:243], a[240:243], v[128:131], v[180:183]
    v_exp_f32 v252, v252
    v_mfma_f32_16x16x32_bf16 v[240:243], a[244:247], v[160:163], v[240:243]
    v_exp_f32 v253, v253
    v_mfma_f32_16x16x32_bf16 v[240:243], a[248:251], v[192:195], v[240:243]
    v_exp_f32 v254, v254
    v_mfma_f32_16x16x32_bf16 v[240:243], a[252:255], v[224:227], v[240:243]
    v_exp_f32 v255, v255
    v_mfma_f32_16x16x32_bf16 a[32:35], v[112:115], v[32:35], a[32:35]
    v_cvt_pk_bf16_f32 v88, v252, v253
    v_cvt_pk_bf16_f32 v89, v254, v255
    v_mfma_f32_16x16x32_bf16 a[32:35], v[116:119], v[36:39], a[32:35]
    ds_read_b128 v[120:123], v2 offset:22528
    ds_read_b128 v[124:127], v2 offset:23552
    v_mfma_f32_16x16x32_bf16 a[36:39], v[112:115], v[40:43], a[36:39]
    v_exp_f32 v240, v240
    v_mfma_f32_16x16x32_bf16 a[36:39], v[116:119], v[44:47], a[36:39]
    v_exp_f32 v241, v241
    v_mfma_f32_16x16x32_bf16 v[244:247], a[240:243], v[132:135], v[148:151]
    v_exp_f32 v242, v242
    v_mfma_f32_16x16x32_bf16 v[244:247], a[244:247], v[164:167], v[244:247]
    v_exp_f32 v243, v243
    v_mfma_f32_16x16x32_bf16 v[244:247], a[248:251], v[196:199], v[244:247]
    v_cvt_pk_bf16_f32 v66, v240, v241
    v_cvt_pk_bf16_f32 v67, v242, v243
    v_mfma_f32_16x16x32_bf16 v[244:247], a[252:255], v[228:231], v[244:247]
    v_mfma_f32_16x16x32_bf16 a[40:43], v[112:115], v[48:51], a[40:43]
    buffer_load_dwordx4 v1, s[36:39], s77 offen offset:3072 sc1 lds
    v_mfma_f32_16x16x32_bf16 a[40:43], v[116:119], v[52:55], a[40:43]
    v_mfma_f32_16x16x32_bf16 a[44:47], v[112:115], v[56:59], a[44:47]
    v_mfma_f32_16x16x32_bf16 a[44:47], v[116:119], v[60:63], a[44:47]
    v_mfma_f32_16x16x32_bf16 v[248:251], a[240:243], v[136:139], v[152:155]
    v_mfma_f32_16x16x32_bf16 v[248:251], a[244:247], v[168:171], v[248:251]
    ds_read_b128 a[224:227], v2 offset:8192
    ds_read_b128 a[228:231], v2 offset:9216
    v_mfma_f32_16x16x32_bf16 v[248:251], a[248:251], v[200:203], v[248:251]
    v_exp_f32 v244, v244
    v_mfma_f32_16x16x32_bf16 v[248:251], a[252:255], v[232:235], v[248:251]
    s_waitcnt lgkmcnt(2)
    ds_read_b128 a[232:235], v2 offset:10240
    ds_read_b128 a[236:239], v2 offset:11264
    v_mfma_f32_16x16x32_bf16 a[48:51], v[120:123], v[32:35], a[48:51]
    v_exp_f32 v245, v245
    v_mfma_f32_16x16x32_bf16 a[48:51], v[124:127], v[36:39], a[48:51]
    ds_read_b128 v[96:99], v2 offset:24576
    ds_read_b128 v[100:103], v2 offset:25600
    v_mfma_f32_16x16x32_bf16 a[52:55], v[120:123], v[40:43], a[52:55]
    v_exp_f32 v246, v246
    v_mfma_f32_16x16x32_bf16 a[52:55], v[124:127], v[44:47], a[52:55]
    v_exp_f32 v247, v247
    v_mfma_f32_16x16x32_bf16 v[252:255], a[240:243], v[140:143], v[156:159]
    v_cvt_pk_bf16_f32 v74, v244, v245
    v_cvt_pk_bf16_f32 v75, v246, v247
    v_mfma_f32_16x16x32_bf16 v[252:255], a[244:247], v[172:175], v[252:255]
    s_add_u32 s100, s77, 4096
    v_exp_f32 v248, v248
    v_mfma_f32_16x16x32_bf16 v[252:255], a[248:251], v[204:207], v[252:255]
    s_add_u32 m0, m0, 4096
    v_exp_f32 v249, v249
    v_mfma_f32_16x16x32_bf16 v[252:255], a[252:255], v[236:239], v[252:255]
    buffer_load_dwordx4 v1, s[36:39], s100 offen sc1 lds
    v_mfma_f32_16x16x32_bf16 a[56:59], v[120:123], v[48:51], a[56:59]
    v_exp_f32 v250, v250
    v_mfma_f32_16x16x32_bf16 a[56:59], v[124:127], v[52:55], a[56:59]
    v_exp_f32 v251, v251
    v_mfma_f32_16x16x32_bf16 a[60:63], v[120:123], v[56:59], a[60:63]
    v_cvt_pk_bf16_f32 v82, v248, v249
    v_cvt_pk_bf16_f32 v83, v250, v251
    v_mfma_f32_16x16x32_bf16 a[60:63], v[124:127], v[60:63], a[60:63]
    s_waitcnt lgkmcnt(0)
    v_exp_f32 v252, v252
    v_mfma_f32_16x16x32_bf16 v[240:243], a[224:227], v[128:131], v[184:187]
    v_exp_f32 v253, v253
    v_mfma_f32_16x16x32_bf16 v[240:243], a[228:231], v[160:163], v[240:243]
    v_exp_f32 v254, v254
    v_mfma_f32_16x16x32_bf16 v[240:243], a[232:235], v[192:195], v[240:243]
    v_exp_f32 v255, v255
    v_mfma_f32_16x16x32_bf16 v[240:243], a[236:239], v[224:227], v[240:243]
    v_cvt_pk_bf16_f32 v90, v252, v253
    v_cvt_pk_bf16_f32 v91, v254, v255
    v_mfma_f32_16x16x32_bf16 a[144:147], v[96:99], v[32:35], a[144:147]
    v_mfma_f32_16x16x32_bf16 a[144:147], v[100:103], v[36:39], a[144:147]
    ds_read_b128 v[104:107], v2 offset:26624
    ds_read_b128 v[108:111], v2 offset:27648
    v_mfma_f32_16x16x32_bf16 a[148:151], v[96:99], v[40:43], a[148:151]
    v_mfma_f32_16x16x32_bf16 a[148:151], v[100:103], v[44:47], a[148:151]
    buffer_load_dwordx4 v1, s[36:39], s100 offen offset:1024 sc1 lds
    v_mfma_f32_16x16x32_bf16 v[244:247], a[224:227], v[132:135], v[148:151]
    v_exp_f32 v240, v240
    v_mfma_f32_16x16x32_bf16 v[244:247], a[228:231], v[164:167], v[244:247]
    v_exp_f32 v241, v241
    v_mfma_f32_16x16x32_bf16 v[244:247], a[232:235], v[196:199], v[244:247]
    v_exp_f32 v242, v242
    v_mfma_f32_16x16x32_bf16 v[244:247], a[236:239], v[228:231], v[244:247]
    v_exp_f32 v243, v243
    v_mfma_f32_16x16x32_bf16 a[152:155], v[96:99], v[48:51], a[152:155]
    v_cvt_pk_bf16_f32 v68, v240, v241
    v_cvt_pk_bf16_f32 v69, v242, v243
    v_mfma_f32_16x16x32_bf16 a[152:155], v[100:103], v[52:55], a[152:155]
    v_mfma_f32_16x16x32_bf16 a[156:159], v[96:99], v[56:59], a[156:159]
    v_mfma_f32_16x16x32_bf16 a[156:159], v[100:103], v[60:63], a[156:159]
    v_mfma_f32_16x16x32_bf16 v[248:251], a[224:227], v[136:139], v[152:155]
    v_exp_f32 v244, v244
    v_mfma_f32_16x16x32_bf16 v[248:251], a[228:231], v[168:171], v[248:251]
    ds_read_b128 a[240:243], v2 offset:12288
    ds_read_b128 a[244:247], v2 offset:13312
    v_mfma_f32_16x16x32_bf16 v[248:251], a[232:235], v[200:203], v[248:251]
    v_exp_f32 v245, v245
    v_mfma_f32_16x16x32_bf16 v[248:251], a[236:239], v[232:235], v[248:251]
    s_waitcnt lgkmcnt(2)
    ds_read_b128 a[248:251], v2 offset:14336
    ds_read_b128 a[252:255], v2 offset:15360
    v_mfma_f32_16x16x32_bf16 a[160:163], v[104:107], v[32:35], a[160:163]
    buffer_load_dwordx4 v1, s[36:39], s100 offen offset:2048 sc1 lds
    v_mfma_f32_16x16x32_bf16 a[160:163], v[108:111], v[36:39], a[160:163]
    ds_read_b128 v[112:115], v2 offset:28672
    ds_read_b128 v[116:119], v2 offset:29696
    v_mfma_f32_16x16x32_bf16 a[164:167], v[104:107], v[40:43], a[164:167]
    v_exp_f32 v246, v246
    v_mfma_f32_16x16x32_bf16 a[164:167], v[108:111], v[44:47], a[164:167]
    v_exp_f32 v247, v247
    v_mfma_f32_16x16x32_bf16 v[252:255], a[224:227], v[140:143], v[156:159]
    v_cvt_pk_bf16_f32 v76, v244, v245
    v_cvt_pk_bf16_f32 v77, v246, v247
    v_mfma_f32_16x16x32_bf16 v[252:255], a[228:231], v[172:175], v[252:255]
    v_exp_f32 v248, v248
    v_mfma_f32_16x16x32_bf16 v[252:255], a[232:235], v[204:207], v[252:255]
    v_exp_f32 v249, v249
    v_mfma_f32_16x16x32_bf16 v[252:255], a[236:239], v[236:239], v[252:255]
    v_exp_f32 v250, v250
    v_mfma_f32_16x16x32_bf16 a[168:171], v[104:107], v[48:51], a[168:171]
    v_exp_f32 v251, v251
    v_mfma_f32_16x16x32_bf16 a[168:171], v[108:111], v[52:55], a[168:171]
    v_cvt_pk_bf16_f32 v84, v248, v249
    v_cvt_pk_bf16_f32 v85, v250, v251
    v_mfma_f32_16x16x32_bf16 a[172:175], v[104:107], v[56:59], a[172:175]
    v_mfma_f32_16x16x32_bf16 a[172:175], v[108:111], v[60:63], a[172:175]
    s_waitcnt lgkmcnt(0)
    v_exp_f32 v252, v252
    v_mfma_f32_16x16x32_bf16 v[240:243], a[240:243], v[128:131], v[188:191]
    v_exp_f32 v253, v253
    v_mfma_f32_16x16x32_bf16 v[240:243], a[244:247], v[160:163], v[240:243]
    buffer_load_dwordx4 v1, s[36:39], s100 offen offset:3072 sc1 lds
    v_mfma_f32_16x16x32_bf16 v[240:243], a[248:251], v[192:195], v[240:243]
    v_exp_f32 v254, v254
    v_mfma_f32_16x16x32_bf16 v[240:243], a[252:255], v[224:227], v[240:243]
    v_exp_f32 v255, v255
    v_mfma_f32_16x16x32_bf16 a[176:179], v[112:115], v[32:35], a[176:179]
    v_cvt_pk_bf16_f32 v92, v252, v253
    v_cvt_pk_bf16_f32 v93, v254, v255
    v_mfma_f32_16x16x32_bf16 a[176:179], v[116:119], v[36:39], a[176:179]
    ds_read_b128 v[120:123], v2 offset:30720
    ds_read_b128 v[124:127], v2 offset:31744
    v_mfma_f32_16x16x32_bf16 a[180:183], v[112:115], v[40:43], a[180:183]
    v_exp_f32 v240, v240
    v_mfma_f32_16x16x32_bf16 a[180:183], v[116:119], v[44:47], a[180:183]
    v_exp_f32 v241, v241
    v_mfma_f32_16x16x32_bf16 v[244:247], a[240:243], v[132:135], v[148:151]
    v_add_u32 v2, s82, v1
    v_cvt_pk_bf16_f32 v70, v240, v241
    v_mfma_f32_16x16x32_bf16 v[244:247], a[244:247], v[164:167], v[244:247]
    v_exp_f32 v242, v242
    v_mfma_f32_16x16x32_bf16 v[244:247], a[248:251], v[196:199], v[244:247]
    v_exp_f32 v243, v243
    v_mfma_f32_16x16x32_bf16 v[244:247], a[252:255], v[228:231], v[244:247]
    v_cvt_pk_bf16_f32 v71, v242, v243
    v_mfma_f32_16x16x32_bf16 a[184:187], v[112:115], v[48:51], a[184:187]
    v_mfma_f32_16x16x32_bf16 a[184:187], v[116:119], v[52:55], a[184:187]
    v_mfma_f32_16x16x32_bf16 a[188:191], v[112:115], v[56:59], a[188:191]
    s_add_u32 s77, s77, 32768
    v_mfma_f32_16x16x32_bf16 a[188:191], v[116:119], v[60:63], a[188:191]
    v_mfma_f32_16x16x32_bf16 v[248:251], a[240:243], v[136:139], v[152:155]
    v_mfma_f32_16x16x32_bf16 v[248:251], a[244:247], v[168:171], v[248:251]
    v_exp_f32 v244, v244
    v_mfma_f32_16x16x32_bf16 v[248:251], a[248:251], v[200:203], v[248:251]
    v_exp_f32 v245, v245
    v_mfma_f32_16x16x32_bf16 v[248:251], a[252:255], v[232:235], v[248:251]
    s_waitcnt lgkmcnt(0)
    v_exp_f32 v246, v246
    v_mfma_f32_16x16x32_bf16 a[192:195], v[120:123], v[32:35], a[192:195]
    v_exp_f32 v247, v247
    v_mfma_f32_16x16x32_bf16 a[192:195], v[124:127], v[36:39], a[192:195]
    ds_read_b128 a[224:227], v2 offset:0
    ds_read_b128 a[228:231], v2 offset:1024
    v_mfma_f32_16x16x32_bf16 a[196:199], v[120:123], v[40:43], a[196:199]
    ds_read_b128 a[232:235], v2 offset:2048
    v_cvt_pk_bf16_f32 v78, v244, v245
    v_mfma_f32_16x16x32_bf16 a[196:199], v[124:127], v[44:47], a[196:199]
    ds_read_b128 a[236:239], v2 offset:3072
    v_cvt_pk_bf16_f32 v79, v246, v247
    v_mfma_f32_16x16x32_bf16 v[252:255], a[240:243], v[140:143], v[156:159]
    v_exp_f32 v248, v248
    v_mfma_f32_16x16x32_bf16 v[252:255], a[244:247], v[172:175], v[252:255]
    ds_read_b128 v[96:99], v2 offset:16384
    ds_read_b128 v[100:103], v2 offset:17408
    v_mfma_f32_16x16x32_bf16 v[252:255], a[248:251], v[204:207], v[252:255]
    v_exp_f32 v249, v249
    v_mfma_f32_16x16x32_bf16 v[252:255], a[252:255], v[236:239], v[252:255]
    v_exp_f32 v250, v250
    v_mfma_f32_16x16x32_bf16 a[200:203], v[120:123], v[48:51], a[200:203]
    v_exp_f32 v251, v251
    v_mfma_f32_16x16x32_bf16 a[200:203], v[124:127], v[52:55], a[200:203]
    v_cvt_pk_bf16_f32 v86, v248, v249
    v_cvt_pk_bf16_f32 v87, v250, v251
    v_mfma_f32_16x16x32_bf16 a[204:207], v[120:123], v[56:59], a[204:207]
    v_mfma_f32_16x16x32_bf16 a[204:207], v[124:127], v[60:63], a[204:207]
    v_exp_f32 v252, v252
    v_smfmac_f32_16x16x64_bf16 a[208:211], a[136:139], v[32:39], v215
    v_smfmac_f32_16x16x64_bf16 a[212:215], a[136:139], v[40:47], v215
    v_smfmac_f32_16x16x64_bf16 a[216:219], a[136:139], v[48:55], v215
    s_cmp_le_u32 s78, 1
    v_smfmac_f32_16x16x64_bf16 a[220:223], a[136:139], v[56:63], v215
    s_cbranch_scc1 K1_LB_MASK
K1_LB_BACK:
    s_waitcnt lgkmcnt(0)
    v_mfma_f32_16x16x32_bf16 v[240:243], a[224:227], v[128:131], v[176:179]
    s_mov_b32 s99, s76
    v_exp_f32 v253, v253
    v_mfma_f32_16x16x32_bf16 v[240:243], a[228:231], v[160:163], v[240:243]
    v_exp_f32 v254, v254
    v_mfma_f32_16x16x32_bf16 v[240:243], a[232:235], v[192:195], v[240:243]
    v_exp_f32 v255, v255
    v_mfma_f32_16x16x32_bf16 v[240:243], a[236:239], v[224:227], v[240:243]
    v_cvt_pk_bf16_f32 v94, v252, v253
    v_cvt_pk_bf16_f32 v95, v254, v255
    v_mfma_f32_16x16x32_bf16 a[0:3], v[96:99], v[64:67], a[0:3]
    s_add_u32 m0, s76, s75
    v_mfma_f32_16x16x32_bf16 a[0:3], v[100:103], v[68:71], a[0:3]
    s_mov_b32 s76, s60
    buffer_load_dwordx4 v1, s[36:39], s77 offen sc1 lds
    v_mfma_f32_16x16x32_bf16 a[4:7], v[96:99], v[72:75], a[4:7]
    s_mov_b32 s60, s82
    ds_read_b128 v[104:107], v2 offset:18432
    ds_read_b128 v[108:111], v2 offset:19456
    v_mfma_f32_16x16x32_bf16 a[4:7], v[100:103], v[76:79], a[4:7]
    s_mov_b32 s82, s95
    v_exp_f32 v240, v240
    v_mfma_f32_16x16x32_bf16 v[244:247], a[224:227], v[132:135], v[148:151]
    s_mov_b32 s95, s93
    v_exp_f32 v241, v241
    v_mfma_f32_16x16x32_bf16 v[244:247], a[228:231], v[164:167], v[244:247]
    s_mov_b32 s93, s99
    v_exp_f32 v242, v242
    v_mfma_f32_16x16x32_bf16 v[244:247], a[232:235], v[196:199], v[244:247]
    v_exp_f32 v243, v243
    v_mfma_f32_16x16x32_bf16 v[244:247], a[236:239], v[228:231], v[244:247]
    v_cvt_pk_bf16_f32 v32, v240, v241
    v_cvt_pk_bf16_f32 v33, v242, v243
    v_mfma_f32_16x16x32_bf16 a[8:11], v[96:99], v[80:83], a[8:11]
    v_mfma_f32_16x16x32_bf16 a[8:11], v[100:103], v[84:87], a[8:11]
    v_mfma_f32_16x16x32_bf16 a[12:15], v[96:99], v[88:91], a[12:15]
    v_mfma_f32_16x16x32_bf16 a[12:15], v[100:103], v[92:95], a[12:15]
    v_mfma_f32_16x16x32_bf16 v[248:251], a[224:227], v[136:139], v[152:155]
    v_mfma_f32_16x16x32_bf16 v[248:251], a[228:231], v[168:171], v[248:251]
    ds_read_b128 a[240:243], v2 offset:4096
    ds_read_b128 a[244:247], v2 offset:5120
    v_mfma_f32_16x16x32_bf16 v[248:251], a[232:235], v[200:203], v[248:251]
    buffer_load_dwordx4 v1, s[36:39], s77 offen offset:1024 sc1 lds
    v_mfma_f32_16x16x32_bf16 v[248:251], a[236:239], v[232:235], v[248:251]
    s_waitcnt lgkmcnt(2)
    ds_read_b128 a[248:251], v2 offset:6144
    ds_read_b128 a[252:255], v2 offset:7168
    v_mfma_f32_16x16x32_bf16 a[16:19], v[104:107], v[64:67], a[16:19]
    v_exp_f32 v244, v244
    v_mfma_f32_16x16x32_bf16 a[16:19], v[108:111], v[68:71], a[16:19]
    ds_read_b128 v[112:115], v2 offset:20480
    ds_read_b128 v[116:119], v2 offset:21504
    v_mfma_f32_16x16x32_bf16 a[20:23], v[104:107], v[72:75], a[20:23]
    v_exp_f32 v245, v245
    v_mfma_f32_16x16x32_bf16 a[20:23], v[108:111], v[76:79], a[20:23]
    v_exp_f32 v246, v246
    v_mfma_f32_16x16x32_bf16 v[252:255], a[224:227], v[140:143], v[156:159]
    v_exp_f32 v247, v247
    v_mfma_f32_16x16x32_bf16 v[252:255], a[228:231], v[172:175], v[252:255]
    v_cvt_pk_bf16_f32 v40, v244, v245
    v_cvt_pk_bf16_f32 v41, v246, v247
    v_mfma_f32_16x16x32_bf16 v[252:255], a[232:235], v[204:207], v[252:255]
    v_exp_f32 v248, v248
    v_mfma_f32_16x16x32_bf16 v[252:255], a[236:239], v[236:239], v[252:255]
    v_exp_f32 v249, v249
    v_mfma_f32_16x16x32_bf16 a[24:27], v[104:107], v[80:83], a[24:27]
    v_exp_f32 v250, v250
    v_mfma_f32_16x16x32_bf16 a[24:27], v[108:111], v[84:87], a[24:27]
    v_exp_f32 v251, v251
    v_mfma_f32_16x16x32_bf16 a[28:31], v[104:107], v[88:91], a[28:31]
    v_cvt_pk_bf16_f32 v48, v248, v249
    v_cvt_pk_bf16_f32 v49, v250, v251
    v_mfma_f32_16x16x32_bf16 a[28:31], v[108:111], v[92:95], a[28:31]
    s_waitcnt lgkmcnt(0)
    buffer_load_dwordx4 v1, s[36:39], s77 offen offset:2048 sc1 lds
    v_mfma_f32_16x16x32_bf16 v[240:243], a[240:243], v[128:131], v[180:183]
    v_exp_f32 v252, v252
    v_mfma_f32_16x16x32_bf16 v[240:243], a[244:247], v[160:163], v[240:243]
    v_exp_f32 v253, v253
    v_mfma_f32_16x16x32_bf16 v[240:243], a[248:251], v[192:195], v[240:243]
    v_exp_f32 v254, v254
    v_mfma_f32_16x16x32_bf16 v[240:243], a[252:255], v[224:227], v[240:243]
    v_exp_f32 v255, v255
    v_mfma_f32_16x16x32_bf16 a[32:35], v[112:115], v[64:67], a[32:35]
    v_cvt_pk_bf16_f32 v56, v252, v253
    v_cvt_pk_bf16_f32 v57, v254, v255
    v_mfma_f32_16x16x32_bf16 a[32:35], v[116:119], v[68:71], a[32:35]
    ds_read_b128 v[120:123], v2 offset:22528
    ds_read_b128 v[124:127], v2 offset:23552
    v_mfma_f32_16x16x32_bf16 a[36:39], v[112:115], v[72:75], a[36:39]
    v_exp_f32 v240, v240
    v_mfma_f32_16x16x32_bf16 a[36:39], v[116:119], v[76:79], a[36:39]
    v_exp_f32 v241, v241
    v_mfma_f32_16x16x32_bf16 v[244:247], a[240:243], v[132:135], v[148:151]
    v_exp_f32 v242, v242
    v_mfma_f32_16x16x32_bf16 v[244:247], a[244:247], v[164:167], v[244:247]
    v_exp_f32 v243, v243
    v_mfma_f32_16x16x32_bf16 v[244:247], a[248:251], v[196:199], v[244:247]
    v_cvt_pk_bf16_f32 v34, v240, v241
    v_cvt_pk_bf16_f32 v35, v242, v243
    v_mfma_f32_16x16x32_bf16 v[244:247], a[252:255], v[228:231], v[244:247]
    v_mfma_f32_16x16x32_bf16 a[40:43], v[112:115], v[80:83], a[40:43]
    buffer_load_dwordx4 v1, s[36:39], s77 offen offset:3072 sc1 lds
    v_mfma_f32_16x16x32_bf16 a[40:43], v[116:119], v[84:87], a[40:43]
    v_mfma_f32_16x16x32_bf16 a[44:47], v[112:115], v[88:91], a[44:47]
    v_mfma_f32_16x16x32_bf16 a[44:47], v[116:119], v[92:95], a[44:47]
    v_mfma_f32_16x16x32_bf16 v[248:251], a[240:243], v[136:139], v[152:155]
    v_mfma_f32_16x16x32_bf16 v[248:251], a[244:247], v[168:171], v[248:251]
    ds_read_b128 a[224:227], v2 offset:8192
    ds_read_b128 a[228:231], v2 offset:9216
    v_mfma_f32_16x16x32_bf16 v[248:251], a[248:251], v[200:203], v[248:251]
    v_exp_f32 v244, v244
    v_mfma_f32_16x16x32_bf16 v[248:251], a[252:255], v[232:235], v[248:251]
    s_waitcnt lgkmcnt(2)
    ds_read_b128 a[232:235], v2 offset:10240
    ds_read_b128 a[236:239], v2 offset:11264
    v_mfma_f32_16x16x32_bf16 a[48:51], v[120:123], v[64:67], a[48:51]
    v_exp_f32 v245, v245
    v_mfma_f32_16x16x32_bf16 a[48:51], v[124:127], v[68:71], a[48:51]
    ds_read_b128 v[96:99], v2 offset:24576
    ds_read_b128 v[100:103], v2 offset:25600
    v_mfma_f32_16x16x32_bf16 a[52:55], v[120:123], v[72:75], a[52:55]
    v_exp_f32 v246, v246
    v_mfma_f32_16x16x32_bf16 a[52:55], v[124:127], v[76:79], a[52:55]
    v_exp_f32 v247, v247
    v_mfma_f32_16x16x32_bf16 v[252:255], a[240:243], v[140:143], v[156:159]
    v_cvt_pk_bf16_f32 v42, v244, v245
    v_cvt_pk_bf16_f32 v43, v246, v247
    v_mfma_f32_16x16x32_bf16 v[252:255], a[244:247], v[172:175], v[252:255]
    s_add_u32 s100, s77, 4096
    v_exp_f32 v248, v248
    v_mfma_f32_16x16x32_bf16 v[252:255], a[248:251], v[204:207], v[252:255]
    s_add_u32 m0, m0, 4096
    v_exp_f32 v249, v249
    v_mfma_f32_16x16x32_bf16 v[252:255], a[252:255], v[236:239], v[252:255]
    buffer_load_dwordx4 v1, s[36:39], s100 offen sc1 lds
    v_mfma_f32_16x16x32_bf16 a[56:59], v[120:123], v[80:83], a[56:59]
    v_exp_f32 v250, v250
    v_mfma_f32_16x16x32_bf16 a[56:59], v[124:127], v[84:87], a[56:59]
    v_exp_f32 v251, v251
    v_mfma_f32_16x16x32_bf16 a[60:63], v[120:123], v[88:91], a[60:63]
    v_cvt_pk_bf16_f32 v50, v248, v249
    v_cvt_pk_bf16_f32 v51, v250, v251
    v_mfma_f32_16x16x32_bf16 a[60:63], v[124:127], v[92:95], a[60:63]
    s_waitcnt lgkmcnt(0)
    v_exp_f32 v252, v252
    v_mfma_f32_16x16x32_bf16 v[240:243], a[224:227], v[128:131], v[184:187]
    v_exp_f32 v253, v253
    v_mfma_f32_16x16x32_bf16 v[240:243], a[228:231], v[160:163], v[240:243]
    v_exp_f32 v254, v254
    v_mfma_f32_16x16x32_bf16 v[240:243], a[232:235], v[192:195], v[240:243]
    v_exp_f32 v255, v255
    v_mfma_f32_16x16x32_bf16 v[240:243], a[236:239], v[224:227], v[240:243]
    v_cvt_pk_bf16_f32 v58, v252, v253
    v_cvt_pk_bf16_f32 v59, v254, v255
    v_mfma_f32_16x16x32_bf16 a[144:147], v[96:99], v[64:67], a[144:147]
    v_mfma_f32_16x16x32_bf16 a[144:147], v[100:103], v[68:71], a[144:147]
    ds_read_b128 v[104:107], v2 offset:26624
    ds_read_b128 v[108:111], v2 offset:27648
    v_mfma_f32_16x16x32_bf16 a[148:151], v[96:99], v[72:75], a[148:151]
    v_mfma_f32_16x16x32_bf16 a[148:151], v[100:103], v[76:79], a[148:151]
    buffer_load_dwordx4 v1, s[36:39], s100 offen offset:1024 sc1 lds
    v_mfma_f32_16x16x32_bf16 v[244:247], a[224:227], v[132:135], v[148:151]
    v_exp_f32 v240, v240
    v_mfma_f32_16x16x32_bf16 v[244:247], a[228:231], v[164:167], v[244:247]
    v_exp_f32 v241, v241
    v_mfma_f32_16x16x32_bf16 v[244:247], a[232:235], v[196:199], v[244:247]
    v_exp_f32 v242, v242
    v_mfma_f32_16x16x32_bf16 v[244:247], a[236:239], v[228:231], v[244:247]
    v_exp_f32 v243, v243
    v_mfma_f32_16x16x32_bf16 a[152:155], v[96:99], v[80:83], a[152:155]
    v_cvt_pk_bf16_f32 v36, v240, v241
    v_cvt_pk_bf16_f32 v37, v242, v243
    v_mfma_f32_16x16x32_bf16 a[152:155], v[100:103], v[84:87], a[152:155]
    v_mfma_f32_16x16x32_bf16 a[156:159], v[96:99], v[88:91], a[156:159]
    v_mfma_f32_16x16x32_bf16 a[156:159], v[100:103], v[92:95], a[156:159]
    v_mfma_f32_16x16x32_bf16 v[248:251], a[224:227], v[136:139], v[152:155]
    v_exp_f32 v244, v244
    v_mfma_f32_16x16x32_bf16 v[248:251], a[228:231], v[168:171], v[248:251]
    ds_read_b128 a[240:243], v2 offset:12288
    ds_read_b128 a[244:247], v2 offset:13312
    v_mfma_f32_16x16x32_bf16 v[248:251], a[232:235], v[200:203], v[248:251]
    v_exp_f32 v245, v245
    v_mfma_f32_16x16x32_bf16 v[248:251], a[236:239], v[232:235], v[248:251]
    s_waitcnt lgkmcnt(2)
    ds_read_b128 a[248:251], v2 offset:14336
    ds_read_b128 a[252:255], v2 offset:15360
    v_mfma_f32_16x16x32_bf16 a[160:163], v[104:107], v[64:67], a[160:163]
    buffer_load_dwordx4 v1, s[36:39], s100 offen offset:2048 sc1 lds
    v_mfma_f32_16x16x32_bf16 a[160:163], v[108:111], v[68:71], a[160:163]
    ds_read_b128 v[112:115], v2 offset:28672
    ds_read_b128 v[116:119], v2 offset:29696
    v_mfma_f32_16x16x32_bf16 a[164:167], v[104:107], v[72:75], a[164:167]
    v_exp_f32 v246, v246
    v_mfma_f32_16x16x32_bf16 a[164:167], v[108:111], v[76:79], a[164:167]
    v_exp_f32 v247, v247
    v_mfma_f32_16x16x32_bf16 v[252:255], a[224:227], v[140:143], v[156:159]
    v_cvt_pk_bf16_f32 v44, v244, v245
    v_cvt_pk_bf16_f32 v45, v246, v247
    v_mfma_f32_16x16x32_bf16 v[252:255], a[228:231], v[172:175], v[252:255]
    v_exp_f32 v248, v248
    v_mfma_f32_16x16x32_bf16 v[252:255], a[232:235], v[204:207], v[252:255]
    v_exp_f32 v249, v249
    v_mfma_f32_16x16x32_bf16 v[252:255], a[236:239], v[236:239], v[252:255]
    v_exp_f32 v250, v250
    v_mfma_f32_16x16x32_bf16 a[168:171], v[104:107], v[80:83], a[168:171]
    v_exp_f32 v251, v251
    v_mfma_f32_16x16x32_bf16 a[168:171], v[108:111], v[84:87], a[168:171]
    v_cvt_pk_bf16_f32 v52, v248, v249
    v_cvt_pk_bf16_f32 v53, v250, v251
    v_mfma_f32_16x16x32_bf16 a[172:175], v[104:107], v[88:91], a[172:175]
    v_mfma_f32_16x16x32_bf16 a[172:175], v[108:111], v[92:95], a[172:175]
    s_waitcnt lgkmcnt(0)
    v_exp_f32 v252, v252
    v_mfma_f32_16x16x32_bf16 v[240:243], a[240:243], v[128:131], v[188:191]
    v_exp_f32 v253, v253
    v_mfma_f32_16x16x32_bf16 v[240:243], a[244:247], v[160:163], v[240:243]
    buffer_load_dwordx4 v1, s[36:39], s100 offen offset:3072 sc1 lds
    v_mfma_f32_16x16x32_bf16 v[240:243], a[248:251], v[192:195], v[240:243]
    v_exp_f32 v254, v254
    v_mfma_f32_16x16x32_bf16 v[240:243], a[252:255], v[224:227], v[240:243]
    v_exp_f32 v255, v255
    v_mfma_f32_16x16x32_bf16 a[176:179], v[112:115], v[64:67], a[176:179]
    v_cvt_pk_bf16_f32 v60, v252, v253
    v_cvt_pk_bf16_f32 v61, v254, v255
    v_mfma_f32_16x16x32_bf16 a[176:179], v[116:119], v[68:71], a[176:179]
    ds_read_b128 v[120:123], v2 offset:30720
    ds_read_b128 v[124:127], v2 offset:31744
    v_mfma_f32_16x16x32_bf16 a[180:183], v[112:115], v[72:75], a[180:183]
    v_exp_f32 v240, v240
    v_mfma_f32_16x16x32_bf16 a[180:183], v[116:119], v[76:79], a[180:183]
    v_exp_f32 v241, v241
    v_mfma_f32_16x16x32_bf16 v[244:247], a[240:243], v[132:135], v[148:151]
    v_add_u32 v2, s82, v1
    v_cvt_pk_bf16_f32 v38, v240, v241
    v_mfma_f32_16x16x32_bf16 v[244:247], a[244:247], v[164:167], v[244:247]
    v_exp_f32 v242, v242
    v_mfma_f32_16x16x32_bf16 v[244:247], a[248:251], v[196:199], v[244:247]
    v_exp_f32 v243, v243
    v_mfma_f32_16x16x32_bf16 v[244:247], a[252:255], v[228:231], v[244:247]
    v_cvt_pk_bf16_f32 v39, v242, v243
    v_mfma_f32_16x16x32_bf16 a[184:187], v[112:115], v[80:83], a[184:187]
    v_mfma_f32_16x16x32_bf16 a[184:187], v[116:119], v[84:87], a[184:187]
    v_mfma_f32_16x16x32_bf16 a[188:191], v[112:115], v[88:91], a[188:191]
    s_add_u32 s77, s77, 32768
    v_mfma_f32_16x16x32_bf16 a[188:191], v[116:119], v[92:95], a[188:191]
    v_mfma_f32_16x16x32_bf16 v[248:251], a[240:243], v[136:139], v[152:155]
    v_mfma_f32_16x16x32_bf16 v[248:251], a[244:247], v[168:171], v[248:251]
    v_exp_f32 v244, v244
    v_mfma_f32_16x16x32_bf16 v[248:251], a[248:251], v[200:203], v[248:251]
    v_exp_f32 v245, v245
    v_mfma_f32_16x16x32_bf16 v[248:251], a[252:255], v[232:235], v[248:251]
    s_waitcnt lgkmcnt(0)
    v_exp_f32 v246, v246
    v_mfma_f32_16x16x32_bf16 a[192:195], v[120:123], v[64:67], a[192:195]
    v_exp_f32 v247, v247
    v_mfma_f32_16x16x32_bf16 a[192:195], v[124:127], v[68:71], a[192:195]
    v_cvt_pk_bf16_f32 v46, v244, v245
    v_cvt_pk_bf16_f32 v47, v246, v247
    v_mfma_f32_16x16x32_bf16 a[196:199], v[120:123], v[72:75], a[196:199]
    s_waitcnt vmcnt(8) lgkmcnt(0)
    v_exp_f32 v248, v248
    v_mfma_f32_16x16x32_bf16 a[196:199], v[124:127], v[76:79], a[196:199]
    s_barrier
    ds_read_b128 a[224:227], v2 offset:0
    ds_read_b128 a[228:231], v2 offset:1024
    v_mfma_f32_16x16x32_bf16 v[252:255], a[240:243], v[140:143], v[156:159]
    v_exp_f32 v249, v249
    v_mfma_f32_16x16x32_bf16 v[252:255], a[244:247], v[172:175], v[252:255]
    ds_read_b128 a[232:235], v2 offset:2048
    ds_read_b128 a[236:239], v2 offset:3072
    v_mfma_f32_16x16x32_bf16 v[252:255], a[248:251], v[204:207], v[252:255]
    ds_read_b128 v[96:99], v2 offset:16384
    v_cvt_pk_bf16_f32 v54, v248, v249
    v_mfma_f32_16x16x32_bf16 v[252:255], a[252:255], v[236:239], v[252:255]
    v_exp_f32 v250, v250
    v_mfma_f32_16x16x32_bf16 a[200:203], v[120:123], v[80:83], a[200:203]
    v_exp_f32 v251, v251
    v_mfma_f32_16x16x32_bf16 a[200:203], v[124:127], v[84:87], a[200:203]
    ds_read_b128 v[100:103], v2 offset:17408
    v_cvt_pk_bf16_f32 v55, v250, v251
    v_mfma_f32_16x16x32_bf16 a[204:207], v[120:123], v[88:91], a[204:207]
    v_mfma_f32_16x16x32_bf16 a[204:207], v[124:127], v[92:95], a[204:207]
    v_exp_f32 v252, v252
    v_smfmac_f32_16x16x64_bf16 a[208:211], a[136:139], v[64:71], v215
    v_smfmac_f32_16x16x64_bf16 a[212:215], a[136:139], v[72:79], v215
    s_sub_u32 s78, s78, 1
    v_smfmac_f32_16x16x64_bf16 a[216:219], a[136:139], v[80:87], v215
    s_cmp_lg_u32 s78, 0
    v_smfmac_f32_16x16x64_bf16 a[220:223], a[136:139], v[88:95], v215
    s_cbranch_scc1 K1_LB
K1_LB_END:
    v_add_f32 v212, s12, v148
    v_fma_f32 v176, v208, s8, v212
    v_fma_f32 v177, v209, s8, v212
    v_fma_f32 v178, v210, s8, v212
    v_fma_f32 v179, v211, s8, v212
    s_nop 1
    s_waitcnt lgkmcnt(0)
    v_mfma_f32_16x16x32_bf16 v[240:243], a[224:227], v[132:135], v[176:179]
    s_mov_b32 s7, 0
    ds_read_b128 v[104:107], v2 offset:18432
    ds_read_b128 v[108:111], v2 offset:19456
    v_mfma_f32_16x16x32_bf16 v[240:243], a[228:231], v[164:167], v[240:243]
    s_mov_b32 s99, s76
    buffer_load_dwordx4 v[64:67], v11, s[48:51], s7 offen nt
    v_mfma_f32_16x16x32_bf16 v[240:243], a[232:235], v[196:199], v[240:243]
    s_mov_b32 s7, 18432
    v_exp_f32 v253, v253
    v_mfma_f32_16x16x32_bf16 v[240:243], a[236:239], v[228:231], v[240:243]
    s_lshl_b32 s29, s6, 2
    v_exp_f32 v254, v254
    v_mfma_f32_16x16x32_bf16 a[0:3], v[96:99], v[32:35], a[0:3]
    s_lshr_b32 s29, 0x41302413, s29
    v_exp_f32 v255, v255
    v_mfma_f32_16x16x32_bf16 a[0:3], v[100:103], v[36:39], a[0:3]
    s_and_b32 s29, s29, 7
    buffer_load_dwordx4 v[68:71], v11, s[48:51], s7 offen nt
    v_mfma_f32_16x16x32_bf16 a[4:7], v[96:99], v[40:43], a[4:7]
    s_mov_b32 s7, 9216
    v_cvt_pk_bf16_f32 v62, v252, v253
    v_cvt_pk_bf16_f32 v63, v254, v255
    v_mfma_f32_16x16x32_bf16 a[4:7], v[100:103], v[44:47], a[4:7]
    s_lshl_b32 s29, s29, 15
    ds_read_b128 a[240:243], v2 offset:4096
    ds_read_b128 a[244:247], v2 offset:5120
    v_mfma_f32_16x16x32_bf16 v[244:247], a[224:227], v[136:139], v[152:155]
    s_add_u32 s44, s29, s75
    ds_read_b128 a[248:251], v2 offset:6144
    v_add_f32 v213, s13, v148
    v_mfma_f32_16x16x32_bf16 v[244:247], a[228:231], v[168:171], v[244:247]
    s_lshl_b32 s29, s6, 2
    buffer_load_dwordx4 v[20:23], v11, s[48:51], s7 offen nt
    v_mfma_f32_16x16x32_bf16 v[244:247], a[232:235], v[200:203], v[244:247]
    s_mov_b32 s7, 27648
    ds_read_b128 a[252:255], v2 offset:7168
    ds_read_b128 v[112:115], v2 offset:20480
    v_mfma_f32_16x16x32_bf16 v[244:247], a[236:239], v[232:235], v[244:247]
    s_lshr_b32 s29, 0x2413024, s29
    ds_read_b128 v[116:119], v2 offset:21504
    v_fma_f32 v180, v208, s9, v213
    v_mfma_f32_16x16x32_bf16 a[8:11], v[96:99], v[48:51], a[8:11]
    s_and_b32 s29, s29, 7
    v_fma_f32 v181, v209, s9, v213
    v_fma_f32 v182, v210, s9, v213
    v_mfma_f32_16x16x32_bf16 a[8:11], v[100:103], v[52:55], a[8:11]
    s_lshl_b32 s29, s29, 15
    buffer_load_dwordx4 v[24:27], v11, s[48:51], s7 offen nt
    v_mfma_f32_16x16x32_bf16 a[12:15], v[96:99], v[56:59], a[12:15]
    s_add_u32 s45, s29, s75
    v_fma_f32 v183, v211, s9, v213
    ds_read_b128 v[120:123], v2 offset:22528
    v_mfma_f32_16x16x32_bf16 a[12:15], v[100:103], v[60:63], a[12:15]
    s_lshl_b32 s29, s6, 2
    v_exp_f32 v240, v240
    s_waitcnt lgkmcnt(2)
    v_mfma_f32_16x16x32_bf16 a[16:19], v[104:107], v[32:35], a[16:19]
    s_lshr_b32 s29, 0x13024130, s29
    v_exp_f32 v241, v241
    v_mfma_f32_16x16x32_bf16 a[16:19], v[108:111], v[36:39], a[16:19]
    s_and_b32 s29, s29, 7
    buffer_load_dwordx4 v[144:147], v12, s[52:55], 0 offen nt
    v_mfma_f32_16x16x32_bf16 v[248:251], a[224:227], v[140:143], v[156:159]
    s_lshl_b32 s29, s29, 15
    v_exp_f32 v242, v242
    v_mfma_f32_16x16x32_bf16 v[248:251], a[228:231], v[172:175], v[248:251]
    s_add_u32 s46, s29, s75
    v_exp_f32 v243, v243
    v_mfma_f32_16x16x32_bf16 v[248:251], a[232:235], v[204:207], v[248:251]
    s_lshl_b32 s29, s6, 2
    v_cvt_pk_bf16_f32 v72, v240, v241
    v_cvt_pk_bf16_f32 v73, v242, v243
    v_mfma_f32_16x16x32_bf16 v[248:251], a[236:239], v[236:239], v[248:251]
    s_lshr_b32 s29, 0x24130241, s29
    buffer_load_dwordx4 a[140:143], v13, s[52:55], 0 offen nt
    v_mfma_f32_16x16x32_bf16 a[20:23], v[104:107], v[40:43], a[20:23]
    s_and_b32 s29, s29, 7
    ds_read_b128 v[124:127], v2 offset:23552
    ds_read_b128 a[224:227], v2 offset:8192
    v_mfma_f32_16x16x32_bf16 a[20:23], v[108:111], v[44:47], a[20:23]
    s_lshl_b32 s29, s29, 15
    v_exp_f32 v244, v244
    v_mfma_f32_16x16x32_bf16 a[24:27], v[104:107], v[48:51], a[24:27]
    s_add_u32 s47, s29, s75
    v_exp_f32 v245, v245
    v_mfma_f32_16x16x32_bf16 a[24:27], v[108:111], v[52:55], a[24:27]
    s_lshl_b32 s29, s6, 2
    v_exp_f32 v246, v246
    v_mfma_f32_16x16x32_bf16 a[28:31], v[104:107], v[56:59], a[28:31]
    s_lshr_b32 s29, 0x30241302, s29
    v_exp_f32 v247, v247
    v_mfma_f32_16x16x32_bf16 a[28:31], v[108:111], v[60:63], a[28:31]
    s_and_b32 s29, s29, 7
    v_cvt_pk_bf16_f32 v80, v244, v245
    v_cvt_pk_bf16_f32 v81, v246, v247
    v_mfma_f32_16x16x32_bf16 v[252:255], a[240:243], v[132:135], v[180:183]
    s_mov_b32 s98, 0x3fb8aa3b
    ds_read_b128 a[228:231], v2 offset:9216
    ds_read_b128 a[232:235], v2 offset:10240
    v_mfma_f32_16x16x32_bf16 v[252:255], a[244:247], v[164:167], v[252:255]
    s_lshr_b32 s61, s5, 3
    ds_read_b128 a[236:239], v2 offset:11264
    v_add_f32 v212, s14, v148
    v_mfma_f32_16x16x32_bf16 v[252:255], a[248:251], v[196:199], v[252:255]
    s_lshl_b32 s29, s29, 15
    ds_read_b128 v[96:99], v2 offset:24576
    v_fma_f32 v184, v208, s10, v212
    v_mfma_f32_16x16x32_bf16 v[252:255], a[252:255], v[228:231], v[252:255]
    s_add_u32 s79, s29, s75
    ds_read_b128 v[100:103], v2 offset:25600
    v_fma_f32 v185, v209, s10, v212
    v_mfma_f32_16x16x32_bf16 a[32:35], v[112:115], v[32:35], a[32:35]
    s_mul_i32 s71, s61, 6144
    v_exp_f32 v248, v248
    s_waitcnt lgkmcnt(5)
    v_mfma_f32_16x16x32_bf16 a[32:35], v[116:119], v[36:39], a[32:35]
    s_and_b32 s29, s5, 7
    v_exp_f32 v249, v249
    v_mfma_f32_16x16x32_bf16 a[36:39], v[112:115], v[40:43], a[36:39]
    s_add_u32 s3, s5, s6
    v_exp_f32 v250, v250
    v_mfma_f32_16x16x32_bf16 a[36:39], v[116:119], v[44:47], a[36:39]
    s_add_u32 s71, s71, 131072
    v_exp_f32 v251, v251
    v_mfma_f32_16x16x32_bf16 v[240:243], a[240:243], v[136:139], v[152:155]
    s_lshl_b32 s29, s29, 8
    v_fma_f32 v186, v210, s10, v212
    v_fma_f32 v187, v211, s10, v212
    v_mfma_f32_16x16x32_bf16 v[240:243], a[244:247], v[168:171], v[240:243]
    s_add_u32 s74, s4, 1
    v_cvt_pk_bf16_f32 v88, v248, v249
    v_cvt_pk_bf16_f32 v89, v250, v251
    v_mfma_f32_16x16x32_bf16 v[240:243], a[248:251], v[200:203], v[240:243]
    s_and_b32 s28, s5, 3
    v_exp_f32 v252, v252
    v_mfma_f32_16x16x32_bf16 v[240:243], a[252:255], v[232:235], v[240:243]
    s_and_b32 s3, s3, 1
    v_exp_f32 v253, v253
    v_mfma_f32_16x16x32_bf16 a[40:43], v[112:115], v[48:51], a[40:43]
    s_lshl2_add_u32 s66, s6, s61
    v_exp_f32 v254, v254
    v_mfma_f32_16x16x32_bf16 a[40:43], v[116:119], v[52:55], a[40:43]
    s_add_u32 s71, s71, s29
    v_exp_f32 v255, v255
    v_mfma_f32_16x16x32_bf16 a[44:47], v[112:115], v[56:59], a[44:47]
    s_lshl_b32 s74, s74, 15
    v_cvt_pk_bf16_f32 v74, v252, v253
    v_cvt_pk_bf16_f32 v75, v254, v255
    v_mfma_f32_16x16x32_bf16 a[44:47], v[116:119], v[60:63], a[44:47]
    s_mul_i32 s28, s28, 9216
    ds_read_b128 v[104:107], v2 offset:26624
    ds_read_b128 v[108:111], v2 offset:27648
    v_mfma_f32_16x16x32_bf16 a[48:51], v[120:123], v[32:35], a[48:51]
    s_lshl3_add_u32 s3, s61, s3
    v_exp_f32 v240, v240
    v_mfma_f32_16x16x32_bf16 a[48:51], v[124:127], v[36:39], a[48:51]
    s_lshl_b32 s66, s66, 10
    v_exp_f32 v241, v241
    v_mfma_f32_16x16x32_bf16 v[244:247], a[240:243], v[140:143], v[156:159]
    s_add_u32 s70, s71, 4096
    v_exp_f32 v242, v242
    v_mfma_f32_16x16x32_bf16 v[244:247], a[244:247], v[172:175], v[244:247]
    s_add_u32 s71, s71, s29
    v_exp_f32 v243, v243
    v_mfma_f32_16x16x32_bf16 v[244:247], a[248:251], v[204:207], v[244:247]
    s_add_u32 s74, s74, s101
    v_cvt_pk_bf16_f32 v82, v240, v241
    v_cvt_pk_bf16_f32 v83, v242, v243
    v_mfma_f32_16x16x32_bf16 v[244:247], a[252:255], v[236:239], v[244:247]
    ds_read_b128 a[240:243], v2 offset:12288
    ds_read_b128 a[244:247], v2 offset:13312
    v_mfma_f32_16x16x32_bf16 a[52:55], v[120:123], v[40:43], a[52:55]
    ds_read_b128 a[248:251], v2 offset:14336
    v_add_f32 v213, s15, v148
    v_mfma_f32_16x16x32_bf16 a[52:55], v[124:127], v[44:47], a[52:55]
    ds_read_b128 a[252:255], v2 offset:15360
    v_fma_f32 v188, v208, s11, v213
    v_mfma_f32_16x16x32_bf16 a[56:59], v[120:123], v[48:51], a[56:59]
    ds_read_b128 v[112:115], v2 offset:28672
    v_fma_f32 v189, v209, s11, v213
    v_mfma_f32_16x16x32_bf16 a[56:59], v[124:127], v[52:55], a[56:59]
    ds_read_b128 v[116:119], v2 offset:29696
    v_fma_f32 v190, v210, s11, v213
    v_mfma_f32_16x16x32_bf16 a[60:63], v[120:123], v[56:59], a[60:63]
    v_exp_f32 v244, v244
    v_mfma_f32_16x16x32_bf16 a[60:63], v[124:127], v[60:63], a[60:63]
    v_exp_f32 v245, v245
    v_mfma_f32_16x16x32_bf16 v[248:251], a[224:227], v[132:135], v[184:187]
    s_waitcnt lgkmcnt(2)
    v_exp_f32 v246, v246
    v_mfma_f32_16x16x32_bf16 v[248:251], a[228:231], v[164:167], v[248:251]
    v_exp_f32 v247, v247
    v_mfma_f32_16x16x32_bf16 v[248:251], a[232:235], v[196:199], v[248:251]
    v_fma_f32 v191, v211, s11, v213
    v_cvt_pk_bf16_f32 v90, v244, v245
    v_mfma_f32_16x16x32_bf16 v[248:251], a[236:239], v[228:231], v[248:251]
    s_add_u32 m0, s76, s75
    v_cvt_pk_bf16_f32 v91, v246, v247
    ds_read_b128 v[120:123], v2 offset:30720
    v_mfma_f32_16x16x32_bf16 a[144:147], v[96:99], v[32:35], a[144:147]
    s_mov_b32 s76, s60
    buffer_load_dwordx4 v1, s[36:39], s77 offen sc1 lds
    v_mfma_f32_16x16x32_bf16 a[144:147], v[100:103], v[36:39], a[144:147]
    s_mov_b32 s60, s82
    v_exp_f32 v248, v248
    v_mfma_f32_16x16x32_bf16 a[148:151], v[96:99], v[40:43], a[148:151]
    s_mov_b32 s82, s95
    v_exp_f32 v249, v249
    v_mfma_f32_16x16x32_bf16 a[148:151], v[100:103], v[44:47], a[148:151]
    s_mov_b32 s95, s93
    v_exp_f32 v250, v250
    v_mfma_f32_16x16x32_bf16 v[252:255], a[224:227], v[136:139], v[152:155]
    s_mov_b32 s93, s99
    v_exp_f32 v251, v251
    v_mfma_f32_16x16x32_bf16 v[252:255], a[228:231], v[168:171], v[252:255]
    v_cvt_pk_bf16_f32 v76, v248, v249
    v_cvt_pk_bf16_f32 v77, v250, v251
    v_mfma_f32_16x16x32_bf16 v[252:255], a[232:235], v[200:203], v[252:255]
    ds_read_b128 v[124:127], v2 offset:31744
    v_add_u32 v2, s82, v1
    v_mfma_f32_16x16x32_bf16 v[252:255], a[236:239], v[232:235], v[252:255]
    buffer_load_dwordx4 v1, s[36:39], s77 offen offset:1024 sc1 lds
    v_mfma_f32_16x16x32_bf16 a[152:155], v[96:99], v[48:51], a[152:155]
    v_bfe_u32 v8, v1, 2, 6
    v_accvgpr_read_b32 v4, a112
    v_mfma_f32_16x16x32_bf16 a[152:155], v[100:103], v[52:55], a[152:155]
    v_accvgpr_read_b32 v5, a116
    v_add_u32 v8, 192, v8
    v_mfma_f32_16x16x32_bf16 a[156:159], v[96:99], v[56:59], a[156:159]
    v_exp_f32 v252, v252
    v_mfma_f32_16x16x32_bf16 a[156:159], v[100:103], v[60:63], a[156:159]
    v_exp_f32 v253, v253
    v_mfma_f32_16x16x32_bf16 a[160:163], v[104:107], v[32:35], a[160:163]
    v_exp_f32 v254, v254
    v_mfma_f32_16x16x32_bf16 a[160:163], v[108:111], v[36:39], a[160:163]
    v_exp_f32 v255, v255
    v_mfma_f32_16x16x32_bf16 v[240:243], a[224:227], v[140:143], v[156:159]
    buffer_load_dwordx4 v1, s[36:39], s77 offen offset:2048 sc1 lds
    v_mfma_f32_16x16x32_bf16 v[240:243], a[228:231], v[172:175], v[240:243]
    v_cvt_pk_bf16_f32 v84, v252, v253
    v_cvt_pk_bf16_f32 v85, v254, v255
    v_mfma_f32_16x16x32_bf16 v[240:243], a[232:235], v[204:207], v[240:243]
    v_cvt_pk_bf16_f32 v4, 0, v4
    v_cvt_pk_bf16_f32 v5, 0, v5
    v_mfma_f32_16x16x32_bf16 v[240:243], a[236:239], v[236:239], v[240:243]
    v_lshrrev_b32 v15, 8, v1
    ds_bpermute_b32 v4, v8, v4
    v_mfma_f32_16x16x32_bf16 a[164:167], v[104:107], v[40:43], a[164:167]
    ds_bpermute_b32 v5, v8, v5
    ds_read_b128 a[224:227], v2 offset:0
    v_mfma_f32_16x16x32_bf16 a[164:167], v[108:111], v[44:47], a[164:167]
    ds_read_b128 a[228:231], v2 offset:1024
    v_bfe_u32 v14, v1, 4, 4
    v_mfma_f32_16x16x32_bf16 a[168:171], v[104:107], v[48:51], a[168:171]
    ds_read_b128 a[232:235], v2 offset:2048
    v_lshlrev_b32 v15, 3, v15
    v_mfma_f32_16x16x32_bf16 a[168:171], v[108:111], v[52:55], a[168:171]
    buffer_load_dwordx4 v1, s[36:39], s77 offen offset:3072 sc1 lds
    v_mfma_f32_16x16x32_bf16 a[172:175], v[104:107], v[56:59], a[172:175]
    ds_read_b128 a[236:239], v2 offset:3072
    ds_read_b128 v[96:99], v2 offset:16384
    v_mfma_f32_16x16x32_bf16 a[172:175], v[108:111], v[60:63], a[172:175]
    ds_read_b128 v[100:103], v2 offset:17408
    v_sub_u32 v14, v14, v15
    v_mfma_f32_16x16x32_bf16 v[244:247], a[240:243], v[132:135], v[188:191]
    v_exp_f32 v240, v240
    v_mfma_f32_16x16x32_bf16 v[244:247], a[244:247], v[164:167], v[244:247]
    v_exp_f32 v241, v241
    v_mfma_f32_16x16x32_bf16 v[244:247], a[248:251], v[196:199], v[244:247]
    v_exp_f32 v242, v242
    v_mfma_f32_16x16x32_bf16 v[244:247], a[252:255], v[228:231], v[244:247]
    s_add_u32 s100, s77, 4096
    v_exp_f32 v243, v243
    s_waitcnt lgkmcnt(1)
    v_mfma_f32_16x16x32_bf16 a[176:179], v[112:115], v[32:35], a[176:179]
    s_add_u32 m0, m0, 4096
    v_cvt_pk_bf16_f32 v92, v240, v241
    v_cvt_pk_bf16_f32 v93, v242, v243
    v_mfma_f32_16x16x32_bf16 a[176:179], v[116:119], v[36:39], a[176:179]
    buffer_load_dwordx4 v1, s[36:39], s100 offen sc1 lds
    v_mfma_f32_16x16x32_bf16 a[180:183], v[112:115], v[40:43], a[180:183]
    v_exp_f32 v244, v244
    v_mfma_f32_16x16x32_bf16 a[180:183], v[116:119], v[44:47], a[180:183]
    v_exp_f32 v245, v245
    v_mfma_f32_16x16x32_bf16 v[248:251], a[240:243], v[136:139], v[152:155]
    v_exp_f32 v246, v246
    v_mfma_f32_16x16x32_bf16 v[248:251], a[244:247], v[168:171], v[248:251]
    v_exp_f32 v247, v247
    v_mfma_f32_16x16x32_bf16 v[248:251], a[248:251], v[200:203], v[248:251]
    v_cvt_pk_bf16_f32 v78, v244, v245
    v_cvt_pk_bf16_f32 v79, v246, v247
    v_mfma_f32_16x16x32_bf16 v[248:251], a[252:255], v[232:235], v[248:251]
    buffer_load_dwordx4 v1, s[36:39], s100 offen offset:1024 sc1 lds
    v_mfma_f32_16x16x32_bf16 a[184:187], v[112:115], v[48:51], a[184:187]
    v_and_b32 v15, 16, v1
    v_mov_b32 v31, 0x3f80
    v_mfma_f32_16x16x32_bf16 a[184:187], v[116:119], v[52:55], a[184:187]
    v_ashrrev_i32 v14, 1, v14
    v_lshlrev_b32 v15, v15, v31
    v_mfma_f32_16x16x32_bf16 a[188:191], v[112:115], v[56:59], a[188:191]
    v_exp_f32 v248, v248
    v_mfma_f32_16x16x32_bf16 a[188:191], v[116:119], v[60:63], a[188:191]
    v_exp_f32 v249, v249
    v_mfma_f32_16x16x32_bf16 a[192:195], v[120:123], v[32:35], a[192:195]
    v_exp_f32 v250, v250
    v_mfma_f32_16x16x32_bf16 a[192:195], v[124:127], v[36:39], a[192:195]
    v_exp_f32 v251, v251
    v_mfma_f32_16x16x32_bf16 v[252:255], a[240:243], v[140:143], v[156:159]
    buffer_load_dwordx4 v1, s[36:39], s100 offen offset:2048 sc1 lds
    v_mfma_f32_16x16x32_bf16 v[252:255], a[244:247], v[172:175], v[252:255]
    v_cvt_pk_bf16_f32 v86, v248, v249
    v_cvt_pk_bf16_f32 v87, v250, v251
    v_mfma_f32_16x16x32_bf16 v[252:255], a[248:251], v[204:207], v[252:255]
    v_cmp_eq_i32 vcc, 0, v14
    v_mul_f32 v4, s98, v4
    v_mfma_f32_16x16x32_bf16 v[252:255], a[252:255], v[236:239], v[252:255]
    v_cndmask_b32 v216, 0, v15, vcc
    v_cmp_eq_i32 vcc, 1, v14
    v_mfma_f32_16x16x32_bf16 a[196:199], v[120:123], v[40:43], a[196:199]
    v_mul_f32 v5, s98, v5
    v_cndmask_b32 v217, 0, v15, vcc
    v_mfma_f32_16x16x32_bf16 a[196:199], v[124:127], v[44:47], a[196:199]
    v_cmp_eq_i32 vcc, 2, v14
    v_and_b32 v31, 512, v1
    v_mfma_f32_16x16x32_bf16 a[200:203], v[120:123], v[48:51], a[200:203]
    v_exp_f32 v252, v252
    v_mfma_f32_16x16x32_bf16 a[200:203], v[124:127], v[52:55], a[200:203]
    buffer_load_dwordx4 v1, s[36:39], s100 offen offset:3072 sc1 lds
    v_mfma_f32_16x16x32_bf16 a[204:207], v[120:123], v[56:59], a[204:207]
    v_cndmask_b32 v218, 0, v15, vcc
    v_cmp_eq_i32 vcc, 3, v14
    v_mfma_f32_16x16x32_bf16 a[204:207], v[124:127], v[60:63], a[204:207]
    v_exp_f32 v4, v4
    v_smfmac_f32_16x16x64_bf16 a[208:211], a[136:139], v[32:39], v215
    v_cndmask_b32 v219, 0, v15, vcc
    v_cmp_eq_i32 vcc, -8, v14
    v_smfmac_f32_16x16x64_bf16 a[212:215], a[136:139], v[40:47], v215
    v_exp_f32 v5, v5
    v_smfmac_f32_16x16x64_bf16 a[216:219], a[136:139], v[48:55], v215
    v_cndmask_b32 v220, 0, v15, vcc
    v_cmp_eq_i32 vcc, -7, v14
    v_smfmac_f32_16x16x64_bf16 a[220:223], a[136:139], v[56:63], v215
    s_add_u32 s77, s77, 32768
    v_cndmask_b32 v221, 0, v15, vcc
    v_cmp_eq_i32 vcc, -6, v14
    v_add_f32 v4, 1.0, v4
    v_add_f32 v5, 1.0, v5
    v_cndmask_b32 v222, 0, v15, vcc
    v_cmp_eq_i32 vcc, -5, v14
    v_rcp_f32 v4, v4
    v_rcp_f32 v5, v5
    v_cndmask_b32 v223, 0, v15, vcc
    v_mad_u32_u24 v31, v31, 17, v1
    s_cmp_eq_u32 s6, 7
    s_cselect_b32 s16, s8, 0
    s_cselect_b32 s17, s9, 0
    s_cselect_b32 s18, s10, 0
    s_cselect_b32 s19, s11, 0
    s_cselect_b32 s20, s12, 0
    s_cselect_b32 s21, s13, 0
    s_cselect_b32 s22, s14, 0
    s_cselect_b32 s23, s15, 0
    s_cbranch_scc1 K1_J7
K1_J7_BACK:
    v_add_f32 v212, s20, v152
    v_fma_f32 v176, v208, s16, v212
    v_fma_f32 v177, v209, s16, v212
    v_fma_f32 v178, v210, s16, v212
    v_fma_f32 v179, v211, s16, v212
    s_nop 1
    s_waitcnt lgkmcnt(0)
    v_mfma_f32_16x16x32_bf16 v[240:243], a[224:227], v[136:139], v[176:179]
    s_mov_b32 s99, s76
    ds_read_b128 v[104:107], v2 offset:18432
    ds_read_b128 v[108:111], v2 offset:19456
    v_mfma_f32_16x16x32_bf16 v[240:243], a[228:231], v[168:171], v[240:243]
    v_exp_f32 v253, v253
    v_mfma_f32_16x16x32_bf16 v[240:243], a[232:235], v[200:203], v[240:243]
    v_exp_f32 v254, v254
    v_mfma_f32_16x16x32_bf16 v[240:243], a[236:239], v[232:235], v[240:243]
    v_exp_f32 v255, v255
    v_mfma_f32_16x16x32_bf16 a[4:7], v[96:99], v[72:75], a[4:7]
    s_add_u32 m0, s76, s75
    v_cvt_pk_bf16_f32 v94, v252, v253
    v_cvt_pk_bf16_f32 v95, v254, v255
    v_mfma_f32_16x16x32_bf16 a[4:7], v[100:103], v[76:79], a[4:7]
    s_mov_b32 s76, s60
    buffer_load_dwordx4 v1, s[36:39], s77 offen sc1 lds
    v_mfma_f32_16x16x32_bf16 a[8:11], v[96:99], v[80:83], a[8:11]
    s_mov_b32 s60, s82
    ds_read_b128 a[240:243], v2 offset:4096
    ds_read_b128 a[244:247], v2 offset:5120
    v_mfma_f32_16x16x32_bf16 a[8:11], v[100:103], v[84:87], a[8:11]
    s_mov_b32 s82, s95
    ds_read_b128 a[248:251], v2 offset:6144
    v_add_f32 v213, s21, v152
    v_mfma_f32_16x16x32_bf16 a[12:15], v[96:99], v[88:91], a[12:15]
    s_mov_b32 s95, s93
    ds_read_b128 a[252:255], v2 offset:7168
    v_fma_f32 v180, v208, s17, v213
    v_mfma_f32_16x16x32_bf16 a[12:15], v[100:103], v[92:95], a[12:15]
    s_mov_b32 s93, s99
    ds_read_b128 v[112:115], v2 offset:20480
    v_fma_f32 v181, v209, s17, v213
    v_mfma_f32_16x16x32_bf16 v[244:247], a[224:227], v[140:143], v[156:159]
    ds_read_b128 v[116:119], v2 offset:21504
    v_fma_f32 v182, v210, s17, v213
    v_mfma_f32_16x16x32_bf16 v[244:247], a[228:231], v[172:175], v[244:247]
    v_fma_f32 v183, v211, s17, v213
    ds_read_b128 v[120:123], v2 offset:22528
    v_mfma_f32_16x16x32_bf16 v[244:247], a[232:235], v[204:207], v[244:247]
    ds_read_b128 v[124:127], v2 offset:23552
    v_add_f32 v212, s22, v152
    v_mfma_f32_16x16x32_bf16 v[244:247], a[236:239], v[236:239], v[244:247]
    s_waitcnt lgkmcnt(4)
    buffer_load_dwordx4 v1, s[36:39], s77 offen offset:1024 sc1 lds
    v_mfma_f32_16x16x32_bf16 a[20:23], v[104:107], v[72:75], a[20:23]
    ds_read_b128 a[224:227], v2 offset:8192
    ds_read_b128 a[228:231], v2 offset:9216
    v_mfma_f32_16x16x32_bf16 a[20:23], v[108:111], v[76:79], a[20:23]
    ds_read_b128 a[232:235], v2 offset:10240
    v_fma_f32 v184, v208, s18, v212
    v_mfma_f32_16x16x32_bf16 a[24:27], v[104:107], v[80:83], a[24:27]
    ds_read_b128 a[236:239], v2 offset:11264
    v_fma_f32 v185, v209, s18, v212
    v_mfma_f32_16x16x32_bf16 a[24:27], v[108:111], v[84:87], a[24:27]
    ds_read_b128 v[96:99], v2 offset:24576
    v_fma_f32 v186, v210, s18, v212
    v_mfma_f32_16x16x32_bf16 a[28:31], v[104:107], v[88:91], a[28:31]
    ds_read_b128 v[100:103], v2 offset:25600
    v_fma_f32 v187, v211, s18, v212
    v_mfma_f32_16x16x32_bf16 a[28:31], v[108:111], v[92:95], a[28:31]
    v_exp_f32 v240, v240
    v_mfma_f32_16x16x32_bf16 v[248:251], a[240:243], v[136:139], v[180:183]
    v_exp_f32 v241, v241
    v_mfma_f32_16x16x32_bf16 v[248:251], a[244:247], v[168:171], v[248:251]
    v_exp_f32 v242, v242
    v_mfma_f32_16x16x32_bf16 v[248:251], a[248:251], v[200:203], v[248:251]
    buffer_load_dwordx4 v1, s[36:39], s77 offen offset:2048 sc1 lds
    v_mfma_f32_16x16x32_bf16 v[248:251], a[252:255], v[232:235], v[248:251]
    s_waitcnt lgkmcnt(0)
    v_exp_f32 v243, v243
    v_mfma_f32_16x16x32_bf16 a[36:39], v[112:115], v[72:75], a[36:39]
    v_cvt_pk_bf16_f32 v48, v240, v241
    v_cvt_pk_bf16_f32 v49, v242, v243
    v_mfma_f32_16x16x32_bf16 a[36:39], v[116:119], v[76:79], a[36:39]
    ds_read_b128 v[104:107], v2 offset:26624
    ds_read_b128 v[108:111], v2 offset:27648
    v_mfma_f32_16x16x32_bf16 a[40:43], v[112:115], v[80:83], a[40:43]
    v_exp_f32 v244, v244
    v_mfma_f32_16x16x32_bf16 a[40:43], v[116:119], v[84:87], a[40:43]
    v_exp_f32 v245, v245
    v_mfma_f32_16x16x32_bf16 a[44:47], v[112:115], v[88:91], a[44:47]
    v_exp_f32 v246, v246
    v_mfma_f32_16x16x32_bf16 a[44:47], v[116:119], v[92:95], a[44:47]
    s_waitcnt vmcnt(11)
    v_exp_f32 v247, v247
    v_mfma_f32_16x16x32_bf16 v[12:15], v[64:67], v[216:219], 0
    buffer_load_dwordx4 v1, s[36:39], s77 offen offset:3072 sc1 lds
    v_mfma_f32_16x16x32_bf16 v[16:19], v[68:71], v[216:219], 0
    v_cvt_pk_bf16_f32 v56, v244, v245
    v_cvt_pk_bf16_f32 v57, v246, v247
    v_mfma_f32_16x16x32_bf16 v[252:255], a[240:243], v[140:143], v[156:159]
    ds_read_b128 a[240:243], v2 offset:12288
    ds_read_b128 v[112:115], v2 offset:28672
    v_mfma_f32_16x16x32_bf16 v[252:255], a[244:247], v[172:175], v[252:255]
    v_cvt_pk_bf16_f32 v12, v12, v13
    v_cvt_pk_bf16_f32 v13, v14, v15
    v_mfma_f32_16x16x32_bf16 v[252:255], a[248:251], v[204:207], v[252:255]
    v_cvt_pk_bf16_f32 v14, v16, v17
    v_cvt_pk_bf16_f32 v15, v18, v19
    v_mfma_f32_16x16x32_bf16 v[252:255], a[252:255], v[236:239], v[252:255]
    buffer_store_dwordx4 v[12:15], v31, s[56:59], s63 offen offset:0 sc1
    v_mfma_f32_16x16x32_bf16 a[52:55], v[120:123], v[72:75], a[52:55]
    ds_read_b128 a[244:247], v2 offset:13312
    ds_read_b128 a[248:251], v2 offset:14336
    v_mfma_f32_16x16x32_bf16 a[52:55], v[124:127], v[76:79], a[52:55]
    ds_read_b128 a[252:255], v2 offset:15360
    v_add_f32 v213, s23, v152
    v_mfma_f32_16x16x32_bf16 a[56:59], v[120:123], v[80:83], a[56:59]
    s_add_u32 s100, s77, 4096
    ds_read_b128 v[116:119], v2 offset:29696
    v_fma_f32 v188, v208, s19, v213
    v_mfma_f32_16x16x32_bf16 a[56:59], v[124:127], v[84:87], a[56:59]
    s_add_u32 m0, m0, 4096
    v_exp_f32 v248, v248
    v_mfma_f32_16x16x32_bf16 a[60:63], v[120:123], v[88:91], a[60:63]
    buffer_load_dwordx4 v1, s[36:39], s100 offen sc1 lds
    v_mfma_f32_16x16x32_bf16 a[60:63], v[124:127], v[92:95], a[60:63]
    v_exp_f32 v249, v249
    v_mfma_f32_16x16x32_bf16 v[12:15], v[64:67], v[220:223], 0
    v_exp_f32 v250, v250
    v_mfma_f32_16x16x32_bf16 v[16:19], v[68:71], v[220:223], 0
    v_exp_f32 v251, v251
    v_mfma_f32_16x16x32_bf16 v[240:243], a[224:227], v[136:139], v[184:187]
    v_fma_f32 v189, v209, s19, v213
    v_fma_f32 v190, v210, s19, v213
    v_mfma_f32_16x16x32_bf16 v[240:243], a[228:231], v[168:171], v[240:243]
    v_fma_f32 v191, v211, s19, v213
    v_cvt_pk_bf16_f32 v12, v12, v13
    v_mfma_f32_16x16x32_bf16 v[240:243], a[232:235], v[200:203], v[240:243]
    v_cvt_pk_bf16_f32 v13, v14, v15
    v_cvt_pk_bf16_f32 v14, v16, v17
    v_mfma_f32_16x16x32_bf16 v[240:243], a[236:239], v[232:235], v[240:243]
    v_cvt_pk_bf16_f32 v15, v18, v19
    v_cvt_pk_bf16_f32 v50, v248, v249
    v_mfma_f32_16x16x32_bf16 a[148:151], v[96:99], v[72:75], a[148:151]
    buffer_load_dwordx4 v1, s[36:39], s100 offen offset:1024 sc1 lds
    v_mfma_f32_16x16x32_bf16 a[148:151], v[100:103], v[76:79], a[148:151]
    buffer_store_dwordx4 v[12:15], v31, s[56:59], s63 offen offset:1024 sc1
    v_mfma_f32_16x16x32_bf16 a[152:155], v[96:99], v[80:83], a[152:155]
    v_cvt_pk_bf16_f32 v51, v250, v251
    ds_read_b128 v[120:123], v2 offset:30720
    v_mfma_f32_16x16x32_bf16 a[152:155], v[100:103], v[84:87], a[152:155]
    ds_read_b128 v[124:127], v2 offset:31744
    v_add_u32 v2, s82, v1
    v_mfma_f32_16x16x32_bf16 a[156:159], v[96:99], v[88:91], a[156:159]
    v_exp_f32 v252, v252
    v_mfma_f32_16x16x32_bf16 a[156:159], v[100:103], v[92:95], a[156:159]
    v_exp_f32 v253, v253
    v_mfma_f32_16x16x32_bf16 v[12:15], v[20:23], v[216:219], 0
    v_exp_f32 v254, v254
    v_mfma_f32_16x16x32_bf16 v[16:19], v[24:27], v[216:219], 0
    v_exp_f32 v255, v255
    v_mfma_f32_16x16x32_bf16 v[244:247], a[224:227], v[140:143], v[156:159]
    buffer_load_dwordx4 v1, s[36:39], s100 offen offset:2048 sc1 lds
    v_mfma_f32_16x16x32_bf16 v[244:247], a[228:231], v[172:175], v[244:247]
    v_cvt_pk_bf16_f32 v58, v252, v253
    v_cvt_pk_bf16_f32 v59, v254, v255
    v_mfma_f32_16x16x32_bf16 v[244:247], a[232:235], v[204:207], v[244:247]
    v_cvt_pk_bf16_f32 v12, v12, v13
    v_cvt_pk_bf16_f32 v13, v14, v15
    v_mfma_f32_16x16x32_bf16 v[244:247], a[236:239], v[236:239], v[244:247]
    s_waitcnt lgkmcnt(0)
    v_cvt_pk_bf16_f32 v14, v16, v17
    v_cvt_pk_bf16_f32 v15, v18, v19
    v_mfma_f32_16x16x32_bf16 a[164:167], v[104:107], v[72:75], a[164:167]
    buffer_store_dwordx4 v[12:15], v31, s[56:59], s63 offen offset:512 sc1
    v_mfma_f32_16x16x32_bf16 a[164:167], v[108:111], v[76:79], a[164:167]
    v_exp_f32 v240, v240
    v_mfma_f32_16x16x32_bf16 a[168:171], v[104:107], v[80:83], a[168:171]
    v_exp_f32 v241, v241
    v_mfma_f32_16x16x32_bf16 a[168:171], v[108:111], v[84:87], a[168:171]
    v_exp_f32 v242, v242
    v_mfma_f32_16x16x32_bf16 a[172:175], v[104:107], v[88:91], a[172:175]
    v_exp_f32 v243, v243
    v_mfma_f32_16x16x32_bf16 a[172:175], v[108:111], v[92:95], a[172:175]
    buffer_load_dwordx4 v1, s[36:39], s100 offen offset:3072 sc1 lds
    v_mfma_f32_16x16x32_bf16 v[12:15], v[20:23], v[220:223], 0
    v_exp_f32 v244, v244
    v_mfma_f32_16x16x32_bf16 v[16:19], v[24:27], v[220:223], 0
    v_exp_f32 v245, v245
    v_mfma_f32_16x16x32_bf16 v[248:251], a[240:243], v[136:139], v[188:191]
    v_exp_f32 v246, v246
    v_mfma_f32_16x16x32_bf16 v[248:251], a[244:247], v[168:171], v[248:251]
    v_exp_f32 v247, v247
    v_mfma_f32_16x16x32_bf16 v[248:251], a[248:251], v[200:203], v[248:251]
    v_cvt_pk_bf16_f32 v12, v12, v13
    v_cvt_pk_bf16_f32 v13, v14, v15
    v_mfma_f32_16x16x32_bf16 v[248:251], a[252:255], v[232:235], v[248:251]
    v_cvt_pk_bf16_f32 v14, v16, v17
    v_cvt_pk_bf16_f32 v15, v18, v19
    v_mfma_f32_16x16x32_bf16 a[180:183], v[112:115], v[72:75], a[180:183]
    buffer_store_dwordx4 v[12:15], v31, s[56:59], s63 offen offset:1536 sc1
    v_mfma_f32_16x16x32_bf16 a[180:183], v[116:119], v[76:79], a[180:183]
    s_add_u32 s77, s77, 32768
    v_cvt_pk_bf16_f32 v52, v240, v241
    v_cvt_pk_bf16_f32 v53, v242, v243
    v_mfma_f32_16x16x32_bf16 a[184:187], v[112:115], v[80:83], a[184:187]
    v_exp_f32 v248, v248
    v_mfma_f32_16x16x32_bf16 a[184:187], v[116:119], v[84:87], a[184:187]
    v_exp_f32 v249, v249
    v_mfma_f32_16x16x32_bf16 a[188:191], v[112:115], v[88:91], a[188:191]
    v_exp_f32 v250, v250
    v_mfma_f32_16x16x32_bf16 a[188:191], v[116:119], v[92:95], a[188:191]
    v_exp_f32 v251, v251
    v_mfma_f32_16x16x32_bf16 v[12:15], v[144:147], v[216:219], 0
    v_cvt_pk_bf16_f32 v60, v244, v245
    v_cvt_pk_bf16_f32 v61, v246, v247
    v_mfma_f32_16x16x32_bf16 v[16:19], a[140:143], v[216:219], 0
    v_cvt_pk_bf16_f32 v54, v248, v249
    v_cvt_pk_bf16_f32 v55, v250, v251
    v_mfma_f32_16x16x32_bf16 v[252:255], a[240:243], v[140:143], v[156:159]
    v_accvgpr_read_b32 v6, a120
    v_accvgpr_read_b32 v7, a124
    v_mfma_f32_16x16x32_bf16 v[252:255], a[244:247], v[172:175], v[252:255]
    v_cvt_pk_bf16_f32 v12, v12, v13
    v_cvt_pk_bf16_f32 v13, v14, v15
    v_mfma_f32_16x16x32_bf16 v[252:255], a[248:251], v[204:207], v[252:255]
    v_cvt_pk_bf16_f32 v14, v16, v17
    v_cvt_pk_bf16_f32 v15, v18, v19
    v_mfma_f32_16x16x32_bf16 v[252:255], a[252:255], v[236:239], v[252:255]
    buffer_store_dwordx4 v[12:15], v1, s[56:59], s64 offen offset:0 sc1
    v_mfma_f32_16x16x32_bf16 a[196:199], v[120:123], v[72:75], a[196:199]
    v_cvt_pk_bf16_f32 v6, 0, v6
    v_cvt_pk_bf16_f32 v7, 0, v7
    v_mfma_f32_16x16x32_bf16 a[196:199], v[124:127], v[76:79], a[196:199]
    ds_bpermute_b32 v6, v8, v6
    ds_bpermute_b32 v7, v8, v7
    s_waitcnt vmcnt(8) lgkmcnt(0)
    s_barrier
    v_mfma_f32_16x16x32_bf16 a[200:203], v[120:123], v[80:83], a[200:203]
    ds_read_b128 a[224:227], v2 offset:0
    ds_read_b128 a[228:231], v2 offset:1024
    v_mfma_f32_16x16x32_bf16 a[200:203], v[124:127], v[84:87], a[200:203]
    ds_read_b128 a[232:235], v2 offset:2048
    v_mul_f32 v6, s98, v6
    v_mfma_f32_16x16x32_bf16 a[204:207], v[120:123], v[88:91], a[204:207]
    ds_read_b128 a[236:239], v2 offset:3072
    v_mul_f32 v7, s98, v7
    v_mfma_f32_16x16x32_bf16 a[204:207], v[124:127], v[92:95], a[204:207]
    ds_read_b128 v[96:99], v2 offset:16384
    v_mfma_f32_16x16x32_bf16 v[12:15], v[144:147], v[220:223], 0
    ds_read_b128 v[100:103], v2 offset:17408
    v_mfma_f32_16x16x32_bf16 v[16:19], a[140:143], v[220:223], 0
    v_exp_f32 v252, v252
    v_smfmac_f32_16x16x64_bf16 a[212:215], a[136:139], v[72:79], v215
    v_exp_f32 v6, v6
    v_smfmac_f32_16x16x64_bf16 a[216:219], a[136:139], v[80:87], v215
    v_exp_f32 v7, v7
    v_smfmac_f32_16x16x64_bf16 a[220:223], a[136:139], v[88:95], v215
    v_cvt_pk_bf16_f32 v12, v12, v13
    v_cvt_pk_bf16_f32 v13, v14, v15
    v_add_f32 v6, 1.0, v6
    v_add_f32 v7, 1.0, v7
    v_cvt_pk_bf16_f32 v14, v16, v17
    v_cvt_pk_bf16_f32 v15, v18, v19
    v_rcp_f32 v6, v6
    v_rcp_f32 v7, v7
    buffer_store_dwordx4 v[12:15], v1, s[56:59], s62 offen offset:0 sc1
    s_nop 1
    v_accvgpr_read_b32 v9, a208
    v_accvgpr_read_b32 v10, a209
    v_add_f32 v9, v9, v10
    v_cmp_nge_f32 vcc, 0x5f800000, v9
    v_rcp_f32 v10, v9
    s_nop 0
    s_or_b64 s[84:85], s[84:85], vcc
    v_mul_f32 v10, v10, v4
    v_accvgpr_read_b32 v12, a0
    v_accvgpr_read_b32 v13, a1
    v_accvgpr_read_b32 v14, a2
    v_accvgpr_read_b32 v15, a3
    v_accvgpr_read_b32 v16, a16
    v_accvgpr_read_b32 v17, a17
    v_accvgpr_read_b32 v18, a18
    v_accvgpr_read_b32 v19, a19
    v_pk_mul_f32 v[12:13], v[12:13], v[10:11] op_sel_hi:[1,0]
    v_pk_mul_f32 v[14:15], v[14:15], v[10:11] op_sel_hi:[1,0]
    v_pk_mul_f32 v[16:17], v[16:17], v[10:11] op_sel_hi:[1,0]
    v_pk_mul_f32 v[18:19], v[18:19], v[10:11] op_sel_hi:[1,0]
    v_cvt_pk_bf16_f32 v12, v12, v13
    v_cvt_pk_bf16_f32 v13, v14, v15
    v_cvt_pk_bf16_f32 v14, v16, v17
    v_cvt_pk_bf16_f32 v15, v18, v19
    buffer_store_dwordx4 v[12:15], v1, s[40:43], s80 offen offset:0 sc1
    v_accvgpr_read_b32 v20, a32
    v_accvgpr_read_b32 v21, a33
    v_accvgpr_read_b32 v22, a34
    v_accvgpr_read_b32 v23, a35
    v_accvgpr_read_b32 v24, a48
    v_accvgpr_read_b32 v25, a49
    v_accvgpr_read_b32 v26, a50
    v_accvgpr_read_b32 v27, a51
    v_pk_mul_f32 v[20:21], v[20:21], v[10:11] op_sel_hi:[1,0]
    v_pk_mul_f32 v[22:23], v[22:23], v[10:11] op_sel_hi:[1,0]
    v_pk_mul_f32 v[24:25], v[24:25], v[10:11] op_sel_hi:[1,0]
    v_pk_mul_f32 v[26:27], v[26:27], v[10:11] op_sel_hi:[1,0]
    v_cvt_pk_bf16_f32 v20, v20, v21
    v_cvt_pk_bf16_f32 v21, v22, v23
    v_cvt_pk_bf16_f32 v22, v24, v25
    v_cvt_pk_bf16_f32 v23, v26, v27
    buffer_store_dwordx4 v[20:23], v1, s[40:43], s80 offen offset:1024 sc1
    v_accvgpr_read_b32 v12, a144
    v_accvgpr_read_b32 v13, a145
    v_accvgpr_read_b32 v14, a146
    v_accvgpr_read_b32 v15, a147
    v_accvgpr_read_b32 v16, a160
    v_accvgpr_read_b32 v17, a161
    v_accvgpr_read_b32 v18, a162
    v_accvgpr_read_b32 v19, a163
    v_pk_mul_f32 v[12:13], v[12:13], v[10:11] op_sel_hi:[1,0]
    v_pk_mul_f32 v[14:15], v[14:15], v[10:11] op_sel_hi:[1,0]
    v_pk_mul_f32 v[16:17], v[16:17], v[10:11] op_sel_hi:[1,0]
    v_pk_mul_f32 v[18:19], v[18:19], v[10:11] op_sel_hi:[1,0]
    v_cvt_pk_bf16_f32 v12, v12, v13
    v_cvt_pk_bf16_f32 v13, v14, v15
    v_cvt_pk_bf16_f32 v14, v16, v17
    v_cvt_pk_bf16_f32 v15, v18, v19
    buffer_store_dwordx4 v[12:15], v1, s[40:43], s80 offen offset:2048 sc1
    v_accvgpr_read_b32 v20, a176
    v_accvgpr_read_b32 v21, a177
    v_accvgpr_read_b32 v22, a178
    v_accvgpr_read_b32 v23, a179
    v_accvgpr_read_b32 v24, a192
    v_accvgpr_read_b32 v25, a193
    v_accvgpr_read_b32 v26, a194
    v_accvgpr_read_b32 v27, a195
    v_pk_mul_f32 v[20:21], v[20:21], v[10:11] op_sel_hi:[1,0]
    v_pk_mul_f32 v[22:23], v[22:23], v[10:11] op_sel_hi:[1,0]
    v_pk_mul_f32 v[24:25], v[24:25], v[10:11] op_sel_hi:[1,0]
    v_pk_mul_f32 v[26:27], v[26:27], v[10:11] op_sel_hi:[1,0]
    v_cvt_pk_bf16_f32 v20, v20, v21
    v_cvt_pk_bf16_f32 v21, v22, v23
    v_cvt_pk_bf16_f32 v22, v24, v25
    v_cvt_pk_bf16_f32 v23, v26, v27
    buffer_store_dwordx4 v[20:23], v1, s[40:43], s80 offen offset:3072 sc1
    v_accvgpr_read_b32 v9, a212
    v_accvgpr_read_b32 v10, a213
    v_add_f32 v9, v9, v10
    v_cmp_nge_f32 vcc, 0x5f800000, v9
    v_rcp_f32 v10, v9
    s_nop 0
    s_or_b64 s[84:85], s[84:85], vcc
    v_mul_f32 v10, v10, v5
    s_add_u32 s72, s80, 622592
    v_accvgpr_read_b32 v12, a4
    v_accvgpr_read_b32 v13, a5
    v_accvgpr_read_b32 v14, a6
    v_accvgpr_read_b32 v15, a7
    v_accvgpr_read_b32 v16, a20
    v_accvgpr_read_b32 v17, a21
    v_accvgpr_read_b32 v18, a22
    v_accvgpr_read_b32 v19, a23
    v_pk_mul_f32 v[12:13], v[12:13], v[10:11] op_sel_hi:[1,0]
    v_pk_mul_f32 v[14:15], v[14:15], v[10:11] op_sel_hi:[1,0]
    v_pk_mul_f32 v[16:17], v[16:17], v[10:11] op_sel_hi:[1,0]
    v_pk_mul_f32 v[18:19], v[18:19], v[10:11] op_sel_hi:[1,0]
    v_cvt_pk_bf16_f32 v12, v12, v13
    v_cvt_pk_bf16_f32 v13, v14, v15
    v_cvt_pk_bf16_f32 v14, v16, v17
    v_cvt_pk_bf16_f32 v15, v18, v19
    buffer_store_dwordx4 v[12:15], v1, s[40:43], s72 offen offset:0 sc1
    v_accvgpr_read_b32 v20, a36
    v_accvgpr_read_b32 v21, a37
    v_accvgpr_read_b32 v22, a38
    v_accvgpr_read_b32 v23, a39
    v_accvgpr_read_b32 v24, a52
    v_accvgpr_read_b32 v25, a53
    v_accvgpr_read_b32 v26, a54
    v_accvgpr_read_b32 v27, a55
    v_pk_mul_f32 v[20:21], v[20:21], v[10:11] op_sel_hi:[1,0]
    v_pk_mul_f32 v[22:23], v[22:23], v[10:11] op_sel_hi:[1,0]
    v_pk_mul_f32 v[24:25], v[24:25], v[10:11] op_sel_hi:[1,0]
    v_pk_mul_f32 v[26:27], v[26:27], v[10:11] op_sel_hi:[1,0]
    v_cvt_pk_bf16_f32 v20, v20, v21
    v_cvt_pk_bf16_f32 v21, v22, v23
    v_cvt_pk_bf16_f32 v22, v24, v25
    v_cvt_pk_bf16_f32 v23, v26, v27
    buffer_store_dwordx4 v[20:23], v1, s[40:43], s72 offen offset:1024 sc1
    v_accvgpr_read_b32 v12, a148
    v_accvgpr_read_b32 v13, a149
    v_accvgpr_read_b32 v14, a150
    v_accvgpr_read_b32 v15, a151
    v_accvgpr_read_b32 v16, a164
    v_accvgpr_read_b32 v17, a165
    v_accvgpr_read_b32 v18, a166
    v_accvgpr_read_b32 v19, a167
    v_pk_mul_f32 v[12:13], v[12:13], v[10:11] op_sel_hi:[1,0]
    v_pk_mul_f32 v[14:15], v[14:15], v[10:11] op_sel_hi:[1,0]
    v_pk_mul_f32 v[16:17], v[16:17], v[10:11] op_sel_hi:[1,0]
    v_pk_mul_f32 v[18:19], v[18:19], v[10:11] op_sel_hi:[1,0]
    v_cvt_pk_bf16_f32 v12, v12, v13
    v_cvt_pk_bf16_f32 v13, v14, v15
    v_cvt_pk_bf16_f32 v14, v16, v17
    v_cvt_pk_bf16_f32 v15, v18, v19
    buffer_store_dwordx4 v[12:15], v1, s[40:43], s72 offen offset:2048 sc1
    v_accvgpr_read_b32 v20, a180
    v_accvgpr_read_b32 v21, a181
    v_accvgpr_read_b32 v22, a182
    v_accvgpr_read_b32 v23, a183
    v_accvgpr_read_b32 v24, a196
    v_accvgpr_read_b32 v25, a197
    v_accvgpr_read_b32 v26, a198
    v_accvgpr_read_b32 v27, a199
    v_pk_mul_f32 v[20:21], v[20:21], v[10:11] op_sel_hi:[1,0]
    v_pk_mul_f32 v[22:23], v[22:23], v[10:11] op_sel_hi:[1,0]
    v_pk_mul_f32 v[24:25], v[24:25], v[10:11] op_sel_hi:[1,0]
    v_pk_mul_f32 v[26:27], v[26:27], v[10:11] op_sel_hi:[1,0]
    v_cvt_pk_bf16_f32 v20, v20, v21
    v_cvt_pk_bf16_f32 v21, v22, v23
    v_cvt_pk_bf16_f32 v22, v24, v25
    v_cvt_pk_bf16_f32 v23, v26, v27
    buffer_store_dwordx4 v[20:23], v1, s[40:43], s72 offen offset:3072 sc1
    v_mov_b32 v9, 1
    v_lshlrev_b32 v216, 20, v1
    s_lshl2_add_u32 s7, s4, s101
    s_add_u32 s7, s7, 163840
    s_waitcnt vmcnt(8)
    buffer_store_dword v9, v216, s[32:35], s7 offen sc1
    s_sub_u32 s78, 14, s6
    s_sub_u32 s78, s78, s6
    s_cmp_eq_u32 s78, 0
    s_cbranch_scc1 K1_LS_END
.p2align 3
K1_LS:
    s_waitcnt lgkmcnt(0)
    v_mfma_f32_16x16x32_bf16 v[240:243], a[224:227], v[136:139], v[176:179]
    s_mov_b32 s99, s76
    ds_read_b128 v[104:107], v2 offset:18432
    ds_read_b128 v[108:111], v2 offset:19456
    v_mfma_f32_16x16x32_bf16 v[240:243], a[228:231], v[168:171], v[240:243]
    v_exp_f32 v253, v253
    v_mfma_f32_16x16x32_bf16 v[240:243], a[232:235], v[200:203], v[240:243]
    v_exp_f32 v254, v254
    v_mfma_f32_16x16x32_bf16 v[240:243], a[236:239], v[232:235], v[240:243]
    v_exp_f32 v255, v255
    v_mfma_f32_16x16x32_bf16 a[8:11], v[96:99], v[48:51], a[8:11]
    s_add_u32 m0, s76, s75
    v_cvt_pk_bf16_f32 v62, v252, v253
    v_cvt_pk_bf16_f32 v63, v254, v255
    v_mfma_f32_16x16x32_bf16 a[8:11], v[100:103], v[52:55], a[8:11]
    s_mov_b32 s76, s60
    ds_read_b128 a[240:243], v2 offset:4096
    ds_read_b128 a[244:247], v2 offset:5120
    v_mfma_f32_16x16x32_bf16 a[12:15], v[96:99], v[56:59], a[12:15]
    s_mov_b32 s60, s82
    buffer_load_dwordx4 v1, s[36:39], s77 offen sc1 lds
    v_mfma_f32_16x16x32_bf16 a[12:15], v[100:103], v[60:63], a[12:15]
    s_mov_b32 s82, s95
    ds_read_b128 a[248:251], v2 offset:6144
    ds_read_b128 a[252:255], v2 offset:7168
    v_mfma_f32_16x16x32_bf16 v[244:247], a[224:227], v[140:143], v[156:159]
    s_mov_b32 s95, s93
    v_exp_f32 v240, v240
    v_mfma_f32_16x16x32_bf16 v[244:247], a[228:231], v[172:175], v[244:247]
    s_mov_b32 s93, s99
    ds_read_b128 v[112:115], v2 offset:20480
    ds_read_b128 v[116:119], v2 offset:21504
    v_mfma_f32_16x16x32_bf16 v[244:247], a[232:235], v[204:207], v[244:247]
    buffer_load_dwordx4 v1, s[36:39], s77 offen offset:1024 sc1 lds
    v_mfma_f32_16x16x32_bf16 v[244:247], a[236:239], v[236:239], v[244:247]
    s_waitcnt lgkmcnt(6)
    v_exp_f32 v241, v241
    v_mfma_f32_16x16x32_bf16 a[24:27], v[104:107], v[48:51], a[24:27]
    v_exp_f32 v242, v242
    v_mfma_f32_16x16x32_bf16 a[24:27], v[108:111], v[52:55], a[24:27]
    v_exp_f32 v243, v243
    v_mfma_f32_16x16x32_bf16 a[28:31], v[104:107], v[56:59], a[28:31]
    buffer_load_dwordx4 v1, s[36:39], s77 offen offset:2048 sc1 lds
    v_mfma_f32_16x16x32_bf16 a[28:31], v[108:111], v[60:63], a[28:31]
    s_waitcnt lgkmcnt(2)
    ds_read_b128 v[120:123], v2 offset:22528
    ds_read_b128 v[124:127], v2 offset:23552
    v_mfma_f32_16x16x32_bf16 v[248:251], a[240:243], v[136:139], v[180:183]
    v_cvt_pk_bf16_f32 v80, v240, v241
    v_cvt_pk_bf16_f32 v81, v242, v243
    v_mfma_f32_16x16x32_bf16 v[248:251], a[244:247], v[168:171], v[248:251]
    v_exp_f32 v244, v244
    v_mfma_f32_16x16x32_bf16 v[248:251], a[248:251], v[200:203], v[248:251]
    buffer_load_dwordx4 v1, s[36:39], s77 offen offset:3072 sc1 lds
    v_mfma_f32_16x16x32_bf16 v[248:251], a[252:255], v[232:235], v[248:251]
    s_waitcnt lgkmcnt(2)
    ds_read_b128 a[224:227], v2 offset:8192
    ds_read_b128 a[228:231], v2 offset:9216
    v_mfma_f32_16x16x32_bf16 a[40:43], v[112:115], v[48:51], a[40:43]
    v_exp_f32 v245, v245
    v_mfma_f32_16x16x32_bf16 a[40:43], v[116:119], v[52:55], a[40:43]
    ds_read_b128 a[232:235], v2 offset:10240
    ds_read_b128 a[236:239], v2 offset:11264
    v_mfma_f32_16x16x32_bf16 a[44:47], v[112:115], v[56:59], a[44:47]
    s_add_u32 s100, s77, 4096
    ds_read_b128 v[96:99], v2 offset:24576
    v_cvt_pk_bf16_f32 v88, v244, v245
    v_mfma_f32_16x16x32_bf16 a[44:47], v[116:119], v[60:63], a[44:47]
    s_add_u32 m0, m0, 4096
    v_exp_f32 v246, v246
    v_mfma_f32_16x16x32_bf16 v[252:255], a[240:243], v[140:143], v[156:159]
    buffer_load_dwordx4 v1, s[36:39], s100 offen sc1 lds
    v_mfma_f32_16x16x32_bf16 v[252:255], a[244:247], v[172:175], v[252:255]
    v_exp_f32 v247, v247
    v_mfma_f32_16x16x32_bf16 v[252:255], a[248:251], v[204:207], v[252:255]
    ds_read_b128 v[100:103], v2 offset:25600
    v_cvt_pk_bf16_f32 v89, v246, v247
    v_mfma_f32_16x16x32_bf16 v[252:255], a[252:255], v[236:239], v[252:255]
    s_waitcnt lgkmcnt(4)
    buffer_load_dwordx4 v1, s[36:39], s100 offen offset:1024 sc1 lds
    v_mfma_f32_16x16x32_bf16 a[56:59], v[120:123], v[48:51], a[56:59]
    v_exp_f32 v248, v248
    v_mfma_f32_16x16x32_bf16 a[56:59], v[124:127], v[52:55], a[56:59]
    v_exp_f32 v249, v249
    v_mfma_f32_16x16x32_bf16 a[60:63], v[120:123], v[56:59], a[60:63]
    ds_read_b128 v[104:107], v2 offset:26624
    ds_read_b128 v[108:111], v2 offset:27648
    v_mfma_f32_16x16x32_bf16 a[60:63], v[124:127], v[60:63], a[60:63]
    v_exp_f32 v250, v250
    v_mfma_f32_16x16x32_bf16 v[240:243], a[224:227], v[136:139], v[184:187]
    buffer_load_dwordx4 v1, s[36:39], s100 offen offset:2048 sc1 lds
    v_mfma_f32_16x16x32_bf16 v[240:243], a[228:231], v[168:171], v[240:243]
    s_waitcnt lgkmcnt(2)
    v_exp_f32 v251, v251
    v_mfma_f32_16x16x32_bf16 v[240:243], a[232:235], v[200:203], v[240:243]
    ds_read_b128 a[240:243], v2 offset:12288
    ds_read_b128 a[244:247], v2 offset:13312
    v_mfma_f32_16x16x32_bf16 v[240:243], a[236:239], v[232:235], v[240:243]
    ds_read_b128 a[248:251], v2 offset:14336
    v_cvt_pk_bf16_f32 v82, v248, v249
    v_mfma_f32_16x16x32_bf16 a[152:155], v[96:99], v[48:51], a[152:155]
    buffer_load_dwordx4 v1, s[36:39], s100 offen offset:3072 sc1 lds
    v_mfma_f32_16x16x32_bf16 a[152:155], v[100:103], v[52:55], a[152:155]
    ds_read_b128 a[252:255], v2 offset:15360
    v_cvt_pk_bf16_f32 v83, v250, v251
    v_mfma_f32_16x16x32_bf16 a[156:159], v[96:99], v[56:59], a[156:159]
    ds_read_b128 v[112:115], v2 offset:28672
    ds_read_b128 v[116:119], v2 offset:29696
    v_mfma_f32_16x16x32_bf16 a[156:159], v[100:103], v[60:63], a[156:159]
    v_exp_f32 v252, v252
    v_mfma_f32_16x16x32_bf16 v[244:247], a[224:227], v[140:143], v[156:159]
    s_add_u32 s77, s77, 32768
    v_exp_f32 v253, v253
    v_mfma_f32_16x16x32_bf16 v[244:247], a[228:231], v[172:175], v[244:247]
    v_exp_f32 v254, v254
    v_mfma_f32_16x16x32_bf16 v[244:247], a[232:235], v[204:207], v[244:247]
    v_exp_f32 v255, v255
    v_mfma_f32_16x16x32_bf16 v[244:247], a[236:239], v[236:239], v[244:247]
    s_waitcnt lgkmcnt(3)
    v_cvt_pk_bf16_f32 v90, v252, v253
    v_cvt_pk_bf16_f32 v91, v254, v255
    v_mfma_f32_16x16x32_bf16 a[168:171], v[104:107], v[48:51], a[168:171]
    v_exp_f32 v240, v240
    v_mfma_f32_16x16x32_bf16 a[168:171], v[108:111], v[52:55], a[168:171]
    v_exp_f32 v241, v241
    v_mfma_f32_16x16x32_bf16 a[172:175], v[104:107], v[56:59], a[172:175]
    ds_read_b128 v[120:123], v2 offset:30720
    ds_read_b128 v[124:127], v2 offset:31744
    v_mfma_f32_16x16x32_bf16 a[172:175], v[108:111], v[60:63], a[172:175]
    v_add_u32 v2, s82, v1
    v_cvt_pk_bf16_f32 v84, v240, v241
    v_mfma_f32_16x16x32_bf16 v[248:251], a[240:243], v[136:139], v[188:191]
    v_exp_f32 v242, v242
    v_mfma_f32_16x16x32_bf16 v[248:251], a[244:247], v[168:171], v[248:251]
    v_exp_f32 v243, v243
    v_mfma_f32_16x16x32_bf16 v[248:251], a[248:251], v[200:203], v[248:251]
    s_waitcnt lgkmcnt(2)
    v_exp_f32 v244, v244
    v_mfma_f32_16x16x32_bf16 v[248:251], a[252:255], v[232:235], v[248:251]
    v_exp_f32 v245, v245
    v_mfma_f32_16x16x32_bf16 a[184:187], v[112:115], v[48:51], a[184:187]
    ds_read_b128 a[224:227], v2 offset:0
    ds_read_b128 a[228:231], v2 offset:1024
    v_mfma_f32_16x16x32_bf16 a[184:187], v[116:119], v[52:55], a[184:187]
    ds_read_b128 a[232:235], v2 offset:2048
    v_cvt_pk_bf16_f32 v85, v242, v243
    v_mfma_f32_16x16x32_bf16 a[188:191], v[112:115], v[56:59], a[188:191]
    ds_read_b128 a[236:239], v2 offset:3072
    v_cvt_pk_bf16_f32 v92, v244, v245
    v_mfma_f32_16x16x32_bf16 a[188:191], v[116:119], v[60:63], a[188:191]
    v_exp_f32 v246, v246
    v_mfma_f32_16x16x32_bf16 v[252:255], a[240:243], v[140:143], v[156:159]
    ds_read_b128 v[96:99], v2 offset:16384
    ds_read_b128 v[100:103], v2 offset:17408
    v_mfma_f32_16x16x32_bf16 v[252:255], a[244:247], v[172:175], v[252:255]
    v_exp_f32 v247, v247
    v_mfma_f32_16x16x32_bf16 v[252:255], a[248:251], v[204:207], v[252:255]
    v_exp_f32 v248, v248
    v_mfma_f32_16x16x32_bf16 v[252:255], a[252:255], v[236:239], v[252:255]
    s_waitcnt lgkmcnt(4)
    v_exp_f32 v249, v249
    v_mfma_f32_16x16x32_bf16 a[200:203], v[120:123], v[48:51], a[200:203]
    v_exp_f32 v250, v250
    v_mfma_f32_16x16x32_bf16 a[200:203], v[124:127], v[52:55], a[200:203]
    v_exp_f32 v251, v251
    v_mfma_f32_16x16x32_bf16 a[204:207], v[120:123], v[56:59], a[204:207]
    v_cvt_pk_bf16_f32 v93, v246, v247
    v_cvt_pk_bf16_f32 v86, v248, v249
    v_mfma_f32_16x16x32_bf16 a[204:207], v[124:127], v[60:63], a[204:207]
    v_exp_f32 v252, v252
    v_smfmac_f32_16x16x64_bf16 a[216:219], a[136:139], v[48:55], v215
    s_cmp_le_u32 s78, 2
    v_cvt_pk_bf16_f32 v87, v250, v251
    v_smfmac_f32_16x16x64_bf16 a[220:223], a[136:139], v[56:63], v215
    s_cbranch_scc1 K1_LS_MASK
K1_LS_BACK:
    s_waitcnt lgkmcnt(0)
    v_mfma_f32_16x16x32_bf16 v[240:243], a[224:227], v[136:139], v[176:179]
    s_mov_b32 s99, s76
    ds_read_b128 v[104:107], v2 offset:18432
    ds_read_b128 v[108:111], v2 offset:19456
    v_mfma_f32_16x16x32_bf16 v[240:243], a[228:231], v[168:171], v[240:243]
    v_exp_f32 v253, v253
    v_mfma_f32_16x16x32_bf16 v[240:243], a[232:235], v[200:203], v[240:243]
    v_exp_f32 v254, v254
    v_mfma_f32_16x16x32_bf16 v[240:243], a[236:239], v[232:235], v[240:243]
    v_exp_f32 v255, v255
    v_mfma_f32_16x16x32_bf16 a[8:11], v[96:99], v[80:83], a[8:11]
    s_add_u32 m0, s76, s75
    v_cvt_pk_bf16_f32 v94, v252, v253
    v_cvt_pk_bf16_f32 v95, v254, v255
    v_mfma_f32_16x16x32_bf16 a[8:11], v[100:103], v[84:87], a[8:11]
    s_mov_b32 s76, s60
    ds_read_b128 a[240:243], v2 offset:4096
    ds_read_b128 a[244:247], v2 offset:5120
    v_mfma_f32_16x16x32_bf16 a[12:15], v[96:99], v[88:91], a[12:15]
    s_mov_b32 s60, s82
    buffer_load_dwordx4 v1, s[36:39], s77 offen sc1 lds
    v_mfma_f32_16x16x32_bf16 a[12:15], v[100:103], v[92:95], a[12:15]
    s_mov_b32 s82, s95
    ds_read_b128 a[248:251], v2 offset:6144
    ds_read_b128 a[252:255], v2 offset:7168
    v_mfma_f32_16x16x32_bf16 v[244:247], a[224:227], v[140:143], v[156:159]
    s_mov_b32 s95, s93
    v_exp_f32 v240, v240
    v_mfma_f32_16x16x32_bf16 v[244:247], a[228:231], v[172:175], v[244:247]
    s_mov_b32 s93, s99
    ds_read_b128 v[112:115], v2 offset:20480
    ds_read_b128 v[116:119], v2 offset:21504
    v_mfma_f32_16x16x32_bf16 v[244:247], a[232:235], v[204:207], v[244:247]
    buffer_load_dwordx4 v1, s[36:39], s77 offen offset:1024 sc1 lds
    v_mfma_f32_16x16x32_bf16 v[244:247], a[236:239], v[236:239], v[244:247]
    s_waitcnt lgkmcnt(6)
    v_exp_f32 v241, v241
    v_mfma_f32_16x16x32_bf16 a[24:27], v[104:107], v[80:83], a[24:27]
    v_exp_f32 v242, v242
    v_mfma_f32_16x16x32_bf16 a[24:27], v[108:111], v[84:87], a[24:27]
    v_exp_f32 v243, v243
    v_mfma_f32_16x16x32_bf16 a[28:31], v[104:107], v[88:91], a[28:31]
    buffer_load_dwordx4 v1, s[36:39], s77 offen offset:2048 sc1 lds
    v_mfma_f32_16x16x32_bf16 a[28:31], v[108:111], v[92:95], a[28:31]
    s_waitcnt lgkmcnt(2)
    ds_read_b128 v[120:123], v2 offset:22528
    ds_read_b128 v[124:127], v2 offset:23552
    v_mfma_f32_16x16x32_bf16 v[248:251], a[240:243], v[136:139], v[180:183]
    v_cvt_pk_bf16_f32 v48, v240, v241
    v_cvt_pk_bf16_f32 v49, v242, v243
    v_mfma_f32_16x16x32_bf16 v[248:251], a[244:247], v[168:171], v[248:251]
    v_exp_f32 v244, v244
    v_mfma_f32_16x16x32_bf16 v[248:251], a[248:251], v[200:203], v[248:251]
    buffer_load_dwordx4 v1, s[36:39], s77 offen offset:3072 sc1 lds
    v_mfma_f32_16x16x32_bf16 v[248:251], a[252:255], v[232:235], v[248:251]
    s_waitcnt lgkmcnt(2)
    ds_read_b128 a[224:227], v2 offset:8192
    ds_read_b128 a[228:231], v2 offset:9216
    v_mfma_f32_16x16x32_bf16 a[40:43], v[112:115], v[80:83], a[40:43]
    v_exp_f32 v245, v245
    v_mfma_f32_16x16x32_bf16 a[40:43], v[116:119], v[84:87], a[40:43]
    ds_read_b128 a[232:235], v2 offset:10240
    ds_read_b128 a[236:239], v2 offset:11264
    v_mfma_f32_16x16x32_bf16 a[44:47], v[112:115], v[88:91], a[44:47]
    s_add_u32 s100, s77, 4096
    ds_read_b128 v[96:99], v2 offset:24576
    v_cvt_pk_bf16_f32 v56, v244, v245
    v_mfma_f32_16x16x32_bf16 a[44:47], v[116:119], v[92:95], a[44:47]
    s_add_u32 m0, m0, 4096
    v_exp_f32 v246, v246
    v_mfma_f32_16x16x32_bf16 v[252:255], a[240:243], v[140:143], v[156:159]
    buffer_load_dwordx4 v1, s[36:39], s100 offen sc1 lds
    v_mfma_f32_16x16x32_bf16 v[252:255], a[244:247], v[172:175], v[252:255]
    v_exp_f32 v247, v247
    v_mfma_f32_16x16x32_bf16 v[252:255], a[248:251], v[204:207], v[252:255]
    ds_read_b128 v[100:103], v2 offset:25600
    v_cvt_pk_bf16_f32 v57, v246, v247
    v_mfma_f32_16x16x32_bf16 v[252:255], a[252:255], v[236:239], v[252:255]
    s_waitcnt lgkmcnt(4)
    buffer_load_dwordx4 v1, s[36:39], s100 offen offset:1024 sc1 lds
    v_mfma_f32_16x16x32_bf16 a[56:59], v[120:123], v[80:83], a[56:59]
    v_exp_f32 v248, v248
    v_mfma_f32_16x16x32_bf16 a[56:59], v[124:127], v[84:87], a[56:59]
    v_exp_f32 v249, v249
    v_mfma_f32_16x16x32_bf16 a[60:63], v[120:123], v[88:91], a[60:63]
    ds_read_b128 v[104:107], v2 offset:26624
    ds_read_b128 v[108:111], v2 offset:27648
    v_mfma_f32_16x16x32_bf16 a[60:63], v[124:127], v[92:95], a[60:63]
    v_exp_f32 v250, v250
    v_mfma_f32_16x16x32_bf16 v[240:243], a[224:227], v[136:139], v[184:187]
    buffer_load_dwordx4 v1, s[36:39], s100 offen offset:2048 sc1 lds
    v_mfma_f32_16x16x32_bf16 v[240:243], a[228:231], v[168:171], v[240:243]
    s_waitcnt lgkmcnt(2)
    v_exp_f32 v251, v251
    v_mfma_f32_16x16x32_bf16 v[240:243], a[232:235], v[200:203], v[240:243]
    ds_read_b128 a[240:243], v2 offset:12288
    ds_read_b128 a[244:247], v2 offset:13312
    v_mfma_f32_16x16x32_bf16 v[240:243], a[236:239], v[232:235], v[240:243]
    ds_read_b128 a[248:251], v2 offset:14336
    v_cvt_pk_bf16_f32 v50, v248, v249
    v_mfma_f32_16x16x32_bf16 a[152:155], v[96:99], v[80:83], a[152:155]
    buffer_load_dwordx4 v1, s[36:39], s100 offen offset:3072 sc1 lds
    v_mfma_f32_16x16x32_bf16 a[152:155], v[100:103], v[84:87], a[152:155]
    ds_read_b128 a[252:255], v2 offset:15360
    v_cvt_pk_bf16_f32 v51, v250, v251
    v_mfma_f32_16x16x32_bf16 a[156:159], v[96:99], v[88:91], a[156:159]
    ds_read_b128 v[112:115], v2 offset:28672
    ds_read_b128 v[116:119], v2 offset:29696
    v_mfma_f32_16x16x32_bf16 a[156:159], v[100:103], v[92:95], a[156:159]
    v_exp_f32 v252, v252
    v_mfma_f32_16x16x32_bf16 v[244:247], a[224:227], v[140:143], v[156:159]
    s_add_u32 s77, s77, 32768
    v_exp_f32 v253, v253
    v_mfma_f32_16x16x32_bf16 v[244:247], a[228:231], v[172:175], v[244:247]
    ds_read_b128 v[120:123], v2 offset:30720
    ds_read_b128 v[124:127], v2 offset:31744
    v_mfma_f32_16x16x32_bf16 v[244:247], a[232:235], v[204:207], v[244:247]
    v_add_u32 v2, s82, v1
    v_cvt_pk_bf16_f32 v58, v252, v253
    v_mfma_f32_16x16x32_bf16 v[244:247], a[236:239], v[236:239], v[244:247]
    s_waitcnt lgkmcnt(5)
    v_exp_f32 v254, v254
    v_mfma_f32_16x16x32_bf16 a[168:171], v[104:107], v[80:83], a[168:171]
    v_exp_f32 v255, v255
    v_mfma_f32_16x16x32_bf16 a[168:171], v[108:111], v[84:87], a[168:171]
    v_exp_f32 v240, v240
    v_mfma_f32_16x16x32_bf16 a[172:175], v[104:107], v[88:91], a[172:175]
    v_exp_f32 v241, v241
    v_mfma_f32_16x16x32_bf16 a[172:175], v[108:111], v[92:95], a[172:175]
    v_cvt_pk_bf16_f32 v59, v254, v255
    v_cvt_pk_bf16_f32 v52, v240, v241
    v_mfma_f32_16x16x32_bf16 v[248:251], a[240:243], v[136:139], v[188:191]
    v_exp_f32 v242, v242
    v_mfma_f32_16x16x32_bf16 v[248:251], a[244:247], v[168:171], v[248:251]
    v_exp_f32 v243, v243
    v_mfma_f32_16x16x32_bf16 v[248:251], a[248:251], v[200:203], v[248:251]
    s_waitcnt lgkmcnt(0)
    v_exp_f32 v244, v244
    v_mfma_f32_16x16x32_bf16 v[248:251], a[252:255], v[232:235], v[248:251]
    v_exp_f32 v245, v245
    v_mfma_f32_16x16x32_bf16 a[184:187], v[112:115], v[80:83], a[184:187]
    s_waitcnt vmcnt(8) lgkmcnt(0)
    v_exp_f32 v246, v246
    v_mfma_f32_16x16x32_bf16 a[184:187], v[116:119], v[84:87], a[184:187]
    s_barrier
    ds_read_b128 a[224:227], v2 offset:0
    ds_read_b128 a[228:231], v2 offset:1024
    v_mfma_f32_16x16x32_bf16 a[188:191], v[112:115], v[88:91], a[188:191]
    ds_read_b128 a[232:235], v2 offset:2048
    v_cvt_pk_bf16_f32 v53, v242, v243
    v_mfma_f32_16x16x32_bf16 a[188:191], v[116:119], v[92:95], a[188:191]
    ds_read_b128 a[236:239], v2 offset:3072
    v_cvt_pk_bf16_f32 v60, v244, v245
    v_mfma_f32_16x16x32_bf16 v[252:255], a[240:243], v[140:143], v[156:159]
    v_exp_f32 v247, v247
    v_mfma_f32_16x16x32_bf16 v[252:255], a[244:247], v[172:175], v[252:255]
    ds_read_b128 v[96:99], v2 offset:16384
    ds_read_b128 v[100:103], v2 offset:17408
    v_mfma_f32_16x16x32_bf16 v[252:255], a[248:251], v[204:207], v[252:255]
    v_exp_f32 v248, v248
    v_mfma_f32_16x16x32_bf16 v[252:255], a[252:255], v[236:239], v[252:255]
    v_exp_f32 v249, v249
    v_mfma_f32_16x16x32_bf16 a[200:203], v[120:123], v[80:83], a[200:203]
    v_exp_f32 v250, v250
    v_mfma_f32_16x16x32_bf16 a[200:203], v[124:127], v[84:87], a[200:203]
    v_exp_f32 v251, v251
    v_mfma_f32_16x16x32_bf16 a[204:207], v[120:123], v[88:91], a[204:207]
    v_cvt_pk_bf16_f32 v61, v246, v247
    v_cvt_pk_bf16_f32 v54, v248, v249
    v_mfma_f32_16x16x32_bf16 a[204:207], v[124:127], v[92:95], a[204:207]
    s_sub_u32 s78, s78, 1
    v_exp_f32 v252, v252
    v_smfmac_f32_16x16x64_bf16 a[216:219], a[136:139], v[80:87], v215
    s_cmp_lg_u32 s78, 0
    v_cvt_pk_bf16_f32 v55, v250, v251
    v_smfmac_f32_16x16x64_bf16 a[220:223], a[136:139], v[88:95], v215
    s_cbranch_scc1 K1_LS
K1_LS_END:
    v_add_f32 v212, s12, v156
    v_fma_f32 v176, v208, s8, v212
    v_fma_f32 v177, v209, s8, v212
    v_fma_f32 v178, v210, s8, v212
    v_fma_f32 v179, v211, s8, v212
    s_nop 1
    s_waitcnt lgkmcnt(0)
    v_mfma_f32_16x16x32_bf16 v[240:243], a[224:227], v[140:143], v[176:179]
    s_xor_b32 s21, s3, 1
    ds_read_b128 v[104:107], v2 offset:18432
    s_lshl2_add_u32 s21, s21, s4
    v_mfma_f32_16x16x32_bf16 v[240:243], a[228:231], v[172:175], v[240:243]
    s_mul_i32 s21, s21, 36864
    ds_read_b128 v[108:111], v2 offset:19456
    ds_read_b128 a[240:243], v2 offset:4096
    v_mfma_f32_16x16x32_bf16 v[240:243], a[232:235], v[204:207], v[240:243]
    s_add_u32 s21, s21, s28
    s_mov_b32 m0, s45
    ds_read_b128 a[244:247], v2 offset:5120
    v_mfma_f32_16x16x32_bf16 v[240:243], a[236:239], v[236:239], v[240:243]
    s_mul_i32 s86, s4, 34
    buffer_load_dwordx4 v1, s[56:59], s21 offen sc1 lds
    v_mfma_f32_16x16x32_bf16 a[8:11], v[96:99], v[48:51], a[8:11]
    s_add_u32 s86, s86, 8
    v_exp_f32 v253, v253
    v_mfma_f32_16x16x32_bf16 a[8:11], v[100:103], v[52:55], a[8:11]
    s_mov_b32 s99, s76
    v_exp_f32 v254, v254
    v_mfma_f32_16x16x32_bf16 a[12:15], v[96:99], v[56:59], a[12:15]
    s_mov_b32 s76, s60
    v_exp_f32 v255, v255
    v_cvt_pk_bf16_f32 v62, v252, v253
    v_cvt_pk_bf16_f32 v63, v254, v255
    s_nop 1
    v_mfma_f32_16x16x32_bf16 a[12:15], v[100:103], v[60:63], a[12:15]
    s_mov_b32 s60, s82
    ds_read_b128 a[248:251], v2 offset:6144
    ds_read_b128 a[252:255], v2 offset:7168
    s_waitcnt lgkmcnt(2)
    v_mfma_f32_16x16x32_bf16 a[24:27], v[104:107], v[48:51], a[24:27]
    s_mov_b32 s82, s95
    v_lshrrev_b32 v28, 4, v1
    ds_read_b128 v[112:115], v2 offset:20480
    v_mfma_f32_16x16x32_bf16 a[24:27], v[108:111], v[52:55], a[24:27]
    s_mov_b32 s95, s93
    v_min_u32 v28, 33, v28
    ds_read_b128 v[116:119], v2 offset:21504
    v_mfma_f32_16x16x32_bf16 a[28:31], v[104:107], v[56:59], a[28:31]
    s_mov_b32 s93, s99
    buffer_load_dwordx4 v1, s[56:59], s21 offen offset:1024 sc1 lds
    v_mfma_f32_16x16x32_bf16 a[28:31], v[108:111], v[60:63], a[28:31]
    s_and_b32 s62, s5, 4
    v_add_lshl_u32 v28, v28, s86, 7
    v_add_f32 v213, s13, v156
    v_fma_f32 v180, v208, s9, v213
    v_fma_f32 v181, v209, s9, v213
    v_fma_f32 v182, v210, s9, v213
    v_fma_f32 v183, v211, s9, v213
    s_nop 1
    v_mfma_f32_16x16x32_bf16 v[244:247], a[240:243], v[140:143], v[180:183]
    s_getpc_b64 s[86:87]
    global_load_dword v28, v28, s[86:87]
    v_mfma_f32_16x16x32_bf16 v[244:247], a[244:247], v[172:175], v[244:247]
    s_lshl_b32 s63, s3, 12
    ds_read_b128 v[120:123], v2 offset:22528
    ds_read_b128 v[124:127], v2 offset:23552
    s_waitcnt lgkmcnt(3)
    v_mfma_f32_16x16x32_bf16 v[244:247], a[248:251], v[204:207], v[244:247]
    s_sub_u32 s19, s74, s101
    buffer_load_dwordx4 v1, s[56:59], s21 offen offset:2048 sc1 lds
    v_mfma_f32_16x16x32_bf16 v[244:247], a[252:255], v[236:239], v[244:247]
    s_add_u32 s62, s62, s4
    ds_read_b128 a[224:227], v2 offset:8192
    ds_read_b128 a[228:231], v2 offset:9216
    v_mfma_f32_16x16x32_bf16 a[40:43], v[112:115], v[48:51], a[40:43]
    s_mov_b32 s20, s63
    ds_read_b128 a[232:235], v2 offset:10240
    v_add_f32 v212, s14, v156
    s_waitcnt lgkmcnt(5)
    v_mfma_f32_16x16x32_bf16 a[40:43], v[116:119], v[52:55], a[40:43]
    s_add_u32 s19, s66, s19
    ds_read_b128 a[236:239], v2 offset:11264
    v_fma_f32 v184, v208, s10, v212
    v_mfma_f32_16x16x32_bf16 a[44:47], v[112:115], v[56:59], a[44:47]
    s_mov_b32 s50, 9437184
    ds_read_b128 v[96:99], v2 offset:24576
    v_fma_f32 v185, v209, s10, v212
    v_mfma_f32_16x16x32_bf16 a[44:47], v[116:119], v[60:63], a[44:47]
    s_waitcnt lgkmcnt(5)
    ds_read_b128 v[100:103], v2 offset:25600
    v_fma_f32 v186, v210, s10, v212
    v_mfma_f32_16x16x32_bf16 a[56:59], v[120:123], v[48:51], a[56:59]
    buffer_load_dwordx4 v1, s[56:59], s21 offen offset:3072 sc1 lds
    v_mfma_f32_16x16x32_bf16 a[56:59], v[124:127], v[52:55], a[56:59]
    s_add_u32 s21, s21, 4096
    v_fma_f32 v187, v211, s10, v212
    ds_read_b128 v[104:107], v2 offset:26624
    v_mfma_f32_16x16x32_bf16 a[60:63], v[120:123], v[56:59], a[60:63]
    s_add_u32 m0, s45, 4096
    ds_read_b128 v[108:111], v2 offset:27648
    ds_read_b128 a[240:243], v2 offset:12288
    v_mfma_f32_16x16x32_bf16 a[60:63], v[124:127], v[60:63], a[60:63]
    s_waitcnt lgkmcnt(4)
    ds_read_b128 a[244:247], v2 offset:13312
    v_add_f32 v213, s15, v156
    v_mfma_f32_16x16x32_bf16 v[248:251], a[224:227], v[140:143], v[184:187]
    ds_read_b128 a[248:251], v2 offset:14336
    v_fma_f32 v188, v208, s11, v213
    v_mfma_f32_16x16x32_bf16 v[248:251], a[228:231], v[172:175], v[248:251]
    ds_read_b128 a[252:255], v2 offset:15360
    v_fma_f32 v189, v209, s11, v213
    v_mfma_f32_16x16x32_bf16 v[248:251], a[232:235], v[204:207], v[248:251]
    buffer_load_dwordx4 v1, s[56:59], s21 offen sc1 lds
    v_mfma_f32_16x16x32_bf16 v[248:251], a[236:239], v[236:239], v[248:251]
    ds_read_b128 v[112:115], v2 offset:28672
    ds_read_b128 v[116:119], v2 offset:29696
    v_mfma_f32_16x16x32_bf16 a[152:155], v[96:99], v[48:51], a[152:155]
    s_waitcnt lgkmcnt(4)
    v_fma_f32 v190, v210, s11, v213
    v_fma_f32 v191, v211, s11, v213
    v_mfma_f32_16x16x32_bf16 a[152:155], v[100:103], v[52:55], a[152:155]
    ds_read_b128 v[120:123], v2 offset:30720
    ds_read_b128 v[124:127], v2 offset:31744
    v_mfma_f32_16x16x32_bf16 a[156:159], v[96:99], v[56:59], a[156:159]
    v_add_u32 v2, s82, v1
    ds_read_b128 v[96:99], v2 offset:16384
    v_mfma_f32_16x16x32_bf16 a[156:159], v[100:103], v[60:63], a[156:159]
    ds_read_b128 v[100:103], v2 offset:17408
    v_bfe_u32 v217, v1, 4, 3
    v_mfma_f32_16x16x32_bf16 a[168:171], v[104:107], v[48:51], a[168:171]
    buffer_load_dwordx4 v1, s[56:59], s21 offen offset:1024 sc1 lds
    v_mfma_f32_16x16x32_bf16 a[168:171], v[108:111], v[52:55], a[168:171]
    v_exp_f32 v240, v240
    v_mfma_f32_16x16x32_bf16 a[172:175], v[104:107], v[56:59], a[172:175]
    ds_read_b128 v[104:107], v2 offset:18432
    v_lshlrev_b32 v217, 7, v217
    v_mfma_f32_16x16x32_bf16 a[172:175], v[108:111], v[60:63], a[172:175]
    v_exp_f32 v241, v241
    v_mfma_f32_16x16x32_bf16 v[252:255], a[240:243], v[140:143], v[188:191]
    ds_read_b128 v[108:111], v2 offset:19456
    v_cvt_pk_bf16_f32 v88, v240, v241
    v_mfma_f32_16x16x32_bf16 v[252:255], a[244:247], v[172:175], v[252:255]
    s_waitcnt lgkmcnt(2)
    v_exp_f32 v242, v242
    v_mfma_f32_16x16x32_bf16 v[252:255], a[248:251], v[204:207], v[252:255]
    buffer_load_dwordx4 v1, s[56:59], s21 offen offset:2048 sc1 lds
    v_mfma_f32_16x16x32_bf16 v[252:255], a[252:255], v[236:239], v[252:255]
    v_exp_f32 v243, v243
    v_mfma_f32_16x16x32_bf16 a[184:187], v[112:115], v[48:51], a[184:187]
    v_exp_f32 v244, v244
    v_mfma_f32_16x16x32_bf16 a[184:187], v[116:119], v[52:55], a[184:187]
    v_exp_f32 v245, v245
    v_mfma_f32_16x16x32_bf16 a[188:191], v[112:115], v[56:59], a[188:191]
    ds_read_b128 v[112:115], v2 offset:20480
    v_cvt_pk_bf16_f32 v89, v242, v243
    v_mfma_f32_16x16x32_bf16 a[188:191], v[116:119], v[60:63], a[188:191]
    v_exp_f32 v246, v246
    v_mfma_f32_16x16x32_bf16 a[200:203], v[120:123], v[48:51], a[200:203]
    v_exp_f32 v247, v247
    v_mfma_f32_16x16x32_bf16 a[200:203], v[124:127], v[52:55], a[200:203]
    v_exp_f32 v248, v248
    v_mfma_f32_16x16x32_bf16 a[204:207], v[120:123], v[56:59], a[204:207]
    v_exp_f32 v249, v249
    v_mfma_f32_16x16x32_bf16 a[204:207], v[124:127], v[60:63], a[204:207]
    v_exp_f32 v250, v250
    v_smfmac_f32_16x16x64_bf16 a[216:219], a[136:139], v[48:55], v215
    s_add_u32 s48, s32, 1048576
    s_addc_u32 s49, s33, 0
    ds_read_b128 v[116:119], v2 offset:21504
    v_smfmac_f32_16x16x64_bf16 a[220:223], a[136:139], v[56:63], v215
    v_exp_f32 v251, v251
    v_cvt_pk_bf16_f32 v90, v244, v245
    v_cvt_pk_bf16_f32 v91, v246, v247
    v_cvt_pk_bf16_f32 v92, v248, v249
    v_cvt_pk_bf16_f32 v93, v250, v251
    v_exp_f32 v252, v252
    s_cmp_eq_u32 s6, 7
    s_cbranch_scc1 K1_S7
K1_S7_BACK:
    s_waitcnt lgkmcnt(0)
    v_mfma_f32_16x16x32_bf16 a[12:15], v[96:99], v[88:91], a[12:15]
    ds_read_b128 v[120:123], v2 offset:22528
    v_exp_f32 v253, v253
    v_exp_f32 v254, v254
    v_exp_f32 v255, v255
    v_cvt_pk_bf16_f32 v94, v252, v253
    v_cvt_pk_bf16_f32 v95, v254, v255
    s_nop 1
    v_mfma_f32_16x16x32_bf16 a[12:15], v[100:103], v[92:95], a[12:15]
    ds_read_b128 v[124:127], v2 offset:23552
    ds_read_b128 v[96:99], v2 offset:24576
    v_accvgpr_read_b32 v12, a8
    v_accvgpr_read_b32 v13, a9
    v_accvgpr_read_b32 v14, a10
    v_mfma_f32_16x16x32_bf16 a[28:31], v[104:107], v[88:91], a[28:31]
    ds_read_b128 v[100:103], v2 offset:25600
    v_accvgpr_read_b32 v9, a216
    v_accvgpr_read_b32 v10, a217
    v_add_f32 v9, v9, v10
    v_accvgpr_read_b32 v15, a11
    v_mfma_f32_16x16x32_bf16 a[28:31], v[108:111], v[92:95], a[28:31]
    ds_read_b128 v[104:107], v2 offset:26624
    v_rcp_f32 v10, v9
    v_accvgpr_read_b32 v16, a24
    v_mul_f32 v10, v10, v6
    v_mfma_f32_16x16x32_bf16 a[44:47], v[112:115], v[88:91], a[44:47]
    ds_read_b128 v[108:111], v2 offset:27648
    v_accvgpr_read_b32 v17, a25
    v_accvgpr_read_b32 v18, a26
    v_accvgpr_read_b32 v19, a27
    v_accvgpr_read_b32 v20, a40
    v_mfma_f32_16x16x32_bf16 a[44:47], v[116:119], v[92:95], a[44:47]
    s_waitcnt lgkmcnt(5)
    ds_read_b128 v[112:115], v2 offset:28672
    v_accvgpr_read_b32 v21, a41
    v_accvgpr_read_b32 v22, a42
    v_accvgpr_read_b32 v23, a43
    v_accvgpr_read_b32 v24, a56
    v_mfma_f32_16x16x32_bf16 a[60:63], v[120:123], v[88:91], a[60:63]
    s_waitcnt lgkmcnt(3)
    ds_read_b128 v[116:119], v2 offset:29696
    v_accvgpr_read_b32 v25, a57
    v_accvgpr_read_b32 v26, a58
    v_accvgpr_read_b32 v27, a59
    v_mul_f32 v12, v10, v12
    v_mfma_f32_16x16x32_bf16 a[60:63], v[124:127], v[92:95], a[60:63]
    ds_read_b128 v[120:123], v2 offset:30720
    v_mul_f32 v13, v10, v13
    v_mul_f32 v14, v10, v14
    v_mul_f32 v15, v10, v15
    v_mul_f32 v16, v10, v16
    v_mfma_f32_16x16x32_bf16 a[156:159], v[96:99], v[88:91], a[156:159]
    ds_read_b128 v[124:127], v2 offset:31744
    v_mul_f32 v17, v10, v17
    v_mul_f32 v18, v10, v18
    v_mul_f32 v19, v10, v19
    v_mul_f32 v20, v10, v20
    v_mfma_f32_16x16x32_bf16 a[156:159], v[100:103], v[92:95], a[156:159]
    s_waitcnt lgkmcnt(3)
    v_mul_f32 v21, v10, v21
    v_mul_f32 v22, v10, v22
    v_mul_f32 v23, v10, v23
    v_mul_f32 v24, v10, v24
    v_mul_f32 v25, v10, v25
    v_mfma_f32_16x16x32_bf16 a[172:175], v[104:107], v[88:91], a[172:175]
    v_mul_f32 v26, v10, v26
    v_mul_f32 v27, v10, v27
    v_cvt_pk_bf16_f32 v12, v12, v13
    v_cvt_pk_bf16_f32 v13, v14, v15
    v_cvt_pk_bf16_f32 v14, v16, v17
    v_mfma_f32_16x16x32_bf16 a[172:175], v[108:111], v[92:95], a[172:175]
    v_cvt_pk_bf16_f32 v15, v18, v19
    v_cvt_pk_bf16_f32 v20, v20, v21
    v_cvt_pk_bf16_f32 v21, v22, v23
    v_cvt_pk_bf16_f32 v22, v24, v25
    v_cvt_pk_bf16_f32 v23, v26, v27
    v_mfma_f32_16x16x32_bf16 a[188:191], v[112:115], v[88:91], a[188:191]
    s_waitcnt lgkmcnt(1)
    buffer_store_dwordx4 v[12:15], v1, s[40:43], s81 offen offset:0 sc1
    buffer_store_dwordx4 v[20:23], v1, s[40:43], s81 offen offset:1024 sc1
    v_accvgpr_read_b32 v16, a168
    v_mfma_f32_16x16x32_bf16 a[188:191], v[116:119], v[92:95], a[188:191]
    v_accvgpr_read_b32 v12, a152
    v_accvgpr_read_b32 v13, a153
    v_accvgpr_read_b32 v14, a154
    v_accvgpr_read_b32 v15, a155
    v_accvgpr_read_b32 v17, a169
    v_mfma_f32_16x16x32_bf16 a[204:207], v[120:123], v[88:91], a[204:207]
    s_waitcnt lgkmcnt(0)
    v_accvgpr_read_b32 v18, a170
    v_accvgpr_read_b32 v19, a171
    v_accvgpr_read_b32 v20, a184
    v_accvgpr_read_b32 v21, a185
    v_accvgpr_read_b32 v22, a186
    v_mfma_f32_16x16x32_bf16 a[204:207], v[124:127], v[92:95], a[204:207]
    v_accvgpr_read_b32 v23, a187
    v_accvgpr_read_b32 v24, a200
    v_accvgpr_read_b32 v25, a201
    v_accvgpr_read_b32 v26, a202
    v_accvgpr_read_b32 v27, a203
    v_smfmac_f32_16x16x64_bf16 a[220:223], a[136:139], v[88:95], v215
    v_mul_f32 v12, v10, v12
    v_mul_f32 v13, v10, v13
    v_mul_f32 v14, v10, v14
    v_mul_f32 v15, v10, v15
    v_mul_f32 v16, v10, v16
    v_mul_f32 v17, v10, v17
    v_mul_f32 v18, v10, v18
    v_mul_f32 v19, v10, v19
    v_mul_f32 v20, v10, v20
    v_mul_f32 v21, v10, v21
    v_mul_f32 v22, v10, v22
    v_mul_f32 v23, v10, v23
    v_mul_f32 v24, v10, v24
    v_mul_f32 v25, v10, v25
    v_mul_f32 v26, v10, v26
    v_mul_f32 v27, v10, v27
    v_cmp_nge_f32 vcc, 0x5f800000, v9
    v_cvt_pk_bf16_f32 v12, v12, v13
    v_cvt_pk_bf16_f32 v13, v14, v15
    v_cvt_pk_bf16_f32 v14, v16, v17
    v_cvt_pk_bf16_f32 v15, v18, v19
    v_cvt_pk_bf16_f32 v20, v20, v21
    v_cvt_pk_bf16_f32 v21, v22, v23
    v_cvt_pk_bf16_f32 v22, v24, v25
    v_cvt_pk_bf16_f32 v23, v26, v27
    s_or_b64 s[84:85], s[84:85], vcc
    buffer_store_dwordx4 v[12:15], v1, s[40:43], s81 offen offset:2048 sc1
    buffer_store_dwordx4 v[20:23], v1, s[40:43], s81 offen offset:3072 sc1
    s_nop 3
    v_accvgpr_read_b32 v9, a220
    v_accvgpr_read_b32 v10, a221
    v_add_f32 v9, v9, v10
    v_cmp_nge_f32 vcc, 0x5f800000, v9
    v_rcp_f32 v10, v9
    s_nop 0
    s_or_b64 s[84:85], s[84:85], vcc
    v_mul_f32 v10, v10, v7
    s_add_u32 s72, s81, 622592
    v_accvgpr_read_b32 v12, a12
    v_accvgpr_read_b32 v13, a13
    v_accvgpr_read_b32 v14, a14
    v_accvgpr_read_b32 v15, a15
    v_accvgpr_read_b32 v16, a28
    v_accvgpr_read_b32 v17, a29
    v_accvgpr_read_b32 v18, a30
    v_accvgpr_read_b32 v19, a31
    v_pk_mul_f32 v[12:13], v[12:13], v[10:11] op_sel_hi:[1,0]
    v_pk_mul_f32 v[14:15], v[14:15], v[10:11] op_sel_hi:[1,0]
    v_pk_mul_f32 v[16:17], v[16:17], v[10:11] op_sel_hi:[1,0]
    v_pk_mul_f32 v[18:19], v[18:19], v[10:11] op_sel_hi:[1,0]
    v_cvt_pk_bf16_f32 v12, v12, v13
    v_cvt_pk_bf16_f32 v13, v14, v15
    v_cvt_pk_bf16_f32 v14, v16, v17
    v_cvt_pk_bf16_f32 v15, v18, v19
    buffer_store_dwordx4 v[12:15], v1, s[40:43], s72 offen offset:0 sc1
    v_accvgpr_read_b32 v20, a44
    v_accvgpr_read_b32 v21, a45
    v_accvgpr_read_b32 v22, a46
    v_accvgpr_read_b32 v23, a47
    v_accvgpr_read_b32 v24, a60
    v_accvgpr_read_b32 v25, a61
    v_accvgpr_read_b32 v26, a62
    v_accvgpr_read_b32 v27, a63
    v_pk_mul_f32 v[20:21], v[20:21], v[10:11] op_sel_hi:[1,0]
    v_pk_mul_f32 v[22:23], v[22:23], v[10:11] op_sel_hi:[1,0]
    v_pk_mul_f32 v[24:25], v[24:25], v[10:11] op_sel_hi:[1,0]
    v_pk_mul_f32 v[26:27], v[26:27], v[10:11] op_sel_hi:[1,0]
    v_cvt_pk_bf16_f32 v20, v20, v21
    v_cvt_pk_bf16_f32 v21, v22, v23
    v_cvt_pk_bf16_f32 v22, v24, v25
    v_cvt_pk_bf16_f32 v23, v26, v27
    buffer_store_dwordx4 v[20:23], v1, s[40:43], s72 offen offset:1024 sc1
    v_accvgpr_read_b32 v12, a156
    v_accvgpr_read_b32 v13, a157
    v_accvgpr_read_b32 v14, a158
    v_accvgpr_read_b32 v15, a159
    v_accvgpr_read_b32 v16, a172
    v_accvgpr_read_b32 v17, a173
    v_accvgpr_read_b32 v18, a174
    v_accvgpr_read_b32 v19, a175
    v_pk_mul_f32 v[12:13], v[12:13], v[10:11] op_sel_hi:[1,0]
    v_pk_mul_f32 v[14:15], v[14:15], v[10:11] op_sel_hi:[1,0]
    v_pk_mul_f32 v[16:17], v[16:17], v[10:11] op_sel_hi:[1,0]
    v_pk_mul_f32 v[18:19], v[18:19], v[10:11] op_sel_hi:[1,0]
    v_cvt_pk_bf16_f32 v12, v12, v13
    v_cvt_pk_bf16_f32 v13, v14, v15
    v_cvt_pk_bf16_f32 v14, v16, v17
    v_cvt_pk_bf16_f32 v15, v18, v19
    buffer_store_dwordx4 v[12:15], v1, s[40:43], s72 offen offset:2048 sc1
    v_accvgpr_read_b32 v20, a188
    v_accvgpr_read_b32 v21, a189
    v_accvgpr_read_b32 v22, a190
    v_accvgpr_read_b32 v23, a191
    v_accvgpr_read_b32 v24, a204
    v_accvgpr_read_b32 v25, a205
    v_accvgpr_read_b32 v26, a206
    v_accvgpr_read_b32 v27, a207
    v_pk_mul_f32 v[20:21], v[20:21], v[10:11] op_sel_hi:[1,0]
    v_pk_mul_f32 v[22:23], v[22:23], v[10:11] op_sel_hi:[1,0]
    v_pk_mul_f32 v[24:25], v[24:25], v[10:11] op_sel_hi:[1,0]
    v_pk_mul_f32 v[26:27], v[26:27], v[10:11] op_sel_hi:[1,0]
    v_cvt_pk_bf16_f32 v20, v20, v21
    v_cvt_pk_bf16_f32 v21, v22, v23
    v_cvt_pk_bf16_f32 v22, v24, v25
    v_cvt_pk_bf16_f32 v23, v26, v27
    buffer_store_dwordx4 v[20:23], v1, s[40:43], s72 offen offset:3072 sc1
    buffer_load_dword v3, v217, s[32:35], s19 offen sc1
    s_waitcnt lgkmcnt(0)
    s_barrier
    s_sub_u32 s30, s47, s75
    s_sub_u32 s31, s79, s75
    v_bfe_u32 v20, v1, 4, 4
    v_lshrrev_b32 v21, 8, v1
    s_lshl_b32 s98, s4, 4
    s_add_u32 s98, s98, 16
    v_add_u32 v22, s98, v20
    v_mul_u32_u24 v22, 144, v22
    v_add_u32 v22, s30, v22
    v_lshl_add_u32 v9, v21, 3, v22
    s_lshr_b32 s98, s73, 1
    v_add_u32 v8, s98, v9
    v_subrev_u32 v10, s98, v9
    s_sub_u32 s99, s31, s30
    v_add_u32 v24, s99, v8
    v_add_u32 v25, s99, v9
    v_add_u32 v26, s99, v10
    s_bitcmp1_b32 s4, 0
    s_cselect_b32 s99, s31, s30
    v_mul_u32_u24 v23, 144, v20
    v_lshl_add_u32 v23, v21, 3, v23
    v_add_u32 v13, s99, v23
    v_add_u32 v12, s98, v13
    v_accvgpr_read_b32 v32, a64
    v_accvgpr_read_b32 v33, a65
    v_accvgpr_read_b32 v34, a66
    v_accvgpr_read_b32 v35, a67
    v_cvt_pk_bf16_f32 v32, v32, v33
    v_cvt_pk_bf16_f32 v33, v34, v35
    ds_write_b64 v8, v[32:33] offset:0
    v_accvgpr_read_b32 v36, a68
    v_accvgpr_read_b32 v37, a69
    v_accvgpr_read_b32 v38, a70
    v_accvgpr_read_b32 v39, a71
    v_cvt_pk_bf16_f32 v36, v36, v37
    v_cvt_pk_bf16_f32 v37, v38, v39
    ds_write_b64 v8, v[36:37] offset:9216
    v_accvgpr_read_b32 v40, a72
    v_accvgpr_read_b32 v41, a73
    v_accvgpr_read_b32 v42, a74
    v_accvgpr_read_b32 v43, a75
    v_cvt_pk_bf16_f32 v40, v40, v41
    v_cvt_pk_bf16_f32 v41, v42, v43
    ds_write_b64 v24, v[40:41] offset:0
    v_accvgpr_read_b32 v44, a76
    v_accvgpr_read_b32 v45, a77
    v_accvgpr_read_b32 v46, a78
    v_accvgpr_read_b32 v47, a79
    v_cvt_pk_bf16_f32 v44, v44, v45
    v_cvt_pk_bf16_f32 v45, v46, v47
    ds_write_b64 v24, v[44:45] offset:9216
    v_accvgpr_read_b32 v32, a80
    v_accvgpr_read_b32 v33, a81
    v_accvgpr_read_b32 v34, a82
    v_accvgpr_read_b32 v35, a83
    v_cvt_pk_bf16_f32 v32, v32, v33
    v_cvt_pk_bf16_f32 v33, v34, v35
    ds_write_b64 v9, v[32:33] offset:32
    v_accvgpr_read_b32 v36, a84
    v_accvgpr_read_b32 v37, a85
    v_accvgpr_read_b32 v38, a86
    v_accvgpr_read_b32 v39, a87
    v_cvt_pk_bf16_f32 v36, v36, v37
    v_cvt_pk_bf16_f32 v37, v38, v39
    ds_write_b64 v9, v[36:37] offset:9248
    v_accvgpr_read_b32 v40, a88
    v_accvgpr_read_b32 v41, a89
    v_accvgpr_read_b32 v42, a90
    v_accvgpr_read_b32 v43, a91
    v_cvt_pk_bf16_f32 v40, v40, v41
    v_cvt_pk_bf16_f32 v41, v42, v43
    ds_write_b64 v25, v[40:41] offset:32
    v_accvgpr_read_b32 v44, a92
    v_accvgpr_read_b32 v45, a93
    v_accvgpr_read_b32 v46, a94
    v_accvgpr_read_b32 v47, a95
    v_cvt_pk_bf16_f32 v44, v44, v45
    v_cvt_pk_bf16_f32 v45, v46, v47
    ds_write_b64 v25, v[44:45] offset:9248
    v_accvgpr_read_b32 v32, a96
    v_accvgpr_read_b32 v33, a97
    v_accvgpr_read_b32 v34, a98
    v_accvgpr_read_b32 v35, a99
    v_cvt_pk_bf16_f32 v32, v32, v33
    v_cvt_pk_bf16_f32 v33, v34, v35
    ds_write_b64 v10, v[32:33] offset:64
    v_accvgpr_read_b32 v36, a100
    v_accvgpr_read_b32 v37, a101
    v_accvgpr_read_b32 v38, a102
    v_accvgpr_read_b32 v39, a103
    v_cvt_pk_bf16_f32 v36, v36, v37
    v_cvt_pk_bf16_f32 v37, v38, v39
    ds_write_b64 v10, v[36:37] offset:9280
    v_accvgpr_read_b32 v40, a104
    v_accvgpr_read_b32 v41, a105
    v_accvgpr_read_b32 v42, a106
    v_accvgpr_read_b32 v43, a107
    v_cvt_pk_bf16_f32 v40, v40, v41
    v_cvt_pk_bf16_f32 v41, v42, v43
    ds_write_b64 v26, v[40:41] offset:64
    v_accvgpr_read_b32 v44, a108
    v_accvgpr_read_b32 v45, a109
    v_accvgpr_read_b32 v46, a110
    v_accvgpr_read_b32 v47, a111
    v_cvt_pk_bf16_f32 v44, v44, v45
    v_cvt_pk_bf16_f32 v45, v46, v47
    ds_write_b64 v26, v[44:45] offset:9280
    v_mov_b32 v218, 2
    s_cmp_eq_u64 s[84:85], 0
    s_cselect_b32 s7, s74, 1073741824
    s_cmp_lg_u32 s83, 0
    s_cselect_b32 s7, s74, s7
    s_waitcnt vmcnt(1)
    buffer_store_dword v218, v216, s[32:35], s7 offen sc1
    s_xor_b32 s21, s3, 2
    s_lshl2_add_u32 s21, s21, s4
    s_mul_i32 s21, s21, 36864
    s_add_u32 s21, s21, s28
    s_mov_b32 m0, s46
    s_nop 0
    buffer_load_dwordx4 v1, s[56:59], s21 offen sc1 lds
    v_accvgpr_read_b32 v32, a112
    v_accvgpr_read_b32 v33, a113
    v_accvgpr_read_b32 v34, a114
    v_accvgpr_read_b32 v35, a115
    v_cvt_pk_bf16_f32 v32, v32, v33
    v_cvt_pk_bf16_f32 v33, v34, v35
    ds_write_b64 v9, v[32:33] offset:96
    v_accvgpr_read_b32 v36, a116
    v_accvgpr_read_b32 v37, a117
    v_accvgpr_read_b32 v38, a118
    v_accvgpr_read_b32 v39, a119
    v_cvt_pk_bf16_f32 v36, v36, v37
    buffer_load_dwordx4 v1, s[56:59], s21 offen offset:1024 sc1 lds
    v_cvt_pk_bf16_f32 v37, v38, v39
    ds_write_b64 v9, v[36:37] offset:9312
    v_accvgpr_read_b32 v40, a120
    v_accvgpr_read_b32 v41, a121
    v_accvgpr_read_b32 v42, a122
    v_accvgpr_read_b32 v43, a123
    v_cvt_pk_bf16_f32 v40, v40, v41
    v_cvt_pk_bf16_f32 v41, v42, v43
    ds_write_b64 v25, v[40:41] offset:96
    v_accvgpr_read_b32 v44, a124
    v_accvgpr_read_b32 v45, a125
    v_accvgpr_read_b32 v46, a126
    buffer_load_dwordx4 v1, s[56:59], s21 offen offset:2048 sc1 lds
    v_accvgpr_read_b32 v47, a127
    v_cvt_pk_bf16_f32 v44, v44, v45
    v_cvt_pk_bf16_f32 v45, v46, v47
    s_waitcnt lgkmcnt(3)
    ds_write_b64 v25, v[44:45] offset:9312
    v_accvgpr_read_b32 v32, a128
    v_accvgpr_read_b32 v33, a129
    v_accvgpr_read_b32 v34, a130
    v_accvgpr_read_b32 v35, a131
    v_cvt_pk_bf16_f32 v32, v32, v33
    v_cvt_pk_bf16_f32 v33, v34, v35
    ds_write_b64 v12, v[32:33] offset:0
    v_accvgpr_read_b32 v36, a132
    buffer_load_dwordx4 v1, s[56:59], s21 offen offset:3072 sc1 lds
    v_accvgpr_read_b32 v37, a133
    v_accvgpr_read_b32 v38, a134
    v_accvgpr_read_b32 v39, a135
    v_cvt_pk_bf16_f32 v36, v36, v37
    v_cvt_pk_bf16_f32 v37, v38, v39
    s_cmp_eq_u32 s73, 0
    s_cselect_b64 exec, -1, 0
    ds_write_b64 v13, v[36:37] offset:32
    s_mov_b64 exec, -1
    s_cmp_lg_u64 s[84:85], 0
    s_cselect_b32 s7, 1, 0
    v_mov_b32 v20, s7
    s_lshl2_add_u32 s98, s4, s30
    s_add_u32 s21, s21, 4096
    s_add_u32 m0, s46, 4096
    s_nop 0
    buffer_load_dwordx4 v1, s[56:59], s21 offen sc1 lds
    v_mov_b32 v21, s98
    ds_write_b32 v21, v20 offset:20736
    v_mov_b32 v21, s30
    s_and_b32 s98, s4, 1
    s_lshl_b32 s98, s98, 6
    v_lshrrev_b32 v14, 4, v1
    v_add_u32 v14, s98, v14
    s_sub_u32 s7, 15, s6
    s_cmp_lt_u32 s4, 2
    s_cselect_b32 s7, s6, s7
    s_cselect_b32 s99, s30, s31
    s_lshl_b32 s7, s7, 7
    buffer_load_dwordx4 v1, s[56:59], s21 offen offset:1024 sc1 lds
    v_add_u32 v2, 2, v14
    v_mul_u32_u24 v2, 144, v2
    v_add_u32 v2, s99, v2
    v_add_u32 v14, s7, v14
    v_lshrrev_b32 v15, 4, v14
    s_mov_b32 s98, 155648
    v_mul_lo_u32 v15, v15, s98
    v_and_b32 v23, 0xf0, v1
    v_add_u32 v15, v15, v23
    s_lshl3_add_u32 s98, s6, s62
    s_mul_i32 s98, s98, 155648
    v_add_u32 v4, s98, v1
    buffer_load_dwordx4 v1, s[56:59], s21 offen offset:2048 sc1 lds
    s_sub_u32 s98, 15, s6
    s_lshl3_add_u32 s98, s98, s62
    s_mul_i32 s98, s98, 155648
    v_add_u32 v5, s98, v1
    v_mov_b32 v19, v217
    v_subrev_u32 v23, s75, v1
    v_add_u32 v11, s44, v23
    v_add_u32 v12, s45, v23
    v_add_u32 v13, s46, v23
    v_add_u32 v6, s47, v23
    v_add_u32 v7, s79, v23
    s_mov_b32 s98, 0xbfb8aa3b
    s_mov_b32 s99, 0x3eae1a93
    s_waitcnt vmcnt(8) lgkmcnt(0)
    s_barrier
    ds_read_b128 v[24:27], v21 offset:20736
    ds_read_b128 v[32:35], v2 offset:2016
    ds_read_b128 v[36:39], v2 offset:2032
    ds_read_b128 v[40:43], v2 offset:2048
    ds_read_b128 v[44:47], v2 offset:1728
    ds_read_b128 v[48:51], v2 offset:1744
    ds_read_b128 v[52:55], v2 offset:1760
    s_waitcnt lgkmcnt(6)
    v_or3_b32 v24, v24, v25, v26
    v_or_b32 v24, v24, v27
    s_nop 0
    v_readfirstlane_b32 s7, v24
    s_nop 1
    s_andn2_b32 s7, s7, s83
    s_cbranch_scc1 K1_REDO
    buffer_load_dword v28, v29, s[32:35], s92 offen sc1
    v_cmp_gt_u32 vcc, 1, v3
    s_nop 1
    s_and_b64 vcc, vcc, exec
    s_cbranch_scc1 SPIN_SHORT
BACK_SHORT:
    buffer_load_dwordx4 a[0:3], v4, s[40:43], s63 offen offset:0 sc1
    ds_read_b128 v[128:131], v2 offset:2096
    ds_read_b128 v[132:135], v2 offset:2112
    ds_read_b128 v[136:139], v2 offset:2128
    ds_read_b128 v[56:59], v2 offset:1440
    ds_read_b128 v[60:63], v2 offset:1456
    ds_read_b128 v[64:67], v2 offset:1472
    ds_read_b128 v[68:71], v2 offset:1152
    ds_read_b128 v[72:75], v2 offset:1168
    ds_read_b128 v[76:79], v2 offset:1184
    s_waitcnt lgkmcnt(8)
    v_dot2_f32_bf16 v140, v128, v32, 0
    v_dot2_f32_bf16 v141, v128, v44, 0
    buffer_load_dwordx4 a[8:11], v4, s[40:43], s63 offen offset:1024 sc1
    ds_read_b128 v[80:83], v2 offset:864
    s_waitcnt lgkmcnt(6)
    v_dot2_f32_bf16 v142, v128, v56, 0
    s_waitcnt lgkmcnt(3)
    v_dot2_f32_bf16 v143, v128, v68, 0
    ds_read_b128 v[84:87], v2 offset:880
    v_dot2c_f32_bf16 v140, v129, v33
    v_dot2c_f32_bf16 v141, v129, v45
    ds_read_b128 v[88:91], v2 offset:896
    v_dot2c_f32_bf16 v142, v129, v57
    v_dot2c_f32_bf16 v143, v129, v69
    ds_read_b128 v[92:95], v2 offset:576
    v_dot2c_f32_bf16 v140, v130, v34
    buffer_load_dwordx4 a[16:19], v4, s[40:43], s63 offen offset:2048 sc1
    v_dot2c_f32_bf16 v141, v130, v46
    ds_read_b128 v[96:99], v2 offset:592
    v_dot2c_f32_bf16 v142, v130, v58
    v_dot2c_f32_bf16 v143, v130, v70
    ds_read_b128 v[100:103], v2 offset:608
    v_dot2c_f32_bf16 v140, v131, v35
    v_dot2c_f32_bf16 v141, v131, v47
    ds_read_b128 v[104:107], v2 offset:288
    v_dot2c_f32_bf16 v142, v131, v59
    v_dot2c_f32_bf16 v143, v131, v71
    ds_read_b128 v[108:111], v2 offset:304
    v_dot2c_f32_bf16 v140, v132, v36
    buffer_load_dwordx4 a[24:27], v4, s[40:43], s63 offen offset:3072 sc1
    v_dot2c_f32_bf16 v141, v132, v48
    ds_read_b128 v[112:115], v2 offset:320
    v_dot2c_f32_bf16 v142, v132, v60
    s_waitcnt lgkmcnt(8)
    v_dot2c_f32_bf16 v143, v132, v72
    ds_read_b128 v[116:119], v2 offset:0
    v_dot2c_f32_bf16 v140, v133, v37
    v_dot2c_f32_bf16 v141, v133, v49
    ds_read_b128 v[120:123], v2 offset:16
    v_dot2c_f32_bf16 v142, v133, v61
    v_dot2c_f32_bf16 v143, v133, v73
    ds_read_b128 v[124:127], v2 offset:32
    s_xor_b32 s63, s63, 4096
    buffer_load_dwordx4 a[32:35], v4, s[40:43], s63 offen offset:0 sc1
    v_dot2c_f32_bf16 v140, v134, v38
    v_dot2c_f32_bf16 v141, v134, v50
    v_dot2c_f32_bf16 v142, v134, v62
    v_dot2c_f32_bf16 v143, v134, v74
    v_dot2c_f32_bf16 v140, v135, v39
    v_dot2c_f32_bf16 v141, v135, v51
    v_dot2c_f32_bf16 v142, v135, v63
    v_dot2c_f32_bf16 v143, v135, v75
    v_dot2c_f32_bf16 v140, v136, v40
    v_dot2c_f32_bf16 v141, v136, v52
    v_dot2c_f32_bf16 v142, v136, v64
    buffer_load_dwordx4 a[40:43], v4, s[40:43], s63 offen offset:1024 sc1
    v_dot2c_f32_bf16 v143, v136, v76
    v_dot2_f32_bf16 v144, v128, v80, 0
    s_waitcnt lgkmcnt(4)
    v_dot2_f32_bf16 v145, v128, v92, 0
    ds_read_b128 v[32:35], v2 offset:2064
    v_dot2_f32_bf16 v146, v128, v104, 0
    s_waitcnt lgkmcnt(3)
    v_dot2_f32_bf16 v147, v128, v116, 0
    ds_read_b128 v[36:39], v2 offset:2080
    v_dot2c_f32_bf16 v144, v129, v81
    v_dot2c_f32_bf16 v145, v129, v93
    ds_read_b128 v[44:47], v2 offset:1776
    v_dot2c_f32_bf16 v146, v129, v105
    v_dot2c_f32_bf16 v147, v129, v117
    buffer_load_dwordx4 a[48:51], v4, s[40:43], s63 offen offset:2048 sc1
    ds_read_b128 v[48:51], v2 offset:1792
    v_dot2c_f32_bf16 v144, v130, v82
    v_dot2c_f32_bf16 v145, v130, v94
    ds_read_b128 v[56:59], v2 offset:1488
    v_dot2c_f32_bf16 v146, v130, v106
    v_dot2c_f32_bf16 v147, v130, v118
    ds_read_b128 v[60:63], v2 offset:1504
    v_dot2c_f32_bf16 v144, v131, v83
    v_dot2c_f32_bf16 v145, v131, v95
    ds_read_b128 v[68:71], v2 offset:1200
    v_dot2c_f32_bf16 v146, v131, v107
    buffer_load_dwordx4 a[56:59], v4, s[40:43], s63 offen offset:3072 sc1
    v_dot2c_f32_bf16 v147, v131, v119
    ds_read_b128 v[72:75], v2 offset:1216
    v_dot2c_f32_bf16 v144, v132, v84
    v_dot2c_f32_bf16 v145, v132, v96
    v_dot2c_f32_bf16 v146, v132, v108
    s_waitcnt lgkmcnt(8)
    v_dot2c_f32_bf16 v147, v132, v120
    v_dot2c_f32_bf16 v144, v133, v85
    v_dot2c_f32_bf16 v145, v133, v97
    v_dot2c_f32_bf16 v146, v133, v109
    v_dot2c_f32_bf16 v147, v133, v121
    v_dot2c_f32_bf16 v144, v134, v86
    s_xor_b32 s63, s63, 12288
    buffer_load_dwordx4 a[64:67], v4, s[40:43], s63 offen offset:0 sc1
    v_dot2c_f32_bf16 v145, v134, v98
    v_dot2c_f32_bf16 v146, v134, v110
    v_dot2c_f32_bf16 v147, v134, v122
    v_dot2c_f32_bf16 v144, v135, v87
    v_dot2c_f32_bf16 v145, v135, v99
    v_dot2c_f32_bf16 v146, v135, v111
    v_dot2c_f32_bf16 v147, v135, v123
    v_dot2c_f32_bf16 v144, v136, v88
    v_dot2c_f32_bf16 v145, v136, v100
    v_dot2c_f32_bf16 v146, v136, v112
    v_dot2c_f32_bf16 v147, v136, v124
    v_lshlrev_b32 v8, 16, v138
    buffer_load_dwordx4 a[72:75], v4, s[40:43], s63 offen offset:1024 sc1
    v_mul_f32 v8, s98, v8
    v_exp_f32 v8, v8
    s_or_b32 s7, s6, s4
    s_cbranch_scc0 K1_WMASK
K1_WMASK_BACK:
    v_max3_f32 v9, v140, v141, v142
    v_max3_f32 v10, v143, v144, v145
    v_max3_f32 v9, v9, v146, v147
    v_max_f32 v9, v9, v10
    v_mul_f32 v9, s99, v9
    v_add_f32 v8, 1.0, v8
    buffer_load_dwordx4 a[80:83], v4, s[40:43], s63 offen offset:2048 sc1
    v_fma_f32 v140, v140, s99, -v9
    ds_read_b128 v[80:83], v2 offset:912
    v_fma_f32 v141, v141, s99, -v9
    ds_read_b128 v[84:87], v2 offset:928
    v_fma_f32 v142, v142, s99, -v9
    ds_read_b128 v[92:95], v2 offset:624
    v_fma_f32 v143, v143, s99, -v9
    ds_read_b128 v[96:99], v2 offset:640
    v_fma_f32 v144, v144, s99, -v9
    ds_read_b128 v[104:107], v2 offset:336
    v_fma_f32 v145, v145, s99, -v9
    buffer_load_dwordx4 a[88:91], v4, s[40:43], s63 offen offset:3072 sc1
    s_xor_b32 s63, s63, 4096
    ds_read_b128 v[108:111], v2 offset:352
    v_fma_f32 v146, v146, s99, -v9
    ds_read_b128 v[116:119], v2 offset:48
    v_fma_f32 v147, v147, s99, -v9
    s_waitcnt lgkmcnt(7)
    ds_read_b128 v[120:123], v2 offset:64
    v_exp_f32 v140, v140
    v_exp_f32 v141, v141
    v_exp_f32 v142, v142
    v_exp_f32 v143, v143
    v_exp_f32 v144, v144
    v_exp_f32 v145, v145
    v_exp_f32 v146, v146
    buffer_load_dword v3, v217, s[32:35], s19 offen sc1
    buffer_load_dwordx4 a[96:99], v4, s[40:43], s63 offen offset:0 sc1
    v_exp_f32 v147, v147
    v_add_f32 v10, v140, v141
    v_add_f32 v10, v10, v142
    v_add_f32 v10, v10, v143
    v_add_f32 v10, v10, v144
    v_add_f32 v10, v10, v145
    buffer_load_dwordx4 a[104:107], v4, s[40:43], s63 offen offset:1024 sc1
    v_add_f32 v10, v10, v146
    v_add_f32 v10, v10, v147
    v_mul_f32 v10, v10, v8
    v_rcp_f32 v10, v10
    s_nop 0
    v_mul_f32 v140, v140, v10
    v_mul_f32 v141, v141, v10
    v_mul_f32 v142, v142, v10
    buffer_load_dwordx4 a[112:115], v4, s[40:43], s63 offen offset:2048 sc1
    v_mul_f32 v143, v143, v10
    v_mul_f32 v144, v144, v10
    v_mul_f32 v145, v145, v10
    v_mul_f32 v146, v146, v10
    v_mul_f32 v147, v147, v10
    v_cvt_pk_bf16_f32 v148, 0, v140
    buffer_load_dwordx4 a[120:123], v4, s[40:43], s63 offen offset:3072 sc1
    v_cvt_pk_bf16_f32 v149, 0, v141
    v_cvt_pk_bf16_f32 v150, 0, v142
    v_cvt_pk_bf16_f32 v151, 0, v143
    v_cvt_pk_bf16_f32 v152, 0, v144
    v_cvt_pk_bf16_f32 v153, 0, v145
    v_cvt_pk_bf16_f32 v154, 0, v146
    v_cvt_pk_bf16_f32 v155, 0, v147
    s_xor_b32 s63, s63, 28672
    buffer_load_dwordx4 a[128:131], v4, s[40:43], s63 offen offset:0 sc1
    v_lshrrev_b32 v140, 16, v148
    v_lshrrev_b32 v141, 16, v149
    v_lshrrev_b32 v142, 16, v150
    v_lshrrev_b32 v143, 16, v151
    v_lshrrev_b32 v144, 16, v152
    v_lshrrev_b32 v145, 16, v153
    v_lshrrev_b32 v146, 16, v154
    buffer_load_dwordx4 a[136:139], v4, s[40:43], s63 offen offset:1024 sc1
    v_lshrrev_b32 v147, 16, v155
    v_dot2_f32_bf16 v128, v42, v140, 0
    v_dot2_f32_bf16 v129, v42, v148, 0
    v_dot2_f32_bf16 v130, v43, v140, 0
    v_dot2_f32_bf16 v131, v43, v148, 0
    v_dot2_f32_bf16 v132, v32, v140, 0
    buffer_load_dwordx4 a[144:147], v4, s[40:43], s63 offen offset:2048 sc1
    v_dot2_f32_bf16 v133, v32, v148, 0
    v_dot2_f32_bf16 v134, v33, v140, 0
    v_dot2_f32_bf16 v135, v33, v148, 0
    v_dot2_f32_bf16 v136, v34, v140, 0
    v_dot2_f32_bf16 v137, v34, v148, 0
    v_dot2_f32_bf16 v138, v35, v140, 0
    v_dot2_f32_bf16 v139, v35, v148, 0
    buffer_load_dwordx4 a[152:155], v4, s[40:43], s63 offen offset:3072 sc1
    s_xor_b32 s63, s63, 4096
    v_dot2_f32_bf16 v156, v36, v140, 0
    v_dot2_f32_bf16 v157, v36, v148, 0
    v_dot2_f32_bf16 v158, v37, v140, 0
    v_dot2_f32_bf16 v159, v37, v148, 0
    v_dot2_f32_bf16 v17, v38, v140, 0
    v_dot2_f32_bf16 v18, v38, v148, 0
    v_dot2c_f32_bf16 v128, v54, v141
    s_waitcnt vmcnt(8)
    v_cmp_gt_u32 vcc, 2, v3
    s_nop 1
    s_and_b64 vcc, vcc, exec
    s_cbranch_scc1 SPIN_CTX
BACK_CTX:
    buffer_load_dwordx4 a[4:7], v5, s[40:43], s20 offen offset:0 sc1
    v_dot2c_f32_bf16 v129, v54, v149
    v_dot2c_f32_bf16 v130, v55, v141
    v_dot2c_f32_bf16 v131, v55, v149
    v_dot2c_f32_bf16 v132, v44, v141
    v_dot2c_f32_bf16 v133, v44, v149
    v_dot2c_f32_bf16 v134, v45, v141
    v_dot2c_f32_bf16 v135, v45, v149
    v_dot2c_f32_bf16 v136, v46, v141
    v_dot2c_f32_bf16 v137, v46, v149
    v_dot2c_f32_bf16 v138, v47, v141
    v_dot2c_f32_bf16 v139, v47, v149
    v_dot2c_f32_bf16 v156, v48, v141
    v_dot2c_f32_bf16 v157, v48, v149
    buffer_load_dwordx4 a[12:15], v5, s[40:43], s20 offen offset:1024 sc1
    v_dot2c_f32_bf16 v158, v49, v141
    v_dot2c_f32_bf16 v159, v49, v149
    v_dot2c_f32_bf16 v17, v50, v141
    v_dot2c_f32_bf16 v18, v50, v149
    v_dot2c_f32_bf16 v128, v66, v142
    v_dot2c_f32_bf16 v129, v66, v150
    v_dot2c_f32_bf16 v130, v67, v142
    v_dot2c_f32_bf16 v131, v67, v150
    v_dot2c_f32_bf16 v132, v56, v142
    v_dot2c_f32_bf16 v133, v56, v150
    v_dot2c_f32_bf16 v134, v57, v142
    v_dot2c_f32_bf16 v135, v57, v150
    v_dot2c_f32_bf16 v136, v58, v142
    v_dot2c_f32_bf16 v137, v58, v150
    buffer_load_dwordx4 a[20:23], v5, s[40:43], s20 offen offset:2048 sc1
    v_dot2c_f32_bf16 v138, v59, v142
    v_dot2c_f32_bf16 v139, v59, v150
    v_dot2c_f32_bf16 v156, v60, v142
    v_dot2c_f32_bf16 v157, v60, v150
    v_dot2c_f32_bf16 v158, v61, v142
    v_dot2c_f32_bf16 v159, v61, v150
    v_dot2c_f32_bf16 v17, v62, v142
    v_dot2c_f32_bf16 v18, v62, v150
    v_dot2c_f32_bf16 v128, v78, v143
    v_dot2c_f32_bf16 v129, v78, v151
    v_dot2c_f32_bf16 v130, v79, v143
    v_dot2c_f32_bf16 v131, v79, v151
    v_dot2c_f32_bf16 v132, v68, v143
    v_dot2c_f32_bf16 v133, v68, v151
    buffer_load_dwordx4 a[28:31], v5, s[40:43], s20 offen offset:3072 sc1
    v_dot2c_f32_bf16 v134, v69, v143
    v_dot2c_f32_bf16 v135, v69, v151
    v_dot2c_f32_bf16 v136, v70, v143
    v_dot2c_f32_bf16 v137, v70, v151
    v_dot2c_f32_bf16 v138, v71, v143
    v_dot2c_f32_bf16 v139, v71, v151
    v_dot2c_f32_bf16 v156, v72, v143
    v_dot2c_f32_bf16 v157, v72, v151
    v_dot2c_f32_bf16 v158, v73, v143
    v_dot2c_f32_bf16 v159, v73, v151
    v_dot2c_f32_bf16 v17, v74, v143
    v_dot2c_f32_bf16 v18, v74, v151
    v_dot2c_f32_bf16 v128, v90, v144
    v_dot2c_f32_bf16 v129, v90, v152
    s_xor_b32 s20, s20, 4096
    buffer_load_dwordx4 a[36:39], v5, s[40:43], s20 offen offset:0 sc1
    v_dot2c_f32_bf16 v130, v91, v144
    v_dot2c_f32_bf16 v131, v91, v152
    s_waitcnt lgkmcnt(0)
    v_dot2c_f32_bf16 v132, v80, v144
    v_dot2c_f32_bf16 v133, v80, v152
    v_dot2c_f32_bf16 v134, v81, v144
    v_dot2c_f32_bf16 v135, v81, v152
    v_dot2c_f32_bf16 v136, v82, v144
    v_dot2c_f32_bf16 v137, v82, v152
    v_dot2c_f32_bf16 v138, v83, v144
    v_dot2c_f32_bf16 v139, v83, v152
    v_dot2c_f32_bf16 v156, v84, v144
    v_dot2c_f32_bf16 v157, v84, v152
    v_dot2c_f32_bf16 v158, v85, v144
    buffer_load_dwordx4 a[44:47], v5, s[40:43], s20 offen offset:1024 sc1
    v_dot2c_f32_bf16 v159, v85, v152
    v_dot2c_f32_bf16 v17, v86, v144
    v_dot2c_f32_bf16 v18, v86, v152
    v_dot2c_f32_bf16 v128, v102, v145
    v_dot2c_f32_bf16 v129, v102, v153
    v_dot2c_f32_bf16 v130, v103, v145
    v_dot2c_f32_bf16 v131, v103, v153
    v_dot2c_f32_bf16 v132, v92, v145
    v_dot2c_f32_bf16 v133, v92, v153
    v_dot2c_f32_bf16 v134, v93, v145
    v_dot2c_f32_bf16 v135, v93, v153
    v_dot2c_f32_bf16 v136, v94, v145
    v_dot2c_f32_bf16 v137, v94, v153
    v_dot2c_f32_bf16 v138, v95, v145
    buffer_load_dwordx4 a[52:55], v5, s[40:43], s20 offen offset:2048 sc1
    v_dot2c_f32_bf16 v139, v95, v153
    v_dot2c_f32_bf16 v156, v96, v145
    v_dot2c_f32_bf16 v157, v96, v153
    v_dot2c_f32_bf16 v158, v97, v145
    v_dot2c_f32_bf16 v159, v97, v153
    v_dot2c_f32_bf16 v17, v98, v145
    v_dot2c_f32_bf16 v18, v98, v153
    v_dot2c_f32_bf16 v128, v114, v146
    v_dot2c_f32_bf16 v129, v114, v154
    v_dot2c_f32_bf16 v130, v115, v146
    v_dot2c_f32_bf16 v131, v115, v154
    v_dot2c_f32_bf16 v132, v104, v146
    v_dot2c_f32_bf16 v133, v104, v154
    v_dot2c_f32_bf16 v134, v105, v146
    buffer_load_dwordx4 a[60:63], v5, s[40:43], s20 offen offset:3072 sc1
    s_xor_b32 s20, s20, 12288
    v_dot2c_f32_bf16 v135, v105, v154
    v_dot2c_f32_bf16 v136, v106, v146
    v_dot2c_f32_bf16 v137, v106, v154
    v_dot2c_f32_bf16 v138, v107, v146
    v_dot2c_f32_bf16 v139, v107, v154
    v_dot2c_f32_bf16 v156, v108, v146
    v_dot2c_f32_bf16 v157, v108, v154
    v_dot2c_f32_bf16 v158, v109, v146
    v_dot2c_f32_bf16 v159, v109, v154
    v_dot2c_f32_bf16 v17, v110, v146
    v_dot2c_f32_bf16 v18, v110, v154
    v_dot2c_f32_bf16 v128, v126, v147
    v_dot2c_f32_bf16 v129, v126, v155
    v_dot2c_f32_bf16 v130, v127, v147
    v_dot2c_f32_bf16 v131, v127, v155
    v_dot2c_f32_bf16 v132, v116, v147
    v_dot2c_f32_bf16 v133, v116, v155
    v_dot2c_f32_bf16 v134, v117, v147
    v_dot2c_f32_bf16 v135, v117, v155
    v_dot2c_f32_bf16 v136, v118, v147
    v_dot2c_f32_bf16 v137, v118, v155
    v_dot2c_f32_bf16 v138, v119, v147
    v_dot2c_f32_bf16 v139, v119, v155
    v_dot2c_f32_bf16 v156, v120, v147
    v_dot2c_f32_bf16 v157, v120, v155
    v_dot2c_f32_bf16 v158, v121, v147
    v_dot2c_f32_bf16 v159, v121, v155
    v_dot2c_f32_bf16 v17, v122, v147
    v_dot2c_f32_bf16 v18, v122, v155
    v_mov_b32 v89, 0
    v_mov_b32 v90, 0
    v_mov_b32 v91, 0
    v_cvt_pk_bf16_f32 v80, v128, v129
    v_cvt_pk_bf16_f32 v81, v130, v131
    v_cvt_pk_bf16_f32 v82, v132, v133
    v_cvt_pk_bf16_f32 v83, v134, v135
    v_cvt_pk_bf16_f32 v84, v136, v137
    v_cvt_pk_bf16_f32 v85, v138, v139
    v_cvt_pk_bf16_f32 v86, v156, v157
    v_cvt_pk_bf16_f32 v87, v158, v159
    v_cvt_pk_bf16_f32 v88, v17, v18
    v_cmp_gt_u32 vcc, 1, v28
    s_nop 1
    s_and_b64 vcc, vcc, exec
    s_cbranch_scc1 SPIN_ALL
BACK_ALL:
    s_waitcnt vmcnt(4)
    s_barrier
    ds_read_b128 v[104:107], v11 offset:0
    ds_read_b128 v[108:111], v11 offset:8192
    ds_read_b128 v[112:115], v11 offset:16384
    ds_read_b128 v[116:119], v11 offset:24576
    s_waitcnt lgkmcnt(3)
    v_mfma_f32_16x16x32_bf16 v[176:179], v[104:107], a[0:3], 0
    s_lshl3_add_u32 s98, 1, s5
    ds_read_b128 v[120:123], v11 offset:1024
    ds_read_b128 v[124:127], v11 offset:9216
    s_waitcnt lgkmcnt(4)
    v_mfma_f32_16x16x32_bf16 v[176:179], v[108:111], a[8:11], v[176:179]
    s_and_b32 s98, s98, 31
    buffer_load_dwordx4 a[68:71], v5, s[40:43], s20 offen offset:0 sc1
    s_waitcnt lgkmcnt(3)
    v_mfma_f32_16x16x32_bf16 v[176:179], v[112:115], a[16:19], v[176:179]
    s_lshl_b32 s8, s6, 5
    ds_read_b128 v[128:131], v11 offset:17408
    ds_read_b128 v[132:135], v11 offset:25600
    s_waitcnt lgkmcnt(4)
    v_mfma_f32_16x16x32_bf16 v[176:179], v[116:119], a[24:27], v[176:179]
    s_add_u32 s98, s98, s8
    ds_read_b128 v[136:139], v11 offset:2048
    v_mov_b32 v16, 0x44444444
    v_mfma_f32_16x16x32_bf16 v[180:183], v[104:107], a[4:7], 0
    s_mul_i32 s98, s98, 3
    buffer_load_dwordx4 a[76:79], v5, s[40:43], s20 offen offset:1024 sc1
    v_mfma_f32_16x16x32_bf16 v[180:183], v[108:111], a[12:15], v[180:183]
    s_sub_u32 s98, s98, 1
    ds_read_b128 v[140:143], v11 offset:10240
    ds_read_b128 v[144:147], v11 offset:18432
    v_mfma_f32_16x16x32_bf16 v[180:183], v[112:115], a[20:23], v[180:183]
    s_add_u32 s98, s98, 3
    ds_read_b128 v[148:151], v11 offset:26624
    v_mfma_f32_16x16x32_bf16 v[180:183], v[116:119], a[28:31], v[180:183]
    s_lshl2_add_u32 s98, s98, s4
    ds_read_b128 v[104:107], v11 offset:3072
    s_waitcnt lgkmcnt(5)
    v_mfma_f32_16x16x32_bf16 v[184:187], v[120:123], a[0:3], 0
    s_mul_i32 s8, s98, 3072
    buffer_load_dwordx4 a[84:87], v5, s[40:43], s20 offen offset:2048 sc1
    v_mfma_f32_16x16x32_bf16 v[184:187], v[124:127], a[8:11], v[184:187]
    s_lshl3_add_u32 s98, 2, s5
    ds_read_b128 v[108:111], v11 offset:11264
    ds_read_b128 v[112:115], v11 offset:19456
    v_mfma_f32_16x16x32_bf16 v[184:187], v[128:131], a[16:19], v[184:187]
    s_and_b32 s98, s98, 31
    ds_read_b128 v[116:119], v11 offset:27648
    v_mfma_f32_16x16x32_bf16 v[184:187], v[132:135], a[24:27], v[184:187]
    s_lshl_b32 s9, s6, 5
    v_mfma_f32_16x16x32_bf16 v[188:191], v[120:123], a[4:7], 0
    s_add_u32 s98, s98, s9
    buffer_load_dwordx4 a[92:95], v5, s[40:43], s20 offen offset:3072 sc1
    v_mfma_f32_16x16x32_bf16 v[188:191], v[124:127], a[12:15], v[188:191]
    s_xor_b32 s20, s20, 4096
    ds_read_b128 v[120:123], v11 offset:4096
    ds_read_b128 v[124:127], v11 offset:12288
    v_mfma_f32_16x16x32_bf16 v[188:191], v[128:131], a[20:23], v[188:191]
    s_mul_i32 s98, s98, 3
    ds_read_b128 v[128:131], v11 offset:20480
    v_mfma_f32_16x16x32_bf16 v[188:191], v[132:135], a[28:31], v[188:191]
    s_sub_u32 s98, s98, 2
    ds_read_b128 v[132:135], v11 offset:28672
    s_waitcnt lgkmcnt(4)
    v_mfma_f32_16x16x32_bf16 v[192:195], v[136:139], a[0:3], 0
    s_add_u32 s98, s98, 3
    buffer_store_dwordx4 v[80:83], v15, s[40:43], s71 offen offset:0 sc1
    v_mfma_f32_16x16x32_bf16 v[192:195], v[140:143], a[8:11], v[192:195]
    s_lshl2_add_u32 s98, s98, s4
    v_mfma_f32_16x16x32_bf16 v[192:195], v[144:147], a[16:19], v[192:195]
    s_mul_i32 s9, s98, 3072
    v_mfma_f32_16x16x32_bf16 v[192:195], v[148:151], a[24:27], v[192:195]
    s_lshl3_add_u32 s98, 3, s5
    v_mfma_f32_16x16x32_bf16 v[196:199], v[136:139], a[4:7], 0
    s_and_b32 s98, s98, 31
    ds_read_b128 v[136:139], v11 offset:5120
    v_mfma_f32_16x16x32_bf16 v[196:199], v[140:143], a[12:15], v[196:199]
    s_lshl_b32 s10, s6, 5
    buffer_store_dwordx4 v[84:87], v15, s[40:43], s71 offen offset:256 sc1
    v_mfma_f32_16x16x32_bf16 v[196:199], v[144:147], a[20:23], v[196:199]
    s_add_u32 s98, s98, s10
    ds_read_b128 v[140:143], v11 offset:13312
    ds_read_b128 v[144:147], v11 offset:21504
    v_mfma_f32_16x16x32_bf16 v[196:199], v[148:151], a[28:31], v[196:199]
    s_mul_i32 s98, s98, 3
    ds_read_b128 v[148:151], v11 offset:29696
    v_mfma_f32_16x16x32_bf16 v[200:203], v[104:107], a[0:3], 0
    s_sub_u32 s98, s98, 3
    v_mfma_f32_16x16x32_bf16 v[200:203], v[108:111], a[8:11], v[200:203]
    s_add_u32 s98, s98, 3
    buffer_store_dwordx4 v[88:91], v15, s[40:43], s70 offen offset:0 sc1
    v_mfma_f32_16x16x32_bf16 v[200:203], v[112:115], a[16:19], v[200:203]
    s_xor_b32 s21, s3, 3
    v_mfma_f32_16x16x32_bf16 v[200:203], v[116:119], a[24:27], v[200:203]
    s_lshl2_add_u32 s21, s21, s4
    v_mfma_f32_16x16x32_bf16 v[204:207], v[104:107], a[4:7], 0
    s_mul_i32 s21, s21, 36864
    ds_read_b128 v[104:107], v11 offset:6144
    v_mfma_f32_16x16x32_bf16 v[204:207], v[108:111], a[12:15], v[204:207]
    s_add_u32 s21, s21, s28
    s_mov_b32 m0, s47
    ds_read_b128 v[108:111], v11 offset:14336
    v_mfma_f32_16x16x32_bf16 v[204:207], v[112:115], a[20:23], v[204:207]
    s_lshl2_add_u32 s98, s98, s4
    buffer_load_dwordx4 v1, s[56:59], s21 offen sc1 lds
    v_mfma_f32_16x16x32_bf16 v[204:207], v[116:119], a[28:31], v[204:207]
    s_mul_i32 s10, s98, 3072
    ds_read_b128 v[112:115], v11 offset:22528
    ds_read_b128 v[116:119], v11 offset:30720
    s_waitcnt lgkmcnt(4)
    v_mfma_f32_16x16x32_bf16 v[208:211], v[120:123], a[0:3], 0
    s_sub_u32 s99, s4, s61
    v_mfma_f32_16x16x32_bf16 v[208:211], v[124:127], a[8:11], v[208:211]
    s_and_b32 s99, s99, 3
    buffer_load_dwordx4 v1, s[56:59], s21 offen offset:1024 sc1 lds
    v_mfma_f32_16x16x32_bf16 v[208:211], v[128:131], a[16:19], v[208:211]
    s_lshl3_add_u32 s98, s99, s5
    v_mfma_f32_16x16x32_bf16 v[208:211], v[132:135], a[24:27], v[208:211]
    s_and_b32 s98, s98, 31
    v_mfma_f32_16x16x32_bf16 v[212:215], v[120:123], a[4:7], 0
    s_lshl_b32 s11, s6, 5
    ds_read_b128 v[120:123], v12 offset:0
    v_mfma_f32_16x16x32_bf16 v[212:215], v[124:127], a[12:15], v[212:215]
    s_add_u32 s98, s98, s11
    buffer_load_dwordx4 v1, s[56:59], s21 offen offset:2048 sc1 lds
    v_mfma_f32_16x16x32_bf16 v[212:215], v[128:131], a[20:23], v[212:215]
    s_mul_i32 s98, s98, 3
    ds_read_b128 v[124:127], v12 offset:8192
    ds_read_b128 v[128:131], v12 offset:16384
    v_mfma_f32_16x16x32_bf16 v[212:215], v[132:135], a[28:31], v[212:215]
    s_sub_u32 s98, s98, s99
    ds_read_b128 v[132:135], v12 offset:24576
    v_mfma_f32_16x16x32_bf16 v[216:219], v[136:139], a[0:3], 0
    s_add_u32 s98, s98, 3
    v_mfma_f32_16x16x32_bf16 v[216:219], v[140:143], a[8:11], v[216:219]
    s_lshl2_add_u32 s98, s98, s4
    v_mfma_f32_16x16x32_bf16 v[216:219], v[144:147], a[16:19], v[216:219]
    s_mul_i32 s11, s98, 3072
    buffer_load_dwordx4 v1, s[56:59], s21 offen offset:3072 sc1 lds
    v_mfma_f32_16x16x32_bf16 v[216:219], v[148:151], a[24:27], v[216:219]
    s_waitcnt vmcnt(11)
    v_mfma_f32_16x16x32_bf16 v[220:223], v[136:139], a[4:7], 0
    s_add_u32 s21, s21, 4096
    ds_read_b128 v[136:139], v12 offset:1024
    v_mfma_f32_16x16x32_bf16 v[220:223], v[140:143], a[12:15], v[220:223]
    s_add_u32 m0, s47, 4096
    ds_read_b128 v[140:143], v12 offset:9216
    v_mfma_f32_16x16x32_bf16 v[220:223], v[144:147], a[20:23], v[220:223]
    buffer_load_dwordx4 v1, s[56:59], s21 offen sc1 lds
    v_mfma_f32_16x16x32_bf16 v[220:223], v[148:151], a[28:31], v[220:223]
    s_waitcnt lgkmcnt(2)
    ds_read_b128 v[144:147], v12 offset:17408
    ds_read_b128 v[148:151], v12 offset:25600
    v_mfma_f32_16x16x32_bf16 v[224:227], v[104:107], a[0:3], 0
    s_cmp_eq_u32 s99, 0
    s_cselect_b32 s11, 1073741824, s11
    v_mfma_f32_16x16x32_bf16 v[224:227], v[108:111], a[8:11], v[224:227]
    v_mfma_f32_16x16x32_bf16 v[224:227], v[112:115], a[16:19], v[224:227]
    buffer_load_dwordx4 v1, s[56:59], s21 offen offset:1024 sc1 lds
    v_mfma_f32_16x16x32_bf16 v[224:227], v[116:119], a[24:27], v[224:227]
    v_mfma_f32_16x16x32_bf16 v[228:231], v[104:107], a[4:7], 0
    ds_read_b128 v[104:107], v12 offset:2048
    v_mfma_f32_16x16x32_bf16 v[228:231], v[108:111], a[12:15], v[228:231]
    ds_read_b128 v[108:111], v12 offset:10240
    v_mfma_f32_16x16x32_bf16 v[228:231], v[112:115], a[20:23], v[228:231]
    buffer_load_dwordx4 v1, s[56:59], s21 offen offset:2048 sc1 lds
    v_mfma_f32_16x16x32_bf16 v[228:231], v[116:119], a[28:31], v[228:231]
    ds_read_b128 v[112:115], v12 offset:18432
    ds_read_b128 v[116:119], v12 offset:26624
    v_mfma_f32_16x16x32_bf16 v[176:179], v[120:123], a[32:35], v[176:179]
    v_mfma_f32_16x16x32_bf16 v[176:179], v[124:127], a[40:43], v[176:179]
    v_mfma_f32_16x16x32_bf16 v[176:179], v[128:131], a[48:51], v[176:179]
    buffer_load_dwordx4 a[100:103], v5, s[40:43], s20 offen offset:0 sc1
    v_mfma_f32_16x16x32_bf16 v[176:179], v[132:135], a[56:59], v[176:179]
    v_mfma_f32_16x16x32_bf16 v[180:183], v[120:123], a[36:39], v[180:183]
    ds_read_b128 v[120:123], v12 offset:3072
    v_mfma_f32_16x16x32_bf16 v[180:183], v[124:127], a[44:47], v[180:183]
    ds_read_b128 v[124:127], v12 offset:11264
    v_mfma_f32_16x16x32_bf16 v[180:183], v[128:131], a[52:55], v[180:183]
    ds_read_b128 v[128:131], v12 offset:19456
    v_mfma_f32_16x16x32_bf16 v[180:183], v[132:135], a[60:63], v[180:183]
    s_waitcnt lgkmcnt(3)
    buffer_load_dwordx4 a[108:111], v5, s[40:43], s20 offen offset:1024 sc1
    v_mfma_f32_16x16x32_bf16 v[184:187], v[136:139], a[32:35], v[184:187]
    ds_read_b128 v[132:135], v12 offset:27648
    v_mfma_f32_16x16x32_bf16 v[184:187], v[140:143], a[40:43], v[184:187]
    v_mfma_f32_16x16x32_bf16 v[184:187], v[144:147], a[48:51], v[184:187]
    v_mfma_f32_16x16x32_bf16 v[184:187], v[148:151], a[56:59], v[184:187]
    buffer_load_dwordx4 a[116:119], v5, s[40:43], s20 offen offset:2048 sc1
    v_mfma_f32_16x16x32_bf16 v[188:191], v[136:139], a[36:39], v[188:191]
    ds_read_b128 v[136:139], v12 offset:4096
    v_mfma_f32_16x16x32_bf16 v[188:191], v[140:143], a[44:47], v[188:191]
    ds_read_b128 v[140:143], v12 offset:12288
    v_mfma_f32_16x16x32_bf16 v[188:191], v[144:147], a[52:55], v[188:191]
    ds_read_b128 v[144:147], v12 offset:20480
    v_mfma_f32_16x16x32_bf16 v[188:191], v[148:151], a[60:63], v[188:191]
    buffer_load_dwordx4 a[124:127], v5, s[40:43], s20 offen offset:3072 sc1
    v_mfma_f32_16x16x32_bf16 v[192:195], v[104:107], a[32:35], v[192:195]
    s_xor_b32 s21, s3, 4
    ds_read_b128 v[148:151], v12 offset:28672
    v_mfma_f32_16x16x32_bf16 v[192:195], v[108:111], a[40:43], v[192:195]
    s_lshl2_add_u32 s21, s21, s4
    v_mfma_f32_16x16x32_bf16 v[192:195], v[112:115], a[48:51], v[192:195]
    s_mul_i32 s21, s21, 36864
    v_mfma_f32_16x16x32_bf16 v[192:195], v[116:119], a[56:59], v[192:195]
    s_add_u32 s21, s21, s28
    s_mov_b32 m0, s79
    v_mfma_f32_16x16x32_bf16 v[196:199], v[104:107], a[36:39], v[196:199]
    s_xor_b32 s20, s20, 28672
    buffer_load_dwordx4 v1, s[56:59], s21 offen sc1 lds
    v_mfma_f32_16x16x32_bf16 v[196:199], v[108:111], a[44:47], v[196:199]
    ds_read_b128 v[104:107], v12 offset:5120
    ds_read_b128 v[108:111], v12 offset:13312
    v_mfma_f32_16x16x32_bf16 v[196:199], v[112:115], a[52:55], v[196:199]
    ds_read_b128 v[112:115], v12 offset:21504
    v_mfma_f32_16x16x32_bf16 v[196:199], v[116:119], a[60:63], v[196:199]
    s_waitcnt lgkmcnt(3)
    buffer_load_dwordx4 v1, s[56:59], s21 offen offset:1024 sc1 lds
    v_mfma_f32_16x16x32_bf16 v[200:203], v[120:123], a[32:35], v[200:203]
    ds_read_b128 v[116:119], v12 offset:29696
    v_mfma_f32_16x16x32_bf16 v[200:203], v[124:127], a[40:43], v[200:203]
    v_mfma_f32_16x16x32_bf16 v[200:203], v[128:131], a[48:51], v[200:203]
    v_mfma_f32_16x16x32_bf16 v[200:203], v[132:135], a[56:59], v[200:203]
    v_mfma_f32_16x16x32_bf16 v[204:207], v[120:123], a[36:39], v[204:207]
    buffer_load_dwordx4 v1, s[56:59], s21 offen offset:2048 sc1 lds
    v_mfma_f32_16x16x32_bf16 v[204:207], v[124:127], a[44:47], v[204:207]
    ds_read_b128 v[120:123], v12 offset:6144
    ds_read_b128 v[124:127], v12 offset:14336
    v_mfma_f32_16x16x32_bf16 v[204:207], v[128:131], a[52:55], v[204:207]
    ds_read_b128 v[128:131], v12 offset:22528
    v_mfma_f32_16x16x32_bf16 v[204:207], v[132:135], a[60:63], v[204:207]
    ds_read_b128 v[132:135], v12 offset:30720
    v_mfma_f32_16x16x32_bf16 v[208:211], v[136:139], a[32:35], v[208:211]
    buffer_load_dwordx4 v1, s[56:59], s21 offen offset:3072 sc1 lds
    v_mfma_f32_16x16x32_bf16 v[208:211], v[140:143], a[40:43], v[208:211]
    s_add_u32 s21, s21, 4096
    v_mfma_f32_16x16x32_bf16 v[208:211], v[144:147], a[48:51], v[208:211]
    s_add_u32 m0, s79, 4096
    v_mfma_f32_16x16x32_bf16 v[208:211], v[148:151], a[56:59], v[208:211]
    v_mfma_f32_16x16x32_bf16 v[212:215], v[136:139], a[36:39], v[212:215]
    buffer_load_dwordx4 v1, s[56:59], s21 offen sc1 lds
    v_mfma_f32_16x16x32_bf16 v[212:215], v[140:143], a[44:47], v[212:215]
    ds_read_b128 v[136:139], v13 offset:0
    ds_read_b128 v[140:143], v13 offset:8192
    v_mfma_f32_16x16x32_bf16 v[212:215], v[144:147], a[52:55], v[212:215]
    ds_read_b128 v[144:147], v13 offset:16384
    v_mfma_f32_16x16x32_bf16 v[212:215], v[148:151], a[60:63], v[212:215]
    s_waitcnt lgkmcnt(3)
    ds_read_b128 v[148:151], v13 offset:24576
    v_mfma_f32_16x16x32_bf16 v[216:219], v[104:107], a[32:35], v[216:219]
    buffer_load_dwordx4 v1, s[56:59], s21 offen offset:1024 sc1 lds
    v_mfma_f32_16x16x32_bf16 v[216:219], v[108:111], a[40:43], v[216:219]
    v_mfma_f32_16x16x32_bf16 v[216:219], v[112:115], a[48:51], v[216:219]
    v_mfma_f32_16x16x32_bf16 v[216:219], v[116:119], a[56:59], v[216:219]
    s_waitcnt vmcnt(20)
    s_barrier
    v_mfma_f32_16x16x32_bf16 v[220:223], v[104:107], a[36:39], v[220:223]
    buffer_load_dwordx4 v1, s[56:59], s21 offen offset:2048 sc1 lds
    v_mfma_f32_16x16x32_bf16 v[220:223], v[108:111], a[44:47], v[220:223]
    ds_read_b128 v[104:107], v13 offset:1024
    ds_read_b128 v[108:111], v13 offset:9216
    v_mfma_f32_16x16x32_bf16 v[220:223], v[112:115], a[52:55], v[220:223]
    ds_read_b128 v[112:115], v13 offset:17408
    v_mfma_f32_16x16x32_bf16 v[220:223], v[116:119], a[60:63], v[220:223]
    ds_read_b128 v[116:119], v13 offset:25600
    v_mfma_f32_16x16x32_bf16 v[224:227], v[120:123], a[32:35], v[224:227]
    v_mfma_f32_16x16x32_bf16 v[224:227], v[124:127], a[40:43], v[224:227]
    buffer_load_dwordx4 a[132:135], v5, s[40:43], s20 offen offset:0 sc1
    v_mfma_f32_16x16x32_bf16 v[224:227], v[128:131], a[48:51], v[224:227]
    v_mfma_f32_16x16x32_bf16 v[224:227], v[132:135], a[56:59], v[224:227]
    v_mfma_f32_16x16x32_bf16 v[228:231], v[120:123], a[36:39], v[228:231]
    ds_read_b128 v[120:123], v13 offset:2048
    v_mfma_f32_16x16x32_bf16 v[228:231], v[124:127], a[44:47], v[228:231]
    buffer_load_dwordx4 a[140:143], v5, s[40:43], s20 offen offset:1024 sc1
    v_mfma_f32_16x16x32_bf16 v[228:231], v[128:131], a[52:55], v[228:231]
    ds_read_b128 v[124:127], v13 offset:10240
    ds_read_b128 v[128:131], v13 offset:18432
    v_mfma_f32_16x16x32_bf16 v[228:231], v[132:135], a[60:63], v[228:231]
    s_waitcnt lgkmcnt(3)
    ds_read_b128 v[132:135], v13 offset:26624
    v_mfma_f32_16x16x32_bf16 v[176:179], v[136:139], a[64:67], v[176:179]
    v_mfma_f32_16x16x32_bf16 v[176:179], v[140:143], a[72:75], v[176:179]
    buffer_load_dwordx4 a[148:151], v5, s[40:43], s20 offen offset:2048 sc1
    v_mfma_f32_16x16x32_bf16 v[176:179], v[144:147], a[80:83], v[176:179]
    v_mfma_f32_16x16x32_bf16 v[176:179], v[148:151], a[88:91], v[176:179]
    v_mfma_f32_16x16x32_bf16 v[180:183], v[136:139], a[68:71], v[180:183]
    ds_read_b128 v[136:139], v13 offset:3072
    v_mfma_f32_16x16x32_bf16 v[180:183], v[140:143], a[76:79], v[180:183]
    buffer_load_dwordx4 a[156:159], v5, s[40:43], s20 offen offset:3072 sc1
    v_mfma_f32_16x16x32_bf16 v[180:183], v[144:147], a[84:87], v[180:183]
    s_xor_b32 s21, s3, 5
    ds_read_b128 v[140:143], v13 offset:11264
    ds_read_b128 v[144:147], v13 offset:19456
    v_mfma_f32_16x16x32_bf16 v[180:183], v[148:151], a[92:95], v[180:183]
    s_lshl2_add_u32 s21, s21, s4
    ds_read_b128 v[148:151], v13 offset:27648
    v_mfma_f32_16x16x32_bf16 v[184:187], v[104:107], a[64:67], v[184:187]
    s_mul_i32 s21, s21, 36864
    v_mfma_f32_16x16x32_bf16 v[184:187], v[108:111], a[72:75], v[184:187]
    s_add_u32 s21, s21, s28
    s_mov_b32 m0, s44
    v_mfma_f32_16x16x32_bf16 v[184:187], v[112:115], a[80:83], v[184:187]
    s_xor_b32 s20, s20, 4096
    buffer_load_dwordx4 v1, s[56:59], s21 offen sc1 lds
    v_mfma_f32_16x16x32_bf16 v[184:187], v[116:119], a[88:91], v[184:187]
    v_mfma_f32_16x16x32_bf16 v[188:191], v[104:107], a[68:71], v[188:191]
    ds_read_b128 v[104:107], v13 offset:4096
    v_mfma_f32_16x16x32_bf16 v[188:191], v[108:111], a[76:79], v[188:191]
    ds_read_b128 v[108:111], v13 offset:12288
    v_mfma_f32_16x16x32_bf16 v[188:191], v[112:115], a[84:87], v[188:191]
    buffer_load_dwordx4 v1, s[56:59], s21 offen offset:1024 sc1 lds
    v_mfma_f32_16x16x32_bf16 v[188:191], v[116:119], a[92:95], v[188:191]
    s_waitcnt lgkmcnt(2)
    ds_read_b128 v[112:115], v13 offset:20480
    ds_read_b128 v[116:119], v13 offset:28672
    v_mfma_f32_16x16x32_bf16 v[192:195], v[120:123], a[64:67], v[192:195]
    v_mfma_f32_16x16x32_bf16 v[192:195], v[124:127], a[72:75], v[192:195]
    v_mfma_f32_16x16x32_bf16 v[192:195], v[128:131], a[80:83], v[192:195]
    buffer_load_dwordx4 v1, s[56:59], s21 offen offset:2048 sc1 lds
    v_mfma_f32_16x16x32_bf16 v[192:195], v[132:135], a[88:91], v[192:195]
    v_mfma_f32_16x16x32_bf16 v[196:199], v[120:123], a[68:71], v[196:199]
    ds_read_b128 v[120:123], v13 offset:5120
    v_mfma_f32_16x16x32_bf16 v[196:199], v[124:127], a[76:79], v[196:199]
    ds_read_b128 v[124:127], v13 offset:13312
    v_mfma_f32_16x16x32_bf16 v[196:199], v[128:131], a[84:87], v[196:199]
    buffer_load_dwordx4 v1, s[56:59], s21 offen offset:3072 sc1 lds
    v_mfma_f32_16x16x32_bf16 v[196:199], v[132:135], a[92:95], v[196:199]
    s_add_u32 s21, s21, 4096
    ds_read_b128 v[128:131], v13 offset:21504
    ds_read_b128 v[132:135], v13 offset:29696
    v_mfma_f32_16x16x32_bf16 v[200:203], v[136:139], a[64:67], v[200:203]
    s_add_u32 m0, s44, 4096
    v_mfma_f32_16x16x32_bf16 v[200:203], v[140:143], a[72:75], v[200:203]
    v_mfma_f32_16x16x32_bf16 v[200:203], v[144:147], a[80:83], v[200:203]
    buffer_load_dwordx4 v1, s[56:59], s21 offen sc1 lds
    v_mfma_f32_16x16x32_bf16 v[200:203], v[148:151], a[88:91], v[200:203]
    v_mfma_f32_16x16x32_bf16 v[204:207], v[136:139], a[68:71], v[204:207]
    ds_read_b128 v[136:139], v13 offset:6144
    v_mfma_f32_16x16x32_bf16 v[204:207], v[140:143], a[76:79], v[204:207]
    ds_read_b128 v[140:143], v13 offset:14336
    v_mfma_f32_16x16x32_bf16 v[204:207], v[144:147], a[84:87], v[204:207]
    buffer_load_dwordx4 v1, s[56:59], s21 offen offset:1024 sc1 lds
    v_mfma_f32_16x16x32_bf16 v[204:207], v[148:151], a[92:95], v[204:207]
    s_waitcnt lgkmcnt(2)
    ds_read_b128 v[144:147], v13 offset:22528
    ds_read_b128 v[148:151], v13 offset:30720
    v_mfma_f32_16x16x32_bf16 v[208:211], v[104:107], a[64:67], v[208:211]
    v_mfma_f32_16x16x32_bf16 v[208:211], v[108:111], a[72:75], v[208:211]
    v_mfma_f32_16x16x32_bf16 v[208:211], v[112:115], a[80:83], v[208:211]
    v_mfma_f32_16x16x32_bf16 v[208:211], v[116:119], a[88:91], v[208:211]
    buffer_load_dwordx4 v1, s[56:59], s21 offen offset:2048 sc1 lds
    v_mfma_f32_16x16x32_bf16 v[212:215], v[104:107], a[68:71], v[212:215]
    v_mfma_f32_16x16x32_bf16 v[212:215], v[108:111], a[76:79], v[212:215]
    v_mfma_f32_16x16x32_bf16 v[212:215], v[112:115], a[84:87], v[212:215]
    v_mfma_f32_16x16x32_bf16 v[212:215], v[116:119], a[92:95], v[212:215]
    buffer_load_dwordx4 a[160:163], v4, s[40:43], s63 offen offset:0 sc1
    v_mfma_f32_16x16x32_bf16 v[216:219], v[120:123], a[64:67], v[216:219]
    v_mfma_f32_16x16x32_bf16 v[216:219], v[124:127], a[72:75], v[216:219]
    v_mfma_f32_16x16x32_bf16 v[216:219], v[128:131], a[80:83], v[216:219]
    v_mfma_f32_16x16x32_bf16 v[216:219], v[132:135], a[88:91], v[216:219]
    s_waitcnt vmcnt(19)
    s_barrier
    v_mov_b32 v31, 3
    v_mfma_f32_16x16x32_bf16 v[220:223], v[120:123], a[68:71], v[220:223]
    buffer_load_dwordx4 a[168:171], v4, s[40:43], s63 offen offset:1024 sc1
    v_mfma_f32_16x16x32_bf16 v[220:223], v[124:127], a[76:79], v[220:223]
    buffer_store_dword v31, v30, s[32:35], s101 offen sc1
    v_mfma_f32_16x16x32_bf16 v[220:223], v[128:131], a[84:87], v[220:223]
    ds_read_b128 v[104:107], v6 offset:0
    ds_read_b128 v[108:111], v6 offset:8192
    v_mfma_f32_16x16x32_bf16 v[220:223], v[132:135], a[92:95], v[220:223]
    s_waitcnt lgkmcnt(2)
    ds_read_b128 v[112:115], v6 offset:16384
    v_mfma_f32_16x16x32_bf16 v[224:227], v[136:139], a[64:67], v[224:227]
    buffer_load_dwordx4 a[176:179], v4, s[40:43], s63 offen offset:2048 sc1
    v_mfma_f32_16x16x32_bf16 v[224:227], v[140:143], a[72:75], v[224:227]
    ds_read_b128 v[116:119], v6 offset:24576
    ds_read_b128 v[120:123], v6 offset:1024
    v_mfma_f32_16x16x32_bf16 v[224:227], v[144:147], a[80:83], v[224:227]
    ds_read_b128 v[124:127], v6 offset:9216
    v_mfma_f32_16x16x32_bf16 v[224:227], v[148:151], a[88:91], v[224:227]
    ds_read_b128 v[128:131], v6 offset:17408
    v_mfma_f32_16x16x32_bf16 v[228:231], v[136:139], a[68:71], v[228:231]
    buffer_load_dwordx4 a[184:187], v4, s[40:43], s63 offen offset:3072 sc1
    v_mfma_f32_16x16x32_bf16 v[228:231], v[140:143], a[76:79], v[228:231]
    s_xor_b32 s63, s63, 12288
    ds_read_b128 v[132:135], v6 offset:25600
    ds_read_b128 v[136:139], v6 offset:2048
    v_mfma_f32_16x16x32_bf16 v[228:231], v[144:147], a[84:87], v[228:231]
    ds_read_b128 v[140:143], v6 offset:10240
    v_mfma_f32_16x16x32_bf16 v[228:231], v[148:151], a[92:95], v[228:231]
    s_waitcnt lgkmcnt(4)
    ds_read_b128 v[144:147], v6 offset:18432
    v_mfma_f32_16x16x32_bf16 v[176:179], v[104:107], a[96:99], v[176:179]
    buffer_load_dwordx4 a[164:167], v5, s[40:43], s20 offen offset:0 sc1
    v_mfma_f32_16x16x32_bf16 v[176:179], v[108:111], a[104:107], v[176:179]
    ds_read_b128 v[148:151], v6 offset:26624
    v_mfma_f32_16x16x32_bf16 v[176:179], v[112:115], a[112:115], v[176:179]
    v_mfma_f32_16x16x32_bf16 v[176:179], v[116:119], a[120:123], v[176:179]
    v_mfma_f32_16x16x32_bf16 v[180:183], v[104:107], a[100:103], v[180:183]
    buffer_load_dwordx4 a[172:175], v5, s[40:43], s20 offen offset:1024 sc1
    v_mfma_f32_16x16x32_bf16 v[180:183], v[108:111], a[108:111], v[180:183]
    ds_read_b128 v[104:107], v6 offset:3072
    ds_read_b128 v[108:111], v6 offset:11264
    v_mfma_f32_16x16x32_bf16 v[180:183], v[112:115], a[116:119], v[180:183]
    ds_read_b128 v[112:115], v6 offset:19456
    v_mfma_f32_16x16x32_bf16 v[180:183], v[116:119], a[124:127], v[180:183]
    ds_read_b128 v[116:119], v6 offset:27648
    v_mfma_f32_16x16x32_bf16 v[184:187], v[120:123], a[96:99], v[184:187]
    buffer_load_dwordx4 a[180:183], v5, s[40:43], s20 offen offset:2048 sc1
    v_mfma_f32_16x16x32_bf16 v[184:187], v[124:127], a[104:107], v[184:187]
    s_waitcnt lgkmcnt(4)
    v_mfma_f32_16x16x32_bf16 v[184:187], v[128:131], a[112:115], v[184:187]
    v_mfma_f32_16x16x32_bf16 v[184:187], v[132:135], a[120:123], v[184:187]
    v_mfma_f32_16x16x32_bf16 v[188:191], v[120:123], a[100:103], v[188:191]
    buffer_load_dwordx4 a[188:191], v5, s[40:43], s20 offen offset:3072 sc1
    v_mfma_f32_16x16x32_bf16 v[188:191], v[124:127], a[108:111], v[188:191]
    s_xor_b32 s21, s3, 6
    ds_read_b128 v[120:123], v6 offset:4096
    ds_read_b128 v[124:127], v6 offset:12288
    v_mfma_f32_16x16x32_bf16 v[188:191], v[128:131], a[116:119], v[188:191]
    s_lshl2_add_u32 s21, s21, s4
    ds_read_b128 v[128:131], v6 offset:20480
    v_mfma_f32_16x16x32_bf16 v[188:191], v[132:135], a[124:127], v[188:191]
    s_mul_i32 s21, s21, 36864
    ds_read_b128 v[132:135], v6 offset:28672
    v_mfma_f32_16x16x32_bf16 v[192:195], v[136:139], a[96:99], v[192:195]
    s_add_u32 s21, s21, s28
    s_mov_b32 m0, s45
    v_mfma_f32_16x16x32_bf16 v[192:195], v[140:143], a[104:107], v[192:195]
    s_xor_b32 s20, s20, 12288
    buffer_load_dwordx4 v1, s[56:59], s21 offen sc1 lds
    v_mfma_f32_16x16x32_bf16 v[192:195], v[144:147], a[112:115], v[192:195]
    v_mfma_f32_16x16x32_bf16 v[192:195], v[148:151], a[120:123], v[192:195]
    v_mfma_f32_16x16x32_bf16 v[196:199], v[136:139], a[100:103], v[196:199]
    buffer_load_dwordx4 v1, s[56:59], s21 offen offset:1024 sc1 lds
    v_mfma_f32_16x16x32_bf16 v[196:199], v[140:143], a[108:111], v[196:199]
    ds_read_b128 v[136:139], v6 offset:5120
    ds_read_b128 v[140:143], v6 offset:13312
    v_mfma_f32_16x16x32_bf16 v[196:199], v[144:147], a[116:119], v[196:199]
    ds_read_b128 v[144:147], v6 offset:21504
    v_mfma_f32_16x16x32_bf16 v[196:199], v[148:151], a[124:127], v[196:199]
    s_waitcnt lgkmcnt(3)
    ds_read_b128 v[148:151], v6 offset:29696
    v_mfma_f32_16x16x32_bf16 v[200:203], v[104:107], a[96:99], v[200:203]
    v_mfma_f32_16x16x32_bf16 v[200:203], v[108:111], a[104:107], v[200:203]
    buffer_load_dwordx4 v1, s[56:59], s21 offen offset:2048 sc1 lds
    v_mfma_f32_16x16x32_bf16 v[200:203], v[112:115], a[112:115], v[200:203]
    v_mfma_f32_16x16x32_bf16 v[200:203], v[116:119], a[120:123], v[200:203]
    v_mfma_f32_16x16x32_bf16 v[204:207], v[104:107], a[100:103], v[204:207]
    ds_read_b128 v[104:107], v6 offset:6144
    v_mfma_f32_16x16x32_bf16 v[204:207], v[108:111], a[108:111], v[204:207]
    buffer_load_dwordx4 v1, s[56:59], s21 offen offset:3072 sc1 lds
    v_mfma_f32_16x16x32_bf16 v[204:207], v[112:115], a[116:119], v[204:207]
    s_add_u32 s21, s21, 4096
    ds_read_b128 v[108:111], v6 offset:14336
    ds_read_b128 v[112:115], v6 offset:22528
    v_mfma_f32_16x16x32_bf16 v[204:207], v[116:119], a[124:127], v[204:207]
    s_add_u32 m0, s45, 4096
    ds_read_b128 v[116:119], v6 offset:30720
    v_mfma_f32_16x16x32_bf16 v[208:211], v[120:123], a[96:99], v[208:211]
    v_mfma_f32_16x16x32_bf16 v[208:211], v[124:127], a[104:107], v[208:211]
    buffer_load_dwordx4 v1, s[56:59], s21 offen sc1 lds
    v_mfma_f32_16x16x32_bf16 v[208:211], v[128:131], a[112:115], v[208:211]
    v_mfma_f32_16x16x32_bf16 v[208:211], v[132:135], a[120:123], v[208:211]
    v_mfma_f32_16x16x32_bf16 v[212:215], v[120:123], a[100:103], v[212:215]
    v_mfma_f32_16x16x32_bf16 v[212:215], v[124:127], a[108:111], v[212:215]
    buffer_load_dwordx4 v1, s[56:59], s21 offen offset:1024 sc1 lds
    v_mfma_f32_16x16x32_bf16 v[212:215], v[128:131], a[116:119], v[212:215]
    v_mfma_f32_16x16x32_bf16 v[212:215], v[132:135], a[124:127], v[212:215]
    s_waitcnt lgkmcnt(0)
    v_mfma_f32_16x16x32_bf16 v[216:219], v[136:139], a[96:99], v[216:219]
    v_mfma_f32_16x16x32_bf16 v[216:219], v[140:143], a[104:107], v[216:219]
    buffer_load_dwordx4 v1, s[56:59], s21 offen offset:2048 sc1 lds
    v_mfma_f32_16x16x32_bf16 v[216:219], v[144:147], a[112:115], v[216:219]
    v_mfma_f32_16x16x32_bf16 v[216:219], v[148:151], a[120:123], v[216:219]
    s_waitcnt vmcnt(23)
    s_barrier
    ds_read_b128 v[120:123], v7 offset:0
    v_mfma_f32_16x16x32_bf16 v[220:223], v[136:139], a[100:103], v[220:223]
    ds_read_b128 v[124:127], v7 offset:8192
    ds_read_b128 v[128:131], v7 offset:16384
    v_mfma_f32_16x16x32_bf16 v[220:223], v[140:143], a[108:111], v[220:223]
    ds_read_b128 v[132:135], v7 offset:24576
    v_mfma_f32_16x16x32_bf16 v[220:223], v[144:147], a[116:119], v[220:223]
    buffer_load_dwordx4 a[192:195], v4, s[40:43], s63 offen offset:0 sc1
    v_mfma_f32_16x16x32_bf16 v[220:223], v[148:151], a[124:127], v[220:223]
    ds_read_b128 v[136:139], v7 offset:1024
    ds_read_b128 v[140:143], v7 offset:9216
    v_mfma_f32_16x16x32_bf16 v[224:227], v[104:107], a[96:99], v[224:227]
    ds_read_b128 v[144:147], v7 offset:17408
    v_mfma_f32_16x16x32_bf16 v[224:227], v[108:111], a[104:107], v[224:227]
    ds_read_b128 v[148:151], v7 offset:25600
    v_mfma_f32_16x16x32_bf16 v[224:227], v[112:115], a[112:115], v[224:227]
    buffer_load_dwordx4 a[200:203], v4, s[40:43], s63 offen offset:1024 sc1
    v_mfma_f32_16x16x32_bf16 v[224:227], v[116:119], a[120:123], v[224:227]
    v_mfma_f32_16x16x32_bf16 v[228:231], v[104:107], a[100:103], v[228:231]
    ds_read_b128 v[104:107], v7 offset:2048
    v_mfma_f32_16x16x32_bf16 v[228:231], v[108:111], a[108:111], v[228:231]
    ds_read_b128 v[108:111], v7 offset:10240
    v_mfma_f32_16x16x32_bf16 v[228:231], v[112:115], a[116:119], v[228:231]
    buffer_load_dwordx4 a[208:211], v4, s[40:43], s63 offen offset:2048 sc1
    v_mfma_f32_16x16x32_bf16 v[228:231], v[116:119], a[124:127], v[228:231]
    s_waitcnt lgkmcnt(2)
    ds_read_b128 v[112:115], v7 offset:18432
    ds_read_b128 v[116:119], v7 offset:26624
    v_mfma_f32_16x16x32_bf16 v[176:179], v[120:123], a[128:131], v[176:179]
    v_mfma_f32_16x16x32_bf16 v[176:179], v[124:127], a[136:139], v[176:179]
    v_mfma_f32_16x16x32_bf16 v[176:179], v[128:131], a[144:147], v[176:179]
    buffer_load_dwordx4 a[216:219], v4, s[40:43], s63 offen offset:3072 sc1
    v_mfma_f32_16x16x32_bf16 v[176:179], v[132:135], a[152:155], v[176:179]
    s_xor_b32 s63, s63, 4096
    v_mfma_f32_16x16x32_bf16 v[180:183], v[120:123], a[132:135], v[180:183]
    ds_read_b128 v[120:123], v7 offset:3072
    v_mfma_f32_16x16x32_bf16 v[180:183], v[124:127], a[140:143], v[180:183]
    ds_read_b128 v[124:127], v7 offset:11264
    v_mfma_f32_16x16x32_bf16 v[180:183], v[128:131], a[148:151], v[180:183]
    buffer_load_dwordx4 a[196:199], v5, s[40:43], s20 offen offset:0 sc1
    v_mfma_f32_16x16x32_bf16 v[180:183], v[132:135], a[156:159], v[180:183]
    ds_read_b128 v[128:131], v7 offset:19456
    ds_read_b128 v[132:135], v7 offset:27648
    v_mfma_f32_16x16x32_bf16 v[184:187], v[136:139], a[128:131], v[184:187]
    v_mfma_f32_16x16x32_bf16 v[184:187], v[140:143], a[136:139], v[184:187]
    v_mfma_f32_16x16x32_bf16 v[184:187], v[144:147], a[144:147], v[184:187]
    v_mfma_f32_16x16x32_bf16 v[184:187], v[148:151], a[152:155], v[184:187]
    buffer_load_dwordx4 a[204:207], v5, s[40:43], s20 offen offset:1024 sc1
    v_mfma_f32_16x16x32_bf16 v[188:191], v[136:139], a[132:135], v[188:191]
    ds_read_b128 v[136:139], v7 offset:4096
    v_mfma_f32_16x16x32_bf16 v[188:191], v[140:143], a[140:143], v[188:191]
    ds_read_b128 v[140:143], v7 offset:12288
    v_mfma_f32_16x16x32_bf16 v[188:191], v[144:147], a[148:151], v[188:191]
    ds_read_b128 v[144:147], v7 offset:20480
    v_mfma_f32_16x16x32_bf16 v[188:191], v[148:151], a[156:159], v[188:191]
    s_waitcnt lgkmcnt(3)
    buffer_load_dwordx4 a[212:215], v5, s[40:43], s20 offen offset:2048 sc1
    v_mfma_f32_16x16x32_bf16 v[192:195], v[104:107], a[128:131], v[192:195]
    ds_read_b128 v[148:151], v7 offset:28672
    v_mfma_f32_16x16x32_bf16 v[192:195], v[108:111], a[136:139], v[192:195]
    v_mfma_f32_16x16x32_bf16 v[192:195], v[112:115], a[144:147], v[192:195]
    v_mfma_f32_16x16x32_bf16 v[192:195], v[116:119], a[152:155], v[192:195]
    buffer_load_dwordx4 a[220:223], v5, s[40:43], s20 offen offset:3072 sc1
    v_mfma_f32_16x16x32_bf16 v[196:199], v[104:107], a[132:135], v[196:199]
    s_xor_b32 s21, s3, 7
    ds_read_b128 v[104:107], v7 offset:5120
    v_mfma_f32_16x16x32_bf16 v[196:199], v[108:111], a[140:143], v[196:199]
    s_lshl2_add_u32 s21, s21, s4
    ds_read_b128 v[108:111], v7 offset:13312
    v_mfma_f32_16x16x32_bf16 v[196:199], v[112:115], a[148:151], v[196:199]
    s_mul_i32 s21, s21, 36864
    ds_read_b128 v[112:115], v7 offset:21504
    v_mfma_f32_16x16x32_bf16 v[196:199], v[116:119], a[156:159], v[196:199]
    s_add_u32 s21, s21, s28
    s_mov_b32 m0, s46
    ds_read_b128 v[116:119], v7 offset:29696
    v_mfma_f32_16x16x32_bf16 v[200:203], v[120:123], a[128:131], v[200:203]
    s_xor_b32 s20, s20, 4096
    buffer_load_dwordx4 v1, s[56:59], s21 offen sc1 lds
    v_mfma_f32_16x16x32_bf16 v[200:203], v[124:127], a[136:139], v[200:203]
    v_mfma_f32_16x16x32_bf16 v[200:203], v[128:131], a[144:147], v[200:203]
    v_mfma_f32_16x16x32_bf16 v[200:203], v[132:135], a[152:155], v[200:203]
    buffer_load_dwordx4 v1, s[56:59], s21 offen offset:1024 sc1 lds
    v_mfma_f32_16x16x32_bf16 v[204:207], v[120:123], a[132:135], v[204:207]
    ds_read_b128 v[120:123], v7 offset:6144
    v_mfma_f32_16x16x32_bf16 v[204:207], v[124:127], a[140:143], v[204:207]
    ds_read_b128 v[124:127], v7 offset:14336
    v_mfma_f32_16x16x32_bf16 v[204:207], v[128:131], a[148:151], v[204:207]
    buffer_load_dword v3, v19, s[32:35], s66 offen sc1
    v_mfma_f32_16x16x32_bf16 v[204:207], v[132:135], a[156:159], v[204:207]
    s_waitcnt lgkmcnt(2)
    ds_read_b128 v[128:131], v7 offset:22528
    ds_read_b128 v[132:135], v7 offset:30720
    v_mfma_f32_16x16x32_bf16 v[208:211], v[136:139], a[128:131], v[208:211]
    buffer_load_dwordx4 v1, s[56:59], s21 offen offset:2048 sc1 lds
    v_mfma_f32_16x16x32_bf16 v[208:211], v[140:143], a[136:139], v[208:211]
    v_mfma_f32_16x16x32_bf16 v[208:211], v[144:147], a[144:147], v[208:211]
    v_mfma_f32_16x16x32_bf16 v[208:211], v[148:151], a[152:155], v[208:211]
    v_mfma_f32_16x16x32_bf16 v[212:215], v[136:139], a[132:135], v[212:215]
    buffer_load_dwordx4 v1, s[56:59], s21 offen offset:3072 sc1 lds
    v_mfma_f32_16x16x32_bf16 v[212:215], v[140:143], a[140:143], v[212:215]
    s_add_u32 s21, s21, 4096
    v_mfma_f32_16x16x32_bf16 v[212:215], v[144:147], a[148:151], v[212:215]
    s_add_u32 m0, s46, 4096
    v_mfma_f32_16x16x32_bf16 v[212:215], v[148:151], a[156:159], v[212:215]
    v_mfma_f32_16x16x32_bf16 v[216:219], v[104:107], a[128:131], v[216:219]
    buffer_load_dwordx4 v1, s[56:59], s21 offen sc1 lds
    v_mfma_f32_16x16x32_bf16 v[216:219], v[108:111], a[136:139], v[216:219]
    v_mfma_f32_16x16x32_bf16 v[216:219], v[112:115], a[144:147], v[216:219]
    v_mfma_f32_16x16x32_bf16 v[216:219], v[116:119], a[152:155], v[216:219]
    s_waitcnt vmcnt(21)
    s_barrier
    ds_read_b128 v[136:139], v11 offset:0
    v_mfma_f32_16x16x32_bf16 v[220:223], v[104:107], a[132:135], v[220:223]
    buffer_load_dwordx4 v1, s[56:59], s21 offen offset:1024 sc1 lds
    v_mfma_f32_16x16x32_bf16 v[220:223], v[108:111], a[140:143], v[220:223]
    ds_read_b128 v[140:143], v11 offset:8192
    ds_read_b128 v[144:147], v11 offset:16384
    v_mfma_f32_16x16x32_bf16 v[220:223], v[112:115], a[148:151], v[220:223]
    ds_read_b128 v[148:151], v11 offset:24576
    v_mfma_f32_16x16x32_bf16 v[220:223], v[116:119], a[156:159], v[220:223]
    s_waitcnt lgkmcnt(4)
    ds_read_b128 v[104:107], v11 offset:1024
    v_mfma_f32_16x16x32_bf16 v[224:227], v[120:123], a[128:131], v[224:227]
    buffer_load_dwordx4 v1, s[56:59], s21 offen offset:2048 sc1 lds
    v_mfma_f32_16x16x32_bf16 v[224:227], v[124:127], a[136:139], v[224:227]
    ds_read_b128 v[108:111], v11 offset:9216
    ds_read_b128 v[112:115], v11 offset:17408
    v_mfma_f32_16x16x32_bf16 v[224:227], v[128:131], a[144:147], v[224:227]
    ds_read_b128 v[116:119], v11 offset:25600
    v_mfma_f32_16x16x32_bf16 v[224:227], v[132:135], a[152:155], v[224:227]
    v_mfma_f32_16x16x32_bf16 v[228:231], v[120:123], a[132:135], v[228:231]
    ds_read_b128 v[120:123], v11 offset:2048
    v_mfma_f32_16x16x32_bf16 v[228:231], v[124:127], a[140:143], v[228:231]
    buffer_load_dwordx4 a[224:227], v4, s[40:43], s63 offen offset:0 sc1
    v_mfma_f32_16x16x32_bf16 v[228:231], v[128:131], a[148:151], v[228:231]
    ds_read_b128 v[124:127], v11 offset:10240
    ds_read_b128 v[128:131], v11 offset:18432
    v_mfma_f32_16x16x32_bf16 v[228:231], v[132:135], a[156:159], v[228:231]
    s_waitcnt lgkmcnt(3)
    ds_read_b128 v[132:135], v11 offset:26624
    v_mfma_f32_16x16x32_bf16 v[176:179], v[136:139], a[160:163], v[176:179]
    v_mfma_f32_16x16x32_bf16 v[176:179], v[140:143], a[168:171], v[176:179]
    buffer_load_dwordx4 a[232:235], v4, s[40:43], s63 offen offset:1024 sc1
    v_mfma_f32_16x16x32_bf16 v[176:179], v[144:147], a[176:179], v[176:179]
    v_mfma_f32_16x16x32_bf16 v[176:179], v[148:151], a[184:187], v[176:179]
    v_mfma_f32_16x16x32_bf16 v[180:183], v[136:139], a[164:167], v[180:183]
    ds_read_b128 v[136:139], v11 offset:3072
    v_mfma_f32_16x16x32_bf16 v[180:183], v[140:143], a[172:175], v[180:183]
    buffer_load_dwordx4 a[240:243], v4, s[40:43], s63 offen offset:2048 sc1
    v_mfma_f32_16x16x32_bf16 v[180:183], v[144:147], a[180:183], v[180:183]
    ds_read_b128 v[140:143], v11 offset:11264
    ds_read_b128 v[144:147], v11 offset:19456
    v_mfma_f32_16x16x32_bf16 v[180:183], v[148:151], a[188:191], v[180:183]
    ds_read_b128 v[148:151], v11 offset:27648
    v_mfma_f32_16x16x32_bf16 v[184:187], v[104:107], a[160:163], v[184:187]
    v_mfma_f32_16x16x32_bf16 v[184:187], v[108:111], a[168:171], v[184:187]
    buffer_load_dwordx4 a[248:251], v4, s[40:43], s63 offen offset:3072 sc1
    v_mfma_f32_16x16x32_bf16 v[184:187], v[112:115], a[176:179], v[184:187]
    s_sub_u32 s63, s63, 4096
    v_mfma_f32_16x16x32_bf16 v[184:187], v[116:119], a[184:187], v[184:187]
    v_mfma_f32_16x16x32_bf16 v[188:191], v[104:107], a[164:167], v[188:191]
    ds_read_b128 v[104:107], v11 offset:4096
    v_mfma_f32_16x16x32_bf16 v[188:191], v[108:111], a[172:175], v[188:191]
    buffer_load_dwordx4 a[228:231], v5, s[40:43], s20 offen offset:0 sc1
    v_mfma_f32_16x16x32_bf16 v[188:191], v[112:115], a[180:183], v[188:191]
    ds_read_b128 v[108:111], v11 offset:12288
    ds_read_b128 v[112:115], v11 offset:20480
    v_mfma_f32_16x16x32_bf16 v[188:191], v[116:119], a[188:191], v[188:191]
    s_waitcnt lgkmcnt(3)
    ds_read_b128 v[116:119], v11 offset:28672
    v_mfma_f32_16x16x32_bf16 v[192:195], v[120:123], a[160:163], v[192:195]
    v_mfma_f32_16x16x32_bf16 v[192:195], v[124:127], a[168:171], v[192:195]
    v_mfma_f32_16x16x32_bf16 v[192:195], v[128:131], a[176:179], v[192:195]
    buffer_load_dwordx4 a[236:239], v5, s[40:43], s20 offen offset:1024 sc1
    v_mfma_f32_16x16x32_bf16 v[192:195], v[132:135], a[184:187], v[192:195]
    v_mfma_f32_16x16x32_bf16 v[196:199], v[120:123], a[164:167], v[196:199]
    ds_read_b128 v[120:123], v11 offset:5120
    v_mfma_f32_16x16x32_bf16 v[196:199], v[124:127], a[172:175], v[196:199]
    ds_read_b128 v[124:127], v11 offset:13312
    v_mfma_f32_16x16x32_bf16 v[196:199], v[128:131], a[180:183], v[196:199]
    buffer_load_dwordx4 a[244:247], v5, s[40:43], s20 offen offset:2048 sc1
    v_mfma_f32_16x16x32_bf16 v[196:199], v[132:135], a[188:191], v[196:199]
    ds_read_b128 v[128:131], v11 offset:21504
    ds_read_b128 v[132:135], v11 offset:29696
    v_mfma_f32_16x16x32_bf16 v[200:203], v[136:139], a[160:163], v[200:203]
    v_mfma_f32_16x16x32_bf16 v[200:203], v[140:143], a[168:171], v[200:203]
    v_mfma_f32_16x16x32_bf16 v[200:203], v[144:147], a[176:179], v[200:203]
    buffer_load_dwordx4 a[252:255], v5, s[40:43], s20 offen offset:3072 sc1
    v_mfma_f32_16x16x32_bf16 v[200:203], v[148:151], a[184:187], v[200:203]
    s_mul_i32 s21, s61, 6
    s_add_u32 s21, s21, 132
    v_mfma_f32_16x16x32_bf16 v[204:207], v[136:139], a[164:167], v[204:207]
    s_mul_i32 s21, s21, 36864
    ds_read_b128 v[136:139], v11 offset:6144
    v_mfma_f32_16x16x32_bf16 v[204:207], v[140:143], a[172:175], v[204:207]
    s_add_u32 s21, s21, s28
    ds_read_b128 v[140:143], v11 offset:14336
    v_mfma_f32_16x16x32_bf16 v[204:207], v[144:147], a[180:183], v[204:207]
    s_add_u32 s21, s21, s67
    s_mov_b32 m0, s47
    ds_read_b128 v[144:147], v11 offset:22528
    v_mfma_f32_16x16x32_bf16 v[204:207], v[148:151], a[188:191], v[204:207]
    s_sub_u32 s20, s20, 4096
    buffer_load_dwordx4 v1, s[56:59], s21 offen sc1 lds
    s_waitcnt lgkmcnt(3)
    v_mfma_f32_16x16x32_bf16 v[208:211], v[104:107], a[160:163], v[208:211]
    ds_read_b128 v[148:151], v11 offset:30720
    v_mfma_f32_16x16x32_bf16 v[208:211], v[108:111], a[168:171], v[208:211]
    v_mfma_f32_16x16x32_bf16 v[208:211], v[112:115], a[176:179], v[208:211]
    buffer_load_dwordx4 v1, s[56:59], s21 offen offset:1024 sc1 lds
    v_mfma_f32_16x16x32_bf16 v[208:211], v[116:119], a[184:187], v[208:211]
    v_mfma_f32_16x16x32_bf16 v[212:215], v[104:107], a[164:167], v[212:215]
    v_mfma_f32_16x16x32_bf16 v[212:215], v[108:111], a[172:175], v[212:215]
    v_mfma_f32_16x16x32_bf16 v[212:215], v[112:115], a[180:183], v[212:215]
    v_mfma_f32_16x16x32_bf16 v[212:215], v[116:119], a[188:191], v[212:215]
    v_mfma_f32_16x16x32_bf16 v[216:219], v[120:123], a[160:163], v[216:219]
    v_mfma_f32_16x16x32_bf16 v[216:219], v[124:127], a[168:171], v[216:219]
    s_mul_i32 s63, s61, 6144
    v_mfma_f32_16x16x32_bf16 v[216:219], v[128:131], a[176:179], v[216:219]
    s_add_u32 s63, s63, 135168
    v_mfma_f32_16x16x32_bf16 v[216:219], v[132:135], a[184:187], v[216:219]
    s_waitcnt vmcnt(15)
    v_cmp_gt_u32 vcc, 3, v3
    s_nop 1
    s_and_b64 vcc, vcc, exec
    s_cbranch_scc1 SPIN_OA
BACK_OA:
    s_barrier
    v_mfma_f32_16x16x32_bf16 v[220:223], v[120:123], a[164:167], v[220:223]
    buffer_load_dwordx4 v[64:67], v4, s[40:43], s63 offen offset:0 sc1
    v_mfma_f32_16x16x32_bf16 v[220:223], v[124:127], a[172:175], v[220:223]
    ds_read_b128 v[104:107], v12 offset:0
    ds_read_b128 v[108:111], v12 offset:8192
    v_mfma_f32_16x16x32_bf16 v[220:223], v[128:131], a[180:183], v[220:223]
    ds_read_b128 v[112:115], v12 offset:16384
    v_mfma_f32_16x16x32_bf16 v[220:223], v[132:135], a[188:191], v[220:223]
    s_waitcnt lgkmcnt(3)
    ds_read_b128 v[116:119], v12 offset:24576
    v_mfma_f32_16x16x32_bf16 v[224:227], v[136:139], a[160:163], v[224:227]
    buffer_load_dwordx4 v[68:71], v4, s[40:43], s63 offen offset:1024 sc1
    v_mfma_f32_16x16x32_bf16 v[224:227], v[140:143], a[168:171], v[224:227]
    s_mul_i32 s20, s61, 6144
    ds_read_b128 v[120:123], v12 offset:1024
    ds_read_b128 v[124:127], v12 offset:9216
    v_mfma_f32_16x16x32_bf16 v[224:227], v[144:147], a[176:179], v[224:227]
    s_add_u32 s20, s20, 135168
    ds_read_b128 v[128:131], v12 offset:17408
    v_mfma_f32_16x16x32_bf16 v[224:227], v[148:151], a[184:187], v[224:227]
    s_sub_u32 s63, s63, 4096
    ds_read_b128 v[132:135], v12 offset:25600
    v_mfma_f32_16x16x32_bf16 v[228:231], v[136:139], a[164:167], v[228:231]
    buffer_load_dwordx4 v[72:75], v5, s[40:43], s20 offen offset:0 sc1
    v_mfma_f32_16x16x32_bf16 v[228:231], v[140:143], a[172:175], v[228:231]
    ds_read_b128 v[136:139], v12 offset:2048
    ds_read_b128 v[140:143], v12 offset:10240
    v_mfma_f32_16x16x32_bf16 v[228:231], v[144:147], a[180:183], v[228:231]
    ds_read_b128 v[144:147], v12 offset:18432
    v_mfma_f32_16x16x32_bf16 v[228:231], v[148:151], a[188:191], v[228:231]
    s_waitcnt lgkmcnt(4)
    ds_read_b128 v[148:151], v12 offset:26624
    v_mfma_f32_16x16x32_bf16 v[176:179], v[104:107], a[192:195], v[176:179]
    buffer_load_dwordx4 v[76:79], v5, s[40:43], s20 offen offset:1024 sc1
    v_mfma_f32_16x16x32_bf16 v[176:179], v[108:111], a[200:203], v[176:179]
    s_mul_i32 s21, s61, 6
    s_add_u32 s21, s4, s21
    v_mfma_f32_16x16x32_bf16 v[176:179], v[112:115], a[208:211], v[176:179]
    s_add_u32 s21, s21, 128
    v_mfma_f32_16x16x32_bf16 v[176:179], v[116:119], a[216:219], v[176:179]
    s_mul_i32 s21, s21, 36864
    v_mfma_f32_16x16x32_bf16 v[180:183], v[104:107], a[196:199], v[180:183]
    s_add_u32 s21, s21, s28
    s_mov_b32 m0, s79
    ds_read_b128 v[104:107], v12 offset:3072
    v_mfma_f32_16x16x32_bf16 v[180:183], v[108:111], a[204:207], v[180:183]
    s_sub_u32 s20, s20, 4096
    buffer_load_dwordx4 v1, s[56:59], s21 offen sc1 lds
    v_mfma_f32_16x16x32_bf16 v[180:183], v[112:115], a[212:215], v[180:183]
    ds_read_b128 v[108:111], v12 offset:11264
    ds_read_b128 v[112:115], v12 offset:19456
    v_mfma_f32_16x16x32_bf16 v[180:183], v[116:119], a[220:223], v[180:183]
    ds_read_b128 v[116:119], v12 offset:27648
    v_mfma_f32_16x16x32_bf16 v[184:187], v[120:123], a[192:195], v[184:187]
    buffer_load_dwordx4 v1, s[56:59], s21 offen offset:1024 sc1 lds
    v_mfma_f32_16x16x32_bf16 v[184:187], v[124:127], a[200:203], v[184:187]
    v_mfma_f32_16x16x32_bf16 v[184:187], v[128:131], a[208:211], v[184:187]
    s_waitcnt lgkmcnt(3)
    v_mfma_f32_16x16x32_bf16 v[184:187], v[132:135], a[216:219], v[184:187]
    v_mfma_f32_16x16x32_bf16 v[188:191], v[120:123], a[196:199], v[188:191]
    ds_read_b128 v[120:123], v12 offset:4096
    v_mfma_f32_16x16x32_bf16 v[188:191], v[124:127], a[204:207], v[188:191]
    buffer_load_dwordx4 v1, s[56:59], s21 offen offset:2048 sc1 lds
    v_mfma_f32_16x16x32_bf16 v[188:191], v[128:131], a[212:215], v[188:191]
    ds_read_b128 v[124:127], v12 offset:12288
    ds_read_b128 v[128:131], v12 offset:20480
    v_mfma_f32_16x16x32_bf16 v[188:191], v[132:135], a[220:223], v[188:191]
    ds_read_b128 v[132:135], v12 offset:28672
    v_mfma_f32_16x16x32_bf16 v[192:195], v[136:139], a[192:195], v[192:195]
    v_mfma_f32_16x16x32_bf16 v[192:195], v[140:143], a[200:203], v[192:195]
    buffer_load_dwordx4 v1, s[56:59], s21 offen offset:3072 sc1 lds
    v_mfma_f32_16x16x32_bf16 v[192:195], v[144:147], a[208:211], v[192:195]
    s_add_u32 s21, s21, 4096
    v_mfma_f32_16x16x32_bf16 v[192:195], v[148:151], a[216:219], v[192:195]
    s_add_u32 m0, s79, 4096
    v_mfma_f32_16x16x32_bf16 v[196:199], v[136:139], a[196:199], v[196:199]
    ds_read_b128 v[136:139], v12 offset:5120
    v_mfma_f32_16x16x32_bf16 v[196:199], v[140:143], a[204:207], v[196:199]
    buffer_load_dwordx4 v1, s[56:59], s21 offen sc1 lds
    v_mfma_f32_16x16x32_bf16 v[196:199], v[144:147], a[212:215], v[196:199]
    ds_read_b128 v[140:143], v12 offset:13312
    ds_read_b128 v[144:147], v12 offset:21504
    v_mfma_f32_16x16x32_bf16 v[196:199], v[148:151], a[220:223], v[196:199]
    ds_read_b128 v[148:151], v12 offset:29696
    v_mfma_f32_16x16x32_bf16 v[200:203], v[104:107], a[192:195], v[200:203]
    s_waitcnt lgkmcnt(4)
    v_mfma_f32_16x16x32_bf16 v[200:203], v[108:111], a[200:203], v[200:203]
    buffer_load_dwordx4 v1, s[56:59], s21 offen offset:1024 sc1 lds
    v_mfma_f32_16x16x32_bf16 v[200:203], v[112:115], a[208:211], v[200:203]
    v_mfma_f32_16x16x32_bf16 v[200:203], v[116:119], a[216:219], v[200:203]
    v_mfma_f32_16x16x32_bf16 v[204:207], v[104:107], a[196:199], v[204:207]
    ds_read_b128 v[104:107], v12 offset:6144
    v_mfma_f32_16x16x32_bf16 v[204:207], v[108:111], a[204:207], v[204:207]
    buffer_load_dwordx4 v1, s[56:59], s21 offen offset:2048 sc1 lds
    v_mfma_f32_16x16x32_bf16 v[204:207], v[112:115], a[212:215], v[204:207]
    ds_read_b128 v[108:111], v12 offset:14336
    ds_read_b128 v[112:115], v12 offset:22528
    v_mfma_f32_16x16x32_bf16 v[204:207], v[116:119], a[220:223], v[204:207]
    ds_read_b128 v[116:119], v12 offset:30720
    v_mfma_f32_16x16x32_bf16 v[208:211], v[120:123], a[192:195], v[208:211]
    v_mfma_f32_16x16x32_bf16 v[208:211], v[124:127], a[200:203], v[208:211]
    v_mfma_f32_16x16x32_bf16 v[208:211], v[128:131], a[208:211], v[208:211]
    buffer_load_dwordx4 v[32:35], v4, s[40:43], s63 offen offset:0 sc1
    v_mfma_f32_16x16x32_bf16 v[208:211], v[132:135], a[216:219], v[208:211]
    v_mfma_f32_16x16x32_bf16 v[212:215], v[120:123], a[196:199], v[212:215]
    v_mfma_f32_16x16x32_bf16 v[212:215], v[124:127], a[204:207], v[212:215]
    v_mfma_f32_16x16x32_bf16 v[212:215], v[128:131], a[212:215], v[212:215]
    buffer_load_dwordx4 v[40:43], v4, s[40:43], s63 offen offset:1024 sc1
    v_mfma_f32_16x16x32_bf16 v[212:215], v[132:135], a[220:223], v[212:215]
    s_waitcnt lgkmcnt(0)
    v_mfma_f32_16x16x32_bf16 v[216:219], v[136:139], a[192:195], v[216:219]
    v_mfma_f32_16x16x32_bf16 v[216:219], v[140:143], a[200:203], v[216:219]
    v_mfma_f32_16x16x32_bf16 v[216:219], v[144:147], a[208:211], v[216:219]
    s_add_u32 s23, s5, 8
    buffer_load_dwordx4 v[48:51], v4, s[40:43], s63 offen offset:2048 sc1
    v_mfma_f32_16x16x32_bf16 v[216:219], v[148:151], a[216:219], v[216:219]
    s_waitcnt vmcnt(16)
    s_barrier
    ds_read_b128 v[120:123], v13 offset:0
    v_mfma_f32_16x16x32_bf16 v[220:223], v[136:139], a[196:199], v[220:223]
    s_and_b32 s65, s5, 3
    ds_read_b128 v[124:127], v13 offset:8192
    ds_read_b128 v[128:131], v13 offset:16384
    v_mfma_f32_16x16x32_bf16 v[220:223], v[140:143], a[204:207], v[220:223]
    s_mul_i32 s70, s4, 3072
    ds_read_b128 v[132:135], v13 offset:24576
    v_lshrrev_b32 v19, 4, v1
    v_mfma_f32_16x16x32_bf16 v[220:223], v[144:147], a[212:215], v[220:223]
    s_andn2_b32 s66, s74, 0xfff
    buffer_load_dwordx4 v[56:59], v4, s[40:43], s63 offen offset:3072 sc1
    v_mfma_f32_16x16x32_bf16 v[220:223], v[148:151], a[220:223], v[220:223]
    s_sub_u32 s63, s63, 4096
    ds_read_b128 v[136:139], v13 offset:1024
    ds_read_b128 v[140:143], v13 offset:9216
    v_mfma_f32_16x16x32_bf16 v[224:227], v[104:107], a[192:195], v[224:227]
    ds_read_b128 v[144:147], v13 offset:17408
    v_min_u32 v19, 2, v19
    v_mfma_f32_16x16x32_bf16 v[224:227], v[108:111], a[200:203], v[224:227]
    ds_read_b128 v[148:151], v13 offset:25600
    v_lshl_add_u32 v19, v19, 3, s23
    v_mfma_f32_16x16x32_bf16 v[224:227], v[112:115], a[208:211], v[224:227]
    s_lshl3_add_u32 s23, s6, s62
    buffer_load_dwordx4 v[36:39], v5, s[40:43], s20 offen offset:0 sc1
    v_mfma_f32_16x16x32_bf16 v[224:227], v[116:119], a[216:219], v[224:227]
    s_lshl_b32 s23, s23, 4
    v_bfe_u32 v20, v1, 4, 4
    v_add_u32 v20, s23, v20
    v_mfma_f32_16x16x32_bf16 v[228:231], v[104:107], a[196:199], v[228:231]
    s_mul_i32 s23, s6, 294912
    ds_read_b128 v[104:107], v13 offset:2048
    v_mul_u32_u24 v20, 1152, v20
    v_mfma_f32_16x16x32_bf16 v[228:231], v[108:111], a[204:207], v[228:231]
    s_sub_u32 s23, 2211840, s23
    ds_read_b128 v[108:111], v13 offset:10240
    v_lshrrev_b32 v21, 8, v1
    v_mfma_f32_16x16x32_bf16 v[228:231], v[112:115], a[212:215], v[228:231]
    ds_read_b128 v[112:115], v13 offset:18432
    v_lshl_add_u32 v20, v21, 3, v20
    v_mfma_f32_16x16x32_bf16 v[228:231], v[116:119], a[220:223], v[228:231]
    s_waitcnt lgkmcnt(3)
    buffer_load_dwordx4 v[44:47], v5, s[40:43], s20 offen offset:1024 sc1
    v_mfma_f32_16x16x32_bf16 v[176:179], v[120:123], a[224:227], v[176:179]
    ds_read_b128 v[116:119], v13 offset:26624
    v_add_u32 v21, s23, v20
    v_mfma_f32_16x16x32_bf16 v[176:179], v[124:127], a[232:235], v[176:179]
    s_mul_i32 s23, s101, 288
    v_and_b32 v19, 31, v19
    v_mov_b32 v31, 3
    v_mfma_f32_16x16x32_bf16 v[176:179], v[128:131], a[240:243], v[176:179]
    s_add_u32 s23, s23, s70
    v_lshlrev_b32 v23, 20, v1
    v_lshlrev_b32 v19, 7, v19
    v_mfma_f32_16x16x32_bf16 v[176:179], v[132:135], a[248:251], v[176:179]
    s_add_u32 s98, s23, 0
    buffer_load_dwordx4 v[52:55], v5, s[40:43], s20 offen offset:2048 sc1
    v_mfma_f32_16x16x32_bf16 v[180:183], v[120:123], a[228:231], v[180:183]
    ds_read_b128 v[120:123], v13 offset:3072
    v_bfe_u32 v92, v1, 6, 2
    v_mfma_f32_16x16x32_bf16 v[180:183], v[124:127], a[236:239], v[180:183]
    ds_read_b128 v[124:127], v13 offset:11264
    v_lshrrev_b32 v93, 8, v1
    v_mfma_f32_16x16x32_bf16 v[180:183], v[128:131], a[244:247], v[180:183]
    ds_read_b128 v[128:131], v13 offset:19456
    v_cmp_eq_u32 vcc, v92, v93
    v_mfma_f32_16x16x32_bf16 v[180:183], v[132:135], a[252:255], v[180:183]
    buffer_load_dwordx4 v[60:63], v5, s[40:43], s20 offen offset:3072 sc1
    v_mfma_f32_16x16x32_bf16 v[184:187], v[136:139], a[224:227], v[184:187]
    s_add_u32 s21, s4, 0
    s_xor_b32 s21, s21, s3
    s_lshl_b32 s21, s21, 2
    v_mfma_f32_16x16x32_bf16 v[184:187], v[140:143], a[232:235], v[184:187]
    s_mul_i32 s21, s21, 36864
    ds_read_b128 v[132:135], v13 offset:27648
    v_and_b32 v92, 16, v1
    v_mfma_f32_16x16x32_bf16 v[184:187], v[144:147], a[240:243], v[184:187]
    s_add_u32 s21, s21, s28
    v_mov_b32 v93, 0x3f80
    v_lshlrev_b32 v92, v92, v93
    v_mfma_f32_16x16x32_bf16 v[184:187], v[148:151], a[248:251], v[184:187]
    s_add_u32 s21, s21, 7168
    s_add_u32 m0, s44, 0
    v_and_b32 v93, 32, v1
    v_mfma_f32_16x16x32_bf16 v[188:191], v[136:139], a[228:231], v[188:191]
    s_sub_u32 s20, s20, 4096
    buffer_load_dwordx4 v1, s[56:59], s21 offen sc1 lds
    v_mfma_f32_16x16x32_bf16 v[188:191], v[140:143], a[236:239], v[188:191]
    ds_read_b128 v[136:139], v13 offset:4096
    ds_read_b128 v[140:143], v13 offset:12288
    v_mfma_f32_16x16x32_bf16 v[188:191], v[144:147], a[244:247], v[188:191]
    ds_read_b128 v[144:147], v13 offset:20480
    v_cndmask_b32 v92, 0, v92, vcc
    v_mfma_f32_16x16x32_bf16 v[188:191], v[148:151], a[252:255], v[188:191]
    s_waitcnt lgkmcnt(3)
    buffer_load_dwordx4 v1, s[56:59], s21 offen offset:1024 sc1 lds
    v_mfma_f32_16x16x32_bf16 v[192:195], v[104:107], a[224:227], v[192:195]
    ds_read_b128 v[148:151], v13 offset:28672
    v_cmp_eq_u32 vcc, 0, v93
    v_mfma_f32_16x16x32_bf16 v[192:195], v[108:111], a[232:235], v[192:195]
    s_add_u32 s21, s21, 36864
    v_cndmask_b32 v96, 0, v92, vcc
    v_cndmask_b32_e64 v97, v92, 0, vcc
    v_mfma_f32_16x16x32_bf16 v[192:195], v[112:115], a[240:243], v[192:195]
    s_add_u32 m0, s44, 2048
    v_mov_b32 v98, 0
    v_mov_b32 v99, 0
    v_mfma_f32_16x16x32_bf16 v[192:195], v[116:119], a[248:251], v[192:195]
    v_mov_b32 v100, v96
    v_mov_b32 v101, v97
    v_mfma_f32_16x16x32_bf16 v[196:199], v[104:107], a[228:231], v[196:199]
    buffer_load_dwordx4 v1, s[56:59], s21 offen sc1 lds
    v_mfma_f32_16x16x32_bf16 v[196:199], v[108:111], a[236:239], v[196:199]
    ds_read_b128 v[104:107], v13 offset:5120
    ds_read_b128 v[108:111], v13 offset:13312
    v_mfma_f32_16x16x32_bf16 v[196:199], v[112:115], a[244:247], v[196:199]
    ds_read_b128 v[112:115], v13 offset:21504
    v_mfma_f32_16x16x32_bf16 v[196:199], v[116:119], a[252:255], v[196:199]
    ds_read_b128 v[116:119], v13 offset:29696
    v_mfma_f32_16x16x32_bf16 v[200:203], v[120:123], a[224:227], v[200:203]
    buffer_load_dwordx4 v1, s[56:59], s21 offen offset:1024 sc1 lds
    v_mfma_f32_16x16x32_bf16 v[200:203], v[124:127], a[232:235], v[200:203]
    s_add_u32 s21, s21, 36864
    v_mfma_f32_16x16x32_bf16 v[200:203], v[128:131], a[240:243], v[200:203]
    s_add_u32 m0, s44, 4096
    v_mfma_f32_16x16x32_bf16 v[200:203], v[132:135], a[248:251], v[200:203]
    v_mfma_f32_16x16x32_bf16 v[204:207], v[120:123], a[228:231], v[204:207]
    buffer_load_dwordx4 v1, s[56:59], s21 offen sc1 lds
    v_mfma_f32_16x16x32_bf16 v[204:207], v[124:127], a[236:239], v[204:207]
    ds_read_b128 v[120:123], v13 offset:6144
    ds_read_b128 v[124:127], v13 offset:14336
    v_mfma_f32_16x16x32_bf16 v[204:207], v[128:131], a[244:247], v[204:207]
    ds_read_b128 v[128:131], v13 offset:22528
    v_mfma_f32_16x16x32_bf16 v[204:207], v[132:135], a[252:255], v[204:207]
    s_waitcnt lgkmcnt(3)
    ds_read_b128 v[132:135], v13 offset:30720
    v_mfma_f32_16x16x32_bf16 v[208:211], v[136:139], a[224:227], v[208:211]
    buffer_load_dwordx4 v1, s[56:59], s21 offen offset:1024 sc1 lds
    v_mfma_f32_16x16x32_bf16 v[208:211], v[140:143], a[232:235], v[208:211]
    s_add_u32 s21, s21, 36864
    v_mfma_f32_16x16x32_bf16 v[208:211], v[144:147], a[240:243], v[208:211]
    s_add_u32 m0, s44, 6144
    v_mfma_f32_16x16x32_bf16 v[208:211], v[148:151], a[248:251], v[208:211]
    v_mfma_f32_16x16x32_bf16 v[212:215], v[136:139], a[228:231], v[212:215]
    buffer_load_dwordx4 v1, s[56:59], s21 offen sc1 lds
    v_mfma_f32_16x16x32_bf16 v[212:215], v[140:143], a[236:239], v[212:215]
    v_mfma_f32_16x16x32_bf16 v[212:215], v[144:147], a[244:247], v[212:215]
    v_mfma_f32_16x16x32_bf16 v[212:215], v[148:151], a[252:255], v[212:215]
    v_mfma_f32_16x16x32_bf16 v[216:219], v[104:107], a[224:227], v[216:219]
    v_mfma_f32_16x16x32_bf16 v[216:219], v[108:111], a[232:235], v[216:219]
    buffer_load_dwordx4 v1, s[56:59], s21 offen offset:1024 sc1 lds
    v_mfma_f32_16x16x32_bf16 v[216:219], v[112:115], a[240:243], v[216:219]
    s_add_u32 s21, s21, 36864
    s_add_u32 s21, s4, 4
    s_xor_b32 s21, s21, s3
    v_mfma_f32_16x16x32_bf16 v[216:219], v[116:119], a[248:251], v[216:219]
    s_lshl_b32 s21, s21, 2
    s_waitcnt vmcnt(16)
    s_barrier
    v_mfma_f32_16x16x32_bf16 v[220:223], v[104:107], a[228:231], v[220:223]
    s_mul_i32 s21, s21, 36864
    s_add_u32 s21, s21, s28
    ds_read_b128 v[136:139], v6 offset:0
    v_mfma_f32_16x16x32_bf16 v[220:223], v[108:111], a[236:239], v[220:223]
    s_add_u32 s21, s21, 7168
    s_add_u32 m0, s45, 0
    ds_read_b128 v[140:143], v6 offset:1024
    v_mfma_f32_16x16x32_bf16 v[220:223], v[112:115], a[244:247], v[220:223]
    buffer_load_dwordx4 v1, s[56:59], s21 offen sc1 lds
    v_mfma_f32_16x16x32_bf16 v[220:223], v[116:119], a[252:255], v[220:223]
    s_waitcnt lgkmcnt(2)
    ds_read_b128 v[144:147], v6 offset:8192
    ds_read_b128 v[148:151], v6 offset:9216
    v_mfma_f32_16x16x32_bf16 v[224:227], v[120:123], a[224:227], v[224:227]
    ds_read_b128 v[104:107], v6 offset:16384
    v_mfma_f32_16x16x32_bf16 v[224:227], v[124:127], a[232:235], v[224:227]
    buffer_load_dwordx4 v1, s[56:59], s21 offen offset:1024 sc1 lds
    v_mfma_f32_16x16x32_bf16 v[224:227], v[128:131], a[240:243], v[224:227]
    s_add_u32 s21, s21, 36864
    ds_read_b128 v[108:111], v6 offset:17408
    ds_read_b128 v[112:115], v6 offset:24576
    v_mfma_f32_16x16x32_bf16 v[224:227], v[132:135], a[248:251], v[224:227]
    s_add_u32 m0, s45, 2048
    ds_read_b128 v[116:119], v7 offset:0
    v_mfma_f32_16x16x32_bf16 v[228:231], v[120:123], a[228:231], v[228:231]
    ds_read_b128 v[120:123], v7 offset:8192
    v_mfma_f32_16x16x32_bf16 v[228:231], v[124:127], a[236:239], v[228:231]
    buffer_load_dwordx4 v1, s[56:59], s21 offen sc1 lds
    v_mfma_f32_16x16x32_bf16 v[228:231], v[128:131], a[244:247], v[228:231]
    ds_read_b128 v[124:127], v7 offset:16384
    ds_read_b128 v[128:131], v7 offset:24576
    v_mfma_f32_16x16x32_bf16 v[228:231], v[132:135], a[252:255], v[228:231]
    s_waitcnt lgkmcnt(4)
    ds_read_b128 v[132:135], v7 offset:1024
    v_smfmac_f32_16x16x64_bf16 v[176:179], v[136:139], v[64:71], v16
    v_smfmac_f32_16x16x64_bf16 v[180:183], v[136:139], v[72:79], v16
    buffer_load_dwordx4 v1, s[56:59], s21 offen offset:1024 sc1 lds
    v_smfmac_f32_16x16x64_bf16 v[184:187], v[140:143], v[64:71], v16
    ds_read_b128 v[136:139], v7 offset:9216
    v_smfmac_f32_16x16x64_bf16 v[188:191], v[140:143], v[72:79], v16
    s_add_u32 s21, s21, 36864
    ds_read_b128 v[140:143], v7 offset:17408
    v_smfmac_f32_16x16x64_bf16 v[192:195], v[144:147], v[64:71], v16
    s_add_u32 m0, s45, 4096
    v_smfmac_f32_16x16x64_bf16 v[196:199], v[144:147], v[72:79], v16
    ds_read_b128 v[144:147], v7 offset:25600
    v_smfmac_f32_16x16x64_bf16 v[200:203], v[148:151], v[64:71], v16
    buffer_load_dwordx4 v1, s[56:59], s21 offen sc1 lds
    v_smfmac_f32_16x16x64_bf16 v[204:207], v[148:151], v[72:79], v16
    ds_read_b128 v[148:151], v7 offset:2048
    v_smfmac_f32_16x16x64_bf16 v[208:211], v[104:107], v[64:71], v16
    v_smfmac_f32_16x16x64_bf16 v[212:215], v[104:107], v[72:79], v16
    ds_read_b128 v[104:107], v7 offset:10240
    v_smfmac_f32_16x16x64_bf16 v[216:219], v[108:111], v[64:71], v16
    buffer_load_dwordx4 v1, s[56:59], s21 offen offset:1024 sc1 lds
    v_smfmac_f32_16x16x64_bf16 v[220:223], v[108:111], v[72:79], v16
    s_add_u32 s21, s21, 36864
    ds_read_b128 v[108:111], v7 offset:18432
    v_smfmac_f32_16x16x64_bf16 v[224:227], v[112:115], v[64:71], v16
    s_waitcnt vmcnt(14)
    v_smfmac_f32_16x16x64_bf16 v[228:231], v[112:115], v[72:79], v16
    s_add_u32 m0, s45, 6144
    ds_read_b128 v[112:115], v7 offset:26624
    s_waitcnt lgkmcnt(3)
    v_mfma_f32_16x16x32_bf16 v[176:179], v[116:119], v[32:35], v[176:179]
    buffer_load_dwordx4 v1, s[56:59], s21 offen sc1 lds
    v_mfma_f32_16x16x32_bf16 v[176:179], v[120:123], v[40:43], v[176:179]
    v_mfma_f32_16x16x32_bf16 v[176:179], v[124:127], v[48:51], v[176:179]
    v_mfma_f32_16x16x32_bf16 v[176:179], v[128:131], v[56:59], v[176:179]
    v_mfma_f32_16x16x32_bf16 v[180:183], v[116:119], v[36:39], v[180:183]
    buffer_load_dwordx4 v1, s[56:59], s21 offen offset:1024 sc1 lds
    v_mfma_f32_16x16x32_bf16 v[180:183], v[120:123], v[44:47], v[180:183]
    s_add_u32 s21, s21, 36864
    ds_read_b128 v[116:119], v7 offset:3072
    ds_read_b128 v[120:123], v7 offset:11264
    v_mfma_f32_16x16x32_bf16 v[180:183], v[124:127], v[52:55], v[180:183]
    ds_read_b128 v[124:127], v7 offset:19456
    v_cvt_pk_bf16_f32 v232, v176, v177
    v_mfma_f32_16x16x32_bf16 v[180:183], v[128:131], v[60:63], v[180:183]
    v_cvt_pk_bf16_f32 v233, v178, v179
    ds_read_b128 v[128:131], v7 offset:27648
    v_mfma_f32_16x16x32_bf16 v[184:187], v[132:135], v[32:35], v[184:187]
    v_mfma_f32_16x16x32_bf16 v[184:187], v[136:139], v[40:43], v[184:187]
    v_mfma_f32_16x16x32_bf16 v[184:187], v[140:143], v[48:51], v[184:187]
    v_mfma_f32_16x16x32_bf16 v[184:187], v[144:147], v[56:59], v[184:187]
    v_mfma_f32_16x16x32_bf16 v[188:191], v[132:135], v[36:39], v[188:191]
    ds_read_b128 v[132:135], v7 offset:4096
    v_cvt_pk_bf16_f32 v234, v180, v181
    v_mfma_f32_16x16x32_bf16 v[188:191], v[136:139], v[44:47], v[188:191]
    v_cvt_pk_bf16_f32 v235, v182, v183
    ds_read_b128 v[136:139], v7 offset:12288
    v_mfma_f32_16x16x32_bf16 v[188:191], v[140:143], v[52:55], v[188:191]
    buffer_store_dwordx4 v[232:235], v1, s[48:51], s8 offen offset:0 sc1
    v_mfma_f32_16x16x32_bf16 v[188:191], v[144:147], v[60:63], v[188:191]
    v_cvt_pk_bf16_f32 v236, v184, v185
    v_cvt_pk_bf16_f32 v237, v186, v187
    v_mfma_f32_16x16x32_bf16 v[192:195], v[148:151], v[32:35], v[192:195]
    s_waitcnt lgkmcnt(2)
    ds_read_b128 v[140:143], v7 offset:20480
    ds_read_b128 v[144:147], v7 offset:28672
    v_mfma_f32_16x16x32_bf16 v[192:195], v[104:107], v[40:43], v[192:195]
    v_mfma_f32_16x16x32_bf16 v[192:195], v[108:111], v[48:51], v[192:195]
    v_mfma_f32_16x16x32_bf16 v[192:195], v[112:115], v[56:59], v[192:195]
    v_cvt_pk_bf16_f32 v238, v188, v189
    v_cvt_pk_bf16_f32 v239, v190, v191
    v_mfma_f32_16x16x32_bf16 v[196:199], v[148:151], v[36:39], v[196:199]
    buffer_store_dwordx4 v[236:239], v1, s[48:51], s8 offen offset:1024 sc1
    v_mfma_f32_16x16x32_bf16 v[196:199], v[104:107], v[44:47], v[196:199]
    ds_read_b128 v[148:151], v7 offset:5120
    ds_read_b128 v[104:107], v7 offset:13312
    v_mfma_f32_16x16x32_bf16 v[196:199], v[108:111], v[52:55], v[196:199]
    v_cvt_pk_bf16_f32 v240, v192, v193
    v_cvt_pk_bf16_f32 v241, v194, v195
    v_mfma_f32_16x16x32_bf16 v[196:199], v[112:115], v[60:63], v[196:199]
    ds_read_b128 v[108:111], v7 offset:21504
    ds_read_b128 v[112:115], v7 offset:29696
    v_mfma_f32_16x16x32_bf16 v[200:203], v[116:119], v[32:35], v[200:203]
    v_mfma_f32_16x16x32_bf16 v[200:203], v[120:123], v[40:43], v[200:203]
    v_mfma_f32_16x16x32_bf16 v[200:203], v[124:127], v[48:51], v[200:203]
    v_mfma_f32_16x16x32_bf16 v[200:203], v[128:131], v[56:59], v[200:203]
    v_mfma_f32_16x16x32_bf16 v[204:207], v[116:119], v[36:39], v[204:207]
    ds_read_b128 v[116:119], v7 offset:6144
    v_cvt_pk_bf16_f32 v242, v196, v197
    v_mfma_f32_16x16x32_bf16 v[204:207], v[120:123], v[44:47], v[204:207]
    v_cvt_pk_bf16_f32 v243, v198, v199
    ds_read_b128 v[120:123], v7 offset:14336
    v_mfma_f32_16x16x32_bf16 v[204:207], v[124:127], v[52:55], v[204:207]
    buffer_store_dwordx4 v[240:243], v1, s[48:51], s9 offen offset:0 sc1
    v_mfma_f32_16x16x32_bf16 v[204:207], v[128:131], v[60:63], v[204:207]
    s_waitcnt lgkmcnt(2)
    v_cvt_pk_bf16_f32 v244, v200, v201
    v_cvt_pk_bf16_f32 v245, v202, v203
    v_mfma_f32_16x16x32_bf16 v[208:211], v[132:135], v[32:35], v[208:211]
    ds_read_b128 v[124:127], v7 offset:22528
    ds_read_b128 v[128:131], v7 offset:30720
    v_mfma_f32_16x16x32_bf16 v[208:211], v[136:139], v[40:43], v[208:211]
    v_mfma_f32_16x16x32_bf16 v[208:211], v[140:143], v[48:51], v[208:211]
    v_mfma_f32_16x16x32_bf16 v[208:211], v[144:147], v[56:59], v[208:211]
    v_cvt_pk_bf16_f32 v246, v204, v205
    v_cvt_pk_bf16_f32 v247, v206, v207
    v_mfma_f32_16x16x32_bf16 v[212:215], v[132:135], v[36:39], v[212:215]
    buffer_store_dwordx4 v[244:247], v1, s[48:51], s9 offen offset:1024 sc1
    v_mfma_f32_16x16x32_bf16 v[212:215], v[136:139], v[44:47], v[212:215]
    v_mfma_f32_16x16x32_bf16 v[212:215], v[140:143], v[52:55], v[212:215]
    v_mfma_f32_16x16x32_bf16 v[212:215], v[144:147], v[60:63], v[212:215]
    v_mfma_f32_16x16x32_bf16 v[216:219], v[148:151], v[32:35], v[216:219]
    v_cvt_pk_bf16_f32 v232, v208, v209
    v_cvt_pk_bf16_f32 v233, v210, v211
    v_mfma_f32_16x16x32_bf16 v[216:219], v[104:107], v[40:43], v[216:219]
    v_mfma_f32_16x16x32_bf16 v[216:219], v[108:111], v[48:51], v[216:219]
    v_mfma_f32_16x16x32_bf16 v[216:219], v[112:115], v[56:59], v[216:219]
    s_waitcnt vmcnt(12)
    s_barrier
    v_cvt_pk_bf16_f32 v234, v212, v213
    v_mfma_f32_16x16x32_bf16 v[220:223], v[148:151], v[36:39], v[220:223]
    v_cvt_pk_bf16_f32 v235, v214, v215
    ds_read_b128 v[132:135], v11 offset:0
    v_mfma_f32_16x16x32_bf16 v[220:223], v[104:107], v[44:47], v[220:223]
    buffer_store_dwordx4 v[232:235], v1, s[48:51], s10 offen offset:0 sc1
    v_mfma_f32_16x16x32_bf16 v[220:223], v[108:111], v[52:55], v[220:223]
    ds_read_b128 v[136:139], v11 offset:2048
    ds_read_b128 v[140:143], v11 offset:4096
    v_mfma_f32_16x16x32_bf16 v[220:223], v[112:115], v[60:63], v[220:223]
    s_waitcnt lgkmcnt(3)
    ds_read_b128 v[144:147], v11 offset:6144
    v_cvt_pk_bf16_f32 v236, v216, v217
    v_mfma_f32_16x16x32_bf16 v[224:227], v[116:119], v[32:35], v[224:227]
    v_cvt_pk_bf16_f32 v237, v218, v219
    ds_read_b128 v[148:151], v11 offset:1024
    v_mfma_f32_16x16x32_bf16 v[224:227], v[120:123], v[40:43], v[224:227]
    ds_read_b128 v[104:107], v11 offset:3072
    v_mfma_f32_16x16x32_bf16 v[224:227], v[124:127], v[48:51], v[224:227]
    v_cvt_pk_bf16_f32 v238, v220, v221
    v_cvt_pk_bf16_f32 v239, v222, v223
    v_mfma_f32_16x16x32_bf16 v[224:227], v[128:131], v[56:59], v[224:227]
    buffer_store_dwordx4 v[236:239], v1, s[48:51], s10 offen offset:1024 sc1
    v_mfma_f32_16x16x32_bf16 v[228:231], v[116:119], v[36:39], v[228:231]
    ds_read_b128 v[108:111], v11 offset:5120
    ds_read_b128 v[112:115], v11 offset:7168
    v_mfma_f32_16x16x32_bf16 v[228:231], v[120:123], v[44:47], v[228:231]
    ds_read_b128 v[116:119], v11 offset:8192
    v_mfma_f32_16x16x32_bf16 v[228:231], v[124:127], v[52:55], v[228:231]
    ds_read_b128 v[120:123], v11 offset:10240
    v_cvt_pk_bf16_f32 v240, v224, v225
    v_mfma_f32_16x16x32_bf16 v[228:231], v[128:131], v[60:63], v[228:231]
    s_waitcnt lgkmcnt(4)
    v_cvt_pk_bf16_f32 v241, v226, v227
    ds_read_b128 v[124:127], v11 offset:12288
    v_mfma_f32_16x16x32_bf16 v[160:163], v[132:135], a[0:3], 0
    ds_read_b128 v[128:131], v11 offset:14336
    v_mfma_f32_16x16x32_bf16 v[160:163], v[136:139], a[8:11], v[160:163]
    v_mfma_f32_16x16x32_bf16 v[160:163], v[140:143], a[16:19], v[160:163]
    v_mfma_f32_16x16x32_bf16 v[160:163], v[144:147], a[24:27], v[160:163]
    v_mfma_f32_16x16x32_bf16 v[164:167], v[132:135], a[4:7], 0
    v_cvt_pk_bf16_f32 v242, v228, v229
    v_cvt_pk_bf16_f32 v243, v230, v231
    v_mfma_f32_16x16x32_bf16 v[164:167], v[136:139], a[12:15], v[164:167]
    buffer_store_dwordx4 v[240:243], v1, s[48:51], s11 offen offset:2048 sc1
    v_mfma_f32_16x16x32_bf16 v[164:167], v[140:143], a[20:23], v[164:167]
    ds_read_b128 v[132:135], v11 offset:9216
    ds_read_b128 v[136:139], v11 offset:11264
    v_mfma_f32_16x16x32_bf16 v[164:167], v[144:147], a[28:31], v[164:167]
    ds_read_b128 v[140:143], v11 offset:13312
    v_mfma_f32_16x16x32_bf16 v[168:171], v[148:151], a[0:3], 0
    ds_read_b128 v[144:147], v11 offset:15360
    v_mfma_f32_16x16x32_bf16 v[168:171], v[104:107], a[8:11], v[168:171]
    s_waitcnt lgkmcnt(4)
    v_mfma_f32_16x16x32_bf16 v[168:171], v[108:111], a[16:19], v[168:171]
    v_mfma_f32_16x16x32_bf16 v[168:171], v[112:115], a[24:27], v[168:171]
    v_mfma_f32_16x16x32_bf16 v[172:175], v[148:151], a[4:7], 0
    ds_read_b128 v[148:151], v11 offset:16384
    v_mfma_f32_16x16x32_bf16 v[172:175], v[104:107], a[12:15], v[172:175]
    ds_read_b128 v[104:107], v11 offset:18432
    v_mfma_f32_16x16x32_bf16 v[172:175], v[108:111], a[20:23], v[172:175]
    ds_read_b128 v[108:111], v11 offset:20480
    v_mfma_f32_16x16x32_bf16 v[172:175], v[112:115], a[28:31], v[172:175]
    ds_read_b128 v[112:115], v11 offset:22528
    v_mfma_f32_16x16x32_bf16 v[160:163], v[116:119], a[32:35], v[160:163]
    v_mfma_f32_16x16x32_bf16 v[160:163], v[120:123], a[40:43], v[160:163]
    v_mfma_f32_16x16x32_bf16 v[160:163], v[124:127], a[48:51], v[160:163]
    v_mfma_f32_16x16x32_bf16 v[160:163], v[128:131], a[56:59], v[160:163]
    v_mfma_f32_16x16x32_bf16 v[164:167], v[116:119], a[36:39], v[164:167]
    ds_read_b128 v[116:119], v11 offset:17408
    v_mfma_f32_16x16x32_bf16 v[164:167], v[120:123], a[44:47], v[164:167]
    ds_read_b128 v[120:123], v11 offset:19456
    v_mfma_f32_16x16x32_bf16 v[164:167], v[124:127], a[52:55], v[164:167]
    ds_read_b128 v[124:127], v11 offset:21504
    v_mfma_f32_16x16x32_bf16 v[164:167], v[128:131], a[60:63], v[164:167]
    s_waitcnt lgkmcnt(3)
    ds_read_b128 v[128:131], v11 offset:23552
    v_mfma_f32_16x16x32_bf16 v[168:171], v[132:135], a[32:35], v[168:171]
    v_mfma_f32_16x16x32_bf16 v[168:171], v[136:139], a[40:43], v[168:171]
    v_mfma_f32_16x16x32_bf16 v[168:171], v[140:143], a[48:51], v[168:171]
    v_mfma_f32_16x16x32_bf16 v[168:171], v[144:147], a[56:59], v[168:171]
    v_mfma_f32_16x16x32_bf16 v[172:175], v[132:135], a[36:39], v[172:175]
    ds_read_b128 v[132:135], v11 offset:24576
    v_mfma_f32_16x16x32_bf16 v[172:175], v[136:139], a[44:47], v[172:175]
    ds_read_b128 v[136:139], v11 offset:26624
    v_mfma_f32_16x16x32_bf16 v[172:175], v[140:143], a[52:55], v[172:175]
    ds_read_b128 v[140:143], v11 offset:28672
    v_mfma_f32_16x16x32_bf16 v[172:175], v[144:147], a[60:63], v[172:175]
    ds_read_b128 v[144:147], v11 offset:30720
    v_mfma_f32_16x16x32_bf16 v[160:163], v[148:151], a[64:67], v[160:163]
    v_mfma_f32_16x16x32_bf16 v[160:163], v[104:107], a[72:75], v[160:163]
    v_mfma_f32_16x16x32_bf16 v[160:163], v[108:111], a[80:83], v[160:163]
    v_mfma_f32_16x16x32_bf16 v[160:163], v[112:115], a[88:91], v[160:163]
    v_mfma_f32_16x16x32_bf16 v[164:167], v[148:151], a[68:71], v[164:167]
    ds_read_b128 v[148:151], v11 offset:25600
    v_mfma_f32_16x16x32_bf16 v[164:167], v[104:107], a[76:79], v[164:167]
    ds_read_b128 v[104:107], v11 offset:27648
    v_mfma_f32_16x16x32_bf16 v[164:167], v[108:111], a[84:87], v[164:167]
    ds_read_b128 v[108:111], v11 offset:29696
    v_mfma_f32_16x16x32_bf16 v[164:167], v[112:115], a[92:95], v[164:167]
    s_waitcnt lgkmcnt(3)
    ds_read_b128 v[112:115], v11 offset:31744
    v_mfma_f32_16x16x32_bf16 v[168:171], v[116:119], a[64:67], v[168:171]
    v_mfma_f32_16x16x32_bf16 v[168:171], v[120:123], a[72:75], v[168:171]
    v_mfma_f32_16x16x32_bf16 v[168:171], v[124:127], a[80:83], v[168:171]
    v_mfma_f32_16x16x32_bf16 v[168:171], v[128:131], a[88:91], v[168:171]
    v_mfma_f32_16x16x32_bf16 v[172:175], v[116:119], a[68:71], v[172:175]
    v_mfma_f32_16x16x32_bf16 v[172:175], v[120:123], a[76:79], v[172:175]
    v_mfma_f32_16x16x32_bf16 v[172:175], v[124:127], a[84:87], v[172:175]
    v_mfma_f32_16x16x32_bf16 v[172:175], v[128:131], a[92:95], v[172:175]
    v_mfma_f32_16x16x32_bf16 v[160:163], v[132:135], a[96:99], v[160:163]
    v_mfma_f32_16x16x32_bf16 v[160:163], v[136:139], a[104:107], v[160:163]
    v_mfma_f32_16x16x32_bf16 v[160:163], v[140:143], a[112:115], v[160:163]
    s_waitcnt vmcnt(0)
    buffer_store_dword v31, v23, s[32:35], s74 offen sc1
    v_mfma_f32_16x16x32_bf16 v[160:163], v[144:147], a[120:123], v[160:163]
    s_waitcnt vmcnt(8)
    s_barrier
    ds_read_b128 v[116:119], v12 offset:0
    v_mfma_f32_16x16x32_bf16 v[164:167], v[132:135], a[100:103], v[164:167]
    ds_read_b128 v[120:123], v12 offset:2048
    ds_read_b128 v[124:127], v12 offset:4096
    v_mfma_f32_16x16x32_bf16 v[164:167], v[136:139], a[108:111], v[164:167]
    ds_read_b128 v[128:131], v12 offset:6144
    v_mfma_f32_16x16x32_bf16 v[164:167], v[140:143], a[116:119], v[164:167]
    ds_read_b128 v[132:135], v12 offset:1024
    v_mfma_f32_16x16x32_bf16 v[164:167], v[144:147], a[124:127], v[164:167]
    s_mul_i32 s21, s61, 6
    s_add_u32 s21, s4, s21
    s_add_u32 s21, s21, 128
    s_waitcnt lgkmcnt(5)
    v_mfma_f32_16x16x32_bf16 v[168:171], v[148:151], a[96:99], v[168:171]
    s_mul_i32 s21, s21, 36864
    s_add_u32 s21, s21, s28
    s_add_u32 s21, s21, 7168
    v_mfma_f32_16x16x32_bf16 v[168:171], v[104:107], a[104:107], v[168:171]
    s_mov_b32 m0, s46
    ds_read_b128 v[136:139], v12 offset:3072
    ds_read_b128 v[140:143], v12 offset:5120
    v_mfma_f32_16x16x32_bf16 v[168:171], v[108:111], a[112:115], v[168:171]
    buffer_load_dwordx4 v1, s[56:59], s21 offen sc1 lds
    v_mfma_f32_16x16x32_bf16 v[168:171], v[112:115], a[120:123], v[168:171]
    ds_read_b128 v[144:147], v12 offset:7168
    v_mfma_f32_16x16x32_bf16 v[172:175], v[148:151], a[100:103], v[172:175]
    ds_read_b128 v[148:151], v12 offset:8192
    v_mfma_f32_16x16x32_bf16 v[172:175], v[104:107], a[108:111], v[172:175]
    ds_read_b128 v[104:107], v12 offset:10240
    v_mfma_f32_16x16x32_bf16 v[172:175], v[108:111], a[116:119], v[172:175]
    buffer_load_dwordx4 v1, s[56:59], s21 offen offset:1024 sc1 lds
    v_mfma_f32_16x16x32_bf16 v[172:175], v[112:115], a[124:127], v[172:175]
    s_mul_i32 s21, s61, 6
    s_add_u32 s21, s21, 132
    s_mul_i32 s21, s21, 36864
    s_waitcnt lgkmcnt(3)
    v_mfma_f32_16x16x32_bf16 v[160:163], v[116:119], a[128:131], v[160:163]
    s_add_u32 s21, s21, s28
    s_add_u32 s21, s21, 7168
    s_and_b32 s64, s68, 1024
    v_mfma_f32_16x16x32_bf16 v[160:163], v[120:123], a[136:139], v[160:163]
    s_add_u32 s21, s21, s64
    ds_read_b128 v[108:111], v12 offset:12288
    ds_read_b128 v[112:115], v12 offset:14336
    v_mfma_f32_16x16x32_bf16 v[160:163], v[124:127], a[144:147], v[160:163]
    s_add_u32 m0, s46, 2048
    s_lshl2_add_u32 s64, s61, s65
    s_lshl_b32 s65, s65, 5
    v_mfma_f32_16x16x32_bf16 v[160:163], v[128:131], a[152:155], v[160:163]
    s_add_u32 s65, s65, 1024
    buffer_load_dwordx4 v1, s[56:59], s21 offen sc1 lds
    v_mfma_f32_16x16x32_bf16 v[164:167], v[116:119], a[132:135], v[164:167]
    s_lshl_b32 s64, s64, 6
    ds_read_b128 v[116:119], v12 offset:9216
    v_mfma_f32_16x16x32_bf16 v[164:167], v[120:123], a[140:143], v[164:167]
    s_cmp_eq_u32 s4, s61
    s_cselect_b32 s65, s65, 1073741824
    s_cselect_b32 s70, s23, 1073741824
    v_mfma_f32_16x16x32_bf16 v[164:167], v[124:127], a[148:151], v[164:167]
    ds_read_b128 v[120:123], v12 offset:11264
    ds_read_b128 v[124:127], v12 offset:13312
    v_mfma_f32_16x16x32_bf16 v[164:167], v[128:131], a[156:159], v[164:167]
    ds_read_b128 v[128:131], v12 offset:15360
    v_mfma_f32_16x16x32_bf16 v[168:171], v[132:135], a[128:131], v[168:171]
    v_mfma_f32_16x16x32_bf16 v[168:171], v[136:139], a[136:139], v[168:171]
    v_mfma_f32_16x16x32_bf16 v[168:171], v[140:143], a[144:147], v[168:171]
    s_waitcnt lgkmcnt(3)
    v_mfma_f32_16x16x32_bf16 v[168:171], v[144:147], a[152:155], v[168:171]
    v_mfma_f32_16x16x32_bf16 v[172:175], v[132:135], a[132:135], v[172:175]
    ds_read_b128 v[132:135], v12 offset:16384
    v_mfma_f32_16x16x32_bf16 v[172:175], v[136:139], a[140:143], v[172:175]
    ds_read_b128 v[136:139], v12 offset:18432
    v_mfma_f32_16x16x32_bf16 v[172:175], v[140:143], a[148:151], v[172:175]
    ds_read_b128 v[140:143], v12 offset:20480
    v_mfma_f32_16x16x32_bf16 v[172:175], v[144:147], a[156:159], v[172:175]
    ds_read_b128 v[144:147], v12 offset:22528
    v_mfma_f32_16x16x32_bf16 v[160:163], v[148:151], a[160:163], v[160:163]
    v_mfma_f32_16x16x32_bf16 v[160:163], v[104:107], a[168:171], v[160:163]
    v_mfma_f32_16x16x32_bf16 v[160:163], v[108:111], a[176:179], v[160:163]
    v_mfma_f32_16x16x32_bf16 v[160:163], v[112:115], a[184:187], v[160:163]
    v_mfma_f32_16x16x32_bf16 v[164:167], v[148:151], a[164:167], v[164:167]
    ds_read_b128 v[148:151], v12 offset:17408
    v_mfma_f32_16x16x32_bf16 v[164:167], v[104:107], a[172:175], v[164:167]
    buffer_load_dword v3, v19, s[32:35], s66 offen sc1
    v_mfma_f32_16x16x32_bf16 v[164:167], v[108:111], a[180:183], v[164:167]
    ds_read_b128 v[104:107], v12 offset:19456
    ds_read_b128 v[108:111], v12 offset:21504
    v_mfma_f32_16x16x32_bf16 v[164:167], v[112:115], a[188:191], v[164:167]
    ds_read_b128 v[112:115], v12 offset:23552
    v_mfma_f32_16x16x32_bf16 v[168:171], v[116:119], a[160:163], v[168:171]
    s_waitcnt lgkmcnt(4)
    v_mfma_f32_16x16x32_bf16 v[168:171], v[120:123], a[168:171], v[168:171]
    v_mfma_f32_16x16x32_bf16 v[168:171], v[124:127], a[176:179], v[168:171]
    v_mfma_f32_16x16x32_bf16 v[168:171], v[128:131], a[184:187], v[168:171]
    v_mfma_f32_16x16x32_bf16 v[172:175], v[116:119], a[164:167], v[172:175]
    ds_read_b128 v[116:119], v12 offset:24576
    v_mfma_f32_16x16x32_bf16 v[172:175], v[120:123], a[172:175], v[172:175]
    ds_read_b128 v[120:123], v12 offset:26624
    v_mfma_f32_16x16x32_bf16 v[172:175], v[124:127], a[180:183], v[172:175]
    ds_read_b128 v[124:127], v12 offset:28672
    v_mfma_f32_16x16x32_bf16 v[172:175], v[128:131], a[188:191], v[172:175]
    ds_read_b128 v[128:131], v12 offset:30720
    v_mfma_f32_16x16x32_bf16 v[160:163], v[132:135], a[192:195], v[160:163]
    v_mfma_f32_16x16x32_bf16 v[160:163], v[136:139], a[200:203], v[160:163]
    v_mfma_f32_16x16x32_bf16 v[160:163], v[140:143], a[208:211], v[160:163]
    v_mfma_f32_16x16x32_bf16 v[160:163], v[144:147], a[216:219], v[160:163]
    v_mfma_f32_16x16x32_bf16 v[164:167], v[132:135], a[196:199], v[164:167]
    ds_read_b128 v[132:135], v12 offset:25600
    v_mfma_f32_16x16x32_bf16 v[164:167], v[136:139], a[204:207], v[164:167]
    ds_read_b128 v[136:139], v12 offset:27648
    v_mfma_f32_16x16x32_bf16 v[164:167], v[140:143], a[212:215], v[164:167]
    ds_read_b128 v[140:143], v12 offset:29696
    v_mfma_f32_16x16x32_bf16 v[164:167], v[144:147], a[220:223], v[164:167]
    s_waitcnt lgkmcnt(3)
    ds_read_b128 v[144:147], v12 offset:31744
    v_mfma_f32_16x16x32_bf16 v[168:171], v[148:151], a[192:195], v[168:171]
    v_mfma_f32_16x16x32_bf16 v[168:171], v[104:107], a[200:203], v[168:171]
    v_mfma_f32_16x16x32_bf16 v[168:171], v[108:111], a[208:211], v[168:171]
    v_mfma_f32_16x16x32_bf16 v[168:171], v[112:115], a[216:219], v[168:171]
    v_mfma_f32_16x16x32_bf16 v[172:175], v[148:151], a[196:199], v[172:175]
    v_mfma_f32_16x16x32_bf16 v[172:175], v[104:107], a[204:207], v[172:175]
    v_mfma_f32_16x16x32_bf16 v[172:175], v[108:111], a[212:215], v[172:175]
    v_mfma_f32_16x16x32_bf16 v[172:175], v[112:115], a[220:223], v[172:175]
    v_mfma_f32_16x16x32_bf16 v[160:163], v[116:119], a[224:227], v[160:163]
    s_waitcnt vmcnt(0)
    v_cmp_gt_u32 vcc, 3, v3
    s_nop 1
    s_and_b64 vcc, vcc, exec
    s_cbranch_scc1 SPIN_X
BACK_X:
    v_mfma_f32_16x16x32_bf16 v[160:163], v[120:123], a[232:235], v[160:163]
    buffer_load_dwordx4 v[176:179], v1, s[48:51], s98 offen offset:0 sc1
    v_mfma_f32_16x16x32_bf16 v[160:163], v[124:127], a[240:243], v[160:163]
    s_add_u32 s98, s23, 12288
    buffer_load_dwordx4 v[180:183], v1, s[48:51], s98 offen offset:0 sc1
    v_mfma_f32_16x16x32_bf16 v[160:163], v[128:131], a[248:251], v[160:163]
    s_waitcnt vmcnt(3)
    s_barrier
    ds_read_b128 v[148:151], v13 offset:2048
    v_mfma_f32_16x16x32_bf16 v[164:167], v[116:119], a[228:231], v[164:167]
    s_add_u32 s98, s23, 24576
    ds_read_b128 v[104:107], v13 offset:1024
    ds_read_b128 v[108:111], v13 offset:9216
    v_mfma_f32_16x16x32_bf16 v[164:167], v[120:123], a[236:239], v[164:167]
    buffer_load_dwordx4 v[184:187], v1, s[48:51], s98 offen offset:0 sc1
    v_mfma_f32_16x16x32_bf16 v[164:167], v[124:127], a[244:247], v[164:167]
    s_add_u32 s98, s23, 0
    ds_read_b128 v[112:115], v13 offset:17408
    ds_read_b128 v[116:119], v13 offset:25600
    v_mfma_f32_16x16x32_bf16 v[164:167], v[128:131], a[252:255], v[164:167]
    s_waitcnt lgkmcnt(5)
    ds_read_b128 v[120:123], v13 offset:0
    v_mfma_f32_16x16x32_bf16 v[168:171], v[132:135], a[224:227], v[168:171]
    ds_read_b128 v[124:127], v13 offset:8192
    v_mfma_f32_16x16x32_bf16 v[168:171], v[136:139], a[232:235], v[168:171]
    buffer_load_dwordx4 v[188:191], v1, s[48:51], s98 offen offset:1024 sc1
    v_mfma_f32_16x16x32_bf16 v[168:171], v[140:143], a[240:243], v[168:171]
    s_add_u32 s98, s23, 12288
    ds_read_b128 v[128:131], v13 offset:16384
    v_mfma_f32_16x16x32_bf16 v[168:171], v[144:147], a[248:251], v[168:171]
    v_mfma_f32_16x16x32_bf16 v[172:175], v[132:135], a[228:231], v[172:175]
    ds_read_b128 v[132:135], v13 offset:24576
    v_mfma_f32_16x16x32_bf16 v[172:175], v[136:139], a[236:239], v[172:175]
    buffer_load_dwordx4 v[192:195], v1, s[48:51], s98 offen offset:1024 sc1
    v_mfma_f32_16x16x32_bf16 v[172:175], v[140:143], a[244:247], v[172:175]
    s_add_u32 s98, s23, 24576
    ds_read_b128 v[136:139], v13 offset:10240
    v_mfma_f32_16x16x32_bf16 v[172:175], v[144:147], a[252:255], v[172:175]
    s_waitcnt lgkmcnt(2)
    v_smfmac_f32_16x16x64_bf16 v[160:163], v[148:151], v[64:71], v16
    v_smfmac_f32_16x16x64_bf16 v[164:167], v[148:151], v[72:79], v16
    buffer_load_dwordx4 v[196:199], v1, s[48:51], s98 offen offset:1024 sc1
    v_mfma_f32_16x16x32_bf16 v[168:171], v[104:107], v[32:35], v[168:171]
    s_add_u32 s98, s70, 0
    v_mfma_f32_16x16x32_bf16 v[168:171], v[108:111], v[40:43], v[168:171]
    v_mfma_f32_16x16x32_bf16 v[168:171], v[112:115], v[48:51], v[168:171]
    v_mfma_f32_16x16x32_bf16 v[168:171], v[116:119], v[56:59], v[168:171]
    buffer_load_dwordx4 v[200:203], v1, s[48:51], s98 offen offset:2048 sc1
    v_mfma_f32_16x16x32_bf16 v[172:175], v[104:107], v[36:39], v[172:175]
    s_add_u32 s98, s70, 12288
    v_mfma_f32_16x16x32_bf16 v[172:175], v[108:111], v[44:47], v[172:175]
    v_mfma_f32_16x16x32_bf16 v[172:175], v[112:115], v[52:55], v[172:175]
    v_mfma_f32_16x16x32_bf16 v[172:175], v[116:119], v[60:63], v[172:175]
    buffer_load_dwordx4 v[204:207], v1, s[48:51], s98 offen offset:2048 sc1
    v_mfma_f32_16x16x32_bf16 v[160:163], v[120:123], v[32:35], v[160:163]
    s_add_u32 s98, s70, 24576
    v_mfma_f32_16x16x32_bf16 v[160:163], v[124:127], v[40:43], v[160:163]
    v_mfma_f32_16x16x32_bf16 v[160:163], v[128:131], v[48:51], v[160:163]
    s_waitcnt lgkmcnt(0)
    v_mfma_f32_16x16x32_bf16 v[160:163], v[132:135], v[56:59], v[160:163]
    buffer_load_dwordx4 v[208:211], v1, s[48:51], s98 offen offset:2048 sc1
    v_mfma_f32_16x16x32_bf16 v[164:167], v[120:123], v[36:39], v[164:167]
    v_mfma_f32_16x16x32_bf16 v[164:167], v[124:127], v[44:47], v[164:167]
    v_mfma_f32_16x16x32_bf16 v[164:167], v[128:131], v[52:55], v[164:167]
    v_mfma_f32_16x16x32_bf16 v[164:167], v[132:135], v[60:63], v[164:167]
    v_smfmac_f32_16x16x64_bf16 v[168:171], v[136:139], v[64:71], v16
    v_smfmac_f32_16x16x64_bf16 v[172:175], v[136:139], v[72:79], v16
    s_waitcnt vmcnt(6)
    v_mfma_f32_16x16x32_bf16 v[160:163], v[96:99], v[176:179], v[160:163]
    v_mfma_f32_16x16x32_bf16 v[160:163], v[96:99], v[180:183], v[160:163]
    v_mfma_f32_16x16x32_bf16 v[160:163], v[96:99], v[184:187], v[160:163]
    v_mfma_f32_16x16x32_bf16 v[164:167], v[98:101], v[176:179], v[164:167]
    v_mfma_f32_16x16x32_bf16 v[164:167], v[98:101], v[180:183], v[164:167]
    v_mfma_f32_16x16x32_bf16 v[164:167], v[98:101], v[184:187], v[164:167]
    s_waitcnt vmcnt(3)
    s_nop 0
    v_mfma_f32_16x16x32_bf16 v[168:171], v[96:99], v[188:191], v[168:171]
    v_mfma_f32_16x16x32_bf16 v[168:171], v[96:99], v[192:195], v[168:171]
    v_mfma_f32_16x16x32_bf16 v[168:171], v[96:99], v[196:199], v[168:171]
    v_mfma_f32_16x16x32_bf16 v[172:175], v[98:101], v[188:191], v[172:175]
    v_mfma_f32_16x16x32_bf16 v[172:175], v[98:101], v[192:195], v[172:175]
    v_mfma_f32_16x16x32_bf16 v[172:175], v[98:101], v[196:199], v[172:175]
    v_cvt_pk_bf16_f32 v160, v160, v161
    v_cvt_pk_bf16_f32 v161, v162, v163
    buffer_store_dwordx2 v[160:161], v20, s[24:27], s64 offen
    v_cvt_pk_bf16_f32 v164, v164, v165
    v_cvt_pk_bf16_f32 v165, v166, v167
    buffer_store_dwordx2 v[164:165], v21, s[24:27], s64 offen
    s_cmp_lg_u32 s4, s61
    s_cbranch_scc1 K1_X2
    s_waitcnt vmcnt(2)
    v_mfma_f32_16x16x32_bf16 v[224:227], v[96:99], v[200:203], v[224:227]
    v_mfma_f32_16x16x32_bf16 v[224:227], v[96:99], v[204:207], v[224:227]
    v_mfma_f32_16x16x32_bf16 v[224:227], v[96:99], v[208:211], v[224:227]
    v_mfma_f32_16x16x32_bf16 v[228:231], v[98:101], v[200:203], v[228:231]
    v_mfma_f32_16x16x32_bf16 v[228:231], v[98:101], v[204:207], v[228:231]
    v_mfma_f32_16x16x32_bf16 v[228:231], v[98:101], v[208:211], v[228:231]
    s_nop 4
    v_cvt_pk_bf16_f32 v224, v224, v225
    v_cvt_pk_bf16_f32 v225, v226, v227
    buffer_store_dwordx2 v[224:225], v20, s[24:27], s65 offen
    v_cvt_pk_bf16_f32 v228, v228, v229
    v_cvt_pk_bf16_f32 v229, v230, v231
    buffer_store_dwordx2 v[228:229], v21, s[24:27], s65 offen
K1_X2:
    v_cvt_pk_bf16_f32 v168, v168, v169
    v_cvt_pk_bf16_f32 v169, v170, v171
    buffer_store_dwordx2 v[168:169], v20, s[24:27], s64 offen offset:32
    v_cvt_pk_bf16_f32 v172, v172, v173
    v_cvt_pk_bf16_f32 v173, v174, v175
    buffer_store_dwordx2 v[172:173], v21, s[24:27], s64 offen offset:32
K1_END:
    s_endpgm
K1_LB_MASK:
    v_add_f32 v212, s12, v144
    v_fma_f32 v176, v208, s8, v212
    v_fma_f32 v177, v209, s8, v212
    v_fma_f32 v178, v210, s8, v212
    v_fma_f32 v179, v211, s8, v212
    v_add_f32 v213, s13, v144
    v_fma_f32 v180, v208, s9, v213
    v_fma_f32 v181, v209, s9, v213
    v_fma_f32 v182, v210, s9, v213
    v_fma_f32 v183, v211, s9, v213
    v_add_f32 v212, s14, v144
    v_fma_f32 v184, v208, s10, v212
    v_fma_f32 v185, v209, s10, v212
    v_fma_f32 v186, v210, s10, v212
    v_fma_f32 v187, v211, s10, v212
    v_add_f32 v213, s15, v144
    v_fma_f32 v188, v208, s11, v213
    v_fma_f32 v189, v209, s11, v213
    v_fma_f32 v190, v210, s11, v213
    v_fma_f32 v191, v211, s11, v213
    buffer_load_dword v3, v29, s[32:35], s92 offen sc1
    buffer_load_dword v28, off, s[32:35], s86 sc1
    s_branch K1_LB_BACK
K1_LS_MASK:
    s_cmp_eq_u32 s78, 1
    s_cbranch_scc1 K1_LS_LAST
    buffer_load_dword v3, v29, s[32:35], s92 offen sc1
    buffer_load_dword v28, off, s[32:35], s86 sc1
    v_mov_b32 v218, 1
    s_cmp_eq_u64 s[84:85], 0
    s_cselect_b32 s7, s74, 1073741824
    s_cmp_lg_u32 s83, 0
    s_cselect_b32 s7, s74, s7
    s_waitcnt vmcnt(10)
    buffer_store_dword v218, v216, s[32:35], s7 offen sc1
    s_branch K1_LS_BACK
K1_LS_LAST:
    v_add_f32 v212, s12, v152
    v_fma_f32 v176, v208, s8, v212
    v_fma_f32 v177, v209, s8, v212
    v_fma_f32 v178, v210, s8, v212
    v_fma_f32 v179, v211, s8, v212
    v_add_f32 v213, s13, v152
    v_fma_f32 v180, v208, s9, v213
    v_fma_f32 v181, v209, s9, v213
    v_fma_f32 v182, v210, s9, v213
    v_fma_f32 v183, v211, s9, v213
    v_add_f32 v212, s14, v152
    v_fma_f32 v184, v208, s10, v212
    v_fma_f32 v185, v209, s10, v212
    v_fma_f32 v186, v210, s10, v212
    v_fma_f32 v187, v211, s10, v212
    v_add_f32 v213, s15, v152
    v_fma_f32 v188, v208, s11, v213
    v_fma_f32 v189, v209, s11, v213
    v_fma_f32 v190, v210, s11, v213
    v_fma_f32 v191, v211, s11, v213
    v_cmp_gt_u32 vcc, 2, v28
    s_nop 1
    s_and_b64 vcc, vcc, exec
    s_cbranch_scc1 SPIN_W0H
BACK_W0H:
    s_lshl4_add_u32 s7, s73, s87
    buffer_load_dwordx4 a[128:131], v1, s[40:43], s7 offen sc1
    buffer_load_dwordx4 a[132:135], v1, s[40:43], s87 offen offset:1024 sc1
    v_cmp_gt_u32 vcc, 1, v3
    s_nop 1
    s_cmp_lg_u32 vcc_lo, 0
    s_cbranch_scc1 SPIN_W0
BACK_W0:
    s_mov_b64 s[36:37], s[56:57]
    s_mov_b32 s38, 5603328
    s_xor_b32 s77, s3, 0
    s_lshl2_add_u32 s77, s77, s4
    s_mul_i32 s77, s77, 36864
    s_add_u32 s77, s77, s28
    s_branch K1_LS_BACK
K1_WMASK:
    v_mov_b32 v9, 0xf149f2ca
    v_cmp_le_u32 vcc, 2, v14
    s_nop 1
    v_cndmask_b32 v141, v9, v141, vcc
    v_cmp_le_u32 vcc, 4, v14
    s_nop 1
    v_cndmask_b32 v142, v9, v142, vcc
    v_cmp_le_u32 vcc, 6, v14
    s_nop 1
    v_cndmask_b32 v143, v9, v143, vcc
    v_cmp_le_u32 vcc, 8, v14
    s_nop 1
    v_cndmask_b32 v144, v9, v144, vcc
    v_cmp_le_u32 vcc, 10, v14
    s_nop 1
    v_cndmask_b32 v145, v9, v145, vcc
    v_cmp_le_u32 vcc, 12, v14
    s_nop 1
    v_cndmask_b32 v146, v9, v146, vcc
    v_cmp_le_u32 vcc, 14, v14
    s_nop 1
    v_cndmask_b32 v147, v9, v147, vcc
    s_branch K1_WMASK_BACK
K1_S7:
    v_mov_b32 v218, 1
    s_cmp_eq_u64 s[84:85], 0
    s_cselect_b32 s7, s74, 1073741824
    s_cmp_lg_u32 s83, 0
    s_cselect_b32 s7, s74, s7
    s_waitcnt vmcnt(8)
    buffer_store_dword v218, v216, s[32:35], s7 offen sc1
    s_branch K1_S7_BACK
K1_J7:
    v_cmp_gt_u32 vcc, 2, v28
    s_nop 1
    s_and_b64 vcc, vcc, exec
    s_cbranch_scc1 SPIN_W7H
BACK_W7H:
    s_lshl4_add_u32 s7, s73, s87
    buffer_load_dwordx4 a[128:131], v1, s[40:43], s7 offen sc1
    buffer_load_dwordx4 a[132:135], v1, s[40:43], s87 offen offset:1024 sc1
    v_cmp_gt_u32 vcc, 1, v3
    s_nop 1
    s_cmp_lg_u32 vcc_lo, 0
    s_cbranch_scc1 SPIN_W7
BACK_W7:
    s_mov_b64 s[36:37], s[56:57]
    s_mov_b32 s38, 5603328
    s_xor_b32 s77, s3, 0
    s_lshl2_add_u32 s77, s77, s4
    s_mul_i32 s77, s77, 36864
    s_add_u32 s77, s77, s28
    s_branch K1_J7_BACK
K1_REDO:
    s_mov_b32 s83, 1
    s_mov_b32 s63, 1073741824
    s_mov_b32 s64, 1073741824
    s_mov_b32 s62, 1073741824
    s_mul_i32 s7, s5, 1081344
    s_sub_u32 s7, 56623104, s7
    s_sub_u32 s36, s56, s7
    s_subb_u32 s37, s57, 0
    s_mov_b32 s38, 1081344
    s_mov_b32 s50, 0
    s_mov_b32 s54, 0
    s_waitcnt vmcnt(0) lgkmcnt(0)
    s_barrier
    v_lshrrev_b32 v92, 4, v1
    v_and_b32 v64, 15, v92
    v_lshrrev_b32 v92, 4, v92
    v_lshlrev_b32 v92, 2, v92
    v_sub_u32 v92, v64, v92
    s_lshl_b32 s98, s4, 4
    v_add_u32 v92, s98, v92
    s_lshl_b32 s98, s6, 7
    s_sub_u32 s99, 1920, s98
    v_add_u32 v64, s98, v92
    v_add_u32 v65, 64, v64
    v_add_u32 v66, s99, v92
    v_add_u32 v67, 64, v66
    v_mov_b32 v93, 0xf149f2ca
    v_mov_b32 v68, v93
    v_mov_b32 v69, v93
    v_mov_b32 v70, v93
    v_mov_b32 v71, v93
    s_mov_b32 s78, 0
    s_add_u32 s99, s99, 128
K1_REDO_L:
    s_lshr_b32 s7, s78, 6
    s_lshl_b32 s7, s7, 15
    s_bfe_u32 s98, s78, 0x20004
    s_lshl_b32 s98, s98, 12
    s_add_u32 s7, s7, s98
    buffer_load_dwordx4 v[72:75], v1, s[36:39], s7 offen offset:0 sc1
    buffer_load_dwordx4 v[76:79], v1, s[36:39], s7 offen offset:1024 sc1
    buffer_load_dwordx4 v[80:83], v1, s[36:39], s7 offen offset:2048 sc1
    buffer_load_dwordx4 v[84:87], v1, s[36:39], s7 offen offset:3072 sc1
    s_waitcnt vmcnt(0)
    v_mfma_f32_16x16x32_bf16 v[88:91], v[72:75], v[128:131], 0
    v_mfma_f32_16x16x32_bf16 v[88:91], v[76:79], v[160:163], v[88:91]
    v_mfma_f32_16x16x32_bf16 v[88:91], v[80:83], v[192:195], v[88:91]
    v_mfma_f32_16x16x32_bf16 v[88:91], v[84:87], v[224:227], v[88:91]
    v_subrev_u32 v92, s78, v64
    v_cmp_le_i32 vcc, 0, v92
    s_nop 5
    v_cndmask_b32 v88, v93, v88, vcc
    v_max_f32 v68, v68, v88
    v_cmp_le_i32 vcc, 1, v92
    s_nop 1
    v_cndmask_b32 v89, v93, v89, vcc
    v_max_f32 v68, v68, v89
    v_cmp_le_i32 vcc, 2, v92
    s_nop 1
    v_cndmask_b32 v90, v93, v90, vcc
    v_max_f32 v68, v68, v90
    v_cmp_le_i32 vcc, 3, v92
    s_nop 1
    v_cndmask_b32 v91, v93, v91, vcc
    v_max_f32 v68, v68, v91
    v_mfma_f32_16x16x32_bf16 v[88:91], v[72:75], v[132:135], 0
    v_mfma_f32_16x16x32_bf16 v[88:91], v[76:79], v[164:167], v[88:91]
    v_mfma_f32_16x16x32_bf16 v[88:91], v[80:83], v[196:199], v[88:91]
    v_mfma_f32_16x16x32_bf16 v[88:91], v[84:87], v[228:231], v[88:91]
    v_subrev_u32 v92, s78, v65
    v_cmp_le_i32 vcc, 0, v92
    s_nop 5
    v_cndmask_b32 v88, v93, v88, vcc
    v_max_f32 v69, v69, v88
    v_cmp_le_i32 vcc, 1, v92
    s_nop 1
    v_cndmask_b32 v89, v93, v89, vcc
    v_max_f32 v69, v69, v89
    v_cmp_le_i32 vcc, 2, v92
    s_nop 1
    v_cndmask_b32 v90, v93, v90, vcc
    v_max_f32 v69, v69, v90
    v_cmp_le_i32 vcc, 3, v92
    s_nop 1
    v_cndmask_b32 v91, v93, v91, vcc
    v_max_f32 v69, v69, v91
    v_mfma_f32_16x16x32_bf16 v[88:91], v[72:75], v[136:139], 0
    v_mfma_f32_16x16x32_bf16 v[88:91], v[76:79], v[168:171], v[88:91]
    v_mfma_f32_16x16x32_bf16 v[88:91], v[80:83], v[200:203], v[88:91]
    v_mfma_f32_16x16x32_bf16 v[88:91], v[84:87], v[232:235], v[88:91]
    v_subrev_u32 v92, s78, v66
    v_cmp_le_i32 vcc, 0, v92
    s_nop 5
    v_cndmask_b32 v88, v93, v88, vcc
    v_max_f32 v70, v70, v88
    v_cmp_le_i32 vcc, 1, v92
    s_nop 1
    v_cndmask_b32 v89, v93, v89, vcc
    v_max_f32 v70, v70, v89
    v_cmp_le_i32 vcc, 2, v92
    s_nop 1
    v_cndmask_b32 v90, v93, v90, vcc
    v_max_f32 v70, v70, v90
    v_cmp_le_i32 vcc, 3, v92
    s_nop 1
    v_cndmask_b32 v91, v93, v91, vcc
    v_max_f32 v70, v70, v91
    v_mfma_f32_16x16x32_bf16 v[88:91], v[72:75], v[140:143], 0
    v_mfma_f32_16x16x32_bf16 v[88:91], v[76:79], v[172:175], v[88:91]
    v_mfma_f32_16x16x32_bf16 v[88:91], v[80:83], v[204:207], v[88:91]
    v_mfma_f32_16x16x32_bf16 v[88:91], v[84:87], v[236:239], v[88:91]
    v_subrev_u32 v92, s78, v67
    v_cmp_le_i32 vcc, 0, v92
    s_nop 5
    v_cndmask_b32 v88, v93, v88, vcc
    v_max_f32 v71, v71, v88
    v_cmp_le_i32 vcc, 1, v92
    s_nop 1
    v_cndmask_b32 v89, v93, v89, vcc
    v_max_f32 v71, v71, v89
    v_cmp_le_i32 vcc, 2, v92
    s_nop 1
    v_cndmask_b32 v90, v93, v90, vcc
    v_max_f32 v71, v71, v90
    v_cmp_le_i32 vcc, 3, v92
    s_nop 1
    v_cndmask_b32 v91, v93, v91, vcc
    v_max_f32 v71, v71, v91
    s_add_u32 s78, s78, 16
    s_cmp_lt_u32 s78, s99
    s_cbranch_scc1 K1_REDO_L
    v_mov_b32 v92, v68
    s_nop 1
    v_permlane32_swap_b32 v68, v92
    v_max_f32 v68, v68, v92
    v_mov_b32 v92, v68
    s_nop 1
    v_permlane16_swap_b32 v68, v92
    v_max_f32 v68, v68, v92
    v_sub_f32 v144, 0, v68
    v_sub_f32 v145, 0, v68
    v_sub_f32 v146, 0, v68
    v_sub_f32 v147, 0, v68
    v_mov_b32 v92, v69
    s_nop 1
    v_permlane32_swap_b32 v69, v92
    v_max_f32 v69, v69, v92
    v_mov_b32 v92, v69
    s_nop 1
    v_permlane16_swap_b32 v69, v92
    v_max_f32 v69, v69, v92
    v_sub_f32 v148, 0, v69
    v_sub_f32 v149, 0, v69
    v_sub_f32 v150, 0, v69
    v_sub_f32 v151, 0, v69
    v_mov_b32 v92, v70
    s_nop 1
    v_permlane32_swap_b32 v70, v92
    v_max_f32 v70, v70, v92
    v_mov_b32 v92, v70
    s_nop 1
    v_permlane16_swap_b32 v70, v92
    v_max_f32 v70, v70, v92
    v_sub_f32 v152, 0, v70
    v_sub_f32 v153, 0, v70
    v_sub_f32 v154, 0, v70
    v_sub_f32 v155, 0, v70
    v_mov_b32 v92, v71
    s_nop 1
    v_permlane32_swap_b32 v71, v92
    v_max_f32 v71, v71, v92
    v_mov_b32 v92, v71
    s_nop 1
    v_permlane16_swap_b32 v71, v92
    v_max_f32 v71, v71, v92
    v_sub_f32 v156, 0, v71
    v_sub_f32 v157, 0, v71
    v_sub_f32 v158, 0, v71
    v_sub_f32 v159, 0, v71
    v_accvgpr_write_b32 a0, 0
    v_accvgpr_write_b32 a1, 0
    v_accvgpr_write_b32 a2, 0
    v_accvgpr_write_b32 a3, 0
    v_accvgpr_write_b32 a4, 0
    v_accvgpr_write_b32 a5, 0
    v_accvgpr_write_b32 a6, 0
    v_accvgpr_write_b32 a7, 0
    v_accvgpr_write_b32 a8, 0
    v_accvgpr_write_b32 a9, 0
    v_accvgpr_write_b32 a10, 0
    v_accvgpr_write_b32 a11, 0
    v_accvgpr_write_b32 a12, 0
    v_accvgpr_write_b32 a13, 0
    v_accvgpr_write_b32 a14, 0
    v_accvgpr_write_b32 a15, 0
    v_accvgpr_write_b32 a16, 0
    v_accvgpr_write_b32 a17, 0
    v_accvgpr_write_b32 a18, 0
    v_accvgpr_write_b32 a19, 0
    v_accvgpr_write_b32 a20, 0
    v_accvgpr_write_b32 a21, 0
    v_accvgpr_write_b32 a22, 0
    v_accvgpr_write_b32 a23, 0
    v_accvgpr_write_b32 a24, 0
    v_accvgpr_write_b32 a25, 0
    v_accvgpr_write_b32 a26, 0
    v_accvgpr_write_b32 a27, 0
    v_accvgpr_write_b32 a28, 0
    v_accvgpr_write_b32 a29, 0
    v_accvgpr_write_b32 a30, 0
    v_accvgpr_write_b32 a31, 0
    v_accvgpr_write_b32 a32, 0
    v_accvgpr_write_b32 a33, 0
    v_accvgpr_write_b32 a34, 0
    v_accvgpr_write_b32 a35, 0
    v_accvgpr_write_b32 a36, 0
    v_accvgpr_write_b32 a37, 0
    v_accvgpr_write_b32 a38, 0
    v_accvgpr_write_b32 a39, 0
    v_accvgpr_write_b32 a40, 0
    v_accvgpr_write_b32 a41, 0
    v_accvgpr_write_b32 a42, 0
    v_accvgpr_write_b32 a43, 0
    v_accvgpr_write_b32 a44, 0
    v_accvgpr_write_b32 a45, 0
    v_accvgpr_write_b32 a46, 0
    v_accvgpr_write_b32 a47, 0
    v_accvgpr_write_b32 a48, 0
    v_accvgpr_write_b32 a49, 0
    v_accvgpr_write_b32 a50, 0
    v_accvgpr_write_b32 a51, 0
    v_accvgpr_write_b32 a52, 0
    v_accvgpr_write_b32 a53, 0
    v_accvgpr_write_b32 a54, 0
    v_accvgpr_write_b32 a55, 0
    v_accvgpr_write_b32 a56, 0
    v_accvgpr_write_b32 a57, 0
    v_accvgpr_write_b32 a58, 0
    v_accvgpr_write_b32 a59, 0
    v_accvgpr_write_b32 a60, 0
    v_accvgpr_write_b32 a61, 0
    v_accvgpr_write_b32 a62, 0
    v_accvgpr_write_b32 a63, 0
    v_accvgpr_write_b32 a144, 0
    v_accvgpr_write_b32 a145, 0
    v_accvgpr_write_b32 a146, 0
    v_accvgpr_write_b32 a147, 0
    v_accvgpr_write_b32 a148, 0
    v_accvgpr_write_b32 a149, 0
    v_accvgpr_write_b32 a150, 0
    v_accvgpr_write_b32 a151, 0
    v_accvgpr_write_b32 a152, 0
    v_accvgpr_write_b32 a153, 0
    v_accvgpr_write_b32 a154, 0
    v_accvgpr_write_b32 a155, 0
    v_accvgpr_write_b32 a156, 0
    v_accvgpr_write_b32 a157, 0
    v_accvgpr_write_b32 a158, 0
    v_accvgpr_write_b32 a159, 0
    v_accvgpr_write_b32 a160, 0
    v_accvgpr_write_b32 a161, 0
    v_accvgpr_write_b32 a162, 0
    v_accvgpr_write_b32 a163, 0
    v_accvgpr_write_b32 a164, 0
    v_accvgpr_write_b32 a165, 0
    v_accvgpr_write_b32 a166, 0
    v_accvgpr_write_b32 a167, 0
    v_accvgpr_write_b32 a168, 0
    v_accvgpr_write_b32 a169, 0
    v_accvgpr_write_b32 a170, 0
    v_accvgpr_write_b32 a171, 0
    v_accvgpr_write_b32 a172, 0
    v_accvgpr_write_b32 a173, 0
    v_accvgpr_write_b32 a174, 0
    v_accvgpr_write_b32 a175, 0
    v_accvgpr_write_b32 a176, 0
    v_accvgpr_write_b32 a177, 0
    v_accvgpr_write_b32 a178, 0
    v_accvgpr_write_b32 a179, 0
    v_accvgpr_write_b32 a180, 0
    v_accvgpr_write_b32 a181, 0
    v_accvgpr_write_b32 a182, 0
    v_accvgpr_write_b32 a183, 0
    v_accvgpr_write_b32 a184, 0
    v_accvgpr_write_b32 a185, 0
    v_accvgpr_write_b32 a186, 0
    v_accvgpr_write_b32 a187, 0
    v_accvgpr_write_b32 a188, 0
    v_accvgpr_write_b32 a189, 0
    v_accvgpr_write_b32 a190, 0
    v_accvgpr_write_b32 a191, 0
    v_accvgpr_write_b32 a192, 0
    v_accvgpr_write_b32 a193, 0
    v_accvgpr_write_b32 a194, 0
    v_accvgpr_write_b32 a195, 0
    v_accvgpr_write_b32 a196, 0
    v_accvgpr_write_b32 a197, 0
    v_accvgpr_write_b32 a198, 0
    v_accvgpr_write_b32 a199, 0
    v_accvgpr_write_b32 a200, 0
    v_accvgpr_write_b32 a201, 0
    v_accvgpr_write_b32 a202, 0
    v_accvgpr_write_b32 a203, 0
    v_accvgpr_write_b32 a204, 0
    v_accvgpr_write_b32 a205, 0
    v_accvgpr_write_b32 a206, 0
    v_accvgpr_write_b32 a207, 0
    v_accvgpr_write_b32 a208, 0
    v_accvgpr_write_b32 a209, 0
    v_accvgpr_write_b32 a210, 0
    v_accvgpr_write_b32 a211, 0
    v_accvgpr_write_b32 a212, 0
    v_accvgpr_write_b32 a213, 0
    v_accvgpr_write_b32 a214, 0
    v_accvgpr_write_b32 a215, 0
    v_accvgpr_write_b32 a216, 0
    v_accvgpr_write_b32 a217, 0
    v_accvgpr_write_b32 a218, 0
    v_accvgpr_write_b32 a219, 0
    v_accvgpr_write_b32 a220, 0
    v_accvgpr_write_b32 a221, 0
    v_accvgpr_write_b32 a222, 0
    v_accvgpr_write_b32 a223, 0
    v_bfe_u32 v92, v1, 4, 1
    v_sub_u32 v92, 0, v92
    v_and_b32 v92, 0xaaaaaaaa, v92
    v_or_b32 v215, 0x44444444, v92
    v_bfe_u32 v92, v1, 5, 1
    v_cmp_eq_u32 vcc, 0, v92
    v_mov_b32 v92, 0x3f803f80
    s_nop 0
    v_cndmask_b32 v92, 0, v92, vcc
    v_accvgpr_write_b32 a136, v92
    v_accvgpr_write_b32 a137, v92
    v_accvgpr_write_b32 a138, v92
    v_accvgpr_write_b32 a139, v92
    s_mov_b32 s77, s75
    s_mov_b32 s76, 0
    s_mov_b32 s38, 16384
    s_add_u32 m0, s76, s75
    s_nop 0
    buffer_load_dwordx4 v1, s[36:39], s77 offen sc1 lds
    buffer_load_dwordx4 v1, s[36:39], s77 offen offset:1024 sc1 lds
    buffer_load_dwordx4 v1, s[36:39], s77 offen offset:2048 sc1 lds
    buffer_load_dwordx4 v1, s[36:39], s77 offen offset:3072 sc1 lds
    s_add_u32 s100, s77, 4096
    s_add_u32 m0, m0, 4096
    s_nop 0
    buffer_load_dwordx4 v1, s[36:39], s100 offen sc1 lds
    buffer_load_dwordx4 v1, s[36:39], s100 offen offset:1024 sc1 lds
    buffer_load_dwordx4 v1, s[36:39], s100 offen offset:2048 sc1 lds
    buffer_load_dwordx4 v1, s[36:39], s100 offen offset:3072 sc1 lds
    s_add_u32 s77, s77, 32768
    s_add_u32 s76, s76, 32768
    s_lshr_b32 s82, s4, 1
    s_add_u32 s82, s82, 32
    s_sub_u32 s82, s82, s6
    s_sub_u32 s82, s82, s6
    s_lshl_b32 s38, s82, 15
    s_add_u32 m0, s76, s75
    s_nop 0
    buffer_load_dwordx4 v1, s[36:39], s77 offen sc1 lds
    buffer_load_dwordx4 v1, s[36:39], s77 offen offset:1024 sc1 lds
    buffer_load_dwordx4 v1, s[36:39], s77 offen offset:2048 sc1 lds
    buffer_load_dwordx4 v1, s[36:39], s77 offen offset:3072 sc1 lds
    s_add_u32 s100, s77, 4096
    s_add_u32 m0, m0, 4096
    s_nop 0
    buffer_load_dwordx4 v1, s[36:39], s100 offen sc1 lds
    buffer_load_dwordx4 v1, s[36:39], s100 offen offset:1024 sc1 lds
    buffer_load_dwordx4 v1, s[36:39], s100 offen offset:2048 sc1 lds
    buffer_load_dwordx4 v1, s[36:39], s100 offen offset:3072 sc1 lds
    s_add_u32 s77, s77, 32768
    s_add_u32 s76, s76, 32768
    s_add_u32 m0, s76, s75
    s_nop 0
    buffer_load_dwordx4 v1, s[36:39], s77 offen sc1 lds
    buffer_load_dwordx4 v1, s[36:39], s77 offen offset:1024 sc1 lds
    buffer_load_dwordx4 v1, s[36:39], s77 offen offset:2048 sc1 lds
    buffer_load_dwordx4 v1, s[36:39], s77 offen offset:3072 sc1 lds
    s_add_u32 s100, s77, 4096
    s_add_u32 m0, m0, 4096
    s_nop 0
    buffer_load_dwordx4 v1, s[36:39], s100 offen sc1 lds
    buffer_load_dwordx4 v1, s[36:39], s100 offen offset:1024 sc1 lds
    buffer_load_dwordx4 v1, s[36:39], s100 offen offset:2048 sc1 lds
    buffer_load_dwordx4 v1, s[36:39], s100 offen offset:3072 sc1 lds
    s_add_u32 s77, s77, 32768
    s_add_u32 s76, s76, 32768
    s_add_u32 s86, s101, 4096
    s_mov_b32 s87, 3072
    s_cmp_eq_u32 s6, 7
    s_cselect_b32 s86, s101, s86
    s_cselect_b32 s87, 0, s87
    s_sub_u32 s7, s101, 4096
    s_mov_b32 s98, 0
    s_cmp_eq_u32 s6, 0
    s_cselect_b32 s7, s101, s7
    s_cselect_b32 s98, 1073741824, s98
    s_bitcmp1_b32 s4, 0
    s_cselect_b32 s86, s86, s7
    s_cselect_b32 s87, s87, s98
    s_mul_i32 s7, s86, 48
    s_add_u32 s87, s87, s7
    s_add_u32 s87, s87, 19922944
    s_mov_b32 s82, 0
    s_mov_b32 s95, 32768
    s_mov_b32 s93, 65536
    s_mov_b32 s60, 131072
    v_mov_b32 v2, v1
    s_cmp_eq_u32 s6, 0
    s_cselect_b32 s16, s8, 0
    s_cselect_b32 s17, s9, 0
    s_cmp_eq_u32 s6, 0
    s_cselect_b32 s18, s10, 0
    s_cselect_b32 s19, s11, 0
    s_cmp_eq_u32 s6, 0
    s_cselect_b32 s20, s12, 0
    s_cselect_b32 s21, s13, 0
    s_cmp_eq_u32 s6, 0
    s_cselect_b32 s22, s14, 0
    s_cselect_b32 s23, s15, 0
    s_waitcnt vmcnt(16)
    s_barrier
    ds_read_b128 a[224:227], v2 offset:0
    ds_read_b128 a[228:231], v2 offset:1024
    ds_read_b128 a[232:235], v2 offset:2048
    ds_read_b128 a[236:239], v2 offset:3072
    s_waitcnt lgkmcnt(0)
    ds_read_b128 a[240:243], v2 offset:4096
    ds_read_b128 a[244:247], v2 offset:5120
    ds_read_b128 a[248:251], v2 offset:6144
    ds_read_b128 a[252:255], v2 offset:7168
    v_mul_f32 v176, s16, v208
    v_mul_f32 v177, s16, v209
    v_mul_f32 v178, s16, v210
    v_mul_f32 v179, s16, v211
    s_nop 1
    v_mfma_f32_16x16x32_bf16 v[240:243], a[224:227], v[128:131], v[176:179]
    v_mfma_f32_16x16x32_bf16 v[240:243], a[228:231], v[160:163], v[240:243]
    v_mfma_f32_16x16x32_bf16 v[240:243], a[232:235], v[192:195], v[240:243]
    v_mfma_f32_16x16x32_bf16 v[240:243], a[236:239], v[224:227], v[240:243]
    v_mfma_f32_16x16x32_bf16 v[244:247], a[224:227], v[132:135], 0
    v_mfma_f32_16x16x32_bf16 v[244:247], a[228:231], v[164:167], v[244:247]
    v_mfma_f32_16x16x32_bf16 v[244:247], a[232:235], v[196:199], v[244:247]
    v_mfma_f32_16x16x32_bf16 v[244:247], a[236:239], v[228:231], v[244:247]
    v_mfma_f32_16x16x32_bf16 v[248:251], a[224:227], v[136:139], 0
    v_mfma_f32_16x16x32_bf16 v[248:251], a[228:231], v[168:171], v[248:251]
    v_mfma_f32_16x16x32_bf16 v[248:251], a[232:235], v[200:203], v[248:251]
    v_mfma_f32_16x16x32_bf16 v[248:251], a[236:239], v[232:235], v[248:251]
    v_mfma_f32_16x16x32_bf16 v[252:255], a[224:227], v[140:143], 0
    v_mfma_f32_16x16x32_bf16 v[252:255], a[228:231], v[172:175], v[252:255]
    v_mfma_f32_16x16x32_bf16 v[252:255], a[232:235], v[204:207], v[252:255]
    v_mfma_f32_16x16x32_bf16 v[252:255], a[236:239], v[236:239], v[252:255]
    v_add_f32 v240, v240, v144
    v_exp_f32 v240, v240
    v_add_f32 v241, v241, v144
    v_exp_f32 v241, v241
    v_add_f32 v242, v242, v144
    v_exp_f32 v242, v242
    v_add_f32 v243, v243, v144
    v_exp_f32 v243, v243
    v_add_f32 v244, v244, v148
    v_exp_f32 v244, v244
    v_add_f32 v245, v245, v148
    v_exp_f32 v245, v245
    v_add_f32 v246, v246, v148
    v_exp_f32 v246, v246
    v_add_f32 v247, v247, v148
    v_exp_f32 v247, v247
    v_add_f32 v248, v248, v152
    v_exp_f32 v248, v248
    v_add_f32 v249, v249, v152
    v_exp_f32 v249, v249
    v_add_f32 v250, v250, v152
    v_exp_f32 v250, v250
    v_add_f32 v251, v251, v152
    v_exp_f32 v251, v251
    v_add_f32 v252, v252, v156
    v_exp_f32 v252, v252
    v_add_f32 v253, v253, v156
    v_exp_f32 v253, v253
    v_add_f32 v254, v254, v156
    v_exp_f32 v254, v254
    v_add_f32 v255, v255, v156
    v_exp_f32 v255, v255
    s_nop 1
    s_branch K1_ATT
SPIN_WA:
    s_mov_b32 s94, 0
SPIN_WA_L:
    s_sleep 2
    buffer_load_dword v7, v9, s[44:47], s69 offen sc1
    s_add_u32 s94, s94, 1
    s_cmp_ge_u32 s94, 0x40000
    s_waitcnt vmcnt(0)
    s_cbranch_scc1 BACK_WA
    v_cmp_gt_u32 vcc, 8, v7
    s_nop 1
    s_and_b64 vcc, vcc, s[86:87]
    s_cbranch_scc1 SPIN_WA_L
    s_branch BACK_WA
SPIN_KV:
    s_mov_b32 s94, 0
SPIN_KV_L:
    s_sleep 2
    buffer_load_dword v7, v8, s[32:35], s61 offen sc1
    s_add_u32 s94, s94, 1
    s_cmp_ge_u32 s94, 0x40000
    s_waitcnt vmcnt(0)
    s_cbranch_scc1 BACK_KV
    v_cmp_gt_u32 vcc, 1, v7
    s_nop 1
    s_and_b64 vcc, vcc, exec
    s_cbranch_scc1 SPIN_KV_L
    s_branch BACK_KV
SPIN_SHORT:
    s_mov_b32 s94, 0
SPIN_SHORT_L:
    s_sleep 2
    buffer_load_dword v3, v217, s[32:35], s19 offen sc1
    s_add_u32 s94, s94, 1
    s_cmp_ge_u32 s94, 0x40000
    s_waitcnt vmcnt(0)
    s_cbranch_scc1 BACK_SHORT
    v_cmp_gt_u32 vcc, 1, v3
    s_nop 1
    s_and_b64 vcc, vcc, exec
    s_cbranch_scc1 SPIN_SHORT_L
    s_branch BACK_SHORT
SPIN_CTX:
    s_mov_b32 s94, 0
SPIN_CTX_L:
    s_sleep 2
    buffer_load_dword v3, v217, s[32:35], s19 offen sc1
    s_add_u32 s94, s94, 1
    s_cmp_ge_u32 s94, 0x40000
    s_waitcnt vmcnt(0)
    s_cbranch_scc1 BACK_CTX
    v_cmp_gt_u32 vcc, 2, v3
    s_nop 1
    s_and_b64 vcc, vcc, exec
    s_cbranch_scc1 SPIN_CTX_L
    s_branch BACK_CTX
SPIN_ALL:
    s_mov_b32 s94, 0
SPIN_ALL_L:
    s_sleep 2
    buffer_load_dword v28, v29, s[32:35], s92 offen sc1
    s_add_u32 s94, s94, 1
    s_cmp_ge_u32 s94, 0x40000
    s_waitcnt vmcnt(0)
    s_cbranch_scc1 BACK_ALL
    v_cmp_gt_u32 vcc, 1, v28
    s_nop 1
    s_and_b64 vcc, vcc, exec
    s_cbranch_scc1 SPIN_ALL_L
    s_branch BACK_ALL
SPIN_OA:
    s_mov_b32 s94, 0
SPIN_OA_L:
    s_sleep 2
    buffer_load_dword v3, v19, s[32:35], s66 offen sc1
    s_add_u32 s94, s94, 1
    s_cmp_ge_u32 s94, 0x40000
    s_waitcnt vmcnt(0)
    s_cbranch_scc1 BACK_OA
    v_cmp_gt_u32 vcc, 3, v3
    s_nop 1
    s_and_b64 vcc, vcc, exec
    s_cbranch_scc1 SPIN_OA_L
    s_branch BACK_OA
SPIN_X:
    s_mov_b32 s94, 0
SPIN_X_L:
    s_sleep 2
    buffer_load_dword v3, v19, s[32:35], s66 offen sc1
    s_add_u32 s94, s94, 1
    s_cmp_ge_u32 s94, 0x40000
    s_waitcnt vmcnt(0)
    s_cbranch_scc1 BACK_X
    v_cmp_gt_u32 vcc, 3, v3
    s_nop 1
    s_and_b64 vcc, vcc, exec
    s_cbranch_scc1 SPIN_X_L
    s_branch BACK_X
SPIN_W0H:
    s_mov_b32 s94, 0
SPIN_W0H_L:
    s_sleep 2
    buffer_load_dword v28, off, s[32:35], s86 sc1
    s_add_u32 s94, s94, 1
    s_cmp_ge_u32 s94, 0x40000
    s_waitcnt vmcnt(0)
    s_cbranch_scc1 BACK_W0H
    v_cmp_gt_u32 vcc, 2, v28
    s_nop 1
    s_and_b64 vcc, vcc, exec
    s_cbranch_scc1 SPIN_W0H_L
    s_branch BACK_W0H
SPIN_W0:
    s_mov_b32 s94, 0
SPIN_W0_L:
    s_sleep 2
    buffer_load_dword v3, v29, s[32:35], s92 offen sc1
    s_add_u32 s94, s94, 1
    s_cmp_ge_u32 s94, 0x40000
    s_waitcnt vmcnt(0)
    s_cbranch_scc1 BACK_W0
    v_cmp_gt_u32 vcc, 1, v3
    s_nop 1
    s_cmp_lg_u32 vcc_lo, 0
    s_cbranch_scc1 SPIN_W0_L
    s_branch BACK_W0
SPIN_W7H:
    s_mov_b32 s94, 0
SPIN_W7H_L:
    s_sleep 2
    buffer_load_dword v28, off, s[32:35], s86 sc1
    s_add_u32 s94, s94, 1
    s_cmp_ge_u32 s94, 0x40000
    s_waitcnt vmcnt(0)
    s_cbranch_scc1 BACK_W7H
    v_cmp_gt_u32 vcc, 2, v28
    s_nop 1
    s_and_b64 vcc, vcc, exec
    s_cbranch_scc1 SPIN_W7H_L
    s_branch BACK_W7H
SPIN_W7:
    s_mov_b32 s94, 0
SPIN_W7_L:
    s_sleep 2
    buffer_load_dword v3, v29, s[32:35], s92 offen sc1
    s_add_u32 s94, s94, 1
    s_cmp_ge_u32 s94, 0x40000
    s_waitcnt vmcnt(0)
    s_cbranch_scc1 BACK_W7
    v_cmp_gt_u32 vcc, 1, v3
    s_nop 1
    s_cmp_lg_u32 vcc_lo, 0
    s_cbranch_scc1 SPIN_W7_L
    s_branch BACK_W7
.section .rodata,"a"
.p2align 6
.amdhsa_kernel gated_mix__sliding_local_dilated__compressed_kv_cla__prompt_kernel
.amdhsa_next_free_vgpr 512
.amdhsa_next_free_sgpr 102
.amdhsa_accum_offset 256
.amdhsa_group_segment_fixed_size 0
.amdhsa_kernarg_size 104
.amdhsa_user_sgpr_count 2
.amdhsa_user_sgpr_kernarg_segment_ptr 1
.amdhsa_system_sgpr_workgroup_id_x 1
.amdhsa_ieee_mode 0
.amdhsa_dx10_clamp 0
.end_amdhsa_kernel
```
